```python
import torch

def _softmax(x, axis=-1):
    return torch.softmax(x, dim=axis)
def _gelu(x):
    return torch.nn.functional.gelu(x, approximate="tanh")
def _silu(x):
    return torch.nn.functional.silu(x)
def _sigmoid(x):
    return torch.sigmoid(x)
def _layernorm(x, axis=-1, eps=1e-5):
    m = x.mean(dim=axis, keepdim=True)
    v = x.var(dim=axis, keepdim=True, unbiased=False)
    return (x - m) / torch.sqrt(v + eps)
def _scatter_add(tgt, idx, src, axis=0):
    return tgt.clone().index_add_(axis, idx, src)
def _segment_sum(src, seg, n):
    out = torch.zeros((n,) + src.shape[1:], dtype=src.dtype)
    return out.index_add_(0, seg, src)
def _pad(x, pw):
    flat = tuple(v for pair in reversed(pw) for v in pair)
    return torch.nn.functional.pad(x, flat)

kernel_name = 'recurrent_scan__mha_block_cached__moe_arch_mod__prompt'

def setup_inputs():

    _w = (lambda a: (lambda t: t.to(torch.bfloat16) if t.is_floating_point() else t)(torch.as_tensor(a)))
    def _A_setup():
        B, Sq, D = 1, 2048, 640
        H, Sk, Dh = 32, 2048, 128
        return {
            "x": _w((lambda *s: torch.randn(*s, dtype=torch.bfloat16) * 0.05)(B, Sq, D)),
            "k_cache": _w((lambda *s: torch.randn(*s, dtype=torch.bfloat16) * 1.6)(B, H, Sk, Dh)),
            "v_cache": _w((lambda *s: torch.randn(*s, dtype=torch.bfloat16) * 0.2)(B, H, Sk, Dh)),
            "wq": _w((lambda *s: torch.randn(*s, dtype=torch.bfloat16) * 1.6)(D, H * Dh) * (D ** -0.5)),
            "wo": _w((lambda *s: torch.randn(*s, dtype=torch.bfloat16) * 0.2)(H * Dh, D) * ((H * Dh) ** -0.5)),
        }
    _A_in = _A_setup()

    def _B_setup():
        B, S, D, F, C = 1, 2048, 640, 1728, 8
        return {
            "x": _w((lambda *s: torch.randn(*s, dtype=torch.bfloat16) * 0.05)(B, S, D)),
            "w_r": _w((lambda *s: torch.randn(*s, dtype=torch.bfloat16) * 0.2)(D)),
            "w_gate": _w((lambda *s: torch.randn(*s, dtype=torch.bfloat16) * 0.1)(D, F)),
            "w_up": _w((lambda *s: torch.randn(*s, dtype=torch.bfloat16) * 0.1)(D, F)),
            "w_down": _w((lambda *s: torch.randn(*s, dtype=torch.bfloat16) * 0.1)(F, D)),
        }
    _B_in = _B_setup()

    return {
        "A_x": _A_in["x"],
        "A_k_cache": _A_in["k_cache"],
        "A_v_cache": _A_in["v_cache"],
        "A_wq": _A_in["wq"],
        "A_wo": _A_in["wo"],
        "B_x": _B_in["x"],
        "B_w_r": _B_in["w_r"],
        "B_w_gate": _B_in["w_gate"],
        "B_w_up": _B_in["w_up"],
        "B_w_down": _B_in["w_down"],
    }

def reference(A_x, A_k_cache, A_v_cache, A_wq, A_wo, B_x, B_w_r, B_w_gate, B_w_up, B_w_down):
    def _A_ref(x, k_cache, v_cache, wq, wo):
        B, Sq, D = x.shape
        H, Dh = 32, 128
        q = (lambda x, *d: x.permute(*d))((x @ wq).reshape(B, Sq, H, Dh), 0, 2, 1, 3)
        scores = torch.einsum("bhqd,bhkd->bhqk", q, k_cache) * (Dh ** -0.5)
        p = _softmax(scores, axis=-1)
        o = torch.einsum("bhqk,bhkd->bhqd", p, v_cache)
        return (lambda x, *d: x.permute(*d))(o, 0, 2, 1, 3).reshape(B, Sq, H * Dh) @ wo

    def _B_ref(x, w_r, w_gate, w_up, w_down):
        B, S, D = x.shape
        C = 8
        r = x @ w_r
        idx = torch.argsort(-r, axis=-1)[:, :C]
        idx_e = (lambda x, n, axis: torch.repeat_interleave(x, n, dim=axis))(idx.reshape(B, C, 1), D, axis=2)
        x_sel = (lambda x, i, axis: torch.take_along_dim(x, i, dim=axis))(x, idx_e, axis=1)
        g = _silu(x_sel @ w_gate)
        u = x_sel @ w_up
        y = (g * u) @ w_down
        r_sel = _sigmoid((lambda x, i, axis: torch.take_along_dim(x, i, dim=axis))(r, idx, axis=1))
        y = y * r_sel.reshape(B, C, 1)
        b_off = (torch.arange(B) * S).reshape(B, 1)
        flat_idx = (idx + b_off).reshape(B * C)
        zero = (x * 0.0).reshape(B * S, D)
        upd = _scatter_add(zero, flat_idx, y.reshape(B * C, D), axis=0)
        return x + upd.reshape(B, S, D)

    x = A_x
    xn = _layernorm(x, axis=-1)
    s = _A_ref(xn, A_k_cache, A_v_cache, A_wq, A_wo)
    g = _silu(_B_ref(xn, B_w_r, B_w_gate, B_w_up, B_w_down))
    return x + s * g
```

```asm
; @launch kernel=prep_kernel grid=(256,1,1) block=(256,1,1) lds=20480
; @launch kernel=ffn1_kernel grid=(216,1,1) block=(256,1,1) lds=28672
; @launch kernel=ffn2_kernel grid=(240,1,1) block=(256,1,1) lds=16384
; @launch kernel=attn_kernel grid=(256,1,1) block=(256,1,1) lds=132096
; @launch kernel=out_kernel grid=(256,1,1) block=(256,1,1) lds=61440
.amdgcn_target "amdgcn-amd-amdhsa--gfx950"
.text
.globl prep_kernel
.p2align 8
.type prep_kernel,@function
prep_kernel:
  s_cmp_ge_u32 s2, 256
  s_cbranch_scc1 prep_end
  s_load_dwordx2 s[4:5], s[0:1], 0
  s_load_dwordx2 s[6:7], s[0:1], 32
  s_load_dwordx2 s[8:9], s[0:1], 48
  s_load_dwordx2 s[10:11], s[0:1], 96
  v_lshrrev_b32 v1, 6, v0
  v_and_b32 v0, 63, v0
  v_readfirstlane_b32 s3, v1
  s_waitcnt lgkmcnt(0)
  s_mov_b32 s12, s4
  s_mov_b32 s13, s5
  s_mov_b32 s14, 2621440
  s_mov_b32 s15, 0x20000
  s_mov_b32 s16, s6
  s_mov_b32 s17, s7
  s_mov_b32 s18, 5242880
  s_mov_b32 s19, 0x20000
  s_mov_b32 s20, s8
  s_mov_b32 s21, s9
  s_mov_b32 s22, 1280
  s_mov_b32 s23, 0x20000
  s_mov_b32 s24, s10
  s_mov_b32 s25, s11
  s_mov_b32 s26, 8388608
  s_mov_b32 s27, 0x20000
  s_cmp_ge_u32 s3, 2
  s_cbranch_scc1 prep_wof
  s_lshl_b32 s28, s2, 3
  s_lshl_b32 s29, s3, 2
  s_add_u32 s28, s28, s29
  s_mul_i32 s29, s28, 1280
  v_lshrrev_b32 v1, 4, v0
  v_and_b32 v2, 15, v0
  v_lshlrev_b32 v3, 4, v2
  v_mul_u32_u24 v4, 0x500, v1
  v_add_u32 v4, v4, v3
  buffer_load_dwordx4 v[8:11], v4, s[12:15], s29 offen offset:0
  buffer_load_dwordx4 v[12:15], v4, s[12:15], s29 offen offset:256
  buffer_load_dwordx4 v[16:19], v4, s[12:15], s29 offen offset:512
  buffer_load_dwordx4 v[20:23], v4, s[12:15], s29 offen offset:768
  buffer_load_dwordx4 v[24:27], v4, s[12:15], s29 offen offset:1024
  buffer_load_dwordx4 v[28:31], v3, s[20:23], 0 offen offset:0
  buffer_load_dwordx4 v[32:35], v3, s[20:23], 0 offen offset:256
  buffer_load_dwordx4 v[36:39], v3, s[20:23], 0 offen offset:512
  buffer_load_dwordx4 v[40:43], v3, s[20:23], 0 offen offset:768
  buffer_load_dwordx4 v[44:47], v3, s[20:23], 0 offen offset:1024
  s_lshr_b32 s30, s28, 6
  s_mul_i32 s30, s30, 81920
  s_bfe_u32 s31, s28, 0x20004
  s_lshl_b32 s31, s31, 10
  s_add_u32 s30, s30, s31
  s_and_b32 s31, s28, 15
  s_lshl_b32 s31, s31, 4
  s_add_u32 s30, s30, s31
  v_lshrrev_b32 v5, 2, v2
  v_lshlrev_b32 v5, 12, v5
  v_and_b32 v6, 3, v2
  v_lshl_add_u32 v5, v6, 8, v5
  v_lshl_add_u32 v5, v1, 4, v5
  s_mov_b32 s33, 0xffff0000
  s_waitcnt vmcnt(9)
  v_lshlrev_b32 v48, 16, v8
  v_and_b32 v49, s33, v8
  v_lshlrev_b32 v50, 16, v9
  v_and_b32 v51, s33, v9
  v_lshlrev_b32 v52, 16, v10
  v_and_b32 v53, s33, v10
  v_lshlrev_b32 v54, 16, v11
  v_and_b32 v55, s33, v11
  s_waitcnt vmcnt(8)
  v_lshlrev_b32 v56, 16, v12
  v_and_b32 v57, s33, v12
  v_lshlrev_b32 v58, 16, v13
  v_and_b32 v59, s33, v13
  v_lshlrev_b32 v60, 16, v14
  v_and_b32 v61, s33, v14
  v_lshlrev_b32 v62, 16, v15
  v_and_b32 v63, s33, v15
  s_waitcnt vmcnt(7)
  v_lshlrev_b32 v64, 16, v16
  v_and_b32 v65, s33, v16
  v_lshlrev_b32 v66, 16, v17
  v_and_b32 v67, s33, v17
  v_lshlrev_b32 v68, 16, v18
  v_and_b32 v69, s33, v18
  v_lshlrev_b32 v70, 16, v19
  v_and_b32 v71, s33, v19
  s_waitcnt vmcnt(6)
  v_lshlrev_b32 v72, 16, v20
  v_and_b32 v73, s33, v20
  v_lshlrev_b32 v74, 16, v21
  v_and_b32 v75, s33, v21
  v_lshlrev_b32 v76, 16, v22
  v_and_b32 v77, s33, v22
  v_lshlrev_b32 v78, 16, v23
  v_and_b32 v79, s33, v23
  s_waitcnt vmcnt(5)
  v_lshlrev_b32 v80, 16, v24
  v_and_b32 v81, s33, v24
  v_lshlrev_b32 v82, 16, v25
  v_and_b32 v83, s33, v25
  v_lshlrev_b32 v84, 16, v26
  v_and_b32 v85, s33, v26
  v_lshlrev_b32 v86, 16, v27
  v_and_b32 v87, s33, v27
  v_pk_add_f32 v[88:89], v[48:49], v[50:51]
  v_pk_add_f32 v[90:91], v[52:53], v[54:55]
  v_pk_add_f32 v[88:89], v[88:89], v[56:57]
  v_pk_add_f32 v[90:91], v[90:91], v[58:59]
  v_pk_add_f32 v[88:89], v[88:89], v[60:61]
  v_pk_add_f32 v[90:91], v[90:91], v[62:63]
  v_pk_add_f32 v[88:89], v[88:89], v[64:65]
  v_pk_add_f32 v[90:91], v[90:91], v[66:67]
  v_pk_add_f32 v[88:89], v[88:89], v[68:69]
  v_pk_add_f32 v[90:91], v[90:91], v[70:71]
  v_pk_add_f32 v[88:89], v[88:89], v[72:73]
  v_pk_add_f32 v[90:91], v[90:91], v[74:75]
  v_pk_add_f32 v[88:89], v[88:89], v[76:77]
  v_pk_add_f32 v[90:91], v[90:91], v[78:79]
  v_pk_add_f32 v[88:89], v[88:89], v[80:81]
  v_pk_add_f32 v[90:91], v[90:91], v[82:83]
  v_pk_add_f32 v[88:89], v[88:89], v[84:85]
  v_pk_add_f32 v[90:91], v[90:91], v[86:87]
  v_pk_add_f32 v[88:89], v[88:89], v[90:91]
  v_add_f32 v92, v88, v89
  s_nop 1
  v_add_f32_dpp v92, v92, v92 row_ror:8 row_mask:0xf bank_mask:0xf
  s_nop 1
  v_add_f32_dpp v92, v92, v92 row_ror:4 row_mask:0xf bank_mask:0xf
  s_nop 1
  v_add_f32_dpp v92, v92, v92 row_ror:2 row_mask:0xf bank_mask:0xf
  s_nop 1
  v_add_f32_dpp v92, v92, v92 row_ror:1 row_mask:0xf bank_mask:0xf
  v_mul_f32 v92, 0x3acccccd, v92
  v_pk_add_f32 v[94:95], v[48:49], v[92:93] op_sel_hi:[1,0] neg_lo:[0,1] neg_hi:[0,1]
  v_pk_mul_f32 v[88:89], v[94:95], v[94:95]
  v_pk_add_f32 v[96:97], v[50:51], v[92:93] op_sel_hi:[1,0] neg_lo:[0,1] neg_hi:[0,1]
  v_pk_mul_f32 v[90:91], v[96:97], v[96:97]
  v_pk_add_f32 v[94:95], v[52:53], v[92:93] op_sel_hi:[1,0] neg_lo:[0,1] neg_hi:[0,1]
  v_pk_fma_f32 v[88:89], v[94:95], v[94:95], v[88:89]
  v_pk_add_f32 v[96:97], v[54:55], v[92:93] op_sel_hi:[1,0] neg_lo:[0,1] neg_hi:[0,1]
  v_pk_fma_f32 v[90:91], v[96:97], v[96:97], v[90:91]
  v_pk_add_f32 v[94:95], v[56:57], v[92:93] op_sel_hi:[1,0] neg_lo:[0,1] neg_hi:[0,1]
  v_pk_fma_f32 v[88:89], v[94:95], v[94:95], v[88:89]
  v_pk_add_f32 v[96:97], v[58:59], v[92:93] op_sel_hi:[1,0] neg_lo:[0,1] neg_hi:[0,1]
  v_pk_fma_f32 v[90:91], v[96:97], v[96:97], v[90:91]
  v_pk_add_f32 v[94:95], v[60:61], v[92:93] op_sel_hi:[1,0] neg_lo:[0,1] neg_hi:[0,1]
  v_pk_fma_f32 v[88:89], v[94:95], v[94:95], v[88:89]
  v_pk_add_f32 v[96:97], v[62:63], v[92:93] op_sel_hi:[1,0] neg_lo:[0,1] neg_hi:[0,1]
  v_pk_fma_f32 v[90:91], v[96:97], v[96:97], v[90:91]
  v_pk_add_f32 v[94:95], v[64:65], v[92:93] op_sel_hi:[1,0] neg_lo:[0,1] neg_hi:[0,1]
  v_pk_fma_f32 v[88:89], v[94:95], v[94:95], v[88:89]
  v_pk_add_f32 v[96:97], v[66:67], v[92:93] op_sel_hi:[1,0] neg_lo:[0,1] neg_hi:[0,1]
  v_pk_fma_f32 v[90:91], v[96:97], v[96:97], v[90:91]
  v_pk_add_f32 v[94:95], v[68:69], v[92:93] op_sel_hi:[1,0] neg_lo:[0,1] neg_hi:[0,1]
  v_pk_fma_f32 v[88:89], v[94:95], v[94:95], v[88:89]
  v_pk_add_f32 v[96:97], v[70:71], v[92:93] op_sel_hi:[1,0] neg_lo:[0,1] neg_hi:[0,1]
  v_pk_fma_f32 v[90:91], v[96:97], v[96:97], v[90:91]
  v_pk_add_f32 v[94:95], v[72:73], v[92:93] op_sel_hi:[1,0] neg_lo:[0,1] neg_hi:[0,1]
  v_pk_fma_f32 v[88:89], v[94:95], v[94:95], v[88:89]
  v_pk_add_f32 v[96:97], v[74:75], v[92:93] op_sel_hi:[1,0] neg_lo:[0,1] neg_hi:[0,1]
  v_pk_fma_f32 v[90:91], v[96:97], v[96:97], v[90:91]
  v_pk_add_f32 v[94:95], v[76:77], v[92:93] op_sel_hi:[1,0] neg_lo:[0,1] neg_hi:[0,1]
  v_pk_fma_f32 v[88:89], v[94:95], v[94:95], v[88:89]
  v_pk_add_f32 v[96:97], v[78:79], v[92:93] op_sel_hi:[1,0] neg_lo:[0,1] neg_hi:[0,1]
  v_pk_fma_f32 v[90:91], v[96:97], v[96:97], v[90:91]
  v_pk_add_f32 v[94:95], v[80:81], v[92:93] op_sel_hi:[1,0] neg_lo:[0,1] neg_hi:[0,1]
  v_pk_fma_f32 v[88:89], v[94:95], v[94:95], v[88:89]
  v_pk_add_f32 v[96:97], v[82:83], v[92:93] op_sel_hi:[1,0] neg_lo:[0,1] neg_hi:[0,1]
  v_pk_fma_f32 v[90:91], v[96:97], v[96:97], v[90:91]
  v_pk_add_f32 v[94:95], v[84:85], v[92:93] op_sel_hi:[1,0] neg_lo:[0,1] neg_hi:[0,1]
  v_pk_fma_f32 v[88:89], v[94:95], v[94:95], v[88:89]
  v_pk_add_f32 v[96:97], v[86:87], v[92:93] op_sel_hi:[1,0] neg_lo:[0,1] neg_hi:[0,1]
  v_pk_fma_f32 v[90:91], v[96:97], v[96:97], v[90:91]
  v_pk_add_f32 v[88:89], v[88:89], v[90:91]
  v_add_f32 v98, v88, v89
  s_nop 1
  v_add_f32_dpp v98, v98, v98 row_ror:8 row_mask:0xf bank_mask:0xf
  s_nop 1
  v_add_f32_dpp v98, v98, v98 row_ror:4 row_mask:0xf bank_mask:0xf
  s_nop 1
  v_add_f32_dpp v98, v98, v98 row_ror:2 row_mask:0xf bank_mask:0xf
  s_nop 1
  v_add_f32_dpp v98, v98, v98 row_ror:1 row_mask:0xf bank_mask:0xf
  v_mul_f32 v98, 0x3acccccd, v98
  v_cvt_pk_bf16_f32 v92, v92, v92
  v_lshlrev_b32 v92, 16, v92
  v_cvt_pk_bf16_f32 v98, v98, v98
  v_lshlrev_b32 v98, 16, v98
  v_add_f32 v98, 0x3727c5ac, v98
  v_cvt_pk_bf16_f32 v98, v98, v98
  v_lshlrev_b32 v98, 16, v98
  v_sqrt_f32 v98, v98
  s_nop 0
  v_cvt_pk_bf16_f32 v98, v98, v98
  v_lshlrev_b32 v98, 16, v98
  v_rcp_f32 v100, v98
  v_mov_b32 v102, 0
  v_mov_b32 v103, 0
  v_pk_add_f32 v[48:49], v[48:49], v[92:93] op_sel_hi:[1,0] neg_lo:[0,1] neg_hi:[0,1]
  v_pk_add_f32 v[50:51], v[50:51], v[92:93] op_sel_hi:[1,0] neg_lo:[0,1] neg_hi:[0,1]
  v_pk_add_f32 v[52:53], v[52:53], v[92:93] op_sel_hi:[1,0] neg_lo:[0,1] neg_hi:[0,1]
  v_pk_add_f32 v[54:55], v[54:55], v[92:93] op_sel_hi:[1,0] neg_lo:[0,1] neg_hi:[0,1]
  v_pk_add_f32 v[56:57], v[56:57], v[92:93] op_sel_hi:[1,0] neg_lo:[0,1] neg_hi:[0,1]
  v_pk_add_f32 v[58:59], v[58:59], v[92:93] op_sel_hi:[1,0] neg_lo:[0,1] neg_hi:[0,1]
  v_pk_add_f32 v[60:61], v[60:61], v[92:93] op_sel_hi:[1,0] neg_lo:[0,1] neg_hi:[0,1]
  v_pk_add_f32 v[62:63], v[62:63], v[92:93] op_sel_hi:[1,0] neg_lo:[0,1] neg_hi:[0,1]
  v_pk_add_f32 v[64:65], v[64:65], v[92:93] op_sel_hi:[1,0] neg_lo:[0,1] neg_hi:[0,1]
  v_pk_add_f32 v[66:67], v[66:67], v[92:93] op_sel_hi:[1,0] neg_lo:[0,1] neg_hi:[0,1]
  v_pk_add_f32 v[68:69], v[68:69], v[92:93] op_sel_hi:[1,0] neg_lo:[0,1] neg_hi:[0,1]
  v_pk_add_f32 v[70:71], v[70:71], v[92:93] op_sel_hi:[1,0] neg_lo:[0,1] neg_hi:[0,1]
  v_pk_add_f32 v[72:73], v[72:73], v[92:93] op_sel_hi:[1,0] neg_lo:[0,1] neg_hi:[0,1]
  v_pk_add_f32 v[74:75], v[74:75], v[92:93] op_sel_hi:[1,0] neg_lo:[0,1] neg_hi:[0,1]
  v_pk_add_f32 v[76:77], v[76:77], v[92:93] op_sel_hi:[1,0] neg_lo:[0,1] neg_hi:[0,1]
  v_pk_add_f32 v[78:79], v[78:79], v[92:93] op_sel_hi:[1,0] neg_lo:[0,1] neg_hi:[0,1]
  v_pk_add_f32 v[80:81], v[80:81], v[92:93] op_sel_hi:[1,0] neg_lo:[0,1] neg_hi:[0,1]
  v_pk_add_f32 v[82:83], v[82:83], v[92:93] op_sel_hi:[1,0] neg_lo:[0,1] neg_hi:[0,1]
  v_pk_add_f32 v[84:85], v[84:85], v[92:93] op_sel_hi:[1,0] neg_lo:[0,1] neg_hi:[0,1]
  v_pk_add_f32 v[86:87], v[86:87], v[92:93] op_sel_hi:[1,0] neg_lo:[0,1] neg_hi:[0,1]
  v_cvt_pk_bf16_f32 v8, v48, v49
  v_cvt_pk_bf16_f32 v9, v50, v51
  v_cvt_pk_bf16_f32 v10, v52, v53
  v_cvt_pk_bf16_f32 v11, v54, v55
  v_cvt_pk_bf16_f32 v12, v56, v57
  v_cvt_pk_bf16_f32 v13, v58, v59
  v_cvt_pk_bf16_f32 v14, v60, v61
  v_cvt_pk_bf16_f32 v15, v62, v63
  v_cvt_pk_bf16_f32 v16, v64, v65
  v_cvt_pk_bf16_f32 v17, v66, v67
  v_cvt_pk_bf16_f32 v18, v68, v69
  v_cvt_pk_bf16_f32 v19, v70, v71
  v_cvt_pk_bf16_f32 v20, v72, v73
  v_cvt_pk_bf16_f32 v21, v74, v75
  v_cvt_pk_bf16_f32 v22, v76, v77
  v_cvt_pk_bf16_f32 v23, v78, v79
  v_cvt_pk_bf16_f32 v24, v80, v81
  v_cvt_pk_bf16_f32 v25, v82, v83
  v_cvt_pk_bf16_f32 v26, v84, v85
  v_cvt_pk_bf16_f32 v27, v86, v87
  v_lshlrev_b32 v48, 16, v8
  v_and_b32 v49, s33, v8
  v_lshlrev_b32 v50, 16, v9
  v_and_b32 v51, s33, v9
  v_lshlrev_b32 v52, 16, v10
  v_and_b32 v53, s33, v10
  v_lshlrev_b32 v54, 16, v11
  v_and_b32 v55, s33, v11
  v_lshlrev_b32 v56, 16, v12
  v_and_b32 v57, s33, v12
  v_lshlrev_b32 v58, 16, v13
  v_and_b32 v59, s33, v13
  v_lshlrev_b32 v60, 16, v14
  v_and_b32 v61, s33, v14
  v_lshlrev_b32 v62, 16, v15
  v_and_b32 v63, s33, v15
  v_lshlrev_b32 v64, 16, v16
  v_and_b32 v65, s33, v16
  v_lshlrev_b32 v66, 16, v17
  v_and_b32 v67, s33, v17
  v_lshlrev_b32 v68, 16, v18
  v_and_b32 v69, s33, v18
  v_lshlrev_b32 v70, 16, v19
  v_and_b32 v71, s33, v19
  v_lshlrev_b32 v72, 16, v20
  v_and_b32 v73, s33, v20
  v_lshlrev_b32 v74, 16, v21
  v_and_b32 v75, s33, v21
  v_lshlrev_b32 v76, 16, v22
  v_and_b32 v77, s33, v22
  v_lshlrev_b32 v78, 16, v23
  v_and_b32 v79, s33, v23
  v_lshlrev_b32 v80, 16, v24
  v_and_b32 v81, s33, v24
  v_lshlrev_b32 v82, 16, v25
  v_and_b32 v83, s33, v25
  v_lshlrev_b32 v84, 16, v26
  v_and_b32 v85, s33, v26
  v_lshlrev_b32 v86, 16, v27
  v_and_b32 v87, s33, v27
  v_pk_mul_f32 v[48:49], v[48:49], v[100:101] op_sel_hi:[1,0]
  v_pk_mul_f32 v[50:51], v[50:51], v[100:101] op_sel_hi:[1,0]
  v_pk_mul_f32 v[52:53], v[52:53], v[100:101] op_sel_hi:[1,0]
  v_pk_mul_f32 v[54:55], v[54:55], v[100:101] op_sel_hi:[1,0]
  v_pk_mul_f32 v[56:57], v[56:57], v[100:101] op_sel_hi:[1,0]
  v_pk_mul_f32 v[58:59], v[58:59], v[100:101] op_sel_hi:[1,0]
  v_pk_mul_f32 v[60:61], v[60:61], v[100:101] op_sel_hi:[1,0]
  v_pk_mul_f32 v[62:63], v[62:63], v[100:101] op_sel_hi:[1,0]
  v_pk_mul_f32 v[64:65], v[64:65], v[100:101] op_sel_hi:[1,0]
  v_pk_mul_f32 v[66:67], v[66:67], v[100:101] op_sel_hi:[1,0]
  v_pk_mul_f32 v[68:69], v[68:69], v[100:101] op_sel_hi:[1,0]
  v_pk_mul_f32 v[70:71], v[70:71], v[100:101] op_sel_hi:[1,0]
  v_pk_mul_f32 v[72:73], v[72:73], v[100:101] op_sel_hi:[1,0]
  v_pk_mul_f32 v[74:75], v[74:75], v[100:101] op_sel_hi:[1,0]
  v_pk_mul_f32 v[76:77], v[76:77], v[100:101] op_sel_hi:[1,0]
  v_pk_mul_f32 v[78:79], v[78:79], v[100:101] op_sel_hi:[1,0]
  v_pk_mul_f32 v[80:81], v[80:81], v[100:101] op_sel_hi:[1,0]
  v_pk_mul_f32 v[82:83], v[82:83], v[100:101] op_sel_hi:[1,0]
  v_pk_mul_f32 v[84:85], v[84:85], v[100:101] op_sel_hi:[1,0]
  v_pk_mul_f32 v[86:87], v[86:87], v[100:101] op_sel_hi:[1,0]
  v_cvt_pk_bf16_f32 v8, v48, v49
  v_cvt_pk_bf16_f32 v9, v50, v51
  v_cvt_pk_bf16_f32 v10, v52, v53
  v_cvt_pk_bf16_f32 v11, v54, v55
  buffer_store_dwordx4 v[8:11], v5, s[24:27], s30 offen
  s_add_u32 s30, s30, 16384
  v_cvt_pk_bf16_f32 v12, v56, v57
  v_cvt_pk_bf16_f32 v13, v58, v59
  v_cvt_pk_bf16_f32 v14, v60, v61
  v_cvt_pk_bf16_f32 v15, v62, v63
  buffer_store_dwordx4 v[12:15], v5, s[24:27], s30 offen
  s_add_u32 s30, s30, 16384
  v_cvt_pk_bf16_f32 v16, v64, v65
  v_cvt_pk_bf16_f32 v17, v66, v67
  v_cvt_pk_bf16_f32 v18, v68, v69
  v_cvt_pk_bf16_f32 v19, v70, v71
  buffer_store_dwordx4 v[16:19], v5, s[24:27], s30 offen
  s_add_u32 s30, s30, 16384
  v_cvt_pk_bf16_f32 v20, v72, v73
  v_cvt_pk_bf16_f32 v21, v74, v75
  v_cvt_pk_bf16_f32 v22, v76, v77
  v_cvt_pk_bf16_f32 v23, v78, v79
  buffer_store_dwordx4 v[20:23], v5, s[24:27], s30 offen
  s_add_u32 s30, s30, 16384
  v_cvt_pk_bf16_f32 v24, v80, v81
  v_cvt_pk_bf16_f32 v25, v82, v83
  v_cvt_pk_bf16_f32 v26, v84, v85
  v_cvt_pk_bf16_f32 v27, v86, v87
  buffer_store_dwordx4 v[24:27], v5, s[24:27], s30 offen
  s_add_u32 s30, s30, 16384
  s_waitcnt vmcnt(9)
  v_dot2_f32_bf16 v102, v8, v28, v102
  v_dot2_f32_bf16 v103, v9, v29, v103
  v_dot2_f32_bf16 v102, v10, v30, v102
  v_dot2_f32_bf16 v103, v11, v31, v103
  s_waitcnt vmcnt(8)
  v_dot2_f32_bf16 v102, v12, v32, v102
  v_dot2_f32_bf16 v103, v13, v33, v103
  v_dot2_f32_bf16 v102, v14, v34, v102
  v_dot2_f32_bf16 v103, v15, v35, v103
  s_waitcnt vmcnt(7)
  v_dot2_f32_bf16 v102, v16, v36, v102
  v_dot2_f32_bf16 v103, v17, v37, v103
  v_dot2_f32_bf16 v102, v18, v38, v102
  v_dot2_f32_bf16 v103, v19, v39, v103
  s_waitcnt vmcnt(6)
  v_dot2_f32_bf16 v102, v20, v40, v102
  v_dot2_f32_bf16 v103, v21, v41, v103
  v_dot2_f32_bf16 v102, v22, v42, v102
  v_dot2_f32_bf16 v103, v23, v43, v103
  s_waitcnt vmcnt(5)
  v_dot2_f32_bf16 v102, v24, v44, v102
  v_dot2_f32_bf16 v103, v25, v45, v103
  v_dot2_f32_bf16 v102, v26, v46, v102
  v_dot2_f32_bf16 v103, v27, v47, v103
  s_nop 2
  v_add_f32 v102, v102, v103
  s_nop 1
  v_add_f32_dpp v102, v102, v102 row_ror:8 row_mask:0xf bank_mask:0xf
  s_nop 1
  v_add_f32_dpp v102, v102, v102 row_ror:4 row_mask:0xf bank_mask:0xf
  s_nop 1
  v_add_f32_dpp v102, v102, v102 row_ror:2 row_mask:0xf bank_mask:0xf
  s_nop 1
  v_add_f32_dpp v102, v102, v102 row_ror:1 row_mask:0xf bank_mask:0xf
  v_cvt_pk_bf16_f32 v102, v102, v102
  v_lshlrev_b32 v102, 16, v102
  v_ashrrev_i32 v103, 31, v102
  v_or_b32 v103, 0x80000000, v103
  v_xor_b32 v102, v102, v103
  v_and_b32 v102, s33, v102
  v_add_u32 v6, s28, v1
  v_sub_u32 v7, 0xffff, v6
  v_or_b32 v102, v102, v7
  v_lshlrev_b32 v6, 2, v6
  s_mov_b32 s31, 2621440
  v_cmp_eq_u32 vcc, 0, v2
  s_nop 0
  s_and_saveexec_b64 s[34:35], vcc
  buffer_store_dword v102, v6, s[24:27], s31 offen
  s_endpgm
prep_wof:
  s_lshr_b32 s28, s2, 1
  s_and_b32 s29, s2, 1
  s_sub_u32 s3, s3, 2
  s_lshl_b32 s29, s29, 1
  s_add_u32 s29, s29, s3
  s_mul_i32 s30, s28, 40960
  s_mul_i32 s31, s29, 320
  s_add_u32 s30, s30, s31
  s_mul_i32 s32, s3, 10240
  v_lshrrev_b32 v1, 1, v0
  v_mul_u32_u24 v1, 0x500, v1
  v_and_b32 v2, 1, v0
  v_lshl_add_u32 v1, v2, 4, v1
  s_add_u32 m0, s32, 0
  s_nop 0
  buffer_load_dwordx4 v1, s[16:19], s30 offen offset:0 lds
  s_add_u32 m0, s32, 992
  s_nop 0
  buffer_load_dwordx4 v1, s[16:19], s30 offen offset:32 lds
  s_add_u32 m0, s32, 1984
  s_nop 0
  buffer_load_dwordx4 v1, s[16:19], s30 offen offset:64 lds
  s_add_u32 m0, s32, 2976
  s_nop 0
  buffer_load_dwordx4 v1, s[16:19], s30 offen offset:96 lds
  s_add_u32 m0, s32, 3968
  s_nop 0
  buffer_load_dwordx4 v1, s[16:19], s30 offen offset:128 lds
  s_add_u32 m0, s32, 4960
  s_nop 0
  buffer_load_dwordx4 v1, s[16:19], s30 offen offset:160 lds
  s_add_u32 m0, s32, 5952
  s_nop 0
  buffer_load_dwordx4 v1, s[16:19], s30 offen offset:192 lds
  s_add_u32 m0, s32, 6944
  s_nop 0
  buffer_load_dwordx4 v1, s[16:19], s30 offen offset:224 lds
  s_add_u32 m0, s32, 7936
  s_nop 0
  buffer_load_dwordx4 v1, s[16:19], s30 offen offset:256 lds
  s_add_u32 m0, s32, 8928
  s_nop 0
  buffer_load_dwordx4 v1, s[16:19], s30 offen offset:288 lds
  v_bfe_u32 v2, v0, 2, 4
  v_lshlrev_b32 v2, 5, v2
  v_and_b32 v3, 3, v0
  v_lshl_add_u32 v2, v3, 3, v2
  v_add_u32 v2, s32, v2
  v_lshlrev_b32 v3, 4, v0
  s_mul_i32 s30, s29, 1310720
  s_mul_i32 s31, s28, 5120
  s_add_u32 s30, s30, s31
  s_add_u32 s30, s30, 3145728
  s_waitcnt vmcnt(9)
  ds_read_b64_tr_b16 v[8:9], v2 offset:0
  ds_read_b64_tr_b16 v[10:11], v2 offset:512
  s_waitcnt vmcnt(8)
  ds_read_b64_tr_b16 v[12:13], v2 offset:1024
  ds_read_b64_tr_b16 v[14:15], v2 offset:1536
  s_waitcnt vmcnt(7)
  ds_read_b64_tr_b16 v[16:17], v2 offset:2048
  ds_read_b64_tr_b16 v[18:19], v2 offset:2560
  s_waitcnt vmcnt(6)
  ds_read_b64_tr_b16 v[20:21], v2 offset:3072
  ds_read_b64_tr_b16 v[22:23], v2 offset:3584
  s_waitcnt vmcnt(5)
  ds_read_b64_tr_b16 v[24:25], v2 offset:4096
  ds_read_b64_tr_b16 v[26:27], v2 offset:4608
  s_waitcnt vmcnt(4)
  ds_read_b64_tr_b16 v[28:29], v2 offset:5120
  ds_read_b64_tr_b16 v[30:31], v2 offset:5632
  s_waitcnt vmcnt(3)
  ds_read_b64_tr_b16 v[32:33], v2 offset:6144
  ds_read_b64_tr_b16 v[34:35], v2 offset:6656
  s_waitcnt vmcnt(2)
  ds_read_b64_tr_b16 v[36:37], v2 offset:7168
  ds_read_b64_tr_b16 v[38:39], v2 offset:7680
  s_waitcnt vmcnt(1)
  ds_read_b64_tr_b16 v[40:41], v2 offset:8192
  ds_read_b64_tr_b16 v[42:43], v2 offset:8704
  s_waitcnt vmcnt(0)
  ds_read_b64_tr_b16 v[44:45], v2 offset:9216
  ds_read_b64_tr_b16 v[46:47], v2 offset:9728
  s_waitcnt lgkmcnt(15)
  buffer_store_dwordx4 v[8:11], v3, s[24:27], s30 offen
  s_add_u32 s30, s30, 1024
  buffer_store_dwordx4 v[12:15], v3, s[24:27], s30 offen
  s_add_u32 s30, s30, 1024
  s_waitcnt lgkmcnt(14)
  buffer_store_dwordx4 v[16:19], v3, s[24:27], s30 offen
  s_add_u32 s30, s30, 1024
  s_waitcnt lgkmcnt(12)
  buffer_store_dwordx4 v[20:23], v3, s[24:27], s30 offen
  s_add_u32 s30, s30, 1024
  s_waitcnt lgkmcnt(10)
  buffer_store_dwordx4 v[24:27], v3, s[24:27], s30 offen
  s_add_u32 s30, s30, 651264
  s_waitcnt lgkmcnt(8)
  buffer_store_dwordx4 v[28:31], v3, s[24:27], s30 offen
  s_add_u32 s30, s30, 1024
  s_waitcnt lgkmcnt(6)
  buffer_store_dwordx4 v[32:35], v3, s[24:27], s30 offen
  s_add_u32 s30, s30, 1024
  s_waitcnt lgkmcnt(4)
  buffer_store_dwordx4 v[36:39], v3, s[24:27], s30 offen
  s_add_u32 s30, s30, 1024
  s_waitcnt lgkmcnt(2)
  buffer_store_dwordx4 v[40:43], v3, s[24:27], s30 offen
  s_add_u32 s30, s30, 1024
  s_waitcnt lgkmcnt(0)
  buffer_store_dwordx4 v[44:47], v3, s[24:27], s30 offen
  s_add_u32 s30, s30, 1024
prep_end:
  s_endpgm
.globl ffn1_kernel
.p2align 8
.type ffn1_kernel,@function
ffn1_kernel:
  s_cmp_ge_u32 s2, 216
  s_cbranch_scc1 ffn1_end
  s_load_dwordx4 s[4:7], s[0:1], 56
  s_load_dwordx2 s[10:11], s[0:1], 96
  v_lshrrev_b32 v1, 6, v0
  v_and_b32 v0, 63, v0
  v_readfirstlane_b32 s3, v1
  s_and_b32 s28, s2, 7
  s_mul_i32 s28, s28, 27
  s_lshr_b32 s29, s2, 3
  s_add_u32 s28, s28, s29
  s_waitcnt lgkmcnt(0)
  s_mov_b32 s12, s4
  s_mov_b32 s13, s5
  s_mov_b32 s14, 2211840
  s_mov_b32 s15, 0x20000
  s_mov_b32 s16, s6
  s_mov_b32 s17, s7
  s_mov_b32 s18, 2211840
  s_mov_b32 s19, 0x20000
  s_mov_b32 s24, s10
  s_mov_b32 s25, s11
  s_mov_b32 s26, 8388608
  s_mov_b32 s27, 0x20000
  v_lshlrev_b32 v1, 4, v0
  s_mov_b32 s29, 2621440
  s_mov_b32 s30, 2625536
  buffer_load_dwordx4 v[8:11], v1, s[24:27], s29 offen offset:0
  buffer_load_dwordx4 v[12:15], v1, s[24:27], s29 offen offset:1024
  buffer_load_dwordx4 v[16:19], v1, s[24:27], s29 offen offset:2048
  buffer_load_dwordx4 v[20:23], v1, s[24:27], s29 offen offset:3072
  buffer_load_dwordx4 v[24:27], v1, s[24:27], s30 offen offset:0
  buffer_load_dwordx4 v[28:31], v1, s[24:27], s30 offen offset:1024
  buffer_load_dwordx4 v[32:35], v1, s[24:27], s30 offen offset:2048
  buffer_load_dwordx4 v[36:39], v1, s[24:27], s30 offen offset:3072
  s_mul_i32 s31, s3, 160*3456
  s_lshl_b32 s32, s28, 4
  s_add_u32 s31, s31, s32
  s_mul_i32 s33, s3, 6144
  v_mul_u32_u24 v2, 0xd80, v0
  s_add_u32 m0, s33, 0
  s_nop 0
  buffer_load_dwordx4 v2, s[12:15], s31 offen lds
  s_add_u32 m0, s33, 3072
  s_nop 0
  buffer_load_dwordx4 v2, s[16:19], s31 offen lds
  s_add_u32 s31, s31, 221184
  s_add_u32 m0, s33, 1024
  s_nop 0
  buffer_load_dwordx4 v2, s[12:15], s31 offen lds
  s_add_u32 m0, s33, 4096
  s_nop 0
  buffer_load_dwordx4 v2, s[16:19], s31 offen lds
  s_add_u32 s31, s31, 221184
  s_add_u32 m0, s33, 2048
  s_nop 0
  buffer_load_dwordx4 v2, s[12:15], s31 offen lds
  s_add_u32 m0, s33, 5120
  s_nop 0
  buffer_load_dwordx4 v2, s[16:19], s31 offen lds
  s_add_u32 s31, s31, 221184
  s_mov_b32 s34, -1
  s_waitcnt vmcnt(13)
  v_sub_u32 v41, s34, v8
  v_sub_u32 v42, s34, v9
  v_min_u32 v40, v41, v42
  v_sub_u32 v43, s34, v10
  v_sub_u32 v44, s34, v11
  v_min3_u32 v40, v40, v43, v44
  s_waitcnt vmcnt(12)
  v_sub_u32 v41, s34, v12
  v_sub_u32 v42, s34, v13
  v_min3_u32 v40, v40, v41, v42
  v_sub_u32 v43, s34, v14
  v_sub_u32 v44, s34, v15
  v_min3_u32 v40, v40, v43, v44
  s_waitcnt vmcnt(11)
  v_sub_u32 v41, s34, v16
  v_sub_u32 v42, s34, v17
  v_min3_u32 v40, v40, v41, v42
  v_sub_u32 v43, s34, v18
  v_sub_u32 v44, s34, v19
  v_min3_u32 v40, v40, v43, v44
  s_waitcnt vmcnt(10)
  v_sub_u32 v41, s34, v20
  v_sub_u32 v42, s34, v21
  v_min3_u32 v40, v40, v41, v42
  v_sub_u32 v43, s34, v22
  v_sub_u32 v44, s34, v23
  v_min3_u32 v40, v40, v43, v44
  s_waitcnt vmcnt(9)
  v_sub_u32 v41, s34, v24
  v_sub_u32 v42, s34, v25
  v_min3_u32 v40, v40, v41, v42
  v_sub_u32 v43, s34, v26
  v_sub_u32 v44, s34, v27
  v_min3_u32 v40, v40, v43, v44
  s_waitcnt vmcnt(8)
  v_sub_u32 v41, s34, v28
  v_sub_u32 v42, s34, v29
  v_min3_u32 v40, v40, v41, v42
  v_sub_u32 v43, s34, v30
  v_sub_u32 v44, s34, v31
  v_min3_u32 v40, v40, v43, v44
  s_waitcnt vmcnt(7)
  v_sub_u32 v41, s34, v32
  v_sub_u32 v42, s34, v33
  v_min3_u32 v40, v40, v41, v42
  v_sub_u32 v43, s34, v34
  v_sub_u32 v44, s34, v35
  v_min3_u32 v40, v40, v43, v44
  s_waitcnt vmcnt(6)
  v_sub_u32 v41, s34, v36
  v_sub_u32 v42, s34, v37
  v_min3_u32 v40, v40, v41, v42
  v_sub_u32 v43, s34, v38
  v_sub_u32 v44, s34, v39
  v_min3_u32 v40, v40, v43, v44
  s_nop 1
  v_min_u32_dpp v40, v40, v40 row_ror:8 row_mask:0xf bank_mask:0xf
  s_nop 1
  v_min_u32_dpp v40, v40, v40 row_ror:4 row_mask:0xf bank_mask:0xf
  s_nop 1
  v_min_u32_dpp v40, v40, v40 row_ror:2 row_mask:0xf bank_mask:0xf
  s_nop 1
  v_min_u32_dpp v40, v40, v40 row_ror:1 row_mask:0xf bank_mask:0xf
  s_nop 0
  v_readlane_b32 s36, v40, 0
  v_readlane_b32 s37, v40, 16
  v_readlane_b32 s38, v40, 32
  v_readlane_b32 s39, v40, 48
  s_min_u32 s36, s36, s37
  s_min_u32 s38, s38, s39
  s_min_u32 s36, s36, s38
  s_sub_u32 s40, s34, s36
  s_sub_u32 s34, s40, 1
  v_sub_u32 v41, s34, v8
  v_sub_u32 v42, s34, v9
  v_min_u32 v40, v41, v42
  v_sub_u32 v43, s34, v10
  v_sub_u32 v44, s34, v11
  v_min3_u32 v40, v40, v43, v44
  v_sub_u32 v41, s34, v12
  v_sub_u32 v42, s34, v13
  v_min3_u32 v40, v40, v41, v42
  v_sub_u32 v43, s34, v14
  v_sub_u32 v44, s34, v15
  v_min3_u32 v40, v40, v43, v44
  v_sub_u32 v41, s34, v16
  v_sub_u32 v42, s34, v17
  v_min3_u32 v40, v40, v41, v42
  v_sub_u32 v43, s34, v18
  v_sub_u32 v44, s34, v19
  v_min3_u32 v40, v40, v43, v44
  v_sub_u32 v41, s34, v20
  v_sub_u32 v42, s34, v21
  v_min3_u32 v40, v40, v41, v42
  v_sub_u32 v43, s34, v22
  v_sub_u32 v44, s34, v23
  v_min3_u32 v40, v40, v43, v44
  v_sub_u32 v41, s34, v24
  v_sub_u32 v42, s34, v25
  v_min3_u32 v40, v40, v41, v42
  v_sub_u32 v43, s34, v26
  v_sub_u32 v44, s34, v27
  v_min3_u32 v40, v40, v43, v44
  v_sub_u32 v41, s34, v28
  v_sub_u32 v42, s34, v29
  v_min3_u32 v40, v40, v41, v42
  v_sub_u32 v43, s34, v30
  v_sub_u32 v44, s34, v31
  v_min3_u32 v40, v40, v43, v44
  v_sub_u32 v41, s34, v32
  v_sub_u32 v42, s34, v33
  v_min3_u32 v40, v40, v41, v42
  v_sub_u32 v43, s34, v34
  v_sub_u32 v44, s34, v35
  v_min3_u32 v40, v40, v43, v44
  v_sub_u32 v41, s34, v36
  v_sub_u32 v42, s34, v37
  v_min3_u32 v40, v40, v41, v42
  v_sub_u32 v43, s34, v38
  v_sub_u32 v44, s34, v39
  v_min3_u32 v40, v40, v43, v44
  s_nop 1
  v_min_u32_dpp v40, v40, v40 row_ror:8 row_mask:0xf bank_mask:0xf
  s_nop 1
  v_min_u32_dpp v40, v40, v40 row_ror:4 row_mask:0xf bank_mask:0xf
  s_nop 1
  v_min_u32_dpp v40, v40, v40 row_ror:2 row_mask:0xf bank_mask:0xf
  s_nop 1
  v_min_u32_dpp v40, v40, v40 row_ror:1 row_mask:0xf bank_mask:0xf
  s_nop 0
  v_readlane_b32 s36, v40, 0
  v_readlane_b32 s37, v40, 16
  v_readlane_b32 s38, v40, 32
  v_readlane_b32 s39, v40, 48
  s_min_u32 s36, s36, s37
  s_min_u32 s38, s38, s39
  s_min_u32 s36, s36, s38
  s_sub_u32 s41, s34, s36
  s_sub_u32 s34, s41, 1
  v_sub_u32 v41, s34, v8
  v_sub_u32 v42, s34, v9
  v_min_u32 v40, v41, v42
  v_sub_u32 v43, s34, v10
  v_sub_u32 v44, s34, v11
  v_min3_u32 v40, v40, v43, v44
  v_sub_u32 v41, s34, v12
  v_sub_u32 v42, s34, v13
  v_min3_u32 v40, v40, v41, v42
  v_sub_u32 v43, s34, v14
  v_sub_u32 v44, s34, v15
  v_min3_u32 v40, v40, v43, v44
  v_sub_u32 v41, s34, v16
  v_sub_u32 v42, s34, v17
  v_min3_u32 v40, v40, v41, v42
  v_sub_u32 v43, s34, v18
  v_sub_u32 v44, s34, v19
  v_min3_u32 v40, v40, v43, v44
  v_sub_u32 v41, s34, v20
  v_sub_u32 v42, s34, v21
  v_min3_u32 v40, v40, v41, v42
  v_sub_u32 v43, s34, v22
  v_sub_u32 v44, s34, v23
  v_min3_u32 v40, v40, v43, v44
  v_sub_u32 v41, s34, v24
  v_sub_u32 v42, s34, v25
  v_min3_u32 v40, v40, v41, v42
  v_sub_u32 v43, s34, v26
  v_sub_u32 v44, s34, v27
  v_min3_u32 v40, v40, v43, v44
  v_sub_u32 v41, s34, v28
  v_sub_u32 v42, s34, v29
  v_min3_u32 v40, v40, v41, v42
  v_sub_u32 v43, s34, v30
  v_sub_u32 v44, s34, v31
  v_min3_u32 v40, v40, v43, v44
  v_sub_u32 v41, s34, v32
  v_sub_u32 v42, s34, v33
  v_min3_u32 v40, v40, v41, v42
  v_sub_u32 v43, s34, v34
  v_sub_u32 v44, s34, v35
  v_min3_u32 v40, v40, v43, v44
  v_sub_u32 v41, s34, v36
  v_sub_u32 v42, s34, v37
  v_min3_u32 v40, v40, v41, v42
  v_sub_u32 v43, s34, v38
  v_sub_u32 v44, s34, v39
  v_min3_u32 v40, v40, v43, v44
  s_nop 1
  v_min_u32_dpp v40, v40, v40 row_ror:8 row_mask:0xf bank_mask:0xf
  s_nop 1
  v_min_u32_dpp v40, v40, v40 row_ror:4 row_mask:0xf bank_mask:0xf
  s_nop 1
  v_min_u32_dpp v40, v40, v40 row_ror:2 row_mask:0xf bank_mask:0xf
  s_nop 1
  v_min_u32_dpp v40, v40, v40 row_ror:1 row_mask:0xf bank_mask:0xf
  s_nop 0
  v_readlane_b32 s36, v40, 0
  v_readlane_b32 s37, v40, 16
  v_readlane_b32 s38, v40, 32
  v_readlane_b32 s39, v40, 48
  s_min_u32 s36, s36, s37
  s_min_u32 s38, s38, s39
  s_min_u32 s36, s36, s38
  s_sub_u32 s42, s34, s36
  s_sub_u32 s34, s42, 1
  v_sub_u32 v41, s34, v8
  v_sub_u32 v42, s34, v9
  v_min_u32 v40, v41, v42
  v_sub_u32 v43, s34, v10
  v_sub_u32 v44, s34, v11
  v_min3_u32 v40, v40, v43, v44
  v_sub_u32 v41, s34, v12
  v_sub_u32 v42, s34, v13
  v_min3_u32 v40, v40, v41, v42
  v_sub_u32 v43, s34, v14
  v_sub_u32 v44, s34, v15
  v_min3_u32 v40, v40, v43, v44
  v_sub_u32 v41, s34, v16
  v_sub_u32 v42, s34, v17
  v_min3_u32 v40, v40, v41, v42
  v_sub_u32 v43, s34, v18
  v_sub_u32 v44, s34, v19
  v_min3_u32 v40, v40, v43, v44
  v_sub_u32 v41, s34, v20
  v_sub_u32 v42, s34, v21
  v_min3_u32 v40, v40, v41, v42
  v_sub_u32 v43, s34, v22
  v_sub_u32 v44, s34, v23
  v_min3_u32 v40, v40, v43, v44
  v_sub_u32 v41, s34, v24
  v_sub_u32 v42, s34, v25
  v_min3_u32 v40, v40, v41, v42
  v_sub_u32 v43, s34, v26
  v_sub_u32 v44, s34, v27
  v_min3_u32 v40, v40, v43, v44
  v_sub_u32 v41, s34, v28
  v_sub_u32 v42, s34, v29
  v_min3_u32 v40, v40, v41, v42
  v_sub_u32 v43, s34, v30
  v_sub_u32 v44, s34, v31
  v_min3_u32 v40, v40, v43, v44
  v_sub_u32 v41, s34, v32
  v_sub_u32 v42, s34, v33
  v_min3_u32 v40, v40, v41, v42
  v_sub_u32 v43, s34, v34
  v_sub_u32 v44, s34, v35
  v_min3_u32 v40, v40, v43, v44
  v_sub_u32 v41, s34, v36
  v_sub_u32 v42, s34, v37
  v_min3_u32 v40, v40, v41, v42
  v_sub_u32 v43, s34, v38
  v_sub_u32 v44, s34, v39
  v_min3_u32 v40, v40, v43, v44
  s_nop 1
  v_min_u32_dpp v40, v40, v40 row_ror:8 row_mask:0xf bank_mask:0xf
  s_nop 1
  v_min_u32_dpp v40, v40, v40 row_ror:4 row_mask:0xf bank_mask:0xf
  s_nop 1
  v_min_u32_dpp v40, v40, v40 row_ror:2 row_mask:0xf bank_mask:0xf
  s_nop 1
  v_min_u32_dpp v40, v40, v40 row_ror:1 row_mask:0xf bank_mask:0xf
  s_nop 0
  v_readlane_b32 s36, v40, 0
  v_readlane_b32 s37, v40, 16
  v_readlane_b32 s38, v40, 32
  v_readlane_b32 s39, v40, 48
  s_min_u32 s36, s36, s37
  s_min_u32 s38, s38, s39
  s_min_u32 s36, s36, s38
  s_sub_u32 s43, s34, s36
  s_sub_u32 s34, s43, 1
  v_sub_u32 v41, s34, v8
  v_sub_u32 v42, s34, v9
  v_min_u32 v40, v41, v42
  v_sub_u32 v43, s34, v10
  v_sub_u32 v44, s34, v11
  v_min3_u32 v40, v40, v43, v44
  v_sub_u32 v41, s34, v12
  v_sub_u32 v42, s34, v13
  v_min3_u32 v40, v40, v41, v42
  v_sub_u32 v43, s34, v14
  v_sub_u32 v44, s34, v15
  v_min3_u32 v40, v40, v43, v44
  v_sub_u32 v41, s34, v16
  v_sub_u32 v42, s34, v17
  v_min3_u32 v40, v40, v41, v42
  v_sub_u32 v43, s34, v18
  v_sub_u32 v44, s34, v19
  v_min3_u32 v40, v40, v43, v44
  v_sub_u32 v41, s34, v20
  v_sub_u32 v42, s34, v21
  v_min3_u32 v40, v40, v41, v42
  v_sub_u32 v43, s34, v22
  v_sub_u32 v44, s34, v23
  v_min3_u32 v40, v40, v43, v44
  v_sub_u32 v41, s34, v24
  v_sub_u32 v42, s34, v25
  v_min3_u32 v40, v40, v41, v42
  v_sub_u32 v43, s34, v26
  v_sub_u32 v44, s34, v27
  v_min3_u32 v40, v40, v43, v44
  v_sub_u32 v41, s34, v28
  v_sub_u32 v42, s34, v29
  v_min3_u32 v40, v40, v41, v42
  v_sub_u32 v43, s34, v30
  v_sub_u32 v44, s34, v31
  v_min3_u32 v40, v40, v43, v44
  v_sub_u32 v41, s34, v32
  v_sub_u32 v42, s34, v33
  v_min3_u32 v40, v40, v41, v42
  v_sub_u32 v43, s34, v34
  v_sub_u32 v44, s34, v35
  v_min3_u32 v40, v40, v43, v44
  v_sub_u32 v41, s34, v36
  v_sub_u32 v42, s34, v37
  v_min3_u32 v40, v40, v41, v42
  v_sub_u32 v43, s34, v38
  v_sub_u32 v44, s34, v39
  v_min3_u32 v40, v40, v43, v44
  s_nop 1
  v_min_u32_dpp v40, v40, v40 row_ror:8 row_mask:0xf bank_mask:0xf
  s_nop 1
  v_min_u32_dpp v40, v40, v40 row_ror:4 row_mask:0xf bank_mask:0xf
  s_nop 1
  v_min_u32_dpp v40, v40, v40 row_ror:2 row_mask:0xf bank_mask:0xf
  s_nop 1
  v_min_u32_dpp v40, v40, v40 row_ror:1 row_mask:0xf bank_mask:0xf
  s_nop 0
  v_readlane_b32 s36, v40, 0
  v_readlane_b32 s37, v40, 16
  v_readlane_b32 s38, v40, 32
  v_readlane_b32 s39, v40, 48
  s_min_u32 s36, s36, s37
  s_min_u32 s38, s38, s39
  s_min_u32 s36, s36, s38
  s_sub_u32 s44, s34, s36
  s_sub_u32 s34, s44, 1
  v_sub_u32 v41, s34, v8
  v_sub_u32 v42, s34, v9
  v_min_u32 v40, v41, v42
  v_sub_u32 v43, s34, v10
  v_sub_u32 v44, s34, v11
  v_min3_u32 v40, v40, v43, v44
  v_sub_u32 v41, s34, v12
  v_sub_u32 v42, s34, v13
  v_min3_u32 v40, v40, v41, v42
  v_sub_u32 v43, s34, v14
  v_sub_u32 v44, s34, v15
  v_min3_u32 v40, v40, v43, v44
  v_sub_u32 v41, s34, v16
  v_sub_u32 v42, s34, v17
  v_min3_u32 v40, v40, v41, v42
  v_sub_u32 v43, s34, v18
  v_sub_u32 v44, s34, v19
  v_min3_u32 v40, v40, v43, v44
  v_sub_u32 v41, s34, v20
  v_sub_u32 v42, s34, v21
  v_min3_u32 v40, v40, v41, v42
  v_sub_u32 v43, s34, v22
  v_sub_u32 v44, s34, v23
  v_min3_u32 v40, v40, v43, v44
  v_sub_u32 v41, s34, v24
  v_sub_u32 v42, s34, v25
  v_min3_u32 v40, v40, v41, v42
  v_sub_u32 v43, s34, v26
  v_sub_u32 v44, s34, v27
  v_min3_u32 v40, v40, v43, v44
  v_sub_u32 v41, s34, v28
  v_sub_u32 v42, s34, v29
  v_min3_u32 v40, v40, v41, v42
  v_sub_u32 v43, s34, v30
  v_sub_u32 v44, s34, v31
  v_min3_u32 v40, v40, v43, v44
  v_sub_u32 v41, s34, v32
  v_sub_u32 v42, s34, v33
  v_min3_u32 v40, v40, v41, v42
  v_sub_u32 v43, s34, v34
  v_sub_u32 v44, s34, v35
  v_min3_u32 v40, v40, v43, v44
  v_sub_u32 v41, s34, v36
  v_sub_u32 v42, s34, v37
  v_min3_u32 v40, v40, v41, v42
  v_sub_u32 v43, s34, v38
  v_sub_u32 v44, s34, v39
  v_min3_u32 v40, v40, v43, v44
  s_nop 1
  v_min_u32_dpp v40, v40, v40 row_ror:8 row_mask:0xf bank_mask:0xf
  s_nop 1
  v_min_u32_dpp v40, v40, v40 row_ror:4 row_mask:0xf bank_mask:0xf
  s_nop 1
  v_min_u32_dpp v40, v40, v40 row_ror:2 row_mask:0xf bank_mask:0xf
  s_nop 1
  v_min_u32_dpp v40, v40, v40 row_ror:1 row_mask:0xf bank_mask:0xf
  s_nop 0
  v_readlane_b32 s36, v40, 0
  v_readlane_b32 s37, v40, 16
  v_readlane_b32 s38, v40, 32
  v_readlane_b32 s39, v40, 48
  s_min_u32 s36, s36, s37
  s_min_u32 s38, s38, s39
  s_min_u32 s36, s36, s38
  s_sub_u32 s45, s34, s36
  s_sub_u32 s34, s45, 1
  v_sub_u32 v41, s34, v8
  v_sub_u32 v42, s34, v9
  v_min_u32 v40, v41, v42
  v_sub_u32 v43, s34, v10
  v_sub_u32 v44, s34, v11
  v_min3_u32 v40, v40, v43, v44
  v_sub_u32 v41, s34, v12
  v_sub_u32 v42, s34, v13
  v_min3_u32 v40, v40, v41, v42
  v_sub_u32 v43, s34, v14
  v_sub_u32 v44, s34, v15
  v_min3_u32 v40, v40, v43, v44
  v_sub_u32 v41, s34, v16
  v_sub_u32 v42, s34, v17
  v_min3_u32 v40, v40, v41, v42
  v_sub_u32 v43, s34, v18
  v_sub_u32 v44, s34, v19
  v_min3_u32 v40, v40, v43, v44
  v_sub_u32 v41, s34, v20
  v_sub_u32 v42, s34, v21
  v_min3_u32 v40, v40, v41, v42
  v_sub_u32 v43, s34, v22
  v_sub_u32 v44, s34, v23
  v_min3_u32 v40, v40, v43, v44
  v_sub_u32 v41, s34, v24
  v_sub_u32 v42, s34, v25
  v_min3_u32 v40, v40, v41, v42
  v_sub_u32 v43, s34, v26
  v_sub_u32 v44, s34, v27
  v_min3_u32 v40, v40, v43, v44
  v_sub_u32 v41, s34, v28
  v_sub_u32 v42, s34, v29
  v_min3_u32 v40, v40, v41, v42
  v_sub_u32 v43, s34, v30
  v_sub_u32 v44, s34, v31
  v_min3_u32 v40, v40, v43, v44
  v_sub_u32 v41, s34, v32
  v_sub_u32 v42, s34, v33
  v_min3_u32 v40, v40, v41, v42
  v_sub_u32 v43, s34, v34
  v_sub_u32 v44, s34, v35
  v_min3_u32 v40, v40, v43, v44
  v_sub_u32 v41, s34, v36
  v_sub_u32 v42, s34, v37
  v_min3_u32 v40, v40, v41, v42
  v_sub_u32 v43, s34, v38
  v_sub_u32 v44, s34, v39
  v_min3_u32 v40, v40, v43, v44
  s_nop 1
  v_min_u32_dpp v40, v40, v40 row_ror:8 row_mask:0xf bank_mask:0xf
  s_nop 1
  v_min_u32_dpp v40, v40, v40 row_ror:4 row_mask:0xf bank_mask:0xf
  s_nop 1
  v_min_u32_dpp v40, v40, v40 row_ror:2 row_mask:0xf bank_mask:0xf
  s_nop 1
  v_min_u32_dpp v40, v40, v40 row_ror:1 row_mask:0xf bank_mask:0xf
  s_nop 0
  v_readlane_b32 s36, v40, 0
  v_readlane_b32 s37, v40, 16
  v_readlane_b32 s38, v40, 32
  v_readlane_b32 s39, v40, 48
  s_min_u32 s36, s36, s37
  s_min_u32 s38, s38, s39
  s_min_u32 s36, s36, s38
  s_sub_u32 s46, s34, s36
  s_sub_u32 s34, s46, 1
  v_sub_u32 v41, s34, v8
  v_sub_u32 v42, s34, v9
  v_min_u32 v40, v41, v42
  v_sub_u32 v43, s34, v10
  v_sub_u32 v44, s34, v11
  v_min3_u32 v40, v40, v43, v44
  v_sub_u32 v41, s34, v12
  v_sub_u32 v42, s34, v13
  v_min3_u32 v40, v40, v41, v42
  v_sub_u32 v43, s34, v14
  v_sub_u32 v44, s34, v15
  v_min3_u32 v40, v40, v43, v44
  v_sub_u32 v41, s34, v16
  v_sub_u32 v42, s34, v17
  v_min3_u32 v40, v40, v41, v42
  v_sub_u32 v43, s34, v18
  v_sub_u32 v44, s34, v19
  v_min3_u32 v40, v40, v43, v44
  v_sub_u32 v41, s34, v20
  v_sub_u32 v42, s34, v21
  v_min3_u32 v40, v40, v41, v42
  v_sub_u32 v43, s34, v22
  v_sub_u32 v44, s34, v23
  v_min3_u32 v40, v40, v43, v44
  v_sub_u32 v41, s34, v24
  v_sub_u32 v42, s34, v25
  v_min3_u32 v40, v40, v41, v42
  v_sub_u32 v43, s34, v26
  v_sub_u32 v44, s34, v27
  v_min3_u32 v40, v40, v43, v44
  v_sub_u32 v41, s34, v28
  v_sub_u32 v42, s34, v29
  v_min3_u32 v40, v40, v41, v42
  v_sub_u32 v43, s34, v30
  v_sub_u32 v44, s34, v31
  v_min3_u32 v40, v40, v43, v44
  v_sub_u32 v41, s34, v32
  v_sub_u32 v42, s34, v33
  v_min3_u32 v40, v40, v41, v42
  v_sub_u32 v43, s34, v34
  v_sub_u32 v44, s34, v35
  v_min3_u32 v40, v40, v43, v44
  v_sub_u32 v41, s34, v36
  v_sub_u32 v42, s34, v37
  v_min3_u32 v40, v40, v41, v42
  v_sub_u32 v43, s34, v38
  v_sub_u32 v44, s34, v39
  v_min3_u32 v40, v40, v43, v44
  s_nop 1
  v_min_u32_dpp v40, v40, v40 row_ror:8 row_mask:0xf bank_mask:0xf
  s_nop 1
  v_min_u32_dpp v40, v40, v40 row_ror:4 row_mask:0xf bank_mask:0xf
  s_nop 1
  v_min_u32_dpp v40, v40, v40 row_ror:2 row_mask:0xf bank_mask:0xf
  s_nop 1
  v_min_u32_dpp v40, v40, v40 row_ror:1 row_mask:0xf bank_mask:0xf
  s_nop 0
  v_readlane_b32 s36, v40, 0
  v_readlane_b32 s37, v40, 16
  v_readlane_b32 s38, v40, 32
  v_readlane_b32 s39, v40, 48
  s_min_u32 s36, s36, s37
  s_min_u32 s38, s38, s39
  s_min_u32 s36, s36, s38
  s_sub_u32 s47, s34, s36
  s_sub_u32 s34, s47, 1
  v_mov_b32 v3, 0
  s_and_b32 s48, s40, 0xffff
  s_sub_u32 s48, 0xffff, s48
  v_writelane_b32 v3, s48, 0
  s_and_b32 s49, s41, 0xffff
  s_sub_u32 s49, 0xffff, s49
  v_writelane_b32 v3, s49, 1
  s_and_b32 s50, s42, 0xffff
  s_sub_u32 s50, 0xffff, s50
  v_writelane_b32 v3, s50, 2
  s_and_b32 s51, s43, 0xffff
  s_sub_u32 s51, 0xffff, s51
  v_writelane_b32 v3, s51, 3
  s_and_b32 s52, s44, 0xffff
  s_sub_u32 s52, 0xffff, s52
  v_writelane_b32 v3, s52, 4
  s_and_b32 s53, s45, 0xffff
  s_sub_u32 s53, 0xffff, s53
  v_writelane_b32 v3, s53, 5
  s_and_b32 s54, s46, 0xffff
  s_sub_u32 s54, 0xffff, s54
  v_writelane_b32 v3, s54, 6
  s_and_b32 s55, s47, 0xffff
  s_sub_u32 s55, 0xffff, s55
  v_writelane_b32 v3, s55, 7
  v_mov_b32 v4, v3
  s_nop 1
  v_permlane16_swap_b32 v3, v4
  v_mov_b32 v4, v3
  s_nop 1
  v_permlane32_swap_b32 v3, v4
  v_lshrrev_b32 v4, 6, v3
  v_mul_u32_u24 v4, 0x14000, v4
  v_bfe_u32 v5, v3, 4, 2
  v_lshl_add_u32 v4, v5, 10, v4
  v_and_b32 v5, 15, v3
  v_lshl_add_u32 v4, v5, 4, v4
  v_lshrrev_b32 v5, 4, v0
  v_lshl_add_u32 v4, v5, 8, v4
  s_mul_i32 s31, s3, 20480
  buffer_load_dwordx4 v[8:11], v4, s[24:27], s31 offen
  s_add_u32 s31, s31, 4096
  buffer_load_dwordx4 v[12:15], v4, s[24:27], s31 offen
  s_add_u32 s31, s31, 4096
  buffer_load_dwordx4 v[16:19], v4, s[24:27], s31 offen
  s_add_u32 s31, s31, 4096
  buffer_load_dwordx4 v[20:23], v4, s[24:27], s31 offen
  s_add_u32 s31, s31, 4096
  buffer_load_dwordx4 v[24:27], v4, s[24:27], s31 offen
  s_add_u32 s31, s31, 4096
  s_cmp_lg_u32 s28, 0
  s_cbranch_scc1 ffn1_notop
  v_mov_b32 v52, 0
  v_writelane_b32 v52, s40, 0
  v_writelane_b32 v52, s41, 1
  v_writelane_b32 v52, s42, 2
  v_writelane_b32 v52, s43, 3
  v_writelane_b32 v52, s44, 4
  v_writelane_b32 v52, s45, 5
  v_writelane_b32 v52, s46, 6
  v_writelane_b32 v52, s47, 7
  v_and_b32 v52, 0xffff0000, v52
  v_ashrrev_i32 v53, 31, v52
  v_not_b32 v53, v53
  v_or_b32 v53, 0x80000000, v53
  v_xor_b32 v52, v52, v53
  v_and_b32 v52, 0xffff0000, v52
  v_mul_f32 v52, 0xbfb8aa3b, v52
  v_exp_f32 v52, v52
  s_nop 0
  v_add_f32 v52, 1.0, v52
  v_rcp_f32 v52, v52
  s_nop 0
  v_cvt_pk_bf16_f32 v52, v52, v52
  v_lshlrev_b32 v52, 16, v52
  v_lshlrev_b32 v53, 2, v0
  s_mov_b32 s31, 2629632
  s_mov_b64 exec, 0xff
  buffer_store_dword v3, v53, s[24:27], s31 offen
  buffer_store_dword v52, v53, s[24:27], s31 offen offset:32
  s_mov_b64 exec, -1
ffn1_notop:
  v_lshrrev_b32 v5, 4, v0
  v_lshlrev_b32 v5, 3, v5
  v_bfe_u32 v6, v0, 2, 2
  v_add_u32 v5, v5, v6
  v_lshlrev_b32 v5, 4, v5
  v_bfe_u32 v6, v0, 1, 1
  v_mul_u32_u24 v6, 0xc00, v6
  v_add_u32 v5, v5, v6
  v_and_b32 v6, 1, v0
  v_lshl_add_u32 v5, v6, 3, v5
  v_add_u32 v5, s33, v5
  s_waitcnt vmcnt(0)
  ds_read_b64_tr_b16 v[28:29], v5 offset:0
  ds_read_b64_tr_b16 v[30:31], v5 offset:64
  ds_read_b64_tr_b16 v[32:33], v5 offset:512
  ds_read_b64_tr_b16 v[34:35], v5 offset:576
  ds_read_b64_tr_b16 v[36:37], v5 offset:1024
  ds_read_b64_tr_b16 v[38:39], v5 offset:1088
  ds_read_b64_tr_b16 v[40:41], v5 offset:1536
  ds_read_b64_tr_b16 v[42:43], v5 offset:1600
  ds_read_b64_tr_b16 v[44:45], v5 offset:2048
  ds_read_b64_tr_b16 v[46:47], v5 offset:2112
  s_waitcnt lgkmcnt(8)
  v_mfma_f32_16x16x32_bf16 v[48:51], v[28:31], v[8:11], 0
  s_waitcnt lgkmcnt(6)
  v_mfma_f32_16x16x32_bf16 v[48:51], v[32:35], v[12:15], v[48:51]
  s_waitcnt lgkmcnt(4)
  v_mfma_f32_16x16x32_bf16 v[48:51], v[36:39], v[16:19], v[48:51]
  s_waitcnt lgkmcnt(2)
  v_mfma_f32_16x16x32_bf16 v[48:51], v[40:43], v[20:23], v[48:51]
  s_waitcnt lgkmcnt(0)
  v_mfma_f32_16x16x32_bf16 v[48:51], v[44:47], v[24:27], v[48:51]
  s_lshl_b32 s31, s3, 10
  v_add_u32 v6, s31, v1
  s_nop 5
  ds_write_b128 v6, v[48:51] offset:24576
  s_waitcnt lgkmcnt(0)
  s_barrier
  s_cmp_lg_u32 s3, 0
  s_cbranch_scc1 ffn1_end
  v_and_b32 v6, 31, v0
  v_lshlrev_b32 v6, 4, v6
  ds_read_b128 v[8:11], v6 offset:24576
  ds_read_b128 v[24:27], v6 offset:25088
  ds_read_b128 v[12:15], v6 offset:25600
  ds_read_b128 v[28:31], v6 offset:26112
  ds_read_b128 v[16:19], v6 offset:26624
  ds_read_b128 v[32:35], v6 offset:27136
  ds_read_b128 v[20:23], v6 offset:27648
  ds_read_b128 v[36:39], v6 offset:28160
  s_waitcnt lgkmcnt(5)
  v_add_f32 v8, v8, v12
  s_waitcnt lgkmcnt(1)
  v_add_f32 v16, v16, v20
  v_add_f32 v8, v8, v16
  v_cvt_pk_bf16_f32 v8, v8, v8
  v_lshlrev_b32 v8, 16, v8
  v_add_f32 v9, v9, v13
  v_add_f32 v17, v17, v21
  v_add_f32 v9, v9, v17
  v_cvt_pk_bf16_f32 v9, v9, v9
  v_lshlrev_b32 v9, 16, v9
  v_add_f32 v10, v10, v14
  v_add_f32 v18, v18, v22
  v_add_f32 v10, v10, v18
  v_cvt_pk_bf16_f32 v10, v10, v10
  v_lshlrev_b32 v10, 16, v10
  v_add_f32 v11, v11, v15
  v_add_f32 v19, v19, v23
  v_add_f32 v11, v11, v19
  v_cvt_pk_bf16_f32 v11, v11, v11
  v_lshlrev_b32 v11, 16, v11
  v_add_f32 v24, v24, v28
  s_waitcnt lgkmcnt(0)
  v_add_f32 v32, v32, v36
  v_add_f32 v24, v24, v32
  v_cvt_pk_bf16_f32 v24, v24, v24
  v_lshlrev_b32 v24, 16, v24
  v_add_f32 v25, v25, v29
  v_add_f32 v33, v33, v37
  v_add_f32 v25, v25, v33
  v_cvt_pk_bf16_f32 v25, v25, v25
  v_lshlrev_b32 v25, 16, v25
  v_add_f32 v26, v26, v30
  v_add_f32 v34, v34, v38
  v_add_f32 v26, v26, v34
  v_cvt_pk_bf16_f32 v26, v26, v26
  v_lshlrev_b32 v26, 16, v26
  v_add_f32 v27, v27, v31
  v_add_f32 v35, v35, v39
  v_add_f32 v27, v27, v35
  v_cvt_pk_bf16_f32 v27, v27, v27
  v_lshlrev_b32 v27, 16, v27
  v_mul_f32 v12, 0xbfb8aa3b, v8
  v_exp_f32 v12, v12
  s_nop 0
  v_add_f32 v12, 1.0, v12
  v_rcp_f32 v12, v12
  s_nop 0
  v_mul_f32 v8, v8, v12
  v_cvt_pk_bf16_f32 v8, v8, v8
  v_lshlrev_b32 v8, 16, v8
  v_mul_f32 v8, v8, v24
  v_mul_f32 v13, 0xbfb8aa3b, v9
  v_exp_f32 v13, v13
  s_nop 0
  v_add_f32 v13, 1.0, v13
  v_rcp_f32 v13, v13
  s_nop 0
  v_mul_f32 v9, v9, v13
  v_cvt_pk_bf16_f32 v9, v9, v9
  v_lshlrev_b32 v9, 16, v9
  v_mul_f32 v9, v9, v25
  v_mul_f32 v14, 0xbfb8aa3b, v10
  v_exp_f32 v14, v14
  s_nop 0
  v_add_f32 v14, 1.0, v14
  v_rcp_f32 v14, v14
  s_nop 0
  v_mul_f32 v10, v10, v14
  v_cvt_pk_bf16_f32 v10, v10, v10
  v_lshlrev_b32 v10, 16, v10
  v_mul_f32 v10, v10, v26
  v_mul_f32 v15, 0xbfb8aa3b, v11
  v_exp_f32 v15, v15
  s_nop 0
  v_add_f32 v15, 1.0, v15
  v_rcp_f32 v15, v15
  s_nop 0
  v_mul_f32 v11, v11, v15
  v_cvt_pk_bf16_f32 v11, v11, v11
  v_lshlrev_b32 v11, 16, v11
  v_mul_f32 v11, v11, v27
  v_cvt_pk_bf16_f32 v8, v8, v9
  v_cvt_pk_bf16_f32 v9, v10, v11
  v_and_b32 v6, 7, v0
  v_mul_u32_u24 v6, 0xd80, v6
  v_bfe_u32 v7, v0, 4, 1
  v_lshl_add_u32 v6, v7, 3, v6
  s_lshl_b32 s31, s28, 4
  s_add_u32 s31, s31, 2633728
  s_mov_b64 exec, 0x00ff00ff
  buffer_store_dwordx2 v[8:9], v6, s[24:27], s31 offen
ffn1_end:
  s_endpgm
.globl ffn2_kernel
.p2align 8
.type ffn2_kernel,@function
ffn2_kernel:
  s_cmp_ge_u32 s2, 240
  s_cbranch_scc1 ffn2_end
  s_load_dwordx2 s[4:5], s[0:1], 72
  s_load_dwordx2 s[10:11], s[0:1], 96
  v_lshrrev_b32 v1, 6, v0
  v_and_b32 v0, 63, v0
  v_readfirstlane_b32 s3, v1
  s_and_b32 s28, s2, 7
  s_mul_i32 s28, s28, 30
  s_lshr_b32 s29, s2, 3
  s_add_u32 s28, s28, s29
  s_mul_i32 s29, s28, 1639
  s_lshr_b32 s29, s29, 16
  s_mul_i32 s30, s29, 40
  s_sub_u32 s30, s28, s30
  s_waitcnt lgkmcnt(0)
  s_mov_b32 s12, s4
  s_mov_b32 s13, s5
  s_mov_b32 s14, 2211840
  s_mov_b32 s15, 0x20000
  s_mov_b32 s24, s10
  s_mov_b32 s25, s11
  s_mov_b32 s26, 8388608
  s_mov_b32 s27, 0x20000
  s_min_u32 s3, s3, 2
  s_mul_i32 s31, s29, 3
  s_add_u32 s31, s31, s3
  s_mul_i32 s31, s31, 96
  s_mul_i32 s32, s31, 1280
  s_lshl_b32 s33, s30, 5
  s_add_u32 s32, s32, s33
  v_lshrrev_b32 v2, 1, v0
  v_mul_u32_u24 v2, 0x500, v2
  v_and_b32 v3, 1, v0
  v_lshl_add_u32 v2, v3, 4, v2
  v_readfirstlane_b32 s34, v1
  s_nop 0
  s_mul_i32 s33, s34, 3072
  s_add_u32 m0, s33, 0
  s_nop 0
  buffer_load_dwordx4 v2, s[12:15], s32 offen lds
  s_add_u32 s32, s32, 40960
  s_add_u32 m0, s33, 1024
  s_nop 0
  buffer_load_dwordx4 v2, s[12:15], s32 offen lds
  s_add_u32 s32, s32, 40960
  s_add_u32 m0, s33, 2048
  s_nop 0
  buffer_load_dwordx4 v2, s[12:15], s32 offen lds
  s_add_u32 s32, s32, 40960
  v_and_b32 v3, 7, v0
  v_mul_u32_u24 v3, 0xd80, v3
  v_lshrrev_b32 v4, 4, v0
  v_lshl_add_u32 v3, v4, 4, v3
  s_lshl_b32 s31, s31, 1
  s_add_u32 s31, s31, 2633728
  buffer_load_dwordx4 v[8:11], v3, s[24:27], s31 offen offset:0
  buffer_load_dwordx4 v[12:15], v3, s[24:27], s31 offen offset:64
  buffer_load_dwordx4 v[16:19], v3, s[24:27], s31 offen offset:128
  v_lshrrev_b32 v5, 4, v0
  v_lshlrev_b32 v5, 3, v5
  v_bfe_u32 v6, v0, 2, 2
  v_add_u32 v5, v5, v6
  v_lshlrev_b32 v5, 5, v5
  v_and_b32 v6, 3, v0
  v_lshl_add_u32 v5, v6, 3, v5
  v_add_u32 v5, s33, v5
  s_waitcnt vmcnt(0)
  ds_read_b64_tr_b16 v[20:21], v5 offset:0
  ds_read_b64_tr_b16 v[22:23], v5 offset:128
  ds_read_b64_tr_b16 v[24:25], v5 offset:1024
  ds_read_b64_tr_b16 v[26:27], v5 offset:1152
  ds_read_b64_tr_b16 v[28:29], v5 offset:2048
  ds_read_b64_tr_b16 v[30:31], v5 offset:2176
  s_waitcnt lgkmcnt(4)
  v_mfma_f32_16x16x32_bf16 v[32:35], v[20:23], v[8:11], 0
  s_waitcnt lgkmcnt(2)
  v_mfma_f32_16x16x32_bf16 v[32:35], v[24:27], v[12:15], v[32:35]
  s_waitcnt lgkmcnt(0)
  v_mfma_f32_16x16x32_bf16 v[32:35], v[28:31], v[16:19], v[32:35]
  v_lshlrev_b32 v1, 4, v0
  s_lshl_b32 s31, s34, 10
  v_add_u32 v6, s31, v1
  s_nop 4
  ds_write_b128 v6, v[32:35] offset:12288
  s_waitcnt lgkmcnt(0)
  s_barrier
  s_cmp_lg_u32 s34, 0
  s_cbranch_scc1 ffn2_end
  ds_read_b128 v[8:11], v1 offset:12288
  ds_read_b128 v[12:15], v1 offset:13312
  ds_read_b128 v[16:19], v1 offset:14336
  s_waitcnt lgkmcnt(1)
  v_add_f32 v8, v8, v12
  s_waitcnt lgkmcnt(0)
  v_add_f32 v8, v8, v16
  v_add_f32 v9, v9, v13
  v_add_f32 v9, v9, v17
  v_add_f32 v10, v10, v14
  v_add_f32 v10, v10, v18
  v_add_f32 v11, v11, v15
  v_add_f32 v11, v11, v19
  v_and_b32 v3, 7, v0
  v_mul_u32_u24 v3, 0xa00, v3
  v_lshl_add_u32 v3, v4, 4, v3
  s_mul_i32 s31, s29, 20480
  s_lshl_b32 s32, s30, 6
  s_add_u32 s31, s31, s32
  s_add_u32 s31, s31, 2686976
  s_mov_b32 exec_lo, 0x00ff00ff
  s_mov_b32 exec_hi, 0x00ff00ff
  buffer_store_dwordx4 v[8:11], v3, s[24:27], s31 offen
ffn2_end:
  s_endpgm
.globl attn_kernel
.p2align 8
.type attn_kernel,@function
attn_kernel:
  s_cmp_ge_u32 s2, 256
  s_cbranch_scc1 attn_end
  s_load_dwordx4 s[4:7], s[0:1], 8
  s_load_dwordx2 s[8:9], s[0:1], 24
  s_load_dwordx2 s[10:11], s[0:1], 96
  v_lshrrev_b32 v249, 6, v0
  v_and_b32 v245, 63, v0
  v_readfirstlane_b32 s3, v249
  s_and_b32 s36, s2, 7
  s_lshl_b32 s36, s36, 2
  s_lshr_b32 s37, s2, 6
  s_add_u32 s36, s36, s37
  s_bfe_u32 s37, s2, 0x30003
  s_lshl_b32 s37, s37, 2
  s_add_u32 s37, s37, s3
  s_lshl_b32 s28, s3, 12
  v_lshlrev_b32 v242, 4, v245
  v_add_u32 v243, 0x1000, v242
  s_mul_i32 s30, s37, 81920
  v_lshrrev_b32 v248, 4, v245
  v_and_b32 v247, 15, v245
  s_lshl_b32 s38, s3, 17
  v_lshlrev_b32 v249, 13, v248
  v_add_u32 v249, s38, v249
  v_or_b32 v250, 0, v248
  v_lshlrev_b32 v250, 1, v250
  v_xor_b32 v250, v250, v247
  v_lshl_add_u32 v238, v250, 4, v249
  v_or_b32 v250, 0, v248
  v_lshlrev_b32 v250, 1, v250
  v_xor_b32 v250, v250, v247
  v_lshl_add_u32 v239, v250, 4, v249
  v_add_u32 v239, 31744, v239
  v_or_b32 v250, 4, v248
  v_lshlrev_b32 v250, 1, v250
  v_xor_b32 v250, v250, v247
  v_lshl_add_u32 v240, v250, 4, v249
  v_add_u32 v240, 63488, v240
  v_or_b32 v250, 4, v248
  v_lshlrev_b32 v250, 1, v250
  v_xor_b32 v250, v250, v247
  v_lshl_add_u32 v241, v250, 4, v249
  v_add_u32 v241, 95232, v241
  s_waitcnt lgkmcnt(0)
  s_lshl_b32 s38, s36, 8
  s_add_u32 s20, s8, s38
  s_addc_u32 s21, s9, 0
  s_mov_b32 s22, 5242880
  s_mov_b32 s23, 0x20000
  s_sub_u32 s22, s22, s38
  s_mov_b32 s24, s10
  s_mov_b32 s25, s11
  s_mov_b32 s26, 25165824
  s_mov_b32 s27, 0x20000
  s_mov_b32 s31, 0
  s_add_u32 m0, s28, 98304
  s_nop 0
  buffer_load_dwordx4 v238, s[20:23], s31 offen offset:0 lds
  buffer_load_dwordx4 v239, s[20:23], s31 offen offset:1024 lds
  buffer_load_dwordx4 v240, s[20:23], s31 offen offset:2048 lds
  buffer_load_dwordx4 v241, s[20:23], s31 offen offset:3072 lds
  s_add_u32 s31, s31, 0x80000
  buffer_load_dwordx4 a[0:3], v242, s[24:27], s30 offen offset:0
  buffer_load_dwordx4 a[4:7], v242, s[24:27], s30 offen offset:1024
  buffer_load_dwordx4 a[8:11], v242, s[24:27], s30 offen offset:2048
  buffer_load_dwordx4 a[12:15], v242, s[24:27], s30 offen offset:3072
  buffer_load_dwordx4 a[16:19], v243, s[24:27], s30 offen offset:0
  buffer_load_dwordx4 a[20:23], v243, s[24:27], s30 offen offset:1024
  buffer_load_dwordx4 a[24:27], v243, s[24:27], s30 offen offset:2048
  buffer_load_dwordx4 a[28:31], v243, s[24:27], s30 offen offset:3072
  s_add_u32 s30, s30, 8192
  s_add_u32 m0, s28, 114688
  s_nop 0
  buffer_load_dwordx4 v238, s[20:23], s31 offen offset:0 lds
  buffer_load_dwordx4 v239, s[20:23], s31 offen offset:1024 lds
  buffer_load_dwordx4 v240, s[20:23], s31 offen offset:2048 lds
  buffer_load_dwordx4 v241, s[20:23], s31 offen offset:3072 lds
  s_add_u32 s31, s31, 0x80000
  buffer_load_dwordx4 a[32:35], v242, s[24:27], s30 offen offset:0
  buffer_load_dwordx4 a[36:39], v242, s[24:27], s30 offen offset:1024
  buffer_load_dwordx4 a[40:43], v242, s[24:27], s30 offen offset:2048
  buffer_load_dwordx4 a[44:47], v242, s[24:27], s30 offen offset:3072
  buffer_load_dwordx4 a[48:51], v243, s[24:27], s30 offen offset:0
  buffer_load_dwordx4 a[52:55], v243, s[24:27], s30 offen offset:1024
  buffer_load_dwordx4 a[56:59], v243, s[24:27], s30 offen offset:2048
  buffer_load_dwordx4 a[60:63], v243, s[24:27], s30 offen offset:3072
  s_add_u32 s30, s30, 8192
  s_add_u32 m0, s28, 65536
  s_nop 0
  buffer_load_dwordx4 v238, s[20:23], s31 offen offset:0 lds
  buffer_load_dwordx4 v239, s[20:23], s31 offen offset:1024 lds
  buffer_load_dwordx4 v240, s[20:23], s31 offen offset:2048 lds
  buffer_load_dwordx4 v241, s[20:23], s31 offen offset:3072 lds
  s_add_u32 s31, s31, 0x80000
  buffer_load_dwordx4 a[64:67], v242, s[24:27], s30 offen offset:0
  buffer_load_dwordx4 a[68:71], v242, s[24:27], s30 offen offset:1024
  buffer_load_dwordx4 a[72:75], v242, s[24:27], s30 offen offset:2048
  buffer_load_dwordx4 a[76:79], v242, s[24:27], s30 offen offset:3072
  buffer_load_dwordx4 a[80:83], v243, s[24:27], s30 offen offset:0
  buffer_load_dwordx4 a[84:87], v243, s[24:27], s30 offen offset:1024
  buffer_load_dwordx4 a[88:91], v243, s[24:27], s30 offen offset:2048
  buffer_load_dwordx4 a[92:95], v243, s[24:27], s30 offen offset:3072
  s_add_u32 s30, s30, 8192
  s_add_u32 m0, s28, 81920
  s_nop 0
  buffer_load_dwordx4 v238, s[20:23], s31 offen offset:0 lds
  buffer_load_dwordx4 v239, s[20:23], s31 offen offset:1024 lds
  buffer_load_dwordx4 v240, s[20:23], s31 offen offset:2048 lds
  buffer_load_dwordx4 v241, s[20:23], s31 offen offset:3072 lds
  s_add_u32 s31, s31, 0x80000
  buffer_load_dwordx4 a[96:99], v242, s[24:27], s30 offen offset:0
  buffer_load_dwordx4 a[100:103], v242, s[24:27], s30 offen offset:1024
  buffer_load_dwordx4 a[104:107], v242, s[24:27], s30 offen offset:2048
  buffer_load_dwordx4 a[108:111], v242, s[24:27], s30 offen offset:3072
  buffer_load_dwordx4 a[112:115], v243, s[24:27], s30 offen offset:0
  buffer_load_dwordx4 a[116:119], v243, s[24:27], s30 offen offset:1024
  buffer_load_dwordx4 a[120:123], v243, s[24:27], s30 offen offset:2048
  buffer_load_dwordx4 a[124:127], v243, s[24:27], s30 offen offset:3072
  s_add_u32 s30, s30, 8192
  s_lshl_b32 s38, s36, 19
  s_add_u32 s12, s4, s38
  s_addc_u32 s13, s5, 0
  s_mov_b32 s14, 524288
  s_mov_b32 s15, 0x20000
  s_add_u32 s16, s6, s38
  s_addc_u32 s17, s7, 0
  s_mov_b32 s18, 524288
  s_mov_b32 s19, 0x20000
  v_lshlrev_b32 v249, 8, v248
  v_add_u32 v249, s28, v249
  v_add_u32 v250, 0, v248
  v_xor_b32 v250, v250, v247
  v_lshl_add_u32 v232, v250, 4, v249
  v_add_u32 v250, 4, v248
  v_xor_b32 v250, v250, v247
  v_lshl_add_u32 v233, v250, 4, v249
  v_add_u32 v250, 8, v248
  v_xor_b32 v250, v250, v247
  v_lshl_add_u32 v234, v250, 4, v249
  v_add_u32 v250, 12, v248
  v_xor_b32 v250, v250, v247
  v_lshl_add_u32 v235, v250, 4, v249
  v_add_u32 v250, 0, v248
  v_lshlrev_b32 v250, 1, v250
  v_xor_b32 v250, v250, v247
  v_lshl_add_u32 v236, v250, 4, v249
  v_add_u32 v250, 4, v248
  v_lshlrev_b32 v250, 1, v250
  v_xor_b32 v250, v250, v247
  v_lshl_add_u32 v237, v250, 4, v249
  v_lshrrev_b32 v249, 1, v248
  v_and_b32 v250, 1, v248
  v_lshl_or_b32 v249, v250, 1, v249
  v_xor_b32 v249, v249, v247
  v_lshlrev_b32 v249, 4, v249
  v_lshl_add_u32 v212, v247, 8, v249
  v_xor_b32 v213, 64, v212
  v_xor_b32 v214, 128, v212
  v_xor_b32 v215, 192, v212
  v_bfe_u32 v246, v245, 2, 2
  v_and_b32 v247, 3, v245
  v_lshlrev_b32 v247, 3, v247
  v_add_u32 v247, 65536, v247
  v_lshl_add_u32 v249, v248, 2, v246
  v_and_b32 v250, 7, v249
  v_lshl_add_u32 v250, v250, 5, v247
  v_lshl_add_u32 v216, v249, 8, v250
  v_lshl_add_u32 v249, v248, 3, v246
  v_and_b32 v250, 1, v248
  v_lshl_add_u32 v250, v250, 2, v246
  v_lshl_add_u32 v250, v250, 5, v247
  v_lshl_add_u32 v224, v249, 8, v250
  v_xor_b32 v217, 32, v216
  v_xor_b32 v225, 32, v224
  v_xor_b32 v218, 64, v216
  v_xor_b32 v226, 64, v224
  v_xor_b32 v219, 96, v216
  v_xor_b32 v227, 96, v224
  v_xor_b32 v220, 128, v216
  v_xor_b32 v228, 128, v224
  v_xor_b32 v221, 160, v216
  v_xor_b32 v229, 160, v224
  v_xor_b32 v222, 192, v216
  v_xor_b32 v230, 192, v224
  v_xor_b32 v223, 224, v216
  v_xor_b32 v231, 224, v224
  v_mov_b32 v244, v242
  s_lshl_b32 s40, s37, 19
  s_lshl_b32 s38, s36, 14
  s_add_u32 s40, s40, s38
  s_add_u32 s40, s40, 8388608
  s_add_u32 s41, s40, 4096
  s_add_u32 s42, s40, 8192
  s_add_u32 s43, s40, 12288
  s_mov_b32 s34, 0x3e0293ee
  s_mov_b32 s29, 0
  v_mov_b32 v208, 0
  v_mov_b32 v209, 0
  v_mov_b32 v210, 0
  v_mov_b32 v211, 0
  s_waitcnt vmcnt(44)
  s_barrier
  ds_read_b64_tr_b16 a[160:161], v224 offset:32768
  ds_read_b64_tr_b16 a[162:163], v224 offset:33792
  ds_read_b64_tr_b16 a[164:165], v224 offset:40960
  ds_read_b64_tr_b16 a[166:167], v224 offset:41984
  ds_read_b64_tr_b16 a[168:169], v225 offset:32768
  ds_read_b64_tr_b16 a[170:171], v225 offset:33792
  ds_read_b64_tr_b16 a[172:173], v225 offset:40960
  ds_read_b64_tr_b16 a[174:175], v225 offset:41984
  s_waitcnt vmcnt(36) lgkmcnt(4)
  v_mfma_f32_16x16x32_bf16 v[0:3], a[160:163], a[0:3], 0
  ds_read_b64_tr_b16 a[176:177], v226 offset:32768
  v_mfma_f32_16x16x32_bf16 v[0:3], a[164:167], a[16:19], v[0:3]
  v_mfma_f32_16x16x32_bf16 v[4:7], a[164:167], a[20:23], 0
  ds_read_b64_tr_b16 a[178:179], v226 offset:33792
  v_mfma_f32_16x16x32_bf16 v[4:7], a[160:163], a[4:7], v[4:7]
  v_mfma_f32_16x16x32_bf16 v[8:11], a[160:163], a[8:11], 0
  ds_read_b64_tr_b16 a[180:181], v226 offset:40960
  v_mfma_f32_16x16x32_bf16 v[8:11], a[164:167], a[24:27], v[8:11]
  v_mfma_f32_16x16x32_bf16 v[12:15], a[164:167], a[28:31], 0
  ds_read_b64_tr_b16 a[182:183], v226 offset:41984
  v_mfma_f32_16x16x32_bf16 v[12:15], a[160:163], a[12:15], v[12:15]
  s_waitcnt lgkmcnt(4)
  v_mfma_f32_16x16x32_bf16 v[16:19], a[168:171], a[0:3], 0
  ds_read_b64_tr_b16 a[184:185], v227 offset:32768
  v_mfma_f32_16x16x32_bf16 v[16:19], a[172:175], a[16:19], v[16:19]
  v_mfma_f32_16x16x32_bf16 v[20:23], a[172:175], a[20:23], 0
  ds_read_b64_tr_b16 a[186:187], v227 offset:33792
  v_mfma_f32_16x16x32_bf16 v[20:23], a[168:171], a[4:7], v[20:23]
  v_mfma_f32_16x16x32_bf16 v[24:27], a[168:171], a[8:11], 0
  ds_read_b64_tr_b16 a[188:189], v227 offset:40960
  v_mfma_f32_16x16x32_bf16 v[24:27], a[172:175], a[24:27], v[24:27]
  v_mfma_f32_16x16x32_bf16 v[28:31], a[172:175], a[28:31], 0
  ds_read_b64_tr_b16 a[190:191], v227 offset:41984
  v_mfma_f32_16x16x32_bf16 v[28:31], a[168:171], a[12:15], v[28:31]
  s_waitcnt lgkmcnt(4)
  v_mfma_f32_16x16x32_bf16 v[32:35], a[176:179], a[0:3], 0
  ds_read_b64_tr_b16 a[160:161], v228 offset:32768
  v_mfma_f32_16x16x32_bf16 v[32:35], a[180:183], a[16:19], v[32:35]
  v_mfma_f32_16x16x32_bf16 v[36:39], a[180:183], a[20:23], 0
  ds_read_b64_tr_b16 a[162:163], v228 offset:33792
  v_mfma_f32_16x16x32_bf16 v[36:39], a[176:179], a[4:7], v[36:39]
  v_mfma_f32_16x16x32_bf16 v[40:43], a[176:179], a[8:11], 0
  ds_read_b64_tr_b16 a[164:165], v228 offset:40960
  v_mfma_f32_16x16x32_bf16 v[40:43], a[180:183], a[24:27], v[40:43]
  v_mfma_f32_16x16x32_bf16 v[44:47], a[180:183], a[28:31], 0
  ds_read_b64_tr_b16 a[166:167], v228 offset:41984
  v_mfma_f32_16x16x32_bf16 v[44:47], a[176:179], a[12:15], v[44:47]
  s_waitcnt lgkmcnt(4)
  v_mfma_f32_16x16x32_bf16 v[48:51], a[184:187], a[0:3], 0
  ds_read_b64_tr_b16 a[168:169], v229 offset:32768
  v_mfma_f32_16x16x32_bf16 v[48:51], a[188:191], a[16:19], v[48:51]
  v_mfma_f32_16x16x32_bf16 v[52:55], a[188:191], a[20:23], 0
  ds_read_b64_tr_b16 a[170:171], v229 offset:33792
  v_mfma_f32_16x16x32_bf16 v[52:55], a[184:187], a[4:7], v[52:55]
  v_mfma_f32_16x16x32_bf16 v[56:59], a[184:187], a[8:11], 0
  ds_read_b64_tr_b16 a[172:173], v229 offset:40960
  v_mfma_f32_16x16x32_bf16 v[56:59], a[188:191], a[24:27], v[56:59]
  v_mfma_f32_16x16x32_bf16 v[60:63], a[188:191], a[28:31], 0
  ds_read_b64_tr_b16 a[174:175], v229 offset:41984
  v_mfma_f32_16x16x32_bf16 v[60:63], a[184:187], a[12:15], v[60:63]
  s_waitcnt lgkmcnt(4)
  v_mfma_f32_16x16x32_bf16 v[64:67], a[160:163], a[0:3], 0
  ds_read_b64_tr_b16 a[176:177], v230 offset:32768
  v_mfma_f32_16x16x32_bf16 v[64:67], a[164:167], a[16:19], v[64:67]
  v_mfma_f32_16x16x32_bf16 v[68:71], a[164:167], a[20:23], 0
  ds_read_b64_tr_b16 a[178:179], v230 offset:33792
  v_mfma_f32_16x16x32_bf16 v[68:71], a[160:163], a[4:7], v[68:71]
  v_mfma_f32_16x16x32_bf16 v[72:75], a[160:163], a[8:11], 0
  ds_read_b64_tr_b16 a[180:181], v230 offset:40960
  v_mfma_f32_16x16x32_bf16 v[72:75], a[164:167], a[24:27], v[72:75]
  v_mfma_f32_16x16x32_bf16 v[76:79], a[164:167], a[28:31], 0
  ds_read_b64_tr_b16 a[182:183], v230 offset:41984
  v_mfma_f32_16x16x32_bf16 v[76:79], a[160:163], a[12:15], v[76:79]
  s_waitcnt lgkmcnt(4)
  v_mfma_f32_16x16x32_bf16 v[80:83], a[168:171], a[0:3], 0
  ds_read_b64_tr_b16 a[184:185], v231 offset:32768
  v_mfma_f32_16x16x32_bf16 v[80:83], a[172:175], a[16:19], v[80:83]
  v_mfma_f32_16x16x32_bf16 v[84:87], a[172:175], a[20:23], 0
  ds_read_b64_tr_b16 a[186:187], v231 offset:33792
  v_mfma_f32_16x16x32_bf16 v[84:87], a[168:171], a[4:7], v[84:87]
  s_waitcnt vmcnt(32)
  v_mfma_f32_16x16x32_bf16 v[88:91], a[168:171], a[8:11], 0
  ds_read_b64_tr_b16 a[188:189], v231 offset:40960
  v_mfma_f32_16x16x32_bf16 v[88:91], a[172:175], a[24:27], v[88:91]
  s_barrier
  v_mfma_f32_16x16x32_bf16 v[92:95], a[172:175], a[28:31], 0
  ds_read_b64_tr_b16 a[190:191], v231 offset:41984
  v_mfma_f32_16x16x32_bf16 v[92:95], a[168:171], a[12:15], v[92:95]
  s_waitcnt lgkmcnt(4)
  v_mfma_f32_16x16x32_bf16 v[96:99], a[176:179], a[0:3], 0
  ds_read_b64_tr_b16 a[160:161], v224 offset:49152
  v_mfma_f32_16x16x32_bf16 v[96:99], a[180:183], a[16:19], v[96:99]
  v_mfma_f32_16x16x32_bf16 v[100:103], a[180:183], a[20:23], 0
  ds_read_b64_tr_b16 a[162:163], v224 offset:50176
  v_mfma_f32_16x16x32_bf16 v[100:103], a[176:179], a[4:7], v[100:103]
  v_mfma_f32_16x16x32_bf16 v[104:107], a[176:179], a[8:11], 0
  ds_read_b64_tr_b16 a[164:165], v224 offset:57344
  v_mfma_f32_16x16x32_bf16 v[104:107], a[180:183], a[24:27], v[104:107]
  v_mfma_f32_16x16x32_bf16 v[108:111], a[180:183], a[28:31], 0
  ds_read_b64_tr_b16 a[166:167], v224 offset:58368
  v_mfma_f32_16x16x32_bf16 v[108:111], a[176:179], a[12:15], v[108:111]
  s_waitcnt lgkmcnt(4)
  v_mfma_f32_16x16x32_bf16 v[112:115], a[184:187], a[0:3], 0
  ds_read_b64_tr_b16 a[168:169], v225 offset:49152
  v_mfma_f32_16x16x32_bf16 v[112:115], a[188:191], a[16:19], v[112:115]
  v_mfma_f32_16x16x32_bf16 v[116:119], a[188:191], a[20:23], 0
  ds_read_b64_tr_b16 a[170:171], v225 offset:50176
  v_mfma_f32_16x16x32_bf16 v[116:119], a[184:187], a[4:7], v[116:119]
  v_mfma_f32_16x16x32_bf16 v[120:123], a[184:187], a[8:11], 0
  ds_read_b64_tr_b16 a[172:173], v225 offset:57344
  v_mfma_f32_16x16x32_bf16 v[120:123], a[188:191], a[24:27], v[120:123]
  v_mfma_f32_16x16x32_bf16 v[124:127], a[188:191], a[28:31], 0
  ds_read_b64_tr_b16 a[174:175], v225 offset:58368
  v_mfma_f32_16x16x32_bf16 v[124:127], a[184:187], a[12:15], v[124:127]
  s_waitcnt vmcnt(24) lgkmcnt(4)
  v_mfma_f32_16x16x32_bf16 v[0:3], a[160:163], a[32:35], v[0:3]
  ds_read_b64_tr_b16 a[176:177], v226 offset:49152
  v_mfma_f32_16x16x32_bf16 v[0:3], a[164:167], a[48:51], v[0:3]
  buffer_load_dwordx4 a[0:3], v242, s[24:27], s30 offen offset:0
  v_mfma_f32_16x16x32_bf16 v[4:7], a[164:167], a[52:55], v[4:7]
  ds_read_b64_tr_b16 a[178:179], v226 offset:50176
  v_mfma_f32_16x16x32_bf16 v[4:7], a[160:163], a[36:39], v[4:7]
  buffer_load_dwordx4 a[4:7], v242, s[24:27], s30 offen offset:1024
  v_mfma_f32_16x16x32_bf16 v[8:11], a[160:163], a[40:43], v[8:11]
  ds_read_b64_tr_b16 a[180:181], v226 offset:57344
  v_mfma_f32_16x16x32_bf16 v[8:11], a[164:167], a[56:59], v[8:11]
  buffer_load_dwordx4 a[8:11], v242, s[24:27], s30 offen offset:2048
  v_mfma_f32_16x16x32_bf16 v[12:15], a[164:167], a[60:63], v[12:15]
  ds_read_b64_tr_b16 a[182:183], v226 offset:58368
  v_mfma_f32_16x16x32_bf16 v[12:15], a[160:163], a[44:47], v[12:15]
  s_waitcnt lgkmcnt(4)
  v_mfma_f32_16x16x32_bf16 v[16:19], a[168:171], a[32:35], v[16:19]
  ds_read_b64_tr_b16 a[184:185], v227 offset:49152
  v_mfma_f32_16x16x32_bf16 v[16:19], a[172:175], a[48:51], v[16:19]
  buffer_load_dwordx4 a[12:15], v242, s[24:27], s30 offen offset:3072
  v_mfma_f32_16x16x32_bf16 v[20:23], a[172:175], a[52:55], v[20:23]
  ds_read_b64_tr_b16 a[186:187], v227 offset:50176
  v_mfma_f32_16x16x32_bf16 v[20:23], a[168:171], a[36:39], v[20:23]
  buffer_load_dwordx4 a[16:19], v243, s[24:27], s30 offen offset:0
  v_mfma_f32_16x16x32_bf16 v[24:27], a[168:171], a[40:43], v[24:27]
  ds_read_b64_tr_b16 a[188:189], v227 offset:57344
  v_mfma_f32_16x16x32_bf16 v[24:27], a[172:175], a[56:59], v[24:27]
  buffer_load_dwordx4 a[20:23], v243, s[24:27], s30 offen offset:1024
  v_mfma_f32_16x16x32_bf16 v[28:31], a[172:175], a[60:63], v[28:31]
  ds_read_b64_tr_b16 a[190:191], v227 offset:58368
  v_mfma_f32_16x16x32_bf16 v[28:31], a[168:171], a[44:47], v[28:31]
  s_waitcnt lgkmcnt(4)
  v_mfma_f32_16x16x32_bf16 v[32:35], a[176:179], a[32:35], v[32:35]
  ds_read_b64_tr_b16 a[160:161], v228 offset:49152
  v_mfma_f32_16x16x32_bf16 v[32:35], a[180:183], a[48:51], v[32:35]
  buffer_load_dwordx4 a[24:27], v243, s[24:27], s30 offen offset:2048
  v_mfma_f32_16x16x32_bf16 v[36:39], a[180:183], a[52:55], v[36:39]
  ds_read_b64_tr_b16 a[162:163], v228 offset:50176
  v_mfma_f32_16x16x32_bf16 v[36:39], a[176:179], a[36:39], v[36:39]
  buffer_load_dwordx4 a[28:31], v243, s[24:27], s30 offen offset:3072
  v_mfma_f32_16x16x32_bf16 v[40:43], a[176:179], a[40:43], v[40:43]
  ds_read_b64_tr_b16 a[164:165], v228 offset:57344
  v_mfma_f32_16x16x32_bf16 v[40:43], a[180:183], a[56:59], v[40:43]
  s_add_u32 s30, s30, 8192
  v_mfma_f32_16x16x32_bf16 v[44:47], a[180:183], a[60:63], v[44:47]
  ds_read_b64_tr_b16 a[166:167], v228 offset:58368
  v_mfma_f32_16x16x32_bf16 v[44:47], a[176:179], a[44:47], v[44:47]
  s_waitcnt lgkmcnt(4)
  v_mfma_f32_16x16x32_bf16 v[48:51], a[184:187], a[32:35], v[48:51]
  ds_read_b64_tr_b16 a[168:169], v229 offset:49152
  v_mfma_f32_16x16x32_bf16 v[48:51], a[188:191], a[48:51], v[48:51]
  v_mfma_f32_16x16x32_bf16 v[52:55], a[188:191], a[52:55], v[52:55]
  ds_read_b64_tr_b16 a[170:171], v229 offset:50176
  v_mfma_f32_16x16x32_bf16 v[52:55], a[184:187], a[36:39], v[52:55]
  v_mfma_f32_16x16x32_bf16 v[56:59], a[184:187], a[40:43], v[56:59]
  ds_read_b64_tr_b16 a[172:173], v229 offset:57344
  v_mfma_f32_16x16x32_bf16 v[56:59], a[188:191], a[56:59], v[56:59]
  v_mfma_f32_16x16x32_bf16 v[60:63], a[188:191], a[60:63], v[60:63]
  ds_read_b64_tr_b16 a[174:175], v229 offset:58368
  v_mfma_f32_16x16x32_bf16 v[60:63], a[184:187], a[44:47], v[60:63]
  s_waitcnt lgkmcnt(4)
  v_mfma_f32_16x16x32_bf16 v[64:67], a[160:163], a[32:35], v[64:67]
  ds_read_b64_tr_b16 a[176:177], v230 offset:49152
  v_mfma_f32_16x16x32_bf16 v[64:67], a[164:167], a[48:51], v[64:67]
  v_mfma_f32_16x16x32_bf16 v[68:71], a[164:167], a[52:55], v[68:71]
  ds_read_b64_tr_b16 a[178:179], v230 offset:50176
  v_mfma_f32_16x16x32_bf16 v[68:71], a[160:163], a[36:39], v[68:71]
  v_mfma_f32_16x16x32_bf16 v[72:75], a[160:163], a[40:43], v[72:75]
  ds_read_b64_tr_b16 a[180:181], v230 offset:57344
  v_mfma_f32_16x16x32_bf16 v[72:75], a[164:167], a[56:59], v[72:75]
  v_mfma_f32_16x16x32_bf16 v[76:79], a[164:167], a[60:63], v[76:79]
  ds_read_b64_tr_b16 a[182:183], v230 offset:58368
  v_mfma_f32_16x16x32_bf16 v[76:79], a[160:163], a[44:47], v[76:79]
  s_waitcnt lgkmcnt(4)
  v_mfma_f32_16x16x32_bf16 v[80:83], a[168:171], a[32:35], v[80:83]
  ds_read_b64_tr_b16 a[184:185], v231 offset:49152
  v_mfma_f32_16x16x32_bf16 v[80:83], a[172:175], a[48:51], v[80:83]
  v_mfma_f32_16x16x32_bf16 v[84:87], a[172:175], a[52:55], v[84:87]
  ds_read_b64_tr_b16 a[186:187], v231 offset:50176
  v_mfma_f32_16x16x32_bf16 v[84:87], a[168:171], a[36:39], v[84:87]
  s_waitcnt vmcnt(28)
  v_mfma_f32_16x16x32_bf16 v[88:91], a[168:171], a[40:43], v[88:91]
  ds_read_b64_tr_b16 a[188:189], v231 offset:57344
  v_mfma_f32_16x16x32_bf16 v[88:91], a[172:175], a[56:59], v[88:91]
  s_barrier
  v_mfma_f32_16x16x32_bf16 v[92:95], a[172:175], a[60:63], v[92:95]
  ds_read_b64_tr_b16 a[190:191], v231 offset:58368
  v_mfma_f32_16x16x32_bf16 v[92:95], a[168:171], a[44:47], v[92:95]
  s_waitcnt lgkmcnt(4)
  v_mfma_f32_16x16x32_bf16 v[96:99], a[176:179], a[32:35], v[96:99]
  s_add_u32 m0, s28, 98304
  v_mfma_f32_16x16x32_bf16 v[96:99], a[180:183], a[48:51], v[96:99]
  ds_read_b64_tr_b16 a[160:161], v224 offset:0
  v_mfma_f32_16x16x32_bf16 v[100:103], a[180:183], a[52:55], v[100:103]
  buffer_load_dwordx4 v238, s[20:23], s31 offen offset:0 lds
  v_mfma_f32_16x16x32_bf16 v[100:103], a[176:179], a[36:39], v[100:103]
  ds_read_b64_tr_b16 a[162:163], v224 offset:1024
  v_mfma_f32_16x16x32_bf16 v[104:107], a[176:179], a[40:43], v[104:107]
  buffer_load_dwordx4 v239, s[20:23], s31 offen offset:1024 lds
  v_mfma_f32_16x16x32_bf16 v[104:107], a[180:183], a[56:59], v[104:107]
  ds_read_b64_tr_b16 a[164:165], v224 offset:8192
  v_mfma_f32_16x16x32_bf16 v[108:111], a[180:183], a[60:63], v[108:111]
  buffer_load_dwordx4 v240, s[20:23], s31 offen offset:2048 lds
  v_mfma_f32_16x16x32_bf16 v[108:111], a[176:179], a[44:47], v[108:111]
  ds_read_b64_tr_b16 a[166:167], v224 offset:9216
  s_waitcnt lgkmcnt(4)
  v_mfma_f32_16x16x32_bf16 v[112:115], a[184:187], a[32:35], v[112:115]
  ds_read_b64_tr_b16 a[168:169], v225 offset:0
  v_mfma_f32_16x16x32_bf16 v[112:115], a[188:191], a[48:51], v[112:115]
  buffer_load_dwordx4 v241, s[20:23], s31 offen offset:3072 lds
  v_mfma_f32_16x16x32_bf16 v[116:119], a[188:191], a[52:55], v[116:119]
  ds_read_b64_tr_b16 a[170:171], v225 offset:1024
  v_mfma_f32_16x16x32_bf16 v[116:119], a[184:187], a[36:39], v[116:119]
  s_add_u32 s31, s31, 0x80000
  v_mfma_f32_16x16x32_bf16 v[120:123], a[184:187], a[40:43], v[120:123]
  ds_read_b64_tr_b16 a[172:173], v225 offset:8192
  v_mfma_f32_16x16x32_bf16 v[120:123], a[188:191], a[56:59], v[120:123]
  v_mfma_f32_16x16x32_bf16 v[124:127], a[188:191], a[60:63], v[124:127]
  ds_read_b64_tr_b16 a[174:175], v225 offset:9216
  v_mfma_f32_16x16x32_bf16 v[124:127], a[184:187], a[44:47], v[124:127]
  s_waitcnt vmcnt(24) lgkmcnt(4)
  v_mfma_f32_16x16x32_bf16 v[0:3], a[160:163], a[64:67], v[0:3]
  ds_read_b64_tr_b16 a[176:177], v226 offset:0
  v_mfma_f32_16x16x32_bf16 v[0:3], a[164:167], a[80:83], v[0:3]
  buffer_load_dwordx4 a[32:35], v242, s[24:27], s30 offen offset:0
  v_mfma_f32_16x16x32_bf16 v[4:7], a[164:167], a[84:87], v[4:7]
  ds_read_b64_tr_b16 a[178:179], v226 offset:1024
  v_mfma_f32_16x16x32_bf16 v[4:7], a[160:163], a[68:71], v[4:7]
  buffer_load_dwordx4 a[36:39], v242, s[24:27], s30 offen offset:1024
  v_mfma_f32_16x16x32_bf16 v[8:11], a[160:163], a[72:75], v[8:11]
  ds_read_b64_tr_b16 a[180:181], v226 offset:8192
  v_mfma_f32_16x16x32_bf16 v[8:11], a[164:167], a[88:91], v[8:11]
  buffer_load_dwordx4 a[40:43], v242, s[24:27], s30 offen offset:2048
  v_mfma_f32_16x16x32_bf16 v[12:15], a[164:167], a[92:95], v[12:15]
  ds_read_b64_tr_b16 a[182:183], v226 offset:9216
  v_mfma_f32_16x16x32_bf16 v[12:15], a[160:163], a[76:79], v[12:15]
  s_waitcnt lgkmcnt(4)
  v_mfma_f32_16x16x32_bf16 v[16:19], a[168:171], a[64:67], v[16:19]
  ds_read_b64_tr_b16 a[184:185], v227 offset:0
  v_mfma_f32_16x16x32_bf16 v[16:19], a[172:175], a[80:83], v[16:19]
  buffer_load_dwordx4 a[44:47], v242, s[24:27], s30 offen offset:3072
  v_mfma_f32_16x16x32_bf16 v[20:23], a[172:175], a[84:87], v[20:23]
  ds_read_b64_tr_b16 a[186:187], v227 offset:1024
  v_mfma_f32_16x16x32_bf16 v[20:23], a[168:171], a[68:71], v[20:23]
  buffer_load_dwordx4 a[48:51], v243, s[24:27], s30 offen offset:0
  v_mfma_f32_16x16x32_bf16 v[24:27], a[168:171], a[72:75], v[24:27]
  ds_read_b64_tr_b16 a[188:189], v227 offset:8192
  v_mfma_f32_16x16x32_bf16 v[24:27], a[172:175], a[88:91], v[24:27]
  buffer_load_dwordx4 a[52:55], v243, s[24:27], s30 offen offset:1024
  v_mfma_f32_16x16x32_bf16 v[28:31], a[172:175], a[92:95], v[28:31]
  ds_read_b64_tr_b16 a[190:191], v227 offset:9216
  v_mfma_f32_16x16x32_bf16 v[28:31], a[168:171], a[76:79], v[28:31]
  s_waitcnt lgkmcnt(4)
  v_mfma_f32_16x16x32_bf16 v[32:35], a[176:179], a[64:67], v[32:35]
  ds_read_b64_tr_b16 a[160:161], v228 offset:0
  v_mfma_f32_16x16x32_bf16 v[32:35], a[180:183], a[80:83], v[32:35]
  buffer_load_dwordx4 a[56:59], v243, s[24:27], s30 offen offset:2048
  v_mfma_f32_16x16x32_bf16 v[36:39], a[180:183], a[84:87], v[36:39]
  ds_read_b64_tr_b16 a[162:163], v228 offset:1024
  v_mfma_f32_16x16x32_bf16 v[36:39], a[176:179], a[68:71], v[36:39]
  buffer_load_dwordx4 a[60:63], v243, s[24:27], s30 offen offset:3072
  v_mfma_f32_16x16x32_bf16 v[40:43], a[176:179], a[72:75], v[40:43]
  ds_read_b64_tr_b16 a[164:165], v228 offset:8192
  v_mfma_f32_16x16x32_bf16 v[40:43], a[180:183], a[88:91], v[40:43]
  s_add_u32 s30, s30, 8192
  v_mfma_f32_16x16x32_bf16 v[44:47], a[180:183], a[92:95], v[44:47]
  ds_read_b64_tr_b16 a[166:167], v228 offset:9216
  v_mfma_f32_16x16x32_bf16 v[44:47], a[176:179], a[76:79], v[44:47]
  s_waitcnt lgkmcnt(4)
  v_mfma_f32_16x16x32_bf16 v[48:51], a[184:187], a[64:67], v[48:51]
  ds_read_b64_tr_b16 a[168:169], v229 offset:0
  v_mfma_f32_16x16x32_bf16 v[48:51], a[188:191], a[80:83], v[48:51]
  v_mfma_f32_16x16x32_bf16 v[52:55], a[188:191], a[84:87], v[52:55]
  ds_read_b64_tr_b16 a[170:171], v229 offset:1024
  v_mfma_f32_16x16x32_bf16 v[52:55], a[184:187], a[68:71], v[52:55]
  v_mfma_f32_16x16x32_bf16 v[56:59], a[184:187], a[72:75], v[56:59]
  ds_read_b64_tr_b16 a[172:173], v229 offset:8192
  v_mfma_f32_16x16x32_bf16 v[56:59], a[188:191], a[88:91], v[56:59]
  v_mfma_f32_16x16x32_bf16 v[60:63], a[188:191], a[92:95], v[60:63]
  ds_read_b64_tr_b16 a[174:175], v229 offset:9216
  v_mfma_f32_16x16x32_bf16 v[60:63], a[184:187], a[76:79], v[60:63]
  s_waitcnt lgkmcnt(4)
  v_mfma_f32_16x16x32_bf16 v[64:67], a[160:163], a[64:67], v[64:67]
  ds_read_b64_tr_b16 a[176:177], v230 offset:0
  v_mfma_f32_16x16x32_bf16 v[64:67], a[164:167], a[80:83], v[64:67]
  v_mfma_f32_16x16x32_bf16 v[68:71], a[164:167], a[84:87], v[68:71]
  ds_read_b64_tr_b16 a[178:179], v230 offset:1024
  v_mfma_f32_16x16x32_bf16 v[68:71], a[160:163], a[68:71], v[68:71]
  v_mfma_f32_16x16x32_bf16 v[72:75], a[160:163], a[72:75], v[72:75]
  ds_read_b64_tr_b16 a[180:181], v230 offset:8192
  v_mfma_f32_16x16x32_bf16 v[72:75], a[164:167], a[88:91], v[72:75]
  v_mfma_f32_16x16x32_bf16 v[76:79], a[164:167], a[92:95], v[76:79]
  ds_read_b64_tr_b16 a[182:183], v230 offset:9216
  v_mfma_f32_16x16x32_bf16 v[76:79], a[160:163], a[76:79], v[76:79]
  s_waitcnt lgkmcnt(4)
  v_mfma_f32_16x16x32_bf16 v[80:83], a[168:171], a[64:67], v[80:83]
  ds_read_b64_tr_b16 a[184:185], v231 offset:0
  v_mfma_f32_16x16x32_bf16 v[80:83], a[172:175], a[80:83], v[80:83]
  v_mfma_f32_16x16x32_bf16 v[84:87], a[172:175], a[84:87], v[84:87]
  ds_read_b64_tr_b16 a[186:187], v231 offset:1024
  v_mfma_f32_16x16x32_bf16 v[84:87], a[168:171], a[68:71], v[84:87]
  s_waitcnt vmcnt(28)
  v_mfma_f32_16x16x32_bf16 v[88:91], a[168:171], a[72:75], v[88:91]
  ds_read_b64_tr_b16 a[188:189], v231 offset:8192
  v_mfma_f32_16x16x32_bf16 v[88:91], a[172:175], a[88:91], v[88:91]
  s_barrier
  v_mfma_f32_16x16x32_bf16 v[92:95], a[172:175], a[92:95], v[92:95]
  ds_read_b64_tr_b16 a[190:191], v231 offset:9216
  v_mfma_f32_16x16x32_bf16 v[92:95], a[168:171], a[76:79], v[92:95]
  s_waitcnt lgkmcnt(4)
  v_mfma_f32_16x16x32_bf16 v[96:99], a[176:179], a[64:67], v[96:99]
  s_add_u32 m0, s28, 114688
  v_mfma_f32_16x16x32_bf16 v[96:99], a[180:183], a[80:83], v[96:99]
  ds_read_b64_tr_b16 a[160:161], v224 offset:16384
  v_mfma_f32_16x16x32_bf16 v[100:103], a[180:183], a[84:87], v[100:103]
  buffer_load_dwordx4 v238, s[20:23], s31 offen offset:0 lds
  v_mfma_f32_16x16x32_bf16 v[100:103], a[176:179], a[68:71], v[100:103]
  ds_read_b64_tr_b16 a[162:163], v224 offset:17408
  v_mfma_f32_16x16x32_bf16 v[104:107], a[176:179], a[72:75], v[104:107]
  buffer_load_dwordx4 v239, s[20:23], s31 offen offset:1024 lds
  v_mfma_f32_16x16x32_bf16 v[104:107], a[180:183], a[88:91], v[104:107]
  ds_read_b64_tr_b16 a[164:165], v224 offset:24576
  v_mfma_f32_16x16x32_bf16 v[108:111], a[180:183], a[92:95], v[108:111]
  buffer_load_dwordx4 v240, s[20:23], s31 offen offset:2048 lds
  v_mfma_f32_16x16x32_bf16 v[108:111], a[176:179], a[76:79], v[108:111]
  ds_read_b64_tr_b16 a[166:167], v224 offset:25600
  s_waitcnt lgkmcnt(4)
  v_mfma_f32_16x16x32_bf16 v[112:115], a[184:187], a[64:67], v[112:115]
  ds_read_b64_tr_b16 a[168:169], v225 offset:16384
  v_mfma_f32_16x16x32_bf16 v[112:115], a[188:191], a[80:83], v[112:115]
  buffer_load_dwordx4 v241, s[20:23], s31 offen offset:3072 lds
  v_mfma_f32_16x16x32_bf16 v[116:119], a[188:191], a[84:87], v[116:119]
  ds_read_b64_tr_b16 a[170:171], v225 offset:17408
  v_mfma_f32_16x16x32_bf16 v[116:119], a[184:187], a[68:71], v[116:119]
  s_add_u32 s31, s31, 0x80000
  v_mfma_f32_16x16x32_bf16 v[120:123], a[184:187], a[72:75], v[120:123]
  ds_read_b64_tr_b16 a[172:173], v225 offset:24576
  v_mfma_f32_16x16x32_bf16 v[120:123], a[188:191], a[88:91], v[120:123]
  v_mfma_f32_16x16x32_bf16 v[124:127], a[188:191], a[92:95], v[124:127]
  ds_read_b64_tr_b16 a[174:175], v225 offset:25600
  v_mfma_f32_16x16x32_bf16 v[124:127], a[184:187], a[76:79], v[124:127]
  s_waitcnt vmcnt(24) lgkmcnt(4)
  v_mfma_f32_16x16x32_bf16 v[0:3], a[160:163], a[96:99], v[0:3]
  ds_read_b64_tr_b16 a[176:177], v226 offset:16384
  v_mfma_f32_16x16x32_bf16 v[0:3], a[164:167], a[112:115], v[0:3]
  buffer_load_dwordx4 a[64:67], v242, s[24:27], s30 offen offset:0
  v_mfma_f32_16x16x32_bf16 v[4:7], a[164:167], a[116:119], v[4:7]
  ds_read_b64_tr_b16 a[178:179], v226 offset:17408
  v_mfma_f32_16x16x32_bf16 v[4:7], a[160:163], a[100:103], v[4:7]
  buffer_load_dwordx4 a[68:71], v242, s[24:27], s30 offen offset:1024
  v_mfma_f32_16x16x32_bf16 v[8:11], a[160:163], a[104:107], v[8:11]
  ds_read_b64_tr_b16 a[180:181], v226 offset:24576
  v_mfma_f32_16x16x32_bf16 v[8:11], a[164:167], a[120:123], v[8:11]
  buffer_load_dwordx4 a[72:75], v242, s[24:27], s30 offen offset:2048
  v_mfma_f32_16x16x32_bf16 v[12:15], a[164:167], a[124:127], v[12:15]
  ds_read_b64_tr_b16 a[182:183], v226 offset:25600
  v_mfma_f32_16x16x32_bf16 v[12:15], a[160:163], a[108:111], v[12:15]
  s_waitcnt lgkmcnt(4)
  v_mfma_f32_16x16x32_bf16 v[16:19], a[168:171], a[96:99], v[16:19]
  ds_read_b64_tr_b16 a[184:185], v227 offset:16384
  v_mfma_f32_16x16x32_bf16 v[16:19], a[172:175], a[112:115], v[16:19]
  buffer_load_dwordx4 a[76:79], v242, s[24:27], s30 offen offset:3072
  v_mfma_f32_16x16x32_bf16 v[20:23], a[172:175], a[116:119], v[20:23]
  ds_read_b64_tr_b16 a[186:187], v227 offset:17408
  v_mfma_f32_16x16x32_bf16 v[20:23], a[168:171], a[100:103], v[20:23]
  buffer_load_dwordx4 a[80:83], v243, s[24:27], s30 offen offset:0
  v_mfma_f32_16x16x32_bf16 v[24:27], a[168:171], a[104:107], v[24:27]
  ds_read_b64_tr_b16 a[188:189], v227 offset:24576
  v_mfma_f32_16x16x32_bf16 v[24:27], a[172:175], a[120:123], v[24:27]
  buffer_load_dwordx4 a[84:87], v243, s[24:27], s30 offen offset:1024
  v_mfma_f32_16x16x32_bf16 v[28:31], a[172:175], a[124:127], v[28:31]
  ds_read_b64_tr_b16 a[190:191], v227 offset:25600
  v_mfma_f32_16x16x32_bf16 v[28:31], a[168:171], a[108:111], v[28:31]
  s_waitcnt lgkmcnt(4)
  v_mfma_f32_16x16x32_bf16 v[32:35], a[176:179], a[96:99], v[32:35]
  ds_read_b64_tr_b16 a[160:161], v228 offset:16384
  v_mfma_f32_16x16x32_bf16 v[32:35], a[180:183], a[112:115], v[32:35]
  buffer_load_dwordx4 a[88:91], v243, s[24:27], s30 offen offset:2048
  v_mfma_f32_16x16x32_bf16 v[36:39], a[180:183], a[116:119], v[36:39]
  ds_read_b64_tr_b16 a[162:163], v228 offset:17408
  v_mfma_f32_16x16x32_bf16 v[36:39], a[176:179], a[100:103], v[36:39]
  buffer_load_dwordx4 a[92:95], v243, s[24:27], s30 offen offset:3072
  v_mfma_f32_16x16x32_bf16 v[40:43], a[176:179], a[104:107], v[40:43]
  ds_read_b64_tr_b16 a[164:165], v228 offset:24576
  v_mfma_f32_16x16x32_bf16 v[40:43], a[180:183], a[120:123], v[40:43]
  s_add_u32 s30, s30, 8192
  v_mfma_f32_16x16x32_bf16 v[44:47], a[180:183], a[124:127], v[44:47]
  ds_read_b64_tr_b16 a[166:167], v228 offset:25600
  v_mfma_f32_16x16x32_bf16 v[44:47], a[176:179], a[108:111], v[44:47]
  s_waitcnt lgkmcnt(4)
  v_mfma_f32_16x16x32_bf16 v[48:51], a[184:187], a[96:99], v[48:51]
  ds_read_b64_tr_b16 a[168:169], v229 offset:16384
  v_mfma_f32_16x16x32_bf16 v[48:51], a[188:191], a[112:115], v[48:51]
  v_mfma_f32_16x16x32_bf16 v[52:55], a[188:191], a[116:119], v[52:55]
  ds_read_b64_tr_b16 a[170:171], v229 offset:17408
  v_mfma_f32_16x16x32_bf16 v[52:55], a[184:187], a[100:103], v[52:55]
  v_mfma_f32_16x16x32_bf16 v[56:59], a[184:187], a[104:107], v[56:59]
  ds_read_b64_tr_b16 a[172:173], v229 offset:24576
  v_mfma_f32_16x16x32_bf16 v[56:59], a[188:191], a[120:123], v[56:59]
  v_mfma_f32_16x16x32_bf16 v[60:63], a[188:191], a[124:127], v[60:63]
  ds_read_b64_tr_b16 a[174:175], v229 offset:25600
  v_mfma_f32_16x16x32_bf16 v[60:63], a[184:187], a[108:111], v[60:63]
  s_waitcnt lgkmcnt(4)
  v_mfma_f32_16x16x32_bf16 v[64:67], a[160:163], a[96:99], v[64:67]
  ds_read_b64_tr_b16 a[176:177], v230 offset:16384
  v_mfma_f32_16x16x32_bf16 v[64:67], a[164:167], a[112:115], v[64:67]
  v_mfma_f32_16x16x32_bf16 v[68:71], a[164:167], a[116:119], v[68:71]
  ds_read_b64_tr_b16 a[178:179], v230 offset:17408
  v_mfma_f32_16x16x32_bf16 v[68:71], a[160:163], a[100:103], v[68:71]
  v_mfma_f32_16x16x32_bf16 v[72:75], a[160:163], a[104:107], v[72:75]
  ds_read_b64_tr_b16 a[180:181], v230 offset:24576
  v_mfma_f32_16x16x32_bf16 v[72:75], a[164:167], a[120:123], v[72:75]
  v_mfma_f32_16x16x32_bf16 v[76:79], a[164:167], a[124:127], v[76:79]
  ds_read_b64_tr_b16 a[182:183], v230 offset:25600
  v_mfma_f32_16x16x32_bf16 v[76:79], a[160:163], a[108:111], v[76:79]
  s_waitcnt lgkmcnt(4)
  v_mfma_f32_16x16x32_bf16 v[80:83], a[168:171], a[96:99], v[80:83]
  ds_read_b64_tr_b16 a[184:185], v231 offset:16384
  v_mfma_f32_16x16x32_bf16 v[80:83], a[172:175], a[112:115], v[80:83]
  v_mfma_f32_16x16x32_bf16 v[84:87], a[172:175], a[116:119], v[84:87]
  ds_read_b64_tr_b16 a[186:187], v231 offset:17408
  v_mfma_f32_16x16x32_bf16 v[84:87], a[168:171], a[100:103], v[84:87]
  s_waitcnt vmcnt(20)
  v_mfma_f32_16x16x32_bf16 v[88:91], a[168:171], a[104:107], v[88:91]
  ds_read_b64_tr_b16 a[188:189], v231 offset:24576
  v_mfma_f32_16x16x32_bf16 v[88:91], a[172:175], a[120:123], v[88:91]
  s_barrier
  v_mfma_f32_16x16x32_bf16 v[92:95], a[172:175], a[124:127], v[92:95]
  ds_read_b64_tr_b16 a[190:191], v231 offset:25600
  v_mfma_f32_16x16x32_bf16 v[92:95], a[168:171], a[108:111], v[92:95]
  s_waitcnt lgkmcnt(4)
  v_mfma_f32_16x16x32_bf16 v[96:99], a[176:179], a[96:99], v[96:99]
  s_add_u32 m0, s28, 65536
  v_mfma_f32_16x16x32_bf16 v[96:99], a[180:183], a[112:115], v[96:99]
  ds_read_b64_tr_b16 a[160:161], v224 offset:32768
  v_mfma_f32_16x16x32_bf16 v[100:103], a[180:183], a[116:119], v[100:103]
  buffer_load_dwordx4 v238, s[20:23], s31 offen offset:0 lds
  v_mfma_f32_16x16x32_bf16 v[100:103], a[176:179], a[100:103], v[100:103]
  ds_read_b64_tr_b16 a[162:163], v224 offset:33792
  v_mfma_f32_16x16x32_bf16 v[104:107], a[176:179], a[104:107], v[104:107]
  buffer_load_dwordx4 v239, s[20:23], s31 offen offset:1024 lds
  v_mfma_f32_16x16x32_bf16 v[104:107], a[180:183], a[120:123], v[104:107]
  ds_read_b64_tr_b16 a[164:165], v224 offset:40960
  v_mfma_f32_16x16x32_bf16 v[108:111], a[180:183], a[124:127], v[108:111]
  buffer_load_dwordx4 v240, s[20:23], s31 offen offset:2048 lds
  v_mfma_f32_16x16x32_bf16 v[108:111], a[176:179], a[108:111], v[108:111]
  ds_read_b64_tr_b16 a[166:167], v224 offset:41984
  s_waitcnt lgkmcnt(4)
  v_mfma_f32_16x16x32_bf16 v[112:115], a[184:187], a[96:99], v[112:115]
  ds_read_b64_tr_b16 a[168:169], v225 offset:32768
  v_mfma_f32_16x16x32_bf16 v[112:115], a[188:191], a[112:115], v[112:115]
  buffer_load_dwordx4 v241, s[20:23], s31 offen offset:3072 lds
  v_mfma_f32_16x16x32_bf16 v[116:119], a[188:191], a[116:119], v[116:119]
  ds_read_b64_tr_b16 a[170:171], v225 offset:33792
  v_mfma_f32_16x16x32_bf16 v[116:119], a[184:187], a[100:103], v[116:119]
  s_add_u32 s31, s31, 0x80000
  v_mfma_f32_16x16x32_bf16 v[120:123], a[184:187], a[104:107], v[120:123]
  ds_read_b64_tr_b16 a[172:173], v225 offset:40960
  v_mfma_f32_16x16x32_bf16 v[120:123], a[188:191], a[120:123], v[120:123]
  v_mfma_f32_16x16x32_bf16 v[124:127], a[188:191], a[124:127], v[124:127]
  ds_read_b64_tr_b16 a[174:175], v225 offset:41984
  v_mfma_f32_16x16x32_bf16 v[124:127], a[184:187], a[108:111], v[124:127]
  s_waitcnt lgkmcnt(4)
  v_mfma_f32_16x16x32_bf16 v[0:3], a[160:163], a[0:3], v[0:3]
  ds_read_b64_tr_b16 a[176:177], v226 offset:32768
  v_mfma_f32_16x16x32_bf16 v[0:3], a[164:167], a[16:19], v[0:3]
  buffer_load_dwordx4 a[96:99], v242, s[24:27], s30 offen offset:0
  v_mfma_f32_16x16x32_bf16 v[4:7], a[164:167], a[20:23], v[4:7]
  ds_read_b64_tr_b16 a[178:179], v226 offset:33792
  v_mfma_f32_16x16x32_bf16 v[4:7], a[160:163], a[4:7], v[4:7]
  buffer_load_dwordx4 a[100:103], v242, s[24:27], s30 offen offset:1024
  v_mfma_f32_16x16x32_bf16 v[8:11], a[160:163], a[8:11], v[8:11]
  ds_read_b64_tr_b16 a[180:181], v226 offset:40960
  v_mfma_f32_16x16x32_bf16 v[8:11], a[164:167], a[24:27], v[8:11]
  buffer_load_dwordx4 a[104:107], v242, s[24:27], s30 offen offset:2048
  v_mfma_f32_16x16x32_bf16 v[12:15], a[164:167], a[28:31], v[12:15]
  ds_read_b64_tr_b16 a[182:183], v226 offset:41984
  v_mfma_f32_16x16x32_bf16 v[12:15], a[160:163], a[12:15], v[12:15]
  s_waitcnt lgkmcnt(4)
  v_mfma_f32_16x16x32_bf16 v[16:19], a[168:171], a[0:3], v[16:19]
  ds_read_b64_tr_b16 a[184:185], v227 offset:32768
  v_mfma_f32_16x16x32_bf16 v[16:19], a[172:175], a[16:19], v[16:19]
  buffer_load_dwordx4 a[108:111], v242, s[24:27], s30 offen offset:3072
  v_mfma_f32_16x16x32_bf16 v[20:23], a[172:175], a[20:23], v[20:23]
  ds_read_b64_tr_b16 a[186:187], v227 offset:33792
  v_mfma_f32_16x16x32_bf16 v[20:23], a[168:171], a[4:7], v[20:23]
  buffer_load_dwordx4 a[112:115], v243, s[24:27], s30 offen offset:0
  v_mfma_f32_16x16x32_bf16 v[24:27], a[168:171], a[8:11], v[24:27]
  ds_read_b64_tr_b16 a[188:189], v227 offset:40960
  v_mfma_f32_16x16x32_bf16 v[24:27], a[172:175], a[24:27], v[24:27]
  buffer_load_dwordx4 a[116:119], v243, s[24:27], s30 offen offset:1024
  v_mfma_f32_16x16x32_bf16 v[28:31], a[172:175], a[28:31], v[28:31]
  ds_read_b64_tr_b16 a[190:191], v227 offset:41984
  v_mfma_f32_16x16x32_bf16 v[28:31], a[168:171], a[12:15], v[28:31]
  s_waitcnt lgkmcnt(4)
  v_mfma_f32_16x16x32_bf16 v[32:35], a[176:179], a[0:3], v[32:35]
  ds_read_b64_tr_b16 a[160:161], v228 offset:32768
  v_mfma_f32_16x16x32_bf16 v[32:35], a[180:183], a[16:19], v[32:35]
  buffer_load_dwordx4 a[120:123], v243, s[24:27], s30 offen offset:2048
  v_mfma_f32_16x16x32_bf16 v[36:39], a[180:183], a[20:23], v[36:39]
  ds_read_b64_tr_b16 a[162:163], v228 offset:33792
  v_mfma_f32_16x16x32_bf16 v[36:39], a[176:179], a[4:7], v[36:39]
  buffer_load_dwordx4 a[124:127], v243, s[24:27], s30 offen offset:3072
  v_mfma_f32_16x16x32_bf16 v[40:43], a[176:179], a[8:11], v[40:43]
  ds_read_b64_tr_b16 a[164:165], v228 offset:40960
  v_mfma_f32_16x16x32_bf16 v[40:43], a[180:183], a[24:27], v[40:43]
  s_add_u32 s30, s30, 8192
  v_mfma_f32_16x16x32_bf16 v[44:47], a[180:183], a[28:31], v[44:47]
  ds_read_b64_tr_b16 a[166:167], v228 offset:41984
  v_mfma_f32_16x16x32_bf16 v[44:47], a[176:179], a[12:15], v[44:47]
  s_waitcnt lgkmcnt(4)
  v_mfma_f32_16x16x32_bf16 v[48:51], a[184:187], a[0:3], v[48:51]
  ds_read_b64_tr_b16 a[168:169], v229 offset:32768
  v_mfma_f32_16x16x32_bf16 v[48:51], a[188:191], a[16:19], v[48:51]
  v_mfma_f32_16x16x32_bf16 v[52:55], a[188:191], a[20:23], v[52:55]
  ds_read_b64_tr_b16 a[170:171], v229 offset:33792
  v_mfma_f32_16x16x32_bf16 v[52:55], a[184:187], a[4:7], v[52:55]
  v_mfma_f32_16x16x32_bf16 v[56:59], a[184:187], a[8:11], v[56:59]
  ds_read_b64_tr_b16 a[172:173], v229 offset:40960
  v_mfma_f32_16x16x32_bf16 v[56:59], a[188:191], a[24:27], v[56:59]
  v_mfma_f32_16x16x32_bf16 v[60:63], a[188:191], a[28:31], v[60:63]
  ds_read_b64_tr_b16 a[174:175], v229 offset:41984
  v_mfma_f32_16x16x32_bf16 v[60:63], a[184:187], a[12:15], v[60:63]
  s_waitcnt lgkmcnt(4)
  v_mfma_f32_16x16x32_bf16 v[64:67], a[160:163], a[0:3], v[64:67]
  ds_read_b64_tr_b16 a[176:177], v230 offset:32768
  v_mfma_f32_16x16x32_bf16 v[64:67], a[164:167], a[16:19], v[64:67]
  v_mfma_f32_16x16x32_bf16 v[68:71], a[164:167], a[20:23], v[68:71]
  ds_read_b64_tr_b16 a[178:179], v230 offset:33792
  v_mfma_f32_16x16x32_bf16 v[68:71], a[160:163], a[4:7], v[68:71]
  v_mfma_f32_16x16x32_bf16 v[72:75], a[160:163], a[8:11], v[72:75]
  ds_read_b64_tr_b16 a[180:181], v230 offset:40960
  v_mfma_f32_16x16x32_bf16 v[72:75], a[164:167], a[24:27], v[72:75]
  v_mfma_f32_16x16x32_bf16 v[76:79], a[164:167], a[28:31], v[76:79]
  ds_read_b64_tr_b16 a[182:183], v230 offset:41984
  v_mfma_f32_16x16x32_bf16 v[76:79], a[160:163], a[12:15], v[76:79]
  s_waitcnt lgkmcnt(4)
  v_mfma_f32_16x16x32_bf16 v[80:83], a[168:171], a[0:3], v[80:83]
  ds_read_b64_tr_b16 a[184:185], v231 offset:32768
  v_mfma_f32_16x16x32_bf16 v[80:83], a[172:175], a[16:19], v[80:83]
  v_mfma_f32_16x16x32_bf16 v[84:87], a[172:175], a[20:23], v[84:87]
  ds_read_b64_tr_b16 a[186:187], v231 offset:33792
  v_mfma_f32_16x16x32_bf16 v[84:87], a[168:171], a[4:7], v[84:87]
  s_waitcnt vmcnt(20)
  v_mfma_f32_16x16x32_bf16 v[88:91], a[168:171], a[8:11], v[88:91]
  ds_read_b64_tr_b16 a[188:189], v231 offset:40960
  v_mfma_f32_16x16x32_bf16 v[88:91], a[172:175], a[24:27], v[88:91]
  s_barrier
  v_mfma_f32_16x16x32_bf16 v[92:95], a[172:175], a[28:31], v[92:95]
  ds_read_b64_tr_b16 a[190:191], v231 offset:41984
  v_mfma_f32_16x16x32_bf16 v[92:95], a[168:171], a[12:15], v[92:95]
  s_waitcnt lgkmcnt(4)
  v_mfma_f32_16x16x32_bf16 v[96:99], a[176:179], a[0:3], v[96:99]
  s_add_u32 m0, s28, 81920
  v_mfma_f32_16x16x32_bf16 v[96:99], a[180:183], a[16:19], v[96:99]
  ds_read_b64_tr_b16 a[160:161], v224 offset:49152
  v_mfma_f32_16x16x32_bf16 v[100:103], a[180:183], a[20:23], v[100:103]
  buffer_load_dwordx4 v238, s[20:23], s31 offen offset:0 lds
  v_mfma_f32_16x16x32_bf16 v[100:103], a[176:179], a[4:7], v[100:103]
  ds_read_b64_tr_b16 a[162:163], v224 offset:50176
  v_mfma_f32_16x16x32_bf16 v[104:107], a[176:179], a[8:11], v[104:107]
  buffer_load_dwordx4 v239, s[20:23], s31 offen offset:1024 lds
  v_mfma_f32_16x16x32_bf16 v[104:107], a[180:183], a[24:27], v[104:107]
  ds_read_b64_tr_b16 a[164:165], v224 offset:57344
  v_mfma_f32_16x16x32_bf16 v[108:111], a[180:183], a[28:31], v[108:111]
  buffer_load_dwordx4 v240, s[20:23], s31 offen offset:2048 lds
  v_mfma_f32_16x16x32_bf16 v[108:111], a[176:179], a[12:15], v[108:111]
  ds_read_b64_tr_b16 a[166:167], v224 offset:58368
  s_waitcnt lgkmcnt(4)
  v_mfma_f32_16x16x32_bf16 v[112:115], a[184:187], a[0:3], v[112:115]
  ds_read_b64_tr_b16 a[168:169], v225 offset:49152
  v_mfma_f32_16x16x32_bf16 v[112:115], a[188:191], a[16:19], v[112:115]
  buffer_load_dwordx4 v241, s[20:23], s31 offen offset:3072 lds
  v_mfma_f32_16x16x32_bf16 v[116:119], a[188:191], a[20:23], v[116:119]
  ds_read_b64_tr_b16 a[170:171], v225 offset:50176
  v_mfma_f32_16x16x32_bf16 v[116:119], a[184:187], a[4:7], v[116:119]
  s_add_u32 s31, s31, 0x80000
  v_mfma_f32_16x16x32_bf16 v[120:123], a[184:187], a[8:11], v[120:123]
  ds_read_b64_tr_b16 a[172:173], v225 offset:57344
  v_mfma_f32_16x16x32_bf16 v[120:123], a[188:191], a[24:27], v[120:123]
  v_mfma_f32_16x16x32_bf16 v[124:127], a[188:191], a[28:31], v[124:127]
  ds_read_b64_tr_b16 a[174:175], v225 offset:58368
  v_mfma_f32_16x16x32_bf16 v[124:127], a[184:187], a[12:15], v[124:127]
  s_waitcnt lgkmcnt(4)
  v_mfma_f32_16x16x32_bf16 v[0:3], a[160:163], a[32:35], v[0:3]
  ds_read_b64_tr_b16 a[176:177], v226 offset:49152
  v_mfma_f32_16x16x32_bf16 v[0:3], a[164:167], a[48:51], v[0:3]
  buffer_load_dwordx4 a[0:3], v242, s[24:27], s30 offen offset:0
  v_mfma_f32_16x16x32_bf16 v[4:7], a[164:167], a[52:55], v[4:7]
  ds_read_b64_tr_b16 a[178:179], v226 offset:50176
  v_mfma_f32_16x16x32_bf16 v[4:7], a[160:163], a[36:39], v[4:7]
  buffer_load_dwordx4 a[4:7], v242, s[24:27], s30 offen offset:1024
  v_mfma_f32_16x16x32_bf16 v[8:11], a[160:163], a[40:43], v[8:11]
  ds_read_b64_tr_b16 a[180:181], v226 offset:57344
  v_mfma_f32_16x16x32_bf16 v[8:11], a[164:167], a[56:59], v[8:11]
  buffer_load_dwordx4 a[8:11], v242, s[24:27], s30 offen offset:2048
  v_mfma_f32_16x16x32_bf16 v[12:15], a[164:167], a[60:63], v[12:15]
  ds_read_b64_tr_b16 a[182:183], v226 offset:58368
  v_mfma_f32_16x16x32_bf16 v[12:15], a[160:163], a[44:47], v[12:15]
  s_waitcnt lgkmcnt(4)
  v_mfma_f32_16x16x32_bf16 v[16:19], a[168:171], a[32:35], v[16:19]
  ds_read_b64_tr_b16 a[184:185], v227 offset:49152
  v_mfma_f32_16x16x32_bf16 v[16:19], a[172:175], a[48:51], v[16:19]
  buffer_load_dwordx4 a[12:15], v242, s[24:27], s30 offen offset:3072
  v_mfma_f32_16x16x32_bf16 v[20:23], a[172:175], a[52:55], v[20:23]
  ds_read_b64_tr_b16 a[186:187], v227 offset:50176
  v_mfma_f32_16x16x32_bf16 v[20:23], a[168:171], a[36:39], v[20:23]
  buffer_load_dwordx4 a[16:19], v243, s[24:27], s30 offen offset:0
  v_mfma_f32_16x16x32_bf16 v[24:27], a[168:171], a[40:43], v[24:27]
  ds_read_b64_tr_b16 a[188:189], v227 offset:57344
  v_mfma_f32_16x16x32_bf16 v[24:27], a[172:175], a[56:59], v[24:27]
  buffer_load_dwordx4 a[20:23], v243, s[24:27], s30 offen offset:1024
  v_mfma_f32_16x16x32_bf16 v[28:31], a[172:175], a[60:63], v[28:31]
  ds_read_b64_tr_b16 a[190:191], v227 offset:58368
  v_mfma_f32_16x16x32_bf16 v[28:31], a[168:171], a[44:47], v[28:31]
  s_waitcnt lgkmcnt(4)
  v_mfma_f32_16x16x32_bf16 v[32:35], a[176:179], a[32:35], v[32:35]
  ds_read_b64_tr_b16 a[160:161], v228 offset:49152
  v_mfma_f32_16x16x32_bf16 v[32:35], a[180:183], a[48:51], v[32:35]
  buffer_load_dwordx4 a[24:27], v243, s[24:27], s30 offen offset:2048
  v_mfma_f32_16x16x32_bf16 v[36:39], a[180:183], a[52:55], v[36:39]
  ds_read_b64_tr_b16 a[162:163], v228 offset:50176
  v_mfma_f32_16x16x32_bf16 v[36:39], a[176:179], a[36:39], v[36:39]
  buffer_load_dwordx4 a[28:31], v243, s[24:27], s30 offen offset:3072
  v_mfma_f32_16x16x32_bf16 v[40:43], a[176:179], a[40:43], v[40:43]
  ds_read_b64_tr_b16 a[164:165], v228 offset:57344
  v_mfma_f32_16x16x32_bf16 v[40:43], a[180:183], a[56:59], v[40:43]
  s_add_u32 s30, s30, 8192
  v_mfma_f32_16x16x32_bf16 v[44:47], a[180:183], a[60:63], v[44:47]
  ds_read_b64_tr_b16 a[166:167], v228 offset:58368
  v_mfma_f32_16x16x32_bf16 v[44:47], a[176:179], a[44:47], v[44:47]
  s_waitcnt lgkmcnt(4)
  v_mfma_f32_16x16x32_bf16 v[48:51], a[184:187], a[32:35], v[48:51]
  ds_read_b64_tr_b16 a[168:169], v229 offset:49152
  v_mfma_f32_16x16x32_bf16 v[48:51], a[188:191], a[48:51], v[48:51]
  s_add_u32 m0, s28, 0
  v_mfma_f32_16x16x32_bf16 v[52:55], a[188:191], a[52:55], v[52:55]
  ds_read_b64_tr_b16 a[170:171], v229 offset:50176
  v_mfma_f32_16x16x32_bf16 v[52:55], a[184:187], a[36:39], v[52:55]
  buffer_load_dwordx4 v232, s[12:15], s29 offen offset:0 lds
  v_mfma_f32_16x16x32_bf16 v[56:59], a[184:187], a[40:43], v[56:59]
  ds_read_b64_tr_b16 a[172:173], v229 offset:57344
  v_mfma_f32_16x16x32_bf16 v[56:59], a[188:191], a[56:59], v[56:59]
  buffer_load_dwordx4 v233, s[12:15], s29 offen offset:1024 lds
  v_mfma_f32_16x16x32_bf16 v[60:63], a[188:191], a[60:63], v[60:63]
  ds_read_b64_tr_b16 a[174:175], v229 offset:58368
  v_mfma_f32_16x16x32_bf16 v[60:63], a[184:187], a[44:47], v[60:63]
  s_waitcnt lgkmcnt(4)
  v_mfma_f32_16x16x32_bf16 v[64:67], a[160:163], a[32:35], v[64:67]
  ds_read_b64_tr_b16 a[176:177], v230 offset:49152
  v_mfma_f32_16x16x32_bf16 v[64:67], a[164:167], a[48:51], v[64:67]
  buffer_load_dwordx4 v234, s[12:15], s29 offen offset:2048 lds
  v_mfma_f32_16x16x32_bf16 v[68:71], a[164:167], a[52:55], v[68:71]
  ds_read_b64_tr_b16 a[178:179], v230 offset:50176
  v_mfma_f32_16x16x32_bf16 v[68:71], a[160:163], a[36:39], v[68:71]
  buffer_load_dwordx4 v235, s[12:15], s29 offen offset:3072 lds
  v_mfma_f32_16x16x32_bf16 v[72:75], a[160:163], a[40:43], v[72:75]
  ds_read_b64_tr_b16 a[180:181], v230 offset:57344
  v_mfma_f32_16x16x32_bf16 v[72:75], a[164:167], a[56:59], v[72:75]
  s_add_u32 s29, s29, 16384
  v_mfma_f32_16x16x32_bf16 v[76:79], a[164:167], a[60:63], v[76:79]
  ds_read_b64_tr_b16 a[182:183], v230 offset:58368
  v_mfma_f32_16x16x32_bf16 v[76:79], a[160:163], a[44:47], v[76:79]
  s_waitcnt lgkmcnt(4)
  v_mfma_f32_16x16x32_bf16 v[80:83], a[168:171], a[32:35], v[80:83]
  ds_read_b64_tr_b16 a[184:185], v231 offset:49152
  v_mfma_f32_16x16x32_bf16 v[80:83], a[172:175], a[48:51], v[80:83]
  v_mfma_f32_16x16x32_bf16 v[84:87], a[172:175], a[52:55], v[84:87]
  ds_read_b64_tr_b16 a[186:187], v231 offset:50176
  v_mfma_f32_16x16x32_bf16 v[84:87], a[168:171], a[36:39], v[84:87]
  s_waitcnt vmcnt(24)
  v_mfma_f32_16x16x32_bf16 v[88:91], a[168:171], a[40:43], v[88:91]
  ds_read_b64_tr_b16 a[188:189], v231 offset:57344
  v_mfma_f32_16x16x32_bf16 v[88:91], a[172:175], a[56:59], v[88:91]
  s_barrier
  v_mfma_f32_16x16x32_bf16 v[92:95], a[172:175], a[60:63], v[92:95]
  ds_read_b64_tr_b16 a[190:191], v231 offset:58368
  v_mfma_f32_16x16x32_bf16 v[92:95], a[168:171], a[44:47], v[92:95]
  s_waitcnt lgkmcnt(4)
  v_mfma_f32_16x16x32_bf16 v[96:99], a[176:179], a[32:35], v[96:99]
  s_add_u32 m0, s28, 98304
  v_mfma_f32_16x16x32_bf16 v[96:99], a[180:183], a[48:51], v[96:99]
  ds_read_b64_tr_b16 a[160:161], v224 offset:0
  v_mfma_f32_16x16x32_bf16 v[100:103], a[180:183], a[52:55], v[100:103]
  buffer_load_dwordx4 v238, s[20:23], s31 offen offset:0 lds
  v_mfma_f32_16x16x32_bf16 v[100:103], a[176:179], a[36:39], v[100:103]
  ds_read_b64_tr_b16 a[162:163], v224 offset:1024
  v_mfma_f32_16x16x32_bf16 v[104:107], a[176:179], a[40:43], v[104:107]
  buffer_load_dwordx4 v239, s[20:23], s31 offen offset:1024 lds
  v_mfma_f32_16x16x32_bf16 v[104:107], a[180:183], a[56:59], v[104:107]
  ds_read_b64_tr_b16 a[164:165], v224 offset:8192
  v_mfma_f32_16x16x32_bf16 v[108:111], a[180:183], a[60:63], v[108:111]
  buffer_load_dwordx4 v240, s[20:23], s31 offen offset:2048 lds
  v_mfma_f32_16x16x32_bf16 v[108:111], a[176:179], a[44:47], v[108:111]
  ds_read_b64_tr_b16 a[166:167], v224 offset:9216
  s_waitcnt lgkmcnt(4)
  v_mfma_f32_16x16x32_bf16 v[112:115], a[184:187], a[32:35], v[112:115]
  ds_read_b64_tr_b16 a[168:169], v225 offset:0
  v_mfma_f32_16x16x32_bf16 v[112:115], a[188:191], a[48:51], v[112:115]
  buffer_load_dwordx4 v241, s[20:23], s31 offen offset:3072 lds
  v_mfma_f32_16x16x32_bf16 v[116:119], a[188:191], a[52:55], v[116:119]
  ds_read_b64_tr_b16 a[170:171], v225 offset:1024
  v_mfma_f32_16x16x32_bf16 v[116:119], a[184:187], a[36:39], v[116:119]
  s_add_u32 s31, s31, 0x80000
  v_mfma_f32_16x16x32_bf16 v[120:123], a[184:187], a[40:43], v[120:123]
  ds_read_b64_tr_b16 a[172:173], v225 offset:8192
  v_mfma_f32_16x16x32_bf16 v[120:123], a[188:191], a[56:59], v[120:123]
  v_mfma_f32_16x16x32_bf16 v[124:127], a[188:191], a[60:63], v[124:127]
  ds_read_b64_tr_b16 a[174:175], v225 offset:9216
  v_mfma_f32_16x16x32_bf16 v[124:127], a[184:187], a[44:47], v[124:127]
  s_waitcnt lgkmcnt(4)
  v_mfma_f32_16x16x32_bf16 v[0:3], a[160:163], a[64:67], v[0:3]
  ds_read_b64_tr_b16 a[176:177], v226 offset:0
  v_mfma_f32_16x16x32_bf16 v[0:3], a[164:167], a[80:83], v[0:3]
  buffer_load_dwordx4 a[32:35], v242, s[24:27], s30 offen offset:0
  v_mfma_f32_16x16x32_bf16 v[4:7], a[164:167], a[84:87], v[4:7]
  ds_read_b64_tr_b16 a[178:179], v226 offset:1024
  v_mfma_f32_16x16x32_bf16 v[4:7], a[160:163], a[68:71], v[4:7]
  buffer_load_dwordx4 a[36:39], v242, s[24:27], s30 offen offset:1024
  v_mfma_f32_16x16x32_bf16 v[8:11], a[160:163], a[72:75], v[8:11]
  ds_read_b64_tr_b16 a[180:181], v226 offset:8192
  v_mfma_f32_16x16x32_bf16 v[8:11], a[164:167], a[88:91], v[8:11]
  buffer_load_dwordx4 a[40:43], v242, s[24:27], s30 offen offset:2048
  v_mfma_f32_16x16x32_bf16 v[12:15], a[164:167], a[92:95], v[12:15]
  ds_read_b64_tr_b16 a[182:183], v226 offset:9216
  v_mfma_f32_16x16x32_bf16 v[12:15], a[160:163], a[76:79], v[12:15]
  s_waitcnt lgkmcnt(4)
  v_mfma_f32_16x16x32_bf16 v[16:19], a[168:171], a[64:67], v[16:19]
  ds_read_b64_tr_b16 a[184:185], v227 offset:0
  v_mfma_f32_16x16x32_bf16 v[16:19], a[172:175], a[80:83], v[16:19]
  buffer_load_dwordx4 a[44:47], v242, s[24:27], s30 offen offset:3072
  v_mfma_f32_16x16x32_bf16 v[20:23], a[172:175], a[84:87], v[20:23]
  ds_read_b64_tr_b16 a[186:187], v227 offset:1024
  v_mfma_f32_16x16x32_bf16 v[20:23], a[168:171], a[68:71], v[20:23]
  buffer_load_dwordx4 a[48:51], v243, s[24:27], s30 offen offset:0
  v_mfma_f32_16x16x32_bf16 v[24:27], a[168:171], a[72:75], v[24:27]
  ds_read_b64_tr_b16 a[188:189], v227 offset:8192
  v_mfma_f32_16x16x32_bf16 v[24:27], a[172:175], a[88:91], v[24:27]
  buffer_load_dwordx4 a[52:55], v243, s[24:27], s30 offen offset:1024
  v_mfma_f32_16x16x32_bf16 v[28:31], a[172:175], a[92:95], v[28:31]
  ds_read_b64_tr_b16 a[190:191], v227 offset:9216
  v_mfma_f32_16x16x32_bf16 v[28:31], a[168:171], a[76:79], v[28:31]
  s_waitcnt lgkmcnt(4)
  v_mfma_f32_16x16x32_bf16 v[32:35], a[176:179], a[64:67], v[32:35]
  ds_read_b64_tr_b16 a[160:161], v228 offset:0
  v_mfma_f32_16x16x32_bf16 v[32:35], a[180:183], a[80:83], v[32:35]
  buffer_load_dwordx4 a[56:59], v243, s[24:27], s30 offen offset:2048
  v_mfma_f32_16x16x32_bf16 v[36:39], a[180:183], a[84:87], v[36:39]
  ds_read_b64_tr_b16 a[162:163], v228 offset:1024
  v_mfma_f32_16x16x32_bf16 v[36:39], a[176:179], a[68:71], v[36:39]
  buffer_load_dwordx4 a[60:63], v243, s[24:27], s30 offen offset:3072
  v_mfma_f32_16x16x32_bf16 v[40:43], a[176:179], a[72:75], v[40:43]
  ds_read_b64_tr_b16 a[164:165], v228 offset:8192
  v_mfma_f32_16x16x32_bf16 v[40:43], a[180:183], a[88:91], v[40:43]
  s_add_u32 s30, s30, 8192
  v_mfma_f32_16x16x32_bf16 v[44:47], a[180:183], a[92:95], v[44:47]
  ds_read_b64_tr_b16 a[166:167], v228 offset:9216
  v_mfma_f32_16x16x32_bf16 v[44:47], a[176:179], a[76:79], v[44:47]
  s_waitcnt lgkmcnt(4)
  v_mfma_f32_16x16x32_bf16 v[48:51], a[184:187], a[64:67], v[48:51]
  ds_read_b64_tr_b16 a[168:169], v229 offset:0
  v_mfma_f32_16x16x32_bf16 v[48:51], a[188:191], a[80:83], v[48:51]
  s_add_u32 m0, s28, 16384
  v_mfma_f32_16x16x32_bf16 v[52:55], a[188:191], a[84:87], v[52:55]
  ds_read_b64_tr_b16 a[170:171], v229 offset:1024
  v_mfma_f32_16x16x32_bf16 v[52:55], a[184:187], a[68:71], v[52:55]
  buffer_load_dwordx4 v232, s[12:15], s29 offen offset:0 lds
  v_mfma_f32_16x16x32_bf16 v[56:59], a[184:187], a[72:75], v[56:59]
  ds_read_b64_tr_b16 a[172:173], v229 offset:8192
  v_mfma_f32_16x16x32_bf16 v[56:59], a[188:191], a[88:91], v[56:59]
  buffer_load_dwordx4 v233, s[12:15], s29 offen offset:1024 lds
  v_mfma_f32_16x16x32_bf16 v[60:63], a[188:191], a[92:95], v[60:63]
  ds_read_b64_tr_b16 a[174:175], v229 offset:9216
  v_mfma_f32_16x16x32_bf16 v[60:63], a[184:187], a[76:79], v[60:63]
  s_waitcnt lgkmcnt(4)
  v_mfma_f32_16x16x32_bf16 v[64:67], a[160:163], a[64:67], v[64:67]
  ds_read_b64_tr_b16 a[176:177], v230 offset:0
  v_mfma_f32_16x16x32_bf16 v[64:67], a[164:167], a[80:83], v[64:67]
  buffer_load_dwordx4 v234, s[12:15], s29 offen offset:2048 lds
  v_mfma_f32_16x16x32_bf16 v[68:71], a[164:167], a[84:87], v[68:71]
  ds_read_b64_tr_b16 a[178:179], v230 offset:1024
  v_mfma_f32_16x16x32_bf16 v[68:71], a[160:163], a[68:71], v[68:71]
  buffer_load_dwordx4 v235, s[12:15], s29 offen offset:3072 lds
  v_mfma_f32_16x16x32_bf16 v[72:75], a[160:163], a[72:75], v[72:75]
  ds_read_b64_tr_b16 a[180:181], v230 offset:8192
  v_mfma_f32_16x16x32_bf16 v[72:75], a[164:167], a[88:91], v[72:75]
  s_add_u32 s29, s29, 16384
  v_mfma_f32_16x16x32_bf16 v[76:79], a[164:167], a[92:95], v[76:79]
  ds_read_b64_tr_b16 a[182:183], v230 offset:9216
  v_mfma_f32_16x16x32_bf16 v[76:79], a[160:163], a[76:79], v[76:79]
  s_waitcnt lgkmcnt(4)
  v_mfma_f32_16x16x32_bf16 v[80:83], a[168:171], a[64:67], v[80:83]
  ds_read_b64_tr_b16 a[184:185], v231 offset:0
  v_mfma_f32_16x16x32_bf16 v[80:83], a[172:175], a[80:83], v[80:83]
  v_mfma_f32_16x16x32_bf16 v[84:87], a[172:175], a[84:87], v[84:87]
  ds_read_b64_tr_b16 a[186:187], v231 offset:1024
  v_mfma_f32_16x16x32_bf16 v[84:87], a[168:171], a[68:71], v[84:87]
  s_waitcnt vmcnt(28)
  v_mfma_f32_16x16x32_bf16 v[88:91], a[168:171], a[72:75], v[88:91]
  ds_read_b64_tr_b16 a[188:189], v231 offset:8192
  v_mfma_f32_16x16x32_bf16 v[88:91], a[172:175], a[88:91], v[88:91]
  s_barrier
  v_mfma_f32_16x16x32_bf16 v[92:95], a[172:175], a[92:95], v[92:95]
  ds_read_b64_tr_b16 a[190:191], v231 offset:9216
  v_mfma_f32_16x16x32_bf16 v[92:95], a[168:171], a[76:79], v[92:95]
  s_waitcnt lgkmcnt(4)
  v_mfma_f32_16x16x32_bf16 v[96:99], a[176:179], a[64:67], v[96:99]
  s_add_u32 m0, s28, 114688
  v_mfma_f32_16x16x32_bf16 v[96:99], a[180:183], a[80:83], v[96:99]
  ds_read_b64_tr_b16 a[160:161], v224 offset:16384
  v_mfma_f32_16x16x32_bf16 v[100:103], a[180:183], a[84:87], v[100:103]
  buffer_load_dwordx4 v238, s[20:23], s31 offen offset:0 lds
  v_mfma_f32_16x16x32_bf16 v[100:103], a[176:179], a[68:71], v[100:103]
  ds_read_b64_tr_b16 a[162:163], v224 offset:17408
  v_mfma_f32_16x16x32_bf16 v[104:107], a[176:179], a[72:75], v[104:107]
  buffer_load_dwordx4 v239, s[20:23], s31 offen offset:1024 lds
  v_mfma_f32_16x16x32_bf16 v[104:107], a[180:183], a[88:91], v[104:107]
  ds_read_b64_tr_b16 a[164:165], v224 offset:24576
  v_mfma_f32_16x16x32_bf16 v[108:111], a[180:183], a[92:95], v[108:111]
  buffer_load_dwordx4 v240, s[20:23], s31 offen offset:2048 lds
  v_mfma_f32_16x16x32_bf16 v[108:111], a[176:179], a[76:79], v[108:111]
  ds_read_b64_tr_b16 a[166:167], v224 offset:25600
  s_waitcnt lgkmcnt(4)
  v_mfma_f32_16x16x32_bf16 v[112:115], a[184:187], a[64:67], v[112:115]
  ds_read_b64_tr_b16 a[168:169], v225 offset:16384
  v_mfma_f32_16x16x32_bf16 v[112:115], a[188:191], a[80:83], v[112:115]
  buffer_load_dwordx4 v241, s[20:23], s31 offen offset:3072 lds
  v_mfma_f32_16x16x32_bf16 v[116:119], a[188:191], a[84:87], v[116:119]
  ds_read_b64_tr_b16 a[170:171], v225 offset:17408
  v_mfma_f32_16x16x32_bf16 v[116:119], a[184:187], a[68:71], v[116:119]
  s_add_u32 s31, s31, 0x80000
  v_mfma_f32_16x16x32_bf16 v[120:123], a[184:187], a[72:75], v[120:123]
  ds_read_b64_tr_b16 a[172:173], v225 offset:24576
  v_mfma_f32_16x16x32_bf16 v[120:123], a[188:191], a[88:91], v[120:123]
  v_mfma_f32_16x16x32_bf16 v[124:127], a[188:191], a[92:95], v[124:127]
  ds_read_b64_tr_b16 a[174:175], v225 offset:25600
  v_mfma_f32_16x16x32_bf16 v[124:127], a[184:187], a[76:79], v[124:127]
  s_waitcnt lgkmcnt(4)
  v_mfma_f32_16x16x32_bf16 v[0:3], a[160:163], a[96:99], v[0:3]
  ds_read_b64_tr_b16 a[176:177], v226 offset:16384
  v_mfma_f32_16x16x32_bf16 v[0:3], a[164:167], a[112:115], v[0:3]
  v_mfma_f32_16x16x32_bf16 v[4:7], a[164:167], a[116:119], v[4:7]
  ds_read_b64_tr_b16 a[178:179], v226 offset:17408
  v_mfma_f32_16x16x32_bf16 v[4:7], a[160:163], a[100:103], v[4:7]
  v_mfma_f32_16x16x32_bf16 v[8:11], a[160:163], a[104:107], v[8:11]
  ds_read_b64_tr_b16 a[180:181], v226 offset:24576
  v_mfma_f32_16x16x32_bf16 v[8:11], a[164:167], a[120:123], v[8:11]
  v_mfma_f32_16x16x32_bf16 v[12:15], a[164:167], a[124:127], v[12:15]
  ds_read_b64_tr_b16 a[182:183], v226 offset:25600
  v_mfma_f32_16x16x32_bf16 v[12:15], a[160:163], a[108:111], v[12:15]
  s_waitcnt lgkmcnt(4)
  v_mfma_f32_16x16x32_bf16 v[16:19], a[168:171], a[96:99], v[16:19]
  ds_read_b64_tr_b16 a[184:185], v227 offset:16384
  v_mfma_f32_16x16x32_bf16 v[16:19], a[172:175], a[112:115], v[16:19]
  v_mfma_f32_16x16x32_bf16 v[20:23], a[172:175], a[116:119], v[20:23]
  ds_read_b64_tr_b16 a[186:187], v227 offset:17408
  v_mfma_f32_16x16x32_bf16 v[20:23], a[168:171], a[100:103], v[20:23]
  v_mfma_f32_16x16x32_bf16 v[24:27], a[168:171], a[104:107], v[24:27]
  ds_read_b64_tr_b16 a[188:189], v227 offset:24576
  v_mfma_f32_16x16x32_bf16 v[24:27], a[172:175], a[120:123], v[24:27]
  v_mfma_f32_16x16x32_bf16 v[28:31], a[172:175], a[124:127], v[28:31]
  ds_read_b64_tr_b16 a[190:191], v227 offset:25600
  v_mfma_f32_16x16x32_bf16 v[28:31], a[168:171], a[108:111], v[28:31]
  s_waitcnt lgkmcnt(4)
  v_mfma_f32_16x16x32_bf16 v[32:35], a[176:179], a[96:99], v[32:35]
  ds_read_b64_tr_b16 a[160:161], v228 offset:16384
  v_mfma_f32_16x16x32_bf16 v[32:35], a[180:183], a[112:115], v[32:35]
  v_mfma_f32_16x16x32_bf16 v[36:39], a[180:183], a[116:119], v[36:39]
  ds_read_b64_tr_b16 a[162:163], v228 offset:17408
  v_mfma_f32_16x16x32_bf16 v[36:39], a[176:179], a[100:103], v[36:39]
  v_mfma_f32_16x16x32_bf16 v[40:43], a[176:179], a[104:107], v[40:43]
  ds_read_b64_tr_b16 a[164:165], v228 offset:24576
  v_mfma_f32_16x16x32_bf16 v[40:43], a[180:183], a[120:123], v[40:43]
  v_mfma_f32_16x16x32_bf16 v[44:47], a[180:183], a[124:127], v[44:47]
  ds_read_b64_tr_b16 a[166:167], v228 offset:25600
  v_mfma_f32_16x16x32_bf16 v[44:47], a[176:179], a[108:111], v[44:47]
  s_waitcnt lgkmcnt(4)
  v_mfma_f32_16x16x32_bf16 v[48:51], a[184:187], a[96:99], v[48:51]
  ds_read_b64_tr_b16 a[168:169], v229 offset:16384
  v_mfma_f32_16x16x32_bf16 v[48:51], a[188:191], a[112:115], v[48:51]
  s_add_u32 m0, s28, 32768
  v_mfma_f32_16x16x32_bf16 v[52:55], a[188:191], a[116:119], v[52:55]
  ds_read_b64_tr_b16 a[170:171], v229 offset:17408
  v_mfma_f32_16x16x32_bf16 v[52:55], a[184:187], a[100:103], v[52:55]
  buffer_load_dwordx4 v232, s[12:15], s29 offen offset:0 lds
  v_mfma_f32_16x16x32_bf16 v[56:59], a[184:187], a[104:107], v[56:59]
  ds_read_b64_tr_b16 a[172:173], v229 offset:24576
  v_mfma_f32_16x16x32_bf16 v[56:59], a[188:191], a[120:123], v[56:59]
  buffer_load_dwordx4 v233, s[12:15], s29 offen offset:1024 lds
  v_mfma_f32_16x16x32_bf16 v[60:63], a[188:191], a[124:127], v[60:63]
  ds_read_b64_tr_b16 a[174:175], v229 offset:25600
  v_mfma_f32_16x16x32_bf16 v[60:63], a[184:187], a[108:111], v[60:63]
  s_waitcnt lgkmcnt(4)
  v_mfma_f32_16x16x32_bf16 v[64:67], a[160:163], a[96:99], v[64:67]
  ds_read_b64_tr_b16 a[176:177], v230 offset:16384
  v_mfma_f32_16x16x32_bf16 v[64:67], a[164:167], a[112:115], v[64:67]
  buffer_load_dwordx4 v234, s[12:15], s29 offen offset:2048 lds
  v_mfma_f32_16x16x32_bf16 v[68:71], a[164:167], a[116:119], v[68:71]
  ds_read_b64_tr_b16 a[178:179], v230 offset:17408
  v_mfma_f32_16x16x32_bf16 v[68:71], a[160:163], a[100:103], v[68:71]
  buffer_load_dwordx4 v235, s[12:15], s29 offen offset:3072 lds
  v_mfma_f32_16x16x32_bf16 v[72:75], a[160:163], a[104:107], v[72:75]
  ds_read_b64_tr_b16 a[180:181], v230 offset:24576
  v_mfma_f32_16x16x32_bf16 v[72:75], a[164:167], a[120:123], v[72:75]
  s_add_u32 s29, s29, 16384
  v_mfma_f32_16x16x32_bf16 v[76:79], a[164:167], a[124:127], v[76:79]
  ds_read_b64_tr_b16 a[182:183], v230 offset:25600
  v_mfma_f32_16x16x32_bf16 v[76:79], a[160:163], a[108:111], v[76:79]
  s_waitcnt lgkmcnt(4)
  v_mfma_f32_16x16x32_bf16 v[80:83], a[168:171], a[96:99], v[80:83]
  ds_read_b64_tr_b16 a[184:185], v231 offset:16384
  v_mfma_f32_16x16x32_bf16 v[80:83], a[172:175], a[112:115], v[80:83]
  s_mov_b32 s29, 0
  v_mfma_f32_16x16x32_bf16 v[84:87], a[172:175], a[116:119], v[84:87]
  ds_read_b64_tr_b16 a[186:187], v231 offset:17408
  v_mfma_f32_16x16x32_bf16 v[84:87], a[168:171], a[100:103], v[84:87]
  s_waitcnt vmcnt(20)
  v_mfma_f32_16x16x32_bf16 v[88:91], a[168:171], a[104:107], v[88:91]
  ds_read_b64_tr_b16 a[188:189], v231 offset:24576
  v_mfma_f32_16x16x32_bf16 v[88:91], a[172:175], a[120:123], v[88:91]
  s_barrier
  v_mfma_f32_16x16x32_bf16 v[92:95], a[172:175], a[124:127], v[92:95]
  ds_read_b64_tr_b16 a[190:191], v231 offset:25600
  v_mfma_f32_16x16x32_bf16 v[92:95], a[168:171], a[108:111], v[92:95]
  s_waitcnt lgkmcnt(4)
  v_mfma_f32_16x16x32_bf16 v[96:99], a[176:179], a[96:99], v[96:99]
  s_add_u32 m0, s28, 65536
  v_mfma_f32_16x16x32_bf16 v[96:99], a[180:183], a[112:115], v[96:99]
  ds_read_b64_tr_b16 a[160:161], v224 offset:32768
  v_mfma_f32_16x16x32_bf16 v[100:103], a[180:183], a[116:119], v[100:103]
  buffer_load_dwordx4 v236, s[16:19], s29 offen offset:0 lds
  v_mfma_f32_16x16x32_bf16 v[100:103], a[176:179], a[100:103], v[100:103]
  ds_read_b64_tr_b16 a[162:163], v224 offset:33792
  v_mfma_f32_16x16x32_bf16 v[104:107], a[176:179], a[104:107], v[104:107]
  buffer_load_dwordx4 v237, s[16:19], s29 offen offset:1024 lds
  v_mfma_f32_16x16x32_bf16 v[104:107], a[180:183], a[120:123], v[104:107]
  ds_read_b64_tr_b16 a[164:165], v224 offset:40960
  v_mfma_f32_16x16x32_bf16 v[108:111], a[180:183], a[124:127], v[108:111]
  buffer_load_dwordx4 v236, s[16:19], s29 offen offset:2048 lds
  v_mfma_f32_16x16x32_bf16 v[108:111], a[176:179], a[108:111], v[108:111]
  ds_read_b64_tr_b16 a[166:167], v224 offset:41984
  s_waitcnt lgkmcnt(4)
  v_mfma_f32_16x16x32_bf16 v[112:115], a[184:187], a[96:99], v[112:115]
  ds_read_b64_tr_b16 a[168:169], v225 offset:32768
  v_mfma_f32_16x16x32_bf16 v[112:115], a[188:191], a[112:115], v[112:115]
  buffer_load_dwordx4 v237, s[16:19], s29 offen offset:3072 lds
  v_mfma_f32_16x16x32_bf16 v[116:119], a[188:191], a[116:119], v[116:119]
  ds_read_b64_tr_b16 a[170:171], v225 offset:33792
  v_mfma_f32_16x16x32_bf16 v[116:119], a[184:187], a[100:103], v[116:119]
  s_add_u32 s29, s29, 16384
  v_mfma_f32_16x16x32_bf16 v[120:123], a[184:187], a[104:107], v[120:123]
  ds_read_b64_tr_b16 a[172:173], v225 offset:40960
  v_mfma_f32_16x16x32_bf16 v[120:123], a[188:191], a[120:123], v[120:123]
  v_mfma_f32_16x16x32_bf16 v[124:127], a[188:191], a[124:127], v[124:127]
  ds_read_b64_tr_b16 a[174:175], v225 offset:41984
  v_mfma_f32_16x16x32_bf16 v[124:127], a[184:187], a[108:111], v[124:127]
  s_waitcnt lgkmcnt(4)
  v_mfma_f32_16x16x32_bf16 v[0:3], a[160:163], a[0:3], v[0:3]
  ds_read_b64_tr_b16 a[176:177], v226 offset:32768
  v_mfma_f32_16x16x32_bf16 v[0:3], a[164:167], a[16:19], v[0:3]
  v_mfma_f32_16x16x32_bf16 v[4:7], a[164:167], a[20:23], v[4:7]
  ds_read_b64_tr_b16 a[178:179], v226 offset:33792
  v_mfma_f32_16x16x32_bf16 v[4:7], a[160:163], a[4:7], v[4:7]
  v_mfma_f32_16x16x32_bf16 v[8:11], a[160:163], a[8:11], v[8:11]
  ds_read_b64_tr_b16 a[180:181], v226 offset:40960
  v_mfma_f32_16x16x32_bf16 v[8:11], a[164:167], a[24:27], v[8:11]
  v_mfma_f32_16x16x32_bf16 v[12:15], a[164:167], a[28:31], v[12:15]
  ds_read_b64_tr_b16 a[182:183], v226 offset:41984
  v_mfma_f32_16x16x32_bf16 v[12:15], a[160:163], a[12:15], v[12:15]
  s_waitcnt lgkmcnt(4)
  v_mfma_f32_16x16x32_bf16 v[16:19], a[168:171], a[0:3], v[16:19]
  ds_read_b64_tr_b16 a[184:185], v227 offset:32768
  v_mfma_f32_16x16x32_bf16 v[16:19], a[172:175], a[16:19], v[16:19]
  v_mfma_f32_16x16x32_bf16 v[20:23], a[172:175], a[20:23], v[20:23]
  ds_read_b64_tr_b16 a[186:187], v227 offset:33792
  v_mfma_f32_16x16x32_bf16 v[20:23], a[168:171], a[4:7], v[20:23]
  v_mfma_f32_16x16x32_bf16 v[24:27], a[168:171], a[8:11], v[24:27]
  ds_read_b64_tr_b16 a[188:189], v227 offset:40960
  v_mfma_f32_16x16x32_bf16 v[24:27], a[172:175], a[24:27], v[24:27]
  v_mfma_f32_16x16x32_bf16 v[28:31], a[172:175], a[28:31], v[28:31]
  ds_read_b64_tr_b16 a[190:191], v227 offset:41984
  v_mfma_f32_16x16x32_bf16 v[28:31], a[168:171], a[12:15], v[28:31]
  s_waitcnt lgkmcnt(4)
  v_mfma_f32_16x16x32_bf16 v[32:35], a[176:179], a[0:3], v[32:35]
  ds_read_b64_tr_b16 a[160:161], v228 offset:32768
  v_mfma_f32_16x16x32_bf16 v[32:35], a[180:183], a[16:19], v[32:35]
  v_mfma_f32_16x16x32_bf16 v[36:39], a[180:183], a[20:23], v[36:39]
  ds_read_b64_tr_b16 a[162:163], v228 offset:33792
  v_mfma_f32_16x16x32_bf16 v[36:39], a[176:179], a[4:7], v[36:39]
  v_mfma_f32_16x16x32_bf16 v[40:43], a[176:179], a[8:11], v[40:43]
  ds_read_b64_tr_b16 a[164:165], v228 offset:40960
  v_mfma_f32_16x16x32_bf16 v[40:43], a[180:183], a[24:27], v[40:43]
  v_mfma_f32_16x16x32_bf16 v[44:47], a[180:183], a[28:31], v[44:47]
  ds_read_b64_tr_b16 a[166:167], v228 offset:41984
  v_mfma_f32_16x16x32_bf16 v[44:47], a[176:179], a[12:15], v[44:47]
  s_waitcnt lgkmcnt(4)
  v_mfma_f32_16x16x32_bf16 v[48:51], a[184:187], a[0:3], v[48:51]
  ds_read_b64_tr_b16 a[168:169], v229 offset:32768
  v_mfma_f32_16x16x32_bf16 v[48:51], a[188:191], a[16:19], v[48:51]
  v_mfma_f32_16x16x32_bf16 v[52:55], a[188:191], a[20:23], v[52:55]
  ds_read_b64_tr_b16 a[170:171], v229 offset:33792
  v_mfma_f32_16x16x32_bf16 v[52:55], a[184:187], a[4:7], v[52:55]
  v_mfma_f32_16x16x32_bf16 v[56:59], a[184:187], a[8:11], v[56:59]
  ds_read_b64_tr_b16 a[172:173], v229 offset:40960
  v_mfma_f32_16x16x32_bf16 v[56:59], a[188:191], a[24:27], v[56:59]
  v_mfma_f32_16x16x32_bf16 v[60:63], a[188:191], a[28:31], v[60:63]
  ds_read_b64_tr_b16 a[174:175], v229 offset:41984
  v_mfma_f32_16x16x32_bf16 v[60:63], a[184:187], a[12:15], v[60:63]
  s_waitcnt lgkmcnt(4)
  v_mfma_f32_16x16x32_bf16 v[64:67], a[160:163], a[0:3], v[64:67]
  ds_read_b64_tr_b16 a[176:177], v230 offset:32768
  v_mfma_f32_16x16x32_bf16 v[64:67], a[164:167], a[16:19], v[64:67]
  v_mfma_f32_16x16x32_bf16 v[68:71], a[164:167], a[20:23], v[68:71]
  ds_read_b64_tr_b16 a[178:179], v230 offset:33792
  v_mfma_f32_16x16x32_bf16 v[68:71], a[160:163], a[4:7], v[68:71]
  v_mfma_f32_16x16x32_bf16 v[72:75], a[160:163], a[8:11], v[72:75]
  ds_read_b64_tr_b16 a[180:181], v230 offset:40960
  v_mfma_f32_16x16x32_bf16 v[72:75], a[164:167], a[24:27], v[72:75]
  v_mfma_f32_16x16x32_bf16 v[76:79], a[164:167], a[28:31], v[76:79]
  ds_read_b64_tr_b16 a[182:183], v230 offset:41984
  v_mfma_f32_16x16x32_bf16 v[76:79], a[160:163], a[12:15], v[76:79]
  s_waitcnt lgkmcnt(4)
  v_mfma_f32_16x16x32_bf16 v[80:83], a[168:171], a[0:3], v[80:83]
  ds_read_b64_tr_b16 a[184:185], v231 offset:32768
  v_mfma_f32_16x16x32_bf16 v[80:83], a[172:175], a[16:19], v[80:83]
  v_mfma_f32_16x16x32_bf16 v[84:87], a[172:175], a[20:23], v[84:87]
  ds_read_b64_tr_b16 a[186:187], v231 offset:33792
  v_mfma_f32_16x16x32_bf16 v[84:87], a[168:171], a[4:7], v[84:87]
  s_waitcnt vmcnt(8)
  v_mfma_f32_16x16x32_bf16 v[88:91], a[168:171], a[8:11], v[88:91]
  ds_read_b64_tr_b16 a[188:189], v231 offset:40960
  v_mfma_f32_16x16x32_bf16 v[88:91], a[172:175], a[24:27], v[88:91]
  s_barrier
  v_mfma_f32_16x16x32_bf16 v[92:95], a[172:175], a[28:31], v[92:95]
  ds_read_b64_tr_b16 a[190:191], v231 offset:41984
  v_mfma_f32_16x16x32_bf16 v[92:95], a[168:171], a[12:15], v[92:95]
  s_waitcnt lgkmcnt(4)
  v_mfma_f32_16x16x32_bf16 v[96:99], a[176:179], a[0:3], v[96:99]
  s_add_u32 m0, s28, 81920
  v_mfma_f32_16x16x32_bf16 v[96:99], a[180:183], a[16:19], v[96:99]
  ds_read_b64_tr_b16 a[160:161], v224 offset:49152
  v_mfma_f32_16x16x32_bf16 v[100:103], a[180:183], a[20:23], v[100:103]
  buffer_load_dwordx4 v236, s[16:19], s29 offen offset:0 lds
  v_mfma_f32_16x16x32_bf16 v[100:103], a[176:179], a[4:7], v[100:103]
  ds_read_b64_tr_b16 a[162:163], v224 offset:50176
  v_mfma_f32_16x16x32_bf16 v[104:107], a[176:179], a[8:11], v[104:107]
  buffer_load_dwordx4 v237, s[16:19], s29 offen offset:1024 lds
  v_mfma_f32_16x16x32_bf16 v[104:107], a[180:183], a[24:27], v[104:107]
  ds_read_b64_tr_b16 a[164:165], v224 offset:57344
  v_mfma_f32_16x16x32_bf16 v[108:111], a[180:183], a[28:31], v[108:111]
  buffer_load_dwordx4 v236, s[16:19], s29 offen offset:2048 lds
  v_mfma_f32_16x16x32_bf16 v[108:111], a[176:179], a[12:15], v[108:111]
  ds_read_b64_tr_b16 a[166:167], v224 offset:58368
  s_waitcnt lgkmcnt(4)
  v_mfma_f32_16x16x32_bf16 v[112:115], a[184:187], a[0:3], v[112:115]
  ds_read_b64_tr_b16 a[168:169], v225 offset:49152
  v_mfma_f32_16x16x32_bf16 v[112:115], a[188:191], a[16:19], v[112:115]
  buffer_load_dwordx4 v237, s[16:19], s29 offen offset:3072 lds
  v_mfma_f32_16x16x32_bf16 v[116:119], a[188:191], a[20:23], v[116:119]
  ds_read_b64_tr_b16 a[170:171], v225 offset:50176
  v_mfma_f32_16x16x32_bf16 v[116:119], a[184:187], a[4:7], v[116:119]
  s_add_u32 s29, s29, 16384
  v_mfma_f32_16x16x32_bf16 v[120:123], a[184:187], a[8:11], v[120:123]
  ds_read_b64_tr_b16 a[172:173], v225 offset:57344
  v_mfma_f32_16x16x32_bf16 v[120:123], a[188:191], a[24:27], v[120:123]
  v_mfma_f32_16x16x32_bf16 v[124:127], a[188:191], a[28:31], v[124:127]
  ds_read_b64_tr_b16 a[174:175], v225 offset:58368
  v_mfma_f32_16x16x32_bf16 v[124:127], a[184:187], a[12:15], v[124:127]
  s_waitcnt lgkmcnt(4)
  v_mfma_f32_16x16x32_bf16 v[0:3], a[160:163], a[32:35], v[0:3]
  ds_read_b64_tr_b16 a[176:177], v226 offset:49152
  v_mfma_f32_16x16x32_bf16 v[0:3], a[164:167], a[48:51], v[0:3]
  v_mfma_f32_16x16x32_bf16 v[4:7], a[164:167], a[52:55], v[4:7]
  ds_read_b64_tr_b16 a[178:179], v226 offset:50176
  v_mfma_f32_16x16x32_bf16 v[4:7], a[160:163], a[36:39], v[4:7]
  v_mfma_f32_16x16x32_bf16 v[8:11], a[160:163], a[40:43], v[8:11]
  ds_read_b64_tr_b16 a[180:181], v226 offset:57344
  v_mfma_f32_16x16x32_bf16 v[8:11], a[164:167], a[56:59], v[8:11]
  v_mfma_f32_16x16x32_bf16 v[12:15], a[164:167], a[60:63], v[12:15]
  ds_read_b64_tr_b16 a[182:183], v226 offset:58368
  v_mfma_f32_16x16x32_bf16 v[12:15], a[160:163], a[44:47], v[12:15]
  s_waitcnt lgkmcnt(4)
  v_mfma_f32_16x16x32_bf16 v[16:19], a[168:171], a[32:35], v[16:19]
  ds_read_b64_tr_b16 a[184:185], v227 offset:49152
  v_mfma_f32_16x16x32_bf16 v[16:19], a[172:175], a[48:51], v[16:19]
  v_mfma_f32_16x16x32_bf16 v[20:23], a[172:175], a[52:55], v[20:23]
  ds_read_b64_tr_b16 a[186:187], v227 offset:50176
  v_mfma_f32_16x16x32_bf16 v[20:23], a[168:171], a[36:39], v[20:23]
  v_mfma_f32_16x16x32_bf16 v[24:27], a[168:171], a[40:43], v[24:27]
  ds_read_b64_tr_b16 a[188:189], v227 offset:57344
  v_mfma_f32_16x16x32_bf16 v[24:27], a[172:175], a[56:59], v[24:27]
  v_mul_f32 v0, s34, v0
  v_mul_f32 v1, s34, v1
  v_mfma_f32_16x16x32_bf16 v[28:31], a[172:175], a[60:63], v[28:31]
  ds_read_b64_tr_b16 a[190:191], v227 offset:58368
  v_mul_f32 v2, s34, v2
  v_mul_f32 v3, s34, v3
  v_mfma_f32_16x16x32_bf16 v[28:31], a[168:171], a[44:47], v[28:31]
  s_waitcnt lgkmcnt(4)
  v_mul_f32 v16, s34, v16
  v_mul_f32 v17, s34, v17
  v_mfma_f32_16x16x32_bf16 v[32:35], a[176:179], a[32:35], v[32:35]
  ds_read_b64_tr_b16 a[160:161], v228 offset:49152
  v_mul_f32 v18, s34, v18
  v_mul_f32 v19, s34, v19
  v_mfma_f32_16x16x32_bf16 v[32:35], a[180:183], a[48:51], v[32:35]
  v_cvt_pk_bf16_f32 v128, v0, v1
  v_cvt_pk_bf16_f32 v129, v2, v3
  v_mfma_f32_16x16x32_bf16 v[36:39], a[180:183], a[52:55], v[36:39]
  ds_read_b64_tr_b16 a[162:163], v228 offset:50176
  v_cvt_pk_bf16_f32 v130, v16, v17
  v_cvt_pk_bf16_f32 v131, v18, v19
  v_mfma_f32_16x16x32_bf16 v[36:39], a[176:179], a[36:39], v[36:39]
  v_mul_f32 v4, s34, v4
  v_mul_f32 v5, s34, v5
  v_mfma_f32_16x16x32_bf16 v[40:43], a[176:179], a[40:43], v[40:43]
  ds_read_b64_tr_b16 a[164:165], v228 offset:57344
  v_mul_f32 v6, s34, v6
  v_mul_f32 v7, s34, v7
  v_mfma_f32_16x16x32_bf16 v[40:43], a[180:183], a[56:59], v[40:43]
  v_mul_f32 v20, s34, v20
  v_mul_f32 v21, s34, v21
  v_mfma_f32_16x16x32_bf16 v[44:47], a[180:183], a[60:63], v[44:47]
  ds_read_b64_tr_b16 a[166:167], v228 offset:58368
  v_mul_f32 v22, s34, v22
  v_mul_f32 v23, s34, v23
  v_mfma_f32_16x16x32_bf16 v[44:47], a[176:179], a[44:47], v[44:47]
  s_waitcnt lgkmcnt(4)
  v_cvt_pk_bf16_f32 v144, v4, v5
  v_cvt_pk_bf16_f32 v145, v6, v7
  v_mfma_f32_16x16x32_bf16 v[48:51], a[184:187], a[32:35], v[48:51]
  ds_read_b64_tr_b16 a[168:169], v229 offset:49152
  v_cvt_pk_bf16_f32 v146, v20, v21
  v_cvt_pk_bf16_f32 v147, v22, v23
  v_mfma_f32_16x16x32_bf16 v[48:51], a[188:191], a[48:51], v[48:51]
  v_permlane16_swap_b32 v128, v130
  v_permlane16_swap_b32 v129, v131
  v_mfma_f32_16x16x32_bf16 v[52:55], a[188:191], a[52:55], v[52:55]
  ds_read_b64_tr_b16 a[170:171], v229 offset:50176
  v_mul_f32 v8, s34, v8
  v_mul_f32 v9, s34, v9
  v_mfma_f32_16x16x32_bf16 v[52:55], a[184:187], a[36:39], v[52:55]
  v_mul_f32 v10, s34, v10
  v_mul_f32 v11, s34, v11
  v_mfma_f32_16x16x32_bf16 v[56:59], a[184:187], a[40:43], v[56:59]
  ds_read_b64_tr_b16 a[172:173], v229 offset:57344
  v_mul_f32 v24, s34, v24
  v_mul_f32 v25, s34, v25
  v_mfma_f32_16x16x32_bf16 v[56:59], a[188:191], a[56:59], v[56:59]
  v_mul_f32 v26, s34, v26
  v_mul_f32 v27, s34, v27
  v_mfma_f32_16x16x32_bf16 v[60:63], a[188:191], a[60:63], v[60:63]
  ds_read_b64_tr_b16 a[174:175], v229 offset:58368
  v_cvt_pk_bf16_f32 v160, v8, v9
  v_cvt_pk_bf16_f32 v161, v10, v11
  v_mfma_f32_16x16x32_bf16 v[60:63], a[184:187], a[44:47], v[60:63]
  s_waitcnt lgkmcnt(4)
  v_cvt_pk_bf16_f32 v162, v24, v25
  v_cvt_pk_bf16_f32 v163, v26, v27
  v_mfma_f32_16x16x32_bf16 v[64:67], a[160:163], a[32:35], v[64:67]
  ds_read_b64_tr_b16 a[176:177], v230 offset:49152
  v_permlane16_swap_b32 v144, v146
  v_permlane16_swap_b32 v145, v147
  v_mfma_f32_16x16x32_bf16 v[64:67], a[164:167], a[48:51], v[64:67]
  v_mul_f32 v12, s34, v12
  v_mul_f32 v13, s34, v13
  v_mfma_f32_16x16x32_bf16 v[68:71], a[164:167], a[52:55], v[68:71]
  ds_read_b64_tr_b16 a[178:179], v230 offset:50176
  v_mul_f32 v14, s34, v14
  v_mul_f32 v15, s34, v15
  v_mfma_f32_16x16x32_bf16 v[68:71], a[160:163], a[36:39], v[68:71]
  v_mul_f32 v28, s34, v28
  v_mul_f32 v29, s34, v29
  v_mfma_f32_16x16x32_bf16 v[72:75], a[160:163], a[40:43], v[72:75]
  ds_read_b64_tr_b16 a[180:181], v230 offset:57344
  v_mul_f32 v30, s34, v30
  v_mul_f32 v31, s34, v31
  v_mfma_f32_16x16x32_bf16 v[72:75], a[164:167], a[56:59], v[72:75]
  v_cvt_pk_bf16_f32 v176, v12, v13
  v_cvt_pk_bf16_f32 v177, v14, v15
  v_mfma_f32_16x16x32_bf16 v[76:79], a[164:167], a[60:63], v[76:79]
  ds_read_b64_tr_b16 a[182:183], v230 offset:58368
  v_cvt_pk_bf16_f32 v178, v28, v29
  v_cvt_pk_bf16_f32 v179, v30, v31
  v_mfma_f32_16x16x32_bf16 v[76:79], a[160:163], a[44:47], v[76:79]
  s_waitcnt lgkmcnt(4)
  v_permlane16_swap_b32 v160, v162
  v_permlane16_swap_b32 v161, v163
  v_mfma_f32_16x16x32_bf16 v[80:83], a[168:171], a[32:35], v[80:83]
  ds_read_b64_tr_b16 a[184:185], v231 offset:49152
  v_mul_f32 v32, s34, v32
  v_mul_f32 v33, s34, v33
  v_mfma_f32_16x16x32_bf16 v[80:83], a[172:175], a[48:51], v[80:83]
  v_mul_f32 v34, s34, v34
  v_mul_f32 v35, s34, v35
  v_mfma_f32_16x16x32_bf16 v[84:87], a[172:175], a[52:55], v[84:87]
  ds_read_b64_tr_b16 a[186:187], v231 offset:50176
  v_mul_f32 v48, s34, v48
  v_mul_f32 v49, s34, v49
  v_mfma_f32_16x16x32_bf16 v[84:87], a[168:171], a[36:39], v[84:87]
  v_mul_f32 v50, s34, v50
  v_mul_f32 v51, s34, v51
  v_mfma_f32_16x16x32_bf16 v[88:91], a[168:171], a[40:43], v[88:91]
  ds_read_b64_tr_b16 a[188:189], v231 offset:57344
  v_cvt_pk_bf16_f32 v132, v32, v33
  v_cvt_pk_bf16_f32 v133, v34, v35
  v_mfma_f32_16x16x32_bf16 v[88:91], a[172:175], a[56:59], v[88:91]
  s_barrier
  v_cvt_pk_bf16_f32 v134, v48, v49
  v_cvt_pk_bf16_f32 v135, v50, v51
  v_mfma_f32_16x16x32_bf16 v[92:95], a[172:175], a[60:63], v[92:95]
  ds_read_b64_tr_b16 a[190:191], v231 offset:58368
  v_permlane16_swap_b32 v176, v178
  v_permlane16_swap_b32 v177, v179
  v_mfma_f32_16x16x32_bf16 v[92:95], a[168:171], a[44:47], v[92:95]
  s_waitcnt lgkmcnt(4)
  v_mul_f32 v36, s34, v36
  v_mul_f32 v37, s34, v37
  v_mfma_f32_16x16x32_bf16 v[96:99], a[176:179], a[32:35], v[96:99]
  ds_read_b128 a[128:131], v212 offset:0
  v_mul_f32 v38, s34, v38
  v_mul_f32 v39, s34, v39
  v_mfma_f32_16x16x32_bf16 v[96:99], a[180:183], a[48:51], v[96:99]
  v_mul_f32 v52, s34, v52
  v_mul_f32 v53, s34, v53
  v_mfma_f32_16x16x32_bf16 v[100:103], a[180:183], a[52:55], v[100:103]
  ds_read_b128 a[132:135], v213 offset:0
  v_mul_f32 v54, s34, v54
  v_mul_f32 v55, s34, v55
  v_mfma_f32_16x16x32_bf16 v[100:103], a[176:179], a[36:39], v[100:103]
  v_cvt_pk_bf16_f32 v148, v36, v37
  v_cvt_pk_bf16_f32 v149, v38, v39
  v_mfma_f32_16x16x32_bf16 v[104:107], a[176:179], a[40:43], v[104:107]
  ds_read_b128 a[136:139], v214 offset:0
  v_cvt_pk_bf16_f32 v150, v52, v53
  v_cvt_pk_bf16_f32 v151, v54, v55
  v_mfma_f32_16x16x32_bf16 v[104:107], a[180:183], a[56:59], v[104:107]
  v_permlane16_swap_b32 v132, v134
  v_permlane16_swap_b32 v133, v135
  v_mfma_f32_16x16x32_bf16 v[108:111], a[180:183], a[60:63], v[108:111]
  ds_read_b128 a[140:143], v215 offset:0
  v_mul_f32 v40, s34, v40
  v_mul_f32 v41, s34, v41
  v_mfma_f32_16x16x32_bf16 v[108:111], a[176:179], a[44:47], v[108:111]
  s_waitcnt lgkmcnt(4)
  v_mul_f32 v42, s34, v42
  v_mul_f32 v43, s34, v43
  v_mfma_f32_16x16x32_bf16 v[112:115], a[184:187], a[32:35], v[112:115]
  v_mul_f32 v56, s34, v56
  v_mul_f32 v57, s34, v57
  v_mfma_f32_16x16x32_bf16 v[112:115], a[188:191], a[48:51], v[112:115]
  v_mul_f32 v58, s34, v58
  v_mul_f32 v59, s34, v59
  v_mfma_f32_16x16x32_bf16 v[116:119], a[188:191], a[52:55], v[116:119]
  v_cvt_pk_bf16_f32 v164, v40, v41
  v_cvt_pk_bf16_f32 v165, v42, v43
  v_mfma_f32_16x16x32_bf16 v[116:119], a[184:187], a[36:39], v[116:119]
  v_cvt_pk_bf16_f32 v166, v56, v57
  v_cvt_pk_bf16_f32 v167, v58, v59
  v_mfma_f32_16x16x32_bf16 v[120:123], a[184:187], a[40:43], v[120:123]
  v_permlane16_swap_b32 v148, v150
  v_permlane16_swap_b32 v149, v151
  v_mfma_f32_16x16x32_bf16 v[120:123], a[188:191], a[56:59], v[120:123]
  v_mul_f32 v44, s34, v44
  v_mul_f32 v45, s34, v45
  v_mfma_f32_16x16x32_bf16 v[124:127], a[188:191], a[60:63], v[124:127]
  v_mul_f32 v46, s34, v46
  v_mul_f32 v47, s34, v47
  v_mfma_f32_16x16x32_bf16 v[124:127], a[184:187], a[44:47], v[124:127]
  s_waitcnt lgkmcnt(0)
  v_mul_f32 v60, s34, v60
  v_mul_f32 v61, s34, v61
  v_mul_f32 v62, s34, v62
  v_mul_f32 v63, s34, v63
  v_cvt_pk_bf16_f32 v180, v44, v45
  v_cvt_pk_bf16_f32 v181, v46, v47
  v_cvt_pk_bf16_f32 v182, v60, v61
  v_cvt_pk_bf16_f32 v183, v62, v63
  v_permlane16_swap_b32 v164, v166
  v_permlane16_swap_b32 v165, v167
  v_mul_f32 v64, s34, v64
  v_mul_f32 v65, s34, v65
  v_mul_f32 v66, s34, v66
  v_mul_f32 v67, s34, v67
  v_mul_f32 v80, s34, v80
  v_mul_f32 v81, s34, v81
  v_mul_f32 v82, s34, v82
  v_mul_f32 v83, s34, v83
  v_cvt_pk_bf16_f32 v136, v64, v65
  v_cvt_pk_bf16_f32 v137, v66, v67
  v_cvt_pk_bf16_f32 v138, v80, v81
  v_cvt_pk_bf16_f32 v139, v82, v83
  v_permlane16_swap_b32 v180, v182
  v_permlane16_swap_b32 v181, v183
  v_mul_f32 v68, s34, v68
  v_mul_f32 v69, s34, v69
  v_mul_f32 v70, s34, v70
  v_mul_f32 v71, s34, v71
  v_mul_f32 v84, s34, v84
  v_mul_f32 v85, s34, v85
  v_mul_f32 v86, s34, v86
  v_mul_f32 v87, s34, v87
  v_cvt_pk_bf16_f32 v152, v68, v69
  v_cvt_pk_bf16_f32 v153, v70, v71
  v_cvt_pk_bf16_f32 v154, v84, v85
  v_cvt_pk_bf16_f32 v155, v86, v87
  v_permlane16_swap_b32 v136, v138
  v_permlane16_swap_b32 v137, v139
  v_mul_f32 v72, s34, v72
  v_mul_f32 v73, s34, v73
  v_mul_f32 v74, s34, v74
  v_mul_f32 v75, s34, v75
  v_mul_f32 v88, s34, v88
  v_mul_f32 v89, s34, v89
  v_mul_f32 v90, s34, v90
  v_mul_f32 v91, s34, v91
  v_cvt_pk_bf16_f32 v168, v72, v73
  v_cvt_pk_bf16_f32 v169, v74, v75
  v_cvt_pk_bf16_f32 v170, v88, v89
  v_cvt_pk_bf16_f32 v171, v90, v91
  v_permlane16_swap_b32 v152, v154
  v_permlane16_swap_b32 v153, v155
  v_mul_f32 v76, s34, v76
  v_mul_f32 v77, s34, v77
  v_mul_f32 v78, s34, v78
  v_mul_f32 v79, s34, v79
  v_mul_f32 v92, s34, v92
  v_mul_f32 v93, s34, v93
  v_mul_f32 v94, s34, v94
  v_mul_f32 v95, s34, v95
  v_cvt_pk_bf16_f32 v184, v76, v77
  v_cvt_pk_bf16_f32 v185, v78, v79
  v_cvt_pk_bf16_f32 v186, v92, v93
  v_cvt_pk_bf16_f32 v187, v94, v95
  v_permlane16_swap_b32 v168, v170
  v_permlane16_swap_b32 v169, v171
  v_mul_f32 v96, s34, v96
  v_mul_f32 v97, s34, v97
  v_mul_f32 v98, s34, v98
  v_mul_f32 v99, s34, v99
  v_mul_f32 v112, s34, v112
  v_mul_f32 v113, s34, v113
  v_mul_f32 v114, s34, v114
  v_mul_f32 v115, s34, v115
  v_cvt_pk_bf16_f32 v140, v96, v97
  v_cvt_pk_bf16_f32 v141, v98, v99
  v_cvt_pk_bf16_f32 v142, v112, v113
  v_cvt_pk_bf16_f32 v143, v114, v115
  v_permlane16_swap_b32 v184, v186
  v_permlane16_swap_b32 v185, v187
  v_mul_f32 v100, s34, v100
  v_mul_f32 v101, s34, v101
  v_mul_f32 v102, s34, v102
  v_mul_f32 v103, s34, v103
  v_mul_f32 v116, s34, v116
  v_mul_f32 v117, s34, v117
  v_mul_f32 v118, s34, v118
  v_mul_f32 v119, s34, v119
  v_cvt_pk_bf16_f32 v156, v100, v101
  v_cvt_pk_bf16_f32 v157, v102, v103
  v_cvt_pk_bf16_f32 v158, v116, v117
  v_cvt_pk_bf16_f32 v159, v118, v119
  v_permlane16_swap_b32 v140, v142
  v_permlane16_swap_b32 v141, v143
  v_mul_f32 v104, s34, v104
  v_mul_f32 v105, s34, v105
  v_mul_f32 v106, s34, v106
  v_mul_f32 v107, s34, v107
  v_mul_f32 v120, s34, v120
  v_mul_f32 v121, s34, v121
  v_mul_f32 v122, s34, v122
  v_mul_f32 v123, s34, v123
  v_cvt_pk_bf16_f32 v172, v104, v105
  v_cvt_pk_bf16_f32 v173, v106, v107
  v_cvt_pk_bf16_f32 v174, v120, v121
  v_cvt_pk_bf16_f32 v175, v122, v123
  v_permlane16_swap_b32 v156, v158
  v_permlane16_swap_b32 v157, v159
  v_mul_f32 v108, s34, v108
  v_mul_f32 v109, s34, v109
  v_mul_f32 v110, s34, v110
  v_mul_f32 v111, s34, v111
  v_mul_f32 v124, s34, v124
  v_mul_f32 v125, s34, v125
  v_mul_f32 v126, s34, v126
  v_mul_f32 v127, s34, v127
  v_cvt_pk_bf16_f32 v188, v108, v109
  v_cvt_pk_bf16_f32 v189, v110, v111
  v_cvt_pk_bf16_f32 v190, v124, v125
  v_cvt_pk_bf16_f32 v191, v126, v127
  v_permlane16_swap_b32 v172, v174
  v_permlane16_swap_b32 v173, v175
  v_permlane16_swap_b32 v188, v190
  v_permlane16_swap_b32 v189, v191
  v_mfma_f32_16x16x32_bf16 v[0:3], a[128:131], v[128:131], 0
  ds_read_b128 a[144:147], v212 offset:4096
  v_mfma_f32_16x16x32_bf16 v[0:3], a[132:135], v[132:135], v[0:3]
  v_mfma_f32_16x16x32_bf16 v[0:3], a[136:139], v[136:139], v[0:3]
  ds_read_b128 a[148:151], v213 offset:4096
  v_mfma_f32_16x16x32_bf16 v[0:3], a[140:143], v[140:143], v[0:3]
  v_mfma_f32_16x16x32_bf16 v[8:11], a[140:143], v[156:159], 0
  ds_read_b128 a[152:155], v214 offset:4096
  v_mfma_f32_16x16x32_bf16 v[8:11], a[136:139], v[152:155], v[8:11]
  v_mfma_f32_16x16x32_bf16 v[8:11], a[132:135], v[148:151], v[8:11]
  ds_read_b128 a[156:159], v215 offset:4096
  v_mfma_f32_16x16x32_bf16 v[8:11], a[128:131], v[144:147], v[8:11]
  v_mfma_f32_16x16x32_bf16 v[16:19], a[128:131], v[160:163], 0
  v_mfma_f32_16x16x32_bf16 v[16:19], a[132:135], v[164:167], v[16:19]
  v_mfma_f32_16x16x32_bf16 v[16:19], a[136:139], v[168:171], v[16:19]
  v_mfma_f32_16x16x32_bf16 v[16:19], a[140:143], v[172:175], v[16:19]
  v_max3_f32 v192, v0, v1, v2
  s_nop 2
  v_max3_f32 v196, v8, v9, v10
  v_mfma_f32_16x16x32_bf16 v[24:27], a[140:143], v[188:191], 0
  v_max_f32 v192, v192, v3
  v_max_f32 v196, v196, v11
  v_mfma_f32_16x16x32_bf16 v[24:27], a[136:139], v[184:187], v[24:27]
  v_mov_b32 v245, v192
  v_mov_b32 v246, v196
  v_mfma_f32_16x16x32_bf16 v[24:27], a[132:135], v[180:183], v[24:27]
  v_permlane16_swap_b32 v192, v245
  v_permlane16_swap_b32 v196, v246
  v_mfma_f32_16x16x32_bf16 v[24:27], a[128:131], v[176:179], v[24:27]
  s_waitcnt lgkmcnt(0)
  v_max_f32 v192, v192, v245
  v_max_f32 v196, v196, v246
  v_mfma_f32_16x16x32_bf16 v[4:7], a[144:147], v[128:131], 0
  ds_read_b128 a[128:131], v212 offset:8192
  v_mov_b32 v245, v192
  v_mov_b32 v246, v196
  v_mfma_f32_16x16x32_bf16 v[4:7], a[148:151], v[132:135], v[4:7]
  v_permlane32_swap_b32 v192, v245
  v_permlane32_swap_b32 v196, v246
  v_mfma_f32_16x16x32_bf16 v[4:7], a[152:155], v[136:139], v[4:7]
  ds_read_b128 a[132:135], v213 offset:8192
  v_max_f32 v192, v192, v245
  v_max_f32 v196, v196, v246
  v_mfma_f32_16x16x32_bf16 v[4:7], a[156:159], v[140:143], v[4:7]
  v_sub_f32 v193, 0, v192
  v_sub_f32 v197, 0, v196
  v_mfma_f32_16x16x32_bf16 v[12:15], a[156:159], v[156:159], 0
  ds_read_b128 a[136:139], v214 offset:8192
  v_sub_f32 v194, 0, v192
  v_sub_f32 v198, 0, v196
  v_mfma_f32_16x16x32_bf16 v[12:15], a[152:155], v[152:155], v[12:15]
  v_sub_f32 v195, 0, v192
  v_sub_f32 v199, 0, v196
  v_mfma_f32_16x16x32_bf16 v[12:15], a[148:151], v[148:151], v[12:15]
  ds_read_b128 a[140:143], v215 offset:8192
  v_sub_f32 v192, 0, v192
  v_sub_f32 v196, 0, v196
  v_mfma_f32_16x16x32_bf16 v[12:15], a[144:147], v[144:147], v[12:15]
  v_max3_f32 v200, v16, v17, v18
  v_max3_f32 v204, v24, v25, v26
  v_mfma_f32_16x16x32_bf16 v[20:23], a[144:147], v[160:163], 0
  v_max_f32 v200, v200, v19
  v_max_f32 v204, v204, v27
  v_mfma_f32_16x16x32_bf16 v[20:23], a[148:151], v[164:167], v[20:23]
  v_mov_b32 v247, v200
  v_mov_b32 v248, v204
  v_mfma_f32_16x16x32_bf16 v[20:23], a[152:155], v[168:171], v[20:23]
  v_permlane16_swap_b32 v200, v247
  v_permlane16_swap_b32 v204, v248
  v_mfma_f32_16x16x32_bf16 v[20:23], a[156:159], v[172:175], v[20:23]
  v_max_f32 v200, v200, v247
  v_max_f32 v204, v204, v248
  v_mfma_f32_16x16x32_bf16 v[28:31], a[156:159], v[188:191], 0
  v_mov_b32 v247, v200
  v_mov_b32 v248, v204
  v_mfma_f32_16x16x32_bf16 v[28:31], a[152:155], v[184:187], v[28:31]
  v_permlane32_swap_b32 v200, v247
  v_permlane32_swap_b32 v204, v248
  v_mfma_f32_16x16x32_bf16 v[28:31], a[148:151], v[180:183], v[28:31]
  v_max_f32 v200, v200, v247
  v_max_f32 v204, v204, v248
  v_sub_f32 v201, 0, v200
  v_sub_f32 v205, 0, v204
  v_sub_f32 v202, 0, v200
  v_sub_f32 v206, 0, v204
  v_sub_f32 v203, 0, v200
  v_sub_f32 v207, 0, v204
  v_sub_f32 v200, 0, v200
  v_sub_f32 v204, 0, v204
  v_mfma_f32_16x16x32_bf16 v[28:31], a[144:147], v[176:179], v[28:31]
  s_waitcnt lgkmcnt(0)
  v_add_f32 v0, v192, v0
  v_add_f32 v1, v192, v1
  v_mfma_f32_16x16x32_bf16 v[32:35], a[128:131], v[128:131], v[192:195]
  ds_read_b128 a[144:147], v212 offset:12288
  v_add_f32 v2, v192, v2
  v_add_f32 v3, v192, v3
  v_mfma_f32_16x16x32_bf16 v[32:35], a[132:135], v[132:135], v[32:35]
  v_exp_f32 v0, v0
  v_mfma_f32_16x16x32_bf16 v[32:35], a[136:139], v[136:139], v[32:35]
  ds_read_b128 a[148:151], v213 offset:12288
  v_exp_f32 v1, v1
  v_mfma_f32_16x16x32_bf16 v[32:35], a[140:143], v[140:143], v[32:35]
  v_add_f32 v208, v208, v0
  v_mfma_f32_16x16x32_bf16 v[40:43], a[140:143], v[156:159], v[196:199]
  ds_read_b128 a[152:155], v214 offset:12288
  v_exp_f32 v2, v2
  v_mfma_f32_16x16x32_bf16 v[40:43], a[136:139], v[152:155], v[40:43]
  v_add_f32 v208, v208, v1
  v_cvt_pk_bf16_f32 v0, v0, v1
  v_mfma_f32_16x16x32_bf16 v[40:43], a[132:135], v[148:151], v[40:43]
  ds_read_b128 a[156:159], v215 offset:12288
  v_exp_f32 v3, v3
  v_mfma_f32_16x16x32_bf16 v[40:43], a[128:131], v[144:147], v[40:43]
  v_add_f32 v208, v208, v2
  v_add_f32 v208, v208, v3
  v_mfma_f32_16x16x32_bf16 v[48:51], a[128:131], v[160:163], v[200:203]
  v_cvt_pk_bf16_f32 v1, v2, v3
  v_add_f32 v8, v196, v8
  v_mfma_f32_16x16x32_bf16 v[48:51], a[132:135], v[164:167], v[48:51]
  v_add_f32 v9, v196, v9
  v_add_f32 v10, v196, v10
  v_mfma_f32_16x16x32_bf16 v[48:51], a[136:139], v[168:171], v[48:51]
  v_add_f32 v11, v196, v11
  v_mfma_f32_16x16x32_bf16 v[48:51], a[140:143], v[172:175], v[48:51]
  v_exp_f32 v8, v8
  v_mfma_f32_16x16x32_bf16 v[56:59], a[140:143], v[188:191], v[204:207]
  v_exp_f32 v9, v9
  v_mfma_f32_16x16x32_bf16 v[56:59], a[136:139], v[184:187], v[56:59]
  v_add_f32 v209, v209, v8
  v_mfma_f32_16x16x32_bf16 v[56:59], a[132:135], v[180:183], v[56:59]
  v_exp_f32 v10, v10
  v_mfma_f32_16x16x32_bf16 v[56:59], a[128:131], v[176:179], v[56:59]
  s_waitcnt lgkmcnt(0)
  v_add_f32 v209, v209, v9
  v_cvt_pk_bf16_f32 v8, v8, v9
  v_mfma_f32_16x16x32_bf16 v[36:39], a[144:147], v[128:131], v[192:195]
  s_waitcnt vmcnt(4)
  v_exp_f32 v11, v11
  v_mfma_f32_16x16x32_bf16 v[36:39], a[148:151], v[132:135], v[36:39]
  s_barrier
  v_add_f32 v209, v209, v10
  v_add_f32 v209, v209, v11
  v_mfma_f32_16x16x32_bf16 v[36:39], a[152:155], v[136:139], v[36:39]
  ds_read_b128 a[128:131], v212 offset:16384
  v_cvt_pk_bf16_f32 v9, v10, v11
  v_add_f32 v16, v200, v16
  v_mfma_f32_16x16x32_bf16 v[36:39], a[156:159], v[140:143], v[36:39]
  v_add_f32 v17, v200, v17
  v_add_f32 v18, v200, v18
  v_mfma_f32_16x16x32_bf16 v[44:47], a[156:159], v[156:159], v[196:199]
  ds_read_b128 a[132:135], v213 offset:16384
  v_add_f32 v19, v200, v19
  v_mfma_f32_16x16x32_bf16 v[44:47], a[152:155], v[152:155], v[44:47]
  v_exp_f32 v16, v16
  v_mfma_f32_16x16x32_bf16 v[44:47], a[148:151], v[148:151], v[44:47]
  ds_read_b128 a[136:139], v214 offset:16384
  v_exp_f32 v17, v17
  v_mfma_f32_16x16x32_bf16 v[44:47], a[144:147], v[144:147], v[44:47]
  v_add_f32 v210, v210, v16
  v_mfma_f32_16x16x32_bf16 v[52:55], a[144:147], v[160:163], v[200:203]
  ds_read_b128 a[140:143], v215 offset:16384
  v_exp_f32 v18, v18
  v_mfma_f32_16x16x32_bf16 v[52:55], a[148:151], v[164:167], v[52:55]
  v_add_f32 v210, v210, v17
  v_cvt_pk_bf16_f32 v16, v16, v17
  v_mfma_f32_16x16x32_bf16 v[52:55], a[152:155], v[168:171], v[52:55]
  v_exp_f32 v19, v19
  v_mfma_f32_16x16x32_bf16 v[52:55], a[156:159], v[172:175], v[52:55]
  v_add_f32 v210, v210, v18
  v_add_f32 v210, v210, v19
  v_mfma_f32_16x16x32_bf16 v[60:63], a[156:159], v[188:191], v[204:207]
  v_cvt_pk_bf16_f32 v17, v18, v19
  v_add_f32 v24, v204, v24
  v_mfma_f32_16x16x32_bf16 v[60:63], a[152:155], v[184:187], v[60:63]
  v_add_f32 v25, v204, v25
  v_add_f32 v26, v204, v26
  v_mfma_f32_16x16x32_bf16 v[60:63], a[148:151], v[180:183], v[60:63]
  v_add_f32 v27, v204, v27
  v_mfma_f32_16x16x32_bf16 v[60:63], a[144:147], v[176:179], v[60:63]
  s_waitcnt lgkmcnt(0)
  v_exp_f32 v24, v24
  v_exp_f32 v25, v25
  v_add_f32 v211, v211, v24
  v_exp_f32 v26, v26
  v_add_f32 v211, v211, v25
  v_cvt_pk_bf16_f32 v24, v24, v25
  v_exp_f32 v27, v27
  v_add_f32 v211, v211, v26
  v_add_f32 v211, v211, v27
  v_cvt_pk_bf16_f32 v25, v26, v27
  v_add_f32 v4, v192, v4
  v_add_f32 v5, v192, v5
  v_add_f32 v6, v192, v6
  v_add_f32 v7, v192, v7
  v_exp_f32 v4, v4
  v_exp_f32 v5, v5
  v_add_f32 v208, v208, v4
  v_exp_f32 v6, v6
  v_add_f32 v208, v208, v5
  v_cvt_pk_bf16_f32 v2, v4, v5
  v_exp_f32 v7, v7
  v_add_f32 v208, v208, v6
  v_add_f32 v208, v208, v7
  v_cvt_pk_bf16_f32 v3, v6, v7
  v_add_f32 v12, v196, v12
  v_add_f32 v13, v196, v13
  v_add_f32 v14, v196, v14
  v_add_f32 v15, v196, v15
  v_exp_f32 v12, v12
  v_exp_f32 v13, v13
  v_add_f32 v209, v209, v12
  v_exp_f32 v14, v14
  v_add_f32 v209, v209, v13
  v_cvt_pk_bf16_f32 v10, v12, v13
  v_exp_f32 v15, v15
  v_add_f32 v209, v209, v14
  v_add_f32 v209, v209, v15
  v_cvt_pk_bf16_f32 v11, v14, v15
  v_add_f32 v20, v200, v20
  v_add_f32 v21, v200, v21
  v_add_f32 v22, v200, v22
  v_add_f32 v23, v200, v23
  v_exp_f32 v20, v20
  v_exp_f32 v21, v21
  v_add_f32 v210, v210, v20
  v_exp_f32 v22, v22
  v_add_f32 v210, v210, v21
  v_cvt_pk_bf16_f32 v18, v20, v21
  v_exp_f32 v23, v23
  v_add_f32 v210, v210, v22
  v_add_f32 v210, v210, v23
  v_cvt_pk_bf16_f32 v19, v22, v23
  v_add_f32 v28, v204, v28
  v_add_f32 v29, v204, v29
  v_add_f32 v30, v204, v30
  v_add_f32 v31, v204, v31
  v_exp_f32 v28, v28
  v_exp_f32 v29, v29
  v_add_f32 v211, v211, v28
  v_exp_f32 v30, v30
  v_add_f32 v211, v211, v29
  v_cvt_pk_bf16_f32 v26, v28, v29
  v_exp_f32 v31, v31
  v_add_f32 v211, v211, v30
  v_add_f32 v211, v211, v31
  v_cvt_pk_bf16_f32 v27, v30, v31
  v_exp_f32 v32, v32
  v_exp_f32 v33, v33
  v_add_f32 v208, v208, v32
  v_exp_f32 v34, v34
  v_add_f32 v208, v208, v33
  v_cvt_pk_bf16_f32 v32, v32, v33
  v_exp_f32 v35, v35
  v_add_f32 v208, v208, v34
  v_add_f32 v208, v208, v35
  v_cvt_pk_bf16_f32 v33, v34, v35
  v_exp_f32 v40, v40
  v_exp_f32 v41, v41
  v_add_f32 v209, v209, v40
  v_exp_f32 v42, v42
  v_add_f32 v209, v209, v41
  v_cvt_pk_bf16_f32 v40, v40, v41
  v_exp_f32 v43, v43
  v_add_f32 v209, v209, v42
  v_add_f32 v209, v209, v43
  v_cvt_pk_bf16_f32 v41, v42, v43
  v_exp_f32 v48, v48
  v_exp_f32 v49, v49
  v_add_f32 v210, v210, v48
  v_exp_f32 v50, v50
  v_add_f32 v210, v210, v49
  v_cvt_pk_bf16_f32 v48, v48, v49
  v_exp_f32 v51, v51
  v_add_f32 v210, v210, v50
  v_add_f32 v210, v210, v51
  v_cvt_pk_bf16_f32 v49, v50, v51
  v_exp_f32 v56, v56
  v_exp_f32 v57, v57
  v_add_f32 v211, v211, v56
  v_exp_f32 v58, v58
  v_add_f32 v211, v211, v57
  v_cvt_pk_bf16_f32 v56, v56, v57
  v_exp_f32 v59, v59
  v_add_f32 v211, v211, v58
  v_add_f32 v211, v211, v59
  v_cvt_pk_bf16_f32 v57, v58, v59
  v_exp_f32 v36, v36
  v_exp_f32 v37, v37
  v_add_f32 v208, v208, v36
  v_exp_f32 v38, v38
  v_add_f32 v208, v208, v37
  v_cvt_pk_bf16_f32 v34, v36, v37
  v_exp_f32 v39, v39
  v_add_f32 v208, v208, v38
  v_add_f32 v208, v208, v39
  v_cvt_pk_bf16_f32 v35, v38, v39
  v_exp_f32 v44, v44
  v_exp_f32 v45, v45
  v_add_f32 v209, v209, v44
  v_exp_f32 v46, v46
  v_add_f32 v209, v209, v45
  v_cvt_pk_bf16_f32 v42, v44, v45
  v_exp_f32 v47, v47
  v_add_f32 v209, v209, v46
  v_add_f32 v209, v209, v47
  v_cvt_pk_bf16_f32 v43, v46, v47
  v_exp_f32 v52, v52
  v_exp_f32 v53, v53
  v_add_f32 v210, v210, v52
  v_exp_f32 v54, v54
  v_add_f32 v210, v210, v53
  v_cvt_pk_bf16_f32 v50, v52, v53
  v_exp_f32 v55, v55
  v_add_f32 v210, v210, v54
  v_mfma_f32_16x16x32_bf16 v[64:67], a[128:131], v[128:131], v[192:195]
  ds_read_b128 a[144:147], v212 offset:20480
  v_exp_f32 v60, v60
  v_mfma_f32_16x16x32_bf16 v[64:67], a[132:135], v[132:135], v[64:67]
  v_add_f32 v210, v210, v55
  v_cvt_pk_bf16_f32 v51, v54, v55
  v_mfma_f32_16x16x32_bf16 v[64:67], a[136:139], v[136:139], v[64:67]
  ds_read_b128 a[148:151], v213 offset:20480
  v_exp_f32 v61, v61
  v_mfma_f32_16x16x32_bf16 v[64:67], a[140:143], v[140:143], v[64:67]
  v_add_f32 v211, v211, v60
  v_mfma_f32_16x16x32_bf16 v[72:75], a[140:143], v[156:159], v[196:199]
  ds_read_b128 a[152:155], v214 offset:20480
  v_exp_f32 v62, v62
  v_mfma_f32_16x16x32_bf16 v[72:75], a[136:139], v[152:155], v[72:75]
  v_add_f32 v211, v211, v61
  v_cvt_pk_bf16_f32 v58, v60, v61
  v_mfma_f32_16x16x32_bf16 v[72:75], a[132:135], v[148:151], v[72:75]
  ds_read_b128 a[156:159], v215 offset:20480
  v_exp_f32 v63, v63
  v_mfma_f32_16x16x32_bf16 v[72:75], a[128:131], v[144:147], v[72:75]
  v_add_f32 v211, v211, v62
  v_mfma_f32_16x16x32_bf16 v[80:83], a[128:131], v[160:163], v[200:203]
  s_add_u32 m0, s28, 98304
  v_exp_f32 v64, v64
  v_mfma_f32_16x16x32_bf16 v[80:83], a[132:135], v[164:167], v[80:83]
  buffer_load_dwordx4 v236, s[16:19], s29 offen offset:0 lds
  v_add_f32 v211, v211, v63
  v_cvt_pk_bf16_f32 v59, v62, v63
  v_mfma_f32_16x16x32_bf16 v[80:83], a[136:139], v[168:171], v[80:83]
  v_exp_f32 v65, v65
  v_mfma_f32_16x16x32_bf16 v[80:83], a[140:143], v[172:175], v[80:83]
  buffer_load_dwordx4 v237, s[16:19], s29 offen offset:1024 lds
  v_add_f32 v208, v208, v64
  v_mfma_f32_16x16x32_bf16 v[88:91], a[140:143], v[188:191], v[204:207]
  v_exp_f32 v66, v66
  v_mfma_f32_16x16x32_bf16 v[88:91], a[136:139], v[184:187], v[88:91]
  buffer_load_dwordx4 v236, s[16:19], s29 offen offset:2048 lds
  v_add_f32 v208, v208, v65
  v_cvt_pk_bf16_f32 v64, v64, v65
  v_mfma_f32_16x16x32_bf16 v[88:91], a[132:135], v[180:183], v[88:91]
  v_exp_f32 v67, v67
  v_mfma_f32_16x16x32_bf16 v[88:91], a[128:131], v[176:179], v[88:91]
  s_waitcnt lgkmcnt(0)
  v_add_f32 v208, v208, v66
  v_mfma_f32_16x16x32_bf16 v[68:71], a[144:147], v[128:131], v[192:195]
  ds_read_b128 a[128:131], v212 offset:24576
  v_exp_f32 v72, v72
  v_mfma_f32_16x16x32_bf16 v[68:71], a[148:151], v[132:135], v[68:71]
  v_add_f32 v208, v208, v67
  v_cvt_pk_bf16_f32 v65, v66, v67
  v_mfma_f32_16x16x32_bf16 v[68:71], a[152:155], v[136:139], v[68:71]
  ds_read_b128 a[132:135], v213 offset:24576
  v_exp_f32 v73, v73
  v_mfma_f32_16x16x32_bf16 v[68:71], a[156:159], v[140:143], v[68:71]
  v_add_f32 v209, v209, v72
  v_mfma_f32_16x16x32_bf16 v[76:79], a[156:159], v[156:159], v[196:199]
  ds_read_b128 a[136:139], v214 offset:24576
  v_exp_f32 v74, v74
  v_mfma_f32_16x16x32_bf16 v[76:79], a[152:155], v[152:155], v[76:79]
  v_add_f32 v209, v209, v73
  v_cvt_pk_bf16_f32 v72, v72, v73
  v_mfma_f32_16x16x32_bf16 v[76:79], a[148:151], v[148:151], v[76:79]
  ds_read_b128 a[140:143], v215 offset:24576
  v_exp_f32 v75, v75
  v_mfma_f32_16x16x32_bf16 v[76:79], a[144:147], v[144:147], v[76:79]
  v_add_f32 v209, v209, v74
  v_mfma_f32_16x16x32_bf16 v[84:87], a[144:147], v[160:163], v[200:203]
  buffer_load_dwordx4 v237, s[16:19], s29 offen offset:3072 lds
  v_exp_f32 v80, v80
  v_mfma_f32_16x16x32_bf16 v[84:87], a[148:151], v[164:167], v[84:87]
  s_add_u32 s29, s29, 16384
  v_add_f32 v209, v209, v75
  v_cvt_pk_bf16_f32 v73, v74, v75
  v_mfma_f32_16x16x32_bf16 v[84:87], a[152:155], v[168:171], v[84:87]
  s_add_u32 m0, s28, 49152
  v_exp_f32 v81, v81
  v_mfma_f32_16x16x32_bf16 v[84:87], a[156:159], v[172:175], v[84:87]
  buffer_load_dwordx4 v232, s[12:15], s29 offen offset:0 lds
  v_add_f32 v210, v210, v80
  v_mfma_f32_16x16x32_bf16 v[92:95], a[156:159], v[188:191], v[204:207]
  v_exp_f32 v82, v82
  v_mfma_f32_16x16x32_bf16 v[92:95], a[152:155], v[184:187], v[92:95]
  buffer_load_dwordx4 v233, s[12:15], s29 offen offset:1024 lds
  v_add_f32 v210, v210, v81
  v_cvt_pk_bf16_f32 v80, v80, v81
  v_mfma_f32_16x16x32_bf16 v[92:95], a[148:151], v[180:183], v[92:95]
  v_exp_f32 v83, v83
  v_mfma_f32_16x16x32_bf16 v[92:95], a[144:147], v[176:179], v[92:95]
  s_waitcnt lgkmcnt(0)
  v_add_f32 v210, v210, v82
  v_mfma_f32_16x16x32_bf16 v[96:99], a[128:131], v[128:131], v[192:195]
  ds_read_b128 a[144:147], v212 offset:28672
  v_exp_f32 v88, v88
  v_mfma_f32_16x16x32_bf16 v[96:99], a[132:135], v[132:135], v[96:99]
  v_add_f32 v210, v210, v83
  v_cvt_pk_bf16_f32 v81, v82, v83
  v_mfma_f32_16x16x32_bf16 v[96:99], a[136:139], v[136:139], v[96:99]
  ds_read_b128 a[148:151], v213 offset:28672
  v_exp_f32 v89, v89
  v_mfma_f32_16x16x32_bf16 v[96:99], a[140:143], v[140:143], v[96:99]
  v_add_f32 v211, v211, v88
  v_mfma_f32_16x16x32_bf16 v[104:107], a[140:143], v[156:159], v[196:199]
  ds_read_b128 a[152:155], v214 offset:28672
  v_exp_f32 v90, v90
  v_mfma_f32_16x16x32_bf16 v[104:107], a[136:139], v[152:155], v[104:107]
  v_add_f32 v211, v211, v89
  v_cvt_pk_bf16_f32 v88, v88, v89
  v_mfma_f32_16x16x32_bf16 v[104:107], a[132:135], v[148:151], v[104:107]
  ds_read_b128 a[156:159], v215 offset:28672
  v_exp_f32 v91, v91
  v_mfma_f32_16x16x32_bf16 v[104:107], a[128:131], v[144:147], v[104:107]
  v_add_f32 v211, v211, v90
  v_mfma_f32_16x16x32_bf16 v[112:115], a[128:131], v[160:163], v[200:203]
  buffer_load_dwordx4 v234, s[12:15], s29 offen offset:2048 lds
  v_exp_f32 v68, v68
  v_mfma_f32_16x16x32_bf16 v[112:115], a[132:135], v[164:167], v[112:115]
  v_add_f32 v211, v211, v91
  v_cvt_pk_bf16_f32 v89, v90, v91
  v_mfma_f32_16x16x32_bf16 v[112:115], a[136:139], v[168:171], v[112:115]
  buffer_load_dwordx4 v235, s[12:15], s29 offen offset:3072 lds
  v_exp_f32 v69, v69
  v_mfma_f32_16x16x32_bf16 v[112:115], a[140:143], v[172:175], v[112:115]
  v_add_f32 v208, v208, v68
  v_mfma_f32_16x16x32_bf16 v[120:123], a[140:143], v[188:191], v[204:207]
  v_exp_f32 v70, v70
  v_mfma_f32_16x16x32_bf16 v[120:123], a[136:139], v[184:187], v[120:123]
  v_add_f32 v208, v208, v69
  v_cvt_pk_bf16_f32 v66, v68, v69
  v_mfma_f32_16x16x32_bf16 v[120:123], a[132:135], v[180:183], v[120:123]
  v_exp_f32 v71, v71
  v_mfma_f32_16x16x32_bf16 v[120:123], a[128:131], v[176:179], v[120:123]
  s_waitcnt lgkmcnt(0)
  v_add_f32 v208, v208, v70
  v_mfma_f32_16x16x32_bf16 v[100:103], a[144:147], v[128:131], v[192:195]
  ds_read_b64_tr_b16 a[160:161], v216 offset:0
  v_exp_f32 v76, v76
  v_mfma_f32_16x16x32_bf16 v[100:103], a[148:151], v[132:135], v[100:103]
  v_add_f32 v208, v208, v71
  v_cvt_pk_bf16_f32 v67, v70, v71
  v_mfma_f32_16x16x32_bf16 v[100:103], a[152:155], v[136:139], v[100:103]
  ds_read_b64_tr_b16 a[162:163], v216 offset:4096
  v_exp_f32 v77, v77
  v_mfma_f32_16x16x32_bf16 v[100:103], a[156:159], v[140:143], v[100:103]
  v_add_f32 v209, v209, v76
  v_mfma_f32_16x16x32_bf16 v[108:111], a[156:159], v[156:159], v[196:199]
  ds_read_b64_tr_b16 a[164:165], v216 offset:8192
  v_exp_f32 v78, v78
  v_mfma_f32_16x16x32_bf16 v[108:111], a[152:155], v[152:155], v[108:111]
  v_add_f32 v209, v209, v77
  v_cvt_pk_bf16_f32 v74, v76, v77
  v_mfma_f32_16x16x32_bf16 v[108:111], a[148:151], v[148:151], v[108:111]
  ds_read_b64_tr_b16 a[166:167], v216 offset:12288
  v_exp_f32 v79, v79
  v_mfma_f32_16x16x32_bf16 v[108:111], a[144:147], v[144:147], v[108:111]
  v_add_f32 v209, v209, v78
  v_mfma_f32_16x16x32_bf16 v[116:119], a[144:147], v[160:163], v[200:203]
  ds_read_b64_tr_b16 a[168:169], v217 offset:0
  v_exp_f32 v84, v84
  v_mfma_f32_16x16x32_bf16 v[116:119], a[148:151], v[164:167], v[116:119]
  v_add_f32 v209, v209, v79
  v_cvt_pk_bf16_f32 v75, v78, v79
  v_mfma_f32_16x16x32_bf16 v[116:119], a[152:155], v[168:171], v[116:119]
  ds_read_b64_tr_b16 a[170:171], v217 offset:4096
  v_exp_f32 v85, v85
  v_mfma_f32_16x16x32_bf16 v[116:119], a[156:159], v[172:175], v[116:119]
  v_add_f32 v210, v210, v84
  v_mfma_f32_16x16x32_bf16 v[124:127], a[156:159], v[188:191], v[204:207]
  ds_read_b64_tr_b16 a[172:173], v217 offset:8192
  v_exp_f32 v86, v86
  v_mfma_f32_16x16x32_bf16 v[124:127], a[152:155], v[184:187], v[124:127]
  v_add_f32 v210, v210, v85
  v_cvt_pk_bf16_f32 v82, v84, v85
  v_mfma_f32_16x16x32_bf16 v[124:127], a[148:151], v[180:183], v[124:127]
  ds_read_b64_tr_b16 a[174:175], v217 offset:12288
  v_exp_f32 v87, v87
  v_mfma_f32_16x16x32_bf16 v[124:127], a[144:147], v[176:179], v[124:127]
  s_waitcnt lgkmcnt(4)
  v_add_f32 v210, v210, v86
  v_mfma_f32_16x16x32_bf16 a[0:3], a[160:163], v[0:3], 0
  ds_read_b64_tr_b16 a[176:177], v218 offset:0
  v_exp_f32 v92, v92
  v_mfma_f32_16x16x32_bf16 a[0:3], a[164:167], v[32:35], a[0:3]
  v_add_f32 v210, v210, v87
  v_cvt_pk_bf16_f32 v83, v86, v87
  v_mfma_f32_16x16x32_bf16 a[4:7], a[164:167], v[40:43], 0
  ds_read_b64_tr_b16 a[178:179], v218 offset:4096
  v_exp_f32 v93, v93
  v_mfma_f32_16x16x32_bf16 a[4:7], a[160:163], v[8:11], a[4:7]
  v_add_f32 v211, v211, v92
  v_mfma_f32_16x16x32_bf16 a[8:11], a[160:163], v[16:19], 0
  ds_read_b64_tr_b16 a[180:181], v218 offset:8192
  v_exp_f32 v94, v94
  v_mfma_f32_16x16x32_bf16 a[8:11], a[164:167], v[48:51], a[8:11]
  v_add_f32 v211, v211, v93
  v_cvt_pk_bf16_f32 v90, v92, v93
  v_mfma_f32_16x16x32_bf16 a[12:15], a[164:167], v[56:59], 0
  ds_read_b64_tr_b16 a[182:183], v218 offset:12288
  v_exp_f32 v95, v95
  v_mfma_f32_16x16x32_bf16 a[12:15], a[160:163], v[24:27], a[12:15]
  s_waitcnt lgkmcnt(4)
  v_add_f32 v211, v211, v94
  v_mfma_f32_16x16x32_bf16 a[16:19], a[168:171], v[0:3], 0
  ds_read_b64_tr_b16 a[184:185], v219 offset:0
  v_exp_f32 v96, v96
  v_mfma_f32_16x16x32_bf16 a[16:19], a[172:175], v[32:35], a[16:19]
  v_add_f32 v211, v211, v95
  v_cvt_pk_bf16_f32 v91, v94, v95
  v_mfma_f32_16x16x32_bf16 a[20:23], a[172:175], v[40:43], 0
  ds_read_b64_tr_b16 a[186:187], v219 offset:4096
  v_exp_f32 v97, v97
  v_mfma_f32_16x16x32_bf16 a[20:23], a[168:171], v[8:11], a[20:23]
  v_add_f32 v208, v208, v96
  v_mfma_f32_16x16x32_bf16 a[24:27], a[168:171], v[16:19], 0
  ds_read_b64_tr_b16 a[188:189], v219 offset:8192
  v_exp_f32 v98, v98
  v_mfma_f32_16x16x32_bf16 a[24:27], a[172:175], v[48:51], a[24:27]
  v_add_f32 v208, v208, v97
  v_cvt_pk_bf16_f32 v96, v96, v97
  v_mfma_f32_16x16x32_bf16 a[28:31], a[172:175], v[56:59], 0
  ds_read_b64_tr_b16 a[190:191], v219 offset:12288
  v_exp_f32 v99, v99
  v_mfma_f32_16x16x32_bf16 a[28:31], a[168:171], v[24:27], a[28:31]
  s_waitcnt lgkmcnt(4)
  v_add_f32 v208, v208, v98
  v_mfma_f32_16x16x32_bf16 a[32:35], a[176:179], v[0:3], 0
  ds_read_b64_tr_b16 a[160:161], v220 offset:0
  v_exp_f32 v104, v104
  v_mfma_f32_16x16x32_bf16 a[32:35], a[180:183], v[32:35], a[32:35]
  v_add_f32 v208, v208, v99
  v_cvt_pk_bf16_f32 v97, v98, v99
  v_mfma_f32_16x16x32_bf16 a[36:39], a[180:183], v[40:43], 0
  ds_read_b64_tr_b16 a[162:163], v220 offset:4096
  v_exp_f32 v105, v105
  v_mfma_f32_16x16x32_bf16 a[36:39], a[176:179], v[8:11], a[36:39]
  v_add_f32 v209, v209, v104
  v_mfma_f32_16x16x32_bf16 a[40:43], a[176:179], v[16:19], 0
  ds_read_b64_tr_b16 a[164:165], v220 offset:8192
  v_exp_f32 v106, v106
  v_mfma_f32_16x16x32_bf16 a[40:43], a[180:183], v[48:51], a[40:43]
  v_add_f32 v209, v209, v105
  v_cvt_pk_bf16_f32 v104, v104, v105
  v_mfma_f32_16x16x32_bf16 a[44:47], a[180:183], v[56:59], 0
  ds_read_b64_tr_b16 a[166:167], v220 offset:12288
  v_exp_f32 v107, v107
  v_mfma_f32_16x16x32_bf16 a[44:47], a[176:179], v[24:27], a[44:47]
  s_waitcnt lgkmcnt(4)
  v_add_f32 v209, v209, v106
  v_mfma_f32_16x16x32_bf16 a[48:51], a[184:187], v[0:3], 0
  ds_read_b64_tr_b16 a[168:169], v221 offset:0
  v_exp_f32 v112, v112
  v_mfma_f32_16x16x32_bf16 a[48:51], a[188:191], v[32:35], a[48:51]
  v_add_f32 v209, v209, v107
  v_cvt_pk_bf16_f32 v105, v106, v107
  v_mfma_f32_16x16x32_bf16 a[52:55], a[188:191], v[40:43], 0
  ds_read_b64_tr_b16 a[170:171], v221 offset:4096
  v_exp_f32 v113, v113
  v_mfma_f32_16x16x32_bf16 a[52:55], a[184:187], v[8:11], a[52:55]
  v_add_f32 v210, v210, v112
  v_mfma_f32_16x16x32_bf16 a[56:59], a[184:187], v[16:19], 0
  ds_read_b64_tr_b16 a[172:173], v221 offset:8192
  v_exp_f32 v114, v114
  v_mfma_f32_16x16x32_bf16 a[56:59], a[188:191], v[48:51], a[56:59]
  v_add_f32 v210, v210, v113
  v_cvt_pk_bf16_f32 v112, v112, v113
  v_mfma_f32_16x16x32_bf16 a[60:63], a[188:191], v[56:59], 0
  ds_read_b64_tr_b16 a[174:175], v221 offset:12288
  v_exp_f32 v115, v115
  v_mfma_f32_16x16x32_bf16 a[60:63], a[184:187], v[24:27], a[60:63]
  s_waitcnt lgkmcnt(4)
  v_add_f32 v210, v210, v114
  v_mfma_f32_16x16x32_bf16 a[64:67], a[160:163], v[0:3], 0
  ds_read_b64_tr_b16 a[176:177], v222 offset:0
  v_exp_f32 v120, v120
  v_mfma_f32_16x16x32_bf16 a[64:67], a[164:167], v[32:35], a[64:67]
  v_add_f32 v210, v210, v115
  v_cvt_pk_bf16_f32 v113, v114, v115
  v_mfma_f32_16x16x32_bf16 a[68:71], a[164:167], v[40:43], 0
  ds_read_b64_tr_b16 a[178:179], v222 offset:4096
  v_exp_f32 v121, v121
  v_mfma_f32_16x16x32_bf16 a[68:71], a[160:163], v[8:11], a[68:71]
  v_add_f32 v211, v211, v120
  v_mfma_f32_16x16x32_bf16 a[72:75], a[160:163], v[16:19], 0
  ds_read_b64_tr_b16 a[180:181], v222 offset:8192
  v_exp_f32 v122, v122
  v_mfma_f32_16x16x32_bf16 a[72:75], a[164:167], v[48:51], a[72:75]
  v_add_f32 v211, v211, v121
  v_cvt_pk_bf16_f32 v120, v120, v121
  v_mfma_f32_16x16x32_bf16 a[76:79], a[164:167], v[56:59], 0
  ds_read_b64_tr_b16 a[182:183], v222 offset:12288
  v_exp_f32 v123, v123
  v_mfma_f32_16x16x32_bf16 a[76:79], a[160:163], v[24:27], a[76:79]
  s_waitcnt lgkmcnt(4)
  v_add_f32 v211, v211, v122
  v_mfma_f32_16x16x32_bf16 a[80:83], a[168:171], v[0:3], 0
  ds_read_b64_tr_b16 a[184:185], v223 offset:0
  v_exp_f32 v100, v100
  v_mfma_f32_16x16x32_bf16 a[80:83], a[172:175], v[32:35], a[80:83]
  v_add_f32 v211, v211, v123
  v_cvt_pk_bf16_f32 v121, v122, v123
  v_mfma_f32_16x16x32_bf16 a[84:87], a[172:175], v[40:43], 0
  ds_read_b64_tr_b16 a[186:187], v223 offset:4096
  v_exp_f32 v101, v101
  v_mfma_f32_16x16x32_bf16 a[84:87], a[168:171], v[8:11], a[84:87]
  v_add_f32 v208, v208, v100
  v_mfma_f32_16x16x32_bf16 a[88:91], a[168:171], v[16:19], 0
  ds_read_b64_tr_b16 a[188:189], v223 offset:8192
  v_exp_f32 v102, v102
  v_mfma_f32_16x16x32_bf16 a[88:91], a[172:175], v[48:51], a[88:91]
  v_add_f32 v208, v208, v101
  v_cvt_pk_bf16_f32 v98, v100, v101
  v_mfma_f32_16x16x32_bf16 a[92:95], a[172:175], v[56:59], 0
  ds_read_b64_tr_b16 a[190:191], v223 offset:12288
  v_exp_f32 v103, v103
  v_mfma_f32_16x16x32_bf16 a[92:95], a[168:171], v[24:27], a[92:95]
  s_waitcnt lgkmcnt(4)
  v_add_f32 v208, v208, v102
  v_mfma_f32_16x16x32_bf16 a[96:99], a[176:179], v[0:3], 0
  s_waitcnt vmcnt(8)
  v_exp_f32 v108, v108
  v_mfma_f32_16x16x32_bf16 a[96:99], a[180:183], v[32:35], a[96:99]
  s_barrier
  v_add_f32 v208, v208, v103
  v_cvt_pk_bf16_f32 v99, v102, v103
  v_mfma_f32_16x16x32_bf16 a[100:103], a[180:183], v[40:43], 0
  ds_read_b128 a[128:131], v212 offset:32768
  v_exp_f32 v109, v109
  v_mfma_f32_16x16x32_bf16 a[100:103], a[176:179], v[8:11], a[100:103]
  v_add_f32 v209, v209, v108
  v_mfma_f32_16x16x32_bf16 a[104:107], a[176:179], v[16:19], 0
  ds_read_b128 a[132:135], v213 offset:32768
  v_exp_f32 v110, v110
  v_mfma_f32_16x16x32_bf16 a[104:107], a[180:183], v[48:51], a[104:107]
  v_add_f32 v209, v209, v109
  v_cvt_pk_bf16_f32 v106, v108, v109
  v_mfma_f32_16x16x32_bf16 a[108:111], a[180:183], v[56:59], 0
  ds_read_b128 a[136:139], v214 offset:32768
  v_exp_f32 v111, v111
  v_mfma_f32_16x16x32_bf16 a[108:111], a[176:179], v[24:27], a[108:111]
  s_waitcnt lgkmcnt(3)
  v_add_f32 v209, v209, v110
  v_mfma_f32_16x16x32_bf16 a[112:115], a[184:187], v[0:3], 0
  ds_read_b128 a[140:143], v215 offset:32768
  v_exp_f32 v116, v116
  v_mfma_f32_16x16x32_bf16 a[112:115], a[188:191], v[32:35], a[112:115]
  v_add_f32 v209, v209, v111
  v_cvt_pk_bf16_f32 v107, v110, v111
  v_mfma_f32_16x16x32_bf16 a[116:119], a[188:191], v[40:43], 0
  v_exp_f32 v117, v117
  v_mfma_f32_16x16x32_bf16 a[116:119], a[184:187], v[8:11], a[116:119]
  v_add_f32 v210, v210, v116
  v_mfma_f32_16x16x32_bf16 a[120:123], a[184:187], v[16:19], 0
  v_exp_f32 v118, v118
  v_mfma_f32_16x16x32_bf16 a[120:123], a[188:191], v[48:51], a[120:123]
  v_add_f32 v210, v210, v117
  v_cvt_pk_bf16_f32 v114, v116, v117
  v_mfma_f32_16x16x32_bf16 a[124:127], a[188:191], v[56:59], 0
  v_exp_f32 v119, v119
  v_mfma_f32_16x16x32_bf16 a[124:127], a[184:187], v[24:27], a[124:127]
  s_waitcnt lgkmcnt(0)
  v_add_f32 v210, v210, v118
  v_mfma_f32_16x16x32_bf16 v[0:3], a[128:131], v[128:131], v[192:195]
  ds_read_b128 a[144:147], v212 offset:36864
  v_exp_f32 v124, v124
  v_mfma_f32_16x16x32_bf16 v[0:3], a[132:135], v[132:135], v[0:3]
  v_add_f32 v210, v210, v119
  v_cvt_pk_bf16_f32 v115, v118, v119
  v_mfma_f32_16x16x32_bf16 v[0:3], a[136:139], v[136:139], v[0:3]
  ds_read_b128 a[148:151], v213 offset:36864
  v_exp_f32 v125, v125
  v_mfma_f32_16x16x32_bf16 v[0:3], a[140:143], v[140:143], v[0:3]
  v_add_f32 v211, v211, v124
  v_mfma_f32_16x16x32_bf16 v[8:11], a[140:143], v[156:159], v[196:199]
  ds_read_b128 a[152:155], v214 offset:36864
  v_exp_f32 v126, v126
  v_mfma_f32_16x16x32_bf16 v[8:11], a[136:139], v[152:155], v[8:11]
  v_add_f32 v211, v211, v125
  v_cvt_pk_bf16_f32 v122, v124, v125
  v_mfma_f32_16x16x32_bf16 v[8:11], a[132:135], v[148:151], v[8:11]
  ds_read_b128 a[156:159], v215 offset:36864
  v_exp_f32 v127, v127
  v_mfma_f32_16x16x32_bf16 v[8:11], a[128:131], v[144:147], v[8:11]
  v_add_f32 v211, v211, v126
  v_mfma_f32_16x16x32_bf16 v[16:19], a[128:131], v[160:163], v[200:203]
  s_add_u32 m0, s28, 114688
  v_exp_f32 v0, v0
  v_mfma_f32_16x16x32_bf16 v[16:19], a[132:135], v[164:167], v[16:19]
  buffer_load_dwordx4 v236, s[16:19], s29 offen offset:0 lds
  v_add_f32 v211, v211, v127
  v_cvt_pk_bf16_f32 v123, v126, v127
  v_mfma_f32_16x16x32_bf16 v[16:19], a[136:139], v[168:171], v[16:19]
  v_exp_f32 v1, v1
  v_mfma_f32_16x16x32_bf16 v[16:19], a[140:143], v[172:175], v[16:19]
  buffer_load_dwordx4 v237, s[16:19], s29 offen offset:1024 lds
  v_add_f32 v208, v208, v0
  v_mfma_f32_16x16x32_bf16 v[24:27], a[140:143], v[188:191], v[204:207]
  v_exp_f32 v2, v2
  v_mfma_f32_16x16x32_bf16 v[24:27], a[136:139], v[184:187], v[24:27]
  buffer_load_dwordx4 v236, s[16:19], s29 offen offset:2048 lds
  v_add_f32 v208, v208, v1
  v_cvt_pk_bf16_f32 v0, v0, v1
  v_mfma_f32_16x16x32_bf16 v[24:27], a[132:135], v[180:183], v[24:27]
  v_exp_f32 v3, v3
  v_mfma_f32_16x16x32_bf16 v[24:27], a[128:131], v[176:179], v[24:27]
  s_waitcnt lgkmcnt(0)
  v_add_f32 v208, v208, v2
  v_mfma_f32_16x16x32_bf16 v[4:7], a[144:147], v[128:131], v[192:195]
  ds_read_b128 a[128:131], v212 offset:40960
  v_exp_f32 v8, v8
  v_mfma_f32_16x16x32_bf16 v[4:7], a[148:151], v[132:135], v[4:7]
  v_add_f32 v208, v208, v3
  v_cvt_pk_bf16_f32 v1, v2, v3
  v_mfma_f32_16x16x32_bf16 v[4:7], a[152:155], v[136:139], v[4:7]
  ds_read_b128 a[132:135], v213 offset:40960
  v_exp_f32 v9, v9
  v_mfma_f32_16x16x32_bf16 v[4:7], a[156:159], v[140:143], v[4:7]
  v_add_f32 v209, v209, v8
  v_mfma_f32_16x16x32_bf16 v[12:15], a[156:159], v[156:159], v[196:199]
  ds_read_b128 a[136:139], v214 offset:40960
  v_exp_f32 v10, v10
  v_mfma_f32_16x16x32_bf16 v[12:15], a[152:155], v[152:155], v[12:15]
  v_add_f32 v209, v209, v9
  v_cvt_pk_bf16_f32 v8, v8, v9
  v_mfma_f32_16x16x32_bf16 v[12:15], a[148:151], v[148:151], v[12:15]
  ds_read_b128 a[140:143], v215 offset:40960
  v_exp_f32 v11, v11
  v_mfma_f32_16x16x32_bf16 v[12:15], a[144:147], v[144:147], v[12:15]
  v_add_f32 v209, v209, v10
  v_mfma_f32_16x16x32_bf16 v[20:23], a[144:147], v[160:163], v[200:203]
  buffer_load_dwordx4 v237, s[16:19], s29 offen offset:3072 lds
  v_exp_f32 v16, v16
  v_mfma_f32_16x16x32_bf16 v[20:23], a[148:151], v[164:167], v[20:23]
  s_add_u32 s29, s29, 16384
  v_add_f32 v209, v209, v11
  v_cvt_pk_bf16_f32 v9, v10, v11
  v_mfma_f32_16x16x32_bf16 v[20:23], a[152:155], v[168:171], v[20:23]
  s_add_u32 m0, s28, 0
  v_exp_f32 v17, v17
  v_mfma_f32_16x16x32_bf16 v[20:23], a[156:159], v[172:175], v[20:23]
  buffer_load_dwordx4 v232, s[12:15], s29 offen offset:0 lds
  v_add_f32 v210, v210, v16
  v_mfma_f32_16x16x32_bf16 v[28:31], a[156:159], v[188:191], v[204:207]
  v_exp_f32 v18, v18
  v_mfma_f32_16x16x32_bf16 v[28:31], a[152:155], v[184:187], v[28:31]
  buffer_load_dwordx4 v233, s[12:15], s29 offen offset:1024 lds
  v_add_f32 v210, v210, v17
  v_cvt_pk_bf16_f32 v16, v16, v17
  v_mfma_f32_16x16x32_bf16 v[28:31], a[148:151], v[180:183], v[28:31]
  v_exp_f32 v19, v19
  v_mfma_f32_16x16x32_bf16 v[28:31], a[144:147], v[176:179], v[28:31]
  s_waitcnt lgkmcnt(0)
  v_add_f32 v210, v210, v18
  v_mfma_f32_16x16x32_bf16 v[32:35], a[128:131], v[128:131], v[192:195]
  ds_read_b128 a[144:147], v212 offset:45056
  v_exp_f32 v24, v24
  v_mfma_f32_16x16x32_bf16 v[32:35], a[132:135], v[132:135], v[32:35]
  v_add_f32 v210, v210, v19
  v_cvt_pk_bf16_f32 v17, v18, v19
  v_mfma_f32_16x16x32_bf16 v[32:35], a[136:139], v[136:139], v[32:35]
  ds_read_b128 a[148:151], v213 offset:45056
  v_exp_f32 v25, v25
  v_mfma_f32_16x16x32_bf16 v[32:35], a[140:143], v[140:143], v[32:35]
  v_add_f32 v211, v211, v24
  v_mfma_f32_16x16x32_bf16 v[40:43], a[140:143], v[156:159], v[196:199]
  ds_read_b128 a[152:155], v214 offset:45056
  v_exp_f32 v26, v26
  v_mfma_f32_16x16x32_bf16 v[40:43], a[136:139], v[152:155], v[40:43]
  v_add_f32 v211, v211, v25
  v_cvt_pk_bf16_f32 v24, v24, v25
  v_mfma_f32_16x16x32_bf16 v[40:43], a[132:135], v[148:151], v[40:43]
  ds_read_b128 a[156:159], v215 offset:45056
  v_exp_f32 v27, v27
  v_mfma_f32_16x16x32_bf16 v[40:43], a[128:131], v[144:147], v[40:43]
  v_add_f32 v211, v211, v26
  v_mfma_f32_16x16x32_bf16 v[48:51], a[128:131], v[160:163], v[200:203]
  buffer_load_dwordx4 v234, s[12:15], s29 offen offset:2048 lds
  v_exp_f32 v4, v4
  v_mfma_f32_16x16x32_bf16 v[48:51], a[132:135], v[164:167], v[48:51]
  v_add_f32 v211, v211, v27
  v_cvt_pk_bf16_f32 v25, v26, v27
  v_mfma_f32_16x16x32_bf16 v[48:51], a[136:139], v[168:171], v[48:51]
  buffer_load_dwordx4 v235, s[12:15], s29 offen offset:3072 lds
  v_exp_f32 v5, v5
  v_mfma_f32_16x16x32_bf16 v[48:51], a[140:143], v[172:175], v[48:51]
  v_add_f32 v208, v208, v4
  v_mfma_f32_16x16x32_bf16 v[56:59], a[140:143], v[188:191], v[204:207]
  v_exp_f32 v6, v6
  v_mfma_f32_16x16x32_bf16 v[56:59], a[136:139], v[184:187], v[56:59]
  v_add_f32 v208, v208, v5
  v_cvt_pk_bf16_f32 v2, v4, v5
  v_mfma_f32_16x16x32_bf16 v[56:59], a[132:135], v[180:183], v[56:59]
  v_exp_f32 v7, v7
  v_mfma_f32_16x16x32_bf16 v[56:59], a[128:131], v[176:179], v[56:59]
  s_waitcnt lgkmcnt(0)
  v_add_f32 v208, v208, v6
  v_mfma_f32_16x16x32_bf16 v[36:39], a[144:147], v[128:131], v[192:195]
  ds_read_b64_tr_b16 a[160:161], v216 offset:16384
  v_exp_f32 v12, v12
  v_mfma_f32_16x16x32_bf16 v[36:39], a[148:151], v[132:135], v[36:39]
  v_add_f32 v208, v208, v7
  v_cvt_pk_bf16_f32 v3, v6, v7
  v_mfma_f32_16x16x32_bf16 v[36:39], a[152:155], v[136:139], v[36:39]
  ds_read_b64_tr_b16 a[162:163], v216 offset:20480
  v_exp_f32 v13, v13
  v_mfma_f32_16x16x32_bf16 v[36:39], a[156:159], v[140:143], v[36:39]
  v_add_f32 v209, v209, v12
  v_mfma_f32_16x16x32_bf16 v[44:47], a[156:159], v[156:159], v[196:199]
  ds_read_b64_tr_b16 a[164:165], v216 offset:24576
  v_exp_f32 v14, v14
  v_mfma_f32_16x16x32_bf16 v[44:47], a[152:155], v[152:155], v[44:47]
  v_add_f32 v209, v209, v13
  v_cvt_pk_bf16_f32 v10, v12, v13
  v_mfma_f32_16x16x32_bf16 v[44:47], a[148:151], v[148:151], v[44:47]
  ds_read_b64_tr_b16 a[166:167], v216 offset:28672
  v_exp_f32 v15, v15
  v_mfma_f32_16x16x32_bf16 v[44:47], a[144:147], v[144:147], v[44:47]
  v_add_f32 v209, v209, v14
  v_mfma_f32_16x16x32_bf16 v[52:55], a[144:147], v[160:163], v[200:203]
  ds_read_b64_tr_b16 a[168:169], v217 offset:16384
  v_exp_f32 v20, v20
  v_mfma_f32_16x16x32_bf16 v[52:55], a[148:151], v[164:167], v[52:55]
  v_add_f32 v209, v209, v15
  v_cvt_pk_bf16_f32 v11, v14, v15
  v_mfma_f32_16x16x32_bf16 v[52:55], a[152:155], v[168:171], v[52:55]
  ds_read_b64_tr_b16 a[170:171], v217 offset:20480
  v_exp_f32 v21, v21
  v_mfma_f32_16x16x32_bf16 v[52:55], a[156:159], v[172:175], v[52:55]
  v_add_f32 v210, v210, v20
  v_mfma_f32_16x16x32_bf16 v[60:63], a[156:159], v[188:191], v[204:207]
  ds_read_b64_tr_b16 a[172:173], v217 offset:24576
  v_exp_f32 v22, v22
  v_mfma_f32_16x16x32_bf16 v[60:63], a[152:155], v[184:187], v[60:63]
  v_add_f32 v210, v210, v21
  v_cvt_pk_bf16_f32 v18, v20, v21
  v_mfma_f32_16x16x32_bf16 v[60:63], a[148:151], v[180:183], v[60:63]
  ds_read_b64_tr_b16 a[174:175], v217 offset:28672
  v_exp_f32 v23, v23
  v_mfma_f32_16x16x32_bf16 v[60:63], a[144:147], v[176:179], v[60:63]
  s_waitcnt lgkmcnt(4)
  v_add_f32 v210, v210, v22
  v_mfma_f32_16x16x32_bf16 a[0:3], a[160:163], v[64:67], a[0:3]
  ds_read_b64_tr_b16 a[176:177], v218 offset:16384
  v_exp_f32 v28, v28
  v_mfma_f32_16x16x32_bf16 a[0:3], a[164:167], v[96:99], a[0:3]
  v_add_f32 v210, v210, v23
  v_cvt_pk_bf16_f32 v19, v22, v23
  v_mfma_f32_16x16x32_bf16 a[4:7], a[164:167], v[104:107], a[4:7]
  ds_read_b64_tr_b16 a[178:179], v218 offset:20480
  v_exp_f32 v29, v29
  v_mfma_f32_16x16x32_bf16 a[4:7], a[160:163], v[72:75], a[4:7]
  v_add_f32 v211, v211, v28
  v_mfma_f32_16x16x32_bf16 a[8:11], a[160:163], v[80:83], a[8:11]
  ds_read_b64_tr_b16 a[180:181], v218 offset:24576
  v_exp_f32 v30, v30
  v_mfma_f32_16x16x32_bf16 a[8:11], a[164:167], v[112:115], a[8:11]
  v_add_f32 v211, v211, v29
  v_cvt_pk_bf16_f32 v26, v28, v29
  v_mfma_f32_16x16x32_bf16 a[12:15], a[164:167], v[120:123], a[12:15]
  ds_read_b64_tr_b16 a[182:183], v218 offset:28672
  v_exp_f32 v31, v31
  v_mfma_f32_16x16x32_bf16 a[12:15], a[160:163], v[88:91], a[12:15]
  s_waitcnt lgkmcnt(4)
  v_add_f32 v211, v211, v30
  v_mfma_f32_16x16x32_bf16 a[16:19], a[168:171], v[64:67], a[16:19]
  ds_read_b64_tr_b16 a[184:185], v219 offset:16384
  v_exp_f32 v32, v32
  v_mfma_f32_16x16x32_bf16 a[16:19], a[172:175], v[96:99], a[16:19]
  v_add_f32 v211, v211, v31
  v_cvt_pk_bf16_f32 v27, v30, v31
  v_mfma_f32_16x16x32_bf16 a[20:23], a[172:175], v[104:107], a[20:23]
  ds_read_b64_tr_b16 a[186:187], v219 offset:20480
  v_exp_f32 v33, v33
  v_mfma_f32_16x16x32_bf16 a[20:23], a[168:171], v[72:75], a[20:23]
  v_add_f32 v208, v208, v32
  v_mfma_f32_16x16x32_bf16 a[24:27], a[168:171], v[80:83], a[24:27]
  ds_read_b64_tr_b16 a[188:189], v219 offset:24576
  v_exp_f32 v34, v34
  v_mfma_f32_16x16x32_bf16 a[24:27], a[172:175], v[112:115], a[24:27]
  v_add_f32 v208, v208, v33
  v_cvt_pk_bf16_f32 v32, v32, v33
  v_mfma_f32_16x16x32_bf16 a[28:31], a[172:175], v[120:123], a[28:31]
  ds_read_b64_tr_b16 a[190:191], v219 offset:28672
  v_exp_f32 v35, v35
  v_mfma_f32_16x16x32_bf16 a[28:31], a[168:171], v[88:91], a[28:31]
  s_waitcnt lgkmcnt(4)
  v_add_f32 v208, v208, v34
  v_mfma_f32_16x16x32_bf16 a[32:35], a[176:179], v[64:67], a[32:35]
  ds_read_b64_tr_b16 a[160:161], v220 offset:16384
  v_exp_f32 v40, v40
  v_mfma_f32_16x16x32_bf16 a[32:35], a[180:183], v[96:99], a[32:35]
  v_add_f32 v208, v208, v35
  v_cvt_pk_bf16_f32 v33, v34, v35
  v_mfma_f32_16x16x32_bf16 a[36:39], a[180:183], v[104:107], a[36:39]
  ds_read_b64_tr_b16 a[162:163], v220 offset:20480
  v_exp_f32 v41, v41
  v_mfma_f32_16x16x32_bf16 a[36:39], a[176:179], v[72:75], a[36:39]
  v_add_f32 v209, v209, v40
  v_mfma_f32_16x16x32_bf16 a[40:43], a[176:179], v[80:83], a[40:43]
  ds_read_b64_tr_b16 a[164:165], v220 offset:24576
  v_exp_f32 v42, v42
  v_mfma_f32_16x16x32_bf16 a[40:43], a[180:183], v[112:115], a[40:43]
  v_add_f32 v209, v209, v41
  v_cvt_pk_bf16_f32 v40, v40, v41
  v_mfma_f32_16x16x32_bf16 a[44:47], a[180:183], v[120:123], a[44:47]
  ds_read_b64_tr_b16 a[166:167], v220 offset:28672
  v_exp_f32 v43, v43
  v_mfma_f32_16x16x32_bf16 a[44:47], a[176:179], v[88:91], a[44:47]
  s_waitcnt lgkmcnt(4)
  v_add_f32 v209, v209, v42
  v_mfma_f32_16x16x32_bf16 a[48:51], a[184:187], v[64:67], a[48:51]
  ds_read_b64_tr_b16 a[168:169], v221 offset:16384
  v_exp_f32 v48, v48
  v_mfma_f32_16x16x32_bf16 a[48:51], a[188:191], v[96:99], a[48:51]
  v_add_f32 v209, v209, v43
  v_cvt_pk_bf16_f32 v41, v42, v43
  v_mfma_f32_16x16x32_bf16 a[52:55], a[188:191], v[104:107], a[52:55]
  ds_read_b64_tr_b16 a[170:171], v221 offset:20480
  v_exp_f32 v49, v49
  v_mfma_f32_16x16x32_bf16 a[52:55], a[184:187], v[72:75], a[52:55]
  v_add_f32 v210, v210, v48
  v_mfma_f32_16x16x32_bf16 a[56:59], a[184:187], v[80:83], a[56:59]
  ds_read_b64_tr_b16 a[172:173], v221 offset:24576
  v_exp_f32 v50, v50
  v_mfma_f32_16x16x32_bf16 a[56:59], a[188:191], v[112:115], a[56:59]
  v_add_f32 v210, v210, v49
  v_cvt_pk_bf16_f32 v48, v48, v49
  v_mfma_f32_16x16x32_bf16 a[60:63], a[188:191], v[120:123], a[60:63]
  ds_read_b64_tr_b16 a[174:175], v221 offset:28672
  v_exp_f32 v51, v51
  v_mfma_f32_16x16x32_bf16 a[60:63], a[184:187], v[88:91], a[60:63]
  s_waitcnt lgkmcnt(4)
  v_add_f32 v210, v210, v50
  v_mfma_f32_16x16x32_bf16 a[64:67], a[160:163], v[64:67], a[64:67]
  ds_read_b64_tr_b16 a[176:177], v222 offset:16384
  v_exp_f32 v56, v56
  v_mfma_f32_16x16x32_bf16 a[64:67], a[164:167], v[96:99], a[64:67]
  v_add_f32 v210, v210, v51
  v_cvt_pk_bf16_f32 v49, v50, v51
  v_mfma_f32_16x16x32_bf16 a[68:71], a[164:167], v[104:107], a[68:71]
  ds_read_b64_tr_b16 a[178:179], v222 offset:20480
  v_exp_f32 v57, v57
  v_mfma_f32_16x16x32_bf16 a[68:71], a[160:163], v[72:75], a[68:71]
  v_add_f32 v211, v211, v56
  v_mfma_f32_16x16x32_bf16 a[72:75], a[160:163], v[80:83], a[72:75]
  ds_read_b64_tr_b16 a[180:181], v222 offset:24576
  v_exp_f32 v58, v58
  v_mfma_f32_16x16x32_bf16 a[72:75], a[164:167], v[112:115], a[72:75]
  v_add_f32 v211, v211, v57
  v_cvt_pk_bf16_f32 v56, v56, v57
  v_mfma_f32_16x16x32_bf16 a[76:79], a[164:167], v[120:123], a[76:79]
  ds_read_b64_tr_b16 a[182:183], v222 offset:28672
  v_exp_f32 v59, v59
  v_mfma_f32_16x16x32_bf16 a[76:79], a[160:163], v[88:91], a[76:79]
  s_waitcnt lgkmcnt(4)
  v_add_f32 v211, v211, v58
  v_mfma_f32_16x16x32_bf16 a[80:83], a[168:171], v[64:67], a[80:83]
  ds_read_b64_tr_b16 a[184:185], v223 offset:16384
  v_exp_f32 v36, v36
  v_mfma_f32_16x16x32_bf16 a[80:83], a[172:175], v[96:99], a[80:83]
  v_add_f32 v211, v211, v59
  v_cvt_pk_bf16_f32 v57, v58, v59
  v_mfma_f32_16x16x32_bf16 a[84:87], a[172:175], v[104:107], a[84:87]
  ds_read_b64_tr_b16 a[186:187], v223 offset:20480
  v_exp_f32 v37, v37
  v_mfma_f32_16x16x32_bf16 a[84:87], a[168:171], v[72:75], a[84:87]
  v_add_f32 v208, v208, v36
  v_mfma_f32_16x16x32_bf16 a[88:91], a[168:171], v[80:83], a[88:91]
  ds_read_b64_tr_b16 a[188:189], v223 offset:24576
  v_exp_f32 v38, v38
  v_mfma_f32_16x16x32_bf16 a[88:91], a[172:175], v[112:115], a[88:91]
  v_add_f32 v208, v208, v37
  v_cvt_pk_bf16_f32 v34, v36, v37
  v_mfma_f32_16x16x32_bf16 a[92:95], a[172:175], v[120:123], a[92:95]
  ds_read_b64_tr_b16 a[190:191], v223 offset:28672
  v_exp_f32 v39, v39
  v_mfma_f32_16x16x32_bf16 a[92:95], a[168:171], v[88:91], a[92:95]
  s_waitcnt lgkmcnt(4)
  v_add_f32 v208, v208, v38
  v_mfma_f32_16x16x32_bf16 a[96:99], a[176:179], v[64:67], a[96:99]
  s_waitcnt vmcnt(8)
  v_exp_f32 v44, v44
  v_mfma_f32_16x16x32_bf16 a[96:99], a[180:183], v[96:99], a[96:99]
  s_barrier
  v_add_f32 v208, v208, v39
  v_cvt_pk_bf16_f32 v35, v38, v39
  v_mfma_f32_16x16x32_bf16 a[100:103], a[180:183], v[104:107], a[100:103]
  ds_read_b128 a[128:131], v212 offset:49152
  v_exp_f32 v45, v45
  v_mfma_f32_16x16x32_bf16 a[100:103], a[176:179], v[72:75], a[100:103]
  v_add_f32 v209, v209, v44
  v_mfma_f32_16x16x32_bf16 a[104:107], a[176:179], v[80:83], a[104:107]
  ds_read_b128 a[132:135], v213 offset:49152
  v_exp_f32 v46, v46
  v_mfma_f32_16x16x32_bf16 a[104:107], a[180:183], v[112:115], a[104:107]
  v_add_f32 v209, v209, v45
  v_cvt_pk_bf16_f32 v42, v44, v45
  v_mfma_f32_16x16x32_bf16 a[108:111], a[180:183], v[120:123], a[108:111]
  ds_read_b128 a[136:139], v214 offset:49152
  v_exp_f32 v47, v47
  v_mfma_f32_16x16x32_bf16 a[108:111], a[176:179], v[88:91], a[108:111]
  s_waitcnt lgkmcnt(3)
  v_add_f32 v209, v209, v46
  v_mfma_f32_16x16x32_bf16 a[112:115], a[184:187], v[64:67], a[112:115]
  ds_read_b128 a[140:143], v215 offset:49152
  v_exp_f32 v52, v52
  v_mfma_f32_16x16x32_bf16 a[112:115], a[188:191], v[96:99], a[112:115]
  v_add_f32 v209, v209, v47
  v_cvt_pk_bf16_f32 v43, v46, v47
  v_mfma_f32_16x16x32_bf16 a[116:119], a[188:191], v[104:107], a[116:119]
  v_exp_f32 v53, v53
  v_mfma_f32_16x16x32_bf16 a[116:119], a[184:187], v[72:75], a[116:119]
  v_add_f32 v210, v210, v52
  v_mfma_f32_16x16x32_bf16 a[120:123], a[184:187], v[80:83], a[120:123]
  v_exp_f32 v54, v54
  v_mfma_f32_16x16x32_bf16 a[120:123], a[188:191], v[112:115], a[120:123]
  v_add_f32 v210, v210, v53
  v_cvt_pk_bf16_f32 v50, v52, v53
  v_mfma_f32_16x16x32_bf16 a[124:127], a[188:191], v[120:123], a[124:127]
  v_exp_f32 v55, v55
  v_mfma_f32_16x16x32_bf16 a[124:127], a[184:187], v[88:91], a[124:127]
  s_waitcnt lgkmcnt(0)
  v_add_f32 v210, v210, v54
  v_mfma_f32_16x16x32_bf16 v[64:67], a[128:131], v[128:131], v[192:195]
  ds_read_b128 a[144:147], v212 offset:53248
  v_exp_f32 v60, v60
  v_mfma_f32_16x16x32_bf16 v[64:67], a[132:135], v[132:135], v[64:67]
  v_add_f32 v210, v210, v55
  v_cvt_pk_bf16_f32 v51, v54, v55
  v_mfma_f32_16x16x32_bf16 v[64:67], a[136:139], v[136:139], v[64:67]
  ds_read_b128 a[148:151], v213 offset:53248
  v_exp_f32 v61, v61
  v_mfma_f32_16x16x32_bf16 v[64:67], a[140:143], v[140:143], v[64:67]
  v_add_f32 v211, v211, v60
  v_mfma_f32_16x16x32_bf16 v[72:75], a[140:143], v[156:159], v[196:199]
  ds_read_b128 a[152:155], v214 offset:53248
  v_exp_f32 v62, v62
  v_mfma_f32_16x16x32_bf16 v[72:75], a[136:139], v[152:155], v[72:75]
  v_add_f32 v211, v211, v61
  v_cvt_pk_bf16_f32 v58, v60, v61
  v_mfma_f32_16x16x32_bf16 v[72:75], a[132:135], v[148:151], v[72:75]
  ds_read_b128 a[156:159], v215 offset:53248
  v_exp_f32 v63, v63
  v_mfma_f32_16x16x32_bf16 v[72:75], a[128:131], v[144:147], v[72:75]
  v_add_f32 v211, v211, v62
  v_mfma_f32_16x16x32_bf16 v[80:83], a[128:131], v[160:163], v[200:203]
  s_add_u32 m0, s28, 65536
  v_exp_f32 v64, v64
  v_mfma_f32_16x16x32_bf16 v[80:83], a[132:135], v[164:167], v[80:83]
  buffer_load_dwordx4 v236, s[16:19], s29 offen offset:0 lds
  v_add_f32 v211, v211, v63
  v_cvt_pk_bf16_f32 v59, v62, v63
  v_mfma_f32_16x16x32_bf16 v[80:83], a[136:139], v[168:171], v[80:83]
  v_exp_f32 v65, v65
  v_mfma_f32_16x16x32_bf16 v[80:83], a[140:143], v[172:175], v[80:83]
  buffer_load_dwordx4 v237, s[16:19], s29 offen offset:1024 lds
  v_add_f32 v208, v208, v64
  v_mfma_f32_16x16x32_bf16 v[88:91], a[140:143], v[188:191], v[204:207]
  v_exp_f32 v66, v66
  v_mfma_f32_16x16x32_bf16 v[88:91], a[136:139], v[184:187], v[88:91]
  buffer_load_dwordx4 v236, s[16:19], s29 offen offset:2048 lds
  v_add_f32 v208, v208, v65
  v_cvt_pk_bf16_f32 v64, v64, v65
  v_mfma_f32_16x16x32_bf16 v[88:91], a[132:135], v[180:183], v[88:91]
  v_exp_f32 v67, v67
  v_mfma_f32_16x16x32_bf16 v[88:91], a[128:131], v[176:179], v[88:91]
  s_waitcnt lgkmcnt(0)
  v_add_f32 v208, v208, v66
  v_mfma_f32_16x16x32_bf16 v[68:71], a[144:147], v[128:131], v[192:195]
  ds_read_b128 a[128:131], v212 offset:57344
  v_exp_f32 v72, v72
  v_mfma_f32_16x16x32_bf16 v[68:71], a[148:151], v[132:135], v[68:71]
  v_add_f32 v208, v208, v67
  v_cvt_pk_bf16_f32 v65, v66, v67
  v_mfma_f32_16x16x32_bf16 v[68:71], a[152:155], v[136:139], v[68:71]
  ds_read_b128 a[132:135], v213 offset:57344
  v_exp_f32 v73, v73
  v_mfma_f32_16x16x32_bf16 v[68:71], a[156:159], v[140:143], v[68:71]
  v_add_f32 v209, v209, v72
  v_mfma_f32_16x16x32_bf16 v[76:79], a[156:159], v[156:159], v[196:199]
  ds_read_b128 a[136:139], v214 offset:57344
  v_exp_f32 v74, v74
  v_mfma_f32_16x16x32_bf16 v[76:79], a[152:155], v[152:155], v[76:79]
  v_add_f32 v209, v209, v73
  v_cvt_pk_bf16_f32 v72, v72, v73
  v_mfma_f32_16x16x32_bf16 v[76:79], a[148:151], v[148:151], v[76:79]
  ds_read_b128 a[140:143], v215 offset:57344
  v_exp_f32 v75, v75
  v_mfma_f32_16x16x32_bf16 v[76:79], a[144:147], v[144:147], v[76:79]
  v_add_f32 v209, v209, v74
  v_mfma_f32_16x16x32_bf16 v[84:87], a[144:147], v[160:163], v[200:203]
  buffer_load_dwordx4 v237, s[16:19], s29 offen offset:3072 lds
  v_exp_f32 v80, v80
  v_mfma_f32_16x16x32_bf16 v[84:87], a[148:151], v[164:167], v[84:87]
  s_add_u32 s29, s29, 16384
  v_add_f32 v209, v209, v75
  v_cvt_pk_bf16_f32 v73, v74, v75
  v_mfma_f32_16x16x32_bf16 v[84:87], a[152:155], v[168:171], v[84:87]
  s_add_u32 m0, s28, 16384
  v_exp_f32 v81, v81
  v_mfma_f32_16x16x32_bf16 v[84:87], a[156:159], v[172:175], v[84:87]
  buffer_load_dwordx4 v232, s[12:15], s29 offen offset:0 lds
  v_add_f32 v210, v210, v80
  v_mfma_f32_16x16x32_bf16 v[92:95], a[156:159], v[188:191], v[204:207]
  v_exp_f32 v82, v82
  v_mfma_f32_16x16x32_bf16 v[92:95], a[152:155], v[184:187], v[92:95]
  buffer_load_dwordx4 v233, s[12:15], s29 offen offset:1024 lds
  v_add_f32 v210, v210, v81
  v_cvt_pk_bf16_f32 v80, v80, v81
  v_mfma_f32_16x16x32_bf16 v[92:95], a[148:151], v[180:183], v[92:95]
  v_exp_f32 v83, v83
  v_mfma_f32_16x16x32_bf16 v[92:95], a[144:147], v[176:179], v[92:95]
  s_waitcnt lgkmcnt(0)
  v_add_f32 v210, v210, v82
  v_mfma_f32_16x16x32_bf16 v[96:99], a[128:131], v[128:131], v[192:195]
  ds_read_b128 a[144:147], v212 offset:61440
  v_exp_f32 v88, v88
  v_mfma_f32_16x16x32_bf16 v[96:99], a[132:135], v[132:135], v[96:99]
  v_add_f32 v210, v210, v83
  v_cvt_pk_bf16_f32 v81, v82, v83
  v_mfma_f32_16x16x32_bf16 v[96:99], a[136:139], v[136:139], v[96:99]
  ds_read_b128 a[148:151], v213 offset:61440
  v_exp_f32 v89, v89
  v_mfma_f32_16x16x32_bf16 v[96:99], a[140:143], v[140:143], v[96:99]
  v_add_f32 v211, v211, v88
  v_mfma_f32_16x16x32_bf16 v[104:107], a[140:143], v[156:159], v[196:199]
  ds_read_b128 a[152:155], v214 offset:61440
  v_exp_f32 v90, v90
  v_mfma_f32_16x16x32_bf16 v[104:107], a[136:139], v[152:155], v[104:107]
  v_add_f32 v211, v211, v89
  v_cvt_pk_bf16_f32 v88, v88, v89
  v_mfma_f32_16x16x32_bf16 v[104:107], a[132:135], v[148:151], v[104:107]
  ds_read_b128 a[156:159], v215 offset:61440
  v_exp_f32 v91, v91
  v_mfma_f32_16x16x32_bf16 v[104:107], a[128:131], v[144:147], v[104:107]
  v_add_f32 v211, v211, v90
  v_mfma_f32_16x16x32_bf16 v[112:115], a[128:131], v[160:163], v[200:203]
  buffer_load_dwordx4 v234, s[12:15], s29 offen offset:2048 lds
  v_exp_f32 v68, v68
  v_mfma_f32_16x16x32_bf16 v[112:115], a[132:135], v[164:167], v[112:115]
  v_add_f32 v211, v211, v91
  v_cvt_pk_bf16_f32 v89, v90, v91
  v_mfma_f32_16x16x32_bf16 v[112:115], a[136:139], v[168:171], v[112:115]
  buffer_load_dwordx4 v235, s[12:15], s29 offen offset:3072 lds
  v_exp_f32 v69, v69
  v_mfma_f32_16x16x32_bf16 v[112:115], a[140:143], v[172:175], v[112:115]
  v_add_f32 v208, v208, v68
  v_mfma_f32_16x16x32_bf16 v[120:123], a[140:143], v[188:191], v[204:207]
  v_exp_f32 v70, v70
  v_mfma_f32_16x16x32_bf16 v[120:123], a[136:139], v[184:187], v[120:123]
  v_add_f32 v208, v208, v69
  v_cvt_pk_bf16_f32 v66, v68, v69
  v_mfma_f32_16x16x32_bf16 v[120:123], a[132:135], v[180:183], v[120:123]
  v_exp_f32 v71, v71
  v_mfma_f32_16x16x32_bf16 v[120:123], a[128:131], v[176:179], v[120:123]
  s_waitcnt lgkmcnt(0)
  v_add_f32 v208, v208, v70
  v_mfma_f32_16x16x32_bf16 v[100:103], a[144:147], v[128:131], v[192:195]
  ds_read_b64_tr_b16 a[160:161], v216 offset:32768
  v_exp_f32 v76, v76
  v_mfma_f32_16x16x32_bf16 v[100:103], a[148:151], v[132:135], v[100:103]
  v_add_f32 v208, v208, v71
  v_cvt_pk_bf16_f32 v67, v70, v71
  v_mfma_f32_16x16x32_bf16 v[100:103], a[152:155], v[136:139], v[100:103]
  ds_read_b64_tr_b16 a[162:163], v216 offset:36864
  v_exp_f32 v77, v77
  v_mfma_f32_16x16x32_bf16 v[100:103], a[156:159], v[140:143], v[100:103]
  v_add_f32 v209, v209, v76
  v_mfma_f32_16x16x32_bf16 v[108:111], a[156:159], v[156:159], v[196:199]
  ds_read_b64_tr_b16 a[164:165], v216 offset:40960
  v_exp_f32 v78, v78
  v_mfma_f32_16x16x32_bf16 v[108:111], a[152:155], v[152:155], v[108:111]
  v_add_f32 v209, v209, v77
  v_cvt_pk_bf16_f32 v74, v76, v77
  v_mfma_f32_16x16x32_bf16 v[108:111], a[148:151], v[148:151], v[108:111]
  ds_read_b64_tr_b16 a[166:167], v216 offset:45056
  v_exp_f32 v79, v79
  v_mfma_f32_16x16x32_bf16 v[108:111], a[144:147], v[144:147], v[108:111]
  v_add_f32 v209, v209, v78
  v_mfma_f32_16x16x32_bf16 v[116:119], a[144:147], v[160:163], v[200:203]
  ds_read_b64_tr_b16 a[168:169], v217 offset:32768
  v_exp_f32 v84, v84
  v_mfma_f32_16x16x32_bf16 v[116:119], a[148:151], v[164:167], v[116:119]
  v_add_f32 v209, v209, v79
  v_cvt_pk_bf16_f32 v75, v78, v79
  v_mfma_f32_16x16x32_bf16 v[116:119], a[152:155], v[168:171], v[116:119]
  ds_read_b64_tr_b16 a[170:171], v217 offset:36864
  v_exp_f32 v85, v85
  v_mfma_f32_16x16x32_bf16 v[116:119], a[156:159], v[172:175], v[116:119]
  v_add_f32 v210, v210, v84
  v_mfma_f32_16x16x32_bf16 v[124:127], a[156:159], v[188:191], v[204:207]
  ds_read_b64_tr_b16 a[172:173], v217 offset:40960
  v_exp_f32 v86, v86
  v_mfma_f32_16x16x32_bf16 v[124:127], a[152:155], v[184:187], v[124:127]
  v_add_f32 v210, v210, v85
  v_cvt_pk_bf16_f32 v82, v84, v85
  v_mfma_f32_16x16x32_bf16 v[124:127], a[148:151], v[180:183], v[124:127]
  ds_read_b64_tr_b16 a[174:175], v217 offset:45056
  v_exp_f32 v87, v87
  v_mfma_f32_16x16x32_bf16 v[124:127], a[144:147], v[176:179], v[124:127]
  s_waitcnt lgkmcnt(4)
  v_add_f32 v210, v210, v86
  v_mfma_f32_16x16x32_bf16 a[0:3], a[160:163], v[0:3], a[0:3]
  ds_read_b64_tr_b16 a[176:177], v218 offset:32768
  v_exp_f32 v92, v92
  v_mfma_f32_16x16x32_bf16 a[0:3], a[164:167], v[32:35], a[0:3]
  v_add_f32 v210, v210, v87
  v_cvt_pk_bf16_f32 v83, v86, v87
  v_mfma_f32_16x16x32_bf16 a[4:7], a[164:167], v[40:43], a[4:7]
  ds_read_b64_tr_b16 a[178:179], v218 offset:36864
  v_exp_f32 v93, v93
  v_mfma_f32_16x16x32_bf16 a[4:7], a[160:163], v[8:11], a[4:7]
  v_add_f32 v211, v211, v92
  v_mfma_f32_16x16x32_bf16 a[8:11], a[160:163], v[16:19], a[8:11]
  ds_read_b64_tr_b16 a[180:181], v218 offset:40960
  v_exp_f32 v94, v94
  v_mfma_f32_16x16x32_bf16 a[8:11], a[164:167], v[48:51], a[8:11]
  v_add_f32 v211, v211, v93
  v_cvt_pk_bf16_f32 v90, v92, v93
  v_mfma_f32_16x16x32_bf16 a[12:15], a[164:167], v[56:59], a[12:15]
  ds_read_b64_tr_b16 a[182:183], v218 offset:45056
  v_exp_f32 v95, v95
  v_mfma_f32_16x16x32_bf16 a[12:15], a[160:163], v[24:27], a[12:15]
  s_waitcnt lgkmcnt(4)
  v_add_f32 v211, v211, v94
  v_mfma_f32_16x16x32_bf16 a[16:19], a[168:171], v[0:3], a[16:19]
  ds_read_b64_tr_b16 a[184:185], v219 offset:32768
  v_exp_f32 v96, v96
  v_mfma_f32_16x16x32_bf16 a[16:19], a[172:175], v[32:35], a[16:19]
  v_add_f32 v211, v211, v95
  v_cvt_pk_bf16_f32 v91, v94, v95
  v_mfma_f32_16x16x32_bf16 a[20:23], a[172:175], v[40:43], a[20:23]
  ds_read_b64_tr_b16 a[186:187], v219 offset:36864
  v_exp_f32 v97, v97
  v_mfma_f32_16x16x32_bf16 a[20:23], a[168:171], v[8:11], a[20:23]
  v_add_f32 v208, v208, v96
  v_mfma_f32_16x16x32_bf16 a[24:27], a[168:171], v[16:19], a[24:27]
  ds_read_b64_tr_b16 a[188:189], v219 offset:40960
  v_exp_f32 v98, v98
  v_mfma_f32_16x16x32_bf16 a[24:27], a[172:175], v[48:51], a[24:27]
  v_add_f32 v208, v208, v97
  v_cvt_pk_bf16_f32 v96, v96, v97
  v_mfma_f32_16x16x32_bf16 a[28:31], a[172:175], v[56:59], a[28:31]
  ds_read_b64_tr_b16 a[190:191], v219 offset:45056
  v_exp_f32 v99, v99
  v_mfma_f32_16x16x32_bf16 a[28:31], a[168:171], v[24:27], a[28:31]
  s_waitcnt lgkmcnt(4)
  v_add_f32 v208, v208, v98
  v_mfma_f32_16x16x32_bf16 a[32:35], a[176:179], v[0:3], a[32:35]
  ds_read_b64_tr_b16 a[160:161], v220 offset:32768
  v_exp_f32 v104, v104
  v_mfma_f32_16x16x32_bf16 a[32:35], a[180:183], v[32:35], a[32:35]
  v_add_f32 v208, v208, v99
  v_cvt_pk_bf16_f32 v97, v98, v99
  v_mfma_f32_16x16x32_bf16 a[36:39], a[180:183], v[40:43], a[36:39]
  ds_read_b64_tr_b16 a[162:163], v220 offset:36864
  v_exp_f32 v105, v105
  v_mfma_f32_16x16x32_bf16 a[36:39], a[176:179], v[8:11], a[36:39]
  v_add_f32 v209, v209, v104
  v_mfma_f32_16x16x32_bf16 a[40:43], a[176:179], v[16:19], a[40:43]
  ds_read_b64_tr_b16 a[164:165], v220 offset:40960
  v_exp_f32 v106, v106
  v_mfma_f32_16x16x32_bf16 a[40:43], a[180:183], v[48:51], a[40:43]
  v_add_f32 v209, v209, v105
  v_cvt_pk_bf16_f32 v104, v104, v105
  v_mfma_f32_16x16x32_bf16 a[44:47], a[180:183], v[56:59], a[44:47]
  ds_read_b64_tr_b16 a[166:167], v220 offset:45056
  v_exp_f32 v107, v107
  v_mfma_f32_16x16x32_bf16 a[44:47], a[176:179], v[24:27], a[44:47]
  s_waitcnt lgkmcnt(4)
  v_add_f32 v209, v209, v106
  v_mfma_f32_16x16x32_bf16 a[48:51], a[184:187], v[0:3], a[48:51]
  ds_read_b64_tr_b16 a[168:169], v221 offset:32768
  v_exp_f32 v112, v112
  v_mfma_f32_16x16x32_bf16 a[48:51], a[188:191], v[32:35], a[48:51]
  v_add_f32 v209, v209, v107
  v_cvt_pk_bf16_f32 v105, v106, v107
  v_mfma_f32_16x16x32_bf16 a[52:55], a[188:191], v[40:43], a[52:55]
  ds_read_b64_tr_b16 a[170:171], v221 offset:36864
  v_exp_f32 v113, v113
  v_mfma_f32_16x16x32_bf16 a[52:55], a[184:187], v[8:11], a[52:55]
  v_add_f32 v210, v210, v112
  v_mfma_f32_16x16x32_bf16 a[56:59], a[184:187], v[16:19], a[56:59]
  ds_read_b64_tr_b16 a[172:173], v221 offset:40960
  v_exp_f32 v114, v114
  v_mfma_f32_16x16x32_bf16 a[56:59], a[188:191], v[48:51], a[56:59]
  v_add_f32 v210, v210, v113
  v_cvt_pk_bf16_f32 v112, v112, v113
  v_mfma_f32_16x16x32_bf16 a[60:63], a[188:191], v[56:59], a[60:63]
  ds_read_b64_tr_b16 a[174:175], v221 offset:45056
  v_exp_f32 v115, v115
  v_mfma_f32_16x16x32_bf16 a[60:63], a[184:187], v[24:27], a[60:63]
  s_waitcnt lgkmcnt(4)
  v_add_f32 v210, v210, v114
  v_mfma_f32_16x16x32_bf16 a[64:67], a[160:163], v[0:3], a[64:67]
  ds_read_b64_tr_b16 a[176:177], v222 offset:32768
  v_exp_f32 v120, v120
  v_mfma_f32_16x16x32_bf16 a[64:67], a[164:167], v[32:35], a[64:67]
  v_add_f32 v210, v210, v115
  v_cvt_pk_bf16_f32 v113, v114, v115
  v_mfma_f32_16x16x32_bf16 a[68:71], a[164:167], v[40:43], a[68:71]
  ds_read_b64_tr_b16 a[178:179], v222 offset:36864
  v_exp_f32 v121, v121
  v_mfma_f32_16x16x32_bf16 a[68:71], a[160:163], v[8:11], a[68:71]
  v_add_f32 v211, v211, v120
  v_mfma_f32_16x16x32_bf16 a[72:75], a[160:163], v[16:19], a[72:75]
  ds_read_b64_tr_b16 a[180:181], v222 offset:40960
  v_exp_f32 v122, v122
  v_mfma_f32_16x16x32_bf16 a[72:75], a[164:167], v[48:51], a[72:75]
  v_add_f32 v211, v211, v121
  v_cvt_pk_bf16_f32 v120, v120, v121
  v_mfma_f32_16x16x32_bf16 a[76:79], a[164:167], v[56:59], a[76:79]
  ds_read_b64_tr_b16 a[182:183], v222 offset:45056
  v_exp_f32 v123, v123
  v_mfma_f32_16x16x32_bf16 a[76:79], a[160:163], v[24:27], a[76:79]
  s_waitcnt lgkmcnt(4)
  v_add_f32 v211, v211, v122
  v_mfma_f32_16x16x32_bf16 a[80:83], a[168:171], v[0:3], a[80:83]
  ds_read_b64_tr_b16 a[184:185], v223 offset:32768
  v_exp_f32 v100, v100
  v_mfma_f32_16x16x32_bf16 a[80:83], a[172:175], v[32:35], a[80:83]
  v_add_f32 v211, v211, v123
  v_cvt_pk_bf16_f32 v121, v122, v123
  v_mfma_f32_16x16x32_bf16 a[84:87], a[172:175], v[40:43], a[84:87]
  ds_read_b64_tr_b16 a[186:187], v223 offset:36864
  v_exp_f32 v101, v101
  v_mfma_f32_16x16x32_bf16 a[84:87], a[168:171], v[8:11], a[84:87]
  v_add_f32 v208, v208, v100
  v_mfma_f32_16x16x32_bf16 a[88:91], a[168:171], v[16:19], a[88:91]
  ds_read_b64_tr_b16 a[188:189], v223 offset:40960
  v_exp_f32 v102, v102
  v_mfma_f32_16x16x32_bf16 a[88:91], a[172:175], v[48:51], a[88:91]
  v_add_f32 v208, v208, v101
  v_cvt_pk_bf16_f32 v98, v100, v101
  v_mfma_f32_16x16x32_bf16 a[92:95], a[172:175], v[56:59], a[92:95]
  ds_read_b64_tr_b16 a[190:191], v223 offset:45056
  v_exp_f32 v103, v103
  v_mfma_f32_16x16x32_bf16 a[92:95], a[168:171], v[24:27], a[92:95]
  s_waitcnt lgkmcnt(4)
  v_add_f32 v208, v208, v102
  v_mfma_f32_16x16x32_bf16 a[96:99], a[176:179], v[0:3], a[96:99]
  s_waitcnt vmcnt(8)
  v_exp_f32 v108, v108
  v_mfma_f32_16x16x32_bf16 a[96:99], a[180:183], v[32:35], a[96:99]
  s_barrier
  v_add_f32 v208, v208, v103
  v_cvt_pk_bf16_f32 v99, v102, v103
  v_mfma_f32_16x16x32_bf16 a[100:103], a[180:183], v[40:43], a[100:103]
  ds_read_b128 a[128:131], v212 offset:0
  v_exp_f32 v109, v109
  v_mfma_f32_16x16x32_bf16 a[100:103], a[176:179], v[8:11], a[100:103]
  v_add_f32 v209, v209, v108
  v_mfma_f32_16x16x32_bf16 a[104:107], a[176:179], v[16:19], a[104:107]
  ds_read_b128 a[132:135], v213 offset:0
  v_exp_f32 v110, v110
  v_mfma_f32_16x16x32_bf16 a[104:107], a[180:183], v[48:51], a[104:107]
  v_add_f32 v209, v209, v109
  v_cvt_pk_bf16_f32 v106, v108, v109
  v_mfma_f32_16x16x32_bf16 a[108:111], a[180:183], v[56:59], a[108:111]
  ds_read_b128 a[136:139], v214 offset:0
  v_exp_f32 v111, v111
  v_mfma_f32_16x16x32_bf16 a[108:111], a[176:179], v[24:27], a[108:111]
  s_waitcnt lgkmcnt(3)
  v_add_f32 v209, v209, v110
  v_mfma_f32_16x16x32_bf16 a[112:115], a[184:187], v[0:3], a[112:115]
  ds_read_b128 a[140:143], v215 offset:0
  v_exp_f32 v116, v116
  v_mfma_f32_16x16x32_bf16 a[112:115], a[188:191], v[32:35], a[112:115]
  v_add_f32 v209, v209, v111
  v_cvt_pk_bf16_f32 v107, v110, v111
  v_mfma_f32_16x16x32_bf16 a[116:119], a[188:191], v[40:43], a[116:119]
  v_exp_f32 v117, v117
  v_mfma_f32_16x16x32_bf16 a[116:119], a[184:187], v[8:11], a[116:119]
  v_add_f32 v210, v210, v116
  v_mfma_f32_16x16x32_bf16 a[120:123], a[184:187], v[16:19], a[120:123]
  v_exp_f32 v118, v118
  v_mfma_f32_16x16x32_bf16 a[120:123], a[188:191], v[48:51], a[120:123]
  v_add_f32 v210, v210, v117
  v_cvt_pk_bf16_f32 v114, v116, v117
  v_mfma_f32_16x16x32_bf16 a[124:127], a[188:191], v[56:59], a[124:127]
  v_exp_f32 v119, v119
  v_mfma_f32_16x16x32_bf16 a[124:127], a[184:187], v[24:27], a[124:127]
  s_waitcnt lgkmcnt(0)
  v_add_f32 v210, v210, v118
  s_mov_b32 s32, 7
attn_loop:
  v_mfma_f32_16x16x32_bf16 v[0:3], a[128:131], v[128:131], v[192:195]
  ds_read_b128 a[144:147], v212 offset:4096
  v_exp_f32 v124, v124
  v_mfma_f32_16x16x32_bf16 v[0:3], a[132:135], v[132:135], v[0:3]
  v_add_f32 v210, v210, v119
  v_cvt_pk_bf16_f32 v115, v118, v119
  v_mfma_f32_16x16x32_bf16 v[0:3], a[136:139], v[136:139], v[0:3]
  ds_read_b128 a[148:151], v213 offset:4096
  v_exp_f32 v125, v125
  v_mfma_f32_16x16x32_bf16 v[0:3], a[140:143], v[140:143], v[0:3]
  v_add_f32 v211, v211, v124
  v_mfma_f32_16x16x32_bf16 v[8:11], a[140:143], v[156:159], v[196:199]
  ds_read_b128 a[152:155], v214 offset:4096
  v_exp_f32 v126, v126
  v_mfma_f32_16x16x32_bf16 v[8:11], a[136:139], v[152:155], v[8:11]
  v_add_f32 v211, v211, v125
  v_cvt_pk_bf16_f32 v122, v124, v125
  v_mfma_f32_16x16x32_bf16 v[8:11], a[132:135], v[148:151], v[8:11]
  ds_read_b128 a[156:159], v215 offset:4096
  v_exp_f32 v127, v127
  v_mfma_f32_16x16x32_bf16 v[8:11], a[128:131], v[144:147], v[8:11]
  v_add_f32 v211, v211, v126
  v_mfma_f32_16x16x32_bf16 v[16:19], a[128:131], v[160:163], v[200:203]
  s_add_u32 m0, s28, 81920
  v_exp_f32 v0, v0
  v_mfma_f32_16x16x32_bf16 v[16:19], a[132:135], v[164:167], v[16:19]
  buffer_load_dwordx4 v236, s[16:19], s29 offen offset:0 lds
  v_add_f32 v211, v211, v127
  v_cvt_pk_bf16_f32 v123, v126, v127
  v_mfma_f32_16x16x32_bf16 v[16:19], a[136:139], v[168:171], v[16:19]
  v_exp_f32 v1, v1
  v_mfma_f32_16x16x32_bf16 v[16:19], a[140:143], v[172:175], v[16:19]
  buffer_load_dwordx4 v237, s[16:19], s29 offen offset:1024 lds
  v_add_f32 v208, v208, v0
  v_mfma_f32_16x16x32_bf16 v[24:27], a[140:143], v[188:191], v[204:207]
  v_exp_f32 v2, v2
  v_mfma_f32_16x16x32_bf16 v[24:27], a[136:139], v[184:187], v[24:27]
  buffer_load_dwordx4 v236, s[16:19], s29 offen offset:2048 lds
  v_add_f32 v208, v208, v1
  v_cvt_pk_bf16_f32 v0, v0, v1
  v_mfma_f32_16x16x32_bf16 v[24:27], a[132:135], v[180:183], v[24:27]
  v_exp_f32 v3, v3
  v_mfma_f32_16x16x32_bf16 v[24:27], a[128:131], v[176:179], v[24:27]
  s_waitcnt lgkmcnt(0)
  v_add_f32 v208, v208, v2
  v_mfma_f32_16x16x32_bf16 v[4:7], a[144:147], v[128:131], v[192:195]
  ds_read_b128 a[128:131], v212 offset:8192
  v_exp_f32 v8, v8
  v_mfma_f32_16x16x32_bf16 v[4:7], a[148:151], v[132:135], v[4:7]
  v_add_f32 v208, v208, v3
  v_cvt_pk_bf16_f32 v1, v2, v3
  v_mfma_f32_16x16x32_bf16 v[4:7], a[152:155], v[136:139], v[4:7]
  ds_read_b128 a[132:135], v213 offset:8192
  v_exp_f32 v9, v9
  v_mfma_f32_16x16x32_bf16 v[4:7], a[156:159], v[140:143], v[4:7]
  v_add_f32 v209, v209, v8
  v_mfma_f32_16x16x32_bf16 v[12:15], a[156:159], v[156:159], v[196:199]
  ds_read_b128 a[136:139], v214 offset:8192
  v_exp_f32 v10, v10
  v_mfma_f32_16x16x32_bf16 v[12:15], a[152:155], v[152:155], v[12:15]
  v_add_f32 v209, v209, v9
  v_cvt_pk_bf16_f32 v8, v8, v9
  v_mfma_f32_16x16x32_bf16 v[12:15], a[148:151], v[148:151], v[12:15]
  ds_read_b128 a[140:143], v215 offset:8192
  v_exp_f32 v11, v11
  v_mfma_f32_16x16x32_bf16 v[12:15], a[144:147], v[144:147], v[12:15]
  v_add_f32 v209, v209, v10
  v_mfma_f32_16x16x32_bf16 v[20:23], a[144:147], v[160:163], v[200:203]
  buffer_load_dwordx4 v237, s[16:19], s29 offen offset:3072 lds
  v_exp_f32 v16, v16
  v_mfma_f32_16x16x32_bf16 v[20:23], a[148:151], v[164:167], v[20:23]
  s_add_u32 s29, s29, 16384
  v_add_f32 v209, v209, v11
  v_cvt_pk_bf16_f32 v9, v10, v11
  v_mfma_f32_16x16x32_bf16 v[20:23], a[152:155], v[168:171], v[20:23]
  s_add_u32 m0, s28, 32768
  v_exp_f32 v17, v17
  v_mfma_f32_16x16x32_bf16 v[20:23], a[156:159], v[172:175], v[20:23]
  buffer_load_dwordx4 v232, s[12:15], s29 offen offset:0 lds
  v_add_f32 v210, v210, v16
  v_mfma_f32_16x16x32_bf16 v[28:31], a[156:159], v[188:191], v[204:207]
  v_exp_f32 v18, v18
  v_mfma_f32_16x16x32_bf16 v[28:31], a[152:155], v[184:187], v[28:31]
  buffer_load_dwordx4 v233, s[12:15], s29 offen offset:1024 lds
  v_add_f32 v210, v210, v17
  v_cvt_pk_bf16_f32 v16, v16, v17
  v_mfma_f32_16x16x32_bf16 v[28:31], a[148:151], v[180:183], v[28:31]
  v_exp_f32 v19, v19
  v_mfma_f32_16x16x32_bf16 v[28:31], a[144:147], v[176:179], v[28:31]
  s_waitcnt lgkmcnt(0)
  v_add_f32 v210, v210, v18
  v_mfma_f32_16x16x32_bf16 v[32:35], a[128:131], v[128:131], v[192:195]
  ds_read_b128 a[144:147], v212 offset:12288
  v_exp_f32 v24, v24
  v_mfma_f32_16x16x32_bf16 v[32:35], a[132:135], v[132:135], v[32:35]
  v_add_f32 v210, v210, v19
  v_cvt_pk_bf16_f32 v17, v18, v19
  v_mfma_f32_16x16x32_bf16 v[32:35], a[136:139], v[136:139], v[32:35]
  ds_read_b128 a[148:151], v213 offset:12288
  v_exp_f32 v25, v25
  v_mfma_f32_16x16x32_bf16 v[32:35], a[140:143], v[140:143], v[32:35]
  v_add_f32 v211, v211, v24
  v_mfma_f32_16x16x32_bf16 v[40:43], a[140:143], v[156:159], v[196:199]
  ds_read_b128 a[152:155], v214 offset:12288
  v_exp_f32 v26, v26
  v_mfma_f32_16x16x32_bf16 v[40:43], a[136:139], v[152:155], v[40:43]
  v_add_f32 v211, v211, v25
  v_cvt_pk_bf16_f32 v24, v24, v25
  v_mfma_f32_16x16x32_bf16 v[40:43], a[132:135], v[148:151], v[40:43]
  ds_read_b128 a[156:159], v215 offset:12288
  v_exp_f32 v27, v27
  v_mfma_f32_16x16x32_bf16 v[40:43], a[128:131], v[144:147], v[40:43]
  v_add_f32 v211, v211, v26
  v_mfma_f32_16x16x32_bf16 v[48:51], a[128:131], v[160:163], v[200:203]
  buffer_load_dwordx4 v234, s[12:15], s29 offen offset:2048 lds
  v_exp_f32 v4, v4
  v_mfma_f32_16x16x32_bf16 v[48:51], a[132:135], v[164:167], v[48:51]
  v_add_f32 v211, v211, v27
  v_cvt_pk_bf16_f32 v25, v26, v27
  v_mfma_f32_16x16x32_bf16 v[48:51], a[136:139], v[168:171], v[48:51]
  buffer_load_dwordx4 v235, s[12:15], s29 offen offset:3072 lds
  v_exp_f32 v5, v5
  v_mfma_f32_16x16x32_bf16 v[48:51], a[140:143], v[172:175], v[48:51]
  v_add_f32 v208, v208, v4
  v_mfma_f32_16x16x32_bf16 v[56:59], a[140:143], v[188:191], v[204:207]
  v_exp_f32 v6, v6
  v_mfma_f32_16x16x32_bf16 v[56:59], a[136:139], v[184:187], v[56:59]
  v_add_f32 v208, v208, v5
  v_cvt_pk_bf16_f32 v2, v4, v5
  v_mfma_f32_16x16x32_bf16 v[56:59], a[132:135], v[180:183], v[56:59]
  v_exp_f32 v7, v7
  v_mfma_f32_16x16x32_bf16 v[56:59], a[128:131], v[176:179], v[56:59]
  s_waitcnt lgkmcnt(0)
  v_add_f32 v208, v208, v6
  v_mfma_f32_16x16x32_bf16 v[36:39], a[144:147], v[128:131], v[192:195]
  ds_read_b64_tr_b16 a[160:161], v216 offset:49152
  v_exp_f32 v12, v12
  v_mfma_f32_16x16x32_bf16 v[36:39], a[148:151], v[132:135], v[36:39]
  v_add_f32 v208, v208, v7
  v_cvt_pk_bf16_f32 v3, v6, v7
  v_mfma_f32_16x16x32_bf16 v[36:39], a[152:155], v[136:139], v[36:39]
  ds_read_b64_tr_b16 a[162:163], v216 offset:53248
  v_exp_f32 v13, v13
  v_mfma_f32_16x16x32_bf16 v[36:39], a[156:159], v[140:143], v[36:39]
  v_add_f32 v209, v209, v12
  v_mfma_f32_16x16x32_bf16 v[44:47], a[156:159], v[156:159], v[196:199]
  ds_read_b64_tr_b16 a[164:165], v216 offset:57344
  v_exp_f32 v14, v14
  v_mfma_f32_16x16x32_bf16 v[44:47], a[152:155], v[152:155], v[44:47]
  v_add_f32 v209, v209, v13
  v_cvt_pk_bf16_f32 v10, v12, v13
  v_mfma_f32_16x16x32_bf16 v[44:47], a[148:151], v[148:151], v[44:47]
  ds_read_b64_tr_b16 a[166:167], v216 offset:61440
  v_exp_f32 v15, v15
  v_mfma_f32_16x16x32_bf16 v[44:47], a[144:147], v[144:147], v[44:47]
  v_add_f32 v209, v209, v14
  v_mfma_f32_16x16x32_bf16 v[52:55], a[144:147], v[160:163], v[200:203]
  ds_read_b64_tr_b16 a[168:169], v217 offset:49152
  v_exp_f32 v20, v20
  v_mfma_f32_16x16x32_bf16 v[52:55], a[148:151], v[164:167], v[52:55]
  v_add_f32 v209, v209, v15
  v_cvt_pk_bf16_f32 v11, v14, v15
  v_mfma_f32_16x16x32_bf16 v[52:55], a[152:155], v[168:171], v[52:55]
  ds_read_b64_tr_b16 a[170:171], v217 offset:53248
  v_exp_f32 v21, v21
  v_mfma_f32_16x16x32_bf16 v[52:55], a[156:159], v[172:175], v[52:55]
  v_add_f32 v210, v210, v20
  v_mfma_f32_16x16x32_bf16 v[60:63], a[156:159], v[188:191], v[204:207]
  ds_read_b64_tr_b16 a[172:173], v217 offset:57344
  v_exp_f32 v22, v22
  v_mfma_f32_16x16x32_bf16 v[60:63], a[152:155], v[184:187], v[60:63]
  v_add_f32 v210, v210, v21
  v_cvt_pk_bf16_f32 v18, v20, v21
  v_mfma_f32_16x16x32_bf16 v[60:63], a[148:151], v[180:183], v[60:63]
  ds_read_b64_tr_b16 a[174:175], v217 offset:61440
  v_exp_f32 v23, v23
  v_mfma_f32_16x16x32_bf16 v[60:63], a[144:147], v[176:179], v[60:63]
  s_waitcnt lgkmcnt(4)
  v_add_f32 v210, v210, v22
  v_mfma_f32_16x16x32_bf16 a[0:3], a[160:163], v[64:67], a[0:3]
  ds_read_b64_tr_b16 a[176:177], v218 offset:49152
  v_exp_f32 v28, v28
  v_mfma_f32_16x16x32_bf16 a[0:3], a[164:167], v[96:99], a[0:3]
  v_add_f32 v210, v210, v23
  v_cvt_pk_bf16_f32 v19, v22, v23
  v_mfma_f32_16x16x32_bf16 a[4:7], a[164:167], v[104:107], a[4:7]
  ds_read_b64_tr_b16 a[178:179], v218 offset:53248
  v_exp_f32 v29, v29
  v_mfma_f32_16x16x32_bf16 a[4:7], a[160:163], v[72:75], a[4:7]
  v_add_f32 v211, v211, v28
  v_mfma_f32_16x16x32_bf16 a[8:11], a[160:163], v[80:83], a[8:11]
  ds_read_b64_tr_b16 a[180:181], v218 offset:57344
  v_exp_f32 v30, v30
  v_mfma_f32_16x16x32_bf16 a[8:11], a[164:167], v[112:115], a[8:11]
  v_add_f32 v211, v211, v29
  v_cvt_pk_bf16_f32 v26, v28, v29
  v_mfma_f32_16x16x32_bf16 a[12:15], a[164:167], v[120:123], a[12:15]
  ds_read_b64_tr_b16 a[182:183], v218 offset:61440
  v_exp_f32 v31, v31
  v_mfma_f32_16x16x32_bf16 a[12:15], a[160:163], v[88:91], a[12:15]
  s_waitcnt lgkmcnt(4)
  v_add_f32 v211, v211, v30
  v_mfma_f32_16x16x32_bf16 a[16:19], a[168:171], v[64:67], a[16:19]
  ds_read_b64_tr_b16 a[184:185], v219 offset:49152
  v_exp_f32 v32, v32
  v_mfma_f32_16x16x32_bf16 a[16:19], a[172:175], v[96:99], a[16:19]
  v_add_f32 v211, v211, v31
  v_cvt_pk_bf16_f32 v27, v30, v31
  v_mfma_f32_16x16x32_bf16 a[20:23], a[172:175], v[104:107], a[20:23]
  ds_read_b64_tr_b16 a[186:187], v219 offset:53248
  v_exp_f32 v33, v33
  v_mfma_f32_16x16x32_bf16 a[20:23], a[168:171], v[72:75], a[20:23]
  v_add_f32 v208, v208, v32
  v_mfma_f32_16x16x32_bf16 a[24:27], a[168:171], v[80:83], a[24:27]
  ds_read_b64_tr_b16 a[188:189], v219 offset:57344
  v_exp_f32 v34, v34
  v_mfma_f32_16x16x32_bf16 a[24:27], a[172:175], v[112:115], a[24:27]
  v_add_f32 v208, v208, v33
  v_cvt_pk_bf16_f32 v32, v32, v33
  v_mfma_f32_16x16x32_bf16 a[28:31], a[172:175], v[120:123], a[28:31]
  ds_read_b64_tr_b16 a[190:191], v219 offset:61440
  v_exp_f32 v35, v35
  v_mfma_f32_16x16x32_bf16 a[28:31], a[168:171], v[88:91], a[28:31]
  s_waitcnt lgkmcnt(4)
  v_add_f32 v208, v208, v34
  v_mfma_f32_16x16x32_bf16 a[32:35], a[176:179], v[64:67], a[32:35]
  ds_read_b64_tr_b16 a[160:161], v220 offset:49152
  v_exp_f32 v40, v40
  v_mfma_f32_16x16x32_bf16 a[32:35], a[180:183], v[96:99], a[32:35]
  v_add_f32 v208, v208, v35
  v_cvt_pk_bf16_f32 v33, v34, v35
  v_mfma_f32_16x16x32_bf16 a[36:39], a[180:183], v[104:107], a[36:39]
  ds_read_b64_tr_b16 a[162:163], v220 offset:53248
  v_exp_f32 v41, v41
  v_mfma_f32_16x16x32_bf16 a[36:39], a[176:179], v[72:75], a[36:39]
  v_add_f32 v209, v209, v40
  v_mfma_f32_16x16x32_bf16 a[40:43], a[176:179], v[80:83], a[40:43]
  ds_read_b64_tr_b16 a[164:165], v220 offset:57344
  v_exp_f32 v42, v42
  v_mfma_f32_16x16x32_bf16 a[40:43], a[180:183], v[112:115], a[40:43]
  v_add_f32 v209, v209, v41
  v_cvt_pk_bf16_f32 v40, v40, v41
  v_mfma_f32_16x16x32_bf16 a[44:47], a[180:183], v[120:123], a[44:47]
  ds_read_b64_tr_b16 a[166:167], v220 offset:61440
  v_exp_f32 v43, v43
  v_mfma_f32_16x16x32_bf16 a[44:47], a[176:179], v[88:91], a[44:47]
  s_waitcnt lgkmcnt(4)
  v_add_f32 v209, v209, v42
  v_mfma_f32_16x16x32_bf16 a[48:51], a[184:187], v[64:67], a[48:51]
  ds_read_b64_tr_b16 a[168:169], v221 offset:49152
  v_exp_f32 v48, v48
  v_mfma_f32_16x16x32_bf16 a[48:51], a[188:191], v[96:99], a[48:51]
  v_add_f32 v209, v209, v43
  v_cvt_pk_bf16_f32 v41, v42, v43
  v_mfma_f32_16x16x32_bf16 a[52:55], a[188:191], v[104:107], a[52:55]
  ds_read_b64_tr_b16 a[170:171], v221 offset:53248
  v_exp_f32 v49, v49
  v_mfma_f32_16x16x32_bf16 a[52:55], a[184:187], v[72:75], a[52:55]
  v_add_f32 v210, v210, v48
  v_mfma_f32_16x16x32_bf16 a[56:59], a[184:187], v[80:83], a[56:59]
  ds_read_b64_tr_b16 a[172:173], v221 offset:57344
  v_exp_f32 v50, v50
  v_mfma_f32_16x16x32_bf16 a[56:59], a[188:191], v[112:115], a[56:59]
  v_add_f32 v210, v210, v49
  v_cvt_pk_bf16_f32 v48, v48, v49
  v_mfma_f32_16x16x32_bf16 a[60:63], a[188:191], v[120:123], a[60:63]
  ds_read_b64_tr_b16 a[174:175], v221 offset:61440
  v_exp_f32 v51, v51
  v_mfma_f32_16x16x32_bf16 a[60:63], a[184:187], v[88:91], a[60:63]
  s_waitcnt lgkmcnt(4)
  v_add_f32 v210, v210, v50
  v_mfma_f32_16x16x32_bf16 a[64:67], a[160:163], v[64:67], a[64:67]
  ds_read_b64_tr_b16 a[176:177], v222 offset:49152
  v_exp_f32 v56, v56
  v_mfma_f32_16x16x32_bf16 a[64:67], a[164:167], v[96:99], a[64:67]
  v_add_f32 v210, v210, v51
  v_cvt_pk_bf16_f32 v49, v50, v51
  v_mfma_f32_16x16x32_bf16 a[68:71], a[164:167], v[104:107], a[68:71]
  ds_read_b64_tr_b16 a[178:179], v222 offset:53248
  v_exp_f32 v57, v57
  v_mfma_f32_16x16x32_bf16 a[68:71], a[160:163], v[72:75], a[68:71]
  v_add_f32 v211, v211, v56
  v_mfma_f32_16x16x32_bf16 a[72:75], a[160:163], v[80:83], a[72:75]
  ds_read_b64_tr_b16 a[180:181], v222 offset:57344
  v_exp_f32 v58, v58
  v_mfma_f32_16x16x32_bf16 a[72:75], a[164:167], v[112:115], a[72:75]
  v_add_f32 v211, v211, v57
  v_cvt_pk_bf16_f32 v56, v56, v57
  v_mfma_f32_16x16x32_bf16 a[76:79], a[164:167], v[120:123], a[76:79]
  ds_read_b64_tr_b16 a[182:183], v222 offset:61440
  v_exp_f32 v59, v59
  v_mfma_f32_16x16x32_bf16 a[76:79], a[160:163], v[88:91], a[76:79]
  s_waitcnt lgkmcnt(4)
  v_add_f32 v211, v211, v58
  v_mfma_f32_16x16x32_bf16 a[80:83], a[168:171], v[64:67], a[80:83]
  ds_read_b64_tr_b16 a[184:185], v223 offset:49152
  v_exp_f32 v36, v36
  v_mfma_f32_16x16x32_bf16 a[80:83], a[172:175], v[96:99], a[80:83]
  v_add_f32 v211, v211, v59
  v_cvt_pk_bf16_f32 v57, v58, v59
  v_mfma_f32_16x16x32_bf16 a[84:87], a[172:175], v[104:107], a[84:87]
  ds_read_b64_tr_b16 a[186:187], v223 offset:53248
  v_exp_f32 v37, v37
  v_mfma_f32_16x16x32_bf16 a[84:87], a[168:171], v[72:75], a[84:87]
  v_add_f32 v208, v208, v36
  v_mfma_f32_16x16x32_bf16 a[88:91], a[168:171], v[80:83], a[88:91]
  ds_read_b64_tr_b16 a[188:189], v223 offset:57344
  v_exp_f32 v38, v38
  v_mfma_f32_16x16x32_bf16 a[88:91], a[172:175], v[112:115], a[88:91]
  v_add_f32 v208, v208, v37
  v_cvt_pk_bf16_f32 v34, v36, v37
  v_mfma_f32_16x16x32_bf16 a[92:95], a[172:175], v[120:123], a[92:95]
  ds_read_b64_tr_b16 a[190:191], v223 offset:61440
  v_exp_f32 v39, v39
  v_mfma_f32_16x16x32_bf16 a[92:95], a[168:171], v[88:91], a[92:95]
  s_waitcnt lgkmcnt(4)
  v_add_f32 v208, v208, v38
  v_mfma_f32_16x16x32_bf16 a[96:99], a[176:179], v[64:67], a[96:99]
  s_waitcnt vmcnt(8)
  v_exp_f32 v44, v44
  v_mfma_f32_16x16x32_bf16 a[96:99], a[180:183], v[96:99], a[96:99]
  s_barrier
  v_add_f32 v208, v208, v39
  v_cvt_pk_bf16_f32 v35, v38, v39
  v_mfma_f32_16x16x32_bf16 a[100:103], a[180:183], v[104:107], a[100:103]
  ds_read_b128 a[128:131], v212 offset:16384
  v_exp_f32 v45, v45
  v_mfma_f32_16x16x32_bf16 a[100:103], a[176:179], v[72:75], a[100:103]
  v_add_f32 v209, v209, v44
  v_mfma_f32_16x16x32_bf16 a[104:107], a[176:179], v[80:83], a[104:107]
  ds_read_b128 a[132:135], v213 offset:16384
  v_exp_f32 v46, v46
  v_mfma_f32_16x16x32_bf16 a[104:107], a[180:183], v[112:115], a[104:107]
  v_add_f32 v209, v209, v45
  v_cvt_pk_bf16_f32 v42, v44, v45
  v_mfma_f32_16x16x32_bf16 a[108:111], a[180:183], v[120:123], a[108:111]
  ds_read_b128 a[136:139], v214 offset:16384
  v_exp_f32 v47, v47
  v_mfma_f32_16x16x32_bf16 a[108:111], a[176:179], v[88:91], a[108:111]
  s_waitcnt lgkmcnt(3)
  v_add_f32 v209, v209, v46
  v_mfma_f32_16x16x32_bf16 a[112:115], a[184:187], v[64:67], a[112:115]
  ds_read_b128 a[140:143], v215 offset:16384
  v_exp_f32 v52, v52
  v_mfma_f32_16x16x32_bf16 a[112:115], a[188:191], v[96:99], a[112:115]
  v_add_f32 v209, v209, v47
  v_cvt_pk_bf16_f32 v43, v46, v47
  v_mfma_f32_16x16x32_bf16 a[116:119], a[188:191], v[104:107], a[116:119]
  v_exp_f32 v53, v53
  v_mfma_f32_16x16x32_bf16 a[116:119], a[184:187], v[72:75], a[116:119]
  v_add_f32 v210, v210, v52
  v_mfma_f32_16x16x32_bf16 a[120:123], a[184:187], v[80:83], a[120:123]
  v_exp_f32 v54, v54
  v_mfma_f32_16x16x32_bf16 a[120:123], a[188:191], v[112:115], a[120:123]
  v_add_f32 v210, v210, v53
  v_cvt_pk_bf16_f32 v50, v52, v53
  v_mfma_f32_16x16x32_bf16 a[124:127], a[188:191], v[120:123], a[124:127]
  v_exp_f32 v55, v55
  v_mfma_f32_16x16x32_bf16 a[124:127], a[184:187], v[88:91], a[124:127]
  s_waitcnt lgkmcnt(0)
  v_add_f32 v210, v210, v54
  v_mfma_f32_16x16x32_bf16 v[64:67], a[128:131], v[128:131], v[192:195]
  ds_read_b128 a[144:147], v212 offset:20480
  v_exp_f32 v60, v60
  v_mfma_f32_16x16x32_bf16 v[64:67], a[132:135], v[132:135], v[64:67]
  v_add_f32 v210, v210, v55
  v_cvt_pk_bf16_f32 v51, v54, v55
  v_mfma_f32_16x16x32_bf16 v[64:67], a[136:139], v[136:139], v[64:67]
  ds_read_b128 a[148:151], v213 offset:20480
  v_exp_f32 v61, v61
  v_mfma_f32_16x16x32_bf16 v[64:67], a[140:143], v[140:143], v[64:67]
  v_add_f32 v211, v211, v60
  v_mfma_f32_16x16x32_bf16 v[72:75], a[140:143], v[156:159], v[196:199]
  ds_read_b128 a[152:155], v214 offset:20480
  v_exp_f32 v62, v62
  v_mfma_f32_16x16x32_bf16 v[72:75], a[136:139], v[152:155], v[72:75]
  v_add_f32 v211, v211, v61
  v_cvt_pk_bf16_f32 v58, v60, v61
  v_mfma_f32_16x16x32_bf16 v[72:75], a[132:135], v[148:151], v[72:75]
  ds_read_b128 a[156:159], v215 offset:20480
  v_exp_f32 v63, v63
  v_mfma_f32_16x16x32_bf16 v[72:75], a[128:131], v[144:147], v[72:75]
  v_add_f32 v211, v211, v62
  v_mfma_f32_16x16x32_bf16 v[80:83], a[128:131], v[160:163], v[200:203]
  s_add_u32 m0, s28, 98304
  v_exp_f32 v64, v64
  v_mfma_f32_16x16x32_bf16 v[80:83], a[132:135], v[164:167], v[80:83]
  buffer_load_dwordx4 v236, s[16:19], s29 offen offset:0 lds
  v_add_f32 v211, v211, v63
  v_cvt_pk_bf16_f32 v59, v62, v63
  v_mfma_f32_16x16x32_bf16 v[80:83], a[136:139], v[168:171], v[80:83]
  v_exp_f32 v65, v65
  v_mfma_f32_16x16x32_bf16 v[80:83], a[140:143], v[172:175], v[80:83]
  buffer_load_dwordx4 v237, s[16:19], s29 offen offset:1024 lds
  v_add_f32 v208, v208, v64
  v_mfma_f32_16x16x32_bf16 v[88:91], a[140:143], v[188:191], v[204:207]
  v_exp_f32 v66, v66
  v_mfma_f32_16x16x32_bf16 v[88:91], a[136:139], v[184:187], v[88:91]
  buffer_load_dwordx4 v236, s[16:19], s29 offen offset:2048 lds
  v_add_f32 v208, v208, v65
  v_cvt_pk_bf16_f32 v64, v64, v65
  v_mfma_f32_16x16x32_bf16 v[88:91], a[132:135], v[180:183], v[88:91]
  v_exp_f32 v67, v67
  v_mfma_f32_16x16x32_bf16 v[88:91], a[128:131], v[176:179], v[88:91]
  s_waitcnt lgkmcnt(0)
  v_add_f32 v208, v208, v66
  v_mfma_f32_16x16x32_bf16 v[68:71], a[144:147], v[128:131], v[192:195]
  ds_read_b128 a[128:131], v212 offset:24576
  v_exp_f32 v72, v72
  v_mfma_f32_16x16x32_bf16 v[68:71], a[148:151], v[132:135], v[68:71]
  v_add_f32 v208, v208, v67
  v_cvt_pk_bf16_f32 v65, v66, v67
  v_mfma_f32_16x16x32_bf16 v[68:71], a[152:155], v[136:139], v[68:71]
  ds_read_b128 a[132:135], v213 offset:24576
  v_exp_f32 v73, v73
  v_mfma_f32_16x16x32_bf16 v[68:71], a[156:159], v[140:143], v[68:71]
  v_add_f32 v209, v209, v72
  v_mfma_f32_16x16x32_bf16 v[76:79], a[156:159], v[156:159], v[196:199]
  ds_read_b128 a[136:139], v214 offset:24576
  v_exp_f32 v74, v74
  v_mfma_f32_16x16x32_bf16 v[76:79], a[152:155], v[152:155], v[76:79]
  v_add_f32 v209, v209, v73
  v_cvt_pk_bf16_f32 v72, v72, v73
  v_mfma_f32_16x16x32_bf16 v[76:79], a[148:151], v[148:151], v[76:79]
  ds_read_b128 a[140:143], v215 offset:24576
  v_exp_f32 v75, v75
  v_mfma_f32_16x16x32_bf16 v[76:79], a[144:147], v[144:147], v[76:79]
  v_add_f32 v209, v209, v74
  v_mfma_f32_16x16x32_bf16 v[84:87], a[144:147], v[160:163], v[200:203]
  buffer_load_dwordx4 v237, s[16:19], s29 offen offset:3072 lds
  v_exp_f32 v80, v80
  v_mfma_f32_16x16x32_bf16 v[84:87], a[148:151], v[164:167], v[84:87]
  s_add_u32 s29, s29, 16384
  v_add_f32 v209, v209, v75
  v_cvt_pk_bf16_f32 v73, v74, v75
  v_mfma_f32_16x16x32_bf16 v[84:87], a[152:155], v[168:171], v[84:87]
  s_add_u32 m0, s28, 49152
  v_exp_f32 v81, v81
  v_mfma_f32_16x16x32_bf16 v[84:87], a[156:159], v[172:175], v[84:87]
  buffer_load_dwordx4 v232, s[12:15], s29 offen offset:0 lds
  v_add_f32 v210, v210, v80
  v_mfma_f32_16x16x32_bf16 v[92:95], a[156:159], v[188:191], v[204:207]
  v_exp_f32 v82, v82
  v_mfma_f32_16x16x32_bf16 v[92:95], a[152:155], v[184:187], v[92:95]
  buffer_load_dwordx4 v233, s[12:15], s29 offen offset:1024 lds
  v_add_f32 v210, v210, v81
  v_cvt_pk_bf16_f32 v80, v80, v81
  v_mfma_f32_16x16x32_bf16 v[92:95], a[148:151], v[180:183], v[92:95]
  v_exp_f32 v83, v83
  v_mfma_f32_16x16x32_bf16 v[92:95], a[144:147], v[176:179], v[92:95]
  s_waitcnt lgkmcnt(0)
  v_add_f32 v210, v210, v82
  v_mfma_f32_16x16x32_bf16 v[96:99], a[128:131], v[128:131], v[192:195]
  ds_read_b128 a[144:147], v212 offset:28672
  v_exp_f32 v88, v88
  v_mfma_f32_16x16x32_bf16 v[96:99], a[132:135], v[132:135], v[96:99]
  v_add_f32 v210, v210, v83
  v_cvt_pk_bf16_f32 v81, v82, v83
  v_mfma_f32_16x16x32_bf16 v[96:99], a[136:139], v[136:139], v[96:99]
  ds_read_b128 a[148:151], v213 offset:28672
  v_exp_f32 v89, v89
  v_mfma_f32_16x16x32_bf16 v[96:99], a[140:143], v[140:143], v[96:99]
  v_add_f32 v211, v211, v88
  v_mfma_f32_16x16x32_bf16 v[104:107], a[140:143], v[156:159], v[196:199]
  ds_read_b128 a[152:155], v214 offset:28672
  v_exp_f32 v90, v90
  v_mfma_f32_16x16x32_bf16 v[104:107], a[136:139], v[152:155], v[104:107]
  v_add_f32 v211, v211, v89
  v_cvt_pk_bf16_f32 v88, v88, v89
  v_mfma_f32_16x16x32_bf16 v[104:107], a[132:135], v[148:151], v[104:107]
  ds_read_b128 a[156:159], v215 offset:28672
  v_exp_f32 v91, v91
  v_mfma_f32_16x16x32_bf16 v[104:107], a[128:131], v[144:147], v[104:107]
  v_add_f32 v211, v211, v90
  v_mfma_f32_16x16x32_bf16 v[112:115], a[128:131], v[160:163], v[200:203]
  buffer_load_dwordx4 v234, s[12:15], s29 offen offset:2048 lds
  v_exp_f32 v68, v68
  v_mfma_f32_16x16x32_bf16 v[112:115], a[132:135], v[164:167], v[112:115]
  v_add_f32 v211, v211, v91
  v_cvt_pk_bf16_f32 v89, v90, v91
  v_mfma_f32_16x16x32_bf16 v[112:115], a[136:139], v[168:171], v[112:115]
  buffer_load_dwordx4 v235, s[12:15], s29 offen offset:3072 lds
  v_exp_f32 v69, v69
  v_mfma_f32_16x16x32_bf16 v[112:115], a[140:143], v[172:175], v[112:115]
  v_add_f32 v208, v208, v68
  v_mfma_f32_16x16x32_bf16 v[120:123], a[140:143], v[188:191], v[204:207]
  v_exp_f32 v70, v70
  v_mfma_f32_16x16x32_bf16 v[120:123], a[136:139], v[184:187], v[120:123]
  v_add_f32 v208, v208, v69
  v_cvt_pk_bf16_f32 v66, v68, v69
  v_mfma_f32_16x16x32_bf16 v[120:123], a[132:135], v[180:183], v[120:123]
  v_exp_f32 v71, v71
  v_mfma_f32_16x16x32_bf16 v[120:123], a[128:131], v[176:179], v[120:123]
  s_waitcnt lgkmcnt(0)
  v_add_f32 v208, v208, v70
  v_mfma_f32_16x16x32_bf16 v[100:103], a[144:147], v[128:131], v[192:195]
  ds_read_b64_tr_b16 a[160:161], v216 offset:0
  v_exp_f32 v76, v76
  v_mfma_f32_16x16x32_bf16 v[100:103], a[148:151], v[132:135], v[100:103]
  v_add_f32 v208, v208, v71
  v_cvt_pk_bf16_f32 v67, v70, v71
  v_mfma_f32_16x16x32_bf16 v[100:103], a[152:155], v[136:139], v[100:103]
  ds_read_b64_tr_b16 a[162:163], v216 offset:4096
  v_exp_f32 v77, v77
  v_mfma_f32_16x16x32_bf16 v[100:103], a[156:159], v[140:143], v[100:103]
  v_add_f32 v209, v209, v76
  v_mfma_f32_16x16x32_bf16 v[108:111], a[156:159], v[156:159], v[196:199]
  ds_read_b64_tr_b16 a[164:165], v216 offset:8192
  v_exp_f32 v78, v78
  v_mfma_f32_16x16x32_bf16 v[108:111], a[152:155], v[152:155], v[108:111]
  v_add_f32 v209, v209, v77
  v_cvt_pk_bf16_f32 v74, v76, v77
  v_mfma_f32_16x16x32_bf16 v[108:111], a[148:151], v[148:151], v[108:111]
  ds_read_b64_tr_b16 a[166:167], v216 offset:12288
  v_exp_f32 v79, v79
  v_mfma_f32_16x16x32_bf16 v[108:111], a[144:147], v[144:147], v[108:111]
  v_add_f32 v209, v209, v78
  v_mfma_f32_16x16x32_bf16 v[116:119], a[144:147], v[160:163], v[200:203]
  ds_read_b64_tr_b16 a[168:169], v217 offset:0
  v_exp_f32 v84, v84
  v_mfma_f32_16x16x32_bf16 v[116:119], a[148:151], v[164:167], v[116:119]
  v_add_f32 v209, v209, v79
  v_cvt_pk_bf16_f32 v75, v78, v79
  v_mfma_f32_16x16x32_bf16 v[116:119], a[152:155], v[168:171], v[116:119]
  ds_read_b64_tr_b16 a[170:171], v217 offset:4096
  v_exp_f32 v85, v85
  v_mfma_f32_16x16x32_bf16 v[116:119], a[156:159], v[172:175], v[116:119]
  v_add_f32 v210, v210, v84
  v_mfma_f32_16x16x32_bf16 v[124:127], a[156:159], v[188:191], v[204:207]
  ds_read_b64_tr_b16 a[172:173], v217 offset:8192
  v_exp_f32 v86, v86
  v_mfma_f32_16x16x32_bf16 v[124:127], a[152:155], v[184:187], v[124:127]
  v_add_f32 v210, v210, v85
  v_cvt_pk_bf16_f32 v82, v84, v85
  v_mfma_f32_16x16x32_bf16 v[124:127], a[148:151], v[180:183], v[124:127]
  ds_read_b64_tr_b16 a[174:175], v217 offset:12288
  v_exp_f32 v87, v87
  v_mfma_f32_16x16x32_bf16 v[124:127], a[144:147], v[176:179], v[124:127]
  s_waitcnt lgkmcnt(4)
  v_add_f32 v210, v210, v86
  v_mfma_f32_16x16x32_bf16 a[0:3], a[160:163], v[0:3], a[0:3]
  ds_read_b64_tr_b16 a[176:177], v218 offset:0
  v_exp_f32 v92, v92
  v_mfma_f32_16x16x32_bf16 a[0:3], a[164:167], v[32:35], a[0:3]
  v_add_f32 v210, v210, v87
  v_cvt_pk_bf16_f32 v83, v86, v87
  v_mfma_f32_16x16x32_bf16 a[4:7], a[164:167], v[40:43], a[4:7]
  ds_read_b64_tr_b16 a[178:179], v218 offset:4096
  v_exp_f32 v93, v93
  v_mfma_f32_16x16x32_bf16 a[4:7], a[160:163], v[8:11], a[4:7]
  v_add_f32 v211, v211, v92
  v_mfma_f32_16x16x32_bf16 a[8:11], a[160:163], v[16:19], a[8:11]
  ds_read_b64_tr_b16 a[180:181], v218 offset:8192
  v_exp_f32 v94, v94
  v_mfma_f32_16x16x32_bf16 a[8:11], a[164:167], v[48:51], a[8:11]
  v_add_f32 v211, v211, v93
  v_cvt_pk_bf16_f32 v90, v92, v93
  v_mfma_f32_16x16x32_bf16 a[12:15], a[164:167], v[56:59], a[12:15]
  ds_read_b64_tr_b16 a[182:183], v218 offset:12288
  v_exp_f32 v95, v95
  v_mfma_f32_16x16x32_bf16 a[12:15], a[160:163], v[24:27], a[12:15]
  s_waitcnt lgkmcnt(4)
  v_add_f32 v211, v211, v94
  v_mfma_f32_16x16x32_bf16 a[16:19], a[168:171], v[0:3], a[16:19]
  ds_read_b64_tr_b16 a[184:185], v219 offset:0
  v_exp_f32 v96, v96
  v_mfma_f32_16x16x32_bf16 a[16:19], a[172:175], v[32:35], a[16:19]
  v_add_f32 v211, v211, v95
  v_cvt_pk_bf16_f32 v91, v94, v95
  v_mfma_f32_16x16x32_bf16 a[20:23], a[172:175], v[40:43], a[20:23]
  ds_read_b64_tr_b16 a[186:187], v219 offset:4096
  v_exp_f32 v97, v97
  v_mfma_f32_16x16x32_bf16 a[20:23], a[168:171], v[8:11], a[20:23]
  v_add_f32 v208, v208, v96
  v_mfma_f32_16x16x32_bf16 a[24:27], a[168:171], v[16:19], a[24:27]
  ds_read_b64_tr_b16 a[188:189], v219 offset:8192
  v_exp_f32 v98, v98
  v_mfma_f32_16x16x32_bf16 a[24:27], a[172:175], v[48:51], a[24:27]
  v_add_f32 v208, v208, v97
  v_cvt_pk_bf16_f32 v96, v96, v97
  v_mfma_f32_16x16x32_bf16 a[28:31], a[172:175], v[56:59], a[28:31]
  ds_read_b64_tr_b16 a[190:191], v219 offset:12288
  v_exp_f32 v99, v99
  v_mfma_f32_16x16x32_bf16 a[28:31], a[168:171], v[24:27], a[28:31]
  s_waitcnt lgkmcnt(4)
  v_add_f32 v208, v208, v98
  v_mfma_f32_16x16x32_bf16 a[32:35], a[176:179], v[0:3], a[32:35]
  ds_read_b64_tr_b16 a[160:161], v220 offset:0
  v_exp_f32 v104, v104
  v_mfma_f32_16x16x32_bf16 a[32:35], a[180:183], v[32:35], a[32:35]
  v_add_f32 v208, v208, v99
  v_cvt_pk_bf16_f32 v97, v98, v99
  v_mfma_f32_16x16x32_bf16 a[36:39], a[180:183], v[40:43], a[36:39]
  ds_read_b64_tr_b16 a[162:163], v220 offset:4096
  v_exp_f32 v105, v105
  v_mfma_f32_16x16x32_bf16 a[36:39], a[176:179], v[8:11], a[36:39]
  v_add_f32 v209, v209, v104
  v_mfma_f32_16x16x32_bf16 a[40:43], a[176:179], v[16:19], a[40:43]
  ds_read_b64_tr_b16 a[164:165], v220 offset:8192
  v_exp_f32 v106, v106
  v_mfma_f32_16x16x32_bf16 a[40:43], a[180:183], v[48:51], a[40:43]
  v_add_f32 v209, v209, v105
  v_cvt_pk_bf16_f32 v104, v104, v105
  v_mfma_f32_16x16x32_bf16 a[44:47], a[180:183], v[56:59], a[44:47]
  ds_read_b64_tr_b16 a[166:167], v220 offset:12288
  v_exp_f32 v107, v107
  v_mfma_f32_16x16x32_bf16 a[44:47], a[176:179], v[24:27], a[44:47]
  s_waitcnt lgkmcnt(4)
  v_add_f32 v209, v209, v106
  v_mfma_f32_16x16x32_bf16 a[48:51], a[184:187], v[0:3], a[48:51]
  ds_read_b64_tr_b16 a[168:169], v221 offset:0
  v_exp_f32 v112, v112
  v_mfma_f32_16x16x32_bf16 a[48:51], a[188:191], v[32:35], a[48:51]
  v_add_f32 v209, v209, v107
  v_cvt_pk_bf16_f32 v105, v106, v107
  v_mfma_f32_16x16x32_bf16 a[52:55], a[188:191], v[40:43], a[52:55]
  ds_read_b64_tr_b16 a[170:171], v221 offset:4096
  v_exp_f32 v113, v113
  v_mfma_f32_16x16x32_bf16 a[52:55], a[184:187], v[8:11], a[52:55]
  v_add_f32 v210, v210, v112
  v_mfma_f32_16x16x32_bf16 a[56:59], a[184:187], v[16:19], a[56:59]
  ds_read_b64_tr_b16 a[172:173], v221 offset:8192
  v_exp_f32 v114, v114
  v_mfma_f32_16x16x32_bf16 a[56:59], a[188:191], v[48:51], a[56:59]
  v_add_f32 v210, v210, v113
  v_cvt_pk_bf16_f32 v112, v112, v113
  v_mfma_f32_16x16x32_bf16 a[60:63], a[188:191], v[56:59], a[60:63]
  ds_read_b64_tr_b16 a[174:175], v221 offset:12288
  v_exp_f32 v115, v115
  v_mfma_f32_16x16x32_bf16 a[60:63], a[184:187], v[24:27], a[60:63]
  s_waitcnt lgkmcnt(4)
  v_add_f32 v210, v210, v114
  v_mfma_f32_16x16x32_bf16 a[64:67], a[160:163], v[0:3], a[64:67]
  ds_read_b64_tr_b16 a[176:177], v222 offset:0
  v_exp_f32 v120, v120
  v_mfma_f32_16x16x32_bf16 a[64:67], a[164:167], v[32:35], a[64:67]
  v_add_f32 v210, v210, v115
  v_cvt_pk_bf16_f32 v113, v114, v115
  v_mfma_f32_16x16x32_bf16 a[68:71], a[164:167], v[40:43], a[68:71]
  ds_read_b64_tr_b16 a[178:179], v222 offset:4096
  v_exp_f32 v121, v121
  v_mfma_f32_16x16x32_bf16 a[68:71], a[160:163], v[8:11], a[68:71]
  v_add_f32 v211, v211, v120
  v_mfma_f32_16x16x32_bf16 a[72:75], a[160:163], v[16:19], a[72:75]
  ds_read_b64_tr_b16 a[180:181], v222 offset:8192
  v_exp_f32 v122, v122
  v_mfma_f32_16x16x32_bf16 a[72:75], a[164:167], v[48:51], a[72:75]
  v_add_f32 v211, v211, v121
  v_cvt_pk_bf16_f32 v120, v120, v121
  v_mfma_f32_16x16x32_bf16 a[76:79], a[164:167], v[56:59], a[76:79]
  ds_read_b64_tr_b16 a[182:183], v222 offset:12288
  v_exp_f32 v123, v123
  v_mfma_f32_16x16x32_bf16 a[76:79], a[160:163], v[24:27], a[76:79]
  s_waitcnt lgkmcnt(4)
  v_add_f32 v211, v211, v122
  v_mfma_f32_16x16x32_bf16 a[80:83], a[168:171], v[0:3], a[80:83]
  ds_read_b64_tr_b16 a[184:185], v223 offset:0
  v_exp_f32 v100, v100
  v_mfma_f32_16x16x32_bf16 a[80:83], a[172:175], v[32:35], a[80:83]
  v_add_f32 v211, v211, v123
  v_cvt_pk_bf16_f32 v121, v122, v123
  v_mfma_f32_16x16x32_bf16 a[84:87], a[172:175], v[40:43], a[84:87]
  ds_read_b64_tr_b16 a[186:187], v223 offset:4096
  v_exp_f32 v101, v101
  v_mfma_f32_16x16x32_bf16 a[84:87], a[168:171], v[8:11], a[84:87]
  v_add_f32 v208, v208, v100
  v_mfma_f32_16x16x32_bf16 a[88:91], a[168:171], v[16:19], a[88:91]
  ds_read_b64_tr_b16 a[188:189], v223 offset:8192
  v_exp_f32 v102, v102
  v_mfma_f32_16x16x32_bf16 a[88:91], a[172:175], v[48:51], a[88:91]
  v_add_f32 v208, v208, v101
  v_cvt_pk_bf16_f32 v98, v100, v101
  v_mfma_f32_16x16x32_bf16 a[92:95], a[172:175], v[56:59], a[92:95]
  ds_read_b64_tr_b16 a[190:191], v223 offset:12288
  v_exp_f32 v103, v103
  v_mfma_f32_16x16x32_bf16 a[92:95], a[168:171], v[24:27], a[92:95]
  s_waitcnt lgkmcnt(4)
  v_add_f32 v208, v208, v102
  v_mfma_f32_16x16x32_bf16 a[96:99], a[176:179], v[0:3], a[96:99]
  s_waitcnt vmcnt(8)
  v_exp_f32 v108, v108
  v_mfma_f32_16x16x32_bf16 a[96:99], a[180:183], v[32:35], a[96:99]
  s_barrier
  v_add_f32 v208, v208, v103
  v_cvt_pk_bf16_f32 v99, v102, v103
  v_mfma_f32_16x16x32_bf16 a[100:103], a[180:183], v[40:43], a[100:103]
  ds_read_b128 a[128:131], v212 offset:32768
  v_exp_f32 v109, v109
  v_mfma_f32_16x16x32_bf16 a[100:103], a[176:179], v[8:11], a[100:103]
  v_add_f32 v209, v209, v108
  v_mfma_f32_16x16x32_bf16 a[104:107], a[176:179], v[16:19], a[104:107]
  ds_read_b128 a[132:135], v213 offset:32768
  v_exp_f32 v110, v110
  v_mfma_f32_16x16x32_bf16 a[104:107], a[180:183], v[48:51], a[104:107]
  v_add_f32 v209, v209, v109
  v_cvt_pk_bf16_f32 v106, v108, v109
  v_mfma_f32_16x16x32_bf16 a[108:111], a[180:183], v[56:59], a[108:111]
  ds_read_b128 a[136:139], v214 offset:32768
  v_exp_f32 v111, v111
  v_mfma_f32_16x16x32_bf16 a[108:111], a[176:179], v[24:27], a[108:111]
  s_waitcnt lgkmcnt(3)
  v_add_f32 v209, v209, v110
  v_mfma_f32_16x16x32_bf16 a[112:115], a[184:187], v[0:3], a[112:115]
  ds_read_b128 a[140:143], v215 offset:32768
  v_exp_f32 v116, v116
  v_mfma_f32_16x16x32_bf16 a[112:115], a[188:191], v[32:35], a[112:115]
  v_add_f32 v209, v209, v111
  v_cvt_pk_bf16_f32 v107, v110, v111
  v_mfma_f32_16x16x32_bf16 a[116:119], a[188:191], v[40:43], a[116:119]
  v_exp_f32 v117, v117
  v_mfma_f32_16x16x32_bf16 a[116:119], a[184:187], v[8:11], a[116:119]
  v_add_f32 v210, v210, v116
  v_mfma_f32_16x16x32_bf16 a[120:123], a[184:187], v[16:19], a[120:123]
  v_exp_f32 v118, v118
  v_mfma_f32_16x16x32_bf16 a[120:123], a[188:191], v[48:51], a[120:123]
  v_add_f32 v210, v210, v117
  v_cvt_pk_bf16_f32 v114, v116, v117
  v_mfma_f32_16x16x32_bf16 a[124:127], a[188:191], v[56:59], a[124:127]
  v_exp_f32 v119, v119
  v_mfma_f32_16x16x32_bf16 a[124:127], a[184:187], v[24:27], a[124:127]
  s_waitcnt lgkmcnt(0)
  v_add_f32 v210, v210, v118
  v_mfma_f32_16x16x32_bf16 v[0:3], a[128:131], v[128:131], v[192:195]
  ds_read_b128 a[144:147], v212 offset:36864
  v_exp_f32 v124, v124
  v_mfma_f32_16x16x32_bf16 v[0:3], a[132:135], v[132:135], v[0:3]
  v_add_f32 v210, v210, v119
  v_cvt_pk_bf16_f32 v115, v118, v119
  v_mfma_f32_16x16x32_bf16 v[0:3], a[136:139], v[136:139], v[0:3]
  ds_read_b128 a[148:151], v213 offset:36864
  v_exp_f32 v125, v125
  v_mfma_f32_16x16x32_bf16 v[0:3], a[140:143], v[140:143], v[0:3]
  v_add_f32 v211, v211, v124
  v_mfma_f32_16x16x32_bf16 v[8:11], a[140:143], v[156:159], v[196:199]
  ds_read_b128 a[152:155], v214 offset:36864
  v_exp_f32 v126, v126
  v_mfma_f32_16x16x32_bf16 v[8:11], a[136:139], v[152:155], v[8:11]
  v_add_f32 v211, v211, v125
  v_cvt_pk_bf16_f32 v122, v124, v125
  v_mfma_f32_16x16x32_bf16 v[8:11], a[132:135], v[148:151], v[8:11]
  ds_read_b128 a[156:159], v215 offset:36864
  v_exp_f32 v127, v127
  v_mfma_f32_16x16x32_bf16 v[8:11], a[128:131], v[144:147], v[8:11]
  v_add_f32 v211, v211, v126
  v_mfma_f32_16x16x32_bf16 v[16:19], a[128:131], v[160:163], v[200:203]
  s_add_u32 m0, s28, 114688
  v_exp_f32 v0, v0
  v_mfma_f32_16x16x32_bf16 v[16:19], a[132:135], v[164:167], v[16:19]
  buffer_load_dwordx4 v236, s[16:19], s29 offen offset:0 lds
  v_add_f32 v211, v211, v127
  v_cvt_pk_bf16_f32 v123, v126, v127
  v_mfma_f32_16x16x32_bf16 v[16:19], a[136:139], v[168:171], v[16:19]
  v_exp_f32 v1, v1
  v_mfma_f32_16x16x32_bf16 v[16:19], a[140:143], v[172:175], v[16:19]
  buffer_load_dwordx4 v237, s[16:19], s29 offen offset:1024 lds
  v_add_f32 v208, v208, v0
  v_mfma_f32_16x16x32_bf16 v[24:27], a[140:143], v[188:191], v[204:207]
  v_exp_f32 v2, v2
  v_mfma_f32_16x16x32_bf16 v[24:27], a[136:139], v[184:187], v[24:27]
  buffer_load_dwordx4 v236, s[16:19], s29 offen offset:2048 lds
  v_add_f32 v208, v208, v1
  v_cvt_pk_bf16_f32 v0, v0, v1
  v_mfma_f32_16x16x32_bf16 v[24:27], a[132:135], v[180:183], v[24:27]
  v_exp_f32 v3, v3
  v_mfma_f32_16x16x32_bf16 v[24:27], a[128:131], v[176:179], v[24:27]
  s_waitcnt lgkmcnt(0)
  v_add_f32 v208, v208, v2
  v_mfma_f32_16x16x32_bf16 v[4:7], a[144:147], v[128:131], v[192:195]
  ds_read_b128 a[128:131], v212 offset:40960
  v_exp_f32 v8, v8
  v_mfma_f32_16x16x32_bf16 v[4:7], a[148:151], v[132:135], v[4:7]
  v_add_f32 v208, v208, v3
  v_cvt_pk_bf16_f32 v1, v2, v3
  v_mfma_f32_16x16x32_bf16 v[4:7], a[152:155], v[136:139], v[4:7]
  ds_read_b128 a[132:135], v213 offset:40960
  v_exp_f32 v9, v9
  v_mfma_f32_16x16x32_bf16 v[4:7], a[156:159], v[140:143], v[4:7]
  v_add_f32 v209, v209, v8
  v_mfma_f32_16x16x32_bf16 v[12:15], a[156:159], v[156:159], v[196:199]
  ds_read_b128 a[136:139], v214 offset:40960
  v_exp_f32 v10, v10
  v_mfma_f32_16x16x32_bf16 v[12:15], a[152:155], v[152:155], v[12:15]
  v_add_f32 v209, v209, v9
  v_cvt_pk_bf16_f32 v8, v8, v9
  v_mfma_f32_16x16x32_bf16 v[12:15], a[148:151], v[148:151], v[12:15]
  ds_read_b128 a[140:143], v215 offset:40960
  v_exp_f32 v11, v11
  v_mfma_f32_16x16x32_bf16 v[12:15], a[144:147], v[144:147], v[12:15]
  v_add_f32 v209, v209, v10
  v_mfma_f32_16x16x32_bf16 v[20:23], a[144:147], v[160:163], v[200:203]
  buffer_load_dwordx4 v237, s[16:19], s29 offen offset:3072 lds
  v_exp_f32 v16, v16
  v_mfma_f32_16x16x32_bf16 v[20:23], a[148:151], v[164:167], v[20:23]
  s_add_u32 s29, s29, 16384
  v_add_f32 v209, v209, v11
  v_cvt_pk_bf16_f32 v9, v10, v11
  v_mfma_f32_16x16x32_bf16 v[20:23], a[152:155], v[168:171], v[20:23]
  s_add_u32 m0, s28, 0
  v_exp_f32 v17, v17
  v_mfma_f32_16x16x32_bf16 v[20:23], a[156:159], v[172:175], v[20:23]
  buffer_load_dwordx4 v232, s[12:15], s29 offen offset:0 lds
  v_add_f32 v210, v210, v16
  v_mfma_f32_16x16x32_bf16 v[28:31], a[156:159], v[188:191], v[204:207]
  v_exp_f32 v18, v18
  v_mfma_f32_16x16x32_bf16 v[28:31], a[152:155], v[184:187], v[28:31]
  buffer_load_dwordx4 v233, s[12:15], s29 offen offset:1024 lds
  v_add_f32 v210, v210, v17
  v_cvt_pk_bf16_f32 v16, v16, v17
  v_mfma_f32_16x16x32_bf16 v[28:31], a[148:151], v[180:183], v[28:31]
  v_exp_f32 v19, v19
  v_mfma_f32_16x16x32_bf16 v[28:31], a[144:147], v[176:179], v[28:31]
  s_waitcnt lgkmcnt(0)
  v_add_f32 v210, v210, v18
  v_mfma_f32_16x16x32_bf16 v[32:35], a[128:131], v[128:131], v[192:195]
  ds_read_b128 a[144:147], v212 offset:45056
  v_exp_f32 v24, v24
  v_mfma_f32_16x16x32_bf16 v[32:35], a[132:135], v[132:135], v[32:35]
  v_add_f32 v210, v210, v19
  v_cvt_pk_bf16_f32 v17, v18, v19
  v_mfma_f32_16x16x32_bf16 v[32:35], a[136:139], v[136:139], v[32:35]
  ds_read_b128 a[148:151], v213 offset:45056
  v_exp_f32 v25, v25
  v_mfma_f32_16x16x32_bf16 v[32:35], a[140:143], v[140:143], v[32:35]
  v_add_f32 v211, v211, v24
  v_mfma_f32_16x16x32_bf16 v[40:43], a[140:143], v[156:159], v[196:199]
  ds_read_b128 a[152:155], v214 offset:45056
  v_exp_f32 v26, v26
  v_mfma_f32_16x16x32_bf16 v[40:43], a[136:139], v[152:155], v[40:43]
  v_add_f32 v211, v211, v25
  v_cvt_pk_bf16_f32 v24, v24, v25
  v_mfma_f32_16x16x32_bf16 v[40:43], a[132:135], v[148:151], v[40:43]
  ds_read_b128 a[156:159], v215 offset:45056
  v_exp_f32 v27, v27
  v_mfma_f32_16x16x32_bf16 v[40:43], a[128:131], v[144:147], v[40:43]
  v_add_f32 v211, v211, v26
  v_mfma_f32_16x16x32_bf16 v[48:51], a[128:131], v[160:163], v[200:203]
  buffer_load_dwordx4 v234, s[12:15], s29 offen offset:2048 lds
  v_exp_f32 v4, v4
  v_mfma_f32_16x16x32_bf16 v[48:51], a[132:135], v[164:167], v[48:51]
  v_add_f32 v211, v211, v27
  v_cvt_pk_bf16_f32 v25, v26, v27
  v_mfma_f32_16x16x32_bf16 v[48:51], a[136:139], v[168:171], v[48:51]
  buffer_load_dwordx4 v235, s[12:15], s29 offen offset:3072 lds
  v_exp_f32 v5, v5
  v_mfma_f32_16x16x32_bf16 v[48:51], a[140:143], v[172:175], v[48:51]
  v_add_f32 v208, v208, v4
  v_mfma_f32_16x16x32_bf16 v[56:59], a[140:143], v[188:191], v[204:207]
  v_exp_f32 v6, v6
  v_mfma_f32_16x16x32_bf16 v[56:59], a[136:139], v[184:187], v[56:59]
  v_add_f32 v208, v208, v5
  v_cvt_pk_bf16_f32 v2, v4, v5
  v_mfma_f32_16x16x32_bf16 v[56:59], a[132:135], v[180:183], v[56:59]
  v_exp_f32 v7, v7
  v_mfma_f32_16x16x32_bf16 v[56:59], a[128:131], v[176:179], v[56:59]
  s_waitcnt lgkmcnt(0)
  v_add_f32 v208, v208, v6
  v_mfma_f32_16x16x32_bf16 v[36:39], a[144:147], v[128:131], v[192:195]
  ds_read_b64_tr_b16 a[160:161], v216 offset:16384
  v_exp_f32 v12, v12
  v_mfma_f32_16x16x32_bf16 v[36:39], a[148:151], v[132:135], v[36:39]
  v_add_f32 v208, v208, v7
  v_cvt_pk_bf16_f32 v3, v6, v7
  v_mfma_f32_16x16x32_bf16 v[36:39], a[152:155], v[136:139], v[36:39]
  ds_read_b64_tr_b16 a[162:163], v216 offset:20480
  v_exp_f32 v13, v13
  v_mfma_f32_16x16x32_bf16 v[36:39], a[156:159], v[140:143], v[36:39]
  v_add_f32 v209, v209, v12
  v_mfma_f32_16x16x32_bf16 v[44:47], a[156:159], v[156:159], v[196:199]
  ds_read_b64_tr_b16 a[164:165], v216 offset:24576
  v_exp_f32 v14, v14
  v_mfma_f32_16x16x32_bf16 v[44:47], a[152:155], v[152:155], v[44:47]
  v_add_f32 v209, v209, v13
  v_cvt_pk_bf16_f32 v10, v12, v13
  v_mfma_f32_16x16x32_bf16 v[44:47], a[148:151], v[148:151], v[44:47]
  ds_read_b64_tr_b16 a[166:167], v216 offset:28672
  v_exp_f32 v15, v15
  v_mfma_f32_16x16x32_bf16 v[44:47], a[144:147], v[144:147], v[44:47]
  v_add_f32 v209, v209, v14
  v_mfma_f32_16x16x32_bf16 v[52:55], a[144:147], v[160:163], v[200:203]
  ds_read_b64_tr_b16 a[168:169], v217 offset:16384
  v_exp_f32 v20, v20
  v_mfma_f32_16x16x32_bf16 v[52:55], a[148:151], v[164:167], v[52:55]
  v_add_f32 v209, v209, v15
  v_cvt_pk_bf16_f32 v11, v14, v15
  v_mfma_f32_16x16x32_bf16 v[52:55], a[152:155], v[168:171], v[52:55]
  ds_read_b64_tr_b16 a[170:171], v217 offset:20480
  v_exp_f32 v21, v21
  v_mfma_f32_16x16x32_bf16 v[52:55], a[156:159], v[172:175], v[52:55]
  v_add_f32 v210, v210, v20
  v_mfma_f32_16x16x32_bf16 v[60:63], a[156:159], v[188:191], v[204:207]
  ds_read_b64_tr_b16 a[172:173], v217 offset:24576
  v_exp_f32 v22, v22
  v_mfma_f32_16x16x32_bf16 v[60:63], a[152:155], v[184:187], v[60:63]
  v_add_f32 v210, v210, v21
  v_cvt_pk_bf16_f32 v18, v20, v21
  v_mfma_f32_16x16x32_bf16 v[60:63], a[148:151], v[180:183], v[60:63]
  ds_read_b64_tr_b16 a[174:175], v217 offset:28672
  v_exp_f32 v23, v23
  v_mfma_f32_16x16x32_bf16 v[60:63], a[144:147], v[176:179], v[60:63]
  s_waitcnt lgkmcnt(4)
  v_add_f32 v210, v210, v22
  v_mfma_f32_16x16x32_bf16 a[0:3], a[160:163], v[64:67], a[0:3]
  ds_read_b64_tr_b16 a[176:177], v218 offset:16384
  v_exp_f32 v28, v28
  v_mfma_f32_16x16x32_bf16 a[0:3], a[164:167], v[96:99], a[0:3]
  v_add_f32 v210, v210, v23
  v_cvt_pk_bf16_f32 v19, v22, v23
  v_mfma_f32_16x16x32_bf16 a[4:7], a[164:167], v[104:107], a[4:7]
  ds_read_b64_tr_b16 a[178:179], v218 offset:20480
  v_exp_f32 v29, v29
  v_mfma_f32_16x16x32_bf16 a[4:7], a[160:163], v[72:75], a[4:7]
  v_add_f32 v211, v211, v28
  v_mfma_f32_16x16x32_bf16 a[8:11], a[160:163], v[80:83], a[8:11]
  ds_read_b64_tr_b16 a[180:181], v218 offset:24576
  v_exp_f32 v30, v30
  v_mfma_f32_16x16x32_bf16 a[8:11], a[164:167], v[112:115], a[8:11]
  v_add_f32 v211, v211, v29
  v_cvt_pk_bf16_f32 v26, v28, v29
  v_mfma_f32_16x16x32_bf16 a[12:15], a[164:167], v[120:123], a[12:15]
  ds_read_b64_tr_b16 a[182:183], v218 offset:28672
  v_exp_f32 v31, v31
  v_mfma_f32_16x16x32_bf16 a[12:15], a[160:163], v[88:91], a[12:15]
  s_waitcnt lgkmcnt(4)
  v_add_f32 v211, v211, v30
  v_mfma_f32_16x16x32_bf16 a[16:19], a[168:171], v[64:67], a[16:19]
  ds_read_b64_tr_b16 a[184:185], v219 offset:16384
  v_exp_f32 v32, v32
  v_mfma_f32_16x16x32_bf16 a[16:19], a[172:175], v[96:99], a[16:19]
  v_add_f32 v211, v211, v31
  v_cvt_pk_bf16_f32 v27, v30, v31
  v_mfma_f32_16x16x32_bf16 a[20:23], a[172:175], v[104:107], a[20:23]
  ds_read_b64_tr_b16 a[186:187], v219 offset:20480
  v_exp_f32 v33, v33
  v_mfma_f32_16x16x32_bf16 a[20:23], a[168:171], v[72:75], a[20:23]
  v_add_f32 v208, v208, v32
  v_mfma_f32_16x16x32_bf16 a[24:27], a[168:171], v[80:83], a[24:27]
  ds_read_b64_tr_b16 a[188:189], v219 offset:24576
  v_exp_f32 v34, v34
  v_mfma_f32_16x16x32_bf16 a[24:27], a[172:175], v[112:115], a[24:27]
  v_add_f32 v208, v208, v33
  v_cvt_pk_bf16_f32 v32, v32, v33
  v_mfma_f32_16x16x32_bf16 a[28:31], a[172:175], v[120:123], a[28:31]
  ds_read_b64_tr_b16 a[190:191], v219 offset:28672
  v_exp_f32 v35, v35
  v_mfma_f32_16x16x32_bf16 a[28:31], a[168:171], v[88:91], a[28:31]
  s_waitcnt lgkmcnt(4)
  v_add_f32 v208, v208, v34
  v_mfma_f32_16x16x32_bf16 a[32:35], a[176:179], v[64:67], a[32:35]
  ds_read_b64_tr_b16 a[160:161], v220 offset:16384
  v_exp_f32 v40, v40
  v_mfma_f32_16x16x32_bf16 a[32:35], a[180:183], v[96:99], a[32:35]
  v_add_f32 v208, v208, v35
  v_cvt_pk_bf16_f32 v33, v34, v35
  v_mfma_f32_16x16x32_bf16 a[36:39], a[180:183], v[104:107], a[36:39]
  ds_read_b64_tr_b16 a[162:163], v220 offset:20480
  v_exp_f32 v41, v41
  v_mfma_f32_16x16x32_bf16 a[36:39], a[176:179], v[72:75], a[36:39]
  v_add_f32 v209, v209, v40
  v_mfma_f32_16x16x32_bf16 a[40:43], a[176:179], v[80:83], a[40:43]
  ds_read_b64_tr_b16 a[164:165], v220 offset:24576
  v_exp_f32 v42, v42
  v_mfma_f32_16x16x32_bf16 a[40:43], a[180:183], v[112:115], a[40:43]
  v_add_f32 v209, v209, v41
  v_cvt_pk_bf16_f32 v40, v40, v41
  v_mfma_f32_16x16x32_bf16 a[44:47], a[180:183], v[120:123], a[44:47]
  ds_read_b64_tr_b16 a[166:167], v220 offset:28672
  v_exp_f32 v43, v43
  v_mfma_f32_16x16x32_bf16 a[44:47], a[176:179], v[88:91], a[44:47]
  s_waitcnt lgkmcnt(4)
  v_add_f32 v209, v209, v42
  v_mfma_f32_16x16x32_bf16 a[48:51], a[184:187], v[64:67], a[48:51]
  ds_read_b64_tr_b16 a[168:169], v221 offset:16384
  v_exp_f32 v48, v48
  v_mfma_f32_16x16x32_bf16 a[48:51], a[188:191], v[96:99], a[48:51]
  v_add_f32 v209, v209, v43
  v_cvt_pk_bf16_f32 v41, v42, v43
  v_mfma_f32_16x16x32_bf16 a[52:55], a[188:191], v[104:107], a[52:55]
  ds_read_b64_tr_b16 a[170:171], v221 offset:20480
  v_exp_f32 v49, v49
  v_mfma_f32_16x16x32_bf16 a[52:55], a[184:187], v[72:75], a[52:55]
  v_add_f32 v210, v210, v48
  v_mfma_f32_16x16x32_bf16 a[56:59], a[184:187], v[80:83], a[56:59]
  ds_read_b64_tr_b16 a[172:173], v221 offset:24576
  v_exp_f32 v50, v50
  v_mfma_f32_16x16x32_bf16 a[56:59], a[188:191], v[112:115], a[56:59]
  v_add_f32 v210, v210, v49
  v_cvt_pk_bf16_f32 v48, v48, v49
  v_mfma_f32_16x16x32_bf16 a[60:63], a[188:191], v[120:123], a[60:63]
  ds_read_b64_tr_b16 a[174:175], v221 offset:28672
  v_exp_f32 v51, v51
  v_mfma_f32_16x16x32_bf16 a[60:63], a[184:187], v[88:91], a[60:63]
  s_waitcnt lgkmcnt(4)
  v_add_f32 v210, v210, v50
  v_mfma_f32_16x16x32_bf16 a[64:67], a[160:163], v[64:67], a[64:67]
  ds_read_b64_tr_b16 a[176:177], v222 offset:16384
  v_exp_f32 v56, v56
  v_mfma_f32_16x16x32_bf16 a[64:67], a[164:167], v[96:99], a[64:67]
  v_add_f32 v210, v210, v51
  v_cvt_pk_bf16_f32 v49, v50, v51
  v_mfma_f32_16x16x32_bf16 a[68:71], a[164:167], v[104:107], a[68:71]
  ds_read_b64_tr_b16 a[178:179], v222 offset:20480
  v_exp_f32 v57, v57
  v_mfma_f32_16x16x32_bf16 a[68:71], a[160:163], v[72:75], a[68:71]
  v_add_f32 v211, v211, v56
  v_mfma_f32_16x16x32_bf16 a[72:75], a[160:163], v[80:83], a[72:75]
  ds_read_b64_tr_b16 a[180:181], v222 offset:24576
  v_exp_f32 v58, v58
  v_mfma_f32_16x16x32_bf16 a[72:75], a[164:167], v[112:115], a[72:75]
  v_add_f32 v211, v211, v57
  v_cvt_pk_bf16_f32 v56, v56, v57
  v_mfma_f32_16x16x32_bf16 a[76:79], a[164:167], v[120:123], a[76:79]
  ds_read_b64_tr_b16 a[182:183], v222 offset:28672
  v_exp_f32 v59, v59
  v_mfma_f32_16x16x32_bf16 a[76:79], a[160:163], v[88:91], a[76:79]
  s_waitcnt lgkmcnt(4)
  v_add_f32 v211, v211, v58
  v_mfma_f32_16x16x32_bf16 a[80:83], a[168:171], v[64:67], a[80:83]
  ds_read_b64_tr_b16 a[184:185], v223 offset:16384
  v_exp_f32 v36, v36
  v_mfma_f32_16x16x32_bf16 a[80:83], a[172:175], v[96:99], a[80:83]
  v_add_f32 v211, v211, v59
  v_cvt_pk_bf16_f32 v57, v58, v59
  v_mfma_f32_16x16x32_bf16 a[84:87], a[172:175], v[104:107], a[84:87]
  ds_read_b64_tr_b16 a[186:187], v223 offset:20480
  v_exp_f32 v37, v37
  v_mfma_f32_16x16x32_bf16 a[84:87], a[168:171], v[72:75], a[84:87]
  v_add_f32 v208, v208, v36
  v_mfma_f32_16x16x32_bf16 a[88:91], a[168:171], v[80:83], a[88:91]
  ds_read_b64_tr_b16 a[188:189], v223 offset:24576
  v_exp_f32 v38, v38
  v_mfma_f32_16x16x32_bf16 a[88:91], a[172:175], v[112:115], a[88:91]
  v_add_f32 v208, v208, v37
  v_cvt_pk_bf16_f32 v34, v36, v37
  v_mfma_f32_16x16x32_bf16 a[92:95], a[172:175], v[120:123], a[92:95]
  ds_read_b64_tr_b16 a[190:191], v223 offset:28672
  v_exp_f32 v39, v39
  v_mfma_f32_16x16x32_bf16 a[92:95], a[168:171], v[88:91], a[92:95]
  s_waitcnt lgkmcnt(4)
  v_add_f32 v208, v208, v38
  v_mfma_f32_16x16x32_bf16 a[96:99], a[176:179], v[64:67], a[96:99]
  s_waitcnt vmcnt(8)
  v_exp_f32 v44, v44
  v_mfma_f32_16x16x32_bf16 a[96:99], a[180:183], v[96:99], a[96:99]
  s_barrier
  v_add_f32 v208, v208, v39
  v_cvt_pk_bf16_f32 v35, v38, v39
  v_mfma_f32_16x16x32_bf16 a[100:103], a[180:183], v[104:107], a[100:103]
  ds_read_b128 a[128:131], v212 offset:49152
  v_exp_f32 v45, v45
  v_mfma_f32_16x16x32_bf16 a[100:103], a[176:179], v[72:75], a[100:103]
  v_add_f32 v209, v209, v44
  v_mfma_f32_16x16x32_bf16 a[104:107], a[176:179], v[80:83], a[104:107]
  ds_read_b128 a[132:135], v213 offset:49152
  v_exp_f32 v46, v46
  v_mfma_f32_16x16x32_bf16 a[104:107], a[180:183], v[112:115], a[104:107]
  v_add_f32 v209, v209, v45
  v_cvt_pk_bf16_f32 v42, v44, v45
  v_mfma_f32_16x16x32_bf16 a[108:111], a[180:183], v[120:123], a[108:111]
  ds_read_b128 a[136:139], v214 offset:49152
  v_exp_f32 v47, v47
  v_mfma_f32_16x16x32_bf16 a[108:111], a[176:179], v[88:91], a[108:111]
  s_waitcnt lgkmcnt(3)
  v_add_f32 v209, v209, v46
  v_mfma_f32_16x16x32_bf16 a[112:115], a[184:187], v[64:67], a[112:115]
  ds_read_b128 a[140:143], v215 offset:49152
  v_exp_f32 v52, v52
  v_mfma_f32_16x16x32_bf16 a[112:115], a[188:191], v[96:99], a[112:115]
  v_add_f32 v209, v209, v47
  v_cvt_pk_bf16_f32 v43, v46, v47
  v_mfma_f32_16x16x32_bf16 a[116:119], a[188:191], v[104:107], a[116:119]
  v_exp_f32 v53, v53
  v_mfma_f32_16x16x32_bf16 a[116:119], a[184:187], v[72:75], a[116:119]
  v_add_f32 v210, v210, v52
  v_mfma_f32_16x16x32_bf16 a[120:123], a[184:187], v[80:83], a[120:123]
  v_exp_f32 v54, v54
  v_mfma_f32_16x16x32_bf16 a[120:123], a[188:191], v[112:115], a[120:123]
  v_add_f32 v210, v210, v53
  v_cvt_pk_bf16_f32 v50, v52, v53
  v_mfma_f32_16x16x32_bf16 a[124:127], a[188:191], v[120:123], a[124:127]
  v_exp_f32 v55, v55
  v_mfma_f32_16x16x32_bf16 a[124:127], a[184:187], v[88:91], a[124:127]
  s_waitcnt lgkmcnt(0)
  v_add_f32 v210, v210, v54
  v_mfma_f32_16x16x32_bf16 v[64:67], a[128:131], v[128:131], v[192:195]
  ds_read_b128 a[144:147], v212 offset:53248
  v_exp_f32 v60, v60
  v_mfma_f32_16x16x32_bf16 v[64:67], a[132:135], v[132:135], v[64:67]
  v_add_f32 v210, v210, v55
  v_cvt_pk_bf16_f32 v51, v54, v55
  v_mfma_f32_16x16x32_bf16 v[64:67], a[136:139], v[136:139], v[64:67]
  ds_read_b128 a[148:151], v213 offset:53248
  v_exp_f32 v61, v61
  v_mfma_f32_16x16x32_bf16 v[64:67], a[140:143], v[140:143], v[64:67]
  v_add_f32 v211, v211, v60
  v_mfma_f32_16x16x32_bf16 v[72:75], a[140:143], v[156:159], v[196:199]
  ds_read_b128 a[152:155], v214 offset:53248
  v_exp_f32 v62, v62
  v_mfma_f32_16x16x32_bf16 v[72:75], a[136:139], v[152:155], v[72:75]
  v_add_f32 v211, v211, v61
  v_cvt_pk_bf16_f32 v58, v60, v61
  v_mfma_f32_16x16x32_bf16 v[72:75], a[132:135], v[148:151], v[72:75]
  ds_read_b128 a[156:159], v215 offset:53248
  v_exp_f32 v63, v63
  v_mfma_f32_16x16x32_bf16 v[72:75], a[128:131], v[144:147], v[72:75]
  v_add_f32 v211, v211, v62
  v_mfma_f32_16x16x32_bf16 v[80:83], a[128:131], v[160:163], v[200:203]
  s_add_u32 m0, s28, 65536
  v_exp_f32 v64, v64
  v_mfma_f32_16x16x32_bf16 v[80:83], a[132:135], v[164:167], v[80:83]
  buffer_load_dwordx4 v236, s[16:19], s29 offen offset:0 lds
  v_add_f32 v211, v211, v63
  v_cvt_pk_bf16_f32 v59, v62, v63
  v_mfma_f32_16x16x32_bf16 v[80:83], a[136:139], v[168:171], v[80:83]
  v_exp_f32 v65, v65
  v_mfma_f32_16x16x32_bf16 v[80:83], a[140:143], v[172:175], v[80:83]
  buffer_load_dwordx4 v237, s[16:19], s29 offen offset:1024 lds
  v_add_f32 v208, v208, v64
  v_mfma_f32_16x16x32_bf16 v[88:91], a[140:143], v[188:191], v[204:207]
  v_exp_f32 v66, v66
  v_mfma_f32_16x16x32_bf16 v[88:91], a[136:139], v[184:187], v[88:91]
  buffer_load_dwordx4 v236, s[16:19], s29 offen offset:2048 lds
  v_add_f32 v208, v208, v65
  v_cvt_pk_bf16_f32 v64, v64, v65
  v_mfma_f32_16x16x32_bf16 v[88:91], a[132:135], v[180:183], v[88:91]
  v_exp_f32 v67, v67
  v_mfma_f32_16x16x32_bf16 v[88:91], a[128:131], v[176:179], v[88:91]
  s_waitcnt lgkmcnt(0)
  v_add_f32 v208, v208, v66
  v_mfma_f32_16x16x32_bf16 v[68:71], a[144:147], v[128:131], v[192:195]
  ds_read_b128 a[128:131], v212 offset:57344
  v_exp_f32 v72, v72
  v_mfma_f32_16x16x32_bf16 v[68:71], a[148:151], v[132:135], v[68:71]
  v_add_f32 v208, v208, v67
  v_cvt_pk_bf16_f32 v65, v66, v67
  v_mfma_f32_16x16x32_bf16 v[68:71], a[152:155], v[136:139], v[68:71]
  ds_read_b128 a[132:135], v213 offset:57344
  v_exp_f32 v73, v73
  v_mfma_f32_16x16x32_bf16 v[68:71], a[156:159], v[140:143], v[68:71]
  v_add_f32 v209, v209, v72
  v_mfma_f32_16x16x32_bf16 v[76:79], a[156:159], v[156:159], v[196:199]
  ds_read_b128 a[136:139], v214 offset:57344
  v_exp_f32 v74, v74
  v_mfma_f32_16x16x32_bf16 v[76:79], a[152:155], v[152:155], v[76:79]
  v_add_f32 v209, v209, v73
  v_cvt_pk_bf16_f32 v72, v72, v73
  v_mfma_f32_16x16x32_bf16 v[76:79], a[148:151], v[148:151], v[76:79]
  ds_read_b128 a[140:143], v215 offset:57344
  v_exp_f32 v75, v75
  v_mfma_f32_16x16x32_bf16 v[76:79], a[144:147], v[144:147], v[76:79]
  v_add_f32 v209, v209, v74
  v_mfma_f32_16x16x32_bf16 v[84:87], a[144:147], v[160:163], v[200:203]
  buffer_load_dwordx4 v237, s[16:19], s29 offen offset:3072 lds
  v_exp_f32 v80, v80
  v_mfma_f32_16x16x32_bf16 v[84:87], a[148:151], v[164:167], v[84:87]
  s_add_u32 s29, s29, 16384
  v_add_f32 v209, v209, v75
  v_cvt_pk_bf16_f32 v73, v74, v75
  v_mfma_f32_16x16x32_bf16 v[84:87], a[152:155], v[168:171], v[84:87]
  s_add_u32 m0, s28, 16384
  v_exp_f32 v81, v81
  v_mfma_f32_16x16x32_bf16 v[84:87], a[156:159], v[172:175], v[84:87]
  buffer_load_dwordx4 v232, s[12:15], s29 offen offset:0 lds
  v_add_f32 v210, v210, v80
  v_mfma_f32_16x16x32_bf16 v[92:95], a[156:159], v[188:191], v[204:207]
  v_exp_f32 v82, v82
  v_mfma_f32_16x16x32_bf16 v[92:95], a[152:155], v[184:187], v[92:95]
  buffer_load_dwordx4 v233, s[12:15], s29 offen offset:1024 lds
  v_add_f32 v210, v210, v81
  v_cvt_pk_bf16_f32 v80, v80, v81
  v_mfma_f32_16x16x32_bf16 v[92:95], a[148:151], v[180:183], v[92:95]
  v_exp_f32 v83, v83
  v_mfma_f32_16x16x32_bf16 v[92:95], a[144:147], v[176:179], v[92:95]
  s_waitcnt lgkmcnt(0)
  v_add_f32 v210, v210, v82
  v_mfma_f32_16x16x32_bf16 v[96:99], a[128:131], v[128:131], v[192:195]
  ds_read_b128 a[144:147], v212 offset:61440
  v_exp_f32 v88, v88
  v_mfma_f32_16x16x32_bf16 v[96:99], a[132:135], v[132:135], v[96:99]
  v_add_f32 v210, v210, v83
  v_cvt_pk_bf16_f32 v81, v82, v83
  v_mfma_f32_16x16x32_bf16 v[96:99], a[136:139], v[136:139], v[96:99]
  ds_read_b128 a[148:151], v213 offset:61440
  v_exp_f32 v89, v89
  v_mfma_f32_16x16x32_bf16 v[96:99], a[140:143], v[140:143], v[96:99]
  v_add_f32 v211, v211, v88
  v_mfma_f32_16x16x32_bf16 v[104:107], a[140:143], v[156:159], v[196:199]
  ds_read_b128 a[152:155], v214 offset:61440
  v_exp_f32 v90, v90
  v_mfma_f32_16x16x32_bf16 v[104:107], a[136:139], v[152:155], v[104:107]
  v_add_f32 v211, v211, v89
  v_cvt_pk_bf16_f32 v88, v88, v89
  v_mfma_f32_16x16x32_bf16 v[104:107], a[132:135], v[148:151], v[104:107]
  ds_read_b128 a[156:159], v215 offset:61440
  v_exp_f32 v91, v91
  v_mfma_f32_16x16x32_bf16 v[104:107], a[128:131], v[144:147], v[104:107]
  v_add_f32 v211, v211, v90
  v_mfma_f32_16x16x32_bf16 v[112:115], a[128:131], v[160:163], v[200:203]
  buffer_load_dwordx4 v234, s[12:15], s29 offen offset:2048 lds
  v_exp_f32 v68, v68
  v_mfma_f32_16x16x32_bf16 v[112:115], a[132:135], v[164:167], v[112:115]
  v_add_f32 v211, v211, v91
  v_cvt_pk_bf16_f32 v89, v90, v91
  v_mfma_f32_16x16x32_bf16 v[112:115], a[136:139], v[168:171], v[112:115]
  buffer_load_dwordx4 v235, s[12:15], s29 offen offset:3072 lds
  v_exp_f32 v69, v69
  v_mfma_f32_16x16x32_bf16 v[112:115], a[140:143], v[172:175], v[112:115]
  v_add_f32 v208, v208, v68
  v_mfma_f32_16x16x32_bf16 v[120:123], a[140:143], v[188:191], v[204:207]
  v_exp_f32 v70, v70
  v_mfma_f32_16x16x32_bf16 v[120:123], a[136:139], v[184:187], v[120:123]
  v_add_f32 v208, v208, v69
  v_cvt_pk_bf16_f32 v66, v68, v69
  v_mfma_f32_16x16x32_bf16 v[120:123], a[132:135], v[180:183], v[120:123]
  v_exp_f32 v71, v71
  v_mfma_f32_16x16x32_bf16 v[120:123], a[128:131], v[176:179], v[120:123]
  s_waitcnt lgkmcnt(0)
  v_add_f32 v208, v208, v70
  v_mfma_f32_16x16x32_bf16 v[100:103], a[144:147], v[128:131], v[192:195]
  ds_read_b64_tr_b16 a[160:161], v216 offset:32768
  v_exp_f32 v76, v76
  v_mfma_f32_16x16x32_bf16 v[100:103], a[148:151], v[132:135], v[100:103]
  v_add_f32 v208, v208, v71
  v_cvt_pk_bf16_f32 v67, v70, v71
  v_mfma_f32_16x16x32_bf16 v[100:103], a[152:155], v[136:139], v[100:103]
  ds_read_b64_tr_b16 a[162:163], v216 offset:36864
  v_exp_f32 v77, v77
  v_mfma_f32_16x16x32_bf16 v[100:103], a[156:159], v[140:143], v[100:103]
  v_add_f32 v209, v209, v76
  v_mfma_f32_16x16x32_bf16 v[108:111], a[156:159], v[156:159], v[196:199]
  ds_read_b64_tr_b16 a[164:165], v216 offset:40960
  v_exp_f32 v78, v78
  v_mfma_f32_16x16x32_bf16 v[108:111], a[152:155], v[152:155], v[108:111]
  v_add_f32 v209, v209, v77
  v_cvt_pk_bf16_f32 v74, v76, v77
  v_mfma_f32_16x16x32_bf16 v[108:111], a[148:151], v[148:151], v[108:111]
  ds_read_b64_tr_b16 a[166:167], v216 offset:45056
  v_exp_f32 v79, v79
  v_mfma_f32_16x16x32_bf16 v[108:111], a[144:147], v[144:147], v[108:111]
  v_add_f32 v209, v209, v78
  v_mfma_f32_16x16x32_bf16 v[116:119], a[144:147], v[160:163], v[200:203]
  ds_read_b64_tr_b16 a[168:169], v217 offset:32768
  v_exp_f32 v84, v84
  v_mfma_f32_16x16x32_bf16 v[116:119], a[148:151], v[164:167], v[116:119]
  v_add_f32 v209, v209, v79
  v_cvt_pk_bf16_f32 v75, v78, v79
  v_mfma_f32_16x16x32_bf16 v[116:119], a[152:155], v[168:171], v[116:119]
  ds_read_b64_tr_b16 a[170:171], v217 offset:36864
  v_exp_f32 v85, v85
  v_mfma_f32_16x16x32_bf16 v[116:119], a[156:159], v[172:175], v[116:119]
  v_add_f32 v210, v210, v84
  v_mfma_f32_16x16x32_bf16 v[124:127], a[156:159], v[188:191], v[204:207]
  ds_read_b64_tr_b16 a[172:173], v217 offset:40960
  v_exp_f32 v86, v86
  v_mfma_f32_16x16x32_bf16 v[124:127], a[152:155], v[184:187], v[124:127]
  v_add_f32 v210, v210, v85
  v_cvt_pk_bf16_f32 v82, v84, v85
  v_mfma_f32_16x16x32_bf16 v[124:127], a[148:151], v[180:183], v[124:127]
  ds_read_b64_tr_b16 a[174:175], v217 offset:45056
  v_exp_f32 v87, v87
  v_mfma_f32_16x16x32_bf16 v[124:127], a[144:147], v[176:179], v[124:127]
  s_waitcnt lgkmcnt(4)
  v_add_f32 v210, v210, v86
  v_mfma_f32_16x16x32_bf16 a[0:3], a[160:163], v[0:3], a[0:3]
  ds_read_b64_tr_b16 a[176:177], v218 offset:32768
  v_exp_f32 v92, v92
  v_mfma_f32_16x16x32_bf16 a[0:3], a[164:167], v[32:35], a[0:3]
  v_add_f32 v210, v210, v87
  v_cvt_pk_bf16_f32 v83, v86, v87
  v_mfma_f32_16x16x32_bf16 a[4:7], a[164:167], v[40:43], a[4:7]
  ds_read_b64_tr_b16 a[178:179], v218 offset:36864
  v_exp_f32 v93, v93
  v_mfma_f32_16x16x32_bf16 a[4:7], a[160:163], v[8:11], a[4:7]
  v_add_f32 v211, v211, v92
  v_mfma_f32_16x16x32_bf16 a[8:11], a[160:163], v[16:19], a[8:11]
  ds_read_b64_tr_b16 a[180:181], v218 offset:40960
  v_exp_f32 v94, v94
  v_mfma_f32_16x16x32_bf16 a[8:11], a[164:167], v[48:51], a[8:11]
  v_add_f32 v211, v211, v93
  v_cvt_pk_bf16_f32 v90, v92, v93
  v_mfma_f32_16x16x32_bf16 a[12:15], a[164:167], v[56:59], a[12:15]
  ds_read_b64_tr_b16 a[182:183], v218 offset:45056
  v_exp_f32 v95, v95
  v_mfma_f32_16x16x32_bf16 a[12:15], a[160:163], v[24:27], a[12:15]
  s_waitcnt lgkmcnt(4)
  v_add_f32 v211, v211, v94
  v_mfma_f32_16x16x32_bf16 a[16:19], a[168:171], v[0:3], a[16:19]
  ds_read_b64_tr_b16 a[184:185], v219 offset:32768
  v_exp_f32 v96, v96
  v_mfma_f32_16x16x32_bf16 a[16:19], a[172:175], v[32:35], a[16:19]
  v_add_f32 v211, v211, v95
  v_cvt_pk_bf16_f32 v91, v94, v95
  v_mfma_f32_16x16x32_bf16 a[20:23], a[172:175], v[40:43], a[20:23]
  ds_read_b64_tr_b16 a[186:187], v219 offset:36864
  v_exp_f32 v97, v97
  v_mfma_f32_16x16x32_bf16 a[20:23], a[168:171], v[8:11], a[20:23]
  v_add_f32 v208, v208, v96
  v_mfma_f32_16x16x32_bf16 a[24:27], a[168:171], v[16:19], a[24:27]
  ds_read_b64_tr_b16 a[188:189], v219 offset:40960
  v_exp_f32 v98, v98
  v_mfma_f32_16x16x32_bf16 a[24:27], a[172:175], v[48:51], a[24:27]
  v_add_f32 v208, v208, v97
  v_cvt_pk_bf16_f32 v96, v96, v97
  v_mfma_f32_16x16x32_bf16 a[28:31], a[172:175], v[56:59], a[28:31]
  ds_read_b64_tr_b16 a[190:191], v219 offset:45056
  v_exp_f32 v99, v99
  v_mfma_f32_16x16x32_bf16 a[28:31], a[168:171], v[24:27], a[28:31]
  s_waitcnt lgkmcnt(4)
  v_add_f32 v208, v208, v98
  v_mfma_f32_16x16x32_bf16 a[32:35], a[176:179], v[0:3], a[32:35]
  ds_read_b64_tr_b16 a[160:161], v220 offset:32768
  v_exp_f32 v104, v104
  v_mfma_f32_16x16x32_bf16 a[32:35], a[180:183], v[32:35], a[32:35]
  v_add_f32 v208, v208, v99
  v_cvt_pk_bf16_f32 v97, v98, v99
  v_mfma_f32_16x16x32_bf16 a[36:39], a[180:183], v[40:43], a[36:39]
  ds_read_b64_tr_b16 a[162:163], v220 offset:36864
  v_exp_f32 v105, v105
  v_mfma_f32_16x16x32_bf16 a[36:39], a[176:179], v[8:11], a[36:39]
  v_add_f32 v209, v209, v104
  v_mfma_f32_16x16x32_bf16 a[40:43], a[176:179], v[16:19], a[40:43]
  ds_read_b64_tr_b16 a[164:165], v220 offset:40960
  v_exp_f32 v106, v106
  v_mfma_f32_16x16x32_bf16 a[40:43], a[180:183], v[48:51], a[40:43]
  v_add_f32 v209, v209, v105
  v_cvt_pk_bf16_f32 v104, v104, v105
  v_mfma_f32_16x16x32_bf16 a[44:47], a[180:183], v[56:59], a[44:47]
  ds_read_b64_tr_b16 a[166:167], v220 offset:45056
  v_exp_f32 v107, v107
  v_mfma_f32_16x16x32_bf16 a[44:47], a[176:179], v[24:27], a[44:47]
  s_waitcnt lgkmcnt(4)
  v_add_f32 v209, v209, v106
  v_mfma_f32_16x16x32_bf16 a[48:51], a[184:187], v[0:3], a[48:51]
  ds_read_b64_tr_b16 a[168:169], v221 offset:32768
  v_exp_f32 v112, v112
  v_mfma_f32_16x16x32_bf16 a[48:51], a[188:191], v[32:35], a[48:51]
  v_add_f32 v209, v209, v107
  v_cvt_pk_bf16_f32 v105, v106, v107
  v_mfma_f32_16x16x32_bf16 a[52:55], a[188:191], v[40:43], a[52:55]
  ds_read_b64_tr_b16 a[170:171], v221 offset:36864
  v_exp_f32 v113, v113
  v_mfma_f32_16x16x32_bf16 a[52:55], a[184:187], v[8:11], a[52:55]
  v_add_f32 v210, v210, v112
  v_mfma_f32_16x16x32_bf16 a[56:59], a[184:187], v[16:19], a[56:59]
  ds_read_b64_tr_b16 a[172:173], v221 offset:40960
  v_exp_f32 v114, v114
  v_mfma_f32_16x16x32_bf16 a[56:59], a[188:191], v[48:51], a[56:59]
  v_add_f32 v210, v210, v113
  v_cvt_pk_bf16_f32 v112, v112, v113
  v_mfma_f32_16x16x32_bf16 a[60:63], a[188:191], v[56:59], a[60:63]
  ds_read_b64_tr_b16 a[174:175], v221 offset:45056
  v_exp_f32 v115, v115
  v_mfma_f32_16x16x32_bf16 a[60:63], a[184:187], v[24:27], a[60:63]
  s_waitcnt lgkmcnt(4)
  v_add_f32 v210, v210, v114
  v_mfma_f32_16x16x32_bf16 a[64:67], a[160:163], v[0:3], a[64:67]
  ds_read_b64_tr_b16 a[176:177], v222 offset:32768
  v_exp_f32 v120, v120
  v_mfma_f32_16x16x32_bf16 a[64:67], a[164:167], v[32:35], a[64:67]
  v_add_f32 v210, v210, v115
  v_cvt_pk_bf16_f32 v113, v114, v115
  v_mfma_f32_16x16x32_bf16 a[68:71], a[164:167], v[40:43], a[68:71]
  ds_read_b64_tr_b16 a[178:179], v222 offset:36864
  v_exp_f32 v121, v121
  v_mfma_f32_16x16x32_bf16 a[68:71], a[160:163], v[8:11], a[68:71]
  v_add_f32 v211, v211, v120
  v_mfma_f32_16x16x32_bf16 a[72:75], a[160:163], v[16:19], a[72:75]
  ds_read_b64_tr_b16 a[180:181], v222 offset:40960
  v_exp_f32 v122, v122
  v_mfma_f32_16x16x32_bf16 a[72:75], a[164:167], v[48:51], a[72:75]
  v_add_f32 v211, v211, v121
  v_cvt_pk_bf16_f32 v120, v120, v121
  v_mfma_f32_16x16x32_bf16 a[76:79], a[164:167], v[56:59], a[76:79]
  ds_read_b64_tr_b16 a[182:183], v222 offset:45056
  v_exp_f32 v123, v123
  v_mfma_f32_16x16x32_bf16 a[76:79], a[160:163], v[24:27], a[76:79]
  s_waitcnt lgkmcnt(4)
  v_add_f32 v211, v211, v122
  v_mfma_f32_16x16x32_bf16 a[80:83], a[168:171], v[0:3], a[80:83]
  ds_read_b64_tr_b16 a[184:185], v223 offset:32768
  v_exp_f32 v100, v100
  v_mfma_f32_16x16x32_bf16 a[80:83], a[172:175], v[32:35], a[80:83]
  v_add_f32 v211, v211, v123
  v_cvt_pk_bf16_f32 v121, v122, v123
  v_mfma_f32_16x16x32_bf16 a[84:87], a[172:175], v[40:43], a[84:87]
  ds_read_b64_tr_b16 a[186:187], v223 offset:36864
  v_exp_f32 v101, v101
  v_mfma_f32_16x16x32_bf16 a[84:87], a[168:171], v[8:11], a[84:87]
  v_add_f32 v208, v208, v100
  v_mfma_f32_16x16x32_bf16 a[88:91], a[168:171], v[16:19], a[88:91]
  ds_read_b64_tr_b16 a[188:189], v223 offset:40960
  v_exp_f32 v102, v102
  v_mfma_f32_16x16x32_bf16 a[88:91], a[172:175], v[48:51], a[88:91]
  v_add_f32 v208, v208, v101
  v_cvt_pk_bf16_f32 v98, v100, v101
  v_mfma_f32_16x16x32_bf16 a[92:95], a[172:175], v[56:59], a[92:95]
  ds_read_b64_tr_b16 a[190:191], v223 offset:45056
  v_exp_f32 v103, v103
  v_mfma_f32_16x16x32_bf16 a[92:95], a[168:171], v[24:27], a[92:95]
  s_waitcnt lgkmcnt(4)
  v_add_f32 v208, v208, v102
  v_mfma_f32_16x16x32_bf16 a[96:99], a[176:179], v[0:3], a[96:99]
  s_waitcnt vmcnt(8)
  v_exp_f32 v108, v108
  v_mfma_f32_16x16x32_bf16 a[96:99], a[180:183], v[32:35], a[96:99]
  s_barrier
  v_add_f32 v208, v208, v103
  v_cvt_pk_bf16_f32 v99, v102, v103
  v_mfma_f32_16x16x32_bf16 a[100:103], a[180:183], v[40:43], a[100:103]
  ds_read_b128 a[128:131], v212 offset:0
  v_exp_f32 v109, v109
  v_mfma_f32_16x16x32_bf16 a[100:103], a[176:179], v[8:11], a[100:103]
  v_add_f32 v209, v209, v108
  v_mfma_f32_16x16x32_bf16 a[104:107], a[176:179], v[16:19], a[104:107]
  ds_read_b128 a[132:135], v213 offset:0
  v_exp_f32 v110, v110
  v_mfma_f32_16x16x32_bf16 a[104:107], a[180:183], v[48:51], a[104:107]
  v_add_f32 v209, v209, v109
  v_cvt_pk_bf16_f32 v106, v108, v109
  v_mfma_f32_16x16x32_bf16 a[108:111], a[180:183], v[56:59], a[108:111]
  ds_read_b128 a[136:139], v214 offset:0
  v_exp_f32 v111, v111
  v_mfma_f32_16x16x32_bf16 a[108:111], a[176:179], v[24:27], a[108:111]
  s_waitcnt lgkmcnt(3)
  v_add_f32 v209, v209, v110
  v_mfma_f32_16x16x32_bf16 a[112:115], a[184:187], v[0:3], a[112:115]
  ds_read_b128 a[140:143], v215 offset:0
  v_exp_f32 v116, v116
  v_mfma_f32_16x16x32_bf16 a[112:115], a[188:191], v[32:35], a[112:115]
  v_add_f32 v209, v209, v111
  v_cvt_pk_bf16_f32 v107, v110, v111
  v_mfma_f32_16x16x32_bf16 a[116:119], a[188:191], v[40:43], a[116:119]
  s_sub_u32 s32, s32, 1
  v_exp_f32 v117, v117
  v_mfma_f32_16x16x32_bf16 a[116:119], a[184:187], v[8:11], a[116:119]
  v_add_f32 v210, v210, v116
  v_mfma_f32_16x16x32_bf16 a[120:123], a[184:187], v[16:19], a[120:123]
  s_cmp_lg_u32 s32, 0
  v_exp_f32 v118, v118
  v_mfma_f32_16x16x32_bf16 a[120:123], a[188:191], v[48:51], a[120:123]
  v_add_f32 v210, v210, v117
  v_cvt_pk_bf16_f32 v114, v116, v117
  v_mfma_f32_16x16x32_bf16 a[124:127], a[188:191], v[56:59], a[124:127]
  v_exp_f32 v119, v119
  v_mfma_f32_16x16x32_bf16 a[124:127], a[184:187], v[24:27], a[124:127]
  s_waitcnt lgkmcnt(0)
  v_add_f32 v210, v210, v118
  s_cbranch_scc1 attn_loop
  ds_read_b64_tr_b16 a[160:161], v216 offset:49152
  ds_read_b64_tr_b16 a[162:163], v216 offset:53248
  ds_read_b64_tr_b16 a[164:165], v216 offset:57344
  ds_read_b64_tr_b16 a[166:167], v216 offset:61440
  ds_read_b64_tr_b16 a[168:169], v217 offset:49152
  ds_read_b64_tr_b16 a[170:171], v217 offset:53248
  ds_read_b64_tr_b16 a[172:173], v217 offset:57344
  ds_read_b64_tr_b16 a[174:175], v217 offset:61440
  v_exp_f32 v124, v124
  v_add_f32 v210, v210, v119
  v_cvt_pk_bf16_f32 v115, v118, v119
  v_exp_f32 v125, v125
  v_add_f32 v211, v211, v124
  v_exp_f32 v126, v126
  v_add_f32 v211, v211, v125
  v_cvt_pk_bf16_f32 v122, v124, v125
  v_exp_f32 v127, v127
  v_add_f32 v211, v211, v126
  v_add_f32 v211, v211, v127
  v_cvt_pk_bf16_f32 v123, v126, v127
  v_mov_b32 v245, v208
  v_mov_b32 v246, v209
  v_mov_b32 v247, v210
  v_mov_b32 v248, v211
  v_permlane16_swap_b32 v208, v245
  v_permlane16_swap_b32 v209, v246
  v_permlane16_swap_b32 v210, v247
  v_permlane16_swap_b32 v211, v248
  v_add_f32 v208, v208, v245
  v_add_f32 v209, v209, v246
  v_add_f32 v210, v210, v247
  v_add_f32 v211, v211, v248
  v_mov_b32 v245, v208
  v_mov_b32 v246, v209
  v_mov_b32 v247, v210
  v_mov_b32 v248, v211
  v_permlane32_swap_b32 v208, v245
  v_permlane32_swap_b32 v209, v246
  v_permlane32_swap_b32 v210, v247
  v_permlane32_swap_b32 v211, v248
  v_add_f32 v208, v208, v245
  v_add_f32 v209, v209, v246
  v_add_f32 v210, v210, v247
  v_add_f32 v211, v211, v248
  v_rcp_f32 v192, v208
  v_rcp_f32 v196, v209
  v_rcp_f32 v200, v210
  v_rcp_f32 v204, v211
  s_mov_b32 s38, 0x5d800000
  v_max3_f32 v245, v208, v209, v210
  v_max_f32 v245, v245, v211
  v_add_f32 v246, v208, v209
  v_add_f32 v247, v210, v211
  v_add_f32 v246, v246, v247
  v_cmp_nlt_f32 vcc, v246, s38
  s_nop 1
  v_cndmask_b32_e64 v245, 0, 1, vcc
  v_lshrrev_b32 v246, 2, v242
  s_lshl_b32 s38, s3, 8
  v_add_u32 v246, s38, v246
  v_add_u32 v246, 131072, v246
  ds_write_b32 v246, v245
  s_waitcnt lgkmcnt(5)
  v_mfma_f32_16x16x32_bf16 a[0:3], a[160:163], v[64:67], a[0:3]
  ds_read_b64_tr_b16 a[176:177], v218 offset:49152
  v_mfma_f32_16x16x32_bf16 a[0:3], a[164:167], v[96:99], a[0:3]
  v_mfma_f32_16x16x32_bf16 a[4:7], a[164:167], v[104:107], a[4:7]
  ds_read_b64_tr_b16 a[178:179], v218 offset:53248
  v_mfma_f32_16x16x32_bf16 a[4:7], a[160:163], v[72:75], a[4:7]
  v_mfma_f32_16x16x32_bf16 a[8:11], a[160:163], v[80:83], a[8:11]
  ds_read_b64_tr_b16 a[180:181], v218 offset:57344
  v_mfma_f32_16x16x32_bf16 a[8:11], a[164:167], v[112:115], a[8:11]
  v_mfma_f32_16x16x32_bf16 a[12:15], a[164:167], v[120:123], a[12:15]
  ds_read_b64_tr_b16 a[182:183], v218 offset:61440
  v_mfma_f32_16x16x32_bf16 a[12:15], a[160:163], v[88:91], a[12:15]
  s_waitcnt lgkmcnt(5)
  v_mfma_f32_16x16x32_bf16 a[16:19], a[168:171], v[64:67], a[16:19]
  ds_read_b64_tr_b16 a[184:185], v219 offset:49152
  v_mfma_f32_16x16x32_bf16 a[16:19], a[172:175], v[96:99], a[16:19]
  v_mfma_f32_16x16x32_bf16 a[20:23], a[172:175], v[104:107], a[20:23]
  ds_read_b64_tr_b16 a[186:187], v219 offset:53248
  v_mfma_f32_16x16x32_bf16 a[20:23], a[168:171], v[72:75], a[20:23]
  v_mfma_f32_16x16x32_bf16 a[24:27], a[168:171], v[80:83], a[24:27]
  ds_read_b64_tr_b16 a[188:189], v219 offset:57344
  v_mfma_f32_16x16x32_bf16 a[24:27], a[172:175], v[112:115], a[24:27]
  v_accvgpr_read_b32 v0, a0
  v_accvgpr_read_b32 v1, a1
  v_mfma_f32_16x16x32_bf16 a[28:31], a[172:175], v[120:123], a[28:31]
  ds_read_b64_tr_b16 a[190:191], v219 offset:61440
  v_accvgpr_read_b32 v2, a2
  v_accvgpr_read_b32 v3, a3
  v_mfma_f32_16x16x32_bf16 a[28:31], a[168:171], v[88:91], a[28:31]
  s_waitcnt lgkmcnt(4)
  v_accvgpr_read_b32 v4, a16
  v_accvgpr_read_b32 v5, a17
  v_mfma_f32_16x16x32_bf16 a[32:35], a[176:179], v[64:67], a[32:35]
  ds_read_b64_tr_b16 a[160:161], v220 offset:49152
  v_accvgpr_read_b32 v6, a18
  v_accvgpr_read_b32 v7, a19
  v_mfma_f32_16x16x32_bf16 a[32:35], a[180:183], v[96:99], a[32:35]
  v_mul_f32 v0, v0, v192
  v_mul_f32 v1, v1, v192
  v_mfma_f32_16x16x32_bf16 a[36:39], a[180:183], v[104:107], a[36:39]
  ds_read_b64_tr_b16 a[162:163], v220 offset:53248
  v_mul_f32 v2, v2, v192
  v_mul_f32 v3, v3, v192
  v_mfma_f32_16x16x32_bf16 a[36:39], a[176:179], v[72:75], a[36:39]
  v_mul_f32 v4, v4, v192
  v_mul_f32 v5, v5, v192
  v_mfma_f32_16x16x32_bf16 a[40:43], a[176:179], v[80:83], a[40:43]
  ds_read_b64_tr_b16 a[164:165], v220 offset:57344
  v_mul_f32 v6, v6, v192
  v_mul_f32 v7, v7, v192
  v_mfma_f32_16x16x32_bf16 a[40:43], a[180:183], v[112:115], a[40:43]
  v_cvt_pk_bf16_f32 v0, v0, v1
  v_cvt_pk_bf16_f32 v1, v2, v3
  v_mfma_f32_16x16x32_bf16 a[44:47], a[180:183], v[120:123], a[44:47]
  ds_read_b64_tr_b16 a[166:167], v220 offset:61440
  v_cvt_pk_bf16_f32 v2, v4, v5
  v_cvt_pk_bf16_f32 v3, v6, v7
  v_mfma_f32_16x16x32_bf16 a[44:47], a[176:179], v[88:91], a[44:47]
  s_waitcnt lgkmcnt(4)
  buffer_store_dwordx4 v[0:3], v244, s[24:27], s40 offen offset:0
  v_accvgpr_read_b32 v8, a4
  v_mfma_f32_16x16x32_bf16 a[48:51], a[184:187], v[64:67], a[48:51]
  ds_read_b64_tr_b16 a[168:169], v221 offset:49152
  v_accvgpr_read_b32 v9, a5
  v_accvgpr_read_b32 v10, a6
  v_mfma_f32_16x16x32_bf16 a[48:51], a[188:191], v[96:99], a[48:51]
  v_accvgpr_read_b32 v11, a7
  v_accvgpr_read_b32 v12, a20
  v_mfma_f32_16x16x32_bf16 a[52:55], a[188:191], v[104:107], a[52:55]
  ds_read_b64_tr_b16 a[170:171], v221 offset:53248
  v_accvgpr_read_b32 v13, a21
  v_accvgpr_read_b32 v14, a22
  v_mfma_f32_16x16x32_bf16 a[52:55], a[184:187], v[72:75], a[52:55]
  v_accvgpr_read_b32 v15, a23
  v_mul_f32 v8, v8, v196
  v_mfma_f32_16x16x32_bf16 a[56:59], a[184:187], v[80:83], a[56:59]
  ds_read_b64_tr_b16 a[172:173], v221 offset:57344
  v_mul_f32 v9, v9, v196
  v_mul_f32 v10, v10, v196
  v_mfma_f32_16x16x32_bf16 a[56:59], a[188:191], v[112:115], a[56:59]
  v_mul_f32 v11, v11, v196
  v_mul_f32 v12, v12, v196
  v_mfma_f32_16x16x32_bf16 a[60:63], a[188:191], v[120:123], a[60:63]
  ds_read_b64_tr_b16 a[174:175], v221 offset:61440
  v_mul_f32 v13, v13, v196
  v_mul_f32 v14, v14, v196
  v_mfma_f32_16x16x32_bf16 a[60:63], a[184:187], v[88:91], a[60:63]
  s_waitcnt lgkmcnt(4)
  v_mul_f32 v15, v15, v196
  v_cvt_pk_bf16_f32 v8, v8, v9
  v_mfma_f32_16x16x32_bf16 a[64:67], a[160:163], v[64:67], a[64:67]
  ds_read_b64_tr_b16 a[176:177], v222 offset:49152
  v_cvt_pk_bf16_f32 v9, v10, v11
  v_cvt_pk_bf16_f32 v10, v12, v13
  v_mfma_f32_16x16x32_bf16 a[64:67], a[164:167], v[96:99], a[64:67]
  v_cvt_pk_bf16_f32 v11, v14, v15
  buffer_store_dwordx4 v[8:11], v244, s[24:27], s40 offen offset:2048
  v_mfma_f32_16x16x32_bf16 a[68:71], a[164:167], v[104:107], a[68:71]
  ds_read_b64_tr_b16 a[178:179], v222 offset:53248
  v_accvgpr_read_b32 v16, a8
  v_accvgpr_read_b32 v17, a9
  v_mfma_f32_16x16x32_bf16 a[68:71], a[160:163], v[72:75], a[68:71]
  v_accvgpr_read_b32 v18, a10
  v_accvgpr_read_b32 v19, a11
  v_mfma_f32_16x16x32_bf16 a[72:75], a[160:163], v[80:83], a[72:75]
  ds_read_b64_tr_b16 a[180:181], v222 offset:57344
  v_accvgpr_read_b32 v20, a24
  v_accvgpr_read_b32 v21, a25
  v_mfma_f32_16x16x32_bf16 a[72:75], a[164:167], v[112:115], a[72:75]
  v_accvgpr_read_b32 v22, a26
  v_accvgpr_read_b32 v23, a27
  v_mfma_f32_16x16x32_bf16 a[76:79], a[164:167], v[120:123], a[76:79]
  ds_read_b64_tr_b16 a[182:183], v222 offset:61440
  v_mul_f32 v16, v16, v200
  v_mul_f32 v17, v17, v200
  v_mfma_f32_16x16x32_bf16 a[76:79], a[160:163], v[88:91], a[76:79]
  s_waitcnt lgkmcnt(4)
  v_mul_f32 v18, v18, v200
  v_mul_f32 v19, v19, v200
  v_mfma_f32_16x16x32_bf16 a[80:83], a[168:171], v[64:67], a[80:83]
  ds_read_b64_tr_b16 a[184:185], v223 offset:49152
  v_mul_f32 v20, v20, v200
  v_mul_f32 v21, v21, v200
  v_mfma_f32_16x16x32_bf16 a[80:83], a[172:175], v[96:99], a[80:83]
  v_mul_f32 v22, v22, v200
  v_mul_f32 v23, v23, v200
  v_mfma_f32_16x16x32_bf16 a[84:87], a[172:175], v[104:107], a[84:87]
  ds_read_b64_tr_b16 a[186:187], v223 offset:53248
  v_cvt_pk_bf16_f32 v16, v16, v17
  v_cvt_pk_bf16_f32 v17, v18, v19
  v_mfma_f32_16x16x32_bf16 a[84:87], a[168:171], v[72:75], a[84:87]
  v_cvt_pk_bf16_f32 v18, v20, v21
  v_cvt_pk_bf16_f32 v19, v22, v23
  v_mfma_f32_16x16x32_bf16 a[88:91], a[168:171], v[80:83], a[88:91]
  ds_read_b64_tr_b16 a[188:189], v223 offset:57344
  buffer_store_dwordx4 v[16:19], v244, s[24:27], s41 offen offset:0
  v_accvgpr_read_b32 v24, a12
  v_mfma_f32_16x16x32_bf16 a[88:91], a[172:175], v[112:115], a[88:91]
  v_accvgpr_read_b32 v25, a13
  v_accvgpr_read_b32 v26, a14
  v_mfma_f32_16x16x32_bf16 a[92:95], a[172:175], v[120:123], a[92:95]
  ds_read_b64_tr_b16 a[190:191], v223 offset:61440
  v_accvgpr_read_b32 v27, a15
  v_accvgpr_read_b32 v28, a28
  v_mfma_f32_16x16x32_bf16 a[92:95], a[168:171], v[88:91], a[92:95]
  s_waitcnt lgkmcnt(4)
  v_accvgpr_read_b32 v29, a29
  v_accvgpr_read_b32 v30, a30
  v_mfma_f32_16x16x32_bf16 a[96:99], a[176:179], v[64:67], a[96:99]
  v_accvgpr_read_b32 v31, a31
  v_mul_f32 v24, v24, v204
  v_mfma_f32_16x16x32_bf16 a[96:99], a[180:183], v[96:99], a[96:99]
  v_mul_f32 v25, v25, v204
  v_mul_f32 v26, v26, v204
  v_mfma_f32_16x16x32_bf16 a[100:103], a[180:183], v[104:107], a[100:103]
  v_mul_f32 v27, v27, v204
  v_mul_f32 v28, v28, v204
  v_mfma_f32_16x16x32_bf16 a[100:103], a[176:179], v[72:75], a[100:103]
  v_mul_f32 v29, v29, v204
  v_mul_f32 v30, v30, v204
  v_mfma_f32_16x16x32_bf16 a[104:107], a[176:179], v[80:83], a[104:107]
  v_mul_f32 v31, v31, v204
  v_cvt_pk_bf16_f32 v24, v24, v25
  v_mfma_f32_16x16x32_bf16 a[104:107], a[180:183], v[112:115], a[104:107]
  v_cvt_pk_bf16_f32 v25, v26, v27
  v_cvt_pk_bf16_f32 v26, v28, v29
  v_mfma_f32_16x16x32_bf16 a[108:111], a[180:183], v[120:123], a[108:111]
  v_cvt_pk_bf16_f32 v27, v30, v31
  buffer_store_dwordx4 v[24:27], v244, s[24:27], s41 offen offset:2048
  v_mfma_f32_16x16x32_bf16 a[108:111], a[176:179], v[88:91], a[108:111]
  s_waitcnt lgkmcnt(0)
  v_accvgpr_read_b32 v32, a32
  v_accvgpr_read_b32 v33, a33
  v_mfma_f32_16x16x32_bf16 a[112:115], a[184:187], v[64:67], a[112:115]
  v_accvgpr_read_b32 v34, a34
  v_accvgpr_read_b32 v35, a35
  v_mfma_f32_16x16x32_bf16 a[112:115], a[188:191], v[96:99], a[112:115]
  v_accvgpr_read_b32 v36, a48
  v_accvgpr_read_b32 v37, a49
  v_mfma_f32_16x16x32_bf16 a[116:119], a[188:191], v[104:107], a[116:119]
  v_accvgpr_read_b32 v38, a50
  v_accvgpr_read_b32 v39, a51
  v_mfma_f32_16x16x32_bf16 a[116:119], a[184:187], v[72:75], a[116:119]
  v_mul_f32 v32, v32, v192
  v_mul_f32 v33, v33, v192
  v_mfma_f32_16x16x32_bf16 a[120:123], a[184:187], v[80:83], a[120:123]
  v_mul_f32 v34, v34, v192
  v_mul_f32 v35, v35, v192
  v_mfma_f32_16x16x32_bf16 a[120:123], a[188:191], v[112:115], a[120:123]
  v_mul_f32 v36, v36, v192
  v_mul_f32 v37, v37, v192
  v_mfma_f32_16x16x32_bf16 a[124:127], a[188:191], v[120:123], a[124:127]
  v_mul_f32 v38, v38, v192
  v_mul_f32 v39, v39, v192
  v_mfma_f32_16x16x32_bf16 a[124:127], a[184:187], v[88:91], a[124:127]
  v_cvt_pk_bf16_f32 v32, v32, v33
  v_cvt_pk_bf16_f32 v33, v34, v35
  v_cvt_pk_bf16_f32 v34, v36, v37
  v_cvt_pk_bf16_f32 v35, v38, v39
  buffer_store_dwordx4 v[32:35], v244, s[24:27], s40 offen offset:1024
  v_accvgpr_read_b32 v40, a36
  v_accvgpr_read_b32 v41, a37
  v_accvgpr_read_b32 v42, a38
  v_accvgpr_read_b32 v43, a39
  v_accvgpr_read_b32 v44, a52
  v_accvgpr_read_b32 v45, a53
  v_accvgpr_read_b32 v46, a54
  v_accvgpr_read_b32 v47, a55
  v_mul_f32 v40, v40, v196
  v_mul_f32 v41, v41, v196
  v_mul_f32 v42, v42, v196
  v_mul_f32 v43, v43, v196
  v_mul_f32 v44, v44, v196
  v_mul_f32 v45, v45, v196
  v_mul_f32 v46, v46, v196
  v_mul_f32 v47, v47, v196
  v_cvt_pk_bf16_f32 v40, v40, v41
  v_cvt_pk_bf16_f32 v41, v42, v43
  v_cvt_pk_bf16_f32 v42, v44, v45
  v_cvt_pk_bf16_f32 v43, v46, v47
  buffer_store_dwordx4 v[40:43], v244, s[24:27], s40 offen offset:3072
  v_accvgpr_read_b32 v48, a40
  v_accvgpr_read_b32 v49, a41
  v_accvgpr_read_b32 v50, a42
  v_accvgpr_read_b32 v51, a43
  v_accvgpr_read_b32 v52, a56
  v_accvgpr_read_b32 v53, a57
  v_accvgpr_read_b32 v54, a58
  v_accvgpr_read_b32 v55, a59
  v_mul_f32 v48, v48, v200
  v_mul_f32 v49, v49, v200
  v_mul_f32 v50, v50, v200
  v_mul_f32 v51, v51, v200
  v_mul_f32 v52, v52, v200
  v_mul_f32 v53, v53, v200
  v_mul_f32 v54, v54, v200
  v_mul_f32 v55, v55, v200
  v_cvt_pk_bf16_f32 v48, v48, v49
  v_cvt_pk_bf16_f32 v49, v50, v51
  v_cvt_pk_bf16_f32 v50, v52, v53
  v_cvt_pk_bf16_f32 v51, v54, v55
  buffer_store_dwordx4 v[48:51], v244, s[24:27], s41 offen offset:1024
  v_accvgpr_read_b32 v56, a44
  v_accvgpr_read_b32 v57, a45
  v_accvgpr_read_b32 v58, a46
  v_accvgpr_read_b32 v59, a47
  v_accvgpr_read_b32 v60, a60
  v_accvgpr_read_b32 v61, a61
  v_accvgpr_read_b32 v62, a62
  v_accvgpr_read_b32 v63, a63
  v_mul_f32 v56, v56, v204
  v_mul_f32 v57, v57, v204
  v_mul_f32 v58, v58, v204
  v_mul_f32 v59, v59, v204
  v_mul_f32 v60, v60, v204
  v_mul_f32 v61, v61, v204
  v_mul_f32 v62, v62, v204
  v_mul_f32 v63, v63, v204
  v_cvt_pk_bf16_f32 v56, v56, v57
  v_cvt_pk_bf16_f32 v57, v58, v59
  v_cvt_pk_bf16_f32 v58, v60, v61
  v_cvt_pk_bf16_f32 v59, v62, v63
  buffer_store_dwordx4 v[56:59], v244, s[24:27], s41 offen offset:3072
  v_accvgpr_read_b32 v0, a64
  v_accvgpr_read_b32 v1, a65
  v_accvgpr_read_b32 v2, a66
  v_accvgpr_read_b32 v3, a67
  v_accvgpr_read_b32 v4, a80
  v_accvgpr_read_b32 v5, a81
  v_accvgpr_read_b32 v6, a82
  v_accvgpr_read_b32 v7, a83
  v_mul_f32 v0, v0, v192
  v_mul_f32 v1, v1, v192
  v_mul_f32 v2, v2, v192
  v_mul_f32 v3, v3, v192
  v_mul_f32 v4, v4, v192
  v_mul_f32 v5, v5, v192
  v_mul_f32 v6, v6, v192
  v_mul_f32 v7, v7, v192
  v_cvt_pk_bf16_f32 v0, v0, v1
  v_cvt_pk_bf16_f32 v1, v2, v3
  v_cvt_pk_bf16_f32 v2, v4, v5
  v_cvt_pk_bf16_f32 v3, v6, v7
  buffer_store_dwordx4 v[0:3], v244, s[24:27], s42 offen offset:0
  v_accvgpr_read_b32 v8, a68
  v_accvgpr_read_b32 v9, a69
  v_accvgpr_read_b32 v10, a70
  v_accvgpr_read_b32 v11, a71
  v_accvgpr_read_b32 v12, a84
  v_accvgpr_read_b32 v13, a85
  v_accvgpr_read_b32 v14, a86
  v_accvgpr_read_b32 v15, a87
  v_mul_f32 v8, v8, v196
  v_mul_f32 v9, v9, v196
  v_mul_f32 v10, v10, v196
  v_mul_f32 v11, v11, v196
  v_mul_f32 v12, v12, v196
  v_mul_f32 v13, v13, v196
  v_mul_f32 v14, v14, v196
  v_mul_f32 v15, v15, v196
  v_cvt_pk_bf16_f32 v8, v8, v9
  v_cvt_pk_bf16_f32 v9, v10, v11
  v_cvt_pk_bf16_f32 v10, v12, v13
  v_cvt_pk_bf16_f32 v11, v14, v15
  buffer_store_dwordx4 v[8:11], v244, s[24:27], s42 offen offset:2048
  v_accvgpr_read_b32 v16, a72
  v_accvgpr_read_b32 v17, a73
  v_accvgpr_read_b32 v18, a74
  v_accvgpr_read_b32 v19, a75
  v_accvgpr_read_b32 v20, a88
  v_accvgpr_read_b32 v21, a89
  v_accvgpr_read_b32 v22, a90
  v_accvgpr_read_b32 v23, a91
  v_mul_f32 v16, v16, v200
  v_mul_f32 v17, v17, v200
  v_mul_f32 v18, v18, v200
  v_mul_f32 v19, v19, v200
  v_mul_f32 v20, v20, v200
  v_mul_f32 v21, v21, v200
  v_mul_f32 v22, v22, v200
  v_mul_f32 v23, v23, v200
  v_cvt_pk_bf16_f32 v16, v16, v17
  v_cvt_pk_bf16_f32 v17, v18, v19
  v_cvt_pk_bf16_f32 v18, v20, v21
  v_cvt_pk_bf16_f32 v19, v22, v23
  buffer_store_dwordx4 v[16:19], v244, s[24:27], s43 offen offset:0
  v_accvgpr_read_b32 v24, a76
  v_accvgpr_read_b32 v25, a77
  v_accvgpr_read_b32 v26, a78
  v_accvgpr_read_b32 v27, a79
  v_accvgpr_read_b32 v28, a92
  v_accvgpr_read_b32 v29, a93
  v_accvgpr_read_b32 v30, a94
  v_accvgpr_read_b32 v31, a95
  v_mul_f32 v24, v24, v204
  v_mul_f32 v25, v25, v204
  v_mul_f32 v26, v26, v204
  v_mul_f32 v27, v27, v204
  v_mul_f32 v28, v28, v204
  v_mul_f32 v29, v29, v204
  v_mul_f32 v30, v30, v204
  v_mul_f32 v31, v31, v204
  v_cvt_pk_bf16_f32 v24, v24, v25
  v_cvt_pk_bf16_f32 v25, v26, v27
  v_cvt_pk_bf16_f32 v26, v28, v29
  v_cvt_pk_bf16_f32 v27, v30, v31
  buffer_store_dwordx4 v[24:27], v244, s[24:27], s43 offen offset:2048
  v_accvgpr_read_b32 v32, a96
  v_accvgpr_read_b32 v33, a97
  v_accvgpr_read_b32 v34, a98
  v_accvgpr_read_b32 v35, a99
  v_accvgpr_read_b32 v36, a112
  v_accvgpr_read_b32 v37, a113
  v_accvgpr_read_b32 v38, a114
  v_accvgpr_read_b32 v39, a115
  v_mul_f32 v32, v32, v192
  v_mul_f32 v33, v33, v192
  v_mul_f32 v34, v34, v192
  v_mul_f32 v35, v35, v192
  v_mul_f32 v36, v36, v192
  v_mul_f32 v37, v37, v192
  v_mul_f32 v38, v38, v192
  v_mul_f32 v39, v39, v192
  v_cvt_pk_bf16_f32 v32, v32, v33
  v_cvt_pk_bf16_f32 v33, v34, v35
  v_cvt_pk_bf16_f32 v34, v36, v37
  v_cvt_pk_bf16_f32 v35, v38, v39
  buffer_store_dwordx4 v[32:35], v244, s[24:27], s42 offen offset:1024
  v_accvgpr_read_b32 v40, a100
  v_accvgpr_read_b32 v41, a101
  v_accvgpr_read_b32 v42, a102
  v_accvgpr_read_b32 v43, a103
  v_accvgpr_read_b32 v44, a116
  v_accvgpr_read_b32 v45, a117
  v_accvgpr_read_b32 v46, a118
  v_accvgpr_read_b32 v47, a119
  v_mul_f32 v40, v40, v196
  v_mul_f32 v41, v41, v196
  v_mul_f32 v42, v42, v196
  v_mul_f32 v43, v43, v196
  v_mul_f32 v44, v44, v196
  v_mul_f32 v45, v45, v196
  v_mul_f32 v46, v46, v196
  v_mul_f32 v47, v47, v196
  v_cvt_pk_bf16_f32 v40, v40, v41
  v_cvt_pk_bf16_f32 v41, v42, v43
  v_cvt_pk_bf16_f32 v42, v44, v45
  v_cvt_pk_bf16_f32 v43, v46, v47
  buffer_store_dwordx4 v[40:43], v244, s[24:27], s42 offen offset:3072
  v_accvgpr_read_b32 v48, a104
  v_accvgpr_read_b32 v49, a105
  v_accvgpr_read_b32 v50, a106
  v_accvgpr_read_b32 v51, a107
  v_accvgpr_read_b32 v52, a120
  v_accvgpr_read_b32 v53, a121
  v_accvgpr_read_b32 v54, a122
  v_accvgpr_read_b32 v55, a123
  v_mul_f32 v48, v48, v200
  v_mul_f32 v49, v49, v200
  v_mul_f32 v50, v50, v200
  v_mul_f32 v51, v51, v200
  v_mul_f32 v52, v52, v200
  v_mul_f32 v53, v53, v200
  v_mul_f32 v54, v54, v200
  v_mul_f32 v55, v55, v200
  v_cvt_pk_bf16_f32 v48, v48, v49
  v_cvt_pk_bf16_f32 v49, v50, v51
  v_cvt_pk_bf16_f32 v50, v52, v53
  v_cvt_pk_bf16_f32 v51, v54, v55
  buffer_store_dwordx4 v[48:51], v244, s[24:27], s43 offen offset:1024
  v_accvgpr_read_b32 v56, a108
  v_accvgpr_read_b32 v57, a109
  v_accvgpr_read_b32 v58, a110
  v_accvgpr_read_b32 v59, a111
  v_accvgpr_read_b32 v60, a124
  v_accvgpr_read_b32 v61, a125
  v_accvgpr_read_b32 v62, a126
  v_accvgpr_read_b32 v63, a127
  v_mul_f32 v56, v56, v204
  v_mul_f32 v57, v57, v204
  v_mul_f32 v58, v58, v204
  v_mul_f32 v59, v59, v204
  v_mul_f32 v60, v60, v204
  v_mul_f32 v61, v61, v204
  v_mul_f32 v62, v62, v204
  v_mul_f32 v63, v63, v204
  v_cvt_pk_bf16_f32 v56, v56, v57
  v_cvt_pk_bf16_f32 v57, v58, v59
  v_cvt_pk_bf16_f32 v58, v60, v61
  v_cvt_pk_bf16_f32 v59, v62, v63
  buffer_store_dwordx4 v[56:59], v244, s[24:27], s43 offen offset:3072
  v_lshlrev_b32 v246, 0, v242
  v_add_u32 v246, 131072, v246
  s_waitcnt lgkmcnt(0)
  s_barrier
  ds_read_b128 v[248:251], v246
  s_waitcnt lgkmcnt(0)
  v_or3_b32 v248, v248, v249, v250
  v_or_b32 v248, v248, v251
  v_cmp_ne_u32 vcc, 0, v248
  s_nop 0
  s_cbranch_vccz attn_end
  s_waitcnt vmcnt(0)
  v_accvgpr_write_b32 a0, 0
  v_accvgpr_write_b32 a1, 0
  v_accvgpr_write_b32 a2, 0
  v_accvgpr_write_b32 a3, 0
  v_accvgpr_write_b32 a4, 0
  v_accvgpr_write_b32 a5, 0
  v_accvgpr_write_b32 a6, 0
  v_accvgpr_write_b32 a7, 0
  v_accvgpr_write_b32 a8, 0
  v_accvgpr_write_b32 a9, 0
  v_accvgpr_write_b32 a10, 0
  v_accvgpr_write_b32 a11, 0
  v_accvgpr_write_b32 a12, 0
  v_accvgpr_write_b32 a13, 0
  v_accvgpr_write_b32 a14, 0
  v_accvgpr_write_b32 a15, 0
  v_accvgpr_write_b32 a16, 0
  v_accvgpr_write_b32 a17, 0
  v_accvgpr_write_b32 a18, 0
  v_accvgpr_write_b32 a19, 0
  v_accvgpr_write_b32 a20, 0
  v_accvgpr_write_b32 a21, 0
  v_accvgpr_write_b32 a22, 0
  v_accvgpr_write_b32 a23, 0
  v_accvgpr_write_b32 a24, 0
  v_accvgpr_write_b32 a25, 0
  v_accvgpr_write_b32 a26, 0
  v_accvgpr_write_b32 a27, 0
  v_accvgpr_write_b32 a28, 0
  v_accvgpr_write_b32 a29, 0
  v_accvgpr_write_b32 a30, 0
  v_accvgpr_write_b32 a31, 0
  v_accvgpr_write_b32 a32, 0
  v_accvgpr_write_b32 a33, 0
  v_accvgpr_write_b32 a34, 0
  v_accvgpr_write_b32 a35, 0
  v_accvgpr_write_b32 a36, 0
  v_accvgpr_write_b32 a37, 0
  v_accvgpr_write_b32 a38, 0
  v_accvgpr_write_b32 a39, 0
  v_accvgpr_write_b32 a40, 0
  v_accvgpr_write_b32 a41, 0
  v_accvgpr_write_b32 a42, 0
  v_accvgpr_write_b32 a43, 0
  v_accvgpr_write_b32 a44, 0
  v_accvgpr_write_b32 a45, 0
  v_accvgpr_write_b32 a46, 0
  v_accvgpr_write_b32 a47, 0
  v_accvgpr_write_b32 a48, 0
  v_accvgpr_write_b32 a49, 0
  v_accvgpr_write_b32 a50, 0
  v_accvgpr_write_b32 a51, 0
  v_accvgpr_write_b32 a52, 0
  v_accvgpr_write_b32 a53, 0
  v_accvgpr_write_b32 a54, 0
  v_accvgpr_write_b32 a55, 0
  v_accvgpr_write_b32 a56, 0
  v_accvgpr_write_b32 a57, 0
  v_accvgpr_write_b32 a58, 0
  v_accvgpr_write_b32 a59, 0
  v_accvgpr_write_b32 a60, 0
  v_accvgpr_write_b32 a61, 0
  v_accvgpr_write_b32 a62, 0
  v_accvgpr_write_b32 a63, 0
  v_accvgpr_write_b32 a64, 0
  v_accvgpr_write_b32 a65, 0
  v_accvgpr_write_b32 a66, 0
  v_accvgpr_write_b32 a67, 0
  v_accvgpr_write_b32 a68, 0
  v_accvgpr_write_b32 a69, 0
  v_accvgpr_write_b32 a70, 0
  v_accvgpr_write_b32 a71, 0
  v_accvgpr_write_b32 a72, 0
  v_accvgpr_write_b32 a73, 0
  v_accvgpr_write_b32 a74, 0
  v_accvgpr_write_b32 a75, 0
  v_accvgpr_write_b32 a76, 0
  v_accvgpr_write_b32 a77, 0
  v_accvgpr_write_b32 a78, 0
  v_accvgpr_write_b32 a79, 0
  v_accvgpr_write_b32 a80, 0
  v_accvgpr_write_b32 a81, 0
  v_accvgpr_write_b32 a82, 0
  v_accvgpr_write_b32 a83, 0
  v_accvgpr_write_b32 a84, 0
  v_accvgpr_write_b32 a85, 0
  v_accvgpr_write_b32 a86, 0
  v_accvgpr_write_b32 a87, 0
  v_accvgpr_write_b32 a88, 0
  v_accvgpr_write_b32 a89, 0
  v_accvgpr_write_b32 a90, 0
  v_accvgpr_write_b32 a91, 0
  v_accvgpr_write_b32 a92, 0
  v_accvgpr_write_b32 a93, 0
  v_accvgpr_write_b32 a94, 0
  v_accvgpr_write_b32 a95, 0
  v_accvgpr_write_b32 a96, 0
  v_accvgpr_write_b32 a97, 0
  v_accvgpr_write_b32 a98, 0
  v_accvgpr_write_b32 a99, 0
  v_accvgpr_write_b32 a100, 0
  v_accvgpr_write_b32 a101, 0
  v_accvgpr_write_b32 a102, 0
  v_accvgpr_write_b32 a103, 0
  v_accvgpr_write_b32 a104, 0
  v_accvgpr_write_b32 a105, 0
  v_accvgpr_write_b32 a106, 0
  v_accvgpr_write_b32 a107, 0
  v_accvgpr_write_b32 a108, 0
  v_accvgpr_write_b32 a109, 0
  v_accvgpr_write_b32 a110, 0
  v_accvgpr_write_b32 a111, 0
  v_accvgpr_write_b32 a112, 0
  v_accvgpr_write_b32 a113, 0
  v_accvgpr_write_b32 a114, 0
  v_accvgpr_write_b32 a115, 0
  v_accvgpr_write_b32 a116, 0
  v_accvgpr_write_b32 a117, 0
  v_accvgpr_write_b32 a118, 0
  v_accvgpr_write_b32 a119, 0
  v_accvgpr_write_b32 a120, 0
  v_accvgpr_write_b32 a121, 0
  v_accvgpr_write_b32 a122, 0
  v_accvgpr_write_b32 a123, 0
  v_accvgpr_write_b32 a124, 0
  v_accvgpr_write_b32 a125, 0
  v_accvgpr_write_b32 a126, 0
  v_accvgpr_write_b32 a127, 0
  v_mov_b32 v208, 0
  v_mov_b32 v249, 0xff800000
  v_mov_b32 v209, 0
  v_mov_b32 v250, 0xff800000
  v_mov_b32 v210, 0
  v_mov_b32 v251, 0xff800000
  v_mov_b32 v211, 0
  v_mov_b32 v252, 0xff800000
  s_mov_b32 s29, 0
attn_slow:
  s_barrier
  s_add_u32 m0, s28, 0
  s_nop 0
  buffer_load_dwordx4 v232, s[12:15], s29 offen offset:0 lds
  buffer_load_dwordx4 v233, s[12:15], s29 offen offset:1024 lds
  buffer_load_dwordx4 v234, s[12:15], s29 offen offset:2048 lds
  buffer_load_dwordx4 v235, s[12:15], s29 offen offset:3072 lds
  s_add_u32 m0, s28, 65536
  s_nop 0
  buffer_load_dwordx4 v236, s[16:19], s29 offen offset:0 lds
  buffer_load_dwordx4 v237, s[16:19], s29 offen offset:1024 lds
  buffer_load_dwordx4 v236, s[16:19], s29 offen offset:2048 lds
  buffer_load_dwordx4 v237, s[16:19], s29 offen offset:3072 lds
  s_waitcnt vmcnt(0)
  s_barrier
  ds_read_b128 a[128:131], v212 offset:0
  ds_read_b128 a[132:135], v213 offset:0
  ds_read_b128 a[136:139], v214 offset:0
  ds_read_b128 a[140:143], v215 offset:0
  s_waitcnt lgkmcnt(3)
  v_mfma_f32_16x16x32_bf16 v[0:3], a[128:131], v[128:131], 0
  s_waitcnt lgkmcnt(2)
  v_mfma_f32_16x16x32_bf16 v[0:3], a[132:135], v[132:135], v[0:3]
  s_waitcnt lgkmcnt(1)
  v_mfma_f32_16x16x32_bf16 v[0:3], a[136:139], v[136:139], v[0:3]
  s_waitcnt lgkmcnt(0)
  v_mfma_f32_16x16x32_bf16 v[0:3], a[140:143], v[140:143], v[0:3]
  v_mfma_f32_16x16x32_bf16 v[8:11], a[140:143], v[156:159], 0
  v_mfma_f32_16x16x32_bf16 v[8:11], a[136:139], v[152:155], v[8:11]
  v_mfma_f32_16x16x32_bf16 v[8:11], a[132:135], v[148:151], v[8:11]
  v_mfma_f32_16x16x32_bf16 v[8:11], a[128:131], v[144:147], v[8:11]
  v_mfma_f32_16x16x32_bf16 v[16:19], a[128:131], v[160:163], 0
  v_mfma_f32_16x16x32_bf16 v[16:19], a[132:135], v[164:167], v[16:19]
  v_mfma_f32_16x16x32_bf16 v[16:19], a[136:139], v[168:171], v[16:19]
  v_mfma_f32_16x16x32_bf16 v[16:19], a[140:143], v[172:175], v[16:19]
  v_mfma_f32_16x16x32_bf16 v[24:27], a[140:143], v[188:191], 0
  v_mfma_f32_16x16x32_bf16 v[24:27], a[136:139], v[184:187], v[24:27]
  v_mfma_f32_16x16x32_bf16 v[24:27], a[132:135], v[180:183], v[24:27]
  v_mfma_f32_16x16x32_bf16 v[24:27], a[128:131], v[176:179], v[24:27]
  ds_read_b128 a[144:147], v212 offset:4096
  ds_read_b128 a[148:151], v213 offset:4096
  ds_read_b128 a[152:155], v214 offset:4096
  ds_read_b128 a[156:159], v215 offset:4096
  s_waitcnt lgkmcnt(3)
  v_mfma_f32_16x16x32_bf16 v[4:7], a[144:147], v[128:131], 0
  s_waitcnt lgkmcnt(2)
  v_mfma_f32_16x16x32_bf16 v[4:7], a[148:151], v[132:135], v[4:7]
  s_waitcnt lgkmcnt(1)
  v_mfma_f32_16x16x32_bf16 v[4:7], a[152:155], v[136:139], v[4:7]
  s_waitcnt lgkmcnt(0)
  v_mfma_f32_16x16x32_bf16 v[4:7], a[156:159], v[140:143], v[4:7]
  v_mfma_f32_16x16x32_bf16 v[12:15], a[156:159], v[156:159], 0
  v_mfma_f32_16x16x32_bf16 v[12:15], a[152:155], v[152:155], v[12:15]
  v_mfma_f32_16x16x32_bf16 v[12:15], a[148:151], v[148:151], v[12:15]
  v_mfma_f32_16x16x32_bf16 v[12:15], a[144:147], v[144:147], v[12:15]
  v_mfma_f32_16x16x32_bf16 v[20:23], a[144:147], v[160:163], 0
  v_mfma_f32_16x16x32_bf16 v[20:23], a[148:151], v[164:167], v[20:23]
  v_mfma_f32_16x16x32_bf16 v[20:23], a[152:155], v[168:171], v[20:23]
  v_mfma_f32_16x16x32_bf16 v[20:23], a[156:159], v[172:175], v[20:23]
  v_mfma_f32_16x16x32_bf16 v[28:31], a[156:159], v[188:191], 0
  v_mfma_f32_16x16x32_bf16 v[28:31], a[152:155], v[184:187], v[28:31]
  v_mfma_f32_16x16x32_bf16 v[28:31], a[148:151], v[180:183], v[28:31]
  v_mfma_f32_16x16x32_bf16 v[28:31], a[144:147], v[176:179], v[28:31]
  ds_read_b128 a[128:131], v212 offset:8192
  ds_read_b128 a[132:135], v213 offset:8192
  ds_read_b128 a[136:139], v214 offset:8192
  ds_read_b128 a[140:143], v215 offset:8192
  s_waitcnt lgkmcnt(3)
  v_mfma_f32_16x16x32_bf16 v[32:35], a[128:131], v[128:131], 0
  s_waitcnt lgkmcnt(2)
  v_mfma_f32_16x16x32_bf16 v[32:35], a[132:135], v[132:135], v[32:35]
  s_waitcnt lgkmcnt(1)
  v_mfma_f32_16x16x32_bf16 v[32:35], a[136:139], v[136:139], v[32:35]
  s_waitcnt lgkmcnt(0)
  v_mfma_f32_16x16x32_bf16 v[32:35], a[140:143], v[140:143], v[32:35]
  v_mfma_f32_16x16x32_bf16 v[40:43], a[140:143], v[156:159], 0
  v_mfma_f32_16x16x32_bf16 v[40:43], a[136:139], v[152:155], v[40:43]
  v_mfma_f32_16x16x32_bf16 v[40:43], a[132:135], v[148:151], v[40:43]
  v_mfma_f32_16x16x32_bf16 v[40:43], a[128:131], v[144:147], v[40:43]
  v_mfma_f32_16x16x32_bf16 v[48:51], a[128:131], v[160:163], 0
  v_mfma_f32_16x16x32_bf16 v[48:51], a[132:135], v[164:167], v[48:51]
  v_mfma_f32_16x16x32_bf16 v[48:51], a[136:139], v[168:171], v[48:51]
  v_mfma_f32_16x16x32_bf16 v[48:51], a[140:143], v[172:175], v[48:51]
  v_mfma_f32_16x16x32_bf16 v[56:59], a[140:143], v[188:191], 0
  v_mfma_f32_16x16x32_bf16 v[56:59], a[136:139], v[184:187], v[56:59]
  v_mfma_f32_16x16x32_bf16 v[56:59], a[132:135], v[180:183], v[56:59]
  v_mfma_f32_16x16x32_bf16 v[56:59], a[128:131], v[176:179], v[56:59]
  ds_read_b128 a[144:147], v212 offset:12288
  ds_read_b128 a[148:151], v213 offset:12288
  ds_read_b128 a[152:155], v214 offset:12288
  ds_read_b128 a[156:159], v215 offset:12288
  s_waitcnt lgkmcnt(3)
  v_mfma_f32_16x16x32_bf16 v[36:39], a[144:147], v[128:131], 0
  s_waitcnt lgkmcnt(2)
  v_mfma_f32_16x16x32_bf16 v[36:39], a[148:151], v[132:135], v[36:39]
  s_waitcnt lgkmcnt(1)
  v_mfma_f32_16x16x32_bf16 v[36:39], a[152:155], v[136:139], v[36:39]
  s_waitcnt lgkmcnt(0)
  v_mfma_f32_16x16x32_bf16 v[36:39], a[156:159], v[140:143], v[36:39]
  v_mfma_f32_16x16x32_bf16 v[44:47], a[156:159], v[156:159], 0
  v_mfma_f32_16x16x32_bf16 v[44:47], a[152:155], v[152:155], v[44:47]
  v_mfma_f32_16x16x32_bf16 v[44:47], a[148:151], v[148:151], v[44:47]
  v_mfma_f32_16x16x32_bf16 v[44:47], a[144:147], v[144:147], v[44:47]
  v_mfma_f32_16x16x32_bf16 v[52:55], a[144:147], v[160:163], 0
  v_mfma_f32_16x16x32_bf16 v[52:55], a[148:151], v[164:167], v[52:55]
  v_mfma_f32_16x16x32_bf16 v[52:55], a[152:155], v[168:171], v[52:55]
  v_mfma_f32_16x16x32_bf16 v[52:55], a[156:159], v[172:175], v[52:55]
  v_mfma_f32_16x16x32_bf16 v[60:63], a[156:159], v[188:191], 0
  v_mfma_f32_16x16x32_bf16 v[60:63], a[152:155], v[184:187], v[60:63]
  v_mfma_f32_16x16x32_bf16 v[60:63], a[148:151], v[180:183], v[60:63]
  v_mfma_f32_16x16x32_bf16 v[60:63], a[144:147], v[176:179], v[60:63]
  v_mov_b32 v192, v249
  v_max3_f32 v192, v192, v0, v1
  v_max3_f32 v192, v192, v2, v3
  v_max3_f32 v192, v192, v4, v5
  v_max3_f32 v192, v192, v6, v7
  v_max3_f32 v192, v192, v32, v33
  v_max3_f32 v192, v192, v34, v35
  v_max3_f32 v192, v192, v36, v37
  v_max3_f32 v192, v192, v38, v39
  v_mov_b32 v245, v192
  s_nop 1
  v_permlane16_swap_b32 v192, v245
  v_max_f32 v192, v192, v245
  v_mov_b32 v245, v192
  s_nop 1
  v_permlane32_swap_b32 v192, v245
  v_max_f32 v192, v192, v245
  v_sub_f32 v193, v249, v192
  v_exp_f32 v193, v193
  v_mov_b32 v249, v192
  v_mul_f32 v208, v208, v193
  v_sub_f32 v0, v0, v192
  v_sub_f32 v1, v1, v192
  v_sub_f32 v2, v2, v192
  v_sub_f32 v3, v3, v192
  v_sub_f32 v4, v4, v192
  v_sub_f32 v5, v5, v192
  v_sub_f32 v6, v6, v192
  v_sub_f32 v7, v7, v192
  v_sub_f32 v32, v32, v192
  v_sub_f32 v33, v33, v192
  v_sub_f32 v34, v34, v192
  v_sub_f32 v35, v35, v192
  v_sub_f32 v36, v36, v192
  v_sub_f32 v37, v37, v192
  v_sub_f32 v38, v38, v192
  v_sub_f32 v39, v39, v192
  v_exp_f32 v0, v0
  v_exp_f32 v1, v1
  v_add_f32 v208, v208, v0
  v_exp_f32 v2, v2
  v_add_f32 v208, v208, v1
  v_cvt_pk_bf16_f32 v0, v0, v1
  v_exp_f32 v3, v3
  v_add_f32 v208, v208, v2
  v_add_f32 v208, v208, v3
  v_cvt_pk_bf16_f32 v1, v2, v3
  v_exp_f32 v4, v4
  v_exp_f32 v5, v5
  v_add_f32 v208, v208, v4
  v_exp_f32 v6, v6
  v_add_f32 v208, v208, v5
  v_cvt_pk_bf16_f32 v2, v4, v5
  v_exp_f32 v7, v7
  v_add_f32 v208, v208, v6
  v_add_f32 v208, v208, v7
  v_cvt_pk_bf16_f32 v3, v6, v7
  v_exp_f32 v32, v32
  v_exp_f32 v33, v33
  v_add_f32 v208, v208, v32
  v_exp_f32 v34, v34
  v_add_f32 v208, v208, v33
  v_cvt_pk_bf16_f32 v32, v32, v33
  v_exp_f32 v35, v35
  v_add_f32 v208, v208, v34
  v_add_f32 v208, v208, v35
  v_cvt_pk_bf16_f32 v33, v34, v35
  v_exp_f32 v36, v36
  v_exp_f32 v37, v37
  v_add_f32 v208, v208, v36
  v_exp_f32 v38, v38
  v_add_f32 v208, v208, v37
  v_cvt_pk_bf16_f32 v34, v36, v37
  v_exp_f32 v39, v39
  v_add_f32 v208, v208, v38
  v_add_f32 v208, v208, v39
  v_cvt_pk_bf16_f32 v35, v38, v39
  v_accvgpr_read_b32 v64, a0
  v_accvgpr_read_b32 v65, a1
  v_accvgpr_read_b32 v66, a2
  v_accvgpr_read_b32 v67, a3
  v_mul_f32 v64, v64, v193
  v_mul_f32 v65, v65, v193
  v_mul_f32 v66, v66, v193
  v_mul_f32 v67, v67, v193
  v_accvgpr_write_b32 a0, v64
  v_accvgpr_write_b32 a1, v65
  v_accvgpr_write_b32 a2, v66
  v_accvgpr_write_b32 a3, v67
  v_accvgpr_read_b32 v64, a16
  v_accvgpr_read_b32 v65, a17
  v_accvgpr_read_b32 v66, a18
  v_accvgpr_read_b32 v67, a19
  v_mul_f32 v64, v64, v193
  v_mul_f32 v65, v65, v193
  v_mul_f32 v66, v66, v193
  v_mul_f32 v67, v67, v193
  v_accvgpr_write_b32 a16, v64
  v_accvgpr_write_b32 a17, v65
  v_accvgpr_write_b32 a18, v66
  v_accvgpr_write_b32 a19, v67
  v_accvgpr_read_b32 v64, a32
  v_accvgpr_read_b32 v65, a33
  v_accvgpr_read_b32 v66, a34
  v_accvgpr_read_b32 v67, a35
  v_mul_f32 v64, v64, v193
  v_mul_f32 v65, v65, v193
  v_mul_f32 v66, v66, v193
  v_mul_f32 v67, v67, v193
  v_accvgpr_write_b32 a32, v64
  v_accvgpr_write_b32 a33, v65
  v_accvgpr_write_b32 a34, v66
  v_accvgpr_write_b32 a35, v67
  v_accvgpr_read_b32 v64, a48
  v_accvgpr_read_b32 v65, a49
  v_accvgpr_read_b32 v66, a50
  v_accvgpr_read_b32 v67, a51
  v_mul_f32 v64, v64, v193
  v_mul_f32 v65, v65, v193
  v_mul_f32 v66, v66, v193
  v_mul_f32 v67, v67, v193
  v_accvgpr_write_b32 a48, v64
  v_accvgpr_write_b32 a49, v65
  v_accvgpr_write_b32 a50, v66
  v_accvgpr_write_b32 a51, v67
  v_accvgpr_read_b32 v64, a64
  v_accvgpr_read_b32 v65, a65
  v_accvgpr_read_b32 v66, a66
  v_accvgpr_read_b32 v67, a67
  v_mul_f32 v64, v64, v193
  v_mul_f32 v65, v65, v193
  v_mul_f32 v66, v66, v193
  v_mul_f32 v67, v67, v193
  v_accvgpr_write_b32 a64, v64
  v_accvgpr_write_b32 a65, v65
  v_accvgpr_write_b32 a66, v66
  v_accvgpr_write_b32 a67, v67
  v_accvgpr_read_b32 v64, a80
  v_accvgpr_read_b32 v65, a81
  v_accvgpr_read_b32 v66, a82
  v_accvgpr_read_b32 v67, a83
  v_mul_f32 v64, v64, v193
  v_mul_f32 v65, v65, v193
  v_mul_f32 v66, v66, v193
  v_mul_f32 v67, v67, v193
  v_accvgpr_write_b32 a80, v64
  v_accvgpr_write_b32 a81, v65
  v_accvgpr_write_b32 a82, v66
  v_accvgpr_write_b32 a83, v67
  v_accvgpr_read_b32 v64, a96
  v_accvgpr_read_b32 v65, a97
  v_accvgpr_read_b32 v66, a98
  v_accvgpr_read_b32 v67, a99
  v_mul_f32 v64, v64, v193
  v_mul_f32 v65, v65, v193
  v_mul_f32 v66, v66, v193
  v_mul_f32 v67, v67, v193
  v_accvgpr_write_b32 a96, v64
  v_accvgpr_write_b32 a97, v65
  v_accvgpr_write_b32 a98, v66
  v_accvgpr_write_b32 a99, v67
  v_accvgpr_read_b32 v64, a112
  v_accvgpr_read_b32 v65, a113
  v_accvgpr_read_b32 v66, a114
  v_accvgpr_read_b32 v67, a115
  v_mul_f32 v64, v64, v193
  v_mul_f32 v65, v65, v193
  v_mul_f32 v66, v66, v193
  v_mul_f32 v67, v67, v193
  v_accvgpr_write_b32 a112, v64
  v_accvgpr_write_b32 a113, v65
  v_accvgpr_write_b32 a114, v66
  v_accvgpr_write_b32 a115, v67
  v_mov_b32 v196, v250
  v_max3_f32 v196, v196, v8, v9
  v_max3_f32 v196, v196, v10, v11
  v_max3_f32 v196, v196, v12, v13
  v_max3_f32 v196, v196, v14, v15
  v_max3_f32 v196, v196, v40, v41
  v_max3_f32 v196, v196, v42, v43
  v_max3_f32 v196, v196, v44, v45
  v_max3_f32 v196, v196, v46, v47
  v_mov_b32 v245, v196
  s_nop 1
  v_permlane16_swap_b32 v196, v245
  v_max_f32 v196, v196, v245
  v_mov_b32 v245, v196
  s_nop 1
  v_permlane32_swap_b32 v196, v245
  v_max_f32 v196, v196, v245
  v_sub_f32 v197, v250, v196
  v_exp_f32 v197, v197
  v_mov_b32 v250, v196
  v_mul_f32 v209, v209, v197
  v_sub_f32 v8, v8, v196
  v_sub_f32 v9, v9, v196
  v_sub_f32 v10, v10, v196
  v_sub_f32 v11, v11, v196
  v_sub_f32 v12, v12, v196
  v_sub_f32 v13, v13, v196
  v_sub_f32 v14, v14, v196
  v_sub_f32 v15, v15, v196
  v_sub_f32 v40, v40, v196
  v_sub_f32 v41, v41, v196
  v_sub_f32 v42, v42, v196
  v_sub_f32 v43, v43, v196
  v_sub_f32 v44, v44, v196
  v_sub_f32 v45, v45, v196
  v_sub_f32 v46, v46, v196
  v_sub_f32 v47, v47, v196
  v_exp_f32 v8, v8
  v_exp_f32 v9, v9
  v_add_f32 v209, v209, v8
  v_exp_f32 v10, v10
  v_add_f32 v209, v209, v9
  v_cvt_pk_bf16_f32 v8, v8, v9
  v_exp_f32 v11, v11
  v_add_f32 v209, v209, v10
  v_add_f32 v209, v209, v11
  v_cvt_pk_bf16_f32 v9, v10, v11
  v_exp_f32 v12, v12
  v_exp_f32 v13, v13
  v_add_f32 v209, v209, v12
  v_exp_f32 v14, v14
  v_add_f32 v209, v209, v13
  v_cvt_pk_bf16_f32 v10, v12, v13
  v_exp_f32 v15, v15
  v_add_f32 v209, v209, v14
  v_add_f32 v209, v209, v15
  v_cvt_pk_bf16_f32 v11, v14, v15
  v_exp_f32 v40, v40
  v_exp_f32 v41, v41
  v_add_f32 v209, v209, v40
  v_exp_f32 v42, v42
  v_add_f32 v209, v209, v41
  v_cvt_pk_bf16_f32 v40, v40, v41
  v_exp_f32 v43, v43
  v_add_f32 v209, v209, v42
  v_add_f32 v209, v209, v43
  v_cvt_pk_bf16_f32 v41, v42, v43
  v_exp_f32 v44, v44
  v_exp_f32 v45, v45
  v_add_f32 v209, v209, v44
  v_exp_f32 v46, v46
  v_add_f32 v209, v209, v45
  v_cvt_pk_bf16_f32 v42, v44, v45
  v_exp_f32 v47, v47
  v_add_f32 v209, v209, v46
  v_add_f32 v209, v209, v47
  v_cvt_pk_bf16_f32 v43, v46, v47
  v_accvgpr_read_b32 v64, a4
  v_accvgpr_read_b32 v65, a5
  v_accvgpr_read_b32 v66, a6
  v_accvgpr_read_b32 v67, a7
  v_mul_f32 v64, v64, v197
  v_mul_f32 v65, v65, v197
  v_mul_f32 v66, v66, v197
  v_mul_f32 v67, v67, v197
  v_accvgpr_write_b32 a4, v64
  v_accvgpr_write_b32 a5, v65
  v_accvgpr_write_b32 a6, v66
  v_accvgpr_write_b32 a7, v67
  v_accvgpr_read_b32 v64, a20
  v_accvgpr_read_b32 v65, a21
  v_accvgpr_read_b32 v66, a22
  v_accvgpr_read_b32 v67, a23
  v_mul_f32 v64, v64, v197
  v_mul_f32 v65, v65, v197
  v_mul_f32 v66, v66, v197
  v_mul_f32 v67, v67, v197
  v_accvgpr_write_b32 a20, v64
  v_accvgpr_write_b32 a21, v65
  v_accvgpr_write_b32 a22, v66
  v_accvgpr_write_b32 a23, v67
  v_accvgpr_read_b32 v64, a36
  v_accvgpr_read_b32 v65, a37
  v_accvgpr_read_b32 v66, a38
  v_accvgpr_read_b32 v67, a39
  v_mul_f32 v64, v64, v197
  v_mul_f32 v65, v65, v197
  v_mul_f32 v66, v66, v197
  v_mul_f32 v67, v67, v197
  v_accvgpr_write_b32 a36, v64
  v_accvgpr_write_b32 a37, v65
  v_accvgpr_write_b32 a38, v66
  v_accvgpr_write_b32 a39, v67
  v_accvgpr_read_b32 v64, a52
  v_accvgpr_read_b32 v65, a53
  v_accvgpr_read_b32 v66, a54
  v_accvgpr_read_b32 v67, a55
  v_mul_f32 v64, v64, v197
  v_mul_f32 v65, v65, v197
  v_mul_f32 v66, v66, v197
  v_mul_f32 v67, v67, v197
  v_accvgpr_write_b32 a52, v64
  v_accvgpr_write_b32 a53, v65
  v_accvgpr_write_b32 a54, v66
  v_accvgpr_write_b32 a55, v67
  v_accvgpr_read_b32 v64, a68
  v_accvgpr_read_b32 v65, a69
  v_accvgpr_read_b32 v66, a70
  v_accvgpr_read_b32 v67, a71
  v_mul_f32 v64, v64, v197
  v_mul_f32 v65, v65, v197
  v_mul_f32 v66, v66, v197
  v_mul_f32 v67, v67, v197
  v_accvgpr_write_b32 a68, v64
  v_accvgpr_write_b32 a69, v65
  v_accvgpr_write_b32 a70, v66
  v_accvgpr_write_b32 a71, v67
  v_accvgpr_read_b32 v64, a84
  v_accvgpr_read_b32 v65, a85
  v_accvgpr_read_b32 v66, a86
  v_accvgpr_read_b32 v67, a87
  v_mul_f32 v64, v64, v197
  v_mul_f32 v65, v65, v197
  v_mul_f32 v66, v66, v197
  v_mul_f32 v67, v67, v197
  v_accvgpr_write_b32 a84, v64
  v_accvgpr_write_b32 a85, v65
  v_accvgpr_write_b32 a86, v66
  v_accvgpr_write_b32 a87, v67
  v_accvgpr_read_b32 v64, a100
  v_accvgpr_read_b32 v65, a101
  v_accvgpr_read_b32 v66, a102
  v_accvgpr_read_b32 v67, a103
  v_mul_f32 v64, v64, v197
  v_mul_f32 v65, v65, v197
  v_mul_f32 v66, v66, v197
  v_mul_f32 v67, v67, v197
  v_accvgpr_write_b32 a100, v64
  v_accvgpr_write_b32 a101, v65
  v_accvgpr_write_b32 a102, v66
  v_accvgpr_write_b32 a103, v67
  v_accvgpr_read_b32 v64, a116
  v_accvgpr_read_b32 v65, a117
  v_accvgpr_read_b32 v66, a118
  v_accvgpr_read_b32 v67, a119
  v_mul_f32 v64, v64, v197
  v_mul_f32 v65, v65, v197
  v_mul_f32 v66, v66, v197
  v_mul_f32 v67, v67, v197
  v_accvgpr_write_b32 a116, v64
  v_accvgpr_write_b32 a117, v65
  v_accvgpr_write_b32 a118, v66
  v_accvgpr_write_b32 a119, v67
  v_mov_b32 v200, v251
  v_max3_f32 v200, v200, v16, v17
  v_max3_f32 v200, v200, v18, v19
  v_max3_f32 v200, v200, v20, v21
  v_max3_f32 v200, v200, v22, v23
  v_max3_f32 v200, v200, v48, v49
  v_max3_f32 v200, v200, v50, v51
  v_max3_f32 v200, v200, v52, v53
  v_max3_f32 v200, v200, v54, v55
  v_mov_b32 v245, v200
  s_nop 1
  v_permlane16_swap_b32 v200, v245
  v_max_f32 v200, v200, v245
  v_mov_b32 v245, v200
  s_nop 1
  v_permlane32_swap_b32 v200, v245
  v_max_f32 v200, v200, v245
  v_sub_f32 v201, v251, v200
  v_exp_f32 v201, v201
  v_mov_b32 v251, v200
  v_mul_f32 v210, v210, v201
  v_sub_f32 v16, v16, v200
  v_sub_f32 v17, v17, v200
  v_sub_f32 v18, v18, v200
  v_sub_f32 v19, v19, v200
  v_sub_f32 v20, v20, v200
  v_sub_f32 v21, v21, v200
  v_sub_f32 v22, v22, v200
  v_sub_f32 v23, v23, v200
  v_sub_f32 v48, v48, v200
  v_sub_f32 v49, v49, v200
  v_sub_f32 v50, v50, v200
  v_sub_f32 v51, v51, v200
  v_sub_f32 v52, v52, v200
  v_sub_f32 v53, v53, v200
  v_sub_f32 v54, v54, v200
  v_sub_f32 v55, v55, v200
  v_exp_f32 v16, v16
  v_exp_f32 v17, v17
  v_add_f32 v210, v210, v16
  v_exp_f32 v18, v18
  v_add_f32 v210, v210, v17
  v_cvt_pk_bf16_f32 v16, v16, v17
  v_exp_f32 v19, v19
  v_add_f32 v210, v210, v18
  v_add_f32 v210, v210, v19
  v_cvt_pk_bf16_f32 v17, v18, v19
  v_exp_f32 v20, v20
  v_exp_f32 v21, v21
  v_add_f32 v210, v210, v20
  v_exp_f32 v22, v22
  v_add_f32 v210, v210, v21
  v_cvt_pk_bf16_f32 v18, v20, v21
  v_exp_f32 v23, v23
  v_add_f32 v210, v210, v22
  v_add_f32 v210, v210, v23
  v_cvt_pk_bf16_f32 v19, v22, v23
  v_exp_f32 v48, v48
  v_exp_f32 v49, v49
  v_add_f32 v210, v210, v48
  v_exp_f32 v50, v50
  v_add_f32 v210, v210, v49
  v_cvt_pk_bf16_f32 v48, v48, v49
  v_exp_f32 v51, v51
  v_add_f32 v210, v210, v50
  v_add_f32 v210, v210, v51
  v_cvt_pk_bf16_f32 v49, v50, v51
  v_exp_f32 v52, v52
  v_exp_f32 v53, v53
  v_add_f32 v210, v210, v52
  v_exp_f32 v54, v54
  v_add_f32 v210, v210, v53
  v_cvt_pk_bf16_f32 v50, v52, v53
  v_exp_f32 v55, v55
  v_add_f32 v210, v210, v54
  v_add_f32 v210, v210, v55
  v_cvt_pk_bf16_f32 v51, v54, v55
  v_accvgpr_read_b32 v64, a8
  v_accvgpr_read_b32 v65, a9
  v_accvgpr_read_b32 v66, a10
  v_accvgpr_read_b32 v67, a11
  v_mul_f32 v64, v64, v201
  v_mul_f32 v65, v65, v201
  v_mul_f32 v66, v66, v201
  v_mul_f32 v67, v67, v201
  v_accvgpr_write_b32 a8, v64
  v_accvgpr_write_b32 a9, v65
  v_accvgpr_write_b32 a10, v66
  v_accvgpr_write_b32 a11, v67
  v_accvgpr_read_b32 v64, a24
  v_accvgpr_read_b32 v65, a25
  v_accvgpr_read_b32 v66, a26
  v_accvgpr_read_b32 v67, a27
  v_mul_f32 v64, v64, v201
  v_mul_f32 v65, v65, v201
  v_mul_f32 v66, v66, v201
  v_mul_f32 v67, v67, v201
  v_accvgpr_write_b32 a24, v64
  v_accvgpr_write_b32 a25, v65
  v_accvgpr_write_b32 a26, v66
  v_accvgpr_write_b32 a27, v67
  v_accvgpr_read_b32 v64, a40
  v_accvgpr_read_b32 v65, a41
  v_accvgpr_read_b32 v66, a42
  v_accvgpr_read_b32 v67, a43
  v_mul_f32 v64, v64, v201
  v_mul_f32 v65, v65, v201
  v_mul_f32 v66, v66, v201
  v_mul_f32 v67, v67, v201
  v_accvgpr_write_b32 a40, v64
  v_accvgpr_write_b32 a41, v65
  v_accvgpr_write_b32 a42, v66
  v_accvgpr_write_b32 a43, v67
  v_accvgpr_read_b32 v64, a56
  v_accvgpr_read_b32 v65, a57
  v_accvgpr_read_b32 v66, a58
  v_accvgpr_read_b32 v67, a59
  v_mul_f32 v64, v64, v201
  v_mul_f32 v65, v65, v201
  v_mul_f32 v66, v66, v201
  v_mul_f32 v67, v67, v201
  v_accvgpr_write_b32 a56, v64
  v_accvgpr_write_b32 a57, v65
  v_accvgpr_write_b32 a58, v66
  v_accvgpr_write_b32 a59, v67
  v_accvgpr_read_b32 v64, a72
  v_accvgpr_read_b32 v65, a73
  v_accvgpr_read_b32 v66, a74
  v_accvgpr_read_b32 v67, a75
  v_mul_f32 v64, v64, v201
  v_mul_f32 v65, v65, v201
  v_mul_f32 v66, v66, v201
  v_mul_f32 v67, v67, v201
  v_accvgpr_write_b32 a72, v64
  v_accvgpr_write_b32 a73, v65
  v_accvgpr_write_b32 a74, v66
  v_accvgpr_write_b32 a75, v67
  v_accvgpr_read_b32 v64, a88
  v_accvgpr_read_b32 v65, a89
  v_accvgpr_read_b32 v66, a90
  v_accvgpr_read_b32 v67, a91
  v_mul_f32 v64, v64, v201
  v_mul_f32 v65, v65, v201
  v_mul_f32 v66, v66, v201
  v_mul_f32 v67, v67, v201
  v_accvgpr_write_b32 a88, v64
  v_accvgpr_write_b32 a89, v65
  v_accvgpr_write_b32 a90, v66
  v_accvgpr_write_b32 a91, v67
  v_accvgpr_read_b32 v64, a104
  v_accvgpr_read_b32 v65, a105
  v_accvgpr_read_b32 v66, a106
  v_accvgpr_read_b32 v67, a107
  v_mul_f32 v64, v64, v201
  v_mul_f32 v65, v65, v201
  v_mul_f32 v66, v66, v201
  v_mul_f32 v67, v67, v201
  v_accvgpr_write_b32 a104, v64
  v_accvgpr_write_b32 a105, v65
  v_accvgpr_write_b32 a106, v66
  v_accvgpr_write_b32 a107, v67
  v_accvgpr_read_b32 v64, a120
  v_accvgpr_read_b32 v65, a121
  v_accvgpr_read_b32 v66, a122
  v_accvgpr_read_b32 v67, a123
  v_mul_f32 v64, v64, v201
  v_mul_f32 v65, v65, v201
  v_mul_f32 v66, v66, v201
  v_mul_f32 v67, v67, v201
  v_accvgpr_write_b32 a120, v64
  v_accvgpr_write_b32 a121, v65
  v_accvgpr_write_b32 a122, v66
  v_accvgpr_write_b32 a123, v67
  v_mov_b32 v204, v252
  v_max3_f32 v204, v204, v24, v25
  v_max3_f32 v204, v204, v26, v27
  v_max3_f32 v204, v204, v28, v29
  v_max3_f32 v204, v204, v30, v31
  v_max3_f32 v204, v204, v56, v57
  v_max3_f32 v204, v204, v58, v59
  v_max3_f32 v204, v204, v60, v61
  v_max3_f32 v204, v204, v62, v63
  v_mov_b32 v245, v204
  s_nop 1
  v_permlane16_swap_b32 v204, v245
  v_max_f32 v204, v204, v245
  v_mov_b32 v245, v204
  s_nop 1
  v_permlane32_swap_b32 v204, v245
  v_max_f32 v204, v204, v245
  v_sub_f32 v205, v252, v204
  v_exp_f32 v205, v205
  v_mov_b32 v252, v204
  v_mul_f32 v211, v211, v205
  v_sub_f32 v24, v24, v204
  v_sub_f32 v25, v25, v204
  v_sub_f32 v26, v26, v204
  v_sub_f32 v27, v27, v204
  v_sub_f32 v28, v28, v204
  v_sub_f32 v29, v29, v204
  v_sub_f32 v30, v30, v204
  v_sub_f32 v31, v31, v204
  v_sub_f32 v56, v56, v204
  v_sub_f32 v57, v57, v204
  v_sub_f32 v58, v58, v204
  v_sub_f32 v59, v59, v204
  v_sub_f32 v60, v60, v204
  v_sub_f32 v61, v61, v204
  v_sub_f32 v62, v62, v204
  v_sub_f32 v63, v63, v204
  v_exp_f32 v24, v24
  v_exp_f32 v25, v25
  v_add_f32 v211, v211, v24
  v_exp_f32 v26, v26
  v_add_f32 v211, v211, v25
  v_cvt_pk_bf16_f32 v24, v24, v25
  v_exp_f32 v27, v27
  v_add_f32 v211, v211, v26
  v_add_f32 v211, v211, v27
  v_cvt_pk_bf16_f32 v25, v26, v27
  v_exp_f32 v28, v28
  v_exp_f32 v29, v29
  v_add_f32 v211, v211, v28
  v_exp_f32 v30, v30
  v_add_f32 v211, v211, v29
  v_cvt_pk_bf16_f32 v26, v28, v29
  v_exp_f32 v31, v31
  v_add_f32 v211, v211, v30
  v_add_f32 v211, v211, v31
  v_cvt_pk_bf16_f32 v27, v30, v31
  v_exp_f32 v56, v56
  v_exp_f32 v57, v57
  v_add_f32 v211, v211, v56
  v_exp_f32 v58, v58
  v_add_f32 v211, v211, v57
  v_cvt_pk_bf16_f32 v56, v56, v57
  v_exp_f32 v59, v59
  v_add_f32 v211, v211, v58
  v_add_f32 v211, v211, v59
  v_cvt_pk_bf16_f32 v57, v58, v59
  v_exp_f32 v60, v60
  v_exp_f32 v61, v61
  v_add_f32 v211, v211, v60
  v_exp_f32 v62, v62
  v_add_f32 v211, v211, v61
  v_cvt_pk_bf16_f32 v58, v60, v61
  v_exp_f32 v63, v63
  v_add_f32 v211, v211, v62
  v_add_f32 v211, v211, v63
  v_cvt_pk_bf16_f32 v59, v62, v63
  v_accvgpr_read_b32 v64, a12
  v_accvgpr_read_b32 v65, a13
  v_accvgpr_read_b32 v66, a14
  v_accvgpr_read_b32 v67, a15
  v_mul_f32 v64, v64, v205
  v_mul_f32 v65, v65, v205
  v_mul_f32 v66, v66, v205
  v_mul_f32 v67, v67, v205
  v_accvgpr_write_b32 a12, v64
  v_accvgpr_write_b32 a13, v65
  v_accvgpr_write_b32 a14, v66
  v_accvgpr_write_b32 a15, v67
  v_accvgpr_read_b32 v64, a28
  v_accvgpr_read_b32 v65, a29
  v_accvgpr_read_b32 v66, a30
  v_accvgpr_read_b32 v67, a31
  v_mul_f32 v64, v64, v205
  v_mul_f32 v65, v65, v205
  v_mul_f32 v66, v66, v205
  v_mul_f32 v67, v67, v205
  v_accvgpr_write_b32 a28, v64
  v_accvgpr_write_b32 a29, v65
  v_accvgpr_write_b32 a30, v66
  v_accvgpr_write_b32 a31, v67
  v_accvgpr_read_b32 v64, a44
  v_accvgpr_read_b32 v65, a45
  v_accvgpr_read_b32 v66, a46
  v_accvgpr_read_b32 v67, a47
  v_mul_f32 v64, v64, v205
  v_mul_f32 v65, v65, v205
  v_mul_f32 v66, v66, v205
  v_mul_f32 v67, v67, v205
  v_accvgpr_write_b32 a44, v64
  v_accvgpr_write_b32 a45, v65
  v_accvgpr_write_b32 a46, v66
  v_accvgpr_write_b32 a47, v67
  v_accvgpr_read_b32 v64, a60
  v_accvgpr_read_b32 v65, a61
  v_accvgpr_read_b32 v66, a62
  v_accvgpr_read_b32 v67, a63
  v_mul_f32 v64, v64, v205
  v_mul_f32 v65, v65, v205
  v_mul_f32 v66, v66, v205
  v_mul_f32 v67, v67, v205
  v_accvgpr_write_b32 a60, v64
  v_accvgpr_write_b32 a61, v65
  v_accvgpr_write_b32 a62, v66
  v_accvgpr_write_b32 a63, v67
  v_accvgpr_read_b32 v64, a76
  v_accvgpr_read_b32 v65, a77
  v_accvgpr_read_b32 v66, a78
  v_accvgpr_read_b32 v67, a79
  v_mul_f32 v64, v64, v205
  v_mul_f32 v65, v65, v205
  v_mul_f32 v66, v66, v205
  v_mul_f32 v67, v67, v205
  v_accvgpr_write_b32 a76, v64
  v_accvgpr_write_b32 a77, v65
  v_accvgpr_write_b32 a78, v66
  v_accvgpr_write_b32 a79, v67
  v_accvgpr_read_b32 v64, a92
  v_accvgpr_read_b32 v65, a93
  v_accvgpr_read_b32 v66, a94
  v_accvgpr_read_b32 v67, a95
  v_mul_f32 v64, v64, v205
  v_mul_f32 v65, v65, v205
  v_mul_f32 v66, v66, v205
  v_mul_f32 v67, v67, v205
  v_accvgpr_write_b32 a92, v64
  v_accvgpr_write_b32 a93, v65
  v_accvgpr_write_b32 a94, v66
  v_accvgpr_write_b32 a95, v67
  v_accvgpr_read_b32 v64, a108
  v_accvgpr_read_b32 v65, a109
  v_accvgpr_read_b32 v66, a110
  v_accvgpr_read_b32 v67, a111
  v_mul_f32 v64, v64, v205
  v_mul_f32 v65, v65, v205
  v_mul_f32 v66, v66, v205
  v_mul_f32 v67, v67, v205
  v_accvgpr_write_b32 a108, v64
  v_accvgpr_write_b32 a109, v65
  v_accvgpr_write_b32 a110, v66
  v_accvgpr_write_b32 a111, v67
  v_accvgpr_read_b32 v64, a124
  v_accvgpr_read_b32 v65, a125
  v_accvgpr_read_b32 v66, a126
  v_accvgpr_read_b32 v67, a127
  v_mul_f32 v64, v64, v205
  v_mul_f32 v65, v65, v205
  v_mul_f32 v66, v66, v205
  v_mul_f32 v67, v67, v205
  v_accvgpr_write_b32 a124, v64
  v_accvgpr_write_b32 a125, v65
  v_accvgpr_write_b32 a126, v66
  v_accvgpr_write_b32 a127, v67
  ds_read_b64_tr_b16 a[160:161], v216 offset:0
  ds_read_b64_tr_b16 a[162:163], v216 offset:4096
  ds_read_b64_tr_b16 a[164:165], v216 offset:8192
  ds_read_b64_tr_b16 a[166:167], v216 offset:12288
  s_waitcnt lgkmcnt(2)
  v_mfma_f32_16x16x32_bf16 a[0:3], a[160:163], v[0:3], a[0:3]
  s_waitcnt lgkmcnt(0)
  v_mfma_f32_16x16x32_bf16 a[0:3], a[164:167], v[32:35], a[0:3]
  v_mfma_f32_16x16x32_bf16 a[4:7], a[164:167], v[40:43], a[4:7]
  v_mfma_f32_16x16x32_bf16 a[4:7], a[160:163], v[8:11], a[4:7]
  v_mfma_f32_16x16x32_bf16 a[8:11], a[160:163], v[16:19], a[8:11]
  v_mfma_f32_16x16x32_bf16 a[8:11], a[164:167], v[48:51], a[8:11]
  v_mfma_f32_16x16x32_bf16 a[12:15], a[164:167], v[56:59], a[12:15]
  v_mfma_f32_16x16x32_bf16 a[12:15], a[160:163], v[24:27], a[12:15]
  ds_read_b64_tr_b16 a[168:169], v217 offset:0
  ds_read_b64_tr_b16 a[170:171], v217 offset:4096
  ds_read_b64_tr_b16 a[172:173], v217 offset:8192
  ds_read_b64_tr_b16 a[174:175], v217 offset:12288
  s_waitcnt lgkmcnt(2)
  v_mfma_f32_16x16x32_bf16 a[16:19], a[168:171], v[0:3], a[16:19]
  s_waitcnt lgkmcnt(0)
  v_mfma_f32_16x16x32_bf16 a[16:19], a[172:175], v[32:35], a[16:19]
  v_mfma_f32_16x16x32_bf16 a[20:23], a[172:175], v[40:43], a[20:23]
  v_mfma_f32_16x16x32_bf16 a[20:23], a[168:171], v[8:11], a[20:23]
  v_mfma_f32_16x16x32_bf16 a[24:27], a[168:171], v[16:19], a[24:27]
  v_mfma_f32_16x16x32_bf16 a[24:27], a[172:175], v[48:51], a[24:27]
  v_mfma_f32_16x16x32_bf16 a[28:31], a[172:175], v[56:59], a[28:31]
  v_mfma_f32_16x16x32_bf16 a[28:31], a[168:171], v[24:27], a[28:31]
  ds_read_b64_tr_b16 a[176:177], v218 offset:0
  ds_read_b64_tr_b16 a[178:179], v218 offset:4096
  ds_read_b64_tr_b16 a[180:181], v218 offset:8192
  ds_read_b64_tr_b16 a[182:183], v218 offset:12288
  s_waitcnt lgkmcnt(2)
  v_mfma_f32_16x16x32_bf16 a[32:35], a[176:179], v[0:3], a[32:35]
  s_waitcnt lgkmcnt(0)
  v_mfma_f32_16x16x32_bf16 a[32:35], a[180:183], v[32:35], a[32:35]
  v_mfma_f32_16x16x32_bf16 a[36:39], a[180:183], v[40:43], a[36:39]
  v_mfma_f32_16x16x32_bf16 a[36:39], a[176:179], v[8:11], a[36:39]
  v_mfma_f32_16x16x32_bf16 a[40:43], a[176:179], v[16:19], a[40:43]
  v_mfma_f32_16x16x32_bf16 a[40:43], a[180:183], v[48:51], a[40:43]
  v_mfma_f32_16x16x32_bf16 a[44:47], a[180:183], v[56:59], a[44:47]
  v_mfma_f32_16x16x32_bf16 a[44:47], a[176:179], v[24:27], a[44:47]
  ds_read_b64_tr_b16 a[184:185], v219 offset:0
  ds_read_b64_tr_b16 a[186:187], v219 offset:4096
  ds_read_b64_tr_b16 a[188:189], v219 offset:8192
  ds_read_b64_tr_b16 a[190:191], v219 offset:12288
  s_waitcnt lgkmcnt(2)
  v_mfma_f32_16x16x32_bf16 a[48:51], a[184:187], v[0:3], a[48:51]
  s_waitcnt lgkmcnt(0)
  v_mfma_f32_16x16x32_bf16 a[48:51], a[188:191], v[32:35], a[48:51]
  v_mfma_f32_16x16x32_bf16 a[52:55], a[188:191], v[40:43], a[52:55]
  v_mfma_f32_16x16x32_bf16 a[52:55], a[184:187], v[8:11], a[52:55]
  v_mfma_f32_16x16x32_bf16 a[56:59], a[184:187], v[16:19], a[56:59]
  v_mfma_f32_16x16x32_bf16 a[56:59], a[188:191], v[48:51], a[56:59]
  v_mfma_f32_16x16x32_bf16 a[60:63], a[188:191], v[56:59], a[60:63]
  v_mfma_f32_16x16x32_bf16 a[60:63], a[184:187], v[24:27], a[60:63]
  ds_read_b64_tr_b16 a[160:161], v220 offset:0
  ds_read_b64_tr_b16 a[162:163], v220 offset:4096
  ds_read_b64_tr_b16 a[164:165], v220 offset:8192
  ds_read_b64_tr_b16 a[166:167], v220 offset:12288
  s_waitcnt lgkmcnt(2)
  v_mfma_f32_16x16x32_bf16 a[64:67], a[160:163], v[0:3], a[64:67]
  s_waitcnt lgkmcnt(0)
  v_mfma_f32_16x16x32_bf16 a[64:67], a[164:167], v[32:35], a[64:67]
  v_mfma_f32_16x16x32_bf16 a[68:71], a[164:167], v[40:43], a[68:71]
  v_mfma_f32_16x16x32_bf16 a[68:71], a[160:163], v[8:11], a[68:71]
  v_mfma_f32_16x16x32_bf16 a[72:75], a[160:163], v[16:19], a[72:75]
  v_mfma_f32_16x16x32_bf16 a[72:75], a[164:167], v[48:51], a[72:75]
  v_mfma_f32_16x16x32_bf16 a[76:79], a[164:167], v[56:59], a[76:79]
  v_mfma_f32_16x16x32_bf16 a[76:79], a[160:163], v[24:27], a[76:79]
  ds_read_b64_tr_b16 a[168:169], v221 offset:0
  ds_read_b64_tr_b16 a[170:171], v221 offset:4096
  ds_read_b64_tr_b16 a[172:173], v221 offset:8192
  ds_read_b64_tr_b16 a[174:175], v221 offset:12288
  s_waitcnt lgkmcnt(2)
  v_mfma_f32_16x16x32_bf16 a[80:83], a[168:171], v[0:3], a[80:83]
  s_waitcnt lgkmcnt(0)
  v_mfma_f32_16x16x32_bf16 a[80:83], a[172:175], v[32:35], a[80:83]
  v_mfma_f32_16x16x32_bf16 a[84:87], a[172:175], v[40:43], a[84:87]
  v_mfma_f32_16x16x32_bf16 a[84:87], a[168:171], v[8:11], a[84:87]
  v_mfma_f32_16x16x32_bf16 a[88:91], a[168:171], v[16:19], a[88:91]
  v_mfma_f32_16x16x32_bf16 a[88:91], a[172:175], v[48:51], a[88:91]
  v_mfma_f32_16x16x32_bf16 a[92:95], a[172:175], v[56:59], a[92:95]
  v_mfma_f32_16x16x32_bf16 a[92:95], a[168:171], v[24:27], a[92:95]
  ds_read_b64_tr_b16 a[176:177], v222 offset:0
  ds_read_b64_tr_b16 a[178:179], v222 offset:4096
  ds_read_b64_tr_b16 a[180:181], v222 offset:8192
  ds_read_b64_tr_b16 a[182:183], v222 offset:12288
  s_waitcnt lgkmcnt(2)
  v_mfma_f32_16x16x32_bf16 a[96:99], a[176:179], v[0:3], a[96:99]
  s_waitcnt lgkmcnt(0)
  v_mfma_f32_16x16x32_bf16 a[96:99], a[180:183], v[32:35], a[96:99]
  v_mfma_f32_16x16x32_bf16 a[100:103], a[180:183], v[40:43], a[100:103]
  v_mfma_f32_16x16x32_bf16 a[100:103], a[176:179], v[8:11], a[100:103]
  v_mfma_f32_16x16x32_bf16 a[104:107], a[176:179], v[16:19], a[104:107]
  v_mfma_f32_16x16x32_bf16 a[104:107], a[180:183], v[48:51], a[104:107]
  v_mfma_f32_16x16x32_bf16 a[108:111], a[180:183], v[56:59], a[108:111]
  v_mfma_f32_16x16x32_bf16 a[108:111], a[176:179], v[24:27], a[108:111]
  ds_read_b64_tr_b16 a[184:185], v223 offset:0
  ds_read_b64_tr_b16 a[186:187], v223 offset:4096
  ds_read_b64_tr_b16 a[188:189], v223 offset:8192
  ds_read_b64_tr_b16 a[190:191], v223 offset:12288
  s_waitcnt lgkmcnt(2)
  v_mfma_f32_16x16x32_bf16 a[112:115], a[184:187], v[0:3], a[112:115]
  s_waitcnt lgkmcnt(0)
  v_mfma_f32_16x16x32_bf16 a[112:115], a[188:191], v[32:35], a[112:115]
  v_mfma_f32_16x16x32_bf16 a[116:119], a[188:191], v[40:43], a[116:119]
  v_mfma_f32_16x16x32_bf16 a[116:119], a[184:187], v[8:11], a[116:119]
  v_mfma_f32_16x16x32_bf16 a[120:123], a[184:187], v[16:19], a[120:123]
  v_mfma_f32_16x16x32_bf16 a[120:123], a[188:191], v[48:51], a[120:123]
  v_mfma_f32_16x16x32_bf16 a[124:127], a[188:191], v[56:59], a[124:127]
  v_mfma_f32_16x16x32_bf16 a[124:127], a[184:187], v[24:27], a[124:127]
  s_add_u32 s29, s29, 16384
  s_cmp_lt_u32 s29, 524288
  s_cbranch_scc1 attn_slow
  v_mov_b32 v245, v208
  v_mov_b32 v246, v209
  v_mov_b32 v247, v210
  v_mov_b32 v248, v211
  v_permlane16_swap_b32 v208, v245
  v_permlane16_swap_b32 v209, v246
  v_permlane16_swap_b32 v210, v247
  v_permlane16_swap_b32 v211, v248
  v_add_f32 v208, v208, v245
  v_add_f32 v209, v209, v246
  v_add_f32 v210, v210, v247
  v_add_f32 v211, v211, v248
  v_mov_b32 v245, v208
  v_mov_b32 v246, v209
  v_mov_b32 v247, v210
  v_mov_b32 v248, v211
  v_permlane32_swap_b32 v208, v245
  v_permlane32_swap_b32 v209, v246
  v_permlane32_swap_b32 v210, v247
  v_permlane32_swap_b32 v211, v248
  v_add_f32 v208, v208, v245
  v_add_f32 v209, v209, v246
  v_add_f32 v210, v210, v247
  v_add_f32 v211, v211, v248
  v_rcp_f32 v192, v208
  v_rcp_f32 v196, v209
  v_rcp_f32 v200, v210
  v_rcp_f32 v204, v211
  v_accvgpr_read_b32 v0, a0
  v_accvgpr_read_b32 v1, a1
  v_accvgpr_read_b32 v2, a2
  v_accvgpr_read_b32 v3, a3
  v_accvgpr_read_b32 v4, a16
  v_accvgpr_read_b32 v5, a17
  v_accvgpr_read_b32 v6, a18
  v_accvgpr_read_b32 v7, a19
  v_mul_f32 v0, v0, v192
  v_mul_f32 v1, v1, v192
  v_mul_f32 v2, v2, v192
  v_mul_f32 v3, v3, v192
  v_mul_f32 v4, v4, v192
  v_mul_f32 v5, v5, v192
  v_mul_f32 v6, v6, v192
  v_mul_f32 v7, v7, v192
  v_cvt_pk_bf16_f32 v0, v0, v1
  v_cvt_pk_bf16_f32 v1, v2, v3
  v_cvt_pk_bf16_f32 v2, v4, v5
  v_cvt_pk_bf16_f32 v3, v6, v7
  buffer_store_dwordx4 v[0:3], v244, s[24:27], s40 offen offset:0
  v_accvgpr_read_b32 v8, a4
  v_accvgpr_read_b32 v9, a5
  v_accvgpr_read_b32 v10, a6
  v_accvgpr_read_b32 v11, a7
  v_accvgpr_read_b32 v12, a20
  v_accvgpr_read_b32 v13, a21
  v_accvgpr_read_b32 v14, a22
  v_accvgpr_read_b32 v15, a23
  v_mul_f32 v8, v8, v196
  v_mul_f32 v9, v9, v196
  v_mul_f32 v10, v10, v196
  v_mul_f32 v11, v11, v196
  v_mul_f32 v12, v12, v196
  v_mul_f32 v13, v13, v196
  v_mul_f32 v14, v14, v196
  v_mul_f32 v15, v15, v196
  v_cvt_pk_bf16_f32 v8, v8, v9
  v_cvt_pk_bf16_f32 v9, v10, v11
  v_cvt_pk_bf16_f32 v10, v12, v13
  v_cvt_pk_bf16_f32 v11, v14, v15
  buffer_store_dwordx4 v[8:11], v244, s[24:27], s40 offen offset:2048
  v_accvgpr_read_b32 v16, a8
  v_accvgpr_read_b32 v17, a9
  v_accvgpr_read_b32 v18, a10
  v_accvgpr_read_b32 v19, a11
  v_accvgpr_read_b32 v20, a24
  v_accvgpr_read_b32 v21, a25
  v_accvgpr_read_b32 v22, a26
  v_accvgpr_read_b32 v23, a27
  v_mul_f32 v16, v16, v200
  v_mul_f32 v17, v17, v200
  v_mul_f32 v18, v18, v200
  v_mul_f32 v19, v19, v200
  v_mul_f32 v20, v20, v200
  v_mul_f32 v21, v21, v200
  v_mul_f32 v22, v22, v200
  v_mul_f32 v23, v23, v200
  v_cvt_pk_bf16_f32 v16, v16, v17
  v_cvt_pk_bf16_f32 v17, v18, v19
  v_cvt_pk_bf16_f32 v18, v20, v21
  v_cvt_pk_bf16_f32 v19, v22, v23
  buffer_store_dwordx4 v[16:19], v244, s[24:27], s41 offen offset:0
  v_accvgpr_read_b32 v24, a12
  v_accvgpr_read_b32 v25, a13
  v_accvgpr_read_b32 v26, a14
  v_accvgpr_read_b32 v27, a15
  v_accvgpr_read_b32 v28, a28
  v_accvgpr_read_b32 v29, a29
  v_accvgpr_read_b32 v30, a30
  v_accvgpr_read_b32 v31, a31
  v_mul_f32 v24, v24, v204
  v_mul_f32 v25, v25, v204
  v_mul_f32 v26, v26, v204
  v_mul_f32 v27, v27, v204
  v_mul_f32 v28, v28, v204
  v_mul_f32 v29, v29, v204
  v_mul_f32 v30, v30, v204
  v_mul_f32 v31, v31, v204
  v_cvt_pk_bf16_f32 v24, v24, v25
  v_cvt_pk_bf16_f32 v25, v26, v27
  v_cvt_pk_bf16_f32 v26, v28, v29
  v_cvt_pk_bf16_f32 v27, v30, v31
  buffer_store_dwordx4 v[24:27], v244, s[24:27], s41 offen offset:2048
  v_accvgpr_read_b32 v32, a32
  v_accvgpr_read_b32 v33, a33
  v_accvgpr_read_b32 v34, a34
  v_accvgpr_read_b32 v35, a35
  v_accvgpr_read_b32 v36, a48
  v_accvgpr_read_b32 v37, a49
  v_accvgpr_read_b32 v38, a50
  v_accvgpr_read_b32 v39, a51
  v_mul_f32 v32, v32, v192
  v_mul_f32 v33, v33, v192
  v_mul_f32 v34, v34, v192
  v_mul_f32 v35, v35, v192
  v_mul_f32 v36, v36, v192
  v_mul_f32 v37, v37, v192
  v_mul_f32 v38, v38, v192
  v_mul_f32 v39, v39, v192
  v_cvt_pk_bf16_f32 v32, v32, v33
  v_cvt_pk_bf16_f32 v33, v34, v35
  v_cvt_pk_bf16_f32 v34, v36, v37
  v_cvt_pk_bf16_f32 v35, v38, v39
  buffer_store_dwordx4 v[32:35], v244, s[24:27], s40 offen offset:1024
  v_accvgpr_read_b32 v40, a36
  v_accvgpr_read_b32 v41, a37
  v_accvgpr_read_b32 v42, a38
  v_accvgpr_read_b32 v43, a39
  v_accvgpr_read_b32 v44, a52
  v_accvgpr_read_b32 v45, a53
  v_accvgpr_read_b32 v46, a54
  v_accvgpr_read_b32 v47, a55
  v_mul_f32 v40, v40, v196
  v_mul_f32 v41, v41, v196
  v_mul_f32 v42, v42, v196
  v_mul_f32 v43, v43, v196
  v_mul_f32 v44, v44, v196
  v_mul_f32 v45, v45, v196
  v_mul_f32 v46, v46, v196
  v_mul_f32 v47, v47, v196
  v_cvt_pk_bf16_f32 v40, v40, v41
  v_cvt_pk_bf16_f32 v41, v42, v43
  v_cvt_pk_bf16_f32 v42, v44, v45
  v_cvt_pk_bf16_f32 v43, v46, v47
  buffer_store_dwordx4 v[40:43], v244, s[24:27], s40 offen offset:3072
  v_accvgpr_read_b32 v48, a40
  v_accvgpr_read_b32 v49, a41
  v_accvgpr_read_b32 v50, a42
  v_accvgpr_read_b32 v51, a43
  v_accvgpr_read_b32 v52, a56
  v_accvgpr_read_b32 v53, a57
  v_accvgpr_read_b32 v54, a58
  v_accvgpr_read_b32 v55, a59
  v_mul_f32 v48, v48, v200
  v_mul_f32 v49, v49, v200
  v_mul_f32 v50, v50, v200
  v_mul_f32 v51, v51, v200
  v_mul_f32 v52, v52, v200
  v_mul_f32 v53, v53, v200
  v_mul_f32 v54, v54, v200
  v_mul_f32 v55, v55, v200
  v_cvt_pk_bf16_f32 v48, v48, v49
  v_cvt_pk_bf16_f32 v49, v50, v51
  v_cvt_pk_bf16_f32 v50, v52, v53
  v_cvt_pk_bf16_f32 v51, v54, v55
  buffer_store_dwordx4 v[48:51], v244, s[24:27], s41 offen offset:1024
  v_accvgpr_read_b32 v56, a44
  v_accvgpr_read_b32 v57, a45
  v_accvgpr_read_b32 v58, a46
  v_accvgpr_read_b32 v59, a47
  v_accvgpr_read_b32 v60, a60
  v_accvgpr_read_b32 v61, a61
  v_accvgpr_read_b32 v62, a62
  v_accvgpr_read_b32 v63, a63
  v_mul_f32 v56, v56, v204
  v_mul_f32 v57, v57, v204
  v_mul_f32 v58, v58, v204
  v_mul_f32 v59, v59, v204
  v_mul_f32 v60, v60, v204
  v_mul_f32 v61, v61, v204
  v_mul_f32 v62, v62, v204
  v_mul_f32 v63, v63, v204
  v_cvt_pk_bf16_f32 v56, v56, v57
  v_cvt_pk_bf16_f32 v57, v58, v59
  v_cvt_pk_bf16_f32 v58, v60, v61
  v_cvt_pk_bf16_f32 v59, v62, v63
  buffer_store_dwordx4 v[56:59], v244, s[24:27], s41 offen offset:3072
  v_accvgpr_read_b32 v0, a64
  v_accvgpr_read_b32 v1, a65
  v_accvgpr_read_b32 v2, a66
  v_accvgpr_read_b32 v3, a67
  v_accvgpr_read_b32 v4, a80
  v_accvgpr_read_b32 v5, a81
  v_accvgpr_read_b32 v6, a82
  v_accvgpr_read_b32 v7, a83
  v_mul_f32 v0, v0, v192
  v_mul_f32 v1, v1, v192
  v_mul_f32 v2, v2, v192
  v_mul_f32 v3, v3, v192
  v_mul_f32 v4, v4, v192
  v_mul_f32 v5, v5, v192
  v_mul_f32 v6, v6, v192
  v_mul_f32 v7, v7, v192
  v_cvt_pk_bf16_f32 v0, v0, v1
  v_cvt_pk_bf16_f32 v1, v2, v3
  v_cvt_pk_bf16_f32 v2, v4, v5
  v_cvt_pk_bf16_f32 v3, v6, v7
  buffer_store_dwordx4 v[0:3], v244, s[24:27], s42 offen offset:0
  v_accvgpr_read_b32 v8, a68
  v_accvgpr_read_b32 v9, a69
  v_accvgpr_read_b32 v10, a70
  v_accvgpr_read_b32 v11, a71
  v_accvgpr_read_b32 v12, a84
  v_accvgpr_read_b32 v13, a85
  v_accvgpr_read_b32 v14, a86
  v_accvgpr_read_b32 v15, a87
  v_mul_f32 v8, v8, v196
  v_mul_f32 v9, v9, v196
  v_mul_f32 v10, v10, v196
  v_mul_f32 v11, v11, v196
  v_mul_f32 v12, v12, v196
  v_mul_f32 v13, v13, v196
  v_mul_f32 v14, v14, v196
  v_mul_f32 v15, v15, v196
  v_cvt_pk_bf16_f32 v8, v8, v9
  v_cvt_pk_bf16_f32 v9, v10, v11
  v_cvt_pk_bf16_f32 v10, v12, v13
  v_cvt_pk_bf16_f32 v11, v14, v15
  buffer_store_dwordx4 v[8:11], v244, s[24:27], s42 offen offset:2048
  v_accvgpr_read_b32 v16, a72
  v_accvgpr_read_b32 v17, a73
  v_accvgpr_read_b32 v18, a74
  v_accvgpr_read_b32 v19, a75
  v_accvgpr_read_b32 v20, a88
  v_accvgpr_read_b32 v21, a89
  v_accvgpr_read_b32 v22, a90
  v_accvgpr_read_b32 v23, a91
  v_mul_f32 v16, v16, v200
  v_mul_f32 v17, v17, v200
  v_mul_f32 v18, v18, v200
  v_mul_f32 v19, v19, v200
  v_mul_f32 v20, v20, v200
  v_mul_f32 v21, v21, v200
  v_mul_f32 v22, v22, v200
  v_mul_f32 v23, v23, v200
  v_cvt_pk_bf16_f32 v16, v16, v17
  v_cvt_pk_bf16_f32 v17, v18, v19
  v_cvt_pk_bf16_f32 v18, v20, v21
  v_cvt_pk_bf16_f32 v19, v22, v23
  buffer_store_dwordx4 v[16:19], v244, s[24:27], s43 offen offset:0
  v_accvgpr_read_b32 v24, a76
  v_accvgpr_read_b32 v25, a77
  v_accvgpr_read_b32 v26, a78
  v_accvgpr_read_b32 v27, a79
  v_accvgpr_read_b32 v28, a92
  v_accvgpr_read_b32 v29, a93
  v_accvgpr_read_b32 v30, a94
  v_accvgpr_read_b32 v31, a95
  v_mul_f32 v24, v24, v204
  v_mul_f32 v25, v25, v204
  v_mul_f32 v26, v26, v204
  v_mul_f32 v27, v27, v204
  v_mul_f32 v28, v28, v204
  v_mul_f32 v29, v29, v204
  v_mul_f32 v30, v30, v204
  v_mul_f32 v31, v31, v204
  v_cvt_pk_bf16_f32 v24, v24, v25
  v_cvt_pk_bf16_f32 v25, v26, v27
  v_cvt_pk_bf16_f32 v26, v28, v29
  v_cvt_pk_bf16_f32 v27, v30, v31
  buffer_store_dwordx4 v[24:27], v244, s[24:27], s43 offen offset:2048
  v_accvgpr_read_b32 v32, a96
  v_accvgpr_read_b32 v33, a97
  v_accvgpr_read_b32 v34, a98
  v_accvgpr_read_b32 v35, a99
  v_accvgpr_read_b32 v36, a112
  v_accvgpr_read_b32 v37, a113
  v_accvgpr_read_b32 v38, a114
  v_accvgpr_read_b32 v39, a115
  v_mul_f32 v32, v32, v192
  v_mul_f32 v33, v33, v192
  v_mul_f32 v34, v34, v192
  v_mul_f32 v35, v35, v192
  v_mul_f32 v36, v36, v192
  v_mul_f32 v37, v37, v192
  v_mul_f32 v38, v38, v192
  v_mul_f32 v39, v39, v192
  v_cvt_pk_bf16_f32 v32, v32, v33
  v_cvt_pk_bf16_f32 v33, v34, v35
  v_cvt_pk_bf16_f32 v34, v36, v37
  v_cvt_pk_bf16_f32 v35, v38, v39
  buffer_store_dwordx4 v[32:35], v244, s[24:27], s42 offen offset:1024
  v_accvgpr_read_b32 v40, a100
  v_accvgpr_read_b32 v41, a101
  v_accvgpr_read_b32 v42, a102
  v_accvgpr_read_b32 v43, a103
  v_accvgpr_read_b32 v44, a116
  v_accvgpr_read_b32 v45, a117
  v_accvgpr_read_b32 v46, a118
  v_accvgpr_read_b32 v47, a119
  v_mul_f32 v40, v40, v196
  v_mul_f32 v41, v41, v196
  v_mul_f32 v42, v42, v196
  v_mul_f32 v43, v43, v196
  v_mul_f32 v44, v44, v196
  v_mul_f32 v45, v45, v196
  v_mul_f32 v46, v46, v196
  v_mul_f32 v47, v47, v196
  v_cvt_pk_bf16_f32 v40, v40, v41
  v_cvt_pk_bf16_f32 v41, v42, v43
  v_cvt_pk_bf16_f32 v42, v44, v45
  v_cvt_pk_bf16_f32 v43, v46, v47
  buffer_store_dwordx4 v[40:43], v244, s[24:27], s42 offen offset:3072
  v_accvgpr_read_b32 v48, a104
  v_accvgpr_read_b32 v49, a105
  v_accvgpr_read_b32 v50, a106
  v_accvgpr_read_b32 v51, a107
  v_accvgpr_read_b32 v52, a120
  v_accvgpr_read_b32 v53, a121
  v_accvgpr_read_b32 v54, a122
  v_accvgpr_read_b32 v55, a123
  v_mul_f32 v48, v48, v200
  v_mul_f32 v49, v49, v200
  v_mul_f32 v50, v50, v200
  v_mul_f32 v51, v51, v200
  v_mul_f32 v52, v52, v200
  v_mul_f32 v53, v53, v200
  v_mul_f32 v54, v54, v200
  v_mul_f32 v55, v55, v200
  v_cvt_pk_bf16_f32 v48, v48, v49
  v_cvt_pk_bf16_f32 v49, v50, v51
  v_cvt_pk_bf16_f32 v50, v52, v53
  v_cvt_pk_bf16_f32 v51, v54, v55
  buffer_store_dwordx4 v[48:51], v244, s[24:27], s43 offen offset:1024
  v_accvgpr_read_b32 v56, a108
  v_accvgpr_read_b32 v57, a109
  v_accvgpr_read_b32 v58, a110
  v_accvgpr_read_b32 v59, a111
  v_accvgpr_read_b32 v60, a124
  v_accvgpr_read_b32 v61, a125
  v_accvgpr_read_b32 v62, a126
  v_accvgpr_read_b32 v63, a127
  v_mul_f32 v56, v56, v204
  v_mul_f32 v57, v57, v204
  v_mul_f32 v58, v58, v204
  v_mul_f32 v59, v59, v204
  v_mul_f32 v60, v60, v204
  v_mul_f32 v61, v61, v204
  v_mul_f32 v62, v62, v204
  v_mul_f32 v63, v63, v204
  v_cvt_pk_bf16_f32 v56, v56, v57
  v_cvt_pk_bf16_f32 v57, v58, v59
  v_cvt_pk_bf16_f32 v58, v60, v61
  v_cvt_pk_bf16_f32 v59, v62, v63
  buffer_store_dwordx4 v[56:59], v244, s[24:27], s43 offen offset:3072
attn_end:
  s_endpgm
.globl out_kernel
.p2align 8
.type out_kernel,@function
out_kernel:
  s_cmp_ge_u32 s2, 256
  s_cbranch_scc1 out_end
  s_load_dwordx2 s[4:5], s[0:1], 0
  s_load_dwordx2 s[6:7], s[0:1], 80
  s_load_dwordx2 s[8:9], s[0:1], 96
  v_lshrrev_b32 v122, 6, v0
  v_and_b32 v123, 63, v0
  v_readfirstlane_b32 s3, v122
  s_and_b32 s10, s2, 7
  s_lshr_b32 s11, s2, 3
  s_lshr_b32 s28, s10, 1
  s_lshl_b32 s28, s28, 3
  s_and_b32 s29, s11, 7
  s_add_u32 s28, s28, s29
  s_and_b32 s29, s10, 1
  s_lshl_b32 s29, s29, 2
  s_lshr_b32 s11, s11, 3
  s_add_u32 s29, s29, s11
  v_and_b32 v124, 15, v123
  v_lshrrev_b32 v125, 4, v123
  v_lshlrev_b32 v114, 4, v123
  v_add_u32 v115, 0x1000, v114
  v_add_u32 v116, 0x2000, v114
  s_add_u32 s10, s3, 0
  s_and_b32 s10, s10, 3
  s_lshl_b32 s11, s10, 11
  v_add_u32 v110, s11, v114
  s_add_u32 s10, s3, 1
  s_and_b32 s10, s10, 3
  s_lshl_b32 s11, s10, 11
  v_add_u32 v111, s11, v114
  s_mul_i32 s10, s10, 15360
  s_add_u32 s10, s10, 0
  v_add_u32 v118, s10, v114
  s_add_u32 s10, s3, 2
  s_and_b32 s10, s10, 3
  s_lshl_b32 s11, s10, 11
  v_add_u32 v112, s11, v114
  s_mul_i32 s10, s10, 15360
  s_add_u32 s10, s10, 5120
  v_add_u32 v119, s10, v114
  s_add_u32 s10, s3, 3
  s_and_b32 s10, s10, 3
  s_lshl_b32 s11, s10, 11
  v_add_u32 v113, s11, v114
  s_mul_i32 s10, s10, 15360
  s_add_u32 s10, s10, 10240
  v_add_u32 v120, s10, v114
  s_mul_i32 s10, s3, 15360
  v_add_u32 v121, s10, v114
  s_lshl_b32 s30, s28, 19
  s_lshl_b32 s10, s3, 17
  s_add_u32 s30, s30, s10
  s_add_u32 s30, s30, 8388608
  s_mul_i32 s31, s29, 655360
  s_mul_i32 s10, s3, 163840
  s_add_u32 s31, s31, s10
  s_add_u32 s31, s31, 3145728
  s_lshl_b32 s10, s28, 6
  s_lshl_b32 s11, s3, 4
  s_add_u32 s10, s10, s11
  v_add_u32 v126, s10, v124
  v_mul_u32_u24 v117, 0x500, v126
  v_lshl_add_u32 v117, v125, 3, v117
  s_mul_i32 s11, s29, 160
  v_add_u32 v117, s11, v117
  s_waitcnt lgkmcnt(0)
  s_mov_b32 s24, s8
  s_mov_b32 s25, s9
  s_mov_b32 s26, 25165824
  s_mov_b32 s27, 0x20000
  s_mov_b32 s12, s4
  s_mov_b32 s13, s5
  s_mov_b32 s14, 2621440
  s_mov_b32 s15, 0x20000
  s_mov_b32 s16, s6
  s_mov_b32 s17, s7
  s_mov_b32 s18, 2621440
  s_mov_b32 s19, 0x20000
  s_add_u32 s8, s8, 2629632
  s_addc_u32 s9, s9, 0
  s_load_dwordx8 s[36:43], s[8:9], 0
  s_mul_i32 s10, s28, 81920
  s_lshl_b32 s11, s3, 10
  s_add_u32 s10, s10, s11
  s_mul_i32 s11, s29, 10
  v_lshrrev_b32 v127, 1, v125
  v_add_u32 v127, s11, v127
  v_and_b32 v128, 1, v125
  v_lshlrev_b32 v128, 3, v128
  v_lshl_add_u32 v128, v124, 4, v128
  v_lshrrev_b32 v129, 2, v127
  v_lshl_add_u32 v129, v129, 12, v128
  v_and_b32 v130, 3, v127
  v_lshl_add_u32 v129, v130, 8, v129
  buffer_load_dwordx2 v[136:137], v129, s[24:27], s10 offen
  v_add_u32 v127, 2, v127
  v_lshrrev_b32 v129, 2, v127
  v_lshl_add_u32 v129, v129, 12, v128
  v_and_b32 v130, 3, v127
  v_lshl_add_u32 v129, v130, 8, v129
  buffer_load_dwordx2 v[138:139], v129, s[24:27], s10 offen
  v_add_u32 v127, 2, v127
  v_lshrrev_b32 v129, 2, v127
  v_lshl_add_u32 v129, v129, 12, v128
  v_and_b32 v130, 3, v127
  v_lshl_add_u32 v129, v130, 8, v129
  buffer_load_dwordx2 v[140:141], v129, s[24:27], s10 offen
  v_add_u32 v127, 2, v127
  v_lshrrev_b32 v129, 2, v127
  v_lshl_add_u32 v129, v129, 12, v128
  v_and_b32 v130, 3, v127
  v_lshl_add_u32 v129, v130, 8, v129
  buffer_load_dwordx2 v[142:143], v129, s[24:27], s10 offen
  v_add_u32 v127, 2, v127
  v_lshrrev_b32 v129, 2, v127
  v_lshl_add_u32 v129, v129, 12, v128
  v_and_b32 v130, 3, v127
  v_lshl_add_u32 v129, v130, 8, v129
  buffer_load_dwordx2 v[144:145], v129, s[24:27], s10 offen
  v_add_u32 v127, 2, v127
  buffer_load_dwordx4 a[0:3], v110, s[24:27], s30 offen offset:0
  buffer_load_dwordx4 a[4:7], v110, s[24:27], s30 offen offset:1024
  buffer_load_dwordx4 a[32:35], v114, s[24:27], s31 offen offset:0
  buffer_load_dwordx4 a[52:55], v115, s[24:27], s31 offen offset:1024
  buffer_load_dwordx4 a[8:11], v111, s[24:27], s30 offen offset:0
  buffer_load_dwordx4 a[12:15], v111, s[24:27], s30 offen offset:1024
  buffer_load_dwordx4 a[16:19], v112, s[24:27], s30 offen offset:0
  buffer_load_dwordx4 a[20:23], v112, s[24:27], s30 offen offset:1024
  buffer_load_dwordx4 a[24:27], v113, s[24:27], s30 offen offset:0
  buffer_load_dwordx4 a[28:31], v113, s[24:27], s30 offen offset:1024
  buffer_load_dwordx4 a[36:39], v114, s[24:27], s31 offen offset:1024
  buffer_load_dwordx4 a[56:59], v115, s[24:27], s31 offen offset:2048
  buffer_load_dwordx4 a[40:43], v114, s[24:27], s31 offen offset:2048
  buffer_load_dwordx4 a[60:63], v115, s[24:27], s31 offen offset:3072
  buffer_load_dwordx4 a[44:47], v114, s[24:27], s31 offen offset:3072
  buffer_load_dwordx4 a[64:67], v116, s[24:27], s31 offen offset:0
  buffer_load_dwordx4 a[48:51], v115, s[24:27], s31 offen offset:0
  buffer_load_dwordx4 a[68:71], v116, s[24:27], s31 offen offset:1024
  s_add_u32 s30, s30, 8192
  s_add_u32 s31, s31, 10240
  buffer_load_dwordx4 a[72:75], v110, s[24:27], s30 offen offset:0
  buffer_load_dwordx4 a[76:79], v110, s[24:27], s30 offen offset:1024
  buffer_load_dwordx4 a[104:107], v114, s[24:27], s31 offen offset:0
  buffer_load_dwordx4 a[124:127], v115, s[24:27], s31 offen offset:1024
  buffer_load_dwordx4 a[80:83], v111, s[24:27], s30 offen offset:0
  buffer_load_dwordx4 a[84:87], v111, s[24:27], s30 offen offset:1024
  buffer_load_dwordx4 a[88:91], v112, s[24:27], s30 offen offset:0
  buffer_load_dwordx4 a[92:95], v112, s[24:27], s30 offen offset:1024
  buffer_load_dwordx4 a[96:99], v113, s[24:27], s30 offen offset:0
  buffer_load_dwordx4 a[100:103], v113, s[24:27], s30 offen offset:1024
  buffer_load_dwordx4 a[108:111], v114, s[24:27], s31 offen offset:1024
  buffer_load_dwordx4 a[128:131], v115, s[24:27], s31 offen offset:2048
  buffer_load_dwordx4 a[112:115], v114, s[24:27], s31 offen offset:2048
  buffer_load_dwordx4 a[132:135], v115, s[24:27], s31 offen offset:3072
  buffer_load_dwordx4 a[116:119], v114, s[24:27], s31 offen offset:3072
  buffer_load_dwordx4 a[136:139], v116, s[24:27], s31 offen offset:0
  buffer_load_dwordx4 a[120:123], v115, s[24:27], s31 offen offset:0
  buffer_load_dwordx4 a[140:143], v116, s[24:27], s31 offen offset:1024
  s_add_u32 s30, s30, 8192
  s_add_u32 s31, s31, 10240
  buffer_load_dwordx4 a[144:147], v110, s[24:27], s30 offen offset:0
  buffer_load_dwordx4 a[148:151], v110, s[24:27], s30 offen offset:1024
  buffer_load_dwordx4 a[176:179], v114, s[24:27], s31 offen offset:0
  buffer_load_dwordx4 a[196:199], v115, s[24:27], s31 offen offset:1024
  buffer_load_dwordx4 a[152:155], v111, s[24:27], s30 offen offset:0
  buffer_load_dwordx4 a[156:159], v111, s[24:27], s30 offen offset:1024
  buffer_load_dwordx4 a[160:163], v112, s[24:27], s30 offen offset:0
  buffer_load_dwordx4 a[164:167], v112, s[24:27], s30 offen offset:1024
  buffer_load_dwordx4 a[168:171], v113, s[24:27], s30 offen offset:0
  buffer_load_dwordx4 a[172:175], v113, s[24:27], s30 offen offset:1024
  buffer_load_dwordx4 a[180:183], v114, s[24:27], s31 offen offset:1024
  buffer_load_dwordx4 a[200:203], v115, s[24:27], s31 offen offset:2048
  buffer_load_dwordx4 a[184:187], v114, s[24:27], s31 offen offset:2048
  buffer_load_dwordx4 a[204:207], v115, s[24:27], s31 offen offset:3072
  buffer_load_dwordx4 a[188:191], v114, s[24:27], s31 offen offset:3072
  buffer_load_dwordx4 a[208:211], v116, s[24:27], s31 offen offset:0
  buffer_load_dwordx4 a[192:195], v115, s[24:27], s31 offen offset:0
  buffer_load_dwordx4 a[212:215], v116, s[24:27], s31 offen offset:1024
  s_add_u32 s30, s30, 8192
  s_add_u32 s31, s31, 10240
  s_mov_b32 s33, 0xffff0000
  s_waitcnt vmcnt(58)
  v_lshlrev_b32 v90, 16, v136
  v_and_b32 v91, s33, v136
  v_lshlrev_b32 v92, 16, v137
  v_and_b32 v93, s33, v137
  s_waitcnt vmcnt(57)
  v_lshlrev_b32 v94, 16, v138
  v_and_b32 v95, s33, v138
  v_lshlrev_b32 v96, 16, v139
  v_and_b32 v97, s33, v139
  s_waitcnt vmcnt(56)
  v_lshlrev_b32 v98, 16, v140
  v_and_b32 v99, s33, v140
  v_lshlrev_b32 v100, 16, v141
  v_and_b32 v101, s33, v141
  s_waitcnt vmcnt(55)
  v_lshlrev_b32 v102, 16, v142
  v_and_b32 v103, s33, v142
  v_lshlrev_b32 v104, 16, v143
  v_and_b32 v105, s33, v143
  s_waitcnt vmcnt(54)
  v_lshlrev_b32 v106, 16, v144
  v_and_b32 v107, s33, v144
  v_lshlrev_b32 v108, 16, v145
  v_and_b32 v109, s33, v145
  buffer_load_dwordx2 v[80:81], v117, s[12:15], 0 offen offset:0
  buffer_load_dwordx2 v[82:83], v117, s[12:15], 0 offen offset:32
  buffer_load_dwordx2 v[84:85], v117, s[12:15], 0 offen offset:64
  buffer_load_dwordx2 v[86:87], v117, s[12:15], 0 offen offset:96
  buffer_load_dwordx2 v[88:89], v117, s[12:15], 0 offen offset:128
  v_mov_b32 v127, -1
  s_waitcnt lgkmcnt(0)
  v_cmp_eq_u32 vcc, s36, v126
  s_nop 1
  v_cndmask_b32_e64 v127, v127, 0, vcc
  v_cmp_eq_u32 vcc, s37, v126
  s_nop 1
  v_cndmask_b32_e64 v127, v127, 1, vcc
  v_cmp_eq_u32 vcc, s38, v126
  s_nop 1
  v_cndmask_b32_e64 v127, v127, 2, vcc
  v_cmp_eq_u32 vcc, s39, v126
  s_nop 1
  v_cndmask_b32_e64 v127, v127, 3, vcc
  v_cmp_eq_u32 vcc, s40, v126
  s_nop 1
  v_cndmask_b32_e64 v127, v127, 4, vcc
  v_cmp_eq_u32 vcc, s41, v126
  s_nop 1
  v_cndmask_b32_e64 v127, v127, 5, vcc
  v_cmp_eq_u32 vcc, s42, v126
  s_nop 1
  v_cndmask_b32_e64 v127, v127, 6, vcc
  v_cmp_eq_u32 vcc, s43, v126
  s_nop 1
  v_cndmask_b32_e64 v127, v127, 7, vcc
  v_cmp_ne_u32 vcc, -1, v127
  s_nop 0
  s_and_saveexec_b64 s[34:35], vcc
  s_cbranch_execz out_noroute
  s_waitcnt vmcnt(28)
  v_lshlrev_b32 v128, 2, v127
  s_mov_b32 s10, 2629664
  buffer_load_dword v129, v128, s[24:27], s10 offen
  v_mul_u32_u24 v128, 0xa00, v127
  v_lshl_add_u32 v128, v125, 4, v128
  s_mul_i32 s10, s29, 320
  s_add_u32 s10, s10, 2686976
  buffer_load_dwordx4 v[0:3], v128, s[24:27], s10 offen offset:0
  buffer_load_dwordx4 v[4:7], v128, s[24:27], s10 offen offset:64
  buffer_load_dwordx4 v[8:11], v128, s[24:27], s10 offen offset:128
  buffer_load_dwordx4 v[12:15], v128, s[24:27], s10 offen offset:192
  buffer_load_dwordx4 v[16:19], v128, s[24:27], s10 offen offset:256
  s_add_u32 s10, s10, 20480
  buffer_load_dwordx4 v[20:23], v128, s[24:27], s10 offen offset:0
  buffer_load_dwordx4 v[24:27], v128, s[24:27], s10 offen offset:64
  buffer_load_dwordx4 v[28:31], v128, s[24:27], s10 offen offset:128
  buffer_load_dwordx4 v[32:35], v128, s[24:27], s10 offen offset:192
  buffer_load_dwordx4 v[36:39], v128, s[24:27], s10 offen offset:256
  s_add_u32 s10, s10, 20480
  buffer_load_dwordx4 v[40:43], v128, s[24:27], s10 offen offset:0
  buffer_load_dwordx4 v[44:47], v128, s[24:27], s10 offen offset:64
  buffer_load_dwordx4 v[48:51], v128, s[24:27], s10 offen offset:128
  buffer_load_dwordx4 v[52:55], v128, s[24:27], s10 offen offset:192
  buffer_load_dwordx4 v[56:59], v128, s[24:27], s10 offen offset:256
  s_add_u32 s10, s10, 20480
  buffer_load_dwordx4 v[60:63], v128, s[24:27], s10 offen offset:0
  buffer_load_dwordx4 v[64:67], v128, s[24:27], s10 offen offset:64
  buffer_load_dwordx4 v[68:71], v128, s[24:27], s10 offen offset:128
  buffer_load_dwordx4 v[72:75], v128, s[24:27], s10 offen offset:192
  buffer_load_dwordx4 v[76:79], v128, s[24:27], s10 offen offset:256
  s_add_u32 s10, s10, 20480
  buffer_load_dwordx4 v[152:155], v128, s[24:27], s10 offen offset:0
  buffer_load_dwordx4 v[156:159], v128, s[24:27], s10 offen offset:64
  buffer_load_dwordx4 v[160:163], v128, s[24:27], s10 offen offset:128
  buffer_load_dwordx4 v[164:167], v128, s[24:27], s10 offen offset:192
  buffer_load_dwordx4 v[168:171], v128, s[24:27], s10 offen offset:256
  s_add_u32 s10, s10, 20480
  buffer_load_dwordx4 v[172:175], v128, s[24:27], s10 offen offset:0
  buffer_load_dwordx4 v[176:179], v128, s[24:27], s10 offen offset:64
  buffer_load_dwordx4 v[180:183], v128, s[24:27], s10 offen offset:128
  buffer_load_dwordx4 v[184:187], v128, s[24:27], s10 offen offset:192
  buffer_load_dwordx4 v[188:191], v128, s[24:27], s10 offen offset:256
  s_add_u32 s10, s10, 20480
  s_waitcnt vmcnt(0)
  v_add_f32 v0, v0, v20
  v_add_f32 v0, v0, v40
  v_add_f32 v0, v0, v60
  v_add_f32 v0, v0, v152
  v_add_f32 v0, v0, v172
  v_cvt_pk_bf16_f32 v0, v0, v0
  v_lshlrev_b32 v0, 16, v0
  v_mul_f32 v0, v0, v129
  v_cvt_pk_bf16_f32 v0, v0, v0
  v_lshlrev_b32 v0, 16, v0
  v_add_f32 v90, v90, v0
  v_cvt_pk_bf16_f32 v90, v90, v90
  v_lshlrev_b32 v90, 16, v90
  v_add_f32 v1, v1, v21
  v_add_f32 v1, v1, v41
  v_add_f32 v1, v1, v61
  v_add_f32 v1, v1, v153
  v_add_f32 v1, v1, v173
  v_cvt_pk_bf16_f32 v1, v1, v1
  v_lshlrev_b32 v1, 16, v1
  v_mul_f32 v1, v1, v129
  v_cvt_pk_bf16_f32 v1, v1, v1
  v_lshlrev_b32 v1, 16, v1
  v_add_f32 v91, v91, v1
  v_cvt_pk_bf16_f32 v91, v91, v91
  v_lshlrev_b32 v91, 16, v91
  v_add_f32 v2, v2, v22
  v_add_f32 v2, v2, v42
  v_add_f32 v2, v2, v62
  v_add_f32 v2, v2, v154
  v_add_f32 v2, v2, v174
  v_cvt_pk_bf16_f32 v2, v2, v2
  v_lshlrev_b32 v2, 16, v2
  v_mul_f32 v2, v2, v129
  v_cvt_pk_bf16_f32 v2, v2, v2
  v_lshlrev_b32 v2, 16, v2
  v_add_f32 v92, v92, v2
  v_cvt_pk_bf16_f32 v92, v92, v92
  v_lshlrev_b32 v92, 16, v92
  v_add_f32 v3, v3, v23
  v_add_f32 v3, v3, v43
  v_add_f32 v3, v3, v63
  v_add_f32 v3, v3, v155
  v_add_f32 v3, v3, v175
  v_cvt_pk_bf16_f32 v3, v3, v3
  v_lshlrev_b32 v3, 16, v3
  v_mul_f32 v3, v3, v129
  v_cvt_pk_bf16_f32 v3, v3, v3
  v_lshlrev_b32 v3, 16, v3
  v_add_f32 v93, v93, v3
  v_cvt_pk_bf16_f32 v93, v93, v93
  v_lshlrev_b32 v93, 16, v93
  v_add_f32 v4, v4, v24
  v_add_f32 v4, v4, v44
  v_add_f32 v4, v4, v64
  v_add_f32 v4, v4, v156
  v_add_f32 v4, v4, v176
  v_cvt_pk_bf16_f32 v4, v4, v4
  v_lshlrev_b32 v4, 16, v4
  v_mul_f32 v4, v4, v129
  v_cvt_pk_bf16_f32 v4, v4, v4
  v_lshlrev_b32 v4, 16, v4
  v_add_f32 v94, v94, v4
  v_cvt_pk_bf16_f32 v94, v94, v94
  v_lshlrev_b32 v94, 16, v94
  v_add_f32 v5, v5, v25
  v_add_f32 v5, v5, v45
  v_add_f32 v5, v5, v65
  v_add_f32 v5, v5, v157
  v_add_f32 v5, v5, v177
  v_cvt_pk_bf16_f32 v5, v5, v5
  v_lshlrev_b32 v5, 16, v5
  v_mul_f32 v5, v5, v129
  v_cvt_pk_bf16_f32 v5, v5, v5
  v_lshlrev_b32 v5, 16, v5
  v_add_f32 v95, v95, v5
  v_cvt_pk_bf16_f32 v95, v95, v95
  v_lshlrev_b32 v95, 16, v95
  v_add_f32 v6, v6, v26
  v_add_f32 v6, v6, v46
  v_add_f32 v6, v6, v66
  v_add_f32 v6, v6, v158
  v_add_f32 v6, v6, v178
  v_cvt_pk_bf16_f32 v6, v6, v6
  v_lshlrev_b32 v6, 16, v6
  v_mul_f32 v6, v6, v129
  v_cvt_pk_bf16_f32 v6, v6, v6
  v_lshlrev_b32 v6, 16, v6
  v_add_f32 v96, v96, v6
  v_cvt_pk_bf16_f32 v96, v96, v96
  v_lshlrev_b32 v96, 16, v96
  v_add_f32 v7, v7, v27
  v_add_f32 v7, v7, v47
  v_add_f32 v7, v7, v67
  v_add_f32 v7, v7, v159
  v_add_f32 v7, v7, v179
  v_cvt_pk_bf16_f32 v7, v7, v7
  v_lshlrev_b32 v7, 16, v7
  v_mul_f32 v7, v7, v129
  v_cvt_pk_bf16_f32 v7, v7, v7
  v_lshlrev_b32 v7, 16, v7
  v_add_f32 v97, v97, v7
  v_cvt_pk_bf16_f32 v97, v97, v97
  v_lshlrev_b32 v97, 16, v97
  v_add_f32 v8, v8, v28
  v_add_f32 v8, v8, v48
  v_add_f32 v8, v8, v68
  v_add_f32 v8, v8, v160
  v_add_f32 v8, v8, v180
  v_cvt_pk_bf16_f32 v8, v8, v8
  v_lshlrev_b32 v8, 16, v8
  v_mul_f32 v8, v8, v129
  v_cvt_pk_bf16_f32 v8, v8, v8
  v_lshlrev_b32 v8, 16, v8
  v_add_f32 v98, v98, v8
  v_cvt_pk_bf16_f32 v98, v98, v98
  v_lshlrev_b32 v98, 16, v98
  v_add_f32 v9, v9, v29
  v_add_f32 v9, v9, v49
  v_add_f32 v9, v9, v69
  v_add_f32 v9, v9, v161
  v_add_f32 v9, v9, v181
  v_cvt_pk_bf16_f32 v9, v9, v9
  v_lshlrev_b32 v9, 16, v9
  v_mul_f32 v9, v9, v129
  v_cvt_pk_bf16_f32 v9, v9, v9
  v_lshlrev_b32 v9, 16, v9
  v_add_f32 v99, v99, v9
  v_cvt_pk_bf16_f32 v99, v99, v99
  v_lshlrev_b32 v99, 16, v99
  v_add_f32 v10, v10, v30
  v_add_f32 v10, v10, v50
  v_add_f32 v10, v10, v70
  v_add_f32 v10, v10, v162
  v_add_f32 v10, v10, v182
  v_cvt_pk_bf16_f32 v10, v10, v10
  v_lshlrev_b32 v10, 16, v10
  v_mul_f32 v10, v10, v129
  v_cvt_pk_bf16_f32 v10, v10, v10
  v_lshlrev_b32 v10, 16, v10
  v_add_f32 v100, v100, v10
  v_cvt_pk_bf16_f32 v100, v100, v100
  v_lshlrev_b32 v100, 16, v100
  v_add_f32 v11, v11, v31
  v_add_f32 v11, v11, v51
  v_add_f32 v11, v11, v71
  v_add_f32 v11, v11, v163
  v_add_f32 v11, v11, v183
  v_cvt_pk_bf16_f32 v11, v11, v11
  v_lshlrev_b32 v11, 16, v11
  v_mul_f32 v11, v11, v129
  v_cvt_pk_bf16_f32 v11, v11, v11
  v_lshlrev_b32 v11, 16, v11
  v_add_f32 v101, v101, v11
  v_cvt_pk_bf16_f32 v101, v101, v101
  v_lshlrev_b32 v101, 16, v101
  v_add_f32 v12, v12, v32
  v_add_f32 v12, v12, v52
  v_add_f32 v12, v12, v72
  v_add_f32 v12, v12, v164
  v_add_f32 v12, v12, v184
  v_cvt_pk_bf16_f32 v12, v12, v12
  v_lshlrev_b32 v12, 16, v12
  v_mul_f32 v12, v12, v129
  v_cvt_pk_bf16_f32 v12, v12, v12
  v_lshlrev_b32 v12, 16, v12
  v_add_f32 v102, v102, v12
  v_cvt_pk_bf16_f32 v102, v102, v102
  v_lshlrev_b32 v102, 16, v102
  v_add_f32 v13, v13, v33
  v_add_f32 v13, v13, v53
  v_add_f32 v13, v13, v73
  v_add_f32 v13, v13, v165
  v_add_f32 v13, v13, v185
  v_cvt_pk_bf16_f32 v13, v13, v13
  v_lshlrev_b32 v13, 16, v13
  v_mul_f32 v13, v13, v129
  v_cvt_pk_bf16_f32 v13, v13, v13
  v_lshlrev_b32 v13, 16, v13
  v_add_f32 v103, v103, v13
  v_cvt_pk_bf16_f32 v103, v103, v103
  v_lshlrev_b32 v103, 16, v103
  v_add_f32 v14, v14, v34
  v_add_f32 v14, v14, v54
  v_add_f32 v14, v14, v74
  v_add_f32 v14, v14, v166
  v_add_f32 v14, v14, v186
  v_cvt_pk_bf16_f32 v14, v14, v14
  v_lshlrev_b32 v14, 16, v14
  v_mul_f32 v14, v14, v129
  v_cvt_pk_bf16_f32 v14, v14, v14
  v_lshlrev_b32 v14, 16, v14
  v_add_f32 v104, v104, v14
  v_cvt_pk_bf16_f32 v104, v104, v104
  v_lshlrev_b32 v104, 16, v104
  v_add_f32 v15, v15, v35
  v_add_f32 v15, v15, v55
  v_add_f32 v15, v15, v75
  v_add_f32 v15, v15, v167
  v_add_f32 v15, v15, v187
  v_cvt_pk_bf16_f32 v15, v15, v15
  v_lshlrev_b32 v15, 16, v15
  v_mul_f32 v15, v15, v129
  v_cvt_pk_bf16_f32 v15, v15, v15
  v_lshlrev_b32 v15, 16, v15
  v_add_f32 v105, v105, v15
  v_cvt_pk_bf16_f32 v105, v105, v105
  v_lshlrev_b32 v105, 16, v105
  v_add_f32 v16, v16, v36
  v_add_f32 v16, v16, v56
  v_add_f32 v16, v16, v76
  v_add_f32 v16, v16, v168
  v_add_f32 v16, v16, v188
  v_cvt_pk_bf16_f32 v16, v16, v16
  v_lshlrev_b32 v16, 16, v16
  v_mul_f32 v16, v16, v129
  v_cvt_pk_bf16_f32 v16, v16, v16
  v_lshlrev_b32 v16, 16, v16
  v_add_f32 v106, v106, v16
  v_cvt_pk_bf16_f32 v106, v106, v106
  v_lshlrev_b32 v106, 16, v106
  v_add_f32 v17, v17, v37
  v_add_f32 v17, v17, v57
  v_add_f32 v17, v17, v77
  v_add_f32 v17, v17, v169
  v_add_f32 v17, v17, v189
  v_cvt_pk_bf16_f32 v17, v17, v17
  v_lshlrev_b32 v17, 16, v17
  v_mul_f32 v17, v17, v129
  v_cvt_pk_bf16_f32 v17, v17, v17
  v_lshlrev_b32 v17, 16, v17
  v_add_f32 v107, v107, v17
  v_cvt_pk_bf16_f32 v107, v107, v107
  v_lshlrev_b32 v107, 16, v107
  v_add_f32 v18, v18, v38
  v_add_f32 v18, v18, v58
  v_add_f32 v18, v18, v78
  v_add_f32 v18, v18, v170
  v_add_f32 v18, v18, v190
  v_cvt_pk_bf16_f32 v18, v18, v18
  v_lshlrev_b32 v18, 16, v18
  v_mul_f32 v18, v18, v129
  v_cvt_pk_bf16_f32 v18, v18, v18
  v_lshlrev_b32 v18, 16, v18
  v_add_f32 v108, v108, v18
  v_cvt_pk_bf16_f32 v108, v108, v108
  v_lshlrev_b32 v108, 16, v108
  v_add_f32 v19, v19, v39
  v_add_f32 v19, v19, v59
  v_add_f32 v19, v19, v79
  v_add_f32 v19, v19, v171
  v_add_f32 v19, v19, v191
  v_cvt_pk_bf16_f32 v19, v19, v19
  v_lshlrev_b32 v19, 16, v19
  v_mul_f32 v19, v19, v129
  v_cvt_pk_bf16_f32 v19, v19, v19
  v_lshlrev_b32 v19, 16, v19
  v_add_f32 v109, v109, v19
  v_cvt_pk_bf16_f32 v109, v109, v109
  v_lshlrev_b32 v109, 16, v109
out_noroute:
  s_mov_b64 exec, s[34:35]
  v_mov_b32 v0, 0
  v_mov_b32 v1, 0
  v_mov_b32 v2, 0
  v_mov_b32 v3, 0
  v_mov_b32 v4, 0
  v_mov_b32 v5, 0
  v_mov_b32 v6, 0
  v_mov_b32 v7, 0
  v_mov_b32 v8, 0
  v_mov_b32 v9, 0
  v_mov_b32 v10, 0
  v_mov_b32 v11, 0
  v_mov_b32 v12, 0
  v_mov_b32 v13, 0
  v_mov_b32 v14, 0
  v_mov_b32 v15, 0
  v_mov_b32 v16, 0
  v_mov_b32 v17, 0
  v_mov_b32 v18, 0
  v_mov_b32 v19, 0
  v_mov_b32 v20, 0
  v_mov_b32 v21, 0
  v_mov_b32 v22, 0
  v_mov_b32 v23, 0
  v_mov_b32 v24, 0
  v_mov_b32 v25, 0
  v_mov_b32 v26, 0
  v_mov_b32 v27, 0
  v_mov_b32 v28, 0
  v_mov_b32 v29, 0
  v_mov_b32 v30, 0
  v_mov_b32 v31, 0
  v_mov_b32 v32, 0
  v_mov_b32 v33, 0
  v_mov_b32 v34, 0
  v_mov_b32 v35, 0
  v_mov_b32 v36, 0
  v_mov_b32 v37, 0
  v_mov_b32 v38, 0
  v_mov_b32 v39, 0
  v_mov_b32 v40, 0
  v_mov_b32 v41, 0
  v_mov_b32 v42, 0
  v_mov_b32 v43, 0
  v_mov_b32 v44, 0
  v_mov_b32 v45, 0
  v_mov_b32 v46, 0
  v_mov_b32 v47, 0
  v_mov_b32 v48, 0
  v_mov_b32 v49, 0
  v_mov_b32 v50, 0
  v_mov_b32 v51, 0
  v_mov_b32 v52, 0
  v_mov_b32 v53, 0
  v_mov_b32 v54, 0
  v_mov_b32 v55, 0
  v_mov_b32 v56, 0
  v_mov_b32 v57, 0
  v_mov_b32 v58, 0
  v_mov_b32 v59, 0
  v_mov_b32 v60, 0
  v_mov_b32 v61, 0
  v_mov_b32 v62, 0
  v_mov_b32 v63, 0
  v_mov_b32 v64, 0
  v_mov_b32 v65, 0
  v_mov_b32 v66, 0
  v_mov_b32 v67, 0
  v_mov_b32 v68, 0
  v_mov_b32 v69, 0
  v_mov_b32 v70, 0
  v_mov_b32 v71, 0
  v_mov_b32 v72, 0
  v_mov_b32 v73, 0
  v_mov_b32 v74, 0
  v_mov_b32 v75, 0
  v_mov_b32 v76, 0
  v_mov_b32 v77, 0
  v_mov_b32 v78, 0
  v_mov_b32 v79, 0
  s_mov_b32 s32, 3
out_loop:
  s_waitcnt vmcnt(44)
  v_mfma_f32_16x16x32_bf16 v[0:3], a[32:35], a[0:3], v[0:3]
  buffer_load_dwordx4 v[136:139], v110, s[24:27], s30 offen offset:0
  v_mfma_f32_16x16x32_bf16 v[0:3], a[52:55], a[4:7], v[0:3]
  buffer_load_dwordx4 v[140:143], v110, s[24:27], s30 offen offset:1024
  v_mfma_f32_16x16x32_bf16 v[4:7], a[52:55], a[12:15], v[4:7]
  buffer_load_dwordx4 v[168:171], v114, s[24:27], s31 offen offset:0
  v_mfma_f32_16x16x32_bf16 v[4:7], a[32:35], a[8:11], v[4:7]
  buffer_load_dwordx4 v[188:191], v115, s[24:27], s31 offen offset:1024
  v_mfma_f32_16x16x32_bf16 v[8:11], a[32:35], a[16:19], v[8:11]
  buffer_load_dwordx4 v[144:147], v111, s[24:27], s30 offen offset:0
  v_mfma_f32_16x16x32_bf16 v[8:11], a[52:55], a[20:23], v[8:11]
  buffer_load_dwordx4 v[148:151], v111, s[24:27], s30 offen offset:1024
  v_mfma_f32_16x16x32_bf16 v[12:15], a[52:55], a[28:31], v[12:15]
  s_waitcnt vmcnt(42)
  v_mfma_f32_16x16x32_bf16 v[12:15], a[32:35], a[24:27], v[12:15]
  buffer_load_dwordx4 v[152:155], v112, s[24:27], s30 offen offset:0
  v_mfma_f32_16x16x32_bf16 v[16:19], a[36:39], a[0:3], v[16:19]
  buffer_load_dwordx4 v[156:159], v112, s[24:27], s30 offen offset:1024
  v_mfma_f32_16x16x32_bf16 v[16:19], a[56:59], a[4:7], v[16:19]
  buffer_load_dwordx4 v[160:163], v113, s[24:27], s30 offen offset:0
  v_mfma_f32_16x16x32_bf16 v[20:23], a[56:59], a[12:15], v[20:23]
  buffer_load_dwordx4 v[164:167], v113, s[24:27], s30 offen offset:1024
  v_mfma_f32_16x16x32_bf16 v[20:23], a[36:39], a[8:11], v[20:23]
  buffer_load_dwordx4 v[172:175], v114, s[24:27], s31 offen offset:1024
  v_mfma_f32_16x16x32_bf16 v[24:27], a[36:39], a[16:19], v[24:27]
  buffer_load_dwordx4 v[192:195], v115, s[24:27], s31 offen offset:2048
  v_mfma_f32_16x16x32_bf16 v[24:27], a[56:59], a[20:23], v[24:27]
  buffer_load_dwordx4 v[176:179], v114, s[24:27], s31 offen offset:2048
  v_mfma_f32_16x16x32_bf16 v[28:31], a[56:59], a[28:31], v[28:31]
  buffer_load_dwordx4 v[196:199], v115, s[24:27], s31 offen offset:3072
  v_mfma_f32_16x16x32_bf16 v[28:31], a[36:39], a[24:27], v[28:31]
  buffer_load_dwordx4 v[180:183], v114, s[24:27], s31 offen offset:3072
  v_mfma_f32_16x16x32_bf16 v[32:35], a[40:43], a[0:3], v[32:35]
  buffer_load_dwordx4 v[200:203], v116, s[24:27], s31 offen offset:0
  v_mfma_f32_16x16x32_bf16 v[32:35], a[60:63], a[4:7], v[32:35]
  buffer_load_dwordx4 v[184:187], v115, s[24:27], s31 offen offset:0
  v_mfma_f32_16x16x32_bf16 v[36:39], a[60:63], a[12:15], v[36:39]
  buffer_load_dwordx4 v[204:207], v116, s[24:27], s31 offen offset:1024
  v_mfma_f32_16x16x32_bf16 v[36:39], a[40:43], a[8:11], v[36:39]
  s_add_u32 s30, s30, 8192
  v_mfma_f32_16x16x32_bf16 v[40:43], a[40:43], a[16:19], v[40:43]
  s_add_u32 s31, s31, 10240
  v_mfma_f32_16x16x32_bf16 v[40:43], a[60:63], a[20:23], v[40:43]
  v_mfma_f32_16x16x32_bf16 v[44:47], a[60:63], a[28:31], v[44:47]
  v_mfma_f32_16x16x32_bf16 v[44:47], a[40:43], a[24:27], v[44:47]
  v_mfma_f32_16x16x32_bf16 v[48:51], a[44:47], a[0:3], v[48:51]
  v_mfma_f32_16x16x32_bf16 v[48:51], a[64:67], a[4:7], v[48:51]
  v_mfma_f32_16x16x32_bf16 v[52:55], a[64:67], a[12:15], v[52:55]
  v_mfma_f32_16x16x32_bf16 v[52:55], a[44:47], a[8:11], v[52:55]
  v_mfma_f32_16x16x32_bf16 v[56:59], a[44:47], a[16:19], v[56:59]
  v_mfma_f32_16x16x32_bf16 v[56:59], a[64:67], a[20:23], v[56:59]
  v_mfma_f32_16x16x32_bf16 v[60:63], a[64:67], a[28:31], v[60:63]
  v_mfma_f32_16x16x32_bf16 v[60:63], a[44:47], a[24:27], v[60:63]
  v_mfma_f32_16x16x32_bf16 v[64:67], a[48:51], a[0:3], v[64:67]
  v_mfma_f32_16x16x32_bf16 v[64:67], a[68:71], a[4:7], v[64:67]
  v_mfma_f32_16x16x32_bf16 v[68:71], a[68:71], a[12:15], v[68:71]
  v_mfma_f32_16x16x32_bf16 v[68:71], a[48:51], a[8:11], v[68:71]
  v_mfma_f32_16x16x32_bf16 v[72:75], a[48:51], a[16:19], v[72:75]
  v_mfma_f32_16x16x32_bf16 v[72:75], a[68:71], a[20:23], v[72:75]
  v_mfma_f32_16x16x32_bf16 v[76:79], a[68:71], a[28:31], v[76:79]
  v_mfma_f32_16x16x32_bf16 v[76:79], a[48:51], a[24:27], v[76:79]
  s_waitcnt vmcnt(44)
  v_mfma_f32_16x16x32_bf16 v[0:3], a[104:107], a[72:75], v[0:3]
  buffer_load_dwordx4 a[0:3], v110, s[24:27], s30 offen offset:0
  v_mfma_f32_16x16x32_bf16 v[0:3], a[124:127], a[76:79], v[0:3]
  buffer_load_dwordx4 a[4:7], v110, s[24:27], s30 offen offset:1024
  v_mfma_f32_16x16x32_bf16 v[4:7], a[124:127], a[84:87], v[4:7]
  buffer_load_dwordx4 a[32:35], v114, s[24:27], s31 offen offset:0
  v_mfma_f32_16x16x32_bf16 v[4:7], a[104:107], a[80:83], v[4:7]
  buffer_load_dwordx4 a[52:55], v115, s[24:27], s31 offen offset:1024
  v_mfma_f32_16x16x32_bf16 v[8:11], a[104:107], a[88:91], v[8:11]
  buffer_load_dwordx4 a[8:11], v111, s[24:27], s30 offen offset:0
  v_mfma_f32_16x16x32_bf16 v[8:11], a[124:127], a[92:95], v[8:11]
  buffer_load_dwordx4 a[12:15], v111, s[24:27], s30 offen offset:1024
  v_mfma_f32_16x16x32_bf16 v[12:15], a[124:127], a[100:103], v[12:15]
  s_waitcnt vmcnt(42)
  v_mfma_f32_16x16x32_bf16 v[12:15], a[104:107], a[96:99], v[12:15]
  buffer_load_dwordx4 a[16:19], v112, s[24:27], s30 offen offset:0
  v_mfma_f32_16x16x32_bf16 v[16:19], a[108:111], a[72:75], v[16:19]
  buffer_load_dwordx4 a[20:23], v112, s[24:27], s30 offen offset:1024
  v_mfma_f32_16x16x32_bf16 v[16:19], a[128:131], a[76:79], v[16:19]
  buffer_load_dwordx4 a[24:27], v113, s[24:27], s30 offen offset:0
  v_mfma_f32_16x16x32_bf16 v[20:23], a[128:131], a[84:87], v[20:23]
  buffer_load_dwordx4 a[28:31], v113, s[24:27], s30 offen offset:1024
  v_mfma_f32_16x16x32_bf16 v[20:23], a[108:111], a[80:83], v[20:23]
  buffer_load_dwordx4 a[36:39], v114, s[24:27], s31 offen offset:1024
  v_mfma_f32_16x16x32_bf16 v[24:27], a[108:111], a[88:91], v[24:27]
  buffer_load_dwordx4 a[56:59], v115, s[24:27], s31 offen offset:2048
  v_mfma_f32_16x16x32_bf16 v[24:27], a[128:131], a[92:95], v[24:27]
  buffer_load_dwordx4 a[40:43], v114, s[24:27], s31 offen offset:2048
  v_mfma_f32_16x16x32_bf16 v[28:31], a[128:131], a[100:103], v[28:31]
  buffer_load_dwordx4 a[60:63], v115, s[24:27], s31 offen offset:3072
  v_mfma_f32_16x16x32_bf16 v[28:31], a[108:111], a[96:99], v[28:31]
  buffer_load_dwordx4 a[44:47], v114, s[24:27], s31 offen offset:3072
  v_mfma_f32_16x16x32_bf16 v[32:35], a[112:115], a[72:75], v[32:35]
  buffer_load_dwordx4 a[64:67], v116, s[24:27], s31 offen offset:0
  v_mfma_f32_16x16x32_bf16 v[32:35], a[132:135], a[76:79], v[32:35]
  buffer_load_dwordx4 a[48:51], v115, s[24:27], s31 offen offset:0
  v_mfma_f32_16x16x32_bf16 v[36:39], a[132:135], a[84:87], v[36:39]
  buffer_load_dwordx4 a[68:71], v116, s[24:27], s31 offen offset:1024
  v_mfma_f32_16x16x32_bf16 v[36:39], a[112:115], a[80:83], v[36:39]
  s_add_u32 s30, s30, 8192
  v_mfma_f32_16x16x32_bf16 v[40:43], a[112:115], a[88:91], v[40:43]
  s_add_u32 s31, s31, 10240
  v_mfma_f32_16x16x32_bf16 v[40:43], a[132:135], a[92:95], v[40:43]
  v_mfma_f32_16x16x32_bf16 v[44:47], a[132:135], a[100:103], v[44:47]
  v_mfma_f32_16x16x32_bf16 v[44:47], a[112:115], a[96:99], v[44:47]
  v_mfma_f32_16x16x32_bf16 v[48:51], a[116:119], a[72:75], v[48:51]
  v_mfma_f32_16x16x32_bf16 v[48:51], a[136:139], a[76:79], v[48:51]
  v_mfma_f32_16x16x32_bf16 v[52:55], a[136:139], a[84:87], v[52:55]
  v_mfma_f32_16x16x32_bf16 v[52:55], a[116:119], a[80:83], v[52:55]
  v_mfma_f32_16x16x32_bf16 v[56:59], a[116:119], a[88:91], v[56:59]
  v_mfma_f32_16x16x32_bf16 v[56:59], a[136:139], a[92:95], v[56:59]
  v_mfma_f32_16x16x32_bf16 v[60:63], a[136:139], a[100:103], v[60:63]
  v_mfma_f32_16x16x32_bf16 v[60:63], a[116:119], a[96:99], v[60:63]
  v_mfma_f32_16x16x32_bf16 v[64:67], a[120:123], a[72:75], v[64:67]
  v_mfma_f32_16x16x32_bf16 v[64:67], a[140:143], a[76:79], v[64:67]
  v_mfma_f32_16x16x32_bf16 v[68:71], a[140:143], a[84:87], v[68:71]
  v_mfma_f32_16x16x32_bf16 v[68:71], a[120:123], a[80:83], v[68:71]
  v_mfma_f32_16x16x32_bf16 v[72:75], a[120:123], a[88:91], v[72:75]
  v_mfma_f32_16x16x32_bf16 v[72:75], a[140:143], a[92:95], v[72:75]
  v_mfma_f32_16x16x32_bf16 v[76:79], a[140:143], a[100:103], v[76:79]
  v_mfma_f32_16x16x32_bf16 v[76:79], a[120:123], a[96:99], v[76:79]
  s_waitcnt vmcnt(44)
  v_mfma_f32_16x16x32_bf16 v[0:3], a[176:179], a[144:147], v[0:3]
  buffer_load_dwordx4 a[72:75], v110, s[24:27], s30 offen offset:0
  v_mfma_f32_16x16x32_bf16 v[0:3], a[196:199], a[148:151], v[0:3]
  buffer_load_dwordx4 a[76:79], v110, s[24:27], s30 offen offset:1024
  v_mfma_f32_16x16x32_bf16 v[4:7], a[196:199], a[156:159], v[4:7]
  buffer_load_dwordx4 a[104:107], v114, s[24:27], s31 offen offset:0
  v_mfma_f32_16x16x32_bf16 v[4:7], a[176:179], a[152:155], v[4:7]
  buffer_load_dwordx4 a[124:127], v115, s[24:27], s31 offen offset:1024
  v_mfma_f32_16x16x32_bf16 v[8:11], a[176:179], a[160:163], v[8:11]
  buffer_load_dwordx4 a[80:83], v111, s[24:27], s30 offen offset:0
  v_mfma_f32_16x16x32_bf16 v[8:11], a[196:199], a[164:167], v[8:11]
  buffer_load_dwordx4 a[84:87], v111, s[24:27], s30 offen offset:1024
  v_mfma_f32_16x16x32_bf16 v[12:15], a[196:199], a[172:175], v[12:15]
  s_waitcnt vmcnt(42)
  v_mfma_f32_16x16x32_bf16 v[12:15], a[176:179], a[168:171], v[12:15]
  buffer_load_dwordx4 a[88:91], v112, s[24:27], s30 offen offset:0
  v_mfma_f32_16x16x32_bf16 v[16:19], a[180:183], a[144:147], v[16:19]
  buffer_load_dwordx4 a[92:95], v112, s[24:27], s30 offen offset:1024
  v_mfma_f32_16x16x32_bf16 v[16:19], a[200:203], a[148:151], v[16:19]
  buffer_load_dwordx4 a[96:99], v113, s[24:27], s30 offen offset:0
  v_mfma_f32_16x16x32_bf16 v[20:23], a[200:203], a[156:159], v[20:23]
  buffer_load_dwordx4 a[100:103], v113, s[24:27], s30 offen offset:1024
  v_mfma_f32_16x16x32_bf16 v[20:23], a[180:183], a[152:155], v[20:23]
  buffer_load_dwordx4 a[108:111], v114, s[24:27], s31 offen offset:1024
  v_mfma_f32_16x16x32_bf16 v[24:27], a[180:183], a[160:163], v[24:27]
  buffer_load_dwordx4 a[128:131], v115, s[24:27], s31 offen offset:2048
  v_mfma_f32_16x16x32_bf16 v[24:27], a[200:203], a[164:167], v[24:27]
  buffer_load_dwordx4 a[112:115], v114, s[24:27], s31 offen offset:2048
  v_mfma_f32_16x16x32_bf16 v[28:31], a[200:203], a[172:175], v[28:31]
  buffer_load_dwordx4 a[132:135], v115, s[24:27], s31 offen offset:3072
  v_mfma_f32_16x16x32_bf16 v[28:31], a[180:183], a[168:171], v[28:31]
  buffer_load_dwordx4 a[116:119], v114, s[24:27], s31 offen offset:3072
  v_mfma_f32_16x16x32_bf16 v[32:35], a[184:187], a[144:147], v[32:35]
  buffer_load_dwordx4 a[136:139], v116, s[24:27], s31 offen offset:0
  v_mfma_f32_16x16x32_bf16 v[32:35], a[204:207], a[148:151], v[32:35]
  buffer_load_dwordx4 a[120:123], v115, s[24:27], s31 offen offset:0
  v_mfma_f32_16x16x32_bf16 v[36:39], a[204:207], a[156:159], v[36:39]
  buffer_load_dwordx4 a[140:143], v116, s[24:27], s31 offen offset:1024
  v_mfma_f32_16x16x32_bf16 v[36:39], a[184:187], a[152:155], v[36:39]
  s_add_u32 s30, s30, 8192
  v_mfma_f32_16x16x32_bf16 v[40:43], a[184:187], a[160:163], v[40:43]
  s_add_u32 s31, s31, 10240
  v_mfma_f32_16x16x32_bf16 v[40:43], a[204:207], a[164:167], v[40:43]
  v_mfma_f32_16x16x32_bf16 v[44:47], a[204:207], a[172:175], v[44:47]
  v_mfma_f32_16x16x32_bf16 v[44:47], a[184:187], a[168:171], v[44:47]
  v_mfma_f32_16x16x32_bf16 v[48:51], a[188:191], a[144:147], v[48:51]
  v_mfma_f32_16x16x32_bf16 v[48:51], a[208:211], a[148:151], v[48:51]
  v_mfma_f32_16x16x32_bf16 v[52:55], a[208:211], a[156:159], v[52:55]
  v_mfma_f32_16x16x32_bf16 v[52:55], a[188:191], a[152:155], v[52:55]
  v_mfma_f32_16x16x32_bf16 v[56:59], a[188:191], a[160:163], v[56:59]
  v_mfma_f32_16x16x32_bf16 v[56:59], a[208:211], a[164:167], v[56:59]
  v_mfma_f32_16x16x32_bf16 v[60:63], a[208:211], a[172:175], v[60:63]
  v_mfma_f32_16x16x32_bf16 v[60:63], a[188:191], a[168:171], v[60:63]
  v_mfma_f32_16x16x32_bf16 v[64:67], a[192:195], a[144:147], v[64:67]
  v_mfma_f32_16x16x32_bf16 v[64:67], a[212:215], a[148:151], v[64:67]
  v_mfma_f32_16x16x32_bf16 v[68:71], a[212:215], a[156:159], v[68:71]
  v_mfma_f32_16x16x32_bf16 v[68:71], a[192:195], a[152:155], v[68:71]
  v_mfma_f32_16x16x32_bf16 v[72:75], a[192:195], a[160:163], v[72:75]
  v_mfma_f32_16x16x32_bf16 v[72:75], a[212:215], a[164:167], v[72:75]
  v_mfma_f32_16x16x32_bf16 v[76:79], a[212:215], a[172:175], v[76:79]
  v_mfma_f32_16x16x32_bf16 v[76:79], a[192:195], a[168:171], v[76:79]
  s_waitcnt vmcnt(44)
  v_mfma_f32_16x16x32_bf16 v[0:3], v[168:171], v[136:139], v[0:3]
  buffer_load_dwordx4 a[144:147], v110, s[24:27], s30 offen offset:0
  v_mfma_f32_16x16x32_bf16 v[0:3], v[188:191], v[140:143], v[0:3]
  buffer_load_dwordx4 a[148:151], v110, s[24:27], s30 offen offset:1024
  v_mfma_f32_16x16x32_bf16 v[4:7], v[188:191], v[148:151], v[4:7]
  buffer_load_dwordx4 a[176:179], v114, s[24:27], s31 offen offset:0
  v_mfma_f32_16x16x32_bf16 v[4:7], v[168:171], v[144:147], v[4:7]
  buffer_load_dwordx4 a[196:199], v115, s[24:27], s31 offen offset:1024
  v_mfma_f32_16x16x32_bf16 v[8:11], v[168:171], v[152:155], v[8:11]
  buffer_load_dwordx4 a[152:155], v111, s[24:27], s30 offen offset:0
  v_mfma_f32_16x16x32_bf16 v[8:11], v[188:191], v[156:159], v[8:11]
  buffer_load_dwordx4 a[156:159], v111, s[24:27], s30 offen offset:1024
  v_mfma_f32_16x16x32_bf16 v[12:15], v[188:191], v[164:167], v[12:15]
  s_waitcnt vmcnt(42)
  v_mfma_f32_16x16x32_bf16 v[12:15], v[168:171], v[160:163], v[12:15]
  buffer_load_dwordx4 a[160:163], v112, s[24:27], s30 offen offset:0
  v_mfma_f32_16x16x32_bf16 v[16:19], v[172:175], v[136:139], v[16:19]
  buffer_load_dwordx4 a[164:167], v112, s[24:27], s30 offen offset:1024
  v_mfma_f32_16x16x32_bf16 v[16:19], v[192:195], v[140:143], v[16:19]
  buffer_load_dwordx4 a[168:171], v113, s[24:27], s30 offen offset:0
  v_mfma_f32_16x16x32_bf16 v[20:23], v[192:195], v[148:151], v[20:23]
  buffer_load_dwordx4 a[172:175], v113, s[24:27], s30 offen offset:1024
  v_mfma_f32_16x16x32_bf16 v[20:23], v[172:175], v[144:147], v[20:23]
  buffer_load_dwordx4 a[180:183], v114, s[24:27], s31 offen offset:1024
  v_mfma_f32_16x16x32_bf16 v[24:27], v[172:175], v[152:155], v[24:27]
  buffer_load_dwordx4 a[200:203], v115, s[24:27], s31 offen offset:2048
  v_mfma_f32_16x16x32_bf16 v[24:27], v[192:195], v[156:159], v[24:27]
  buffer_load_dwordx4 a[184:187], v114, s[24:27], s31 offen offset:2048
  v_mfma_f32_16x16x32_bf16 v[28:31], v[192:195], v[164:167], v[28:31]
  buffer_load_dwordx4 a[204:207], v115, s[24:27], s31 offen offset:3072
  v_mfma_f32_16x16x32_bf16 v[28:31], v[172:175], v[160:163], v[28:31]
  buffer_load_dwordx4 a[188:191], v114, s[24:27], s31 offen offset:3072
  v_mfma_f32_16x16x32_bf16 v[32:35], v[176:179], v[136:139], v[32:35]
  buffer_load_dwordx4 a[208:211], v116, s[24:27], s31 offen offset:0
  v_mfma_f32_16x16x32_bf16 v[32:35], v[196:199], v[140:143], v[32:35]
  buffer_load_dwordx4 a[192:195], v115, s[24:27], s31 offen offset:0
  v_mfma_f32_16x16x32_bf16 v[36:39], v[196:199], v[148:151], v[36:39]
  buffer_load_dwordx4 a[212:215], v116, s[24:27], s31 offen offset:1024
  v_mfma_f32_16x16x32_bf16 v[36:39], v[176:179], v[144:147], v[36:39]
  s_add_u32 s30, s30, 8192
  v_mfma_f32_16x16x32_bf16 v[40:43], v[176:179], v[152:155], v[40:43]
  s_add_u32 s31, s31, 10240
  v_mfma_f32_16x16x32_bf16 v[40:43], v[196:199], v[156:159], v[40:43]
  v_mfma_f32_16x16x32_bf16 v[44:47], v[196:199], v[164:167], v[44:47]
  v_mfma_f32_16x16x32_bf16 v[44:47], v[176:179], v[160:163], v[44:47]
  v_mfma_f32_16x16x32_bf16 v[48:51], v[180:183], v[136:139], v[48:51]
  v_mfma_f32_16x16x32_bf16 v[48:51], v[200:203], v[140:143], v[48:51]
  v_mfma_f32_16x16x32_bf16 v[52:55], v[200:203], v[148:151], v[52:55]
  v_mfma_f32_16x16x32_bf16 v[52:55], v[180:183], v[144:147], v[52:55]
  v_mfma_f32_16x16x32_bf16 v[56:59], v[180:183], v[152:155], v[56:59]
  v_mfma_f32_16x16x32_bf16 v[56:59], v[200:203], v[156:159], v[56:59]
  v_mfma_f32_16x16x32_bf16 v[60:63], v[200:203], v[164:167], v[60:63]
  s_sub_u32 s32, s32, 1
  v_mfma_f32_16x16x32_bf16 v[60:63], v[180:183], v[160:163], v[60:63]
  s_cmp_lg_u32 s32, 0
  v_mfma_f32_16x16x32_bf16 v[64:67], v[184:187], v[136:139], v[64:67]
  v_mfma_f32_16x16x32_bf16 v[64:67], v[204:207], v[140:143], v[64:67]
  v_mfma_f32_16x16x32_bf16 v[68:71], v[204:207], v[148:151], v[68:71]
  v_mfma_f32_16x16x32_bf16 v[68:71], v[184:187], v[144:147], v[68:71]
  v_mfma_f32_16x16x32_bf16 v[72:75], v[184:187], v[152:155], v[72:75]
  v_mfma_f32_16x16x32_bf16 v[72:75], v[204:207], v[156:159], v[72:75]
  v_mfma_f32_16x16x32_bf16 v[76:79], v[204:207], v[164:167], v[76:79]
  v_mfma_f32_16x16x32_bf16 v[76:79], v[184:187], v[160:163], v[76:79]
  s_cbranch_scc1 out_loop
  s_waitcnt vmcnt(44)
  v_mfma_f32_16x16x32_bf16 v[0:3], a[32:35], a[0:3], v[0:3]
  buffer_load_dwordx4 v[136:139], v110, s[24:27], s30 offen offset:0
  v_mul_f32 v128, 0xbfb8aa3b, v90
  v_mul_f32 v129, 0xbfb8aa3b, v91
  v_mfma_f32_16x16x32_bf16 v[0:3], a[52:55], a[4:7], v[0:3]
  buffer_load_dwordx4 v[140:143], v110, s[24:27], s30 offen offset:1024
  v_mul_f32 v130, 0xbfb8aa3b, v92
  v_mul_f32 v131, 0xbfb8aa3b, v93
  v_mfma_f32_16x16x32_bf16 v[4:7], a[52:55], a[12:15], v[4:7]
  buffer_load_dwordx4 v[168:171], v114, s[24:27], s31 offen offset:0
  v_exp_f32 v128, v128
  v_mfma_f32_16x16x32_bf16 v[4:7], a[32:35], a[8:11], v[4:7]
  buffer_load_dwordx4 v[188:191], v115, s[24:27], s31 offen offset:1024
  v_exp_f32 v129, v129
  v_mfma_f32_16x16x32_bf16 v[8:11], a[32:35], a[16:19], v[8:11]
  buffer_load_dwordx4 v[144:147], v111, s[24:27], s30 offen offset:0
  v_exp_f32 v130, v130
  v_mfma_f32_16x16x32_bf16 v[8:11], a[52:55], a[20:23], v[8:11]
  buffer_load_dwordx4 v[148:151], v111, s[24:27], s30 offen offset:1024
  v_exp_f32 v131, v131
  v_mfma_f32_16x16x32_bf16 v[12:15], a[52:55], a[28:31], v[12:15]
  s_waitcnt vmcnt(42)
  v_add_f32 v128, 1.0, v128
  v_add_f32 v129, 1.0, v129
  v_mfma_f32_16x16x32_bf16 v[12:15], a[32:35], a[24:27], v[12:15]
  buffer_load_dwordx4 v[152:155], v112, s[24:27], s30 offen offset:0
  v_add_f32 v130, 1.0, v130
  v_add_f32 v131, 1.0, v131
  v_mfma_f32_16x16x32_bf16 v[16:19], a[36:39], a[0:3], v[16:19]
  buffer_load_dwordx4 v[156:159], v112, s[24:27], s30 offen offset:1024
  v_rcp_f32 v128, v128
  v_mfma_f32_16x16x32_bf16 v[16:19], a[56:59], a[4:7], v[16:19]
  buffer_load_dwordx4 v[160:163], v113, s[24:27], s30 offen offset:0
  v_rcp_f32 v129, v129
  v_mfma_f32_16x16x32_bf16 v[20:23], a[56:59], a[12:15], v[20:23]
  buffer_load_dwordx4 v[164:167], v113, s[24:27], s30 offen offset:1024
  v_rcp_f32 v130, v130
  v_mfma_f32_16x16x32_bf16 v[20:23], a[36:39], a[8:11], v[20:23]
  buffer_load_dwordx4 v[172:175], v114, s[24:27], s31 offen offset:1024
  v_rcp_f32 v131, v131
  v_mfma_f32_16x16x32_bf16 v[24:27], a[36:39], a[16:19], v[24:27]
  buffer_load_dwordx4 v[192:195], v115, s[24:27], s31 offen offset:2048
  v_mul_f32 v90, v90, v128
  v_mul_f32 v91, v91, v129
  v_mfma_f32_16x16x32_bf16 v[24:27], a[56:59], a[20:23], v[24:27]
  buffer_load_dwordx4 v[176:179], v114, s[24:27], s31 offen offset:2048
  v_mul_f32 v92, v92, v130
  v_mul_f32 v93, v93, v131
  v_mfma_f32_16x16x32_bf16 v[28:31], a[56:59], a[28:31], v[28:31]
  buffer_load_dwordx4 v[196:199], v115, s[24:27], s31 offen offset:3072
  v_cvt_pk_bf16_f32 v90, v90, v90
  v_cvt_pk_bf16_f32 v91, v91, v91
  v_mfma_f32_16x16x32_bf16 v[28:31], a[36:39], a[24:27], v[28:31]
  buffer_load_dwordx4 v[180:183], v114, s[24:27], s31 offen offset:3072
  v_cvt_pk_bf16_f32 v92, v92, v92
  v_cvt_pk_bf16_f32 v93, v93, v93
  v_mfma_f32_16x16x32_bf16 v[32:35], a[40:43], a[0:3], v[32:35]
  buffer_load_dwordx4 v[200:203], v116, s[24:27], s31 offen offset:0
  v_lshlrev_b32 v90, 16, v90
  v_lshlrev_b32 v91, 16, v91
  v_mfma_f32_16x16x32_bf16 v[32:35], a[60:63], a[4:7], v[32:35]
  buffer_load_dwordx4 v[184:187], v115, s[24:27], s31 offen offset:0
  v_lshlrev_b32 v92, 16, v92
  v_lshlrev_b32 v93, 16, v93
  v_mfma_f32_16x16x32_bf16 v[36:39], a[60:63], a[12:15], v[36:39]
  buffer_load_dwordx4 v[204:207], v116, s[24:27], s31 offen offset:1024
  v_mul_f32 v128, 0xbfb8aa3b, v94
  v_mul_f32 v129, 0xbfb8aa3b, v95
  v_mfma_f32_16x16x32_bf16 v[36:39], a[40:43], a[8:11], v[36:39]
  s_add_u32 s30, s30, 8192
  v_mul_f32 v130, 0xbfb8aa3b, v96
  v_mul_f32 v131, 0xbfb8aa3b, v97
  v_mfma_f32_16x16x32_bf16 v[40:43], a[40:43], a[16:19], v[40:43]
  s_add_u32 s31, s31, 10240
  v_exp_f32 v128, v128
  v_mfma_f32_16x16x32_bf16 v[40:43], a[60:63], a[20:23], v[40:43]
  v_exp_f32 v129, v129
  v_mfma_f32_16x16x32_bf16 v[44:47], a[60:63], a[28:31], v[44:47]
  v_exp_f32 v130, v130
  v_mfma_f32_16x16x32_bf16 v[44:47], a[40:43], a[24:27], v[44:47]
  v_exp_f32 v131, v131
  v_mfma_f32_16x16x32_bf16 v[48:51], a[44:47], a[0:3], v[48:51]
  v_add_f32 v128, 1.0, v128
  v_add_f32 v129, 1.0, v129
  v_mfma_f32_16x16x32_bf16 v[48:51], a[64:67], a[4:7], v[48:51]
  v_add_f32 v130, 1.0, v130
  v_add_f32 v131, 1.0, v131
  v_mfma_f32_16x16x32_bf16 v[52:55], a[64:67], a[12:15], v[52:55]
  v_rcp_f32 v128, v128
  v_mfma_f32_16x16x32_bf16 v[52:55], a[44:47], a[8:11], v[52:55]
  v_rcp_f32 v129, v129
  v_mfma_f32_16x16x32_bf16 v[56:59], a[44:47], a[16:19], v[56:59]
  v_rcp_f32 v130, v130
  v_mfma_f32_16x16x32_bf16 v[56:59], a[64:67], a[20:23], v[56:59]
  v_rcp_f32 v131, v131
  v_mfma_f32_16x16x32_bf16 v[60:63], a[64:67], a[28:31], v[60:63]
  v_mul_f32 v94, v94, v128
  v_mul_f32 v95, v95, v129
  v_mfma_f32_16x16x32_bf16 v[60:63], a[44:47], a[24:27], v[60:63]
  v_mul_f32 v96, v96, v130
  v_mul_f32 v97, v97, v131
  v_mfma_f32_16x16x32_bf16 v[64:67], a[48:51], a[0:3], v[64:67]
  v_cvt_pk_bf16_f32 v94, v94, v94
  v_cvt_pk_bf16_f32 v95, v95, v95
  v_mfma_f32_16x16x32_bf16 v[64:67], a[68:71], a[4:7], v[64:67]
  v_cvt_pk_bf16_f32 v96, v96, v96
  v_cvt_pk_bf16_f32 v97, v97, v97
  v_mfma_f32_16x16x32_bf16 v[68:71], a[68:71], a[12:15], v[68:71]
  v_lshlrev_b32 v94, 16, v94
  v_lshlrev_b32 v95, 16, v95
  v_mfma_f32_16x16x32_bf16 v[68:71], a[48:51], a[8:11], v[68:71]
  v_lshlrev_b32 v96, 16, v96
  v_lshlrev_b32 v97, 16, v97
  v_mfma_f32_16x16x32_bf16 v[72:75], a[48:51], a[16:19], v[72:75]
  v_mul_f32 v128, 0xbfb8aa3b, v98
  v_mul_f32 v129, 0xbfb8aa3b, v99
  v_mfma_f32_16x16x32_bf16 v[72:75], a[68:71], a[20:23], v[72:75]
  v_mul_f32 v130, 0xbfb8aa3b, v100
  v_mul_f32 v131, 0xbfb8aa3b, v101
  v_mfma_f32_16x16x32_bf16 v[76:79], a[68:71], a[28:31], v[76:79]
  v_exp_f32 v128, v128
  v_mfma_f32_16x16x32_bf16 v[76:79], a[48:51], a[24:27], v[76:79]
  v_exp_f32 v129, v129
  s_waitcnt vmcnt(44)
  v_mfma_f32_16x16x32_bf16 v[0:3], a[104:107], a[72:75], v[0:3]
  v_exp_f32 v130, v130
  v_mfma_f32_16x16x32_bf16 v[0:3], a[124:127], a[76:79], v[0:3]
  v_exp_f32 v131, v131
  v_mfma_f32_16x16x32_bf16 v[4:7], a[124:127], a[84:87], v[4:7]
  v_add_f32 v128, 1.0, v128
  v_add_f32 v129, 1.0, v129
  v_mfma_f32_16x16x32_bf16 v[4:7], a[104:107], a[80:83], v[4:7]
  v_add_f32 v130, 1.0, v130
  v_add_f32 v131, 1.0, v131
  v_mfma_f32_16x16x32_bf16 v[8:11], a[104:107], a[88:91], v[8:11]
  v_rcp_f32 v128, v128
  v_mfma_f32_16x16x32_bf16 v[8:11], a[124:127], a[92:95], v[8:11]
  v_rcp_f32 v129, v129
  v_mfma_f32_16x16x32_bf16 v[12:15], a[124:127], a[100:103], v[12:15]
  s_waitcnt vmcnt(36)
  v_rcp_f32 v130, v130
  v_mfma_f32_16x16x32_bf16 v[12:15], a[104:107], a[96:99], v[12:15]
  v_rcp_f32 v131, v131
  v_mfma_f32_16x16x32_bf16 v[16:19], a[108:111], a[72:75], v[16:19]
  v_mul_f32 v98, v98, v128
  v_mul_f32 v99, v99, v129
  v_mfma_f32_16x16x32_bf16 v[16:19], a[128:131], a[76:79], v[16:19]
  v_mul_f32 v100, v100, v130
  v_mul_f32 v101, v101, v131
  v_mfma_f32_16x16x32_bf16 v[20:23], a[128:131], a[84:87], v[20:23]
  v_cvt_pk_bf16_f32 v98, v98, v98
  v_cvt_pk_bf16_f32 v99, v99, v99
  v_mfma_f32_16x16x32_bf16 v[20:23], a[108:111], a[80:83], v[20:23]
  v_cvt_pk_bf16_f32 v100, v100, v100
  v_cvt_pk_bf16_f32 v101, v101, v101
  v_mfma_f32_16x16x32_bf16 v[24:27], a[108:111], a[88:91], v[24:27]
  v_lshlrev_b32 v98, 16, v98
  v_lshlrev_b32 v99, 16, v99
  v_mfma_f32_16x16x32_bf16 v[24:27], a[128:131], a[92:95], v[24:27]
  v_lshlrev_b32 v100, 16, v100
  v_lshlrev_b32 v101, 16, v101
  v_mfma_f32_16x16x32_bf16 v[28:31], a[128:131], a[100:103], v[28:31]
  v_mul_f32 v128, 0xbfb8aa3b, v102
  v_mul_f32 v129, 0xbfb8aa3b, v103
  v_mfma_f32_16x16x32_bf16 v[28:31], a[108:111], a[96:99], v[28:31]
  v_mul_f32 v130, 0xbfb8aa3b, v104
  v_mul_f32 v131, 0xbfb8aa3b, v105
  v_mfma_f32_16x16x32_bf16 v[32:35], a[112:115], a[72:75], v[32:35]
  v_exp_f32 v128, v128
  v_mfma_f32_16x16x32_bf16 v[32:35], a[132:135], a[76:79], v[32:35]
  v_exp_f32 v129, v129
  v_mfma_f32_16x16x32_bf16 v[36:39], a[132:135], a[84:87], v[36:39]
  v_exp_f32 v130, v130
  v_mfma_f32_16x16x32_bf16 v[36:39], a[112:115], a[80:83], v[36:39]
  v_exp_f32 v131, v131
  v_mfma_f32_16x16x32_bf16 v[40:43], a[112:115], a[88:91], v[40:43]
  v_add_f32 v128, 1.0, v128
  v_add_f32 v129, 1.0, v129
  v_mfma_f32_16x16x32_bf16 v[40:43], a[132:135], a[92:95], v[40:43]
  v_add_f32 v130, 1.0, v130
  v_add_f32 v131, 1.0, v131
  v_mfma_f32_16x16x32_bf16 v[44:47], a[132:135], a[100:103], v[44:47]
  v_rcp_f32 v128, v128
  v_mfma_f32_16x16x32_bf16 v[44:47], a[112:115], a[96:99], v[44:47]
  v_rcp_f32 v129, v129
  v_mfma_f32_16x16x32_bf16 v[48:51], a[116:119], a[72:75], v[48:51]
  v_rcp_f32 v130, v130
  v_mfma_f32_16x16x32_bf16 v[48:51], a[136:139], a[76:79], v[48:51]
  v_rcp_f32 v131, v131
  v_mfma_f32_16x16x32_bf16 v[52:55], a[136:139], a[84:87], v[52:55]
  v_mul_f32 v102, v102, v128
  v_mul_f32 v103, v103, v129
  v_mfma_f32_16x16x32_bf16 v[52:55], a[116:119], a[80:83], v[52:55]
  v_mul_f32 v104, v104, v130
  v_mul_f32 v105, v105, v131
  v_mfma_f32_16x16x32_bf16 v[56:59], a[116:119], a[88:91], v[56:59]
  v_cvt_pk_bf16_f32 v102, v102, v102
  v_cvt_pk_bf16_f32 v103, v103, v103
  v_mfma_f32_16x16x32_bf16 v[56:59], a[136:139], a[92:95], v[56:59]
  v_cvt_pk_bf16_f32 v104, v104, v104
  v_cvt_pk_bf16_f32 v105, v105, v105
  v_mfma_f32_16x16x32_bf16 v[60:63], a[136:139], a[100:103], v[60:63]
  v_lshlrev_b32 v102, 16, v102
  v_lshlrev_b32 v103, 16, v103
  v_mfma_f32_16x16x32_bf16 v[60:63], a[116:119], a[96:99], v[60:63]
  v_lshlrev_b32 v104, 16, v104
  v_lshlrev_b32 v105, 16, v105
  v_mfma_f32_16x16x32_bf16 v[64:67], a[120:123], a[72:75], v[64:67]
  v_mul_f32 v128, 0xbfb8aa3b, v106
  v_mul_f32 v129, 0xbfb8aa3b, v107
  v_mfma_f32_16x16x32_bf16 v[64:67], a[140:143], a[76:79], v[64:67]
  v_mul_f32 v130, 0xbfb8aa3b, v108
  v_mul_f32 v131, 0xbfb8aa3b, v109
  v_mfma_f32_16x16x32_bf16 v[68:71], a[140:143], a[84:87], v[68:71]
  v_exp_f32 v128, v128
  v_mfma_f32_16x16x32_bf16 v[68:71], a[120:123], a[80:83], v[68:71]
  v_exp_f32 v129, v129
  v_mfma_f32_16x16x32_bf16 v[72:75], a[120:123], a[88:91], v[72:75]
  v_exp_f32 v130, v130
  v_mfma_f32_16x16x32_bf16 v[72:75], a[140:143], a[92:95], v[72:75]
  v_exp_f32 v131, v131
  v_mfma_f32_16x16x32_bf16 v[76:79], a[140:143], a[100:103], v[76:79]
  v_add_f32 v128, 1.0, v128
  v_add_f32 v129, 1.0, v129
  v_mfma_f32_16x16x32_bf16 v[76:79], a[120:123], a[96:99], v[76:79]
  v_add_f32 v130, 1.0, v130
  v_add_f32 v131, 1.0, v131
  s_waitcnt vmcnt(26)
  v_mfma_f32_16x16x32_bf16 v[0:3], a[176:179], a[144:147], v[0:3]
  v_rcp_f32 v128, v128
  v_mfma_f32_16x16x32_bf16 v[0:3], a[196:199], a[148:151], v[0:3]
  v_rcp_f32 v129, v129
  v_mfma_f32_16x16x32_bf16 v[4:7], a[196:199], a[156:159], v[4:7]
  v_rcp_f32 v130, v130
  v_mfma_f32_16x16x32_bf16 v[4:7], a[176:179], a[152:155], v[4:7]
  v_rcp_f32 v131, v131
  v_mfma_f32_16x16x32_bf16 v[8:11], a[176:179], a[160:163], v[8:11]
  v_mul_f32 v106, v106, v128
  v_mul_f32 v107, v107, v129
  v_mfma_f32_16x16x32_bf16 v[8:11], a[196:199], a[164:167], v[8:11]
  v_mul_f32 v108, v108, v130
  v_mul_f32 v109, v109, v131
  v_mfma_f32_16x16x32_bf16 v[12:15], a[196:199], a[172:175], v[12:15]
  s_waitcnt vmcnt(18)
  v_cvt_pk_bf16_f32 v106, v106, v106
  v_cvt_pk_bf16_f32 v107, v107, v107
  v_mfma_f32_16x16x32_bf16 v[12:15], a[176:179], a[168:171], v[12:15]
  v_cvt_pk_bf16_f32 v108, v108, v108
  v_cvt_pk_bf16_f32 v109, v109, v109
  v_mfma_f32_16x16x32_bf16 v[16:19], a[180:183], a[144:147], v[16:19]
  v_lshlrev_b32 v106, 16, v106
  v_lshlrev_b32 v107, 16, v107
  v_mfma_f32_16x16x32_bf16 v[16:19], a[200:203], a[148:151], v[16:19]
  v_lshlrev_b32 v108, 16, v108
  v_lshlrev_b32 v109, 16, v109
  v_mfma_f32_16x16x32_bf16 v[20:23], a[200:203], a[156:159], v[20:23]
  v_mfma_f32_16x16x32_bf16 v[20:23], a[180:183], a[152:155], v[20:23]
  v_mfma_f32_16x16x32_bf16 v[24:27], a[180:183], a[160:163], v[24:27]
  v_mfma_f32_16x16x32_bf16 v[24:27], a[200:203], a[164:167], v[24:27]
  v_mfma_f32_16x16x32_bf16 v[28:31], a[200:203], a[172:175], v[28:31]
  v_mfma_f32_16x16x32_bf16 v[28:31], a[180:183], a[168:171], v[28:31]
  v_mfma_f32_16x16x32_bf16 v[32:35], a[184:187], a[144:147], v[32:35]
  v_mfma_f32_16x16x32_bf16 v[32:35], a[204:207], a[148:151], v[32:35]
  v_mfma_f32_16x16x32_bf16 v[36:39], a[204:207], a[156:159], v[36:39]
  v_mfma_f32_16x16x32_bf16 v[36:39], a[184:187], a[152:155], v[36:39]
  v_mfma_f32_16x16x32_bf16 v[40:43], a[184:187], a[160:163], v[40:43]
  v_mfma_f32_16x16x32_bf16 v[40:43], a[204:207], a[164:167], v[40:43]
  v_mfma_f32_16x16x32_bf16 v[44:47], a[204:207], a[172:175], v[44:47]
  v_mfma_f32_16x16x32_bf16 v[44:47], a[184:187], a[168:171], v[44:47]
  v_mfma_f32_16x16x32_bf16 v[48:51], a[188:191], a[144:147], v[48:51]
  v_mfma_f32_16x16x32_bf16 v[48:51], a[208:211], a[148:151], v[48:51]
  v_mfma_f32_16x16x32_bf16 v[52:55], a[208:211], a[156:159], v[52:55]
  v_mfma_f32_16x16x32_bf16 v[52:55], a[188:191], a[152:155], v[52:55]
  v_mfma_f32_16x16x32_bf16 v[56:59], a[188:191], a[160:163], v[56:59]
  v_mfma_f32_16x16x32_bf16 v[56:59], a[208:211], a[164:167], v[56:59]
  v_mfma_f32_16x16x32_bf16 v[60:63], a[208:211], a[172:175], v[60:63]
  v_mfma_f32_16x16x32_bf16 v[60:63], a[188:191], a[168:171], v[60:63]
  v_mfma_f32_16x16x32_bf16 v[64:67], a[192:195], a[144:147], v[64:67]
  v_mfma_f32_16x16x32_bf16 v[64:67], a[212:215], a[148:151], v[64:67]
  v_mfma_f32_16x16x32_bf16 v[68:71], a[212:215], a[156:159], v[68:71]
  v_mfma_f32_16x16x32_bf16 v[68:71], a[192:195], a[152:155], v[68:71]
  v_mfma_f32_16x16x32_bf16 v[72:75], a[192:195], a[160:163], v[72:75]
  v_mfma_f32_16x16x32_bf16 v[72:75], a[212:215], a[164:167], v[72:75]
  v_mfma_f32_16x16x32_bf16 v[76:79], a[212:215], a[172:175], v[76:79]
  v_mfma_f32_16x16x32_bf16 v[76:79], a[192:195], a[168:171], v[76:79]
  s_waitcnt vmcnt(8)
  v_mfma_f32_16x16x32_bf16 v[0:3], v[168:171], v[136:139], v[0:3]
  v_mfma_f32_16x16x32_bf16 v[0:3], v[188:191], v[140:143], v[0:3]
  v_mfma_f32_16x16x32_bf16 v[4:7], v[188:191], v[148:151], v[4:7]
  v_mfma_f32_16x16x32_bf16 v[4:7], v[168:171], v[144:147], v[4:7]
  v_mfma_f32_16x16x32_bf16 v[8:11], v[168:171], v[152:155], v[8:11]
  v_mfma_f32_16x16x32_bf16 v[8:11], v[188:191], v[156:159], v[8:11]
  v_mfma_f32_16x16x32_bf16 v[12:15], v[188:191], v[164:167], v[12:15]
  s_waitcnt vmcnt(0)
  v_mfma_f32_16x16x32_bf16 v[12:15], v[168:171], v[160:163], v[12:15]
  v_mfma_f32_16x16x32_bf16 v[16:19], v[172:175], v[136:139], v[16:19]
  v_mfma_f32_16x16x32_bf16 v[16:19], v[192:195], v[140:143], v[16:19]
  v_mfma_f32_16x16x32_bf16 v[20:23], v[192:195], v[148:151], v[20:23]
  v_mfma_f32_16x16x32_bf16 v[20:23], v[172:175], v[144:147], v[20:23]
  v_mfma_f32_16x16x32_bf16 v[24:27], v[172:175], v[152:155], v[24:27]
  v_mfma_f32_16x16x32_bf16 v[24:27], v[192:195], v[156:159], v[24:27]
  v_mfma_f32_16x16x32_bf16 v[28:31], v[192:195], v[164:167], v[28:31]
  v_mfma_f32_16x16x32_bf16 v[28:31], v[172:175], v[160:163], v[28:31]
  v_mfma_f32_16x16x32_bf16 v[32:35], v[176:179], v[136:139], v[32:35]
  v_mfma_f32_16x16x32_bf16 v[32:35], v[196:199], v[140:143], v[32:35]
  v_mfma_f32_16x16x32_bf16 v[36:39], v[196:199], v[148:151], v[36:39]
  v_mfma_f32_16x16x32_bf16 v[36:39], v[176:179], v[144:147], v[36:39]
  v_mfma_f32_16x16x32_bf16 v[40:43], v[176:179], v[152:155], v[40:43]
  v_mfma_f32_16x16x32_bf16 v[40:43], v[196:199], v[156:159], v[40:43]
  v_mfma_f32_16x16x32_bf16 v[44:47], v[196:199], v[164:167], v[44:47]
  v_mfma_f32_16x16x32_bf16 v[44:47], v[176:179], v[160:163], v[44:47]
  v_mfma_f32_16x16x32_bf16 v[48:51], v[180:183], v[136:139], v[48:51]
  v_mfma_f32_16x16x32_bf16 v[48:51], v[200:203], v[140:143], v[48:51]
  v_mfma_f32_16x16x32_bf16 v[52:55], v[200:203], v[148:151], v[52:55]
  v_mfma_f32_16x16x32_bf16 v[52:55], v[180:183], v[144:147], v[52:55]
  v_mfma_f32_16x16x32_bf16 v[56:59], v[180:183], v[152:155], v[56:59]
  v_mfma_f32_16x16x32_bf16 v[56:59], v[200:203], v[156:159], v[56:59]
  v_mfma_f32_16x16x32_bf16 v[60:63], v[200:203], v[164:167], v[60:63]
  v_mfma_f32_16x16x32_bf16 v[60:63], v[180:183], v[160:163], v[60:63]
  v_mfma_f32_16x16x32_bf16 v[64:67], v[184:187], v[136:139], v[64:67]
  v_mfma_f32_16x16x32_bf16 v[64:67], v[204:207], v[140:143], v[64:67]
  v_mfma_f32_16x16x32_bf16 v[68:71], v[204:207], v[148:151], v[68:71]
  v_mfma_f32_16x16x32_bf16 v[68:71], v[184:187], v[144:147], v[68:71]
  v_mfma_f32_16x16x32_bf16 v[72:75], v[184:187], v[152:155], v[72:75]
  v_mfma_f32_16x16x32_bf16 v[72:75], v[204:207], v[156:159], v[72:75]
  v_mfma_f32_16x16x32_bf16 v[76:79], v[204:207], v[164:167], v[76:79]
  v_mfma_f32_16x16x32_bf16 v[76:79], v[184:187], v[160:163], v[76:79]
  ds_write_b128 v118, v[4:7] offset:0
  ds_write_b128 v118, v[20:23] offset:1024
  ds_write_b128 v118, v[36:39] offset:2048
  ds_write_b128 v118, v[52:55] offset:3072
  ds_write_b128 v118, v[68:71] offset:4096
  ds_write_b128 v119, v[8:11] offset:0
  ds_write_b128 v119, v[24:27] offset:1024
  ds_write_b128 v119, v[40:43] offset:2048
  ds_write_b128 v119, v[56:59] offset:3072
  ds_write_b128 v119, v[72:75] offset:4096
  ds_write_b128 v120, v[12:15] offset:0
  ds_write_b128 v120, v[28:31] offset:1024
  ds_write_b128 v120, v[44:47] offset:2048
  ds_write_b128 v120, v[60:63] offset:3072
  ds_write_b128 v120, v[76:79] offset:4096
  s_waitcnt lgkmcnt(0)
  s_barrier
  ds_read_b128 v[136:139], v121 offset:0
  ds_read_b128 v[140:143], v121 offset:5120
  ds_read_b128 v[144:147], v121 offset:10240
  ds_read_b128 v[148:151], v121 offset:1024
  ds_read_b128 v[152:155], v121 offset:6144
  ds_read_b128 v[156:159], v121 offset:11264
  ds_read_b128 v[160:163], v121 offset:2048
  ds_read_b128 v[164:167], v121 offset:7168
  ds_read_b128 v[168:171], v121 offset:12288
  ds_read_b128 v[172:175], v121 offset:3072
  ds_read_b128 v[176:179], v121 offset:8192
  ds_read_b128 v[180:183], v121 offset:13312
  ds_read_b128 v[184:187], v121 offset:4096
  ds_read_b128 v[188:191], v121 offset:9216
  ds_read_b128 v[192:195], v121 offset:14336
  s_waitcnt lgkmcnt(13)
  v_add_f32 v136, v136, v140
  s_waitcnt lgkmcnt(12)
  v_add_f32 v0, v0, v144
  v_add_f32 v137, v137, v141
  v_add_f32 v1, v1, v145
  v_add_f32 v138, v138, v142
  v_add_f32 v2, v2, v146
  v_add_f32 v139, v139, v143
  v_add_f32 v3, v3, v147
  v_add_f32 v0, v0, v136
  v_add_f32 v1, v1, v137
  v_add_f32 v2, v2, v138
  v_add_f32 v3, v3, v139
  v_cvt_pk_bf16_f32 v136, v0, v1
  v_cvt_pk_bf16_f32 v137, v2, v3
  v_lshlrev_b32 v0, 16, v136
  v_and_b32 v1, s33, v136
  v_lshlrev_b32 v2, 16, v137
  v_and_b32 v3, s33, v137
  v_mul_f32 v0, v0, v90
  v_mul_f32 v1, v1, v91
  v_mul_f32 v2, v2, v92
  v_mul_f32 v3, v3, v93
  v_cvt_pk_bf16_f32 v136, v0, v1
  v_cvt_pk_bf16_f32 v137, v2, v3
  v_lshlrev_b32 v0, 16, v136
  v_and_b32 v1, s33, v136
  v_lshlrev_b32 v140, 16, v80
  v_and_b32 v141, s33, v80
  v_lshlrev_b32 v2, 16, v137
  v_and_b32 v3, s33, v137
  v_lshlrev_b32 v142, 16, v81
  v_and_b32 v143, s33, v81
  v_add_f32 v0, v0, v140
  v_add_f32 v1, v1, v141
  v_add_f32 v2, v2, v142
  v_add_f32 v3, v3, v143
  v_cvt_pk_bf16_f32 v136, v0, v1
  v_cvt_pk_bf16_f32 v137, v2, v3
  buffer_store_dwordx2 v[136:137], v117, s[16:19], 0 offen offset:0
  s_waitcnt lgkmcnt(10)
  v_add_f32 v148, v148, v152
  s_waitcnt lgkmcnt(9)
  v_add_f32 v16, v16, v156
  v_add_f32 v149, v149, v153
  v_add_f32 v17, v17, v157
  v_add_f32 v150, v150, v154
  v_add_f32 v18, v18, v158
  v_add_f32 v151, v151, v155
  v_add_f32 v19, v19, v159
  v_add_f32 v16, v16, v148
  v_add_f32 v17, v17, v149
  v_add_f32 v18, v18, v150
  v_add_f32 v19, v19, v151
  v_cvt_pk_bf16_f32 v148, v16, v17
  v_cvt_pk_bf16_f32 v149, v18, v19
  v_lshlrev_b32 v16, 16, v148
  v_and_b32 v17, s33, v148
  v_lshlrev_b32 v18, 16, v149
  v_and_b32 v19, s33, v149
  v_mul_f32 v16, v16, v94
  v_mul_f32 v17, v17, v95
  v_mul_f32 v18, v18, v96
  v_mul_f32 v19, v19, v97
  v_cvt_pk_bf16_f32 v148, v16, v17
  v_cvt_pk_bf16_f32 v149, v18, v19
  v_lshlrev_b32 v16, 16, v148
  v_and_b32 v17, s33, v148
  v_lshlrev_b32 v152, 16, v82
  v_and_b32 v153, s33, v82
  v_lshlrev_b32 v18, 16, v149
  v_and_b32 v19, s33, v149
  v_lshlrev_b32 v154, 16, v83
  v_and_b32 v155, s33, v83
  v_add_f32 v16, v16, v152
  v_add_f32 v17, v17, v153
  v_add_f32 v18, v18, v154
  v_add_f32 v19, v19, v155
  v_cvt_pk_bf16_f32 v148, v16, v17
  v_cvt_pk_bf16_f32 v149, v18, v19
  buffer_store_dwordx2 v[148:149], v117, s[16:19], 0 offen offset:32
  s_waitcnt lgkmcnt(7)
  v_add_f32 v160, v160, v164
  s_waitcnt lgkmcnt(6)
  v_add_f32 v32, v32, v168
  v_add_f32 v161, v161, v165
  v_add_f32 v33, v33, v169
  v_add_f32 v162, v162, v166
  v_add_f32 v34, v34, v170
  v_add_f32 v163, v163, v167
  v_add_f32 v35, v35, v171
  v_add_f32 v32, v32, v160
  v_add_f32 v33, v33, v161
  v_add_f32 v34, v34, v162
  v_add_f32 v35, v35, v163
  v_cvt_pk_bf16_f32 v160, v32, v33
  v_cvt_pk_bf16_f32 v161, v34, v35
  v_lshlrev_b32 v32, 16, v160
  v_and_b32 v33, s33, v160
  v_lshlrev_b32 v34, 16, v161
  v_and_b32 v35, s33, v161
  v_mul_f32 v32, v32, v98
  v_mul_f32 v33, v33, v99
  v_mul_f32 v34, v34, v100
  v_mul_f32 v35, v35, v101
  v_cvt_pk_bf16_f32 v160, v32, v33
  v_cvt_pk_bf16_f32 v161, v34, v35
  v_lshlrev_b32 v32, 16, v160
  v_and_b32 v33, s33, v160
  v_lshlrev_b32 v164, 16, v84
  v_and_b32 v165, s33, v84
  v_lshlrev_b32 v34, 16, v161
  v_and_b32 v35, s33, v161
  v_lshlrev_b32 v166, 16, v85
  v_and_b32 v167, s33, v85
  v_add_f32 v32, v32, v164
  v_add_f32 v33, v33, v165
  v_add_f32 v34, v34, v166
  v_add_f32 v35, v35, v167
  v_cvt_pk_bf16_f32 v160, v32, v33
  v_cvt_pk_bf16_f32 v161, v34, v35
  buffer_store_dwordx2 v[160:161], v117, s[16:19], 0 offen offset:64
  s_waitcnt lgkmcnt(4)
  v_add_f32 v172, v172, v176
  s_waitcnt lgkmcnt(3)
  v_add_f32 v48, v48, v180
  v_add_f32 v173, v173, v177
  v_add_f32 v49, v49, v181
  v_add_f32 v174, v174, v178
  v_add_f32 v50, v50, v182
  v_add_f32 v175, v175, v179
  v_add_f32 v51, v51, v183
  v_add_f32 v48, v48, v172
  v_add_f32 v49, v49, v173
  v_add_f32 v50, v50, v174
  v_add_f32 v51, v51, v175
  v_cvt_pk_bf16_f32 v172, v48, v49
  v_cvt_pk_bf16_f32 v173, v50, v51
  v_lshlrev_b32 v48, 16, v172
  v_and_b32 v49, s33, v172
  v_lshlrev_b32 v50, 16, v173
  v_and_b32 v51, s33, v173
  v_mul_f32 v48, v48, v102
  v_mul_f32 v49, v49, v103
  v_mul_f32 v50, v50, v104
  v_mul_f32 v51, v51, v105
  v_cvt_pk_bf16_f32 v172, v48, v49
  v_cvt_pk_bf16_f32 v173, v50, v51
  v_lshlrev_b32 v48, 16, v172
  v_and_b32 v49, s33, v172
  v_lshlrev_b32 v176, 16, v86
  v_and_b32 v177, s33, v86
  v_lshlrev_b32 v50, 16, v173
  v_and_b32 v51, s33, v173
  v_lshlrev_b32 v178, 16, v87
  v_and_b32 v179, s33, v87
  v_add_f32 v48, v48, v176
  v_add_f32 v49, v49, v177
  v_add_f32 v50, v50, v178
  v_add_f32 v51, v51, v179
  v_cvt_pk_bf16_f32 v172, v48, v49
  v_cvt_pk_bf16_f32 v173, v50, v51
  buffer_store_dwordx2 v[172:173], v117, s[16:19], 0 offen offset:96
  s_waitcnt lgkmcnt(1)
  v_add_f32 v184, v184, v188
  s_waitcnt lgkmcnt(0)
  v_add_f32 v64, v64, v192
  v_add_f32 v185, v185, v189
  v_add_f32 v65, v65, v193
  v_add_f32 v186, v186, v190
  v_add_f32 v66, v66, v194
  v_add_f32 v187, v187, v191
  v_add_f32 v67, v67, v195
  v_add_f32 v64, v64, v184
  v_add_f32 v65, v65, v185
  v_add_f32 v66, v66, v186
  v_add_f32 v67, v67, v187
  v_cvt_pk_bf16_f32 v184, v64, v65
  v_cvt_pk_bf16_f32 v185, v66, v67
  v_lshlrev_b32 v64, 16, v184
  v_and_b32 v65, s33, v184
  v_lshlrev_b32 v66, 16, v185
  v_and_b32 v67, s33, v185
  v_mul_f32 v64, v64, v106
  v_mul_f32 v65, v65, v107
  v_mul_f32 v66, v66, v108
  v_mul_f32 v67, v67, v109
  v_cvt_pk_bf16_f32 v184, v64, v65
  v_cvt_pk_bf16_f32 v185, v66, v67
  v_lshlrev_b32 v64, 16, v184
  v_and_b32 v65, s33, v184
  v_lshlrev_b32 v188, 16, v88
  v_and_b32 v189, s33, v88
  v_lshlrev_b32 v66, 16, v185
  v_and_b32 v67, s33, v185
  v_lshlrev_b32 v190, 16, v89
  v_and_b32 v191, s33, v89
  v_add_f32 v64, v64, v188
  v_add_f32 v65, v65, v189
  v_add_f32 v66, v66, v190
  v_add_f32 v67, v67, v191
  v_cvt_pk_bf16_f32 v184, v64, v65
  v_cvt_pk_bf16_f32 v185, v66, v67
  buffer_store_dwordx2 v[184:185], v117, s[16:19], 0 offen offset:128
out_end:
  s_endpgm
.section .rodata,"a"
.p2align 6
.amdhsa_kernel prep_kernel
  .amdhsa_next_free_vgpr 104
  .amdhsa_next_free_sgpr 48
  .amdhsa_accum_offset 104
  .amdhsa_group_segment_fixed_size 0
  .amdhsa_kernarg_size 104
  .amdhsa_user_sgpr_count 2
  .amdhsa_user_sgpr_kernarg_segment_ptr 1
  .amdhsa_system_sgpr_workgroup_id_x 1
.end_amdhsa_kernel
.p2align 6
.amdhsa_kernel ffn1_kernel
  .amdhsa_next_free_vgpr 64
  .amdhsa_next_free_sgpr 64
  .amdhsa_accum_offset 64
  .amdhsa_group_segment_fixed_size 0
  .amdhsa_kernarg_size 104
  .amdhsa_user_sgpr_count 2
  .amdhsa_user_sgpr_kernarg_segment_ptr 1
  .amdhsa_system_sgpr_workgroup_id_x 1
.end_amdhsa_kernel
.p2align 6
.amdhsa_kernel ffn2_kernel
  .amdhsa_next_free_vgpr 64
  .amdhsa_next_free_sgpr 64
  .amdhsa_accum_offset 64
  .amdhsa_group_segment_fixed_size 0
  .amdhsa_kernarg_size 104
  .amdhsa_user_sgpr_count 2
  .amdhsa_user_sgpr_kernarg_segment_ptr 1
  .amdhsa_system_sgpr_workgroup_id_x 1
.end_amdhsa_kernel
.p2align 6
.amdhsa_kernel attn_kernel
  .amdhsa_next_free_vgpr 512
  .amdhsa_next_free_sgpr 64
  .amdhsa_accum_offset 256
  .amdhsa_group_segment_fixed_size 0
  .amdhsa_kernarg_size 104
  .amdhsa_user_sgpr_count 2
  .amdhsa_user_sgpr_kernarg_segment_ptr 1
  .amdhsa_system_sgpr_workgroup_id_x 1
.end_amdhsa_kernel
.p2align 6
.amdhsa_kernel out_kernel
  .amdhsa_next_free_vgpr 512
  .amdhsa_next_free_sgpr 64
  .amdhsa_accum_offset 256
  .amdhsa_group_segment_fixed_size 0
  .amdhsa_kernarg_size 104
  .amdhsa_user_sgpr_count 2
  .amdhsa_user_sgpr_kernarg_segment_ptr 1
  .amdhsa_system_sgpr_workgroup_id_x 1
.end_amdhsa_kernel
```

```asm
; @launch kernel=prep_kernel grid=(256,1,1) block=(128,1,1) lds=0
; @launch kernel=attn_kernel grid=(256,1,1) block=(256,1,1) lds=161792
; @launch kernel=out_kernel grid=(256,1,1) block=(256,1,1) lds=61440
.amdgcn_target "amdgcn-amd-amdhsa--gfx950"
.text
.globl prep_kernel
.p2align 8
.type prep_kernel,@function
prep_kernel:
  s_cmp_ge_u32 s2, 256
  s_cbranch_scc1 prep_end
  s_load_dwordx2 s[4:5], s[0:1], 0
  s_load_dwordx2 s[8:9], s[0:1], 48
  s_load_dwordx2 s[10:11], s[0:1], 96
  s_getpc_b64 s[6:7]
prep_hot_pc:
  s_add_u32 s6, s6, prep_hot-prep_hot_pc
  s_addc_u32 s7, s7, 0
  v_lshlrev_b32 v1, 7, v0
  v_min_u32 v1, prep_end-prep_hot-4, v1
  global_load_dword v106, v1, s[6:7]
prep_hot:
  v_lshrrev_b32 v1, 6, v0
  v_and_b32 v0, 63, v0
  v_readfirstlane_b32 s3, v1
  s_waitcnt lgkmcnt(0)
  s_mov_b32 s12, s4
  s_mov_b32 s13, s5
  s_mov_b32 s14, 2621440
  s_mov_b32 s15, 0x20000
  s_mov_b32 s20, s8
  s_mov_b32 s21, s9
  s_mov_b32 s22, 1280
  s_mov_b32 s23, 0x20000
  s_mov_b32 s24, s10
  s_mov_b32 s25, s11
  s_mov_b32 s26, 8388608
  s_mov_b32 s27, 0x20000
  s_lshl_b32 s28, s2, 3
  s_lshl_b32 s29, s3, 2
  s_add_u32 s28, s28, s29
  s_mul_i32 s29, s28, 1280
  v_lshrrev_b32 v1, 4, v0
  v_and_b32 v2, 15, v0
  v_lshlrev_b32 v3, 4, v2
  v_mul_u32_u24 v4, 0x500, v1
  v_add_u32 v4, v4, v3
  buffer_load_dwordx4 v[8:11], v4, s[12:15], s29 offen offset:0
  buffer_load_dwordx4 v[12:15], v4, s[12:15], s29 offen offset:256
  buffer_load_dwordx4 v[16:19], v4, s[12:15], s29 offen offset:512
  buffer_load_dwordx4 v[20:23], v4, s[12:15], s29 offen offset:768
  buffer_load_dwordx4 v[24:27], v4, s[12:15], s29 offen offset:1024
  buffer_load_dwordx4 v[28:31], v3, s[20:23], 0 offen offset:0
  buffer_load_dwordx4 v[32:35], v3, s[20:23], 0 offen offset:256
  buffer_load_dwordx4 v[36:39], v3, s[20:23], 0 offen offset:512
  buffer_load_dwordx4 v[40:43], v3, s[20:23], 0 offen offset:768
  buffer_load_dwordx4 v[44:47], v3, s[20:23], 0 offen offset:1024
  s_lshr_b32 s30, s28, 6
  s_mul_i32 s30, s30, 81920
  s_bfe_u32 s31, s28, 0x20004
  s_lshl_b32 s31, s31, 10
  s_add_u32 s30, s30, s31
  s_and_b32 s31, s28, 15
  s_lshl_b32 s31, s31, 4
  s_add_u32 s30, s30, s31
  v_lshrrev_b32 v5, 2, v2
  v_lshlrev_b32 v5, 12, v5
  v_and_b32 v6, 3, v2
  v_lshl_add_u32 v5, v6, 8, v5
  v_lshl_add_u32 v5, v1, 4, v5
  s_mov_b32 s33, 0xffff0000
  s_waitcnt vmcnt(9)
  v_lshlrev_b32 v48, 16, v8
  v_and_b32 v49, s33, v8
  v_lshlrev_b32 v50, 16, v9
  v_and_b32 v51, s33, v9
  v_lshlrev_b32 v52, 16, v10
  v_and_b32 v53, s33, v10
  v_lshlrev_b32 v54, 16, v11
  v_and_b32 v55, s33, v11
  s_waitcnt vmcnt(8)
  v_lshlrev_b32 v56, 16, v12
  v_and_b32 v57, s33, v12
  v_lshlrev_b32 v58, 16, v13
  v_and_b32 v59, s33, v13
  v_lshlrev_b32 v60, 16, v14
  v_and_b32 v61, s33, v14
  v_lshlrev_b32 v62, 16, v15
  v_and_b32 v63, s33, v15
  s_waitcnt vmcnt(7)
  v_lshlrev_b32 v64, 16, v16
  v_and_b32 v65, s33, v16
  v_lshlrev_b32 v66, 16, v17
  v_and_b32 v67, s33, v17
  v_lshlrev_b32 v68, 16, v18
  v_and_b32 v69, s33, v18
  v_lshlrev_b32 v70, 16, v19
  v_and_b32 v71, s33, v19
  s_waitcnt vmcnt(6)
  v_lshlrev_b32 v72, 16, v20
  v_and_b32 v73, s33, v20
  v_lshlrev_b32 v74, 16, v21
  v_and_b32 v75, s33, v21
  v_lshlrev_b32 v76, 16, v22
  v_and_b32 v77, s33, v22
  v_lshlrev_b32 v78, 16, v23
  v_and_b32 v79, s33, v23
  s_waitcnt vmcnt(5)
  v_lshlrev_b32 v80, 16, v24
  v_and_b32 v81, s33, v24
  v_lshlrev_b32 v82, 16, v25
  v_and_b32 v83, s33, v25
  v_lshlrev_b32 v84, 16, v26
  v_and_b32 v85, s33, v26
  v_lshlrev_b32 v86, 16, v27
  v_and_b32 v87, s33, v27
  v_pk_add_f32 v[88:89], v[48:49], v[50:51]
  v_pk_add_f32 v[90:91], v[52:53], v[54:55]
  v_pk_add_f32 v[88:89], v[88:89], v[56:57]
  v_pk_add_f32 v[90:91], v[90:91], v[58:59]
  v_pk_add_f32 v[88:89], v[88:89], v[60:61]
  v_pk_add_f32 v[90:91], v[90:91], v[62:63]
  v_pk_add_f32 v[88:89], v[88:89], v[64:65]
  v_pk_add_f32 v[90:91], v[90:91], v[66:67]
  v_pk_add_f32 v[88:89], v[88:89], v[68:69]
  v_pk_add_f32 v[90:91], v[90:91], v[70:71]
  v_pk_add_f32 v[88:89], v[88:89], v[72:73]
  v_pk_add_f32 v[90:91], v[90:91], v[74:75]
  v_pk_add_f32 v[88:89], v[88:89], v[76:77]
  v_pk_add_f32 v[90:91], v[90:91], v[78:79]
  v_pk_add_f32 v[88:89], v[88:89], v[80:81]
  v_pk_add_f32 v[90:91], v[90:91], v[82:83]
  v_pk_add_f32 v[88:89], v[88:89], v[84:85]
  v_pk_add_f32 v[90:91], v[90:91], v[86:87]
  v_pk_add_f32 v[88:89], v[88:89], v[90:91]
  v_add_f32 v92, v88, v89
  s_nop 1
  v_add_f32_dpp v92, v92, v92 row_ror:8 row_mask:0xf bank_mask:0xf
  s_nop 1
  v_add_f32_dpp v92, v92, v92 row_ror:4 row_mask:0xf bank_mask:0xf
  s_nop 1
  v_add_f32_dpp v92, v92, v92 row_ror:2 row_mask:0xf bank_mask:0xf
  s_nop 1
  v_add_f32_dpp v92, v92, v92 row_ror:1 row_mask:0xf bank_mask:0xf
  v_mul_f32 v92, 0x3acccccd, v92
  v_pk_add_f32 v[94:95], v[48:49], v[92:93] op_sel_hi:[1,0] neg_lo:[0,1] neg_hi:[0,1]
  v_pk_mul_f32 v[88:89], v[94:95], v[94:95]
  v_pk_add_f32 v[96:97], v[50:51], v[92:93] op_sel_hi:[1,0] neg_lo:[0,1] neg_hi:[0,1]
  v_pk_mul_f32 v[90:91], v[96:97], v[96:97]
  v_pk_add_f32 v[94:95], v[52:53], v[92:93] op_sel_hi:[1,0] neg_lo:[0,1] neg_hi:[0,1]
  v_pk_fma_f32 v[88:89], v[94:95], v[94:95], v[88:89]
  v_pk_add_f32 v[96:97], v[54:55], v[92:93] op_sel_hi:[1,0] neg_lo:[0,1] neg_hi:[0,1]
  v_pk_fma_f32 v[90:91], v[96:97], v[96:97], v[90:91]
  v_pk_add_f32 v[94:95], v[56:57], v[92:93] op_sel_hi:[1,0] neg_lo:[0,1] neg_hi:[0,1]
  v_pk_fma_f32 v[88:89], v[94:95], v[94:95], v[88:89]
  v_pk_add_f32 v[96:97], v[58:59], v[92:93] op_sel_hi:[1,0] neg_lo:[0,1] neg_hi:[0,1]
  v_pk_fma_f32 v[90:91], v[96:97], v[96:97], v[90:91]
  v_pk_add_f32 v[94:95], v[60:61], v[92:93] op_sel_hi:[1,0] neg_lo:[0,1] neg_hi:[0,1]
  v_pk_fma_f32 v[88:89], v[94:95], v[94:95], v[88:89]
  v_pk_add_f32 v[96:97], v[62:63], v[92:93] op_sel_hi:[1,0] neg_lo:[0,1] neg_hi:[0,1]
  v_pk_fma_f32 v[90:91], v[96:97], v[96:97], v[90:91]
  v_pk_add_f32 v[94:95], v[64:65], v[92:93] op_sel_hi:[1,0] neg_lo:[0,1] neg_hi:[0,1]
  v_pk_fma_f32 v[88:89], v[94:95], v[94:95], v[88:89]
  v_pk_add_f32 v[96:97], v[66:67], v[92:93] op_sel_hi:[1,0] neg_lo:[0,1] neg_hi:[0,1]
  v_pk_fma_f32 v[90:91], v[96:97], v[96:97], v[90:91]
  v_pk_add_f32 v[94:95], v[68:69], v[92:93] op_sel_hi:[1,0] neg_lo:[0,1] neg_hi:[0,1]
  v_pk_fma_f32 v[88:89], v[94:95], v[94:95], v[88:89]
  v_pk_add_f32 v[96:97], v[70:71], v[92:93] op_sel_hi:[1,0] neg_lo:[0,1] neg_hi:[0,1]
  v_pk_fma_f32 v[90:91], v[96:97], v[96:97], v[90:91]
  v_pk_add_f32 v[94:95], v[72:73], v[92:93] op_sel_hi:[1,0] neg_lo:[0,1] neg_hi:[0,1]
  v_pk_fma_f32 v[88:89], v[94:95], v[94:95], v[88:89]
  v_pk_add_f32 v[96:97], v[74:75], v[92:93] op_sel_hi:[1,0] neg_lo:[0,1] neg_hi:[0,1]
  v_pk_fma_f32 v[90:91], v[96:97], v[96:97], v[90:91]
  v_pk_add_f32 v[94:95], v[76:77], v[92:93] op_sel_hi:[1,0] neg_lo:[0,1] neg_hi:[0,1]
  v_pk_fma_f32 v[88:89], v[94:95], v[94:95], v[88:89]
  v_pk_add_f32 v[96:97], v[78:79], v[92:93] op_sel_hi:[1,0] neg_lo:[0,1] neg_hi:[0,1]
  v_pk_fma_f32 v[90:91], v[96:97], v[96:97], v[90:91]
  v_pk_add_f32 v[94:95], v[80:81], v[92:93] op_sel_hi:[1,0] neg_lo:[0,1] neg_hi:[0,1]
  v_pk_fma_f32 v[88:89], v[94:95], v[94:95], v[88:89]
  v_pk_add_f32 v[96:97], v[82:83], v[92:93] op_sel_hi:[1,0] neg_lo:[0,1] neg_hi:[0,1]
  v_pk_fma_f32 v[90:91], v[96:97], v[96:97], v[90:91]
  v_pk_add_f32 v[94:95], v[84:85], v[92:93] op_sel_hi:[1,0] neg_lo:[0,1] neg_hi:[0,1]
  v_pk_fma_f32 v[88:89], v[94:95], v[94:95], v[88:89]
  v_pk_add_f32 v[96:97], v[86:87], v[92:93] op_sel_hi:[1,0] neg_lo:[0,1] neg_hi:[0,1]
  v_pk_fma_f32 v[90:91], v[96:97], v[96:97], v[90:91]
  v_pk_add_f32 v[88:89], v[88:89], v[90:91]
  v_add_f32 v98, v88, v89
  s_nop 1
  v_add_f32_dpp v98, v98, v98 row_ror:8 row_mask:0xf bank_mask:0xf
  s_nop 1
  v_add_f32_dpp v98, v98, v98 row_ror:4 row_mask:0xf bank_mask:0xf
  s_nop 1
  v_add_f32_dpp v98, v98, v98 row_ror:2 row_mask:0xf bank_mask:0xf
  s_nop 1
  v_add_f32_dpp v98, v98, v98 row_ror:1 row_mask:0xf bank_mask:0xf
  v_mul_f32 v98, 0x3acccccd, v98
  v_cvt_pk_bf16_f32 v92, v92, v92
  v_lshlrev_b32 v92, 16, v92
  v_cvt_pk_bf16_f32 v98, v98, v98
  v_lshlrev_b32 v98, 16, v98
  v_add_f32 v98, 0x3727c5ac, v98
  v_cvt_pk_bf16_f32 v98, v98, v98
  v_lshlrev_b32 v98, 16, v98
  v_sqrt_f32 v98, v98
  s_nop 0
  v_cvt_pk_bf16_f32 v98, v98, v98
  v_lshlrev_b32 v98, 16, v98
  v_rcp_f32 v100, v98
  v_mov_b32 v104, 0
  v_mov_b32 v105, 0
  v_pk_add_f32 v[48:49], v[48:49], v[92:93] op_sel_hi:[1,0] neg_lo:[0,1] neg_hi:[0,1]
  v_pk_add_f32 v[50:51], v[50:51], v[92:93] op_sel_hi:[1,0] neg_lo:[0,1] neg_hi:[0,1]
  v_pk_add_f32 v[52:53], v[52:53], v[92:93] op_sel_hi:[1,0] neg_lo:[0,1] neg_hi:[0,1]
  v_pk_add_f32 v[54:55], v[54:55], v[92:93] op_sel_hi:[1,0] neg_lo:[0,1] neg_hi:[0,1]
  v_pk_add_f32 v[56:57], v[56:57], v[92:93] op_sel_hi:[1,0] neg_lo:[0,1] neg_hi:[0,1]
  v_pk_add_f32 v[58:59], v[58:59], v[92:93] op_sel_hi:[1,0] neg_lo:[0,1] neg_hi:[0,1]
  v_pk_add_f32 v[60:61], v[60:61], v[92:93] op_sel_hi:[1,0] neg_lo:[0,1] neg_hi:[0,1]
  v_pk_add_f32 v[62:63], v[62:63], v[92:93] op_sel_hi:[1,0] neg_lo:[0,1] neg_hi:[0,1]
  v_pk_add_f32 v[64:65], v[64:65], v[92:93] op_sel_hi:[1,0] neg_lo:[0,1] neg_hi:[0,1]
  v_pk_add_f32 v[66:67], v[66:67], v[92:93] op_sel_hi:[1,0] neg_lo:[0,1] neg_hi:[0,1]
  v_pk_add_f32 v[68:69], v[68:69], v[92:93] op_sel_hi:[1,0] neg_lo:[0,1] neg_hi:[0,1]
  v_pk_add_f32 v[70:71], v[70:71], v[92:93] op_sel_hi:[1,0] neg_lo:[0,1] neg_hi:[0,1]
  v_pk_add_f32 v[72:73], v[72:73], v[92:93] op_sel_hi:[1,0] neg_lo:[0,1] neg_hi:[0,1]
  v_pk_add_f32 v[74:75], v[74:75], v[92:93] op_sel_hi:[1,0] neg_lo:[0,1] neg_hi:[0,1]
  v_pk_add_f32 v[76:77], v[76:77], v[92:93] op_sel_hi:[1,0] neg_lo:[0,1] neg_hi:[0,1]
  v_pk_add_f32 v[78:79], v[78:79], v[92:93] op_sel_hi:[1,0] neg_lo:[0,1] neg_hi:[0,1]
  v_pk_add_f32 v[80:81], v[80:81], v[92:93] op_sel_hi:[1,0] neg_lo:[0,1] neg_hi:[0,1]
  v_pk_add_f32 v[82:83], v[82:83], v[92:93] op_sel_hi:[1,0] neg_lo:[0,1] neg_hi:[0,1]
  v_pk_add_f32 v[84:85], v[84:85], v[92:93] op_sel_hi:[1,0] neg_lo:[0,1] neg_hi:[0,1]
  v_pk_add_f32 v[86:87], v[86:87], v[92:93] op_sel_hi:[1,0] neg_lo:[0,1] neg_hi:[0,1]
  v_cvt_pk_bf16_f32 v8, v48, v49
  v_cvt_pk_bf16_f32 v9, v50, v51
  v_cvt_pk_bf16_f32 v10, v52, v53
  v_cvt_pk_bf16_f32 v11, v54, v55
  v_cvt_pk_bf16_f32 v12, v56, v57
  v_cvt_pk_bf16_f32 v13, v58, v59
  v_cvt_pk_bf16_f32 v14, v60, v61
  v_cvt_pk_bf16_f32 v15, v62, v63
  v_cvt_pk_bf16_f32 v16, v64, v65
  v_cvt_pk_bf16_f32 v17, v66, v67
  v_cvt_pk_bf16_f32 v18, v68, v69
  v_cvt_pk_bf16_f32 v19, v70, v71
  v_cvt_pk_bf16_f32 v20, v72, v73
  v_cvt_pk_bf16_f32 v21, v74, v75
  v_cvt_pk_bf16_f32 v22, v76, v77
  v_cvt_pk_bf16_f32 v23, v78, v79
  v_cvt_pk_bf16_f32 v24, v80, v81
  v_cvt_pk_bf16_f32 v25, v82, v83
  v_cvt_pk_bf16_f32 v26, v84, v85
  v_cvt_pk_bf16_f32 v27, v86, v87
  v_lshlrev_b32 v48, 16, v8
  v_and_b32 v49, s33, v8
  v_lshlrev_b32 v50, 16, v9
  v_and_b32 v51, s33, v9
  v_lshlrev_b32 v52, 16, v10
  v_and_b32 v53, s33, v10
  v_lshlrev_b32 v54, 16, v11
  v_and_b32 v55, s33, v11
  v_lshlrev_b32 v56, 16, v12
  v_and_b32 v57, s33, v12
  v_lshlrev_b32 v58, 16, v13
  v_and_b32 v59, s33, v13
  v_lshlrev_b32 v60, 16, v14
  v_and_b32 v61, s33, v14
  v_lshlrev_b32 v62, 16, v15
  v_and_b32 v63, s33, v15
  v_lshlrev_b32 v64, 16, v16
  v_and_b32 v65, s33, v16
  v_lshlrev_b32 v66, 16, v17
  v_and_b32 v67, s33, v17
  v_lshlrev_b32 v68, 16, v18
  v_and_b32 v69, s33, v18
  v_lshlrev_b32 v70, 16, v19
  v_and_b32 v71, s33, v19
  v_lshlrev_b32 v72, 16, v20
  v_and_b32 v73, s33, v20
  v_lshlrev_b32 v74, 16, v21
  v_and_b32 v75, s33, v21
  v_lshlrev_b32 v76, 16, v22
  v_and_b32 v77, s33, v22
  v_lshlrev_b32 v78, 16, v23
  v_and_b32 v79, s33, v23
  v_lshlrev_b32 v80, 16, v24
  v_and_b32 v81, s33, v24
  v_lshlrev_b32 v82, 16, v25
  v_and_b32 v83, s33, v25
  v_lshlrev_b32 v84, 16, v26
  v_and_b32 v85, s33, v26
  v_lshlrev_b32 v86, 16, v27
  v_and_b32 v87, s33, v27
  v_pk_mul_f32 v[48:49], v[48:49], v[100:101] op_sel_hi:[1,0]
  v_pk_mul_f32 v[50:51], v[50:51], v[100:101] op_sel_hi:[1,0]
  v_pk_mul_f32 v[52:53], v[52:53], v[100:101] op_sel_hi:[1,0]
  v_pk_mul_f32 v[54:55], v[54:55], v[100:101] op_sel_hi:[1,0]
  v_pk_mul_f32 v[56:57], v[56:57], v[100:101] op_sel_hi:[1,0]
  v_pk_mul_f32 v[58:59], v[58:59], v[100:101] op_sel_hi:[1,0]
  v_pk_mul_f32 v[60:61], v[60:61], v[100:101] op_sel_hi:[1,0]
  v_pk_mul_f32 v[62:63], v[62:63], v[100:101] op_sel_hi:[1,0]
  v_pk_mul_f32 v[64:65], v[64:65], v[100:101] op_sel_hi:[1,0]
  v_pk_mul_f32 v[66:67], v[66:67], v[100:101] op_sel_hi:[1,0]
  v_pk_mul_f32 v[68:69], v[68:69], v[100:101] op_sel_hi:[1,0]
  v_pk_mul_f32 v[70:71], v[70:71], v[100:101] op_sel_hi:[1,0]
  v_pk_mul_f32 v[72:73], v[72:73], v[100:101] op_sel_hi:[1,0]
  v_pk_mul_f32 v[74:75], v[74:75], v[100:101] op_sel_hi:[1,0]
  v_pk_mul_f32 v[76:77], v[76:77], v[100:101] op_sel_hi:[1,0]
  v_pk_mul_f32 v[78:79], v[78:79], v[100:101] op_sel_hi:[1,0]
  v_pk_mul_f32 v[80:81], v[80:81], v[100:101] op_sel_hi:[1,0]
  v_pk_mul_f32 v[82:83], v[82:83], v[100:101] op_sel_hi:[1,0]
  v_pk_mul_f32 v[84:85], v[84:85], v[100:101] op_sel_hi:[1,0]
  v_pk_mul_f32 v[86:87], v[86:87], v[100:101] op_sel_hi:[1,0]
  v_cvt_pk_bf16_f32 v8, v48, v49
  v_cvt_pk_bf16_f32 v9, v50, v51
  v_cvt_pk_bf16_f32 v10, v52, v53
  v_cvt_pk_bf16_f32 v11, v54, v55
  buffer_store_dwordx4 v[8:11], v5, s[24:27], s30 offen
  s_add_u32 s30, s30, 16384
  v_cvt_pk_bf16_f32 v12, v56, v57
  v_cvt_pk_bf16_f32 v13, v58, v59
  v_cvt_pk_bf16_f32 v14, v60, v61
  v_cvt_pk_bf16_f32 v15, v62, v63
  buffer_store_dwordx4 v[12:15], v5, s[24:27], s30 offen
  s_add_u32 s30, s30, 16384
  v_cvt_pk_bf16_f32 v16, v64, v65
  v_cvt_pk_bf16_f32 v17, v66, v67
  v_cvt_pk_bf16_f32 v18, v68, v69
  v_cvt_pk_bf16_f32 v19, v70, v71
  buffer_store_dwordx4 v[16:19], v5, s[24:27], s30 offen
  s_add_u32 s30, s30, 16384
  v_cvt_pk_bf16_f32 v20, v72, v73
  v_cvt_pk_bf16_f32 v21, v74, v75
  v_cvt_pk_bf16_f32 v22, v76, v77
  v_cvt_pk_bf16_f32 v23, v78, v79
  buffer_store_dwordx4 v[20:23], v5, s[24:27], s30 offen
  s_add_u32 s30, s30, 16384
  v_cvt_pk_bf16_f32 v24, v80, v81
  v_cvt_pk_bf16_f32 v25, v82, v83
  v_cvt_pk_bf16_f32 v26, v84, v85
  v_cvt_pk_bf16_f32 v27, v86, v87
  buffer_store_dwordx4 v[24:27], v5, s[24:27], s30 offen
  s_add_u32 s30, s30, 16384
  s_waitcnt vmcnt(9)
  v_dot2_f32_bf16 v104, v8, v28, v104
  v_dot2_f32_bf16 v105, v9, v29, v105
  v_dot2_f32_bf16 v104, v10, v30, v104
  v_dot2_f32_bf16 v105, v11, v31, v105
  s_waitcnt vmcnt(8)
  v_dot2_f32_bf16 v104, v12, v32, v104
  v_dot2_f32_bf16 v105, v13, v33, v105
  v_dot2_f32_bf16 v104, v14, v34, v104
  v_dot2_f32_bf16 v105, v15, v35, v105
  s_waitcnt vmcnt(7)
  v_dot2_f32_bf16 v104, v16, v36, v104
  v_dot2_f32_bf16 v105, v17, v37, v105
  v_dot2_f32_bf16 v104, v18, v38, v104
  v_dot2_f32_bf16 v105, v19, v39, v105
  s_waitcnt vmcnt(6)
  v_dot2_f32_bf16 v104, v20, v40, v104
  v_dot2_f32_bf16 v105, v21, v41, v105
  v_dot2_f32_bf16 v104, v22, v42, v104
  v_dot2_f32_bf16 v105, v23, v43, v105
  s_waitcnt vmcnt(5)
  v_dot2_f32_bf16 v104, v24, v44, v104
  v_dot2_f32_bf16 v105, v25, v45, v105
  v_dot2_f32_bf16 v104, v26, v46, v104
  v_dot2_f32_bf16 v105, v27, v47, v105
  s_nop 2
  v_add_f32 v104, v104, v105
  s_nop 1
  v_add_f32_dpp v104, v104, v104 row_ror:8 row_mask:0xf bank_mask:0xf
  s_nop 1
  v_add_f32_dpp v104, v104, v104 row_ror:4 row_mask:0xf bank_mask:0xf
  s_nop 1
  v_add_f32_dpp v104, v104, v104 row_ror:2 row_mask:0xf bank_mask:0xf
  s_nop 1
  v_add_f32_dpp v104, v104, v104 row_ror:1 row_mask:0xf bank_mask:0xf
  v_cvt_pk_bf16_f32 v104, v104, v104
  v_lshlrev_b32 v104, 16, v104
  v_ashrrev_i32 v105, 31, v104
  v_or_b32 v105, 0x80000000, v105
  v_xor_b32 v104, v104, v105
  v_and_b32 v104, s33, v104
  v_add_u32 v6, s28, v1
  v_sub_u32 v7, 0xffff, v6
  v_or_b32 v104, v104, v7
  v_lshlrev_b32 v6, 2, v6
  s_mov_b32 s31, 2621440
  v_cmp_eq_u32 vcc, 0, v2
  s_nop 0
  s_and_saveexec_b64 s[34:35], vcc
  buffer_store_dword v104, v6, s[24:27], s31 offen
prep_end:
  s_endpgm
.globl attn_kernel
.p2align 8
.type attn_kernel,@function
attn_kernel:
  s_cmp_ge_u32 s2, 256
  s_cbranch_scc1 attn_end
  s_load_dwordx4 s[4:7], s[0:1], 8
  s_load_dwordx2 s[8:9], s[0:1], 24
  s_load_dwordx2 s[10:11], s[0:1], 96
  s_load_dwordx2 s[88:89], s[0:1], 32
  s_load_dwordx2 s[90:91], s[0:1], 56
  s_load_dwordx4 s[92:95], s[0:1], 64
  s_load_dwordx2 s[96:97], s[0:1], 88
  s_getpc_b64 s[48:49]
attn_hot_pc:
  s_add_u32 s48, s48, attn_hot-attn_hot_pc
  s_addc_u32 s49, s49, 0
  v_lshlrev_b32 v249, 7, v0
  v_min_u32 v249, attn_slow-attn_hot-4, v249
  global_load_dword v255, v249, s[48:49]
  v_add_u32 v249, 0x8000, v249
  v_min_u32 v249, attn_slow-attn_hot-4, v249
  global_load_dword v255, v249, s[48:49]
  v_lshrrev_b32 v249, 6, v0
  v_and_b32 v245, 63, v0
  v_readfirstlane_b32 s3, v249
  s_and_b32 s36, s2, 7
  s_lshl_b32 s36, s36, 2
  s_lshr_b32 s37, s2, 6
  s_add_u32 s36, s36, s37
  s_bfe_u32 s37, s2, 0x30003
  s_lshl_b32 s37, s37, 2
  s_add_u32 s37, s37, s3
  s_lshl_b32 s28, s3, 12
  v_lshlrev_b32 v242, 4, v245
  v_add_u32 v243, 0x1000, v242
  s_mul_i32 s30, s37, 81920
  v_lshrrev_b32 v248, 4, v245
  v_and_b32 v247, 15, v245
  s_lshl_b32 s38, s3, 17
  v_lshlrev_b32 v249, 13, v248
  v_add_u32 v249, s38, v249
  v_or_b32 v250, 0, v248
  v_lshlrev_b32 v250, 1, v250
  v_xor_b32 v250, v250, v247
  v_lshl_add_u32 v238, v250, 4, v249
  v_or_b32 v250, 0, v248
  v_lshlrev_b32 v250, 1, v250
  v_xor_b32 v250, v250, v247
  v_lshl_add_u32 v239, v250, 4, v249
  v_add_u32 v239, 31744, v239
  v_or_b32 v250, 4, v248
  v_lshlrev_b32 v250, 1, v250
  v_xor_b32 v250, v250, v247
  v_lshl_add_u32 v240, v250, 4, v249
  v_add_u32 v240, 63488, v240
  v_or_b32 v250, 4, v248
  v_lshlrev_b32 v250, 1, v250
  v_xor_b32 v250, v250, v247
  v_lshl_add_u32 v241, v250, 4, v249
  v_add_u32 v241, 95232, v241
  s_waitcnt lgkmcnt(0)
  s_lshl_b32 s38, s36, 8
  s_add_u32 s20, s8, s38
  s_addc_u32 s21, s9, 0
  s_mov_b32 s22, 5242880
  s_mov_b32 s23, 0x20000
  s_sub_u32 s22, s22, s38
  s_mov_b32 s24, s10
  s_mov_b32 s25, s11
  s_mov_b32 s26, 25165824
  s_mov_b32 s27, 0x20000
  s_mov_b32 s31, 0
  s_lshl_b32 s38, s36, 19
  s_add_u32 s12, s4, s38
  s_addc_u32 s13, s5, 0
  s_mov_b32 s14, 524288
  s_mov_b32 s15, 0x20000
  s_add_u32 s16, s6, s38
  s_addc_u32 s17, s7, 0
  s_mov_b32 s18, 524288
  s_mov_b32 s19, 0x20000
  v_lshlrev_b32 v251, 7, v247
  v_lshl_add_u32 v251, v248, 13, v251
  s_lshr_b32 s49, s2, 3
  s_mul_i32 s49, s49, 81920
  s_lshl_b32 s38, s3, 11
  s_add_u32 s49, s49, s38
  s_add_u32 m0, s28, 98304
  s_nop 0
  buffer_load_dwordx4 v238, s[20:23], s31 offen offset:0 lds
  buffer_load_dwordx4 v239, s[20:23], s31 offen offset:1024 lds
  buffer_load_dwordx4 v240, s[20:23], s31 offen offset:2048 lds
  buffer_load_dwordx4 v241, s[20:23], s31 offen offset:3072 lds
  s_add_u32 s31, s31, 0x80000
  buffer_load_dwordx4 a[0:3], v242, s[24:27], s30 offen offset:0
  buffer_load_dwordx4 a[4:7], v242, s[24:27], s30 offen offset:1024
  buffer_load_dwordx4 a[8:11], v242, s[24:27], s30 offen offset:2048
  buffer_load_dwordx4 a[12:15], v242, s[24:27], s30 offen offset:3072
  buffer_load_dwordx4 a[16:19], v243, s[24:27], s30 offen offset:0
  buffer_load_dwordx4 a[20:23], v243, s[24:27], s30 offen offset:1024
  buffer_load_dwordx4 a[24:27], v243, s[24:27], s30 offen offset:2048
  buffer_load_dwordx4 a[28:31], v243, s[24:27], s30 offen offset:3072
  s_add_u32 s30, s30, 8192
  s_add_u32 m0, s28, 114688
  s_nop 0
  buffer_load_dwordx4 v238, s[20:23], s31 offen offset:0 lds
  buffer_load_dwordx4 v239, s[20:23], s31 offen offset:1024 lds
  buffer_load_dwordx4 v240, s[20:23], s31 offen offset:2048 lds
  buffer_load_dwordx4 v241, s[20:23], s31 offen offset:3072 lds
  s_add_u32 s31, s31, 0x80000
  buffer_load_dwordx4 a[32:35], v242, s[24:27], s30 offen offset:0
  buffer_load_dwordx4 a[36:39], v242, s[24:27], s30 offen offset:1024
  buffer_load_dwordx4 a[40:43], v242, s[24:27], s30 offen offset:2048
  buffer_load_dwordx4 a[44:47], v242, s[24:27], s30 offen offset:3072
  buffer_load_dwordx4 a[48:51], v243, s[24:27], s30 offen offset:0
  buffer_load_dwordx4 a[52:55], v243, s[24:27], s30 offen offset:1024
  buffer_load_dwordx4 a[56:59], v243, s[24:27], s30 offen offset:2048
  buffer_load_dwordx4 a[60:63], v243, s[24:27], s30 offen offset:3072
  s_add_u32 s30, s30, 8192
  v_lshlrev_b32 v249, 8, v248
  v_add_u32 v249, s28, v249
  v_add_u32 v250, 0, v248
  v_xor_b32 v250, v250, v247
  v_lshl_add_u32 v232, v250, 4, v249
  v_add_u32 v250, 4, v248
  v_xor_b32 v250, v250, v247
  v_lshl_add_u32 v233, v250, 4, v249
  v_add_u32 v250, 8, v248
  v_xor_b32 v250, v250, v247
  v_lshl_add_u32 v234, v250, 4, v249
  v_add_u32 v250, 12, v248
  v_xor_b32 v250, v250, v247
  v_lshl_add_u32 v235, v250, 4, v249
  v_add_u32 v250, 0, v248
  v_lshlrev_b32 v250, 1, v250
  v_xor_b32 v250, v250, v247
  v_lshl_add_u32 v236, v250, 4, v249
  v_add_u32 v250, 4, v248
  v_lshlrev_b32 v250, 1, v250
  v_xor_b32 v250, v250, v247
  v_lshl_add_u32 v237, v250, 4, v249
  v_lshrrev_b32 v249, 1, v248
  v_and_b32 v250, 1, v248
  v_lshl_or_b32 v249, v250, 1, v249
  v_xor_b32 v249, v249, v247
  v_lshlrev_b32 v249, 4, v249
  v_lshl_add_u32 v212, v247, 8, v249
  v_xor_b32 v213, 64, v212
  v_xor_b32 v214, 128, v212
  v_xor_b32 v215, 192, v212
  v_bfe_u32 v246, v245, 2, 2
  v_and_b32 v247, 3, v245
  v_lshlrev_b32 v247, 3, v247
  v_add_u32 v247, 65536, v247
  v_lshl_add_u32 v249, v248, 2, v246
  v_and_b32 v250, 7, v249
  v_lshl_add_u32 v250, v250, 5, v247
  v_lshl_add_u32 v216, v249, 8, v250
  v_lshl_add_u32 v249, v248, 3, v246
  v_and_b32 v250, 1, v248
  v_lshl_add_u32 v250, v250, 2, v246
  v_lshl_add_u32 v250, v250, 5, v247
  v_lshl_add_u32 v224, v249, 8, v250
  v_xor_b32 v217, 32, v216
  v_xor_b32 v225, 32, v224
  v_xor_b32 v218, 64, v216
  v_xor_b32 v226, 64, v224
  v_xor_b32 v219, 96, v216
  v_xor_b32 v227, 96, v224
  v_xor_b32 v220, 128, v216
  v_xor_b32 v228, 128, v224
  v_xor_b32 v221, 160, v216
  v_xor_b32 v229, 160, v224
  v_xor_b32 v222, 192, v216
  v_xor_b32 v230, 192, v224
  v_xor_b32 v223, 224, v216
  v_xor_b32 v231, 224, v224
  s_lshr_b32 s38, s2, 3
  s_min_u32 s38, s38, 26
  s_and_b32 s39, s2, 7
  s_mul_i32 s39, s39, 27
  s_add_u32 s33, s38, s39
  s_mul_i32 s50, s3, 6144
  s_add_u32 s50, s50, 137216
  v_mov_b32 v244, v242
  s_lshl_b32 s40, s37, 19
  s_lshl_b32 s38, s36, 14
  s_add_u32 s40, s40, s38
  s_add_u32 s40, s40, 8388608
  s_add_u32 s41, s40, 4096
  s_add_u32 s42, s40, 8192
  s_add_u32 s43, s40, 12288
  s_mov_b32 s34, 0x3e0293ee
  s_mov_b32 s29, 0
  v_and_b32 v249, 15, v245
  v_cmp_eq_u32 vcc, 0, v249
  v_mov_b32 v249, 0x3f803f80
  s_nop 0
  v_cndmask_b32 v249, 0, v249, vcc
  v_accvgpr_write_b32 a208, v249
  v_accvgpr_write_b32 a209, v249
  v_accvgpr_write_b32 a210, v249
  v_accvgpr_write_b32 a211, v249
attn_hot:
  s_waitcnt vmcnt(20)
  s_barrier
  ds_read_b64_tr_b16 a[160:161], v224 offset:32768
  ds_read_b64_tr_b16 a[162:163], v224 offset:33792
  ds_read_b64_tr_b16 a[164:165], v224 offset:40960
  ds_read_b64_tr_b16 a[166:167], v224 offset:41984
  ds_read_b64_tr_b16 a[168:169], v225 offset:32768
  ds_read_b64_tr_b16 a[170:171], v225 offset:33792
  ds_read_b64_tr_b16 a[172:173], v225 offset:40960
  ds_read_b64_tr_b16 a[174:175], v225 offset:41984
  s_waitcnt vmcnt(12) lgkmcnt(4)
  v_mfma_f32_16x16x32_bf16 v[0:3], a[160:163], a[0:3], 0
  ds_read_b64_tr_b16 a[176:177], v226 offset:32768
  s_add_u32 m0, s28, 65536
  v_mfma_f32_16x16x32_bf16 v[0:3], a[164:167], a[16:19], v[0:3]
  buffer_load_dwordx4 v238, s[20:23], s31 offen offset:0 lds
  v_mfma_f32_16x16x32_bf16 v[4:7], a[164:167], a[20:23], 0
  ds_read_b64_tr_b16 a[178:179], v226 offset:33792
  buffer_load_dwordx4 v239, s[20:23], s31 offen offset:1024 lds
  v_mfma_f32_16x16x32_bf16 v[4:7], a[160:163], a[4:7], v[4:7]
  buffer_load_dwordx4 v240, s[20:23], s31 offen offset:2048 lds
  v_mfma_f32_16x16x32_bf16 v[8:11], a[160:163], a[8:11], 0
  ds_read_b64_tr_b16 a[180:181], v226 offset:40960
  buffer_load_dwordx4 v241, s[20:23], s31 offen offset:3072 lds
  s_add_u32 s31, s31, 0x80000
  v_mfma_f32_16x16x32_bf16 v[8:11], a[164:167], a[24:27], v[8:11]
  buffer_load_dwordx4 a[64:67], v242, s[24:27], s30 offen offset:0
  v_mfma_f32_16x16x32_bf16 v[12:15], a[164:167], a[28:31], 0
  ds_read_b64_tr_b16 a[182:183], v226 offset:41984
  buffer_load_dwordx4 a[68:71], v242, s[24:27], s30 offen offset:1024
  v_mfma_f32_16x16x32_bf16 v[12:15], a[160:163], a[12:15], v[12:15]
  s_waitcnt lgkmcnt(4)
  buffer_load_dwordx4 a[72:75], v242, s[24:27], s30 offen offset:2048
  v_mfma_f32_16x16x32_bf16 v[16:19], a[168:171], a[0:3], 0
  ds_read_b64_tr_b16 a[184:185], v227 offset:32768
  buffer_load_dwordx4 a[76:79], v242, s[24:27], s30 offen offset:3072
  v_mfma_f32_16x16x32_bf16 v[16:19], a[172:175], a[16:19], v[16:19]
  buffer_load_dwordx4 a[80:83], v243, s[24:27], s30 offen offset:0
  v_mfma_f32_16x16x32_bf16 v[20:23], a[172:175], a[20:23], 0
  ds_read_b64_tr_b16 a[186:187], v227 offset:33792
  buffer_load_dwordx4 a[84:87], v243, s[24:27], s30 offen offset:1024
  v_mfma_f32_16x16x32_bf16 v[20:23], a[168:171], a[4:7], v[20:23]
  buffer_load_dwordx4 a[88:91], v243, s[24:27], s30 offen offset:2048
  v_mfma_f32_16x16x32_bf16 v[24:27], a[168:171], a[8:11], 0
  ds_read_b64_tr_b16 a[188:189], v227 offset:40960
  buffer_load_dwordx4 a[92:95], v243, s[24:27], s30 offen offset:3072
  s_add_u32 s30, s30, 8192
  s_add_u32 m0, s28, 81920
  v_mfma_f32_16x16x32_bf16 v[24:27], a[172:175], a[24:27], v[24:27]
  buffer_load_dwordx4 v238, s[20:23], s31 offen offset:0 lds
  v_mfma_f32_16x16x32_bf16 v[28:31], a[172:175], a[28:31], 0
  ds_read_b64_tr_b16 a[190:191], v227 offset:41984
  buffer_load_dwordx4 v239, s[20:23], s31 offen offset:1024 lds
  v_mfma_f32_16x16x32_bf16 v[28:31], a[168:171], a[12:15], v[28:31]
  s_waitcnt lgkmcnt(4)
  buffer_load_dwordx4 v240, s[20:23], s31 offen offset:2048 lds
  v_mfma_f32_16x16x32_bf16 v[32:35], a[176:179], a[0:3], 0
  ds_read_b64_tr_b16 a[160:161], v228 offset:32768
  buffer_load_dwordx4 v241, s[20:23], s31 offen offset:3072 lds
  s_add_u32 s31, s31, 0x80000
  v_mfma_f32_16x16x32_bf16 v[32:35], a[180:183], a[16:19], v[32:35]
  buffer_load_dwordx4 a[96:99], v242, s[24:27], s30 offen offset:0
  v_mfma_f32_16x16x32_bf16 v[36:39], a[180:183], a[20:23], 0
  ds_read_b64_tr_b16 a[162:163], v228 offset:33792
  buffer_load_dwordx4 a[100:103], v242, s[24:27], s30 offen offset:1024
  v_mfma_f32_16x16x32_bf16 v[36:39], a[176:179], a[4:7], v[36:39]
  buffer_load_dwordx4 a[104:107], v242, s[24:27], s30 offen offset:2048
  v_mfma_f32_16x16x32_bf16 v[40:43], a[176:179], a[8:11], 0
  ds_read_b64_tr_b16 a[164:165], v228 offset:40960
  buffer_load_dwordx4 a[108:111], v242, s[24:27], s30 offen offset:3072
  v_mfma_f32_16x16x32_bf16 v[40:43], a[180:183], a[24:27], v[40:43]
  buffer_load_dwordx4 a[112:115], v243, s[24:27], s30 offen offset:0
  v_mfma_f32_16x16x32_bf16 v[44:47], a[180:183], a[28:31], 0
  ds_read_b64_tr_b16 a[166:167], v228 offset:41984
  buffer_load_dwordx4 a[116:119], v243, s[24:27], s30 offen offset:1024
  v_mfma_f32_16x16x32_bf16 v[44:47], a[176:179], a[12:15], v[44:47]
  s_waitcnt lgkmcnt(4)
  buffer_load_dwordx4 a[120:123], v243, s[24:27], s30 offen offset:2048
  v_mfma_f32_16x16x32_bf16 v[48:51], a[184:187], a[0:3], 0
  ds_read_b64_tr_b16 a[168:169], v229 offset:32768
  buffer_load_dwordx4 a[124:127], v243, s[24:27], s30 offen offset:3072
  s_add_u32 s30, s30, 8192
  v_mfma_f32_16x16x32_bf16 v[48:51], a[188:191], a[16:19], v[48:51]
  v_mfma_f32_16x16x32_bf16 v[52:55], a[188:191], a[20:23], 0
  ds_read_b64_tr_b16 a[170:171], v229 offset:33792
  v_mfma_f32_16x16x32_bf16 v[52:55], a[184:187], a[4:7], v[52:55]
  v_mfma_f32_16x16x32_bf16 v[56:59], a[184:187], a[8:11], 0
  ds_read_b64_tr_b16 a[172:173], v229 offset:40960
  v_mfma_f32_16x16x32_bf16 v[56:59], a[188:191], a[24:27], v[56:59]
  v_mfma_f32_16x16x32_bf16 v[60:63], a[188:191], a[28:31], 0
  ds_read_b64_tr_b16 a[174:175], v229 offset:41984
  v_mfma_f32_16x16x32_bf16 v[60:63], a[184:187], a[12:15], v[60:63]
  s_waitcnt lgkmcnt(4)
  v_mfma_f32_16x16x32_bf16 v[64:67], a[160:163], a[0:3], 0
  ds_read_b64_tr_b16 a[176:177], v230 offset:32768
  v_mfma_f32_16x16x32_bf16 v[64:67], a[164:167], a[16:19], v[64:67]
  v_mfma_f32_16x16x32_bf16 v[68:71], a[164:167], a[20:23], 0
  ds_read_b64_tr_b16 a[178:179], v230 offset:33792
  v_mfma_f32_16x16x32_bf16 v[68:71], a[160:163], a[4:7], v[68:71]
  v_mfma_f32_16x16x32_bf16 v[72:75], a[160:163], a[8:11], 0
  ds_read_b64_tr_b16 a[180:181], v230 offset:40960
  v_mfma_f32_16x16x32_bf16 v[72:75], a[164:167], a[24:27], v[72:75]
  v_mfma_f32_16x16x32_bf16 v[76:79], a[164:167], a[28:31], 0
  ds_read_b64_tr_b16 a[182:183], v230 offset:41984
  v_mfma_f32_16x16x32_bf16 v[76:79], a[160:163], a[12:15], v[76:79]
  s_waitcnt lgkmcnt(4)
  v_mfma_f32_16x16x32_bf16 v[80:83], a[168:171], a[0:3], 0
  ds_read_b64_tr_b16 a[184:185], v231 offset:32768
  v_mfma_f32_16x16x32_bf16 v[80:83], a[172:175], a[16:19], v[80:83]
  v_mfma_f32_16x16x32_bf16 v[84:87], a[172:175], a[20:23], 0
  ds_read_b64_tr_b16 a[186:187], v231 offset:33792
  v_mfma_f32_16x16x32_bf16 v[84:87], a[168:171], a[4:7], v[84:87]
  s_waitcnt vmcnt(32)
  v_mfma_f32_16x16x32_bf16 v[88:91], a[168:171], a[8:11], 0
  ds_read_b64_tr_b16 a[188:189], v231 offset:40960
  v_mfma_f32_16x16x32_bf16 v[88:91], a[172:175], a[24:27], v[88:91]
  s_barrier
  v_mfma_f32_16x16x32_bf16 v[92:95], a[172:175], a[28:31], 0
  ds_read_b64_tr_b16 a[190:191], v231 offset:41984
  v_mfma_f32_16x16x32_bf16 v[92:95], a[168:171], a[12:15], v[92:95]
  s_waitcnt lgkmcnt(4)
  v_mfma_f32_16x16x32_bf16 v[96:99], a[176:179], a[0:3], 0
  ds_read_b64_tr_b16 a[160:161], v224 offset:49152
  v_mfma_f32_16x16x32_bf16 v[96:99], a[180:183], a[16:19], v[96:99]
  v_mfma_f32_16x16x32_bf16 v[100:103], a[180:183], a[20:23], 0
  ds_read_b64_tr_b16 a[162:163], v224 offset:50176
  v_mfma_f32_16x16x32_bf16 v[100:103], a[176:179], a[4:7], v[100:103]
  v_mfma_f32_16x16x32_bf16 v[104:107], a[176:179], a[8:11], 0
  ds_read_b64_tr_b16 a[164:165], v224 offset:57344
  v_mfma_f32_16x16x32_bf16 v[104:107], a[180:183], a[24:27], v[104:107]
  v_mfma_f32_16x16x32_bf16 v[108:111], a[180:183], a[28:31], 0
  ds_read_b64_tr_b16 a[166:167], v224 offset:58368
  v_mfma_f32_16x16x32_bf16 v[108:111], a[176:179], a[12:15], v[108:111]
  s_waitcnt lgkmcnt(4)
  v_mfma_f32_16x16x32_bf16 v[112:115], a[184:187], a[0:3], 0
  ds_read_b64_tr_b16 a[168:169], v225 offset:49152
  v_mfma_f32_16x16x32_bf16 v[112:115], a[188:191], a[16:19], v[112:115]
  v_mfma_f32_16x16x32_bf16 v[116:119], a[188:191], a[20:23], 0
  ds_read_b64_tr_b16 a[170:171], v225 offset:50176
  v_mfma_f32_16x16x32_bf16 v[116:119], a[184:187], a[4:7], v[116:119]
  v_mfma_f32_16x16x32_bf16 v[120:123], a[184:187], a[8:11], 0
  ds_read_b64_tr_b16 a[172:173], v225 offset:57344
  v_mfma_f32_16x16x32_bf16 v[120:123], a[188:191], a[24:27], v[120:123]
  v_mfma_f32_16x16x32_bf16 v[124:127], a[188:191], a[28:31], 0
  ds_read_b64_tr_b16 a[174:175], v225 offset:58368
  v_mfma_f32_16x16x32_bf16 v[124:127], a[184:187], a[12:15], v[124:127]
  s_waitcnt vmcnt(24) lgkmcnt(4)
  v_mfma_f32_16x16x32_bf16 v[0:3], a[160:163], a[32:35], v[0:3]
  ds_read_b64_tr_b16 a[176:177], v226 offset:49152
  v_mfma_f32_16x16x32_bf16 v[0:3], a[164:167], a[48:51], v[0:3]
  buffer_load_dwordx4 a[0:3], v242, s[24:27], s30 offen offset:0
  v_mfma_f32_16x16x32_bf16 v[4:7], a[164:167], a[52:55], v[4:7]
  ds_read_b64_tr_b16 a[178:179], v226 offset:50176
  v_mfma_f32_16x16x32_bf16 v[4:7], a[160:163], a[36:39], v[4:7]
  buffer_load_dwordx4 a[4:7], v242, s[24:27], s30 offen offset:1024
  v_mfma_f32_16x16x32_bf16 v[8:11], a[160:163], a[40:43], v[8:11]
  ds_read_b64_tr_b16 a[180:181], v226 offset:57344
  v_mfma_f32_16x16x32_bf16 v[8:11], a[164:167], a[56:59], v[8:11]
  buffer_load_dwordx4 a[8:11], v242, s[24:27], s30 offen offset:2048
  v_mfma_f32_16x16x32_bf16 v[12:15], a[164:167], a[60:63], v[12:15]
  ds_read_b64_tr_b16 a[182:183], v226 offset:58368
  v_mfma_f32_16x16x32_bf16 v[12:15], a[160:163], a[44:47], v[12:15]
  s_waitcnt lgkmcnt(4)
  v_mfma_f32_16x16x32_bf16 v[16:19], a[168:171], a[32:35], v[16:19]
  ds_read_b64_tr_b16 a[184:185], v227 offset:49152
  v_mfma_f32_16x16x32_bf16 v[16:19], a[172:175], a[48:51], v[16:19]
  buffer_load_dwordx4 a[12:15], v242, s[24:27], s30 offen offset:3072
  v_mfma_f32_16x16x32_bf16 v[20:23], a[172:175], a[52:55], v[20:23]
  ds_read_b64_tr_b16 a[186:187], v227 offset:50176
  v_mfma_f32_16x16x32_bf16 v[20:23], a[168:171], a[36:39], v[20:23]
  buffer_load_dwordx4 a[16:19], v243, s[24:27], s30 offen offset:0
  v_mfma_f32_16x16x32_bf16 v[24:27], a[168:171], a[40:43], v[24:27]
  ds_read_b64_tr_b16 a[188:189], v227 offset:57344
  v_mfma_f32_16x16x32_bf16 v[24:27], a[172:175], a[56:59], v[24:27]
  buffer_load_dwordx4 a[20:23], v243, s[24:27], s30 offen offset:1024
  v_mfma_f32_16x16x32_bf16 v[28:31], a[172:175], a[60:63], v[28:31]
  ds_read_b64_tr_b16 a[190:191], v227 offset:58368
  v_mfma_f32_16x16x32_bf16 v[28:31], a[168:171], a[44:47], v[28:31]
  s_waitcnt lgkmcnt(4)
  v_mfma_f32_16x16x32_bf16 v[32:35], a[176:179], a[32:35], v[32:35]
  ds_read_b64_tr_b16 a[160:161], v228 offset:49152
  v_mfma_f32_16x16x32_bf16 v[32:35], a[180:183], a[48:51], v[32:35]
  buffer_load_dwordx4 a[24:27], v243, s[24:27], s30 offen offset:2048
  v_mfma_f32_16x16x32_bf16 v[36:39], a[180:183], a[52:55], v[36:39]
  ds_read_b64_tr_b16 a[162:163], v228 offset:50176
  v_mfma_f32_16x16x32_bf16 v[36:39], a[176:179], a[36:39], v[36:39]
  buffer_load_dwordx4 a[28:31], v243, s[24:27], s30 offen offset:3072
  v_mfma_f32_16x16x32_bf16 v[40:43], a[176:179], a[40:43], v[40:43]
  ds_read_b64_tr_b16 a[164:165], v228 offset:57344
  v_mfma_f32_16x16x32_bf16 v[40:43], a[180:183], a[56:59], v[40:43]
  s_add_u32 s30, s30, 8192
  v_mfma_f32_16x16x32_bf16 v[44:47], a[180:183], a[60:63], v[44:47]
  ds_read_b64_tr_b16 a[166:167], v228 offset:58368
  v_mfma_f32_16x16x32_bf16 v[44:47], a[176:179], a[44:47], v[44:47]
  s_waitcnt lgkmcnt(4)
  v_mfma_f32_16x16x32_bf16 v[48:51], a[184:187], a[32:35], v[48:51]
  ds_read_b64_tr_b16 a[168:169], v229 offset:49152
  s_lshl_b32 s35, s3, 11
  s_add_u32 s35, s35, 2621440
  buffer_load_dwordx4 v[128:131], v242, s[24:27], s35 offen
  v_mfma_f32_16x16x32_bf16 v[48:51], a[188:191], a[48:51], v[48:51]
  buffer_load_dwordx4 v[132:135], v242, s[24:27], s35 offen offset:1024
  v_mfma_f32_16x16x32_bf16 v[52:55], a[188:191], a[52:55], v[52:55]
  ds_read_b64_tr_b16 a[170:171], v229 offset:50176
  v_mfma_f32_16x16x32_bf16 v[52:55], a[184:187], a[36:39], v[52:55]
  v_mfma_f32_16x16x32_bf16 v[56:59], a[184:187], a[40:43], v[56:59]
  ds_read_b64_tr_b16 a[172:173], v229 offset:57344
  v_mfma_f32_16x16x32_bf16 v[56:59], a[188:191], a[56:59], v[56:59]
  v_mfma_f32_16x16x32_bf16 v[60:63], a[188:191], a[60:63], v[60:63]
  ds_read_b64_tr_b16 a[174:175], v229 offset:58368
  v_mfma_f32_16x16x32_bf16 v[60:63], a[184:187], a[44:47], v[60:63]
  s_waitcnt lgkmcnt(4)
  v_mfma_f32_16x16x32_bf16 v[64:67], a[160:163], a[32:35], v[64:67]
  ds_read_b64_tr_b16 a[176:177], v230 offset:49152
  v_mfma_f32_16x16x32_bf16 v[64:67], a[164:167], a[48:51], v[64:67]
  v_mfma_f32_16x16x32_bf16 v[68:71], a[164:167], a[52:55], v[68:71]
  ds_read_b64_tr_b16 a[178:179], v230 offset:50176
  v_mfma_f32_16x16x32_bf16 v[68:71], a[160:163], a[36:39], v[68:71]
  v_mfma_f32_16x16x32_bf16 v[72:75], a[160:163], a[40:43], v[72:75]
  ds_read_b64_tr_b16 a[180:181], v230 offset:57344
  v_mfma_f32_16x16x32_bf16 v[72:75], a[164:167], a[56:59], v[72:75]
  v_mfma_f32_16x16x32_bf16 v[76:79], a[164:167], a[60:63], v[76:79]
  ds_read_b64_tr_b16 a[182:183], v230 offset:58368
  v_mfma_f32_16x16x32_bf16 v[76:79], a[160:163], a[44:47], v[76:79]
  s_waitcnt lgkmcnt(4)
  v_mfma_f32_16x16x32_bf16 v[80:83], a[168:171], a[32:35], v[80:83]
  ds_read_b64_tr_b16 a[184:185], v231 offset:49152
  v_mfma_f32_16x16x32_bf16 v[80:83], a[172:175], a[48:51], v[80:83]
  v_mfma_f32_16x16x32_bf16 v[84:87], a[172:175], a[52:55], v[84:87]
  ds_read_b64_tr_b16 a[186:187], v231 offset:50176
  v_mfma_f32_16x16x32_bf16 v[84:87], a[168:171], a[36:39], v[84:87]
  s_waitcnt vmcnt(30)
  v_mfma_f32_16x16x32_bf16 v[88:91], a[168:171], a[40:43], v[88:91]
  ds_read_b64_tr_b16 a[188:189], v231 offset:57344
  v_mfma_f32_16x16x32_bf16 v[88:91], a[172:175], a[56:59], v[88:91]
  s_barrier
  v_mfma_f32_16x16x32_bf16 v[92:95], a[172:175], a[60:63], v[92:95]
  ds_read_b64_tr_b16 a[190:191], v231 offset:58368
  v_mfma_f32_16x16x32_bf16 v[92:95], a[168:171], a[44:47], v[92:95]
  s_waitcnt lgkmcnt(4)
  s_add_u32 m0, s28, 98304
  v_mfma_f32_16x16x32_bf16 v[96:99], a[176:179], a[32:35], v[96:99]
  ds_read_b64_tr_b16 a[160:161], v224 offset:0
  v_mfma_f32_16x16x32_bf16 v[96:99], a[180:183], a[48:51], v[96:99]
  buffer_load_dwordx4 v238, s[20:23], s31 offen offset:0 lds
  v_mfma_f32_16x16x32_bf16 v[100:103], a[180:183], a[52:55], v[100:103]
  ds_read_b64_tr_b16 a[162:163], v224 offset:1024
  v_mfma_f32_16x16x32_bf16 v[100:103], a[176:179], a[36:39], v[100:103]
  buffer_load_dwordx4 v239, s[20:23], s31 offen offset:1024 lds
  v_mfma_f32_16x16x32_bf16 v[104:107], a[176:179], a[40:43], v[104:107]
  ds_read_b64_tr_b16 a[164:165], v224 offset:8192
  v_mfma_f32_16x16x32_bf16 v[104:107], a[180:183], a[56:59], v[104:107]
  buffer_load_dwordx4 v240, s[20:23], s31 offen offset:2048 lds
  v_mfma_f32_16x16x32_bf16 v[108:111], a[180:183], a[60:63], v[108:111]
  ds_read_b64_tr_b16 a[166:167], v224 offset:9216
  v_mfma_f32_16x16x32_bf16 v[108:111], a[176:179], a[44:47], v[108:111]
  s_waitcnt lgkmcnt(4)
  v_mfma_f32_16x16x32_bf16 v[112:115], a[184:187], a[32:35], v[112:115]
  ds_read_b64_tr_b16 a[168:169], v225 offset:0
  v_mfma_f32_16x16x32_bf16 v[112:115], a[188:191], a[48:51], v[112:115]
  buffer_load_dwordx4 v241, s[20:23], s31 offen offset:3072 lds
  v_mfma_f32_16x16x32_bf16 v[116:119], a[188:191], a[52:55], v[116:119]
  ds_read_b64_tr_b16 a[170:171], v225 offset:1024
  v_mfma_f32_16x16x32_bf16 v[116:119], a[184:187], a[36:39], v[116:119]
  s_add_u32 s31, s31, 0x80000
  v_mfma_f32_16x16x32_bf16 v[120:123], a[184:187], a[40:43], v[120:123]
  ds_read_b64_tr_b16 a[172:173], v225 offset:8192
  v_mfma_f32_16x16x32_bf16 v[120:123], a[188:191], a[56:59], v[120:123]
  v_mfma_f32_16x16x32_bf16 v[124:127], a[188:191], a[60:63], v[124:127]
  ds_read_b64_tr_b16 a[174:175], v225 offset:9216
  v_mfma_f32_16x16x32_bf16 v[124:127], a[184:187], a[44:47], v[124:127]
  s_waitcnt vmcnt(26) lgkmcnt(4)
  v_mfma_f32_16x16x32_bf16 v[0:3], a[160:163], a[64:67], v[0:3]
  ds_read_b64_tr_b16 a[176:177], v226 offset:0
  v_mfma_f32_16x16x32_bf16 v[0:3], a[164:167], a[80:83], v[0:3]
  buffer_load_dwordx4 a[32:35], v242, s[24:27], s30 offen offset:0
  v_mfma_f32_16x16x32_bf16 v[4:7], a[164:167], a[84:87], v[4:7]
  ds_read_b64_tr_b16 a[178:179], v226 offset:1024
  v_mfma_f32_16x16x32_bf16 v[4:7], a[160:163], a[68:71], v[4:7]
  buffer_load_dwordx4 a[36:39], v242, s[24:27], s30 offen offset:1024
  v_mfma_f32_16x16x32_bf16 v[8:11], a[160:163], a[72:75], v[8:11]
  ds_read_b64_tr_b16 a[180:181], v226 offset:8192
  v_mfma_f32_16x16x32_bf16 v[8:11], a[164:167], a[88:91], v[8:11]
  buffer_load_dwordx4 a[40:43], v242, s[24:27], s30 offen offset:2048
  v_mfma_f32_16x16x32_bf16 v[12:15], a[164:167], a[92:95], v[12:15]
  ds_read_b64_tr_b16 a[182:183], v226 offset:9216
  v_mfma_f32_16x16x32_bf16 v[12:15], a[160:163], a[76:79], v[12:15]
  s_waitcnt lgkmcnt(4)
  v_mfma_f32_16x16x32_bf16 v[16:19], a[168:171], a[64:67], v[16:19]
  ds_read_b64_tr_b16 a[184:185], v227 offset:0
  v_mfma_f32_16x16x32_bf16 v[16:19], a[172:175], a[80:83], v[16:19]
  buffer_load_dwordx4 a[44:47], v242, s[24:27], s30 offen offset:3072
  v_mfma_f32_16x16x32_bf16 v[20:23], a[172:175], a[84:87], v[20:23]
  ds_read_b64_tr_b16 a[186:187], v227 offset:1024
  v_mfma_f32_16x16x32_bf16 v[20:23], a[168:171], a[68:71], v[20:23]
  buffer_load_dwordx4 a[48:51], v243, s[24:27], s30 offen offset:0
  v_mfma_f32_16x16x32_bf16 v[24:27], a[168:171], a[72:75], v[24:27]
  ds_read_b64_tr_b16 a[188:189], v227 offset:8192
  v_mfma_f32_16x16x32_bf16 v[24:27], a[172:175], a[88:91], v[24:27]
  buffer_load_dwordx4 a[52:55], v243, s[24:27], s30 offen offset:1024
  v_mfma_f32_16x16x32_bf16 v[28:31], a[172:175], a[92:95], v[28:31]
  ds_read_b64_tr_b16 a[190:191], v227 offset:9216
  v_mfma_f32_16x16x32_bf16 v[28:31], a[168:171], a[76:79], v[28:31]
  s_waitcnt lgkmcnt(4)
  v_mfma_f32_16x16x32_bf16 v[32:35], a[176:179], a[64:67], v[32:35]
  ds_read_b64_tr_b16 a[160:161], v228 offset:0
  v_mfma_f32_16x16x32_bf16 v[32:35], a[180:183], a[80:83], v[32:35]
  buffer_load_dwordx4 a[56:59], v243, s[24:27], s30 offen offset:2048
  v_mfma_f32_16x16x32_bf16 v[36:39], a[180:183], a[84:87], v[36:39]
  ds_read_b64_tr_b16 a[162:163], v228 offset:1024
  v_mfma_f32_16x16x32_bf16 v[36:39], a[176:179], a[68:71], v[36:39]
  buffer_load_dwordx4 a[60:63], v243, s[24:27], s30 offen offset:3072
  v_mfma_f32_16x16x32_bf16 v[40:43], a[176:179], a[72:75], v[40:43]
  ds_read_b64_tr_b16 a[164:165], v228 offset:8192
  v_mfma_f32_16x16x32_bf16 v[40:43], a[180:183], a[88:91], v[40:43]
  s_add_u32 s30, s30, 8192
  v_mfma_f32_16x16x32_bf16 v[44:47], a[180:183], a[92:95], v[44:47]
  ds_read_b64_tr_b16 a[166:167], v228 offset:9216
  v_mfma_f32_16x16x32_bf16 v[44:47], a[176:179], a[76:79], v[44:47]
  s_waitcnt lgkmcnt(4)
  v_mfma_f32_16x16x32_bf16 v[48:51], a[184:187], a[64:67], v[48:51]
  ds_read_b64_tr_b16 a[168:169], v229 offset:0
  v_mfma_f32_16x16x32_bf16 v[48:51], a[188:191], a[80:83], v[48:51]
  v_mfma_f32_16x16x32_bf16 v[52:55], a[188:191], a[84:87], v[52:55]
  ds_read_b64_tr_b16 a[170:171], v229 offset:1024
  v_mfma_f32_16x16x32_bf16 v[52:55], a[184:187], a[68:71], v[52:55]
  v_mfma_f32_16x16x32_bf16 v[56:59], a[184:187], a[72:75], v[56:59]
  ds_read_b64_tr_b16 a[172:173], v229 offset:8192
  v_mfma_f32_16x16x32_bf16 v[56:59], a[188:191], a[88:91], v[56:59]
  v_mfma_f32_16x16x32_bf16 v[60:63], a[188:191], a[92:95], v[60:63]
  ds_read_b64_tr_b16 a[174:175], v229 offset:9216
  v_mfma_f32_16x16x32_bf16 v[60:63], a[184:187], a[76:79], v[60:63]
  s_waitcnt lgkmcnt(4)
  v_mfma_f32_16x16x32_bf16 v[64:67], a[160:163], a[64:67], v[64:67]
  ds_read_b64_tr_b16 a[176:177], v230 offset:0
  v_mfma_f32_16x16x32_bf16 v[64:67], a[164:167], a[80:83], v[64:67]
  v_mfma_f32_16x16x32_bf16 v[68:71], a[164:167], a[84:87], v[68:71]
  ds_read_b64_tr_b16 a[178:179], v230 offset:1024
  v_mfma_f32_16x16x32_bf16 v[68:71], a[160:163], a[68:71], v[68:71]
  v_mfma_f32_16x16x32_bf16 v[72:75], a[160:163], a[72:75], v[72:75]
  ds_read_b64_tr_b16 a[180:181], v230 offset:8192
  v_mfma_f32_16x16x32_bf16 v[72:75], a[164:167], a[88:91], v[72:75]
  v_mfma_f32_16x16x32_bf16 v[76:79], a[164:167], a[92:95], v[76:79]
  ds_read_b64_tr_b16 a[182:183], v230 offset:9216
  v_mfma_f32_16x16x32_bf16 v[76:79], a[160:163], a[76:79], v[76:79]
  s_waitcnt lgkmcnt(4)
  v_mfma_f32_16x16x32_bf16 v[80:83], a[168:171], a[64:67], v[80:83]
  ds_read_b64_tr_b16 a[184:185], v231 offset:0
  v_mfma_f32_16x16x32_bf16 v[80:83], a[172:175], a[80:83], v[80:83]
  v_mfma_f32_16x16x32_bf16 v[84:87], a[172:175], a[84:87], v[84:87]
  ds_read_b64_tr_b16 a[186:187], v231 offset:1024
  v_mfma_f32_16x16x32_bf16 v[84:87], a[168:171], a[68:71], v[84:87]
  s_waitcnt vmcnt(30)
  v_mfma_f32_16x16x32_bf16 v[88:91], a[168:171], a[72:75], v[88:91]
  ds_read_b64_tr_b16 a[188:189], v231 offset:8192
  v_mfma_f32_16x16x32_bf16 v[88:91], a[172:175], a[88:91], v[88:91]
  s_barrier
  v_mfma_f32_16x16x32_bf16 v[92:95], a[172:175], a[92:95], v[92:95]
  ds_read_b64_tr_b16 a[190:191], v231 offset:9216
  v_mfma_f32_16x16x32_bf16 v[92:95], a[168:171], a[76:79], v[92:95]
  s_waitcnt lgkmcnt(4)
  s_add_u32 m0, s28, 114688
  v_mfma_f32_16x16x32_bf16 v[96:99], a[176:179], a[64:67], v[96:99]
  ds_read_b64_tr_b16 a[160:161], v224 offset:16384
  v_mfma_f32_16x16x32_bf16 v[96:99], a[180:183], a[80:83], v[96:99]
  buffer_load_dwordx4 v238, s[20:23], s31 offen offset:0 lds
  v_mfma_f32_16x16x32_bf16 v[100:103], a[180:183], a[84:87], v[100:103]
  ds_read_b64_tr_b16 a[162:163], v224 offset:17408
  v_mfma_f32_16x16x32_bf16 v[100:103], a[176:179], a[68:71], v[100:103]
  buffer_load_dwordx4 v239, s[20:23], s31 offen offset:1024 lds
  v_mfma_f32_16x16x32_bf16 v[104:107], a[176:179], a[72:75], v[104:107]
  ds_read_b64_tr_b16 a[164:165], v224 offset:24576
  v_mfma_f32_16x16x32_bf16 v[104:107], a[180:183], a[88:91], v[104:107]
  buffer_load_dwordx4 v240, s[20:23], s31 offen offset:2048 lds
  v_mfma_f32_16x16x32_bf16 v[108:111], a[180:183], a[92:95], v[108:111]
  ds_read_b64_tr_b16 a[166:167], v224 offset:25600
  v_mfma_f32_16x16x32_bf16 v[108:111], a[176:179], a[76:79], v[108:111]
  s_waitcnt lgkmcnt(4)
  v_mfma_f32_16x16x32_bf16 v[112:115], a[184:187], a[64:67], v[112:115]
  ds_read_b64_tr_b16 a[168:169], v225 offset:16384
  v_mfma_f32_16x16x32_bf16 v[112:115], a[188:191], a[80:83], v[112:115]
  buffer_load_dwordx4 v241, s[20:23], s31 offen offset:3072 lds
  v_mfma_f32_16x16x32_bf16 v[116:119], a[188:191], a[84:87], v[116:119]
  ds_read_b64_tr_b16 a[170:171], v225 offset:17408
  v_mfma_f32_16x16x32_bf16 v[116:119], a[184:187], a[68:71], v[116:119]
  s_add_u32 s31, s31, 0x80000
  v_mfma_f32_16x16x32_bf16 v[120:123], a[184:187], a[72:75], v[120:123]
  ds_read_b64_tr_b16 a[172:173], v225 offset:24576
  v_mfma_f32_16x16x32_bf16 v[120:123], a[188:191], a[88:91], v[120:123]
  v_mfma_f32_16x16x32_bf16 v[124:127], a[188:191], a[92:95], v[124:127]
  ds_read_b64_tr_b16 a[174:175], v225 offset:25600
  v_mfma_f32_16x16x32_bf16 v[124:127], a[184:187], a[76:79], v[124:127]
  s_waitcnt vmcnt(26) lgkmcnt(4)
  v_mfma_f32_16x16x32_bf16 v[0:3], a[160:163], a[96:99], v[0:3]
  ds_read_b64_tr_b16 a[176:177], v226 offset:16384
  v_mfma_f32_16x16x32_bf16 v[0:3], a[164:167], a[112:115], v[0:3]
  buffer_load_dwordx4 a[64:67], v242, s[24:27], s30 offen offset:0
  v_mfma_f32_16x16x32_bf16 v[4:7], a[164:167], a[116:119], v[4:7]
  ds_read_b64_tr_b16 a[178:179], v226 offset:17408
  v_mfma_f32_16x16x32_bf16 v[4:7], a[160:163], a[100:103], v[4:7]
  buffer_load_dwordx4 a[68:71], v242, s[24:27], s30 offen offset:1024
  v_mfma_f32_16x16x32_bf16 v[8:11], a[160:163], a[104:107], v[8:11]
  ds_read_b64_tr_b16 a[180:181], v226 offset:24576
  v_mfma_f32_16x16x32_bf16 v[8:11], a[164:167], a[120:123], v[8:11]
  buffer_load_dwordx4 a[72:75], v242, s[24:27], s30 offen offset:2048
  v_mfma_f32_16x16x32_bf16 v[12:15], a[164:167], a[124:127], v[12:15]
  ds_read_b64_tr_b16 a[182:183], v226 offset:25600
  v_mfma_f32_16x16x32_bf16 v[12:15], a[160:163], a[108:111], v[12:15]
  s_waitcnt lgkmcnt(4)
  v_mfma_f32_16x16x32_bf16 v[16:19], a[168:171], a[96:99], v[16:19]
  ds_read_b64_tr_b16 a[184:185], v227 offset:16384
  v_mfma_f32_16x16x32_bf16 v[16:19], a[172:175], a[112:115], v[16:19]
  buffer_load_dwordx4 a[76:79], v242, s[24:27], s30 offen offset:3072
  v_mfma_f32_16x16x32_bf16 v[20:23], a[172:175], a[116:119], v[20:23]
  ds_read_b64_tr_b16 a[186:187], v227 offset:17408
  v_mfma_f32_16x16x32_bf16 v[20:23], a[168:171], a[100:103], v[20:23]
  buffer_load_dwordx4 a[80:83], v243, s[24:27], s30 offen offset:0
  v_mfma_f32_16x16x32_bf16 v[24:27], a[168:171], a[104:107], v[24:27]
  ds_read_b64_tr_b16 a[188:189], v227 offset:24576
  v_mfma_f32_16x16x32_bf16 v[24:27], a[172:175], a[120:123], v[24:27]
  buffer_load_dwordx4 a[84:87], v243, s[24:27], s30 offen offset:1024
  v_mfma_f32_16x16x32_bf16 v[28:31], a[172:175], a[124:127], v[28:31]
  ds_read_b64_tr_b16 a[190:191], v227 offset:25600
  v_mfma_f32_16x16x32_bf16 v[28:31], a[168:171], a[108:111], v[28:31]
  s_waitcnt lgkmcnt(4)
  v_mfma_f32_16x16x32_bf16 v[32:35], a[176:179], a[96:99], v[32:35]
  ds_read_b64_tr_b16 a[160:161], v228 offset:16384
  v_mfma_f32_16x16x32_bf16 v[32:35], a[180:183], a[112:115], v[32:35]
  buffer_load_dwordx4 a[88:91], v243, s[24:27], s30 offen offset:2048
  v_mfma_f32_16x16x32_bf16 v[36:39], a[180:183], a[116:119], v[36:39]
  ds_read_b64_tr_b16 a[162:163], v228 offset:17408
  v_mfma_f32_16x16x32_bf16 v[36:39], a[176:179], a[100:103], v[36:39]
  buffer_load_dwordx4 a[92:95], v243, s[24:27], s30 offen offset:3072
  v_mfma_f32_16x16x32_bf16 v[40:43], a[176:179], a[104:107], v[40:43]
  ds_read_b64_tr_b16 a[164:165], v228 offset:24576
  v_mfma_f32_16x16x32_bf16 v[40:43], a[180:183], a[120:123], v[40:43]
  s_add_u32 s30, s30, 8192
  v_mfma_f32_16x16x32_bf16 v[44:47], a[180:183], a[124:127], v[44:47]
  ds_read_b64_tr_b16 a[166:167], v228 offset:25600
  v_mfma_f32_16x16x32_bf16 v[44:47], a[176:179], a[108:111], v[44:47]
  s_waitcnt lgkmcnt(4)
  v_mfma_f32_16x16x32_bf16 v[48:51], a[184:187], a[96:99], v[48:51]
  ds_read_b64_tr_b16 a[168:169], v229 offset:16384
  v_mfma_f32_16x16x32_bf16 v[48:51], a[188:191], a[112:115], v[48:51]
  v_mfma_f32_16x16x32_bf16 v[52:55], a[188:191], a[116:119], v[52:55]
  ds_read_b64_tr_b16 a[170:171], v229 offset:17408
  v_mfma_f32_16x16x32_bf16 v[52:55], a[184:187], a[100:103], v[52:55]
  v_mfma_f32_16x16x32_bf16 v[56:59], a[184:187], a[104:107], v[56:59]
  ds_read_b64_tr_b16 a[172:173], v229 offset:24576
  v_mfma_f32_16x16x32_bf16 v[56:59], a[188:191], a[120:123], v[56:59]
  v_mfma_f32_16x16x32_bf16 v[60:63], a[188:191], a[124:127], v[60:63]
  ds_read_b64_tr_b16 a[174:175], v229 offset:25600
  v_mfma_f32_16x16x32_bf16 v[60:63], a[184:187], a[108:111], v[60:63]
  s_waitcnt lgkmcnt(4)
  v_mfma_f32_16x16x32_bf16 v[64:67], a[160:163], a[96:99], v[64:67]
  ds_read_b64_tr_b16 a[176:177], v230 offset:16384
  s_waitcnt vmcnt(24)
  s_mov_b32 s51, -1
  v_sub_u32 v137, s51, v128
  v_mfma_f32_16x16x32_bf16 v[64:67], a[164:167], a[112:115], v[64:67]
  v_sub_u32 v138, s51, v129
  v_min_u32 v136, v137, v138
  v_mfma_f32_16x16x32_bf16 v[68:71], a[164:167], a[116:119], v[68:71]
  ds_read_b64_tr_b16 a[178:179], v230 offset:17408
  v_sub_u32 v139, s51, v130
  v_mfma_f32_16x16x32_bf16 v[68:71], a[160:163], a[100:103], v[68:71]
  v_sub_u32 v140, s51, v131
  v_min3_u32 v136, v136, v139, v140
  v_mfma_f32_16x16x32_bf16 v[72:75], a[160:163], a[104:107], v[72:75]
  ds_read_b64_tr_b16 a[180:181], v230 offset:24576
  v_sub_u32 v137, s51, v132
  v_mfma_f32_16x16x32_bf16 v[72:75], a[164:167], a[120:123], v[72:75]
  v_sub_u32 v138, s51, v133
  v_min3_u32 v136, v136, v137, v138
  v_mfma_f32_16x16x32_bf16 v[76:79], a[164:167], a[124:127], v[76:79]
  ds_read_b64_tr_b16 a[182:183], v230 offset:25600
  v_sub_u32 v139, s51, v134
  v_mfma_f32_16x16x32_bf16 v[76:79], a[160:163], a[108:111], v[76:79]
  s_waitcnt lgkmcnt(4)
  v_sub_u32 v140, s51, v135
  v_min3_u32 v136, v136, v139, v140
  v_mfma_f32_16x16x32_bf16 v[80:83], a[168:171], a[96:99], v[80:83]
  ds_read_b64_tr_b16 a[184:185], v231 offset:16384
  v_min_u32_dpp v136, v136, v136 row_ror:8 row_mask:0xf bank_mask:0xf
  v_mfma_f32_16x16x32_bf16 v[80:83], a[172:175], a[112:115], v[80:83]
  v_mfma_f32_16x16x32_bf16 v[84:87], a[172:175], a[116:119], v[84:87]
  ds_read_b64_tr_b16 a[186:187], v231 offset:17408
  v_min_u32_dpp v136, v136, v136 row_ror:4 row_mask:0xf bank_mask:0xf
  v_mfma_f32_16x16x32_bf16 v[84:87], a[168:171], a[100:103], v[84:87]
  s_waitcnt vmcnt(20)
  v_min_u32_dpp v136, v136, v136 row_ror:2 row_mask:0xf bank_mask:0xf
  v_mfma_f32_16x16x32_bf16 v[88:91], a[168:171], a[104:107], v[88:91]
  ds_read_b64_tr_b16 a[188:189], v231 offset:24576
  v_min_u32_dpp v136, v136, v136 row_ror:1 row_mask:0xf bank_mask:0xf
  v_mfma_f32_16x16x32_bf16 v[88:91], a[172:175], a[120:123], v[88:91]
  s_barrier
  v_readlane_b32 s98, v136, 0
  v_readlane_b32 s99, v136, 16
  v_mfma_f32_16x16x32_bf16 v[92:95], a[172:175], a[124:127], v[92:95]
  ds_read_b64_tr_b16 a[190:191], v231 offset:25600
  v_readlane_b32 s100, v136, 32
  v_mfma_f32_16x16x32_bf16 v[92:95], a[168:171], a[108:111], v[92:95]
  s_waitcnt lgkmcnt(4)
  s_add_u32 m0, s28, 65536
  v_readlane_b32 s101, v136, 48
  v_mfma_f32_16x16x32_bf16 v[96:99], a[176:179], a[96:99], v[96:99]
  ds_read_b64_tr_b16 a[160:161], v224 offset:32768
  s_min_u32 s98, s98, s99
  s_min_u32 s100, s100, s101
  s_min_u32 s98, s98, s100
  s_sub_u32 s52, s51, s98
  s_sub_u32 s51, s52, 1
  v_sub_u32 v137, s51, v128
  v_mfma_f32_16x16x32_bf16 v[96:99], a[180:183], a[112:115], v[96:99]
  buffer_load_dwordx4 v238, s[20:23], s31 offen offset:0 lds
  v_mfma_f32_16x16x32_bf16 v[100:103], a[180:183], a[116:119], v[100:103]
  ds_read_b64_tr_b16 a[162:163], v224 offset:33792
  v_sub_u32 v138, s51, v129
  v_mfma_f32_16x16x32_bf16 v[100:103], a[176:179], a[100:103], v[100:103]
  buffer_load_dwordx4 v239, s[20:23], s31 offen offset:1024 lds
  v_mfma_f32_16x16x32_bf16 v[104:107], a[176:179], a[104:107], v[104:107]
  ds_read_b64_tr_b16 a[164:165], v224 offset:40960
  v_min_u32 v136, v137, v138
  v_mfma_f32_16x16x32_bf16 v[104:107], a[180:183], a[120:123], v[104:107]
  buffer_load_dwordx4 v240, s[20:23], s31 offen offset:2048 lds
  v_mfma_f32_16x16x32_bf16 v[108:111], a[180:183], a[124:127], v[108:111]
  ds_read_b64_tr_b16 a[166:167], v224 offset:41984
  v_sub_u32 v139, s51, v130
  v_mfma_f32_16x16x32_bf16 v[108:111], a[176:179], a[108:111], v[108:111]
  s_waitcnt lgkmcnt(4)
  v_sub_u32 v140, s51, v131
  v_min3_u32 v136, v136, v139, v140
  v_mfma_f32_16x16x32_bf16 v[112:115], a[184:187], a[96:99], v[112:115]
  ds_read_b64_tr_b16 a[168:169], v225 offset:32768
  v_sub_u32 v137, s51, v132
  v_mfma_f32_16x16x32_bf16 v[112:115], a[188:191], a[112:115], v[112:115]
  buffer_load_dwordx4 v241, s[20:23], s31 offen offset:3072 lds
  v_mfma_f32_16x16x32_bf16 v[116:119], a[188:191], a[116:119], v[116:119]
  ds_read_b64_tr_b16 a[170:171], v225 offset:33792
  v_sub_u32 v138, s51, v133
  v_mfma_f32_16x16x32_bf16 v[116:119], a[184:187], a[100:103], v[116:119]
  s_add_u32 s31, s31, 0x80000
  v_min3_u32 v136, v136, v137, v138
  v_sub_u32 v139, s51, v134
  v_mfma_f32_16x16x32_bf16 v[120:123], a[184:187], a[104:107], v[120:123]
  ds_read_b64_tr_b16 a[172:173], v225 offset:40960
  v_sub_u32 v140, s51, v135
  v_mfma_f32_16x16x32_bf16 v[120:123], a[188:191], a[120:123], v[120:123]
  v_min3_u32 v136, v136, v139, v140
  v_mfma_f32_16x16x32_bf16 v[124:127], a[188:191], a[124:127], v[124:127]
  ds_read_b64_tr_b16 a[174:175], v225 offset:41984
  v_min_u32_dpp v136, v136, v136 row_ror:8 row_mask:0xf bank_mask:0xf
  v_mfma_f32_16x16x32_bf16 v[124:127], a[184:187], a[108:111], v[124:127]
  s_waitcnt lgkmcnt(4)
  v_min_u32_dpp v136, v136, v136 row_ror:4 row_mask:0xf bank_mask:0xf
  v_mfma_f32_16x16x32_bf16 v[0:3], a[160:163], a[0:3], v[0:3]
  ds_read_b64_tr_b16 a[176:177], v226 offset:32768
  v_mfma_f32_16x16x32_bf16 v[0:3], a[164:167], a[16:19], v[0:3]
  buffer_load_dwordx4 a[96:99], v242, s[24:27], s30 offen offset:0
  v_mfma_f32_16x16x32_bf16 v[4:7], a[164:167], a[20:23], v[4:7]
  ds_read_b64_tr_b16 a[178:179], v226 offset:33792
  v_mfma_f32_16x16x32_bf16 v[4:7], a[160:163], a[4:7], v[4:7]
  buffer_load_dwordx4 a[100:103], v242, s[24:27], s30 offen offset:1024
  v_mfma_f32_16x16x32_bf16 v[8:11], a[160:163], a[8:11], v[8:11]
  ds_read_b64_tr_b16 a[180:181], v226 offset:40960
  v_mfma_f32_16x16x32_bf16 v[8:11], a[164:167], a[24:27], v[8:11]
  buffer_load_dwordx4 a[104:107], v242, s[24:27], s30 offen offset:2048
  v_mfma_f32_16x16x32_bf16 v[12:15], a[164:167], a[28:31], v[12:15]
  ds_read_b64_tr_b16 a[182:183], v226 offset:41984
  v_mfma_f32_16x16x32_bf16 v[12:15], a[160:163], a[12:15], v[12:15]
  s_waitcnt lgkmcnt(4)
  v_mfma_f32_16x16x32_bf16 v[16:19], a[168:171], a[0:3], v[16:19]
  ds_read_b64_tr_b16 a[184:185], v227 offset:32768
  v_mfma_f32_16x16x32_bf16 v[16:19], a[172:175], a[16:19], v[16:19]
  buffer_load_dwordx4 a[108:111], v242, s[24:27], s30 offen offset:3072
  v_mfma_f32_16x16x32_bf16 v[20:23], a[172:175], a[20:23], v[20:23]
  ds_read_b64_tr_b16 a[186:187], v227 offset:33792
  v_mfma_f32_16x16x32_bf16 v[20:23], a[168:171], a[4:7], v[20:23]
  buffer_load_dwordx4 a[112:115], v243, s[24:27], s30 offen offset:0
  v_mfma_f32_16x16x32_bf16 v[24:27], a[168:171], a[8:11], v[24:27]
  ds_read_b64_tr_b16 a[188:189], v227 offset:40960
  v_mfma_f32_16x16x32_bf16 v[24:27], a[172:175], a[24:27], v[24:27]
  buffer_load_dwordx4 a[116:119], v243, s[24:27], s30 offen offset:1024
  v_mfma_f32_16x16x32_bf16 v[28:31], a[172:175], a[28:31], v[28:31]
  ds_read_b64_tr_b16 a[190:191], v227 offset:41984
  v_mfma_f32_16x16x32_bf16 v[28:31], a[168:171], a[12:15], v[28:31]
  s_waitcnt lgkmcnt(4)
  v_mfma_f32_16x16x32_bf16 v[32:35], a[176:179], a[0:3], v[32:35]
  ds_read_b64_tr_b16 a[160:161], v228 offset:32768
  v_mfma_f32_16x16x32_bf16 v[32:35], a[180:183], a[16:19], v[32:35]
  buffer_load_dwordx4 a[120:123], v243, s[24:27], s30 offen offset:2048
  v_mfma_f32_16x16x32_bf16 v[36:39], a[180:183], a[20:23], v[36:39]
  ds_read_b64_tr_b16 a[162:163], v228 offset:33792
  v_mfma_f32_16x16x32_bf16 v[36:39], a[176:179], a[4:7], v[36:39]
  buffer_load_dwordx4 a[124:127], v243, s[24:27], s30 offen offset:3072
  v_mfma_f32_16x16x32_bf16 v[40:43], a[176:179], a[8:11], v[40:43]
  ds_read_b64_tr_b16 a[164:165], v228 offset:40960
  v_mfma_f32_16x16x32_bf16 v[40:43], a[180:183], a[24:27], v[40:43]
  s_add_u32 s30, s30, 8192
  v_mfma_f32_16x16x32_bf16 v[44:47], a[180:183], a[28:31], v[44:47]
  ds_read_b64_tr_b16 a[166:167], v228 offset:41984
  v_mfma_f32_16x16x32_bf16 v[44:47], a[176:179], a[12:15], v[44:47]
  s_waitcnt lgkmcnt(4)
  v_mfma_f32_16x16x32_bf16 v[48:51], a[184:187], a[0:3], v[48:51]
  ds_read_b64_tr_b16 a[168:169], v229 offset:32768
  v_mfma_f32_16x16x32_bf16 v[48:51], a[188:191], a[16:19], v[48:51]
  v_mfma_f32_16x16x32_bf16 v[52:55], a[188:191], a[20:23], v[52:55]
  ds_read_b64_tr_b16 a[170:171], v229 offset:33792
  v_mfma_f32_16x16x32_bf16 v[52:55], a[184:187], a[4:7], v[52:55]
  v_mfma_f32_16x16x32_bf16 v[56:59], a[184:187], a[8:11], v[56:59]
  ds_read_b64_tr_b16 a[172:173], v229 offset:40960
  v_mfma_f32_16x16x32_bf16 v[56:59], a[188:191], a[24:27], v[56:59]
  v_mfma_f32_16x16x32_bf16 v[60:63], a[188:191], a[28:31], v[60:63]
  ds_read_b64_tr_b16 a[174:175], v229 offset:41984
  v_mfma_f32_16x16x32_bf16 v[60:63], a[184:187], a[12:15], v[60:63]
  s_waitcnt lgkmcnt(4)
  v_mfma_f32_16x16x32_bf16 v[64:67], a[160:163], a[0:3], v[64:67]
  ds_read_b64_tr_b16 a[176:177], v230 offset:32768
  v_min_u32_dpp v136, v136, v136 row_ror:2 row_mask:0xf bank_mask:0xf
  v_mfma_f32_16x16x32_bf16 v[64:67], a[164:167], a[16:19], v[64:67]
  v_mfma_f32_16x16x32_bf16 v[68:71], a[164:167], a[20:23], v[68:71]
  ds_read_b64_tr_b16 a[178:179], v230 offset:33792
  v_min_u32_dpp v136, v136, v136 row_ror:1 row_mask:0xf bank_mask:0xf
  v_mfma_f32_16x16x32_bf16 v[68:71], a[160:163], a[4:7], v[68:71]
  v_readlane_b32 s98, v136, 0
  v_readlane_b32 s99, v136, 16
  v_mfma_f32_16x16x32_bf16 v[72:75], a[160:163], a[8:11], v[72:75]
  ds_read_b64_tr_b16 a[180:181], v230 offset:40960
  v_readlane_b32 s100, v136, 32
  v_mfma_f32_16x16x32_bf16 v[72:75], a[164:167], a[24:27], v[72:75]
  v_readlane_b32 s101, v136, 48
  v_mfma_f32_16x16x32_bf16 v[76:79], a[164:167], a[28:31], v[76:79]
  ds_read_b64_tr_b16 a[182:183], v230 offset:41984
  s_min_u32 s98, s98, s99
  s_min_u32 s100, s100, s101
  s_min_u32 s98, s98, s100
  s_sub_u32 s53, s51, s98
  s_sub_u32 s51, s53, 1
  v_sub_u32 v137, s51, v128
  v_mfma_f32_16x16x32_bf16 v[76:79], a[160:163], a[12:15], v[76:79]
  s_waitcnt lgkmcnt(4)
  v_sub_u32 v138, s51, v129
  v_min_u32 v136, v137, v138
  v_mfma_f32_16x16x32_bf16 v[80:83], a[168:171], a[0:3], v[80:83]
  ds_read_b64_tr_b16 a[184:185], v231 offset:32768
  v_sub_u32 v139, s51, v130
  v_mfma_f32_16x16x32_bf16 v[80:83], a[172:175], a[16:19], v[80:83]
  v_sub_u32 v140, s51, v131
  v_min3_u32 v136, v136, v139, v140
  v_mfma_f32_16x16x32_bf16 v[84:87], a[172:175], a[20:23], v[84:87]
  ds_read_b64_tr_b16 a[186:187], v231 offset:33792
  v_sub_u32 v137, s51, v132
  v_mfma_f32_16x16x32_bf16 v[84:87], a[168:171], a[4:7], v[84:87]
  s_waitcnt vmcnt(20)
  v_sub_u32 v138, s51, v133
  v_min3_u32 v136, v136, v137, v138
  v_mfma_f32_16x16x32_bf16 v[88:91], a[168:171], a[8:11], v[88:91]
  ds_read_b64_tr_b16 a[188:189], v231 offset:40960
  v_sub_u32 v139, s51, v134
  v_mfma_f32_16x16x32_bf16 v[88:91], a[172:175], a[24:27], v[88:91]
  s_barrier
  v_sub_u32 v140, s51, v135
  v_min3_u32 v136, v136, v139, v140
  v_mfma_f32_16x16x32_bf16 v[92:95], a[172:175], a[28:31], v[92:95]
  ds_read_b64_tr_b16 a[190:191], v231 offset:41984
  v_min_u32_dpp v136, v136, v136 row_ror:8 row_mask:0xf bank_mask:0xf
  v_mfma_f32_16x16x32_bf16 v[92:95], a[168:171], a[12:15], v[92:95]
  s_waitcnt lgkmcnt(4)
  s_add_u32 m0, s28, 81920
  v_min_u32_dpp v136, v136, v136 row_ror:4 row_mask:0xf bank_mask:0xf
  v_mfma_f32_16x16x32_bf16 v[96:99], a[176:179], a[0:3], v[96:99]
  ds_read_b64_tr_b16 a[160:161], v224 offset:49152
  v_min_u32_dpp v136, v136, v136 row_ror:2 row_mask:0xf bank_mask:0xf
  v_mfma_f32_16x16x32_bf16 v[96:99], a[180:183], a[16:19], v[96:99]
  buffer_load_dwordx4 v238, s[20:23], s31 offen offset:0 lds
  v_mfma_f32_16x16x32_bf16 v[100:103], a[180:183], a[20:23], v[100:103]
  ds_read_b64_tr_b16 a[162:163], v224 offset:50176
  v_min_u32_dpp v136, v136, v136 row_ror:1 row_mask:0xf bank_mask:0xf
  v_mfma_f32_16x16x32_bf16 v[100:103], a[176:179], a[4:7], v[100:103]
  buffer_load_dwordx4 v239, s[20:23], s31 offen offset:1024 lds
  v_mfma_f32_16x16x32_bf16 v[104:107], a[176:179], a[8:11], v[104:107]
  ds_read_b64_tr_b16 a[164:165], v224 offset:57344
  v_readlane_b32 s98, v136, 0
  v_mfma_f32_16x16x32_bf16 v[104:107], a[180:183], a[24:27], v[104:107]
  buffer_load_dwordx4 v240, s[20:23], s31 offen offset:2048 lds
  v_mfma_f32_16x16x32_bf16 v[108:111], a[180:183], a[28:31], v[108:111]
  ds_read_b64_tr_b16 a[166:167], v224 offset:58368
  v_readlane_b32 s99, v136, 16
  v_mfma_f32_16x16x32_bf16 v[108:111], a[176:179], a[12:15], v[108:111]
  s_waitcnt lgkmcnt(4)
  v_readlane_b32 s100, v136, 32
  v_readlane_b32 s101, v136, 48
  v_mfma_f32_16x16x32_bf16 v[112:115], a[184:187], a[0:3], v[112:115]
  ds_read_b64_tr_b16 a[168:169], v225 offset:49152
  s_min_u32 s98, s98, s99
  s_min_u32 s100, s100, s101
  s_min_u32 s98, s98, s100
  s_sub_u32 s54, s51, s98
  s_sub_u32 s51, s54, 1
  v_sub_u32 v137, s51, v128
  v_mfma_f32_16x16x32_bf16 v[112:115], a[188:191], a[16:19], v[112:115]
  buffer_load_dwordx4 v241, s[20:23], s31 offen offset:3072 lds
  v_mfma_f32_16x16x32_bf16 v[116:119], a[188:191], a[20:23], v[116:119]
  ds_read_b64_tr_b16 a[170:171], v225 offset:50176
  v_sub_u32 v138, s51, v129
  v_mfma_f32_16x16x32_bf16 v[116:119], a[184:187], a[4:7], v[116:119]
  s_add_u32 s31, s31, 0x80000
  v_min_u32 v136, v137, v138
  v_sub_u32 v139, s51, v130
  v_mfma_f32_16x16x32_bf16 v[120:123], a[184:187], a[8:11], v[120:123]
  ds_read_b64_tr_b16 a[172:173], v225 offset:57344
  v_sub_u32 v140, s51, v131
  v_mfma_f32_16x16x32_bf16 v[120:123], a[188:191], a[24:27], v[120:123]
  v_min3_u32 v136, v136, v139, v140
  v_sub_u32 v137, s51, v132
  v_mfma_f32_16x16x32_bf16 v[124:127], a[188:191], a[28:31], v[124:127]
  ds_read_b64_tr_b16 a[174:175], v225 offset:58368
  v_sub_u32 v138, s51, v133
  v_mfma_f32_16x16x32_bf16 v[124:127], a[184:187], a[12:15], v[124:127]
  s_waitcnt lgkmcnt(4)
  v_min3_u32 v136, v136, v137, v138
  v_sub_u32 v139, s51, v134
  v_mfma_f32_16x16x32_bf16 v[0:3], a[160:163], a[32:35], v[0:3]
  ds_read_b64_tr_b16 a[176:177], v226 offset:49152
  v_mfma_f32_16x16x32_bf16 v[0:3], a[164:167], a[48:51], v[0:3]
  buffer_load_dwordx4 a[0:3], v242, s[24:27], s30 offen offset:0
  v_mfma_f32_16x16x32_bf16 v[4:7], a[164:167], a[52:55], v[4:7]
  ds_read_b64_tr_b16 a[178:179], v226 offset:50176
  v_mfma_f32_16x16x32_bf16 v[4:7], a[160:163], a[36:39], v[4:7]
  buffer_load_dwordx4 a[4:7], v242, s[24:27], s30 offen offset:1024
  v_mfma_f32_16x16x32_bf16 v[8:11], a[160:163], a[40:43], v[8:11]
  ds_read_b64_tr_b16 a[180:181], v226 offset:57344
  v_mfma_f32_16x16x32_bf16 v[8:11], a[164:167], a[56:59], v[8:11]
  buffer_load_dwordx4 a[8:11], v242, s[24:27], s30 offen offset:2048
  v_mfma_f32_16x16x32_bf16 v[12:15], a[164:167], a[60:63], v[12:15]
  ds_read_b64_tr_b16 a[182:183], v226 offset:58368
  v_mfma_f32_16x16x32_bf16 v[12:15], a[160:163], a[44:47], v[12:15]
  s_waitcnt lgkmcnt(4)
  v_mfma_f32_16x16x32_bf16 v[16:19], a[168:171], a[32:35], v[16:19]
  ds_read_b64_tr_b16 a[184:185], v227 offset:49152
  v_mfma_f32_16x16x32_bf16 v[16:19], a[172:175], a[48:51], v[16:19]
  buffer_load_dwordx4 a[12:15], v242, s[24:27], s30 offen offset:3072
  v_mfma_f32_16x16x32_bf16 v[20:23], a[172:175], a[52:55], v[20:23]
  ds_read_b64_tr_b16 a[186:187], v227 offset:50176
  v_mfma_f32_16x16x32_bf16 v[20:23], a[168:171], a[36:39], v[20:23]
  buffer_load_dwordx4 a[16:19], v243, s[24:27], s30 offen offset:0
  v_mfma_f32_16x16x32_bf16 v[24:27], a[168:171], a[40:43], v[24:27]
  ds_read_b64_tr_b16 a[188:189], v227 offset:57344
  v_mfma_f32_16x16x32_bf16 v[24:27], a[172:175], a[56:59], v[24:27]
  buffer_load_dwordx4 a[20:23], v243, s[24:27], s30 offen offset:1024
  v_mfma_f32_16x16x32_bf16 v[28:31], a[172:175], a[60:63], v[28:31]
  ds_read_b64_tr_b16 a[190:191], v227 offset:58368
  v_mfma_f32_16x16x32_bf16 v[28:31], a[168:171], a[44:47], v[28:31]
  s_waitcnt lgkmcnt(4)
  v_mfma_f32_16x16x32_bf16 v[32:35], a[176:179], a[32:35], v[32:35]
  ds_read_b64_tr_b16 a[160:161], v228 offset:49152
  v_mfma_f32_16x16x32_bf16 v[32:35], a[180:183], a[48:51], v[32:35]
  buffer_load_dwordx4 a[24:27], v243, s[24:27], s30 offen offset:2048
  v_mfma_f32_16x16x32_bf16 v[36:39], a[180:183], a[52:55], v[36:39]
  ds_read_b64_tr_b16 a[162:163], v228 offset:50176
  v_mfma_f32_16x16x32_bf16 v[36:39], a[176:179], a[36:39], v[36:39]
  buffer_load_dwordx4 a[28:31], v243, s[24:27], s30 offen offset:3072
  v_mfma_f32_16x16x32_bf16 v[40:43], a[176:179], a[40:43], v[40:43]
  ds_read_b64_tr_b16 a[164:165], v228 offset:57344
  v_mfma_f32_16x16x32_bf16 v[40:43], a[180:183], a[56:59], v[40:43]
  s_add_u32 s30, s30, 8192
  v_mfma_f32_16x16x32_bf16 v[44:47], a[180:183], a[60:63], v[44:47]
  ds_read_b64_tr_b16 a[166:167], v228 offset:58368
  v_mfma_f32_16x16x32_bf16 v[44:47], a[176:179], a[44:47], v[44:47]
  s_waitcnt lgkmcnt(4)
  v_mfma_f32_16x16x32_bf16 v[48:51], a[184:187], a[32:35], v[48:51]
  ds_read_b64_tr_b16 a[168:169], v229 offset:49152
  v_mfma_f32_16x16x32_bf16 v[48:51], a[188:191], a[48:51], v[48:51]
  s_add_u32 m0, s28, 0
  v_mfma_f32_16x16x32_bf16 v[52:55], a[188:191], a[52:55], v[52:55]
  ds_read_b64_tr_b16 a[170:171], v229 offset:50176
  v_mfma_f32_16x16x32_bf16 v[52:55], a[184:187], a[36:39], v[52:55]
  buffer_load_dwordx4 v232, s[12:15], s29 offen offset:0 lds
  v_mfma_f32_16x16x32_bf16 v[56:59], a[184:187], a[40:43], v[56:59]
  ds_read_b64_tr_b16 a[172:173], v229 offset:57344
  v_mfma_f32_16x16x32_bf16 v[56:59], a[188:191], a[56:59], v[56:59]
  buffer_load_dwordx4 v233, s[12:15], s29 offen offset:1024 lds
  v_mfma_f32_16x16x32_bf16 v[60:63], a[188:191], a[60:63], v[60:63]
  ds_read_b64_tr_b16 a[174:175], v229 offset:58368
  v_mfma_f32_16x16x32_bf16 v[60:63], a[184:187], a[44:47], v[60:63]
  s_waitcnt lgkmcnt(4)
  v_mfma_f32_16x16x32_bf16 v[64:67], a[160:163], a[32:35], v[64:67]
  ds_read_b64_tr_b16 a[176:177], v230 offset:49152
  v_sub_u32 v140, s51, v135
  v_mfma_f32_16x16x32_bf16 v[64:67], a[164:167], a[48:51], v[64:67]
  buffer_load_dwordx4 v234, s[12:15], s29 offen offset:2048 lds
  v_mfma_f32_16x16x32_bf16 v[68:71], a[164:167], a[52:55], v[68:71]
  ds_read_b64_tr_b16 a[178:179], v230 offset:50176
  v_min3_u32 v136, v136, v139, v140
  v_mfma_f32_16x16x32_bf16 v[68:71], a[160:163], a[36:39], v[68:71]
  buffer_load_dwordx4 v235, s[12:15], s29 offen offset:3072 lds
  v_mfma_f32_16x16x32_bf16 v[72:75], a[160:163], a[40:43], v[72:75]
  ds_read_b64_tr_b16 a[180:181], v230 offset:57344
  v_min_u32_dpp v136, v136, v136 row_ror:8 row_mask:0xf bank_mask:0xf
  v_mfma_f32_16x16x32_bf16 v[72:75], a[164:167], a[56:59], v[72:75]
  s_add_u32 s29, s29, 16384
  v_min_u32_dpp v136, v136, v136 row_ror:4 row_mask:0xf bank_mask:0xf
  v_mfma_f32_16x16x32_bf16 v[76:79], a[164:167], a[60:63], v[76:79]
  ds_read_b64_tr_b16 a[182:183], v230 offset:58368
  v_min_u32_dpp v136, v136, v136 row_ror:2 row_mask:0xf bank_mask:0xf
  v_mfma_f32_16x16x32_bf16 v[76:79], a[160:163], a[44:47], v[76:79]
  s_waitcnt lgkmcnt(4)
  v_min_u32_dpp v136, v136, v136 row_ror:1 row_mask:0xf bank_mask:0xf
  v_mfma_f32_16x16x32_bf16 v[80:83], a[168:171], a[32:35], v[80:83]
  ds_read_b64_tr_b16 a[184:185], v231 offset:49152
  v_readlane_b32 s98, v136, 0
  v_mfma_f32_16x16x32_bf16 v[80:83], a[172:175], a[48:51], v[80:83]
  v_readlane_b32 s99, v136, 16
  v_readlane_b32 s100, v136, 32
  v_mfma_f32_16x16x32_bf16 v[84:87], a[172:175], a[52:55], v[84:87]
  ds_read_b64_tr_b16 a[186:187], v231 offset:50176
  v_readlane_b32 s101, v136, 48
  v_mfma_f32_16x16x32_bf16 v[84:87], a[168:171], a[36:39], v[84:87]
  s_waitcnt vmcnt(24)
  s_min_u32 s98, s98, s99
  s_min_u32 s100, s100, s101
  s_min_u32 s98, s98, s100
  s_sub_u32 s55, s51, s98
  s_sub_u32 s51, s55, 1
  v_sub_u32 v137, s51, v128
  v_sub_u32 v138, s51, v129
  v_mfma_f32_16x16x32_bf16 v[88:91], a[168:171], a[40:43], v[88:91]
  ds_read_b64_tr_b16 a[188:189], v231 offset:57344
  v_min_u32 v136, v137, v138
  v_mfma_f32_16x16x32_bf16 v[88:91], a[172:175], a[56:59], v[88:91]
  s_barrier
  v_sub_u32 v139, s51, v130
  v_sub_u32 v140, s51, v131
  v_mfma_f32_16x16x32_bf16 v[92:95], a[172:175], a[60:63], v[92:95]
  ds_read_b64_tr_b16 a[190:191], v231 offset:58368
  v_min3_u32 v136, v136, v139, v140
  v_mfma_f32_16x16x32_bf16 v[92:95], a[168:171], a[44:47], v[92:95]
  s_waitcnt lgkmcnt(4)
  s_add_u32 m0, s28, 98304
  v_sub_u32 v137, s51, v132
  v_sub_u32 v138, s51, v133
  v_mfma_f32_16x16x32_bf16 v[96:99], a[176:179], a[32:35], v[96:99]
  ds_read_b64_tr_b16 a[160:161], v224 offset:0
  v_min3_u32 v136, v136, v137, v138
  v_mfma_f32_16x16x32_bf16 v[96:99], a[180:183], a[48:51], v[96:99]
  buffer_load_dwordx4 v238, s[20:23], s31 offen offset:0 lds
  v_mfma_f32_16x16x32_bf16 v[100:103], a[180:183], a[52:55], v[100:103]
  ds_read_b64_tr_b16 a[162:163], v224 offset:1024
  v_sub_u32 v139, s51, v134
  v_mfma_f32_16x16x32_bf16 v[100:103], a[176:179], a[36:39], v[100:103]
  buffer_load_dwordx4 v239, s[20:23], s31 offen offset:1024 lds
  v_mfma_f32_16x16x32_bf16 v[104:107], a[176:179], a[40:43], v[104:107]
  ds_read_b64_tr_b16 a[164:165], v224 offset:8192
  v_sub_u32 v140, s51, v135
  v_mfma_f32_16x16x32_bf16 v[104:107], a[180:183], a[56:59], v[104:107]
  buffer_load_dwordx4 v240, s[20:23], s31 offen offset:2048 lds
  v_mfma_f32_16x16x32_bf16 v[108:111], a[180:183], a[60:63], v[108:111]
  ds_read_b64_tr_b16 a[166:167], v224 offset:9216
  v_min3_u32 v136, v136, v139, v140
  v_mfma_f32_16x16x32_bf16 v[108:111], a[176:179], a[44:47], v[108:111]
  s_waitcnt lgkmcnt(4)
  v_min_u32_dpp v136, v136, v136 row_ror:8 row_mask:0xf bank_mask:0xf
  v_mfma_f32_16x16x32_bf16 v[112:115], a[184:187], a[32:35], v[112:115]
  ds_read_b64_tr_b16 a[168:169], v225 offset:0
  v_min_u32_dpp v136, v136, v136 row_ror:4 row_mask:0xf bank_mask:0xf
  v_mfma_f32_16x16x32_bf16 v[112:115], a[188:191], a[48:51], v[112:115]
  buffer_load_dwordx4 v241, s[20:23], s31 offen offset:3072 lds
  v_mfma_f32_16x16x32_bf16 v[116:119], a[188:191], a[52:55], v[116:119]
  ds_read_b64_tr_b16 a[170:171], v225 offset:1024
  v_min_u32_dpp v136, v136, v136 row_ror:2 row_mask:0xf bank_mask:0xf
  v_mfma_f32_16x16x32_bf16 v[116:119], a[184:187], a[36:39], v[116:119]
  s_add_u32 s31, s31, 0x80000
  v_min_u32_dpp v136, v136, v136 row_ror:1 row_mask:0xf bank_mask:0xf
  v_mfma_f32_16x16x32_bf16 v[120:123], a[184:187], a[40:43], v[120:123]
  ds_read_b64_tr_b16 a[172:173], v225 offset:8192
  v_readlane_b32 s98, v136, 0
  v_mfma_f32_16x16x32_bf16 v[120:123], a[188:191], a[56:59], v[120:123]
  v_readlane_b32 s99, v136, 16
  v_readlane_b32 s100, v136, 32
  v_mfma_f32_16x16x32_bf16 v[124:127], a[188:191], a[60:63], v[124:127]
  ds_read_b64_tr_b16 a[174:175], v225 offset:9216
  v_readlane_b32 s101, v136, 48
  v_mfma_f32_16x16x32_bf16 v[124:127], a[184:187], a[44:47], v[124:127]
  s_waitcnt lgkmcnt(4)
  s_min_u32 s98, s98, s99
  s_min_u32 s100, s100, s101
  s_min_u32 s98, s98, s100
  s_sub_u32 s56, s51, s98
  s_sub_u32 s51, s56, 1
  v_sub_u32 v137, s51, v128
  v_sub_u32 v138, s51, v129
  v_mfma_f32_16x16x32_bf16 v[0:3], a[160:163], a[64:67], v[0:3]
  ds_read_b64_tr_b16 a[176:177], v226 offset:0
  v_mfma_f32_16x16x32_bf16 v[0:3], a[164:167], a[80:83], v[0:3]
  buffer_load_dwordx4 a[32:35], v242, s[24:27], s30 offen offset:0
  v_mfma_f32_16x16x32_bf16 v[4:7], a[164:167], a[84:87], v[4:7]
  ds_read_b64_tr_b16 a[178:179], v226 offset:1024
  v_mfma_f32_16x16x32_bf16 v[4:7], a[160:163], a[68:71], v[4:7]
  buffer_load_dwordx4 a[36:39], v242, s[24:27], s30 offen offset:1024
  v_mfma_f32_16x16x32_bf16 v[8:11], a[160:163], a[72:75], v[8:11]
  ds_read_b64_tr_b16 a[180:181], v226 offset:8192
  v_mfma_f32_16x16x32_bf16 v[8:11], a[164:167], a[88:91], v[8:11]
  buffer_load_dwordx4 a[40:43], v242, s[24:27], s30 offen offset:2048
  v_mfma_f32_16x16x32_bf16 v[12:15], a[164:167], a[92:95], v[12:15]
  ds_read_b64_tr_b16 a[182:183], v226 offset:9216
  v_mfma_f32_16x16x32_bf16 v[12:15], a[160:163], a[76:79], v[12:15]
  s_waitcnt lgkmcnt(4)
  v_mfma_f32_16x16x32_bf16 v[16:19], a[168:171], a[64:67], v[16:19]
  ds_read_b64_tr_b16 a[184:185], v227 offset:0
  v_mfma_f32_16x16x32_bf16 v[16:19], a[172:175], a[80:83], v[16:19]
  buffer_load_dwordx4 a[44:47], v242, s[24:27], s30 offen offset:3072
  v_mfma_f32_16x16x32_bf16 v[20:23], a[172:175], a[84:87], v[20:23]
  ds_read_b64_tr_b16 a[186:187], v227 offset:1024
  v_mfma_f32_16x16x32_bf16 v[20:23], a[168:171], a[68:71], v[20:23]
  buffer_load_dwordx4 a[48:51], v243, s[24:27], s30 offen offset:0
  v_mfma_f32_16x16x32_bf16 v[24:27], a[168:171], a[72:75], v[24:27]
  ds_read_b64_tr_b16 a[188:189], v227 offset:8192
  v_mfma_f32_16x16x32_bf16 v[24:27], a[172:175], a[88:91], v[24:27]
  buffer_load_dwordx4 a[52:55], v243, s[24:27], s30 offen offset:1024
  v_mfma_f32_16x16x32_bf16 v[28:31], a[172:175], a[92:95], v[28:31]
  ds_read_b64_tr_b16 a[190:191], v227 offset:9216
  v_mfma_f32_16x16x32_bf16 v[28:31], a[168:171], a[76:79], v[28:31]
  s_waitcnt lgkmcnt(4)
  v_mfma_f32_16x16x32_bf16 v[32:35], a[176:179], a[64:67], v[32:35]
  ds_read_b64_tr_b16 a[160:161], v228 offset:0
  v_mfma_f32_16x16x32_bf16 v[32:35], a[180:183], a[80:83], v[32:35]
  buffer_load_dwordx4 a[56:59], v243, s[24:27], s30 offen offset:2048
  v_mfma_f32_16x16x32_bf16 v[36:39], a[180:183], a[84:87], v[36:39]
  ds_read_b64_tr_b16 a[162:163], v228 offset:1024
  v_mfma_f32_16x16x32_bf16 v[36:39], a[176:179], a[68:71], v[36:39]
  buffer_load_dwordx4 a[60:63], v243, s[24:27], s30 offen offset:3072
  v_mfma_f32_16x16x32_bf16 v[40:43], a[176:179], a[72:75], v[40:43]
  ds_read_b64_tr_b16 a[164:165], v228 offset:8192
  v_mfma_f32_16x16x32_bf16 v[40:43], a[180:183], a[88:91], v[40:43]
  s_add_u32 s30, s30, 8192
  v_mfma_f32_16x16x32_bf16 v[44:47], a[180:183], a[92:95], v[44:47]
  ds_read_b64_tr_b16 a[166:167], v228 offset:9216
  v_mfma_f32_16x16x32_bf16 v[44:47], a[176:179], a[76:79], v[44:47]
  s_waitcnt lgkmcnt(4)
  v_mfma_f32_16x16x32_bf16 v[48:51], a[184:187], a[64:67], v[48:51]
  ds_read_b64_tr_b16 a[168:169], v229 offset:0
  v_mfma_f32_16x16x32_bf16 v[48:51], a[188:191], a[80:83], v[48:51]
  s_add_u32 m0, s28, 16384
  v_mfma_f32_16x16x32_bf16 v[52:55], a[188:191], a[84:87], v[52:55]
  ds_read_b64_tr_b16 a[170:171], v229 offset:1024
  v_mfma_f32_16x16x32_bf16 v[52:55], a[184:187], a[68:71], v[52:55]
  buffer_load_dwordx4 v232, s[12:15], s29 offen offset:0 lds
  v_mfma_f32_16x16x32_bf16 v[56:59], a[184:187], a[72:75], v[56:59]
  ds_read_b64_tr_b16 a[172:173], v229 offset:8192
  v_mfma_f32_16x16x32_bf16 v[56:59], a[188:191], a[88:91], v[56:59]
  buffer_load_dwordx4 v233, s[12:15], s29 offen offset:1024 lds
  v_mfma_f32_16x16x32_bf16 v[60:63], a[188:191], a[92:95], v[60:63]
  ds_read_b64_tr_b16 a[174:175], v229 offset:9216
  v_mfma_f32_16x16x32_bf16 v[60:63], a[184:187], a[76:79], v[60:63]
  s_waitcnt lgkmcnt(4)
  v_mfma_f32_16x16x32_bf16 v[64:67], a[160:163], a[64:67], v[64:67]
  ds_read_b64_tr_b16 a[176:177], v230 offset:0
  v_min_u32 v136, v137, v138
  v_mfma_f32_16x16x32_bf16 v[64:67], a[164:167], a[80:83], v[64:67]
  buffer_load_dwordx4 v234, s[12:15], s29 offen offset:2048 lds
  v_mfma_f32_16x16x32_bf16 v[68:71], a[164:167], a[84:87], v[68:71]
  ds_read_b64_tr_b16 a[178:179], v230 offset:1024
  v_sub_u32 v139, s51, v130
  v_mfma_f32_16x16x32_bf16 v[68:71], a[160:163], a[68:71], v[68:71]
  buffer_load_dwordx4 v235, s[12:15], s29 offen offset:3072 lds
  v_mfma_f32_16x16x32_bf16 v[72:75], a[160:163], a[72:75], v[72:75]
  ds_read_b64_tr_b16 a[180:181], v230 offset:8192
  v_sub_u32 v140, s51, v131
  v_mfma_f32_16x16x32_bf16 v[72:75], a[164:167], a[88:91], v[72:75]
  s_add_u32 s29, s29, 16384
  v_min3_u32 v136, v136, v139, v140
  v_sub_u32 v137, s51, v132
  v_mfma_f32_16x16x32_bf16 v[76:79], a[164:167], a[92:95], v[76:79]
  ds_read_b64_tr_b16 a[182:183], v230 offset:9216
  v_sub_u32 v138, s51, v133
  v_mfma_f32_16x16x32_bf16 v[76:79], a[160:163], a[76:79], v[76:79]
  s_waitcnt lgkmcnt(4)
  v_min3_u32 v136, v136, v137, v138
  v_sub_u32 v139, s51, v134
  v_mfma_f32_16x16x32_bf16 v[80:83], a[168:171], a[64:67], v[80:83]
  ds_read_b64_tr_b16 a[184:185], v231 offset:0
  v_sub_u32 v140, s51, v135
  v_mfma_f32_16x16x32_bf16 v[80:83], a[172:175], a[80:83], v[80:83]
  v_min3_u32 v136, v136, v139, v140
  v_mfma_f32_16x16x32_bf16 v[84:87], a[172:175], a[84:87], v[84:87]
  ds_read_b64_tr_b16 a[186:187], v231 offset:1024
  v_min_u32_dpp v136, v136, v136 row_ror:8 row_mask:0xf bank_mask:0xf
  v_mfma_f32_16x16x32_bf16 v[84:87], a[168:171], a[68:71], v[84:87]
  s_waitcnt vmcnt(28)
  v_min_u32_dpp v136, v136, v136 row_ror:4 row_mask:0xf bank_mask:0xf
  v_mfma_f32_16x16x32_bf16 v[88:91], a[168:171], a[72:75], v[88:91]
  ds_read_b64_tr_b16 a[188:189], v231 offset:8192
  v_min_u32_dpp v136, v136, v136 row_ror:2 row_mask:0xf bank_mask:0xf
  s_nop 1
  v_min_u32_dpp v136, v136, v136 row_ror:1 row_mask:0xf bank_mask:0xf
  s_nop 0
  v_readlane_b32 s98, v136, 0
  v_readlane_b32 s99, v136, 16
  v_readlane_b32 s100, v136, 32
  v_readlane_b32 s101, v136, 48
  s_min_u32 s98, s98, s99
  s_min_u32 s100, s100, s101
  s_min_u32 s98, s98, s100
  s_sub_u32 s57, s51, s98
  s_sub_u32 s51, s57, 1
  v_sub_u32 v137, s51, v128
  v_sub_u32 v138, s51, v129
  v_min_u32 v136, v137, v138
  v_sub_u32 v139, s51, v130
  v_sub_u32 v140, s51, v131
  v_min3_u32 v136, v136, v139, v140
  v_sub_u32 v137, s51, v132
  v_sub_u32 v138, s51, v133
  v_min3_u32 v136, v136, v137, v138
  v_sub_u32 v139, s51, v134
  v_sub_u32 v140, s51, v135
  v_min3_u32 v136, v136, v139, v140
  s_nop 1
  v_min_u32_dpp v136, v136, v136 row_ror:8 row_mask:0xf bank_mask:0xf
  s_nop 1
  v_min_u32_dpp v136, v136, v136 row_ror:4 row_mask:0xf bank_mask:0xf
  s_nop 1
  v_min_u32_dpp v136, v136, v136 row_ror:2 row_mask:0xf bank_mask:0xf
  s_nop 1
  v_min_u32_dpp v136, v136, v136 row_ror:1 row_mask:0xf bank_mask:0xf
  s_nop 0
  v_readlane_b32 s98, v136, 0
  v_readlane_b32 s99, v136, 16
  v_readlane_b32 s100, v136, 32
  v_readlane_b32 s101, v136, 48
  s_min_u32 s98, s98, s99
  s_min_u32 s100, s100, s101
  s_min_u32 s98, s98, s100
  s_sub_u32 s58, s51, s98
  s_sub_u32 s51, s58, 1
  v_sub_u32 v137, s51, v128
  v_sub_u32 v138, s51, v129
  v_min_u32 v136, v137, v138
  v_sub_u32 v139, s51, v130
  v_sub_u32 v140, s51, v131
  v_min3_u32 v136, v136, v139, v140
  v_sub_u32 v137, s51, v132
  v_sub_u32 v138, s51, v133
  v_min3_u32 v136, v136, v137, v138
  v_sub_u32 v139, s51, v134
  v_sub_u32 v140, s51, v135
  v_min3_u32 v136, v136, v139, v140
  s_nop 1
  v_min_u32_dpp v136, v136, v136 row_ror:8 row_mask:0xf bank_mask:0xf
  s_nop 1
  v_min_u32_dpp v136, v136, v136 row_ror:4 row_mask:0xf bank_mask:0xf
  s_nop 1
  v_min_u32_dpp v136, v136, v136 row_ror:2 row_mask:0xf bank_mask:0xf
  s_nop 1
  v_min_u32_dpp v136, v136, v136 row_ror:1 row_mask:0xf bank_mask:0xf
  s_nop 0
  v_readlane_b32 s98, v136, 0
  v_readlane_b32 s99, v136, 16
  v_readlane_b32 s100, v136, 32
  v_readlane_b32 s101, v136, 48
  s_min_u32 s98, s98, s99
  s_min_u32 s100, s100, s101
  s_min_u32 s98, s98, s100
  s_sub_u32 s59, s51, s98
  s_sub_u32 s51, s59, 1
  v_writelane_b32 v136, s52, 0
  v_writelane_b32 v136, s53, 1
  v_writelane_b32 v136, s54, 2
  v_writelane_b32 v136, s55, 3
  v_writelane_b32 v136, s56, 4
  v_writelane_b32 v136, s57, 5
  v_writelane_b32 v136, s58, 6
  v_writelane_b32 v136, s59, 7
  s_lshl_b32 s35, s3, 8
  s_add_u32 s35, s35, 132096
  v_lshrrev_b32 v137, 2, v242
  v_add_u32 v137, s35, v137
  ds_write_b32 v137, v136
  s_waitcnt lgkmcnt(0)
  v_mfma_f32_16x16x32_bf16 v[88:91], a[172:175], a[88:91], v[88:91]
  s_barrier
  v_mfma_f32_16x16x32_bf16 v[92:95], a[172:175], a[92:95], v[92:95]
  ds_read_b64_tr_b16 a[190:191], v231 offset:9216
  v_mfma_f32_16x16x32_bf16 v[92:95], a[168:171], a[76:79], v[92:95]
  s_add_u32 m0, s28, 114688
  v_mfma_f32_16x16x32_bf16 v[96:99], a[176:179], a[64:67], v[96:99]
  ds_read_b64_tr_b16 a[160:161], v224 offset:16384
  v_mfma_f32_16x16x32_bf16 v[96:99], a[180:183], a[80:83], v[96:99]
  buffer_load_dwordx4 v238, s[20:23], s31 offen offset:0 lds
  v_mfma_f32_16x16x32_bf16 v[100:103], a[180:183], a[84:87], v[100:103]
  ds_read_b64_tr_b16 a[162:163], v224 offset:17408
  v_mfma_f32_16x16x32_bf16 v[100:103], a[176:179], a[68:71], v[100:103]
  buffer_load_dwordx4 v239, s[20:23], s31 offen offset:1024 lds
  v_mfma_f32_16x16x32_bf16 v[104:107], a[176:179], a[72:75], v[104:107]
  ds_read_b64_tr_b16 a[164:165], v224 offset:24576
  v_mfma_f32_16x16x32_bf16 v[104:107], a[180:183], a[88:91], v[104:107]
  buffer_load_dwordx4 v240, s[20:23], s31 offen offset:2048 lds
  v_mfma_f32_16x16x32_bf16 v[108:111], a[180:183], a[92:95], v[108:111]
  ds_read_b64_tr_b16 a[166:167], v224 offset:25600
  v_mfma_f32_16x16x32_bf16 v[108:111], a[176:179], a[76:79], v[108:111]
  s_waitcnt lgkmcnt(4)
  v_mfma_f32_16x16x32_bf16 v[112:115], a[184:187], a[64:67], v[112:115]
  ds_read_b64_tr_b16 a[168:169], v225 offset:16384
  v_mfma_f32_16x16x32_bf16 v[112:115], a[188:191], a[80:83], v[112:115]
  buffer_load_dwordx4 v241, s[20:23], s31 offen offset:3072 lds
  v_mfma_f32_16x16x32_bf16 v[116:119], a[188:191], a[84:87], v[116:119]
  ds_read_b64_tr_b16 a[170:171], v225 offset:17408
  v_mfma_f32_16x16x32_bf16 v[116:119], a[184:187], a[68:71], v[116:119]
  s_add_u32 s31, s31, 0x80000
  v_mfma_f32_16x16x32_bf16 v[120:123], a[184:187], a[72:75], v[120:123]
  ds_read_b64_tr_b16 a[172:173], v225 offset:24576
  v_mfma_f32_16x16x32_bf16 v[120:123], a[188:191], a[88:91], v[120:123]
  v_mfma_f32_16x16x32_bf16 v[124:127], a[188:191], a[92:95], v[124:127]
  ds_read_b64_tr_b16 a[174:175], v225 offset:25600
  v_mfma_f32_16x16x32_bf16 v[124:127], a[184:187], a[76:79], v[124:127]
  s_waitcnt lgkmcnt(4)
  v_mfma_f32_16x16x32_bf16 v[0:3], a[160:163], a[96:99], v[0:3]
  ds_read_b64_tr_b16 a[176:177], v226 offset:16384
  v_lshrrev_b32 v136, 4, v242
  v_mfma_f32_16x16x32_bf16 v[0:3], a[164:167], a[112:115], v[0:3]
  v_bfe_u32 v137, v136, 3, 2
  v_and_b32 v138, 7, v136
  v_mfma_f32_16x16x32_bf16 v[4:7], a[164:167], a[116:119], v[4:7]
  ds_read_b64_tr_b16 a[178:179], v226 offset:17408
  v_lshlrev_b32 v137, 8, v137
  v_mfma_f32_16x16x32_bf16 v[4:7], a[160:163], a[100:103], v[4:7]
  v_lshl_add_u32 v137, v138, 2, v137
  v_add_u32 v137, 132096, v137
  v_mfma_f32_16x16x32_bf16 v[8:11], a[160:163], a[104:107], v[8:11]
  ds_read_b64_tr_b16 a[180:181], v226 offset:24576
  ds_read_b32 v128, v137
  s_waitcnt lgkmcnt(0)
  s_mov_b32 s51, -1
  v_mfma_f32_16x16x32_bf16 v[8:11], a[164:167], a[120:123], v[8:11]
  v_sub_u32 v137, s51, v128
  v_mfma_f32_16x16x32_bf16 v[12:15], a[164:167], a[124:127], v[12:15]
  ds_read_b64_tr_b16 a[182:183], v226 offset:25600
  v_min_u32_dpp v137, v137, v137 row_ror:8 row_mask:0xf bank_mask:0xf
  v_mfma_f32_16x16x32_bf16 v[12:15], a[160:163], a[108:111], v[12:15]
  s_nop 0
  v_min_u32_dpp v137, v137, v137 row_ror:4 row_mask:0xf bank_mask:0xf
  v_mfma_f32_16x16x32_bf16 v[16:19], a[168:171], a[96:99], v[16:19]
  ds_read_b64_tr_b16 a[184:185], v227 offset:16384
  v_min_u32_dpp v137, v137, v137 row_ror:2 row_mask:0xf bank_mask:0xf
  v_mfma_f32_16x16x32_bf16 v[16:19], a[172:175], a[112:115], v[16:19]
  v_mfma_f32_16x16x32_bf16 v[20:23], a[172:175], a[116:119], v[20:23]
  ds_read_b64_tr_b16 a[186:187], v227 offset:17408
  v_min_u32_dpp v137, v137, v137 row_ror:1 row_mask:0xf bank_mask:0xf
  v_mfma_f32_16x16x32_bf16 v[20:23], a[168:171], a[100:103], v[20:23]
  v_readlane_b32 s98, v137, 0
  v_readlane_b32 s99, v137, 16
  v_mfma_f32_16x16x32_bf16 v[24:27], a[168:171], a[104:107], v[24:27]
  ds_read_b64_tr_b16 a[188:189], v227 offset:24576
  s_min_u32 s98, s98, s99
  s_sub_u32 s52, s51, s98
  s_sub_u32 s51, s52, 1
  v_sub_u32 v137, s51, v128
  v_mfma_f32_16x16x32_bf16 v[24:27], a[172:175], a[120:123], v[24:27]
  v_mfma_f32_16x16x32_bf16 v[28:31], a[172:175], a[124:127], v[28:31]
  ds_read_b64_tr_b16 a[190:191], v227 offset:25600
  v_min_u32_dpp v137, v137, v137 row_ror:8 row_mask:0xf bank_mask:0xf
  v_mfma_f32_16x16x32_bf16 v[28:31], a[168:171], a[108:111], v[28:31]
  s_waitcnt lgkmcnt(4)
  v_min_u32_dpp v137, v137, v137 row_ror:4 row_mask:0xf bank_mask:0xf
  v_mfma_f32_16x16x32_bf16 v[32:35], a[176:179], a[96:99], v[32:35]
  ds_read_b64_tr_b16 a[160:161], v228 offset:16384
  v_min_u32_dpp v137, v137, v137 row_ror:2 row_mask:0xf bank_mask:0xf
  v_mfma_f32_16x16x32_bf16 v[32:35], a[180:183], a[112:115], v[32:35]
  v_mfma_f32_16x16x32_bf16 v[36:39], a[180:183], a[116:119], v[36:39]
  ds_read_b64_tr_b16 a[162:163], v228 offset:17408
  v_min_u32_dpp v137, v137, v137 row_ror:1 row_mask:0xf bank_mask:0xf
  v_mfma_f32_16x16x32_bf16 v[36:39], a[176:179], a[100:103], v[36:39]
  v_readlane_b32 s98, v137, 0
  v_readlane_b32 s99, v137, 16
  v_mfma_f32_16x16x32_bf16 v[40:43], a[176:179], a[104:107], v[40:43]
  ds_read_b64_tr_b16 a[164:165], v228 offset:24576
  s_min_u32 s98, s98, s99
  s_sub_u32 s53, s51, s98
  s_sub_u32 s51, s53, 1
  v_sub_u32 v137, s51, v128
  v_mfma_f32_16x16x32_bf16 v[40:43], a[180:183], a[120:123], v[40:43]
  v_mfma_f32_16x16x32_bf16 v[44:47], a[180:183], a[124:127], v[44:47]
  ds_read_b64_tr_b16 a[166:167], v228 offset:25600
  v_min_u32_dpp v137, v137, v137 row_ror:8 row_mask:0xf bank_mask:0xf
  v_mfma_f32_16x16x32_bf16 v[44:47], a[176:179], a[108:111], v[44:47]
  s_waitcnt lgkmcnt(4)
  v_min_u32_dpp v137, v137, v137 row_ror:4 row_mask:0xf bank_mask:0xf
  v_mfma_f32_16x16x32_bf16 v[48:51], a[184:187], a[96:99], v[48:51]
  ds_read_b64_tr_b16 a[168:169], v229 offset:16384
  v_min_u32_dpp v137, v137, v137 row_ror:2 row_mask:0xf bank_mask:0xf
  v_mfma_f32_16x16x32_bf16 v[48:51], a[188:191], a[112:115], v[48:51]
  s_add_u32 m0, s28, 32768
  v_min_u32_dpp v137, v137, v137 row_ror:1 row_mask:0xf bank_mask:0xf
  v_mfma_f32_16x16x32_bf16 v[52:55], a[188:191], a[116:119], v[52:55]
  ds_read_b64_tr_b16 a[170:171], v229 offset:17408
  v_readlane_b32 s98, v137, 0
  v_mfma_f32_16x16x32_bf16 v[52:55], a[184:187], a[100:103], v[52:55]
  buffer_load_dwordx4 v232, s[12:15], s29 offen offset:0 lds
  v_mfma_f32_16x16x32_bf16 v[56:59], a[184:187], a[104:107], v[56:59]
  ds_read_b64_tr_b16 a[172:173], v229 offset:24576
  v_readlane_b32 s99, v137, 16
  v_mfma_f32_16x16x32_bf16 v[56:59], a[188:191], a[120:123], v[56:59]
  buffer_load_dwordx4 v233, s[12:15], s29 offen offset:1024 lds
  s_min_u32 s98, s98, s99
  s_sub_u32 s54, s51, s98
  s_sub_u32 s51, s54, 1
  v_mfma_f32_16x16x32_bf16 v[60:63], a[188:191], a[124:127], v[60:63]
  ds_read_b64_tr_b16 a[174:175], v229 offset:25600
  v_sub_u32 v137, s51, v128
  v_mfma_f32_16x16x32_bf16 v[60:63], a[184:187], a[108:111], v[60:63]
  s_waitcnt lgkmcnt(4)
  v_min_u32_dpp v137, v137, v137 row_ror:8 row_mask:0xf bank_mask:0xf
  v_mfma_f32_16x16x32_bf16 v[64:67], a[160:163], a[96:99], v[64:67]
  ds_read_b64_tr_b16 a[176:177], v230 offset:16384
  v_min_u32_dpp v137, v137, v137 row_ror:4 row_mask:0xf bank_mask:0xf
  v_mfma_f32_16x16x32_bf16 v[64:67], a[164:167], a[112:115], v[64:67]
  buffer_load_dwordx4 v234, s[12:15], s29 offen offset:2048 lds
  v_mfma_f32_16x16x32_bf16 v[68:71], a[164:167], a[116:119], v[68:71]
  ds_read_b64_tr_b16 a[178:179], v230 offset:17408
  v_min_u32_dpp v137, v137, v137 row_ror:2 row_mask:0xf bank_mask:0xf
  v_mfma_f32_16x16x32_bf16 v[68:71], a[160:163], a[100:103], v[68:71]
  buffer_load_dwordx4 v235, s[12:15], s29 offen offset:3072 lds
  v_mfma_f32_16x16x32_bf16 v[72:75], a[160:163], a[104:107], v[72:75]
  ds_read_b64_tr_b16 a[180:181], v230 offset:24576
  v_min_u32_dpp v137, v137, v137 row_ror:1 row_mask:0xf bank_mask:0xf
  v_mfma_f32_16x16x32_bf16 v[72:75], a[164:167], a[120:123], v[72:75]
  s_add_u32 s29, s29, 16384
  v_readlane_b32 s98, v137, 0
  v_readlane_b32 s99, v137, 16
  v_mfma_f32_16x16x32_bf16 v[76:79], a[164:167], a[124:127], v[76:79]
  ds_read_b64_tr_b16 a[182:183], v230 offset:25600
  s_min_u32 s98, s98, s99
  s_sub_u32 s55, s51, s98
  s_sub_u32 s51, s55, 1
  v_sub_u32 v137, s51, v128
  v_mfma_f32_16x16x32_bf16 v[76:79], a[160:163], a[108:111], v[76:79]
  s_waitcnt lgkmcnt(4)
  v_min_u32_dpp v137, v137, v137 row_ror:8 row_mask:0xf bank_mask:0xf
  v_mfma_f32_16x16x32_bf16 v[80:83], a[168:171], a[96:99], v[80:83]
  ds_read_b64_tr_b16 a[184:185], v231 offset:16384
  v_min_u32_dpp v137, v137, v137 row_ror:4 row_mask:0xf bank_mask:0xf
  v_mfma_f32_16x16x32_bf16 v[80:83], a[172:175], a[112:115], v[80:83]
  s_mov_b32 s29, 0
  v_min_u32_dpp v137, v137, v137 row_ror:2 row_mask:0xf bank_mask:0xf
  v_mfma_f32_16x16x32_bf16 v[84:87], a[172:175], a[116:119], v[84:87]
  ds_read_b64_tr_b16 a[186:187], v231 offset:17408
  v_min_u32_dpp v137, v137, v137 row_ror:1 row_mask:0xf bank_mask:0xf
  v_mfma_f32_16x16x32_bf16 v[84:87], a[168:171], a[100:103], v[84:87]
  s_waitcnt vmcnt(20)
  v_readlane_b32 s98, v137, 0
  v_readlane_b32 s99, v137, 16
  v_mfma_f32_16x16x32_bf16 v[88:91], a[168:171], a[104:107], v[88:91]
  ds_read_b64_tr_b16 a[188:189], v231 offset:24576
  s_min_u32 s98, s98, s99
  s_sub_u32 s56, s51, s98
  s_sub_u32 s51, s56, 1
  v_sub_u32 v137, s51, v128
  v_mfma_f32_16x16x32_bf16 v[88:91], a[172:175], a[120:123], v[88:91]
  s_barrier
  v_min_u32_dpp v137, v137, v137 row_ror:8 row_mask:0xf bank_mask:0xf
  v_mfma_f32_16x16x32_bf16 v[92:95], a[172:175], a[124:127], v[92:95]
  ds_read_b64_tr_b16 a[190:191], v231 offset:25600
  v_min_u32_dpp v137, v137, v137 row_ror:4 row_mask:0xf bank_mask:0xf
  v_mfma_f32_16x16x32_bf16 v[92:95], a[168:171], a[108:111], v[92:95]
  s_waitcnt lgkmcnt(4)
  s_add_u32 m0, s28, 65536
  v_min_u32_dpp v137, v137, v137 row_ror:2 row_mask:0xf bank_mask:0xf
  v_mfma_f32_16x16x32_bf16 v[96:99], a[176:179], a[96:99], v[96:99]
  ds_read_b64_tr_b16 a[160:161], v224 offset:32768
  v_min_u32_dpp v137, v137, v137 row_ror:1 row_mask:0xf bank_mask:0xf
  v_mfma_f32_16x16x32_bf16 v[96:99], a[180:183], a[112:115], v[96:99]
  buffer_load_dwordx4 v236, s[16:19], s29 offen offset:0 lds
  v_mfma_f32_16x16x32_bf16 v[100:103], a[180:183], a[116:119], v[100:103]
  ds_read_b64_tr_b16 a[162:163], v224 offset:33792
  v_readlane_b32 s98, v137, 0
  v_mfma_f32_16x16x32_bf16 v[100:103], a[176:179], a[100:103], v[100:103]
  buffer_load_dwordx4 v237, s[16:19], s29 offen offset:1024 lds
  v_mfma_f32_16x16x32_bf16 v[104:107], a[176:179], a[104:107], v[104:107]
  ds_read_b64_tr_b16 a[164:165], v224 offset:40960
  v_readlane_b32 s99, v137, 16
  v_mfma_f32_16x16x32_bf16 v[104:107], a[180:183], a[120:123], v[104:107]
  buffer_load_dwordx4 v236, s[16:19], s29 offen offset:2048 lds
  s_min_u32 s98, s98, s99
  s_sub_u32 s57, s51, s98
  s_sub_u32 s51, s57, 1
  v_mfma_f32_16x16x32_bf16 v[108:111], a[180:183], a[124:127], v[108:111]
  ds_read_b64_tr_b16 a[166:167], v224 offset:41984
  v_sub_u32 v137, s51, v128
  v_mfma_f32_16x16x32_bf16 v[108:111], a[176:179], a[108:111], v[108:111]
  s_waitcnt lgkmcnt(4)
  v_min_u32_dpp v137, v137, v137 row_ror:8 row_mask:0xf bank_mask:0xf
  v_mfma_f32_16x16x32_bf16 v[112:115], a[184:187], a[96:99], v[112:115]
  ds_read_b64_tr_b16 a[168:169], v225 offset:32768
  v_min_u32_dpp v137, v137, v137 row_ror:4 row_mask:0xf bank_mask:0xf
  v_mfma_f32_16x16x32_bf16 v[112:115], a[188:191], a[112:115], v[112:115]
  buffer_load_dwordx4 v237, s[16:19], s29 offen offset:3072 lds
  v_mfma_f32_16x16x32_bf16 v[116:119], a[188:191], a[116:119], v[116:119]
  ds_read_b64_tr_b16 a[170:171], v225 offset:33792
  v_min_u32_dpp v137, v137, v137 row_ror:2 row_mask:0xf bank_mask:0xf
  v_mfma_f32_16x16x32_bf16 v[116:119], a[184:187], a[100:103], v[116:119]
  s_add_u32 s29, s29, 16384
  v_min_u32_dpp v137, v137, v137 row_ror:1 row_mask:0xf bank_mask:0xf
  v_mfma_f32_16x16x32_bf16 v[120:123], a[184:187], a[104:107], v[120:123]
  ds_read_b64_tr_b16 a[172:173], v225 offset:40960
  v_readlane_b32 s98, v137, 0
  v_mfma_f32_16x16x32_bf16 v[120:123], a[188:191], a[120:123], v[120:123]
  v_readlane_b32 s99, v137, 16
  v_mfma_f32_16x16x32_bf16 v[124:127], a[188:191], a[124:127], v[124:127]
  ds_read_b64_tr_b16 a[174:175], v225 offset:41984
  s_min_u32 s98, s98, s99
  s_sub_u32 s58, s51, s98
  s_sub_u32 s51, s58, 1
  v_sub_u32 v137, s51, v128
  v_mfma_f32_16x16x32_bf16 v[124:127], a[184:187], a[108:111], v[124:127]
  s_waitcnt lgkmcnt(4)
  v_min_u32_dpp v137, v137, v137 row_ror:8 row_mask:0xf bank_mask:0xf
  v_mfma_f32_16x16x32_bf16 v[0:3], a[160:163], a[0:3], v[0:3]
  ds_read_b64_tr_b16 a[176:177], v226 offset:32768
  v_min_u32_dpp v137, v137, v137 row_ror:4 row_mask:0xf bank_mask:0xf
  v_mfma_f32_16x16x32_bf16 v[0:3], a[164:167], a[16:19], v[0:3]
  v_mfma_f32_16x16x32_bf16 v[4:7], a[164:167], a[20:23], v[4:7]
  ds_read_b64_tr_b16 a[178:179], v226 offset:33792
  v_min_u32_dpp v137, v137, v137 row_ror:2 row_mask:0xf bank_mask:0xf
  v_mfma_f32_16x16x32_bf16 v[4:7], a[160:163], a[4:7], v[4:7]
  v_mfma_f32_16x16x32_bf16 v[8:11], a[160:163], a[8:11], v[8:11]
  ds_read_b64_tr_b16 a[180:181], v226 offset:40960
  v_min_u32_dpp v137, v137, v137 row_ror:1 row_mask:0xf bank_mask:0xf
  v_mfma_f32_16x16x32_bf16 v[8:11], a[164:167], a[24:27], v[8:11]
  v_readlane_b32 s98, v137, 0
  v_readlane_b32 s99, v137, 16
  v_mfma_f32_16x16x32_bf16 v[12:15], a[164:167], a[28:31], v[12:15]
  ds_read_b64_tr_b16 a[182:183], v226 offset:41984
  s_min_u32 s98, s98, s99
  s_sub_u32 s59, s51, s98
  s_sub_u32 s51, s59, 1
  v_mov_b32 v128, 0
  v_mfma_f32_16x16x32_bf16 v[12:15], a[160:163], a[12:15], v[12:15]
  s_waitcnt lgkmcnt(4)
  v_writelane_b32 v128, s52, 0
  v_writelane_b32 v128, s53, 1
  v_mfma_f32_16x16x32_bf16 v[16:19], a[168:171], a[0:3], v[16:19]
  ds_read_b64_tr_b16 a[184:185], v227 offset:32768
  v_writelane_b32 v128, s54, 2
  v_mfma_f32_16x16x32_bf16 v[16:19], a[172:175], a[16:19], v[16:19]
  v_writelane_b32 v128, s55, 3
  v_writelane_b32 v128, s56, 4
  v_mfma_f32_16x16x32_bf16 v[20:23], a[172:175], a[20:23], v[20:23]
  ds_read_b64_tr_b16 a[186:187], v227 offset:33792
  v_writelane_b32 v128, s57, 5
  v_mfma_f32_16x16x32_bf16 v[20:23], a[168:171], a[4:7], v[20:23]
  v_writelane_b32 v128, s58, 6
  v_writelane_b32 v128, s59, 7
  v_mfma_f32_16x16x32_bf16 v[24:27], a[168:171], a[8:11], v[24:27]
  ds_read_b64_tr_b16 a[188:189], v227 offset:40960
  s_cmp_eq_u32 s2, 0
  s_cselect_b32 s35, 0, 1073741824
  v_lshrrev_b32 v137, 3, v136
  v_mfma_f32_16x16x32_bf16 v[24:27], a[172:175], a[24:27], v[24:27]
  v_lshlrev_b32 v137, 28, v137
  v_lshl_add_u32 v137, v136, 2, v137
  v_mfma_f32_16x16x32_bf16 v[28:31], a[172:175], a[28:31], v[28:31]
  ds_read_b64_tr_b16 a[190:191], v227 offset:41984
  v_or_b32 v137, s35, v137
  v_mfma_f32_16x16x32_bf16 v[28:31], a[168:171], a[12:15], v[28:31]
  s_waitcnt lgkmcnt(4)
  s_mov_b32 s35, 2629632
  buffer_store_dword v128, v137, s[24:27], s35 offen
  v_mfma_f32_16x16x32_bf16 v[32:35], a[176:179], a[0:3], v[32:35]
  ds_read_b64_tr_b16 a[160:161], v228 offset:32768
  v_and_b32 v129, 0xffff, v128
  v_mfma_f32_16x16x32_bf16 v[32:35], a[180:183], a[16:19], v[32:35]
  v_sub_u32 v129, 0xffff, v129
  v_and_b32 v129, 0x7ff, v129
  v_mfma_f32_16x16x32_bf16 v[36:39], a[180:183], a[20:23], v[36:39]
  ds_read_b64_tr_b16 a[162:163], v228 offset:33792
  v_mov_b32 v130, v129
  v_mfma_f32_16x16x32_bf16 v[36:39], a[176:179], a[4:7], v[36:39]
  v_mfma_f32_16x16x32_bf16 v[40:43], a[176:179], a[8:11], v[40:43]
  ds_read_b64_tr_b16 a[164:165], v228 offset:40960
  v_permlane16_swap_b32 v129, v130
  v_mfma_f32_16x16x32_bf16 v[40:43], a[180:183], a[24:27], v[40:43]
  v_mov_b32 v130, v129
  v_mfma_f32_16x16x32_bf16 v[44:47], a[180:183], a[28:31], v[44:47]
  ds_read_b64_tr_b16 a[166:167], v228 offset:41984
  v_permlane32_swap_b32 v129, v130
  v_mfma_f32_16x16x32_bf16 v[44:47], a[176:179], a[12:15], v[44:47]
  s_waitcnt lgkmcnt(4)
  v_lshrrev_b32 v130, 6, v129
  v_mul_u32_u24 v130, 0x14000, v130
  v_mfma_f32_16x16x32_bf16 v[48:51], a[184:187], a[0:3], v[48:51]
  ds_read_b64_tr_b16 a[168:169], v229 offset:32768
  v_bfe_u32 v131, v129, 4, 2
  v_mfma_f32_16x16x32_bf16 v[48:51], a[188:191], a[16:19], v[48:51]
  v_lshl_add_u32 v130, v131, 10, v130
  v_and_b32 v131, 15, v129
  v_mfma_f32_16x16x32_bf16 v[52:55], a[188:191], a[20:23], v[52:55]
  ds_read_b64_tr_b16 a[170:171], v229 offset:33792
  v_lshl_add_u32 v130, v131, 4, v130
  v_mfma_f32_16x16x32_bf16 v[52:55], a[184:187], a[4:7], v[52:55]
  v_lshrrev_b32 v131, 4, v136
  v_lshl_add_u32 v130, v131, 8, v130
  v_mfma_f32_16x16x32_bf16 v[56:59], a[184:187], a[8:11], v[56:59]
  ds_read_b64_tr_b16 a[172:173], v229 offset:40960
  s_mul_i32 s35, s3, 20480
  buffer_load_dwordx4 a[212:215], v130, s[24:27], s35 offen
  s_add_u32 s35, s35, 4096
  v_mfma_f32_16x16x32_bf16 v[56:59], a[188:191], a[24:27], v[56:59]
  buffer_load_dwordx4 a[216:219], v130, s[24:27], s35 offen
  s_add_u32 s35, s35, 4096
  v_mfma_f32_16x16x32_bf16 v[60:63], a[188:191], a[28:31], v[60:63]
  ds_read_b64_tr_b16 a[174:175], v229 offset:41984
  buffer_load_dwordx4 a[220:223], v130, s[24:27], s35 offen
  s_add_u32 s35, s35, 4096
  v_mfma_f32_16x16x32_bf16 v[60:63], a[184:187], a[12:15], v[60:63]
  s_waitcnt lgkmcnt(4)
  buffer_load_dwordx4 a[224:227], v130, s[24:27], s35 offen
  s_add_u32 s35, s35, 4096
  v_mfma_f32_16x16x32_bf16 v[64:67], a[160:163], a[0:3], v[64:67]
  ds_read_b64_tr_b16 a[176:177], v230 offset:32768
  buffer_load_dwordx4 a[228:231], v130, s[24:27], s35 offen
  s_add_u32 s35, s35, 4096
  v_mfma_f32_16x16x32_bf16 v[64:67], a[164:167], a[16:19], v[64:67]
  v_mfma_f32_16x16x32_bf16 v[68:71], a[164:167], a[20:23], v[68:71]
  ds_read_b64_tr_b16 a[178:179], v230 offset:33792
  v_mfma_f32_16x16x32_bf16 v[68:71], a[160:163], a[4:7], v[68:71]
  v_mfma_f32_16x16x32_bf16 v[72:75], a[160:163], a[8:11], v[72:75]
  ds_read_b64_tr_b16 a[180:181], v230 offset:40960
  v_mfma_f32_16x16x32_bf16 v[72:75], a[164:167], a[24:27], v[72:75]
  v_mfma_f32_16x16x32_bf16 v[76:79], a[164:167], a[28:31], v[76:79]
  ds_read_b64_tr_b16 a[182:183], v230 offset:41984
  v_mfma_f32_16x16x32_bf16 v[76:79], a[160:163], a[12:15], v[76:79]
  s_waitcnt lgkmcnt(4)
  v_mfma_f32_16x16x32_bf16 v[80:83], a[168:171], a[0:3], v[80:83]
  ds_read_b64_tr_b16 a[184:185], v231 offset:32768
  v_mfma_f32_16x16x32_bf16 v[80:83], a[172:175], a[16:19], v[80:83]
  v_mfma_f32_16x16x32_bf16 v[84:87], a[172:175], a[20:23], v[84:87]
  ds_read_b64_tr_b16 a[186:187], v231 offset:33792
  v_mfma_f32_16x16x32_bf16 v[84:87], a[168:171], a[4:7], v[84:87]
  s_waitcnt vmcnt(14)
  v_mfma_f32_16x16x32_bf16 v[88:91], a[168:171], a[8:11], v[88:91]
  ds_read_b64_tr_b16 a[188:189], v231 offset:40960
  v_mfma_f32_16x16x32_bf16 v[88:91], a[172:175], a[24:27], v[88:91]
  s_barrier
  v_mfma_f32_16x16x32_bf16 v[92:95], a[172:175], a[28:31], v[92:95]
  ds_read_b64_tr_b16 a[190:191], v231 offset:41984
  v_mfma_f32_16x16x32_bf16 v[92:95], a[168:171], a[12:15], v[92:95]
  s_waitcnt lgkmcnt(4)
  s_add_u32 m0, s28, 81920
  v_mfma_f32_16x16x32_bf16 v[96:99], a[176:179], a[0:3], v[96:99]
  ds_read_b64_tr_b16 a[160:161], v224 offset:49152
  v_mfma_f32_16x16x32_bf16 v[96:99], a[180:183], a[16:19], v[96:99]
  buffer_load_dwordx4 v236, s[16:19], s29 offen offset:0 lds
  v_mfma_f32_16x16x32_bf16 v[100:103], a[180:183], a[20:23], v[100:103]
  ds_read_b64_tr_b16 a[162:163], v224 offset:50176
  v_mfma_f32_16x16x32_bf16 v[100:103], a[176:179], a[4:7], v[100:103]
  buffer_load_dwordx4 v237, s[16:19], s29 offen offset:1024 lds
  v_mfma_f32_16x16x32_bf16 v[104:107], a[176:179], a[8:11], v[104:107]
  ds_read_b64_tr_b16 a[164:165], v224 offset:57344
  v_mfma_f32_16x16x32_bf16 v[104:107], a[180:183], a[24:27], v[104:107]
  buffer_load_dwordx4 v236, s[16:19], s29 offen offset:2048 lds
  v_mfma_f32_16x16x32_bf16 v[108:111], a[180:183], a[28:31], v[108:111]
  ds_read_b64_tr_b16 a[166:167], v224 offset:58368
  v_mfma_f32_16x16x32_bf16 v[108:111], a[176:179], a[12:15], v[108:111]
  s_waitcnt lgkmcnt(4)
  v_mfma_f32_16x16x32_bf16 v[112:115], a[184:187], a[0:3], v[112:115]
  ds_read_b64_tr_b16 a[168:169], v225 offset:49152
  v_mfma_f32_16x16x32_bf16 v[112:115], a[188:191], a[16:19], v[112:115]
  buffer_load_dwordx4 v237, s[16:19], s29 offen offset:3072 lds
  v_mfma_f32_16x16x32_bf16 v[116:119], a[188:191], a[20:23], v[116:119]
  ds_read_b64_tr_b16 a[170:171], v225 offset:50176
  v_mfma_f32_16x16x32_bf16 v[116:119], a[184:187], a[4:7], v[116:119]
  s_add_u32 s29, s29, 16384
  v_mfma_f32_16x16x32_bf16 v[120:123], a[184:187], a[8:11], v[120:123]
  ds_read_b64_tr_b16 a[172:173], v225 offset:57344
  v_mfma_f32_16x16x32_bf16 v[120:123], a[188:191], a[24:27], v[120:123]
  v_mfma_f32_16x16x32_bf16 v[124:127], a[188:191], a[28:31], v[124:127]
  ds_read_b64_tr_b16 a[174:175], v225 offset:58368
  v_mfma_f32_16x16x32_bf16 v[124:127], a[184:187], a[12:15], v[124:127]
  s_waitcnt lgkmcnt(4)
  v_mfma_f32_16x16x32_bf16 v[0:3], a[160:163], a[32:35], v[0:3]
  ds_read_b64_tr_b16 a[176:177], v226 offset:49152
  v_mfma_f32_16x16x32_bf16 v[0:3], a[164:167], a[48:51], v[0:3]
  v_mfma_f32_16x16x32_bf16 v[4:7], a[164:167], a[52:55], v[4:7]
  ds_read_b64_tr_b16 a[178:179], v226 offset:50176
  v_mfma_f32_16x16x32_bf16 v[4:7], a[160:163], a[36:39], v[4:7]
  v_mfma_f32_16x16x32_bf16 v[8:11], a[160:163], a[40:43], v[8:11]
  ds_read_b64_tr_b16 a[180:181], v226 offset:57344
  v_mfma_f32_16x16x32_bf16 v[8:11], a[164:167], a[56:59], v[8:11]
  v_mfma_f32_16x16x32_bf16 v[12:15], a[164:167], a[60:63], v[12:15]
  ds_read_b64_tr_b16 a[182:183], v226 offset:58368
  v_mfma_f32_16x16x32_bf16 v[12:15], a[160:163], a[44:47], v[12:15]
  s_waitcnt lgkmcnt(4)
  v_mfma_f32_16x16x32_bf16 v[16:19], a[168:171], a[32:35], v[16:19]
  ds_read_b64_tr_b16 a[184:185], v227 offset:49152
  v_mfma_f32_16x16x32_bf16 v[16:19], a[172:175], a[48:51], v[16:19]
  v_mfma_f32_16x16x32_bf16 v[20:23], a[172:175], a[52:55], v[20:23]
  ds_read_b64_tr_b16 a[186:187], v227 offset:50176
  v_mfma_f32_16x16x32_bf16 v[20:23], a[168:171], a[36:39], v[20:23]
  v_mfma_f32_16x16x32_bf16 v[24:27], a[168:171], a[40:43], v[24:27]
  ds_read_b64_tr_b16 a[188:189], v227 offset:57344
  v_mfma_f32_16x16x32_bf16 v[24:27], a[172:175], a[56:59], v[24:27]
  v_mul_f32 v0, s34, v0
  v_mul_f32 v1, s34, v1
  v_mfma_f32_16x16x32_bf16 v[28:31], a[172:175], a[60:63], v[28:31]
  ds_read_b64_tr_b16 a[190:191], v227 offset:58368
  v_mul_f32 v2, s34, v2
  v_mfma_f32_16x16x32_bf16 v[28:31], a[168:171], a[44:47], v[28:31]
  s_waitcnt lgkmcnt(4)
  v_mul_f32 v3, s34, v3
  v_mul_f32 v16, s34, v16
  v_mfma_f32_16x16x32_bf16 v[32:35], a[176:179], a[32:35], v[32:35]
  ds_read_b64_tr_b16 a[160:161], v228 offset:49152
  v_mul_f32 v17, s34, v17
  v_mfma_f32_16x16x32_bf16 v[32:35], a[180:183], a[48:51], v[32:35]
  v_mul_f32 v18, s34, v18
  v_mul_f32 v19, s34, v19
  v_mfma_f32_16x16x32_bf16 v[36:39], a[180:183], a[52:55], v[36:39]
  ds_read_b64_tr_b16 a[162:163], v228 offset:50176
  v_cvt_pk_bf16_f32 v128, v0, v1
  v_mfma_f32_16x16x32_bf16 v[36:39], a[176:179], a[36:39], v[36:39]
  v_cvt_pk_bf16_f32 v129, v2, v3
  v_cvt_pk_bf16_f32 v130, v16, v17
  v_mfma_f32_16x16x32_bf16 v[40:43], a[176:179], a[40:43], v[40:43]
  ds_read_b64_tr_b16 a[164:165], v228 offset:57344
  v_cvt_pk_bf16_f32 v131, v18, v19
  v_mfma_f32_16x16x32_bf16 v[40:43], a[180:183], a[56:59], v[40:43]
  v_mul_f32 v4, s34, v4
  v_mul_f32 v5, s34, v5
  v_mfma_f32_16x16x32_bf16 v[44:47], a[180:183], a[60:63], v[44:47]
  ds_read_b64_tr_b16 a[166:167], v228 offset:58368
  v_mul_f32 v6, s34, v6
  v_mfma_f32_16x16x32_bf16 v[44:47], a[176:179], a[44:47], v[44:47]
  s_waitcnt lgkmcnt(4)
  v_mul_f32 v7, s34, v7
  v_mul_f32 v20, s34, v20
  v_mfma_f32_16x16x32_bf16 v[48:51], a[184:187], a[32:35], v[48:51]
  ds_read_b64_tr_b16 a[168:169], v229 offset:49152
  v_mul_f32 v21, s34, v21
  v_mfma_f32_16x16x32_bf16 v[48:51], a[188:191], a[48:51], v[48:51]
  v_mul_f32 v22, s34, v22
  v_mul_f32 v23, s34, v23
  v_mfma_f32_16x16x32_bf16 v[52:55], a[188:191], a[52:55], v[52:55]
  ds_read_b64_tr_b16 a[170:171], v229 offset:50176
  v_cvt_pk_bf16_f32 v144, v4, v5
  v_mfma_f32_16x16x32_bf16 v[52:55], a[184:187], a[36:39], v[52:55]
  v_cvt_pk_bf16_f32 v145, v6, v7
  v_cvt_pk_bf16_f32 v146, v20, v21
  v_mfma_f32_16x16x32_bf16 v[56:59], a[184:187], a[40:43], v[56:59]
  ds_read_b64_tr_b16 a[172:173], v229 offset:57344
  v_cvt_pk_bf16_f32 v147, v22, v23
  v_mfma_f32_16x16x32_bf16 v[56:59], a[188:191], a[56:59], v[56:59]
  v_permlane16_swap_b32 v128, v130
  v_permlane16_swap_b32 v129, v131
  v_mfma_f32_16x16x32_bf16 v[60:63], a[188:191], a[60:63], v[60:63]
  ds_read_b64_tr_b16 a[174:175], v229 offset:58368
  v_mul_f32 v8, s34, v8
  v_mfma_f32_16x16x32_bf16 v[60:63], a[184:187], a[44:47], v[60:63]
  s_waitcnt lgkmcnt(4)
  v_mul_f32 v9, s34, v9
  v_mul_f32 v10, s34, v10
  v_mfma_f32_16x16x32_bf16 v[64:67], a[160:163], a[32:35], v[64:67]
  ds_read_b64_tr_b16 a[176:177], v230 offset:49152
  v_mul_f32 v11, s34, v11
  v_mfma_f32_16x16x32_bf16 v[64:67], a[164:167], a[48:51], v[64:67]
  v_mul_f32 v24, s34, v24
  v_mul_f32 v25, s34, v25
  v_mfma_f32_16x16x32_bf16 v[68:71], a[164:167], a[52:55], v[68:71]
  ds_read_b64_tr_b16 a[178:179], v230 offset:50176
  v_mul_f32 v26, s34, v26
  v_mfma_f32_16x16x32_bf16 v[68:71], a[160:163], a[36:39], v[68:71]
  v_mul_f32 v27, s34, v27
  v_cvt_pk_bf16_f32 v160, v8, v9
  v_mfma_f32_16x16x32_bf16 v[72:75], a[160:163], a[40:43], v[72:75]
  ds_read_b64_tr_b16 a[180:181], v230 offset:57344
  v_cvt_pk_bf16_f32 v161, v10, v11
  v_mfma_f32_16x16x32_bf16 v[72:75], a[164:167], a[56:59], v[72:75]
  v_cvt_pk_bf16_f32 v162, v24, v25
  v_cvt_pk_bf16_f32 v163, v26, v27
  v_mfma_f32_16x16x32_bf16 v[76:79], a[164:167], a[60:63], v[76:79]
  ds_read_b64_tr_b16 a[182:183], v230 offset:58368
  v_permlane16_swap_b32 v144, v146
  v_mfma_f32_16x16x32_bf16 v[76:79], a[160:163], a[44:47], v[76:79]
  s_waitcnt lgkmcnt(4)
  v_permlane16_swap_b32 v145, v147
  v_mul_f32 v12, s34, v12
  v_mfma_f32_16x16x32_bf16 v[80:83], a[168:171], a[32:35], v[80:83]
  ds_read_b64_tr_b16 a[184:185], v231 offset:49152
  v_mul_f32 v13, s34, v13
  v_mfma_f32_16x16x32_bf16 v[80:83], a[172:175], a[48:51], v[80:83]
  v_mul_f32 v14, s34, v14
  v_mul_f32 v15, s34, v15
  v_mfma_f32_16x16x32_bf16 v[84:87], a[172:175], a[52:55], v[84:87]
  ds_read_b64_tr_b16 a[186:187], v231 offset:50176
  v_mul_f32 v28, s34, v28
  v_mfma_f32_16x16x32_bf16 v[84:87], a[168:171], a[36:39], v[84:87]
  v_mul_f32 v29, s34, v29
  v_mul_f32 v30, s34, v30
  v_mfma_f32_16x16x32_bf16 v[88:91], a[168:171], a[40:43], v[88:91]
  ds_read_b64_tr_b16 a[188:189], v231 offset:57344
  v_mul_f32 v31, s34, v31
  v_mfma_f32_16x16x32_bf16 v[88:91], a[172:175], a[56:59], v[88:91]
  s_barrier
  v_cvt_pk_bf16_f32 v176, v12, v13
  v_cvt_pk_bf16_f32 v177, v14, v15
  v_mfma_f32_16x16x32_bf16 v[92:95], a[172:175], a[60:63], v[92:95]
  ds_read_b64_tr_b16 a[190:191], v231 offset:58368
  v_cvt_pk_bf16_f32 v178, v28, v29
  v_mfma_f32_16x16x32_bf16 v[92:95], a[168:171], a[44:47], v[92:95]
  s_waitcnt lgkmcnt(4)
  v_cvt_pk_bf16_f32 v179, v30, v31
  v_permlane16_swap_b32 v160, v162
  v_mfma_f32_16x16x32_bf16 v[96:99], a[176:179], a[32:35], v[96:99]
  ds_read_b128 a[128:131], v212 offset:0
  v_permlane16_swap_b32 v161, v163
  v_mfma_f32_16x16x32_bf16 v[96:99], a[180:183], a[48:51], v[96:99]
  v_mul_f32 v32, s34, v32
  v_mul_f32 v33, s34, v33
  v_mfma_f32_16x16x32_bf16 v[100:103], a[180:183], a[52:55], v[100:103]
  ds_read_b128 a[132:135], v213 offset:0
  v_mul_f32 v34, s34, v34
  v_mfma_f32_16x16x32_bf16 v[100:103], a[176:179], a[36:39], v[100:103]
  v_mul_f32 v35, s34, v35
  v_mul_f32 v48, s34, v48
  v_mfma_f32_16x16x32_bf16 v[104:107], a[176:179], a[40:43], v[104:107]
  ds_read_b128 a[136:139], v214 offset:0
  v_mul_f32 v49, s34, v49
  v_mfma_f32_16x16x32_bf16 v[104:107], a[180:183], a[56:59], v[104:107]
  v_mul_f32 v50, s34, v50
  v_mul_f32 v51, s34, v51
  v_mfma_f32_16x16x32_bf16 v[108:111], a[180:183], a[60:63], v[108:111]
  ds_read_b128 a[140:143], v215 offset:0
  v_cvt_pk_bf16_f32 v132, v32, v33
  v_mfma_f32_16x16x32_bf16 v[108:111], a[176:179], a[44:47], v[108:111]
  s_waitcnt lgkmcnt(4)
  v_cvt_pk_bf16_f32 v133, v34, v35
  v_cvt_pk_bf16_f32 v134, v48, v49
  v_mfma_f32_16x16x32_bf16 v[112:115], a[184:187], a[32:35], v[112:115]
  v_cvt_pk_bf16_f32 v135, v50, v51
  v_permlane16_swap_b32 v176, v178
  v_mfma_f32_16x16x32_bf16 v[112:115], a[188:191], a[48:51], v[112:115]
  v_permlane16_swap_b32 v177, v179
  v_mul_f32 v36, s34, v36
  v_mfma_f32_16x16x32_bf16 v[116:119], a[188:191], a[52:55], v[116:119]
  v_mul_f32 v37, s34, v37
  v_mul_f32 v38, s34, v38
  v_mfma_f32_16x16x32_bf16 v[116:119], a[184:187], a[36:39], v[116:119]
  v_mul_f32 v39, s34, v39
  v_mul_f32 v52, s34, v52
  v_mfma_f32_16x16x32_bf16 v[120:123], a[184:187], a[40:43], v[120:123]
  v_mul_f32 v53, s34, v53
  v_mul_f32 v54, s34, v54
  v_mfma_f32_16x16x32_bf16 v[120:123], a[188:191], a[56:59], v[120:123]
  v_mul_f32 v55, s34, v55
  v_cvt_pk_bf16_f32 v148, v36, v37
  v_mfma_f32_16x16x32_bf16 v[124:127], a[188:191], a[60:63], v[124:127]
  v_cvt_pk_bf16_f32 v149, v38, v39
  v_cvt_pk_bf16_f32 v150, v52, v53
  v_mfma_f32_16x16x32_bf16 v[124:127], a[184:187], a[44:47], v[124:127]
  s_waitcnt lgkmcnt(0)
  v_cvt_pk_bf16_f32 v151, v54, v55
  v_permlane16_swap_b32 v132, v134
  v_permlane16_swap_b32 v133, v135
  v_mul_f32 v40, s34, v40
  v_mul_f32 v41, s34, v41
  v_mul_f32 v42, s34, v42
  v_mul_f32 v43, s34, v43
  v_mul_f32 v56, s34, v56
  v_mul_f32 v57, s34, v57
  v_mul_f32 v58, s34, v58
  v_mul_f32 v59, s34, v59
  v_cvt_pk_bf16_f32 v164, v40, v41
  v_cvt_pk_bf16_f32 v165, v42, v43
  v_cvt_pk_bf16_f32 v166, v56, v57
  v_cvt_pk_bf16_f32 v167, v58, v59
  v_permlane16_swap_b32 v148, v150
  v_permlane16_swap_b32 v149, v151
  v_mul_f32 v44, s34, v44
  v_mul_f32 v45, s34, v45
  v_mul_f32 v46, s34, v46
  v_mul_f32 v47, s34, v47
  v_mul_f32 v60, s34, v60
  v_mul_f32 v61, s34, v61
  v_mul_f32 v62, s34, v62
  v_mul_f32 v63, s34, v63
  v_cvt_pk_bf16_f32 v180, v44, v45
  v_cvt_pk_bf16_f32 v181, v46, v47
  v_cvt_pk_bf16_f32 v182, v60, v61
  v_cvt_pk_bf16_f32 v183, v62, v63
  v_permlane16_swap_b32 v164, v166
  v_permlane16_swap_b32 v165, v167
  v_mul_f32 v64, s34, v64
  v_mul_f32 v65, s34, v65
  v_mul_f32 v66, s34, v66
  v_mul_f32 v67, s34, v67
  v_mul_f32 v80, s34, v80
  v_mul_f32 v81, s34, v81
  v_mul_f32 v82, s34, v82
  v_mul_f32 v83, s34, v83
  v_cvt_pk_bf16_f32 v136, v64, v65
  v_cvt_pk_bf16_f32 v137, v66, v67
  v_cvt_pk_bf16_f32 v138, v80, v81
  v_cvt_pk_bf16_f32 v139, v82, v83
  v_permlane16_swap_b32 v180, v182
  v_permlane16_swap_b32 v181, v183
  v_mul_f32 v68, s34, v68
  v_mul_f32 v69, s34, v69
  v_mul_f32 v70, s34, v70
  v_mul_f32 v71, s34, v71
  v_mul_f32 v84, s34, v84
  v_mul_f32 v85, s34, v85
  v_mul_f32 v86, s34, v86
  v_mul_f32 v87, s34, v87
  v_cvt_pk_bf16_f32 v152, v68, v69
  v_cvt_pk_bf16_f32 v153, v70, v71
  v_cvt_pk_bf16_f32 v154, v84, v85
  v_cvt_pk_bf16_f32 v155, v86, v87
  v_permlane16_swap_b32 v136, v138
  v_permlane16_swap_b32 v137, v139
  v_mul_f32 v72, s34, v72
  v_mul_f32 v73, s34, v73
  v_mul_f32 v74, s34, v74
  v_mul_f32 v75, s34, v75
  v_mul_f32 v88, s34, v88
  v_mul_f32 v89, s34, v89
  v_mul_f32 v90, s34, v90
  v_mul_f32 v91, s34, v91
  v_cvt_pk_bf16_f32 v168, v72, v73
  v_cvt_pk_bf16_f32 v169, v74, v75
  v_cvt_pk_bf16_f32 v170, v88, v89
  v_cvt_pk_bf16_f32 v171, v90, v91
  v_permlane16_swap_b32 v152, v154
  v_permlane16_swap_b32 v153, v155
  v_mul_f32 v76, s34, v76
  v_mul_f32 v77, s34, v77
  v_mul_f32 v78, s34, v78
  v_mul_f32 v79, s34, v79
  v_mul_f32 v92, s34, v92
  v_mul_f32 v93, s34, v93
  v_mul_f32 v94, s34, v94
  v_mul_f32 v95, s34, v95
  v_cvt_pk_bf16_f32 v184, v76, v77
  v_cvt_pk_bf16_f32 v185, v78, v79
  v_cvt_pk_bf16_f32 v186, v92, v93
  v_cvt_pk_bf16_f32 v187, v94, v95
  v_permlane16_swap_b32 v168, v170
  v_permlane16_swap_b32 v169, v171
  v_mul_f32 v96, s34, v96
  v_mul_f32 v97, s34, v97
  v_mul_f32 v98, s34, v98
  v_mul_f32 v99, s34, v99
  v_mul_f32 v112, s34, v112
  v_mul_f32 v113, s34, v113
  v_mul_f32 v114, s34, v114
  v_mul_f32 v115, s34, v115
  v_cvt_pk_bf16_f32 v140, v96, v97
  v_cvt_pk_bf16_f32 v141, v98, v99
  v_cvt_pk_bf16_f32 v142, v112, v113
  v_cvt_pk_bf16_f32 v143, v114, v115
  v_permlane16_swap_b32 v184, v186
  v_permlane16_swap_b32 v185, v187
  v_mul_f32 v100, s34, v100
  v_mul_f32 v101, s34, v101
  v_mul_f32 v102, s34, v102
  v_mul_f32 v103, s34, v103
  v_mul_f32 v116, s34, v116
  v_mul_f32 v117, s34, v117
  v_mul_f32 v118, s34, v118
  v_mul_f32 v119, s34, v119
  v_cvt_pk_bf16_f32 v156, v100, v101
  v_cvt_pk_bf16_f32 v157, v102, v103
  v_cvt_pk_bf16_f32 v158, v116, v117
  v_cvt_pk_bf16_f32 v159, v118, v119
  v_permlane16_swap_b32 v140, v142
  v_permlane16_swap_b32 v141, v143
  v_mul_f32 v104, s34, v104
  v_mul_f32 v105, s34, v105
  v_mul_f32 v106, s34, v106
  v_mul_f32 v107, s34, v107
  v_mul_f32 v120, s34, v120
  v_mul_f32 v121, s34, v121
  v_mul_f32 v122, s34, v122
  v_mul_f32 v123, s34, v123
  v_cvt_pk_bf16_f32 v172, v104, v105
  v_cvt_pk_bf16_f32 v173, v106, v107
  v_cvt_pk_bf16_f32 v174, v120, v121
  v_cvt_pk_bf16_f32 v175, v122, v123
  v_permlane16_swap_b32 v156, v158
  v_permlane16_swap_b32 v157, v159
  v_mul_f32 v108, s34, v108
  v_mul_f32 v109, s34, v109
  v_mul_f32 v110, s34, v110
  v_mul_f32 v111, s34, v111
  v_mul_f32 v124, s34, v124
  v_mul_f32 v125, s34, v125
  v_mul_f32 v126, s34, v126
  v_mul_f32 v127, s34, v127
  v_cvt_pk_bf16_f32 v188, v108, v109
  v_cvt_pk_bf16_f32 v189, v110, v111
  v_cvt_pk_bf16_f32 v190, v124, v125
  v_cvt_pk_bf16_f32 v191, v126, v127
  v_permlane16_swap_b32 v172, v174
  v_permlane16_swap_b32 v173, v175
  v_permlane16_swap_b32 v188, v190
  v_permlane16_swap_b32 v189, v191
  v_mfma_f32_16x16x32_bf16 v[0:3], a[128:131], v[128:131], 0
  ds_read_b128 a[144:147], v212 offset:4096
  s_mov_b32 s20, s90
  s_mov_b32 s21, s91
  s_mov_b32 s22, 2211840
  s_mov_b32 s23, 0x20000
  s_mov_b32 s44, s92
  s_mov_b32 s45, s93
  s_mov_b32 s46, 2211840
  s_mov_b32 s47, 0x20000
  v_lshrrev_b32 v226, 4, v242
  v_mfma_f32_16x16x32_bf16 v[0:3], a[132:135], v[132:135], v[0:3]
  v_mul_u32_u24 v226, 0xd80, v226
  v_mfma_f32_16x16x32_bf16 v[0:3], a[136:139], v[136:139], v[0:3]
  ds_read_b128 a[148:151], v213 offset:4096
  s_mul_i32 s35, s3, 552960
  s_lshl_b32 s38, s33, 4
  s_add_u32 s35, s35, s38
  s_add_u32 m0, s50, 0
  v_mfma_f32_16x16x32_bf16 v[0:3], a[140:143], v[140:143], v[0:3]
  buffer_load_dwordx4 v226, s[20:23], s35 offen lds
  v_mfma_f32_16x16x32_bf16 v[8:11], a[140:143], v[156:159], 0
  ds_read_b128 a[152:155], v214 offset:4096
  v_mfma_f32_16x16x32_bf16 v[8:11], a[136:139], v[152:155], v[8:11]
  v_mfma_f32_16x16x32_bf16 v[8:11], a[132:135], v[148:151], v[8:11]
  ds_read_b128 a[156:159], v215 offset:4096
  v_mfma_f32_16x16x32_bf16 v[8:11], a[128:131], v[144:147], v[8:11]
  v_mfma_f32_16x16x32_bf16 v[16:19], a[128:131], v[160:163], 0
  v_mfma_f32_16x16x32_bf16 v[16:19], a[132:135], v[164:167], v[16:19]
  v_mfma_f32_16x16x32_bf16 v[16:19], a[136:139], v[168:171], v[16:19]
  v_mfma_f32_16x16x32_bf16 v[16:19], a[140:143], v[172:175], v[16:19]
  v_max3_f32 v192, v0, v1, v2
  s_nop 2
  v_max3_f32 v196, v8, v9, v10
  v_mfma_f32_16x16x32_bf16 v[24:27], a[140:143], v[188:191], 0
  v_max_f32 v192, v192, v3
  v_max_f32 v196, v196, v11
  v_mfma_f32_16x16x32_bf16 v[24:27], a[136:139], v[184:187], v[24:27]
  v_mov_b32 v245, v192
  v_mov_b32 v246, v196
  v_mfma_f32_16x16x32_bf16 v[24:27], a[132:135], v[180:183], v[24:27]
  v_permlane16_swap_b32 v192, v245
  v_permlane16_swap_b32 v196, v246
  v_mfma_f32_16x16x32_bf16 v[24:27], a[128:131], v[176:179], v[24:27]
  s_waitcnt lgkmcnt(0)
  v_max_f32 v192, v192, v245
  v_max_f32 v196, v196, v246
  v_mfma_f32_16x16x32_bf16 v[4:7], a[144:147], v[128:131], 0
  ds_read_b128 a[128:131], v212 offset:8192
  v_mov_b32 v245, v192
  v_mfma_f32_16x16x32_bf16 v[4:7], a[148:151], v[132:135], v[4:7]
  v_mov_b32 v246, v196
  v_permlane32_swap_b32 v192, v245
  v_mfma_f32_16x16x32_bf16 v[4:7], a[152:155], v[136:139], v[4:7]
  ds_read_b128 a[132:135], v213 offset:8192
  v_permlane32_swap_b32 v196, v246
  v_mfma_f32_16x16x32_bf16 v[4:7], a[156:159], v[140:143], v[4:7]
  v_max_f32 v192, v192, v245
  v_max_f32 v196, v196, v246
  v_mfma_f32_16x16x32_bf16 v[12:15], a[156:159], v[156:159], 0
  ds_read_b128 a[136:139], v214 offset:8192
  v_sub_f32 v193, 0, v192
  v_mfma_f32_16x16x32_bf16 v[12:15], a[152:155], v[152:155], v[12:15]
  v_sub_f32 v197, 0, v196
  v_sub_f32 v194, 0, v192
  v_mfma_f32_16x16x32_bf16 v[12:15], a[148:151], v[148:151], v[12:15]
  ds_read_b128 a[140:143], v215 offset:8192
  v_sub_f32 v198, 0, v196
  v_mfma_f32_16x16x32_bf16 v[12:15], a[144:147], v[144:147], v[12:15]
  v_sub_f32 v195, 0, v192
  v_sub_f32 v199, 0, v196
  v_mfma_f32_16x16x32_bf16 v[20:23], a[144:147], v[160:163], 0
  v_sub_f32 v192, 0, v192
  v_sub_f32 v196, 0, v196
  v_mfma_f32_16x16x32_bf16 v[20:23], a[148:151], v[164:167], v[20:23]
  v_max3_f32 v200, v16, v17, v18
  v_max3_f32 v204, v24, v25, v26
  v_mfma_f32_16x16x32_bf16 v[20:23], a[152:155], v[168:171], v[20:23]
  v_max_f32 v200, v200, v19
  v_max_f32 v204, v204, v27
  v_mfma_f32_16x16x32_bf16 v[20:23], a[156:159], v[172:175], v[20:23]
  v_mov_b32 v247, v200
  v_mov_b32 v248, v204
  v_mfma_f32_16x16x32_bf16 v[28:31], a[156:159], v[188:191], 0
  v_permlane16_swap_b32 v200, v247
  v_permlane16_swap_b32 v204, v248
  v_mfma_f32_16x16x32_bf16 v[28:31], a[152:155], v[184:187], v[28:31]
  v_max_f32 v200, v200, v247
  v_max_f32 v204, v204, v248
  v_mfma_f32_16x16x32_bf16 v[28:31], a[148:151], v[180:183], v[28:31]
  v_mov_b32 v247, v200
  v_mov_b32 v248, v204
  s_nop 0
  v_permlane32_swap_b32 v200, v247
  v_permlane32_swap_b32 v204, v248
  v_max_f32 v200, v200, v247
  v_max_f32 v204, v204, v248
  v_sub_f32 v201, 0, v200
  v_sub_f32 v205, 0, v204
  v_sub_f32 v202, 0, v200
  v_sub_f32 v206, 0, v204
  v_sub_f32 v203, 0, v200
  v_sub_f32 v207, 0, v204
  v_sub_f32 v200, 0, v200
  v_sub_f32 v204, 0, v204
  v_mfma_f32_16x16x32_bf16 v[28:31], a[144:147], v[176:179], v[28:31]
  s_waitcnt lgkmcnt(0)
  v_add_f32 v0, v192, v0
  v_add_f32 v1, v192, v1
  v_mfma_f32_16x16x32_bf16 v[32:35], a[128:131], v[128:131], v[192:195]
  ds_read_b128 a[144:147], v212 offset:12288
  v_add_f32 v2, v192, v2
  v_mfma_f32_16x16x32_bf16 v[32:35], a[132:135], v[132:135], v[32:35]
  v_add_f32 v3, v192, v3
  v_mfma_f32_16x16x32_bf16 v[32:35], a[136:139], v[136:139], v[32:35]
  ds_read_b128 a[148:151], v213 offset:12288
  v_mfma_f32_16x16x32_bf16 v[32:35], a[140:143], v[140:143], v[32:35]
  v_exp_f32 v0, v0
  v_mfma_f32_16x16x32_bf16 v[40:43], a[140:143], v[156:159], v[196:199]
  ds_read_b128 a[152:155], v214 offset:12288
  v_mfma_f32_16x16x32_bf16 v[40:43], a[136:139], v[152:155], v[40:43]
  v_exp_f32 v1, v1
  v_mfma_f32_16x16x32_bf16 v[40:43], a[132:135], v[148:151], v[40:43]
  ds_read_b128 a[156:159], v215 offset:12288
  v_mfma_f32_16x16x32_bf16 v[40:43], a[128:131], v[144:147], v[40:43]
  v_exp_f32 v2, v2
  v_mfma_f32_16x16x32_bf16 v[48:51], a[128:131], v[160:163], v[200:203]
  v_cvt_pk_bf16_f32 v0, v0, v1
  v_mfma_f32_16x16x32_bf16 v[48:51], a[132:135], v[164:167], v[48:51]
  v_exp_f32 v3, v3
  v_mfma_f32_16x16x32_bf16 v[48:51], a[136:139], v[168:171], v[48:51]
  v_add_f32 v8, v196, v8
  v_add_f32 v9, v196, v9
  v_mfma_f32_16x16x32_bf16 v[48:51], a[140:143], v[172:175], v[48:51]
  v_add_f32 v10, v196, v10
  v_add_f32 v11, v196, v11
  v_mfma_f32_16x16x32_bf16 v[56:59], a[140:143], v[188:191], v[204:207]
  v_exp_f32 v8, v8
  v_mfma_f32_16x16x32_bf16 v[56:59], a[136:139], v[184:187], v[56:59]
  v_exp_f32 v9, v9
  v_mfma_f32_16x16x32_bf16 v[56:59], a[132:135], v[180:183], v[56:59]
  v_exp_f32 v10, v10
  v_mfma_f32_16x16x32_bf16 v[56:59], a[128:131], v[176:179], v[56:59]
  s_waitcnt lgkmcnt(0)
  v_cvt_pk_bf16_f32 v8, v8, v9
  v_mfma_f32_16x16x32_bf16 v[36:39], a[144:147], v[128:131], v[192:195]
  s_waitcnt vmcnt(11)
  v_exp_f32 v11, v11
  v_mfma_f32_16x16x32_bf16 v[36:39], a[148:151], v[132:135], v[36:39]
  s_barrier
  v_cvt_pk_bf16_f32 v1, v2, v3
  v_add_f32 v16, v200, v16
  v_mfma_f32_16x16x32_bf16 v[36:39], a[152:155], v[136:139], v[36:39]
  ds_read_b128 a[128:131], v212 offset:16384
  v_add_f32 v17, v200, v17
  v_mfma_f32_16x16x32_bf16 v[36:39], a[156:159], v[140:143], v[36:39]
  v_add_f32 v18, v200, v18
  v_add_f32 v19, v200, v19
  v_mfma_f32_16x16x32_bf16 v[44:47], a[156:159], v[156:159], v[196:199]
  ds_read_b128 a[132:135], v213 offset:16384
  v_mfma_f32_16x16x32_bf16 v[44:47], a[152:155], v[152:155], v[44:47]
  v_exp_f32 v16, v16
  v_mfma_f32_16x16x32_bf16 v[44:47], a[148:151], v[148:151], v[44:47]
  ds_read_b128 a[136:139], v214 offset:16384
  v_mfma_f32_16x16x32_bf16 v[44:47], a[144:147], v[144:147], v[44:47]
  v_exp_f32 v17, v17
  v_mfma_f32_16x16x32_bf16 v[52:55], a[144:147], v[160:163], v[200:203]
  ds_read_b128 a[140:143], v215 offset:16384
  v_mfma_f32_16x16x32_bf16 v[52:55], a[148:151], v[164:167], v[52:55]
  v_exp_f32 v18, v18
  v_mfma_f32_16x16x32_bf16 v[52:55], a[152:155], v[168:171], v[52:55]
  v_cvt_pk_bf16_f32 v16, v16, v17
  v_mfma_f32_16x16x32_bf16 v[52:55], a[156:159], v[172:175], v[52:55]
  v_exp_f32 v19, v19
  v_mfma_f32_16x16x32_bf16 v[60:63], a[156:159], v[188:191], v[204:207]
  v_cvt_pk_bf16_f32 v9, v10, v11
  v_add_f32 v24, v204, v24
  v_mfma_f32_16x16x32_bf16 v[60:63], a[152:155], v[184:187], v[60:63]
  v_add_f32 v25, v204, v25
  v_add_f32 v26, v204, v26
  v_mfma_f32_16x16x32_bf16 v[60:63], a[148:151], v[180:183], v[60:63]
  v_add_f32 v27, v204, v27
  v_mfma_f32_16x16x32_bf16 v[60:63], a[144:147], v[176:179], v[60:63]
  s_waitcnt lgkmcnt(0)
  v_exp_f32 v24, v24
  v_exp_f32 v25, v25
  v_exp_f32 v26, v26
  v_cvt_pk_bf16_f32 v24, v24, v25
  v_exp_f32 v27, v27
  v_cvt_pk_bf16_f32 v17, v18, v19
  v_add_f32 v4, v192, v4
  v_add_f32 v5, v192, v5
  v_add_f32 v6, v192, v6
  v_add_f32 v7, v192, v7
  v_exp_f32 v4, v4
  v_exp_f32 v5, v5
  v_exp_f32 v6, v6
  v_cvt_pk_bf16_f32 v2, v4, v5
  v_exp_f32 v7, v7
  v_cvt_pk_bf16_f32 v25, v26, v27
  v_add_f32 v12, v196, v12
  v_add_f32 v13, v196, v13
  v_add_f32 v14, v196, v14
  v_add_f32 v15, v196, v15
  v_exp_f32 v12, v12
  v_exp_f32 v13, v13
  v_exp_f32 v14, v14
  v_cvt_pk_bf16_f32 v10, v12, v13
  v_exp_f32 v15, v15
  v_cvt_pk_bf16_f32 v3, v6, v7
  v_add_f32 v20, v200, v20
  v_add_f32 v21, v200, v21
  v_add_f32 v22, v200, v22
  v_add_f32 v23, v200, v23
  v_exp_f32 v20, v20
  v_exp_f32 v21, v21
  v_exp_f32 v22, v22
  v_cvt_pk_bf16_f32 v18, v20, v21
  v_exp_f32 v23, v23
  v_cvt_pk_bf16_f32 v11, v14, v15
  v_add_f32 v28, v204, v28
  v_add_f32 v29, v204, v29
  v_add_f32 v30, v204, v30
  v_add_f32 v31, v204, v31
  v_exp_f32 v28, v28
  v_exp_f32 v29, v29
  v_exp_f32 v30, v30
  v_cvt_pk_bf16_f32 v26, v28, v29
  v_exp_f32 v31, v31
  v_cvt_pk_bf16_f32 v19, v22, v23
  v_exp_f32 v32, v32
  v_exp_f32 v33, v33
  v_exp_f32 v34, v34
  v_cvt_pk_bf16_f32 v32, v32, v33
  v_exp_f32 v35, v35
  v_cvt_pk_bf16_f32 v27, v30, v31
  v_exp_f32 v40, v40
  v_exp_f32 v41, v41
  v_exp_f32 v42, v42
  v_cvt_pk_bf16_f32 v40, v40, v41
  v_exp_f32 v43, v43
  v_cvt_pk_bf16_f32 v33, v34, v35
  v_exp_f32 v48, v48
  v_exp_f32 v49, v49
  v_exp_f32 v50, v50
  v_cvt_pk_bf16_f32 v48, v48, v49
  v_exp_f32 v51, v51
  v_cvt_pk_bf16_f32 v41, v42, v43
  v_exp_f32 v56, v56
  v_exp_f32 v57, v57
  v_exp_f32 v58, v58
  v_cvt_pk_bf16_f32 v56, v56, v57
  v_exp_f32 v59, v59
  v_cvt_pk_bf16_f32 v49, v50, v51
  v_exp_f32 v36, v36
  v_exp_f32 v37, v37
  v_exp_f32 v38, v38
  v_cvt_pk_bf16_f32 v34, v36, v37
  v_exp_f32 v39, v39
  v_cvt_pk_bf16_f32 v57, v58, v59
  v_exp_f32 v44, v44
  v_exp_f32 v45, v45
  v_exp_f32 v46, v46
  v_cvt_pk_bf16_f32 v42, v44, v45
  v_exp_f32 v47, v47
  v_cvt_pk_bf16_f32 v35, v38, v39
  v_exp_f32 v52, v52
  v_exp_f32 v53, v53
  v_exp_f32 v54, v54
  v_cvt_pk_bf16_f32 v50, v52, v53
  v_exp_f32 v55, v55
  v_cvt_pk_bf16_f32 v43, v46, v47
  v_exp_f32 v60, v60
  v_exp_f32 v61, v61
  v_exp_f32 v62, v62
  v_cvt_pk_bf16_f32 v58, v60, v61
  v_exp_f32 v63, v63
  v_cvt_pk_bf16_f32 v51, v54, v55
  v_cvt_pk_bf16_f32 v59, v62, v63
  v_mfma_f32_16x16x32_bf16 v[64:67], a[128:131], v[128:131], v[192:195]
  v_mfma_f32_16x16x32_bf16 v[64:67], a[132:135], v[132:135], v[64:67]
  ds_read_b128 a[144:147], v212 offset:20480
  v_mfma_f32_16x16x32_bf16 v[64:67], a[136:139], v[136:139], v[64:67]
  v_mfma_f32_16x16x32_bf16 v[64:67], a[140:143], v[140:143], v[64:67]
  ds_read_b128 a[148:151], v213 offset:20480
  v_mfma_f32_16x16x32_bf16 v[72:75], a[140:143], v[156:159], v[196:199]
  v_mfma_f32_16x16x32_bf16 v[72:75], a[136:139], v[152:155], v[72:75]
  ds_read_b128 a[152:155], v214 offset:20480
  v_mfma_f32_16x16x32_bf16 v[72:75], a[132:135], v[148:151], v[72:75]
  v_mfma_f32_16x16x32_bf16 v[72:75], a[128:131], v[144:147], v[72:75]
  ds_read_b128 a[156:159], v215 offset:20480
  v_mfma_f32_16x16x32_bf16 v[80:83], a[128:131], v[160:163], v[200:203]
  s_add_u32 m0, s28, 98304
  v_exp_f32 v64, v64
  v_mfma_f32_16x16x32_bf16 v[80:83], a[132:135], v[164:167], v[80:83]
  buffer_load_dwordx4 v236, s[16:19], s29 offen offset:0 lds
  v_mfma_f32_16x16x32_bf16 v[80:83], a[136:139], v[168:171], v[80:83]
  v_exp_f32 v65, v65
  v_mfma_f32_16x16x32_bf16 v[80:83], a[140:143], v[172:175], v[80:83]
  v_cvt_pk_bf16_f32 v64, v64, v65
  v_mfma_f32_16x16x32_bf16 v[88:91], a[140:143], v[188:191], v[204:207]
  v_exp_f32 v66, v66
  v_mfma_f32_16x16x32_bf16 v[88:91], a[136:139], v[184:187], v[88:91]
  buffer_load_dwordx4 v237, s[16:19], s29 offen offset:1024 lds
  v_mfma_f32_16x16x32_bf16 v[88:91], a[132:135], v[180:183], v[88:91]
  s_waitcnt lgkmcnt(0)
  v_exp_f32 v67, v67
  v_mfma_f32_16x16x32_bf16 v[88:91], a[128:131], v[176:179], v[88:91]
  v_cvt_pk_bf16_f32 v65, v66, v67
  v_mfma_f32_16x16x32_bf16 v[68:71], a[144:147], v[128:131], v[192:195]
  v_exp_f32 v72, v72
  v_mfma_f32_16x16x32_bf16 v[68:71], a[148:151], v[132:135], v[68:71]
  ds_read_b128 a[128:131], v212 offset:24576
  v_mfma_f32_16x16x32_bf16 v[68:71], a[152:155], v[136:139], v[68:71]
  v_exp_f32 v73, v73
  v_mfma_f32_16x16x32_bf16 v[68:71], a[156:159], v[140:143], v[68:71]
  ds_read_b128 a[132:135], v213 offset:24576
  v_cvt_pk_bf16_f32 v72, v72, v73
  v_mfma_f32_16x16x32_bf16 v[76:79], a[156:159], v[156:159], v[196:199]
  v_exp_f32 v74, v74
  v_mfma_f32_16x16x32_bf16 v[76:79], a[152:155], v[152:155], v[76:79]
  ds_read_b128 a[136:139], v214 offset:24576
  v_mfma_f32_16x16x32_bf16 v[76:79], a[148:151], v[148:151], v[76:79]
  v_exp_f32 v75, v75
  v_mfma_f32_16x16x32_bf16 v[76:79], a[144:147], v[144:147], v[76:79]
  ds_read_b128 a[140:143], v215 offset:24576
  v_cvt_pk_bf16_f32 v73, v74, v75
  v_mfma_f32_16x16x32_bf16 v[84:87], a[144:147], v[160:163], v[200:203]
  v_exp_f32 v80, v80
  v_mfma_f32_16x16x32_bf16 v[84:87], a[148:151], v[164:167], v[84:87]
  buffer_load_dwordx4 v236, s[16:19], s29 offen offset:2048 lds
  v_mfma_f32_16x16x32_bf16 v[84:87], a[152:155], v[168:171], v[84:87]
  v_exp_f32 v81, v81
  v_mfma_f32_16x16x32_bf16 v[84:87], a[156:159], v[172:175], v[84:87]
  v_cvt_pk_bf16_f32 v80, v80, v81
  v_mfma_f32_16x16x32_bf16 v[92:95], a[156:159], v[188:191], v[204:207]
  v_exp_f32 v82, v82
  v_mfma_f32_16x16x32_bf16 v[92:95], a[152:155], v[184:187], v[92:95]
  buffer_load_dwordx4 v237, s[16:19], s29 offen offset:3072 lds
  v_mfma_f32_16x16x32_bf16 v[92:95], a[148:151], v[180:183], v[92:95]
  s_waitcnt lgkmcnt(0)
  s_add_u32 s29, s29, 16384
  v_exp_f32 v83, v83
  v_mfma_f32_16x16x32_bf16 v[92:95], a[144:147], v[176:179], v[92:95]
  v_cvt_pk_bf16_f32 v81, v82, v83
  v_mfma_f32_16x16x32_bf16 v[96:99], a[128:131], v[128:131], v[192:195]
  s_add_u32 m0, s28, 49152
  v_exp_f32 v88, v88
  v_mfma_f32_16x16x32_bf16 v[96:99], a[132:135], v[132:135], v[96:99]
  ds_read_b128 a[144:147], v212 offset:28672
  v_mfma_f32_16x16x32_bf16 v[96:99], a[136:139], v[136:139], v[96:99]
  v_exp_f32 v89, v89
  v_mfma_f32_16x16x32_bf16 v[96:99], a[140:143], v[140:143], v[96:99]
  ds_read_b128 a[148:151], v213 offset:28672
  v_cvt_pk_bf16_f32 v88, v88, v89
  v_mfma_f32_16x16x32_bf16 v[104:107], a[140:143], v[156:159], v[196:199]
  v_exp_f32 v90, v90
  v_mfma_f32_16x16x32_bf16 v[104:107], a[136:139], v[152:155], v[104:107]
  ds_read_b128 a[152:155], v214 offset:28672
  v_mfma_f32_16x16x32_bf16 v[104:107], a[132:135], v[148:151], v[104:107]
  v_exp_f32 v91, v91
  v_mfma_f32_16x16x32_bf16 v[104:107], a[128:131], v[144:147], v[104:107]
  ds_read_b128 a[156:159], v215 offset:28672
  v_cvt_pk_bf16_f32 v89, v90, v91
  v_mfma_f32_16x16x32_bf16 v[112:115], a[128:131], v[160:163], v[200:203]
  v_exp_f32 v68, v68
  v_mfma_f32_16x16x32_bf16 v[112:115], a[132:135], v[164:167], v[112:115]
  buffer_load_dwordx4 v232, s[12:15], s29 offen offset:0 lds
  v_mfma_f32_16x16x32_bf16 v[112:115], a[136:139], v[168:171], v[112:115]
  v_exp_f32 v69, v69
  v_mfma_f32_16x16x32_bf16 v[112:115], a[140:143], v[172:175], v[112:115]
  v_cvt_pk_bf16_f32 v66, v68, v69
  v_mfma_f32_16x16x32_bf16 v[120:123], a[140:143], v[188:191], v[204:207]
  v_exp_f32 v70, v70
  v_mfma_f32_16x16x32_bf16 v[120:123], a[136:139], v[184:187], v[120:123]
  buffer_load_dwordx4 v233, s[12:15], s29 offen offset:1024 lds
  v_mfma_f32_16x16x32_bf16 v[120:123], a[132:135], v[180:183], v[120:123]
  s_waitcnt lgkmcnt(0)
  v_exp_f32 v71, v71
  v_mfma_f32_16x16x32_bf16 v[120:123], a[128:131], v[176:179], v[120:123]
  v_cvt_pk_bf16_f32 v67, v70, v71
  v_mfma_f32_16x16x32_bf16 v[100:103], a[144:147], v[128:131], v[192:195]
  v_exp_f32 v76, v76
  v_mfma_f32_16x16x32_bf16 v[100:103], a[148:151], v[132:135], v[100:103]
  buffer_load_dwordx4 v234, s[12:15], s29 offen offset:2048 lds
  v_mfma_f32_16x16x32_bf16 v[100:103], a[152:155], v[136:139], v[100:103]
  v_exp_f32 v77, v77
  v_mfma_f32_16x16x32_bf16 v[100:103], a[156:159], v[140:143], v[100:103]
  v_cvt_pk_bf16_f32 v74, v76, v77
  v_mfma_f32_16x16x32_bf16 v[108:111], a[156:159], v[156:159], v[196:199]
  v_exp_f32 v78, v78
  v_mfma_f32_16x16x32_bf16 v[108:111], a[152:155], v[152:155], v[108:111]
  buffer_load_dwordx4 v235, s[12:15], s29 offen offset:3072 lds
  v_mfma_f32_16x16x32_bf16 v[108:111], a[148:151], v[148:151], v[108:111]
  v_exp_f32 v79, v79
  v_mfma_f32_16x16x32_bf16 v[108:111], a[144:147], v[144:147], v[108:111]
  v_cvt_pk_bf16_f32 v75, v78, v79
  v_mfma_f32_16x16x32_bf16 v[116:119], a[144:147], v[160:163], v[200:203]
  v_exp_f32 v84, v84
  v_mfma_f32_16x16x32_bf16 v[116:119], a[148:151], v[164:167], v[116:119]
  ds_read_b64_tr_b16 a[160:161], v216 offset:0
  s_add_u32 m0, s50, 3072
  v_mfma_f32_16x16x32_bf16 v[116:119], a[152:155], v[168:171], v[116:119]
  v_exp_f32 v85, v85
  v_mfma_f32_16x16x32_bf16 v[116:119], a[156:159], v[172:175], v[116:119]
  ds_read_b64_tr_b16 a[162:163], v216 offset:4096
  v_cvt_pk_bf16_f32 v82, v84, v85
  v_mfma_f32_16x16x32_bf16 v[124:127], a[156:159], v[188:191], v[204:207]
  v_exp_f32 v86, v86
  v_mfma_f32_16x16x32_bf16 v[124:127], a[152:155], v[184:187], v[124:127]
  ds_read_b64_tr_b16 a[164:165], v216 offset:8192
  buffer_load_dwordx4 v226, s[44:47], s35 offen lds
  s_add_u32 s35, s35, 221184
  v_mfma_f32_16x16x32_bf16 v[124:127], a[148:151], v[180:183], v[124:127]
  v_exp_f32 v87, v87
  v_mfma_f32_16x16x32_bf16 v[124:127], a[144:147], v[176:179], v[124:127]
  ds_read_b64_tr_b16 a[166:167], v216 offset:12288
  v_cvt_pk_bf16_f32 v83, v86, v87
  v_mfma_f32_16x16x32_bf16 a[192:195], a[208:211], v[0:3], 0
  v_exp_f32 v92, v92
  v_mfma_f32_16x16x32_bf16 a[192:195], a[208:211], v[32:35], a[192:195]
  ds_read_b64_tr_b16 a[168:169], v217 offset:0
  v_mfma_f32_16x16x32_bf16 a[196:199], a[208:211], v[8:11], 0
  v_exp_f32 v93, v93
  v_mfma_f32_16x16x32_bf16 a[196:199], a[208:211], v[40:43], a[196:199]
  ds_read_b64_tr_b16 a[170:171], v217 offset:4096
  v_cvt_pk_bf16_f32 v90, v92, v93
  v_mfma_f32_16x16x32_bf16 a[200:203], a[208:211], v[16:19], 0
  v_exp_f32 v94, v94
  v_mfma_f32_16x16x32_bf16 a[200:203], a[208:211], v[48:51], a[200:203]
  ds_read_b64_tr_b16 a[172:173], v217 offset:8192
  v_mfma_f32_16x16x32_bf16 a[204:207], a[208:211], v[24:27], 0
  s_waitcnt lgkmcnt(3)
  v_exp_f32 v95, v95
  v_mfma_f32_16x16x32_bf16 a[204:207], a[208:211], v[56:59], a[204:207]
  ds_read_b64_tr_b16 a[174:175], v217 offset:12288
  v_cvt_pk_bf16_f32 v91, v94, v95
  v_mfma_f32_16x16x32_bf16 a[0:3], a[160:163], v[0:3], 0
  v_exp_f32 v96, v96
  v_mfma_f32_16x16x32_bf16 a[0:3], a[164:167], v[32:35], a[0:3]
  ds_read_b64_tr_b16 a[176:177], v218 offset:0
  v_mfma_f32_16x16x32_bf16 a[4:7], a[164:167], v[40:43], 0
  v_exp_f32 v97, v97
  v_mfma_f32_16x16x32_bf16 a[4:7], a[160:163], v[8:11], a[4:7]
  ds_read_b64_tr_b16 a[178:179], v218 offset:4096
  v_cvt_pk_bf16_f32 v96, v96, v97
  v_mfma_f32_16x16x32_bf16 a[8:11], a[160:163], v[16:19], 0
  v_exp_f32 v98, v98
  v_mfma_f32_16x16x32_bf16 a[8:11], a[164:167], v[48:51], a[8:11]
  ds_read_b64_tr_b16 a[180:181], v218 offset:8192
  v_mfma_f32_16x16x32_bf16 a[12:15], a[164:167], v[56:59], 0
  s_waitcnt lgkmcnt(3)
  v_exp_f32 v99, v99
  v_mfma_f32_16x16x32_bf16 a[12:15], a[160:163], v[24:27], a[12:15]
  ds_read_b64_tr_b16 a[182:183], v218 offset:12288
  v_cvt_pk_bf16_f32 v97, v98, v99
  v_mfma_f32_16x16x32_bf16 a[16:19], a[168:171], v[0:3], 0
  v_exp_f32 v104, v104
  v_mfma_f32_16x16x32_bf16 a[16:19], a[172:175], v[32:35], a[16:19]
  ds_read_b64_tr_b16 a[184:185], v219 offset:0
  v_mfma_f32_16x16x32_bf16 a[20:23], a[172:175], v[40:43], 0
  v_exp_f32 v105, v105
  v_mfma_f32_16x16x32_bf16 a[20:23], a[168:171], v[8:11], a[20:23]
  ds_read_b64_tr_b16 a[186:187], v219 offset:4096
  v_cvt_pk_bf16_f32 v104, v104, v105
  v_mfma_f32_16x16x32_bf16 a[24:27], a[168:171], v[16:19], 0
  v_exp_f32 v106, v106
  v_mfma_f32_16x16x32_bf16 a[24:27], a[172:175], v[48:51], a[24:27]
  ds_read_b64_tr_b16 a[188:189], v219 offset:8192
  v_mfma_f32_16x16x32_bf16 a[28:31], a[172:175], v[56:59], 0
  s_waitcnt lgkmcnt(3)
  v_exp_f32 v107, v107
  v_mfma_f32_16x16x32_bf16 a[28:31], a[168:171], v[24:27], a[28:31]
  ds_read_b64_tr_b16 a[190:191], v219 offset:12288
  v_cvt_pk_bf16_f32 v105, v106, v107
  v_mfma_f32_16x16x32_bf16 a[32:35], a[176:179], v[0:3], 0
  v_exp_f32 v112, v112
  v_mfma_f32_16x16x32_bf16 a[32:35], a[180:183], v[32:35], a[32:35]
  ds_read_b64_tr_b16 a[160:161], v220 offset:0
  v_mfma_f32_16x16x32_bf16 a[36:39], a[180:183], v[40:43], 0
  v_exp_f32 v113, v113
  v_mfma_f32_16x16x32_bf16 a[36:39], a[176:179], v[8:11], a[36:39]
  ds_read_b64_tr_b16 a[162:163], v220 offset:4096
  v_cvt_pk_bf16_f32 v112, v112, v113
  v_mfma_f32_16x16x32_bf16 a[40:43], a[176:179], v[16:19], 0
  v_exp_f32 v114, v114
  v_mfma_f32_16x16x32_bf16 a[40:43], a[180:183], v[48:51], a[40:43]
  ds_read_b64_tr_b16 a[164:165], v220 offset:8192
  v_mfma_f32_16x16x32_bf16 a[44:47], a[180:183], v[56:59], 0
  s_waitcnt lgkmcnt(3)
  v_exp_f32 v115, v115
  v_mfma_f32_16x16x32_bf16 a[44:47], a[176:179], v[24:27], a[44:47]
  ds_read_b64_tr_b16 a[166:167], v220 offset:12288
  v_cvt_pk_bf16_f32 v113, v114, v115
  v_mfma_f32_16x16x32_bf16 a[48:51], a[184:187], v[0:3], 0
  v_exp_f32 v120, v120
  v_mfma_f32_16x16x32_bf16 a[48:51], a[188:191], v[32:35], a[48:51]
  ds_read_b64_tr_b16 a[168:169], v221 offset:0
  v_mfma_f32_16x16x32_bf16 a[52:55], a[188:191], v[40:43], 0
  v_exp_f32 v121, v121
  v_mfma_f32_16x16x32_bf16 a[52:55], a[184:187], v[8:11], a[52:55]
  ds_read_b64_tr_b16 a[170:171], v221 offset:4096
  v_cvt_pk_bf16_f32 v120, v120, v121
  v_mfma_f32_16x16x32_bf16 a[56:59], a[184:187], v[16:19], 0
  v_exp_f32 v122, v122
  v_mfma_f32_16x16x32_bf16 a[56:59], a[188:191], v[48:51], a[56:59]
  ds_read_b64_tr_b16 a[172:173], v221 offset:8192
  v_mfma_f32_16x16x32_bf16 a[60:63], a[188:191], v[56:59], 0
  s_waitcnt lgkmcnt(3)
  v_exp_f32 v123, v123
  v_mfma_f32_16x16x32_bf16 a[60:63], a[184:187], v[24:27], a[60:63]
  ds_read_b64_tr_b16 a[174:175], v221 offset:12288
  v_cvt_pk_bf16_f32 v121, v122, v123
  v_mfma_f32_16x16x32_bf16 a[64:67], a[160:163], v[0:3], 0
  v_exp_f32 v100, v100
  v_mfma_f32_16x16x32_bf16 a[64:67], a[164:167], v[32:35], a[64:67]
  ds_read_b64_tr_b16 a[176:177], v222 offset:0
  v_mfma_f32_16x16x32_bf16 a[68:71], a[164:167], v[40:43], 0
  v_exp_f32 v101, v101
  v_mfma_f32_16x16x32_bf16 a[68:71], a[160:163], v[8:11], a[68:71]
  ds_read_b64_tr_b16 a[178:179], v222 offset:4096
  v_cvt_pk_bf16_f32 v98, v100, v101
  v_mfma_f32_16x16x32_bf16 a[72:75], a[160:163], v[16:19], 0
  v_exp_f32 v102, v102
  v_mfma_f32_16x16x32_bf16 a[72:75], a[164:167], v[48:51], a[72:75]
  ds_read_b64_tr_b16 a[180:181], v222 offset:8192
  v_mfma_f32_16x16x32_bf16 a[76:79], a[164:167], v[56:59], 0
  s_waitcnt lgkmcnt(3)
  v_exp_f32 v103, v103
  v_mfma_f32_16x16x32_bf16 a[76:79], a[160:163], v[24:27], a[76:79]
  ds_read_b64_tr_b16 a[182:183], v222 offset:12288
  v_cvt_pk_bf16_f32 v99, v102, v103
  v_mfma_f32_16x16x32_bf16 a[80:83], a[168:171], v[0:3], 0
  v_exp_f32 v108, v108
  v_mfma_f32_16x16x32_bf16 a[80:83], a[172:175], v[32:35], a[80:83]
  ds_read_b64_tr_b16 a[184:185], v223 offset:0
  v_mfma_f32_16x16x32_bf16 a[84:87], a[172:175], v[40:43], 0
  v_exp_f32 v109, v109
  v_mfma_f32_16x16x32_bf16 a[84:87], a[168:171], v[8:11], a[84:87]
  ds_read_b64_tr_b16 a[186:187], v223 offset:4096
  v_cvt_pk_bf16_f32 v106, v108, v109
  v_mfma_f32_16x16x32_bf16 a[88:91], a[168:171], v[16:19], 0
  v_exp_f32 v110, v110
  v_mfma_f32_16x16x32_bf16 a[88:91], a[172:175], v[48:51], a[88:91]
  ds_read_b64_tr_b16 a[188:189], v223 offset:8192
  v_mfma_f32_16x16x32_bf16 a[92:95], a[172:175], v[56:59], 0
  s_waitcnt lgkmcnt(3)
  v_exp_f32 v111, v111
  v_mfma_f32_16x16x32_bf16 a[92:95], a[168:171], v[24:27], a[92:95]
  ds_read_b64_tr_b16 a[190:191], v223 offset:12288
  v_cvt_pk_bf16_f32 v107, v110, v111
  v_mfma_f32_16x16x32_bf16 a[96:99], a[176:179], v[0:3], 0
  s_waitcnt vmcnt(10)
  v_exp_f32 v116, v116
  v_mfma_f32_16x16x32_bf16 a[96:99], a[180:183], v[32:35], a[96:99]
  v_mfma_f32_16x16x32_bf16 a[100:103], a[180:183], v[40:43], 0
  s_barrier
  v_exp_f32 v117, v117
  v_mfma_f32_16x16x32_bf16 a[100:103], a[176:179], v[8:11], a[100:103]
  ds_read_b128 a[128:131], v212 offset:32768
  v_cvt_pk_bf16_f32 v114, v116, v117
  v_mfma_f32_16x16x32_bf16 a[104:107], a[176:179], v[16:19], 0
  v_exp_f32 v118, v118
  v_mfma_f32_16x16x32_bf16 a[104:107], a[180:183], v[48:51], a[104:107]
  ds_read_b128 a[132:135], v213 offset:32768
  v_mfma_f32_16x16x32_bf16 a[108:111], a[180:183], v[56:59], 0
  s_waitcnt lgkmcnt(2)
  v_exp_f32 v119, v119
  v_mfma_f32_16x16x32_bf16 a[108:111], a[176:179], v[24:27], a[108:111]
  ds_read_b128 a[136:139], v214 offset:32768
  v_cvt_pk_bf16_f32 v115, v118, v119
  v_mfma_f32_16x16x32_bf16 a[112:115], a[184:187], v[0:3], 0
  v_exp_f32 v124, v124
  v_mfma_f32_16x16x32_bf16 a[112:115], a[188:191], v[32:35], a[112:115]
  ds_read_b128 a[140:143], v215 offset:32768
  v_mfma_f32_16x16x32_bf16 a[116:119], a[188:191], v[40:43], 0
  v_exp_f32 v125, v125
  v_mfma_f32_16x16x32_bf16 a[116:119], a[184:187], v[8:11], a[116:119]
  v_cvt_pk_bf16_f32 v122, v124, v125
  v_mfma_f32_16x16x32_bf16 a[120:123], a[184:187], v[16:19], 0
  v_exp_f32 v126, v126
  v_mfma_f32_16x16x32_bf16 a[120:123], a[188:191], v[48:51], a[120:123]
  v_mfma_f32_16x16x32_bf16 a[124:127], a[188:191], v[56:59], 0
  s_waitcnt lgkmcnt(0)
  v_exp_f32 v127, v127
  v_mfma_f32_16x16x32_bf16 a[124:127], a[184:187], v[24:27], a[124:127]
  v_cvt_pk_bf16_f32 v123, v126, v127
  v_mfma_f32_16x16x32_bf16 v[0:3], a[128:131], v[128:131], v[192:195]
  v_mfma_f32_16x16x32_bf16 v[0:3], a[132:135], v[132:135], v[0:3]
  ds_read_b128 a[144:147], v212 offset:36864
  v_mfma_f32_16x16x32_bf16 v[0:3], a[136:139], v[136:139], v[0:3]
  v_mfma_f32_16x16x32_bf16 v[0:3], a[140:143], v[140:143], v[0:3]
  ds_read_b128 a[148:151], v213 offset:36864
  v_mfma_f32_16x16x32_bf16 v[8:11], a[140:143], v[156:159], v[196:199]
  v_mfma_f32_16x16x32_bf16 v[8:11], a[136:139], v[152:155], v[8:11]
  ds_read_b128 a[152:155], v214 offset:36864
  v_mfma_f32_16x16x32_bf16 v[8:11], a[132:135], v[148:151], v[8:11]
  v_mfma_f32_16x16x32_bf16 v[8:11], a[128:131], v[144:147], v[8:11]
  ds_read_b128 a[156:159], v215 offset:36864
  v_mfma_f32_16x16x32_bf16 v[16:19], a[128:131], v[160:163], v[200:203]
  s_add_u32 m0, s28, 114688
  v_exp_f32 v0, v0
  v_mfma_f32_16x16x32_bf16 v[16:19], a[132:135], v[164:167], v[16:19]
  buffer_load_dwordx4 v236, s[16:19], s29 offen offset:0 lds
  v_mfma_f32_16x16x32_bf16 v[16:19], a[136:139], v[168:171], v[16:19]
  v_exp_f32 v1, v1
  v_mfma_f32_16x16x32_bf16 v[16:19], a[140:143], v[172:175], v[16:19]
  v_cvt_pk_bf16_f32 v0, v0, v1
  v_mfma_f32_16x16x32_bf16 v[24:27], a[140:143], v[188:191], v[204:207]
  v_exp_f32 v2, v2
  v_mfma_f32_16x16x32_bf16 v[24:27], a[136:139], v[184:187], v[24:27]
  buffer_load_dwordx4 v237, s[16:19], s29 offen offset:1024 lds
  v_mfma_f32_16x16x32_bf16 v[24:27], a[132:135], v[180:183], v[24:27]
  s_waitcnt lgkmcnt(0)
  v_exp_f32 v3, v3
  v_mfma_f32_16x16x32_bf16 v[24:27], a[128:131], v[176:179], v[24:27]
  v_cvt_pk_bf16_f32 v1, v2, v3
  v_mfma_f32_16x16x32_bf16 v[4:7], a[144:147], v[128:131], v[192:195]
  v_exp_f32 v8, v8
  v_mfma_f32_16x16x32_bf16 v[4:7], a[148:151], v[132:135], v[4:7]
  ds_read_b128 a[128:131], v212 offset:40960
  v_mfma_f32_16x16x32_bf16 v[4:7], a[152:155], v[136:139], v[4:7]
  v_exp_f32 v9, v9
  v_mfma_f32_16x16x32_bf16 v[4:7], a[156:159], v[140:143], v[4:7]
  ds_read_b128 a[132:135], v213 offset:40960
  v_cvt_pk_bf16_f32 v8, v8, v9
  v_mfma_f32_16x16x32_bf16 v[12:15], a[156:159], v[156:159], v[196:199]
  v_exp_f32 v10, v10
  v_mfma_f32_16x16x32_bf16 v[12:15], a[152:155], v[152:155], v[12:15]
  ds_read_b128 a[136:139], v214 offset:40960
  v_mfma_f32_16x16x32_bf16 v[12:15], a[148:151], v[148:151], v[12:15]
  v_exp_f32 v11, v11
  v_mfma_f32_16x16x32_bf16 v[12:15], a[144:147], v[144:147], v[12:15]
  ds_read_b128 a[140:143], v215 offset:40960
  v_cvt_pk_bf16_f32 v9, v10, v11
  v_mfma_f32_16x16x32_bf16 v[20:23], a[144:147], v[160:163], v[200:203]
  v_exp_f32 v16, v16
  v_mfma_f32_16x16x32_bf16 v[20:23], a[148:151], v[164:167], v[20:23]
  buffer_load_dwordx4 v236, s[16:19], s29 offen offset:2048 lds
  v_mfma_f32_16x16x32_bf16 v[20:23], a[152:155], v[168:171], v[20:23]
  v_exp_f32 v17, v17
  v_mfma_f32_16x16x32_bf16 v[20:23], a[156:159], v[172:175], v[20:23]
  v_cvt_pk_bf16_f32 v16, v16, v17
  v_mfma_f32_16x16x32_bf16 v[28:31], a[156:159], v[188:191], v[204:207]
  v_exp_f32 v18, v18
  v_mfma_f32_16x16x32_bf16 v[28:31], a[152:155], v[184:187], v[28:31]
  buffer_load_dwordx4 v237, s[16:19], s29 offen offset:3072 lds
  v_mfma_f32_16x16x32_bf16 v[28:31], a[148:151], v[180:183], v[28:31]
  s_waitcnt lgkmcnt(0)
  s_add_u32 s29, s29, 16384
  v_exp_f32 v19, v19
  v_mfma_f32_16x16x32_bf16 v[28:31], a[144:147], v[176:179], v[28:31]
  v_cvt_pk_bf16_f32 v17, v18, v19
  v_mfma_f32_16x16x32_bf16 v[32:35], a[128:131], v[128:131], v[192:195]
  s_add_u32 m0, s28, 0
  v_exp_f32 v24, v24
  v_mfma_f32_16x16x32_bf16 v[32:35], a[132:135], v[132:135], v[32:35]
  ds_read_b128 a[144:147], v212 offset:45056
  v_mfma_f32_16x16x32_bf16 v[32:35], a[136:139], v[136:139], v[32:35]
  v_exp_f32 v25, v25
  v_mfma_f32_16x16x32_bf16 v[32:35], a[140:143], v[140:143], v[32:35]
  ds_read_b128 a[148:151], v213 offset:45056
  v_cvt_pk_bf16_f32 v24, v24, v25
  v_mfma_f32_16x16x32_bf16 v[40:43], a[140:143], v[156:159], v[196:199]
  v_exp_f32 v26, v26
  v_mfma_f32_16x16x32_bf16 v[40:43], a[136:139], v[152:155], v[40:43]
  ds_read_b128 a[152:155], v214 offset:45056
  v_mfma_f32_16x16x32_bf16 v[40:43], a[132:135], v[148:151], v[40:43]
  v_exp_f32 v27, v27
  v_mfma_f32_16x16x32_bf16 v[40:43], a[128:131], v[144:147], v[40:43]
  ds_read_b128 a[156:159], v215 offset:45056
  v_cvt_pk_bf16_f32 v25, v26, v27
  v_mfma_f32_16x16x32_bf16 v[48:51], a[128:131], v[160:163], v[200:203]
  v_exp_f32 v4, v4
  v_mfma_f32_16x16x32_bf16 v[48:51], a[132:135], v[164:167], v[48:51]
  buffer_load_dwordx4 v232, s[12:15], s29 offen offset:0 lds
  v_mfma_f32_16x16x32_bf16 v[48:51], a[136:139], v[168:171], v[48:51]
  v_exp_f32 v5, v5
  v_mfma_f32_16x16x32_bf16 v[48:51], a[140:143], v[172:175], v[48:51]
  v_cvt_pk_bf16_f32 v2, v4, v5
  v_mfma_f32_16x16x32_bf16 v[56:59], a[140:143], v[188:191], v[204:207]
  v_exp_f32 v6, v6
  v_mfma_f32_16x16x32_bf16 v[56:59], a[136:139], v[184:187], v[56:59]
  buffer_load_dwordx4 v233, s[12:15], s29 offen offset:1024 lds
  v_mfma_f32_16x16x32_bf16 v[56:59], a[132:135], v[180:183], v[56:59]
  s_waitcnt lgkmcnt(0)
  v_exp_f32 v7, v7
  v_mfma_f32_16x16x32_bf16 v[56:59], a[128:131], v[176:179], v[56:59]
  v_cvt_pk_bf16_f32 v3, v6, v7
  v_mfma_f32_16x16x32_bf16 v[36:39], a[144:147], v[128:131], v[192:195]
  v_exp_f32 v12, v12
  v_mfma_f32_16x16x32_bf16 v[36:39], a[148:151], v[132:135], v[36:39]
  buffer_load_dwordx4 v234, s[12:15], s29 offen offset:2048 lds
  v_mfma_f32_16x16x32_bf16 v[36:39], a[152:155], v[136:139], v[36:39]
  v_exp_f32 v13, v13
  v_mfma_f32_16x16x32_bf16 v[36:39], a[156:159], v[140:143], v[36:39]
  v_cvt_pk_bf16_f32 v10, v12, v13
  v_mfma_f32_16x16x32_bf16 v[44:47], a[156:159], v[156:159], v[196:199]
  v_exp_f32 v14, v14
  v_mfma_f32_16x16x32_bf16 v[44:47], a[152:155], v[152:155], v[44:47]
  buffer_load_dwordx4 v235, s[12:15], s29 offen offset:3072 lds
  v_mfma_f32_16x16x32_bf16 v[44:47], a[148:151], v[148:151], v[44:47]
  v_exp_f32 v15, v15
  v_mfma_f32_16x16x32_bf16 v[44:47], a[144:147], v[144:147], v[44:47]
  v_cvt_pk_bf16_f32 v11, v14, v15
  v_mfma_f32_16x16x32_bf16 v[52:55], a[144:147], v[160:163], v[200:203]
  v_exp_f32 v20, v20
  v_mfma_f32_16x16x32_bf16 v[52:55], a[148:151], v[164:167], v[52:55]
  ds_read_b64_tr_b16 a[160:161], v216 offset:16384
  s_add_u32 m0, s50, 1024
  v_mfma_f32_16x16x32_bf16 v[52:55], a[152:155], v[168:171], v[52:55]
  v_exp_f32 v21, v21
  v_mfma_f32_16x16x32_bf16 v[52:55], a[156:159], v[172:175], v[52:55]
  ds_read_b64_tr_b16 a[162:163], v216 offset:20480
  v_cvt_pk_bf16_f32 v18, v20, v21
  v_mfma_f32_16x16x32_bf16 v[60:63], a[156:159], v[188:191], v[204:207]
  v_exp_f32 v22, v22
  v_mfma_f32_16x16x32_bf16 v[60:63], a[152:155], v[184:187], v[60:63]
  ds_read_b64_tr_b16 a[164:165], v216 offset:24576
  buffer_load_dwordx4 v226, s[20:23], s35 offen lds
  v_mfma_f32_16x16x32_bf16 v[60:63], a[148:151], v[180:183], v[60:63]
  v_exp_f32 v23, v23
  v_mfma_f32_16x16x32_bf16 v[60:63], a[144:147], v[176:179], v[60:63]
  ds_read_b64_tr_b16 a[166:167], v216 offset:28672
  v_cvt_pk_bf16_f32 v19, v22, v23
  v_mfma_f32_16x16x32_bf16 a[192:195], a[208:211], v[64:67], a[192:195]
  v_exp_f32 v28, v28
  v_mfma_f32_16x16x32_bf16 a[192:195], a[208:211], v[96:99], a[192:195]
  ds_read_b64_tr_b16 a[168:169], v217 offset:16384
  v_mfma_f32_16x16x32_bf16 a[196:199], a[208:211], v[72:75], a[196:199]
  v_exp_f32 v29, v29
  v_mfma_f32_16x16x32_bf16 a[196:199], a[208:211], v[104:107], a[196:199]
  ds_read_b64_tr_b16 a[170:171], v217 offset:20480
  v_cvt_pk_bf16_f32 v26, v28, v29
  v_mfma_f32_16x16x32_bf16 a[200:203], a[208:211], v[80:83], a[200:203]
  v_exp_f32 v30, v30
  v_mfma_f32_16x16x32_bf16 a[200:203], a[208:211], v[112:115], a[200:203]
  ds_read_b64_tr_b16 a[172:173], v217 offset:24576
  v_mfma_f32_16x16x32_bf16 a[204:207], a[208:211], v[88:91], a[204:207]
  s_waitcnt lgkmcnt(3)
  v_exp_f32 v31, v31
  v_mfma_f32_16x16x32_bf16 a[204:207], a[208:211], v[120:123], a[204:207]
  ds_read_b64_tr_b16 a[174:175], v217 offset:28672
  v_cvt_pk_bf16_f32 v27, v30, v31
  v_mfma_f32_16x16x32_bf16 a[0:3], a[160:163], v[64:67], a[0:3]
  v_exp_f32 v32, v32
  v_mfma_f32_16x16x32_bf16 a[0:3], a[164:167], v[96:99], a[0:3]
  ds_read_b64_tr_b16 a[176:177], v218 offset:16384
  v_mfma_f32_16x16x32_bf16 a[4:7], a[164:167], v[104:107], a[4:7]
  v_exp_f32 v33, v33
  v_mfma_f32_16x16x32_bf16 a[4:7], a[160:163], v[72:75], a[4:7]
  ds_read_b64_tr_b16 a[178:179], v218 offset:20480
  v_cvt_pk_bf16_f32 v32, v32, v33
  v_mfma_f32_16x16x32_bf16 a[8:11], a[160:163], v[80:83], a[8:11]
  v_exp_f32 v34, v34
  v_mfma_f32_16x16x32_bf16 a[8:11], a[164:167], v[112:115], a[8:11]
  ds_read_b64_tr_b16 a[180:181], v218 offset:24576
  v_mfma_f32_16x16x32_bf16 a[12:15], a[164:167], v[120:123], a[12:15]
  s_waitcnt lgkmcnt(3)
  v_exp_f32 v35, v35
  v_mfma_f32_16x16x32_bf16 a[12:15], a[160:163], v[88:91], a[12:15]
  ds_read_b64_tr_b16 a[182:183], v218 offset:28672
  v_cvt_pk_bf16_f32 v33, v34, v35
  v_mfma_f32_16x16x32_bf16 a[16:19], a[168:171], v[64:67], a[16:19]
  v_exp_f32 v40, v40
  v_mfma_f32_16x16x32_bf16 a[16:19], a[172:175], v[96:99], a[16:19]
  ds_read_b64_tr_b16 a[184:185], v219 offset:16384
  v_mfma_f32_16x16x32_bf16 a[20:23], a[172:175], v[104:107], a[20:23]
  v_exp_f32 v41, v41
  v_mfma_f32_16x16x32_bf16 a[20:23], a[168:171], v[72:75], a[20:23]
  ds_read_b64_tr_b16 a[186:187], v219 offset:20480
  v_cvt_pk_bf16_f32 v40, v40, v41
  v_mfma_f32_16x16x32_bf16 a[24:27], a[168:171], v[80:83], a[24:27]
  v_exp_f32 v42, v42
  v_mfma_f32_16x16x32_bf16 a[24:27], a[172:175], v[112:115], a[24:27]
  ds_read_b64_tr_b16 a[188:189], v219 offset:24576
  v_mfma_f32_16x16x32_bf16 a[28:31], a[172:175], v[120:123], a[28:31]
  s_waitcnt lgkmcnt(3)
  v_exp_f32 v43, v43
  v_mfma_f32_16x16x32_bf16 a[28:31], a[168:171], v[88:91], a[28:31]
  ds_read_b64_tr_b16 a[190:191], v219 offset:28672
  v_cvt_pk_bf16_f32 v41, v42, v43
  v_mfma_f32_16x16x32_bf16 a[32:35], a[176:179], v[64:67], a[32:35]
  v_exp_f32 v48, v48
  v_mfma_f32_16x16x32_bf16 a[32:35], a[180:183], v[96:99], a[32:35]
  ds_read_b64_tr_b16 a[160:161], v220 offset:16384
  v_mfma_f32_16x16x32_bf16 a[36:39], a[180:183], v[104:107], a[36:39]
  v_exp_f32 v49, v49
  v_mfma_f32_16x16x32_bf16 a[36:39], a[176:179], v[72:75], a[36:39]
  ds_read_b64_tr_b16 a[162:163], v220 offset:20480
  v_cvt_pk_bf16_f32 v48, v48, v49
  v_mfma_f32_16x16x32_bf16 a[40:43], a[176:179], v[80:83], a[40:43]
  v_exp_f32 v50, v50
  v_mfma_f32_16x16x32_bf16 a[40:43], a[180:183], v[112:115], a[40:43]
  ds_read_b64_tr_b16 a[164:165], v220 offset:24576
  v_mfma_f32_16x16x32_bf16 a[44:47], a[180:183], v[120:123], a[44:47]
  s_waitcnt lgkmcnt(3)
  v_exp_f32 v51, v51
  v_mfma_f32_16x16x32_bf16 a[44:47], a[176:179], v[88:91], a[44:47]
  ds_read_b64_tr_b16 a[166:167], v220 offset:28672
  v_cvt_pk_bf16_f32 v49, v50, v51
  v_mfma_f32_16x16x32_bf16 a[48:51], a[184:187], v[64:67], a[48:51]
  v_exp_f32 v56, v56
  v_mfma_f32_16x16x32_bf16 a[48:51], a[188:191], v[96:99], a[48:51]
  ds_read_b64_tr_b16 a[168:169], v221 offset:16384
  v_mfma_f32_16x16x32_bf16 a[52:55], a[188:191], v[104:107], a[52:55]
  v_exp_f32 v57, v57
  v_mfma_f32_16x16x32_bf16 a[52:55], a[184:187], v[72:75], a[52:55]
  ds_read_b64_tr_b16 a[170:171], v221 offset:20480
  v_cvt_pk_bf16_f32 v56, v56, v57
  v_mfma_f32_16x16x32_bf16 a[56:59], a[184:187], v[80:83], a[56:59]
  v_exp_f32 v58, v58
  v_mfma_f32_16x16x32_bf16 a[56:59], a[188:191], v[112:115], a[56:59]
  ds_read_b64_tr_b16 a[172:173], v221 offset:24576
  v_mfma_f32_16x16x32_bf16 a[60:63], a[188:191], v[120:123], a[60:63]
  s_waitcnt lgkmcnt(3)
  v_exp_f32 v59, v59
  v_mfma_f32_16x16x32_bf16 a[60:63], a[184:187], v[88:91], a[60:63]
  ds_read_b64_tr_b16 a[174:175], v221 offset:28672
  v_cvt_pk_bf16_f32 v57, v58, v59
  v_mfma_f32_16x16x32_bf16 a[64:67], a[160:163], v[64:67], a[64:67]
  v_exp_f32 v36, v36
  v_mfma_f32_16x16x32_bf16 a[64:67], a[164:167], v[96:99], a[64:67]
  ds_read_b64_tr_b16 a[176:177], v222 offset:16384
  v_mfma_f32_16x16x32_bf16 a[68:71], a[164:167], v[104:107], a[68:71]
  v_exp_f32 v37, v37
  v_mfma_f32_16x16x32_bf16 a[68:71], a[160:163], v[72:75], a[68:71]
  ds_read_b64_tr_b16 a[178:179], v222 offset:20480
  v_cvt_pk_bf16_f32 v34, v36, v37
  v_mfma_f32_16x16x32_bf16 a[72:75], a[160:163], v[80:83], a[72:75]
  v_exp_f32 v38, v38
  v_mfma_f32_16x16x32_bf16 a[72:75], a[164:167], v[112:115], a[72:75]
  ds_read_b64_tr_b16 a[180:181], v222 offset:24576
  v_mfma_f32_16x16x32_bf16 a[76:79], a[164:167], v[120:123], a[76:79]
  s_waitcnt lgkmcnt(3)
  v_exp_f32 v39, v39
  v_mfma_f32_16x16x32_bf16 a[76:79], a[160:163], v[88:91], a[76:79]
  ds_read_b64_tr_b16 a[182:183], v222 offset:28672
  v_cvt_pk_bf16_f32 v35, v38, v39
  v_mfma_f32_16x16x32_bf16 a[80:83], a[168:171], v[64:67], a[80:83]
  v_exp_f32 v44, v44
  v_mfma_f32_16x16x32_bf16 a[80:83], a[172:175], v[96:99], a[80:83]
  ds_read_b64_tr_b16 a[184:185], v223 offset:16384
  v_mfma_f32_16x16x32_bf16 a[84:87], a[172:175], v[104:107], a[84:87]
  v_exp_f32 v45, v45
  v_mfma_f32_16x16x32_bf16 a[84:87], a[168:171], v[72:75], a[84:87]
  ds_read_b64_tr_b16 a[186:187], v223 offset:20480
  v_cvt_pk_bf16_f32 v42, v44, v45
  v_mfma_f32_16x16x32_bf16 a[88:91], a[168:171], v[80:83], a[88:91]
  v_exp_f32 v46, v46
  v_mfma_f32_16x16x32_bf16 a[88:91], a[172:175], v[112:115], a[88:91]
  ds_read_b64_tr_b16 a[188:189], v223 offset:24576
  v_mfma_f32_16x16x32_bf16 a[92:95], a[172:175], v[120:123], a[92:95]
  s_waitcnt lgkmcnt(3)
  v_exp_f32 v47, v47
  v_mfma_f32_16x16x32_bf16 a[92:95], a[168:171], v[88:91], a[92:95]
  ds_read_b64_tr_b16 a[190:191], v223 offset:28672
  v_cvt_pk_bf16_f32 v43, v46, v47
  v_mfma_f32_16x16x32_bf16 a[96:99], a[176:179], v[64:67], a[96:99]
  s_waitcnt vmcnt(10)
  v_exp_f32 v52, v52
  v_mfma_f32_16x16x32_bf16 a[96:99], a[180:183], v[96:99], a[96:99]
  v_mfma_f32_16x16x32_bf16 a[100:103], a[180:183], v[104:107], a[100:103]
  s_barrier
  v_exp_f32 v53, v53
  v_mfma_f32_16x16x32_bf16 a[100:103], a[176:179], v[72:75], a[100:103]
  ds_read_b128 a[128:131], v212 offset:49152
  v_cvt_pk_bf16_f32 v50, v52, v53
  v_mfma_f32_16x16x32_bf16 a[104:107], a[176:179], v[80:83], a[104:107]
  v_exp_f32 v54, v54
  v_mfma_f32_16x16x32_bf16 a[104:107], a[180:183], v[112:115], a[104:107]
  ds_read_b128 a[132:135], v213 offset:49152
  v_mfma_f32_16x16x32_bf16 a[108:111], a[180:183], v[120:123], a[108:111]
  s_waitcnt lgkmcnt(2)
  v_exp_f32 v55, v55
  v_mfma_f32_16x16x32_bf16 a[108:111], a[176:179], v[88:91], a[108:111]
  ds_read_b128 a[136:139], v214 offset:49152
  v_cvt_pk_bf16_f32 v51, v54, v55
  v_mfma_f32_16x16x32_bf16 a[112:115], a[184:187], v[64:67], a[112:115]
  v_exp_f32 v60, v60
  v_mfma_f32_16x16x32_bf16 a[112:115], a[188:191], v[96:99], a[112:115]
  ds_read_b128 a[140:143], v215 offset:49152
  v_mfma_f32_16x16x32_bf16 a[116:119], a[188:191], v[104:107], a[116:119]
  v_exp_f32 v61, v61
  v_mfma_f32_16x16x32_bf16 a[116:119], a[184:187], v[72:75], a[116:119]
  v_cvt_pk_bf16_f32 v58, v60, v61
  v_mfma_f32_16x16x32_bf16 a[120:123], a[184:187], v[80:83], a[120:123]
  v_exp_f32 v62, v62
  v_mfma_f32_16x16x32_bf16 a[120:123], a[188:191], v[112:115], a[120:123]
  v_mfma_f32_16x16x32_bf16 a[124:127], a[188:191], v[120:123], a[124:127]
  s_waitcnt lgkmcnt(0)
  v_exp_f32 v63, v63
  v_mfma_f32_16x16x32_bf16 a[124:127], a[184:187], v[88:91], a[124:127]
  v_cvt_pk_bf16_f32 v59, v62, v63
  v_mfma_f32_16x16x32_bf16 v[64:67], a[128:131], v[128:131], v[192:195]
  v_mfma_f32_16x16x32_bf16 v[64:67], a[132:135], v[132:135], v[64:67]
  ds_read_b128 a[144:147], v212 offset:53248
  v_mfma_f32_16x16x32_bf16 v[64:67], a[136:139], v[136:139], v[64:67]
  v_mfma_f32_16x16x32_bf16 v[64:67], a[140:143], v[140:143], v[64:67]
  ds_read_b128 a[148:151], v213 offset:53248
  v_mfma_f32_16x16x32_bf16 v[72:75], a[140:143], v[156:159], v[196:199]
  v_mfma_f32_16x16x32_bf16 v[72:75], a[136:139], v[152:155], v[72:75]
  ds_read_b128 a[152:155], v214 offset:53248
  v_mfma_f32_16x16x32_bf16 v[72:75], a[132:135], v[148:151], v[72:75]
  v_mfma_f32_16x16x32_bf16 v[72:75], a[128:131], v[144:147], v[72:75]
  ds_read_b128 a[156:159], v215 offset:53248
  v_mfma_f32_16x16x32_bf16 v[80:83], a[128:131], v[160:163], v[200:203]
  s_add_u32 m0, s28, 65536
  v_exp_f32 v64, v64
  v_mfma_f32_16x16x32_bf16 v[80:83], a[132:135], v[164:167], v[80:83]
  buffer_load_dwordx4 v236, s[16:19], s29 offen offset:0 lds
  v_mfma_f32_16x16x32_bf16 v[80:83], a[136:139], v[168:171], v[80:83]
  v_exp_f32 v65, v65
  v_mfma_f32_16x16x32_bf16 v[80:83], a[140:143], v[172:175], v[80:83]
  v_cvt_pk_bf16_f32 v64, v64, v65
  v_mfma_f32_16x16x32_bf16 v[88:91], a[140:143], v[188:191], v[204:207]
  v_exp_f32 v66, v66
  v_mfma_f32_16x16x32_bf16 v[88:91], a[136:139], v[184:187], v[88:91]
  buffer_load_dwordx4 v237, s[16:19], s29 offen offset:1024 lds
  v_mfma_f32_16x16x32_bf16 v[88:91], a[132:135], v[180:183], v[88:91]
  s_waitcnt lgkmcnt(0)
  v_exp_f32 v67, v67
  v_mfma_f32_16x16x32_bf16 v[88:91], a[128:131], v[176:179], v[88:91]
  v_cvt_pk_bf16_f32 v65, v66, v67
  v_mfma_f32_16x16x32_bf16 v[68:71], a[144:147], v[128:131], v[192:195]
  v_exp_f32 v72, v72
  v_mfma_f32_16x16x32_bf16 v[68:71], a[148:151], v[132:135], v[68:71]
  ds_read_b128 a[128:131], v212 offset:57344
  v_mfma_f32_16x16x32_bf16 v[68:71], a[152:155], v[136:139], v[68:71]
  v_exp_f32 v73, v73
  v_mfma_f32_16x16x32_bf16 v[68:71], a[156:159], v[140:143], v[68:71]
  ds_read_b128 a[132:135], v213 offset:57344
  v_cvt_pk_bf16_f32 v72, v72, v73
  v_mfma_f32_16x16x32_bf16 v[76:79], a[156:159], v[156:159], v[196:199]
  v_exp_f32 v74, v74
  v_mfma_f32_16x16x32_bf16 v[76:79], a[152:155], v[152:155], v[76:79]
  ds_read_b128 a[136:139], v214 offset:57344
  v_mfma_f32_16x16x32_bf16 v[76:79], a[148:151], v[148:151], v[76:79]
  v_exp_f32 v75, v75
  v_mfma_f32_16x16x32_bf16 v[76:79], a[144:147], v[144:147], v[76:79]
  ds_read_b128 a[140:143], v215 offset:57344
  v_cvt_pk_bf16_f32 v73, v74, v75
  v_mfma_f32_16x16x32_bf16 v[84:87], a[144:147], v[160:163], v[200:203]
  v_exp_f32 v80, v80
  v_mfma_f32_16x16x32_bf16 v[84:87], a[148:151], v[164:167], v[84:87]
  buffer_load_dwordx4 v236, s[16:19], s29 offen offset:2048 lds
  v_mfma_f32_16x16x32_bf16 v[84:87], a[152:155], v[168:171], v[84:87]
  v_exp_f32 v81, v81
  v_mfma_f32_16x16x32_bf16 v[84:87], a[156:159], v[172:175], v[84:87]
  v_cvt_pk_bf16_f32 v80, v80, v81
  v_mfma_f32_16x16x32_bf16 v[92:95], a[156:159], v[188:191], v[204:207]
  v_exp_f32 v82, v82
  v_mfma_f32_16x16x32_bf16 v[92:95], a[152:155], v[184:187], v[92:95]
  buffer_load_dwordx4 v237, s[16:19], s29 offen offset:3072 lds
  v_mfma_f32_16x16x32_bf16 v[92:95], a[148:151], v[180:183], v[92:95]
  s_waitcnt lgkmcnt(0)
  s_add_u32 s29, s29, 16384
  v_exp_f32 v83, v83
  v_mfma_f32_16x16x32_bf16 v[92:95], a[144:147], v[176:179], v[92:95]
  v_cvt_pk_bf16_f32 v81, v82, v83
  v_mfma_f32_16x16x32_bf16 v[96:99], a[128:131], v[128:131], v[192:195]
  s_add_u32 m0, s28, 16384
  v_exp_f32 v88, v88
  v_mfma_f32_16x16x32_bf16 v[96:99], a[132:135], v[132:135], v[96:99]
  ds_read_b128 a[144:147], v212 offset:61440
  v_mfma_f32_16x16x32_bf16 v[96:99], a[136:139], v[136:139], v[96:99]
  v_exp_f32 v89, v89
  v_mfma_f32_16x16x32_bf16 v[96:99], a[140:143], v[140:143], v[96:99]
  ds_read_b128 a[148:151], v213 offset:61440
  v_cvt_pk_bf16_f32 v88, v88, v89
  v_mfma_f32_16x16x32_bf16 v[104:107], a[140:143], v[156:159], v[196:199]
  v_exp_f32 v90, v90
  v_mfma_f32_16x16x32_bf16 v[104:107], a[136:139], v[152:155], v[104:107]
  ds_read_b128 a[152:155], v214 offset:61440
  v_mfma_f32_16x16x32_bf16 v[104:107], a[132:135], v[148:151], v[104:107]
  v_exp_f32 v91, v91
  v_mfma_f32_16x16x32_bf16 v[104:107], a[128:131], v[144:147], v[104:107]
  ds_read_b128 a[156:159], v215 offset:61440
  v_cvt_pk_bf16_f32 v89, v90, v91
  v_mfma_f32_16x16x32_bf16 v[112:115], a[128:131], v[160:163], v[200:203]
  v_exp_f32 v68, v68
  v_mfma_f32_16x16x32_bf16 v[112:115], a[132:135], v[164:167], v[112:115]
  buffer_load_dwordx4 v232, s[12:15], s29 offen offset:0 lds
  v_mfma_f32_16x16x32_bf16 v[112:115], a[136:139], v[168:171], v[112:115]
  v_exp_f32 v69, v69
  v_mfma_f32_16x16x32_bf16 v[112:115], a[140:143], v[172:175], v[112:115]
  v_cvt_pk_bf16_f32 v66, v68, v69
  v_mfma_f32_16x16x32_bf16 v[120:123], a[140:143], v[188:191], v[204:207]
  v_exp_f32 v70, v70
  v_mfma_f32_16x16x32_bf16 v[120:123], a[136:139], v[184:187], v[120:123]
  buffer_load_dwordx4 v233, s[12:15], s29 offen offset:1024 lds
  v_mfma_f32_16x16x32_bf16 v[120:123], a[132:135], v[180:183], v[120:123]
  s_waitcnt lgkmcnt(0)
  v_exp_f32 v71, v71
  v_mfma_f32_16x16x32_bf16 v[120:123], a[128:131], v[176:179], v[120:123]
  v_cvt_pk_bf16_f32 v67, v70, v71
  v_mfma_f32_16x16x32_bf16 v[100:103], a[144:147], v[128:131], v[192:195]
  v_exp_f32 v76, v76
  v_mfma_f32_16x16x32_bf16 v[100:103], a[148:151], v[132:135], v[100:103]
  buffer_load_dwordx4 v234, s[12:15], s29 offen offset:2048 lds
  v_mfma_f32_16x16x32_bf16 v[100:103], a[152:155], v[136:139], v[100:103]
  v_exp_f32 v77, v77
  v_mfma_f32_16x16x32_bf16 v[100:103], a[156:159], v[140:143], v[100:103]
  v_cvt_pk_bf16_f32 v74, v76, v77
  v_mfma_f32_16x16x32_bf16 v[108:111], a[156:159], v[156:159], v[196:199]
  v_exp_f32 v78, v78
  v_mfma_f32_16x16x32_bf16 v[108:111], a[152:155], v[152:155], v[108:111]
  buffer_load_dwordx4 v235, s[12:15], s29 offen offset:3072 lds
  v_mfma_f32_16x16x32_bf16 v[108:111], a[148:151], v[148:151], v[108:111]
  v_exp_f32 v79, v79
  v_mfma_f32_16x16x32_bf16 v[108:111], a[144:147], v[144:147], v[108:111]
  v_cvt_pk_bf16_f32 v75, v78, v79
  v_mfma_f32_16x16x32_bf16 v[116:119], a[144:147], v[160:163], v[200:203]
  v_exp_f32 v84, v84
  v_mfma_f32_16x16x32_bf16 v[116:119], a[148:151], v[164:167], v[116:119]
  ds_read_b64_tr_b16 a[160:161], v216 offset:32768
  s_add_u32 m0, s50, 4096
  v_mfma_f32_16x16x32_bf16 v[116:119], a[152:155], v[168:171], v[116:119]
  v_exp_f32 v85, v85
  v_mfma_f32_16x16x32_bf16 v[116:119], a[156:159], v[172:175], v[116:119]
  ds_read_b64_tr_b16 a[162:163], v216 offset:36864
  v_cvt_pk_bf16_f32 v82, v84, v85
  v_mfma_f32_16x16x32_bf16 v[124:127], a[156:159], v[188:191], v[204:207]
  v_exp_f32 v86, v86
  v_mfma_f32_16x16x32_bf16 v[124:127], a[152:155], v[184:187], v[124:127]
  ds_read_b64_tr_b16 a[164:165], v216 offset:40960
  buffer_load_dwordx4 v226, s[44:47], s35 offen lds
  s_add_u32 s35, s35, 221184
  v_mfma_f32_16x16x32_bf16 v[124:127], a[148:151], v[180:183], v[124:127]
  v_exp_f32 v87, v87
  v_mfma_f32_16x16x32_bf16 v[124:127], a[144:147], v[176:179], v[124:127]
  ds_read_b64_tr_b16 a[166:167], v216 offset:45056
  v_cvt_pk_bf16_f32 v83, v86, v87
  v_mfma_f32_16x16x32_bf16 a[192:195], a[208:211], v[0:3], a[192:195]
  v_exp_f32 v92, v92
  v_mfma_f32_16x16x32_bf16 a[192:195], a[208:211], v[32:35], a[192:195]
  ds_read_b64_tr_b16 a[168:169], v217 offset:32768
  v_mfma_f32_16x16x32_bf16 a[196:199], a[208:211], v[8:11], a[196:199]
  v_exp_f32 v93, v93
  v_mfma_f32_16x16x32_bf16 a[196:199], a[208:211], v[40:43], a[196:199]
  ds_read_b64_tr_b16 a[170:171], v217 offset:36864
  v_cvt_pk_bf16_f32 v90, v92, v93
  v_mfma_f32_16x16x32_bf16 a[200:203], a[208:211], v[16:19], a[200:203]
  v_exp_f32 v94, v94
  v_mfma_f32_16x16x32_bf16 a[200:203], a[208:211], v[48:51], a[200:203]
  ds_read_b64_tr_b16 a[172:173], v217 offset:40960
  v_mfma_f32_16x16x32_bf16 a[204:207], a[208:211], v[24:27], a[204:207]
  s_waitcnt lgkmcnt(3)
  v_exp_f32 v95, v95
  v_mfma_f32_16x16x32_bf16 a[204:207], a[208:211], v[56:59], a[204:207]
  ds_read_b64_tr_b16 a[174:175], v217 offset:45056
  v_cvt_pk_bf16_f32 v91, v94, v95
  v_mfma_f32_16x16x32_bf16 a[0:3], a[160:163], v[0:3], a[0:3]
  v_exp_f32 v96, v96
  v_mfma_f32_16x16x32_bf16 a[0:3], a[164:167], v[32:35], a[0:3]
  ds_read_b64_tr_b16 a[176:177], v218 offset:32768
  v_mfma_f32_16x16x32_bf16 a[4:7], a[164:167], v[40:43], a[4:7]
  v_exp_f32 v97, v97
  v_mfma_f32_16x16x32_bf16 a[4:7], a[160:163], v[8:11], a[4:7]
  ds_read_b64_tr_b16 a[178:179], v218 offset:36864
  v_cvt_pk_bf16_f32 v96, v96, v97
  v_mfma_f32_16x16x32_bf16 a[8:11], a[160:163], v[16:19], a[8:11]
  v_exp_f32 v98, v98
  v_mfma_f32_16x16x32_bf16 a[8:11], a[164:167], v[48:51], a[8:11]
  ds_read_b64_tr_b16 a[180:181], v218 offset:40960
  v_mfma_f32_16x16x32_bf16 a[12:15], a[164:167], v[56:59], a[12:15]
  s_waitcnt lgkmcnt(3)
  v_exp_f32 v99, v99
  v_mfma_f32_16x16x32_bf16 a[12:15], a[160:163], v[24:27], a[12:15]
  ds_read_b64_tr_b16 a[182:183], v218 offset:45056
  v_cvt_pk_bf16_f32 v97, v98, v99
  v_mfma_f32_16x16x32_bf16 a[16:19], a[168:171], v[0:3], a[16:19]
  v_exp_f32 v104, v104
  v_mfma_f32_16x16x32_bf16 a[16:19], a[172:175], v[32:35], a[16:19]
  ds_read_b64_tr_b16 a[184:185], v219 offset:32768
  v_mfma_f32_16x16x32_bf16 a[20:23], a[172:175], v[40:43], a[20:23]
  v_exp_f32 v105, v105
  v_mfma_f32_16x16x32_bf16 a[20:23], a[168:171], v[8:11], a[20:23]
  ds_read_b64_tr_b16 a[186:187], v219 offset:36864
  v_cvt_pk_bf16_f32 v104, v104, v105
  v_mfma_f32_16x16x32_bf16 a[24:27], a[168:171], v[16:19], a[24:27]
  v_exp_f32 v106, v106
  v_mfma_f32_16x16x32_bf16 a[24:27], a[172:175], v[48:51], a[24:27]
  ds_read_b64_tr_b16 a[188:189], v219 offset:40960
  v_mfma_f32_16x16x32_bf16 a[28:31], a[172:175], v[56:59], a[28:31]
  s_waitcnt lgkmcnt(3)
  v_exp_f32 v107, v107
  v_mfma_f32_16x16x32_bf16 a[28:31], a[168:171], v[24:27], a[28:31]
  ds_read_b64_tr_b16 a[190:191], v219 offset:45056
  v_cvt_pk_bf16_f32 v105, v106, v107
  v_mfma_f32_16x16x32_bf16 a[32:35], a[176:179], v[0:3], a[32:35]
  v_exp_f32 v112, v112
  v_mfma_f32_16x16x32_bf16 a[32:35], a[180:183], v[32:35], a[32:35]
  ds_read_b64_tr_b16 a[160:161], v220 offset:32768
  v_mfma_f32_16x16x32_bf16 a[36:39], a[180:183], v[40:43], a[36:39]
  v_exp_f32 v113, v113
  v_mfma_f32_16x16x32_bf16 a[36:39], a[176:179], v[8:11], a[36:39]
  ds_read_b64_tr_b16 a[162:163], v220 offset:36864
  v_cvt_pk_bf16_f32 v112, v112, v113
  v_mfma_f32_16x16x32_bf16 a[40:43], a[176:179], v[16:19], a[40:43]
  v_exp_f32 v114, v114
  v_mfma_f32_16x16x32_bf16 a[40:43], a[180:183], v[48:51], a[40:43]
  ds_read_b64_tr_b16 a[164:165], v220 offset:40960
  v_mfma_f32_16x16x32_bf16 a[44:47], a[180:183], v[56:59], a[44:47]
  s_waitcnt lgkmcnt(3)
  v_exp_f32 v115, v115
  v_mfma_f32_16x16x32_bf16 a[44:47], a[176:179], v[24:27], a[44:47]
  ds_read_b64_tr_b16 a[166:167], v220 offset:45056
  v_cvt_pk_bf16_f32 v113, v114, v115
  v_mfma_f32_16x16x32_bf16 a[48:51], a[184:187], v[0:3], a[48:51]
  v_exp_f32 v120, v120
  v_mfma_f32_16x16x32_bf16 a[48:51], a[188:191], v[32:35], a[48:51]
  ds_read_b64_tr_b16 a[168:169], v221 offset:32768
  v_mfma_f32_16x16x32_bf16 a[52:55], a[188:191], v[40:43], a[52:55]
  v_exp_f32 v121, v121
  v_mfma_f32_16x16x32_bf16 a[52:55], a[184:187], v[8:11], a[52:55]
  ds_read_b64_tr_b16 a[170:171], v221 offset:36864
  v_cvt_pk_bf16_f32 v120, v120, v121
  v_mfma_f32_16x16x32_bf16 a[56:59], a[184:187], v[16:19], a[56:59]
  v_exp_f32 v122, v122
  v_mfma_f32_16x16x32_bf16 a[56:59], a[188:191], v[48:51], a[56:59]
  ds_read_b64_tr_b16 a[172:173], v221 offset:40960
  v_mfma_f32_16x16x32_bf16 a[60:63], a[188:191], v[56:59], a[60:63]
  s_waitcnt lgkmcnt(3)
  v_exp_f32 v123, v123
  v_mfma_f32_16x16x32_bf16 a[60:63], a[184:187], v[24:27], a[60:63]
  ds_read_b64_tr_b16 a[174:175], v221 offset:45056
  v_cvt_pk_bf16_f32 v121, v122, v123
  v_mfma_f32_16x16x32_bf16 a[64:67], a[160:163], v[0:3], a[64:67]
  v_exp_f32 v100, v100
  v_mfma_f32_16x16x32_bf16 a[64:67], a[164:167], v[32:35], a[64:67]
  ds_read_b64_tr_b16 a[176:177], v222 offset:32768
  v_mfma_f32_16x16x32_bf16 a[68:71], a[164:167], v[40:43], a[68:71]
  v_exp_f32 v101, v101
  v_mfma_f32_16x16x32_bf16 a[68:71], a[160:163], v[8:11], a[68:71]
  ds_read_b64_tr_b16 a[178:179], v222 offset:36864
  v_cvt_pk_bf16_f32 v98, v100, v101
  v_mfma_f32_16x16x32_bf16 a[72:75], a[160:163], v[16:19], a[72:75]
  v_exp_f32 v102, v102
  v_mfma_f32_16x16x32_bf16 a[72:75], a[164:167], v[48:51], a[72:75]
  ds_read_b64_tr_b16 a[180:181], v222 offset:40960
  v_mfma_f32_16x16x32_bf16 a[76:79], a[164:167], v[56:59], a[76:79]
  s_waitcnt lgkmcnt(3)
  v_exp_f32 v103, v103
  v_mfma_f32_16x16x32_bf16 a[76:79], a[160:163], v[24:27], a[76:79]
  ds_read_b64_tr_b16 a[182:183], v222 offset:45056
  v_cvt_pk_bf16_f32 v99, v102, v103
  v_mfma_f32_16x16x32_bf16 a[80:83], a[168:171], v[0:3], a[80:83]
  v_exp_f32 v108, v108
  v_mfma_f32_16x16x32_bf16 a[80:83], a[172:175], v[32:35], a[80:83]
  ds_read_b64_tr_b16 a[184:185], v223 offset:32768
  v_mfma_f32_16x16x32_bf16 a[84:87], a[172:175], v[40:43], a[84:87]
  v_exp_f32 v109, v109
  v_mfma_f32_16x16x32_bf16 a[84:87], a[168:171], v[8:11], a[84:87]
  ds_read_b64_tr_b16 a[186:187], v223 offset:36864
  v_cvt_pk_bf16_f32 v106, v108, v109
  v_mfma_f32_16x16x32_bf16 a[88:91], a[168:171], v[16:19], a[88:91]
  v_exp_f32 v110, v110
  v_mfma_f32_16x16x32_bf16 a[88:91], a[172:175], v[48:51], a[88:91]
  ds_read_b64_tr_b16 a[188:189], v223 offset:40960
  v_mfma_f32_16x16x32_bf16 a[92:95], a[172:175], v[56:59], a[92:95]
  s_waitcnt lgkmcnt(3)
  v_exp_f32 v111, v111
  v_mfma_f32_16x16x32_bf16 a[92:95], a[168:171], v[24:27], a[92:95]
  ds_read_b64_tr_b16 a[190:191], v223 offset:45056
  v_cvt_pk_bf16_f32 v107, v110, v111
  v_mfma_f32_16x16x32_bf16 a[96:99], a[176:179], v[0:3], a[96:99]
  s_waitcnt vmcnt(10)
  v_exp_f32 v116, v116
  v_mfma_f32_16x16x32_bf16 a[96:99], a[180:183], v[32:35], a[96:99]
  v_mfma_f32_16x16x32_bf16 a[100:103], a[180:183], v[40:43], a[100:103]
  s_barrier
  v_exp_f32 v117, v117
  v_mfma_f32_16x16x32_bf16 a[100:103], a[176:179], v[8:11], a[100:103]
  ds_read_b128 a[128:131], v212 offset:0
  v_cvt_pk_bf16_f32 v114, v116, v117
  v_mfma_f32_16x16x32_bf16 a[104:107], a[176:179], v[16:19], a[104:107]
  v_exp_f32 v118, v118
  v_mfma_f32_16x16x32_bf16 a[104:107], a[180:183], v[48:51], a[104:107]
  ds_read_b128 a[132:135], v213 offset:0
  v_mfma_f32_16x16x32_bf16 a[108:111], a[180:183], v[56:59], a[108:111]
  s_waitcnt lgkmcnt(2)
  v_exp_f32 v119, v119
  v_mfma_f32_16x16x32_bf16 a[108:111], a[176:179], v[24:27], a[108:111]
  ds_read_b128 a[136:139], v214 offset:0
  v_cvt_pk_bf16_f32 v115, v118, v119
  v_mfma_f32_16x16x32_bf16 a[112:115], a[184:187], v[0:3], a[112:115]
  v_exp_f32 v124, v124
  v_mfma_f32_16x16x32_bf16 a[112:115], a[188:191], v[32:35], a[112:115]
  ds_read_b128 a[140:143], v215 offset:0
  v_mfma_f32_16x16x32_bf16 a[116:119], a[188:191], v[40:43], a[116:119]
  v_exp_f32 v125, v125
  v_mfma_f32_16x16x32_bf16 a[116:119], a[184:187], v[8:11], a[116:119]
  v_cvt_pk_bf16_f32 v122, v124, v125
  v_mfma_f32_16x16x32_bf16 a[120:123], a[184:187], v[16:19], a[120:123]
  v_exp_f32 v126, v126
  v_mfma_f32_16x16x32_bf16 a[120:123], a[188:191], v[48:51], a[120:123]
  v_mfma_f32_16x16x32_bf16 a[124:127], a[188:191], v[56:59], a[124:127]
  s_waitcnt lgkmcnt(0)
  v_exp_f32 v127, v127
  v_mfma_f32_16x16x32_bf16 a[124:127], a[184:187], v[24:27], a[124:127]
  v_cvt_pk_bf16_f32 v123, v126, v127
  v_mfma_f32_16x16x32_bf16 v[0:3], a[128:131], v[128:131], v[192:195]
  v_mfma_f32_16x16x32_bf16 v[0:3], a[132:135], v[132:135], v[0:3]
  ds_read_b128 a[144:147], v212 offset:4096
  v_mfma_f32_16x16x32_bf16 v[0:3], a[136:139], v[136:139], v[0:3]
  v_mfma_f32_16x16x32_bf16 v[0:3], a[140:143], v[140:143], v[0:3]
  ds_read_b128 a[148:151], v213 offset:4096
  v_mfma_f32_16x16x32_bf16 v[8:11], a[140:143], v[156:159], v[196:199]
  v_mfma_f32_16x16x32_bf16 v[8:11], a[136:139], v[152:155], v[8:11]
  ds_read_b128 a[152:155], v214 offset:4096
  v_mfma_f32_16x16x32_bf16 v[8:11], a[132:135], v[148:151], v[8:11]
  v_mfma_f32_16x16x32_bf16 v[8:11], a[128:131], v[144:147], v[8:11]
  ds_read_b128 a[156:159], v215 offset:4096
  v_mfma_f32_16x16x32_bf16 v[16:19], a[128:131], v[160:163], v[200:203]
  s_add_u32 m0, s28, 81920
  v_exp_f32 v0, v0
  v_mfma_f32_16x16x32_bf16 v[16:19], a[132:135], v[164:167], v[16:19]
  buffer_load_dwordx4 v236, s[16:19], s29 offen offset:0 lds
  v_mfma_f32_16x16x32_bf16 v[16:19], a[136:139], v[168:171], v[16:19]
  v_exp_f32 v1, v1
  v_mfma_f32_16x16x32_bf16 v[16:19], a[140:143], v[172:175], v[16:19]
  v_cvt_pk_bf16_f32 v0, v0, v1
  v_mfma_f32_16x16x32_bf16 v[24:27], a[140:143], v[188:191], v[204:207]
  v_exp_f32 v2, v2
  v_mfma_f32_16x16x32_bf16 v[24:27], a[136:139], v[184:187], v[24:27]
  buffer_load_dwordx4 v237, s[16:19], s29 offen offset:1024 lds
  v_mfma_f32_16x16x32_bf16 v[24:27], a[132:135], v[180:183], v[24:27]
  s_waitcnt lgkmcnt(0)
  v_exp_f32 v3, v3
  v_mfma_f32_16x16x32_bf16 v[24:27], a[128:131], v[176:179], v[24:27]
  v_cvt_pk_bf16_f32 v1, v2, v3
  v_mfma_f32_16x16x32_bf16 v[4:7], a[144:147], v[128:131], v[192:195]
  v_exp_f32 v8, v8
  v_mfma_f32_16x16x32_bf16 v[4:7], a[148:151], v[132:135], v[4:7]
  ds_read_b128 a[128:131], v212 offset:8192
  v_mfma_f32_16x16x32_bf16 v[4:7], a[152:155], v[136:139], v[4:7]
  v_exp_f32 v9, v9
  v_mfma_f32_16x16x32_bf16 v[4:7], a[156:159], v[140:143], v[4:7]
  ds_read_b128 a[132:135], v213 offset:8192
  v_cvt_pk_bf16_f32 v8, v8, v9
  v_mfma_f32_16x16x32_bf16 v[12:15], a[156:159], v[156:159], v[196:199]
  v_exp_f32 v10, v10
  v_mfma_f32_16x16x32_bf16 v[12:15], a[152:155], v[152:155], v[12:15]
  ds_read_b128 a[136:139], v214 offset:8192
  v_mfma_f32_16x16x32_bf16 v[12:15], a[148:151], v[148:151], v[12:15]
  v_exp_f32 v11, v11
  v_mfma_f32_16x16x32_bf16 v[12:15], a[144:147], v[144:147], v[12:15]
  ds_read_b128 a[140:143], v215 offset:8192
  v_cvt_pk_bf16_f32 v9, v10, v11
  v_mfma_f32_16x16x32_bf16 v[20:23], a[144:147], v[160:163], v[200:203]
  v_exp_f32 v16, v16
  v_mfma_f32_16x16x32_bf16 v[20:23], a[148:151], v[164:167], v[20:23]
  buffer_load_dwordx4 v236, s[16:19], s29 offen offset:2048 lds
  v_mfma_f32_16x16x32_bf16 v[20:23], a[152:155], v[168:171], v[20:23]
  v_exp_f32 v17, v17
  v_mfma_f32_16x16x32_bf16 v[20:23], a[156:159], v[172:175], v[20:23]
  v_cvt_pk_bf16_f32 v16, v16, v17
  v_mfma_f32_16x16x32_bf16 v[28:31], a[156:159], v[188:191], v[204:207]
  v_exp_f32 v18, v18
  v_mfma_f32_16x16x32_bf16 v[28:31], a[152:155], v[184:187], v[28:31]
  buffer_load_dwordx4 v237, s[16:19], s29 offen offset:3072 lds
  v_mfma_f32_16x16x32_bf16 v[28:31], a[148:151], v[180:183], v[28:31]
  s_waitcnt lgkmcnt(0)
  s_add_u32 s29, s29, 16384
  v_exp_f32 v19, v19
  v_mfma_f32_16x16x32_bf16 v[28:31], a[144:147], v[176:179], v[28:31]
  v_cvt_pk_bf16_f32 v17, v18, v19
  v_mfma_f32_16x16x32_bf16 v[32:35], a[128:131], v[128:131], v[192:195]
  s_add_u32 m0, s28, 32768
  v_exp_f32 v24, v24
  v_mfma_f32_16x16x32_bf16 v[32:35], a[132:135], v[132:135], v[32:35]
  ds_read_b128 a[144:147], v212 offset:12288
  v_mfma_f32_16x16x32_bf16 v[32:35], a[136:139], v[136:139], v[32:35]
  v_exp_f32 v25, v25
  v_mfma_f32_16x16x32_bf16 v[32:35], a[140:143], v[140:143], v[32:35]
  ds_read_b128 a[148:151], v213 offset:12288
  v_cvt_pk_bf16_f32 v24, v24, v25
  v_mfma_f32_16x16x32_bf16 v[40:43], a[140:143], v[156:159], v[196:199]
  v_exp_f32 v26, v26
  v_mfma_f32_16x16x32_bf16 v[40:43], a[136:139], v[152:155], v[40:43]
  ds_read_b128 a[152:155], v214 offset:12288
  v_mfma_f32_16x16x32_bf16 v[40:43], a[132:135], v[148:151], v[40:43]
  v_exp_f32 v27, v27
  v_mfma_f32_16x16x32_bf16 v[40:43], a[128:131], v[144:147], v[40:43]
  ds_read_b128 a[156:159], v215 offset:12288
  v_cvt_pk_bf16_f32 v25, v26, v27
  v_mfma_f32_16x16x32_bf16 v[48:51], a[128:131], v[160:163], v[200:203]
  v_exp_f32 v4, v4
  v_mfma_f32_16x16x32_bf16 v[48:51], a[132:135], v[164:167], v[48:51]
  buffer_load_dwordx4 v232, s[12:15], s29 offen offset:0 lds
  v_mfma_f32_16x16x32_bf16 v[48:51], a[136:139], v[168:171], v[48:51]
  v_exp_f32 v5, v5
  v_mfma_f32_16x16x32_bf16 v[48:51], a[140:143], v[172:175], v[48:51]
  v_cvt_pk_bf16_f32 v2, v4, v5
  v_mfma_f32_16x16x32_bf16 v[56:59], a[140:143], v[188:191], v[204:207]
  v_exp_f32 v6, v6
  v_mfma_f32_16x16x32_bf16 v[56:59], a[136:139], v[184:187], v[56:59]
  buffer_load_dwordx4 v233, s[12:15], s29 offen offset:1024 lds
  v_mfma_f32_16x16x32_bf16 v[56:59], a[132:135], v[180:183], v[56:59]
  s_waitcnt lgkmcnt(0)
  v_exp_f32 v7, v7
  v_mfma_f32_16x16x32_bf16 v[56:59], a[128:131], v[176:179], v[56:59]
  v_cvt_pk_bf16_f32 v3, v6, v7
  v_mfma_f32_16x16x32_bf16 v[36:39], a[144:147], v[128:131], v[192:195]
  v_exp_f32 v12, v12
  v_mfma_f32_16x16x32_bf16 v[36:39], a[148:151], v[132:135], v[36:39]
  buffer_load_dwordx4 v234, s[12:15], s29 offen offset:2048 lds
  v_mfma_f32_16x16x32_bf16 v[36:39], a[152:155], v[136:139], v[36:39]
  v_exp_f32 v13, v13
  v_mfma_f32_16x16x32_bf16 v[36:39], a[156:159], v[140:143], v[36:39]
  v_cvt_pk_bf16_f32 v10, v12, v13
  v_mfma_f32_16x16x32_bf16 v[44:47], a[156:159], v[156:159], v[196:199]
  v_exp_f32 v14, v14
  v_mfma_f32_16x16x32_bf16 v[44:47], a[152:155], v[152:155], v[44:47]
  buffer_load_dwordx4 v235, s[12:15], s29 offen offset:3072 lds
  v_mfma_f32_16x16x32_bf16 v[44:47], a[148:151], v[148:151], v[44:47]
  v_exp_f32 v15, v15
  v_mfma_f32_16x16x32_bf16 v[44:47], a[144:147], v[144:147], v[44:47]
  v_cvt_pk_bf16_f32 v11, v14, v15
  v_mfma_f32_16x16x32_bf16 v[52:55], a[144:147], v[160:163], v[200:203]
  v_exp_f32 v20, v20
  v_mfma_f32_16x16x32_bf16 v[52:55], a[148:151], v[164:167], v[52:55]
  ds_read_b64_tr_b16 a[160:161], v216 offset:49152
  s_add_u32 m0, s50, 2048
  v_mfma_f32_16x16x32_bf16 v[52:55], a[152:155], v[168:171], v[52:55]
  v_exp_f32 v21, v21
  v_mfma_f32_16x16x32_bf16 v[52:55], a[156:159], v[172:175], v[52:55]
  ds_read_b64_tr_b16 a[162:163], v216 offset:53248
  v_cvt_pk_bf16_f32 v18, v20, v21
  v_mfma_f32_16x16x32_bf16 v[60:63], a[156:159], v[188:191], v[204:207]
  v_exp_f32 v22, v22
  v_mfma_f32_16x16x32_bf16 v[60:63], a[152:155], v[184:187], v[60:63]
  ds_read_b64_tr_b16 a[164:165], v216 offset:57344
  buffer_load_dwordx4 v226, s[20:23], s35 offen lds
  v_mfma_f32_16x16x32_bf16 v[60:63], a[148:151], v[180:183], v[60:63]
  v_exp_f32 v23, v23
  v_mfma_f32_16x16x32_bf16 v[60:63], a[144:147], v[176:179], v[60:63]
  ds_read_b64_tr_b16 a[166:167], v216 offset:61440
  v_cvt_pk_bf16_f32 v19, v22, v23
  v_mfma_f32_16x16x32_bf16 a[192:195], a[208:211], v[64:67], a[192:195]
  v_exp_f32 v28, v28
  v_mfma_f32_16x16x32_bf16 a[192:195], a[208:211], v[96:99], a[192:195]
  ds_read_b64_tr_b16 a[168:169], v217 offset:49152
  v_mfma_f32_16x16x32_bf16 a[196:199], a[208:211], v[72:75], a[196:199]
  v_exp_f32 v29, v29
  v_mfma_f32_16x16x32_bf16 a[196:199], a[208:211], v[104:107], a[196:199]
  ds_read_b64_tr_b16 a[170:171], v217 offset:53248
  v_cvt_pk_bf16_f32 v26, v28, v29
  v_mfma_f32_16x16x32_bf16 a[200:203], a[208:211], v[80:83], a[200:203]
  v_exp_f32 v30, v30
  v_mfma_f32_16x16x32_bf16 a[200:203], a[208:211], v[112:115], a[200:203]
  ds_read_b64_tr_b16 a[172:173], v217 offset:57344
  v_mfma_f32_16x16x32_bf16 a[204:207], a[208:211], v[88:91], a[204:207]
  s_waitcnt lgkmcnt(3)
  v_exp_f32 v31, v31
  v_mfma_f32_16x16x32_bf16 a[204:207], a[208:211], v[120:123], a[204:207]
  ds_read_b64_tr_b16 a[174:175], v217 offset:61440
  v_cvt_pk_bf16_f32 v27, v30, v31
  v_mfma_f32_16x16x32_bf16 a[0:3], a[160:163], v[64:67], a[0:3]
  v_exp_f32 v32, v32
  v_mfma_f32_16x16x32_bf16 a[0:3], a[164:167], v[96:99], a[0:3]
  ds_read_b64_tr_b16 a[176:177], v218 offset:49152
  v_mfma_f32_16x16x32_bf16 a[4:7], a[164:167], v[104:107], a[4:7]
  v_exp_f32 v33, v33
  v_mfma_f32_16x16x32_bf16 a[4:7], a[160:163], v[72:75], a[4:7]
  ds_read_b64_tr_b16 a[178:179], v218 offset:53248
  v_cvt_pk_bf16_f32 v32, v32, v33
  v_mfma_f32_16x16x32_bf16 a[8:11], a[160:163], v[80:83], a[8:11]
  v_exp_f32 v34, v34
  v_mfma_f32_16x16x32_bf16 a[8:11], a[164:167], v[112:115], a[8:11]
  ds_read_b64_tr_b16 a[180:181], v218 offset:57344
  v_mfma_f32_16x16x32_bf16 a[12:15], a[164:167], v[120:123], a[12:15]
  s_waitcnt lgkmcnt(3)
  v_exp_f32 v35, v35
  v_mfma_f32_16x16x32_bf16 a[12:15], a[160:163], v[88:91], a[12:15]
  ds_read_b64_tr_b16 a[182:183], v218 offset:61440
  v_cvt_pk_bf16_f32 v33, v34, v35
  v_mfma_f32_16x16x32_bf16 a[16:19], a[168:171], v[64:67], a[16:19]
  v_exp_f32 v40, v40
  v_mfma_f32_16x16x32_bf16 a[16:19], a[172:175], v[96:99], a[16:19]
  ds_read_b64_tr_b16 a[184:185], v219 offset:49152
  v_mfma_f32_16x16x32_bf16 a[20:23], a[172:175], v[104:107], a[20:23]
  v_exp_f32 v41, v41
  v_mfma_f32_16x16x32_bf16 a[20:23], a[168:171], v[72:75], a[20:23]
  ds_read_b64_tr_b16 a[186:187], v219 offset:53248
  v_cvt_pk_bf16_f32 v40, v40, v41
  v_mfma_f32_16x16x32_bf16 a[24:27], a[168:171], v[80:83], a[24:27]
  v_exp_f32 v42, v42
  v_mfma_f32_16x16x32_bf16 a[24:27], a[172:175], v[112:115], a[24:27]
  ds_read_b64_tr_b16 a[188:189], v219 offset:57344
  v_mfma_f32_16x16x32_bf16 a[28:31], a[172:175], v[120:123], a[28:31]
  s_waitcnt lgkmcnt(3)
  v_exp_f32 v43, v43
  v_mfma_f32_16x16x32_bf16 a[28:31], a[168:171], v[88:91], a[28:31]
  ds_read_b64_tr_b16 a[190:191], v219 offset:61440
  v_cvt_pk_bf16_f32 v41, v42, v43
  v_mfma_f32_16x16x32_bf16 a[32:35], a[176:179], v[64:67], a[32:35]
  v_exp_f32 v48, v48
  v_mfma_f32_16x16x32_bf16 a[32:35], a[180:183], v[96:99], a[32:35]
  ds_read_b64_tr_b16 a[160:161], v220 offset:49152
  v_mfma_f32_16x16x32_bf16 a[36:39], a[180:183], v[104:107], a[36:39]
  v_exp_f32 v49, v49
  v_mfma_f32_16x16x32_bf16 a[36:39], a[176:179], v[72:75], a[36:39]
  ds_read_b64_tr_b16 a[162:163], v220 offset:53248
  v_cvt_pk_bf16_f32 v48, v48, v49
  v_mfma_f32_16x16x32_bf16 a[40:43], a[176:179], v[80:83], a[40:43]
  v_exp_f32 v50, v50
  v_mfma_f32_16x16x32_bf16 a[40:43], a[180:183], v[112:115], a[40:43]
  ds_read_b64_tr_b16 a[164:165], v220 offset:57344
  v_mfma_f32_16x16x32_bf16 a[44:47], a[180:183], v[120:123], a[44:47]
  s_waitcnt lgkmcnt(3)
  v_exp_f32 v51, v51
  v_mfma_f32_16x16x32_bf16 a[44:47], a[176:179], v[88:91], a[44:47]
  ds_read_b64_tr_b16 a[166:167], v220 offset:61440
  v_cvt_pk_bf16_f32 v49, v50, v51
  v_mfma_f32_16x16x32_bf16 a[48:51], a[184:187], v[64:67], a[48:51]
  v_exp_f32 v56, v56
  v_mfma_f32_16x16x32_bf16 a[48:51], a[188:191], v[96:99], a[48:51]
  ds_read_b64_tr_b16 a[168:169], v221 offset:49152
  v_mfma_f32_16x16x32_bf16 a[52:55], a[188:191], v[104:107], a[52:55]
  v_exp_f32 v57, v57
  v_mfma_f32_16x16x32_bf16 a[52:55], a[184:187], v[72:75], a[52:55]
  ds_read_b64_tr_b16 a[170:171], v221 offset:53248
  v_cvt_pk_bf16_f32 v56, v56, v57
  v_mfma_f32_16x16x32_bf16 a[56:59], a[184:187], v[80:83], a[56:59]
  v_exp_f32 v58, v58
  v_mfma_f32_16x16x32_bf16 a[56:59], a[188:191], v[112:115], a[56:59]
  ds_read_b64_tr_b16 a[172:173], v221 offset:57344
  v_mfma_f32_16x16x32_bf16 a[60:63], a[188:191], v[120:123], a[60:63]
  s_waitcnt lgkmcnt(3)
  v_exp_f32 v59, v59
  v_mfma_f32_16x16x32_bf16 a[60:63], a[184:187], v[88:91], a[60:63]
  ds_read_b64_tr_b16 a[174:175], v221 offset:61440
  v_cvt_pk_bf16_f32 v57, v58, v59
  v_mfma_f32_16x16x32_bf16 a[64:67], a[160:163], v[64:67], a[64:67]
  v_exp_f32 v36, v36
  v_mfma_f32_16x16x32_bf16 a[64:67], a[164:167], v[96:99], a[64:67]
  ds_read_b64_tr_b16 a[176:177], v222 offset:49152
  v_mfma_f32_16x16x32_bf16 a[68:71], a[164:167], v[104:107], a[68:71]
  v_exp_f32 v37, v37
  v_mfma_f32_16x16x32_bf16 a[68:71], a[160:163], v[72:75], a[68:71]
  ds_read_b64_tr_b16 a[178:179], v222 offset:53248
  v_cvt_pk_bf16_f32 v34, v36, v37
  v_mfma_f32_16x16x32_bf16 a[72:75], a[160:163], v[80:83], a[72:75]
  v_exp_f32 v38, v38
  v_mfma_f32_16x16x32_bf16 a[72:75], a[164:167], v[112:115], a[72:75]
  ds_read_b64_tr_b16 a[180:181], v222 offset:57344
  v_mfma_f32_16x16x32_bf16 a[76:79], a[164:167], v[120:123], a[76:79]
  s_waitcnt lgkmcnt(3)
  v_exp_f32 v39, v39
  v_mfma_f32_16x16x32_bf16 a[76:79], a[160:163], v[88:91], a[76:79]
  ds_read_b64_tr_b16 a[182:183], v222 offset:61440
  v_cvt_pk_bf16_f32 v35, v38, v39
  v_mfma_f32_16x16x32_bf16 a[80:83], a[168:171], v[64:67], a[80:83]
  v_exp_f32 v44, v44
  v_mfma_f32_16x16x32_bf16 a[80:83], a[172:175], v[96:99], a[80:83]
  ds_read_b64_tr_b16 a[184:185], v223 offset:49152
  v_mfma_f32_16x16x32_bf16 a[84:87], a[172:175], v[104:107], a[84:87]
  v_exp_f32 v45, v45
  v_mfma_f32_16x16x32_bf16 a[84:87], a[168:171], v[72:75], a[84:87]
  ds_read_b64_tr_b16 a[186:187], v223 offset:53248
  v_cvt_pk_bf16_f32 v42, v44, v45
  v_mfma_f32_16x16x32_bf16 a[88:91], a[168:171], v[80:83], a[88:91]
  v_exp_f32 v46, v46
  v_mfma_f32_16x16x32_bf16 a[88:91], a[172:175], v[112:115], a[88:91]
  ds_read_b64_tr_b16 a[188:189], v223 offset:57344
  v_mfma_f32_16x16x32_bf16 a[92:95], a[172:175], v[120:123], a[92:95]
  s_waitcnt lgkmcnt(3)
  v_exp_f32 v47, v47
  v_mfma_f32_16x16x32_bf16 a[92:95], a[168:171], v[88:91], a[92:95]
  ds_read_b64_tr_b16 a[190:191], v223 offset:61440
  v_cvt_pk_bf16_f32 v43, v46, v47
  v_mfma_f32_16x16x32_bf16 a[96:99], a[176:179], v[64:67], a[96:99]
  s_waitcnt vmcnt(10)
  v_exp_f32 v52, v52
  v_mfma_f32_16x16x32_bf16 a[96:99], a[180:183], v[96:99], a[96:99]
  v_mfma_f32_16x16x32_bf16 a[100:103], a[180:183], v[104:107], a[100:103]
  s_barrier
  v_exp_f32 v53, v53
  v_mfma_f32_16x16x32_bf16 a[100:103], a[176:179], v[72:75], a[100:103]
  ds_read_b128 a[128:131], v212 offset:16384
  v_cvt_pk_bf16_f32 v50, v52, v53
  v_mfma_f32_16x16x32_bf16 a[104:107], a[176:179], v[80:83], a[104:107]
  v_exp_f32 v54, v54
  v_mfma_f32_16x16x32_bf16 a[104:107], a[180:183], v[112:115], a[104:107]
  ds_read_b128 a[132:135], v213 offset:16384
  v_mfma_f32_16x16x32_bf16 a[108:111], a[180:183], v[120:123], a[108:111]
  s_waitcnt lgkmcnt(2)
  v_exp_f32 v55, v55
  v_mfma_f32_16x16x32_bf16 a[108:111], a[176:179], v[88:91], a[108:111]
  ds_read_b128 a[136:139], v214 offset:16384
  v_cvt_pk_bf16_f32 v51, v54, v55
  v_mfma_f32_16x16x32_bf16 a[112:115], a[184:187], v[64:67], a[112:115]
  v_exp_f32 v60, v60
  v_mfma_f32_16x16x32_bf16 a[112:115], a[188:191], v[96:99], a[112:115]
  ds_read_b128 a[140:143], v215 offset:16384
  v_mfma_f32_16x16x32_bf16 a[116:119], a[188:191], v[104:107], a[116:119]
  v_exp_f32 v61, v61
  v_mfma_f32_16x16x32_bf16 a[116:119], a[184:187], v[72:75], a[116:119]
  v_cvt_pk_bf16_f32 v58, v60, v61
  v_mfma_f32_16x16x32_bf16 a[120:123], a[184:187], v[80:83], a[120:123]
  v_exp_f32 v62, v62
  v_mfma_f32_16x16x32_bf16 a[120:123], a[188:191], v[112:115], a[120:123]
  v_mfma_f32_16x16x32_bf16 a[124:127], a[188:191], v[120:123], a[124:127]
  s_waitcnt lgkmcnt(0)
  v_exp_f32 v63, v63
  v_mfma_f32_16x16x32_bf16 a[124:127], a[184:187], v[88:91], a[124:127]
  v_cvt_pk_bf16_f32 v59, v62, v63
  v_mfma_f32_16x16x32_bf16 v[64:67], a[128:131], v[128:131], v[192:195]
  v_mfma_f32_16x16x32_bf16 v[64:67], a[132:135], v[132:135], v[64:67]
  ds_read_b128 a[144:147], v212 offset:20480
  v_mfma_f32_16x16x32_bf16 v[64:67], a[136:139], v[136:139], v[64:67]
  v_mfma_f32_16x16x32_bf16 v[64:67], a[140:143], v[140:143], v[64:67]
  ds_read_b128 a[148:151], v213 offset:20480
  v_mfma_f32_16x16x32_bf16 v[72:75], a[140:143], v[156:159], v[196:199]
  v_mfma_f32_16x16x32_bf16 v[72:75], a[136:139], v[152:155], v[72:75]
  ds_read_b128 a[152:155], v214 offset:20480
  v_mfma_f32_16x16x32_bf16 v[72:75], a[132:135], v[148:151], v[72:75]
  v_mfma_f32_16x16x32_bf16 v[72:75], a[128:131], v[144:147], v[72:75]
  ds_read_b128 a[156:159], v215 offset:20480
  v_mfma_f32_16x16x32_bf16 v[80:83], a[128:131], v[160:163], v[200:203]
  s_add_u32 m0, s28, 98304
  v_exp_f32 v64, v64
  v_mfma_f32_16x16x32_bf16 v[80:83], a[132:135], v[164:167], v[80:83]
  buffer_load_dwordx4 v236, s[16:19], s29 offen offset:0 lds
  v_mfma_f32_16x16x32_bf16 v[80:83], a[136:139], v[168:171], v[80:83]
  v_exp_f32 v65, v65
  v_mfma_f32_16x16x32_bf16 v[80:83], a[140:143], v[172:175], v[80:83]
  v_cvt_pk_bf16_f32 v64, v64, v65
  v_mfma_f32_16x16x32_bf16 v[88:91], a[140:143], v[188:191], v[204:207]
  v_exp_f32 v66, v66
  v_mfma_f32_16x16x32_bf16 v[88:91], a[136:139], v[184:187], v[88:91]
  buffer_load_dwordx4 v237, s[16:19], s29 offen offset:1024 lds
  v_mfma_f32_16x16x32_bf16 v[88:91], a[132:135], v[180:183], v[88:91]
  s_waitcnt lgkmcnt(0)
  v_exp_f32 v67, v67
  v_mfma_f32_16x16x32_bf16 v[88:91], a[128:131], v[176:179], v[88:91]
  v_cvt_pk_bf16_f32 v65, v66, v67
  v_mfma_f32_16x16x32_bf16 v[68:71], a[144:147], v[128:131], v[192:195]
  v_exp_f32 v72, v72
  v_mfma_f32_16x16x32_bf16 v[68:71], a[148:151], v[132:135], v[68:71]
  ds_read_b128 a[128:131], v212 offset:24576
  v_mfma_f32_16x16x32_bf16 v[68:71], a[152:155], v[136:139], v[68:71]
  v_exp_f32 v73, v73
  v_mfma_f32_16x16x32_bf16 v[68:71], a[156:159], v[140:143], v[68:71]
  ds_read_b128 a[132:135], v213 offset:24576
  v_cvt_pk_bf16_f32 v72, v72, v73
  v_mfma_f32_16x16x32_bf16 v[76:79], a[156:159], v[156:159], v[196:199]
  v_exp_f32 v74, v74
  v_mfma_f32_16x16x32_bf16 v[76:79], a[152:155], v[152:155], v[76:79]
  ds_read_b128 a[136:139], v214 offset:24576
  v_mfma_f32_16x16x32_bf16 v[76:79], a[148:151], v[148:151], v[76:79]
  v_exp_f32 v75, v75
  v_mfma_f32_16x16x32_bf16 v[76:79], a[144:147], v[144:147], v[76:79]
  ds_read_b128 a[140:143], v215 offset:24576
  v_cvt_pk_bf16_f32 v73, v74, v75
  v_mfma_f32_16x16x32_bf16 v[84:87], a[144:147], v[160:163], v[200:203]
  v_exp_f32 v80, v80
  v_mfma_f32_16x16x32_bf16 v[84:87], a[148:151], v[164:167], v[84:87]
  buffer_load_dwordx4 v236, s[16:19], s29 offen offset:2048 lds
  v_mfma_f32_16x16x32_bf16 v[84:87], a[152:155], v[168:171], v[84:87]
  v_exp_f32 v81, v81
  v_mfma_f32_16x16x32_bf16 v[84:87], a[156:159], v[172:175], v[84:87]
  v_cvt_pk_bf16_f32 v80, v80, v81
  v_mfma_f32_16x16x32_bf16 v[92:95], a[156:159], v[188:191], v[204:207]
  v_exp_f32 v82, v82
  v_mfma_f32_16x16x32_bf16 v[92:95], a[152:155], v[184:187], v[92:95]
  buffer_load_dwordx4 v237, s[16:19], s29 offen offset:3072 lds
  v_mfma_f32_16x16x32_bf16 v[92:95], a[148:151], v[180:183], v[92:95]
  s_waitcnt lgkmcnt(0)
  s_add_u32 s29, s29, 16384
  v_exp_f32 v83, v83
  v_mfma_f32_16x16x32_bf16 v[92:95], a[144:147], v[176:179], v[92:95]
  v_cvt_pk_bf16_f32 v81, v82, v83
  v_mfma_f32_16x16x32_bf16 v[96:99], a[128:131], v[128:131], v[192:195]
  s_add_u32 m0, s28, 49152
  v_exp_f32 v88, v88
  v_mfma_f32_16x16x32_bf16 v[96:99], a[132:135], v[132:135], v[96:99]
  ds_read_b128 a[144:147], v212 offset:28672
  v_mfma_f32_16x16x32_bf16 v[96:99], a[136:139], v[136:139], v[96:99]
  v_exp_f32 v89, v89
  v_mfma_f32_16x16x32_bf16 v[96:99], a[140:143], v[140:143], v[96:99]
  ds_read_b128 a[148:151], v213 offset:28672
  v_cvt_pk_bf16_f32 v88, v88, v89
  v_mfma_f32_16x16x32_bf16 v[104:107], a[140:143], v[156:159], v[196:199]
  v_exp_f32 v90, v90
  v_mfma_f32_16x16x32_bf16 v[104:107], a[136:139], v[152:155], v[104:107]
  ds_read_b128 a[152:155], v214 offset:28672
  v_mfma_f32_16x16x32_bf16 v[104:107], a[132:135], v[148:151], v[104:107]
  v_exp_f32 v91, v91
  v_mfma_f32_16x16x32_bf16 v[104:107], a[128:131], v[144:147], v[104:107]
  ds_read_b128 a[156:159], v215 offset:28672
  v_cvt_pk_bf16_f32 v89, v90, v91
  v_mfma_f32_16x16x32_bf16 v[112:115], a[128:131], v[160:163], v[200:203]
  v_exp_f32 v68, v68
  v_mfma_f32_16x16x32_bf16 v[112:115], a[132:135], v[164:167], v[112:115]
  buffer_load_dwordx4 v232, s[12:15], s29 offen offset:0 lds
  v_mfma_f32_16x16x32_bf16 v[112:115], a[136:139], v[168:171], v[112:115]
  v_exp_f32 v69, v69
  v_mfma_f32_16x16x32_bf16 v[112:115], a[140:143], v[172:175], v[112:115]
  v_cvt_pk_bf16_f32 v66, v68, v69
  v_mfma_f32_16x16x32_bf16 v[120:123], a[140:143], v[188:191], v[204:207]
  v_exp_f32 v70, v70
  v_mfma_f32_16x16x32_bf16 v[120:123], a[136:139], v[184:187], v[120:123]
  buffer_load_dwordx4 v233, s[12:15], s29 offen offset:1024 lds
  v_mfma_f32_16x16x32_bf16 v[120:123], a[132:135], v[180:183], v[120:123]
  s_waitcnt lgkmcnt(0)
  v_exp_f32 v71, v71
  v_mfma_f32_16x16x32_bf16 v[120:123], a[128:131], v[176:179], v[120:123]
  v_cvt_pk_bf16_f32 v67, v70, v71
  v_mfma_f32_16x16x32_bf16 v[100:103], a[144:147], v[128:131], v[192:195]
  v_exp_f32 v76, v76
  v_mfma_f32_16x16x32_bf16 v[100:103], a[148:151], v[132:135], v[100:103]
  buffer_load_dwordx4 v234, s[12:15], s29 offen offset:2048 lds
  v_mfma_f32_16x16x32_bf16 v[100:103], a[152:155], v[136:139], v[100:103]
  v_exp_f32 v77, v77
  v_mfma_f32_16x16x32_bf16 v[100:103], a[156:159], v[140:143], v[100:103]
  v_cvt_pk_bf16_f32 v74, v76, v77
  v_mfma_f32_16x16x32_bf16 v[108:111], a[156:159], v[156:159], v[196:199]
  v_exp_f32 v78, v78
  v_mfma_f32_16x16x32_bf16 v[108:111], a[152:155], v[152:155], v[108:111]
  buffer_load_dwordx4 v235, s[12:15], s29 offen offset:3072 lds
  v_mfma_f32_16x16x32_bf16 v[108:111], a[148:151], v[148:151], v[108:111]
  v_exp_f32 v79, v79
  v_mfma_f32_16x16x32_bf16 v[108:111], a[144:147], v[144:147], v[108:111]
  v_cvt_pk_bf16_f32 v75, v78, v79
  v_mfma_f32_16x16x32_bf16 v[116:119], a[144:147], v[160:163], v[200:203]
  v_exp_f32 v84, v84
  v_mfma_f32_16x16x32_bf16 v[116:119], a[148:151], v[164:167], v[116:119]
  ds_read_b64_tr_b16 a[160:161], v216 offset:0
  s_add_u32 m0, s50, 5120
  v_mfma_f32_16x16x32_bf16 v[116:119], a[152:155], v[168:171], v[116:119]
  v_exp_f32 v85, v85
  v_mfma_f32_16x16x32_bf16 v[116:119], a[156:159], v[172:175], v[116:119]
  ds_read_b64_tr_b16 a[162:163], v216 offset:4096
  v_cvt_pk_bf16_f32 v82, v84, v85
  v_mfma_f32_16x16x32_bf16 v[124:127], a[156:159], v[188:191], v[204:207]
  v_exp_f32 v86, v86
  v_mfma_f32_16x16x32_bf16 v[124:127], a[152:155], v[184:187], v[124:127]
  ds_read_b64_tr_b16 a[164:165], v216 offset:8192
  buffer_load_dwordx4 v226, s[44:47], s35 offen lds
  s_add_u32 s35, s35, 221184
  v_mfma_f32_16x16x32_bf16 v[124:127], a[148:151], v[180:183], v[124:127]
  v_exp_f32 v87, v87
  v_mfma_f32_16x16x32_bf16 v[124:127], a[144:147], v[176:179], v[124:127]
  ds_read_b64_tr_b16 a[166:167], v216 offset:12288
  v_cvt_pk_bf16_f32 v83, v86, v87
  v_mfma_f32_16x16x32_bf16 a[192:195], a[208:211], v[0:3], a[192:195]
  v_exp_f32 v92, v92
  v_mfma_f32_16x16x32_bf16 a[192:195], a[208:211], v[32:35], a[192:195]
  ds_read_b64_tr_b16 a[168:169], v217 offset:0
  v_mfma_f32_16x16x32_bf16 a[196:199], a[208:211], v[8:11], a[196:199]
  v_exp_f32 v93, v93
  v_mfma_f32_16x16x32_bf16 a[196:199], a[208:211], v[40:43], a[196:199]
  ds_read_b64_tr_b16 a[170:171], v217 offset:4096
  v_cvt_pk_bf16_f32 v90, v92, v93
  v_mfma_f32_16x16x32_bf16 a[200:203], a[208:211], v[16:19], a[200:203]
  v_exp_f32 v94, v94
  v_mfma_f32_16x16x32_bf16 a[200:203], a[208:211], v[48:51], a[200:203]
  ds_read_b64_tr_b16 a[172:173], v217 offset:8192
  v_mfma_f32_16x16x32_bf16 a[204:207], a[208:211], v[24:27], a[204:207]
  s_waitcnt lgkmcnt(3)
  v_exp_f32 v95, v95
  v_mfma_f32_16x16x32_bf16 a[204:207], a[208:211], v[56:59], a[204:207]
  ds_read_b64_tr_b16 a[174:175], v217 offset:12288
  v_cvt_pk_bf16_f32 v91, v94, v95
  v_mfma_f32_16x16x32_bf16 a[0:3], a[160:163], v[0:3], a[0:3]
  v_exp_f32 v96, v96
  v_mfma_f32_16x16x32_bf16 a[0:3], a[164:167], v[32:35], a[0:3]
  ds_read_b64_tr_b16 a[176:177], v218 offset:0
  v_mfma_f32_16x16x32_bf16 a[4:7], a[164:167], v[40:43], a[4:7]
  v_exp_f32 v97, v97
  v_mfma_f32_16x16x32_bf16 a[4:7], a[160:163], v[8:11], a[4:7]
  ds_read_b64_tr_b16 a[178:179], v218 offset:4096
  v_cvt_pk_bf16_f32 v96, v96, v97
  v_mfma_f32_16x16x32_bf16 a[8:11], a[160:163], v[16:19], a[8:11]
  v_exp_f32 v98, v98
  v_mfma_f32_16x16x32_bf16 a[8:11], a[164:167], v[48:51], a[8:11]
  ds_read_b64_tr_b16 a[180:181], v218 offset:8192
  v_mfma_f32_16x16x32_bf16 a[12:15], a[164:167], v[56:59], a[12:15]
  s_waitcnt lgkmcnt(3)
  v_exp_f32 v99, v99
  v_mfma_f32_16x16x32_bf16 a[12:15], a[160:163], v[24:27], a[12:15]
  ds_read_b64_tr_b16 a[182:183], v218 offset:12288
  v_cvt_pk_bf16_f32 v97, v98, v99
  v_mfma_f32_16x16x32_bf16 a[16:19], a[168:171], v[0:3], a[16:19]
  v_exp_f32 v104, v104
  v_mfma_f32_16x16x32_bf16 a[16:19], a[172:175], v[32:35], a[16:19]
  ds_read_b64_tr_b16 a[184:185], v219 offset:0
  v_mfma_f32_16x16x32_bf16 a[20:23], a[172:175], v[40:43], a[20:23]
  v_exp_f32 v105, v105
  v_mfma_f32_16x16x32_bf16 a[20:23], a[168:171], v[8:11], a[20:23]
  ds_read_b64_tr_b16 a[186:187], v219 offset:4096
  v_cvt_pk_bf16_f32 v104, v104, v105
  v_mfma_f32_16x16x32_bf16 a[24:27], a[168:171], v[16:19], a[24:27]
  v_exp_f32 v106, v106
  v_mfma_f32_16x16x32_bf16 a[24:27], a[172:175], v[48:51], a[24:27]
  ds_read_b64_tr_b16 a[188:189], v219 offset:8192
  v_mfma_f32_16x16x32_bf16 a[28:31], a[172:175], v[56:59], a[28:31]
  s_waitcnt lgkmcnt(3)
  v_exp_f32 v107, v107
  v_mfma_f32_16x16x32_bf16 a[28:31], a[168:171], v[24:27], a[28:31]
  ds_read_b64_tr_b16 a[190:191], v219 offset:12288
  v_cvt_pk_bf16_f32 v105, v106, v107
  v_mfma_f32_16x16x32_bf16 a[32:35], a[176:179], v[0:3], a[32:35]
  v_exp_f32 v112, v112
  v_mfma_f32_16x16x32_bf16 a[32:35], a[180:183], v[32:35], a[32:35]
  ds_read_b64_tr_b16 a[160:161], v220 offset:0
  v_mfma_f32_16x16x32_bf16 a[36:39], a[180:183], v[40:43], a[36:39]
  v_exp_f32 v113, v113
  v_mfma_f32_16x16x32_bf16 a[36:39], a[176:179], v[8:11], a[36:39]
  ds_read_b64_tr_b16 a[162:163], v220 offset:4096
  v_cvt_pk_bf16_f32 v112, v112, v113
  v_mfma_f32_16x16x32_bf16 a[40:43], a[176:179], v[16:19], a[40:43]
  v_exp_f32 v114, v114
  v_mfma_f32_16x16x32_bf16 a[40:43], a[180:183], v[48:51], a[40:43]
  ds_read_b64_tr_b16 a[164:165], v220 offset:8192
  v_mfma_f32_16x16x32_bf16 a[44:47], a[180:183], v[56:59], a[44:47]
  s_waitcnt lgkmcnt(3)
  v_exp_f32 v115, v115
  v_mfma_f32_16x16x32_bf16 a[44:47], a[176:179], v[24:27], a[44:47]
  ds_read_b64_tr_b16 a[166:167], v220 offset:12288
  v_cvt_pk_bf16_f32 v113, v114, v115
  v_mfma_f32_16x16x32_bf16 a[48:51], a[184:187], v[0:3], a[48:51]
  v_exp_f32 v120, v120
  v_mfma_f32_16x16x32_bf16 a[48:51], a[188:191], v[32:35], a[48:51]
  ds_read_b64_tr_b16 a[168:169], v221 offset:0
  v_mfma_f32_16x16x32_bf16 a[52:55], a[188:191], v[40:43], a[52:55]
  v_exp_f32 v121, v121
  v_mfma_f32_16x16x32_bf16 a[52:55], a[184:187], v[8:11], a[52:55]
  ds_read_b64_tr_b16 a[170:171], v221 offset:4096
  v_cvt_pk_bf16_f32 v120, v120, v121
  v_mfma_f32_16x16x32_bf16 a[56:59], a[184:187], v[16:19], a[56:59]
  v_exp_f32 v122, v122
  v_mfma_f32_16x16x32_bf16 a[56:59], a[188:191], v[48:51], a[56:59]
  ds_read_b64_tr_b16 a[172:173], v221 offset:8192
  v_mfma_f32_16x16x32_bf16 a[60:63], a[188:191], v[56:59], a[60:63]
  s_waitcnt lgkmcnt(3)
  v_exp_f32 v123, v123
  v_mfma_f32_16x16x32_bf16 a[60:63], a[184:187], v[24:27], a[60:63]
  ds_read_b64_tr_b16 a[174:175], v221 offset:12288
  v_cvt_pk_bf16_f32 v121, v122, v123
  v_mfma_f32_16x16x32_bf16 a[64:67], a[160:163], v[0:3], a[64:67]
  v_exp_f32 v100, v100
  v_mfma_f32_16x16x32_bf16 a[64:67], a[164:167], v[32:35], a[64:67]
  ds_read_b64_tr_b16 a[176:177], v222 offset:0
  v_mfma_f32_16x16x32_bf16 a[68:71], a[164:167], v[40:43], a[68:71]
  v_exp_f32 v101, v101
  v_mfma_f32_16x16x32_bf16 a[68:71], a[160:163], v[8:11], a[68:71]
  ds_read_b64_tr_b16 a[178:179], v222 offset:4096
  v_cvt_pk_bf16_f32 v98, v100, v101
  v_mfma_f32_16x16x32_bf16 a[72:75], a[160:163], v[16:19], a[72:75]
  v_exp_f32 v102, v102
  v_mfma_f32_16x16x32_bf16 a[72:75], a[164:167], v[48:51], a[72:75]
  ds_read_b64_tr_b16 a[180:181], v222 offset:8192
  v_mfma_f32_16x16x32_bf16 a[76:79], a[164:167], v[56:59], a[76:79]
  s_waitcnt lgkmcnt(3)
  v_exp_f32 v103, v103
  v_mfma_f32_16x16x32_bf16 a[76:79], a[160:163], v[24:27], a[76:79]
  ds_read_b64_tr_b16 a[182:183], v222 offset:12288
  v_cvt_pk_bf16_f32 v99, v102, v103
  v_mfma_f32_16x16x32_bf16 a[80:83], a[168:171], v[0:3], a[80:83]
  v_exp_f32 v108, v108
  v_mfma_f32_16x16x32_bf16 a[80:83], a[172:175], v[32:35], a[80:83]
  ds_read_b64_tr_b16 a[184:185], v223 offset:0
  v_mfma_f32_16x16x32_bf16 a[84:87], a[172:175], v[40:43], a[84:87]
  v_exp_f32 v109, v109
  v_mfma_f32_16x16x32_bf16 a[84:87], a[168:171], v[8:11], a[84:87]
  ds_read_b64_tr_b16 a[186:187], v223 offset:4096
  v_cvt_pk_bf16_f32 v106, v108, v109
  v_mfma_f32_16x16x32_bf16 a[88:91], a[168:171], v[16:19], a[88:91]
  v_exp_f32 v110, v110
  v_mfma_f32_16x16x32_bf16 a[88:91], a[172:175], v[48:51], a[88:91]
  ds_read_b64_tr_b16 a[188:189], v223 offset:8192
  v_mfma_f32_16x16x32_bf16 a[92:95], a[172:175], v[56:59], a[92:95]
  s_waitcnt lgkmcnt(3)
  v_exp_f32 v111, v111
  v_mfma_f32_16x16x32_bf16 a[92:95], a[168:171], v[24:27], a[92:95]
  ds_read_b64_tr_b16 a[190:191], v223 offset:12288
  v_cvt_pk_bf16_f32 v107, v110, v111
  v_mfma_f32_16x16x32_bf16 a[96:99], a[176:179], v[0:3], a[96:99]
  s_waitcnt vmcnt(10)
  v_exp_f32 v116, v116
  v_mfma_f32_16x16x32_bf16 a[96:99], a[180:183], v[32:35], a[96:99]
  v_mfma_f32_16x16x32_bf16 a[100:103], a[180:183], v[40:43], a[100:103]
  s_barrier
  v_exp_f32 v117, v117
  v_mfma_f32_16x16x32_bf16 a[100:103], a[176:179], v[8:11], a[100:103]
  ds_read_b128 a[128:131], v212 offset:32768
  v_cvt_pk_bf16_f32 v114, v116, v117
  v_mfma_f32_16x16x32_bf16 a[104:107], a[176:179], v[16:19], a[104:107]
  v_exp_f32 v118, v118
  v_mfma_f32_16x16x32_bf16 a[104:107], a[180:183], v[48:51], a[104:107]
  ds_read_b128 a[132:135], v213 offset:32768
  v_mfma_f32_16x16x32_bf16 a[108:111], a[180:183], v[56:59], a[108:111]
  s_waitcnt lgkmcnt(2)
  v_exp_f32 v119, v119
  v_mfma_f32_16x16x32_bf16 a[108:111], a[176:179], v[24:27], a[108:111]
  ds_read_b128 a[136:139], v214 offset:32768
  v_cvt_pk_bf16_f32 v115, v118, v119
  v_mfma_f32_16x16x32_bf16 a[112:115], a[184:187], v[0:3], a[112:115]
  v_exp_f32 v124, v124
  v_mfma_f32_16x16x32_bf16 a[112:115], a[188:191], v[32:35], a[112:115]
  ds_read_b128 a[140:143], v215 offset:32768
  v_mfma_f32_16x16x32_bf16 a[116:119], a[188:191], v[40:43], a[116:119]
  v_exp_f32 v125, v125
  v_mfma_f32_16x16x32_bf16 a[116:119], a[184:187], v[8:11], a[116:119]
  v_cvt_pk_bf16_f32 v122, v124, v125
  v_mfma_f32_16x16x32_bf16 a[120:123], a[184:187], v[16:19], a[120:123]
  v_exp_f32 v126, v126
  v_mfma_f32_16x16x32_bf16 a[120:123], a[188:191], v[48:51], a[120:123]
  v_mfma_f32_16x16x32_bf16 a[124:127], a[188:191], v[56:59], a[124:127]
  s_waitcnt lgkmcnt(0)
  v_exp_f32 v127, v127
  v_mfma_f32_16x16x32_bf16 a[124:127], a[184:187], v[24:27], a[124:127]
  v_cvt_pk_bf16_f32 v123, v126, v127
  v_mfma_f32_16x16x32_bf16 v[0:3], a[128:131], v[128:131], v[192:195]
  s_mov_b32 s20, s88
  s_mov_b32 s21, s89
  s_mov_b32 s22, 5242880
  s_mov_b32 s23, 0x20000
  v_lshrrev_b32 v208, 4, v242
  v_and_b32 v209, 1, v208
  v_mfma_f32_16x16x32_bf16 v[0:3], a[132:135], v[132:135], v[0:3]
  ds_read_b128 a[144:147], v212 offset:36864
  v_lshrrev_b32 v208, 1, v208
  v_mfma_f32_16x16x32_bf16 v[0:3], a[136:139], v[136:139], v[0:3]
  v_mul_u32_u24 v208, 0x500, v208
  v_lshl_add_u32 v208, v209, 4, v208
  v_mfma_f32_16x16x32_bf16 v[0:3], a[140:143], v[140:143], v[0:3]
  ds_read_b128 a[148:151], v213 offset:36864
  v_lshrrev_b32 v209, 4, v242
  v_mfma_f32_16x16x32_bf16 v[8:11], a[140:143], v[156:159], v[196:199]
  v_lshrrev_b32 v210, 5, v209
  v_lshlrev_b32 v210, 30, v210
  v_mfma_f32_16x16x32_bf16 v[8:11], a[136:139], v[152:155], v[8:11]
  ds_read_b128 a[152:155], v214 offset:36864
  v_or_b32 v210, v210, v208
  v_mfma_f32_16x16x32_bf16 v[8:11], a[132:135], v[148:151], v[8:11]
  v_bfe_u32 v211, v209, 2, 4
  v_and_b32 v209, 3, v209
  v_mfma_f32_16x16x32_bf16 v[8:11], a[128:131], v[144:147], v[8:11]
  ds_read_b128 a[156:159], v215 offset:36864
  v_lshlrev_b32 v209, 3, v209
  v_mfma_f32_16x16x32_bf16 v[16:19], a[128:131], v[160:163], v[200:203]
  s_add_u32 m0, s28, 114688
  v_exp_f32 v0, v0
  v_mfma_f32_16x16x32_bf16 v[16:19], a[132:135], v[164:167], v[16:19]
  buffer_load_dwordx4 v236, s[16:19], s29 offen offset:0 lds
  v_mfma_f32_16x16x32_bf16 v[16:19], a[136:139], v[168:171], v[16:19]
  v_exp_f32 v1, v1
  v_mfma_f32_16x16x32_bf16 v[16:19], a[140:143], v[172:175], v[16:19]
  v_cvt_pk_bf16_f32 v0, v0, v1
  v_lshl_add_u32 v209, v211, 5, v209
  v_mfma_f32_16x16x32_bf16 v[24:27], a[140:143], v[188:191], v[204:207]
  v_exp_f32 v2, v2
  v_mfma_f32_16x16x32_bf16 v[24:27], a[136:139], v[184:187], v[24:27]
  buffer_load_dwordx4 v237, s[16:19], s29 offen offset:1024 lds
  v_mfma_f32_16x16x32_bf16 v[24:27], a[132:135], v[180:183], v[24:27]
  s_waitcnt lgkmcnt(0)
  v_exp_f32 v3, v3
  v_mfma_f32_16x16x32_bf16 v[24:27], a[128:131], v[176:179], v[24:27]
  v_cvt_pk_bf16_f32 v1, v2, v3
  v_add_u32 v209, s50, v209
  v_mfma_f32_16x16x32_bf16 v[4:7], a[144:147], v[128:131], v[192:195]
  s_and_b32 s39, s2, 1
  s_lshl_b32 s39, s39, 2
  s_add_u32 s39, s39, s3
  s_lshr_b32 s31, s2, 1
  s_mul_i32 s30, s31, 40960
  s_mul_i32 s48, s39, 160
  s_add_u32 s30, s30, s48
  s_mul_i32 s31, s31, 5120
  s_mul_i32 s39, s39, 655360
  s_add_u32 s31, s31, s39
  s_add_u32 s31, s31, 3145728
  s_lshr_b32 s39, s2, 3
  s_min_u32 s39, s39, 29
  s_and_b32 s48, s2, 7
  s_mul_i32 s48, s48, 30
  s_add_u32 s39, s39, s48
  s_mul_i32 s98, s39, 1639
  s_lshr_b32 s98, s98, 16
  s_mul_i32 s99, s98, 40
  s_sub_u32 s99, s39, s99
  s_min_u32 s39, s3, 2
  s_mul_i32 s48, s98, 3
  s_add_u32 s48, s48, s39
  s_mul_i32 s100, s48, 122880
  s_lshl_b32 s39, s99, 5
  s_add_u32 s100, s100, s39
  s_mul_i32 s101, s48, 192
  s_add_u32 s101, s101, 2633728
  s_mov_b32 s51, s50
  s_mov_b32 s4, s94
  s_mov_b32 s5, s95
  s_mov_b32 s6, 2211840
  s_mov_b32 s7, 0x20000
  v_exp_f32 v8, v8
  v_mfma_f32_16x16x32_bf16 v[4:7], a[148:151], v[132:135], v[4:7]
  ds_read_b128 a[128:131], v212 offset:40960
  v_mfma_f32_16x16x32_bf16 v[4:7], a[152:155], v[136:139], v[4:7]
  v_exp_f32 v9, v9
  v_mfma_f32_16x16x32_bf16 v[4:7], a[156:159], v[140:143], v[4:7]
  ds_read_b128 a[132:135], v213 offset:40960
  v_cvt_pk_bf16_f32 v8, v8, v9
  v_mfma_f32_16x16x32_bf16 v[12:15], a[156:159], v[156:159], v[196:199]
  v_exp_f32 v10, v10
  v_mfma_f32_16x16x32_bf16 v[12:15], a[152:155], v[152:155], v[12:15]
  ds_read_b128 a[136:139], v214 offset:40960
  v_mfma_f32_16x16x32_bf16 v[12:15], a[148:151], v[148:151], v[12:15]
  v_exp_f32 v11, v11
  v_mfma_f32_16x16x32_bf16 v[12:15], a[144:147], v[144:147], v[12:15]
  ds_read_b128 a[140:143], v215 offset:40960
  v_cvt_pk_bf16_f32 v9, v10, v11
  v_mfma_f32_16x16x32_bf16 v[20:23], a[144:147], v[160:163], v[200:203]
  v_exp_f32 v16, v16
  v_mfma_f32_16x16x32_bf16 v[20:23], a[148:151], v[164:167], v[20:23]
  buffer_load_dwordx4 v236, s[16:19], s29 offen offset:2048 lds
  v_mfma_f32_16x16x32_bf16 v[20:23], a[152:155], v[168:171], v[20:23]
  v_exp_f32 v17, v17
  v_mfma_f32_16x16x32_bf16 v[20:23], a[156:159], v[172:175], v[20:23]
  v_cvt_pk_bf16_f32 v16, v16, v17
  v_mfma_f32_16x16x32_bf16 v[28:31], a[156:159], v[188:191], v[204:207]
  v_exp_f32 v18, v18
  v_mfma_f32_16x16x32_bf16 v[28:31], a[152:155], v[184:187], v[28:31]
  buffer_load_dwordx4 v237, s[16:19], s29 offen offset:3072 lds
  v_mfma_f32_16x16x32_bf16 v[28:31], a[148:151], v[180:183], v[28:31]
  s_waitcnt lgkmcnt(0)
  s_add_u32 s29, s29, 16384
  v_exp_f32 v19, v19
  v_mfma_f32_16x16x32_bf16 v[28:31], a[144:147], v[176:179], v[28:31]
  v_cvt_pk_bf16_f32 v17, v18, v19
  v_mfma_f32_16x16x32_bf16 v[32:35], a[128:131], v[128:131], v[192:195]
  s_add_u32 m0, s28, 0
  v_exp_f32 v24, v24
  v_mfma_f32_16x16x32_bf16 v[32:35], a[132:135], v[132:135], v[32:35]
  ds_read_b128 a[144:147], v212 offset:45056
  v_mfma_f32_16x16x32_bf16 v[32:35], a[136:139], v[136:139], v[32:35]
  v_exp_f32 v25, v25
  v_mfma_f32_16x16x32_bf16 v[32:35], a[140:143], v[140:143], v[32:35]
  ds_read_b128 a[148:151], v213 offset:45056
  v_cvt_pk_bf16_f32 v24, v24, v25
  v_mfma_f32_16x16x32_bf16 v[40:43], a[140:143], v[156:159], v[196:199]
  v_exp_f32 v26, v26
  v_mfma_f32_16x16x32_bf16 v[40:43], a[136:139], v[152:155], v[40:43]
  ds_read_b128 a[152:155], v214 offset:45056
  v_mfma_f32_16x16x32_bf16 v[40:43], a[132:135], v[148:151], v[40:43]
  v_exp_f32 v27, v27
  v_mfma_f32_16x16x32_bf16 v[40:43], a[128:131], v[144:147], v[40:43]
  ds_read_b128 a[156:159], v215 offset:45056
  v_cvt_pk_bf16_f32 v25, v26, v27
  v_mfma_f32_16x16x32_bf16 v[48:51], a[128:131], v[160:163], v[200:203]
  v_exp_f32 v4, v4
  v_mfma_f32_16x16x32_bf16 v[48:51], a[132:135], v[164:167], v[48:51]
  buffer_load_dwordx4 v232, s[12:15], s29 offen offset:0 lds
  v_mfma_f32_16x16x32_bf16 v[48:51], a[136:139], v[168:171], v[48:51]
  v_exp_f32 v5, v5
  v_mfma_f32_16x16x32_bf16 v[48:51], a[140:143], v[172:175], v[48:51]
  v_cvt_pk_bf16_f32 v2, v4, v5
  v_mfma_f32_16x16x32_bf16 v[56:59], a[140:143], v[188:191], v[204:207]
  v_exp_f32 v6, v6
  v_mfma_f32_16x16x32_bf16 v[56:59], a[136:139], v[184:187], v[56:59]
  buffer_load_dwordx4 v233, s[12:15], s29 offen offset:1024 lds
  v_mfma_f32_16x16x32_bf16 v[56:59], a[132:135], v[180:183], v[56:59]
  s_waitcnt lgkmcnt(0)
  v_exp_f32 v7, v7
  v_mfma_f32_16x16x32_bf16 v[56:59], a[128:131], v[176:179], v[56:59]
  v_cvt_pk_bf16_f32 v3, v6, v7
  v_mfma_f32_16x16x32_bf16 v[36:39], a[144:147], v[128:131], v[192:195]
  v_exp_f32 v12, v12
  v_mfma_f32_16x16x32_bf16 v[36:39], a[148:151], v[132:135], v[36:39]
  buffer_load_dwordx4 v234, s[12:15], s29 offen offset:2048 lds
  v_mfma_f32_16x16x32_bf16 v[36:39], a[152:155], v[136:139], v[36:39]
  v_exp_f32 v13, v13
  v_mfma_f32_16x16x32_bf16 v[36:39], a[156:159], v[140:143], v[36:39]
  v_cvt_pk_bf16_f32 v10, v12, v13
  v_mfma_f32_16x16x32_bf16 v[44:47], a[156:159], v[156:159], v[196:199]
  v_exp_f32 v14, v14
  v_mfma_f32_16x16x32_bf16 v[44:47], a[152:155], v[152:155], v[44:47]
  buffer_load_dwordx4 v235, s[12:15], s29 offen offset:3072 lds
  v_mfma_f32_16x16x32_bf16 v[44:47], a[148:151], v[148:151], v[44:47]
  v_exp_f32 v15, v15
  v_mfma_f32_16x16x32_bf16 v[44:47], a[144:147], v[144:147], v[44:47]
  v_cvt_pk_bf16_f32 v11, v14, v15
  v_mfma_f32_16x16x32_bf16 v[52:55], a[144:147], v[160:163], v[200:203]
  v_exp_f32 v20, v20
  v_mfma_f32_16x16x32_bf16 v[52:55], a[148:151], v[164:167], v[52:55]
  ds_read_b64_tr_b16 a[160:161], v216 offset:16384
  v_mfma_f32_16x16x32_bf16 v[52:55], a[152:155], v[168:171], v[52:55]
  v_exp_f32 v21, v21
  v_mfma_f32_16x16x32_bf16 v[52:55], a[156:159], v[172:175], v[52:55]
  ds_read_b64_tr_b16 a[162:163], v216 offset:20480
  v_cvt_pk_bf16_f32 v18, v20, v21
  v_mfma_f32_16x16x32_bf16 v[60:63], a[156:159], v[188:191], v[204:207]
  v_exp_f32 v22, v22
  v_mfma_f32_16x16x32_bf16 v[60:63], a[152:155], v[184:187], v[60:63]
  ds_read_b64_tr_b16 a[164:165], v216 offset:24576
  v_mfma_f32_16x16x32_bf16 v[60:63], a[148:151], v[180:183], v[60:63]
  v_exp_f32 v23, v23
  v_mfma_f32_16x16x32_bf16 v[60:63], a[144:147], v[176:179], v[60:63]
  ds_read_b64_tr_b16 a[166:167], v216 offset:28672
  v_cvt_pk_bf16_f32 v19, v22, v23
  v_mfma_f32_16x16x32_bf16 a[192:195], a[208:211], v[64:67], a[192:195]
  v_exp_f32 v28, v28
  v_mfma_f32_16x16x32_bf16 a[192:195], a[208:211], v[96:99], a[192:195]
  ds_read_b64_tr_b16 a[168:169], v217 offset:16384
  v_mfma_f32_16x16x32_bf16 a[196:199], a[208:211], v[72:75], a[196:199]
  v_exp_f32 v29, v29
  v_mfma_f32_16x16x32_bf16 a[196:199], a[208:211], v[104:107], a[196:199]
  ds_read_b64_tr_b16 a[170:171], v217 offset:20480
  v_cvt_pk_bf16_f32 v26, v28, v29
  v_mfma_f32_16x16x32_bf16 a[200:203], a[208:211], v[80:83], a[200:203]
  v_exp_f32 v30, v30
  v_mfma_f32_16x16x32_bf16 a[200:203], a[208:211], v[112:115], a[200:203]
  ds_read_b64_tr_b16 a[172:173], v217 offset:24576
  v_mfma_f32_16x16x32_bf16 a[204:207], a[208:211], v[88:91], a[204:207]
  s_waitcnt lgkmcnt(3)
  v_exp_f32 v31, v31
  v_mfma_f32_16x16x32_bf16 a[204:207], a[208:211], v[120:123], a[204:207]
  ds_read_b64_tr_b16 a[174:175], v217 offset:28672
  v_cvt_pk_bf16_f32 v27, v30, v31
  v_mfma_f32_16x16x32_bf16 a[0:3], a[160:163], v[64:67], a[0:3]
  v_exp_f32 v32, v32
  v_mfma_f32_16x16x32_bf16 a[0:3], a[164:167], v[96:99], a[0:3]
  ds_read_b64_tr_b16 a[176:177], v218 offset:16384
  v_mfma_f32_16x16x32_bf16 a[4:7], a[164:167], v[104:107], a[4:7]
  v_exp_f32 v33, v33
  v_mfma_f32_16x16x32_bf16 a[4:7], a[160:163], v[72:75], a[4:7]
  ds_read_b64_tr_b16 a[178:179], v218 offset:20480
  v_cvt_pk_bf16_f32 v32, v32, v33
  v_mfma_f32_16x16x32_bf16 a[8:11], a[160:163], v[80:83], a[8:11]
  v_exp_f32 v34, v34
  v_mfma_f32_16x16x32_bf16 a[8:11], a[164:167], v[112:115], a[8:11]
  ds_read_b64_tr_b16 a[180:181], v218 offset:24576
  v_mfma_f32_16x16x32_bf16 a[12:15], a[164:167], v[120:123], a[12:15]
  s_waitcnt lgkmcnt(3)
  v_exp_f32 v35, v35
  v_mfma_f32_16x16x32_bf16 a[12:15], a[160:163], v[88:91], a[12:15]
  ds_read_b64_tr_b16 a[182:183], v218 offset:28672
  v_cvt_pk_bf16_f32 v33, v34, v35
  v_mfma_f32_16x16x32_bf16 a[16:19], a[168:171], v[64:67], a[16:19]
  v_exp_f32 v40, v40
  v_mfma_f32_16x16x32_bf16 a[16:19], a[172:175], v[96:99], a[16:19]
  ds_read_b64_tr_b16 a[184:185], v219 offset:16384
  v_mfma_f32_16x16x32_bf16 a[20:23], a[172:175], v[104:107], a[20:23]
  v_exp_f32 v41, v41
  v_mfma_f32_16x16x32_bf16 a[20:23], a[168:171], v[72:75], a[20:23]
  ds_read_b64_tr_b16 a[186:187], v219 offset:20480
  v_cvt_pk_bf16_f32 v40, v40, v41
  v_mfma_f32_16x16x32_bf16 a[24:27], a[168:171], v[80:83], a[24:27]
  v_exp_f32 v42, v42
  v_mfma_f32_16x16x32_bf16 a[24:27], a[172:175], v[112:115], a[24:27]
  ds_read_b64_tr_b16 a[188:189], v219 offset:24576
  v_mfma_f32_16x16x32_bf16 a[28:31], a[172:175], v[120:123], a[28:31]
  s_waitcnt lgkmcnt(3)
  v_exp_f32 v43, v43
  v_mfma_f32_16x16x32_bf16 a[28:31], a[168:171], v[88:91], a[28:31]
  ds_read_b64_tr_b16 a[190:191], v219 offset:28672
  v_cvt_pk_bf16_f32 v41, v42, v43
  v_mfma_f32_16x16x32_bf16 a[32:35], a[176:179], v[64:67], a[32:35]
  v_exp_f32 v48, v48
  v_mfma_f32_16x16x32_bf16 a[32:35], a[180:183], v[96:99], a[32:35]
  ds_read_b64_tr_b16 a[160:161], v220 offset:16384
  v_mfma_f32_16x16x32_bf16 a[36:39], a[180:183], v[104:107], a[36:39]
  v_exp_f32 v49, v49
  v_mfma_f32_16x16x32_bf16 a[36:39], a[176:179], v[72:75], a[36:39]
  ds_read_b64_tr_b16 a[162:163], v220 offset:20480
  v_cvt_pk_bf16_f32 v48, v48, v49
  v_mfma_f32_16x16x32_bf16 a[40:43], a[176:179], v[80:83], a[40:43]
  v_exp_f32 v50, v50
  v_mfma_f32_16x16x32_bf16 a[40:43], a[180:183], v[112:115], a[40:43]
  ds_read_b64_tr_b16 a[164:165], v220 offset:24576
  v_mfma_f32_16x16x32_bf16 a[44:47], a[180:183], v[120:123], a[44:47]
  s_waitcnt lgkmcnt(3)
  v_exp_f32 v51, v51
  v_mfma_f32_16x16x32_bf16 a[44:47], a[176:179], v[88:91], a[44:47]
  ds_read_b64_tr_b16 a[166:167], v220 offset:28672
  v_cvt_pk_bf16_f32 v49, v50, v51
  v_mfma_f32_16x16x32_bf16 a[48:51], a[184:187], v[64:67], a[48:51]
  v_exp_f32 v56, v56
  v_mfma_f32_16x16x32_bf16 a[48:51], a[188:191], v[96:99], a[48:51]
  ds_read_b64_tr_b16 a[168:169], v221 offset:16384
  v_mfma_f32_16x16x32_bf16 a[52:55], a[188:191], v[104:107], a[52:55]
  v_exp_f32 v57, v57
  v_mfma_f32_16x16x32_bf16 a[52:55], a[184:187], v[72:75], a[52:55]
  ds_read_b64_tr_b16 a[170:171], v221 offset:20480
  v_cvt_pk_bf16_f32 v56, v56, v57
  v_mfma_f32_16x16x32_bf16 a[56:59], a[184:187], v[80:83], a[56:59]
  v_exp_f32 v58, v58
  v_mfma_f32_16x16x32_bf16 a[56:59], a[188:191], v[112:115], a[56:59]
  ds_read_b64_tr_b16 a[172:173], v221 offset:24576
  v_mfma_f32_16x16x32_bf16 a[60:63], a[188:191], v[120:123], a[60:63]
  s_waitcnt lgkmcnt(3)
  v_exp_f32 v59, v59
  v_mfma_f32_16x16x32_bf16 a[60:63], a[184:187], v[88:91], a[60:63]
  ds_read_b64_tr_b16 a[174:175], v221 offset:28672
  v_cvt_pk_bf16_f32 v57, v58, v59
  v_mfma_f32_16x16x32_bf16 a[64:67], a[160:163], v[64:67], a[64:67]
  v_exp_f32 v36, v36
  v_mfma_f32_16x16x32_bf16 a[64:67], a[164:167], v[96:99], a[64:67]
  ds_read_b64_tr_b16 a[176:177], v222 offset:16384
  v_mfma_f32_16x16x32_bf16 a[68:71], a[164:167], v[104:107], a[68:71]
  v_exp_f32 v37, v37
  v_mfma_f32_16x16x32_bf16 a[68:71], a[160:163], v[72:75], a[68:71]
  ds_read_b64_tr_b16 a[178:179], v222 offset:20480
  v_cvt_pk_bf16_f32 v34, v36, v37
  v_mfma_f32_16x16x32_bf16 a[72:75], a[160:163], v[80:83], a[72:75]
  v_exp_f32 v38, v38
  v_mfma_f32_16x16x32_bf16 a[72:75], a[164:167], v[112:115], a[72:75]
  ds_read_b64_tr_b16 a[180:181], v222 offset:24576
  v_mfma_f32_16x16x32_bf16 a[76:79], a[164:167], v[120:123], a[76:79]
  s_waitcnt lgkmcnt(3)
  v_exp_f32 v39, v39
  v_mfma_f32_16x16x32_bf16 a[76:79], a[160:163], v[88:91], a[76:79]
  ds_read_b64_tr_b16 a[182:183], v222 offset:28672
  v_cvt_pk_bf16_f32 v35, v38, v39
  v_mfma_f32_16x16x32_bf16 a[80:83], a[168:171], v[64:67], a[80:83]
  v_exp_f32 v44, v44
  v_mfma_f32_16x16x32_bf16 a[80:83], a[172:175], v[96:99], a[80:83]
  ds_read_b64_tr_b16 a[184:185], v223 offset:16384
  v_mfma_f32_16x16x32_bf16 a[84:87], a[172:175], v[104:107], a[84:87]
  v_exp_f32 v45, v45
  v_mfma_f32_16x16x32_bf16 a[84:87], a[168:171], v[72:75], a[84:87]
  ds_read_b64_tr_b16 a[186:187], v223 offset:20480
  v_cvt_pk_bf16_f32 v42, v44, v45
  v_mfma_f32_16x16x32_bf16 a[88:91], a[168:171], v[80:83], a[88:91]
  v_exp_f32 v46, v46
  v_mfma_f32_16x16x32_bf16 a[88:91], a[172:175], v[112:115], a[88:91]
  ds_read_b64_tr_b16 a[188:189], v223 offset:24576
  v_mfma_f32_16x16x32_bf16 a[92:95], a[172:175], v[120:123], a[92:95]
  s_waitcnt lgkmcnt(3)
  v_exp_f32 v47, v47
  v_mfma_f32_16x16x32_bf16 a[92:95], a[168:171], v[88:91], a[92:95]
  ds_read_b64_tr_b16 a[190:191], v223 offset:28672
  v_cvt_pk_bf16_f32 v43, v46, v47
  v_mfma_f32_16x16x32_bf16 a[96:99], a[176:179], v[64:67], a[96:99]
  s_waitcnt vmcnt(9)
  v_exp_f32 v52, v52
  v_mfma_f32_16x16x32_bf16 a[96:99], a[180:183], v[96:99], a[96:99]
  v_mfma_f32_16x16x32_bf16 a[100:103], a[180:183], v[104:107], a[100:103]
  s_barrier
  v_exp_f32 v53, v53
  v_mfma_f32_16x16x32_bf16 a[100:103], a[176:179], v[72:75], a[100:103]
  ds_read_b128 a[128:131], v212 offset:49152
  v_cvt_pk_bf16_f32 v50, v52, v53
  v_mfma_f32_16x16x32_bf16 a[104:107], a[176:179], v[80:83], a[104:107]
  v_exp_f32 v54, v54
  v_mfma_f32_16x16x32_bf16 a[104:107], a[180:183], v[112:115], a[104:107]
  ds_read_b128 a[132:135], v213 offset:49152
  v_mfma_f32_16x16x32_bf16 a[108:111], a[180:183], v[120:123], a[108:111]
  s_waitcnt lgkmcnt(2)
  v_exp_f32 v55, v55
  v_mfma_f32_16x16x32_bf16 a[108:111], a[176:179], v[88:91], a[108:111]
  ds_read_b128 a[136:139], v214 offset:49152
  v_cvt_pk_bf16_f32 v51, v54, v55
  v_mfma_f32_16x16x32_bf16 a[112:115], a[184:187], v[64:67], a[112:115]
  v_exp_f32 v60, v60
  v_mfma_f32_16x16x32_bf16 a[112:115], a[188:191], v[96:99], a[112:115]
  ds_read_b128 a[140:143], v215 offset:49152
  v_mfma_f32_16x16x32_bf16 a[116:119], a[188:191], v[104:107], a[116:119]
  v_exp_f32 v61, v61
  v_mfma_f32_16x16x32_bf16 a[116:119], a[184:187], v[72:75], a[116:119]
  v_cvt_pk_bf16_f32 v58, v60, v61
  v_mfma_f32_16x16x32_bf16 a[120:123], a[184:187], v[80:83], a[120:123]
  v_exp_f32 v62, v62
  v_mfma_f32_16x16x32_bf16 a[120:123], a[188:191], v[112:115], a[120:123]
  v_mfma_f32_16x16x32_bf16 a[124:127], a[188:191], v[120:123], a[124:127]
  s_waitcnt lgkmcnt(0)
  v_exp_f32 v63, v63
  v_mfma_f32_16x16x32_bf16 a[124:127], a[184:187], v[88:91], a[124:127]
  v_cvt_pk_bf16_f32 v59, v62, v63
  v_mfma_f32_16x16x32_bf16 v[64:67], a[128:131], v[128:131], v[192:195]
  v_lshrrev_b32 v224, 4, v242
  v_lshrrev_b32 v225, 4, v224
  v_mfma_f32_16x16x32_bf16 v[64:67], a[132:135], v[132:135], v[64:67]
  ds_read_b128 a[144:147], v212 offset:53248
  v_bfe_u32 v226, v224, 2, 2
  v_mfma_f32_16x16x32_bf16 v[64:67], a[136:139], v[136:139], v[64:67]
  v_lshl_add_u32 v225, v225, 3, v226
  v_lshlrev_b32 v225, 4, v225
  v_mfma_f32_16x16x32_bf16 v[64:67], a[140:143], v[140:143], v[64:67]
  ds_read_b128 a[148:151], v213 offset:53248
  v_bfe_u32 v226, v224, 1, 1
  v_mfma_f32_16x16x32_bf16 v[72:75], a[140:143], v[156:159], v[196:199]
  v_mul_u32_u24 v226, 0xc00, v226
  v_add3_u32 v225, v225, v226, s50
  v_mfma_f32_16x16x32_bf16 v[72:75], a[136:139], v[152:155], v[72:75]
  ds_read_b128 a[152:155], v214 offset:53248
  v_and_b32 v226, 1, v224
  v_mfma_f32_16x16x32_bf16 v[72:75], a[132:135], v[148:151], v[72:75]
  v_lshl_add_u32 v225, v226, 3, v225
  v_mfma_f32_16x16x32_bf16 v[72:75], a[128:131], v[144:147], v[72:75]
  ds_read_b128 a[156:159], v215 offset:53248
  s_waitcnt vmcnt(8)
  ds_read_b64_tr_b16 a[232:233], v225 offset:0
  v_mfma_f32_16x16x32_bf16 v[80:83], a[128:131], v[160:163], v[200:203]
  s_add_u32 m0, s28, 65536
  v_exp_f32 v64, v64
  v_mfma_f32_16x16x32_bf16 v[80:83], a[132:135], v[164:167], v[80:83]
  buffer_load_dwordx4 v236, s[16:19], s29 offen offset:0 lds
  v_mfma_f32_16x16x32_bf16 v[80:83], a[136:139], v[168:171], v[80:83]
  v_exp_f32 v65, v65
  v_mfma_f32_16x16x32_bf16 v[80:83], a[140:143], v[172:175], v[80:83]
  ds_read_b64_tr_b16 a[234:235], v225 offset:64
  v_cvt_pk_bf16_f32 v64, v64, v65
  v_mfma_f32_16x16x32_bf16 v[88:91], a[140:143], v[188:191], v[204:207]
  v_exp_f32 v66, v66
  v_mfma_f32_16x16x32_bf16 v[88:91], a[136:139], v[184:187], v[88:91]
  buffer_load_dwordx4 v237, s[16:19], s29 offen offset:1024 lds
  v_mfma_f32_16x16x32_bf16 v[88:91], a[132:135], v[180:183], v[88:91]
  s_waitcnt lgkmcnt(2)
  v_exp_f32 v67, v67
  v_mfma_f32_16x16x32_bf16 v[88:91], a[128:131], v[176:179], v[88:91]
  ds_read_b64_tr_b16 a[236:237], v225 offset:512
  v_cvt_pk_bf16_f32 v65, v66, v67
  v_mfma_f32_16x16x32_bf16 v[68:71], a[144:147], v[128:131], v[192:195]
  v_exp_f32 v72, v72
  v_mfma_f32_16x16x32_bf16 v[68:71], a[148:151], v[132:135], v[68:71]
  ds_read_b128 a[128:131], v212 offset:57344
  ds_read_b64_tr_b16 a[238:239], v225 offset:576
  v_mfma_f32_16x16x32_bf16 v[68:71], a[152:155], v[136:139], v[68:71]
  v_exp_f32 v73, v73
  v_mfma_f32_16x16x32_bf16 v[68:71], a[156:159], v[140:143], v[68:71]
  ds_read_b128 a[132:135], v213 offset:57344
  v_cvt_pk_bf16_f32 v72, v72, v73
  v_mfma_f32_16x16x32_bf16 v[76:79], a[156:159], v[156:159], v[196:199]
  v_exp_f32 v74, v74
  v_mfma_f32_16x16x32_bf16 v[76:79], a[152:155], v[152:155], v[76:79]
  ds_read_b128 a[136:139], v214 offset:57344
  ds_read_b64_tr_b16 a[240:241], v225 offset:1024
  v_mfma_f32_16x16x32_bf16 v[76:79], a[148:151], v[148:151], v[76:79]
  v_exp_f32 v75, v75
  v_mfma_f32_16x16x32_bf16 v[76:79], a[144:147], v[144:147], v[76:79]
  ds_read_b128 a[140:143], v215 offset:57344
  v_cvt_pk_bf16_f32 v73, v74, v75
  v_mfma_f32_16x16x32_bf16 v[84:87], a[144:147], v[160:163], v[200:203]
  v_exp_f32 v80, v80
  v_mfma_f32_16x16x32_bf16 v[84:87], a[148:151], v[164:167], v[84:87]
  buffer_load_dwordx4 v236, s[16:19], s29 offen offset:2048 lds
  v_mfma_f32_16x16x32_bf16 v[84:87], a[152:155], v[168:171], v[84:87]
  v_exp_f32 v81, v81
  v_mfma_f32_16x16x32_bf16 v[84:87], a[156:159], v[172:175], v[84:87]
  ds_read_b64_tr_b16 a[242:243], v225 offset:1088
  v_cvt_pk_bf16_f32 v80, v80, v81
  v_mfma_f32_16x16x32_bf16 v[92:95], a[156:159], v[188:191], v[204:207]
  v_exp_f32 v82, v82
  v_mfma_f32_16x16x32_bf16 v[92:95], a[152:155], v[184:187], v[92:95]
  buffer_load_dwordx4 v237, s[16:19], s29 offen offset:3072 lds
  v_mfma_f32_16x16x32_bf16 v[92:95], a[148:151], v[180:183], v[92:95]
  s_waitcnt lgkmcnt(1)
  s_add_u32 s29, s29, 16384
  v_exp_f32 v83, v83
  v_mfma_f32_16x16x32_bf16 v[92:95], a[144:147], v[176:179], v[92:95]
  ds_read_b64_tr_b16 a[244:245], v225 offset:1536
  v_cvt_pk_bf16_f32 v81, v82, v83
  v_mfma_f32_16x16x32_bf16 v[96:99], a[128:131], v[128:131], v[192:195]
  s_add_u32 m0, s28, 16384
  v_exp_f32 v88, v88
  v_mfma_f32_16x16x32_bf16 v[96:99], a[132:135], v[132:135], v[96:99]
  ds_read_b128 a[144:147], v212 offset:61440
  ds_read_b64_tr_b16 a[246:247], v225 offset:1600
  v_mfma_f32_16x16x32_bf16 v[96:99], a[136:139], v[136:139], v[96:99]
  v_exp_f32 v89, v89
  v_mfma_f32_16x16x32_bf16 v[96:99], a[140:143], v[140:143], v[96:99]
  ds_read_b128 a[148:151], v213 offset:61440
  v_cvt_pk_bf16_f32 v88, v88, v89
  v_mfma_f32_16x16x32_bf16 v[104:107], a[140:143], v[156:159], v[196:199]
  v_exp_f32 v90, v90
  v_mfma_f32_16x16x32_bf16 v[104:107], a[136:139], v[152:155], v[104:107]
  ds_read_b128 a[152:155], v214 offset:61440
  ds_read_b64_tr_b16 a[248:249], v225 offset:2048
  v_mfma_f32_16x16x32_bf16 v[104:107], a[132:135], v[148:151], v[104:107]
  v_exp_f32 v91, v91
  v_mfma_f32_16x16x32_bf16 v[104:107], a[128:131], v[144:147], v[104:107]
  ds_read_b128 a[156:159], v215 offset:61440
  v_cvt_pk_bf16_f32 v89, v90, v91
  v_mfma_f32_16x16x32_bf16 v[112:115], a[128:131], v[160:163], v[200:203]
  v_exp_f32 v68, v68
  v_mfma_f32_16x16x32_bf16 v[112:115], a[132:135], v[164:167], v[112:115]
  buffer_load_dwordx4 v232, s[12:15], s29 offen offset:0 lds
  v_mfma_f32_16x16x32_bf16 v[112:115], a[136:139], v[168:171], v[112:115]
  v_exp_f32 v69, v69
  v_mfma_f32_16x16x32_bf16 v[112:115], a[140:143], v[172:175], v[112:115]
  ds_read_b64_tr_b16 a[250:251], v225 offset:2112
  s_waitcnt lgkmcnt(0)
  v_cvt_pk_bf16_f32 v66, v68, v69
  v_mfma_f32_16x16x32_bf16 v[228:231], a[232:235], a[212:215], 0
  v_mfma_f32_16x16x32_bf16 v[228:231], a[236:239], a[216:219], v[228:231]
  v_mfma_f32_16x16x32_bf16 v[228:231], a[240:243], a[220:223], v[228:231]
  v_mfma_f32_16x16x32_bf16 v[228:231], a[244:247], a[224:227], v[228:231]
  v_mfma_f32_16x16x32_bf16 v[228:231], a[248:251], a[228:231], v[228:231]
  v_mfma_f32_16x16x32_bf16 v[120:123], a[140:143], v[188:191], v[204:207]
  s_lshl_b32 s35, s3, 10
  s_add_u32 s35, s35, 133120
  v_exp_f32 v70, v70
  v_mfma_f32_16x16x32_bf16 v[120:123], a[136:139], v[184:187], v[120:123]
  buffer_load_dwordx4 v233, s[12:15], s29 offen offset:1024 lds
  v_mfma_f32_16x16x32_bf16 v[120:123], a[132:135], v[180:183], v[120:123]
  v_exp_f32 v71, v71
  v_mfma_f32_16x16x32_bf16 v[120:123], a[128:131], v[176:179], v[120:123]
  v_cvt_pk_bf16_f32 v67, v70, v71
  v_add_u32 v224, s35, v242
  v_mfma_f32_16x16x32_bf16 v[100:103], a[144:147], v[128:131], v[192:195]
  v_exp_f32 v76, v76
  v_mfma_f32_16x16x32_bf16 v[100:103], a[148:151], v[132:135], v[100:103]
  buffer_load_dwordx4 v234, s[12:15], s29 offen offset:2048 lds
  v_mfma_f32_16x16x32_bf16 v[100:103], a[152:155], v[136:139], v[100:103]
  v_exp_f32 v77, v77
  v_mfma_f32_16x16x32_bf16 v[100:103], a[156:159], v[140:143], v[100:103]
  ds_write_b128 v224, v[228:231]
  s_waitcnt lgkmcnt(0)
  v_cvt_pk_bf16_f32 v74, v76, v77
  v_mfma_f32_16x16x32_bf16 v[108:111], a[156:159], v[156:159], v[196:199]
  v_exp_f32 v78, v78
  v_mfma_f32_16x16x32_bf16 v[108:111], a[152:155], v[152:155], v[108:111]
  buffer_load_dwordx4 v235, s[12:15], s29 offen offset:3072 lds
  v_mfma_f32_16x16x32_bf16 v[108:111], a[148:151], v[148:151], v[108:111]
  v_exp_f32 v79, v79
  v_mfma_f32_16x16x32_bf16 v[108:111], a[144:147], v[144:147], v[108:111]
  v_cvt_pk_bf16_f32 v75, v78, v79
  v_lshrrev_b32 v224, 4, v242
  v_mfma_f32_16x16x32_bf16 v[116:119], a[144:147], v[160:163], v[200:203]
  v_exp_f32 v84, v84
  v_mfma_f32_16x16x32_bf16 v[116:119], a[148:151], v[164:167], v[116:119]
  ds_read_b64_tr_b16 a[160:161], v216 offset:32768
  v_bfe_u32 v225, v224, 2, 1
  v_mfma_f32_16x16x32_bf16 v[116:119], a[152:155], v[168:171], v[116:119]
  v_exp_f32 v85, v85
  v_mfma_f32_16x16x32_bf16 v[116:119], a[156:159], v[172:175], v[116:119]
  ds_read_b64_tr_b16 a[162:163], v216 offset:36864
  v_cvt_pk_bf16_f32 v82, v84, v85
  v_mfma_f32_16x16x32_bf16 v[124:127], a[156:159], v[188:191], v[204:207]
  v_exp_f32 v86, v86
  v_mfma_f32_16x16x32_bf16 v[124:127], a[152:155], v[184:187], v[124:127]
  ds_read_b64_tr_b16 a[164:165], v216 offset:40960
  v_lshlrev_b32 v225, 8, v225
  v_mfma_f32_16x16x32_bf16 v[124:127], a[148:151], v[180:183], v[124:127]
  v_exp_f32 v87, v87
  v_mfma_f32_16x16x32_bf16 v[124:127], a[144:147], v[176:179], v[124:127]
  ds_read_b64_tr_b16 a[166:167], v216 offset:45056
  v_cvt_pk_bf16_f32 v83, v86, v87
  v_mfma_f32_16x16x32_bf16 a[192:195], a[208:211], v[0:3], a[192:195]
  v_exp_f32 v92, v92
  v_mfma_f32_16x16x32_bf16 a[192:195], a[208:211], v[32:35], a[192:195]
  ds_read_b64_tr_b16 a[168:169], v217 offset:32768
  v_lshrrev_b32 v226, 3, v224
  v_mfma_f32_16x16x32_bf16 a[196:199], a[208:211], v[8:11], a[196:199]
  v_exp_f32 v93, v93
  v_mfma_f32_16x16x32_bf16 a[196:199], a[208:211], v[40:43], a[196:199]
  ds_read_b64_tr_b16 a[170:171], v217 offset:36864
  v_cvt_pk_bf16_f32 v90, v92, v93
  v_mfma_f32_16x16x32_bf16 a[200:203], a[208:211], v[16:19], a[200:203]
  v_exp_f32 v94, v94
  v_mfma_f32_16x16x32_bf16 a[200:203], a[208:211], v[48:51], a[200:203]
  ds_read_b64_tr_b16 a[172:173], v217 offset:40960
  v_lshl_add_u32 v225, v226, 4, v225
  v_mfma_f32_16x16x32_bf16 a[204:207], a[208:211], v[24:27], a[204:207]
  s_waitcnt lgkmcnt(3)
  v_exp_f32 v95, v95
  v_mfma_f32_16x16x32_bf16 a[204:207], a[208:211], v[56:59], a[204:207]
  ds_read_b64_tr_b16 a[174:175], v217 offset:45056
  v_cvt_pk_bf16_f32 v91, v94, v95
  v_mfma_f32_16x16x32_bf16 a[0:3], a[160:163], v[0:3], a[0:3]
  v_exp_f32 v96, v96
  v_mfma_f32_16x16x32_bf16 a[0:3], a[164:167], v[32:35], a[0:3]
  ds_read_b64_tr_b16 a[176:177], v218 offset:32768
  v_and_b32 v227, 3, v224
  v_mfma_f32_16x16x32_bf16 a[4:7], a[164:167], v[40:43], a[4:7]
  v_exp_f32 v97, v97
  v_mfma_f32_16x16x32_bf16 a[4:7], a[160:163], v[8:11], a[4:7]
  ds_read_b64_tr_b16 a[178:179], v218 offset:36864
  v_cvt_pk_bf16_f32 v96, v96, v97
  v_mfma_f32_16x16x32_bf16 a[8:11], a[160:163], v[16:19], a[8:11]
  v_exp_f32 v98, v98
  v_mfma_f32_16x16x32_bf16 a[8:11], a[164:167], v[48:51], a[8:11]
  ds_read_b64_tr_b16 a[180:181], v218 offset:40960
  v_lshl_add_u32 v225, v227, 2, v225
  v_mfma_f32_16x16x32_bf16 a[12:15], a[164:167], v[56:59], a[12:15]
  s_waitcnt lgkmcnt(3)
  v_exp_f32 v99, v99
  v_mfma_f32_16x16x32_bf16 a[12:15], a[160:163], v[24:27], a[12:15]
  ds_read_b64_tr_b16 a[182:183], v218 offset:45056
  v_cvt_pk_bf16_f32 v97, v98, v99
  v_mfma_f32_16x16x32_bf16 a[16:19], a[168:171], v[0:3], a[16:19]
  v_exp_f32 v104, v104
  v_mfma_f32_16x16x32_bf16 a[16:19], a[172:175], v[32:35], a[16:19]
  ds_read_b64_tr_b16 a[184:185], v219 offset:32768
  v_add_u32 v225, 133120, v225
  v_mfma_f32_16x16x32_bf16 a[20:23], a[172:175], v[40:43], a[20:23]
  v_exp_f32 v105, v105
  v_mfma_f32_16x16x32_bf16 a[20:23], a[168:171], v[8:11], a[20:23]
  ds_read_b64_tr_b16 a[186:187], v219 offset:36864
  v_cvt_pk_bf16_f32 v104, v104, v105
  v_mfma_f32_16x16x32_bf16 a[24:27], a[168:171], v[16:19], a[24:27]
  v_exp_f32 v106, v106
  v_mfma_f32_16x16x32_bf16 a[24:27], a[172:175], v[48:51], a[24:27]
  ds_read_b64_tr_b16 a[188:189], v219 offset:40960
  v_mfma_f32_16x16x32_bf16 a[28:31], a[172:175], v[56:59], a[28:31]
  s_waitcnt lgkmcnt(3)
  v_exp_f32 v107, v107
  v_mfma_f32_16x16x32_bf16 a[28:31], a[168:171], v[24:27], a[28:31]
  ds_read_b64_tr_b16 a[190:191], v219 offset:45056
  v_cvt_pk_bf16_f32 v105, v106, v107
  v_mfma_f32_16x16x32_bf16 a[32:35], a[176:179], v[0:3], a[32:35]
  v_exp_f32 v112, v112
  v_mfma_f32_16x16x32_bf16 a[32:35], a[180:183], v[32:35], a[32:35]
  ds_read_b64_tr_b16 a[160:161], v220 offset:32768
  v_mfma_f32_16x16x32_bf16 a[36:39], a[180:183], v[40:43], a[36:39]
  v_exp_f32 v113, v113
  v_mfma_f32_16x16x32_bf16 a[36:39], a[176:179], v[8:11], a[36:39]
  ds_read_b64_tr_b16 a[162:163], v220 offset:36864
  v_cvt_pk_bf16_f32 v112, v112, v113
  v_mfma_f32_16x16x32_bf16 a[40:43], a[176:179], v[16:19], a[40:43]
  v_exp_f32 v114, v114
  v_mfma_f32_16x16x32_bf16 a[40:43], a[180:183], v[48:51], a[40:43]
  ds_read_b64_tr_b16 a[164:165], v220 offset:40960
  v_mfma_f32_16x16x32_bf16 a[44:47], a[180:183], v[56:59], a[44:47]
  s_waitcnt lgkmcnt(3)
  v_exp_f32 v115, v115
  v_mfma_f32_16x16x32_bf16 a[44:47], a[176:179], v[24:27], a[44:47]
  ds_read_b64_tr_b16 a[166:167], v220 offset:45056
  v_cvt_pk_bf16_f32 v113, v114, v115
  v_mfma_f32_16x16x32_bf16 a[48:51], a[184:187], v[0:3], a[48:51]
  v_exp_f32 v120, v120
  v_mfma_f32_16x16x32_bf16 a[48:51], a[188:191], v[32:35], a[48:51]
  ds_read_b64_tr_b16 a[168:169], v221 offset:32768
  v_mfma_f32_16x16x32_bf16 a[52:55], a[188:191], v[40:43], a[52:55]
  v_exp_f32 v121, v121
  v_mfma_f32_16x16x32_bf16 a[52:55], a[184:187], v[8:11], a[52:55]
  ds_read_b64_tr_b16 a[170:171], v221 offset:36864
  v_cvt_pk_bf16_f32 v120, v120, v121
  v_mfma_f32_16x16x32_bf16 a[56:59], a[184:187], v[16:19], a[56:59]
  v_exp_f32 v122, v122
  v_mfma_f32_16x16x32_bf16 a[56:59], a[188:191], v[48:51], a[56:59]
  ds_read_b64_tr_b16 a[172:173], v221 offset:40960
  v_mfma_f32_16x16x32_bf16 a[60:63], a[188:191], v[56:59], a[60:63]
  s_waitcnt lgkmcnt(3)
  v_exp_f32 v123, v123
  v_mfma_f32_16x16x32_bf16 a[60:63], a[184:187], v[24:27], a[60:63]
  ds_read_b64_tr_b16 a[174:175], v221 offset:45056
  v_cvt_pk_bf16_f32 v121, v122, v123
  v_mfma_f32_16x16x32_bf16 a[64:67], a[160:163], v[0:3], a[64:67]
  v_exp_f32 v100, v100
  v_mfma_f32_16x16x32_bf16 a[64:67], a[164:167], v[32:35], a[64:67]
  ds_read_b64_tr_b16 a[176:177], v222 offset:32768
  v_mfma_f32_16x16x32_bf16 a[68:71], a[164:167], v[40:43], a[68:71]
  v_exp_f32 v101, v101
  v_mfma_f32_16x16x32_bf16 a[68:71], a[160:163], v[8:11], a[68:71]
  ds_read_b64_tr_b16 a[178:179], v222 offset:36864
  v_cvt_pk_bf16_f32 v98, v100, v101
  v_mfma_f32_16x16x32_bf16 a[72:75], a[160:163], v[16:19], a[72:75]
  v_exp_f32 v102, v102
  v_mfma_f32_16x16x32_bf16 a[72:75], a[164:167], v[48:51], a[72:75]
  ds_read_b64_tr_b16 a[180:181], v222 offset:40960
  v_mfma_f32_16x16x32_bf16 a[76:79], a[164:167], v[56:59], a[76:79]
  s_waitcnt lgkmcnt(3)
  v_exp_f32 v103, v103
  v_mfma_f32_16x16x32_bf16 a[76:79], a[160:163], v[24:27], a[76:79]
  ds_read_b64_tr_b16 a[182:183], v222 offset:45056
  v_cvt_pk_bf16_f32 v99, v102, v103
  v_mfma_f32_16x16x32_bf16 a[80:83], a[168:171], v[0:3], a[80:83]
  v_exp_f32 v108, v108
  v_mfma_f32_16x16x32_bf16 a[80:83], a[172:175], v[32:35], a[80:83]
  ds_read_b64_tr_b16 a[184:185], v223 offset:32768
  v_mfma_f32_16x16x32_bf16 a[84:87], a[172:175], v[40:43], a[84:87]
  v_exp_f32 v109, v109
  v_mfma_f32_16x16x32_bf16 a[84:87], a[168:171], v[8:11], a[84:87]
  ds_read_b64_tr_b16 a[186:187], v223 offset:36864
  v_cvt_pk_bf16_f32 v106, v108, v109
  v_mfma_f32_16x16x32_bf16 a[88:91], a[168:171], v[16:19], a[88:91]
  v_exp_f32 v110, v110
  v_mfma_f32_16x16x32_bf16 a[88:91], a[172:175], v[48:51], a[88:91]
  ds_read_b64_tr_b16 a[188:189], v223 offset:40960
  v_mfma_f32_16x16x32_bf16 a[92:95], a[172:175], v[56:59], a[92:95]
  s_waitcnt lgkmcnt(3)
  v_exp_f32 v111, v111
  v_mfma_f32_16x16x32_bf16 a[92:95], a[168:171], v[24:27], a[92:95]
  ds_read_b64_tr_b16 a[190:191], v223 offset:45056
  v_cvt_pk_bf16_f32 v107, v110, v111
  v_mfma_f32_16x16x32_bf16 a[96:99], a[176:179], v[0:3], a[96:99]
  s_waitcnt vmcnt(8)
  v_exp_f32 v116, v116
  v_mfma_f32_16x16x32_bf16 a[96:99], a[180:183], v[32:35], a[96:99]
  v_mfma_f32_16x16x32_bf16 a[100:103], a[180:183], v[40:43], a[100:103]
  s_barrier
  v_exp_f32 v117, v117
  v_mfma_f32_16x16x32_bf16 a[100:103], a[176:179], v[8:11], a[100:103]
  ds_read_b128 a[128:131], v212 offset:0
  v_cvt_pk_bf16_f32 v114, v116, v117
  v_mfma_f32_16x16x32_bf16 a[104:107], a[176:179], v[16:19], a[104:107]
  v_exp_f32 v118, v118
  v_mfma_f32_16x16x32_bf16 a[104:107], a[180:183], v[48:51], a[104:107]
  ds_read_b128 a[132:135], v213 offset:0
  ds_read_b32 v228, v225 offset:0
  v_mfma_f32_16x16x32_bf16 a[108:111], a[180:183], v[56:59], a[108:111]
  s_waitcnt lgkmcnt(3)
  v_exp_f32 v119, v119
  v_mfma_f32_16x16x32_bf16 a[108:111], a[176:179], v[24:27], a[108:111]
  ds_read_b128 a[136:139], v214 offset:0
  v_cvt_pk_bf16_f32 v115, v118, v119
  v_mfma_f32_16x16x32_bf16 a[112:115], a[184:187], v[0:3], a[112:115]
  v_exp_f32 v124, v124
  v_mfma_f32_16x16x32_bf16 a[112:115], a[188:191], v[32:35], a[112:115]
  ds_read_b128 a[140:143], v215 offset:0
  ds_read_b32 v229, v225 offset:1024
  v_mfma_f32_16x16x32_bf16 a[116:119], a[188:191], v[40:43], a[116:119]
  v_exp_f32 v125, v125
  v_mfma_f32_16x16x32_bf16 a[116:119], a[184:187], v[8:11], a[116:119]
  ds_read_b32 v230, v225 offset:2048
  v_cvt_pk_bf16_f32 v122, v124, v125
  v_mfma_f32_16x16x32_bf16 a[120:123], a[184:187], v[16:19], a[120:123]
  v_exp_f32 v126, v126
  v_mfma_f32_16x16x32_bf16 a[120:123], a[188:191], v[48:51], a[120:123]
  ds_read_b32 v231, v225 offset:3072
  ds_read_b32 v238, v225 offset:512
  v_mfma_f32_16x16x32_bf16 a[124:127], a[188:191], v[56:59], a[124:127]
  s_waitcnt lgkmcnt(4)
  v_exp_f32 v127, v127
  v_mfma_f32_16x16x32_bf16 a[124:127], a[184:187], v[24:27], a[124:127]
  ds_read_b32 v239, v225 offset:1536
  v_cvt_pk_bf16_f32 v123, v126, v127
  ds_read_b32 v240, v225 offset:2560
  ds_read_b32 v241, v225 offset:3584
  s_cmp_eq_u32 s3, 0
  s_cselect_b32 s35, 0, 1073741824
  v_mul_u32_u24 v226, 0xd80, v226
  v_and_b32 v227, 7, v224
  v_lshl_add_u32 v226, v227, 1, v226
  v_and_b32 v227, 1, v224
  v_lshl_add_u32 v226, v227, 30, v226
  v_or_b32 v226, s35, v226
  v_min_u32 v249, 1, v224
  v_lshlrev_b32 v249, 30, v249
  v_or_b32 v249, s35, v249
  v_mov_b32 v250, 1
  s_lshl_b32 s35, s33, 4
  s_add_u32 s35, s35, 2633728
  s_waitcnt lgkmcnt(0)
  v_add_f32 v228, v228, v229
  v_add_f32 v238, v238, v239
  v_add_f32 v230, v230, v231
  v_add_f32 v240, v240, v241
  v_add_f32 v228, v228, v230
  v_add_f32 v238, v238, v240
  v_cvt_pk_bf16_f32 v228, v228, v228
  v_cvt_pk_bf16_f32 v238, v238, v238
  v_lshlrev_b32 v228, 16, v228
  v_lshlrev_b32 v238, 16, v238
  v_mul_f32 v229, 0xbfb8aa3b, v228
  v_exp_f32 v229, v229
  s_nop 0
  v_add_f32 v229, 1.0, v229
  v_rcp_f32 v229, v229
  s_nop 0
  v_mul_f32 v228, v228, v229
  v_cvt_pk_bf16_f32 v228, v228, v228
  v_lshlrev_b32 v228, 16, v228
  v_mul_f32 v228, v228, v238
  s_nop 1
  v_mov_b32_dpp v229, v228 quad_perm:[1,0,3,2] row_mask:0xf bank_mask:0xf
  v_cvt_pk_bf16_f32 v228, v228, v229
  buffer_store_dword v228, v226, s[24:27], s35 offen sc1
  s_mov_b32 s44, s96
  s_mov_b32 s45, s97
  s_mov_b32 s46, 256
  s_mov_b32 s47, 0x20000
  s_mov_b32 s32, 6
attn_loop:
  v_mfma_f32_16x16x32_bf16 v[0:3], a[128:131], v[128:131], v[192:195]
  s_add_u32 m0, s50, 4096
  v_mfma_f32_16x16x32_bf16 v[0:3], a[132:135], v[132:135], v[0:3]
  ds_read_b128 a[144:147], v212 offset:4096
  buffer_load_dwordx4 v208, s[20:23], s30 offen lds
  v_mfma_f32_16x16x32_bf16 v[0:3], a[136:139], v[136:139], v[0:3]
  v_mfma_f32_16x16x32_bf16 v[0:3], a[140:143], v[140:143], v[0:3]
  ds_read_b128 a[148:151], v213 offset:4096
  v_mfma_f32_16x16x32_bf16 v[8:11], a[140:143], v[156:159], v[196:199]
  v_mfma_f32_16x16x32_bf16 v[8:11], a[136:139], v[152:155], v[8:11]
  ds_read_b128 a[152:155], v214 offset:4096
  v_mfma_f32_16x16x32_bf16 v[8:11], a[132:135], v[148:151], v[8:11]
  v_mfma_f32_16x16x32_bf16 v[8:11], a[128:131], v[144:147], v[8:11]
  ds_read_b128 a[156:159], v215 offset:4096
  v_mfma_f32_16x16x32_bf16 v[16:19], a[128:131], v[160:163], v[200:203]
  s_add_u32 m0, s28, 81920
  v_exp_f32 v0, v0
  v_mfma_f32_16x16x32_bf16 v[16:19], a[132:135], v[164:167], v[16:19]
  buffer_load_dwordx4 v236, s[16:19], s29 offen offset:0 lds
  v_mfma_f32_16x16x32_bf16 v[16:19], a[136:139], v[168:171], v[16:19]
  v_exp_f32 v1, v1
  v_mfma_f32_16x16x32_bf16 v[16:19], a[140:143], v[172:175], v[16:19]
  v_cvt_pk_bf16_f32 v0, v0, v1
  v_mfma_f32_16x16x32_bf16 v[24:27], a[140:143], v[188:191], v[204:207]
  v_exp_f32 v2, v2
  v_mfma_f32_16x16x32_bf16 v[24:27], a[136:139], v[184:187], v[24:27]
  buffer_load_dwordx4 v237, s[16:19], s29 offen offset:1024 lds
  v_mfma_f32_16x16x32_bf16 v[24:27], a[132:135], v[180:183], v[24:27]
  s_waitcnt lgkmcnt(0)
  v_exp_f32 v3, v3
  v_mfma_f32_16x16x32_bf16 v[24:27], a[128:131], v[176:179], v[24:27]
  v_cvt_pk_bf16_f32 v1, v2, v3
  v_mfma_f32_16x16x32_bf16 v[4:7], a[144:147], v[128:131], v[192:195]
  v_exp_f32 v8, v8
  v_mfma_f32_16x16x32_bf16 v[4:7], a[148:151], v[132:135], v[4:7]
  ds_read_b128 a[128:131], v212 offset:8192
  v_mfma_f32_16x16x32_bf16 v[4:7], a[152:155], v[136:139], v[4:7]
  v_exp_f32 v9, v9
  v_mfma_f32_16x16x32_bf16 v[4:7], a[156:159], v[140:143], v[4:7]
  ds_read_b128 a[132:135], v213 offset:8192
  v_cvt_pk_bf16_f32 v8, v8, v9
  v_mfma_f32_16x16x32_bf16 v[12:15], a[156:159], v[156:159], v[196:199]
  v_exp_f32 v10, v10
  v_mfma_f32_16x16x32_bf16 v[12:15], a[152:155], v[152:155], v[12:15]
  ds_read_b128 a[136:139], v214 offset:8192
  v_mfma_f32_16x16x32_bf16 v[12:15], a[148:151], v[148:151], v[12:15]
  v_exp_f32 v11, v11
  v_mfma_f32_16x16x32_bf16 v[12:15], a[144:147], v[144:147], v[12:15]
  ds_read_b128 a[140:143], v215 offset:8192
  v_cvt_pk_bf16_f32 v9, v10, v11
  v_mfma_f32_16x16x32_bf16 v[20:23], a[144:147], v[160:163], v[200:203]
  v_exp_f32 v16, v16
  v_mfma_f32_16x16x32_bf16 v[20:23], a[148:151], v[164:167], v[20:23]
  buffer_load_dwordx4 v236, s[16:19], s29 offen offset:2048 lds
  v_mfma_f32_16x16x32_bf16 v[20:23], a[152:155], v[168:171], v[20:23]
  v_exp_f32 v17, v17
  v_mfma_f32_16x16x32_bf16 v[20:23], a[156:159], v[172:175], v[20:23]
  v_cvt_pk_bf16_f32 v16, v16, v17
  v_mfma_f32_16x16x32_bf16 v[28:31], a[156:159], v[188:191], v[204:207]
  v_exp_f32 v18, v18
  v_mfma_f32_16x16x32_bf16 v[28:31], a[152:155], v[184:187], v[28:31]
  buffer_load_dwordx4 v237, s[16:19], s29 offen offset:3072 lds
  v_mfma_f32_16x16x32_bf16 v[28:31], a[148:151], v[180:183], v[28:31]
  s_waitcnt lgkmcnt(0)
  s_add_u32 s29, s29, 16384
  v_exp_f32 v19, v19
  v_mfma_f32_16x16x32_bf16 v[28:31], a[144:147], v[176:179], v[28:31]
  v_cvt_pk_bf16_f32 v17, v18, v19
  v_mfma_f32_16x16x32_bf16 v[32:35], a[128:131], v[128:131], v[192:195]
  s_add_u32 m0, s28, 32768
  v_exp_f32 v24, v24
  v_mfma_f32_16x16x32_bf16 v[32:35], a[132:135], v[132:135], v[32:35]
  ds_read_b128 a[144:147], v212 offset:12288
  v_mfma_f32_16x16x32_bf16 v[32:35], a[136:139], v[136:139], v[32:35]
  v_exp_f32 v25, v25
  v_mfma_f32_16x16x32_bf16 v[32:35], a[140:143], v[140:143], v[32:35]
  ds_read_b128 a[148:151], v213 offset:12288
  v_cvt_pk_bf16_f32 v24, v24, v25
  v_mfma_f32_16x16x32_bf16 v[40:43], a[140:143], v[156:159], v[196:199]
  v_exp_f32 v26, v26
  v_mfma_f32_16x16x32_bf16 v[40:43], a[136:139], v[152:155], v[40:43]
  ds_read_b128 a[152:155], v214 offset:12288
  v_mfma_f32_16x16x32_bf16 v[40:43], a[132:135], v[148:151], v[40:43]
  v_exp_f32 v27, v27
  v_mfma_f32_16x16x32_bf16 v[40:43], a[128:131], v[144:147], v[40:43]
  ds_read_b128 a[156:159], v215 offset:12288
  v_cvt_pk_bf16_f32 v25, v26, v27
  v_mfma_f32_16x16x32_bf16 v[48:51], a[128:131], v[160:163], v[200:203]
  v_exp_f32 v4, v4
  v_mfma_f32_16x16x32_bf16 v[48:51], a[132:135], v[164:167], v[48:51]
  buffer_load_dwordx4 v232, s[12:15], s29 offen offset:0 lds
  v_mfma_f32_16x16x32_bf16 v[48:51], a[136:139], v[168:171], v[48:51]
  v_exp_f32 v5, v5
  v_mfma_f32_16x16x32_bf16 v[48:51], a[140:143], v[172:175], v[48:51]
  v_cvt_pk_bf16_f32 v2, v4, v5
  v_mfma_f32_16x16x32_bf16 v[56:59], a[140:143], v[188:191], v[204:207]
  v_exp_f32 v6, v6
  v_mfma_f32_16x16x32_bf16 v[56:59], a[136:139], v[184:187], v[56:59]
  buffer_load_dwordx4 v233, s[12:15], s29 offen offset:1024 lds
  v_mfma_f32_16x16x32_bf16 v[56:59], a[132:135], v[180:183], v[56:59]
  s_waitcnt lgkmcnt(0)
  v_exp_f32 v7, v7
  v_mfma_f32_16x16x32_bf16 v[56:59], a[128:131], v[176:179], v[56:59]
  v_cvt_pk_bf16_f32 v3, v6, v7
  v_mfma_f32_16x16x32_bf16 v[36:39], a[144:147], v[128:131], v[192:195]
  v_exp_f32 v12, v12
  v_mfma_f32_16x16x32_bf16 v[36:39], a[148:151], v[132:135], v[36:39]
  buffer_load_dwordx4 v234, s[12:15], s29 offen offset:2048 lds
  v_mfma_f32_16x16x32_bf16 v[36:39], a[152:155], v[136:139], v[36:39]
  v_exp_f32 v13, v13
  v_mfma_f32_16x16x32_bf16 v[36:39], a[156:159], v[140:143], v[36:39]
  v_cvt_pk_bf16_f32 v10, v12, v13
  v_mfma_f32_16x16x32_bf16 v[44:47], a[156:159], v[156:159], v[196:199]
  v_exp_f32 v14, v14
  v_mfma_f32_16x16x32_bf16 v[44:47], a[152:155], v[152:155], v[44:47]
  buffer_load_dwordx4 v235, s[12:15], s29 offen offset:3072 lds
  v_mfma_f32_16x16x32_bf16 v[44:47], a[148:151], v[148:151], v[44:47]
  v_exp_f32 v15, v15
  v_mfma_f32_16x16x32_bf16 v[44:47], a[144:147], v[144:147], v[44:47]
  v_cvt_pk_bf16_f32 v11, v14, v15
  v_mfma_f32_16x16x32_bf16 v[52:55], a[144:147], v[160:163], v[200:203]
  v_exp_f32 v20, v20
  v_mfma_f32_16x16x32_bf16 v[52:55], a[148:151], v[164:167], v[52:55]
  ds_read_b64_tr_b16 a[160:161], v216 offset:49152
  v_mfma_f32_16x16x32_bf16 v[52:55], a[152:155], v[168:171], v[52:55]
  v_exp_f32 v21, v21
  v_mfma_f32_16x16x32_bf16 v[52:55], a[156:159], v[172:175], v[52:55]
  ds_read_b64_tr_b16 a[162:163], v216 offset:53248
  v_cvt_pk_bf16_f32 v18, v20, v21
  v_mfma_f32_16x16x32_bf16 v[60:63], a[156:159], v[188:191], v[204:207]
  v_exp_f32 v22, v22
  v_mfma_f32_16x16x32_bf16 v[60:63], a[152:155], v[184:187], v[60:63]
  ds_read_b64_tr_b16 a[164:165], v216 offset:57344
  v_mfma_f32_16x16x32_bf16 v[60:63], a[148:151], v[180:183], v[60:63]
  v_exp_f32 v23, v23
  v_mfma_f32_16x16x32_bf16 v[60:63], a[144:147], v[176:179], v[60:63]
  ds_read_b64_tr_b16 a[166:167], v216 offset:61440
  v_cvt_pk_bf16_f32 v19, v22, v23
  v_mfma_f32_16x16x32_bf16 a[192:195], a[208:211], v[64:67], a[192:195]
  v_exp_f32 v28, v28
  v_mfma_f32_16x16x32_bf16 a[192:195], a[208:211], v[96:99], a[192:195]
  ds_read_b64_tr_b16 a[168:169], v217 offset:49152
  v_mfma_f32_16x16x32_bf16 a[196:199], a[208:211], v[72:75], a[196:199]
  v_exp_f32 v29, v29
  v_mfma_f32_16x16x32_bf16 a[196:199], a[208:211], v[104:107], a[196:199]
  ds_read_b64_tr_b16 a[170:171], v217 offset:53248
  v_cvt_pk_bf16_f32 v26, v28, v29
  v_mfma_f32_16x16x32_bf16 a[200:203], a[208:211], v[80:83], a[200:203]
  v_exp_f32 v30, v30
  v_mfma_f32_16x16x32_bf16 a[200:203], a[208:211], v[112:115], a[200:203]
  ds_read_b64_tr_b16 a[172:173], v217 offset:57344
  v_mfma_f32_16x16x32_bf16 a[204:207], a[208:211], v[88:91], a[204:207]
  s_waitcnt lgkmcnt(3)
  v_exp_f32 v31, v31
  v_mfma_f32_16x16x32_bf16 a[204:207], a[208:211], v[120:123], a[204:207]
  ds_read_b64_tr_b16 a[174:175], v217 offset:61440
  v_cvt_pk_bf16_f32 v27, v30, v31
  v_mfma_f32_16x16x32_bf16 a[0:3], a[160:163], v[64:67], a[0:3]
  v_exp_f32 v32, v32
  v_mfma_f32_16x16x32_bf16 a[0:3], a[164:167], v[96:99], a[0:3]
  ds_read_b64_tr_b16 a[176:177], v218 offset:49152
  v_mfma_f32_16x16x32_bf16 a[4:7], a[164:167], v[104:107], a[4:7]
  v_exp_f32 v33, v33
  v_mfma_f32_16x16x32_bf16 a[4:7], a[160:163], v[72:75], a[4:7]
  ds_read_b64_tr_b16 a[178:179], v218 offset:53248
  v_cvt_pk_bf16_f32 v32, v32, v33
  v_mfma_f32_16x16x32_bf16 a[8:11], a[160:163], v[80:83], a[8:11]
  v_exp_f32 v34, v34
  v_mfma_f32_16x16x32_bf16 a[8:11], a[164:167], v[112:115], a[8:11]
  ds_read_b64_tr_b16 a[180:181], v218 offset:57344
  v_mfma_f32_16x16x32_bf16 a[12:15], a[164:167], v[120:123], a[12:15]
  s_waitcnt lgkmcnt(3)
  v_exp_f32 v35, v35
  v_mfma_f32_16x16x32_bf16 a[12:15], a[160:163], v[88:91], a[12:15]
  ds_read_b64_tr_b16 a[182:183], v218 offset:61440
  v_cvt_pk_bf16_f32 v33, v34, v35
  v_mfma_f32_16x16x32_bf16 a[16:19], a[168:171], v[64:67], a[16:19]
  v_exp_f32 v40, v40
  v_mfma_f32_16x16x32_bf16 a[16:19], a[172:175], v[96:99], a[16:19]
  ds_read_b64_tr_b16 a[184:185], v219 offset:49152
  v_mfma_f32_16x16x32_bf16 a[20:23], a[172:175], v[104:107], a[20:23]
  v_exp_f32 v41, v41
  v_mfma_f32_16x16x32_bf16 a[20:23], a[168:171], v[72:75], a[20:23]
  ds_read_b64_tr_b16 a[186:187], v219 offset:53248
  v_cvt_pk_bf16_f32 v40, v40, v41
  v_mfma_f32_16x16x32_bf16 a[24:27], a[168:171], v[80:83], a[24:27]
  v_exp_f32 v42, v42
  v_mfma_f32_16x16x32_bf16 a[24:27], a[172:175], v[112:115], a[24:27]
  ds_read_b64_tr_b16 a[188:189], v219 offset:57344
  v_mfma_f32_16x16x32_bf16 a[28:31], a[172:175], v[120:123], a[28:31]
  s_waitcnt lgkmcnt(3)
  v_exp_f32 v43, v43
  v_mfma_f32_16x16x32_bf16 a[28:31], a[168:171], v[88:91], a[28:31]
  ds_read_b64_tr_b16 a[190:191], v219 offset:61440
  v_cvt_pk_bf16_f32 v41, v42, v43
  v_mfma_f32_16x16x32_bf16 a[32:35], a[176:179], v[64:67], a[32:35]
  v_exp_f32 v48, v48
  v_mfma_f32_16x16x32_bf16 a[32:35], a[180:183], v[96:99], a[32:35]
  ds_read_b64_tr_b16 a[160:161], v220 offset:49152
  v_mfma_f32_16x16x32_bf16 a[36:39], a[180:183], v[104:107], a[36:39]
  v_exp_f32 v49, v49
  v_mfma_f32_16x16x32_bf16 a[36:39], a[176:179], v[72:75], a[36:39]
  ds_read_b64_tr_b16 a[162:163], v220 offset:53248
  v_cvt_pk_bf16_f32 v48, v48, v49
  v_mfma_f32_16x16x32_bf16 a[40:43], a[176:179], v[80:83], a[40:43]
  v_exp_f32 v50, v50
  v_mfma_f32_16x16x32_bf16 a[40:43], a[180:183], v[112:115], a[40:43]
  ds_read_b64_tr_b16 a[164:165], v220 offset:57344
  v_mfma_f32_16x16x32_bf16 a[44:47], a[180:183], v[120:123], a[44:47]
  s_waitcnt lgkmcnt(3)
  v_exp_f32 v51, v51
  v_mfma_f32_16x16x32_bf16 a[44:47], a[176:179], v[88:91], a[44:47]
  ds_read_b64_tr_b16 a[166:167], v220 offset:61440
  v_cvt_pk_bf16_f32 v49, v50, v51
  v_mfma_f32_16x16x32_bf16 a[48:51], a[184:187], v[64:67], a[48:51]
  v_exp_f32 v56, v56
  v_mfma_f32_16x16x32_bf16 a[48:51], a[188:191], v[96:99], a[48:51]
  ds_read_b64_tr_b16 a[168:169], v221 offset:49152
  v_mfma_f32_16x16x32_bf16 a[52:55], a[188:191], v[104:107], a[52:55]
  v_exp_f32 v57, v57
  v_mfma_f32_16x16x32_bf16 a[52:55], a[184:187], v[72:75], a[52:55]
  ds_read_b64_tr_b16 a[170:171], v221 offset:53248
  v_cvt_pk_bf16_f32 v56, v56, v57
  v_mfma_f32_16x16x32_bf16 a[56:59], a[184:187], v[80:83], a[56:59]
  v_exp_f32 v58, v58
  v_mfma_f32_16x16x32_bf16 a[56:59], a[188:191], v[112:115], a[56:59]
  ds_read_b64_tr_b16 a[172:173], v221 offset:57344
  v_mfma_f32_16x16x32_bf16 a[60:63], a[188:191], v[120:123], a[60:63]
  s_waitcnt lgkmcnt(3)
  v_exp_f32 v59, v59
  v_mfma_f32_16x16x32_bf16 a[60:63], a[184:187], v[88:91], a[60:63]
  ds_read_b64_tr_b16 a[174:175], v221 offset:61440
  v_cvt_pk_bf16_f32 v57, v58, v59
  v_mfma_f32_16x16x32_bf16 a[64:67], a[160:163], v[64:67], a[64:67]
  v_exp_f32 v36, v36
  v_mfma_f32_16x16x32_bf16 a[64:67], a[164:167], v[96:99], a[64:67]
  ds_read_b64_tr_b16 a[176:177], v222 offset:49152
  v_mfma_f32_16x16x32_bf16 a[68:71], a[164:167], v[104:107], a[68:71]
  v_exp_f32 v37, v37
  v_mfma_f32_16x16x32_bf16 a[68:71], a[160:163], v[72:75], a[68:71]
  ds_read_b64_tr_b16 a[178:179], v222 offset:53248
  v_cvt_pk_bf16_f32 v34, v36, v37
  v_mfma_f32_16x16x32_bf16 a[72:75], a[160:163], v[80:83], a[72:75]
  v_exp_f32 v38, v38
  v_mfma_f32_16x16x32_bf16 a[72:75], a[164:167], v[112:115], a[72:75]
  ds_read_b64_tr_b16 a[180:181], v222 offset:57344
  v_mfma_f32_16x16x32_bf16 a[76:79], a[164:167], v[120:123], a[76:79]
  s_waitcnt lgkmcnt(3)
  v_exp_f32 v39, v39
  v_mfma_f32_16x16x32_bf16 a[76:79], a[160:163], v[88:91], a[76:79]
  ds_read_b64_tr_b16 a[182:183], v222 offset:61440
  v_cvt_pk_bf16_f32 v35, v38, v39
  v_mfma_f32_16x16x32_bf16 a[80:83], a[168:171], v[64:67], a[80:83]
  v_exp_f32 v44, v44
  v_mfma_f32_16x16x32_bf16 a[80:83], a[172:175], v[96:99], a[80:83]
  ds_read_b64_tr_b16 a[184:185], v223 offset:49152
  v_mfma_f32_16x16x32_bf16 a[84:87], a[172:175], v[104:107], a[84:87]
  v_exp_f32 v45, v45
  v_mfma_f32_16x16x32_bf16 a[84:87], a[168:171], v[72:75], a[84:87]
  ds_read_b64_tr_b16 a[186:187], v223 offset:53248
  v_cvt_pk_bf16_f32 v42, v44, v45
  v_mfma_f32_16x16x32_bf16 a[88:91], a[168:171], v[80:83], a[88:91]
  v_exp_f32 v46, v46
  v_mfma_f32_16x16x32_bf16 a[88:91], a[172:175], v[112:115], a[88:91]
  ds_read_b64_tr_b16 a[188:189], v223 offset:57344
  v_mfma_f32_16x16x32_bf16 a[92:95], a[172:175], v[120:123], a[92:95]
  s_waitcnt lgkmcnt(3)
  v_exp_f32 v47, v47
  v_mfma_f32_16x16x32_bf16 a[92:95], a[168:171], v[88:91], a[92:95]
  ds_read_b64_tr_b16 a[190:191], v223 offset:61440
  v_cvt_pk_bf16_f32 v43, v46, v47
  v_mfma_f32_16x16x32_bf16 a[96:99], a[176:179], v[64:67], a[96:99]
  s_waitcnt vmcnt(9)
  v_exp_f32 v52, v52
  v_mfma_f32_16x16x32_bf16 a[96:99], a[180:183], v[96:99], a[96:99]
  v_mfma_f32_16x16x32_bf16 a[100:103], a[180:183], v[104:107], a[100:103]
  s_barrier
  v_exp_f32 v53, v53
  v_mfma_f32_16x16x32_bf16 a[100:103], a[176:179], v[72:75], a[100:103]
  ds_read_b128 a[128:131], v212 offset:16384
  v_cvt_pk_bf16_f32 v50, v52, v53
  v_mfma_f32_16x16x32_bf16 a[104:107], a[176:179], v[80:83], a[104:107]
  v_exp_f32 v54, v54
  v_mfma_f32_16x16x32_bf16 a[104:107], a[180:183], v[112:115], a[104:107]
  ds_read_b128 a[132:135], v213 offset:16384
  v_mfma_f32_16x16x32_bf16 a[108:111], a[180:183], v[120:123], a[108:111]
  s_waitcnt lgkmcnt(2)
  v_exp_f32 v55, v55
  v_mfma_f32_16x16x32_bf16 a[108:111], a[176:179], v[88:91], a[108:111]
  ds_read_b128 a[136:139], v214 offset:16384
  v_cvt_pk_bf16_f32 v51, v54, v55
  v_mfma_f32_16x16x32_bf16 a[112:115], a[184:187], v[64:67], a[112:115]
  v_exp_f32 v60, v60
  v_mfma_f32_16x16x32_bf16 a[112:115], a[188:191], v[96:99], a[112:115]
  ds_read_b128 a[140:143], v215 offset:16384
  v_mfma_f32_16x16x32_bf16 a[116:119], a[188:191], v[104:107], a[116:119]
  v_exp_f32 v61, v61
  v_mfma_f32_16x16x32_bf16 a[116:119], a[184:187], v[72:75], a[116:119]
  v_cvt_pk_bf16_f32 v58, v60, v61
  v_mfma_f32_16x16x32_bf16 a[120:123], a[184:187], v[80:83], a[120:123]
  v_exp_f32 v62, v62
  v_mfma_f32_16x16x32_bf16 a[120:123], a[188:191], v[112:115], a[120:123]
  v_mfma_f32_16x16x32_bf16 a[124:127], a[188:191], v[120:123], a[124:127]
  s_waitcnt lgkmcnt(0)
  v_exp_f32 v63, v63
  v_mfma_f32_16x16x32_bf16 a[124:127], a[184:187], v[88:91], a[124:127]
  v_cvt_pk_bf16_f32 v59, v62, v63
  v_mfma_f32_16x16x32_bf16 v[64:67], a[128:131], v[128:131], v[192:195]
  s_mov_b32 m0, s51
  v_mfma_f32_16x16x32_bf16 v[64:67], a[132:135], v[132:135], v[64:67]
  ds_read_b128 a[144:147], v212 offset:20480
  buffer_load_dwordx4 v210, s[4:7], s100 offen lds
  s_add_u32 s100, s100, 20480
  s_add_u32 s51, s51, 512
  v_mfma_f32_16x16x32_bf16 v[64:67], a[136:139], v[136:139], v[64:67]
  buffer_atomic_add v250, v249, s[44:47], 0 offen
  v_mfma_f32_16x16x32_bf16 v[64:67], a[140:143], v[140:143], v[64:67]
  ds_read_b128 a[148:151], v213 offset:20480
  v_mov_b32 v249, 1073741824
  v_mfma_f32_16x16x32_bf16 v[72:75], a[140:143], v[156:159], v[196:199]
  v_mfma_f32_16x16x32_bf16 v[72:75], a[136:139], v[152:155], v[72:75]
  ds_read_b128 a[152:155], v214 offset:20480
  v_mfma_f32_16x16x32_bf16 v[72:75], a[132:135], v[148:151], v[72:75]
  v_mfma_f32_16x16x32_bf16 v[72:75], a[128:131], v[144:147], v[72:75]
  ds_read_b128 a[156:159], v215 offset:20480
  v_mfma_f32_16x16x32_bf16 v[80:83], a[128:131], v[160:163], v[200:203]
  s_add_u32 m0, s28, 98304
  v_exp_f32 v64, v64
  v_mfma_f32_16x16x32_bf16 v[80:83], a[132:135], v[164:167], v[80:83]
  buffer_load_dwordx4 v236, s[16:19], s29 offen offset:0 lds
  v_mfma_f32_16x16x32_bf16 v[80:83], a[136:139], v[168:171], v[80:83]
  v_exp_f32 v65, v65
  v_mfma_f32_16x16x32_bf16 v[80:83], a[140:143], v[172:175], v[80:83]
  v_cvt_pk_bf16_f32 v64, v64, v65
  v_mfma_f32_16x16x32_bf16 v[88:91], a[140:143], v[188:191], v[204:207]
  v_exp_f32 v66, v66
  v_mfma_f32_16x16x32_bf16 v[88:91], a[136:139], v[184:187], v[88:91]
  buffer_load_dwordx4 v237, s[16:19], s29 offen offset:1024 lds
  v_mfma_f32_16x16x32_bf16 v[88:91], a[132:135], v[180:183], v[88:91]
  s_waitcnt lgkmcnt(0)
  v_exp_f32 v67, v67
  v_mfma_f32_16x16x32_bf16 v[88:91], a[128:131], v[176:179], v[88:91]
  v_cvt_pk_bf16_f32 v65, v66, v67
  v_mfma_f32_16x16x32_bf16 v[68:71], a[144:147], v[128:131], v[192:195]
  v_exp_f32 v72, v72
  v_mfma_f32_16x16x32_bf16 v[68:71], a[148:151], v[132:135], v[68:71]
  ds_read_b128 a[128:131], v212 offset:24576
  v_mfma_f32_16x16x32_bf16 v[68:71], a[152:155], v[136:139], v[68:71]
  v_exp_f32 v73, v73
  v_mfma_f32_16x16x32_bf16 v[68:71], a[156:159], v[140:143], v[68:71]
  ds_read_b128 a[132:135], v213 offset:24576
  v_cvt_pk_bf16_f32 v72, v72, v73
  v_mfma_f32_16x16x32_bf16 v[76:79], a[156:159], v[156:159], v[196:199]
  v_exp_f32 v74, v74
  v_mfma_f32_16x16x32_bf16 v[76:79], a[152:155], v[152:155], v[76:79]
  ds_read_b128 a[136:139], v214 offset:24576
  v_mfma_f32_16x16x32_bf16 v[76:79], a[148:151], v[148:151], v[76:79]
  v_exp_f32 v75, v75
  v_mfma_f32_16x16x32_bf16 v[76:79], a[144:147], v[144:147], v[76:79]
  ds_read_b128 a[140:143], v215 offset:24576
  v_cvt_pk_bf16_f32 v73, v74, v75
  v_mfma_f32_16x16x32_bf16 v[84:87], a[144:147], v[160:163], v[200:203]
  v_exp_f32 v80, v80
  v_mfma_f32_16x16x32_bf16 v[84:87], a[148:151], v[164:167], v[84:87]
  buffer_load_dwordx4 v236, s[16:19], s29 offen offset:2048 lds
  v_mfma_f32_16x16x32_bf16 v[84:87], a[152:155], v[168:171], v[84:87]
  v_exp_f32 v81, v81
  v_mfma_f32_16x16x32_bf16 v[84:87], a[156:159], v[172:175], v[84:87]
  v_cvt_pk_bf16_f32 v80, v80, v81
  v_mfma_f32_16x16x32_bf16 v[92:95], a[156:159], v[188:191], v[204:207]
  v_exp_f32 v82, v82
  v_mfma_f32_16x16x32_bf16 v[92:95], a[152:155], v[184:187], v[92:95]
  buffer_load_dwordx4 v237, s[16:19], s29 offen offset:3072 lds
  v_mfma_f32_16x16x32_bf16 v[92:95], a[148:151], v[180:183], v[92:95]
  s_waitcnt lgkmcnt(0)
  s_add_u32 s29, s29, 16384
  v_exp_f32 v83, v83
  v_mfma_f32_16x16x32_bf16 v[92:95], a[144:147], v[176:179], v[92:95]
  v_cvt_pk_bf16_f32 v81, v82, v83
  v_mfma_f32_16x16x32_bf16 v[96:99], a[128:131], v[128:131], v[192:195]
  s_add_u32 m0, s28, 49152
  v_exp_f32 v88, v88
  v_mfma_f32_16x16x32_bf16 v[96:99], a[132:135], v[132:135], v[96:99]
  ds_read_b128 a[144:147], v212 offset:28672
  v_mfma_f32_16x16x32_bf16 v[96:99], a[136:139], v[136:139], v[96:99]
  v_exp_f32 v89, v89
  v_mfma_f32_16x16x32_bf16 v[96:99], a[140:143], v[140:143], v[96:99]
  ds_read_b128 a[148:151], v213 offset:28672
  v_cvt_pk_bf16_f32 v88, v88, v89
  v_mfma_f32_16x16x32_bf16 v[104:107], a[140:143], v[156:159], v[196:199]
  v_exp_f32 v90, v90
  v_mfma_f32_16x16x32_bf16 v[104:107], a[136:139], v[152:155], v[104:107]
  ds_read_b128 a[152:155], v214 offset:28672
  v_mfma_f32_16x16x32_bf16 v[104:107], a[132:135], v[148:151], v[104:107]
  v_exp_f32 v91, v91
  v_mfma_f32_16x16x32_bf16 v[104:107], a[128:131], v[144:147], v[104:107]
  ds_read_b128 a[156:159], v215 offset:28672
  v_cvt_pk_bf16_f32 v89, v90, v91
  v_mfma_f32_16x16x32_bf16 v[112:115], a[128:131], v[160:163], v[200:203]
  v_exp_f32 v68, v68
  v_mfma_f32_16x16x32_bf16 v[112:115], a[132:135], v[164:167], v[112:115]
  buffer_load_dwordx4 v232, s[12:15], s29 offen offset:0 lds
  v_mfma_f32_16x16x32_bf16 v[112:115], a[136:139], v[168:171], v[112:115]
  v_exp_f32 v69, v69
  v_mfma_f32_16x16x32_bf16 v[112:115], a[140:143], v[172:175], v[112:115]
  v_cvt_pk_bf16_f32 v66, v68, v69
  v_mfma_f32_16x16x32_bf16 v[120:123], a[140:143], v[188:191], v[204:207]
  v_exp_f32 v70, v70
  v_mfma_f32_16x16x32_bf16 v[120:123], a[136:139], v[184:187], v[120:123]
  buffer_load_dwordx4 v233, s[12:15], s29 offen offset:1024 lds
  v_mfma_f32_16x16x32_bf16 v[120:123], a[132:135], v[180:183], v[120:123]
  s_waitcnt lgkmcnt(0)
  v_exp_f32 v71, v71
  v_mfma_f32_16x16x32_bf16 v[120:123], a[128:131], v[176:179], v[120:123]
  v_cvt_pk_bf16_f32 v67, v70, v71
  v_mfma_f32_16x16x32_bf16 v[100:103], a[144:147], v[128:131], v[192:195]
  v_exp_f32 v76, v76
  v_mfma_f32_16x16x32_bf16 v[100:103], a[148:151], v[132:135], v[100:103]
  buffer_load_dwordx4 v234, s[12:15], s29 offen offset:2048 lds
  v_mfma_f32_16x16x32_bf16 v[100:103], a[152:155], v[136:139], v[100:103]
  v_exp_f32 v77, v77
  v_mfma_f32_16x16x32_bf16 v[100:103], a[156:159], v[140:143], v[100:103]
  v_cvt_pk_bf16_f32 v74, v76, v77
  v_mfma_f32_16x16x32_bf16 v[108:111], a[156:159], v[156:159], v[196:199]
  v_exp_f32 v78, v78
  v_mfma_f32_16x16x32_bf16 v[108:111], a[152:155], v[152:155], v[108:111]
  buffer_load_dwordx4 v235, s[12:15], s29 offen offset:3072 lds
  v_mfma_f32_16x16x32_bf16 v[108:111], a[148:151], v[148:151], v[108:111]
  v_exp_f32 v79, v79
  v_mfma_f32_16x16x32_bf16 v[108:111], a[144:147], v[144:147], v[108:111]
  v_cvt_pk_bf16_f32 v75, v78, v79
  v_mfma_f32_16x16x32_bf16 v[116:119], a[144:147], v[160:163], v[200:203]
  v_exp_f32 v84, v84
  v_mfma_f32_16x16x32_bf16 v[116:119], a[148:151], v[164:167], v[116:119]
  ds_read_b64_tr_b16 a[160:161], v216 offset:0
  v_mfma_f32_16x16x32_bf16 v[116:119], a[152:155], v[168:171], v[116:119]
  v_exp_f32 v85, v85
  v_mfma_f32_16x16x32_bf16 v[116:119], a[156:159], v[172:175], v[116:119]
  ds_read_b64_tr_b16 a[162:163], v216 offset:4096
  v_cvt_pk_bf16_f32 v82, v84, v85
  v_mfma_f32_16x16x32_bf16 v[124:127], a[156:159], v[188:191], v[204:207]
  v_exp_f32 v86, v86
  v_mfma_f32_16x16x32_bf16 v[124:127], a[152:155], v[184:187], v[124:127]
  ds_read_b64_tr_b16 a[164:165], v216 offset:8192
  v_mfma_f32_16x16x32_bf16 v[124:127], a[148:151], v[180:183], v[124:127]
  v_exp_f32 v87, v87
  v_mfma_f32_16x16x32_bf16 v[124:127], a[144:147], v[176:179], v[124:127]
  ds_read_b64_tr_b16 a[166:167], v216 offset:12288
  v_cvt_pk_bf16_f32 v83, v86, v87
  v_mfma_f32_16x16x32_bf16 a[192:195], a[208:211], v[0:3], a[192:195]
  v_exp_f32 v92, v92
  v_mfma_f32_16x16x32_bf16 a[192:195], a[208:211], v[32:35], a[192:195]
  ds_read_b64_tr_b16 a[168:169], v217 offset:0
  v_mfma_f32_16x16x32_bf16 a[196:199], a[208:211], v[8:11], a[196:199]
  v_exp_f32 v93, v93
  v_mfma_f32_16x16x32_bf16 a[196:199], a[208:211], v[40:43], a[196:199]
  ds_read_b64_tr_b16 a[170:171], v217 offset:4096
  v_cvt_pk_bf16_f32 v90, v92, v93
  v_mfma_f32_16x16x32_bf16 a[200:203], a[208:211], v[16:19], a[200:203]
  v_exp_f32 v94, v94
  v_mfma_f32_16x16x32_bf16 a[200:203], a[208:211], v[48:51], a[200:203]
  ds_read_b64_tr_b16 a[172:173], v217 offset:8192
  v_mfma_f32_16x16x32_bf16 a[204:207], a[208:211], v[24:27], a[204:207]
  s_waitcnt lgkmcnt(3)
  v_exp_f32 v95, v95
  v_mfma_f32_16x16x32_bf16 a[204:207], a[208:211], v[56:59], a[204:207]
  ds_read_b64_tr_b16 a[174:175], v217 offset:12288
  v_cvt_pk_bf16_f32 v91, v94, v95
  v_mfma_f32_16x16x32_bf16 a[0:3], a[160:163], v[0:3], a[0:3]
  v_exp_f32 v96, v96
  v_mfma_f32_16x16x32_bf16 a[0:3], a[164:167], v[32:35], a[0:3]
  ds_read_b64_tr_b16 a[176:177], v218 offset:0
  v_mfma_f32_16x16x32_bf16 a[4:7], a[164:167], v[40:43], a[4:7]
  v_exp_f32 v97, v97
  v_mfma_f32_16x16x32_bf16 a[4:7], a[160:163], v[8:11], a[4:7]
  ds_read_b64_tr_b16 a[178:179], v218 offset:4096
  v_cvt_pk_bf16_f32 v96, v96, v97
  v_mfma_f32_16x16x32_bf16 a[8:11], a[160:163], v[16:19], a[8:11]
  v_exp_f32 v98, v98
  v_mfma_f32_16x16x32_bf16 a[8:11], a[164:167], v[48:51], a[8:11]
  ds_read_b64_tr_b16 a[180:181], v218 offset:8192
  v_mfma_f32_16x16x32_bf16 a[12:15], a[164:167], v[56:59], a[12:15]
  s_waitcnt lgkmcnt(3)
  v_exp_f32 v99, v99
  v_mfma_f32_16x16x32_bf16 a[12:15], a[160:163], v[24:27], a[12:15]
  ds_read_b64_tr_b16 a[182:183], v218 offset:12288
  v_cvt_pk_bf16_f32 v97, v98, v99
  v_mfma_f32_16x16x32_bf16 a[16:19], a[168:171], v[0:3], a[16:19]
  v_exp_f32 v104, v104
  v_mfma_f32_16x16x32_bf16 a[16:19], a[172:175], v[32:35], a[16:19]
  ds_read_b64_tr_b16 a[184:185], v219 offset:0
  v_mfma_f32_16x16x32_bf16 a[20:23], a[172:175], v[40:43], a[20:23]
  v_exp_f32 v105, v105
  v_mfma_f32_16x16x32_bf16 a[20:23], a[168:171], v[8:11], a[20:23]
  ds_read_b64_tr_b16 a[186:187], v219 offset:4096
  v_cvt_pk_bf16_f32 v104, v104, v105
  v_mfma_f32_16x16x32_bf16 a[24:27], a[168:171], v[16:19], a[24:27]
  v_exp_f32 v106, v106
  v_mfma_f32_16x16x32_bf16 a[24:27], a[172:175], v[48:51], a[24:27]
  ds_read_b64_tr_b16 a[188:189], v219 offset:8192
  v_mfma_f32_16x16x32_bf16 a[28:31], a[172:175], v[56:59], a[28:31]
  s_waitcnt lgkmcnt(3)
  v_exp_f32 v107, v107
  v_mfma_f32_16x16x32_bf16 a[28:31], a[168:171], v[24:27], a[28:31]
  ds_read_b64_tr_b16 a[190:191], v219 offset:12288
  v_cvt_pk_bf16_f32 v105, v106, v107
  v_mfma_f32_16x16x32_bf16 a[32:35], a[176:179], v[0:3], a[32:35]
  v_exp_f32 v112, v112
  v_mfma_f32_16x16x32_bf16 a[32:35], a[180:183], v[32:35], a[32:35]
  ds_read_b64_tr_b16 a[160:161], v220 offset:0
  v_mfma_f32_16x16x32_bf16 a[36:39], a[180:183], v[40:43], a[36:39]
  v_exp_f32 v113, v113
  v_mfma_f32_16x16x32_bf16 a[36:39], a[176:179], v[8:11], a[36:39]
  ds_read_b64_tr_b16 a[162:163], v220 offset:4096
  v_cvt_pk_bf16_f32 v112, v112, v113
  v_mfma_f32_16x16x32_bf16 a[40:43], a[176:179], v[16:19], a[40:43]
  v_exp_f32 v114, v114
  v_mfma_f32_16x16x32_bf16 a[40:43], a[180:183], v[48:51], a[40:43]
  ds_read_b64_tr_b16 a[164:165], v220 offset:8192
  v_mfma_f32_16x16x32_bf16 a[44:47], a[180:183], v[56:59], a[44:47]
  s_waitcnt lgkmcnt(3)
  v_exp_f32 v115, v115
  v_mfma_f32_16x16x32_bf16 a[44:47], a[176:179], v[24:27], a[44:47]
  ds_read_b64_tr_b16 a[166:167], v220 offset:12288
  v_cvt_pk_bf16_f32 v113, v114, v115
  v_mfma_f32_16x16x32_bf16 a[48:51], a[184:187], v[0:3], a[48:51]
  v_exp_f32 v120, v120
  v_mfma_f32_16x16x32_bf16 a[48:51], a[188:191], v[32:35], a[48:51]
  ds_read_b64_tr_b16 a[168:169], v221 offset:0
  v_mfma_f32_16x16x32_bf16 a[52:55], a[188:191], v[40:43], a[52:55]
  v_exp_f32 v121, v121
  v_mfma_f32_16x16x32_bf16 a[52:55], a[184:187], v[8:11], a[52:55]
  ds_read_b64_tr_b16 a[170:171], v221 offset:4096
  v_cvt_pk_bf16_f32 v120, v120, v121
  v_mfma_f32_16x16x32_bf16 a[56:59], a[184:187], v[16:19], a[56:59]
  v_exp_f32 v122, v122
  v_mfma_f32_16x16x32_bf16 a[56:59], a[188:191], v[48:51], a[56:59]
  ds_read_b64_tr_b16 a[172:173], v221 offset:8192
  v_mfma_f32_16x16x32_bf16 a[60:63], a[188:191], v[56:59], a[60:63]
  s_waitcnt lgkmcnt(3)
  v_exp_f32 v123, v123
  v_mfma_f32_16x16x32_bf16 a[60:63], a[184:187], v[24:27], a[60:63]
  ds_read_b64_tr_b16 a[174:175], v221 offset:12288
  v_cvt_pk_bf16_f32 v121, v122, v123
  v_mfma_f32_16x16x32_bf16 a[64:67], a[160:163], v[0:3], a[64:67]
  v_exp_f32 v100, v100
  v_mfma_f32_16x16x32_bf16 a[64:67], a[164:167], v[32:35], a[64:67]
  ds_read_b64_tr_b16 a[176:177], v222 offset:0
  v_mfma_f32_16x16x32_bf16 a[68:71], a[164:167], v[40:43], a[68:71]
  v_exp_f32 v101, v101
  v_mfma_f32_16x16x32_bf16 a[68:71], a[160:163], v[8:11], a[68:71]
  ds_read_b64_tr_b16 a[178:179], v222 offset:4096
  v_cvt_pk_bf16_f32 v98, v100, v101
  v_mfma_f32_16x16x32_bf16 a[72:75], a[160:163], v[16:19], a[72:75]
  v_exp_f32 v102, v102
  v_mfma_f32_16x16x32_bf16 a[72:75], a[164:167], v[48:51], a[72:75]
  ds_read_b64_tr_b16 a[180:181], v222 offset:8192
  v_mfma_f32_16x16x32_bf16 a[76:79], a[164:167], v[56:59], a[76:79]
  s_waitcnt lgkmcnt(3)
  v_exp_f32 v103, v103
  v_mfma_f32_16x16x32_bf16 a[76:79], a[160:163], v[24:27], a[76:79]
  ds_read_b64_tr_b16 a[182:183], v222 offset:12288
  v_cvt_pk_bf16_f32 v99, v102, v103
  v_mfma_f32_16x16x32_bf16 a[80:83], a[168:171], v[0:3], a[80:83]
  v_exp_f32 v108, v108
  v_mfma_f32_16x16x32_bf16 a[80:83], a[172:175], v[32:35], a[80:83]
  ds_read_b64_tr_b16 a[184:185], v223 offset:0
  v_mfma_f32_16x16x32_bf16 a[84:87], a[172:175], v[40:43], a[84:87]
  v_exp_f32 v109, v109
  v_mfma_f32_16x16x32_bf16 a[84:87], a[168:171], v[8:11], a[84:87]
  ds_read_b64_tr_b16 a[186:187], v223 offset:4096
  v_cvt_pk_bf16_f32 v106, v108, v109
  v_mfma_f32_16x16x32_bf16 a[88:91], a[168:171], v[16:19], a[88:91]
  v_exp_f32 v110, v110
  v_mfma_f32_16x16x32_bf16 a[88:91], a[172:175], v[48:51], a[88:91]
  ds_read_b64_tr_b16 a[188:189], v223 offset:8192
  v_mfma_f32_16x16x32_bf16 a[92:95], a[172:175], v[56:59], a[92:95]
  s_waitcnt lgkmcnt(3)
  v_exp_f32 v111, v111
  v_mfma_f32_16x16x32_bf16 a[92:95], a[168:171], v[24:27], a[92:95]
  ds_read_b64_tr_b16 a[190:191], v223 offset:12288
  v_cvt_pk_bf16_f32 v107, v110, v111
  v_mfma_f32_16x16x32_bf16 a[96:99], a[176:179], v[0:3], a[96:99]
  s_waitcnt vmcnt(10)
  v_exp_f32 v116, v116
  v_mfma_f32_16x16x32_bf16 a[96:99], a[180:183], v[32:35], a[96:99]
  v_mfma_f32_16x16x32_bf16 a[100:103], a[180:183], v[40:43], a[100:103]
  s_barrier
  v_exp_f32 v117, v117
  v_mfma_f32_16x16x32_bf16 a[100:103], a[176:179], v[8:11], a[100:103]
  ds_read_b128 a[128:131], v212 offset:32768
  v_cvt_pk_bf16_f32 v114, v116, v117
  v_mfma_f32_16x16x32_bf16 a[104:107], a[176:179], v[16:19], a[104:107]
  v_exp_f32 v118, v118
  v_mfma_f32_16x16x32_bf16 a[104:107], a[180:183], v[48:51], a[104:107]
  ds_read_b128 a[132:135], v213 offset:32768
  v_mfma_f32_16x16x32_bf16 a[108:111], a[180:183], v[56:59], a[108:111]
  s_waitcnt lgkmcnt(2)
  v_exp_f32 v119, v119
  v_mfma_f32_16x16x32_bf16 a[108:111], a[176:179], v[24:27], a[108:111]
  ds_read_b128 a[136:139], v214 offset:32768
  v_cvt_pk_bf16_f32 v115, v118, v119
  v_mfma_f32_16x16x32_bf16 a[112:115], a[184:187], v[0:3], a[112:115]
  v_exp_f32 v124, v124
  v_mfma_f32_16x16x32_bf16 a[112:115], a[188:191], v[32:35], a[112:115]
  ds_read_b128 a[140:143], v215 offset:32768
  v_mfma_f32_16x16x32_bf16 a[116:119], a[188:191], v[40:43], a[116:119]
  v_exp_f32 v125, v125
  v_mfma_f32_16x16x32_bf16 a[116:119], a[184:187], v[8:11], a[116:119]
  v_cvt_pk_bf16_f32 v122, v124, v125
  v_mfma_f32_16x16x32_bf16 a[120:123], a[184:187], v[16:19], a[120:123]
  v_exp_f32 v126, v126
  v_mfma_f32_16x16x32_bf16 a[120:123], a[188:191], v[48:51], a[120:123]
  v_mfma_f32_16x16x32_bf16 a[124:127], a[188:191], v[56:59], a[124:127]
  s_waitcnt lgkmcnt(0)
  v_exp_f32 v127, v127
  v_mfma_f32_16x16x32_bf16 a[124:127], a[184:187], v[24:27], a[124:127]
  v_cvt_pk_bf16_f32 v123, v126, v127
  v_mfma_f32_16x16x32_bf16 v[0:3], a[128:131], v[128:131], v[192:195]
  v_mfma_f32_16x16x32_bf16 v[0:3], a[132:135], v[132:135], v[0:3]
  ds_read_b128 a[144:147], v212 offset:36864
  v_mfma_f32_16x16x32_bf16 v[0:3], a[136:139], v[136:139], v[0:3]
  v_mfma_f32_16x16x32_bf16 v[0:3], a[140:143], v[140:143], v[0:3]
  ds_read_b128 a[148:151], v213 offset:36864
  v_mfma_f32_16x16x32_bf16 v[8:11], a[140:143], v[156:159], v[196:199]
  v_mfma_f32_16x16x32_bf16 v[8:11], a[136:139], v[152:155], v[8:11]
  ds_read_b128 a[152:155], v214 offset:36864
  v_mfma_f32_16x16x32_bf16 v[8:11], a[132:135], v[148:151], v[8:11]
  v_mfma_f32_16x16x32_bf16 v[8:11], a[128:131], v[144:147], v[8:11]
  ds_read_b128 a[156:159], v215 offset:36864
  v_mfma_f32_16x16x32_bf16 v[16:19], a[128:131], v[160:163], v[200:203]
  s_add_u32 m0, s28, 114688
  v_exp_f32 v0, v0
  v_mfma_f32_16x16x32_bf16 v[16:19], a[132:135], v[164:167], v[16:19]
  buffer_load_dwordx4 v236, s[16:19], s29 offen offset:0 lds
  v_mfma_f32_16x16x32_bf16 v[16:19], a[136:139], v[168:171], v[16:19]
  v_exp_f32 v1, v1
  v_mfma_f32_16x16x32_bf16 v[16:19], a[140:143], v[172:175], v[16:19]
  v_cvt_pk_bf16_f32 v0, v0, v1
  v_mfma_f32_16x16x32_bf16 v[24:27], a[140:143], v[188:191], v[204:207]
  v_exp_f32 v2, v2
  v_mfma_f32_16x16x32_bf16 v[24:27], a[136:139], v[184:187], v[24:27]
  buffer_load_dwordx4 v237, s[16:19], s29 offen offset:1024 lds
  v_mfma_f32_16x16x32_bf16 v[24:27], a[132:135], v[180:183], v[24:27]
  s_waitcnt lgkmcnt(0)
  v_exp_f32 v3, v3
  v_mfma_f32_16x16x32_bf16 v[24:27], a[128:131], v[176:179], v[24:27]
  v_cvt_pk_bf16_f32 v1, v2, v3
  v_mfma_f32_16x16x32_bf16 v[4:7], a[144:147], v[128:131], v[192:195]
  v_exp_f32 v8, v8
  v_mfma_f32_16x16x32_bf16 v[4:7], a[148:151], v[132:135], v[4:7]
  ds_read_b128 a[128:131], v212 offset:40960
  v_mfma_f32_16x16x32_bf16 v[4:7], a[152:155], v[136:139], v[4:7]
  v_exp_f32 v9, v9
  v_mfma_f32_16x16x32_bf16 v[4:7], a[156:159], v[140:143], v[4:7]
  ds_read_b128 a[132:135], v213 offset:40960
  v_cvt_pk_bf16_f32 v8, v8, v9
  v_mfma_f32_16x16x32_bf16 v[12:15], a[156:159], v[156:159], v[196:199]
  v_exp_f32 v10, v10
  v_mfma_f32_16x16x32_bf16 v[12:15], a[152:155], v[152:155], v[12:15]
  ds_read_b128 a[136:139], v214 offset:40960
  v_mfma_f32_16x16x32_bf16 v[12:15], a[148:151], v[148:151], v[12:15]
  v_exp_f32 v11, v11
  v_mfma_f32_16x16x32_bf16 v[12:15], a[144:147], v[144:147], v[12:15]
  ds_read_b128 a[140:143], v215 offset:40960
  v_cvt_pk_bf16_f32 v9, v10, v11
  v_mfma_f32_16x16x32_bf16 v[20:23], a[144:147], v[160:163], v[200:203]
  v_exp_f32 v16, v16
  v_mfma_f32_16x16x32_bf16 v[20:23], a[148:151], v[164:167], v[20:23]
  buffer_load_dwordx4 v236, s[16:19], s29 offen offset:2048 lds
  v_mfma_f32_16x16x32_bf16 v[20:23], a[152:155], v[168:171], v[20:23]
  v_exp_f32 v17, v17
  v_mfma_f32_16x16x32_bf16 v[20:23], a[156:159], v[172:175], v[20:23]
  v_cvt_pk_bf16_f32 v16, v16, v17
  v_mfma_f32_16x16x32_bf16 v[28:31], a[156:159], v[188:191], v[204:207]
  v_exp_f32 v18, v18
  v_mfma_f32_16x16x32_bf16 v[28:31], a[152:155], v[184:187], v[28:31]
  buffer_load_dwordx4 v237, s[16:19], s29 offen offset:3072 lds
  v_mfma_f32_16x16x32_bf16 v[28:31], a[148:151], v[180:183], v[28:31]
  s_waitcnt lgkmcnt(0)
  s_add_u32 s29, s29, 16384
  v_exp_f32 v19, v19
  v_mfma_f32_16x16x32_bf16 v[28:31], a[144:147], v[176:179], v[28:31]
  v_cvt_pk_bf16_f32 v17, v18, v19
  v_mfma_f32_16x16x32_bf16 v[32:35], a[128:131], v[128:131], v[192:195]
  s_add_u32 m0, s28, 0
  v_exp_f32 v24, v24
  v_mfma_f32_16x16x32_bf16 v[32:35], a[132:135], v[132:135], v[32:35]
  ds_read_b128 a[144:147], v212 offset:45056
  v_mfma_f32_16x16x32_bf16 v[32:35], a[136:139], v[136:139], v[32:35]
  v_exp_f32 v25, v25
  v_mfma_f32_16x16x32_bf16 v[32:35], a[140:143], v[140:143], v[32:35]
  ds_read_b128 a[148:151], v213 offset:45056
  v_cvt_pk_bf16_f32 v24, v24, v25
  v_mfma_f32_16x16x32_bf16 v[40:43], a[140:143], v[156:159], v[196:199]
  v_exp_f32 v26, v26
  v_mfma_f32_16x16x32_bf16 v[40:43], a[136:139], v[152:155], v[40:43]
  ds_read_b128 a[152:155], v214 offset:45056
  v_mfma_f32_16x16x32_bf16 v[40:43], a[132:135], v[148:151], v[40:43]
  v_exp_f32 v27, v27
  v_mfma_f32_16x16x32_bf16 v[40:43], a[128:131], v[144:147], v[40:43]
  ds_read_b128 a[156:159], v215 offset:45056
  v_cvt_pk_bf16_f32 v25, v26, v27
  v_mfma_f32_16x16x32_bf16 v[48:51], a[128:131], v[160:163], v[200:203]
  v_exp_f32 v4, v4
  v_mfma_f32_16x16x32_bf16 v[48:51], a[132:135], v[164:167], v[48:51]
  buffer_load_dwordx4 v232, s[12:15], s29 offen offset:0 lds
  v_mfma_f32_16x16x32_bf16 v[48:51], a[136:139], v[168:171], v[48:51]
  v_exp_f32 v5, v5
  v_mfma_f32_16x16x32_bf16 v[48:51], a[140:143], v[172:175], v[48:51]
  v_cvt_pk_bf16_f32 v2, v4, v5
  v_mfma_f32_16x16x32_bf16 v[56:59], a[140:143], v[188:191], v[204:207]
  v_exp_f32 v6, v6
  v_mfma_f32_16x16x32_bf16 v[56:59], a[136:139], v[184:187], v[56:59]
  buffer_load_dwordx4 v233, s[12:15], s29 offen offset:1024 lds
  v_mfma_f32_16x16x32_bf16 v[56:59], a[132:135], v[180:183], v[56:59]
  s_waitcnt lgkmcnt(0)
  v_exp_f32 v7, v7
  v_mfma_f32_16x16x32_bf16 v[56:59], a[128:131], v[176:179], v[56:59]
  v_cvt_pk_bf16_f32 v3, v6, v7
  v_mfma_f32_16x16x32_bf16 v[36:39], a[144:147], v[128:131], v[192:195]
  v_exp_f32 v12, v12
  v_mfma_f32_16x16x32_bf16 v[36:39], a[148:151], v[132:135], v[36:39]
  buffer_load_dwordx4 v234, s[12:15], s29 offen offset:2048 lds
  v_mfma_f32_16x16x32_bf16 v[36:39], a[152:155], v[136:139], v[36:39]
  v_exp_f32 v13, v13
  v_mfma_f32_16x16x32_bf16 v[36:39], a[156:159], v[140:143], v[36:39]
  v_cvt_pk_bf16_f32 v10, v12, v13
  v_mfma_f32_16x16x32_bf16 v[44:47], a[156:159], v[156:159], v[196:199]
  v_exp_f32 v14, v14
  v_mfma_f32_16x16x32_bf16 v[44:47], a[152:155], v[152:155], v[44:47]
  buffer_load_dwordx4 v235, s[12:15], s29 offen offset:3072 lds
  v_mfma_f32_16x16x32_bf16 v[44:47], a[148:151], v[148:151], v[44:47]
  v_exp_f32 v15, v15
  v_mfma_f32_16x16x32_bf16 v[44:47], a[144:147], v[144:147], v[44:47]
  v_cvt_pk_bf16_f32 v11, v14, v15
  v_mfma_f32_16x16x32_bf16 v[52:55], a[144:147], v[160:163], v[200:203]
  v_exp_f32 v20, v20
  v_mfma_f32_16x16x32_bf16 v[52:55], a[148:151], v[164:167], v[52:55]
  ds_read_b64_tr_b16 a[160:161], v216 offset:16384
  ds_read_b64_tr_b16 a[232:233], v209 offset:4096
  v_mfma_f32_16x16x32_bf16 v[52:55], a[152:155], v[168:171], v[52:55]
  v_exp_f32 v21, v21
  v_mfma_f32_16x16x32_bf16 v[52:55], a[156:159], v[172:175], v[52:55]
  ds_read_b64_tr_b16 a[162:163], v216 offset:20480
  v_cvt_pk_bf16_f32 v18, v20, v21
  v_mfma_f32_16x16x32_bf16 v[60:63], a[156:159], v[188:191], v[204:207]
  v_exp_f32 v22, v22
  v_mfma_f32_16x16x32_bf16 v[60:63], a[152:155], v[184:187], v[60:63]
  ds_read_b64_tr_b16 a[164:165], v216 offset:24576
  ds_read_b64_tr_b16 a[234:235], v209 offset:4608
  s_waitcnt lgkmcnt(0)
  v_mfma_f32_16x16x32_bf16 v[60:63], a[148:151], v[180:183], v[60:63]
  v_exp_f32 v23, v23
  v_mfma_f32_16x16x32_bf16 v[60:63], a[144:147], v[176:179], v[60:63]
  ds_read_b64_tr_b16 a[166:167], v216 offset:28672
  v_cvt_pk_bf16_f32 v19, v22, v23
  v_mfma_f32_16x16x32_bf16 a[192:195], a[208:211], v[64:67], a[192:195]
  v_exp_f32 v28, v28
  v_mfma_f32_16x16x32_bf16 a[192:195], a[208:211], v[96:99], a[192:195]
  ds_read_b64_tr_b16 a[168:169], v217 offset:16384
  buffer_store_dwordx4 a[232:235], v242, s[24:27], s31 offen
  s_cmp_gt_u32 s32, 2
  s_cselect_b32 s39, 32, 0
  s_add_u32 s30, s30, s39
  s_lshl_b32 s39, s39, 5
  s_add_u32 s31, s31, s39
  v_mfma_f32_16x16x32_bf16 a[196:199], a[208:211], v[72:75], a[196:199]
  v_exp_f32 v29, v29
  v_mfma_f32_16x16x32_bf16 a[196:199], a[208:211], v[104:107], a[196:199]
  ds_read_b64_tr_b16 a[170:171], v217 offset:20480
  v_cvt_pk_bf16_f32 v26, v28, v29
  v_mfma_f32_16x16x32_bf16 a[200:203], a[208:211], v[80:83], a[200:203]
  v_exp_f32 v30, v30
  v_mfma_f32_16x16x32_bf16 a[200:203], a[208:211], v[112:115], a[200:203]
  ds_read_b64_tr_b16 a[172:173], v217 offset:24576
  v_mfma_f32_16x16x32_bf16 a[204:207], a[208:211], v[88:91], a[204:207]
  s_waitcnt lgkmcnt(3)
  v_exp_f32 v31, v31
  v_mfma_f32_16x16x32_bf16 a[204:207], a[208:211], v[120:123], a[204:207]
  ds_read_b64_tr_b16 a[174:175], v217 offset:28672
  v_cvt_pk_bf16_f32 v27, v30, v31
  v_mfma_f32_16x16x32_bf16 a[0:3], a[160:163], v[64:67], a[0:3]
  v_exp_f32 v32, v32
  v_mfma_f32_16x16x32_bf16 a[0:3], a[164:167], v[96:99], a[0:3]
  ds_read_b64_tr_b16 a[176:177], v218 offset:16384
  v_mfma_f32_16x16x32_bf16 a[4:7], a[164:167], v[104:107], a[4:7]
  v_exp_f32 v33, v33
  v_mfma_f32_16x16x32_bf16 a[4:7], a[160:163], v[72:75], a[4:7]
  ds_read_b64_tr_b16 a[178:179], v218 offset:20480
  v_cvt_pk_bf16_f32 v32, v32, v33
  v_mfma_f32_16x16x32_bf16 a[8:11], a[160:163], v[80:83], a[8:11]
  v_exp_f32 v34, v34
  v_mfma_f32_16x16x32_bf16 a[8:11], a[164:167], v[112:115], a[8:11]
  ds_read_b64_tr_b16 a[180:181], v218 offset:24576
  v_mfma_f32_16x16x32_bf16 a[12:15], a[164:167], v[120:123], a[12:15]
  s_waitcnt lgkmcnt(3)
  v_exp_f32 v35, v35
  v_mfma_f32_16x16x32_bf16 a[12:15], a[160:163], v[88:91], a[12:15]
  ds_read_b64_tr_b16 a[182:183], v218 offset:28672
  v_cvt_pk_bf16_f32 v33, v34, v35
  v_mfma_f32_16x16x32_bf16 a[16:19], a[168:171], v[64:67], a[16:19]
  v_exp_f32 v40, v40
  v_mfma_f32_16x16x32_bf16 a[16:19], a[172:175], v[96:99], a[16:19]
  ds_read_b64_tr_b16 a[184:185], v219 offset:16384
  v_mfma_f32_16x16x32_bf16 a[20:23], a[172:175], v[104:107], a[20:23]
  v_exp_f32 v41, v41
  v_mfma_f32_16x16x32_bf16 a[20:23], a[168:171], v[72:75], a[20:23]
  ds_read_b64_tr_b16 a[186:187], v219 offset:20480
  v_cvt_pk_bf16_f32 v40, v40, v41
  v_mfma_f32_16x16x32_bf16 a[24:27], a[168:171], v[80:83], a[24:27]
  v_exp_f32 v42, v42
  v_mfma_f32_16x16x32_bf16 a[24:27], a[172:175], v[112:115], a[24:27]
  ds_read_b64_tr_b16 a[188:189], v219 offset:24576
  v_mfma_f32_16x16x32_bf16 a[28:31], a[172:175], v[120:123], a[28:31]
  s_waitcnt lgkmcnt(3)
  v_exp_f32 v43, v43
  v_mfma_f32_16x16x32_bf16 a[28:31], a[168:171], v[88:91], a[28:31]
  ds_read_b64_tr_b16 a[190:191], v219 offset:28672
  v_cvt_pk_bf16_f32 v41, v42, v43
  v_mfma_f32_16x16x32_bf16 a[32:35], a[176:179], v[64:67], a[32:35]
  v_exp_f32 v48, v48
  v_mfma_f32_16x16x32_bf16 a[32:35], a[180:183], v[96:99], a[32:35]
  ds_read_b64_tr_b16 a[160:161], v220 offset:16384
  v_mfma_f32_16x16x32_bf16 a[36:39], a[180:183], v[104:107], a[36:39]
  v_exp_f32 v49, v49
  v_mfma_f32_16x16x32_bf16 a[36:39], a[176:179], v[72:75], a[36:39]
  ds_read_b64_tr_b16 a[162:163], v220 offset:20480
  v_cvt_pk_bf16_f32 v48, v48, v49
  v_mfma_f32_16x16x32_bf16 a[40:43], a[176:179], v[80:83], a[40:43]
  v_exp_f32 v50, v50
  v_mfma_f32_16x16x32_bf16 a[40:43], a[180:183], v[112:115], a[40:43]
  ds_read_b64_tr_b16 a[164:165], v220 offset:24576
  v_mfma_f32_16x16x32_bf16 a[44:47], a[180:183], v[120:123], a[44:47]
  s_waitcnt lgkmcnt(3)
  v_exp_f32 v51, v51
  v_mfma_f32_16x16x32_bf16 a[44:47], a[176:179], v[88:91], a[44:47]
  ds_read_b64_tr_b16 a[166:167], v220 offset:28672
  v_cvt_pk_bf16_f32 v49, v50, v51
  v_mfma_f32_16x16x32_bf16 a[48:51], a[184:187], v[64:67], a[48:51]
  v_exp_f32 v56, v56
  v_mfma_f32_16x16x32_bf16 a[48:51], a[188:191], v[96:99], a[48:51]
  ds_read_b64_tr_b16 a[168:169], v221 offset:16384
  v_mfma_f32_16x16x32_bf16 a[52:55], a[188:191], v[104:107], a[52:55]
  v_exp_f32 v57, v57
  v_mfma_f32_16x16x32_bf16 a[52:55], a[184:187], v[72:75], a[52:55]
  ds_read_b64_tr_b16 a[170:171], v221 offset:20480
  v_cvt_pk_bf16_f32 v56, v56, v57
  v_mfma_f32_16x16x32_bf16 a[56:59], a[184:187], v[80:83], a[56:59]
  v_exp_f32 v58, v58
  v_mfma_f32_16x16x32_bf16 a[56:59], a[188:191], v[112:115], a[56:59]
  ds_read_b64_tr_b16 a[172:173], v221 offset:24576
  v_mfma_f32_16x16x32_bf16 a[60:63], a[188:191], v[120:123], a[60:63]
  s_waitcnt lgkmcnt(3)
  v_exp_f32 v59, v59
  v_mfma_f32_16x16x32_bf16 a[60:63], a[184:187], v[88:91], a[60:63]
  ds_read_b64_tr_b16 a[174:175], v221 offset:28672
  v_cvt_pk_bf16_f32 v57, v58, v59
  v_mfma_f32_16x16x32_bf16 a[64:67], a[160:163], v[64:67], a[64:67]
  v_exp_f32 v36, v36
  v_mfma_f32_16x16x32_bf16 a[64:67], a[164:167], v[96:99], a[64:67]
  ds_read_b64_tr_b16 a[176:177], v222 offset:16384
  v_mfma_f32_16x16x32_bf16 a[68:71], a[164:167], v[104:107], a[68:71]
  v_exp_f32 v37, v37
  v_mfma_f32_16x16x32_bf16 a[68:71], a[160:163], v[72:75], a[68:71]
  ds_read_b64_tr_b16 a[178:179], v222 offset:20480
  v_cvt_pk_bf16_f32 v34, v36, v37
  v_mfma_f32_16x16x32_bf16 a[72:75], a[160:163], v[80:83], a[72:75]
  v_exp_f32 v38, v38
  v_mfma_f32_16x16x32_bf16 a[72:75], a[164:167], v[112:115], a[72:75]
  ds_read_b64_tr_b16 a[180:181], v222 offset:24576
  v_mfma_f32_16x16x32_bf16 a[76:79], a[164:167], v[120:123], a[76:79]
  s_waitcnt lgkmcnt(3)
  v_exp_f32 v39, v39
  v_mfma_f32_16x16x32_bf16 a[76:79], a[160:163], v[88:91], a[76:79]
  ds_read_b64_tr_b16 a[182:183], v222 offset:28672
  v_cvt_pk_bf16_f32 v35, v38, v39
  v_mfma_f32_16x16x32_bf16 a[80:83], a[168:171], v[64:67], a[80:83]
  v_exp_f32 v44, v44
  v_mfma_f32_16x16x32_bf16 a[80:83], a[172:175], v[96:99], a[80:83]
  ds_read_b64_tr_b16 a[184:185], v223 offset:16384
  v_mfma_f32_16x16x32_bf16 a[84:87], a[172:175], v[104:107], a[84:87]
  v_exp_f32 v45, v45
  v_mfma_f32_16x16x32_bf16 a[84:87], a[168:171], v[72:75], a[84:87]
  ds_read_b64_tr_b16 a[186:187], v223 offset:20480
  v_cvt_pk_bf16_f32 v42, v44, v45
  v_mfma_f32_16x16x32_bf16 a[88:91], a[168:171], v[80:83], a[88:91]
  v_exp_f32 v46, v46
  v_mfma_f32_16x16x32_bf16 a[88:91], a[172:175], v[112:115], a[88:91]
  ds_read_b64_tr_b16 a[188:189], v223 offset:24576
  v_mfma_f32_16x16x32_bf16 a[92:95], a[172:175], v[120:123], a[92:95]
  s_waitcnt lgkmcnt(3)
  v_exp_f32 v47, v47
  v_mfma_f32_16x16x32_bf16 a[92:95], a[168:171], v[88:91], a[92:95]
  ds_read_b64_tr_b16 a[190:191], v223 offset:28672
  v_cvt_pk_bf16_f32 v43, v46, v47
  v_mfma_f32_16x16x32_bf16 a[96:99], a[176:179], v[64:67], a[96:99]
  s_waitcnt vmcnt(9)
  v_exp_f32 v52, v52
  v_mfma_f32_16x16x32_bf16 a[96:99], a[180:183], v[96:99], a[96:99]
  v_mfma_f32_16x16x32_bf16 a[100:103], a[180:183], v[104:107], a[100:103]
  s_barrier
  v_exp_f32 v53, v53
  v_mfma_f32_16x16x32_bf16 a[100:103], a[176:179], v[72:75], a[100:103]
  ds_read_b128 a[128:131], v212 offset:49152
  v_cvt_pk_bf16_f32 v50, v52, v53
  v_mfma_f32_16x16x32_bf16 a[104:107], a[176:179], v[80:83], a[104:107]
  v_exp_f32 v54, v54
  v_mfma_f32_16x16x32_bf16 a[104:107], a[180:183], v[112:115], a[104:107]
  ds_read_b128 a[132:135], v213 offset:49152
  v_mfma_f32_16x16x32_bf16 a[108:111], a[180:183], v[120:123], a[108:111]
  s_waitcnt lgkmcnt(2)
  v_exp_f32 v55, v55
  v_mfma_f32_16x16x32_bf16 a[108:111], a[176:179], v[88:91], a[108:111]
  ds_read_b128 a[136:139], v214 offset:49152
  v_cvt_pk_bf16_f32 v51, v54, v55
  v_mfma_f32_16x16x32_bf16 a[112:115], a[184:187], v[64:67], a[112:115]
  v_exp_f32 v60, v60
  v_mfma_f32_16x16x32_bf16 a[112:115], a[188:191], v[96:99], a[112:115]
  ds_read_b128 a[140:143], v215 offset:49152
  v_mfma_f32_16x16x32_bf16 a[116:119], a[188:191], v[104:107], a[116:119]
  v_exp_f32 v61, v61
  v_mfma_f32_16x16x32_bf16 a[116:119], a[184:187], v[72:75], a[116:119]
  v_cvt_pk_bf16_f32 v58, v60, v61
  v_mfma_f32_16x16x32_bf16 a[120:123], a[184:187], v[80:83], a[120:123]
  v_exp_f32 v62, v62
  v_mfma_f32_16x16x32_bf16 a[120:123], a[188:191], v[112:115], a[120:123]
  v_mfma_f32_16x16x32_bf16 a[124:127], a[188:191], v[120:123], a[124:127]
  s_waitcnt lgkmcnt(0)
  v_exp_f32 v63, v63
  v_mfma_f32_16x16x32_bf16 a[124:127], a[184:187], v[88:91], a[124:127]
  v_cvt_pk_bf16_f32 v59, v62, v63
  v_mfma_f32_16x16x32_bf16 v[64:67], a[128:131], v[128:131], v[192:195]
  buffer_load_dword v254, off, s[44:47], 0 sc1
  v_mfma_f32_16x16x32_bf16 v[64:67], a[132:135], v[132:135], v[64:67]
  ds_read_b128 a[144:147], v212 offset:53248
  v_mfma_f32_16x16x32_bf16 v[64:67], a[136:139], v[136:139], v[64:67]
  v_mfma_f32_16x16x32_bf16 v[64:67], a[140:143], v[140:143], v[64:67]
  ds_read_b128 a[148:151], v213 offset:53248
  v_mfma_f32_16x16x32_bf16 v[72:75], a[140:143], v[156:159], v[196:199]
  v_mfma_f32_16x16x32_bf16 v[72:75], a[136:139], v[152:155], v[72:75]
  ds_read_b128 a[152:155], v214 offset:53248
  v_mfma_f32_16x16x32_bf16 v[72:75], a[132:135], v[148:151], v[72:75]
  v_mfma_f32_16x16x32_bf16 v[72:75], a[128:131], v[144:147], v[72:75]
  ds_read_b128 a[156:159], v215 offset:53248
  v_mfma_f32_16x16x32_bf16 v[80:83], a[128:131], v[160:163], v[200:203]
  s_add_u32 m0, s28, 65536
  v_exp_f32 v64, v64
  v_mfma_f32_16x16x32_bf16 v[80:83], a[132:135], v[164:167], v[80:83]
  buffer_load_dwordx4 v236, s[16:19], s29 offen offset:0 lds
  v_mfma_f32_16x16x32_bf16 v[80:83], a[136:139], v[168:171], v[80:83]
  v_exp_f32 v65, v65
  v_mfma_f32_16x16x32_bf16 v[80:83], a[140:143], v[172:175], v[80:83]
  v_cvt_pk_bf16_f32 v64, v64, v65
  v_mfma_f32_16x16x32_bf16 v[88:91], a[140:143], v[188:191], v[204:207]
  v_exp_f32 v66, v66
  v_mfma_f32_16x16x32_bf16 v[88:91], a[136:139], v[184:187], v[88:91]
  buffer_load_dwordx4 v237, s[16:19], s29 offen offset:1024 lds
  v_mfma_f32_16x16x32_bf16 v[88:91], a[132:135], v[180:183], v[88:91]
  s_waitcnt lgkmcnt(0)
  v_exp_f32 v67, v67
  v_mfma_f32_16x16x32_bf16 v[88:91], a[128:131], v[176:179], v[88:91]
  v_cvt_pk_bf16_f32 v65, v66, v67
  v_mfma_f32_16x16x32_bf16 v[68:71], a[144:147], v[128:131], v[192:195]
  v_exp_f32 v72, v72
  v_mfma_f32_16x16x32_bf16 v[68:71], a[148:151], v[132:135], v[68:71]
  ds_read_b128 a[128:131], v212 offset:57344
  v_mfma_f32_16x16x32_bf16 v[68:71], a[152:155], v[136:139], v[68:71]
  v_exp_f32 v73, v73
  v_mfma_f32_16x16x32_bf16 v[68:71], a[156:159], v[140:143], v[68:71]
  ds_read_b128 a[132:135], v213 offset:57344
  v_cvt_pk_bf16_f32 v72, v72, v73
  v_mfma_f32_16x16x32_bf16 v[76:79], a[156:159], v[156:159], v[196:199]
  v_exp_f32 v74, v74
  v_mfma_f32_16x16x32_bf16 v[76:79], a[152:155], v[152:155], v[76:79]
  ds_read_b128 a[136:139], v214 offset:57344
  v_mfma_f32_16x16x32_bf16 v[76:79], a[148:151], v[148:151], v[76:79]
  v_exp_f32 v75, v75
  v_mfma_f32_16x16x32_bf16 v[76:79], a[144:147], v[144:147], v[76:79]
  ds_read_b128 a[140:143], v215 offset:57344
  v_cvt_pk_bf16_f32 v73, v74, v75
  v_mfma_f32_16x16x32_bf16 v[84:87], a[144:147], v[160:163], v[200:203]
  v_exp_f32 v80, v80
  v_mfma_f32_16x16x32_bf16 v[84:87], a[148:151], v[164:167], v[84:87]
  buffer_load_dwordx4 v236, s[16:19], s29 offen offset:2048 lds
  v_mfma_f32_16x16x32_bf16 v[84:87], a[152:155], v[168:171], v[84:87]
  v_exp_f32 v81, v81
  v_mfma_f32_16x16x32_bf16 v[84:87], a[156:159], v[172:175], v[84:87]
  v_cvt_pk_bf16_f32 v80, v80, v81
  v_mfma_f32_16x16x32_bf16 v[92:95], a[156:159], v[188:191], v[204:207]
  v_exp_f32 v82, v82
  v_mfma_f32_16x16x32_bf16 v[92:95], a[152:155], v[184:187], v[92:95]
  buffer_load_dwordx4 v237, s[16:19], s29 offen offset:3072 lds
  v_mfma_f32_16x16x32_bf16 v[92:95], a[148:151], v[180:183], v[92:95]
  s_waitcnt lgkmcnt(0)
  s_add_u32 s29, s29, 16384
  v_exp_f32 v83, v83
  v_mfma_f32_16x16x32_bf16 v[92:95], a[144:147], v[176:179], v[92:95]
  v_cvt_pk_bf16_f32 v81, v82, v83
  v_mfma_f32_16x16x32_bf16 v[96:99], a[128:131], v[128:131], v[192:195]
  s_add_u32 m0, s28, 16384
  v_exp_f32 v88, v88
  v_mfma_f32_16x16x32_bf16 v[96:99], a[132:135], v[132:135], v[96:99]
  ds_read_b128 a[144:147], v212 offset:61440
  v_mfma_f32_16x16x32_bf16 v[96:99], a[136:139], v[136:139], v[96:99]
  v_exp_f32 v89, v89
  v_mfma_f32_16x16x32_bf16 v[96:99], a[140:143], v[140:143], v[96:99]
  ds_read_b128 a[148:151], v213 offset:61440
  v_cvt_pk_bf16_f32 v88, v88, v89
  v_mfma_f32_16x16x32_bf16 v[104:107], a[140:143], v[156:159], v[196:199]
  v_exp_f32 v90, v90
  v_mfma_f32_16x16x32_bf16 v[104:107], a[136:139], v[152:155], v[104:107]
  ds_read_b128 a[152:155], v214 offset:61440
  v_mfma_f32_16x16x32_bf16 v[104:107], a[132:135], v[148:151], v[104:107]
  v_exp_f32 v91, v91
  v_mfma_f32_16x16x32_bf16 v[104:107], a[128:131], v[144:147], v[104:107]
  ds_read_b128 a[156:159], v215 offset:61440
  v_cvt_pk_bf16_f32 v89, v90, v91
  v_mfma_f32_16x16x32_bf16 v[112:115], a[128:131], v[160:163], v[200:203]
  v_exp_f32 v68, v68
  v_mfma_f32_16x16x32_bf16 v[112:115], a[132:135], v[164:167], v[112:115]
  buffer_load_dwordx4 v232, s[12:15], s29 offen offset:0 lds
  v_mfma_f32_16x16x32_bf16 v[112:115], a[136:139], v[168:171], v[112:115]
  v_exp_f32 v69, v69
  v_mfma_f32_16x16x32_bf16 v[112:115], a[140:143], v[172:175], v[112:115]
  v_cvt_pk_bf16_f32 v66, v68, v69
  v_mfma_f32_16x16x32_bf16 v[120:123], a[140:143], v[188:191], v[204:207]
  v_exp_f32 v70, v70
  v_mfma_f32_16x16x32_bf16 v[120:123], a[136:139], v[184:187], v[120:123]
  buffer_load_dwordx4 v233, s[12:15], s29 offen offset:1024 lds
  v_mfma_f32_16x16x32_bf16 v[120:123], a[132:135], v[180:183], v[120:123]
  s_waitcnt lgkmcnt(0)
  v_exp_f32 v71, v71
  v_mfma_f32_16x16x32_bf16 v[120:123], a[128:131], v[176:179], v[120:123]
  v_cvt_pk_bf16_f32 v67, v70, v71
  v_mfma_f32_16x16x32_bf16 v[100:103], a[144:147], v[128:131], v[192:195]
  v_exp_f32 v76, v76
  v_mfma_f32_16x16x32_bf16 v[100:103], a[148:151], v[132:135], v[100:103]
  buffer_load_dwordx4 v234, s[12:15], s29 offen offset:2048 lds
  v_mfma_f32_16x16x32_bf16 v[100:103], a[152:155], v[136:139], v[100:103]
  v_exp_f32 v77, v77
  v_mfma_f32_16x16x32_bf16 v[100:103], a[156:159], v[140:143], v[100:103]
  v_cvt_pk_bf16_f32 v74, v76, v77
  v_mfma_f32_16x16x32_bf16 v[108:111], a[156:159], v[156:159], v[196:199]
  v_exp_f32 v78, v78
  v_mfma_f32_16x16x32_bf16 v[108:111], a[152:155], v[152:155], v[108:111]
  buffer_load_dwordx4 v235, s[12:15], s29 offen offset:3072 lds
  v_mfma_f32_16x16x32_bf16 v[108:111], a[148:151], v[148:151], v[108:111]
  v_exp_f32 v79, v79
  v_mfma_f32_16x16x32_bf16 v[108:111], a[144:147], v[144:147], v[108:111]
  v_cvt_pk_bf16_f32 v75, v78, v79
  v_mfma_f32_16x16x32_bf16 v[116:119], a[144:147], v[160:163], v[200:203]
  v_exp_f32 v84, v84
  v_mfma_f32_16x16x32_bf16 v[116:119], a[148:151], v[164:167], v[116:119]
  ds_read_b64_tr_b16 a[160:161], v216 offset:32768
  v_mfma_f32_16x16x32_bf16 v[116:119], a[152:155], v[168:171], v[116:119]
  v_exp_f32 v85, v85
  v_mfma_f32_16x16x32_bf16 v[116:119], a[156:159], v[172:175], v[116:119]
  ds_read_b64_tr_b16 a[162:163], v216 offset:36864
  v_cvt_pk_bf16_f32 v82, v84, v85
  v_mfma_f32_16x16x32_bf16 v[124:127], a[156:159], v[188:191], v[204:207]
  v_exp_f32 v86, v86
  v_mfma_f32_16x16x32_bf16 v[124:127], a[152:155], v[184:187], v[124:127]
  ds_read_b64_tr_b16 a[164:165], v216 offset:40960
  v_mfma_f32_16x16x32_bf16 v[124:127], a[148:151], v[180:183], v[124:127]
  v_exp_f32 v87, v87
  v_mfma_f32_16x16x32_bf16 v[124:127], a[144:147], v[176:179], v[124:127]
  ds_read_b64_tr_b16 a[166:167], v216 offset:45056
  v_cvt_pk_bf16_f32 v83, v86, v87
  v_mfma_f32_16x16x32_bf16 a[192:195], a[208:211], v[0:3], a[192:195]
  v_exp_f32 v92, v92
  v_mfma_f32_16x16x32_bf16 a[192:195], a[208:211], v[32:35], a[192:195]
  ds_read_b64_tr_b16 a[168:169], v217 offset:32768
  v_mfma_f32_16x16x32_bf16 a[196:199], a[208:211], v[8:11], a[196:199]
  v_exp_f32 v93, v93
  v_mfma_f32_16x16x32_bf16 a[196:199], a[208:211], v[40:43], a[196:199]
  ds_read_b64_tr_b16 a[170:171], v217 offset:36864
  v_cvt_pk_bf16_f32 v90, v92, v93
  v_mfma_f32_16x16x32_bf16 a[200:203], a[208:211], v[16:19], a[200:203]
  v_exp_f32 v94, v94
  v_mfma_f32_16x16x32_bf16 a[200:203], a[208:211], v[48:51], a[200:203]
  ds_read_b64_tr_b16 a[172:173], v217 offset:40960
  v_mfma_f32_16x16x32_bf16 a[204:207], a[208:211], v[24:27], a[204:207]
  s_waitcnt lgkmcnt(3)
  v_exp_f32 v95, v95
  v_mfma_f32_16x16x32_bf16 a[204:207], a[208:211], v[56:59], a[204:207]
  ds_read_b64_tr_b16 a[174:175], v217 offset:45056
  v_cvt_pk_bf16_f32 v91, v94, v95
  v_mfma_f32_16x16x32_bf16 a[0:3], a[160:163], v[0:3], a[0:3]
  v_exp_f32 v96, v96
  v_mfma_f32_16x16x32_bf16 a[0:3], a[164:167], v[32:35], a[0:3]
  ds_read_b64_tr_b16 a[176:177], v218 offset:32768
  v_mfma_f32_16x16x32_bf16 a[4:7], a[164:167], v[40:43], a[4:7]
  v_exp_f32 v97, v97
  v_mfma_f32_16x16x32_bf16 a[4:7], a[160:163], v[8:11], a[4:7]
  ds_read_b64_tr_b16 a[178:179], v218 offset:36864
  v_cvt_pk_bf16_f32 v96, v96, v97
  v_mfma_f32_16x16x32_bf16 a[8:11], a[160:163], v[16:19], a[8:11]
  v_exp_f32 v98, v98
  v_mfma_f32_16x16x32_bf16 a[8:11], a[164:167], v[48:51], a[8:11]
  ds_read_b64_tr_b16 a[180:181], v218 offset:40960
  v_mfma_f32_16x16x32_bf16 a[12:15], a[164:167], v[56:59], a[12:15]
  s_waitcnt lgkmcnt(3)
  v_exp_f32 v99, v99
  v_mfma_f32_16x16x32_bf16 a[12:15], a[160:163], v[24:27], a[12:15]
  ds_read_b64_tr_b16 a[182:183], v218 offset:45056
  v_cvt_pk_bf16_f32 v97, v98, v99
  v_mfma_f32_16x16x32_bf16 a[16:19], a[168:171], v[0:3], a[16:19]
  v_exp_f32 v104, v104
  v_mfma_f32_16x16x32_bf16 a[16:19], a[172:175], v[32:35], a[16:19]
  ds_read_b64_tr_b16 a[184:185], v219 offset:32768
  v_mfma_f32_16x16x32_bf16 a[20:23], a[172:175], v[40:43], a[20:23]
  v_exp_f32 v105, v105
  v_mfma_f32_16x16x32_bf16 a[20:23], a[168:171], v[8:11], a[20:23]
  ds_read_b64_tr_b16 a[186:187], v219 offset:36864
  v_cvt_pk_bf16_f32 v104, v104, v105
  v_mfma_f32_16x16x32_bf16 a[24:27], a[168:171], v[16:19], a[24:27]
  v_exp_f32 v106, v106
  v_mfma_f32_16x16x32_bf16 a[24:27], a[172:175], v[48:51], a[24:27]
  ds_read_b64_tr_b16 a[188:189], v219 offset:40960
  v_mfma_f32_16x16x32_bf16 a[28:31], a[172:175], v[56:59], a[28:31]
  s_waitcnt lgkmcnt(3)
  v_exp_f32 v107, v107
  v_mfma_f32_16x16x32_bf16 a[28:31], a[168:171], v[24:27], a[28:31]
  ds_read_b64_tr_b16 a[190:191], v219 offset:45056
  v_cvt_pk_bf16_f32 v105, v106, v107
  v_mfma_f32_16x16x32_bf16 a[32:35], a[176:179], v[0:3], a[32:35]
  v_exp_f32 v112, v112
  v_mfma_f32_16x16x32_bf16 a[32:35], a[180:183], v[32:35], a[32:35]
  ds_read_b64_tr_b16 a[160:161], v220 offset:32768
  v_mfma_f32_16x16x32_bf16 a[36:39], a[180:183], v[40:43], a[36:39]
  v_exp_f32 v113, v113
  v_mfma_f32_16x16x32_bf16 a[36:39], a[176:179], v[8:11], a[36:39]
  ds_read_b64_tr_b16 a[162:163], v220 offset:36864
  v_cvt_pk_bf16_f32 v112, v112, v113
  v_mfma_f32_16x16x32_bf16 a[40:43], a[176:179], v[16:19], a[40:43]
  v_exp_f32 v114, v114
  v_mfma_f32_16x16x32_bf16 a[40:43], a[180:183], v[48:51], a[40:43]
  ds_read_b64_tr_b16 a[164:165], v220 offset:40960
  v_mfma_f32_16x16x32_bf16 a[44:47], a[180:183], v[56:59], a[44:47]
  s_waitcnt lgkmcnt(3)
  v_exp_f32 v115, v115
  v_mfma_f32_16x16x32_bf16 a[44:47], a[176:179], v[24:27], a[44:47]
  ds_read_b64_tr_b16 a[166:167], v220 offset:45056
  v_cvt_pk_bf16_f32 v113, v114, v115
  v_mfma_f32_16x16x32_bf16 a[48:51], a[184:187], v[0:3], a[48:51]
  v_exp_f32 v120, v120
  v_mfma_f32_16x16x32_bf16 a[48:51], a[188:191], v[32:35], a[48:51]
  ds_read_b64_tr_b16 a[168:169], v221 offset:32768
  v_mfma_f32_16x16x32_bf16 a[52:55], a[188:191], v[40:43], a[52:55]
  v_exp_f32 v121, v121
  v_mfma_f32_16x16x32_bf16 a[52:55], a[184:187], v[8:11], a[52:55]
  ds_read_b64_tr_b16 a[170:171], v221 offset:36864
  v_cvt_pk_bf16_f32 v120, v120, v121
  v_mfma_f32_16x16x32_bf16 a[56:59], a[184:187], v[16:19], a[56:59]
  v_exp_f32 v122, v122
  v_mfma_f32_16x16x32_bf16 a[56:59], a[188:191], v[48:51], a[56:59]
  ds_read_b64_tr_b16 a[172:173], v221 offset:40960
  v_mfma_f32_16x16x32_bf16 a[60:63], a[188:191], v[56:59], a[60:63]
  s_waitcnt lgkmcnt(3)
  v_exp_f32 v123, v123
  v_mfma_f32_16x16x32_bf16 a[60:63], a[184:187], v[24:27], a[60:63]
  ds_read_b64_tr_b16 a[174:175], v221 offset:45056
  v_cvt_pk_bf16_f32 v121, v122, v123
  v_mfma_f32_16x16x32_bf16 a[64:67], a[160:163], v[0:3], a[64:67]
  v_exp_f32 v100, v100
  v_mfma_f32_16x16x32_bf16 a[64:67], a[164:167], v[32:35], a[64:67]
  ds_read_b64_tr_b16 a[176:177], v222 offset:32768
  v_mfma_f32_16x16x32_bf16 a[68:71], a[164:167], v[40:43], a[68:71]
  v_exp_f32 v101, v101
  v_mfma_f32_16x16x32_bf16 a[68:71], a[160:163], v[8:11], a[68:71]
  ds_read_b64_tr_b16 a[178:179], v222 offset:36864
  v_cvt_pk_bf16_f32 v98, v100, v101
  v_mfma_f32_16x16x32_bf16 a[72:75], a[160:163], v[16:19], a[72:75]
  v_exp_f32 v102, v102
  v_mfma_f32_16x16x32_bf16 a[72:75], a[164:167], v[48:51], a[72:75]
  ds_read_b64_tr_b16 a[180:181], v222 offset:40960
  v_mfma_f32_16x16x32_bf16 a[76:79], a[164:167], v[56:59], a[76:79]
  s_waitcnt lgkmcnt(3)
  v_exp_f32 v103, v103
  v_mfma_f32_16x16x32_bf16 a[76:79], a[160:163], v[24:27], a[76:79]
  ds_read_b64_tr_b16 a[182:183], v222 offset:45056
  v_cvt_pk_bf16_f32 v99, v102, v103
  v_mfma_f32_16x16x32_bf16 a[80:83], a[168:171], v[0:3], a[80:83]
  v_exp_f32 v108, v108
  v_mfma_f32_16x16x32_bf16 a[80:83], a[172:175], v[32:35], a[80:83]
  ds_read_b64_tr_b16 a[184:185], v223 offset:32768
  v_mfma_f32_16x16x32_bf16 a[84:87], a[172:175], v[40:43], a[84:87]
  v_exp_f32 v109, v109
  v_mfma_f32_16x16x32_bf16 a[84:87], a[168:171], v[8:11], a[84:87]
  ds_read_b64_tr_b16 a[186:187], v223 offset:36864
  v_cvt_pk_bf16_f32 v106, v108, v109
  v_mfma_f32_16x16x32_bf16 a[88:91], a[168:171], v[16:19], a[88:91]
  v_exp_f32 v110, v110
  v_mfma_f32_16x16x32_bf16 a[88:91], a[172:175], v[48:51], a[88:91]
  ds_read_b64_tr_b16 a[188:189], v223 offset:40960
  v_mfma_f32_16x16x32_bf16 a[92:95], a[172:175], v[56:59], a[92:95]
  s_waitcnt lgkmcnt(3)
  v_exp_f32 v111, v111
  v_mfma_f32_16x16x32_bf16 a[92:95], a[168:171], v[24:27], a[92:95]
  ds_read_b64_tr_b16 a[190:191], v223 offset:45056
  v_cvt_pk_bf16_f32 v107, v110, v111
  v_mfma_f32_16x16x32_bf16 a[96:99], a[176:179], v[0:3], a[96:99]
  s_waitcnt vmcnt(10)
  v_exp_f32 v116, v116
  v_mfma_f32_16x16x32_bf16 a[96:99], a[180:183], v[32:35], a[96:99]
  v_mfma_f32_16x16x32_bf16 a[100:103], a[180:183], v[40:43], a[100:103]
  s_barrier
  v_exp_f32 v117, v117
  v_mfma_f32_16x16x32_bf16 a[100:103], a[176:179], v[8:11], a[100:103]
  ds_read_b128 a[128:131], v212 offset:0
  v_cvt_pk_bf16_f32 v114, v116, v117
  v_mfma_f32_16x16x32_bf16 a[104:107], a[176:179], v[16:19], a[104:107]
  v_exp_f32 v118, v118
  v_mfma_f32_16x16x32_bf16 a[104:107], a[180:183], v[48:51], a[104:107]
  ds_read_b128 a[132:135], v213 offset:0
  v_mfma_f32_16x16x32_bf16 a[108:111], a[180:183], v[56:59], a[108:111]
  s_waitcnt lgkmcnt(2)
  v_exp_f32 v119, v119
  v_mfma_f32_16x16x32_bf16 a[108:111], a[176:179], v[24:27], a[108:111]
  ds_read_b128 a[136:139], v214 offset:0
  v_cvt_pk_bf16_f32 v115, v118, v119
  v_mfma_f32_16x16x32_bf16 a[112:115], a[184:187], v[0:3], a[112:115]
  v_exp_f32 v124, v124
  v_mfma_f32_16x16x32_bf16 a[112:115], a[188:191], v[32:35], a[112:115]
  ds_read_b128 a[140:143], v215 offset:0
  v_mfma_f32_16x16x32_bf16 a[116:119], a[188:191], v[40:43], a[116:119]
  s_sub_u32 s32, s32, 1
  v_exp_f32 v125, v125
  v_mfma_f32_16x16x32_bf16 a[116:119], a[184:187], v[8:11], a[116:119]
  v_cvt_pk_bf16_f32 v122, v124, v125
  v_mfma_f32_16x16x32_bf16 a[120:123], a[184:187], v[16:19], a[120:123]
  s_cmp_lg_u32 s32, 0
  v_exp_f32 v126, v126
  v_mfma_f32_16x16x32_bf16 a[120:123], a[188:191], v[48:51], a[120:123]
  v_mfma_f32_16x16x32_bf16 a[124:127], a[188:191], v[56:59], a[124:127]
  s_waitcnt lgkmcnt(0)
  v_exp_f32 v127, v127
  v_mfma_f32_16x16x32_bf16 a[124:127], a[184:187], v[24:27], a[124:127]
  v_cvt_pk_bf16_f32 v123, v126, v127
  s_cbranch_scc1 attn_loop
  ds_read_b64_tr_b16 a[160:161], v216 offset:49152
  ds_read_b64_tr_b16 a[162:163], v216 offset:53248
  ds_read_b64_tr_b16 a[164:165], v216 offset:57344
  ds_read_b64_tr_b16 a[166:167], v216 offset:61440
  ds_read_b64_tr_b16 a[168:169], v217 offset:49152
  ds_read_b64_tr_b16 a[170:171], v217 offset:53248
  ds_read_b64_tr_b16 a[172:173], v217 offset:57344
  ds_read_b64_tr_b16 a[174:175], v217 offset:61440
  s_waitcnt vmcnt(8)
  v_readfirstlane_b32 s38, v254
  s_nop 0
  s_cmp_ge_u32 s38, 256
  s_cbranch_scc1 attn_h_ready
  s_mov_b32 s39, 0x100000
attn_spin:
  s_sleep 4
  buffer_load_dword v254, off, s[44:47], 0 sc1
  s_waitcnt vmcnt(0)
  v_readfirstlane_b32 s38, v254
  s_nop 0
  s_cmp_ge_u32 s38, 256
  s_cbranch_scc1 attn_h_ready
  s_sub_u32 s39, s39, 1
  s_cmp_lg_u32 s39, 0
  s_cbranch_scc1 attn_spin
attn_h_ready:
  s_mov_b32 s48, 0x5d800000
  s_lshl_b32 s39, s3, 8
  v_mfma_f32_16x16x32_bf16 a[192:195], a[208:211], v[64:67], a[192:195]
  v_lshrrev_b32 v224, 4, v242
  v_and_b32 v225, 7, v224
  v_mfma_f32_16x16x32_bf16 a[192:195], a[208:211], v[96:99], a[192:195]
  v_mul_u32_u24 v225, 0xd80, v225
  v_lshrrev_b32 v224, 4, v224
  v_mfma_f32_16x16x32_bf16 a[196:199], a[208:211], v[72:75], a[196:199]
  v_lshl_add_u32 v225, v224, 4, v225
  v_mfma_f32_16x16x32_bf16 a[196:199], a[208:211], v[104:107], a[196:199]
  buffer_load_dwordx4 a[212:215], v225, s[24:27], s101 offen offset:0 sc1
  v_mfma_f32_16x16x32_bf16 a[200:203], a[208:211], v[80:83], a[200:203]
  buffer_load_dwordx4 a[216:219], v225, s[24:27], s101 offen offset:64 sc1
  v_mfma_f32_16x16x32_bf16 a[200:203], a[208:211], v[112:115], a[200:203]
  buffer_load_dwordx4 a[220:223], v225, s[24:27], s101 offen offset:128 sc1
  v_mfma_f32_16x16x32_bf16 a[204:207], a[208:211], v[88:91], a[204:207]
  v_mfma_f32_16x16x32_bf16 a[204:207], a[208:211], v[120:123], a[204:207]
  s_waitcnt lgkmcnt(4)
  v_mfma_f32_16x16x32_bf16 a[0:3], a[160:163], v[64:67], a[0:3]
  v_mfma_f32_16x16x32_bf16 a[0:3], a[164:167], v[96:99], a[0:3]
  ds_read_b64_tr_b16 a[176:177], v218 offset:49152
  v_mfma_f32_16x16x32_bf16 a[4:7], a[164:167], v[104:107], a[4:7]
  v_mfma_f32_16x16x32_bf16 a[4:7], a[160:163], v[72:75], a[4:7]
  ds_read_b64_tr_b16 a[178:179], v218 offset:53248
  v_accvgpr_read_b32 v208, a192
  v_mfma_f32_16x16x32_bf16 a[8:11], a[160:163], v[80:83], a[8:11]
  v_accvgpr_read_b32 v209, a196
  v_accvgpr_read_b32 v210, a200
  v_mfma_f32_16x16x32_bf16 a[8:11], a[164:167], v[112:115], a[8:11]
  ds_read_b64_tr_b16 a[180:181], v218 offset:57344
  v_accvgpr_read_b32 v211, a204
  v_mfma_f32_16x16x32_bf16 a[12:15], a[164:167], v[120:123], a[12:15]
  v_mov_b32 v245, v208
  v_mov_b32 v246, v209
  v_mfma_f32_16x16x32_bf16 a[12:15], a[160:163], v[88:91], a[12:15]
  ds_read_b64_tr_b16 a[182:183], v218 offset:61440
  s_waitcnt lgkmcnt(4)
  v_mov_b32 v247, v210
  v_mfma_f32_16x16x32_bf16 a[16:19], a[168:171], v[64:67], a[16:19]
  v_mov_b32 v248, v211
  v_permlane16_swap_b32 v208, v245
  v_mfma_f32_16x16x32_bf16 a[16:19], a[172:175], v[96:99], a[16:19]
  ds_read_b64_tr_b16 a[184:185], v219 offset:49152
  v_permlane16_swap_b32 v209, v246
  v_mfma_f32_16x16x32_bf16 a[20:23], a[172:175], v[104:107], a[20:23]
  v_permlane16_swap_b32 v210, v247
  v_permlane16_swap_b32 v211, v248
  v_mfma_f32_16x16x32_bf16 a[20:23], a[168:171], v[72:75], a[20:23]
  ds_read_b64_tr_b16 a[186:187], v219 offset:53248
  v_add_f32 v208, v208, v245
  v_mfma_f32_16x16x32_bf16 a[24:27], a[168:171], v[80:83], a[24:27]
  v_add_f32 v209, v209, v246
  v_add_f32 v210, v210, v247
  v_mfma_f32_16x16x32_bf16 a[24:27], a[172:175], v[112:115], a[24:27]
  ds_read_b64_tr_b16 a[188:189], v219 offset:57344
  v_add_f32 v211, v211, v248
  v_mfma_f32_16x16x32_bf16 a[28:31], a[172:175], v[120:123], a[28:31]
  v_mov_b32 v245, v208
  v_mov_b32 v246, v209
  v_mfma_f32_16x16x32_bf16 a[28:31], a[168:171], v[88:91], a[28:31]
  ds_read_b64_tr_b16 a[190:191], v219 offset:61440
  s_waitcnt lgkmcnt(4)
  v_mov_b32 v247, v210
  v_mfma_f32_16x16x32_bf16 a[32:35], a[176:179], v[64:67], a[32:35]
  v_mov_b32 v248, v211
  v_permlane32_swap_b32 v208, v245
  v_mfma_f32_16x16x32_bf16 a[32:35], a[180:183], v[96:99], a[32:35]
  ds_read_b64_tr_b16 a[160:161], v220 offset:49152
  v_permlane32_swap_b32 v209, v246
  v_mfma_f32_16x16x32_bf16 a[36:39], a[180:183], v[104:107], a[36:39]
  v_permlane32_swap_b32 v210, v247
  v_permlane32_swap_b32 v211, v248
  v_mfma_f32_16x16x32_bf16 a[36:39], a[176:179], v[72:75], a[36:39]
  ds_read_b64_tr_b16 a[162:163], v220 offset:53248
  v_add_f32 v208, v208, v245
  v_mfma_f32_16x16x32_bf16 a[40:43], a[176:179], v[80:83], a[40:43]
  v_add_f32 v209, v209, v246
  v_add_f32 v210, v210, v247
  v_mfma_f32_16x16x32_bf16 a[40:43], a[180:183], v[112:115], a[40:43]
  ds_read_b64_tr_b16 a[164:165], v220 offset:57344
  v_add_f32 v211, v211, v248
  v_mfma_f32_16x16x32_bf16 a[44:47], a[180:183], v[120:123], a[44:47]
  v_rcp_f32 v192, v208
  v_mfma_f32_16x16x32_bf16 a[44:47], a[176:179], v[88:91], a[44:47]
  ds_read_b64_tr_b16 a[166:167], v220 offset:61440
  s_waitcnt lgkmcnt(4)
  v_mfma_f32_16x16x32_bf16 a[48:51], a[184:187], v[64:67], a[48:51]
  v_rcp_f32 v196, v209
  v_mfma_f32_16x16x32_bf16 a[48:51], a[188:191], v[96:99], a[48:51]
  ds_read_b64_tr_b16 a[168:169], v221 offset:49152
  v_mfma_f32_16x16x32_bf16 a[52:55], a[188:191], v[104:107], a[52:55]
  v_rcp_f32 v200, v210
  v_mfma_f32_16x16x32_bf16 a[52:55], a[184:187], v[72:75], a[52:55]
  ds_read_b64_tr_b16 a[170:171], v221 offset:53248
  v_mfma_f32_16x16x32_bf16 a[56:59], a[184:187], v[80:83], a[56:59]
  v_rcp_f32 v204, v211
  v_mfma_f32_16x16x32_bf16 a[56:59], a[188:191], v[112:115], a[56:59]
  ds_read_b64_tr_b16 a[172:173], v221 offset:57344
  v_add_f32 v246, v208, v209
  v_mfma_f32_16x16x32_bf16 a[60:63], a[188:191], v[120:123], a[60:63]
  v_add_f32 v247, v210, v211
  v_add_f32 v246, v246, v247
  v_mfma_f32_16x16x32_bf16 a[60:63], a[184:187], v[88:91], a[60:63]
  ds_read_b64_tr_b16 a[174:175], v221 offset:61440
  s_waitcnt lgkmcnt(4)
  v_lshrrev_b32 v247, 2, v242
  v_mfma_f32_16x16x32_bf16 a[64:67], a[160:163], v[64:67], a[64:67]
  v_cmp_nlt_f32 vcc, v246, s48
  v_add_u32 v247, s39, v247
  v_mfma_f32_16x16x32_bf16 a[64:67], a[164:167], v[96:99], a[64:67]
  ds_read_b64_tr_b16 a[176:177], v222 offset:49152
  v_add_u32 v247, 131072, v247
  v_mfma_f32_16x16x32_bf16 a[68:71], a[164:167], v[104:107], a[68:71]
  v_cndmask_b32_e64 v245, 0, 1, vcc
  v_accvgpr_read_b32 v0, a0
  v_mfma_f32_16x16x32_bf16 a[68:71], a[160:163], v[72:75], a[68:71]
  ds_read_b64_tr_b16 a[178:179], v222 offset:53248
  v_accvgpr_read_b32 v1, a1
  v_mfma_f32_16x16x32_bf16 a[72:75], a[160:163], v[80:83], a[72:75]
  v_accvgpr_read_b32 v2, a2
  v_accvgpr_read_b32 v3, a3
  v_mfma_f32_16x16x32_bf16 a[72:75], a[164:167], v[112:115], a[72:75]
  ds_read_b64_tr_b16 a[180:181], v222 offset:57344
  v_accvgpr_read_b32 v4, a16
  v_mfma_f32_16x16x32_bf16 a[76:79], a[164:167], v[120:123], a[76:79]
  v_accvgpr_read_b32 v5, a17
  v_accvgpr_read_b32 v6, a18
  v_mfma_f32_16x16x32_bf16 a[76:79], a[160:163], v[88:91], a[76:79]
  ds_read_b64_tr_b16 a[182:183], v222 offset:61440
  s_waitcnt lgkmcnt(4)
  v_accvgpr_read_b32 v7, a19
  v_mfma_f32_16x16x32_bf16 a[80:83], a[168:171], v[64:67], a[80:83]
  v_mul_f32 v0, v0, v192
  v_mul_f32 v1, v1, v192
  v_mfma_f32_16x16x32_bf16 a[80:83], a[172:175], v[96:99], a[80:83]
  ds_read_b64_tr_b16 a[184:185], v223 offset:49152
  v_mul_f32 v2, v2, v192
  v_mfma_f32_16x16x32_bf16 a[84:87], a[172:175], v[104:107], a[84:87]
  v_mul_f32 v3, v3, v192
  v_mul_f32 v4, v4, v192
  v_mfma_f32_16x16x32_bf16 a[84:87], a[168:171], v[72:75], a[84:87]
  ds_read_b64_tr_b16 a[186:187], v223 offset:53248
  v_mul_f32 v5, v5, v192
  v_mfma_f32_16x16x32_bf16 a[88:91], a[168:171], v[80:83], a[88:91]
  v_mul_f32 v6, v6, v192
  v_mul_f32 v7, v7, v192
  v_mfma_f32_16x16x32_bf16 a[88:91], a[172:175], v[112:115], a[88:91]
  ds_read_b64_tr_b16 a[188:189], v223 offset:57344
  v_cvt_pk_bf16_f32 v0, v0, v1
  v_mfma_f32_16x16x32_bf16 a[92:95], a[172:175], v[120:123], a[92:95]
  v_cvt_pk_bf16_f32 v1, v2, v3
  v_cvt_pk_bf16_f32 v2, v4, v5
  v_mfma_f32_16x16x32_bf16 a[92:95], a[168:171], v[88:91], a[92:95]
  ds_read_b64_tr_b16 a[190:191], v223 offset:61440
  s_waitcnt lgkmcnt(4)
  v_cvt_pk_bf16_f32 v3, v6, v7
  v_mfma_f32_16x16x32_bf16 a[96:99], a[176:179], v[64:67], a[96:99]
  buffer_store_dwordx4 v[0:3], v244, s[24:27], s40 offen offset:0
  v_mfma_f32_16x16x32_bf16 a[96:99], a[180:183], v[96:99], a[96:99]
  v_accvgpr_read_b32 v8, a4
  v_accvgpr_read_b32 v9, a5
  v_mfma_f32_16x16x32_bf16 a[100:103], a[180:183], v[104:107], a[100:103]
  v_accvgpr_read_b32 v10, a6
  v_accvgpr_read_b32 v11, a7
  v_mfma_f32_16x16x32_bf16 a[100:103], a[176:179], v[72:75], a[100:103]
  v_accvgpr_read_b32 v12, a20
  v_accvgpr_read_b32 v13, a21
  v_mfma_f32_16x16x32_bf16 a[104:107], a[176:179], v[80:83], a[104:107]
  v_accvgpr_read_b32 v14, a22
  v_accvgpr_read_b32 v15, a23
  v_mfma_f32_16x16x32_bf16 a[104:107], a[180:183], v[112:115], a[104:107]
  v_mul_f32 v8, v8, v196
  v_mul_f32 v9, v9, v196
  v_mfma_f32_16x16x32_bf16 a[108:111], a[180:183], v[120:123], a[108:111]
  v_mul_f32 v10, v10, v196
  v_mul_f32 v11, v11, v196
  v_mfma_f32_16x16x32_bf16 a[108:111], a[176:179], v[88:91], a[108:111]
  s_waitcnt lgkmcnt(0)
  v_mul_f32 v12, v12, v196
  v_mul_f32 v13, v13, v196
  v_mfma_f32_16x16x32_bf16 a[112:115], a[184:187], v[64:67], a[112:115]
  v_mul_f32 v14, v14, v196
  v_mul_f32 v15, v15, v196
  v_mfma_f32_16x16x32_bf16 a[112:115], a[188:191], v[96:99], a[112:115]
  v_cvt_pk_bf16_f32 v8, v8, v9
  v_cvt_pk_bf16_f32 v9, v10, v11
  v_mfma_f32_16x16x32_bf16 a[116:119], a[188:191], v[104:107], a[116:119]
  v_cvt_pk_bf16_f32 v10, v12, v13
  v_cvt_pk_bf16_f32 v11, v14, v15
  v_mfma_f32_16x16x32_bf16 a[116:119], a[184:187], v[72:75], a[116:119]
  buffer_store_dwordx4 v[8:11], v244, s[24:27], s40 offen offset:2048
  v_mfma_f32_16x16x32_bf16 a[120:123], a[184:187], v[80:83], a[120:123]
  v_accvgpr_read_b32 v16, a8
  v_accvgpr_read_b32 v17, a9
  v_mfma_f32_16x16x32_bf16 a[120:123], a[188:191], v[112:115], a[120:123]
  v_accvgpr_read_b32 v18, a10
  v_accvgpr_read_b32 v19, a11
  v_mfma_f32_16x16x32_bf16 a[124:127], a[188:191], v[120:123], a[124:127]
  v_accvgpr_read_b32 v20, a24
  v_accvgpr_read_b32 v21, a25
  v_mfma_f32_16x16x32_bf16 a[124:127], a[184:187], v[88:91], a[124:127]
  v_accvgpr_read_b32 v22, a26
  v_accvgpr_read_b32 v23, a27
  v_mul_f32 v16, v16, v200
  v_mul_f32 v17, v17, v200
  v_mul_f32 v18, v18, v200
  v_mul_f32 v19, v19, v200
  v_mul_f32 v20, v20, v200
  v_mul_f32 v21, v21, v200
  v_mul_f32 v22, v22, v200
  v_mul_f32 v23, v23, v200
  v_cvt_pk_bf16_f32 v16, v16, v17
  v_cvt_pk_bf16_f32 v17, v18, v19
  v_cvt_pk_bf16_f32 v18, v20, v21
  v_cvt_pk_bf16_f32 v19, v22, v23
  buffer_store_dwordx4 v[16:19], v244, s[24:27], s41 offen offset:0
  v_accvgpr_read_b32 v24, a12
  v_accvgpr_read_b32 v25, a13
  v_accvgpr_read_b32 v26, a14
  v_accvgpr_read_b32 v27, a15
  v_accvgpr_read_b32 v28, a28
  v_accvgpr_read_b32 v29, a29
  v_accvgpr_read_b32 v30, a30
  v_accvgpr_read_b32 v31, a31
  v_mul_f32 v24, v24, v204
  v_mul_f32 v25, v25, v204
  v_mul_f32 v26, v26, v204
  v_mul_f32 v27, v27, v204
  v_mul_f32 v28, v28, v204
  v_mul_f32 v29, v29, v204
  v_mul_f32 v30, v30, v204
  v_mul_f32 v31, v31, v204
  v_cvt_pk_bf16_f32 v24, v24, v25
  v_cvt_pk_bf16_f32 v25, v26, v27
  v_cvt_pk_bf16_f32 v26, v28, v29
  v_cvt_pk_bf16_f32 v27, v30, v31
  buffer_store_dwordx4 v[24:27], v244, s[24:27], s41 offen offset:2048
  v_accvgpr_read_b32 v32, a32
  v_accvgpr_read_b32 v33, a33
  v_accvgpr_read_b32 v34, a34
  v_accvgpr_read_b32 v35, a35
  v_accvgpr_read_b32 v36, a48
  v_accvgpr_read_b32 v37, a49
  v_accvgpr_read_b32 v38, a50
  v_accvgpr_read_b32 v39, a51
  v_mul_f32 v32, v32, v192
  v_mul_f32 v33, v33, v192
  v_mul_f32 v34, v34, v192
  v_mul_f32 v35, v35, v192
  v_mul_f32 v36, v36, v192
  v_mul_f32 v37, v37, v192
  v_mul_f32 v38, v38, v192
  v_mul_f32 v39, v39, v192
  v_cvt_pk_bf16_f32 v32, v32, v33
  v_cvt_pk_bf16_f32 v33, v34, v35
  v_cvt_pk_bf16_f32 v34, v36, v37
  v_cvt_pk_bf16_f32 v35, v38, v39
  buffer_store_dwordx4 v[32:35], v244, s[24:27], s40 offen offset:1024
  v_accvgpr_read_b32 v40, a36
  v_accvgpr_read_b32 v41, a37
  v_accvgpr_read_b32 v42, a38
  v_accvgpr_read_b32 v43, a39
  v_accvgpr_read_b32 v44, a52
  v_accvgpr_read_b32 v45, a53
  v_accvgpr_read_b32 v46, a54
  v_accvgpr_read_b32 v47, a55
  v_mul_f32 v40, v40, v196
  v_mul_f32 v41, v41, v196
  v_mul_f32 v42, v42, v196
  v_mul_f32 v43, v43, v196
  v_mul_f32 v44, v44, v196
  v_mul_f32 v45, v45, v196
  v_mul_f32 v46, v46, v196
  v_mul_f32 v47, v47, v196
  v_cvt_pk_bf16_f32 v40, v40, v41
  v_cvt_pk_bf16_f32 v41, v42, v43
  v_cvt_pk_bf16_f32 v42, v44, v45
  v_cvt_pk_bf16_f32 v43, v46, v47
  buffer_store_dwordx4 v[40:43], v244, s[24:27], s40 offen offset:3072
  v_accvgpr_read_b32 v48, a40
  v_accvgpr_read_b32 v49, a41
  v_accvgpr_read_b32 v50, a42
  v_accvgpr_read_b32 v51, a43
  v_accvgpr_read_b32 v52, a56
  v_accvgpr_read_b32 v53, a57
  v_accvgpr_read_b32 v54, a58
  v_accvgpr_read_b32 v55, a59
  v_mul_f32 v48, v48, v200
  v_mul_f32 v49, v49, v200
  v_mul_f32 v50, v50, v200
  v_mul_f32 v51, v51, v200
  v_mul_f32 v52, v52, v200
  v_mul_f32 v53, v53, v200
  v_mul_f32 v54, v54, v200
  v_mul_f32 v55, v55, v200
  v_cvt_pk_bf16_f32 v48, v48, v49
  v_cvt_pk_bf16_f32 v49, v50, v51
  v_cvt_pk_bf16_f32 v50, v52, v53
  v_cvt_pk_bf16_f32 v51, v54, v55
  buffer_store_dwordx4 v[48:51], v244, s[24:27], s41 offen offset:1024
  v_accvgpr_read_b32 v56, a44
  v_accvgpr_read_b32 v57, a45
  v_accvgpr_read_b32 v58, a46
  v_accvgpr_read_b32 v59, a47
  v_accvgpr_read_b32 v60, a60
  v_accvgpr_read_b32 v61, a61
  v_accvgpr_read_b32 v62, a62
  v_accvgpr_read_b32 v63, a63
  v_mul_f32 v56, v56, v204
  v_mul_f32 v57, v57, v204
  v_mul_f32 v58, v58, v204
  v_mul_f32 v59, v59, v204
  v_mul_f32 v60, v60, v204
  v_mul_f32 v61, v61, v204
  v_mul_f32 v62, v62, v204
  v_mul_f32 v63, v63, v204
  v_cvt_pk_bf16_f32 v56, v56, v57
  v_cvt_pk_bf16_f32 v57, v58, v59
  v_cvt_pk_bf16_f32 v58, v60, v61
  v_cvt_pk_bf16_f32 v59, v62, v63
  buffer_store_dwordx4 v[56:59], v244, s[24:27], s41 offen offset:3072
  v_accvgpr_read_b32 v0, a64
  v_accvgpr_read_b32 v1, a65
  v_accvgpr_read_b32 v2, a66
  v_accvgpr_read_b32 v3, a67
  v_accvgpr_read_b32 v4, a80
  v_accvgpr_read_b32 v5, a81
  v_accvgpr_read_b32 v6, a82
  v_accvgpr_read_b32 v7, a83
  v_mul_f32 v0, v0, v192
  v_mul_f32 v1, v1, v192
  v_mul_f32 v2, v2, v192
  v_mul_f32 v3, v3, v192
  v_mul_f32 v4, v4, v192
  v_mul_f32 v5, v5, v192
  v_mul_f32 v6, v6, v192
  v_mul_f32 v7, v7, v192
  v_cvt_pk_bf16_f32 v0, v0, v1
  v_cvt_pk_bf16_f32 v1, v2, v3
  v_cvt_pk_bf16_f32 v2, v4, v5
  v_cvt_pk_bf16_f32 v3, v6, v7
  buffer_store_dwordx4 v[0:3], v244, s[24:27], s42 offen offset:0
  v_accvgpr_read_b32 v8, a68
  v_accvgpr_read_b32 v9, a69
  v_accvgpr_read_b32 v10, a70
  v_accvgpr_read_b32 v11, a71
  v_accvgpr_read_b32 v12, a84
  v_accvgpr_read_b32 v13, a85
  v_accvgpr_read_b32 v14, a86
  v_accvgpr_read_b32 v15, a87
  v_mul_f32 v8, v8, v196
  v_mul_f32 v9, v9, v196
  v_mul_f32 v10, v10, v196
  v_mul_f32 v11, v11, v196
  v_mul_f32 v12, v12, v196
  v_mul_f32 v13, v13, v196
  v_mul_f32 v14, v14, v196
  v_mul_f32 v15, v15, v196
  v_cvt_pk_bf16_f32 v8, v8, v9
  v_cvt_pk_bf16_f32 v9, v10, v11
  v_cvt_pk_bf16_f32 v10, v12, v13
  v_cvt_pk_bf16_f32 v11, v14, v15
  buffer_store_dwordx4 v[8:11], v244, s[24:27], s42 offen offset:2048
  v_accvgpr_read_b32 v16, a72
  v_accvgpr_read_b32 v17, a73
  v_accvgpr_read_b32 v18, a74
  v_accvgpr_read_b32 v19, a75
  v_accvgpr_read_b32 v20, a88
  v_accvgpr_read_b32 v21, a89
  v_accvgpr_read_b32 v22, a90
  v_accvgpr_read_b32 v23, a91
  v_mul_f32 v16, v16, v200
  v_mul_f32 v17, v17, v200
  v_mul_f32 v18, v18, v200
  v_mul_f32 v19, v19, v200
  v_mul_f32 v20, v20, v200
  v_mul_f32 v21, v21, v200
  v_mul_f32 v22, v22, v200
  v_mul_f32 v23, v23, v200
  v_cvt_pk_bf16_f32 v16, v16, v17
  v_cvt_pk_bf16_f32 v17, v18, v19
  v_cvt_pk_bf16_f32 v18, v20, v21
  v_cvt_pk_bf16_f32 v19, v22, v23
  buffer_store_dwordx4 v[16:19], v244, s[24:27], s43 offen offset:0
  v_accvgpr_read_b32 v24, a76
  v_accvgpr_read_b32 v25, a77
  v_accvgpr_read_b32 v26, a78
  v_accvgpr_read_b32 v27, a79
  v_accvgpr_read_b32 v28, a92
  v_accvgpr_read_b32 v29, a93
  v_accvgpr_read_b32 v30, a94
  v_accvgpr_read_b32 v31, a95
  v_mul_f32 v24, v24, v204
  v_mul_f32 v25, v25, v204
  v_mul_f32 v26, v26, v204
  v_mul_f32 v27, v27, v204
  v_mul_f32 v28, v28, v204
  v_mul_f32 v29, v29, v204
  v_mul_f32 v30, v30, v204
  v_mul_f32 v31, v31, v204
  v_cvt_pk_bf16_f32 v24, v24, v25
  v_cvt_pk_bf16_f32 v25, v26, v27
  v_cvt_pk_bf16_f32 v26, v28, v29
  v_cvt_pk_bf16_f32 v27, v30, v31
  buffer_store_dwordx4 v[24:27], v244, s[24:27], s43 offen offset:2048
  v_accvgpr_read_b32 v32, a96
  v_accvgpr_read_b32 v33, a97
  v_accvgpr_read_b32 v34, a98
  v_accvgpr_read_b32 v35, a99
  v_accvgpr_read_b32 v36, a112
  v_accvgpr_read_b32 v37, a113
  v_accvgpr_read_b32 v38, a114
  v_accvgpr_read_b32 v39, a115
  v_mul_f32 v32, v32, v192
  v_mul_f32 v33, v33, v192
  v_mul_f32 v34, v34, v192
  v_mul_f32 v35, v35, v192
  v_mul_f32 v36, v36, v192
  v_mul_f32 v37, v37, v192
  v_mul_f32 v38, v38, v192
  v_mul_f32 v39, v39, v192
  v_cvt_pk_bf16_f32 v32, v32, v33
  v_cvt_pk_bf16_f32 v33, v34, v35
  v_cvt_pk_bf16_f32 v34, v36, v37
  v_cvt_pk_bf16_f32 v35, v38, v39
  buffer_store_dwordx4 v[32:35], v244, s[24:27], s42 offen offset:1024
  v_accvgpr_read_b32 v40, a100
  v_accvgpr_read_b32 v41, a101
  v_accvgpr_read_b32 v42, a102
  v_accvgpr_read_b32 v43, a103
  v_accvgpr_read_b32 v44, a116
  v_accvgpr_read_b32 v45, a117
  v_accvgpr_read_b32 v46, a118
  v_accvgpr_read_b32 v47, a119
  v_mul_f32 v40, v40, v196
  v_mul_f32 v41, v41, v196
  v_mul_f32 v42, v42, v196
  v_mul_f32 v43, v43, v196
  v_mul_f32 v44, v44, v196
  v_mul_f32 v45, v45, v196
  v_mul_f32 v46, v46, v196
  v_mul_f32 v47, v47, v196
  v_cvt_pk_bf16_f32 v40, v40, v41
  v_cvt_pk_bf16_f32 v41, v42, v43
  v_cvt_pk_bf16_f32 v42, v44, v45
  v_cvt_pk_bf16_f32 v43, v46, v47
  buffer_store_dwordx4 v[40:43], v244, s[24:27], s42 offen offset:3072
  v_accvgpr_read_b32 v48, a104
  v_accvgpr_read_b32 v49, a105
  v_accvgpr_read_b32 v50, a106
  v_accvgpr_read_b32 v51, a107
  v_accvgpr_read_b32 v52, a120
  v_accvgpr_read_b32 v53, a121
  v_accvgpr_read_b32 v54, a122
  v_accvgpr_read_b32 v55, a123
  v_mul_f32 v48, v48, v200
  v_mul_f32 v49, v49, v200
  v_mul_f32 v50, v50, v200
  v_mul_f32 v51, v51, v200
  v_mul_f32 v52, v52, v200
  v_mul_f32 v53, v53, v200
  v_mul_f32 v54, v54, v200
  v_mul_f32 v55, v55, v200
  v_cvt_pk_bf16_f32 v48, v48, v49
  v_cvt_pk_bf16_f32 v49, v50, v51
  v_cvt_pk_bf16_f32 v50, v52, v53
  v_cvt_pk_bf16_f32 v51, v54, v55
  buffer_store_dwordx4 v[48:51], v244, s[24:27], s43 offen offset:1024
  v_accvgpr_read_b32 v56, a108
  v_accvgpr_read_b32 v57, a109
  v_accvgpr_read_b32 v58, a110
  v_accvgpr_read_b32 v59, a111
  v_accvgpr_read_b32 v60, a124
  v_accvgpr_read_b32 v61, a125
  v_accvgpr_read_b32 v62, a126
  v_accvgpr_read_b32 v63, a127
  v_mul_f32 v56, v56, v204
  v_mul_f32 v57, v57, v204
  v_mul_f32 v58, v58, v204
  v_mul_f32 v59, v59, v204
  v_mul_f32 v60, v60, v204
  v_mul_f32 v61, v61, v204
  v_mul_f32 v62, v62, v204
  v_mul_f32 v63, v63, v204
  v_cvt_pk_bf16_f32 v56, v56, v57
  v_cvt_pk_bf16_f32 v57, v58, v59
  v_cvt_pk_bf16_f32 v58, v60, v61
  v_cvt_pk_bf16_f32 v59, v62, v63
  buffer_store_dwordx4 v[56:59], v244, s[24:27], s43 offen offset:3072
  ds_write_b32 v247, v245
  v_lshrrev_b32 v224, 4, v242
  v_lshrrev_b32 v225, 4, v224
  v_bfe_u32 v226, v224, 2, 2
  v_lshl_add_u32 v225, v225, 3, v226
  v_lshlrev_b32 v225, 5, v225
  v_and_b32 v226, 3, v224
  v_lshl_add_u32 v225, v226, 3, v225
  v_add_u32 v225, s50, v225
  s_waitcnt vmcnt(16)
  ds_read_b64_tr_b16 a[232:233], v225 offset:0
  ds_read_b64_tr_b16 a[234:235], v225 offset:128
  ds_read_b64_tr_b16 a[236:237], v225 offset:1024
  ds_read_b64_tr_b16 a[238:239], v225 offset:1152
  ds_read_b64_tr_b16 a[240:241], v225 offset:2048
  ds_read_b64_tr_b16 a[242:243], v225 offset:2176
  s_waitcnt lgkmcnt(0)
  v_mfma_f32_16x16x32_bf16 v[228:231], a[232:235], a[212:215], 0
  v_mfma_f32_16x16x32_bf16 v[228:231], a[236:239], a[216:219], v[228:231]
  v_mfma_f32_16x16x32_bf16 v[228:231], a[240:243], a[220:223], v[228:231]
  s_lshl_b32 s35, s3, 10
  s_add_u32 s35, s35, 133120
  v_add_u32 v224, s35, v242
  s_nop 4
  ds_write_b128 v224, v[228:231]
  s_waitcnt lgkmcnt(0)
  v_lshlrev_b32 v246, 0, v242
  v_add_u32 v246, 131072, v246
  s_waitcnt lgkmcnt(0)
  s_barrier
  ds_read_b128 v[248:251], v246
  v_add_u32 v224, 133120, v242
  ds_read_b128 v[64:67], v224 offset:0
  ds_read_b128 v[68:71], v224 offset:1024
  ds_read_b128 v[72:75], v224 offset:2048
  v_lshrrev_b32 v224, 4, v242
  s_cmp_eq_u32 s3, 0
  s_cselect_b32 s35, 0, 1073741824
  v_and_b32 v225, 7, v224
  v_mul_u32_u24 v225, 0xa00, v225
  v_lshrrev_b32 v226, 4, v224
  v_lshl_add_u32 v225, v226, 4, v225
  v_bfe_u32 v226, v224, 3, 1
  v_lshl_add_u32 v225, v226, 30, v225
  v_or_b32 v225, s35, v225
  s_mul_i32 s35, s98, 20480
  s_lshl_b32 s38, s99, 6
  s_add_u32 s35, s35, s38
  s_add_u32 s35, s35, 2686976
  s_waitcnt lgkmcnt(1)
  v_add_f32 v64, v64, v68
  v_add_f32 v65, v65, v69
  v_add_f32 v66, v66, v70
  v_add_f32 v67, v67, v71
  s_waitcnt lgkmcnt(0)
  v_add_f32 v64, v64, v72
  v_add_f32 v65, v65, v73
  v_add_f32 v66, v66, v74
  v_add_f32 v67, v67, v75
  buffer_store_dwordx4 v[64:67], v225, s[24:27], s35 offen
  v_or3_b32 v248, v248, v249, v250
  v_or_b32 v248, v248, v251
  v_cmp_ne_u32 vcc, 0, v248
  s_nop 0
  s_cbranch_vccz attn_end
  s_waitcnt vmcnt(0)
  v_accvgpr_write_b32 a0, 0
  v_accvgpr_write_b32 a1, 0
  v_accvgpr_write_b32 a2, 0
  v_accvgpr_write_b32 a3, 0
  v_accvgpr_write_b32 a4, 0
  v_accvgpr_write_b32 a5, 0
  v_accvgpr_write_b32 a6, 0
  v_accvgpr_write_b32 a7, 0
  v_accvgpr_write_b32 a8, 0
  v_accvgpr_write_b32 a9, 0
  v_accvgpr_write_b32 a10, 0
  v_accvgpr_write_b32 a11, 0
  v_accvgpr_write_b32 a12, 0
  v_accvgpr_write_b32 a13, 0
  v_accvgpr_write_b32 a14, 0
  v_accvgpr_write_b32 a15, 0
  v_accvgpr_write_b32 a16, 0
  v_accvgpr_write_b32 a17, 0
  v_accvgpr_write_b32 a18, 0
  v_accvgpr_write_b32 a19, 0
  v_accvgpr_write_b32 a20, 0
  v_accvgpr_write_b32 a21, 0
  v_accvgpr_write_b32 a22, 0
  v_accvgpr_write_b32 a23, 0
  v_accvgpr_write_b32 a24, 0
  v_accvgpr_write_b32 a25, 0
  v_accvgpr_write_b32 a26, 0
  v_accvgpr_write_b32 a27, 0
  v_accvgpr_write_b32 a28, 0
  v_accvgpr_write_b32 a29, 0
  v_accvgpr_write_b32 a30, 0
  v_accvgpr_write_b32 a31, 0
  v_accvgpr_write_b32 a32, 0
  v_accvgpr_write_b32 a33, 0
  v_accvgpr_write_b32 a34, 0
  v_accvgpr_write_b32 a35, 0
  v_accvgpr_write_b32 a36, 0
  v_accvgpr_write_b32 a37, 0
  v_accvgpr_write_b32 a38, 0
  v_accvgpr_write_b32 a39, 0
  v_accvgpr_write_b32 a40, 0
  v_accvgpr_write_b32 a41, 0
  v_accvgpr_write_b32 a42, 0
  v_accvgpr_write_b32 a43, 0
  v_accvgpr_write_b32 a44, 0
  v_accvgpr_write_b32 a45, 0
  v_accvgpr_write_b32 a46, 0
  v_accvgpr_write_b32 a47, 0
  v_accvgpr_write_b32 a48, 0
  v_accvgpr_write_b32 a49, 0
  v_accvgpr_write_b32 a50, 0
  v_accvgpr_write_b32 a51, 0
  v_accvgpr_write_b32 a52, 0
  v_accvgpr_write_b32 a53, 0
  v_accvgpr_write_b32 a54, 0
  v_accvgpr_write_b32 a55, 0
  v_accvgpr_write_b32 a56, 0
  v_accvgpr_write_b32 a57, 0
  v_accvgpr_write_b32 a58, 0
  v_accvgpr_write_b32 a59, 0
  v_accvgpr_write_b32 a60, 0
  v_accvgpr_write_b32 a61, 0
  v_accvgpr_write_b32 a62, 0
  v_accvgpr_write_b32 a63, 0
  v_accvgpr_write_b32 a64, 0
  v_accvgpr_write_b32 a65, 0
  v_accvgpr_write_b32 a66, 0
  v_accvgpr_write_b32 a67, 0
  v_accvgpr_write_b32 a68, 0
  v_accvgpr_write_b32 a69, 0
  v_accvgpr_write_b32 a70, 0
  v_accvgpr_write_b32 a71, 0
  v_accvgpr_write_b32 a72, 0
  v_accvgpr_write_b32 a73, 0
  v_accvgpr_write_b32 a74, 0
  v_accvgpr_write_b32 a75, 0
  v_accvgpr_write_b32 a76, 0
  v_accvgpr_write_b32 a77, 0
  v_accvgpr_write_b32 a78, 0
  v_accvgpr_write_b32 a79, 0
  v_accvgpr_write_b32 a80, 0
  v_accvgpr_write_b32 a81, 0
  v_accvgpr_write_b32 a82, 0
  v_accvgpr_write_b32 a83, 0
  v_accvgpr_write_b32 a84, 0
  v_accvgpr_write_b32 a85, 0
  v_accvgpr_write_b32 a86, 0
  v_accvgpr_write_b32 a87, 0
  v_accvgpr_write_b32 a88, 0
  v_accvgpr_write_b32 a89, 0
  v_accvgpr_write_b32 a90, 0
  v_accvgpr_write_b32 a91, 0
  v_accvgpr_write_b32 a92, 0
  v_accvgpr_write_b32 a93, 0
  v_accvgpr_write_b32 a94, 0
  v_accvgpr_write_b32 a95, 0
  v_accvgpr_write_b32 a96, 0
  v_accvgpr_write_b32 a97, 0
  v_accvgpr_write_b32 a98, 0
  v_accvgpr_write_b32 a99, 0
  v_accvgpr_write_b32 a100, 0
  v_accvgpr_write_b32 a101, 0
  v_accvgpr_write_b32 a102, 0
  v_accvgpr_write_b32 a103, 0
  v_accvgpr_write_b32 a104, 0
  v_accvgpr_write_b32 a105, 0
  v_accvgpr_write_b32 a106, 0
  v_accvgpr_write_b32 a107, 0
  v_accvgpr_write_b32 a108, 0
  v_accvgpr_write_b32 a109, 0
  v_accvgpr_write_b32 a110, 0
  v_accvgpr_write_b32 a111, 0
  v_accvgpr_write_b32 a112, 0
  v_accvgpr_write_b32 a113, 0
  v_accvgpr_write_b32 a114, 0
  v_accvgpr_write_b32 a115, 0
  v_accvgpr_write_b32 a116, 0
  v_accvgpr_write_b32 a117, 0
  v_accvgpr_write_b32 a118, 0
  v_accvgpr_write_b32 a119, 0
  v_accvgpr_write_b32 a120, 0
  v_accvgpr_write_b32 a121, 0
  v_accvgpr_write_b32 a122, 0
  v_accvgpr_write_b32 a123, 0
  v_accvgpr_write_b32 a124, 0
  v_accvgpr_write_b32 a125, 0
  v_accvgpr_write_b32 a126, 0
  v_accvgpr_write_b32 a127, 0
  v_mov_b32 v208, 0
  v_mov_b32 v249, 0xff800000
  v_mov_b32 v209, 0
  v_mov_b32 v250, 0xff800000
  v_mov_b32 v210, 0
  v_mov_b32 v251, 0xff800000
  v_mov_b32 v211, 0
  v_mov_b32 v252, 0xff800000
  s_mov_b32 s29, 0
attn_slow:
  s_barrier
  s_add_u32 m0, s28, 0
  s_nop 0
  buffer_load_dwordx4 v232, s[12:15], s29 offen offset:0 lds
  buffer_load_dwordx4 v233, s[12:15], s29 offen offset:1024 lds
  buffer_load_dwordx4 v234, s[12:15], s29 offen offset:2048 lds
  buffer_load_dwordx4 v235, s[12:15], s29 offen offset:3072 lds
  s_add_u32 m0, s28, 65536
  s_nop 0
  buffer_load_dwordx4 v236, s[16:19], s29 offen offset:0 lds
  buffer_load_dwordx4 v237, s[16:19], s29 offen offset:1024 lds
  buffer_load_dwordx4 v236, s[16:19], s29 offen offset:2048 lds
  buffer_load_dwordx4 v237, s[16:19], s29 offen offset:3072 lds
  s_waitcnt vmcnt(0)
  s_barrier
  ds_read_b128 a[128:131], v212 offset:0
  ds_read_b128 a[132:135], v213 offset:0
  ds_read_b128 a[136:139], v214 offset:0
  ds_read_b128 a[140:143], v215 offset:0
  s_waitcnt lgkmcnt(3)
  v_mfma_f32_16x16x32_bf16 v[0:3], a[128:131], v[128:131], 0
  s_waitcnt lgkmcnt(2)
  v_mfma_f32_16x16x32_bf16 v[0:3], a[132:135], v[132:135], v[0:3]
  s_waitcnt lgkmcnt(1)
  v_mfma_f32_16x16x32_bf16 v[0:3], a[136:139], v[136:139], v[0:3]
  s_waitcnt lgkmcnt(0)
  v_mfma_f32_16x16x32_bf16 v[0:3], a[140:143], v[140:143], v[0:3]
  v_mfma_f32_16x16x32_bf16 v[8:11], a[140:143], v[156:159], 0
  v_mfma_f32_16x16x32_bf16 v[8:11], a[136:139], v[152:155], v[8:11]
  v_mfma_f32_16x16x32_bf16 v[8:11], a[132:135], v[148:151], v[8:11]
  v_mfma_f32_16x16x32_bf16 v[8:11], a[128:131], v[144:147], v[8:11]
  v_mfma_f32_16x16x32_bf16 v[16:19], a[128:131], v[160:163], 0
  v_mfma_f32_16x16x32_bf16 v[16:19], a[132:135], v[164:167], v[16:19]
  v_mfma_f32_16x16x32_bf16 v[16:19], a[136:139], v[168:171], v[16:19]
  v_mfma_f32_16x16x32_bf16 v[16:19], a[140:143], v[172:175], v[16:19]
  v_mfma_f32_16x16x32_bf16 v[24:27], a[140:143], v[188:191], 0
  v_mfma_f32_16x16x32_bf16 v[24:27], a[136:139], v[184:187], v[24:27]
  v_mfma_f32_16x16x32_bf16 v[24:27], a[132:135], v[180:183], v[24:27]
  v_mfma_f32_16x16x32_bf16 v[24:27], a[128:131], v[176:179], v[24:27]
  ds_read_b128 a[144:147], v212 offset:4096
  ds_read_b128 a[148:151], v213 offset:4096
  ds_read_b128 a[152:155], v214 offset:4096
  ds_read_b128 a[156:159], v215 offset:4096
  s_waitcnt lgkmcnt(3)
  v_mfma_f32_16x16x32_bf16 v[4:7], a[144:147], v[128:131], 0
  s_waitcnt lgkmcnt(2)
  v_mfma_f32_16x16x32_bf16 v[4:7], a[148:151], v[132:135], v[4:7]
  s_waitcnt lgkmcnt(1)
  v_mfma_f32_16x16x32_bf16 v[4:7], a[152:155], v[136:139], v[4:7]
  s_waitcnt lgkmcnt(0)
  v_mfma_f32_16x16x32_bf16 v[4:7], a[156:159], v[140:143], v[4:7]
  v_mfma_f32_16x16x32_bf16 v[12:15], a[156:159], v[156:159], 0
  v_mfma_f32_16x16x32_bf16 v[12:15], a[152:155], v[152:155], v[12:15]
  v_mfma_f32_16x16x32_bf16 v[12:15], a[148:151], v[148:151], v[12:15]
  v_mfma_f32_16x16x32_bf16 v[12:15], a[144:147], v[144:147], v[12:15]
  v_mfma_f32_16x16x32_bf16 v[20:23], a[144:147], v[160:163], 0
  v_mfma_f32_16x16x32_bf16 v[20:23], a[148:151], v[164:167], v[20:23]
  v_mfma_f32_16x16x32_bf16 v[20:23], a[152:155], v[168:171], v[20:23]
  v_mfma_f32_16x16x32_bf16 v[20:23], a[156:159], v[172:175], v[20:23]
  v_mfma_f32_16x16x32_bf16 v[28:31], a[156:159], v[188:191], 0
  v_mfma_f32_16x16x32_bf16 v[28:31], a[152:155], v[184:187], v[28:31]
  v_mfma_f32_16x16x32_bf16 v[28:31], a[148:151], v[180:183], v[28:31]
  v_mfma_f32_16x16x32_bf16 v[28:31], a[144:147], v[176:179], v[28:31]
  ds_read_b128 a[128:131], v212 offset:8192
  ds_read_b128 a[132:135], v213 offset:8192
  ds_read_b128 a[136:139], v214 offset:8192
  ds_read_b128 a[140:143], v215 offset:8192
  s_waitcnt lgkmcnt(3)
  v_mfma_f32_16x16x32_bf16 v[32:35], a[128:131], v[128:131], 0
  s_waitcnt lgkmcnt(2)
  v_mfma_f32_16x16x32_bf16 v[32:35], a[132:135], v[132:135], v[32:35]
  s_waitcnt lgkmcnt(1)
  v_mfma_f32_16x16x32_bf16 v[32:35], a[136:139], v[136:139], v[32:35]
  s_waitcnt lgkmcnt(0)
  v_mfma_f32_16x16x32_bf16 v[32:35], a[140:143], v[140:143], v[32:35]
  v_mfma_f32_16x16x32_bf16 v[40:43], a[140:143], v[156:159], 0
  v_mfma_f32_16x16x32_bf16 v[40:43], a[136:139], v[152:155], v[40:43]
  v_mfma_f32_16x16x32_bf16 v[40:43], a[132:135], v[148:151], v[40:43]
  v_mfma_f32_16x16x32_bf16 v[40:43], a[128:131], v[144:147], v[40:43]
  v_mfma_f32_16x16x32_bf16 v[48:51], a[128:131], v[160:163], 0
  v_mfma_f32_16x16x32_bf16 v[48:51], a[132:135], v[164:167], v[48:51]
  v_mfma_f32_16x16x32_bf16 v[48:51], a[136:139], v[168:171], v[48:51]
  v_mfma_f32_16x16x32_bf16 v[48:51], a[140:143], v[172:175], v[48:51]
  v_mfma_f32_16x16x32_bf16 v[56:59], a[140:143], v[188:191], 0
  v_mfma_f32_16x16x32_bf16 v[56:59], a[136:139], v[184:187], v[56:59]
  v_mfma_f32_16x16x32_bf16 v[56:59], a[132:135], v[180:183], v[56:59]
  v_mfma_f32_16x16x32_bf16 v[56:59], a[128:131], v[176:179], v[56:59]
  ds_read_b128 a[144:147], v212 offset:12288
  ds_read_b128 a[148:151], v213 offset:12288
  ds_read_b128 a[152:155], v214 offset:12288
  ds_read_b128 a[156:159], v215 offset:12288
  s_waitcnt lgkmcnt(3)
  v_mfma_f32_16x16x32_bf16 v[36:39], a[144:147], v[128:131], 0
  s_waitcnt lgkmcnt(2)
  v_mfma_f32_16x16x32_bf16 v[36:39], a[148:151], v[132:135], v[36:39]
  s_waitcnt lgkmcnt(1)
  v_mfma_f32_16x16x32_bf16 v[36:39], a[152:155], v[136:139], v[36:39]
  s_waitcnt lgkmcnt(0)
  v_mfma_f32_16x16x32_bf16 v[36:39], a[156:159], v[140:143], v[36:39]
  v_mfma_f32_16x16x32_bf16 v[44:47], a[156:159], v[156:159], 0
  v_mfma_f32_16x16x32_bf16 v[44:47], a[152:155], v[152:155], v[44:47]
  v_mfma_f32_16x16x32_bf16 v[44:47], a[148:151], v[148:151], v[44:47]
  v_mfma_f32_16x16x32_bf16 v[44:47], a[144:147], v[144:147], v[44:47]
  v_mfma_f32_16x16x32_bf16 v[52:55], a[144:147], v[160:163], 0
  v_mfma_f32_16x16x32_bf16 v[52:55], a[148:151], v[164:167], v[52:55]
  v_mfma_f32_16x16x32_bf16 v[52:55], a[152:155], v[168:171], v[52:55]
  v_mfma_f32_16x16x32_bf16 v[52:55], a[156:159], v[172:175], v[52:55]
  v_mfma_f32_16x16x32_bf16 v[60:63], a[156:159], v[188:191], 0
  v_mfma_f32_16x16x32_bf16 v[60:63], a[152:155], v[184:187], v[60:63]
  v_mfma_f32_16x16x32_bf16 v[60:63], a[148:151], v[180:183], v[60:63]
  v_mfma_f32_16x16x32_bf16 v[60:63], a[144:147], v[176:179], v[60:63]
  v_mov_b32 v192, v249
  v_max3_f32 v192, v192, v0, v1
  v_max3_f32 v192, v192, v2, v3
  v_max3_f32 v192, v192, v4, v5
  v_max3_f32 v192, v192, v6, v7
  v_max3_f32 v192, v192, v32, v33
  v_max3_f32 v192, v192, v34, v35
  v_max3_f32 v192, v192, v36, v37
  v_max3_f32 v192, v192, v38, v39
  v_mov_b32 v245, v192
  s_nop 1
  v_permlane16_swap_b32 v192, v245
  v_max_f32 v192, v192, v245
  v_mov_b32 v245, v192
  s_nop 1
  v_permlane32_swap_b32 v192, v245
  v_max_f32 v192, v192, v245
  v_sub_f32 v193, v249, v192
  v_exp_f32 v193, v193
  v_mov_b32 v249, v192
  v_mul_f32 v208, v208, v193
  v_sub_f32 v0, v0, v192
  v_sub_f32 v1, v1, v192
  v_sub_f32 v2, v2, v192
  v_sub_f32 v3, v3, v192
  v_sub_f32 v4, v4, v192
  v_sub_f32 v5, v5, v192
  v_sub_f32 v6, v6, v192
  v_sub_f32 v7, v7, v192
  v_sub_f32 v32, v32, v192
  v_sub_f32 v33, v33, v192
  v_sub_f32 v34, v34, v192
  v_sub_f32 v35, v35, v192
  v_sub_f32 v36, v36, v192
  v_sub_f32 v37, v37, v192
  v_sub_f32 v38, v38, v192
  v_sub_f32 v39, v39, v192
  v_exp_f32 v0, v0
  v_exp_f32 v1, v1
  v_add_f32 v208, v208, v0
  v_exp_f32 v2, v2
  v_add_f32 v208, v208, v1
  v_cvt_pk_bf16_f32 v0, v0, v1
  v_exp_f32 v3, v3
  v_add_f32 v208, v208, v2
  v_add_f32 v208, v208, v3
  v_cvt_pk_bf16_f32 v1, v2, v3
  v_exp_f32 v4, v4
  v_exp_f32 v5, v5
  v_add_f32 v208, v208, v4
  v_exp_f32 v6, v6
  v_add_f32 v208, v208, v5
  v_cvt_pk_bf16_f32 v2, v4, v5
  v_exp_f32 v7, v7
  v_add_f32 v208, v208, v6
  v_add_f32 v208, v208, v7
  v_cvt_pk_bf16_f32 v3, v6, v7
  v_exp_f32 v32, v32
  v_exp_f32 v33, v33
  v_add_f32 v208, v208, v32
  v_exp_f32 v34, v34
  v_add_f32 v208, v208, v33
  v_cvt_pk_bf16_f32 v32, v32, v33
  v_exp_f32 v35, v35
  v_add_f32 v208, v208, v34
  v_add_f32 v208, v208, v35
  v_cvt_pk_bf16_f32 v33, v34, v35
  v_exp_f32 v36, v36
  v_exp_f32 v37, v37
  v_add_f32 v208, v208, v36
  v_exp_f32 v38, v38
  v_add_f32 v208, v208, v37
  v_cvt_pk_bf16_f32 v34, v36, v37
  v_exp_f32 v39, v39
  v_add_f32 v208, v208, v38
  v_add_f32 v208, v208, v39
  v_cvt_pk_bf16_f32 v35, v38, v39
  v_accvgpr_read_b32 v64, a0
  v_accvgpr_read_b32 v65, a1
  v_accvgpr_read_b32 v66, a2
  v_accvgpr_read_b32 v67, a3
  v_mul_f32 v64, v64, v193
  v_mul_f32 v65, v65, v193
  v_mul_f32 v66, v66, v193
  v_mul_f32 v67, v67, v193
  v_accvgpr_write_b32 a0, v64
  v_accvgpr_write_b32 a1, v65
  v_accvgpr_write_b32 a2, v66
  v_accvgpr_write_b32 a3, v67
  v_accvgpr_read_b32 v64, a16
  v_accvgpr_read_b32 v65, a17
  v_accvgpr_read_b32 v66, a18
  v_accvgpr_read_b32 v67, a19
  v_mul_f32 v64, v64, v193
  v_mul_f32 v65, v65, v193
  v_mul_f32 v66, v66, v193
  v_mul_f32 v67, v67, v193
  v_accvgpr_write_b32 a16, v64
  v_accvgpr_write_b32 a17, v65
  v_accvgpr_write_b32 a18, v66
  v_accvgpr_write_b32 a19, v67
  v_accvgpr_read_b32 v64, a32
  v_accvgpr_read_b32 v65, a33
  v_accvgpr_read_b32 v66, a34
  v_accvgpr_read_b32 v67, a35
  v_mul_f32 v64, v64, v193
  v_mul_f32 v65, v65, v193
  v_mul_f32 v66, v66, v193
  v_mul_f32 v67, v67, v193
  v_accvgpr_write_b32 a32, v64
  v_accvgpr_write_b32 a33, v65
  v_accvgpr_write_b32 a34, v66
  v_accvgpr_write_b32 a35, v67
  v_accvgpr_read_b32 v64, a48
  v_accvgpr_read_b32 v65, a49
  v_accvgpr_read_b32 v66, a50
  v_accvgpr_read_b32 v67, a51
  v_mul_f32 v64, v64, v193
  v_mul_f32 v65, v65, v193
  v_mul_f32 v66, v66, v193
  v_mul_f32 v67, v67, v193
  v_accvgpr_write_b32 a48, v64
  v_accvgpr_write_b32 a49, v65
  v_accvgpr_write_b32 a50, v66
  v_accvgpr_write_b32 a51, v67
  v_accvgpr_read_b32 v64, a64
  v_accvgpr_read_b32 v65, a65
  v_accvgpr_read_b32 v66, a66
  v_accvgpr_read_b32 v67, a67
  v_mul_f32 v64, v64, v193
  v_mul_f32 v65, v65, v193
  v_mul_f32 v66, v66, v193
  v_mul_f32 v67, v67, v193
  v_accvgpr_write_b32 a64, v64
  v_accvgpr_write_b32 a65, v65
  v_accvgpr_write_b32 a66, v66
  v_accvgpr_write_b32 a67, v67
  v_accvgpr_read_b32 v64, a80
  v_accvgpr_read_b32 v65, a81
  v_accvgpr_read_b32 v66, a82
  v_accvgpr_read_b32 v67, a83
  v_mul_f32 v64, v64, v193
  v_mul_f32 v65, v65, v193
  v_mul_f32 v66, v66, v193
  v_mul_f32 v67, v67, v193
  v_accvgpr_write_b32 a80, v64
  v_accvgpr_write_b32 a81, v65
  v_accvgpr_write_b32 a82, v66
  v_accvgpr_write_b32 a83, v67
  v_accvgpr_read_b32 v64, a96
  v_accvgpr_read_b32 v65, a97
  v_accvgpr_read_b32 v66, a98
  v_accvgpr_read_b32 v67, a99
  v_mul_f32 v64, v64, v193
  v_mul_f32 v65, v65, v193
  v_mul_f32 v66, v66, v193
  v_mul_f32 v67, v67, v193
  v_accvgpr_write_b32 a96, v64
  v_accvgpr_write_b32 a97, v65
  v_accvgpr_write_b32 a98, v66
  v_accvgpr_write_b32 a99, v67
  v_accvgpr_read_b32 v64, a112
  v_accvgpr_read_b32 v65, a113
  v_accvgpr_read_b32 v66, a114
  v_accvgpr_read_b32 v67, a115
  v_mul_f32 v64, v64, v193
  v_mul_f32 v65, v65, v193
  v_mul_f32 v66, v66, v193
  v_mul_f32 v67, v67, v193
  v_accvgpr_write_b32 a112, v64
  v_accvgpr_write_b32 a113, v65
  v_accvgpr_write_b32 a114, v66
  v_accvgpr_write_b32 a115, v67
  v_mov_b32 v196, v250
  v_max3_f32 v196, v196, v8, v9
  v_max3_f32 v196, v196, v10, v11
  v_max3_f32 v196, v196, v12, v13
  v_max3_f32 v196, v196, v14, v15
  v_max3_f32 v196, v196, v40, v41
  v_max3_f32 v196, v196, v42, v43
  v_max3_f32 v196, v196, v44, v45
  v_max3_f32 v196, v196, v46, v47
  v_mov_b32 v245, v196
  s_nop 1
  v_permlane16_swap_b32 v196, v245
  v_max_f32 v196, v196, v245
  v_mov_b32 v245, v196
  s_nop 1
  v_permlane32_swap_b32 v196, v245
  v_max_f32 v196, v196, v245
  v_sub_f32 v197, v250, v196
  v_exp_f32 v197, v197
  v_mov_b32 v250, v196
  v_mul_f32 v209, v209, v197
  v_sub_f32 v8, v8, v196
  v_sub_f32 v9, v9, v196
  v_sub_f32 v10, v10, v196
  v_sub_f32 v11, v11, v196
  v_sub_f32 v12, v12, v196
  v_sub_f32 v13, v13, v196
  v_sub_f32 v14, v14, v196
  v_sub_f32 v15, v15, v196
  v_sub_f32 v40, v40, v196
  v_sub_f32 v41, v41, v196
  v_sub_f32 v42, v42, v196
  v_sub_f32 v43, v43, v196
  v_sub_f32 v44, v44, v196
  v_sub_f32 v45, v45, v196
  v_sub_f32 v46, v46, v196
  v_sub_f32 v47, v47, v196
  v_exp_f32 v8, v8
  v_exp_f32 v9, v9
  v_add_f32 v209, v209, v8
  v_exp_f32 v10, v10
  v_add_f32 v209, v209, v9
  v_cvt_pk_bf16_f32 v8, v8, v9
  v_exp_f32 v11, v11
  v_add_f32 v209, v209, v10
  v_add_f32 v209, v209, v11
  v_cvt_pk_bf16_f32 v9, v10, v11
  v_exp_f32 v12, v12
  v_exp_f32 v13, v13
  v_add_f32 v209, v209, v12
  v_exp_f32 v14, v14
  v_add_f32 v209, v209, v13
  v_cvt_pk_bf16_f32 v10, v12, v13
  v_exp_f32 v15, v15
  v_add_f32 v209, v209, v14
  v_add_f32 v209, v209, v15
  v_cvt_pk_bf16_f32 v11, v14, v15
  v_exp_f32 v40, v40
  v_exp_f32 v41, v41
  v_add_f32 v209, v209, v40
  v_exp_f32 v42, v42
  v_add_f32 v209, v209, v41
  v_cvt_pk_bf16_f32 v40, v40, v41
  v_exp_f32 v43, v43
  v_add_f32 v209, v209, v42
  v_add_f32 v209, v209, v43
  v_cvt_pk_bf16_f32 v41, v42, v43
  v_exp_f32 v44, v44
  v_exp_f32 v45, v45
  v_add_f32 v209, v209, v44
  v_exp_f32 v46, v46
  v_add_f32 v209, v209, v45
  v_cvt_pk_bf16_f32 v42, v44, v45
  v_exp_f32 v47, v47
  v_add_f32 v209, v209, v46
  v_add_f32 v209, v209, v47
  v_cvt_pk_bf16_f32 v43, v46, v47
  v_accvgpr_read_b32 v64, a4
  v_accvgpr_read_b32 v65, a5
  v_accvgpr_read_b32 v66, a6
  v_accvgpr_read_b32 v67, a7
  v_mul_f32 v64, v64, v197
  v_mul_f32 v65, v65, v197
  v_mul_f32 v66, v66, v197
  v_mul_f32 v67, v67, v197
  v_accvgpr_write_b32 a4, v64
  v_accvgpr_write_b32 a5, v65
  v_accvgpr_write_b32 a6, v66
  v_accvgpr_write_b32 a7, v67
  v_accvgpr_read_b32 v64, a20
  v_accvgpr_read_b32 v65, a21
  v_accvgpr_read_b32 v66, a22
  v_accvgpr_read_b32 v67, a23
  v_mul_f32 v64, v64, v197
  v_mul_f32 v65, v65, v197
  v_mul_f32 v66, v66, v197
  v_mul_f32 v67, v67, v197
  v_accvgpr_write_b32 a20, v64
  v_accvgpr_write_b32 a21, v65
  v_accvgpr_write_b32 a22, v66
  v_accvgpr_write_b32 a23, v67
  v_accvgpr_read_b32 v64, a36
  v_accvgpr_read_b32 v65, a37
  v_accvgpr_read_b32 v66, a38
  v_accvgpr_read_b32 v67, a39
  v_mul_f32 v64, v64, v197
  v_mul_f32 v65, v65, v197
  v_mul_f32 v66, v66, v197
  v_mul_f32 v67, v67, v197
  v_accvgpr_write_b32 a36, v64
  v_accvgpr_write_b32 a37, v65
  v_accvgpr_write_b32 a38, v66
  v_accvgpr_write_b32 a39, v67
  v_accvgpr_read_b32 v64, a52
  v_accvgpr_read_b32 v65, a53
  v_accvgpr_read_b32 v66, a54
  v_accvgpr_read_b32 v67, a55
  v_mul_f32 v64, v64, v197
  v_mul_f32 v65, v65, v197
  v_mul_f32 v66, v66, v197
  v_mul_f32 v67, v67, v197
  v_accvgpr_write_b32 a52, v64
  v_accvgpr_write_b32 a53, v65
  v_accvgpr_write_b32 a54, v66
  v_accvgpr_write_b32 a55, v67
  v_accvgpr_read_b32 v64, a68
  v_accvgpr_read_b32 v65, a69
  v_accvgpr_read_b32 v66, a70
  v_accvgpr_read_b32 v67, a71
  v_mul_f32 v64, v64, v197
  v_mul_f32 v65, v65, v197
  v_mul_f32 v66, v66, v197
  v_mul_f32 v67, v67, v197
  v_accvgpr_write_b32 a68, v64
  v_accvgpr_write_b32 a69, v65
  v_accvgpr_write_b32 a70, v66
  v_accvgpr_write_b32 a71, v67
  v_accvgpr_read_b32 v64, a84
  v_accvgpr_read_b32 v65, a85
  v_accvgpr_read_b32 v66, a86
  v_accvgpr_read_b32 v67, a87
  v_mul_f32 v64, v64, v197
  v_mul_f32 v65, v65, v197
  v_mul_f32 v66, v66, v197
  v_mul_f32 v67, v67, v197
  v_accvgpr_write_b32 a84, v64
  v_accvgpr_write_b32 a85, v65
  v_accvgpr_write_b32 a86, v66
  v_accvgpr_write_b32 a87, v67
  v_accvgpr_read_b32 v64, a100
  v_accvgpr_read_b32 v65, a101
  v_accvgpr_read_b32 v66, a102
  v_accvgpr_read_b32 v67, a103
  v_mul_f32 v64, v64, v197
  v_mul_f32 v65, v65, v197
  v_mul_f32 v66, v66, v197
  v_mul_f32 v67, v67, v197
  v_accvgpr_write_b32 a100, v64
  v_accvgpr_write_b32 a101, v65
  v_accvgpr_write_b32 a102, v66
  v_accvgpr_write_b32 a103, v67
  v_accvgpr_read_b32 v64, a116
  v_accvgpr_read_b32 v65, a117
  v_accvgpr_read_b32 v66, a118
  v_accvgpr_read_b32 v67, a119
  v_mul_f32 v64, v64, v197
  v_mul_f32 v65, v65, v197
  v_mul_f32 v66, v66, v197
  v_mul_f32 v67, v67, v197
  v_accvgpr_write_b32 a116, v64
  v_accvgpr_write_b32 a117, v65
  v_accvgpr_write_b32 a118, v66
  v_accvgpr_write_b32 a119, v67
  v_mov_b32 v200, v251
  v_max3_f32 v200, v200, v16, v17
  v_max3_f32 v200, v200, v18, v19
  v_max3_f32 v200, v200, v20, v21
  v_max3_f32 v200, v200, v22, v23
  v_max3_f32 v200, v200, v48, v49
  v_max3_f32 v200, v200, v50, v51
  v_max3_f32 v200, v200, v52, v53
  v_max3_f32 v200, v200, v54, v55
  v_mov_b32 v245, v200
  s_nop 1
  v_permlane16_swap_b32 v200, v245
  v_max_f32 v200, v200, v245
  v_mov_b32 v245, v200
  s_nop 1
  v_permlane32_swap_b32 v200, v245
  v_max_f32 v200, v200, v245
  v_sub_f32 v201, v251, v200
  v_exp_f32 v201, v201
  v_mov_b32 v251, v200
  v_mul_f32 v210, v210, v201
  v_sub_f32 v16, v16, v200
  v_sub_f32 v17, v17, v200
  v_sub_f32 v18, v18, v200
  v_sub_f32 v19, v19, v200
  v_sub_f32 v20, v20, v200
  v_sub_f32 v21, v21, v200
  v_sub_f32 v22, v22, v200
  v_sub_f32 v23, v23, v200
  v_sub_f32 v48, v48, v200
  v_sub_f32 v49, v49, v200
  v_sub_f32 v50, v50, v200
  v_sub_f32 v51, v51, v200
  v_sub_f32 v52, v52, v200
  v_sub_f32 v53, v53, v200
  v_sub_f32 v54, v54, v200
  v_sub_f32 v55, v55, v200
  v_exp_f32 v16, v16
  v_exp_f32 v17, v17
  v_add_f32 v210, v210, v16
  v_exp_f32 v18, v18
  v_add_f32 v210, v210, v17
  v_cvt_pk_bf16_f32 v16, v16, v17
  v_exp_f32 v19, v19
  v_add_f32 v210, v210, v18
  v_add_f32 v210, v210, v19
  v_cvt_pk_bf16_f32 v17, v18, v19
  v_exp_f32 v20, v20
  v_exp_f32 v21, v21
  v_add_f32 v210, v210, v20
  v_exp_f32 v22, v22
  v_add_f32 v210, v210, v21
  v_cvt_pk_bf16_f32 v18, v20, v21
  v_exp_f32 v23, v23
  v_add_f32 v210, v210, v22
  v_add_f32 v210, v210, v23
  v_cvt_pk_bf16_f32 v19, v22, v23
  v_exp_f32 v48, v48
  v_exp_f32 v49, v49
  v_add_f32 v210, v210, v48
  v_exp_f32 v50, v50
  v_add_f32 v210, v210, v49
  v_cvt_pk_bf16_f32 v48, v48, v49
  v_exp_f32 v51, v51
  v_add_f32 v210, v210, v50
  v_add_f32 v210, v210, v51
  v_cvt_pk_bf16_f32 v49, v50, v51
  v_exp_f32 v52, v52
  v_exp_f32 v53, v53
  v_add_f32 v210, v210, v52
  v_exp_f32 v54, v54
  v_add_f32 v210, v210, v53
  v_cvt_pk_bf16_f32 v50, v52, v53
  v_exp_f32 v55, v55
  v_add_f32 v210, v210, v54
  v_add_f32 v210, v210, v55
  v_cvt_pk_bf16_f32 v51, v54, v55
  v_accvgpr_read_b32 v64, a8
  v_accvgpr_read_b32 v65, a9
  v_accvgpr_read_b32 v66, a10
  v_accvgpr_read_b32 v67, a11
  v_mul_f32 v64, v64, v201
  v_mul_f32 v65, v65, v201
  v_mul_f32 v66, v66, v201
  v_mul_f32 v67, v67, v201
  v_accvgpr_write_b32 a8, v64
  v_accvgpr_write_b32 a9, v65
  v_accvgpr_write_b32 a10, v66
  v_accvgpr_write_b32 a11, v67
  v_accvgpr_read_b32 v64, a24
  v_accvgpr_read_b32 v65, a25
  v_accvgpr_read_b32 v66, a26
  v_accvgpr_read_b32 v67, a27
  v_mul_f32 v64, v64, v201
  v_mul_f32 v65, v65, v201
  v_mul_f32 v66, v66, v201
  v_mul_f32 v67, v67, v201
  v_accvgpr_write_b32 a24, v64
  v_accvgpr_write_b32 a25, v65
  v_accvgpr_write_b32 a26, v66
  v_accvgpr_write_b32 a27, v67
  v_accvgpr_read_b32 v64, a40
  v_accvgpr_read_b32 v65, a41
  v_accvgpr_read_b32 v66, a42
  v_accvgpr_read_b32 v67, a43
  v_mul_f32 v64, v64, v201
  v_mul_f32 v65, v65, v201
  v_mul_f32 v66, v66, v201
  v_mul_f32 v67, v67, v201
  v_accvgpr_write_b32 a40, v64
  v_accvgpr_write_b32 a41, v65
  v_accvgpr_write_b32 a42, v66
  v_accvgpr_write_b32 a43, v67
  v_accvgpr_read_b32 v64, a56
  v_accvgpr_read_b32 v65, a57
  v_accvgpr_read_b32 v66, a58
  v_accvgpr_read_b32 v67, a59
  v_mul_f32 v64, v64, v201
  v_mul_f32 v65, v65, v201
  v_mul_f32 v66, v66, v201
  v_mul_f32 v67, v67, v201
  v_accvgpr_write_b32 a56, v64
  v_accvgpr_write_b32 a57, v65
  v_accvgpr_write_b32 a58, v66
  v_accvgpr_write_b32 a59, v67
  v_accvgpr_read_b32 v64, a72
  v_accvgpr_read_b32 v65, a73
  v_accvgpr_read_b32 v66, a74
  v_accvgpr_read_b32 v67, a75
  v_mul_f32 v64, v64, v201
  v_mul_f32 v65, v65, v201
  v_mul_f32 v66, v66, v201
  v_mul_f32 v67, v67, v201
  v_accvgpr_write_b32 a72, v64
  v_accvgpr_write_b32 a73, v65
  v_accvgpr_write_b32 a74, v66
  v_accvgpr_write_b32 a75, v67
  v_accvgpr_read_b32 v64, a88
  v_accvgpr_read_b32 v65, a89
  v_accvgpr_read_b32 v66, a90
  v_accvgpr_read_b32 v67, a91
  v_mul_f32 v64, v64, v201
  v_mul_f32 v65, v65, v201
  v_mul_f32 v66, v66, v201
  v_mul_f32 v67, v67, v201
  v_accvgpr_write_b32 a88, v64
  v_accvgpr_write_b32 a89, v65
  v_accvgpr_write_b32 a90, v66
  v_accvgpr_write_b32 a91, v67
  v_accvgpr_read_b32 v64, a104
  v_accvgpr_read_b32 v65, a105
  v_accvgpr_read_b32 v66, a106
  v_accvgpr_read_b32 v67, a107
  v_mul_f32 v64, v64, v201
  v_mul_f32 v65, v65, v201
  v_mul_f32 v66, v66, v201
  v_mul_f32 v67, v67, v201
  v_accvgpr_write_b32 a104, v64
  v_accvgpr_write_b32 a105, v65
  v_accvgpr_write_b32 a106, v66
  v_accvgpr_write_b32 a107, v67
  v_accvgpr_read_b32 v64, a120
  v_accvgpr_read_b32 v65, a121
  v_accvgpr_read_b32 v66, a122
  v_accvgpr_read_b32 v67, a123
  v_mul_f32 v64, v64, v201
  v_mul_f32 v65, v65, v201
  v_mul_f32 v66, v66, v201
  v_mul_f32 v67, v67, v201
  v_accvgpr_write_b32 a120, v64
  v_accvgpr_write_b32 a121, v65
  v_accvgpr_write_b32 a122, v66
  v_accvgpr_write_b32 a123, v67
  v_mov_b32 v204, v252
  v_max3_f32 v204, v204, v24, v25
  v_max3_f32 v204, v204, v26, v27
  v_max3_f32 v204, v204, v28, v29
  v_max3_f32 v204, v204, v30, v31
  v_max3_f32 v204, v204, v56, v57
  v_max3_f32 v204, v204, v58, v59
  v_max3_f32 v204, v204, v60, v61
  v_max3_f32 v204, v204, v62, v63
  v_mov_b32 v245, v204
  s_nop 1
  v_permlane16_swap_b32 v204, v245
  v_max_f32 v204, v204, v245
  v_mov_b32 v245, v204
  s_nop 1
  v_permlane32_swap_b32 v204, v245
  v_max_f32 v204, v204, v245
  v_sub_f32 v205, v252, v204
  v_exp_f32 v205, v205
  v_mov_b32 v252, v204
  v_mul_f32 v211, v211, v205
  v_sub_f32 v24, v24, v204
  v_sub_f32 v25, v25, v204
  v_sub_f32 v26, v26, v204
  v_sub_f32 v27, v27, v204
  v_sub_f32 v28, v28, v204
  v_sub_f32 v29, v29, v204
  v_sub_f32 v30, v30, v204
  v_sub_f32 v31, v31, v204
  v_sub_f32 v56, v56, v204
  v_sub_f32 v57, v57, v204
  v_sub_f32 v58, v58, v204
  v_sub_f32 v59, v59, v204
  v_sub_f32 v60, v60, v204
  v_sub_f32 v61, v61, v204
  v_sub_f32 v62, v62, v204
  v_sub_f32 v63, v63, v204
  v_exp_f32 v24, v24
  v_exp_f32 v25, v25
  v_add_f32 v211, v211, v24
  v_exp_f32 v26, v26
  v_add_f32 v211, v211, v25
  v_cvt_pk_bf16_f32 v24, v24, v25
  v_exp_f32 v27, v27
  v_add_f32 v211, v211, v26
  v_add_f32 v211, v211, v27
  v_cvt_pk_bf16_f32 v25, v26, v27
  v_exp_f32 v28, v28
  v_exp_f32 v29, v29
  v_add_f32 v211, v211, v28
  v_exp_f32 v30, v30
  v_add_f32 v211, v211, v29
  v_cvt_pk_bf16_f32 v26, v28, v29
  v_exp_f32 v31, v31
  v_add_f32 v211, v211, v30
  v_add_f32 v211, v211, v31
  v_cvt_pk_bf16_f32 v27, v30, v31
  v_exp_f32 v56, v56
  v_exp_f32 v57, v57
  v_add_f32 v211, v211, v56
  v_exp_f32 v58, v58
  v_add_f32 v211, v211, v57
  v_cvt_pk_bf16_f32 v56, v56, v57
  v_exp_f32 v59, v59
  v_add_f32 v211, v211, v58
  v_add_f32 v211, v211, v59
  v_cvt_pk_bf16_f32 v57, v58, v59
  v_exp_f32 v60, v60
  v_exp_f32 v61, v61
  v_add_f32 v211, v211, v60
  v_exp_f32 v62, v62
  v_add_f32 v211, v211, v61
  v_cvt_pk_bf16_f32 v58, v60, v61
  v_exp_f32 v63, v63
  v_add_f32 v211, v211, v62
  v_add_f32 v211, v211, v63
  v_cvt_pk_bf16_f32 v59, v62, v63
  v_accvgpr_read_b32 v64, a12
  v_accvgpr_read_b32 v65, a13
  v_accvgpr_read_b32 v66, a14
  v_accvgpr_read_b32 v67, a15
  v_mul_f32 v64, v64, v205
  v_mul_f32 v65, v65, v205
  v_mul_f32 v66, v66, v205
  v_mul_f32 v67, v67, v205
  v_accvgpr_write_b32 a12, v64
  v_accvgpr_write_b32 a13, v65
  v_accvgpr_write_b32 a14, v66
  v_accvgpr_write_b32 a15, v67
  v_accvgpr_read_b32 v64, a28
  v_accvgpr_read_b32 v65, a29
  v_accvgpr_read_b32 v66, a30
  v_accvgpr_read_b32 v67, a31
  v_mul_f32 v64, v64, v205
  v_mul_f32 v65, v65, v205
  v_mul_f32 v66, v66, v205
  v_mul_f32 v67, v67, v205
  v_accvgpr_write_b32 a28, v64
  v_accvgpr_write_b32 a29, v65
  v_accvgpr_write_b32 a30, v66
  v_accvgpr_write_b32 a31, v67
  v_accvgpr_read_b32 v64, a44
  v_accvgpr_read_b32 v65, a45
  v_accvgpr_read_b32 v66, a46
  v_accvgpr_read_b32 v67, a47
  v_mul_f32 v64, v64, v205
  v_mul_f32 v65, v65, v205
  v_mul_f32 v66, v66, v205
  v_mul_f32 v67, v67, v205
  v_accvgpr_write_b32 a44, v64
  v_accvgpr_write_b32 a45, v65
  v_accvgpr_write_b32 a46, v66
  v_accvgpr_write_b32 a47, v67
  v_accvgpr_read_b32 v64, a60
  v_accvgpr_read_b32 v65, a61
  v_accvgpr_read_b32 v66, a62
  v_accvgpr_read_b32 v67, a63
  v_mul_f32 v64, v64, v205
  v_mul_f32 v65, v65, v205
  v_mul_f32 v66, v66, v205
  v_mul_f32 v67, v67, v205
  v_accvgpr_write_b32 a60, v64
  v_accvgpr_write_b32 a61, v65
  v_accvgpr_write_b32 a62, v66
  v_accvgpr_write_b32 a63, v67
  v_accvgpr_read_b32 v64, a76
  v_accvgpr_read_b32 v65, a77
  v_accvgpr_read_b32 v66, a78
  v_accvgpr_read_b32 v67, a79
  v_mul_f32 v64, v64, v205
  v_mul_f32 v65, v65, v205
  v_mul_f32 v66, v66, v205
  v_mul_f32 v67, v67, v205
  v_accvgpr_write_b32 a76, v64
  v_accvgpr_write_b32 a77, v65
  v_accvgpr_write_b32 a78, v66
  v_accvgpr_write_b32 a79, v67
  v_accvgpr_read_b32 v64, a92
  v_accvgpr_read_b32 v65, a93
  v_accvgpr_read_b32 v66, a94
  v_accvgpr_read_b32 v67, a95
  v_mul_f32 v64, v64, v205
  v_mul_f32 v65, v65, v205
  v_mul_f32 v66, v66, v205
  v_mul_f32 v67, v67, v205
  v_accvgpr_write_b32 a92, v64
  v_accvgpr_write_b32 a93, v65
  v_accvgpr_write_b32 a94, v66
  v_accvgpr_write_b32 a95, v67
  v_accvgpr_read_b32 v64, a108
  v_accvgpr_read_b32 v65, a109
  v_accvgpr_read_b32 v66, a110
  v_accvgpr_read_b32 v67, a111
  v_mul_f32 v64, v64, v205
  v_mul_f32 v65, v65, v205
  v_mul_f32 v66, v66, v205
  v_mul_f32 v67, v67, v205
  v_accvgpr_write_b32 a108, v64
  v_accvgpr_write_b32 a109, v65
  v_accvgpr_write_b32 a110, v66
  v_accvgpr_write_b32 a111, v67
  v_accvgpr_read_b32 v64, a124
  v_accvgpr_read_b32 v65, a125
  v_accvgpr_read_b32 v66, a126
  v_accvgpr_read_b32 v67, a127
  v_mul_f32 v64, v64, v205
  v_mul_f32 v65, v65, v205
  v_mul_f32 v66, v66, v205
  v_mul_f32 v67, v67, v205
  v_accvgpr_write_b32 a124, v64
  v_accvgpr_write_b32 a125, v65
  v_accvgpr_write_b32 a126, v66
  v_accvgpr_write_b32 a127, v67
  ds_read_b64_tr_b16 a[160:161], v216 offset:0
  ds_read_b64_tr_b16 a[162:163], v216 offset:4096
  ds_read_b64_tr_b16 a[164:165], v216 offset:8192
  ds_read_b64_tr_b16 a[166:167], v216 offset:12288
  s_waitcnt lgkmcnt(2)
  v_mfma_f32_16x16x32_bf16 a[0:3], a[160:163], v[0:3], a[0:3]
  s_waitcnt lgkmcnt(0)
  v_mfma_f32_16x16x32_bf16 a[0:3], a[164:167], v[32:35], a[0:3]
  v_mfma_f32_16x16x32_bf16 a[4:7], a[164:167], v[40:43], a[4:7]
  v_mfma_f32_16x16x32_bf16 a[4:7], a[160:163], v[8:11], a[4:7]
  v_mfma_f32_16x16x32_bf16 a[8:11], a[160:163], v[16:19], a[8:11]
  v_mfma_f32_16x16x32_bf16 a[8:11], a[164:167], v[48:51], a[8:11]
  v_mfma_f32_16x16x32_bf16 a[12:15], a[164:167], v[56:59], a[12:15]
  v_mfma_f32_16x16x32_bf16 a[12:15], a[160:163], v[24:27], a[12:15]
  ds_read_b64_tr_b16 a[168:169], v217 offset:0
  ds_read_b64_tr_b16 a[170:171], v217 offset:4096
  ds_read_b64_tr_b16 a[172:173], v217 offset:8192
  ds_read_b64_tr_b16 a[174:175], v217 offset:12288
  s_waitcnt lgkmcnt(2)
  v_mfma_f32_16x16x32_bf16 a[16:19], a[168:171], v[0:3], a[16:19]
  s_waitcnt lgkmcnt(0)
  v_mfma_f32_16x16x32_bf16 a[16:19], a[172:175], v[32:35], a[16:19]
  v_mfma_f32_16x16x32_bf16 a[20:23], a[172:175], v[40:43], a[20:23]
  v_mfma_f32_16x16x32_bf16 a[20:23], a[168:171], v[8:11], a[20:23]
  v_mfma_f32_16x16x32_bf16 a[24:27], a[168:171], v[16:19], a[24:27]
  v_mfma_f32_16x16x32_bf16 a[24:27], a[172:175], v[48:51], a[24:27]
  v_mfma_f32_16x16x32_bf16 a[28:31], a[172:175], v[56:59], a[28:31]
  v_mfma_f32_16x16x32_bf16 a[28:31], a[168:171], v[24:27], a[28:31]
  ds_read_b64_tr_b16 a[176:177], v218 offset:0
  ds_read_b64_tr_b16 a[178:179], v218 offset:4096
  ds_read_b64_tr_b16 a[180:181], v218 offset:8192
  ds_read_b64_tr_b16 a[182:183], v218 offset:12288
  s_waitcnt lgkmcnt(2)
  v_mfma_f32_16x16x32_bf16 a[32:35], a[176:179], v[0:3], a[32:35]
  s_waitcnt lgkmcnt(0)
  v_mfma_f32_16x16x32_bf16 a[32:35], a[180:183], v[32:35], a[32:35]
  v_mfma_f32_16x16x32_bf16 a[36:39], a[180:183], v[40:43], a[36:39]
  v_mfma_f32_16x16x32_bf16 a[36:39], a[176:179], v[8:11], a[36:39]
  v_mfma_f32_16x16x32_bf16 a[40:43], a[176:179], v[16:19], a[40:43]
  v_mfma_f32_16x16x32_bf16 a[40:43], a[180:183], v[48:51], a[40:43]
  v_mfma_f32_16x16x32_bf16 a[44:47], a[180:183], v[56:59], a[44:47]
  v_mfma_f32_16x16x32_bf16 a[44:47], a[176:179], v[24:27], a[44:47]
  ds_read_b64_tr_b16 a[184:185], v219 offset:0
  ds_read_b64_tr_b16 a[186:187], v219 offset:4096
  ds_read_b64_tr_b16 a[188:189], v219 offset:8192
  ds_read_b64_tr_b16 a[190:191], v219 offset:12288
  s_waitcnt lgkmcnt(2)
  v_mfma_f32_16x16x32_bf16 a[48:51], a[184:187], v[0:3], a[48:51]
  s_waitcnt lgkmcnt(0)
  v_mfma_f32_16x16x32_bf16 a[48:51], a[188:191], v[32:35], a[48:51]
  v_mfma_f32_16x16x32_bf16 a[52:55], a[188:191], v[40:43], a[52:55]
  v_mfma_f32_16x16x32_bf16 a[52:55], a[184:187], v[8:11], a[52:55]
  v_mfma_f32_16x16x32_bf16 a[56:59], a[184:187], v[16:19], a[56:59]
  v_mfma_f32_16x16x32_bf16 a[56:59], a[188:191], v[48:51], a[56:59]
  v_mfma_f32_16x16x32_bf16 a[60:63], a[188:191], v[56:59], a[60:63]
  v_mfma_f32_16x16x32_bf16 a[60:63], a[184:187], v[24:27], a[60:63]
  ds_read_b64_tr_b16 a[160:161], v220 offset:0
  ds_read_b64_tr_b16 a[162:163], v220 offset:4096
  ds_read_b64_tr_b16 a[164:165], v220 offset:8192
  ds_read_b64_tr_b16 a[166:167], v220 offset:12288
  s_waitcnt lgkmcnt(2)
  v_mfma_f32_16x16x32_bf16 a[64:67], a[160:163], v[0:3], a[64:67]
  s_waitcnt lgkmcnt(0)
  v_mfma_f32_16x16x32_bf16 a[64:67], a[164:167], v[32:35], a[64:67]
  v_mfma_f32_16x16x32_bf16 a[68:71], a[164:167], v[40:43], a[68:71]
  v_mfma_f32_16x16x32_bf16 a[68:71], a[160:163], v[8:11], a[68:71]
  v_mfma_f32_16x16x32_bf16 a[72:75], a[160:163], v[16:19], a[72:75]
  v_mfma_f32_16x16x32_bf16 a[72:75], a[164:167], v[48:51], a[72:75]
  v_mfma_f32_16x16x32_bf16 a[76:79], a[164:167], v[56:59], a[76:79]
  v_mfma_f32_16x16x32_bf16 a[76:79], a[160:163], v[24:27], a[76:79]
  ds_read_b64_tr_b16 a[168:169], v221 offset:0
  ds_read_b64_tr_b16 a[170:171], v221 offset:4096
  ds_read_b64_tr_b16 a[172:173], v221 offset:8192
  ds_read_b64_tr_b16 a[174:175], v221 offset:12288
  s_waitcnt lgkmcnt(2)
  v_mfma_f32_16x16x32_bf16 a[80:83], a[168:171], v[0:3], a[80:83]
  s_waitcnt lgkmcnt(0)
  v_mfma_f32_16x16x32_bf16 a[80:83], a[172:175], v[32:35], a[80:83]
  v_mfma_f32_16x16x32_bf16 a[84:87], a[172:175], v[40:43], a[84:87]
  v_mfma_f32_16x16x32_bf16 a[84:87], a[168:171], v[8:11], a[84:87]
  v_mfma_f32_16x16x32_bf16 a[88:91], a[168:171], v[16:19], a[88:91]
  v_mfma_f32_16x16x32_bf16 a[88:91], a[172:175], v[48:51], a[88:91]
  v_mfma_f32_16x16x32_bf16 a[92:95], a[172:175], v[56:59], a[92:95]
  v_mfma_f32_16x16x32_bf16 a[92:95], a[168:171], v[24:27], a[92:95]
  ds_read_b64_tr_b16 a[176:177], v222 offset:0
  ds_read_b64_tr_b16 a[178:179], v222 offset:4096
  ds_read_b64_tr_b16 a[180:181], v222 offset:8192
  ds_read_b64_tr_b16 a[182:183], v222 offset:12288
  s_waitcnt lgkmcnt(2)
  v_mfma_f32_16x16x32_bf16 a[96:99], a[176:179], v[0:3], a[96:99]
  s_waitcnt lgkmcnt(0)
  v_mfma_f32_16x16x32_bf16 a[96:99], a[180:183], v[32:35], a[96:99]
  v_mfma_f32_16x16x32_bf16 a[100:103], a[180:183], v[40:43], a[100:103]
  v_mfma_f32_16x16x32_bf16 a[100:103], a[176:179], v[8:11], a[100:103]
  v_mfma_f32_16x16x32_bf16 a[104:107], a[176:179], v[16:19], a[104:107]
  v_mfma_f32_16x16x32_bf16 a[104:107], a[180:183], v[48:51], a[104:107]
  v_mfma_f32_16x16x32_bf16 a[108:111], a[180:183], v[56:59], a[108:111]
  v_mfma_f32_16x16x32_bf16 a[108:111], a[176:179], v[24:27], a[108:111]
  ds_read_b64_tr_b16 a[184:185], v223 offset:0
  ds_read_b64_tr_b16 a[186:187], v223 offset:4096
  ds_read_b64_tr_b16 a[188:189], v223 offset:8192
  ds_read_b64_tr_b16 a[190:191], v223 offset:12288
  s_waitcnt lgkmcnt(2)
  v_mfma_f32_16x16x32_bf16 a[112:115], a[184:187], v[0:3], a[112:115]
  s_waitcnt lgkmcnt(0)
  v_mfma_f32_16x16x32_bf16 a[112:115], a[188:191], v[32:35], a[112:115]
  v_mfma_f32_16x16x32_bf16 a[116:119], a[188:191], v[40:43], a[116:119]
  v_mfma_f32_16x16x32_bf16 a[116:119], a[184:187], v[8:11], a[116:119]
  v_mfma_f32_16x16x32_bf16 a[120:123], a[184:187], v[16:19], a[120:123]
  v_mfma_f32_16x16x32_bf16 a[120:123], a[188:191], v[48:51], a[120:123]
  v_mfma_f32_16x16x32_bf16 a[124:127], a[188:191], v[56:59], a[124:127]
  v_mfma_f32_16x16x32_bf16 a[124:127], a[184:187], v[24:27], a[124:127]
  s_add_u32 s29, s29, 16384
  s_cmp_lt_u32 s29, 524288
  s_cbranch_scc1 attn_slow
  v_mov_b32 v245, v208
  v_mov_b32 v246, v209
  v_mov_b32 v247, v210
  v_mov_b32 v248, v211
  v_permlane16_swap_b32 v208, v245
  v_permlane16_swap_b32 v209, v246
  v_permlane16_swap_b32 v210, v247
  v_permlane16_swap_b32 v211, v248
  v_add_f32 v208, v208, v245
  v_add_f32 v209, v209, v246
  v_add_f32 v210, v210, v247
  v_add_f32 v211, v211, v248
  v_mov_b32 v245, v208
  v_mov_b32 v246, v209
  v_mov_b32 v247, v210
  v_mov_b32 v248, v211
  v_permlane32_swap_b32 v208, v245
  v_permlane32_swap_b32 v209, v246
  v_permlane32_swap_b32 v210, v247
  v_permlane32_swap_b32 v211, v248
  v_add_f32 v208, v208, v245
  v_add_f32 v209, v209, v246
  v_add_f32 v210, v210, v247
  v_add_f32 v211, v211, v248
  v_rcp_f32 v192, v208
  v_rcp_f32 v196, v209
  v_rcp_f32 v200, v210
  v_rcp_f32 v204, v211
  v_accvgpr_read_b32 v0, a0
  v_accvgpr_read_b32 v1, a1
  v_accvgpr_read_b32 v2, a2
  v_accvgpr_read_b32 v3, a3
  v_accvgpr_read_b32 v4, a16
  v_accvgpr_read_b32 v5, a17
  v_accvgpr_read_b32 v6, a18
  v_accvgpr_read_b32 v7, a19
  v_mul_f32 v0, v0, v192
  v_mul_f32 v1, v1, v192
  v_mul_f32 v2, v2, v192
  v_mul_f32 v3, v3, v192
  v_mul_f32 v4, v4, v192
  v_mul_f32 v5, v5, v192
  v_mul_f32 v6, v6, v192
  v_mul_f32 v7, v7, v192
  v_cvt_pk_bf16_f32 v0, v0, v1
  v_cvt_pk_bf16_f32 v1, v2, v3
  v_cvt_pk_bf16_f32 v2, v4, v5
  v_cvt_pk_bf16_f32 v3, v6, v7
  buffer_store_dwordx4 v[0:3], v244, s[24:27], s40 offen offset:0
  v_accvgpr_read_b32 v8, a4
  v_accvgpr_read_b32 v9, a5
  v_accvgpr_read_b32 v10, a6
  v_accvgpr_read_b32 v11, a7
  v_accvgpr_read_b32 v12, a20
  v_accvgpr_read_b32 v13, a21
  v_accvgpr_read_b32 v14, a22
  v_accvgpr_read_b32 v15, a23
  v_mul_f32 v8, v8, v196
  v_mul_f32 v9, v9, v196
  v_mul_f32 v10, v10, v196
  v_mul_f32 v11, v11, v196
  v_mul_f32 v12, v12, v196
  v_mul_f32 v13, v13, v196
  v_mul_f32 v14, v14, v196
  v_mul_f32 v15, v15, v196
  v_cvt_pk_bf16_f32 v8, v8, v9
  v_cvt_pk_bf16_f32 v9, v10, v11
  v_cvt_pk_bf16_f32 v10, v12, v13
  v_cvt_pk_bf16_f32 v11, v14, v15
  buffer_store_dwordx4 v[8:11], v244, s[24:27], s40 offen offset:2048
  v_accvgpr_read_b32 v16, a8
  v_accvgpr_read_b32 v17, a9
  v_accvgpr_read_b32 v18, a10
  v_accvgpr_read_b32 v19, a11
  v_accvgpr_read_b32 v20, a24
  v_accvgpr_read_b32 v21, a25
  v_accvgpr_read_b32 v22, a26
  v_accvgpr_read_b32 v23, a27
  v_mul_f32 v16, v16, v200
  v_mul_f32 v17, v17, v200
  v_mul_f32 v18, v18, v200
  v_mul_f32 v19, v19, v200
  v_mul_f32 v20, v20, v200
  v_mul_f32 v21, v21, v200
  v_mul_f32 v22, v22, v200
  v_mul_f32 v23, v23, v200
  v_cvt_pk_bf16_f32 v16, v16, v17
  v_cvt_pk_bf16_f32 v17, v18, v19
  v_cvt_pk_bf16_f32 v18, v20, v21
  v_cvt_pk_bf16_f32 v19, v22, v23
  buffer_store_dwordx4 v[16:19], v244, s[24:27], s41 offen offset:0
  v_accvgpr_read_b32 v24, a12
  v_accvgpr_read_b32 v25, a13
  v_accvgpr_read_b32 v26, a14
  v_accvgpr_read_b32 v27, a15
  v_accvgpr_read_b32 v28, a28
  v_accvgpr_read_b32 v29, a29
  v_accvgpr_read_b32 v30, a30
  v_accvgpr_read_b32 v31, a31
  v_mul_f32 v24, v24, v204
  v_mul_f32 v25, v25, v204
  v_mul_f32 v26, v26, v204
  v_mul_f32 v27, v27, v204
  v_mul_f32 v28, v28, v204
  v_mul_f32 v29, v29, v204
  v_mul_f32 v30, v30, v204
  v_mul_f32 v31, v31, v204
  v_cvt_pk_bf16_f32 v24, v24, v25
  v_cvt_pk_bf16_f32 v25, v26, v27
  v_cvt_pk_bf16_f32 v26, v28, v29
  v_cvt_pk_bf16_f32 v27, v30, v31
  buffer_store_dwordx4 v[24:27], v244, s[24:27], s41 offen offset:2048
  v_accvgpr_read_b32 v32, a32
  v_accvgpr_read_b32 v33, a33
  v_accvgpr_read_b32 v34, a34
  v_accvgpr_read_b32 v35, a35
  v_accvgpr_read_b32 v36, a48
  v_accvgpr_read_b32 v37, a49
  v_accvgpr_read_b32 v38, a50
  v_accvgpr_read_b32 v39, a51
  v_mul_f32 v32, v32, v192
  v_mul_f32 v33, v33, v192
  v_mul_f32 v34, v34, v192
  v_mul_f32 v35, v35, v192
  v_mul_f32 v36, v36, v192
  v_mul_f32 v37, v37, v192
  v_mul_f32 v38, v38, v192
  v_mul_f32 v39, v39, v192
  v_cvt_pk_bf16_f32 v32, v32, v33
  v_cvt_pk_bf16_f32 v33, v34, v35
  v_cvt_pk_bf16_f32 v34, v36, v37
  v_cvt_pk_bf16_f32 v35, v38, v39
  buffer_store_dwordx4 v[32:35], v244, s[24:27], s40 offen offset:1024
  v_accvgpr_read_b32 v40, a36
  v_accvgpr_read_b32 v41, a37
  v_accvgpr_read_b32 v42, a38
  v_accvgpr_read_b32 v43, a39
  v_accvgpr_read_b32 v44, a52
  v_accvgpr_read_b32 v45, a53
  v_accvgpr_read_b32 v46, a54
  v_accvgpr_read_b32 v47, a55
  v_mul_f32 v40, v40, v196
  v_mul_f32 v41, v41, v196
  v_mul_f32 v42, v42, v196
  v_mul_f32 v43, v43, v196
  v_mul_f32 v44, v44, v196
  v_mul_f32 v45, v45, v196
  v_mul_f32 v46, v46, v196
  v_mul_f32 v47, v47, v196
  v_cvt_pk_bf16_f32 v40, v40, v41
  v_cvt_pk_bf16_f32 v41, v42, v43
  v_cvt_pk_bf16_f32 v42, v44, v45
  v_cvt_pk_bf16_f32 v43, v46, v47
  buffer_store_dwordx4 v[40:43], v244, s[24:27], s40 offen offset:3072
  v_accvgpr_read_b32 v48, a40
  v_accvgpr_read_b32 v49, a41
  v_accvgpr_read_b32 v50, a42
  v_accvgpr_read_b32 v51, a43
  v_accvgpr_read_b32 v52, a56
  v_accvgpr_read_b32 v53, a57
  v_accvgpr_read_b32 v54, a58
  v_accvgpr_read_b32 v55, a59
  v_mul_f32 v48, v48, v200
  v_mul_f32 v49, v49, v200
  v_mul_f32 v50, v50, v200
  v_mul_f32 v51, v51, v200
  v_mul_f32 v52, v52, v200
  v_mul_f32 v53, v53, v200
  v_mul_f32 v54, v54, v200
  v_mul_f32 v55, v55, v200
  v_cvt_pk_bf16_f32 v48, v48, v49
  v_cvt_pk_bf16_f32 v49, v50, v51
  v_cvt_pk_bf16_f32 v50, v52, v53
  v_cvt_pk_bf16_f32 v51, v54, v55
  buffer_store_dwordx4 v[48:51], v244, s[24:27], s41 offen offset:1024
  v_accvgpr_read_b32 v56, a44
  v_accvgpr_read_b32 v57, a45
  v_accvgpr_read_b32 v58, a46
  v_accvgpr_read_b32 v59, a47
  v_accvgpr_read_b32 v60, a60
  v_accvgpr_read_b32 v61, a61
  v_accvgpr_read_b32 v62, a62
  v_accvgpr_read_b32 v63, a63
  v_mul_f32 v56, v56, v204
  v_mul_f32 v57, v57, v204
  v_mul_f32 v58, v58, v204
  v_mul_f32 v59, v59, v204
  v_mul_f32 v60, v60, v204
  v_mul_f32 v61, v61, v204
  v_mul_f32 v62, v62, v204
  v_mul_f32 v63, v63, v204
  v_cvt_pk_bf16_f32 v56, v56, v57
  v_cvt_pk_bf16_f32 v57, v58, v59
  v_cvt_pk_bf16_f32 v58, v60, v61
  v_cvt_pk_bf16_f32 v59, v62, v63
  buffer_store_dwordx4 v[56:59], v244, s[24:27], s41 offen offset:3072
  v_accvgpr_read_b32 v0, a64
  v_accvgpr_read_b32 v1, a65
  v_accvgpr_read_b32 v2, a66
  v_accvgpr_read_b32 v3, a67
  v_accvgpr_read_b32 v4, a80
  v_accvgpr_read_b32 v5, a81
  v_accvgpr_read_b32 v6, a82
  v_accvgpr_read_b32 v7, a83
  v_mul_f32 v0, v0, v192
  v_mul_f32 v1, v1, v192
  v_mul_f32 v2, v2, v192
  v_mul_f32 v3, v3, v192
  v_mul_f32 v4, v4, v192
  v_mul_f32 v5, v5, v192
  v_mul_f32 v6, v6, v192
  v_mul_f32 v7, v7, v192
  v_cvt_pk_bf16_f32 v0, v0, v1
  v_cvt_pk_bf16_f32 v1, v2, v3
  v_cvt_pk_bf16_f32 v2, v4, v5
  v_cvt_pk_bf16_f32 v3, v6, v7
  buffer_store_dwordx4 v[0:3], v244, s[24:27], s42 offen offset:0
  v_accvgpr_read_b32 v8, a68
  v_accvgpr_read_b32 v9, a69
  v_accvgpr_read_b32 v10, a70
  v_accvgpr_read_b32 v11, a71
  v_accvgpr_read_b32 v12, a84
  v_accvgpr_read_b32 v13, a85
  v_accvgpr_read_b32 v14, a86
  v_accvgpr_read_b32 v15, a87
  v_mul_f32 v8, v8, v196
  v_mul_f32 v9, v9, v196
  v_mul_f32 v10, v10, v196
  v_mul_f32 v11, v11, v196
  v_mul_f32 v12, v12, v196
  v_mul_f32 v13, v13, v196
  v_mul_f32 v14, v14, v196
  v_mul_f32 v15, v15, v196
  v_cvt_pk_bf16_f32 v8, v8, v9
  v_cvt_pk_bf16_f32 v9, v10, v11
  v_cvt_pk_bf16_f32 v10, v12, v13
  v_cvt_pk_bf16_f32 v11, v14, v15
  buffer_store_dwordx4 v[8:11], v244, s[24:27], s42 offen offset:2048
  v_accvgpr_read_b32 v16, a72
  v_accvgpr_read_b32 v17, a73
  v_accvgpr_read_b32 v18, a74
  v_accvgpr_read_b32 v19, a75
  v_accvgpr_read_b32 v20, a88
  v_accvgpr_read_b32 v21, a89
  v_accvgpr_read_b32 v22, a90
  v_accvgpr_read_b32 v23, a91
  v_mul_f32 v16, v16, v200
  v_mul_f32 v17, v17, v200
  v_mul_f32 v18, v18, v200
  v_mul_f32 v19, v19, v200
  v_mul_f32 v20, v20, v200
  v_mul_f32 v21, v21, v200
  v_mul_f32 v22, v22, v200
  v_mul_f32 v23, v23, v200
  v_cvt_pk_bf16_f32 v16, v16, v17
  v_cvt_pk_bf16_f32 v17, v18, v19
  v_cvt_pk_bf16_f32 v18, v20, v21
  v_cvt_pk_bf16_f32 v19, v22, v23
  buffer_store_dwordx4 v[16:19], v244, s[24:27], s43 offen offset:0
  v_accvgpr_read_b32 v24, a76
  v_accvgpr_read_b32 v25, a77
  v_accvgpr_read_b32 v26, a78
  v_accvgpr_read_b32 v27, a79
  v_accvgpr_read_b32 v28, a92
  v_accvgpr_read_b32 v29, a93
  v_accvgpr_read_b32 v30, a94
  v_accvgpr_read_b32 v31, a95
  v_mul_f32 v24, v24, v204
  v_mul_f32 v25, v25, v204
  v_mul_f32 v26, v26, v204
  v_mul_f32 v27, v27, v204
  v_mul_f32 v28, v28, v204
  v_mul_f32 v29, v29, v204
  v_mul_f32 v30, v30, v204
  v_mul_f32 v31, v31, v204
  v_cvt_pk_bf16_f32 v24, v24, v25
  v_cvt_pk_bf16_f32 v25, v26, v27
  v_cvt_pk_bf16_f32 v26, v28, v29
  v_cvt_pk_bf16_f32 v27, v30, v31
  buffer_store_dwordx4 v[24:27], v244, s[24:27], s43 offen offset:2048
  v_accvgpr_read_b32 v32, a96
  v_accvgpr_read_b32 v33, a97
  v_accvgpr_read_b32 v34, a98
  v_accvgpr_read_b32 v35, a99
  v_accvgpr_read_b32 v36, a112
  v_accvgpr_read_b32 v37, a113
  v_accvgpr_read_b32 v38, a114
  v_accvgpr_read_b32 v39, a115
  v_mul_f32 v32, v32, v192
  v_mul_f32 v33, v33, v192
  v_mul_f32 v34, v34, v192
  v_mul_f32 v35, v35, v192
  v_mul_f32 v36, v36, v192
  v_mul_f32 v37, v37, v192
  v_mul_f32 v38, v38, v192
  v_mul_f32 v39, v39, v192
  v_cvt_pk_bf16_f32 v32, v32, v33
  v_cvt_pk_bf16_f32 v33, v34, v35
  v_cvt_pk_bf16_f32 v34, v36, v37
  v_cvt_pk_bf16_f32 v35, v38, v39
  buffer_store_dwordx4 v[32:35], v244, s[24:27], s42 offen offset:1024
  v_accvgpr_read_b32 v40, a100
  v_accvgpr_read_b32 v41, a101
  v_accvgpr_read_b32 v42, a102
  v_accvgpr_read_b32 v43, a103
  v_accvgpr_read_b32 v44, a116
  v_accvgpr_read_b32 v45, a117
  v_accvgpr_read_b32 v46, a118
  v_accvgpr_read_b32 v47, a119
  v_mul_f32 v40, v40, v196
  v_mul_f32 v41, v41, v196
  v_mul_f32 v42, v42, v196
  v_mul_f32 v43, v43, v196
  v_mul_f32 v44, v44, v196
  v_mul_f32 v45, v45, v196
  v_mul_f32 v46, v46, v196
  v_mul_f32 v47, v47, v196
  v_cvt_pk_bf16_f32 v40, v40, v41
  v_cvt_pk_bf16_f32 v41, v42, v43
  v_cvt_pk_bf16_f32 v42, v44, v45
  v_cvt_pk_bf16_f32 v43, v46, v47
  buffer_store_dwordx4 v[40:43], v244, s[24:27], s42 offen offset:3072
  v_accvgpr_read_b32 v48, a104
  v_accvgpr_read_b32 v49, a105
  v_accvgpr_read_b32 v50, a106
  v_accvgpr_read_b32 v51, a107
  v_accvgpr_read_b32 v52, a120
  v_accvgpr_read_b32 v53, a121
  v_accvgpr_read_b32 v54, a122
  v_accvgpr_read_b32 v55, a123
  v_mul_f32 v48, v48, v200
  v_mul_f32 v49, v49, v200
  v_mul_f32 v50, v50, v200
  v_mul_f32 v51, v51, v200
  v_mul_f32 v52, v52, v200
  v_mul_f32 v53, v53, v200
  v_mul_f32 v54, v54, v200
  v_mul_f32 v55, v55, v200
  v_cvt_pk_bf16_f32 v48, v48, v49
  v_cvt_pk_bf16_f32 v49, v50, v51
  v_cvt_pk_bf16_f32 v50, v52, v53
  v_cvt_pk_bf16_f32 v51, v54, v55
  buffer_store_dwordx4 v[48:51], v244, s[24:27], s43 offen offset:1024
  v_accvgpr_read_b32 v56, a108
  v_accvgpr_read_b32 v57, a109
  v_accvgpr_read_b32 v58, a110
  v_accvgpr_read_b32 v59, a111
  v_accvgpr_read_b32 v60, a124
  v_accvgpr_read_b32 v61, a125
  v_accvgpr_read_b32 v62, a126
  v_accvgpr_read_b32 v63, a127
  v_mul_f32 v56, v56, v204
  v_mul_f32 v57, v57, v204
  v_mul_f32 v58, v58, v204
  v_mul_f32 v59, v59, v204
  v_mul_f32 v60, v60, v204
  v_mul_f32 v61, v61, v204
  v_mul_f32 v62, v62, v204
  v_mul_f32 v63, v63, v204
  v_cvt_pk_bf16_f32 v56, v56, v57
  v_cvt_pk_bf16_f32 v57, v58, v59
  v_cvt_pk_bf16_f32 v58, v60, v61
  v_cvt_pk_bf16_f32 v59, v62, v63
  buffer_store_dwordx4 v[56:59], v244, s[24:27], s43 offen offset:3072
attn_end:
  s_endpgm
.globl out_kernel
.p2align 8
.type out_kernel,@function
out_kernel:
  s_cmp_ge_u32 s2, 256
  s_cbranch_scc1 out_end
  s_load_dwordx2 s[4:5], s[0:1], 0
  s_load_dwordx2 s[6:7], s[0:1], 80
  s_load_dwordx2 s[8:9], s[0:1], 96
  s_getpc_b64 s[46:47]
out_hot_pc:
  s_add_u32 s46, s46, out_hot-out_hot_pc
  s_addc_u32 s47, s47, 0
  v_lshlrev_b32 v122, 7, v0
  v_min_u32 v122, out_end-out_hot-4, v122
  global_load_dword v135, v122, s[46:47]
out_hot:
  v_lshrrev_b32 v122, 6, v0
  v_and_b32 v123, 63, v0
  v_readfirstlane_b32 s3, v122
  s_and_b32 s10, s2, 7
  s_lshr_b32 s11, s2, 3
  s_lshr_b32 s28, s10, 1
  s_lshl_b32 s28, s28, 3
  s_and_b32 s29, s11, 7
  s_add_u32 s28, s28, s29
  s_and_b32 s29, s10, 1
  s_lshl_b32 s29, s29, 2
  s_lshr_b32 s11, s11, 3
  s_add_u32 s29, s29, s11
  v_and_b32 v124, 15, v123
  v_lshrrev_b32 v125, 4, v123
  v_lshlrev_b32 v114, 4, v123
  v_add_u32 v115, 0x1000, v114
  v_add_u32 v116, 0x2000, v114
  s_add_u32 s10, s3, 0
  s_and_b32 s10, s10, 3
  s_lshl_b32 s11, s10, 11
  v_add_u32 v110, s11, v114
  s_add_u32 s10, s3, 1
  s_and_b32 s10, s10, 3
  s_lshl_b32 s11, s10, 11
  v_add_u32 v111, s11, v114
  s_mul_i32 s10, s10, 15360
  s_add_u32 s10, s10, 0
  v_add_u32 v118, s10, v114
  s_add_u32 s10, s3, 2
  s_and_b32 s10, s10, 3
  s_lshl_b32 s11, s10, 11
  v_add_u32 v112, s11, v114
  s_mul_i32 s10, s10, 15360
  s_add_u32 s10, s10, 5120
  v_add_u32 v119, s10, v114
  s_add_u32 s10, s3, 3
  s_and_b32 s10, s10, 3
  s_lshl_b32 s11, s10, 11
  v_add_u32 v113, s11, v114
  s_mul_i32 s10, s10, 15360
  s_add_u32 s10, s10, 10240
  v_add_u32 v120, s10, v114
  s_mul_i32 s10, s3, 15360
  v_add_u32 v121, s10, v114
  s_lshl_b32 s30, s28, 19
  s_lshl_b32 s10, s3, 17
  s_add_u32 s30, s30, s10
  s_add_u32 s30, s30, 8388608
  s_mul_i32 s31, s29, 655360
  s_mul_i32 s10, s3, 163840
  s_add_u32 s31, s31, s10
  s_add_u32 s31, s31, 3145728
  s_lshl_b32 s10, s28, 6
  s_lshl_b32 s11, s3, 4
  s_add_u32 s10, s10, s11
  v_add_u32 v126, s10, v124
  v_mul_u32_u24 v117, 0x500, v126
  v_lshl_add_u32 v117, v125, 3, v117
  s_mul_i32 s11, s29, 160
  v_add_u32 v117, s11, v117
  s_waitcnt lgkmcnt(0)
  s_mov_b32 s24, s8
  s_mov_b32 s25, s9
  s_mov_b32 s26, 25165824
  s_mov_b32 s27, 0x20000
  s_mov_b32 s12, s4
  s_mov_b32 s13, s5
  s_mov_b32 s14, 2621440
  s_mov_b32 s15, 0x20000
  s_mov_b32 s16, s6
  s_mov_b32 s17, s7
  s_mov_b32 s18, 2621440
  s_mov_b32 s19, 0x20000
  s_add_u32 s44, s8, 2629632
  s_addc_u32 s45, s9, 0
  s_load_dwordx8 s[36:43], s[44:45], 0
  s_mul_i32 s10, s28, 81920
  s_lshl_b32 s11, s3, 10
  s_add_u32 s10, s10, s11
  s_mul_i32 s11, s29, 10
  v_lshrrev_b32 v127, 1, v125
  v_add_u32 v127, s11, v127
  v_and_b32 v128, 1, v125
  v_lshlrev_b32 v128, 3, v128
  v_lshl_add_u32 v128, v124, 4, v128
  v_lshrrev_b32 v129, 2, v127
  v_lshl_add_u32 v129, v129, 12, v128
  v_and_b32 v130, 3, v127
  v_lshl_add_u32 v129, v130, 8, v129
  buffer_load_dwordx2 v[136:137], v129, s[24:27], s10 offen
  v_add_u32 v127, 2, v127
  v_lshrrev_b32 v129, 2, v127
  v_lshl_add_u32 v129, v129, 12, v128
  v_and_b32 v130, 3, v127
  v_lshl_add_u32 v129, v130, 8, v129
  buffer_load_dwordx2 v[138:139], v129, s[24:27], s10 offen
  v_add_u32 v127, 2, v127
  v_lshrrev_b32 v129, 2, v127
  v_lshl_add_u32 v129, v129, 12, v128
  v_and_b32 v130, 3, v127
  v_lshl_add_u32 v129, v130, 8, v129
  buffer_load_dwordx2 v[140:141], v129, s[24:27], s10 offen
  v_add_u32 v127, 2, v127
  v_lshrrev_b32 v129, 2, v127
  v_lshl_add_u32 v129, v129, 12, v128
  v_and_b32 v130, 3, v127
  v_lshl_add_u32 v129, v130, 8, v129
  buffer_load_dwordx2 v[142:143], v129, s[24:27], s10 offen
  v_add_u32 v127, 2, v127
  v_lshrrev_b32 v129, 2, v127
  v_lshl_add_u32 v129, v129, 12, v128
  v_and_b32 v130, 3, v127
  v_lshl_add_u32 v129, v130, 8, v129
  buffer_load_dwordx2 v[144:145], v129, s[24:27], s10 offen
  v_add_u32 v127, 2, v127
  buffer_load_dwordx4 a[0:3], v110, s[24:27], s30 offen offset:0
  buffer_load_dwordx4 a[4:7], v110, s[24:27], s30 offen offset:1024
  buffer_load_dwordx4 a[32:35], v114, s[24:27], s31 offen offset:0
  buffer_load_dwordx4 a[52:55], v115, s[24:27], s31 offen offset:1024
  buffer_load_dwordx4 a[8:11], v111, s[24:27], s30 offen offset:0
  buffer_load_dwordx4 a[12:15], v111, s[24:27], s30 offen offset:1024
  buffer_load_dwordx4 a[16:19], v112, s[24:27], s30 offen offset:0
  buffer_load_dwordx4 a[20:23], v112, s[24:27], s30 offen offset:1024
  buffer_load_dwordx4 a[24:27], v113, s[24:27], s30 offen offset:0
  buffer_load_dwordx4 a[28:31], v113, s[24:27], s30 offen offset:1024
  buffer_load_dwordx4 a[36:39], v114, s[24:27], s31 offen offset:1024
  buffer_load_dwordx4 a[56:59], v115, s[24:27], s31 offen offset:2048
  buffer_load_dwordx4 a[40:43], v114, s[24:27], s31 offen offset:2048
  buffer_load_dwordx4 a[60:63], v115, s[24:27], s31 offen offset:3072
  buffer_load_dwordx4 a[44:47], v114, s[24:27], s31 offen offset:3072
  buffer_load_dwordx4 a[64:67], v116, s[24:27], s31 offen offset:0
  buffer_load_dwordx4 a[48:51], v115, s[24:27], s31 offen offset:0
  buffer_load_dwordx4 a[68:71], v116, s[24:27], s31 offen offset:1024
  s_add_u32 s30, s30, 8192
  s_add_u32 s31, s31, 10240
  buffer_load_dwordx4 a[72:75], v110, s[24:27], s30 offen offset:0
  buffer_load_dwordx4 a[76:79], v110, s[24:27], s30 offen offset:1024
  buffer_load_dwordx4 a[104:107], v114, s[24:27], s31 offen offset:0
  buffer_load_dwordx4 a[124:127], v115, s[24:27], s31 offen offset:1024
  buffer_load_dwordx4 a[80:83], v111, s[24:27], s30 offen offset:0
  buffer_load_dwordx4 a[84:87], v111, s[24:27], s30 offen offset:1024
  buffer_load_dwordx4 a[88:91], v112, s[24:27], s30 offen offset:0
  buffer_load_dwordx4 a[92:95], v112, s[24:27], s30 offen offset:1024
  buffer_load_dwordx4 a[96:99], v113, s[24:27], s30 offen offset:0
  buffer_load_dwordx4 a[100:103], v113, s[24:27], s30 offen offset:1024
  buffer_load_dwordx4 a[108:111], v114, s[24:27], s31 offen offset:1024
  buffer_load_dwordx4 a[128:131], v115, s[24:27], s31 offen offset:2048
  buffer_load_dwordx4 a[112:115], v114, s[24:27], s31 offen offset:2048
  buffer_load_dwordx4 a[132:135], v115, s[24:27], s31 offen offset:3072
  buffer_load_dwordx4 a[116:119], v114, s[24:27], s31 offen offset:3072
  buffer_load_dwordx4 a[136:139], v116, s[24:27], s31 offen offset:0
  buffer_load_dwordx4 a[120:123], v115, s[24:27], s31 offen offset:0
  buffer_load_dwordx4 a[140:143], v116, s[24:27], s31 offen offset:1024
  s_add_u32 s30, s30, 8192
  s_add_u32 s31, s31, 10240
  buffer_load_dwordx4 a[144:147], v110, s[24:27], s30 offen offset:0
  buffer_load_dwordx4 a[148:151], v110, s[24:27], s30 offen offset:1024
  buffer_load_dwordx4 a[176:179], v114, s[24:27], s31 offen offset:0
  buffer_load_dwordx4 a[196:199], v115, s[24:27], s31 offen offset:1024
  buffer_load_dwordx4 a[152:155], v111, s[24:27], s30 offen offset:0
  buffer_load_dwordx4 a[156:159], v111, s[24:27], s30 offen offset:1024
  buffer_load_dwordx4 a[160:163], v112, s[24:27], s30 offen offset:0
  buffer_load_dwordx4 a[164:167], v112, s[24:27], s30 offen offset:1024
  buffer_load_dwordx4 a[168:171], v113, s[24:27], s30 offen offset:0
  buffer_load_dwordx4 a[172:175], v113, s[24:27], s30 offen offset:1024
  buffer_load_dwordx4 a[180:183], v114, s[24:27], s31 offen offset:1024
  buffer_load_dwordx4 a[200:203], v115, s[24:27], s31 offen offset:2048
  buffer_load_dwordx4 a[184:187], v114, s[24:27], s31 offen offset:2048
  buffer_load_dwordx4 a[204:207], v115, s[24:27], s31 offen offset:3072
  buffer_load_dwordx4 a[188:191], v114, s[24:27], s31 offen offset:3072
  buffer_load_dwordx4 a[208:211], v116, s[24:27], s31 offen offset:0
  buffer_load_dwordx4 a[192:195], v115, s[24:27], s31 offen offset:0
  buffer_load_dwordx4 a[212:215], v116, s[24:27], s31 offen offset:1024
  s_add_u32 s30, s30, 8192
  s_add_u32 s31, s31, 10240
  s_mov_b32 s33, 0xffff0000
  s_waitcnt vmcnt(58)
  v_lshlrev_b32 v90, 16, v136
  v_and_b32 v91, s33, v136
  v_lshlrev_b32 v92, 16, v137
  v_and_b32 v93, s33, v137
  s_waitcnt vmcnt(57)
  v_lshlrev_b32 v94, 16, v138
  v_and_b32 v95, s33, v138
  v_lshlrev_b32 v96, 16, v139
  v_and_b32 v97, s33, v139
  s_waitcnt vmcnt(56)
  v_lshlrev_b32 v98, 16, v140
  v_and_b32 v99, s33, v140
  v_lshlrev_b32 v100, 16, v141
  v_and_b32 v101, s33, v141
  s_waitcnt vmcnt(55)
  v_lshlrev_b32 v102, 16, v142
  v_and_b32 v103, s33, v142
  v_lshlrev_b32 v104, 16, v143
  v_and_b32 v105, s33, v143
  s_waitcnt vmcnt(54)
  v_lshlrev_b32 v106, 16, v144
  v_and_b32 v107, s33, v144
  v_lshlrev_b32 v108, 16, v145
  v_and_b32 v109, s33, v145
  buffer_load_dwordx2 v[80:81], v117, s[12:15], 0 offen offset:0
  buffer_load_dwordx2 v[82:83], v117, s[12:15], 0 offen offset:32
  buffer_load_dwordx2 v[84:85], v117, s[12:15], 0 offen offset:64
  buffer_load_dwordx2 v[86:87], v117, s[12:15], 0 offen offset:96
  buffer_load_dwordx2 v[88:89], v117, s[12:15], 0 offen offset:128
  v_mov_b32 v127, -1
  s_waitcnt lgkmcnt(0)
  s_and_b32 s36, s36, 0xffff
  s_sub_u32 s36, 0xffff, s36
  v_cmp_eq_u32 vcc, s36, v126
  s_nop 1
  v_cndmask_b32_e64 v127, v127, 0, vcc
  s_and_b32 s37, s37, 0xffff
  s_sub_u32 s37, 0xffff, s37
  v_cmp_eq_u32 vcc, s37, v126
  s_nop 1
  v_cndmask_b32_e64 v127, v127, 1, vcc
  s_and_b32 s38, s38, 0xffff
  s_sub_u32 s38, 0xffff, s38
  v_cmp_eq_u32 vcc, s38, v126
  s_nop 1
  v_cndmask_b32_e64 v127, v127, 2, vcc
  s_and_b32 s39, s39, 0xffff
  s_sub_u32 s39, 0xffff, s39
  v_cmp_eq_u32 vcc, s39, v126
  s_nop 1
  v_cndmask_b32_e64 v127, v127, 3, vcc
  s_and_b32 s40, s40, 0xffff
  s_sub_u32 s40, 0xffff, s40
  v_cmp_eq_u32 vcc, s40, v126
  s_nop 1
  v_cndmask_b32_e64 v127, v127, 4, vcc
  s_and_b32 s41, s41, 0xffff
  s_sub_u32 s41, 0xffff, s41
  v_cmp_eq_u32 vcc, s41, v126
  s_nop 1
  v_cndmask_b32_e64 v127, v127, 5, vcc
  s_and_b32 s42, s42, 0xffff
  s_sub_u32 s42, 0xffff, s42
  v_cmp_eq_u32 vcc, s42, v126
  s_nop 1
  v_cndmask_b32_e64 v127, v127, 6, vcc
  s_and_b32 s43, s43, 0xffff
  s_sub_u32 s43, 0xffff, s43
  v_cmp_eq_u32 vcc, s43, v126
  s_nop 1
  v_cndmask_b32_e64 v127, v127, 7, vcc
  v_cmp_ne_u32 vcc, -1, v127
  s_nop 0
  s_and_saveexec_b64 s[34:35], vcc
  s_cbranch_execz out_noroute
  s_waitcnt vmcnt(28)
  v_lshlrev_b32 v128, 2, v127
  s_mov_b32 s10, 2629632
  buffer_load_dword v129, v128, s[24:27], s10 offen
  v_mul_u32_u24 v128, 0xa00, v127
  v_lshl_add_u32 v128, v125, 4, v128
  s_mul_i32 s10, s29, 320
  s_add_u32 s10, s10, 2686976
  buffer_load_dwordx4 v[0:3], v128, s[24:27], s10 offen offset:0
  buffer_load_dwordx4 v[4:7], v128, s[24:27], s10 offen offset:64
  buffer_load_dwordx4 v[8:11], v128, s[24:27], s10 offen offset:128
  buffer_load_dwordx4 v[12:15], v128, s[24:27], s10 offen offset:192
  buffer_load_dwordx4 v[16:19], v128, s[24:27], s10 offen offset:256
  s_add_u32 s10, s10, 20480
  buffer_load_dwordx4 v[20:23], v128, s[24:27], s10 offen offset:0
  buffer_load_dwordx4 v[24:27], v128, s[24:27], s10 offen offset:64
  buffer_load_dwordx4 v[28:31], v128, s[24:27], s10 offen offset:128
  buffer_load_dwordx4 v[32:35], v128, s[24:27], s10 offen offset:192
  buffer_load_dwordx4 v[36:39], v128, s[24:27], s10 offen offset:256
  s_add_u32 s10, s10, 20480
  buffer_load_dwordx4 v[40:43], v128, s[24:27], s10 offen offset:0
  buffer_load_dwordx4 v[44:47], v128, s[24:27], s10 offen offset:64
  buffer_load_dwordx4 v[48:51], v128, s[24:27], s10 offen offset:128
  buffer_load_dwordx4 v[52:55], v128, s[24:27], s10 offen offset:192
  buffer_load_dwordx4 v[56:59], v128, s[24:27], s10 offen offset:256
  s_add_u32 s10, s10, 20480
  buffer_load_dwordx4 v[60:63], v128, s[24:27], s10 offen offset:0
  buffer_load_dwordx4 v[64:67], v128, s[24:27], s10 offen offset:64
  buffer_load_dwordx4 v[68:71], v128, s[24:27], s10 offen offset:128
  buffer_load_dwordx4 v[72:75], v128, s[24:27], s10 offen offset:192
  buffer_load_dwordx4 v[76:79], v128, s[24:27], s10 offen offset:256
  s_add_u32 s10, s10, 20480
  buffer_load_dwordx4 v[152:155], v128, s[24:27], s10 offen offset:0
  buffer_load_dwordx4 v[156:159], v128, s[24:27], s10 offen offset:64
  buffer_load_dwordx4 v[160:163], v128, s[24:27], s10 offen offset:128
  buffer_load_dwordx4 v[164:167], v128, s[24:27], s10 offen offset:192
  buffer_load_dwordx4 v[168:171], v128, s[24:27], s10 offen offset:256
  s_add_u32 s10, s10, 20480
  buffer_load_dwordx4 v[172:175], v128, s[24:27], s10 offen offset:0
  buffer_load_dwordx4 v[176:179], v128, s[24:27], s10 offen offset:64
  buffer_load_dwordx4 v[180:183], v128, s[24:27], s10 offen offset:128
  buffer_load_dwordx4 v[184:187], v128, s[24:27], s10 offen offset:192
  buffer_load_dwordx4 v[188:191], v128, s[24:27], s10 offen offset:256
  s_add_u32 s10, s10, 20480
  s_waitcnt vmcnt(0)
  v_ashrrev_i32 v130, 31, v129
  v_not_b32 v130, v130
  v_or_b32 v130, 0x80000000, v130
  v_xor_b32 v129, v129, v130
  v_and_b32 v129, s33, v129
  v_mul_f32 v129, 0xbfb8aa3b, v129
  v_exp_f32 v129, v129
  s_nop 0
  v_add_f32 v129, 1.0, v129
  v_rcp_f32 v129, v129
  s_nop 0
  v_cvt_pk_bf16_f32 v129, v129, v129
  v_lshlrev_b32 v129, 16, v129
  v_add_f32 v0, v0, v20
  v_add_f32 v0, v0, v40
  v_add_f32 v0, v0, v60
  v_add_f32 v0, v0, v152
  v_add_f32 v0, v0, v172
  v_cvt_pk_bf16_f32 v0, v0, v0
  v_lshlrev_b32 v0, 16, v0
  v_mul_f32 v0, v0, v129
  v_cvt_pk_bf16_f32 v0, v0, v0
  v_lshlrev_b32 v0, 16, v0
  v_add_f32 v90, v90, v0
  v_cvt_pk_bf16_f32 v90, v90, v90
  v_lshlrev_b32 v90, 16, v90
  v_add_f32 v1, v1, v21
  v_add_f32 v1, v1, v41
  v_add_f32 v1, v1, v61
  v_add_f32 v1, v1, v153
  v_add_f32 v1, v1, v173
  v_cvt_pk_bf16_f32 v1, v1, v1
  v_lshlrev_b32 v1, 16, v1
  v_mul_f32 v1, v1, v129
  v_cvt_pk_bf16_f32 v1, v1, v1
  v_lshlrev_b32 v1, 16, v1
  v_add_f32 v91, v91, v1
  v_cvt_pk_bf16_f32 v91, v91, v91
  v_lshlrev_b32 v91, 16, v91
  v_add_f32 v2, v2, v22
  v_add_f32 v2, v2, v42
  v_add_f32 v2, v2, v62
  v_add_f32 v2, v2, v154
  v_add_f32 v2, v2, v174
  v_cvt_pk_bf16_f32 v2, v2, v2
  v_lshlrev_b32 v2, 16, v2
  v_mul_f32 v2, v2, v129
  v_cvt_pk_bf16_f32 v2, v2, v2
  v_lshlrev_b32 v2, 16, v2
  v_add_f32 v92, v92, v2
  v_cvt_pk_bf16_f32 v92, v92, v92
  v_lshlrev_b32 v92, 16, v92
  v_add_f32 v3, v3, v23
  v_add_f32 v3, v3, v43
  v_add_f32 v3, v3, v63
  v_add_f32 v3, v3, v155
  v_add_f32 v3, v3, v175
  v_cvt_pk_bf16_f32 v3, v3, v3
  v_lshlrev_b32 v3, 16, v3
  v_mul_f32 v3, v3, v129
  v_cvt_pk_bf16_f32 v3, v3, v3
  v_lshlrev_b32 v3, 16, v3
  v_add_f32 v93, v93, v3
  v_cvt_pk_bf16_f32 v93, v93, v93
  v_lshlrev_b32 v93, 16, v93
  v_add_f32 v4, v4, v24
  v_add_f32 v4, v4, v44
  v_add_f32 v4, v4, v64
  v_add_f32 v4, v4, v156
  v_add_f32 v4, v4, v176
  v_cvt_pk_bf16_f32 v4, v4, v4
  v_lshlrev_b32 v4, 16, v4
  v_mul_f32 v4, v4, v129
  v_cvt_pk_bf16_f32 v4, v4, v4
  v_lshlrev_b32 v4, 16, v4
  v_add_f32 v94, v94, v4
  v_cvt_pk_bf16_f32 v94, v94, v94
  v_lshlrev_b32 v94, 16, v94
  v_add_f32 v5, v5, v25
  v_add_f32 v5, v5, v45
  v_add_f32 v5, v5, v65
  v_add_f32 v5, v5, v157
  v_add_f32 v5, v5, v177
  v_cvt_pk_bf16_f32 v5, v5, v5
  v_lshlrev_b32 v5, 16, v5
  v_mul_f32 v5, v5, v129
  v_cvt_pk_bf16_f32 v5, v5, v5
  v_lshlrev_b32 v5, 16, v5
  v_add_f32 v95, v95, v5
  v_cvt_pk_bf16_f32 v95, v95, v95
  v_lshlrev_b32 v95, 16, v95
  v_add_f32 v6, v6, v26
  v_add_f32 v6, v6, v46
  v_add_f32 v6, v6, v66
  v_add_f32 v6, v6, v158
  v_add_f32 v6, v6, v178
  v_cvt_pk_bf16_f32 v6, v6, v6
  v_lshlrev_b32 v6, 16, v6
  v_mul_f32 v6, v6, v129
  v_cvt_pk_bf16_f32 v6, v6, v6
  v_lshlrev_b32 v6, 16, v6
  v_add_f32 v96, v96, v6
  v_cvt_pk_bf16_f32 v96, v96, v96
  v_lshlrev_b32 v96, 16, v96
  v_add_f32 v7, v7, v27
  v_add_f32 v7, v7, v47
  v_add_f32 v7, v7, v67
  v_add_f32 v7, v7, v159
  v_add_f32 v7, v7, v179
  v_cvt_pk_bf16_f32 v7, v7, v7
  v_lshlrev_b32 v7, 16, v7
  v_mul_f32 v7, v7, v129
  v_cvt_pk_bf16_f32 v7, v7, v7
  v_lshlrev_b32 v7, 16, v7
  v_add_f32 v97, v97, v7
  v_cvt_pk_bf16_f32 v97, v97, v97
  v_lshlrev_b32 v97, 16, v97
  v_add_f32 v8, v8, v28
  v_add_f32 v8, v8, v48
  v_add_f32 v8, v8, v68
  v_add_f32 v8, v8, v160
  v_add_f32 v8, v8, v180
  v_cvt_pk_bf16_f32 v8, v8, v8
  v_lshlrev_b32 v8, 16, v8
  v_mul_f32 v8, v8, v129
  v_cvt_pk_bf16_f32 v8, v8, v8
  v_lshlrev_b32 v8, 16, v8
  v_add_f32 v98, v98, v8
  v_cvt_pk_bf16_f32 v98, v98, v98
  v_lshlrev_b32 v98, 16, v98
  v_add_f32 v9, v9, v29
  v_add_f32 v9, v9, v49
  v_add_f32 v9, v9, v69
  v_add_f32 v9, v9, v161
  v_add_f32 v9, v9, v181
  v_cvt_pk_bf16_f32 v9, v9, v9
  v_lshlrev_b32 v9, 16, v9
  v_mul_f32 v9, v9, v129
  v_cvt_pk_bf16_f32 v9, v9, v9
  v_lshlrev_b32 v9, 16, v9
  v_add_f32 v99, v99, v9
  v_cvt_pk_bf16_f32 v99, v99, v99
  v_lshlrev_b32 v99, 16, v99
  v_add_f32 v10, v10, v30
  v_add_f32 v10, v10, v50
  v_add_f32 v10, v10, v70
  v_add_f32 v10, v10, v162
  v_add_f32 v10, v10, v182
  v_cvt_pk_bf16_f32 v10, v10, v10
  v_lshlrev_b32 v10, 16, v10
  v_mul_f32 v10, v10, v129
  v_cvt_pk_bf16_f32 v10, v10, v10
  v_lshlrev_b32 v10, 16, v10
  v_add_f32 v100, v100, v10
  v_cvt_pk_bf16_f32 v100, v100, v100
  v_lshlrev_b32 v100, 16, v100
  v_add_f32 v11, v11, v31
  v_add_f32 v11, v11, v51
  v_add_f32 v11, v11, v71
  v_add_f32 v11, v11, v163
  v_add_f32 v11, v11, v183
  v_cvt_pk_bf16_f32 v11, v11, v11
  v_lshlrev_b32 v11, 16, v11
  v_mul_f32 v11, v11, v129
  v_cvt_pk_bf16_f32 v11, v11, v11
  v_lshlrev_b32 v11, 16, v11
  v_add_f32 v101, v101, v11
  v_cvt_pk_bf16_f32 v101, v101, v101
  v_lshlrev_b32 v101, 16, v101
  v_add_f32 v12, v12, v32
  v_add_f32 v12, v12, v52
  v_add_f32 v12, v12, v72
  v_add_f32 v12, v12, v164
  v_add_f32 v12, v12, v184
  v_cvt_pk_bf16_f32 v12, v12, v12
  v_lshlrev_b32 v12, 16, v12
  v_mul_f32 v12, v12, v129
  v_cvt_pk_bf16_f32 v12, v12, v12
  v_lshlrev_b32 v12, 16, v12
  v_add_f32 v102, v102, v12
  v_cvt_pk_bf16_f32 v102, v102, v102
  v_lshlrev_b32 v102, 16, v102
  v_add_f32 v13, v13, v33
  v_add_f32 v13, v13, v53
  v_add_f32 v13, v13, v73
  v_add_f32 v13, v13, v165
  v_add_f32 v13, v13, v185
  v_cvt_pk_bf16_f32 v13, v13, v13
  v_lshlrev_b32 v13, 16, v13
  v_mul_f32 v13, v13, v129
  v_cvt_pk_bf16_f32 v13, v13, v13
  v_lshlrev_b32 v13, 16, v13
  v_add_f32 v103, v103, v13
  v_cvt_pk_bf16_f32 v103, v103, v103
  v_lshlrev_b32 v103, 16, v103
  v_add_f32 v14, v14, v34
  v_add_f32 v14, v14, v54
  v_add_f32 v14, v14, v74
  v_add_f32 v14, v14, v166
  v_add_f32 v14, v14, v186
  v_cvt_pk_bf16_f32 v14, v14, v14
  v_lshlrev_b32 v14, 16, v14
  v_mul_f32 v14, v14, v129
  v_cvt_pk_bf16_f32 v14, v14, v14
  v_lshlrev_b32 v14, 16, v14
  v_add_f32 v104, v104, v14
  v_cvt_pk_bf16_f32 v104, v104, v104
  v_lshlrev_b32 v104, 16, v104
  v_add_f32 v15, v15, v35
  v_add_f32 v15, v15, v55
  v_add_f32 v15, v15, v75
  v_add_f32 v15, v15, v167
  v_add_f32 v15, v15, v187
  v_cvt_pk_bf16_f32 v15, v15, v15
  v_lshlrev_b32 v15, 16, v15
  v_mul_f32 v15, v15, v129
  v_cvt_pk_bf16_f32 v15, v15, v15
  v_lshlrev_b32 v15, 16, v15
  v_add_f32 v105, v105, v15
  v_cvt_pk_bf16_f32 v105, v105, v105
  v_lshlrev_b32 v105, 16, v105
  v_add_f32 v16, v16, v36
  v_add_f32 v16, v16, v56
  v_add_f32 v16, v16, v76
  v_add_f32 v16, v16, v168
  v_add_f32 v16, v16, v188
  v_cvt_pk_bf16_f32 v16, v16, v16
  v_lshlrev_b32 v16, 16, v16
  v_mul_f32 v16, v16, v129
  v_cvt_pk_bf16_f32 v16, v16, v16
  v_lshlrev_b32 v16, 16, v16
  v_add_f32 v106, v106, v16
  v_cvt_pk_bf16_f32 v106, v106, v106
  v_lshlrev_b32 v106, 16, v106
  v_add_f32 v17, v17, v37
  v_add_f32 v17, v17, v57
  v_add_f32 v17, v17, v77
  v_add_f32 v17, v17, v169
  v_add_f32 v17, v17, v189
  v_cvt_pk_bf16_f32 v17, v17, v17
  v_lshlrev_b32 v17, 16, v17
  v_mul_f32 v17, v17, v129
  v_cvt_pk_bf16_f32 v17, v17, v17
  v_lshlrev_b32 v17, 16, v17
  v_add_f32 v107, v107, v17
  v_cvt_pk_bf16_f32 v107, v107, v107
  v_lshlrev_b32 v107, 16, v107
  v_add_f32 v18, v18, v38
  v_add_f32 v18, v18, v58
  v_add_f32 v18, v18, v78
  v_add_f32 v18, v18, v170
  v_add_f32 v18, v18, v190
  v_cvt_pk_bf16_f32 v18, v18, v18
  v_lshlrev_b32 v18, 16, v18
  v_mul_f32 v18, v18, v129
  v_cvt_pk_bf16_f32 v18, v18, v18
  v_lshlrev_b32 v18, 16, v18
  v_add_f32 v108, v108, v18
  v_cvt_pk_bf16_f32 v108, v108, v108
  v_lshlrev_b32 v108, 16, v108
  v_add_f32 v19, v19, v39
  v_add_f32 v19, v19, v59
  v_add_f32 v19, v19, v79
  v_add_f32 v19, v19, v171
  v_add_f32 v19, v19, v191
  v_cvt_pk_bf16_f32 v19, v19, v19
  v_lshlrev_b32 v19, 16, v19
  v_mul_f32 v19, v19, v129
  v_cvt_pk_bf16_f32 v19, v19, v19
  v_lshlrev_b32 v19, 16, v19
  v_add_f32 v109, v109, v19
  v_cvt_pk_bf16_f32 v109, v109, v109
  v_lshlrev_b32 v109, 16, v109
out_noroute:
  s_mov_b64 exec, s[34:35]
  v_mov_b32 v0, 0
  v_mov_b32 v1, 0
  v_mov_b32 v2, 0
  v_mov_b32 v3, 0
  v_mov_b32 v4, 0
  v_mov_b32 v5, 0
  v_mov_b32 v6, 0
  v_mov_b32 v7, 0
  v_mov_b32 v8, 0
  v_mov_b32 v9, 0
  v_mov_b32 v10, 0
  v_mov_b32 v11, 0
  v_mov_b32 v12, 0
  v_mov_b32 v13, 0
  v_mov_b32 v14, 0
  v_mov_b32 v15, 0
  v_mov_b32 v16, 0
  v_mov_b32 v17, 0
  v_mov_b32 v18, 0
  v_mov_b32 v19, 0
  v_mov_b32 v20, 0
  v_mov_b32 v21, 0
  v_mov_b32 v22, 0
  v_mov_b32 v23, 0
  v_mov_b32 v24, 0
  v_mov_b32 v25, 0
  v_mov_b32 v26, 0
  v_mov_b32 v27, 0
  v_mov_b32 v28, 0
  v_mov_b32 v29, 0
  v_mov_b32 v30, 0
  v_mov_b32 v31, 0
  v_mov_b32 v32, 0
  v_mov_b32 v33, 0
  v_mov_b32 v34, 0
  v_mov_b32 v35, 0
  v_mov_b32 v36, 0
  v_mov_b32 v37, 0
  v_mov_b32 v38, 0
  v_mov_b32 v39, 0
  v_mov_b32 v40, 0
  v_mov_b32 v41, 0
  v_mov_b32 v42, 0
  v_mov_b32 v43, 0
  v_mov_b32 v44, 0
  v_mov_b32 v45, 0
  v_mov_b32 v46, 0
  v_mov_b32 v47, 0
  v_mov_b32 v48, 0
  v_mov_b32 v49, 0
  v_mov_b32 v50, 0
  v_mov_b32 v51, 0
  v_mov_b32 v52, 0
  v_mov_b32 v53, 0
  v_mov_b32 v54, 0
  v_mov_b32 v55, 0
  v_mov_b32 v56, 0
  v_mov_b32 v57, 0
  v_mov_b32 v58, 0
  v_mov_b32 v59, 0
  v_mov_b32 v60, 0
  v_mov_b32 v61, 0
  v_mov_b32 v62, 0
  v_mov_b32 v63, 0
  v_mov_b32 v64, 0
  v_mov_b32 v65, 0
  v_mov_b32 v66, 0
  v_mov_b32 v67, 0
  v_mov_b32 v68, 0
  v_mov_b32 v69, 0
  v_mov_b32 v70, 0
  v_mov_b32 v71, 0
  v_mov_b32 v72, 0
  v_mov_b32 v73, 0
  v_mov_b32 v74, 0
  v_mov_b32 v75, 0
  v_mov_b32 v76, 0
  v_mov_b32 v77, 0
  v_mov_b32 v78, 0
  v_mov_b32 v79, 0
  s_mov_b32 s32, 3
out_loop:
  s_waitcnt vmcnt(44)
  v_mfma_f32_16x16x32_bf16 v[0:3], a[32:35], a[0:3], v[0:3]
  buffer_load_dwordx4 v[136:139], v110, s[24:27], s30 offen offset:0
  v_mfma_f32_16x16x32_bf16 v[0:3], a[52:55], a[4:7], v[0:3]
  buffer_load_dwordx4 v[140:143], v110, s[24:27], s30 offen offset:1024
  v_mfma_f32_16x16x32_bf16 v[4:7], a[52:55], a[12:15], v[4:7]
  buffer_load_dwordx4 v[168:171], v114, s[24:27], s31 offen offset:0
  v_mfma_f32_16x16x32_bf16 v[4:7], a[32:35], a[8:11], v[4:7]
  buffer_load_dwordx4 v[188:191], v115, s[24:27], s31 offen offset:1024
  v_mfma_f32_16x16x32_bf16 v[8:11], a[32:35], a[16:19], v[8:11]
  buffer_load_dwordx4 v[144:147], v111, s[24:27], s30 offen offset:0
  v_mfma_f32_16x16x32_bf16 v[8:11], a[52:55], a[20:23], v[8:11]
  buffer_load_dwordx4 v[148:151], v111, s[24:27], s30 offen offset:1024
  v_mfma_f32_16x16x32_bf16 v[12:15], a[52:55], a[28:31], v[12:15]
  s_waitcnt vmcnt(42)
  buffer_load_dwordx4 v[152:155], v112, s[24:27], s30 offen offset:0
  v_mfma_f32_16x16x32_bf16 v[12:15], a[32:35], a[24:27], v[12:15]
  buffer_load_dwordx4 v[156:159], v112, s[24:27], s30 offen offset:1024
  v_mfma_f32_16x16x32_bf16 v[16:19], a[36:39], a[0:3], v[16:19]
  buffer_load_dwordx4 v[160:163], v113, s[24:27], s30 offen offset:0
  v_mfma_f32_16x16x32_bf16 v[16:19], a[56:59], a[4:7], v[16:19]
  buffer_load_dwordx4 v[164:167], v113, s[24:27], s30 offen offset:1024
  v_mfma_f32_16x16x32_bf16 v[20:23], a[56:59], a[12:15], v[20:23]
  buffer_load_dwordx4 v[172:175], v114, s[24:27], s31 offen offset:1024
  v_mfma_f32_16x16x32_bf16 v[20:23], a[36:39], a[8:11], v[20:23]
  buffer_load_dwordx4 v[192:195], v115, s[24:27], s31 offen offset:2048
  v_mfma_f32_16x16x32_bf16 v[24:27], a[36:39], a[16:19], v[24:27]
  buffer_load_dwordx4 v[176:179], v114, s[24:27], s31 offen offset:2048
  v_mfma_f32_16x16x32_bf16 v[24:27], a[56:59], a[20:23], v[24:27]
  buffer_load_dwordx4 v[196:199], v115, s[24:27], s31 offen offset:3072
  v_mfma_f32_16x16x32_bf16 v[28:31], a[56:59], a[28:31], v[28:31]
  buffer_load_dwordx4 v[180:183], v114, s[24:27], s31 offen offset:3072
  v_mfma_f32_16x16x32_bf16 v[28:31], a[36:39], a[24:27], v[28:31]
  buffer_load_dwordx4 v[200:203], v116, s[24:27], s31 offen offset:0
  v_mfma_f32_16x16x32_bf16 v[32:35], a[40:43], a[0:3], v[32:35]
  buffer_load_dwordx4 v[184:187], v115, s[24:27], s31 offen offset:0
  v_mfma_f32_16x16x32_bf16 v[32:35], a[60:63], a[4:7], v[32:35]
  buffer_load_dwordx4 v[204:207], v116, s[24:27], s31 offen offset:1024
  s_add_u32 s30, s30, 8192
  s_add_u32 s31, s31, 10240
  v_mfma_f32_16x16x32_bf16 v[36:39], a[60:63], a[12:15], v[36:39]
  v_mfma_f32_16x16x32_bf16 v[36:39], a[40:43], a[8:11], v[36:39]
  v_mfma_f32_16x16x32_bf16 v[40:43], a[40:43], a[16:19], v[40:43]
  v_mfma_f32_16x16x32_bf16 v[40:43], a[60:63], a[20:23], v[40:43]
  v_mfma_f32_16x16x32_bf16 v[44:47], a[60:63], a[28:31], v[44:47]
  v_mfma_f32_16x16x32_bf16 v[44:47], a[40:43], a[24:27], v[44:47]
  v_mfma_f32_16x16x32_bf16 v[48:51], a[44:47], a[0:3], v[48:51]
  v_mfma_f32_16x16x32_bf16 v[48:51], a[64:67], a[4:7], v[48:51]
  v_mfma_f32_16x16x32_bf16 v[52:55], a[64:67], a[12:15], v[52:55]
  v_mfma_f32_16x16x32_bf16 v[52:55], a[44:47], a[8:11], v[52:55]
  v_mfma_f32_16x16x32_bf16 v[56:59], a[44:47], a[16:19], v[56:59]
  v_mfma_f32_16x16x32_bf16 v[56:59], a[64:67], a[20:23], v[56:59]
  v_mfma_f32_16x16x32_bf16 v[60:63], a[64:67], a[28:31], v[60:63]
  v_mfma_f32_16x16x32_bf16 v[60:63], a[44:47], a[24:27], v[60:63]
  v_mfma_f32_16x16x32_bf16 v[64:67], a[48:51], a[0:3], v[64:67]
  v_mfma_f32_16x16x32_bf16 v[64:67], a[68:71], a[4:7], v[64:67]
  v_mfma_f32_16x16x32_bf16 v[68:71], a[68:71], a[12:15], v[68:71]
  v_mfma_f32_16x16x32_bf16 v[68:71], a[48:51], a[8:11], v[68:71]
  v_mfma_f32_16x16x32_bf16 v[72:75], a[48:51], a[16:19], v[72:75]
  v_mfma_f32_16x16x32_bf16 v[72:75], a[68:71], a[20:23], v[72:75]
  v_mfma_f32_16x16x32_bf16 v[76:79], a[68:71], a[28:31], v[76:79]
  v_mfma_f32_16x16x32_bf16 v[76:79], a[48:51], a[24:27], v[76:79]
  s_waitcnt vmcnt(44)
  v_mfma_f32_16x16x32_bf16 v[0:3], a[104:107], a[72:75], v[0:3]
  buffer_load_dwordx4 a[0:3], v110, s[24:27], s30 offen offset:0
  v_mfma_f32_16x16x32_bf16 v[0:3], a[124:127], a[76:79], v[0:3]
  buffer_load_dwordx4 a[4:7], v110, s[24:27], s30 offen offset:1024
  v_mfma_f32_16x16x32_bf16 v[4:7], a[124:127], a[84:87], v[4:7]
  buffer_load_dwordx4 a[32:35], v114, s[24:27], s31 offen offset:0
  v_mfma_f32_16x16x32_bf16 v[4:7], a[104:107], a[80:83], v[4:7]
  buffer_load_dwordx4 a[52:55], v115, s[24:27], s31 offen offset:1024
  v_mfma_f32_16x16x32_bf16 v[8:11], a[104:107], a[88:91], v[8:11]
  buffer_load_dwordx4 a[8:11], v111, s[24:27], s30 offen offset:0
  v_mfma_f32_16x16x32_bf16 v[8:11], a[124:127], a[92:95], v[8:11]
  buffer_load_dwordx4 a[12:15], v111, s[24:27], s30 offen offset:1024
  v_mfma_f32_16x16x32_bf16 v[12:15], a[124:127], a[100:103], v[12:15]
  s_waitcnt vmcnt(42)
  buffer_load_dwordx4 a[16:19], v112, s[24:27], s30 offen offset:0
  v_mfma_f32_16x16x32_bf16 v[12:15], a[104:107], a[96:99], v[12:15]
  buffer_load_dwordx4 a[20:23], v112, s[24:27], s30 offen offset:1024
  v_mfma_f32_16x16x32_bf16 v[16:19], a[108:111], a[72:75], v[16:19]
  buffer_load_dwordx4 a[24:27], v113, s[24:27], s30 offen offset:0
  v_mfma_f32_16x16x32_bf16 v[16:19], a[128:131], a[76:79], v[16:19]
  buffer_load_dwordx4 a[28:31], v113, s[24:27], s30 offen offset:1024
  v_mfma_f32_16x16x32_bf16 v[20:23], a[128:131], a[84:87], v[20:23]
  buffer_load_dwordx4 a[36:39], v114, s[24:27], s31 offen offset:1024
  v_mfma_f32_16x16x32_bf16 v[20:23], a[108:111], a[80:83], v[20:23]
  buffer_load_dwordx4 a[56:59], v115, s[24:27], s31 offen offset:2048
  v_mfma_f32_16x16x32_bf16 v[24:27], a[108:111], a[88:91], v[24:27]
  buffer_load_dwordx4 a[40:43], v114, s[24:27], s31 offen offset:2048
  v_mfma_f32_16x16x32_bf16 v[24:27], a[128:131], a[92:95], v[24:27]
  buffer_load_dwordx4 a[60:63], v115, s[24:27], s31 offen offset:3072
  v_mfma_f32_16x16x32_bf16 v[28:31], a[128:131], a[100:103], v[28:31]
  buffer_load_dwordx4 a[44:47], v114, s[24:27], s31 offen offset:3072
  v_mfma_f32_16x16x32_bf16 v[28:31], a[108:111], a[96:99], v[28:31]
  buffer_load_dwordx4 a[64:67], v116, s[24:27], s31 offen offset:0
  v_mfma_f32_16x16x32_bf16 v[32:35], a[112:115], a[72:75], v[32:35]
  buffer_load_dwordx4 a[48:51], v115, s[24:27], s31 offen offset:0
  v_mfma_f32_16x16x32_bf16 v[32:35], a[132:135], a[76:79], v[32:35]
  buffer_load_dwordx4 a[68:71], v116, s[24:27], s31 offen offset:1024
  s_add_u32 s30, s30, 8192
  s_add_u32 s31, s31, 10240
  v_mfma_f32_16x16x32_bf16 v[36:39], a[132:135], a[84:87], v[36:39]
  v_mfma_f32_16x16x32_bf16 v[36:39], a[112:115], a[80:83], v[36:39]
  v_mfma_f32_16x16x32_bf16 v[40:43], a[112:115], a[88:91], v[40:43]
  v_mfma_f32_16x16x32_bf16 v[40:43], a[132:135], a[92:95], v[40:43]
  v_mfma_f32_16x16x32_bf16 v[44:47], a[132:135], a[100:103], v[44:47]
  v_mfma_f32_16x16x32_bf16 v[44:47], a[112:115], a[96:99], v[44:47]
  v_mfma_f32_16x16x32_bf16 v[48:51], a[116:119], a[72:75], v[48:51]
  v_mfma_f32_16x16x32_bf16 v[48:51], a[136:139], a[76:79], v[48:51]
  v_mfma_f32_16x16x32_bf16 v[52:55], a[136:139], a[84:87], v[52:55]
  v_mfma_f32_16x16x32_bf16 v[52:55], a[116:119], a[80:83], v[52:55]
  v_mfma_f32_16x16x32_bf16 v[56:59], a[116:119], a[88:91], v[56:59]
  v_mfma_f32_16x16x32_bf16 v[56:59], a[136:139], a[92:95], v[56:59]
  v_mfma_f32_16x16x32_bf16 v[60:63], a[136:139], a[100:103], v[60:63]
  v_mfma_f32_16x16x32_bf16 v[60:63], a[116:119], a[96:99], v[60:63]
  v_mfma_f32_16x16x32_bf16 v[64:67], a[120:123], a[72:75], v[64:67]
  v_mfma_f32_16x16x32_bf16 v[64:67], a[140:143], a[76:79], v[64:67]
  v_mfma_f32_16x16x32_bf16 v[68:71], a[140:143], a[84:87], v[68:71]
  v_mfma_f32_16x16x32_bf16 v[68:71], a[120:123], a[80:83], v[68:71]
  v_mfma_f32_16x16x32_bf16 v[72:75], a[120:123], a[88:91], v[72:75]
  v_mfma_f32_16x16x32_bf16 v[72:75], a[140:143], a[92:95], v[72:75]
  v_mfma_f32_16x16x32_bf16 v[76:79], a[140:143], a[100:103], v[76:79]
  v_mfma_f32_16x16x32_bf16 v[76:79], a[120:123], a[96:99], v[76:79]
  s_waitcnt vmcnt(44)
  v_mfma_f32_16x16x32_bf16 v[0:3], a[176:179], a[144:147], v[0:3]
  buffer_load_dwordx4 a[72:75], v110, s[24:27], s30 offen offset:0
  v_mfma_f32_16x16x32_bf16 v[0:3], a[196:199], a[148:151], v[0:3]
  buffer_load_dwordx4 a[76:79], v110, s[24:27], s30 offen offset:1024
  v_mfma_f32_16x16x32_bf16 v[4:7], a[196:199], a[156:159], v[4:7]
  buffer_load_dwordx4 a[104:107], v114, s[24:27], s31 offen offset:0
  v_mfma_f32_16x16x32_bf16 v[4:7], a[176:179], a[152:155], v[4:7]
  buffer_load_dwordx4 a[124:127], v115, s[24:27], s31 offen offset:1024
  v_mfma_f32_16x16x32_bf16 v[8:11], a[176:179], a[160:163], v[8:11]
  buffer_load_dwordx4 a[80:83], v111, s[24:27], s30 offen offset:0
  v_mfma_f32_16x16x32_bf16 v[8:11], a[196:199], a[164:167], v[8:11]
  buffer_load_dwordx4 a[84:87], v111, s[24:27], s30 offen offset:1024
  v_mfma_f32_16x16x32_bf16 v[12:15], a[196:199], a[172:175], v[12:15]
  s_waitcnt vmcnt(42)
  buffer_load_dwordx4 a[88:91], v112, s[24:27], s30 offen offset:0
  v_mfma_f32_16x16x32_bf16 v[12:15], a[176:179], a[168:171], v[12:15]
  buffer_load_dwordx4 a[92:95], v112, s[24:27], s30 offen offset:1024
  v_mfma_f32_16x16x32_bf16 v[16:19], a[180:183], a[144:147], v[16:19]
  buffer_load_dwordx4 a[96:99], v113, s[24:27], s30 offen offset:0
  v_mfma_f32_16x16x32_bf16 v[16:19], a[200:203], a[148:151], v[16:19]
  buffer_load_dwordx4 a[100:103], v113, s[24:27], s30 offen offset:1024
  v_mfma_f32_16x16x32_bf16 v[20:23], a[200:203], a[156:159], v[20:23]
  buffer_load_dwordx4 a[108:111], v114, s[24:27], s31 offen offset:1024
  v_mfma_f32_16x16x32_bf16 v[20:23], a[180:183], a[152:155], v[20:23]
  buffer_load_dwordx4 a[128:131], v115, s[24:27], s31 offen offset:2048
  v_mfma_f32_16x16x32_bf16 v[24:27], a[180:183], a[160:163], v[24:27]
  buffer_load_dwordx4 a[112:115], v114, s[24:27], s31 offen offset:2048
  v_mfma_f32_16x16x32_bf16 v[24:27], a[200:203], a[164:167], v[24:27]
  buffer_load_dwordx4 a[132:135], v115, s[24:27], s31 offen offset:3072
  v_mfma_f32_16x16x32_bf16 v[28:31], a[200:203], a[172:175], v[28:31]
  buffer_load_dwordx4 a[116:119], v114, s[24:27], s31 offen offset:3072
  v_mfma_f32_16x16x32_bf16 v[28:31], a[180:183], a[168:171], v[28:31]
  buffer_load_dwordx4 a[136:139], v116, s[24:27], s31 offen offset:0
  v_mfma_f32_16x16x32_bf16 v[32:35], a[184:187], a[144:147], v[32:35]
  buffer_load_dwordx4 a[120:123], v115, s[24:27], s31 offen offset:0
  v_mfma_f32_16x16x32_bf16 v[32:35], a[204:207], a[148:151], v[32:35]
  buffer_load_dwordx4 a[140:143], v116, s[24:27], s31 offen offset:1024
  s_add_u32 s30, s30, 8192
  s_add_u32 s31, s31, 10240
  v_mfma_f32_16x16x32_bf16 v[36:39], a[204:207], a[156:159], v[36:39]
  v_mfma_f32_16x16x32_bf16 v[36:39], a[184:187], a[152:155], v[36:39]
  v_mfma_f32_16x16x32_bf16 v[40:43], a[184:187], a[160:163], v[40:43]
  v_mfma_f32_16x16x32_bf16 v[40:43], a[204:207], a[164:167], v[40:43]
  v_mfma_f32_16x16x32_bf16 v[44:47], a[204:207], a[172:175], v[44:47]
  v_mfma_f32_16x16x32_bf16 v[44:47], a[184:187], a[168:171], v[44:47]
  v_mfma_f32_16x16x32_bf16 v[48:51], a[188:191], a[144:147], v[48:51]
  v_mfma_f32_16x16x32_bf16 v[48:51], a[208:211], a[148:151], v[48:51]
  v_mfma_f32_16x16x32_bf16 v[52:55], a[208:211], a[156:159], v[52:55]
  v_mfma_f32_16x16x32_bf16 v[52:55], a[188:191], a[152:155], v[52:55]
  v_mfma_f32_16x16x32_bf16 v[56:59], a[188:191], a[160:163], v[56:59]
  v_mfma_f32_16x16x32_bf16 v[56:59], a[208:211], a[164:167], v[56:59]
  v_mfma_f32_16x16x32_bf16 v[60:63], a[208:211], a[172:175], v[60:63]
  v_mfma_f32_16x16x32_bf16 v[60:63], a[188:191], a[168:171], v[60:63]
  v_mfma_f32_16x16x32_bf16 v[64:67], a[192:195], a[144:147], v[64:67]
  v_mfma_f32_16x16x32_bf16 v[64:67], a[212:215], a[148:151], v[64:67]
  v_mfma_f32_16x16x32_bf16 v[68:71], a[212:215], a[156:159], v[68:71]
  v_mfma_f32_16x16x32_bf16 v[68:71], a[192:195], a[152:155], v[68:71]
  v_mfma_f32_16x16x32_bf16 v[72:75], a[192:195], a[160:163], v[72:75]
  v_mfma_f32_16x16x32_bf16 v[72:75], a[212:215], a[164:167], v[72:75]
  v_mfma_f32_16x16x32_bf16 v[76:79], a[212:215], a[172:175], v[76:79]
  v_mfma_f32_16x16x32_bf16 v[76:79], a[192:195], a[168:171], v[76:79]
  s_waitcnt vmcnt(44)
  v_mfma_f32_16x16x32_bf16 v[0:3], v[168:171], v[136:139], v[0:3]
  buffer_load_dwordx4 a[144:147], v110, s[24:27], s30 offen offset:0
  v_mfma_f32_16x16x32_bf16 v[0:3], v[188:191], v[140:143], v[0:3]
  buffer_load_dwordx4 a[148:151], v110, s[24:27], s30 offen offset:1024
  v_mfma_f32_16x16x32_bf16 v[4:7], v[188:191], v[148:151], v[4:7]
  buffer_load_dwordx4 a[176:179], v114, s[24:27], s31 offen offset:0
  v_mfma_f32_16x16x32_bf16 v[4:7], v[168:171], v[144:147], v[4:7]
  buffer_load_dwordx4 a[196:199], v115, s[24:27], s31 offen offset:1024
  v_mfma_f32_16x16x32_bf16 v[8:11], v[168:171], v[152:155], v[8:11]
  buffer_load_dwordx4 a[152:155], v111, s[24:27], s30 offen offset:0
  v_mfma_f32_16x16x32_bf16 v[8:11], v[188:191], v[156:159], v[8:11]
  buffer_load_dwordx4 a[156:159], v111, s[24:27], s30 offen offset:1024
  v_mfma_f32_16x16x32_bf16 v[12:15], v[188:191], v[164:167], v[12:15]
  s_waitcnt vmcnt(42)
  buffer_load_dwordx4 a[160:163], v112, s[24:27], s30 offen offset:0
  v_mfma_f32_16x16x32_bf16 v[12:15], v[168:171], v[160:163], v[12:15]
  buffer_load_dwordx4 a[164:167], v112, s[24:27], s30 offen offset:1024
  v_mfma_f32_16x16x32_bf16 v[16:19], v[172:175], v[136:139], v[16:19]
  buffer_load_dwordx4 a[168:171], v113, s[24:27], s30 offen offset:0
  v_mfma_f32_16x16x32_bf16 v[16:19], v[192:195], v[140:143], v[16:19]
  buffer_load_dwordx4 a[172:175], v113, s[24:27], s30 offen offset:1024
  v_mfma_f32_16x16x32_bf16 v[20:23], v[192:195], v[148:151], v[20:23]
  buffer_load_dwordx4 a[180:183], v114, s[24:27], s31 offen offset:1024
  v_mfma_f32_16x16x32_bf16 v[20:23], v[172:175], v[144:147], v[20:23]
  buffer_load_dwordx4 a[200:203], v115, s[24:27], s31 offen offset:2048
  v_mfma_f32_16x16x32_bf16 v[24:27], v[172:175], v[152:155], v[24:27]
  buffer_load_dwordx4 a[184:187], v114, s[24:27], s31 offen offset:2048
  v_mfma_f32_16x16x32_bf16 v[24:27], v[192:195], v[156:159], v[24:27]
  buffer_load_dwordx4 a[204:207], v115, s[24:27], s31 offen offset:3072
  v_mfma_f32_16x16x32_bf16 v[28:31], v[192:195], v[164:167], v[28:31]
  buffer_load_dwordx4 a[188:191], v114, s[24:27], s31 offen offset:3072
  v_mfma_f32_16x16x32_bf16 v[28:31], v[172:175], v[160:163], v[28:31]
  buffer_load_dwordx4 a[208:211], v116, s[24:27], s31 offen offset:0
  v_mfma_f32_16x16x32_bf16 v[32:35], v[176:179], v[136:139], v[32:35]
  buffer_load_dwordx4 a[192:195], v115, s[24:27], s31 offen offset:0
  v_mfma_f32_16x16x32_bf16 v[32:35], v[196:199], v[140:143], v[32:35]
  buffer_load_dwordx4 a[212:215], v116, s[24:27], s31 offen offset:1024
  s_add_u32 s30, s30, 8192
  s_add_u32 s31, s31, 10240
  v_mfma_f32_16x16x32_bf16 v[36:39], v[196:199], v[148:151], v[36:39]
  v_mfma_f32_16x16x32_bf16 v[36:39], v[176:179], v[144:147], v[36:39]
  v_mfma_f32_16x16x32_bf16 v[40:43], v[176:179], v[152:155], v[40:43]
  v_mfma_f32_16x16x32_bf16 v[40:43], v[196:199], v[156:159], v[40:43]
  v_mfma_f32_16x16x32_bf16 v[44:47], v[196:199], v[164:167], v[44:47]
  v_mfma_f32_16x16x32_bf16 v[44:47], v[176:179], v[160:163], v[44:47]
  v_mfma_f32_16x16x32_bf16 v[48:51], v[180:183], v[136:139], v[48:51]
  v_mfma_f32_16x16x32_bf16 v[48:51], v[200:203], v[140:143], v[48:51]
  v_mfma_f32_16x16x32_bf16 v[52:55], v[200:203], v[148:151], v[52:55]
  v_mfma_f32_16x16x32_bf16 v[52:55], v[180:183], v[144:147], v[52:55]
  v_mfma_f32_16x16x32_bf16 v[56:59], v[180:183], v[152:155], v[56:59]
  v_mfma_f32_16x16x32_bf16 v[56:59], v[200:203], v[156:159], v[56:59]
  v_mfma_f32_16x16x32_bf16 v[60:63], v[200:203], v[164:167], v[60:63]
  s_sub_u32 s32, s32, 1
  s_cmp_lg_u32 s32, 0
  v_mfma_f32_16x16x32_bf16 v[60:63], v[180:183], v[160:163], v[60:63]
  v_mfma_f32_16x16x32_bf16 v[64:67], v[184:187], v[136:139], v[64:67]
  v_mfma_f32_16x16x32_bf16 v[64:67], v[204:207], v[140:143], v[64:67]
  v_mfma_f32_16x16x32_bf16 v[68:71], v[204:207], v[148:151], v[68:71]
  v_mfma_f32_16x16x32_bf16 v[68:71], v[184:187], v[144:147], v[68:71]
  v_mfma_f32_16x16x32_bf16 v[72:75], v[184:187], v[152:155], v[72:75]
  v_mfma_f32_16x16x32_bf16 v[72:75], v[204:207], v[156:159], v[72:75]
  v_mfma_f32_16x16x32_bf16 v[76:79], v[204:207], v[164:167], v[76:79]
  v_mfma_f32_16x16x32_bf16 v[76:79], v[184:187], v[160:163], v[76:79]
  s_cbranch_scc1 out_loop
  s_waitcnt vmcnt(44)
  v_mfma_f32_16x16x32_bf16 v[0:3], a[32:35], a[0:3], v[0:3]
  buffer_load_dwordx4 v[136:139], v110, s[24:27], s30 offen offset:0
  v_mfma_f32_16x16x32_bf16 v[0:3], a[52:55], a[4:7], v[0:3]
  buffer_load_dwordx4 v[140:143], v110, s[24:27], s30 offen offset:1024
  v_mfma_f32_16x16x32_bf16 v[4:7], a[52:55], a[12:15], v[4:7]
  buffer_load_dwordx4 v[168:171], v114, s[24:27], s31 offen offset:0
  v_mfma_f32_16x16x32_bf16 v[4:7], a[32:35], a[8:11], v[4:7]
  buffer_load_dwordx4 v[188:191], v115, s[24:27], s31 offen offset:1024
  v_mfma_f32_16x16x32_bf16 v[8:11], a[32:35], a[16:19], v[8:11]
  buffer_load_dwordx4 v[144:147], v111, s[24:27], s30 offen offset:0
  v_mfma_f32_16x16x32_bf16 v[8:11], a[52:55], a[20:23], v[8:11]
  buffer_load_dwordx4 v[148:151], v111, s[24:27], s30 offen offset:1024
  v_mfma_f32_16x16x32_bf16 v[12:15], a[52:55], a[28:31], v[12:15]
  s_waitcnt vmcnt(42)
  buffer_load_dwordx4 v[152:155], v112, s[24:27], s30 offen offset:0
  v_mfma_f32_16x16x32_bf16 v[12:15], a[32:35], a[24:27], v[12:15]
  buffer_load_dwordx4 v[156:159], v112, s[24:27], s30 offen offset:1024
  v_mfma_f32_16x16x32_bf16 v[16:19], a[36:39], a[0:3], v[16:19]
  buffer_load_dwordx4 v[160:163], v113, s[24:27], s30 offen offset:0
  v_mfma_f32_16x16x32_bf16 v[16:19], a[56:59], a[4:7], v[16:19]
  buffer_load_dwordx4 v[164:167], v113, s[24:27], s30 offen offset:1024
  v_mfma_f32_16x16x32_bf16 v[20:23], a[56:59], a[12:15], v[20:23]
  buffer_load_dwordx4 v[172:175], v114, s[24:27], s31 offen offset:1024
  v_mfma_f32_16x16x32_bf16 v[20:23], a[36:39], a[8:11], v[20:23]
  buffer_load_dwordx4 v[192:195], v115, s[24:27], s31 offen offset:2048
  v_mfma_f32_16x16x32_bf16 v[24:27], a[36:39], a[16:19], v[24:27]
  buffer_load_dwordx4 v[176:179], v114, s[24:27], s31 offen offset:2048
  v_mfma_f32_16x16x32_bf16 v[24:27], a[56:59], a[20:23], v[24:27]
  buffer_load_dwordx4 v[196:199], v115, s[24:27], s31 offen offset:3072
  v_mfma_f32_16x16x32_bf16 v[28:31], a[56:59], a[28:31], v[28:31]
  buffer_load_dwordx4 v[180:183], v114, s[24:27], s31 offen offset:3072
  v_mfma_f32_16x16x32_bf16 v[28:31], a[36:39], a[24:27], v[28:31]
  buffer_load_dwordx4 v[200:203], v116, s[24:27], s31 offen offset:0
  v_mfma_f32_16x16x32_bf16 v[32:35], a[40:43], a[0:3], v[32:35]
  buffer_load_dwordx4 v[184:187], v115, s[24:27], s31 offen offset:0
  v_mfma_f32_16x16x32_bf16 v[32:35], a[60:63], a[4:7], v[32:35]
  buffer_load_dwordx4 v[204:207], v116, s[24:27], s31 offen offset:1024
  s_add_u32 s30, s30, 8192
  s_add_u32 s31, s31, 10240
  v_mfma_f32_16x16x32_bf16 v[36:39], a[60:63], a[12:15], v[36:39]
  v_mul_f32 v128, 0xbfb8aa3b, v90
  v_mul_f32 v129, 0xbfb8aa3b, v91
  v_mfma_f32_16x16x32_bf16 v[36:39], a[40:43], a[8:11], v[36:39]
  v_mul_f32 v130, 0xbfb8aa3b, v92
  v_mul_f32 v131, 0xbfb8aa3b, v93
  v_mfma_f32_16x16x32_bf16 v[40:43], a[40:43], a[16:19], v[40:43]
  v_exp_f32 v128, v128
  v_mfma_f32_16x16x32_bf16 v[40:43], a[60:63], a[20:23], v[40:43]
  v_exp_f32 v129, v129
  v_mfma_f32_16x16x32_bf16 v[44:47], a[60:63], a[28:31], v[44:47]
  v_exp_f32 v130, v130
  v_mfma_f32_16x16x32_bf16 v[44:47], a[40:43], a[24:27], v[44:47]
  v_exp_f32 v131, v131
  v_mfma_f32_16x16x32_bf16 v[48:51], a[44:47], a[0:3], v[48:51]
  v_add_f32 v128, 1.0, v128
  v_add_f32 v129, 1.0, v129
  v_mfma_f32_16x16x32_bf16 v[48:51], a[64:67], a[4:7], v[48:51]
  v_add_f32 v130, 1.0, v130
  v_add_f32 v131, 1.0, v131
  v_mfma_f32_16x16x32_bf16 v[52:55], a[64:67], a[12:15], v[52:55]
  v_rcp_f32 v128, v128
  v_mfma_f32_16x16x32_bf16 v[52:55], a[44:47], a[8:11], v[52:55]
  v_rcp_f32 v129, v129
  v_mfma_f32_16x16x32_bf16 v[56:59], a[44:47], a[16:19], v[56:59]
  v_rcp_f32 v130, v130
  v_mfma_f32_16x16x32_bf16 v[56:59], a[64:67], a[20:23], v[56:59]
  v_rcp_f32 v131, v131
  v_mfma_f32_16x16x32_bf16 v[60:63], a[64:67], a[28:31], v[60:63]
  v_mul_f32 v90, v90, v128
  v_mul_f32 v91, v91, v129
  v_mfma_f32_16x16x32_bf16 v[60:63], a[44:47], a[24:27], v[60:63]
  v_mul_f32 v92, v92, v130
  v_mul_f32 v93, v93, v131
  v_mfma_f32_16x16x32_bf16 v[64:67], a[48:51], a[0:3], v[64:67]
  v_cvt_pk_bf16_f32 v90, v90, v90
  v_cvt_pk_bf16_f32 v91, v91, v91
  v_mfma_f32_16x16x32_bf16 v[64:67], a[68:71], a[4:7], v[64:67]
  v_cvt_pk_bf16_f32 v92, v92, v92
  v_cvt_pk_bf16_f32 v93, v93, v93
  v_mfma_f32_16x16x32_bf16 v[68:71], a[68:71], a[12:15], v[68:71]
  v_lshlrev_b32 v90, 16, v90
  v_lshlrev_b32 v91, 16, v91
  v_mfma_f32_16x16x32_bf16 v[68:71], a[48:51], a[8:11], v[68:71]
  v_lshlrev_b32 v92, 16, v92
  v_lshlrev_b32 v93, 16, v93
  v_mfma_f32_16x16x32_bf16 v[72:75], a[48:51], a[16:19], v[72:75]
  v_mul_f32 v128, 0xbfb8aa3b, v94
  v_mul_f32 v129, 0xbfb8aa3b, v95
  v_mfma_f32_16x16x32_bf16 v[72:75], a[68:71], a[20:23], v[72:75]
  v_mul_f32 v130, 0xbfb8aa3b, v96
  v_mul_f32 v131, 0xbfb8aa3b, v97
  v_mfma_f32_16x16x32_bf16 v[76:79], a[68:71], a[28:31], v[76:79]
  v_exp_f32 v128, v128
  v_mfma_f32_16x16x32_bf16 v[76:79], a[48:51], a[24:27], v[76:79]
  v_exp_f32 v129, v129
  s_waitcnt vmcnt(44)
  v_mfma_f32_16x16x32_bf16 v[0:3], a[104:107], a[72:75], v[0:3]
  v_exp_f32 v130, v130
  v_mfma_f32_16x16x32_bf16 v[0:3], a[124:127], a[76:79], v[0:3]
  v_exp_f32 v131, v131
  v_mfma_f32_16x16x32_bf16 v[4:7], a[124:127], a[84:87], v[4:7]
  v_add_f32 v128, 1.0, v128
  v_add_f32 v129, 1.0, v129
  v_mfma_f32_16x16x32_bf16 v[4:7], a[104:107], a[80:83], v[4:7]
  v_add_f32 v130, 1.0, v130
  v_add_f32 v131, 1.0, v131
  v_mfma_f32_16x16x32_bf16 v[8:11], a[104:107], a[88:91], v[8:11]
  v_rcp_f32 v128, v128
  v_mfma_f32_16x16x32_bf16 v[8:11], a[124:127], a[92:95], v[8:11]
  v_rcp_f32 v129, v129
  v_mfma_f32_16x16x32_bf16 v[12:15], a[124:127], a[100:103], v[12:15]
  s_waitcnt vmcnt(36)
  v_rcp_f32 v130, v130
  v_mfma_f32_16x16x32_bf16 v[12:15], a[104:107], a[96:99], v[12:15]
  v_rcp_f32 v131, v131
  v_mfma_f32_16x16x32_bf16 v[16:19], a[108:111], a[72:75], v[16:19]
  v_mul_f32 v94, v94, v128
  v_mul_f32 v95, v95, v129
  v_mfma_f32_16x16x32_bf16 v[16:19], a[128:131], a[76:79], v[16:19]
  v_mul_f32 v96, v96, v130
  v_mul_f32 v97, v97, v131
  v_mfma_f32_16x16x32_bf16 v[20:23], a[128:131], a[84:87], v[20:23]
  v_cvt_pk_bf16_f32 v94, v94, v94
  v_cvt_pk_bf16_f32 v95, v95, v95
  v_mfma_f32_16x16x32_bf16 v[20:23], a[108:111], a[80:83], v[20:23]
  v_cvt_pk_bf16_f32 v96, v96, v96
  v_cvt_pk_bf16_f32 v97, v97, v97
  v_mfma_f32_16x16x32_bf16 v[24:27], a[108:111], a[88:91], v[24:27]
  v_lshlrev_b32 v94, 16, v94
  v_lshlrev_b32 v95, 16, v95
  v_mfma_f32_16x16x32_bf16 v[24:27], a[128:131], a[92:95], v[24:27]
  v_lshlrev_b32 v96, 16, v96
  v_lshlrev_b32 v97, 16, v97
  v_mfma_f32_16x16x32_bf16 v[28:31], a[128:131], a[100:103], v[28:31]
  v_mul_f32 v128, 0xbfb8aa3b, v98
  v_mul_f32 v129, 0xbfb8aa3b, v99
  v_mfma_f32_16x16x32_bf16 v[28:31], a[108:111], a[96:99], v[28:31]
  v_mul_f32 v130, 0xbfb8aa3b, v100
  v_mul_f32 v131, 0xbfb8aa3b, v101
  v_mfma_f32_16x16x32_bf16 v[32:35], a[112:115], a[72:75], v[32:35]
  v_exp_f32 v128, v128
  v_mfma_f32_16x16x32_bf16 v[32:35], a[132:135], a[76:79], v[32:35]
  v_exp_f32 v129, v129
  v_mfma_f32_16x16x32_bf16 v[36:39], a[132:135], a[84:87], v[36:39]
  v_exp_f32 v130, v130
  v_mfma_f32_16x16x32_bf16 v[36:39], a[112:115], a[80:83], v[36:39]
  v_exp_f32 v131, v131
  v_mfma_f32_16x16x32_bf16 v[40:43], a[112:115], a[88:91], v[40:43]
  v_add_f32 v128, 1.0, v128
  v_add_f32 v129, 1.0, v129
  v_mfma_f32_16x16x32_bf16 v[40:43], a[132:135], a[92:95], v[40:43]
  v_add_f32 v130, 1.0, v130
  v_add_f32 v131, 1.0, v131
  v_mfma_f32_16x16x32_bf16 v[44:47], a[132:135], a[100:103], v[44:47]
  v_rcp_f32 v128, v128
  v_mfma_f32_16x16x32_bf16 v[44:47], a[112:115], a[96:99], v[44:47]
  v_rcp_f32 v129, v129
  v_mfma_f32_16x16x32_bf16 v[48:51], a[116:119], a[72:75], v[48:51]
  v_rcp_f32 v130, v130
  v_mfma_f32_16x16x32_bf16 v[48:51], a[136:139], a[76:79], v[48:51]
  v_rcp_f32 v131, v131
  v_mfma_f32_16x16x32_bf16 v[52:55], a[136:139], a[84:87], v[52:55]
  v_mul_f32 v98, v98, v128
  v_mul_f32 v99, v99, v129
  v_mfma_f32_16x16x32_bf16 v[52:55], a[116:119], a[80:83], v[52:55]
  v_mul_f32 v100, v100, v130
  v_mul_f32 v101, v101, v131
  v_mfma_f32_16x16x32_bf16 v[56:59], a[116:119], a[88:91], v[56:59]
  v_cvt_pk_bf16_f32 v98, v98, v98
  v_cvt_pk_bf16_f32 v99, v99, v99
  v_mfma_f32_16x16x32_bf16 v[56:59], a[136:139], a[92:95], v[56:59]
  v_cvt_pk_bf16_f32 v100, v100, v100
  v_cvt_pk_bf16_f32 v101, v101, v101
  v_mfma_f32_16x16x32_bf16 v[60:63], a[136:139], a[100:103], v[60:63]
  v_lshlrev_b32 v98, 16, v98
  v_lshlrev_b32 v99, 16, v99
  v_mfma_f32_16x16x32_bf16 v[60:63], a[116:119], a[96:99], v[60:63]
  v_lshlrev_b32 v100, 16, v100
  v_lshlrev_b32 v101, 16, v101
  v_mfma_f32_16x16x32_bf16 v[64:67], a[120:123], a[72:75], v[64:67]
  v_mul_f32 v128, 0xbfb8aa3b, v102
  v_mul_f32 v129, 0xbfb8aa3b, v103
  v_mfma_f32_16x16x32_bf16 v[64:67], a[140:143], a[76:79], v[64:67]
  v_mul_f32 v130, 0xbfb8aa3b, v104
  v_mul_f32 v131, 0xbfb8aa3b, v105
  v_mfma_f32_16x16x32_bf16 v[68:71], a[140:143], a[84:87], v[68:71]
  v_exp_f32 v128, v128
  v_mfma_f32_16x16x32_bf16 v[68:71], a[120:123], a[80:83], v[68:71]
  v_exp_f32 v129, v129
  v_mfma_f32_16x16x32_bf16 v[72:75], a[120:123], a[88:91], v[72:75]
  v_exp_f32 v130, v130
  v_mfma_f32_16x16x32_bf16 v[72:75], a[140:143], a[92:95], v[72:75]
  v_exp_f32 v131, v131
  v_mfma_f32_16x16x32_bf16 v[76:79], a[140:143], a[100:103], v[76:79]
  v_add_f32 v128, 1.0, v128
  v_add_f32 v129, 1.0, v129
  v_mfma_f32_16x16x32_bf16 v[76:79], a[120:123], a[96:99], v[76:79]
  v_add_f32 v130, 1.0, v130
  v_add_f32 v131, 1.0, v131
  s_waitcnt vmcnt(26)
  v_mfma_f32_16x16x32_bf16 v[0:3], a[176:179], a[144:147], v[0:3]
  v_rcp_f32 v128, v128
  v_mfma_f32_16x16x32_bf16 v[0:3], a[196:199], a[148:151], v[0:3]
  v_rcp_f32 v129, v129
  v_mfma_f32_16x16x32_bf16 v[4:7], a[196:199], a[156:159], v[4:7]
  v_rcp_f32 v130, v130
  v_mfma_f32_16x16x32_bf16 v[4:7], a[176:179], a[152:155], v[4:7]
  v_rcp_f32 v131, v131
  v_mfma_f32_16x16x32_bf16 v[8:11], a[176:179], a[160:163], v[8:11]
  v_mul_f32 v102, v102, v128
  v_mul_f32 v103, v103, v129
  v_mfma_f32_16x16x32_bf16 v[8:11], a[196:199], a[164:167], v[8:11]
  v_mul_f32 v104, v104, v130
  v_mul_f32 v105, v105, v131
  v_mfma_f32_16x16x32_bf16 v[12:15], a[196:199], a[172:175], v[12:15]
  s_waitcnt vmcnt(18)
  v_cvt_pk_bf16_f32 v102, v102, v102
  v_cvt_pk_bf16_f32 v103, v103, v103
  v_mfma_f32_16x16x32_bf16 v[12:15], a[176:179], a[168:171], v[12:15]
  v_cvt_pk_bf16_f32 v104, v104, v104
  v_cvt_pk_bf16_f32 v105, v105, v105
  v_mfma_f32_16x16x32_bf16 v[16:19], a[180:183], a[144:147], v[16:19]
  v_lshlrev_b32 v102, 16, v102
  v_lshlrev_b32 v103, 16, v103
  v_mfma_f32_16x16x32_bf16 v[16:19], a[200:203], a[148:151], v[16:19]
  v_lshlrev_b32 v104, 16, v104
  v_lshlrev_b32 v105, 16, v105
  v_mfma_f32_16x16x32_bf16 v[20:23], a[200:203], a[156:159], v[20:23]
  v_mul_f32 v128, 0xbfb8aa3b, v106
  v_mul_f32 v129, 0xbfb8aa3b, v107
  v_mfma_f32_16x16x32_bf16 v[20:23], a[180:183], a[152:155], v[20:23]
  v_mul_f32 v130, 0xbfb8aa3b, v108
  v_mul_f32 v131, 0xbfb8aa3b, v109
  v_mfma_f32_16x16x32_bf16 v[24:27], a[180:183], a[160:163], v[24:27]
  v_exp_f32 v128, v128
  v_mfma_f32_16x16x32_bf16 v[24:27], a[200:203], a[164:167], v[24:27]
  v_exp_f32 v129, v129
  v_mfma_f32_16x16x32_bf16 v[28:31], a[200:203], a[172:175], v[28:31]
  v_exp_f32 v130, v130
  v_mfma_f32_16x16x32_bf16 v[28:31], a[180:183], a[168:171], v[28:31]
  v_exp_f32 v131, v131
  v_mfma_f32_16x16x32_bf16 v[32:35], a[184:187], a[144:147], v[32:35]
  v_add_f32 v128, 1.0, v128
  v_add_f32 v129, 1.0, v129
  v_mfma_f32_16x16x32_bf16 v[32:35], a[204:207], a[148:151], v[32:35]
  v_add_f32 v130, 1.0, v130
  v_add_f32 v131, 1.0, v131
  v_mfma_f32_16x16x32_bf16 v[36:39], a[204:207], a[156:159], v[36:39]
  v_rcp_f32 v128, v128
  v_mfma_f32_16x16x32_bf16 v[36:39], a[184:187], a[152:155], v[36:39]
  v_rcp_f32 v129, v129
  v_mfma_f32_16x16x32_bf16 v[40:43], a[184:187], a[160:163], v[40:43]
  v_rcp_f32 v130, v130
  v_mfma_f32_16x16x32_bf16 v[40:43], a[204:207], a[164:167], v[40:43]
  v_rcp_f32 v131, v131
  v_mfma_f32_16x16x32_bf16 v[44:47], a[204:207], a[172:175], v[44:47]
  v_mul_f32 v106, v106, v128
  v_mul_f32 v107, v107, v129
  v_mfma_f32_16x16x32_bf16 v[44:47], a[184:187], a[168:171], v[44:47]
  v_mul_f32 v108, v108, v130
  v_mul_f32 v109, v109, v131
  v_mfma_f32_16x16x32_bf16 v[48:51], a[188:191], a[144:147], v[48:51]
  v_cvt_pk_bf16_f32 v106, v106, v106
  v_cvt_pk_bf16_f32 v107, v107, v107
  v_mfma_f32_16x16x32_bf16 v[48:51], a[208:211], a[148:151], v[48:51]
  v_cvt_pk_bf16_f32 v108, v108, v108
  v_cvt_pk_bf16_f32 v109, v109, v109
  v_mfma_f32_16x16x32_bf16 v[52:55], a[208:211], a[156:159], v[52:55]
  v_lshlrev_b32 v106, 16, v106
  v_lshlrev_b32 v107, 16, v107
  v_mfma_f32_16x16x32_bf16 v[52:55], a[188:191], a[152:155], v[52:55]
  v_lshlrev_b32 v108, 16, v108
  v_lshlrev_b32 v109, 16, v109
  v_mfma_f32_16x16x32_bf16 v[56:59], a[188:191], a[160:163], v[56:59]
  v_mfma_f32_16x16x32_bf16 v[56:59], a[208:211], a[164:167], v[56:59]
  v_mfma_f32_16x16x32_bf16 v[60:63], a[208:211], a[172:175], v[60:63]
  v_mfma_f32_16x16x32_bf16 v[60:63], a[188:191], a[168:171], v[60:63]
  v_mfma_f32_16x16x32_bf16 v[64:67], a[192:195], a[144:147], v[64:67]
  v_mfma_f32_16x16x32_bf16 v[64:67], a[212:215], a[148:151], v[64:67]
  v_mfma_f32_16x16x32_bf16 v[68:71], a[212:215], a[156:159], v[68:71]
  v_mfma_f32_16x16x32_bf16 v[68:71], a[192:195], a[152:155], v[68:71]
  v_mfma_f32_16x16x32_bf16 v[72:75], a[192:195], a[160:163], v[72:75]
  v_mfma_f32_16x16x32_bf16 v[72:75], a[212:215], a[164:167], v[72:75]
  v_mfma_f32_16x16x32_bf16 v[76:79], a[212:215], a[172:175], v[76:79]
  v_mfma_f32_16x16x32_bf16 v[76:79], a[192:195], a[168:171], v[76:79]
  s_waitcnt vmcnt(8)
  v_mfma_f32_16x16x32_bf16 v[0:3], v[168:171], v[136:139], v[0:3]
  v_mfma_f32_16x16x32_bf16 v[0:3], v[188:191], v[140:143], v[0:3]
  v_mfma_f32_16x16x32_bf16 v[4:7], v[188:191], v[148:151], v[4:7]
  v_mfma_f32_16x16x32_bf16 v[4:7], v[168:171], v[144:147], v[4:7]
  v_mfma_f32_16x16x32_bf16 v[8:11], v[168:171], v[152:155], v[8:11]
  v_mfma_f32_16x16x32_bf16 v[8:11], v[188:191], v[156:159], v[8:11]
  v_mfma_f32_16x16x32_bf16 v[12:15], v[188:191], v[164:167], v[12:15]
  s_waitcnt vmcnt(0)
  v_mfma_f32_16x16x32_bf16 v[12:15], v[168:171], v[160:163], v[12:15]
  v_mfma_f32_16x16x32_bf16 v[16:19], v[172:175], v[136:139], v[16:19]
  v_mfma_f32_16x16x32_bf16 v[16:19], v[192:195], v[140:143], v[16:19]
  v_mfma_f32_16x16x32_bf16 v[20:23], v[192:195], v[148:151], v[20:23]
  v_mfma_f32_16x16x32_bf16 v[20:23], v[172:175], v[144:147], v[20:23]
  v_mfma_f32_16x16x32_bf16 v[24:27], v[172:175], v[152:155], v[24:27]
  v_mfma_f32_16x16x32_bf16 v[24:27], v[192:195], v[156:159], v[24:27]
  v_mfma_f32_16x16x32_bf16 v[28:31], v[192:195], v[164:167], v[28:31]
  v_mfma_f32_16x16x32_bf16 v[28:31], v[172:175], v[160:163], v[28:31]
  v_mfma_f32_16x16x32_bf16 v[32:35], v[176:179], v[136:139], v[32:35]
  v_mfma_f32_16x16x32_bf16 v[32:35], v[196:199], v[140:143], v[32:35]
  v_mfma_f32_16x16x32_bf16 v[36:39], v[196:199], v[148:151], v[36:39]
  v_mfma_f32_16x16x32_bf16 v[36:39], v[176:179], v[144:147], v[36:39]
  v_mfma_f32_16x16x32_bf16 v[40:43], v[176:179], v[152:155], v[40:43]
  v_mfma_f32_16x16x32_bf16 v[40:43], v[196:199], v[156:159], v[40:43]
  v_mfma_f32_16x16x32_bf16 v[44:47], v[196:199], v[164:167], v[44:47]
  v_mfma_f32_16x16x32_bf16 v[44:47], v[176:179], v[160:163], v[44:47]
  v_mfma_f32_16x16x32_bf16 v[48:51], v[180:183], v[136:139], v[48:51]
  v_mfma_f32_16x16x32_bf16 v[48:51], v[200:203], v[140:143], v[48:51]
  v_mfma_f32_16x16x32_bf16 v[52:55], v[200:203], v[148:151], v[52:55]
  v_mfma_f32_16x16x32_bf16 v[52:55], v[180:183], v[144:147], v[52:55]
  v_mfma_f32_16x16x32_bf16 v[56:59], v[180:183], v[152:155], v[56:59]
  v_mfma_f32_16x16x32_bf16 v[56:59], v[200:203], v[156:159], v[56:59]
  v_mfma_f32_16x16x32_bf16 v[60:63], v[200:203], v[164:167], v[60:63]
  v_mfma_f32_16x16x32_bf16 v[60:63], v[180:183], v[160:163], v[60:63]
  v_mfma_f32_16x16x32_bf16 v[64:67], v[184:187], v[136:139], v[64:67]
  v_mfma_f32_16x16x32_bf16 v[64:67], v[204:207], v[140:143], v[64:67]
  v_mfma_f32_16x16x32_bf16 v[68:71], v[204:207], v[148:151], v[68:71]
  v_mfma_f32_16x16x32_bf16 v[68:71], v[184:187], v[144:147], v[68:71]
  v_mfma_f32_16x16x32_bf16 v[72:75], v[184:187], v[152:155], v[72:75]
  v_mfma_f32_16x16x32_bf16 v[72:75], v[204:207], v[156:159], v[72:75]
  v_mfma_f32_16x16x32_bf16 v[76:79], v[204:207], v[164:167], v[76:79]
  v_mfma_f32_16x16x32_bf16 v[76:79], v[184:187], v[160:163], v[76:79]
  ds_write_b128 v118, v[4:7] offset:0
  ds_write_b128 v118, v[20:23] offset:1024
  ds_write_b128 v118, v[36:39] offset:2048
  ds_write_b128 v118, v[52:55] offset:3072
  ds_write_b128 v118, v[68:71] offset:4096
  ds_write_b128 v119, v[8:11] offset:0
  ds_write_b128 v119, v[24:27] offset:1024
  ds_write_b128 v119, v[40:43] offset:2048
  ds_write_b128 v119, v[56:59] offset:3072
  ds_write_b128 v119, v[72:75] offset:4096
  ds_write_b128 v120, v[12:15] offset:0
  ds_write_b128 v120, v[28:31] offset:1024
  ds_write_b128 v120, v[44:47] offset:2048
  ds_write_b128 v120, v[60:63] offset:3072
  ds_write_b128 v120, v[76:79] offset:4096
  s_waitcnt lgkmcnt(0)
  s_barrier
  ds_read_b128 v[136:139], v121 offset:0
  ds_read_b128 v[140:143], v121 offset:5120
  ds_read_b128 v[144:147], v121 offset:10240
  ds_read_b128 v[148:151], v121 offset:1024
  ds_read_b128 v[152:155], v121 offset:6144
  ds_read_b128 v[156:159], v121 offset:11264
  ds_read_b128 v[160:163], v121 offset:2048
  ds_read_b128 v[164:167], v121 offset:7168
  ds_read_b128 v[168:171], v121 offset:12288
  ds_read_b128 v[172:175], v121 offset:3072
  ds_read_b128 v[176:179], v121 offset:8192
  ds_read_b128 v[180:183], v121 offset:13312
  ds_read_b128 v[184:187], v121 offset:4096
  ds_read_b128 v[188:191], v121 offset:9216
  ds_read_b128 v[192:195], v121 offset:14336
  s_waitcnt lgkmcnt(13)
  v_add_f32 v136, v136, v140
  s_waitcnt lgkmcnt(12)
  v_add_f32 v0, v0, v144
  v_add_f32 v137, v137, v141
  v_add_f32 v1, v1, v145
  v_add_f32 v138, v138, v142
  v_add_f32 v2, v2, v146
  v_add_f32 v139, v139, v143
  v_add_f32 v3, v3, v147
  v_add_f32 v0, v0, v136
  v_add_f32 v1, v1, v137
  v_add_f32 v2, v2, v138
  v_add_f32 v3, v3, v139
  v_cvt_pk_bf16_f32 v136, v0, v1
  v_cvt_pk_bf16_f32 v137, v2, v3
  v_lshlrev_b32 v0, 16, v136
  v_and_b32 v1, s33, v136
  v_lshlrev_b32 v2, 16, v137
  v_and_b32 v3, s33, v137
  v_mul_f32 v0, v0, v90
  v_mul_f32 v1, v1, v91
  v_mul_f32 v2, v2, v92
  v_mul_f32 v3, v3, v93
  v_cvt_pk_bf16_f32 v136, v0, v1
  v_cvt_pk_bf16_f32 v137, v2, v3
  v_lshlrev_b32 v0, 16, v136
  v_and_b32 v1, s33, v136
  v_lshlrev_b32 v140, 16, v80
  v_and_b32 v141, s33, v80
  v_lshlrev_b32 v2, 16, v137
  v_and_b32 v3, s33, v137
  v_lshlrev_b32 v142, 16, v81
  v_and_b32 v143, s33, v81
  v_add_f32 v0, v0, v140
  v_add_f32 v1, v1, v141
  v_add_f32 v2, v2, v142
  v_add_f32 v3, v3, v143
  v_cvt_pk_bf16_f32 v136, v0, v1
  v_cvt_pk_bf16_f32 v137, v2, v3
  buffer_store_dwordx2 v[136:137], v117, s[16:19], 0 offen offset:0
  s_waitcnt lgkmcnt(10)
  v_add_f32 v148, v148, v152
  s_waitcnt lgkmcnt(9)
  v_add_f32 v16, v16, v156
  v_add_f32 v149, v149, v153
  v_add_f32 v17, v17, v157
  v_add_f32 v150, v150, v154
  v_add_f32 v18, v18, v158
  v_add_f32 v151, v151, v155
  v_add_f32 v19, v19, v159
  v_add_f32 v16, v16, v148
  v_add_f32 v17, v17, v149
  v_add_f32 v18, v18, v150
  v_add_f32 v19, v19, v151
  v_cvt_pk_bf16_f32 v148, v16, v17
  v_cvt_pk_bf16_f32 v149, v18, v19
  v_lshlrev_b32 v16, 16, v148
  v_and_b32 v17, s33, v148
  v_lshlrev_b32 v18, 16, v149
  v_and_b32 v19, s33, v149
  v_mul_f32 v16, v16, v94
  v_mul_f32 v17, v17, v95
  v_mul_f32 v18, v18, v96
  v_mul_f32 v19, v19, v97
  v_cvt_pk_bf16_f32 v148, v16, v17
  v_cvt_pk_bf16_f32 v149, v18, v19
  v_lshlrev_b32 v16, 16, v148
  v_and_b32 v17, s33, v148
  v_lshlrev_b32 v152, 16, v82
  v_and_b32 v153, s33, v82
  v_lshlrev_b32 v18, 16, v149
  v_and_b32 v19, s33, v149
  v_lshlrev_b32 v154, 16, v83
  v_and_b32 v155, s33, v83
  v_add_f32 v16, v16, v152
  v_add_f32 v17, v17, v153
  v_add_f32 v18, v18, v154
  v_add_f32 v19, v19, v155
  v_cvt_pk_bf16_f32 v148, v16, v17
  v_cvt_pk_bf16_f32 v149, v18, v19
  buffer_store_dwordx2 v[148:149], v117, s[16:19], 0 offen offset:32
  s_waitcnt lgkmcnt(7)
  v_add_f32 v160, v160, v164
  s_waitcnt lgkmcnt(6)
  v_add_f32 v32, v32, v168
  v_add_f32 v161, v161, v165
  v_add_f32 v33, v33, v169
  v_add_f32 v162, v162, v166
  v_add_f32 v34, v34, v170
  v_add_f32 v163, v163, v167
  v_add_f32 v35, v35, v171
  v_add_f32 v32, v32, v160
  v_add_f32 v33, v33, v161
  v_add_f32 v34, v34, v162
  v_add_f32 v35, v35, v163
  v_cvt_pk_bf16_f32 v160, v32, v33
  v_cvt_pk_bf16_f32 v161, v34, v35
  v_lshlrev_b32 v32, 16, v160
  v_and_b32 v33, s33, v160
  v_lshlrev_b32 v34, 16, v161
  v_and_b32 v35, s33, v161
  v_mul_f32 v32, v32, v98
  v_mul_f32 v33, v33, v99
  v_mul_f32 v34, v34, v100
  v_mul_f32 v35, v35, v101
  v_cvt_pk_bf16_f32 v160, v32, v33
  v_cvt_pk_bf16_f32 v161, v34, v35
  v_lshlrev_b32 v32, 16, v160
  v_and_b32 v33, s33, v160
  v_lshlrev_b32 v164, 16, v84
  v_and_b32 v165, s33, v84
  v_lshlrev_b32 v34, 16, v161
  v_and_b32 v35, s33, v161
  v_lshlrev_b32 v166, 16, v85
  v_and_b32 v167, s33, v85
  v_add_f32 v32, v32, v164
  v_add_f32 v33, v33, v165
  v_add_f32 v34, v34, v166
  v_add_f32 v35, v35, v167
  v_cvt_pk_bf16_f32 v160, v32, v33
  v_cvt_pk_bf16_f32 v161, v34, v35
  buffer_store_dwordx2 v[160:161], v117, s[16:19], 0 offen offset:64
  s_waitcnt lgkmcnt(4)
  v_add_f32 v172, v172, v176
  s_waitcnt lgkmcnt(3)
  v_add_f32 v48, v48, v180
  v_add_f32 v173, v173, v177
  v_add_f32 v49, v49, v181
  v_add_f32 v174, v174, v178
  v_add_f32 v50, v50, v182
  v_add_f32 v175, v175, v179
  v_add_f32 v51, v51, v183
  v_add_f32 v48, v48, v172
  v_add_f32 v49, v49, v173
  v_add_f32 v50, v50, v174
  v_add_f32 v51, v51, v175
  v_cvt_pk_bf16_f32 v172, v48, v49
  v_cvt_pk_bf16_f32 v173, v50, v51
  v_lshlrev_b32 v48, 16, v172
  v_and_b32 v49, s33, v172
  v_lshlrev_b32 v50, 16, v173
  v_and_b32 v51, s33, v173
  v_mul_f32 v48, v48, v102
  v_mul_f32 v49, v49, v103
  v_mul_f32 v50, v50, v104
  v_mul_f32 v51, v51, v105
  v_cvt_pk_bf16_f32 v172, v48, v49
  v_cvt_pk_bf16_f32 v173, v50, v51
  v_lshlrev_b32 v48, 16, v172
  v_and_b32 v49, s33, v172
  v_lshlrev_b32 v176, 16, v86
  v_and_b32 v177, s33, v86
  v_lshlrev_b32 v50, 16, v173
  v_and_b32 v51, s33, v173
  v_lshlrev_b32 v178, 16, v87
  v_and_b32 v179, s33, v87
  v_add_f32 v48, v48, v176
  v_add_f32 v49, v49, v177
  v_add_f32 v50, v50, v178
  v_add_f32 v51, v51, v179
  v_cvt_pk_bf16_f32 v172, v48, v49
  v_cvt_pk_bf16_f32 v173, v50, v51
  buffer_store_dwordx2 v[172:173], v117, s[16:19], 0 offen offset:96
  s_waitcnt lgkmcnt(1)
  v_add_f32 v184, v184, v188
  s_waitcnt lgkmcnt(0)
  v_add_f32 v64, v64, v192
  v_add_f32 v185, v185, v189
  v_add_f32 v65, v65, v193
  v_add_f32 v186, v186, v190
  v_add_f32 v66, v66, v194
  v_add_f32 v187, v187, v191
  v_add_f32 v67, v67, v195
  v_add_f32 v64, v64, v184
  v_add_f32 v65, v65, v185
  v_add_f32 v66, v66, v186
  v_add_f32 v67, v67, v187
  v_cvt_pk_bf16_f32 v184, v64, v65
  v_cvt_pk_bf16_f32 v185, v66, v67
  v_lshlrev_b32 v64, 16, v184
  v_and_b32 v65, s33, v184
  v_lshlrev_b32 v66, 16, v185
  v_and_b32 v67, s33, v185
  v_mul_f32 v64, v64, v106
  v_mul_f32 v65, v65, v107
  v_mul_f32 v66, v66, v108
  v_mul_f32 v67, v67, v109
  v_cvt_pk_bf16_f32 v184, v64, v65
  v_cvt_pk_bf16_f32 v185, v66, v67
  v_lshlrev_b32 v64, 16, v184
  v_and_b32 v65, s33, v184
  v_lshlrev_b32 v188, 16, v88
  v_and_b32 v189, s33, v88
  v_lshlrev_b32 v66, 16, v185
  v_and_b32 v67, s33, v185
  v_lshlrev_b32 v190, 16, v89
  v_and_b32 v191, s33, v89
  v_add_f32 v64, v64, v188
  v_add_f32 v65, v65, v189
  v_add_f32 v66, v66, v190
  v_add_f32 v67, v67, v191
  v_cvt_pk_bf16_f32 v184, v64, v65
  v_cvt_pk_bf16_f32 v185, v66, v67
  buffer_store_dwordx2 v[184:185], v117, s[16:19], 0 offen offset:128
out_end:
  s_endpgm
.section .rodata,"a"
.p2align 6
.amdhsa_kernel prep_kernel
  .amdhsa_next_free_vgpr 108
  .amdhsa_next_free_sgpr 48
  .amdhsa_accum_offset 108
  .amdhsa_group_segment_fixed_size 0
  .amdhsa_kernarg_size 104
  .amdhsa_user_sgpr_count 2
  .amdhsa_user_sgpr_kernarg_segment_ptr 1
  .amdhsa_system_sgpr_workgroup_id_x 1
.end_amdhsa_kernel
.p2align 6
.amdhsa_kernel attn_kernel
  .amdhsa_next_free_vgpr 512
  .amdhsa_next_free_sgpr 102
  .amdhsa_accum_offset 256
  .amdhsa_group_segment_fixed_size 0
  .amdhsa_kernarg_size 104
  .amdhsa_user_sgpr_count 2
  .amdhsa_user_sgpr_kernarg_segment_ptr 1
  .amdhsa_system_sgpr_workgroup_id_x 1
.end_amdhsa_kernel
.p2align 6
.amdhsa_kernel out_kernel
  .amdhsa_next_free_vgpr 512
  .amdhsa_next_free_sgpr 96
  .amdhsa_accum_offset 256
  .amdhsa_group_segment_fixed_size 0
  .amdhsa_kernarg_size 104
  .amdhsa_user_sgpr_count 2
  .amdhsa_user_sgpr_kernarg_segment_ptr 1
  .amdhsa_system_sgpr_workgroup_id_x 1
.end_amdhsa_kernel
```

```asm
; @launch kernel=prep_kernel grid=(256,1,1) block=(256,1,1) lds=0
; @launch kernel=attn_kernel grid=(256,1,1) block=(256,1,1) lds=163840
.amdgcn_target "amdgcn-amd-amdhsa--gfx950"
.text
.globl prep_kernel
.p2align 8
.type prep_kernel,@function
prep_kernel:
  s_cmp_ge_u32 s2, 256
  s_cbranch_scc1 prep_end
  s_load_dwordx2 s[4:5], s[0:1], 0
  s_load_dwordx4 s[36:39], s[0:1], 8
  s_load_dwordx2 s[40:41], s[0:1], 24
  s_load_dwordx2 s[8:9], s[0:1], 48
  s_load_dwordx2 s[10:11], s[0:1], 96
  s_getpc_b64 s[6:7]
prep_hot_pc:
  s_add_u32 s6, s6, prep_hot-prep_hot_pc
  s_addc_u32 s7, s7, 0
  v_lshlrev_b32 v1, 7, v0
  v_min_u32 v1, prep_warm-prep_hot-4, v1
  global_load_dword v106, v1, s[6:7]
prep_hot:
  v_lshrrev_b32 v1, 6, v0
  v_and_b32 v0, 63, v0
  v_readfirstlane_b32 s3, v1
  s_waitcnt lgkmcnt(0)
  s_mov_b32 s12, s4
  s_mov_b32 s13, s5
  s_mov_b32 s14, 2621440
  s_mov_b32 s15, 0x20000
  s_mov_b32 s20, s8
  s_mov_b32 s21, s9
  s_mov_b32 s22, 1280
  s_mov_b32 s23, 0x20000
  s_mov_b32 s24, s10
  s_mov_b32 s25, s11
  s_mov_b32 s26, 8388608
  s_mov_b32 s27, 0x20000
  s_cmp_ge_u32 s3, 2
  s_cbranch_scc1 prep_warm
  s_lshl_b32 s28, s2, 3
  s_lshl_b32 s29, s3, 2
  s_add_u32 s28, s28, s29
  s_mul_i32 s29, s28, 1280
  v_lshrrev_b32 v1, 4, v0
  v_and_b32 v2, 15, v0
  v_lshlrev_b32 v3, 4, v2
  v_mul_u32_u24 v4, 0x500, v1
  v_add_u32 v4, v4, v3
  buffer_load_dwordx4 v[8:11], v4, s[12:15], s29 offen offset:0
  buffer_load_dwordx4 v[12:15], v4, s[12:15], s29 offen offset:256
  buffer_load_dwordx4 v[16:19], v4, s[12:15], s29 offen offset:512
  buffer_load_dwordx4 v[20:23], v4, s[12:15], s29 offen offset:768
  buffer_load_dwordx4 v[24:27], v4, s[12:15], s29 offen offset:1024
  buffer_load_dwordx4 v[28:31], v3, s[20:23], 0 offen offset:0
  buffer_load_dwordx4 v[32:35], v3, s[20:23], 0 offen offset:256
  buffer_load_dwordx4 v[36:39], v3, s[20:23], 0 offen offset:512
  buffer_load_dwordx4 v[40:43], v3, s[20:23], 0 offen offset:768
  buffer_load_dwordx4 v[44:47], v3, s[20:23], 0 offen offset:1024
  s_lshr_b32 s30, s28, 6
  s_mul_i32 s30, s30, 81920
  s_bfe_u32 s31, s28, 0x20004
  s_lshl_b32 s31, s31, 10
  s_add_u32 s30, s30, s31
  s_and_b32 s31, s28, 15
  s_lshl_b32 s31, s31, 4
  s_add_u32 s30, s30, s31
  v_lshrrev_b32 v5, 2, v2
  v_lshlrev_b32 v5, 12, v5
  v_and_b32 v6, 3, v2
  v_lshl_add_u32 v5, v6, 8, v5
  v_lshl_add_u32 v5, v1, 4, v5
  s_mov_b32 s33, 0xffff0000
  s_waitcnt vmcnt(9)
  v_lshlrev_b32 v48, 16, v8
  v_and_b32 v49, s33, v8
  v_lshlrev_b32 v50, 16, v9
  v_and_b32 v51, s33, v9
  v_lshlrev_b32 v52, 16, v10
  v_and_b32 v53, s33, v10
  v_lshlrev_b32 v54, 16, v11
  v_and_b32 v55, s33, v11
  s_waitcnt vmcnt(8)
  v_lshlrev_b32 v56, 16, v12
  v_and_b32 v57, s33, v12
  v_lshlrev_b32 v58, 16, v13
  v_and_b32 v59, s33, v13
  v_lshlrev_b32 v60, 16, v14
  v_and_b32 v61, s33, v14
  v_lshlrev_b32 v62, 16, v15
  v_and_b32 v63, s33, v15
  s_waitcnt vmcnt(7)
  v_lshlrev_b32 v64, 16, v16
  v_and_b32 v65, s33, v16
  v_lshlrev_b32 v66, 16, v17
  v_and_b32 v67, s33, v17
  v_lshlrev_b32 v68, 16, v18
  v_and_b32 v69, s33, v18
  v_lshlrev_b32 v70, 16, v19
  v_and_b32 v71, s33, v19
  s_waitcnt vmcnt(6)
  v_lshlrev_b32 v72, 16, v20
  v_and_b32 v73, s33, v20
  v_lshlrev_b32 v74, 16, v21
  v_and_b32 v75, s33, v21
  v_lshlrev_b32 v76, 16, v22
  v_and_b32 v77, s33, v22
  v_lshlrev_b32 v78, 16, v23
  v_and_b32 v79, s33, v23
  s_waitcnt vmcnt(5)
  v_lshlrev_b32 v80, 16, v24
  v_and_b32 v81, s33, v24
  v_lshlrev_b32 v82, 16, v25
  v_and_b32 v83, s33, v25
  v_lshlrev_b32 v84, 16, v26
  v_and_b32 v85, s33, v26
  v_lshlrev_b32 v86, 16, v27
  v_and_b32 v87, s33, v27
  v_pk_add_f32 v[88:89], v[48:49], v[50:51]
  v_pk_add_f32 v[90:91], v[52:53], v[54:55]
  v_pk_add_f32 v[88:89], v[88:89], v[56:57]
  v_pk_add_f32 v[90:91], v[90:91], v[58:59]
  v_pk_add_f32 v[88:89], v[88:89], v[60:61]
  v_pk_add_f32 v[90:91], v[90:91], v[62:63]
  v_pk_add_f32 v[88:89], v[88:89], v[64:65]
  v_pk_add_f32 v[90:91], v[90:91], v[66:67]
  v_pk_add_f32 v[88:89], v[88:89], v[68:69]
  v_pk_add_f32 v[90:91], v[90:91], v[70:71]
  v_pk_add_f32 v[88:89], v[88:89], v[72:73]
  v_pk_add_f32 v[90:91], v[90:91], v[74:75]
  v_pk_add_f32 v[88:89], v[88:89], v[76:77]
  v_pk_add_f32 v[90:91], v[90:91], v[78:79]
  v_pk_add_f32 v[88:89], v[88:89], v[80:81]
  v_pk_add_f32 v[90:91], v[90:91], v[82:83]
  v_pk_add_f32 v[88:89], v[88:89], v[84:85]
  v_pk_add_f32 v[90:91], v[90:91], v[86:87]
  v_pk_add_f32 v[88:89], v[88:89], v[90:91]
  v_add_f32 v92, v88, v89
  s_nop 1
  v_add_f32_dpp v92, v92, v92 row_ror:8 row_mask:0xf bank_mask:0xf
  s_nop 1
  v_add_f32_dpp v92, v92, v92 row_ror:4 row_mask:0xf bank_mask:0xf
  s_nop 1
  v_add_f32_dpp v92, v92, v92 row_ror:2 row_mask:0xf bank_mask:0xf
  s_nop 1
  v_add_f32_dpp v92, v92, v92 row_ror:1 row_mask:0xf bank_mask:0xf
  v_mul_f32 v92, 0x3acccccd, v92
  v_pk_add_f32 v[94:95], v[48:49], v[92:93] op_sel_hi:[1,0] neg_lo:[0,1] neg_hi:[0,1]
  v_pk_mul_f32 v[88:89], v[94:95], v[94:95]
  v_pk_add_f32 v[96:97], v[50:51], v[92:93] op_sel_hi:[1,0] neg_lo:[0,1] neg_hi:[0,1]
  v_pk_mul_f32 v[90:91], v[96:97], v[96:97]
  v_pk_add_f32 v[94:95], v[52:53], v[92:93] op_sel_hi:[1,0] neg_lo:[0,1] neg_hi:[0,1]
  v_pk_fma_f32 v[88:89], v[94:95], v[94:95], v[88:89]
  v_pk_add_f32 v[96:97], v[54:55], v[92:93] op_sel_hi:[1,0] neg_lo:[0,1] neg_hi:[0,1]
  v_pk_fma_f32 v[90:91], v[96:97], v[96:97], v[90:91]
  v_pk_add_f32 v[94:95], v[56:57], v[92:93] op_sel_hi:[1,0] neg_lo:[0,1] neg_hi:[0,1]
  v_pk_fma_f32 v[88:89], v[94:95], v[94:95], v[88:89]
  v_pk_add_f32 v[96:97], v[58:59], v[92:93] op_sel_hi:[1,0] neg_lo:[0,1] neg_hi:[0,1]
  v_pk_fma_f32 v[90:91], v[96:97], v[96:97], v[90:91]
  v_pk_add_f32 v[94:95], v[60:61], v[92:93] op_sel_hi:[1,0] neg_lo:[0,1] neg_hi:[0,1]
  v_pk_fma_f32 v[88:89], v[94:95], v[94:95], v[88:89]
  v_pk_add_f32 v[96:97], v[62:63], v[92:93] op_sel_hi:[1,0] neg_lo:[0,1] neg_hi:[0,1]
  v_pk_fma_f32 v[90:91], v[96:97], v[96:97], v[90:91]
  v_pk_add_f32 v[94:95], v[64:65], v[92:93] op_sel_hi:[1,0] neg_lo:[0,1] neg_hi:[0,1]
  v_pk_fma_f32 v[88:89], v[94:95], v[94:95], v[88:89]
  v_pk_add_f32 v[96:97], v[66:67], v[92:93] op_sel_hi:[1,0] neg_lo:[0,1] neg_hi:[0,1]
  v_pk_fma_f32 v[90:91], v[96:97], v[96:97], v[90:91]
  v_pk_add_f32 v[94:95], v[68:69], v[92:93] op_sel_hi:[1,0] neg_lo:[0,1] neg_hi:[0,1]
  v_pk_fma_f32 v[88:89], v[94:95], v[94:95], v[88:89]
  v_pk_add_f32 v[96:97], v[70:71], v[92:93] op_sel_hi:[1,0] neg_lo:[0,1] neg_hi:[0,1]
  v_pk_fma_f32 v[90:91], v[96:97], v[96:97], v[90:91]
  v_pk_add_f32 v[94:95], v[72:73], v[92:93] op_sel_hi:[1,0] neg_lo:[0,1] neg_hi:[0,1]
  v_pk_fma_f32 v[88:89], v[94:95], v[94:95], v[88:89]
  v_pk_add_f32 v[96:97], v[74:75], v[92:93] op_sel_hi:[1,0] neg_lo:[0,1] neg_hi:[0,1]
  v_pk_fma_f32 v[90:91], v[96:97], v[96:97], v[90:91]
  v_pk_add_f32 v[94:95], v[76:77], v[92:93] op_sel_hi:[1,0] neg_lo:[0,1] neg_hi:[0,1]
  v_pk_fma_f32 v[88:89], v[94:95], v[94:95], v[88:89]
  v_pk_add_f32 v[96:97], v[78:79], v[92:93] op_sel_hi:[1,0] neg_lo:[0,1] neg_hi:[0,1]
  v_pk_fma_f32 v[90:91], v[96:97], v[96:97], v[90:91]
  v_pk_add_f32 v[94:95], v[80:81], v[92:93] op_sel_hi:[1,0] neg_lo:[0,1] neg_hi:[0,1]
  v_pk_fma_f32 v[88:89], v[94:95], v[94:95], v[88:89]
  v_pk_add_f32 v[96:97], v[82:83], v[92:93] op_sel_hi:[1,0] neg_lo:[0,1] neg_hi:[0,1]
  v_pk_fma_f32 v[90:91], v[96:97], v[96:97], v[90:91]
  v_pk_add_f32 v[94:95], v[84:85], v[92:93] op_sel_hi:[1,0] neg_lo:[0,1] neg_hi:[0,1]
  v_pk_fma_f32 v[88:89], v[94:95], v[94:95], v[88:89]
  v_pk_add_f32 v[96:97], v[86:87], v[92:93] op_sel_hi:[1,0] neg_lo:[0,1] neg_hi:[0,1]
  v_pk_fma_f32 v[90:91], v[96:97], v[96:97], v[90:91]
  v_pk_add_f32 v[88:89], v[88:89], v[90:91]
  v_add_f32 v98, v88, v89
  s_nop 1
  v_add_f32_dpp v98, v98, v98 row_ror:8 row_mask:0xf bank_mask:0xf
  s_nop 1
  v_add_f32_dpp v98, v98, v98 row_ror:4 row_mask:0xf bank_mask:0xf
  s_nop 1
  v_add_f32_dpp v98, v98, v98 row_ror:2 row_mask:0xf bank_mask:0xf
  s_nop 1
  v_add_f32_dpp v98, v98, v98 row_ror:1 row_mask:0xf bank_mask:0xf
  v_mul_f32 v98, 0x3acccccd, v98
  v_cvt_pk_bf16_f32 v92, v92, v92
  v_lshlrev_b32 v92, 16, v92
  v_cvt_pk_bf16_f32 v98, v98, v98
  v_lshlrev_b32 v98, 16, v98
  v_add_f32 v98, 0x3727c5ac, v98
  v_cvt_pk_bf16_f32 v98, v98, v98
  v_lshlrev_b32 v98, 16, v98
  v_sqrt_f32 v98, v98
  s_nop 0
  v_cvt_pk_bf16_f32 v98, v98, v98
  v_lshlrev_b32 v98, 16, v98
  v_rcp_f32 v100, v98
  v_mov_b32 v104, 0
  v_mov_b32 v105, 0
  v_pk_add_f32 v[48:49], v[48:49], v[92:93] op_sel_hi:[1,0] neg_lo:[0,1] neg_hi:[0,1]
  v_pk_add_f32 v[50:51], v[50:51], v[92:93] op_sel_hi:[1,0] neg_lo:[0,1] neg_hi:[0,1]
  v_pk_add_f32 v[52:53], v[52:53], v[92:93] op_sel_hi:[1,0] neg_lo:[0,1] neg_hi:[0,1]
  v_pk_add_f32 v[54:55], v[54:55], v[92:93] op_sel_hi:[1,0] neg_lo:[0,1] neg_hi:[0,1]
  v_pk_add_f32 v[56:57], v[56:57], v[92:93] op_sel_hi:[1,0] neg_lo:[0,1] neg_hi:[0,1]
  v_pk_add_f32 v[58:59], v[58:59], v[92:93] op_sel_hi:[1,0] neg_lo:[0,1] neg_hi:[0,1]
  v_pk_add_f32 v[60:61], v[60:61], v[92:93] op_sel_hi:[1,0] neg_lo:[0,1] neg_hi:[0,1]
  v_pk_add_f32 v[62:63], v[62:63], v[92:93] op_sel_hi:[1,0] neg_lo:[0,1] neg_hi:[0,1]
  v_pk_add_f32 v[64:65], v[64:65], v[92:93] op_sel_hi:[1,0] neg_lo:[0,1] neg_hi:[0,1]
  v_pk_add_f32 v[66:67], v[66:67], v[92:93] op_sel_hi:[1,0] neg_lo:[0,1] neg_hi:[0,1]
  v_pk_add_f32 v[68:69], v[68:69], v[92:93] op_sel_hi:[1,0] neg_lo:[0,1] neg_hi:[0,1]
  v_pk_add_f32 v[70:71], v[70:71], v[92:93] op_sel_hi:[1,0] neg_lo:[0,1] neg_hi:[0,1]
  v_pk_add_f32 v[72:73], v[72:73], v[92:93] op_sel_hi:[1,0] neg_lo:[0,1] neg_hi:[0,1]
  v_pk_add_f32 v[74:75], v[74:75], v[92:93] op_sel_hi:[1,0] neg_lo:[0,1] neg_hi:[0,1]
  v_pk_add_f32 v[76:77], v[76:77], v[92:93] op_sel_hi:[1,0] neg_lo:[0,1] neg_hi:[0,1]
  v_pk_add_f32 v[78:79], v[78:79], v[92:93] op_sel_hi:[1,0] neg_lo:[0,1] neg_hi:[0,1]
  v_pk_add_f32 v[80:81], v[80:81], v[92:93] op_sel_hi:[1,0] neg_lo:[0,1] neg_hi:[0,1]
  v_pk_add_f32 v[82:83], v[82:83], v[92:93] op_sel_hi:[1,0] neg_lo:[0,1] neg_hi:[0,1]
  v_pk_add_f32 v[84:85], v[84:85], v[92:93] op_sel_hi:[1,0] neg_lo:[0,1] neg_hi:[0,1]
  v_pk_add_f32 v[86:87], v[86:87], v[92:93] op_sel_hi:[1,0] neg_lo:[0,1] neg_hi:[0,1]
  v_cvt_pk_bf16_f32 v8, v48, v49
  v_cvt_pk_bf16_f32 v9, v50, v51
  v_cvt_pk_bf16_f32 v10, v52, v53
  v_cvt_pk_bf16_f32 v11, v54, v55
  v_cvt_pk_bf16_f32 v12, v56, v57
  v_cvt_pk_bf16_f32 v13, v58, v59
  v_cvt_pk_bf16_f32 v14, v60, v61
  v_cvt_pk_bf16_f32 v15, v62, v63
  v_cvt_pk_bf16_f32 v16, v64, v65
  v_cvt_pk_bf16_f32 v17, v66, v67
  v_cvt_pk_bf16_f32 v18, v68, v69
  v_cvt_pk_bf16_f32 v19, v70, v71
  v_cvt_pk_bf16_f32 v20, v72, v73
  v_cvt_pk_bf16_f32 v21, v74, v75
  v_cvt_pk_bf16_f32 v22, v76, v77
  v_cvt_pk_bf16_f32 v23, v78, v79
  v_cvt_pk_bf16_f32 v24, v80, v81
  v_cvt_pk_bf16_f32 v25, v82, v83
  v_cvt_pk_bf16_f32 v26, v84, v85
  v_cvt_pk_bf16_f32 v27, v86, v87
  v_lshlrev_b32 v48, 16, v8
  v_and_b32 v49, s33, v8
  v_lshlrev_b32 v50, 16, v9
  v_and_b32 v51, s33, v9
  v_lshlrev_b32 v52, 16, v10
  v_and_b32 v53, s33, v10
  v_lshlrev_b32 v54, 16, v11
  v_and_b32 v55, s33, v11
  v_lshlrev_b32 v56, 16, v12
  v_and_b32 v57, s33, v12
  v_lshlrev_b32 v58, 16, v13
  v_and_b32 v59, s33, v13
  v_lshlrev_b32 v60, 16, v14
  v_and_b32 v61, s33, v14
  v_lshlrev_b32 v62, 16, v15
  v_and_b32 v63, s33, v15
  v_lshlrev_b32 v64, 16, v16
  v_and_b32 v65, s33, v16
  v_lshlrev_b32 v66, 16, v17
  v_and_b32 v67, s33, v17
  v_lshlrev_b32 v68, 16, v18
  v_and_b32 v69, s33, v18
  v_lshlrev_b32 v70, 16, v19
  v_and_b32 v71, s33, v19
  v_lshlrev_b32 v72, 16, v20
  v_and_b32 v73, s33, v20
  v_lshlrev_b32 v74, 16, v21
  v_and_b32 v75, s33, v21
  v_lshlrev_b32 v76, 16, v22
  v_and_b32 v77, s33, v22
  v_lshlrev_b32 v78, 16, v23
  v_and_b32 v79, s33, v23
  v_lshlrev_b32 v80, 16, v24
  v_and_b32 v81, s33, v24
  v_lshlrev_b32 v82, 16, v25
  v_and_b32 v83, s33, v25
  v_lshlrev_b32 v84, 16, v26
  v_and_b32 v85, s33, v26
  v_lshlrev_b32 v86, 16, v27
  v_and_b32 v87, s33, v27
  v_pk_mul_f32 v[48:49], v[48:49], v[100:101] op_sel_hi:[1,0]
  v_pk_mul_f32 v[50:51], v[50:51], v[100:101] op_sel_hi:[1,0]
  v_pk_mul_f32 v[52:53], v[52:53], v[100:101] op_sel_hi:[1,0]
  v_pk_mul_f32 v[54:55], v[54:55], v[100:101] op_sel_hi:[1,0]
  v_pk_mul_f32 v[56:57], v[56:57], v[100:101] op_sel_hi:[1,0]
  v_pk_mul_f32 v[58:59], v[58:59], v[100:101] op_sel_hi:[1,0]
  v_pk_mul_f32 v[60:61], v[60:61], v[100:101] op_sel_hi:[1,0]
  v_pk_mul_f32 v[62:63], v[62:63], v[100:101] op_sel_hi:[1,0]
  v_pk_mul_f32 v[64:65], v[64:65], v[100:101] op_sel_hi:[1,0]
  v_pk_mul_f32 v[66:67], v[66:67], v[100:101] op_sel_hi:[1,0]
  v_pk_mul_f32 v[68:69], v[68:69], v[100:101] op_sel_hi:[1,0]
  v_pk_mul_f32 v[70:71], v[70:71], v[100:101] op_sel_hi:[1,0]
  v_pk_mul_f32 v[72:73], v[72:73], v[100:101] op_sel_hi:[1,0]
  v_pk_mul_f32 v[74:75], v[74:75], v[100:101] op_sel_hi:[1,0]
  v_pk_mul_f32 v[76:77], v[76:77], v[100:101] op_sel_hi:[1,0]
  v_pk_mul_f32 v[78:79], v[78:79], v[100:101] op_sel_hi:[1,0]
  v_pk_mul_f32 v[80:81], v[80:81], v[100:101] op_sel_hi:[1,0]
  v_pk_mul_f32 v[82:83], v[82:83], v[100:101] op_sel_hi:[1,0]
  v_pk_mul_f32 v[84:85], v[84:85], v[100:101] op_sel_hi:[1,0]
  v_pk_mul_f32 v[86:87], v[86:87], v[100:101] op_sel_hi:[1,0]
  v_cvt_pk_bf16_f32 v8, v48, v49
  v_cvt_pk_bf16_f32 v9, v50, v51
  v_cvt_pk_bf16_f32 v10, v52, v53
  v_cvt_pk_bf16_f32 v11, v54, v55
  buffer_store_dwordx4 v[8:11], v5, s[24:27], s30 offen
  s_add_u32 s30, s30, 16384
  v_cvt_pk_bf16_f32 v12, v56, v57
  v_cvt_pk_bf16_f32 v13, v58, v59
  v_cvt_pk_bf16_f32 v14, v60, v61
  v_cvt_pk_bf16_f32 v15, v62, v63
  buffer_store_dwordx4 v[12:15], v5, s[24:27], s30 offen
  s_add_u32 s30, s30, 16384
  v_cvt_pk_bf16_f32 v16, v64, v65
  v_cvt_pk_bf16_f32 v17, v66, v67
  v_cvt_pk_bf16_f32 v18, v68, v69
  v_cvt_pk_bf16_f32 v19, v70, v71
  buffer_store_dwordx4 v[16:19], v5, s[24:27], s30 offen
  s_add_u32 s30, s30, 16384
  v_cvt_pk_bf16_f32 v20, v72, v73
  v_cvt_pk_bf16_f32 v21, v74, v75
  v_cvt_pk_bf16_f32 v22, v76, v77
  v_cvt_pk_bf16_f32 v23, v78, v79
  buffer_store_dwordx4 v[20:23], v5, s[24:27], s30 offen
  s_add_u32 s30, s30, 16384
  v_cvt_pk_bf16_f32 v24, v80, v81
  v_cvt_pk_bf16_f32 v25, v82, v83
  v_cvt_pk_bf16_f32 v26, v84, v85
  v_cvt_pk_bf16_f32 v27, v86, v87
  buffer_store_dwordx4 v[24:27], v5, s[24:27], s30 offen
  s_add_u32 s30, s30, 16384
  s_waitcnt vmcnt(9)
  v_dot2_f32_bf16 v104, v8, v28, v104
  v_dot2_f32_bf16 v105, v9, v29, v105
  v_dot2_f32_bf16 v104, v10, v30, v104
  v_dot2_f32_bf16 v105, v11, v31, v105
  s_waitcnt vmcnt(8)
  v_dot2_f32_bf16 v104, v12, v32, v104
  v_dot2_f32_bf16 v105, v13, v33, v105
  v_dot2_f32_bf16 v104, v14, v34, v104
  v_dot2_f32_bf16 v105, v15, v35, v105
  s_waitcnt vmcnt(7)
  v_dot2_f32_bf16 v104, v16, v36, v104
  v_dot2_f32_bf16 v105, v17, v37, v105
  v_dot2_f32_bf16 v104, v18, v38, v104
  v_dot2_f32_bf16 v105, v19, v39, v105
  s_waitcnt vmcnt(6)
  v_dot2_f32_bf16 v104, v20, v40, v104
  v_dot2_f32_bf16 v105, v21, v41, v105
  v_dot2_f32_bf16 v104, v22, v42, v104
  v_dot2_f32_bf16 v105, v23, v43, v105
  s_waitcnt vmcnt(5)
  v_dot2_f32_bf16 v104, v24, v44, v104
  v_dot2_f32_bf16 v105, v25, v45, v105
  v_dot2_f32_bf16 v104, v26, v46, v104
  v_dot2_f32_bf16 v105, v27, v47, v105
  s_nop 2
  v_add_f32 v104, v104, v105
  s_nop 1
  v_add_f32_dpp v104, v104, v104 row_ror:8 row_mask:0xf bank_mask:0xf
  s_nop 1
  v_add_f32_dpp v104, v104, v104 row_ror:4 row_mask:0xf bank_mask:0xf
  s_nop 1
  v_add_f32_dpp v104, v104, v104 row_ror:2 row_mask:0xf bank_mask:0xf
  s_nop 1
  v_add_f32_dpp v104, v104, v104 row_ror:1 row_mask:0xf bank_mask:0xf
  v_cvt_pk_bf16_f32 v104, v104, v104
  v_lshlrev_b32 v104, 16, v104
  v_ashrrev_i32 v105, 31, v104
  v_or_b32 v105, 0x80000000, v105
  v_xor_b32 v104, v104, v105
  v_and_b32 v104, s33, v104
  v_add_u32 v6, s28, v1
  v_sub_u32 v7, 0xffff, v6
  v_or_b32 v104, v104, v7
  v_lshlrev_b32 v6, 2, v6
  s_mov_b32 s31, 2621440
  v_cmp_eq_u32 vcc, 0, v2
  s_nop 0
  s_and_saveexec_b64 s[34:35], vcc
  buffer_store_dword v104, v6, s[24:27], s31 offen
  s_endpgm
prep_warm:
  v_mov_b32 v4, 0
  v_lshlrev_b32 v5, 8, v0
  s_cmp_eq_u32 s2, 0
  s_cselect_b32 s30, 0, 0x40000000
  v_or_b32 v5, s30, v5
  s_mov_b32 s30, 2818048
  buffer_store_dword v4, v5, s[24:27], s30 offen
  s_and_b32 s28, s2, 7
  s_lshr_b32 s29, s2, 3
  s_lshl_b32 s29, s29, 1
  s_add_u32 s29, s29, s3
  s_sub_u32 s29, s29, 2
  s_getpc_b64 s[6:7]
prep_warm_pc:
  s_add_u32 s6, s6, attn_kernel-prep_warm_pc
  s_addc_u32 s7, s7, 0
  v_and_b32 v1, 7, v0
  s_lshl_b32 s30, s29, 3
  v_add_u32 v1, s30, v1
  v_lshlrev_b32 v1, 7, v1
  v_min_u32 v1, attn_end-attn_kernel-4, v1
  global_load_dword v8, v1, s[6:7]
  s_mov_b32 s16, s40
  s_mov_b32 s17, s41
  s_mov_b32 s18, 5242880
  s_mov_b32 s19, 0x20000
  v_lshrrev_b32 v1, 3, v0
  v_lshlrev_b32 v1, 19, v1
  v_and_b32 v2, 7, v0
  v_lshl_add_u32 v1, v2, 7, v1
  s_lshl_b32 s30, s29, 13
  s_lshl_b32 s31, s28, 10
  s_add_u32 s30, s30, s31
  buffer_load_dword v8, v1, s[16:19], s30 offen
  v_add_u32 v1, 0x400000, v1
  buffer_load_dword v8, v1, s[16:19], s30 offen
  s_lshl_b32 s30, s28, 21
  s_lshr_b32 s31, s29, 4
  s_lshl_b32 s31, s31, 19
  s_add_u32 s30, s30, s31
  s_add_u32 s16, s36, s30
  s_addc_u32 s17, s37, 0
  s_mov_b32 s18, 49152
  s_mov_b32 s19, 0x20000
  s_add_u32 s44, s38, s30
  s_addc_u32 s45, s39, 0
  s_mov_b32 s46, 32768
  s_mov_b32 s47, 0x20000
  s_and_b32 s31, s29, 15
  s_mul_i32 s30, s31, 3072
  s_lshl_b32 s31, s31, 11
  v_lshlrev_b32 v1, 7, v0
  v_lshrrev_b32 v2, 4, v0
  v_lshl_add_u32 v2, v2, 20, v1
  v_cmp_gt_u32 vcc, 24, v0
  v_mov_b32 v3, 0x100000
  s_nop 0
  v_cndmask_b32 v1, v3, v1, vcc
  buffer_load_dword v8, v1, s[16:19], s30 offen
  buffer_load_dword v8, v2, s[44:47], s31 offen
prep_end:
  s_endpgm
.globl attn_kernel
.p2align 8
.type attn_kernel,@function
attn_kernel:
  s_cmp_ge_u32 s2, 256
  s_cbranch_scc1 attn_end
  s_load_dwordx4 s[4:7], s[0:1], 8
  s_load_dwordx2 s[8:9], s[0:1], 24
  s_load_dwordx2 s[10:11], s[0:1], 96
  s_load_dwordx2 s[88:89], s[0:1], 32
  s_load_dwordx2 s[90:91], s[0:1], 56
  s_load_dwordx4 s[92:95], s[0:1], 64
  s_load_dwordx2 s[60:61], s[0:1], 0
  s_load_dwordx2 s[62:63], s[0:1], 80
  s_getpc_b64 s[48:49]
attn_hot_pc:
  s_add_u32 s48, s48, attn_hot-attn_hot_pc
  s_addc_u32 s49, s49, 0
  v_lshlrev_b32 v249, 7, v0
  v_min_u32 v249, attn_end-attn_hot-4, v249
  global_load_dword v255, v249, s[48:49]
  v_add_u32 v249, 0x8000, v249
  v_min_u32 v249, attn_end-attn_hot-4, v249
  global_load_dword v255, v249, s[48:49]
  v_lshrrev_b32 v249, 6, v0
  v_and_b32 v245, 63, v0
  v_readfirstlane_b32 s3, v249
  s_and_b32 s36, s2, 7
  s_lshl_b32 s36, s36, 2
  s_lshr_b32 s37, s2, 6
  s_add_u32 s36, s36, s37
  s_bfe_u32 s37, s2, 0x30003
  s_lshl_b32 s37, s37, 2
  s_add_u32 s37, s37, s3
  s_lshl_b32 s28, s3, 12
  v_lshlrev_b32 v242, 4, v245
  v_add_u32 v243, 0x1000, v242
  s_mul_i32 s30, s37, 81920
  v_lshrrev_b32 v248, 4, v245
  v_and_b32 v247, 15, v245
  s_lshl_b32 s38, s3, 17
  v_lshlrev_b32 v249, 13, v248
  v_add_u32 v249, s38, v249
  v_or_b32 v250, 0, v248
  v_lshlrev_b32 v250, 1, v250
  v_xor_b32 v250, v250, v247
  v_lshl_add_u32 v238, v250, 4, v249
  v_or_b32 v250, 0, v248
  v_lshlrev_b32 v250, 1, v250
  v_xor_b32 v250, v250, v247
  v_lshl_add_u32 v239, v250, 4, v249
  v_add_u32 v239, 31744, v239
  v_or_b32 v250, 4, v248
  v_lshlrev_b32 v250, 1, v250
  v_xor_b32 v250, v250, v247
  v_lshl_add_u32 v240, v250, 4, v249
  v_add_u32 v240, 63488, v240
  v_or_b32 v250, 4, v248
  v_lshlrev_b32 v250, 1, v250
  v_xor_b32 v250, v250, v247
  v_lshl_add_u32 v241, v250, 4, v249
  v_add_u32 v241, 95232, v241
  s_waitcnt lgkmcnt(0)
  s_lshl_b32 s38, s36, 8
  s_add_u32 s20, s8, s38
  s_addc_u32 s21, s9, 0
  s_mov_b32 s22, 5242880
  s_mov_b32 s23, 0x20000
  s_sub_u32 s22, s22, s38
  s_mov_b32 s24, s10
  s_mov_b32 s25, s11
  s_mov_b32 s26, 25165824
  s_mov_b32 s27, 0x20000
  s_mov_b32 s31, 0
  s_lshl_b32 s38, s36, 19
  s_add_u32 s12, s4, s38
  s_addc_u32 s13, s5, 0
  s_mov_b32 s14, 524288
  s_mov_b32 s15, 0x20000
  s_add_u32 s16, s6, s38
  s_addc_u32 s17, s7, 0
  s_mov_b32 s18, 524288
  s_mov_b32 s19, 0x20000
  v_lshlrev_b32 v251, 7, v247
  v_lshl_add_u32 v251, v248, 13, v251
  s_lshr_b32 s49, s2, 3
  s_mul_i32 s49, s49, 81920
  s_lshl_b32 s38, s3, 11
  s_add_u32 s49, s49, s38
  s_add_u32 m0, s28, 98304
  s_nop 0
  buffer_load_dwordx4 v238, s[20:23], s31 offen offset:0 lds
  buffer_load_dwordx4 v239, s[20:23], s31 offen offset:1024 lds
  buffer_load_dwordx4 v240, s[20:23], s31 offen offset:2048 lds
  buffer_load_dwordx4 v241, s[20:23], s31 offen offset:3072 lds
  s_add_u32 s31, s31, 0x80000
  buffer_load_dwordx4 a[0:3], v242, s[24:27], s30 offen offset:0
  buffer_load_dwordx4 a[4:7], v242, s[24:27], s30 offen offset:1024
  buffer_load_dwordx4 a[8:11], v242, s[24:27], s30 offen offset:2048
  buffer_load_dwordx4 a[12:15], v242, s[24:27], s30 offen offset:3072
  buffer_load_dwordx4 a[16:19], v243, s[24:27], s30 offen offset:0
  buffer_load_dwordx4 a[20:23], v243, s[24:27], s30 offen offset:1024
  buffer_load_dwordx4 a[24:27], v243, s[24:27], s30 offen offset:2048
  buffer_load_dwordx4 a[28:31], v243, s[24:27], s30 offen offset:3072
  s_add_u32 s30, s30, 8192
  s_add_u32 m0, s28, 114688
  s_nop 0
  buffer_load_dwordx4 v238, s[20:23], s31 offen offset:0 lds
  buffer_load_dwordx4 v239, s[20:23], s31 offen offset:1024 lds
  buffer_load_dwordx4 v240, s[20:23], s31 offen offset:2048 lds
  buffer_load_dwordx4 v241, s[20:23], s31 offen offset:3072 lds
  s_add_u32 s31, s31, 0x80000
  buffer_load_dwordx4 a[32:35], v242, s[24:27], s30 offen offset:0
  buffer_load_dwordx4 a[36:39], v242, s[24:27], s30 offen offset:1024
  buffer_load_dwordx4 a[40:43], v242, s[24:27], s30 offen offset:2048
  buffer_load_dwordx4 a[44:47], v242, s[24:27], s30 offen offset:3072
  buffer_load_dwordx4 a[48:51], v243, s[24:27], s30 offen offset:0
  buffer_load_dwordx4 a[52:55], v243, s[24:27], s30 offen offset:1024
  buffer_load_dwordx4 a[56:59], v243, s[24:27], s30 offen offset:2048
  buffer_load_dwordx4 a[60:63], v243, s[24:27], s30 offen offset:3072
  s_add_u32 s30, s30, 8192
  s_add_u32 m0, s28, 65536
  s_nop 0
  buffer_load_dwordx4 v238, s[20:23], s31 offen offset:0 lds
  buffer_load_dwordx4 v239, s[20:23], s31 offen offset:1024 lds
  buffer_load_dwordx4 v240, s[20:23], s31 offen offset:2048 lds
  buffer_load_dwordx4 v241, s[20:23], s31 offen offset:3072 lds
  s_add_u32 s31, s31, 0x80000
  buffer_load_dwordx4 a[64:67], v242, s[24:27], s30 offen offset:0
  buffer_load_dwordx4 a[68:71], v242, s[24:27], s30 offen offset:1024
  buffer_load_dwordx4 a[72:75], v242, s[24:27], s30 offen offset:2048
  buffer_load_dwordx4 a[76:79], v242, s[24:27], s30 offen offset:3072
  buffer_load_dwordx4 a[80:83], v243, s[24:27], s30 offen offset:0
  buffer_load_dwordx4 a[84:87], v243, s[24:27], s30 offen offset:1024
  buffer_load_dwordx4 a[88:91], v243, s[24:27], s30 offen offset:2048
  buffer_load_dwordx4 a[92:95], v243, s[24:27], s30 offen offset:3072
  s_add_u32 s30, s30, 8192
  v_lshlrev_b32 v249, 8, v248
  v_add_u32 v249, s28, v249
  v_add_u32 v250, 0, v248
  v_xor_b32 v250, v250, v247
  v_lshl_add_u32 v232, v250, 4, v249
  v_add_u32 v250, 4, v248
  v_xor_b32 v250, v250, v247
  v_lshl_add_u32 v233, v250, 4, v249
  v_add_u32 v250, 8, v248
  v_xor_b32 v250, v250, v247
  v_lshl_add_u32 v234, v250, 4, v249
  v_add_u32 v250, 12, v248
  v_xor_b32 v250, v250, v247
  v_lshl_add_u32 v235, v250, 4, v249
  v_add_u32 v250, 0, v248
  v_lshlrev_b32 v250, 1, v250
  v_xor_b32 v250, v250, v247
  v_lshl_add_u32 v236, v250, 4, v249
  v_add_u32 v250, 4, v248
  v_lshlrev_b32 v250, 1, v250
  v_xor_b32 v250, v250, v247
  v_lshl_add_u32 v237, v250, 4, v249
  v_lshrrev_b32 v249, 1, v248
  v_and_b32 v250, 1, v248
  v_lshl_or_b32 v249, v250, 1, v249
  v_xor_b32 v249, v249, v247
  v_lshlrev_b32 v249, 4, v249
  v_lshl_add_u32 v212, v247, 8, v249
  v_xor_b32 v213, 64, v212
  v_xor_b32 v214, 128, v212
  v_xor_b32 v215, 192, v212
  v_bfe_u32 v246, v245, 2, 2
  v_and_b32 v247, 3, v245
  v_lshlrev_b32 v247, 3, v247
  v_add_u32 v247, 65536, v247
  v_lshl_add_u32 v249, v248, 2, v246
  v_and_b32 v250, 7, v249
  v_lshl_add_u32 v250, v250, 5, v247
  v_lshl_add_u32 v216, v249, 8, v250
  v_lshl_add_u32 v249, v248, 3, v246
  v_and_b32 v250, 1, v248
  v_lshl_add_u32 v250, v250, 2, v246
  v_lshl_add_u32 v250, v250, 5, v247
  v_lshl_add_u32 v224, v249, 8, v250
  v_xor_b32 v217, 32, v216
  v_xor_b32 v225, 32, v224
  v_xor_b32 v218, 64, v216
  v_xor_b32 v226, 64, v224
  v_xor_b32 v219, 96, v216
  v_xor_b32 v227, 96, v224
  v_xor_b32 v220, 128, v216
  v_xor_b32 v228, 128, v224
  v_xor_b32 v221, 160, v216
  v_xor_b32 v229, 160, v224
  v_xor_b32 v222, 192, v216
  v_xor_b32 v230, 192, v224
  v_xor_b32 v223, 224, v216
  v_xor_b32 v231, 224, v224
  s_lshr_b32 s38, s2, 3
  s_min_u32 s38, s38, 26
  s_and_b32 s39, s2, 7
  s_mul_i32 s39, s39, 27
  s_add_u32 s33, s38, s39
  s_mul_i32 s50, s3, 6144
  s_add_u32 s50, s50, 133120
  v_mov_b32 v244, v242
  s_lshl_b32 s40, s37, 19
  s_lshl_b32 s38, s36, 14
  s_add_u32 s40, s40, s38
  s_add_u32 s40, s40, 8388608
  s_add_u32 s41, s40, 4096
  s_add_u32 s42, s40, 8192
  s_add_u32 s43, s40, 12288
  s_mov_b32 s34, 0x3e0293ee
  s_mov_b32 s29, 0
  v_and_b32 v249, 15, v245
  v_cmp_eq_u32 vcc, 0, v249
  v_mov_b32 v249, 0x3f803f80
  s_nop 0
  v_cndmask_b32 v249, 0, v249, vcc
  v_accvgpr_write_b32 a208, v249
  v_accvgpr_write_b32 a209, v249
  v_accvgpr_write_b32 a210, v249
  v_accvgpr_write_b32 a211, v249
attn_hot:
  s_waitcnt vmcnt(32)
  s_barrier
  ds_read_b64_tr_b16 a[160:161], v224 offset:32768
  ds_read_b64_tr_b16 a[162:163], v224 offset:33792
  ds_read_b64_tr_b16 a[164:165], v224 offset:40960
  ds_read_b64_tr_b16 a[166:167], v224 offset:41984
  ds_read_b64_tr_b16 a[168:169], v225 offset:32768
  ds_read_b64_tr_b16 a[170:171], v225 offset:33792
  ds_read_b64_tr_b16 a[172:173], v225 offset:40960
  ds_read_b64_tr_b16 a[174:175], v225 offset:41984
  s_waitcnt vmcnt(24) lgkmcnt(4)
  v_mfma_f32_16x16x32_bf16 v[0:3], a[160:163], a[0:3], 0
  ds_read_b64_tr_b16 a[176:177], v226 offset:32768
  s_add_u32 m0, s28, 81920
  v_mfma_f32_16x16x32_bf16 v[0:3], a[164:167], a[16:19], v[0:3]
  buffer_load_dwordx4 v238, s[20:23], s31 offen offset:0 lds
  v_mfma_f32_16x16x32_bf16 v[4:7], a[164:167], a[20:23], 0
  ds_read_b64_tr_b16 a[178:179], v226 offset:33792
  buffer_load_dwordx4 v239, s[20:23], s31 offen offset:1024 lds
  v_mfma_f32_16x16x32_bf16 v[4:7], a[160:163], a[4:7], v[4:7]
  buffer_load_dwordx4 v240, s[20:23], s31 offen offset:2048 lds
  v_mfma_f32_16x16x32_bf16 v[8:11], a[160:163], a[8:11], 0
  ds_read_b64_tr_b16 a[180:181], v226 offset:40960
  buffer_load_dwordx4 v241, s[20:23], s31 offen offset:3072 lds
  s_add_u32 s31, s31, 0x80000
  v_mfma_f32_16x16x32_bf16 v[8:11], a[164:167], a[24:27], v[8:11]
  buffer_load_dwordx4 a[96:99], v242, s[24:27], s30 offen offset:0
  v_mfma_f32_16x16x32_bf16 v[12:15], a[164:167], a[28:31], 0
  ds_read_b64_tr_b16 a[182:183], v226 offset:41984
  buffer_load_dwordx4 a[100:103], v242, s[24:27], s30 offen offset:1024
  v_mfma_f32_16x16x32_bf16 v[12:15], a[160:163], a[12:15], v[12:15]
  s_waitcnt lgkmcnt(4)
  buffer_load_dwordx4 a[104:107], v242, s[24:27], s30 offen offset:2048
  v_mfma_f32_16x16x32_bf16 v[16:19], a[168:171], a[0:3], 0
  ds_read_b64_tr_b16 a[184:185], v227 offset:32768
  buffer_load_dwordx4 a[108:111], v242, s[24:27], s30 offen offset:3072
  v_mfma_f32_16x16x32_bf16 v[16:19], a[172:175], a[16:19], v[16:19]
  buffer_load_dwordx4 a[112:115], v243, s[24:27], s30 offen offset:0
  v_mfma_f32_16x16x32_bf16 v[20:23], a[172:175], a[20:23], 0
  ds_read_b64_tr_b16 a[186:187], v227 offset:33792
  buffer_load_dwordx4 a[116:119], v243, s[24:27], s30 offen offset:1024
  v_mfma_f32_16x16x32_bf16 v[20:23], a[168:171], a[4:7], v[20:23]
  buffer_load_dwordx4 a[120:123], v243, s[24:27], s30 offen offset:2048
  v_mfma_f32_16x16x32_bf16 v[24:27], a[168:171], a[8:11], 0
  ds_read_b64_tr_b16 a[188:189], v227 offset:40960
  buffer_load_dwordx4 a[124:127], v243, s[24:27], s30 offen offset:3072
  s_add_u32 s30, s30, 8192
  v_mfma_f32_16x16x32_bf16 v[24:27], a[172:175], a[24:27], v[24:27]
  v_mfma_f32_16x16x32_bf16 v[28:31], a[172:175], a[28:31], 0
  ds_read_b64_tr_b16 a[190:191], v227 offset:41984
  v_mfma_f32_16x16x32_bf16 v[28:31], a[168:171], a[12:15], v[28:31]
  s_waitcnt lgkmcnt(4)
  v_mfma_f32_16x16x32_bf16 v[32:35], a[176:179], a[0:3], 0
  ds_read_b64_tr_b16 a[160:161], v228 offset:32768
  v_mfma_f32_16x16x32_bf16 v[32:35], a[180:183], a[16:19], v[32:35]
  v_mfma_f32_16x16x32_bf16 v[36:39], a[180:183], a[20:23], 0
  ds_read_b64_tr_b16 a[162:163], v228 offset:33792
  v_mfma_f32_16x16x32_bf16 v[36:39], a[176:179], a[4:7], v[36:39]
  v_mfma_f32_16x16x32_bf16 v[40:43], a[176:179], a[8:11], 0
  ds_read_b64_tr_b16 a[164:165], v228 offset:40960
  v_mfma_f32_16x16x32_bf16 v[40:43], a[180:183], a[24:27], v[40:43]
  v_mfma_f32_16x16x32_bf16 v[44:47], a[180:183], a[28:31], 0
  ds_read_b64_tr_b16 a[166:167], v228 offset:41984
  v_mfma_f32_16x16x32_bf16 v[44:47], a[176:179], a[12:15], v[44:47]
  s_waitcnt lgkmcnt(4)
  v_mfma_f32_16x16x32_bf16 v[48:51], a[184:187], a[0:3], 0
  ds_read_b64_tr_b16 a[168:169], v229 offset:32768
  v_mfma_f32_16x16x32_bf16 v[48:51], a[188:191], a[16:19], v[48:51]
  v_mfma_f32_16x16x32_bf16 v[52:55], a[188:191], a[20:23], 0
  ds_read_b64_tr_b16 a[170:171], v229 offset:33792
  v_mfma_f32_16x16x32_bf16 v[52:55], a[184:187], a[4:7], v[52:55]
  v_mfma_f32_16x16x32_bf16 v[56:59], a[184:187], a[8:11], 0
  ds_read_b64_tr_b16 a[172:173], v229 offset:40960
  v_mfma_f32_16x16x32_bf16 v[56:59], a[188:191], a[24:27], v[56:59]
  v_mfma_f32_16x16x32_bf16 v[60:63], a[188:191], a[28:31], 0
  ds_read_b64_tr_b16 a[174:175], v229 offset:41984
  v_mfma_f32_16x16x32_bf16 v[60:63], a[184:187], a[12:15], v[60:63]
  s_waitcnt lgkmcnt(4)
  v_mfma_f32_16x16x32_bf16 v[64:67], a[160:163], a[0:3], 0
  ds_read_b64_tr_b16 a[176:177], v230 offset:32768
  v_mfma_f32_16x16x32_bf16 v[64:67], a[164:167], a[16:19], v[64:67]
  v_mfma_f32_16x16x32_bf16 v[68:71], a[164:167], a[20:23], 0
  ds_read_b64_tr_b16 a[178:179], v230 offset:33792
  v_mfma_f32_16x16x32_bf16 v[68:71], a[160:163], a[4:7], v[68:71]
  v_mfma_f32_16x16x32_bf16 v[72:75], a[160:163], a[8:11], 0
  ds_read_b64_tr_b16 a[180:181], v230 offset:40960
  v_mfma_f32_16x16x32_bf16 v[72:75], a[164:167], a[24:27], v[72:75]
  v_mfma_f32_16x16x32_bf16 v[76:79], a[164:167], a[28:31], 0
  ds_read_b64_tr_b16 a[182:183], v230 offset:41984
  v_mfma_f32_16x16x32_bf16 v[76:79], a[160:163], a[12:15], v[76:79]
  s_waitcnt lgkmcnt(4)
  v_mfma_f32_16x16x32_bf16 v[80:83], a[168:171], a[0:3], 0
  ds_read_b64_tr_b16 a[184:185], v231 offset:32768
  v_mfma_f32_16x16x32_bf16 v[80:83], a[172:175], a[16:19], v[80:83]
  v_mfma_f32_16x16x32_bf16 v[84:87], a[172:175], a[20:23], 0
  ds_read_b64_tr_b16 a[186:187], v231 offset:33792
  v_mfma_f32_16x16x32_bf16 v[84:87], a[168:171], a[4:7], v[84:87]
  s_waitcnt vmcnt(32)
  v_mfma_f32_16x16x32_bf16 v[88:91], a[168:171], a[8:11], 0
  ds_read_b64_tr_b16 a[188:189], v231 offset:40960
  v_mfma_f32_16x16x32_bf16 v[88:91], a[172:175], a[24:27], v[88:91]
  s_barrier
  v_mfma_f32_16x16x32_bf16 v[92:95], a[172:175], a[28:31], 0
  ds_read_b64_tr_b16 a[190:191], v231 offset:41984
  v_mfma_f32_16x16x32_bf16 v[92:95], a[168:171], a[12:15], v[92:95]
  s_waitcnt lgkmcnt(4)
  v_mfma_f32_16x16x32_bf16 v[96:99], a[176:179], a[0:3], 0
  ds_read_b64_tr_b16 a[160:161], v224 offset:49152
  v_mfma_f32_16x16x32_bf16 v[96:99], a[180:183], a[16:19], v[96:99]
  v_mfma_f32_16x16x32_bf16 v[100:103], a[180:183], a[20:23], 0
  ds_read_b64_tr_b16 a[162:163], v224 offset:50176
  v_mfma_f32_16x16x32_bf16 v[100:103], a[176:179], a[4:7], v[100:103]
  v_mfma_f32_16x16x32_bf16 v[104:107], a[176:179], a[8:11], 0
  ds_read_b64_tr_b16 a[164:165], v224 offset:57344
  v_mfma_f32_16x16x32_bf16 v[104:107], a[180:183], a[24:27], v[104:107]
  v_mfma_f32_16x16x32_bf16 v[108:111], a[180:183], a[28:31], 0
  ds_read_b64_tr_b16 a[166:167], v224 offset:58368
  v_mfma_f32_16x16x32_bf16 v[108:111], a[176:179], a[12:15], v[108:111]
  s_waitcnt lgkmcnt(4)
  v_mfma_f32_16x16x32_bf16 v[112:115], a[184:187], a[0:3], 0
  ds_read_b64_tr_b16 a[168:169], v225 offset:49152
  v_mfma_f32_16x16x32_bf16 v[112:115], a[188:191], a[16:19], v[112:115]
  v_mfma_f32_16x16x32_bf16 v[116:119], a[188:191], a[20:23], 0
  ds_read_b64_tr_b16 a[170:171], v225 offset:50176
  v_mfma_f32_16x16x32_bf16 v[116:119], a[184:187], a[4:7], v[116:119]
  v_mfma_f32_16x16x32_bf16 v[120:123], a[184:187], a[8:11], 0
  ds_read_b64_tr_b16 a[172:173], v225 offset:57344
  v_mfma_f32_16x16x32_bf16 v[120:123], a[188:191], a[24:27], v[120:123]
  v_mfma_f32_16x16x32_bf16 v[124:127], a[188:191], a[28:31], 0
  ds_read_b64_tr_b16 a[174:175], v225 offset:58368
  v_mfma_f32_16x16x32_bf16 v[124:127], a[184:187], a[12:15], v[124:127]
  s_waitcnt vmcnt(24) lgkmcnt(4)
  v_mfma_f32_16x16x32_bf16 v[0:3], a[160:163], a[32:35], v[0:3]
  ds_read_b64_tr_b16 a[176:177], v226 offset:49152
  v_mfma_f32_16x16x32_bf16 v[0:3], a[164:167], a[48:51], v[0:3]
  buffer_load_dwordx4 a[0:3], v242, s[24:27], s30 offen offset:0
  v_mfma_f32_16x16x32_bf16 v[4:7], a[164:167], a[52:55], v[4:7]
  ds_read_b64_tr_b16 a[178:179], v226 offset:50176
  v_mfma_f32_16x16x32_bf16 v[4:7], a[160:163], a[36:39], v[4:7]
  buffer_load_dwordx4 a[4:7], v242, s[24:27], s30 offen offset:1024
  v_mfma_f32_16x16x32_bf16 v[8:11], a[160:163], a[40:43], v[8:11]
  ds_read_b64_tr_b16 a[180:181], v226 offset:57344
  v_mfma_f32_16x16x32_bf16 v[8:11], a[164:167], a[56:59], v[8:11]
  buffer_load_dwordx4 a[8:11], v242, s[24:27], s30 offen offset:2048
  v_mfma_f32_16x16x32_bf16 v[12:15], a[164:167], a[60:63], v[12:15]
  ds_read_b64_tr_b16 a[182:183], v226 offset:58368
  v_mfma_f32_16x16x32_bf16 v[12:15], a[160:163], a[44:47], v[12:15]
  s_waitcnt lgkmcnt(4)
  v_mfma_f32_16x16x32_bf16 v[16:19], a[168:171], a[32:35], v[16:19]
  ds_read_b64_tr_b16 a[184:185], v227 offset:49152
  v_mfma_f32_16x16x32_bf16 v[16:19], a[172:175], a[48:51], v[16:19]
  buffer_load_dwordx4 a[12:15], v242, s[24:27], s30 offen offset:3072
  v_mfma_f32_16x16x32_bf16 v[20:23], a[172:175], a[52:55], v[20:23]
  ds_read_b64_tr_b16 a[186:187], v227 offset:50176
  v_mfma_f32_16x16x32_bf16 v[20:23], a[168:171], a[36:39], v[20:23]
  buffer_load_dwordx4 a[16:19], v243, s[24:27], s30 offen offset:0
  v_mfma_f32_16x16x32_bf16 v[24:27], a[168:171], a[40:43], v[24:27]
  ds_read_b64_tr_b16 a[188:189], v227 offset:57344
  v_mfma_f32_16x16x32_bf16 v[24:27], a[172:175], a[56:59], v[24:27]
  buffer_load_dwordx4 a[20:23], v243, s[24:27], s30 offen offset:1024
  v_mfma_f32_16x16x32_bf16 v[28:31], a[172:175], a[60:63], v[28:31]
  ds_read_b64_tr_b16 a[190:191], v227 offset:58368
  v_mfma_f32_16x16x32_bf16 v[28:31], a[168:171], a[44:47], v[28:31]
  s_waitcnt lgkmcnt(4)
  v_mfma_f32_16x16x32_bf16 v[32:35], a[176:179], a[32:35], v[32:35]
  ds_read_b64_tr_b16 a[160:161], v228 offset:49152
  v_mfma_f32_16x16x32_bf16 v[32:35], a[180:183], a[48:51], v[32:35]
  buffer_load_dwordx4 a[24:27], v243, s[24:27], s30 offen offset:2048
  v_mfma_f32_16x16x32_bf16 v[36:39], a[180:183], a[52:55], v[36:39]
  ds_read_b64_tr_b16 a[162:163], v228 offset:50176
  v_mfma_f32_16x16x32_bf16 v[36:39], a[176:179], a[36:39], v[36:39]
  buffer_load_dwordx4 a[28:31], v243, s[24:27], s30 offen offset:3072
  v_mfma_f32_16x16x32_bf16 v[40:43], a[176:179], a[40:43], v[40:43]
  ds_read_b64_tr_b16 a[164:165], v228 offset:57344
  v_mfma_f32_16x16x32_bf16 v[40:43], a[180:183], a[56:59], v[40:43]
  s_add_u32 s30, s30, 8192
  v_mfma_f32_16x16x32_bf16 v[44:47], a[180:183], a[60:63], v[44:47]
  ds_read_b64_tr_b16 a[166:167], v228 offset:58368
  v_mfma_f32_16x16x32_bf16 v[44:47], a[176:179], a[44:47], v[44:47]
  s_waitcnt lgkmcnt(4)
  v_mfma_f32_16x16x32_bf16 v[48:51], a[184:187], a[32:35], v[48:51]
  ds_read_b64_tr_b16 a[168:169], v229 offset:49152
  s_lshl_b32 s35, s3, 11
  s_add_u32 s35, s35, 2621440
  buffer_load_dwordx4 v[128:131], v242, s[24:27], s35 offen
  v_mfma_f32_16x16x32_bf16 v[48:51], a[188:191], a[48:51], v[48:51]
  buffer_load_dwordx4 v[132:135], v242, s[24:27], s35 offen offset:1024
  v_mfma_f32_16x16x32_bf16 v[52:55], a[188:191], a[52:55], v[52:55]
  ds_read_b64_tr_b16 a[170:171], v229 offset:50176
  v_mfma_f32_16x16x32_bf16 v[52:55], a[184:187], a[36:39], v[52:55]
  v_mfma_f32_16x16x32_bf16 v[56:59], a[184:187], a[40:43], v[56:59]
  ds_read_b64_tr_b16 a[172:173], v229 offset:57344
  v_mfma_f32_16x16x32_bf16 v[56:59], a[188:191], a[56:59], v[56:59]
  v_mfma_f32_16x16x32_bf16 v[60:63], a[188:191], a[60:63], v[60:63]
  ds_read_b64_tr_b16 a[174:175], v229 offset:58368
  v_mfma_f32_16x16x32_bf16 v[60:63], a[184:187], a[44:47], v[60:63]
  s_waitcnt lgkmcnt(4)
  v_mfma_f32_16x16x32_bf16 v[64:67], a[160:163], a[32:35], v[64:67]
  ds_read_b64_tr_b16 a[176:177], v230 offset:49152
  v_mfma_f32_16x16x32_bf16 v[64:67], a[164:167], a[48:51], v[64:67]
  v_mfma_f32_16x16x32_bf16 v[68:71], a[164:167], a[52:55], v[68:71]
  ds_read_b64_tr_b16 a[178:179], v230 offset:50176
  v_mfma_f32_16x16x32_bf16 v[68:71], a[160:163], a[36:39], v[68:71]
  v_mfma_f32_16x16x32_bf16 v[72:75], a[160:163], a[40:43], v[72:75]
  ds_read_b64_tr_b16 a[180:181], v230 offset:57344
  v_mfma_f32_16x16x32_bf16 v[72:75], a[164:167], a[56:59], v[72:75]
  v_mfma_f32_16x16x32_bf16 v[76:79], a[164:167], a[60:63], v[76:79]
  ds_read_b64_tr_b16 a[182:183], v230 offset:58368
  v_mfma_f32_16x16x32_bf16 v[76:79], a[160:163], a[44:47], v[76:79]
  s_waitcnt lgkmcnt(4)
  v_mfma_f32_16x16x32_bf16 v[80:83], a[168:171], a[32:35], v[80:83]
  ds_read_b64_tr_b16 a[184:185], v231 offset:49152
  v_mfma_f32_16x16x32_bf16 v[80:83], a[172:175], a[48:51], v[80:83]
  v_mfma_f32_16x16x32_bf16 v[84:87], a[172:175], a[52:55], v[84:87]
  ds_read_b64_tr_b16 a[186:187], v231 offset:50176
  v_mfma_f32_16x16x32_bf16 v[84:87], a[168:171], a[36:39], v[84:87]
  s_waitcnt vmcnt(30)
  v_mfma_f32_16x16x32_bf16 v[88:91], a[168:171], a[40:43], v[88:91]
  ds_read_b64_tr_b16 a[188:189], v231 offset:57344
  v_mfma_f32_16x16x32_bf16 v[88:91], a[172:175], a[56:59], v[88:91]
  s_barrier
  v_mfma_f32_16x16x32_bf16 v[92:95], a[172:175], a[60:63], v[92:95]
  ds_read_b64_tr_b16 a[190:191], v231 offset:58368
  v_mfma_f32_16x16x32_bf16 v[92:95], a[168:171], a[44:47], v[92:95]
  s_waitcnt lgkmcnt(4)
  s_add_u32 m0, s28, 98304
  v_mfma_f32_16x16x32_bf16 v[96:99], a[176:179], a[32:35], v[96:99]
  ds_read_b64_tr_b16 a[160:161], v224 offset:0
  v_mfma_f32_16x16x32_bf16 v[96:99], a[180:183], a[48:51], v[96:99]
  buffer_load_dwordx4 v238, s[20:23], s31 offen offset:0 lds
  v_mfma_f32_16x16x32_bf16 v[100:103], a[180:183], a[52:55], v[100:103]
  ds_read_b64_tr_b16 a[162:163], v224 offset:1024
  v_mfma_f32_16x16x32_bf16 v[100:103], a[176:179], a[36:39], v[100:103]
  buffer_load_dwordx4 v239, s[20:23], s31 offen offset:1024 lds
  v_mfma_f32_16x16x32_bf16 v[104:107], a[176:179], a[40:43], v[104:107]
  ds_read_b64_tr_b16 a[164:165], v224 offset:8192
  v_mfma_f32_16x16x32_bf16 v[104:107], a[180:183], a[56:59], v[104:107]
  buffer_load_dwordx4 v240, s[20:23], s31 offen offset:2048 lds
  v_mfma_f32_16x16x32_bf16 v[108:111], a[180:183], a[60:63], v[108:111]
  ds_read_b64_tr_b16 a[166:167], v224 offset:9216
  v_mfma_f32_16x16x32_bf16 v[108:111], a[176:179], a[44:47], v[108:111]
  s_waitcnt lgkmcnt(4)
  v_mfma_f32_16x16x32_bf16 v[112:115], a[184:187], a[32:35], v[112:115]
  ds_read_b64_tr_b16 a[168:169], v225 offset:0
  v_mfma_f32_16x16x32_bf16 v[112:115], a[188:191], a[48:51], v[112:115]
  buffer_load_dwordx4 v241, s[20:23], s31 offen offset:3072 lds
  v_mfma_f32_16x16x32_bf16 v[116:119], a[188:191], a[52:55], v[116:119]
  ds_read_b64_tr_b16 a[170:171], v225 offset:1024
  v_mfma_f32_16x16x32_bf16 v[116:119], a[184:187], a[36:39], v[116:119]
  s_add_u32 s31, s31, 0x80000
  v_mfma_f32_16x16x32_bf16 v[120:123], a[184:187], a[40:43], v[120:123]
  ds_read_b64_tr_b16 a[172:173], v225 offset:8192
  v_mfma_f32_16x16x32_bf16 v[120:123], a[188:191], a[56:59], v[120:123]
  v_mfma_f32_16x16x32_bf16 v[124:127], a[188:191], a[60:63], v[124:127]
  ds_read_b64_tr_b16 a[174:175], v225 offset:9216
  v_mfma_f32_16x16x32_bf16 v[124:127], a[184:187], a[44:47], v[124:127]
  s_waitcnt vmcnt(26) lgkmcnt(4)
  v_mfma_f32_16x16x32_bf16 v[0:3], a[160:163], a[64:67], v[0:3]
  ds_read_b64_tr_b16 a[176:177], v226 offset:0
  v_mfma_f32_16x16x32_bf16 v[0:3], a[164:167], a[80:83], v[0:3]
  buffer_load_dwordx4 a[32:35], v242, s[24:27], s30 offen offset:0
  v_mfma_f32_16x16x32_bf16 v[4:7], a[164:167], a[84:87], v[4:7]
  ds_read_b64_tr_b16 a[178:179], v226 offset:1024
  v_mfma_f32_16x16x32_bf16 v[4:7], a[160:163], a[68:71], v[4:7]
  buffer_load_dwordx4 a[36:39], v242, s[24:27], s30 offen offset:1024
  v_mfma_f32_16x16x32_bf16 v[8:11], a[160:163], a[72:75], v[8:11]
  ds_read_b64_tr_b16 a[180:181], v226 offset:8192
  v_mfma_f32_16x16x32_bf16 v[8:11], a[164:167], a[88:91], v[8:11]
  buffer_load_dwordx4 a[40:43], v242, s[24:27], s30 offen offset:2048
  v_mfma_f32_16x16x32_bf16 v[12:15], a[164:167], a[92:95], v[12:15]
  ds_read_b64_tr_b16 a[182:183], v226 offset:9216
  v_mfma_f32_16x16x32_bf16 v[12:15], a[160:163], a[76:79], v[12:15]
  s_waitcnt lgkmcnt(4)
  v_mfma_f32_16x16x32_bf16 v[16:19], a[168:171], a[64:67], v[16:19]
  ds_read_b64_tr_b16 a[184:185], v227 offset:0
  v_mfma_f32_16x16x32_bf16 v[16:19], a[172:175], a[80:83], v[16:19]
  buffer_load_dwordx4 a[44:47], v242, s[24:27], s30 offen offset:3072
  v_mfma_f32_16x16x32_bf16 v[20:23], a[172:175], a[84:87], v[20:23]
  ds_read_b64_tr_b16 a[186:187], v227 offset:1024
  v_mfma_f32_16x16x32_bf16 v[20:23], a[168:171], a[68:71], v[20:23]
  buffer_load_dwordx4 a[48:51], v243, s[24:27], s30 offen offset:0
  v_mfma_f32_16x16x32_bf16 v[24:27], a[168:171], a[72:75], v[24:27]
  ds_read_b64_tr_b16 a[188:189], v227 offset:8192
  v_mfma_f32_16x16x32_bf16 v[24:27], a[172:175], a[88:91], v[24:27]
  buffer_load_dwordx4 a[52:55], v243, s[24:27], s30 offen offset:1024
  v_mfma_f32_16x16x32_bf16 v[28:31], a[172:175], a[92:95], v[28:31]
  ds_read_b64_tr_b16 a[190:191], v227 offset:9216
  v_mfma_f32_16x16x32_bf16 v[28:31], a[168:171], a[76:79], v[28:31]
  s_waitcnt lgkmcnt(4)
  v_mfma_f32_16x16x32_bf16 v[32:35], a[176:179], a[64:67], v[32:35]
  ds_read_b64_tr_b16 a[160:161], v228 offset:0
  v_mfma_f32_16x16x32_bf16 v[32:35], a[180:183], a[80:83], v[32:35]
  buffer_load_dwordx4 a[56:59], v243, s[24:27], s30 offen offset:2048
  v_mfma_f32_16x16x32_bf16 v[36:39], a[180:183], a[84:87], v[36:39]
  ds_read_b64_tr_b16 a[162:163], v228 offset:1024
  v_mfma_f32_16x16x32_bf16 v[36:39], a[176:179], a[68:71], v[36:39]
  buffer_load_dwordx4 a[60:63], v243, s[24:27], s30 offen offset:3072
  v_mfma_f32_16x16x32_bf16 v[40:43], a[176:179], a[72:75], v[40:43]
  ds_read_b64_tr_b16 a[164:165], v228 offset:8192
  v_mfma_f32_16x16x32_bf16 v[40:43], a[180:183], a[88:91], v[40:43]
  s_add_u32 s30, s30, 8192
  v_mfma_f32_16x16x32_bf16 v[44:47], a[180:183], a[92:95], v[44:47]
  ds_read_b64_tr_b16 a[166:167], v228 offset:9216
  v_mfma_f32_16x16x32_bf16 v[44:47], a[176:179], a[76:79], v[44:47]
  s_waitcnt lgkmcnt(4)
  v_mfma_f32_16x16x32_bf16 v[48:51], a[184:187], a[64:67], v[48:51]
  ds_read_b64_tr_b16 a[168:169], v229 offset:0
  v_mfma_f32_16x16x32_bf16 v[48:51], a[188:191], a[80:83], v[48:51]
  v_mfma_f32_16x16x32_bf16 v[52:55], a[188:191], a[84:87], v[52:55]
  ds_read_b64_tr_b16 a[170:171], v229 offset:1024
  v_mfma_f32_16x16x32_bf16 v[52:55], a[184:187], a[68:71], v[52:55]
  v_mfma_f32_16x16x32_bf16 v[56:59], a[184:187], a[72:75], v[56:59]
  ds_read_b64_tr_b16 a[172:173], v229 offset:8192
  v_mfma_f32_16x16x32_bf16 v[56:59], a[188:191], a[88:91], v[56:59]
  v_mfma_f32_16x16x32_bf16 v[60:63], a[188:191], a[92:95], v[60:63]
  ds_read_b64_tr_b16 a[174:175], v229 offset:9216
  v_mfma_f32_16x16x32_bf16 v[60:63], a[184:187], a[76:79], v[60:63]
  s_waitcnt lgkmcnt(4)
  v_mfma_f32_16x16x32_bf16 v[64:67], a[160:163], a[64:67], v[64:67]
  ds_read_b64_tr_b16 a[176:177], v230 offset:0
  v_mfma_f32_16x16x32_bf16 v[64:67], a[164:167], a[80:83], v[64:67]
  v_mfma_f32_16x16x32_bf16 v[68:71], a[164:167], a[84:87], v[68:71]
  ds_read_b64_tr_b16 a[178:179], v230 offset:1024
  v_mfma_f32_16x16x32_bf16 v[68:71], a[160:163], a[68:71], v[68:71]
  v_mfma_f32_16x16x32_bf16 v[72:75], a[160:163], a[72:75], v[72:75]
  ds_read_b64_tr_b16 a[180:181], v230 offset:8192
  v_mfma_f32_16x16x32_bf16 v[72:75], a[164:167], a[88:91], v[72:75]
  v_mfma_f32_16x16x32_bf16 v[76:79], a[164:167], a[92:95], v[76:79]
  ds_read_b64_tr_b16 a[182:183], v230 offset:9216
  v_mfma_f32_16x16x32_bf16 v[76:79], a[160:163], a[76:79], v[76:79]
  s_waitcnt lgkmcnt(4)
  v_mfma_f32_16x16x32_bf16 v[80:83], a[168:171], a[64:67], v[80:83]
  ds_read_b64_tr_b16 a[184:185], v231 offset:0
  v_mfma_f32_16x16x32_bf16 v[80:83], a[172:175], a[80:83], v[80:83]
  v_mfma_f32_16x16x32_bf16 v[84:87], a[172:175], a[84:87], v[84:87]
  ds_read_b64_tr_b16 a[186:187], v231 offset:1024
  v_mfma_f32_16x16x32_bf16 v[84:87], a[168:171], a[68:71], v[84:87]
  s_waitcnt vmcnt(30)
  v_mfma_f32_16x16x32_bf16 v[88:91], a[168:171], a[72:75], v[88:91]
  ds_read_b64_tr_b16 a[188:189], v231 offset:8192
  v_mfma_f32_16x16x32_bf16 v[88:91], a[172:175], a[88:91], v[88:91]
  s_barrier
  v_mfma_f32_16x16x32_bf16 v[92:95], a[172:175], a[92:95], v[92:95]
  ds_read_b64_tr_b16 a[190:191], v231 offset:9216
  v_mfma_f32_16x16x32_bf16 v[92:95], a[168:171], a[76:79], v[92:95]
  s_waitcnt lgkmcnt(4)
  s_add_u32 m0, s28, 114688
  v_mfma_f32_16x16x32_bf16 v[96:99], a[176:179], a[64:67], v[96:99]
  ds_read_b64_tr_b16 a[160:161], v224 offset:16384
  v_mfma_f32_16x16x32_bf16 v[96:99], a[180:183], a[80:83], v[96:99]
  buffer_load_dwordx4 v238, s[20:23], s31 offen offset:0 lds
  v_mfma_f32_16x16x32_bf16 v[100:103], a[180:183], a[84:87], v[100:103]
  ds_read_b64_tr_b16 a[162:163], v224 offset:17408
  v_mfma_f32_16x16x32_bf16 v[100:103], a[176:179], a[68:71], v[100:103]
  buffer_load_dwordx4 v239, s[20:23], s31 offen offset:1024 lds
  v_mfma_f32_16x16x32_bf16 v[104:107], a[176:179], a[72:75], v[104:107]
  ds_read_b64_tr_b16 a[164:165], v224 offset:24576
  v_mfma_f32_16x16x32_bf16 v[104:107], a[180:183], a[88:91], v[104:107]
  buffer_load_dwordx4 v240, s[20:23], s31 offen offset:2048 lds
  v_mfma_f32_16x16x32_bf16 v[108:111], a[180:183], a[92:95], v[108:111]
  ds_read_b64_tr_b16 a[166:167], v224 offset:25600
  v_mfma_f32_16x16x32_bf16 v[108:111], a[176:179], a[76:79], v[108:111]
  s_waitcnt lgkmcnt(4)
  v_mfma_f32_16x16x32_bf16 v[112:115], a[184:187], a[64:67], v[112:115]
  ds_read_b64_tr_b16 a[168:169], v225 offset:16384
  v_mfma_f32_16x16x32_bf16 v[112:115], a[188:191], a[80:83], v[112:115]
  buffer_load_dwordx4 v241, s[20:23], s31 offen offset:3072 lds
  v_mfma_f32_16x16x32_bf16 v[116:119], a[188:191], a[84:87], v[116:119]
  ds_read_b64_tr_b16 a[170:171], v225 offset:17408
  v_mfma_f32_16x16x32_bf16 v[116:119], a[184:187], a[68:71], v[116:119]
  s_add_u32 s31, s31, 0x80000
  v_mfma_f32_16x16x32_bf16 v[120:123], a[184:187], a[72:75], v[120:123]
  ds_read_b64_tr_b16 a[172:173], v225 offset:24576
  v_mfma_f32_16x16x32_bf16 v[120:123], a[188:191], a[88:91], v[120:123]
  v_mfma_f32_16x16x32_bf16 v[124:127], a[188:191], a[92:95], v[124:127]
  ds_read_b64_tr_b16 a[174:175], v225 offset:25600
  v_mfma_f32_16x16x32_bf16 v[124:127], a[184:187], a[76:79], v[124:127]
  s_waitcnt vmcnt(26) lgkmcnt(4)
  v_mfma_f32_16x16x32_bf16 v[0:3], a[160:163], a[96:99], v[0:3]
  ds_read_b64_tr_b16 a[176:177], v226 offset:16384
  v_mfma_f32_16x16x32_bf16 v[0:3], a[164:167], a[112:115], v[0:3]
  buffer_load_dwordx4 a[64:67], v242, s[24:27], s30 offen offset:0
  v_mfma_f32_16x16x32_bf16 v[4:7], a[164:167], a[116:119], v[4:7]
  ds_read_b64_tr_b16 a[178:179], v226 offset:17408
  v_mfma_f32_16x16x32_bf16 v[4:7], a[160:163], a[100:103], v[4:7]
  buffer_load_dwordx4 a[68:71], v242, s[24:27], s30 offen offset:1024
  v_mfma_f32_16x16x32_bf16 v[8:11], a[160:163], a[104:107], v[8:11]
  ds_read_b64_tr_b16 a[180:181], v226 offset:24576
  v_mfma_f32_16x16x32_bf16 v[8:11], a[164:167], a[120:123], v[8:11]
  buffer_load_dwordx4 a[72:75], v242, s[24:27], s30 offen offset:2048
  v_mfma_f32_16x16x32_bf16 v[12:15], a[164:167], a[124:127], v[12:15]
  ds_read_b64_tr_b16 a[182:183], v226 offset:25600
  v_mfma_f32_16x16x32_bf16 v[12:15], a[160:163], a[108:111], v[12:15]
  s_waitcnt lgkmcnt(4)
  v_mfma_f32_16x16x32_bf16 v[16:19], a[168:171], a[96:99], v[16:19]
  ds_read_b64_tr_b16 a[184:185], v227 offset:16384
  v_mfma_f32_16x16x32_bf16 v[16:19], a[172:175], a[112:115], v[16:19]
  buffer_load_dwordx4 a[76:79], v242, s[24:27], s30 offen offset:3072
  v_mfma_f32_16x16x32_bf16 v[20:23], a[172:175], a[116:119], v[20:23]
  ds_read_b64_tr_b16 a[186:187], v227 offset:17408
  v_mfma_f32_16x16x32_bf16 v[20:23], a[168:171], a[100:103], v[20:23]
  buffer_load_dwordx4 a[80:83], v243, s[24:27], s30 offen offset:0
  v_mfma_f32_16x16x32_bf16 v[24:27], a[168:171], a[104:107], v[24:27]
  ds_read_b64_tr_b16 a[188:189], v227 offset:24576
  v_mfma_f32_16x16x32_bf16 v[24:27], a[172:175], a[120:123], v[24:27]
  buffer_load_dwordx4 a[84:87], v243, s[24:27], s30 offen offset:1024
  v_mfma_f32_16x16x32_bf16 v[28:31], a[172:175], a[124:127], v[28:31]
  ds_read_b64_tr_b16 a[190:191], v227 offset:25600
  v_mfma_f32_16x16x32_bf16 v[28:31], a[168:171], a[108:111], v[28:31]
  s_waitcnt lgkmcnt(4)
  v_mfma_f32_16x16x32_bf16 v[32:35], a[176:179], a[96:99], v[32:35]
  ds_read_b64_tr_b16 a[160:161], v228 offset:16384
  v_mfma_f32_16x16x32_bf16 v[32:35], a[180:183], a[112:115], v[32:35]
  buffer_load_dwordx4 a[88:91], v243, s[24:27], s30 offen offset:2048
  v_mfma_f32_16x16x32_bf16 v[36:39], a[180:183], a[116:119], v[36:39]
  ds_read_b64_tr_b16 a[162:163], v228 offset:17408
  v_mfma_f32_16x16x32_bf16 v[36:39], a[176:179], a[100:103], v[36:39]
  buffer_load_dwordx4 a[92:95], v243, s[24:27], s30 offen offset:3072
  v_mfma_f32_16x16x32_bf16 v[40:43], a[176:179], a[104:107], v[40:43]
  ds_read_b64_tr_b16 a[164:165], v228 offset:24576
  v_mfma_f32_16x16x32_bf16 v[40:43], a[180:183], a[120:123], v[40:43]
  s_add_u32 s30, s30, 8192
  v_mfma_f32_16x16x32_bf16 v[44:47], a[180:183], a[124:127], v[44:47]
  ds_read_b64_tr_b16 a[166:167], v228 offset:25600
  v_mfma_f32_16x16x32_bf16 v[44:47], a[176:179], a[108:111], v[44:47]
  s_waitcnt lgkmcnt(4)
  v_mfma_f32_16x16x32_bf16 v[48:51], a[184:187], a[96:99], v[48:51]
  ds_read_b64_tr_b16 a[168:169], v229 offset:16384
  v_mfma_f32_16x16x32_bf16 v[48:51], a[188:191], a[112:115], v[48:51]
  v_mfma_f32_16x16x32_bf16 v[52:55], a[188:191], a[116:119], v[52:55]
  ds_read_b64_tr_b16 a[170:171], v229 offset:17408
  v_mfma_f32_16x16x32_bf16 v[52:55], a[184:187], a[100:103], v[52:55]
  v_mfma_f32_16x16x32_bf16 v[56:59], a[184:187], a[104:107], v[56:59]
  ds_read_b64_tr_b16 a[172:173], v229 offset:24576
  v_mfma_f32_16x16x32_bf16 v[56:59], a[188:191], a[120:123], v[56:59]
  v_mfma_f32_16x16x32_bf16 v[60:63], a[188:191], a[124:127], v[60:63]
  ds_read_b64_tr_b16 a[174:175], v229 offset:25600
  v_mfma_f32_16x16x32_bf16 v[60:63], a[184:187], a[108:111], v[60:63]
  s_waitcnt lgkmcnt(4)
  v_mfma_f32_16x16x32_bf16 v[64:67], a[160:163], a[96:99], v[64:67]
  ds_read_b64_tr_b16 a[176:177], v230 offset:16384
  s_waitcnt vmcnt(24)
  s_mov_b32 s51, -1
  v_sub_u32 v137, s51, v128
  v_mfma_f32_16x16x32_bf16 v[64:67], a[164:167], a[112:115], v[64:67]
  v_sub_u32 v138, s51, v129
  v_min_u32 v136, v137, v138
  v_mfma_f32_16x16x32_bf16 v[68:71], a[164:167], a[116:119], v[68:71]
  ds_read_b64_tr_b16 a[178:179], v230 offset:17408
  v_sub_u32 v139, s51, v130
  v_mfma_f32_16x16x32_bf16 v[68:71], a[160:163], a[100:103], v[68:71]
  v_sub_u32 v140, s51, v131
  v_min3_u32 v136, v136, v139, v140
  v_mfma_f32_16x16x32_bf16 v[72:75], a[160:163], a[104:107], v[72:75]
  ds_read_b64_tr_b16 a[180:181], v230 offset:24576
  v_sub_u32 v137, s51, v132
  v_mfma_f32_16x16x32_bf16 v[72:75], a[164:167], a[120:123], v[72:75]
  v_sub_u32 v138, s51, v133
  v_min3_u32 v136, v136, v137, v138
  v_mfma_f32_16x16x32_bf16 v[76:79], a[164:167], a[124:127], v[76:79]
  ds_read_b64_tr_b16 a[182:183], v230 offset:25600
  v_sub_u32 v139, s51, v134
  v_mfma_f32_16x16x32_bf16 v[76:79], a[160:163], a[108:111], v[76:79]
  s_waitcnt lgkmcnt(4)
  v_sub_u32 v140, s51, v135
  v_min3_u32 v136, v136, v139, v140
  v_mfma_f32_16x16x32_bf16 v[80:83], a[168:171], a[96:99], v[80:83]
  ds_read_b64_tr_b16 a[184:185], v231 offset:16384
  v_min_u32_dpp v136, v136, v136 row_ror:8 row_mask:0xf bank_mask:0xf
  v_mfma_f32_16x16x32_bf16 v[80:83], a[172:175], a[112:115], v[80:83]
  v_mfma_f32_16x16x32_bf16 v[84:87], a[172:175], a[116:119], v[84:87]
  ds_read_b64_tr_b16 a[186:187], v231 offset:17408
  v_min_u32_dpp v136, v136, v136 row_ror:4 row_mask:0xf bank_mask:0xf
  v_mfma_f32_16x16x32_bf16 v[84:87], a[168:171], a[100:103], v[84:87]
  s_waitcnt vmcnt(20)
  v_min_u32_dpp v136, v136, v136 row_ror:2 row_mask:0xf bank_mask:0xf
  v_mfma_f32_16x16x32_bf16 v[88:91], a[168:171], a[104:107], v[88:91]
  ds_read_b64_tr_b16 a[188:189], v231 offset:24576
  v_min_u32_dpp v136, v136, v136 row_ror:1 row_mask:0xf bank_mask:0xf
  v_mfma_f32_16x16x32_bf16 v[88:91], a[172:175], a[120:123], v[88:91]
  s_barrier
  v_readlane_b32 s98, v136, 0
  v_readlane_b32 s99, v136, 16
  v_mfma_f32_16x16x32_bf16 v[92:95], a[172:175], a[124:127], v[92:95]
  ds_read_b64_tr_b16 a[190:191], v231 offset:25600
  v_readlane_b32 s100, v136, 32
  v_mfma_f32_16x16x32_bf16 v[92:95], a[168:171], a[108:111], v[92:95]
  s_waitcnt lgkmcnt(4)
  s_add_u32 m0, s28, 65536
  v_readlane_b32 s101, v136, 48
  v_mfma_f32_16x16x32_bf16 v[96:99], a[176:179], a[96:99], v[96:99]
  ds_read_b64_tr_b16 a[160:161], v224 offset:32768
  s_min_u32 s98, s98, s99
  s_min_u32 s100, s100, s101
  s_min_u32 s98, s98, s100
  s_sub_u32 s52, s51, s98
  s_sub_u32 s51, s52, 1
  v_sub_u32 v137, s51, v128
  v_mfma_f32_16x16x32_bf16 v[96:99], a[180:183], a[112:115], v[96:99]
  buffer_load_dwordx4 v238, s[20:23], s31 offen offset:0 lds
  v_mfma_f32_16x16x32_bf16 v[100:103], a[180:183], a[116:119], v[100:103]
  ds_read_b64_tr_b16 a[162:163], v224 offset:33792
  v_sub_u32 v138, s51, v129
  v_mfma_f32_16x16x32_bf16 v[100:103], a[176:179], a[100:103], v[100:103]
  buffer_load_dwordx4 v239, s[20:23], s31 offen offset:1024 lds
  v_mfma_f32_16x16x32_bf16 v[104:107], a[176:179], a[104:107], v[104:107]
  ds_read_b64_tr_b16 a[164:165], v224 offset:40960
  v_min_u32 v136, v137, v138
  v_mfma_f32_16x16x32_bf16 v[104:107], a[180:183], a[120:123], v[104:107]
  buffer_load_dwordx4 v240, s[20:23], s31 offen offset:2048 lds
  v_mfma_f32_16x16x32_bf16 v[108:111], a[180:183], a[124:127], v[108:111]
  ds_read_b64_tr_b16 a[166:167], v224 offset:41984
  v_sub_u32 v139, s51, v130
  v_mfma_f32_16x16x32_bf16 v[108:111], a[176:179], a[108:111], v[108:111]
  s_waitcnt lgkmcnt(4)
  v_sub_u32 v140, s51, v131
  v_min3_u32 v136, v136, v139, v140
  v_mfma_f32_16x16x32_bf16 v[112:115], a[184:187], a[96:99], v[112:115]
  ds_read_b64_tr_b16 a[168:169], v225 offset:32768
  v_sub_u32 v137, s51, v132
  v_mfma_f32_16x16x32_bf16 v[112:115], a[188:191], a[112:115], v[112:115]
  buffer_load_dwordx4 v241, s[20:23], s31 offen offset:3072 lds
  v_mfma_f32_16x16x32_bf16 v[116:119], a[188:191], a[116:119], v[116:119]
  ds_read_b64_tr_b16 a[170:171], v225 offset:33792
  v_sub_u32 v138, s51, v133
  v_mfma_f32_16x16x32_bf16 v[116:119], a[184:187], a[100:103], v[116:119]
  s_add_u32 s31, s31, 0x80000
  v_min3_u32 v136, v136, v137, v138
  v_sub_u32 v139, s51, v134
  v_mfma_f32_16x16x32_bf16 v[120:123], a[184:187], a[104:107], v[120:123]
  ds_read_b64_tr_b16 a[172:173], v225 offset:40960
  v_sub_u32 v140, s51, v135
  v_mfma_f32_16x16x32_bf16 v[120:123], a[188:191], a[120:123], v[120:123]
  v_min3_u32 v136, v136, v139, v140
  v_mfma_f32_16x16x32_bf16 v[124:127], a[188:191], a[124:127], v[124:127]
  ds_read_b64_tr_b16 a[174:175], v225 offset:41984
  v_min_u32_dpp v136, v136, v136 row_ror:8 row_mask:0xf bank_mask:0xf
  v_mfma_f32_16x16x32_bf16 v[124:127], a[184:187], a[108:111], v[124:127]
  s_waitcnt lgkmcnt(4)
  v_min_u32_dpp v136, v136, v136 row_ror:4 row_mask:0xf bank_mask:0xf
  v_mfma_f32_16x16x32_bf16 v[0:3], a[160:163], a[0:3], v[0:3]
  ds_read_b64_tr_b16 a[176:177], v226 offset:32768
  v_mfma_f32_16x16x32_bf16 v[0:3], a[164:167], a[16:19], v[0:3]
  buffer_load_dwordx4 a[96:99], v242, s[24:27], s30 offen offset:0
  v_mfma_f32_16x16x32_bf16 v[4:7], a[164:167], a[20:23], v[4:7]
  ds_read_b64_tr_b16 a[178:179], v226 offset:33792
  v_mfma_f32_16x16x32_bf16 v[4:7], a[160:163], a[4:7], v[4:7]
  buffer_load_dwordx4 a[100:103], v242, s[24:27], s30 offen offset:1024
  v_mfma_f32_16x16x32_bf16 v[8:11], a[160:163], a[8:11], v[8:11]
  ds_read_b64_tr_b16 a[180:181], v226 offset:40960
  v_mfma_f32_16x16x32_bf16 v[8:11], a[164:167], a[24:27], v[8:11]
  buffer_load_dwordx4 a[104:107], v242, s[24:27], s30 offen offset:2048
  v_mfma_f32_16x16x32_bf16 v[12:15], a[164:167], a[28:31], v[12:15]
  ds_read_b64_tr_b16 a[182:183], v226 offset:41984
  v_mfma_f32_16x16x32_bf16 v[12:15], a[160:163], a[12:15], v[12:15]
  s_waitcnt lgkmcnt(4)
  v_mfma_f32_16x16x32_bf16 v[16:19], a[168:171], a[0:3], v[16:19]
  ds_read_b64_tr_b16 a[184:185], v227 offset:32768
  v_mfma_f32_16x16x32_bf16 v[16:19], a[172:175], a[16:19], v[16:19]
  buffer_load_dwordx4 a[108:111], v242, s[24:27], s30 offen offset:3072
  v_mfma_f32_16x16x32_bf16 v[20:23], a[172:175], a[20:23], v[20:23]
  ds_read_b64_tr_b16 a[186:187], v227 offset:33792
  v_mfma_f32_16x16x32_bf16 v[20:23], a[168:171], a[4:7], v[20:23]
  buffer_load_dwordx4 a[112:115], v243, s[24:27], s30 offen offset:0
  v_mfma_f32_16x16x32_bf16 v[24:27], a[168:171], a[8:11], v[24:27]
  ds_read_b64_tr_b16 a[188:189], v227 offset:40960
  v_mfma_f32_16x16x32_bf16 v[24:27], a[172:175], a[24:27], v[24:27]
  buffer_load_dwordx4 a[116:119], v243, s[24:27], s30 offen offset:1024
  v_mfma_f32_16x16x32_bf16 v[28:31], a[172:175], a[28:31], v[28:31]
  ds_read_b64_tr_b16 a[190:191], v227 offset:41984
  v_mfma_f32_16x16x32_bf16 v[28:31], a[168:171], a[12:15], v[28:31]
  s_waitcnt lgkmcnt(4)
  v_mfma_f32_16x16x32_bf16 v[32:35], a[176:179], a[0:3], v[32:35]
  ds_read_b64_tr_b16 a[160:161], v228 offset:32768
  v_mfma_f32_16x16x32_bf16 v[32:35], a[180:183], a[16:19], v[32:35]
  buffer_load_dwordx4 a[120:123], v243, s[24:27], s30 offen offset:2048
  v_mfma_f32_16x16x32_bf16 v[36:39], a[180:183], a[20:23], v[36:39]
  ds_read_b64_tr_b16 a[162:163], v228 offset:33792
  v_mfma_f32_16x16x32_bf16 v[36:39], a[176:179], a[4:7], v[36:39]
  buffer_load_dwordx4 a[124:127], v243, s[24:27], s30 offen offset:3072
  v_mfma_f32_16x16x32_bf16 v[40:43], a[176:179], a[8:11], v[40:43]
  ds_read_b64_tr_b16 a[164:165], v228 offset:40960
  v_mfma_f32_16x16x32_bf16 v[40:43], a[180:183], a[24:27], v[40:43]
  s_add_u32 s30, s30, 8192
  v_mfma_f32_16x16x32_bf16 v[44:47], a[180:183], a[28:31], v[44:47]
  ds_read_b64_tr_b16 a[166:167], v228 offset:41984
  v_mfma_f32_16x16x32_bf16 v[44:47], a[176:179], a[12:15], v[44:47]
  s_waitcnt lgkmcnt(4)
  v_mfma_f32_16x16x32_bf16 v[48:51], a[184:187], a[0:3], v[48:51]
  ds_read_b64_tr_b16 a[168:169], v229 offset:32768
  v_mfma_f32_16x16x32_bf16 v[48:51], a[188:191], a[16:19], v[48:51]
  v_mfma_f32_16x16x32_bf16 v[52:55], a[188:191], a[20:23], v[52:55]
  ds_read_b64_tr_b16 a[170:171], v229 offset:33792
  v_mfma_f32_16x16x32_bf16 v[52:55], a[184:187], a[4:7], v[52:55]
  v_mfma_f32_16x16x32_bf16 v[56:59], a[184:187], a[8:11], v[56:59]
  ds_read_b64_tr_b16 a[172:173], v229 offset:40960
  v_mfma_f32_16x16x32_bf16 v[56:59], a[188:191], a[24:27], v[56:59]
  v_mfma_f32_16x16x32_bf16 v[60:63], a[188:191], a[28:31], v[60:63]
  ds_read_b64_tr_b16 a[174:175], v229 offset:41984
  v_mfma_f32_16x16x32_bf16 v[60:63], a[184:187], a[12:15], v[60:63]
  s_waitcnt lgkmcnt(4)
  v_mfma_f32_16x16x32_bf16 v[64:67], a[160:163], a[0:3], v[64:67]
  ds_read_b64_tr_b16 a[176:177], v230 offset:32768
  v_min_u32_dpp v136, v136, v136 row_ror:2 row_mask:0xf bank_mask:0xf
  v_mfma_f32_16x16x32_bf16 v[64:67], a[164:167], a[16:19], v[64:67]
  v_mfma_f32_16x16x32_bf16 v[68:71], a[164:167], a[20:23], v[68:71]
  ds_read_b64_tr_b16 a[178:179], v230 offset:33792
  v_min_u32_dpp v136, v136, v136 row_ror:1 row_mask:0xf bank_mask:0xf
  v_mfma_f32_16x16x32_bf16 v[68:71], a[160:163], a[4:7], v[68:71]
  v_readlane_b32 s98, v136, 0
  v_readlane_b32 s99, v136, 16
  v_mfma_f32_16x16x32_bf16 v[72:75], a[160:163], a[8:11], v[72:75]
  ds_read_b64_tr_b16 a[180:181], v230 offset:40960
  v_readlane_b32 s100, v136, 32
  v_mfma_f32_16x16x32_bf16 v[72:75], a[164:167], a[24:27], v[72:75]
  v_readlane_b32 s101, v136, 48
  v_mfma_f32_16x16x32_bf16 v[76:79], a[164:167], a[28:31], v[76:79]
  ds_read_b64_tr_b16 a[182:183], v230 offset:41984
  s_min_u32 s98, s98, s99
  s_min_u32 s100, s100, s101
  s_min_u32 s98, s98, s100
  s_sub_u32 s53, s51, s98
  s_sub_u32 s51, s53, 1
  v_sub_u32 v137, s51, v128
  v_mfma_f32_16x16x32_bf16 v[76:79], a[160:163], a[12:15], v[76:79]
  s_waitcnt lgkmcnt(4)
  v_sub_u32 v138, s51, v129
  v_min_u32 v136, v137, v138
  v_mfma_f32_16x16x32_bf16 v[80:83], a[168:171], a[0:3], v[80:83]
  ds_read_b64_tr_b16 a[184:185], v231 offset:32768
  v_sub_u32 v139, s51, v130
  v_mfma_f32_16x16x32_bf16 v[80:83], a[172:175], a[16:19], v[80:83]
  v_sub_u32 v140, s51, v131
  v_min3_u32 v136, v136, v139, v140
  v_mfma_f32_16x16x32_bf16 v[84:87], a[172:175], a[20:23], v[84:87]
  ds_read_b64_tr_b16 a[186:187], v231 offset:33792
  v_sub_u32 v137, s51, v132
  v_mfma_f32_16x16x32_bf16 v[84:87], a[168:171], a[4:7], v[84:87]
  s_waitcnt vmcnt(20)
  v_sub_u32 v138, s51, v133
  v_min3_u32 v136, v136, v137, v138
  v_mfma_f32_16x16x32_bf16 v[88:91], a[168:171], a[8:11], v[88:91]
  ds_read_b64_tr_b16 a[188:189], v231 offset:40960
  v_sub_u32 v139, s51, v134
  v_mfma_f32_16x16x32_bf16 v[88:91], a[172:175], a[24:27], v[88:91]
  s_barrier
  v_sub_u32 v140, s51, v135
  v_min3_u32 v136, v136, v139, v140
  v_mfma_f32_16x16x32_bf16 v[92:95], a[172:175], a[28:31], v[92:95]
  ds_read_b64_tr_b16 a[190:191], v231 offset:41984
  v_min_u32_dpp v136, v136, v136 row_ror:8 row_mask:0xf bank_mask:0xf
  v_mfma_f32_16x16x32_bf16 v[92:95], a[168:171], a[12:15], v[92:95]
  s_waitcnt lgkmcnt(4)
  s_add_u32 m0, s28, 81920
  v_min_u32_dpp v136, v136, v136 row_ror:4 row_mask:0xf bank_mask:0xf
  v_mfma_f32_16x16x32_bf16 v[96:99], a[176:179], a[0:3], v[96:99]
  ds_read_b64_tr_b16 a[160:161], v224 offset:49152
  v_min_u32_dpp v136, v136, v136 row_ror:2 row_mask:0xf bank_mask:0xf
  v_mfma_f32_16x16x32_bf16 v[96:99], a[180:183], a[16:19], v[96:99]
  buffer_load_dwordx4 v238, s[20:23], s31 offen offset:0 lds
  v_mfma_f32_16x16x32_bf16 v[100:103], a[180:183], a[20:23], v[100:103]
  ds_read_b64_tr_b16 a[162:163], v224 offset:50176
  v_min_u32_dpp v136, v136, v136 row_ror:1 row_mask:0xf bank_mask:0xf
  v_mfma_f32_16x16x32_bf16 v[100:103], a[176:179], a[4:7], v[100:103]
  buffer_load_dwordx4 v239, s[20:23], s31 offen offset:1024 lds
  v_mfma_f32_16x16x32_bf16 v[104:107], a[176:179], a[8:11], v[104:107]
  ds_read_b64_tr_b16 a[164:165], v224 offset:57344
  v_readlane_b32 s98, v136, 0
  v_mfma_f32_16x16x32_bf16 v[104:107], a[180:183], a[24:27], v[104:107]
  buffer_load_dwordx4 v240, s[20:23], s31 offen offset:2048 lds
  v_mfma_f32_16x16x32_bf16 v[108:111], a[180:183], a[28:31], v[108:111]
  ds_read_b64_tr_b16 a[166:167], v224 offset:58368
  v_readlane_b32 s99, v136, 16
  v_mfma_f32_16x16x32_bf16 v[108:111], a[176:179], a[12:15], v[108:111]
  s_waitcnt lgkmcnt(4)
  v_readlane_b32 s100, v136, 32
  v_readlane_b32 s101, v136, 48
  v_mfma_f32_16x16x32_bf16 v[112:115], a[184:187], a[0:3], v[112:115]
  ds_read_b64_tr_b16 a[168:169], v225 offset:49152
  s_min_u32 s98, s98, s99
  s_min_u32 s100, s100, s101
  s_min_u32 s98, s98, s100
  s_sub_u32 s54, s51, s98
  s_sub_u32 s51, s54, 1
  v_sub_u32 v137, s51, v128
  v_mfma_f32_16x16x32_bf16 v[112:115], a[188:191], a[16:19], v[112:115]
  buffer_load_dwordx4 v241, s[20:23], s31 offen offset:3072 lds
  v_mfma_f32_16x16x32_bf16 v[116:119], a[188:191], a[20:23], v[116:119]
  ds_read_b64_tr_b16 a[170:171], v225 offset:50176
  v_sub_u32 v138, s51, v129
  v_mfma_f32_16x16x32_bf16 v[116:119], a[184:187], a[4:7], v[116:119]
  s_add_u32 s31, s31, 0x80000
  v_min_u32 v136, v137, v138
  v_sub_u32 v139, s51, v130
  v_mfma_f32_16x16x32_bf16 v[120:123], a[184:187], a[8:11], v[120:123]
  ds_read_b64_tr_b16 a[172:173], v225 offset:57344
  v_sub_u32 v140, s51, v131
  v_mfma_f32_16x16x32_bf16 v[120:123], a[188:191], a[24:27], v[120:123]
  v_min3_u32 v136, v136, v139, v140
  v_sub_u32 v137, s51, v132
  v_mfma_f32_16x16x32_bf16 v[124:127], a[188:191], a[28:31], v[124:127]
  ds_read_b64_tr_b16 a[174:175], v225 offset:58368
  v_sub_u32 v138, s51, v133
  v_mfma_f32_16x16x32_bf16 v[124:127], a[184:187], a[12:15], v[124:127]
  s_waitcnt lgkmcnt(4)
  v_min3_u32 v136, v136, v137, v138
  v_sub_u32 v139, s51, v134
  v_mfma_f32_16x16x32_bf16 v[0:3], a[160:163], a[32:35], v[0:3]
  ds_read_b64_tr_b16 a[176:177], v226 offset:49152
  v_mfma_f32_16x16x32_bf16 v[0:3], a[164:167], a[48:51], v[0:3]
  buffer_load_dwordx4 a[0:3], v242, s[24:27], s30 offen offset:0
  v_mfma_f32_16x16x32_bf16 v[4:7], a[164:167], a[52:55], v[4:7]
  ds_read_b64_tr_b16 a[178:179], v226 offset:50176
  v_mfma_f32_16x16x32_bf16 v[4:7], a[160:163], a[36:39], v[4:7]
  buffer_load_dwordx4 a[4:7], v242, s[24:27], s30 offen offset:1024
  v_mfma_f32_16x16x32_bf16 v[8:11], a[160:163], a[40:43], v[8:11]
  ds_read_b64_tr_b16 a[180:181], v226 offset:57344
  v_mfma_f32_16x16x32_bf16 v[8:11], a[164:167], a[56:59], v[8:11]
  buffer_load_dwordx4 a[8:11], v242, s[24:27], s30 offen offset:2048
  v_mfma_f32_16x16x32_bf16 v[12:15], a[164:167], a[60:63], v[12:15]
  ds_read_b64_tr_b16 a[182:183], v226 offset:58368
  v_mfma_f32_16x16x32_bf16 v[12:15], a[160:163], a[44:47], v[12:15]
  s_waitcnt lgkmcnt(4)
  v_mfma_f32_16x16x32_bf16 v[16:19], a[168:171], a[32:35], v[16:19]
  ds_read_b64_tr_b16 a[184:185], v227 offset:49152
  v_mfma_f32_16x16x32_bf16 v[16:19], a[172:175], a[48:51], v[16:19]
  buffer_load_dwordx4 a[12:15], v242, s[24:27], s30 offen offset:3072
  v_mfma_f32_16x16x32_bf16 v[20:23], a[172:175], a[52:55], v[20:23]
  ds_read_b64_tr_b16 a[186:187], v227 offset:50176
  v_mfma_f32_16x16x32_bf16 v[20:23], a[168:171], a[36:39], v[20:23]
  buffer_load_dwordx4 a[16:19], v243, s[24:27], s30 offen offset:0
  v_mfma_f32_16x16x32_bf16 v[24:27], a[168:171], a[40:43], v[24:27]
  ds_read_b64_tr_b16 a[188:189], v227 offset:57344
  v_mfma_f32_16x16x32_bf16 v[24:27], a[172:175], a[56:59], v[24:27]
  buffer_load_dwordx4 a[20:23], v243, s[24:27], s30 offen offset:1024
  v_mfma_f32_16x16x32_bf16 v[28:31], a[172:175], a[60:63], v[28:31]
  ds_read_b64_tr_b16 a[190:191], v227 offset:58368
  v_mfma_f32_16x16x32_bf16 v[28:31], a[168:171], a[44:47], v[28:31]
  s_waitcnt lgkmcnt(4)
  v_mfma_f32_16x16x32_bf16 v[32:35], a[176:179], a[32:35], v[32:35]
  ds_read_b64_tr_b16 a[160:161], v228 offset:49152
  v_mfma_f32_16x16x32_bf16 v[32:35], a[180:183], a[48:51], v[32:35]
  buffer_load_dwordx4 a[24:27], v243, s[24:27], s30 offen offset:2048
  v_mfma_f32_16x16x32_bf16 v[36:39], a[180:183], a[52:55], v[36:39]
  ds_read_b64_tr_b16 a[162:163], v228 offset:50176
  v_mfma_f32_16x16x32_bf16 v[36:39], a[176:179], a[36:39], v[36:39]
  buffer_load_dwordx4 a[28:31], v243, s[24:27], s30 offen offset:3072
  v_mfma_f32_16x16x32_bf16 v[40:43], a[176:179], a[40:43], v[40:43]
  ds_read_b64_tr_b16 a[164:165], v228 offset:57344
  v_mfma_f32_16x16x32_bf16 v[40:43], a[180:183], a[56:59], v[40:43]
  s_add_u32 s30, s30, 8192
  v_mfma_f32_16x16x32_bf16 v[44:47], a[180:183], a[60:63], v[44:47]
  ds_read_b64_tr_b16 a[166:167], v228 offset:58368
  v_mfma_f32_16x16x32_bf16 v[44:47], a[176:179], a[44:47], v[44:47]
  s_waitcnt lgkmcnt(4)
  v_mfma_f32_16x16x32_bf16 v[48:51], a[184:187], a[32:35], v[48:51]
  ds_read_b64_tr_b16 a[168:169], v229 offset:49152
  v_mfma_f32_16x16x32_bf16 v[48:51], a[188:191], a[48:51], v[48:51]
  s_add_u32 m0, s28, 0
  v_mfma_f32_16x16x32_bf16 v[52:55], a[188:191], a[52:55], v[52:55]
  ds_read_b64_tr_b16 a[170:171], v229 offset:50176
  v_mfma_f32_16x16x32_bf16 v[52:55], a[184:187], a[36:39], v[52:55]
  buffer_load_dwordx4 v232, s[12:15], s29 offen offset:0 lds
  v_mfma_f32_16x16x32_bf16 v[56:59], a[184:187], a[40:43], v[56:59]
  ds_read_b64_tr_b16 a[172:173], v229 offset:57344
  v_mfma_f32_16x16x32_bf16 v[56:59], a[188:191], a[56:59], v[56:59]
  buffer_load_dwordx4 v233, s[12:15], s29 offen offset:1024 lds
  v_mfma_f32_16x16x32_bf16 v[60:63], a[188:191], a[60:63], v[60:63]
  ds_read_b64_tr_b16 a[174:175], v229 offset:58368
  v_mfma_f32_16x16x32_bf16 v[60:63], a[184:187], a[44:47], v[60:63]
  s_waitcnt lgkmcnt(4)
  v_mfma_f32_16x16x32_bf16 v[64:67], a[160:163], a[32:35], v[64:67]
  ds_read_b64_tr_b16 a[176:177], v230 offset:49152
  v_sub_u32 v140, s51, v135
  v_mfma_f32_16x16x32_bf16 v[64:67], a[164:167], a[48:51], v[64:67]
  buffer_load_dwordx4 v234, s[12:15], s29 offen offset:2048 lds
  v_mfma_f32_16x16x32_bf16 v[68:71], a[164:167], a[52:55], v[68:71]
  ds_read_b64_tr_b16 a[178:179], v230 offset:50176
  v_min3_u32 v136, v136, v139, v140
  v_mfma_f32_16x16x32_bf16 v[68:71], a[160:163], a[36:39], v[68:71]
  buffer_load_dwordx4 v235, s[12:15], s29 offen offset:3072 lds
  v_mfma_f32_16x16x32_bf16 v[72:75], a[160:163], a[40:43], v[72:75]
  ds_read_b64_tr_b16 a[180:181], v230 offset:57344
  v_min_u32_dpp v136, v136, v136 row_ror:8 row_mask:0xf bank_mask:0xf
  v_mfma_f32_16x16x32_bf16 v[72:75], a[164:167], a[56:59], v[72:75]
  s_add_u32 s29, s29, 16384
  v_min_u32_dpp v136, v136, v136 row_ror:4 row_mask:0xf bank_mask:0xf
  v_mfma_f32_16x16x32_bf16 v[76:79], a[164:167], a[60:63], v[76:79]
  ds_read_b64_tr_b16 a[182:183], v230 offset:58368
  v_min_u32_dpp v136, v136, v136 row_ror:2 row_mask:0xf bank_mask:0xf
  v_mfma_f32_16x16x32_bf16 v[76:79], a[160:163], a[44:47], v[76:79]
  s_waitcnt lgkmcnt(4)
  v_min_u32_dpp v136, v136, v136 row_ror:1 row_mask:0xf bank_mask:0xf
  v_mfma_f32_16x16x32_bf16 v[80:83], a[168:171], a[32:35], v[80:83]
  ds_read_b64_tr_b16 a[184:185], v231 offset:49152
  v_readlane_b32 s98, v136, 0
  v_mfma_f32_16x16x32_bf16 v[80:83], a[172:175], a[48:51], v[80:83]
  v_readlane_b32 s99, v136, 16
  v_readlane_b32 s100, v136, 32
  v_mfma_f32_16x16x32_bf16 v[84:87], a[172:175], a[52:55], v[84:87]
  ds_read_b64_tr_b16 a[186:187], v231 offset:50176
  v_readlane_b32 s101, v136, 48
  v_mfma_f32_16x16x32_bf16 v[84:87], a[168:171], a[36:39], v[84:87]
  s_waitcnt vmcnt(24)
  s_min_u32 s98, s98, s99
  s_min_u32 s100, s100, s101
  s_min_u32 s98, s98, s100
  s_sub_u32 s55, s51, s98
  s_sub_u32 s51, s55, 1
  v_sub_u32 v137, s51, v128
  v_sub_u32 v138, s51, v129
  v_mfma_f32_16x16x32_bf16 v[88:91], a[168:171], a[40:43], v[88:91]
  ds_read_b64_tr_b16 a[188:189], v231 offset:57344
  v_min_u32 v136, v137, v138
  v_mfma_f32_16x16x32_bf16 v[88:91], a[172:175], a[56:59], v[88:91]
  s_barrier
  v_sub_u32 v139, s51, v130
  v_sub_u32 v140, s51, v131
  v_mfma_f32_16x16x32_bf16 v[92:95], a[172:175], a[60:63], v[92:95]
  ds_read_b64_tr_b16 a[190:191], v231 offset:58368
  v_min3_u32 v136, v136, v139, v140
  v_mfma_f32_16x16x32_bf16 v[92:95], a[168:171], a[44:47], v[92:95]
  s_waitcnt lgkmcnt(4)
  s_add_u32 m0, s28, 98304
  v_sub_u32 v137, s51, v132
  v_sub_u32 v138, s51, v133
  v_mfma_f32_16x16x32_bf16 v[96:99], a[176:179], a[32:35], v[96:99]
  ds_read_b64_tr_b16 a[160:161], v224 offset:0
  v_min3_u32 v136, v136, v137, v138
  v_mfma_f32_16x16x32_bf16 v[96:99], a[180:183], a[48:51], v[96:99]
  buffer_load_dwordx4 v238, s[20:23], s31 offen offset:0 lds
  v_mfma_f32_16x16x32_bf16 v[100:103], a[180:183], a[52:55], v[100:103]
  ds_read_b64_tr_b16 a[162:163], v224 offset:1024
  v_sub_u32 v139, s51, v134
  v_mfma_f32_16x16x32_bf16 v[100:103], a[176:179], a[36:39], v[100:103]
  buffer_load_dwordx4 v239, s[20:23], s31 offen offset:1024 lds
  v_mfma_f32_16x16x32_bf16 v[104:107], a[176:179], a[40:43], v[104:107]
  ds_read_b64_tr_b16 a[164:165], v224 offset:8192
  v_sub_u32 v140, s51, v135
  v_mfma_f32_16x16x32_bf16 v[104:107], a[180:183], a[56:59], v[104:107]
  buffer_load_dwordx4 v240, s[20:23], s31 offen offset:2048 lds
  v_mfma_f32_16x16x32_bf16 v[108:111], a[180:183], a[60:63], v[108:111]
  ds_read_b64_tr_b16 a[166:167], v224 offset:9216
  v_min3_u32 v136, v136, v139, v140
  v_mfma_f32_16x16x32_bf16 v[108:111], a[176:179], a[44:47], v[108:111]
  s_waitcnt lgkmcnt(4)
  v_min_u32_dpp v136, v136, v136 row_ror:8 row_mask:0xf bank_mask:0xf
  v_mfma_f32_16x16x32_bf16 v[112:115], a[184:187], a[32:35], v[112:115]
  ds_read_b64_tr_b16 a[168:169], v225 offset:0
  v_min_u32_dpp v136, v136, v136 row_ror:4 row_mask:0xf bank_mask:0xf
  v_mfma_f32_16x16x32_bf16 v[112:115], a[188:191], a[48:51], v[112:115]
  buffer_load_dwordx4 v241, s[20:23], s31 offen offset:3072 lds
  v_mfma_f32_16x16x32_bf16 v[116:119], a[188:191], a[52:55], v[116:119]
  ds_read_b64_tr_b16 a[170:171], v225 offset:1024
  v_min_u32_dpp v136, v136, v136 row_ror:2 row_mask:0xf bank_mask:0xf
  v_mfma_f32_16x16x32_bf16 v[116:119], a[184:187], a[36:39], v[116:119]
  s_add_u32 s31, s31, 0x80000
  v_min_u32_dpp v136, v136, v136 row_ror:1 row_mask:0xf bank_mask:0xf
  v_mfma_f32_16x16x32_bf16 v[120:123], a[184:187], a[40:43], v[120:123]
  ds_read_b64_tr_b16 a[172:173], v225 offset:8192
  v_readlane_b32 s98, v136, 0
  v_mfma_f32_16x16x32_bf16 v[120:123], a[188:191], a[56:59], v[120:123]
  v_readlane_b32 s99, v136, 16
  v_readlane_b32 s100, v136, 32
  v_mfma_f32_16x16x32_bf16 v[124:127], a[188:191], a[60:63], v[124:127]
  ds_read_b64_tr_b16 a[174:175], v225 offset:9216
  v_readlane_b32 s101, v136, 48
  v_mfma_f32_16x16x32_bf16 v[124:127], a[184:187], a[44:47], v[124:127]
  s_waitcnt lgkmcnt(4)
  s_min_u32 s98, s98, s99
  s_min_u32 s100, s100, s101
  s_min_u32 s98, s98, s100
  s_sub_u32 s56, s51, s98
  s_sub_u32 s51, s56, 1
  v_sub_u32 v137, s51, v128
  v_sub_u32 v138, s51, v129
  v_mfma_f32_16x16x32_bf16 v[0:3], a[160:163], a[64:67], v[0:3]
  ds_read_b64_tr_b16 a[176:177], v226 offset:0
  v_mfma_f32_16x16x32_bf16 v[0:3], a[164:167], a[80:83], v[0:3]
  buffer_load_dwordx4 a[32:35], v242, s[24:27], s30 offen offset:0
  v_mfma_f32_16x16x32_bf16 v[4:7], a[164:167], a[84:87], v[4:7]
  ds_read_b64_tr_b16 a[178:179], v226 offset:1024
  v_mfma_f32_16x16x32_bf16 v[4:7], a[160:163], a[68:71], v[4:7]
  buffer_load_dwordx4 a[36:39], v242, s[24:27], s30 offen offset:1024
  v_mfma_f32_16x16x32_bf16 v[8:11], a[160:163], a[72:75], v[8:11]
  ds_read_b64_tr_b16 a[180:181], v226 offset:8192
  v_mfma_f32_16x16x32_bf16 v[8:11], a[164:167], a[88:91], v[8:11]
  buffer_load_dwordx4 a[40:43], v242, s[24:27], s30 offen offset:2048
  v_mfma_f32_16x16x32_bf16 v[12:15], a[164:167], a[92:95], v[12:15]
  ds_read_b64_tr_b16 a[182:183], v226 offset:9216
  v_mfma_f32_16x16x32_bf16 v[12:15], a[160:163], a[76:79], v[12:15]
  s_waitcnt lgkmcnt(4)
  v_mfma_f32_16x16x32_bf16 v[16:19], a[168:171], a[64:67], v[16:19]
  ds_read_b64_tr_b16 a[184:185], v227 offset:0
  v_mfma_f32_16x16x32_bf16 v[16:19], a[172:175], a[80:83], v[16:19]
  buffer_load_dwordx4 a[44:47], v242, s[24:27], s30 offen offset:3072
  v_mfma_f32_16x16x32_bf16 v[20:23], a[172:175], a[84:87], v[20:23]
  ds_read_b64_tr_b16 a[186:187], v227 offset:1024
  v_mfma_f32_16x16x32_bf16 v[20:23], a[168:171], a[68:71], v[20:23]
  buffer_load_dwordx4 a[48:51], v243, s[24:27], s30 offen offset:0
  v_mfma_f32_16x16x32_bf16 v[24:27], a[168:171], a[72:75], v[24:27]
  ds_read_b64_tr_b16 a[188:189], v227 offset:8192
  v_mfma_f32_16x16x32_bf16 v[24:27], a[172:175], a[88:91], v[24:27]
  buffer_load_dwordx4 a[52:55], v243, s[24:27], s30 offen offset:1024
  v_mfma_f32_16x16x32_bf16 v[28:31], a[172:175], a[92:95], v[28:31]
  ds_read_b64_tr_b16 a[190:191], v227 offset:9216
  v_mfma_f32_16x16x32_bf16 v[28:31], a[168:171], a[76:79], v[28:31]
  s_waitcnt lgkmcnt(4)
  v_mfma_f32_16x16x32_bf16 v[32:35], a[176:179], a[64:67], v[32:35]
  ds_read_b64_tr_b16 a[160:161], v228 offset:0
  v_mfma_f32_16x16x32_bf16 v[32:35], a[180:183], a[80:83], v[32:35]
  buffer_load_dwordx4 a[56:59], v243, s[24:27], s30 offen offset:2048
  v_mfma_f32_16x16x32_bf16 v[36:39], a[180:183], a[84:87], v[36:39]
  ds_read_b64_tr_b16 a[162:163], v228 offset:1024
  v_mfma_f32_16x16x32_bf16 v[36:39], a[176:179], a[68:71], v[36:39]
  buffer_load_dwordx4 a[60:63], v243, s[24:27], s30 offen offset:3072
  v_mfma_f32_16x16x32_bf16 v[40:43], a[176:179], a[72:75], v[40:43]
  ds_read_b64_tr_b16 a[164:165], v228 offset:8192
  v_mfma_f32_16x16x32_bf16 v[40:43], a[180:183], a[88:91], v[40:43]
  s_add_u32 s30, s30, 8192
  v_mfma_f32_16x16x32_bf16 v[44:47], a[180:183], a[92:95], v[44:47]
  ds_read_b64_tr_b16 a[166:167], v228 offset:9216
  v_mfma_f32_16x16x32_bf16 v[44:47], a[176:179], a[76:79], v[44:47]
  s_waitcnt lgkmcnt(4)
  v_mfma_f32_16x16x32_bf16 v[48:51], a[184:187], a[64:67], v[48:51]
  ds_read_b64_tr_b16 a[168:169], v229 offset:0
  v_mfma_f32_16x16x32_bf16 v[48:51], a[188:191], a[80:83], v[48:51]
  s_add_u32 m0, s28, 16384
  v_mfma_f32_16x16x32_bf16 v[52:55], a[188:191], a[84:87], v[52:55]
  ds_read_b64_tr_b16 a[170:171], v229 offset:1024
  v_mfma_f32_16x16x32_bf16 v[52:55], a[184:187], a[68:71], v[52:55]
  buffer_load_dwordx4 v232, s[12:15], s29 offen offset:0 lds
  v_mfma_f32_16x16x32_bf16 v[56:59], a[184:187], a[72:75], v[56:59]
  ds_read_b64_tr_b16 a[172:173], v229 offset:8192
  v_mfma_f32_16x16x32_bf16 v[56:59], a[188:191], a[88:91], v[56:59]
  buffer_load_dwordx4 v233, s[12:15], s29 offen offset:1024 lds
  v_mfma_f32_16x16x32_bf16 v[60:63], a[188:191], a[92:95], v[60:63]
  ds_read_b64_tr_b16 a[174:175], v229 offset:9216
  v_mfma_f32_16x16x32_bf16 v[60:63], a[184:187], a[76:79], v[60:63]
  s_waitcnt lgkmcnt(4)
  v_mfma_f32_16x16x32_bf16 v[64:67], a[160:163], a[64:67], v[64:67]
  ds_read_b64_tr_b16 a[176:177], v230 offset:0
  v_min_u32 v136, v137, v138
  v_mfma_f32_16x16x32_bf16 v[64:67], a[164:167], a[80:83], v[64:67]
  buffer_load_dwordx4 v234, s[12:15], s29 offen offset:2048 lds
  v_mfma_f32_16x16x32_bf16 v[68:71], a[164:167], a[84:87], v[68:71]
  ds_read_b64_tr_b16 a[178:179], v230 offset:1024
  v_sub_u32 v139, s51, v130
  v_mfma_f32_16x16x32_bf16 v[68:71], a[160:163], a[68:71], v[68:71]
  buffer_load_dwordx4 v235, s[12:15], s29 offen offset:3072 lds
  v_mfma_f32_16x16x32_bf16 v[72:75], a[160:163], a[72:75], v[72:75]
  ds_read_b64_tr_b16 a[180:181], v230 offset:8192
  v_sub_u32 v140, s51, v131
  v_mfma_f32_16x16x32_bf16 v[72:75], a[164:167], a[88:91], v[72:75]
  s_add_u32 s29, s29, 16384
  v_min3_u32 v136, v136, v139, v140
  v_sub_u32 v137, s51, v132
  v_mfma_f32_16x16x32_bf16 v[76:79], a[164:167], a[92:95], v[76:79]
  ds_read_b64_tr_b16 a[182:183], v230 offset:9216
  v_sub_u32 v138, s51, v133
  v_mfma_f32_16x16x32_bf16 v[76:79], a[160:163], a[76:79], v[76:79]
  s_waitcnt lgkmcnt(4)
  v_min3_u32 v136, v136, v137, v138
  v_sub_u32 v139, s51, v134
  v_mfma_f32_16x16x32_bf16 v[80:83], a[168:171], a[64:67], v[80:83]
  ds_read_b64_tr_b16 a[184:185], v231 offset:0
  v_sub_u32 v140, s51, v135
  v_mfma_f32_16x16x32_bf16 v[80:83], a[172:175], a[80:83], v[80:83]
  v_min3_u32 v136, v136, v139, v140
  v_mfma_f32_16x16x32_bf16 v[84:87], a[172:175], a[84:87], v[84:87]
  ds_read_b64_tr_b16 a[186:187], v231 offset:1024
  v_min_u32_dpp v136, v136, v136 row_ror:8 row_mask:0xf bank_mask:0xf
  v_mfma_f32_16x16x32_bf16 v[84:87], a[168:171], a[68:71], v[84:87]
  s_waitcnt vmcnt(28)
  v_min_u32_dpp v136, v136, v136 row_ror:4 row_mask:0xf bank_mask:0xf
  v_mfma_f32_16x16x32_bf16 v[88:91], a[168:171], a[72:75], v[88:91]
  ds_read_b64_tr_b16 a[188:189], v231 offset:8192
  v_min_u32_dpp v136, v136, v136 row_ror:2 row_mask:0xf bank_mask:0xf
  s_nop 1
  v_min_u32_dpp v136, v136, v136 row_ror:1 row_mask:0xf bank_mask:0xf
  s_nop 0
  v_readlane_b32 s98, v136, 0
  v_readlane_b32 s99, v136, 16
  v_readlane_b32 s100, v136, 32
  v_readlane_b32 s101, v136, 48
  s_min_u32 s98, s98, s99
  s_min_u32 s100, s100, s101
  s_min_u32 s98, s98, s100
  s_sub_u32 s57, s51, s98
  s_sub_u32 s51, s57, 1
  v_sub_u32 v137, s51, v128
  v_sub_u32 v138, s51, v129
  v_min_u32 v136, v137, v138
  v_sub_u32 v139, s51, v130
  v_sub_u32 v140, s51, v131
  v_min3_u32 v136, v136, v139, v140
  v_sub_u32 v137, s51, v132
  v_sub_u32 v138, s51, v133
  v_min3_u32 v136, v136, v137, v138
  v_sub_u32 v139, s51, v134
  v_sub_u32 v140, s51, v135
  v_min3_u32 v136, v136, v139, v140
  s_nop 1
  v_min_u32_dpp v136, v136, v136 row_ror:8 row_mask:0xf bank_mask:0xf
  s_nop 1
  v_min_u32_dpp v136, v136, v136 row_ror:4 row_mask:0xf bank_mask:0xf
  s_nop 1
  v_min_u32_dpp v136, v136, v136 row_ror:2 row_mask:0xf bank_mask:0xf
  s_nop 1
  v_min_u32_dpp v136, v136, v136 row_ror:1 row_mask:0xf bank_mask:0xf
  s_nop 0
  v_readlane_b32 s98, v136, 0
  v_readlane_b32 s99, v136, 16
  v_readlane_b32 s100, v136, 32
  v_readlane_b32 s101, v136, 48
  s_min_u32 s98, s98, s99
  s_min_u32 s100, s100, s101
  s_min_u32 s98, s98, s100
  s_sub_u32 s58, s51, s98
  s_sub_u32 s51, s58, 1
  v_sub_u32 v137, s51, v128
  v_sub_u32 v138, s51, v129
  v_min_u32 v136, v137, v138
  v_sub_u32 v139, s51, v130
  v_sub_u32 v140, s51, v131
  v_min3_u32 v136, v136, v139, v140
  v_sub_u32 v137, s51, v132
  v_sub_u32 v138, s51, v133
  v_min3_u32 v136, v136, v137, v138
  v_sub_u32 v139, s51, v134
  v_sub_u32 v140, s51, v135
  v_min3_u32 v136, v136, v139, v140
  s_nop 1
  v_min_u32_dpp v136, v136, v136 row_ror:8 row_mask:0xf bank_mask:0xf
  s_nop 1
  v_min_u32_dpp v136, v136, v136 row_ror:4 row_mask:0xf bank_mask:0xf
  s_nop 1
  v_min_u32_dpp v136, v136, v136 row_ror:2 row_mask:0xf bank_mask:0xf
  s_nop 1
  v_min_u32_dpp v136, v136, v136 row_ror:1 row_mask:0xf bank_mask:0xf
  s_nop 0
  v_readlane_b32 s98, v136, 0
  v_readlane_b32 s99, v136, 16
  v_readlane_b32 s100, v136, 32
  v_readlane_b32 s101, v136, 48
  s_min_u32 s98, s98, s99
  s_min_u32 s100, s100, s101
  s_min_u32 s98, s98, s100
  s_sub_u32 s59, s51, s98
  s_sub_u32 s51, s59, 1
  v_writelane_b32 v136, s52, 0
  v_writelane_b32 v136, s53, 1
  v_writelane_b32 v136, s54, 2
  v_writelane_b32 v136, s55, 3
  v_writelane_b32 v136, s56, 4
  v_writelane_b32 v136, s57, 5
  v_writelane_b32 v136, s58, 6
  v_writelane_b32 v136, s59, 7
  s_lshl_b32 s35, s3, 8
  s_add_u32 s35, s35, 158720
  v_lshrrev_b32 v137, 2, v242
  v_add_u32 v137, s35, v137
  ds_write_b32 v137, v136
  s_waitcnt lgkmcnt(0)
  v_mfma_f32_16x16x32_bf16 v[88:91], a[172:175], a[88:91], v[88:91]
  s_barrier
  v_mfma_f32_16x16x32_bf16 v[92:95], a[172:175], a[92:95], v[92:95]
  ds_read_b64_tr_b16 a[190:191], v231 offset:9216
  v_mfma_f32_16x16x32_bf16 v[92:95], a[168:171], a[76:79], v[92:95]
  s_add_u32 m0, s28, 114688
  v_mfma_f32_16x16x32_bf16 v[96:99], a[176:179], a[64:67], v[96:99]
  ds_read_b64_tr_b16 a[160:161], v224 offset:16384
  v_mfma_f32_16x16x32_bf16 v[96:99], a[180:183], a[80:83], v[96:99]
  buffer_load_dwordx4 v238, s[20:23], s31 offen offset:0 lds
  v_mfma_f32_16x16x32_bf16 v[100:103], a[180:183], a[84:87], v[100:103]
  ds_read_b64_tr_b16 a[162:163], v224 offset:17408
  v_mfma_f32_16x16x32_bf16 v[100:103], a[176:179], a[68:71], v[100:103]
  buffer_load_dwordx4 v239, s[20:23], s31 offen offset:1024 lds
  v_mfma_f32_16x16x32_bf16 v[104:107], a[176:179], a[72:75], v[104:107]
  ds_read_b64_tr_b16 a[164:165], v224 offset:24576
  v_mfma_f32_16x16x32_bf16 v[104:107], a[180:183], a[88:91], v[104:107]
  buffer_load_dwordx4 v240, s[20:23], s31 offen offset:2048 lds
  v_mfma_f32_16x16x32_bf16 v[108:111], a[180:183], a[92:95], v[108:111]
  ds_read_b64_tr_b16 a[166:167], v224 offset:25600
  v_mfma_f32_16x16x32_bf16 v[108:111], a[176:179], a[76:79], v[108:111]
  s_waitcnt lgkmcnt(4)
  v_mfma_f32_16x16x32_bf16 v[112:115], a[184:187], a[64:67], v[112:115]
  ds_read_b64_tr_b16 a[168:169], v225 offset:16384
  v_mfma_f32_16x16x32_bf16 v[112:115], a[188:191], a[80:83], v[112:115]
  buffer_load_dwordx4 v241, s[20:23], s31 offen offset:3072 lds
  v_mfma_f32_16x16x32_bf16 v[116:119], a[188:191], a[84:87], v[116:119]
  ds_read_b64_tr_b16 a[170:171], v225 offset:17408
  v_mfma_f32_16x16x32_bf16 v[116:119], a[184:187], a[68:71], v[116:119]
  s_add_u32 s31, s31, 0x80000
  v_mfma_f32_16x16x32_bf16 v[120:123], a[184:187], a[72:75], v[120:123]
  ds_read_b64_tr_b16 a[172:173], v225 offset:24576
  v_mfma_f32_16x16x32_bf16 v[120:123], a[188:191], a[88:91], v[120:123]
  v_mfma_f32_16x16x32_bf16 v[124:127], a[188:191], a[92:95], v[124:127]
  ds_read_b64_tr_b16 a[174:175], v225 offset:25600
  v_mfma_f32_16x16x32_bf16 v[124:127], a[184:187], a[76:79], v[124:127]
  s_waitcnt lgkmcnt(4)
  v_mfma_f32_16x16x32_bf16 v[0:3], a[160:163], a[96:99], v[0:3]
  ds_read_b64_tr_b16 a[176:177], v226 offset:16384
  v_lshrrev_b32 v136, 4, v242
  v_mfma_f32_16x16x32_bf16 v[0:3], a[164:167], a[112:115], v[0:3]
  v_bfe_u32 v137, v136, 3, 2
  v_and_b32 v138, 7, v136
  v_mfma_f32_16x16x32_bf16 v[4:7], a[164:167], a[116:119], v[4:7]
  ds_read_b64_tr_b16 a[178:179], v226 offset:17408
  v_lshlrev_b32 v137, 8, v137
  v_mfma_f32_16x16x32_bf16 v[4:7], a[160:163], a[100:103], v[4:7]
  v_lshl_add_u32 v137, v138, 2, v137
  v_add_u32 v137, 158720, v137
  v_mfma_f32_16x16x32_bf16 v[8:11], a[160:163], a[104:107], v[8:11]
  ds_read_b64_tr_b16 a[180:181], v226 offset:24576
  ds_read_b32 v128, v137
  v_mfma_f32_16x16x32_bf16 v[8:11], a[164:167], a[120:123], v[8:11]
  v_mfma_f32_16x16x32_bf16 v[12:15], a[164:167], a[124:127], v[12:15]
  ds_read_b64_tr_b16 a[182:183], v226 offset:25600
  v_mfma_f32_16x16x32_bf16 v[12:15], a[160:163], a[108:111], v[12:15]
  s_waitcnt lgkmcnt(5)
  v_mfma_f32_16x16x32_bf16 v[16:19], a[168:171], a[96:99], v[16:19]
  ds_read_b64_tr_b16 a[184:185], v227 offset:16384
  v_mfma_f32_16x16x32_bf16 v[16:19], a[172:175], a[112:115], v[16:19]
  v_mfma_f32_16x16x32_bf16 v[20:23], a[172:175], a[116:119], v[20:23]
  ds_read_b64_tr_b16 a[186:187], v227 offset:17408
  v_mfma_f32_16x16x32_bf16 v[20:23], a[168:171], a[100:103], v[20:23]
  v_mfma_f32_16x16x32_bf16 v[24:27], a[168:171], a[104:107], v[24:27]
  ds_read_b64_tr_b16 a[188:189], v227 offset:24576
  s_waitcnt lgkmcnt(4)
  s_mov_b32 s51, -1
  v_sub_u32 v137, s51, v128
  v_mfma_f32_16x16x32_bf16 v[24:27], a[172:175], a[120:123], v[24:27]
  v_mfma_f32_16x16x32_bf16 v[28:31], a[172:175], a[124:127], v[28:31]
  ds_read_b64_tr_b16 a[190:191], v227 offset:25600
  v_min_u32_dpp v137, v137, v137 row_ror:8 row_mask:0xf bank_mask:0xf
  v_mfma_f32_16x16x32_bf16 v[28:31], a[168:171], a[108:111], v[28:31]
  s_waitcnt lgkmcnt(4)
  v_min_u32_dpp v137, v137, v137 row_ror:4 row_mask:0xf bank_mask:0xf
  v_mfma_f32_16x16x32_bf16 v[32:35], a[176:179], a[96:99], v[32:35]
  ds_read_b64_tr_b16 a[160:161], v228 offset:16384
  v_min_u32_dpp v137, v137, v137 row_ror:2 row_mask:0xf bank_mask:0xf
  v_mfma_f32_16x16x32_bf16 v[32:35], a[180:183], a[112:115], v[32:35]
  v_mfma_f32_16x16x32_bf16 v[36:39], a[180:183], a[116:119], v[36:39]
  ds_read_b64_tr_b16 a[162:163], v228 offset:17408
  v_min_u32_dpp v137, v137, v137 row_ror:1 row_mask:0xf bank_mask:0xf
  v_mfma_f32_16x16x32_bf16 v[36:39], a[176:179], a[100:103], v[36:39]
  v_readlane_b32 s98, v137, 0
  v_readlane_b32 s99, v137, 16
  v_mfma_f32_16x16x32_bf16 v[40:43], a[176:179], a[104:107], v[40:43]
  ds_read_b64_tr_b16 a[164:165], v228 offset:24576
  s_min_u32 s98, s98, s99
  s_sub_u32 s52, s51, s98
  s_sub_u32 s51, s52, 1
  v_sub_u32 v137, s51, v128
  v_mfma_f32_16x16x32_bf16 v[40:43], a[180:183], a[120:123], v[40:43]
  v_mfma_f32_16x16x32_bf16 v[44:47], a[180:183], a[124:127], v[44:47]
  ds_read_b64_tr_b16 a[166:167], v228 offset:25600
  v_min_u32_dpp v137, v137, v137 row_ror:8 row_mask:0xf bank_mask:0xf
  v_mfma_f32_16x16x32_bf16 v[44:47], a[176:179], a[108:111], v[44:47]
  s_waitcnt lgkmcnt(4)
  v_min_u32_dpp v137, v137, v137 row_ror:4 row_mask:0xf bank_mask:0xf
  v_mfma_f32_16x16x32_bf16 v[48:51], a[184:187], a[96:99], v[48:51]
  ds_read_b64_tr_b16 a[168:169], v229 offset:16384
  v_min_u32_dpp v137, v137, v137 row_ror:2 row_mask:0xf bank_mask:0xf
  v_mfma_f32_16x16x32_bf16 v[48:51], a[188:191], a[112:115], v[48:51]
  s_add_u32 m0, s28, 32768
  v_min_u32_dpp v137, v137, v137 row_ror:1 row_mask:0xf bank_mask:0xf
  v_mfma_f32_16x16x32_bf16 v[52:55], a[188:191], a[116:119], v[52:55]
  ds_read_b64_tr_b16 a[170:171], v229 offset:17408
  v_readlane_b32 s98, v137, 0
  v_mfma_f32_16x16x32_bf16 v[52:55], a[184:187], a[100:103], v[52:55]
  buffer_load_dwordx4 v232, s[12:15], s29 offen offset:0 lds
  v_mfma_f32_16x16x32_bf16 v[56:59], a[184:187], a[104:107], v[56:59]
  ds_read_b64_tr_b16 a[172:173], v229 offset:24576
  v_readlane_b32 s99, v137, 16
  v_mfma_f32_16x16x32_bf16 v[56:59], a[188:191], a[120:123], v[56:59]
  buffer_load_dwordx4 v233, s[12:15], s29 offen offset:1024 lds
  s_min_u32 s98, s98, s99
  s_sub_u32 s53, s51, s98
  s_sub_u32 s51, s53, 1
  v_mfma_f32_16x16x32_bf16 v[60:63], a[188:191], a[124:127], v[60:63]
  ds_read_b64_tr_b16 a[174:175], v229 offset:25600
  v_sub_u32 v137, s51, v128
  v_mfma_f32_16x16x32_bf16 v[60:63], a[184:187], a[108:111], v[60:63]
  s_waitcnt lgkmcnt(4)
  v_min_u32_dpp v137, v137, v137 row_ror:8 row_mask:0xf bank_mask:0xf
  v_mfma_f32_16x16x32_bf16 v[64:67], a[160:163], a[96:99], v[64:67]
  ds_read_b64_tr_b16 a[176:177], v230 offset:16384
  v_min_u32_dpp v137, v137, v137 row_ror:4 row_mask:0xf bank_mask:0xf
  v_mfma_f32_16x16x32_bf16 v[64:67], a[164:167], a[112:115], v[64:67]
  buffer_load_dwordx4 v234, s[12:15], s29 offen offset:2048 lds
  v_mfma_f32_16x16x32_bf16 v[68:71], a[164:167], a[116:119], v[68:71]
  ds_read_b64_tr_b16 a[178:179], v230 offset:17408
  v_min_u32_dpp v137, v137, v137 row_ror:2 row_mask:0xf bank_mask:0xf
  v_mfma_f32_16x16x32_bf16 v[68:71], a[160:163], a[100:103], v[68:71]
  buffer_load_dwordx4 v235, s[12:15], s29 offen offset:3072 lds
  v_mfma_f32_16x16x32_bf16 v[72:75], a[160:163], a[104:107], v[72:75]
  ds_read_b64_tr_b16 a[180:181], v230 offset:24576
  v_min_u32_dpp v137, v137, v137 row_ror:1 row_mask:0xf bank_mask:0xf
  v_mfma_f32_16x16x32_bf16 v[72:75], a[164:167], a[120:123], v[72:75]
  s_add_u32 s29, s29, 16384
  v_readlane_b32 s98, v137, 0
  v_readlane_b32 s99, v137, 16
  v_mfma_f32_16x16x32_bf16 v[76:79], a[164:167], a[124:127], v[76:79]
  ds_read_b64_tr_b16 a[182:183], v230 offset:25600
  s_min_u32 s98, s98, s99
  s_sub_u32 s54, s51, s98
  s_sub_u32 s51, s54, 1
  v_sub_u32 v137, s51, v128
  v_mfma_f32_16x16x32_bf16 v[76:79], a[160:163], a[108:111], v[76:79]
  s_waitcnt lgkmcnt(4)
  v_min_u32_dpp v137, v137, v137 row_ror:8 row_mask:0xf bank_mask:0xf
  v_mfma_f32_16x16x32_bf16 v[80:83], a[168:171], a[96:99], v[80:83]
  ds_read_b64_tr_b16 a[184:185], v231 offset:16384
  v_min_u32_dpp v137, v137, v137 row_ror:4 row_mask:0xf bank_mask:0xf
  v_mfma_f32_16x16x32_bf16 v[80:83], a[172:175], a[112:115], v[80:83]
  s_mov_b32 s29, 0
  v_min_u32_dpp v137, v137, v137 row_ror:2 row_mask:0xf bank_mask:0xf
  v_mfma_f32_16x16x32_bf16 v[84:87], a[172:175], a[116:119], v[84:87]
  ds_read_b64_tr_b16 a[186:187], v231 offset:17408
  v_min_u32_dpp v137, v137, v137 row_ror:1 row_mask:0xf bank_mask:0xf
  v_mfma_f32_16x16x32_bf16 v[84:87], a[168:171], a[100:103], v[84:87]
  s_waitcnt vmcnt(20)
  v_readlane_b32 s98, v137, 0
  v_readlane_b32 s99, v137, 16
  v_mfma_f32_16x16x32_bf16 v[88:91], a[168:171], a[104:107], v[88:91]
  ds_read_b64_tr_b16 a[188:189], v231 offset:24576
  s_min_u32 s98, s98, s99
  s_sub_u32 s55, s51, s98
  s_sub_u32 s51, s55, 1
  v_sub_u32 v137, s51, v128
  v_mfma_f32_16x16x32_bf16 v[88:91], a[172:175], a[120:123], v[88:91]
  s_barrier
  v_min_u32_dpp v137, v137, v137 row_ror:8 row_mask:0xf bank_mask:0xf
  v_mfma_f32_16x16x32_bf16 v[92:95], a[172:175], a[124:127], v[92:95]
  ds_read_b64_tr_b16 a[190:191], v231 offset:25600
  v_min_u32_dpp v137, v137, v137 row_ror:4 row_mask:0xf bank_mask:0xf
  v_mfma_f32_16x16x32_bf16 v[92:95], a[168:171], a[108:111], v[92:95]
  s_waitcnt lgkmcnt(4)
  s_add_u32 m0, s28, 65536
  v_min_u32_dpp v137, v137, v137 row_ror:2 row_mask:0xf bank_mask:0xf
  v_mfma_f32_16x16x32_bf16 v[96:99], a[176:179], a[96:99], v[96:99]
  ds_read_b64_tr_b16 a[160:161], v224 offset:32768
  v_min_u32_dpp v137, v137, v137 row_ror:1 row_mask:0xf bank_mask:0xf
  v_mfma_f32_16x16x32_bf16 v[96:99], a[180:183], a[112:115], v[96:99]
  buffer_load_dwordx4 v236, s[16:19], s29 offen offset:0 lds
  v_mfma_f32_16x16x32_bf16 v[100:103], a[180:183], a[116:119], v[100:103]
  ds_read_b64_tr_b16 a[162:163], v224 offset:33792
  v_readlane_b32 s98, v137, 0
  v_mfma_f32_16x16x32_bf16 v[100:103], a[176:179], a[100:103], v[100:103]
  buffer_load_dwordx4 v237, s[16:19], s29 offen offset:1024 lds
  v_mfma_f32_16x16x32_bf16 v[104:107], a[176:179], a[104:107], v[104:107]
  ds_read_b64_tr_b16 a[164:165], v224 offset:40960
  v_readlane_b32 s99, v137, 16
  v_mfma_f32_16x16x32_bf16 v[104:107], a[180:183], a[120:123], v[104:107]
  buffer_load_dwordx4 v236, s[16:19], s29 offen offset:2048 lds
  s_min_u32 s98, s98, s99
  s_sub_u32 s56, s51, s98
  s_sub_u32 s51, s56, 1
  v_mfma_f32_16x16x32_bf16 v[108:111], a[180:183], a[124:127], v[108:111]
  ds_read_b64_tr_b16 a[166:167], v224 offset:41984
  v_sub_u32 v137, s51, v128
  v_mfma_f32_16x16x32_bf16 v[108:111], a[176:179], a[108:111], v[108:111]
  s_waitcnt lgkmcnt(4)
  v_min_u32_dpp v137, v137, v137 row_ror:8 row_mask:0xf bank_mask:0xf
  v_mfma_f32_16x16x32_bf16 v[112:115], a[184:187], a[96:99], v[112:115]
  ds_read_b64_tr_b16 a[168:169], v225 offset:32768
  v_min_u32_dpp v137, v137, v137 row_ror:4 row_mask:0xf bank_mask:0xf
  v_mfma_f32_16x16x32_bf16 v[112:115], a[188:191], a[112:115], v[112:115]
  buffer_load_dwordx4 v237, s[16:19], s29 offen offset:3072 lds
  v_mfma_f32_16x16x32_bf16 v[116:119], a[188:191], a[116:119], v[116:119]
  ds_read_b64_tr_b16 a[170:171], v225 offset:33792
  v_min_u32_dpp v137, v137, v137 row_ror:2 row_mask:0xf bank_mask:0xf
  v_mfma_f32_16x16x32_bf16 v[116:119], a[184:187], a[100:103], v[116:119]
  s_add_u32 s29, s29, 16384
  v_min_u32_dpp v137, v137, v137 row_ror:1 row_mask:0xf bank_mask:0xf
  v_mfma_f32_16x16x32_bf16 v[120:123], a[184:187], a[104:107], v[120:123]
  ds_read_b64_tr_b16 a[172:173], v225 offset:40960
  v_readlane_b32 s98, v137, 0
  v_mfma_f32_16x16x32_bf16 v[120:123], a[188:191], a[120:123], v[120:123]
  v_readlane_b32 s99, v137, 16
  v_mfma_f32_16x16x32_bf16 v[124:127], a[188:191], a[124:127], v[124:127]
  ds_read_b64_tr_b16 a[174:175], v225 offset:41984
  s_min_u32 s98, s98, s99
  s_sub_u32 s57, s51, s98
  s_sub_u32 s51, s57, 1
  v_sub_u32 v137, s51, v128
  v_mfma_f32_16x16x32_bf16 v[124:127], a[184:187], a[108:111], v[124:127]
  s_waitcnt lgkmcnt(4)
  v_min_u32_dpp v137, v137, v137 row_ror:8 row_mask:0xf bank_mask:0xf
  v_mfma_f32_16x16x32_bf16 v[0:3], a[160:163], a[0:3], v[0:3]
  ds_read_b64_tr_b16 a[176:177], v226 offset:32768
  v_min_u32_dpp v137, v137, v137 row_ror:4 row_mask:0xf bank_mask:0xf
  v_mfma_f32_16x16x32_bf16 v[0:3], a[164:167], a[16:19], v[0:3]
  v_mfma_f32_16x16x32_bf16 v[4:7], a[164:167], a[20:23], v[4:7]
  ds_read_b64_tr_b16 a[178:179], v226 offset:33792
  v_min_u32_dpp v137, v137, v137 row_ror:2 row_mask:0xf bank_mask:0xf
  v_mfma_f32_16x16x32_bf16 v[4:7], a[160:163], a[4:7], v[4:7]
  v_mfma_f32_16x16x32_bf16 v[8:11], a[160:163], a[8:11], v[8:11]
  ds_read_b64_tr_b16 a[180:181], v226 offset:40960
  v_min_u32_dpp v137, v137, v137 row_ror:1 row_mask:0xf bank_mask:0xf
  v_mfma_f32_16x16x32_bf16 v[8:11], a[164:167], a[24:27], v[8:11]
  v_readlane_b32 s98, v137, 0
  v_readlane_b32 s99, v137, 16
  v_mfma_f32_16x16x32_bf16 v[12:15], a[164:167], a[28:31], v[12:15]
  ds_read_b64_tr_b16 a[182:183], v226 offset:41984
  s_min_u32 s98, s98, s99
  s_sub_u32 s58, s51, s98
  s_sub_u32 s51, s58, 1
  v_sub_u32 v137, s51, v128
  v_mfma_f32_16x16x32_bf16 v[12:15], a[160:163], a[12:15], v[12:15]
  s_waitcnt lgkmcnt(4)
  v_min_u32_dpp v137, v137, v137 row_ror:8 row_mask:0xf bank_mask:0xf
  v_mfma_f32_16x16x32_bf16 v[16:19], a[168:171], a[0:3], v[16:19]
  ds_read_b64_tr_b16 a[184:185], v227 offset:32768
  v_min_u32_dpp v137, v137, v137 row_ror:4 row_mask:0xf bank_mask:0xf
  v_mfma_f32_16x16x32_bf16 v[16:19], a[172:175], a[16:19], v[16:19]
  v_mfma_f32_16x16x32_bf16 v[20:23], a[172:175], a[20:23], v[20:23]
  ds_read_b64_tr_b16 a[186:187], v227 offset:33792
  v_min_u32_dpp v137, v137, v137 row_ror:2 row_mask:0xf bank_mask:0xf
  v_mfma_f32_16x16x32_bf16 v[20:23], a[168:171], a[4:7], v[20:23]
  v_mfma_f32_16x16x32_bf16 v[24:27], a[168:171], a[8:11], v[24:27]
  ds_read_b64_tr_b16 a[188:189], v227 offset:40960
  v_min_u32_dpp v137, v137, v137 row_ror:1 row_mask:0xf bank_mask:0xf
  v_mfma_f32_16x16x32_bf16 v[24:27], a[172:175], a[24:27], v[24:27]
  v_readlane_b32 s98, v137, 0
  v_readlane_b32 s99, v137, 16
  v_mfma_f32_16x16x32_bf16 v[28:31], a[172:175], a[28:31], v[28:31]
  ds_read_b64_tr_b16 a[190:191], v227 offset:41984
  s_min_u32 s98, s98, s99
  s_sub_u32 s59, s51, s98
  s_sub_u32 s51, s59, 1
  v_mov_b32 v128, 0
  v_mfma_f32_16x16x32_bf16 v[28:31], a[168:171], a[12:15], v[28:31]
  s_waitcnt lgkmcnt(4)
  v_writelane_b32 v128, s52, 0
  v_writelane_b32 v128, s53, 1
  v_mfma_f32_16x16x32_bf16 v[32:35], a[176:179], a[0:3], v[32:35]
  ds_read_b64_tr_b16 a[160:161], v228 offset:32768
  v_writelane_b32 v128, s54, 2
  v_mfma_f32_16x16x32_bf16 v[32:35], a[180:183], a[16:19], v[32:35]
  v_writelane_b32 v128, s55, 3
  v_writelane_b32 v128, s56, 4
  v_mfma_f32_16x16x32_bf16 v[36:39], a[180:183], a[20:23], v[36:39]
  ds_read_b64_tr_b16 a[162:163], v228 offset:33792
  v_writelane_b32 v128, s57, 5
  v_mfma_f32_16x16x32_bf16 v[36:39], a[176:179], a[4:7], v[36:39]
  v_writelane_b32 v128, s58, 6
  v_writelane_b32 v128, s59, 7
  v_mfma_f32_16x16x32_bf16 v[40:43], a[176:179], a[8:11], v[40:43]
  ds_read_b64_tr_b16 a[164:165], v228 offset:40960
  s_cmp_eq_u32 s2, 0
  s_cselect_b32 s35, 0, 1073741824
  v_lshrrev_b32 v137, 3, v136
  v_mfma_f32_16x16x32_bf16 v[40:43], a[180:183], a[24:27], v[40:43]
  v_lshlrev_b32 v137, 28, v137
  v_lshl_add_u32 v137, v136, 2, v137
  v_mfma_f32_16x16x32_bf16 v[44:47], a[180:183], a[28:31], v[44:47]
  ds_read_b64_tr_b16 a[166:167], v228 offset:41984
  v_or_b32 v137, s35, v137
  v_mfma_f32_16x16x32_bf16 v[44:47], a[176:179], a[12:15], v[44:47]
  s_waitcnt lgkmcnt(4)
  s_mov_b32 s35, 2629632
  buffer_store_dword v128, v137, s[24:27], s35 offen
  v_mfma_f32_16x16x32_bf16 v[48:51], a[184:187], a[0:3], v[48:51]
  ds_read_b64_tr_b16 a[168:169], v229 offset:32768
  v_and_b32 v129, 0xffff, v128
  v_mfma_f32_16x16x32_bf16 v[48:51], a[188:191], a[16:19], v[48:51]
  v_sub_u32 v129, 0xffff, v129
  v_and_b32 v129, 0x7ff, v129
  v_mfma_f32_16x16x32_bf16 v[52:55], a[188:191], a[20:23], v[52:55]
  ds_read_b64_tr_b16 a[170:171], v229 offset:33792
  v_mov_b32 v130, v129
  v_mfma_f32_16x16x32_bf16 v[52:55], a[184:187], a[4:7], v[52:55]
  v_mfma_f32_16x16x32_bf16 v[56:59], a[184:187], a[8:11], v[56:59]
  ds_read_b64_tr_b16 a[172:173], v229 offset:40960
  v_permlane16_swap_b32 v129, v130
  v_mfma_f32_16x16x32_bf16 v[56:59], a[188:191], a[24:27], v[56:59]
  v_mov_b32 v130, v129
  v_mfma_f32_16x16x32_bf16 v[60:63], a[188:191], a[28:31], v[60:63]
  ds_read_b64_tr_b16 a[174:175], v229 offset:41984
  v_permlane32_swap_b32 v129, v130
  v_mfma_f32_16x16x32_bf16 v[60:63], a[184:187], a[12:15], v[60:63]
  s_waitcnt lgkmcnt(4)
  v_lshrrev_b32 v130, 6, v129
  v_mul_u32_u24 v130, 0x14000, v130
  v_mfma_f32_16x16x32_bf16 v[64:67], a[160:163], a[0:3], v[64:67]
  ds_read_b64_tr_b16 a[176:177], v230 offset:32768
  v_bfe_u32 v131, v129, 4, 2
  v_mfma_f32_16x16x32_bf16 v[64:67], a[164:167], a[16:19], v[64:67]
  v_lshl_add_u32 v130, v131, 10, v130
  v_and_b32 v131, 15, v129
  v_mfma_f32_16x16x32_bf16 v[68:71], a[164:167], a[20:23], v[68:71]
  ds_read_b64_tr_b16 a[178:179], v230 offset:33792
  v_lshl_add_u32 v130, v131, 4, v130
  v_mfma_f32_16x16x32_bf16 v[68:71], a[160:163], a[4:7], v[68:71]
  v_lshrrev_b32 v131, 4, v136
  v_lshl_add_u32 v130, v131, 8, v130
  v_mfma_f32_16x16x32_bf16 v[72:75], a[160:163], a[8:11], v[72:75]
  ds_read_b64_tr_b16 a[180:181], v230 offset:40960
  s_mul_i32 s35, s3, 20480
  buffer_load_dwordx4 a[212:215], v130, s[24:27], s35 offen
  s_add_u32 s35, s35, 4096
  v_mfma_f32_16x16x32_bf16 v[72:75], a[164:167], a[24:27], v[72:75]
  buffer_load_dwordx4 a[216:219], v130, s[24:27], s35 offen
  s_add_u32 s35, s35, 4096
  v_mfma_f32_16x16x32_bf16 v[76:79], a[164:167], a[28:31], v[76:79]
  ds_read_b64_tr_b16 a[182:183], v230 offset:41984
  buffer_load_dwordx4 a[220:223], v130, s[24:27], s35 offen
  s_add_u32 s35, s35, 4096
  v_mfma_f32_16x16x32_bf16 v[76:79], a[160:163], a[12:15], v[76:79]
  s_waitcnt lgkmcnt(4)
  buffer_load_dwordx4 a[224:227], v130, s[24:27], s35 offen
  s_add_u32 s35, s35, 4096
  v_mfma_f32_16x16x32_bf16 v[80:83], a[168:171], a[0:3], v[80:83]
  ds_read_b64_tr_b16 a[184:185], v231 offset:32768
  buffer_load_dwordx4 a[228:231], v130, s[24:27], s35 offen
  s_add_u32 s35, s35, 4096
  v_mfma_f32_16x16x32_bf16 v[80:83], a[172:175], a[16:19], v[80:83]
  v_mfma_f32_16x16x32_bf16 v[84:87], a[172:175], a[20:23], v[84:87]
  ds_read_b64_tr_b16 a[186:187], v231 offset:33792
  v_mfma_f32_16x16x32_bf16 v[84:87], a[168:171], a[4:7], v[84:87]
  s_waitcnt vmcnt(14)
  v_mfma_f32_16x16x32_bf16 v[88:91], a[168:171], a[8:11], v[88:91]
  ds_read_b64_tr_b16 a[188:189], v231 offset:40960
  v_mfma_f32_16x16x32_bf16 v[88:91], a[172:175], a[24:27], v[88:91]
  s_barrier
  v_mfma_f32_16x16x32_bf16 v[92:95], a[172:175], a[28:31], v[92:95]
  ds_read_b64_tr_b16 a[190:191], v231 offset:41984
  v_mfma_f32_16x16x32_bf16 v[92:95], a[168:171], a[12:15], v[92:95]
  s_waitcnt lgkmcnt(4)
  s_add_u32 m0, s28, 81920
  v_mfma_f32_16x16x32_bf16 v[96:99], a[176:179], a[0:3], v[96:99]
  ds_read_b64_tr_b16 a[160:161], v224 offset:49152
  v_mfma_f32_16x16x32_bf16 v[96:99], a[180:183], a[16:19], v[96:99]
  buffer_load_dwordx4 v236, s[16:19], s29 offen offset:0 lds
  v_mfma_f32_16x16x32_bf16 v[100:103], a[180:183], a[20:23], v[100:103]
  ds_read_b64_tr_b16 a[162:163], v224 offset:50176
  v_mfma_f32_16x16x32_bf16 v[100:103], a[176:179], a[4:7], v[100:103]
  buffer_load_dwordx4 v237, s[16:19], s29 offen offset:1024 lds
  v_mfma_f32_16x16x32_bf16 v[104:107], a[176:179], a[8:11], v[104:107]
  ds_read_b64_tr_b16 a[164:165], v224 offset:57344
  v_mfma_f32_16x16x32_bf16 v[104:107], a[180:183], a[24:27], v[104:107]
  buffer_load_dwordx4 v236, s[16:19], s29 offen offset:2048 lds
  v_mfma_f32_16x16x32_bf16 v[108:111], a[180:183], a[28:31], v[108:111]
  ds_read_b64_tr_b16 a[166:167], v224 offset:58368
  v_mfma_f32_16x16x32_bf16 v[108:111], a[176:179], a[12:15], v[108:111]
  s_waitcnt lgkmcnt(4)
  v_mfma_f32_16x16x32_bf16 v[112:115], a[184:187], a[0:3], v[112:115]
  ds_read_b64_tr_b16 a[168:169], v225 offset:49152
  v_mfma_f32_16x16x32_bf16 v[112:115], a[188:191], a[16:19], v[112:115]
  buffer_load_dwordx4 v237, s[16:19], s29 offen offset:3072 lds
  v_mfma_f32_16x16x32_bf16 v[116:119], a[188:191], a[20:23], v[116:119]
  ds_read_b64_tr_b16 a[170:171], v225 offset:50176
  v_mfma_f32_16x16x32_bf16 v[116:119], a[184:187], a[4:7], v[116:119]
  s_add_u32 s29, s29, 16384
  v_mfma_f32_16x16x32_bf16 v[120:123], a[184:187], a[8:11], v[120:123]
  ds_read_b64_tr_b16 a[172:173], v225 offset:57344
  v_mfma_f32_16x16x32_bf16 v[120:123], a[188:191], a[24:27], v[120:123]
  v_mfma_f32_16x16x32_bf16 v[124:127], a[188:191], a[28:31], v[124:127]
  ds_read_b64_tr_b16 a[174:175], v225 offset:58368
  v_mfma_f32_16x16x32_bf16 v[124:127], a[184:187], a[12:15], v[124:127]
  s_waitcnt lgkmcnt(4)
  v_mfma_f32_16x16x32_bf16 v[0:3], a[160:163], a[32:35], v[0:3]
  ds_read_b64_tr_b16 a[176:177], v226 offset:49152
  v_mfma_f32_16x16x32_bf16 v[0:3], a[164:167], a[48:51], v[0:3]
  v_mfma_f32_16x16x32_bf16 v[4:7], a[164:167], a[52:55], v[4:7]
  ds_read_b64_tr_b16 a[178:179], v226 offset:50176
  v_mfma_f32_16x16x32_bf16 v[4:7], a[160:163], a[36:39], v[4:7]
  v_mfma_f32_16x16x32_bf16 v[8:11], a[160:163], a[40:43], v[8:11]
  ds_read_b64_tr_b16 a[180:181], v226 offset:57344
  v_mfma_f32_16x16x32_bf16 v[8:11], a[164:167], a[56:59], v[8:11]
  v_mfma_f32_16x16x32_bf16 v[12:15], a[164:167], a[60:63], v[12:15]
  ds_read_b64_tr_b16 a[182:183], v226 offset:58368
  v_mfma_f32_16x16x32_bf16 v[12:15], a[160:163], a[44:47], v[12:15]
  s_waitcnt lgkmcnt(4)
  v_mfma_f32_16x16x32_bf16 v[16:19], a[168:171], a[32:35], v[16:19]
  ds_read_b64_tr_b16 a[184:185], v227 offset:49152
  v_mfma_f32_16x16x32_bf16 v[16:19], a[172:175], a[48:51], v[16:19]
  v_mfma_f32_16x16x32_bf16 v[20:23], a[172:175], a[52:55], v[20:23]
  ds_read_b64_tr_b16 a[186:187], v227 offset:50176
  v_mfma_f32_16x16x32_bf16 v[20:23], a[168:171], a[36:39], v[20:23]
  v_mfma_f32_16x16x32_bf16 v[24:27], a[168:171], a[40:43], v[24:27]
  ds_read_b64_tr_b16 a[188:189], v227 offset:57344
  v_mfma_f32_16x16x32_bf16 v[24:27], a[172:175], a[56:59], v[24:27]
  v_mul_f32 v0, s34, v0
  v_mul_f32 v1, s34, v1
  v_mfma_f32_16x16x32_bf16 v[28:31], a[172:175], a[60:63], v[28:31]
  ds_read_b64_tr_b16 a[190:191], v227 offset:58368
  v_mul_f32 v2, s34, v2
  v_mfma_f32_16x16x32_bf16 v[28:31], a[168:171], a[44:47], v[28:31]
  s_waitcnt lgkmcnt(4)
  v_mul_f32 v3, s34, v3
  v_mul_f32 v16, s34, v16
  v_mfma_f32_16x16x32_bf16 v[32:35], a[176:179], a[32:35], v[32:35]
  ds_read_b64_tr_b16 a[160:161], v228 offset:49152
  v_mul_f32 v17, s34, v17
  v_mfma_f32_16x16x32_bf16 v[32:35], a[180:183], a[48:51], v[32:35]
  v_mul_f32 v18, s34, v18
  v_mul_f32 v19, s34, v19
  v_mfma_f32_16x16x32_bf16 v[36:39], a[180:183], a[52:55], v[36:39]
  ds_read_b64_tr_b16 a[162:163], v228 offset:50176
  v_cvt_pk_bf16_f32 v128, v0, v1
  v_mfma_f32_16x16x32_bf16 v[36:39], a[176:179], a[36:39], v[36:39]
  v_cvt_pk_bf16_f32 v129, v2, v3
  v_cvt_pk_bf16_f32 v130, v16, v17
  v_mfma_f32_16x16x32_bf16 v[40:43], a[176:179], a[40:43], v[40:43]
  ds_read_b64_tr_b16 a[164:165], v228 offset:57344
  v_cvt_pk_bf16_f32 v131, v18, v19
  v_mfma_f32_16x16x32_bf16 v[40:43], a[180:183], a[56:59], v[40:43]
  v_mul_f32 v4, s34, v4
  v_mul_f32 v5, s34, v5
  v_mfma_f32_16x16x32_bf16 v[44:47], a[180:183], a[60:63], v[44:47]
  ds_read_b64_tr_b16 a[166:167], v228 offset:58368
  v_mul_f32 v6, s34, v6
  v_mfma_f32_16x16x32_bf16 v[44:47], a[176:179], a[44:47], v[44:47]
  s_waitcnt lgkmcnt(4)
  v_mul_f32 v7, s34, v7
  v_mul_f32 v20, s34, v20
  v_mfma_f32_16x16x32_bf16 v[48:51], a[184:187], a[32:35], v[48:51]
  ds_read_b64_tr_b16 a[168:169], v229 offset:49152
  v_mul_f32 v21, s34, v21
  v_mfma_f32_16x16x32_bf16 v[48:51], a[188:191], a[48:51], v[48:51]
  v_mul_f32 v22, s34, v22
  v_mul_f32 v23, s34, v23
  v_mfma_f32_16x16x32_bf16 v[52:55], a[188:191], a[52:55], v[52:55]
  ds_read_b64_tr_b16 a[170:171], v229 offset:50176
  v_cvt_pk_bf16_f32 v144, v4, v5
  v_mfma_f32_16x16x32_bf16 v[52:55], a[184:187], a[36:39], v[52:55]
  v_cvt_pk_bf16_f32 v145, v6, v7
  v_cvt_pk_bf16_f32 v146, v20, v21
  v_mfma_f32_16x16x32_bf16 v[56:59], a[184:187], a[40:43], v[56:59]
  ds_read_b64_tr_b16 a[172:173], v229 offset:57344
  v_cvt_pk_bf16_f32 v147, v22, v23
  v_mfma_f32_16x16x32_bf16 v[56:59], a[188:191], a[56:59], v[56:59]
  v_permlane16_swap_b32 v128, v130
  v_permlane16_swap_b32 v129, v131
  v_mfma_f32_16x16x32_bf16 v[60:63], a[188:191], a[60:63], v[60:63]
  ds_read_b64_tr_b16 a[174:175], v229 offset:58368
  v_mul_f32 v8, s34, v8
  v_mfma_f32_16x16x32_bf16 v[60:63], a[184:187], a[44:47], v[60:63]
  s_waitcnt lgkmcnt(4)
  v_mul_f32 v9, s34, v9
  v_mul_f32 v10, s34, v10
  v_mfma_f32_16x16x32_bf16 v[64:67], a[160:163], a[32:35], v[64:67]
  ds_read_b64_tr_b16 a[176:177], v230 offset:49152
  v_mul_f32 v11, s34, v11
  v_mfma_f32_16x16x32_bf16 v[64:67], a[164:167], a[48:51], v[64:67]
  v_mul_f32 v24, s34, v24
  v_mul_f32 v25, s34, v25
  v_mfma_f32_16x16x32_bf16 v[68:71], a[164:167], a[52:55], v[68:71]
  ds_read_b64_tr_b16 a[178:179], v230 offset:50176
  v_mul_f32 v26, s34, v26
  v_mfma_f32_16x16x32_bf16 v[68:71], a[160:163], a[36:39], v[68:71]
  v_mul_f32 v27, s34, v27
  v_cvt_pk_bf16_f32 v160, v8, v9
  v_mfma_f32_16x16x32_bf16 v[72:75], a[160:163], a[40:43], v[72:75]
  ds_read_b64_tr_b16 a[180:181], v230 offset:57344
  v_cvt_pk_bf16_f32 v161, v10, v11
  v_mfma_f32_16x16x32_bf16 v[72:75], a[164:167], a[56:59], v[72:75]
  v_cvt_pk_bf16_f32 v162, v24, v25
  v_cvt_pk_bf16_f32 v163, v26, v27
  v_mfma_f32_16x16x32_bf16 v[76:79], a[164:167], a[60:63], v[76:79]
  ds_read_b64_tr_b16 a[182:183], v230 offset:58368
  v_permlane16_swap_b32 v144, v146
  v_mfma_f32_16x16x32_bf16 v[76:79], a[160:163], a[44:47], v[76:79]
  s_waitcnt lgkmcnt(4)
  v_permlane16_swap_b32 v145, v147
  v_mul_f32 v12, s34, v12
  v_mfma_f32_16x16x32_bf16 v[80:83], a[168:171], a[32:35], v[80:83]
  ds_read_b64_tr_b16 a[184:185], v231 offset:49152
  v_mul_f32 v13, s34, v13
  v_mfma_f32_16x16x32_bf16 v[80:83], a[172:175], a[48:51], v[80:83]
  v_mul_f32 v14, s34, v14
  v_mul_f32 v15, s34, v15
  v_mfma_f32_16x16x32_bf16 v[84:87], a[172:175], a[52:55], v[84:87]
  ds_read_b64_tr_b16 a[186:187], v231 offset:50176
  v_mul_f32 v28, s34, v28
  v_mfma_f32_16x16x32_bf16 v[84:87], a[168:171], a[36:39], v[84:87]
  v_mul_f32 v29, s34, v29
  v_mul_f32 v30, s34, v30
  v_mfma_f32_16x16x32_bf16 v[88:91], a[168:171], a[40:43], v[88:91]
  ds_read_b64_tr_b16 a[188:189], v231 offset:57344
  v_mul_f32 v31, s34, v31
  v_mfma_f32_16x16x32_bf16 v[88:91], a[172:175], a[56:59], v[88:91]
  s_barrier
  v_cvt_pk_bf16_f32 v176, v12, v13
  v_cvt_pk_bf16_f32 v177, v14, v15
  v_mfma_f32_16x16x32_bf16 v[92:95], a[172:175], a[60:63], v[92:95]
  ds_read_b64_tr_b16 a[190:191], v231 offset:58368
  v_cvt_pk_bf16_f32 v178, v28, v29
  v_mfma_f32_16x16x32_bf16 v[92:95], a[168:171], a[44:47], v[92:95]
  s_waitcnt lgkmcnt(4)
  v_cvt_pk_bf16_f32 v179, v30, v31
  v_permlane16_swap_b32 v160, v162
  v_mfma_f32_16x16x32_bf16 v[96:99], a[176:179], a[32:35], v[96:99]
  ds_read_b128 a[128:131], v212 offset:0
  v_permlane16_swap_b32 v161, v163
  v_mfma_f32_16x16x32_bf16 v[96:99], a[180:183], a[48:51], v[96:99]
  v_mul_f32 v32, s34, v32
  v_mul_f32 v33, s34, v33
  v_mfma_f32_16x16x32_bf16 v[100:103], a[180:183], a[52:55], v[100:103]
  ds_read_b128 a[132:135], v213 offset:0
  v_mul_f32 v34, s34, v34
  v_mfma_f32_16x16x32_bf16 v[100:103], a[176:179], a[36:39], v[100:103]
  v_mul_f32 v35, s34, v35
  v_mul_f32 v48, s34, v48
  v_mfma_f32_16x16x32_bf16 v[104:107], a[176:179], a[40:43], v[104:107]
  ds_read_b128 a[136:139], v214 offset:0
  v_mul_f32 v49, s34, v49
  v_mfma_f32_16x16x32_bf16 v[104:107], a[180:183], a[56:59], v[104:107]
  v_mul_f32 v50, s34, v50
  v_mul_f32 v51, s34, v51
  v_mfma_f32_16x16x32_bf16 v[108:111], a[180:183], a[60:63], v[108:111]
  ds_read_b128 a[140:143], v215 offset:0
  v_cvt_pk_bf16_f32 v132, v32, v33
  v_mfma_f32_16x16x32_bf16 v[108:111], a[176:179], a[44:47], v[108:111]
  s_waitcnt lgkmcnt(4)
  v_cvt_pk_bf16_f32 v133, v34, v35
  v_cvt_pk_bf16_f32 v134, v48, v49
  v_mfma_f32_16x16x32_bf16 v[112:115], a[184:187], a[32:35], v[112:115]
  v_cvt_pk_bf16_f32 v135, v50, v51
  v_permlane16_swap_b32 v176, v178
  v_mfma_f32_16x16x32_bf16 v[112:115], a[188:191], a[48:51], v[112:115]
  v_permlane16_swap_b32 v177, v179
  v_mul_f32 v36, s34, v36
  v_mfma_f32_16x16x32_bf16 v[116:119], a[188:191], a[52:55], v[116:119]
  v_mul_f32 v37, s34, v37
  v_mul_f32 v38, s34, v38
  v_mfma_f32_16x16x32_bf16 v[116:119], a[184:187], a[36:39], v[116:119]
  v_mul_f32 v39, s34, v39
  v_mul_f32 v52, s34, v52
  v_mfma_f32_16x16x32_bf16 v[120:123], a[184:187], a[40:43], v[120:123]
  v_mul_f32 v53, s34, v53
  v_mul_f32 v54, s34, v54
  v_mfma_f32_16x16x32_bf16 v[120:123], a[188:191], a[56:59], v[120:123]
  v_mul_f32 v55, s34, v55
  v_cvt_pk_bf16_f32 v148, v36, v37
  v_mfma_f32_16x16x32_bf16 v[124:127], a[188:191], a[60:63], v[124:127]
  v_cvt_pk_bf16_f32 v149, v38, v39
  v_cvt_pk_bf16_f32 v150, v52, v53
  v_mfma_f32_16x16x32_bf16 v[124:127], a[184:187], a[44:47], v[124:127]
  s_waitcnt lgkmcnt(0)
  v_cvt_pk_bf16_f32 v151, v54, v55
  v_permlane16_swap_b32 v132, v134
  v_permlane16_swap_b32 v133, v135
  v_mul_f32 v40, s34, v40
  v_mul_f32 v41, s34, v41
  v_mul_f32 v42, s34, v42
  v_mul_f32 v43, s34, v43
  v_mul_f32 v56, s34, v56
  v_mul_f32 v57, s34, v57
  v_mul_f32 v58, s34, v58
  v_mul_f32 v59, s34, v59
  v_cvt_pk_bf16_f32 v164, v40, v41
  v_cvt_pk_bf16_f32 v165, v42, v43
  v_cvt_pk_bf16_f32 v166, v56, v57
  v_cvt_pk_bf16_f32 v167, v58, v59
  v_permlane16_swap_b32 v148, v150
  v_permlane16_swap_b32 v149, v151
  v_mul_f32 v44, s34, v44
  v_mul_f32 v45, s34, v45
  v_mul_f32 v46, s34, v46
  v_mul_f32 v47, s34, v47
  v_mul_f32 v60, s34, v60
  v_mul_f32 v61, s34, v61
  v_mul_f32 v62, s34, v62
  v_mul_f32 v63, s34, v63
  v_cvt_pk_bf16_f32 v180, v44, v45
  v_cvt_pk_bf16_f32 v181, v46, v47
  v_cvt_pk_bf16_f32 v182, v60, v61
  v_cvt_pk_bf16_f32 v183, v62, v63
  v_permlane16_swap_b32 v164, v166
  v_permlane16_swap_b32 v165, v167
  v_mul_f32 v64, s34, v64
  v_mul_f32 v65, s34, v65
  v_mul_f32 v66, s34, v66
  v_mul_f32 v67, s34, v67
  v_mul_f32 v80, s34, v80
  v_mul_f32 v81, s34, v81
  v_mul_f32 v82, s34, v82
  v_mul_f32 v83, s34, v83
  v_cvt_pk_bf16_f32 v136, v64, v65
  v_cvt_pk_bf16_f32 v137, v66, v67
  v_cvt_pk_bf16_f32 v138, v80, v81
  v_cvt_pk_bf16_f32 v139, v82, v83
  v_permlane16_swap_b32 v180, v182
  v_permlane16_swap_b32 v181, v183
  v_mul_f32 v68, s34, v68
  v_mul_f32 v69, s34, v69
  v_mul_f32 v70, s34, v70
  v_mul_f32 v71, s34, v71
  v_mul_f32 v84, s34, v84
  v_mul_f32 v85, s34, v85
  v_mul_f32 v86, s34, v86
  v_mul_f32 v87, s34, v87
  v_cvt_pk_bf16_f32 v152, v68, v69
  v_cvt_pk_bf16_f32 v153, v70, v71
  v_cvt_pk_bf16_f32 v154, v84, v85
  v_cvt_pk_bf16_f32 v155, v86, v87
  v_permlane16_swap_b32 v136, v138
  v_permlane16_swap_b32 v137, v139
  v_mul_f32 v72, s34, v72
  v_mul_f32 v73, s34, v73
  v_mul_f32 v74, s34, v74
  v_mul_f32 v75, s34, v75
  v_mul_f32 v88, s34, v88
  v_mul_f32 v89, s34, v89
  v_mul_f32 v90, s34, v90
  v_mul_f32 v91, s34, v91
  v_cvt_pk_bf16_f32 v168, v72, v73
  v_cvt_pk_bf16_f32 v169, v74, v75
  v_cvt_pk_bf16_f32 v170, v88, v89
  v_cvt_pk_bf16_f32 v171, v90, v91
  v_permlane16_swap_b32 v152, v154
  v_permlane16_swap_b32 v153, v155
  v_mul_f32 v76, s34, v76
  v_mul_f32 v77, s34, v77
  v_mul_f32 v78, s34, v78
  v_mul_f32 v79, s34, v79
  v_mul_f32 v92, s34, v92
  v_mul_f32 v93, s34, v93
  v_mul_f32 v94, s34, v94
  v_mul_f32 v95, s34, v95
  v_cvt_pk_bf16_f32 v184, v76, v77
  v_cvt_pk_bf16_f32 v185, v78, v79
  v_cvt_pk_bf16_f32 v186, v92, v93
  v_cvt_pk_bf16_f32 v187, v94, v95
  v_permlane16_swap_b32 v168, v170
  v_permlane16_swap_b32 v169, v171
  v_mul_f32 v96, s34, v96
  v_mul_f32 v97, s34, v97
  v_mul_f32 v98, s34, v98
  v_mul_f32 v99, s34, v99
  v_mul_f32 v112, s34, v112
  v_mul_f32 v113, s34, v113
  v_mul_f32 v114, s34, v114
  v_mul_f32 v115, s34, v115
  v_cvt_pk_bf16_f32 v140, v96, v97
  v_cvt_pk_bf16_f32 v141, v98, v99
  v_cvt_pk_bf16_f32 v142, v112, v113
  v_cvt_pk_bf16_f32 v143, v114, v115
  v_permlane16_swap_b32 v184, v186
  v_permlane16_swap_b32 v185, v187
  v_mul_f32 v100, s34, v100
  v_mul_f32 v101, s34, v101
  v_mul_f32 v102, s34, v102
  v_mul_f32 v103, s34, v103
  v_mul_f32 v116, s34, v116
  v_mul_f32 v117, s34, v117
  v_mul_f32 v118, s34, v118
  v_mul_f32 v119, s34, v119
  v_cvt_pk_bf16_f32 v156, v100, v101
  v_cvt_pk_bf16_f32 v157, v102, v103
  v_cvt_pk_bf16_f32 v158, v116, v117
  v_cvt_pk_bf16_f32 v159, v118, v119
  v_permlane16_swap_b32 v140, v142
  v_permlane16_swap_b32 v141, v143
  v_mul_f32 v104, s34, v104
  v_mul_f32 v105, s34, v105
  v_mul_f32 v106, s34, v106
  v_mul_f32 v107, s34, v107
  v_mul_f32 v120, s34, v120
  v_mul_f32 v121, s34, v121
  v_mul_f32 v122, s34, v122
  v_mul_f32 v123, s34, v123
  v_cvt_pk_bf16_f32 v172, v104, v105
  v_cvt_pk_bf16_f32 v173, v106, v107
  v_cvt_pk_bf16_f32 v174, v120, v121
  v_cvt_pk_bf16_f32 v175, v122, v123
  v_permlane16_swap_b32 v156, v158
  v_permlane16_swap_b32 v157, v159
  v_mul_f32 v108, s34, v108
  v_mul_f32 v109, s34, v109
  v_mul_f32 v110, s34, v110
  v_mul_f32 v111, s34, v111
  v_mul_f32 v124, s34, v124
  v_mul_f32 v125, s34, v125
  v_mul_f32 v126, s34, v126
  v_mul_f32 v127, s34, v127
  v_cvt_pk_bf16_f32 v188, v108, v109
  v_cvt_pk_bf16_f32 v189, v110, v111
  v_cvt_pk_bf16_f32 v190, v124, v125
  v_cvt_pk_bf16_f32 v191, v126, v127
  v_permlane16_swap_b32 v172, v174
  v_permlane16_swap_b32 v173, v175
  v_permlane16_swap_b32 v188, v190
  v_permlane16_swap_b32 v189, v191
  v_mfma_f32_16x16x32_bf16 v[0:3], a[128:131], v[128:131], 0
  ds_read_b128 a[144:147], v212 offset:4096
  s_mov_b32 s20, s90
  s_mov_b32 s21, s91
  s_mov_b32 s22, 2211840
  s_mov_b32 s23, 0x20000
  s_mov_b32 s44, s92
  s_mov_b32 s45, s93
  s_mov_b32 s46, 2211840
  s_mov_b32 s47, 0x20000
  v_lshrrev_b32 v226, 4, v242
  v_mfma_f32_16x16x32_bf16 v[0:3], a[132:135], v[132:135], v[0:3]
  v_mul_u32_u24 v226, 0xd80, v226
  v_mfma_f32_16x16x32_bf16 v[0:3], a[136:139], v[136:139], v[0:3]
  ds_read_b128 a[148:151], v213 offset:4096
  s_mul_i32 s35, s3, 552960
  s_lshl_b32 s38, s33, 4
  s_add_u32 s35, s35, s38
  s_add_u32 m0, s50, 0
  v_mfma_f32_16x16x32_bf16 v[0:3], a[140:143], v[140:143], v[0:3]
  buffer_load_dwordx4 v226, s[20:23], s35 offen lds
  v_mfma_f32_16x16x32_bf16 v[8:11], a[140:143], v[156:159], 0
  ds_read_b128 a[152:155], v214 offset:4096
  v_mfma_f32_16x16x32_bf16 v[8:11], a[136:139], v[152:155], v[8:11]
  v_mfma_f32_16x16x32_bf16 v[8:11], a[132:135], v[148:151], v[8:11]
  ds_read_b128 a[156:159], v215 offset:4096
  v_mfma_f32_16x16x32_bf16 v[8:11], a[128:131], v[144:147], v[8:11]
  v_mfma_f32_16x16x32_bf16 v[16:19], a[128:131], v[160:163], 0
  v_mfma_f32_16x16x32_bf16 v[16:19], a[132:135], v[164:167], v[16:19]
  v_mfma_f32_16x16x32_bf16 v[16:19], a[136:139], v[168:171], v[16:19]
  v_mfma_f32_16x16x32_bf16 v[16:19], a[140:143], v[172:175], v[16:19]
  v_max3_f32 v192, v0, v1, v2
  s_nop 2
  v_max3_f32 v196, v8, v9, v10
  v_mfma_f32_16x16x32_bf16 v[24:27], a[140:143], v[188:191], 0
  v_max_f32 v192, v192, v3
  v_max_f32 v196, v196, v11
  v_mfma_f32_16x16x32_bf16 v[24:27], a[136:139], v[184:187], v[24:27]
  v_mov_b32 v245, v192
  v_mov_b32 v246, v196
  v_mfma_f32_16x16x32_bf16 v[24:27], a[132:135], v[180:183], v[24:27]
  v_permlane16_swap_b32 v192, v245
  v_permlane16_swap_b32 v196, v246
  v_mfma_f32_16x16x32_bf16 v[24:27], a[128:131], v[176:179], v[24:27]
  s_waitcnt lgkmcnt(0)
  v_max_f32 v192, v192, v245
  v_max_f32 v196, v196, v246
  v_mfma_f32_16x16x32_bf16 v[4:7], a[144:147], v[128:131], 0
  ds_read_b128 a[128:131], v212 offset:8192
  v_mov_b32 v245, v192
  v_mfma_f32_16x16x32_bf16 v[4:7], a[148:151], v[132:135], v[4:7]
  v_mov_b32 v246, v196
  v_permlane32_swap_b32 v192, v245
  v_mfma_f32_16x16x32_bf16 v[4:7], a[152:155], v[136:139], v[4:7]
  ds_read_b128 a[132:135], v213 offset:8192
  v_permlane32_swap_b32 v196, v246
  v_mfma_f32_16x16x32_bf16 v[4:7], a[156:159], v[140:143], v[4:7]
  v_max_f32 v192, v192, v245
  v_max_f32 v196, v196, v246
  v_mfma_f32_16x16x32_bf16 v[12:15], a[156:159], v[156:159], 0
  ds_read_b128 a[136:139], v214 offset:8192
  v_sub_f32 v193, 0, v192
  v_mfma_f32_16x16x32_bf16 v[12:15], a[152:155], v[152:155], v[12:15]
  v_sub_f32 v197, 0, v196
  v_sub_f32 v194, 0, v192
  v_mfma_f32_16x16x32_bf16 v[12:15], a[148:151], v[148:151], v[12:15]
  ds_read_b128 a[140:143], v215 offset:8192
  v_sub_f32 v198, 0, v196
  v_mfma_f32_16x16x32_bf16 v[12:15], a[144:147], v[144:147], v[12:15]
  v_sub_f32 v195, 0, v192
  v_sub_f32 v199, 0, v196
  v_mfma_f32_16x16x32_bf16 v[20:23], a[144:147], v[160:163], 0
  v_sub_f32 v192, 0, v192
  v_sub_f32 v196, 0, v196
  v_mfma_f32_16x16x32_bf16 v[20:23], a[148:151], v[164:167], v[20:23]
  v_max3_f32 v200, v16, v17, v18
  v_max3_f32 v204, v24, v25, v26
  v_mfma_f32_16x16x32_bf16 v[20:23], a[152:155], v[168:171], v[20:23]
  v_max_f32 v200, v200, v19
  v_max_f32 v204, v204, v27
  v_mfma_f32_16x16x32_bf16 v[20:23], a[156:159], v[172:175], v[20:23]
  v_mov_b32 v247, v200
  v_mov_b32 v248, v204
  v_mfma_f32_16x16x32_bf16 v[28:31], a[156:159], v[188:191], 0
  v_permlane16_swap_b32 v200, v247
  v_permlane16_swap_b32 v204, v248
  v_mfma_f32_16x16x32_bf16 v[28:31], a[152:155], v[184:187], v[28:31]
  v_max_f32 v200, v200, v247
  v_max_f32 v204, v204, v248
  v_mfma_f32_16x16x32_bf16 v[28:31], a[148:151], v[180:183], v[28:31]
  v_mov_b32 v247, v200
  v_mov_b32 v248, v204
  s_nop 0
  v_permlane32_swap_b32 v200, v247
  v_permlane32_swap_b32 v204, v248
  v_max_f32 v200, v200, v247
  v_max_f32 v204, v204, v248
  v_sub_f32 v201, 0, v200
  v_sub_f32 v205, 0, v204
  v_sub_f32 v202, 0, v200
  v_sub_f32 v206, 0, v204
  v_sub_f32 v203, 0, v200
  v_sub_f32 v207, 0, v204
  v_sub_f32 v200, 0, v200
  v_sub_f32 v204, 0, v204
  v_mfma_f32_16x16x32_bf16 v[28:31], a[144:147], v[176:179], v[28:31]
  s_waitcnt lgkmcnt(0)
  v_add_f32 v0, v192, v0
  v_add_f32 v1, v192, v1
  v_mfma_f32_16x16x32_bf16 v[32:35], a[128:131], v[128:131], v[192:195]
  ds_read_b128 a[144:147], v212 offset:12288
  v_add_f32 v2, v192, v2
  v_mfma_f32_16x16x32_bf16 v[32:35], a[132:135], v[132:135], v[32:35]
  v_add_f32 v3, v192, v3
  v_mfma_f32_16x16x32_bf16 v[32:35], a[136:139], v[136:139], v[32:35]
  ds_read_b128 a[148:151], v213 offset:12288
  v_mfma_f32_16x16x32_bf16 v[32:35], a[140:143], v[140:143], v[32:35]
  v_exp_f32 v0, v0
  v_mfma_f32_16x16x32_bf16 v[40:43], a[140:143], v[156:159], v[196:199]
  ds_read_b128 a[152:155], v214 offset:12288
  v_mfma_f32_16x16x32_bf16 v[40:43], a[136:139], v[152:155], v[40:43]
  v_exp_f32 v1, v1
  v_mfma_f32_16x16x32_bf16 v[40:43], a[132:135], v[148:151], v[40:43]
  ds_read_b128 a[156:159], v215 offset:12288
  v_mfma_f32_16x16x32_bf16 v[40:43], a[128:131], v[144:147], v[40:43]
  v_exp_f32 v2, v2
  v_mfma_f32_16x16x32_bf16 v[48:51], a[128:131], v[160:163], v[200:203]
  v_cvt_pk_bf16_f32 v0, v0, v1
  v_mfma_f32_16x16x32_bf16 v[48:51], a[132:135], v[164:167], v[48:51]
  v_exp_f32 v3, v3
  v_mfma_f32_16x16x32_bf16 v[48:51], a[136:139], v[168:171], v[48:51]
  v_add_f32 v8, v196, v8
  v_add_f32 v9, v196, v9
  v_mfma_f32_16x16x32_bf16 v[48:51], a[140:143], v[172:175], v[48:51]
  v_add_f32 v10, v196, v10
  v_add_f32 v11, v196, v11
  v_mfma_f32_16x16x32_bf16 v[56:59], a[140:143], v[188:191], v[204:207]
  v_exp_f32 v8, v8
  v_mfma_f32_16x16x32_bf16 v[56:59], a[136:139], v[184:187], v[56:59]
  v_exp_f32 v9, v9
  v_mfma_f32_16x16x32_bf16 v[56:59], a[132:135], v[180:183], v[56:59]
  v_exp_f32 v10, v10
  v_mfma_f32_16x16x32_bf16 v[56:59], a[128:131], v[176:179], v[56:59]
  s_waitcnt lgkmcnt(0)
  v_cvt_pk_bf16_f32 v8, v8, v9
  v_mfma_f32_16x16x32_bf16 v[36:39], a[144:147], v[128:131], v[192:195]
  s_waitcnt vmcnt(11)
  v_exp_f32 v11, v11
  v_mfma_f32_16x16x32_bf16 v[36:39], a[148:151], v[132:135], v[36:39]
  s_barrier
  v_cvt_pk_bf16_f32 v1, v2, v3
  v_add_f32 v16, v200, v16
  v_mfma_f32_16x16x32_bf16 v[36:39], a[152:155], v[136:139], v[36:39]
  ds_read_b128 a[128:131], v212 offset:16384
  v_add_f32 v17, v200, v17
  v_mfma_f32_16x16x32_bf16 v[36:39], a[156:159], v[140:143], v[36:39]
  v_add_f32 v18, v200, v18
  v_add_f32 v19, v200, v19
  v_mfma_f32_16x16x32_bf16 v[44:47], a[156:159], v[156:159], v[196:199]
  ds_read_b128 a[132:135], v213 offset:16384
  v_mfma_f32_16x16x32_bf16 v[44:47], a[152:155], v[152:155], v[44:47]
  v_exp_f32 v16, v16
  v_mfma_f32_16x16x32_bf16 v[44:47], a[148:151], v[148:151], v[44:47]
  ds_read_b128 a[136:139], v214 offset:16384
  v_mfma_f32_16x16x32_bf16 v[44:47], a[144:147], v[144:147], v[44:47]
  v_exp_f32 v17, v17
  v_mfma_f32_16x16x32_bf16 v[52:55], a[144:147], v[160:163], v[200:203]
  ds_read_b128 a[140:143], v215 offset:16384
  v_mfma_f32_16x16x32_bf16 v[52:55], a[148:151], v[164:167], v[52:55]
  v_exp_f32 v18, v18
  v_mfma_f32_16x16x32_bf16 v[52:55], a[152:155], v[168:171], v[52:55]
  v_cvt_pk_bf16_f32 v16, v16, v17
  v_mfma_f32_16x16x32_bf16 v[52:55], a[156:159], v[172:175], v[52:55]
  v_exp_f32 v19, v19
  v_mfma_f32_16x16x32_bf16 v[60:63], a[156:159], v[188:191], v[204:207]
  v_cvt_pk_bf16_f32 v9, v10, v11
  v_add_f32 v24, v204, v24
  v_mfma_f32_16x16x32_bf16 v[60:63], a[152:155], v[184:187], v[60:63]
  v_add_f32 v25, v204, v25
  v_add_f32 v26, v204, v26
  v_mfma_f32_16x16x32_bf16 v[60:63], a[148:151], v[180:183], v[60:63]
  v_add_f32 v27, v204, v27
  v_mfma_f32_16x16x32_bf16 v[60:63], a[144:147], v[176:179], v[60:63]
  s_waitcnt lgkmcnt(0)
  v_exp_f32 v24, v24
  v_exp_f32 v25, v25
  v_exp_f32 v26, v26
  v_cvt_pk_bf16_f32 v24, v24, v25
  v_exp_f32 v27, v27
  v_cvt_pk_bf16_f32 v17, v18, v19
  v_add_f32 v4, v192, v4
  v_add_f32 v5, v192, v5
  v_add_f32 v6, v192, v6
  v_add_f32 v7, v192, v7
  v_exp_f32 v4, v4
  v_exp_f32 v5, v5
  v_exp_f32 v6, v6
  v_cvt_pk_bf16_f32 v2, v4, v5
  v_exp_f32 v7, v7
  v_cvt_pk_bf16_f32 v25, v26, v27
  v_add_f32 v12, v196, v12
  v_add_f32 v13, v196, v13
  v_add_f32 v14, v196, v14
  v_add_f32 v15, v196, v15
  v_exp_f32 v12, v12
  v_exp_f32 v13, v13
  v_exp_f32 v14, v14
  v_cvt_pk_bf16_f32 v10, v12, v13
  v_exp_f32 v15, v15
  v_cvt_pk_bf16_f32 v3, v6, v7
  v_add_f32 v20, v200, v20
  v_add_f32 v21, v200, v21
  v_add_f32 v22, v200, v22
  v_add_f32 v23, v200, v23
  v_exp_f32 v20, v20
  v_exp_f32 v21, v21
  v_exp_f32 v22, v22
  v_cvt_pk_bf16_f32 v18, v20, v21
  v_exp_f32 v23, v23
  v_cvt_pk_bf16_f32 v11, v14, v15
  v_add_f32 v28, v204, v28
  v_add_f32 v29, v204, v29
  v_add_f32 v30, v204, v30
  v_add_f32 v31, v204, v31
  v_exp_f32 v28, v28
  v_exp_f32 v29, v29
  v_exp_f32 v30, v30
  v_cvt_pk_bf16_f32 v26, v28, v29
  v_exp_f32 v31, v31
  v_cvt_pk_bf16_f32 v19, v22, v23
  v_exp_f32 v32, v32
  v_exp_f32 v33, v33
  v_exp_f32 v34, v34
  v_cvt_pk_bf16_f32 v32, v32, v33
  v_exp_f32 v35, v35
  v_cvt_pk_bf16_f32 v27, v30, v31
  v_exp_f32 v40, v40
  v_exp_f32 v41, v41
  v_exp_f32 v42, v42
  v_cvt_pk_bf16_f32 v40, v40, v41
  v_exp_f32 v43, v43
  v_cvt_pk_bf16_f32 v33, v34, v35
  v_exp_f32 v48, v48
  v_exp_f32 v49, v49
  v_exp_f32 v50, v50
  v_cvt_pk_bf16_f32 v48, v48, v49
  v_exp_f32 v51, v51
  v_cvt_pk_bf16_f32 v41, v42, v43
  v_exp_f32 v56, v56
  v_exp_f32 v57, v57
  v_exp_f32 v58, v58
  v_cvt_pk_bf16_f32 v56, v56, v57
  v_exp_f32 v59, v59
  v_cvt_pk_bf16_f32 v49, v50, v51
  v_exp_f32 v36, v36
  v_exp_f32 v37, v37
  v_exp_f32 v38, v38
  v_cvt_pk_bf16_f32 v34, v36, v37
  v_exp_f32 v39, v39
  v_cvt_pk_bf16_f32 v57, v58, v59
  v_exp_f32 v44, v44
  v_exp_f32 v45, v45
  v_exp_f32 v46, v46
  v_cvt_pk_bf16_f32 v42, v44, v45
  v_exp_f32 v47, v47
  v_cvt_pk_bf16_f32 v35, v38, v39
  v_exp_f32 v52, v52
  v_exp_f32 v53, v53
  v_exp_f32 v54, v54
  v_cvt_pk_bf16_f32 v50, v52, v53
  v_exp_f32 v55, v55
  v_cvt_pk_bf16_f32 v43, v46, v47
  v_exp_f32 v60, v60
  v_exp_f32 v61, v61
  v_exp_f32 v62, v62
  v_cvt_pk_bf16_f32 v58, v60, v61
  v_exp_f32 v63, v63
  v_cvt_pk_bf16_f32 v51, v54, v55
  v_cvt_pk_bf16_f32 v59, v62, v63
  v_mfma_f32_16x16x32_bf16 v[64:67], a[128:131], v[128:131], v[192:195]
  s_add_u32 m0, s28, 98304
  v_mfma_f32_16x16x32_bf16 v[64:67], a[132:135], v[132:135], v[64:67]
  ds_read_b128 a[144:147], v212 offset:20480
  v_mfma_f32_16x16x32_bf16 v[64:67], a[136:139], v[136:139], v[64:67]
  buffer_load_dwordx4 v236, s[16:19], s29 offen offset:0 lds
  v_mfma_f32_16x16x32_bf16 v[64:67], a[140:143], v[140:143], v[64:67]
  ds_read_b128 a[148:151], v213 offset:20480
  v_mfma_f32_16x16x32_bf16 v[72:75], a[140:143], v[156:159], v[196:199]
  buffer_load_dwordx4 v237, s[16:19], s29 offen offset:1024 lds
  v_mfma_f32_16x16x32_bf16 v[72:75], a[136:139], v[152:155], v[72:75]
  ds_read_b128 a[152:155], v214 offset:20480
  v_mfma_f32_16x16x32_bf16 v[72:75], a[132:135], v[148:151], v[72:75]
  buffer_load_dwordx4 v236, s[16:19], s29 offen offset:2048 lds
  v_mfma_f32_16x16x32_bf16 v[72:75], a[128:131], v[144:147], v[72:75]
  ds_read_b128 a[156:159], v215 offset:20480
  v_mfma_f32_16x16x32_bf16 v[80:83], a[128:131], v[160:163], v[200:203]
  v_exp_f32 v64, v64
  v_mfma_f32_16x16x32_bf16 v[80:83], a[132:135], v[164:167], v[80:83]
  buffer_load_dwordx4 v237, s[16:19], s29 offen offset:3072 lds
  v_mfma_f32_16x16x32_bf16 v[80:83], a[136:139], v[168:171], v[80:83]
  s_add_u32 s29, s29, 16384
  v_exp_f32 v65, v65
  v_mfma_f32_16x16x32_bf16 v[80:83], a[140:143], v[172:175], v[80:83]
  v_cvt_pk_bf16_f32 v64, v64, v65
  v_mfma_f32_16x16x32_bf16 v[88:91], a[140:143], v[188:191], v[204:207]
  s_add_u32 m0, s28, 49152
  v_exp_f32 v66, v66
  v_mfma_f32_16x16x32_bf16 v[88:91], a[136:139], v[184:187], v[88:91]
  buffer_load_dwordx4 v232, s[12:15], s29 offen offset:0 lds
  v_mfma_f32_16x16x32_bf16 v[88:91], a[132:135], v[180:183], v[88:91]
  s_waitcnt lgkmcnt(0)
  v_exp_f32 v67, v67
  v_mfma_f32_16x16x32_bf16 v[88:91], a[128:131], v[176:179], v[88:91]
  v_cvt_pk_bf16_f32 v65, v66, v67
  v_mfma_f32_16x16x32_bf16 v[68:71], a[144:147], v[128:131], v[192:195]
  v_exp_f32 v72, v72
  v_mfma_f32_16x16x32_bf16 v[68:71], a[148:151], v[132:135], v[68:71]
  ds_read_b128 a[128:131], v212 offset:24576
  v_mfma_f32_16x16x32_bf16 v[68:71], a[152:155], v[136:139], v[68:71]
  v_exp_f32 v73, v73
  v_mfma_f32_16x16x32_bf16 v[68:71], a[156:159], v[140:143], v[68:71]
  ds_read_b128 a[132:135], v213 offset:24576
  v_cvt_pk_bf16_f32 v72, v72, v73
  v_mfma_f32_16x16x32_bf16 v[76:79], a[156:159], v[156:159], v[196:199]
  v_exp_f32 v74, v74
  v_mfma_f32_16x16x32_bf16 v[76:79], a[152:155], v[152:155], v[76:79]
  ds_read_b128 a[136:139], v214 offset:24576
  v_mfma_f32_16x16x32_bf16 v[76:79], a[148:151], v[148:151], v[76:79]
  v_exp_f32 v75, v75
  v_mfma_f32_16x16x32_bf16 v[76:79], a[144:147], v[144:147], v[76:79]
  ds_read_b128 a[140:143], v215 offset:24576
  v_cvt_pk_bf16_f32 v73, v74, v75
  v_mfma_f32_16x16x32_bf16 v[84:87], a[144:147], v[160:163], v[200:203]
  v_exp_f32 v80, v80
  v_mfma_f32_16x16x32_bf16 v[84:87], a[148:151], v[164:167], v[84:87]
  buffer_load_dwordx4 v233, s[12:15], s29 offen offset:1024 lds
  v_mfma_f32_16x16x32_bf16 v[84:87], a[152:155], v[168:171], v[84:87]
  v_exp_f32 v81, v81
  v_mfma_f32_16x16x32_bf16 v[84:87], a[156:159], v[172:175], v[84:87]
  v_cvt_pk_bf16_f32 v80, v80, v81
  v_mfma_f32_16x16x32_bf16 v[92:95], a[156:159], v[188:191], v[204:207]
  v_exp_f32 v82, v82
  v_mfma_f32_16x16x32_bf16 v[92:95], a[152:155], v[184:187], v[92:95]
  buffer_load_dwordx4 v234, s[12:15], s29 offen offset:2048 lds
  v_mfma_f32_16x16x32_bf16 v[92:95], a[148:151], v[180:183], v[92:95]
  s_waitcnt lgkmcnt(0)
  v_exp_f32 v83, v83
  v_mfma_f32_16x16x32_bf16 v[92:95], a[144:147], v[176:179], v[92:95]
  v_cvt_pk_bf16_f32 v81, v82, v83
  v_mfma_f32_16x16x32_bf16 v[96:99], a[128:131], v[128:131], v[192:195]
  v_exp_f32 v88, v88
  v_mfma_f32_16x16x32_bf16 v[96:99], a[132:135], v[132:135], v[96:99]
  ds_read_b128 a[144:147], v212 offset:28672
  v_mfma_f32_16x16x32_bf16 v[96:99], a[136:139], v[136:139], v[96:99]
  v_exp_f32 v89, v89
  v_mfma_f32_16x16x32_bf16 v[96:99], a[140:143], v[140:143], v[96:99]
  ds_read_b128 a[148:151], v213 offset:28672
  v_cvt_pk_bf16_f32 v88, v88, v89
  v_mfma_f32_16x16x32_bf16 v[104:107], a[140:143], v[156:159], v[196:199]
  v_exp_f32 v90, v90
  v_mfma_f32_16x16x32_bf16 v[104:107], a[136:139], v[152:155], v[104:107]
  ds_read_b128 a[152:155], v214 offset:28672
  v_mfma_f32_16x16x32_bf16 v[104:107], a[132:135], v[148:151], v[104:107]
  v_exp_f32 v91, v91
  v_mfma_f32_16x16x32_bf16 v[104:107], a[128:131], v[144:147], v[104:107]
  ds_read_b128 a[156:159], v215 offset:28672
  v_cvt_pk_bf16_f32 v89, v90, v91
  v_mfma_f32_16x16x32_bf16 v[112:115], a[128:131], v[160:163], v[200:203]
  v_exp_f32 v68, v68
  v_mfma_f32_16x16x32_bf16 v[112:115], a[132:135], v[164:167], v[112:115]
  buffer_load_dwordx4 v235, s[12:15], s29 offen offset:3072 lds
  v_mfma_f32_16x16x32_bf16 v[112:115], a[136:139], v[168:171], v[112:115]
  v_exp_f32 v69, v69
  v_mfma_f32_16x16x32_bf16 v[112:115], a[140:143], v[172:175], v[112:115]
  v_cvt_pk_bf16_f32 v66, v68, v69
  v_mfma_f32_16x16x32_bf16 v[120:123], a[140:143], v[188:191], v[204:207]
  v_exp_f32 v70, v70
  v_mfma_f32_16x16x32_bf16 v[120:123], a[136:139], v[184:187], v[120:123]
  s_add_u32 m0, s50, 3072
  v_mfma_f32_16x16x32_bf16 v[120:123], a[132:135], v[180:183], v[120:123]
  s_waitcnt lgkmcnt(0)
  v_exp_f32 v71, v71
  v_mfma_f32_16x16x32_bf16 v[120:123], a[128:131], v[176:179], v[120:123]
  buffer_load_dwordx4 v226, s[44:47], s35 offen lds
  s_add_u32 s35, s35, 221184
  v_cvt_pk_bf16_f32 v67, v70, v71
  v_mfma_f32_16x16x32_bf16 v[100:103], a[144:147], v[128:131], v[192:195]
  v_exp_f32 v76, v76
  v_mfma_f32_16x16x32_bf16 v[100:103], a[148:151], v[132:135], v[100:103]
  ds_read_b64_tr_b16 a[160:161], v216 offset:0
  v_mfma_f32_16x16x32_bf16 v[100:103], a[152:155], v[136:139], v[100:103]
  v_exp_f32 v77, v77
  v_mfma_f32_16x16x32_bf16 v[100:103], a[156:159], v[140:143], v[100:103]
  ds_read_b64_tr_b16 a[162:163], v216 offset:4096
  v_cvt_pk_bf16_f32 v74, v76, v77
  v_mfma_f32_16x16x32_bf16 v[108:111], a[156:159], v[156:159], v[196:199]
  v_exp_f32 v78, v78
  v_mfma_f32_16x16x32_bf16 v[108:111], a[152:155], v[152:155], v[108:111]
  ds_read_b64_tr_b16 a[164:165], v216 offset:8192
  v_mfma_f32_16x16x32_bf16 v[108:111], a[148:151], v[148:151], v[108:111]
  v_exp_f32 v79, v79
  v_mfma_f32_16x16x32_bf16 v[108:111], a[144:147], v[144:147], v[108:111]
  ds_read_b64_tr_b16 a[166:167], v216 offset:12288
  v_cvt_pk_bf16_f32 v75, v78, v79
  v_mfma_f32_16x16x32_bf16 v[116:119], a[144:147], v[160:163], v[200:203]
  v_exp_f32 v84, v84
  v_mfma_f32_16x16x32_bf16 v[116:119], a[148:151], v[164:167], v[116:119]
  ds_read_b64_tr_b16 a[168:169], v217 offset:0
  v_mfma_f32_16x16x32_bf16 v[116:119], a[152:155], v[168:171], v[116:119]
  v_exp_f32 v85, v85
  v_mfma_f32_16x16x32_bf16 v[116:119], a[156:159], v[172:175], v[116:119]
  ds_read_b64_tr_b16 a[170:171], v217 offset:4096
  v_cvt_pk_bf16_f32 v82, v84, v85
  v_mfma_f32_16x16x32_bf16 v[124:127], a[156:159], v[188:191], v[204:207]
  v_exp_f32 v86, v86
  v_mfma_f32_16x16x32_bf16 v[124:127], a[152:155], v[184:187], v[124:127]
  ds_read_b64_tr_b16 a[172:173], v217 offset:8192
  v_mfma_f32_16x16x32_bf16 v[124:127], a[148:151], v[180:183], v[124:127]
  v_exp_f32 v87, v87
  v_mfma_f32_16x16x32_bf16 v[124:127], a[144:147], v[176:179], v[124:127]
  ds_read_b64_tr_b16 a[174:175], v217 offset:12288
  v_cvt_pk_bf16_f32 v83, v86, v87
  v_mfma_f32_16x16x32_bf16 a[192:195], a[208:211], v[0:3], 0
  v_exp_f32 v92, v92
  v_mfma_f32_16x16x32_bf16 a[192:195], a[208:211], v[32:35], a[192:195]
  ds_read_b64_tr_b16 a[176:177], v218 offset:0
  v_mfma_f32_16x16x32_bf16 a[196:199], a[208:211], v[8:11], 0
  v_exp_f32 v93, v93
  v_mfma_f32_16x16x32_bf16 a[196:199], a[208:211], v[40:43], a[196:199]
  ds_read_b64_tr_b16 a[178:179], v218 offset:4096
  v_cvt_pk_bf16_f32 v90, v92, v93
  v_mfma_f32_16x16x32_bf16 a[200:203], a[208:211], v[16:19], 0
  v_exp_f32 v94, v94
  v_mfma_f32_16x16x32_bf16 a[200:203], a[208:211], v[48:51], a[200:203]
  ds_read_b64_tr_b16 a[180:181], v218 offset:8192
  v_mfma_f32_16x16x32_bf16 a[204:207], a[208:211], v[24:27], 0
  s_waitcnt lgkmcnt(7)
  v_exp_f32 v95, v95
  v_mfma_f32_16x16x32_bf16 a[204:207], a[208:211], v[56:59], a[204:207]
  ds_read_b64_tr_b16 a[182:183], v218 offset:12288
  v_cvt_pk_bf16_f32 v91, v94, v95
  v_mfma_f32_16x16x32_bf16 a[0:3], a[160:163], v[0:3], 0
  v_exp_f32 v96, v96
  v_mfma_f32_16x16x32_bf16 a[0:3], a[164:167], v[32:35], a[0:3]
  ds_read_b64_tr_b16 a[184:185], v219 offset:0
  v_mfma_f32_16x16x32_bf16 a[4:7], a[164:167], v[40:43], 0
  v_exp_f32 v97, v97
  v_mfma_f32_16x16x32_bf16 a[4:7], a[160:163], v[8:11], a[4:7]
  ds_read_b64_tr_b16 a[186:187], v219 offset:4096
  v_cvt_pk_bf16_f32 v96, v96, v97
  v_mfma_f32_16x16x32_bf16 a[8:11], a[160:163], v[16:19], 0
  v_exp_f32 v98, v98
  v_mfma_f32_16x16x32_bf16 a[8:11], a[164:167], v[48:51], a[8:11]
  ds_read_b64_tr_b16 a[188:189], v219 offset:8192
  v_mfma_f32_16x16x32_bf16 a[12:15], a[164:167], v[56:59], 0
  s_waitcnt lgkmcnt(7)
  v_exp_f32 v99, v99
  v_mfma_f32_16x16x32_bf16 a[12:15], a[160:163], v[24:27], a[12:15]
  ds_read_b64_tr_b16 a[190:191], v219 offset:12288
  v_cvt_pk_bf16_f32 v97, v98, v99
  v_mfma_f32_16x16x32_bf16 a[16:19], a[168:171], v[0:3], 0
  v_exp_f32 v104, v104
  v_mfma_f32_16x16x32_bf16 a[16:19], a[172:175], v[32:35], a[16:19]
  ds_read_b64_tr_b16 a[160:161], v220 offset:0
  v_mfma_f32_16x16x32_bf16 a[20:23], a[172:175], v[40:43], 0
  v_exp_f32 v105, v105
  v_mfma_f32_16x16x32_bf16 a[20:23], a[168:171], v[8:11], a[20:23]
  ds_read_b64_tr_b16 a[162:163], v220 offset:4096
  v_cvt_pk_bf16_f32 v104, v104, v105
  v_mfma_f32_16x16x32_bf16 a[24:27], a[168:171], v[16:19], 0
  v_exp_f32 v106, v106
  v_mfma_f32_16x16x32_bf16 a[24:27], a[172:175], v[48:51], a[24:27]
  ds_read_b64_tr_b16 a[164:165], v220 offset:8192
  v_mfma_f32_16x16x32_bf16 a[28:31], a[172:175], v[56:59], 0
  s_waitcnt lgkmcnt(7)
  v_exp_f32 v107, v107
  v_mfma_f32_16x16x32_bf16 a[28:31], a[168:171], v[24:27], a[28:31]
  ds_read_b64_tr_b16 a[166:167], v220 offset:12288
  v_cvt_pk_bf16_f32 v105, v106, v107
  v_mfma_f32_16x16x32_bf16 a[32:35], a[176:179], v[0:3], 0
  v_exp_f32 v112, v112
  v_mfma_f32_16x16x32_bf16 a[32:35], a[180:183], v[32:35], a[32:35]
  ds_read_b64_tr_b16 a[168:169], v221 offset:0
  v_mfma_f32_16x16x32_bf16 a[36:39], a[180:183], v[40:43], 0
  v_exp_f32 v113, v113
  v_mfma_f32_16x16x32_bf16 a[36:39], a[176:179], v[8:11], a[36:39]
  ds_read_b64_tr_b16 a[170:171], v221 offset:4096
  v_cvt_pk_bf16_f32 v112, v112, v113
  v_mfma_f32_16x16x32_bf16 a[40:43], a[176:179], v[16:19], 0
  v_exp_f32 v114, v114
  v_mfma_f32_16x16x32_bf16 a[40:43], a[180:183], v[48:51], a[40:43]
  ds_read_b64_tr_b16 a[172:173], v221 offset:8192
  v_mfma_f32_16x16x32_bf16 a[44:47], a[180:183], v[56:59], 0
  s_waitcnt lgkmcnt(7)
  v_exp_f32 v115, v115
  v_mfma_f32_16x16x32_bf16 a[44:47], a[176:179], v[24:27], a[44:47]
  ds_read_b64_tr_b16 a[174:175], v221 offset:12288
  v_cvt_pk_bf16_f32 v113, v114, v115
  v_mfma_f32_16x16x32_bf16 a[48:51], a[184:187], v[0:3], 0
  v_exp_f32 v120, v120
  v_mfma_f32_16x16x32_bf16 a[48:51], a[188:191], v[32:35], a[48:51]
  ds_read_b64_tr_b16 a[176:177], v222 offset:0
  v_mfma_f32_16x16x32_bf16 a[52:55], a[188:191], v[40:43], 0
  v_exp_f32 v121, v121
  v_mfma_f32_16x16x32_bf16 a[52:55], a[184:187], v[8:11], a[52:55]
  ds_read_b64_tr_b16 a[178:179], v222 offset:4096
  v_cvt_pk_bf16_f32 v120, v120, v121
  v_mfma_f32_16x16x32_bf16 a[56:59], a[184:187], v[16:19], 0
  v_exp_f32 v122, v122
  v_mfma_f32_16x16x32_bf16 a[56:59], a[188:191], v[48:51], a[56:59]
  ds_read_b64_tr_b16 a[180:181], v222 offset:8192
  v_mfma_f32_16x16x32_bf16 a[60:63], a[188:191], v[56:59], 0
  s_waitcnt lgkmcnt(7)
  v_exp_f32 v123, v123
  v_mfma_f32_16x16x32_bf16 a[60:63], a[184:187], v[24:27], a[60:63]
  ds_read_b64_tr_b16 a[182:183], v222 offset:12288
  v_cvt_pk_bf16_f32 v121, v122, v123
  v_mfma_f32_16x16x32_bf16 a[64:67], a[160:163], v[0:3], 0
  v_exp_f32 v100, v100
  v_mfma_f32_16x16x32_bf16 a[64:67], a[164:167], v[32:35], a[64:67]
  ds_read_b64_tr_b16 a[184:185], v223 offset:0
  v_mfma_f32_16x16x32_bf16 a[68:71], a[164:167], v[40:43], 0
  v_exp_f32 v101, v101
  v_mfma_f32_16x16x32_bf16 a[68:71], a[160:163], v[8:11], a[68:71]
  ds_read_b64_tr_b16 a[186:187], v223 offset:4096
  v_cvt_pk_bf16_f32 v98, v100, v101
  v_mfma_f32_16x16x32_bf16 a[72:75], a[160:163], v[16:19], 0
  v_exp_f32 v102, v102
  v_mfma_f32_16x16x32_bf16 a[72:75], a[164:167], v[48:51], a[72:75]
  ds_read_b64_tr_b16 a[188:189], v223 offset:8192
  v_mfma_f32_16x16x32_bf16 a[76:79], a[164:167], v[56:59], 0
  s_waitcnt lgkmcnt(7)
  v_exp_f32 v103, v103
  v_mfma_f32_16x16x32_bf16 a[76:79], a[160:163], v[24:27], a[76:79]
  ds_read_b64_tr_b16 a[190:191], v223 offset:12288
  v_cvt_pk_bf16_f32 v99, v102, v103
  v_mfma_f32_16x16x32_bf16 a[80:83], a[168:171], v[0:3], 0
  s_waitcnt vmcnt(10)
  v_exp_f32 v108, v108
  v_mfma_f32_16x16x32_bf16 a[80:83], a[172:175], v[32:35], a[80:83]
  v_mfma_f32_16x16x32_bf16 a[84:87], a[172:175], v[40:43], 0
  s_barrier
  v_exp_f32 v109, v109
  v_mfma_f32_16x16x32_bf16 a[84:87], a[168:171], v[8:11], a[84:87]
  ds_read_b128 a[128:131], v212 offset:32768
  v_cvt_pk_bf16_f32 v106, v108, v109
  v_mfma_f32_16x16x32_bf16 a[88:91], a[168:171], v[16:19], 0
  v_exp_f32 v110, v110
  v_mfma_f32_16x16x32_bf16 a[88:91], a[172:175], v[48:51], a[88:91]
  ds_read_b128 a[132:135], v213 offset:32768
  v_mfma_f32_16x16x32_bf16 a[92:95], a[172:175], v[56:59], 0
  s_waitcnt lgkmcnt(6)
  v_exp_f32 v111, v111
  v_mfma_f32_16x16x32_bf16 a[92:95], a[168:171], v[24:27], a[92:95]
  ds_read_b128 a[136:139], v214 offset:32768
  v_cvt_pk_bf16_f32 v107, v110, v111
  v_mfma_f32_16x16x32_bf16 a[96:99], a[176:179], v[0:3], 0
  v_exp_f32 v116, v116
  v_mfma_f32_16x16x32_bf16 a[96:99], a[180:183], v[32:35], a[96:99]
  ds_read_b128 a[140:143], v215 offset:32768
  v_mfma_f32_16x16x32_bf16 a[100:103], a[180:183], v[40:43], 0
  v_exp_f32 v117, v117
  v_mfma_f32_16x16x32_bf16 a[100:103], a[176:179], v[8:11], a[100:103]
  v_cvt_pk_bf16_f32 v114, v116, v117
  v_mfma_f32_16x16x32_bf16 a[104:107], a[176:179], v[16:19], 0
  v_exp_f32 v118, v118
  v_mfma_f32_16x16x32_bf16 a[104:107], a[180:183], v[48:51], a[104:107]
  v_mfma_f32_16x16x32_bf16 a[108:111], a[180:183], v[56:59], 0
  s_waitcnt lgkmcnt(4)
  v_exp_f32 v119, v119
  v_mfma_f32_16x16x32_bf16 a[108:111], a[176:179], v[24:27], a[108:111]
  v_cvt_pk_bf16_f32 v115, v118, v119
  v_mfma_f32_16x16x32_bf16 a[112:115], a[184:187], v[0:3], 0
  v_exp_f32 v124, v124
  v_mfma_f32_16x16x32_bf16 a[112:115], a[188:191], v[32:35], a[112:115]
  v_mfma_f32_16x16x32_bf16 a[116:119], a[188:191], v[40:43], 0
  v_exp_f32 v125, v125
  v_mfma_f32_16x16x32_bf16 a[116:119], a[184:187], v[8:11], a[116:119]
  v_cvt_pk_bf16_f32 v122, v124, v125
  v_mfma_f32_16x16x32_bf16 a[120:123], a[184:187], v[16:19], 0
  v_exp_f32 v126, v126
  v_mfma_f32_16x16x32_bf16 a[120:123], a[188:191], v[48:51], a[120:123]
  v_mfma_f32_16x16x32_bf16 a[124:127], a[188:191], v[56:59], 0
  s_waitcnt lgkmcnt(0)
  v_exp_f32 v127, v127
  v_mfma_f32_16x16x32_bf16 a[124:127], a[184:187], v[24:27], a[124:127]
  v_cvt_pk_bf16_f32 v123, v126, v127
  v_mfma_f32_16x16x32_bf16 v[0:3], a[128:131], v[128:131], v[192:195]
  s_add_u32 m0, s28, 114688
  v_mfma_f32_16x16x32_bf16 v[0:3], a[132:135], v[132:135], v[0:3]
  ds_read_b128 a[144:147], v212 offset:36864
  v_mfma_f32_16x16x32_bf16 v[0:3], a[136:139], v[136:139], v[0:3]
  buffer_load_dwordx4 v236, s[16:19], s29 offen offset:0 lds
  v_mfma_f32_16x16x32_bf16 v[0:3], a[140:143], v[140:143], v[0:3]
  ds_read_b128 a[148:151], v213 offset:36864
  v_mfma_f32_16x16x32_bf16 v[8:11], a[140:143], v[156:159], v[196:199]
  buffer_load_dwordx4 v237, s[16:19], s29 offen offset:1024 lds
  v_mfma_f32_16x16x32_bf16 v[8:11], a[136:139], v[152:155], v[8:11]
  ds_read_b128 a[152:155], v214 offset:36864
  v_mfma_f32_16x16x32_bf16 v[8:11], a[132:135], v[148:151], v[8:11]
  buffer_load_dwordx4 v236, s[16:19], s29 offen offset:2048 lds
  v_mfma_f32_16x16x32_bf16 v[8:11], a[128:131], v[144:147], v[8:11]
  ds_read_b128 a[156:159], v215 offset:36864
  v_mfma_f32_16x16x32_bf16 v[16:19], a[128:131], v[160:163], v[200:203]
  v_exp_f32 v0, v0
  v_mfma_f32_16x16x32_bf16 v[16:19], a[132:135], v[164:167], v[16:19]
  buffer_load_dwordx4 v237, s[16:19], s29 offen offset:3072 lds
  v_mfma_f32_16x16x32_bf16 v[16:19], a[136:139], v[168:171], v[16:19]
  s_add_u32 s29, s29, 16384
  v_exp_f32 v1, v1
  v_mfma_f32_16x16x32_bf16 v[16:19], a[140:143], v[172:175], v[16:19]
  v_cvt_pk_bf16_f32 v0, v0, v1
  v_mfma_f32_16x16x32_bf16 v[24:27], a[140:143], v[188:191], v[204:207]
  s_add_u32 m0, s28, 0
  v_exp_f32 v2, v2
  v_mfma_f32_16x16x32_bf16 v[24:27], a[136:139], v[184:187], v[24:27]
  buffer_load_dwordx4 v232, s[12:15], s29 offen offset:0 lds
  v_mfma_f32_16x16x32_bf16 v[24:27], a[132:135], v[180:183], v[24:27]
  s_waitcnt lgkmcnt(0)
  v_exp_f32 v3, v3
  v_mfma_f32_16x16x32_bf16 v[24:27], a[128:131], v[176:179], v[24:27]
  v_cvt_pk_bf16_f32 v1, v2, v3
  v_mfma_f32_16x16x32_bf16 v[4:7], a[144:147], v[128:131], v[192:195]
  v_exp_f32 v8, v8
  v_mfma_f32_16x16x32_bf16 v[4:7], a[148:151], v[132:135], v[4:7]
  ds_read_b128 a[128:131], v212 offset:40960
  v_mfma_f32_16x16x32_bf16 v[4:7], a[152:155], v[136:139], v[4:7]
  v_exp_f32 v9, v9
  v_mfma_f32_16x16x32_bf16 v[4:7], a[156:159], v[140:143], v[4:7]
  ds_read_b128 a[132:135], v213 offset:40960
  v_cvt_pk_bf16_f32 v8, v8, v9
  v_mfma_f32_16x16x32_bf16 v[12:15], a[156:159], v[156:159], v[196:199]
  v_exp_f32 v10, v10
  v_mfma_f32_16x16x32_bf16 v[12:15], a[152:155], v[152:155], v[12:15]
  ds_read_b128 a[136:139], v214 offset:40960
  v_mfma_f32_16x16x32_bf16 v[12:15], a[148:151], v[148:151], v[12:15]
  v_exp_f32 v11, v11
  v_mfma_f32_16x16x32_bf16 v[12:15], a[144:147], v[144:147], v[12:15]
  ds_read_b128 a[140:143], v215 offset:40960
  v_cvt_pk_bf16_f32 v9, v10, v11
  v_mfma_f32_16x16x32_bf16 v[20:23], a[144:147], v[160:163], v[200:203]
  v_exp_f32 v16, v16
  v_mfma_f32_16x16x32_bf16 v[20:23], a[148:151], v[164:167], v[20:23]
  buffer_load_dwordx4 v233, s[12:15], s29 offen offset:1024 lds
  v_mfma_f32_16x16x32_bf16 v[20:23], a[152:155], v[168:171], v[20:23]
  v_exp_f32 v17, v17
  v_mfma_f32_16x16x32_bf16 v[20:23], a[156:159], v[172:175], v[20:23]
  v_cvt_pk_bf16_f32 v16, v16, v17
  v_mfma_f32_16x16x32_bf16 v[28:31], a[156:159], v[188:191], v[204:207]
  v_exp_f32 v18, v18
  v_mfma_f32_16x16x32_bf16 v[28:31], a[152:155], v[184:187], v[28:31]
  buffer_load_dwordx4 v234, s[12:15], s29 offen offset:2048 lds
  v_mfma_f32_16x16x32_bf16 v[28:31], a[148:151], v[180:183], v[28:31]
  s_waitcnt lgkmcnt(0)
  v_exp_f32 v19, v19
  v_mfma_f32_16x16x32_bf16 v[28:31], a[144:147], v[176:179], v[28:31]
  v_cvt_pk_bf16_f32 v17, v18, v19
  v_mfma_f32_16x16x32_bf16 v[32:35], a[128:131], v[128:131], v[192:195]
  v_exp_f32 v24, v24
  v_mfma_f32_16x16x32_bf16 v[32:35], a[132:135], v[132:135], v[32:35]
  ds_read_b128 a[144:147], v212 offset:45056
  v_mfma_f32_16x16x32_bf16 v[32:35], a[136:139], v[136:139], v[32:35]
  v_exp_f32 v25, v25
  v_mfma_f32_16x16x32_bf16 v[32:35], a[140:143], v[140:143], v[32:35]
  ds_read_b128 a[148:151], v213 offset:45056
  v_cvt_pk_bf16_f32 v24, v24, v25
  v_mfma_f32_16x16x32_bf16 v[40:43], a[140:143], v[156:159], v[196:199]
  v_exp_f32 v26, v26
  v_mfma_f32_16x16x32_bf16 v[40:43], a[136:139], v[152:155], v[40:43]
  ds_read_b128 a[152:155], v214 offset:45056
  v_mfma_f32_16x16x32_bf16 v[40:43], a[132:135], v[148:151], v[40:43]
  v_exp_f32 v27, v27
  v_mfma_f32_16x16x32_bf16 v[40:43], a[128:131], v[144:147], v[40:43]
  ds_read_b128 a[156:159], v215 offset:45056
  v_cvt_pk_bf16_f32 v25, v26, v27
  v_mfma_f32_16x16x32_bf16 v[48:51], a[128:131], v[160:163], v[200:203]
  v_exp_f32 v4, v4
  v_mfma_f32_16x16x32_bf16 v[48:51], a[132:135], v[164:167], v[48:51]
  buffer_load_dwordx4 v235, s[12:15], s29 offen offset:3072 lds
  v_mfma_f32_16x16x32_bf16 v[48:51], a[136:139], v[168:171], v[48:51]
  v_exp_f32 v5, v5
  v_mfma_f32_16x16x32_bf16 v[48:51], a[140:143], v[172:175], v[48:51]
  v_cvt_pk_bf16_f32 v2, v4, v5
  v_mfma_f32_16x16x32_bf16 v[56:59], a[140:143], v[188:191], v[204:207]
  v_exp_f32 v6, v6
  v_mfma_f32_16x16x32_bf16 v[56:59], a[136:139], v[184:187], v[56:59]
  s_add_u32 m0, s50, 1024
  v_mfma_f32_16x16x32_bf16 v[56:59], a[132:135], v[180:183], v[56:59]
  s_waitcnt lgkmcnt(0)
  v_exp_f32 v7, v7
  v_mfma_f32_16x16x32_bf16 v[56:59], a[128:131], v[176:179], v[56:59]
  buffer_load_dwordx4 v226, s[20:23], s35 offen lds
  v_cvt_pk_bf16_f32 v3, v6, v7
  v_mfma_f32_16x16x32_bf16 v[36:39], a[144:147], v[128:131], v[192:195]
  v_exp_f32 v12, v12
  v_mfma_f32_16x16x32_bf16 v[36:39], a[148:151], v[132:135], v[36:39]
  ds_read_b64_tr_b16 a[160:161], v216 offset:16384
  v_mfma_f32_16x16x32_bf16 v[36:39], a[152:155], v[136:139], v[36:39]
  v_exp_f32 v13, v13
  v_mfma_f32_16x16x32_bf16 v[36:39], a[156:159], v[140:143], v[36:39]
  ds_read_b64_tr_b16 a[162:163], v216 offset:20480
  v_cvt_pk_bf16_f32 v10, v12, v13
  v_mfma_f32_16x16x32_bf16 v[44:47], a[156:159], v[156:159], v[196:199]
  v_exp_f32 v14, v14
  v_mfma_f32_16x16x32_bf16 v[44:47], a[152:155], v[152:155], v[44:47]
  ds_read_b64_tr_b16 a[164:165], v216 offset:24576
  v_mfma_f32_16x16x32_bf16 v[44:47], a[148:151], v[148:151], v[44:47]
  v_exp_f32 v15, v15
  v_mfma_f32_16x16x32_bf16 v[44:47], a[144:147], v[144:147], v[44:47]
  ds_read_b64_tr_b16 a[166:167], v216 offset:28672
  v_cvt_pk_bf16_f32 v11, v14, v15
  v_mfma_f32_16x16x32_bf16 v[52:55], a[144:147], v[160:163], v[200:203]
  v_exp_f32 v20, v20
  v_mfma_f32_16x16x32_bf16 v[52:55], a[148:151], v[164:167], v[52:55]
  ds_read_b64_tr_b16 a[168:169], v217 offset:16384
  v_mfma_f32_16x16x32_bf16 v[52:55], a[152:155], v[168:171], v[52:55]
  v_exp_f32 v21, v21
  v_mfma_f32_16x16x32_bf16 v[52:55], a[156:159], v[172:175], v[52:55]
  ds_read_b64_tr_b16 a[170:171], v217 offset:20480
  v_cvt_pk_bf16_f32 v18, v20, v21
  v_mfma_f32_16x16x32_bf16 v[60:63], a[156:159], v[188:191], v[204:207]
  v_exp_f32 v22, v22
  v_mfma_f32_16x16x32_bf16 v[60:63], a[152:155], v[184:187], v[60:63]
  ds_read_b64_tr_b16 a[172:173], v217 offset:24576
  v_mfma_f32_16x16x32_bf16 v[60:63], a[148:151], v[180:183], v[60:63]
  v_exp_f32 v23, v23
  v_mfma_f32_16x16x32_bf16 v[60:63], a[144:147], v[176:179], v[60:63]
  ds_read_b64_tr_b16 a[174:175], v217 offset:28672
  v_cvt_pk_bf16_f32 v19, v22, v23
  v_mfma_f32_16x16x32_bf16 a[192:195], a[208:211], v[64:67], a[192:195]
  v_exp_f32 v28, v28
  v_mfma_f32_16x16x32_bf16 a[192:195], a[208:211], v[96:99], a[192:195]
  ds_read_b64_tr_b16 a[176:177], v218 offset:16384
  v_mfma_f32_16x16x32_bf16 a[196:199], a[208:211], v[72:75], a[196:199]
  v_exp_f32 v29, v29
  v_mfma_f32_16x16x32_bf16 a[196:199], a[208:211], v[104:107], a[196:199]
  ds_read_b64_tr_b16 a[178:179], v218 offset:20480
  v_cvt_pk_bf16_f32 v26, v28, v29
  v_mfma_f32_16x16x32_bf16 a[200:203], a[208:211], v[80:83], a[200:203]
  v_exp_f32 v30, v30
  v_mfma_f32_16x16x32_bf16 a[200:203], a[208:211], v[112:115], a[200:203]
  ds_read_b64_tr_b16 a[180:181], v218 offset:24576
  v_mfma_f32_16x16x32_bf16 a[204:207], a[208:211], v[88:91], a[204:207]
  s_waitcnt lgkmcnt(7)
  v_exp_f32 v31, v31
  v_mfma_f32_16x16x32_bf16 a[204:207], a[208:211], v[120:123], a[204:207]
  ds_read_b64_tr_b16 a[182:183], v218 offset:28672
  v_cvt_pk_bf16_f32 v27, v30, v31
  v_mfma_f32_16x16x32_bf16 a[0:3], a[160:163], v[64:67], a[0:3]
  v_exp_f32 v32, v32
  v_mfma_f32_16x16x32_bf16 a[0:3], a[164:167], v[96:99], a[0:3]
  ds_read_b64_tr_b16 a[184:185], v219 offset:16384
  v_mfma_f32_16x16x32_bf16 a[4:7], a[164:167], v[104:107], a[4:7]
  v_exp_f32 v33, v33
  v_mfma_f32_16x16x32_bf16 a[4:7], a[160:163], v[72:75], a[4:7]
  ds_read_b64_tr_b16 a[186:187], v219 offset:20480
  v_cvt_pk_bf16_f32 v32, v32, v33
  v_mfma_f32_16x16x32_bf16 a[8:11], a[160:163], v[80:83], a[8:11]
  v_exp_f32 v34, v34
  v_mfma_f32_16x16x32_bf16 a[8:11], a[164:167], v[112:115], a[8:11]
  ds_read_b64_tr_b16 a[188:189], v219 offset:24576
  v_mfma_f32_16x16x32_bf16 a[12:15], a[164:167], v[120:123], a[12:15]
  s_waitcnt lgkmcnt(7)
  v_exp_f32 v35, v35
  v_mfma_f32_16x16x32_bf16 a[12:15], a[160:163], v[88:91], a[12:15]
  ds_read_b64_tr_b16 a[190:191], v219 offset:28672
  v_cvt_pk_bf16_f32 v33, v34, v35
  v_mfma_f32_16x16x32_bf16 a[16:19], a[168:171], v[64:67], a[16:19]
  v_exp_f32 v40, v40
  v_mfma_f32_16x16x32_bf16 a[16:19], a[172:175], v[96:99], a[16:19]
  ds_read_b64_tr_b16 a[160:161], v220 offset:16384
  v_mfma_f32_16x16x32_bf16 a[20:23], a[172:175], v[104:107], a[20:23]
  v_exp_f32 v41, v41
  v_mfma_f32_16x16x32_bf16 a[20:23], a[168:171], v[72:75], a[20:23]
  ds_read_b64_tr_b16 a[162:163], v220 offset:20480
  v_cvt_pk_bf16_f32 v40, v40, v41
  v_mfma_f32_16x16x32_bf16 a[24:27], a[168:171], v[80:83], a[24:27]
  v_exp_f32 v42, v42
  v_mfma_f32_16x16x32_bf16 a[24:27], a[172:175], v[112:115], a[24:27]
  ds_read_b64_tr_b16 a[164:165], v220 offset:24576
  v_mfma_f32_16x16x32_bf16 a[28:31], a[172:175], v[120:123], a[28:31]
  s_waitcnt lgkmcnt(7)
  v_exp_f32 v43, v43
  v_mfma_f32_16x16x32_bf16 a[28:31], a[168:171], v[88:91], a[28:31]
  ds_read_b64_tr_b16 a[166:167], v220 offset:28672
  v_cvt_pk_bf16_f32 v41, v42, v43
  v_mfma_f32_16x16x32_bf16 a[32:35], a[176:179], v[64:67], a[32:35]
  v_exp_f32 v48, v48
  v_mfma_f32_16x16x32_bf16 a[32:35], a[180:183], v[96:99], a[32:35]
  ds_read_b64_tr_b16 a[168:169], v221 offset:16384
  v_mfma_f32_16x16x32_bf16 a[36:39], a[180:183], v[104:107], a[36:39]
  v_exp_f32 v49, v49
  v_mfma_f32_16x16x32_bf16 a[36:39], a[176:179], v[72:75], a[36:39]
  ds_read_b64_tr_b16 a[170:171], v221 offset:20480
  v_cvt_pk_bf16_f32 v48, v48, v49
  v_mfma_f32_16x16x32_bf16 a[40:43], a[176:179], v[80:83], a[40:43]
  v_exp_f32 v50, v50
  v_mfma_f32_16x16x32_bf16 a[40:43], a[180:183], v[112:115], a[40:43]
  ds_read_b64_tr_b16 a[172:173], v221 offset:24576
  v_mfma_f32_16x16x32_bf16 a[44:47], a[180:183], v[120:123], a[44:47]
  s_waitcnt lgkmcnt(7)
  v_exp_f32 v51, v51
  v_mfma_f32_16x16x32_bf16 a[44:47], a[176:179], v[88:91], a[44:47]
  ds_read_b64_tr_b16 a[174:175], v221 offset:28672
  v_cvt_pk_bf16_f32 v49, v50, v51
  v_mfma_f32_16x16x32_bf16 a[48:51], a[184:187], v[64:67], a[48:51]
  v_exp_f32 v56, v56
  v_mfma_f32_16x16x32_bf16 a[48:51], a[188:191], v[96:99], a[48:51]
  ds_read_b64_tr_b16 a[176:177], v222 offset:16384
  v_mfma_f32_16x16x32_bf16 a[52:55], a[188:191], v[104:107], a[52:55]
  v_exp_f32 v57, v57
  v_mfma_f32_16x16x32_bf16 a[52:55], a[184:187], v[72:75], a[52:55]
  ds_read_b64_tr_b16 a[178:179], v222 offset:20480
  v_cvt_pk_bf16_f32 v56, v56, v57
  v_mfma_f32_16x16x32_bf16 a[56:59], a[184:187], v[80:83], a[56:59]
  v_exp_f32 v58, v58
  v_mfma_f32_16x16x32_bf16 a[56:59], a[188:191], v[112:115], a[56:59]
  ds_read_b64_tr_b16 a[180:181], v222 offset:24576
  v_mfma_f32_16x16x32_bf16 a[60:63], a[188:191], v[120:123], a[60:63]
  s_waitcnt lgkmcnt(7)
  v_exp_f32 v59, v59
  v_mfma_f32_16x16x32_bf16 a[60:63], a[184:187], v[88:91], a[60:63]
  ds_read_b64_tr_b16 a[182:183], v222 offset:28672
  v_cvt_pk_bf16_f32 v57, v58, v59
  v_mfma_f32_16x16x32_bf16 a[64:67], a[160:163], v[64:67], a[64:67]
  v_exp_f32 v36, v36
  v_mfma_f32_16x16x32_bf16 a[64:67], a[164:167], v[96:99], a[64:67]
  ds_read_b64_tr_b16 a[184:185], v223 offset:16384
  v_mfma_f32_16x16x32_bf16 a[68:71], a[164:167], v[104:107], a[68:71]
  v_exp_f32 v37, v37
  v_mfma_f32_16x16x32_bf16 a[68:71], a[160:163], v[72:75], a[68:71]
  ds_read_b64_tr_b16 a[186:187], v223 offset:20480
  v_cvt_pk_bf16_f32 v34, v36, v37
  v_mfma_f32_16x16x32_bf16 a[72:75], a[160:163], v[80:83], a[72:75]
  v_exp_f32 v38, v38
  v_mfma_f32_16x16x32_bf16 a[72:75], a[164:167], v[112:115], a[72:75]
  ds_read_b64_tr_b16 a[188:189], v223 offset:24576
  v_mfma_f32_16x16x32_bf16 a[76:79], a[164:167], v[120:123], a[76:79]
  s_waitcnt lgkmcnt(7)
  v_exp_f32 v39, v39
  v_mfma_f32_16x16x32_bf16 a[76:79], a[160:163], v[88:91], a[76:79]
  ds_read_b64_tr_b16 a[190:191], v223 offset:28672
  v_cvt_pk_bf16_f32 v35, v38, v39
  v_mfma_f32_16x16x32_bf16 a[80:83], a[168:171], v[64:67], a[80:83]
  s_waitcnt vmcnt(10)
  v_exp_f32 v44, v44
  v_mfma_f32_16x16x32_bf16 a[80:83], a[172:175], v[96:99], a[80:83]
  v_mfma_f32_16x16x32_bf16 a[84:87], a[172:175], v[104:107], a[84:87]
  s_barrier
  v_exp_f32 v45, v45
  v_mfma_f32_16x16x32_bf16 a[84:87], a[168:171], v[72:75], a[84:87]
  ds_read_b128 a[128:131], v212 offset:49152
  v_cvt_pk_bf16_f32 v42, v44, v45
  v_mfma_f32_16x16x32_bf16 a[88:91], a[168:171], v[80:83], a[88:91]
  v_exp_f32 v46, v46
  v_mfma_f32_16x16x32_bf16 a[88:91], a[172:175], v[112:115], a[88:91]
  ds_read_b128 a[132:135], v213 offset:49152
  v_mfma_f32_16x16x32_bf16 a[92:95], a[172:175], v[120:123], a[92:95]
  s_waitcnt lgkmcnt(6)
  v_exp_f32 v47, v47
  v_mfma_f32_16x16x32_bf16 a[92:95], a[168:171], v[88:91], a[92:95]
  ds_read_b128 a[136:139], v214 offset:49152
  v_cvt_pk_bf16_f32 v43, v46, v47
  v_mfma_f32_16x16x32_bf16 a[96:99], a[176:179], v[64:67], a[96:99]
  v_exp_f32 v52, v52
  v_mfma_f32_16x16x32_bf16 a[96:99], a[180:183], v[96:99], a[96:99]
  ds_read_b128 a[140:143], v215 offset:49152
  v_mfma_f32_16x16x32_bf16 a[100:103], a[180:183], v[104:107], a[100:103]
  v_exp_f32 v53, v53
  v_mfma_f32_16x16x32_bf16 a[100:103], a[176:179], v[72:75], a[100:103]
  v_cvt_pk_bf16_f32 v50, v52, v53
  v_mfma_f32_16x16x32_bf16 a[104:107], a[176:179], v[80:83], a[104:107]
  v_exp_f32 v54, v54
  v_mfma_f32_16x16x32_bf16 a[104:107], a[180:183], v[112:115], a[104:107]
  v_mfma_f32_16x16x32_bf16 a[108:111], a[180:183], v[120:123], a[108:111]
  s_waitcnt lgkmcnt(4)
  v_exp_f32 v55, v55
  v_mfma_f32_16x16x32_bf16 a[108:111], a[176:179], v[88:91], a[108:111]
  v_cvt_pk_bf16_f32 v51, v54, v55
  v_mfma_f32_16x16x32_bf16 a[112:115], a[184:187], v[64:67], a[112:115]
  v_exp_f32 v60, v60
  v_mfma_f32_16x16x32_bf16 a[112:115], a[188:191], v[96:99], a[112:115]
  v_mfma_f32_16x16x32_bf16 a[116:119], a[188:191], v[104:107], a[116:119]
  v_exp_f32 v61, v61
  v_mfma_f32_16x16x32_bf16 a[116:119], a[184:187], v[72:75], a[116:119]
  v_cvt_pk_bf16_f32 v58, v60, v61
  v_mfma_f32_16x16x32_bf16 a[120:123], a[184:187], v[80:83], a[120:123]
  v_exp_f32 v62, v62
  v_mfma_f32_16x16x32_bf16 a[120:123], a[188:191], v[112:115], a[120:123]
  v_mfma_f32_16x16x32_bf16 a[124:127], a[188:191], v[120:123], a[124:127]
  s_waitcnt lgkmcnt(0)
  v_exp_f32 v63, v63
  v_mfma_f32_16x16x32_bf16 a[124:127], a[184:187], v[88:91], a[124:127]
  v_cvt_pk_bf16_f32 v59, v62, v63
  v_mfma_f32_16x16x32_bf16 v[64:67], a[128:131], v[128:131], v[192:195]
  s_add_u32 m0, s28, 65536
  v_mfma_f32_16x16x32_bf16 v[64:67], a[132:135], v[132:135], v[64:67]
  ds_read_b128 a[144:147], v212 offset:53248
  v_mfma_f32_16x16x32_bf16 v[64:67], a[136:139], v[136:139], v[64:67]
  buffer_load_dwordx4 v236, s[16:19], s29 offen offset:0 lds
  v_mfma_f32_16x16x32_bf16 v[64:67], a[140:143], v[140:143], v[64:67]
  ds_read_b128 a[148:151], v213 offset:53248
  v_mfma_f32_16x16x32_bf16 v[72:75], a[140:143], v[156:159], v[196:199]
  buffer_load_dwordx4 v237, s[16:19], s29 offen offset:1024 lds
  v_mfma_f32_16x16x32_bf16 v[72:75], a[136:139], v[152:155], v[72:75]
  ds_read_b128 a[152:155], v214 offset:53248
  v_mfma_f32_16x16x32_bf16 v[72:75], a[132:135], v[148:151], v[72:75]
  buffer_load_dwordx4 v236, s[16:19], s29 offen offset:2048 lds
  v_mfma_f32_16x16x32_bf16 v[72:75], a[128:131], v[144:147], v[72:75]
  ds_read_b128 a[156:159], v215 offset:53248
  v_mfma_f32_16x16x32_bf16 v[80:83], a[128:131], v[160:163], v[200:203]
  v_exp_f32 v64, v64
  v_mfma_f32_16x16x32_bf16 v[80:83], a[132:135], v[164:167], v[80:83]
  buffer_load_dwordx4 v237, s[16:19], s29 offen offset:3072 lds
  v_mfma_f32_16x16x32_bf16 v[80:83], a[136:139], v[168:171], v[80:83]
  s_add_u32 s29, s29, 16384
  v_exp_f32 v65, v65
  v_mfma_f32_16x16x32_bf16 v[80:83], a[140:143], v[172:175], v[80:83]
  v_cvt_pk_bf16_f32 v64, v64, v65
  v_mfma_f32_16x16x32_bf16 v[88:91], a[140:143], v[188:191], v[204:207]
  s_add_u32 m0, s28, 16384
  v_exp_f32 v66, v66
  v_mfma_f32_16x16x32_bf16 v[88:91], a[136:139], v[184:187], v[88:91]
  buffer_load_dwordx4 v232, s[12:15], s29 offen offset:0 lds
  v_mfma_f32_16x16x32_bf16 v[88:91], a[132:135], v[180:183], v[88:91]
  s_waitcnt lgkmcnt(0)
  v_exp_f32 v67, v67
  v_mfma_f32_16x16x32_bf16 v[88:91], a[128:131], v[176:179], v[88:91]
  v_cvt_pk_bf16_f32 v65, v66, v67
  v_mfma_f32_16x16x32_bf16 v[68:71], a[144:147], v[128:131], v[192:195]
  v_exp_f32 v72, v72
  v_mfma_f32_16x16x32_bf16 v[68:71], a[148:151], v[132:135], v[68:71]
  ds_read_b128 a[128:131], v212 offset:57344
  v_mfma_f32_16x16x32_bf16 v[68:71], a[152:155], v[136:139], v[68:71]
  v_exp_f32 v73, v73
  v_mfma_f32_16x16x32_bf16 v[68:71], a[156:159], v[140:143], v[68:71]
  ds_read_b128 a[132:135], v213 offset:57344
  v_cvt_pk_bf16_f32 v72, v72, v73
  v_mfma_f32_16x16x32_bf16 v[76:79], a[156:159], v[156:159], v[196:199]
  v_exp_f32 v74, v74
  v_mfma_f32_16x16x32_bf16 v[76:79], a[152:155], v[152:155], v[76:79]
  ds_read_b128 a[136:139], v214 offset:57344
  v_mfma_f32_16x16x32_bf16 v[76:79], a[148:151], v[148:151], v[76:79]
  v_exp_f32 v75, v75
  v_mfma_f32_16x16x32_bf16 v[76:79], a[144:147], v[144:147], v[76:79]
  ds_read_b128 a[140:143], v215 offset:57344
  v_cvt_pk_bf16_f32 v73, v74, v75
  v_mfma_f32_16x16x32_bf16 v[84:87], a[144:147], v[160:163], v[200:203]
  v_exp_f32 v80, v80
  v_mfma_f32_16x16x32_bf16 v[84:87], a[148:151], v[164:167], v[84:87]
  buffer_load_dwordx4 v233, s[12:15], s29 offen offset:1024 lds
  v_mfma_f32_16x16x32_bf16 v[84:87], a[152:155], v[168:171], v[84:87]
  v_exp_f32 v81, v81
  v_mfma_f32_16x16x32_bf16 v[84:87], a[156:159], v[172:175], v[84:87]
  v_cvt_pk_bf16_f32 v80, v80, v81
  v_mfma_f32_16x16x32_bf16 v[92:95], a[156:159], v[188:191], v[204:207]
  v_exp_f32 v82, v82
  v_mfma_f32_16x16x32_bf16 v[92:95], a[152:155], v[184:187], v[92:95]
  buffer_load_dwordx4 v234, s[12:15], s29 offen offset:2048 lds
  v_mfma_f32_16x16x32_bf16 v[92:95], a[148:151], v[180:183], v[92:95]
  s_waitcnt lgkmcnt(0)
  v_exp_f32 v83, v83
  v_mfma_f32_16x16x32_bf16 v[92:95], a[144:147], v[176:179], v[92:95]
  v_cvt_pk_bf16_f32 v81, v82, v83
  v_mfma_f32_16x16x32_bf16 v[96:99], a[128:131], v[128:131], v[192:195]
  v_exp_f32 v88, v88
  v_mfma_f32_16x16x32_bf16 v[96:99], a[132:135], v[132:135], v[96:99]
  ds_read_b128 a[144:147], v212 offset:61440
  v_mfma_f32_16x16x32_bf16 v[96:99], a[136:139], v[136:139], v[96:99]
  v_exp_f32 v89, v89
  v_mfma_f32_16x16x32_bf16 v[96:99], a[140:143], v[140:143], v[96:99]
  ds_read_b128 a[148:151], v213 offset:61440
  v_cvt_pk_bf16_f32 v88, v88, v89
  v_mfma_f32_16x16x32_bf16 v[104:107], a[140:143], v[156:159], v[196:199]
  v_exp_f32 v90, v90
  v_mfma_f32_16x16x32_bf16 v[104:107], a[136:139], v[152:155], v[104:107]
  ds_read_b128 a[152:155], v214 offset:61440
  v_mfma_f32_16x16x32_bf16 v[104:107], a[132:135], v[148:151], v[104:107]
  v_exp_f32 v91, v91
  v_mfma_f32_16x16x32_bf16 v[104:107], a[128:131], v[144:147], v[104:107]
  ds_read_b128 a[156:159], v215 offset:61440
  v_cvt_pk_bf16_f32 v89, v90, v91
  v_mfma_f32_16x16x32_bf16 v[112:115], a[128:131], v[160:163], v[200:203]
  v_exp_f32 v68, v68
  v_mfma_f32_16x16x32_bf16 v[112:115], a[132:135], v[164:167], v[112:115]
  buffer_load_dwordx4 v235, s[12:15], s29 offen offset:3072 lds
  v_mfma_f32_16x16x32_bf16 v[112:115], a[136:139], v[168:171], v[112:115]
  v_exp_f32 v69, v69
  v_mfma_f32_16x16x32_bf16 v[112:115], a[140:143], v[172:175], v[112:115]
  v_cvt_pk_bf16_f32 v66, v68, v69
  v_mfma_f32_16x16x32_bf16 v[120:123], a[140:143], v[188:191], v[204:207]
  v_exp_f32 v70, v70
  v_mfma_f32_16x16x32_bf16 v[120:123], a[136:139], v[184:187], v[120:123]
  s_add_u32 m0, s50, 4096
  v_mfma_f32_16x16x32_bf16 v[120:123], a[132:135], v[180:183], v[120:123]
  s_waitcnt lgkmcnt(0)
  v_exp_f32 v71, v71
  v_mfma_f32_16x16x32_bf16 v[120:123], a[128:131], v[176:179], v[120:123]
  buffer_load_dwordx4 v226, s[44:47], s35 offen lds
  s_add_u32 s35, s35, 221184
  v_cvt_pk_bf16_f32 v67, v70, v71
  v_mfma_f32_16x16x32_bf16 v[100:103], a[144:147], v[128:131], v[192:195]
  v_exp_f32 v76, v76
  v_mfma_f32_16x16x32_bf16 v[100:103], a[148:151], v[132:135], v[100:103]
  ds_read_b64_tr_b16 a[160:161], v216 offset:32768
  v_mfma_f32_16x16x32_bf16 v[100:103], a[152:155], v[136:139], v[100:103]
  v_exp_f32 v77, v77
  v_mfma_f32_16x16x32_bf16 v[100:103], a[156:159], v[140:143], v[100:103]
  ds_read_b64_tr_b16 a[162:163], v216 offset:36864
  v_cvt_pk_bf16_f32 v74, v76, v77
  v_mfma_f32_16x16x32_bf16 v[108:111], a[156:159], v[156:159], v[196:199]
  v_exp_f32 v78, v78
  v_mfma_f32_16x16x32_bf16 v[108:111], a[152:155], v[152:155], v[108:111]
  ds_read_b64_tr_b16 a[164:165], v216 offset:40960
  v_mfma_f32_16x16x32_bf16 v[108:111], a[148:151], v[148:151], v[108:111]
  v_exp_f32 v79, v79
  v_mfma_f32_16x16x32_bf16 v[108:111], a[144:147], v[144:147], v[108:111]
  ds_read_b64_tr_b16 a[166:167], v216 offset:45056
  v_cvt_pk_bf16_f32 v75, v78, v79
  v_mfma_f32_16x16x32_bf16 v[116:119], a[144:147], v[160:163], v[200:203]
  v_exp_f32 v84, v84
  v_mfma_f32_16x16x32_bf16 v[116:119], a[148:151], v[164:167], v[116:119]
  ds_read_b64_tr_b16 a[168:169], v217 offset:32768
  v_mfma_f32_16x16x32_bf16 v[116:119], a[152:155], v[168:171], v[116:119]
  v_exp_f32 v85, v85
  v_mfma_f32_16x16x32_bf16 v[116:119], a[156:159], v[172:175], v[116:119]
  ds_read_b64_tr_b16 a[170:171], v217 offset:36864
  v_cvt_pk_bf16_f32 v82, v84, v85
  v_mfma_f32_16x16x32_bf16 v[124:127], a[156:159], v[188:191], v[204:207]
  v_exp_f32 v86, v86
  v_mfma_f32_16x16x32_bf16 v[124:127], a[152:155], v[184:187], v[124:127]
  ds_read_b64_tr_b16 a[172:173], v217 offset:40960
  v_mfma_f32_16x16x32_bf16 v[124:127], a[148:151], v[180:183], v[124:127]
  v_exp_f32 v87, v87
  v_mfma_f32_16x16x32_bf16 v[124:127], a[144:147], v[176:179], v[124:127]
  ds_read_b64_tr_b16 a[174:175], v217 offset:45056
  v_cvt_pk_bf16_f32 v83, v86, v87
  v_mfma_f32_16x16x32_bf16 a[192:195], a[208:211], v[0:3], a[192:195]
  v_exp_f32 v92, v92
  v_mfma_f32_16x16x32_bf16 a[192:195], a[208:211], v[32:35], a[192:195]
  ds_read_b64_tr_b16 a[176:177], v218 offset:32768
  v_mfma_f32_16x16x32_bf16 a[196:199], a[208:211], v[8:11], a[196:199]
  v_exp_f32 v93, v93
  v_mfma_f32_16x16x32_bf16 a[196:199], a[208:211], v[40:43], a[196:199]
  ds_read_b64_tr_b16 a[178:179], v218 offset:36864
  v_cvt_pk_bf16_f32 v90, v92, v93
  v_mfma_f32_16x16x32_bf16 a[200:203], a[208:211], v[16:19], a[200:203]
  v_exp_f32 v94, v94
  v_mfma_f32_16x16x32_bf16 a[200:203], a[208:211], v[48:51], a[200:203]
  ds_read_b64_tr_b16 a[180:181], v218 offset:40960
  v_mfma_f32_16x16x32_bf16 a[204:207], a[208:211], v[24:27], a[204:207]
  s_waitcnt lgkmcnt(7)
  v_exp_f32 v95, v95
  v_mfma_f32_16x16x32_bf16 a[204:207], a[208:211], v[56:59], a[204:207]
  ds_read_b64_tr_b16 a[182:183], v218 offset:45056
  v_cvt_pk_bf16_f32 v91, v94, v95
  v_mfma_f32_16x16x32_bf16 a[0:3], a[160:163], v[0:3], a[0:3]
  v_exp_f32 v96, v96
  v_mfma_f32_16x16x32_bf16 a[0:3], a[164:167], v[32:35], a[0:3]
  ds_read_b64_tr_b16 a[184:185], v219 offset:32768
  v_mfma_f32_16x16x32_bf16 a[4:7], a[164:167], v[40:43], a[4:7]
  v_exp_f32 v97, v97
  v_mfma_f32_16x16x32_bf16 a[4:7], a[160:163], v[8:11], a[4:7]
  ds_read_b64_tr_b16 a[186:187], v219 offset:36864
  v_cvt_pk_bf16_f32 v96, v96, v97
  v_mfma_f32_16x16x32_bf16 a[8:11], a[160:163], v[16:19], a[8:11]
  v_exp_f32 v98, v98
  v_mfma_f32_16x16x32_bf16 a[8:11], a[164:167], v[48:51], a[8:11]
  ds_read_b64_tr_b16 a[188:189], v219 offset:40960
  v_mfma_f32_16x16x32_bf16 a[12:15], a[164:167], v[56:59], a[12:15]
  s_waitcnt lgkmcnt(7)
  v_exp_f32 v99, v99
  v_mfma_f32_16x16x32_bf16 a[12:15], a[160:163], v[24:27], a[12:15]
  ds_read_b64_tr_b16 a[190:191], v219 offset:45056
  v_cvt_pk_bf16_f32 v97, v98, v99
  v_mfma_f32_16x16x32_bf16 a[16:19], a[168:171], v[0:3], a[16:19]
  v_exp_f32 v104, v104
  v_mfma_f32_16x16x32_bf16 a[16:19], a[172:175], v[32:35], a[16:19]
  ds_read_b64_tr_b16 a[160:161], v220 offset:32768
  v_mfma_f32_16x16x32_bf16 a[20:23], a[172:175], v[40:43], a[20:23]
  v_exp_f32 v105, v105
  v_mfma_f32_16x16x32_bf16 a[20:23], a[168:171], v[8:11], a[20:23]
  ds_read_b64_tr_b16 a[162:163], v220 offset:36864
  v_cvt_pk_bf16_f32 v104, v104, v105
  v_mfma_f32_16x16x32_bf16 a[24:27], a[168:171], v[16:19], a[24:27]
  v_exp_f32 v106, v106
  v_mfma_f32_16x16x32_bf16 a[24:27], a[172:175], v[48:51], a[24:27]
  ds_read_b64_tr_b16 a[164:165], v220 offset:40960
  v_mfma_f32_16x16x32_bf16 a[28:31], a[172:175], v[56:59], a[28:31]
  s_waitcnt lgkmcnt(7)
  v_exp_f32 v107, v107
  v_mfma_f32_16x16x32_bf16 a[28:31], a[168:171], v[24:27], a[28:31]
  ds_read_b64_tr_b16 a[166:167], v220 offset:45056
  v_cvt_pk_bf16_f32 v105, v106, v107
  v_mfma_f32_16x16x32_bf16 a[32:35], a[176:179], v[0:3], a[32:35]
  v_exp_f32 v112, v112
  v_mfma_f32_16x16x32_bf16 a[32:35], a[180:183], v[32:35], a[32:35]
  ds_read_b64_tr_b16 a[168:169], v221 offset:32768
  v_mfma_f32_16x16x32_bf16 a[36:39], a[180:183], v[40:43], a[36:39]
  v_exp_f32 v113, v113
  v_mfma_f32_16x16x32_bf16 a[36:39], a[176:179], v[8:11], a[36:39]
  ds_read_b64_tr_b16 a[170:171], v221 offset:36864
  v_cvt_pk_bf16_f32 v112, v112, v113
  v_mfma_f32_16x16x32_bf16 a[40:43], a[176:179], v[16:19], a[40:43]
  v_exp_f32 v114, v114
  v_mfma_f32_16x16x32_bf16 a[40:43], a[180:183], v[48:51], a[40:43]
  ds_read_b64_tr_b16 a[172:173], v221 offset:40960
  v_mfma_f32_16x16x32_bf16 a[44:47], a[180:183], v[56:59], a[44:47]
  s_waitcnt lgkmcnt(7)
  v_exp_f32 v115, v115
  v_mfma_f32_16x16x32_bf16 a[44:47], a[176:179], v[24:27], a[44:47]
  ds_read_b64_tr_b16 a[174:175], v221 offset:45056
  v_cvt_pk_bf16_f32 v113, v114, v115
  v_mfma_f32_16x16x32_bf16 a[48:51], a[184:187], v[0:3], a[48:51]
  v_exp_f32 v120, v120
  v_mfma_f32_16x16x32_bf16 a[48:51], a[188:191], v[32:35], a[48:51]
  ds_read_b64_tr_b16 a[176:177], v222 offset:32768
  v_mfma_f32_16x16x32_bf16 a[52:55], a[188:191], v[40:43], a[52:55]
  v_exp_f32 v121, v121
  v_mfma_f32_16x16x32_bf16 a[52:55], a[184:187], v[8:11], a[52:55]
  ds_read_b64_tr_b16 a[178:179], v222 offset:36864
  v_cvt_pk_bf16_f32 v120, v120, v121
  v_mfma_f32_16x16x32_bf16 a[56:59], a[184:187], v[16:19], a[56:59]
  v_exp_f32 v122, v122
  v_mfma_f32_16x16x32_bf16 a[56:59], a[188:191], v[48:51], a[56:59]
  ds_read_b64_tr_b16 a[180:181], v222 offset:40960
  v_mfma_f32_16x16x32_bf16 a[60:63], a[188:191], v[56:59], a[60:63]
  s_waitcnt lgkmcnt(7)
  v_exp_f32 v123, v123
  v_mfma_f32_16x16x32_bf16 a[60:63], a[184:187], v[24:27], a[60:63]
  ds_read_b64_tr_b16 a[182:183], v222 offset:45056
  v_cvt_pk_bf16_f32 v121, v122, v123
  v_mfma_f32_16x16x32_bf16 a[64:67], a[160:163], v[0:3], a[64:67]
  v_exp_f32 v100, v100
  v_mfma_f32_16x16x32_bf16 a[64:67], a[164:167], v[32:35], a[64:67]
  ds_read_b64_tr_b16 a[184:185], v223 offset:32768
  v_mfma_f32_16x16x32_bf16 a[68:71], a[164:167], v[40:43], a[68:71]
  v_exp_f32 v101, v101
  v_mfma_f32_16x16x32_bf16 a[68:71], a[160:163], v[8:11], a[68:71]
  ds_read_b64_tr_b16 a[186:187], v223 offset:36864
  v_cvt_pk_bf16_f32 v98, v100, v101
  v_mfma_f32_16x16x32_bf16 a[72:75], a[160:163], v[16:19], a[72:75]
  v_exp_f32 v102, v102
  v_mfma_f32_16x16x32_bf16 a[72:75], a[164:167], v[48:51], a[72:75]
  ds_read_b64_tr_b16 a[188:189], v223 offset:40960
  v_mfma_f32_16x16x32_bf16 a[76:79], a[164:167], v[56:59], a[76:79]
  s_waitcnt lgkmcnt(7)
  v_exp_f32 v103, v103
  v_mfma_f32_16x16x32_bf16 a[76:79], a[160:163], v[24:27], a[76:79]
  ds_read_b64_tr_b16 a[190:191], v223 offset:45056
  v_cvt_pk_bf16_f32 v99, v102, v103
  v_mfma_f32_16x16x32_bf16 a[80:83], a[168:171], v[0:3], a[80:83]
  s_waitcnt vmcnt(10)
  v_exp_f32 v108, v108
  v_mfma_f32_16x16x32_bf16 a[80:83], a[172:175], v[32:35], a[80:83]
  v_mfma_f32_16x16x32_bf16 a[84:87], a[172:175], v[40:43], a[84:87]
  s_barrier
  v_exp_f32 v109, v109
  v_mfma_f32_16x16x32_bf16 a[84:87], a[168:171], v[8:11], a[84:87]
  ds_read_b128 a[128:131], v212 offset:0
  v_cvt_pk_bf16_f32 v106, v108, v109
  v_mfma_f32_16x16x32_bf16 a[88:91], a[168:171], v[16:19], a[88:91]
  v_exp_f32 v110, v110
  v_mfma_f32_16x16x32_bf16 a[88:91], a[172:175], v[48:51], a[88:91]
  ds_read_b128 a[132:135], v213 offset:0
  v_mfma_f32_16x16x32_bf16 a[92:95], a[172:175], v[56:59], a[92:95]
  s_waitcnt lgkmcnt(6)
  v_exp_f32 v111, v111
  v_mfma_f32_16x16x32_bf16 a[92:95], a[168:171], v[24:27], a[92:95]
  ds_read_b128 a[136:139], v214 offset:0
  v_cvt_pk_bf16_f32 v107, v110, v111
  v_mfma_f32_16x16x32_bf16 a[96:99], a[176:179], v[0:3], a[96:99]
  v_exp_f32 v116, v116
  v_mfma_f32_16x16x32_bf16 a[96:99], a[180:183], v[32:35], a[96:99]
  ds_read_b128 a[140:143], v215 offset:0
  v_mfma_f32_16x16x32_bf16 a[100:103], a[180:183], v[40:43], a[100:103]
  v_exp_f32 v117, v117
  v_mfma_f32_16x16x32_bf16 a[100:103], a[176:179], v[8:11], a[100:103]
  v_cvt_pk_bf16_f32 v114, v116, v117
  v_mfma_f32_16x16x32_bf16 a[104:107], a[176:179], v[16:19], a[104:107]
  v_exp_f32 v118, v118
  v_mfma_f32_16x16x32_bf16 a[104:107], a[180:183], v[48:51], a[104:107]
  v_mfma_f32_16x16x32_bf16 a[108:111], a[180:183], v[56:59], a[108:111]
  s_waitcnt lgkmcnt(4)
  v_exp_f32 v119, v119
  v_mfma_f32_16x16x32_bf16 a[108:111], a[176:179], v[24:27], a[108:111]
  v_cvt_pk_bf16_f32 v115, v118, v119
  v_mfma_f32_16x16x32_bf16 a[112:115], a[184:187], v[0:3], a[112:115]
  v_exp_f32 v124, v124
  v_mfma_f32_16x16x32_bf16 a[112:115], a[188:191], v[32:35], a[112:115]
  v_mfma_f32_16x16x32_bf16 a[116:119], a[188:191], v[40:43], a[116:119]
  v_exp_f32 v125, v125
  v_mfma_f32_16x16x32_bf16 a[116:119], a[184:187], v[8:11], a[116:119]
  v_cvt_pk_bf16_f32 v122, v124, v125
  v_mfma_f32_16x16x32_bf16 a[120:123], a[184:187], v[16:19], a[120:123]
  v_exp_f32 v126, v126
  v_mfma_f32_16x16x32_bf16 a[120:123], a[188:191], v[48:51], a[120:123]
  v_mfma_f32_16x16x32_bf16 a[124:127], a[188:191], v[56:59], a[124:127]
  s_waitcnt lgkmcnt(0)
  v_exp_f32 v127, v127
  v_mfma_f32_16x16x32_bf16 a[124:127], a[184:187], v[24:27], a[124:127]
  v_cvt_pk_bf16_f32 v123, v126, v127
  v_mfma_f32_16x16x32_bf16 v[0:3], a[128:131], v[128:131], v[192:195]
  s_add_u32 m0, s28, 81920
  v_mfma_f32_16x16x32_bf16 v[0:3], a[132:135], v[132:135], v[0:3]
  ds_read_b128 a[144:147], v212 offset:4096
  v_mfma_f32_16x16x32_bf16 v[0:3], a[136:139], v[136:139], v[0:3]
  buffer_load_dwordx4 v236, s[16:19], s29 offen offset:0 lds
  v_mfma_f32_16x16x32_bf16 v[0:3], a[140:143], v[140:143], v[0:3]
  ds_read_b128 a[148:151], v213 offset:4096
  v_mfma_f32_16x16x32_bf16 v[8:11], a[140:143], v[156:159], v[196:199]
  buffer_load_dwordx4 v237, s[16:19], s29 offen offset:1024 lds
  v_mfma_f32_16x16x32_bf16 v[8:11], a[136:139], v[152:155], v[8:11]
  ds_read_b128 a[152:155], v214 offset:4096
  v_mfma_f32_16x16x32_bf16 v[8:11], a[132:135], v[148:151], v[8:11]
  buffer_load_dwordx4 v236, s[16:19], s29 offen offset:2048 lds
  v_mfma_f32_16x16x32_bf16 v[8:11], a[128:131], v[144:147], v[8:11]
  ds_read_b128 a[156:159], v215 offset:4096
  v_mfma_f32_16x16x32_bf16 v[16:19], a[128:131], v[160:163], v[200:203]
  v_exp_f32 v0, v0
  v_mfma_f32_16x16x32_bf16 v[16:19], a[132:135], v[164:167], v[16:19]
  buffer_load_dwordx4 v237, s[16:19], s29 offen offset:3072 lds
  v_mfma_f32_16x16x32_bf16 v[16:19], a[136:139], v[168:171], v[16:19]
  s_add_u32 s29, s29, 16384
  v_exp_f32 v1, v1
  v_mfma_f32_16x16x32_bf16 v[16:19], a[140:143], v[172:175], v[16:19]
  v_cvt_pk_bf16_f32 v0, v0, v1
  v_mfma_f32_16x16x32_bf16 v[24:27], a[140:143], v[188:191], v[204:207]
  s_add_u32 m0, s28, 32768
  v_exp_f32 v2, v2
  v_mfma_f32_16x16x32_bf16 v[24:27], a[136:139], v[184:187], v[24:27]
  buffer_load_dwordx4 v232, s[12:15], s29 offen offset:0 lds
  v_mfma_f32_16x16x32_bf16 v[24:27], a[132:135], v[180:183], v[24:27]
  s_waitcnt lgkmcnt(0)
  v_exp_f32 v3, v3
  v_mfma_f32_16x16x32_bf16 v[24:27], a[128:131], v[176:179], v[24:27]
  v_cvt_pk_bf16_f32 v1, v2, v3
  v_mfma_f32_16x16x32_bf16 v[4:7], a[144:147], v[128:131], v[192:195]
  v_exp_f32 v8, v8
  v_mfma_f32_16x16x32_bf16 v[4:7], a[148:151], v[132:135], v[4:7]
  ds_read_b128 a[128:131], v212 offset:8192
  v_mfma_f32_16x16x32_bf16 v[4:7], a[152:155], v[136:139], v[4:7]
  v_exp_f32 v9, v9
  v_mfma_f32_16x16x32_bf16 v[4:7], a[156:159], v[140:143], v[4:7]
  ds_read_b128 a[132:135], v213 offset:8192
  v_cvt_pk_bf16_f32 v8, v8, v9
  v_mfma_f32_16x16x32_bf16 v[12:15], a[156:159], v[156:159], v[196:199]
  v_exp_f32 v10, v10
  v_mfma_f32_16x16x32_bf16 v[12:15], a[152:155], v[152:155], v[12:15]
  ds_read_b128 a[136:139], v214 offset:8192
  v_mfma_f32_16x16x32_bf16 v[12:15], a[148:151], v[148:151], v[12:15]
  v_exp_f32 v11, v11
  v_mfma_f32_16x16x32_bf16 v[12:15], a[144:147], v[144:147], v[12:15]
  ds_read_b128 a[140:143], v215 offset:8192
  v_cvt_pk_bf16_f32 v9, v10, v11
  v_mfma_f32_16x16x32_bf16 v[20:23], a[144:147], v[160:163], v[200:203]
  v_exp_f32 v16, v16
  v_mfma_f32_16x16x32_bf16 v[20:23], a[148:151], v[164:167], v[20:23]
  buffer_load_dwordx4 v233, s[12:15], s29 offen offset:1024 lds
  v_mfma_f32_16x16x32_bf16 v[20:23], a[152:155], v[168:171], v[20:23]
  v_exp_f32 v17, v17
  v_mfma_f32_16x16x32_bf16 v[20:23], a[156:159], v[172:175], v[20:23]
  v_cvt_pk_bf16_f32 v16, v16, v17
  v_mfma_f32_16x16x32_bf16 v[28:31], a[156:159], v[188:191], v[204:207]
  v_exp_f32 v18, v18
  v_mfma_f32_16x16x32_bf16 v[28:31], a[152:155], v[184:187], v[28:31]
  buffer_load_dwordx4 v234, s[12:15], s29 offen offset:2048 lds
  v_mfma_f32_16x16x32_bf16 v[28:31], a[148:151], v[180:183], v[28:31]
  s_waitcnt lgkmcnt(0)
  v_exp_f32 v19, v19
  v_mfma_f32_16x16x32_bf16 v[28:31], a[144:147], v[176:179], v[28:31]
  v_cvt_pk_bf16_f32 v17, v18, v19
  v_mfma_f32_16x16x32_bf16 v[32:35], a[128:131], v[128:131], v[192:195]
  v_exp_f32 v24, v24
  v_mfma_f32_16x16x32_bf16 v[32:35], a[132:135], v[132:135], v[32:35]
  ds_read_b128 a[144:147], v212 offset:12288
  v_mfma_f32_16x16x32_bf16 v[32:35], a[136:139], v[136:139], v[32:35]
  v_exp_f32 v25, v25
  v_mfma_f32_16x16x32_bf16 v[32:35], a[140:143], v[140:143], v[32:35]
  ds_read_b128 a[148:151], v213 offset:12288
  v_cvt_pk_bf16_f32 v24, v24, v25
  v_mfma_f32_16x16x32_bf16 v[40:43], a[140:143], v[156:159], v[196:199]
  v_exp_f32 v26, v26
  v_mfma_f32_16x16x32_bf16 v[40:43], a[136:139], v[152:155], v[40:43]
  ds_read_b128 a[152:155], v214 offset:12288
  v_mfma_f32_16x16x32_bf16 v[40:43], a[132:135], v[148:151], v[40:43]
  v_exp_f32 v27, v27
  v_mfma_f32_16x16x32_bf16 v[40:43], a[128:131], v[144:147], v[40:43]
  ds_read_b128 a[156:159], v215 offset:12288
  v_cvt_pk_bf16_f32 v25, v26, v27
  v_mfma_f32_16x16x32_bf16 v[48:51], a[128:131], v[160:163], v[200:203]
  v_exp_f32 v4, v4
  v_mfma_f32_16x16x32_bf16 v[48:51], a[132:135], v[164:167], v[48:51]
  buffer_load_dwordx4 v235, s[12:15], s29 offen offset:3072 lds
  v_mfma_f32_16x16x32_bf16 v[48:51], a[136:139], v[168:171], v[48:51]
  v_exp_f32 v5, v5
  v_mfma_f32_16x16x32_bf16 v[48:51], a[140:143], v[172:175], v[48:51]
  v_cvt_pk_bf16_f32 v2, v4, v5
  v_mfma_f32_16x16x32_bf16 v[56:59], a[140:143], v[188:191], v[204:207]
  v_exp_f32 v6, v6
  v_mfma_f32_16x16x32_bf16 v[56:59], a[136:139], v[184:187], v[56:59]
  s_add_u32 m0, s50, 2048
  v_mfma_f32_16x16x32_bf16 v[56:59], a[132:135], v[180:183], v[56:59]
  s_waitcnt lgkmcnt(0)
  v_exp_f32 v7, v7
  v_mfma_f32_16x16x32_bf16 v[56:59], a[128:131], v[176:179], v[56:59]
  buffer_load_dwordx4 v226, s[20:23], s35 offen lds
  v_cvt_pk_bf16_f32 v3, v6, v7
  v_mfma_f32_16x16x32_bf16 v[36:39], a[144:147], v[128:131], v[192:195]
  v_exp_f32 v12, v12
  v_mfma_f32_16x16x32_bf16 v[36:39], a[148:151], v[132:135], v[36:39]
  ds_read_b64_tr_b16 a[160:161], v216 offset:49152
  v_mfma_f32_16x16x32_bf16 v[36:39], a[152:155], v[136:139], v[36:39]
  v_exp_f32 v13, v13
  v_mfma_f32_16x16x32_bf16 v[36:39], a[156:159], v[140:143], v[36:39]
  ds_read_b64_tr_b16 a[162:163], v216 offset:53248
  v_cvt_pk_bf16_f32 v10, v12, v13
  v_mfma_f32_16x16x32_bf16 v[44:47], a[156:159], v[156:159], v[196:199]
  v_exp_f32 v14, v14
  v_mfma_f32_16x16x32_bf16 v[44:47], a[152:155], v[152:155], v[44:47]
  ds_read_b64_tr_b16 a[164:165], v216 offset:57344
  v_mfma_f32_16x16x32_bf16 v[44:47], a[148:151], v[148:151], v[44:47]
  v_exp_f32 v15, v15
  v_mfma_f32_16x16x32_bf16 v[44:47], a[144:147], v[144:147], v[44:47]
  ds_read_b64_tr_b16 a[166:167], v216 offset:61440
  v_cvt_pk_bf16_f32 v11, v14, v15
  v_mfma_f32_16x16x32_bf16 v[52:55], a[144:147], v[160:163], v[200:203]
  v_exp_f32 v20, v20
  v_mfma_f32_16x16x32_bf16 v[52:55], a[148:151], v[164:167], v[52:55]
  ds_read_b64_tr_b16 a[168:169], v217 offset:49152
  v_mfma_f32_16x16x32_bf16 v[52:55], a[152:155], v[168:171], v[52:55]
  v_exp_f32 v21, v21
  v_mfma_f32_16x16x32_bf16 v[52:55], a[156:159], v[172:175], v[52:55]
  ds_read_b64_tr_b16 a[170:171], v217 offset:53248
  v_cvt_pk_bf16_f32 v18, v20, v21
  v_mfma_f32_16x16x32_bf16 v[60:63], a[156:159], v[188:191], v[204:207]
  v_exp_f32 v22, v22
  v_mfma_f32_16x16x32_bf16 v[60:63], a[152:155], v[184:187], v[60:63]
  ds_read_b64_tr_b16 a[172:173], v217 offset:57344
  v_mfma_f32_16x16x32_bf16 v[60:63], a[148:151], v[180:183], v[60:63]
  v_exp_f32 v23, v23
  v_mfma_f32_16x16x32_bf16 v[60:63], a[144:147], v[176:179], v[60:63]
  ds_read_b64_tr_b16 a[174:175], v217 offset:61440
  v_cvt_pk_bf16_f32 v19, v22, v23
  v_mfma_f32_16x16x32_bf16 a[192:195], a[208:211], v[64:67], a[192:195]
  v_exp_f32 v28, v28
  v_mfma_f32_16x16x32_bf16 a[192:195], a[208:211], v[96:99], a[192:195]
  ds_read_b64_tr_b16 a[176:177], v218 offset:49152
  v_mfma_f32_16x16x32_bf16 a[196:199], a[208:211], v[72:75], a[196:199]
  v_exp_f32 v29, v29
  v_mfma_f32_16x16x32_bf16 a[196:199], a[208:211], v[104:107], a[196:199]
  ds_read_b64_tr_b16 a[178:179], v218 offset:53248
  v_cvt_pk_bf16_f32 v26, v28, v29
  v_mfma_f32_16x16x32_bf16 a[200:203], a[208:211], v[80:83], a[200:203]
  v_exp_f32 v30, v30
  v_mfma_f32_16x16x32_bf16 a[200:203], a[208:211], v[112:115], a[200:203]
  ds_read_b64_tr_b16 a[180:181], v218 offset:57344
  v_mfma_f32_16x16x32_bf16 a[204:207], a[208:211], v[88:91], a[204:207]
  s_waitcnt lgkmcnt(7)
  v_exp_f32 v31, v31
  v_mfma_f32_16x16x32_bf16 a[204:207], a[208:211], v[120:123], a[204:207]
  ds_read_b64_tr_b16 a[182:183], v218 offset:61440
  v_cvt_pk_bf16_f32 v27, v30, v31
  v_mfma_f32_16x16x32_bf16 a[0:3], a[160:163], v[64:67], a[0:3]
  v_exp_f32 v32, v32
  v_mfma_f32_16x16x32_bf16 a[0:3], a[164:167], v[96:99], a[0:3]
  ds_read_b64_tr_b16 a[184:185], v219 offset:49152
  v_mfma_f32_16x16x32_bf16 a[4:7], a[164:167], v[104:107], a[4:7]
  v_exp_f32 v33, v33
  v_mfma_f32_16x16x32_bf16 a[4:7], a[160:163], v[72:75], a[4:7]
  ds_read_b64_tr_b16 a[186:187], v219 offset:53248
  v_cvt_pk_bf16_f32 v32, v32, v33
  v_mfma_f32_16x16x32_bf16 a[8:11], a[160:163], v[80:83], a[8:11]
  v_exp_f32 v34, v34
  v_mfma_f32_16x16x32_bf16 a[8:11], a[164:167], v[112:115], a[8:11]
  ds_read_b64_tr_b16 a[188:189], v219 offset:57344
  v_mfma_f32_16x16x32_bf16 a[12:15], a[164:167], v[120:123], a[12:15]
  s_waitcnt lgkmcnt(7)
  v_exp_f32 v35, v35
  v_mfma_f32_16x16x32_bf16 a[12:15], a[160:163], v[88:91], a[12:15]
  ds_read_b64_tr_b16 a[190:191], v219 offset:61440
  v_cvt_pk_bf16_f32 v33, v34, v35
  v_mfma_f32_16x16x32_bf16 a[16:19], a[168:171], v[64:67], a[16:19]
  v_exp_f32 v40, v40
  v_mfma_f32_16x16x32_bf16 a[16:19], a[172:175], v[96:99], a[16:19]
  ds_read_b64_tr_b16 a[160:161], v220 offset:49152
  v_mfma_f32_16x16x32_bf16 a[20:23], a[172:175], v[104:107], a[20:23]
  v_exp_f32 v41, v41
  v_mfma_f32_16x16x32_bf16 a[20:23], a[168:171], v[72:75], a[20:23]
  ds_read_b64_tr_b16 a[162:163], v220 offset:53248
  v_cvt_pk_bf16_f32 v40, v40, v41
  v_mfma_f32_16x16x32_bf16 a[24:27], a[168:171], v[80:83], a[24:27]
  v_exp_f32 v42, v42
  v_mfma_f32_16x16x32_bf16 a[24:27], a[172:175], v[112:115], a[24:27]
  ds_read_b64_tr_b16 a[164:165], v220 offset:57344
  v_mfma_f32_16x16x32_bf16 a[28:31], a[172:175], v[120:123], a[28:31]
  s_waitcnt lgkmcnt(7)
  v_exp_f32 v43, v43
  v_mfma_f32_16x16x32_bf16 a[28:31], a[168:171], v[88:91], a[28:31]
  ds_read_b64_tr_b16 a[166:167], v220 offset:61440
  v_cvt_pk_bf16_f32 v41, v42, v43
  v_mfma_f32_16x16x32_bf16 a[32:35], a[176:179], v[64:67], a[32:35]
  v_exp_f32 v48, v48
  v_mfma_f32_16x16x32_bf16 a[32:35], a[180:183], v[96:99], a[32:35]
  ds_read_b64_tr_b16 a[168:169], v221 offset:49152
  v_mfma_f32_16x16x32_bf16 a[36:39], a[180:183], v[104:107], a[36:39]
  v_exp_f32 v49, v49
  v_mfma_f32_16x16x32_bf16 a[36:39], a[176:179], v[72:75], a[36:39]
  ds_read_b64_tr_b16 a[170:171], v221 offset:53248
  v_cvt_pk_bf16_f32 v48, v48, v49
  v_mfma_f32_16x16x32_bf16 a[40:43], a[176:179], v[80:83], a[40:43]
  v_exp_f32 v50, v50
  v_mfma_f32_16x16x32_bf16 a[40:43], a[180:183], v[112:115], a[40:43]
  ds_read_b64_tr_b16 a[172:173], v221 offset:57344
  v_mfma_f32_16x16x32_bf16 a[44:47], a[180:183], v[120:123], a[44:47]
  s_waitcnt lgkmcnt(7)
  v_exp_f32 v51, v51
  v_mfma_f32_16x16x32_bf16 a[44:47], a[176:179], v[88:91], a[44:47]
  ds_read_b64_tr_b16 a[174:175], v221 offset:61440
  v_cvt_pk_bf16_f32 v49, v50, v51
  v_mfma_f32_16x16x32_bf16 a[48:51], a[184:187], v[64:67], a[48:51]
  v_exp_f32 v56, v56
  v_mfma_f32_16x16x32_bf16 a[48:51], a[188:191], v[96:99], a[48:51]
  ds_read_b64_tr_b16 a[176:177], v222 offset:49152
  v_mfma_f32_16x16x32_bf16 a[52:55], a[188:191], v[104:107], a[52:55]
  v_exp_f32 v57, v57
  v_mfma_f32_16x16x32_bf16 a[52:55], a[184:187], v[72:75], a[52:55]
  ds_read_b64_tr_b16 a[178:179], v222 offset:53248
  v_cvt_pk_bf16_f32 v56, v56, v57
  v_mfma_f32_16x16x32_bf16 a[56:59], a[184:187], v[80:83], a[56:59]
  v_exp_f32 v58, v58
  v_mfma_f32_16x16x32_bf16 a[56:59], a[188:191], v[112:115], a[56:59]
  ds_read_b64_tr_b16 a[180:181], v222 offset:57344
  v_mfma_f32_16x16x32_bf16 a[60:63], a[188:191], v[120:123], a[60:63]
  s_waitcnt lgkmcnt(7)
  v_exp_f32 v59, v59
  v_mfma_f32_16x16x32_bf16 a[60:63], a[184:187], v[88:91], a[60:63]
  ds_read_b64_tr_b16 a[182:183], v222 offset:61440
  v_cvt_pk_bf16_f32 v57, v58, v59
  v_mfma_f32_16x16x32_bf16 a[64:67], a[160:163], v[64:67], a[64:67]
  v_exp_f32 v36, v36
  v_mfma_f32_16x16x32_bf16 a[64:67], a[164:167], v[96:99], a[64:67]
  ds_read_b64_tr_b16 a[184:185], v223 offset:49152
  v_mfma_f32_16x16x32_bf16 a[68:71], a[164:167], v[104:107], a[68:71]
  v_exp_f32 v37, v37
  v_mfma_f32_16x16x32_bf16 a[68:71], a[160:163], v[72:75], a[68:71]
  ds_read_b64_tr_b16 a[186:187], v223 offset:53248
  v_cvt_pk_bf16_f32 v34, v36, v37
  v_mfma_f32_16x16x32_bf16 a[72:75], a[160:163], v[80:83], a[72:75]
  v_exp_f32 v38, v38
  v_mfma_f32_16x16x32_bf16 a[72:75], a[164:167], v[112:115], a[72:75]
  ds_read_b64_tr_b16 a[188:189], v223 offset:57344
  v_mfma_f32_16x16x32_bf16 a[76:79], a[164:167], v[120:123], a[76:79]
  s_waitcnt lgkmcnt(7)
  v_exp_f32 v39, v39
  v_mfma_f32_16x16x32_bf16 a[76:79], a[160:163], v[88:91], a[76:79]
  ds_read_b64_tr_b16 a[190:191], v223 offset:61440
  v_cvt_pk_bf16_f32 v35, v38, v39
  v_mfma_f32_16x16x32_bf16 a[80:83], a[168:171], v[64:67], a[80:83]
  s_waitcnt vmcnt(10)
  v_exp_f32 v44, v44
  v_mfma_f32_16x16x32_bf16 a[80:83], a[172:175], v[96:99], a[80:83]
  v_mfma_f32_16x16x32_bf16 a[84:87], a[172:175], v[104:107], a[84:87]
  s_barrier
  v_exp_f32 v45, v45
  v_mfma_f32_16x16x32_bf16 a[84:87], a[168:171], v[72:75], a[84:87]
  ds_read_b128 a[128:131], v212 offset:16384
  v_cvt_pk_bf16_f32 v42, v44, v45
  v_mfma_f32_16x16x32_bf16 a[88:91], a[168:171], v[80:83], a[88:91]
  v_exp_f32 v46, v46
  v_mfma_f32_16x16x32_bf16 a[88:91], a[172:175], v[112:115], a[88:91]
  ds_read_b128 a[132:135], v213 offset:16384
  v_mfma_f32_16x16x32_bf16 a[92:95], a[172:175], v[120:123], a[92:95]
  s_waitcnt lgkmcnt(6)
  v_exp_f32 v47, v47
  v_mfma_f32_16x16x32_bf16 a[92:95], a[168:171], v[88:91], a[92:95]
  ds_read_b128 a[136:139], v214 offset:16384
  v_cvt_pk_bf16_f32 v43, v46, v47
  v_mfma_f32_16x16x32_bf16 a[96:99], a[176:179], v[64:67], a[96:99]
  v_exp_f32 v52, v52
  v_mfma_f32_16x16x32_bf16 a[96:99], a[180:183], v[96:99], a[96:99]
  ds_read_b128 a[140:143], v215 offset:16384
  v_mfma_f32_16x16x32_bf16 a[100:103], a[180:183], v[104:107], a[100:103]
  v_exp_f32 v53, v53
  v_mfma_f32_16x16x32_bf16 a[100:103], a[176:179], v[72:75], a[100:103]
  v_cvt_pk_bf16_f32 v50, v52, v53
  v_mfma_f32_16x16x32_bf16 a[104:107], a[176:179], v[80:83], a[104:107]
  v_exp_f32 v54, v54
  v_mfma_f32_16x16x32_bf16 a[104:107], a[180:183], v[112:115], a[104:107]
  v_mfma_f32_16x16x32_bf16 a[108:111], a[180:183], v[120:123], a[108:111]
  s_waitcnt lgkmcnt(4)
  v_exp_f32 v55, v55
  v_mfma_f32_16x16x32_bf16 a[108:111], a[176:179], v[88:91], a[108:111]
  v_cvt_pk_bf16_f32 v51, v54, v55
  v_mfma_f32_16x16x32_bf16 a[112:115], a[184:187], v[64:67], a[112:115]
  v_exp_f32 v60, v60
  v_mfma_f32_16x16x32_bf16 a[112:115], a[188:191], v[96:99], a[112:115]
  v_mfma_f32_16x16x32_bf16 a[116:119], a[188:191], v[104:107], a[116:119]
  v_exp_f32 v61, v61
  v_mfma_f32_16x16x32_bf16 a[116:119], a[184:187], v[72:75], a[116:119]
  v_cvt_pk_bf16_f32 v58, v60, v61
  v_mfma_f32_16x16x32_bf16 a[120:123], a[184:187], v[80:83], a[120:123]
  v_exp_f32 v62, v62
  v_mfma_f32_16x16x32_bf16 a[120:123], a[188:191], v[112:115], a[120:123]
  v_mfma_f32_16x16x32_bf16 a[124:127], a[188:191], v[120:123], a[124:127]
  s_waitcnt lgkmcnt(0)
  v_exp_f32 v63, v63
  v_mfma_f32_16x16x32_bf16 a[124:127], a[184:187], v[88:91], a[124:127]
  v_cvt_pk_bf16_f32 v59, v62, v63
  v_mfma_f32_16x16x32_bf16 v[64:67], a[128:131], v[128:131], v[192:195]
  s_add_u32 m0, s28, 98304
  v_mfma_f32_16x16x32_bf16 v[64:67], a[132:135], v[132:135], v[64:67]
  ds_read_b128 a[144:147], v212 offset:20480
  v_mfma_f32_16x16x32_bf16 v[64:67], a[136:139], v[136:139], v[64:67]
  buffer_load_dwordx4 v236, s[16:19], s29 offen offset:0 lds
  v_mfma_f32_16x16x32_bf16 v[64:67], a[140:143], v[140:143], v[64:67]
  ds_read_b128 a[148:151], v213 offset:20480
  v_mfma_f32_16x16x32_bf16 v[72:75], a[140:143], v[156:159], v[196:199]
  buffer_load_dwordx4 v237, s[16:19], s29 offen offset:1024 lds
  v_mfma_f32_16x16x32_bf16 v[72:75], a[136:139], v[152:155], v[72:75]
  ds_read_b128 a[152:155], v214 offset:20480
  v_mfma_f32_16x16x32_bf16 v[72:75], a[132:135], v[148:151], v[72:75]
  buffer_load_dwordx4 v236, s[16:19], s29 offen offset:2048 lds
  v_mfma_f32_16x16x32_bf16 v[72:75], a[128:131], v[144:147], v[72:75]
  ds_read_b128 a[156:159], v215 offset:20480
  v_mfma_f32_16x16x32_bf16 v[80:83], a[128:131], v[160:163], v[200:203]
  v_exp_f32 v64, v64
  v_mfma_f32_16x16x32_bf16 v[80:83], a[132:135], v[164:167], v[80:83]
  buffer_load_dwordx4 v237, s[16:19], s29 offen offset:3072 lds
  v_mfma_f32_16x16x32_bf16 v[80:83], a[136:139], v[168:171], v[80:83]
  s_add_u32 s29, s29, 16384
  v_exp_f32 v65, v65
  v_mfma_f32_16x16x32_bf16 v[80:83], a[140:143], v[172:175], v[80:83]
  v_cvt_pk_bf16_f32 v64, v64, v65
  v_mfma_f32_16x16x32_bf16 v[88:91], a[140:143], v[188:191], v[204:207]
  s_add_u32 m0, s28, 49152
  v_exp_f32 v66, v66
  v_mfma_f32_16x16x32_bf16 v[88:91], a[136:139], v[184:187], v[88:91]
  buffer_load_dwordx4 v232, s[12:15], s29 offen offset:0 lds
  v_mfma_f32_16x16x32_bf16 v[88:91], a[132:135], v[180:183], v[88:91]
  s_waitcnt lgkmcnt(0)
  v_exp_f32 v67, v67
  v_mfma_f32_16x16x32_bf16 v[88:91], a[128:131], v[176:179], v[88:91]
  v_cvt_pk_bf16_f32 v65, v66, v67
  v_mfma_f32_16x16x32_bf16 v[68:71], a[144:147], v[128:131], v[192:195]
  v_exp_f32 v72, v72
  v_mfma_f32_16x16x32_bf16 v[68:71], a[148:151], v[132:135], v[68:71]
  ds_read_b128 a[128:131], v212 offset:24576
  v_mfma_f32_16x16x32_bf16 v[68:71], a[152:155], v[136:139], v[68:71]
  v_exp_f32 v73, v73
  v_mfma_f32_16x16x32_bf16 v[68:71], a[156:159], v[140:143], v[68:71]
  ds_read_b128 a[132:135], v213 offset:24576
  v_cvt_pk_bf16_f32 v72, v72, v73
  v_mfma_f32_16x16x32_bf16 v[76:79], a[156:159], v[156:159], v[196:199]
  v_exp_f32 v74, v74
  v_mfma_f32_16x16x32_bf16 v[76:79], a[152:155], v[152:155], v[76:79]
  ds_read_b128 a[136:139], v214 offset:24576
  v_mfma_f32_16x16x32_bf16 v[76:79], a[148:151], v[148:151], v[76:79]
  v_exp_f32 v75, v75
  v_mfma_f32_16x16x32_bf16 v[76:79], a[144:147], v[144:147], v[76:79]
  ds_read_b128 a[140:143], v215 offset:24576
  v_cvt_pk_bf16_f32 v73, v74, v75
  v_mfma_f32_16x16x32_bf16 v[84:87], a[144:147], v[160:163], v[200:203]
  v_exp_f32 v80, v80
  v_mfma_f32_16x16x32_bf16 v[84:87], a[148:151], v[164:167], v[84:87]
  buffer_load_dwordx4 v233, s[12:15], s29 offen offset:1024 lds
  v_mfma_f32_16x16x32_bf16 v[84:87], a[152:155], v[168:171], v[84:87]
  v_exp_f32 v81, v81
  v_mfma_f32_16x16x32_bf16 v[84:87], a[156:159], v[172:175], v[84:87]
  v_cvt_pk_bf16_f32 v80, v80, v81
  v_mfma_f32_16x16x32_bf16 v[92:95], a[156:159], v[188:191], v[204:207]
  v_exp_f32 v82, v82
  v_mfma_f32_16x16x32_bf16 v[92:95], a[152:155], v[184:187], v[92:95]
  buffer_load_dwordx4 v234, s[12:15], s29 offen offset:2048 lds
  v_mfma_f32_16x16x32_bf16 v[92:95], a[148:151], v[180:183], v[92:95]
  s_waitcnt lgkmcnt(0)
  v_exp_f32 v83, v83
  v_mfma_f32_16x16x32_bf16 v[92:95], a[144:147], v[176:179], v[92:95]
  v_cvt_pk_bf16_f32 v81, v82, v83
  v_mfma_f32_16x16x32_bf16 v[96:99], a[128:131], v[128:131], v[192:195]
  v_exp_f32 v88, v88
  v_mfma_f32_16x16x32_bf16 v[96:99], a[132:135], v[132:135], v[96:99]
  ds_read_b128 a[144:147], v212 offset:28672
  v_mfma_f32_16x16x32_bf16 v[96:99], a[136:139], v[136:139], v[96:99]
  v_exp_f32 v89, v89
  v_mfma_f32_16x16x32_bf16 v[96:99], a[140:143], v[140:143], v[96:99]
  ds_read_b128 a[148:151], v213 offset:28672
  v_cvt_pk_bf16_f32 v88, v88, v89
  v_mfma_f32_16x16x32_bf16 v[104:107], a[140:143], v[156:159], v[196:199]
  v_exp_f32 v90, v90
  v_mfma_f32_16x16x32_bf16 v[104:107], a[136:139], v[152:155], v[104:107]
  ds_read_b128 a[152:155], v214 offset:28672
  v_mfma_f32_16x16x32_bf16 v[104:107], a[132:135], v[148:151], v[104:107]
  v_exp_f32 v91, v91
  v_mfma_f32_16x16x32_bf16 v[104:107], a[128:131], v[144:147], v[104:107]
  ds_read_b128 a[156:159], v215 offset:28672
  v_cvt_pk_bf16_f32 v89, v90, v91
  v_mfma_f32_16x16x32_bf16 v[112:115], a[128:131], v[160:163], v[200:203]
  v_exp_f32 v68, v68
  v_mfma_f32_16x16x32_bf16 v[112:115], a[132:135], v[164:167], v[112:115]
  buffer_load_dwordx4 v235, s[12:15], s29 offen offset:3072 lds
  v_mfma_f32_16x16x32_bf16 v[112:115], a[136:139], v[168:171], v[112:115]
  v_exp_f32 v69, v69
  v_mfma_f32_16x16x32_bf16 v[112:115], a[140:143], v[172:175], v[112:115]
  v_cvt_pk_bf16_f32 v66, v68, v69
  v_mfma_f32_16x16x32_bf16 v[120:123], a[140:143], v[188:191], v[204:207]
  v_exp_f32 v70, v70
  v_mfma_f32_16x16x32_bf16 v[120:123], a[136:139], v[184:187], v[120:123]
  s_add_u32 m0, s50, 5120
  v_mfma_f32_16x16x32_bf16 v[120:123], a[132:135], v[180:183], v[120:123]
  s_waitcnt lgkmcnt(0)
  v_exp_f32 v71, v71
  v_mfma_f32_16x16x32_bf16 v[120:123], a[128:131], v[176:179], v[120:123]
  buffer_load_dwordx4 v226, s[44:47], s35 offen lds
  s_add_u32 s35, s35, 221184
  v_cvt_pk_bf16_f32 v67, v70, v71
  v_mfma_f32_16x16x32_bf16 v[100:103], a[144:147], v[128:131], v[192:195]
  v_exp_f32 v76, v76
  v_mfma_f32_16x16x32_bf16 v[100:103], a[148:151], v[132:135], v[100:103]
  ds_read_b64_tr_b16 a[160:161], v216 offset:0
  v_mfma_f32_16x16x32_bf16 v[100:103], a[152:155], v[136:139], v[100:103]
  v_exp_f32 v77, v77
  v_mfma_f32_16x16x32_bf16 v[100:103], a[156:159], v[140:143], v[100:103]
  ds_read_b64_tr_b16 a[162:163], v216 offset:4096
  v_cvt_pk_bf16_f32 v74, v76, v77
  v_mfma_f32_16x16x32_bf16 v[108:111], a[156:159], v[156:159], v[196:199]
  v_exp_f32 v78, v78
  v_mfma_f32_16x16x32_bf16 v[108:111], a[152:155], v[152:155], v[108:111]
  ds_read_b64_tr_b16 a[164:165], v216 offset:8192
  v_mfma_f32_16x16x32_bf16 v[108:111], a[148:151], v[148:151], v[108:111]
  v_exp_f32 v79, v79
  v_mfma_f32_16x16x32_bf16 v[108:111], a[144:147], v[144:147], v[108:111]
  ds_read_b64_tr_b16 a[166:167], v216 offset:12288
  v_cvt_pk_bf16_f32 v75, v78, v79
  v_mfma_f32_16x16x32_bf16 v[116:119], a[144:147], v[160:163], v[200:203]
  v_exp_f32 v84, v84
  v_mfma_f32_16x16x32_bf16 v[116:119], a[148:151], v[164:167], v[116:119]
  ds_read_b64_tr_b16 a[168:169], v217 offset:0
  v_mfma_f32_16x16x32_bf16 v[116:119], a[152:155], v[168:171], v[116:119]
  v_exp_f32 v85, v85
  v_mfma_f32_16x16x32_bf16 v[116:119], a[156:159], v[172:175], v[116:119]
  ds_read_b64_tr_b16 a[170:171], v217 offset:4096
  v_cvt_pk_bf16_f32 v82, v84, v85
  v_mfma_f32_16x16x32_bf16 v[124:127], a[156:159], v[188:191], v[204:207]
  v_exp_f32 v86, v86
  v_mfma_f32_16x16x32_bf16 v[124:127], a[152:155], v[184:187], v[124:127]
  ds_read_b64_tr_b16 a[172:173], v217 offset:8192
  v_mfma_f32_16x16x32_bf16 v[124:127], a[148:151], v[180:183], v[124:127]
  v_exp_f32 v87, v87
  v_mfma_f32_16x16x32_bf16 v[124:127], a[144:147], v[176:179], v[124:127]
  ds_read_b64_tr_b16 a[174:175], v217 offset:12288
  v_cvt_pk_bf16_f32 v83, v86, v87
  v_mfma_f32_16x16x32_bf16 a[192:195], a[208:211], v[0:3], a[192:195]
  v_exp_f32 v92, v92
  v_mfma_f32_16x16x32_bf16 a[192:195], a[208:211], v[32:35], a[192:195]
  ds_read_b64_tr_b16 a[176:177], v218 offset:0
  v_mfma_f32_16x16x32_bf16 a[196:199], a[208:211], v[8:11], a[196:199]
  v_exp_f32 v93, v93
  v_mfma_f32_16x16x32_bf16 a[196:199], a[208:211], v[40:43], a[196:199]
  ds_read_b64_tr_b16 a[178:179], v218 offset:4096
  v_cvt_pk_bf16_f32 v90, v92, v93
  v_mfma_f32_16x16x32_bf16 a[200:203], a[208:211], v[16:19], a[200:203]
  v_exp_f32 v94, v94
  v_mfma_f32_16x16x32_bf16 a[200:203], a[208:211], v[48:51], a[200:203]
  ds_read_b64_tr_b16 a[180:181], v218 offset:8192
  v_mfma_f32_16x16x32_bf16 a[204:207], a[208:211], v[24:27], a[204:207]
  s_waitcnt lgkmcnt(7)
  v_exp_f32 v95, v95
  v_mfma_f32_16x16x32_bf16 a[204:207], a[208:211], v[56:59], a[204:207]
  ds_read_b64_tr_b16 a[182:183], v218 offset:12288
  v_cvt_pk_bf16_f32 v91, v94, v95
  v_mfma_f32_16x16x32_bf16 a[0:3], a[160:163], v[0:3], a[0:3]
  v_exp_f32 v96, v96
  v_mfma_f32_16x16x32_bf16 a[0:3], a[164:167], v[32:35], a[0:3]
  ds_read_b64_tr_b16 a[184:185], v219 offset:0
  v_mfma_f32_16x16x32_bf16 a[4:7], a[164:167], v[40:43], a[4:7]
  v_exp_f32 v97, v97
  v_mfma_f32_16x16x32_bf16 a[4:7], a[160:163], v[8:11], a[4:7]
  ds_read_b64_tr_b16 a[186:187], v219 offset:4096
  v_cvt_pk_bf16_f32 v96, v96, v97
  v_mfma_f32_16x16x32_bf16 a[8:11], a[160:163], v[16:19], a[8:11]
  v_exp_f32 v98, v98
  v_mfma_f32_16x16x32_bf16 a[8:11], a[164:167], v[48:51], a[8:11]
  ds_read_b64_tr_b16 a[188:189], v219 offset:8192
  v_mfma_f32_16x16x32_bf16 a[12:15], a[164:167], v[56:59], a[12:15]
  s_waitcnt lgkmcnt(7)
  v_exp_f32 v99, v99
  v_mfma_f32_16x16x32_bf16 a[12:15], a[160:163], v[24:27], a[12:15]
  ds_read_b64_tr_b16 a[190:191], v219 offset:12288
  v_cvt_pk_bf16_f32 v97, v98, v99
  v_mfma_f32_16x16x32_bf16 a[16:19], a[168:171], v[0:3], a[16:19]
  v_exp_f32 v104, v104
  v_mfma_f32_16x16x32_bf16 a[16:19], a[172:175], v[32:35], a[16:19]
  ds_read_b64_tr_b16 a[160:161], v220 offset:0
  v_mfma_f32_16x16x32_bf16 a[20:23], a[172:175], v[40:43], a[20:23]
  v_exp_f32 v105, v105
  v_mfma_f32_16x16x32_bf16 a[20:23], a[168:171], v[8:11], a[20:23]
  ds_read_b64_tr_b16 a[162:163], v220 offset:4096
  v_cvt_pk_bf16_f32 v104, v104, v105
  v_mfma_f32_16x16x32_bf16 a[24:27], a[168:171], v[16:19], a[24:27]
  v_exp_f32 v106, v106
  v_mfma_f32_16x16x32_bf16 a[24:27], a[172:175], v[48:51], a[24:27]
  ds_read_b64_tr_b16 a[164:165], v220 offset:8192
  v_mfma_f32_16x16x32_bf16 a[28:31], a[172:175], v[56:59], a[28:31]
  s_waitcnt lgkmcnt(7)
  v_exp_f32 v107, v107
  v_mfma_f32_16x16x32_bf16 a[28:31], a[168:171], v[24:27], a[28:31]
  ds_read_b64_tr_b16 a[166:167], v220 offset:12288
  v_cvt_pk_bf16_f32 v105, v106, v107
  v_mfma_f32_16x16x32_bf16 a[32:35], a[176:179], v[0:3], a[32:35]
  v_exp_f32 v112, v112
  v_mfma_f32_16x16x32_bf16 a[32:35], a[180:183], v[32:35], a[32:35]
  ds_read_b64_tr_b16 a[168:169], v221 offset:0
  v_mfma_f32_16x16x32_bf16 a[36:39], a[180:183], v[40:43], a[36:39]
  v_exp_f32 v113, v113
  v_mfma_f32_16x16x32_bf16 a[36:39], a[176:179], v[8:11], a[36:39]
  ds_read_b64_tr_b16 a[170:171], v221 offset:4096
  v_cvt_pk_bf16_f32 v112, v112, v113
  v_mfma_f32_16x16x32_bf16 a[40:43], a[176:179], v[16:19], a[40:43]
  v_exp_f32 v114, v114
  v_mfma_f32_16x16x32_bf16 a[40:43], a[180:183], v[48:51], a[40:43]
  ds_read_b64_tr_b16 a[172:173], v221 offset:8192
  v_mfma_f32_16x16x32_bf16 a[44:47], a[180:183], v[56:59], a[44:47]
  s_waitcnt lgkmcnt(7)
  v_exp_f32 v115, v115
  v_mfma_f32_16x16x32_bf16 a[44:47], a[176:179], v[24:27], a[44:47]
  ds_read_b64_tr_b16 a[174:175], v221 offset:12288
  v_cvt_pk_bf16_f32 v113, v114, v115
  v_mfma_f32_16x16x32_bf16 a[48:51], a[184:187], v[0:3], a[48:51]
  v_exp_f32 v120, v120
  v_mfma_f32_16x16x32_bf16 a[48:51], a[188:191], v[32:35], a[48:51]
  ds_read_b64_tr_b16 a[176:177], v222 offset:0
  v_mfma_f32_16x16x32_bf16 a[52:55], a[188:191], v[40:43], a[52:55]
  v_exp_f32 v121, v121
  v_mfma_f32_16x16x32_bf16 a[52:55], a[184:187], v[8:11], a[52:55]
  ds_read_b64_tr_b16 a[178:179], v222 offset:4096
  v_cvt_pk_bf16_f32 v120, v120, v121
  v_mfma_f32_16x16x32_bf16 a[56:59], a[184:187], v[16:19], a[56:59]
  v_exp_f32 v122, v122
  v_mfma_f32_16x16x32_bf16 a[56:59], a[188:191], v[48:51], a[56:59]
  ds_read_b64_tr_b16 a[180:181], v222 offset:8192
  v_mfma_f32_16x16x32_bf16 a[60:63], a[188:191], v[56:59], a[60:63]
  s_waitcnt lgkmcnt(7)
  v_exp_f32 v123, v123
  v_mfma_f32_16x16x32_bf16 a[60:63], a[184:187], v[24:27], a[60:63]
  ds_read_b64_tr_b16 a[182:183], v222 offset:12288
  v_cvt_pk_bf16_f32 v121, v122, v123
  v_mfma_f32_16x16x32_bf16 a[64:67], a[160:163], v[0:3], a[64:67]
  v_exp_f32 v100, v100
  v_mfma_f32_16x16x32_bf16 a[64:67], a[164:167], v[32:35], a[64:67]
  ds_read_b64_tr_b16 a[184:185], v223 offset:0
  v_mfma_f32_16x16x32_bf16 a[68:71], a[164:167], v[40:43], a[68:71]
  v_exp_f32 v101, v101
  v_mfma_f32_16x16x32_bf16 a[68:71], a[160:163], v[8:11], a[68:71]
  ds_read_b64_tr_b16 a[186:187], v223 offset:4096
  v_cvt_pk_bf16_f32 v98, v100, v101
  v_mfma_f32_16x16x32_bf16 a[72:75], a[160:163], v[16:19], a[72:75]
  v_exp_f32 v102, v102
  v_mfma_f32_16x16x32_bf16 a[72:75], a[164:167], v[48:51], a[72:75]
  ds_read_b64_tr_b16 a[188:189], v223 offset:8192
  v_mfma_f32_16x16x32_bf16 a[76:79], a[164:167], v[56:59], a[76:79]
  s_waitcnt lgkmcnt(7)
  v_exp_f32 v103, v103
  v_mfma_f32_16x16x32_bf16 a[76:79], a[160:163], v[24:27], a[76:79]
  ds_read_b64_tr_b16 a[190:191], v223 offset:12288
  v_cvt_pk_bf16_f32 v99, v102, v103
  v_mfma_f32_16x16x32_bf16 a[80:83], a[168:171], v[0:3], a[80:83]
  s_waitcnt vmcnt(10)
  v_exp_f32 v108, v108
  v_mfma_f32_16x16x32_bf16 a[80:83], a[172:175], v[32:35], a[80:83]
  v_mfma_f32_16x16x32_bf16 a[84:87], a[172:175], v[40:43], a[84:87]
  s_barrier
  v_exp_f32 v109, v109
  v_mfma_f32_16x16x32_bf16 a[84:87], a[168:171], v[8:11], a[84:87]
  ds_read_b128 a[128:131], v212 offset:32768
  v_cvt_pk_bf16_f32 v106, v108, v109
  v_mfma_f32_16x16x32_bf16 a[88:91], a[168:171], v[16:19], a[88:91]
  v_exp_f32 v110, v110
  v_mfma_f32_16x16x32_bf16 a[88:91], a[172:175], v[48:51], a[88:91]
  ds_read_b128 a[132:135], v213 offset:32768
  v_mfma_f32_16x16x32_bf16 a[92:95], a[172:175], v[56:59], a[92:95]
  s_waitcnt lgkmcnt(6)
  v_exp_f32 v111, v111
  v_mfma_f32_16x16x32_bf16 a[92:95], a[168:171], v[24:27], a[92:95]
  ds_read_b128 a[136:139], v214 offset:32768
  v_cvt_pk_bf16_f32 v107, v110, v111
  v_mfma_f32_16x16x32_bf16 a[96:99], a[176:179], v[0:3], a[96:99]
  v_exp_f32 v116, v116
  v_mfma_f32_16x16x32_bf16 a[96:99], a[180:183], v[32:35], a[96:99]
  ds_read_b128 a[140:143], v215 offset:32768
  v_mfma_f32_16x16x32_bf16 a[100:103], a[180:183], v[40:43], a[100:103]
  v_exp_f32 v117, v117
  v_mfma_f32_16x16x32_bf16 a[100:103], a[176:179], v[8:11], a[100:103]
  v_cvt_pk_bf16_f32 v114, v116, v117
  v_mfma_f32_16x16x32_bf16 a[104:107], a[176:179], v[16:19], a[104:107]
  v_exp_f32 v118, v118
  v_mfma_f32_16x16x32_bf16 a[104:107], a[180:183], v[48:51], a[104:107]
  v_mfma_f32_16x16x32_bf16 a[108:111], a[180:183], v[56:59], a[108:111]
  s_waitcnt lgkmcnt(4)
  v_exp_f32 v119, v119
  v_mfma_f32_16x16x32_bf16 a[108:111], a[176:179], v[24:27], a[108:111]
  v_cvt_pk_bf16_f32 v115, v118, v119
  v_mfma_f32_16x16x32_bf16 a[112:115], a[184:187], v[0:3], a[112:115]
  v_exp_f32 v124, v124
  v_mfma_f32_16x16x32_bf16 a[112:115], a[188:191], v[32:35], a[112:115]
  v_mfma_f32_16x16x32_bf16 a[116:119], a[188:191], v[40:43], a[116:119]
  v_exp_f32 v125, v125
  v_mfma_f32_16x16x32_bf16 a[116:119], a[184:187], v[8:11], a[116:119]
  v_cvt_pk_bf16_f32 v122, v124, v125
  v_mfma_f32_16x16x32_bf16 a[120:123], a[184:187], v[16:19], a[120:123]
  v_exp_f32 v126, v126
  v_mfma_f32_16x16x32_bf16 a[120:123], a[188:191], v[48:51], a[120:123]
  v_mfma_f32_16x16x32_bf16 a[124:127], a[188:191], v[56:59], a[124:127]
  s_waitcnt lgkmcnt(0)
  v_exp_f32 v127, v127
  v_mfma_f32_16x16x32_bf16 a[124:127], a[184:187], v[24:27], a[124:127]
  v_cvt_pk_bf16_f32 v123, v126, v127
  v_mfma_f32_16x16x32_bf16 v[0:3], a[128:131], v[128:131], v[192:195]
  s_add_u32 m0, s28, 114688
  s_mov_b32 s20, s88
  s_mov_b32 s21, s89
  s_mov_b32 s22, 5242880
  s_mov_b32 s23, 0x20000
  v_lshrrev_b32 v208, 4, v242
  v_and_b32 v209, 1, v208
  v_mfma_f32_16x16x32_bf16 v[0:3], a[132:135], v[132:135], v[0:3]
  ds_read_b128 a[144:147], v212 offset:36864
  v_lshrrev_b32 v208, 1, v208
  v_mfma_f32_16x16x32_bf16 v[0:3], a[136:139], v[136:139], v[0:3]
  buffer_load_dwordx4 v236, s[16:19], s29 offen offset:0 lds
  v_mfma_f32_16x16x32_bf16 v[0:3], a[140:143], v[140:143], v[0:3]
  ds_read_b128 a[148:151], v213 offset:36864
  v_mul_u32_u24 v208, 0x500, v208
  v_mfma_f32_16x16x32_bf16 v[8:11], a[140:143], v[156:159], v[196:199]
  buffer_load_dwordx4 v237, s[16:19], s29 offen offset:1024 lds
  v_mfma_f32_16x16x32_bf16 v[8:11], a[136:139], v[152:155], v[8:11]
  ds_read_b128 a[152:155], v214 offset:36864
  v_lshl_add_u32 v208, v209, 4, v208
  v_mfma_f32_16x16x32_bf16 v[8:11], a[132:135], v[148:151], v[8:11]
  buffer_load_dwordx4 v236, s[16:19], s29 offen offset:2048 lds
  v_mfma_f32_16x16x32_bf16 v[8:11], a[128:131], v[144:147], v[8:11]
  ds_read_b128 a[156:159], v215 offset:36864
  v_lshrrev_b32 v209, 4, v242
  v_mfma_f32_16x16x32_bf16 v[16:19], a[128:131], v[160:163], v[200:203]
  v_exp_f32 v0, v0
  v_mfma_f32_16x16x32_bf16 v[16:19], a[132:135], v[164:167], v[16:19]
  buffer_load_dwordx4 v237, s[16:19], s29 offen offset:3072 lds
  v_mfma_f32_16x16x32_bf16 v[16:19], a[136:139], v[168:171], v[16:19]
  s_add_u32 s29, s29, 16384
  v_exp_f32 v1, v1
  v_mfma_f32_16x16x32_bf16 v[16:19], a[140:143], v[172:175], v[16:19]
  v_cvt_pk_bf16_f32 v0, v0, v1
  v_lshrrev_b32 v210, 5, v209
  v_mfma_f32_16x16x32_bf16 v[24:27], a[140:143], v[188:191], v[204:207]
  s_add_u32 m0, s28, 0
  v_exp_f32 v2, v2
  v_mfma_f32_16x16x32_bf16 v[24:27], a[136:139], v[184:187], v[24:27]
  buffer_load_dwordx4 v232, s[12:15], s29 offen offset:0 lds
  v_mfma_f32_16x16x32_bf16 v[24:27], a[132:135], v[180:183], v[24:27]
  s_waitcnt lgkmcnt(0)
  v_exp_f32 v3, v3
  v_mfma_f32_16x16x32_bf16 v[24:27], a[128:131], v[176:179], v[24:27]
  v_cvt_pk_bf16_f32 v1, v2, v3
  v_lshlrev_b32 v210, 30, v210
  v_mfma_f32_16x16x32_bf16 v[4:7], a[144:147], v[128:131], v[192:195]
  v_exp_f32 v8, v8
  v_mfma_f32_16x16x32_bf16 v[4:7], a[148:151], v[132:135], v[4:7]
  ds_read_b128 a[128:131], v212 offset:40960
  v_or_b32 v210, v210, v208
  v_mfma_f32_16x16x32_bf16 v[4:7], a[152:155], v[136:139], v[4:7]
  v_exp_f32 v9, v9
  v_mfma_f32_16x16x32_bf16 v[4:7], a[156:159], v[140:143], v[4:7]
  ds_read_b128 a[132:135], v213 offset:40960
  v_cvt_pk_bf16_f32 v8, v8, v9
  v_mfma_f32_16x16x32_bf16 v[12:15], a[156:159], v[156:159], v[196:199]
  v_exp_f32 v10, v10
  v_mfma_f32_16x16x32_bf16 v[12:15], a[152:155], v[152:155], v[12:15]
  ds_read_b128 a[136:139], v214 offset:40960
  v_bfe_u32 v211, v209, 2, 4
  v_mfma_f32_16x16x32_bf16 v[12:15], a[148:151], v[148:151], v[12:15]
  v_exp_f32 v11, v11
  v_mfma_f32_16x16x32_bf16 v[12:15], a[144:147], v[144:147], v[12:15]
  ds_read_b128 a[140:143], v215 offset:40960
  v_cvt_pk_bf16_f32 v9, v10, v11
  v_mfma_f32_16x16x32_bf16 v[20:23], a[144:147], v[160:163], v[200:203]
  v_exp_f32 v16, v16
  v_mfma_f32_16x16x32_bf16 v[20:23], a[148:151], v[164:167], v[20:23]
  buffer_load_dwordx4 v233, s[12:15], s29 offen offset:1024 lds
  v_mfma_f32_16x16x32_bf16 v[20:23], a[152:155], v[168:171], v[20:23]
  v_exp_f32 v17, v17
  v_mfma_f32_16x16x32_bf16 v[20:23], a[156:159], v[172:175], v[20:23]
  v_cvt_pk_bf16_f32 v16, v16, v17
  v_and_b32 v209, 3, v209
  v_mfma_f32_16x16x32_bf16 v[28:31], a[156:159], v[188:191], v[204:207]
  v_exp_f32 v18, v18
  v_mfma_f32_16x16x32_bf16 v[28:31], a[152:155], v[184:187], v[28:31]
  buffer_load_dwordx4 v234, s[12:15], s29 offen offset:2048 lds
  v_mfma_f32_16x16x32_bf16 v[28:31], a[148:151], v[180:183], v[28:31]
  s_waitcnt lgkmcnt(0)
  v_exp_f32 v19, v19
  v_mfma_f32_16x16x32_bf16 v[28:31], a[144:147], v[176:179], v[28:31]
  v_cvt_pk_bf16_f32 v17, v18, v19
  v_lshlrev_b32 v209, 3, v209
  v_mfma_f32_16x16x32_bf16 v[32:35], a[128:131], v[128:131], v[192:195]
  v_exp_f32 v24, v24
  v_mfma_f32_16x16x32_bf16 v[32:35], a[132:135], v[132:135], v[32:35]
  ds_read_b128 a[144:147], v212 offset:45056
  v_lshl_add_u32 v209, v211, 5, v209
  v_mfma_f32_16x16x32_bf16 v[32:35], a[136:139], v[136:139], v[32:35]
  v_exp_f32 v25, v25
  v_mfma_f32_16x16x32_bf16 v[32:35], a[140:143], v[140:143], v[32:35]
  ds_read_b128 a[148:151], v213 offset:45056
  v_cvt_pk_bf16_f32 v24, v24, v25
  v_mfma_f32_16x16x32_bf16 v[40:43], a[140:143], v[156:159], v[196:199]
  v_exp_f32 v26, v26
  v_mfma_f32_16x16x32_bf16 v[40:43], a[136:139], v[152:155], v[40:43]
  ds_read_b128 a[152:155], v214 offset:45056
  v_add_u32 v209, s50, v209
  v_mfma_f32_16x16x32_bf16 v[40:43], a[132:135], v[148:151], v[40:43]
  s_and_b32 s39, s2, 1
  s_lshl_b32 s39, s39, 2
  s_add_u32 s39, s39, s3
  s_lshr_b32 s31, s2, 1
  s_mul_i32 s30, s31, 40960
  s_mul_i32 s48, s39, 160
  s_add_u32 s30, s30, s48
  s_mul_i32 s31, s31, 5120
  s_mul_i32 s39, s39, 655360
  s_add_u32 s31, s31, s39
  s_add_u32 s31, s31, 3145728
  s_lshr_b32 s39, s2, 3
  s_min_u32 s39, s39, 29
  s_and_b32 s48, s2, 7
  s_mul_i32 s48, s48, 30
  s_add_u32 s39, s39, s48
  s_mul_i32 s98, s39, 1639
  s_lshr_b32 s98, s98, 16
  s_mul_i32 s99, s98, 40
  s_sub_u32 s99, s39, s99
  s_min_u32 s39, s3, 2
  s_mul_i32 s48, s98, 3
  s_add_u32 s48, s48, s39
  s_mul_i32 s100, s48, 122880
  s_lshl_b32 s39, s99, 5
  s_add_u32 s100, s100, s39
  s_mul_i32 s101, s48, 192
  s_add_u32 s101, s101, 2633728
  s_mov_b32 s51, s50
  v_exp_f32 v27, v27
  v_mfma_f32_16x16x32_bf16 v[40:43], a[128:131], v[144:147], v[40:43]
  ds_read_b128 a[156:159], v215 offset:45056
  v_cvt_pk_bf16_f32 v25, v26, v27
  v_mfma_f32_16x16x32_bf16 v[48:51], a[128:131], v[160:163], v[200:203]
  v_exp_f32 v4, v4
  v_mfma_f32_16x16x32_bf16 v[48:51], a[132:135], v[164:167], v[48:51]
  buffer_load_dwordx4 v235, s[12:15], s29 offen offset:3072 lds
  v_mfma_f32_16x16x32_bf16 v[48:51], a[136:139], v[168:171], v[48:51]
  v_exp_f32 v5, v5
  v_mfma_f32_16x16x32_bf16 v[48:51], a[140:143], v[172:175], v[48:51]
  v_cvt_pk_bf16_f32 v2, v4, v5
  v_mov_b32 v211, v242
  v_mfma_f32_16x16x32_bf16 v[56:59], a[140:143], v[188:191], v[204:207]
  s_mov_b32 s4, s94
  s_mov_b32 s5, s95
  s_mov_b32 s6, 2211840
  s_mov_b32 s7, 0x20000
  v_exp_f32 v6, v6
  v_mfma_f32_16x16x32_bf16 v[56:59], a[136:139], v[184:187], v[56:59]
  v_mfma_f32_16x16x32_bf16 v[56:59], a[132:135], v[180:183], v[56:59]
  s_waitcnt lgkmcnt(0)
  v_exp_f32 v7, v7
  v_mfma_f32_16x16x32_bf16 v[56:59], a[128:131], v[176:179], v[56:59]
  v_cvt_pk_bf16_f32 v3, v6, v7
  v_mfma_f32_16x16x32_bf16 v[36:39], a[144:147], v[128:131], v[192:195]
  v_exp_f32 v12, v12
  v_mfma_f32_16x16x32_bf16 v[36:39], a[148:151], v[132:135], v[36:39]
  ds_read_b64_tr_b16 a[160:161], v216 offset:16384
  v_mfma_f32_16x16x32_bf16 v[36:39], a[152:155], v[136:139], v[36:39]
  v_exp_f32 v13, v13
  v_mfma_f32_16x16x32_bf16 v[36:39], a[156:159], v[140:143], v[36:39]
  ds_read_b64_tr_b16 a[162:163], v216 offset:20480
  v_cvt_pk_bf16_f32 v10, v12, v13
  v_mfma_f32_16x16x32_bf16 v[44:47], a[156:159], v[156:159], v[196:199]
  v_exp_f32 v14, v14
  v_mfma_f32_16x16x32_bf16 v[44:47], a[152:155], v[152:155], v[44:47]
  ds_read_b64_tr_b16 a[164:165], v216 offset:24576
  v_mfma_f32_16x16x32_bf16 v[44:47], a[148:151], v[148:151], v[44:47]
  v_exp_f32 v15, v15
  v_mfma_f32_16x16x32_bf16 v[44:47], a[144:147], v[144:147], v[44:47]
  ds_read_b64_tr_b16 a[166:167], v216 offset:28672
  v_cvt_pk_bf16_f32 v11, v14, v15
  v_mfma_f32_16x16x32_bf16 v[52:55], a[144:147], v[160:163], v[200:203]
  v_exp_f32 v20, v20
  v_mfma_f32_16x16x32_bf16 v[52:55], a[148:151], v[164:167], v[52:55]
  ds_read_b64_tr_b16 a[168:169], v217 offset:16384
  v_mfma_f32_16x16x32_bf16 v[52:55], a[152:155], v[168:171], v[52:55]
  v_exp_f32 v21, v21
  v_mfma_f32_16x16x32_bf16 v[52:55], a[156:159], v[172:175], v[52:55]
  ds_read_b64_tr_b16 a[170:171], v217 offset:20480
  v_cvt_pk_bf16_f32 v18, v20, v21
  v_mfma_f32_16x16x32_bf16 v[60:63], a[156:159], v[188:191], v[204:207]
  v_exp_f32 v22, v22
  v_mfma_f32_16x16x32_bf16 v[60:63], a[152:155], v[184:187], v[60:63]
  ds_read_b64_tr_b16 a[172:173], v217 offset:24576
  v_mfma_f32_16x16x32_bf16 v[60:63], a[148:151], v[180:183], v[60:63]
  v_exp_f32 v23, v23
  v_mfma_f32_16x16x32_bf16 v[60:63], a[144:147], v[176:179], v[60:63]
  ds_read_b64_tr_b16 a[174:175], v217 offset:28672
  v_cvt_pk_bf16_f32 v19, v22, v23
  v_mfma_f32_16x16x32_bf16 a[192:195], a[208:211], v[64:67], a[192:195]
  v_exp_f32 v28, v28
  v_mfma_f32_16x16x32_bf16 a[192:195], a[208:211], v[96:99], a[192:195]
  ds_read_b64_tr_b16 a[176:177], v218 offset:16384
  v_mfma_f32_16x16x32_bf16 a[196:199], a[208:211], v[72:75], a[196:199]
  v_exp_f32 v29, v29
  v_mfma_f32_16x16x32_bf16 a[196:199], a[208:211], v[104:107], a[196:199]
  ds_read_b64_tr_b16 a[178:179], v218 offset:20480
  v_cvt_pk_bf16_f32 v26, v28, v29
  v_mfma_f32_16x16x32_bf16 a[200:203], a[208:211], v[80:83], a[200:203]
  v_exp_f32 v30, v30
  v_mfma_f32_16x16x32_bf16 a[200:203], a[208:211], v[112:115], a[200:203]
  ds_read_b64_tr_b16 a[180:181], v218 offset:24576
  v_mfma_f32_16x16x32_bf16 a[204:207], a[208:211], v[88:91], a[204:207]
  s_waitcnt lgkmcnt(7)
  v_exp_f32 v31, v31
  v_mfma_f32_16x16x32_bf16 a[204:207], a[208:211], v[120:123], a[204:207]
  ds_read_b64_tr_b16 a[182:183], v218 offset:28672
  v_cvt_pk_bf16_f32 v27, v30, v31
  v_mfma_f32_16x16x32_bf16 a[0:3], a[160:163], v[64:67], a[0:3]
  v_exp_f32 v32, v32
  v_mfma_f32_16x16x32_bf16 a[0:3], a[164:167], v[96:99], a[0:3]
  ds_read_b64_tr_b16 a[184:185], v219 offset:16384
  v_mfma_f32_16x16x32_bf16 a[4:7], a[164:167], v[104:107], a[4:7]
  v_exp_f32 v33, v33
  v_mfma_f32_16x16x32_bf16 a[4:7], a[160:163], v[72:75], a[4:7]
  ds_read_b64_tr_b16 a[186:187], v219 offset:20480
  v_cvt_pk_bf16_f32 v32, v32, v33
  v_mfma_f32_16x16x32_bf16 a[8:11], a[160:163], v[80:83], a[8:11]
  v_exp_f32 v34, v34
  v_mfma_f32_16x16x32_bf16 a[8:11], a[164:167], v[112:115], a[8:11]
  ds_read_b64_tr_b16 a[188:189], v219 offset:24576
  v_mfma_f32_16x16x32_bf16 a[12:15], a[164:167], v[120:123], a[12:15]
  s_waitcnt lgkmcnt(7)
  v_exp_f32 v35, v35
  v_mfma_f32_16x16x32_bf16 a[12:15], a[160:163], v[88:91], a[12:15]
  ds_read_b64_tr_b16 a[190:191], v219 offset:28672
  v_cvt_pk_bf16_f32 v33, v34, v35
  v_mfma_f32_16x16x32_bf16 a[16:19], a[168:171], v[64:67], a[16:19]
  v_exp_f32 v40, v40
  v_mfma_f32_16x16x32_bf16 a[16:19], a[172:175], v[96:99], a[16:19]
  ds_read_b64_tr_b16 a[160:161], v220 offset:16384
  v_mfma_f32_16x16x32_bf16 a[20:23], a[172:175], v[104:107], a[20:23]
  v_exp_f32 v41, v41
  v_mfma_f32_16x16x32_bf16 a[20:23], a[168:171], v[72:75], a[20:23]
  ds_read_b64_tr_b16 a[162:163], v220 offset:20480
  v_cvt_pk_bf16_f32 v40, v40, v41
  v_mfma_f32_16x16x32_bf16 a[24:27], a[168:171], v[80:83], a[24:27]
  v_exp_f32 v42, v42
  v_mfma_f32_16x16x32_bf16 a[24:27], a[172:175], v[112:115], a[24:27]
  ds_read_b64_tr_b16 a[164:165], v220 offset:24576
  v_mfma_f32_16x16x32_bf16 a[28:31], a[172:175], v[120:123], a[28:31]
  s_waitcnt lgkmcnt(7)
  v_exp_f32 v43, v43
  v_mfma_f32_16x16x32_bf16 a[28:31], a[168:171], v[88:91], a[28:31]
  ds_read_b64_tr_b16 a[166:167], v220 offset:28672
  v_cvt_pk_bf16_f32 v41, v42, v43
  v_mfma_f32_16x16x32_bf16 a[32:35], a[176:179], v[64:67], a[32:35]
  v_exp_f32 v48, v48
  v_mfma_f32_16x16x32_bf16 a[32:35], a[180:183], v[96:99], a[32:35]
  ds_read_b64_tr_b16 a[168:169], v221 offset:16384
  v_mfma_f32_16x16x32_bf16 a[36:39], a[180:183], v[104:107], a[36:39]
  v_exp_f32 v49, v49
  v_mfma_f32_16x16x32_bf16 a[36:39], a[176:179], v[72:75], a[36:39]
  ds_read_b64_tr_b16 a[170:171], v221 offset:20480
  v_cvt_pk_bf16_f32 v48, v48, v49
  v_mfma_f32_16x16x32_bf16 a[40:43], a[176:179], v[80:83], a[40:43]
  v_exp_f32 v50, v50
  v_mfma_f32_16x16x32_bf16 a[40:43], a[180:183], v[112:115], a[40:43]
  ds_read_b64_tr_b16 a[172:173], v221 offset:24576
  v_mfma_f32_16x16x32_bf16 a[44:47], a[180:183], v[120:123], a[44:47]
  s_waitcnt lgkmcnt(7)
  v_exp_f32 v51, v51
  v_mfma_f32_16x16x32_bf16 a[44:47], a[176:179], v[88:91], a[44:47]
  ds_read_b64_tr_b16 a[174:175], v221 offset:28672
  v_cvt_pk_bf16_f32 v49, v50, v51
  v_mfma_f32_16x16x32_bf16 a[48:51], a[184:187], v[64:67], a[48:51]
  v_exp_f32 v56, v56
  v_mfma_f32_16x16x32_bf16 a[48:51], a[188:191], v[96:99], a[48:51]
  ds_read_b64_tr_b16 a[176:177], v222 offset:16384
  v_mfma_f32_16x16x32_bf16 a[52:55], a[188:191], v[104:107], a[52:55]
  v_exp_f32 v57, v57
  v_mfma_f32_16x16x32_bf16 a[52:55], a[184:187], v[72:75], a[52:55]
  ds_read_b64_tr_b16 a[178:179], v222 offset:20480
  v_cvt_pk_bf16_f32 v56, v56, v57
  v_mfma_f32_16x16x32_bf16 a[56:59], a[184:187], v[80:83], a[56:59]
  v_exp_f32 v58, v58
  v_mfma_f32_16x16x32_bf16 a[56:59], a[188:191], v[112:115], a[56:59]
  ds_read_b64_tr_b16 a[180:181], v222 offset:24576
  v_mfma_f32_16x16x32_bf16 a[60:63], a[188:191], v[120:123], a[60:63]
  s_waitcnt lgkmcnt(7)
  v_exp_f32 v59, v59
  v_mfma_f32_16x16x32_bf16 a[60:63], a[184:187], v[88:91], a[60:63]
  ds_read_b64_tr_b16 a[182:183], v222 offset:28672
  v_cvt_pk_bf16_f32 v57, v58, v59
  v_mfma_f32_16x16x32_bf16 a[64:67], a[160:163], v[64:67], a[64:67]
  v_exp_f32 v36, v36
  v_mfma_f32_16x16x32_bf16 a[64:67], a[164:167], v[96:99], a[64:67]
  ds_read_b64_tr_b16 a[184:185], v223 offset:16384
  v_mfma_f32_16x16x32_bf16 a[68:71], a[164:167], v[104:107], a[68:71]
  v_exp_f32 v37, v37
  v_mfma_f32_16x16x32_bf16 a[68:71], a[160:163], v[72:75], a[68:71]
  ds_read_b64_tr_b16 a[186:187], v223 offset:20480
  v_cvt_pk_bf16_f32 v34, v36, v37
  v_mfma_f32_16x16x32_bf16 a[72:75], a[160:163], v[80:83], a[72:75]
  v_exp_f32 v38, v38
  v_mfma_f32_16x16x32_bf16 a[72:75], a[164:167], v[112:115], a[72:75]
  ds_read_b64_tr_b16 a[188:189], v223 offset:24576
  v_mfma_f32_16x16x32_bf16 a[76:79], a[164:167], v[120:123], a[76:79]
  s_waitcnt lgkmcnt(7)
  v_exp_f32 v39, v39
  v_mfma_f32_16x16x32_bf16 a[76:79], a[160:163], v[88:91], a[76:79]
  ds_read_b64_tr_b16 a[190:191], v223 offset:28672
  v_cvt_pk_bf16_f32 v35, v38, v39
  v_mfma_f32_16x16x32_bf16 a[80:83], a[168:171], v[64:67], a[80:83]
  s_waitcnt vmcnt(9)
  v_exp_f32 v44, v44
  v_mfma_f32_16x16x32_bf16 a[80:83], a[172:175], v[96:99], a[80:83]
  v_mfma_f32_16x16x32_bf16 a[84:87], a[172:175], v[104:107], a[84:87]
  s_barrier
  v_exp_f32 v45, v45
  v_mfma_f32_16x16x32_bf16 a[84:87], a[168:171], v[72:75], a[84:87]
  ds_read_b128 a[128:131], v212 offset:49152
  v_cvt_pk_bf16_f32 v42, v44, v45
  v_mfma_f32_16x16x32_bf16 a[88:91], a[168:171], v[80:83], a[88:91]
  v_exp_f32 v46, v46
  v_mfma_f32_16x16x32_bf16 a[88:91], a[172:175], v[112:115], a[88:91]
  ds_read_b128 a[132:135], v213 offset:49152
  v_mfma_f32_16x16x32_bf16 a[92:95], a[172:175], v[120:123], a[92:95]
  s_waitcnt lgkmcnt(6)
  v_exp_f32 v47, v47
  v_mfma_f32_16x16x32_bf16 a[92:95], a[168:171], v[88:91], a[92:95]
  ds_read_b128 a[136:139], v214 offset:49152
  v_cvt_pk_bf16_f32 v43, v46, v47
  v_mfma_f32_16x16x32_bf16 a[96:99], a[176:179], v[64:67], a[96:99]
  v_exp_f32 v52, v52
  v_mfma_f32_16x16x32_bf16 a[96:99], a[180:183], v[96:99], a[96:99]
  ds_read_b128 a[140:143], v215 offset:49152
  v_mfma_f32_16x16x32_bf16 a[100:103], a[180:183], v[104:107], a[100:103]
  v_exp_f32 v53, v53
  v_mfma_f32_16x16x32_bf16 a[100:103], a[176:179], v[72:75], a[100:103]
  v_cvt_pk_bf16_f32 v50, v52, v53
  v_mfma_f32_16x16x32_bf16 a[104:107], a[176:179], v[80:83], a[104:107]
  v_exp_f32 v54, v54
  v_mfma_f32_16x16x32_bf16 a[104:107], a[180:183], v[112:115], a[104:107]
  v_mfma_f32_16x16x32_bf16 a[108:111], a[180:183], v[120:123], a[108:111]
  s_waitcnt lgkmcnt(4)
  v_exp_f32 v55, v55
  v_mfma_f32_16x16x32_bf16 a[108:111], a[176:179], v[88:91], a[108:111]
  v_cvt_pk_bf16_f32 v51, v54, v55
  v_mfma_f32_16x16x32_bf16 a[112:115], a[184:187], v[64:67], a[112:115]
  v_exp_f32 v60, v60
  v_mfma_f32_16x16x32_bf16 a[112:115], a[188:191], v[96:99], a[112:115]
  v_mfma_f32_16x16x32_bf16 a[116:119], a[188:191], v[104:107], a[116:119]
  v_exp_f32 v61, v61
  v_mfma_f32_16x16x32_bf16 a[116:119], a[184:187], v[72:75], a[116:119]
  v_cvt_pk_bf16_f32 v58, v60, v61
  v_mfma_f32_16x16x32_bf16 a[120:123], a[184:187], v[80:83], a[120:123]
  v_exp_f32 v62, v62
  v_mfma_f32_16x16x32_bf16 a[120:123], a[188:191], v[112:115], a[120:123]
  v_mfma_f32_16x16x32_bf16 a[124:127], a[188:191], v[120:123], a[124:127]
  s_waitcnt lgkmcnt(0)
  v_exp_f32 v63, v63
  v_mfma_f32_16x16x32_bf16 a[124:127], a[184:187], v[88:91], a[124:127]
  v_cvt_pk_bf16_f32 v59, v62, v63
  v_mfma_f32_16x16x32_bf16 v[64:67], a[128:131], v[128:131], v[192:195]
  s_add_u32 m0, s28, 65536
  v_lshrrev_b32 v224, 4, v242
  v_lshrrev_b32 v225, 4, v224
  v_mfma_f32_16x16x32_bf16 v[64:67], a[132:135], v[132:135], v[64:67]
  ds_read_b128 a[144:147], v212 offset:53248
  v_bfe_u32 v226, v224, 2, 2
  v_mfma_f32_16x16x32_bf16 v[64:67], a[136:139], v[136:139], v[64:67]
  buffer_load_dwordx4 v236, s[16:19], s29 offen offset:0 lds
  v_mfma_f32_16x16x32_bf16 v[64:67], a[140:143], v[140:143], v[64:67]
  ds_read_b128 a[148:151], v213 offset:53248
  v_lshl_add_u32 v225, v225, 3, v226
  v_mfma_f32_16x16x32_bf16 v[72:75], a[140:143], v[156:159], v[196:199]
  buffer_load_dwordx4 v237, s[16:19], s29 offen offset:1024 lds
  v_mfma_f32_16x16x32_bf16 v[72:75], a[136:139], v[152:155], v[72:75]
  ds_read_b128 a[152:155], v214 offset:53248
  v_lshlrev_b32 v225, 4, v225
  v_mfma_f32_16x16x32_bf16 v[72:75], a[132:135], v[148:151], v[72:75]
  buffer_load_dwordx4 v236, s[16:19], s29 offen offset:2048 lds
  v_mfma_f32_16x16x32_bf16 v[72:75], a[128:131], v[144:147], v[72:75]
  ds_read_b128 a[156:159], v215 offset:53248
  v_bfe_u32 v226, v224, 1, 1
  v_mfma_f32_16x16x32_bf16 v[80:83], a[128:131], v[160:163], v[200:203]
  v_exp_f32 v64, v64
  v_mfma_f32_16x16x32_bf16 v[80:83], a[132:135], v[164:167], v[80:83]
  buffer_load_dwordx4 v237, s[16:19], s29 offen offset:3072 lds
  v_mfma_f32_16x16x32_bf16 v[80:83], a[136:139], v[168:171], v[80:83]
  s_add_u32 s29, s29, 16384
  v_exp_f32 v65, v65
  v_mfma_f32_16x16x32_bf16 v[80:83], a[140:143], v[172:175], v[80:83]
  v_cvt_pk_bf16_f32 v64, v64, v65
  v_mul_u32_u24 v226, 0xc00, v226
  v_mfma_f32_16x16x32_bf16 v[88:91], a[140:143], v[188:191], v[204:207]
  s_add_u32 m0, s28, 16384
  v_exp_f32 v66, v66
  v_mfma_f32_16x16x32_bf16 v[88:91], a[136:139], v[184:187], v[88:91]
  buffer_load_dwordx4 v232, s[12:15], s29 offen offset:0 lds
  v_mfma_f32_16x16x32_bf16 v[88:91], a[132:135], v[180:183], v[88:91]
  s_waitcnt lgkmcnt(0)
  v_exp_f32 v67, v67
  v_mfma_f32_16x16x32_bf16 v[88:91], a[128:131], v[176:179], v[88:91]
  v_cvt_pk_bf16_f32 v65, v66, v67
  v_add3_u32 v225, v225, v226, s50
  v_mfma_f32_16x16x32_bf16 v[68:71], a[144:147], v[128:131], v[192:195]
  v_exp_f32 v72, v72
  v_mfma_f32_16x16x32_bf16 v[68:71], a[148:151], v[132:135], v[68:71]
  ds_read_b128 a[128:131], v212 offset:57344
  v_and_b32 v226, 1, v224
  v_mfma_f32_16x16x32_bf16 v[68:71], a[152:155], v[136:139], v[68:71]
  v_exp_f32 v73, v73
  v_mfma_f32_16x16x32_bf16 v[68:71], a[156:159], v[140:143], v[68:71]
  ds_read_b128 a[132:135], v213 offset:57344
  v_cvt_pk_bf16_f32 v72, v72, v73
  v_mfma_f32_16x16x32_bf16 v[76:79], a[156:159], v[156:159], v[196:199]
  v_exp_f32 v74, v74
  v_mfma_f32_16x16x32_bf16 v[76:79], a[152:155], v[152:155], v[76:79]
  ds_read_b128 a[136:139], v214 offset:57344
  v_lshl_add_u32 v225, v226, 3, v225
  v_mfma_f32_16x16x32_bf16 v[76:79], a[148:151], v[148:151], v[76:79]
  s_waitcnt vmcnt(13)
  v_exp_f32 v75, v75
  v_mfma_f32_16x16x32_bf16 v[76:79], a[144:147], v[144:147], v[76:79]
  ds_read_b128 a[140:143], v215 offset:57344
  v_cvt_pk_bf16_f32 v73, v74, v75
  v_mfma_f32_16x16x32_bf16 v[84:87], a[144:147], v[160:163], v[200:203]
  v_exp_f32 v80, v80
  v_mfma_f32_16x16x32_bf16 v[84:87], a[148:151], v[164:167], v[84:87]
  buffer_load_dwordx4 v233, s[12:15], s29 offen offset:1024 lds
  v_mfma_f32_16x16x32_bf16 v[84:87], a[152:155], v[168:171], v[84:87]
  v_exp_f32 v81, v81
  v_mfma_f32_16x16x32_bf16 v[84:87], a[156:159], v[172:175], v[84:87]
  ds_read_b64_tr_b16 a[232:233], v225 offset:0
  v_cvt_pk_bf16_f32 v80, v80, v81
  v_mfma_f32_16x16x32_bf16 v[92:95], a[156:159], v[188:191], v[204:207]
  v_exp_f32 v82, v82
  v_mfma_f32_16x16x32_bf16 v[92:95], a[152:155], v[184:187], v[92:95]
  buffer_load_dwordx4 v234, s[12:15], s29 offen offset:2048 lds
  v_mfma_f32_16x16x32_bf16 v[92:95], a[148:151], v[180:183], v[92:95]
  s_waitcnt lgkmcnt(1)
  v_exp_f32 v83, v83
  v_mfma_f32_16x16x32_bf16 v[92:95], a[144:147], v[176:179], v[92:95]
  ds_read_b64_tr_b16 a[234:235], v225 offset:64
  v_cvt_pk_bf16_f32 v81, v82, v83
  v_mfma_f32_16x16x32_bf16 v[96:99], a[128:131], v[128:131], v[192:195]
  v_exp_f32 v88, v88
  v_mfma_f32_16x16x32_bf16 v[96:99], a[132:135], v[132:135], v[96:99]
  ds_read_b128 a[144:147], v212 offset:61440
  ds_read_b64_tr_b16 a[236:237], v225 offset:512
  v_mfma_f32_16x16x32_bf16 v[96:99], a[136:139], v[136:139], v[96:99]
  v_exp_f32 v89, v89
  v_mfma_f32_16x16x32_bf16 v[96:99], a[140:143], v[140:143], v[96:99]
  ds_read_b128 a[148:151], v213 offset:61440
  v_cvt_pk_bf16_f32 v88, v88, v89
  v_mfma_f32_16x16x32_bf16 v[104:107], a[140:143], v[156:159], v[196:199]
  v_exp_f32 v90, v90
  v_mfma_f32_16x16x32_bf16 v[104:107], a[136:139], v[152:155], v[104:107]
  ds_read_b128 a[152:155], v214 offset:61440
  ds_read_b64_tr_b16 a[238:239], v225 offset:576
  v_mfma_f32_16x16x32_bf16 v[104:107], a[132:135], v[148:151], v[104:107]
  v_exp_f32 v91, v91
  v_mfma_f32_16x16x32_bf16 v[104:107], a[128:131], v[144:147], v[104:107]
  ds_read_b128 a[156:159], v215 offset:61440
  v_cvt_pk_bf16_f32 v89, v90, v91
  v_mfma_f32_16x16x32_bf16 v[112:115], a[128:131], v[160:163], v[200:203]
  v_exp_f32 v68, v68
  v_mfma_f32_16x16x32_bf16 v[112:115], a[132:135], v[164:167], v[112:115]
  buffer_load_dwordx4 v235, s[12:15], s29 offen offset:3072 lds
  v_mfma_f32_16x16x32_bf16 v[112:115], a[136:139], v[168:171], v[112:115]
  v_exp_f32 v69, v69
  v_mfma_f32_16x16x32_bf16 v[112:115], a[140:143], v[172:175], v[112:115]
  ds_read_b64_tr_b16 a[240:241], v225 offset:1024
  v_cvt_pk_bf16_f32 v66, v68, v69
  v_mfma_f32_16x16x32_bf16 v[120:123], a[140:143], v[188:191], v[204:207]
  v_exp_f32 v70, v70
  v_mfma_f32_16x16x32_bf16 v[120:123], a[136:139], v[184:187], v[120:123]
  ds_read_b64_tr_b16 a[242:243], v225 offset:1088
  ds_read_b64_tr_b16 a[244:245], v225 offset:1536
  v_mfma_f32_16x16x32_bf16 v[120:123], a[132:135], v[180:183], v[120:123]
  s_waitcnt lgkmcnt(3)
  v_exp_f32 v71, v71
  v_mfma_f32_16x16x32_bf16 v[120:123], a[128:131], v[176:179], v[120:123]
  ds_read_b64_tr_b16 a[246:247], v225 offset:1600
  v_cvt_pk_bf16_f32 v67, v70, v71
  v_mfma_f32_16x16x32_bf16 v[100:103], a[144:147], v[128:131], v[192:195]
  v_exp_f32 v76, v76
  v_mfma_f32_16x16x32_bf16 v[100:103], a[148:151], v[132:135], v[100:103]
  ds_read_b64_tr_b16 a[160:161], v216 offset:32768
  ds_read_b64_tr_b16 a[248:249], v225 offset:2048
  v_mfma_f32_16x16x32_bf16 v[100:103], a[152:155], v[136:139], v[100:103]
  v_exp_f32 v77, v77
  v_mfma_f32_16x16x32_bf16 v[100:103], a[156:159], v[140:143], v[100:103]
  ds_read_b64_tr_b16 a[162:163], v216 offset:36864
  v_cvt_pk_bf16_f32 v74, v76, v77
  v_mfma_f32_16x16x32_bf16 v[108:111], a[156:159], v[156:159], v[196:199]
  v_exp_f32 v78, v78
  v_mfma_f32_16x16x32_bf16 v[108:111], a[152:155], v[152:155], v[108:111]
  ds_read_b64_tr_b16 a[164:165], v216 offset:40960
  ds_read_b64_tr_b16 a[250:251], v225 offset:2112
  v_mfma_f32_16x16x32_bf16 v[108:111], a[148:151], v[148:151], v[108:111]
  v_exp_f32 v79, v79
  v_mfma_f32_16x16x32_bf16 v[108:111], a[144:147], v[144:147], v[108:111]
  ds_read_b64_tr_b16 a[166:167], v216 offset:45056
  v_cvt_pk_bf16_f32 v75, v78, v79
  v_mfma_f32_16x16x32_bf16 v[116:119], a[144:147], v[160:163], v[200:203]
  v_exp_f32 v84, v84
  v_mfma_f32_16x16x32_bf16 v[116:119], a[148:151], v[164:167], v[116:119]
  ds_read_b64_tr_b16 a[168:169], v217 offset:32768
  v_mfma_f32_16x16x32_bf16 v[116:119], a[152:155], v[168:171], v[116:119]
  v_exp_f32 v85, v85
  v_mfma_f32_16x16x32_bf16 v[116:119], a[156:159], v[172:175], v[116:119]
  ds_read_b64_tr_b16 a[170:171], v217 offset:36864
  v_cvt_pk_bf16_f32 v82, v84, v85
  v_mfma_f32_16x16x32_bf16 v[124:127], a[156:159], v[188:191], v[204:207]
  v_exp_f32 v86, v86
  v_mfma_f32_16x16x32_bf16 v[124:127], a[152:155], v[184:187], v[124:127]
  ds_read_b64_tr_b16 a[172:173], v217 offset:40960
  s_waitcnt lgkmcnt(4)
  v_mfma_f32_16x16x32_bf16 v[228:231], a[232:235], a[212:215], 0
  v_mfma_f32_16x16x32_bf16 v[228:231], a[236:239], a[216:219], v[228:231]
  v_mfma_f32_16x16x32_bf16 v[228:231], a[240:243], a[220:223], v[228:231]
  v_mfma_f32_16x16x32_bf16 v[228:231], a[244:247], a[224:227], v[228:231]
  v_mfma_f32_16x16x32_bf16 v[228:231], a[248:251], a[228:231], v[228:231]
  v_mfma_f32_16x16x32_bf16 v[124:127], a[148:151], v[180:183], v[124:127]
  s_lshl_b32 s35, s3, 10
  s_add_u32 s35, s35, 159744
  v_exp_f32 v87, v87
  v_mfma_f32_16x16x32_bf16 v[124:127], a[144:147], v[176:179], v[124:127]
  ds_read_b64_tr_b16 a[174:175], v217 offset:45056
  v_cvt_pk_bf16_f32 v83, v86, v87
  v_mfma_f32_16x16x32_bf16 a[192:195], a[208:211], v[0:3], a[192:195]
  v_exp_f32 v92, v92
  v_mfma_f32_16x16x32_bf16 a[192:195], a[208:211], v[32:35], a[192:195]
  ds_read_b64_tr_b16 a[176:177], v218 offset:32768
  v_add_u32 v224, s35, v242
  v_mfma_f32_16x16x32_bf16 a[196:199], a[208:211], v[8:11], a[196:199]
  v_exp_f32 v93, v93
  v_mfma_f32_16x16x32_bf16 a[196:199], a[208:211], v[40:43], a[196:199]
  ds_read_b64_tr_b16 a[178:179], v218 offset:36864
  v_cvt_pk_bf16_f32 v90, v92, v93
  v_mfma_f32_16x16x32_bf16 a[200:203], a[208:211], v[16:19], a[200:203]
  v_exp_f32 v94, v94
  v_mfma_f32_16x16x32_bf16 a[200:203], a[208:211], v[48:51], a[200:203]
  ds_read_b64_tr_b16 a[180:181], v218 offset:40960
  ds_write_b128 v224, v[228:231]
  v_mfma_f32_16x16x32_bf16 a[204:207], a[208:211], v[24:27], a[204:207]
  s_waitcnt lgkmcnt(8)
  v_exp_f32 v95, v95
  v_mfma_f32_16x16x32_bf16 a[204:207], a[208:211], v[56:59], a[204:207]
  ds_read_b64_tr_b16 a[182:183], v218 offset:45056
  v_cvt_pk_bf16_f32 v91, v94, v95
  v_mfma_f32_16x16x32_bf16 a[0:3], a[160:163], v[0:3], a[0:3]
  v_exp_f32 v96, v96
  v_mfma_f32_16x16x32_bf16 a[0:3], a[164:167], v[32:35], a[0:3]
  ds_read_b64_tr_b16 a[184:185], v219 offset:32768
  v_mfma_f32_16x16x32_bf16 a[4:7], a[164:167], v[40:43], a[4:7]
  v_exp_f32 v97, v97
  v_mfma_f32_16x16x32_bf16 a[4:7], a[160:163], v[8:11], a[4:7]
  ds_read_b64_tr_b16 a[186:187], v219 offset:36864
  v_cvt_pk_bf16_f32 v96, v96, v97
  v_mfma_f32_16x16x32_bf16 a[8:11], a[160:163], v[16:19], a[8:11]
  v_exp_f32 v98, v98
  v_mfma_f32_16x16x32_bf16 a[8:11], a[164:167], v[48:51], a[8:11]
  ds_read_b64_tr_b16 a[188:189], v219 offset:40960
  s_waitcnt lgkmcnt(4)
  v_lshrrev_b32 v224, 4, v242
  v_mfma_f32_16x16x32_bf16 a[12:15], a[164:167], v[56:59], a[12:15]
  v_exp_f32 v99, v99
  v_mfma_f32_16x16x32_bf16 a[12:15], a[160:163], v[24:27], a[12:15]
  ds_read_b64_tr_b16 a[190:191], v219 offset:45056
  v_cvt_pk_bf16_f32 v97, v98, v99
  v_mfma_f32_16x16x32_bf16 a[16:19], a[168:171], v[0:3], a[16:19]
  v_exp_f32 v104, v104
  v_mfma_f32_16x16x32_bf16 a[16:19], a[172:175], v[32:35], a[16:19]
  ds_read_b64_tr_b16 a[160:161], v220 offset:32768
  v_bfe_u32 v225, v224, 2, 1
  v_mfma_f32_16x16x32_bf16 a[20:23], a[172:175], v[40:43], a[20:23]
  v_exp_f32 v105, v105
  v_mfma_f32_16x16x32_bf16 a[20:23], a[168:171], v[8:11], a[20:23]
  ds_read_b64_tr_b16 a[162:163], v220 offset:36864
  v_cvt_pk_bf16_f32 v104, v104, v105
  v_mfma_f32_16x16x32_bf16 a[24:27], a[168:171], v[16:19], a[24:27]
  v_exp_f32 v106, v106
  v_mfma_f32_16x16x32_bf16 a[24:27], a[172:175], v[48:51], a[24:27]
  ds_read_b64_tr_b16 a[164:165], v220 offset:40960
  v_lshlrev_b32 v225, 8, v225
  v_mfma_f32_16x16x32_bf16 a[28:31], a[172:175], v[56:59], a[28:31]
  s_waitcnt lgkmcnt(7)
  v_exp_f32 v107, v107
  v_mfma_f32_16x16x32_bf16 a[28:31], a[168:171], v[24:27], a[28:31]
  ds_read_b64_tr_b16 a[166:167], v220 offset:45056
  v_cvt_pk_bf16_f32 v105, v106, v107
  v_mfma_f32_16x16x32_bf16 a[32:35], a[176:179], v[0:3], a[32:35]
  v_exp_f32 v112, v112
  v_mfma_f32_16x16x32_bf16 a[32:35], a[180:183], v[32:35], a[32:35]
  ds_read_b64_tr_b16 a[168:169], v221 offset:32768
  v_lshrrev_b32 v226, 3, v224
  v_mfma_f32_16x16x32_bf16 a[36:39], a[180:183], v[40:43], a[36:39]
  v_exp_f32 v113, v113
  v_mfma_f32_16x16x32_bf16 a[36:39], a[176:179], v[8:11], a[36:39]
  ds_read_b64_tr_b16 a[170:171], v221 offset:36864
  v_cvt_pk_bf16_f32 v112, v112, v113
  v_mfma_f32_16x16x32_bf16 a[40:43], a[176:179], v[16:19], a[40:43]
  v_exp_f32 v114, v114
  v_mfma_f32_16x16x32_bf16 a[40:43], a[180:183], v[48:51], a[40:43]
  ds_read_b64_tr_b16 a[172:173], v221 offset:40960
  v_lshl_add_u32 v225, v226, 4, v225
  v_mfma_f32_16x16x32_bf16 a[44:47], a[180:183], v[56:59], a[44:47]
  s_waitcnt lgkmcnt(7)
  v_exp_f32 v115, v115
  v_mfma_f32_16x16x32_bf16 a[44:47], a[176:179], v[24:27], a[44:47]
  ds_read_b64_tr_b16 a[174:175], v221 offset:45056
  v_cvt_pk_bf16_f32 v113, v114, v115
  v_mfma_f32_16x16x32_bf16 a[48:51], a[184:187], v[0:3], a[48:51]
  v_exp_f32 v120, v120
  v_mfma_f32_16x16x32_bf16 a[48:51], a[188:191], v[32:35], a[48:51]
  ds_read_b64_tr_b16 a[176:177], v222 offset:32768
  v_and_b32 v227, 3, v224
  v_mfma_f32_16x16x32_bf16 a[52:55], a[188:191], v[40:43], a[52:55]
  v_exp_f32 v121, v121
  v_mfma_f32_16x16x32_bf16 a[52:55], a[184:187], v[8:11], a[52:55]
  ds_read_b64_tr_b16 a[178:179], v222 offset:36864
  v_cvt_pk_bf16_f32 v120, v120, v121
  v_mfma_f32_16x16x32_bf16 a[56:59], a[184:187], v[16:19], a[56:59]
  v_exp_f32 v122, v122
  v_mfma_f32_16x16x32_bf16 a[56:59], a[188:191], v[48:51], a[56:59]
  ds_read_b64_tr_b16 a[180:181], v222 offset:40960
  v_lshl_add_u32 v225, v227, 2, v225
  v_mfma_f32_16x16x32_bf16 a[60:63], a[188:191], v[56:59], a[60:63]
  s_waitcnt lgkmcnt(7)
  v_exp_f32 v123, v123
  v_mfma_f32_16x16x32_bf16 a[60:63], a[184:187], v[24:27], a[60:63]
  ds_read_b64_tr_b16 a[182:183], v222 offset:45056
  v_cvt_pk_bf16_f32 v121, v122, v123
  v_mfma_f32_16x16x32_bf16 a[64:67], a[160:163], v[0:3], a[64:67]
  v_exp_f32 v100, v100
  v_mfma_f32_16x16x32_bf16 a[64:67], a[164:167], v[32:35], a[64:67]
  ds_read_b64_tr_b16 a[184:185], v223 offset:32768
  v_add_u32 v225, 159744, v225
  v_mfma_f32_16x16x32_bf16 a[68:71], a[164:167], v[40:43], a[68:71]
  v_exp_f32 v101, v101
  v_mfma_f32_16x16x32_bf16 a[68:71], a[160:163], v[8:11], a[68:71]
  ds_read_b64_tr_b16 a[186:187], v223 offset:36864
  v_cvt_pk_bf16_f32 v98, v100, v101
  v_mfma_f32_16x16x32_bf16 a[72:75], a[160:163], v[16:19], a[72:75]
  v_exp_f32 v102, v102
  v_mfma_f32_16x16x32_bf16 a[72:75], a[164:167], v[48:51], a[72:75]
  ds_read_b64_tr_b16 a[188:189], v223 offset:40960
  v_mfma_f32_16x16x32_bf16 a[76:79], a[164:167], v[56:59], a[76:79]
  s_waitcnt lgkmcnt(7)
  v_exp_f32 v103, v103
  v_mfma_f32_16x16x32_bf16 a[76:79], a[160:163], v[24:27], a[76:79]
  ds_read_b64_tr_b16 a[190:191], v223 offset:45056
  v_cvt_pk_bf16_f32 v99, v102, v103
  v_mfma_f32_16x16x32_bf16 a[80:83], a[168:171], v[0:3], a[80:83]
  s_waitcnt vmcnt(8)
  v_exp_f32 v108, v108
  v_mfma_f32_16x16x32_bf16 a[80:83], a[172:175], v[32:35], a[80:83]
  v_mfma_f32_16x16x32_bf16 a[84:87], a[172:175], v[40:43], a[84:87]
  s_barrier
  v_exp_f32 v109, v109
  v_mfma_f32_16x16x32_bf16 a[84:87], a[168:171], v[8:11], a[84:87]
  ds_read_b128 a[128:131], v212 offset:0
  v_cvt_pk_bf16_f32 v106, v108, v109
  v_mfma_f32_16x16x32_bf16 a[88:91], a[168:171], v[16:19], a[88:91]
  v_exp_f32 v110, v110
  v_mfma_f32_16x16x32_bf16 a[88:91], a[172:175], v[48:51], a[88:91]
  ds_read_b128 a[132:135], v213 offset:0
  ds_read_b32 v228, v225 offset:0
  v_mfma_f32_16x16x32_bf16 a[92:95], a[172:175], v[56:59], a[92:95]
  s_waitcnt lgkmcnt(7)
  v_exp_f32 v111, v111
  v_mfma_f32_16x16x32_bf16 a[92:95], a[168:171], v[24:27], a[92:95]
  ds_read_b128 a[136:139], v214 offset:0
  v_cvt_pk_bf16_f32 v107, v110, v111
  v_mfma_f32_16x16x32_bf16 a[96:99], a[176:179], v[0:3], a[96:99]
  v_exp_f32 v116, v116
  v_mfma_f32_16x16x32_bf16 a[96:99], a[180:183], v[32:35], a[96:99]
  ds_read_b128 a[140:143], v215 offset:0
  ds_read_b32 v229, v225 offset:1024
  v_mfma_f32_16x16x32_bf16 a[100:103], a[180:183], v[40:43], a[100:103]
  v_exp_f32 v117, v117
  v_mfma_f32_16x16x32_bf16 a[100:103], a[176:179], v[8:11], a[100:103]
  ds_read_b32 v230, v225 offset:2048
  v_cvt_pk_bf16_f32 v114, v116, v117
  v_mfma_f32_16x16x32_bf16 a[104:107], a[176:179], v[16:19], a[104:107]
  v_exp_f32 v118, v118
  v_mfma_f32_16x16x32_bf16 a[104:107], a[180:183], v[48:51], a[104:107]
  ds_read_b32 v231, v225 offset:3072
  ds_read_b32 v238, v225 offset:512
  v_mfma_f32_16x16x32_bf16 a[108:111], a[180:183], v[56:59], a[108:111]
  s_waitcnt lgkmcnt(9)
  v_exp_f32 v119, v119
  v_mfma_f32_16x16x32_bf16 a[108:111], a[176:179], v[24:27], a[108:111]
  ds_read_b32 v239, v225 offset:1536
  v_cvt_pk_bf16_f32 v115, v118, v119
  v_mfma_f32_16x16x32_bf16 a[112:115], a[184:187], v[0:3], a[112:115]
  v_exp_f32 v124, v124
  v_mfma_f32_16x16x32_bf16 a[112:115], a[188:191], v[32:35], a[112:115]
  ds_read_b32 v240, v225 offset:2560
  ds_read_b32 v241, v225 offset:3584
  s_cmp_eq_u32 s3, 0
  s_cselect_b32 s35, 0, 1073741824
  v_mfma_f32_16x16x32_bf16 a[116:119], a[188:191], v[40:43], a[116:119]
  v_exp_f32 v125, v125
  v_mfma_f32_16x16x32_bf16 a[116:119], a[184:187], v[8:11], a[116:119]
  v_cvt_pk_bf16_f32 v122, v124, v125
  v_mul_u32_u24 v226, 0xd80, v226
  v_mfma_f32_16x16x32_bf16 a[120:123], a[184:187], v[16:19], a[120:123]
  v_exp_f32 v126, v126
  v_mfma_f32_16x16x32_bf16 a[120:123], a[188:191], v[48:51], a[120:123]
  v_and_b32 v227, 7, v224
  v_lshl_add_u32 v226, v227, 1, v226
  v_mfma_f32_16x16x32_bf16 a[124:127], a[188:191], v[56:59], a[124:127]
  s_waitcnt lgkmcnt(7)
  v_exp_f32 v127, v127
  v_mfma_f32_16x16x32_bf16 a[124:127], a[184:187], v[24:27], a[124:127]
  v_cvt_pk_bf16_f32 v123, v126, v127
  v_and_b32 v227, 1, v224
  v_lshl_add_u32 v226, v227, 30, v226
  v_or_b32 v226, s35, v226
  v_min_u32 v249, 1, v224
  v_lshlrev_b32 v249, 30, v249
  v_or_b32 v249, s35, v249
  v_mov_b32 v251, v249
  v_mov_b32 v250, 1
  s_mov_b32 s47, 2818048
  s_lshl_b32 s35, s33, 4
  s_add_u32 s35, s35, 2633728
  s_waitcnt lgkmcnt(0)
  v_add_f32 v228, v228, v229
  v_add_f32 v238, v238, v239
  v_add_f32 v230, v230, v231
  v_add_f32 v240, v240, v241
  v_add_f32 v228, v228, v230
  v_add_f32 v238, v238, v240
  v_cvt_pk_bf16_f32 v228, v228, v228
  v_cvt_pk_bf16_f32 v238, v238, v238
  v_lshlrev_b32 v228, 16, v228
  v_lshlrev_b32 v238, 16, v238
  v_mul_f32 v229, 0xbfb8aa3b, v228
  v_exp_f32 v229, v229
  s_nop 0
  v_add_f32 v229, 1.0, v229
  v_rcp_f32 v229, v229
  s_nop 0
  v_mul_f32 v228, v228, v229
  v_cvt_pk_bf16_f32 v228, v228, v228
  v_lshlrev_b32 v228, 16, v228
  v_mul_f32 v228, v228, v238
  s_nop 1
  v_mov_b32_dpp v229, v228 quad_perm:[1,0,3,2] row_mask:0xf bank_mask:0xf
  v_cvt_pk_bf16_f32 v228, v228, v229
  buffer_store_dword v228, v226, s[24:27], s35 offen sc1
  s_mov_b32 s32, 6
attn_loop:
  v_mfma_f32_16x16x32_bf16 v[0:3], a[128:131], v[128:131], v[192:195]
  s_add_u32 m0, s28, 81920
  v_mfma_f32_16x16x32_bf16 v[0:3], a[132:135], v[132:135], v[0:3]
  ds_read_b128 a[144:147], v212 offset:4096
  v_mfma_f32_16x16x32_bf16 v[0:3], a[136:139], v[136:139], v[0:3]
  buffer_load_dwordx4 v236, s[16:19], s29 offen offset:0 lds
  v_mfma_f32_16x16x32_bf16 v[0:3], a[140:143], v[140:143], v[0:3]
  ds_read_b128 a[148:151], v213 offset:4096
  v_mfma_f32_16x16x32_bf16 v[8:11], a[140:143], v[156:159], v[196:199]
  buffer_load_dwordx4 v237, s[16:19], s29 offen offset:1024 lds
  v_mfma_f32_16x16x32_bf16 v[8:11], a[136:139], v[152:155], v[8:11]
  ds_read_b128 a[152:155], v214 offset:4096
  v_mfma_f32_16x16x32_bf16 v[8:11], a[132:135], v[148:151], v[8:11]
  buffer_load_dwordx4 v236, s[16:19], s29 offen offset:2048 lds
  v_mfma_f32_16x16x32_bf16 v[8:11], a[128:131], v[144:147], v[8:11]
  ds_read_b128 a[156:159], v215 offset:4096
  v_mfma_f32_16x16x32_bf16 v[16:19], a[128:131], v[160:163], v[200:203]
  v_exp_f32 v0, v0
  v_mfma_f32_16x16x32_bf16 v[16:19], a[132:135], v[164:167], v[16:19]
  buffer_load_dwordx4 v237, s[16:19], s29 offen offset:3072 lds
  v_mfma_f32_16x16x32_bf16 v[16:19], a[136:139], v[168:171], v[16:19]
  s_add_u32 s29, s29, 16384
  v_exp_f32 v1, v1
  v_mfma_f32_16x16x32_bf16 v[16:19], a[140:143], v[172:175], v[16:19]
  v_cvt_pk_bf16_f32 v0, v0, v1
  v_mfma_f32_16x16x32_bf16 v[24:27], a[140:143], v[188:191], v[204:207]
  s_add_u32 m0, s28, 32768
  v_exp_f32 v2, v2
  v_mfma_f32_16x16x32_bf16 v[24:27], a[136:139], v[184:187], v[24:27]
  buffer_load_dwordx4 v232, s[12:15], s29 offen offset:0 lds
  v_mfma_f32_16x16x32_bf16 v[24:27], a[132:135], v[180:183], v[24:27]
  s_waitcnt lgkmcnt(0)
  v_exp_f32 v3, v3
  v_mfma_f32_16x16x32_bf16 v[24:27], a[128:131], v[176:179], v[24:27]
  v_cvt_pk_bf16_f32 v1, v2, v3
  v_mfma_f32_16x16x32_bf16 v[4:7], a[144:147], v[128:131], v[192:195]
  v_exp_f32 v8, v8
  v_mfma_f32_16x16x32_bf16 v[4:7], a[148:151], v[132:135], v[4:7]
  ds_read_b128 a[128:131], v212 offset:8192
  v_mfma_f32_16x16x32_bf16 v[4:7], a[152:155], v[136:139], v[4:7]
  v_exp_f32 v9, v9
  v_mfma_f32_16x16x32_bf16 v[4:7], a[156:159], v[140:143], v[4:7]
  ds_read_b128 a[132:135], v213 offset:8192
  v_cvt_pk_bf16_f32 v8, v8, v9
  v_mfma_f32_16x16x32_bf16 v[12:15], a[156:159], v[156:159], v[196:199]
  v_exp_f32 v10, v10
  v_mfma_f32_16x16x32_bf16 v[12:15], a[152:155], v[152:155], v[12:15]
  ds_read_b128 a[136:139], v214 offset:8192
  v_mfma_f32_16x16x32_bf16 v[12:15], a[148:151], v[148:151], v[12:15]
  v_exp_f32 v11, v11
  v_mfma_f32_16x16x32_bf16 v[12:15], a[144:147], v[144:147], v[12:15]
  ds_read_b128 a[140:143], v215 offset:8192
  v_cvt_pk_bf16_f32 v9, v10, v11
  v_mfma_f32_16x16x32_bf16 v[20:23], a[144:147], v[160:163], v[200:203]
  v_exp_f32 v16, v16
  v_mfma_f32_16x16x32_bf16 v[20:23], a[148:151], v[164:167], v[20:23]
  buffer_load_dwordx4 v233, s[12:15], s29 offen offset:1024 lds
  v_mfma_f32_16x16x32_bf16 v[20:23], a[152:155], v[168:171], v[20:23]
  v_exp_f32 v17, v17
  v_mfma_f32_16x16x32_bf16 v[20:23], a[156:159], v[172:175], v[20:23]
  v_cvt_pk_bf16_f32 v16, v16, v17
  v_mfma_f32_16x16x32_bf16 v[28:31], a[156:159], v[188:191], v[204:207]
  v_exp_f32 v18, v18
  v_mfma_f32_16x16x32_bf16 v[28:31], a[152:155], v[184:187], v[28:31]
  buffer_load_dwordx4 v234, s[12:15], s29 offen offset:2048 lds
  v_mfma_f32_16x16x32_bf16 v[28:31], a[148:151], v[180:183], v[28:31]
  s_waitcnt lgkmcnt(0)
  v_exp_f32 v19, v19
  v_mfma_f32_16x16x32_bf16 v[28:31], a[144:147], v[176:179], v[28:31]
  v_cvt_pk_bf16_f32 v17, v18, v19
  v_mfma_f32_16x16x32_bf16 v[32:35], a[128:131], v[128:131], v[192:195]
  v_exp_f32 v24, v24
  v_mfma_f32_16x16x32_bf16 v[32:35], a[132:135], v[132:135], v[32:35]
  ds_read_b128 a[144:147], v212 offset:12288
  v_mfma_f32_16x16x32_bf16 v[32:35], a[136:139], v[136:139], v[32:35]
  v_exp_f32 v25, v25
  v_mfma_f32_16x16x32_bf16 v[32:35], a[140:143], v[140:143], v[32:35]
  ds_read_b128 a[148:151], v213 offset:12288
  v_cvt_pk_bf16_f32 v24, v24, v25
  v_mfma_f32_16x16x32_bf16 v[40:43], a[140:143], v[156:159], v[196:199]
  v_exp_f32 v26, v26
  v_mfma_f32_16x16x32_bf16 v[40:43], a[136:139], v[152:155], v[40:43]
  ds_read_b128 a[152:155], v214 offset:12288
  v_mfma_f32_16x16x32_bf16 v[40:43], a[132:135], v[148:151], v[40:43]
  v_exp_f32 v27, v27
  v_mfma_f32_16x16x32_bf16 v[40:43], a[128:131], v[144:147], v[40:43]
  ds_read_b128 a[156:159], v215 offset:12288
  v_cvt_pk_bf16_f32 v25, v26, v27
  v_mfma_f32_16x16x32_bf16 v[48:51], a[128:131], v[160:163], v[200:203]
  v_exp_f32 v4, v4
  v_mfma_f32_16x16x32_bf16 v[48:51], a[132:135], v[164:167], v[48:51]
  buffer_load_dwordx4 v235, s[12:15], s29 offen offset:3072 lds
  v_mfma_f32_16x16x32_bf16 v[48:51], a[136:139], v[168:171], v[48:51]
  v_exp_f32 v5, v5
  v_mfma_f32_16x16x32_bf16 v[48:51], a[140:143], v[172:175], v[48:51]
  v_cvt_pk_bf16_f32 v2, v4, v5
  v_mfma_f32_16x16x32_bf16 v[56:59], a[140:143], v[188:191], v[204:207]
  s_add_u32 m0, s50, 4096
  v_exp_f32 v6, v6
  v_mfma_f32_16x16x32_bf16 v[56:59], a[136:139], v[184:187], v[56:59]
  buffer_load_dwordx4 v208, s[20:23], s30 offen lds
  s_add_u32 s30, s30, 32
  v_mfma_f32_16x16x32_bf16 v[56:59], a[132:135], v[180:183], v[56:59]
  s_waitcnt lgkmcnt(0)
  v_exp_f32 v7, v7
  v_mfma_f32_16x16x32_bf16 v[56:59], a[128:131], v[176:179], v[56:59]
  v_cvt_pk_bf16_f32 v3, v6, v7
  v_mfma_f32_16x16x32_bf16 v[36:39], a[144:147], v[128:131], v[192:195]
  v_exp_f32 v12, v12
  v_mfma_f32_16x16x32_bf16 v[36:39], a[148:151], v[132:135], v[36:39]
  ds_read_b64_tr_b16 a[160:161], v216 offset:49152
  v_mfma_f32_16x16x32_bf16 v[36:39], a[152:155], v[136:139], v[36:39]
  v_exp_f32 v13, v13
  v_mfma_f32_16x16x32_bf16 v[36:39], a[156:159], v[140:143], v[36:39]
  ds_read_b64_tr_b16 a[162:163], v216 offset:53248
  v_cvt_pk_bf16_f32 v10, v12, v13
  v_mfma_f32_16x16x32_bf16 v[44:47], a[156:159], v[156:159], v[196:199]
  v_exp_f32 v14, v14
  v_mfma_f32_16x16x32_bf16 v[44:47], a[152:155], v[152:155], v[44:47]
  ds_read_b64_tr_b16 a[164:165], v216 offset:57344
  v_mfma_f32_16x16x32_bf16 v[44:47], a[148:151], v[148:151], v[44:47]
  v_exp_f32 v15, v15
  v_mfma_f32_16x16x32_bf16 v[44:47], a[144:147], v[144:147], v[44:47]
  ds_read_b64_tr_b16 a[166:167], v216 offset:61440
  v_cvt_pk_bf16_f32 v11, v14, v15
  v_mfma_f32_16x16x32_bf16 v[52:55], a[144:147], v[160:163], v[200:203]
  v_exp_f32 v20, v20
  v_mfma_f32_16x16x32_bf16 v[52:55], a[148:151], v[164:167], v[52:55]
  ds_read_b64_tr_b16 a[168:169], v217 offset:49152
  v_mfma_f32_16x16x32_bf16 v[52:55], a[152:155], v[168:171], v[52:55]
  v_exp_f32 v21, v21
  v_mfma_f32_16x16x32_bf16 v[52:55], a[156:159], v[172:175], v[52:55]
  ds_read_b64_tr_b16 a[170:171], v217 offset:53248
  v_cvt_pk_bf16_f32 v18, v20, v21
  v_mfma_f32_16x16x32_bf16 v[60:63], a[156:159], v[188:191], v[204:207]
  v_exp_f32 v22, v22
  v_mfma_f32_16x16x32_bf16 v[60:63], a[152:155], v[184:187], v[60:63]
  ds_read_b64_tr_b16 a[172:173], v217 offset:57344
  v_mfma_f32_16x16x32_bf16 v[60:63], a[148:151], v[180:183], v[60:63]
  v_exp_f32 v23, v23
  v_mfma_f32_16x16x32_bf16 v[60:63], a[144:147], v[176:179], v[60:63]
  ds_read_b64_tr_b16 a[174:175], v217 offset:61440
  v_cvt_pk_bf16_f32 v19, v22, v23
  v_mfma_f32_16x16x32_bf16 a[192:195], a[208:211], v[64:67], a[192:195]
  v_exp_f32 v28, v28
  v_mfma_f32_16x16x32_bf16 a[192:195], a[208:211], v[96:99], a[192:195]
  ds_read_b64_tr_b16 a[176:177], v218 offset:49152
  v_mfma_f32_16x16x32_bf16 a[196:199], a[208:211], v[72:75], a[196:199]
  v_exp_f32 v29, v29
  v_mfma_f32_16x16x32_bf16 a[196:199], a[208:211], v[104:107], a[196:199]
  ds_read_b64_tr_b16 a[178:179], v218 offset:53248
  v_cvt_pk_bf16_f32 v26, v28, v29
  v_mfma_f32_16x16x32_bf16 a[200:203], a[208:211], v[80:83], a[200:203]
  v_exp_f32 v30, v30
  v_mfma_f32_16x16x32_bf16 a[200:203], a[208:211], v[112:115], a[200:203]
  ds_read_b64_tr_b16 a[180:181], v218 offset:57344
  v_mfma_f32_16x16x32_bf16 a[204:207], a[208:211], v[88:91], a[204:207]
  s_waitcnt lgkmcnt(7)
  v_exp_f32 v31, v31
  v_mfma_f32_16x16x32_bf16 a[204:207], a[208:211], v[120:123], a[204:207]
  ds_read_b64_tr_b16 a[182:183], v218 offset:61440
  v_cvt_pk_bf16_f32 v27, v30, v31
  v_mfma_f32_16x16x32_bf16 a[0:3], a[160:163], v[64:67], a[0:3]
  v_exp_f32 v32, v32
  v_mfma_f32_16x16x32_bf16 a[0:3], a[164:167], v[96:99], a[0:3]
  ds_read_b64_tr_b16 a[184:185], v219 offset:49152
  v_mfma_f32_16x16x32_bf16 a[4:7], a[164:167], v[104:107], a[4:7]
  v_exp_f32 v33, v33
  v_mfma_f32_16x16x32_bf16 a[4:7], a[160:163], v[72:75], a[4:7]
  ds_read_b64_tr_b16 a[186:187], v219 offset:53248
  v_cvt_pk_bf16_f32 v32, v32, v33
  v_mfma_f32_16x16x32_bf16 a[8:11], a[160:163], v[80:83], a[8:11]
  v_exp_f32 v34, v34
  v_mfma_f32_16x16x32_bf16 a[8:11], a[164:167], v[112:115], a[8:11]
  ds_read_b64_tr_b16 a[188:189], v219 offset:57344
  v_mfma_f32_16x16x32_bf16 a[12:15], a[164:167], v[120:123], a[12:15]
  s_waitcnt lgkmcnt(7)
  v_exp_f32 v35, v35
  v_mfma_f32_16x16x32_bf16 a[12:15], a[160:163], v[88:91], a[12:15]
  ds_read_b64_tr_b16 a[190:191], v219 offset:61440
  v_cvt_pk_bf16_f32 v33, v34, v35
  v_mfma_f32_16x16x32_bf16 a[16:19], a[168:171], v[64:67], a[16:19]
  v_exp_f32 v40, v40
  v_mfma_f32_16x16x32_bf16 a[16:19], a[172:175], v[96:99], a[16:19]
  ds_read_b64_tr_b16 a[160:161], v220 offset:49152
  v_mfma_f32_16x16x32_bf16 a[20:23], a[172:175], v[104:107], a[20:23]
  v_exp_f32 v41, v41
  v_mfma_f32_16x16x32_bf16 a[20:23], a[168:171], v[72:75], a[20:23]
  ds_read_b64_tr_b16 a[162:163], v220 offset:53248
  v_cvt_pk_bf16_f32 v40, v40, v41
  v_mfma_f32_16x16x32_bf16 a[24:27], a[168:171], v[80:83], a[24:27]
  v_exp_f32 v42, v42
  v_mfma_f32_16x16x32_bf16 a[24:27], a[172:175], v[112:115], a[24:27]
  ds_read_b64_tr_b16 a[164:165], v220 offset:57344
  v_mfma_f32_16x16x32_bf16 a[28:31], a[172:175], v[120:123], a[28:31]
  s_waitcnt lgkmcnt(7)
  v_exp_f32 v43, v43
  v_mfma_f32_16x16x32_bf16 a[28:31], a[168:171], v[88:91], a[28:31]
  ds_read_b64_tr_b16 a[166:167], v220 offset:61440
  v_cvt_pk_bf16_f32 v41, v42, v43
  v_mfma_f32_16x16x32_bf16 a[32:35], a[176:179], v[64:67], a[32:35]
  v_exp_f32 v48, v48
  v_mfma_f32_16x16x32_bf16 a[32:35], a[180:183], v[96:99], a[32:35]
  ds_read_b64_tr_b16 a[168:169], v221 offset:49152
  v_mfma_f32_16x16x32_bf16 a[36:39], a[180:183], v[104:107], a[36:39]
  v_exp_f32 v49, v49
  v_mfma_f32_16x16x32_bf16 a[36:39], a[176:179], v[72:75], a[36:39]
  ds_read_b64_tr_b16 a[170:171], v221 offset:53248
  v_cvt_pk_bf16_f32 v48, v48, v49
  v_mfma_f32_16x16x32_bf16 a[40:43], a[176:179], v[80:83], a[40:43]
  v_exp_f32 v50, v50
  v_mfma_f32_16x16x32_bf16 a[40:43], a[180:183], v[112:115], a[40:43]
  ds_read_b64_tr_b16 a[172:173], v221 offset:57344
  v_mfma_f32_16x16x32_bf16 a[44:47], a[180:183], v[120:123], a[44:47]
  s_waitcnt lgkmcnt(7)
  v_exp_f32 v51, v51
  v_mfma_f32_16x16x32_bf16 a[44:47], a[176:179], v[88:91], a[44:47]
  ds_read_b64_tr_b16 a[174:175], v221 offset:61440
  v_cvt_pk_bf16_f32 v49, v50, v51
  v_mfma_f32_16x16x32_bf16 a[48:51], a[184:187], v[64:67], a[48:51]
  v_exp_f32 v56, v56
  v_mfma_f32_16x16x32_bf16 a[48:51], a[188:191], v[96:99], a[48:51]
  ds_read_b64_tr_b16 a[176:177], v222 offset:49152
  v_mfma_f32_16x16x32_bf16 a[52:55], a[188:191], v[104:107], a[52:55]
  v_exp_f32 v57, v57
  v_mfma_f32_16x16x32_bf16 a[52:55], a[184:187], v[72:75], a[52:55]
  ds_read_b64_tr_b16 a[178:179], v222 offset:53248
  v_cvt_pk_bf16_f32 v56, v56, v57
  v_mfma_f32_16x16x32_bf16 a[56:59], a[184:187], v[80:83], a[56:59]
  v_exp_f32 v58, v58
  v_mfma_f32_16x16x32_bf16 a[56:59], a[188:191], v[112:115], a[56:59]
  ds_read_b64_tr_b16 a[180:181], v222 offset:57344
  v_mfma_f32_16x16x32_bf16 a[60:63], a[188:191], v[120:123], a[60:63]
  s_waitcnt lgkmcnt(7)
  v_exp_f32 v59, v59
  v_mfma_f32_16x16x32_bf16 a[60:63], a[184:187], v[88:91], a[60:63]
  ds_read_b64_tr_b16 a[182:183], v222 offset:61440
  v_cvt_pk_bf16_f32 v57, v58, v59
  v_mfma_f32_16x16x32_bf16 a[64:67], a[160:163], v[64:67], a[64:67]
  v_exp_f32 v36, v36
  v_mfma_f32_16x16x32_bf16 a[64:67], a[164:167], v[96:99], a[64:67]
  ds_read_b64_tr_b16 a[184:185], v223 offset:49152
  v_mfma_f32_16x16x32_bf16 a[68:71], a[164:167], v[104:107], a[68:71]
  v_exp_f32 v37, v37
  v_mfma_f32_16x16x32_bf16 a[68:71], a[160:163], v[72:75], a[68:71]
  ds_read_b64_tr_b16 a[186:187], v223 offset:53248
  v_cvt_pk_bf16_f32 v34, v36, v37
  v_mfma_f32_16x16x32_bf16 a[72:75], a[160:163], v[80:83], a[72:75]
  v_exp_f32 v38, v38
  v_mfma_f32_16x16x32_bf16 a[72:75], a[164:167], v[112:115], a[72:75]
  ds_read_b64_tr_b16 a[188:189], v223 offset:57344
  v_mfma_f32_16x16x32_bf16 a[76:79], a[164:167], v[120:123], a[76:79]
  s_waitcnt lgkmcnt(7)
  v_exp_f32 v39, v39
  v_mfma_f32_16x16x32_bf16 a[76:79], a[160:163], v[88:91], a[76:79]
  ds_read_b64_tr_b16 a[190:191], v223 offset:61440
  v_cvt_pk_bf16_f32 v35, v38, v39
  v_mfma_f32_16x16x32_bf16 a[80:83], a[168:171], v[64:67], a[80:83]
  s_waitcnt vmcnt(10)
  v_exp_f32 v44, v44
  v_mfma_f32_16x16x32_bf16 a[80:83], a[172:175], v[96:99], a[80:83]
  v_mfma_f32_16x16x32_bf16 a[84:87], a[172:175], v[104:107], a[84:87]
  s_barrier
  v_exp_f32 v45, v45
  v_mfma_f32_16x16x32_bf16 a[84:87], a[168:171], v[72:75], a[84:87]
  ds_read_b128 a[128:131], v212 offset:16384
  v_cvt_pk_bf16_f32 v42, v44, v45
  v_mfma_f32_16x16x32_bf16 a[88:91], a[168:171], v[80:83], a[88:91]
  v_exp_f32 v46, v46
  v_mfma_f32_16x16x32_bf16 a[88:91], a[172:175], v[112:115], a[88:91]
  ds_read_b128 a[132:135], v213 offset:16384
  v_mfma_f32_16x16x32_bf16 a[92:95], a[172:175], v[120:123], a[92:95]
  s_waitcnt lgkmcnt(6)
  v_exp_f32 v47, v47
  v_mfma_f32_16x16x32_bf16 a[92:95], a[168:171], v[88:91], a[92:95]
  ds_read_b128 a[136:139], v214 offset:16384
  v_cvt_pk_bf16_f32 v43, v46, v47
  v_mfma_f32_16x16x32_bf16 a[96:99], a[176:179], v[64:67], a[96:99]
  v_exp_f32 v52, v52
  v_mfma_f32_16x16x32_bf16 a[96:99], a[180:183], v[96:99], a[96:99]
  ds_read_b128 a[140:143], v215 offset:16384
  v_mfma_f32_16x16x32_bf16 a[100:103], a[180:183], v[104:107], a[100:103]
  v_exp_f32 v53, v53
  v_mfma_f32_16x16x32_bf16 a[100:103], a[176:179], v[72:75], a[100:103]
  v_cvt_pk_bf16_f32 v50, v52, v53
  v_mfma_f32_16x16x32_bf16 a[104:107], a[176:179], v[80:83], a[104:107]
  v_exp_f32 v54, v54
  v_mfma_f32_16x16x32_bf16 a[104:107], a[180:183], v[112:115], a[104:107]
  v_mfma_f32_16x16x32_bf16 a[108:111], a[180:183], v[120:123], a[108:111]
  s_waitcnt lgkmcnt(4)
  v_exp_f32 v55, v55
  v_mfma_f32_16x16x32_bf16 a[108:111], a[176:179], v[88:91], a[108:111]
  v_cvt_pk_bf16_f32 v51, v54, v55
  v_mfma_f32_16x16x32_bf16 a[112:115], a[184:187], v[64:67], a[112:115]
  v_exp_f32 v60, v60
  v_mfma_f32_16x16x32_bf16 a[112:115], a[188:191], v[96:99], a[112:115]
  v_mfma_f32_16x16x32_bf16 a[116:119], a[188:191], v[104:107], a[116:119]
  v_exp_f32 v61, v61
  v_mfma_f32_16x16x32_bf16 a[116:119], a[184:187], v[72:75], a[116:119]
  v_cvt_pk_bf16_f32 v58, v60, v61
  v_mfma_f32_16x16x32_bf16 a[120:123], a[184:187], v[80:83], a[120:123]
  v_exp_f32 v62, v62
  v_mfma_f32_16x16x32_bf16 a[120:123], a[188:191], v[112:115], a[120:123]
  v_mfma_f32_16x16x32_bf16 a[124:127], a[188:191], v[120:123], a[124:127]
  s_waitcnt lgkmcnt(0)
  v_exp_f32 v63, v63
  v_mfma_f32_16x16x32_bf16 a[124:127], a[184:187], v[88:91], a[124:127]
  v_cvt_pk_bf16_f32 v59, v62, v63
  v_mfma_f32_16x16x32_bf16 v[64:67], a[128:131], v[128:131], v[192:195]
  s_add_u32 m0, s28, 98304
  v_mfma_f32_16x16x32_bf16 v[64:67], a[132:135], v[132:135], v[64:67]
  ds_read_b128 a[144:147], v212 offset:20480
  v_mfma_f32_16x16x32_bf16 v[64:67], a[136:139], v[136:139], v[64:67]
  buffer_load_dwordx4 v236, s[16:19], s29 offen offset:0 lds
  v_mfma_f32_16x16x32_bf16 v[64:67], a[140:143], v[140:143], v[64:67]
  ds_read_b128 a[148:151], v213 offset:20480
  v_mfma_f32_16x16x32_bf16 v[72:75], a[140:143], v[156:159], v[196:199]
  buffer_load_dwordx4 v237, s[16:19], s29 offen offset:1024 lds
  v_mfma_f32_16x16x32_bf16 v[72:75], a[136:139], v[152:155], v[72:75]
  ds_read_b128 a[152:155], v214 offset:20480
  v_mfma_f32_16x16x32_bf16 v[72:75], a[132:135], v[148:151], v[72:75]
  buffer_load_dwordx4 v236, s[16:19], s29 offen offset:2048 lds
  v_mfma_f32_16x16x32_bf16 v[72:75], a[128:131], v[144:147], v[72:75]
  ds_read_b128 a[156:159], v215 offset:20480
  v_mfma_f32_16x16x32_bf16 v[80:83], a[128:131], v[160:163], v[200:203]
  v_exp_f32 v64, v64
  v_mfma_f32_16x16x32_bf16 v[80:83], a[132:135], v[164:167], v[80:83]
  buffer_load_dwordx4 v237, s[16:19], s29 offen offset:3072 lds
  v_mfma_f32_16x16x32_bf16 v[80:83], a[136:139], v[168:171], v[80:83]
  s_add_u32 s29, s29, 16384
  v_exp_f32 v65, v65
  v_mfma_f32_16x16x32_bf16 v[80:83], a[140:143], v[172:175], v[80:83]
  v_cvt_pk_bf16_f32 v64, v64, v65
  v_mfma_f32_16x16x32_bf16 v[88:91], a[140:143], v[188:191], v[204:207]
  s_add_u32 m0, s28, 49152
  v_exp_f32 v66, v66
  v_mfma_f32_16x16x32_bf16 v[88:91], a[136:139], v[184:187], v[88:91]
  buffer_load_dwordx4 v232, s[12:15], s29 offen offset:0 lds
  v_mfma_f32_16x16x32_bf16 v[88:91], a[132:135], v[180:183], v[88:91]
  s_waitcnt lgkmcnt(0)
  v_exp_f32 v67, v67
  v_mfma_f32_16x16x32_bf16 v[88:91], a[128:131], v[176:179], v[88:91]
  v_cvt_pk_bf16_f32 v65, v66, v67
  v_mfma_f32_16x16x32_bf16 v[68:71], a[144:147], v[128:131], v[192:195]
  v_exp_f32 v72, v72
  v_mfma_f32_16x16x32_bf16 v[68:71], a[148:151], v[132:135], v[68:71]
  ds_read_b128 a[128:131], v212 offset:24576
  v_mfma_f32_16x16x32_bf16 v[68:71], a[152:155], v[136:139], v[68:71]
  v_exp_f32 v73, v73
  v_mfma_f32_16x16x32_bf16 v[68:71], a[156:159], v[140:143], v[68:71]
  ds_read_b128 a[132:135], v213 offset:24576
  v_cvt_pk_bf16_f32 v72, v72, v73
  v_mfma_f32_16x16x32_bf16 v[76:79], a[156:159], v[156:159], v[196:199]
  v_exp_f32 v74, v74
  v_mfma_f32_16x16x32_bf16 v[76:79], a[152:155], v[152:155], v[76:79]
  ds_read_b128 a[136:139], v214 offset:24576
  v_mfma_f32_16x16x32_bf16 v[76:79], a[148:151], v[148:151], v[76:79]
  v_exp_f32 v75, v75
  v_mfma_f32_16x16x32_bf16 v[76:79], a[144:147], v[144:147], v[76:79]
  ds_read_b128 a[140:143], v215 offset:24576
  v_cvt_pk_bf16_f32 v73, v74, v75
  v_mfma_f32_16x16x32_bf16 v[84:87], a[144:147], v[160:163], v[200:203]
  v_exp_f32 v80, v80
  v_mfma_f32_16x16x32_bf16 v[84:87], a[148:151], v[164:167], v[84:87]
  buffer_load_dwordx4 v233, s[12:15], s29 offen offset:1024 lds
  v_mfma_f32_16x16x32_bf16 v[84:87], a[152:155], v[168:171], v[84:87]
  v_exp_f32 v81, v81
  v_mfma_f32_16x16x32_bf16 v[84:87], a[156:159], v[172:175], v[84:87]
  v_cvt_pk_bf16_f32 v80, v80, v81
  v_mfma_f32_16x16x32_bf16 v[92:95], a[156:159], v[188:191], v[204:207]
  v_exp_f32 v82, v82
  v_mfma_f32_16x16x32_bf16 v[92:95], a[152:155], v[184:187], v[92:95]
  buffer_load_dwordx4 v234, s[12:15], s29 offen offset:2048 lds
  v_mfma_f32_16x16x32_bf16 v[92:95], a[148:151], v[180:183], v[92:95]
  s_waitcnt lgkmcnt(0)
  v_exp_f32 v83, v83
  v_mfma_f32_16x16x32_bf16 v[92:95], a[144:147], v[176:179], v[92:95]
  v_cvt_pk_bf16_f32 v81, v82, v83
  v_mfma_f32_16x16x32_bf16 v[96:99], a[128:131], v[128:131], v[192:195]
  v_exp_f32 v88, v88
  v_mfma_f32_16x16x32_bf16 v[96:99], a[132:135], v[132:135], v[96:99]
  ds_read_b128 a[144:147], v212 offset:28672
  v_mfma_f32_16x16x32_bf16 v[96:99], a[136:139], v[136:139], v[96:99]
  v_exp_f32 v89, v89
  v_mfma_f32_16x16x32_bf16 v[96:99], a[140:143], v[140:143], v[96:99]
  ds_read_b128 a[148:151], v213 offset:28672
  v_cvt_pk_bf16_f32 v88, v88, v89
  v_mfma_f32_16x16x32_bf16 v[104:107], a[140:143], v[156:159], v[196:199]
  v_exp_f32 v90, v90
  v_mfma_f32_16x16x32_bf16 v[104:107], a[136:139], v[152:155], v[104:107]
  ds_read_b128 a[152:155], v214 offset:28672
  v_mfma_f32_16x16x32_bf16 v[104:107], a[132:135], v[148:151], v[104:107]
  v_exp_f32 v91, v91
  v_mfma_f32_16x16x32_bf16 v[104:107], a[128:131], v[144:147], v[104:107]
  ds_read_b128 a[156:159], v215 offset:28672
  v_cvt_pk_bf16_f32 v89, v90, v91
  v_mfma_f32_16x16x32_bf16 v[112:115], a[128:131], v[160:163], v[200:203]
  v_exp_f32 v68, v68
  v_mfma_f32_16x16x32_bf16 v[112:115], a[132:135], v[164:167], v[112:115]
  buffer_load_dwordx4 v235, s[12:15], s29 offen offset:3072 lds
  v_mfma_f32_16x16x32_bf16 v[112:115], a[136:139], v[168:171], v[112:115]
  v_exp_f32 v69, v69
  v_mfma_f32_16x16x32_bf16 v[112:115], a[140:143], v[172:175], v[112:115]
  v_cvt_pk_bf16_f32 v66, v68, v69
  v_mfma_f32_16x16x32_bf16 v[120:123], a[140:143], v[188:191], v[204:207]
  s_add_u32 m0, s50, 5120
  v_exp_f32 v70, v70
  v_mfma_f32_16x16x32_bf16 v[120:123], a[136:139], v[184:187], v[120:123]
  buffer_load_dwordx4 v208, s[20:23], s30 offen lds
  s_add_u32 s30, s30, 32
  v_mfma_f32_16x16x32_bf16 v[120:123], a[132:135], v[180:183], v[120:123]
  s_waitcnt lgkmcnt(0)
  v_exp_f32 v71, v71
  v_mfma_f32_16x16x32_bf16 v[120:123], a[128:131], v[176:179], v[120:123]
  v_cvt_pk_bf16_f32 v67, v70, v71
  v_mfma_f32_16x16x32_bf16 v[100:103], a[144:147], v[128:131], v[192:195]
  v_exp_f32 v76, v76
  v_mfma_f32_16x16x32_bf16 v[100:103], a[148:151], v[132:135], v[100:103]
  ds_read_b64_tr_b16 a[160:161], v216 offset:0
  v_mfma_f32_16x16x32_bf16 v[100:103], a[152:155], v[136:139], v[100:103]
  v_exp_f32 v77, v77
  v_mfma_f32_16x16x32_bf16 v[100:103], a[156:159], v[140:143], v[100:103]
  ds_read_b64_tr_b16 a[162:163], v216 offset:4096
  v_cvt_pk_bf16_f32 v74, v76, v77
  v_mfma_f32_16x16x32_bf16 v[108:111], a[156:159], v[156:159], v[196:199]
  v_exp_f32 v78, v78
  v_mfma_f32_16x16x32_bf16 v[108:111], a[152:155], v[152:155], v[108:111]
  ds_read_b64_tr_b16 a[164:165], v216 offset:8192
  v_mfma_f32_16x16x32_bf16 v[108:111], a[148:151], v[148:151], v[108:111]
  v_exp_f32 v79, v79
  v_mfma_f32_16x16x32_bf16 v[108:111], a[144:147], v[144:147], v[108:111]
  ds_read_b64_tr_b16 a[166:167], v216 offset:12288
  v_cvt_pk_bf16_f32 v75, v78, v79
  v_mfma_f32_16x16x32_bf16 v[116:119], a[144:147], v[160:163], v[200:203]
  v_exp_f32 v84, v84
  v_mfma_f32_16x16x32_bf16 v[116:119], a[148:151], v[164:167], v[116:119]
  ds_read_b64_tr_b16 a[168:169], v217 offset:0
  v_mfma_f32_16x16x32_bf16 v[116:119], a[152:155], v[168:171], v[116:119]
  v_exp_f32 v85, v85
  v_mfma_f32_16x16x32_bf16 v[116:119], a[156:159], v[172:175], v[116:119]
  ds_read_b64_tr_b16 a[170:171], v217 offset:4096
  v_cvt_pk_bf16_f32 v82, v84, v85
  v_mfma_f32_16x16x32_bf16 v[124:127], a[156:159], v[188:191], v[204:207]
  v_exp_f32 v86, v86
  v_mfma_f32_16x16x32_bf16 v[124:127], a[152:155], v[184:187], v[124:127]
  ds_read_b64_tr_b16 a[172:173], v217 offset:8192
  v_mfma_f32_16x16x32_bf16 v[124:127], a[148:151], v[180:183], v[124:127]
  v_exp_f32 v87, v87
  v_mfma_f32_16x16x32_bf16 v[124:127], a[144:147], v[176:179], v[124:127]
  ds_read_b64_tr_b16 a[174:175], v217 offset:12288
  v_cvt_pk_bf16_f32 v83, v86, v87
  v_mfma_f32_16x16x32_bf16 a[192:195], a[208:211], v[0:3], a[192:195]
  v_exp_f32 v92, v92
  v_mfma_f32_16x16x32_bf16 a[192:195], a[208:211], v[32:35], a[192:195]
  ds_read_b64_tr_b16 a[176:177], v218 offset:0
  v_mfma_f32_16x16x32_bf16 a[196:199], a[208:211], v[8:11], a[196:199]
  v_exp_f32 v93, v93
  v_mfma_f32_16x16x32_bf16 a[196:199], a[208:211], v[40:43], a[196:199]
  ds_read_b64_tr_b16 a[178:179], v218 offset:4096
  v_cvt_pk_bf16_f32 v90, v92, v93
  v_mfma_f32_16x16x32_bf16 a[200:203], a[208:211], v[16:19], a[200:203]
  v_exp_f32 v94, v94
  v_mfma_f32_16x16x32_bf16 a[200:203], a[208:211], v[48:51], a[200:203]
  ds_read_b64_tr_b16 a[180:181], v218 offset:8192
  v_mfma_f32_16x16x32_bf16 a[204:207], a[208:211], v[24:27], a[204:207]
  s_waitcnt lgkmcnt(7)
  v_exp_f32 v95, v95
  v_mfma_f32_16x16x32_bf16 a[204:207], a[208:211], v[56:59], a[204:207]
  ds_read_b64_tr_b16 a[182:183], v218 offset:12288
  v_cvt_pk_bf16_f32 v91, v94, v95
  v_mfma_f32_16x16x32_bf16 a[0:3], a[160:163], v[0:3], a[0:3]
  v_exp_f32 v96, v96
  v_mfma_f32_16x16x32_bf16 a[0:3], a[164:167], v[32:35], a[0:3]
  ds_read_b64_tr_b16 a[184:185], v219 offset:0
  v_mfma_f32_16x16x32_bf16 a[4:7], a[164:167], v[40:43], a[4:7]
  v_exp_f32 v97, v97
  v_mfma_f32_16x16x32_bf16 a[4:7], a[160:163], v[8:11], a[4:7]
  ds_read_b64_tr_b16 a[186:187], v219 offset:4096
  v_cvt_pk_bf16_f32 v96, v96, v97
  v_mfma_f32_16x16x32_bf16 a[8:11], a[160:163], v[16:19], a[8:11]
  v_exp_f32 v98, v98
  v_mfma_f32_16x16x32_bf16 a[8:11], a[164:167], v[48:51], a[8:11]
  ds_read_b64_tr_b16 a[188:189], v219 offset:8192
  v_mfma_f32_16x16x32_bf16 a[12:15], a[164:167], v[56:59], a[12:15]
  s_waitcnt lgkmcnt(7)
  v_exp_f32 v99, v99
  v_mfma_f32_16x16x32_bf16 a[12:15], a[160:163], v[24:27], a[12:15]
  ds_read_b64_tr_b16 a[190:191], v219 offset:12288
  v_cvt_pk_bf16_f32 v97, v98, v99
  v_mfma_f32_16x16x32_bf16 a[16:19], a[168:171], v[0:3], a[16:19]
  v_exp_f32 v104, v104
  v_mfma_f32_16x16x32_bf16 a[16:19], a[172:175], v[32:35], a[16:19]
  ds_read_b64_tr_b16 a[160:161], v220 offset:0
  v_mfma_f32_16x16x32_bf16 a[20:23], a[172:175], v[40:43], a[20:23]
  v_exp_f32 v105, v105
  v_mfma_f32_16x16x32_bf16 a[20:23], a[168:171], v[8:11], a[20:23]
  ds_read_b64_tr_b16 a[162:163], v220 offset:4096
  v_cvt_pk_bf16_f32 v104, v104, v105
  v_mfma_f32_16x16x32_bf16 a[24:27], a[168:171], v[16:19], a[24:27]
  v_exp_f32 v106, v106
  v_mfma_f32_16x16x32_bf16 a[24:27], a[172:175], v[48:51], a[24:27]
  ds_read_b64_tr_b16 a[164:165], v220 offset:8192
  v_mfma_f32_16x16x32_bf16 a[28:31], a[172:175], v[56:59], a[28:31]
  s_waitcnt lgkmcnt(7)
  v_exp_f32 v107, v107
  v_mfma_f32_16x16x32_bf16 a[28:31], a[168:171], v[24:27], a[28:31]
  ds_read_b64_tr_b16 a[166:167], v220 offset:12288
  v_cvt_pk_bf16_f32 v105, v106, v107
  v_mfma_f32_16x16x32_bf16 a[32:35], a[176:179], v[0:3], a[32:35]
  v_exp_f32 v112, v112
  v_mfma_f32_16x16x32_bf16 a[32:35], a[180:183], v[32:35], a[32:35]
  ds_read_b64_tr_b16 a[168:169], v221 offset:0
  v_mfma_f32_16x16x32_bf16 a[36:39], a[180:183], v[40:43], a[36:39]
  v_exp_f32 v113, v113
  v_mfma_f32_16x16x32_bf16 a[36:39], a[176:179], v[8:11], a[36:39]
  ds_read_b64_tr_b16 a[170:171], v221 offset:4096
  v_cvt_pk_bf16_f32 v112, v112, v113
  v_mfma_f32_16x16x32_bf16 a[40:43], a[176:179], v[16:19], a[40:43]
  v_exp_f32 v114, v114
  v_mfma_f32_16x16x32_bf16 a[40:43], a[180:183], v[48:51], a[40:43]
  ds_read_b64_tr_b16 a[172:173], v221 offset:8192
  v_mfma_f32_16x16x32_bf16 a[44:47], a[180:183], v[56:59], a[44:47]
  s_waitcnt lgkmcnt(7)
  v_exp_f32 v115, v115
  v_mfma_f32_16x16x32_bf16 a[44:47], a[176:179], v[24:27], a[44:47]
  ds_read_b64_tr_b16 a[174:175], v221 offset:12288
  v_cvt_pk_bf16_f32 v113, v114, v115
  v_mfma_f32_16x16x32_bf16 a[48:51], a[184:187], v[0:3], a[48:51]
  v_exp_f32 v120, v120
  v_mfma_f32_16x16x32_bf16 a[48:51], a[188:191], v[32:35], a[48:51]
  ds_read_b64_tr_b16 a[176:177], v222 offset:0
  v_mfma_f32_16x16x32_bf16 a[52:55], a[188:191], v[40:43], a[52:55]
  v_exp_f32 v121, v121
  v_mfma_f32_16x16x32_bf16 a[52:55], a[184:187], v[8:11], a[52:55]
  ds_read_b64_tr_b16 a[178:179], v222 offset:4096
  v_cvt_pk_bf16_f32 v120, v120, v121
  v_mfma_f32_16x16x32_bf16 a[56:59], a[184:187], v[16:19], a[56:59]
  v_exp_f32 v122, v122
  v_mfma_f32_16x16x32_bf16 a[56:59], a[188:191], v[48:51], a[56:59]
  ds_read_b64_tr_b16 a[180:181], v222 offset:8192
  v_mfma_f32_16x16x32_bf16 a[60:63], a[188:191], v[56:59], a[60:63]
  s_waitcnt lgkmcnt(7)
  v_exp_f32 v123, v123
  v_mfma_f32_16x16x32_bf16 a[60:63], a[184:187], v[24:27], a[60:63]
  ds_read_b64_tr_b16 a[182:183], v222 offset:12288
  v_cvt_pk_bf16_f32 v121, v122, v123
  v_mfma_f32_16x16x32_bf16 a[64:67], a[160:163], v[0:3], a[64:67]
  v_exp_f32 v100, v100
  v_mfma_f32_16x16x32_bf16 a[64:67], a[164:167], v[32:35], a[64:67]
  ds_read_b64_tr_b16 a[184:185], v223 offset:0
  v_mfma_f32_16x16x32_bf16 a[68:71], a[164:167], v[40:43], a[68:71]
  v_exp_f32 v101, v101
  v_mfma_f32_16x16x32_bf16 a[68:71], a[160:163], v[8:11], a[68:71]
  ds_read_b64_tr_b16 a[186:187], v223 offset:4096
  v_cvt_pk_bf16_f32 v98, v100, v101
  v_mfma_f32_16x16x32_bf16 a[72:75], a[160:163], v[16:19], a[72:75]
  v_exp_f32 v102, v102
  v_mfma_f32_16x16x32_bf16 a[72:75], a[164:167], v[48:51], a[72:75]
  ds_read_b64_tr_b16 a[188:189], v223 offset:8192
  v_mfma_f32_16x16x32_bf16 a[76:79], a[164:167], v[56:59], a[76:79]
  s_waitcnt lgkmcnt(7)
  v_exp_f32 v103, v103
  v_mfma_f32_16x16x32_bf16 a[76:79], a[160:163], v[24:27], a[76:79]
  ds_read_b64_tr_b16 a[190:191], v223 offset:12288
  v_cvt_pk_bf16_f32 v99, v102, v103
  v_mfma_f32_16x16x32_bf16 a[80:83], a[168:171], v[0:3], a[80:83]
  s_waitcnt vmcnt(10)
  v_exp_f32 v108, v108
  v_mfma_f32_16x16x32_bf16 a[80:83], a[172:175], v[32:35], a[80:83]
  v_mfma_f32_16x16x32_bf16 a[84:87], a[172:175], v[40:43], a[84:87]
  s_barrier
  v_exp_f32 v109, v109
  v_mfma_f32_16x16x32_bf16 a[84:87], a[168:171], v[8:11], a[84:87]
  ds_read_b128 a[128:131], v212 offset:32768
  v_cvt_pk_bf16_f32 v106, v108, v109
  v_mfma_f32_16x16x32_bf16 a[88:91], a[168:171], v[16:19], a[88:91]
  v_exp_f32 v110, v110
  v_mfma_f32_16x16x32_bf16 a[88:91], a[172:175], v[48:51], a[88:91]
  ds_read_b128 a[132:135], v213 offset:32768
  buffer_atomic_add v250, v249, s[24:27], s47 offen
  s_cmp_eq_u32 s32, 4
  s_cselect_b32 s39, 0, 1073741824
  v_mfma_f32_16x16x32_bf16 a[92:95], a[172:175], v[56:59], a[92:95]
  s_waitcnt lgkmcnt(6)
  v_exp_f32 v111, v111
  v_mfma_f32_16x16x32_bf16 a[92:95], a[168:171], v[24:27], a[92:95]
  ds_read_b128 a[136:139], v214 offset:32768
  v_cvt_pk_bf16_f32 v107, v110, v111
  v_mfma_f32_16x16x32_bf16 a[96:99], a[176:179], v[0:3], a[96:99]
  v_exp_f32 v116, v116
  v_mfma_f32_16x16x32_bf16 a[96:99], a[180:183], v[32:35], a[96:99]
  ds_read_b128 a[140:143], v215 offset:32768
  v_or_b32 v249, s39, v251
  v_mfma_f32_16x16x32_bf16 a[100:103], a[180:183], v[40:43], a[100:103]
  v_exp_f32 v117, v117
  v_mfma_f32_16x16x32_bf16 a[100:103], a[176:179], v[8:11], a[100:103]
  v_cvt_pk_bf16_f32 v114, v116, v117
  v_mfma_f32_16x16x32_bf16 a[104:107], a[176:179], v[16:19], a[104:107]
  v_exp_f32 v118, v118
  v_mfma_f32_16x16x32_bf16 a[104:107], a[180:183], v[48:51], a[104:107]
  v_mfma_f32_16x16x32_bf16 a[108:111], a[180:183], v[56:59], a[108:111]
  s_waitcnt lgkmcnt(4)
  v_exp_f32 v119, v119
  v_mfma_f32_16x16x32_bf16 a[108:111], a[176:179], v[24:27], a[108:111]
  v_cvt_pk_bf16_f32 v115, v118, v119
  v_mfma_f32_16x16x32_bf16 a[112:115], a[184:187], v[0:3], a[112:115]
  v_exp_f32 v124, v124
  v_mfma_f32_16x16x32_bf16 a[112:115], a[188:191], v[32:35], a[112:115]
  v_mfma_f32_16x16x32_bf16 a[116:119], a[188:191], v[40:43], a[116:119]
  v_exp_f32 v125, v125
  v_mfma_f32_16x16x32_bf16 a[116:119], a[184:187], v[8:11], a[116:119]
  v_cvt_pk_bf16_f32 v122, v124, v125
  v_mfma_f32_16x16x32_bf16 a[120:123], a[184:187], v[16:19], a[120:123]
  v_exp_f32 v126, v126
  v_mfma_f32_16x16x32_bf16 a[120:123], a[188:191], v[48:51], a[120:123]
  v_mfma_f32_16x16x32_bf16 a[124:127], a[188:191], v[56:59], a[124:127]
  s_waitcnt lgkmcnt(0)
  v_exp_f32 v127, v127
  v_mfma_f32_16x16x32_bf16 a[124:127], a[184:187], v[24:27], a[124:127]
  v_cvt_pk_bf16_f32 v123, v126, v127
  v_mfma_f32_16x16x32_bf16 v[0:3], a[128:131], v[128:131], v[192:195]
  s_add_u32 m0, s28, 114688
  v_mfma_f32_16x16x32_bf16 v[0:3], a[132:135], v[132:135], v[0:3]
  ds_read_b128 a[144:147], v212 offset:36864
  v_mfma_f32_16x16x32_bf16 v[0:3], a[136:139], v[136:139], v[0:3]
  buffer_load_dwordx4 v236, s[16:19], s29 offen offset:0 lds
  v_mfma_f32_16x16x32_bf16 v[0:3], a[140:143], v[140:143], v[0:3]
  ds_read_b128 a[148:151], v213 offset:36864
  v_mfma_f32_16x16x32_bf16 v[8:11], a[140:143], v[156:159], v[196:199]
  buffer_load_dwordx4 v237, s[16:19], s29 offen offset:1024 lds
  v_mfma_f32_16x16x32_bf16 v[8:11], a[136:139], v[152:155], v[8:11]
  ds_read_b128 a[152:155], v214 offset:36864
  v_mfma_f32_16x16x32_bf16 v[8:11], a[132:135], v[148:151], v[8:11]
  buffer_load_dwordx4 v236, s[16:19], s29 offen offset:2048 lds
  v_mfma_f32_16x16x32_bf16 v[8:11], a[128:131], v[144:147], v[8:11]
  ds_read_b128 a[156:159], v215 offset:36864
  v_mfma_f32_16x16x32_bf16 v[16:19], a[128:131], v[160:163], v[200:203]
  v_exp_f32 v0, v0
  v_mfma_f32_16x16x32_bf16 v[16:19], a[132:135], v[164:167], v[16:19]
  buffer_load_dwordx4 v237, s[16:19], s29 offen offset:3072 lds
  v_mfma_f32_16x16x32_bf16 v[16:19], a[136:139], v[168:171], v[16:19]
  s_add_u32 s29, s29, 16384
  v_exp_f32 v1, v1
  v_mfma_f32_16x16x32_bf16 v[16:19], a[140:143], v[172:175], v[16:19]
  v_cvt_pk_bf16_f32 v0, v0, v1
  v_mfma_f32_16x16x32_bf16 v[24:27], a[140:143], v[188:191], v[204:207]
  s_add_u32 m0, s28, 0
  v_exp_f32 v2, v2
  v_mfma_f32_16x16x32_bf16 v[24:27], a[136:139], v[184:187], v[24:27]
  buffer_load_dwordx4 v232, s[12:15], s29 offen offset:0 lds
  v_mfma_f32_16x16x32_bf16 v[24:27], a[132:135], v[180:183], v[24:27]
  s_waitcnt lgkmcnt(0)
  v_exp_f32 v3, v3
  v_mfma_f32_16x16x32_bf16 v[24:27], a[128:131], v[176:179], v[24:27]
  v_cvt_pk_bf16_f32 v1, v2, v3
  v_mfma_f32_16x16x32_bf16 v[4:7], a[144:147], v[128:131], v[192:195]
  v_exp_f32 v8, v8
  v_mfma_f32_16x16x32_bf16 v[4:7], a[148:151], v[132:135], v[4:7]
  ds_read_b128 a[128:131], v212 offset:40960
  v_mfma_f32_16x16x32_bf16 v[4:7], a[152:155], v[136:139], v[4:7]
  v_exp_f32 v9, v9
  v_mfma_f32_16x16x32_bf16 v[4:7], a[156:159], v[140:143], v[4:7]
  ds_read_b128 a[132:135], v213 offset:40960
  v_cvt_pk_bf16_f32 v8, v8, v9
  v_mfma_f32_16x16x32_bf16 v[12:15], a[156:159], v[156:159], v[196:199]
  v_exp_f32 v10, v10
  v_mfma_f32_16x16x32_bf16 v[12:15], a[152:155], v[152:155], v[12:15]
  ds_read_b128 a[136:139], v214 offset:40960
  v_mfma_f32_16x16x32_bf16 v[12:15], a[148:151], v[148:151], v[12:15]
  v_exp_f32 v11, v11
  v_mfma_f32_16x16x32_bf16 v[12:15], a[144:147], v[144:147], v[12:15]
  ds_read_b128 a[140:143], v215 offset:40960
  v_cvt_pk_bf16_f32 v9, v10, v11
  v_mfma_f32_16x16x32_bf16 v[20:23], a[144:147], v[160:163], v[200:203]
  v_exp_f32 v16, v16
  v_mfma_f32_16x16x32_bf16 v[20:23], a[148:151], v[164:167], v[20:23]
  buffer_load_dwordx4 v233, s[12:15], s29 offen offset:1024 lds
  v_mfma_f32_16x16x32_bf16 v[20:23], a[152:155], v[168:171], v[20:23]
  v_exp_f32 v17, v17
  v_mfma_f32_16x16x32_bf16 v[20:23], a[156:159], v[172:175], v[20:23]
  v_cvt_pk_bf16_f32 v16, v16, v17
  v_mfma_f32_16x16x32_bf16 v[28:31], a[156:159], v[188:191], v[204:207]
  v_exp_f32 v18, v18
  v_mfma_f32_16x16x32_bf16 v[28:31], a[152:155], v[184:187], v[28:31]
  buffer_load_dwordx4 v234, s[12:15], s29 offen offset:2048 lds
  v_mfma_f32_16x16x32_bf16 v[28:31], a[148:151], v[180:183], v[28:31]
  s_waitcnt lgkmcnt(0)
  v_exp_f32 v19, v19
  v_mfma_f32_16x16x32_bf16 v[28:31], a[144:147], v[176:179], v[28:31]
  v_cvt_pk_bf16_f32 v17, v18, v19
  v_mfma_f32_16x16x32_bf16 v[32:35], a[128:131], v[128:131], v[192:195]
  v_exp_f32 v24, v24
  v_mfma_f32_16x16x32_bf16 v[32:35], a[132:135], v[132:135], v[32:35]
  ds_read_b128 a[144:147], v212 offset:45056
  v_mfma_f32_16x16x32_bf16 v[32:35], a[136:139], v[136:139], v[32:35]
  v_exp_f32 v25, v25
  v_mfma_f32_16x16x32_bf16 v[32:35], a[140:143], v[140:143], v[32:35]
  ds_read_b128 a[148:151], v213 offset:45056
  v_cvt_pk_bf16_f32 v24, v24, v25
  v_mfma_f32_16x16x32_bf16 v[40:43], a[140:143], v[156:159], v[196:199]
  v_exp_f32 v26, v26
  v_mfma_f32_16x16x32_bf16 v[40:43], a[136:139], v[152:155], v[40:43]
  ds_read_b128 a[152:155], v214 offset:45056
  v_mfma_f32_16x16x32_bf16 v[40:43], a[132:135], v[148:151], v[40:43]
  v_exp_f32 v27, v27
  v_mfma_f32_16x16x32_bf16 v[40:43], a[128:131], v[144:147], v[40:43]
  ds_read_b128 a[156:159], v215 offset:45056
  v_cvt_pk_bf16_f32 v25, v26, v27
  v_mfma_f32_16x16x32_bf16 v[48:51], a[128:131], v[160:163], v[200:203]
  v_exp_f32 v4, v4
  v_mfma_f32_16x16x32_bf16 v[48:51], a[132:135], v[164:167], v[48:51]
  buffer_load_dwordx4 v235, s[12:15], s29 offen offset:3072 lds
  v_mfma_f32_16x16x32_bf16 v[48:51], a[136:139], v[168:171], v[48:51]
  v_exp_f32 v5, v5
  v_mfma_f32_16x16x32_bf16 v[48:51], a[140:143], v[172:175], v[48:51]
  v_cvt_pk_bf16_f32 v2, v4, v5
  v_mfma_f32_16x16x32_bf16 v[56:59], a[140:143], v[188:191], v[204:207]
  s_mov_b32 m0, s51
  v_exp_f32 v6, v6
  v_mfma_f32_16x16x32_bf16 v[56:59], a[136:139], v[184:187], v[56:59]
  buffer_load_dwordx4 v210, s[4:7], s100 offen lds
  s_add_u32 s100, s100, 20480
  s_add_u32 s51, s51, 512
  v_mfma_f32_16x16x32_bf16 v[56:59], a[132:135], v[180:183], v[56:59]
  s_waitcnt lgkmcnt(0)
  v_exp_f32 v7, v7
  v_mfma_f32_16x16x32_bf16 v[56:59], a[128:131], v[176:179], v[56:59]
  v_cvt_pk_bf16_f32 v3, v6, v7
  v_mfma_f32_16x16x32_bf16 v[36:39], a[144:147], v[128:131], v[192:195]
  v_exp_f32 v12, v12
  v_mfma_f32_16x16x32_bf16 v[36:39], a[148:151], v[132:135], v[36:39]
  ds_read_b64_tr_b16 a[160:161], v216 offset:16384
  v_mfma_f32_16x16x32_bf16 v[36:39], a[152:155], v[136:139], v[36:39]
  v_exp_f32 v13, v13
  v_mfma_f32_16x16x32_bf16 v[36:39], a[156:159], v[140:143], v[36:39]
  ds_read_b64_tr_b16 a[162:163], v216 offset:20480
  v_cvt_pk_bf16_f32 v10, v12, v13
  v_mfma_f32_16x16x32_bf16 v[44:47], a[156:159], v[156:159], v[196:199]
  v_exp_f32 v14, v14
  v_mfma_f32_16x16x32_bf16 v[44:47], a[152:155], v[152:155], v[44:47]
  ds_read_b64_tr_b16 a[164:165], v216 offset:24576
  v_mfma_f32_16x16x32_bf16 v[44:47], a[148:151], v[148:151], v[44:47]
  v_exp_f32 v15, v15
  v_mfma_f32_16x16x32_bf16 v[44:47], a[144:147], v[144:147], v[44:47]
  ds_read_b64_tr_b16 a[166:167], v216 offset:28672
  v_cvt_pk_bf16_f32 v11, v14, v15
  v_mfma_f32_16x16x32_bf16 v[52:55], a[144:147], v[160:163], v[200:203]
  v_exp_f32 v20, v20
  v_mfma_f32_16x16x32_bf16 v[52:55], a[148:151], v[164:167], v[52:55]
  ds_read_b64_tr_b16 a[168:169], v217 offset:16384
  v_mfma_f32_16x16x32_bf16 v[52:55], a[152:155], v[168:171], v[52:55]
  v_exp_f32 v21, v21
  v_mfma_f32_16x16x32_bf16 v[52:55], a[156:159], v[172:175], v[52:55]
  ds_read_b64_tr_b16 a[170:171], v217 offset:20480
  v_cvt_pk_bf16_f32 v18, v20, v21
  v_mfma_f32_16x16x32_bf16 v[60:63], a[156:159], v[188:191], v[204:207]
  v_exp_f32 v22, v22
  v_mfma_f32_16x16x32_bf16 v[60:63], a[152:155], v[184:187], v[60:63]
  ds_read_b64_tr_b16 a[172:173], v217 offset:24576
  v_mfma_f32_16x16x32_bf16 v[60:63], a[148:151], v[180:183], v[60:63]
  v_exp_f32 v23, v23
  v_mfma_f32_16x16x32_bf16 v[60:63], a[144:147], v[176:179], v[60:63]
  ds_read_b64_tr_b16 a[174:175], v217 offset:28672
  v_cvt_pk_bf16_f32 v19, v22, v23
  v_mfma_f32_16x16x32_bf16 a[192:195], a[208:211], v[64:67], a[192:195]
  v_exp_f32 v28, v28
  v_mfma_f32_16x16x32_bf16 a[192:195], a[208:211], v[96:99], a[192:195]
  ds_read_b64_tr_b16 a[176:177], v218 offset:16384
  v_mfma_f32_16x16x32_bf16 a[196:199], a[208:211], v[72:75], a[196:199]
  v_exp_f32 v29, v29
  v_mfma_f32_16x16x32_bf16 a[196:199], a[208:211], v[104:107], a[196:199]
  ds_read_b64_tr_b16 a[178:179], v218 offset:20480
  v_cvt_pk_bf16_f32 v26, v28, v29
  v_mfma_f32_16x16x32_bf16 a[200:203], a[208:211], v[80:83], a[200:203]
  v_exp_f32 v30, v30
  v_mfma_f32_16x16x32_bf16 a[200:203], a[208:211], v[112:115], a[200:203]
  ds_read_b64_tr_b16 a[180:181], v218 offset:24576
  v_mfma_f32_16x16x32_bf16 a[204:207], a[208:211], v[88:91], a[204:207]
  s_waitcnt lgkmcnt(7)
  v_exp_f32 v31, v31
  v_mfma_f32_16x16x32_bf16 a[204:207], a[208:211], v[120:123], a[204:207]
  ds_read_b64_tr_b16 a[182:183], v218 offset:28672
  v_cvt_pk_bf16_f32 v27, v30, v31
  v_mfma_f32_16x16x32_bf16 a[0:3], a[160:163], v[64:67], a[0:3]
  v_exp_f32 v32, v32
  v_mfma_f32_16x16x32_bf16 a[0:3], a[164:167], v[96:99], a[0:3]
  ds_read_b64_tr_b16 a[184:185], v219 offset:16384
  v_mfma_f32_16x16x32_bf16 a[4:7], a[164:167], v[104:107], a[4:7]
  v_exp_f32 v33, v33
  v_mfma_f32_16x16x32_bf16 a[4:7], a[160:163], v[72:75], a[4:7]
  ds_read_b64_tr_b16 a[186:187], v219 offset:20480
  v_cvt_pk_bf16_f32 v32, v32, v33
  v_mfma_f32_16x16x32_bf16 a[8:11], a[160:163], v[80:83], a[8:11]
  v_exp_f32 v34, v34
  v_mfma_f32_16x16x32_bf16 a[8:11], a[164:167], v[112:115], a[8:11]
  ds_read_b64_tr_b16 a[188:189], v219 offset:24576
  v_mfma_f32_16x16x32_bf16 a[12:15], a[164:167], v[120:123], a[12:15]
  s_waitcnt lgkmcnt(7)
  v_exp_f32 v35, v35
  v_mfma_f32_16x16x32_bf16 a[12:15], a[160:163], v[88:91], a[12:15]
  ds_read_b64_tr_b16 a[190:191], v219 offset:28672
  v_cvt_pk_bf16_f32 v33, v34, v35
  v_mfma_f32_16x16x32_bf16 a[16:19], a[168:171], v[64:67], a[16:19]
  v_exp_f32 v40, v40
  v_mfma_f32_16x16x32_bf16 a[16:19], a[172:175], v[96:99], a[16:19]
  ds_read_b64_tr_b16 a[160:161], v220 offset:16384
  v_mfma_f32_16x16x32_bf16 a[20:23], a[172:175], v[104:107], a[20:23]
  v_exp_f32 v41, v41
  v_mfma_f32_16x16x32_bf16 a[20:23], a[168:171], v[72:75], a[20:23]
  ds_read_b64_tr_b16 a[162:163], v220 offset:20480
  v_cvt_pk_bf16_f32 v40, v40, v41
  v_mfma_f32_16x16x32_bf16 a[24:27], a[168:171], v[80:83], a[24:27]
  v_exp_f32 v42, v42
  v_mfma_f32_16x16x32_bf16 a[24:27], a[172:175], v[112:115], a[24:27]
  ds_read_b64_tr_b16 a[164:165], v220 offset:24576
  v_mfma_f32_16x16x32_bf16 a[28:31], a[172:175], v[120:123], a[28:31]
  s_waitcnt lgkmcnt(7)
  v_exp_f32 v43, v43
  v_mfma_f32_16x16x32_bf16 a[28:31], a[168:171], v[88:91], a[28:31]
  ds_read_b64_tr_b16 a[166:167], v220 offset:28672
  v_cvt_pk_bf16_f32 v41, v42, v43
  v_mfma_f32_16x16x32_bf16 a[32:35], a[176:179], v[64:67], a[32:35]
  v_exp_f32 v48, v48
  v_mfma_f32_16x16x32_bf16 a[32:35], a[180:183], v[96:99], a[32:35]
  ds_read_b64_tr_b16 a[168:169], v221 offset:16384
  v_mfma_f32_16x16x32_bf16 a[36:39], a[180:183], v[104:107], a[36:39]
  v_exp_f32 v49, v49
  v_mfma_f32_16x16x32_bf16 a[36:39], a[176:179], v[72:75], a[36:39]
  ds_read_b64_tr_b16 a[170:171], v221 offset:20480
  v_cvt_pk_bf16_f32 v48, v48, v49
  v_mfma_f32_16x16x32_bf16 a[40:43], a[176:179], v[80:83], a[40:43]
  v_exp_f32 v50, v50
  v_mfma_f32_16x16x32_bf16 a[40:43], a[180:183], v[112:115], a[40:43]
  ds_read_b64_tr_b16 a[172:173], v221 offset:24576
  v_mfma_f32_16x16x32_bf16 a[44:47], a[180:183], v[120:123], a[44:47]
  s_waitcnt lgkmcnt(7)
  v_exp_f32 v51, v51
  v_mfma_f32_16x16x32_bf16 a[44:47], a[176:179], v[88:91], a[44:47]
  ds_read_b64_tr_b16 a[174:175], v221 offset:28672
  v_cvt_pk_bf16_f32 v49, v50, v51
  v_mfma_f32_16x16x32_bf16 a[48:51], a[184:187], v[64:67], a[48:51]
  v_exp_f32 v56, v56
  v_mfma_f32_16x16x32_bf16 a[48:51], a[188:191], v[96:99], a[48:51]
  ds_read_b64_tr_b16 a[176:177], v222 offset:16384
  v_mfma_f32_16x16x32_bf16 a[52:55], a[188:191], v[104:107], a[52:55]
  v_exp_f32 v57, v57
  v_mfma_f32_16x16x32_bf16 a[52:55], a[184:187], v[72:75], a[52:55]
  ds_read_b64_tr_b16 a[178:179], v222 offset:20480
  v_cvt_pk_bf16_f32 v56, v56, v57
  v_mfma_f32_16x16x32_bf16 a[56:59], a[184:187], v[80:83], a[56:59]
  v_exp_f32 v58, v58
  v_mfma_f32_16x16x32_bf16 a[56:59], a[188:191], v[112:115], a[56:59]
  ds_read_b64_tr_b16 a[180:181], v222 offset:24576
  v_mfma_f32_16x16x32_bf16 a[60:63], a[188:191], v[120:123], a[60:63]
  s_waitcnt lgkmcnt(7)
  v_exp_f32 v59, v59
  v_mfma_f32_16x16x32_bf16 a[60:63], a[184:187], v[88:91], a[60:63]
  ds_read_b64_tr_b16 a[182:183], v222 offset:28672
  v_cvt_pk_bf16_f32 v57, v58, v59
  v_mfma_f32_16x16x32_bf16 a[64:67], a[160:163], v[64:67], a[64:67]
  v_exp_f32 v36, v36
  v_mfma_f32_16x16x32_bf16 a[64:67], a[164:167], v[96:99], a[64:67]
  ds_read_b64_tr_b16 a[184:185], v223 offset:16384
  v_mfma_f32_16x16x32_bf16 a[68:71], a[164:167], v[104:107], a[68:71]
  v_exp_f32 v37, v37
  v_mfma_f32_16x16x32_bf16 a[68:71], a[160:163], v[72:75], a[68:71]
  ds_read_b64_tr_b16 a[186:187], v223 offset:20480
  v_cvt_pk_bf16_f32 v34, v36, v37
  v_mfma_f32_16x16x32_bf16 a[72:75], a[160:163], v[80:83], a[72:75]
  v_exp_f32 v38, v38
  v_mfma_f32_16x16x32_bf16 a[72:75], a[164:167], v[112:115], a[72:75]
  ds_read_b64_tr_b16 a[188:189], v223 offset:24576
  v_mfma_f32_16x16x32_bf16 a[76:79], a[164:167], v[120:123], a[76:79]
  s_waitcnt lgkmcnt(7)
  v_exp_f32 v39, v39
  v_mfma_f32_16x16x32_bf16 a[76:79], a[160:163], v[88:91], a[76:79]
  ds_read_b64_tr_b16 a[190:191], v223 offset:28672
  v_cvt_pk_bf16_f32 v35, v38, v39
  v_mfma_f32_16x16x32_bf16 a[80:83], a[168:171], v[64:67], a[80:83]
  s_waitcnt vmcnt(11)
  v_exp_f32 v44, v44
  v_mfma_f32_16x16x32_bf16 a[80:83], a[172:175], v[96:99], a[80:83]
  v_mfma_f32_16x16x32_bf16 a[84:87], a[172:175], v[104:107], a[84:87]
  s_barrier
  v_exp_f32 v45, v45
  v_mfma_f32_16x16x32_bf16 a[84:87], a[168:171], v[72:75], a[84:87]
  ds_read_b128 a[128:131], v212 offset:49152
  v_cvt_pk_bf16_f32 v42, v44, v45
  v_mfma_f32_16x16x32_bf16 a[88:91], a[168:171], v[80:83], a[88:91]
  v_exp_f32 v46, v46
  v_mfma_f32_16x16x32_bf16 a[88:91], a[172:175], v[112:115], a[88:91]
  ds_read_b128 a[132:135], v213 offset:49152
  ds_read_b64_tr_b16 a[232:233], v209 offset:4096
  v_mfma_f32_16x16x32_bf16 a[92:95], a[172:175], v[120:123], a[92:95]
  s_waitcnt lgkmcnt(7)
  v_exp_f32 v47, v47
  v_mfma_f32_16x16x32_bf16 a[92:95], a[168:171], v[88:91], a[92:95]
  ds_read_b128 a[136:139], v214 offset:49152
  v_cvt_pk_bf16_f32 v43, v46, v47
  v_mfma_f32_16x16x32_bf16 a[96:99], a[176:179], v[64:67], a[96:99]
  v_exp_f32 v52, v52
  v_mfma_f32_16x16x32_bf16 a[96:99], a[180:183], v[96:99], a[96:99]
  ds_read_b128 a[140:143], v215 offset:49152
  ds_read_b64_tr_b16 a[234:235], v209 offset:4608
  v_mfma_f32_16x16x32_bf16 a[100:103], a[180:183], v[104:107], a[100:103]
  v_exp_f32 v53, v53
  v_mfma_f32_16x16x32_bf16 a[100:103], a[176:179], v[72:75], a[100:103]
  v_cvt_pk_bf16_f32 v50, v52, v53
  v_mfma_f32_16x16x32_bf16 a[104:107], a[176:179], v[80:83], a[104:107]
  v_exp_f32 v54, v54
  v_mfma_f32_16x16x32_bf16 a[104:107], a[180:183], v[112:115], a[104:107]
  v_mfma_f32_16x16x32_bf16 a[108:111], a[180:183], v[120:123], a[108:111]
  s_waitcnt lgkmcnt(6)
  v_exp_f32 v55, v55
  v_mfma_f32_16x16x32_bf16 a[108:111], a[176:179], v[88:91], a[108:111]
  v_cvt_pk_bf16_f32 v51, v54, v55
  v_mfma_f32_16x16x32_bf16 a[112:115], a[184:187], v[64:67], a[112:115]
  v_exp_f32 v60, v60
  v_mfma_f32_16x16x32_bf16 a[112:115], a[188:191], v[96:99], a[112:115]
  s_waitcnt lgkmcnt(0)
  buffer_store_dwordx4 a[232:235], v211, s[24:27], s31 offen sc1
  s_add_u32 s31, s31, 1024
  s_cmp_gt_u32 s32, 4
  s_cselect_b32 s39, 0, 1073741824
  v_mfma_f32_16x16x32_bf16 a[116:119], a[188:191], v[104:107], a[116:119]
  v_exp_f32 v61, v61
  v_mfma_f32_16x16x32_bf16 a[116:119], a[184:187], v[72:75], a[116:119]
  v_cvt_pk_bf16_f32 v58, v60, v61
  v_or_b32 v211, s39, v211
  v_mfma_f32_16x16x32_bf16 a[120:123], a[184:187], v[80:83], a[120:123]
  v_exp_f32 v62, v62
  v_mfma_f32_16x16x32_bf16 a[120:123], a[188:191], v[112:115], a[120:123]
  v_or_b32 v208, s39, v208
  v_mfma_f32_16x16x32_bf16 a[124:127], a[188:191], v[120:123], a[124:127]
  v_exp_f32 v63, v63
  v_mfma_f32_16x16x32_bf16 a[124:127], a[184:187], v[88:91], a[124:127]
  v_cvt_pk_bf16_f32 v59, v62, v63
  v_mfma_f32_16x16x32_bf16 v[64:67], a[128:131], v[128:131], v[192:195]
  s_add_u32 m0, s28, 65536
  v_mfma_f32_16x16x32_bf16 v[64:67], a[132:135], v[132:135], v[64:67]
  ds_read_b128 a[144:147], v212 offset:53248
  v_mfma_f32_16x16x32_bf16 v[64:67], a[136:139], v[136:139], v[64:67]
  buffer_load_dwordx4 v236, s[16:19], s29 offen offset:0 lds
  v_mfma_f32_16x16x32_bf16 v[64:67], a[140:143], v[140:143], v[64:67]
  ds_read_b128 a[148:151], v213 offset:53248
  v_mfma_f32_16x16x32_bf16 v[72:75], a[140:143], v[156:159], v[196:199]
  buffer_load_dwordx4 v237, s[16:19], s29 offen offset:1024 lds
  v_mfma_f32_16x16x32_bf16 v[72:75], a[136:139], v[152:155], v[72:75]
  ds_read_b128 a[152:155], v214 offset:53248
  v_mfma_f32_16x16x32_bf16 v[72:75], a[132:135], v[148:151], v[72:75]
  buffer_load_dwordx4 v236, s[16:19], s29 offen offset:2048 lds
  v_mfma_f32_16x16x32_bf16 v[72:75], a[128:131], v[144:147], v[72:75]
  ds_read_b128 a[156:159], v215 offset:53248
  v_mfma_f32_16x16x32_bf16 v[80:83], a[128:131], v[160:163], v[200:203]
  v_exp_f32 v64, v64
  v_mfma_f32_16x16x32_bf16 v[80:83], a[132:135], v[164:167], v[80:83]
  buffer_load_dwordx4 v237, s[16:19], s29 offen offset:3072 lds
  v_mfma_f32_16x16x32_bf16 v[80:83], a[136:139], v[168:171], v[80:83]
  s_add_u32 s29, s29, 16384
  v_exp_f32 v65, v65
  v_mfma_f32_16x16x32_bf16 v[80:83], a[140:143], v[172:175], v[80:83]
  v_cvt_pk_bf16_f32 v64, v64, v65
  v_mfma_f32_16x16x32_bf16 v[88:91], a[140:143], v[188:191], v[204:207]
  s_add_u32 m0, s28, 16384
  v_exp_f32 v66, v66
  v_mfma_f32_16x16x32_bf16 v[88:91], a[136:139], v[184:187], v[88:91]
  buffer_load_dwordx4 v232, s[12:15], s29 offen offset:0 lds
  v_mfma_f32_16x16x32_bf16 v[88:91], a[132:135], v[180:183], v[88:91]
  s_waitcnt lgkmcnt(0)
  v_exp_f32 v67, v67
  v_mfma_f32_16x16x32_bf16 v[88:91], a[128:131], v[176:179], v[88:91]
  v_cvt_pk_bf16_f32 v65, v66, v67
  v_mfma_f32_16x16x32_bf16 v[68:71], a[144:147], v[128:131], v[192:195]
  v_exp_f32 v72, v72
  v_mfma_f32_16x16x32_bf16 v[68:71], a[148:151], v[132:135], v[68:71]
  ds_read_b128 a[128:131], v212 offset:57344
  v_mfma_f32_16x16x32_bf16 v[68:71], a[152:155], v[136:139], v[68:71]
  v_exp_f32 v73, v73
  v_mfma_f32_16x16x32_bf16 v[68:71], a[156:159], v[140:143], v[68:71]
  ds_read_b128 a[132:135], v213 offset:57344
  v_cvt_pk_bf16_f32 v72, v72, v73
  v_mfma_f32_16x16x32_bf16 v[76:79], a[156:159], v[156:159], v[196:199]
  v_exp_f32 v74, v74
  v_mfma_f32_16x16x32_bf16 v[76:79], a[152:155], v[152:155], v[76:79]
  ds_read_b128 a[136:139], v214 offset:57344
  v_mfma_f32_16x16x32_bf16 v[76:79], a[148:151], v[148:151], v[76:79]
  v_exp_f32 v75, v75
  v_mfma_f32_16x16x32_bf16 v[76:79], a[144:147], v[144:147], v[76:79]
  ds_read_b128 a[140:143], v215 offset:57344
  v_cvt_pk_bf16_f32 v73, v74, v75
  v_mfma_f32_16x16x32_bf16 v[84:87], a[144:147], v[160:163], v[200:203]
  v_exp_f32 v80, v80
  v_mfma_f32_16x16x32_bf16 v[84:87], a[148:151], v[164:167], v[84:87]
  buffer_load_dwordx4 v233, s[12:15], s29 offen offset:1024 lds
  v_mfma_f32_16x16x32_bf16 v[84:87], a[152:155], v[168:171], v[84:87]
  v_exp_f32 v81, v81
  v_mfma_f32_16x16x32_bf16 v[84:87], a[156:159], v[172:175], v[84:87]
  v_cvt_pk_bf16_f32 v80, v80, v81
  v_mfma_f32_16x16x32_bf16 v[92:95], a[156:159], v[188:191], v[204:207]
  v_exp_f32 v82, v82
  v_mfma_f32_16x16x32_bf16 v[92:95], a[152:155], v[184:187], v[92:95]
  buffer_load_dwordx4 v234, s[12:15], s29 offen offset:2048 lds
  v_mfma_f32_16x16x32_bf16 v[92:95], a[148:151], v[180:183], v[92:95]
  s_waitcnt lgkmcnt(0)
  v_exp_f32 v83, v83
  v_mfma_f32_16x16x32_bf16 v[92:95], a[144:147], v[176:179], v[92:95]
  v_cvt_pk_bf16_f32 v81, v82, v83
  v_mfma_f32_16x16x32_bf16 v[96:99], a[128:131], v[128:131], v[192:195]
  v_exp_f32 v88, v88
  v_mfma_f32_16x16x32_bf16 v[96:99], a[132:135], v[132:135], v[96:99]
  ds_read_b128 a[144:147], v212 offset:61440
  v_mfma_f32_16x16x32_bf16 v[96:99], a[136:139], v[136:139], v[96:99]
  v_exp_f32 v89, v89
  v_mfma_f32_16x16x32_bf16 v[96:99], a[140:143], v[140:143], v[96:99]
  ds_read_b128 a[148:151], v213 offset:61440
  v_cvt_pk_bf16_f32 v88, v88, v89
  v_mfma_f32_16x16x32_bf16 v[104:107], a[140:143], v[156:159], v[196:199]
  v_exp_f32 v90, v90
  v_mfma_f32_16x16x32_bf16 v[104:107], a[136:139], v[152:155], v[104:107]
  ds_read_b128 a[152:155], v214 offset:61440
  v_mfma_f32_16x16x32_bf16 v[104:107], a[132:135], v[148:151], v[104:107]
  v_exp_f32 v91, v91
  v_mfma_f32_16x16x32_bf16 v[104:107], a[128:131], v[144:147], v[104:107]
  ds_read_b128 a[156:159], v215 offset:61440
  v_cvt_pk_bf16_f32 v89, v90, v91
  v_mfma_f32_16x16x32_bf16 v[112:115], a[128:131], v[160:163], v[200:203]
  v_exp_f32 v68, v68
  v_mfma_f32_16x16x32_bf16 v[112:115], a[132:135], v[164:167], v[112:115]
  buffer_load_dwordx4 v235, s[12:15], s29 offen offset:3072 lds
  v_mfma_f32_16x16x32_bf16 v[112:115], a[136:139], v[168:171], v[112:115]
  v_exp_f32 v69, v69
  v_mfma_f32_16x16x32_bf16 v[112:115], a[140:143], v[172:175], v[112:115]
  v_cvt_pk_bf16_f32 v66, v68, v69
  v_mfma_f32_16x16x32_bf16 v[120:123], a[140:143], v[188:191], v[204:207]
  v_exp_f32 v70, v70
  v_mfma_f32_16x16x32_bf16 v[120:123], a[136:139], v[184:187], v[120:123]
  buffer_load_dword v254, off, s[24:27], s47 sc1
  v_mfma_f32_16x16x32_bf16 v[120:123], a[132:135], v[180:183], v[120:123]
  s_waitcnt lgkmcnt(0)
  v_exp_f32 v71, v71
  v_mfma_f32_16x16x32_bf16 v[120:123], a[128:131], v[176:179], v[120:123]
  v_cvt_pk_bf16_f32 v67, v70, v71
  v_mfma_f32_16x16x32_bf16 v[100:103], a[144:147], v[128:131], v[192:195]
  v_exp_f32 v76, v76
  v_mfma_f32_16x16x32_bf16 v[100:103], a[148:151], v[132:135], v[100:103]
  ds_read_b64_tr_b16 a[160:161], v216 offset:32768
  v_mfma_f32_16x16x32_bf16 v[100:103], a[152:155], v[136:139], v[100:103]
  v_exp_f32 v77, v77
  v_mfma_f32_16x16x32_bf16 v[100:103], a[156:159], v[140:143], v[100:103]
  ds_read_b64_tr_b16 a[162:163], v216 offset:36864
  v_cvt_pk_bf16_f32 v74, v76, v77
  v_mfma_f32_16x16x32_bf16 v[108:111], a[156:159], v[156:159], v[196:199]
  v_exp_f32 v78, v78
  v_mfma_f32_16x16x32_bf16 v[108:111], a[152:155], v[152:155], v[108:111]
  ds_read_b64_tr_b16 a[164:165], v216 offset:40960
  v_mfma_f32_16x16x32_bf16 v[108:111], a[148:151], v[148:151], v[108:111]
  v_exp_f32 v79, v79
  v_mfma_f32_16x16x32_bf16 v[108:111], a[144:147], v[144:147], v[108:111]
  ds_read_b64_tr_b16 a[166:167], v216 offset:45056
  v_cvt_pk_bf16_f32 v75, v78, v79
  v_mfma_f32_16x16x32_bf16 v[116:119], a[144:147], v[160:163], v[200:203]
  v_exp_f32 v84, v84
  v_mfma_f32_16x16x32_bf16 v[116:119], a[148:151], v[164:167], v[116:119]
  ds_read_b64_tr_b16 a[168:169], v217 offset:32768
  v_mfma_f32_16x16x32_bf16 v[116:119], a[152:155], v[168:171], v[116:119]
  v_exp_f32 v85, v85
  v_mfma_f32_16x16x32_bf16 v[116:119], a[156:159], v[172:175], v[116:119]
  ds_read_b64_tr_b16 a[170:171], v217 offset:36864
  v_cvt_pk_bf16_f32 v82, v84, v85
  v_mfma_f32_16x16x32_bf16 v[124:127], a[156:159], v[188:191], v[204:207]
  s_waitcnt vmcnt(20)
  v_exp_f32 v86, v86
  v_mfma_f32_16x16x32_bf16 v[124:127], a[152:155], v[184:187], v[124:127]
  ds_read_b64_tr_b16 a[172:173], v217 offset:40960
  ds_read_b64_tr_b16 a[232:233], v209 offset:5120
  v_mfma_f32_16x16x32_bf16 v[124:127], a[148:151], v[180:183], v[124:127]
  v_exp_f32 v87, v87
  v_mfma_f32_16x16x32_bf16 v[124:127], a[144:147], v[176:179], v[124:127]
  ds_read_b64_tr_b16 a[174:175], v217 offset:45056
  v_cvt_pk_bf16_f32 v83, v86, v87
  v_mfma_f32_16x16x32_bf16 a[192:195], a[208:211], v[0:3], a[192:195]
  v_exp_f32 v92, v92
  v_mfma_f32_16x16x32_bf16 a[192:195], a[208:211], v[32:35], a[192:195]
  ds_read_b64_tr_b16 a[176:177], v218 offset:32768
  ds_read_b64_tr_b16 a[234:235], v209 offset:5632
  v_mfma_f32_16x16x32_bf16 a[196:199], a[208:211], v[8:11], a[196:199]
  v_exp_f32 v93, v93
  v_mfma_f32_16x16x32_bf16 a[196:199], a[208:211], v[40:43], a[196:199]
  ds_read_b64_tr_b16 a[178:179], v218 offset:36864
  v_cvt_pk_bf16_f32 v90, v92, v93
  v_mfma_f32_16x16x32_bf16 a[200:203], a[208:211], v[16:19], a[200:203]
  v_exp_f32 v94, v94
  v_mfma_f32_16x16x32_bf16 a[200:203], a[208:211], v[48:51], a[200:203]
  ds_read_b64_tr_b16 a[180:181], v218 offset:40960
  v_mfma_f32_16x16x32_bf16 a[204:207], a[208:211], v[24:27], a[204:207]
  s_waitcnt lgkmcnt(9)
  v_exp_f32 v95, v95
  v_mfma_f32_16x16x32_bf16 a[204:207], a[208:211], v[56:59], a[204:207]
  ds_read_b64_tr_b16 a[182:183], v218 offset:45056
  v_cvt_pk_bf16_f32 v91, v94, v95
  v_mfma_f32_16x16x32_bf16 a[0:3], a[160:163], v[0:3], a[0:3]
  v_exp_f32 v96, v96
  v_mfma_f32_16x16x32_bf16 a[0:3], a[164:167], v[32:35], a[0:3]
  ds_read_b64_tr_b16 a[184:185], v219 offset:32768
  s_waitcnt lgkmcnt(4)
  buffer_store_dwordx4 a[232:235], v211, s[24:27], s31 offen sc1
  s_add_u32 s31, s31, 1024
  v_mfma_f32_16x16x32_bf16 a[4:7], a[164:167], v[40:43], a[4:7]
  v_exp_f32 v97, v97
  v_mfma_f32_16x16x32_bf16 a[4:7], a[160:163], v[8:11], a[4:7]
  ds_read_b64_tr_b16 a[186:187], v219 offset:36864
  v_cvt_pk_bf16_f32 v96, v96, v97
  v_mfma_f32_16x16x32_bf16 a[8:11], a[160:163], v[16:19], a[8:11]
  v_exp_f32 v98, v98
  v_mfma_f32_16x16x32_bf16 a[8:11], a[164:167], v[48:51], a[8:11]
  ds_read_b64_tr_b16 a[188:189], v219 offset:40960
  v_mfma_f32_16x16x32_bf16 a[12:15], a[164:167], v[56:59], a[12:15]
  v_exp_f32 v99, v99
  v_mfma_f32_16x16x32_bf16 a[12:15], a[160:163], v[24:27], a[12:15]
  ds_read_b64_tr_b16 a[190:191], v219 offset:45056
  v_cvt_pk_bf16_f32 v97, v98, v99
  v_mfma_f32_16x16x32_bf16 a[16:19], a[168:171], v[0:3], a[16:19]
  v_exp_f32 v104, v104
  v_mfma_f32_16x16x32_bf16 a[16:19], a[172:175], v[32:35], a[16:19]
  ds_read_b64_tr_b16 a[160:161], v220 offset:32768
  v_mfma_f32_16x16x32_bf16 a[20:23], a[172:175], v[40:43], a[20:23]
  v_exp_f32 v105, v105
  v_mfma_f32_16x16x32_bf16 a[20:23], a[168:171], v[8:11], a[20:23]
  ds_read_b64_tr_b16 a[162:163], v220 offset:36864
  v_cvt_pk_bf16_f32 v104, v104, v105
  v_mfma_f32_16x16x32_bf16 a[24:27], a[168:171], v[16:19], a[24:27]
  v_exp_f32 v106, v106
  v_mfma_f32_16x16x32_bf16 a[24:27], a[172:175], v[48:51], a[24:27]
  ds_read_b64_tr_b16 a[164:165], v220 offset:40960
  v_mfma_f32_16x16x32_bf16 a[28:31], a[172:175], v[56:59], a[28:31]
  s_waitcnt lgkmcnt(7)
  v_exp_f32 v107, v107
  v_mfma_f32_16x16x32_bf16 a[28:31], a[168:171], v[24:27], a[28:31]
  ds_read_b64_tr_b16 a[166:167], v220 offset:45056
  v_cvt_pk_bf16_f32 v105, v106, v107
  v_mfma_f32_16x16x32_bf16 a[32:35], a[176:179], v[0:3], a[32:35]
  v_exp_f32 v112, v112
  v_mfma_f32_16x16x32_bf16 a[32:35], a[180:183], v[32:35], a[32:35]
  ds_read_b64_tr_b16 a[168:169], v221 offset:32768
  v_mfma_f32_16x16x32_bf16 a[36:39], a[180:183], v[40:43], a[36:39]
  v_exp_f32 v113, v113
  v_mfma_f32_16x16x32_bf16 a[36:39], a[176:179], v[8:11], a[36:39]
  ds_read_b64_tr_b16 a[170:171], v221 offset:36864
  v_cvt_pk_bf16_f32 v112, v112, v113
  v_mfma_f32_16x16x32_bf16 a[40:43], a[176:179], v[16:19], a[40:43]
  v_exp_f32 v114, v114
  v_mfma_f32_16x16x32_bf16 a[40:43], a[180:183], v[48:51], a[40:43]
  ds_read_b64_tr_b16 a[172:173], v221 offset:40960
  v_mfma_f32_16x16x32_bf16 a[44:47], a[180:183], v[56:59], a[44:47]
  s_waitcnt lgkmcnt(7)
  v_exp_f32 v115, v115
  v_mfma_f32_16x16x32_bf16 a[44:47], a[176:179], v[24:27], a[44:47]
  ds_read_b64_tr_b16 a[174:175], v221 offset:45056
  v_cvt_pk_bf16_f32 v113, v114, v115
  v_mfma_f32_16x16x32_bf16 a[48:51], a[184:187], v[0:3], a[48:51]
  v_exp_f32 v120, v120
  v_mfma_f32_16x16x32_bf16 a[48:51], a[188:191], v[32:35], a[48:51]
  ds_read_b64_tr_b16 a[176:177], v222 offset:32768
  v_mfma_f32_16x16x32_bf16 a[52:55], a[188:191], v[40:43], a[52:55]
  v_exp_f32 v121, v121
  v_mfma_f32_16x16x32_bf16 a[52:55], a[184:187], v[8:11], a[52:55]
  ds_read_b64_tr_b16 a[178:179], v222 offset:36864
  v_cvt_pk_bf16_f32 v120, v120, v121
  v_mfma_f32_16x16x32_bf16 a[56:59], a[184:187], v[16:19], a[56:59]
  v_exp_f32 v122, v122
  v_mfma_f32_16x16x32_bf16 a[56:59], a[188:191], v[48:51], a[56:59]
  ds_read_b64_tr_b16 a[180:181], v222 offset:40960
  v_mfma_f32_16x16x32_bf16 a[60:63], a[188:191], v[56:59], a[60:63]
  s_waitcnt lgkmcnt(7)
  v_exp_f32 v123, v123
  v_mfma_f32_16x16x32_bf16 a[60:63], a[184:187], v[24:27], a[60:63]
  ds_read_b64_tr_b16 a[182:183], v222 offset:45056
  v_cvt_pk_bf16_f32 v121, v122, v123
  v_mfma_f32_16x16x32_bf16 a[64:67], a[160:163], v[0:3], a[64:67]
  v_exp_f32 v100, v100
  v_mfma_f32_16x16x32_bf16 a[64:67], a[164:167], v[32:35], a[64:67]
  ds_read_b64_tr_b16 a[184:185], v223 offset:32768
  v_mfma_f32_16x16x32_bf16 a[68:71], a[164:167], v[40:43], a[68:71]
  v_exp_f32 v101, v101
  v_mfma_f32_16x16x32_bf16 a[68:71], a[160:163], v[8:11], a[68:71]
  ds_read_b64_tr_b16 a[186:187], v223 offset:36864
  v_cvt_pk_bf16_f32 v98, v100, v101
  v_mfma_f32_16x16x32_bf16 a[72:75], a[160:163], v[16:19], a[72:75]
  v_exp_f32 v102, v102
  v_mfma_f32_16x16x32_bf16 a[72:75], a[164:167], v[48:51], a[72:75]
  ds_read_b64_tr_b16 a[188:189], v223 offset:40960
  v_mfma_f32_16x16x32_bf16 a[76:79], a[164:167], v[56:59], a[76:79]
  s_waitcnt lgkmcnt(7)
  v_exp_f32 v103, v103
  v_mfma_f32_16x16x32_bf16 a[76:79], a[160:163], v[24:27], a[76:79]
  ds_read_b64_tr_b16 a[190:191], v223 offset:45056
  v_cvt_pk_bf16_f32 v99, v102, v103
  v_mfma_f32_16x16x32_bf16 a[80:83], a[168:171], v[0:3], a[80:83]
  s_waitcnt vmcnt(12)
  v_exp_f32 v108, v108
  v_mfma_f32_16x16x32_bf16 a[80:83], a[172:175], v[32:35], a[80:83]
  v_mfma_f32_16x16x32_bf16 a[84:87], a[172:175], v[40:43], a[84:87]
  s_barrier
  v_exp_f32 v109, v109
  v_mfma_f32_16x16x32_bf16 a[84:87], a[168:171], v[8:11], a[84:87]
  ds_read_b128 a[128:131], v212 offset:0
  v_cvt_pk_bf16_f32 v106, v108, v109
  v_mfma_f32_16x16x32_bf16 a[88:91], a[168:171], v[16:19], a[88:91]
  v_exp_f32 v110, v110
  v_mfma_f32_16x16x32_bf16 a[88:91], a[172:175], v[48:51], a[88:91]
  ds_read_b128 a[132:135], v213 offset:0
  v_mfma_f32_16x16x32_bf16 a[92:95], a[172:175], v[56:59], a[92:95]
  s_waitcnt lgkmcnt(6)
  v_exp_f32 v111, v111
  v_mfma_f32_16x16x32_bf16 a[92:95], a[168:171], v[24:27], a[92:95]
  ds_read_b128 a[136:139], v214 offset:0
  v_cvt_pk_bf16_f32 v107, v110, v111
  v_mfma_f32_16x16x32_bf16 a[96:99], a[176:179], v[0:3], a[96:99]
  v_exp_f32 v116, v116
  v_mfma_f32_16x16x32_bf16 a[96:99], a[180:183], v[32:35], a[96:99]
  ds_read_b128 a[140:143], v215 offset:0
  v_mfma_f32_16x16x32_bf16 a[100:103], a[180:183], v[40:43], a[100:103]
  v_exp_f32 v117, v117
  v_mfma_f32_16x16x32_bf16 a[100:103], a[176:179], v[8:11], a[100:103]
  v_cvt_pk_bf16_f32 v114, v116, v117
  v_mfma_f32_16x16x32_bf16 a[104:107], a[176:179], v[16:19], a[104:107]
  v_exp_f32 v118, v118
  v_mfma_f32_16x16x32_bf16 a[104:107], a[180:183], v[48:51], a[104:107]
  v_mfma_f32_16x16x32_bf16 a[108:111], a[180:183], v[56:59], a[108:111]
  s_waitcnt lgkmcnt(4)
  v_exp_f32 v119, v119
  v_mfma_f32_16x16x32_bf16 a[108:111], a[176:179], v[24:27], a[108:111]
  v_cvt_pk_bf16_f32 v115, v118, v119
  v_mfma_f32_16x16x32_bf16 a[112:115], a[184:187], v[0:3], a[112:115]
  v_exp_f32 v124, v124
  v_mfma_f32_16x16x32_bf16 a[112:115], a[188:191], v[32:35], a[112:115]
  v_mfma_f32_16x16x32_bf16 a[116:119], a[188:191], v[40:43], a[116:119]
  s_sub_u32 s32, s32, 1
  v_exp_f32 v125, v125
  v_mfma_f32_16x16x32_bf16 a[116:119], a[184:187], v[8:11], a[116:119]
  v_cvt_pk_bf16_f32 v122, v124, v125
  v_mfma_f32_16x16x32_bf16 a[120:123], a[184:187], v[16:19], a[120:123]
  s_cmp_lg_u32 s32, 0
  v_exp_f32 v126, v126
  v_mfma_f32_16x16x32_bf16 a[120:123], a[188:191], v[48:51], a[120:123]
  v_mfma_f32_16x16x32_bf16 a[124:127], a[188:191], v[56:59], a[124:127]
  s_waitcnt lgkmcnt(0)
  v_exp_f32 v127, v127
  v_mfma_f32_16x16x32_bf16 a[124:127], a[184:187], v[24:27], a[124:127]
  v_cvt_pk_bf16_f32 v123, v126, v127
  s_cbranch_scc1 attn_loop
  ds_read_b64_tr_b16 a[160:161], v216 offset:49152
  ds_read_b64_tr_b16 a[162:163], v216 offset:53248
  ds_read_b64_tr_b16 a[164:165], v216 offset:57344
  ds_read_b64_tr_b16 a[166:167], v216 offset:61440
  ds_read_b64_tr_b16 a[168:169], v217 offset:49152
  ds_read_b64_tr_b16 a[170:171], v217 offset:53248
  ds_read_b64_tr_b16 a[172:173], v217 offset:57344
  ds_read_b64_tr_b16 a[174:175], v217 offset:61440
  s_waitcnt vmcnt(1)
  v_readfirstlane_b32 s38, v254
  s_nop 0
  s_cmp_ge_u32 s38, 512
  s_cbranch_scc1 attn_h_ready
  s_mov_b32 s39, 32768
attn_spin:
  s_sleep 4
  buffer_load_dword v254, off, s[24:27], s47 sc1
  s_waitcnt vmcnt(0)
  v_readfirstlane_b32 s38, v254
  s_nop 0
  s_cmp_ge_u32 s38, 512
  s_cbranch_scc1 attn_h_ready
  s_sub_u32 s39, s39, 1
  s_cmp_lg_u32 s39, 0
  s_cbranch_scc1 attn_spin
attn_h_ready:
  s_mov_b32 s48, 0x5d800000
  s_lshl_b32 s39, s3, 8
  v_mfma_f32_16x16x32_bf16 a[192:195], a[208:211], v[64:67], a[192:195]
  v_lshrrev_b32 v224, 4, v242
  v_and_b32 v225, 7, v224
  v_mfma_f32_16x16x32_bf16 a[192:195], a[208:211], v[96:99], a[192:195]
  v_mul_u32_u24 v225, 0xd80, v225
  v_lshrrev_b32 v224, 4, v224
  v_mfma_f32_16x16x32_bf16 a[196:199], a[208:211], v[72:75], a[196:199]
  v_lshl_add_u32 v225, v224, 4, v225
  v_mfma_f32_16x16x32_bf16 a[196:199], a[208:211], v[104:107], a[196:199]
  buffer_load_dwordx4 a[212:215], v225, s[24:27], s101 offen offset:0 sc1
  v_mfma_f32_16x16x32_bf16 a[200:203], a[208:211], v[80:83], a[200:203]
  buffer_load_dwordx4 a[216:219], v225, s[24:27], s101 offen offset:64 sc1
  v_mfma_f32_16x16x32_bf16 a[200:203], a[208:211], v[112:115], a[200:203]
  buffer_load_dwordx4 a[220:223], v225, s[24:27], s101 offen offset:128 sc1
  v_mfma_f32_16x16x32_bf16 a[204:207], a[208:211], v[88:91], a[204:207]
  v_mfma_f32_16x16x32_bf16 a[204:207], a[208:211], v[120:123], a[204:207]
  s_waitcnt lgkmcnt(4)
  v_mfma_f32_16x16x32_bf16 a[0:3], a[160:163], v[64:67], a[0:3]
  v_mfma_f32_16x16x32_bf16 a[0:3], a[164:167], v[96:99], a[0:3]
  ds_read_b64_tr_b16 a[176:177], v218 offset:49152
  v_mfma_f32_16x16x32_bf16 a[4:7], a[164:167], v[104:107], a[4:7]
  v_mfma_f32_16x16x32_bf16 a[4:7], a[160:163], v[72:75], a[4:7]
  ds_read_b64_tr_b16 a[178:179], v218 offset:53248
  v_accvgpr_read_b32 v208, a192
  v_mfma_f32_16x16x32_bf16 a[8:11], a[160:163], v[80:83], a[8:11]
  v_accvgpr_read_b32 v209, a196
  v_accvgpr_read_b32 v210, a200
  v_mfma_f32_16x16x32_bf16 a[8:11], a[164:167], v[112:115], a[8:11]
  ds_read_b64_tr_b16 a[180:181], v218 offset:57344
  v_accvgpr_read_b32 v211, a204
  v_mfma_f32_16x16x32_bf16 a[12:15], a[164:167], v[120:123], a[12:15]
  v_mov_b32 v245, v208
  v_mov_b32 v246, v209
  v_mfma_f32_16x16x32_bf16 a[12:15], a[160:163], v[88:91], a[12:15]
  ds_read_b64_tr_b16 a[182:183], v218 offset:61440
  s_waitcnt lgkmcnt(4)
  v_mov_b32 v247, v210
  v_mfma_f32_16x16x32_bf16 a[16:19], a[168:171], v[64:67], a[16:19]
  v_mov_b32 v248, v211
  v_permlane16_swap_b32 v208, v245
  v_mfma_f32_16x16x32_bf16 a[16:19], a[172:175], v[96:99], a[16:19]
  ds_read_b64_tr_b16 a[184:185], v219 offset:49152
  v_permlane16_swap_b32 v209, v246
  v_mfma_f32_16x16x32_bf16 a[20:23], a[172:175], v[104:107], a[20:23]
  v_permlane16_swap_b32 v210, v247
  v_permlane16_swap_b32 v211, v248
  v_mfma_f32_16x16x32_bf16 a[20:23], a[168:171], v[72:75], a[20:23]
  ds_read_b64_tr_b16 a[186:187], v219 offset:53248
  v_add_f32 v208, v208, v245
  v_mfma_f32_16x16x32_bf16 a[24:27], a[168:171], v[80:83], a[24:27]
  v_add_f32 v209, v209, v246
  v_add_f32 v210, v210, v247
  v_mfma_f32_16x16x32_bf16 a[24:27], a[172:175], v[112:115], a[24:27]
  ds_read_b64_tr_b16 a[188:189], v219 offset:57344
  v_add_f32 v211, v211, v248
  v_mfma_f32_16x16x32_bf16 a[28:31], a[172:175], v[120:123], a[28:31]
  v_mov_b32 v245, v208
  v_mov_b32 v246, v209
  v_mfma_f32_16x16x32_bf16 a[28:31], a[168:171], v[88:91], a[28:31]
  ds_read_b64_tr_b16 a[190:191], v219 offset:61440
  s_waitcnt lgkmcnt(4)
  v_mov_b32 v247, v210
  v_mfma_f32_16x16x32_bf16 a[32:35], a[176:179], v[64:67], a[32:35]
  v_mov_b32 v248, v211
  v_permlane32_swap_b32 v208, v245
  v_mfma_f32_16x16x32_bf16 a[32:35], a[180:183], v[96:99], a[32:35]
  ds_read_b64_tr_b16 a[160:161], v220 offset:49152
  v_permlane32_swap_b32 v209, v246
  v_mfma_f32_16x16x32_bf16 a[36:39], a[180:183], v[104:107], a[36:39]
  v_permlane32_swap_b32 v210, v247
  v_permlane32_swap_b32 v211, v248
  v_mfma_f32_16x16x32_bf16 a[36:39], a[176:179], v[72:75], a[36:39]
  ds_read_b64_tr_b16 a[162:163], v220 offset:53248
  v_add_f32 v208, v208, v245
  v_mfma_f32_16x16x32_bf16 a[40:43], a[176:179], v[80:83], a[40:43]
  v_add_f32 v209, v209, v246
  v_add_f32 v210, v210, v247
  v_mfma_f32_16x16x32_bf16 a[40:43], a[180:183], v[112:115], a[40:43]
  ds_read_b64_tr_b16 a[164:165], v220 offset:57344
  v_add_f32 v211, v211, v248
  v_mfma_f32_16x16x32_bf16 a[44:47], a[180:183], v[120:123], a[44:47]
  v_rcp_f32 v192, v208
  v_mfma_f32_16x16x32_bf16 a[44:47], a[176:179], v[88:91], a[44:47]
  ds_read_b64_tr_b16 a[166:167], v220 offset:61440
  s_waitcnt lgkmcnt(4)
  v_mfma_f32_16x16x32_bf16 a[48:51], a[184:187], v[64:67], a[48:51]
  v_rcp_f32 v196, v209
  v_mfma_f32_16x16x32_bf16 a[48:51], a[188:191], v[96:99], a[48:51]
  ds_read_b64_tr_b16 a[168:169], v221 offset:49152
  v_mfma_f32_16x16x32_bf16 a[52:55], a[188:191], v[104:107], a[52:55]
  v_rcp_f32 v200, v210
  v_mfma_f32_16x16x32_bf16 a[52:55], a[184:187], v[72:75], a[52:55]
  ds_read_b64_tr_b16 a[170:171], v221 offset:53248
  v_mfma_f32_16x16x32_bf16 a[56:59], a[184:187], v[80:83], a[56:59]
  v_rcp_f32 v204, v211
  v_mfma_f32_16x16x32_bf16 a[56:59], a[188:191], v[112:115], a[56:59]
  ds_read_b64_tr_b16 a[172:173], v221 offset:57344
  v_add_f32 v246, v208, v209
  v_mfma_f32_16x16x32_bf16 a[60:63], a[188:191], v[120:123], a[60:63]
  v_add_f32 v247, v210, v211
  v_add_f32 v246, v246, v247
  v_mfma_f32_16x16x32_bf16 a[60:63], a[184:187], v[88:91], a[60:63]
  ds_read_b64_tr_b16 a[174:175], v221 offset:61440
  s_waitcnt lgkmcnt(4)
  v_lshrrev_b32 v247, 2, v242
  v_mfma_f32_16x16x32_bf16 a[64:67], a[160:163], v[64:67], a[64:67]
  v_cmp_nlt_f32 vcc, v246, s48
  v_add_u32 v247, s39, v247
  v_mfma_f32_16x16x32_bf16 a[64:67], a[164:167], v[96:99], a[64:67]
  ds_read_b64_tr_b16 a[176:177], v222 offset:49152
  v_add_u32 v247, 157696, v247
  v_mfma_f32_16x16x32_bf16 a[68:71], a[164:167], v[104:107], a[68:71]
  v_cndmask_b32_e64 v245, 0, 1, vcc
  v_accvgpr_read_b32 v0, a0
  v_mfma_f32_16x16x32_bf16 a[68:71], a[160:163], v[72:75], a[68:71]
  ds_read_b64_tr_b16 a[178:179], v222 offset:53248
  v_accvgpr_read_b32 v1, a1
  v_mfma_f32_16x16x32_bf16 a[72:75], a[160:163], v[80:83], a[72:75]
  v_accvgpr_read_b32 v2, a2
  v_accvgpr_read_b32 v3, a3
  v_mfma_f32_16x16x32_bf16 a[72:75], a[164:167], v[112:115], a[72:75]
  ds_read_b64_tr_b16 a[180:181], v222 offset:57344
  v_accvgpr_read_b32 v4, a16
  v_mfma_f32_16x16x32_bf16 a[76:79], a[164:167], v[120:123], a[76:79]
  v_accvgpr_read_b32 v5, a17
  v_accvgpr_read_b32 v6, a18
  v_mfma_f32_16x16x32_bf16 a[76:79], a[160:163], v[88:91], a[76:79]
  ds_read_b64_tr_b16 a[182:183], v222 offset:61440
  s_waitcnt lgkmcnt(4)
  v_accvgpr_read_b32 v7, a19
  v_mfma_f32_16x16x32_bf16 a[80:83], a[168:171], v[64:67], a[80:83]
  v_mul_f32 v0, v0, v192
  v_mul_f32 v1, v1, v192
  v_mfma_f32_16x16x32_bf16 a[80:83], a[172:175], v[96:99], a[80:83]
  ds_read_b64_tr_b16 a[184:185], v223 offset:49152
  v_mul_f32 v2, v2, v192
  v_mfma_f32_16x16x32_bf16 a[84:87], a[172:175], v[104:107], a[84:87]
  v_mul_f32 v3, v3, v192
  v_mul_f32 v4, v4, v192
  v_mfma_f32_16x16x32_bf16 a[84:87], a[168:171], v[72:75], a[84:87]
  ds_read_b64_tr_b16 a[186:187], v223 offset:53248
  v_mul_f32 v5, v5, v192
  v_mfma_f32_16x16x32_bf16 a[88:91], a[168:171], v[80:83], a[88:91]
  v_mul_f32 v6, v6, v192
  v_mul_f32 v7, v7, v192
  v_mfma_f32_16x16x32_bf16 a[88:91], a[172:175], v[112:115], a[88:91]
  ds_read_b64_tr_b16 a[188:189], v223 offset:57344
  v_cvt_pk_bf16_f32 v0, v0, v1
  v_mfma_f32_16x16x32_bf16 a[92:95], a[172:175], v[120:123], a[92:95]
  v_cvt_pk_bf16_f32 v1, v2, v3
  v_cvt_pk_bf16_f32 v2, v4, v5
  v_mfma_f32_16x16x32_bf16 a[92:95], a[168:171], v[88:91], a[92:95]
  ds_read_b64_tr_b16 a[190:191], v223 offset:61440
  s_waitcnt lgkmcnt(4)
  v_cvt_pk_bf16_f32 v3, v6, v7
  v_mfma_f32_16x16x32_bf16 a[96:99], a[176:179], v[64:67], a[96:99]
  buffer_store_dwordx4 v[0:3], v244, s[24:27], s40 offen offset:0 sc1
  v_mfma_f32_16x16x32_bf16 a[96:99], a[180:183], v[96:99], a[96:99]
  v_accvgpr_read_b32 v8, a4
  v_accvgpr_read_b32 v9, a5
  v_mfma_f32_16x16x32_bf16 a[100:103], a[180:183], v[104:107], a[100:103]
  v_accvgpr_read_b32 v10, a6
  v_accvgpr_read_b32 v11, a7
  v_mfma_f32_16x16x32_bf16 a[100:103], a[176:179], v[72:75], a[100:103]
  v_accvgpr_read_b32 v12, a20
  v_accvgpr_read_b32 v13, a21
  v_mfma_f32_16x16x32_bf16 a[104:107], a[176:179], v[80:83], a[104:107]
  v_accvgpr_read_b32 v14, a22
  v_accvgpr_read_b32 v15, a23
  v_mfma_f32_16x16x32_bf16 a[104:107], a[180:183], v[112:115], a[104:107]
  v_mul_f32 v8, v8, v196
  v_mul_f32 v9, v9, v196
  v_mfma_f32_16x16x32_bf16 a[108:111], a[180:183], v[120:123], a[108:111]
  v_mul_f32 v10, v10, v196
  v_mul_f32 v11, v11, v196
  v_mfma_f32_16x16x32_bf16 a[108:111], a[176:179], v[88:91], a[108:111]
  s_waitcnt lgkmcnt(0)
  v_mul_f32 v12, v12, v196
  v_mul_f32 v13, v13, v196
  v_mfma_f32_16x16x32_bf16 a[112:115], a[184:187], v[64:67], a[112:115]
  v_mul_f32 v14, v14, v196
  v_mul_f32 v15, v15, v196
  v_mfma_f32_16x16x32_bf16 a[112:115], a[188:191], v[96:99], a[112:115]
  v_cvt_pk_bf16_f32 v8, v8, v9
  v_cvt_pk_bf16_f32 v9, v10, v11
  v_mfma_f32_16x16x32_bf16 a[116:119], a[188:191], v[104:107], a[116:119]
  v_cvt_pk_bf16_f32 v10, v12, v13
  v_cvt_pk_bf16_f32 v11, v14, v15
  v_mfma_f32_16x16x32_bf16 a[116:119], a[184:187], v[72:75], a[116:119]
  buffer_store_dwordx4 v[8:11], v244, s[24:27], s40 offen offset:2048 sc1
  v_mfma_f32_16x16x32_bf16 a[120:123], a[184:187], v[80:83], a[120:123]
  v_accvgpr_read_b32 v16, a8
  v_accvgpr_read_b32 v17, a9
  v_mfma_f32_16x16x32_bf16 a[120:123], a[188:191], v[112:115], a[120:123]
  v_accvgpr_read_b32 v18, a10
  v_accvgpr_read_b32 v19, a11
  v_mfma_f32_16x16x32_bf16 a[124:127], a[188:191], v[120:123], a[124:127]
  v_accvgpr_read_b32 v20, a24
  v_accvgpr_read_b32 v21, a25
  v_mfma_f32_16x16x32_bf16 a[124:127], a[184:187], v[88:91], a[124:127]
  v_accvgpr_read_b32 v22, a26
  v_accvgpr_read_b32 v23, a27
  v_mul_f32 v16, v16, v200
  v_mul_f32 v17, v17, v200
  v_mul_f32 v18, v18, v200
  v_mul_f32 v19, v19, v200
  v_mul_f32 v20, v20, v200
  v_mul_f32 v21, v21, v200
  v_mul_f32 v22, v22, v200
  v_mul_f32 v23, v23, v200
  v_cvt_pk_bf16_f32 v16, v16, v17
  v_cvt_pk_bf16_f32 v17, v18, v19
  v_cvt_pk_bf16_f32 v18, v20, v21
  v_cvt_pk_bf16_f32 v19, v22, v23
  buffer_store_dwordx4 v[16:19], v244, s[24:27], s41 offen offset:0 sc1
  v_accvgpr_read_b32 v24, a12
  v_accvgpr_read_b32 v25, a13
  v_accvgpr_read_b32 v26, a14
  v_accvgpr_read_b32 v27, a15
  v_accvgpr_read_b32 v28, a28
  v_accvgpr_read_b32 v29, a29
  v_accvgpr_read_b32 v30, a30
  v_accvgpr_read_b32 v31, a31
  v_mul_f32 v24, v24, v204
  v_mul_f32 v25, v25, v204
  v_mul_f32 v26, v26, v204
  v_mul_f32 v27, v27, v204
  v_mul_f32 v28, v28, v204
  v_mul_f32 v29, v29, v204
  v_mul_f32 v30, v30, v204
  v_mul_f32 v31, v31, v204
  v_cvt_pk_bf16_f32 v24, v24, v25
  v_cvt_pk_bf16_f32 v25, v26, v27
  v_cvt_pk_bf16_f32 v26, v28, v29
  v_cvt_pk_bf16_f32 v27, v30, v31
  buffer_store_dwordx4 v[24:27], v244, s[24:27], s41 offen offset:2048 sc1
  v_accvgpr_read_b32 v32, a32
  v_accvgpr_read_b32 v33, a33
  v_accvgpr_read_b32 v34, a34
  v_accvgpr_read_b32 v35, a35
  v_accvgpr_read_b32 v36, a48
  v_accvgpr_read_b32 v37, a49
  v_accvgpr_read_b32 v38, a50
  v_accvgpr_read_b32 v39, a51
  v_mul_f32 v32, v32, v192
  v_mul_f32 v33, v33, v192
  v_mul_f32 v34, v34, v192
  v_mul_f32 v35, v35, v192
  v_mul_f32 v36, v36, v192
  v_mul_f32 v37, v37, v192
  v_mul_f32 v38, v38, v192
  v_mul_f32 v39, v39, v192
  v_cvt_pk_bf16_f32 v32, v32, v33
  v_cvt_pk_bf16_f32 v33, v34, v35
  v_cvt_pk_bf16_f32 v34, v36, v37
  v_cvt_pk_bf16_f32 v35, v38, v39
  buffer_store_dwordx4 v[32:35], v244, s[24:27], s40 offen offset:1024 sc1
  v_accvgpr_read_b32 v40, a36
  v_accvgpr_read_b32 v41, a37
  v_accvgpr_read_b32 v42, a38
  v_accvgpr_read_b32 v43, a39
  v_accvgpr_read_b32 v44, a52
  v_accvgpr_read_b32 v45, a53
  v_accvgpr_read_b32 v46, a54
  v_accvgpr_read_b32 v47, a55
  v_mul_f32 v40, v40, v196
  v_mul_f32 v41, v41, v196
  v_mul_f32 v42, v42, v196
  v_mul_f32 v43, v43, v196
  v_mul_f32 v44, v44, v196
  v_mul_f32 v45, v45, v196
  v_mul_f32 v46, v46, v196
  v_mul_f32 v47, v47, v196
  v_cvt_pk_bf16_f32 v40, v40, v41
  v_cvt_pk_bf16_f32 v41, v42, v43
  v_cvt_pk_bf16_f32 v42, v44, v45
  v_cvt_pk_bf16_f32 v43, v46, v47
  buffer_store_dwordx4 v[40:43], v244, s[24:27], s40 offen offset:3072 sc1
  v_accvgpr_read_b32 v48, a40
  v_accvgpr_read_b32 v49, a41
  v_accvgpr_read_b32 v50, a42
  v_accvgpr_read_b32 v51, a43
  v_accvgpr_read_b32 v52, a56
  v_accvgpr_read_b32 v53, a57
  v_accvgpr_read_b32 v54, a58
  v_accvgpr_read_b32 v55, a59
  v_mul_f32 v48, v48, v200
  v_mul_f32 v49, v49, v200
  v_mul_f32 v50, v50, v200
  v_mul_f32 v51, v51, v200
  v_mul_f32 v52, v52, v200
  v_mul_f32 v53, v53, v200
  v_mul_f32 v54, v54, v200
  v_mul_f32 v55, v55, v200
  v_cvt_pk_bf16_f32 v48, v48, v49
  v_cvt_pk_bf16_f32 v49, v50, v51
  v_cvt_pk_bf16_f32 v50, v52, v53
  v_cvt_pk_bf16_f32 v51, v54, v55
  buffer_store_dwordx4 v[48:51], v244, s[24:27], s41 offen offset:1024 sc1
  v_accvgpr_read_b32 v56, a44
  v_accvgpr_read_b32 v57, a45
  v_accvgpr_read_b32 v58, a46
  v_accvgpr_read_b32 v59, a47
  v_accvgpr_read_b32 v60, a60
  v_accvgpr_read_b32 v61, a61
  v_accvgpr_read_b32 v62, a62
  v_accvgpr_read_b32 v63, a63
  v_mul_f32 v56, v56, v204
  v_mul_f32 v57, v57, v204
  v_mul_f32 v58, v58, v204
  v_mul_f32 v59, v59, v204
  v_mul_f32 v60, v60, v204
  v_mul_f32 v61, v61, v204
  v_mul_f32 v62, v62, v204
  v_mul_f32 v63, v63, v204
  v_cvt_pk_bf16_f32 v56, v56, v57
  v_cvt_pk_bf16_f32 v57, v58, v59
  v_cvt_pk_bf16_f32 v58, v60, v61
  v_cvt_pk_bf16_f32 v59, v62, v63
  buffer_store_dwordx4 v[56:59], v244, s[24:27], s41 offen offset:3072 sc1
  v_accvgpr_read_b32 v0, a64
  v_accvgpr_read_b32 v1, a65
  v_accvgpr_read_b32 v2, a66
  v_accvgpr_read_b32 v3, a67
  v_accvgpr_read_b32 v4, a80
  v_accvgpr_read_b32 v5, a81
  v_accvgpr_read_b32 v6, a82
  v_accvgpr_read_b32 v7, a83
  v_mul_f32 v0, v0, v192
  v_mul_f32 v1, v1, v192
  v_mul_f32 v2, v2, v192
  v_mul_f32 v3, v3, v192
  v_mul_f32 v4, v4, v192
  v_mul_f32 v5, v5, v192
  v_mul_f32 v6, v6, v192
  v_mul_f32 v7, v7, v192
  v_cvt_pk_bf16_f32 v0, v0, v1
  v_cvt_pk_bf16_f32 v1, v2, v3
  v_cvt_pk_bf16_f32 v2, v4, v5
  v_cvt_pk_bf16_f32 v3, v6, v7
  buffer_store_dwordx4 v[0:3], v244, s[24:27], s42 offen offset:0 sc1
  v_accvgpr_read_b32 v8, a68
  v_accvgpr_read_b32 v9, a69
  v_accvgpr_read_b32 v10, a70
  v_accvgpr_read_b32 v11, a71
  v_accvgpr_read_b32 v12, a84
  v_accvgpr_read_b32 v13, a85
  v_accvgpr_read_b32 v14, a86
  v_accvgpr_read_b32 v15, a87
  v_mul_f32 v8, v8, v196
  v_mul_f32 v9, v9, v196
  v_mul_f32 v10, v10, v196
  v_mul_f32 v11, v11, v196
  v_mul_f32 v12, v12, v196
  v_mul_f32 v13, v13, v196
  v_mul_f32 v14, v14, v196
  v_mul_f32 v15, v15, v196
  v_cvt_pk_bf16_f32 v8, v8, v9
  v_cvt_pk_bf16_f32 v9, v10, v11
  v_cvt_pk_bf16_f32 v10, v12, v13
  v_cvt_pk_bf16_f32 v11, v14, v15
  buffer_store_dwordx4 v[8:11], v244, s[24:27], s42 offen offset:2048 sc1
  v_accvgpr_read_b32 v16, a72
  v_accvgpr_read_b32 v17, a73
  v_accvgpr_read_b32 v18, a74
  v_accvgpr_read_b32 v19, a75
  v_accvgpr_read_b32 v20, a88
  v_accvgpr_read_b32 v21, a89
  v_accvgpr_read_b32 v22, a90
  v_accvgpr_read_b32 v23, a91
  v_mul_f32 v16, v16, v200
  v_mul_f32 v17, v17, v200
  v_mul_f32 v18, v18, v200
  v_mul_f32 v19, v19, v200
  v_mul_f32 v20, v20, v200
  v_mul_f32 v21, v21, v200
  v_mul_f32 v22, v22, v200
  v_mul_f32 v23, v23, v200
  v_cvt_pk_bf16_f32 v16, v16, v17
  v_cvt_pk_bf16_f32 v17, v18, v19
  v_cvt_pk_bf16_f32 v18, v20, v21
  v_cvt_pk_bf16_f32 v19, v22, v23
  buffer_store_dwordx4 v[16:19], v244, s[24:27], s43 offen offset:0 sc1
  v_accvgpr_read_b32 v24, a76
  v_accvgpr_read_b32 v25, a77
  v_accvgpr_read_b32 v26, a78
  v_accvgpr_read_b32 v27, a79
  v_accvgpr_read_b32 v28, a92
  v_accvgpr_read_b32 v29, a93
  v_accvgpr_read_b32 v30, a94
  v_accvgpr_read_b32 v31, a95
  v_mul_f32 v24, v24, v204
  v_mul_f32 v25, v25, v204
  v_mul_f32 v26, v26, v204
  v_mul_f32 v27, v27, v204
  v_mul_f32 v28, v28, v204
  v_mul_f32 v29, v29, v204
  v_mul_f32 v30, v30, v204
  v_mul_f32 v31, v31, v204
  v_cvt_pk_bf16_f32 v24, v24, v25
  v_cvt_pk_bf16_f32 v25, v26, v27
  v_cvt_pk_bf16_f32 v26, v28, v29
  v_cvt_pk_bf16_f32 v27, v30, v31
  buffer_store_dwordx4 v[24:27], v244, s[24:27], s43 offen offset:2048 sc1
  v_accvgpr_read_b32 v32, a96
  v_accvgpr_read_b32 v33, a97
  v_accvgpr_read_b32 v34, a98
  v_accvgpr_read_b32 v35, a99
  v_accvgpr_read_b32 v36, a112
  v_accvgpr_read_b32 v37, a113
  v_accvgpr_read_b32 v38, a114
  v_accvgpr_read_b32 v39, a115
  v_mul_f32 v32, v32, v192
  v_mul_f32 v33, v33, v192
  v_mul_f32 v34, v34, v192
  v_mul_f32 v35, v35, v192
  v_mul_f32 v36, v36, v192
  v_mul_f32 v37, v37, v192
  v_mul_f32 v38, v38, v192
  v_mul_f32 v39, v39, v192
  v_cvt_pk_bf16_f32 v32, v32, v33
  v_cvt_pk_bf16_f32 v33, v34, v35
  v_cvt_pk_bf16_f32 v34, v36, v37
  v_cvt_pk_bf16_f32 v35, v38, v39
  buffer_store_dwordx4 v[32:35], v244, s[24:27], s42 offen offset:1024 sc1
  v_accvgpr_read_b32 v40, a100
  v_accvgpr_read_b32 v41, a101
  v_accvgpr_read_b32 v42, a102
  v_accvgpr_read_b32 v43, a103
  v_accvgpr_read_b32 v44, a116
  v_accvgpr_read_b32 v45, a117
  v_accvgpr_read_b32 v46, a118
  v_accvgpr_read_b32 v47, a119
  v_mul_f32 v40, v40, v196
  v_mul_f32 v41, v41, v196
  v_mul_f32 v42, v42, v196
  v_mul_f32 v43, v43, v196
  v_mul_f32 v44, v44, v196
  v_mul_f32 v45, v45, v196
  v_mul_f32 v46, v46, v196
  v_mul_f32 v47, v47, v196
  v_cvt_pk_bf16_f32 v40, v40, v41
  v_cvt_pk_bf16_f32 v41, v42, v43
  v_cvt_pk_bf16_f32 v42, v44, v45
  v_cvt_pk_bf16_f32 v43, v46, v47
  buffer_store_dwordx4 v[40:43], v244, s[24:27], s42 offen offset:3072 sc1
  v_accvgpr_read_b32 v48, a104
  v_accvgpr_read_b32 v49, a105
  v_accvgpr_read_b32 v50, a106
  v_accvgpr_read_b32 v51, a107
  v_accvgpr_read_b32 v52, a120
  v_accvgpr_read_b32 v53, a121
  v_accvgpr_read_b32 v54, a122
  v_accvgpr_read_b32 v55, a123
  v_mul_f32 v48, v48, v200
  v_mul_f32 v49, v49, v200
  v_mul_f32 v50, v50, v200
  v_mul_f32 v51, v51, v200
  v_mul_f32 v52, v52, v200
  v_mul_f32 v53, v53, v200
  v_mul_f32 v54, v54, v200
  v_mul_f32 v55, v55, v200
  v_cvt_pk_bf16_f32 v48, v48, v49
  v_cvt_pk_bf16_f32 v49, v50, v51
  v_cvt_pk_bf16_f32 v50, v52, v53
  v_cvt_pk_bf16_f32 v51, v54, v55
  buffer_store_dwordx4 v[48:51], v244, s[24:27], s43 offen offset:1024 sc1
  v_accvgpr_read_b32 v56, a108
  v_accvgpr_read_b32 v57, a109
  v_accvgpr_read_b32 v58, a110
  v_accvgpr_read_b32 v59, a111
  v_accvgpr_read_b32 v60, a124
  v_accvgpr_read_b32 v61, a125
  v_accvgpr_read_b32 v62, a126
  v_accvgpr_read_b32 v63, a127
  v_mul_f32 v56, v56, v204
  v_mul_f32 v57, v57, v204
  v_mul_f32 v58, v58, v204
  v_mul_f32 v59, v59, v204
  v_mul_f32 v60, v60, v204
  v_mul_f32 v61, v61, v204
  v_mul_f32 v62, v62, v204
  v_mul_f32 v63, v63, v204
  v_cvt_pk_bf16_f32 v56, v56, v57
  v_cvt_pk_bf16_f32 v57, v58, v59
  v_cvt_pk_bf16_f32 v58, v60, v61
  v_cvt_pk_bf16_f32 v59, v62, v63
  buffer_store_dwordx4 v[56:59], v244, s[24:27], s43 offen offset:3072 sc1
  ds_write_b32 v247, v245
  v_lshrrev_b32 v224, 4, v242
  v_lshrrev_b32 v225, 4, v224
  v_bfe_u32 v226, v224, 2, 2
  v_lshl_add_u32 v225, v225, 3, v226
  v_lshlrev_b32 v225, 5, v225
  v_and_b32 v226, 3, v224
  v_lshl_add_u32 v225, v226, 3, v225
  v_add_u32 v225, s50, v225
  s_waitcnt vmcnt(16)
  ds_read_b64_tr_b16 a[232:233], v225 offset:0
  ds_read_b64_tr_b16 a[234:235], v225 offset:128
  ds_read_b64_tr_b16 a[236:237], v225 offset:1024
  ds_read_b64_tr_b16 a[238:239], v225 offset:1152
  ds_read_b64_tr_b16 a[240:241], v225 offset:2048
  ds_read_b64_tr_b16 a[242:243], v225 offset:2176
  s_waitcnt lgkmcnt(0)
  v_mfma_f32_16x16x32_bf16 v[228:231], a[232:235], a[212:215], 0
  v_mfma_f32_16x16x32_bf16 v[228:231], a[236:239], a[216:219], v[228:231]
  v_mfma_f32_16x16x32_bf16 v[228:231], a[240:243], a[220:223], v[228:231]
  s_lshl_b32 s35, s3, 10
  s_add_u32 s35, s35, 159744
  v_add_u32 v224, s35, v242
  s_nop 4
  ds_write_b128 v224, v[228:231]
  s_waitcnt lgkmcnt(0)
  v_lshlrev_b32 v246, 0, v242
  v_add_u32 v246, 157696, v246
  s_waitcnt lgkmcnt(0)
  s_barrier
  ds_read_b128 v[248:251], v246
  v_add_u32 v224, 159744, v242
  ds_read_b128 v[64:67], v224 offset:0
  ds_read_b128 v[68:71], v224 offset:1024
  ds_read_b128 v[72:75], v224 offset:2048
  v_lshrrev_b32 v224, 4, v242
  s_cmp_eq_u32 s3, 0
  s_cselect_b32 s35, 0, 1073741824
  v_and_b32 v225, 7, v224
  v_mul_u32_u24 v225, 0xa00, v225
  v_lshrrev_b32 v226, 4, v224
  v_lshl_add_u32 v225, v226, 4, v225
  v_bfe_u32 v226, v224, 3, 1
  v_lshl_add_u32 v225, v226, 30, v225
  v_or_b32 v225, s35, v225
  s_mul_i32 s35, s98, 20480
  s_lshl_b32 s38, s99, 6
  s_add_u32 s35, s35, s38
  s_add_u32 s35, s35, 2686976
  s_waitcnt lgkmcnt(1)
  v_add_f32 v64, v64, v68
  v_add_f32 v65, v65, v69
  v_add_f32 v66, v66, v70
  v_add_f32 v67, v67, v71
  s_waitcnt lgkmcnt(0)
  v_add_f32 v64, v64, v72
  v_add_f32 v65, v65, v73
  v_add_f32 v66, v66, v74
  v_add_f32 v67, v67, v75
  buffer_store_dwordx4 v[64:67], v225, s[24:27], s35 offen sc1
  v_or3_b32 v248, v248, v249, v250
  v_or_b32 v248, v248, v251
  v_cmp_ne_u32 vcc, 0, v248
  s_nop 0
  s_cbranch_vccnz attn_redo
tail_go:
  s_and_b32 s38, s2, 7
  s_lshr_b32 s39, s2, 3
  s_lshr_b32 s28, s38, 1
  s_lshl_b32 s28, s28, 3
  s_and_b32 s35, s39, 7
  s_add_u32 s28, s28, s35
  s_and_b32 s29, s38, 1
  s_lshl_b32 s29, s29, 2
  s_lshr_b32 s39, s39, 3
  s_add_u32 s29, s29, s39
  v_mov_b32 v114, v242
  v_add_u32 v115, 0x1000, v114
  v_add_u32 v116, 0x2000, v114
  s_mul_i32 s31, s29, 655360
  s_mul_i32 s38, s3, 163840
  s_add_u32 s31, s31, s38
  s_add_u32 s31, s31, 3145728
  s_mul_i32 s33, s3, 35840
  s_add_u32 s33, s33, 4096
  s_add_u32 s4, s31, 0
  s_add_u32 s5, s31, 12288
  s_add_u32 s6, s31, 24576
  s_add_u32 s7, s31, 36864
  s_add_u32 s8, s31, 49152
  s_add_u32 s9, s31, 61440
  s_add_u32 s10, s31, 73728
  s_add_u32 s11, s31, 86016
  buffer_load_dwordx4 v[176:179], v114, s[24:27], s4 offen offset:0 sc1
  buffer_load_dwordx4 v[180:183], v114, s[24:27], s4 offen offset:1024 sc1
  buffer_load_dwordx4 v[184:187], v114, s[24:27], s4 offen offset:2048 sc1
  buffer_load_dwordx4 v[188:191], v114, s[24:27], s4 offen offset:3072 sc1
  buffer_load_dwordx4 v[192:195], v115, s[24:27], s4 offen offset:0 sc1
  buffer_load_dwordx4 v[196:199], v115, s[24:27], s4 offen offset:1024 sc1
  buffer_load_dwordx4 v[200:203], v115, s[24:27], s4 offen offset:2048 sc1
  buffer_load_dwordx4 v[204:207], v115, s[24:27], s4 offen offset:3072 sc1
  buffer_load_dwordx4 v[208:211], v116, s[24:27], s4 offen offset:0 sc1
  buffer_load_dwordx4 v[212:215], v116, s[24:27], s4 offen offset:1024 sc1
  buffer_load_dwordx4 v[216:219], v116, s[24:27], s4 offen offset:2048 sc1
  buffer_load_dwordx4 v[220:223], v116, s[24:27], s4 offen offset:3072 sc1
  buffer_load_dwordx4 v[224:227], v114, s[24:27], s5 offen offset:0 sc1
  buffer_load_dwordx4 v[228:231], v114, s[24:27], s5 offen offset:1024 sc1
  buffer_load_dwordx4 v[232:235], v114, s[24:27], s5 offen offset:2048 sc1
  buffer_load_dwordx4 v[236:239], v114, s[24:27], s5 offen offset:3072 sc1
  buffer_load_dwordx4 v[240:243], v115, s[24:27], s5 offen offset:0 sc1
  buffer_load_dwordx4 v[244:247], v115, s[24:27], s5 offen offset:1024 sc1
  buffer_load_dwordx4 v[248:251], v115, s[24:27], s5 offen offset:2048 sc1
  buffer_load_dwordx4 v[252:255], v115, s[24:27], s5 offen offset:3072 sc1
  buffer_load_dwordx4 a[0:3], v116, s[24:27], s5 offen offset:0 sc1
  buffer_load_dwordx4 a[4:7], v116, s[24:27], s5 offen offset:1024 sc1
  buffer_load_dwordx4 a[8:11], v116, s[24:27], s5 offen offset:2048 sc1
  buffer_load_dwordx4 a[12:15], v116, s[24:27], s5 offen offset:3072 sc1
  buffer_load_dwordx4 a[16:19], v114, s[24:27], s6 offen offset:0 sc1
  buffer_load_dwordx4 a[20:23], v114, s[24:27], s6 offen offset:1024 sc1
  buffer_load_dwordx4 a[24:27], v114, s[24:27], s6 offen offset:2048 sc1
  buffer_load_dwordx4 a[28:31], v114, s[24:27], s6 offen offset:3072 sc1
  buffer_load_dwordx4 a[32:35], v115, s[24:27], s6 offen offset:0 sc1
  buffer_load_dwordx4 a[36:39], v115, s[24:27], s6 offen offset:1024 sc1
  buffer_load_dwordx4 a[40:43], v115, s[24:27], s6 offen offset:2048 sc1
  buffer_load_dwordx4 a[44:47], v115, s[24:27], s6 offen offset:3072 sc1
  buffer_load_dwordx4 a[48:51], v116, s[24:27], s6 offen offset:0 sc1
  buffer_load_dwordx4 a[52:55], v116, s[24:27], s6 offen offset:1024 sc1
  buffer_load_dwordx4 a[56:59], v116, s[24:27], s6 offen offset:2048 sc1
  buffer_load_dwordx4 a[60:63], v116, s[24:27], s6 offen offset:3072 sc1
  buffer_load_dwordx4 a[64:67], v114, s[24:27], s7 offen offset:0 sc1
  buffer_load_dwordx4 a[68:71], v114, s[24:27], s7 offen offset:1024 sc1
  buffer_load_dwordx4 a[72:75], v114, s[24:27], s7 offen offset:2048 sc1
  buffer_load_dwordx4 a[76:79], v114, s[24:27], s7 offen offset:3072 sc1
  s_bfe_u32 s38, s2, 0x30003
  s_lshl_b32 s38, s38, 8
  s_add_u32 s38, s38, 2818304
  s_mul_i32 s39, s99, 13108
  s_lshr_b32 s39, s39, 16
  s_lshl_b32 s39, s39, 8
  s_add_u32 s39, s39, 2820352
  s_cmp_lt_u32 s2, 240
  s_cselect_b32 s39, s39, 1073741824
  v_mov_b32 v135, 1073741824
  v_writelane_b32 v135, s38, 0
  v_writelane_b32 v135, s39, 1
  s_cmp_eq_u32 s3, 0
  s_cselect_b32 s38, 0, 1073741824
  v_or_b32 v135, s38, v135
  v_mov_b32 v129, 1
  s_waitcnt vmcnt(40)
  s_barrier
  buffer_atomic_add v129, v135, s[24:27], 0 offen
  buffer_load_dwordx4 a[80:83], v115, s[24:27], s7 offen offset:0 sc1
  buffer_load_dwordx4 a[84:87], v115, s[24:27], s7 offen offset:1024 sc1
  buffer_load_dwordx4 a[88:91], v115, s[24:27], s7 offen offset:2048 sc1
  buffer_load_dwordx4 a[92:95], v115, s[24:27], s7 offen offset:3072 sc1
  buffer_load_dwordx4 a[96:99], v116, s[24:27], s7 offen offset:0 sc1
  buffer_load_dwordx4 a[100:103], v116, s[24:27], s7 offen offset:1024 sc1
  buffer_load_dwordx4 a[104:107], v116, s[24:27], s7 offen offset:2048 sc1
  buffer_load_dwordx4 a[108:111], v116, s[24:27], s7 offen offset:3072 sc1
  buffer_load_dwordx4 a[112:115], v114, s[24:27], s8 offen offset:0 sc1
  buffer_load_dwordx4 a[116:119], v114, s[24:27], s8 offen offset:1024 sc1
  s_add_u32 m0, s33, -2048
  s_nop 0
  buffer_load_dwordx4 v114, s[24:27], s8 offen offset:2048 sc1 lds
  s_add_u32 m0, s33, -2048
  s_nop 0
  buffer_load_dwordx4 v114, s[24:27], s8 offen offset:3072 sc1 lds
  s_add_u32 m0, s33, 2048
  s_nop 0
  buffer_load_dwordx4 v115, s[24:27], s8 offen offset:0 sc1 lds
  s_add_u32 m0, s33, 2048
  s_nop 0
  buffer_load_dwordx4 v115, s[24:27], s8 offen offset:1024 sc1 lds
  s_add_u32 m0, s33, 2048
  s_nop 0
  buffer_load_dwordx4 v115, s[24:27], s8 offen offset:2048 sc1 lds
  s_add_u32 m0, s33, 2048
  s_nop 0
  buffer_load_dwordx4 v115, s[24:27], s8 offen offset:3072 sc1 lds
  s_add_u32 m0, s33, 6144
  s_nop 0
  buffer_load_dwordx4 v116, s[24:27], s8 offen offset:0 sc1 lds
  s_add_u32 m0, s33, 6144
  s_nop 0
  buffer_load_dwordx4 v116, s[24:27], s8 offen offset:1024 sc1 lds
  s_add_u32 m0, s33, 6144
  s_nop 0
  buffer_load_dwordx4 v116, s[24:27], s8 offen offset:2048 sc1 lds
  s_add_u32 m0, s33, 6144
  s_nop 0
  buffer_load_dwordx4 v116, s[24:27], s8 offen offset:3072 sc1 lds
  s_add_u32 m0, s33, 10240
  s_nop 0
  buffer_load_dwordx4 v114, s[24:27], s9 offen offset:0 sc1 lds
  s_add_u32 m0, s33, 10240
  s_waitcnt vmcnt(60)
  buffer_load_dwordx4 v114, s[24:27], s9 offen offset:1024 sc1 lds
  s_add_u32 m0, s33, 10240
  s_nop 0
  buffer_load_dwordx4 v114, s[24:27], s9 offen offset:2048 sc1 lds
  s_add_u32 m0, s33, 10240
  s_waitcnt vmcnt(60)
  buffer_load_dwordx4 v114, s[24:27], s9 offen offset:3072 sc1 lds
  s_add_u32 m0, s33, 14336
  s_nop 0
  buffer_load_dwordx4 v115, s[24:27], s9 offen offset:0 sc1 lds
  s_add_u32 m0, s33, 14336
  s_waitcnt vmcnt(60)
  buffer_load_dwordx4 v115, s[24:27], s9 offen offset:1024 sc1 lds
  s_add_u32 m0, s33, 14336
  s_nop 0
  buffer_load_dwordx4 v115, s[24:27], s9 offen offset:2048 sc1 lds
  s_add_u32 m0, s33, 14336
  s_waitcnt vmcnt(60)
  buffer_load_dwordx4 v115, s[24:27], s9 offen offset:3072 sc1 lds
  s_add_u32 m0, s33, 18432
  s_nop 0
  buffer_load_dwordx4 v116, s[24:27], s9 offen offset:0 sc1 lds
  s_add_u32 m0, s33, 18432
  s_waitcnt vmcnt(60)
  buffer_load_dwordx4 v116, s[24:27], s9 offen offset:1024 sc1 lds
  v_lshrrev_b32 v125, 4, v114
  v_and_b32 v126, 15, v125
  v_lshrrev_b32 v127, 4, v125
  s_add_u32 s38, s3, 0
  s_and_b32 s38, s38, 3
  s_lshl_b32 s38, s38, 11
  v_add_u32 v110, s38, v114
  s_add_u32 s38, s3, 1
  s_and_b32 s38, s38, 3
  s_lshl_b32 s38, s38, 11
  v_add_u32 v111, s38, v114
  s_sub_u32 s38, s3, 1
  s_and_b32 s38, s38, 3
  s_mul_i32 s38, s38, 35840
  s_add_u32 s38, s38, 4096
  v_add_u32 v119, s38, v114
  s_add_u32 s38, s3, 2
  s_and_b32 s38, s38, 3
  s_lshl_b32 s38, s38, 11
  v_add_u32 v112, s38, v114
  s_sub_u32 s38, s3, 2
  s_and_b32 s38, s38, 3
  s_mul_i32 s38, s38, 35840
  s_add_u32 s38, s38, 9216
  v_add_u32 v120, s38, v114
  s_add_u32 s38, s3, 3
  s_and_b32 s38, s38, 3
  s_lshl_b32 s38, s38, 11
  v_add_u32 v113, s38, v114
  s_sub_u32 s38, s3, 3
  s_and_b32 s38, s38, 3
  s_mul_i32 s38, s38, 35840
  s_add_u32 s38, s38, 14336
  v_add_u32 v121, s38, v114
  v_add_u32 v122, s33, v114
  s_lshl_b32 s30, s28, 19
  s_lshl_b32 s38, s3, 17
  s_add_u32 s30, s30, s38
  s_add_u32 s30, s30, 8388608
  s_lshl_b32 s38, s28, 6
  s_lshl_b32 s39, s3, 4
  s_add_u32 s38, s38, s39
  v_add_u32 v128, s38, v126
  v_mul_u32_u24 v117, 0x500, v128
  v_lshl_add_u32 v117, v127, 3, v117
  s_mul_i32 s38, s29, 160
  v_add_u32 v117, s38, v117
  s_mov_b32 s12, s60
  s_mov_b32 s13, s61
  s_mov_b32 s14, 2621440
  s_mov_b32 s15, 0x20000
  s_mov_b32 s16, s62
  s_mov_b32 s17, s63
  s_mov_b32 s18, 2621440
  s_mov_b32 s19, 0x20000
  s_mul_i32 s38, s28, 81920
  s_lshl_b32 s39, s3, 10
  s_add_u32 s38, s38, s39
  s_mul_i32 s39, s29, 10
  v_lshrrev_b32 v129, 1, v127
  v_add_u32 v129, s39, v129
  v_and_b32 v130, 1, v127
  v_lshlrev_b32 v130, 3, v130
  v_lshl_add_u32 v130, v126, 4, v130
  v_lshrrev_b32 v131, 2, v129
  v_lshl_add_u32 v131, v131, 12, v130
  v_and_b32 v132, 3, v129
  v_lshl_add_u32 v131, v132, 8, v131
  buffer_load_dwordx2 v[156:157], v131, s[24:27], s38 offen
  v_add_u32 v129, 2, v129
  s_waitcnt vmcnt(60)
  buffer_load_dwordx2 v[80:81], v117, s[12:15], 0 offen offset:0
  v_lshrrev_b32 v131, 2, v129
  v_lshl_add_u32 v131, v131, 12, v130
  v_and_b32 v132, 3, v129
  v_lshl_add_u32 v131, v132, 8, v131
  buffer_load_dwordx2 v[158:159], v131, s[24:27], s38 offen
  v_add_u32 v129, 2, v129
  s_waitcnt vmcnt(60)
  buffer_load_dwordx2 v[82:83], v117, s[12:15], 0 offen offset:32
  v_lshrrev_b32 v131, 2, v129
  v_lshl_add_u32 v131, v131, 12, v130
  v_and_b32 v132, 3, v129
  v_lshl_add_u32 v131, v132, 8, v131
  buffer_load_dwordx2 v[160:161], v131, s[24:27], s38 offen
  v_add_u32 v129, 2, v129
  s_waitcnt vmcnt(60)
  buffer_load_dwordx2 v[84:85], v117, s[12:15], 0 offen offset:64
  v_lshrrev_b32 v131, 2, v129
  v_lshl_add_u32 v131, v131, 12, v130
  v_and_b32 v132, 3, v129
  v_lshl_add_u32 v131, v132, 8, v131
  buffer_load_dwordx2 v[162:163], v131, s[24:27], s38 offen
  v_add_u32 v129, 2, v129
  s_waitcnt vmcnt(60)
  buffer_load_dwordx2 v[86:87], v117, s[12:15], 0 offen offset:96
  v_lshrrev_b32 v131, 2, v129
  v_lshl_add_u32 v131, v131, 12, v130
  v_and_b32 v132, 3, v129
  v_lshl_add_u32 v131, v132, 8, v131
  buffer_load_dwordx2 v[164:165], v131, s[24:27], s38 offen
  v_add_u32 v129, 2, v129
  s_waitcnt vmcnt(60)
  buffer_load_dwordx2 v[88:89], v117, s[12:15], 0 offen offset:128
  v_mov_b32 v123, 1073741824
  v_bfrev_b32 v124, 1
  v_sub_u32 v128, 0xffff, v128
  s_mov_b32 s34, 0xffff0000
  s_and_b32 s38, s52, 0xffff
  v_cmp_eq_u32 vcc, s38, v128
  v_mov_b32 v129, s52
  v_mov_b32 v130, 0
  v_cndmask_b32 v124, v124, v129, vcc
  v_cndmask_b32 v123, v123, v130, vcc
  s_and_b32 s38, s53, 0xffff
  v_cmp_eq_u32 vcc, s38, v128
  v_mov_b32 v129, s53
  v_mov_b32 v130, 2560
  v_cndmask_b32 v124, v124, v129, vcc
  v_cndmask_b32 v123, v123, v130, vcc
  s_and_b32 s38, s54, 0xffff
  v_cmp_eq_u32 vcc, s38, v128
  v_mov_b32 v129, s54
  v_mov_b32 v130, 5120
  v_cndmask_b32 v124, v124, v129, vcc
  v_cndmask_b32 v123, v123, v130, vcc
  s_and_b32 s38, s55, 0xffff
  v_cmp_eq_u32 vcc, s38, v128
  v_mov_b32 v129, s55
  v_mov_b32 v130, 7680
  v_cndmask_b32 v124, v124, v129, vcc
  v_cndmask_b32 v123, v123, v130, vcc
  s_and_b32 s38, s56, 0xffff
  v_cmp_eq_u32 vcc, s38, v128
  v_mov_b32 v129, s56
  v_mov_b32 v130, 10240
  v_cndmask_b32 v124, v124, v129, vcc
  v_cndmask_b32 v123, v123, v130, vcc
  s_and_b32 s38, s57, 0xffff
  v_cmp_eq_u32 vcc, s38, v128
  v_mov_b32 v129, s57
  v_mov_b32 v130, 12800
  v_cndmask_b32 v124, v124, v129, vcc
  v_cndmask_b32 v123, v123, v130, vcc
  s_and_b32 s38, s58, 0xffff
  v_cmp_eq_u32 vcc, s38, v128
  v_mov_b32 v129, s58
  v_mov_b32 v130, 15360
  v_cndmask_b32 v124, v124, v129, vcc
  v_cndmask_b32 v123, v123, v130, vcc
  s_and_b32 s38, s59, 0xffff
  v_cmp_eq_u32 vcc, s38, v128
  v_mov_b32 v129, s59
  v_mov_b32 v130, 17920
  v_cndmask_b32 v124, v124, v129, vcc
  v_cndmask_b32 v123, v123, v130, vcc
  v_lshl_add_u32 v123, v127, 4, v123
  s_mul_i32 s32, s29, 320
  s_add_u32 s32, s32, 2686976
  v_ashrrev_i32 v129, 31, v124
  v_not_b32 v129, v129
  v_or_b32 v129, 0x80000000, v129
  v_xor_b32 v124, v124, v129
  v_and_b32 v124, s34, v124
  v_mul_f32 v124, 0xbfb8aa3b, v124
  v_exp_f32 v124, v124
  s_nop 0
  v_add_f32 v124, 1.0, v124
  v_rcp_f32 v124, v124
  s_nop 0
  v_cvt_pk_bf16_f32 v124, v124, v124
  v_lshlrev_b32 v124, 16, v124
  s_lshr_b32 s38, s28, 2
  s_lshl_b32 s38, s38, 8
  s_add_u32 s38, s38, 2818304
  s_lshl_b32 s39, s29, 8
  s_add_u32 s39, s39, 2820352
  v_mov_b32 v133, s38
  v_writelane_b32 v133, s39, 1
  v_mov_b32 v134, 32
  v_writelane_b32 v134, 30, 1
  buffer_load_dword v132, v133, s[24:27], 0 offen sc1
  s_add_u32 m0, s33, 18432
  s_waitcnt vmcnt(60)
  buffer_load_dwordx4 v116, s[24:27], s9 offen offset:2048 sc1 lds
  s_add_u32 m0, s33, 18432
  s_nop 0
  buffer_load_dwordx4 v116, s[24:27], s9 offen offset:3072 sc1 lds
  s_add_u32 m0, s33, 22528
  s_waitcnt vmcnt(60)
  buffer_load_dwordx4 v114, s[24:27], s10 offen offset:0 sc1 lds
  s_add_u32 m0, s33, 22528
  s_nop 0
  buffer_load_dwordx4 v114, s[24:27], s10 offen offset:1024 sc1 lds
  s_add_u32 m0, s33, 22528
  s_waitcnt vmcnt(60)
  buffer_load_dwordx4 v114, s[24:27], s10 offen offset:2048 sc1 lds
  s_add_u32 m0, s33, 22528
  s_nop 0
  buffer_load_dwordx4 v114, s[24:27], s10 offen offset:3072 sc1 lds
  s_add_u32 m0, s33, 26624
  s_waitcnt vmcnt(60)
  buffer_load_dwordx4 v115, s[24:27], s10 offen offset:0 sc1 lds
  s_add_u32 m0, s33, 26624
  s_nop 0
  buffer_load_dwordx4 v115, s[24:27], s10 offen offset:1024 sc1 lds
  s_add_u32 m0, s33, 26624
  s_waitcnt vmcnt(60)
  buffer_load_dwordx4 v115, s[24:27], s10 offen offset:2048 sc1 lds
  s_add_u32 m0, s33, 26624
  s_nop 0
  buffer_load_dwordx4 v115, s[24:27], s10 offen offset:3072 sc1 lds
  s_add_u32 m0, s33, 30720
  s_waitcnt vmcnt(60)
  buffer_load_dwordx4 v116, s[24:27], s10 offen offset:0 sc1 lds
  s_add_u32 m0, s33, 30720
  s_nop 0
  buffer_load_dwordx4 v116, s[24:27], s10 offen offset:1024 sc1 lds
  s_add_u32 m0, s33, 30720
  s_waitcnt vmcnt(60)
  buffer_load_dwordx4 v116, s[24:27], s10 offen offset:2048 sc1 lds
  s_add_u32 m0, s33, 30720
  s_nop 0
  buffer_load_dwordx4 v116, s[24:27], s10 offen offset:3072 sc1 lds
  s_add_u32 m0, s33, 34816
  s_waitcnt vmcnt(60)
  buffer_load_dwordx4 v114, s[24:27], s11 offen offset:0 sc1 lds
  s_waitcnt vmcnt(15)
  v_cmp_lt_u32 vcc, v132, v134
  s_nop 0
  s_cbranch_vccz tail_ready
  s_mov_b32 s39, 32768
tail_spin:
  s_sleep 2
  buffer_load_dword v132, v133, s[24:27], 0 offen sc1
  s_waitcnt vmcnt(0)
  v_cmp_lt_u32 vcc, v132, v134
  s_nop 0
  s_cbranch_vccz tail_ready
  s_sub_u32 s39, s39, 1
  s_cmp_lg_u32 s39, 0
  s_cbranch_scc1 tail_spin
tail_ready:
  buffer_load_dwordx4 a[120:123], v110, s[24:27], s30 offen offset:0 sc1
  buffer_load_dwordx4 a[124:127], v110, s[24:27], s30 offen offset:1024 sc1
  buffer_load_dwordx4 a[128:131], v111, s[24:27], s30 offen offset:0 sc1
  buffer_load_dwordx4 a[132:135], v111, s[24:27], s30 offen offset:1024 sc1
  buffer_load_dwordx4 a[136:139], v112, s[24:27], s30 offen offset:0 sc1
  buffer_load_dwordx4 a[140:143], v112, s[24:27], s30 offen offset:1024 sc1
  buffer_load_dwordx4 a[144:147], v113, s[24:27], s30 offen offset:0 sc1
  buffer_load_dwordx4 a[148:151], v113, s[24:27], s30 offen offset:1024 sc1
  s_add_u32 s30, s30, 8192
  buffer_load_dwordx4 a[152:155], v110, s[24:27], s30 offen offset:0 sc1
  buffer_load_dwordx4 a[156:159], v110, s[24:27], s30 offen offset:1024 sc1
  buffer_load_dwordx4 a[160:163], v111, s[24:27], s30 offen offset:0 sc1
  buffer_load_dwordx4 a[164:167], v111, s[24:27], s30 offen offset:1024 sc1
  buffer_load_dwordx4 a[168:171], v112, s[24:27], s30 offen offset:0 sc1
  buffer_load_dwordx4 a[172:175], v112, s[24:27], s30 offen offset:1024 sc1
  buffer_load_dwordx4 a[176:179], v113, s[24:27], s30 offen offset:0 sc1
  buffer_load_dwordx4 a[180:183], v113, s[24:27], s30 offen offset:1024 sc1
  s_add_u32 s30, s30, 8192
  buffer_load_dwordx4 a[184:187], v110, s[24:27], s30 offen offset:0 sc1
  buffer_load_dwordx4 a[188:191], v110, s[24:27], s30 offen offset:1024 sc1
  buffer_load_dwordx4 a[192:195], v111, s[24:27], s30 offen offset:0 sc1
  buffer_load_dwordx4 a[196:199], v111, s[24:27], s30 offen offset:1024 sc1
  buffer_load_dwordx4 a[200:203], v112, s[24:27], s30 offen offset:0 sc1
  buffer_load_dwordx4 a[204:207], v112, s[24:27], s30 offen offset:1024 sc1
  buffer_load_dwordx4 a[208:211], v113, s[24:27], s30 offen offset:0 sc1
  buffer_load_dwordx4 a[212:215], v113, s[24:27], s30 offen offset:1024 sc1
  s_add_u32 s30, s30, 8192
  buffer_load_dwordx4 a[216:219], v110, s[24:27], s30 offen offset:0 sc1
  buffer_load_dwordx4 a[220:223], v110, s[24:27], s30 offen offset:1024 sc1
  buffer_load_dwordx4 a[224:227], v111, s[24:27], s30 offen offset:0 sc1
  buffer_load_dwordx4 a[228:231], v111, s[24:27], s30 offen offset:1024 sc1
  buffer_load_dwordx4 a[232:235], v112, s[24:27], s30 offen offset:0 sc1
  buffer_load_dwordx4 a[236:239], v112, s[24:27], s30 offen offset:1024 sc1
  buffer_load_dwordx4 a[240:243], v113, s[24:27], s30 offen offset:0 sc1
  buffer_load_dwordx4 a[244:247], v113, s[24:27], s30 offen offset:1024 sc1
  s_add_u32 s30, s30, 8192
  buffer_load_dwordx4 a[248:251], v110, s[24:27], s30 offen offset:0 sc1
  buffer_load_dwordx4 a[252:255], v110, s[24:27], s30 offen offset:1024 sc1
  s_waitcnt vmcnt(26)
  v_mfma_f32_16x16x32_bf16 v[0:3], v[176:179], a[120:123], 0
  v_lshlrev_b32 v90, 16, v156
  v_and_b32 v91, s34, v156
  v_mfma_f32_16x16x32_bf16 v[0:3], v[196:199], a[124:127], v[0:3]
  v_lshlrev_b32 v92, 16, v157
  v_and_b32 v93, s34, v157
  v_mfma_f32_16x16x32_bf16 v[4:7], v[196:199], a[132:135], 0
  v_lshlrev_b32 v94, 16, v158
  v_and_b32 v95, s34, v158
  v_mfma_f32_16x16x32_bf16 v[4:7], v[176:179], a[128:131], v[4:7]
  v_lshlrev_b32 v96, 16, v159
  v_and_b32 v97, s34, v159
  v_mfma_f32_16x16x32_bf16 v[8:11], v[176:179], a[136:139], 0
  v_lshlrev_b32 v98, 16, v160
  v_and_b32 v99, s34, v160
  v_mfma_f32_16x16x32_bf16 v[8:11], v[196:199], a[140:143], v[8:11]
  v_lshlrev_b32 v100, 16, v161
  v_and_b32 v101, s34, v161
  v_mfma_f32_16x16x32_bf16 v[12:15], v[196:199], a[148:151], 0
  v_lshlrev_b32 v102, 16, v162
  v_and_b32 v103, s34, v162
  v_mfma_f32_16x16x32_bf16 v[12:15], v[176:179], a[144:147], v[12:15]
  v_lshlrev_b32 v104, 16, v163
  v_and_b32 v105, s34, v163
  v_mfma_f32_16x16x32_bf16 v[16:19], v[180:183], a[120:123], 0
  v_lshlrev_b32 v106, 16, v164
  v_and_b32 v107, s34, v164
  v_mfma_f32_16x16x32_bf16 v[16:19], v[200:203], a[124:127], v[16:19]
  v_lshlrev_b32 v108, 16, v165
  v_and_b32 v109, s34, v165
  v_mfma_f32_16x16x32_bf16 v[20:23], v[200:203], a[132:135], 0
  v_mfma_f32_16x16x32_bf16 v[20:23], v[180:183], a[128:131], v[20:23]
  v_mfma_f32_16x16x32_bf16 v[24:27], v[180:183], a[136:139], 0
  v_mfma_f32_16x16x32_bf16 v[24:27], v[200:203], a[140:143], v[24:27]
  v_mfma_f32_16x16x32_bf16 v[28:31], v[200:203], a[148:151], 0
  v_mfma_f32_16x16x32_bf16 v[28:31], v[180:183], a[144:147], v[28:31]
  v_mfma_f32_16x16x32_bf16 v[32:35], v[184:187], a[120:123], 0
  buffer_load_dwordx4 v[176:179], v111, s[24:27], s30 offen offset:0 sc1
  v_mfma_f32_16x16x32_bf16 v[32:35], v[204:207], a[124:127], v[32:35]
  buffer_load_dwordx4 v[196:199], v111, s[24:27], s30 offen offset:1024 sc1
  v_mfma_f32_16x16x32_bf16 v[36:39], v[204:207], a[132:135], 0
  v_mfma_f32_16x16x32_bf16 v[36:39], v[184:187], a[128:131], v[36:39]
  v_mfma_f32_16x16x32_bf16 v[40:43], v[184:187], a[136:139], 0
  v_mfma_f32_16x16x32_bf16 v[40:43], v[204:207], a[140:143], v[40:43]
  v_mfma_f32_16x16x32_bf16 v[44:47], v[204:207], a[148:151], 0
  v_mfma_f32_16x16x32_bf16 v[44:47], v[184:187], a[144:147], v[44:47]
  v_mfma_f32_16x16x32_bf16 v[48:51], v[188:191], a[120:123], 0
  buffer_load_dwordx4 v[180:183], v112, s[24:27], s30 offen offset:0 sc1
  v_mfma_f32_16x16x32_bf16 v[48:51], v[208:211], a[124:127], v[48:51]
  buffer_load_dwordx4 v[200:203], v112, s[24:27], s30 offen offset:1024 sc1
  v_mfma_f32_16x16x32_bf16 v[52:55], v[208:211], a[132:135], 0
  v_mfma_f32_16x16x32_bf16 v[52:55], v[188:191], a[128:131], v[52:55]
  v_mfma_f32_16x16x32_bf16 v[56:59], v[188:191], a[136:139], 0
  v_mfma_f32_16x16x32_bf16 v[56:59], v[208:211], a[140:143], v[56:59]
  v_mfma_f32_16x16x32_bf16 v[60:63], v[208:211], a[148:151], 0
  v_mfma_f32_16x16x32_bf16 v[60:63], v[188:191], a[144:147], v[60:63]
  v_mfma_f32_16x16x32_bf16 v[64:67], v[192:195], a[120:123], 0
  buffer_load_dwordx4 v[184:187], v113, s[24:27], s30 offen offset:0 sc1
  v_mfma_f32_16x16x32_bf16 v[64:67], v[212:215], a[124:127], v[64:67]
  buffer_load_dwordx4 v[204:207], v113, s[24:27], s30 offen offset:1024 sc1
  s_add_u32 s30, s30, 8192
  v_mfma_f32_16x16x32_bf16 v[68:71], v[212:215], a[132:135], 0
  v_mfma_f32_16x16x32_bf16 v[68:71], v[192:195], a[128:131], v[68:71]
  v_mfma_f32_16x16x32_bf16 v[72:75], v[192:195], a[136:139], 0
  v_mfma_f32_16x16x32_bf16 v[72:75], v[212:215], a[140:143], v[72:75]
  v_mfma_f32_16x16x32_bf16 v[76:79], v[212:215], a[148:151], 0
  v_mfma_f32_16x16x32_bf16 v[76:79], v[192:195], a[144:147], v[76:79]
  s_waitcnt vmcnt(24)
  v_mfma_f32_16x16x32_bf16 v[0:3], v[216:219], a[152:155], v[0:3]
  buffer_load_dwordx4 v[188:191], v110, s[24:27], s30 offen offset:0 sc1
  v_mfma_f32_16x16x32_bf16 v[0:3], v[236:239], a[156:159], v[0:3]
  buffer_load_dwordx4 v[208:211], v110, s[24:27], s30 offen offset:1024 sc1
  v_mfma_f32_16x16x32_bf16 v[4:7], v[236:239], a[164:167], v[4:7]
  buffer_load_dwordx4 v[192:195], v111, s[24:27], s30 offen offset:0 sc1
  v_mfma_f32_16x16x32_bf16 v[4:7], v[216:219], a[160:163], v[4:7]
  buffer_load_dwordx4 v[212:215], v111, s[24:27], s30 offen offset:1024 sc1
  v_mfma_f32_16x16x32_bf16 v[8:11], v[216:219], a[168:171], v[8:11]
  buffer_load_dwordx4 a[120:123], v112, s[24:27], s30 offen offset:0 sc1
  v_mfma_f32_16x16x32_bf16 v[8:11], v[236:239], a[172:175], v[8:11]
  buffer_load_dwordx4 a[124:127], v112, s[24:27], s30 offen offset:1024 sc1
  v_mfma_f32_16x16x32_bf16 v[12:15], v[236:239], a[180:183], v[12:15]
  buffer_load_dwordx4 v[156:159], v123, s[24:27], s32 offen offset:0 sc1
  v_mfma_f32_16x16x32_bf16 v[12:15], v[216:219], a[176:179], v[12:15]
  buffer_load_dwordx4 v[160:163], v123, s[24:27], s32 offen offset:64 sc1
  v_mfma_f32_16x16x32_bf16 v[16:19], v[220:223], a[152:155], v[16:19]
  buffer_load_dwordx4 a[128:131], v113, s[24:27], s30 offen offset:0 sc1
  v_mfma_f32_16x16x32_bf16 v[16:19], v[240:243], a[156:159], v[16:19]
  buffer_load_dwordx4 a[132:135], v113, s[24:27], s30 offen offset:1024 sc1
  s_add_u32 s30, s30, 8192
  v_mfma_f32_16x16x32_bf16 v[20:23], v[240:243], a[164:167], v[20:23]
  buffer_load_dwordx4 a[136:139], v110, s[24:27], s30 offen offset:0 sc1
  v_mfma_f32_16x16x32_bf16 v[20:23], v[220:223], a[160:163], v[20:23]
  buffer_load_dwordx4 a[140:143], v110, s[24:27], s30 offen offset:1024 sc1
  v_mfma_f32_16x16x32_bf16 v[24:27], v[220:223], a[168:171], v[24:27]
  buffer_load_dwordx4 a[144:147], v111, s[24:27], s30 offen offset:0 sc1
  v_mfma_f32_16x16x32_bf16 v[24:27], v[240:243], a[172:175], v[24:27]
  buffer_load_dwordx4 a[148:151], v111, s[24:27], s30 offen offset:1024 sc1
  v_mfma_f32_16x16x32_bf16 v[28:31], v[240:243], a[180:183], v[28:31]
  buffer_load_dwordx4 v[164:167], v123, s[24:27], s32 offen offset:128 sc1
  v_mfma_f32_16x16x32_bf16 v[28:31], v[220:223], a[176:179], v[28:31]
  buffer_load_dwordx4 v[168:171], v123, s[24:27], s32 offen offset:192 sc1
  v_mfma_f32_16x16x32_bf16 v[32:35], v[224:227], a[152:155], v[32:35]
  buffer_load_dwordx4 v[216:219], v112, s[24:27], s30 offen offset:0 sc1
  v_mfma_f32_16x16x32_bf16 v[32:35], v[244:247], a[156:159], v[32:35]
  buffer_load_dwordx4 v[236:239], v112, s[24:27], s30 offen offset:1024 sc1
  v_mfma_f32_16x16x32_bf16 v[36:39], v[244:247], a[164:167], v[36:39]
  buffer_load_dwordx4 v[172:175], v123, s[24:27], s32 offen offset:256 sc1
  s_add_u32 s32, s32, 20480
  v_mfma_f32_16x16x32_bf16 v[36:39], v[224:227], a[160:163], v[36:39]
  buffer_load_dwordx4 v[136:139], v123, s[24:27], s32 offen offset:0 sc1
  v_mfma_f32_16x16x32_bf16 v[40:43], v[224:227], a[168:171], v[40:43]
  buffer_load_dwordx4 v[140:143], v123, s[24:27], s32 offen offset:64 sc1
  v_mfma_f32_16x16x32_bf16 v[40:43], v[244:247], a[172:175], v[40:43]
  buffer_load_dwordx4 v[144:147], v123, s[24:27], s32 offen offset:128 sc1
  v_mfma_f32_16x16x32_bf16 v[44:47], v[244:247], a[180:183], v[44:47]
  buffer_load_dwordx4 v[148:151], v123, s[24:27], s32 offen offset:192 sc1
  v_mfma_f32_16x16x32_bf16 v[44:47], v[224:227], a[176:179], v[44:47]
  buffer_load_dwordx4 v[152:155], v123, s[24:27], s32 offen offset:256 sc1
  s_add_u32 s32, s32, 20480
  v_mfma_f32_16x16x32_bf16 v[48:51], v[228:231], a[152:155], v[48:51]
  buffer_load_dwordx4 v[220:223], v113, s[24:27], s30 offen offset:0 sc1
  v_mfma_f32_16x16x32_bf16 v[48:51], v[248:251], a[156:159], v[48:51]
  buffer_load_dwordx4 v[240:243], v113, s[24:27], s30 offen offset:1024 sc1
  s_add_u32 s30, s30, 8192
  v_mfma_f32_16x16x32_bf16 v[52:55], v[248:251], a[164:167], v[52:55]
  v_mfma_f32_16x16x32_bf16 v[52:55], v[228:231], a[160:163], v[52:55]
  v_mfma_f32_16x16x32_bf16 v[56:59], v[228:231], a[168:171], v[56:59]
  v_mfma_f32_16x16x32_bf16 v[56:59], v[248:251], a[172:175], v[56:59]
  v_mfma_f32_16x16x32_bf16 v[60:63], v[248:251], a[180:183], v[60:63]
  v_mfma_f32_16x16x32_bf16 v[60:63], v[228:231], a[176:179], v[60:63]
  v_mfma_f32_16x16x32_bf16 v[64:67], v[232:235], a[152:155], v[64:67]
  buffer_load_dwordx4 v[224:227], v110, s[24:27], s30 offen offset:0 sc1
  v_mfma_f32_16x16x32_bf16 v[64:67], v[252:255], a[156:159], v[64:67]
  buffer_load_dwordx4 v[244:247], v110, s[24:27], s30 offen offset:1024 sc1
  v_mfma_f32_16x16x32_bf16 v[68:71], v[252:255], a[164:167], v[68:71]
  v_mfma_f32_16x16x32_bf16 v[68:71], v[232:235], a[160:163], v[68:71]
  v_mfma_f32_16x16x32_bf16 v[72:75], v[232:235], a[168:171], v[72:75]
  v_mfma_f32_16x16x32_bf16 v[72:75], v[252:255], a[172:175], v[72:75]
  v_mfma_f32_16x16x32_bf16 v[76:79], v[252:255], a[180:183], v[76:79]
  v_mfma_f32_16x16x32_bf16 v[76:79], v[232:235], a[176:179], v[76:79]
  s_waitcnt vmcnt(44)
  v_mfma_f32_16x16x32_bf16 v[0:3], a[0:3], a[184:187], v[0:3]
  buffer_load_dwordx4 v[228:231], v111, s[24:27], s30 offen offset:0 sc1
  v_mfma_f32_16x16x32_bf16 v[0:3], a[20:23], a[188:191], v[0:3]
  buffer_load_dwordx4 v[248:251], v111, s[24:27], s30 offen offset:1024 sc1
  v_mfma_f32_16x16x32_bf16 v[4:7], a[20:23], a[196:199], v[4:7]
  buffer_load_dwordx4 v[232:235], v112, s[24:27], s30 offen offset:0 sc1
  v_mfma_f32_16x16x32_bf16 v[4:7], a[0:3], a[192:195], v[4:7]
  buffer_load_dwordx4 v[252:255], v112, s[24:27], s30 offen offset:1024 sc1
  v_mfma_f32_16x16x32_bf16 v[8:11], a[0:3], a[200:203], v[8:11]
  buffer_load_dwordx4 a[152:155], v113, s[24:27], s30 offen offset:0 sc1
  v_mfma_f32_16x16x32_bf16 v[8:11], a[20:23], a[204:207], v[8:11]
  buffer_load_dwordx4 a[156:159], v113, s[24:27], s30 offen offset:1024 sc1
  v_mfma_f32_16x16x32_bf16 v[12:15], a[20:23], a[212:215], v[12:15]
  v_mfma_f32_16x16x32_bf16 v[12:15], a[0:3], a[208:211], v[12:15]
  v_mfma_f32_16x16x32_bf16 v[16:19], a[4:7], a[184:187], v[16:19]
  s_add_u32 s30, s30, 8192
  s_add_u32 s4, s31, 98304
  buffer_load_dwordx4 a[160:163], v114, s[24:27], s11 offen offset:1024 sc1
  v_mfma_f32_16x16x32_bf16 v[16:19], a[24:27], a[188:191], v[16:19]
  buffer_load_dwordx4 a[164:167], v114, s[24:27], s11 offen offset:2048 sc1
  v_mfma_f32_16x16x32_bf16 v[20:23], a[24:27], a[196:199], v[20:23]
  buffer_load_dwordx4 a[168:171], v114, s[24:27], s11 offen offset:3072 sc1
  v_mfma_f32_16x16x32_bf16 v[20:23], a[4:7], a[192:195], v[20:23]
  buffer_load_dwordx4 a[172:175], v115, s[24:27], s11 offen offset:0 sc1
  v_mfma_f32_16x16x32_bf16 v[24:27], a[4:7], a[200:203], v[24:27]
  buffer_load_dwordx4 a[176:179], v115, s[24:27], s11 offen offset:1024 sc1
  v_mfma_f32_16x16x32_bf16 v[24:27], a[24:27], a[204:207], v[24:27]
  buffer_load_dwordx4 a[180:183], v110, s[24:27], s30 offen offset:0 sc1
  v_mfma_f32_16x16x32_bf16 v[28:31], a[24:27], a[212:215], v[28:31]
  v_mfma_f32_16x16x32_bf16 v[28:31], a[4:7], a[208:211], v[28:31]
  v_mfma_f32_16x16x32_bf16 v[32:35], a[8:11], a[184:187], v[32:35]
  buffer_load_dwordx4 a[0:3], v110, s[24:27], s30 offen offset:1024 sc1
  v_mfma_f32_16x16x32_bf16 v[32:35], a[28:31], a[188:191], v[32:35]
  buffer_load_dwordx4 a[20:23], v111, s[24:27], s30 offen offset:0 sc1
  v_mfma_f32_16x16x32_bf16 v[36:39], a[28:31], a[196:199], v[36:39]
  v_mfma_f32_16x16x32_bf16 v[36:39], a[8:11], a[192:195], v[36:39]
  v_mfma_f32_16x16x32_bf16 v[40:43], a[8:11], a[200:203], v[40:43]
  v_mfma_f32_16x16x32_bf16 v[40:43], a[28:31], a[204:207], v[40:43]
  v_mfma_f32_16x16x32_bf16 v[44:47], a[28:31], a[212:215], v[44:47]
  v_mfma_f32_16x16x32_bf16 v[44:47], a[8:11], a[208:211], v[44:47]
  v_mfma_f32_16x16x32_bf16 v[48:51], a[12:15], a[184:187], v[48:51]
  buffer_load_dwordx4 a[4:7], v111, s[24:27], s30 offen offset:1024 sc1
  s_waitcnt vmcnt(19)
  v_mfma_f32_16x16x32_bf16 v[48:51], a[32:35], a[188:191], v[48:51]
  buffer_load_dwordx4 a[24:27], v112, s[24:27], s30 offen offset:0 sc1
  v_mfma_f32_16x16x32_bf16 v[52:55], a[32:35], a[196:199], v[52:55]
  v_add_f32 v156, v156, v136
  v_add_f32 v157, v157, v137
  v_mfma_f32_16x16x32_bf16 v[52:55], a[12:15], a[192:195], v[52:55]
  v_add_f32 v158, v158, v138
  v_add_f32 v159, v159, v139
  v_mfma_f32_16x16x32_bf16 v[56:59], a[12:15], a[200:203], v[56:59]
  v_add_f32 v160, v160, v140
  v_add_f32 v161, v161, v141
  v_mfma_f32_16x16x32_bf16 v[56:59], a[32:35], a[204:207], v[56:59]
  v_add_f32 v162, v162, v142
  v_add_f32 v163, v163, v143
  v_mfma_f32_16x16x32_bf16 v[60:63], a[32:35], a[212:215], v[60:63]
  v_add_f32 v164, v164, v144
  v_add_f32 v165, v165, v145
  v_mfma_f32_16x16x32_bf16 v[60:63], a[12:15], a[208:211], v[60:63]
  v_add_f32 v166, v166, v146
  v_add_f32 v167, v167, v147
  v_mfma_f32_16x16x32_bf16 v[64:67], a[16:19], a[184:187], v[64:67]
  buffer_load_dwordx4 a[8:11], v112, s[24:27], s30 offen offset:1024 sc1
  v_mfma_f32_16x16x32_bf16 v[64:67], a[36:39], a[188:191], v[64:67]
  buffer_load_dwordx4 a[28:31], v113, s[24:27], s30 offen offset:0 sc1
  v_mfma_f32_16x16x32_bf16 v[68:71], a[36:39], a[196:199], v[68:71]
  v_add_f32 v168, v168, v148
  v_add_f32 v169, v169, v149
  v_mfma_f32_16x16x32_bf16 v[68:71], a[16:19], a[192:195], v[68:71]
  v_add_f32 v170, v170, v150
  v_add_f32 v171, v171, v151
  v_mfma_f32_16x16x32_bf16 v[72:75], a[16:19], a[200:203], v[72:75]
  v_add_f32 v172, v172, v152
  v_add_f32 v173, v173, v153
  v_mfma_f32_16x16x32_bf16 v[72:75], a[36:39], a[204:207], v[72:75]
  v_add_f32 v174, v174, v154
  v_add_f32 v175, v175, v155
  v_mfma_f32_16x16x32_bf16 v[76:79], a[36:39], a[212:215], v[76:79]
  buffer_load_dwordx4 v[136:139], v123, s[24:27], s32 offen offset:0 sc1
  v_mfma_f32_16x16x32_bf16 v[76:79], a[16:19], a[208:211], v[76:79]
  buffer_load_dwordx4 v[140:143], v123, s[24:27], s32 offen offset:64 sc1
  v_mfma_f32_16x16x32_bf16 v[0:3], a[40:43], a[216:219], v[0:3]
  buffer_load_dwordx4 a[12:15], v113, s[24:27], s30 offen offset:1024 sc1
  s_add_u32 s30, s30, 8192
  v_mfma_f32_16x16x32_bf16 v[0:3], a[60:63], a[220:223], v[0:3]
  buffer_load_dwordx4 a[32:35], v115, s[24:27], s11 offen offset:2048 sc1
  v_mfma_f32_16x16x32_bf16 v[4:7], a[60:63], a[228:231], v[4:7]
  buffer_load_dwordx4 a[16:19], v116, s[24:27], s11 offen offset:3072 sc1
  v_mfma_f32_16x16x32_bf16 v[4:7], a[40:43], a[224:227], v[4:7]
  buffer_load_dwordx4 a[36:39], v115, s[24:27], s11 offen offset:3072 sc1
  v_mfma_f32_16x16x32_bf16 v[8:11], a[40:43], a[232:235], v[8:11]
  buffer_load_dwordx4 a[184:187], v114, s[24:27], s4 offen offset:0 sc1
  v_mfma_f32_16x16x32_bf16 v[8:11], a[60:63], a[236:239], v[8:11]
  buffer_load_dwordx4 a[188:191], v116, s[24:27], s11 offen offset:0 sc1
  v_mfma_f32_16x16x32_bf16 v[12:15], a[60:63], a[244:247], v[12:15]
  buffer_load_dwordx4 v[144:147], v123, s[24:27], s32 offen offset:128 sc1
  v_mfma_f32_16x16x32_bf16 v[12:15], a[40:43], a[240:243], v[12:15]
  buffer_load_dwordx4 v[148:151], v123, s[24:27], s32 offen offset:192 sc1
  v_mfma_f32_16x16x32_bf16 v[16:19], a[44:47], a[216:219], v[16:19]
  buffer_load_dwordx4 a[192:195], v114, s[24:27], s4 offen offset:1024 sc1
  v_mfma_f32_16x16x32_bf16 v[16:19], a[64:67], a[220:223], v[16:19]
  buffer_load_dwordx4 a[196:199], v116, s[24:27], s11 offen offset:1024 sc1
  v_mfma_f32_16x16x32_bf16 v[20:23], a[64:67], a[228:231], v[20:23]
  buffer_load_dwordx4 a[200:203], v114, s[24:27], s4 offen offset:2048 sc1
  v_mfma_f32_16x16x32_bf16 v[20:23], a[44:47], a[224:227], v[20:23]
  buffer_load_dwordx4 a[204:207], v116, s[24:27], s11 offen offset:2048 sc1
  v_mfma_f32_16x16x32_bf16 v[24:27], a[44:47], a[232:235], v[24:27]
  buffer_load_dwordx4 a[208:211], v114, s[24:27], s4 offen offset:3072 sc1
  v_mfma_f32_16x16x32_bf16 v[24:27], a[64:67], a[236:239], v[24:27]
  buffer_load_dwordx4 a[212:215], v110, s[24:27], s30 offen offset:0 sc1
  v_mfma_f32_16x16x32_bf16 v[28:31], a[64:67], a[244:247], v[28:31]
  buffer_load_dwordx4 v[152:155], v123, s[24:27], s32 offen offset:256 sc1
  s_add_u32 s32, s32, 20480
  v_mfma_f32_16x16x32_bf16 v[28:31], a[44:47], a[240:243], v[28:31]
  v_mfma_f32_16x16x32_bf16 v[32:35], a[48:51], a[216:219], v[32:35]
  buffer_load_dwordx4 a[40:43], v110, s[24:27], s30 offen offset:1024 sc1
  v_mfma_f32_16x16x32_bf16 v[32:35], a[68:71], a[220:223], v[32:35]
  buffer_load_dwordx4 a[60:63], v111, s[24:27], s30 offen offset:0 sc1
  v_mfma_f32_16x16x32_bf16 v[36:39], a[68:71], a[228:231], v[36:39]
  v_mfma_f32_16x16x32_bf16 v[36:39], a[48:51], a[224:227], v[36:39]
  v_mfma_f32_16x16x32_bf16 v[40:43], a[48:51], a[232:235], v[40:43]
  v_mfma_f32_16x16x32_bf16 v[40:43], a[68:71], a[236:239], v[40:43]
  v_mfma_f32_16x16x32_bf16 v[44:47], a[68:71], a[244:247], v[44:47]
  v_mfma_f32_16x16x32_bf16 v[44:47], a[48:51], a[240:243], v[44:47]
  v_mfma_f32_16x16x32_bf16 v[48:51], a[52:55], a[216:219], v[48:51]
  buffer_load_dwordx4 a[44:47], v111, s[24:27], s30 offen offset:1024 sc1
  v_mfma_f32_16x16x32_bf16 v[48:51], a[72:75], a[220:223], v[48:51]
  buffer_load_dwordx4 a[64:67], v112, s[24:27], s30 offen offset:0 sc1
  v_mfma_f32_16x16x32_bf16 v[52:55], a[72:75], a[228:231], v[52:55]
  v_mfma_f32_16x16x32_bf16 v[52:55], a[52:55], a[224:227], v[52:55]
  v_mfma_f32_16x16x32_bf16 v[56:59], a[52:55], a[232:235], v[56:59]
  v_mfma_f32_16x16x32_bf16 v[56:59], a[72:75], a[236:239], v[56:59]
  v_mfma_f32_16x16x32_bf16 v[60:63], a[72:75], a[244:247], v[60:63]
  v_mfma_f32_16x16x32_bf16 v[60:63], a[52:55], a[240:243], v[60:63]
  v_mfma_f32_16x16x32_bf16 v[64:67], a[56:59], a[216:219], v[64:67]
  buffer_load_dwordx4 a[48:51], v112, s[24:27], s30 offen offset:1024 sc1
  v_mfma_f32_16x16x32_bf16 v[64:67], a[76:79], a[220:223], v[64:67]
  buffer_load_dwordx4 a[68:71], v113, s[24:27], s30 offen offset:0 sc1
  v_mfma_f32_16x16x32_bf16 v[68:71], a[76:79], a[228:231], v[68:71]
  v_mfma_f32_16x16x32_bf16 v[68:71], a[56:59], a[224:227], v[68:71]
  v_mfma_f32_16x16x32_bf16 v[72:75], a[56:59], a[232:235], v[72:75]
  v_mfma_f32_16x16x32_bf16 v[72:75], a[76:79], a[236:239], v[72:75]
  v_mfma_f32_16x16x32_bf16 v[76:79], a[76:79], a[244:247], v[76:79]
  v_mfma_f32_16x16x32_bf16 v[76:79], a[56:59], a[240:243], v[76:79]
  v_mfma_f32_16x16x32_bf16 v[0:3], a[80:83], a[248:251], v[0:3]
  buffer_load_dwordx4 a[52:55], v113, s[24:27], s30 offen offset:1024 sc1
  s_add_u32 s30, s30, 8192
  s_add_u32 s5, s31, 110592
  v_mfma_f32_16x16x32_bf16 v[0:3], a[100:103], a[252:255], v[0:3]
  buffer_load_dwordx4 a[72:75], v115, s[24:27], s4 offen offset:0 sc1
  v_mfma_f32_16x16x32_bf16 v[4:7], a[100:103], v[196:199], v[4:7]
  buffer_load_dwordx4 a[56:59], v116, s[24:27], s4 offen offset:1024 sc1
  v_mfma_f32_16x16x32_bf16 v[4:7], a[80:83], v[176:179], v[4:7]
  buffer_load_dwordx4 a[76:79], v115, s[24:27], s4 offen offset:1024 sc1
  v_mfma_f32_16x16x32_bf16 v[8:11], a[80:83], v[180:183], v[8:11]
  buffer_load_dwordx4 a[216:219], v116, s[24:27], s4 offen offset:2048 sc1
  v_mfma_f32_16x16x32_bf16 v[8:11], a[100:103], v[200:203], v[8:11]
  buffer_load_dwordx4 a[220:223], v115, s[24:27], s4 offen offset:2048 sc1
  v_mfma_f32_16x16x32_bf16 v[12:15], a[100:103], v[204:207], v[12:15]
  v_mfma_f32_16x16x32_bf16 v[12:15], a[80:83], v[184:187], v[12:15]
  v_mfma_f32_16x16x32_bf16 v[16:19], a[84:87], a[248:251], v[16:19]
  buffer_load_dwordx4 a[224:227], v116, s[24:27], s4 offen offset:3072 sc1
  s_waitcnt vmcnt(13)
  v_mfma_f32_16x16x32_bf16 v[16:19], a[104:107], a[252:255], v[16:19]
  buffer_load_dwordx4 a[228:231], v115, s[24:27], s4 offen offset:3072 sc1
  v_mfma_f32_16x16x32_bf16 v[20:23], a[104:107], v[196:199], v[20:23]
  buffer_load_dwordx4 a[232:235], v114, s[24:27], s5 offen offset:0 sc1
  v_mfma_f32_16x16x32_bf16 v[20:23], a[84:87], v[176:179], v[20:23]
  buffer_load_dwordx4 a[236:239], v116, s[24:27], s4 offen offset:0 sc1
  v_mfma_f32_16x16x32_bf16 v[24:27], a[84:87], v[180:183], v[24:27]
  buffer_load_dwordx4 a[240:243], v114, s[24:27], s5 offen offset:1024 sc1
  v_mfma_f32_16x16x32_bf16 v[24:27], a[104:107], v[200:203], v[24:27]
  buffer_load_dwordx4 a[244:247], v110, s[24:27], s30 offen offset:0 sc1
  v_mfma_f32_16x16x32_bf16 v[28:31], a[104:107], v[204:207], v[28:31]
  v_add_f32 v156, v156, v136
  v_add_f32 v157, v157, v137
  v_mfma_f32_16x16x32_bf16 v[28:31], a[84:87], v[184:187], v[28:31]
  v_add_f32 v158, v158, v138
  v_add_f32 v159, v159, v139
  v_mfma_f32_16x16x32_bf16 v[32:35], a[88:91], a[248:251], v[32:35]
  ds_read_b128 a[80:83], v122 offset:0
  ds_read_b128 a[100:103], v122 offset:5120
  v_mfma_f32_16x16x32_bf16 v[32:35], a[108:111], a[252:255], v[32:35]
  v_add_f32 v160, v160, v140
  v_add_f32 v161, v161, v141
  v_mfma_f32_16x16x32_bf16 v[36:39], a[108:111], v[196:199], v[36:39]
  v_add_f32 v162, v162, v142
  v_add_f32 v163, v163, v143
  v_mfma_f32_16x16x32_bf16 v[36:39], a[88:91], v[176:179], v[36:39]
  v_add_f32 v164, v164, v144
  v_add_f32 v165, v165, v145
  v_mfma_f32_16x16x32_bf16 v[40:43], a[88:91], v[180:183], v[40:43]
  v_add_f32 v166, v166, v146
  v_add_f32 v167, v167, v147
  v_mfma_f32_16x16x32_bf16 v[40:43], a[108:111], v[200:203], v[40:43]
  v_add_f32 v168, v168, v148
  v_add_f32 v169, v169, v149
  v_mfma_f32_16x16x32_bf16 v[44:47], a[108:111], v[204:207], v[44:47]
  v_add_f32 v170, v170, v150
  v_add_f32 v171, v171, v151
  v_mfma_f32_16x16x32_bf16 v[44:47], a[88:91], v[184:187], v[44:47]
  v_add_f32 v172, v172, v152
  v_add_f32 v173, v173, v153
  v_mfma_f32_16x16x32_bf16 v[48:51], a[92:95], a[248:251], v[48:51]
  ds_read_b128 a[84:87], v122 offset:1024
  ds_read_b128 a[104:107], v122 offset:6144
  v_mfma_f32_16x16x32_bf16 v[48:51], a[112:115], a[252:255], v[48:51]
  v_add_f32 v174, v174, v154
  v_add_f32 v175, v175, v155
  v_mfma_f32_16x16x32_bf16 v[52:55], a[112:115], v[196:199], v[52:55]
  buffer_load_dwordx4 v[136:139], v123, s[24:27], s32 offen offset:0 sc1
  v_mfma_f32_16x16x32_bf16 v[52:55], a[92:95], v[176:179], v[52:55]
  buffer_load_dwordx4 v[140:143], v123, s[24:27], s32 offen offset:64 sc1
  v_mfma_f32_16x16x32_bf16 v[56:59], a[92:95], v[180:183], v[56:59]
  buffer_load_dwordx4 v[144:147], v123, s[24:27], s32 offen offset:128 sc1
  v_mfma_f32_16x16x32_bf16 v[56:59], a[112:115], v[200:203], v[56:59]
  buffer_load_dwordx4 v[148:151], v123, s[24:27], s32 offen offset:192 sc1
  v_mfma_f32_16x16x32_bf16 v[60:63], a[112:115], v[204:207], v[60:63]
  buffer_load_dwordx4 v[152:155], v123, s[24:27], s32 offen offset:256 sc1
  s_add_u32 s32, s32, 20480
  v_mfma_f32_16x16x32_bf16 v[60:63], a[92:95], v[184:187], v[60:63]
  v_mfma_f32_16x16x32_bf16 v[64:67], a[96:99], a[248:251], v[64:67]
  ds_read_b128 a[88:91], v122 offset:2048
  ds_read_b128 a[108:111], v122 offset:7168
  v_mfma_f32_16x16x32_bf16 v[64:67], a[116:119], a[252:255], v[64:67]
  v_mfma_f32_16x16x32_bf16 v[68:71], a[116:119], v[196:199], v[68:71]
  v_mfma_f32_16x16x32_bf16 v[68:71], a[96:99], v[176:179], v[68:71]
  v_mfma_f32_16x16x32_bf16 v[72:75], a[96:99], v[180:183], v[72:75]
  v_mfma_f32_16x16x32_bf16 v[72:75], a[116:119], v[200:203], v[72:75]
  v_mfma_f32_16x16x32_bf16 v[76:79], a[116:119], v[204:207], v[76:79]
  v_mfma_f32_16x16x32_bf16 v[76:79], a[96:99], v[184:187], v[76:79]
  s_waitcnt lgkmcnt(4)
  v_mfma_f32_16x16x32_bf16 v[0:3], a[80:83], v[188:191], v[0:3]
  ds_read_b128 a[92:95], v122 offset:3072
  ds_read_b128 a[112:115], v122 offset:8192
  v_mfma_f32_16x16x32_bf16 v[0:3], a[100:103], v[208:211], v[0:3]
  buffer_load_dwordx4 a[96:99], v110, s[24:27], s30 offen offset:1024 sc1
  v_mfma_f32_16x16x32_bf16 v[4:7], a[100:103], v[212:215], v[4:7]
  buffer_load_dwordx4 a[116:119], v111, s[24:27], s30 offen offset:0 sc1
  v_mfma_f32_16x16x32_bf16 v[4:7], a[80:83], v[192:195], v[4:7]
  buffer_load_dwordx4 a[248:251], v111, s[24:27], s30 offen offset:1024 sc1
  v_mfma_f32_16x16x32_bf16 v[8:11], a[80:83], a[120:123], v[8:11]
  buffer_load_dwordx4 a[252:255], v112, s[24:27], s30 offen offset:0 sc1
  v_mfma_f32_16x16x32_bf16 v[8:11], a[100:103], a[124:127], v[8:11]
  buffer_load_dwordx4 v[176:179], v112, s[24:27], s30 offen offset:1024 sc1
  v_mfma_f32_16x16x32_bf16 v[12:15], a[100:103], a[132:135], v[12:15]
  buffer_load_dwordx4 v[196:199], v113, s[24:27], s30 offen offset:0 sc1
  v_mfma_f32_16x16x32_bf16 v[12:15], a[80:83], a[128:131], v[12:15]
  s_waitcnt lgkmcnt(4)
  v_mfma_f32_16x16x32_bf16 v[16:19], a[84:87], v[188:191], v[16:19]
  ds_read_b128 v[180:183], v122 offset:4096
  ds_read_b128 v[200:203], v122 offset:9216
  v_mfma_f32_16x16x32_bf16 v[16:19], a[104:107], v[208:211], v[16:19]
  buffer_load_dwordx4 v[184:187], v113, s[24:27], s30 offen offset:1024 sc1
  s_add_u32 s30, s30, 8192
  s_add_u32 s6, s31, 122880
  v_mfma_f32_16x16x32_bf16 v[20:23], a[104:107], v[212:215], v[20:23]
  buffer_load_dwordx4 v[204:207], v114, s[24:27], s5 offen offset:2048 sc1
  v_mfma_f32_16x16x32_bf16 v[20:23], a[84:87], v[192:195], v[20:23]
  v_mfma_f32_16x16x32_bf16 v[24:27], a[84:87], a[120:123], v[24:27]
  v_mfma_f32_16x16x32_bf16 v[24:27], a[104:107], a[124:127], v[24:27]
  v_mfma_f32_16x16x32_bf16 v[28:31], a[104:107], a[132:135], v[28:31]
  v_mfma_f32_16x16x32_bf16 v[28:31], a[84:87], a[128:131], v[28:31]
  s_waitcnt lgkmcnt(4)
  v_mfma_f32_16x16x32_bf16 v[32:35], a[88:91], v[188:191], v[32:35]
  ds_read_b128 a[80:83], v122 offset:10240
  ds_read_b128 a[100:103], v122 offset:15360
  v_mfma_f32_16x16x32_bf16 v[32:35], a[108:111], v[208:211], v[32:35]
  v_mfma_f32_16x16x32_bf16 v[36:39], a[108:111], v[212:215], v[36:39]
  v_mfma_f32_16x16x32_bf16 v[36:39], a[88:91], v[192:195], v[36:39]
  v_mfma_f32_16x16x32_bf16 v[40:43], a[88:91], a[120:123], v[40:43]
  v_mfma_f32_16x16x32_bf16 v[40:43], a[108:111], a[124:127], v[40:43]
  v_mfma_f32_16x16x32_bf16 v[44:47], a[108:111], a[132:135], v[44:47]
  v_mfma_f32_16x16x32_bf16 v[44:47], a[88:91], a[128:131], v[44:47]
  s_waitcnt lgkmcnt(4)
  v_mfma_f32_16x16x32_bf16 v[48:51], a[92:95], v[188:191], v[48:51]
  ds_read_b128 a[84:87], v122 offset:11264
  ds_read_b128 a[104:107], v122 offset:16384
  v_mfma_f32_16x16x32_bf16 v[48:51], a[112:115], v[208:211], v[48:51]
  v_mfma_f32_16x16x32_bf16 v[52:55], a[112:115], v[212:215], v[52:55]
  v_mfma_f32_16x16x32_bf16 v[52:55], a[92:95], v[192:195], v[52:55]
  v_mfma_f32_16x16x32_bf16 v[56:59], a[92:95], a[120:123], v[56:59]
  v_mfma_f32_16x16x32_bf16 v[56:59], a[112:115], a[124:127], v[56:59]
  v_mfma_f32_16x16x32_bf16 v[60:63], a[112:115], a[132:135], v[60:63]
  v_mfma_f32_16x16x32_bf16 v[60:63], a[92:95], a[128:131], v[60:63]
  s_waitcnt lgkmcnt(4)
  v_mfma_f32_16x16x32_bf16 v[64:67], v[180:183], v[188:191], v[64:67]
  ds_read_b128 a[88:91], v122 offset:12288
  ds_read_b128 a[108:111], v122 offset:17408
  s_waitcnt vmcnt(8)
  v_mfma_f32_16x16x32_bf16 v[64:67], v[200:203], v[208:211], v[64:67]
  v_add_f32 v156, v156, v136
  v_add_f32 v157, v157, v137
  v_mfma_f32_16x16x32_bf16 v[68:71], v[200:203], v[212:215], v[68:71]
  v_add_f32 v158, v158, v138
  v_add_f32 v159, v159, v139
  v_mfma_f32_16x16x32_bf16 v[68:71], v[180:183], v[192:195], v[68:71]
  v_add_f32 v160, v160, v140
  v_add_f32 v161, v161, v141
  v_mfma_f32_16x16x32_bf16 v[72:75], v[180:183], a[120:123], v[72:75]
  v_add_f32 v162, v162, v142
  v_add_f32 v163, v163, v143
  v_mfma_f32_16x16x32_bf16 v[72:75], v[200:203], a[124:127], v[72:75]
  v_add_f32 v164, v164, v144
  v_add_f32 v165, v165, v145
  v_mfma_f32_16x16x32_bf16 v[76:79], v[200:203], a[132:135], v[76:79]
  v_add_f32 v166, v166, v146
  v_add_f32 v167, v167, v147
  v_mfma_f32_16x16x32_bf16 v[76:79], v[180:183], a[128:131], v[76:79]
  v_add_f32 v168, v168, v148
  v_add_f32 v169, v169, v149
  s_waitcnt lgkmcnt(4)
  v_mfma_f32_16x16x32_bf16 v[0:3], a[80:83], a[136:139], v[0:3]
  ds_read_b128 a[92:95], v122 offset:13312
  ds_read_b128 a[112:115], v122 offset:18432
  v_mfma_f32_16x16x32_bf16 v[0:3], a[100:103], a[140:143], v[0:3]
  buffer_load_dwordx4 v[180:183], v115, s[24:27], s5 offen offset:3072 sc1
  v_mfma_f32_16x16x32_bf16 v[4:7], a[100:103], a[148:151], v[4:7]
  buffer_load_dwordx4 v[200:203], v114, s[24:27], s5 offen offset:3072 sc1
  v_mfma_f32_16x16x32_bf16 v[4:7], a[80:83], a[144:147], v[4:7]
  buffer_load_dwordx4 v[188:191], v116, s[24:27], s5 offen offset:0 sc1
  v_mfma_f32_16x16x32_bf16 v[8:11], a[80:83], v[216:219], v[8:11]
  buffer_load_dwordx4 v[208:211], v115, s[24:27], s5 offen offset:0 sc1
  v_mfma_f32_16x16x32_bf16 v[8:11], a[100:103], v[236:239], v[8:11]
  buffer_load_dwordx4 v[192:195], v116, s[24:27], s5 offen offset:1024 sc1
  v_mfma_f32_16x16x32_bf16 v[12:15], a[100:103], v[240:243], v[12:15]
  buffer_load_dwordx4 v[212:215], v115, s[24:27], s5 offen offset:1024 sc1
  v_mfma_f32_16x16x32_bf16 v[12:15], a[80:83], v[220:223], v[12:15]
  v_add_f32 v170, v170, v150
  v_add_f32 v171, v171, v151
  s_waitcnt lgkmcnt(4)
  v_mfma_f32_16x16x32_bf16 v[16:19], a[84:87], a[136:139], v[16:19]
  ds_read_b128 a[120:123], v122 offset:14336
  ds_read_b128 a[124:127], v122 offset:19456
  v_mfma_f32_16x16x32_bf16 v[16:19], a[104:107], a[140:143], v[16:19]
  buffer_load_dwordx4 a[128:131], v116, s[24:27], s5 offen offset:2048 sc1
  v_mfma_f32_16x16x32_bf16 v[20:23], a[104:107], a[148:151], v[20:23]
  buffer_load_dwordx4 a[132:135], v115, s[24:27], s5 offen offset:2048 sc1
  v_mfma_f32_16x16x32_bf16 v[20:23], a[84:87], a[144:147], v[20:23]
  v_add_f32 v172, v172, v152
  v_add_f32 v173, v173, v153
  v_mfma_f32_16x16x32_bf16 v[24:27], a[84:87], v[216:219], v[24:27]
  v_add_f32 v174, v174, v154
  v_add_f32 v175, v175, v155
  v_mfma_f32_16x16x32_bf16 v[24:27], a[104:107], v[236:239], v[24:27]
  buffer_load_dwordx4 v[136:139], v123, s[24:27], s32 offen offset:0 sc1
  v_mfma_f32_16x16x32_bf16 v[28:31], a[104:107], v[240:243], v[28:31]
  buffer_load_dwordx4 v[140:143], v123, s[24:27], s32 offen offset:64 sc1
  v_mfma_f32_16x16x32_bf16 v[28:31], a[84:87], v[220:223], v[28:31]
  buffer_load_dwordx4 v[144:147], v123, s[24:27], s32 offen offset:128 sc1
  s_waitcnt lgkmcnt(4)
  v_mfma_f32_16x16x32_bf16 v[32:35], a[88:91], a[136:139], v[32:35]
  ds_read_b128 a[80:83], v122 offset:20480
  ds_read_b128 a[100:103], v122 offset:25600
  v_mfma_f32_16x16x32_bf16 v[32:35], a[108:111], a[140:143], v[32:35]
  buffer_load_dwordx4 v[148:151], v123, s[24:27], s32 offen offset:192 sc1
  v_mfma_f32_16x16x32_bf16 v[36:39], a[108:111], a[148:151], v[36:39]
  buffer_load_dwordx4 v[152:155], v123, s[24:27], s32 offen offset:256 sc1
  s_add_u32 s32, s32, 20480
  v_mfma_f32_16x16x32_bf16 v[36:39], a[88:91], a[144:147], v[36:39]
  v_mfma_f32_16x16x32_bf16 v[40:43], a[88:91], v[216:219], v[40:43]
  v_mfma_f32_16x16x32_bf16 v[40:43], a[108:111], v[236:239], v[40:43]
  v_mfma_f32_16x16x32_bf16 v[44:47], a[108:111], v[240:243], v[44:47]
  v_mfma_f32_16x16x32_bf16 v[44:47], a[88:91], v[220:223], v[44:47]
  s_waitcnt lgkmcnt(4)
  v_mfma_f32_16x16x32_bf16 v[48:51], a[92:95], a[136:139], v[48:51]
  ds_read_b128 a[84:87], v122 offset:21504
  ds_read_b128 a[104:107], v122 offset:26624
  v_mfma_f32_16x16x32_bf16 v[48:51], a[112:115], a[140:143], v[48:51]
  v_mfma_f32_16x16x32_bf16 v[52:55], a[112:115], a[148:151], v[52:55]
  v_mfma_f32_16x16x32_bf16 v[52:55], a[92:95], a[144:147], v[52:55]
  v_mfma_f32_16x16x32_bf16 v[56:59], a[92:95], v[216:219], v[56:59]
  v_mfma_f32_16x16x32_bf16 v[56:59], a[112:115], v[236:239], v[56:59]
  v_mfma_f32_16x16x32_bf16 v[60:63], a[112:115], v[240:243], v[60:63]
  v_mfma_f32_16x16x32_bf16 v[60:63], a[92:95], v[220:223], v[60:63]
  s_waitcnt lgkmcnt(4)
  v_mfma_f32_16x16x32_bf16 v[64:67], a[120:123], a[136:139], v[64:67]
  ds_read_b128 a[88:91], v122 offset:22528
  ds_read_b128 a[108:111], v122 offset:27648
  v_mfma_f32_16x16x32_bf16 v[64:67], a[124:127], a[140:143], v[64:67]
  v_mfma_f32_16x16x32_bf16 v[68:71], a[124:127], a[148:151], v[68:71]
  v_mfma_f32_16x16x32_bf16 v[68:71], a[120:123], a[144:147], v[68:71]
  v_mfma_f32_16x16x32_bf16 v[72:75], a[120:123], v[216:219], v[72:75]
  v_mfma_f32_16x16x32_bf16 v[72:75], a[124:127], v[236:239], v[72:75]
  v_mfma_f32_16x16x32_bf16 v[76:79], a[124:127], v[240:243], v[76:79]
  v_mfma_f32_16x16x32_bf16 v[76:79], a[120:123], v[220:223], v[76:79]
  s_waitcnt lgkmcnt(4)
  v_mfma_f32_16x16x32_bf16 v[0:3], a[80:83], v[224:227], v[0:3]
  ds_read_b128 a[92:95], v122 offset:23552
  ds_read_b128 a[112:115], v122 offset:28672
  v_mfma_f32_16x16x32_bf16 v[0:3], a[100:103], v[244:247], v[0:3]
  buffer_load_dwordx4 a[120:123], v116, s[24:27], s5 offen offset:3072 sc1
  v_mfma_f32_16x16x32_bf16 v[4:7], a[100:103], v[248:251], v[4:7]
  buffer_load_dwordx4 a[124:127], v110, s[24:27], s30 offen offset:0 sc1
  v_mfma_f32_16x16x32_bf16 v[4:7], a[80:83], v[228:231], v[4:7]
  buffer_load_dwordx4 a[136:139], v110, s[24:27], s30 offen offset:1024 sc1
  v_mfma_f32_16x16x32_bf16 v[8:11], a[80:83], v[232:235], v[8:11]
  buffer_load_dwordx4 a[140:143], v111, s[24:27], s30 offen offset:0 sc1
  v_mfma_f32_16x16x32_bf16 v[8:11], a[100:103], v[252:255], v[8:11]
  buffer_load_dwordx4 a[144:147], v111, s[24:27], s30 offen offset:1024 sc1
  v_mfma_f32_16x16x32_bf16 v[12:15], a[100:103], a[156:159], v[12:15]
  buffer_load_dwordx4 a[148:151], v112, s[24:27], s30 offen offset:0 sc1
  v_mfma_f32_16x16x32_bf16 v[12:15], a[80:83], a[152:155], v[12:15]
  s_waitcnt lgkmcnt(4)
  v_mfma_f32_16x16x32_bf16 v[16:19], a[84:87], v[224:227], v[16:19]
  ds_read_b128 v[216:219], v122 offset:24576
  ds_read_b128 v[236:239], v122 offset:29696
  v_mfma_f32_16x16x32_bf16 v[16:19], a[104:107], v[244:247], v[16:19]
  buffer_load_dwordx4 v[220:223], v112, s[24:27], s30 offen offset:1024 sc1
  v_mfma_f32_16x16x32_bf16 v[20:23], a[104:107], v[248:251], v[20:23]
  buffer_load_dwordx4 v[240:243], v113, s[24:27], s30 offen offset:0 sc1
  v_mfma_f32_16x16x32_bf16 v[20:23], a[84:87], v[228:231], v[20:23]
  v_mfma_f32_16x16x32_bf16 v[24:27], a[84:87], v[232:235], v[24:27]
  v_mfma_f32_16x16x32_bf16 v[24:27], a[104:107], v[252:255], v[24:27]
  v_mfma_f32_16x16x32_bf16 v[28:31], a[104:107], a[156:159], v[28:31]
  v_mfma_f32_16x16x32_bf16 v[28:31], a[84:87], a[152:155], v[28:31]
  s_waitcnt lgkmcnt(4)
  v_mfma_f32_16x16x32_bf16 v[32:35], a[88:91], v[224:227], v[32:35]
  ds_read_b128 a[80:83], v122 offset:30720
  s_waitcnt vmcnt(8)
  v_add_f32 v156, v156, v136
  v_mfma_f32_16x16x32_bf16 v[32:35], a[108:111], v[244:247], v[32:35]
  buffer_load_dwordx4 a[100:103], v113, s[24:27], s30 offen offset:1024 sc1
  s_add_u32 s30, s30, 8192
  v_mfma_f32_16x16x32_bf16 v[36:39], a[108:111], v[248:251], v[36:39]
  v_add_f32 v157, v157, v137
  v_add_f32 v158, v158, v138
  v_mfma_f32_16x16x32_bf16 v[36:39], a[88:91], v[228:231], v[36:39]
  v_add_f32 v159, v159, v139
  v_add_f32 v160, v160, v140
  v_mfma_f32_16x16x32_bf16 v[40:43], a[88:91], v[232:235], v[40:43]
  v_add_f32 v161, v161, v141
  v_add_f32 v162, v162, v142
  v_mfma_f32_16x16x32_bf16 v[40:43], a[108:111], v[252:255], v[40:43]
  v_add_f32 v163, v163, v143
  v_add_f32 v164, v164, v144
  v_mfma_f32_16x16x32_bf16 v[44:47], a[108:111], a[156:159], v[44:47]
  v_add_f32 v165, v165, v145
  v_add_f32 v166, v166, v146
  v_mfma_f32_16x16x32_bf16 v[44:47], a[88:91], a[152:155], v[44:47]
  v_add_f32 v167, v167, v147
  v_add_f32 v168, v168, v148
  s_waitcnt lgkmcnt(3)
  v_mfma_f32_16x16x32_bf16 v[48:51], a[92:95], v[224:227], v[48:51]
  ds_read_b128 a[84:87], v122 offset:31744
  s_add_u32 s7, s31, 135168
  v_add_f32 v169, v169, v149
  v_mfma_f32_16x16x32_bf16 v[48:51], a[112:115], v[244:247], v[48:51]
  buffer_load_dwordx4 a[104:107], v114, s[24:27], s6 offen offset:0 sc1
  v_mfma_f32_16x16x32_bf16 v[52:55], a[112:115], v[248:251], v[52:55]
  v_add_f32 v170, v170, v150
  v_add_f32 v171, v171, v151
  v_mfma_f32_16x16x32_bf16 v[52:55], a[92:95], v[228:231], v[52:55]
  v_add_f32 v172, v172, v152
  v_add_f32 v173, v173, v153
  v_mfma_f32_16x16x32_bf16 v[56:59], a[92:95], v[232:235], v[56:59]
  v_add_f32 v174, v174, v154
  v_add_f32 v175, v175, v155
  v_mfma_f32_16x16x32_bf16 v[56:59], a[112:115], v[252:255], v[56:59]
  buffer_load_dwordx4 v[136:139], v123, s[24:27], s32 offen offset:0 sc1
  v_mfma_f32_16x16x32_bf16 v[60:63], a[112:115], a[156:159], v[60:63]
  buffer_load_dwordx4 v[140:143], v123, s[24:27], s32 offen offset:64 sc1
  v_mfma_f32_16x16x32_bf16 v[60:63], a[92:95], a[152:155], v[60:63]
  buffer_load_dwordx4 v[144:147], v123, s[24:27], s32 offen offset:128 sc1
  s_waitcnt lgkmcnt(2)
  v_mfma_f32_16x16x32_bf16 v[64:67], v[216:219], v[224:227], v[64:67]
  ds_read_b128 a[88:91], v122 offset:32768
  buffer_load_dwordx4 v[148:151], v123, s[24:27], s32 offen offset:192 sc1
  v_mfma_f32_16x16x32_bf16 v[64:67], v[236:239], v[244:247], v[64:67]
  buffer_load_dwordx4 a[108:111], v115, s[24:27], s6 offen offset:1024 sc1
  v_mfma_f32_16x16x32_bf16 v[68:71], v[236:239], v[248:251], v[68:71]
  buffer_load_dwordx4 v[152:155], v123, s[24:27], s32 offen offset:256 sc1
  s_add_u32 s32, s32, 20480
  v_mfma_f32_16x16x32_bf16 v[68:71], v[216:219], v[228:231], v[68:71]
  v_mfma_f32_16x16x32_bf16 v[72:75], v[216:219], v[232:235], v[72:75]
  v_mfma_f32_16x16x32_bf16 v[72:75], v[236:239], v[252:255], v[72:75]
  v_mfma_f32_16x16x32_bf16 v[76:79], v[236:239], a[156:159], v[76:79]
  v_mfma_f32_16x16x32_bf16 v[76:79], v[216:219], a[152:155], v[76:79]
  s_waitcnt lgkmcnt(2)
  v_mfma_f32_16x16x32_bf16 v[0:3], a[80:83], a[180:183], v[0:3]
  ds_read_b128 a[92:95], v122 offset:33792
  v_mfma_f32_16x16x32_bf16 v[0:3], a[160:163], a[0:3], v[0:3]
  buffer_load_dwordx4 a[112:115], v114, s[24:27], s6 offen offset:1024 sc1
  v_mfma_f32_16x16x32_bf16 v[4:7], a[160:163], a[4:7], v[4:7]
  buffer_load_dwordx4 v[216:219], v115, s[24:27], s6 offen offset:2048 sc1
  v_mfma_f32_16x16x32_bf16 v[4:7], a[80:83], a[20:23], v[4:7]
  buffer_load_dwordx4 v[236:239], v114, s[24:27], s6 offen offset:2048 sc1
  v_mfma_f32_16x16x32_bf16 v[8:11], a[80:83], a[24:27], v[8:11]
  buffer_load_dwordx4 v[224:227], v115, s[24:27], s6 offen offset:3072 sc1
  v_mfma_f32_16x16x32_bf16 v[8:11], a[160:163], a[8:11], v[8:11]
  buffer_load_dwordx4 v[244:247], v114, s[24:27], s6 offen offset:3072 sc1
  v_mfma_f32_16x16x32_bf16 v[12:15], a[160:163], a[12:15], v[12:15]
  buffer_load_dwordx4 v[228:231], v116, s[24:27], s6 offen offset:0 sc1
  v_mfma_f32_16x16x32_bf16 v[12:15], a[80:83], a[28:31], v[12:15]
  s_waitcnt lgkmcnt(2)
  v_mfma_f32_16x16x32_bf16 v[16:19], a[84:87], a[180:183], v[16:19]
  ds_read_b128 v[248:251], v122 offset:34816
  v_mfma_f32_16x16x32_bf16 v[16:19], a[164:167], a[0:3], v[16:19]
  buffer_load_dwordx4 v[232:235], v115, s[24:27], s6 offen offset:0 sc1
  v_mfma_f32_16x16x32_bf16 v[20:23], a[164:167], a[4:7], v[20:23]
  buffer_load_dwordx4 v[252:255], v116, s[24:27], s6 offen offset:1024 sc1
  v_mfma_f32_16x16x32_bf16 v[20:23], a[84:87], a[20:23], v[20:23]
  buffer_load_dwordx4 a[152:155], v110, s[24:27], s30 offen offset:0 sc1
  v_mfma_f32_16x16x32_bf16 v[24:27], a[84:87], a[24:27], v[24:27]
  buffer_load_dwordx4 a[156:159], v110, s[24:27], s30 offen offset:1024 sc1
  v_mfma_f32_16x16x32_bf16 v[24:27], a[164:167], a[8:11], v[24:27]
  v_mfma_f32_16x16x32_bf16 v[28:31], a[164:167], a[12:15], v[28:31]
  v_mfma_f32_16x16x32_bf16 v[28:31], a[84:87], a[28:31], v[28:31]
  s_waitcnt lgkmcnt(2)
  v_mfma_f32_16x16x32_bf16 v[32:35], a[88:91], a[180:183], v[32:35]
  buffer_load_dwordx4 a[80:83], v111, s[24:27], s30 offen offset:0 sc1
  v_mfma_f32_16x16x32_bf16 v[32:35], a[168:171], a[0:3], v[32:35]
  buffer_load_dwordx4 a[160:163], v111, s[24:27], s30 offen offset:1024 sc1
  v_mfma_f32_16x16x32_bf16 v[36:39], a[168:171], a[4:7], v[36:39]
  buffer_load_dwordx4 a[84:87], v112, s[24:27], s30 offen offset:0 sc1
  v_mfma_f32_16x16x32_bf16 v[36:39], a[88:91], a[20:23], v[36:39]
  buffer_load_dwordx4 a[164:167], v112, s[24:27], s30 offen offset:1024 sc1
  v_mfma_f32_16x16x32_bf16 v[40:43], a[88:91], a[24:27], v[40:43]
  v_mfma_f32_16x16x32_bf16 v[40:43], a[168:171], a[8:11], v[40:43]
  v_mfma_f32_16x16x32_bf16 v[44:47], a[168:171], a[12:15], v[44:47]
  v_mfma_f32_16x16x32_bf16 v[44:47], a[88:91], a[28:31], v[44:47]
  s_waitcnt lgkmcnt(1)
  v_mfma_f32_16x16x32_bf16 v[48:51], a[92:95], a[180:183], v[48:51]
  buffer_load_dwordx4 a[88:91], v113, s[24:27], s30 offen offset:0 sc1
  v_mfma_f32_16x16x32_bf16 v[48:51], a[172:175], a[0:3], v[48:51]
  buffer_load_dwordx4 a[168:171], v113, s[24:27], s30 offen offset:1024 sc1
  s_add_u32 s30, s30, 8192
  v_mfma_f32_16x16x32_bf16 v[52:55], a[172:175], a[4:7], v[52:55]
  v_mfma_f32_16x16x32_bf16 v[52:55], a[92:95], a[20:23], v[52:55]
  v_mfma_f32_16x16x32_bf16 v[56:59], a[92:95], a[24:27], v[56:59]
  v_mfma_f32_16x16x32_bf16 v[56:59], a[172:175], a[8:11], v[56:59]
  v_mfma_f32_16x16x32_bf16 v[60:63], a[172:175], a[12:15], v[60:63]
  v_mfma_f32_16x16x32_bf16 v[60:63], a[92:95], a[28:31], v[60:63]
  s_waitcnt lgkmcnt(0)
  v_mfma_f32_16x16x32_bf16 v[64:67], v[248:251], a[180:183], v[64:67]
  buffer_load_dwordx4 a[92:95], v116, s[24:27], s6 offen offset:2048 sc1
  s_add_u32 s8, s31, 147456
  v_mfma_f32_16x16x32_bf16 v[64:67], a[176:179], a[0:3], v[64:67]
  buffer_load_dwordx4 a[172:175], v114, s[24:27], s7 offen offset:3072 sc1
  v_mfma_f32_16x16x32_bf16 v[68:71], a[176:179], a[4:7], v[68:71]
  v_mfma_f32_16x16x32_bf16 v[68:71], v[248:251], a[20:23], v[68:71]
  v_mfma_f32_16x16x32_bf16 v[72:75], v[248:251], a[24:27], v[72:75]
  v_mfma_f32_16x16x32_bf16 v[72:75], a[176:179], a[8:11], v[72:75]
  v_mfma_f32_16x16x32_bf16 v[76:79], a[176:179], a[12:15], v[76:79]
  v_mfma_f32_16x16x32_bf16 v[76:79], v[248:251], a[28:31], v[76:79]
  v_mfma_f32_16x16x32_bf16 v[0:3], a[32:35], a[212:215], v[0:3]
  buffer_load_dwordx4 v[248:251], v116, s[24:27], s6 offen offset:3072 sc1
  s_waitcnt vmcnt(19)
  v_mfma_f32_16x16x32_bf16 v[0:3], a[16:19], a[40:43], v[0:3]
  buffer_load_dwordx4 a[176:179], v115, s[24:27], s7 offen offset:0 sc1
  v_mfma_f32_16x16x32_bf16 v[4:7], a[16:19], a[44:47], v[4:7]
  buffer_load_dwordx4 a[180:183], v114, s[24:27], s7 offen offset:0 sc1
  v_mfma_f32_16x16x32_bf16 v[4:7], a[32:35], a[60:63], v[4:7]
  buffer_load_dwordx4 a[0:3], v115, s[24:27], s7 offen offset:1024 sc1
  v_mfma_f32_16x16x32_bf16 v[8:11], a[32:35], a[64:67], v[8:11]
  buffer_load_dwordx4 a[20:23], v114, s[24:27], s7 offen offset:1024 sc1
  v_mfma_f32_16x16x32_bf16 v[8:11], a[16:19], a[48:51], v[8:11]
  buffer_load_dwordx4 a[4:7], v115, s[24:27], s7 offen offset:2048 sc1
  v_mfma_f32_16x16x32_bf16 v[12:15], a[16:19], a[52:55], v[12:15]
  v_add_f32 v156, v156, v136
  v_add_f32 v157, v157, v137
  v_mfma_f32_16x16x32_bf16 v[12:15], a[32:35], a[68:71], v[12:15]
  v_add_f32 v158, v158, v138
  v_add_f32 v159, v159, v139
  v_mfma_f32_16x16x32_bf16 v[16:19], a[36:39], a[212:215], v[16:19]
  buffer_load_dwordx4 a[24:27], v114, s[24:27], s7 offen offset:2048 sc1
  v_mfma_f32_16x16x32_bf16 v[16:19], a[184:187], a[40:43], v[16:19]
  buffer_load_dwordx4 a[8:11], v115, s[24:27], s7 offen offset:3072 sc1
  v_mfma_f32_16x16x32_bf16 v[20:23], a[184:187], a[44:47], v[20:23]
  buffer_load_dwordx4 a[28:31], v110, s[24:27], s30 offen offset:0 sc1
  v_mfma_f32_16x16x32_bf16 v[20:23], a[36:39], a[60:63], v[20:23]
  buffer_load_dwordx4 a[12:15], v110, s[24:27], s30 offen offset:1024 sc1
  v_mfma_f32_16x16x32_bf16 v[24:27], a[36:39], a[64:67], v[24:27]
  buffer_load_dwordx4 a[32:35], v111, s[24:27], s30 offen offset:0 sc1
  v_mfma_f32_16x16x32_bf16 v[24:27], a[184:187], a[48:51], v[24:27]
  buffer_load_dwordx4 a[16:19], v111, s[24:27], s30 offen offset:1024 sc1
  v_mfma_f32_16x16x32_bf16 v[28:31], a[184:187], a[52:55], v[28:31]
  v_add_f32 v160, v160, v140
  v_add_f32 v161, v161, v141
  v_mfma_f32_16x16x32_bf16 v[28:31], a[36:39], a[68:71], v[28:31]
  v_add_f32 v162, v162, v142
  v_add_f32 v163, v163, v143
  v_mfma_f32_16x16x32_bf16 v[32:35], a[188:191], a[212:215], v[32:35]
  buffer_load_dwordx4 a[36:39], v112, s[24:27], s30 offen offset:0 sc1
  v_mfma_f32_16x16x32_bf16 v[32:35], a[192:195], a[40:43], v[32:35]
  buffer_load_dwordx4 a[184:187], v112, s[24:27], s30 offen offset:1024 sc1
  v_mfma_f32_16x16x32_bf16 v[36:39], a[192:195], a[44:47], v[36:39]
  v_add_f32 v164, v164, v144
  v_add_f32 v165, v165, v145
  v_mfma_f32_16x16x32_bf16 v[36:39], a[188:191], a[60:63], v[36:39]
  v_add_f32 v166, v166, v146
  v_add_f32 v167, v167, v147
  v_mfma_f32_16x16x32_bf16 v[40:43], a[188:191], a[64:67], v[40:43]
  v_add_f32 v168, v168, v148
  v_add_f32 v169, v169, v149
  v_mfma_f32_16x16x32_bf16 v[40:43], a[192:195], a[48:51], v[40:43]
  v_add_f32 v170, v170, v150
  v_add_f32 v171, v171, v151
  v_mfma_f32_16x16x32_bf16 v[44:47], a[192:195], a[52:55], v[44:47]
  v_add_f32 v172, v172, v152
  v_add_f32 v173, v173, v153
  v_mfma_f32_16x16x32_bf16 v[44:47], a[188:191], a[68:71], v[44:47]
  v_add_f32 v174, v174, v154
  v_add_f32 v175, v175, v155
  v_mfma_f32_16x16x32_bf16 v[48:51], a[196:199], a[212:215], v[48:51]
  buffer_load_dwordx4 a[188:191], v113, s[24:27], s30 offen offset:0 sc1
  v_mfma_f32_16x16x32_bf16 v[48:51], a[200:203], a[40:43], v[48:51]
  buffer_load_dwordx4 a[192:195], v113, s[24:27], s30 offen offset:1024 sc1
  s_add_u32 s30, s30, 8192
  v_mfma_f32_16x16x32_bf16 v[52:55], a[200:203], a[44:47], v[52:55]
  v_cvt_pk_bf16_f32 v156, v156, v156
  v_cvt_pk_bf16_f32 v157, v157, v157
  v_mfma_f32_16x16x32_bf16 v[52:55], a[196:199], a[60:63], v[52:55]
  v_cvt_pk_bf16_f32 v158, v158, v158
  v_cvt_pk_bf16_f32 v159, v159, v159
  v_mfma_f32_16x16x32_bf16 v[56:59], a[196:199], a[64:67], v[56:59]
  v_lshlrev_b32 v156, 16, v156
  v_lshlrev_b32 v157, 16, v157
  v_mfma_f32_16x16x32_bf16 v[56:59], a[200:203], a[48:51], v[56:59]
  v_lshlrev_b32 v158, 16, v158
  v_lshlrev_b32 v159, 16, v159
  v_mfma_f32_16x16x32_bf16 v[60:63], a[200:203], a[52:55], v[60:63]
  v_mul_f32 v156, v156, v124
  v_mul_f32 v157, v157, v124
  v_mfma_f32_16x16x32_bf16 v[60:63], a[196:199], a[68:71], v[60:63]
  v_mul_f32 v158, v158, v124
  v_mul_f32 v159, v159, v124
  v_mfma_f32_16x16x32_bf16 v[64:67], a[204:207], a[212:215], v[64:67]
  buffer_load_dwordx4 a[196:199], v116, s[24:27], s7 offen offset:0 sc1
  s_add_u32 s9, s31, 159744
  v_mfma_f32_16x16x32_bf16 v[64:67], a[208:211], a[40:43], v[64:67]
  buffer_load_dwordx4 a[200:203], v114, s[24:27], s8 offen offset:1024 sc1
  v_mfma_f32_16x16x32_bf16 v[68:71], a[208:211], a[44:47], v[68:71]
  v_cvt_pk_bf16_f32 v156, v156, v156
  v_cvt_pk_bf16_f32 v157, v157, v157
  v_mfma_f32_16x16x32_bf16 v[68:71], a[204:207], a[60:63], v[68:71]
  v_cvt_pk_bf16_f32 v158, v158, v158
  v_cvt_pk_bf16_f32 v159, v159, v159
  v_mfma_f32_16x16x32_bf16 v[72:75], a[204:207], a[64:67], v[72:75]
  v_lshlrev_b32 v156, 16, v156
  v_lshlrev_b32 v157, 16, v157
  v_mfma_f32_16x16x32_bf16 v[72:75], a[208:211], a[48:51], v[72:75]
  v_lshlrev_b32 v158, 16, v158
  v_lshlrev_b32 v159, 16, v159
  v_mfma_f32_16x16x32_bf16 v[76:79], a[208:211], a[52:55], v[76:79]
  v_add_f32 v90, v90, v156
  v_add_f32 v91, v91, v157
  v_mfma_f32_16x16x32_bf16 v[76:79], a[204:207], a[68:71], v[76:79]
  v_add_f32 v92, v92, v158
  v_add_f32 v93, v93, v159
  v_mfma_f32_16x16x32_bf16 v[0:3], a[72:75], a[244:247], v[0:3]
  buffer_load_dwordx4 a[204:207], v116, s[24:27], s7 offen offset:1024 sc1
  v_mfma_f32_16x16x32_bf16 v[0:3], a[56:59], a[96:99], v[0:3]
  buffer_load_dwordx4 a[208:211], v114, s[24:27], s8 offen offset:2048 sc1
  v_mfma_f32_16x16x32_bf16 v[4:7], a[56:59], a[248:251], v[4:7]
  buffer_load_dwordx4 a[212:215], v116, s[24:27], s7 offen offset:2048 sc1
  v_mfma_f32_16x16x32_bf16 v[4:7], a[72:75], a[116:119], v[4:7]
  buffer_load_dwordx4 a[40:43], v114, s[24:27], s8 offen offset:3072 sc1
  v_mfma_f32_16x16x32_bf16 v[8:11], a[72:75], a[252:255], v[8:11]
  buffer_load_dwordx4 a[60:63], v116, s[24:27], s7 offen offset:3072 sc1
  v_mfma_f32_16x16x32_bf16 v[8:11], a[56:59], v[176:179], v[8:11]
  buffer_load_dwordx4 a[44:47], v115, s[24:27], s8 offen offset:0 sc1
  v_mfma_f32_16x16x32_bf16 v[12:15], a[56:59], v[184:187], v[12:15]
  v_cvt_pk_bf16_f32 v90, v90, v90
  v_cvt_pk_bf16_f32 v91, v91, v91
  v_mfma_f32_16x16x32_bf16 v[12:15], a[72:75], v[196:199], v[12:15]
  v_cvt_pk_bf16_f32 v92, v92, v92
  v_cvt_pk_bf16_f32 v93, v93, v93
  v_mfma_f32_16x16x32_bf16 v[16:19], a[76:79], a[244:247], v[16:19]
  buffer_load_dwordx4 a[64:67], v114, s[24:27], s8 offen offset:0 sc1
  v_mfma_f32_16x16x32_bf16 v[16:19], a[216:219], a[96:99], v[16:19]
  buffer_load_dwordx4 a[48:51], v115, s[24:27], s8 offen offset:1024 sc1
  v_mfma_f32_16x16x32_bf16 v[20:23], a[216:219], a[248:251], v[20:23]
  buffer_load_dwordx4 a[68:71], v110, s[24:27], s30 offen offset:0 sc1
  v_mfma_f32_16x16x32_bf16 v[20:23], a[76:79], a[116:119], v[20:23]
  buffer_load_dwordx4 a[52:55], v110, s[24:27], s30 offen offset:1024 sc1
  v_mfma_f32_16x16x32_bf16 v[24:27], a[76:79], a[252:255], v[24:27]
  buffer_load_dwordx4 a[72:75], v111, s[24:27], s30 offen offset:0 sc1
  v_mfma_f32_16x16x32_bf16 v[24:27], a[216:219], v[176:179], v[24:27]
  buffer_load_dwordx4 a[56:59], v111, s[24:27], s30 offen offset:1024 sc1
  v_mfma_f32_16x16x32_bf16 v[28:31], a[216:219], v[184:187], v[28:31]
  v_lshlrev_b32 v90, 16, v90
  v_lshlrev_b32 v91, 16, v91
  v_mfma_f32_16x16x32_bf16 v[28:31], a[76:79], v[196:199], v[28:31]
  v_lshlrev_b32 v92, 16, v92
  v_lshlrev_b32 v93, 16, v93
  v_mfma_f32_16x16x32_bf16 v[32:35], a[220:223], a[244:247], v[32:35]
  buffer_load_dwordx4 a[76:79], v112, s[24:27], s30 offen offset:0 sc1
  v_mfma_f32_16x16x32_bf16 v[32:35], a[224:227], a[96:99], v[32:35]
  buffer_load_dwordx4 a[216:219], v112, s[24:27], s30 offen offset:1024 sc1
  v_mfma_f32_16x16x32_bf16 v[36:39], a[224:227], a[248:251], v[36:39]
  v_mul_f32 v129, 0xbfb8aa3b, v90
  v_mul_f32 v130, 0xbfb8aa3b, v91
  v_mfma_f32_16x16x32_bf16 v[36:39], a[220:223], a[116:119], v[36:39]
  v_mul_f32 v131, 0xbfb8aa3b, v92
  v_mul_f32 v132, 0xbfb8aa3b, v93
  v_mfma_f32_16x16x32_bf16 v[40:43], a[220:223], a[252:255], v[40:43]
  v_exp_f32 v129, v129
  v_mfma_f32_16x16x32_bf16 v[40:43], a[224:227], v[176:179], v[40:43]
  v_exp_f32 v130, v130
  v_mfma_f32_16x16x32_bf16 v[44:47], a[224:227], v[184:187], v[44:47]
  v_exp_f32 v131, v131
  v_mfma_f32_16x16x32_bf16 v[44:47], a[220:223], v[196:199], v[44:47]
  v_exp_f32 v132, v132
  v_mfma_f32_16x16x32_bf16 v[48:51], a[228:231], a[244:247], v[48:51]
  buffer_load_dwordx4 a[220:223], v113, s[24:27], s30 offen offset:0 sc1
  v_mfma_f32_16x16x32_bf16 v[48:51], a[232:235], a[96:99], v[48:51]
  buffer_load_dwordx4 a[224:227], v113, s[24:27], s30 offen offset:1024 sc1
  s_add_u32 s30, s30, 8192
  v_mfma_f32_16x16x32_bf16 v[52:55], a[232:235], a[248:251], v[52:55]
  v_add_f32 v129, 1.0, v129
  v_add_f32 v130, 1.0, v130
  v_mfma_f32_16x16x32_bf16 v[52:55], a[228:231], a[116:119], v[52:55]
  v_add_f32 v131, 1.0, v131
  v_add_f32 v132, 1.0, v132
  v_mfma_f32_16x16x32_bf16 v[56:59], a[228:231], a[252:255], v[56:59]
  v_rcp_f32 v129, v129
  v_mfma_f32_16x16x32_bf16 v[56:59], a[232:235], v[176:179], v[56:59]
  v_rcp_f32 v130, v130
  v_mfma_f32_16x16x32_bf16 v[60:63], a[232:235], v[184:187], v[60:63]
  v_rcp_f32 v131, v131
  v_mfma_f32_16x16x32_bf16 v[60:63], a[228:231], v[196:199], v[60:63]
  v_rcp_f32 v132, v132
  v_mfma_f32_16x16x32_bf16 v[64:67], a[236:239], a[244:247], v[64:67]
  buffer_load_dwordx4 a[228:231], v115, s[24:27], s8 offen offset:2048 sc1
  v_mfma_f32_16x16x32_bf16 v[64:67], a[240:243], a[96:99], v[64:67]
  buffer_load_dwordx4 a[232:235], v116, s[24:27], s8 offen offset:3072 sc1
  v_mfma_f32_16x16x32_bf16 v[68:71], a[240:243], a[248:251], v[68:71]
  v_mul_f32 v90, v90, v129
  v_mul_f32 v91, v91, v130
  v_mfma_f32_16x16x32_bf16 v[68:71], a[236:239], a[116:119], v[68:71]
  v_mul_f32 v92, v92, v131
  v_mul_f32 v93, v93, v132
  v_mfma_f32_16x16x32_bf16 v[72:75], a[236:239], a[252:255], v[72:75]
  v_cvt_pk_bf16_f32 v90, v90, v90
  v_cvt_pk_bf16_f32 v91, v91, v91
  v_mfma_f32_16x16x32_bf16 v[72:75], a[240:243], v[176:179], v[72:75]
  v_cvt_pk_bf16_f32 v92, v92, v92
  v_cvt_pk_bf16_f32 v93, v93, v93
  v_mfma_f32_16x16x32_bf16 v[76:79], a[240:243], v[184:187], v[76:79]
  v_lshlrev_b32 v90, 16, v90
  v_lshlrev_b32 v91, 16, v91
  v_mfma_f32_16x16x32_bf16 v[76:79], a[236:239], v[196:199], v[76:79]
  v_lshlrev_b32 v92, 16, v92
  v_lshlrev_b32 v93, 16, v93
  v_mfma_f32_16x16x32_bf16 v[0:3], v[204:207], a[124:127], v[0:3]
  buffer_load_dwordx4 a[236:239], v115, s[24:27], s8 offen offset:3072 sc1
  v_mfma_f32_16x16x32_bf16 v[0:3], v[180:183], a[136:139], v[0:3]
  buffer_load_dwordx4 a[240:243], v114, s[24:27], s9 offen offset:0 sc1
  v_mfma_f32_16x16x32_bf16 v[4:7], v[180:183], a[144:147], v[4:7]
  buffer_load_dwordx4 a[244:247], v116, s[24:27], s8 offen offset:0 sc1
  v_mfma_f32_16x16x32_bf16 v[4:7], v[204:207], a[140:143], v[4:7]
  buffer_load_dwordx4 a[96:99], v114, s[24:27], s9 offen offset:1024 sc1
  v_mfma_f32_16x16x32_bf16 v[8:11], v[204:207], a[148:151], v[8:11]
  buffer_load_dwordx4 a[116:119], v116, s[24:27], s8 offen offset:1024 sc1
  v_mfma_f32_16x16x32_bf16 v[8:11], v[180:183], v[220:223], v[8:11]
  buffer_load_dwordx4 a[248:251], v114, s[24:27], s9 offen offset:2048 sc1
  v_mfma_f32_16x16x32_bf16 v[12:15], v[180:183], a[100:103], v[12:15]
  v_cvt_pk_bf16_f32 v160, v160, v160
  v_cvt_pk_bf16_f32 v161, v161, v161
  v_mfma_f32_16x16x32_bf16 v[12:15], v[204:207], v[240:243], v[12:15]
  v_cvt_pk_bf16_f32 v162, v162, v162
  v_cvt_pk_bf16_f32 v163, v163, v163
  v_mfma_f32_16x16x32_bf16 v[16:19], v[200:203], a[124:127], v[16:19]
  buffer_load_dwordx4 a[252:255], v116, s[24:27], s8 offen offset:2048 sc1
  v_mfma_f32_16x16x32_bf16 v[16:19], v[188:191], a[136:139], v[16:19]
  buffer_load_dwordx4 v[176:179], v114, s[24:27], s9 offen offset:3072 sc1
  v_mfma_f32_16x16x32_bf16 v[20:23], v[188:191], a[144:147], v[20:23]
  s_waitcnt vmcnt(60)
  buffer_load_dwordx4 v[196:199], v110, s[24:27], s30 offen offset:0 sc1
  v_mfma_f32_16x16x32_bf16 v[20:23], v[200:203], a[140:143], v[20:23]
  buffer_load_dwordx4 v[184:187], v110, s[24:27], s30 offen offset:1024 sc1
  v_mfma_f32_16x16x32_bf16 v[24:27], v[200:203], a[148:151], v[24:27]
  s_waitcnt vmcnt(60)
  buffer_load_dwordx4 v[204:207], v111, s[24:27], s30 offen offset:0 sc1
  v_mfma_f32_16x16x32_bf16 v[24:27], v[188:191], v[220:223], v[24:27]
  buffer_load_dwordx4 v[180:183], v111, s[24:27], s30 offen offset:1024 sc1
  v_mfma_f32_16x16x32_bf16 v[28:31], v[188:191], a[100:103], v[28:31]
  v_lshlrev_b32 v160, 16, v160
  v_lshlrev_b32 v161, 16, v161
  v_mfma_f32_16x16x32_bf16 v[28:31], v[200:203], v[240:243], v[28:31]
  v_lshlrev_b32 v162, 16, v162
  v_lshlrev_b32 v163, 16, v163
  v_mfma_f32_16x16x32_bf16 v[32:35], v[208:211], a[124:127], v[32:35]
  s_waitcnt vmcnt(60)
  buffer_load_dwordx4 v[200:203], v112, s[24:27], s30 offen offset:0 sc1
  v_mfma_f32_16x16x32_bf16 v[32:35], v[192:195], a[136:139], v[32:35]
  buffer_load_dwordx4 v[188:191], v112, s[24:27], s30 offen offset:1024 sc1
  v_mfma_f32_16x16x32_bf16 v[36:39], v[192:195], a[144:147], v[36:39]
  v_mul_f32 v160, v160, v124
  v_mul_f32 v161, v161, v124
  v_mfma_f32_16x16x32_bf16 v[36:39], v[208:211], a[140:143], v[36:39]
  v_mul_f32 v162, v162, v124
  v_mul_f32 v163, v163, v124
  v_mfma_f32_16x16x32_bf16 v[40:43], v[208:211], a[148:151], v[40:43]
  v_cvt_pk_bf16_f32 v160, v160, v160
  v_cvt_pk_bf16_f32 v161, v161, v161
  v_mfma_f32_16x16x32_bf16 v[40:43], v[192:195], v[220:223], v[40:43]
  v_cvt_pk_bf16_f32 v162, v162, v162
  v_cvt_pk_bf16_f32 v163, v163, v163
  v_mfma_f32_16x16x32_bf16 v[44:47], v[192:195], a[100:103], v[44:47]
  v_lshlrev_b32 v160, 16, v160
  v_lshlrev_b32 v161, 16, v161
  v_mfma_f32_16x16x32_bf16 v[44:47], v[208:211], v[240:243], v[44:47]
  v_lshlrev_b32 v162, 16, v162
  v_lshlrev_b32 v163, 16, v163
  v_mfma_f32_16x16x32_bf16 v[48:51], v[212:215], a[124:127], v[48:51]
  s_waitcnt vmcnt(60)
  buffer_load_dwordx4 v[208:211], v113, s[24:27], s30 offen offset:0 sc1
  v_mfma_f32_16x16x32_bf16 v[48:51], a[128:131], a[136:139], v[48:51]
  buffer_load_dwordx4 v[192:195], v113, s[24:27], s30 offen offset:1024 sc1
  s_add_u32 s30, s30, 8192
  v_mfma_f32_16x16x32_bf16 v[52:55], a[128:131], a[144:147], v[52:55]
  v_add_f32 v94, v94, v160
  v_add_f32 v95, v95, v161
  v_mfma_f32_16x16x32_bf16 v[52:55], v[212:215], a[140:143], v[52:55]
  v_add_f32 v96, v96, v162
  v_add_f32 v97, v97, v163
  v_mfma_f32_16x16x32_bf16 v[56:59], v[212:215], a[148:151], v[56:59]
  v_cvt_pk_bf16_f32 v94, v94, v94
  v_cvt_pk_bf16_f32 v95, v95, v95
  v_mfma_f32_16x16x32_bf16 v[56:59], a[128:131], v[220:223], v[56:59]
  v_cvt_pk_bf16_f32 v96, v96, v96
  v_cvt_pk_bf16_f32 v97, v97, v97
  v_mfma_f32_16x16x32_bf16 v[60:63], a[128:131], a[100:103], v[60:63]
  v_lshlrev_b32 v94, 16, v94
  v_lshlrev_b32 v95, 16, v95
  v_mfma_f32_16x16x32_bf16 v[60:63], v[212:215], v[240:243], v[60:63]
  v_lshlrev_b32 v96, 16, v96
  v_lshlrev_b32 v97, 16, v97
  v_mfma_f32_16x16x32_bf16 v[64:67], a[132:135], a[124:127], v[64:67]
  v_mul_f32 v129, 0xbfb8aa3b, v94
  v_mul_f32 v130, 0xbfb8aa3b, v95
  v_mfma_f32_16x16x32_bf16 v[64:67], a[120:123], a[136:139], v[64:67]
  v_mul_f32 v131, 0xbfb8aa3b, v96
  v_mul_f32 v132, 0xbfb8aa3b, v97
  v_mfma_f32_16x16x32_bf16 v[68:71], a[120:123], a[144:147], v[68:71]
  v_exp_f32 v129, v129
  v_mfma_f32_16x16x32_bf16 v[68:71], a[132:135], a[140:143], v[68:71]
  v_exp_f32 v130, v130
  v_mfma_f32_16x16x32_bf16 v[72:75], a[132:135], a[148:151], v[72:75]
  v_exp_f32 v131, v131
  v_mfma_f32_16x16x32_bf16 v[72:75], a[120:123], v[220:223], v[72:75]
  v_exp_f32 v132, v132
  v_mfma_f32_16x16x32_bf16 v[76:79], a[120:123], a[100:103], v[76:79]
  v_add_f32 v129, 1.0, v129
  v_add_f32 v130, 1.0, v130
  v_mfma_f32_16x16x32_bf16 v[76:79], a[132:135], v[240:243], v[76:79]
  v_add_f32 v131, 1.0, v131
  v_add_f32 v132, 1.0, v132
  s_waitcnt vmcnt(54)
  v_mfma_f32_16x16x32_bf16 v[0:3], a[104:107], a[152:155], v[0:3]
  v_rcp_f32 v129, v129
  v_mfma_f32_16x16x32_bf16 v[0:3], a[108:111], a[156:159], v[0:3]
  v_rcp_f32 v130, v130
  v_mfma_f32_16x16x32_bf16 v[4:7], a[108:111], a[160:163], v[4:7]
  v_rcp_f32 v131, v131
  v_mfma_f32_16x16x32_bf16 v[4:7], a[104:107], a[80:83], v[4:7]
  v_rcp_f32 v132, v132
  v_mfma_f32_16x16x32_bf16 v[8:11], a[104:107], a[84:87], v[8:11]
  v_mul_f32 v94, v94, v129
  v_mul_f32 v95, v95, v130
  v_mfma_f32_16x16x32_bf16 v[8:11], a[108:111], a[164:167], v[8:11]
  v_mul_f32 v96, v96, v131
  v_mul_f32 v97, v97, v132
  v_mfma_f32_16x16x32_bf16 v[12:15], a[108:111], a[168:171], v[12:15]
  v_cvt_pk_bf16_f32 v94, v94, v94
  v_cvt_pk_bf16_f32 v95, v95, v95
  v_mfma_f32_16x16x32_bf16 v[12:15], a[104:107], a[88:91], v[12:15]
  v_cvt_pk_bf16_f32 v96, v96, v96
  v_cvt_pk_bf16_f32 v97, v97, v97
  v_mfma_f32_16x16x32_bf16 v[16:19], a[112:115], a[152:155], v[16:19]
  v_lshlrev_b32 v94, 16, v94
  v_lshlrev_b32 v95, 16, v95
  v_mfma_f32_16x16x32_bf16 v[16:19], v[216:219], a[156:159], v[16:19]
  v_lshlrev_b32 v96, 16, v96
  v_lshlrev_b32 v97, 16, v97
  v_mfma_f32_16x16x32_bf16 v[20:23], v[216:219], a[160:163], v[20:23]
  v_cvt_pk_bf16_f32 v164, v164, v164
  v_cvt_pk_bf16_f32 v165, v165, v165
  v_mfma_f32_16x16x32_bf16 v[20:23], a[112:115], a[80:83], v[20:23]
  v_cvt_pk_bf16_f32 v166, v166, v166
  v_cvt_pk_bf16_f32 v167, v167, v167
  v_mfma_f32_16x16x32_bf16 v[24:27], a[112:115], a[84:87], v[24:27]
  v_lshlrev_b32 v164, 16, v164
  v_lshlrev_b32 v165, 16, v165
  v_mfma_f32_16x16x32_bf16 v[24:27], v[216:219], a[164:167], v[24:27]
  v_lshlrev_b32 v166, 16, v166
  v_lshlrev_b32 v167, 16, v167
  v_mfma_f32_16x16x32_bf16 v[28:31], v[216:219], a[168:171], v[28:31]
  v_mul_f32 v164, v164, v124
  v_mul_f32 v165, v165, v124
  v_mfma_f32_16x16x32_bf16 v[28:31], a[112:115], a[88:91], v[28:31]
  v_mul_f32 v166, v166, v124
  v_mul_f32 v167, v167, v124
  v_mfma_f32_16x16x32_bf16 v[32:35], v[236:239], a[152:155], v[32:35]
  v_cvt_pk_bf16_f32 v164, v164, v164
  v_cvt_pk_bf16_f32 v165, v165, v165
  v_mfma_f32_16x16x32_bf16 v[32:35], v[224:227], a[156:159], v[32:35]
  v_cvt_pk_bf16_f32 v166, v166, v166
  v_cvt_pk_bf16_f32 v167, v167, v167
  v_mfma_f32_16x16x32_bf16 v[36:39], v[224:227], a[160:163], v[36:39]
  v_lshlrev_b32 v164, 16, v164
  v_lshlrev_b32 v165, 16, v165
  v_mfma_f32_16x16x32_bf16 v[36:39], v[236:239], a[80:83], v[36:39]
  v_lshlrev_b32 v166, 16, v166
  v_lshlrev_b32 v167, 16, v167
  v_mfma_f32_16x16x32_bf16 v[40:43], v[236:239], a[84:87], v[40:43]
  v_add_f32 v98, v98, v164
  v_add_f32 v99, v99, v165
  v_mfma_f32_16x16x32_bf16 v[40:43], v[224:227], a[164:167], v[40:43]
  v_add_f32 v100, v100, v166
  v_add_f32 v101, v101, v167
  v_mfma_f32_16x16x32_bf16 v[44:47], v[224:227], a[168:171], v[44:47]
  v_cvt_pk_bf16_f32 v98, v98, v98
  v_cvt_pk_bf16_f32 v99, v99, v99
  v_mfma_f32_16x16x32_bf16 v[44:47], v[236:239], a[88:91], v[44:47]
  v_cvt_pk_bf16_f32 v100, v100, v100
  v_cvt_pk_bf16_f32 v101, v101, v101
  v_mfma_f32_16x16x32_bf16 v[48:51], v[244:247], a[152:155], v[48:51]
  v_lshlrev_b32 v98, 16, v98
  v_lshlrev_b32 v99, 16, v99
  v_mfma_f32_16x16x32_bf16 v[48:51], v[228:231], a[156:159], v[48:51]
  v_lshlrev_b32 v100, 16, v100
  v_lshlrev_b32 v101, 16, v101
  v_mfma_f32_16x16x32_bf16 v[52:55], v[228:231], a[160:163], v[52:55]
  v_mul_f32 v129, 0xbfb8aa3b, v98
  v_mul_f32 v130, 0xbfb8aa3b, v99
  v_mfma_f32_16x16x32_bf16 v[52:55], v[244:247], a[80:83], v[52:55]
  v_mul_f32 v131, 0xbfb8aa3b, v100
  v_mul_f32 v132, 0xbfb8aa3b, v101
  v_mfma_f32_16x16x32_bf16 v[56:59], v[244:247], a[84:87], v[56:59]
  v_exp_f32 v129, v129
  v_mfma_f32_16x16x32_bf16 v[56:59], v[228:231], a[164:167], v[56:59]
  v_exp_f32 v130, v130
  v_mfma_f32_16x16x32_bf16 v[60:63], v[228:231], a[168:171], v[60:63]
  v_exp_f32 v131, v131
  v_mfma_f32_16x16x32_bf16 v[60:63], v[244:247], a[88:91], v[60:63]
  v_exp_f32 v132, v132
  v_mfma_f32_16x16x32_bf16 v[64:67], v[232:235], a[152:155], v[64:67]
  v_add_f32 v129, 1.0, v129
  v_add_f32 v130, 1.0, v130
  v_mfma_f32_16x16x32_bf16 v[64:67], v[252:255], a[156:159], v[64:67]
  v_add_f32 v131, 1.0, v131
  v_add_f32 v132, 1.0, v132
  v_mfma_f32_16x16x32_bf16 v[68:71], v[252:255], a[160:163], v[68:71]
  v_rcp_f32 v129, v129
  v_mfma_f32_16x16x32_bf16 v[68:71], v[232:235], a[80:83], v[68:71]
  v_rcp_f32 v130, v130
  v_mfma_f32_16x16x32_bf16 v[72:75], v[232:235], a[84:87], v[72:75]
  v_rcp_f32 v131, v131
  v_mfma_f32_16x16x32_bf16 v[72:75], v[252:255], a[164:167], v[72:75]
  v_rcp_f32 v132, v132
  v_mfma_f32_16x16x32_bf16 v[76:79], v[252:255], a[168:171], v[76:79]
  v_mul_f32 v98, v98, v129
  v_mul_f32 v99, v99, v130
  v_mfma_f32_16x16x32_bf16 v[76:79], v[232:235], a[88:91], v[76:79]
  v_mul_f32 v100, v100, v131
  v_mul_f32 v101, v101, v132
  s_waitcnt vmcnt(36)
  v_mfma_f32_16x16x32_bf16 v[0:3], a[92:95], a[28:31], v[0:3]
  v_cvt_pk_bf16_f32 v98, v98, v98
  v_cvt_pk_bf16_f32 v99, v99, v99
  v_mfma_f32_16x16x32_bf16 v[0:3], a[172:175], a[12:15], v[0:3]
  v_cvt_pk_bf16_f32 v100, v100, v100
  v_cvt_pk_bf16_f32 v101, v101, v101
  v_mfma_f32_16x16x32_bf16 v[4:7], a[172:175], a[16:19], v[4:7]
  v_lshlrev_b32 v98, 16, v98
  v_lshlrev_b32 v99, 16, v99
  v_mfma_f32_16x16x32_bf16 v[4:7], a[92:95], a[32:35], v[4:7]
  v_lshlrev_b32 v100, 16, v100
  v_lshlrev_b32 v101, 16, v101
  v_mfma_f32_16x16x32_bf16 v[8:11], a[92:95], a[36:39], v[8:11]
  v_cvt_pk_bf16_f32 v168, v168, v168
  v_cvt_pk_bf16_f32 v169, v169, v169
  v_mfma_f32_16x16x32_bf16 v[8:11], a[172:175], a[184:187], v[8:11]
  v_cvt_pk_bf16_f32 v170, v170, v170
  v_cvt_pk_bf16_f32 v171, v171, v171
  v_mfma_f32_16x16x32_bf16 v[12:15], a[172:175], a[192:195], v[12:15]
  v_lshlrev_b32 v168, 16, v168
  v_lshlrev_b32 v169, 16, v169
  v_mfma_f32_16x16x32_bf16 v[12:15], a[92:95], a[188:191], v[12:15]
  v_lshlrev_b32 v170, 16, v170
  v_lshlrev_b32 v171, 16, v171
  v_mfma_f32_16x16x32_bf16 v[16:19], v[248:251], a[28:31], v[16:19]
  v_mul_f32 v168, v168, v124
  v_mul_f32 v169, v169, v124
  v_mfma_f32_16x16x32_bf16 v[16:19], a[176:179], a[12:15], v[16:19]
  v_mul_f32 v170, v170, v124
  v_mul_f32 v171, v171, v124
  v_mfma_f32_16x16x32_bf16 v[20:23], a[176:179], a[16:19], v[20:23]
  v_cvt_pk_bf16_f32 v168, v168, v168
  v_cvt_pk_bf16_f32 v169, v169, v169
  v_mfma_f32_16x16x32_bf16 v[20:23], v[248:251], a[32:35], v[20:23]
  v_cvt_pk_bf16_f32 v170, v170, v170
  v_cvt_pk_bf16_f32 v171, v171, v171
  v_mfma_f32_16x16x32_bf16 v[24:27], v[248:251], a[36:39], v[24:27]
  v_lshlrev_b32 v168, 16, v168
  v_lshlrev_b32 v169, 16, v169
  v_mfma_f32_16x16x32_bf16 v[24:27], a[176:179], a[184:187], v[24:27]
  v_lshlrev_b32 v170, 16, v170
  v_lshlrev_b32 v171, 16, v171
  v_mfma_f32_16x16x32_bf16 v[28:31], a[176:179], a[192:195], v[28:31]
  v_add_f32 v102, v102, v168
  v_add_f32 v103, v103, v169
  v_mfma_f32_16x16x32_bf16 v[28:31], v[248:251], a[188:191], v[28:31]
  v_add_f32 v104, v104, v170
  v_add_f32 v105, v105, v171
  v_mfma_f32_16x16x32_bf16 v[32:35], a[180:183], a[28:31], v[32:35]
  v_cvt_pk_bf16_f32 v102, v102, v102
  v_cvt_pk_bf16_f32 v103, v103, v103
  v_mfma_f32_16x16x32_bf16 v[32:35], a[0:3], a[12:15], v[32:35]
  v_cvt_pk_bf16_f32 v104, v104, v104
  v_cvt_pk_bf16_f32 v105, v105, v105
  v_mfma_f32_16x16x32_bf16 v[36:39], a[0:3], a[16:19], v[36:39]
  v_lshlrev_b32 v102, 16, v102
  v_lshlrev_b32 v103, 16, v103
  v_mfma_f32_16x16x32_bf16 v[36:39], a[180:183], a[32:35], v[36:39]
  v_lshlrev_b32 v104, 16, v104
  v_lshlrev_b32 v105, 16, v105
  v_mfma_f32_16x16x32_bf16 v[40:43], a[180:183], a[36:39], v[40:43]
  v_mul_f32 v129, 0xbfb8aa3b, v102
  v_mul_f32 v130, 0xbfb8aa3b, v103
  v_mfma_f32_16x16x32_bf16 v[40:43], a[0:3], a[184:187], v[40:43]
  v_mul_f32 v131, 0xbfb8aa3b, v104
  v_mul_f32 v132, 0xbfb8aa3b, v105
  v_mfma_f32_16x16x32_bf16 v[44:47], a[0:3], a[192:195], v[44:47]
  v_exp_f32 v129, v129
  v_mfma_f32_16x16x32_bf16 v[44:47], a[180:183], a[188:191], v[44:47]
  v_exp_f32 v130, v130
  v_mfma_f32_16x16x32_bf16 v[48:51], a[20:23], a[28:31], v[48:51]
  v_exp_f32 v131, v131
  v_mfma_f32_16x16x32_bf16 v[48:51], a[4:7], a[12:15], v[48:51]
  v_exp_f32 v132, v132
  v_mfma_f32_16x16x32_bf16 v[52:55], a[4:7], a[16:19], v[52:55]
  v_add_f32 v129, 1.0, v129
  v_add_f32 v130, 1.0, v130
  v_mfma_f32_16x16x32_bf16 v[52:55], a[20:23], a[32:35], v[52:55]
  v_add_f32 v131, 1.0, v131
  v_add_f32 v132, 1.0, v132
  v_mfma_f32_16x16x32_bf16 v[56:59], a[20:23], a[36:39], v[56:59]
  v_rcp_f32 v129, v129
  v_mfma_f32_16x16x32_bf16 v[56:59], a[4:7], a[184:187], v[56:59]
  v_rcp_f32 v130, v130
  v_mfma_f32_16x16x32_bf16 v[60:63], a[4:7], a[192:195], v[60:63]
  v_rcp_f32 v131, v131
  v_mfma_f32_16x16x32_bf16 v[60:63], a[20:23], a[188:191], v[60:63]
  v_rcp_f32 v132, v132
  v_mfma_f32_16x16x32_bf16 v[64:67], a[24:27], a[28:31], v[64:67]
  v_mul_f32 v102, v102, v129
  v_mul_f32 v103, v103, v130
  v_mfma_f32_16x16x32_bf16 v[64:67], a[8:11], a[12:15], v[64:67]
  v_mul_f32 v104, v104, v131
  v_mul_f32 v105, v105, v132
  v_mfma_f32_16x16x32_bf16 v[68:71], a[8:11], a[16:19], v[68:71]
  v_cvt_pk_bf16_f32 v102, v102, v102
  v_cvt_pk_bf16_f32 v103, v103, v103
  v_mfma_f32_16x16x32_bf16 v[68:71], a[24:27], a[32:35], v[68:71]
  v_cvt_pk_bf16_f32 v104, v104, v104
  v_cvt_pk_bf16_f32 v105, v105, v105
  v_mfma_f32_16x16x32_bf16 v[72:75], a[24:27], a[36:39], v[72:75]
  v_lshlrev_b32 v102, 16, v102
  v_lshlrev_b32 v103, 16, v103
  v_mfma_f32_16x16x32_bf16 v[72:75], a[8:11], a[184:187], v[72:75]
  v_lshlrev_b32 v104, 16, v104
  v_lshlrev_b32 v105, 16, v105
  v_mfma_f32_16x16x32_bf16 v[76:79], a[8:11], a[192:195], v[76:79]
  v_cvt_pk_bf16_f32 v172, v172, v172
  v_cvt_pk_bf16_f32 v173, v173, v173
  v_mfma_f32_16x16x32_bf16 v[76:79], a[24:27], a[188:191], v[76:79]
  v_cvt_pk_bf16_f32 v174, v174, v174
  v_cvt_pk_bf16_f32 v175, v175, v175
  s_waitcnt vmcnt(18)
  v_mfma_f32_16x16x32_bf16 v[0:3], a[196:199], a[68:71], v[0:3]
  v_lshlrev_b32 v172, 16, v172
  v_lshlrev_b32 v173, 16, v173
  v_mfma_f32_16x16x32_bf16 v[0:3], a[200:203], a[52:55], v[0:3]
  v_lshlrev_b32 v174, 16, v174
  v_lshlrev_b32 v175, 16, v175
  v_mfma_f32_16x16x32_bf16 v[4:7], a[200:203], a[56:59], v[4:7]
  v_mul_f32 v172, v172, v124
  v_mul_f32 v173, v173, v124
  v_mfma_f32_16x16x32_bf16 v[4:7], a[196:199], a[72:75], v[4:7]
  v_mul_f32 v174, v174, v124
  v_mul_f32 v175, v175, v124
  v_mfma_f32_16x16x32_bf16 v[8:11], a[196:199], a[76:79], v[8:11]
  v_cvt_pk_bf16_f32 v172, v172, v172
  v_cvt_pk_bf16_f32 v173, v173, v173
  v_mfma_f32_16x16x32_bf16 v[8:11], a[200:203], a[216:219], v[8:11]
  v_cvt_pk_bf16_f32 v174, v174, v174
  v_cvt_pk_bf16_f32 v175, v175, v175
  v_mfma_f32_16x16x32_bf16 v[12:15], a[200:203], a[224:227], v[12:15]
  v_lshlrev_b32 v172, 16, v172
  v_lshlrev_b32 v173, 16, v173
  v_mfma_f32_16x16x32_bf16 v[12:15], a[196:199], a[220:223], v[12:15]
  v_lshlrev_b32 v174, 16, v174
  v_lshlrev_b32 v175, 16, v175
  v_mfma_f32_16x16x32_bf16 v[16:19], a[204:207], a[68:71], v[16:19]
  v_add_f32 v106, v106, v172
  v_add_f32 v107, v107, v173
  v_mfma_f32_16x16x32_bf16 v[16:19], a[208:211], a[52:55], v[16:19]
  v_add_f32 v108, v108, v174
  v_add_f32 v109, v109, v175
  v_mfma_f32_16x16x32_bf16 v[20:23], a[208:211], a[56:59], v[20:23]
  v_cvt_pk_bf16_f32 v106, v106, v106
  v_cvt_pk_bf16_f32 v107, v107, v107
  v_mfma_f32_16x16x32_bf16 v[20:23], a[204:207], a[72:75], v[20:23]
  v_cvt_pk_bf16_f32 v108, v108, v108
  v_cvt_pk_bf16_f32 v109, v109, v109
  v_mfma_f32_16x16x32_bf16 v[24:27], a[204:207], a[76:79], v[24:27]
  v_lshlrev_b32 v106, 16, v106
  v_lshlrev_b32 v107, 16, v107
  v_mfma_f32_16x16x32_bf16 v[24:27], a[208:211], a[216:219], v[24:27]
  v_lshlrev_b32 v108, 16, v108
  v_lshlrev_b32 v109, 16, v109
  v_mfma_f32_16x16x32_bf16 v[28:31], a[208:211], a[224:227], v[28:31]
  v_mul_f32 v129, 0xbfb8aa3b, v106
  v_mul_f32 v130, 0xbfb8aa3b, v107
  v_mfma_f32_16x16x32_bf16 v[28:31], a[204:207], a[220:223], v[28:31]
  v_mul_f32 v131, 0xbfb8aa3b, v108
  v_mul_f32 v132, 0xbfb8aa3b, v109
  v_mfma_f32_16x16x32_bf16 v[32:35], a[212:215], a[68:71], v[32:35]
  v_exp_f32 v129, v129
  v_mfma_f32_16x16x32_bf16 v[32:35], a[40:43], a[52:55], v[32:35]
  v_exp_f32 v130, v130
  v_mfma_f32_16x16x32_bf16 v[36:39], a[40:43], a[56:59], v[36:39]
  v_exp_f32 v131, v131
  v_mfma_f32_16x16x32_bf16 v[36:39], a[212:215], a[72:75], v[36:39]
  v_exp_f32 v132, v132
  v_mfma_f32_16x16x32_bf16 v[40:43], a[212:215], a[76:79], v[40:43]
  v_add_f32 v129, 1.0, v129
  v_add_f32 v130, 1.0, v130
  v_mfma_f32_16x16x32_bf16 v[40:43], a[40:43], a[216:219], v[40:43]
  v_add_f32 v131, 1.0, v131
  v_add_f32 v132, 1.0, v132
  v_mfma_f32_16x16x32_bf16 v[44:47], a[40:43], a[224:227], v[44:47]
  v_rcp_f32 v129, v129
  v_mfma_f32_16x16x32_bf16 v[44:47], a[212:215], a[220:223], v[44:47]
  v_rcp_f32 v130, v130
  v_mfma_f32_16x16x32_bf16 v[48:51], a[60:63], a[68:71], v[48:51]
  v_rcp_f32 v131, v131
  v_mfma_f32_16x16x32_bf16 v[48:51], a[44:47], a[52:55], v[48:51]
  v_rcp_f32 v132, v132
  v_mfma_f32_16x16x32_bf16 v[52:55], a[44:47], a[56:59], v[52:55]
  v_mul_f32 v106, v106, v129
  v_mul_f32 v107, v107, v130
  v_mfma_f32_16x16x32_bf16 v[52:55], a[60:63], a[72:75], v[52:55]
  v_mul_f32 v108, v108, v131
  v_mul_f32 v109, v109, v132
  v_mfma_f32_16x16x32_bf16 v[56:59], a[60:63], a[76:79], v[56:59]
  v_cvt_pk_bf16_f32 v106, v106, v106
  v_cvt_pk_bf16_f32 v107, v107, v107
  v_mfma_f32_16x16x32_bf16 v[56:59], a[44:47], a[216:219], v[56:59]
  v_cvt_pk_bf16_f32 v108, v108, v108
  v_cvt_pk_bf16_f32 v109, v109, v109
  v_mfma_f32_16x16x32_bf16 v[60:63], a[44:47], a[224:227], v[60:63]
  v_lshlrev_b32 v106, 16, v106
  v_lshlrev_b32 v107, 16, v107
  v_mfma_f32_16x16x32_bf16 v[60:63], a[60:63], a[220:223], v[60:63]
  v_lshlrev_b32 v108, 16, v108
  v_lshlrev_b32 v109, 16, v109
  v_mfma_f32_16x16x32_bf16 v[64:67], a[64:67], a[68:71], v[64:67]
  v_mfma_f32_16x16x32_bf16 v[64:67], a[48:51], a[52:55], v[64:67]
  v_mfma_f32_16x16x32_bf16 v[68:71], a[48:51], a[56:59], v[68:71]
  v_mfma_f32_16x16x32_bf16 v[68:71], a[64:67], a[72:75], v[68:71]
  v_mfma_f32_16x16x32_bf16 v[72:75], a[64:67], a[76:79], v[72:75]
  v_mfma_f32_16x16x32_bf16 v[72:75], a[48:51], a[216:219], v[72:75]
  v_mfma_f32_16x16x32_bf16 v[76:79], a[48:51], a[224:227], v[76:79]
  v_mfma_f32_16x16x32_bf16 v[76:79], a[64:67], a[220:223], v[76:79]
  s_waitcnt vmcnt(0)
  v_mfma_f32_16x16x32_bf16 v[0:3], a[228:231], v[196:199], v[0:3]
  v_mfma_f32_16x16x32_bf16 v[0:3], a[232:235], v[184:187], v[0:3]
  v_mfma_f32_16x16x32_bf16 v[4:7], a[232:235], v[180:183], v[4:7]
  v_mfma_f32_16x16x32_bf16 v[4:7], a[228:231], v[204:207], v[4:7]
  v_mfma_f32_16x16x32_bf16 v[8:11], a[228:231], v[200:203], v[8:11]
  v_mfma_f32_16x16x32_bf16 v[8:11], a[232:235], v[188:191], v[8:11]
  v_mfma_f32_16x16x32_bf16 v[12:15], a[232:235], v[192:195], v[12:15]
  v_mfma_f32_16x16x32_bf16 v[12:15], a[228:231], v[208:211], v[12:15]
  v_mfma_f32_16x16x32_bf16 v[16:19], a[236:239], v[196:199], v[16:19]
  v_mfma_f32_16x16x32_bf16 v[16:19], a[240:243], v[184:187], v[16:19]
  v_mfma_f32_16x16x32_bf16 v[20:23], a[240:243], v[180:183], v[20:23]
  v_mfma_f32_16x16x32_bf16 v[20:23], a[236:239], v[204:207], v[20:23]
  v_mfma_f32_16x16x32_bf16 v[24:27], a[236:239], v[200:203], v[24:27]
  v_mfma_f32_16x16x32_bf16 v[24:27], a[240:243], v[188:191], v[24:27]
  v_mfma_f32_16x16x32_bf16 v[28:31], a[240:243], v[192:195], v[28:31]
  v_mfma_f32_16x16x32_bf16 v[28:31], a[236:239], v[208:211], v[28:31]
  v_mfma_f32_16x16x32_bf16 v[32:35], a[244:247], v[196:199], v[32:35]
  v_mfma_f32_16x16x32_bf16 v[32:35], a[96:99], v[184:187], v[32:35]
  v_mfma_f32_16x16x32_bf16 v[36:39], a[96:99], v[180:183], v[36:39]
  v_mfma_f32_16x16x32_bf16 v[36:39], a[244:247], v[204:207], v[36:39]
  v_mfma_f32_16x16x32_bf16 v[40:43], a[244:247], v[200:203], v[40:43]
  v_mfma_f32_16x16x32_bf16 v[40:43], a[96:99], v[188:191], v[40:43]
  v_mfma_f32_16x16x32_bf16 v[44:47], a[96:99], v[192:195], v[44:47]
  v_mfma_f32_16x16x32_bf16 v[44:47], a[244:247], v[208:211], v[44:47]
  v_mfma_f32_16x16x32_bf16 v[48:51], a[116:119], v[196:199], v[48:51]
  v_mfma_f32_16x16x32_bf16 v[48:51], a[248:251], v[184:187], v[48:51]
  v_mfma_f32_16x16x32_bf16 v[52:55], a[248:251], v[180:183], v[52:55]
  v_mfma_f32_16x16x32_bf16 v[52:55], a[116:119], v[204:207], v[52:55]
  v_mfma_f32_16x16x32_bf16 v[56:59], a[116:119], v[200:203], v[56:59]
  v_mfma_f32_16x16x32_bf16 v[56:59], a[248:251], v[188:191], v[56:59]
  v_mfma_f32_16x16x32_bf16 v[60:63], a[248:251], v[192:195], v[60:63]
  v_mfma_f32_16x16x32_bf16 v[60:63], a[116:119], v[208:211], v[60:63]
  v_mfma_f32_16x16x32_bf16 v[64:67], a[252:255], v[196:199], v[64:67]
  v_mfma_f32_16x16x32_bf16 v[64:67], v[176:179], v[184:187], v[64:67]
  v_mfma_f32_16x16x32_bf16 v[68:71], v[176:179], v[180:183], v[68:71]
  v_mfma_f32_16x16x32_bf16 v[68:71], a[252:255], v[204:207], v[68:71]
  v_mfma_f32_16x16x32_bf16 v[72:75], a[252:255], v[200:203], v[72:75]
  v_mfma_f32_16x16x32_bf16 v[72:75], v[176:179], v[188:191], v[72:75]
  v_mfma_f32_16x16x32_bf16 v[76:79], v[176:179], v[192:195], v[76:79]
  v_mfma_f32_16x16x32_bf16 v[76:79], a[252:255], v[208:211], v[76:79]
  ds_write_b128 v122, v[4:7] offset:0
  ds_write_b128 v122, v[20:23] offset:1024
  ds_write_b128 v122, v[36:39] offset:2048
  ds_write_b128 v122, v[52:55] offset:3072
  ds_write_b128 v122, v[68:71] offset:4096
  ds_write_b128 v122, v[8:11] offset:5120
  ds_write_b128 v122, v[24:27] offset:6144
  ds_write_b128 v122, v[40:43] offset:7168
  ds_write_b128 v122, v[56:59] offset:8192
  ds_write_b128 v122, v[72:75] offset:9216
  ds_write_b128 v122, v[12:15] offset:10240
  ds_write_b128 v122, v[28:31] offset:11264
  ds_write_b128 v122, v[44:47] offset:12288
  ds_write_b128 v122, v[60:63] offset:13312
  ds_write_b128 v122, v[76:79] offset:14336
  s_waitcnt lgkmcnt(0)
  s_barrier
  ds_read_b128 v[176:179], v119 offset:0
  ds_read_b128 v[180:183], v120 offset:0
  ds_read_b128 v[184:187], v121 offset:0
  ds_read_b128 v[188:191], v119 offset:1024
  ds_read_b128 v[192:195], v120 offset:1024
  ds_read_b128 v[196:199], v121 offset:1024
  ds_read_b128 v[200:203], v119 offset:2048
  ds_read_b128 v[204:207], v120 offset:2048
  ds_read_b128 v[208:211], v121 offset:2048
  ds_read_b128 v[212:215], v119 offset:3072
  ds_read_b128 v[216:219], v120 offset:3072
  ds_read_b128 v[220:223], v121 offset:3072
  ds_read_b128 v[224:227], v119 offset:4096
  ds_read_b128 v[228:231], v120 offset:4096
  ds_read_b128 v[232:235], v121 offset:4096
  v_lshlrev_b32 v156, 16, v80
  v_and_b32 v157, s34, v80
  v_lshlrev_b32 v158, 16, v81
  v_and_b32 v159, s34, v81
  v_lshlrev_b32 v160, 16, v82
  v_and_b32 v161, s34, v82
  v_lshlrev_b32 v162, 16, v83
  v_and_b32 v163, s34, v83
  v_lshlrev_b32 v164, 16, v84
  v_and_b32 v165, s34, v84
  v_lshlrev_b32 v166, 16, v85
  v_and_b32 v167, s34, v85
  v_lshlrev_b32 v168, 16, v86
  v_and_b32 v169, s34, v86
  v_lshlrev_b32 v170, 16, v87
  v_and_b32 v171, s34, v87
  v_lshlrev_b32 v172, 16, v88
  v_and_b32 v173, s34, v88
  v_lshlrev_b32 v174, 16, v89
  v_and_b32 v175, s34, v89
  s_waitcnt lgkmcnt(13)
  v_add_f32 v176, v176, v180
  s_waitcnt lgkmcnt(12)
  v_add_f32 v0, v0, v184
  v_add_f32 v177, v177, v181
  v_add_f32 v1, v1, v185
  v_add_f32 v178, v178, v182
  v_add_f32 v2, v2, v186
  v_add_f32 v179, v179, v183
  v_add_f32 v3, v3, v187
  v_add_f32 v0, v0, v176
  v_add_f32 v1, v1, v177
  v_add_f32 v2, v2, v178
  v_add_f32 v3, v3, v179
  v_cvt_pk_bf16_f32 v176, v0, v1
  v_cvt_pk_bf16_f32 v177, v2, v3
  v_lshlrev_b32 v0, 16, v176
  v_and_b32 v1, s34, v176
  v_lshlrev_b32 v2, 16, v177
  v_and_b32 v3, s34, v177
  v_mul_f32 v0, v0, v90
  v_mul_f32 v1, v1, v91
  v_mul_f32 v2, v2, v92
  v_mul_f32 v3, v3, v93
  v_cvt_pk_bf16_f32 v176, v0, v1
  v_cvt_pk_bf16_f32 v177, v2, v3
  v_lshlrev_b32 v0, 16, v176
  v_and_b32 v1, s34, v176
  v_lshlrev_b32 v2, 16, v177
  v_and_b32 v3, s34, v177
  v_add_f32 v0, v0, v156
  v_add_f32 v1, v1, v157
  v_add_f32 v2, v2, v158
  v_add_f32 v3, v3, v159
  v_cvt_pk_bf16_f32 v176, v0, v1
  v_cvt_pk_bf16_f32 v177, v2, v3
  buffer_store_dwordx2 v[176:177], v117, s[16:19], 0 offen offset:0
  s_waitcnt lgkmcnt(10)
  v_add_f32 v188, v188, v192
  s_waitcnt lgkmcnt(9)
  v_add_f32 v16, v16, v196
  v_add_f32 v189, v189, v193
  v_add_f32 v17, v17, v197
  v_add_f32 v190, v190, v194
  v_add_f32 v18, v18, v198
  v_add_f32 v191, v191, v195
  v_add_f32 v19, v19, v199
  v_add_f32 v16, v16, v188
  v_add_f32 v17, v17, v189
  v_add_f32 v18, v18, v190
  v_add_f32 v19, v19, v191
  v_cvt_pk_bf16_f32 v188, v16, v17
  v_cvt_pk_bf16_f32 v189, v18, v19
  v_lshlrev_b32 v16, 16, v188
  v_and_b32 v17, s34, v188
  v_lshlrev_b32 v18, 16, v189
  v_and_b32 v19, s34, v189
  v_mul_f32 v16, v16, v94
  v_mul_f32 v17, v17, v95
  v_mul_f32 v18, v18, v96
  v_mul_f32 v19, v19, v97
  v_cvt_pk_bf16_f32 v188, v16, v17
  v_cvt_pk_bf16_f32 v189, v18, v19
  v_lshlrev_b32 v16, 16, v188
  v_and_b32 v17, s34, v188
  v_lshlrev_b32 v18, 16, v189
  v_and_b32 v19, s34, v189
  v_add_f32 v16, v16, v160
  v_add_f32 v17, v17, v161
  v_add_f32 v18, v18, v162
  v_add_f32 v19, v19, v163
  v_cvt_pk_bf16_f32 v188, v16, v17
  v_cvt_pk_bf16_f32 v189, v18, v19
  buffer_store_dwordx2 v[188:189], v117, s[16:19], 0 offen offset:32
  s_waitcnt lgkmcnt(7)
  v_add_f32 v200, v200, v204
  s_waitcnt lgkmcnt(6)
  v_add_f32 v32, v32, v208
  v_add_f32 v201, v201, v205
  v_add_f32 v33, v33, v209
  v_add_f32 v202, v202, v206
  v_add_f32 v34, v34, v210
  v_add_f32 v203, v203, v207
  v_add_f32 v35, v35, v211
  v_add_f32 v32, v32, v200
  v_add_f32 v33, v33, v201
  v_add_f32 v34, v34, v202
  v_add_f32 v35, v35, v203
  v_cvt_pk_bf16_f32 v200, v32, v33
  v_cvt_pk_bf16_f32 v201, v34, v35
  v_lshlrev_b32 v32, 16, v200
  v_and_b32 v33, s34, v200
  v_lshlrev_b32 v34, 16, v201
  v_and_b32 v35, s34, v201
  v_mul_f32 v32, v32, v98
  v_mul_f32 v33, v33, v99
  v_mul_f32 v34, v34, v100
  v_mul_f32 v35, v35, v101
  v_cvt_pk_bf16_f32 v200, v32, v33
  v_cvt_pk_bf16_f32 v201, v34, v35
  v_lshlrev_b32 v32, 16, v200
  v_and_b32 v33, s34, v200
  v_lshlrev_b32 v34, 16, v201
  v_and_b32 v35, s34, v201
  v_add_f32 v32, v32, v164
  v_add_f32 v33, v33, v165
  v_add_f32 v34, v34, v166
  v_add_f32 v35, v35, v167
  v_cvt_pk_bf16_f32 v200, v32, v33
  v_cvt_pk_bf16_f32 v201, v34, v35
  buffer_store_dwordx2 v[200:201], v117, s[16:19], 0 offen offset:64
  s_waitcnt lgkmcnt(4)
  v_add_f32 v212, v212, v216
  s_waitcnt lgkmcnt(3)
  v_add_f32 v48, v48, v220
  v_add_f32 v213, v213, v217
  v_add_f32 v49, v49, v221
  v_add_f32 v214, v214, v218
  v_add_f32 v50, v50, v222
  v_add_f32 v215, v215, v219
  v_add_f32 v51, v51, v223
  v_add_f32 v48, v48, v212
  v_add_f32 v49, v49, v213
  v_add_f32 v50, v50, v214
  v_add_f32 v51, v51, v215
  v_cvt_pk_bf16_f32 v212, v48, v49
  v_cvt_pk_bf16_f32 v213, v50, v51
  v_lshlrev_b32 v48, 16, v212
  v_and_b32 v49, s34, v212
  v_lshlrev_b32 v50, 16, v213
  v_and_b32 v51, s34, v213
  v_mul_f32 v48, v48, v102
  v_mul_f32 v49, v49, v103
  v_mul_f32 v50, v50, v104
  v_mul_f32 v51, v51, v105
  v_cvt_pk_bf16_f32 v212, v48, v49
  v_cvt_pk_bf16_f32 v213, v50, v51
  v_lshlrev_b32 v48, 16, v212
  v_and_b32 v49, s34, v212
  v_lshlrev_b32 v50, 16, v213
  v_and_b32 v51, s34, v213
  v_add_f32 v48, v48, v168
  v_add_f32 v49, v49, v169
  v_add_f32 v50, v50, v170
  v_add_f32 v51, v51, v171
  v_cvt_pk_bf16_f32 v212, v48, v49
  v_cvt_pk_bf16_f32 v213, v50, v51
  buffer_store_dwordx2 v[212:213], v117, s[16:19], 0 offen offset:96
  s_waitcnt lgkmcnt(1)
  v_add_f32 v224, v224, v228
  s_waitcnt lgkmcnt(0)
  v_add_f32 v64, v64, v232
  v_add_f32 v225, v225, v229
  v_add_f32 v65, v65, v233
  v_add_f32 v226, v226, v230
  v_add_f32 v66, v66, v234
  v_add_f32 v227, v227, v231
  v_add_f32 v67, v67, v235
  v_add_f32 v64, v64, v224
  v_add_f32 v65, v65, v225
  v_add_f32 v66, v66, v226
  v_add_f32 v67, v67, v227
  v_cvt_pk_bf16_f32 v224, v64, v65
  v_cvt_pk_bf16_f32 v225, v66, v67
  v_lshlrev_b32 v64, 16, v224
  v_and_b32 v65, s34, v224
  v_lshlrev_b32 v66, 16, v225
  v_and_b32 v67, s34, v225
  v_mul_f32 v64, v64, v106
  v_mul_f32 v65, v65, v107
  v_mul_f32 v66, v66, v108
  v_mul_f32 v67, v67, v109
  v_cvt_pk_bf16_f32 v224, v64, v65
  v_cvt_pk_bf16_f32 v225, v66, v67
  v_lshlrev_b32 v64, 16, v224
  v_and_b32 v65, s34, v224
  v_lshlrev_b32 v66, 16, v225
  v_and_b32 v67, s34, v225
  v_add_f32 v64, v64, v172
  v_add_f32 v65, v65, v173
  v_add_f32 v66, v66, v174
  v_add_f32 v67, v67, v175
  v_cvt_pk_bf16_f32 v224, v64, v65
  v_cvt_pk_bf16_f32 v225, v66, v67
  buffer_store_dwordx2 v[224:225], v117, s[16:19], 0 offen offset:128
attn_end:
  s_endpgm
attn_redo:
  s_waitcnt vmcnt(0)
  v_accvgpr_write_b32 a0, 0
  v_accvgpr_write_b32 a1, 0
  v_accvgpr_write_b32 a2, 0
  v_accvgpr_write_b32 a3, 0
  v_accvgpr_write_b32 a4, 0
  v_accvgpr_write_b32 a5, 0
  v_accvgpr_write_b32 a6, 0
  v_accvgpr_write_b32 a7, 0
  v_accvgpr_write_b32 a8, 0
  v_accvgpr_write_b32 a9, 0
  v_accvgpr_write_b32 a10, 0
  v_accvgpr_write_b32 a11, 0
  v_accvgpr_write_b32 a12, 0
  v_accvgpr_write_b32 a13, 0
  v_accvgpr_write_b32 a14, 0
  v_accvgpr_write_b32 a15, 0
  v_accvgpr_write_b32 a16, 0
  v_accvgpr_write_b32 a17, 0
  v_accvgpr_write_b32 a18, 0
  v_accvgpr_write_b32 a19, 0
  v_accvgpr_write_b32 a20, 0
  v_accvgpr_write_b32 a21, 0
  v_accvgpr_write_b32 a22, 0
  v_accvgpr_write_b32 a23, 0
  v_accvgpr_write_b32 a24, 0
  v_accvgpr_write_b32 a25, 0
  v_accvgpr_write_b32 a26, 0
  v_accvgpr_write_b32 a27, 0
  v_accvgpr_write_b32 a28, 0
  v_accvgpr_write_b32 a29, 0
  v_accvgpr_write_b32 a30, 0
  v_accvgpr_write_b32 a31, 0
  v_accvgpr_write_b32 a32, 0
  v_accvgpr_write_b32 a33, 0
  v_accvgpr_write_b32 a34, 0
  v_accvgpr_write_b32 a35, 0
  v_accvgpr_write_b32 a36, 0
  v_accvgpr_write_b32 a37, 0
  v_accvgpr_write_b32 a38, 0
  v_accvgpr_write_b32 a39, 0
  v_accvgpr_write_b32 a40, 0
  v_accvgpr_write_b32 a41, 0
  v_accvgpr_write_b32 a42, 0
  v_accvgpr_write_b32 a43, 0
  v_accvgpr_write_b32 a44, 0
  v_accvgpr_write_b32 a45, 0
  v_accvgpr_write_b32 a46, 0
  v_accvgpr_write_b32 a47, 0
  v_accvgpr_write_b32 a48, 0
  v_accvgpr_write_b32 a49, 0
  v_accvgpr_write_b32 a50, 0
  v_accvgpr_write_b32 a51, 0
  v_accvgpr_write_b32 a52, 0
  v_accvgpr_write_b32 a53, 0
  v_accvgpr_write_b32 a54, 0
  v_accvgpr_write_b32 a55, 0
  v_accvgpr_write_b32 a56, 0
  v_accvgpr_write_b32 a57, 0
  v_accvgpr_write_b32 a58, 0
  v_accvgpr_write_b32 a59, 0
  v_accvgpr_write_b32 a60, 0
  v_accvgpr_write_b32 a61, 0
  v_accvgpr_write_b32 a62, 0
  v_accvgpr_write_b32 a63, 0
  v_accvgpr_write_b32 a64, 0
  v_accvgpr_write_b32 a65, 0
  v_accvgpr_write_b32 a66, 0
  v_accvgpr_write_b32 a67, 0
  v_accvgpr_write_b32 a68, 0
  v_accvgpr_write_b32 a69, 0
  v_accvgpr_write_b32 a70, 0
  v_accvgpr_write_b32 a71, 0
  v_accvgpr_write_b32 a72, 0
  v_accvgpr_write_b32 a73, 0
  v_accvgpr_write_b32 a74, 0
  v_accvgpr_write_b32 a75, 0
  v_accvgpr_write_b32 a76, 0
  v_accvgpr_write_b32 a77, 0
  v_accvgpr_write_b32 a78, 0
  v_accvgpr_write_b32 a79, 0
  v_accvgpr_write_b32 a80, 0
  v_accvgpr_write_b32 a81, 0
  v_accvgpr_write_b32 a82, 0
  v_accvgpr_write_b32 a83, 0
  v_accvgpr_write_b32 a84, 0
  v_accvgpr_write_b32 a85, 0
  v_accvgpr_write_b32 a86, 0
  v_accvgpr_write_b32 a87, 0
  v_accvgpr_write_b32 a88, 0
  v_accvgpr_write_b32 a89, 0
  v_accvgpr_write_b32 a90, 0
  v_accvgpr_write_b32 a91, 0
  v_accvgpr_write_b32 a92, 0
  v_accvgpr_write_b32 a93, 0
  v_accvgpr_write_b32 a94, 0
  v_accvgpr_write_b32 a95, 0
  v_accvgpr_write_b32 a96, 0
  v_accvgpr_write_b32 a97, 0
  v_accvgpr_write_b32 a98, 0
  v_accvgpr_write_b32 a99, 0
  v_accvgpr_write_b32 a100, 0
  v_accvgpr_write_b32 a101, 0
  v_accvgpr_write_b32 a102, 0
  v_accvgpr_write_b32 a103, 0
  v_accvgpr_write_b32 a104, 0
  v_accvgpr_write_b32 a105, 0
  v_accvgpr_write_b32 a106, 0
  v_accvgpr_write_b32 a107, 0
  v_accvgpr_write_b32 a108, 0
  v_accvgpr_write_b32 a109, 0
  v_accvgpr_write_b32 a110, 0
  v_accvgpr_write_b32 a111, 0
  v_accvgpr_write_b32 a112, 0
  v_accvgpr_write_b32 a113, 0
  v_accvgpr_write_b32 a114, 0
  v_accvgpr_write_b32 a115, 0
  v_accvgpr_write_b32 a116, 0
  v_accvgpr_write_b32 a117, 0
  v_accvgpr_write_b32 a118, 0
  v_accvgpr_write_b32 a119, 0
  v_accvgpr_write_b32 a120, 0
  v_accvgpr_write_b32 a121, 0
  v_accvgpr_write_b32 a122, 0
  v_accvgpr_write_b32 a123, 0
  v_accvgpr_write_b32 a124, 0
  v_accvgpr_write_b32 a125, 0
  v_accvgpr_write_b32 a126, 0
  v_accvgpr_write_b32 a127, 0
  v_mov_b32 v208, 0
  v_mov_b32 v249, 0xff800000
  v_mov_b32 v209, 0
  v_mov_b32 v250, 0xff800000
  v_mov_b32 v210, 0
  v_mov_b32 v251, 0xff800000
  v_mov_b32 v211, 0
  v_mov_b32 v252, 0xff800000
  s_mov_b32 s29, 0
attn_slow:
  s_barrier
  s_add_u32 m0, s28, 0
  s_nop 0
  buffer_load_dwordx4 v232, s[12:15], s29 offen offset:0 lds
  buffer_load_dwordx4 v233, s[12:15], s29 offen offset:1024 lds
  buffer_load_dwordx4 v234, s[12:15], s29 offen offset:2048 lds
  buffer_load_dwordx4 v235, s[12:15], s29 offen offset:3072 lds
  s_add_u32 m0, s28, 65536
  s_nop 0
  buffer_load_dwordx4 v236, s[16:19], s29 offen offset:0 lds
  buffer_load_dwordx4 v237, s[16:19], s29 offen offset:1024 lds
  buffer_load_dwordx4 v236, s[16:19], s29 offen offset:2048 lds
  buffer_load_dwordx4 v237, s[16:19], s29 offen offset:3072 lds
  s_waitcnt vmcnt(0)
  s_barrier
  ds_read_b128 a[128:131], v212 offset:0
  ds_read_b128 a[132:135], v213 offset:0
  ds_read_b128 a[136:139], v214 offset:0
  ds_read_b128 a[140:143], v215 offset:0
  s_waitcnt lgkmcnt(3)
  v_mfma_f32_16x16x32_bf16 v[0:3], a[128:131], v[128:131], 0
  s_waitcnt lgkmcnt(2)
  v_mfma_f32_16x16x32_bf16 v[0:3], a[132:135], v[132:135], v[0:3]
  s_waitcnt lgkmcnt(1)
  v_mfma_f32_16x16x32_bf16 v[0:3], a[136:139], v[136:139], v[0:3]
  s_waitcnt lgkmcnt(0)
  v_mfma_f32_16x16x32_bf16 v[0:3], a[140:143], v[140:143], v[0:3]
  v_mfma_f32_16x16x32_bf16 v[8:11], a[140:143], v[156:159], 0
  v_mfma_f32_16x16x32_bf16 v[8:11], a[136:139], v[152:155], v[8:11]
  v_mfma_f32_16x16x32_bf16 v[8:11], a[132:135], v[148:151], v[8:11]
  v_mfma_f32_16x16x32_bf16 v[8:11], a[128:131], v[144:147], v[8:11]
  v_mfma_f32_16x16x32_bf16 v[16:19], a[128:131], v[160:163], 0
  v_mfma_f32_16x16x32_bf16 v[16:19], a[132:135], v[164:167], v[16:19]
  v_mfma_f32_16x16x32_bf16 v[16:19], a[136:139], v[168:171], v[16:19]
  v_mfma_f32_16x16x32_bf16 v[16:19], a[140:143], v[172:175], v[16:19]
  v_mfma_f32_16x16x32_bf16 v[24:27], a[140:143], v[188:191], 0
  v_mfma_f32_16x16x32_bf16 v[24:27], a[136:139], v[184:187], v[24:27]
  v_mfma_f32_16x16x32_bf16 v[24:27], a[132:135], v[180:183], v[24:27]
  v_mfma_f32_16x16x32_bf16 v[24:27], a[128:131], v[176:179], v[24:27]
  ds_read_b128 a[144:147], v212 offset:4096
  ds_read_b128 a[148:151], v213 offset:4096
  ds_read_b128 a[152:155], v214 offset:4096
  ds_read_b128 a[156:159], v215 offset:4096
  s_waitcnt lgkmcnt(3)
  v_mfma_f32_16x16x32_bf16 v[4:7], a[144:147], v[128:131], 0
  s_waitcnt lgkmcnt(2)
  v_mfma_f32_16x16x32_bf16 v[4:7], a[148:151], v[132:135], v[4:7]
  s_waitcnt lgkmcnt(1)
  v_mfma_f32_16x16x32_bf16 v[4:7], a[152:155], v[136:139], v[4:7]
  s_waitcnt lgkmcnt(0)
  v_mfma_f32_16x16x32_bf16 v[4:7], a[156:159], v[140:143], v[4:7]
  v_mfma_f32_16x16x32_bf16 v[12:15], a[156:159], v[156:159], 0
  v_mfma_f32_16x16x32_bf16 v[12:15], a[152:155], v[152:155], v[12:15]
  v_mfma_f32_16x16x32_bf16 v[12:15], a[148:151], v[148:151], v[12:15]
  v_mfma_f32_16x16x32_bf16 v[12:15], a[144:147], v[144:147], v[12:15]
  v_mfma_f32_16x16x32_bf16 v[20:23], a[144:147], v[160:163], 0
  v_mfma_f32_16x16x32_bf16 v[20:23], a[148:151], v[164:167], v[20:23]
  v_mfma_f32_16x16x32_bf16 v[20:23], a[152:155], v[168:171], v[20:23]
  v_mfma_f32_16x16x32_bf16 v[20:23], a[156:159], v[172:175], v[20:23]
  v_mfma_f32_16x16x32_bf16 v[28:31], a[156:159], v[188:191], 0
  v_mfma_f32_16x16x32_bf16 v[28:31], a[152:155], v[184:187], v[28:31]
  v_mfma_f32_16x16x32_bf16 v[28:31], a[148:151], v[180:183], v[28:31]
  v_mfma_f32_16x16x32_bf16 v[28:31], a[144:147], v[176:179], v[28:31]
  ds_read_b128 a[128:131], v212 offset:8192
  ds_read_b128 a[132:135], v213 offset:8192
  ds_read_b128 a[136:139], v214 offset:8192
  ds_read_b128 a[140:143], v215 offset:8192
  s_waitcnt lgkmcnt(3)
  v_mfma_f32_16x16x32_bf16 v[32:35], a[128:131], v[128:131], 0
  s_waitcnt lgkmcnt(2)
  v_mfma_f32_16x16x32_bf16 v[32:35], a[132:135], v[132:135], v[32:35]
  s_waitcnt lgkmcnt(1)
  v_mfma_f32_16x16x32_bf16 v[32:35], a[136:139], v[136:139], v[32:35]
  s_waitcnt lgkmcnt(0)
  v_mfma_f32_16x16x32_bf16 v[32:35], a[140:143], v[140:143], v[32:35]
  v_mfma_f32_16x16x32_bf16 v[40:43], a[140:143], v[156:159], 0
  v_mfma_f32_16x16x32_bf16 v[40:43], a[136:139], v[152:155], v[40:43]
  v_mfma_f32_16x16x32_bf16 v[40:43], a[132:135], v[148:151], v[40:43]
  v_mfma_f32_16x16x32_bf16 v[40:43], a[128:131], v[144:147], v[40:43]
  v_mfma_f32_16x16x32_bf16 v[48:51], a[128:131], v[160:163], 0
  v_mfma_f32_16x16x32_bf16 v[48:51], a[132:135], v[164:167], v[48:51]
  v_mfma_f32_16x16x32_bf16 v[48:51], a[136:139], v[168:171], v[48:51]
  v_mfma_f32_16x16x32_bf16 v[48:51], a[140:143], v[172:175], v[48:51]
  v_mfma_f32_16x16x32_bf16 v[56:59], a[140:143], v[188:191], 0
  v_mfma_f32_16x16x32_bf16 v[56:59], a[136:139], v[184:187], v[56:59]
  v_mfma_f32_16x16x32_bf16 v[56:59], a[132:135], v[180:183], v[56:59]
  v_mfma_f32_16x16x32_bf16 v[56:59], a[128:131], v[176:179], v[56:59]
  ds_read_b128 a[144:147], v212 offset:12288
  ds_read_b128 a[148:151], v213 offset:12288
  ds_read_b128 a[152:155], v214 offset:12288
  ds_read_b128 a[156:159], v215 offset:12288
  s_waitcnt lgkmcnt(3)
  v_mfma_f32_16x16x32_bf16 v[36:39], a[144:147], v[128:131], 0
  s_waitcnt lgkmcnt(2)
  v_mfma_f32_16x16x32_bf16 v[36:39], a[148:151], v[132:135], v[36:39]
  s_waitcnt lgkmcnt(1)
  v_mfma_f32_16x16x32_bf16 v[36:39], a[152:155], v[136:139], v[36:39]
  s_waitcnt lgkmcnt(0)
  v_mfma_f32_16x16x32_bf16 v[36:39], a[156:159], v[140:143], v[36:39]
  v_mfma_f32_16x16x32_bf16 v[44:47], a[156:159], v[156:159], 0
  v_mfma_f32_16x16x32_bf16 v[44:47], a[152:155], v[152:155], v[44:47]
  v_mfma_f32_16x16x32_bf16 v[44:47], a[148:151], v[148:151], v[44:47]
  v_mfma_f32_16x16x32_bf16 v[44:47], a[144:147], v[144:147], v[44:47]
  v_mfma_f32_16x16x32_bf16 v[52:55], a[144:147], v[160:163], 0
  v_mfma_f32_16x16x32_bf16 v[52:55], a[148:151], v[164:167], v[52:55]
  v_mfma_f32_16x16x32_bf16 v[52:55], a[152:155], v[168:171], v[52:55]
  v_mfma_f32_16x16x32_bf16 v[52:55], a[156:159], v[172:175], v[52:55]
  v_mfma_f32_16x16x32_bf16 v[60:63], a[156:159], v[188:191], 0
  v_mfma_f32_16x16x32_bf16 v[60:63], a[152:155], v[184:187], v[60:63]
  v_mfma_f32_16x16x32_bf16 v[60:63], a[148:151], v[180:183], v[60:63]
  v_mfma_f32_16x16x32_bf16 v[60:63], a[144:147], v[176:179], v[60:63]
  v_mov_b32 v192, v249
  v_max3_f32 v192, v192, v0, v1
  v_max3_f32 v192, v192, v2, v3
  v_max3_f32 v192, v192, v4, v5
  v_max3_f32 v192, v192, v6, v7
  v_max3_f32 v192, v192, v32, v33
  v_max3_f32 v192, v192, v34, v35
  v_max3_f32 v192, v192, v36, v37
  v_max3_f32 v192, v192, v38, v39
  v_mov_b32 v245, v192
  s_nop 1
  v_permlane16_swap_b32 v192, v245
  v_max_f32 v192, v192, v245
  v_mov_b32 v245, v192
  s_nop 1
  v_permlane32_swap_b32 v192, v245
  v_max_f32 v192, v192, v245
  v_sub_f32 v193, v249, v192
  v_exp_f32 v193, v193
  v_mov_b32 v249, v192
  v_mul_f32 v208, v208, v193
  v_sub_f32 v0, v0, v192
  v_sub_f32 v1, v1, v192
  v_sub_f32 v2, v2, v192
  v_sub_f32 v3, v3, v192
  v_sub_f32 v4, v4, v192
  v_sub_f32 v5, v5, v192
  v_sub_f32 v6, v6, v192
  v_sub_f32 v7, v7, v192
  v_sub_f32 v32, v32, v192
  v_sub_f32 v33, v33, v192
  v_sub_f32 v34, v34, v192
  v_sub_f32 v35, v35, v192
  v_sub_f32 v36, v36, v192
  v_sub_f32 v37, v37, v192
  v_sub_f32 v38, v38, v192
  v_sub_f32 v39, v39, v192
  v_exp_f32 v0, v0
  v_exp_f32 v1, v1
  v_add_f32 v208, v208, v0
  v_exp_f32 v2, v2
  v_add_f32 v208, v208, v1
  v_cvt_pk_bf16_f32 v0, v0, v1
  v_exp_f32 v3, v3
  v_add_f32 v208, v208, v2
  v_add_f32 v208, v208, v3
  v_cvt_pk_bf16_f32 v1, v2, v3
  v_exp_f32 v4, v4
  v_exp_f32 v5, v5
  v_add_f32 v208, v208, v4
  v_exp_f32 v6, v6
  v_add_f32 v208, v208, v5
  v_cvt_pk_bf16_f32 v2, v4, v5
  v_exp_f32 v7, v7
  v_add_f32 v208, v208, v6
  v_add_f32 v208, v208, v7
  v_cvt_pk_bf16_f32 v3, v6, v7
  v_exp_f32 v32, v32
  v_exp_f32 v33, v33
  v_add_f32 v208, v208, v32
  v_exp_f32 v34, v34
  v_add_f32 v208, v208, v33
  v_cvt_pk_bf16_f32 v32, v32, v33
  v_exp_f32 v35, v35
  v_add_f32 v208, v208, v34
  v_add_f32 v208, v208, v35
  v_cvt_pk_bf16_f32 v33, v34, v35
  v_exp_f32 v36, v36
  v_exp_f32 v37, v37
  v_add_f32 v208, v208, v36
  v_exp_f32 v38, v38
  v_add_f32 v208, v208, v37
  v_cvt_pk_bf16_f32 v34, v36, v37
  v_exp_f32 v39, v39
  v_add_f32 v208, v208, v38
  v_add_f32 v208, v208, v39
  v_cvt_pk_bf16_f32 v35, v38, v39
  v_accvgpr_read_b32 v64, a0
  v_accvgpr_read_b32 v65, a1
  v_accvgpr_read_b32 v66, a2
  v_accvgpr_read_b32 v67, a3
  v_mul_f32 v64, v64, v193
  v_mul_f32 v65, v65, v193
  v_mul_f32 v66, v66, v193
  v_mul_f32 v67, v67, v193
  v_accvgpr_write_b32 a0, v64
  v_accvgpr_write_b32 a1, v65
  v_accvgpr_write_b32 a2, v66
  v_accvgpr_write_b32 a3, v67
  v_accvgpr_read_b32 v64, a16
  v_accvgpr_read_b32 v65, a17
  v_accvgpr_read_b32 v66, a18
  v_accvgpr_read_b32 v67, a19
  v_mul_f32 v64, v64, v193
  v_mul_f32 v65, v65, v193
  v_mul_f32 v66, v66, v193
  v_mul_f32 v67, v67, v193
  v_accvgpr_write_b32 a16, v64
  v_accvgpr_write_b32 a17, v65
  v_accvgpr_write_b32 a18, v66
  v_accvgpr_write_b32 a19, v67
  v_accvgpr_read_b32 v64, a32
  v_accvgpr_read_b32 v65, a33
  v_accvgpr_read_b32 v66, a34
  v_accvgpr_read_b32 v67, a35
  v_mul_f32 v64, v64, v193
  v_mul_f32 v65, v65, v193
  v_mul_f32 v66, v66, v193
  v_mul_f32 v67, v67, v193
  v_accvgpr_write_b32 a32, v64
  v_accvgpr_write_b32 a33, v65
  v_accvgpr_write_b32 a34, v66
  v_accvgpr_write_b32 a35, v67
  v_accvgpr_read_b32 v64, a48
  v_accvgpr_read_b32 v65, a49
  v_accvgpr_read_b32 v66, a50
  v_accvgpr_read_b32 v67, a51
  v_mul_f32 v64, v64, v193
  v_mul_f32 v65, v65, v193
  v_mul_f32 v66, v66, v193
  v_mul_f32 v67, v67, v193
  v_accvgpr_write_b32 a48, v64
  v_accvgpr_write_b32 a49, v65
  v_accvgpr_write_b32 a50, v66
  v_accvgpr_write_b32 a51, v67
  v_accvgpr_read_b32 v64, a64
  v_accvgpr_read_b32 v65, a65
  v_accvgpr_read_b32 v66, a66
  v_accvgpr_read_b32 v67, a67
  v_mul_f32 v64, v64, v193
  v_mul_f32 v65, v65, v193
  v_mul_f32 v66, v66, v193
  v_mul_f32 v67, v67, v193
  v_accvgpr_write_b32 a64, v64
  v_accvgpr_write_b32 a65, v65
  v_accvgpr_write_b32 a66, v66
  v_accvgpr_write_b32 a67, v67
  v_accvgpr_read_b32 v64, a80
  v_accvgpr_read_b32 v65, a81
  v_accvgpr_read_b32 v66, a82
  v_accvgpr_read_b32 v67, a83
  v_mul_f32 v64, v64, v193
  v_mul_f32 v65, v65, v193
  v_mul_f32 v66, v66, v193
  v_mul_f32 v67, v67, v193
  v_accvgpr_write_b32 a80, v64
  v_accvgpr_write_b32 a81, v65
  v_accvgpr_write_b32 a82, v66
  v_accvgpr_write_b32 a83, v67
  v_accvgpr_read_b32 v64, a96
  v_accvgpr_read_b32 v65, a97
  v_accvgpr_read_b32 v66, a98
  v_accvgpr_read_b32 v67, a99
  v_mul_f32 v64, v64, v193
  v_mul_f32 v65, v65, v193
  v_mul_f32 v66, v66, v193
  v_mul_f32 v67, v67, v193
  v_accvgpr_write_b32 a96, v64
  v_accvgpr_write_b32 a97, v65
  v_accvgpr_write_b32 a98, v66
  v_accvgpr_write_b32 a99, v67
  v_accvgpr_read_b32 v64, a112
  v_accvgpr_read_b32 v65, a113
  v_accvgpr_read_b32 v66, a114
  v_accvgpr_read_b32 v67, a115
  v_mul_f32 v64, v64, v193
  v_mul_f32 v65, v65, v193
  v_mul_f32 v66, v66, v193
  v_mul_f32 v67, v67, v193
  v_accvgpr_write_b32 a112, v64
  v_accvgpr_write_b32 a113, v65
  v_accvgpr_write_b32 a114, v66
  v_accvgpr_write_b32 a115, v67
  v_mov_b32 v196, v250
  v_max3_f32 v196, v196, v8, v9
  v_max3_f32 v196, v196, v10, v11
  v_max3_f32 v196, v196, v12, v13
  v_max3_f32 v196, v196, v14, v15
  v_max3_f32 v196, v196, v40, v41
  v_max3_f32 v196, v196, v42, v43
  v_max3_f32 v196, v196, v44, v45
  v_max3_f32 v196, v196, v46, v47
  v_mov_b32 v245, v196
  s_nop 1
  v_permlane16_swap_b32 v196, v245
  v_max_f32 v196, v196, v245
  v_mov_b32 v245, v196
  s_nop 1
  v_permlane32_swap_b32 v196, v245
  v_max_f32 v196, v196, v245
  v_sub_f32 v197, v250, v196
  v_exp_f32 v197, v197
  v_mov_b32 v250, v196
  v_mul_f32 v209, v209, v197
  v_sub_f32 v8, v8, v196
  v_sub_f32 v9, v9, v196
  v_sub_f32 v10, v10, v196
  v_sub_f32 v11, v11, v196
  v_sub_f32 v12, v12, v196
  v_sub_f32 v13, v13, v196
  v_sub_f32 v14, v14, v196
  v_sub_f32 v15, v15, v196
  v_sub_f32 v40, v40, v196
  v_sub_f32 v41, v41, v196
  v_sub_f32 v42, v42, v196
  v_sub_f32 v43, v43, v196
  v_sub_f32 v44, v44, v196
  v_sub_f32 v45, v45, v196
  v_sub_f32 v46, v46, v196
  v_sub_f32 v47, v47, v196
  v_exp_f32 v8, v8
  v_exp_f32 v9, v9
  v_add_f32 v209, v209, v8
  v_exp_f32 v10, v10
  v_add_f32 v209, v209, v9
  v_cvt_pk_bf16_f32 v8, v8, v9
  v_exp_f32 v11, v11
  v_add_f32 v209, v209, v10
  v_add_f32 v209, v209, v11
  v_cvt_pk_bf16_f32 v9, v10, v11
  v_exp_f32 v12, v12
  v_exp_f32 v13, v13
  v_add_f32 v209, v209, v12
  v_exp_f32 v14, v14
  v_add_f32 v209, v209, v13
  v_cvt_pk_bf16_f32 v10, v12, v13
  v_exp_f32 v15, v15
  v_add_f32 v209, v209, v14
  v_add_f32 v209, v209, v15
  v_cvt_pk_bf16_f32 v11, v14, v15
  v_exp_f32 v40, v40
  v_exp_f32 v41, v41
  v_add_f32 v209, v209, v40
  v_exp_f32 v42, v42
  v_add_f32 v209, v209, v41
  v_cvt_pk_bf16_f32 v40, v40, v41
  v_exp_f32 v43, v43
  v_add_f32 v209, v209, v42
  v_add_f32 v209, v209, v43
  v_cvt_pk_bf16_f32 v41, v42, v43
  v_exp_f32 v44, v44
  v_exp_f32 v45, v45
  v_add_f32 v209, v209, v44
  v_exp_f32 v46, v46
  v_add_f32 v209, v209, v45
  v_cvt_pk_bf16_f32 v42, v44, v45
  v_exp_f32 v47, v47
  v_add_f32 v209, v209, v46
  v_add_f32 v209, v209, v47
  v_cvt_pk_bf16_f32 v43, v46, v47
  v_accvgpr_read_b32 v64, a4
  v_accvgpr_read_b32 v65, a5
  v_accvgpr_read_b32 v66, a6
  v_accvgpr_read_b32 v67, a7
  v_mul_f32 v64, v64, v197
  v_mul_f32 v65, v65, v197
  v_mul_f32 v66, v66, v197
  v_mul_f32 v67, v67, v197
  v_accvgpr_write_b32 a4, v64
  v_accvgpr_write_b32 a5, v65
  v_accvgpr_write_b32 a6, v66
  v_accvgpr_write_b32 a7, v67
  v_accvgpr_read_b32 v64, a20
  v_accvgpr_read_b32 v65, a21
  v_accvgpr_read_b32 v66, a22
  v_accvgpr_read_b32 v67, a23
  v_mul_f32 v64, v64, v197
  v_mul_f32 v65, v65, v197
  v_mul_f32 v66, v66, v197
  v_mul_f32 v67, v67, v197
  v_accvgpr_write_b32 a20, v64
  v_accvgpr_write_b32 a21, v65
  v_accvgpr_write_b32 a22, v66
  v_accvgpr_write_b32 a23, v67
  v_accvgpr_read_b32 v64, a36
  v_accvgpr_read_b32 v65, a37
  v_accvgpr_read_b32 v66, a38
  v_accvgpr_read_b32 v67, a39
  v_mul_f32 v64, v64, v197
  v_mul_f32 v65, v65, v197
  v_mul_f32 v66, v66, v197
  v_mul_f32 v67, v67, v197
  v_accvgpr_write_b32 a36, v64
  v_accvgpr_write_b32 a37, v65
  v_accvgpr_write_b32 a38, v66
  v_accvgpr_write_b32 a39, v67
  v_accvgpr_read_b32 v64, a52
  v_accvgpr_read_b32 v65, a53
  v_accvgpr_read_b32 v66, a54
  v_accvgpr_read_b32 v67, a55
  v_mul_f32 v64, v64, v197
  v_mul_f32 v65, v65, v197
  v_mul_f32 v66, v66, v197
  v_mul_f32 v67, v67, v197
  v_accvgpr_write_b32 a52, v64
  v_accvgpr_write_b32 a53, v65
  v_accvgpr_write_b32 a54, v66
  v_accvgpr_write_b32 a55, v67
  v_accvgpr_read_b32 v64, a68
  v_accvgpr_read_b32 v65, a69
  v_accvgpr_read_b32 v66, a70
  v_accvgpr_read_b32 v67, a71
  v_mul_f32 v64, v64, v197
  v_mul_f32 v65, v65, v197
  v_mul_f32 v66, v66, v197
  v_mul_f32 v67, v67, v197
  v_accvgpr_write_b32 a68, v64
  v_accvgpr_write_b32 a69, v65
  v_accvgpr_write_b32 a70, v66
  v_accvgpr_write_b32 a71, v67
  v_accvgpr_read_b32 v64, a84
  v_accvgpr_read_b32 v65, a85
  v_accvgpr_read_b32 v66, a86
  v_accvgpr_read_b32 v67, a87
  v_mul_f32 v64, v64, v197
  v_mul_f32 v65, v65, v197
  v_mul_f32 v66, v66, v197
  v_mul_f32 v67, v67, v197
  v_accvgpr_write_b32 a84, v64
  v_accvgpr_write_b32 a85, v65
  v_accvgpr_write_b32 a86, v66
  v_accvgpr_write_b32 a87, v67
  v_accvgpr_read_b32 v64, a100
  v_accvgpr_read_b32 v65, a101
  v_accvgpr_read_b32 v66, a102
  v_accvgpr_read_b32 v67, a103
  v_mul_f32 v64, v64, v197
  v_mul_f32 v65, v65, v197
  v_mul_f32 v66, v66, v197
  v_mul_f32 v67, v67, v197
  v_accvgpr_write_b32 a100, v64
  v_accvgpr_write_b32 a101, v65
  v_accvgpr_write_b32 a102, v66
  v_accvgpr_write_b32 a103, v67
  v_accvgpr_read_b32 v64, a116
  v_accvgpr_read_b32 v65, a117
  v_accvgpr_read_b32 v66, a118
  v_accvgpr_read_b32 v67, a119
  v_mul_f32 v64, v64, v197
  v_mul_f32 v65, v65, v197
  v_mul_f32 v66, v66, v197
  v_mul_f32 v67, v67, v197
  v_accvgpr_write_b32 a116, v64
  v_accvgpr_write_b32 a117, v65
  v_accvgpr_write_b32 a118, v66
  v_accvgpr_write_b32 a119, v67
  v_mov_b32 v200, v251
  v_max3_f32 v200, v200, v16, v17
  v_max3_f32 v200, v200, v18, v19
  v_max3_f32 v200, v200, v20, v21
  v_max3_f32 v200, v200, v22, v23
  v_max3_f32 v200, v200, v48, v49
  v_max3_f32 v200, v200, v50, v51
  v_max3_f32 v200, v200, v52, v53
  v_max3_f32 v200, v200, v54, v55
  v_mov_b32 v245, v200
  s_nop 1
  v_permlane16_swap_b32 v200, v245
  v_max_f32 v200, v200, v245
  v_mov_b32 v245, v200
  s_nop 1
  v_permlane32_swap_b32 v200, v245
  v_max_f32 v200, v200, v245
  v_sub_f32 v201, v251, v200
  v_exp_f32 v201, v201
  v_mov_b32 v251, v200
  v_mul_f32 v210, v210, v201
  v_sub_f32 v16, v16, v200
  v_sub_f32 v17, v17, v200
  v_sub_f32 v18, v18, v200
  v_sub_f32 v19, v19, v200
  v_sub_f32 v20, v20, v200
  v_sub_f32 v21, v21, v200
  v_sub_f32 v22, v22, v200
  v_sub_f32 v23, v23, v200
  v_sub_f32 v48, v48, v200
  v_sub_f32 v49, v49, v200
  v_sub_f32 v50, v50, v200
  v_sub_f32 v51, v51, v200
  v_sub_f32 v52, v52, v200
  v_sub_f32 v53, v53, v200
  v_sub_f32 v54, v54, v200
  v_sub_f32 v55, v55, v200
  v_exp_f32 v16, v16
  v_exp_f32 v17, v17
  v_add_f32 v210, v210, v16
  v_exp_f32 v18, v18
  v_add_f32 v210, v210, v17
  v_cvt_pk_bf16_f32 v16, v16, v17
  v_exp_f32 v19, v19
  v_add_f32 v210, v210, v18
  v_add_f32 v210, v210, v19
  v_cvt_pk_bf16_f32 v17, v18, v19
  v_exp_f32 v20, v20
  v_exp_f32 v21, v21
  v_add_f32 v210, v210, v20
  v_exp_f32 v22, v22
  v_add_f32 v210, v210, v21
  v_cvt_pk_bf16_f32 v18, v20, v21
  v_exp_f32 v23, v23
  v_add_f32 v210, v210, v22
  v_add_f32 v210, v210, v23
  v_cvt_pk_bf16_f32 v19, v22, v23
  v_exp_f32 v48, v48
  v_exp_f32 v49, v49
  v_add_f32 v210, v210, v48
  v_exp_f32 v50, v50
  v_add_f32 v210, v210, v49
  v_cvt_pk_bf16_f32 v48, v48, v49
  v_exp_f32 v51, v51
  v_add_f32 v210, v210, v50
  v_add_f32 v210, v210, v51
  v_cvt_pk_bf16_f32 v49, v50, v51
  v_exp_f32 v52, v52
  v_exp_f32 v53, v53
  v_add_f32 v210, v210, v52
  v_exp_f32 v54, v54
  v_add_f32 v210, v210, v53
  v_cvt_pk_bf16_f32 v50, v52, v53
  v_exp_f32 v55, v55
  v_add_f32 v210, v210, v54
  v_add_f32 v210, v210, v55
  v_cvt_pk_bf16_f32 v51, v54, v55
  v_accvgpr_read_b32 v64, a8
  v_accvgpr_read_b32 v65, a9
  v_accvgpr_read_b32 v66, a10
  v_accvgpr_read_b32 v67, a11
  v_mul_f32 v64, v64, v201
  v_mul_f32 v65, v65, v201
  v_mul_f32 v66, v66, v201
  v_mul_f32 v67, v67, v201
  v_accvgpr_write_b32 a8, v64
  v_accvgpr_write_b32 a9, v65
  v_accvgpr_write_b32 a10, v66
  v_accvgpr_write_b32 a11, v67
  v_accvgpr_read_b32 v64, a24
  v_accvgpr_read_b32 v65, a25
  v_accvgpr_read_b32 v66, a26
  v_accvgpr_read_b32 v67, a27
  v_mul_f32 v64, v64, v201
  v_mul_f32 v65, v65, v201
  v_mul_f32 v66, v66, v201
  v_mul_f32 v67, v67, v201
  v_accvgpr_write_b32 a24, v64
  v_accvgpr_write_b32 a25, v65
  v_accvgpr_write_b32 a26, v66
  v_accvgpr_write_b32 a27, v67
  v_accvgpr_read_b32 v64, a40
  v_accvgpr_read_b32 v65, a41
  v_accvgpr_read_b32 v66, a42
  v_accvgpr_read_b32 v67, a43
  v_mul_f32 v64, v64, v201
  v_mul_f32 v65, v65, v201
  v_mul_f32 v66, v66, v201
  v_mul_f32 v67, v67, v201
  v_accvgpr_write_b32 a40, v64
  v_accvgpr_write_b32 a41, v65
  v_accvgpr_write_b32 a42, v66
  v_accvgpr_write_b32 a43, v67
  v_accvgpr_read_b32 v64, a56
  v_accvgpr_read_b32 v65, a57
  v_accvgpr_read_b32 v66, a58
  v_accvgpr_read_b32 v67, a59
  v_mul_f32 v64, v64, v201
  v_mul_f32 v65, v65, v201
  v_mul_f32 v66, v66, v201
  v_mul_f32 v67, v67, v201
  v_accvgpr_write_b32 a56, v64
  v_accvgpr_write_b32 a57, v65
  v_accvgpr_write_b32 a58, v66
  v_accvgpr_write_b32 a59, v67
  v_accvgpr_read_b32 v64, a72
  v_accvgpr_read_b32 v65, a73
  v_accvgpr_read_b32 v66, a74
  v_accvgpr_read_b32 v67, a75
  v_mul_f32 v64, v64, v201
  v_mul_f32 v65, v65, v201
  v_mul_f32 v66, v66, v201
  v_mul_f32 v67, v67, v201
  v_accvgpr_write_b32 a72, v64
  v_accvgpr_write_b32 a73, v65
  v_accvgpr_write_b32 a74, v66
  v_accvgpr_write_b32 a75, v67
  v_accvgpr_read_b32 v64, a88
  v_accvgpr_read_b32 v65, a89
  v_accvgpr_read_b32 v66, a90
  v_accvgpr_read_b32 v67, a91
  v_mul_f32 v64, v64, v201
  v_mul_f32 v65, v65, v201
  v_mul_f32 v66, v66, v201
  v_mul_f32 v67, v67, v201
  v_accvgpr_write_b32 a88, v64
  v_accvgpr_write_b32 a89, v65
  v_accvgpr_write_b32 a90, v66
  v_accvgpr_write_b32 a91, v67
  v_accvgpr_read_b32 v64, a104
  v_accvgpr_read_b32 v65, a105
  v_accvgpr_read_b32 v66, a106
  v_accvgpr_read_b32 v67, a107
  v_mul_f32 v64, v64, v201
  v_mul_f32 v65, v65, v201
  v_mul_f32 v66, v66, v201
  v_mul_f32 v67, v67, v201
  v_accvgpr_write_b32 a104, v64
  v_accvgpr_write_b32 a105, v65
  v_accvgpr_write_b32 a106, v66
  v_accvgpr_write_b32 a107, v67
  v_accvgpr_read_b32 v64, a120
  v_accvgpr_read_b32 v65, a121
  v_accvgpr_read_b32 v66, a122
  v_accvgpr_read_b32 v67, a123
  v_mul_f32 v64, v64, v201
  v_mul_f32 v65, v65, v201
  v_mul_f32 v66, v66, v201
  v_mul_f32 v67, v67, v201
  v_accvgpr_write_b32 a120, v64
  v_accvgpr_write_b32 a121, v65
  v_accvgpr_write_b32 a122, v66
  v_accvgpr_write_b32 a123, v67
  v_mov_b32 v204, v252
  v_max3_f32 v204, v204, v24, v25
  v_max3_f32 v204, v204, v26, v27
  v_max3_f32 v204, v204, v28, v29
  v_max3_f32 v204, v204, v30, v31
  v_max3_f32 v204, v204, v56, v57
  v_max3_f32 v204, v204, v58, v59
  v_max3_f32 v204, v204, v60, v61
  v_max3_f32 v204, v204, v62, v63
  v_mov_b32 v245, v204
  s_nop 1
  v_permlane16_swap_b32 v204, v245
  v_max_f32 v204, v204, v245
  v_mov_b32 v245, v204
  s_nop 1
  v_permlane32_swap_b32 v204, v245
  v_max_f32 v204, v204, v245
  v_sub_f32 v205, v252, v204
  v_exp_f32 v205, v205
  v_mov_b32 v252, v204
  v_mul_f32 v211, v211, v205
  v_sub_f32 v24, v24, v204
  v_sub_f32 v25, v25, v204
  v_sub_f32 v26, v26, v204
  v_sub_f32 v27, v27, v204
  v_sub_f32 v28, v28, v204
  v_sub_f32 v29, v29, v204
  v_sub_f32 v30, v30, v204
  v_sub_f32 v31, v31, v204
  v_sub_f32 v56, v56, v204
  v_sub_f32 v57, v57, v204
  v_sub_f32 v58, v58, v204
  v_sub_f32 v59, v59, v204
  v_sub_f32 v60, v60, v204
  v_sub_f32 v61, v61, v204
  v_sub_f32 v62, v62, v204
  v_sub_f32 v63, v63, v204
  v_exp_f32 v24, v24
  v_exp_f32 v25, v25
  v_add_f32 v211, v211, v24
  v_exp_f32 v26, v26
  v_add_f32 v211, v211, v25
  v_cvt_pk_bf16_f32 v24, v24, v25
  v_exp_f32 v27, v27
  v_add_f32 v211, v211, v26
  v_add_f32 v211, v211, v27
  v_cvt_pk_bf16_f32 v25, v26, v27
  v_exp_f32 v28, v28
  v_exp_f32 v29, v29
  v_add_f32 v211, v211, v28
  v_exp_f32 v30, v30
  v_add_f32 v211, v211, v29
  v_cvt_pk_bf16_f32 v26, v28, v29
  v_exp_f32 v31, v31
  v_add_f32 v211, v211, v30
  v_add_f32 v211, v211, v31
  v_cvt_pk_bf16_f32 v27, v30, v31
  v_exp_f32 v56, v56
  v_exp_f32 v57, v57
  v_add_f32 v211, v211, v56
  v_exp_f32 v58, v58
  v_add_f32 v211, v211, v57
  v_cvt_pk_bf16_f32 v56, v56, v57
  v_exp_f32 v59, v59
  v_add_f32 v211, v211, v58
  v_add_f32 v211, v211, v59
  v_cvt_pk_bf16_f32 v57, v58, v59
  v_exp_f32 v60, v60
  v_exp_f32 v61, v61
  v_add_f32 v211, v211, v60
  v_exp_f32 v62, v62
  v_add_f32 v211, v211, v61
  v_cvt_pk_bf16_f32 v58, v60, v61
  v_exp_f32 v63, v63
  v_add_f32 v211, v211, v62
  v_add_f32 v211, v211, v63
  v_cvt_pk_bf16_f32 v59, v62, v63
  v_accvgpr_read_b32 v64, a12
  v_accvgpr_read_b32 v65, a13
  v_accvgpr_read_b32 v66, a14
  v_accvgpr_read_b32 v67, a15
  v_mul_f32 v64, v64, v205
  v_mul_f32 v65, v65, v205
  v_mul_f32 v66, v66, v205
  v_mul_f32 v67, v67, v205
  v_accvgpr_write_b32 a12, v64
  v_accvgpr_write_b32 a13, v65
  v_accvgpr_write_b32 a14, v66
  v_accvgpr_write_b32 a15, v67
  v_accvgpr_read_b32 v64, a28
  v_accvgpr_read_b32 v65, a29
  v_accvgpr_read_b32 v66, a30
  v_accvgpr_read_b32 v67, a31
  v_mul_f32 v64, v64, v205
  v_mul_f32 v65, v65, v205
  v_mul_f32 v66, v66, v205
  v_mul_f32 v67, v67, v205
  v_accvgpr_write_b32 a28, v64
  v_accvgpr_write_b32 a29, v65
  v_accvgpr_write_b32 a30, v66
  v_accvgpr_write_b32 a31, v67
  v_accvgpr_read_b32 v64, a44
  v_accvgpr_read_b32 v65, a45
  v_accvgpr_read_b32 v66, a46
  v_accvgpr_read_b32 v67, a47
  v_mul_f32 v64, v64, v205
  v_mul_f32 v65, v65, v205
  v_mul_f32 v66, v66, v205
  v_mul_f32 v67, v67, v205
  v_accvgpr_write_b32 a44, v64
  v_accvgpr_write_b32 a45, v65
  v_accvgpr_write_b32 a46, v66
  v_accvgpr_write_b32 a47, v67
  v_accvgpr_read_b32 v64, a60
  v_accvgpr_read_b32 v65, a61
  v_accvgpr_read_b32 v66, a62
  v_accvgpr_read_b32 v67, a63
  v_mul_f32 v64, v64, v205
  v_mul_f32 v65, v65, v205
  v_mul_f32 v66, v66, v205
  v_mul_f32 v67, v67, v205
  v_accvgpr_write_b32 a60, v64
  v_accvgpr_write_b32 a61, v65
  v_accvgpr_write_b32 a62, v66
  v_accvgpr_write_b32 a63, v67
  v_accvgpr_read_b32 v64, a76
  v_accvgpr_read_b32 v65, a77
  v_accvgpr_read_b32 v66, a78
  v_accvgpr_read_b32 v67, a79
  v_mul_f32 v64, v64, v205
  v_mul_f32 v65, v65, v205
  v_mul_f32 v66, v66, v205
  v_mul_f32 v67, v67, v205
  v_accvgpr_write_b32 a76, v64
  v_accvgpr_write_b32 a77, v65
  v_accvgpr_write_b32 a78, v66
  v_accvgpr_write_b32 a79, v67
  v_accvgpr_read_b32 v64, a92
  v_accvgpr_read_b32 v65, a93
  v_accvgpr_read_b32 v66, a94
  v_accvgpr_read_b32 v67, a95
  v_mul_f32 v64, v64, v205
  v_mul_f32 v65, v65, v205
  v_mul_f32 v66, v66, v205
  v_mul_f32 v67, v67, v205
  v_accvgpr_write_b32 a92, v64
  v_accvgpr_write_b32 a93, v65
  v_accvgpr_write_b32 a94, v66
  v_accvgpr_write_b32 a95, v67
  v_accvgpr_read_b32 v64, a108
  v_accvgpr_read_b32 v65, a109
  v_accvgpr_read_b32 v66, a110
  v_accvgpr_read_b32 v67, a111
  v_mul_f32 v64, v64, v205
  v_mul_f32 v65, v65, v205
  v_mul_f32 v66, v66, v205
  v_mul_f32 v67, v67, v205
  v_accvgpr_write_b32 a108, v64
  v_accvgpr_write_b32 a109, v65
  v_accvgpr_write_b32 a110, v66
  v_accvgpr_write_b32 a111, v67
  v_accvgpr_read_b32 v64, a124
  v_accvgpr_read_b32 v65, a125
  v_accvgpr_read_b32 v66, a126
  v_accvgpr_read_b32 v67, a127
  v_mul_f32 v64, v64, v205
  v_mul_f32 v65, v65, v205
  v_mul_f32 v66, v66, v205
  v_mul_f32 v67, v67, v205
  v_accvgpr_write_b32 a124, v64
  v_accvgpr_write_b32 a125, v65
  v_accvgpr_write_b32 a126, v66
  v_accvgpr_write_b32 a127, v67
  ds_read_b64_tr_b16 a[160:161], v216 offset:0
  ds_read_b64_tr_b16 a[162:163], v216 offset:4096
  ds_read_b64_tr_b16 a[164:165], v216 offset:8192
  ds_read_b64_tr_b16 a[166:167], v216 offset:12288
  s_waitcnt lgkmcnt(2)
  v_mfma_f32_16x16x32_bf16 a[0:3], a[160:163], v[0:3], a[0:3]
  s_waitcnt lgkmcnt(0)
  v_mfma_f32_16x16x32_bf16 a[0:3], a[164:167], v[32:35], a[0:3]
  v_mfma_f32_16x16x32_bf16 a[4:7], a[164:167], v[40:43], a[4:7]
  v_mfma_f32_16x16x32_bf16 a[4:7], a[160:163], v[8:11], a[4:7]
  v_mfma_f32_16x16x32_bf16 a[8:11], a[160:163], v[16:19], a[8:11]
  v_mfma_f32_16x16x32_bf16 a[8:11], a[164:167], v[48:51], a[8:11]
  v_mfma_f32_16x16x32_bf16 a[12:15], a[164:167], v[56:59], a[12:15]
  v_mfma_f32_16x16x32_bf16 a[12:15], a[160:163], v[24:27], a[12:15]
  ds_read_b64_tr_b16 a[168:169], v217 offset:0
  ds_read_b64_tr_b16 a[170:171], v217 offset:4096
  ds_read_b64_tr_b16 a[172:173], v217 offset:8192
  ds_read_b64_tr_b16 a[174:175], v217 offset:12288
  s_waitcnt lgkmcnt(2)
  v_mfma_f32_16x16x32_bf16 a[16:19], a[168:171], v[0:3], a[16:19]
  s_waitcnt lgkmcnt(0)
  v_mfma_f32_16x16x32_bf16 a[16:19], a[172:175], v[32:35], a[16:19]
  v_mfma_f32_16x16x32_bf16 a[20:23], a[172:175], v[40:43], a[20:23]
  v_mfma_f32_16x16x32_bf16 a[20:23], a[168:171], v[8:11], a[20:23]
  v_mfma_f32_16x16x32_bf16 a[24:27], a[168:171], v[16:19], a[24:27]
  v_mfma_f32_16x16x32_bf16 a[24:27], a[172:175], v[48:51], a[24:27]
  v_mfma_f32_16x16x32_bf16 a[28:31], a[172:175], v[56:59], a[28:31]
  v_mfma_f32_16x16x32_bf16 a[28:31], a[168:171], v[24:27], a[28:31]
  ds_read_b64_tr_b16 a[176:177], v218 offset:0
  ds_read_b64_tr_b16 a[178:179], v218 offset:4096
  ds_read_b64_tr_b16 a[180:181], v218 offset:8192
  ds_read_b64_tr_b16 a[182:183], v218 offset:12288
  s_waitcnt lgkmcnt(2)
  v_mfma_f32_16x16x32_bf16 a[32:35], a[176:179], v[0:3], a[32:35]
  s_waitcnt lgkmcnt(0)
  v_mfma_f32_16x16x32_bf16 a[32:35], a[180:183], v[32:35], a[32:35]
  v_mfma_f32_16x16x32_bf16 a[36:39], a[180:183], v[40:43], a[36:39]
  v_mfma_f32_16x16x32_bf16 a[36:39], a[176:179], v[8:11], a[36:39]
  v_mfma_f32_16x16x32_bf16 a[40:43], a[176:179], v[16:19], a[40:43]
  v_mfma_f32_16x16x32_bf16 a[40:43], a[180:183], v[48:51], a[40:43]
  v_mfma_f32_16x16x32_bf16 a[44:47], a[180:183], v[56:59], a[44:47]
  v_mfma_f32_16x16x32_bf16 a[44:47], a[176:179], v[24:27], a[44:47]
  ds_read_b64_tr_b16 a[184:185], v219 offset:0
  ds_read_b64_tr_b16 a[186:187], v219 offset:4096
  ds_read_b64_tr_b16 a[188:189], v219 offset:8192
  ds_read_b64_tr_b16 a[190:191], v219 offset:12288
  s_waitcnt lgkmcnt(2)
  v_mfma_f32_16x16x32_bf16 a[48:51], a[184:187], v[0:3], a[48:51]
  s_waitcnt lgkmcnt(0)
  v_mfma_f32_16x16x32_bf16 a[48:51], a[188:191], v[32:35], a[48:51]
  v_mfma_f32_16x16x32_bf16 a[52:55], a[188:191], v[40:43], a[52:55]
  v_mfma_f32_16x16x32_bf16 a[52:55], a[184:187], v[8:11], a[52:55]
  v_mfma_f32_16x16x32_bf16 a[56:59], a[184:187], v[16:19], a[56:59]
  v_mfma_f32_16x16x32_bf16 a[56:59], a[188:191], v[48:51], a[56:59]
  v_mfma_f32_16x16x32_bf16 a[60:63], a[188:191], v[56:59], a[60:63]
  v_mfma_f32_16x16x32_bf16 a[60:63], a[184:187], v[24:27], a[60:63]
  ds_read_b64_tr_b16 a[160:161], v220 offset:0
  ds_read_b64_tr_b16 a[162:163], v220 offset:4096
  ds_read_b64_tr_b16 a[164:165], v220 offset:8192
  ds_read_b64_tr_b16 a[166:167], v220 offset:12288
  s_waitcnt lgkmcnt(2)
  v_mfma_f32_16x16x32_bf16 a[64:67], a[160:163], v[0:3], a[64:67]
  s_waitcnt lgkmcnt(0)
  v_mfma_f32_16x16x32_bf16 a[64:67], a[164:167], v[32:35], a[64:67]
  v_mfma_f32_16x16x32_bf16 a[68:71], a[164:167], v[40:43], a[68:71]
  v_mfma_f32_16x16x32_bf16 a[68:71], a[160:163], v[8:11], a[68:71]
  v_mfma_f32_16x16x32_bf16 a[72:75], a[160:163], v[16:19], a[72:75]
  v_mfma_f32_16x16x32_bf16 a[72:75], a[164:167], v[48:51], a[72:75]
  v_mfma_f32_16x16x32_bf16 a[76:79], a[164:167], v[56:59], a[76:79]
  v_mfma_f32_16x16x32_bf16 a[76:79], a[160:163], v[24:27], a[76:79]
  ds_read_b64_tr_b16 a[168:169], v221 offset:0
  ds_read_b64_tr_b16 a[170:171], v221 offset:4096
  ds_read_b64_tr_b16 a[172:173], v221 offset:8192
  ds_read_b64_tr_b16 a[174:175], v221 offset:12288
  s_waitcnt lgkmcnt(2)
  v_mfma_f32_16x16x32_bf16 a[80:83], a[168:171], v[0:3], a[80:83]
  s_waitcnt lgkmcnt(0)
  v_mfma_f32_16x16x32_bf16 a[80:83], a[172:175], v[32:35], a[80:83]
  v_mfma_f32_16x16x32_bf16 a[84:87], a[172:175], v[40:43], a[84:87]
  v_mfma_f32_16x16x32_bf16 a[84:87], a[168:171], v[8:11], a[84:87]
  v_mfma_f32_16x16x32_bf16 a[88:91], a[168:171], v[16:19], a[88:91]
  v_mfma_f32_16x16x32_bf16 a[88:91], a[172:175], v[48:51], a[88:91]
  v_mfma_f32_16x16x32_bf16 a[92:95], a[172:175], v[56:59], a[92:95]
  v_mfma_f32_16x16x32_bf16 a[92:95], a[168:171], v[24:27], a[92:95]
  ds_read_b64_tr_b16 a[176:177], v222 offset:0
  ds_read_b64_tr_b16 a[178:179], v222 offset:4096
  ds_read_b64_tr_b16 a[180:181], v222 offset:8192
  ds_read_b64_tr_b16 a[182:183], v222 offset:12288
  s_waitcnt lgkmcnt(2)
  v_mfma_f32_16x16x32_bf16 a[96:99], a[176:179], v[0:3], a[96:99]
  s_waitcnt lgkmcnt(0)
  v_mfma_f32_16x16x32_bf16 a[96:99], a[180:183], v[32:35], a[96:99]
  v_mfma_f32_16x16x32_bf16 a[100:103], a[180:183], v[40:43], a[100:103]
  v_mfma_f32_16x16x32_bf16 a[100:103], a[176:179], v[8:11], a[100:103]
  v_mfma_f32_16x16x32_bf16 a[104:107], a[176:179], v[16:19], a[104:107]
  v_mfma_f32_16x16x32_bf16 a[104:107], a[180:183], v[48:51], a[104:107]
  v_mfma_f32_16x16x32_bf16 a[108:111], a[180:183], v[56:59], a[108:111]
  v_mfma_f32_16x16x32_bf16 a[108:111], a[176:179], v[24:27], a[108:111]
  ds_read_b64_tr_b16 a[184:185], v223 offset:0
  ds_read_b64_tr_b16 a[186:187], v223 offset:4096
  ds_read_b64_tr_b16 a[188:189], v223 offset:8192
  ds_read_b64_tr_b16 a[190:191], v223 offset:12288
  s_waitcnt lgkmcnt(2)
  v_mfma_f32_16x16x32_bf16 a[112:115], a[184:187], v[0:3], a[112:115]
  s_waitcnt lgkmcnt(0)
  v_mfma_f32_16x16x32_bf16 a[112:115], a[188:191], v[32:35], a[112:115]
  v_mfma_f32_16x16x32_bf16 a[116:119], a[188:191], v[40:43], a[116:119]
  v_mfma_f32_16x16x32_bf16 a[116:119], a[184:187], v[8:11], a[116:119]
  v_mfma_f32_16x16x32_bf16 a[120:123], a[184:187], v[16:19], a[120:123]
  v_mfma_f32_16x16x32_bf16 a[120:123], a[188:191], v[48:51], a[120:123]
  v_mfma_f32_16x16x32_bf16 a[124:127], a[188:191], v[56:59], a[124:127]
  v_mfma_f32_16x16x32_bf16 a[124:127], a[184:187], v[24:27], a[124:127]
  s_add_u32 s29, s29, 16384
  s_cmp_lt_u32 s29, 524288
  s_cbranch_scc1 attn_slow
  v_mov_b32 v245, v208
  v_mov_b32 v246, v209
  v_mov_b32 v247, v210
  v_mov_b32 v248, v211
  v_permlane16_swap_b32 v208, v245
  v_permlane16_swap_b32 v209, v246
  v_permlane16_swap_b32 v210, v247
  v_permlane16_swap_b32 v211, v248
  v_add_f32 v208, v208, v245
  v_add_f32 v209, v209, v246
  v_add_f32 v210, v210, v247
  v_add_f32 v211, v211, v248
  v_mov_b32 v245, v208
  v_mov_b32 v246, v209
  v_mov_b32 v247, v210
  v_mov_b32 v248, v211
  v_permlane32_swap_b32 v208, v245
  v_permlane32_swap_b32 v209, v246
  v_permlane32_swap_b32 v210, v247
  v_permlane32_swap_b32 v211, v248
  v_add_f32 v208, v208, v245
  v_add_f32 v209, v209, v246
  v_add_f32 v210, v210, v247
  v_add_f32 v211, v211, v248
  v_rcp_f32 v192, v208
  v_rcp_f32 v196, v209
  v_rcp_f32 v200, v210
  v_rcp_f32 v204, v211
  v_accvgpr_read_b32 v0, a0
  v_accvgpr_read_b32 v1, a1
  v_accvgpr_read_b32 v2, a2
  v_accvgpr_read_b32 v3, a3
  v_accvgpr_read_b32 v4, a16
  v_accvgpr_read_b32 v5, a17
  v_accvgpr_read_b32 v6, a18
  v_accvgpr_read_b32 v7, a19
  v_mul_f32 v0, v0, v192
  v_mul_f32 v1, v1, v192
  v_mul_f32 v2, v2, v192
  v_mul_f32 v3, v3, v192
  v_mul_f32 v4, v4, v192
  v_mul_f32 v5, v5, v192
  v_mul_f32 v6, v6, v192
  v_mul_f32 v7, v7, v192
  v_cvt_pk_bf16_f32 v0, v0, v1
  v_cvt_pk_bf16_f32 v1, v2, v3
  v_cvt_pk_bf16_f32 v2, v4, v5
  v_cvt_pk_bf16_f32 v3, v6, v7
  buffer_store_dwordx4 v[0:3], v244, s[24:27], s40 offen offset:0 sc1
  v_accvgpr_read_b32 v8, a4
  v_accvgpr_read_b32 v9, a5
  v_accvgpr_read_b32 v10, a6
  v_accvgpr_read_b32 v11, a7
  v_accvgpr_read_b32 v12, a20
  v_accvgpr_read_b32 v13, a21
  v_accvgpr_read_b32 v14, a22
  v_accvgpr_read_b32 v15, a23
  v_mul_f32 v8, v8, v196
  v_mul_f32 v9, v9, v196
  v_mul_f32 v10, v10, v196
  v_mul_f32 v11, v11, v196
  v_mul_f32 v12, v12, v196
  v_mul_f32 v13, v13, v196
  v_mul_f32 v14, v14, v196
  v_mul_f32 v15, v15, v196
  v_cvt_pk_bf16_f32 v8, v8, v9
  v_cvt_pk_bf16_f32 v9, v10, v11
  v_cvt_pk_bf16_f32 v10, v12, v13
  v_cvt_pk_bf16_f32 v11, v14, v15
  buffer_store_dwordx4 v[8:11], v244, s[24:27], s40 offen offset:2048 sc1
  v_accvgpr_read_b32 v16, a8
  v_accvgpr_read_b32 v17, a9
  v_accvgpr_read_b32 v18, a10
  v_accvgpr_read_b32 v19, a11
  v_accvgpr_read_b32 v20, a24
  v_accvgpr_read_b32 v21, a25
  v_accvgpr_read_b32 v22, a26
  v_accvgpr_read_b32 v23, a27
  v_mul_f32 v16, v16, v200
  v_mul_f32 v17, v17, v200
  v_mul_f32 v18, v18, v200
  v_mul_f32 v19, v19, v200
  v_mul_f32 v20, v20, v200
  v_mul_f32 v21, v21, v200
  v_mul_f32 v22, v22, v200
  v_mul_f32 v23, v23, v200
  v_cvt_pk_bf16_f32 v16, v16, v17
  v_cvt_pk_bf16_f32 v17, v18, v19
  v_cvt_pk_bf16_f32 v18, v20, v21
  v_cvt_pk_bf16_f32 v19, v22, v23
  buffer_store_dwordx4 v[16:19], v244, s[24:27], s41 offen offset:0 sc1
  v_accvgpr_read_b32 v24, a12
  v_accvgpr_read_b32 v25, a13
  v_accvgpr_read_b32 v26, a14
  v_accvgpr_read_b32 v27, a15
  v_accvgpr_read_b32 v28, a28
  v_accvgpr_read_b32 v29, a29
  v_accvgpr_read_b32 v30, a30
  v_accvgpr_read_b32 v31, a31
  v_mul_f32 v24, v24, v204
  v_mul_f32 v25, v25, v204
  v_mul_f32 v26, v26, v204
  v_mul_f32 v27, v27, v204
  v_mul_f32 v28, v28, v204
  v_mul_f32 v29, v29, v204
  v_mul_f32 v30, v30, v204
  v_mul_f32 v31, v31, v204
  v_cvt_pk_bf16_f32 v24, v24, v25
  v_cvt_pk_bf16_f32 v25, v26, v27
  v_cvt_pk_bf16_f32 v26, v28, v29
  v_cvt_pk_bf16_f32 v27, v30, v31
  buffer_store_dwordx4 v[24:27], v244, s[24:27], s41 offen offset:2048 sc1
  v_accvgpr_read_b32 v32, a32
  v_accvgpr_read_b32 v33, a33
  v_accvgpr_read_b32 v34, a34
  v_accvgpr_read_b32 v35, a35
  v_accvgpr_read_b32 v36, a48
  v_accvgpr_read_b32 v37, a49
  v_accvgpr_read_b32 v38, a50
  v_accvgpr_read_b32 v39, a51
  v_mul_f32 v32, v32, v192
  v_mul_f32 v33, v33, v192
  v_mul_f32 v34, v34, v192
  v_mul_f32 v35, v35, v192
  v_mul_f32 v36, v36, v192
  v_mul_f32 v37, v37, v192
  v_mul_f32 v38, v38, v192
  v_mul_f32 v39, v39, v192
  v_cvt_pk_bf16_f32 v32, v32, v33
  v_cvt_pk_bf16_f32 v33, v34, v35
  v_cvt_pk_bf16_f32 v34, v36, v37
  v_cvt_pk_bf16_f32 v35, v38, v39
  buffer_store_dwordx4 v[32:35], v244, s[24:27], s40 offen offset:1024 sc1
  v_accvgpr_read_b32 v40, a36
  v_accvgpr_read_b32 v41, a37
  v_accvgpr_read_b32 v42, a38
  v_accvgpr_read_b32 v43, a39
  v_accvgpr_read_b32 v44, a52
  v_accvgpr_read_b32 v45, a53
  v_accvgpr_read_b32 v46, a54
  v_accvgpr_read_b32 v47, a55
  v_mul_f32 v40, v40, v196
  v_mul_f32 v41, v41, v196
  v_mul_f32 v42, v42, v196
  v_mul_f32 v43, v43, v196
  v_mul_f32 v44, v44, v196
  v_mul_f32 v45, v45, v196
  v_mul_f32 v46, v46, v196
  v_mul_f32 v47, v47, v196
  v_cvt_pk_bf16_f32 v40, v40, v41
  v_cvt_pk_bf16_f32 v41, v42, v43
  v_cvt_pk_bf16_f32 v42, v44, v45
  v_cvt_pk_bf16_f32 v43, v46, v47
  buffer_store_dwordx4 v[40:43], v244, s[24:27], s40 offen offset:3072 sc1
  v_accvgpr_read_b32 v48, a40
  v_accvgpr_read_b32 v49, a41
  v_accvgpr_read_b32 v50, a42
  v_accvgpr_read_b32 v51, a43
  v_accvgpr_read_b32 v52, a56
  v_accvgpr_read_b32 v53, a57
  v_accvgpr_read_b32 v54, a58
  v_accvgpr_read_b32 v55, a59
  v_mul_f32 v48, v48, v200
  v_mul_f32 v49, v49, v200
  v_mul_f32 v50, v50, v200
  v_mul_f32 v51, v51, v200
  v_mul_f32 v52, v52, v200
  v_mul_f32 v53, v53, v200
  v_mul_f32 v54, v54, v200
  v_mul_f32 v55, v55, v200
  v_cvt_pk_bf16_f32 v48, v48, v49
  v_cvt_pk_bf16_f32 v49, v50, v51
  v_cvt_pk_bf16_f32 v50, v52, v53
  v_cvt_pk_bf16_f32 v51, v54, v55
  buffer_store_dwordx4 v[48:51], v244, s[24:27], s41 offen offset:1024 sc1
  v_accvgpr_read_b32 v56, a44
  v_accvgpr_read_b32 v57, a45
  v_accvgpr_read_b32 v58, a46
  v_accvgpr_read_b32 v59, a47
  v_accvgpr_read_b32 v60, a60
  v_accvgpr_read_b32 v61, a61
  v_accvgpr_read_b32 v62, a62
  v_accvgpr_read_b32 v63, a63
  v_mul_f32 v56, v56, v204
  v_mul_f32 v57, v57, v204
  v_mul_f32 v58, v58, v204
  v_mul_f32 v59, v59, v204
  v_mul_f32 v60, v60, v204
  v_mul_f32 v61, v61, v204
  v_mul_f32 v62, v62, v204
  v_mul_f32 v63, v63, v204
  v_cvt_pk_bf16_f32 v56, v56, v57
  v_cvt_pk_bf16_f32 v57, v58, v59
  v_cvt_pk_bf16_f32 v58, v60, v61
  v_cvt_pk_bf16_f32 v59, v62, v63
  buffer_store_dwordx4 v[56:59], v244, s[24:27], s41 offen offset:3072 sc1
  v_accvgpr_read_b32 v0, a64
  v_accvgpr_read_b32 v1, a65
  v_accvgpr_read_b32 v2, a66
  v_accvgpr_read_b32 v3, a67
  v_accvgpr_read_b32 v4, a80
  v_accvgpr_read_b32 v5, a81
  v_accvgpr_read_b32 v6, a82
  v_accvgpr_read_b32 v7, a83
  v_mul_f32 v0, v0, v192
  v_mul_f32 v1, v1, v192
  v_mul_f32 v2, v2, v192
  v_mul_f32 v3, v3, v192
  v_mul_f32 v4, v4, v192
  v_mul_f32 v5, v5, v192
  v_mul_f32 v6, v6, v192
  v_mul_f32 v7, v7, v192
  v_cvt_pk_bf16_f32 v0, v0, v1
  v_cvt_pk_bf16_f32 v1, v2, v3
  v_cvt_pk_bf16_f32 v2, v4, v5
  v_cvt_pk_bf16_f32 v3, v6, v7
  buffer_store_dwordx4 v[0:3], v244, s[24:27], s42 offen offset:0 sc1
  v_accvgpr_read_b32 v8, a68
  v_accvgpr_read_b32 v9, a69
  v_accvgpr_read_b32 v10, a70
  v_accvgpr_read_b32 v11, a71
  v_accvgpr_read_b32 v12, a84
  v_accvgpr_read_b32 v13, a85
  v_accvgpr_read_b32 v14, a86
  v_accvgpr_read_b32 v15, a87
  v_mul_f32 v8, v8, v196
  v_mul_f32 v9, v9, v196
  v_mul_f32 v10, v10, v196
  v_mul_f32 v11, v11, v196
  v_mul_f32 v12, v12, v196
  v_mul_f32 v13, v13, v196
  v_mul_f32 v14, v14, v196
  v_mul_f32 v15, v15, v196
  v_cvt_pk_bf16_f32 v8, v8, v9
  v_cvt_pk_bf16_f32 v9, v10, v11
  v_cvt_pk_bf16_f32 v10, v12, v13
  v_cvt_pk_bf16_f32 v11, v14, v15
  buffer_store_dwordx4 v[8:11], v244, s[24:27], s42 offen offset:2048 sc1
  v_accvgpr_read_b32 v16, a72
  v_accvgpr_read_b32 v17, a73
  v_accvgpr_read_b32 v18, a74
  v_accvgpr_read_b32 v19, a75
  v_accvgpr_read_b32 v20, a88
  v_accvgpr_read_b32 v21, a89
  v_accvgpr_read_b32 v22, a90
  v_accvgpr_read_b32 v23, a91
  v_mul_f32 v16, v16, v200
  v_mul_f32 v17, v17, v200
  v_mul_f32 v18, v18, v200
  v_mul_f32 v19, v19, v200
  v_mul_f32 v20, v20, v200
  v_mul_f32 v21, v21, v200
  v_mul_f32 v22, v22, v200
  v_mul_f32 v23, v23, v200
  v_cvt_pk_bf16_f32 v16, v16, v17
  v_cvt_pk_bf16_f32 v17, v18, v19
  v_cvt_pk_bf16_f32 v18, v20, v21
  v_cvt_pk_bf16_f32 v19, v22, v23
  buffer_store_dwordx4 v[16:19], v244, s[24:27], s43 offen offset:0 sc1
  v_accvgpr_read_b32 v24, a76
  v_accvgpr_read_b32 v25, a77
  v_accvgpr_read_b32 v26, a78
  v_accvgpr_read_b32 v27, a79
  v_accvgpr_read_b32 v28, a92
  v_accvgpr_read_b32 v29, a93
  v_accvgpr_read_b32 v30, a94
  v_accvgpr_read_b32 v31, a95
  v_mul_f32 v24, v24, v204
  v_mul_f32 v25, v25, v204
  v_mul_f32 v26, v26, v204
  v_mul_f32 v27, v27, v204
  v_mul_f32 v28, v28, v204
  v_mul_f32 v29, v29, v204
  v_mul_f32 v30, v30, v204
  v_mul_f32 v31, v31, v204
  v_cvt_pk_bf16_f32 v24, v24, v25
  v_cvt_pk_bf16_f32 v25, v26, v27
  v_cvt_pk_bf16_f32 v26, v28, v29
  v_cvt_pk_bf16_f32 v27, v30, v31
  buffer_store_dwordx4 v[24:27], v244, s[24:27], s43 offen offset:2048 sc1
  v_accvgpr_read_b32 v32, a96
  v_accvgpr_read_b32 v33, a97
  v_accvgpr_read_b32 v34, a98
  v_accvgpr_read_b32 v35, a99
  v_accvgpr_read_b32 v36, a112
  v_accvgpr_read_b32 v37, a113
  v_accvgpr_read_b32 v38, a114
  v_accvgpr_read_b32 v39, a115
  v_mul_f32 v32, v32, v192
  v_mul_f32 v33, v33, v192
  v_mul_f32 v34, v34, v192
  v_mul_f32 v35, v35, v192
  v_mul_f32 v36, v36, v192
  v_mul_f32 v37, v37, v192
  v_mul_f32 v38, v38, v192
  v_mul_f32 v39, v39, v192
  v_cvt_pk_bf16_f32 v32, v32, v33
  v_cvt_pk_bf16_f32 v33, v34, v35
  v_cvt_pk_bf16_f32 v34, v36, v37
  v_cvt_pk_bf16_f32 v35, v38, v39
  buffer_store_dwordx4 v[32:35], v244, s[24:27], s42 offen offset:1024 sc1
  v_accvgpr_read_b32 v40, a100
  v_accvgpr_read_b32 v41, a101
  v_accvgpr_read_b32 v42, a102
  v_accvgpr_read_b32 v43, a103
  v_accvgpr_read_b32 v44, a116
  v_accvgpr_read_b32 v45, a117
  v_accvgpr_read_b32 v46, a118
  v_accvgpr_read_b32 v47, a119
  v_mul_f32 v40, v40, v196
  v_mul_f32 v41, v41, v196
  v_mul_f32 v42, v42, v196
  v_mul_f32 v43, v43, v196
  v_mul_f32 v44, v44, v196
  v_mul_f32 v45, v45, v196
  v_mul_f32 v46, v46, v196
  v_mul_f32 v47, v47, v196
  v_cvt_pk_bf16_f32 v40, v40, v41
  v_cvt_pk_bf16_f32 v41, v42, v43
  v_cvt_pk_bf16_f32 v42, v44, v45
  v_cvt_pk_bf16_f32 v43, v46, v47
  buffer_store_dwordx4 v[40:43], v244, s[24:27], s42 offen offset:3072 sc1
  v_accvgpr_read_b32 v48, a104
  v_accvgpr_read_b32 v49, a105
  v_accvgpr_read_b32 v50, a106
  v_accvgpr_read_b32 v51, a107
  v_accvgpr_read_b32 v52, a120
  v_accvgpr_read_b32 v53, a121
  v_accvgpr_read_b32 v54, a122
  v_accvgpr_read_b32 v55, a123
  v_mul_f32 v48, v48, v200
  v_mul_f32 v49, v49, v200
  v_mul_f32 v50, v50, v200
  v_mul_f32 v51, v51, v200
  v_mul_f32 v52, v52, v200
  v_mul_f32 v53, v53, v200
  v_mul_f32 v54, v54, v200
  v_mul_f32 v55, v55, v200
  v_cvt_pk_bf16_f32 v48, v48, v49
  v_cvt_pk_bf16_f32 v49, v50, v51
  v_cvt_pk_bf16_f32 v50, v52, v53
  v_cvt_pk_bf16_f32 v51, v54, v55
  buffer_store_dwordx4 v[48:51], v244, s[24:27], s43 offen offset:1024 sc1
  v_accvgpr_read_b32 v56, a108
  v_accvgpr_read_b32 v57, a109
  v_accvgpr_read_b32 v58, a110
  v_accvgpr_read_b32 v59, a111
  v_accvgpr_read_b32 v60, a124
  v_accvgpr_read_b32 v61, a125
  v_accvgpr_read_b32 v62, a126
  v_accvgpr_read_b32 v63, a127
  v_mul_f32 v56, v56, v204
  v_mul_f32 v57, v57, v204
  v_mul_f32 v58, v58, v204
  v_mul_f32 v59, v59, v204
  v_mul_f32 v60, v60, v204
  v_mul_f32 v61, v61, v204
  v_mul_f32 v62, v62, v204
  v_mul_f32 v63, v63, v204
  v_cvt_pk_bf16_f32 v56, v56, v57
  v_cvt_pk_bf16_f32 v57, v58, v59
  v_cvt_pk_bf16_f32 v58, v60, v61
  v_cvt_pk_bf16_f32 v59, v62, v63
  buffer_store_dwordx4 v[56:59], v244, s[24:27], s43 offen offset:3072 sc1
  s_branch tail_go
.section .rodata,"a"
.p2align 6
.amdhsa_kernel prep_kernel
  .amdhsa_next_free_vgpr 108
  .amdhsa_next_free_sgpr 96
  .amdhsa_accum_offset 108
  .amdhsa_group_segment_fixed_size 0
  .amdhsa_kernarg_size 104
  .amdhsa_user_sgpr_count 2
  .amdhsa_user_sgpr_kernarg_segment_ptr 1
  .amdhsa_system_sgpr_workgroup_id_x 1
.end_amdhsa_kernel
.p2align 6
.amdhsa_kernel attn_kernel
  .amdhsa_next_free_vgpr 512
  .amdhsa_next_free_sgpr 102
  .amdhsa_accum_offset 256
  .amdhsa_group_segment_fixed_size 0
  .amdhsa_kernarg_size 104
  .amdhsa_user_sgpr_count 2
  .amdhsa_user_sgpr_kernarg_segment_ptr 1
  .amdhsa_system_sgpr_workgroup_id_x 1
.end_amdhsa_kernel
```

```asm
; @launch kernel=prep_kernel grid=(256,1,1) block=(256,1,1) lds=0
; @launch kernel=attn_kernel grid=(256,1,1) block=(256,1,1) lds=163840
.amdgcn_target "amdgcn-amd-amdhsa--gfx950"
.text
.globl prep_kernel
.p2align 8
.type prep_kernel,@function
prep_kernel:
  s_cmp_ge_u32 s2, 256
  s_cbranch_scc1 prep_end
  s_load_dwordx2 s[4:5], s[0:1], 0
  s_load_dwordx4 s[36:39], s[0:1], 8
  s_load_dwordx2 s[40:41], s[0:1], 24
  s_load_dwordx2 s[8:9], s[0:1], 48
  s_load_dwordx2 s[10:11], s[0:1], 96
  s_getpc_b64 s[6:7]
prep_hot_pc:
  s_add_u32 s6, s6, prep_hot-prep_hot_pc
  s_addc_u32 s7, s7, 0
  v_lshlrev_b32 v1, 7, v0
  v_min_u32 v1, prep_warm-prep_hot-4, v1
  global_load_dword v106, v1, s[6:7]
prep_hot:
  v_lshrrev_b32 v1, 6, v0
  v_and_b32 v0, 63, v0
  v_readfirstlane_b32 s3, v1
  s_waitcnt lgkmcnt(0)
  s_mov_b32 s12, s4
  s_mov_b32 s13, s5
  s_mov_b32 s14, 2621440
  s_mov_b32 s15, 0x20000
  s_mov_b32 s20, s8
  s_mov_b32 s21, s9
  s_mov_b32 s22, 1280
  s_mov_b32 s23, 0x20000
  s_mov_b32 s24, s10
  s_mov_b32 s25, s11
  s_mov_b32 s26, 8388608
  s_mov_b32 s27, 0x20000
  s_cmp_ge_u32 s3, 2
  s_cbranch_scc1 prep_warm
  s_lshl_b32 s28, s2, 3
  s_lshl_b32 s29, s3, 2
  s_add_u32 s28, s28, s29
  s_mul_i32 s29, s28, 1280
  v_lshrrev_b32 v1, 4, v0
  v_and_b32 v2, 15, v0
  v_lshlrev_b32 v3, 4, v2
  v_mul_u32_u24 v4, 0x500, v1
  v_add_u32 v4, v4, v3
  buffer_load_dwordx4 v[8:11], v4, s[12:15], s29 offen offset:0
  buffer_load_dwordx4 v[12:15], v4, s[12:15], s29 offen offset:256
  buffer_load_dwordx4 v[16:19], v4, s[12:15], s29 offen offset:512
  buffer_load_dwordx4 v[20:23], v4, s[12:15], s29 offen offset:768
  buffer_load_dwordx4 v[24:27], v4, s[12:15], s29 offen offset:1024
  buffer_load_dwordx4 v[28:31], v3, s[20:23], 0 offen offset:0
  buffer_load_dwordx4 v[32:35], v3, s[20:23], 0 offen offset:256
  buffer_load_dwordx4 v[36:39], v3, s[20:23], 0 offen offset:512
  buffer_load_dwordx4 v[40:43], v3, s[20:23], 0 offen offset:768
  buffer_load_dwordx4 v[44:47], v3, s[20:23], 0 offen offset:1024
  s_lshr_b32 s30, s28, 6
  s_mul_i32 s30, s30, 81920
  s_bfe_u32 s31, s28, 0x20004
  s_lshl_b32 s31, s31, 10
  s_add_u32 s30, s30, s31
  s_and_b32 s31, s28, 15
  s_lshl_b32 s31, s31, 4
  s_add_u32 s30, s30, s31
  v_lshrrev_b32 v5, 2, v2
  v_lshlrev_b32 v5, 12, v5
  v_and_b32 v6, 3, v2
  v_lshl_add_u32 v5, v6, 8, v5
  v_lshl_add_u32 v5, v1, 4, v5
  s_mov_b32 s33, 0xffff0000
  s_waitcnt vmcnt(9)
  v_lshlrev_b32 v48, 16, v8
  v_and_b32 v49, s33, v8
  v_lshlrev_b32 v50, 16, v9
  v_and_b32 v51, s33, v9
  v_lshlrev_b32 v52, 16, v10
  v_and_b32 v53, s33, v10
  v_lshlrev_b32 v54, 16, v11
  v_and_b32 v55, s33, v11
  s_waitcnt vmcnt(8)
  v_lshlrev_b32 v56, 16, v12
  v_and_b32 v57, s33, v12
  v_lshlrev_b32 v58, 16, v13
  v_and_b32 v59, s33, v13
  v_lshlrev_b32 v60, 16, v14
  v_and_b32 v61, s33, v14
  v_lshlrev_b32 v62, 16, v15
  v_and_b32 v63, s33, v15
  s_waitcnt vmcnt(7)
  v_lshlrev_b32 v64, 16, v16
  v_and_b32 v65, s33, v16
  v_lshlrev_b32 v66, 16, v17
  v_and_b32 v67, s33, v17
  v_lshlrev_b32 v68, 16, v18
  v_and_b32 v69, s33, v18
  v_lshlrev_b32 v70, 16, v19
  v_and_b32 v71, s33, v19
  s_waitcnt vmcnt(6)
  v_lshlrev_b32 v72, 16, v20
  v_and_b32 v73, s33, v20
  v_lshlrev_b32 v74, 16, v21
  v_and_b32 v75, s33, v21
  v_lshlrev_b32 v76, 16, v22
  v_and_b32 v77, s33, v22
  v_lshlrev_b32 v78, 16, v23
  v_and_b32 v79, s33, v23
  s_waitcnt vmcnt(5)
  v_lshlrev_b32 v80, 16, v24
  v_and_b32 v81, s33, v24
  v_lshlrev_b32 v82, 16, v25
  v_and_b32 v83, s33, v25
  v_lshlrev_b32 v84, 16, v26
  v_and_b32 v85, s33, v26
  v_lshlrev_b32 v86, 16, v27
  v_and_b32 v87, s33, v27
  v_pk_add_f32 v[88:89], v[48:49], v[50:51]
  v_pk_add_f32 v[90:91], v[52:53], v[54:55]
  v_pk_add_f32 v[88:89], v[88:89], v[56:57]
  v_pk_add_f32 v[90:91], v[90:91], v[58:59]
  v_pk_add_f32 v[88:89], v[88:89], v[60:61]
  v_pk_add_f32 v[90:91], v[90:91], v[62:63]
  v_pk_add_f32 v[88:89], v[88:89], v[64:65]
  v_pk_add_f32 v[90:91], v[90:91], v[66:67]
  v_pk_add_f32 v[88:89], v[88:89], v[68:69]
  v_pk_add_f32 v[90:91], v[90:91], v[70:71]
  v_pk_add_f32 v[88:89], v[88:89], v[72:73]
  v_pk_add_f32 v[90:91], v[90:91], v[74:75]
  v_pk_add_f32 v[88:89], v[88:89], v[76:77]
  v_pk_add_f32 v[90:91], v[90:91], v[78:79]
  v_pk_add_f32 v[88:89], v[88:89], v[80:81]
  v_pk_add_f32 v[90:91], v[90:91], v[82:83]
  v_pk_add_f32 v[88:89], v[88:89], v[84:85]
  v_pk_add_f32 v[90:91], v[90:91], v[86:87]
  v_pk_add_f32 v[88:89], v[88:89], v[90:91]
  v_add_f32 v92, v88, v89
  s_nop 1
  v_add_f32_dpp v92, v92, v92 row_ror:8 row_mask:0xf bank_mask:0xf
  s_nop 1
  v_add_f32_dpp v92, v92, v92 row_ror:4 row_mask:0xf bank_mask:0xf
  s_nop 1
  v_add_f32_dpp v92, v92, v92 row_ror:2 row_mask:0xf bank_mask:0xf
  s_nop 1
  v_add_f32_dpp v92, v92, v92 row_ror:1 row_mask:0xf bank_mask:0xf
  v_mul_f32 v92, 0x3acccccd, v92
  v_pk_add_f32 v[94:95], v[48:49], v[92:93] op_sel_hi:[1,0] neg_lo:[0,1] neg_hi:[0,1]
  v_pk_mul_f32 v[88:89], v[94:95], v[94:95]
  v_pk_add_f32 v[96:97], v[50:51], v[92:93] op_sel_hi:[1,0] neg_lo:[0,1] neg_hi:[0,1]
  v_pk_mul_f32 v[90:91], v[96:97], v[96:97]
  v_pk_add_f32 v[94:95], v[52:53], v[92:93] op_sel_hi:[1,0] neg_lo:[0,1] neg_hi:[0,1]
  v_pk_fma_f32 v[88:89], v[94:95], v[94:95], v[88:89]
  v_pk_add_f32 v[96:97], v[54:55], v[92:93] op_sel_hi:[1,0] neg_lo:[0,1] neg_hi:[0,1]
  v_pk_fma_f32 v[90:91], v[96:97], v[96:97], v[90:91]
  v_pk_add_f32 v[94:95], v[56:57], v[92:93] op_sel_hi:[1,0] neg_lo:[0,1] neg_hi:[0,1]
  v_pk_fma_f32 v[88:89], v[94:95], v[94:95], v[88:89]
  v_pk_add_f32 v[96:97], v[58:59], v[92:93] op_sel_hi:[1,0] neg_lo:[0,1] neg_hi:[0,1]
  v_pk_fma_f32 v[90:91], v[96:97], v[96:97], v[90:91]
  v_pk_add_f32 v[94:95], v[60:61], v[92:93] op_sel_hi:[1,0] neg_lo:[0,1] neg_hi:[0,1]
  v_pk_fma_f32 v[88:89], v[94:95], v[94:95], v[88:89]
  v_pk_add_f32 v[96:97], v[62:63], v[92:93] op_sel_hi:[1,0] neg_lo:[0,1] neg_hi:[0,1]
  v_pk_fma_f32 v[90:91], v[96:97], v[96:97], v[90:91]
  v_pk_add_f32 v[94:95], v[64:65], v[92:93] op_sel_hi:[1,0] neg_lo:[0,1] neg_hi:[0,1]
  v_pk_fma_f32 v[88:89], v[94:95], v[94:95], v[88:89]
  v_pk_add_f32 v[96:97], v[66:67], v[92:93] op_sel_hi:[1,0] neg_lo:[0,1] neg_hi:[0,1]
  v_pk_fma_f32 v[90:91], v[96:97], v[96:97], v[90:91]
  v_pk_add_f32 v[94:95], v[68:69], v[92:93] op_sel_hi:[1,0] neg_lo:[0,1] neg_hi:[0,1]
  v_pk_fma_f32 v[88:89], v[94:95], v[94:95], v[88:89]
  v_pk_add_f32 v[96:97], v[70:71], v[92:93] op_sel_hi:[1,0] neg_lo:[0,1] neg_hi:[0,1]
  v_pk_fma_f32 v[90:91], v[96:97], v[96:97], v[90:91]
  v_pk_add_f32 v[94:95], v[72:73], v[92:93] op_sel_hi:[1,0] neg_lo:[0,1] neg_hi:[0,1]
  v_pk_fma_f32 v[88:89], v[94:95], v[94:95], v[88:89]
  v_pk_add_f32 v[96:97], v[74:75], v[92:93] op_sel_hi:[1,0] neg_lo:[0,1] neg_hi:[0,1]
  v_pk_fma_f32 v[90:91], v[96:97], v[96:97], v[90:91]
  v_pk_add_f32 v[94:95], v[76:77], v[92:93] op_sel_hi:[1,0] neg_lo:[0,1] neg_hi:[0,1]
  v_pk_fma_f32 v[88:89], v[94:95], v[94:95], v[88:89]
  v_pk_add_f32 v[96:97], v[78:79], v[92:93] op_sel_hi:[1,0] neg_lo:[0,1] neg_hi:[0,1]
  v_pk_fma_f32 v[90:91], v[96:97], v[96:97], v[90:91]
  v_pk_add_f32 v[94:95], v[80:81], v[92:93] op_sel_hi:[1,0] neg_lo:[0,1] neg_hi:[0,1]
  v_pk_fma_f32 v[88:89], v[94:95], v[94:95], v[88:89]
  v_pk_add_f32 v[96:97], v[82:83], v[92:93] op_sel_hi:[1,0] neg_lo:[0,1] neg_hi:[0,1]
  v_pk_fma_f32 v[90:91], v[96:97], v[96:97], v[90:91]
  v_pk_add_f32 v[94:95], v[84:85], v[92:93] op_sel_hi:[1,0] neg_lo:[0,1] neg_hi:[0,1]
  v_pk_fma_f32 v[88:89], v[94:95], v[94:95], v[88:89]
  v_pk_add_f32 v[96:97], v[86:87], v[92:93] op_sel_hi:[1,0] neg_lo:[0,1] neg_hi:[0,1]
  v_pk_fma_f32 v[90:91], v[96:97], v[96:97], v[90:91]
  v_pk_add_f32 v[88:89], v[88:89], v[90:91]
  v_add_f32 v98, v88, v89
  s_nop 1
  v_add_f32_dpp v98, v98, v98 row_ror:8 row_mask:0xf bank_mask:0xf
  s_nop 1
  v_add_f32_dpp v98, v98, v98 row_ror:4 row_mask:0xf bank_mask:0xf
  s_nop 1
  v_add_f32_dpp v98, v98, v98 row_ror:2 row_mask:0xf bank_mask:0xf
  s_nop 1
  v_add_f32_dpp v98, v98, v98 row_ror:1 row_mask:0xf bank_mask:0xf
  v_mul_f32 v98, 0x3acccccd, v98
  v_cvt_pk_bf16_f32 v92, v92, v92
  v_lshlrev_b32 v92, 16, v92
  v_cvt_pk_bf16_f32 v98, v98, v98
  v_lshlrev_b32 v98, 16, v98
  v_add_f32 v98, 0x3727c5ac, v98
  v_cvt_pk_bf16_f32 v98, v98, v98
  v_lshlrev_b32 v98, 16, v98
  v_sqrt_f32 v98, v98
  s_nop 0
  v_cvt_pk_bf16_f32 v98, v98, v98
  v_lshlrev_b32 v98, 16, v98
  v_rcp_f32 v100, v98
  v_mov_b32 v104, 0
  v_mov_b32 v105, 0
  v_pk_add_f32 v[48:49], v[48:49], v[92:93] op_sel_hi:[1,0] neg_lo:[0,1] neg_hi:[0,1]
  v_pk_add_f32 v[50:51], v[50:51], v[92:93] op_sel_hi:[1,0] neg_lo:[0,1] neg_hi:[0,1]
  v_pk_add_f32 v[52:53], v[52:53], v[92:93] op_sel_hi:[1,0] neg_lo:[0,1] neg_hi:[0,1]
  v_pk_add_f32 v[54:55], v[54:55], v[92:93] op_sel_hi:[1,0] neg_lo:[0,1] neg_hi:[0,1]
  v_pk_add_f32 v[56:57], v[56:57], v[92:93] op_sel_hi:[1,0] neg_lo:[0,1] neg_hi:[0,1]
  v_pk_add_f32 v[58:59], v[58:59], v[92:93] op_sel_hi:[1,0] neg_lo:[0,1] neg_hi:[0,1]
  v_pk_add_f32 v[60:61], v[60:61], v[92:93] op_sel_hi:[1,0] neg_lo:[0,1] neg_hi:[0,1]
  v_pk_add_f32 v[62:63], v[62:63], v[92:93] op_sel_hi:[1,0] neg_lo:[0,1] neg_hi:[0,1]
  v_pk_add_f32 v[64:65], v[64:65], v[92:93] op_sel_hi:[1,0] neg_lo:[0,1] neg_hi:[0,1]
  v_pk_add_f32 v[66:67], v[66:67], v[92:93] op_sel_hi:[1,0] neg_lo:[0,1] neg_hi:[0,1]
  v_pk_add_f32 v[68:69], v[68:69], v[92:93] op_sel_hi:[1,0] neg_lo:[0,1] neg_hi:[0,1]
  v_pk_add_f32 v[70:71], v[70:71], v[92:93] op_sel_hi:[1,0] neg_lo:[0,1] neg_hi:[0,1]
  v_pk_add_f32 v[72:73], v[72:73], v[92:93] op_sel_hi:[1,0] neg_lo:[0,1] neg_hi:[0,1]
  v_pk_add_f32 v[74:75], v[74:75], v[92:93] op_sel_hi:[1,0] neg_lo:[0,1] neg_hi:[0,1]
  v_pk_add_f32 v[76:77], v[76:77], v[92:93] op_sel_hi:[1,0] neg_lo:[0,1] neg_hi:[0,1]
  v_pk_add_f32 v[78:79], v[78:79], v[92:93] op_sel_hi:[1,0] neg_lo:[0,1] neg_hi:[0,1]
  v_pk_add_f32 v[80:81], v[80:81], v[92:93] op_sel_hi:[1,0] neg_lo:[0,1] neg_hi:[0,1]
  v_pk_add_f32 v[82:83], v[82:83], v[92:93] op_sel_hi:[1,0] neg_lo:[0,1] neg_hi:[0,1]
  v_pk_add_f32 v[84:85], v[84:85], v[92:93] op_sel_hi:[1,0] neg_lo:[0,1] neg_hi:[0,1]
  v_pk_add_f32 v[86:87], v[86:87], v[92:93] op_sel_hi:[1,0] neg_lo:[0,1] neg_hi:[0,1]
  v_cvt_pk_bf16_f32 v8, v48, v49
  v_cvt_pk_bf16_f32 v9, v50, v51
  v_cvt_pk_bf16_f32 v10, v52, v53
  v_cvt_pk_bf16_f32 v11, v54, v55
  v_cvt_pk_bf16_f32 v12, v56, v57
  v_cvt_pk_bf16_f32 v13, v58, v59
  v_cvt_pk_bf16_f32 v14, v60, v61
  v_cvt_pk_bf16_f32 v15, v62, v63
  v_cvt_pk_bf16_f32 v16, v64, v65
  v_cvt_pk_bf16_f32 v17, v66, v67
  v_cvt_pk_bf16_f32 v18, v68, v69
  v_cvt_pk_bf16_f32 v19, v70, v71
  v_cvt_pk_bf16_f32 v20, v72, v73
  v_cvt_pk_bf16_f32 v21, v74, v75
  v_cvt_pk_bf16_f32 v22, v76, v77
  v_cvt_pk_bf16_f32 v23, v78, v79
  v_cvt_pk_bf16_f32 v24, v80, v81
  v_cvt_pk_bf16_f32 v25, v82, v83
  v_cvt_pk_bf16_f32 v26, v84, v85
  v_cvt_pk_bf16_f32 v27, v86, v87
  v_lshlrev_b32 v48, 16, v8
  v_and_b32 v49, s33, v8
  v_lshlrev_b32 v50, 16, v9
  v_and_b32 v51, s33, v9
  v_lshlrev_b32 v52, 16, v10
  v_and_b32 v53, s33, v10
  v_lshlrev_b32 v54, 16, v11
  v_and_b32 v55, s33, v11
  v_lshlrev_b32 v56, 16, v12
  v_and_b32 v57, s33, v12
  v_lshlrev_b32 v58, 16, v13
  v_and_b32 v59, s33, v13
  v_lshlrev_b32 v60, 16, v14
  v_and_b32 v61, s33, v14
  v_lshlrev_b32 v62, 16, v15
  v_and_b32 v63, s33, v15
  v_lshlrev_b32 v64, 16, v16
  v_and_b32 v65, s33, v16
  v_lshlrev_b32 v66, 16, v17
  v_and_b32 v67, s33, v17
  v_lshlrev_b32 v68, 16, v18
  v_and_b32 v69, s33, v18
  v_lshlrev_b32 v70, 16, v19
  v_and_b32 v71, s33, v19
  v_lshlrev_b32 v72, 16, v20
  v_and_b32 v73, s33, v20
  v_lshlrev_b32 v74, 16, v21
  v_and_b32 v75, s33, v21
  v_lshlrev_b32 v76, 16, v22
  v_and_b32 v77, s33, v22
  v_lshlrev_b32 v78, 16, v23
  v_and_b32 v79, s33, v23
  v_lshlrev_b32 v80, 16, v24
  v_and_b32 v81, s33, v24
  v_lshlrev_b32 v82, 16, v25
  v_and_b32 v83, s33, v25
  v_lshlrev_b32 v84, 16, v26
  v_and_b32 v85, s33, v26
  v_lshlrev_b32 v86, 16, v27
  v_and_b32 v87, s33, v27
  v_pk_mul_f32 v[48:49], v[48:49], v[100:101] op_sel_hi:[1,0]
  v_pk_mul_f32 v[50:51], v[50:51], v[100:101] op_sel_hi:[1,0]
  v_pk_mul_f32 v[52:53], v[52:53], v[100:101] op_sel_hi:[1,0]
  v_pk_mul_f32 v[54:55], v[54:55], v[100:101] op_sel_hi:[1,0]
  v_pk_mul_f32 v[56:57], v[56:57], v[100:101] op_sel_hi:[1,0]
  v_pk_mul_f32 v[58:59], v[58:59], v[100:101] op_sel_hi:[1,0]
  v_pk_mul_f32 v[60:61], v[60:61], v[100:101] op_sel_hi:[1,0]
  v_pk_mul_f32 v[62:63], v[62:63], v[100:101] op_sel_hi:[1,0]
  v_pk_mul_f32 v[64:65], v[64:65], v[100:101] op_sel_hi:[1,0]
  v_pk_mul_f32 v[66:67], v[66:67], v[100:101] op_sel_hi:[1,0]
  v_pk_mul_f32 v[68:69], v[68:69], v[100:101] op_sel_hi:[1,0]
  v_pk_mul_f32 v[70:71], v[70:71], v[100:101] op_sel_hi:[1,0]
  v_pk_mul_f32 v[72:73], v[72:73], v[100:101] op_sel_hi:[1,0]
  v_pk_mul_f32 v[74:75], v[74:75], v[100:101] op_sel_hi:[1,0]
  v_pk_mul_f32 v[76:77], v[76:77], v[100:101] op_sel_hi:[1,0]
  v_pk_mul_f32 v[78:79], v[78:79], v[100:101] op_sel_hi:[1,0]
  v_pk_mul_f32 v[80:81], v[80:81], v[100:101] op_sel_hi:[1,0]
  v_pk_mul_f32 v[82:83], v[82:83], v[100:101] op_sel_hi:[1,0]
  v_pk_mul_f32 v[84:85], v[84:85], v[100:101] op_sel_hi:[1,0]
  v_pk_mul_f32 v[86:87], v[86:87], v[100:101] op_sel_hi:[1,0]
  v_cvt_pk_bf16_f32 v8, v48, v49
  v_cvt_pk_bf16_f32 v9, v50, v51
  v_cvt_pk_bf16_f32 v10, v52, v53
  v_cvt_pk_bf16_f32 v11, v54, v55
  buffer_store_dwordx4 v[8:11], v5, s[24:27], s30 offen
  s_add_u32 s30, s30, 16384
  v_cvt_pk_bf16_f32 v12, v56, v57
  v_cvt_pk_bf16_f32 v13, v58, v59
  v_cvt_pk_bf16_f32 v14, v60, v61
  v_cvt_pk_bf16_f32 v15, v62, v63
  buffer_store_dwordx4 v[12:15], v5, s[24:27], s30 offen
  s_add_u32 s30, s30, 16384
  v_cvt_pk_bf16_f32 v16, v64, v65
  v_cvt_pk_bf16_f32 v17, v66, v67
  v_cvt_pk_bf16_f32 v18, v68, v69
  v_cvt_pk_bf16_f32 v19, v70, v71
  buffer_store_dwordx4 v[16:19], v5, s[24:27], s30 offen
  s_add_u32 s30, s30, 16384
  v_cvt_pk_bf16_f32 v20, v72, v73
  v_cvt_pk_bf16_f32 v21, v74, v75
  v_cvt_pk_bf16_f32 v22, v76, v77
  v_cvt_pk_bf16_f32 v23, v78, v79
  buffer_store_dwordx4 v[20:23], v5, s[24:27], s30 offen
  s_add_u32 s30, s30, 16384
  v_cvt_pk_bf16_f32 v24, v80, v81
  v_cvt_pk_bf16_f32 v25, v82, v83
  v_cvt_pk_bf16_f32 v26, v84, v85
  v_cvt_pk_bf16_f32 v27, v86, v87
  buffer_store_dwordx4 v[24:27], v5, s[24:27], s30 offen
  s_add_u32 s30, s30, 16384
  s_waitcnt vmcnt(9)
  v_dot2_f32_bf16 v104, v8, v28, v104
  v_dot2_f32_bf16 v105, v9, v29, v105
  v_dot2_f32_bf16 v104, v10, v30, v104
  v_dot2_f32_bf16 v105, v11, v31, v105
  s_waitcnt vmcnt(8)
  v_dot2_f32_bf16 v104, v12, v32, v104
  v_dot2_f32_bf16 v105, v13, v33, v105
  v_dot2_f32_bf16 v104, v14, v34, v104
  v_dot2_f32_bf16 v105, v15, v35, v105
  s_waitcnt vmcnt(7)
  v_dot2_f32_bf16 v104, v16, v36, v104
  v_dot2_f32_bf16 v105, v17, v37, v105
  v_dot2_f32_bf16 v104, v18, v38, v104
  v_dot2_f32_bf16 v105, v19, v39, v105
  s_waitcnt vmcnt(6)
  v_dot2_f32_bf16 v104, v20, v40, v104
  v_dot2_f32_bf16 v105, v21, v41, v105
  v_dot2_f32_bf16 v104, v22, v42, v104
  v_dot2_f32_bf16 v105, v23, v43, v105
  s_waitcnt vmcnt(5)
  v_dot2_f32_bf16 v104, v24, v44, v104
  v_dot2_f32_bf16 v105, v25, v45, v105
  v_dot2_f32_bf16 v104, v26, v46, v104
  v_dot2_f32_bf16 v105, v27, v47, v105
  s_nop 2
  v_add_f32 v104, v104, v105
  s_nop 1
  v_add_f32_dpp v104, v104, v104 row_ror:8 row_mask:0xf bank_mask:0xf
  s_nop 1
  v_add_f32_dpp v104, v104, v104 row_ror:4 row_mask:0xf bank_mask:0xf
  s_nop 1
  v_add_f32_dpp v104, v104, v104 row_ror:2 row_mask:0xf bank_mask:0xf
  s_nop 1
  v_add_f32_dpp v104, v104, v104 row_ror:1 row_mask:0xf bank_mask:0xf
  v_cvt_pk_bf16_f32 v104, v104, v104
  v_lshlrev_b32 v104, 16, v104
  v_ashrrev_i32 v105, 31, v104
  v_or_b32 v105, 0x80000000, v105
  v_xor_b32 v104, v104, v105
  v_and_b32 v104, s33, v104
  v_add_u32 v6, s28, v1
  v_sub_u32 v7, 0xffff, v6
  v_or_b32 v104, v104, v7
  v_lshlrev_b32 v6, 2, v6
  s_mov_b32 s31, 2621440
  v_cmp_eq_u32 vcc, 0, v2
  s_nop 0
  s_and_saveexec_b64 s[34:35], vcc
  buffer_store_dword v104, v6, s[24:27], s31 offen
  s_endpgm
prep_warm:
  v_mov_b32 v4, 0
  v_lshlrev_b32 v5, 8, v0
  s_cmp_eq_u32 s2, 0
  s_cselect_b32 s30, 0, 0x40000000
  v_or_b32 v5, s30, v5
  s_mov_b32 s30, 2818048
  buffer_store_dword v4, v5, s[24:27], s30 offen
  v_lshlrev_b32 v5, 24, v0
  s_lshl_b32 s30, s2, 7
  s_add_u32 s30, s30, 2834432
  buffer_store_dword v4, v5, s[24:27], s30 offen
  s_and_b32 s28, s2, 7
  s_lshr_b32 s29, s2, 3
  s_lshl_b32 s29, s29, 1
  s_add_u32 s29, s29, s3
  s_sub_u32 s29, s29, 2
  s_getpc_b64 s[6:7]
prep_warm_pc:
  s_add_u32 s6, s6, attn_kernel-prep_warm_pc
  s_addc_u32 s7, s7, 0
  v_and_b32 v1, 7, v0
  s_lshl_b32 s30, s29, 3
  v_add_u32 v1, s30, v1
  v_lshlrev_b32 v1, 7, v1
  v_min_u32 v1, attn_end-attn_kernel-4, v1
  global_load_dword v8, v1, s[6:7]
  s_mov_b32 s16, s40
  s_mov_b32 s17, s41
  s_mov_b32 s18, 5242880
  s_mov_b32 s19, 0x20000
  v_lshrrev_b32 v1, 3, v0
  v_lshlrev_b32 v1, 19, v1
  v_and_b32 v2, 7, v0
  v_lshl_add_u32 v1, v2, 7, v1
  s_lshl_b32 s30, s29, 13
  s_lshl_b32 s31, s28, 10
  s_add_u32 s30, s30, s31
  buffer_load_dword v8, v1, s[16:19], s30 offen
  v_add_u32 v1, 0x400000, v1
  buffer_load_dword v8, v1, s[16:19], s30 offen
  s_lshl_b32 s30, s28, 21
  s_lshr_b32 s31, s29, 4
  s_lshl_b32 s31, s31, 19
  s_add_u32 s30, s30, s31
  s_add_u32 s16, s36, s30
  s_addc_u32 s17, s37, 0
  s_mov_b32 s18, 49152
  s_mov_b32 s19, 0x20000
  s_add_u32 s44, s38, s30
  s_addc_u32 s45, s39, 0
  s_mov_b32 s46, 32768
  s_mov_b32 s47, 0x20000
  s_and_b32 s31, s29, 15
  s_mul_i32 s30, s31, 3072
  s_lshl_b32 s31, s31, 11
  v_lshlrev_b32 v1, 7, v0
  v_lshrrev_b32 v2, 4, v0
  v_lshl_add_u32 v2, v2, 20, v1
  v_cmp_gt_u32 vcc, 24, v0
  v_mov_b32 v3, 0x100000
  s_nop 0
  v_cndmask_b32 v1, v3, v1, vcc
  buffer_load_dword v8, v1, s[16:19], s30 offen
  buffer_load_dword v8, v2, s[44:47], s31 offen
prep_end:
  s_endpgm
.globl attn_kernel
.p2align 8
.type attn_kernel,@function
attn_kernel:
  s_cmp_ge_u32 s2, 256
  s_cbranch_scc1 attn_end
  s_load_dwordx4 s[4:7], s[0:1], 8
  s_load_dwordx2 s[8:9], s[0:1], 24
  s_load_dwordx2 s[10:11], s[0:1], 96
  s_load_dwordx2 s[88:89], s[0:1], 32
  s_load_dwordx2 s[90:91], s[0:1], 56
  s_load_dwordx4 s[92:95], s[0:1], 64
  s_load_dwordx2 s[60:61], s[0:1], 0
  s_load_dwordx2 s[62:63], s[0:1], 80
  s_getpc_b64 s[48:49]
attn_hot_pc:
  s_add_u32 s48, s48, attn_hot-attn_hot_pc
  s_addc_u32 s49, s49, 0
  v_lshlrev_b32 v249, 7, v0
  v_min_u32 v249, attn_end-attn_hot-4, v249
  global_load_dword v255, v249, s[48:49]
  v_add_u32 v249, 0x8000, v249
  v_min_u32 v249, attn_end-attn_hot-4, v249
  global_load_dword v255, v249, s[48:49]
  v_lshrrev_b32 v249, 6, v0
  v_and_b32 v245, 63, v0
  v_readfirstlane_b32 s3, v249
  s_and_b32 s36, s2, 7
  s_lshl_b32 s36, s36, 2
  s_lshr_b32 s37, s2, 6
  s_add_u32 s36, s36, s37
  s_bfe_u32 s37, s2, 0x30003
  s_lshl_b32 s37, s37, 2
  s_add_u32 s37, s37, s3
  s_lshl_b32 s28, s3, 12
  v_lshlrev_b32 v242, 4, v245
  v_add_u32 v243, 0x1000, v242
  s_mul_i32 s30, s37, 81920
  v_lshrrev_b32 v248, 4, v245
  v_and_b32 v247, 15, v245
  s_lshl_b32 s38, s3, 17
  v_lshlrev_b32 v249, 13, v248
  v_add_u32 v249, s38, v249
  v_or_b32 v250, 0, v248
  v_lshlrev_b32 v250, 1, v250
  v_xor_b32 v250, v250, v247
  v_lshl_add_u32 v238, v250, 4, v249
  v_or_b32 v250, 0, v248
  v_lshlrev_b32 v250, 1, v250
  v_xor_b32 v250, v250, v247
  v_lshl_add_u32 v239, v250, 4, v249
  v_add_u32 v239, 31744, v239
  v_or_b32 v250, 4, v248
  v_lshlrev_b32 v250, 1, v250
  v_xor_b32 v250, v250, v247
  v_lshl_add_u32 v240, v250, 4, v249
  v_add_u32 v240, 63488, v240
  v_or_b32 v250, 4, v248
  v_lshlrev_b32 v250, 1, v250
  v_xor_b32 v250, v250, v247
  v_lshl_add_u32 v241, v250, 4, v249
  v_add_u32 v241, 95232, v241
  s_waitcnt lgkmcnt(0)
  s_lshl_b32 s38, s36, 8
  s_add_u32 s20, s8, s38
  s_addc_u32 s21, s9, 0
  s_mov_b32 s22, 5242880
  s_mov_b32 s23, 0x20000
  s_sub_u32 s22, s22, s38
  s_mov_b32 s24, s10
  s_mov_b32 s25, s11
  s_mov_b32 s26, 30408704
  s_mov_b32 s27, 0x20000
  s_mov_b32 s31, 0
  s_lshl_b32 s38, s36, 19
  s_add_u32 s12, s4, s38
  s_addc_u32 s13, s5, 0
  s_mov_b32 s14, 524288
  s_mov_b32 s15, 0x20000
  s_add_u32 s16, s6, s38
  s_addc_u32 s17, s7, 0
  s_mov_b32 s18, 524288
  s_mov_b32 s19, 0x20000
  v_lshlrev_b32 v251, 7, v247
  v_lshl_add_u32 v251, v248, 13, v251
  s_lshr_b32 s49, s2, 3
  s_mul_i32 s49, s49, 81920
  s_lshl_b32 s38, s3, 11
  s_add_u32 s49, s49, s38
  s_add_u32 m0, s28, 98304
  s_nop 0
  buffer_load_dwordx4 v238, s[20:23], s31 offen offset:0 lds
  buffer_load_dwordx4 v239, s[20:23], s31 offen offset:1024 lds
  buffer_load_dwordx4 v240, s[20:23], s31 offen offset:2048 lds
  buffer_load_dwordx4 v241, s[20:23], s31 offen offset:3072 lds
  s_add_u32 s31, s31, 0x80000
  buffer_load_dwordx4 a[0:3], v242, s[24:27], s30 offen offset:0
  buffer_load_dwordx4 a[4:7], v242, s[24:27], s30 offen offset:1024
  buffer_load_dwordx4 a[8:11], v242, s[24:27], s30 offen offset:2048
  buffer_load_dwordx4 a[12:15], v242, s[24:27], s30 offen offset:3072
  buffer_load_dwordx4 a[16:19], v243, s[24:27], s30 offen offset:0
  buffer_load_dwordx4 a[20:23], v243, s[24:27], s30 offen offset:1024
  buffer_load_dwordx4 a[24:27], v243, s[24:27], s30 offen offset:2048
  buffer_load_dwordx4 a[28:31], v243, s[24:27], s30 offen offset:3072
  s_add_u32 s30, s30, 8192
  s_add_u32 m0, s28, 114688
  s_nop 0
  buffer_load_dwordx4 v238, s[20:23], s31 offen offset:0 lds
  buffer_load_dwordx4 v239, s[20:23], s31 offen offset:1024 lds
  buffer_load_dwordx4 v240, s[20:23], s31 offen offset:2048 lds
  buffer_load_dwordx4 v241, s[20:23], s31 offen offset:3072 lds
  s_add_u32 s31, s31, 0x80000
  buffer_load_dwordx4 a[32:35], v242, s[24:27], s30 offen offset:0
  buffer_load_dwordx4 a[36:39], v242, s[24:27], s30 offen offset:1024
  buffer_load_dwordx4 a[40:43], v242, s[24:27], s30 offen offset:2048
  buffer_load_dwordx4 a[44:47], v242, s[24:27], s30 offen offset:3072
  buffer_load_dwordx4 a[48:51], v243, s[24:27], s30 offen offset:0
  buffer_load_dwordx4 a[52:55], v243, s[24:27], s30 offen offset:1024
  buffer_load_dwordx4 a[56:59], v243, s[24:27], s30 offen offset:2048
  buffer_load_dwordx4 a[60:63], v243, s[24:27], s30 offen offset:3072
  s_add_u32 s30, s30, 8192
  s_add_u32 m0, s28, 65536
  s_nop 0
  buffer_load_dwordx4 v238, s[20:23], s31 offen offset:0 lds
  buffer_load_dwordx4 v239, s[20:23], s31 offen offset:1024 lds
  buffer_load_dwordx4 v240, s[20:23], s31 offen offset:2048 lds
  buffer_load_dwordx4 v241, s[20:23], s31 offen offset:3072 lds
  s_add_u32 s31, s31, 0x80000
  buffer_load_dwordx4 a[64:67], v242, s[24:27], s30 offen offset:0
  buffer_load_dwordx4 a[68:71], v242, s[24:27], s30 offen offset:1024
  buffer_load_dwordx4 a[72:75], v242, s[24:27], s30 offen offset:2048
  buffer_load_dwordx4 a[76:79], v242, s[24:27], s30 offen offset:3072
  buffer_load_dwordx4 a[80:83], v243, s[24:27], s30 offen offset:0
  buffer_load_dwordx4 a[84:87], v243, s[24:27], s30 offen offset:1024
  buffer_load_dwordx4 a[88:91], v243, s[24:27], s30 offen offset:2048
  buffer_load_dwordx4 a[92:95], v243, s[24:27], s30 offen offset:3072
  s_add_u32 s30, s30, 8192
  v_lshlrev_b32 v249, 8, v248
  v_add_u32 v249, s28, v249
  v_add_u32 v250, 0, v248
  v_xor_b32 v250, v250, v247
  v_lshl_add_u32 v232, v250, 4, v249
  v_add_u32 v250, 4, v248
  v_xor_b32 v250, v250, v247
  v_lshl_add_u32 v233, v250, 4, v249
  v_add_u32 v250, 8, v248
  v_xor_b32 v250, v250, v247
  v_lshl_add_u32 v234, v250, 4, v249
  v_add_u32 v250, 12, v248
  v_xor_b32 v250, v250, v247
  v_lshl_add_u32 v235, v250, 4, v249
  v_add_u32 v250, 0, v248
  v_lshlrev_b32 v250, 1, v250
  v_xor_b32 v250, v250, v247
  v_lshl_add_u32 v236, v250, 4, v249
  v_add_u32 v250, 4, v248
  v_lshlrev_b32 v250, 1, v250
  v_xor_b32 v250, v250, v247
  v_lshl_add_u32 v237, v250, 4, v249
  v_lshrrev_b32 v249, 1, v248
  v_and_b32 v250, 1, v248
  v_lshl_or_b32 v249, v250, 1, v249
  v_xor_b32 v249, v249, v247
  v_lshlrev_b32 v249, 4, v249
  v_lshl_add_u32 v212, v247, 8, v249
  v_xor_b32 v213, 64, v212
  v_xor_b32 v214, 128, v212
  v_xor_b32 v215, 192, v212
  v_bfe_u32 v246, v245, 2, 2
  v_and_b32 v247, 3, v245
  v_lshlrev_b32 v247, 3, v247
  v_add_u32 v247, 65536, v247
  v_lshl_add_u32 v249, v248, 2, v246
  v_and_b32 v250, 7, v249
  v_lshl_add_u32 v250, v250, 5, v247
  v_lshl_add_u32 v216, v249, 8, v250
  v_lshl_add_u32 v249, v248, 3, v246
  v_and_b32 v250, 1, v248
  v_lshl_add_u32 v250, v250, 2, v246
  v_lshl_add_u32 v250, v250, 5, v247
  v_lshl_add_u32 v224, v249, 8, v250
  v_xor_b32 v217, 32, v216
  v_xor_b32 v225, 32, v224
  v_xor_b32 v218, 64, v216
  v_xor_b32 v226, 64, v224
  v_xor_b32 v219, 96, v216
  v_xor_b32 v227, 96, v224
  v_xor_b32 v220, 128, v216
  v_xor_b32 v228, 128, v224
  v_xor_b32 v221, 160, v216
  v_xor_b32 v229, 160, v224
  v_xor_b32 v222, 192, v216
  v_xor_b32 v230, 192, v224
  v_xor_b32 v223, 224, v216
  v_xor_b32 v231, 224, v224
  s_lshr_b32 s38, s2, 3
  s_min_u32 s38, s38, 26
  s_and_b32 s39, s2, 7
  s_mul_i32 s39, s39, 27
  s_add_u32 s33, s38, s39
  s_mul_i32 s50, s3, 6144
  s_add_u32 s50, s50, 133120
  v_mov_b32 v244, v242
  s_lshl_b32 s40, s37, 19
  s_lshl_b32 s38, s36, 14
  s_add_u32 s40, s40, s38
  s_add_u32 s40, s40, 8388608
  s_add_u32 s41, s40, 4096
  s_add_u32 s42, s40, 8192
  s_add_u32 s43, s40, 12288
  s_mov_b32 s34, 0x3e0293ee
  s_mov_b32 s29, 0
  v_and_b32 v249, 15, v245
  v_cmp_eq_u32 vcc, 0, v249
  v_mov_b32 v249, 0x3f803f80
  s_nop 0
  v_cndmask_b32 v249, 0, v249, vcc
  v_accvgpr_write_b32 a208, v249
  v_accvgpr_write_b32 a209, v249
  v_accvgpr_write_b32 a210, v249
  v_accvgpr_write_b32 a211, v249
attn_hot:
  s_waitcnt vmcnt(32)
  s_barrier
  ds_read_b64_tr_b16 a[160:161], v224 offset:32768
  ds_read_b64_tr_b16 a[162:163], v224 offset:33792
  ds_read_b64_tr_b16 a[164:165], v224 offset:40960
  ds_read_b64_tr_b16 a[166:167], v224 offset:41984
  ds_read_b64_tr_b16 a[168:169], v225 offset:32768
  ds_read_b64_tr_b16 a[170:171], v225 offset:33792
  ds_read_b64_tr_b16 a[172:173], v225 offset:40960
  ds_read_b64_tr_b16 a[174:175], v225 offset:41984
  s_waitcnt vmcnt(24) lgkmcnt(4)
  v_mfma_f32_16x16x32_bf16 v[0:3], a[160:163], a[0:3], 0
  ds_read_b64_tr_b16 a[176:177], v226 offset:32768
  s_add_u32 m0, s28, 81920
  v_mfma_f32_16x16x32_bf16 v[0:3], a[164:167], a[16:19], v[0:3]
  buffer_load_dwordx4 v238, s[20:23], s31 offen offset:0 lds
  v_mfma_f32_16x16x32_bf16 v[4:7], a[164:167], a[20:23], 0
  ds_read_b64_tr_b16 a[178:179], v226 offset:33792
  buffer_load_dwordx4 v239, s[20:23], s31 offen offset:1024 lds
  v_mfma_f32_16x16x32_bf16 v[4:7], a[160:163], a[4:7], v[4:7]
  buffer_load_dwordx4 v240, s[20:23], s31 offen offset:2048 lds
  v_mfma_f32_16x16x32_bf16 v[8:11], a[160:163], a[8:11], 0
  ds_read_b64_tr_b16 a[180:181], v226 offset:40960
  buffer_load_dwordx4 v241, s[20:23], s31 offen offset:3072 lds
  s_add_u32 s31, s31, 0x80000
  v_mfma_f32_16x16x32_bf16 v[8:11], a[164:167], a[24:27], v[8:11]
  buffer_load_dwordx4 a[96:99], v242, s[24:27], s30 offen offset:0
  v_mfma_f32_16x16x32_bf16 v[12:15], a[164:167], a[28:31], 0
  ds_read_b64_tr_b16 a[182:183], v226 offset:41984
  buffer_load_dwordx4 a[100:103], v242, s[24:27], s30 offen offset:1024
  v_mfma_f32_16x16x32_bf16 v[12:15], a[160:163], a[12:15], v[12:15]
  s_waitcnt lgkmcnt(4)
  buffer_load_dwordx4 a[104:107], v242, s[24:27], s30 offen offset:2048
  v_mfma_f32_16x16x32_bf16 v[16:19], a[168:171], a[0:3], 0
  ds_read_b64_tr_b16 a[184:185], v227 offset:32768
  buffer_load_dwordx4 a[108:111], v242, s[24:27], s30 offen offset:3072
  v_mfma_f32_16x16x32_bf16 v[16:19], a[172:175], a[16:19], v[16:19]
  buffer_load_dwordx4 a[112:115], v243, s[24:27], s30 offen offset:0
  v_mfma_f32_16x16x32_bf16 v[20:23], a[172:175], a[20:23], 0
  ds_read_b64_tr_b16 a[186:187], v227 offset:33792
  buffer_load_dwordx4 a[116:119], v243, s[24:27], s30 offen offset:1024
  v_mfma_f32_16x16x32_bf16 v[20:23], a[168:171], a[4:7], v[20:23]
  buffer_load_dwordx4 a[120:123], v243, s[24:27], s30 offen offset:2048
  v_mfma_f32_16x16x32_bf16 v[24:27], a[168:171], a[8:11], 0
  ds_read_b64_tr_b16 a[188:189], v227 offset:40960
  buffer_load_dwordx4 a[124:127], v243, s[24:27], s30 offen offset:3072
  s_add_u32 s30, s30, 8192
  v_mfma_f32_16x16x32_bf16 v[24:27], a[172:175], a[24:27], v[24:27]
  v_mfma_f32_16x16x32_bf16 v[28:31], a[172:175], a[28:31], 0
  ds_read_b64_tr_b16 a[190:191], v227 offset:41984
  v_mfma_f32_16x16x32_bf16 v[28:31], a[168:171], a[12:15], v[28:31]
  s_waitcnt lgkmcnt(4)
  v_mfma_f32_16x16x32_bf16 v[32:35], a[176:179], a[0:3], 0
  ds_read_b64_tr_b16 a[160:161], v228 offset:32768
  v_mfma_f32_16x16x32_bf16 v[32:35], a[180:183], a[16:19], v[32:35]
  v_mfma_f32_16x16x32_bf16 v[36:39], a[180:183], a[20:23], 0
  ds_read_b64_tr_b16 a[162:163], v228 offset:33792
  v_mfma_f32_16x16x32_bf16 v[36:39], a[176:179], a[4:7], v[36:39]
  v_mfma_f32_16x16x32_bf16 v[40:43], a[176:179], a[8:11], 0
  ds_read_b64_tr_b16 a[164:165], v228 offset:40960
  v_mfma_f32_16x16x32_bf16 v[40:43], a[180:183], a[24:27], v[40:43]
  v_mfma_f32_16x16x32_bf16 v[44:47], a[180:183], a[28:31], 0
  ds_read_b64_tr_b16 a[166:167], v228 offset:41984
  v_mfma_f32_16x16x32_bf16 v[44:47], a[176:179], a[12:15], v[44:47]
  s_waitcnt lgkmcnt(4)
  v_mfma_f32_16x16x32_bf16 v[48:51], a[184:187], a[0:3], 0
  ds_read_b64_tr_b16 a[168:169], v229 offset:32768
  v_mfma_f32_16x16x32_bf16 v[48:51], a[188:191], a[16:19], v[48:51]
  v_mfma_f32_16x16x32_bf16 v[52:55], a[188:191], a[20:23], 0
  ds_read_b64_tr_b16 a[170:171], v229 offset:33792
  v_mfma_f32_16x16x32_bf16 v[52:55], a[184:187], a[4:7], v[52:55]
  v_mfma_f32_16x16x32_bf16 v[56:59], a[184:187], a[8:11], 0
  ds_read_b64_tr_b16 a[172:173], v229 offset:40960
  v_mfma_f32_16x16x32_bf16 v[56:59], a[188:191], a[24:27], v[56:59]
  v_mfma_f32_16x16x32_bf16 v[60:63], a[188:191], a[28:31], 0
  ds_read_b64_tr_b16 a[174:175], v229 offset:41984
  v_mfma_f32_16x16x32_bf16 v[60:63], a[184:187], a[12:15], v[60:63]
  s_waitcnt lgkmcnt(4)
  v_mfma_f32_16x16x32_bf16 v[64:67], a[160:163], a[0:3], 0
  ds_read_b64_tr_b16 a[176:177], v230 offset:32768
  v_mfma_f32_16x16x32_bf16 v[64:67], a[164:167], a[16:19], v[64:67]
  v_mfma_f32_16x16x32_bf16 v[68:71], a[164:167], a[20:23], 0
  ds_read_b64_tr_b16 a[178:179], v230 offset:33792
  v_mfma_f32_16x16x32_bf16 v[68:71], a[160:163], a[4:7], v[68:71]
  v_mfma_f32_16x16x32_bf16 v[72:75], a[160:163], a[8:11], 0
  ds_read_b64_tr_b16 a[180:181], v230 offset:40960
  v_mfma_f32_16x16x32_bf16 v[72:75], a[164:167], a[24:27], v[72:75]
  v_mfma_f32_16x16x32_bf16 v[76:79], a[164:167], a[28:31], 0
  ds_read_b64_tr_b16 a[182:183], v230 offset:41984
  v_mfma_f32_16x16x32_bf16 v[76:79], a[160:163], a[12:15], v[76:79]
  s_waitcnt lgkmcnt(4)
  v_mfma_f32_16x16x32_bf16 v[80:83], a[168:171], a[0:3], 0
  ds_read_b64_tr_b16 a[184:185], v231 offset:32768
  v_mfma_f32_16x16x32_bf16 v[80:83], a[172:175], a[16:19], v[80:83]
  v_mfma_f32_16x16x32_bf16 v[84:87], a[172:175], a[20:23], 0
  ds_read_b64_tr_b16 a[186:187], v231 offset:33792
  v_mfma_f32_16x16x32_bf16 v[84:87], a[168:171], a[4:7], v[84:87]
  s_waitcnt vmcnt(32)
  v_mfma_f32_16x16x32_bf16 v[88:91], a[168:171], a[8:11], 0
  ds_read_b64_tr_b16 a[188:189], v231 offset:40960
  v_mfma_f32_16x16x32_bf16 v[88:91], a[172:175], a[24:27], v[88:91]
  s_barrier
  v_mfma_f32_16x16x32_bf16 v[92:95], a[172:175], a[28:31], 0
  ds_read_b64_tr_b16 a[190:191], v231 offset:41984
  v_mfma_f32_16x16x32_bf16 v[92:95], a[168:171], a[12:15], v[92:95]
  s_waitcnt lgkmcnt(4)
  v_mfma_f32_16x16x32_bf16 v[96:99], a[176:179], a[0:3], 0
  ds_read_b64_tr_b16 a[160:161], v224 offset:49152
  v_mfma_f32_16x16x32_bf16 v[96:99], a[180:183], a[16:19], v[96:99]
  v_mfma_f32_16x16x32_bf16 v[100:103], a[180:183], a[20:23], 0
  ds_read_b64_tr_b16 a[162:163], v224 offset:50176
  v_mfma_f32_16x16x32_bf16 v[100:103], a[176:179], a[4:7], v[100:103]
  v_mfma_f32_16x16x32_bf16 v[104:107], a[176:179], a[8:11], 0
  ds_read_b64_tr_b16 a[164:165], v224 offset:57344
  v_mfma_f32_16x16x32_bf16 v[104:107], a[180:183], a[24:27], v[104:107]
  v_mfma_f32_16x16x32_bf16 v[108:111], a[180:183], a[28:31], 0
  ds_read_b64_tr_b16 a[166:167], v224 offset:58368
  v_mfma_f32_16x16x32_bf16 v[108:111], a[176:179], a[12:15], v[108:111]
  s_waitcnt lgkmcnt(4)
  v_mfma_f32_16x16x32_bf16 v[112:115], a[184:187], a[0:3], 0
  ds_read_b64_tr_b16 a[168:169], v225 offset:49152
  v_mfma_f32_16x16x32_bf16 v[112:115], a[188:191], a[16:19], v[112:115]
  v_mfma_f32_16x16x32_bf16 v[116:119], a[188:191], a[20:23], 0
  ds_read_b64_tr_b16 a[170:171], v225 offset:50176
  v_mfma_f32_16x16x32_bf16 v[116:119], a[184:187], a[4:7], v[116:119]
  v_mfma_f32_16x16x32_bf16 v[120:123], a[184:187], a[8:11], 0
  ds_read_b64_tr_b16 a[172:173], v225 offset:57344
  v_mfma_f32_16x16x32_bf16 v[120:123], a[188:191], a[24:27], v[120:123]
  v_mfma_f32_16x16x32_bf16 v[124:127], a[188:191], a[28:31], 0
  ds_read_b64_tr_b16 a[174:175], v225 offset:58368
  v_mfma_f32_16x16x32_bf16 v[124:127], a[184:187], a[12:15], v[124:127]
  s_waitcnt vmcnt(24) lgkmcnt(4)
  v_mfma_f32_16x16x32_bf16 v[0:3], a[160:163], a[32:35], v[0:3]
  ds_read_b64_tr_b16 a[176:177], v226 offset:49152
  v_mfma_f32_16x16x32_bf16 v[0:3], a[164:167], a[48:51], v[0:3]
  buffer_load_dwordx4 a[0:3], v242, s[24:27], s30 offen offset:0
  v_mfma_f32_16x16x32_bf16 v[4:7], a[164:167], a[52:55], v[4:7]
  ds_read_b64_tr_b16 a[178:179], v226 offset:50176
  v_mfma_f32_16x16x32_bf16 v[4:7], a[160:163], a[36:39], v[4:7]
  buffer_load_dwordx4 a[4:7], v242, s[24:27], s30 offen offset:1024
  v_mfma_f32_16x16x32_bf16 v[8:11], a[160:163], a[40:43], v[8:11]
  ds_read_b64_tr_b16 a[180:181], v226 offset:57344
  v_mfma_f32_16x16x32_bf16 v[8:11], a[164:167], a[56:59], v[8:11]
  buffer_load_dwordx4 a[8:11], v242, s[24:27], s30 offen offset:2048
  v_mfma_f32_16x16x32_bf16 v[12:15], a[164:167], a[60:63], v[12:15]
  ds_read_b64_tr_b16 a[182:183], v226 offset:58368
  v_mfma_f32_16x16x32_bf16 v[12:15], a[160:163], a[44:47], v[12:15]
  s_waitcnt lgkmcnt(4)
  v_mfma_f32_16x16x32_bf16 v[16:19], a[168:171], a[32:35], v[16:19]
  ds_read_b64_tr_b16 a[184:185], v227 offset:49152
  v_mfma_f32_16x16x32_bf16 v[16:19], a[172:175], a[48:51], v[16:19]
  buffer_load_dwordx4 a[12:15], v242, s[24:27], s30 offen offset:3072
  v_mfma_f32_16x16x32_bf16 v[20:23], a[172:175], a[52:55], v[20:23]
  ds_read_b64_tr_b16 a[186:187], v227 offset:50176
  v_mfma_f32_16x16x32_bf16 v[20:23], a[168:171], a[36:39], v[20:23]
  buffer_load_dwordx4 a[16:19], v243, s[24:27], s30 offen offset:0
  v_mfma_f32_16x16x32_bf16 v[24:27], a[168:171], a[40:43], v[24:27]
  ds_read_b64_tr_b16 a[188:189], v227 offset:57344
  v_mfma_f32_16x16x32_bf16 v[24:27], a[172:175], a[56:59], v[24:27]
  buffer_load_dwordx4 a[20:23], v243, s[24:27], s30 offen offset:1024
  v_mfma_f32_16x16x32_bf16 v[28:31], a[172:175], a[60:63], v[28:31]
  ds_read_b64_tr_b16 a[190:191], v227 offset:58368
  v_mfma_f32_16x16x32_bf16 v[28:31], a[168:171], a[44:47], v[28:31]
  s_waitcnt lgkmcnt(4)
  v_mfma_f32_16x16x32_bf16 v[32:35], a[176:179], a[32:35], v[32:35]
  ds_read_b64_tr_b16 a[160:161], v228 offset:49152
  v_mfma_f32_16x16x32_bf16 v[32:35], a[180:183], a[48:51], v[32:35]
  buffer_load_dwordx4 a[24:27], v243, s[24:27], s30 offen offset:2048
  v_mfma_f32_16x16x32_bf16 v[36:39], a[180:183], a[52:55], v[36:39]
  ds_read_b64_tr_b16 a[162:163], v228 offset:50176
  v_mfma_f32_16x16x32_bf16 v[36:39], a[176:179], a[36:39], v[36:39]
  buffer_load_dwordx4 a[28:31], v243, s[24:27], s30 offen offset:3072
  v_mfma_f32_16x16x32_bf16 v[40:43], a[176:179], a[40:43], v[40:43]
  ds_read_b64_tr_b16 a[164:165], v228 offset:57344
  v_mfma_f32_16x16x32_bf16 v[40:43], a[180:183], a[56:59], v[40:43]
  s_add_u32 s30, s30, 8192
  v_mfma_f32_16x16x32_bf16 v[44:47], a[180:183], a[60:63], v[44:47]
  ds_read_b64_tr_b16 a[166:167], v228 offset:58368
  v_mfma_f32_16x16x32_bf16 v[44:47], a[176:179], a[44:47], v[44:47]
  s_waitcnt lgkmcnt(4)
  v_mfma_f32_16x16x32_bf16 v[48:51], a[184:187], a[32:35], v[48:51]
  ds_read_b64_tr_b16 a[168:169], v229 offset:49152
  s_lshl_b32 s35, s3, 11
  s_add_u32 s35, s35, 2621440
  buffer_load_dwordx4 v[128:131], v242, s[24:27], s35 offen
  v_mfma_f32_16x16x32_bf16 v[48:51], a[188:191], a[48:51], v[48:51]
  buffer_load_dwordx4 v[132:135], v242, s[24:27], s35 offen offset:1024
  v_mfma_f32_16x16x32_bf16 v[52:55], a[188:191], a[52:55], v[52:55]
  ds_read_b64_tr_b16 a[170:171], v229 offset:50176
  v_mfma_f32_16x16x32_bf16 v[52:55], a[184:187], a[36:39], v[52:55]
  v_mfma_f32_16x16x32_bf16 v[56:59], a[184:187], a[40:43], v[56:59]
  ds_read_b64_tr_b16 a[172:173], v229 offset:57344
  v_mfma_f32_16x16x32_bf16 v[56:59], a[188:191], a[56:59], v[56:59]
  v_mfma_f32_16x16x32_bf16 v[60:63], a[188:191], a[60:63], v[60:63]
  ds_read_b64_tr_b16 a[174:175], v229 offset:58368
  v_mfma_f32_16x16x32_bf16 v[60:63], a[184:187], a[44:47], v[60:63]
  s_waitcnt lgkmcnt(4)
  v_mfma_f32_16x16x32_bf16 v[64:67], a[160:163], a[32:35], v[64:67]
  ds_read_b64_tr_b16 a[176:177], v230 offset:49152
  v_mfma_f32_16x16x32_bf16 v[64:67], a[164:167], a[48:51], v[64:67]
  v_mfma_f32_16x16x32_bf16 v[68:71], a[164:167], a[52:55], v[68:71]
  ds_read_b64_tr_b16 a[178:179], v230 offset:50176
  v_mfma_f32_16x16x32_bf16 v[68:71], a[160:163], a[36:39], v[68:71]
  v_mfma_f32_16x16x32_bf16 v[72:75], a[160:163], a[40:43], v[72:75]
  ds_read_b64_tr_b16 a[180:181], v230 offset:57344
  v_mfma_f32_16x16x32_bf16 v[72:75], a[164:167], a[56:59], v[72:75]
  v_mfma_f32_16x16x32_bf16 v[76:79], a[164:167], a[60:63], v[76:79]
  ds_read_b64_tr_b16 a[182:183], v230 offset:58368
  v_mfma_f32_16x16x32_bf16 v[76:79], a[160:163], a[44:47], v[76:79]
  s_waitcnt lgkmcnt(4)
  v_mfma_f32_16x16x32_bf16 v[80:83], a[168:171], a[32:35], v[80:83]
  ds_read_b64_tr_b16 a[184:185], v231 offset:49152
  v_mfma_f32_16x16x32_bf16 v[80:83], a[172:175], a[48:51], v[80:83]
  v_mfma_f32_16x16x32_bf16 v[84:87], a[172:175], a[52:55], v[84:87]
  ds_read_b64_tr_b16 a[186:187], v231 offset:50176
  v_mfma_f32_16x16x32_bf16 v[84:87], a[168:171], a[36:39], v[84:87]
  s_waitcnt vmcnt(30)
  v_mfma_f32_16x16x32_bf16 v[88:91], a[168:171], a[40:43], v[88:91]
  ds_read_b64_tr_b16 a[188:189], v231 offset:57344
  v_mfma_f32_16x16x32_bf16 v[88:91], a[172:175], a[56:59], v[88:91]
  s_barrier
  v_mfma_f32_16x16x32_bf16 v[92:95], a[172:175], a[60:63], v[92:95]
  ds_read_b64_tr_b16 a[190:191], v231 offset:58368
  v_mfma_f32_16x16x32_bf16 v[92:95], a[168:171], a[44:47], v[92:95]
  s_waitcnt lgkmcnt(4)
  s_add_u32 m0, s28, 98304
  v_mfma_f32_16x16x32_bf16 v[96:99], a[176:179], a[32:35], v[96:99]
  ds_read_b64_tr_b16 a[160:161], v224 offset:0
  v_mfma_f32_16x16x32_bf16 v[96:99], a[180:183], a[48:51], v[96:99]
  buffer_load_dwordx4 v238, s[20:23], s31 offen offset:0 lds
  v_mfma_f32_16x16x32_bf16 v[100:103], a[180:183], a[52:55], v[100:103]
  ds_read_b64_tr_b16 a[162:163], v224 offset:1024
  v_mfma_f32_16x16x32_bf16 v[100:103], a[176:179], a[36:39], v[100:103]
  buffer_load_dwordx4 v239, s[20:23], s31 offen offset:1024 lds
  v_mfma_f32_16x16x32_bf16 v[104:107], a[176:179], a[40:43], v[104:107]
  ds_read_b64_tr_b16 a[164:165], v224 offset:8192
  v_mfma_f32_16x16x32_bf16 v[104:107], a[180:183], a[56:59], v[104:107]
  buffer_load_dwordx4 v240, s[20:23], s31 offen offset:2048 lds
  v_mfma_f32_16x16x32_bf16 v[108:111], a[180:183], a[60:63], v[108:111]
  ds_read_b64_tr_b16 a[166:167], v224 offset:9216
  v_mfma_f32_16x16x32_bf16 v[108:111], a[176:179], a[44:47], v[108:111]
  s_waitcnt lgkmcnt(4)
  v_mfma_f32_16x16x32_bf16 v[112:115], a[184:187], a[32:35], v[112:115]
  ds_read_b64_tr_b16 a[168:169], v225 offset:0
  v_mfma_f32_16x16x32_bf16 v[112:115], a[188:191], a[48:51], v[112:115]
  buffer_load_dwordx4 v241, s[20:23], s31 offen offset:3072 lds
  v_mfma_f32_16x16x32_bf16 v[116:119], a[188:191], a[52:55], v[116:119]
  ds_read_b64_tr_b16 a[170:171], v225 offset:1024
  v_mfma_f32_16x16x32_bf16 v[116:119], a[184:187], a[36:39], v[116:119]
  s_add_u32 s31, s31, 0x80000
  v_mfma_f32_16x16x32_bf16 v[120:123], a[184:187], a[40:43], v[120:123]
  ds_read_b64_tr_b16 a[172:173], v225 offset:8192
  v_mfma_f32_16x16x32_bf16 v[120:123], a[188:191], a[56:59], v[120:123]
  v_mfma_f32_16x16x32_bf16 v[124:127], a[188:191], a[60:63], v[124:127]
  ds_read_b64_tr_b16 a[174:175], v225 offset:9216
  v_mfma_f32_16x16x32_bf16 v[124:127], a[184:187], a[44:47], v[124:127]
  s_waitcnt vmcnt(26) lgkmcnt(4)
  v_mfma_f32_16x16x32_bf16 v[0:3], a[160:163], a[64:67], v[0:3]
  ds_read_b64_tr_b16 a[176:177], v226 offset:0
  v_mfma_f32_16x16x32_bf16 v[0:3], a[164:167], a[80:83], v[0:3]
  buffer_load_dwordx4 a[32:35], v242, s[24:27], s30 offen offset:0
  v_mfma_f32_16x16x32_bf16 v[4:7], a[164:167], a[84:87], v[4:7]
  ds_read_b64_tr_b16 a[178:179], v226 offset:1024
  v_mfma_f32_16x16x32_bf16 v[4:7], a[160:163], a[68:71], v[4:7]
  buffer_load_dwordx4 a[36:39], v242, s[24:27], s30 offen offset:1024
  v_mfma_f32_16x16x32_bf16 v[8:11], a[160:163], a[72:75], v[8:11]
  ds_read_b64_tr_b16 a[180:181], v226 offset:8192
  v_mfma_f32_16x16x32_bf16 v[8:11], a[164:167], a[88:91], v[8:11]
  buffer_load_dwordx4 a[40:43], v242, s[24:27], s30 offen offset:2048
  v_mfma_f32_16x16x32_bf16 v[12:15], a[164:167], a[92:95], v[12:15]
  ds_read_b64_tr_b16 a[182:183], v226 offset:9216
  v_mfma_f32_16x16x32_bf16 v[12:15], a[160:163], a[76:79], v[12:15]
  s_waitcnt lgkmcnt(4)
  v_mfma_f32_16x16x32_bf16 v[16:19], a[168:171], a[64:67], v[16:19]
  ds_read_b64_tr_b16 a[184:185], v227 offset:0
  v_mfma_f32_16x16x32_bf16 v[16:19], a[172:175], a[80:83], v[16:19]
  buffer_load_dwordx4 a[44:47], v242, s[24:27], s30 offen offset:3072
  v_mfma_f32_16x16x32_bf16 v[20:23], a[172:175], a[84:87], v[20:23]
  ds_read_b64_tr_b16 a[186:187], v227 offset:1024
  v_mfma_f32_16x16x32_bf16 v[20:23], a[168:171], a[68:71], v[20:23]
  buffer_load_dwordx4 a[48:51], v243, s[24:27], s30 offen offset:0
  v_mfma_f32_16x16x32_bf16 v[24:27], a[168:171], a[72:75], v[24:27]
  ds_read_b64_tr_b16 a[188:189], v227 offset:8192
  v_mfma_f32_16x16x32_bf16 v[24:27], a[172:175], a[88:91], v[24:27]
  buffer_load_dwordx4 a[52:55], v243, s[24:27], s30 offen offset:1024
  v_mfma_f32_16x16x32_bf16 v[28:31], a[172:175], a[92:95], v[28:31]
  ds_read_b64_tr_b16 a[190:191], v227 offset:9216
  v_mfma_f32_16x16x32_bf16 v[28:31], a[168:171], a[76:79], v[28:31]
  s_waitcnt lgkmcnt(4)
  v_mfma_f32_16x16x32_bf16 v[32:35], a[176:179], a[64:67], v[32:35]
  ds_read_b64_tr_b16 a[160:161], v228 offset:0
  v_mfma_f32_16x16x32_bf16 v[32:35], a[180:183], a[80:83], v[32:35]
  buffer_load_dwordx4 a[56:59], v243, s[24:27], s30 offen offset:2048
  v_mfma_f32_16x16x32_bf16 v[36:39], a[180:183], a[84:87], v[36:39]
  ds_read_b64_tr_b16 a[162:163], v228 offset:1024
  v_mfma_f32_16x16x32_bf16 v[36:39], a[176:179], a[68:71], v[36:39]
  buffer_load_dwordx4 a[60:63], v243, s[24:27], s30 offen offset:3072
  v_mfma_f32_16x16x32_bf16 v[40:43], a[176:179], a[72:75], v[40:43]
  ds_read_b64_tr_b16 a[164:165], v228 offset:8192
  v_mfma_f32_16x16x32_bf16 v[40:43], a[180:183], a[88:91], v[40:43]
  s_add_u32 s30, s30, 8192
  v_mfma_f32_16x16x32_bf16 v[44:47], a[180:183], a[92:95], v[44:47]
  ds_read_b64_tr_b16 a[166:167], v228 offset:9216
  v_mfma_f32_16x16x32_bf16 v[44:47], a[176:179], a[76:79], v[44:47]
  s_waitcnt lgkmcnt(4)
  v_mfma_f32_16x16x32_bf16 v[48:51], a[184:187], a[64:67], v[48:51]
  ds_read_b64_tr_b16 a[168:169], v229 offset:0
  v_mfma_f32_16x16x32_bf16 v[48:51], a[188:191], a[80:83], v[48:51]
  v_mfma_f32_16x16x32_bf16 v[52:55], a[188:191], a[84:87], v[52:55]
  ds_read_b64_tr_b16 a[170:171], v229 offset:1024
  v_mfma_f32_16x16x32_bf16 v[52:55], a[184:187], a[68:71], v[52:55]
  v_mfma_f32_16x16x32_bf16 v[56:59], a[184:187], a[72:75], v[56:59]
  ds_read_b64_tr_b16 a[172:173], v229 offset:8192
  v_mfma_f32_16x16x32_bf16 v[56:59], a[188:191], a[88:91], v[56:59]
  v_mfma_f32_16x16x32_bf16 v[60:63], a[188:191], a[92:95], v[60:63]
  ds_read_b64_tr_b16 a[174:175], v229 offset:9216
  v_mfma_f32_16x16x32_bf16 v[60:63], a[184:187], a[76:79], v[60:63]
  s_waitcnt lgkmcnt(4)
  v_mfma_f32_16x16x32_bf16 v[64:67], a[160:163], a[64:67], v[64:67]
  ds_read_b64_tr_b16 a[176:177], v230 offset:0
  v_mfma_f32_16x16x32_bf16 v[64:67], a[164:167], a[80:83], v[64:67]
  v_mfma_f32_16x16x32_bf16 v[68:71], a[164:167], a[84:87], v[68:71]
  ds_read_b64_tr_b16 a[178:179], v230 offset:1024
  v_mfma_f32_16x16x32_bf16 v[68:71], a[160:163], a[68:71], v[68:71]
  v_mfma_f32_16x16x32_bf16 v[72:75], a[160:163], a[72:75], v[72:75]
  ds_read_b64_tr_b16 a[180:181], v230 offset:8192
  v_mfma_f32_16x16x32_bf16 v[72:75], a[164:167], a[88:91], v[72:75]
  v_mfma_f32_16x16x32_bf16 v[76:79], a[164:167], a[92:95], v[76:79]
  ds_read_b64_tr_b16 a[182:183], v230 offset:9216
  v_mfma_f32_16x16x32_bf16 v[76:79], a[160:163], a[76:79], v[76:79]
  s_waitcnt lgkmcnt(4)
  v_mfma_f32_16x16x32_bf16 v[80:83], a[168:171], a[64:67], v[80:83]
  ds_read_b64_tr_b16 a[184:185], v231 offset:0
  v_mfma_f32_16x16x32_bf16 v[80:83], a[172:175], a[80:83], v[80:83]
  v_mfma_f32_16x16x32_bf16 v[84:87], a[172:175], a[84:87], v[84:87]
  ds_read_b64_tr_b16 a[186:187], v231 offset:1024
  v_mfma_f32_16x16x32_bf16 v[84:87], a[168:171], a[68:71], v[84:87]
  s_waitcnt vmcnt(30)
  v_mfma_f32_16x16x32_bf16 v[88:91], a[168:171], a[72:75], v[88:91]
  ds_read_b64_tr_b16 a[188:189], v231 offset:8192
  v_mfma_f32_16x16x32_bf16 v[88:91], a[172:175], a[88:91], v[88:91]
  s_barrier
  v_mfma_f32_16x16x32_bf16 v[92:95], a[172:175], a[92:95], v[92:95]
  ds_read_b64_tr_b16 a[190:191], v231 offset:9216
  v_mfma_f32_16x16x32_bf16 v[92:95], a[168:171], a[76:79], v[92:95]
  s_waitcnt lgkmcnt(4)
  s_add_u32 m0, s28, 114688
  v_mfma_f32_16x16x32_bf16 v[96:99], a[176:179], a[64:67], v[96:99]
  ds_read_b64_tr_b16 a[160:161], v224 offset:16384
  v_mfma_f32_16x16x32_bf16 v[96:99], a[180:183], a[80:83], v[96:99]
  buffer_load_dwordx4 v238, s[20:23], s31 offen offset:0 lds
  v_mfma_f32_16x16x32_bf16 v[100:103], a[180:183], a[84:87], v[100:103]
  ds_read_b64_tr_b16 a[162:163], v224 offset:17408
  v_mfma_f32_16x16x32_bf16 v[100:103], a[176:179], a[68:71], v[100:103]
  buffer_load_dwordx4 v239, s[20:23], s31 offen offset:1024 lds
  v_mfma_f32_16x16x32_bf16 v[104:107], a[176:179], a[72:75], v[104:107]
  ds_read_b64_tr_b16 a[164:165], v224 offset:24576
  v_mfma_f32_16x16x32_bf16 v[104:107], a[180:183], a[88:91], v[104:107]
  buffer_load_dwordx4 v240, s[20:23], s31 offen offset:2048 lds
  v_mfma_f32_16x16x32_bf16 v[108:111], a[180:183], a[92:95], v[108:111]
  ds_read_b64_tr_b16 a[166:167], v224 offset:25600
  v_mfma_f32_16x16x32_bf16 v[108:111], a[176:179], a[76:79], v[108:111]
  s_waitcnt lgkmcnt(4)
  v_mfma_f32_16x16x32_bf16 v[112:115], a[184:187], a[64:67], v[112:115]
  ds_read_b64_tr_b16 a[168:169], v225 offset:16384
  v_mfma_f32_16x16x32_bf16 v[112:115], a[188:191], a[80:83], v[112:115]
  buffer_load_dwordx4 v241, s[20:23], s31 offen offset:3072 lds
  v_mfma_f32_16x16x32_bf16 v[116:119], a[188:191], a[84:87], v[116:119]
  ds_read_b64_tr_b16 a[170:171], v225 offset:17408
  v_mfma_f32_16x16x32_bf16 v[116:119], a[184:187], a[68:71], v[116:119]
  s_add_u32 s31, s31, 0x80000
  v_mfma_f32_16x16x32_bf16 v[120:123], a[184:187], a[72:75], v[120:123]
  ds_read_b64_tr_b16 a[172:173], v225 offset:24576
  v_mfma_f32_16x16x32_bf16 v[120:123], a[188:191], a[88:91], v[120:123]
  v_mfma_f32_16x16x32_bf16 v[124:127], a[188:191], a[92:95], v[124:127]
  ds_read_b64_tr_b16 a[174:175], v225 offset:25600
  v_mfma_f32_16x16x32_bf16 v[124:127], a[184:187], a[76:79], v[124:127]
  s_waitcnt vmcnt(26) lgkmcnt(4)
  v_mfma_f32_16x16x32_bf16 v[0:3], a[160:163], a[96:99], v[0:3]
  ds_read_b64_tr_b16 a[176:177], v226 offset:16384
  v_mfma_f32_16x16x32_bf16 v[0:3], a[164:167], a[112:115], v[0:3]
  buffer_load_dwordx4 a[64:67], v242, s[24:27], s30 offen offset:0
  v_mfma_f32_16x16x32_bf16 v[4:7], a[164:167], a[116:119], v[4:7]
  ds_read_b64_tr_b16 a[178:179], v226 offset:17408
  v_mfma_f32_16x16x32_bf16 v[4:7], a[160:163], a[100:103], v[4:7]
  buffer_load_dwordx4 a[68:71], v242, s[24:27], s30 offen offset:1024
  v_mfma_f32_16x16x32_bf16 v[8:11], a[160:163], a[104:107], v[8:11]
  ds_read_b64_tr_b16 a[180:181], v226 offset:24576
  v_mfma_f32_16x16x32_bf16 v[8:11], a[164:167], a[120:123], v[8:11]
  buffer_load_dwordx4 a[72:75], v242, s[24:27], s30 offen offset:2048
  v_mfma_f32_16x16x32_bf16 v[12:15], a[164:167], a[124:127], v[12:15]
  ds_read_b64_tr_b16 a[182:183], v226 offset:25600
  v_mfma_f32_16x16x32_bf16 v[12:15], a[160:163], a[108:111], v[12:15]
  s_waitcnt lgkmcnt(4)
  v_mfma_f32_16x16x32_bf16 v[16:19], a[168:171], a[96:99], v[16:19]
  ds_read_b64_tr_b16 a[184:185], v227 offset:16384
  v_mfma_f32_16x16x32_bf16 v[16:19], a[172:175], a[112:115], v[16:19]
  buffer_load_dwordx4 a[76:79], v242, s[24:27], s30 offen offset:3072
  v_mfma_f32_16x16x32_bf16 v[20:23], a[172:175], a[116:119], v[20:23]
  ds_read_b64_tr_b16 a[186:187], v227 offset:17408
  v_mfma_f32_16x16x32_bf16 v[20:23], a[168:171], a[100:103], v[20:23]
  buffer_load_dwordx4 a[80:83], v243, s[24:27], s30 offen offset:0
  v_mfma_f32_16x16x32_bf16 v[24:27], a[168:171], a[104:107], v[24:27]
  ds_read_b64_tr_b16 a[188:189], v227 offset:24576
  v_mfma_f32_16x16x32_bf16 v[24:27], a[172:175], a[120:123], v[24:27]
  buffer_load_dwordx4 a[84:87], v243, s[24:27], s30 offen offset:1024
  v_mfma_f32_16x16x32_bf16 v[28:31], a[172:175], a[124:127], v[28:31]
  ds_read_b64_tr_b16 a[190:191], v227 offset:25600
  v_mfma_f32_16x16x32_bf16 v[28:31], a[168:171], a[108:111], v[28:31]
  s_waitcnt lgkmcnt(4)
  v_mfma_f32_16x16x32_bf16 v[32:35], a[176:179], a[96:99], v[32:35]
  ds_read_b64_tr_b16 a[160:161], v228 offset:16384
  v_mfma_f32_16x16x32_bf16 v[32:35], a[180:183], a[112:115], v[32:35]
  buffer_load_dwordx4 a[88:91], v243, s[24:27], s30 offen offset:2048
  v_mfma_f32_16x16x32_bf16 v[36:39], a[180:183], a[116:119], v[36:39]
  ds_read_b64_tr_b16 a[162:163], v228 offset:17408
  v_mfma_f32_16x16x32_bf16 v[36:39], a[176:179], a[100:103], v[36:39]
  buffer_load_dwordx4 a[92:95], v243, s[24:27], s30 offen offset:3072
  v_mfma_f32_16x16x32_bf16 v[40:43], a[176:179], a[104:107], v[40:43]
  ds_read_b64_tr_b16 a[164:165], v228 offset:24576
  v_mfma_f32_16x16x32_bf16 v[40:43], a[180:183], a[120:123], v[40:43]
  s_add_u32 s30, s30, 8192
  v_mfma_f32_16x16x32_bf16 v[44:47], a[180:183], a[124:127], v[44:47]
  ds_read_b64_tr_b16 a[166:167], v228 offset:25600
  v_mfma_f32_16x16x32_bf16 v[44:47], a[176:179], a[108:111], v[44:47]
  s_waitcnt lgkmcnt(4)
  v_mfma_f32_16x16x32_bf16 v[48:51], a[184:187], a[96:99], v[48:51]
  ds_read_b64_tr_b16 a[168:169], v229 offset:16384
  v_mfma_f32_16x16x32_bf16 v[48:51], a[188:191], a[112:115], v[48:51]
  v_mfma_f32_16x16x32_bf16 v[52:55], a[188:191], a[116:119], v[52:55]
  ds_read_b64_tr_b16 a[170:171], v229 offset:17408
  v_mfma_f32_16x16x32_bf16 v[52:55], a[184:187], a[100:103], v[52:55]
  v_mfma_f32_16x16x32_bf16 v[56:59], a[184:187], a[104:107], v[56:59]
  ds_read_b64_tr_b16 a[172:173], v229 offset:24576
  v_mfma_f32_16x16x32_bf16 v[56:59], a[188:191], a[120:123], v[56:59]
  v_mfma_f32_16x16x32_bf16 v[60:63], a[188:191], a[124:127], v[60:63]
  ds_read_b64_tr_b16 a[174:175], v229 offset:25600
  v_mfma_f32_16x16x32_bf16 v[60:63], a[184:187], a[108:111], v[60:63]
  s_waitcnt lgkmcnt(4)
  v_mfma_f32_16x16x32_bf16 v[64:67], a[160:163], a[96:99], v[64:67]
  ds_read_b64_tr_b16 a[176:177], v230 offset:16384
  s_waitcnt vmcnt(24)
  s_mov_b32 s51, -1
  v_sub_u32 v137, s51, v128
  v_mfma_f32_16x16x32_bf16 v[64:67], a[164:167], a[112:115], v[64:67]
  v_sub_u32 v138, s51, v129
  v_min_u32 v136, v137, v138
  v_mfma_f32_16x16x32_bf16 v[68:71], a[164:167], a[116:119], v[68:71]
  ds_read_b64_tr_b16 a[178:179], v230 offset:17408
  v_sub_u32 v139, s51, v130
  v_mfma_f32_16x16x32_bf16 v[68:71], a[160:163], a[100:103], v[68:71]
  v_sub_u32 v140, s51, v131
  v_min3_u32 v136, v136, v139, v140
  v_mfma_f32_16x16x32_bf16 v[72:75], a[160:163], a[104:107], v[72:75]
  ds_read_b64_tr_b16 a[180:181], v230 offset:24576
  v_sub_u32 v137, s51, v132
  v_mfma_f32_16x16x32_bf16 v[72:75], a[164:167], a[120:123], v[72:75]
  v_sub_u32 v138, s51, v133
  v_min3_u32 v136, v136, v137, v138
  v_mfma_f32_16x16x32_bf16 v[76:79], a[164:167], a[124:127], v[76:79]
  ds_read_b64_tr_b16 a[182:183], v230 offset:25600
  v_sub_u32 v139, s51, v134
  v_mfma_f32_16x16x32_bf16 v[76:79], a[160:163], a[108:111], v[76:79]
  s_waitcnt lgkmcnt(4)
  v_sub_u32 v140, s51, v135
  v_min3_u32 v136, v136, v139, v140
  v_mfma_f32_16x16x32_bf16 v[80:83], a[168:171], a[96:99], v[80:83]
  ds_read_b64_tr_b16 a[184:185], v231 offset:16384
  v_min_u32_dpp v136, v136, v136 row_ror:8 row_mask:0xf bank_mask:0xf
  v_mfma_f32_16x16x32_bf16 v[80:83], a[172:175], a[112:115], v[80:83]
  v_mfma_f32_16x16x32_bf16 v[84:87], a[172:175], a[116:119], v[84:87]
  ds_read_b64_tr_b16 a[186:187], v231 offset:17408
  v_min_u32_dpp v136, v136, v136 row_ror:4 row_mask:0xf bank_mask:0xf
  v_mfma_f32_16x16x32_bf16 v[84:87], a[168:171], a[100:103], v[84:87]
  s_waitcnt vmcnt(20)
  v_min_u32_dpp v136, v136, v136 row_ror:2 row_mask:0xf bank_mask:0xf
  v_mfma_f32_16x16x32_bf16 v[88:91], a[168:171], a[104:107], v[88:91]
  ds_read_b64_tr_b16 a[188:189], v231 offset:24576
  v_min_u32_dpp v136, v136, v136 row_ror:1 row_mask:0xf bank_mask:0xf
  v_mfma_f32_16x16x32_bf16 v[88:91], a[172:175], a[120:123], v[88:91]
  s_barrier
  v_readlane_b32 s98, v136, 0
  v_readlane_b32 s99, v136, 16
  v_mfma_f32_16x16x32_bf16 v[92:95], a[172:175], a[124:127], v[92:95]
  ds_read_b64_tr_b16 a[190:191], v231 offset:25600
  v_readlane_b32 s100, v136, 32
  v_mfma_f32_16x16x32_bf16 v[92:95], a[168:171], a[108:111], v[92:95]
  s_waitcnt lgkmcnt(4)
  s_add_u32 m0, s28, 65536
  v_readlane_b32 s101, v136, 48
  v_mfma_f32_16x16x32_bf16 v[96:99], a[176:179], a[96:99], v[96:99]
  ds_read_b64_tr_b16 a[160:161], v224 offset:32768
  s_min_u32 s98, s98, s99
  s_min_u32 s100, s100, s101
  s_min_u32 s98, s98, s100
  s_sub_u32 s52, s51, s98
  s_sub_u32 s51, s52, 1
  v_sub_u32 v137, s51, v128
  v_mfma_f32_16x16x32_bf16 v[96:99], a[180:183], a[112:115], v[96:99]
  buffer_load_dwordx4 v238, s[20:23], s31 offen offset:0 lds
  v_mfma_f32_16x16x32_bf16 v[100:103], a[180:183], a[116:119], v[100:103]
  ds_read_b64_tr_b16 a[162:163], v224 offset:33792
  v_sub_u32 v138, s51, v129
  v_mfma_f32_16x16x32_bf16 v[100:103], a[176:179], a[100:103], v[100:103]
  buffer_load_dwordx4 v239, s[20:23], s31 offen offset:1024 lds
  v_mfma_f32_16x16x32_bf16 v[104:107], a[176:179], a[104:107], v[104:107]
  ds_read_b64_tr_b16 a[164:165], v224 offset:40960
  v_min_u32 v136, v137, v138
  v_mfma_f32_16x16x32_bf16 v[104:107], a[180:183], a[120:123], v[104:107]
  buffer_load_dwordx4 v240, s[20:23], s31 offen offset:2048 lds
  v_mfma_f32_16x16x32_bf16 v[108:111], a[180:183], a[124:127], v[108:111]
  ds_read_b64_tr_b16 a[166:167], v224 offset:41984
  v_sub_u32 v139, s51, v130
  v_mfma_f32_16x16x32_bf16 v[108:111], a[176:179], a[108:111], v[108:111]
  s_waitcnt lgkmcnt(4)
  v_sub_u32 v140, s51, v131
  v_min3_u32 v136, v136, v139, v140
  v_mfma_f32_16x16x32_bf16 v[112:115], a[184:187], a[96:99], v[112:115]
  ds_read_b64_tr_b16 a[168:169], v225 offset:32768
  v_sub_u32 v137, s51, v132
  v_mfma_f32_16x16x32_bf16 v[112:115], a[188:191], a[112:115], v[112:115]
  buffer_load_dwordx4 v241, s[20:23], s31 offen offset:3072 lds
  v_mfma_f32_16x16x32_bf16 v[116:119], a[188:191], a[116:119], v[116:119]
  ds_read_b64_tr_b16 a[170:171], v225 offset:33792
  v_sub_u32 v138, s51, v133
  v_mfma_f32_16x16x32_bf16 v[116:119], a[184:187], a[100:103], v[116:119]
  s_add_u32 s31, s31, 0x80000
  v_min3_u32 v136, v136, v137, v138
  v_sub_u32 v139, s51, v134
  v_mfma_f32_16x16x32_bf16 v[120:123], a[184:187], a[104:107], v[120:123]
  ds_read_b64_tr_b16 a[172:173], v225 offset:40960
  v_sub_u32 v140, s51, v135
  v_mfma_f32_16x16x32_bf16 v[120:123], a[188:191], a[120:123], v[120:123]
  v_min3_u32 v136, v136, v139, v140
  v_mfma_f32_16x16x32_bf16 v[124:127], a[188:191], a[124:127], v[124:127]
  ds_read_b64_tr_b16 a[174:175], v225 offset:41984
  v_min_u32_dpp v136, v136, v136 row_ror:8 row_mask:0xf bank_mask:0xf
  v_mfma_f32_16x16x32_bf16 v[124:127], a[184:187], a[108:111], v[124:127]
  s_waitcnt lgkmcnt(4)
  v_min_u32_dpp v136, v136, v136 row_ror:4 row_mask:0xf bank_mask:0xf
  v_mfma_f32_16x16x32_bf16 v[0:3], a[160:163], a[0:3], v[0:3]
  ds_read_b64_tr_b16 a[176:177], v226 offset:32768
  v_mfma_f32_16x16x32_bf16 v[0:3], a[164:167], a[16:19], v[0:3]
  buffer_load_dwordx4 a[96:99], v242, s[24:27], s30 offen offset:0
  v_mfma_f32_16x16x32_bf16 v[4:7], a[164:167], a[20:23], v[4:7]
  ds_read_b64_tr_b16 a[178:179], v226 offset:33792
  v_mfma_f32_16x16x32_bf16 v[4:7], a[160:163], a[4:7], v[4:7]
  buffer_load_dwordx4 a[100:103], v242, s[24:27], s30 offen offset:1024
  v_mfma_f32_16x16x32_bf16 v[8:11], a[160:163], a[8:11], v[8:11]
  ds_read_b64_tr_b16 a[180:181], v226 offset:40960
  v_mfma_f32_16x16x32_bf16 v[8:11], a[164:167], a[24:27], v[8:11]
  buffer_load_dwordx4 a[104:107], v242, s[24:27], s30 offen offset:2048
  v_mfma_f32_16x16x32_bf16 v[12:15], a[164:167], a[28:31], v[12:15]
  ds_read_b64_tr_b16 a[182:183], v226 offset:41984
  v_mfma_f32_16x16x32_bf16 v[12:15], a[160:163], a[12:15], v[12:15]
  s_waitcnt lgkmcnt(4)
  v_mfma_f32_16x16x32_bf16 v[16:19], a[168:171], a[0:3], v[16:19]
  ds_read_b64_tr_b16 a[184:185], v227 offset:32768
  v_mfma_f32_16x16x32_bf16 v[16:19], a[172:175], a[16:19], v[16:19]
  buffer_load_dwordx4 a[108:111], v242, s[24:27], s30 offen offset:3072
  v_mfma_f32_16x16x32_bf16 v[20:23], a[172:175], a[20:23], v[20:23]
  ds_read_b64_tr_b16 a[186:187], v227 offset:33792
  v_mfma_f32_16x16x32_bf16 v[20:23], a[168:171], a[4:7], v[20:23]
  buffer_load_dwordx4 a[112:115], v243, s[24:27], s30 offen offset:0
  v_mfma_f32_16x16x32_bf16 v[24:27], a[168:171], a[8:11], v[24:27]
  ds_read_b64_tr_b16 a[188:189], v227 offset:40960
  v_mfma_f32_16x16x32_bf16 v[24:27], a[172:175], a[24:27], v[24:27]
  buffer_load_dwordx4 a[116:119], v243, s[24:27], s30 offen offset:1024
  v_mfma_f32_16x16x32_bf16 v[28:31], a[172:175], a[28:31], v[28:31]
  ds_read_b64_tr_b16 a[190:191], v227 offset:41984
  v_mfma_f32_16x16x32_bf16 v[28:31], a[168:171], a[12:15], v[28:31]
  s_waitcnt lgkmcnt(4)
  v_mfma_f32_16x16x32_bf16 v[32:35], a[176:179], a[0:3], v[32:35]
  ds_read_b64_tr_b16 a[160:161], v228 offset:32768
  v_mfma_f32_16x16x32_bf16 v[32:35], a[180:183], a[16:19], v[32:35]
  buffer_load_dwordx4 a[120:123], v243, s[24:27], s30 offen offset:2048
  v_mfma_f32_16x16x32_bf16 v[36:39], a[180:183], a[20:23], v[36:39]
  ds_read_b64_tr_b16 a[162:163], v228 offset:33792
  v_mfma_f32_16x16x32_bf16 v[36:39], a[176:179], a[4:7], v[36:39]
  buffer_load_dwordx4 a[124:127], v243, s[24:27], s30 offen offset:3072
  v_mfma_f32_16x16x32_bf16 v[40:43], a[176:179], a[8:11], v[40:43]
  ds_read_b64_tr_b16 a[164:165], v228 offset:40960
  v_mfma_f32_16x16x32_bf16 v[40:43], a[180:183], a[24:27], v[40:43]
  s_add_u32 s30, s30, 8192
  v_mfma_f32_16x16x32_bf16 v[44:47], a[180:183], a[28:31], v[44:47]
  ds_read_b64_tr_b16 a[166:167], v228 offset:41984
  v_mfma_f32_16x16x32_bf16 v[44:47], a[176:179], a[12:15], v[44:47]
  s_waitcnt lgkmcnt(4)
  v_mfma_f32_16x16x32_bf16 v[48:51], a[184:187], a[0:3], v[48:51]
  ds_read_b64_tr_b16 a[168:169], v229 offset:32768
  v_mfma_f32_16x16x32_bf16 v[48:51], a[188:191], a[16:19], v[48:51]
  v_mfma_f32_16x16x32_bf16 v[52:55], a[188:191], a[20:23], v[52:55]
  ds_read_b64_tr_b16 a[170:171], v229 offset:33792
  v_mfma_f32_16x16x32_bf16 v[52:55], a[184:187], a[4:7], v[52:55]
  v_mfma_f32_16x16x32_bf16 v[56:59], a[184:187], a[8:11], v[56:59]
  ds_read_b64_tr_b16 a[172:173], v229 offset:40960
  v_mfma_f32_16x16x32_bf16 v[56:59], a[188:191], a[24:27], v[56:59]
  v_mfma_f32_16x16x32_bf16 v[60:63], a[188:191], a[28:31], v[60:63]
  ds_read_b64_tr_b16 a[174:175], v229 offset:41984
  v_mfma_f32_16x16x32_bf16 v[60:63], a[184:187], a[12:15], v[60:63]
  s_waitcnt lgkmcnt(4)
  v_mfma_f32_16x16x32_bf16 v[64:67], a[160:163], a[0:3], v[64:67]
  ds_read_b64_tr_b16 a[176:177], v230 offset:32768
  v_min_u32_dpp v136, v136, v136 row_ror:2 row_mask:0xf bank_mask:0xf
  v_mfma_f32_16x16x32_bf16 v[64:67], a[164:167], a[16:19], v[64:67]
  v_mfma_f32_16x16x32_bf16 v[68:71], a[164:167], a[20:23], v[68:71]
  ds_read_b64_tr_b16 a[178:179], v230 offset:33792
  v_min_u32_dpp v136, v136, v136 row_ror:1 row_mask:0xf bank_mask:0xf
  v_mfma_f32_16x16x32_bf16 v[68:71], a[160:163], a[4:7], v[68:71]
  v_readlane_b32 s98, v136, 0
  v_readlane_b32 s99, v136, 16
  v_mfma_f32_16x16x32_bf16 v[72:75], a[160:163], a[8:11], v[72:75]
  ds_read_b64_tr_b16 a[180:181], v230 offset:40960
  v_readlane_b32 s100, v136, 32
  v_mfma_f32_16x16x32_bf16 v[72:75], a[164:167], a[24:27], v[72:75]
  v_readlane_b32 s101, v136, 48
  v_mfma_f32_16x16x32_bf16 v[76:79], a[164:167], a[28:31], v[76:79]
  ds_read_b64_tr_b16 a[182:183], v230 offset:41984
  s_min_u32 s98, s98, s99
  s_min_u32 s100, s100, s101
  s_min_u32 s98, s98, s100
  s_sub_u32 s53, s51, s98
  s_sub_u32 s51, s53, 1
  v_sub_u32 v137, s51, v128
  v_mfma_f32_16x16x32_bf16 v[76:79], a[160:163], a[12:15], v[76:79]
  s_waitcnt lgkmcnt(4)
  v_sub_u32 v138, s51, v129
  v_min_u32 v136, v137, v138
  v_mfma_f32_16x16x32_bf16 v[80:83], a[168:171], a[0:3], v[80:83]
  ds_read_b64_tr_b16 a[184:185], v231 offset:32768
  v_sub_u32 v139, s51, v130
  v_mfma_f32_16x16x32_bf16 v[80:83], a[172:175], a[16:19], v[80:83]
  v_sub_u32 v140, s51, v131
  v_min3_u32 v136, v136, v139, v140
  v_mfma_f32_16x16x32_bf16 v[84:87], a[172:175], a[20:23], v[84:87]
  ds_read_b64_tr_b16 a[186:187], v231 offset:33792
  v_sub_u32 v137, s51, v132
  v_mfma_f32_16x16x32_bf16 v[84:87], a[168:171], a[4:7], v[84:87]
  s_waitcnt vmcnt(20)
  v_sub_u32 v138, s51, v133
  v_min3_u32 v136, v136, v137, v138
  v_mfma_f32_16x16x32_bf16 v[88:91], a[168:171], a[8:11], v[88:91]
  ds_read_b64_tr_b16 a[188:189], v231 offset:40960
  v_sub_u32 v139, s51, v134
  v_mfma_f32_16x16x32_bf16 v[88:91], a[172:175], a[24:27], v[88:91]
  s_barrier
  v_sub_u32 v140, s51, v135
  v_min3_u32 v136, v136, v139, v140
  v_mfma_f32_16x16x32_bf16 v[92:95], a[172:175], a[28:31], v[92:95]
  ds_read_b64_tr_b16 a[190:191], v231 offset:41984
  v_min_u32_dpp v136, v136, v136 row_ror:8 row_mask:0xf bank_mask:0xf
  v_mfma_f32_16x16x32_bf16 v[92:95], a[168:171], a[12:15], v[92:95]
  s_waitcnt lgkmcnt(4)
  s_add_u32 m0, s28, 81920
  v_min_u32_dpp v136, v136, v136 row_ror:4 row_mask:0xf bank_mask:0xf
  v_mfma_f32_16x16x32_bf16 v[96:99], a[176:179], a[0:3], v[96:99]
  ds_read_b64_tr_b16 a[160:161], v224 offset:49152
  v_min_u32_dpp v136, v136, v136 row_ror:2 row_mask:0xf bank_mask:0xf
  v_mfma_f32_16x16x32_bf16 v[96:99], a[180:183], a[16:19], v[96:99]
  buffer_load_dwordx4 v238, s[20:23], s31 offen offset:0 lds
  v_mfma_f32_16x16x32_bf16 v[100:103], a[180:183], a[20:23], v[100:103]
  ds_read_b64_tr_b16 a[162:163], v224 offset:50176
  v_min_u32_dpp v136, v136, v136 row_ror:1 row_mask:0xf bank_mask:0xf
  v_mfma_f32_16x16x32_bf16 v[100:103], a[176:179], a[4:7], v[100:103]
  buffer_load_dwordx4 v239, s[20:23], s31 offen offset:1024 lds
  v_mfma_f32_16x16x32_bf16 v[104:107], a[176:179], a[8:11], v[104:107]
  ds_read_b64_tr_b16 a[164:165], v224 offset:57344
  v_readlane_b32 s98, v136, 0
  v_mfma_f32_16x16x32_bf16 v[104:107], a[180:183], a[24:27], v[104:107]
  buffer_load_dwordx4 v240, s[20:23], s31 offen offset:2048 lds
  v_mfma_f32_16x16x32_bf16 v[108:111], a[180:183], a[28:31], v[108:111]
  ds_read_b64_tr_b16 a[166:167], v224 offset:58368
  v_readlane_b32 s99, v136, 16
  v_mfma_f32_16x16x32_bf16 v[108:111], a[176:179], a[12:15], v[108:111]
  s_waitcnt lgkmcnt(4)
  v_readlane_b32 s100, v136, 32
  v_readlane_b32 s101, v136, 48
  v_mfma_f32_16x16x32_bf16 v[112:115], a[184:187], a[0:3], v[112:115]
  ds_read_b64_tr_b16 a[168:169], v225 offset:49152
  s_min_u32 s98, s98, s99
  s_min_u32 s100, s100, s101
  s_min_u32 s98, s98, s100
  s_sub_u32 s54, s51, s98
  s_sub_u32 s51, s54, 1
  v_sub_u32 v137, s51, v128
  v_mfma_f32_16x16x32_bf16 v[112:115], a[188:191], a[16:19], v[112:115]
  buffer_load_dwordx4 v241, s[20:23], s31 offen offset:3072 lds
  v_mfma_f32_16x16x32_bf16 v[116:119], a[188:191], a[20:23], v[116:119]
  ds_read_b64_tr_b16 a[170:171], v225 offset:50176
  v_sub_u32 v138, s51, v129
  v_mfma_f32_16x16x32_bf16 v[116:119], a[184:187], a[4:7], v[116:119]
  s_add_u32 s31, s31, 0x80000
  v_min_u32 v136, v137, v138
  v_sub_u32 v139, s51, v130
  v_mfma_f32_16x16x32_bf16 v[120:123], a[184:187], a[8:11], v[120:123]
  ds_read_b64_tr_b16 a[172:173], v225 offset:57344
  v_sub_u32 v140, s51, v131
  v_mfma_f32_16x16x32_bf16 v[120:123], a[188:191], a[24:27], v[120:123]
  v_min3_u32 v136, v136, v139, v140
  v_sub_u32 v137, s51, v132
  v_mfma_f32_16x16x32_bf16 v[124:127], a[188:191], a[28:31], v[124:127]
  ds_read_b64_tr_b16 a[174:175], v225 offset:58368
  v_sub_u32 v138, s51, v133
  v_mfma_f32_16x16x32_bf16 v[124:127], a[184:187], a[12:15], v[124:127]
  s_waitcnt lgkmcnt(4)
  v_min3_u32 v136, v136, v137, v138
  v_sub_u32 v139, s51, v134
  v_mfma_f32_16x16x32_bf16 v[0:3], a[160:163], a[32:35], v[0:3]
  ds_read_b64_tr_b16 a[176:177], v226 offset:49152
  v_mfma_f32_16x16x32_bf16 v[0:3], a[164:167], a[48:51], v[0:3]
  buffer_load_dwordx4 a[0:3], v242, s[24:27], s30 offen offset:0
  v_mfma_f32_16x16x32_bf16 v[4:7], a[164:167], a[52:55], v[4:7]
  ds_read_b64_tr_b16 a[178:179], v226 offset:50176
  v_mfma_f32_16x16x32_bf16 v[4:7], a[160:163], a[36:39], v[4:7]
  buffer_load_dwordx4 a[4:7], v242, s[24:27], s30 offen offset:1024
  v_mfma_f32_16x16x32_bf16 v[8:11], a[160:163], a[40:43], v[8:11]
  ds_read_b64_tr_b16 a[180:181], v226 offset:57344
  v_mfma_f32_16x16x32_bf16 v[8:11], a[164:167], a[56:59], v[8:11]
  buffer_load_dwordx4 a[8:11], v242, s[24:27], s30 offen offset:2048
  v_mfma_f32_16x16x32_bf16 v[12:15], a[164:167], a[60:63], v[12:15]
  ds_read_b64_tr_b16 a[182:183], v226 offset:58368
  v_mfma_f32_16x16x32_bf16 v[12:15], a[160:163], a[44:47], v[12:15]
  s_waitcnt lgkmcnt(4)
  v_mfma_f32_16x16x32_bf16 v[16:19], a[168:171], a[32:35], v[16:19]
  ds_read_b64_tr_b16 a[184:185], v227 offset:49152
  v_mfma_f32_16x16x32_bf16 v[16:19], a[172:175], a[48:51], v[16:19]
  buffer_load_dwordx4 a[12:15], v242, s[24:27], s30 offen offset:3072
  v_mfma_f32_16x16x32_bf16 v[20:23], a[172:175], a[52:55], v[20:23]
  ds_read_b64_tr_b16 a[186:187], v227 offset:50176
  v_mfma_f32_16x16x32_bf16 v[20:23], a[168:171], a[36:39], v[20:23]
  buffer_load_dwordx4 a[16:19], v243, s[24:27], s30 offen offset:0
  v_mfma_f32_16x16x32_bf16 v[24:27], a[168:171], a[40:43], v[24:27]
  ds_read_b64_tr_b16 a[188:189], v227 offset:57344
  v_mfma_f32_16x16x32_bf16 v[24:27], a[172:175], a[56:59], v[24:27]
  buffer_load_dwordx4 a[20:23], v243, s[24:27], s30 offen offset:1024
  v_mfma_f32_16x16x32_bf16 v[28:31], a[172:175], a[60:63], v[28:31]
  ds_read_b64_tr_b16 a[190:191], v227 offset:58368
  v_mfma_f32_16x16x32_bf16 v[28:31], a[168:171], a[44:47], v[28:31]
  s_waitcnt lgkmcnt(4)
  v_mfma_f32_16x16x32_bf16 v[32:35], a[176:179], a[32:35], v[32:35]
  ds_read_b64_tr_b16 a[160:161], v228 offset:49152
  v_mfma_f32_16x16x32_bf16 v[32:35], a[180:183], a[48:51], v[32:35]
  buffer_load_dwordx4 a[24:27], v243, s[24:27], s30 offen offset:2048
  v_mfma_f32_16x16x32_bf16 v[36:39], a[180:183], a[52:55], v[36:39]
  ds_read_b64_tr_b16 a[162:163], v228 offset:50176
  v_mfma_f32_16x16x32_bf16 v[36:39], a[176:179], a[36:39], v[36:39]
  buffer_load_dwordx4 a[28:31], v243, s[24:27], s30 offen offset:3072
  v_mfma_f32_16x16x32_bf16 v[40:43], a[176:179], a[40:43], v[40:43]
  ds_read_b64_tr_b16 a[164:165], v228 offset:57344
  v_mfma_f32_16x16x32_bf16 v[40:43], a[180:183], a[56:59], v[40:43]
  s_add_u32 s30, s30, 8192
  v_mfma_f32_16x16x32_bf16 v[44:47], a[180:183], a[60:63], v[44:47]
  ds_read_b64_tr_b16 a[166:167], v228 offset:58368
  v_mfma_f32_16x16x32_bf16 v[44:47], a[176:179], a[44:47], v[44:47]
  s_waitcnt lgkmcnt(4)
  v_mfma_f32_16x16x32_bf16 v[48:51], a[184:187], a[32:35], v[48:51]
  ds_read_b64_tr_b16 a[168:169], v229 offset:49152
  v_mfma_f32_16x16x32_bf16 v[48:51], a[188:191], a[48:51], v[48:51]
  s_add_u32 m0, s28, 0
  v_mfma_f32_16x16x32_bf16 v[52:55], a[188:191], a[52:55], v[52:55]
  ds_read_b64_tr_b16 a[170:171], v229 offset:50176
  v_mfma_f32_16x16x32_bf16 v[52:55], a[184:187], a[36:39], v[52:55]
  buffer_load_dwordx4 v232, s[12:15], s29 offen offset:0 lds
  v_mfma_f32_16x16x32_bf16 v[56:59], a[184:187], a[40:43], v[56:59]
  ds_read_b64_tr_b16 a[172:173], v229 offset:57344
  v_mfma_f32_16x16x32_bf16 v[56:59], a[188:191], a[56:59], v[56:59]
  buffer_load_dwordx4 v233, s[12:15], s29 offen offset:1024 lds
  v_mfma_f32_16x16x32_bf16 v[60:63], a[188:191], a[60:63], v[60:63]
  ds_read_b64_tr_b16 a[174:175], v229 offset:58368
  v_mfma_f32_16x16x32_bf16 v[60:63], a[184:187], a[44:47], v[60:63]
  s_waitcnt lgkmcnt(4)
  v_mfma_f32_16x16x32_bf16 v[64:67], a[160:163], a[32:35], v[64:67]
  ds_read_b64_tr_b16 a[176:177], v230 offset:49152
  v_sub_u32 v140, s51, v135
  v_mfma_f32_16x16x32_bf16 v[64:67], a[164:167], a[48:51], v[64:67]
  buffer_load_dwordx4 v234, s[12:15], s29 offen offset:2048 lds
  v_mfma_f32_16x16x32_bf16 v[68:71], a[164:167], a[52:55], v[68:71]
  ds_read_b64_tr_b16 a[178:179], v230 offset:50176
  v_min3_u32 v136, v136, v139, v140
  v_mfma_f32_16x16x32_bf16 v[68:71], a[160:163], a[36:39], v[68:71]
  buffer_load_dwordx4 v235, s[12:15], s29 offen offset:3072 lds
  v_mfma_f32_16x16x32_bf16 v[72:75], a[160:163], a[40:43], v[72:75]
  ds_read_b64_tr_b16 a[180:181], v230 offset:57344
  v_min_u32_dpp v136, v136, v136 row_ror:8 row_mask:0xf bank_mask:0xf
  v_mfma_f32_16x16x32_bf16 v[72:75], a[164:167], a[56:59], v[72:75]
  s_add_u32 s29, s29, 16384
  v_min_u32_dpp v136, v136, v136 row_ror:4 row_mask:0xf bank_mask:0xf
  v_mfma_f32_16x16x32_bf16 v[76:79], a[164:167], a[60:63], v[76:79]
  ds_read_b64_tr_b16 a[182:183], v230 offset:58368
  v_min_u32_dpp v136, v136, v136 row_ror:2 row_mask:0xf bank_mask:0xf
  v_mfma_f32_16x16x32_bf16 v[76:79], a[160:163], a[44:47], v[76:79]
  s_waitcnt lgkmcnt(4)
  v_min_u32_dpp v136, v136, v136 row_ror:1 row_mask:0xf bank_mask:0xf
  v_mfma_f32_16x16x32_bf16 v[80:83], a[168:171], a[32:35], v[80:83]
  ds_read_b64_tr_b16 a[184:185], v231 offset:49152
  v_readlane_b32 s98, v136, 0
  v_mfma_f32_16x16x32_bf16 v[80:83], a[172:175], a[48:51], v[80:83]
  v_readlane_b32 s99, v136, 16
  v_readlane_b32 s100, v136, 32
  v_mfma_f32_16x16x32_bf16 v[84:87], a[172:175], a[52:55], v[84:87]
  ds_read_b64_tr_b16 a[186:187], v231 offset:50176
  v_readlane_b32 s101, v136, 48
  v_mfma_f32_16x16x32_bf16 v[84:87], a[168:171], a[36:39], v[84:87]
  s_waitcnt vmcnt(24)
  s_min_u32 s98, s98, s99
  s_min_u32 s100, s100, s101
  s_min_u32 s98, s98, s100
  s_sub_u32 s55, s51, s98
  s_sub_u32 s51, s55, 1
  v_sub_u32 v137, s51, v128
  v_sub_u32 v138, s51, v129
  v_mfma_f32_16x16x32_bf16 v[88:91], a[168:171], a[40:43], v[88:91]
  ds_read_b64_tr_b16 a[188:189], v231 offset:57344
  v_min_u32 v136, v137, v138
  v_mfma_f32_16x16x32_bf16 v[88:91], a[172:175], a[56:59], v[88:91]
  s_barrier
  v_sub_u32 v139, s51, v130
  v_sub_u32 v140, s51, v131
  v_mfma_f32_16x16x32_bf16 v[92:95], a[172:175], a[60:63], v[92:95]
  ds_read_b64_tr_b16 a[190:191], v231 offset:58368
  v_min3_u32 v136, v136, v139, v140
  v_mfma_f32_16x16x32_bf16 v[92:95], a[168:171], a[44:47], v[92:95]
  s_waitcnt lgkmcnt(4)
  s_add_u32 m0, s28, 98304
  v_sub_u32 v137, s51, v132
  v_sub_u32 v138, s51, v133
  v_mfma_f32_16x16x32_bf16 v[96:99], a[176:179], a[32:35], v[96:99]
  ds_read_b64_tr_b16 a[160:161], v224 offset:0
  v_min3_u32 v136, v136, v137, v138
  v_mfma_f32_16x16x32_bf16 v[96:99], a[180:183], a[48:51], v[96:99]
  buffer_load_dwordx4 v238, s[20:23], s31 offen offset:0 lds
  v_mfma_f32_16x16x32_bf16 v[100:103], a[180:183], a[52:55], v[100:103]
  ds_read_b64_tr_b16 a[162:163], v224 offset:1024
  v_sub_u32 v139, s51, v134
  v_mfma_f32_16x16x32_bf16 v[100:103], a[176:179], a[36:39], v[100:103]
  buffer_load_dwordx4 v239, s[20:23], s31 offen offset:1024 lds
  v_mfma_f32_16x16x32_bf16 v[104:107], a[176:179], a[40:43], v[104:107]
  ds_read_b64_tr_b16 a[164:165], v224 offset:8192
  v_sub_u32 v140, s51, v135
  v_mfma_f32_16x16x32_bf16 v[104:107], a[180:183], a[56:59], v[104:107]
  buffer_load_dwordx4 v240, s[20:23], s31 offen offset:2048 lds
  v_mfma_f32_16x16x32_bf16 v[108:111], a[180:183], a[60:63], v[108:111]
  ds_read_b64_tr_b16 a[166:167], v224 offset:9216
  v_min3_u32 v136, v136, v139, v140
  v_mfma_f32_16x16x32_bf16 v[108:111], a[176:179], a[44:47], v[108:111]
  s_waitcnt lgkmcnt(4)
  v_min_u32_dpp v136, v136, v136 row_ror:8 row_mask:0xf bank_mask:0xf
  v_mfma_f32_16x16x32_bf16 v[112:115], a[184:187], a[32:35], v[112:115]
  ds_read_b64_tr_b16 a[168:169], v225 offset:0
  v_min_u32_dpp v136, v136, v136 row_ror:4 row_mask:0xf bank_mask:0xf
  v_mfma_f32_16x16x32_bf16 v[112:115], a[188:191], a[48:51], v[112:115]
  buffer_load_dwordx4 v241, s[20:23], s31 offen offset:3072 lds
  v_mfma_f32_16x16x32_bf16 v[116:119], a[188:191], a[52:55], v[116:119]
  ds_read_b64_tr_b16 a[170:171], v225 offset:1024
  v_min_u32_dpp v136, v136, v136 row_ror:2 row_mask:0xf bank_mask:0xf
  v_mfma_f32_16x16x32_bf16 v[116:119], a[184:187], a[36:39], v[116:119]
  s_add_u32 s31, s31, 0x80000
  v_min_u32_dpp v136, v136, v136 row_ror:1 row_mask:0xf bank_mask:0xf
  v_mfma_f32_16x16x32_bf16 v[120:123], a[184:187], a[40:43], v[120:123]
  ds_read_b64_tr_b16 a[172:173], v225 offset:8192
  v_readlane_b32 s98, v136, 0
  v_mfma_f32_16x16x32_bf16 v[120:123], a[188:191], a[56:59], v[120:123]
  v_readlane_b32 s99, v136, 16
  v_readlane_b32 s100, v136, 32
  v_mfma_f32_16x16x32_bf16 v[124:127], a[188:191], a[60:63], v[124:127]
  ds_read_b64_tr_b16 a[174:175], v225 offset:9216
  v_readlane_b32 s101, v136, 48
  v_mfma_f32_16x16x32_bf16 v[124:127], a[184:187], a[44:47], v[124:127]
  s_waitcnt lgkmcnt(4)
  s_min_u32 s98, s98, s99
  s_min_u32 s100, s100, s101
  s_min_u32 s98, s98, s100
  s_sub_u32 s56, s51, s98
  s_sub_u32 s51, s56, 1
  v_sub_u32 v137, s51, v128
  v_sub_u32 v138, s51, v129
  v_mfma_f32_16x16x32_bf16 v[0:3], a[160:163], a[64:67], v[0:3]
  ds_read_b64_tr_b16 a[176:177], v226 offset:0
  v_mfma_f32_16x16x32_bf16 v[0:3], a[164:167], a[80:83], v[0:3]
  buffer_load_dwordx4 a[32:35], v242, s[24:27], s30 offen offset:0
  v_mfma_f32_16x16x32_bf16 v[4:7], a[164:167], a[84:87], v[4:7]
  ds_read_b64_tr_b16 a[178:179], v226 offset:1024
  v_mfma_f32_16x16x32_bf16 v[4:7], a[160:163], a[68:71], v[4:7]
  buffer_load_dwordx4 a[36:39], v242, s[24:27], s30 offen offset:1024
  v_mfma_f32_16x16x32_bf16 v[8:11], a[160:163], a[72:75], v[8:11]
  ds_read_b64_tr_b16 a[180:181], v226 offset:8192
  v_mfma_f32_16x16x32_bf16 v[8:11], a[164:167], a[88:91], v[8:11]
  buffer_load_dwordx4 a[40:43], v242, s[24:27], s30 offen offset:2048
  v_mfma_f32_16x16x32_bf16 v[12:15], a[164:167], a[92:95], v[12:15]
  ds_read_b64_tr_b16 a[182:183], v226 offset:9216
  v_mfma_f32_16x16x32_bf16 v[12:15], a[160:163], a[76:79], v[12:15]
  s_waitcnt lgkmcnt(4)
  v_mfma_f32_16x16x32_bf16 v[16:19], a[168:171], a[64:67], v[16:19]
  ds_read_b64_tr_b16 a[184:185], v227 offset:0
  v_mfma_f32_16x16x32_bf16 v[16:19], a[172:175], a[80:83], v[16:19]
  buffer_load_dwordx4 a[44:47], v242, s[24:27], s30 offen offset:3072
  v_mfma_f32_16x16x32_bf16 v[20:23], a[172:175], a[84:87], v[20:23]
  ds_read_b64_tr_b16 a[186:187], v227 offset:1024
  v_mfma_f32_16x16x32_bf16 v[20:23], a[168:171], a[68:71], v[20:23]
  buffer_load_dwordx4 a[48:51], v243, s[24:27], s30 offen offset:0
  v_mfma_f32_16x16x32_bf16 v[24:27], a[168:171], a[72:75], v[24:27]
  ds_read_b64_tr_b16 a[188:189], v227 offset:8192
  v_mfma_f32_16x16x32_bf16 v[24:27], a[172:175], a[88:91], v[24:27]
  buffer_load_dwordx4 a[52:55], v243, s[24:27], s30 offen offset:1024
  v_mfma_f32_16x16x32_bf16 v[28:31], a[172:175], a[92:95], v[28:31]
  ds_read_b64_tr_b16 a[190:191], v227 offset:9216
  v_mfma_f32_16x16x32_bf16 v[28:31], a[168:171], a[76:79], v[28:31]
  s_waitcnt lgkmcnt(4)
  v_mfma_f32_16x16x32_bf16 v[32:35], a[176:179], a[64:67], v[32:35]
  ds_read_b64_tr_b16 a[160:161], v228 offset:0
  v_mfma_f32_16x16x32_bf16 v[32:35], a[180:183], a[80:83], v[32:35]
  buffer_load_dwordx4 a[56:59], v243, s[24:27], s30 offen offset:2048
  v_mfma_f32_16x16x32_bf16 v[36:39], a[180:183], a[84:87], v[36:39]
  ds_read_b64_tr_b16 a[162:163], v228 offset:1024
  v_mfma_f32_16x16x32_bf16 v[36:39], a[176:179], a[68:71], v[36:39]
  buffer_load_dwordx4 a[60:63], v243, s[24:27], s30 offen offset:3072
  v_mfma_f32_16x16x32_bf16 v[40:43], a[176:179], a[72:75], v[40:43]
  ds_read_b64_tr_b16 a[164:165], v228 offset:8192
  v_mfma_f32_16x16x32_bf16 v[40:43], a[180:183], a[88:91], v[40:43]
  s_add_u32 s30, s30, 8192
  v_mfma_f32_16x16x32_bf16 v[44:47], a[180:183], a[92:95], v[44:47]
  ds_read_b64_tr_b16 a[166:167], v228 offset:9216
  v_mfma_f32_16x16x32_bf16 v[44:47], a[176:179], a[76:79], v[44:47]
  s_waitcnt lgkmcnt(4)
  v_mfma_f32_16x16x32_bf16 v[48:51], a[184:187], a[64:67], v[48:51]
  ds_read_b64_tr_b16 a[168:169], v229 offset:0
  v_mfma_f32_16x16x32_bf16 v[48:51], a[188:191], a[80:83], v[48:51]
  s_add_u32 m0, s28, 16384
  v_mfma_f32_16x16x32_bf16 v[52:55], a[188:191], a[84:87], v[52:55]
  ds_read_b64_tr_b16 a[170:171], v229 offset:1024
  v_mfma_f32_16x16x32_bf16 v[52:55], a[184:187], a[68:71], v[52:55]
  buffer_load_dwordx4 v232, s[12:15], s29 offen offset:0 lds
  v_mfma_f32_16x16x32_bf16 v[56:59], a[184:187], a[72:75], v[56:59]
  ds_read_b64_tr_b16 a[172:173], v229 offset:8192
  v_mfma_f32_16x16x32_bf16 v[56:59], a[188:191], a[88:91], v[56:59]
  buffer_load_dwordx4 v233, s[12:15], s29 offen offset:1024 lds
  v_mfma_f32_16x16x32_bf16 v[60:63], a[188:191], a[92:95], v[60:63]
  ds_read_b64_tr_b16 a[174:175], v229 offset:9216
  v_mfma_f32_16x16x32_bf16 v[60:63], a[184:187], a[76:79], v[60:63]
  s_waitcnt lgkmcnt(4)
  v_mfma_f32_16x16x32_bf16 v[64:67], a[160:163], a[64:67], v[64:67]
  ds_read_b64_tr_b16 a[176:177], v230 offset:0
  v_min_u32 v136, v137, v138
  v_mfma_f32_16x16x32_bf16 v[64:67], a[164:167], a[80:83], v[64:67]
  buffer_load_dwordx4 v234, s[12:15], s29 offen offset:2048 lds
  v_mfma_f32_16x16x32_bf16 v[68:71], a[164:167], a[84:87], v[68:71]
  ds_read_b64_tr_b16 a[178:179], v230 offset:1024
  v_sub_u32 v139, s51, v130
  v_mfma_f32_16x16x32_bf16 v[68:71], a[160:163], a[68:71], v[68:71]
  buffer_load_dwordx4 v235, s[12:15], s29 offen offset:3072 lds
  v_mfma_f32_16x16x32_bf16 v[72:75], a[160:163], a[72:75], v[72:75]
  ds_read_b64_tr_b16 a[180:181], v230 offset:8192
  v_sub_u32 v140, s51, v131
  v_mfma_f32_16x16x32_bf16 v[72:75], a[164:167], a[88:91], v[72:75]
  s_add_u32 s29, s29, 16384
  v_min3_u32 v136, v136, v139, v140
  v_sub_u32 v137, s51, v132
  v_mfma_f32_16x16x32_bf16 v[76:79], a[164:167], a[92:95], v[76:79]
  ds_read_b64_tr_b16 a[182:183], v230 offset:9216
  v_sub_u32 v138, s51, v133
  v_mfma_f32_16x16x32_bf16 v[76:79], a[160:163], a[76:79], v[76:79]
  s_waitcnt lgkmcnt(4)
  v_min3_u32 v136, v136, v137, v138
  v_sub_u32 v139, s51, v134
  v_mfma_f32_16x16x32_bf16 v[80:83], a[168:171], a[64:67], v[80:83]
  ds_read_b64_tr_b16 a[184:185], v231 offset:0
  v_sub_u32 v140, s51, v135
  v_mfma_f32_16x16x32_bf16 v[80:83], a[172:175], a[80:83], v[80:83]
  v_min3_u32 v136, v136, v139, v140
  v_mfma_f32_16x16x32_bf16 v[84:87], a[172:175], a[84:87], v[84:87]
  ds_read_b64_tr_b16 a[186:187], v231 offset:1024
  v_min_u32_dpp v136, v136, v136 row_ror:8 row_mask:0xf bank_mask:0xf
  v_mfma_f32_16x16x32_bf16 v[84:87], a[168:171], a[68:71], v[84:87]
  s_waitcnt vmcnt(28)
  v_min_u32_dpp v136, v136, v136 row_ror:4 row_mask:0xf bank_mask:0xf
  v_mfma_f32_16x16x32_bf16 v[88:91], a[168:171], a[72:75], v[88:91]
  ds_read_b64_tr_b16 a[188:189], v231 offset:8192
  v_min_u32_dpp v136, v136, v136 row_ror:2 row_mask:0xf bank_mask:0xf
  s_nop 1
  v_min_u32_dpp v136, v136, v136 row_ror:1 row_mask:0xf bank_mask:0xf
  s_nop 0
  v_readlane_b32 s98, v136, 0
  v_readlane_b32 s99, v136, 16
  v_readlane_b32 s100, v136, 32
  v_readlane_b32 s101, v136, 48
  s_min_u32 s98, s98, s99
  s_min_u32 s100, s100, s101
  s_min_u32 s98, s98, s100
  s_sub_u32 s57, s51, s98
  s_sub_u32 s51, s57, 1
  v_sub_u32 v137, s51, v128
  v_sub_u32 v138, s51, v129
  v_min_u32 v136, v137, v138
  v_sub_u32 v139, s51, v130
  v_sub_u32 v140, s51, v131
  v_min3_u32 v136, v136, v139, v140
  v_sub_u32 v137, s51, v132
  v_sub_u32 v138, s51, v133
  v_min3_u32 v136, v136, v137, v138
  v_sub_u32 v139, s51, v134
  v_sub_u32 v140, s51, v135
  v_min3_u32 v136, v136, v139, v140
  s_nop 1
  v_min_u32_dpp v136, v136, v136 row_ror:8 row_mask:0xf bank_mask:0xf
  s_nop 1
  v_min_u32_dpp v136, v136, v136 row_ror:4 row_mask:0xf bank_mask:0xf
  s_nop 1
  v_min_u32_dpp v136, v136, v136 row_ror:2 row_mask:0xf bank_mask:0xf
  s_nop 1
  v_min_u32_dpp v136, v136, v136 row_ror:1 row_mask:0xf bank_mask:0xf
  s_nop 0
  v_readlane_b32 s98, v136, 0
  v_readlane_b32 s99, v136, 16
  v_readlane_b32 s100, v136, 32
  v_readlane_b32 s101, v136, 48
  s_min_u32 s98, s98, s99
  s_min_u32 s100, s100, s101
  s_min_u32 s98, s98, s100
  s_sub_u32 s58, s51, s98
  s_sub_u32 s51, s58, 1
  v_sub_u32 v137, s51, v128
  v_sub_u32 v138, s51, v129
  v_min_u32 v136, v137, v138
  v_sub_u32 v139, s51, v130
  v_sub_u32 v140, s51, v131
  v_min3_u32 v136, v136, v139, v140
  v_sub_u32 v137, s51, v132
  v_sub_u32 v138, s51, v133
  v_min3_u32 v136, v136, v137, v138
  v_sub_u32 v139, s51, v134
  v_sub_u32 v140, s51, v135
  v_min3_u32 v136, v136, v139, v140
  s_nop 1
  v_min_u32_dpp v136, v136, v136 row_ror:8 row_mask:0xf bank_mask:0xf
  s_nop 1
  v_min_u32_dpp v136, v136, v136 row_ror:4 row_mask:0xf bank_mask:0xf
  s_nop 1
  v_min_u32_dpp v136, v136, v136 row_ror:2 row_mask:0xf bank_mask:0xf
  s_nop 1
  v_min_u32_dpp v136, v136, v136 row_ror:1 row_mask:0xf bank_mask:0xf
  s_nop 0
  v_readlane_b32 s98, v136, 0
  v_readlane_b32 s99, v136, 16
  v_readlane_b32 s100, v136, 32
  v_readlane_b32 s101, v136, 48
  s_min_u32 s98, s98, s99
  s_min_u32 s100, s100, s101
  s_min_u32 s98, s98, s100
  s_sub_u32 s59, s51, s98
  s_sub_u32 s51, s59, 1
  v_writelane_b32 v136, s52, 0
  v_writelane_b32 v136, s53, 1
  v_writelane_b32 v136, s54, 2
  v_writelane_b32 v136, s55, 3
  v_writelane_b32 v136, s56, 4
  v_writelane_b32 v136, s57, 5
  v_writelane_b32 v136, s58, 6
  v_writelane_b32 v136, s59, 7
  s_lshl_b32 s35, s3, 8
  s_add_u32 s35, s35, 158720
  v_lshrrev_b32 v137, 2, v242
  v_add_u32 v137, s35, v137
  ds_write_b32 v137, v136
  s_waitcnt lgkmcnt(0)
  v_mfma_f32_16x16x32_bf16 v[88:91], a[172:175], a[88:91], v[88:91]
  s_barrier
  v_mfma_f32_16x16x32_bf16 v[92:95], a[172:175], a[92:95], v[92:95]
  ds_read_b64_tr_b16 a[190:191], v231 offset:9216
  v_mfma_f32_16x16x32_bf16 v[92:95], a[168:171], a[76:79], v[92:95]
  s_add_u32 m0, s28, 114688
  v_mfma_f32_16x16x32_bf16 v[96:99], a[176:179], a[64:67], v[96:99]
  ds_read_b64_tr_b16 a[160:161], v224 offset:16384
  v_mfma_f32_16x16x32_bf16 v[96:99], a[180:183], a[80:83], v[96:99]
  buffer_load_dwordx4 v238, s[20:23], s31 offen offset:0 lds
  v_mfma_f32_16x16x32_bf16 v[100:103], a[180:183], a[84:87], v[100:103]
  ds_read_b64_tr_b16 a[162:163], v224 offset:17408
  v_mfma_f32_16x16x32_bf16 v[100:103], a[176:179], a[68:71], v[100:103]
  buffer_load_dwordx4 v239, s[20:23], s31 offen offset:1024 lds
  v_mfma_f32_16x16x32_bf16 v[104:107], a[176:179], a[72:75], v[104:107]
  ds_read_b64_tr_b16 a[164:165], v224 offset:24576
  v_mfma_f32_16x16x32_bf16 v[104:107], a[180:183], a[88:91], v[104:107]
  buffer_load_dwordx4 v240, s[20:23], s31 offen offset:2048 lds
  v_mfma_f32_16x16x32_bf16 v[108:111], a[180:183], a[92:95], v[108:111]
  ds_read_b64_tr_b16 a[166:167], v224 offset:25600
  v_mfma_f32_16x16x32_bf16 v[108:111], a[176:179], a[76:79], v[108:111]
  s_waitcnt lgkmcnt(4)
  v_mfma_f32_16x16x32_bf16 v[112:115], a[184:187], a[64:67], v[112:115]
  ds_read_b64_tr_b16 a[168:169], v225 offset:16384
  v_mfma_f32_16x16x32_bf16 v[112:115], a[188:191], a[80:83], v[112:115]
  buffer_load_dwordx4 v241, s[20:23], s31 offen offset:3072 lds
  v_mfma_f32_16x16x32_bf16 v[116:119], a[188:191], a[84:87], v[116:119]
  ds_read_b64_tr_b16 a[170:171], v225 offset:17408
  v_mfma_f32_16x16x32_bf16 v[116:119], a[184:187], a[68:71], v[116:119]
  s_add_u32 s31, s31, 0x80000
  v_mfma_f32_16x16x32_bf16 v[120:123], a[184:187], a[72:75], v[120:123]
  ds_read_b64_tr_b16 a[172:173], v225 offset:24576
  v_mfma_f32_16x16x32_bf16 v[120:123], a[188:191], a[88:91], v[120:123]
  v_mfma_f32_16x16x32_bf16 v[124:127], a[188:191], a[92:95], v[124:127]
  ds_read_b64_tr_b16 a[174:175], v225 offset:25600
  v_mfma_f32_16x16x32_bf16 v[124:127], a[184:187], a[76:79], v[124:127]
  s_waitcnt lgkmcnt(4)
  v_mfma_f32_16x16x32_bf16 v[0:3], a[160:163], a[96:99], v[0:3]
  ds_read_b64_tr_b16 a[176:177], v226 offset:16384
  v_lshrrev_b32 v136, 4, v242
  v_mfma_f32_16x16x32_bf16 v[0:3], a[164:167], a[112:115], v[0:3]
  v_bfe_u32 v137, v136, 3, 2
  v_and_b32 v138, 7, v136
  v_mfma_f32_16x16x32_bf16 v[4:7], a[164:167], a[116:119], v[4:7]
  ds_read_b64_tr_b16 a[178:179], v226 offset:17408
  v_lshlrev_b32 v137, 8, v137
  v_mfma_f32_16x16x32_bf16 v[4:7], a[160:163], a[100:103], v[4:7]
  v_lshl_add_u32 v137, v138, 2, v137
  v_add_u32 v137, 158720, v137
  v_mfma_f32_16x16x32_bf16 v[8:11], a[160:163], a[104:107], v[8:11]
  ds_read_b64_tr_b16 a[180:181], v226 offset:24576
  ds_read_b32 v128, v137
  v_mfma_f32_16x16x32_bf16 v[8:11], a[164:167], a[120:123], v[8:11]
  v_mfma_f32_16x16x32_bf16 v[12:15], a[164:167], a[124:127], v[12:15]
  ds_read_b64_tr_b16 a[182:183], v226 offset:25600
  v_mfma_f32_16x16x32_bf16 v[12:15], a[160:163], a[108:111], v[12:15]
  s_waitcnt lgkmcnt(5)
  v_mfma_f32_16x16x32_bf16 v[16:19], a[168:171], a[96:99], v[16:19]
  ds_read_b64_tr_b16 a[184:185], v227 offset:16384
  v_mfma_f32_16x16x32_bf16 v[16:19], a[172:175], a[112:115], v[16:19]
  v_mfma_f32_16x16x32_bf16 v[20:23], a[172:175], a[116:119], v[20:23]
  ds_read_b64_tr_b16 a[186:187], v227 offset:17408
  v_mfma_f32_16x16x32_bf16 v[20:23], a[168:171], a[100:103], v[20:23]
  v_mfma_f32_16x16x32_bf16 v[24:27], a[168:171], a[104:107], v[24:27]
  ds_read_b64_tr_b16 a[188:189], v227 offset:24576
  s_waitcnt lgkmcnt(4)
  s_mov_b32 s51, -1
  v_sub_u32 v137, s51, v128
  v_mfma_f32_16x16x32_bf16 v[24:27], a[172:175], a[120:123], v[24:27]
  v_mfma_f32_16x16x32_bf16 v[28:31], a[172:175], a[124:127], v[28:31]
  ds_read_b64_tr_b16 a[190:191], v227 offset:25600
  v_min_u32_dpp v137, v137, v137 row_ror:8 row_mask:0xf bank_mask:0xf
  v_mfma_f32_16x16x32_bf16 v[28:31], a[168:171], a[108:111], v[28:31]
  s_waitcnt lgkmcnt(4)
  v_min_u32_dpp v137, v137, v137 row_ror:4 row_mask:0xf bank_mask:0xf
  v_mfma_f32_16x16x32_bf16 v[32:35], a[176:179], a[96:99], v[32:35]
  ds_read_b64_tr_b16 a[160:161], v228 offset:16384
  v_min_u32_dpp v137, v137, v137 row_ror:2 row_mask:0xf bank_mask:0xf
  v_mfma_f32_16x16x32_bf16 v[32:35], a[180:183], a[112:115], v[32:35]
  v_mfma_f32_16x16x32_bf16 v[36:39], a[180:183], a[116:119], v[36:39]
  ds_read_b64_tr_b16 a[162:163], v228 offset:17408
  v_min_u32_dpp v137, v137, v137 row_ror:1 row_mask:0xf bank_mask:0xf
  v_mfma_f32_16x16x32_bf16 v[36:39], a[176:179], a[100:103], v[36:39]
  v_readlane_b32 s98, v137, 0
  v_readlane_b32 s99, v137, 16
  v_mfma_f32_16x16x32_bf16 v[40:43], a[176:179], a[104:107], v[40:43]
  ds_read_b64_tr_b16 a[164:165], v228 offset:24576
  s_min_u32 s98, s98, s99
  s_sub_u32 s52, s51, s98
  s_sub_u32 s51, s52, 1
  v_sub_u32 v137, s51, v128
  v_mfma_f32_16x16x32_bf16 v[40:43], a[180:183], a[120:123], v[40:43]
  v_mfma_f32_16x16x32_bf16 v[44:47], a[180:183], a[124:127], v[44:47]
  ds_read_b64_tr_b16 a[166:167], v228 offset:25600
  v_min_u32_dpp v137, v137, v137 row_ror:8 row_mask:0xf bank_mask:0xf
  v_mfma_f32_16x16x32_bf16 v[44:47], a[176:179], a[108:111], v[44:47]
  s_waitcnt lgkmcnt(4)
  v_min_u32_dpp v137, v137, v137 row_ror:4 row_mask:0xf bank_mask:0xf
  v_mfma_f32_16x16x32_bf16 v[48:51], a[184:187], a[96:99], v[48:51]
  ds_read_b64_tr_b16 a[168:169], v229 offset:16384
  v_min_u32_dpp v137, v137, v137 row_ror:2 row_mask:0xf bank_mask:0xf
  v_mfma_f32_16x16x32_bf16 v[48:51], a[188:191], a[112:115], v[48:51]
  s_add_u32 m0, s28, 32768
  v_min_u32_dpp v137, v137, v137 row_ror:1 row_mask:0xf bank_mask:0xf
  v_mfma_f32_16x16x32_bf16 v[52:55], a[188:191], a[116:119], v[52:55]
  ds_read_b64_tr_b16 a[170:171], v229 offset:17408
  v_readlane_b32 s98, v137, 0
  v_mfma_f32_16x16x32_bf16 v[52:55], a[184:187], a[100:103], v[52:55]
  buffer_load_dwordx4 v232, s[12:15], s29 offen offset:0 lds
  v_mfma_f32_16x16x32_bf16 v[56:59], a[184:187], a[104:107], v[56:59]
  ds_read_b64_tr_b16 a[172:173], v229 offset:24576
  v_readlane_b32 s99, v137, 16
  v_mfma_f32_16x16x32_bf16 v[56:59], a[188:191], a[120:123], v[56:59]
  buffer_load_dwordx4 v233, s[12:15], s29 offen offset:1024 lds
  s_min_u32 s98, s98, s99
  s_sub_u32 s53, s51, s98
  s_sub_u32 s51, s53, 1
  v_mfma_f32_16x16x32_bf16 v[60:63], a[188:191], a[124:127], v[60:63]
  ds_read_b64_tr_b16 a[174:175], v229 offset:25600
  v_sub_u32 v137, s51, v128
  v_mfma_f32_16x16x32_bf16 v[60:63], a[184:187], a[108:111], v[60:63]
  s_waitcnt lgkmcnt(4)
  v_min_u32_dpp v137, v137, v137 row_ror:8 row_mask:0xf bank_mask:0xf
  v_mfma_f32_16x16x32_bf16 v[64:67], a[160:163], a[96:99], v[64:67]
  ds_read_b64_tr_b16 a[176:177], v230 offset:16384
  v_min_u32_dpp v137, v137, v137 row_ror:4 row_mask:0xf bank_mask:0xf
  v_mfma_f32_16x16x32_bf16 v[64:67], a[164:167], a[112:115], v[64:67]
  buffer_load_dwordx4 v234, s[12:15], s29 offen offset:2048 lds
  v_mfma_f32_16x16x32_bf16 v[68:71], a[164:167], a[116:119], v[68:71]
  ds_read_b64_tr_b16 a[178:179], v230 offset:17408
  v_min_u32_dpp v137, v137, v137 row_ror:2 row_mask:0xf bank_mask:0xf
  v_mfma_f32_16x16x32_bf16 v[68:71], a[160:163], a[100:103], v[68:71]
  buffer_load_dwordx4 v235, s[12:15], s29 offen offset:3072 lds
  v_mfma_f32_16x16x32_bf16 v[72:75], a[160:163], a[104:107], v[72:75]
  ds_read_b64_tr_b16 a[180:181], v230 offset:24576
  v_min_u32_dpp v137, v137, v137 row_ror:1 row_mask:0xf bank_mask:0xf
  v_mfma_f32_16x16x32_bf16 v[72:75], a[164:167], a[120:123], v[72:75]
  s_add_u32 s29, s29, 16384
  v_readlane_b32 s98, v137, 0
  v_readlane_b32 s99, v137, 16
  v_mfma_f32_16x16x32_bf16 v[76:79], a[164:167], a[124:127], v[76:79]
  ds_read_b64_tr_b16 a[182:183], v230 offset:25600
  s_min_u32 s98, s98, s99
  s_sub_u32 s54, s51, s98
  s_sub_u32 s51, s54, 1
  v_sub_u32 v137, s51, v128
  v_mfma_f32_16x16x32_bf16 v[76:79], a[160:163], a[108:111], v[76:79]
  s_waitcnt lgkmcnt(4)
  v_min_u32_dpp v137, v137, v137 row_ror:8 row_mask:0xf bank_mask:0xf
  v_mfma_f32_16x16x32_bf16 v[80:83], a[168:171], a[96:99], v[80:83]
  ds_read_b64_tr_b16 a[184:185], v231 offset:16384
  v_min_u32_dpp v137, v137, v137 row_ror:4 row_mask:0xf bank_mask:0xf
  v_mfma_f32_16x16x32_bf16 v[80:83], a[172:175], a[112:115], v[80:83]
  s_mov_b32 s29, 0
  v_min_u32_dpp v137, v137, v137 row_ror:2 row_mask:0xf bank_mask:0xf
  v_mfma_f32_16x16x32_bf16 v[84:87], a[172:175], a[116:119], v[84:87]
  ds_read_b64_tr_b16 a[186:187], v231 offset:17408
  v_min_u32_dpp v137, v137, v137 row_ror:1 row_mask:0xf bank_mask:0xf
  v_mfma_f32_16x16x32_bf16 v[84:87], a[168:171], a[100:103], v[84:87]
  s_waitcnt vmcnt(20)
  v_readlane_b32 s98, v137, 0
  v_readlane_b32 s99, v137, 16
  v_mfma_f32_16x16x32_bf16 v[88:91], a[168:171], a[104:107], v[88:91]
  ds_read_b64_tr_b16 a[188:189], v231 offset:24576
  s_min_u32 s98, s98, s99
  s_sub_u32 s55, s51, s98
  s_sub_u32 s51, s55, 1
  v_sub_u32 v137, s51, v128
  v_mfma_f32_16x16x32_bf16 v[88:91], a[172:175], a[120:123], v[88:91]
  s_barrier
  v_min_u32_dpp v137, v137, v137 row_ror:8 row_mask:0xf bank_mask:0xf
  v_mfma_f32_16x16x32_bf16 v[92:95], a[172:175], a[124:127], v[92:95]
  ds_read_b64_tr_b16 a[190:191], v231 offset:25600
  v_min_u32_dpp v137, v137, v137 row_ror:4 row_mask:0xf bank_mask:0xf
  v_mfma_f32_16x16x32_bf16 v[92:95], a[168:171], a[108:111], v[92:95]
  s_waitcnt lgkmcnt(4)
  s_add_u32 m0, s28, 65536
  v_min_u32_dpp v137, v137, v137 row_ror:2 row_mask:0xf bank_mask:0xf
  v_mfma_f32_16x16x32_bf16 v[96:99], a[176:179], a[96:99], v[96:99]
  ds_read_b64_tr_b16 a[160:161], v224 offset:32768
  v_min_u32_dpp v137, v137, v137 row_ror:1 row_mask:0xf bank_mask:0xf
  v_mfma_f32_16x16x32_bf16 v[96:99], a[180:183], a[112:115], v[96:99]
  buffer_load_dwordx4 v236, s[16:19], s29 offen offset:0 lds
  v_mfma_f32_16x16x32_bf16 v[100:103], a[180:183], a[116:119], v[100:103]
  ds_read_b64_tr_b16 a[162:163], v224 offset:33792
  v_readlane_b32 s98, v137, 0
  v_mfma_f32_16x16x32_bf16 v[100:103], a[176:179], a[100:103], v[100:103]
  buffer_load_dwordx4 v237, s[16:19], s29 offen offset:1024 lds
  v_mfma_f32_16x16x32_bf16 v[104:107], a[176:179], a[104:107], v[104:107]
  ds_read_b64_tr_b16 a[164:165], v224 offset:40960
  v_readlane_b32 s99, v137, 16
  v_mfma_f32_16x16x32_bf16 v[104:107], a[180:183], a[120:123], v[104:107]
  buffer_load_dwordx4 v236, s[16:19], s29 offen offset:2048 lds
  s_min_u32 s98, s98, s99
  s_sub_u32 s56, s51, s98
  s_sub_u32 s51, s56, 1
  v_mfma_f32_16x16x32_bf16 v[108:111], a[180:183], a[124:127], v[108:111]
  ds_read_b64_tr_b16 a[166:167], v224 offset:41984
  v_sub_u32 v137, s51, v128
  v_mfma_f32_16x16x32_bf16 v[108:111], a[176:179], a[108:111], v[108:111]
  s_waitcnt lgkmcnt(4)
  v_min_u32_dpp v137, v137, v137 row_ror:8 row_mask:0xf bank_mask:0xf
  v_mfma_f32_16x16x32_bf16 v[112:115], a[184:187], a[96:99], v[112:115]
  ds_read_b64_tr_b16 a[168:169], v225 offset:32768
  v_min_u32_dpp v137, v137, v137 row_ror:4 row_mask:0xf bank_mask:0xf
  v_mfma_f32_16x16x32_bf16 v[112:115], a[188:191], a[112:115], v[112:115]
  buffer_load_dwordx4 v237, s[16:19], s29 offen offset:3072 lds
  v_mfma_f32_16x16x32_bf16 v[116:119], a[188:191], a[116:119], v[116:119]
  ds_read_b64_tr_b16 a[170:171], v225 offset:33792
  v_min_u32_dpp v137, v137, v137 row_ror:2 row_mask:0xf bank_mask:0xf
  v_mfma_f32_16x16x32_bf16 v[116:119], a[184:187], a[100:103], v[116:119]
  s_add_u32 s29, s29, 16384
  v_min_u32_dpp v137, v137, v137 row_ror:1 row_mask:0xf bank_mask:0xf
  v_mfma_f32_16x16x32_bf16 v[120:123], a[184:187], a[104:107], v[120:123]
  ds_read_b64_tr_b16 a[172:173], v225 offset:40960
  v_readlane_b32 s98, v137, 0
  v_mfma_f32_16x16x32_bf16 v[120:123], a[188:191], a[120:123], v[120:123]
  v_readlane_b32 s99, v137, 16
  v_mfma_f32_16x16x32_bf16 v[124:127], a[188:191], a[124:127], v[124:127]
  ds_read_b64_tr_b16 a[174:175], v225 offset:41984
  s_min_u32 s98, s98, s99
  s_sub_u32 s57, s51, s98
  s_sub_u32 s51, s57, 1
  v_sub_u32 v137, s51, v128
  v_mfma_f32_16x16x32_bf16 v[124:127], a[184:187], a[108:111], v[124:127]
  s_waitcnt lgkmcnt(4)
  v_min_u32_dpp v137, v137, v137 row_ror:8 row_mask:0xf bank_mask:0xf
  v_mfma_f32_16x16x32_bf16 v[0:3], a[160:163], a[0:3], v[0:3]
  ds_read_b64_tr_b16 a[176:177], v226 offset:32768
  v_min_u32_dpp v137, v137, v137 row_ror:4 row_mask:0xf bank_mask:0xf
  v_mfma_f32_16x16x32_bf16 v[0:3], a[164:167], a[16:19], v[0:3]
  v_mfma_f32_16x16x32_bf16 v[4:7], a[164:167], a[20:23], v[4:7]
  ds_read_b64_tr_b16 a[178:179], v226 offset:33792
  v_min_u32_dpp v137, v137, v137 row_ror:2 row_mask:0xf bank_mask:0xf
  v_mfma_f32_16x16x32_bf16 v[4:7], a[160:163], a[4:7], v[4:7]
  v_mfma_f32_16x16x32_bf16 v[8:11], a[160:163], a[8:11], v[8:11]
  ds_read_b64_tr_b16 a[180:181], v226 offset:40960
  v_min_u32_dpp v137, v137, v137 row_ror:1 row_mask:0xf bank_mask:0xf
  v_mfma_f32_16x16x32_bf16 v[8:11], a[164:167], a[24:27], v[8:11]
  v_readlane_b32 s98, v137, 0
  v_readlane_b32 s99, v137, 16
  v_mfma_f32_16x16x32_bf16 v[12:15], a[164:167], a[28:31], v[12:15]
  ds_read_b64_tr_b16 a[182:183], v226 offset:41984
  s_min_u32 s98, s98, s99
  s_sub_u32 s58, s51, s98
  s_sub_u32 s51, s58, 1
  v_sub_u32 v137, s51, v128
  v_mfma_f32_16x16x32_bf16 v[12:15], a[160:163], a[12:15], v[12:15]
  s_waitcnt lgkmcnt(4)
  v_min_u32_dpp v137, v137, v137 row_ror:8 row_mask:0xf bank_mask:0xf
  v_mfma_f32_16x16x32_bf16 v[16:19], a[168:171], a[0:3], v[16:19]
  ds_read_b64_tr_b16 a[184:185], v227 offset:32768
  v_min_u32_dpp v137, v137, v137 row_ror:4 row_mask:0xf bank_mask:0xf
  v_mfma_f32_16x16x32_bf16 v[16:19], a[172:175], a[16:19], v[16:19]
  v_mfma_f32_16x16x32_bf16 v[20:23], a[172:175], a[20:23], v[20:23]
  ds_read_b64_tr_b16 a[186:187], v227 offset:33792
  v_min_u32_dpp v137, v137, v137 row_ror:2 row_mask:0xf bank_mask:0xf
  v_mfma_f32_16x16x32_bf16 v[20:23], a[168:171], a[4:7], v[20:23]
  v_mfma_f32_16x16x32_bf16 v[24:27], a[168:171], a[8:11], v[24:27]
  ds_read_b64_tr_b16 a[188:189], v227 offset:40960
  v_min_u32_dpp v137, v137, v137 row_ror:1 row_mask:0xf bank_mask:0xf
  v_mfma_f32_16x16x32_bf16 v[24:27], a[172:175], a[24:27], v[24:27]
  v_readlane_b32 s98, v137, 0
  v_readlane_b32 s99, v137, 16
  v_mfma_f32_16x16x32_bf16 v[28:31], a[172:175], a[28:31], v[28:31]
  ds_read_b64_tr_b16 a[190:191], v227 offset:41984
  s_min_u32 s98, s98, s99
  s_sub_u32 s59, s51, s98
  s_sub_u32 s51, s59, 1
  v_mov_b32 v128, 0
  v_mfma_f32_16x16x32_bf16 v[28:31], a[168:171], a[12:15], v[28:31]
  s_waitcnt lgkmcnt(4)
  v_writelane_b32 v128, s52, 0
  v_writelane_b32 v128, s53, 1
  v_mfma_f32_16x16x32_bf16 v[32:35], a[176:179], a[0:3], v[32:35]
  ds_read_b64_tr_b16 a[160:161], v228 offset:32768
  v_writelane_b32 v128, s54, 2
  v_mfma_f32_16x16x32_bf16 v[32:35], a[180:183], a[16:19], v[32:35]
  v_writelane_b32 v128, s55, 3
  v_writelane_b32 v128, s56, 4
  v_mfma_f32_16x16x32_bf16 v[36:39], a[180:183], a[20:23], v[36:39]
  ds_read_b64_tr_b16 a[162:163], v228 offset:33792
  v_writelane_b32 v128, s57, 5
  v_mfma_f32_16x16x32_bf16 v[36:39], a[176:179], a[4:7], v[36:39]
  v_writelane_b32 v128, s58, 6
  v_writelane_b32 v128, s59, 7
  v_mfma_f32_16x16x32_bf16 v[40:43], a[176:179], a[8:11], v[40:43]
  ds_read_b64_tr_b16 a[164:165], v228 offset:40960
  s_cmp_eq_u32 s2, 0
  s_cselect_b32 s35, 0, 1073741824
  v_lshrrev_b32 v137, 3, v136
  v_mfma_f32_16x16x32_bf16 v[40:43], a[180:183], a[24:27], v[40:43]
  v_lshlrev_b32 v137, 28, v137
  v_lshl_add_u32 v137, v136, 2, v137
  v_mfma_f32_16x16x32_bf16 v[44:47], a[180:183], a[28:31], v[44:47]
  ds_read_b64_tr_b16 a[166:167], v228 offset:41984
  v_or_b32 v137, s35, v137
  v_mfma_f32_16x16x32_bf16 v[44:47], a[176:179], a[12:15], v[44:47]
  s_waitcnt lgkmcnt(4)
  s_mov_b32 s35, 2629632
  buffer_store_dword v128, v137, s[24:27], s35 offen
  v_mfma_f32_16x16x32_bf16 v[48:51], a[184:187], a[0:3], v[48:51]
  ds_read_b64_tr_b16 a[168:169], v229 offset:32768
  v_and_b32 v129, 0xffff, v128
  v_mfma_f32_16x16x32_bf16 v[48:51], a[188:191], a[16:19], v[48:51]
  v_sub_u32 v129, 0xffff, v129
  v_and_b32 v129, 0x7ff, v129
  v_mfma_f32_16x16x32_bf16 v[52:55], a[188:191], a[20:23], v[52:55]
  ds_read_b64_tr_b16 a[170:171], v229 offset:33792
  v_mov_b32 v130, v129
  v_mfma_f32_16x16x32_bf16 v[52:55], a[184:187], a[4:7], v[52:55]
  v_mfma_f32_16x16x32_bf16 v[56:59], a[184:187], a[8:11], v[56:59]
  ds_read_b64_tr_b16 a[172:173], v229 offset:40960
  v_permlane16_swap_b32 v129, v130
  v_mfma_f32_16x16x32_bf16 v[56:59], a[188:191], a[24:27], v[56:59]
  v_mov_b32 v130, v129
  v_mfma_f32_16x16x32_bf16 v[60:63], a[188:191], a[28:31], v[60:63]
  ds_read_b64_tr_b16 a[174:175], v229 offset:41984
  v_permlane32_swap_b32 v129, v130
  v_mfma_f32_16x16x32_bf16 v[60:63], a[184:187], a[12:15], v[60:63]
  s_waitcnt lgkmcnt(4)
  v_lshrrev_b32 v130, 6, v129
  v_mul_u32_u24 v130, 0x14000, v130
  v_mfma_f32_16x16x32_bf16 v[64:67], a[160:163], a[0:3], v[64:67]
  ds_read_b64_tr_b16 a[176:177], v230 offset:32768
  v_bfe_u32 v131, v129, 4, 2
  v_mfma_f32_16x16x32_bf16 v[64:67], a[164:167], a[16:19], v[64:67]
  v_lshl_add_u32 v130, v131, 10, v130
  v_and_b32 v131, 15, v129
  v_mfma_f32_16x16x32_bf16 v[68:71], a[164:167], a[20:23], v[68:71]
  ds_read_b64_tr_b16 a[178:179], v230 offset:33792
  v_lshl_add_u32 v130, v131, 4, v130
  v_mfma_f32_16x16x32_bf16 v[68:71], a[160:163], a[4:7], v[68:71]
  v_lshrrev_b32 v131, 4, v136
  v_lshl_add_u32 v130, v131, 8, v130
  v_mfma_f32_16x16x32_bf16 v[72:75], a[160:163], a[8:11], v[72:75]
  ds_read_b64_tr_b16 a[180:181], v230 offset:40960
  s_mul_i32 s35, s3, 20480
  buffer_load_dwordx4 a[212:215], v130, s[24:27], s35 offen
  s_add_u32 s35, s35, 4096
  v_mfma_f32_16x16x32_bf16 v[72:75], a[164:167], a[24:27], v[72:75]
  buffer_load_dwordx4 a[216:219], v130, s[24:27], s35 offen
  s_add_u32 s35, s35, 4096
  v_mfma_f32_16x16x32_bf16 v[76:79], a[164:167], a[28:31], v[76:79]
  ds_read_b64_tr_b16 a[182:183], v230 offset:41984
  buffer_load_dwordx4 a[220:223], v130, s[24:27], s35 offen
  s_add_u32 s35, s35, 4096
  v_mfma_f32_16x16x32_bf16 v[76:79], a[160:163], a[12:15], v[76:79]
  s_waitcnt lgkmcnt(4)
  buffer_load_dwordx4 a[224:227], v130, s[24:27], s35 offen
  s_add_u32 s35, s35, 4096
  v_mfma_f32_16x16x32_bf16 v[80:83], a[168:171], a[0:3], v[80:83]
  ds_read_b64_tr_b16 a[184:185], v231 offset:32768
  buffer_load_dwordx4 a[228:231], v130, s[24:27], s35 offen
  s_add_u32 s35, s35, 4096
  v_mfma_f32_16x16x32_bf16 v[80:83], a[172:175], a[16:19], v[80:83]
  v_mfma_f32_16x16x32_bf16 v[84:87], a[172:175], a[20:23], v[84:87]
  ds_read_b64_tr_b16 a[186:187], v231 offset:33792
  v_mfma_f32_16x16x32_bf16 v[84:87], a[168:171], a[4:7], v[84:87]
  s_waitcnt vmcnt(14)
  v_mfma_f32_16x16x32_bf16 v[88:91], a[168:171], a[8:11], v[88:91]
  ds_read_b64_tr_b16 a[188:189], v231 offset:40960
  v_mfma_f32_16x16x32_bf16 v[88:91], a[172:175], a[24:27], v[88:91]
  s_barrier
  v_mfma_f32_16x16x32_bf16 v[92:95], a[172:175], a[28:31], v[92:95]
  ds_read_b64_tr_b16 a[190:191], v231 offset:41984
  v_mfma_f32_16x16x32_bf16 v[92:95], a[168:171], a[12:15], v[92:95]
  s_waitcnt lgkmcnt(4)
  s_add_u32 m0, s28, 81920
  v_mfma_f32_16x16x32_bf16 v[96:99], a[176:179], a[0:3], v[96:99]
  ds_read_b64_tr_b16 a[160:161], v224 offset:49152
  v_mfma_f32_16x16x32_bf16 v[96:99], a[180:183], a[16:19], v[96:99]
  buffer_load_dwordx4 v236, s[16:19], s29 offen offset:0 lds
  v_mfma_f32_16x16x32_bf16 v[100:103], a[180:183], a[20:23], v[100:103]
  ds_read_b64_tr_b16 a[162:163], v224 offset:50176
  v_mfma_f32_16x16x32_bf16 v[100:103], a[176:179], a[4:7], v[100:103]
  buffer_load_dwordx4 v237, s[16:19], s29 offen offset:1024 lds
  v_mfma_f32_16x16x32_bf16 v[104:107], a[176:179], a[8:11], v[104:107]
  ds_read_b64_tr_b16 a[164:165], v224 offset:57344
  v_mfma_f32_16x16x32_bf16 v[104:107], a[180:183], a[24:27], v[104:107]
  buffer_load_dwordx4 v236, s[16:19], s29 offen offset:2048 lds
  v_mfma_f32_16x16x32_bf16 v[108:111], a[180:183], a[28:31], v[108:111]
  ds_read_b64_tr_b16 a[166:167], v224 offset:58368
  v_mfma_f32_16x16x32_bf16 v[108:111], a[176:179], a[12:15], v[108:111]
  s_waitcnt lgkmcnt(4)
  v_mfma_f32_16x16x32_bf16 v[112:115], a[184:187], a[0:3], v[112:115]
  ds_read_b64_tr_b16 a[168:169], v225 offset:49152
  v_mfma_f32_16x16x32_bf16 v[112:115], a[188:191], a[16:19], v[112:115]
  buffer_load_dwordx4 v237, s[16:19], s29 offen offset:3072 lds
  v_mfma_f32_16x16x32_bf16 v[116:119], a[188:191], a[20:23], v[116:119]
  ds_read_b64_tr_b16 a[170:171], v225 offset:50176
  v_mfma_f32_16x16x32_bf16 v[116:119], a[184:187], a[4:7], v[116:119]
  s_add_u32 s29, s29, 16384
  v_mfma_f32_16x16x32_bf16 v[120:123], a[184:187], a[8:11], v[120:123]
  ds_read_b64_tr_b16 a[172:173], v225 offset:57344
  v_mfma_f32_16x16x32_bf16 v[120:123], a[188:191], a[24:27], v[120:123]
  v_mfma_f32_16x16x32_bf16 v[124:127], a[188:191], a[28:31], v[124:127]
  ds_read_b64_tr_b16 a[174:175], v225 offset:58368
  v_mfma_f32_16x16x32_bf16 v[124:127], a[184:187], a[12:15], v[124:127]
  s_waitcnt lgkmcnt(4)
  v_mfma_f32_16x16x32_bf16 v[0:3], a[160:163], a[32:35], v[0:3]
  ds_read_b64_tr_b16 a[176:177], v226 offset:49152
  v_mfma_f32_16x16x32_bf16 v[0:3], a[164:167], a[48:51], v[0:3]
  v_mfma_f32_16x16x32_bf16 v[4:7], a[164:167], a[52:55], v[4:7]
  ds_read_b64_tr_b16 a[178:179], v226 offset:50176
  v_mfma_f32_16x16x32_bf16 v[4:7], a[160:163], a[36:39], v[4:7]
  v_mfma_f32_16x16x32_bf16 v[8:11], a[160:163], a[40:43], v[8:11]
  ds_read_b64_tr_b16 a[180:181], v226 offset:57344
  v_mfma_f32_16x16x32_bf16 v[8:11], a[164:167], a[56:59], v[8:11]
  v_mfma_f32_16x16x32_bf16 v[12:15], a[164:167], a[60:63], v[12:15]
  ds_read_b64_tr_b16 a[182:183], v226 offset:58368
  v_mfma_f32_16x16x32_bf16 v[12:15], a[160:163], a[44:47], v[12:15]
  s_waitcnt lgkmcnt(4)
  v_mfma_f32_16x16x32_bf16 v[16:19], a[168:171], a[32:35], v[16:19]
  ds_read_b64_tr_b16 a[184:185], v227 offset:49152
  v_mfma_f32_16x16x32_bf16 v[16:19], a[172:175], a[48:51], v[16:19]
  v_mfma_f32_16x16x32_bf16 v[20:23], a[172:175], a[52:55], v[20:23]
  ds_read_b64_tr_b16 a[186:187], v227 offset:50176
  v_mfma_f32_16x16x32_bf16 v[20:23], a[168:171], a[36:39], v[20:23]
  v_mfma_f32_16x16x32_bf16 v[24:27], a[168:171], a[40:43], v[24:27]
  ds_read_b64_tr_b16 a[188:189], v227 offset:57344
  v_mfma_f32_16x16x32_bf16 v[24:27], a[172:175], a[56:59], v[24:27]
  v_mul_f32 v0, s34, v0
  v_mul_f32 v1, s34, v1
  v_mfma_f32_16x16x32_bf16 v[28:31], a[172:175], a[60:63], v[28:31]
  ds_read_b64_tr_b16 a[190:191], v227 offset:58368
  v_mul_f32 v2, s34, v2
  v_mfma_f32_16x16x32_bf16 v[28:31], a[168:171], a[44:47], v[28:31]
  s_waitcnt lgkmcnt(4)
  v_mul_f32 v3, s34, v3
  v_mul_f32 v16, s34, v16
  v_mfma_f32_16x16x32_bf16 v[32:35], a[176:179], a[32:35], v[32:35]
  ds_read_b64_tr_b16 a[160:161], v228 offset:49152
  v_mul_f32 v17, s34, v17
  v_mfma_f32_16x16x32_bf16 v[32:35], a[180:183], a[48:51], v[32:35]
  v_mul_f32 v18, s34, v18
  v_mul_f32 v19, s34, v19
  v_mfma_f32_16x16x32_bf16 v[36:39], a[180:183], a[52:55], v[36:39]
  ds_read_b64_tr_b16 a[162:163], v228 offset:50176
  v_cvt_pk_bf16_f32 v128, v0, v1
  v_mfma_f32_16x16x32_bf16 v[36:39], a[176:179], a[36:39], v[36:39]
  v_cvt_pk_bf16_f32 v129, v2, v3
  v_cvt_pk_bf16_f32 v130, v16, v17
  v_mfma_f32_16x16x32_bf16 v[40:43], a[176:179], a[40:43], v[40:43]
  ds_read_b64_tr_b16 a[164:165], v228 offset:57344
  v_cvt_pk_bf16_f32 v131, v18, v19
  v_mfma_f32_16x16x32_bf16 v[40:43], a[180:183], a[56:59], v[40:43]
  v_mul_f32 v4, s34, v4
  v_mul_f32 v5, s34, v5
  v_mfma_f32_16x16x32_bf16 v[44:47], a[180:183], a[60:63], v[44:47]
  ds_read_b64_tr_b16 a[166:167], v228 offset:58368
  v_mul_f32 v6, s34, v6
  v_mfma_f32_16x16x32_bf16 v[44:47], a[176:179], a[44:47], v[44:47]
  s_waitcnt lgkmcnt(4)
  v_mul_f32 v7, s34, v7
  v_mul_f32 v20, s34, v20
  v_mfma_f32_16x16x32_bf16 v[48:51], a[184:187], a[32:35], v[48:51]
  ds_read_b64_tr_b16 a[168:169], v229 offset:49152
  v_mul_f32 v21, s34, v21
  v_mfma_f32_16x16x32_bf16 v[48:51], a[188:191], a[48:51], v[48:51]
  v_mul_f32 v22, s34, v22
  v_mul_f32 v23, s34, v23
  v_mfma_f32_16x16x32_bf16 v[52:55], a[188:191], a[52:55], v[52:55]
  ds_read_b64_tr_b16 a[170:171], v229 offset:50176
  v_cvt_pk_bf16_f32 v144, v4, v5
  v_mfma_f32_16x16x32_bf16 v[52:55], a[184:187], a[36:39], v[52:55]
  v_cvt_pk_bf16_f32 v145, v6, v7
  v_cvt_pk_bf16_f32 v146, v20, v21
  v_mfma_f32_16x16x32_bf16 v[56:59], a[184:187], a[40:43], v[56:59]
  ds_read_b64_tr_b16 a[172:173], v229 offset:57344
  v_cvt_pk_bf16_f32 v147, v22, v23
  v_mfma_f32_16x16x32_bf16 v[56:59], a[188:191], a[56:59], v[56:59]
  v_permlane16_swap_b32 v128, v130
  v_permlane16_swap_b32 v129, v131
  v_mfma_f32_16x16x32_bf16 v[60:63], a[188:191], a[60:63], v[60:63]
  ds_read_b64_tr_b16 a[174:175], v229 offset:58368
  v_mul_f32 v8, s34, v8
  v_mfma_f32_16x16x32_bf16 v[60:63], a[184:187], a[44:47], v[60:63]
  s_waitcnt lgkmcnt(4)
  v_mul_f32 v9, s34, v9
  v_mul_f32 v10, s34, v10
  v_mfma_f32_16x16x32_bf16 v[64:67], a[160:163], a[32:35], v[64:67]
  ds_read_b64_tr_b16 a[176:177], v230 offset:49152
  v_mul_f32 v11, s34, v11
  v_mfma_f32_16x16x32_bf16 v[64:67], a[164:167], a[48:51], v[64:67]
  v_mul_f32 v24, s34, v24
  v_mul_f32 v25, s34, v25
  v_mfma_f32_16x16x32_bf16 v[68:71], a[164:167], a[52:55], v[68:71]
  ds_read_b64_tr_b16 a[178:179], v230 offset:50176
  v_mul_f32 v26, s34, v26
  v_mfma_f32_16x16x32_bf16 v[68:71], a[160:163], a[36:39], v[68:71]
  v_mul_f32 v27, s34, v27
  v_cvt_pk_bf16_f32 v160, v8, v9
  v_mfma_f32_16x16x32_bf16 v[72:75], a[160:163], a[40:43], v[72:75]
  ds_read_b64_tr_b16 a[180:181], v230 offset:57344
  v_cvt_pk_bf16_f32 v161, v10, v11
  v_mfma_f32_16x16x32_bf16 v[72:75], a[164:167], a[56:59], v[72:75]
  v_cvt_pk_bf16_f32 v162, v24, v25
  v_cvt_pk_bf16_f32 v163, v26, v27
  v_mfma_f32_16x16x32_bf16 v[76:79], a[164:167], a[60:63], v[76:79]
  ds_read_b64_tr_b16 a[182:183], v230 offset:58368
  v_permlane16_swap_b32 v144, v146
  v_mfma_f32_16x16x32_bf16 v[76:79], a[160:163], a[44:47], v[76:79]
  s_waitcnt lgkmcnt(4)
  v_permlane16_swap_b32 v145, v147
  v_mul_f32 v12, s34, v12
  v_mfma_f32_16x16x32_bf16 v[80:83], a[168:171], a[32:35], v[80:83]
  ds_read_b64_tr_b16 a[184:185], v231 offset:49152
  v_mul_f32 v13, s34, v13
  v_mfma_f32_16x16x32_bf16 v[80:83], a[172:175], a[48:51], v[80:83]
  v_mul_f32 v14, s34, v14
  v_mul_f32 v15, s34, v15
  v_mfma_f32_16x16x32_bf16 v[84:87], a[172:175], a[52:55], v[84:87]
  ds_read_b64_tr_b16 a[186:187], v231 offset:50176
  v_mul_f32 v28, s34, v28
  v_mfma_f32_16x16x32_bf16 v[84:87], a[168:171], a[36:39], v[84:87]
  v_mul_f32 v29, s34, v29
  v_mul_f32 v30, s34, v30
  v_mfma_f32_16x16x32_bf16 v[88:91], a[168:171], a[40:43], v[88:91]
  ds_read_b64_tr_b16 a[188:189], v231 offset:57344
  v_mul_f32 v31, s34, v31
  v_mfma_f32_16x16x32_bf16 v[88:91], a[172:175], a[56:59], v[88:91]
  s_barrier
  v_cvt_pk_bf16_f32 v176, v12, v13
  v_cvt_pk_bf16_f32 v177, v14, v15
  v_mfma_f32_16x16x32_bf16 v[92:95], a[172:175], a[60:63], v[92:95]
  ds_read_b64_tr_b16 a[190:191], v231 offset:58368
  v_cvt_pk_bf16_f32 v178, v28, v29
  v_mfma_f32_16x16x32_bf16 v[92:95], a[168:171], a[44:47], v[92:95]
  s_waitcnt lgkmcnt(4)
  v_cvt_pk_bf16_f32 v179, v30, v31
  v_permlane16_swap_b32 v160, v162
  v_mfma_f32_16x16x32_bf16 v[96:99], a[176:179], a[32:35], v[96:99]
  ds_read_b128 a[128:131], v212 offset:0
  v_permlane16_swap_b32 v161, v163
  v_mfma_f32_16x16x32_bf16 v[96:99], a[180:183], a[48:51], v[96:99]
  v_mul_f32 v32, s34, v32
  v_mul_f32 v33, s34, v33
  v_mfma_f32_16x16x32_bf16 v[100:103], a[180:183], a[52:55], v[100:103]
  ds_read_b128 a[132:135], v213 offset:0
  v_mul_f32 v34, s34, v34
  v_mfma_f32_16x16x32_bf16 v[100:103], a[176:179], a[36:39], v[100:103]
  v_mul_f32 v35, s34, v35
  v_mul_f32 v48, s34, v48
  v_mfma_f32_16x16x32_bf16 v[104:107], a[176:179], a[40:43], v[104:107]
  ds_read_b128 a[136:139], v214 offset:0
  v_mul_f32 v49, s34, v49
  v_mfma_f32_16x16x32_bf16 v[104:107], a[180:183], a[56:59], v[104:107]
  v_mul_f32 v50, s34, v50
  v_mul_f32 v51, s34, v51
  v_mfma_f32_16x16x32_bf16 v[108:111], a[180:183], a[60:63], v[108:111]
  ds_read_b128 a[140:143], v215 offset:0
  v_cvt_pk_bf16_f32 v132, v32, v33
  v_mfma_f32_16x16x32_bf16 v[108:111], a[176:179], a[44:47], v[108:111]
  s_waitcnt lgkmcnt(4)
  v_cvt_pk_bf16_f32 v133, v34, v35
  v_cvt_pk_bf16_f32 v134, v48, v49
  v_mfma_f32_16x16x32_bf16 v[112:115], a[184:187], a[32:35], v[112:115]
  v_cvt_pk_bf16_f32 v135, v50, v51
  v_permlane16_swap_b32 v176, v178
  v_mfma_f32_16x16x32_bf16 v[112:115], a[188:191], a[48:51], v[112:115]
  v_permlane16_swap_b32 v177, v179
  v_mul_f32 v36, s34, v36
  v_mfma_f32_16x16x32_bf16 v[116:119], a[188:191], a[52:55], v[116:119]
  v_mul_f32 v37, s34, v37
  v_mul_f32 v38, s34, v38
  v_mfma_f32_16x16x32_bf16 v[116:119], a[184:187], a[36:39], v[116:119]
  v_mul_f32 v39, s34, v39
  v_mul_f32 v52, s34, v52
  v_mfma_f32_16x16x32_bf16 v[120:123], a[184:187], a[40:43], v[120:123]
  v_mul_f32 v53, s34, v53
  v_mul_f32 v54, s34, v54
  v_mfma_f32_16x16x32_bf16 v[120:123], a[188:191], a[56:59], v[120:123]
  v_mul_f32 v55, s34, v55
  v_cvt_pk_bf16_f32 v148, v36, v37
  v_mfma_f32_16x16x32_bf16 v[124:127], a[188:191], a[60:63], v[124:127]
  v_cvt_pk_bf16_f32 v149, v38, v39
  v_cvt_pk_bf16_f32 v150, v52, v53
  v_mfma_f32_16x16x32_bf16 v[124:127], a[184:187], a[44:47], v[124:127]
  s_waitcnt lgkmcnt(0)
  v_cvt_pk_bf16_f32 v151, v54, v55
  v_permlane16_swap_b32 v132, v134
  v_permlane16_swap_b32 v133, v135
  v_mul_f32 v40, s34, v40
  v_mul_f32 v41, s34, v41
  v_mul_f32 v42, s34, v42
  v_mul_f32 v43, s34, v43
  v_mul_f32 v56, s34, v56
  v_mul_f32 v57, s34, v57
  v_mul_f32 v58, s34, v58
  v_mul_f32 v59, s34, v59
  v_cvt_pk_bf16_f32 v164, v40, v41
  v_cvt_pk_bf16_f32 v165, v42, v43
  v_cvt_pk_bf16_f32 v166, v56, v57
  v_cvt_pk_bf16_f32 v167, v58, v59
  v_permlane16_swap_b32 v148, v150
  v_permlane16_swap_b32 v149, v151
  v_mul_f32 v44, s34, v44
  v_mul_f32 v45, s34, v45
  v_mul_f32 v46, s34, v46
  v_mul_f32 v47, s34, v47
  v_mul_f32 v60, s34, v60
  v_mul_f32 v61, s34, v61
  v_mul_f32 v62, s34, v62
  v_mul_f32 v63, s34, v63
  v_cvt_pk_bf16_f32 v180, v44, v45
  v_cvt_pk_bf16_f32 v181, v46, v47
  v_cvt_pk_bf16_f32 v182, v60, v61
  v_cvt_pk_bf16_f32 v183, v62, v63
  v_permlane16_swap_b32 v164, v166
  v_permlane16_swap_b32 v165, v167
  v_mul_f32 v64, s34, v64
  v_mul_f32 v65, s34, v65
  v_mul_f32 v66, s34, v66
  v_mul_f32 v67, s34, v67
  v_mul_f32 v80, s34, v80
  v_mul_f32 v81, s34, v81
  v_mul_f32 v82, s34, v82
  v_mul_f32 v83, s34, v83
  v_cvt_pk_bf16_f32 v136, v64, v65
  v_cvt_pk_bf16_f32 v137, v66, v67
  v_cvt_pk_bf16_f32 v138, v80, v81
  v_cvt_pk_bf16_f32 v139, v82, v83
  v_permlane16_swap_b32 v180, v182
  v_permlane16_swap_b32 v181, v183
  v_mul_f32 v68, s34, v68
  v_mul_f32 v69, s34, v69
  v_mul_f32 v70, s34, v70
  v_mul_f32 v71, s34, v71
  v_mul_f32 v84, s34, v84
  v_mul_f32 v85, s34, v85
  v_mul_f32 v86, s34, v86
  v_mul_f32 v87, s34, v87
  v_cvt_pk_bf16_f32 v152, v68, v69
  v_cvt_pk_bf16_f32 v153, v70, v71
  v_cvt_pk_bf16_f32 v154, v84, v85
  v_cvt_pk_bf16_f32 v155, v86, v87
  v_permlane16_swap_b32 v136, v138
  v_permlane16_swap_b32 v137, v139
  v_mul_f32 v72, s34, v72
  v_mul_f32 v73, s34, v73
  v_mul_f32 v74, s34, v74
  v_mul_f32 v75, s34, v75
  v_mul_f32 v88, s34, v88
  v_mul_f32 v89, s34, v89
  v_mul_f32 v90, s34, v90
  v_mul_f32 v91, s34, v91
  v_cvt_pk_bf16_f32 v168, v72, v73
  v_cvt_pk_bf16_f32 v169, v74, v75
  v_cvt_pk_bf16_f32 v170, v88, v89
  v_cvt_pk_bf16_f32 v171, v90, v91
  v_permlane16_swap_b32 v152, v154
  v_permlane16_swap_b32 v153, v155
  v_mul_f32 v76, s34, v76
  v_mul_f32 v77, s34, v77
  v_mul_f32 v78, s34, v78
  v_mul_f32 v79, s34, v79
  v_mul_f32 v92, s34, v92
  v_mul_f32 v93, s34, v93
  v_mul_f32 v94, s34, v94
  v_mul_f32 v95, s34, v95
  v_cvt_pk_bf16_f32 v184, v76, v77
  v_cvt_pk_bf16_f32 v185, v78, v79
  v_cvt_pk_bf16_f32 v186, v92, v93
  v_cvt_pk_bf16_f32 v187, v94, v95
  v_permlane16_swap_b32 v168, v170
  v_permlane16_swap_b32 v169, v171
  v_mul_f32 v96, s34, v96
  v_mul_f32 v97, s34, v97
  v_mul_f32 v98, s34, v98
  v_mul_f32 v99, s34, v99
  v_mul_f32 v112, s34, v112
  v_mul_f32 v113, s34, v113
  v_mul_f32 v114, s34, v114
  v_mul_f32 v115, s34, v115
  v_cvt_pk_bf16_f32 v140, v96, v97
  v_cvt_pk_bf16_f32 v141, v98, v99
  v_cvt_pk_bf16_f32 v142, v112, v113
  v_cvt_pk_bf16_f32 v143, v114, v115
  v_permlane16_swap_b32 v184, v186
  v_permlane16_swap_b32 v185, v187
  v_mul_f32 v100, s34, v100
  v_mul_f32 v101, s34, v101
  v_mul_f32 v102, s34, v102
  v_mul_f32 v103, s34, v103
  v_mul_f32 v116, s34, v116
  v_mul_f32 v117, s34, v117
  v_mul_f32 v118, s34, v118
  v_mul_f32 v119, s34, v119
  v_cvt_pk_bf16_f32 v156, v100, v101
  v_cvt_pk_bf16_f32 v157, v102, v103
  v_cvt_pk_bf16_f32 v158, v116, v117
  v_cvt_pk_bf16_f32 v159, v118, v119
  v_permlane16_swap_b32 v140, v142
  v_permlane16_swap_b32 v141, v143
  v_mul_f32 v104, s34, v104
  v_mul_f32 v105, s34, v105
  v_mul_f32 v106, s34, v106
  v_mul_f32 v107, s34, v107
  v_mul_f32 v120, s34, v120
  v_mul_f32 v121, s34, v121
  v_mul_f32 v122, s34, v122
  v_mul_f32 v123, s34, v123
  v_cvt_pk_bf16_f32 v172, v104, v105
  v_cvt_pk_bf16_f32 v173, v106, v107
  v_cvt_pk_bf16_f32 v174, v120, v121
  v_cvt_pk_bf16_f32 v175, v122, v123
  v_permlane16_swap_b32 v156, v158
  v_permlane16_swap_b32 v157, v159
  v_mul_f32 v108, s34, v108
  v_mul_f32 v109, s34, v109
  v_mul_f32 v110, s34, v110
  v_mul_f32 v111, s34, v111
  v_mul_f32 v124, s34, v124
  v_mul_f32 v125, s34, v125
  v_mul_f32 v126, s34, v126
  v_mul_f32 v127, s34, v127
  v_cvt_pk_bf16_f32 v188, v108, v109
  v_cvt_pk_bf16_f32 v189, v110, v111
  v_cvt_pk_bf16_f32 v190, v124, v125
  v_cvt_pk_bf16_f32 v191, v126, v127
  v_permlane16_swap_b32 v172, v174
  v_permlane16_swap_b32 v173, v175
  v_permlane16_swap_b32 v188, v190
  v_permlane16_swap_b32 v189, v191
  v_mfma_f32_16x16x32_bf16 v[0:3], a[128:131], v[128:131], 0
  ds_read_b128 a[144:147], v212 offset:4096
  s_mov_b32 s20, s90
  s_mov_b32 s21, s91
  s_mov_b32 s22, 2211840
  s_mov_b32 s23, 0x20000
  s_mov_b32 s44, s92
  s_mov_b32 s45, s93
  s_mov_b32 s46, 2211840
  s_mov_b32 s47, 0x20000
  v_lshrrev_b32 v226, 4, v242
  v_mfma_f32_16x16x32_bf16 v[0:3], a[132:135], v[132:135], v[0:3]
  v_mul_u32_u24 v226, 0xd80, v226
  v_mfma_f32_16x16x32_bf16 v[0:3], a[136:139], v[136:139], v[0:3]
  ds_read_b128 a[148:151], v213 offset:4096
  s_mul_i32 s35, s3, 552960
  s_lshl_b32 s38, s33, 4
  s_add_u32 s35, s35, s38
  s_add_u32 m0, s50, 0
  v_mfma_f32_16x16x32_bf16 v[0:3], a[140:143], v[140:143], v[0:3]
  buffer_load_dwordx4 v226, s[20:23], s35 offen lds
  v_mfma_f32_16x16x32_bf16 v[8:11], a[140:143], v[156:159], 0
  ds_read_b128 a[152:155], v214 offset:4096
  v_mfma_f32_16x16x32_bf16 v[8:11], a[136:139], v[152:155], v[8:11]
  v_mfma_f32_16x16x32_bf16 v[8:11], a[132:135], v[148:151], v[8:11]
  ds_read_b128 a[156:159], v215 offset:4096
  v_mfma_f32_16x16x32_bf16 v[8:11], a[128:131], v[144:147], v[8:11]
  v_mfma_f32_16x16x32_bf16 v[16:19], a[128:131], v[160:163], 0
  v_mfma_f32_16x16x32_bf16 v[16:19], a[132:135], v[164:167], v[16:19]
  v_mfma_f32_16x16x32_bf16 v[16:19], a[136:139], v[168:171], v[16:19]
  v_mfma_f32_16x16x32_bf16 v[16:19], a[140:143], v[172:175], v[16:19]
  v_max3_f32 v192, v0, v1, v2
  s_nop 2
  v_max3_f32 v196, v8, v9, v10
  v_mfma_f32_16x16x32_bf16 v[24:27], a[140:143], v[188:191], 0
  v_max_f32 v192, v192, v3
  v_max_f32 v196, v196, v11
  v_mfma_f32_16x16x32_bf16 v[24:27], a[136:139], v[184:187], v[24:27]
  v_mov_b32 v245, v192
  v_mov_b32 v246, v196
  v_mfma_f32_16x16x32_bf16 v[24:27], a[132:135], v[180:183], v[24:27]
  v_permlane16_swap_b32 v192, v245
  v_permlane16_swap_b32 v196, v246
  v_mfma_f32_16x16x32_bf16 v[24:27], a[128:131], v[176:179], v[24:27]
  s_waitcnt lgkmcnt(0)
  v_max_f32 v192, v192, v245
  v_max_f32 v196, v196, v246
  v_mfma_f32_16x16x32_bf16 v[4:7], a[144:147], v[128:131], 0
  ds_read_b128 a[128:131], v212 offset:8192
  v_mov_b32 v245, v192
  v_mfma_f32_16x16x32_bf16 v[4:7], a[148:151], v[132:135], v[4:7]
  v_mov_b32 v246, v196
  v_permlane32_swap_b32 v192, v245
  v_mfma_f32_16x16x32_bf16 v[4:7], a[152:155], v[136:139], v[4:7]
  ds_read_b128 a[132:135], v213 offset:8192
  v_permlane32_swap_b32 v196, v246
  v_mfma_f32_16x16x32_bf16 v[4:7], a[156:159], v[140:143], v[4:7]
  v_max_f32 v192, v192, v245
  v_max_f32 v196, v196, v246
  v_mfma_f32_16x16x32_bf16 v[12:15], a[156:159], v[156:159], 0
  ds_read_b128 a[136:139], v214 offset:8192
  v_sub_f32 v193, 0, v192
  v_mfma_f32_16x16x32_bf16 v[12:15], a[152:155], v[152:155], v[12:15]
  v_sub_f32 v197, 0, v196
  v_sub_f32 v194, 0, v192
  v_mfma_f32_16x16x32_bf16 v[12:15], a[148:151], v[148:151], v[12:15]
  ds_read_b128 a[140:143], v215 offset:8192
  v_sub_f32 v198, 0, v196
  v_mfma_f32_16x16x32_bf16 v[12:15], a[144:147], v[144:147], v[12:15]
  v_sub_f32 v195, 0, v192
  v_sub_f32 v199, 0, v196
  v_mfma_f32_16x16x32_bf16 v[20:23], a[144:147], v[160:163], 0
  v_sub_f32 v192, 0, v192
  v_sub_f32 v196, 0, v196
  v_mfma_f32_16x16x32_bf16 v[20:23], a[148:151], v[164:167], v[20:23]
  v_max3_f32 v200, v16, v17, v18
  v_max3_f32 v204, v24, v25, v26
  v_mfma_f32_16x16x32_bf16 v[20:23], a[152:155], v[168:171], v[20:23]
  v_max_f32 v200, v200, v19
  v_max_f32 v204, v204, v27
  v_mfma_f32_16x16x32_bf16 v[20:23], a[156:159], v[172:175], v[20:23]
  v_mov_b32 v247, v200
  v_mov_b32 v248, v204
  v_mfma_f32_16x16x32_bf16 v[28:31], a[156:159], v[188:191], 0
  v_permlane16_swap_b32 v200, v247
  v_permlane16_swap_b32 v204, v248
  v_mfma_f32_16x16x32_bf16 v[28:31], a[152:155], v[184:187], v[28:31]
  v_max_f32 v200, v200, v247
  v_max_f32 v204, v204, v248
  v_mfma_f32_16x16x32_bf16 v[28:31], a[148:151], v[180:183], v[28:31]
  v_mov_b32 v247, v200
  v_mov_b32 v248, v204
  s_nop 0
  v_permlane32_swap_b32 v200, v247
  v_permlane32_swap_b32 v204, v248
  v_max_f32 v200, v200, v247
  v_max_f32 v204, v204, v248
  v_sub_f32 v201, 0, v200
  v_sub_f32 v205, 0, v204
  v_sub_f32 v202, 0, v200
  v_sub_f32 v206, 0, v204
  v_sub_f32 v203, 0, v200
  v_sub_f32 v207, 0, v204
  v_sub_f32 v200, 0, v200
  v_sub_f32 v204, 0, v204
  v_mfma_f32_16x16x32_bf16 v[28:31], a[144:147], v[176:179], v[28:31]
  s_waitcnt lgkmcnt(0)
  v_add_f32 v0, v192, v0
  v_add_f32 v1, v192, v1
  v_mfma_f32_16x16x32_bf16 v[32:35], a[128:131], v[128:131], v[192:195]
  ds_read_b128 a[144:147], v212 offset:12288
  v_add_f32 v2, v192, v2
  v_mfma_f32_16x16x32_bf16 v[32:35], a[132:135], v[132:135], v[32:35]
  v_add_f32 v3, v192, v3
  v_mfma_f32_16x16x32_bf16 v[32:35], a[136:139], v[136:139], v[32:35]
  ds_read_b128 a[148:151], v213 offset:12288
  v_mfma_f32_16x16x32_bf16 v[32:35], a[140:143], v[140:143], v[32:35]
  v_exp_f32 v0, v0
  v_mfma_f32_16x16x32_bf16 v[40:43], a[140:143], v[156:159], v[196:199]
  ds_read_b128 a[152:155], v214 offset:12288
  v_mfma_f32_16x16x32_bf16 v[40:43], a[136:139], v[152:155], v[40:43]
  v_exp_f32 v1, v1
  v_mfma_f32_16x16x32_bf16 v[40:43], a[132:135], v[148:151], v[40:43]
  ds_read_b128 a[156:159], v215 offset:12288
  v_mfma_f32_16x16x32_bf16 v[40:43], a[128:131], v[144:147], v[40:43]
  v_exp_f32 v2, v2
  v_mfma_f32_16x16x32_bf16 v[48:51], a[128:131], v[160:163], v[200:203]
  v_cvt_pk_bf16_f32 v0, v0, v1
  v_mfma_f32_16x16x32_bf16 v[48:51], a[132:135], v[164:167], v[48:51]
  v_exp_f32 v3, v3
  v_mfma_f32_16x16x32_bf16 v[48:51], a[136:139], v[168:171], v[48:51]
  v_add_f32 v8, v196, v8
  v_add_f32 v9, v196, v9
  v_mfma_f32_16x16x32_bf16 v[48:51], a[140:143], v[172:175], v[48:51]
  v_add_f32 v10, v196, v10
  v_add_f32 v11, v196, v11
  v_mfma_f32_16x16x32_bf16 v[56:59], a[140:143], v[188:191], v[204:207]
  v_exp_f32 v8, v8
  v_mfma_f32_16x16x32_bf16 v[56:59], a[136:139], v[184:187], v[56:59]
  v_exp_f32 v9, v9
  v_mfma_f32_16x16x32_bf16 v[56:59], a[132:135], v[180:183], v[56:59]
  v_exp_f32 v10, v10
  v_mfma_f32_16x16x32_bf16 v[56:59], a[128:131], v[176:179], v[56:59]
  s_waitcnt lgkmcnt(0)
  v_cvt_pk_bf16_f32 v8, v8, v9
  v_mfma_f32_16x16x32_bf16 v[36:39], a[144:147], v[128:131], v[192:195]
  s_waitcnt vmcnt(11)
  v_exp_f32 v11, v11
  v_mfma_f32_16x16x32_bf16 v[36:39], a[148:151], v[132:135], v[36:39]
  s_barrier
  v_cvt_pk_bf16_f32 v1, v2, v3
  v_add_f32 v16, v200, v16
  v_mfma_f32_16x16x32_bf16 v[36:39], a[152:155], v[136:139], v[36:39]
  ds_read_b128 a[128:131], v212 offset:16384
  v_add_f32 v17, v200, v17
  v_mfma_f32_16x16x32_bf16 v[36:39], a[156:159], v[140:143], v[36:39]
  v_add_f32 v18, v200, v18
  v_add_f32 v19, v200, v19
  v_mfma_f32_16x16x32_bf16 v[44:47], a[156:159], v[156:159], v[196:199]
  ds_read_b128 a[132:135], v213 offset:16384
  v_mfma_f32_16x16x32_bf16 v[44:47], a[152:155], v[152:155], v[44:47]
  v_exp_f32 v16, v16
  v_mfma_f32_16x16x32_bf16 v[44:47], a[148:151], v[148:151], v[44:47]
  ds_read_b128 a[136:139], v214 offset:16384
  v_mfma_f32_16x16x32_bf16 v[44:47], a[144:147], v[144:147], v[44:47]
  v_exp_f32 v17, v17
  v_mfma_f32_16x16x32_bf16 v[52:55], a[144:147], v[160:163], v[200:203]
  ds_read_b128 a[140:143], v215 offset:16384
  v_mfma_f32_16x16x32_bf16 v[52:55], a[148:151], v[164:167], v[52:55]
  v_exp_f32 v18, v18
  v_mfma_f32_16x16x32_bf16 v[52:55], a[152:155], v[168:171], v[52:55]
  v_cvt_pk_bf16_f32 v16, v16, v17
  v_mfma_f32_16x16x32_bf16 v[52:55], a[156:159], v[172:175], v[52:55]
  v_exp_f32 v19, v19
  v_mfma_f32_16x16x32_bf16 v[60:63], a[156:159], v[188:191], v[204:207]
  v_cvt_pk_bf16_f32 v9, v10, v11
  v_add_f32 v24, v204, v24
  v_mfma_f32_16x16x32_bf16 v[60:63], a[152:155], v[184:187], v[60:63]
  v_add_f32 v25, v204, v25
  v_add_f32 v26, v204, v26
  v_mfma_f32_16x16x32_bf16 v[60:63], a[148:151], v[180:183], v[60:63]
  v_add_f32 v27, v204, v27
  v_mfma_f32_16x16x32_bf16 v[60:63], a[144:147], v[176:179], v[60:63]
  s_waitcnt lgkmcnt(0)
  v_exp_f32 v24, v24
  v_exp_f32 v25, v25
  v_exp_f32 v26, v26
  v_cvt_pk_bf16_f32 v24, v24, v25
  v_exp_f32 v27, v27
  v_cvt_pk_bf16_f32 v17, v18, v19
  v_add_f32 v4, v192, v4
  v_add_f32 v5, v192, v5
  v_add_f32 v6, v192, v6
  v_add_f32 v7, v192, v7
  v_exp_f32 v4, v4
  v_exp_f32 v5, v5
  v_exp_f32 v6, v6
  v_cvt_pk_bf16_f32 v2, v4, v5
  v_exp_f32 v7, v7
  v_cvt_pk_bf16_f32 v25, v26, v27
  v_add_f32 v12, v196, v12
  v_add_f32 v13, v196, v13
  v_add_f32 v14, v196, v14
  v_add_f32 v15, v196, v15
  v_exp_f32 v12, v12
  v_exp_f32 v13, v13
  v_exp_f32 v14, v14
  v_cvt_pk_bf16_f32 v10, v12, v13
  v_exp_f32 v15, v15
  v_cvt_pk_bf16_f32 v3, v6, v7
  v_add_f32 v20, v200, v20
  v_add_f32 v21, v200, v21
  v_add_f32 v22, v200, v22
  v_add_f32 v23, v200, v23
  v_exp_f32 v20, v20
  v_exp_f32 v21, v21
  v_exp_f32 v22, v22
  v_cvt_pk_bf16_f32 v18, v20, v21
  v_exp_f32 v23, v23
  v_cvt_pk_bf16_f32 v11, v14, v15
  v_add_f32 v28, v204, v28
  v_add_f32 v29, v204, v29
  v_add_f32 v30, v204, v30
  v_add_f32 v31, v204, v31
  v_exp_f32 v28, v28
  v_exp_f32 v29, v29
  v_exp_f32 v30, v30
  v_cvt_pk_bf16_f32 v26, v28, v29
  v_exp_f32 v31, v31
  v_cvt_pk_bf16_f32 v19, v22, v23
  v_exp_f32 v32, v32
  v_exp_f32 v33, v33
  v_exp_f32 v34, v34
  v_cvt_pk_bf16_f32 v32, v32, v33
  v_exp_f32 v35, v35
  v_cvt_pk_bf16_f32 v27, v30, v31
  v_exp_f32 v40, v40
  v_exp_f32 v41, v41
  v_exp_f32 v42, v42
  v_cvt_pk_bf16_f32 v40, v40, v41
  v_exp_f32 v43, v43
  v_cvt_pk_bf16_f32 v33, v34, v35
  v_exp_f32 v48, v48
  v_exp_f32 v49, v49
  v_exp_f32 v50, v50
  v_cvt_pk_bf16_f32 v48, v48, v49
  v_exp_f32 v51, v51
  v_cvt_pk_bf16_f32 v41, v42, v43
  v_exp_f32 v56, v56
  v_exp_f32 v57, v57
  v_exp_f32 v58, v58
  v_cvt_pk_bf16_f32 v56, v56, v57
  v_exp_f32 v59, v59
  v_cvt_pk_bf16_f32 v49, v50, v51
  v_exp_f32 v36, v36
  v_exp_f32 v37, v37
  v_exp_f32 v38, v38
  v_cvt_pk_bf16_f32 v34, v36, v37
  v_exp_f32 v39, v39
  v_cvt_pk_bf16_f32 v57, v58, v59
  v_exp_f32 v44, v44
  v_exp_f32 v45, v45
  v_exp_f32 v46, v46
  v_cvt_pk_bf16_f32 v42, v44, v45
  v_exp_f32 v47, v47
  v_cvt_pk_bf16_f32 v35, v38, v39
  v_exp_f32 v52, v52
  v_exp_f32 v53, v53
  v_exp_f32 v54, v54
  v_cvt_pk_bf16_f32 v50, v52, v53
  v_exp_f32 v55, v55
  v_cvt_pk_bf16_f32 v43, v46, v47
  v_exp_f32 v60, v60
  v_exp_f32 v61, v61
  v_exp_f32 v62, v62
  v_cvt_pk_bf16_f32 v58, v60, v61
  v_exp_f32 v63, v63
  v_cvt_pk_bf16_f32 v51, v54, v55
  v_cvt_pk_bf16_f32 v59, v62, v63
  v_mfma_f32_16x16x32_bf16 v[64:67], a[128:131], v[128:131], v[192:195]
  s_add_u32 m0, s28, 98304
  v_mfma_f32_16x16x32_bf16 v[64:67], a[132:135], v[132:135], v[64:67]
  ds_read_b128 a[144:147], v212 offset:20480
  v_mfma_f32_16x16x32_bf16 v[64:67], a[136:139], v[136:139], v[64:67]
  buffer_load_dwordx4 v236, s[16:19], s29 offen offset:0 lds
  v_mfma_f32_16x16x32_bf16 v[64:67], a[140:143], v[140:143], v[64:67]
  ds_read_b128 a[148:151], v213 offset:20480
  v_mfma_f32_16x16x32_bf16 v[72:75], a[140:143], v[156:159], v[196:199]
  buffer_load_dwordx4 v237, s[16:19], s29 offen offset:1024 lds
  v_mfma_f32_16x16x32_bf16 v[72:75], a[136:139], v[152:155], v[72:75]
  ds_read_b128 a[152:155], v214 offset:20480
  v_mfma_f32_16x16x32_bf16 v[72:75], a[132:135], v[148:151], v[72:75]
  buffer_load_dwordx4 v236, s[16:19], s29 offen offset:2048 lds
  v_mfma_f32_16x16x32_bf16 v[72:75], a[128:131], v[144:147], v[72:75]
  ds_read_b128 a[156:159], v215 offset:20480
  v_mfma_f32_16x16x32_bf16 v[80:83], a[128:131], v[160:163], v[200:203]
  v_exp_f32 v64, v64
  v_mfma_f32_16x16x32_bf16 v[80:83], a[132:135], v[164:167], v[80:83]
  buffer_load_dwordx4 v237, s[16:19], s29 offen offset:3072 lds
  v_mfma_f32_16x16x32_bf16 v[80:83], a[136:139], v[168:171], v[80:83]
  s_add_u32 s29, s29, 16384
  v_exp_f32 v65, v65
  v_mfma_f32_16x16x32_bf16 v[80:83], a[140:143], v[172:175], v[80:83]
  v_cvt_pk_bf16_f32 v64, v64, v65
  v_mfma_f32_16x16x32_bf16 v[88:91], a[140:143], v[188:191], v[204:207]
  s_add_u32 m0, s28, 49152
  v_exp_f32 v66, v66
  v_mfma_f32_16x16x32_bf16 v[88:91], a[136:139], v[184:187], v[88:91]
  buffer_load_dwordx4 v232, s[12:15], s29 offen offset:0 lds
  v_mfma_f32_16x16x32_bf16 v[88:91], a[132:135], v[180:183], v[88:91]
  s_waitcnt lgkmcnt(0)
  v_exp_f32 v67, v67
  v_mfma_f32_16x16x32_bf16 v[88:91], a[128:131], v[176:179], v[88:91]
  v_cvt_pk_bf16_f32 v65, v66, v67
  v_mfma_f32_16x16x32_bf16 v[68:71], a[144:147], v[128:131], v[192:195]
  v_exp_f32 v72, v72
  v_mfma_f32_16x16x32_bf16 v[68:71], a[148:151], v[132:135], v[68:71]
  ds_read_b128 a[128:131], v212 offset:24576
  v_mfma_f32_16x16x32_bf16 v[68:71], a[152:155], v[136:139], v[68:71]
  v_exp_f32 v73, v73
  v_mfma_f32_16x16x32_bf16 v[68:71], a[156:159], v[140:143], v[68:71]
  ds_read_b128 a[132:135], v213 offset:24576
  v_cvt_pk_bf16_f32 v72, v72, v73
  v_mfma_f32_16x16x32_bf16 v[76:79], a[156:159], v[156:159], v[196:199]
  v_exp_f32 v74, v74
  v_mfma_f32_16x16x32_bf16 v[76:79], a[152:155], v[152:155], v[76:79]
  ds_read_b128 a[136:139], v214 offset:24576
  v_mfma_f32_16x16x32_bf16 v[76:79], a[148:151], v[148:151], v[76:79]
  v_exp_f32 v75, v75
  v_mfma_f32_16x16x32_bf16 v[76:79], a[144:147], v[144:147], v[76:79]
  ds_read_b128 a[140:143], v215 offset:24576
  v_cvt_pk_bf16_f32 v73, v74, v75
  v_mfma_f32_16x16x32_bf16 v[84:87], a[144:147], v[160:163], v[200:203]
  v_exp_f32 v80, v80
  v_mfma_f32_16x16x32_bf16 v[84:87], a[148:151], v[164:167], v[84:87]
  buffer_load_dwordx4 v233, s[12:15], s29 offen offset:1024 lds
  v_mfma_f32_16x16x32_bf16 v[84:87], a[152:155], v[168:171], v[84:87]
  v_exp_f32 v81, v81
  v_mfma_f32_16x16x32_bf16 v[84:87], a[156:159], v[172:175], v[84:87]
  v_cvt_pk_bf16_f32 v80, v80, v81
  v_mfma_f32_16x16x32_bf16 v[92:95], a[156:159], v[188:191], v[204:207]
  v_exp_f32 v82, v82
  v_mfma_f32_16x16x32_bf16 v[92:95], a[152:155], v[184:187], v[92:95]
  buffer_load_dwordx4 v234, s[12:15], s29 offen offset:2048 lds
  v_mfma_f32_16x16x32_bf16 v[92:95], a[148:151], v[180:183], v[92:95]
  s_waitcnt lgkmcnt(0)
  v_exp_f32 v83, v83
  v_mfma_f32_16x16x32_bf16 v[92:95], a[144:147], v[176:179], v[92:95]
  v_cvt_pk_bf16_f32 v81, v82, v83
  v_mfma_f32_16x16x32_bf16 v[96:99], a[128:131], v[128:131], v[192:195]
  v_exp_f32 v88, v88
  v_mfma_f32_16x16x32_bf16 v[96:99], a[132:135], v[132:135], v[96:99]
  ds_read_b128 a[144:147], v212 offset:28672
  v_mfma_f32_16x16x32_bf16 v[96:99], a[136:139], v[136:139], v[96:99]
  v_exp_f32 v89, v89
  v_mfma_f32_16x16x32_bf16 v[96:99], a[140:143], v[140:143], v[96:99]
  ds_read_b128 a[148:151], v213 offset:28672
  v_cvt_pk_bf16_f32 v88, v88, v89
  v_mfma_f32_16x16x32_bf16 v[104:107], a[140:143], v[156:159], v[196:199]
  v_exp_f32 v90, v90
  v_mfma_f32_16x16x32_bf16 v[104:107], a[136:139], v[152:155], v[104:107]
  ds_read_b128 a[152:155], v214 offset:28672
  v_mfma_f32_16x16x32_bf16 v[104:107], a[132:135], v[148:151], v[104:107]
  v_exp_f32 v91, v91
  v_mfma_f32_16x16x32_bf16 v[104:107], a[128:131], v[144:147], v[104:107]
  ds_read_b128 a[156:159], v215 offset:28672
  v_cvt_pk_bf16_f32 v89, v90, v91
  v_mfma_f32_16x16x32_bf16 v[112:115], a[128:131], v[160:163], v[200:203]
  v_exp_f32 v68, v68
  v_mfma_f32_16x16x32_bf16 v[112:115], a[132:135], v[164:167], v[112:115]
  buffer_load_dwordx4 v235, s[12:15], s29 offen offset:3072 lds
  v_mfma_f32_16x16x32_bf16 v[112:115], a[136:139], v[168:171], v[112:115]
  v_exp_f32 v69, v69
  v_mfma_f32_16x16x32_bf16 v[112:115], a[140:143], v[172:175], v[112:115]
  v_cvt_pk_bf16_f32 v66, v68, v69
  v_mfma_f32_16x16x32_bf16 v[120:123], a[140:143], v[188:191], v[204:207]
  v_exp_f32 v70, v70
  v_mfma_f32_16x16x32_bf16 v[120:123], a[136:139], v[184:187], v[120:123]
  s_add_u32 m0, s50, 3072
  v_mfma_f32_16x16x32_bf16 v[120:123], a[132:135], v[180:183], v[120:123]
  s_waitcnt lgkmcnt(0)
  v_exp_f32 v71, v71
  v_mfma_f32_16x16x32_bf16 v[120:123], a[128:131], v[176:179], v[120:123]
  buffer_load_dwordx4 v226, s[44:47], s35 offen lds
  s_add_u32 s35, s35, 221184
  v_cvt_pk_bf16_f32 v67, v70, v71
  v_mfma_f32_16x16x32_bf16 v[100:103], a[144:147], v[128:131], v[192:195]
  v_exp_f32 v76, v76
  v_mfma_f32_16x16x32_bf16 v[100:103], a[148:151], v[132:135], v[100:103]
  ds_read_b64_tr_b16 a[160:161], v216 offset:0
  v_mfma_f32_16x16x32_bf16 v[100:103], a[152:155], v[136:139], v[100:103]
  v_exp_f32 v77, v77
  v_mfma_f32_16x16x32_bf16 v[100:103], a[156:159], v[140:143], v[100:103]
  ds_read_b64_tr_b16 a[162:163], v216 offset:4096
  v_cvt_pk_bf16_f32 v74, v76, v77
  v_mfma_f32_16x16x32_bf16 v[108:111], a[156:159], v[156:159], v[196:199]
  v_exp_f32 v78, v78
  v_mfma_f32_16x16x32_bf16 v[108:111], a[152:155], v[152:155], v[108:111]
  ds_read_b64_tr_b16 a[164:165], v216 offset:8192
  v_mfma_f32_16x16x32_bf16 v[108:111], a[148:151], v[148:151], v[108:111]
  v_exp_f32 v79, v79
  v_mfma_f32_16x16x32_bf16 v[108:111], a[144:147], v[144:147], v[108:111]
  ds_read_b64_tr_b16 a[166:167], v216 offset:12288
  v_cvt_pk_bf16_f32 v75, v78, v79
  v_mfma_f32_16x16x32_bf16 v[116:119], a[144:147], v[160:163], v[200:203]
  v_exp_f32 v84, v84
  v_mfma_f32_16x16x32_bf16 v[116:119], a[148:151], v[164:167], v[116:119]
  ds_read_b64_tr_b16 a[168:169], v217 offset:0
  v_mfma_f32_16x16x32_bf16 v[116:119], a[152:155], v[168:171], v[116:119]
  v_exp_f32 v85, v85
  v_mfma_f32_16x16x32_bf16 v[116:119], a[156:159], v[172:175], v[116:119]
  ds_read_b64_tr_b16 a[170:171], v217 offset:4096
  v_cvt_pk_bf16_f32 v82, v84, v85
  v_mfma_f32_16x16x32_bf16 v[124:127], a[156:159], v[188:191], v[204:207]
  v_exp_f32 v86, v86
  v_mfma_f32_16x16x32_bf16 v[124:127], a[152:155], v[184:187], v[124:127]
  ds_read_b64_tr_b16 a[172:173], v217 offset:8192
  v_mfma_f32_16x16x32_bf16 v[124:127], a[148:151], v[180:183], v[124:127]
  v_exp_f32 v87, v87
  v_mfma_f32_16x16x32_bf16 v[124:127], a[144:147], v[176:179], v[124:127]
  ds_read_b64_tr_b16 a[174:175], v217 offset:12288
  v_cvt_pk_bf16_f32 v83, v86, v87
  v_mfma_f32_16x16x32_bf16 a[192:195], a[208:211], v[0:3], 0
  v_exp_f32 v92, v92
  v_mfma_f32_16x16x32_bf16 a[192:195], a[208:211], v[32:35], a[192:195]
  ds_read_b64_tr_b16 a[176:177], v218 offset:0
  v_mfma_f32_16x16x32_bf16 a[196:199], a[208:211], v[8:11], 0
  v_exp_f32 v93, v93
  v_mfma_f32_16x16x32_bf16 a[196:199], a[208:211], v[40:43], a[196:199]
  ds_read_b64_tr_b16 a[178:179], v218 offset:4096
  v_cvt_pk_bf16_f32 v90, v92, v93
  v_mfma_f32_16x16x32_bf16 a[200:203], a[208:211], v[16:19], 0
  v_exp_f32 v94, v94
  v_mfma_f32_16x16x32_bf16 a[200:203], a[208:211], v[48:51], a[200:203]
  ds_read_b64_tr_b16 a[180:181], v218 offset:8192
  v_mfma_f32_16x16x32_bf16 a[204:207], a[208:211], v[24:27], 0
  s_waitcnt lgkmcnt(7)
  v_exp_f32 v95, v95
  v_mfma_f32_16x16x32_bf16 a[204:207], a[208:211], v[56:59], a[204:207]
  ds_read_b64_tr_b16 a[182:183], v218 offset:12288
  v_cvt_pk_bf16_f32 v91, v94, v95
  v_mfma_f32_16x16x32_bf16 a[0:3], a[160:163], v[0:3], 0
  v_exp_f32 v96, v96
  v_mfma_f32_16x16x32_bf16 a[0:3], a[164:167], v[32:35], a[0:3]
  ds_read_b64_tr_b16 a[184:185], v219 offset:0
  v_mfma_f32_16x16x32_bf16 a[4:7], a[164:167], v[40:43], 0
  v_exp_f32 v97, v97
  v_mfma_f32_16x16x32_bf16 a[4:7], a[160:163], v[8:11], a[4:7]
  ds_read_b64_tr_b16 a[186:187], v219 offset:4096
  v_cvt_pk_bf16_f32 v96, v96, v97
  v_mfma_f32_16x16x32_bf16 a[8:11], a[160:163], v[16:19], 0
  v_exp_f32 v98, v98
  v_mfma_f32_16x16x32_bf16 a[8:11], a[164:167], v[48:51], a[8:11]
  ds_read_b64_tr_b16 a[188:189], v219 offset:8192
  v_mfma_f32_16x16x32_bf16 a[12:15], a[164:167], v[56:59], 0
  s_waitcnt lgkmcnt(7)
  v_exp_f32 v99, v99
  v_mfma_f32_16x16x32_bf16 a[12:15], a[160:163], v[24:27], a[12:15]
  ds_read_b64_tr_b16 a[190:191], v219 offset:12288
  v_cvt_pk_bf16_f32 v97, v98, v99
  v_mfma_f32_16x16x32_bf16 a[16:19], a[168:171], v[0:3], 0
  v_exp_f32 v104, v104
  v_mfma_f32_16x16x32_bf16 a[16:19], a[172:175], v[32:35], a[16:19]
  ds_read_b64_tr_b16 a[160:161], v220 offset:0
  v_mfma_f32_16x16x32_bf16 a[20:23], a[172:175], v[40:43], 0
  v_exp_f32 v105, v105
  v_mfma_f32_16x16x32_bf16 a[20:23], a[168:171], v[8:11], a[20:23]
  ds_read_b64_tr_b16 a[162:163], v220 offset:4096
  v_cvt_pk_bf16_f32 v104, v104, v105
  v_mfma_f32_16x16x32_bf16 a[24:27], a[168:171], v[16:19], 0
  v_exp_f32 v106, v106
  v_mfma_f32_16x16x32_bf16 a[24:27], a[172:175], v[48:51], a[24:27]
  ds_read_b64_tr_b16 a[164:165], v220 offset:8192
  v_mfma_f32_16x16x32_bf16 a[28:31], a[172:175], v[56:59], 0
  s_waitcnt lgkmcnt(7)
  v_exp_f32 v107, v107
  v_mfma_f32_16x16x32_bf16 a[28:31], a[168:171], v[24:27], a[28:31]
  ds_read_b64_tr_b16 a[166:167], v220 offset:12288
  v_cvt_pk_bf16_f32 v105, v106, v107
  v_mfma_f32_16x16x32_bf16 a[32:35], a[176:179], v[0:3], 0
  v_exp_f32 v112, v112
  v_mfma_f32_16x16x32_bf16 a[32:35], a[180:183], v[32:35], a[32:35]
  ds_read_b64_tr_b16 a[168:169], v221 offset:0
  v_mfma_f32_16x16x32_bf16 a[36:39], a[180:183], v[40:43], 0
  v_exp_f32 v113, v113
  v_mfma_f32_16x16x32_bf16 a[36:39], a[176:179], v[8:11], a[36:39]
  ds_read_b64_tr_b16 a[170:171], v221 offset:4096
  v_cvt_pk_bf16_f32 v112, v112, v113
  v_mfma_f32_16x16x32_bf16 a[40:43], a[176:179], v[16:19], 0
  v_exp_f32 v114, v114
  v_mfma_f32_16x16x32_bf16 a[40:43], a[180:183], v[48:51], a[40:43]
  ds_read_b64_tr_b16 a[172:173], v221 offset:8192
  v_mfma_f32_16x16x32_bf16 a[44:47], a[180:183], v[56:59], 0
  s_waitcnt lgkmcnt(7)
  v_exp_f32 v115, v115
  v_mfma_f32_16x16x32_bf16 a[44:47], a[176:179], v[24:27], a[44:47]
  ds_read_b64_tr_b16 a[174:175], v221 offset:12288
  v_cvt_pk_bf16_f32 v113, v114, v115
  v_mfma_f32_16x16x32_bf16 a[48:51], a[184:187], v[0:3], 0
  v_exp_f32 v120, v120
  v_mfma_f32_16x16x32_bf16 a[48:51], a[188:191], v[32:35], a[48:51]
  ds_read_b64_tr_b16 a[176:177], v222 offset:0
  v_mfma_f32_16x16x32_bf16 a[52:55], a[188:191], v[40:43], 0
  v_exp_f32 v121, v121
  v_mfma_f32_16x16x32_bf16 a[52:55], a[184:187], v[8:11], a[52:55]
  ds_read_b64_tr_b16 a[178:179], v222 offset:4096
  v_cvt_pk_bf16_f32 v120, v120, v121
  v_mfma_f32_16x16x32_bf16 a[56:59], a[184:187], v[16:19], 0
  v_exp_f32 v122, v122
  v_mfma_f32_16x16x32_bf16 a[56:59], a[188:191], v[48:51], a[56:59]
  ds_read_b64_tr_b16 a[180:181], v222 offset:8192
  v_mfma_f32_16x16x32_bf16 a[60:63], a[188:191], v[56:59], 0
  s_waitcnt lgkmcnt(7)
  v_exp_f32 v123, v123
  v_mfma_f32_16x16x32_bf16 a[60:63], a[184:187], v[24:27], a[60:63]
  ds_read_b64_tr_b16 a[182:183], v222 offset:12288
  v_cvt_pk_bf16_f32 v121, v122, v123
  v_mfma_f32_16x16x32_bf16 a[64:67], a[160:163], v[0:3], 0
  v_exp_f32 v100, v100
  v_mfma_f32_16x16x32_bf16 a[64:67], a[164:167], v[32:35], a[64:67]
  ds_read_b64_tr_b16 a[184:185], v223 offset:0
  v_mfma_f32_16x16x32_bf16 a[68:71], a[164:167], v[40:43], 0
  v_exp_f32 v101, v101
  v_mfma_f32_16x16x32_bf16 a[68:71], a[160:163], v[8:11], a[68:71]
  ds_read_b64_tr_b16 a[186:187], v223 offset:4096
  v_cvt_pk_bf16_f32 v98, v100, v101
  v_mfma_f32_16x16x32_bf16 a[72:75], a[160:163], v[16:19], 0
  v_exp_f32 v102, v102
  v_mfma_f32_16x16x32_bf16 a[72:75], a[164:167], v[48:51], a[72:75]
  ds_read_b64_tr_b16 a[188:189], v223 offset:8192
  v_mfma_f32_16x16x32_bf16 a[76:79], a[164:167], v[56:59], 0
  s_waitcnt lgkmcnt(7)
  v_exp_f32 v103, v103
  v_mfma_f32_16x16x32_bf16 a[76:79], a[160:163], v[24:27], a[76:79]
  ds_read_b64_tr_b16 a[190:191], v223 offset:12288
  v_cvt_pk_bf16_f32 v99, v102, v103
  v_mfma_f32_16x16x32_bf16 a[80:83], a[168:171], v[0:3], 0
  s_waitcnt vmcnt(10)
  v_exp_f32 v108, v108
  v_mfma_f32_16x16x32_bf16 a[80:83], a[172:175], v[32:35], a[80:83]
  v_mfma_f32_16x16x32_bf16 a[84:87], a[172:175], v[40:43], 0
  s_barrier
  v_exp_f32 v109, v109
  v_mfma_f32_16x16x32_bf16 a[84:87], a[168:171], v[8:11], a[84:87]
  ds_read_b128 a[128:131], v212 offset:32768
  v_cvt_pk_bf16_f32 v106, v108, v109
  v_mfma_f32_16x16x32_bf16 a[88:91], a[168:171], v[16:19], 0
  v_exp_f32 v110, v110
  v_mfma_f32_16x16x32_bf16 a[88:91], a[172:175], v[48:51], a[88:91]
  ds_read_b128 a[132:135], v213 offset:32768
  v_mfma_f32_16x16x32_bf16 a[92:95], a[172:175], v[56:59], 0
  s_waitcnt lgkmcnt(6)
  v_exp_f32 v111, v111
  v_mfma_f32_16x16x32_bf16 a[92:95], a[168:171], v[24:27], a[92:95]
  ds_read_b128 a[136:139], v214 offset:32768
  v_cvt_pk_bf16_f32 v107, v110, v111
  v_mfma_f32_16x16x32_bf16 a[96:99], a[176:179], v[0:3], 0
  v_exp_f32 v116, v116
  v_mfma_f32_16x16x32_bf16 a[96:99], a[180:183], v[32:35], a[96:99]
  ds_read_b128 a[140:143], v215 offset:32768
  v_mfma_f32_16x16x32_bf16 a[100:103], a[180:183], v[40:43], 0
  v_exp_f32 v117, v117
  v_mfma_f32_16x16x32_bf16 a[100:103], a[176:179], v[8:11], a[100:103]
  v_cvt_pk_bf16_f32 v114, v116, v117
  v_mfma_f32_16x16x32_bf16 a[104:107], a[176:179], v[16:19], 0
  v_exp_f32 v118, v118
  v_mfma_f32_16x16x32_bf16 a[104:107], a[180:183], v[48:51], a[104:107]
  v_mfma_f32_16x16x32_bf16 a[108:111], a[180:183], v[56:59], 0
  s_waitcnt lgkmcnt(4)
  v_exp_f32 v119, v119
  v_mfma_f32_16x16x32_bf16 a[108:111], a[176:179], v[24:27], a[108:111]
  v_cvt_pk_bf16_f32 v115, v118, v119
  v_mfma_f32_16x16x32_bf16 a[112:115], a[184:187], v[0:3], 0
  v_exp_f32 v124, v124
  v_mfma_f32_16x16x32_bf16 a[112:115], a[188:191], v[32:35], a[112:115]
  v_mfma_f32_16x16x32_bf16 a[116:119], a[188:191], v[40:43], 0
  v_exp_f32 v125, v125
  v_mfma_f32_16x16x32_bf16 a[116:119], a[184:187], v[8:11], a[116:119]
  v_cvt_pk_bf16_f32 v122, v124, v125
  v_mfma_f32_16x16x32_bf16 a[120:123], a[184:187], v[16:19], 0
  v_exp_f32 v126, v126
  v_mfma_f32_16x16x32_bf16 a[120:123], a[188:191], v[48:51], a[120:123]
  v_mfma_f32_16x16x32_bf16 a[124:127], a[188:191], v[56:59], 0
  s_waitcnt lgkmcnt(0)
  v_exp_f32 v127, v127
  v_mfma_f32_16x16x32_bf16 a[124:127], a[184:187], v[24:27], a[124:127]
  v_cvt_pk_bf16_f32 v123, v126, v127
  v_mfma_f32_16x16x32_bf16 v[0:3], a[128:131], v[128:131], v[192:195]
  s_add_u32 m0, s28, 114688
  v_mfma_f32_16x16x32_bf16 v[0:3], a[132:135], v[132:135], v[0:3]
  ds_read_b128 a[144:147], v212 offset:36864
  v_mfma_f32_16x16x32_bf16 v[0:3], a[136:139], v[136:139], v[0:3]
  buffer_load_dwordx4 v236, s[16:19], s29 offen offset:0 lds
  v_mfma_f32_16x16x32_bf16 v[0:3], a[140:143], v[140:143], v[0:3]
  ds_read_b128 a[148:151], v213 offset:36864
  v_mfma_f32_16x16x32_bf16 v[8:11], a[140:143], v[156:159], v[196:199]
  buffer_load_dwordx4 v237, s[16:19], s29 offen offset:1024 lds
  v_mfma_f32_16x16x32_bf16 v[8:11], a[136:139], v[152:155], v[8:11]
  ds_read_b128 a[152:155], v214 offset:36864
  v_mfma_f32_16x16x32_bf16 v[8:11], a[132:135], v[148:151], v[8:11]
  buffer_load_dwordx4 v236, s[16:19], s29 offen offset:2048 lds
  v_mfma_f32_16x16x32_bf16 v[8:11], a[128:131], v[144:147], v[8:11]
  ds_read_b128 a[156:159], v215 offset:36864
  v_mfma_f32_16x16x32_bf16 v[16:19], a[128:131], v[160:163], v[200:203]
  v_exp_f32 v0, v0
  v_mfma_f32_16x16x32_bf16 v[16:19], a[132:135], v[164:167], v[16:19]
  buffer_load_dwordx4 v237, s[16:19], s29 offen offset:3072 lds
  v_mfma_f32_16x16x32_bf16 v[16:19], a[136:139], v[168:171], v[16:19]
  s_add_u32 s29, s29, 16384
  v_exp_f32 v1, v1
  v_mfma_f32_16x16x32_bf16 v[16:19], a[140:143], v[172:175], v[16:19]
  v_cvt_pk_bf16_f32 v0, v0, v1
  v_mfma_f32_16x16x32_bf16 v[24:27], a[140:143], v[188:191], v[204:207]
  s_add_u32 m0, s28, 0
  v_exp_f32 v2, v2
  v_mfma_f32_16x16x32_bf16 v[24:27], a[136:139], v[184:187], v[24:27]
  buffer_load_dwordx4 v232, s[12:15], s29 offen offset:0 lds
  v_mfma_f32_16x16x32_bf16 v[24:27], a[132:135], v[180:183], v[24:27]
  s_waitcnt lgkmcnt(0)
  v_exp_f32 v3, v3
  v_mfma_f32_16x16x32_bf16 v[24:27], a[128:131], v[176:179], v[24:27]
  v_cvt_pk_bf16_f32 v1, v2, v3
  v_mfma_f32_16x16x32_bf16 v[4:7], a[144:147], v[128:131], v[192:195]
  v_exp_f32 v8, v8
  v_mfma_f32_16x16x32_bf16 v[4:7], a[148:151], v[132:135], v[4:7]
  ds_read_b128 a[128:131], v212 offset:40960
  v_mfma_f32_16x16x32_bf16 v[4:7], a[152:155], v[136:139], v[4:7]
  v_exp_f32 v9, v9
  v_mfma_f32_16x16x32_bf16 v[4:7], a[156:159], v[140:143], v[4:7]
  ds_read_b128 a[132:135], v213 offset:40960
  v_cvt_pk_bf16_f32 v8, v8, v9
  v_mfma_f32_16x16x32_bf16 v[12:15], a[156:159], v[156:159], v[196:199]
  v_exp_f32 v10, v10
  v_mfma_f32_16x16x32_bf16 v[12:15], a[152:155], v[152:155], v[12:15]
  ds_read_b128 a[136:139], v214 offset:40960
  v_mfma_f32_16x16x32_bf16 v[12:15], a[148:151], v[148:151], v[12:15]
  v_exp_f32 v11, v11
  v_mfma_f32_16x16x32_bf16 v[12:15], a[144:147], v[144:147], v[12:15]
  ds_read_b128 a[140:143], v215 offset:40960
  v_cvt_pk_bf16_f32 v9, v10, v11
  v_mfma_f32_16x16x32_bf16 v[20:23], a[144:147], v[160:163], v[200:203]
  v_exp_f32 v16, v16
  v_mfma_f32_16x16x32_bf16 v[20:23], a[148:151], v[164:167], v[20:23]
  buffer_load_dwordx4 v233, s[12:15], s29 offen offset:1024 lds
  v_mfma_f32_16x16x32_bf16 v[20:23], a[152:155], v[168:171], v[20:23]
  v_exp_f32 v17, v17
  v_mfma_f32_16x16x32_bf16 v[20:23], a[156:159], v[172:175], v[20:23]
  v_cvt_pk_bf16_f32 v16, v16, v17
  v_mfma_f32_16x16x32_bf16 v[28:31], a[156:159], v[188:191], v[204:207]
  v_exp_f32 v18, v18
  v_mfma_f32_16x16x32_bf16 v[28:31], a[152:155], v[184:187], v[28:31]
  buffer_load_dwordx4 v234, s[12:15], s29 offen offset:2048 lds
  v_mfma_f32_16x16x32_bf16 v[28:31], a[148:151], v[180:183], v[28:31]
  s_waitcnt lgkmcnt(0)
  v_exp_f32 v19, v19
  v_mfma_f32_16x16x32_bf16 v[28:31], a[144:147], v[176:179], v[28:31]
  v_cvt_pk_bf16_f32 v17, v18, v19
  v_mfma_f32_16x16x32_bf16 v[32:35], a[128:131], v[128:131], v[192:195]
  v_exp_f32 v24, v24
  v_mfma_f32_16x16x32_bf16 v[32:35], a[132:135], v[132:135], v[32:35]
  ds_read_b128 a[144:147], v212 offset:45056
  v_mfma_f32_16x16x32_bf16 v[32:35], a[136:139], v[136:139], v[32:35]
  v_exp_f32 v25, v25
  v_mfma_f32_16x16x32_bf16 v[32:35], a[140:143], v[140:143], v[32:35]
  ds_read_b128 a[148:151], v213 offset:45056
  v_cvt_pk_bf16_f32 v24, v24, v25
  v_mfma_f32_16x16x32_bf16 v[40:43], a[140:143], v[156:159], v[196:199]
  v_exp_f32 v26, v26
  v_mfma_f32_16x16x32_bf16 v[40:43], a[136:139], v[152:155], v[40:43]
  ds_read_b128 a[152:155], v214 offset:45056
  v_mfma_f32_16x16x32_bf16 v[40:43], a[132:135], v[148:151], v[40:43]
  v_exp_f32 v27, v27
  v_mfma_f32_16x16x32_bf16 v[40:43], a[128:131], v[144:147], v[40:43]
  ds_read_b128 a[156:159], v215 offset:45056
  v_cvt_pk_bf16_f32 v25, v26, v27
  v_mfma_f32_16x16x32_bf16 v[48:51], a[128:131], v[160:163], v[200:203]
  v_exp_f32 v4, v4
  v_mfma_f32_16x16x32_bf16 v[48:51], a[132:135], v[164:167], v[48:51]
  buffer_load_dwordx4 v235, s[12:15], s29 offen offset:3072 lds
  v_mfma_f32_16x16x32_bf16 v[48:51], a[136:139], v[168:171], v[48:51]
  v_exp_f32 v5, v5
  v_mfma_f32_16x16x32_bf16 v[48:51], a[140:143], v[172:175], v[48:51]
  v_cvt_pk_bf16_f32 v2, v4, v5
  v_mfma_f32_16x16x32_bf16 v[56:59], a[140:143], v[188:191], v[204:207]
  v_exp_f32 v6, v6
  v_mfma_f32_16x16x32_bf16 v[56:59], a[136:139], v[184:187], v[56:59]
  s_add_u32 m0, s50, 1024
  v_mfma_f32_16x16x32_bf16 v[56:59], a[132:135], v[180:183], v[56:59]
  s_waitcnt lgkmcnt(0)
  v_exp_f32 v7, v7
  v_mfma_f32_16x16x32_bf16 v[56:59], a[128:131], v[176:179], v[56:59]
  buffer_load_dwordx4 v226, s[20:23], s35 offen lds
  v_cvt_pk_bf16_f32 v3, v6, v7
  v_mfma_f32_16x16x32_bf16 v[36:39], a[144:147], v[128:131], v[192:195]
  v_exp_f32 v12, v12
  v_mfma_f32_16x16x32_bf16 v[36:39], a[148:151], v[132:135], v[36:39]
  ds_read_b64_tr_b16 a[160:161], v216 offset:16384
  v_mfma_f32_16x16x32_bf16 v[36:39], a[152:155], v[136:139], v[36:39]
  v_exp_f32 v13, v13
  v_mfma_f32_16x16x32_bf16 v[36:39], a[156:159], v[140:143], v[36:39]
  ds_read_b64_tr_b16 a[162:163], v216 offset:20480
  v_cvt_pk_bf16_f32 v10, v12, v13
  v_mfma_f32_16x16x32_bf16 v[44:47], a[156:159], v[156:159], v[196:199]
  v_exp_f32 v14, v14
  v_mfma_f32_16x16x32_bf16 v[44:47], a[152:155], v[152:155], v[44:47]
  ds_read_b64_tr_b16 a[164:165], v216 offset:24576
  v_mfma_f32_16x16x32_bf16 v[44:47], a[148:151], v[148:151], v[44:47]
  v_exp_f32 v15, v15
  v_mfma_f32_16x16x32_bf16 v[44:47], a[144:147], v[144:147], v[44:47]
  ds_read_b64_tr_b16 a[166:167], v216 offset:28672
  v_cvt_pk_bf16_f32 v11, v14, v15
  v_mfma_f32_16x16x32_bf16 v[52:55], a[144:147], v[160:163], v[200:203]
  v_exp_f32 v20, v20
  v_mfma_f32_16x16x32_bf16 v[52:55], a[148:151], v[164:167], v[52:55]
  ds_read_b64_tr_b16 a[168:169], v217 offset:16384
  v_mfma_f32_16x16x32_bf16 v[52:55], a[152:155], v[168:171], v[52:55]
  v_exp_f32 v21, v21
  v_mfma_f32_16x16x32_bf16 v[52:55], a[156:159], v[172:175], v[52:55]
  ds_read_b64_tr_b16 a[170:171], v217 offset:20480
  v_cvt_pk_bf16_f32 v18, v20, v21
  v_mfma_f32_16x16x32_bf16 v[60:63], a[156:159], v[188:191], v[204:207]
  v_exp_f32 v22, v22
  v_mfma_f32_16x16x32_bf16 v[60:63], a[152:155], v[184:187], v[60:63]
  ds_read_b64_tr_b16 a[172:173], v217 offset:24576
  v_mfma_f32_16x16x32_bf16 v[60:63], a[148:151], v[180:183], v[60:63]
  v_exp_f32 v23, v23
  v_mfma_f32_16x16x32_bf16 v[60:63], a[144:147], v[176:179], v[60:63]
  ds_read_b64_tr_b16 a[174:175], v217 offset:28672
  v_cvt_pk_bf16_f32 v19, v22, v23
  v_mfma_f32_16x16x32_bf16 a[192:195], a[208:211], v[64:67], a[192:195]
  v_exp_f32 v28, v28
  v_mfma_f32_16x16x32_bf16 a[192:195], a[208:211], v[96:99], a[192:195]
  ds_read_b64_tr_b16 a[176:177], v218 offset:16384
  v_mfma_f32_16x16x32_bf16 a[196:199], a[208:211], v[72:75], a[196:199]
  v_exp_f32 v29, v29
  v_mfma_f32_16x16x32_bf16 a[196:199], a[208:211], v[104:107], a[196:199]
  ds_read_b64_tr_b16 a[178:179], v218 offset:20480
  v_cvt_pk_bf16_f32 v26, v28, v29
  v_mfma_f32_16x16x32_bf16 a[200:203], a[208:211], v[80:83], a[200:203]
  v_exp_f32 v30, v30
  v_mfma_f32_16x16x32_bf16 a[200:203], a[208:211], v[112:115], a[200:203]
  ds_read_b64_tr_b16 a[180:181], v218 offset:24576
  v_mfma_f32_16x16x32_bf16 a[204:207], a[208:211], v[88:91], a[204:207]
  s_waitcnt lgkmcnt(7)
  v_exp_f32 v31, v31
  v_mfma_f32_16x16x32_bf16 a[204:207], a[208:211], v[120:123], a[204:207]
  ds_read_b64_tr_b16 a[182:183], v218 offset:28672
  v_cvt_pk_bf16_f32 v27, v30, v31
  v_mfma_f32_16x16x32_bf16 a[0:3], a[160:163], v[64:67], a[0:3]
  v_exp_f32 v32, v32
  v_mfma_f32_16x16x32_bf16 a[0:3], a[164:167], v[96:99], a[0:3]
  ds_read_b64_tr_b16 a[184:185], v219 offset:16384
  v_mfma_f32_16x16x32_bf16 a[4:7], a[164:167], v[104:107], a[4:7]
  v_exp_f32 v33, v33
  v_mfma_f32_16x16x32_bf16 a[4:7], a[160:163], v[72:75], a[4:7]
  ds_read_b64_tr_b16 a[186:187], v219 offset:20480
  v_cvt_pk_bf16_f32 v32, v32, v33
  v_mfma_f32_16x16x32_bf16 a[8:11], a[160:163], v[80:83], a[8:11]
  v_exp_f32 v34, v34
  v_mfma_f32_16x16x32_bf16 a[8:11], a[164:167], v[112:115], a[8:11]
  ds_read_b64_tr_b16 a[188:189], v219 offset:24576
  v_mfma_f32_16x16x32_bf16 a[12:15], a[164:167], v[120:123], a[12:15]
  s_waitcnt lgkmcnt(7)
  v_exp_f32 v35, v35
  v_mfma_f32_16x16x32_bf16 a[12:15], a[160:163], v[88:91], a[12:15]
  ds_read_b64_tr_b16 a[190:191], v219 offset:28672
  v_cvt_pk_bf16_f32 v33, v34, v35
  v_mfma_f32_16x16x32_bf16 a[16:19], a[168:171], v[64:67], a[16:19]
  v_exp_f32 v40, v40
  v_mfma_f32_16x16x32_bf16 a[16:19], a[172:175], v[96:99], a[16:19]
  ds_read_b64_tr_b16 a[160:161], v220 offset:16384
  v_mfma_f32_16x16x32_bf16 a[20:23], a[172:175], v[104:107], a[20:23]
  v_exp_f32 v41, v41
  v_mfma_f32_16x16x32_bf16 a[20:23], a[168:171], v[72:75], a[20:23]
  ds_read_b64_tr_b16 a[162:163], v220 offset:20480
  v_cvt_pk_bf16_f32 v40, v40, v41
  v_mfma_f32_16x16x32_bf16 a[24:27], a[168:171], v[80:83], a[24:27]
  v_exp_f32 v42, v42
  v_mfma_f32_16x16x32_bf16 a[24:27], a[172:175], v[112:115], a[24:27]
  ds_read_b64_tr_b16 a[164:165], v220 offset:24576
  v_mfma_f32_16x16x32_bf16 a[28:31], a[172:175], v[120:123], a[28:31]
  s_waitcnt lgkmcnt(7)
  v_exp_f32 v43, v43
  v_mfma_f32_16x16x32_bf16 a[28:31], a[168:171], v[88:91], a[28:31]
  ds_read_b64_tr_b16 a[166:167], v220 offset:28672
  v_cvt_pk_bf16_f32 v41, v42, v43
  v_mfma_f32_16x16x32_bf16 a[32:35], a[176:179], v[64:67], a[32:35]
  v_exp_f32 v48, v48
  v_mfma_f32_16x16x32_bf16 a[32:35], a[180:183], v[96:99], a[32:35]
  ds_read_b64_tr_b16 a[168:169], v221 offset:16384
  v_mfma_f32_16x16x32_bf16 a[36:39], a[180:183], v[104:107], a[36:39]
  v_exp_f32 v49, v49
  v_mfma_f32_16x16x32_bf16 a[36:39], a[176:179], v[72:75], a[36:39]
  ds_read_b64_tr_b16 a[170:171], v221 offset:20480
  v_cvt_pk_bf16_f32 v48, v48, v49
  v_mfma_f32_16x16x32_bf16 a[40:43], a[176:179], v[80:83], a[40:43]
  v_exp_f32 v50, v50
  v_mfma_f32_16x16x32_bf16 a[40:43], a[180:183], v[112:115], a[40:43]
  ds_read_b64_tr_b16 a[172:173], v221 offset:24576
  v_mfma_f32_16x16x32_bf16 a[44:47], a[180:183], v[120:123], a[44:47]
  s_waitcnt lgkmcnt(7)
  v_exp_f32 v51, v51
  v_mfma_f32_16x16x32_bf16 a[44:47], a[176:179], v[88:91], a[44:47]
  ds_read_b64_tr_b16 a[174:175], v221 offset:28672
  v_cvt_pk_bf16_f32 v49, v50, v51
  v_mfma_f32_16x16x32_bf16 a[48:51], a[184:187], v[64:67], a[48:51]
  v_exp_f32 v56, v56
  v_mfma_f32_16x16x32_bf16 a[48:51], a[188:191], v[96:99], a[48:51]
  ds_read_b64_tr_b16 a[176:177], v222 offset:16384
  v_mfma_f32_16x16x32_bf16 a[52:55], a[188:191], v[104:107], a[52:55]
  v_exp_f32 v57, v57
  v_mfma_f32_16x16x32_bf16 a[52:55], a[184:187], v[72:75], a[52:55]
  ds_read_b64_tr_b16 a[178:179], v222 offset:20480
  v_cvt_pk_bf16_f32 v56, v56, v57
  v_mfma_f32_16x16x32_bf16 a[56:59], a[184:187], v[80:83], a[56:59]
  v_exp_f32 v58, v58
  v_mfma_f32_16x16x32_bf16 a[56:59], a[188:191], v[112:115], a[56:59]
  ds_read_b64_tr_b16 a[180:181], v222 offset:24576
  v_mfma_f32_16x16x32_bf16 a[60:63], a[188:191], v[120:123], a[60:63]
  s_waitcnt lgkmcnt(7)
  v_exp_f32 v59, v59
  v_mfma_f32_16x16x32_bf16 a[60:63], a[184:187], v[88:91], a[60:63]
  ds_read_b64_tr_b16 a[182:183], v222 offset:28672
  v_cvt_pk_bf16_f32 v57, v58, v59
  v_mfma_f32_16x16x32_bf16 a[64:67], a[160:163], v[64:67], a[64:67]
  v_exp_f32 v36, v36
  v_mfma_f32_16x16x32_bf16 a[64:67], a[164:167], v[96:99], a[64:67]
  ds_read_b64_tr_b16 a[184:185], v223 offset:16384
  v_mfma_f32_16x16x32_bf16 a[68:71], a[164:167], v[104:107], a[68:71]
  v_exp_f32 v37, v37
  v_mfma_f32_16x16x32_bf16 a[68:71], a[160:163], v[72:75], a[68:71]
  ds_read_b64_tr_b16 a[186:187], v223 offset:20480
  v_cvt_pk_bf16_f32 v34, v36, v37
  v_mfma_f32_16x16x32_bf16 a[72:75], a[160:163], v[80:83], a[72:75]
  v_exp_f32 v38, v38
  v_mfma_f32_16x16x32_bf16 a[72:75], a[164:167], v[112:115], a[72:75]
  ds_read_b64_tr_b16 a[188:189], v223 offset:24576
  v_mfma_f32_16x16x32_bf16 a[76:79], a[164:167], v[120:123], a[76:79]
  s_waitcnt lgkmcnt(7)
  v_exp_f32 v39, v39
  v_mfma_f32_16x16x32_bf16 a[76:79], a[160:163], v[88:91], a[76:79]
  ds_read_b64_tr_b16 a[190:191], v223 offset:28672
  v_cvt_pk_bf16_f32 v35, v38, v39
  v_mfma_f32_16x16x32_bf16 a[80:83], a[168:171], v[64:67], a[80:83]
  s_waitcnt vmcnt(10)
  v_exp_f32 v44, v44
  v_mfma_f32_16x16x32_bf16 a[80:83], a[172:175], v[96:99], a[80:83]
  v_mfma_f32_16x16x32_bf16 a[84:87], a[172:175], v[104:107], a[84:87]
  s_barrier
  v_exp_f32 v45, v45
  v_mfma_f32_16x16x32_bf16 a[84:87], a[168:171], v[72:75], a[84:87]
  ds_read_b128 a[128:131], v212 offset:49152
  v_cvt_pk_bf16_f32 v42, v44, v45
  v_mfma_f32_16x16x32_bf16 a[88:91], a[168:171], v[80:83], a[88:91]
  v_exp_f32 v46, v46
  v_mfma_f32_16x16x32_bf16 a[88:91], a[172:175], v[112:115], a[88:91]
  ds_read_b128 a[132:135], v213 offset:49152
  v_mfma_f32_16x16x32_bf16 a[92:95], a[172:175], v[120:123], a[92:95]
  s_waitcnt lgkmcnt(6)
  v_exp_f32 v47, v47
  v_mfma_f32_16x16x32_bf16 a[92:95], a[168:171], v[88:91], a[92:95]
  ds_read_b128 a[136:139], v214 offset:49152
  v_cvt_pk_bf16_f32 v43, v46, v47
  v_mfma_f32_16x16x32_bf16 a[96:99], a[176:179], v[64:67], a[96:99]
  v_exp_f32 v52, v52
  v_mfma_f32_16x16x32_bf16 a[96:99], a[180:183], v[96:99], a[96:99]
  ds_read_b128 a[140:143], v215 offset:49152
  v_mfma_f32_16x16x32_bf16 a[100:103], a[180:183], v[104:107], a[100:103]
  v_exp_f32 v53, v53
  v_mfma_f32_16x16x32_bf16 a[100:103], a[176:179], v[72:75], a[100:103]
  v_cvt_pk_bf16_f32 v50, v52, v53
  v_mfma_f32_16x16x32_bf16 a[104:107], a[176:179], v[80:83], a[104:107]
  v_exp_f32 v54, v54
  v_mfma_f32_16x16x32_bf16 a[104:107], a[180:183], v[112:115], a[104:107]
  v_mfma_f32_16x16x32_bf16 a[108:111], a[180:183], v[120:123], a[108:111]
  s_waitcnt lgkmcnt(4)
  v_exp_f32 v55, v55
  v_mfma_f32_16x16x32_bf16 a[108:111], a[176:179], v[88:91], a[108:111]
  v_cvt_pk_bf16_f32 v51, v54, v55
  v_mfma_f32_16x16x32_bf16 a[112:115], a[184:187], v[64:67], a[112:115]
  v_exp_f32 v60, v60
  v_mfma_f32_16x16x32_bf16 a[112:115], a[188:191], v[96:99], a[112:115]
  v_mfma_f32_16x16x32_bf16 a[116:119], a[188:191], v[104:107], a[116:119]
  v_exp_f32 v61, v61
  v_mfma_f32_16x16x32_bf16 a[116:119], a[184:187], v[72:75], a[116:119]
  v_cvt_pk_bf16_f32 v58, v60, v61
  v_mfma_f32_16x16x32_bf16 a[120:123], a[184:187], v[80:83], a[120:123]
  v_exp_f32 v62, v62
  v_mfma_f32_16x16x32_bf16 a[120:123], a[188:191], v[112:115], a[120:123]
  v_mfma_f32_16x16x32_bf16 a[124:127], a[188:191], v[120:123], a[124:127]
  s_waitcnt lgkmcnt(0)
  v_exp_f32 v63, v63
  v_mfma_f32_16x16x32_bf16 a[124:127], a[184:187], v[88:91], a[124:127]
  v_cvt_pk_bf16_f32 v59, v62, v63
  v_mfma_f32_16x16x32_bf16 v[64:67], a[128:131], v[128:131], v[192:195]
  s_add_u32 m0, s28, 65536
  v_mfma_f32_16x16x32_bf16 v[64:67], a[132:135], v[132:135], v[64:67]
  ds_read_b128 a[144:147], v212 offset:53248
  v_mfma_f32_16x16x32_bf16 v[64:67], a[136:139], v[136:139], v[64:67]
  buffer_load_dwordx4 v236, s[16:19], s29 offen offset:0 lds
  v_mfma_f32_16x16x32_bf16 v[64:67], a[140:143], v[140:143], v[64:67]
  ds_read_b128 a[148:151], v213 offset:53248
  v_mfma_f32_16x16x32_bf16 v[72:75], a[140:143], v[156:159], v[196:199]
  buffer_load_dwordx4 v237, s[16:19], s29 offen offset:1024 lds
  v_mfma_f32_16x16x32_bf16 v[72:75], a[136:139], v[152:155], v[72:75]
  ds_read_b128 a[152:155], v214 offset:53248
  v_mfma_f32_16x16x32_bf16 v[72:75], a[132:135], v[148:151], v[72:75]
  buffer_load_dwordx4 v236, s[16:19], s29 offen offset:2048 lds
  v_mfma_f32_16x16x32_bf16 v[72:75], a[128:131], v[144:147], v[72:75]
  ds_read_b128 a[156:159], v215 offset:53248
  v_mfma_f32_16x16x32_bf16 v[80:83], a[128:131], v[160:163], v[200:203]
  v_exp_f32 v64, v64
  v_mfma_f32_16x16x32_bf16 v[80:83], a[132:135], v[164:167], v[80:83]
  buffer_load_dwordx4 v237, s[16:19], s29 offen offset:3072 lds
  v_mfma_f32_16x16x32_bf16 v[80:83], a[136:139], v[168:171], v[80:83]
  s_add_u32 s29, s29, 16384
  v_exp_f32 v65, v65
  v_mfma_f32_16x16x32_bf16 v[80:83], a[140:143], v[172:175], v[80:83]
  v_cvt_pk_bf16_f32 v64, v64, v65
  v_mfma_f32_16x16x32_bf16 v[88:91], a[140:143], v[188:191], v[204:207]
  s_add_u32 m0, s28, 16384
  v_exp_f32 v66, v66
  v_mfma_f32_16x16x32_bf16 v[88:91], a[136:139], v[184:187], v[88:91]
  buffer_load_dwordx4 v232, s[12:15], s29 offen offset:0 lds
  v_mfma_f32_16x16x32_bf16 v[88:91], a[132:135], v[180:183], v[88:91]
  s_waitcnt lgkmcnt(0)
  v_exp_f32 v67, v67
  v_mfma_f32_16x16x32_bf16 v[88:91], a[128:131], v[176:179], v[88:91]
  v_cvt_pk_bf16_f32 v65, v66, v67
  v_mfma_f32_16x16x32_bf16 v[68:71], a[144:147], v[128:131], v[192:195]
  v_exp_f32 v72, v72
  v_mfma_f32_16x16x32_bf16 v[68:71], a[148:151], v[132:135], v[68:71]
  ds_read_b128 a[128:131], v212 offset:57344
  v_mfma_f32_16x16x32_bf16 v[68:71], a[152:155], v[136:139], v[68:71]
  v_exp_f32 v73, v73
  v_mfma_f32_16x16x32_bf16 v[68:71], a[156:159], v[140:143], v[68:71]
  ds_read_b128 a[132:135], v213 offset:57344
  v_cvt_pk_bf16_f32 v72, v72, v73
  v_mfma_f32_16x16x32_bf16 v[76:79], a[156:159], v[156:159], v[196:199]
  v_exp_f32 v74, v74
  v_mfma_f32_16x16x32_bf16 v[76:79], a[152:155], v[152:155], v[76:79]
  ds_read_b128 a[136:139], v214 offset:57344
  v_mfma_f32_16x16x32_bf16 v[76:79], a[148:151], v[148:151], v[76:79]
  v_exp_f32 v75, v75
  v_mfma_f32_16x16x32_bf16 v[76:79], a[144:147], v[144:147], v[76:79]
  ds_read_b128 a[140:143], v215 offset:57344
  v_cvt_pk_bf16_f32 v73, v74, v75
  v_mfma_f32_16x16x32_bf16 v[84:87], a[144:147], v[160:163], v[200:203]
  v_exp_f32 v80, v80
  v_mfma_f32_16x16x32_bf16 v[84:87], a[148:151], v[164:167], v[84:87]
  buffer_load_dwordx4 v233, s[12:15], s29 offen offset:1024 lds
  v_mfma_f32_16x16x32_bf16 v[84:87], a[152:155], v[168:171], v[84:87]
  v_exp_f32 v81, v81
  v_mfma_f32_16x16x32_bf16 v[84:87], a[156:159], v[172:175], v[84:87]
  v_cvt_pk_bf16_f32 v80, v80, v81
  v_mfma_f32_16x16x32_bf16 v[92:95], a[156:159], v[188:191], v[204:207]
  v_exp_f32 v82, v82
  v_mfma_f32_16x16x32_bf16 v[92:95], a[152:155], v[184:187], v[92:95]
  buffer_load_dwordx4 v234, s[12:15], s29 offen offset:2048 lds
  v_mfma_f32_16x16x32_bf16 v[92:95], a[148:151], v[180:183], v[92:95]
  s_waitcnt lgkmcnt(0)
  v_exp_f32 v83, v83
  v_mfma_f32_16x16x32_bf16 v[92:95], a[144:147], v[176:179], v[92:95]
  v_cvt_pk_bf16_f32 v81, v82, v83
  v_mfma_f32_16x16x32_bf16 v[96:99], a[128:131], v[128:131], v[192:195]
  v_exp_f32 v88, v88
  v_mfma_f32_16x16x32_bf16 v[96:99], a[132:135], v[132:135], v[96:99]
  ds_read_b128 a[144:147], v212 offset:61440
  v_mfma_f32_16x16x32_bf16 v[96:99], a[136:139], v[136:139], v[96:99]
  v_exp_f32 v89, v89
  v_mfma_f32_16x16x32_bf16 v[96:99], a[140:143], v[140:143], v[96:99]
  ds_read_b128 a[148:151], v213 offset:61440
  v_cvt_pk_bf16_f32 v88, v88, v89
  v_mfma_f32_16x16x32_bf16 v[104:107], a[140:143], v[156:159], v[196:199]
  v_exp_f32 v90, v90
  v_mfma_f32_16x16x32_bf16 v[104:107], a[136:139], v[152:155], v[104:107]
  ds_read_b128 a[152:155], v214 offset:61440
  v_mfma_f32_16x16x32_bf16 v[104:107], a[132:135], v[148:151], v[104:107]
  v_exp_f32 v91, v91
  v_mfma_f32_16x16x32_bf16 v[104:107], a[128:131], v[144:147], v[104:107]
  ds_read_b128 a[156:159], v215 offset:61440
  v_cvt_pk_bf16_f32 v89, v90, v91
  v_mfma_f32_16x16x32_bf16 v[112:115], a[128:131], v[160:163], v[200:203]
  v_exp_f32 v68, v68
  v_mfma_f32_16x16x32_bf16 v[112:115], a[132:135], v[164:167], v[112:115]
  buffer_load_dwordx4 v235, s[12:15], s29 offen offset:3072 lds
  v_mfma_f32_16x16x32_bf16 v[112:115], a[136:139], v[168:171], v[112:115]
  v_exp_f32 v69, v69
  v_mfma_f32_16x16x32_bf16 v[112:115], a[140:143], v[172:175], v[112:115]
  v_cvt_pk_bf16_f32 v66, v68, v69
  v_mfma_f32_16x16x32_bf16 v[120:123], a[140:143], v[188:191], v[204:207]
  v_exp_f32 v70, v70
  v_mfma_f32_16x16x32_bf16 v[120:123], a[136:139], v[184:187], v[120:123]
  s_add_u32 m0, s50, 4096
  v_mfma_f32_16x16x32_bf16 v[120:123], a[132:135], v[180:183], v[120:123]
  s_waitcnt lgkmcnt(0)
  v_exp_f32 v71, v71
  v_mfma_f32_16x16x32_bf16 v[120:123], a[128:131], v[176:179], v[120:123]
  buffer_load_dwordx4 v226, s[44:47], s35 offen lds
  s_add_u32 s35, s35, 221184
  v_cvt_pk_bf16_f32 v67, v70, v71
  v_mfma_f32_16x16x32_bf16 v[100:103], a[144:147], v[128:131], v[192:195]
  v_exp_f32 v76, v76
  v_mfma_f32_16x16x32_bf16 v[100:103], a[148:151], v[132:135], v[100:103]
  ds_read_b64_tr_b16 a[160:161], v216 offset:32768
  v_mfma_f32_16x16x32_bf16 v[100:103], a[152:155], v[136:139], v[100:103]
  v_exp_f32 v77, v77
  v_mfma_f32_16x16x32_bf16 v[100:103], a[156:159], v[140:143], v[100:103]
  ds_read_b64_tr_b16 a[162:163], v216 offset:36864
  v_cvt_pk_bf16_f32 v74, v76, v77
  v_mfma_f32_16x16x32_bf16 v[108:111], a[156:159], v[156:159], v[196:199]
  v_exp_f32 v78, v78
  v_mfma_f32_16x16x32_bf16 v[108:111], a[152:155], v[152:155], v[108:111]
  ds_read_b64_tr_b16 a[164:165], v216 offset:40960
  v_mfma_f32_16x16x32_bf16 v[108:111], a[148:151], v[148:151], v[108:111]
  v_exp_f32 v79, v79
  v_mfma_f32_16x16x32_bf16 v[108:111], a[144:147], v[144:147], v[108:111]
  ds_read_b64_tr_b16 a[166:167], v216 offset:45056
  v_cvt_pk_bf16_f32 v75, v78, v79
  v_mfma_f32_16x16x32_bf16 v[116:119], a[144:147], v[160:163], v[200:203]
  v_exp_f32 v84, v84
  v_mfma_f32_16x16x32_bf16 v[116:119], a[148:151], v[164:167], v[116:119]
  ds_read_b64_tr_b16 a[168:169], v217 offset:32768
  v_mfma_f32_16x16x32_bf16 v[116:119], a[152:155], v[168:171], v[116:119]
  v_exp_f32 v85, v85
  v_mfma_f32_16x16x32_bf16 v[116:119], a[156:159], v[172:175], v[116:119]
  ds_read_b64_tr_b16 a[170:171], v217 offset:36864
  v_cvt_pk_bf16_f32 v82, v84, v85
  v_mfma_f32_16x16x32_bf16 v[124:127], a[156:159], v[188:191], v[204:207]
  v_exp_f32 v86, v86
  v_mfma_f32_16x16x32_bf16 v[124:127], a[152:155], v[184:187], v[124:127]
  ds_read_b64_tr_b16 a[172:173], v217 offset:40960
  v_mfma_f32_16x16x32_bf16 v[124:127], a[148:151], v[180:183], v[124:127]
  v_exp_f32 v87, v87
  v_mfma_f32_16x16x32_bf16 v[124:127], a[144:147], v[176:179], v[124:127]
  ds_read_b64_tr_b16 a[174:175], v217 offset:45056
  v_cvt_pk_bf16_f32 v83, v86, v87
  v_mfma_f32_16x16x32_bf16 a[192:195], a[208:211], v[0:3], a[192:195]
  v_exp_f32 v92, v92
  v_mfma_f32_16x16x32_bf16 a[192:195], a[208:211], v[32:35], a[192:195]
  ds_read_b64_tr_b16 a[176:177], v218 offset:32768
  v_mfma_f32_16x16x32_bf16 a[196:199], a[208:211], v[8:11], a[196:199]
  v_exp_f32 v93, v93
  v_mfma_f32_16x16x32_bf16 a[196:199], a[208:211], v[40:43], a[196:199]
  ds_read_b64_tr_b16 a[178:179], v218 offset:36864
  v_cvt_pk_bf16_f32 v90, v92, v93
  v_mfma_f32_16x16x32_bf16 a[200:203], a[208:211], v[16:19], a[200:203]
  v_exp_f32 v94, v94
  v_mfma_f32_16x16x32_bf16 a[200:203], a[208:211], v[48:51], a[200:203]
  ds_read_b64_tr_b16 a[180:181], v218 offset:40960
  v_mfma_f32_16x16x32_bf16 a[204:207], a[208:211], v[24:27], a[204:207]
  s_waitcnt lgkmcnt(7)
  v_exp_f32 v95, v95
  v_mfma_f32_16x16x32_bf16 a[204:207], a[208:211], v[56:59], a[204:207]
  ds_read_b64_tr_b16 a[182:183], v218 offset:45056
  v_cvt_pk_bf16_f32 v91, v94, v95
  v_mfma_f32_16x16x32_bf16 a[0:3], a[160:163], v[0:3], a[0:3]
  v_exp_f32 v96, v96
  v_mfma_f32_16x16x32_bf16 a[0:3], a[164:167], v[32:35], a[0:3]
  ds_read_b64_tr_b16 a[184:185], v219 offset:32768
  v_mfma_f32_16x16x32_bf16 a[4:7], a[164:167], v[40:43], a[4:7]
  v_exp_f32 v97, v97
  v_mfma_f32_16x16x32_bf16 a[4:7], a[160:163], v[8:11], a[4:7]
  ds_read_b64_tr_b16 a[186:187], v219 offset:36864
  v_cvt_pk_bf16_f32 v96, v96, v97
  v_mfma_f32_16x16x32_bf16 a[8:11], a[160:163], v[16:19], a[8:11]
  v_exp_f32 v98, v98
  v_mfma_f32_16x16x32_bf16 a[8:11], a[164:167], v[48:51], a[8:11]
  ds_read_b64_tr_b16 a[188:189], v219 offset:40960
  v_mfma_f32_16x16x32_bf16 a[12:15], a[164:167], v[56:59], a[12:15]
  s_waitcnt lgkmcnt(7)
  v_exp_f32 v99, v99
  v_mfma_f32_16x16x32_bf16 a[12:15], a[160:163], v[24:27], a[12:15]
  ds_read_b64_tr_b16 a[190:191], v219 offset:45056
  v_cvt_pk_bf16_f32 v97, v98, v99
  v_mfma_f32_16x16x32_bf16 a[16:19], a[168:171], v[0:3], a[16:19]
  v_exp_f32 v104, v104
  v_mfma_f32_16x16x32_bf16 a[16:19], a[172:175], v[32:35], a[16:19]
  ds_read_b64_tr_b16 a[160:161], v220 offset:32768
  v_mfma_f32_16x16x32_bf16 a[20:23], a[172:175], v[40:43], a[20:23]
  v_exp_f32 v105, v105
  v_mfma_f32_16x16x32_bf16 a[20:23], a[168:171], v[8:11], a[20:23]
  ds_read_b64_tr_b16 a[162:163], v220 offset:36864
  v_cvt_pk_bf16_f32 v104, v104, v105
  v_mfma_f32_16x16x32_bf16 a[24:27], a[168:171], v[16:19], a[24:27]
  v_exp_f32 v106, v106
  v_mfma_f32_16x16x32_bf16 a[24:27], a[172:175], v[48:51], a[24:27]
  ds_read_b64_tr_b16 a[164:165], v220 offset:40960
  v_mfma_f32_16x16x32_bf16 a[28:31], a[172:175], v[56:59], a[28:31]
  s_waitcnt lgkmcnt(7)
  v_exp_f32 v107, v107
  v_mfma_f32_16x16x32_bf16 a[28:31], a[168:171], v[24:27], a[28:31]
  ds_read_b64_tr_b16 a[166:167], v220 offset:45056
  v_cvt_pk_bf16_f32 v105, v106, v107
  v_mfma_f32_16x16x32_bf16 a[32:35], a[176:179], v[0:3], a[32:35]
  v_exp_f32 v112, v112
  v_mfma_f32_16x16x32_bf16 a[32:35], a[180:183], v[32:35], a[32:35]
  ds_read_b64_tr_b16 a[168:169], v221 offset:32768
  v_mfma_f32_16x16x32_bf16 a[36:39], a[180:183], v[40:43], a[36:39]
  v_exp_f32 v113, v113
  v_mfma_f32_16x16x32_bf16 a[36:39], a[176:179], v[8:11], a[36:39]
  ds_read_b64_tr_b16 a[170:171], v221 offset:36864
  v_cvt_pk_bf16_f32 v112, v112, v113
  v_mfma_f32_16x16x32_bf16 a[40:43], a[176:179], v[16:19], a[40:43]
  v_exp_f32 v114, v114
  v_mfma_f32_16x16x32_bf16 a[40:43], a[180:183], v[48:51], a[40:43]
  ds_read_b64_tr_b16 a[172:173], v221 offset:40960
  v_mfma_f32_16x16x32_bf16 a[44:47], a[180:183], v[56:59], a[44:47]
  s_waitcnt lgkmcnt(7)
  v_exp_f32 v115, v115
  v_mfma_f32_16x16x32_bf16 a[44:47], a[176:179], v[24:27], a[44:47]
  ds_read_b64_tr_b16 a[174:175], v221 offset:45056
  v_cvt_pk_bf16_f32 v113, v114, v115
  v_mfma_f32_16x16x32_bf16 a[48:51], a[184:187], v[0:3], a[48:51]
  v_exp_f32 v120, v120
  v_mfma_f32_16x16x32_bf16 a[48:51], a[188:191], v[32:35], a[48:51]
  ds_read_b64_tr_b16 a[176:177], v222 offset:32768
  v_mfma_f32_16x16x32_bf16 a[52:55], a[188:191], v[40:43], a[52:55]
  v_exp_f32 v121, v121
  v_mfma_f32_16x16x32_bf16 a[52:55], a[184:187], v[8:11], a[52:55]
  ds_read_b64_tr_b16 a[178:179], v222 offset:36864
  v_cvt_pk_bf16_f32 v120, v120, v121
  v_mfma_f32_16x16x32_bf16 a[56:59], a[184:187], v[16:19], a[56:59]
  v_exp_f32 v122, v122
  v_mfma_f32_16x16x32_bf16 a[56:59], a[188:191], v[48:51], a[56:59]
  ds_read_b64_tr_b16 a[180:181], v222 offset:40960
  v_mfma_f32_16x16x32_bf16 a[60:63], a[188:191], v[56:59], a[60:63]
  s_waitcnt lgkmcnt(7)
  v_exp_f32 v123, v123
  v_mfma_f32_16x16x32_bf16 a[60:63], a[184:187], v[24:27], a[60:63]
  ds_read_b64_tr_b16 a[182:183], v222 offset:45056
  v_cvt_pk_bf16_f32 v121, v122, v123
  v_mfma_f32_16x16x32_bf16 a[64:67], a[160:163], v[0:3], a[64:67]
  v_exp_f32 v100, v100
  v_mfma_f32_16x16x32_bf16 a[64:67], a[164:167], v[32:35], a[64:67]
  ds_read_b64_tr_b16 a[184:185], v223 offset:32768
  v_mfma_f32_16x16x32_bf16 a[68:71], a[164:167], v[40:43], a[68:71]
  v_exp_f32 v101, v101
  v_mfma_f32_16x16x32_bf16 a[68:71], a[160:163], v[8:11], a[68:71]
  ds_read_b64_tr_b16 a[186:187], v223 offset:36864
  v_cvt_pk_bf16_f32 v98, v100, v101
  v_mfma_f32_16x16x32_bf16 a[72:75], a[160:163], v[16:19], a[72:75]
  v_exp_f32 v102, v102
  v_mfma_f32_16x16x32_bf16 a[72:75], a[164:167], v[48:51], a[72:75]
  ds_read_b64_tr_b16 a[188:189], v223 offset:40960
  v_mfma_f32_16x16x32_bf16 a[76:79], a[164:167], v[56:59], a[76:79]
  s_waitcnt lgkmcnt(7)
  v_exp_f32 v103, v103
  v_mfma_f32_16x16x32_bf16 a[76:79], a[160:163], v[24:27], a[76:79]
  ds_read_b64_tr_b16 a[190:191], v223 offset:45056
  v_cvt_pk_bf16_f32 v99, v102, v103
  v_mfma_f32_16x16x32_bf16 a[80:83], a[168:171], v[0:3], a[80:83]
  s_waitcnt vmcnt(10)
  v_exp_f32 v108, v108
  v_mfma_f32_16x16x32_bf16 a[80:83], a[172:175], v[32:35], a[80:83]
  v_mfma_f32_16x16x32_bf16 a[84:87], a[172:175], v[40:43], a[84:87]
  s_barrier
  v_exp_f32 v109, v109
  v_mfma_f32_16x16x32_bf16 a[84:87], a[168:171], v[8:11], a[84:87]
  ds_read_b128 a[128:131], v212 offset:0
  v_cvt_pk_bf16_f32 v106, v108, v109
  v_mfma_f32_16x16x32_bf16 a[88:91], a[168:171], v[16:19], a[88:91]
  v_exp_f32 v110, v110
  v_mfma_f32_16x16x32_bf16 a[88:91], a[172:175], v[48:51], a[88:91]
  ds_read_b128 a[132:135], v213 offset:0
  v_mfma_f32_16x16x32_bf16 a[92:95], a[172:175], v[56:59], a[92:95]
  s_waitcnt lgkmcnt(6)
  v_exp_f32 v111, v111
  v_mfma_f32_16x16x32_bf16 a[92:95], a[168:171], v[24:27], a[92:95]
  ds_read_b128 a[136:139], v214 offset:0
  v_cvt_pk_bf16_f32 v107, v110, v111
  v_mfma_f32_16x16x32_bf16 a[96:99], a[176:179], v[0:3], a[96:99]
  v_exp_f32 v116, v116
  v_mfma_f32_16x16x32_bf16 a[96:99], a[180:183], v[32:35], a[96:99]
  ds_read_b128 a[140:143], v215 offset:0
  v_mfma_f32_16x16x32_bf16 a[100:103], a[180:183], v[40:43], a[100:103]
  v_exp_f32 v117, v117
  v_mfma_f32_16x16x32_bf16 a[100:103], a[176:179], v[8:11], a[100:103]
  v_cvt_pk_bf16_f32 v114, v116, v117
  v_mfma_f32_16x16x32_bf16 a[104:107], a[176:179], v[16:19], a[104:107]
  v_exp_f32 v118, v118
  v_mfma_f32_16x16x32_bf16 a[104:107], a[180:183], v[48:51], a[104:107]
  v_mfma_f32_16x16x32_bf16 a[108:111], a[180:183], v[56:59], a[108:111]
  s_waitcnt lgkmcnt(4)
  v_exp_f32 v119, v119
  v_mfma_f32_16x16x32_bf16 a[108:111], a[176:179], v[24:27], a[108:111]
  v_cvt_pk_bf16_f32 v115, v118, v119
  v_mfma_f32_16x16x32_bf16 a[112:115], a[184:187], v[0:3], a[112:115]
  v_exp_f32 v124, v124
  v_mfma_f32_16x16x32_bf16 a[112:115], a[188:191], v[32:35], a[112:115]
  v_mfma_f32_16x16x32_bf16 a[116:119], a[188:191], v[40:43], a[116:119]
  v_exp_f32 v125, v125
  v_mfma_f32_16x16x32_bf16 a[116:119], a[184:187], v[8:11], a[116:119]
  v_cvt_pk_bf16_f32 v122, v124, v125
  v_mfma_f32_16x16x32_bf16 a[120:123], a[184:187], v[16:19], a[120:123]
  v_exp_f32 v126, v126
  v_mfma_f32_16x16x32_bf16 a[120:123], a[188:191], v[48:51], a[120:123]
  v_mfma_f32_16x16x32_bf16 a[124:127], a[188:191], v[56:59], a[124:127]
  s_waitcnt lgkmcnt(0)
  v_exp_f32 v127, v127
  v_mfma_f32_16x16x32_bf16 a[124:127], a[184:187], v[24:27], a[124:127]
  v_cvt_pk_bf16_f32 v123, v126, v127
  v_mfma_f32_16x16x32_bf16 v[0:3], a[128:131], v[128:131], v[192:195]
  s_add_u32 m0, s28, 81920
  v_mfma_f32_16x16x32_bf16 v[0:3], a[132:135], v[132:135], v[0:3]
  ds_read_b128 a[144:147], v212 offset:4096
  v_mfma_f32_16x16x32_bf16 v[0:3], a[136:139], v[136:139], v[0:3]
  buffer_load_dwordx4 v236, s[16:19], s29 offen offset:0 lds
  v_mfma_f32_16x16x32_bf16 v[0:3], a[140:143], v[140:143], v[0:3]
  ds_read_b128 a[148:151], v213 offset:4096
  v_mfma_f32_16x16x32_bf16 v[8:11], a[140:143], v[156:159], v[196:199]
  buffer_load_dwordx4 v237, s[16:19], s29 offen offset:1024 lds
  v_mfma_f32_16x16x32_bf16 v[8:11], a[136:139], v[152:155], v[8:11]
  ds_read_b128 a[152:155], v214 offset:4096
  v_mfma_f32_16x16x32_bf16 v[8:11], a[132:135], v[148:151], v[8:11]
  buffer_load_dwordx4 v236, s[16:19], s29 offen offset:2048 lds
  v_mfma_f32_16x16x32_bf16 v[8:11], a[128:131], v[144:147], v[8:11]
  ds_read_b128 a[156:159], v215 offset:4096
  v_mfma_f32_16x16x32_bf16 v[16:19], a[128:131], v[160:163], v[200:203]
  v_exp_f32 v0, v0
  v_mfma_f32_16x16x32_bf16 v[16:19], a[132:135], v[164:167], v[16:19]
  buffer_load_dwordx4 v237, s[16:19], s29 offen offset:3072 lds
  v_mfma_f32_16x16x32_bf16 v[16:19], a[136:139], v[168:171], v[16:19]
  s_add_u32 s29, s29, 16384
  v_exp_f32 v1, v1
  v_mfma_f32_16x16x32_bf16 v[16:19], a[140:143], v[172:175], v[16:19]
  v_cvt_pk_bf16_f32 v0, v0, v1
  v_mfma_f32_16x16x32_bf16 v[24:27], a[140:143], v[188:191], v[204:207]
  s_add_u32 m0, s28, 32768
  v_exp_f32 v2, v2
  v_mfma_f32_16x16x32_bf16 v[24:27], a[136:139], v[184:187], v[24:27]
  buffer_load_dwordx4 v232, s[12:15], s29 offen offset:0 lds
  v_mfma_f32_16x16x32_bf16 v[24:27], a[132:135], v[180:183], v[24:27]
  s_waitcnt lgkmcnt(0)
  v_exp_f32 v3, v3
  v_mfma_f32_16x16x32_bf16 v[24:27], a[128:131], v[176:179], v[24:27]
  v_cvt_pk_bf16_f32 v1, v2, v3
  v_mfma_f32_16x16x32_bf16 v[4:7], a[144:147], v[128:131], v[192:195]
  v_exp_f32 v8, v8
  v_mfma_f32_16x16x32_bf16 v[4:7], a[148:151], v[132:135], v[4:7]
  ds_read_b128 a[128:131], v212 offset:8192
  v_mfma_f32_16x16x32_bf16 v[4:7], a[152:155], v[136:139], v[4:7]
  v_exp_f32 v9, v9
  v_mfma_f32_16x16x32_bf16 v[4:7], a[156:159], v[140:143], v[4:7]
  ds_read_b128 a[132:135], v213 offset:8192
  v_cvt_pk_bf16_f32 v8, v8, v9
  v_mfma_f32_16x16x32_bf16 v[12:15], a[156:159], v[156:159], v[196:199]
  v_exp_f32 v10, v10
  v_mfma_f32_16x16x32_bf16 v[12:15], a[152:155], v[152:155], v[12:15]
  ds_read_b128 a[136:139], v214 offset:8192
  v_mfma_f32_16x16x32_bf16 v[12:15], a[148:151], v[148:151], v[12:15]
  v_exp_f32 v11, v11
  v_mfma_f32_16x16x32_bf16 v[12:15], a[144:147], v[144:147], v[12:15]
  ds_read_b128 a[140:143], v215 offset:8192
  v_cvt_pk_bf16_f32 v9, v10, v11
  v_mfma_f32_16x16x32_bf16 v[20:23], a[144:147], v[160:163], v[200:203]
  v_exp_f32 v16, v16
  v_mfma_f32_16x16x32_bf16 v[20:23], a[148:151], v[164:167], v[20:23]
  buffer_load_dwordx4 v233, s[12:15], s29 offen offset:1024 lds
  v_mfma_f32_16x16x32_bf16 v[20:23], a[152:155], v[168:171], v[20:23]
  v_exp_f32 v17, v17
  v_mfma_f32_16x16x32_bf16 v[20:23], a[156:159], v[172:175], v[20:23]
  v_cvt_pk_bf16_f32 v16, v16, v17
  v_mfma_f32_16x16x32_bf16 v[28:31], a[156:159], v[188:191], v[204:207]
  v_exp_f32 v18, v18
  v_mfma_f32_16x16x32_bf16 v[28:31], a[152:155], v[184:187], v[28:31]
  buffer_load_dwordx4 v234, s[12:15], s29 offen offset:2048 lds
  v_mfma_f32_16x16x32_bf16 v[28:31], a[148:151], v[180:183], v[28:31]
  s_waitcnt lgkmcnt(0)
  v_exp_f32 v19, v19
  v_mfma_f32_16x16x32_bf16 v[28:31], a[144:147], v[176:179], v[28:31]
  v_cvt_pk_bf16_f32 v17, v18, v19
  v_mfma_f32_16x16x32_bf16 v[32:35], a[128:131], v[128:131], v[192:195]
  v_exp_f32 v24, v24
  v_mfma_f32_16x16x32_bf16 v[32:35], a[132:135], v[132:135], v[32:35]
  ds_read_b128 a[144:147], v212 offset:12288
  v_mfma_f32_16x16x32_bf16 v[32:35], a[136:139], v[136:139], v[32:35]
  v_exp_f32 v25, v25
  v_mfma_f32_16x16x32_bf16 v[32:35], a[140:143], v[140:143], v[32:35]
  ds_read_b128 a[148:151], v213 offset:12288
  v_cvt_pk_bf16_f32 v24, v24, v25
  v_mfma_f32_16x16x32_bf16 v[40:43], a[140:143], v[156:159], v[196:199]
  v_exp_f32 v26, v26
  v_mfma_f32_16x16x32_bf16 v[40:43], a[136:139], v[152:155], v[40:43]
  ds_read_b128 a[152:155], v214 offset:12288
  v_mfma_f32_16x16x32_bf16 v[40:43], a[132:135], v[148:151], v[40:43]
  v_exp_f32 v27, v27
  v_mfma_f32_16x16x32_bf16 v[40:43], a[128:131], v[144:147], v[40:43]
  ds_read_b128 a[156:159], v215 offset:12288
  v_cvt_pk_bf16_f32 v25, v26, v27
  v_mfma_f32_16x16x32_bf16 v[48:51], a[128:131], v[160:163], v[200:203]
  v_exp_f32 v4, v4
  v_mfma_f32_16x16x32_bf16 v[48:51], a[132:135], v[164:167], v[48:51]
  buffer_load_dwordx4 v235, s[12:15], s29 offen offset:3072 lds
  v_mfma_f32_16x16x32_bf16 v[48:51], a[136:139], v[168:171], v[48:51]
  v_exp_f32 v5, v5
  v_mfma_f32_16x16x32_bf16 v[48:51], a[140:143], v[172:175], v[48:51]
  v_cvt_pk_bf16_f32 v2, v4, v5
  v_mfma_f32_16x16x32_bf16 v[56:59], a[140:143], v[188:191], v[204:207]
  v_exp_f32 v6, v6
  v_mfma_f32_16x16x32_bf16 v[56:59], a[136:139], v[184:187], v[56:59]
  s_add_u32 m0, s50, 2048
  v_mfma_f32_16x16x32_bf16 v[56:59], a[132:135], v[180:183], v[56:59]
  s_waitcnt lgkmcnt(0)
  v_exp_f32 v7, v7
  v_mfma_f32_16x16x32_bf16 v[56:59], a[128:131], v[176:179], v[56:59]
  buffer_load_dwordx4 v226, s[20:23], s35 offen lds
  v_cvt_pk_bf16_f32 v3, v6, v7
  v_mfma_f32_16x16x32_bf16 v[36:39], a[144:147], v[128:131], v[192:195]
  v_exp_f32 v12, v12
  v_mfma_f32_16x16x32_bf16 v[36:39], a[148:151], v[132:135], v[36:39]
  ds_read_b64_tr_b16 a[160:161], v216 offset:49152
  v_mfma_f32_16x16x32_bf16 v[36:39], a[152:155], v[136:139], v[36:39]
  v_exp_f32 v13, v13
  v_mfma_f32_16x16x32_bf16 v[36:39], a[156:159], v[140:143], v[36:39]
  ds_read_b64_tr_b16 a[162:163], v216 offset:53248
  v_cvt_pk_bf16_f32 v10, v12, v13
  v_mfma_f32_16x16x32_bf16 v[44:47], a[156:159], v[156:159], v[196:199]
  v_exp_f32 v14, v14
  v_mfma_f32_16x16x32_bf16 v[44:47], a[152:155], v[152:155], v[44:47]
  ds_read_b64_tr_b16 a[164:165], v216 offset:57344
  v_mfma_f32_16x16x32_bf16 v[44:47], a[148:151], v[148:151], v[44:47]
  v_exp_f32 v15, v15
  v_mfma_f32_16x16x32_bf16 v[44:47], a[144:147], v[144:147], v[44:47]
  ds_read_b64_tr_b16 a[166:167], v216 offset:61440
  v_cvt_pk_bf16_f32 v11, v14, v15
  v_mfma_f32_16x16x32_bf16 v[52:55], a[144:147], v[160:163], v[200:203]
  v_exp_f32 v20, v20
  v_mfma_f32_16x16x32_bf16 v[52:55], a[148:151], v[164:167], v[52:55]
  ds_read_b64_tr_b16 a[168:169], v217 offset:49152
  v_mfma_f32_16x16x32_bf16 v[52:55], a[152:155], v[168:171], v[52:55]
  v_exp_f32 v21, v21
  v_mfma_f32_16x16x32_bf16 v[52:55], a[156:159], v[172:175], v[52:55]
  ds_read_b64_tr_b16 a[170:171], v217 offset:53248
  v_cvt_pk_bf16_f32 v18, v20, v21
  v_mfma_f32_16x16x32_bf16 v[60:63], a[156:159], v[188:191], v[204:207]
  v_exp_f32 v22, v22
  v_mfma_f32_16x16x32_bf16 v[60:63], a[152:155], v[184:187], v[60:63]
  ds_read_b64_tr_b16 a[172:173], v217 offset:57344
  v_mfma_f32_16x16x32_bf16 v[60:63], a[148:151], v[180:183], v[60:63]
  v_exp_f32 v23, v23
  v_mfma_f32_16x16x32_bf16 v[60:63], a[144:147], v[176:179], v[60:63]
  ds_read_b64_tr_b16 a[174:175], v217 offset:61440
  v_cvt_pk_bf16_f32 v19, v22, v23
  v_mfma_f32_16x16x32_bf16 a[192:195], a[208:211], v[64:67], a[192:195]
  v_exp_f32 v28, v28
  v_mfma_f32_16x16x32_bf16 a[192:195], a[208:211], v[96:99], a[192:195]
  ds_read_b64_tr_b16 a[176:177], v218 offset:49152
  v_mfma_f32_16x16x32_bf16 a[196:199], a[208:211], v[72:75], a[196:199]
  v_exp_f32 v29, v29
  v_mfma_f32_16x16x32_bf16 a[196:199], a[208:211], v[104:107], a[196:199]
  ds_read_b64_tr_b16 a[178:179], v218 offset:53248
  v_cvt_pk_bf16_f32 v26, v28, v29
  v_mfma_f32_16x16x32_bf16 a[200:203], a[208:211], v[80:83], a[200:203]
  v_exp_f32 v30, v30
  v_mfma_f32_16x16x32_bf16 a[200:203], a[208:211], v[112:115], a[200:203]
  ds_read_b64_tr_b16 a[180:181], v218 offset:57344
  v_mfma_f32_16x16x32_bf16 a[204:207], a[208:211], v[88:91], a[204:207]
  s_waitcnt lgkmcnt(7)
  v_exp_f32 v31, v31
  v_mfma_f32_16x16x32_bf16 a[204:207], a[208:211], v[120:123], a[204:207]
  ds_read_b64_tr_b16 a[182:183], v218 offset:61440
  v_cvt_pk_bf16_f32 v27, v30, v31
  v_mfma_f32_16x16x32_bf16 a[0:3], a[160:163], v[64:67], a[0:3]
  v_exp_f32 v32, v32
  v_mfma_f32_16x16x32_bf16 a[0:3], a[164:167], v[96:99], a[0:3]
  ds_read_b64_tr_b16 a[184:185], v219 offset:49152
  v_mfma_f32_16x16x32_bf16 a[4:7], a[164:167], v[104:107], a[4:7]
  v_exp_f32 v33, v33
  v_mfma_f32_16x16x32_bf16 a[4:7], a[160:163], v[72:75], a[4:7]
  ds_read_b64_tr_b16 a[186:187], v219 offset:53248
  v_cvt_pk_bf16_f32 v32, v32, v33
  v_mfma_f32_16x16x32_bf16 a[8:11], a[160:163], v[80:83], a[8:11]
  v_exp_f32 v34, v34
  v_mfma_f32_16x16x32_bf16 a[8:11], a[164:167], v[112:115], a[8:11]
  ds_read_b64_tr_b16 a[188:189], v219 offset:57344
  v_mfma_f32_16x16x32_bf16 a[12:15], a[164:167], v[120:123], a[12:15]
  s_waitcnt lgkmcnt(7)
  v_exp_f32 v35, v35
  v_mfma_f32_16x16x32_bf16 a[12:15], a[160:163], v[88:91], a[12:15]
  ds_read_b64_tr_b16 a[190:191], v219 offset:61440
  v_cvt_pk_bf16_f32 v33, v34, v35
  v_mfma_f32_16x16x32_bf16 a[16:19], a[168:171], v[64:67], a[16:19]
  v_exp_f32 v40, v40
  v_mfma_f32_16x16x32_bf16 a[16:19], a[172:175], v[96:99], a[16:19]
  ds_read_b64_tr_b16 a[160:161], v220 offset:49152
  v_mfma_f32_16x16x32_bf16 a[20:23], a[172:175], v[104:107], a[20:23]
  v_exp_f32 v41, v41
  v_mfma_f32_16x16x32_bf16 a[20:23], a[168:171], v[72:75], a[20:23]
  ds_read_b64_tr_b16 a[162:163], v220 offset:53248
  v_cvt_pk_bf16_f32 v40, v40, v41
  v_mfma_f32_16x16x32_bf16 a[24:27], a[168:171], v[80:83], a[24:27]
  v_exp_f32 v42, v42
  v_mfma_f32_16x16x32_bf16 a[24:27], a[172:175], v[112:115], a[24:27]
  ds_read_b64_tr_b16 a[164:165], v220 offset:57344
  v_mfma_f32_16x16x32_bf16 a[28:31], a[172:175], v[120:123], a[28:31]
  s_waitcnt lgkmcnt(7)
  v_exp_f32 v43, v43
  v_mfma_f32_16x16x32_bf16 a[28:31], a[168:171], v[88:91], a[28:31]
  ds_read_b64_tr_b16 a[166:167], v220 offset:61440
  v_cvt_pk_bf16_f32 v41, v42, v43
  v_mfma_f32_16x16x32_bf16 a[32:35], a[176:179], v[64:67], a[32:35]
  v_exp_f32 v48, v48
  v_mfma_f32_16x16x32_bf16 a[32:35], a[180:183], v[96:99], a[32:35]
  ds_read_b64_tr_b16 a[168:169], v221 offset:49152
  v_mfma_f32_16x16x32_bf16 a[36:39], a[180:183], v[104:107], a[36:39]
  v_exp_f32 v49, v49
  v_mfma_f32_16x16x32_bf16 a[36:39], a[176:179], v[72:75], a[36:39]
  ds_read_b64_tr_b16 a[170:171], v221 offset:53248
  v_cvt_pk_bf16_f32 v48, v48, v49
  v_mfma_f32_16x16x32_bf16 a[40:43], a[176:179], v[80:83], a[40:43]
  v_exp_f32 v50, v50
  v_mfma_f32_16x16x32_bf16 a[40:43], a[180:183], v[112:115], a[40:43]
  ds_read_b64_tr_b16 a[172:173], v221 offset:57344
  v_mfma_f32_16x16x32_bf16 a[44:47], a[180:183], v[120:123], a[44:47]
  s_waitcnt lgkmcnt(7)
  v_exp_f32 v51, v51
  v_mfma_f32_16x16x32_bf16 a[44:47], a[176:179], v[88:91], a[44:47]
  ds_read_b64_tr_b16 a[174:175], v221 offset:61440
  v_cvt_pk_bf16_f32 v49, v50, v51
  v_mfma_f32_16x16x32_bf16 a[48:51], a[184:187], v[64:67], a[48:51]
  v_exp_f32 v56, v56
  v_mfma_f32_16x16x32_bf16 a[48:51], a[188:191], v[96:99], a[48:51]
  ds_read_b64_tr_b16 a[176:177], v222 offset:49152
  v_mfma_f32_16x16x32_bf16 a[52:55], a[188:191], v[104:107], a[52:55]
  v_exp_f32 v57, v57
  v_mfma_f32_16x16x32_bf16 a[52:55], a[184:187], v[72:75], a[52:55]
  ds_read_b64_tr_b16 a[178:179], v222 offset:53248
  v_cvt_pk_bf16_f32 v56, v56, v57
  v_mfma_f32_16x16x32_bf16 a[56:59], a[184:187], v[80:83], a[56:59]
  v_exp_f32 v58, v58
  v_mfma_f32_16x16x32_bf16 a[56:59], a[188:191], v[112:115], a[56:59]
  ds_read_b64_tr_b16 a[180:181], v222 offset:57344
  v_mfma_f32_16x16x32_bf16 a[60:63], a[188:191], v[120:123], a[60:63]
  s_waitcnt lgkmcnt(7)
  v_exp_f32 v59, v59
  v_mfma_f32_16x16x32_bf16 a[60:63], a[184:187], v[88:91], a[60:63]
  ds_read_b64_tr_b16 a[182:183], v222 offset:61440
  v_cvt_pk_bf16_f32 v57, v58, v59
  v_mfma_f32_16x16x32_bf16 a[64:67], a[160:163], v[64:67], a[64:67]
  v_exp_f32 v36, v36
  v_mfma_f32_16x16x32_bf16 a[64:67], a[164:167], v[96:99], a[64:67]
  ds_read_b64_tr_b16 a[184:185], v223 offset:49152
  v_mfma_f32_16x16x32_bf16 a[68:71], a[164:167], v[104:107], a[68:71]
  v_exp_f32 v37, v37
  v_mfma_f32_16x16x32_bf16 a[68:71], a[160:163], v[72:75], a[68:71]
  ds_read_b64_tr_b16 a[186:187], v223 offset:53248
  v_cvt_pk_bf16_f32 v34, v36, v37
  v_mfma_f32_16x16x32_bf16 a[72:75], a[160:163], v[80:83], a[72:75]
  v_exp_f32 v38, v38
  v_mfma_f32_16x16x32_bf16 a[72:75], a[164:167], v[112:115], a[72:75]
  ds_read_b64_tr_b16 a[188:189], v223 offset:57344
  v_mfma_f32_16x16x32_bf16 a[76:79], a[164:167], v[120:123], a[76:79]
  s_waitcnt lgkmcnt(7)
  v_exp_f32 v39, v39
  v_mfma_f32_16x16x32_bf16 a[76:79], a[160:163], v[88:91], a[76:79]
  ds_read_b64_tr_b16 a[190:191], v223 offset:61440
  v_cvt_pk_bf16_f32 v35, v38, v39
  v_mfma_f32_16x16x32_bf16 a[80:83], a[168:171], v[64:67], a[80:83]
  s_waitcnt vmcnt(10)
  v_exp_f32 v44, v44
  v_mfma_f32_16x16x32_bf16 a[80:83], a[172:175], v[96:99], a[80:83]
  v_mfma_f32_16x16x32_bf16 a[84:87], a[172:175], v[104:107], a[84:87]
  s_barrier
  v_exp_f32 v45, v45
  v_mfma_f32_16x16x32_bf16 a[84:87], a[168:171], v[72:75], a[84:87]
  ds_read_b128 a[128:131], v212 offset:16384
  v_cvt_pk_bf16_f32 v42, v44, v45
  v_mfma_f32_16x16x32_bf16 a[88:91], a[168:171], v[80:83], a[88:91]
  v_exp_f32 v46, v46
  v_mfma_f32_16x16x32_bf16 a[88:91], a[172:175], v[112:115], a[88:91]
  ds_read_b128 a[132:135], v213 offset:16384
  v_mfma_f32_16x16x32_bf16 a[92:95], a[172:175], v[120:123], a[92:95]
  s_waitcnt lgkmcnt(6)
  v_exp_f32 v47, v47
  v_mfma_f32_16x16x32_bf16 a[92:95], a[168:171], v[88:91], a[92:95]
  ds_read_b128 a[136:139], v214 offset:16384
  v_cvt_pk_bf16_f32 v43, v46, v47
  v_mfma_f32_16x16x32_bf16 a[96:99], a[176:179], v[64:67], a[96:99]
  v_exp_f32 v52, v52
  v_mfma_f32_16x16x32_bf16 a[96:99], a[180:183], v[96:99], a[96:99]
  ds_read_b128 a[140:143], v215 offset:16384
  v_mfma_f32_16x16x32_bf16 a[100:103], a[180:183], v[104:107], a[100:103]
  v_exp_f32 v53, v53
  v_mfma_f32_16x16x32_bf16 a[100:103], a[176:179], v[72:75], a[100:103]
  v_cvt_pk_bf16_f32 v50, v52, v53
  v_mfma_f32_16x16x32_bf16 a[104:107], a[176:179], v[80:83], a[104:107]
  v_exp_f32 v54, v54
  v_mfma_f32_16x16x32_bf16 a[104:107], a[180:183], v[112:115], a[104:107]
  v_mfma_f32_16x16x32_bf16 a[108:111], a[180:183], v[120:123], a[108:111]
  s_waitcnt lgkmcnt(4)
  v_exp_f32 v55, v55
  v_mfma_f32_16x16x32_bf16 a[108:111], a[176:179], v[88:91], a[108:111]
  v_cvt_pk_bf16_f32 v51, v54, v55
  v_mfma_f32_16x16x32_bf16 a[112:115], a[184:187], v[64:67], a[112:115]
  v_exp_f32 v60, v60
  v_mfma_f32_16x16x32_bf16 a[112:115], a[188:191], v[96:99], a[112:115]
  v_mfma_f32_16x16x32_bf16 a[116:119], a[188:191], v[104:107], a[116:119]
  v_exp_f32 v61, v61
  v_mfma_f32_16x16x32_bf16 a[116:119], a[184:187], v[72:75], a[116:119]
  v_cvt_pk_bf16_f32 v58, v60, v61
  v_mfma_f32_16x16x32_bf16 a[120:123], a[184:187], v[80:83], a[120:123]
  v_exp_f32 v62, v62
  v_mfma_f32_16x16x32_bf16 a[120:123], a[188:191], v[112:115], a[120:123]
  v_mfma_f32_16x16x32_bf16 a[124:127], a[188:191], v[120:123], a[124:127]
  s_waitcnt lgkmcnt(0)
  v_exp_f32 v63, v63
  v_mfma_f32_16x16x32_bf16 a[124:127], a[184:187], v[88:91], a[124:127]
  v_cvt_pk_bf16_f32 v59, v62, v63
  v_mfma_f32_16x16x32_bf16 v[64:67], a[128:131], v[128:131], v[192:195]
  s_add_u32 m0, s28, 98304
  v_mfma_f32_16x16x32_bf16 v[64:67], a[132:135], v[132:135], v[64:67]
  ds_read_b128 a[144:147], v212 offset:20480
  v_mfma_f32_16x16x32_bf16 v[64:67], a[136:139], v[136:139], v[64:67]
  buffer_load_dwordx4 v236, s[16:19], s29 offen offset:0 lds
  v_mfma_f32_16x16x32_bf16 v[64:67], a[140:143], v[140:143], v[64:67]
  ds_read_b128 a[148:151], v213 offset:20480
  v_mfma_f32_16x16x32_bf16 v[72:75], a[140:143], v[156:159], v[196:199]
  buffer_load_dwordx4 v237, s[16:19], s29 offen offset:1024 lds
  v_mfma_f32_16x16x32_bf16 v[72:75], a[136:139], v[152:155], v[72:75]
  ds_read_b128 a[152:155], v214 offset:20480
  v_mfma_f32_16x16x32_bf16 v[72:75], a[132:135], v[148:151], v[72:75]
  buffer_load_dwordx4 v236, s[16:19], s29 offen offset:2048 lds
  v_mfma_f32_16x16x32_bf16 v[72:75], a[128:131], v[144:147], v[72:75]
  ds_read_b128 a[156:159], v215 offset:20480
  v_mfma_f32_16x16x32_bf16 v[80:83], a[128:131], v[160:163], v[200:203]
  v_exp_f32 v64, v64
  v_mfma_f32_16x16x32_bf16 v[80:83], a[132:135], v[164:167], v[80:83]
  buffer_load_dwordx4 v237, s[16:19], s29 offen offset:3072 lds
  v_mfma_f32_16x16x32_bf16 v[80:83], a[136:139], v[168:171], v[80:83]
  s_add_u32 s29, s29, 16384
  v_exp_f32 v65, v65
  v_mfma_f32_16x16x32_bf16 v[80:83], a[140:143], v[172:175], v[80:83]
  v_cvt_pk_bf16_f32 v64, v64, v65
  v_mfma_f32_16x16x32_bf16 v[88:91], a[140:143], v[188:191], v[204:207]
  s_add_u32 m0, s28, 49152
  v_exp_f32 v66, v66
  v_mfma_f32_16x16x32_bf16 v[88:91], a[136:139], v[184:187], v[88:91]
  buffer_load_dwordx4 v232, s[12:15], s29 offen offset:0 lds
  v_mfma_f32_16x16x32_bf16 v[88:91], a[132:135], v[180:183], v[88:91]
  s_waitcnt lgkmcnt(0)
  v_exp_f32 v67, v67
  v_mfma_f32_16x16x32_bf16 v[88:91], a[128:131], v[176:179], v[88:91]
  v_cvt_pk_bf16_f32 v65, v66, v67
  v_mfma_f32_16x16x32_bf16 v[68:71], a[144:147], v[128:131], v[192:195]
  v_exp_f32 v72, v72
  v_mfma_f32_16x16x32_bf16 v[68:71], a[148:151], v[132:135], v[68:71]
  ds_read_b128 a[128:131], v212 offset:24576
  v_mfma_f32_16x16x32_bf16 v[68:71], a[152:155], v[136:139], v[68:71]
  v_exp_f32 v73, v73
  v_mfma_f32_16x16x32_bf16 v[68:71], a[156:159], v[140:143], v[68:71]
  ds_read_b128 a[132:135], v213 offset:24576
  v_cvt_pk_bf16_f32 v72, v72, v73
  v_mfma_f32_16x16x32_bf16 v[76:79], a[156:159], v[156:159], v[196:199]
  v_exp_f32 v74, v74
  v_mfma_f32_16x16x32_bf16 v[76:79], a[152:155], v[152:155], v[76:79]
  ds_read_b128 a[136:139], v214 offset:24576
  v_mfma_f32_16x16x32_bf16 v[76:79], a[148:151], v[148:151], v[76:79]
  v_exp_f32 v75, v75
  v_mfma_f32_16x16x32_bf16 v[76:79], a[144:147], v[144:147], v[76:79]
  ds_read_b128 a[140:143], v215 offset:24576
  v_cvt_pk_bf16_f32 v73, v74, v75
  v_mfma_f32_16x16x32_bf16 v[84:87], a[144:147], v[160:163], v[200:203]
  v_exp_f32 v80, v80
  v_mfma_f32_16x16x32_bf16 v[84:87], a[148:151], v[164:167], v[84:87]
  buffer_load_dwordx4 v233, s[12:15], s29 offen offset:1024 lds
  v_mfma_f32_16x16x32_bf16 v[84:87], a[152:155], v[168:171], v[84:87]
  v_exp_f32 v81, v81
  v_mfma_f32_16x16x32_bf16 v[84:87], a[156:159], v[172:175], v[84:87]
  v_cvt_pk_bf16_f32 v80, v80, v81
  v_mfma_f32_16x16x32_bf16 v[92:95], a[156:159], v[188:191], v[204:207]
  v_exp_f32 v82, v82
  v_mfma_f32_16x16x32_bf16 v[92:95], a[152:155], v[184:187], v[92:95]
  buffer_load_dwordx4 v234, s[12:15], s29 offen offset:2048 lds
  v_mfma_f32_16x16x32_bf16 v[92:95], a[148:151], v[180:183], v[92:95]
  s_waitcnt lgkmcnt(0)
  v_exp_f32 v83, v83
  v_mfma_f32_16x16x32_bf16 v[92:95], a[144:147], v[176:179], v[92:95]
  v_cvt_pk_bf16_f32 v81, v82, v83
  v_mfma_f32_16x16x32_bf16 v[96:99], a[128:131], v[128:131], v[192:195]
  v_exp_f32 v88, v88
  v_mfma_f32_16x16x32_bf16 v[96:99], a[132:135], v[132:135], v[96:99]
  ds_read_b128 a[144:147], v212 offset:28672
  v_mfma_f32_16x16x32_bf16 v[96:99], a[136:139], v[136:139], v[96:99]
  v_exp_f32 v89, v89
  v_mfma_f32_16x16x32_bf16 v[96:99], a[140:143], v[140:143], v[96:99]
  ds_read_b128 a[148:151], v213 offset:28672
  v_cvt_pk_bf16_f32 v88, v88, v89
  v_mfma_f32_16x16x32_bf16 v[104:107], a[140:143], v[156:159], v[196:199]
  v_exp_f32 v90, v90
  v_mfma_f32_16x16x32_bf16 v[104:107], a[136:139], v[152:155], v[104:107]
  ds_read_b128 a[152:155], v214 offset:28672
  v_mfma_f32_16x16x32_bf16 v[104:107], a[132:135], v[148:151], v[104:107]
  v_exp_f32 v91, v91
  v_mfma_f32_16x16x32_bf16 v[104:107], a[128:131], v[144:147], v[104:107]
  ds_read_b128 a[156:159], v215 offset:28672
  v_cvt_pk_bf16_f32 v89, v90, v91
  v_mfma_f32_16x16x32_bf16 v[112:115], a[128:131], v[160:163], v[200:203]
  v_exp_f32 v68, v68
  v_mfma_f32_16x16x32_bf16 v[112:115], a[132:135], v[164:167], v[112:115]
  buffer_load_dwordx4 v235, s[12:15], s29 offen offset:3072 lds
  v_mfma_f32_16x16x32_bf16 v[112:115], a[136:139], v[168:171], v[112:115]
  v_exp_f32 v69, v69
  v_mfma_f32_16x16x32_bf16 v[112:115], a[140:143], v[172:175], v[112:115]
  v_cvt_pk_bf16_f32 v66, v68, v69
  v_mfma_f32_16x16x32_bf16 v[120:123], a[140:143], v[188:191], v[204:207]
  v_exp_f32 v70, v70
  v_mfma_f32_16x16x32_bf16 v[120:123], a[136:139], v[184:187], v[120:123]
  s_add_u32 m0, s50, 5120
  v_mfma_f32_16x16x32_bf16 v[120:123], a[132:135], v[180:183], v[120:123]
  s_waitcnt lgkmcnt(0)
  v_exp_f32 v71, v71
  v_mfma_f32_16x16x32_bf16 v[120:123], a[128:131], v[176:179], v[120:123]
  buffer_load_dwordx4 v226, s[44:47], s35 offen lds
  s_add_u32 s35, s35, 221184
  v_cvt_pk_bf16_f32 v67, v70, v71
  v_mfma_f32_16x16x32_bf16 v[100:103], a[144:147], v[128:131], v[192:195]
  v_exp_f32 v76, v76
  v_mfma_f32_16x16x32_bf16 v[100:103], a[148:151], v[132:135], v[100:103]
  ds_read_b64_tr_b16 a[160:161], v216 offset:0
  v_mfma_f32_16x16x32_bf16 v[100:103], a[152:155], v[136:139], v[100:103]
  v_exp_f32 v77, v77
  v_mfma_f32_16x16x32_bf16 v[100:103], a[156:159], v[140:143], v[100:103]
  ds_read_b64_tr_b16 a[162:163], v216 offset:4096
  v_cvt_pk_bf16_f32 v74, v76, v77
  v_mfma_f32_16x16x32_bf16 v[108:111], a[156:159], v[156:159], v[196:199]
  v_exp_f32 v78, v78
  v_mfma_f32_16x16x32_bf16 v[108:111], a[152:155], v[152:155], v[108:111]
  ds_read_b64_tr_b16 a[164:165], v216 offset:8192
  v_mfma_f32_16x16x32_bf16 v[108:111], a[148:151], v[148:151], v[108:111]
  v_exp_f32 v79, v79
  v_mfma_f32_16x16x32_bf16 v[108:111], a[144:147], v[144:147], v[108:111]
  ds_read_b64_tr_b16 a[166:167], v216 offset:12288
  v_cvt_pk_bf16_f32 v75, v78, v79
  v_mfma_f32_16x16x32_bf16 v[116:119], a[144:147], v[160:163], v[200:203]
  v_exp_f32 v84, v84
  v_mfma_f32_16x16x32_bf16 v[116:119], a[148:151], v[164:167], v[116:119]
  ds_read_b64_tr_b16 a[168:169], v217 offset:0
  v_mfma_f32_16x16x32_bf16 v[116:119], a[152:155], v[168:171], v[116:119]
  v_exp_f32 v85, v85
  v_mfma_f32_16x16x32_bf16 v[116:119], a[156:159], v[172:175], v[116:119]
  ds_read_b64_tr_b16 a[170:171], v217 offset:4096
  v_cvt_pk_bf16_f32 v82, v84, v85
  v_mfma_f32_16x16x32_bf16 v[124:127], a[156:159], v[188:191], v[204:207]
  v_exp_f32 v86, v86
  v_mfma_f32_16x16x32_bf16 v[124:127], a[152:155], v[184:187], v[124:127]
  ds_read_b64_tr_b16 a[172:173], v217 offset:8192
  v_mfma_f32_16x16x32_bf16 v[124:127], a[148:151], v[180:183], v[124:127]
  v_exp_f32 v87, v87
  v_mfma_f32_16x16x32_bf16 v[124:127], a[144:147], v[176:179], v[124:127]
  ds_read_b64_tr_b16 a[174:175], v217 offset:12288
  v_cvt_pk_bf16_f32 v83, v86, v87
  v_mfma_f32_16x16x32_bf16 a[192:195], a[208:211], v[0:3], a[192:195]
  v_exp_f32 v92, v92
  v_mfma_f32_16x16x32_bf16 a[192:195], a[208:211], v[32:35], a[192:195]
  ds_read_b64_tr_b16 a[176:177], v218 offset:0
  v_mfma_f32_16x16x32_bf16 a[196:199], a[208:211], v[8:11], a[196:199]
  v_exp_f32 v93, v93
  v_mfma_f32_16x16x32_bf16 a[196:199], a[208:211], v[40:43], a[196:199]
  ds_read_b64_tr_b16 a[178:179], v218 offset:4096
  v_cvt_pk_bf16_f32 v90, v92, v93
  v_mfma_f32_16x16x32_bf16 a[200:203], a[208:211], v[16:19], a[200:203]
  v_exp_f32 v94, v94
  v_mfma_f32_16x16x32_bf16 a[200:203], a[208:211], v[48:51], a[200:203]
  ds_read_b64_tr_b16 a[180:181], v218 offset:8192
  v_mfma_f32_16x16x32_bf16 a[204:207], a[208:211], v[24:27], a[204:207]
  s_waitcnt lgkmcnt(7)
  v_exp_f32 v95, v95
  v_mfma_f32_16x16x32_bf16 a[204:207], a[208:211], v[56:59], a[204:207]
  ds_read_b64_tr_b16 a[182:183], v218 offset:12288
  v_cvt_pk_bf16_f32 v91, v94, v95
  v_mfma_f32_16x16x32_bf16 a[0:3], a[160:163], v[0:3], a[0:3]
  v_exp_f32 v96, v96
  v_mfma_f32_16x16x32_bf16 a[0:3], a[164:167], v[32:35], a[0:3]
  ds_read_b64_tr_b16 a[184:185], v219 offset:0
  v_mfma_f32_16x16x32_bf16 a[4:7], a[164:167], v[40:43], a[4:7]
  v_exp_f32 v97, v97
  v_mfma_f32_16x16x32_bf16 a[4:7], a[160:163], v[8:11], a[4:7]
  ds_read_b64_tr_b16 a[186:187], v219 offset:4096
  v_cvt_pk_bf16_f32 v96, v96, v97
  v_mfma_f32_16x16x32_bf16 a[8:11], a[160:163], v[16:19], a[8:11]
  v_exp_f32 v98, v98
  v_mfma_f32_16x16x32_bf16 a[8:11], a[164:167], v[48:51], a[8:11]
  ds_read_b64_tr_b16 a[188:189], v219 offset:8192
  v_mfma_f32_16x16x32_bf16 a[12:15], a[164:167], v[56:59], a[12:15]
  s_waitcnt lgkmcnt(7)
  v_exp_f32 v99, v99
  v_mfma_f32_16x16x32_bf16 a[12:15], a[160:163], v[24:27], a[12:15]
  ds_read_b64_tr_b16 a[190:191], v219 offset:12288
  v_cvt_pk_bf16_f32 v97, v98, v99
  v_mfma_f32_16x16x32_bf16 a[16:19], a[168:171], v[0:3], a[16:19]
  v_exp_f32 v104, v104
  v_mfma_f32_16x16x32_bf16 a[16:19], a[172:175], v[32:35], a[16:19]
  ds_read_b64_tr_b16 a[160:161], v220 offset:0
  v_mfma_f32_16x16x32_bf16 a[20:23], a[172:175], v[40:43], a[20:23]
  v_exp_f32 v105, v105
  v_mfma_f32_16x16x32_bf16 a[20:23], a[168:171], v[8:11], a[20:23]
  ds_read_b64_tr_b16 a[162:163], v220 offset:4096
  v_cvt_pk_bf16_f32 v104, v104, v105
  v_mfma_f32_16x16x32_bf16 a[24:27], a[168:171], v[16:19], a[24:27]
  v_exp_f32 v106, v106
  v_mfma_f32_16x16x32_bf16 a[24:27], a[172:175], v[48:51], a[24:27]
  ds_read_b64_tr_b16 a[164:165], v220 offset:8192
  v_mfma_f32_16x16x32_bf16 a[28:31], a[172:175], v[56:59], a[28:31]
  s_waitcnt lgkmcnt(7)
  v_exp_f32 v107, v107
  v_mfma_f32_16x16x32_bf16 a[28:31], a[168:171], v[24:27], a[28:31]
  ds_read_b64_tr_b16 a[166:167], v220 offset:12288
  v_cvt_pk_bf16_f32 v105, v106, v107
  v_mfma_f32_16x16x32_bf16 a[32:35], a[176:179], v[0:3], a[32:35]
  v_exp_f32 v112, v112
  v_mfma_f32_16x16x32_bf16 a[32:35], a[180:183], v[32:35], a[32:35]
  ds_read_b64_tr_b16 a[168:169], v221 offset:0
  v_mfma_f32_16x16x32_bf16 a[36:39], a[180:183], v[40:43], a[36:39]
  v_exp_f32 v113, v113
  v_mfma_f32_16x16x32_bf16 a[36:39], a[176:179], v[8:11], a[36:39]
  ds_read_b64_tr_b16 a[170:171], v221 offset:4096
  v_cvt_pk_bf16_f32 v112, v112, v113
  v_mfma_f32_16x16x32_bf16 a[40:43], a[176:179], v[16:19], a[40:43]
  v_exp_f32 v114, v114
  v_mfma_f32_16x16x32_bf16 a[40:43], a[180:183], v[48:51], a[40:43]
  ds_read_b64_tr_b16 a[172:173], v221 offset:8192
  v_mfma_f32_16x16x32_bf16 a[44:47], a[180:183], v[56:59], a[44:47]
  s_waitcnt lgkmcnt(7)
  v_exp_f32 v115, v115
  v_mfma_f32_16x16x32_bf16 a[44:47], a[176:179], v[24:27], a[44:47]
  ds_read_b64_tr_b16 a[174:175], v221 offset:12288
  v_cvt_pk_bf16_f32 v113, v114, v115
  v_mfma_f32_16x16x32_bf16 a[48:51], a[184:187], v[0:3], a[48:51]
  v_exp_f32 v120, v120
  v_mfma_f32_16x16x32_bf16 a[48:51], a[188:191], v[32:35], a[48:51]
  ds_read_b64_tr_b16 a[176:177], v222 offset:0
  v_mfma_f32_16x16x32_bf16 a[52:55], a[188:191], v[40:43], a[52:55]
  v_exp_f32 v121, v121
  v_mfma_f32_16x16x32_bf16 a[52:55], a[184:187], v[8:11], a[52:55]
  ds_read_b64_tr_b16 a[178:179], v222 offset:4096
  v_cvt_pk_bf16_f32 v120, v120, v121
  v_mfma_f32_16x16x32_bf16 a[56:59], a[184:187], v[16:19], a[56:59]
  v_exp_f32 v122, v122
  v_mfma_f32_16x16x32_bf16 a[56:59], a[188:191], v[48:51], a[56:59]
  ds_read_b64_tr_b16 a[180:181], v222 offset:8192
  v_mfma_f32_16x16x32_bf16 a[60:63], a[188:191], v[56:59], a[60:63]
  s_waitcnt lgkmcnt(7)
  v_exp_f32 v123, v123
  v_mfma_f32_16x16x32_bf16 a[60:63], a[184:187], v[24:27], a[60:63]
  ds_read_b64_tr_b16 a[182:183], v222 offset:12288
  v_cvt_pk_bf16_f32 v121, v122, v123
  v_mfma_f32_16x16x32_bf16 a[64:67], a[160:163], v[0:3], a[64:67]
  v_exp_f32 v100, v100
  v_mfma_f32_16x16x32_bf16 a[64:67], a[164:167], v[32:35], a[64:67]
  ds_read_b64_tr_b16 a[184:185], v223 offset:0
  v_mfma_f32_16x16x32_bf16 a[68:71], a[164:167], v[40:43], a[68:71]
  v_exp_f32 v101, v101
  v_mfma_f32_16x16x32_bf16 a[68:71], a[160:163], v[8:11], a[68:71]
  ds_read_b64_tr_b16 a[186:187], v223 offset:4096
  v_cvt_pk_bf16_f32 v98, v100, v101
  v_mfma_f32_16x16x32_bf16 a[72:75], a[160:163], v[16:19], a[72:75]
  v_exp_f32 v102, v102
  v_mfma_f32_16x16x32_bf16 a[72:75], a[164:167], v[48:51], a[72:75]
  ds_read_b64_tr_b16 a[188:189], v223 offset:8192
  v_mfma_f32_16x16x32_bf16 a[76:79], a[164:167], v[56:59], a[76:79]
  s_waitcnt lgkmcnt(7)
  v_exp_f32 v103, v103
  v_mfma_f32_16x16x32_bf16 a[76:79], a[160:163], v[24:27], a[76:79]
  ds_read_b64_tr_b16 a[190:191], v223 offset:12288
  v_cvt_pk_bf16_f32 v99, v102, v103
  v_mfma_f32_16x16x32_bf16 a[80:83], a[168:171], v[0:3], a[80:83]
  s_waitcnt vmcnt(10)
  v_exp_f32 v108, v108
  v_mfma_f32_16x16x32_bf16 a[80:83], a[172:175], v[32:35], a[80:83]
  v_mfma_f32_16x16x32_bf16 a[84:87], a[172:175], v[40:43], a[84:87]
  s_barrier
  v_exp_f32 v109, v109
  v_mfma_f32_16x16x32_bf16 a[84:87], a[168:171], v[8:11], a[84:87]
  ds_read_b128 a[128:131], v212 offset:32768
  v_cvt_pk_bf16_f32 v106, v108, v109
  v_mfma_f32_16x16x32_bf16 a[88:91], a[168:171], v[16:19], a[88:91]
  v_exp_f32 v110, v110
  v_mfma_f32_16x16x32_bf16 a[88:91], a[172:175], v[48:51], a[88:91]
  ds_read_b128 a[132:135], v213 offset:32768
  v_mfma_f32_16x16x32_bf16 a[92:95], a[172:175], v[56:59], a[92:95]
  s_waitcnt lgkmcnt(6)
  v_exp_f32 v111, v111
  v_mfma_f32_16x16x32_bf16 a[92:95], a[168:171], v[24:27], a[92:95]
  ds_read_b128 a[136:139], v214 offset:32768
  v_cvt_pk_bf16_f32 v107, v110, v111
  v_mfma_f32_16x16x32_bf16 a[96:99], a[176:179], v[0:3], a[96:99]
  v_exp_f32 v116, v116
  v_mfma_f32_16x16x32_bf16 a[96:99], a[180:183], v[32:35], a[96:99]
  ds_read_b128 a[140:143], v215 offset:32768
  v_mfma_f32_16x16x32_bf16 a[100:103], a[180:183], v[40:43], a[100:103]
  v_exp_f32 v117, v117
  v_mfma_f32_16x16x32_bf16 a[100:103], a[176:179], v[8:11], a[100:103]
  v_cvt_pk_bf16_f32 v114, v116, v117
  v_mfma_f32_16x16x32_bf16 a[104:107], a[176:179], v[16:19], a[104:107]
  v_exp_f32 v118, v118
  v_mfma_f32_16x16x32_bf16 a[104:107], a[180:183], v[48:51], a[104:107]
  v_mfma_f32_16x16x32_bf16 a[108:111], a[180:183], v[56:59], a[108:111]
  s_waitcnt lgkmcnt(4)
  v_exp_f32 v119, v119
  v_mfma_f32_16x16x32_bf16 a[108:111], a[176:179], v[24:27], a[108:111]
  v_cvt_pk_bf16_f32 v115, v118, v119
  v_mfma_f32_16x16x32_bf16 a[112:115], a[184:187], v[0:3], a[112:115]
  v_exp_f32 v124, v124
  v_mfma_f32_16x16x32_bf16 a[112:115], a[188:191], v[32:35], a[112:115]
  v_mfma_f32_16x16x32_bf16 a[116:119], a[188:191], v[40:43], a[116:119]
  v_exp_f32 v125, v125
  v_mfma_f32_16x16x32_bf16 a[116:119], a[184:187], v[8:11], a[116:119]
  v_cvt_pk_bf16_f32 v122, v124, v125
  v_mfma_f32_16x16x32_bf16 a[120:123], a[184:187], v[16:19], a[120:123]
  v_exp_f32 v126, v126
  v_mfma_f32_16x16x32_bf16 a[120:123], a[188:191], v[48:51], a[120:123]
  v_mfma_f32_16x16x32_bf16 a[124:127], a[188:191], v[56:59], a[124:127]
  s_waitcnt lgkmcnt(0)
  v_exp_f32 v127, v127
  v_mfma_f32_16x16x32_bf16 a[124:127], a[184:187], v[24:27], a[124:127]
  v_cvt_pk_bf16_f32 v123, v126, v127
  v_mfma_f32_16x16x32_bf16 v[0:3], a[128:131], v[128:131], v[192:195]
  s_add_u32 m0, s28, 114688
  s_mov_b32 s20, s88
  s_mov_b32 s21, s89
  s_mov_b32 s22, 5242880
  s_mov_b32 s23, 0x20000
  v_lshrrev_b32 v208, 4, v242
  v_and_b32 v209, 1, v208
  v_mfma_f32_16x16x32_bf16 v[0:3], a[132:135], v[132:135], v[0:3]
  ds_read_b128 a[144:147], v212 offset:36864
  v_lshrrev_b32 v208, 1, v208
  v_mfma_f32_16x16x32_bf16 v[0:3], a[136:139], v[136:139], v[0:3]
  buffer_load_dwordx4 v236, s[16:19], s29 offen offset:0 lds
  v_mfma_f32_16x16x32_bf16 v[0:3], a[140:143], v[140:143], v[0:3]
  ds_read_b128 a[148:151], v213 offset:36864
  v_mul_u32_u24 v208, 0x500, v208
  v_mfma_f32_16x16x32_bf16 v[8:11], a[140:143], v[156:159], v[196:199]
  buffer_load_dwordx4 v237, s[16:19], s29 offen offset:1024 lds
  v_mfma_f32_16x16x32_bf16 v[8:11], a[136:139], v[152:155], v[8:11]
  ds_read_b128 a[152:155], v214 offset:36864
  v_lshl_add_u32 v208, v209, 4, v208
  v_mfma_f32_16x16x32_bf16 v[8:11], a[132:135], v[148:151], v[8:11]
  buffer_load_dwordx4 v236, s[16:19], s29 offen offset:2048 lds
  v_mfma_f32_16x16x32_bf16 v[8:11], a[128:131], v[144:147], v[8:11]
  ds_read_b128 a[156:159], v215 offset:36864
  v_lshrrev_b32 v209, 4, v242
  v_mfma_f32_16x16x32_bf16 v[16:19], a[128:131], v[160:163], v[200:203]
  v_exp_f32 v0, v0
  v_mfma_f32_16x16x32_bf16 v[16:19], a[132:135], v[164:167], v[16:19]
  buffer_load_dwordx4 v237, s[16:19], s29 offen offset:3072 lds
  v_mfma_f32_16x16x32_bf16 v[16:19], a[136:139], v[168:171], v[16:19]
  s_add_u32 s29, s29, 16384
  v_exp_f32 v1, v1
  v_mfma_f32_16x16x32_bf16 v[16:19], a[140:143], v[172:175], v[16:19]
  v_cvt_pk_bf16_f32 v0, v0, v1
  v_lshrrev_b32 v210, 5, v209
  v_mfma_f32_16x16x32_bf16 v[24:27], a[140:143], v[188:191], v[204:207]
  s_add_u32 m0, s28, 0
  v_exp_f32 v2, v2
  v_mfma_f32_16x16x32_bf16 v[24:27], a[136:139], v[184:187], v[24:27]
  buffer_load_dwordx4 v232, s[12:15], s29 offen offset:0 lds
  v_mfma_f32_16x16x32_bf16 v[24:27], a[132:135], v[180:183], v[24:27]
  s_waitcnt lgkmcnt(0)
  v_exp_f32 v3, v3
  v_mfma_f32_16x16x32_bf16 v[24:27], a[128:131], v[176:179], v[24:27]
  v_cvt_pk_bf16_f32 v1, v2, v3
  v_lshlrev_b32 v210, 30, v210
  v_mfma_f32_16x16x32_bf16 v[4:7], a[144:147], v[128:131], v[192:195]
  v_exp_f32 v8, v8
  v_mfma_f32_16x16x32_bf16 v[4:7], a[148:151], v[132:135], v[4:7]
  ds_read_b128 a[128:131], v212 offset:40960
  v_or_b32 v210, v210, v208
  v_mfma_f32_16x16x32_bf16 v[4:7], a[152:155], v[136:139], v[4:7]
  v_exp_f32 v9, v9
  v_mfma_f32_16x16x32_bf16 v[4:7], a[156:159], v[140:143], v[4:7]
  ds_read_b128 a[132:135], v213 offset:40960
  v_cvt_pk_bf16_f32 v8, v8, v9
  v_mfma_f32_16x16x32_bf16 v[12:15], a[156:159], v[156:159], v[196:199]
  v_exp_f32 v10, v10
  v_mfma_f32_16x16x32_bf16 v[12:15], a[152:155], v[152:155], v[12:15]
  ds_read_b128 a[136:139], v214 offset:40960
  v_bfe_u32 v211, v209, 2, 4
  v_mfma_f32_16x16x32_bf16 v[12:15], a[148:151], v[148:151], v[12:15]
  v_exp_f32 v11, v11
  v_mfma_f32_16x16x32_bf16 v[12:15], a[144:147], v[144:147], v[12:15]
  ds_read_b128 a[140:143], v215 offset:40960
  v_cvt_pk_bf16_f32 v9, v10, v11
  v_mfma_f32_16x16x32_bf16 v[20:23], a[144:147], v[160:163], v[200:203]
  v_exp_f32 v16, v16
  v_mfma_f32_16x16x32_bf16 v[20:23], a[148:151], v[164:167], v[20:23]
  buffer_load_dwordx4 v233, s[12:15], s29 offen offset:1024 lds
  v_mfma_f32_16x16x32_bf16 v[20:23], a[152:155], v[168:171], v[20:23]
  v_exp_f32 v17, v17
  v_mfma_f32_16x16x32_bf16 v[20:23], a[156:159], v[172:175], v[20:23]
  v_cvt_pk_bf16_f32 v16, v16, v17
  v_and_b32 v209, 3, v209
  v_mfma_f32_16x16x32_bf16 v[28:31], a[156:159], v[188:191], v[204:207]
  v_exp_f32 v18, v18
  v_mfma_f32_16x16x32_bf16 v[28:31], a[152:155], v[184:187], v[28:31]
  buffer_load_dwordx4 v234, s[12:15], s29 offen offset:2048 lds
  v_mfma_f32_16x16x32_bf16 v[28:31], a[148:151], v[180:183], v[28:31]
  s_waitcnt lgkmcnt(0)
  v_exp_f32 v19, v19
  v_mfma_f32_16x16x32_bf16 v[28:31], a[144:147], v[176:179], v[28:31]
  v_cvt_pk_bf16_f32 v17, v18, v19
  v_lshlrev_b32 v209, 3, v209
  v_mfma_f32_16x16x32_bf16 v[32:35], a[128:131], v[128:131], v[192:195]
  v_exp_f32 v24, v24
  v_mfma_f32_16x16x32_bf16 v[32:35], a[132:135], v[132:135], v[32:35]
  ds_read_b128 a[144:147], v212 offset:45056
  v_lshl_add_u32 v209, v211, 5, v209
  v_mfma_f32_16x16x32_bf16 v[32:35], a[136:139], v[136:139], v[32:35]
  v_exp_f32 v25, v25
  v_mfma_f32_16x16x32_bf16 v[32:35], a[140:143], v[140:143], v[32:35]
  ds_read_b128 a[148:151], v213 offset:45056
  v_cvt_pk_bf16_f32 v24, v24, v25
  v_mfma_f32_16x16x32_bf16 v[40:43], a[140:143], v[156:159], v[196:199]
  v_exp_f32 v26, v26
  v_mfma_f32_16x16x32_bf16 v[40:43], a[136:139], v[152:155], v[40:43]
  ds_read_b128 a[152:155], v214 offset:45056
  v_add_u32 v209, s50, v209
  v_mfma_f32_16x16x32_bf16 v[40:43], a[132:135], v[148:151], v[40:43]
  s_and_b32 s39, s2, 1
  s_lshl_b32 s39, s39, 2
  s_add_u32 s39, s39, s3
  s_lshr_b32 s31, s2, 1
  s_mul_i32 s30, s31, 40960
  s_mul_i32 s48, s39, 160
  s_add_u32 s30, s30, s48
  s_mul_i32 s31, s31, 5120
  s_mul_i32 s39, s39, 655360
  s_add_u32 s31, s31, s39
  s_add_u32 s31, s31, 3145728
  s_lshr_b32 s39, s2, 3
  s_min_u32 s39, s39, 29
  s_and_b32 s48, s2, 7
  s_mul_i32 s48, s48, 30
  s_add_u32 s39, s39, s48
  s_mul_i32 s98, s39, 1639
  s_lshr_b32 s98, s98, 16
  s_mul_i32 s99, s98, 40
  s_sub_u32 s99, s39, s99
  s_min_u32 s39, s3, 2
  s_mul_i32 s48, s98, 3
  s_add_u32 s48, s48, s39
  s_mul_i32 s100, s48, 122880
  s_lshl_b32 s39, s99, 5
  s_add_u32 s100, s100, s39
  s_mul_i32 s101, s48, 192
  s_add_u32 s101, s101, 2633728
  s_mov_b32 s51, s50
  v_exp_f32 v27, v27
  v_mfma_f32_16x16x32_bf16 v[40:43], a[128:131], v[144:147], v[40:43]
  ds_read_b128 a[156:159], v215 offset:45056
  v_cvt_pk_bf16_f32 v25, v26, v27
  v_mfma_f32_16x16x32_bf16 v[48:51], a[128:131], v[160:163], v[200:203]
  v_exp_f32 v4, v4
  v_mfma_f32_16x16x32_bf16 v[48:51], a[132:135], v[164:167], v[48:51]
  buffer_load_dwordx4 v235, s[12:15], s29 offen offset:3072 lds
  v_mfma_f32_16x16x32_bf16 v[48:51], a[136:139], v[168:171], v[48:51]
  v_exp_f32 v5, v5
  v_mfma_f32_16x16x32_bf16 v[48:51], a[140:143], v[172:175], v[48:51]
  v_cvt_pk_bf16_f32 v2, v4, v5
  v_mov_b32 v211, v242
  v_mfma_f32_16x16x32_bf16 v[56:59], a[140:143], v[188:191], v[204:207]
  s_mov_b32 s4, s94
  s_mov_b32 s5, s95
  s_mov_b32 s6, 2211840
  s_mov_b32 s7, 0x20000
  v_exp_f32 v6, v6
  v_mfma_f32_16x16x32_bf16 v[56:59], a[136:139], v[184:187], v[56:59]
  v_mfma_f32_16x16x32_bf16 v[56:59], a[132:135], v[180:183], v[56:59]
  s_waitcnt lgkmcnt(0)
  v_exp_f32 v7, v7
  v_mfma_f32_16x16x32_bf16 v[56:59], a[128:131], v[176:179], v[56:59]
  v_cvt_pk_bf16_f32 v3, v6, v7
  v_mfma_f32_16x16x32_bf16 v[36:39], a[144:147], v[128:131], v[192:195]
  v_exp_f32 v12, v12
  v_mfma_f32_16x16x32_bf16 v[36:39], a[148:151], v[132:135], v[36:39]
  ds_read_b64_tr_b16 a[160:161], v216 offset:16384
  v_mfma_f32_16x16x32_bf16 v[36:39], a[152:155], v[136:139], v[36:39]
  v_exp_f32 v13, v13
  v_mfma_f32_16x16x32_bf16 v[36:39], a[156:159], v[140:143], v[36:39]
  ds_read_b64_tr_b16 a[162:163], v216 offset:20480
  v_cvt_pk_bf16_f32 v10, v12, v13
  v_mfma_f32_16x16x32_bf16 v[44:47], a[156:159], v[156:159], v[196:199]
  v_exp_f32 v14, v14
  v_mfma_f32_16x16x32_bf16 v[44:47], a[152:155], v[152:155], v[44:47]
  ds_read_b64_tr_b16 a[164:165], v216 offset:24576
  v_mfma_f32_16x16x32_bf16 v[44:47], a[148:151], v[148:151], v[44:47]
  v_exp_f32 v15, v15
  v_mfma_f32_16x16x32_bf16 v[44:47], a[144:147], v[144:147], v[44:47]
  ds_read_b64_tr_b16 a[166:167], v216 offset:28672
  v_cvt_pk_bf16_f32 v11, v14, v15
  v_mfma_f32_16x16x32_bf16 v[52:55], a[144:147], v[160:163], v[200:203]
  v_exp_f32 v20, v20
  v_mfma_f32_16x16x32_bf16 v[52:55], a[148:151], v[164:167], v[52:55]
  ds_read_b64_tr_b16 a[168:169], v217 offset:16384
  v_mfma_f32_16x16x32_bf16 v[52:55], a[152:155], v[168:171], v[52:55]
  v_exp_f32 v21, v21
  v_mfma_f32_16x16x32_bf16 v[52:55], a[156:159], v[172:175], v[52:55]
  ds_read_b64_tr_b16 a[170:171], v217 offset:20480
  v_cvt_pk_bf16_f32 v18, v20, v21
  v_mfma_f32_16x16x32_bf16 v[60:63], a[156:159], v[188:191], v[204:207]
  v_exp_f32 v22, v22
  v_mfma_f32_16x16x32_bf16 v[60:63], a[152:155], v[184:187], v[60:63]
  ds_read_b64_tr_b16 a[172:173], v217 offset:24576
  v_mfma_f32_16x16x32_bf16 v[60:63], a[148:151], v[180:183], v[60:63]
  v_exp_f32 v23, v23
  v_mfma_f32_16x16x32_bf16 v[60:63], a[144:147], v[176:179], v[60:63]
  ds_read_b64_tr_b16 a[174:175], v217 offset:28672
  v_cvt_pk_bf16_f32 v19, v22, v23
  v_mfma_f32_16x16x32_bf16 a[192:195], a[208:211], v[64:67], a[192:195]
  v_exp_f32 v28, v28
  v_mfma_f32_16x16x32_bf16 a[192:195], a[208:211], v[96:99], a[192:195]
  ds_read_b64_tr_b16 a[176:177], v218 offset:16384
  v_mfma_f32_16x16x32_bf16 a[196:199], a[208:211], v[72:75], a[196:199]
  v_exp_f32 v29, v29
  v_mfma_f32_16x16x32_bf16 a[196:199], a[208:211], v[104:107], a[196:199]
  ds_read_b64_tr_b16 a[178:179], v218 offset:20480
  v_cvt_pk_bf16_f32 v26, v28, v29
  v_mfma_f32_16x16x32_bf16 a[200:203], a[208:211], v[80:83], a[200:203]
  v_exp_f32 v30, v30
  v_mfma_f32_16x16x32_bf16 a[200:203], a[208:211], v[112:115], a[200:203]
  ds_read_b64_tr_b16 a[180:181], v218 offset:24576
  v_mfma_f32_16x16x32_bf16 a[204:207], a[208:211], v[88:91], a[204:207]
  s_waitcnt lgkmcnt(7)
  v_exp_f32 v31, v31
  v_mfma_f32_16x16x32_bf16 a[204:207], a[208:211], v[120:123], a[204:207]
  ds_read_b64_tr_b16 a[182:183], v218 offset:28672
  v_cvt_pk_bf16_f32 v27, v30, v31
  v_mfma_f32_16x16x32_bf16 a[0:3], a[160:163], v[64:67], a[0:3]
  v_exp_f32 v32, v32
  v_mfma_f32_16x16x32_bf16 a[0:3], a[164:167], v[96:99], a[0:3]
  ds_read_b64_tr_b16 a[184:185], v219 offset:16384
  v_mfma_f32_16x16x32_bf16 a[4:7], a[164:167], v[104:107], a[4:7]
  v_exp_f32 v33, v33
  v_mfma_f32_16x16x32_bf16 a[4:7], a[160:163], v[72:75], a[4:7]
  ds_read_b64_tr_b16 a[186:187], v219 offset:20480
  v_cvt_pk_bf16_f32 v32, v32, v33
  v_mfma_f32_16x16x32_bf16 a[8:11], a[160:163], v[80:83], a[8:11]
  v_exp_f32 v34, v34
  v_mfma_f32_16x16x32_bf16 a[8:11], a[164:167], v[112:115], a[8:11]
  ds_read_b64_tr_b16 a[188:189], v219 offset:24576
  v_mfma_f32_16x16x32_bf16 a[12:15], a[164:167], v[120:123], a[12:15]
  s_waitcnt lgkmcnt(7)
  v_exp_f32 v35, v35
  v_mfma_f32_16x16x32_bf16 a[12:15], a[160:163], v[88:91], a[12:15]
  ds_read_b64_tr_b16 a[190:191], v219 offset:28672
  v_cvt_pk_bf16_f32 v33, v34, v35
  v_mfma_f32_16x16x32_bf16 a[16:19], a[168:171], v[64:67], a[16:19]
  v_exp_f32 v40, v40
  v_mfma_f32_16x16x32_bf16 a[16:19], a[172:175], v[96:99], a[16:19]
  ds_read_b64_tr_b16 a[160:161], v220 offset:16384
  v_mfma_f32_16x16x32_bf16 a[20:23], a[172:175], v[104:107], a[20:23]
  v_exp_f32 v41, v41
  v_mfma_f32_16x16x32_bf16 a[20:23], a[168:171], v[72:75], a[20:23]
  ds_read_b64_tr_b16 a[162:163], v220 offset:20480
  v_cvt_pk_bf16_f32 v40, v40, v41
  v_mfma_f32_16x16x32_bf16 a[24:27], a[168:171], v[80:83], a[24:27]
  v_exp_f32 v42, v42
  v_mfma_f32_16x16x32_bf16 a[24:27], a[172:175], v[112:115], a[24:27]
  ds_read_b64_tr_b16 a[164:165], v220 offset:24576
  v_mfma_f32_16x16x32_bf16 a[28:31], a[172:175], v[120:123], a[28:31]
  s_waitcnt lgkmcnt(7)
  v_exp_f32 v43, v43
  v_mfma_f32_16x16x32_bf16 a[28:31], a[168:171], v[88:91], a[28:31]
  ds_read_b64_tr_b16 a[166:167], v220 offset:28672
  v_cvt_pk_bf16_f32 v41, v42, v43
  v_mfma_f32_16x16x32_bf16 a[32:35], a[176:179], v[64:67], a[32:35]
  v_exp_f32 v48, v48
  v_mfma_f32_16x16x32_bf16 a[32:35], a[180:183], v[96:99], a[32:35]
  ds_read_b64_tr_b16 a[168:169], v221 offset:16384
  v_mfma_f32_16x16x32_bf16 a[36:39], a[180:183], v[104:107], a[36:39]
  v_exp_f32 v49, v49
  v_mfma_f32_16x16x32_bf16 a[36:39], a[176:179], v[72:75], a[36:39]
  ds_read_b64_tr_b16 a[170:171], v221 offset:20480
  v_cvt_pk_bf16_f32 v48, v48, v49
  v_mfma_f32_16x16x32_bf16 a[40:43], a[176:179], v[80:83], a[40:43]
  v_exp_f32 v50, v50
  v_mfma_f32_16x16x32_bf16 a[40:43], a[180:183], v[112:115], a[40:43]
  ds_read_b64_tr_b16 a[172:173], v221 offset:24576
  v_mfma_f32_16x16x32_bf16 a[44:47], a[180:183], v[120:123], a[44:47]
  s_waitcnt lgkmcnt(7)
  v_exp_f32 v51, v51
  v_mfma_f32_16x16x32_bf16 a[44:47], a[176:179], v[88:91], a[44:47]
  ds_read_b64_tr_b16 a[174:175], v221 offset:28672
  v_cvt_pk_bf16_f32 v49, v50, v51
  v_mfma_f32_16x16x32_bf16 a[48:51], a[184:187], v[64:67], a[48:51]
  v_exp_f32 v56, v56
  v_mfma_f32_16x16x32_bf16 a[48:51], a[188:191], v[96:99], a[48:51]
  ds_read_b64_tr_b16 a[176:177], v222 offset:16384
  v_mfma_f32_16x16x32_bf16 a[52:55], a[188:191], v[104:107], a[52:55]
  v_exp_f32 v57, v57
  v_mfma_f32_16x16x32_bf16 a[52:55], a[184:187], v[72:75], a[52:55]
  ds_read_b64_tr_b16 a[178:179], v222 offset:20480
  v_cvt_pk_bf16_f32 v56, v56, v57
  v_mfma_f32_16x16x32_bf16 a[56:59], a[184:187], v[80:83], a[56:59]
  v_exp_f32 v58, v58
  v_mfma_f32_16x16x32_bf16 a[56:59], a[188:191], v[112:115], a[56:59]
  ds_read_b64_tr_b16 a[180:181], v222 offset:24576
  v_mfma_f32_16x16x32_bf16 a[60:63], a[188:191], v[120:123], a[60:63]
  s_waitcnt lgkmcnt(7)
  v_exp_f32 v59, v59
  v_mfma_f32_16x16x32_bf16 a[60:63], a[184:187], v[88:91], a[60:63]
  ds_read_b64_tr_b16 a[182:183], v222 offset:28672
  v_cvt_pk_bf16_f32 v57, v58, v59
  v_mfma_f32_16x16x32_bf16 a[64:67], a[160:163], v[64:67], a[64:67]
  v_exp_f32 v36, v36
  v_mfma_f32_16x16x32_bf16 a[64:67], a[164:167], v[96:99], a[64:67]
  ds_read_b64_tr_b16 a[184:185], v223 offset:16384
  v_mfma_f32_16x16x32_bf16 a[68:71], a[164:167], v[104:107], a[68:71]
  v_exp_f32 v37, v37
  v_mfma_f32_16x16x32_bf16 a[68:71], a[160:163], v[72:75], a[68:71]
  ds_read_b64_tr_b16 a[186:187], v223 offset:20480
  v_cvt_pk_bf16_f32 v34, v36, v37
  v_mfma_f32_16x16x32_bf16 a[72:75], a[160:163], v[80:83], a[72:75]
  v_exp_f32 v38, v38
  v_mfma_f32_16x16x32_bf16 a[72:75], a[164:167], v[112:115], a[72:75]
  ds_read_b64_tr_b16 a[188:189], v223 offset:24576
  v_mfma_f32_16x16x32_bf16 a[76:79], a[164:167], v[120:123], a[76:79]
  s_waitcnt lgkmcnt(7)
  v_exp_f32 v39, v39
  v_mfma_f32_16x16x32_bf16 a[76:79], a[160:163], v[88:91], a[76:79]
  ds_read_b64_tr_b16 a[190:191], v223 offset:28672
  v_cvt_pk_bf16_f32 v35, v38, v39
  v_mfma_f32_16x16x32_bf16 a[80:83], a[168:171], v[64:67], a[80:83]
  s_waitcnt vmcnt(9)
  v_exp_f32 v44, v44
  v_mfma_f32_16x16x32_bf16 a[80:83], a[172:175], v[96:99], a[80:83]
  v_mfma_f32_16x16x32_bf16 a[84:87], a[172:175], v[104:107], a[84:87]
  s_barrier
  v_exp_f32 v45, v45
  v_mfma_f32_16x16x32_bf16 a[84:87], a[168:171], v[72:75], a[84:87]
  ds_read_b128 a[128:131], v212 offset:49152
  v_cvt_pk_bf16_f32 v42, v44, v45
  v_mfma_f32_16x16x32_bf16 a[88:91], a[168:171], v[80:83], a[88:91]
  v_exp_f32 v46, v46
  v_mfma_f32_16x16x32_bf16 a[88:91], a[172:175], v[112:115], a[88:91]
  ds_read_b128 a[132:135], v213 offset:49152
  v_mfma_f32_16x16x32_bf16 a[92:95], a[172:175], v[120:123], a[92:95]
  s_waitcnt lgkmcnt(6)
  v_exp_f32 v47, v47
  v_mfma_f32_16x16x32_bf16 a[92:95], a[168:171], v[88:91], a[92:95]
  ds_read_b128 a[136:139], v214 offset:49152
  v_cvt_pk_bf16_f32 v43, v46, v47
  v_mfma_f32_16x16x32_bf16 a[96:99], a[176:179], v[64:67], a[96:99]
  v_exp_f32 v52, v52
  v_mfma_f32_16x16x32_bf16 a[96:99], a[180:183], v[96:99], a[96:99]
  ds_read_b128 a[140:143], v215 offset:49152
  v_mfma_f32_16x16x32_bf16 a[100:103], a[180:183], v[104:107], a[100:103]
  v_exp_f32 v53, v53
  v_mfma_f32_16x16x32_bf16 a[100:103], a[176:179], v[72:75], a[100:103]
  v_cvt_pk_bf16_f32 v50, v52, v53
  v_mfma_f32_16x16x32_bf16 a[104:107], a[176:179], v[80:83], a[104:107]
  v_exp_f32 v54, v54
  v_mfma_f32_16x16x32_bf16 a[104:107], a[180:183], v[112:115], a[104:107]
  v_mfma_f32_16x16x32_bf16 a[108:111], a[180:183], v[120:123], a[108:111]
  s_waitcnt lgkmcnt(4)
  v_exp_f32 v55, v55
  v_mfma_f32_16x16x32_bf16 a[108:111], a[176:179], v[88:91], a[108:111]
  v_cvt_pk_bf16_f32 v51, v54, v55
  v_mfma_f32_16x16x32_bf16 a[112:115], a[184:187], v[64:67], a[112:115]
  v_exp_f32 v60, v60
  v_mfma_f32_16x16x32_bf16 a[112:115], a[188:191], v[96:99], a[112:115]
  v_mfma_f32_16x16x32_bf16 a[116:119], a[188:191], v[104:107], a[116:119]
  v_exp_f32 v61, v61
  v_mfma_f32_16x16x32_bf16 a[116:119], a[184:187], v[72:75], a[116:119]
  v_cvt_pk_bf16_f32 v58, v60, v61
  v_mfma_f32_16x16x32_bf16 a[120:123], a[184:187], v[80:83], a[120:123]
  v_exp_f32 v62, v62
  v_mfma_f32_16x16x32_bf16 a[120:123], a[188:191], v[112:115], a[120:123]
  v_mfma_f32_16x16x32_bf16 a[124:127], a[188:191], v[120:123], a[124:127]
  s_waitcnt lgkmcnt(0)
  v_exp_f32 v63, v63
  v_mfma_f32_16x16x32_bf16 a[124:127], a[184:187], v[88:91], a[124:127]
  v_cvt_pk_bf16_f32 v59, v62, v63
  v_mfma_f32_16x16x32_bf16 v[64:67], a[128:131], v[128:131], v[192:195]
  s_add_u32 m0, s28, 65536
  v_lshrrev_b32 v224, 4, v242
  v_lshrrev_b32 v225, 4, v224
  v_mfma_f32_16x16x32_bf16 v[64:67], a[132:135], v[132:135], v[64:67]
  ds_read_b128 a[144:147], v212 offset:53248
  v_bfe_u32 v226, v224, 2, 2
  v_mfma_f32_16x16x32_bf16 v[64:67], a[136:139], v[136:139], v[64:67]
  buffer_load_dwordx4 v236, s[16:19], s29 offen offset:0 lds
  v_mfma_f32_16x16x32_bf16 v[64:67], a[140:143], v[140:143], v[64:67]
  ds_read_b128 a[148:151], v213 offset:53248
  v_lshl_add_u32 v225, v225, 3, v226
  v_mfma_f32_16x16x32_bf16 v[72:75], a[140:143], v[156:159], v[196:199]
  buffer_load_dwordx4 v237, s[16:19], s29 offen offset:1024 lds
  v_mfma_f32_16x16x32_bf16 v[72:75], a[136:139], v[152:155], v[72:75]
  ds_read_b128 a[152:155], v214 offset:53248
  v_lshlrev_b32 v225, 4, v225
  v_mfma_f32_16x16x32_bf16 v[72:75], a[132:135], v[148:151], v[72:75]
  buffer_load_dwordx4 v236, s[16:19], s29 offen offset:2048 lds
  v_mfma_f32_16x16x32_bf16 v[72:75], a[128:131], v[144:147], v[72:75]
  ds_read_b128 a[156:159], v215 offset:53248
  v_bfe_u32 v226, v224, 1, 1
  v_mfma_f32_16x16x32_bf16 v[80:83], a[128:131], v[160:163], v[200:203]
  v_exp_f32 v64, v64
  v_mfma_f32_16x16x32_bf16 v[80:83], a[132:135], v[164:167], v[80:83]
  buffer_load_dwordx4 v237, s[16:19], s29 offen offset:3072 lds
  v_mfma_f32_16x16x32_bf16 v[80:83], a[136:139], v[168:171], v[80:83]
  s_add_u32 s29, s29, 16384
  v_exp_f32 v65, v65
  v_mfma_f32_16x16x32_bf16 v[80:83], a[140:143], v[172:175], v[80:83]
  v_cvt_pk_bf16_f32 v64, v64, v65
  v_mul_u32_u24 v226, 0xc00, v226
  v_mfma_f32_16x16x32_bf16 v[88:91], a[140:143], v[188:191], v[204:207]
  s_add_u32 m0, s28, 16384
  v_exp_f32 v66, v66
  v_mfma_f32_16x16x32_bf16 v[88:91], a[136:139], v[184:187], v[88:91]
  buffer_load_dwordx4 v232, s[12:15], s29 offen offset:0 lds
  v_mfma_f32_16x16x32_bf16 v[88:91], a[132:135], v[180:183], v[88:91]
  s_waitcnt lgkmcnt(0)
  v_exp_f32 v67, v67
  v_mfma_f32_16x16x32_bf16 v[88:91], a[128:131], v[176:179], v[88:91]
  v_cvt_pk_bf16_f32 v65, v66, v67
  v_add3_u32 v225, v225, v226, s50
  v_mfma_f32_16x16x32_bf16 v[68:71], a[144:147], v[128:131], v[192:195]
  v_exp_f32 v72, v72
  v_mfma_f32_16x16x32_bf16 v[68:71], a[148:151], v[132:135], v[68:71]
  ds_read_b128 a[128:131], v212 offset:57344
  v_and_b32 v226, 1, v224
  v_mfma_f32_16x16x32_bf16 v[68:71], a[152:155], v[136:139], v[68:71]
  v_exp_f32 v73, v73
  v_mfma_f32_16x16x32_bf16 v[68:71], a[156:159], v[140:143], v[68:71]
  ds_read_b128 a[132:135], v213 offset:57344
  v_cvt_pk_bf16_f32 v72, v72, v73
  v_mfma_f32_16x16x32_bf16 v[76:79], a[156:159], v[156:159], v[196:199]
  v_exp_f32 v74, v74
  v_mfma_f32_16x16x32_bf16 v[76:79], a[152:155], v[152:155], v[76:79]
  ds_read_b128 a[136:139], v214 offset:57344
  v_lshl_add_u32 v225, v226, 3, v225
  v_mfma_f32_16x16x32_bf16 v[76:79], a[148:151], v[148:151], v[76:79]
  s_waitcnt vmcnt(13)
  v_exp_f32 v75, v75
  v_mfma_f32_16x16x32_bf16 v[76:79], a[144:147], v[144:147], v[76:79]
  ds_read_b128 a[140:143], v215 offset:57344
  v_cvt_pk_bf16_f32 v73, v74, v75
  v_mfma_f32_16x16x32_bf16 v[84:87], a[144:147], v[160:163], v[200:203]
  v_exp_f32 v80, v80
  v_mfma_f32_16x16x32_bf16 v[84:87], a[148:151], v[164:167], v[84:87]
  buffer_load_dwordx4 v233, s[12:15], s29 offen offset:1024 lds
  v_mfma_f32_16x16x32_bf16 v[84:87], a[152:155], v[168:171], v[84:87]
  v_exp_f32 v81, v81
  v_mfma_f32_16x16x32_bf16 v[84:87], a[156:159], v[172:175], v[84:87]
  ds_read_b64_tr_b16 a[232:233], v225 offset:0
  v_cvt_pk_bf16_f32 v80, v80, v81
  v_mfma_f32_16x16x32_bf16 v[92:95], a[156:159], v[188:191], v[204:207]
  v_exp_f32 v82, v82
  v_mfma_f32_16x16x32_bf16 v[92:95], a[152:155], v[184:187], v[92:95]
  buffer_load_dwordx4 v234, s[12:15], s29 offen offset:2048 lds
  v_mfma_f32_16x16x32_bf16 v[92:95], a[148:151], v[180:183], v[92:95]
  s_waitcnt lgkmcnt(1)
  v_exp_f32 v83, v83
  v_mfma_f32_16x16x32_bf16 v[92:95], a[144:147], v[176:179], v[92:95]
  ds_read_b64_tr_b16 a[234:235], v225 offset:64
  v_cvt_pk_bf16_f32 v81, v82, v83
  v_mfma_f32_16x16x32_bf16 v[96:99], a[128:131], v[128:131], v[192:195]
  v_exp_f32 v88, v88
  v_mfma_f32_16x16x32_bf16 v[96:99], a[132:135], v[132:135], v[96:99]
  ds_read_b128 a[144:147], v212 offset:61440
  ds_read_b64_tr_b16 a[236:237], v225 offset:512
  v_mfma_f32_16x16x32_bf16 v[96:99], a[136:139], v[136:139], v[96:99]
  v_exp_f32 v89, v89
  v_mfma_f32_16x16x32_bf16 v[96:99], a[140:143], v[140:143], v[96:99]
  ds_read_b128 a[148:151], v213 offset:61440
  v_cvt_pk_bf16_f32 v88, v88, v89
  v_mfma_f32_16x16x32_bf16 v[104:107], a[140:143], v[156:159], v[196:199]
  v_exp_f32 v90, v90
  v_mfma_f32_16x16x32_bf16 v[104:107], a[136:139], v[152:155], v[104:107]
  ds_read_b128 a[152:155], v214 offset:61440
  ds_read_b64_tr_b16 a[238:239], v225 offset:576
  v_mfma_f32_16x16x32_bf16 v[104:107], a[132:135], v[148:151], v[104:107]
  v_exp_f32 v91, v91
  v_mfma_f32_16x16x32_bf16 v[104:107], a[128:131], v[144:147], v[104:107]
  ds_read_b128 a[156:159], v215 offset:61440
  v_cvt_pk_bf16_f32 v89, v90, v91
  v_mfma_f32_16x16x32_bf16 v[112:115], a[128:131], v[160:163], v[200:203]
  v_exp_f32 v68, v68
  v_mfma_f32_16x16x32_bf16 v[112:115], a[132:135], v[164:167], v[112:115]
  buffer_load_dwordx4 v235, s[12:15], s29 offen offset:3072 lds
  v_mfma_f32_16x16x32_bf16 v[112:115], a[136:139], v[168:171], v[112:115]
  v_exp_f32 v69, v69
  v_mfma_f32_16x16x32_bf16 v[112:115], a[140:143], v[172:175], v[112:115]
  ds_read_b64_tr_b16 a[240:241], v225 offset:1024
  v_cvt_pk_bf16_f32 v66, v68, v69
  v_mfma_f32_16x16x32_bf16 v[120:123], a[140:143], v[188:191], v[204:207]
  v_exp_f32 v70, v70
  v_mfma_f32_16x16x32_bf16 v[120:123], a[136:139], v[184:187], v[120:123]
  ds_read_b64_tr_b16 a[242:243], v225 offset:1088
  ds_read_b64_tr_b16 a[244:245], v225 offset:1536
  v_mfma_f32_16x16x32_bf16 v[120:123], a[132:135], v[180:183], v[120:123]
  s_waitcnt lgkmcnt(3)
  v_exp_f32 v71, v71
  v_mfma_f32_16x16x32_bf16 v[120:123], a[128:131], v[176:179], v[120:123]
  ds_read_b64_tr_b16 a[246:247], v225 offset:1600
  v_cvt_pk_bf16_f32 v67, v70, v71
  v_mfma_f32_16x16x32_bf16 v[100:103], a[144:147], v[128:131], v[192:195]
  v_exp_f32 v76, v76
  v_mfma_f32_16x16x32_bf16 v[100:103], a[148:151], v[132:135], v[100:103]
  ds_read_b64_tr_b16 a[160:161], v216 offset:32768
  ds_read_b64_tr_b16 a[248:249], v225 offset:2048
  v_mfma_f32_16x16x32_bf16 v[100:103], a[152:155], v[136:139], v[100:103]
  v_exp_f32 v77, v77
  v_mfma_f32_16x16x32_bf16 v[100:103], a[156:159], v[140:143], v[100:103]
  ds_read_b64_tr_b16 a[162:163], v216 offset:36864
  v_cvt_pk_bf16_f32 v74, v76, v77
  v_mfma_f32_16x16x32_bf16 v[108:111], a[156:159], v[156:159], v[196:199]
  v_exp_f32 v78, v78
  v_mfma_f32_16x16x32_bf16 v[108:111], a[152:155], v[152:155], v[108:111]
  ds_read_b64_tr_b16 a[164:165], v216 offset:40960
  ds_read_b64_tr_b16 a[250:251], v225 offset:2112
  v_mfma_f32_16x16x32_bf16 v[108:111], a[148:151], v[148:151], v[108:111]
  v_exp_f32 v79, v79
  v_mfma_f32_16x16x32_bf16 v[108:111], a[144:147], v[144:147], v[108:111]
  ds_read_b64_tr_b16 a[166:167], v216 offset:45056
  v_cvt_pk_bf16_f32 v75, v78, v79
  v_mfma_f32_16x16x32_bf16 v[116:119], a[144:147], v[160:163], v[200:203]
  v_exp_f32 v84, v84
  v_mfma_f32_16x16x32_bf16 v[116:119], a[148:151], v[164:167], v[116:119]
  ds_read_b64_tr_b16 a[168:169], v217 offset:32768
  v_mfma_f32_16x16x32_bf16 v[116:119], a[152:155], v[168:171], v[116:119]
  v_exp_f32 v85, v85
  v_mfma_f32_16x16x32_bf16 v[116:119], a[156:159], v[172:175], v[116:119]
  ds_read_b64_tr_b16 a[170:171], v217 offset:36864
  v_cvt_pk_bf16_f32 v82, v84, v85
  v_mfma_f32_16x16x32_bf16 v[124:127], a[156:159], v[188:191], v[204:207]
  v_exp_f32 v86, v86
  v_mfma_f32_16x16x32_bf16 v[124:127], a[152:155], v[184:187], v[124:127]
  ds_read_b64_tr_b16 a[172:173], v217 offset:40960
  s_waitcnt lgkmcnt(4)
  v_mfma_f32_16x16x32_bf16 v[228:231], a[232:235], a[212:215], 0
  v_mfma_f32_16x16x32_bf16 v[228:231], a[236:239], a[216:219], v[228:231]
  v_mfma_f32_16x16x32_bf16 v[228:231], a[240:243], a[220:223], v[228:231]
  v_mfma_f32_16x16x32_bf16 v[228:231], a[244:247], a[224:227], v[228:231]
  v_mfma_f32_16x16x32_bf16 v[228:231], a[248:251], a[228:231], v[228:231]
  v_mfma_f32_16x16x32_bf16 v[124:127], a[148:151], v[180:183], v[124:127]
  s_lshl_b32 s35, s3, 10
  s_add_u32 s35, s35, 159744
  v_exp_f32 v87, v87
  v_mfma_f32_16x16x32_bf16 v[124:127], a[144:147], v[176:179], v[124:127]
  ds_read_b64_tr_b16 a[174:175], v217 offset:45056
  v_cvt_pk_bf16_f32 v83, v86, v87
  v_mfma_f32_16x16x32_bf16 a[192:195], a[208:211], v[0:3], a[192:195]
  v_exp_f32 v92, v92
  v_mfma_f32_16x16x32_bf16 a[192:195], a[208:211], v[32:35], a[192:195]
  ds_read_b64_tr_b16 a[176:177], v218 offset:32768
  v_add_u32 v224, s35, v242
  v_mfma_f32_16x16x32_bf16 a[196:199], a[208:211], v[8:11], a[196:199]
  v_exp_f32 v93, v93
  v_mfma_f32_16x16x32_bf16 a[196:199], a[208:211], v[40:43], a[196:199]
  ds_read_b64_tr_b16 a[178:179], v218 offset:36864
  v_cvt_pk_bf16_f32 v90, v92, v93
  v_mfma_f32_16x16x32_bf16 a[200:203], a[208:211], v[16:19], a[200:203]
  v_exp_f32 v94, v94
  v_mfma_f32_16x16x32_bf16 a[200:203], a[208:211], v[48:51], a[200:203]
  ds_read_b64_tr_b16 a[180:181], v218 offset:40960
  ds_write_b128 v224, v[228:231]
  v_mfma_f32_16x16x32_bf16 a[204:207], a[208:211], v[24:27], a[204:207]
  s_waitcnt lgkmcnt(8)
  v_exp_f32 v95, v95
  v_mfma_f32_16x16x32_bf16 a[204:207], a[208:211], v[56:59], a[204:207]
  ds_read_b64_tr_b16 a[182:183], v218 offset:45056
  v_cvt_pk_bf16_f32 v91, v94, v95
  v_mfma_f32_16x16x32_bf16 a[0:3], a[160:163], v[0:3], a[0:3]
  v_exp_f32 v96, v96
  v_mfma_f32_16x16x32_bf16 a[0:3], a[164:167], v[32:35], a[0:3]
  ds_read_b64_tr_b16 a[184:185], v219 offset:32768
  v_mfma_f32_16x16x32_bf16 a[4:7], a[164:167], v[40:43], a[4:7]
  v_exp_f32 v97, v97
  v_mfma_f32_16x16x32_bf16 a[4:7], a[160:163], v[8:11], a[4:7]
  ds_read_b64_tr_b16 a[186:187], v219 offset:36864
  v_cvt_pk_bf16_f32 v96, v96, v97
  v_mfma_f32_16x16x32_bf16 a[8:11], a[160:163], v[16:19], a[8:11]
  v_exp_f32 v98, v98
  v_mfma_f32_16x16x32_bf16 a[8:11], a[164:167], v[48:51], a[8:11]
  ds_read_b64_tr_b16 a[188:189], v219 offset:40960
  s_waitcnt lgkmcnt(4)
  v_lshrrev_b32 v224, 4, v242
  v_mfma_f32_16x16x32_bf16 a[12:15], a[164:167], v[56:59], a[12:15]
  v_exp_f32 v99, v99
  v_mfma_f32_16x16x32_bf16 a[12:15], a[160:163], v[24:27], a[12:15]
  ds_read_b64_tr_b16 a[190:191], v219 offset:45056
  v_cvt_pk_bf16_f32 v97, v98, v99
  v_mfma_f32_16x16x32_bf16 a[16:19], a[168:171], v[0:3], a[16:19]
  v_exp_f32 v104, v104
  v_mfma_f32_16x16x32_bf16 a[16:19], a[172:175], v[32:35], a[16:19]
  ds_read_b64_tr_b16 a[160:161], v220 offset:32768
  v_bfe_u32 v225, v224, 2, 1
  v_mfma_f32_16x16x32_bf16 a[20:23], a[172:175], v[40:43], a[20:23]
  v_exp_f32 v105, v105
  v_mfma_f32_16x16x32_bf16 a[20:23], a[168:171], v[8:11], a[20:23]
  ds_read_b64_tr_b16 a[162:163], v220 offset:36864
  v_cvt_pk_bf16_f32 v104, v104, v105
  v_mfma_f32_16x16x32_bf16 a[24:27], a[168:171], v[16:19], a[24:27]
  v_exp_f32 v106, v106
  v_mfma_f32_16x16x32_bf16 a[24:27], a[172:175], v[48:51], a[24:27]
  ds_read_b64_tr_b16 a[164:165], v220 offset:40960
  v_lshlrev_b32 v225, 8, v225
  v_mfma_f32_16x16x32_bf16 a[28:31], a[172:175], v[56:59], a[28:31]
  s_waitcnt lgkmcnt(7)
  v_exp_f32 v107, v107
  v_mfma_f32_16x16x32_bf16 a[28:31], a[168:171], v[24:27], a[28:31]
  ds_read_b64_tr_b16 a[166:167], v220 offset:45056
  v_cvt_pk_bf16_f32 v105, v106, v107
  v_mfma_f32_16x16x32_bf16 a[32:35], a[176:179], v[0:3], a[32:35]
  v_exp_f32 v112, v112
  v_mfma_f32_16x16x32_bf16 a[32:35], a[180:183], v[32:35], a[32:35]
  ds_read_b64_tr_b16 a[168:169], v221 offset:32768
  v_lshrrev_b32 v226, 3, v224
  v_mfma_f32_16x16x32_bf16 a[36:39], a[180:183], v[40:43], a[36:39]
  v_exp_f32 v113, v113
  v_mfma_f32_16x16x32_bf16 a[36:39], a[176:179], v[8:11], a[36:39]
  ds_read_b64_tr_b16 a[170:171], v221 offset:36864
  v_cvt_pk_bf16_f32 v112, v112, v113
  v_mfma_f32_16x16x32_bf16 a[40:43], a[176:179], v[16:19], a[40:43]
  v_exp_f32 v114, v114
  v_mfma_f32_16x16x32_bf16 a[40:43], a[180:183], v[48:51], a[40:43]
  ds_read_b64_tr_b16 a[172:173], v221 offset:40960
  v_lshl_add_u32 v225, v226, 4, v225
  v_mfma_f32_16x16x32_bf16 a[44:47], a[180:183], v[56:59], a[44:47]
  s_waitcnt lgkmcnt(7)
  v_exp_f32 v115, v115
  v_mfma_f32_16x16x32_bf16 a[44:47], a[176:179], v[24:27], a[44:47]
  ds_read_b64_tr_b16 a[174:175], v221 offset:45056
  v_cvt_pk_bf16_f32 v113, v114, v115
  v_mfma_f32_16x16x32_bf16 a[48:51], a[184:187], v[0:3], a[48:51]
  v_exp_f32 v120, v120
  v_mfma_f32_16x16x32_bf16 a[48:51], a[188:191], v[32:35], a[48:51]
  ds_read_b64_tr_b16 a[176:177], v222 offset:32768
  v_and_b32 v227, 3, v224
  v_mfma_f32_16x16x32_bf16 a[52:55], a[188:191], v[40:43], a[52:55]
  v_exp_f32 v121, v121
  v_mfma_f32_16x16x32_bf16 a[52:55], a[184:187], v[8:11], a[52:55]
  ds_read_b64_tr_b16 a[178:179], v222 offset:36864
  v_cvt_pk_bf16_f32 v120, v120, v121
  v_mfma_f32_16x16x32_bf16 a[56:59], a[184:187], v[16:19], a[56:59]
  v_exp_f32 v122, v122
  v_mfma_f32_16x16x32_bf16 a[56:59], a[188:191], v[48:51], a[56:59]
  ds_read_b64_tr_b16 a[180:181], v222 offset:40960
  v_lshl_add_u32 v225, v227, 2, v225
  v_mfma_f32_16x16x32_bf16 a[60:63], a[188:191], v[56:59], a[60:63]
  s_waitcnt lgkmcnt(7)
  v_exp_f32 v123, v123
  v_mfma_f32_16x16x32_bf16 a[60:63], a[184:187], v[24:27], a[60:63]
  ds_read_b64_tr_b16 a[182:183], v222 offset:45056
  v_cvt_pk_bf16_f32 v121, v122, v123
  v_mfma_f32_16x16x32_bf16 a[64:67], a[160:163], v[0:3], a[64:67]
  v_exp_f32 v100, v100
  v_mfma_f32_16x16x32_bf16 a[64:67], a[164:167], v[32:35], a[64:67]
  ds_read_b64_tr_b16 a[184:185], v223 offset:32768
  v_add_u32 v225, 159744, v225
  v_mfma_f32_16x16x32_bf16 a[68:71], a[164:167], v[40:43], a[68:71]
  v_exp_f32 v101, v101
  v_mfma_f32_16x16x32_bf16 a[68:71], a[160:163], v[8:11], a[68:71]
  ds_read_b64_tr_b16 a[186:187], v223 offset:36864
  v_cvt_pk_bf16_f32 v98, v100, v101
  v_mfma_f32_16x16x32_bf16 a[72:75], a[160:163], v[16:19], a[72:75]
  v_exp_f32 v102, v102
  v_mfma_f32_16x16x32_bf16 a[72:75], a[164:167], v[48:51], a[72:75]
  ds_read_b64_tr_b16 a[188:189], v223 offset:40960
  v_mfma_f32_16x16x32_bf16 a[76:79], a[164:167], v[56:59], a[76:79]
  s_waitcnt lgkmcnt(7)
  v_exp_f32 v103, v103
  v_mfma_f32_16x16x32_bf16 a[76:79], a[160:163], v[24:27], a[76:79]
  ds_read_b64_tr_b16 a[190:191], v223 offset:45056
  v_cvt_pk_bf16_f32 v99, v102, v103
  v_mfma_f32_16x16x32_bf16 a[80:83], a[168:171], v[0:3], a[80:83]
  s_waitcnt vmcnt(8)
  v_exp_f32 v108, v108
  v_mfma_f32_16x16x32_bf16 a[80:83], a[172:175], v[32:35], a[80:83]
  v_mfma_f32_16x16x32_bf16 a[84:87], a[172:175], v[40:43], a[84:87]
  s_barrier
  v_exp_f32 v109, v109
  v_mfma_f32_16x16x32_bf16 a[84:87], a[168:171], v[8:11], a[84:87]
  ds_read_b128 a[128:131], v212 offset:0
  v_cvt_pk_bf16_f32 v106, v108, v109
  v_mfma_f32_16x16x32_bf16 a[88:91], a[168:171], v[16:19], a[88:91]
  v_exp_f32 v110, v110
  v_mfma_f32_16x16x32_bf16 a[88:91], a[172:175], v[48:51], a[88:91]
  ds_read_b128 a[132:135], v213 offset:0
  ds_read_b32 v228, v225 offset:0
  v_mfma_f32_16x16x32_bf16 a[92:95], a[172:175], v[56:59], a[92:95]
  s_waitcnt lgkmcnt(7)
  v_exp_f32 v111, v111
  v_mfma_f32_16x16x32_bf16 a[92:95], a[168:171], v[24:27], a[92:95]
  ds_read_b128 a[136:139], v214 offset:0
  v_cvt_pk_bf16_f32 v107, v110, v111
  v_mfma_f32_16x16x32_bf16 a[96:99], a[176:179], v[0:3], a[96:99]
  v_exp_f32 v116, v116
  v_mfma_f32_16x16x32_bf16 a[96:99], a[180:183], v[32:35], a[96:99]
  ds_read_b128 a[140:143], v215 offset:0
  ds_read_b32 v229, v225 offset:1024
  v_mfma_f32_16x16x32_bf16 a[100:103], a[180:183], v[40:43], a[100:103]
  v_exp_f32 v117, v117
  v_mfma_f32_16x16x32_bf16 a[100:103], a[176:179], v[8:11], a[100:103]
  ds_read_b32 v230, v225 offset:2048
  v_cvt_pk_bf16_f32 v114, v116, v117
  v_mfma_f32_16x16x32_bf16 a[104:107], a[176:179], v[16:19], a[104:107]
  v_exp_f32 v118, v118
  v_mfma_f32_16x16x32_bf16 a[104:107], a[180:183], v[48:51], a[104:107]
  ds_read_b32 v231, v225 offset:3072
  ds_read_b32 v238, v225 offset:512
  v_mfma_f32_16x16x32_bf16 a[108:111], a[180:183], v[56:59], a[108:111]
  s_waitcnt lgkmcnt(9)
  v_exp_f32 v119, v119
  v_mfma_f32_16x16x32_bf16 a[108:111], a[176:179], v[24:27], a[108:111]
  ds_read_b32 v239, v225 offset:1536
  v_cvt_pk_bf16_f32 v115, v118, v119
  v_mfma_f32_16x16x32_bf16 a[112:115], a[184:187], v[0:3], a[112:115]
  v_exp_f32 v124, v124
  v_mfma_f32_16x16x32_bf16 a[112:115], a[188:191], v[32:35], a[112:115]
  ds_read_b32 v240, v225 offset:2560
  ds_read_b32 v241, v225 offset:3584
  s_cmp_eq_u32 s3, 0
  s_cselect_b32 s35, 0, 1073741824
  v_mfma_f32_16x16x32_bf16 a[116:119], a[188:191], v[40:43], a[116:119]
  v_exp_f32 v125, v125
  v_mfma_f32_16x16x32_bf16 a[116:119], a[184:187], v[8:11], a[116:119]
  v_cvt_pk_bf16_f32 v122, v124, v125
  v_mul_u32_u24 v226, 0xd80, v226
  v_mfma_f32_16x16x32_bf16 a[120:123], a[184:187], v[16:19], a[120:123]
  v_exp_f32 v126, v126
  v_mfma_f32_16x16x32_bf16 a[120:123], a[188:191], v[48:51], a[120:123]
  v_and_b32 v227, 7, v224
  v_lshl_add_u32 v226, v227, 1, v226
  v_mfma_f32_16x16x32_bf16 a[124:127], a[188:191], v[56:59], a[124:127]
  s_waitcnt lgkmcnt(7)
  v_exp_f32 v127, v127
  v_mfma_f32_16x16x32_bf16 a[124:127], a[184:187], v[24:27], a[124:127]
  v_cvt_pk_bf16_f32 v123, v126, v127
  v_and_b32 v227, 1, v224
  v_lshl_add_u32 v226, v227, 30, v226
  v_or_b32 v226, s35, v226
  v_min_u32 v249, 1, v224
  v_lshlrev_b32 v249, 30, v249
  v_or_b32 v249, s35, v249
  v_mov_b32 v251, v249
  v_mov_b32 v250, 1
  s_mov_b32 s47, 2818048
  s_lshl_b32 s35, s33, 4
  s_add_u32 s35, s35, 2633728
  s_waitcnt lgkmcnt(0)
  v_add_f32 v228, v228, v229
  v_add_f32 v238, v238, v239
  v_add_f32 v230, v230, v231
  v_add_f32 v240, v240, v241
  v_add_f32 v228, v228, v230
  v_add_f32 v238, v238, v240
  v_cvt_pk_bf16_f32 v228, v228, v228
  v_cvt_pk_bf16_f32 v238, v238, v238
  v_lshlrev_b32 v228, 16, v228
  v_lshlrev_b32 v238, 16, v238
  v_mul_f32 v229, 0xbfb8aa3b, v228
  v_exp_f32 v229, v229
  s_nop 0
  v_add_f32 v229, 1.0, v229
  v_rcp_f32 v229, v229
  s_nop 0
  v_mul_f32 v228, v228, v229
  v_cvt_pk_bf16_f32 v228, v228, v228
  v_lshlrev_b32 v228, 16, v228
  v_mul_f32 v228, v228, v238
  s_nop 1
  v_mov_b32_dpp v229, v228 quad_perm:[1,0,3,2] row_mask:0xf bank_mask:0xf
  v_cvt_pk_bf16_f32 v228, v228, v229
  buffer_store_dword v228, v226, s[24:27], s35 offen sc1
  s_mov_b32 s32, 6
attn_loop:
  v_mfma_f32_16x16x32_bf16 v[0:3], a[128:131], v[128:131], v[192:195]
  s_add_u32 m0, s28, 81920
  v_mfma_f32_16x16x32_bf16 v[0:3], a[132:135], v[132:135], v[0:3]
  ds_read_b128 a[144:147], v212 offset:4096
  v_mfma_f32_16x16x32_bf16 v[0:3], a[136:139], v[136:139], v[0:3]
  buffer_load_dwordx4 v236, s[16:19], s29 offen offset:0 lds
  v_mfma_f32_16x16x32_bf16 v[0:3], a[140:143], v[140:143], v[0:3]
  ds_read_b128 a[148:151], v213 offset:4096
  v_mfma_f32_16x16x32_bf16 v[8:11], a[140:143], v[156:159], v[196:199]
  buffer_load_dwordx4 v237, s[16:19], s29 offen offset:1024 lds
  v_mfma_f32_16x16x32_bf16 v[8:11], a[136:139], v[152:155], v[8:11]
  ds_read_b128 a[152:155], v214 offset:4096
  v_mfma_f32_16x16x32_bf16 v[8:11], a[132:135], v[148:151], v[8:11]
  buffer_load_dwordx4 v236, s[16:19], s29 offen offset:2048 lds
  v_mfma_f32_16x16x32_bf16 v[8:11], a[128:131], v[144:147], v[8:11]
  ds_read_b128 a[156:159], v215 offset:4096
  v_mfma_f32_16x16x32_bf16 v[16:19], a[128:131], v[160:163], v[200:203]
  v_exp_f32 v0, v0
  v_mfma_f32_16x16x32_bf16 v[16:19], a[132:135], v[164:167], v[16:19]
  buffer_load_dwordx4 v237, s[16:19], s29 offen offset:3072 lds
  v_mfma_f32_16x16x32_bf16 v[16:19], a[136:139], v[168:171], v[16:19]
  s_add_u32 s29, s29, 16384
  v_exp_f32 v1, v1
  v_mfma_f32_16x16x32_bf16 v[16:19], a[140:143], v[172:175], v[16:19]
  v_cvt_pk_bf16_f32 v0, v0, v1
  v_mfma_f32_16x16x32_bf16 v[24:27], a[140:143], v[188:191], v[204:207]
  s_add_u32 m0, s28, 32768
  v_exp_f32 v2, v2
  v_mfma_f32_16x16x32_bf16 v[24:27], a[136:139], v[184:187], v[24:27]
  buffer_load_dwordx4 v232, s[12:15], s29 offen offset:0 lds
  v_mfma_f32_16x16x32_bf16 v[24:27], a[132:135], v[180:183], v[24:27]
  s_waitcnt lgkmcnt(0)
  v_exp_f32 v3, v3
  v_mfma_f32_16x16x32_bf16 v[24:27], a[128:131], v[176:179], v[24:27]
  v_cvt_pk_bf16_f32 v1, v2, v3
  v_mfma_f32_16x16x32_bf16 v[4:7], a[144:147], v[128:131], v[192:195]
  v_exp_f32 v8, v8
  v_mfma_f32_16x16x32_bf16 v[4:7], a[148:151], v[132:135], v[4:7]
  ds_read_b128 a[128:131], v212 offset:8192
  v_mfma_f32_16x16x32_bf16 v[4:7], a[152:155], v[136:139], v[4:7]
  v_exp_f32 v9, v9
  v_mfma_f32_16x16x32_bf16 v[4:7], a[156:159], v[140:143], v[4:7]
  ds_read_b128 a[132:135], v213 offset:8192
  v_cvt_pk_bf16_f32 v8, v8, v9
  v_mfma_f32_16x16x32_bf16 v[12:15], a[156:159], v[156:159], v[196:199]
  v_exp_f32 v10, v10
  v_mfma_f32_16x16x32_bf16 v[12:15], a[152:155], v[152:155], v[12:15]
  ds_read_b128 a[136:139], v214 offset:8192
  v_mfma_f32_16x16x32_bf16 v[12:15], a[148:151], v[148:151], v[12:15]
  v_exp_f32 v11, v11
  v_mfma_f32_16x16x32_bf16 v[12:15], a[144:147], v[144:147], v[12:15]
  ds_read_b128 a[140:143], v215 offset:8192
  v_cvt_pk_bf16_f32 v9, v10, v11
  v_mfma_f32_16x16x32_bf16 v[20:23], a[144:147], v[160:163], v[200:203]
  v_exp_f32 v16, v16
  v_mfma_f32_16x16x32_bf16 v[20:23], a[148:151], v[164:167], v[20:23]
  buffer_load_dwordx4 v233, s[12:15], s29 offen offset:1024 lds
  v_mfma_f32_16x16x32_bf16 v[20:23], a[152:155], v[168:171], v[20:23]
  v_exp_f32 v17, v17
  v_mfma_f32_16x16x32_bf16 v[20:23], a[156:159], v[172:175], v[20:23]
  v_cvt_pk_bf16_f32 v16, v16, v17
  v_mfma_f32_16x16x32_bf16 v[28:31], a[156:159], v[188:191], v[204:207]
  v_exp_f32 v18, v18
  v_mfma_f32_16x16x32_bf16 v[28:31], a[152:155], v[184:187], v[28:31]
  buffer_load_dwordx4 v234, s[12:15], s29 offen offset:2048 lds
  v_mfma_f32_16x16x32_bf16 v[28:31], a[148:151], v[180:183], v[28:31]
  s_waitcnt lgkmcnt(0)
  v_exp_f32 v19, v19
  v_mfma_f32_16x16x32_bf16 v[28:31], a[144:147], v[176:179], v[28:31]
  v_cvt_pk_bf16_f32 v17, v18, v19
  v_mfma_f32_16x16x32_bf16 v[32:35], a[128:131], v[128:131], v[192:195]
  v_exp_f32 v24, v24
  v_mfma_f32_16x16x32_bf16 v[32:35], a[132:135], v[132:135], v[32:35]
  ds_read_b128 a[144:147], v212 offset:12288
  v_mfma_f32_16x16x32_bf16 v[32:35], a[136:139], v[136:139], v[32:35]
  v_exp_f32 v25, v25
  v_mfma_f32_16x16x32_bf16 v[32:35], a[140:143], v[140:143], v[32:35]
  ds_read_b128 a[148:151], v213 offset:12288
  v_cvt_pk_bf16_f32 v24, v24, v25
  v_mfma_f32_16x16x32_bf16 v[40:43], a[140:143], v[156:159], v[196:199]
  v_exp_f32 v26, v26
  v_mfma_f32_16x16x32_bf16 v[40:43], a[136:139], v[152:155], v[40:43]
  ds_read_b128 a[152:155], v214 offset:12288
  v_mfma_f32_16x16x32_bf16 v[40:43], a[132:135], v[148:151], v[40:43]
  v_exp_f32 v27, v27
  v_mfma_f32_16x16x32_bf16 v[40:43], a[128:131], v[144:147], v[40:43]
  ds_read_b128 a[156:159], v215 offset:12288
  v_cvt_pk_bf16_f32 v25, v26, v27
  v_mfma_f32_16x16x32_bf16 v[48:51], a[128:131], v[160:163], v[200:203]
  v_exp_f32 v4, v4
  v_mfma_f32_16x16x32_bf16 v[48:51], a[132:135], v[164:167], v[48:51]
  buffer_load_dwordx4 v235, s[12:15], s29 offen offset:3072 lds
  v_mfma_f32_16x16x32_bf16 v[48:51], a[136:139], v[168:171], v[48:51]
  v_exp_f32 v5, v5
  v_mfma_f32_16x16x32_bf16 v[48:51], a[140:143], v[172:175], v[48:51]
  v_cvt_pk_bf16_f32 v2, v4, v5
  v_mfma_f32_16x16x32_bf16 v[56:59], a[140:143], v[188:191], v[204:207]
  s_add_u32 m0, s50, 4096
  v_exp_f32 v6, v6
  v_mfma_f32_16x16x32_bf16 v[56:59], a[136:139], v[184:187], v[56:59]
  buffer_load_dwordx4 v208, s[20:23], s30 offen lds
  s_add_u32 s30, s30, 32
  v_mfma_f32_16x16x32_bf16 v[56:59], a[132:135], v[180:183], v[56:59]
  s_waitcnt lgkmcnt(0)
  v_exp_f32 v7, v7
  v_mfma_f32_16x16x32_bf16 v[56:59], a[128:131], v[176:179], v[56:59]
  v_cvt_pk_bf16_f32 v3, v6, v7
  v_mfma_f32_16x16x32_bf16 v[36:39], a[144:147], v[128:131], v[192:195]
  v_exp_f32 v12, v12
  v_mfma_f32_16x16x32_bf16 v[36:39], a[148:151], v[132:135], v[36:39]
  ds_read_b64_tr_b16 a[160:161], v216 offset:49152
  v_mfma_f32_16x16x32_bf16 v[36:39], a[152:155], v[136:139], v[36:39]
  v_exp_f32 v13, v13
  v_mfma_f32_16x16x32_bf16 v[36:39], a[156:159], v[140:143], v[36:39]
  ds_read_b64_tr_b16 a[162:163], v216 offset:53248
  v_cvt_pk_bf16_f32 v10, v12, v13
  v_mfma_f32_16x16x32_bf16 v[44:47], a[156:159], v[156:159], v[196:199]
  v_exp_f32 v14, v14
  v_mfma_f32_16x16x32_bf16 v[44:47], a[152:155], v[152:155], v[44:47]
  ds_read_b64_tr_b16 a[164:165], v216 offset:57344
  v_mfma_f32_16x16x32_bf16 v[44:47], a[148:151], v[148:151], v[44:47]
  v_exp_f32 v15, v15
  v_mfma_f32_16x16x32_bf16 v[44:47], a[144:147], v[144:147], v[44:47]
  ds_read_b64_tr_b16 a[166:167], v216 offset:61440
  v_cvt_pk_bf16_f32 v11, v14, v15
  v_mfma_f32_16x16x32_bf16 v[52:55], a[144:147], v[160:163], v[200:203]
  v_exp_f32 v20, v20
  v_mfma_f32_16x16x32_bf16 v[52:55], a[148:151], v[164:167], v[52:55]
  ds_read_b64_tr_b16 a[168:169], v217 offset:49152
  v_mfma_f32_16x16x32_bf16 v[52:55], a[152:155], v[168:171], v[52:55]
  v_exp_f32 v21, v21
  v_mfma_f32_16x16x32_bf16 v[52:55], a[156:159], v[172:175], v[52:55]
  ds_read_b64_tr_b16 a[170:171], v217 offset:53248
  v_cvt_pk_bf16_f32 v18, v20, v21
  v_mfma_f32_16x16x32_bf16 v[60:63], a[156:159], v[188:191], v[204:207]
  v_exp_f32 v22, v22
  v_mfma_f32_16x16x32_bf16 v[60:63], a[152:155], v[184:187], v[60:63]
  ds_read_b64_tr_b16 a[172:173], v217 offset:57344
  v_mfma_f32_16x16x32_bf16 v[60:63], a[148:151], v[180:183], v[60:63]
  v_exp_f32 v23, v23
  v_mfma_f32_16x16x32_bf16 v[60:63], a[144:147], v[176:179], v[60:63]
  ds_read_b64_tr_b16 a[174:175], v217 offset:61440
  v_cvt_pk_bf16_f32 v19, v22, v23
  v_mfma_f32_16x16x32_bf16 a[192:195], a[208:211], v[64:67], a[192:195]
  v_exp_f32 v28, v28
  v_mfma_f32_16x16x32_bf16 a[192:195], a[208:211], v[96:99], a[192:195]
  ds_read_b64_tr_b16 a[176:177], v218 offset:49152
  v_mfma_f32_16x16x32_bf16 a[196:199], a[208:211], v[72:75], a[196:199]
  v_exp_f32 v29, v29
  v_mfma_f32_16x16x32_bf16 a[196:199], a[208:211], v[104:107], a[196:199]
  ds_read_b64_tr_b16 a[178:179], v218 offset:53248
  v_cvt_pk_bf16_f32 v26, v28, v29
  v_mfma_f32_16x16x32_bf16 a[200:203], a[208:211], v[80:83], a[200:203]
  v_exp_f32 v30, v30
  v_mfma_f32_16x16x32_bf16 a[200:203], a[208:211], v[112:115], a[200:203]
  ds_read_b64_tr_b16 a[180:181], v218 offset:57344
  v_mfma_f32_16x16x32_bf16 a[204:207], a[208:211], v[88:91], a[204:207]
  s_waitcnt lgkmcnt(7)
  v_exp_f32 v31, v31
  v_mfma_f32_16x16x32_bf16 a[204:207], a[208:211], v[120:123], a[204:207]
  ds_read_b64_tr_b16 a[182:183], v218 offset:61440
  v_cvt_pk_bf16_f32 v27, v30, v31
  v_mfma_f32_16x16x32_bf16 a[0:3], a[160:163], v[64:67], a[0:3]
  v_exp_f32 v32, v32
  v_mfma_f32_16x16x32_bf16 a[0:3], a[164:167], v[96:99], a[0:3]
  ds_read_b64_tr_b16 a[184:185], v219 offset:49152
  v_mfma_f32_16x16x32_bf16 a[4:7], a[164:167], v[104:107], a[4:7]
  v_exp_f32 v33, v33
  v_mfma_f32_16x16x32_bf16 a[4:7], a[160:163], v[72:75], a[4:7]
  ds_read_b64_tr_b16 a[186:187], v219 offset:53248
  v_cvt_pk_bf16_f32 v32, v32, v33
  v_mfma_f32_16x16x32_bf16 a[8:11], a[160:163], v[80:83], a[8:11]
  v_exp_f32 v34, v34
  v_mfma_f32_16x16x32_bf16 a[8:11], a[164:167], v[112:115], a[8:11]
  ds_read_b64_tr_b16 a[188:189], v219 offset:57344
  v_mfma_f32_16x16x32_bf16 a[12:15], a[164:167], v[120:123], a[12:15]
  s_waitcnt lgkmcnt(7)
  v_exp_f32 v35, v35
  v_mfma_f32_16x16x32_bf16 a[12:15], a[160:163], v[88:91], a[12:15]
  ds_read_b64_tr_b16 a[190:191], v219 offset:61440
  v_cvt_pk_bf16_f32 v33, v34, v35
  v_mfma_f32_16x16x32_bf16 a[16:19], a[168:171], v[64:67], a[16:19]
  v_exp_f32 v40, v40
  v_mfma_f32_16x16x32_bf16 a[16:19], a[172:175], v[96:99], a[16:19]
  ds_read_b64_tr_b16 a[160:161], v220 offset:49152
  v_mfma_f32_16x16x32_bf16 a[20:23], a[172:175], v[104:107], a[20:23]
  v_exp_f32 v41, v41
  v_mfma_f32_16x16x32_bf16 a[20:23], a[168:171], v[72:75], a[20:23]
  ds_read_b64_tr_b16 a[162:163], v220 offset:53248
  v_cvt_pk_bf16_f32 v40, v40, v41
  v_mfma_f32_16x16x32_bf16 a[24:27], a[168:171], v[80:83], a[24:27]
  v_exp_f32 v42, v42
  v_mfma_f32_16x16x32_bf16 a[24:27], a[172:175], v[112:115], a[24:27]
  ds_read_b64_tr_b16 a[164:165], v220 offset:57344
  v_mfma_f32_16x16x32_bf16 a[28:31], a[172:175], v[120:123], a[28:31]
  s_waitcnt lgkmcnt(7)
  v_exp_f32 v43, v43
  v_mfma_f32_16x16x32_bf16 a[28:31], a[168:171], v[88:91], a[28:31]
  ds_read_b64_tr_b16 a[166:167], v220 offset:61440
  v_cvt_pk_bf16_f32 v41, v42, v43
  v_mfma_f32_16x16x32_bf16 a[32:35], a[176:179], v[64:67], a[32:35]
  v_exp_f32 v48, v48
  v_mfma_f32_16x16x32_bf16 a[32:35], a[180:183], v[96:99], a[32:35]
  ds_read_b64_tr_b16 a[168:169], v221 offset:49152
  v_mfma_f32_16x16x32_bf16 a[36:39], a[180:183], v[104:107], a[36:39]
  v_exp_f32 v49, v49
  v_mfma_f32_16x16x32_bf16 a[36:39], a[176:179], v[72:75], a[36:39]
  ds_read_b64_tr_b16 a[170:171], v221 offset:53248
  v_cvt_pk_bf16_f32 v48, v48, v49
  v_mfma_f32_16x16x32_bf16 a[40:43], a[176:179], v[80:83], a[40:43]
  v_exp_f32 v50, v50
  v_mfma_f32_16x16x32_bf16 a[40:43], a[180:183], v[112:115], a[40:43]
  ds_read_b64_tr_b16 a[172:173], v221 offset:57344
  v_mfma_f32_16x16x32_bf16 a[44:47], a[180:183], v[120:123], a[44:47]
  s_waitcnt lgkmcnt(7)
  v_exp_f32 v51, v51
  v_mfma_f32_16x16x32_bf16 a[44:47], a[176:179], v[88:91], a[44:47]
  ds_read_b64_tr_b16 a[174:175], v221 offset:61440
  v_cvt_pk_bf16_f32 v49, v50, v51
  v_mfma_f32_16x16x32_bf16 a[48:51], a[184:187], v[64:67], a[48:51]
  v_exp_f32 v56, v56
  v_mfma_f32_16x16x32_bf16 a[48:51], a[188:191], v[96:99], a[48:51]
  ds_read_b64_tr_b16 a[176:177], v222 offset:49152
  v_mfma_f32_16x16x32_bf16 a[52:55], a[188:191], v[104:107], a[52:55]
  v_exp_f32 v57, v57
  v_mfma_f32_16x16x32_bf16 a[52:55], a[184:187], v[72:75], a[52:55]
  ds_read_b64_tr_b16 a[178:179], v222 offset:53248
  v_cvt_pk_bf16_f32 v56, v56, v57
  v_mfma_f32_16x16x32_bf16 a[56:59], a[184:187], v[80:83], a[56:59]
  v_exp_f32 v58, v58
  v_mfma_f32_16x16x32_bf16 a[56:59], a[188:191], v[112:115], a[56:59]
  ds_read_b64_tr_b16 a[180:181], v222 offset:57344
  v_mfma_f32_16x16x32_bf16 a[60:63], a[188:191], v[120:123], a[60:63]
  s_waitcnt lgkmcnt(7)
  v_exp_f32 v59, v59
  v_mfma_f32_16x16x32_bf16 a[60:63], a[184:187], v[88:91], a[60:63]
  ds_read_b64_tr_b16 a[182:183], v222 offset:61440
  v_cvt_pk_bf16_f32 v57, v58, v59
  v_mfma_f32_16x16x32_bf16 a[64:67], a[160:163], v[64:67], a[64:67]
  v_exp_f32 v36, v36
  v_mfma_f32_16x16x32_bf16 a[64:67], a[164:167], v[96:99], a[64:67]
  ds_read_b64_tr_b16 a[184:185], v223 offset:49152
  v_mfma_f32_16x16x32_bf16 a[68:71], a[164:167], v[104:107], a[68:71]
  v_exp_f32 v37, v37
  v_mfma_f32_16x16x32_bf16 a[68:71], a[160:163], v[72:75], a[68:71]
  ds_read_b64_tr_b16 a[186:187], v223 offset:53248
  v_cvt_pk_bf16_f32 v34, v36, v37
  v_mfma_f32_16x16x32_bf16 a[72:75], a[160:163], v[80:83], a[72:75]
  v_exp_f32 v38, v38
  v_mfma_f32_16x16x32_bf16 a[72:75], a[164:167], v[112:115], a[72:75]
  ds_read_b64_tr_b16 a[188:189], v223 offset:57344
  v_mfma_f32_16x16x32_bf16 a[76:79], a[164:167], v[120:123], a[76:79]
  s_waitcnt lgkmcnt(7)
  v_exp_f32 v39, v39
  v_mfma_f32_16x16x32_bf16 a[76:79], a[160:163], v[88:91], a[76:79]
  ds_read_b64_tr_b16 a[190:191], v223 offset:61440
  v_cvt_pk_bf16_f32 v35, v38, v39
  v_mfma_f32_16x16x32_bf16 a[80:83], a[168:171], v[64:67], a[80:83]
  s_waitcnt vmcnt(10)
  v_exp_f32 v44, v44
  v_mfma_f32_16x16x32_bf16 a[80:83], a[172:175], v[96:99], a[80:83]
  v_mfma_f32_16x16x32_bf16 a[84:87], a[172:175], v[104:107], a[84:87]
  s_barrier
  v_exp_f32 v45, v45
  v_mfma_f32_16x16x32_bf16 a[84:87], a[168:171], v[72:75], a[84:87]
  ds_read_b128 a[128:131], v212 offset:16384
  v_cvt_pk_bf16_f32 v42, v44, v45
  v_mfma_f32_16x16x32_bf16 a[88:91], a[168:171], v[80:83], a[88:91]
  v_exp_f32 v46, v46
  v_mfma_f32_16x16x32_bf16 a[88:91], a[172:175], v[112:115], a[88:91]
  ds_read_b128 a[132:135], v213 offset:16384
  v_mfma_f32_16x16x32_bf16 a[92:95], a[172:175], v[120:123], a[92:95]
  s_waitcnt lgkmcnt(6)
  v_exp_f32 v47, v47
  v_mfma_f32_16x16x32_bf16 a[92:95], a[168:171], v[88:91], a[92:95]
  ds_read_b128 a[136:139], v214 offset:16384
  v_cvt_pk_bf16_f32 v43, v46, v47
  v_mfma_f32_16x16x32_bf16 a[96:99], a[176:179], v[64:67], a[96:99]
  v_exp_f32 v52, v52
  v_mfma_f32_16x16x32_bf16 a[96:99], a[180:183], v[96:99], a[96:99]
  ds_read_b128 a[140:143], v215 offset:16384
  v_mfma_f32_16x16x32_bf16 a[100:103], a[180:183], v[104:107], a[100:103]
  v_exp_f32 v53, v53
  v_mfma_f32_16x16x32_bf16 a[100:103], a[176:179], v[72:75], a[100:103]
  v_cvt_pk_bf16_f32 v50, v52, v53
  v_mfma_f32_16x16x32_bf16 a[104:107], a[176:179], v[80:83], a[104:107]
  v_exp_f32 v54, v54
  v_mfma_f32_16x16x32_bf16 a[104:107], a[180:183], v[112:115], a[104:107]
  v_mfma_f32_16x16x32_bf16 a[108:111], a[180:183], v[120:123], a[108:111]
  s_waitcnt lgkmcnt(4)
  v_exp_f32 v55, v55
  v_mfma_f32_16x16x32_bf16 a[108:111], a[176:179], v[88:91], a[108:111]
  v_cvt_pk_bf16_f32 v51, v54, v55
  v_mfma_f32_16x16x32_bf16 a[112:115], a[184:187], v[64:67], a[112:115]
  v_exp_f32 v60, v60
  v_mfma_f32_16x16x32_bf16 a[112:115], a[188:191], v[96:99], a[112:115]
  v_mfma_f32_16x16x32_bf16 a[116:119], a[188:191], v[104:107], a[116:119]
  v_exp_f32 v61, v61
  v_mfma_f32_16x16x32_bf16 a[116:119], a[184:187], v[72:75], a[116:119]
  v_cvt_pk_bf16_f32 v58, v60, v61
  v_mfma_f32_16x16x32_bf16 a[120:123], a[184:187], v[80:83], a[120:123]
  v_exp_f32 v62, v62
  v_mfma_f32_16x16x32_bf16 a[120:123], a[188:191], v[112:115], a[120:123]
  v_mfma_f32_16x16x32_bf16 a[124:127], a[188:191], v[120:123], a[124:127]
  s_waitcnt lgkmcnt(0)
  v_exp_f32 v63, v63
  v_mfma_f32_16x16x32_bf16 a[124:127], a[184:187], v[88:91], a[124:127]
  v_cvt_pk_bf16_f32 v59, v62, v63
  v_mfma_f32_16x16x32_bf16 v[64:67], a[128:131], v[128:131], v[192:195]
  s_add_u32 m0, s28, 98304
  v_mfma_f32_16x16x32_bf16 v[64:67], a[132:135], v[132:135], v[64:67]
  ds_read_b128 a[144:147], v212 offset:20480
  v_mfma_f32_16x16x32_bf16 v[64:67], a[136:139], v[136:139], v[64:67]
  buffer_load_dwordx4 v236, s[16:19], s29 offen offset:0 lds
  v_mfma_f32_16x16x32_bf16 v[64:67], a[140:143], v[140:143], v[64:67]
  ds_read_b128 a[148:151], v213 offset:20480
  v_mfma_f32_16x16x32_bf16 v[72:75], a[140:143], v[156:159], v[196:199]
  buffer_load_dwordx4 v237, s[16:19], s29 offen offset:1024 lds
  v_mfma_f32_16x16x32_bf16 v[72:75], a[136:139], v[152:155], v[72:75]
  ds_read_b128 a[152:155], v214 offset:20480
  v_mfma_f32_16x16x32_bf16 v[72:75], a[132:135], v[148:151], v[72:75]
  buffer_load_dwordx4 v236, s[16:19], s29 offen offset:2048 lds
  v_mfma_f32_16x16x32_bf16 v[72:75], a[128:131], v[144:147], v[72:75]
  ds_read_b128 a[156:159], v215 offset:20480
  v_mfma_f32_16x16x32_bf16 v[80:83], a[128:131], v[160:163], v[200:203]
  v_exp_f32 v64, v64
  v_mfma_f32_16x16x32_bf16 v[80:83], a[132:135], v[164:167], v[80:83]
  buffer_load_dwordx4 v237, s[16:19], s29 offen offset:3072 lds
  v_mfma_f32_16x16x32_bf16 v[80:83], a[136:139], v[168:171], v[80:83]
  s_add_u32 s29, s29, 16384
  v_exp_f32 v65, v65
  v_mfma_f32_16x16x32_bf16 v[80:83], a[140:143], v[172:175], v[80:83]
  v_cvt_pk_bf16_f32 v64, v64, v65
  v_mfma_f32_16x16x32_bf16 v[88:91], a[140:143], v[188:191], v[204:207]
  s_add_u32 m0, s28, 49152
  v_exp_f32 v66, v66
  v_mfma_f32_16x16x32_bf16 v[88:91], a[136:139], v[184:187], v[88:91]
  buffer_load_dwordx4 v232, s[12:15], s29 offen offset:0 lds
  v_mfma_f32_16x16x32_bf16 v[88:91], a[132:135], v[180:183], v[88:91]
  s_waitcnt lgkmcnt(0)
  v_exp_f32 v67, v67
  v_mfma_f32_16x16x32_bf16 v[88:91], a[128:131], v[176:179], v[88:91]
  v_cvt_pk_bf16_f32 v65, v66, v67
  v_mfma_f32_16x16x32_bf16 v[68:71], a[144:147], v[128:131], v[192:195]
  v_exp_f32 v72, v72
  v_mfma_f32_16x16x32_bf16 v[68:71], a[148:151], v[132:135], v[68:71]
  ds_read_b128 a[128:131], v212 offset:24576
  v_mfma_f32_16x16x32_bf16 v[68:71], a[152:155], v[136:139], v[68:71]
  v_exp_f32 v73, v73
  v_mfma_f32_16x16x32_bf16 v[68:71], a[156:159], v[140:143], v[68:71]
  ds_read_b128 a[132:135], v213 offset:24576
  v_cvt_pk_bf16_f32 v72, v72, v73
  v_mfma_f32_16x16x32_bf16 v[76:79], a[156:159], v[156:159], v[196:199]
  v_exp_f32 v74, v74
  v_mfma_f32_16x16x32_bf16 v[76:79], a[152:155], v[152:155], v[76:79]
  ds_read_b128 a[136:139], v214 offset:24576
  v_mfma_f32_16x16x32_bf16 v[76:79], a[148:151], v[148:151], v[76:79]
  v_exp_f32 v75, v75
  v_mfma_f32_16x16x32_bf16 v[76:79], a[144:147], v[144:147], v[76:79]
  ds_read_b128 a[140:143], v215 offset:24576
  v_cvt_pk_bf16_f32 v73, v74, v75
  v_mfma_f32_16x16x32_bf16 v[84:87], a[144:147], v[160:163], v[200:203]
  v_exp_f32 v80, v80
  v_mfma_f32_16x16x32_bf16 v[84:87], a[148:151], v[164:167], v[84:87]
  buffer_load_dwordx4 v233, s[12:15], s29 offen offset:1024 lds
  v_mfma_f32_16x16x32_bf16 v[84:87], a[152:155], v[168:171], v[84:87]
  v_exp_f32 v81, v81
  v_mfma_f32_16x16x32_bf16 v[84:87], a[156:159], v[172:175], v[84:87]
  v_cvt_pk_bf16_f32 v80, v80, v81
  v_mfma_f32_16x16x32_bf16 v[92:95], a[156:159], v[188:191], v[204:207]
  v_exp_f32 v82, v82
  v_mfma_f32_16x16x32_bf16 v[92:95], a[152:155], v[184:187], v[92:95]
  buffer_load_dwordx4 v234, s[12:15], s29 offen offset:2048 lds
  v_mfma_f32_16x16x32_bf16 v[92:95], a[148:151], v[180:183], v[92:95]
  s_waitcnt lgkmcnt(0)
  v_exp_f32 v83, v83
  v_mfma_f32_16x16x32_bf16 v[92:95], a[144:147], v[176:179], v[92:95]
  v_cvt_pk_bf16_f32 v81, v82, v83
  v_mfma_f32_16x16x32_bf16 v[96:99], a[128:131], v[128:131], v[192:195]
  v_exp_f32 v88, v88
  v_mfma_f32_16x16x32_bf16 v[96:99], a[132:135], v[132:135], v[96:99]
  ds_read_b128 a[144:147], v212 offset:28672
  v_mfma_f32_16x16x32_bf16 v[96:99], a[136:139], v[136:139], v[96:99]
  v_exp_f32 v89, v89
  v_mfma_f32_16x16x32_bf16 v[96:99], a[140:143], v[140:143], v[96:99]
  ds_read_b128 a[148:151], v213 offset:28672
  v_cvt_pk_bf16_f32 v88, v88, v89
  v_mfma_f32_16x16x32_bf16 v[104:107], a[140:143], v[156:159], v[196:199]
  v_exp_f32 v90, v90
  v_mfma_f32_16x16x32_bf16 v[104:107], a[136:139], v[152:155], v[104:107]
  ds_read_b128 a[152:155], v214 offset:28672
  v_mfma_f32_16x16x32_bf16 v[104:107], a[132:135], v[148:151], v[104:107]
  v_exp_f32 v91, v91
  v_mfma_f32_16x16x32_bf16 v[104:107], a[128:131], v[144:147], v[104:107]
  ds_read_b128 a[156:159], v215 offset:28672
  v_cvt_pk_bf16_f32 v89, v90, v91
  v_mfma_f32_16x16x32_bf16 v[112:115], a[128:131], v[160:163], v[200:203]
  v_exp_f32 v68, v68
  v_mfma_f32_16x16x32_bf16 v[112:115], a[132:135], v[164:167], v[112:115]
  buffer_load_dwordx4 v235, s[12:15], s29 offen offset:3072 lds
  v_mfma_f32_16x16x32_bf16 v[112:115], a[136:139], v[168:171], v[112:115]
  v_exp_f32 v69, v69
  v_mfma_f32_16x16x32_bf16 v[112:115], a[140:143], v[172:175], v[112:115]
  v_cvt_pk_bf16_f32 v66, v68, v69
  v_mfma_f32_16x16x32_bf16 v[120:123], a[140:143], v[188:191], v[204:207]
  s_add_u32 m0, s50, 5120
  v_exp_f32 v70, v70
  v_mfma_f32_16x16x32_bf16 v[120:123], a[136:139], v[184:187], v[120:123]
  buffer_load_dwordx4 v208, s[20:23], s30 offen lds
  s_add_u32 s30, s30, 32
  v_mfma_f32_16x16x32_bf16 v[120:123], a[132:135], v[180:183], v[120:123]
  s_waitcnt lgkmcnt(0)
  v_exp_f32 v71, v71
  v_mfma_f32_16x16x32_bf16 v[120:123], a[128:131], v[176:179], v[120:123]
  v_cvt_pk_bf16_f32 v67, v70, v71
  v_mfma_f32_16x16x32_bf16 v[100:103], a[144:147], v[128:131], v[192:195]
  v_exp_f32 v76, v76
  v_mfma_f32_16x16x32_bf16 v[100:103], a[148:151], v[132:135], v[100:103]
  ds_read_b64_tr_b16 a[160:161], v216 offset:0
  v_mfma_f32_16x16x32_bf16 v[100:103], a[152:155], v[136:139], v[100:103]
  v_exp_f32 v77, v77
  v_mfma_f32_16x16x32_bf16 v[100:103], a[156:159], v[140:143], v[100:103]
  ds_read_b64_tr_b16 a[162:163], v216 offset:4096
  v_cvt_pk_bf16_f32 v74, v76, v77
  v_mfma_f32_16x16x32_bf16 v[108:111], a[156:159], v[156:159], v[196:199]
  v_exp_f32 v78, v78
  v_mfma_f32_16x16x32_bf16 v[108:111], a[152:155], v[152:155], v[108:111]
  ds_read_b64_tr_b16 a[164:165], v216 offset:8192
  v_mfma_f32_16x16x32_bf16 v[108:111], a[148:151], v[148:151], v[108:111]
  v_exp_f32 v79, v79
  v_mfma_f32_16x16x32_bf16 v[108:111], a[144:147], v[144:147], v[108:111]
  ds_read_b64_tr_b16 a[166:167], v216 offset:12288
  v_cvt_pk_bf16_f32 v75, v78, v79
  v_mfma_f32_16x16x32_bf16 v[116:119], a[144:147], v[160:163], v[200:203]
  v_exp_f32 v84, v84
  v_mfma_f32_16x16x32_bf16 v[116:119], a[148:151], v[164:167], v[116:119]
  ds_read_b64_tr_b16 a[168:169], v217 offset:0
  v_mfma_f32_16x16x32_bf16 v[116:119], a[152:155], v[168:171], v[116:119]
  v_exp_f32 v85, v85
  v_mfma_f32_16x16x32_bf16 v[116:119], a[156:159], v[172:175], v[116:119]
  ds_read_b64_tr_b16 a[170:171], v217 offset:4096
  v_cvt_pk_bf16_f32 v82, v84, v85
  v_mfma_f32_16x16x32_bf16 v[124:127], a[156:159], v[188:191], v[204:207]
  v_exp_f32 v86, v86
  v_mfma_f32_16x16x32_bf16 v[124:127], a[152:155], v[184:187], v[124:127]
  ds_read_b64_tr_b16 a[172:173], v217 offset:8192
  v_mfma_f32_16x16x32_bf16 v[124:127], a[148:151], v[180:183], v[124:127]
  v_exp_f32 v87, v87
  v_mfma_f32_16x16x32_bf16 v[124:127], a[144:147], v[176:179], v[124:127]
  ds_read_b64_tr_b16 a[174:175], v217 offset:12288
  v_cvt_pk_bf16_f32 v83, v86, v87
  v_mfma_f32_16x16x32_bf16 a[192:195], a[208:211], v[0:3], a[192:195]
  v_exp_f32 v92, v92
  v_mfma_f32_16x16x32_bf16 a[192:195], a[208:211], v[32:35], a[192:195]
  ds_read_b64_tr_b16 a[176:177], v218 offset:0
  v_mfma_f32_16x16x32_bf16 a[196:199], a[208:211], v[8:11], a[196:199]
  v_exp_f32 v93, v93
  v_mfma_f32_16x16x32_bf16 a[196:199], a[208:211], v[40:43], a[196:199]
  ds_read_b64_tr_b16 a[178:179], v218 offset:4096
  v_cvt_pk_bf16_f32 v90, v92, v93
  v_mfma_f32_16x16x32_bf16 a[200:203], a[208:211], v[16:19], a[200:203]
  v_exp_f32 v94, v94
  v_mfma_f32_16x16x32_bf16 a[200:203], a[208:211], v[48:51], a[200:203]
  ds_read_b64_tr_b16 a[180:181], v218 offset:8192
  v_mfma_f32_16x16x32_bf16 a[204:207], a[208:211], v[24:27], a[204:207]
  s_waitcnt lgkmcnt(7)
  v_exp_f32 v95, v95
  v_mfma_f32_16x16x32_bf16 a[204:207], a[208:211], v[56:59], a[204:207]
  ds_read_b64_tr_b16 a[182:183], v218 offset:12288
  v_cvt_pk_bf16_f32 v91, v94, v95
  v_mfma_f32_16x16x32_bf16 a[0:3], a[160:163], v[0:3], a[0:3]
  v_exp_f32 v96, v96
  v_mfma_f32_16x16x32_bf16 a[0:3], a[164:167], v[32:35], a[0:3]
  ds_read_b64_tr_b16 a[184:185], v219 offset:0
  v_mfma_f32_16x16x32_bf16 a[4:7], a[164:167], v[40:43], a[4:7]
  v_exp_f32 v97, v97
  v_mfma_f32_16x16x32_bf16 a[4:7], a[160:163], v[8:11], a[4:7]
  ds_read_b64_tr_b16 a[186:187], v219 offset:4096
  v_cvt_pk_bf16_f32 v96, v96, v97
  v_mfma_f32_16x16x32_bf16 a[8:11], a[160:163], v[16:19], a[8:11]
  v_exp_f32 v98, v98
  v_mfma_f32_16x16x32_bf16 a[8:11], a[164:167], v[48:51], a[8:11]
  ds_read_b64_tr_b16 a[188:189], v219 offset:8192
  v_mfma_f32_16x16x32_bf16 a[12:15], a[164:167], v[56:59], a[12:15]
  s_waitcnt lgkmcnt(7)
  v_exp_f32 v99, v99
  v_mfma_f32_16x16x32_bf16 a[12:15], a[160:163], v[24:27], a[12:15]
  ds_read_b64_tr_b16 a[190:191], v219 offset:12288
  v_cvt_pk_bf16_f32 v97, v98, v99
  v_mfma_f32_16x16x32_bf16 a[16:19], a[168:171], v[0:3], a[16:19]
  v_exp_f32 v104, v104
  v_mfma_f32_16x16x32_bf16 a[16:19], a[172:175], v[32:35], a[16:19]
  ds_read_b64_tr_b16 a[160:161], v220 offset:0
  v_mfma_f32_16x16x32_bf16 a[20:23], a[172:175], v[40:43], a[20:23]
  v_exp_f32 v105, v105
  v_mfma_f32_16x16x32_bf16 a[20:23], a[168:171], v[8:11], a[20:23]
  ds_read_b64_tr_b16 a[162:163], v220 offset:4096
  v_cvt_pk_bf16_f32 v104, v104, v105
  v_mfma_f32_16x16x32_bf16 a[24:27], a[168:171], v[16:19], a[24:27]
  v_exp_f32 v106, v106
  v_mfma_f32_16x16x32_bf16 a[24:27], a[172:175], v[48:51], a[24:27]
  ds_read_b64_tr_b16 a[164:165], v220 offset:8192
  v_mfma_f32_16x16x32_bf16 a[28:31], a[172:175], v[56:59], a[28:31]
  s_waitcnt lgkmcnt(7)
  v_exp_f32 v107, v107
  v_mfma_f32_16x16x32_bf16 a[28:31], a[168:171], v[24:27], a[28:31]
  ds_read_b64_tr_b16 a[166:167], v220 offset:12288
  v_cvt_pk_bf16_f32 v105, v106, v107
  v_mfma_f32_16x16x32_bf16 a[32:35], a[176:179], v[0:3], a[32:35]
  v_exp_f32 v112, v112
  v_mfma_f32_16x16x32_bf16 a[32:35], a[180:183], v[32:35], a[32:35]
  ds_read_b64_tr_b16 a[168:169], v221 offset:0
  v_mfma_f32_16x16x32_bf16 a[36:39], a[180:183], v[40:43], a[36:39]
  v_exp_f32 v113, v113
  v_mfma_f32_16x16x32_bf16 a[36:39], a[176:179], v[8:11], a[36:39]
  ds_read_b64_tr_b16 a[170:171], v221 offset:4096
  v_cvt_pk_bf16_f32 v112, v112, v113
  v_mfma_f32_16x16x32_bf16 a[40:43], a[176:179], v[16:19], a[40:43]
  v_exp_f32 v114, v114
  v_mfma_f32_16x16x32_bf16 a[40:43], a[180:183], v[48:51], a[40:43]
  ds_read_b64_tr_b16 a[172:173], v221 offset:8192
  v_mfma_f32_16x16x32_bf16 a[44:47], a[180:183], v[56:59], a[44:47]
  s_waitcnt lgkmcnt(7)
  v_exp_f32 v115, v115
  v_mfma_f32_16x16x32_bf16 a[44:47], a[176:179], v[24:27], a[44:47]
  ds_read_b64_tr_b16 a[174:175], v221 offset:12288
  v_cvt_pk_bf16_f32 v113, v114, v115
  v_mfma_f32_16x16x32_bf16 a[48:51], a[184:187], v[0:3], a[48:51]
  v_exp_f32 v120, v120
  v_mfma_f32_16x16x32_bf16 a[48:51], a[188:191], v[32:35], a[48:51]
  ds_read_b64_tr_b16 a[176:177], v222 offset:0
  v_mfma_f32_16x16x32_bf16 a[52:55], a[188:191], v[40:43], a[52:55]
  v_exp_f32 v121, v121
  v_mfma_f32_16x16x32_bf16 a[52:55], a[184:187], v[8:11], a[52:55]
  ds_read_b64_tr_b16 a[178:179], v222 offset:4096
  v_cvt_pk_bf16_f32 v120, v120, v121
  v_mfma_f32_16x16x32_bf16 a[56:59], a[184:187], v[16:19], a[56:59]
  v_exp_f32 v122, v122
  v_mfma_f32_16x16x32_bf16 a[56:59], a[188:191], v[48:51], a[56:59]
  ds_read_b64_tr_b16 a[180:181], v222 offset:8192
  v_mfma_f32_16x16x32_bf16 a[60:63], a[188:191], v[56:59], a[60:63]
  s_waitcnt lgkmcnt(7)
  v_exp_f32 v123, v123
  v_mfma_f32_16x16x32_bf16 a[60:63], a[184:187], v[24:27], a[60:63]
  ds_read_b64_tr_b16 a[182:183], v222 offset:12288
  v_cvt_pk_bf16_f32 v121, v122, v123
  v_mfma_f32_16x16x32_bf16 a[64:67], a[160:163], v[0:3], a[64:67]
  v_exp_f32 v100, v100
  v_mfma_f32_16x16x32_bf16 a[64:67], a[164:167], v[32:35], a[64:67]
  ds_read_b64_tr_b16 a[184:185], v223 offset:0
  v_mfma_f32_16x16x32_bf16 a[68:71], a[164:167], v[40:43], a[68:71]
  v_exp_f32 v101, v101
  v_mfma_f32_16x16x32_bf16 a[68:71], a[160:163], v[8:11], a[68:71]
  ds_read_b64_tr_b16 a[186:187], v223 offset:4096
  v_cvt_pk_bf16_f32 v98, v100, v101
  v_mfma_f32_16x16x32_bf16 a[72:75], a[160:163], v[16:19], a[72:75]
  v_exp_f32 v102, v102
  v_mfma_f32_16x16x32_bf16 a[72:75], a[164:167], v[48:51], a[72:75]
  ds_read_b64_tr_b16 a[188:189], v223 offset:8192
  v_mfma_f32_16x16x32_bf16 a[76:79], a[164:167], v[56:59], a[76:79]
  s_waitcnt lgkmcnt(7)
  v_exp_f32 v103, v103
  v_mfma_f32_16x16x32_bf16 a[76:79], a[160:163], v[24:27], a[76:79]
  ds_read_b64_tr_b16 a[190:191], v223 offset:12288
  v_cvt_pk_bf16_f32 v99, v102, v103
  v_mfma_f32_16x16x32_bf16 a[80:83], a[168:171], v[0:3], a[80:83]
  s_waitcnt vmcnt(10)
  v_exp_f32 v108, v108
  v_mfma_f32_16x16x32_bf16 a[80:83], a[172:175], v[32:35], a[80:83]
  v_mfma_f32_16x16x32_bf16 a[84:87], a[172:175], v[40:43], a[84:87]
  s_barrier
  v_exp_f32 v109, v109
  v_mfma_f32_16x16x32_bf16 a[84:87], a[168:171], v[8:11], a[84:87]
  ds_read_b128 a[128:131], v212 offset:32768
  v_cvt_pk_bf16_f32 v106, v108, v109
  v_mfma_f32_16x16x32_bf16 a[88:91], a[168:171], v[16:19], a[88:91]
  v_exp_f32 v110, v110
  v_mfma_f32_16x16x32_bf16 a[88:91], a[172:175], v[48:51], a[88:91]
  ds_read_b128 a[132:135], v213 offset:32768
  buffer_atomic_add v250, v249, s[24:27], s47 offen
  s_cmp_eq_u32 s32, 4
  s_cselect_b32 s39, 0, 1073741824
  v_mfma_f32_16x16x32_bf16 a[92:95], a[172:175], v[56:59], a[92:95]
  s_waitcnt lgkmcnt(6)
  v_exp_f32 v111, v111
  v_mfma_f32_16x16x32_bf16 a[92:95], a[168:171], v[24:27], a[92:95]
  ds_read_b128 a[136:139], v214 offset:32768
  v_cvt_pk_bf16_f32 v107, v110, v111
  v_mfma_f32_16x16x32_bf16 a[96:99], a[176:179], v[0:3], a[96:99]
  v_exp_f32 v116, v116
  v_mfma_f32_16x16x32_bf16 a[96:99], a[180:183], v[32:35], a[96:99]
  ds_read_b128 a[140:143], v215 offset:32768
  v_or_b32 v249, s39, v251
  v_mfma_f32_16x16x32_bf16 a[100:103], a[180:183], v[40:43], a[100:103]
  v_exp_f32 v117, v117
  v_mfma_f32_16x16x32_bf16 a[100:103], a[176:179], v[8:11], a[100:103]
  v_cvt_pk_bf16_f32 v114, v116, v117
  v_mfma_f32_16x16x32_bf16 a[104:107], a[176:179], v[16:19], a[104:107]
  v_exp_f32 v118, v118
  v_mfma_f32_16x16x32_bf16 a[104:107], a[180:183], v[48:51], a[104:107]
  v_mfma_f32_16x16x32_bf16 a[108:111], a[180:183], v[56:59], a[108:111]
  s_waitcnt lgkmcnt(4)
  v_exp_f32 v119, v119
  v_mfma_f32_16x16x32_bf16 a[108:111], a[176:179], v[24:27], a[108:111]
  v_cvt_pk_bf16_f32 v115, v118, v119
  v_mfma_f32_16x16x32_bf16 a[112:115], a[184:187], v[0:3], a[112:115]
  v_exp_f32 v124, v124
  v_mfma_f32_16x16x32_bf16 a[112:115], a[188:191], v[32:35], a[112:115]
  v_mfma_f32_16x16x32_bf16 a[116:119], a[188:191], v[40:43], a[116:119]
  v_exp_f32 v125, v125
  v_mfma_f32_16x16x32_bf16 a[116:119], a[184:187], v[8:11], a[116:119]
  v_cvt_pk_bf16_f32 v122, v124, v125
  v_mfma_f32_16x16x32_bf16 a[120:123], a[184:187], v[16:19], a[120:123]
  v_exp_f32 v126, v126
  v_mfma_f32_16x16x32_bf16 a[120:123], a[188:191], v[48:51], a[120:123]
  v_mfma_f32_16x16x32_bf16 a[124:127], a[188:191], v[56:59], a[124:127]
  s_waitcnt lgkmcnt(0)
  v_exp_f32 v127, v127
  v_mfma_f32_16x16x32_bf16 a[124:127], a[184:187], v[24:27], a[124:127]
  v_cvt_pk_bf16_f32 v123, v126, v127
  v_mfma_f32_16x16x32_bf16 v[0:3], a[128:131], v[128:131], v[192:195]
  s_add_u32 m0, s28, 114688
  v_mfma_f32_16x16x32_bf16 v[0:3], a[132:135], v[132:135], v[0:3]
  ds_read_b128 a[144:147], v212 offset:36864
  v_mfma_f32_16x16x32_bf16 v[0:3], a[136:139], v[136:139], v[0:3]
  buffer_load_dwordx4 v236, s[16:19], s29 offen offset:0 lds
  v_mfma_f32_16x16x32_bf16 v[0:3], a[140:143], v[140:143], v[0:3]
  ds_read_b128 a[148:151], v213 offset:36864
  v_mfma_f32_16x16x32_bf16 v[8:11], a[140:143], v[156:159], v[196:199]
  buffer_load_dwordx4 v237, s[16:19], s29 offen offset:1024 lds
  v_mfma_f32_16x16x32_bf16 v[8:11], a[136:139], v[152:155], v[8:11]
  ds_read_b128 a[152:155], v214 offset:36864
  v_mfma_f32_16x16x32_bf16 v[8:11], a[132:135], v[148:151], v[8:11]
  buffer_load_dwordx4 v236, s[16:19], s29 offen offset:2048 lds
  v_mfma_f32_16x16x32_bf16 v[8:11], a[128:131], v[144:147], v[8:11]
  ds_read_b128 a[156:159], v215 offset:36864
  v_mfma_f32_16x16x32_bf16 v[16:19], a[128:131], v[160:163], v[200:203]
  v_exp_f32 v0, v0
  v_mfma_f32_16x16x32_bf16 v[16:19], a[132:135], v[164:167], v[16:19]
  buffer_load_dwordx4 v237, s[16:19], s29 offen offset:3072 lds
  v_mfma_f32_16x16x32_bf16 v[16:19], a[136:139], v[168:171], v[16:19]
  s_add_u32 s29, s29, 16384
  v_exp_f32 v1, v1
  v_mfma_f32_16x16x32_bf16 v[16:19], a[140:143], v[172:175], v[16:19]
  v_cvt_pk_bf16_f32 v0, v0, v1
  v_mfma_f32_16x16x32_bf16 v[24:27], a[140:143], v[188:191], v[204:207]
  s_add_u32 m0, s28, 0
  v_exp_f32 v2, v2
  v_mfma_f32_16x16x32_bf16 v[24:27], a[136:139], v[184:187], v[24:27]
  buffer_load_dwordx4 v232, s[12:15], s29 offen offset:0 lds
  v_mfma_f32_16x16x32_bf16 v[24:27], a[132:135], v[180:183], v[24:27]
  s_waitcnt lgkmcnt(0)
  v_exp_f32 v3, v3
  v_mfma_f32_16x16x32_bf16 v[24:27], a[128:131], v[176:179], v[24:27]
  v_cvt_pk_bf16_f32 v1, v2, v3
  v_mfma_f32_16x16x32_bf16 v[4:7], a[144:147], v[128:131], v[192:195]
  v_exp_f32 v8, v8
  v_mfma_f32_16x16x32_bf16 v[4:7], a[148:151], v[132:135], v[4:7]
  ds_read_b128 a[128:131], v212 offset:40960
  v_mfma_f32_16x16x32_bf16 v[4:7], a[152:155], v[136:139], v[4:7]
  v_exp_f32 v9, v9
  v_mfma_f32_16x16x32_bf16 v[4:7], a[156:159], v[140:143], v[4:7]
  ds_read_b128 a[132:135], v213 offset:40960
  v_cvt_pk_bf16_f32 v8, v8, v9
  v_mfma_f32_16x16x32_bf16 v[12:15], a[156:159], v[156:159], v[196:199]
  v_exp_f32 v10, v10
  v_mfma_f32_16x16x32_bf16 v[12:15], a[152:155], v[152:155], v[12:15]
  ds_read_b128 a[136:139], v214 offset:40960
  v_mfma_f32_16x16x32_bf16 v[12:15], a[148:151], v[148:151], v[12:15]
  v_exp_f32 v11, v11
  v_mfma_f32_16x16x32_bf16 v[12:15], a[144:147], v[144:147], v[12:15]
  ds_read_b128 a[140:143], v215 offset:40960
  v_cvt_pk_bf16_f32 v9, v10, v11
  v_mfma_f32_16x16x32_bf16 v[20:23], a[144:147], v[160:163], v[200:203]
  v_exp_f32 v16, v16
  v_mfma_f32_16x16x32_bf16 v[20:23], a[148:151], v[164:167], v[20:23]
  buffer_load_dwordx4 v233, s[12:15], s29 offen offset:1024 lds
  v_mfma_f32_16x16x32_bf16 v[20:23], a[152:155], v[168:171], v[20:23]
  v_exp_f32 v17, v17
  v_mfma_f32_16x16x32_bf16 v[20:23], a[156:159], v[172:175], v[20:23]
  v_cvt_pk_bf16_f32 v16, v16, v17
  v_mfma_f32_16x16x32_bf16 v[28:31], a[156:159], v[188:191], v[204:207]
  v_exp_f32 v18, v18
  v_mfma_f32_16x16x32_bf16 v[28:31], a[152:155], v[184:187], v[28:31]
  buffer_load_dwordx4 v234, s[12:15], s29 offen offset:2048 lds
  v_mfma_f32_16x16x32_bf16 v[28:31], a[148:151], v[180:183], v[28:31]
  s_waitcnt lgkmcnt(0)
  v_exp_f32 v19, v19
  v_mfma_f32_16x16x32_bf16 v[28:31], a[144:147], v[176:179], v[28:31]
  v_cvt_pk_bf16_f32 v17, v18, v19
  v_mfma_f32_16x16x32_bf16 v[32:35], a[128:131], v[128:131], v[192:195]
  v_exp_f32 v24, v24
  v_mfma_f32_16x16x32_bf16 v[32:35], a[132:135], v[132:135], v[32:35]
  ds_read_b128 a[144:147], v212 offset:45056
  v_mfma_f32_16x16x32_bf16 v[32:35], a[136:139], v[136:139], v[32:35]
  v_exp_f32 v25, v25
  v_mfma_f32_16x16x32_bf16 v[32:35], a[140:143], v[140:143], v[32:35]
  ds_read_b128 a[148:151], v213 offset:45056
  v_cvt_pk_bf16_f32 v24, v24, v25
  v_mfma_f32_16x16x32_bf16 v[40:43], a[140:143], v[156:159], v[196:199]
  v_exp_f32 v26, v26
  v_mfma_f32_16x16x32_bf16 v[40:43], a[136:139], v[152:155], v[40:43]
  ds_read_b128 a[152:155], v214 offset:45056
  v_mfma_f32_16x16x32_bf16 v[40:43], a[132:135], v[148:151], v[40:43]
  v_exp_f32 v27, v27
  v_mfma_f32_16x16x32_bf16 v[40:43], a[128:131], v[144:147], v[40:43]
  ds_read_b128 a[156:159], v215 offset:45056
  v_cvt_pk_bf16_f32 v25, v26, v27
  v_mfma_f32_16x16x32_bf16 v[48:51], a[128:131], v[160:163], v[200:203]
  v_exp_f32 v4, v4
  v_mfma_f32_16x16x32_bf16 v[48:51], a[132:135], v[164:167], v[48:51]
  buffer_load_dwordx4 v235, s[12:15], s29 offen offset:3072 lds
  v_mfma_f32_16x16x32_bf16 v[48:51], a[136:139], v[168:171], v[48:51]
  v_exp_f32 v5, v5
  v_mfma_f32_16x16x32_bf16 v[48:51], a[140:143], v[172:175], v[48:51]
  v_cvt_pk_bf16_f32 v2, v4, v5
  v_mfma_f32_16x16x32_bf16 v[56:59], a[140:143], v[188:191], v[204:207]
  s_mov_b32 m0, s51
  v_exp_f32 v6, v6
  v_mfma_f32_16x16x32_bf16 v[56:59], a[136:139], v[184:187], v[56:59]
  buffer_load_dwordx4 v210, s[4:7], s100 offen lds
  s_add_u32 s100, s100, 20480
  s_add_u32 s51, s51, 512
  v_mfma_f32_16x16x32_bf16 v[56:59], a[132:135], v[180:183], v[56:59]
  s_waitcnt lgkmcnt(0)
  v_exp_f32 v7, v7
  v_mfma_f32_16x16x32_bf16 v[56:59], a[128:131], v[176:179], v[56:59]
  v_cvt_pk_bf16_f32 v3, v6, v7
  v_mfma_f32_16x16x32_bf16 v[36:39], a[144:147], v[128:131], v[192:195]
  v_exp_f32 v12, v12
  v_mfma_f32_16x16x32_bf16 v[36:39], a[148:151], v[132:135], v[36:39]
  ds_read_b64_tr_b16 a[160:161], v216 offset:16384
  v_mfma_f32_16x16x32_bf16 v[36:39], a[152:155], v[136:139], v[36:39]
  v_exp_f32 v13, v13
  v_mfma_f32_16x16x32_bf16 v[36:39], a[156:159], v[140:143], v[36:39]
  ds_read_b64_tr_b16 a[162:163], v216 offset:20480
  v_cvt_pk_bf16_f32 v10, v12, v13
  v_mfma_f32_16x16x32_bf16 v[44:47], a[156:159], v[156:159], v[196:199]
  v_exp_f32 v14, v14
  v_mfma_f32_16x16x32_bf16 v[44:47], a[152:155], v[152:155], v[44:47]
  ds_read_b64_tr_b16 a[164:165], v216 offset:24576
  v_mfma_f32_16x16x32_bf16 v[44:47], a[148:151], v[148:151], v[44:47]
  v_exp_f32 v15, v15
  v_mfma_f32_16x16x32_bf16 v[44:47], a[144:147], v[144:147], v[44:47]
  ds_read_b64_tr_b16 a[166:167], v216 offset:28672
  v_cvt_pk_bf16_f32 v11, v14, v15
  v_mfma_f32_16x16x32_bf16 v[52:55], a[144:147], v[160:163], v[200:203]
  v_exp_f32 v20, v20
  v_mfma_f32_16x16x32_bf16 v[52:55], a[148:151], v[164:167], v[52:55]
  ds_read_b64_tr_b16 a[168:169], v217 offset:16384
  v_mfma_f32_16x16x32_bf16 v[52:55], a[152:155], v[168:171], v[52:55]
  v_exp_f32 v21, v21
  v_mfma_f32_16x16x32_bf16 v[52:55], a[156:159], v[172:175], v[52:55]
  ds_read_b64_tr_b16 a[170:171], v217 offset:20480
  v_cvt_pk_bf16_f32 v18, v20, v21
  v_mfma_f32_16x16x32_bf16 v[60:63], a[156:159], v[188:191], v[204:207]
  v_exp_f32 v22, v22
  v_mfma_f32_16x16x32_bf16 v[60:63], a[152:155], v[184:187], v[60:63]
  ds_read_b64_tr_b16 a[172:173], v217 offset:24576
  v_mfma_f32_16x16x32_bf16 v[60:63], a[148:151], v[180:183], v[60:63]
  v_exp_f32 v23, v23
  v_mfma_f32_16x16x32_bf16 v[60:63], a[144:147], v[176:179], v[60:63]
  ds_read_b64_tr_b16 a[174:175], v217 offset:28672
  v_cvt_pk_bf16_f32 v19, v22, v23
  v_mfma_f32_16x16x32_bf16 a[192:195], a[208:211], v[64:67], a[192:195]
  v_exp_f32 v28, v28
  v_mfma_f32_16x16x32_bf16 a[192:195], a[208:211], v[96:99], a[192:195]
  ds_read_b64_tr_b16 a[176:177], v218 offset:16384
  v_mfma_f32_16x16x32_bf16 a[196:199], a[208:211], v[72:75], a[196:199]
  v_exp_f32 v29, v29
  v_mfma_f32_16x16x32_bf16 a[196:199], a[208:211], v[104:107], a[196:199]
  ds_read_b64_tr_b16 a[178:179], v218 offset:20480
  v_cvt_pk_bf16_f32 v26, v28, v29
  v_mfma_f32_16x16x32_bf16 a[200:203], a[208:211], v[80:83], a[200:203]
  v_exp_f32 v30, v30
  v_mfma_f32_16x16x32_bf16 a[200:203], a[208:211], v[112:115], a[200:203]
  ds_read_b64_tr_b16 a[180:181], v218 offset:24576
  v_mfma_f32_16x16x32_bf16 a[204:207], a[208:211], v[88:91], a[204:207]
  s_waitcnt lgkmcnt(7)
  v_exp_f32 v31, v31
  v_mfma_f32_16x16x32_bf16 a[204:207], a[208:211], v[120:123], a[204:207]
  ds_read_b64_tr_b16 a[182:183], v218 offset:28672
  v_cvt_pk_bf16_f32 v27, v30, v31
  v_mfma_f32_16x16x32_bf16 a[0:3], a[160:163], v[64:67], a[0:3]
  v_exp_f32 v32, v32
  v_mfma_f32_16x16x32_bf16 a[0:3], a[164:167], v[96:99], a[0:3]
  ds_read_b64_tr_b16 a[184:185], v219 offset:16384
  v_mfma_f32_16x16x32_bf16 a[4:7], a[164:167], v[104:107], a[4:7]
  v_exp_f32 v33, v33
  v_mfma_f32_16x16x32_bf16 a[4:7], a[160:163], v[72:75], a[4:7]
  ds_read_b64_tr_b16 a[186:187], v219 offset:20480
  v_cvt_pk_bf16_f32 v32, v32, v33
  v_mfma_f32_16x16x32_bf16 a[8:11], a[160:163], v[80:83], a[8:11]
  v_exp_f32 v34, v34
  v_mfma_f32_16x16x32_bf16 a[8:11], a[164:167], v[112:115], a[8:11]
  ds_read_b64_tr_b16 a[188:189], v219 offset:24576
  v_mfma_f32_16x16x32_bf16 a[12:15], a[164:167], v[120:123], a[12:15]
  s_waitcnt lgkmcnt(7)
  v_exp_f32 v35, v35
  v_mfma_f32_16x16x32_bf16 a[12:15], a[160:163], v[88:91], a[12:15]
  ds_read_b64_tr_b16 a[190:191], v219 offset:28672
  v_cvt_pk_bf16_f32 v33, v34, v35
  v_mfma_f32_16x16x32_bf16 a[16:19], a[168:171], v[64:67], a[16:19]
  v_exp_f32 v40, v40
  v_mfma_f32_16x16x32_bf16 a[16:19], a[172:175], v[96:99], a[16:19]
  ds_read_b64_tr_b16 a[160:161], v220 offset:16384
  v_mfma_f32_16x16x32_bf16 a[20:23], a[172:175], v[104:107], a[20:23]
  v_exp_f32 v41, v41
  v_mfma_f32_16x16x32_bf16 a[20:23], a[168:171], v[72:75], a[20:23]
  ds_read_b64_tr_b16 a[162:163], v220 offset:20480
  v_cvt_pk_bf16_f32 v40, v40, v41
  v_mfma_f32_16x16x32_bf16 a[24:27], a[168:171], v[80:83], a[24:27]
  v_exp_f32 v42, v42
  v_mfma_f32_16x16x32_bf16 a[24:27], a[172:175], v[112:115], a[24:27]
  ds_read_b64_tr_b16 a[164:165], v220 offset:24576
  v_mfma_f32_16x16x32_bf16 a[28:31], a[172:175], v[120:123], a[28:31]
  s_waitcnt lgkmcnt(7)
  v_exp_f32 v43, v43
  v_mfma_f32_16x16x32_bf16 a[28:31], a[168:171], v[88:91], a[28:31]
  ds_read_b64_tr_b16 a[166:167], v220 offset:28672
  v_cvt_pk_bf16_f32 v41, v42, v43
  v_mfma_f32_16x16x32_bf16 a[32:35], a[176:179], v[64:67], a[32:35]
  v_exp_f32 v48, v48
  v_mfma_f32_16x16x32_bf16 a[32:35], a[180:183], v[96:99], a[32:35]
  ds_read_b64_tr_b16 a[168:169], v221 offset:16384
  v_mfma_f32_16x16x32_bf16 a[36:39], a[180:183], v[104:107], a[36:39]
  v_exp_f32 v49, v49
  v_mfma_f32_16x16x32_bf16 a[36:39], a[176:179], v[72:75], a[36:39]
  ds_read_b64_tr_b16 a[170:171], v221 offset:20480
  v_cvt_pk_bf16_f32 v48, v48, v49
  v_mfma_f32_16x16x32_bf16 a[40:43], a[176:179], v[80:83], a[40:43]
  v_exp_f32 v50, v50
  v_mfma_f32_16x16x32_bf16 a[40:43], a[180:183], v[112:115], a[40:43]
  ds_read_b64_tr_b16 a[172:173], v221 offset:24576
  v_mfma_f32_16x16x32_bf16 a[44:47], a[180:183], v[120:123], a[44:47]
  s_waitcnt lgkmcnt(7)
  v_exp_f32 v51, v51
  v_mfma_f32_16x16x32_bf16 a[44:47], a[176:179], v[88:91], a[44:47]
  ds_read_b64_tr_b16 a[174:175], v221 offset:28672
  v_cvt_pk_bf16_f32 v49, v50, v51
  v_mfma_f32_16x16x32_bf16 a[48:51], a[184:187], v[64:67], a[48:51]
  v_exp_f32 v56, v56
  v_mfma_f32_16x16x32_bf16 a[48:51], a[188:191], v[96:99], a[48:51]
  ds_read_b64_tr_b16 a[176:177], v222 offset:16384
  v_mfma_f32_16x16x32_bf16 a[52:55], a[188:191], v[104:107], a[52:55]
  v_exp_f32 v57, v57
  v_mfma_f32_16x16x32_bf16 a[52:55], a[184:187], v[72:75], a[52:55]
  ds_read_b64_tr_b16 a[178:179], v222 offset:20480
  v_cvt_pk_bf16_f32 v56, v56, v57
  v_mfma_f32_16x16x32_bf16 a[56:59], a[184:187], v[80:83], a[56:59]
  v_exp_f32 v58, v58
  v_mfma_f32_16x16x32_bf16 a[56:59], a[188:191], v[112:115], a[56:59]
  ds_read_b64_tr_b16 a[180:181], v222 offset:24576
  v_mfma_f32_16x16x32_bf16 a[60:63], a[188:191], v[120:123], a[60:63]
  s_waitcnt lgkmcnt(7)
  v_exp_f32 v59, v59
  v_mfma_f32_16x16x32_bf16 a[60:63], a[184:187], v[88:91], a[60:63]
  ds_read_b64_tr_b16 a[182:183], v222 offset:28672
  v_cvt_pk_bf16_f32 v57, v58, v59
  v_mfma_f32_16x16x32_bf16 a[64:67], a[160:163], v[64:67], a[64:67]
  v_exp_f32 v36, v36
  v_mfma_f32_16x16x32_bf16 a[64:67], a[164:167], v[96:99], a[64:67]
  ds_read_b64_tr_b16 a[184:185], v223 offset:16384
  v_mfma_f32_16x16x32_bf16 a[68:71], a[164:167], v[104:107], a[68:71]
  v_exp_f32 v37, v37
  v_mfma_f32_16x16x32_bf16 a[68:71], a[160:163], v[72:75], a[68:71]
  ds_read_b64_tr_b16 a[186:187], v223 offset:20480
  v_cvt_pk_bf16_f32 v34, v36, v37
  v_mfma_f32_16x16x32_bf16 a[72:75], a[160:163], v[80:83], a[72:75]
  v_exp_f32 v38, v38
  v_mfma_f32_16x16x32_bf16 a[72:75], a[164:167], v[112:115], a[72:75]
  ds_read_b64_tr_b16 a[188:189], v223 offset:24576
  v_mfma_f32_16x16x32_bf16 a[76:79], a[164:167], v[120:123], a[76:79]
  s_waitcnt lgkmcnt(7)
  v_exp_f32 v39, v39
  v_mfma_f32_16x16x32_bf16 a[76:79], a[160:163], v[88:91], a[76:79]
  ds_read_b64_tr_b16 a[190:191], v223 offset:28672
  v_cvt_pk_bf16_f32 v35, v38, v39
  v_mfma_f32_16x16x32_bf16 a[80:83], a[168:171], v[64:67], a[80:83]
  s_waitcnt vmcnt(11)
  v_exp_f32 v44, v44
  v_mfma_f32_16x16x32_bf16 a[80:83], a[172:175], v[96:99], a[80:83]
  v_mfma_f32_16x16x32_bf16 a[84:87], a[172:175], v[104:107], a[84:87]
  s_barrier
  v_exp_f32 v45, v45
  v_mfma_f32_16x16x32_bf16 a[84:87], a[168:171], v[72:75], a[84:87]
  ds_read_b128 a[128:131], v212 offset:49152
  v_cvt_pk_bf16_f32 v42, v44, v45
  v_mfma_f32_16x16x32_bf16 a[88:91], a[168:171], v[80:83], a[88:91]
  v_exp_f32 v46, v46
  v_mfma_f32_16x16x32_bf16 a[88:91], a[172:175], v[112:115], a[88:91]
  ds_read_b128 a[132:135], v213 offset:49152
  ds_read_b64_tr_b16 a[232:233], v209 offset:4096
  v_mfma_f32_16x16x32_bf16 a[92:95], a[172:175], v[120:123], a[92:95]
  s_waitcnt lgkmcnt(7)
  v_exp_f32 v47, v47
  v_mfma_f32_16x16x32_bf16 a[92:95], a[168:171], v[88:91], a[92:95]
  ds_read_b128 a[136:139], v214 offset:49152
  v_cvt_pk_bf16_f32 v43, v46, v47
  v_mfma_f32_16x16x32_bf16 a[96:99], a[176:179], v[64:67], a[96:99]
  v_exp_f32 v52, v52
  v_mfma_f32_16x16x32_bf16 a[96:99], a[180:183], v[96:99], a[96:99]
  ds_read_b128 a[140:143], v215 offset:49152
  ds_read_b64_tr_b16 a[234:235], v209 offset:4608
  v_mfma_f32_16x16x32_bf16 a[100:103], a[180:183], v[104:107], a[100:103]
  v_exp_f32 v53, v53
  v_mfma_f32_16x16x32_bf16 a[100:103], a[176:179], v[72:75], a[100:103]
  v_cvt_pk_bf16_f32 v50, v52, v53
  v_mfma_f32_16x16x32_bf16 a[104:107], a[176:179], v[80:83], a[104:107]
  v_exp_f32 v54, v54
  v_mfma_f32_16x16x32_bf16 a[104:107], a[180:183], v[112:115], a[104:107]
  v_mfma_f32_16x16x32_bf16 a[108:111], a[180:183], v[120:123], a[108:111]
  s_waitcnt lgkmcnt(6)
  v_exp_f32 v55, v55
  v_mfma_f32_16x16x32_bf16 a[108:111], a[176:179], v[88:91], a[108:111]
  v_cvt_pk_bf16_f32 v51, v54, v55
  v_mfma_f32_16x16x32_bf16 a[112:115], a[184:187], v[64:67], a[112:115]
  v_exp_f32 v60, v60
  v_mfma_f32_16x16x32_bf16 a[112:115], a[188:191], v[96:99], a[112:115]
  s_waitcnt lgkmcnt(0)
  buffer_store_dwordx4 a[232:235], v211, s[24:27], s31 offen sc1
  s_add_u32 s31, s31, 1024
  s_cmp_gt_u32 s32, 4
  s_cselect_b32 s39, 0, 1073741824
  v_mfma_f32_16x16x32_bf16 a[116:119], a[188:191], v[104:107], a[116:119]
  v_exp_f32 v61, v61
  v_mfma_f32_16x16x32_bf16 a[116:119], a[184:187], v[72:75], a[116:119]
  v_cvt_pk_bf16_f32 v58, v60, v61
  v_or_b32 v211, s39, v211
  v_mfma_f32_16x16x32_bf16 a[120:123], a[184:187], v[80:83], a[120:123]
  v_exp_f32 v62, v62
  v_mfma_f32_16x16x32_bf16 a[120:123], a[188:191], v[112:115], a[120:123]
  v_or_b32 v208, s39, v208
  v_mfma_f32_16x16x32_bf16 a[124:127], a[188:191], v[120:123], a[124:127]
  v_exp_f32 v63, v63
  v_mfma_f32_16x16x32_bf16 a[124:127], a[184:187], v[88:91], a[124:127]
  v_cvt_pk_bf16_f32 v59, v62, v63
  v_mfma_f32_16x16x32_bf16 v[64:67], a[128:131], v[128:131], v[192:195]
  s_add_u32 m0, s28, 65536
  v_mfma_f32_16x16x32_bf16 v[64:67], a[132:135], v[132:135], v[64:67]
  ds_read_b128 a[144:147], v212 offset:53248
  v_mfma_f32_16x16x32_bf16 v[64:67], a[136:139], v[136:139], v[64:67]
  buffer_load_dwordx4 v236, s[16:19], s29 offen offset:0 lds
  v_mfma_f32_16x16x32_bf16 v[64:67], a[140:143], v[140:143], v[64:67]
  ds_read_b128 a[148:151], v213 offset:53248
  v_mfma_f32_16x16x32_bf16 v[72:75], a[140:143], v[156:159], v[196:199]
  buffer_load_dwordx4 v237, s[16:19], s29 offen offset:1024 lds
  v_mfma_f32_16x16x32_bf16 v[72:75], a[136:139], v[152:155], v[72:75]
  ds_read_b128 a[152:155], v214 offset:53248
  v_mfma_f32_16x16x32_bf16 v[72:75], a[132:135], v[148:151], v[72:75]
  buffer_load_dwordx4 v236, s[16:19], s29 offen offset:2048 lds
  v_mfma_f32_16x16x32_bf16 v[72:75], a[128:131], v[144:147], v[72:75]
  ds_read_b128 a[156:159], v215 offset:53248
  v_mfma_f32_16x16x32_bf16 v[80:83], a[128:131], v[160:163], v[200:203]
  v_exp_f32 v64, v64
  v_mfma_f32_16x16x32_bf16 v[80:83], a[132:135], v[164:167], v[80:83]
  buffer_load_dwordx4 v237, s[16:19], s29 offen offset:3072 lds
  v_mfma_f32_16x16x32_bf16 v[80:83], a[136:139], v[168:171], v[80:83]
  s_add_u32 s29, s29, 16384
  v_exp_f32 v65, v65
  v_mfma_f32_16x16x32_bf16 v[80:83], a[140:143], v[172:175], v[80:83]
  v_cvt_pk_bf16_f32 v64, v64, v65
  v_mfma_f32_16x16x32_bf16 v[88:91], a[140:143], v[188:191], v[204:207]
  s_add_u32 m0, s28, 16384
  v_exp_f32 v66, v66
  v_mfma_f32_16x16x32_bf16 v[88:91], a[136:139], v[184:187], v[88:91]
  buffer_load_dwordx4 v232, s[12:15], s29 offen offset:0 lds
  v_mfma_f32_16x16x32_bf16 v[88:91], a[132:135], v[180:183], v[88:91]
  s_waitcnt lgkmcnt(0)
  v_exp_f32 v67, v67
  v_mfma_f32_16x16x32_bf16 v[88:91], a[128:131], v[176:179], v[88:91]
  v_cvt_pk_bf16_f32 v65, v66, v67
  v_mfma_f32_16x16x32_bf16 v[68:71], a[144:147], v[128:131], v[192:195]
  v_exp_f32 v72, v72
  v_mfma_f32_16x16x32_bf16 v[68:71], a[148:151], v[132:135], v[68:71]
  ds_read_b128 a[128:131], v212 offset:57344
  v_mfma_f32_16x16x32_bf16 v[68:71], a[152:155], v[136:139], v[68:71]
  v_exp_f32 v73, v73
  v_mfma_f32_16x16x32_bf16 v[68:71], a[156:159], v[140:143], v[68:71]
  ds_read_b128 a[132:135], v213 offset:57344
  v_cvt_pk_bf16_f32 v72, v72, v73
  v_mfma_f32_16x16x32_bf16 v[76:79], a[156:159], v[156:159], v[196:199]
  v_exp_f32 v74, v74
  v_mfma_f32_16x16x32_bf16 v[76:79], a[152:155], v[152:155], v[76:79]
  ds_read_b128 a[136:139], v214 offset:57344
  v_mfma_f32_16x16x32_bf16 v[76:79], a[148:151], v[148:151], v[76:79]
  v_exp_f32 v75, v75
  v_mfma_f32_16x16x32_bf16 v[76:79], a[144:147], v[144:147], v[76:79]
  ds_read_b128 a[140:143], v215 offset:57344
  v_cvt_pk_bf16_f32 v73, v74, v75
  v_mfma_f32_16x16x32_bf16 v[84:87], a[144:147], v[160:163], v[200:203]
  v_exp_f32 v80, v80
  v_mfma_f32_16x16x32_bf16 v[84:87], a[148:151], v[164:167], v[84:87]
  buffer_load_dwordx4 v233, s[12:15], s29 offen offset:1024 lds
  v_mfma_f32_16x16x32_bf16 v[84:87], a[152:155], v[168:171], v[84:87]
  v_exp_f32 v81, v81
  v_mfma_f32_16x16x32_bf16 v[84:87], a[156:159], v[172:175], v[84:87]
  v_cvt_pk_bf16_f32 v80, v80, v81
  v_mfma_f32_16x16x32_bf16 v[92:95], a[156:159], v[188:191], v[204:207]
  v_exp_f32 v82, v82
  v_mfma_f32_16x16x32_bf16 v[92:95], a[152:155], v[184:187], v[92:95]
  buffer_load_dwordx4 v234, s[12:15], s29 offen offset:2048 lds
  v_mfma_f32_16x16x32_bf16 v[92:95], a[148:151], v[180:183], v[92:95]
  s_waitcnt lgkmcnt(0)
  v_exp_f32 v83, v83
  v_mfma_f32_16x16x32_bf16 v[92:95], a[144:147], v[176:179], v[92:95]
  v_cvt_pk_bf16_f32 v81, v82, v83
  v_mfma_f32_16x16x32_bf16 v[96:99], a[128:131], v[128:131], v[192:195]
  v_exp_f32 v88, v88
  v_mfma_f32_16x16x32_bf16 v[96:99], a[132:135], v[132:135], v[96:99]
  ds_read_b128 a[144:147], v212 offset:61440
  v_mfma_f32_16x16x32_bf16 v[96:99], a[136:139], v[136:139], v[96:99]
  v_exp_f32 v89, v89
  v_mfma_f32_16x16x32_bf16 v[96:99], a[140:143], v[140:143], v[96:99]
  ds_read_b128 a[148:151], v213 offset:61440
  v_cvt_pk_bf16_f32 v88, v88, v89
  v_mfma_f32_16x16x32_bf16 v[104:107], a[140:143], v[156:159], v[196:199]
  v_exp_f32 v90, v90
  v_mfma_f32_16x16x32_bf16 v[104:107], a[136:139], v[152:155], v[104:107]
  ds_read_b128 a[152:155], v214 offset:61440
  v_mfma_f32_16x16x32_bf16 v[104:107], a[132:135], v[148:151], v[104:107]
  v_exp_f32 v91, v91
  v_mfma_f32_16x16x32_bf16 v[104:107], a[128:131], v[144:147], v[104:107]
  ds_read_b128 a[156:159], v215 offset:61440
  v_cvt_pk_bf16_f32 v89, v90, v91
  v_mfma_f32_16x16x32_bf16 v[112:115], a[128:131], v[160:163], v[200:203]
  v_exp_f32 v68, v68
  v_mfma_f32_16x16x32_bf16 v[112:115], a[132:135], v[164:167], v[112:115]
  buffer_load_dwordx4 v235, s[12:15], s29 offen offset:3072 lds
  v_mfma_f32_16x16x32_bf16 v[112:115], a[136:139], v[168:171], v[112:115]
  v_exp_f32 v69, v69
  v_mfma_f32_16x16x32_bf16 v[112:115], a[140:143], v[172:175], v[112:115]
  v_cvt_pk_bf16_f32 v66, v68, v69
  v_mfma_f32_16x16x32_bf16 v[120:123], a[140:143], v[188:191], v[204:207]
  v_exp_f32 v70, v70
  v_mfma_f32_16x16x32_bf16 v[120:123], a[136:139], v[184:187], v[120:123]
  buffer_load_dword v254, off, s[24:27], s47 sc1
  v_mfma_f32_16x16x32_bf16 v[120:123], a[132:135], v[180:183], v[120:123]
  s_waitcnt lgkmcnt(0)
  v_exp_f32 v71, v71
  v_mfma_f32_16x16x32_bf16 v[120:123], a[128:131], v[176:179], v[120:123]
  v_cvt_pk_bf16_f32 v67, v70, v71
  v_mfma_f32_16x16x32_bf16 v[100:103], a[144:147], v[128:131], v[192:195]
  v_exp_f32 v76, v76
  v_mfma_f32_16x16x32_bf16 v[100:103], a[148:151], v[132:135], v[100:103]
  ds_read_b64_tr_b16 a[160:161], v216 offset:32768
  v_mfma_f32_16x16x32_bf16 v[100:103], a[152:155], v[136:139], v[100:103]
  v_exp_f32 v77, v77
  v_mfma_f32_16x16x32_bf16 v[100:103], a[156:159], v[140:143], v[100:103]
  ds_read_b64_tr_b16 a[162:163], v216 offset:36864
  v_cvt_pk_bf16_f32 v74, v76, v77
  v_mfma_f32_16x16x32_bf16 v[108:111], a[156:159], v[156:159], v[196:199]
  v_exp_f32 v78, v78
  v_mfma_f32_16x16x32_bf16 v[108:111], a[152:155], v[152:155], v[108:111]
  ds_read_b64_tr_b16 a[164:165], v216 offset:40960
  v_mfma_f32_16x16x32_bf16 v[108:111], a[148:151], v[148:151], v[108:111]
  v_exp_f32 v79, v79
  v_mfma_f32_16x16x32_bf16 v[108:111], a[144:147], v[144:147], v[108:111]
  ds_read_b64_tr_b16 a[166:167], v216 offset:45056
  v_cvt_pk_bf16_f32 v75, v78, v79
  v_mfma_f32_16x16x32_bf16 v[116:119], a[144:147], v[160:163], v[200:203]
  v_exp_f32 v84, v84
  v_mfma_f32_16x16x32_bf16 v[116:119], a[148:151], v[164:167], v[116:119]
  ds_read_b64_tr_b16 a[168:169], v217 offset:32768
  v_mfma_f32_16x16x32_bf16 v[116:119], a[152:155], v[168:171], v[116:119]
  v_exp_f32 v85, v85
  v_mfma_f32_16x16x32_bf16 v[116:119], a[156:159], v[172:175], v[116:119]
  ds_read_b64_tr_b16 a[170:171], v217 offset:36864
  v_cvt_pk_bf16_f32 v82, v84, v85
  v_mfma_f32_16x16x32_bf16 v[124:127], a[156:159], v[188:191], v[204:207]
  s_waitcnt vmcnt(20)
  v_exp_f32 v86, v86
  v_mfma_f32_16x16x32_bf16 v[124:127], a[152:155], v[184:187], v[124:127]
  ds_read_b64_tr_b16 a[172:173], v217 offset:40960
  ds_read_b64_tr_b16 a[232:233], v209 offset:5120
  v_mfma_f32_16x16x32_bf16 v[124:127], a[148:151], v[180:183], v[124:127]
  v_exp_f32 v87, v87
  v_mfma_f32_16x16x32_bf16 v[124:127], a[144:147], v[176:179], v[124:127]
  ds_read_b64_tr_b16 a[174:175], v217 offset:45056
  v_cvt_pk_bf16_f32 v83, v86, v87
  v_mfma_f32_16x16x32_bf16 a[192:195], a[208:211], v[0:3], a[192:195]
  v_exp_f32 v92, v92
  v_mfma_f32_16x16x32_bf16 a[192:195], a[208:211], v[32:35], a[192:195]
  ds_read_b64_tr_b16 a[176:177], v218 offset:32768
  ds_read_b64_tr_b16 a[234:235], v209 offset:5632
  v_mfma_f32_16x16x32_bf16 a[196:199], a[208:211], v[8:11], a[196:199]
  v_exp_f32 v93, v93
  v_mfma_f32_16x16x32_bf16 a[196:199], a[208:211], v[40:43], a[196:199]
  ds_read_b64_tr_b16 a[178:179], v218 offset:36864
  v_cvt_pk_bf16_f32 v90, v92, v93
  v_mfma_f32_16x16x32_bf16 a[200:203], a[208:211], v[16:19], a[200:203]
  v_exp_f32 v94, v94
  v_mfma_f32_16x16x32_bf16 a[200:203], a[208:211], v[48:51], a[200:203]
  ds_read_b64_tr_b16 a[180:181], v218 offset:40960
  v_mfma_f32_16x16x32_bf16 a[204:207], a[208:211], v[24:27], a[204:207]
  s_waitcnt lgkmcnt(9)
  v_exp_f32 v95, v95
  v_mfma_f32_16x16x32_bf16 a[204:207], a[208:211], v[56:59], a[204:207]
  ds_read_b64_tr_b16 a[182:183], v218 offset:45056
  v_cvt_pk_bf16_f32 v91, v94, v95
  v_mfma_f32_16x16x32_bf16 a[0:3], a[160:163], v[0:3], a[0:3]
  v_exp_f32 v96, v96
  v_mfma_f32_16x16x32_bf16 a[0:3], a[164:167], v[32:35], a[0:3]
  ds_read_b64_tr_b16 a[184:185], v219 offset:32768
  s_waitcnt lgkmcnt(4)
  buffer_store_dwordx4 a[232:235], v211, s[24:27], s31 offen sc1
  s_add_u32 s31, s31, 1024
  v_mfma_f32_16x16x32_bf16 a[4:7], a[164:167], v[40:43], a[4:7]
  v_exp_f32 v97, v97
  v_mfma_f32_16x16x32_bf16 a[4:7], a[160:163], v[8:11], a[4:7]
  ds_read_b64_tr_b16 a[186:187], v219 offset:36864
  v_cvt_pk_bf16_f32 v96, v96, v97
  v_mfma_f32_16x16x32_bf16 a[8:11], a[160:163], v[16:19], a[8:11]
  v_exp_f32 v98, v98
  v_mfma_f32_16x16x32_bf16 a[8:11], a[164:167], v[48:51], a[8:11]
  ds_read_b64_tr_b16 a[188:189], v219 offset:40960
  v_mfma_f32_16x16x32_bf16 a[12:15], a[164:167], v[56:59], a[12:15]
  v_exp_f32 v99, v99
  v_mfma_f32_16x16x32_bf16 a[12:15], a[160:163], v[24:27], a[12:15]
  ds_read_b64_tr_b16 a[190:191], v219 offset:45056
  v_cvt_pk_bf16_f32 v97, v98, v99
  v_mfma_f32_16x16x32_bf16 a[16:19], a[168:171], v[0:3], a[16:19]
  v_exp_f32 v104, v104
  v_mfma_f32_16x16x32_bf16 a[16:19], a[172:175], v[32:35], a[16:19]
  ds_read_b64_tr_b16 a[160:161], v220 offset:32768
  v_mfma_f32_16x16x32_bf16 a[20:23], a[172:175], v[40:43], a[20:23]
  v_exp_f32 v105, v105
  v_mfma_f32_16x16x32_bf16 a[20:23], a[168:171], v[8:11], a[20:23]
  ds_read_b64_tr_b16 a[162:163], v220 offset:36864
  v_cvt_pk_bf16_f32 v104, v104, v105
  v_mfma_f32_16x16x32_bf16 a[24:27], a[168:171], v[16:19], a[24:27]
  v_exp_f32 v106, v106
  v_mfma_f32_16x16x32_bf16 a[24:27], a[172:175], v[48:51], a[24:27]
  ds_read_b64_tr_b16 a[164:165], v220 offset:40960
  v_mfma_f32_16x16x32_bf16 a[28:31], a[172:175], v[56:59], a[28:31]
  s_waitcnt lgkmcnt(7)
  v_exp_f32 v107, v107
  v_mfma_f32_16x16x32_bf16 a[28:31], a[168:171], v[24:27], a[28:31]
  ds_read_b64_tr_b16 a[166:167], v220 offset:45056
  v_cvt_pk_bf16_f32 v105, v106, v107
  v_mfma_f32_16x16x32_bf16 a[32:35], a[176:179], v[0:3], a[32:35]
  v_exp_f32 v112, v112
  v_mfma_f32_16x16x32_bf16 a[32:35], a[180:183], v[32:35], a[32:35]
  ds_read_b64_tr_b16 a[168:169], v221 offset:32768
  v_mfma_f32_16x16x32_bf16 a[36:39], a[180:183], v[40:43], a[36:39]
  v_exp_f32 v113, v113
  v_mfma_f32_16x16x32_bf16 a[36:39], a[176:179], v[8:11], a[36:39]
  ds_read_b64_tr_b16 a[170:171], v221 offset:36864
  v_cvt_pk_bf16_f32 v112, v112, v113
  v_mfma_f32_16x16x32_bf16 a[40:43], a[176:179], v[16:19], a[40:43]
  v_exp_f32 v114, v114
  v_mfma_f32_16x16x32_bf16 a[40:43], a[180:183], v[48:51], a[40:43]
  ds_read_b64_tr_b16 a[172:173], v221 offset:40960
  v_mfma_f32_16x16x32_bf16 a[44:47], a[180:183], v[56:59], a[44:47]
  s_waitcnt lgkmcnt(7)
  v_exp_f32 v115, v115
  v_mfma_f32_16x16x32_bf16 a[44:47], a[176:179], v[24:27], a[44:47]
  ds_read_b64_tr_b16 a[174:175], v221 offset:45056
  v_cvt_pk_bf16_f32 v113, v114, v115
  v_mfma_f32_16x16x32_bf16 a[48:51], a[184:187], v[0:3], a[48:51]
  v_exp_f32 v120, v120
  v_mfma_f32_16x16x32_bf16 a[48:51], a[188:191], v[32:35], a[48:51]
  ds_read_b64_tr_b16 a[176:177], v222 offset:32768
  v_mfma_f32_16x16x32_bf16 a[52:55], a[188:191], v[40:43], a[52:55]
  v_exp_f32 v121, v121
  v_mfma_f32_16x16x32_bf16 a[52:55], a[184:187], v[8:11], a[52:55]
  ds_read_b64_tr_b16 a[178:179], v222 offset:36864
  v_cvt_pk_bf16_f32 v120, v120, v121
  v_mfma_f32_16x16x32_bf16 a[56:59], a[184:187], v[16:19], a[56:59]
  v_exp_f32 v122, v122
  v_mfma_f32_16x16x32_bf16 a[56:59], a[188:191], v[48:51], a[56:59]
  ds_read_b64_tr_b16 a[180:181], v222 offset:40960
  v_mfma_f32_16x16x32_bf16 a[60:63], a[188:191], v[56:59], a[60:63]
  s_waitcnt lgkmcnt(7)
  v_exp_f32 v123, v123
  v_mfma_f32_16x16x32_bf16 a[60:63], a[184:187], v[24:27], a[60:63]
  ds_read_b64_tr_b16 a[182:183], v222 offset:45056
  v_cvt_pk_bf16_f32 v121, v122, v123
  v_mfma_f32_16x16x32_bf16 a[64:67], a[160:163], v[0:3], a[64:67]
  v_exp_f32 v100, v100
  v_mfma_f32_16x16x32_bf16 a[64:67], a[164:167], v[32:35], a[64:67]
  ds_read_b64_tr_b16 a[184:185], v223 offset:32768
  v_mfma_f32_16x16x32_bf16 a[68:71], a[164:167], v[40:43], a[68:71]
  v_exp_f32 v101, v101
  v_mfma_f32_16x16x32_bf16 a[68:71], a[160:163], v[8:11], a[68:71]
  ds_read_b64_tr_b16 a[186:187], v223 offset:36864
  v_cvt_pk_bf16_f32 v98, v100, v101
  v_mfma_f32_16x16x32_bf16 a[72:75], a[160:163], v[16:19], a[72:75]
  v_exp_f32 v102, v102
  v_mfma_f32_16x16x32_bf16 a[72:75], a[164:167], v[48:51], a[72:75]
  ds_read_b64_tr_b16 a[188:189], v223 offset:40960
  v_mfma_f32_16x16x32_bf16 a[76:79], a[164:167], v[56:59], a[76:79]
  s_waitcnt lgkmcnt(7)
  v_exp_f32 v103, v103
  v_mfma_f32_16x16x32_bf16 a[76:79], a[160:163], v[24:27], a[76:79]
  ds_read_b64_tr_b16 a[190:191], v223 offset:45056
  v_cvt_pk_bf16_f32 v99, v102, v103
  v_mfma_f32_16x16x32_bf16 a[80:83], a[168:171], v[0:3], a[80:83]
  s_waitcnt vmcnt(12)
  v_exp_f32 v108, v108
  v_mfma_f32_16x16x32_bf16 a[80:83], a[172:175], v[32:35], a[80:83]
  v_mfma_f32_16x16x32_bf16 a[84:87], a[172:175], v[40:43], a[84:87]
  s_barrier
  v_exp_f32 v109, v109
  v_mfma_f32_16x16x32_bf16 a[84:87], a[168:171], v[8:11], a[84:87]
  ds_read_b128 a[128:131], v212 offset:0
  v_cvt_pk_bf16_f32 v106, v108, v109
  v_mfma_f32_16x16x32_bf16 a[88:91], a[168:171], v[16:19], a[88:91]
  v_exp_f32 v110, v110
  v_mfma_f32_16x16x32_bf16 a[88:91], a[172:175], v[48:51], a[88:91]
  ds_read_b128 a[132:135], v213 offset:0
  v_mfma_f32_16x16x32_bf16 a[92:95], a[172:175], v[56:59], a[92:95]
  s_waitcnt lgkmcnt(6)
  v_exp_f32 v111, v111
  v_mfma_f32_16x16x32_bf16 a[92:95], a[168:171], v[24:27], a[92:95]
  ds_read_b128 a[136:139], v214 offset:0
  v_cvt_pk_bf16_f32 v107, v110, v111
  v_mfma_f32_16x16x32_bf16 a[96:99], a[176:179], v[0:3], a[96:99]
  v_exp_f32 v116, v116
  v_mfma_f32_16x16x32_bf16 a[96:99], a[180:183], v[32:35], a[96:99]
  ds_read_b128 a[140:143], v215 offset:0
  v_mfma_f32_16x16x32_bf16 a[100:103], a[180:183], v[40:43], a[100:103]
  v_exp_f32 v117, v117
  v_mfma_f32_16x16x32_bf16 a[100:103], a[176:179], v[8:11], a[100:103]
  v_cvt_pk_bf16_f32 v114, v116, v117
  v_mfma_f32_16x16x32_bf16 a[104:107], a[176:179], v[16:19], a[104:107]
  v_exp_f32 v118, v118
  v_mfma_f32_16x16x32_bf16 a[104:107], a[180:183], v[48:51], a[104:107]
  v_mfma_f32_16x16x32_bf16 a[108:111], a[180:183], v[56:59], a[108:111]
  s_waitcnt lgkmcnt(4)
  v_exp_f32 v119, v119
  v_mfma_f32_16x16x32_bf16 a[108:111], a[176:179], v[24:27], a[108:111]
  v_cvt_pk_bf16_f32 v115, v118, v119
  v_mfma_f32_16x16x32_bf16 a[112:115], a[184:187], v[0:3], a[112:115]
  v_exp_f32 v124, v124
  v_mfma_f32_16x16x32_bf16 a[112:115], a[188:191], v[32:35], a[112:115]
  v_mfma_f32_16x16x32_bf16 a[116:119], a[188:191], v[40:43], a[116:119]
  s_sub_u32 s32, s32, 1
  v_exp_f32 v125, v125
  v_mfma_f32_16x16x32_bf16 a[116:119], a[184:187], v[8:11], a[116:119]
  v_cvt_pk_bf16_f32 v122, v124, v125
  v_mfma_f32_16x16x32_bf16 a[120:123], a[184:187], v[16:19], a[120:123]
  s_cmp_lg_u32 s32, 0
  v_exp_f32 v126, v126
  v_mfma_f32_16x16x32_bf16 a[120:123], a[188:191], v[48:51], a[120:123]
  v_mfma_f32_16x16x32_bf16 a[124:127], a[188:191], v[56:59], a[124:127]
  s_waitcnt lgkmcnt(0)
  v_exp_f32 v127, v127
  v_mfma_f32_16x16x32_bf16 a[124:127], a[184:187], v[24:27], a[124:127]
  v_cvt_pk_bf16_f32 v123, v126, v127
  s_cbranch_scc1 attn_loop
  ds_read_b64_tr_b16 a[160:161], v216 offset:49152
  ds_read_b64_tr_b16 a[162:163], v216 offset:53248
  ds_read_b64_tr_b16 a[164:165], v216 offset:57344
  ds_read_b64_tr_b16 a[166:167], v216 offset:61440
  ds_read_b64_tr_b16 a[168:169], v217 offset:49152
  ds_read_b64_tr_b16 a[170:171], v217 offset:53248
  ds_read_b64_tr_b16 a[172:173], v217 offset:57344
  ds_read_b64_tr_b16 a[174:175], v217 offset:61440
  s_waitcnt vmcnt(1)
  v_readfirstlane_b32 s38, v254
  s_nop 0
  s_cmp_ge_u32 s38, 512
  s_cbranch_scc1 attn_h_ready
  s_mov_b32 s39, 32768
attn_spin:
  s_sleep 4
  buffer_load_dword v254, off, s[24:27], s47 sc1
  s_waitcnt vmcnt(0)
  v_readfirstlane_b32 s38, v254
  s_nop 0
  s_cmp_ge_u32 s38, 512
  s_cbranch_scc1 attn_h_ready
  s_sub_u32 s39, s39, 1
  s_cmp_lg_u32 s39, 0
  s_cbranch_scc1 attn_spin
attn_h_ready:
  s_mov_b32 s48, 0x5d800000
  s_lshl_b32 s39, s3, 8
  v_mfma_f32_16x16x32_bf16 a[192:195], a[208:211], v[64:67], a[192:195]
  v_lshrrev_b32 v224, 4, v242
  v_and_b32 v225, 7, v224
  v_mfma_f32_16x16x32_bf16 a[192:195], a[208:211], v[96:99], a[192:195]
  v_mul_u32_u24 v225, 0xd80, v225
  v_lshrrev_b32 v224, 4, v224
  v_mfma_f32_16x16x32_bf16 a[196:199], a[208:211], v[72:75], a[196:199]
  v_lshl_add_u32 v225, v224, 4, v225
  v_mfma_f32_16x16x32_bf16 a[196:199], a[208:211], v[104:107], a[196:199]
  buffer_load_dwordx4 a[212:215], v225, s[24:27], s101 offen offset:0 sc1
  v_mfma_f32_16x16x32_bf16 a[200:203], a[208:211], v[80:83], a[200:203]
  buffer_load_dwordx4 a[216:219], v225, s[24:27], s101 offen offset:64 sc1
  v_mfma_f32_16x16x32_bf16 a[200:203], a[208:211], v[112:115], a[200:203]
  buffer_load_dwordx4 a[220:223], v225, s[24:27], s101 offen offset:128 sc1
  v_mfma_f32_16x16x32_bf16 a[204:207], a[208:211], v[88:91], a[204:207]
  v_mfma_f32_16x16x32_bf16 a[204:207], a[208:211], v[120:123], a[204:207]
  s_waitcnt lgkmcnt(4)
  v_mfma_f32_16x16x32_bf16 a[0:3], a[160:163], v[64:67], a[0:3]
  v_mfma_f32_16x16x32_bf16 a[0:3], a[164:167], v[96:99], a[0:3]
  ds_read_b64_tr_b16 a[176:177], v218 offset:49152
  v_mfma_f32_16x16x32_bf16 a[4:7], a[164:167], v[104:107], a[4:7]
  v_mfma_f32_16x16x32_bf16 a[4:7], a[160:163], v[72:75], a[4:7]
  ds_read_b64_tr_b16 a[178:179], v218 offset:53248
  v_accvgpr_read_b32 v208, a192
  v_mfma_f32_16x16x32_bf16 a[8:11], a[160:163], v[80:83], a[8:11]
  v_accvgpr_read_b32 v209, a196
  v_accvgpr_read_b32 v210, a200
  v_mfma_f32_16x16x32_bf16 a[8:11], a[164:167], v[112:115], a[8:11]
  ds_read_b64_tr_b16 a[180:181], v218 offset:57344
  v_accvgpr_read_b32 v211, a204
  v_mfma_f32_16x16x32_bf16 a[12:15], a[164:167], v[120:123], a[12:15]
  v_mov_b32 v245, v208
  v_mov_b32 v246, v209
  v_mfma_f32_16x16x32_bf16 a[12:15], a[160:163], v[88:91], a[12:15]
  ds_read_b64_tr_b16 a[182:183], v218 offset:61440
  s_waitcnt lgkmcnt(4)
  v_mov_b32 v247, v210
  v_mfma_f32_16x16x32_bf16 a[16:19], a[168:171], v[64:67], a[16:19]
  v_mov_b32 v248, v211
  v_permlane16_swap_b32 v208, v245
  v_mfma_f32_16x16x32_bf16 a[16:19], a[172:175], v[96:99], a[16:19]
  ds_read_b64_tr_b16 a[184:185], v219 offset:49152
  v_permlane16_swap_b32 v209, v246
  v_mfma_f32_16x16x32_bf16 a[20:23], a[172:175], v[104:107], a[20:23]
  v_permlane16_swap_b32 v210, v247
  v_permlane16_swap_b32 v211, v248
  v_mfma_f32_16x16x32_bf16 a[20:23], a[168:171], v[72:75], a[20:23]
  ds_read_b64_tr_b16 a[186:187], v219 offset:53248
  v_add_f32 v208, v208, v245
  v_mfma_f32_16x16x32_bf16 a[24:27], a[168:171], v[80:83], a[24:27]
  v_add_f32 v209, v209, v246
  v_add_f32 v210, v210, v247
  v_mfma_f32_16x16x32_bf16 a[24:27], a[172:175], v[112:115], a[24:27]
  ds_read_b64_tr_b16 a[188:189], v219 offset:57344
  v_add_f32 v211, v211, v248
  v_mfma_f32_16x16x32_bf16 a[28:31], a[172:175], v[120:123], a[28:31]
  v_mov_b32 v245, v208
  v_mov_b32 v246, v209
  v_mfma_f32_16x16x32_bf16 a[28:31], a[168:171], v[88:91], a[28:31]
  ds_read_b64_tr_b16 a[190:191], v219 offset:61440
  s_waitcnt lgkmcnt(4)
  v_mov_b32 v247, v210
  v_mfma_f32_16x16x32_bf16 a[32:35], a[176:179], v[64:67], a[32:35]
  v_mov_b32 v248, v211
  v_permlane32_swap_b32 v208, v245
  v_mfma_f32_16x16x32_bf16 a[32:35], a[180:183], v[96:99], a[32:35]
  ds_read_b64_tr_b16 a[160:161], v220 offset:49152
  v_permlane32_swap_b32 v209, v246
  v_mfma_f32_16x16x32_bf16 a[36:39], a[180:183], v[104:107], a[36:39]
  v_permlane32_swap_b32 v210, v247
  v_permlane32_swap_b32 v211, v248
  v_mfma_f32_16x16x32_bf16 a[36:39], a[176:179], v[72:75], a[36:39]
  ds_read_b64_tr_b16 a[162:163], v220 offset:53248
  v_add_f32 v208, v208, v245
  v_mfma_f32_16x16x32_bf16 a[40:43], a[176:179], v[80:83], a[40:43]
  v_add_f32 v209, v209, v246
  v_add_f32 v210, v210, v247
  v_mfma_f32_16x16x32_bf16 a[40:43], a[180:183], v[112:115], a[40:43]
  ds_read_b64_tr_b16 a[164:165], v220 offset:57344
  v_add_f32 v211, v211, v248
  v_mfma_f32_16x16x32_bf16 a[44:47], a[180:183], v[120:123], a[44:47]
  v_rcp_f32 v192, v208
  v_mfma_f32_16x16x32_bf16 a[44:47], a[176:179], v[88:91], a[44:47]
  ds_read_b64_tr_b16 a[166:167], v220 offset:61440
  s_waitcnt lgkmcnt(4)
  v_mfma_f32_16x16x32_bf16 a[48:51], a[184:187], v[64:67], a[48:51]
  v_rcp_f32 v196, v209
  v_mfma_f32_16x16x32_bf16 a[48:51], a[188:191], v[96:99], a[48:51]
  ds_read_b64_tr_b16 a[168:169], v221 offset:49152
  v_mfma_f32_16x16x32_bf16 a[52:55], a[188:191], v[104:107], a[52:55]
  v_rcp_f32 v200, v210
  v_mfma_f32_16x16x32_bf16 a[52:55], a[184:187], v[72:75], a[52:55]
  ds_read_b64_tr_b16 a[170:171], v221 offset:53248
  v_mfma_f32_16x16x32_bf16 a[56:59], a[184:187], v[80:83], a[56:59]
  v_rcp_f32 v204, v211
  v_mfma_f32_16x16x32_bf16 a[56:59], a[188:191], v[112:115], a[56:59]
  ds_read_b64_tr_b16 a[172:173], v221 offset:57344
  v_add_f32 v246, v208, v209
  v_mfma_f32_16x16x32_bf16 a[60:63], a[188:191], v[120:123], a[60:63]
  v_add_f32 v247, v210, v211
  v_add_f32 v246, v246, v247
  v_mfma_f32_16x16x32_bf16 a[60:63], a[184:187], v[88:91], a[60:63]
  ds_read_b64_tr_b16 a[174:175], v221 offset:61440
  s_waitcnt lgkmcnt(4)
  v_lshrrev_b32 v247, 2, v242
  v_mfma_f32_16x16x32_bf16 a[64:67], a[160:163], v[64:67], a[64:67]
  v_cmp_nlt_f32 vcc, v246, s48
  v_add_u32 v247, s39, v247
  v_mfma_f32_16x16x32_bf16 a[64:67], a[164:167], v[96:99], a[64:67]
  ds_read_b64_tr_b16 a[176:177], v222 offset:49152
  v_add_u32 v247, 157696, v247
  v_mfma_f32_16x16x32_bf16 a[68:71], a[164:167], v[104:107], a[68:71]
  v_cndmask_b32_e64 v245, 0, 1, vcc
  v_accvgpr_read_b32 v0, a0
  v_mfma_f32_16x16x32_bf16 a[68:71], a[160:163], v[72:75], a[68:71]
  ds_read_b64_tr_b16 a[178:179], v222 offset:53248
  v_accvgpr_read_b32 v1, a1
  v_mfma_f32_16x16x32_bf16 a[72:75], a[160:163], v[80:83], a[72:75]
  v_accvgpr_read_b32 v2, a2
  v_accvgpr_read_b32 v3, a3
  v_mfma_f32_16x16x32_bf16 a[72:75], a[164:167], v[112:115], a[72:75]
  ds_read_b64_tr_b16 a[180:181], v222 offset:57344
  v_accvgpr_read_b32 v4, a16
  v_mfma_f32_16x16x32_bf16 a[76:79], a[164:167], v[120:123], a[76:79]
  v_accvgpr_read_b32 v5, a17
  v_accvgpr_read_b32 v6, a18
  v_mfma_f32_16x16x32_bf16 a[76:79], a[160:163], v[88:91], a[76:79]
  ds_read_b64_tr_b16 a[182:183], v222 offset:61440
  s_waitcnt lgkmcnt(4)
  v_accvgpr_read_b32 v7, a19
  v_mfma_f32_16x16x32_bf16 a[80:83], a[168:171], v[64:67], a[80:83]
  v_mul_f32 v0, v0, v192
  v_mul_f32 v1, v1, v192
  v_mfma_f32_16x16x32_bf16 a[80:83], a[172:175], v[96:99], a[80:83]
  ds_read_b64_tr_b16 a[184:185], v223 offset:49152
  v_mul_f32 v2, v2, v192
  v_mfma_f32_16x16x32_bf16 a[84:87], a[172:175], v[104:107], a[84:87]
  v_mul_f32 v3, v3, v192
  v_mul_f32 v4, v4, v192
  v_mfma_f32_16x16x32_bf16 a[84:87], a[168:171], v[72:75], a[84:87]
  ds_read_b64_tr_b16 a[186:187], v223 offset:53248
  v_mul_f32 v5, v5, v192
  v_mfma_f32_16x16x32_bf16 a[88:91], a[168:171], v[80:83], a[88:91]
  v_mul_f32 v6, v6, v192
  v_mul_f32 v7, v7, v192
  v_mfma_f32_16x16x32_bf16 a[88:91], a[172:175], v[112:115], a[88:91]
  ds_read_b64_tr_b16 a[188:189], v223 offset:57344
  v_cvt_pk_bf16_f32 v0, v0, v1
  v_mfma_f32_16x16x32_bf16 a[92:95], a[172:175], v[120:123], a[92:95]
  v_cvt_pk_bf16_f32 v1, v2, v3
  v_cvt_pk_bf16_f32 v2, v4, v5
  v_mfma_f32_16x16x32_bf16 a[92:95], a[168:171], v[88:91], a[92:95]
  ds_read_b64_tr_b16 a[190:191], v223 offset:61440
  s_waitcnt lgkmcnt(4)
  v_cvt_pk_bf16_f32 v3, v6, v7
  v_mfma_f32_16x16x32_bf16 a[96:99], a[176:179], v[64:67], a[96:99]
  buffer_store_dwordx4 v[0:3], v244, s[24:27], s40 offen offset:0 sc1
  v_mfma_f32_16x16x32_bf16 a[96:99], a[180:183], v[96:99], a[96:99]
  v_accvgpr_read_b32 v8, a4
  v_accvgpr_read_b32 v9, a5
  v_mfma_f32_16x16x32_bf16 a[100:103], a[180:183], v[104:107], a[100:103]
  v_accvgpr_read_b32 v10, a6
  v_accvgpr_read_b32 v11, a7
  v_mfma_f32_16x16x32_bf16 a[100:103], a[176:179], v[72:75], a[100:103]
  v_accvgpr_read_b32 v12, a20
  v_accvgpr_read_b32 v13, a21
  v_mfma_f32_16x16x32_bf16 a[104:107], a[176:179], v[80:83], a[104:107]
  v_accvgpr_read_b32 v14, a22
  v_accvgpr_read_b32 v15, a23
  v_mfma_f32_16x16x32_bf16 a[104:107], a[180:183], v[112:115], a[104:107]
  v_mul_f32 v8, v8, v196
  v_mul_f32 v9, v9, v196
  v_mfma_f32_16x16x32_bf16 a[108:111], a[180:183], v[120:123], a[108:111]
  v_mul_f32 v10, v10, v196
  v_mul_f32 v11, v11, v196
  v_mfma_f32_16x16x32_bf16 a[108:111], a[176:179], v[88:91], a[108:111]
  s_waitcnt lgkmcnt(0)
  v_mul_f32 v12, v12, v196
  v_mul_f32 v13, v13, v196
  v_mfma_f32_16x16x32_bf16 a[112:115], a[184:187], v[64:67], a[112:115]
  v_mul_f32 v14, v14, v196
  v_mul_f32 v15, v15, v196
  v_mfma_f32_16x16x32_bf16 a[112:115], a[188:191], v[96:99], a[112:115]
  v_cvt_pk_bf16_f32 v8, v8, v9
  v_cvt_pk_bf16_f32 v9, v10, v11
  v_mfma_f32_16x16x32_bf16 a[116:119], a[188:191], v[104:107], a[116:119]
  v_cvt_pk_bf16_f32 v10, v12, v13
  v_cvt_pk_bf16_f32 v11, v14, v15
  v_mfma_f32_16x16x32_bf16 a[116:119], a[184:187], v[72:75], a[116:119]
  buffer_store_dwordx4 v[8:11], v244, s[24:27], s40 offen offset:2048 sc1
  v_mfma_f32_16x16x32_bf16 a[120:123], a[184:187], v[80:83], a[120:123]
  v_accvgpr_read_b32 v16, a8
  v_accvgpr_read_b32 v17, a9
  v_mfma_f32_16x16x32_bf16 a[120:123], a[188:191], v[112:115], a[120:123]
  v_accvgpr_read_b32 v18, a10
  v_accvgpr_read_b32 v19, a11
  v_mfma_f32_16x16x32_bf16 a[124:127], a[188:191], v[120:123], a[124:127]
  v_accvgpr_read_b32 v20, a24
  v_accvgpr_read_b32 v21, a25
  v_mfma_f32_16x16x32_bf16 a[124:127], a[184:187], v[88:91], a[124:127]
  v_accvgpr_read_b32 v22, a26
  v_accvgpr_read_b32 v23, a27
  v_mul_f32 v16, v16, v200
  v_mul_f32 v17, v17, v200
  v_mul_f32 v18, v18, v200
  v_mul_f32 v19, v19, v200
  v_mul_f32 v20, v20, v200
  v_mul_f32 v21, v21, v200
  v_mul_f32 v22, v22, v200
  v_mul_f32 v23, v23, v200
  v_cvt_pk_bf16_f32 v16, v16, v17
  v_cvt_pk_bf16_f32 v17, v18, v19
  v_cvt_pk_bf16_f32 v18, v20, v21
  v_cvt_pk_bf16_f32 v19, v22, v23
  buffer_store_dwordx4 v[16:19], v244, s[24:27], s41 offen offset:0 sc1
  v_accvgpr_read_b32 v24, a12
  v_accvgpr_read_b32 v25, a13
  v_accvgpr_read_b32 v26, a14
  v_accvgpr_read_b32 v27, a15
  v_accvgpr_read_b32 v28, a28
  v_accvgpr_read_b32 v29, a29
  v_accvgpr_read_b32 v30, a30
  v_accvgpr_read_b32 v31, a31
  v_mul_f32 v24, v24, v204
  v_mul_f32 v25, v25, v204
  v_mul_f32 v26, v26, v204
  v_mul_f32 v27, v27, v204
  v_mul_f32 v28, v28, v204
  v_mul_f32 v29, v29, v204
  v_mul_f32 v30, v30, v204
  v_mul_f32 v31, v31, v204
  v_cvt_pk_bf16_f32 v24, v24, v25
  v_cvt_pk_bf16_f32 v25, v26, v27
  v_cvt_pk_bf16_f32 v26, v28, v29
  v_cvt_pk_bf16_f32 v27, v30, v31
  buffer_store_dwordx4 v[24:27], v244, s[24:27], s41 offen offset:2048 sc1
  v_accvgpr_read_b32 v32, a32
  v_accvgpr_read_b32 v33, a33
  v_accvgpr_read_b32 v34, a34
  v_accvgpr_read_b32 v35, a35
  v_accvgpr_read_b32 v36, a48
  v_accvgpr_read_b32 v37, a49
  v_accvgpr_read_b32 v38, a50
  v_accvgpr_read_b32 v39, a51
  v_mul_f32 v32, v32, v192
  v_mul_f32 v33, v33, v192
  v_mul_f32 v34, v34, v192
  v_mul_f32 v35, v35, v192
  v_mul_f32 v36, v36, v192
  v_mul_f32 v37, v37, v192
  v_mul_f32 v38, v38, v192
  v_mul_f32 v39, v39, v192
  v_cvt_pk_bf16_f32 v32, v32, v33
  v_cvt_pk_bf16_f32 v33, v34, v35
  v_cvt_pk_bf16_f32 v34, v36, v37
  v_cvt_pk_bf16_f32 v35, v38, v39
  buffer_store_dwordx4 v[32:35], v244, s[24:27], s40 offen offset:1024 sc1
  v_accvgpr_read_b32 v40, a36
  v_accvgpr_read_b32 v41, a37
  v_accvgpr_read_b32 v42, a38
  v_accvgpr_read_b32 v43, a39
  v_accvgpr_read_b32 v44, a52
  v_accvgpr_read_b32 v45, a53
  v_accvgpr_read_b32 v46, a54
  v_accvgpr_read_b32 v47, a55
  v_mul_f32 v40, v40, v196
  v_mul_f32 v41, v41, v196
  v_mul_f32 v42, v42, v196
  v_mul_f32 v43, v43, v196
  v_mul_f32 v44, v44, v196
  v_mul_f32 v45, v45, v196
  v_mul_f32 v46, v46, v196
  v_mul_f32 v47, v47, v196
  v_cvt_pk_bf16_f32 v40, v40, v41
  v_cvt_pk_bf16_f32 v41, v42, v43
  v_cvt_pk_bf16_f32 v42, v44, v45
  v_cvt_pk_bf16_f32 v43, v46, v47
  buffer_store_dwordx4 v[40:43], v244, s[24:27], s40 offen offset:3072 sc1
  v_accvgpr_read_b32 v48, a40
  v_accvgpr_read_b32 v49, a41
  v_accvgpr_read_b32 v50, a42
  v_accvgpr_read_b32 v51, a43
  v_accvgpr_read_b32 v52, a56
  v_accvgpr_read_b32 v53, a57
  v_accvgpr_read_b32 v54, a58
  v_accvgpr_read_b32 v55, a59
  v_mul_f32 v48, v48, v200
  v_mul_f32 v49, v49, v200
  v_mul_f32 v50, v50, v200
  v_mul_f32 v51, v51, v200
  v_mul_f32 v52, v52, v200
  v_mul_f32 v53, v53, v200
  v_mul_f32 v54, v54, v200
  v_mul_f32 v55, v55, v200
  v_cvt_pk_bf16_f32 v48, v48, v49
  v_cvt_pk_bf16_f32 v49, v50, v51
  v_cvt_pk_bf16_f32 v50, v52, v53
  v_cvt_pk_bf16_f32 v51, v54, v55
  buffer_store_dwordx4 v[48:51], v244, s[24:27], s41 offen offset:1024 sc1
  v_accvgpr_read_b32 v56, a44
  v_accvgpr_read_b32 v57, a45
  v_accvgpr_read_b32 v58, a46
  v_accvgpr_read_b32 v59, a47
  v_accvgpr_read_b32 v60, a60
  v_accvgpr_read_b32 v61, a61
  v_accvgpr_read_b32 v62, a62
  v_accvgpr_read_b32 v63, a63
  v_mul_f32 v56, v56, v204
  v_mul_f32 v57, v57, v204
  v_mul_f32 v58, v58, v204
  v_mul_f32 v59, v59, v204
  v_mul_f32 v60, v60, v204
  v_mul_f32 v61, v61, v204
  v_mul_f32 v62, v62, v204
  v_mul_f32 v63, v63, v204
  v_cvt_pk_bf16_f32 v56, v56, v57
  v_cvt_pk_bf16_f32 v57, v58, v59
  v_cvt_pk_bf16_f32 v58, v60, v61
  v_cvt_pk_bf16_f32 v59, v62, v63
  buffer_store_dwordx4 v[56:59], v244, s[24:27], s41 offen offset:3072 sc1
  v_accvgpr_read_b32 v0, a64
  v_accvgpr_read_b32 v1, a65
  v_accvgpr_read_b32 v2, a66
  v_accvgpr_read_b32 v3, a67
  v_accvgpr_read_b32 v4, a80
  v_accvgpr_read_b32 v5, a81
  v_accvgpr_read_b32 v6, a82
  v_accvgpr_read_b32 v7, a83
  v_mul_f32 v0, v0, v192
  v_mul_f32 v1, v1, v192
  v_mul_f32 v2, v2, v192
  v_mul_f32 v3, v3, v192
  v_mul_f32 v4, v4, v192
  v_mul_f32 v5, v5, v192
  v_mul_f32 v6, v6, v192
  v_mul_f32 v7, v7, v192
  v_cvt_pk_bf16_f32 v0, v0, v1
  v_cvt_pk_bf16_f32 v1, v2, v3
  v_cvt_pk_bf16_f32 v2, v4, v5
  v_cvt_pk_bf16_f32 v3, v6, v7
  buffer_store_dwordx4 v[0:3], v244, s[24:27], s42 offen offset:0 sc1
  v_accvgpr_read_b32 v8, a68
  v_accvgpr_read_b32 v9, a69
  v_accvgpr_read_b32 v10, a70
  v_accvgpr_read_b32 v11, a71
  v_accvgpr_read_b32 v12, a84
  v_accvgpr_read_b32 v13, a85
  v_accvgpr_read_b32 v14, a86
  v_accvgpr_read_b32 v15, a87
  v_mul_f32 v8, v8, v196
  v_mul_f32 v9, v9, v196
  v_mul_f32 v10, v10, v196
  v_mul_f32 v11, v11, v196
  v_mul_f32 v12, v12, v196
  v_mul_f32 v13, v13, v196
  v_mul_f32 v14, v14, v196
  v_mul_f32 v15, v15, v196
  v_cvt_pk_bf16_f32 v8, v8, v9
  v_cvt_pk_bf16_f32 v9, v10, v11
  v_cvt_pk_bf16_f32 v10, v12, v13
  v_cvt_pk_bf16_f32 v11, v14, v15
  buffer_store_dwordx4 v[8:11], v244, s[24:27], s42 offen offset:2048 sc1
  v_accvgpr_read_b32 v16, a72
  v_accvgpr_read_b32 v17, a73
  v_accvgpr_read_b32 v18, a74
  v_accvgpr_read_b32 v19, a75
  v_accvgpr_read_b32 v20, a88
  v_accvgpr_read_b32 v21, a89
  v_accvgpr_read_b32 v22, a90
  v_accvgpr_read_b32 v23, a91
  v_mul_f32 v16, v16, v200
  v_mul_f32 v17, v17, v200
  v_mul_f32 v18, v18, v200
  v_mul_f32 v19, v19, v200
  v_mul_f32 v20, v20, v200
  v_mul_f32 v21, v21, v200
  v_mul_f32 v22, v22, v200
  v_mul_f32 v23, v23, v200
  v_cvt_pk_bf16_f32 v16, v16, v17
  v_cvt_pk_bf16_f32 v17, v18, v19
  v_cvt_pk_bf16_f32 v18, v20, v21
  v_cvt_pk_bf16_f32 v19, v22, v23
  buffer_store_dwordx4 v[16:19], v244, s[24:27], s43 offen offset:0 sc1
  v_accvgpr_read_b32 v24, a76
  v_accvgpr_read_b32 v25, a77
  v_accvgpr_read_b32 v26, a78
  v_accvgpr_read_b32 v27, a79
  v_accvgpr_read_b32 v28, a92
  v_accvgpr_read_b32 v29, a93
  v_accvgpr_read_b32 v30, a94
  v_accvgpr_read_b32 v31, a95
  v_mul_f32 v24, v24, v204
  v_mul_f32 v25, v25, v204
  v_mul_f32 v26, v26, v204
  v_mul_f32 v27, v27, v204
  v_mul_f32 v28, v28, v204
  v_mul_f32 v29, v29, v204
  v_mul_f32 v30, v30, v204
  v_mul_f32 v31, v31, v204
  v_cvt_pk_bf16_f32 v24, v24, v25
  v_cvt_pk_bf16_f32 v25, v26, v27
  v_cvt_pk_bf16_f32 v26, v28, v29
  v_cvt_pk_bf16_f32 v27, v30, v31
  buffer_store_dwordx4 v[24:27], v244, s[24:27], s43 offen offset:2048 sc1
  v_accvgpr_read_b32 v32, a96
  v_accvgpr_read_b32 v33, a97
  v_accvgpr_read_b32 v34, a98
  v_accvgpr_read_b32 v35, a99
  v_accvgpr_read_b32 v36, a112
  v_accvgpr_read_b32 v37, a113
  v_accvgpr_read_b32 v38, a114
  v_accvgpr_read_b32 v39, a115
  v_mul_f32 v32, v32, v192
  v_mul_f32 v33, v33, v192
  v_mul_f32 v34, v34, v192
  v_mul_f32 v35, v35, v192
  v_mul_f32 v36, v36, v192
  v_mul_f32 v37, v37, v192
  v_mul_f32 v38, v38, v192
  v_mul_f32 v39, v39, v192
  v_cvt_pk_bf16_f32 v32, v32, v33
  v_cvt_pk_bf16_f32 v33, v34, v35
  v_cvt_pk_bf16_f32 v34, v36, v37
  v_cvt_pk_bf16_f32 v35, v38, v39
  buffer_store_dwordx4 v[32:35], v244, s[24:27], s42 offen offset:1024 sc1
  v_accvgpr_read_b32 v40, a100
  v_accvgpr_read_b32 v41, a101
  v_accvgpr_read_b32 v42, a102
  v_accvgpr_read_b32 v43, a103
  v_accvgpr_read_b32 v44, a116
  v_accvgpr_read_b32 v45, a117
  v_accvgpr_read_b32 v46, a118
  v_accvgpr_read_b32 v47, a119
  v_mul_f32 v40, v40, v196
  v_mul_f32 v41, v41, v196
  v_mul_f32 v42, v42, v196
  v_mul_f32 v43, v43, v196
  v_mul_f32 v44, v44, v196
  v_mul_f32 v45, v45, v196
  v_mul_f32 v46, v46, v196
  v_mul_f32 v47, v47, v196
  v_cvt_pk_bf16_f32 v40, v40, v41
  v_cvt_pk_bf16_f32 v41, v42, v43
  v_cvt_pk_bf16_f32 v42, v44, v45
  v_cvt_pk_bf16_f32 v43, v46, v47
  buffer_store_dwordx4 v[40:43], v244, s[24:27], s42 offen offset:3072 sc1
  v_accvgpr_read_b32 v48, a104
  v_accvgpr_read_b32 v49, a105
  v_accvgpr_read_b32 v50, a106
  v_accvgpr_read_b32 v51, a107
  v_accvgpr_read_b32 v52, a120
  v_accvgpr_read_b32 v53, a121
  v_accvgpr_read_b32 v54, a122
  v_accvgpr_read_b32 v55, a123
  v_mul_f32 v48, v48, v200
  v_mul_f32 v49, v49, v200
  v_mul_f32 v50, v50, v200
  v_mul_f32 v51, v51, v200
  v_mul_f32 v52, v52, v200
  v_mul_f32 v53, v53, v200
  v_mul_f32 v54, v54, v200
  v_mul_f32 v55, v55, v200
  v_cvt_pk_bf16_f32 v48, v48, v49
  v_cvt_pk_bf16_f32 v49, v50, v51
  v_cvt_pk_bf16_f32 v50, v52, v53
  v_cvt_pk_bf16_f32 v51, v54, v55
  buffer_store_dwordx4 v[48:51], v244, s[24:27], s43 offen offset:1024 sc1
  v_accvgpr_read_b32 v56, a108
  v_accvgpr_read_b32 v57, a109
  v_accvgpr_read_b32 v58, a110
  v_accvgpr_read_b32 v59, a111
  v_accvgpr_read_b32 v60, a124
  v_accvgpr_read_b32 v61, a125
  v_accvgpr_read_b32 v62, a126
  v_accvgpr_read_b32 v63, a127
  v_mul_f32 v56, v56, v204
  v_mul_f32 v57, v57, v204
  v_mul_f32 v58, v58, v204
  v_mul_f32 v59, v59, v204
  v_mul_f32 v60, v60, v204
  v_mul_f32 v61, v61, v204
  v_mul_f32 v62, v62, v204
  v_mul_f32 v63, v63, v204
  v_cvt_pk_bf16_f32 v56, v56, v57
  v_cvt_pk_bf16_f32 v57, v58, v59
  v_cvt_pk_bf16_f32 v58, v60, v61
  v_cvt_pk_bf16_f32 v59, v62, v63
  buffer_store_dwordx4 v[56:59], v244, s[24:27], s43 offen offset:3072 sc1
  ds_write_b32 v247, v245
  v_lshrrev_b32 v224, 4, v242
  v_lshrrev_b32 v225, 4, v224
  v_bfe_u32 v226, v224, 2, 2
  v_lshl_add_u32 v225, v225, 3, v226
  v_lshlrev_b32 v225, 5, v225
  v_and_b32 v226, 3, v224
  v_lshl_add_u32 v225, v226, 3, v225
  v_add_u32 v225, s50, v225
  s_waitcnt vmcnt(16)
  ds_read_b64_tr_b16 a[232:233], v225 offset:0
  ds_read_b64_tr_b16 a[234:235], v225 offset:128
  ds_read_b64_tr_b16 a[236:237], v225 offset:1024
  ds_read_b64_tr_b16 a[238:239], v225 offset:1152
  ds_read_b64_tr_b16 a[240:241], v225 offset:2048
  ds_read_b64_tr_b16 a[242:243], v225 offset:2176
  s_waitcnt lgkmcnt(0)
  v_mfma_f32_16x16x32_bf16 v[228:231], a[232:235], a[212:215], 0
  v_mfma_f32_16x16x32_bf16 v[228:231], a[236:239], a[216:219], v[228:231]
  v_mfma_f32_16x16x32_bf16 v[228:231], a[240:243], a[220:223], v[228:231]
  s_lshl_b32 s35, s3, 10
  s_add_u32 s35, s35, 159744
  v_add_u32 v224, s35, v242
  s_nop 4
  ds_write_b128 v224, v[228:231]
  s_waitcnt lgkmcnt(0)
  v_lshlrev_b32 v246, 0, v242
  v_add_u32 v246, 157696, v246
  s_waitcnt lgkmcnt(0)
  s_barrier
  ds_read_b128 v[248:251], v246
  v_add_u32 v224, 159744, v242
  ds_read_b128 v[64:67], v224 offset:0
  ds_read_b128 v[68:71], v224 offset:1024
  ds_read_b128 v[72:75], v224 offset:2048
  v_lshrrev_b32 v224, 4, v242
  s_cmp_eq_u32 s3, 0
  s_cselect_b32 s35, 0, 1073741824
  v_and_b32 v225, 7, v224
  v_mul_u32_u24 v225, 0xa00, v225
  v_lshrrev_b32 v226, 4, v224
  v_lshl_add_u32 v225, v226, 4, v225
  v_bfe_u32 v226, v224, 3, 1
  v_lshl_add_u32 v225, v226, 30, v225
  v_or_b32 v225, s35, v225
  s_mul_i32 s35, s98, 20480
  s_lshl_b32 s38, s99, 6
  s_add_u32 s35, s35, s38
  s_add_u32 s35, s35, 2686976
  s_waitcnt lgkmcnt(1)
  v_add_f32 v64, v64, v68
  v_add_f32 v65, v65, v69
  v_add_f32 v66, v66, v70
  v_add_f32 v67, v67, v71
  s_waitcnt lgkmcnt(0)
  v_add_f32 v64, v64, v72
  v_add_f32 v65, v65, v73
  v_add_f32 v66, v66, v74
  v_add_f32 v67, v67, v75
  buffer_store_dwordx4 v[64:67], v225, s[24:27], s35 offen sc1
  v_or3_b32 v248, v248, v249, v250
  v_or_b32 v248, v248, v251
  v_cmp_ne_u32 vcc, 0, v248
  s_nop 0
  s_cbranch_vccnz attn_redo
tail_go:
  s_and_b32 s36, s2, 1
  s_bfe_u32 s28, s2, 0x20001
  s_lshl_b32 s28, s28, 2
  s_bfe_u32 s38, s2, 0x20003
  s_add_u32 s28, s28, s38
  s_lshr_b32 s29, s2, 5
  v_mov_b32 v114, v242
  v_add_u32 v115, 0x1000, v114
  v_add_u32 v116, 0x2000, v114
  s_lshl_b32 s38, s36, 2
  s_add_u32 s38, s38, s3
  s_mul_i32 s39, s38, 81920
  s_lshl_b32 s30, s38, 16
  s_mul_i32 s31, s29, 655360
  s_add_u32 s31, s31, s39
  s_add_u32 s31, s31, 3145728
  s_mul_i32 s33, s3, 24576
  s_add_u32 s33, s33, 4096
  s_add_u32 s4, s31, 0
  s_add_u32 s5, s31, 12288
  s_add_u32 s6, s31, 24576
  s_add_u32 s7, s31, 36864
  s_add_u32 s8, s31, 49152
  s_add_u32 s9, s31, 61440
  s_add_u32 s10, s31, 73728
  buffer_load_dwordx4 v[176:179], v114, s[24:27], s4 offen offset:0 sc1
  buffer_load_dwordx4 v[180:183], v114, s[24:27], s4 offen offset:1024 sc1
  buffer_load_dwordx4 v[184:187], v114, s[24:27], s4 offen offset:2048 sc1
  buffer_load_dwordx4 v[188:191], v114, s[24:27], s4 offen offset:3072 sc1
  buffer_load_dwordx4 v[192:195], v115, s[24:27], s4 offen offset:0 sc1
  buffer_load_dwordx4 v[196:199], v115, s[24:27], s4 offen offset:1024 sc1
  buffer_load_dwordx4 v[200:203], v115, s[24:27], s4 offen offset:2048 sc1
  buffer_load_dwordx4 v[204:207], v115, s[24:27], s4 offen offset:3072 sc1
  buffer_load_dwordx4 v[208:211], v116, s[24:27], s4 offen offset:0 sc1
  buffer_load_dwordx4 v[212:215], v116, s[24:27], s4 offen offset:1024 sc1
  buffer_load_dwordx4 v[216:219], v116, s[24:27], s4 offen offset:2048 sc1
  buffer_load_dwordx4 v[220:223], v116, s[24:27], s4 offen offset:3072 sc1
  buffer_load_dwordx4 v[224:227], v114, s[24:27], s5 offen offset:0 sc1
  buffer_load_dwordx4 v[228:231], v114, s[24:27], s5 offen offset:1024 sc1
  buffer_load_dwordx4 v[232:235], v114, s[24:27], s5 offen offset:2048 sc1
  buffer_load_dwordx4 v[236:239], v114, s[24:27], s5 offen offset:3072 sc1
  s_bfe_u32 s38, s2, 0x40002
  s_lshl_b32 s38, s38, 8
  s_add_u32 s38, s38, 2818304
  s_mul_i32 s39, s99, 13108
  s_lshr_b32 s39, s39, 16
  s_lshl_b32 s39, s39, 8
  s_add_u32 s39, s39, 2822400
  s_cmp_lt_u32 s2, 240
  s_cselect_b32 s39, s39, 1073741824
  v_mov_b32 v135, 1073741824
  v_writelane_b32 v135, s38, 0
  v_writelane_b32 v135, s39, 1
  s_cmp_eq_u32 s3, 0
  s_cselect_b32 s38, 0, 1073741824
  v_or_b32 v135, s38, v135
  v_mov_b32 v129, 1
  s_waitcnt vmcnt(16)
  s_barrier
  buffer_atomic_add v129, v135, s[24:27], 0 offen
  buffer_load_dwordx4 v[240:243], v115, s[24:27], s5 offen offset:0 sc1
  buffer_load_dwordx4 v[244:247], v115, s[24:27], s5 offen offset:1024 sc1
  buffer_load_dwordx4 v[248:251], v115, s[24:27], s5 offen offset:2048 sc1
  buffer_load_dwordx4 v[252:255], v115, s[24:27], s5 offen offset:3072 sc1
  buffer_load_dwordx4 a[0:3], v116, s[24:27], s5 offen offset:0 sc1
  buffer_load_dwordx4 a[4:7], v116, s[24:27], s5 offen offset:1024 sc1
  buffer_load_dwordx4 a[8:11], v116, s[24:27], s5 offen offset:2048 sc1
  buffer_load_dwordx4 a[12:15], v116, s[24:27], s5 offen offset:3072 sc1
  buffer_load_dwordx4 a[16:19], v114, s[24:27], s6 offen offset:0 sc1
  buffer_load_dwordx4 a[20:23], v114, s[24:27], s6 offen offset:1024 sc1
  buffer_load_dwordx4 a[24:27], v114, s[24:27], s6 offen offset:2048 sc1
  buffer_load_dwordx4 a[28:31], v114, s[24:27], s6 offen offset:3072 sc1
  buffer_load_dwordx4 a[32:35], v115, s[24:27], s6 offen offset:0 sc1
  buffer_load_dwordx4 a[36:39], v115, s[24:27], s6 offen offset:1024 sc1
  buffer_load_dwordx4 a[40:43], v115, s[24:27], s6 offen offset:2048 sc1
  buffer_load_dwordx4 a[44:47], v115, s[24:27], s6 offen offset:3072 sc1
  buffer_load_dwordx4 a[48:51], v116, s[24:27], s6 offen offset:0 sc1
  buffer_load_dwordx4 a[52:55], v116, s[24:27], s6 offen offset:1024 sc1
  buffer_load_dwordx4 a[56:59], v116, s[24:27], s6 offen offset:2048 sc1
  buffer_load_dwordx4 a[60:63], v116, s[24:27], s6 offen offset:3072 sc1
  buffer_load_dwordx4 a[64:67], v114, s[24:27], s7 offen offset:0 sc1
  buffer_load_dwordx4 a[68:71], v114, s[24:27], s7 offen offset:1024 sc1
  buffer_load_dwordx4 a[72:75], v114, s[24:27], s7 offen offset:2048 sc1
  buffer_load_dwordx4 a[76:79], v114, s[24:27], s7 offen offset:3072 sc1
  v_lshrrev_b32 v125, 4, v114
  v_and_b32 v126, 15, v125
  v_lshrrev_b32 v127, 4, v125
  s_add_u32 s38, s3, 0
  s_and_b32 s38, s38, 3
  s_lshl_b32 s38, s38, 11
  v_add_u32 v110, s38, v114
  s_sub_u32 s38, s3, 0
  s_and_b32 s38, s38, 3
  s_mul_i32 s38, s38, 15360
  s_add_u32 s38, s38, 102400
  v_add_u32 v118, s38, v114
  s_add_u32 s38, s3, 1
  s_and_b32 s38, s38, 3
  s_lshl_b32 s38, s38, 11
  v_add_u32 v111, s38, v114
  s_sub_u32 s38, s3, 1
  s_and_b32 s38, s38, 3
  s_mul_i32 s38, s38, 15360
  s_add_u32 s38, s38, 102400
  v_add_u32 v119, s38, v114
  s_add_u32 s38, s3, 2
  s_and_b32 s38, s38, 3
  s_lshl_b32 s38, s38, 11
  v_add_u32 v112, s38, v114
  s_sub_u32 s38, s3, 2
  s_and_b32 s38, s38, 3
  s_mul_i32 s38, s38, 15360
  s_add_u32 s38, s38, 107520
  v_add_u32 v120, s38, v114
  s_add_u32 s38, s3, 3
  s_and_b32 s38, s38, 3
  s_lshl_b32 s38, s38, 11
  v_add_u32 v113, s38, v114
  s_sub_u32 s38, s3, 3
  s_and_b32 s38, s38, 3
  s_mul_i32 s38, s38, 15360
  s_add_u32 s38, s38, 112640
  v_add_u32 v121, s38, v114
  v_add_u32 v122, s33, v114
  s_and_b32 s38, s28, 14
  s_add_u32 s38, s38, s36
  s_lshl_b32 s38, s38, 8
  s_add_u32 s38, s38, 2818304
  s_lshl_b32 s39, s29, 8
  s_add_u32 s39, s39, 2822400
  v_mov_b32 v133, s38
  v_writelane_b32 v133, s39, 1
  v_mov_b32 v134, 16
  v_writelane_b32 v134, 30, 1
  s_lshl_b32 s28, s28, 1
  s_add_u32 s28, s28, s36
  s_add_u32 s30, s30, 8388608
  s_lshl_b32 s38, s28, 19
  s_add_u32 s37, s30, s38
  s_xor_b32 s38, s38, 0x80000
  s_add_u32 s30, s30, s38
  s_lshl_b32 s40, s29, 5
  s_add_u32 s40, s40, s28
  s_lshl_b32 s38, s28, 6
  s_lshl_b32 s39, s3, 4
  s_add_u32 s38, s38, s39
  v_add_u32 v128, s38, v126
  v_mul_u32_u24 v117, 0x500, v128
  v_lshl_add_u32 v117, v127, 3, v117
  s_mul_i32 s38, s29, 160
  v_add_u32 v117, s38, v117
  s_mov_b32 s12, s60
  s_mov_b32 s13, s61
  s_mov_b32 s14, 2621440
  s_mov_b32 s15, 0x20000
  s_mov_b32 s16, s62
  s_mov_b32 s17, s63
  s_mov_b32 s18, 2621440
  s_mov_b32 s19, 0x20000
  s_mul_i32 s38, s28, 81920
  s_lshl_b32 s39, s3, 10
  s_add_u32 s38, s38, s39
  s_mul_i32 s39, s29, 10
  v_lshrrev_b32 v129, 1, v127
  v_add_u32 v129, s39, v129
  v_and_b32 v130, 1, v127
  v_lshlrev_b32 v130, 3, v130
  v_lshl_add_u32 v130, v126, 4, v130
  v_lshrrev_b32 v131, 2, v129
  v_lshl_add_u32 v131, v131, 12, v130
  v_and_b32 v132, 3, v129
  v_lshl_add_u32 v131, v132, 8, v131
  buffer_load_dwordx2 v[156:157], v131, s[24:27], s38 offen
  v_add_u32 v129, 2, v129
  buffer_load_dwordx2 v[80:81], v117, s[12:15], 0 offen offset:0
  v_lshrrev_b32 v131, 2, v129
  v_lshl_add_u32 v131, v131, 12, v130
  v_and_b32 v132, 3, v129
  v_lshl_add_u32 v131, v132, 8, v131
  buffer_load_dwordx2 v[158:159], v131, s[24:27], s38 offen
  v_add_u32 v129, 2, v129
  buffer_load_dwordx2 v[82:83], v117, s[12:15], 0 offen offset:32
  v_lshrrev_b32 v131, 2, v129
  v_lshl_add_u32 v131, v131, 12, v130
  v_and_b32 v132, 3, v129
  v_lshl_add_u32 v131, v132, 8, v131
  buffer_load_dwordx2 v[160:161], v131, s[24:27], s38 offen
  v_add_u32 v129, 2, v129
  buffer_load_dwordx2 v[84:85], v117, s[12:15], 0 offen offset:64
  v_lshrrev_b32 v131, 2, v129
  v_lshl_add_u32 v131, v131, 12, v130
  v_and_b32 v132, 3, v129
  v_lshl_add_u32 v131, v132, 8, v131
  buffer_load_dwordx2 v[162:163], v131, s[24:27], s38 offen
  v_add_u32 v129, 2, v129
  buffer_load_dwordx2 v[86:87], v117, s[12:15], 0 offen offset:96
  v_lshrrev_b32 v131, 2, v129
  v_lshl_add_u32 v131, v131, 12, v130
  v_and_b32 v132, 3, v129
  v_lshl_add_u32 v131, v132, 8, v131
  buffer_load_dwordx2 v[164:165], v131, s[24:27], s38 offen
  v_add_u32 v129, 2, v129
  buffer_load_dwordx2 v[88:89], v117, s[12:15], 0 offen offset:128
  v_mov_b32 v123, 1073741824
  v_bfrev_b32 v124, 1
  v_sub_u32 v128, 0xffff, v128
  s_mov_b32 s34, 0xffff0000
  s_and_b32 s38, s52, 0xffff
  v_cmp_eq_u32 vcc, s38, v128
  v_mov_b32 v129, s52
  v_mov_b32 v130, 0
  v_cndmask_b32 v124, v124, v129, vcc
  v_cndmask_b32 v123, v123, v130, vcc
  s_and_b32 s38, s53, 0xffff
  v_cmp_eq_u32 vcc, s38, v128
  v_mov_b32 v129, s53
  v_mov_b32 v130, 2560
  v_cndmask_b32 v124, v124, v129, vcc
  v_cndmask_b32 v123, v123, v130, vcc
  s_and_b32 s38, s54, 0xffff
  v_cmp_eq_u32 vcc, s38, v128
  v_mov_b32 v129, s54
  v_mov_b32 v130, 5120
  v_cndmask_b32 v124, v124, v129, vcc
  v_cndmask_b32 v123, v123, v130, vcc
  s_and_b32 s38, s55, 0xffff
  v_cmp_eq_u32 vcc, s38, v128
  v_mov_b32 v129, s55
  v_mov_b32 v130, 7680
  v_cndmask_b32 v124, v124, v129, vcc
  v_cndmask_b32 v123, v123, v130, vcc
  s_and_b32 s38, s56, 0xffff
  v_cmp_eq_u32 vcc, s38, v128
  v_mov_b32 v129, s56
  v_mov_b32 v130, 10240
  v_cndmask_b32 v124, v124, v129, vcc
  v_cndmask_b32 v123, v123, v130, vcc
  s_and_b32 s38, s57, 0xffff
  v_cmp_eq_u32 vcc, s38, v128
  v_mov_b32 v129, s57
  v_mov_b32 v130, 12800
  v_cndmask_b32 v124, v124, v129, vcc
  v_cndmask_b32 v123, v123, v130, vcc
  s_and_b32 s38, s58, 0xffff
  v_cmp_eq_u32 vcc, s38, v128
  v_mov_b32 v129, s58
  v_mov_b32 v130, 15360
  v_cndmask_b32 v124, v124, v129, vcc
  v_cndmask_b32 v123, v123, v130, vcc
  s_and_b32 s38, s59, 0xffff
  v_cmp_eq_u32 vcc, s38, v128
  v_mov_b32 v129, s59
  v_mov_b32 v130, 17920
  v_cndmask_b32 v124, v124, v129, vcc
  v_cndmask_b32 v123, v123, v130, vcc
  v_lshl_add_u32 v123, v127, 4, v123
  s_mul_i32 s32, s29, 320
  s_add_u32 s32, s32, 2686976
  v_ashrrev_i32 v129, 31, v124
  v_not_b32 v129, v129
  v_or_b32 v129, 0x80000000, v129
  v_xor_b32 v124, v124, v129
  v_and_b32 v124, s34, v124
  v_mul_f32 v124, 0xbfb8aa3b, v124
  v_exp_f32 v124, v124
  s_nop 0
  v_add_f32 v124, 1.0, v124
  v_rcp_f32 v124, v124
  s_nop 0
  v_cvt_pk_bf16_f32 v124, v124, v124
  v_lshlrev_b32 v124, 16, v124
  buffer_load_dword v128, v133, s[24:27], 0 offen sc1
  buffer_load_dwordx4 a[80:83], v115, s[24:27], s7 offen offset:0 sc1
  buffer_load_dwordx4 a[84:87], v115, s[24:27], s7 offen offset:1024 sc1
  buffer_load_dwordx4 a[88:91], v115, s[24:27], s7 offen offset:2048 sc1
  buffer_load_dwordx4 a[92:95], v115, s[24:27], s7 offen offset:3072 sc1
  buffer_load_dwordx4 a[96:99], v116, s[24:27], s7 offen offset:0 sc1
  buffer_load_dwordx4 a[100:103], v116, s[24:27], s7 offen offset:1024 sc1
  buffer_load_dwordx4 a[104:107], v116, s[24:27], s7 offen offset:2048 sc1
  buffer_load_dwordx4 a[108:111], v116, s[24:27], s7 offen offset:3072 sc1
  buffer_load_dwordx4 a[112:115], v114, s[24:27], s8 offen offset:0 sc1
  buffer_load_dwordx4 a[116:119], v114, s[24:27], s8 offen offset:1024 sc1
  s_waitcnt vmcnt(60)
  buffer_load_dwordx4 a[120:123], v114, s[24:27], s8 offen offset:2048 sc1
  buffer_load_dwordx4 a[124:127], v114, s[24:27], s8 offen offset:3072 sc1
  s_waitcnt vmcnt(60)
  buffer_load_dwordx4 a[128:131], v115, s[24:27], s8 offen offset:0 sc1
  buffer_load_dwordx4 a[132:135], v115, s[24:27], s8 offen offset:1024 sc1
  s_waitcnt vmcnt(60)
  buffer_load_dwordx4 a[136:139], v115, s[24:27], s8 offen offset:2048 sc1
  buffer_load_dwordx4 a[140:143], v115, s[24:27], s8 offen offset:3072 sc1
  s_add_u32 m0, s33, 0
  s_waitcnt vmcnt(60)
  buffer_load_dwordx4 v116, s[24:27], s8 offen offset:0 sc1 lds
  s_add_u32 m0, s33, 0
  s_nop 0
  buffer_load_dwordx4 v116, s[24:27], s8 offen offset:1024 sc1 lds
  s_add_u32 m0, s33, 0
  s_waitcnt vmcnt(60)
  buffer_load_dwordx4 v116, s[24:27], s8 offen offset:2048 sc1 lds
  s_add_u32 m0, s33, 0
  s_nop 0
  buffer_load_dwordx4 v116, s[24:27], s8 offen offset:3072 sc1 lds
  s_add_u32 m0, s33, 4096
  s_waitcnt vmcnt(60)
  buffer_load_dwordx4 v114, s[24:27], s9 offen offset:0 sc1 lds
  s_add_u32 m0, s33, 4096
  s_nop 0
  buffer_load_dwordx4 v114, s[24:27], s9 offen offset:1024 sc1 lds
  s_add_u32 m0, s33, 4096
  s_waitcnt vmcnt(60)
  buffer_load_dwordx4 v114, s[24:27], s9 offen offset:2048 sc1 lds
  s_add_u32 m0, s33, 4096
  s_nop 0
  buffer_load_dwordx4 v114, s[24:27], s9 offen offset:3072 sc1 lds
  s_add_u32 m0, s33, 8192
  s_waitcnt vmcnt(60)
  buffer_load_dwordx4 v115, s[24:27], s9 offen offset:0 sc1 lds
  s_add_u32 m0, s33, 8192
  s_nop 0
  buffer_load_dwordx4 v115, s[24:27], s9 offen offset:1024 sc1 lds
  s_add_u32 m0, s33, 8192
  s_waitcnt vmcnt(60)
  buffer_load_dwordx4 v115, s[24:27], s9 offen offset:2048 sc1 lds
  s_add_u32 m0, s33, 8192
  s_nop 0
  buffer_load_dwordx4 v115, s[24:27], s9 offen offset:3072 sc1 lds
  s_add_u32 m0, s33, 12288
  s_waitcnt vmcnt(60)
  buffer_load_dwordx4 v116, s[24:27], s9 offen offset:0 sc1 lds
  s_add_u32 m0, s33, 12288
  s_nop 0
  buffer_load_dwordx4 v116, s[24:27], s9 offen offset:1024 sc1 lds
  s_add_u32 m0, s33, 12288
  s_waitcnt vmcnt(60)
  buffer_load_dwordx4 v116, s[24:27], s9 offen offset:2048 sc1 lds
  s_add_u32 m0, s33, 12288
  s_nop 0
  buffer_load_dwordx4 v116, s[24:27], s9 offen offset:3072 sc1 lds
  s_add_u32 m0, s33, 16384
  s_waitcnt vmcnt(60)
  buffer_load_dwordx4 v114, s[24:27], s10 offen offset:0 sc1 lds
  s_add_u32 m0, s33, 16384
  s_nop 0
  buffer_load_dwordx4 v114, s[24:27], s10 offen offset:1024 sc1 lds
  s_add_u32 m0, s33, 16384
  s_waitcnt vmcnt(60)
  buffer_load_dwordx4 v114, s[24:27], s10 offen offset:2048 sc1 lds
  s_add_u32 m0, s33, 16384
  s_nop 0
  buffer_load_dwordx4 v114, s[24:27], s10 offen offset:3072 sc1 lds
  s_add_u32 m0, s33, 20480
  s_waitcnt vmcnt(60)
  buffer_load_dwordx4 v115, s[24:27], s10 offen offset:0 sc1 lds
  s_add_u32 m0, s33, 20480
  s_nop 0
  buffer_load_dwordx4 v115, s[24:27], s10 offen offset:1024 sc1 lds
  s_add_u32 m0, s33, 20480
  s_waitcnt vmcnt(60)
  buffer_load_dwordx4 v115, s[24:27], s10 offen offset:2048 sc1 lds
  s_add_u32 m0, s33, 20480
  s_nop 0
  buffer_load_dwordx4 v115, s[24:27], s10 offen offset:3072 sc1 lds
  s_waitcnt vmcnt(50)
  v_lshlrev_b32 v90, 16, v156
  v_and_b32 v91, s34, v156
  v_lshlrev_b32 v92, 16, v157
  v_and_b32 v93, s34, v157
  s_waitcnt vmcnt(48)
  v_lshlrev_b32 v94, 16, v158
  v_and_b32 v95, s34, v158
  v_lshlrev_b32 v96, 16, v159
  v_and_b32 v97, s34, v159
  s_waitcnt vmcnt(46)
  v_lshlrev_b32 v98, 16, v160
  v_and_b32 v99, s34, v160
  v_lshlrev_b32 v100, 16, v161
  v_and_b32 v101, s34, v161
  s_waitcnt vmcnt(44)
  v_lshlrev_b32 v102, 16, v162
  v_and_b32 v103, s34, v162
  v_lshlrev_b32 v104, 16, v163
  v_and_b32 v105, s34, v163
  s_waitcnt vmcnt(42)
  v_lshlrev_b32 v106, 16, v164
  v_and_b32 v107, s34, v164
  v_lshlrev_b32 v108, 16, v165
  v_and_b32 v109, s34, v165
  s_waitcnt vmcnt(40)
  v_cmp_lt_u32 vcc, v128, v134
  s_nop 0
  s_cbranch_vccz tail_ready
  s_mov_b32 s35, 32768
tail_spin:
  s_sleep 2
  buffer_load_dword v128, v133, s[24:27], 0 offen sc1
  s_waitcnt vmcnt(0)
  v_cmp_lt_u32 vcc, v128, v134
  s_nop 0
  s_cbranch_vccz tail_ready
  s_sub_u32 s35, s35, 1
  s_cmp_lg_u32 s35, 0
  s_cbranch_scc1 tail_spin
tail_ready:
  buffer_load_dwordx4 v[156:159], v123, s[24:27], s32 offen offset:0 sc1
  buffer_load_dwordx4 v[160:163], v123, s[24:27], s32 offen offset:64 sc1
  buffer_load_dwordx4 v[164:167], v123, s[24:27], s32 offen offset:128 sc1
  buffer_load_dwordx4 v[168:171], v123, s[24:27], s32 offen offset:192 sc1
  buffer_load_dwordx4 v[172:175], v123, s[24:27], s32 offen offset:256 sc1
  s_add_u32 s32, s32, 20480
  buffer_load_dwordx4 v[136:139], v123, s[24:27], s32 offen offset:0 sc1
  buffer_load_dwordx4 v[140:143], v123, s[24:27], s32 offen offset:64 sc1
  buffer_load_dwordx4 v[144:147], v123, s[24:27], s32 offen offset:128 sc1
  buffer_load_dwordx4 v[148:151], v123, s[24:27], s32 offen offset:192 sc1
  buffer_load_dwordx4 v[152:155], v123, s[24:27], s32 offen offset:256 sc1
  s_add_u32 s32, s32, 20480
  buffer_load_dwordx4 v[0:3], v123, s[24:27], s32 offen offset:0 sc1
  buffer_load_dwordx4 v[4:7], v123, s[24:27], s32 offen offset:64 sc1
  buffer_load_dwordx4 v[8:11], v123, s[24:27], s32 offen offset:128 sc1
  buffer_load_dwordx4 v[12:15], v123, s[24:27], s32 offen offset:192 sc1
  buffer_load_dwordx4 v[16:19], v123, s[24:27], s32 offen offset:256 sc1
  s_add_u32 s32, s32, 20480
  buffer_load_dwordx4 v[20:23], v123, s[24:27], s32 offen offset:0 sc1
  buffer_load_dwordx4 v[24:27], v123, s[24:27], s32 offen offset:64 sc1
  buffer_load_dwordx4 v[28:31], v123, s[24:27], s32 offen offset:128 sc1
  buffer_load_dwordx4 v[32:35], v123, s[24:27], s32 offen offset:192 sc1
  buffer_load_dwordx4 v[36:39], v123, s[24:27], s32 offen offset:256 sc1
  s_add_u32 s32, s32, 20480
  buffer_load_dwordx4 v[40:43], v123, s[24:27], s32 offen offset:0 sc1
  buffer_load_dwordx4 v[44:47], v123, s[24:27], s32 offen offset:64 sc1
  s_waitcnt vmcnt(60)
  buffer_load_dwordx4 v[48:51], v123, s[24:27], s32 offen offset:128 sc1
  buffer_load_dwordx4 v[52:55], v123, s[24:27], s32 offen offset:192 sc1
  s_waitcnt vmcnt(60)
  buffer_load_dwordx4 v[56:59], v123, s[24:27], s32 offen offset:256 sc1
  s_add_u32 s32, s32, 20480
  buffer_load_dwordx4 v[60:63], v123, s[24:27], s32 offen offset:0 sc1
  s_waitcnt vmcnt(60)
  buffer_load_dwordx4 v[64:67], v123, s[24:27], s32 offen offset:64 sc1
  buffer_load_dwordx4 v[68:71], v123, s[24:27], s32 offen offset:128 sc1
  s_waitcnt vmcnt(60)
  buffer_load_dwordx4 v[72:75], v123, s[24:27], s32 offen offset:192 sc1
  buffer_load_dwordx4 v[76:79], v123, s[24:27], s32 offen offset:256 sc1
  s_add_u32 s32, s32, 20480
  s_waitcnt vmcnt(60)
  buffer_load_dwordx4 a[144:147], v110, s[24:27], s30 offen offset:0 sc1
  buffer_load_dwordx4 a[148:151], v110, s[24:27], s30 offen offset:1024 sc1
  s_waitcnt vmcnt(60)
  buffer_load_dwordx4 a[152:155], v111, s[24:27], s30 offen offset:0 sc1
  buffer_load_dwordx4 a[156:159], v111, s[24:27], s30 offen offset:1024 sc1
  s_waitcnt vmcnt(60)
  buffer_load_dwordx4 a[160:163], v112, s[24:27], s30 offen offset:0 sc1
  buffer_load_dwordx4 a[164:167], v112, s[24:27], s30 offen offset:1024 sc1
  s_waitcnt vmcnt(60)
  buffer_load_dwordx4 a[168:171], v113, s[24:27], s30 offen offset:0 sc1
  buffer_load_dwordx4 a[172:175], v113, s[24:27], s30 offen offset:1024 sc1
  s_add_u32 s30, s30, 8192
  s_waitcnt vmcnt(60)
  buffer_load_dwordx4 a[176:179], v110, s[24:27], s30 offen offset:0 sc1
  buffer_load_dwordx4 a[180:183], v110, s[24:27], s30 offen offset:1024 sc1
  s_waitcnt vmcnt(60)
  buffer_load_dwordx4 a[184:187], v111, s[24:27], s30 offen offset:0 sc1
  buffer_load_dwordx4 a[188:191], v111, s[24:27], s30 offen offset:1024 sc1
  s_waitcnt vmcnt(60)
  buffer_load_dwordx4 a[192:195], v112, s[24:27], s30 offen offset:0 sc1
  buffer_load_dwordx4 a[196:199], v112, s[24:27], s30 offen offset:1024 sc1
  s_waitcnt vmcnt(60)
  buffer_load_dwordx4 a[200:203], v113, s[24:27], s30 offen offset:0 sc1
  buffer_load_dwordx4 a[204:207], v113, s[24:27], s30 offen offset:1024 sc1
  s_add_u32 s30, s30, 8192
  s_waitcnt vmcnt(60)
  buffer_load_dwordx4 a[208:211], v110, s[24:27], s30 offen offset:0 sc1
  buffer_load_dwordx4 a[212:215], v110, s[24:27], s30 offen offset:1024 sc1
  s_waitcnt vmcnt(60)
  buffer_load_dwordx4 a[216:219], v111, s[24:27], s30 offen offset:0 sc1
  buffer_load_dwordx4 a[220:223], v111, s[24:27], s30 offen offset:1024 sc1
  s_waitcnt vmcnt(60)
  buffer_load_dwordx4 a[224:227], v112, s[24:27], s30 offen offset:0 sc1
  buffer_load_dwordx4 a[228:231], v112, s[24:27], s30 offen offset:1024 sc1
  s_waitcnt vmcnt(60)
  buffer_load_dwordx4 a[232:235], v113, s[24:27], s30 offen offset:0 sc1
  buffer_load_dwordx4 a[236:239], v113, s[24:27], s30 offen offset:1024 sc1
  s_add_u32 s30, s30, 8192
  s_waitcnt vmcnt(60)
  buffer_load_dwordx4 a[240:243], v110, s[24:27], s30 offen offset:0 sc1
  buffer_load_dwordx4 a[244:247], v110, s[24:27], s30 offen offset:1024 sc1
  s_waitcnt vmcnt(60)
  buffer_load_dwordx4 a[248:251], v111, s[24:27], s30 offen offset:0 sc1
  buffer_load_dwordx4 a[252:255], v111, s[24:27], s30 offen offset:1024 sc1
  s_waitcnt vmcnt(52)
  v_add_f32 v156, v156, v136
  v_add_f32 v157, v157, v137
  v_add_f32 v158, v158, v138
  v_add_f32 v159, v159, v139
  s_waitcnt vmcnt(51)
  v_add_f32 v160, v160, v140
  v_add_f32 v161, v161, v141
  v_add_f32 v162, v162, v142
  v_add_f32 v163, v163, v143
  s_waitcnt vmcnt(50)
  v_add_f32 v164, v164, v144
  v_add_f32 v165, v165, v145
  v_add_f32 v166, v166, v146
  v_add_f32 v167, v167, v147
  s_waitcnt vmcnt(49)
  v_add_f32 v168, v168, v148
  v_add_f32 v169, v169, v149
  v_add_f32 v170, v170, v150
  v_add_f32 v171, v171, v151
  s_waitcnt vmcnt(48)
  v_add_f32 v172, v172, v152
  v_add_f32 v173, v173, v153
  v_add_f32 v174, v174, v154
  v_add_f32 v175, v175, v155
  s_waitcnt vmcnt(47)
  v_add_f32 v156, v156, v0
  v_add_f32 v157, v157, v1
  v_add_f32 v158, v158, v2
  v_add_f32 v159, v159, v3
  s_waitcnt vmcnt(46)
  v_add_f32 v160, v160, v4
  v_add_f32 v161, v161, v5
  v_add_f32 v162, v162, v6
  v_add_f32 v163, v163, v7
  s_waitcnt vmcnt(45)
  v_add_f32 v164, v164, v8
  v_add_f32 v165, v165, v9
  v_add_f32 v166, v166, v10
  v_add_f32 v167, v167, v11
  s_waitcnt vmcnt(44)
  v_add_f32 v168, v168, v12
  v_add_f32 v169, v169, v13
  v_add_f32 v170, v170, v14
  v_add_f32 v171, v171, v15
  s_waitcnt vmcnt(43)
  v_add_f32 v172, v172, v16
  v_add_f32 v173, v173, v17
  v_add_f32 v174, v174, v18
  v_add_f32 v175, v175, v19
  s_waitcnt vmcnt(42)
  v_add_f32 v156, v156, v20
  v_add_f32 v157, v157, v21
  v_add_f32 v158, v158, v22
  v_add_f32 v159, v159, v23
  s_waitcnt vmcnt(41)
  v_add_f32 v160, v160, v24
  v_add_f32 v161, v161, v25
  v_add_f32 v162, v162, v26
  v_add_f32 v163, v163, v27
  s_waitcnt vmcnt(40)
  v_add_f32 v164, v164, v28
  v_add_f32 v165, v165, v29
  v_add_f32 v166, v166, v30
  v_add_f32 v167, v167, v31
  s_waitcnt vmcnt(39)
  v_add_f32 v168, v168, v32
  v_add_f32 v169, v169, v33
  v_add_f32 v170, v170, v34
  v_add_f32 v171, v171, v35
  s_waitcnt vmcnt(38)
  v_add_f32 v172, v172, v36
  v_add_f32 v173, v173, v37
  v_add_f32 v174, v174, v38
  v_add_f32 v175, v175, v39
  s_waitcnt vmcnt(37)
  v_add_f32 v156, v156, v40
  v_add_f32 v157, v157, v41
  v_add_f32 v158, v158, v42
  v_add_f32 v159, v159, v43
  s_waitcnt vmcnt(36)
  v_add_f32 v160, v160, v44
  v_add_f32 v161, v161, v45
  v_add_f32 v162, v162, v46
  v_add_f32 v163, v163, v47
  s_waitcnt vmcnt(35)
  v_add_f32 v164, v164, v48
  v_add_f32 v165, v165, v49
  v_add_f32 v166, v166, v50
  v_add_f32 v167, v167, v51
  s_waitcnt vmcnt(34)
  v_add_f32 v168, v168, v52
  v_add_f32 v169, v169, v53
  v_add_f32 v170, v170, v54
  v_add_f32 v171, v171, v55
  s_waitcnt vmcnt(33)
  v_add_f32 v172, v172, v56
  v_add_f32 v173, v173, v57
  v_add_f32 v174, v174, v58
  v_add_f32 v175, v175, v59
  s_waitcnt vmcnt(32)
  v_add_f32 v156, v156, v60
  v_add_f32 v157, v157, v61
  v_add_f32 v158, v158, v62
  v_add_f32 v159, v159, v63
  s_waitcnt vmcnt(31)
  v_add_f32 v160, v160, v64
  v_add_f32 v161, v161, v65
  v_add_f32 v162, v162, v66
  v_add_f32 v163, v163, v67
  s_waitcnt vmcnt(30)
  v_add_f32 v164, v164, v68
  v_add_f32 v165, v165, v69
  v_add_f32 v166, v166, v70
  v_add_f32 v167, v167, v71
  s_waitcnt vmcnt(29)
  v_add_f32 v168, v168, v72
  v_add_f32 v169, v169, v73
  v_add_f32 v170, v170, v74
  v_add_f32 v171, v171, v75
  s_waitcnt vmcnt(28)
  v_add_f32 v172, v172, v76
  v_add_f32 v173, v173, v77
  v_add_f32 v174, v174, v78
  v_add_f32 v175, v175, v79
  s_waitcnt vmcnt(20)
  v_mfma_f32_16x16x32_bf16 v[0:3], v[176:179], a[144:147], 0
  buffer_load_dwordx4 v[136:139], v112, s[24:27], s30 offen offset:0 sc1
  v_mfma_f32_16x16x32_bf16 v[0:3], v[196:199], a[148:151], v[0:3]
  buffer_load_dwordx4 v[140:143], v112, s[24:27], s30 offen offset:1024 sc1
  v_mfma_f32_16x16x32_bf16 v[4:7], v[196:199], a[156:159], 0
  buffer_load_dwordx4 v[144:147], v113, s[24:27], s30 offen offset:0 sc1
  v_mfma_f32_16x16x32_bf16 v[4:7], v[176:179], a[152:155], v[4:7]
  buffer_load_dwordx4 v[148:151], v113, s[24:27], s30 offen offset:1024 sc1
  s_add_u32 s30, s30, 8192
  v_mfma_f32_16x16x32_bf16 v[8:11], v[176:179], a[160:163], 0
  buffer_load_dwordx4 v[152:155], v110, s[24:27], s30 offen offset:0 sc1
  v_mfma_f32_16x16x32_bf16 v[8:11], v[196:199], a[164:167], v[8:11]
  v_cvt_pk_bf16_f32 v156, v156, v156
  v_cvt_pk_bf16_f32 v157, v157, v157
  v_mfma_f32_16x16x32_bf16 v[12:15], v[196:199], a[172:175], 0
  v_cvt_pk_bf16_f32 v158, v158, v158
  v_cvt_pk_bf16_f32 v159, v159, v159
  v_mfma_f32_16x16x32_bf16 v[12:15], v[176:179], a[168:171], v[12:15]
  v_lshlrev_b32 v156, 16, v156
  v_lshlrev_b32 v157, 16, v157
  v_mfma_f32_16x16x32_bf16 v[16:19], v[180:183], a[144:147], 0
  v_lshlrev_b32 v158, 16, v158
  v_lshlrev_b32 v159, 16, v159
  v_mfma_f32_16x16x32_bf16 v[16:19], v[200:203], a[148:151], v[16:19]
  v_mul_f32 v156, v156, v124
  v_mul_f32 v157, v157, v124
  v_mfma_f32_16x16x32_bf16 v[20:23], v[200:203], a[156:159], 0
  v_mul_f32 v158, v158, v124
  v_mul_f32 v159, v159, v124
  v_mfma_f32_16x16x32_bf16 v[20:23], v[180:183], a[152:155], v[20:23]
  v_cvt_pk_bf16_f32 v156, v156, v156
  v_cvt_pk_bf16_f32 v157, v157, v157
  v_mfma_f32_16x16x32_bf16 v[24:27], v[180:183], a[160:163], 0
  v_cvt_pk_bf16_f32 v158, v158, v158
  v_cvt_pk_bf16_f32 v159, v159, v159
  v_mfma_f32_16x16x32_bf16 v[24:27], v[200:203], a[164:167], v[24:27]
  v_lshlrev_b32 v156, 16, v156
  v_lshlrev_b32 v157, 16, v157
  v_mfma_f32_16x16x32_bf16 v[28:31], v[200:203], a[172:175], 0
  v_lshlrev_b32 v158, 16, v158
  v_lshlrev_b32 v159, 16, v159
  v_mfma_f32_16x16x32_bf16 v[28:31], v[180:183], a[168:171], v[28:31]
  v_add_f32 v90, v90, v156
  v_add_f32 v91, v91, v157
  v_mfma_f32_16x16x32_bf16 v[32:35], v[184:187], a[144:147], 0
  v_add_f32 v92, v92, v158
  v_add_f32 v93, v93, v159
  v_mfma_f32_16x16x32_bf16 v[32:35], v[204:207], a[148:151], v[32:35]
  v_cvt_pk_bf16_f32 v90, v90, v90
  v_cvt_pk_bf16_f32 v91, v91, v91
  v_mfma_f32_16x16x32_bf16 v[36:39], v[204:207], a[156:159], 0
  v_cvt_pk_bf16_f32 v92, v92, v92
  v_cvt_pk_bf16_f32 v93, v93, v93
  v_mfma_f32_16x16x32_bf16 v[36:39], v[184:187], a[152:155], v[36:39]
  v_lshlrev_b32 v90, 16, v90
  v_lshlrev_b32 v91, 16, v91
  v_mfma_f32_16x16x32_bf16 v[40:43], v[184:187], a[160:163], 0
  v_lshlrev_b32 v92, 16, v92
  v_lshlrev_b32 v93, 16, v93
  v_mfma_f32_16x16x32_bf16 v[40:43], v[204:207], a[164:167], v[40:43]
  v_mul_f32 v129, 0xbfb8aa3b, v90
  v_mul_f32 v130, 0xbfb8aa3b, v91
  v_mfma_f32_16x16x32_bf16 v[44:47], v[204:207], a[172:175], 0
  v_mul_f32 v131, 0xbfb8aa3b, v92
  v_mul_f32 v132, 0xbfb8aa3b, v93
  v_mfma_f32_16x16x32_bf16 v[44:47], v[184:187], a[168:171], v[44:47]
  v_exp_f32 v129, v129
  v_mfma_f32_16x16x32_bf16 v[48:51], v[188:191], a[144:147], 0
  v_exp_f32 v130, v130
  v_mfma_f32_16x16x32_bf16 v[48:51], v[208:211], a[148:151], v[48:51]
  v_exp_f32 v131, v131
  v_mfma_f32_16x16x32_bf16 v[52:55], v[208:211], a[156:159], 0
  v_exp_f32 v132, v132
  v_mfma_f32_16x16x32_bf16 v[52:55], v[188:191], a[152:155], v[52:55]
  v_add_f32 v129, 1.0, v129
  v_add_f32 v130, 1.0, v130
  v_mfma_f32_16x16x32_bf16 v[56:59], v[188:191], a[160:163], 0
  v_add_f32 v131, 1.0, v131
  v_add_f32 v132, 1.0, v132
  v_mfma_f32_16x16x32_bf16 v[56:59], v[208:211], a[164:167], v[56:59]
  v_rcp_f32 v129, v129
  v_mfma_f32_16x16x32_bf16 v[60:63], v[208:211], a[172:175], 0
  v_rcp_f32 v130, v130
  v_mfma_f32_16x16x32_bf16 v[60:63], v[188:191], a[168:171], v[60:63]
  v_rcp_f32 v131, v131
  v_mfma_f32_16x16x32_bf16 v[64:67], v[192:195], a[144:147], 0
  v_rcp_f32 v132, v132
  v_mfma_f32_16x16x32_bf16 v[64:67], v[212:215], a[148:151], v[64:67]
  v_mul_f32 v90, v90, v129
  v_mul_f32 v91, v91, v130
  v_mfma_f32_16x16x32_bf16 v[68:71], v[212:215], a[156:159], 0
  v_mul_f32 v92, v92, v131
  v_mul_f32 v93, v93, v132
  v_mfma_f32_16x16x32_bf16 v[68:71], v[192:195], a[152:155], v[68:71]
  v_cvt_pk_bf16_f32 v90, v90, v90
  v_cvt_pk_bf16_f32 v91, v91, v91
  v_mfma_f32_16x16x32_bf16 v[72:75], v[192:195], a[160:163], 0
  v_cvt_pk_bf16_f32 v92, v92, v92
  v_cvt_pk_bf16_f32 v93, v93, v93
  v_mfma_f32_16x16x32_bf16 v[72:75], v[212:215], a[164:167], v[72:75]
  v_lshlrev_b32 v90, 16, v90
  v_lshlrev_b32 v91, 16, v91
  v_mfma_f32_16x16x32_bf16 v[76:79], v[212:215], a[172:175], 0
  v_lshlrev_b32 v92, 16, v92
  v_lshlrev_b32 v93, 16, v93
  v_mfma_f32_16x16x32_bf16 v[76:79], v[192:195], a[168:171], v[76:79]
  v_cvt_pk_bf16_f32 v160, v160, v160
  v_cvt_pk_bf16_f32 v161, v161, v161
  s_waitcnt vmcnt(17)
  v_mfma_f32_16x16x32_bf16 v[0:3], v[216:219], a[176:179], v[0:3]
  buffer_load_dwordx4 a[144:147], v110, s[24:27], s30 offen offset:1024 sc1
  v_mfma_f32_16x16x32_bf16 v[0:3], v[236:239], a[180:183], v[0:3]
  buffer_load_dwordx4 a[148:151], v111, s[24:27], s30 offen offset:0 sc1
  v_mfma_f32_16x16x32_bf16 v[4:7], v[236:239], a[188:191], v[4:7]
  buffer_load_dwordx4 a[152:155], v111, s[24:27], s30 offen offset:1024 sc1
  v_mfma_f32_16x16x32_bf16 v[4:7], v[216:219], a[184:187], v[4:7]
  buffer_load_dwordx4 a[156:159], v112, s[24:27], s30 offen offset:0 sc1
  v_mfma_f32_16x16x32_bf16 v[8:11], v[216:219], a[192:195], v[8:11]
  buffer_load_dwordx4 a[160:163], v112, s[24:27], s30 offen offset:1024 sc1
  v_mfma_f32_16x16x32_bf16 v[8:11], v[236:239], a[196:199], v[8:11]
  buffer_load_dwordx4 a[164:167], v113, s[24:27], s30 offen offset:0 sc1
  v_mfma_f32_16x16x32_bf16 v[12:15], v[236:239], a[204:207], v[12:15]
  v_cvt_pk_bf16_f32 v162, v162, v162
  v_cvt_pk_bf16_f32 v163, v163, v163
  v_mfma_f32_16x16x32_bf16 v[12:15], v[216:219], a[200:203], v[12:15]
  v_lshlrev_b32 v160, 16, v160
  v_lshlrev_b32 v161, 16, v161
  v_mfma_f32_16x16x32_bf16 v[16:19], v[220:223], a[176:179], v[16:19]
  buffer_load_dwordx4 a[168:171], v113, s[24:27], s30 offen offset:1024 sc1
  s_add_u32 s30, s30, 8192
  v_mfma_f32_16x16x32_bf16 v[16:19], v[240:243], a[180:183], v[16:19]
  buffer_load_dwordx4 a[172:175], v110, s[24:27], s30 offen offset:0 sc1
  v_mfma_f32_16x16x32_bf16 v[20:23], v[240:243], a[188:191], v[20:23]
  v_lshlrev_b32 v162, 16, v162
  v_lshlrev_b32 v163, 16, v163
  v_mfma_f32_16x16x32_bf16 v[20:23], v[220:223], a[184:187], v[20:23]
  v_mul_f32 v160, v160, v124
  v_mul_f32 v161, v161, v124
  v_mfma_f32_16x16x32_bf16 v[24:27], v[220:223], a[192:195], v[24:27]
  v_mul_f32 v162, v162, v124
  v_mul_f32 v163, v163, v124
  v_mfma_f32_16x16x32_bf16 v[24:27], v[240:243], a[196:199], v[24:27]
  v_cvt_pk_bf16_f32 v160, v160, v160
  v_cvt_pk_bf16_f32 v161, v161, v161
  v_mfma_f32_16x16x32_bf16 v[28:31], v[240:243], a[204:207], v[28:31]
  v_cvt_pk_bf16_f32 v162, v162, v162
  v_cvt_pk_bf16_f32 v163, v163, v163
  v_mfma_f32_16x16x32_bf16 v[28:31], v[220:223], a[200:203], v[28:31]
  v_lshlrev_b32 v160, 16, v160
  v_lshlrev_b32 v161, 16, v161
  v_mfma_f32_16x16x32_bf16 v[32:35], v[224:227], a[176:179], v[32:35]
  v_lshlrev_b32 v162, 16, v162
  v_lshlrev_b32 v163, 16, v163
  v_mfma_f32_16x16x32_bf16 v[32:35], v[244:247], a[180:183], v[32:35]
  v_add_f32 v94, v94, v160
  v_add_f32 v95, v95, v161
  v_mfma_f32_16x16x32_bf16 v[36:39], v[244:247], a[188:191], v[36:39]
  v_add_f32 v96, v96, v162
  v_add_f32 v97, v97, v163
  v_mfma_f32_16x16x32_bf16 v[36:39], v[224:227], a[184:187], v[36:39]
  v_cvt_pk_bf16_f32 v94, v94, v94
  v_cvt_pk_bf16_f32 v95, v95, v95
  v_mfma_f32_16x16x32_bf16 v[40:43], v[224:227], a[192:195], v[40:43]
  v_cvt_pk_bf16_f32 v96, v96, v96
  v_cvt_pk_bf16_f32 v97, v97, v97
  v_mfma_f32_16x16x32_bf16 v[40:43], v[244:247], a[196:199], v[40:43]
  v_lshlrev_b32 v94, 16, v94
  v_lshlrev_b32 v95, 16, v95
  v_mfma_f32_16x16x32_bf16 v[44:47], v[244:247], a[204:207], v[44:47]
  v_lshlrev_b32 v96, 16, v96
  v_lshlrev_b32 v97, 16, v97
  v_mfma_f32_16x16x32_bf16 v[44:47], v[224:227], a[200:203], v[44:47]
  v_mul_f32 v129, 0xbfb8aa3b, v94
  v_mul_f32 v130, 0xbfb8aa3b, v95
  v_mfma_f32_16x16x32_bf16 v[48:51], v[228:231], a[176:179], v[48:51]
  v_mul_f32 v131, 0xbfb8aa3b, v96
  v_mul_f32 v132, 0xbfb8aa3b, v97
  v_mfma_f32_16x16x32_bf16 v[48:51], v[248:251], a[180:183], v[48:51]
  v_exp_f32 v129, v129
  v_mfma_f32_16x16x32_bf16 v[52:55], v[248:251], a[188:191], v[52:55]
  v_exp_f32 v130, v130
  v_mfma_f32_16x16x32_bf16 v[52:55], v[228:231], a[184:187], v[52:55]
  v_exp_f32 v131, v131
  v_mfma_f32_16x16x32_bf16 v[56:59], v[228:231], a[192:195], v[56:59]
  v_exp_f32 v132, v132
  v_mfma_f32_16x16x32_bf16 v[56:59], v[248:251], a[196:199], v[56:59]
  v_add_f32 v129, 1.0, v129
  v_add_f32 v130, 1.0, v130
  v_mfma_f32_16x16x32_bf16 v[60:63], v[248:251], a[204:207], v[60:63]
  v_add_f32 v131, 1.0, v131
  v_add_f32 v132, 1.0, v132
  v_mfma_f32_16x16x32_bf16 v[60:63], v[228:231], a[200:203], v[60:63]
  v_rcp_f32 v129, v129
  v_mfma_f32_16x16x32_bf16 v[64:67], v[232:235], a[176:179], v[64:67]
  v_rcp_f32 v130, v130
  v_mfma_f32_16x16x32_bf16 v[64:67], v[252:255], a[180:183], v[64:67]
  v_rcp_f32 v131, v131
  v_mfma_f32_16x16x32_bf16 v[68:71], v[252:255], a[188:191], v[68:71]
  v_rcp_f32 v132, v132
  v_mfma_f32_16x16x32_bf16 v[68:71], v[232:235], a[184:187], v[68:71]
  v_mul_f32 v94, v94, v129
  v_mul_f32 v95, v95, v130
  v_mfma_f32_16x16x32_bf16 v[72:75], v[232:235], a[192:195], v[72:75]
  v_mul_f32 v96, v96, v131
  v_mul_f32 v97, v97, v132
  v_mfma_f32_16x16x32_bf16 v[72:75], v[252:255], a[196:199], v[72:75]
  v_cvt_pk_bf16_f32 v94, v94, v94
  v_cvt_pk_bf16_f32 v95, v95, v95
  v_mfma_f32_16x16x32_bf16 v[76:79], v[252:255], a[204:207], v[76:79]
  v_cvt_pk_bf16_f32 v96, v96, v96
  v_cvt_pk_bf16_f32 v97, v97, v97
  v_mfma_f32_16x16x32_bf16 v[76:79], v[232:235], a[200:203], v[76:79]
  v_lshlrev_b32 v94, 16, v94
  v_lshlrev_b32 v95, 16, v95
  s_waitcnt vmcnt(17)
  v_mfma_f32_16x16x32_bf16 v[0:3], a[0:3], a[208:211], v[0:3]
  buffer_load_dwordx4 a[176:179], v110, s[24:27], s30 offen offset:1024 sc1
  v_mfma_f32_16x16x32_bf16 v[0:3], a[20:23], a[212:215], v[0:3]
  buffer_load_dwordx4 a[180:183], v111, s[24:27], s30 offen offset:0 sc1
  v_mfma_f32_16x16x32_bf16 v[4:7], a[20:23], a[220:223], v[4:7]
  buffer_load_dwordx4 a[184:187], v111, s[24:27], s30 offen offset:1024 sc1
  v_mfma_f32_16x16x32_bf16 v[4:7], a[0:3], a[216:219], v[4:7]
  buffer_load_dwordx4 a[188:191], v112, s[24:27], s30 offen offset:0 sc1
  v_mfma_f32_16x16x32_bf16 v[8:11], a[0:3], a[224:227], v[8:11]
  buffer_load_dwordx4 a[192:195], v112, s[24:27], s30 offen offset:1024 sc1
  v_mfma_f32_16x16x32_bf16 v[8:11], a[20:23], a[228:231], v[8:11]
  buffer_load_dwordx4 a[196:199], v113, s[24:27], s30 offen offset:0 sc1
  v_mfma_f32_16x16x32_bf16 v[12:15], a[20:23], a[236:239], v[12:15]
  v_lshlrev_b32 v96, 16, v96
  v_lshlrev_b32 v97, 16, v97
  v_mfma_f32_16x16x32_bf16 v[12:15], a[0:3], a[232:235], v[12:15]
  v_cvt_pk_bf16_f32 v164, v164, v164
  v_cvt_pk_bf16_f32 v165, v165, v165
  v_mfma_f32_16x16x32_bf16 v[16:19], a[4:7], a[208:211], v[16:19]
  buffer_load_dwordx4 a[200:203], v113, s[24:27], s30 offen offset:1024 sc1
  s_add_u32 s30, s30, 8192
  v_mfma_f32_16x16x32_bf16 v[16:19], a[24:27], a[212:215], v[16:19]
  buffer_load_dwordx4 a[204:207], v110, s[24:27], s30 offen offset:0 sc1
  v_mfma_f32_16x16x32_bf16 v[20:23], a[24:27], a[220:223], v[20:23]
  v_cvt_pk_bf16_f32 v166, v166, v166
  v_cvt_pk_bf16_f32 v167, v167, v167
  v_mfma_f32_16x16x32_bf16 v[20:23], a[4:7], a[216:219], v[20:23]
  v_lshlrev_b32 v164, 16, v164
  v_lshlrev_b32 v165, 16, v165
  v_mfma_f32_16x16x32_bf16 v[24:27], a[4:7], a[224:227], v[24:27]
  v_lshlrev_b32 v166, 16, v166
  v_lshlrev_b32 v167, 16, v167
  v_mfma_f32_16x16x32_bf16 v[24:27], a[24:27], a[228:231], v[24:27]
  v_mul_f32 v164, v164, v124
  v_mul_f32 v165, v165, v124
  v_mfma_f32_16x16x32_bf16 v[28:31], a[24:27], a[236:239], v[28:31]
  v_mul_f32 v166, v166, v124
  v_mul_f32 v167, v167, v124
  v_mfma_f32_16x16x32_bf16 v[28:31], a[4:7], a[232:235], v[28:31]
  v_cvt_pk_bf16_f32 v164, v164, v164
  v_cvt_pk_bf16_f32 v165, v165, v165
  v_mfma_f32_16x16x32_bf16 v[32:35], a[8:11], a[208:211], v[32:35]
  v_cvt_pk_bf16_f32 v166, v166, v166
  v_cvt_pk_bf16_f32 v167, v167, v167
  v_mfma_f32_16x16x32_bf16 v[32:35], a[28:31], a[212:215], v[32:35]
  v_lshlrev_b32 v164, 16, v164
  v_lshlrev_b32 v165, 16, v165
  v_mfma_f32_16x16x32_bf16 v[36:39], a[28:31], a[220:223], v[36:39]
  v_lshlrev_b32 v166, 16, v166
  v_lshlrev_b32 v167, 16, v167
  v_mfma_f32_16x16x32_bf16 v[36:39], a[8:11], a[216:219], v[36:39]
  v_add_f32 v98, v98, v164
  v_add_f32 v99, v99, v165
  v_mfma_f32_16x16x32_bf16 v[40:43], a[8:11], a[224:227], v[40:43]
  v_add_f32 v100, v100, v166
  v_add_f32 v101, v101, v167
  v_mfma_f32_16x16x32_bf16 v[40:43], a[28:31], a[228:231], v[40:43]
  v_cvt_pk_bf16_f32 v98, v98, v98
  v_cvt_pk_bf16_f32 v99, v99, v99
  v_mfma_f32_16x16x32_bf16 v[44:47], a[28:31], a[236:239], v[44:47]
  v_cvt_pk_bf16_f32 v100, v100, v100
  v_cvt_pk_bf16_f32 v101, v101, v101
  v_mfma_f32_16x16x32_bf16 v[44:47], a[8:11], a[232:235], v[44:47]
  v_lshlrev_b32 v98, 16, v98
  v_lshlrev_b32 v99, 16, v99
  v_mfma_f32_16x16x32_bf16 v[48:51], a[12:15], a[208:211], v[48:51]
  v_lshlrev_b32 v100, 16, v100
  v_lshlrev_b32 v101, 16, v101
  v_mfma_f32_16x16x32_bf16 v[48:51], a[32:35], a[212:215], v[48:51]
  v_mul_f32 v129, 0xbfb8aa3b, v98
  v_mul_f32 v130, 0xbfb8aa3b, v99
  v_mfma_f32_16x16x32_bf16 v[52:55], a[32:35], a[220:223], v[52:55]
  v_mul_f32 v131, 0xbfb8aa3b, v100
  v_mul_f32 v132, 0xbfb8aa3b, v101
  v_mfma_f32_16x16x32_bf16 v[52:55], a[12:15], a[216:219], v[52:55]
  v_exp_f32 v129, v129
  v_mfma_f32_16x16x32_bf16 v[56:59], a[12:15], a[224:227], v[56:59]
  v_exp_f32 v130, v130
  v_mfma_f32_16x16x32_bf16 v[56:59], a[32:35], a[228:231], v[56:59]
  v_exp_f32 v131, v131
  v_mfma_f32_16x16x32_bf16 v[60:63], a[32:35], a[236:239], v[60:63]
  v_exp_f32 v132, v132
  v_mfma_f32_16x16x32_bf16 v[60:63], a[12:15], a[232:235], v[60:63]
  v_add_f32 v129, 1.0, v129
  v_add_f32 v130, 1.0, v130
  v_mfma_f32_16x16x32_bf16 v[64:67], a[16:19], a[208:211], v[64:67]
  v_add_f32 v131, 1.0, v131
  v_add_f32 v132, 1.0, v132
  v_mfma_f32_16x16x32_bf16 v[64:67], a[36:39], a[212:215], v[64:67]
  v_rcp_f32 v129, v129
  v_mfma_f32_16x16x32_bf16 v[68:71], a[36:39], a[220:223], v[68:71]
  v_rcp_f32 v130, v130
  v_mfma_f32_16x16x32_bf16 v[68:71], a[16:19], a[216:219], v[68:71]
  v_rcp_f32 v131, v131
  v_mfma_f32_16x16x32_bf16 v[72:75], a[16:19], a[224:227], v[72:75]
  v_rcp_f32 v132, v132
  v_mfma_f32_16x16x32_bf16 v[72:75], a[36:39], a[228:231], v[72:75]
  v_mul_f32 v98, v98, v129
  v_mul_f32 v99, v99, v130
  v_mfma_f32_16x16x32_bf16 v[76:79], a[36:39], a[236:239], v[76:79]
  v_mul_f32 v100, v100, v131
  v_mul_f32 v101, v101, v132
  v_mfma_f32_16x16x32_bf16 v[76:79], a[16:19], a[232:235], v[76:79]
  v_cvt_pk_bf16_f32 v98, v98, v98
  v_cvt_pk_bf16_f32 v99, v99, v99
  s_waitcnt vmcnt(17)
  v_mfma_f32_16x16x32_bf16 v[0:3], a[40:43], a[240:243], v[0:3]
  buffer_load_dwordx4 a[208:211], v110, s[24:27], s30 offen offset:1024 sc1
  v_mfma_f32_16x16x32_bf16 v[0:3], a[60:63], a[244:247], v[0:3]
  buffer_load_dwordx4 a[212:215], v111, s[24:27], s30 offen offset:0 sc1
  v_mfma_f32_16x16x32_bf16 v[4:7], a[60:63], a[252:255], v[4:7]
  buffer_load_dwordx4 a[216:219], v111, s[24:27], s30 offen offset:1024 sc1
  v_mfma_f32_16x16x32_bf16 v[4:7], a[40:43], a[248:251], v[4:7]
  buffer_load_dwordx4 a[220:223], v112, s[24:27], s30 offen offset:0 sc1
  v_mfma_f32_16x16x32_bf16 v[8:11], a[40:43], v[136:139], v[8:11]
  buffer_load_dwordx4 a[224:227], v112, s[24:27], s30 offen offset:1024 sc1
  v_mfma_f32_16x16x32_bf16 v[8:11], a[60:63], v[140:143], v[8:11]
  buffer_load_dwordx4 a[228:231], v113, s[24:27], s30 offen offset:0 sc1
  v_mfma_f32_16x16x32_bf16 v[12:15], a[60:63], v[148:151], v[12:15]
  v_cvt_pk_bf16_f32 v100, v100, v100
  v_cvt_pk_bf16_f32 v101, v101, v101
  v_mfma_f32_16x16x32_bf16 v[12:15], a[40:43], v[144:147], v[12:15]
  v_lshlrev_b32 v98, 16, v98
  v_lshlrev_b32 v99, 16, v99
  v_mfma_f32_16x16x32_bf16 v[16:19], a[44:47], a[240:243], v[16:19]
  buffer_load_dwordx4 a[232:235], v113, s[24:27], s30 offen offset:1024 sc1
  s_add_u32 s30, s30, 8192
  v_mfma_f32_16x16x32_bf16 v[16:19], a[64:67], a[244:247], v[16:19]
  buffer_load_dwordx4 a[236:239], v110, s[24:27], s30 offen offset:0 sc1
  v_mfma_f32_16x16x32_bf16 v[20:23], a[64:67], a[252:255], v[20:23]
  v_lshlrev_b32 v100, 16, v100
  v_lshlrev_b32 v101, 16, v101
  v_mfma_f32_16x16x32_bf16 v[20:23], a[44:47], a[248:251], v[20:23]
  v_cvt_pk_bf16_f32 v168, v168, v168
  v_cvt_pk_bf16_f32 v169, v169, v169
  v_mfma_f32_16x16x32_bf16 v[24:27], a[44:47], v[136:139], v[24:27]
  v_cvt_pk_bf16_f32 v170, v170, v170
  v_cvt_pk_bf16_f32 v171, v171, v171
  v_mfma_f32_16x16x32_bf16 v[24:27], a[64:67], v[140:143], v[24:27]
  v_lshlrev_b32 v168, 16, v168
  v_lshlrev_b32 v169, 16, v169
  v_mfma_f32_16x16x32_bf16 v[28:31], a[64:67], v[148:151], v[28:31]
  v_lshlrev_b32 v170, 16, v170
  v_lshlrev_b32 v171, 16, v171
  v_mfma_f32_16x16x32_bf16 v[28:31], a[44:47], v[144:147], v[28:31]
  v_mul_f32 v168, v168, v124
  v_mul_f32 v169, v169, v124
  v_mfma_f32_16x16x32_bf16 v[32:35], a[48:51], a[240:243], v[32:35]
  v_mul_f32 v170, v170, v124
  v_mul_f32 v171, v171, v124
  v_mfma_f32_16x16x32_bf16 v[32:35], a[68:71], a[244:247], v[32:35]
  v_cvt_pk_bf16_f32 v168, v168, v168
  v_cvt_pk_bf16_f32 v169, v169, v169
  v_mfma_f32_16x16x32_bf16 v[36:39], a[68:71], a[252:255], v[36:39]
  v_cvt_pk_bf16_f32 v170, v170, v170
  v_cvt_pk_bf16_f32 v171, v171, v171
  v_mfma_f32_16x16x32_bf16 v[36:39], a[48:51], a[248:251], v[36:39]
  v_lshlrev_b32 v168, 16, v168
  v_lshlrev_b32 v169, 16, v169
  v_mfma_f32_16x16x32_bf16 v[40:43], a[48:51], v[136:139], v[40:43]
  v_lshlrev_b32 v170, 16, v170
  v_lshlrev_b32 v171, 16, v171
  v_mfma_f32_16x16x32_bf16 v[40:43], a[68:71], v[140:143], v[40:43]
  v_add_f32 v102, v102, v168
  v_add_f32 v103, v103, v169
  v_mfma_f32_16x16x32_bf16 v[44:47], a[68:71], v[148:151], v[44:47]
  v_add_f32 v104, v104, v170
  v_add_f32 v105, v105, v171
  v_mfma_f32_16x16x32_bf16 v[44:47], a[48:51], v[144:147], v[44:47]
  v_cvt_pk_bf16_f32 v102, v102, v102
  v_cvt_pk_bf16_f32 v103, v103, v103
  v_mfma_f32_16x16x32_bf16 v[48:51], a[52:55], a[240:243], v[48:51]
  v_cvt_pk_bf16_f32 v104, v104, v104
  v_cvt_pk_bf16_f32 v105, v105, v105
  v_mfma_f32_16x16x32_bf16 v[48:51], a[72:75], a[244:247], v[48:51]
  v_lshlrev_b32 v102, 16, v102
  v_lshlrev_b32 v103, 16, v103
  v_mfma_f32_16x16x32_bf16 v[52:55], a[72:75], a[252:255], v[52:55]
  v_lshlrev_b32 v104, 16, v104
  v_lshlrev_b32 v105, 16, v105
  v_mfma_f32_16x16x32_bf16 v[52:55], a[52:55], a[248:251], v[52:55]
  v_mul_f32 v129, 0xbfb8aa3b, v102
  v_mul_f32 v130, 0xbfb8aa3b, v103
  v_mfma_f32_16x16x32_bf16 v[56:59], a[52:55], v[136:139], v[56:59]
  v_mul_f32 v131, 0xbfb8aa3b, v104
  v_mul_f32 v132, 0xbfb8aa3b, v105
  v_mfma_f32_16x16x32_bf16 v[56:59], a[72:75], v[140:143], v[56:59]
  v_exp_f32 v129, v129
  v_mfma_f32_16x16x32_bf16 v[60:63], a[72:75], v[148:151], v[60:63]
  v_exp_f32 v130, v130
  v_mfma_f32_16x16x32_bf16 v[60:63], a[52:55], v[144:147], v[60:63]
  v_exp_f32 v131, v131
  v_mfma_f32_16x16x32_bf16 v[64:67], a[56:59], a[240:243], v[64:67]
  v_exp_f32 v132, v132
  v_mfma_f32_16x16x32_bf16 v[64:67], a[76:79], a[244:247], v[64:67]
  v_add_f32 v129, 1.0, v129
  v_add_f32 v130, 1.0, v130
  v_mfma_f32_16x16x32_bf16 v[68:71], a[76:79], a[252:255], v[68:71]
  v_add_f32 v131, 1.0, v131
  v_add_f32 v132, 1.0, v132
  v_mfma_f32_16x16x32_bf16 v[68:71], a[56:59], a[248:251], v[68:71]
  v_rcp_f32 v129, v129
  v_mfma_f32_16x16x32_bf16 v[72:75], a[56:59], v[136:139], v[72:75]
  v_rcp_f32 v130, v130
  v_mfma_f32_16x16x32_bf16 v[72:75], a[76:79], v[140:143], v[72:75]
  v_rcp_f32 v131, v131
  v_mfma_f32_16x16x32_bf16 v[76:79], a[76:79], v[148:151], v[76:79]
  v_rcp_f32 v132, v132
  v_mfma_f32_16x16x32_bf16 v[76:79], a[56:59], v[144:147], v[76:79]
  v_mul_f32 v102, v102, v129
  v_mul_f32 v103, v103, v130
  s_waitcnt vmcnt(17)
  v_mfma_f32_16x16x32_bf16 v[0:3], a[80:83], v[152:155], v[0:3]
  buffer_load_dwordx4 a[240:243], v110, s[24:27], s30 offen offset:1024 sc1
  v_mfma_f32_16x16x32_bf16 v[0:3], a[100:103], a[144:147], v[0:3]
  buffer_load_dwordx4 a[244:247], v111, s[24:27], s30 offen offset:0 sc1
  v_mfma_f32_16x16x32_bf16 v[4:7], a[100:103], a[152:155], v[4:7]
  buffer_load_dwordx4 a[248:251], v111, s[24:27], s30 offen offset:1024 sc1
  v_mfma_f32_16x16x32_bf16 v[4:7], a[80:83], a[148:151], v[4:7]
  buffer_load_dwordx4 a[252:255], v112, s[24:27], s30 offen offset:0 sc1
  v_mfma_f32_16x16x32_bf16 v[8:11], a[80:83], a[156:159], v[8:11]
  buffer_load_dwordx4 v[136:139], v112, s[24:27], s30 offen offset:1024 sc1
  v_mfma_f32_16x16x32_bf16 v[8:11], a[100:103], a[160:163], v[8:11]
  buffer_load_dwordx4 v[140:143], v113, s[24:27], s30 offen offset:0 sc1
  v_mfma_f32_16x16x32_bf16 v[12:15], a[100:103], a[168:171], v[12:15]
  v_mul_f32 v104, v104, v131
  v_mul_f32 v105, v105, v132
  v_mfma_f32_16x16x32_bf16 v[12:15], a[80:83], a[164:167], v[12:15]
  v_cvt_pk_bf16_f32 v102, v102, v102
  v_cvt_pk_bf16_f32 v103, v103, v103
  v_mfma_f32_16x16x32_bf16 v[16:19], a[84:87], v[152:155], v[16:19]
  v_cvt_pk_bf16_f32 v104, v104, v104
  v_cvt_pk_bf16_f32 v105, v105, v105
  v_mfma_f32_16x16x32_bf16 v[16:19], a[104:107], a[144:147], v[16:19]
  v_lshlrev_b32 v102, 16, v102
  v_lshlrev_b32 v103, 16, v103
  v_mfma_f32_16x16x32_bf16 v[20:23], a[104:107], a[152:155], v[20:23]
  v_lshlrev_b32 v104, 16, v104
  v_lshlrev_b32 v105, 16, v105
  v_mfma_f32_16x16x32_bf16 v[20:23], a[84:87], a[148:151], v[20:23]
  v_cvt_pk_bf16_f32 v172, v172, v172
  v_cvt_pk_bf16_f32 v173, v173, v173
  v_mfma_f32_16x16x32_bf16 v[24:27], a[84:87], a[156:159], v[24:27]
  v_cvt_pk_bf16_f32 v174, v174, v174
  v_cvt_pk_bf16_f32 v175, v175, v175
  v_mfma_f32_16x16x32_bf16 v[24:27], a[104:107], a[160:163], v[24:27]
  v_lshlrev_b32 v172, 16, v172
  v_lshlrev_b32 v173, 16, v173
  v_mfma_f32_16x16x32_bf16 v[28:31], a[104:107], a[168:171], v[28:31]
  v_lshlrev_b32 v174, 16, v174
  v_lshlrev_b32 v175, 16, v175
  v_mfma_f32_16x16x32_bf16 v[28:31], a[84:87], a[164:167], v[28:31]
  v_mul_f32 v172, v172, v124
  v_mul_f32 v173, v173, v124
  v_mfma_f32_16x16x32_bf16 v[32:35], a[88:91], v[152:155], v[32:35]
  v_mul_f32 v174, v174, v124
  v_mul_f32 v175, v175, v124
  v_mfma_f32_16x16x32_bf16 v[32:35], a[108:111], a[144:147], v[32:35]
  v_cvt_pk_bf16_f32 v172, v172, v172
  v_cvt_pk_bf16_f32 v173, v173, v173
  v_mfma_f32_16x16x32_bf16 v[36:39], a[108:111], a[152:155], v[36:39]
  v_cvt_pk_bf16_f32 v174, v174, v174
  v_cvt_pk_bf16_f32 v175, v175, v175
  v_mfma_f32_16x16x32_bf16 v[36:39], a[88:91], a[148:151], v[36:39]
  v_lshlrev_b32 v172, 16, v172
  v_lshlrev_b32 v173, 16, v173
  v_mfma_f32_16x16x32_bf16 v[40:43], a[88:91], a[156:159], v[40:43]
  v_lshlrev_b32 v174, 16, v174
  v_lshlrev_b32 v175, 16, v175
  v_mfma_f32_16x16x32_bf16 v[40:43], a[108:111], a[160:163], v[40:43]
  v_add_f32 v106, v106, v172
  v_add_f32 v107, v107, v173
  v_mfma_f32_16x16x32_bf16 v[44:47], a[108:111], a[168:171], v[44:47]
  v_add_f32 v108, v108, v174
  v_add_f32 v109, v109, v175
  v_mfma_f32_16x16x32_bf16 v[44:47], a[88:91], a[164:167], v[44:47]
  v_cvt_pk_bf16_f32 v106, v106, v106
  v_cvt_pk_bf16_f32 v107, v107, v107
  v_mfma_f32_16x16x32_bf16 v[48:51], a[92:95], v[152:155], v[48:51]
  v_cvt_pk_bf16_f32 v108, v108, v108
  v_cvt_pk_bf16_f32 v109, v109, v109
  v_mfma_f32_16x16x32_bf16 v[48:51], a[112:115], a[144:147], v[48:51]
  v_lshlrev_b32 v106, 16, v106
  v_lshlrev_b32 v107, 16, v107
  v_mfma_f32_16x16x32_bf16 v[52:55], a[112:115], a[152:155], v[52:55]
  v_lshlrev_b32 v108, 16, v108
  v_lshlrev_b32 v109, 16, v109
  v_mfma_f32_16x16x32_bf16 v[52:55], a[92:95], a[148:151], v[52:55]
  v_mul_f32 v129, 0xbfb8aa3b, v106
  v_mul_f32 v130, 0xbfb8aa3b, v107
  v_mfma_f32_16x16x32_bf16 v[56:59], a[92:95], a[156:159], v[56:59]
  v_mul_f32 v131, 0xbfb8aa3b, v108
  v_mul_f32 v132, 0xbfb8aa3b, v109
  v_mfma_f32_16x16x32_bf16 v[56:59], a[112:115], a[160:163], v[56:59]
  v_exp_f32 v129, v129
  v_mfma_f32_16x16x32_bf16 v[60:63], a[112:115], a[168:171], v[60:63]
  v_exp_f32 v130, v130
  v_mfma_f32_16x16x32_bf16 v[60:63], a[92:95], a[164:167], v[60:63]
  v_exp_f32 v131, v131
  v_mfma_f32_16x16x32_bf16 v[64:67], a[96:99], v[152:155], v[64:67]
  v_exp_f32 v132, v132
  v_mfma_f32_16x16x32_bf16 v[64:67], a[116:119], a[144:147], v[64:67]
  v_add_f32 v129, 1.0, v129
  v_add_f32 v130, 1.0, v130
  v_mfma_f32_16x16x32_bf16 v[68:71], a[116:119], a[152:155], v[68:71]
  v_add_f32 v131, 1.0, v131
  v_add_f32 v132, 1.0, v132
  v_mfma_f32_16x16x32_bf16 v[68:71], a[96:99], a[148:151], v[68:71]
  v_rcp_f32 v129, v129
  v_mfma_f32_16x16x32_bf16 v[72:75], a[96:99], a[156:159], v[72:75]
  v_rcp_f32 v130, v130
  v_mfma_f32_16x16x32_bf16 v[72:75], a[116:119], a[160:163], v[72:75]
  v_rcp_f32 v131, v131
  v_mfma_f32_16x16x32_bf16 v[76:79], a[116:119], a[168:171], v[76:79]
  v_rcp_f32 v132, v132
  v_mfma_f32_16x16x32_bf16 v[76:79], a[96:99], a[164:167], v[76:79]
  v_mul_f32 v106, v106, v129
  v_mul_f32 v107, v107, v130
  s_waitcnt vmcnt(15)
  v_mfma_f32_16x16x32_bf16 v[0:3], a[120:123], a[172:175], v[0:3]
  ds_read_b128 v[144:147], v122 offset:0
  v_mul_f32 v108, v108, v131
  v_mfma_f32_16x16x32_bf16 v[0:3], a[140:143], a[176:179], v[0:3]
  buffer_load_dwordx4 v[148:151], v113, s[24:27], s30 offen offset:1024 sc1
  s_mov_b32 s30, s37
  v_mfma_f32_16x16x32_bf16 v[4:7], a[140:143], a[184:187], v[4:7]
  buffer_load_dwordx4 v[152:155], v110, s[24:27], s30 offen offset:0 sc1
  v_mfma_f32_16x16x32_bf16 v[4:7], a[120:123], a[180:183], v[4:7]
  buffer_load_dwordx4 a[144:147], v110, s[24:27], s30 offen offset:1024 sc1
  v_mfma_f32_16x16x32_bf16 v[8:11], a[120:123], a[188:191], v[8:11]
  buffer_load_dwordx4 a[148:151], v111, s[24:27], s30 offen offset:0 sc1
  v_mfma_f32_16x16x32_bf16 v[8:11], a[140:143], a[192:195], v[8:11]
  buffer_load_dwordx4 a[152:155], v111, s[24:27], s30 offen offset:1024 sc1
  v_mfma_f32_16x16x32_bf16 v[12:15], a[140:143], a[200:203], v[12:15]
  buffer_load_dwordx4 a[156:159], v112, s[24:27], s30 offen offset:0 sc1
  v_mfma_f32_16x16x32_bf16 v[12:15], a[120:123], a[196:199], v[12:15]
  v_mul_f32 v109, v109, v132
  v_cvt_pk_bf16_f32 v106, v106, v106
  s_waitcnt lgkmcnt(0)
  v_mfma_f32_16x16x32_bf16 v[16:19], a[124:127], a[172:175], v[16:19]
  ds_read_b128 a[160:163], v122 offset:1024
  v_cvt_pk_bf16_f32 v107, v107, v107
  v_mfma_f32_16x16x32_bf16 v[16:19], v[144:147], a[176:179], v[16:19]
  v_cvt_pk_bf16_f32 v108, v108, v108
  v_cvt_pk_bf16_f32 v109, v109, v109
  v_mfma_f32_16x16x32_bf16 v[20:23], v[144:147], a[184:187], v[20:23]
  v_lshlrev_b32 v106, 16, v106
  v_lshlrev_b32 v107, 16, v107
  v_mfma_f32_16x16x32_bf16 v[20:23], a[124:127], a[180:183], v[20:23]
  v_lshlrev_b32 v108, 16, v108
  v_lshlrev_b32 v109, 16, v109
  v_mfma_f32_16x16x32_bf16 v[24:27], a[124:127], a[188:191], v[24:27]
  v_lshlrev_b32 v156, 16, v80
  v_and_b32 v157, s34, v80
  v_mfma_f32_16x16x32_bf16 v[24:27], v[144:147], a[192:195], v[24:27]
  v_lshlrev_b32 v158, 16, v81
  v_and_b32 v159, s34, v81
  v_mfma_f32_16x16x32_bf16 v[28:31], v[144:147], a[200:203], v[28:31]
  v_lshlrev_b32 v160, 16, v82
  v_and_b32 v161, s34, v82
  v_mfma_f32_16x16x32_bf16 v[28:31], a[124:127], a[196:199], v[28:31]
  v_lshlrev_b32 v162, 16, v83
  v_and_b32 v163, s34, v83
  s_waitcnt lgkmcnt(0)
  v_mfma_f32_16x16x32_bf16 v[32:35], a[128:131], a[172:175], v[32:35]
  ds_read_b128 a[164:167], v122 offset:2048
  v_lshlrev_b32 v164, 16, v84
  v_mfma_f32_16x16x32_bf16 v[32:35], a[160:163], a[176:179], v[32:35]
  v_and_b32 v165, s34, v84
  v_lshlrev_b32 v166, 16, v85
  v_mfma_f32_16x16x32_bf16 v[36:39], a[160:163], a[184:187], v[36:39]
  v_and_b32 v167, s34, v85
  v_lshlrev_b32 v168, 16, v86
  v_mfma_f32_16x16x32_bf16 v[36:39], a[128:131], a[180:183], v[36:39]
  v_and_b32 v169, s34, v86
  v_lshlrev_b32 v170, 16, v87
  v_mfma_f32_16x16x32_bf16 v[40:43], a[128:131], a[188:191], v[40:43]
  v_and_b32 v171, s34, v87
  v_lshlrev_b32 v172, 16, v88
  v_mfma_f32_16x16x32_bf16 v[40:43], a[160:163], a[192:195], v[40:43]
  v_and_b32 v173, s34, v88
  v_lshlrev_b32 v174, 16, v89
  v_mfma_f32_16x16x32_bf16 v[44:47], a[160:163], a[200:203], v[44:47]
  v_and_b32 v175, s34, v89
  v_mfma_f32_16x16x32_bf16 v[44:47], a[128:131], a[196:199], v[44:47]
  s_waitcnt lgkmcnt(0)
  v_mfma_f32_16x16x32_bf16 v[48:51], a[132:135], a[172:175], v[48:51]
  ds_read_b128 a[168:171], v122 offset:3072
  v_mfma_f32_16x16x32_bf16 v[48:51], a[164:167], a[176:179], v[48:51]
  v_mfma_f32_16x16x32_bf16 v[52:55], a[164:167], a[184:187], v[52:55]
  v_mfma_f32_16x16x32_bf16 v[52:55], a[132:135], a[180:183], v[52:55]
  v_mfma_f32_16x16x32_bf16 v[56:59], a[132:135], a[188:191], v[56:59]
  v_mfma_f32_16x16x32_bf16 v[56:59], a[164:167], a[192:195], v[56:59]
  v_mfma_f32_16x16x32_bf16 v[60:63], a[164:167], a[200:203], v[60:63]
  v_mfma_f32_16x16x32_bf16 v[60:63], a[132:135], a[196:199], v[60:63]
  s_waitcnt lgkmcnt(0)
  v_mfma_f32_16x16x32_bf16 v[64:67], a[136:139], a[172:175], v[64:67]
  ds_read_b128 v[144:147], v122 offset:4096
  ds_read_b128 a[160:163], v122 offset:9216
  v_mfma_f32_16x16x32_bf16 v[64:67], a[168:171], a[176:179], v[64:67]
  v_mfma_f32_16x16x32_bf16 v[68:71], a[168:171], a[184:187], v[68:71]
  v_mfma_f32_16x16x32_bf16 v[68:71], a[136:139], a[180:183], v[68:71]
  v_mfma_f32_16x16x32_bf16 v[72:75], a[136:139], a[188:191], v[72:75]
  v_mfma_f32_16x16x32_bf16 v[72:75], a[168:171], a[192:195], v[72:75]
  v_mfma_f32_16x16x32_bf16 v[76:79], a[168:171], a[200:203], v[76:79]
  v_mfma_f32_16x16x32_bf16 v[76:79], a[136:139], a[196:199], v[76:79]
  s_waitcnt vmcnt(13) lgkmcnt(0)
  v_mfma_f32_16x16x32_bf16 v[0:3], v[144:147], a[204:207], v[0:3]
  ds_read_b128 a[164:167], v122 offset:5120
  ds_read_b128 a[168:171], v122 offset:10240
  v_mfma_f32_16x16x32_bf16 v[0:3], a[160:163], a[208:211], v[0:3]
  buffer_load_dwordx4 a[172:175], v112, s[24:27], s30 offen offset:1024 sc1
  v_mfma_f32_16x16x32_bf16 v[4:7], a[160:163], a[216:219], v[4:7]
  buffer_load_dwordx4 a[176:179], v113, s[24:27], s30 offen offset:0 sc1
  v_mfma_f32_16x16x32_bf16 v[4:7], v[144:147], a[212:215], v[4:7]
  buffer_load_dwordx4 a[180:183], v113, s[24:27], s30 offen offset:1024 sc1
  s_add_u32 s30, s30, 8192
  v_mfma_f32_16x16x32_bf16 v[8:11], v[144:147], a[220:223], v[8:11]
  buffer_load_dwordx4 a[184:187], v110, s[24:27], s30 offen offset:0 sc1
  v_mfma_f32_16x16x32_bf16 v[8:11], a[160:163], a[224:227], v[8:11]
  buffer_load_dwordx4 a[188:191], v110, s[24:27], s30 offen offset:1024 sc1
  v_mfma_f32_16x16x32_bf16 v[12:15], a[160:163], a[232:235], v[12:15]
  buffer_load_dwordx4 a[192:195], v111, s[24:27], s30 offen offset:0 sc1
  v_mfma_f32_16x16x32_bf16 v[12:15], v[144:147], a[228:231], v[12:15]
  s_waitcnt lgkmcnt(0)
  v_mfma_f32_16x16x32_bf16 v[16:19], a[164:167], a[204:207], v[16:19]
  ds_read_b128 a[196:199], v122 offset:6144
  ds_read_b128 a[200:203], v122 offset:11264
  v_mfma_f32_16x16x32_bf16 v[16:19], a[168:171], a[208:211], v[16:19]
  v_mfma_f32_16x16x32_bf16 v[20:23], a[168:171], a[216:219], v[20:23]
  v_mfma_f32_16x16x32_bf16 v[20:23], a[164:167], a[212:215], v[20:23]
  v_mfma_f32_16x16x32_bf16 v[24:27], a[164:167], a[220:223], v[24:27]
  v_mfma_f32_16x16x32_bf16 v[24:27], a[168:171], a[224:227], v[24:27]
  v_mfma_f32_16x16x32_bf16 v[28:31], a[168:171], a[232:235], v[28:31]
  v_mfma_f32_16x16x32_bf16 v[28:31], a[164:167], a[228:231], v[28:31]
  s_waitcnt lgkmcnt(0)
  v_mfma_f32_16x16x32_bf16 v[32:35], a[196:199], a[204:207], v[32:35]
  ds_read_b128 v[144:147], v122 offset:7168
  ds_read_b128 a[160:163], v122 offset:12288
  v_mfma_f32_16x16x32_bf16 v[32:35], a[200:203], a[208:211], v[32:35]
  v_mfma_f32_16x16x32_bf16 v[36:39], a[200:203], a[216:219], v[36:39]
  v_mfma_f32_16x16x32_bf16 v[36:39], a[196:199], a[212:215], v[36:39]
  v_mfma_f32_16x16x32_bf16 v[40:43], a[196:199], a[220:223], v[40:43]
  v_mfma_f32_16x16x32_bf16 v[40:43], a[200:203], a[224:227], v[40:43]
  v_mfma_f32_16x16x32_bf16 v[44:47], a[200:203], a[232:235], v[44:47]
  v_mfma_f32_16x16x32_bf16 v[44:47], a[196:199], a[228:231], v[44:47]
  s_waitcnt lgkmcnt(0)
  v_mfma_f32_16x16x32_bf16 v[48:51], v[144:147], a[204:207], v[48:51]
  ds_read_b128 a[164:167], v122 offset:8192
  ds_read_b128 a[168:171], v122 offset:13312
  v_mfma_f32_16x16x32_bf16 v[48:51], a[160:163], a[208:211], v[48:51]
  v_mfma_f32_16x16x32_bf16 v[52:55], a[160:163], a[216:219], v[52:55]
  v_mfma_f32_16x16x32_bf16 v[52:55], v[144:147], a[212:215], v[52:55]
  v_mfma_f32_16x16x32_bf16 v[56:59], v[144:147], a[220:223], v[56:59]
  v_mfma_f32_16x16x32_bf16 v[56:59], a[160:163], a[224:227], v[56:59]
  v_mfma_f32_16x16x32_bf16 v[60:63], a[160:163], a[232:235], v[60:63]
  v_mfma_f32_16x16x32_bf16 v[60:63], v[144:147], a[228:231], v[60:63]
  s_waitcnt lgkmcnt(0)
  v_mfma_f32_16x16x32_bf16 v[64:67], a[164:167], a[204:207], v[64:67]
  ds_read_b128 a[196:199], v122 offset:14336
  ds_read_b128 a[200:203], v122 offset:19456
  v_mfma_f32_16x16x32_bf16 v[64:67], a[168:171], a[208:211], v[64:67]
  v_mfma_f32_16x16x32_bf16 v[68:71], a[168:171], a[216:219], v[68:71]
  v_mfma_f32_16x16x32_bf16 v[68:71], a[164:167], a[212:215], v[68:71]
  v_mfma_f32_16x16x32_bf16 v[72:75], a[164:167], a[220:223], v[72:75]
  v_mfma_f32_16x16x32_bf16 v[72:75], a[168:171], a[224:227], v[72:75]
  v_mfma_f32_16x16x32_bf16 v[76:79], a[168:171], a[232:235], v[76:79]
  v_mfma_f32_16x16x32_bf16 v[76:79], a[164:167], a[228:231], v[76:79]
  s_waitcnt vmcnt(11) lgkmcnt(0)
  v_mfma_f32_16x16x32_bf16 v[0:3], a[196:199], a[236:239], v[0:3]
  ds_read_b128 v[144:147], v122 offset:15360
  ds_read_b128 a[160:163], v122 offset:20480
  v_mfma_f32_16x16x32_bf16 v[0:3], a[200:203], a[240:243], v[0:3]
  buffer_load_dwordx4 a[164:167], v111, s[24:27], s30 offen offset:1024 sc1
  v_mfma_f32_16x16x32_bf16 v[4:7], a[200:203], a[248:251], v[4:7]
  buffer_load_dwordx4 a[168:171], v112, s[24:27], s30 offen offset:0 sc1
  v_mfma_f32_16x16x32_bf16 v[4:7], a[196:199], a[244:247], v[4:7]
  buffer_load_dwordx4 a[204:207], v112, s[24:27], s30 offen offset:1024 sc1
  v_mfma_f32_16x16x32_bf16 v[8:11], a[196:199], a[252:255], v[8:11]
  buffer_load_dwordx4 a[208:211], v113, s[24:27], s30 offen offset:0 sc1
  v_mfma_f32_16x16x32_bf16 v[8:11], a[200:203], v[136:139], v[8:11]
  buffer_load_dwordx4 a[212:215], v113, s[24:27], s30 offen offset:1024 sc1
  s_add_u32 s30, s30, 8192
  v_mfma_f32_16x16x32_bf16 v[12:15], a[200:203], v[148:151], v[12:15]
  buffer_load_dwordx4 a[216:219], v110, s[24:27], s30 offen offset:0 sc1
  v_mfma_f32_16x16x32_bf16 v[12:15], a[196:199], v[140:143], v[12:15]
  s_waitcnt lgkmcnt(0)
  v_mfma_f32_16x16x32_bf16 v[16:19], v[144:147], a[236:239], v[16:19]
  ds_read_b128 a[220:223], v122 offset:16384
  ds_read_b128 a[224:227], v122 offset:21504
  v_mfma_f32_16x16x32_bf16 v[16:19], a[160:163], a[240:243], v[16:19]
  buffer_load_dwordx4 a[228:231], v110, s[24:27], s30 offen offset:1024 sc1
  v_mfma_f32_16x16x32_bf16 v[20:23], a[160:163], a[248:251], v[20:23]
  buffer_load_dwordx4 a[232:235], v111, s[24:27], s30 offen offset:0 sc1
  v_mfma_f32_16x16x32_bf16 v[20:23], v[144:147], a[244:247], v[20:23]
  v_mfma_f32_16x16x32_bf16 v[24:27], v[144:147], a[252:255], v[24:27]
  v_mfma_f32_16x16x32_bf16 v[24:27], a[160:163], v[136:139], v[24:27]
  v_mfma_f32_16x16x32_bf16 v[28:31], a[160:163], v[148:151], v[28:31]
  v_mfma_f32_16x16x32_bf16 v[28:31], v[144:147], v[140:143], v[28:31]
  s_waitcnt lgkmcnt(0)
  v_mfma_f32_16x16x32_bf16 v[32:35], a[220:223], a[236:239], v[32:35]
  ds_read_b128 a[196:199], v122 offset:17408
  ds_read_b128 a[200:203], v122 offset:22528
  v_mfma_f32_16x16x32_bf16 v[32:35], a[224:227], a[240:243], v[32:35]
  v_mfma_f32_16x16x32_bf16 v[36:39], a[224:227], a[248:251], v[36:39]
  v_mfma_f32_16x16x32_bf16 v[36:39], a[220:223], a[244:247], v[36:39]
  v_mfma_f32_16x16x32_bf16 v[40:43], a[220:223], a[252:255], v[40:43]
  v_mfma_f32_16x16x32_bf16 v[40:43], a[224:227], v[136:139], v[40:43]
  v_mfma_f32_16x16x32_bf16 v[44:47], a[224:227], v[148:151], v[44:47]
  v_mfma_f32_16x16x32_bf16 v[44:47], a[220:223], v[140:143], v[44:47]
  s_waitcnt lgkmcnt(0)
  v_mfma_f32_16x16x32_bf16 v[48:51], a[196:199], a[236:239], v[48:51]
  ds_read_b128 v[144:147], v122 offset:18432
  ds_read_b128 a[160:163], v122 offset:23552
  v_mfma_f32_16x16x32_bf16 v[48:51], a[200:203], a[240:243], v[48:51]
  buffer_load_dwordx4 a[220:223], v111, s[24:27], s30 offen offset:1024 sc1
  v_mfma_f32_16x16x32_bf16 v[52:55], a[200:203], a[248:251], v[52:55]
  buffer_load_dwordx4 a[224:227], v112, s[24:27], s30 offen offset:0 sc1
  v_mfma_f32_16x16x32_bf16 v[52:55], a[196:199], a[244:247], v[52:55]
  v_mfma_f32_16x16x32_bf16 v[56:59], a[196:199], a[252:255], v[56:59]
  v_mfma_f32_16x16x32_bf16 v[56:59], a[200:203], v[136:139], v[56:59]
  v_mfma_f32_16x16x32_bf16 v[60:63], a[200:203], v[148:151], v[60:63]
  v_mfma_f32_16x16x32_bf16 v[60:63], a[196:199], v[140:143], v[60:63]
  s_waitcnt lgkmcnt(0)
  v_mfma_f32_16x16x32_bf16 v[64:67], v[144:147], a[236:239], v[64:67]
  buffer_load_dwordx4 a[196:199], v112, s[24:27], s30 offen offset:1024 sc1
  v_mfma_f32_16x16x32_bf16 v[64:67], a[160:163], a[240:243], v[64:67]
  buffer_load_dwordx4 a[200:203], v113, s[24:27], s30 offen offset:0 sc1
  v_mfma_f32_16x16x32_bf16 v[68:71], a[160:163], a[248:251], v[68:71]
  v_mfma_f32_16x16x32_bf16 v[68:71], v[144:147], a[244:247], v[68:71]
  v_mfma_f32_16x16x32_bf16 v[72:75], v[144:147], a[252:255], v[72:75]
  v_mfma_f32_16x16x32_bf16 v[72:75], a[160:163], v[136:139], v[72:75]
  v_mfma_f32_16x16x32_bf16 v[76:79], a[160:163], v[148:151], v[76:79]
  v_mfma_f32_16x16x32_bf16 v[76:79], v[144:147], v[140:143], v[76:79]
  buffer_load_dwordx4 v[144:147], v113, s[24:27], s30 offen offset:1024 sc1
  s_add_u32 s30, s30, 8192
  buffer_load_dwordx4 a[160:163], v110, s[24:27], s30 offen offset:0 sc1
  buffer_load_dwordx4 a[236:239], v110, s[24:27], s30 offen offset:1024 sc1
  buffer_load_dwordx4 a[240:243], v111, s[24:27], s30 offen offset:0 sc1
  buffer_load_dwordx4 a[244:247], v111, s[24:27], s30 offen offset:1024 sc1
  buffer_load_dwordx4 a[248:251], v112, s[24:27], s30 offen offset:0 sc1
  buffer_load_dwordx4 a[252:255], v112, s[24:27], s30 offen offset:1024 sc1
  buffer_load_dwordx4 v[136:139], v113, s[24:27], s30 offen offset:0 sc1
  buffer_load_dwordx4 v[140:143], v113, s[24:27], s30 offen offset:1024 sc1
  s_add_u32 s30, s30, 8192
  buffer_load_dwordx4 v[148:151], v110, s[24:27], s30 offen offset:0 sc1
  s_xor_b32 s38, s40, 1
  s_lshl_b32 s38, s38, 2
  s_add_u32 s38, s38, s3
  s_mul_i32 s38, s38, 5120
  s_add_u32 s38, s38, 25165824
  s_add_u32 s39, s38, 4096
  ds_write_b128 v118, v[4:7] offset:0
  ds_write_b128 v118, v[20:23] offset:1024
  ds_write_b128 v118, v[36:39] offset:2048
  ds_write_b128 v118, v[52:55] offset:3072
  ds_write_b128 v118, v[68:71] offset:4096
  ds_write_b128 v118, v[8:11] offset:5120
  ds_write_b128 v118, v[24:27] offset:6144
  ds_write_b128 v118, v[40:43] offset:7168
  ds_write_b128 v118, v[56:59] offset:8192
  ds_write_b128 v118, v[72:75] offset:9216
  ds_write_b128 v118, v[12:15] offset:10240
  ds_write_b128 v118, v[28:31] offset:11264
  ds_write_b128 v118, v[44:47] offset:12288
  ds_write_b128 v118, v[60:63] offset:13312
  ds_write_b128 v118, v[76:79] offset:14336
  s_waitcnt lgkmcnt(0)
  s_barrier
  ds_read_b128 v[4:7], v119 offset:0
  ds_read_b128 v[8:11], v120 offset:0
  ds_read_b128 v[12:15], v121 offset:0
  ds_read_b128 v[20:23], v119 offset:1024
  ds_read_b128 v[24:27], v120 offset:1024
  ds_read_b128 v[28:31], v121 offset:1024
  ds_read_b128 v[36:39], v119 offset:2048
  ds_read_b128 v[40:43], v120 offset:2048
  ds_read_b128 v[44:47], v121 offset:2048
  ds_read_b128 v[52:55], v119 offset:3072
  ds_read_b128 v[56:59], v120 offset:3072
  ds_read_b128 v[60:63], v121 offset:3072
  ds_read_b128 v[68:71], v119 offset:4096
  ds_read_b128 v[72:75], v120 offset:4096
  ds_read_b128 v[76:79], v121 offset:4096
  s_waitcnt lgkmcnt(13)
  v_add_f32 v4, v4, v8
  v_add_f32 v5, v5, v9
  v_add_f32 v6, v6, v10
  v_add_f32 v7, v7, v11
  s_waitcnt lgkmcnt(12)
  v_add_f32 v0, v0, v12
  v_add_f32 v1, v1, v13
  v_add_f32 v2, v2, v14
  v_add_f32 v3, v3, v15
  v_add_f32 v0, v0, v4
  v_add_f32 v1, v1, v5
  v_add_f32 v2, v2, v6
  v_add_f32 v3, v3, v7
  buffer_store_dwordx4 v[0:3], v114, s[24:27], s38 offen offset:0 sc1
  s_waitcnt lgkmcnt(10)
  v_add_f32 v20, v20, v24
  v_add_f32 v21, v21, v25
  v_add_f32 v22, v22, v26
  v_add_f32 v23, v23, v27
  s_waitcnt lgkmcnt(9)
  v_add_f32 v16, v16, v28
  v_add_f32 v17, v17, v29
  v_add_f32 v18, v18, v30
  v_add_f32 v19, v19, v31
  v_add_f32 v16, v16, v20
  v_add_f32 v17, v17, v21
  v_add_f32 v18, v18, v22
  v_add_f32 v19, v19, v23
  buffer_store_dwordx4 v[16:19], v114, s[24:27], s38 offen offset:1024 sc1
  s_waitcnt lgkmcnt(7)
  v_add_f32 v36, v36, v40
  v_add_f32 v37, v37, v41
  v_add_f32 v38, v38, v42
  v_add_f32 v39, v39, v43
  s_waitcnt lgkmcnt(6)
  v_add_f32 v32, v32, v44
  v_add_f32 v33, v33, v45
  v_add_f32 v34, v34, v46
  v_add_f32 v35, v35, v47
  v_add_f32 v32, v32, v36
  v_add_f32 v33, v33, v37
  v_add_f32 v34, v34, v38
  v_add_f32 v35, v35, v39
  buffer_store_dwordx4 v[32:35], v114, s[24:27], s38 offen offset:2048 sc1
  s_waitcnt lgkmcnt(4)
  v_add_f32 v52, v52, v56
  v_add_f32 v53, v53, v57
  v_add_f32 v54, v54, v58
  v_add_f32 v55, v55, v59
  s_waitcnt lgkmcnt(3)
  v_add_f32 v48, v48, v60
  v_add_f32 v49, v49, v61
  v_add_f32 v50, v50, v62
  v_add_f32 v51, v51, v63
  v_add_f32 v48, v48, v52
  v_add_f32 v49, v49, v53
  v_add_f32 v50, v50, v54
  v_add_f32 v51, v51, v55
  buffer_store_dwordx4 v[48:51], v114, s[24:27], s38 offen offset:3072 sc1
  s_waitcnt lgkmcnt(1)
  v_add_f32 v68, v68, v72
  v_add_f32 v69, v69, v73
  v_add_f32 v70, v70, v74
  v_add_f32 v71, v71, v75
  s_waitcnt lgkmcnt(0)
  v_add_f32 v64, v64, v76
  v_add_f32 v65, v65, v77
  v_add_f32 v66, v66, v78
  v_add_f32 v67, v67, v79
  v_add_f32 v64, v64, v68
  v_add_f32 v65, v65, v69
  v_add_f32 v66, v66, v70
  v_add_f32 v67, v67, v71
  buffer_store_dwordx4 v[64:67], v114, s[24:27], s39 offen offset:0 sc1
  s_barrier
  s_waitcnt vmcnt(30)
  v_mfma_f32_16x16x32_bf16 v[0:3], v[176:179], v[152:155], 0
  s_xor_b32 s38, s40, 1
  s_lshl_b32 s38, s38, 7
  s_add_u32 s38, s38, 2834432
  v_mov_b32 v135, 1073741824
  v_writelane_b32 v135, s38, 0
  v_mfma_f32_16x16x32_bf16 v[0:3], v[196:199], a[144:147], v[0:3]
  v_mov_b32 v129, 1
  v_mfma_f32_16x16x32_bf16 v[4:7], v[196:199], a[152:155], 0
  s_xor_b32 s38, s38, 128
  v_mov_b32 v133, s38
  v_mov_b32 v134, 4
  v_mfma_f32_16x16x32_bf16 v[4:7], v[176:179], a[148:151], v[4:7]
  v_mfma_f32_16x16x32_bf16 v[8:11], v[176:179], a[156:159], 0
  v_mfma_f32_16x16x32_bf16 v[8:11], v[196:199], a[172:175], v[8:11]
  v_mfma_f32_16x16x32_bf16 v[12:15], v[196:199], a[180:183], 0
  v_mfma_f32_16x16x32_bf16 v[12:15], v[176:179], a[176:179], v[12:15]
  v_mfma_f32_16x16x32_bf16 v[16:19], v[180:183], v[152:155], 0
  buffer_load_dwordx4 v[176:179], v110, s[24:27], s30 offen offset:1024 sc1
  v_mfma_f32_16x16x32_bf16 v[16:19], v[200:203], a[144:147], v[16:19]
  buffer_load_dwordx4 v[196:199], v111, s[24:27], s30 offen offset:0 sc1
  v_mfma_f32_16x16x32_bf16 v[20:23], v[200:203], a[152:155], 0
  v_mfma_f32_16x16x32_bf16 v[20:23], v[180:183], a[148:151], v[20:23]
  v_mfma_f32_16x16x32_bf16 v[24:27], v[180:183], a[156:159], 0
  v_mfma_f32_16x16x32_bf16 v[24:27], v[200:203], a[172:175], v[24:27]
  v_mfma_f32_16x16x32_bf16 v[28:31], v[200:203], a[180:183], 0
  v_mfma_f32_16x16x32_bf16 v[28:31], v[180:183], a[176:179], v[28:31]
  v_mfma_f32_16x16x32_bf16 v[32:35], v[184:187], v[152:155], 0
  buffer_load_dwordx4 v[180:183], v111, s[24:27], s30 offen offset:1024 sc1
  v_mfma_f32_16x16x32_bf16 v[32:35], v[204:207], a[144:147], v[32:35]
  buffer_load_dwordx4 v[200:203], v112, s[24:27], s30 offen offset:0 sc1
  v_mfma_f32_16x16x32_bf16 v[36:39], v[204:207], a[152:155], 0
  v_mfma_f32_16x16x32_bf16 v[36:39], v[184:187], a[148:151], v[36:39]
  v_mfma_f32_16x16x32_bf16 v[40:43], v[184:187], a[156:159], 0
  v_mfma_f32_16x16x32_bf16 v[40:43], v[204:207], a[172:175], v[40:43]
  v_mfma_f32_16x16x32_bf16 v[44:47], v[204:207], a[180:183], 0
  v_mfma_f32_16x16x32_bf16 v[44:47], v[184:187], a[176:179], v[44:47]
  v_mfma_f32_16x16x32_bf16 v[48:51], v[188:191], v[152:155], 0
  buffer_load_dwordx4 v[184:187], v112, s[24:27], s30 offen offset:1024 sc1
  v_mfma_f32_16x16x32_bf16 v[48:51], v[208:211], a[144:147], v[48:51]
  buffer_load_dwordx4 v[204:207], v113, s[24:27], s30 offen offset:0 sc1
  v_mfma_f32_16x16x32_bf16 v[52:55], v[208:211], a[152:155], 0
  v_mfma_f32_16x16x32_bf16 v[52:55], v[188:191], a[148:151], v[52:55]
  v_mfma_f32_16x16x32_bf16 v[56:59], v[188:191], a[156:159], 0
  v_mfma_f32_16x16x32_bf16 v[56:59], v[208:211], a[172:175], v[56:59]
  v_mfma_f32_16x16x32_bf16 v[60:63], v[208:211], a[180:183], 0
  v_mfma_f32_16x16x32_bf16 v[60:63], v[188:191], a[176:179], v[60:63]
  v_mfma_f32_16x16x32_bf16 v[64:67], v[192:195], v[152:155], 0
  buffer_load_dwordx4 v[188:191], v113, s[24:27], s30 offen offset:1024 sc1
  s_add_u32 s30, s30, 8192
  v_mfma_f32_16x16x32_bf16 v[64:67], v[212:215], a[144:147], v[64:67]
  buffer_load_dwordx4 v[208:211], v110, s[24:27], s30 offen offset:0 sc1
  v_mfma_f32_16x16x32_bf16 v[68:71], v[212:215], a[152:155], 0
  v_mfma_f32_16x16x32_bf16 v[68:71], v[192:195], a[148:151], v[68:71]
  v_mfma_f32_16x16x32_bf16 v[72:75], v[192:195], a[156:159], 0
  v_mfma_f32_16x16x32_bf16 v[72:75], v[212:215], a[172:175], v[72:75]
  v_mfma_f32_16x16x32_bf16 v[76:79], v[212:215], a[180:183], 0
  v_mfma_f32_16x16x32_bf16 v[76:79], v[192:195], a[176:179], v[76:79]
  s_waitcnt vmcnt(30)
  v_mfma_f32_16x16x32_bf16 v[0:3], v[216:219], a[184:187], v[0:3]
  buffer_load_dwordx4 v[192:195], v110, s[24:27], s30 offen offset:1024 sc1
  v_mfma_f32_16x16x32_bf16 v[0:3], v[236:239], a[188:191], v[0:3]
  buffer_load_dwordx4 v[212:215], v111, s[24:27], s30 offen offset:0 sc1
  v_mfma_f32_16x16x32_bf16 v[4:7], v[236:239], a[164:167], v[4:7]
  buffer_load_dwordx4 a[144:147], v111, s[24:27], s30 offen offset:1024 sc1
  v_mfma_f32_16x16x32_bf16 v[4:7], v[216:219], a[192:195], v[4:7]
  buffer_load_dwordx4 a[148:151], v112, s[24:27], s30 offen offset:0 sc1
  v_mfma_f32_16x16x32_bf16 v[8:11], v[216:219], a[168:171], v[8:11]
  buffer_load_dwordx4 a[152:155], v112, s[24:27], s30 offen offset:1024 sc1
  v_mfma_f32_16x16x32_bf16 v[8:11], v[236:239], a[204:207], v[8:11]
  buffer_load_dwordx4 a[156:159], v113, s[24:27], s30 offen offset:0 sc1
  v_mfma_f32_16x16x32_bf16 v[12:15], v[236:239], a[212:215], v[12:15]
  v_mfma_f32_16x16x32_bf16 v[12:15], v[216:219], a[208:211], v[12:15]
  v_mfma_f32_16x16x32_bf16 v[16:19], v[220:223], a[184:187], v[16:19]
  buffer_load_dwordx4 a[172:175], v113, s[24:27], s30 offen offset:1024 sc1
  s_add_u32 s30, s30, 8192
  v_mfma_f32_16x16x32_bf16 v[16:19], v[240:243], a[188:191], v[16:19]
  buffer_load_dwordx4 a[176:179], v110, s[24:27], s30 offen offset:0 sc1
  v_mfma_f32_16x16x32_bf16 v[20:23], v[240:243], a[164:167], v[20:23]
  buffer_load_dwordx4 a[180:183], v110, s[24:27], s30 offen offset:1024 sc1
  v_mfma_f32_16x16x32_bf16 v[20:23], v[220:223], a[192:195], v[20:23]
  buffer_load_dwordx4 v[216:219], v111, s[24:27], s30 offen offset:0 sc1
  v_mfma_f32_16x16x32_bf16 v[24:27], v[220:223], a[168:171], v[24:27]
  buffer_load_dwordx4 v[236:239], v111, s[24:27], s30 offen offset:1024 sc1
  v_mfma_f32_16x16x32_bf16 v[24:27], v[240:243], a[204:207], v[24:27]
  v_mfma_f32_16x16x32_bf16 v[28:31], v[240:243], a[212:215], v[28:31]
  v_mfma_f32_16x16x32_bf16 v[28:31], v[220:223], a[208:211], v[28:31]
  v_mfma_f32_16x16x32_bf16 v[32:35], v[224:227], a[184:187], v[32:35]
  buffer_load_dwordx4 v[220:223], v112, s[24:27], s30 offen offset:0 sc1
  v_mfma_f32_16x16x32_bf16 v[32:35], v[244:247], a[188:191], v[32:35]
  buffer_load_dwordx4 v[240:243], v112, s[24:27], s30 offen offset:1024 sc1
  v_mfma_f32_16x16x32_bf16 v[36:39], v[244:247], a[164:167], v[36:39]
  v_mfma_f32_16x16x32_bf16 v[36:39], v[224:227], a[192:195], v[36:39]
  v_mfma_f32_16x16x32_bf16 v[40:43], v[224:227], a[168:171], v[40:43]
  v_mfma_f32_16x16x32_bf16 v[40:43], v[244:247], a[204:207], v[40:43]
  v_mfma_f32_16x16x32_bf16 v[44:47], v[244:247], a[212:215], v[44:47]
  v_mfma_f32_16x16x32_bf16 v[44:47], v[224:227], a[208:211], v[44:47]
  v_mfma_f32_16x16x32_bf16 v[48:51], v[228:231], a[184:187], v[48:51]
  buffer_load_dwordx4 v[224:227], v113, s[24:27], s30 offen offset:0 sc1
  v_mfma_f32_16x16x32_bf16 v[48:51], v[248:251], a[188:191], v[48:51]
  buffer_load_dwordx4 v[244:247], v113, s[24:27], s30 offen offset:1024 sc1
  s_add_u32 s30, s30, 8192
  v_mfma_f32_16x16x32_bf16 v[52:55], v[248:251], a[164:167], v[52:55]
  v_mfma_f32_16x16x32_bf16 v[52:55], v[228:231], a[192:195], v[52:55]
  v_mfma_f32_16x16x32_bf16 v[56:59], v[228:231], a[168:171], v[56:59]
  v_mfma_f32_16x16x32_bf16 v[56:59], v[248:251], a[204:207], v[56:59]
  v_mfma_f32_16x16x32_bf16 v[60:63], v[248:251], a[212:215], v[60:63]
  v_mfma_f32_16x16x32_bf16 v[60:63], v[228:231], a[208:211], v[60:63]
  v_mfma_f32_16x16x32_bf16 v[64:67], v[232:235], a[184:187], v[64:67]
  buffer_load_dwordx4 v[228:231], v110, s[24:27], s30 offen offset:0 sc1
  v_mfma_f32_16x16x32_bf16 v[64:67], v[252:255], a[188:191], v[64:67]
  buffer_load_dwordx4 v[248:251], v110, s[24:27], s30 offen offset:1024 sc1
  v_mfma_f32_16x16x32_bf16 v[68:71], v[252:255], a[164:167], v[68:71]
  v_mfma_f32_16x16x32_bf16 v[68:71], v[232:235], a[192:195], v[68:71]
  v_mfma_f32_16x16x32_bf16 v[72:75], v[232:235], a[168:171], v[72:75]
  v_mfma_f32_16x16x32_bf16 v[72:75], v[252:255], a[204:207], v[72:75]
  v_mfma_f32_16x16x32_bf16 v[76:79], v[252:255], a[212:215], v[76:79]
  v_mfma_f32_16x16x32_bf16 v[76:79], v[232:235], a[208:211], v[76:79]
  s_waitcnt vmcnt(39)
  v_mfma_f32_16x16x32_bf16 v[0:3], a[0:3], a[216:219], v[0:3]
  buffer_load_dwordx4 v[232:235], v111, s[24:27], s30 offen offset:0 sc1
  v_mfma_f32_16x16x32_bf16 v[0:3], a[20:23], a[228:231], v[0:3]
  buffer_load_dwordx4 v[252:255], v111, s[24:27], s30 offen offset:1024 sc1
  v_mfma_f32_16x16x32_bf16 v[4:7], a[20:23], a[220:223], v[4:7]
  buffer_load_dwordx4 a[184:187], v112, s[24:27], s30 offen offset:0 sc1
  v_mfma_f32_16x16x32_bf16 v[4:7], a[0:3], a[232:235], v[4:7]
  buffer_load_dwordx4 a[188:191], v112, s[24:27], s30 offen offset:1024 sc1
  v_mfma_f32_16x16x32_bf16 v[8:11], a[0:3], a[224:227], v[8:11]
  buffer_load_dwordx4 a[192:195], v113, s[24:27], s30 offen offset:0 sc1
  v_mfma_f32_16x16x32_bf16 v[8:11], a[20:23], a[196:199], v[8:11]
  buffer_load_dwordx4 a[164:167], v113, s[24:27], s30 offen offset:1024 sc1
  v_mfma_f32_16x16x32_bf16 v[12:15], a[20:23], v[144:147], v[12:15]
  v_mfma_f32_16x16x32_bf16 v[12:15], a[0:3], a[200:203], v[12:15]
  v_mfma_f32_16x16x32_bf16 v[16:19], a[4:7], a[216:219], v[16:19]
  s_add_u32 s30, s30, 8192
  v_mfma_f32_16x16x32_bf16 v[16:19], a[24:27], a[228:231], v[16:19]
  v_mfma_f32_16x16x32_bf16 v[20:23], a[24:27], a[220:223], v[20:23]
  v_mfma_f32_16x16x32_bf16 v[20:23], a[4:7], a[232:235], v[20:23]
  v_mfma_f32_16x16x32_bf16 v[24:27], a[4:7], a[224:227], v[24:27]
  v_mfma_f32_16x16x32_bf16 v[24:27], a[24:27], a[196:199], v[24:27]
  v_mfma_f32_16x16x32_bf16 v[28:31], a[24:27], v[144:147], v[28:31]
  v_mfma_f32_16x16x32_bf16 v[28:31], a[4:7], a[200:203], v[28:31]
  v_mfma_f32_16x16x32_bf16 v[32:35], a[8:11], a[216:219], v[32:35]
  v_mfma_f32_16x16x32_bf16 v[32:35], a[28:31], a[228:231], v[32:35]
  v_mfma_f32_16x16x32_bf16 v[36:39], a[28:31], a[220:223], v[36:39]
  v_mfma_f32_16x16x32_bf16 v[36:39], a[8:11], a[232:235], v[36:39]
  v_mfma_f32_16x16x32_bf16 v[40:43], a[8:11], a[224:227], v[40:43]
  v_mfma_f32_16x16x32_bf16 v[40:43], a[28:31], a[196:199], v[40:43]
  v_mfma_f32_16x16x32_bf16 v[44:47], a[28:31], v[144:147], v[44:47]
  v_mfma_f32_16x16x32_bf16 v[44:47], a[8:11], a[200:203], v[44:47]
  v_mfma_f32_16x16x32_bf16 v[48:51], a[12:15], a[216:219], v[48:51]
  v_mfma_f32_16x16x32_bf16 v[48:51], a[32:35], a[228:231], v[48:51]
  v_mfma_f32_16x16x32_bf16 v[52:55], a[32:35], a[220:223], v[52:55]
  v_mfma_f32_16x16x32_bf16 v[52:55], a[12:15], a[232:235], v[52:55]
  v_mfma_f32_16x16x32_bf16 v[56:59], a[12:15], a[224:227], v[56:59]
  v_mfma_f32_16x16x32_bf16 v[56:59], a[32:35], a[196:199], v[56:59]
  v_mfma_f32_16x16x32_bf16 v[60:63], a[32:35], v[144:147], v[60:63]
  v_mfma_f32_16x16x32_bf16 v[60:63], a[12:15], a[200:203], v[60:63]
  v_mfma_f32_16x16x32_bf16 v[64:67], a[16:19], a[216:219], v[64:67]
  v_mfma_f32_16x16x32_bf16 v[64:67], a[36:39], a[228:231], v[64:67]
  v_mfma_f32_16x16x32_bf16 v[68:71], a[36:39], a[220:223], v[68:71]
  v_mfma_f32_16x16x32_bf16 v[68:71], a[16:19], a[232:235], v[68:71]
  v_mfma_f32_16x16x32_bf16 v[72:75], a[16:19], a[224:227], v[72:75]
  v_mfma_f32_16x16x32_bf16 v[72:75], a[36:39], a[196:199], v[72:75]
  v_mfma_f32_16x16x32_bf16 v[76:79], a[36:39], v[144:147], v[76:79]
  v_mfma_f32_16x16x32_bf16 v[76:79], a[16:19], a[200:203], v[76:79]
  s_waitcnt vmcnt(37)
  v_mfma_f32_16x16x32_bf16 v[0:3], a[40:43], a[160:163], v[0:3]
  s_waitcnt vmcnt(31)
  buffer_atomic_add v129, v135, s[24:27], 0 offen
  v_mfma_f32_16x16x32_bf16 v[0:3], a[60:63], a[236:239], v[0:3]
  v_mfma_f32_16x16x32_bf16 v[4:7], a[60:63], a[244:247], v[4:7]
  v_mfma_f32_16x16x32_bf16 v[4:7], a[40:43], a[240:243], v[4:7]
  v_mfma_f32_16x16x32_bf16 v[8:11], a[40:43], a[248:251], v[8:11]
  v_mfma_f32_16x16x32_bf16 v[8:11], a[60:63], a[252:255], v[8:11]
  v_mfma_f32_16x16x32_bf16 v[12:15], a[60:63], v[140:143], v[12:15]
  v_mfma_f32_16x16x32_bf16 v[12:15], a[40:43], v[136:139], v[12:15]
  v_mfma_f32_16x16x32_bf16 v[16:19], a[44:47], a[160:163], v[16:19]
  v_mfma_f32_16x16x32_bf16 v[16:19], a[64:67], a[236:239], v[16:19]
  v_mfma_f32_16x16x32_bf16 v[20:23], a[64:67], a[244:247], v[20:23]
  v_mfma_f32_16x16x32_bf16 v[20:23], a[44:47], a[240:243], v[20:23]
  v_mfma_f32_16x16x32_bf16 v[24:27], a[44:47], a[248:251], v[24:27]
  v_mfma_f32_16x16x32_bf16 v[24:27], a[64:67], a[252:255], v[24:27]
  v_mfma_f32_16x16x32_bf16 v[28:31], a[64:67], v[140:143], v[28:31]
  v_mfma_f32_16x16x32_bf16 v[28:31], a[44:47], v[136:139], v[28:31]
  v_mfma_f32_16x16x32_bf16 v[32:35], a[48:51], a[160:163], v[32:35]
  v_mfma_f32_16x16x32_bf16 v[32:35], a[68:71], a[236:239], v[32:35]
  v_mfma_f32_16x16x32_bf16 v[36:39], a[68:71], a[244:247], v[36:39]
  v_mfma_f32_16x16x32_bf16 v[36:39], a[48:51], a[240:243], v[36:39]
  v_mfma_f32_16x16x32_bf16 v[40:43], a[48:51], a[248:251], v[40:43]
  v_mfma_f32_16x16x32_bf16 v[40:43], a[68:71], a[252:255], v[40:43]
  v_mfma_f32_16x16x32_bf16 v[44:47], a[68:71], v[140:143], v[44:47]
  v_mfma_f32_16x16x32_bf16 v[44:47], a[48:51], v[136:139], v[44:47]
  v_mfma_f32_16x16x32_bf16 v[48:51], a[52:55], a[160:163], v[48:51]
  v_mfma_f32_16x16x32_bf16 v[48:51], a[72:75], a[236:239], v[48:51]
  v_mfma_f32_16x16x32_bf16 v[52:55], a[72:75], a[244:247], v[52:55]
  v_mfma_f32_16x16x32_bf16 v[52:55], a[52:55], a[240:243], v[52:55]
  v_mfma_f32_16x16x32_bf16 v[56:59], a[52:55], a[248:251], v[56:59]
  v_mfma_f32_16x16x32_bf16 v[56:59], a[72:75], a[252:255], v[56:59]
  v_mfma_f32_16x16x32_bf16 v[60:63], a[72:75], v[140:143], v[60:63]
  v_mfma_f32_16x16x32_bf16 v[60:63], a[52:55], v[136:139], v[60:63]
  v_mfma_f32_16x16x32_bf16 v[64:67], a[56:59], a[160:163], v[64:67]
  v_mfma_f32_16x16x32_bf16 v[64:67], a[76:79], a[236:239], v[64:67]
  v_mfma_f32_16x16x32_bf16 v[68:71], a[76:79], a[244:247], v[68:71]
  v_mfma_f32_16x16x32_bf16 v[68:71], a[56:59], a[240:243], v[68:71]
  v_mfma_f32_16x16x32_bf16 v[72:75], a[56:59], a[248:251], v[72:75]
  v_mfma_f32_16x16x32_bf16 v[72:75], a[76:79], a[252:255], v[72:75]
  v_mfma_f32_16x16x32_bf16 v[76:79], a[76:79], v[140:143], v[76:79]
  v_mfma_f32_16x16x32_bf16 v[76:79], a[56:59], v[136:139], v[76:79]
  s_waitcnt vmcnt(25)
  v_mfma_f32_16x16x32_bf16 v[0:3], a[80:83], v[148:151], v[0:3]
  v_mfma_f32_16x16x32_bf16 v[0:3], a[100:103], v[176:179], v[0:3]
  v_mfma_f32_16x16x32_bf16 v[4:7], a[100:103], v[180:183], v[4:7]
  v_mfma_f32_16x16x32_bf16 v[4:7], a[80:83], v[196:199], v[4:7]
  v_mfma_f32_16x16x32_bf16 v[8:11], a[80:83], v[200:203], v[8:11]
  v_mfma_f32_16x16x32_bf16 v[8:11], a[100:103], v[184:187], v[8:11]
  v_mfma_f32_16x16x32_bf16 v[12:15], a[100:103], v[188:191], v[12:15]
  v_mfma_f32_16x16x32_bf16 v[12:15], a[80:83], v[204:207], v[12:15]
  v_mfma_f32_16x16x32_bf16 v[16:19], a[84:87], v[148:151], v[16:19]
  v_mfma_f32_16x16x32_bf16 v[16:19], a[104:107], v[176:179], v[16:19]
  v_mfma_f32_16x16x32_bf16 v[20:23], a[104:107], v[180:183], v[20:23]
  v_mfma_f32_16x16x32_bf16 v[20:23], a[84:87], v[196:199], v[20:23]
  v_mfma_f32_16x16x32_bf16 v[24:27], a[84:87], v[200:203], v[24:27]
  v_mfma_f32_16x16x32_bf16 v[24:27], a[104:107], v[184:187], v[24:27]
  v_mfma_f32_16x16x32_bf16 v[28:31], a[104:107], v[188:191], v[28:31]
  v_mfma_f32_16x16x32_bf16 v[28:31], a[84:87], v[204:207], v[28:31]
  v_mfma_f32_16x16x32_bf16 v[32:35], a[88:91], v[148:151], v[32:35]
  v_mfma_f32_16x16x32_bf16 v[32:35], a[108:111], v[176:179], v[32:35]
  v_mfma_f32_16x16x32_bf16 v[36:39], a[108:111], v[180:183], v[36:39]
  v_mfma_f32_16x16x32_bf16 v[36:39], a[88:91], v[196:199], v[36:39]
  v_mfma_f32_16x16x32_bf16 v[40:43], a[88:91], v[200:203], v[40:43]
  v_mfma_f32_16x16x32_bf16 v[40:43], a[108:111], v[184:187], v[40:43]
  v_mfma_f32_16x16x32_bf16 v[44:47], a[108:111], v[188:191], v[44:47]
  v_mfma_f32_16x16x32_bf16 v[44:47], a[88:91], v[204:207], v[44:47]
  v_mfma_f32_16x16x32_bf16 v[48:51], a[92:95], v[148:151], v[48:51]
  v_mfma_f32_16x16x32_bf16 v[48:51], a[112:115], v[176:179], v[48:51]
  v_mfma_f32_16x16x32_bf16 v[52:55], a[112:115], v[180:183], v[52:55]
  v_mfma_f32_16x16x32_bf16 v[52:55], a[92:95], v[196:199], v[52:55]
  v_mfma_f32_16x16x32_bf16 v[56:59], a[92:95], v[200:203], v[56:59]
  v_mfma_f32_16x16x32_bf16 v[56:59], a[112:115], v[184:187], v[56:59]
  v_mfma_f32_16x16x32_bf16 v[60:63], a[112:115], v[188:191], v[60:63]
  v_mfma_f32_16x16x32_bf16 v[60:63], a[92:95], v[204:207], v[60:63]
  v_mfma_f32_16x16x32_bf16 v[64:67], a[96:99], v[148:151], v[64:67]
  v_mfma_f32_16x16x32_bf16 v[64:67], a[116:119], v[176:179], v[64:67]
  v_mfma_f32_16x16x32_bf16 v[68:71], a[116:119], v[180:183], v[68:71]
  v_mfma_f32_16x16x32_bf16 v[68:71], a[96:99], v[196:199], v[68:71]
  v_mfma_f32_16x16x32_bf16 v[72:75], a[96:99], v[200:203], v[72:75]
  v_mfma_f32_16x16x32_bf16 v[72:75], a[116:119], v[184:187], v[72:75]
  v_mfma_f32_16x16x32_bf16 v[76:79], a[116:119], v[188:191], v[76:79]
  v_mfma_f32_16x16x32_bf16 v[76:79], a[96:99], v[204:207], v[76:79]
  s_waitcnt vmcnt(17)
  v_mfma_f32_16x16x32_bf16 v[0:3], a[120:123], v[208:211], v[0:3]
  ds_read_b128 a[168:171], v122 offset:0
  buffer_load_dword v128, v133, s[24:27], 0 offen sc1
  s_xor_b32 s38, s40, 0
  s_lshl_b32 s38, s38, 2
  s_add_u32 s38, s38, s3
  s_mul_i32 s38, s38, 5120
  s_add_u32 s38, s38, 25165824
  s_add_u32 s39, s38, 4096
  v_mfma_f32_16x16x32_bf16 v[0:3], a[140:143], v[192:195], v[0:3]
  v_mfma_f32_16x16x32_bf16 v[4:7], a[140:143], a[144:147], v[4:7]
  v_mfma_f32_16x16x32_bf16 v[4:7], a[120:123], v[212:215], v[4:7]
  v_mfma_f32_16x16x32_bf16 v[8:11], a[120:123], a[148:151], v[8:11]
  v_mfma_f32_16x16x32_bf16 v[8:11], a[140:143], a[152:155], v[8:11]
  v_mfma_f32_16x16x32_bf16 v[12:15], a[140:143], a[172:175], v[12:15]
  v_mfma_f32_16x16x32_bf16 v[12:15], a[120:123], a[156:159], v[12:15]
  s_waitcnt lgkmcnt(0)
  v_mfma_f32_16x16x32_bf16 v[16:19], a[124:127], v[208:211], v[16:19]
  ds_read_b128 a[204:207], v122 offset:1024
  v_mfma_f32_16x16x32_bf16 v[16:19], a[168:171], v[192:195], v[16:19]
  v_mfma_f32_16x16x32_bf16 v[20:23], a[168:171], a[144:147], v[20:23]
  v_mfma_f32_16x16x32_bf16 v[20:23], a[124:127], v[212:215], v[20:23]
  v_mfma_f32_16x16x32_bf16 v[24:27], a[124:127], a[148:151], v[24:27]
  v_mfma_f32_16x16x32_bf16 v[24:27], a[168:171], a[152:155], v[24:27]
  v_mfma_f32_16x16x32_bf16 v[28:31], a[168:171], a[172:175], v[28:31]
  v_mfma_f32_16x16x32_bf16 v[28:31], a[124:127], a[156:159], v[28:31]
  s_waitcnt lgkmcnt(0)
  v_mfma_f32_16x16x32_bf16 v[32:35], a[128:131], v[208:211], v[32:35]
  ds_read_b128 a[208:211], v122 offset:2048
  v_mfma_f32_16x16x32_bf16 v[32:35], a[204:207], v[192:195], v[32:35]
  v_mfma_f32_16x16x32_bf16 v[36:39], a[204:207], a[144:147], v[36:39]
  v_mfma_f32_16x16x32_bf16 v[36:39], a[128:131], v[212:215], v[36:39]
  v_mfma_f32_16x16x32_bf16 v[40:43], a[128:131], a[148:151], v[40:43]
  v_mfma_f32_16x16x32_bf16 v[40:43], a[204:207], a[152:155], v[40:43]
  v_mfma_f32_16x16x32_bf16 v[44:47], a[204:207], a[172:175], v[44:47]
  v_mfma_f32_16x16x32_bf16 v[44:47], a[128:131], a[156:159], v[44:47]
  s_waitcnt lgkmcnt(0)
  v_mfma_f32_16x16x32_bf16 v[48:51], a[132:135], v[208:211], v[48:51]
  ds_read_b128 a[212:215], v122 offset:3072
  v_mfma_f32_16x16x32_bf16 v[48:51], a[208:211], v[192:195], v[48:51]
  v_mfma_f32_16x16x32_bf16 v[52:55], a[208:211], a[144:147], v[52:55]
  v_mfma_f32_16x16x32_bf16 v[52:55], a[132:135], v[212:215], v[52:55]
  v_mfma_f32_16x16x32_bf16 v[56:59], a[132:135], a[148:151], v[56:59]
  v_mfma_f32_16x16x32_bf16 v[56:59], a[208:211], a[152:155], v[56:59]
  v_mfma_f32_16x16x32_bf16 v[60:63], a[208:211], a[172:175], v[60:63]
  v_mfma_f32_16x16x32_bf16 v[60:63], a[132:135], a[156:159], v[60:63]
  s_waitcnt lgkmcnt(0)
  v_mfma_f32_16x16x32_bf16 v[64:67], a[136:139], v[208:211], v[64:67]
  ds_read_b128 a[0:3], v122 offset:4096
  ds_read_b128 a[20:23], v122 offset:9216
  v_mfma_f32_16x16x32_bf16 v[64:67], a[212:215], v[192:195], v[64:67]
  v_mfma_f32_16x16x32_bf16 v[68:71], a[212:215], a[144:147], v[68:71]
  v_mfma_f32_16x16x32_bf16 v[68:71], a[136:139], v[212:215], v[68:71]
  v_mfma_f32_16x16x32_bf16 v[72:75], a[136:139], a[148:151], v[72:75]
  v_mfma_f32_16x16x32_bf16 v[72:75], a[212:215], a[152:155], v[72:75]
  v_mfma_f32_16x16x32_bf16 v[76:79], a[212:215], a[172:175], v[76:79]
  v_mfma_f32_16x16x32_bf16 v[76:79], a[136:139], a[156:159], v[76:79]
  s_waitcnt vmcnt(10) lgkmcnt(0)
  v_mfma_f32_16x16x32_bf16 v[0:3], a[0:3], a[176:179], v[0:3]
  ds_read_b128 a[4:7], v122 offset:5120
  ds_read_b128 a[24:27], v122 offset:10240
  v_mfma_f32_16x16x32_bf16 v[0:3], a[20:23], a[180:183], v[0:3]
  v_mfma_f32_16x16x32_bf16 v[4:7], a[20:23], v[236:239], v[4:7]
  v_mfma_f32_16x16x32_bf16 v[4:7], a[0:3], v[216:219], v[4:7]
  v_mfma_f32_16x16x32_bf16 v[8:11], a[0:3], v[220:223], v[8:11]
  v_mfma_f32_16x16x32_bf16 v[8:11], a[20:23], v[240:243], v[8:11]
  v_mfma_f32_16x16x32_bf16 v[12:15], a[20:23], v[244:247], v[12:15]
  v_mfma_f32_16x16x32_bf16 v[12:15], a[0:3], v[224:227], v[12:15]
  s_waitcnt lgkmcnt(0)
  v_mfma_f32_16x16x32_bf16 v[16:19], a[4:7], a[176:179], v[16:19]
  ds_read_b128 a[8:11], v122 offset:6144
  ds_read_b128 a[28:31], v122 offset:11264
  v_mfma_f32_16x16x32_bf16 v[16:19], a[24:27], a[180:183], v[16:19]
  v_mfma_f32_16x16x32_bf16 v[20:23], a[24:27], v[236:239], v[20:23]
  v_mfma_f32_16x16x32_bf16 v[20:23], a[4:7], v[216:219], v[20:23]
  v_mfma_f32_16x16x32_bf16 v[24:27], a[4:7], v[220:223], v[24:27]
  v_mfma_f32_16x16x32_bf16 v[24:27], a[24:27], v[240:243], v[24:27]
  v_mfma_f32_16x16x32_bf16 v[28:31], a[24:27], v[244:247], v[28:31]
  v_mfma_f32_16x16x32_bf16 v[28:31], a[4:7], v[224:227], v[28:31]
  s_waitcnt lgkmcnt(0)
  v_mfma_f32_16x16x32_bf16 v[32:35], a[8:11], a[176:179], v[32:35]
  ds_read_b128 a[12:15], v122 offset:7168
  ds_read_b128 a[32:35], v122 offset:12288
  v_mfma_f32_16x16x32_bf16 v[32:35], a[28:31], a[180:183], v[32:35]
  v_mfma_f32_16x16x32_bf16 v[36:39], a[28:31], v[236:239], v[36:39]
  v_mfma_f32_16x16x32_bf16 v[36:39], a[8:11], v[216:219], v[36:39]
  v_mfma_f32_16x16x32_bf16 v[40:43], a[8:11], v[220:223], v[40:43]
  v_mfma_f32_16x16x32_bf16 v[40:43], a[28:31], v[240:243], v[40:43]
  v_mfma_f32_16x16x32_bf16 v[44:47], a[28:31], v[244:247], v[44:47]
  v_mfma_f32_16x16x32_bf16 v[44:47], a[8:11], v[224:227], v[44:47]
  s_waitcnt lgkmcnt(0)
  v_mfma_f32_16x16x32_bf16 v[48:51], a[12:15], a[176:179], v[48:51]
  ds_read_b128 a[16:19], v122 offset:8192
  ds_read_b128 a[36:39], v122 offset:13312
  v_mfma_f32_16x16x32_bf16 v[48:51], a[32:35], a[180:183], v[48:51]
  v_mfma_f32_16x16x32_bf16 v[52:55], a[32:35], v[236:239], v[52:55]
  v_mfma_f32_16x16x32_bf16 v[52:55], a[12:15], v[216:219], v[52:55]
  v_mfma_f32_16x16x32_bf16 v[56:59], a[12:15], v[220:223], v[56:59]
  v_mfma_f32_16x16x32_bf16 v[56:59], a[32:35], v[240:243], v[56:59]
  v_mfma_f32_16x16x32_bf16 v[60:63], a[32:35], v[244:247], v[60:63]
  v_mfma_f32_16x16x32_bf16 v[60:63], a[12:15], v[224:227], v[60:63]
  s_waitcnt lgkmcnt(0)
  v_mfma_f32_16x16x32_bf16 v[64:67], a[16:19], a[176:179], v[64:67]
  ds_read_b128 a[216:219], v122 offset:14336
  ds_read_b128 a[228:231], v122 offset:19456
  v_mfma_f32_16x16x32_bf16 v[64:67], a[36:39], a[180:183], v[64:67]
  v_mfma_f32_16x16x32_bf16 v[68:71], a[36:39], v[236:239], v[68:71]
  v_mfma_f32_16x16x32_bf16 v[68:71], a[16:19], v[216:219], v[68:71]
  v_mfma_f32_16x16x32_bf16 v[72:75], a[16:19], v[220:223], v[72:75]
  v_mfma_f32_16x16x32_bf16 v[72:75], a[36:39], v[240:243], v[72:75]
  v_mfma_f32_16x16x32_bf16 v[76:79], a[36:39], v[244:247], v[76:79]
  v_mfma_f32_16x16x32_bf16 v[76:79], a[16:19], v[224:227], v[76:79]
  s_waitcnt vmcnt(0)
  v_cmp_lt_u32 vcc, v128, v134
  s_nop 0
  s_cbranch_vccz tail_partner
  s_mov_b32 s35, 32768
tail_spin2:
  s_sleep 2
  buffer_load_dword v128, v133, s[24:27], 0 offen sc1
  s_waitcnt vmcnt(0)
  v_cmp_lt_u32 vcc, v128, v134
  s_nop 0
  s_cbranch_vccz tail_partner
  s_sub_u32 s35, s35, 1
  s_cmp_lg_u32 s35, 0
  s_cbranch_scc1 tail_spin2
tail_partner:
  s_waitcnt lgkmcnt(0)
  v_mfma_f32_16x16x32_bf16 v[0:3], a[216:219], v[228:231], v[0:3]
  ds_read_b128 a[232:235], v122 offset:15360
  ds_read_b128 a[220:223], v122 offset:20480
  v_mfma_f32_16x16x32_bf16 v[0:3], a[228:231], v[248:251], v[0:3]
  buffer_load_dwordx4 v[136:139], v114, s[24:27], s38 offen offset:0 sc1
  v_mfma_f32_16x16x32_bf16 v[4:7], a[228:231], v[252:255], v[4:7]
  buffer_load_dwordx4 v[140:143], v114, s[24:27], s38 offen offset:1024 sc1
  v_mfma_f32_16x16x32_bf16 v[4:7], a[216:219], v[232:235], v[4:7]
  buffer_load_dwordx4 v[144:147], v114, s[24:27], s38 offen offset:2048 sc1
  v_mfma_f32_16x16x32_bf16 v[8:11], a[216:219], a[184:187], v[8:11]
  buffer_load_dwordx4 v[148:151], v114, s[24:27], s38 offen offset:3072 sc1
  v_mfma_f32_16x16x32_bf16 v[8:11], a[228:231], a[188:191], v[8:11]
  buffer_load_dwordx4 v[152:155], v114, s[24:27], s39 offen offset:0 sc1
  v_mfma_f32_16x16x32_bf16 v[12:15], a[228:231], a[164:167], v[12:15]
  v_mfma_f32_16x16x32_bf16 v[12:15], a[216:219], a[192:195], v[12:15]
  s_waitcnt lgkmcnt(0)
  v_mfma_f32_16x16x32_bf16 v[16:19], a[232:235], v[228:231], v[16:19]
  ds_read_b128 a[224:227], v122 offset:16384
  ds_read_b128 a[196:199], v122 offset:21504
  v_mfma_f32_16x16x32_bf16 v[16:19], a[220:223], v[248:251], v[16:19]
  v_mfma_f32_16x16x32_bf16 v[20:23], a[220:223], v[252:255], v[20:23]
  v_mfma_f32_16x16x32_bf16 v[20:23], a[232:235], v[232:235], v[20:23]
  v_mfma_f32_16x16x32_bf16 v[24:27], a[232:235], a[184:187], v[24:27]
  v_mfma_f32_16x16x32_bf16 v[24:27], a[220:223], a[188:191], v[24:27]
  v_mfma_f32_16x16x32_bf16 v[28:31], a[220:223], a[164:167], v[28:31]
  v_mfma_f32_16x16x32_bf16 v[28:31], a[232:235], a[192:195], v[28:31]
  s_waitcnt lgkmcnt(0)
  v_mfma_f32_16x16x32_bf16 v[32:35], a[224:227], v[228:231], v[32:35]
  ds_read_b128 a[200:203], v122 offset:17408
  ds_read_b128 a[40:43], v122 offset:22528
  v_mfma_f32_16x16x32_bf16 v[32:35], a[196:199], v[248:251], v[32:35]
  v_mfma_f32_16x16x32_bf16 v[36:39], a[196:199], v[252:255], v[36:39]
  v_mfma_f32_16x16x32_bf16 v[36:39], a[224:227], v[232:235], v[36:39]
  v_mfma_f32_16x16x32_bf16 v[40:43], a[224:227], a[184:187], v[40:43]
  v_mfma_f32_16x16x32_bf16 v[40:43], a[196:199], a[188:191], v[40:43]
  v_mfma_f32_16x16x32_bf16 v[44:47], a[196:199], a[164:167], v[44:47]
  v_mfma_f32_16x16x32_bf16 v[44:47], a[224:227], a[192:195], v[44:47]
  s_waitcnt lgkmcnt(0)
  v_mfma_f32_16x16x32_bf16 v[48:51], a[200:203], v[228:231], v[48:51]
  ds_read_b128 a[60:63], v122 offset:18432
  ds_read_b128 a[44:47], v122 offset:23552
  v_mfma_f32_16x16x32_bf16 v[48:51], a[40:43], v[248:251], v[48:51]
  v_mfma_f32_16x16x32_bf16 v[52:55], a[40:43], v[252:255], v[52:55]
  v_mfma_f32_16x16x32_bf16 v[52:55], a[200:203], v[232:235], v[52:55]
  v_mfma_f32_16x16x32_bf16 v[56:59], a[200:203], a[184:187], v[56:59]
  v_mfma_f32_16x16x32_bf16 v[56:59], a[40:43], a[188:191], v[56:59]
  v_mfma_f32_16x16x32_bf16 v[60:63], a[40:43], a[164:167], v[60:63]
  v_mfma_f32_16x16x32_bf16 v[60:63], a[200:203], a[192:195], v[60:63]
  s_waitcnt lgkmcnt(0)
  v_mfma_f32_16x16x32_bf16 v[64:67], a[60:63], v[228:231], v[64:67]
  v_mfma_f32_16x16x32_bf16 v[64:67], a[44:47], v[248:251], v[64:67]
  v_mfma_f32_16x16x32_bf16 v[68:71], a[44:47], v[252:255], v[68:71]
  v_mfma_f32_16x16x32_bf16 v[68:71], a[60:63], v[232:235], v[68:71]
  v_mfma_f32_16x16x32_bf16 v[72:75], a[60:63], a[184:187], v[72:75]
  v_mfma_f32_16x16x32_bf16 v[72:75], a[44:47], a[188:191], v[72:75]
  v_mfma_f32_16x16x32_bf16 v[76:79], a[44:47], a[164:167], v[76:79]
  v_mfma_f32_16x16x32_bf16 v[76:79], a[60:63], a[192:195], v[76:79]
  ds_write_b128 v118, v[4:7] offset:0
  ds_write_b128 v118, v[20:23] offset:1024
  ds_write_b128 v118, v[36:39] offset:2048
  ds_write_b128 v118, v[52:55] offset:3072
  ds_write_b128 v118, v[68:71] offset:4096
  ds_write_b128 v118, v[8:11] offset:5120
  ds_write_b128 v118, v[24:27] offset:6144
  ds_write_b128 v118, v[40:43] offset:7168
  ds_write_b128 v118, v[56:59] offset:8192
  ds_write_b128 v118, v[72:75] offset:9216
  ds_write_b128 v118, v[12:15] offset:10240
  ds_write_b128 v118, v[28:31] offset:11264
  ds_write_b128 v118, v[44:47] offset:12288
  ds_write_b128 v118, v[60:63] offset:13312
  ds_write_b128 v118, v[76:79] offset:14336
  s_waitcnt lgkmcnt(0)
  s_barrier
  ds_read_b128 v[4:7], v119 offset:0
  ds_read_b128 v[8:11], v120 offset:0
  ds_read_b128 v[12:15], v121 offset:0
  ds_read_b128 v[20:23], v119 offset:1024
  ds_read_b128 v[24:27], v120 offset:1024
  ds_read_b128 v[28:31], v121 offset:1024
  ds_read_b128 v[36:39], v119 offset:2048
  ds_read_b128 v[40:43], v120 offset:2048
  ds_read_b128 v[44:47], v121 offset:2048
  ds_read_b128 v[52:55], v119 offset:3072
  ds_read_b128 v[56:59], v120 offset:3072
  ds_read_b128 v[60:63], v121 offset:3072
  ds_read_b128 v[68:71], v119 offset:4096
  ds_read_b128 v[72:75], v120 offset:4096
  ds_read_b128 v[76:79], v121 offset:4096
  s_waitcnt lgkmcnt(13)
  v_add_f32 v4, v4, v8
  v_add_f32 v5, v5, v9
  v_add_f32 v6, v6, v10
  v_add_f32 v7, v7, v11
  s_waitcnt lgkmcnt(12)
  v_add_f32 v0, v0, v12
  v_add_f32 v1, v1, v13
  v_add_f32 v2, v2, v14
  v_add_f32 v3, v3, v15
  s_waitcnt vmcnt(4)
  v_add_f32 v4, v4, v136
  v_add_f32 v5, v5, v137
  v_add_f32 v6, v6, v138
  v_add_f32 v7, v7, v139
  v_add_f32 v0, v0, v4
  v_add_f32 v1, v1, v5
  v_add_f32 v2, v2, v6
  v_add_f32 v3, v3, v7
  v_cvt_pk_bf16_f32 v4, v0, v1
  v_cvt_pk_bf16_f32 v5, v2, v3
  v_lshlrev_b32 v0, 16, v4
  v_and_b32 v1, s34, v4
  v_lshlrev_b32 v2, 16, v5
  v_and_b32 v3, s34, v5
  v_mul_f32 v0, v0, v90
  v_mul_f32 v1, v1, v91
  v_mul_f32 v2, v2, v92
  v_mul_f32 v3, v3, v93
  v_cvt_pk_bf16_f32 v4, v0, v1
  v_cvt_pk_bf16_f32 v5, v2, v3
  v_lshlrev_b32 v0, 16, v4
  v_and_b32 v1, s34, v4
  v_lshlrev_b32 v2, 16, v5
  v_and_b32 v3, s34, v5
  v_add_f32 v0, v0, v156
  v_add_f32 v1, v1, v157
  v_add_f32 v2, v2, v158
  v_add_f32 v3, v3, v159
  v_cvt_pk_bf16_f32 v4, v0, v1
  v_cvt_pk_bf16_f32 v5, v2, v3
  buffer_store_dwordx2 v[4:5], v117, s[16:19], 0 offen offset:0
  s_waitcnt lgkmcnt(10)
  v_add_f32 v20, v20, v24
  v_add_f32 v21, v21, v25
  v_add_f32 v22, v22, v26
  v_add_f32 v23, v23, v27
  s_waitcnt lgkmcnt(9)
  v_add_f32 v16, v16, v28
  v_add_f32 v17, v17, v29
  v_add_f32 v18, v18, v30
  v_add_f32 v19, v19, v31
  s_waitcnt vmcnt(4)
  v_add_f32 v20, v20, v140
  v_add_f32 v21, v21, v141
  v_add_f32 v22, v22, v142
  v_add_f32 v23, v23, v143
  v_add_f32 v16, v16, v20
  v_add_f32 v17, v17, v21
  v_add_f32 v18, v18, v22
  v_add_f32 v19, v19, v23
  v_cvt_pk_bf16_f32 v20, v16, v17
  v_cvt_pk_bf16_f32 v21, v18, v19
  v_lshlrev_b32 v16, 16, v20
  v_and_b32 v17, s34, v20
  v_lshlrev_b32 v18, 16, v21
  v_and_b32 v19, s34, v21
  v_mul_f32 v16, v16, v94
  v_mul_f32 v17, v17, v95
  v_mul_f32 v18, v18, v96
  v_mul_f32 v19, v19, v97
  v_cvt_pk_bf16_f32 v20, v16, v17
  v_cvt_pk_bf16_f32 v21, v18, v19
  v_lshlrev_b32 v16, 16, v20
  v_and_b32 v17, s34, v20
  v_lshlrev_b32 v18, 16, v21
  v_and_b32 v19, s34, v21
  v_add_f32 v16, v16, v160
  v_add_f32 v17, v17, v161
  v_add_f32 v18, v18, v162
  v_add_f32 v19, v19, v163
  v_cvt_pk_bf16_f32 v20, v16, v17
  v_cvt_pk_bf16_f32 v21, v18, v19
  buffer_store_dwordx2 v[20:21], v117, s[16:19], 0 offen offset:32
  s_waitcnt lgkmcnt(7)
  v_add_f32 v36, v36, v40
  v_add_f32 v37, v37, v41
  v_add_f32 v38, v38, v42
  v_add_f32 v39, v39, v43
  s_waitcnt lgkmcnt(6)
  v_add_f32 v32, v32, v44
  v_add_f32 v33, v33, v45
  v_add_f32 v34, v34, v46
  v_add_f32 v35, v35, v47
  s_waitcnt vmcnt(4)
  v_add_f32 v36, v36, v144
  v_add_f32 v37, v37, v145
  v_add_f32 v38, v38, v146
  v_add_f32 v39, v39, v147
  v_add_f32 v32, v32, v36
  v_add_f32 v33, v33, v37
  v_add_f32 v34, v34, v38
  v_add_f32 v35, v35, v39
  v_cvt_pk_bf16_f32 v36, v32, v33
  v_cvt_pk_bf16_f32 v37, v34, v35
  v_lshlrev_b32 v32, 16, v36
  v_and_b32 v33, s34, v36
  v_lshlrev_b32 v34, 16, v37
  v_and_b32 v35, s34, v37
  v_mul_f32 v32, v32, v98
  v_mul_f32 v33, v33, v99
  v_mul_f32 v34, v34, v100
  v_mul_f32 v35, v35, v101
  v_cvt_pk_bf16_f32 v36, v32, v33
  v_cvt_pk_bf16_f32 v37, v34, v35
  v_lshlrev_b32 v32, 16, v36
  v_and_b32 v33, s34, v36
  v_lshlrev_b32 v34, 16, v37
  v_and_b32 v35, s34, v37
  v_add_f32 v32, v32, v164
  v_add_f32 v33, v33, v165
  v_add_f32 v34, v34, v166
  v_add_f32 v35, v35, v167
  v_cvt_pk_bf16_f32 v36, v32, v33
  v_cvt_pk_bf16_f32 v37, v34, v35
  buffer_store_dwordx2 v[36:37], v117, s[16:19], 0 offen offset:64
  s_waitcnt lgkmcnt(4)
  v_add_f32 v52, v52, v56
  v_add_f32 v53, v53, v57
  v_add_f32 v54, v54, v58
  v_add_f32 v55, v55, v59
  s_waitcnt lgkmcnt(3)
  v_add_f32 v48, v48, v60
  v_add_f32 v49, v49, v61
  v_add_f32 v50, v50, v62
  v_add_f32 v51, v51, v63
  s_waitcnt vmcnt(4)
  v_add_f32 v52, v52, v148
  v_add_f32 v53, v53, v149
  v_add_f32 v54, v54, v150
  v_add_f32 v55, v55, v151
  v_add_f32 v48, v48, v52
  v_add_f32 v49, v49, v53
  v_add_f32 v50, v50, v54
  v_add_f32 v51, v51, v55
  v_cvt_pk_bf16_f32 v52, v48, v49
  v_cvt_pk_bf16_f32 v53, v50, v51
  v_lshlrev_b32 v48, 16, v52
  v_and_b32 v49, s34, v52
  v_lshlrev_b32 v50, 16, v53
  v_and_b32 v51, s34, v53
  v_mul_f32 v48, v48, v102
  v_mul_f32 v49, v49, v103
  v_mul_f32 v50, v50, v104
  v_mul_f32 v51, v51, v105
  v_cvt_pk_bf16_f32 v52, v48, v49
  v_cvt_pk_bf16_f32 v53, v50, v51
  v_lshlrev_b32 v48, 16, v52
  v_and_b32 v49, s34, v52
  v_lshlrev_b32 v50, 16, v53
  v_and_b32 v51, s34, v53
  v_add_f32 v48, v48, v168
  v_add_f32 v49, v49, v169
  v_add_f32 v50, v50, v170
  v_add_f32 v51, v51, v171
  v_cvt_pk_bf16_f32 v52, v48, v49
  v_cvt_pk_bf16_f32 v53, v50, v51
  buffer_store_dwordx2 v[52:53], v117, s[16:19], 0 offen offset:96
  s_waitcnt lgkmcnt(1)
  v_add_f32 v68, v68, v72
  v_add_f32 v69, v69, v73
  v_add_f32 v70, v70, v74
  v_add_f32 v71, v71, v75
  s_waitcnt lgkmcnt(0)
  v_add_f32 v64, v64, v76
  v_add_f32 v65, v65, v77
  v_add_f32 v66, v66, v78
  v_add_f32 v67, v67, v79
  s_waitcnt vmcnt(4)
  v_add_f32 v68, v68, v152
  v_add_f32 v69, v69, v153
  v_add_f32 v70, v70, v154
  v_add_f32 v71, v71, v155
  v_add_f32 v64, v64, v68
  v_add_f32 v65, v65, v69
  v_add_f32 v66, v66, v70
  v_add_f32 v67, v67, v71
  v_cvt_pk_bf16_f32 v68, v64, v65
  v_cvt_pk_bf16_f32 v69, v66, v67
  v_lshlrev_b32 v64, 16, v68
  v_and_b32 v65, s34, v68
  v_lshlrev_b32 v66, 16, v69
  v_and_b32 v67, s34, v69
  v_mul_f32 v64, v64, v106
  v_mul_f32 v65, v65, v107
  v_mul_f32 v66, v66, v108
  v_mul_f32 v67, v67, v109
  v_cvt_pk_bf16_f32 v68, v64, v65
  v_cvt_pk_bf16_f32 v69, v66, v67
  v_lshlrev_b32 v64, 16, v68
  v_and_b32 v65, s34, v68
  v_lshlrev_b32 v66, 16, v69
  v_and_b32 v67, s34, v69
  v_add_f32 v64, v64, v172
  v_add_f32 v65, v65, v173
  v_add_f32 v66, v66, v174
  v_add_f32 v67, v67, v175
  v_cvt_pk_bf16_f32 v68, v64, v65
  v_cvt_pk_bf16_f32 v69, v66, v67
  buffer_store_dwordx2 v[68:69], v117, s[16:19], 0 offen offset:128
attn_end:
  s_endpgm
attn_redo:
  s_waitcnt vmcnt(0)
  v_accvgpr_write_b32 a0, 0
  v_accvgpr_write_b32 a1, 0
  v_accvgpr_write_b32 a2, 0
  v_accvgpr_write_b32 a3, 0
  v_accvgpr_write_b32 a4, 0
  v_accvgpr_write_b32 a5, 0
  v_accvgpr_write_b32 a6, 0
  v_accvgpr_write_b32 a7, 0
  v_accvgpr_write_b32 a8, 0
  v_accvgpr_write_b32 a9, 0
  v_accvgpr_write_b32 a10, 0
  v_accvgpr_write_b32 a11, 0
  v_accvgpr_write_b32 a12, 0
  v_accvgpr_write_b32 a13, 0
  v_accvgpr_write_b32 a14, 0
  v_accvgpr_write_b32 a15, 0
  v_accvgpr_write_b32 a16, 0
  v_accvgpr_write_b32 a17, 0
  v_accvgpr_write_b32 a18, 0
  v_accvgpr_write_b32 a19, 0
  v_accvgpr_write_b32 a20, 0
  v_accvgpr_write_b32 a21, 0
  v_accvgpr_write_b32 a22, 0
  v_accvgpr_write_b32 a23, 0
  v_accvgpr_write_b32 a24, 0
  v_accvgpr_write_b32 a25, 0
  v_accvgpr_write_b32 a26, 0
  v_accvgpr_write_b32 a27, 0
  v_accvgpr_write_b32 a28, 0
  v_accvgpr_write_b32 a29, 0
  v_accvgpr_write_b32 a30, 0
  v_accvgpr_write_b32 a31, 0
  v_accvgpr_write_b32 a32, 0
  v_accvgpr_write_b32 a33, 0
  v_accvgpr_write_b32 a34, 0
  v_accvgpr_write_b32 a35, 0
  v_accvgpr_write_b32 a36, 0
  v_accvgpr_write_b32 a37, 0
  v_accvgpr_write_b32 a38, 0
  v_accvgpr_write_b32 a39, 0
  v_accvgpr_write_b32 a40, 0
  v_accvgpr_write_b32 a41, 0
  v_accvgpr_write_b32 a42, 0
  v_accvgpr_write_b32 a43, 0
  v_accvgpr_write_b32 a44, 0
  v_accvgpr_write_b32 a45, 0
  v_accvgpr_write_b32 a46, 0
  v_accvgpr_write_b32 a47, 0
  v_accvgpr_write_b32 a48, 0
  v_accvgpr_write_b32 a49, 0
  v_accvgpr_write_b32 a50, 0
  v_accvgpr_write_b32 a51, 0
  v_accvgpr_write_b32 a52, 0
  v_accvgpr_write_b32 a53, 0
  v_accvgpr_write_b32 a54, 0
  v_accvgpr_write_b32 a55, 0
  v_accvgpr_write_b32 a56, 0
  v_accvgpr_write_b32 a57, 0
  v_accvgpr_write_b32 a58, 0
  v_accvgpr_write_b32 a59, 0
  v_accvgpr_write_b32 a60, 0
  v_accvgpr_write_b32 a61, 0
  v_accvgpr_write_b32 a62, 0
  v_accvgpr_write_b32 a63, 0
  v_accvgpr_write_b32 a64, 0
  v_accvgpr_write_b32 a65, 0
  v_accvgpr_write_b32 a66, 0
  v_accvgpr_write_b32 a67, 0
  v_accvgpr_write_b32 a68, 0
  v_accvgpr_write_b32 a69, 0
  v_accvgpr_write_b32 a70, 0
  v_accvgpr_write_b32 a71, 0
  v_accvgpr_write_b32 a72, 0
  v_accvgpr_write_b32 a73, 0
  v_accvgpr_write_b32 a74, 0
  v_accvgpr_write_b32 a75, 0
  v_accvgpr_write_b32 a76, 0
  v_accvgpr_write_b32 a77, 0
  v_accvgpr_write_b32 a78, 0
  v_accvgpr_write_b32 a79, 0
  v_accvgpr_write_b32 a80, 0
  v_accvgpr_write_b32 a81, 0
  v_accvgpr_write_b32 a82, 0
  v_accvgpr_write_b32 a83, 0
  v_accvgpr_write_b32 a84, 0
  v_accvgpr_write_b32 a85, 0
  v_accvgpr_write_b32 a86, 0
  v_accvgpr_write_b32 a87, 0
  v_accvgpr_write_b32 a88, 0
  v_accvgpr_write_b32 a89, 0
  v_accvgpr_write_b32 a90, 0
  v_accvgpr_write_b32 a91, 0
  v_accvgpr_write_b32 a92, 0
  v_accvgpr_write_b32 a93, 0
  v_accvgpr_write_b32 a94, 0
  v_accvgpr_write_b32 a95, 0
  v_accvgpr_write_b32 a96, 0
  v_accvgpr_write_b32 a97, 0
  v_accvgpr_write_b32 a98, 0
  v_accvgpr_write_b32 a99, 0
  v_accvgpr_write_b32 a100, 0
  v_accvgpr_write_b32 a101, 0
  v_accvgpr_write_b32 a102, 0
  v_accvgpr_write_b32 a103, 0
  v_accvgpr_write_b32 a104, 0
  v_accvgpr_write_b32 a105, 0
  v_accvgpr_write_b32 a106, 0
  v_accvgpr_write_b32 a107, 0
  v_accvgpr_write_b32 a108, 0
  v_accvgpr_write_b32 a109, 0
  v_accvgpr_write_b32 a110, 0
  v_accvgpr_write_b32 a111, 0
  v_accvgpr_write_b32 a112, 0
  v_accvgpr_write_b32 a113, 0
  v_accvgpr_write_b32 a114, 0
  v_accvgpr_write_b32 a115, 0
  v_accvgpr_write_b32 a116, 0
  v_accvgpr_write_b32 a117, 0
  v_accvgpr_write_b32 a118, 0
  v_accvgpr_write_b32 a119, 0
  v_accvgpr_write_b32 a120, 0
  v_accvgpr_write_b32 a121, 0
  v_accvgpr_write_b32 a122, 0
  v_accvgpr_write_b32 a123, 0
  v_accvgpr_write_b32 a124, 0
  v_accvgpr_write_b32 a125, 0
  v_accvgpr_write_b32 a126, 0
  v_accvgpr_write_b32 a127, 0
  v_mov_b32 v208, 0
  v_mov_b32 v249, 0xff800000
  v_mov_b32 v209, 0
  v_mov_b32 v250, 0xff800000
  v_mov_b32 v210, 0
  v_mov_b32 v251, 0xff800000
  v_mov_b32 v211, 0
  v_mov_b32 v252, 0xff800000
  s_mov_b32 s29, 0
attn_slow:
  s_barrier
  s_add_u32 m0, s28, 0
  s_nop 0
  buffer_load_dwordx4 v232, s[12:15], s29 offen offset:0 lds
  buffer_load_dwordx4 v233, s[12:15], s29 offen offset:1024 lds
  buffer_load_dwordx4 v234, s[12:15], s29 offen offset:2048 lds
  buffer_load_dwordx4 v235, s[12:15], s29 offen offset:3072 lds
  s_add_u32 m0, s28, 65536
  s_nop 0
  buffer_load_dwordx4 v236, s[16:19], s29 offen offset:0 lds
  buffer_load_dwordx4 v237, s[16:19], s29 offen offset:1024 lds
  buffer_load_dwordx4 v236, s[16:19], s29 offen offset:2048 lds
  buffer_load_dwordx4 v237, s[16:19], s29 offen offset:3072 lds
  s_waitcnt vmcnt(0)
  s_barrier
  ds_read_b128 a[128:131], v212 offset:0
  ds_read_b128 a[132:135], v213 offset:0
  ds_read_b128 a[136:139], v214 offset:0
  ds_read_b128 a[140:143], v215 offset:0
  s_waitcnt lgkmcnt(3)
  v_mfma_f32_16x16x32_bf16 v[0:3], a[128:131], v[128:131], 0
  s_waitcnt lgkmcnt(2)
  v_mfma_f32_16x16x32_bf16 v[0:3], a[132:135], v[132:135], v[0:3]
  s_waitcnt lgkmcnt(1)
  v_mfma_f32_16x16x32_bf16 v[0:3], a[136:139], v[136:139], v[0:3]
  s_waitcnt lgkmcnt(0)
  v_mfma_f32_16x16x32_bf16 v[0:3], a[140:143], v[140:143], v[0:3]
  v_mfma_f32_16x16x32_bf16 v[8:11], a[140:143], v[156:159], 0
  v_mfma_f32_16x16x32_bf16 v[8:11], a[136:139], v[152:155], v[8:11]
  v_mfma_f32_16x16x32_bf16 v[8:11], a[132:135], v[148:151], v[8:11]
  v_mfma_f32_16x16x32_bf16 v[8:11], a[128:131], v[144:147], v[8:11]
  v_mfma_f32_16x16x32_bf16 v[16:19], a[128:131], v[160:163], 0
  v_mfma_f32_16x16x32_bf16 v[16:19], a[132:135], v[164:167], v[16:19]
  v_mfma_f32_16x16x32_bf16 v[16:19], a[136:139], v[168:171], v[16:19]
  v_mfma_f32_16x16x32_bf16 v[16:19], a[140:143], v[172:175], v[16:19]
  v_mfma_f32_16x16x32_bf16 v[24:27], a[140:143], v[188:191], 0
  v_mfma_f32_16x16x32_bf16 v[24:27], a[136:139], v[184:187], v[24:27]
  v_mfma_f32_16x16x32_bf16 v[24:27], a[132:135], v[180:183], v[24:27]
  v_mfma_f32_16x16x32_bf16 v[24:27], a[128:131], v[176:179], v[24:27]
  ds_read_b128 a[144:147], v212 offset:4096
  ds_read_b128 a[148:151], v213 offset:4096
  ds_read_b128 a[152:155], v214 offset:4096
  ds_read_b128 a[156:159], v215 offset:4096
  s_waitcnt lgkmcnt(3)
  v_mfma_f32_16x16x32_bf16 v[4:7], a[144:147], v[128:131], 0
  s_waitcnt lgkmcnt(2)
  v_mfma_f32_16x16x32_bf16 v[4:7], a[148:151], v[132:135], v[4:7]
  s_waitcnt lgkmcnt(1)
  v_mfma_f32_16x16x32_bf16 v[4:7], a[152:155], v[136:139], v[4:7]
  s_waitcnt lgkmcnt(0)
  v_mfma_f32_16x16x32_bf16 v[4:7], a[156:159], v[140:143], v[4:7]
  v_mfma_f32_16x16x32_bf16 v[12:15], a[156:159], v[156:159], 0
  v_mfma_f32_16x16x32_bf16 v[12:15], a[152:155], v[152:155], v[12:15]
  v_mfma_f32_16x16x32_bf16 v[12:15], a[148:151], v[148:151], v[12:15]
  v_mfma_f32_16x16x32_bf16 v[12:15], a[144:147], v[144:147], v[12:15]
  v_mfma_f32_16x16x32_bf16 v[20:23], a[144:147], v[160:163], 0
  v_mfma_f32_16x16x32_bf16 v[20:23], a[148:151], v[164:167], v[20:23]
  v_mfma_f32_16x16x32_bf16 v[20:23], a[152:155], v[168:171], v[20:23]
  v_mfma_f32_16x16x32_bf16 v[20:23], a[156:159], v[172:175], v[20:23]
  v_mfma_f32_16x16x32_bf16 v[28:31], a[156:159], v[188:191], 0
  v_mfma_f32_16x16x32_bf16 v[28:31], a[152:155], v[184:187], v[28:31]
  v_mfma_f32_16x16x32_bf16 v[28:31], a[148:151], v[180:183], v[28:31]
  v_mfma_f32_16x16x32_bf16 v[28:31], a[144:147], v[176:179], v[28:31]
  ds_read_b128 a[128:131], v212 offset:8192
  ds_read_b128 a[132:135], v213 offset:8192
  ds_read_b128 a[136:139], v214 offset:8192
  ds_read_b128 a[140:143], v215 offset:8192
  s_waitcnt lgkmcnt(3)
  v_mfma_f32_16x16x32_bf16 v[32:35], a[128:131], v[128:131], 0
  s_waitcnt lgkmcnt(2)
  v_mfma_f32_16x16x32_bf16 v[32:35], a[132:135], v[132:135], v[32:35]
  s_waitcnt lgkmcnt(1)
  v_mfma_f32_16x16x32_bf16 v[32:35], a[136:139], v[136:139], v[32:35]
  s_waitcnt lgkmcnt(0)
  v_mfma_f32_16x16x32_bf16 v[32:35], a[140:143], v[140:143], v[32:35]
  v_mfma_f32_16x16x32_bf16 v[40:43], a[140:143], v[156:159], 0
  v_mfma_f32_16x16x32_bf16 v[40:43], a[136:139], v[152:155], v[40:43]
  v_mfma_f32_16x16x32_bf16 v[40:43], a[132:135], v[148:151], v[40:43]
  v_mfma_f32_16x16x32_bf16 v[40:43], a[128:131], v[144:147], v[40:43]
  v_mfma_f32_16x16x32_bf16 v[48:51], a[128:131], v[160:163], 0
  v_mfma_f32_16x16x32_bf16 v[48:51], a[132:135], v[164:167], v[48:51]
  v_mfma_f32_16x16x32_bf16 v[48:51], a[136:139], v[168:171], v[48:51]
  v_mfma_f32_16x16x32_bf16 v[48:51], a[140:143], v[172:175], v[48:51]
  v_mfma_f32_16x16x32_bf16 v[56:59], a[140:143], v[188:191], 0
  v_mfma_f32_16x16x32_bf16 v[56:59], a[136:139], v[184:187], v[56:59]
  v_mfma_f32_16x16x32_bf16 v[56:59], a[132:135], v[180:183], v[56:59]
  v_mfma_f32_16x16x32_bf16 v[56:59], a[128:131], v[176:179], v[56:59]
  ds_read_b128 a[144:147], v212 offset:12288
  ds_read_b128 a[148:151], v213 offset:12288
  ds_read_b128 a[152:155], v214 offset:12288
  ds_read_b128 a[156:159], v215 offset:12288
  s_waitcnt lgkmcnt(3)
  v_mfma_f32_16x16x32_bf16 v[36:39], a[144:147], v[128:131], 0
  s_waitcnt lgkmcnt(2)
  v_mfma_f32_16x16x32_bf16 v[36:39], a[148:151], v[132:135], v[36:39]
  s_waitcnt lgkmcnt(1)
  v_mfma_f32_16x16x32_bf16 v[36:39], a[152:155], v[136:139], v[36:39]
  s_waitcnt lgkmcnt(0)
  v_mfma_f32_16x16x32_bf16 v[36:39], a[156:159], v[140:143], v[36:39]
  v_mfma_f32_16x16x32_bf16 v[44:47], a[156:159], v[156:159], 0
  v_mfma_f32_16x16x32_bf16 v[44:47], a[152:155], v[152:155], v[44:47]
  v_mfma_f32_16x16x32_bf16 v[44:47], a[148:151], v[148:151], v[44:47]
  v_mfma_f32_16x16x32_bf16 v[44:47], a[144:147], v[144:147], v[44:47]
  v_mfma_f32_16x16x32_bf16 v[52:55], a[144:147], v[160:163], 0
  v_mfma_f32_16x16x32_bf16 v[52:55], a[148:151], v[164:167], v[52:55]
  v_mfma_f32_16x16x32_bf16 v[52:55], a[152:155], v[168:171], v[52:55]
  v_mfma_f32_16x16x32_bf16 v[52:55], a[156:159], v[172:175], v[52:55]
  v_mfma_f32_16x16x32_bf16 v[60:63], a[156:159], v[188:191], 0
  v_mfma_f32_16x16x32_bf16 v[60:63], a[152:155], v[184:187], v[60:63]
  v_mfma_f32_16x16x32_bf16 v[60:63], a[148:151], v[180:183], v[60:63]
  v_mfma_f32_16x16x32_bf16 v[60:63], a[144:147], v[176:179], v[60:63]
  v_mov_b32 v192, v249
  v_max3_f32 v192, v192, v0, v1
  v_max3_f32 v192, v192, v2, v3
  v_max3_f32 v192, v192, v4, v5
  v_max3_f32 v192, v192, v6, v7
  v_max3_f32 v192, v192, v32, v33
  v_max3_f32 v192, v192, v34, v35
  v_max3_f32 v192, v192, v36, v37
  v_max3_f32 v192, v192, v38, v39
  v_mov_b32 v245, v192
  s_nop 1
  v_permlane16_swap_b32 v192, v245
  v_max_f32 v192, v192, v245
  v_mov_b32 v245, v192
  s_nop 1
  v_permlane32_swap_b32 v192, v245
  v_max_f32 v192, v192, v245
  v_sub_f32 v193, v249, v192
  v_exp_f32 v193, v193
  v_mov_b32 v249, v192
  v_mul_f32 v208, v208, v193
  v_sub_f32 v0, v0, v192
  v_sub_f32 v1, v1, v192
  v_sub_f32 v2, v2, v192
  v_sub_f32 v3, v3, v192
  v_sub_f32 v4, v4, v192
  v_sub_f32 v5, v5, v192
  v_sub_f32 v6, v6, v192
  v_sub_f32 v7, v7, v192
  v_sub_f32 v32, v32, v192
  v_sub_f32 v33, v33, v192
  v_sub_f32 v34, v34, v192
  v_sub_f32 v35, v35, v192
  v_sub_f32 v36, v36, v192
  v_sub_f32 v37, v37, v192
  v_sub_f32 v38, v38, v192
  v_sub_f32 v39, v39, v192
  v_exp_f32 v0, v0
  v_exp_f32 v1, v1
  v_add_f32 v208, v208, v0
  v_exp_f32 v2, v2
  v_add_f32 v208, v208, v1
  v_cvt_pk_bf16_f32 v0, v0, v1
  v_exp_f32 v3, v3
  v_add_f32 v208, v208, v2
  v_add_f32 v208, v208, v3
  v_cvt_pk_bf16_f32 v1, v2, v3
  v_exp_f32 v4, v4
  v_exp_f32 v5, v5
  v_add_f32 v208, v208, v4
  v_exp_f32 v6, v6
  v_add_f32 v208, v208, v5
  v_cvt_pk_bf16_f32 v2, v4, v5
  v_exp_f32 v7, v7
  v_add_f32 v208, v208, v6
  v_add_f32 v208, v208, v7
  v_cvt_pk_bf16_f32 v3, v6, v7
  v_exp_f32 v32, v32
  v_exp_f32 v33, v33
  v_add_f32 v208, v208, v32
  v_exp_f32 v34, v34
  v_add_f32 v208, v208, v33
  v_cvt_pk_bf16_f32 v32, v32, v33
  v_exp_f32 v35, v35
  v_add_f32 v208, v208, v34
  v_add_f32 v208, v208, v35
  v_cvt_pk_bf16_f32 v33, v34, v35
  v_exp_f32 v36, v36
  v_exp_f32 v37, v37
  v_add_f32 v208, v208, v36
  v_exp_f32 v38, v38
  v_add_f32 v208, v208, v37
  v_cvt_pk_bf16_f32 v34, v36, v37
  v_exp_f32 v39, v39
  v_add_f32 v208, v208, v38
  v_add_f32 v208, v208, v39
  v_cvt_pk_bf16_f32 v35, v38, v39
  v_accvgpr_read_b32 v64, a0
  v_accvgpr_read_b32 v65, a1
  v_accvgpr_read_b32 v66, a2
  v_accvgpr_read_b32 v67, a3
  v_mul_f32 v64, v64, v193
  v_mul_f32 v65, v65, v193
  v_mul_f32 v66, v66, v193
  v_mul_f32 v67, v67, v193
  v_accvgpr_write_b32 a0, v64
  v_accvgpr_write_b32 a1, v65
  v_accvgpr_write_b32 a2, v66
  v_accvgpr_write_b32 a3, v67
  v_accvgpr_read_b32 v64, a16
  v_accvgpr_read_b32 v65, a17
  v_accvgpr_read_b32 v66, a18
  v_accvgpr_read_b32 v67, a19
  v_mul_f32 v64, v64, v193
  v_mul_f32 v65, v65, v193
  v_mul_f32 v66, v66, v193
  v_mul_f32 v67, v67, v193
  v_accvgpr_write_b32 a16, v64
  v_accvgpr_write_b32 a17, v65
  v_accvgpr_write_b32 a18, v66
  v_accvgpr_write_b32 a19, v67
  v_accvgpr_read_b32 v64, a32
  v_accvgpr_read_b32 v65, a33
  v_accvgpr_read_b32 v66, a34
  v_accvgpr_read_b32 v67, a35
  v_mul_f32 v64, v64, v193
  v_mul_f32 v65, v65, v193
  v_mul_f32 v66, v66, v193
  v_mul_f32 v67, v67, v193
  v_accvgpr_write_b32 a32, v64
  v_accvgpr_write_b32 a33, v65
  v_accvgpr_write_b32 a34, v66
  v_accvgpr_write_b32 a35, v67
  v_accvgpr_read_b32 v64, a48
  v_accvgpr_read_b32 v65, a49
  v_accvgpr_read_b32 v66, a50
  v_accvgpr_read_b32 v67, a51
  v_mul_f32 v64, v64, v193
  v_mul_f32 v65, v65, v193
  v_mul_f32 v66, v66, v193
  v_mul_f32 v67, v67, v193
  v_accvgpr_write_b32 a48, v64
  v_accvgpr_write_b32 a49, v65
  v_accvgpr_write_b32 a50, v66
  v_accvgpr_write_b32 a51, v67
  v_accvgpr_read_b32 v64, a64
  v_accvgpr_read_b32 v65, a65
  v_accvgpr_read_b32 v66, a66
  v_accvgpr_read_b32 v67, a67
  v_mul_f32 v64, v64, v193
  v_mul_f32 v65, v65, v193
  v_mul_f32 v66, v66, v193
  v_mul_f32 v67, v67, v193
  v_accvgpr_write_b32 a64, v64
  v_accvgpr_write_b32 a65, v65
  v_accvgpr_write_b32 a66, v66
  v_accvgpr_write_b32 a67, v67
  v_accvgpr_read_b32 v64, a80
  v_accvgpr_read_b32 v65, a81
  v_accvgpr_read_b32 v66, a82
  v_accvgpr_read_b32 v67, a83
  v_mul_f32 v64, v64, v193
  v_mul_f32 v65, v65, v193
  v_mul_f32 v66, v66, v193
  v_mul_f32 v67, v67, v193
  v_accvgpr_write_b32 a80, v64
  v_accvgpr_write_b32 a81, v65
  v_accvgpr_write_b32 a82, v66
  v_accvgpr_write_b32 a83, v67
  v_accvgpr_read_b32 v64, a96
  v_accvgpr_read_b32 v65, a97
  v_accvgpr_read_b32 v66, a98
  v_accvgpr_read_b32 v67, a99
  v_mul_f32 v64, v64, v193
  v_mul_f32 v65, v65, v193
  v_mul_f32 v66, v66, v193
  v_mul_f32 v67, v67, v193
  v_accvgpr_write_b32 a96, v64
  v_accvgpr_write_b32 a97, v65
  v_accvgpr_write_b32 a98, v66
  v_accvgpr_write_b32 a99, v67
  v_accvgpr_read_b32 v64, a112
  v_accvgpr_read_b32 v65, a113
  v_accvgpr_read_b32 v66, a114
  v_accvgpr_read_b32 v67, a115
  v_mul_f32 v64, v64, v193
  v_mul_f32 v65, v65, v193
  v_mul_f32 v66, v66, v193
  v_mul_f32 v67, v67, v193
  v_accvgpr_write_b32 a112, v64
  v_accvgpr_write_b32 a113, v65
  v_accvgpr_write_b32 a114, v66
  v_accvgpr_write_b32 a115, v67
  v_mov_b32 v196, v250
  v_max3_f32 v196, v196, v8, v9
  v_max3_f32 v196, v196, v10, v11
  v_max3_f32 v196, v196, v12, v13
  v_max3_f32 v196, v196, v14, v15
  v_max3_f32 v196, v196, v40, v41
  v_max3_f32 v196, v196, v42, v43
  v_max3_f32 v196, v196, v44, v45
  v_max3_f32 v196, v196, v46, v47
  v_mov_b32 v245, v196
  s_nop 1
  v_permlane16_swap_b32 v196, v245
  v_max_f32 v196, v196, v245
  v_mov_b32 v245, v196
  s_nop 1
  v_permlane32_swap_b32 v196, v245
  v_max_f32 v196, v196, v245
  v_sub_f32 v197, v250, v196
  v_exp_f32 v197, v197
  v_mov_b32 v250, v196
  v_mul_f32 v209, v209, v197
  v_sub_f32 v8, v8, v196
  v_sub_f32 v9, v9, v196
  v_sub_f32 v10, v10, v196
  v_sub_f32 v11, v11, v196
  v_sub_f32 v12, v12, v196
  v_sub_f32 v13, v13, v196
  v_sub_f32 v14, v14, v196
  v_sub_f32 v15, v15, v196
  v_sub_f32 v40, v40, v196
  v_sub_f32 v41, v41, v196
  v_sub_f32 v42, v42, v196
  v_sub_f32 v43, v43, v196
  v_sub_f32 v44, v44, v196
  v_sub_f32 v45, v45, v196
  v_sub_f32 v46, v46, v196
  v_sub_f32 v47, v47, v196
  v_exp_f32 v8, v8
  v_exp_f32 v9, v9
  v_add_f32 v209, v209, v8
  v_exp_f32 v10, v10
  v_add_f32 v209, v209, v9
  v_cvt_pk_bf16_f32 v8, v8, v9
  v_exp_f32 v11, v11
  v_add_f32 v209, v209, v10
  v_add_f32 v209, v209, v11
  v_cvt_pk_bf16_f32 v9, v10, v11
  v_exp_f32 v12, v12
  v_exp_f32 v13, v13
  v_add_f32 v209, v209, v12
  v_exp_f32 v14, v14
  v_add_f32 v209, v209, v13
  v_cvt_pk_bf16_f32 v10, v12, v13
  v_exp_f32 v15, v15
  v_add_f32 v209, v209, v14
  v_add_f32 v209, v209, v15
  v_cvt_pk_bf16_f32 v11, v14, v15
  v_exp_f32 v40, v40
  v_exp_f32 v41, v41
  v_add_f32 v209, v209, v40
  v_exp_f32 v42, v42
  v_add_f32 v209, v209, v41
  v_cvt_pk_bf16_f32 v40, v40, v41
  v_exp_f32 v43, v43
  v_add_f32 v209, v209, v42
  v_add_f32 v209, v209, v43
  v_cvt_pk_bf16_f32 v41, v42, v43
  v_exp_f32 v44, v44
  v_exp_f32 v45, v45
  v_add_f32 v209, v209, v44
  v_exp_f32 v46, v46
  v_add_f32 v209, v209, v45
  v_cvt_pk_bf16_f32 v42, v44, v45
  v_exp_f32 v47, v47
  v_add_f32 v209, v209, v46
  v_add_f32 v209, v209, v47
  v_cvt_pk_bf16_f32 v43, v46, v47
  v_accvgpr_read_b32 v64, a4
  v_accvgpr_read_b32 v65, a5
  v_accvgpr_read_b32 v66, a6
  v_accvgpr_read_b32 v67, a7
  v_mul_f32 v64, v64, v197
  v_mul_f32 v65, v65, v197
  v_mul_f32 v66, v66, v197
  v_mul_f32 v67, v67, v197
  v_accvgpr_write_b32 a4, v64
  v_accvgpr_write_b32 a5, v65
  v_accvgpr_write_b32 a6, v66
  v_accvgpr_write_b32 a7, v67
  v_accvgpr_read_b32 v64, a20
  v_accvgpr_read_b32 v65, a21
  v_accvgpr_read_b32 v66, a22
  v_accvgpr_read_b32 v67, a23
  v_mul_f32 v64, v64, v197
  v_mul_f32 v65, v65, v197
  v_mul_f32 v66, v66, v197
  v_mul_f32 v67, v67, v197
  v_accvgpr_write_b32 a20, v64
  v_accvgpr_write_b32 a21, v65
  v_accvgpr_write_b32 a22, v66
  v_accvgpr_write_b32 a23, v67
  v_accvgpr_read_b32 v64, a36
  v_accvgpr_read_b32 v65, a37
  v_accvgpr_read_b32 v66, a38
  v_accvgpr_read_b32 v67, a39
  v_mul_f32 v64, v64, v197
  v_mul_f32 v65, v65, v197
  v_mul_f32 v66, v66, v197
  v_mul_f32 v67, v67, v197
  v_accvgpr_write_b32 a36, v64
  v_accvgpr_write_b32 a37, v65
  v_accvgpr_write_b32 a38, v66
  v_accvgpr_write_b32 a39, v67
  v_accvgpr_read_b32 v64, a52
  v_accvgpr_read_b32 v65, a53
  v_accvgpr_read_b32 v66, a54
  v_accvgpr_read_b32 v67, a55
  v_mul_f32 v64, v64, v197
  v_mul_f32 v65, v65, v197
  v_mul_f32 v66, v66, v197
  v_mul_f32 v67, v67, v197
  v_accvgpr_write_b32 a52, v64
  v_accvgpr_write_b32 a53, v65
  v_accvgpr_write_b32 a54, v66
  v_accvgpr_write_b32 a55, v67
  v_accvgpr_read_b32 v64, a68
  v_accvgpr_read_b32 v65, a69
  v_accvgpr_read_b32 v66, a70
  v_accvgpr_read_b32 v67, a71
  v_mul_f32 v64, v64, v197
  v_mul_f32 v65, v65, v197
  v_mul_f32 v66, v66, v197
  v_mul_f32 v67, v67, v197
  v_accvgpr_write_b32 a68, v64
  v_accvgpr_write_b32 a69, v65
  v_accvgpr_write_b32 a70, v66
  v_accvgpr_write_b32 a71, v67
  v_accvgpr_read_b32 v64, a84
  v_accvgpr_read_b32 v65, a85
  v_accvgpr_read_b32 v66, a86
  v_accvgpr_read_b32 v67, a87
  v_mul_f32 v64, v64, v197
  v_mul_f32 v65, v65, v197
  v_mul_f32 v66, v66, v197
  v_mul_f32 v67, v67, v197
  v_accvgpr_write_b32 a84, v64
  v_accvgpr_write_b32 a85, v65
  v_accvgpr_write_b32 a86, v66
  v_accvgpr_write_b32 a87, v67
  v_accvgpr_read_b32 v64, a100
  v_accvgpr_read_b32 v65, a101
  v_accvgpr_read_b32 v66, a102
  v_accvgpr_read_b32 v67, a103
  v_mul_f32 v64, v64, v197
  v_mul_f32 v65, v65, v197
  v_mul_f32 v66, v66, v197
  v_mul_f32 v67, v67, v197
  v_accvgpr_write_b32 a100, v64
  v_accvgpr_write_b32 a101, v65
  v_accvgpr_write_b32 a102, v66
  v_accvgpr_write_b32 a103, v67
  v_accvgpr_read_b32 v64, a116
  v_accvgpr_read_b32 v65, a117
  v_accvgpr_read_b32 v66, a118
  v_accvgpr_read_b32 v67, a119
  v_mul_f32 v64, v64, v197
  v_mul_f32 v65, v65, v197
  v_mul_f32 v66, v66, v197
  v_mul_f32 v67, v67, v197
  v_accvgpr_write_b32 a116, v64
  v_accvgpr_write_b32 a117, v65
  v_accvgpr_write_b32 a118, v66
  v_accvgpr_write_b32 a119, v67
  v_mov_b32 v200, v251
  v_max3_f32 v200, v200, v16, v17
  v_max3_f32 v200, v200, v18, v19
  v_max3_f32 v200, v200, v20, v21
  v_max3_f32 v200, v200, v22, v23
  v_max3_f32 v200, v200, v48, v49
  v_max3_f32 v200, v200, v50, v51
  v_max3_f32 v200, v200, v52, v53
  v_max3_f32 v200, v200, v54, v55
  v_mov_b32 v245, v200
  s_nop 1
  v_permlane16_swap_b32 v200, v245
  v_max_f32 v200, v200, v245
  v_mov_b32 v245, v200
  s_nop 1
  v_permlane32_swap_b32 v200, v245
  v_max_f32 v200, v200, v245
  v_sub_f32 v201, v251, v200
  v_exp_f32 v201, v201
  v_mov_b32 v251, v200
  v_mul_f32 v210, v210, v201
  v_sub_f32 v16, v16, v200
  v_sub_f32 v17, v17, v200
  v_sub_f32 v18, v18, v200
  v_sub_f32 v19, v19, v200
  v_sub_f32 v20, v20, v200
  v_sub_f32 v21, v21, v200
  v_sub_f32 v22, v22, v200
  v_sub_f32 v23, v23, v200
  v_sub_f32 v48, v48, v200
  v_sub_f32 v49, v49, v200
  v_sub_f32 v50, v50, v200
  v_sub_f32 v51, v51, v200
  v_sub_f32 v52, v52, v200
  v_sub_f32 v53, v53, v200
  v_sub_f32 v54, v54, v200
  v_sub_f32 v55, v55, v200
  v_exp_f32 v16, v16
  v_exp_f32 v17, v17
  v_add_f32 v210, v210, v16
  v_exp_f32 v18, v18
  v_add_f32 v210, v210, v17
  v_cvt_pk_bf16_f32 v16, v16, v17
  v_exp_f32 v19, v19
  v_add_f32 v210, v210, v18
  v_add_f32 v210, v210, v19
  v_cvt_pk_bf16_f32 v17, v18, v19
  v_exp_f32 v20, v20
  v_exp_f32 v21, v21
  v_add_f32 v210, v210, v20
  v_exp_f32 v22, v22
  v_add_f32 v210, v210, v21
  v_cvt_pk_bf16_f32 v18, v20, v21
  v_exp_f32 v23, v23
  v_add_f32 v210, v210, v22
  v_add_f32 v210, v210, v23
  v_cvt_pk_bf16_f32 v19, v22, v23
  v_exp_f32 v48, v48
  v_exp_f32 v49, v49
  v_add_f32 v210, v210, v48
  v_exp_f32 v50, v50
  v_add_f32 v210, v210, v49
  v_cvt_pk_bf16_f32 v48, v48, v49
  v_exp_f32 v51, v51
  v_add_f32 v210, v210, v50
  v_add_f32 v210, v210, v51
  v_cvt_pk_bf16_f32 v49, v50, v51
  v_exp_f32 v52, v52
  v_exp_f32 v53, v53
  v_add_f32 v210, v210, v52
  v_exp_f32 v54, v54
  v_add_f32 v210, v210, v53
  v_cvt_pk_bf16_f32 v50, v52, v53
  v_exp_f32 v55, v55
  v_add_f32 v210, v210, v54
  v_add_f32 v210, v210, v55
  v_cvt_pk_bf16_f32 v51, v54, v55
  v_accvgpr_read_b32 v64, a8
  v_accvgpr_read_b32 v65, a9
  v_accvgpr_read_b32 v66, a10
  v_accvgpr_read_b32 v67, a11
  v_mul_f32 v64, v64, v201
  v_mul_f32 v65, v65, v201
  v_mul_f32 v66, v66, v201
  v_mul_f32 v67, v67, v201
  v_accvgpr_write_b32 a8, v64
  v_accvgpr_write_b32 a9, v65
  v_accvgpr_write_b32 a10, v66
  v_accvgpr_write_b32 a11, v67
  v_accvgpr_read_b32 v64, a24
  v_accvgpr_read_b32 v65, a25
  v_accvgpr_read_b32 v66, a26
  v_accvgpr_read_b32 v67, a27
  v_mul_f32 v64, v64, v201
  v_mul_f32 v65, v65, v201
  v_mul_f32 v66, v66, v201
  v_mul_f32 v67, v67, v201
  v_accvgpr_write_b32 a24, v64
  v_accvgpr_write_b32 a25, v65
  v_accvgpr_write_b32 a26, v66
  v_accvgpr_write_b32 a27, v67
  v_accvgpr_read_b32 v64, a40
  v_accvgpr_read_b32 v65, a41
  v_accvgpr_read_b32 v66, a42
  v_accvgpr_read_b32 v67, a43
  v_mul_f32 v64, v64, v201
  v_mul_f32 v65, v65, v201
  v_mul_f32 v66, v66, v201
  v_mul_f32 v67, v67, v201
  v_accvgpr_write_b32 a40, v64
  v_accvgpr_write_b32 a41, v65
  v_accvgpr_write_b32 a42, v66
  v_accvgpr_write_b32 a43, v67
  v_accvgpr_read_b32 v64, a56
  v_accvgpr_read_b32 v65, a57
  v_accvgpr_read_b32 v66, a58
  v_accvgpr_read_b32 v67, a59
  v_mul_f32 v64, v64, v201
  v_mul_f32 v65, v65, v201
  v_mul_f32 v66, v66, v201
  v_mul_f32 v67, v67, v201
  v_accvgpr_write_b32 a56, v64
  v_accvgpr_write_b32 a57, v65
  v_accvgpr_write_b32 a58, v66
  v_accvgpr_write_b32 a59, v67
  v_accvgpr_read_b32 v64, a72
  v_accvgpr_read_b32 v65, a73
  v_accvgpr_read_b32 v66, a74
  v_accvgpr_read_b32 v67, a75
  v_mul_f32 v64, v64, v201
  v_mul_f32 v65, v65, v201
  v_mul_f32 v66, v66, v201
  v_mul_f32 v67, v67, v201
  v_accvgpr_write_b32 a72, v64
  v_accvgpr_write_b32 a73, v65
  v_accvgpr_write_b32 a74, v66
  v_accvgpr_write_b32 a75, v67
  v_accvgpr_read_b32 v64, a88
  v_accvgpr_read_b32 v65, a89
  v_accvgpr_read_b32 v66, a90
  v_accvgpr_read_b32 v67, a91
  v_mul_f32 v64, v64, v201
  v_mul_f32 v65, v65, v201
  v_mul_f32 v66, v66, v201
  v_mul_f32 v67, v67, v201
  v_accvgpr_write_b32 a88, v64
  v_accvgpr_write_b32 a89, v65
  v_accvgpr_write_b32 a90, v66
  v_accvgpr_write_b32 a91, v67
  v_accvgpr_read_b32 v64, a104
  v_accvgpr_read_b32 v65, a105
  v_accvgpr_read_b32 v66, a106
  v_accvgpr_read_b32 v67, a107
  v_mul_f32 v64, v64, v201
  v_mul_f32 v65, v65, v201
  v_mul_f32 v66, v66, v201
  v_mul_f32 v67, v67, v201
  v_accvgpr_write_b32 a104, v64
  v_accvgpr_write_b32 a105, v65
  v_accvgpr_write_b32 a106, v66
  v_accvgpr_write_b32 a107, v67
  v_accvgpr_read_b32 v64, a120
  v_accvgpr_read_b32 v65, a121
  v_accvgpr_read_b32 v66, a122
  v_accvgpr_read_b32 v67, a123
  v_mul_f32 v64, v64, v201
  v_mul_f32 v65, v65, v201
  v_mul_f32 v66, v66, v201
  v_mul_f32 v67, v67, v201
  v_accvgpr_write_b32 a120, v64
  v_accvgpr_write_b32 a121, v65
  v_accvgpr_write_b32 a122, v66
  v_accvgpr_write_b32 a123, v67
  v_mov_b32 v204, v252
  v_max3_f32 v204, v204, v24, v25
  v_max3_f32 v204, v204, v26, v27
  v_max3_f32 v204, v204, v28, v29
  v_max3_f32 v204, v204, v30, v31
  v_max3_f32 v204, v204, v56, v57
  v_max3_f32 v204, v204, v58, v59
  v_max3_f32 v204, v204, v60, v61
  v_max3_f32 v204, v204, v62, v63
  v_mov_b32 v245, v204
  s_nop 1
  v_permlane16_swap_b32 v204, v245
  v_max_f32 v204, v204, v245
  v_mov_b32 v245, v204
  s_nop 1
  v_permlane32_swap_b32 v204, v245
  v_max_f32 v204, v204, v245
  v_sub_f32 v205, v252, v204
  v_exp_f32 v205, v205
  v_mov_b32 v252, v204
  v_mul_f32 v211, v211, v205
  v_sub_f32 v24, v24, v204
  v_sub_f32 v25, v25, v204
  v_sub_f32 v26, v26, v204
  v_sub_f32 v27, v27, v204
  v_sub_f32 v28, v28, v204
  v_sub_f32 v29, v29, v204
  v_sub_f32 v30, v30, v204
  v_sub_f32 v31, v31, v204
  v_sub_f32 v56, v56, v204
  v_sub_f32 v57, v57, v204
  v_sub_f32 v58, v58, v204
  v_sub_f32 v59, v59, v204
  v_sub_f32 v60, v60, v204
  v_sub_f32 v61, v61, v204
  v_sub_f32 v62, v62, v204
  v_sub_f32 v63, v63, v204
  v_exp_f32 v24, v24
  v_exp_f32 v25, v25
  v_add_f32 v211, v211, v24
  v_exp_f32 v26, v26
  v_add_f32 v211, v211, v25
  v_cvt_pk_bf16_f32 v24, v24, v25
  v_exp_f32 v27, v27
  v_add_f32 v211, v211, v26
  v_add_f32 v211, v211, v27
  v_cvt_pk_bf16_f32 v25, v26, v27
  v_exp_f32 v28, v28
  v_exp_f32 v29, v29
  v_add_f32 v211, v211, v28
  v_exp_f32 v30, v30
  v_add_f32 v211, v211, v29
  v_cvt_pk_bf16_f32 v26, v28, v29
  v_exp_f32 v31, v31
  v_add_f32 v211, v211, v30
  v_add_f32 v211, v211, v31
  v_cvt_pk_bf16_f32 v27, v30, v31
  v_exp_f32 v56, v56
  v_exp_f32 v57, v57
  v_add_f32 v211, v211, v56
  v_exp_f32 v58, v58
  v_add_f32 v211, v211, v57
  v_cvt_pk_bf16_f32 v56, v56, v57
  v_exp_f32 v59, v59
  v_add_f32 v211, v211, v58
  v_add_f32 v211, v211, v59
  v_cvt_pk_bf16_f32 v57, v58, v59
  v_exp_f32 v60, v60
  v_exp_f32 v61, v61
  v_add_f32 v211, v211, v60
  v_exp_f32 v62, v62
  v_add_f32 v211, v211, v61
  v_cvt_pk_bf16_f32 v58, v60, v61
  v_exp_f32 v63, v63
  v_add_f32 v211, v211, v62
  v_add_f32 v211, v211, v63
  v_cvt_pk_bf16_f32 v59, v62, v63
  v_accvgpr_read_b32 v64, a12
  v_accvgpr_read_b32 v65, a13
  v_accvgpr_read_b32 v66, a14
  v_accvgpr_read_b32 v67, a15
  v_mul_f32 v64, v64, v205
  v_mul_f32 v65, v65, v205
  v_mul_f32 v66, v66, v205
  v_mul_f32 v67, v67, v205
  v_accvgpr_write_b32 a12, v64
  v_accvgpr_write_b32 a13, v65
  v_accvgpr_write_b32 a14, v66
  v_accvgpr_write_b32 a15, v67
  v_accvgpr_read_b32 v64, a28
  v_accvgpr_read_b32 v65, a29
  v_accvgpr_read_b32 v66, a30
  v_accvgpr_read_b32 v67, a31
  v_mul_f32 v64, v64, v205
  v_mul_f32 v65, v65, v205
  v_mul_f32 v66, v66, v205
  v_mul_f32 v67, v67, v205
  v_accvgpr_write_b32 a28, v64
  v_accvgpr_write_b32 a29, v65
  v_accvgpr_write_b32 a30, v66
  v_accvgpr_write_b32 a31, v67
  v_accvgpr_read_b32 v64, a44
  v_accvgpr_read_b32 v65, a45
  v_accvgpr_read_b32 v66, a46
  v_accvgpr_read_b32 v67, a47
  v_mul_f32 v64, v64, v205
  v_mul_f32 v65, v65, v205
  v_mul_f32 v66, v66, v205
  v_mul_f32 v67, v67, v205
  v_accvgpr_write_b32 a44, v64
  v_accvgpr_write_b32 a45, v65
  v_accvgpr_write_b32 a46, v66
  v_accvgpr_write_b32 a47, v67
  v_accvgpr_read_b32 v64, a60
  v_accvgpr_read_b32 v65, a61
  v_accvgpr_read_b32 v66, a62
  v_accvgpr_read_b32 v67, a63
  v_mul_f32 v64, v64, v205
  v_mul_f32 v65, v65, v205
  v_mul_f32 v66, v66, v205
  v_mul_f32 v67, v67, v205
  v_accvgpr_write_b32 a60, v64
  v_accvgpr_write_b32 a61, v65
  v_accvgpr_write_b32 a62, v66
  v_accvgpr_write_b32 a63, v67
  v_accvgpr_read_b32 v64, a76
  v_accvgpr_read_b32 v65, a77
  v_accvgpr_read_b32 v66, a78
  v_accvgpr_read_b32 v67, a79
  v_mul_f32 v64, v64, v205
  v_mul_f32 v65, v65, v205
  v_mul_f32 v66, v66, v205
  v_mul_f32 v67, v67, v205
  v_accvgpr_write_b32 a76, v64
  v_accvgpr_write_b32 a77, v65
  v_accvgpr_write_b32 a78, v66
  v_accvgpr_write_b32 a79, v67
  v_accvgpr_read_b32 v64, a92
  v_accvgpr_read_b32 v65, a93
  v_accvgpr_read_b32 v66, a94
  v_accvgpr_read_b32 v67, a95
  v_mul_f32 v64, v64, v205
  v_mul_f32 v65, v65, v205
  v_mul_f32 v66, v66, v205
  v_mul_f32 v67, v67, v205
  v_accvgpr_write_b32 a92, v64
  v_accvgpr_write_b32 a93, v65
  v_accvgpr_write_b32 a94, v66
  v_accvgpr_write_b32 a95, v67
  v_accvgpr_read_b32 v64, a108
  v_accvgpr_read_b32 v65, a109
  v_accvgpr_read_b32 v66, a110
  v_accvgpr_read_b32 v67, a111
  v_mul_f32 v64, v64, v205
  v_mul_f32 v65, v65, v205
  v_mul_f32 v66, v66, v205
  v_mul_f32 v67, v67, v205
  v_accvgpr_write_b32 a108, v64
  v_accvgpr_write_b32 a109, v65
  v_accvgpr_write_b32 a110, v66
  v_accvgpr_write_b32 a111, v67
  v_accvgpr_read_b32 v64, a124
  v_accvgpr_read_b32 v65, a125
  v_accvgpr_read_b32 v66, a126
  v_accvgpr_read_b32 v67, a127
  v_mul_f32 v64, v64, v205
  v_mul_f32 v65, v65, v205
  v_mul_f32 v66, v66, v205
  v_mul_f32 v67, v67, v205
  v_accvgpr_write_b32 a124, v64
  v_accvgpr_write_b32 a125, v65
  v_accvgpr_write_b32 a126, v66
  v_accvgpr_write_b32 a127, v67
  ds_read_b64_tr_b16 a[160:161], v216 offset:0
  ds_read_b64_tr_b16 a[162:163], v216 offset:4096
  ds_read_b64_tr_b16 a[164:165], v216 offset:8192
  ds_read_b64_tr_b16 a[166:167], v216 offset:12288
  s_waitcnt lgkmcnt(2)
  v_mfma_f32_16x16x32_bf16 a[0:3], a[160:163], v[0:3], a[0:3]
  s_waitcnt lgkmcnt(0)
  v_mfma_f32_16x16x32_bf16 a[0:3], a[164:167], v[32:35], a[0:3]
  v_mfma_f32_16x16x32_bf16 a[4:7], a[164:167], v[40:43], a[4:7]
  v_mfma_f32_16x16x32_bf16 a[4:7], a[160:163], v[8:11], a[4:7]
  v_mfma_f32_16x16x32_bf16 a[8:11], a[160:163], v[16:19], a[8:11]
  v_mfma_f32_16x16x32_bf16 a[8:11], a[164:167], v[48:51], a[8:11]
  v_mfma_f32_16x16x32_bf16 a[12:15], a[164:167], v[56:59], a[12:15]
  v_mfma_f32_16x16x32_bf16 a[12:15], a[160:163], v[24:27], a[12:15]
  ds_read_b64_tr_b16 a[168:169], v217 offset:0
  ds_read_b64_tr_b16 a[170:171], v217 offset:4096
  ds_read_b64_tr_b16 a[172:173], v217 offset:8192
  ds_read_b64_tr_b16 a[174:175], v217 offset:12288
  s_waitcnt lgkmcnt(2)
  v_mfma_f32_16x16x32_bf16 a[16:19], a[168:171], v[0:3], a[16:19]
  s_waitcnt lgkmcnt(0)
  v_mfma_f32_16x16x32_bf16 a[16:19], a[172:175], v[32:35], a[16:19]
  v_mfma_f32_16x16x32_bf16 a[20:23], a[172:175], v[40:43], a[20:23]
  v_mfma_f32_16x16x32_bf16 a[20:23], a[168:171], v[8:11], a[20:23]
  v_mfma_f32_16x16x32_bf16 a[24:27], a[168:171], v[16:19], a[24:27]
  v_mfma_f32_16x16x32_bf16 a[24:27], a[172:175], v[48:51], a[24:27]
  v_mfma_f32_16x16x32_bf16 a[28:31], a[172:175], v[56:59], a[28:31]
  v_mfma_f32_16x16x32_bf16 a[28:31], a[168:171], v[24:27], a[28:31]
  ds_read_b64_tr_b16 a[176:177], v218 offset:0
  ds_read_b64_tr_b16 a[178:179], v218 offset:4096
  ds_read_b64_tr_b16 a[180:181], v218 offset:8192
  ds_read_b64_tr_b16 a[182:183], v218 offset:12288
  s_waitcnt lgkmcnt(2)
  v_mfma_f32_16x16x32_bf16 a[32:35], a[176:179], v[0:3], a[32:35]
  s_waitcnt lgkmcnt(0)
  v_mfma_f32_16x16x32_bf16 a[32:35], a[180:183], v[32:35], a[32:35]
  v_mfma_f32_16x16x32_bf16 a[36:39], a[180:183], v[40:43], a[36:39]
  v_mfma_f32_16x16x32_bf16 a[36:39], a[176:179], v[8:11], a[36:39]
  v_mfma_f32_16x16x32_bf16 a[40:43], a[176:179], v[16:19], a[40:43]
  v_mfma_f32_16x16x32_bf16 a[40:43], a[180:183], v[48:51], a[40:43]
  v_mfma_f32_16x16x32_bf16 a[44:47], a[180:183], v[56:59], a[44:47]
  v_mfma_f32_16x16x32_bf16 a[44:47], a[176:179], v[24:27], a[44:47]
  ds_read_b64_tr_b16 a[184:185], v219 offset:0
  ds_read_b64_tr_b16 a[186:187], v219 offset:4096
  ds_read_b64_tr_b16 a[188:189], v219 offset:8192
  ds_read_b64_tr_b16 a[190:191], v219 offset:12288
  s_waitcnt lgkmcnt(2)
  v_mfma_f32_16x16x32_bf16 a[48:51], a[184:187], v[0:3], a[48:51]
  s_waitcnt lgkmcnt(0)
  v_mfma_f32_16x16x32_bf16 a[48:51], a[188:191], v[32:35], a[48:51]
  v_mfma_f32_16x16x32_bf16 a[52:55], a[188:191], v[40:43], a[52:55]
  v_mfma_f32_16x16x32_bf16 a[52:55], a[184:187], v[8:11], a[52:55]
  v_mfma_f32_16x16x32_bf16 a[56:59], a[184:187], v[16:19], a[56:59]
  v_mfma_f32_16x16x32_bf16 a[56:59], a[188:191], v[48:51], a[56:59]
  v_mfma_f32_16x16x32_bf16 a[60:63], a[188:191], v[56:59], a[60:63]
  v_mfma_f32_16x16x32_bf16 a[60:63], a[184:187], v[24:27], a[60:63]
  ds_read_b64_tr_b16 a[160:161], v220 offset:0
  ds_read_b64_tr_b16 a[162:163], v220 offset:4096
  ds_read_b64_tr_b16 a[164:165], v220 offset:8192
  ds_read_b64_tr_b16 a[166:167], v220 offset:12288
  s_waitcnt lgkmcnt(2)
  v_mfma_f32_16x16x32_bf16 a[64:67], a[160:163], v[0:3], a[64:67]
  s_waitcnt lgkmcnt(0)
  v_mfma_f32_16x16x32_bf16 a[64:67], a[164:167], v[32:35], a[64:67]
  v_mfma_f32_16x16x32_bf16 a[68:71], a[164:167], v[40:43], a[68:71]
  v_mfma_f32_16x16x32_bf16 a[68:71], a[160:163], v[8:11], a[68:71]
  v_mfma_f32_16x16x32_bf16 a[72:75], a[160:163], v[16:19], a[72:75]
  v_mfma_f32_16x16x32_bf16 a[72:75], a[164:167], v[48:51], a[72:75]
  v_mfma_f32_16x16x32_bf16 a[76:79], a[164:167], v[56:59], a[76:79]
  v_mfma_f32_16x16x32_bf16 a[76:79], a[160:163], v[24:27], a[76:79]
  ds_read_b64_tr_b16 a[168:169], v221 offset:0
  ds_read_b64_tr_b16 a[170:171], v221 offset:4096
  ds_read_b64_tr_b16 a[172:173], v221 offset:8192
  ds_read_b64_tr_b16 a[174:175], v221 offset:12288
  s_waitcnt lgkmcnt(2)
  v_mfma_f32_16x16x32_bf16 a[80:83], a[168:171], v[0:3], a[80:83]
  s_waitcnt lgkmcnt(0)
  v_mfma_f32_16x16x32_bf16 a[80:83], a[172:175], v[32:35], a[80:83]
  v_mfma_f32_16x16x32_bf16 a[84:87], a[172:175], v[40:43], a[84:87]
  v_mfma_f32_16x16x32_bf16 a[84:87], a[168:171], v[8:11], a[84:87]
  v_mfma_f32_16x16x32_bf16 a[88:91], a[168:171], v[16:19], a[88:91]
  v_mfma_f32_16x16x32_bf16 a[88:91], a[172:175], v[48:51], a[88:91]
  v_mfma_f32_16x16x32_bf16 a[92:95], a[172:175], v[56:59], a[92:95]
  v_mfma_f32_16x16x32_bf16 a[92:95], a[168:171], v[24:27], a[92:95]
  ds_read_b64_tr_b16 a[176:177], v222 offset:0
  ds_read_b64_tr_b16 a[178:179], v222 offset:4096
  ds_read_b64_tr_b16 a[180:181], v222 offset:8192
  ds_read_b64_tr_b16 a[182:183], v222 offset:12288
  s_waitcnt lgkmcnt(2)
  v_mfma_f32_16x16x32_bf16 a[96:99], a[176:179], v[0:3], a[96:99]
  s_waitcnt lgkmcnt(0)
  v_mfma_f32_16x16x32_bf16 a[96:99], a[180:183], v[32:35], a[96:99]
  v_mfma_f32_16x16x32_bf16 a[100:103], a[180:183], v[40:43], a[100:103]
  v_mfma_f32_16x16x32_bf16 a[100:103], a[176:179], v[8:11], a[100:103]
  v_mfma_f32_16x16x32_bf16 a[104:107], a[176:179], v[16:19], a[104:107]
  v_mfma_f32_16x16x32_bf16 a[104:107], a[180:183], v[48:51], a[104:107]
  v_mfma_f32_16x16x32_bf16 a[108:111], a[180:183], v[56:59], a[108:111]
  v_mfma_f32_16x16x32_bf16 a[108:111], a[176:179], v[24:27], a[108:111]
  ds_read_b64_tr_b16 a[184:185], v223 offset:0
  ds_read_b64_tr_b16 a[186:187], v223 offset:4096
  ds_read_b64_tr_b16 a[188:189], v223 offset:8192
  ds_read_b64_tr_b16 a[190:191], v223 offset:12288
  s_waitcnt lgkmcnt(2)
  v_mfma_f32_16x16x32_bf16 a[112:115], a[184:187], v[0:3], a[112:115]
  s_waitcnt lgkmcnt(0)
  v_mfma_f32_16x16x32_bf16 a[112:115], a[188:191], v[32:35], a[112:115]
  v_mfma_f32_16x16x32_bf16 a[116:119], a[188:191], v[40:43], a[116:119]
  v_mfma_f32_16x16x32_bf16 a[116:119], a[184:187], v[8:11], a[116:119]
  v_mfma_f32_16x16x32_bf16 a[120:123], a[184:187], v[16:19], a[120:123]
  v_mfma_f32_16x16x32_bf16 a[120:123], a[188:191], v[48:51], a[120:123]
  v_mfma_f32_16x16x32_bf16 a[124:127], a[188:191], v[56:59], a[124:127]
  v_mfma_f32_16x16x32_bf16 a[124:127], a[184:187], v[24:27], a[124:127]
  s_add_u32 s29, s29, 16384
  s_cmp_lt_u32 s29, 524288
  s_cbranch_scc1 attn_slow
  v_mov_b32 v245, v208
  v_mov_b32 v246, v209
  v_mov_b32 v247, v210
  v_mov_b32 v248, v211
  v_permlane16_swap_b32 v208, v245
  v_permlane16_swap_b32 v209, v246
  v_permlane16_swap_b32 v210, v247
  v_permlane16_swap_b32 v211, v248
  v_add_f32 v208, v208, v245
  v_add_f32 v209, v209, v246
  v_add_f32 v210, v210, v247
  v_add_f32 v211, v211, v248
  v_mov_b32 v245, v208
  v_mov_b32 v246, v209
  v_mov_b32 v247, v210
  v_mov_b32 v248, v211
  v_permlane32_swap_b32 v208, v245
  v_permlane32_swap_b32 v209, v246
  v_permlane32_swap_b32 v210, v247
  v_permlane32_swap_b32 v211, v248
  v_add_f32 v208, v208, v245
  v_add_f32 v209, v209, v246
  v_add_f32 v210, v210, v247
  v_add_f32 v211, v211, v248
  v_rcp_f32 v192, v208
  v_rcp_f32 v196, v209
  v_rcp_f32 v200, v210
  v_rcp_f32 v204, v211
  v_accvgpr_read_b32 v0, a0
  v_accvgpr_read_b32 v1, a1
  v_accvgpr_read_b32 v2, a2
  v_accvgpr_read_b32 v3, a3
  v_accvgpr_read_b32 v4, a16
  v_accvgpr_read_b32 v5, a17
  v_accvgpr_read_b32 v6, a18
  v_accvgpr_read_b32 v7, a19
  v_mul_f32 v0, v0, v192
  v_mul_f32 v1, v1, v192
  v_mul_f32 v2, v2, v192
  v_mul_f32 v3, v3, v192
  v_mul_f32 v4, v4, v192
  v_mul_f32 v5, v5, v192
  v_mul_f32 v6, v6, v192
  v_mul_f32 v7, v7, v192
  v_cvt_pk_bf16_f32 v0, v0, v1
  v_cvt_pk_bf16_f32 v1, v2, v3
  v_cvt_pk_bf16_f32 v2, v4, v5
  v_cvt_pk_bf16_f32 v3, v6, v7
  buffer_store_dwordx4 v[0:3], v244, s[24:27], s40 offen offset:0 sc1
  v_accvgpr_read_b32 v8, a4
  v_accvgpr_read_b32 v9, a5
  v_accvgpr_read_b32 v10, a6
  v_accvgpr_read_b32 v11, a7
  v_accvgpr_read_b32 v12, a20
  v_accvgpr_read_b32 v13, a21
  v_accvgpr_read_b32 v14, a22
  v_accvgpr_read_b32 v15, a23
  v_mul_f32 v8, v8, v196
  v_mul_f32 v9, v9, v196
  v_mul_f32 v10, v10, v196
  v_mul_f32 v11, v11, v196
  v_mul_f32 v12, v12, v196
  v_mul_f32 v13, v13, v196
  v_mul_f32 v14, v14, v196
  v_mul_f32 v15, v15, v196
  v_cvt_pk_bf16_f32 v8, v8, v9
  v_cvt_pk_bf16_f32 v9, v10, v11
  v_cvt_pk_bf16_f32 v10, v12, v13
  v_cvt_pk_bf16_f32 v11, v14, v15
  buffer_store_dwordx4 v[8:11], v244, s[24:27], s40 offen offset:2048 sc1
  v_accvgpr_read_b32 v16, a8
  v_accvgpr_read_b32 v17, a9
  v_accvgpr_read_b32 v18, a10
  v_accvgpr_read_b32 v19, a11
  v_accvgpr_read_b32 v20, a24
  v_accvgpr_read_b32 v21, a25
  v_accvgpr_read_b32 v22, a26
  v_accvgpr_read_b32 v23, a27
  v_mul_f32 v16, v16, v200
  v_mul_f32 v17, v17, v200
  v_mul_f32 v18, v18, v200
  v_mul_f32 v19, v19, v200
  v_mul_f32 v20, v20, v200
  v_mul_f32 v21, v21, v200
  v_mul_f32 v22, v22, v200
  v_mul_f32 v23, v23, v200
  v_cvt_pk_bf16_f32 v16, v16, v17
  v_cvt_pk_bf16_f32 v17, v18, v19
  v_cvt_pk_bf16_f32 v18, v20, v21
  v_cvt_pk_bf16_f32 v19, v22, v23
  buffer_store_dwordx4 v[16:19], v244, s[24:27], s41 offen offset:0 sc1
  v_accvgpr_read_b32 v24, a12
  v_accvgpr_read_b32 v25, a13
  v_accvgpr_read_b32 v26, a14
  v_accvgpr_read_b32 v27, a15
  v_accvgpr_read_b32 v28, a28
  v_accvgpr_read_b32 v29, a29
  v_accvgpr_read_b32 v30, a30
  v_accvgpr_read_b32 v31, a31
  v_mul_f32 v24, v24, v204
  v_mul_f32 v25, v25, v204
  v_mul_f32 v26, v26, v204
  v_mul_f32 v27, v27, v204
  v_mul_f32 v28, v28, v204
  v_mul_f32 v29, v29, v204
  v_mul_f32 v30, v30, v204
  v_mul_f32 v31, v31, v204
  v_cvt_pk_bf16_f32 v24, v24, v25
  v_cvt_pk_bf16_f32 v25, v26, v27
  v_cvt_pk_bf16_f32 v26, v28, v29
  v_cvt_pk_bf16_f32 v27, v30, v31
  buffer_store_dwordx4 v[24:27], v244, s[24:27], s41 offen offset:2048 sc1
  v_accvgpr_read_b32 v32, a32
  v_accvgpr_read_b32 v33, a33
  v_accvgpr_read_b32 v34, a34
  v_accvgpr_read_b32 v35, a35
  v_accvgpr_read_b32 v36, a48
  v_accvgpr_read_b32 v37, a49
  v_accvgpr_read_b32 v38, a50
  v_accvgpr_read_b32 v39, a51
  v_mul_f32 v32, v32, v192
  v_mul_f32 v33, v33, v192
  v_mul_f32 v34, v34, v192
  v_mul_f32 v35, v35, v192
  v_mul_f32 v36, v36, v192
  v_mul_f32 v37, v37, v192
  v_mul_f32 v38, v38, v192
  v_mul_f32 v39, v39, v192
  v_cvt_pk_bf16_f32 v32, v32, v33
  v_cvt_pk_bf16_f32 v33, v34, v35
  v_cvt_pk_bf16_f32 v34, v36, v37
  v_cvt_pk_bf16_f32 v35, v38, v39
  buffer_store_dwordx4 v[32:35], v244, s[24:27], s40 offen offset:1024 sc1
  v_accvgpr_read_b32 v40, a36
  v_accvgpr_read_b32 v41, a37
  v_accvgpr_read_b32 v42, a38
  v_accvgpr_read_b32 v43, a39
  v_accvgpr_read_b32 v44, a52
  v_accvgpr_read_b32 v45, a53
  v_accvgpr_read_b32 v46, a54
  v_accvgpr_read_b32 v47, a55
  v_mul_f32 v40, v40, v196
  v_mul_f32 v41, v41, v196
  v_mul_f32 v42, v42, v196
  v_mul_f32 v43, v43, v196
  v_mul_f32 v44, v44, v196
  v_mul_f32 v45, v45, v196
  v_mul_f32 v46, v46, v196
  v_mul_f32 v47, v47, v196
  v_cvt_pk_bf16_f32 v40, v40, v41
  v_cvt_pk_bf16_f32 v41, v42, v43
  v_cvt_pk_bf16_f32 v42, v44, v45
  v_cvt_pk_bf16_f32 v43, v46, v47
  buffer_store_dwordx4 v[40:43], v244, s[24:27], s40 offen offset:3072 sc1
  v_accvgpr_read_b32 v48, a40
  v_accvgpr_read_b32 v49, a41
  v_accvgpr_read_b32 v50, a42
  v_accvgpr_read_b32 v51, a43
  v_accvgpr_read_b32 v52, a56
  v_accvgpr_read_b32 v53, a57
  v_accvgpr_read_b32 v54, a58
  v_accvgpr_read_b32 v55, a59
  v_mul_f32 v48, v48, v200
  v_mul_f32 v49, v49, v200
  v_mul_f32 v50, v50, v200
  v_mul_f32 v51, v51, v200
  v_mul_f32 v52, v52, v200
  v_mul_f32 v53, v53, v200
  v_mul_f32 v54, v54, v200
  v_mul_f32 v55, v55, v200
  v_cvt_pk_bf16_f32 v48, v48, v49
  v_cvt_pk_bf16_f32 v49, v50, v51
  v_cvt_pk_bf16_f32 v50, v52, v53
  v_cvt_pk_bf16_f32 v51, v54, v55
  buffer_store_dwordx4 v[48:51], v244, s[24:27], s41 offen offset:1024 sc1
  v_accvgpr_read_b32 v56, a44
  v_accvgpr_read_b32 v57, a45
  v_accvgpr_read_b32 v58, a46
  v_accvgpr_read_b32 v59, a47
  v_accvgpr_read_b32 v60, a60
  v_accvgpr_read_b32 v61, a61
  v_accvgpr_read_b32 v62, a62
  v_accvgpr_read_b32 v63, a63
  v_mul_f32 v56, v56, v204
  v_mul_f32 v57, v57, v204
  v_mul_f32 v58, v58, v204
  v_mul_f32 v59, v59, v204
  v_mul_f32 v60, v60, v204
  v_mul_f32 v61, v61, v204
  v_mul_f32 v62, v62, v204
  v_mul_f32 v63, v63, v204
  v_cvt_pk_bf16_f32 v56, v56, v57
  v_cvt_pk_bf16_f32 v57, v58, v59
  v_cvt_pk_bf16_f32 v58, v60, v61
  v_cvt_pk_bf16_f32 v59, v62, v63
  buffer_store_dwordx4 v[56:59], v244, s[24:27], s41 offen offset:3072 sc1
  v_accvgpr_read_b32 v0, a64
  v_accvgpr_read_b32 v1, a65
  v_accvgpr_read_b32 v2, a66
  v_accvgpr_read_b32 v3, a67
  v_accvgpr_read_b32 v4, a80
  v_accvgpr_read_b32 v5, a81
  v_accvgpr_read_b32 v6, a82
  v_accvgpr_read_b32 v7, a83
  v_mul_f32 v0, v0, v192
  v_mul_f32 v1, v1, v192
  v_mul_f32 v2, v2, v192
  v_mul_f32 v3, v3, v192
  v_mul_f32 v4, v4, v192
  v_mul_f32 v5, v5, v192
  v_mul_f32 v6, v6, v192
  v_mul_f32 v7, v7, v192
  v_cvt_pk_bf16_f32 v0, v0, v1
  v_cvt_pk_bf16_f32 v1, v2, v3
  v_cvt_pk_bf16_f32 v2, v4, v5
  v_cvt_pk_bf16_f32 v3, v6, v7
  buffer_store_dwordx4 v[0:3], v244, s[24:27], s42 offen offset:0 sc1
  v_accvgpr_read_b32 v8, a68
  v_accvgpr_read_b32 v9, a69
  v_accvgpr_read_b32 v10, a70
  v_accvgpr_read_b32 v11, a71
  v_accvgpr_read_b32 v12, a84
  v_accvgpr_read_b32 v13, a85
  v_accvgpr_read_b32 v14, a86
  v_accvgpr_read_b32 v15, a87
  v_mul_f32 v8, v8, v196
  v_mul_f32 v9, v9, v196
  v_mul_f32 v10, v10, v196
  v_mul_f32 v11, v11, v196
  v_mul_f32 v12, v12, v196
  v_mul_f32 v13, v13, v196
  v_mul_f32 v14, v14, v196
  v_mul_f32 v15, v15, v196
  v_cvt_pk_bf16_f32 v8, v8, v9
  v_cvt_pk_bf16_f32 v9, v10, v11
  v_cvt_pk_bf16_f32 v10, v12, v13
  v_cvt_pk_bf16_f32 v11, v14, v15
  buffer_store_dwordx4 v[8:11], v244, s[24:27], s42 offen offset:2048 sc1
  v_accvgpr_read_b32 v16, a72
  v_accvgpr_read_b32 v17, a73
  v_accvgpr_read_b32 v18, a74
  v_accvgpr_read_b32 v19, a75
  v_accvgpr_read_b32 v20, a88
  v_accvgpr_read_b32 v21, a89
  v_accvgpr_read_b32 v22, a90
  v_accvgpr_read_b32 v23, a91
  v_mul_f32 v16, v16, v200
  v_mul_f32 v17, v17, v200
  v_mul_f32 v18, v18, v200
  v_mul_f32 v19, v19, v200
  v_mul_f32 v20, v20, v200
  v_mul_f32 v21, v21, v200
  v_mul_f32 v22, v22, v200
  v_mul_f32 v23, v23, v200
  v_cvt_pk_bf16_f32 v16, v16, v17
  v_cvt_pk_bf16_f32 v17, v18, v19
  v_cvt_pk_bf16_f32 v18, v20, v21
  v_cvt_pk_bf16_f32 v19, v22, v23
  buffer_store_dwordx4 v[16:19], v244, s[24:27], s43 offen offset:0 sc1
  v_accvgpr_read_b32 v24, a76
  v_accvgpr_read_b32 v25, a77
  v_accvgpr_read_b32 v26, a78
  v_accvgpr_read_b32 v27, a79
  v_accvgpr_read_b32 v28, a92
  v_accvgpr_read_b32 v29, a93
  v_accvgpr_read_b32 v30, a94
  v_accvgpr_read_b32 v31, a95
  v_mul_f32 v24, v24, v204
  v_mul_f32 v25, v25, v204
  v_mul_f32 v26, v26, v204
  v_mul_f32 v27, v27, v204
  v_mul_f32 v28, v28, v204
  v_mul_f32 v29, v29, v204
  v_mul_f32 v30, v30, v204
  v_mul_f32 v31, v31, v204
  v_cvt_pk_bf16_f32 v24, v24, v25
  v_cvt_pk_bf16_f32 v25, v26, v27
  v_cvt_pk_bf16_f32 v26, v28, v29
  v_cvt_pk_bf16_f32 v27, v30, v31
  buffer_store_dwordx4 v[24:27], v244, s[24:27], s43 offen offset:2048 sc1
  v_accvgpr_read_b32 v32, a96
  v_accvgpr_read_b32 v33, a97
  v_accvgpr_read_b32 v34, a98
  v_accvgpr_read_b32 v35, a99
  v_accvgpr_read_b32 v36, a112
  v_accvgpr_read_b32 v37, a113
  v_accvgpr_read_b32 v38, a114
  v_accvgpr_read_b32 v39, a115
  v_mul_f32 v32, v32, v192
  v_mul_f32 v33, v33, v192
  v_mul_f32 v34, v34, v192
  v_mul_f32 v35, v35, v192
  v_mul_f32 v36, v36, v192
  v_mul_f32 v37, v37, v192
  v_mul_f32 v38, v38, v192
  v_mul_f32 v39, v39, v192
  v_cvt_pk_bf16_f32 v32, v32, v33
  v_cvt_pk_bf16_f32 v33, v34, v35
  v_cvt_pk_bf16_f32 v34, v36, v37
  v_cvt_pk_bf16_f32 v35, v38, v39
  buffer_store_dwordx4 v[32:35], v244, s[24:27], s42 offen offset:1024 sc1
  v_accvgpr_read_b32 v40, a100
  v_accvgpr_read_b32 v41, a101
  v_accvgpr_read_b32 v42, a102
  v_accvgpr_read_b32 v43, a103
  v_accvgpr_read_b32 v44, a116
  v_accvgpr_read_b32 v45, a117
  v_accvgpr_read_b32 v46, a118
  v_accvgpr_read_b32 v47, a119
  v_mul_f32 v40, v40, v196
  v_mul_f32 v41, v41, v196
  v_mul_f32 v42, v42, v196
  v_mul_f32 v43, v43, v196
  v_mul_f32 v44, v44, v196
  v_mul_f32 v45, v45, v196
  v_mul_f32 v46, v46, v196
  v_mul_f32 v47, v47, v196
  v_cvt_pk_bf16_f32 v40, v40, v41
  v_cvt_pk_bf16_f32 v41, v42, v43
  v_cvt_pk_bf16_f32 v42, v44, v45
  v_cvt_pk_bf16_f32 v43, v46, v47
  buffer_store_dwordx4 v[40:43], v244, s[24:27], s42 offen offset:3072 sc1
  v_accvgpr_read_b32 v48, a104
  v_accvgpr_read_b32 v49, a105
  v_accvgpr_read_b32 v50, a106
  v_accvgpr_read_b32 v51, a107
  v_accvgpr_read_b32 v52, a120
  v_accvgpr_read_b32 v53, a121
  v_accvgpr_read_b32 v54, a122
  v_accvgpr_read_b32 v55, a123
  v_mul_f32 v48, v48, v200
  v_mul_f32 v49, v49, v200
  v_mul_f32 v50, v50, v200
  v_mul_f32 v51, v51, v200
  v_mul_f32 v52, v52, v200
  v_mul_f32 v53, v53, v200
  v_mul_f32 v54, v54, v200
  v_mul_f32 v55, v55, v200
  v_cvt_pk_bf16_f32 v48, v48, v49
  v_cvt_pk_bf16_f32 v49, v50, v51
  v_cvt_pk_bf16_f32 v50, v52, v53
  v_cvt_pk_bf16_f32 v51, v54, v55
  buffer_store_dwordx4 v[48:51], v244, s[24:27], s43 offen offset:1024 sc1
  v_accvgpr_read_b32 v56, a108
  v_accvgpr_read_b32 v57, a109
  v_accvgpr_read_b32 v58, a110
  v_accvgpr_read_b32 v59, a111
  v_accvgpr_read_b32 v60, a124
  v_accvgpr_read_b32 v61, a125
  v_accvgpr_read_b32 v62, a126
  v_accvgpr_read_b32 v63, a127
  v_mul_f32 v56, v56, v204
  v_mul_f32 v57, v57, v204
  v_mul_f32 v58, v58, v204
  v_mul_f32 v59, v59, v204
  v_mul_f32 v60, v60, v204
  v_mul_f32 v61, v61, v204
  v_mul_f32 v62, v62, v204
  v_mul_f32 v63, v63, v204
  v_cvt_pk_bf16_f32 v56, v56, v57
  v_cvt_pk_bf16_f32 v57, v58, v59
  v_cvt_pk_bf16_f32 v58, v60, v61
  v_cvt_pk_bf16_f32 v59, v62, v63
  buffer_store_dwordx4 v[56:59], v244, s[24:27], s43 offen offset:3072 sc1
  s_branch tail_go
.section .rodata,"a"
.p2align 6
.amdhsa_kernel prep_kernel
  .amdhsa_next_free_vgpr 108
  .amdhsa_next_free_sgpr 96
  .amdhsa_accum_offset 108
  .amdhsa_group_segment_fixed_size 0
  .amdhsa_kernarg_size 104
  .amdhsa_user_sgpr_count 2
  .amdhsa_user_sgpr_kernarg_segment_ptr 1
  .amdhsa_system_sgpr_workgroup_id_x 1
.end_amdhsa_kernel
.p2align 6
.amdhsa_kernel attn_kernel
  .amdhsa_next_free_vgpr 512
  .amdhsa_next_free_sgpr 102
  .amdhsa_accum_offset 256
  .amdhsa_group_segment_fixed_size 0
  .amdhsa_kernarg_size 104
  .amdhsa_user_sgpr_count 2
  .amdhsa_user_sgpr_kernarg_segment_ptr 1
  .amdhsa_system_sgpr_workgroup_id_x 1
.end_amdhsa_kernel
```

```asm
; @launch grid=(256,1,1) block=(256,1,1) lds=163840
.amdgcn_target "amdgcn-amd-amdhsa--gfx950"
.text
.globl recurrent_scan__mha_block_cached__moe_arch_mod__prompt_kernel
.p2align 8
.type recurrent_scan__mha_block_cached__moe_arch_mod__prompt_kernel,@function
recurrent_scan__mha_block_cached__moe_arch_mod__prompt_kernel:
  s_cmp_ge_u32 s2, 256
  s_cbranch_scc1 attn_end
  s_load_dwordx2 s[60:61], s[0:1], 0
  s_load_dwordx2 s[48:49], s[0:1], 48
  s_load_dwordx4 s[4:7], s[0:1], 8
  s_load_dwordx2 s[8:9], s[0:1], 24
  s_load_dwordx2 s[10:11], s[0:1], 96
  s_load_dwordx2 s[88:89], s[0:1], 32
  s_load_dwordx2 s[90:91], s[0:1], 56
  s_load_dwordx4 s[92:95], s[0:1], 64
  s_load_dwordx2 s[96:97], s[0:1], 88
  s_load_dwordx2 s[62:63], s[0:1], 80
  s_getpc_b64 s[98:99]
attn_hot_pc:
  s_add_u32 s98, s98, attn_hot-attn_hot_pc
  s_addc_u32 s99, s99, 0
  v_lshlrev_b32 v249, 7, v0
  v_min_u32 v249, attn_end-attn_hot-4, v249
  global_load_dword v255, v249, s[98:99]
  v_add_u32 v249, 0x8000, v249
  v_min_u32 v249, attn_end-attn_hot-4, v249
  global_load_dword v255, v249, s[98:99]
attn_hot:
  v_lshrrev_b32 v249, 6, v0
  v_and_b32 v0, 63, v0
  v_mov_b32 v245, v0
  v_readfirstlane_b32 s3, v249
  s_and_b32 s36, s2, 7
  s_lshl_b32 s36, s36, 2
  s_lshr_b32 s37, s2, 6
  s_add_u32 s36, s36, s37
  s_bfe_u32 s37, s2, 0x30003
  s_lshl_b32 s37, s37, 2
  s_add_u32 s37, s37, s3
  s_lshl_b32 s28, s3, 12
  v_lshrrev_b32 v248, 4, v245
  v_and_b32 v247, 15, v245
  s_lshl_b32 s38, s3, 17
  v_lshlrev_b32 v249, 13, v248
  v_add_u32 v249, s38, v249
  v_or_b32 v250, 0, v248
  v_lshlrev_b32 v250, 1, v250
  v_xor_b32 v250, v250, v247
  v_lshl_add_u32 v238, v250, 4, v249
  v_or_b32 v250, 0, v248
  v_lshlrev_b32 v250, 1, v250
  v_xor_b32 v250, v250, v247
  v_lshl_add_u32 v239, v250, 4, v249
  v_add_u32 v239, 31744, v239
  v_or_b32 v250, 4, v248
  v_lshlrev_b32 v250, 1, v250
  v_xor_b32 v250, v250, v247
  v_lshl_add_u32 v240, v250, 4, v249
  v_add_u32 v240, 63488, v240
  v_or_b32 v250, 4, v248
  v_lshlrev_b32 v250, 1, v250
  v_xor_b32 v250, v250, v247
  v_lshl_add_u32 v241, v250, 4, v249
  v_add_u32 v241, 95232, v241
  s_waitcnt lgkmcnt(0)
  s_mov_b32 s24, s10
  s_mov_b32 s25, s11
  s_mov_b32 s26, 33554432
  s_mov_b32 s27, 0x20000
  s_lshl_b32 s38, s36, 8
  s_add_u32 s20, s8, s38
  s_addc_u32 s21, s9, 0
  s_mov_b32 s22, 5242880
  s_mov_b32 s23, 0x20000
  s_sub_u32 s22, s22, s38
  s_cmp_ge_u32 s3, 2
  s_cbranch_scc1 front_fetch
  s_mov_b32 s12, s60
  s_mov_b32 s13, s61
  s_mov_b32 s14, 2621440
  s_mov_b32 s15, 0x20000
  s_mov_b32 s16, s48
  s_mov_b32 s17, s49
  s_mov_b32 s18, 1280
  s_mov_b32 s19, 0x20000
  s_lshr_b32 s52, s37, 2
  s_lshl_b32 s52, s52, 5
  s_add_u32 s52, s52, s36
  s_lshl_b32 s52, s52, 1
  s_add_u32 s52, s52, s3
  s_lshl_b32 s52, s52, 2
  s_mul_i32 s53, s52, 1280
  v_lshrrev_b32 v1, 4, v0
  v_and_b32 v2, 15, v0
  v_lshlrev_b32 v3, 4, v2
  v_mul_u32_u24 v4, 0x500, v1
  v_add_u32 v4, v4, v3
  buffer_load_dwordx4 v[8:11], v4, s[12:15], s53 offen offset:0
  buffer_load_dwordx4 v[12:15], v4, s[12:15], s53 offen offset:256
  buffer_load_dwordx4 v[16:19], v4, s[12:15], s53 offen offset:512
  buffer_load_dwordx4 v[20:23], v4, s[12:15], s53 offen offset:768
  buffer_load_dwordx4 v[24:27], v4, s[12:15], s53 offen offset:1024
  buffer_load_dwordx4 v[28:31], v3, s[16:19], 0 offen offset:0
  buffer_load_dwordx4 v[32:35], v3, s[16:19], 0 offen offset:256
  buffer_load_dwordx4 v[36:39], v3, s[16:19], 0 offen offset:512
  buffer_load_dwordx4 v[40:43], v3, s[16:19], 0 offen offset:768
  buffer_load_dwordx4 v[44:47], v3, s[16:19], 0 offen offset:1024
  v_mov_b32 v7, 0
  v_lshlrev_b32 v6, 26, v0
  s_lshl_b32 s53, s2, 7
  s_add_u32 s53, s53, 2834432
  buffer_store_dword v7, v6, s[24:27], s53 offen sc1
  v_lshlrev_b32 v6, 8, v0
  s_cmp_eq_u32 s2, 0
  s_cselect_b32 s53, 0, 1073741824
  v_or_b32 v6, s53, v6
  s_mov_b32 s53, 2818048
  buffer_store_dword v7, v6, s[24:27], s53 offen sc1
  s_lshr_b32 s53, s52, 6
  s_mul_i32 s53, s53, 81920
  s_bfe_u32 s54, s52, 0x20004
  s_lshl_b32 s54, s54, 10
  s_add_u32 s53, s53, s54
  s_and_b32 s54, s52, 15
  s_lshl_b32 s54, s54, 4
  s_add_u32 s53, s53, s54
  v_lshrrev_b32 v5, 2, v2
  v_lshlrev_b32 v5, 12, v5
  v_and_b32 v6, 3, v2
  v_lshl_add_u32 v5, v6, 8, v5
  v_lshl_add_u32 v5, v1, 4, v5
  s_mov_b32 s56, 0xffff0000
  s_waitcnt vmcnt(11)
  v_lshlrev_b32 v48, 16, v8
  v_and_b32 v49, s56, v8
  v_lshlrev_b32 v50, 16, v9
  v_and_b32 v51, s56, v9
  v_lshlrev_b32 v52, 16, v10
  v_and_b32 v53, s56, v10
  v_lshlrev_b32 v54, 16, v11
  v_and_b32 v55, s56, v11
  s_waitcnt vmcnt(10)
  v_lshlrev_b32 v56, 16, v12
  v_and_b32 v57, s56, v12
  v_lshlrev_b32 v58, 16, v13
  v_and_b32 v59, s56, v13
  v_lshlrev_b32 v60, 16, v14
  v_and_b32 v61, s56, v14
  v_lshlrev_b32 v62, 16, v15
  v_and_b32 v63, s56, v15
  s_waitcnt vmcnt(9)
  v_lshlrev_b32 v64, 16, v16
  v_and_b32 v65, s56, v16
  v_lshlrev_b32 v66, 16, v17
  v_and_b32 v67, s56, v17
  v_lshlrev_b32 v68, 16, v18
  v_and_b32 v69, s56, v18
  v_lshlrev_b32 v70, 16, v19
  v_and_b32 v71, s56, v19
  s_waitcnt vmcnt(8)
  v_lshlrev_b32 v72, 16, v20
  v_and_b32 v73, s56, v20
  v_lshlrev_b32 v74, 16, v21
  v_and_b32 v75, s56, v21
  v_lshlrev_b32 v76, 16, v22
  v_and_b32 v77, s56, v22
  v_lshlrev_b32 v78, 16, v23
  v_and_b32 v79, s56, v23
  s_waitcnt vmcnt(7)
  v_lshlrev_b32 v80, 16, v24
  v_and_b32 v81, s56, v24
  v_lshlrev_b32 v82, 16, v25
  v_and_b32 v83, s56, v25
  v_lshlrev_b32 v84, 16, v26
  v_and_b32 v85, s56, v26
  v_lshlrev_b32 v86, 16, v27
  v_and_b32 v87, s56, v27
  v_pk_add_f32 v[88:89], v[48:49], v[50:51]
  v_pk_add_f32 v[90:91], v[52:53], v[54:55]
  v_pk_add_f32 v[88:89], v[88:89], v[56:57]
  v_pk_add_f32 v[90:91], v[90:91], v[58:59]
  v_pk_add_f32 v[88:89], v[88:89], v[60:61]
  v_pk_add_f32 v[90:91], v[90:91], v[62:63]
  v_pk_add_f32 v[88:89], v[88:89], v[64:65]
  v_pk_add_f32 v[90:91], v[90:91], v[66:67]
  v_pk_add_f32 v[88:89], v[88:89], v[68:69]
  v_pk_add_f32 v[90:91], v[90:91], v[70:71]
  v_pk_add_f32 v[88:89], v[88:89], v[72:73]
  v_pk_add_f32 v[90:91], v[90:91], v[74:75]
  v_pk_add_f32 v[88:89], v[88:89], v[76:77]
  v_pk_add_f32 v[90:91], v[90:91], v[78:79]
  v_pk_add_f32 v[88:89], v[88:89], v[80:81]
  v_pk_add_f32 v[90:91], v[90:91], v[82:83]
  v_pk_add_f32 v[88:89], v[88:89], v[84:85]
  v_pk_add_f32 v[90:91], v[90:91], v[86:87]
  v_pk_add_f32 v[88:89], v[88:89], v[90:91]
  v_add_f32 v92, v88, v89
  s_nop 1
  v_add_f32_dpp v92, v92, v92 row_ror:8 row_mask:0xf bank_mask:0xf
  s_nop 1
  v_add_f32_dpp v92, v92, v92 row_ror:4 row_mask:0xf bank_mask:0xf
  s_nop 1
  v_add_f32_dpp v92, v92, v92 row_ror:2 row_mask:0xf bank_mask:0xf
  s_nop 1
  v_add_f32_dpp v92, v92, v92 row_ror:1 row_mask:0xf bank_mask:0xf
  v_mul_f32 v92, 0x3acccccd, v92
  v_pk_add_f32 v[94:95], v[48:49], v[92:93] op_sel_hi:[1,0] neg_lo:[0,1] neg_hi:[0,1]
  v_pk_mul_f32 v[88:89], v[94:95], v[94:95]
  v_pk_add_f32 v[96:97], v[50:51], v[92:93] op_sel_hi:[1,0] neg_lo:[0,1] neg_hi:[0,1]
  v_pk_mul_f32 v[90:91], v[96:97], v[96:97]
  v_pk_add_f32 v[94:95], v[52:53], v[92:93] op_sel_hi:[1,0] neg_lo:[0,1] neg_hi:[0,1]
  v_pk_fma_f32 v[88:89], v[94:95], v[94:95], v[88:89]
  v_pk_add_f32 v[96:97], v[54:55], v[92:93] op_sel_hi:[1,0] neg_lo:[0,1] neg_hi:[0,1]
  v_pk_fma_f32 v[90:91], v[96:97], v[96:97], v[90:91]
  v_pk_add_f32 v[94:95], v[56:57], v[92:93] op_sel_hi:[1,0] neg_lo:[0,1] neg_hi:[0,1]
  v_pk_fma_f32 v[88:89], v[94:95], v[94:95], v[88:89]
  v_pk_add_f32 v[96:97], v[58:59], v[92:93] op_sel_hi:[1,0] neg_lo:[0,1] neg_hi:[0,1]
  v_pk_fma_f32 v[90:91], v[96:97], v[96:97], v[90:91]
  v_pk_add_f32 v[94:95], v[60:61], v[92:93] op_sel_hi:[1,0] neg_lo:[0,1] neg_hi:[0,1]
  v_pk_fma_f32 v[88:89], v[94:95], v[94:95], v[88:89]
  v_pk_add_f32 v[96:97], v[62:63], v[92:93] op_sel_hi:[1,0] neg_lo:[0,1] neg_hi:[0,1]
  v_pk_fma_f32 v[90:91], v[96:97], v[96:97], v[90:91]
  v_pk_add_f32 v[94:95], v[64:65], v[92:93] op_sel_hi:[1,0] neg_lo:[0,1] neg_hi:[0,1]
  v_pk_fma_f32 v[88:89], v[94:95], v[94:95], v[88:89]
  v_pk_add_f32 v[96:97], v[66:67], v[92:93] op_sel_hi:[1,0] neg_lo:[0,1] neg_hi:[0,1]
  v_pk_fma_f32 v[90:91], v[96:97], v[96:97], v[90:91]
  v_pk_add_f32 v[94:95], v[68:69], v[92:93] op_sel_hi:[1,0] neg_lo:[0,1] neg_hi:[0,1]
  v_pk_fma_f32 v[88:89], v[94:95], v[94:95], v[88:89]
  v_pk_add_f32 v[96:97], v[70:71], v[92:93] op_sel_hi:[1,0] neg_lo:[0,1] neg_hi:[0,1]
  v_pk_fma_f32 v[90:91], v[96:97], v[96:97], v[90:91]
  v_pk_add_f32 v[94:95], v[72:73], v[92:93] op_sel_hi:[1,0] neg_lo:[0,1] neg_hi:[0,1]
  v_pk_fma_f32 v[88:89], v[94:95], v[94:95], v[88:89]
  v_pk_add_f32 v[96:97], v[74:75], v[92:93] op_sel_hi:[1,0] neg_lo:[0,1] neg_hi:[0,1]
  v_pk_fma_f32 v[90:91], v[96:97], v[96:97], v[90:91]
  v_pk_add_f32 v[94:95], v[76:77], v[92:93] op_sel_hi:[1,0] neg_lo:[0,1] neg_hi:[0,1]
  v_pk_fma_f32 v[88:89], v[94:95], v[94:95], v[88:89]
  v_pk_add_f32 v[96:97], v[78:79], v[92:93] op_sel_hi:[1,0] neg_lo:[0,1] neg_hi:[0,1]
  v_pk_fma_f32 v[90:91], v[96:97], v[96:97], v[90:91]
  v_pk_add_f32 v[94:95], v[80:81], v[92:93] op_sel_hi:[1,0] neg_lo:[0,1] neg_hi:[0,1]
  v_pk_fma_f32 v[88:89], v[94:95], v[94:95], v[88:89]
  v_pk_add_f32 v[96:97], v[82:83], v[92:93] op_sel_hi:[1,0] neg_lo:[0,1] neg_hi:[0,1]
  v_pk_fma_f32 v[90:91], v[96:97], v[96:97], v[90:91]
  v_pk_add_f32 v[94:95], v[84:85], v[92:93] op_sel_hi:[1,0] neg_lo:[0,1] neg_hi:[0,1]
  v_pk_fma_f32 v[88:89], v[94:95], v[94:95], v[88:89]
  v_pk_add_f32 v[96:97], v[86:87], v[92:93] op_sel_hi:[1,0] neg_lo:[0,1] neg_hi:[0,1]
  v_pk_fma_f32 v[90:91], v[96:97], v[96:97], v[90:91]
  v_pk_add_f32 v[88:89], v[88:89], v[90:91]
  v_add_f32 v98, v88, v89
  s_nop 1
  v_add_f32_dpp v98, v98, v98 row_ror:8 row_mask:0xf bank_mask:0xf
  v_cvt_pk_bf16_f32 v92, v92, v92
  s_nop 0
  v_add_f32_dpp v98, v98, v98 row_ror:4 row_mask:0xf bank_mask:0xf
  v_lshlrev_b32 v92, 16, v92
  s_nop 0
  v_add_f32_dpp v98, v98, v98 row_ror:2 row_mask:0xf bank_mask:0xf
  s_nop 1
  v_add_f32_dpp v98, v98, v98 row_ror:1 row_mask:0xf bank_mask:0xf
  v_mul_f32 v98, 0x3acccccd, v98
  v_cvt_pk_bf16_f32 v98, v98, v98
  v_pk_add_f32 v[48:49], v[48:49], v[92:93] op_sel_hi:[1,0] neg_lo:[0,1] neg_hi:[0,1]
  v_lshlrev_b32 v98, 16, v98
  v_pk_add_f32 v[50:51], v[50:51], v[92:93] op_sel_hi:[1,0] neg_lo:[0,1] neg_hi:[0,1]
  v_add_f32 v98, 0x3727c5ac, v98
  v_pk_add_f32 v[52:53], v[52:53], v[92:93] op_sel_hi:[1,0] neg_lo:[0,1] neg_hi:[0,1]
  v_cvt_pk_bf16_f32 v98, v98, v98
  v_pk_add_f32 v[54:55], v[54:55], v[92:93] op_sel_hi:[1,0] neg_lo:[0,1] neg_hi:[0,1]
  v_lshlrev_b32 v98, 16, v98
  v_pk_add_f32 v[56:57], v[56:57], v[92:93] op_sel_hi:[1,0] neg_lo:[0,1] neg_hi:[0,1]
  v_sqrt_f32 v98, v98
  v_pk_add_f32 v[58:59], v[58:59], v[92:93] op_sel_hi:[1,0] neg_lo:[0,1] neg_hi:[0,1]
  v_cvt_pk_bf16_f32 v98, v98, v98
  v_pk_add_f32 v[60:61], v[60:61], v[92:93] op_sel_hi:[1,0] neg_lo:[0,1] neg_hi:[0,1]
  v_lshlrev_b32 v98, 16, v98
  v_pk_add_f32 v[62:63], v[62:63], v[92:93] op_sel_hi:[1,0] neg_lo:[0,1] neg_hi:[0,1]
  v_rcp_f32 v100, v98
  v_pk_add_f32 v[64:65], v[64:65], v[92:93] op_sel_hi:[1,0] neg_lo:[0,1] neg_hi:[0,1]
  v_pk_add_f32 v[66:67], v[66:67], v[92:93] op_sel_hi:[1,0] neg_lo:[0,1] neg_hi:[0,1]
  v_pk_add_f32 v[68:69], v[68:69], v[92:93] op_sel_hi:[1,0] neg_lo:[0,1] neg_hi:[0,1]
  v_pk_add_f32 v[70:71], v[70:71], v[92:93] op_sel_hi:[1,0] neg_lo:[0,1] neg_hi:[0,1]
  v_pk_add_f32 v[72:73], v[72:73], v[92:93] op_sel_hi:[1,0] neg_lo:[0,1] neg_hi:[0,1]
  v_pk_add_f32 v[74:75], v[74:75], v[92:93] op_sel_hi:[1,0] neg_lo:[0,1] neg_hi:[0,1]
  v_pk_add_f32 v[76:77], v[76:77], v[92:93] op_sel_hi:[1,0] neg_lo:[0,1] neg_hi:[0,1]
  v_pk_add_f32 v[78:79], v[78:79], v[92:93] op_sel_hi:[1,0] neg_lo:[0,1] neg_hi:[0,1]
  v_pk_add_f32 v[80:81], v[80:81], v[92:93] op_sel_hi:[1,0] neg_lo:[0,1] neg_hi:[0,1]
  v_pk_add_f32 v[82:83], v[82:83], v[92:93] op_sel_hi:[1,0] neg_lo:[0,1] neg_hi:[0,1]
  v_pk_add_f32 v[84:85], v[84:85], v[92:93] op_sel_hi:[1,0] neg_lo:[0,1] neg_hi:[0,1]
  v_pk_add_f32 v[86:87], v[86:87], v[92:93] op_sel_hi:[1,0] neg_lo:[0,1] neg_hi:[0,1]
  v_mov_b32 v104, 0
  v_mov_b32 v105, 0
  v_cvt_pk_bf16_f32 v8, v48, v49
  v_cvt_pk_bf16_f32 v9, v50, v51
  v_cvt_pk_bf16_f32 v10, v52, v53
  v_cvt_pk_bf16_f32 v11, v54, v55
  v_cvt_pk_bf16_f32 v12, v56, v57
  v_cvt_pk_bf16_f32 v13, v58, v59
  v_cvt_pk_bf16_f32 v14, v60, v61
  v_cvt_pk_bf16_f32 v15, v62, v63
  v_cvt_pk_bf16_f32 v16, v64, v65
  v_cvt_pk_bf16_f32 v17, v66, v67
  v_cvt_pk_bf16_f32 v18, v68, v69
  v_cvt_pk_bf16_f32 v19, v70, v71
  v_cvt_pk_bf16_f32 v20, v72, v73
  v_cvt_pk_bf16_f32 v21, v74, v75
  v_cvt_pk_bf16_f32 v22, v76, v77
  v_cvt_pk_bf16_f32 v23, v78, v79
  v_cvt_pk_bf16_f32 v24, v80, v81
  v_cvt_pk_bf16_f32 v25, v82, v83
  v_cvt_pk_bf16_f32 v26, v84, v85
  v_cvt_pk_bf16_f32 v27, v86, v87
  v_lshlrev_b32 v48, 16, v8
  v_and_b32 v49, s56, v8
  v_lshlrev_b32 v50, 16, v9
  v_and_b32 v51, s56, v9
  v_lshlrev_b32 v52, 16, v10
  v_and_b32 v53, s56, v10
  v_lshlrev_b32 v54, 16, v11
  v_and_b32 v55, s56, v11
  v_lshlrev_b32 v56, 16, v12
  v_and_b32 v57, s56, v12
  v_lshlrev_b32 v58, 16, v13
  v_and_b32 v59, s56, v13
  v_lshlrev_b32 v60, 16, v14
  v_and_b32 v61, s56, v14
  v_lshlrev_b32 v62, 16, v15
  v_and_b32 v63, s56, v15
  v_lshlrev_b32 v64, 16, v16
  v_and_b32 v65, s56, v16
  v_lshlrev_b32 v66, 16, v17
  v_and_b32 v67, s56, v17
  v_lshlrev_b32 v68, 16, v18
  v_and_b32 v69, s56, v18
  v_lshlrev_b32 v70, 16, v19
  v_and_b32 v71, s56, v19
  v_lshlrev_b32 v72, 16, v20
  v_and_b32 v73, s56, v20
  v_lshlrev_b32 v74, 16, v21
  v_and_b32 v75, s56, v21
  v_lshlrev_b32 v76, 16, v22
  v_and_b32 v77, s56, v22
  v_lshlrev_b32 v78, 16, v23
  v_and_b32 v79, s56, v23
  v_lshlrev_b32 v80, 16, v24
  v_and_b32 v81, s56, v24
  v_lshlrev_b32 v82, 16, v25
  v_and_b32 v83, s56, v25
  v_lshlrev_b32 v84, 16, v26
  v_and_b32 v85, s56, v26
  v_lshlrev_b32 v86, 16, v27
  v_and_b32 v87, s56, v27
  v_pk_mul_f32 v[48:49], v[48:49], v[100:101] op_sel_hi:[1,0]
  v_pk_mul_f32 v[50:51], v[50:51], v[100:101] op_sel_hi:[1,0]
  v_pk_mul_f32 v[52:53], v[52:53], v[100:101] op_sel_hi:[1,0]
  v_pk_mul_f32 v[54:55], v[54:55], v[100:101] op_sel_hi:[1,0]
  v_cvt_pk_bf16_f32 v8, v48, v49
  v_cvt_pk_bf16_f32 v9, v50, v51
  v_cvt_pk_bf16_f32 v10, v52, v53
  v_cvt_pk_bf16_f32 v11, v54, v55
  buffer_store_dwordx4 v[8:11], v5, s[24:27], s53 offen sc1
  s_add_u32 s53, s53, 16384
  v_pk_mul_f32 v[56:57], v[56:57], v[100:101] op_sel_hi:[1,0]
  v_pk_mul_f32 v[58:59], v[58:59], v[100:101] op_sel_hi:[1,0]
  v_pk_mul_f32 v[60:61], v[60:61], v[100:101] op_sel_hi:[1,0]
  v_pk_mul_f32 v[62:63], v[62:63], v[100:101] op_sel_hi:[1,0]
  v_cvt_pk_bf16_f32 v12, v56, v57
  v_cvt_pk_bf16_f32 v13, v58, v59
  v_cvt_pk_bf16_f32 v14, v60, v61
  v_cvt_pk_bf16_f32 v15, v62, v63
  buffer_store_dwordx4 v[12:15], v5, s[24:27], s53 offen sc1
  s_add_u32 s53, s53, 16384
  v_pk_mul_f32 v[64:65], v[64:65], v[100:101] op_sel_hi:[1,0]
  v_pk_mul_f32 v[66:67], v[66:67], v[100:101] op_sel_hi:[1,0]
  v_pk_mul_f32 v[68:69], v[68:69], v[100:101] op_sel_hi:[1,0]
  v_pk_mul_f32 v[70:71], v[70:71], v[100:101] op_sel_hi:[1,0]
  v_cvt_pk_bf16_f32 v16, v64, v65
  v_cvt_pk_bf16_f32 v17, v66, v67
  v_cvt_pk_bf16_f32 v18, v68, v69
  v_cvt_pk_bf16_f32 v19, v70, v71
  buffer_store_dwordx4 v[16:19], v5, s[24:27], s53 offen sc1
  s_add_u32 s53, s53, 16384
  v_pk_mul_f32 v[72:73], v[72:73], v[100:101] op_sel_hi:[1,0]
  v_pk_mul_f32 v[74:75], v[74:75], v[100:101] op_sel_hi:[1,0]
  v_pk_mul_f32 v[76:77], v[76:77], v[100:101] op_sel_hi:[1,0]
  v_pk_mul_f32 v[78:79], v[78:79], v[100:101] op_sel_hi:[1,0]
  v_cvt_pk_bf16_f32 v20, v72, v73
  v_cvt_pk_bf16_f32 v21, v74, v75
  v_cvt_pk_bf16_f32 v22, v76, v77
  v_cvt_pk_bf16_f32 v23, v78, v79
  buffer_store_dwordx4 v[20:23], v5, s[24:27], s53 offen sc1
  s_add_u32 s53, s53, 16384
  v_pk_mul_f32 v[80:81], v[80:81], v[100:101] op_sel_hi:[1,0]
  v_pk_mul_f32 v[82:83], v[82:83], v[100:101] op_sel_hi:[1,0]
  v_pk_mul_f32 v[84:85], v[84:85], v[100:101] op_sel_hi:[1,0]
  v_pk_mul_f32 v[86:87], v[86:87], v[100:101] op_sel_hi:[1,0]
  v_cvt_pk_bf16_f32 v24, v80, v81
  v_cvt_pk_bf16_f32 v25, v82, v83
  v_cvt_pk_bf16_f32 v26, v84, v85
  v_cvt_pk_bf16_f32 v27, v86, v87
  buffer_store_dwordx4 v[24:27], v5, s[24:27], s53 offen sc1
  s_add_u32 s53, s53, 16384
  s_waitcnt vmcnt(11)
  v_dot2_f32_bf16 v104, v8, v28, v104
  v_dot2_f32_bf16 v105, v9, v29, v105
  v_dot2_f32_bf16 v104, v10, v30, v104
  v_dot2_f32_bf16 v105, v11, v31, v105
  s_waitcnt vmcnt(10)
  v_dot2_f32_bf16 v104, v12, v32, v104
  v_dot2_f32_bf16 v105, v13, v33, v105
  v_dot2_f32_bf16 v104, v14, v34, v104
  v_dot2_f32_bf16 v105, v15, v35, v105
  s_waitcnt vmcnt(9)
  v_dot2_f32_bf16 v104, v16, v36, v104
  v_dot2_f32_bf16 v105, v17, v37, v105
  v_dot2_f32_bf16 v104, v18, v38, v104
  v_dot2_f32_bf16 v105, v19, v39, v105
  s_waitcnt vmcnt(8)
  v_dot2_f32_bf16 v104, v20, v40, v104
  v_dot2_f32_bf16 v105, v21, v41, v105
  v_dot2_f32_bf16 v104, v22, v42, v104
  v_dot2_f32_bf16 v105, v23, v43, v105
  s_waitcnt vmcnt(7)
  v_dot2_f32_bf16 v104, v24, v44, v104
  v_dot2_f32_bf16 v105, v25, v45, v105
  v_dot2_f32_bf16 v104, v26, v46, v104
  v_dot2_f32_bf16 v105, v27, v47, v105
  s_nop 2
  v_add_f32 v104, v104, v105
  s_nop 1
  v_add_f32_dpp v104, v104, v104 row_ror:8 row_mask:0xf bank_mask:0xf
  s_nop 1
  v_add_f32_dpp v104, v104, v104 row_ror:4 row_mask:0xf bank_mask:0xf
  s_nop 1
  v_add_f32_dpp v104, v104, v104 row_ror:2 row_mask:0xf bank_mask:0xf
  s_nop 1
  v_add_f32_dpp v104, v104, v104 row_ror:1 row_mask:0xf bank_mask:0xf
  v_cvt_pk_bf16_f32 v104, v104, v104
  v_lshlrev_b32 v104, 16, v104
  v_ashrrev_i32 v105, 31, v104
  v_or_b32 v105, 0x80000000, v105
  v_xor_b32 v104, v104, v105
  v_and_b32 v104, s56, v104
  v_add_u32 v6, s52, v1
  v_sub_u32 v7, 0xffff, v6
  v_or_b32 v104, v104, v7
  v_lshlrev_b32 v6, 2, v6
  v_lshl_add_u32 v6, v2, 26, v6
  s_mov_b32 s53, 2621440
  buffer_store_dword v104, v6, s[24:27], s53 offen sc1
  s_waitcnt vmcnt(0)
  s_branch front_join
front_fetch:
  v_subrev_u32 v16, 0x40000, v238
  v_subrev_u32 v17, 0x40000, v239
  v_subrev_u32 v18, 0x40000, v240
  v_subrev_u32 v19, 0x40000, v241
front_join:
  s_barrier
  s_mov_b32 s44, s96
  s_mov_b32 s45, s97
  s_mov_b32 s46, 256
  s_mov_b32 s47, 0x20000
  s_bfe_u32 s58, s2, 0x30003
  s_lshl_b32 s58, s58, 5
  s_lshl_b32 s54, s3, 12
  v_lshlrev_b32 v1, 8, v0
  v_add_u32 v1, s54, v1
  v_mov_b32 v2, 1
  buffer_atomic_add v2, v1, s[44:47], s58 offen
  s_cmp_lt_u32 s3, 2
  s_cbranch_scc1 front_addr
  s_mov_b32 s31, 0
  s_add_u32 m0, s28, 90112
  s_nop 0
  buffer_load_dwordx4 v16, s[20:23], s31 offen offset:0 lds
  buffer_load_dwordx4 v17, s[20:23], s31 offen offset:1024 lds
  buffer_load_dwordx4 v18, s[20:23], s31 offen offset:2048 lds
  buffer_load_dwordx4 v19, s[20:23], s31 offen offset:3072 lds
  s_add_u32 m0, s28, 98304
  s_nop 0
  buffer_load_dwordx4 v238, s[20:23], s31 offen offset:0 lds
  buffer_load_dwordx4 v239, s[20:23], s31 offen offset:1024 lds
  buffer_load_dwordx4 v240, s[20:23], s31 offen offset:2048 lds
  buffer_load_dwordx4 v241, s[20:23], s31 offen offset:3072 lds
  s_mov_b32 s31, 524288
  s_add_u32 m0, s28, 106496
  s_nop 0
  buffer_load_dwordx4 v16, s[20:23], s31 offen offset:0 lds
  buffer_load_dwordx4 v17, s[20:23], s31 offen offset:1024 lds
  buffer_load_dwordx4 v18, s[20:23], s31 offen offset:2048 lds
  buffer_load_dwordx4 v19, s[20:23], s31 offen offset:3072 lds
  s_add_u32 m0, s28, 114688
  s_nop 0
  buffer_load_dwordx4 v238, s[20:23], s31 offen offset:0 lds
  buffer_load_dwordx4 v239, s[20:23], s31 offen offset:1024 lds
  buffer_load_dwordx4 v240, s[20:23], s31 offen offset:2048 lds
  buffer_load_dwordx4 v241, s[20:23], s31 offen offset:3072 lds
  s_mov_b32 s31, 1048576
  s_add_u32 m0, s28, 57344
  s_nop 0
  buffer_load_dwordx4 v16, s[20:23], s31 offen offset:0 lds
  buffer_load_dwordx4 v17, s[20:23], s31 offen offset:1024 lds
  buffer_load_dwordx4 v18, s[20:23], s31 offen offset:2048 lds
  buffer_load_dwordx4 v19, s[20:23], s31 offen offset:3072 lds
  s_add_u32 m0, s28, 65536
  s_nop 0
  buffer_load_dwordx4 v238, s[20:23], s31 offen offset:0 lds
  buffer_load_dwordx4 v239, s[20:23], s31 offen offset:1024 lds
  buffer_load_dwordx4 v240, s[20:23], s31 offen offset:2048 lds
  buffer_load_dwordx4 v241, s[20:23], s31 offen offset:3072 lds
  s_mov_b32 s31, 1572864
  s_add_u32 m0, s28, 73728
  s_nop 0
  buffer_load_dwordx4 v16, s[20:23], s31 offen offset:0 lds
  buffer_load_dwordx4 v17, s[20:23], s31 offen offset:1024 lds
  buffer_load_dwordx4 v18, s[20:23], s31 offen offset:2048 lds
  buffer_load_dwordx4 v19, s[20:23], s31 offen offset:3072 lds
  s_add_u32 m0, s28, 81920
  s_nop 0
  buffer_load_dwordx4 v238, s[20:23], s31 offen offset:0 lds
  buffer_load_dwordx4 v239, s[20:23], s31 offen offset:1024 lds
  buffer_load_dwordx4 v240, s[20:23], s31 offen offset:2048 lds
  buffer_load_dwordx4 v241, s[20:23], s31 offen offset:3072 lds
front_addr:
  s_mov_b32 s31, 0x200000
  v_lshlrev_b32 v242, 4, v245
  v_add_u32 v243, 0x1000, v242
  s_mul_i32 s30, s37, 81920
  s_lshl_b32 s38, s36, 19
  s_add_u32 s12, s4, s38
  s_addc_u32 s13, s5, 0
  s_mov_b32 s14, 524288
  s_mov_b32 s15, 0x20000
  s_add_u32 s16, s6, s38
  s_addc_u32 s17, s7, 0
  s_mov_b32 s18, 524288
  s_mov_b32 s19, 0x20000
  v_lshlrev_b32 v249, 8, v248
  v_add_u32 v249, s28, v249
  v_add_u32 v250, 0, v248
  v_xor_b32 v250, v250, v247
  v_lshl_add_u32 v232, v250, 4, v249
  v_add_u32 v250, 4, v248
  v_xor_b32 v250, v250, v247
  v_lshl_add_u32 v233, v250, 4, v249
  v_add_u32 v250, 8, v248
  v_xor_b32 v250, v250, v247
  v_lshl_add_u32 v234, v250, 4, v249
  v_add_u32 v250, 12, v248
  v_xor_b32 v250, v250, v247
  v_lshl_add_u32 v235, v250, 4, v249
  v_add_u32 v250, 0, v248
  v_lshlrev_b32 v250, 1, v250
  v_xor_b32 v250, v250, v247
  v_lshl_add_u32 v236, v250, 4, v249
  v_add_u32 v250, 4, v248
  v_lshlrev_b32 v250, 1, v250
  v_xor_b32 v250, v250, v247
  v_lshl_add_u32 v237, v250, 4, v249
  v_lshrrev_b32 v249, 1, v248
  v_and_b32 v250, 1, v248
  v_lshl_or_b32 v249, v250, 1, v249
  v_xor_b32 v249, v249, v247
  v_lshlrev_b32 v249, 4, v249
  v_lshl_add_u32 v212, v247, 8, v249
  v_xor_b32 v213, 64, v212
  v_xor_b32 v214, 128, v212
  v_xor_b32 v215, 192, v212
  v_bfe_u32 v246, v245, 2, 2
  v_and_b32 v247, 3, v245
  v_lshlrev_b32 v247, 3, v247
  v_add_u32 v247, 65536, v247
  v_lshl_add_u32 v249, v248, 2, v246
  v_and_b32 v250, 7, v249
  v_lshl_add_u32 v250, v250, 5, v247
  v_lshl_add_u32 v216, v249, 8, v250
  v_lshl_add_u32 v249, v248, 3, v246
  v_and_b32 v250, 1, v248
  v_lshl_add_u32 v250, v250, 2, v246
  v_lshl_add_u32 v250, v250, 5, v247
  v_lshl_add_u32 v224, v249, 8, v250
  v_xor_b32 v217, 32, v216
  v_xor_b32 v225, 32, v224
  v_xor_b32 v218, 64, v216
  v_xor_b32 v226, 64, v224
  v_xor_b32 v219, 96, v216
  v_xor_b32 v227, 96, v224
  v_xor_b32 v220, 128, v216
  v_xor_b32 v228, 128, v224
  v_xor_b32 v221, 160, v216
  v_xor_b32 v229, 160, v224
  v_xor_b32 v222, 192, v216
  v_xor_b32 v230, 192, v224
  v_xor_b32 v223, 224, v216
  v_xor_b32 v231, 224, v224
  s_lshr_b32 s38, s2, 3
  s_min_u32 s38, s38, 26
  s_and_b32 s39, s2, 7
  s_mul_i32 s39, s39, 27
  s_add_u32 s33, s38, s39
  s_mul_i32 s50, s3, 6144
  s_add_u32 s50, s50, 133120
  v_mov_b32 v244, v242
  s_lshl_b32 s40, s37, 19
  s_lshl_b32 s38, s36, 14
  s_add_u32 s40, s40, s38
  s_add_u32 s40, s40, 8388608
  s_add_u32 s41, s40, 4096
  s_add_u32 s42, s40, 8192
  s_add_u32 s43, s40, 12288
  s_mov_b32 s34, 0x3e0293ee
  s_mov_b32 s29, 0
  v_and_b32 v249, 15, v245
  v_cmp_eq_u32 vcc, 0, v249
  v_mov_b32 v249, 0x3f803f80
  s_nop 0
  v_cndmask_b32 v249, 0, v249, vcc
  v_accvgpr_write_b32 a208, v249
  v_accvgpr_write_b32 a209, v249
  v_accvgpr_write_b32 a210, v249
  v_accvgpr_write_b32 a211, v249
  s_cmp_lg_u32 s3, 0
  s_cbranch_scc1 front_go
  s_mov_b32 s54, 32768
front_poll:
  buffer_load_dword v1, off, s[44:47], s58 sc1
  s_waitcnt vmcnt(0)
  v_cmp_gt_u32 vcc, 32, v1
  s_nop 0
  s_cbranch_vccz front_go
  s_sleep 2
  s_sub_u32 s54, s54, 1
  s_cmp_lg_u32 s54, 0
  s_cbranch_scc1 front_poll
front_go:
  s_waitcnt vmcnt(0)
  s_barrier
  buffer_load_dwordx4 a[0:3], v242, s[24:27], s30 offen offset:0 sc1
  buffer_load_dwordx4 a[4:7], v242, s[24:27], s30 offen offset:1024 sc1
  buffer_load_dwordx4 a[8:11], v242, s[24:27], s30 offen offset:2048 sc1
  buffer_load_dwordx4 a[12:15], v242, s[24:27], s30 offen offset:3072 sc1
  buffer_load_dwordx4 a[16:19], v243, s[24:27], s30 offen offset:0 sc1
  buffer_load_dwordx4 a[20:23], v243, s[24:27], s30 offen offset:1024 sc1
  buffer_load_dwordx4 a[24:27], v243, s[24:27], s30 offen offset:2048 sc1
  buffer_load_dwordx4 a[28:31], v243, s[24:27], s30 offen offset:3072 sc1
  s_add_u32 s30, s30, 8192
  buffer_load_dwordx4 a[32:35], v242, s[24:27], s30 offen offset:0 sc1
  buffer_load_dwordx4 a[36:39], v242, s[24:27], s30 offen offset:1024 sc1
  buffer_load_dwordx4 a[40:43], v242, s[24:27], s30 offen offset:2048 sc1
  buffer_load_dwordx4 a[44:47], v242, s[24:27], s30 offen offset:3072 sc1
  buffer_load_dwordx4 a[48:51], v243, s[24:27], s30 offen offset:0 sc1
  buffer_load_dwordx4 a[52:55], v243, s[24:27], s30 offen offset:1024 sc1
  buffer_load_dwordx4 a[56:59], v243, s[24:27], s30 offen offset:2048 sc1
  buffer_load_dwordx4 a[60:63], v243, s[24:27], s30 offen offset:3072 sc1
  s_add_u32 s30, s30, 8192
  ds_read_b64_tr_b16 a[160:161], v224 offset:32768
  ds_read_b64_tr_b16 a[162:163], v224 offset:33792
  ds_read_b64_tr_b16 a[164:165], v224 offset:40960
  ds_read_b64_tr_b16 a[166:167], v224 offset:41984
  ds_read_b64_tr_b16 a[168:169], v225 offset:32768
  ds_read_b64_tr_b16 a[170:171], v225 offset:33792
  ds_read_b64_tr_b16 a[172:173], v225 offset:40960
  ds_read_b64_tr_b16 a[174:175], v225 offset:41984
  s_waitcnt vmcnt(8) lgkmcnt(4)
  v_mfma_f32_16x16x32_bf16 v[0:3], a[160:163], a[0:3], 0
  ds_read_b64_tr_b16 a[176:177], v226 offset:32768
  buffer_load_dwordx4 a[64:67], v242, s[24:27], s30 offen offset:0 sc1
  v_mfma_f32_16x16x32_bf16 v[0:3], a[164:167], a[16:19], v[0:3]
  buffer_load_dwordx4 a[68:71], v242, s[24:27], s30 offen offset:1024 sc1
  v_mfma_f32_16x16x32_bf16 v[4:7], a[164:167], a[20:23], 0
  ds_read_b64_tr_b16 a[178:179], v226 offset:33792
  buffer_load_dwordx4 a[72:75], v242, s[24:27], s30 offen offset:2048 sc1
  v_mfma_f32_16x16x32_bf16 v[4:7], a[160:163], a[4:7], v[4:7]
  buffer_load_dwordx4 a[76:79], v242, s[24:27], s30 offen offset:3072 sc1
  v_mfma_f32_16x16x32_bf16 v[8:11], a[160:163], a[8:11], 0
  ds_read_b64_tr_b16 a[180:181], v226 offset:40960
  buffer_load_dwordx4 a[80:83], v243, s[24:27], s30 offen offset:0 sc1
  v_mfma_f32_16x16x32_bf16 v[8:11], a[164:167], a[24:27], v[8:11]
  buffer_load_dwordx4 a[84:87], v243, s[24:27], s30 offen offset:1024 sc1
  v_mfma_f32_16x16x32_bf16 v[12:15], a[164:167], a[28:31], 0
  ds_read_b64_tr_b16 a[182:183], v226 offset:41984
  buffer_load_dwordx4 a[88:91], v243, s[24:27], s30 offen offset:2048 sc1
  v_mfma_f32_16x16x32_bf16 v[12:15], a[160:163], a[12:15], v[12:15]
  s_waitcnt lgkmcnt(4)
  buffer_load_dwordx4 a[92:95], v243, s[24:27], s30 offen offset:3072 sc1
  s_add_u32 s30, s30, 8192
  v_mfma_f32_16x16x32_bf16 v[16:19], a[168:171], a[0:3], 0
  ds_read_b64_tr_b16 a[184:185], v227 offset:32768
  buffer_load_dwordx4 a[96:99], v242, s[24:27], s30 offen offset:0 sc1
  v_mfma_f32_16x16x32_bf16 v[16:19], a[172:175], a[16:19], v[16:19]
  buffer_load_dwordx4 a[100:103], v242, s[24:27], s30 offen offset:1024 sc1
  v_mfma_f32_16x16x32_bf16 v[20:23], a[172:175], a[20:23], 0
  ds_read_b64_tr_b16 a[186:187], v227 offset:33792
  buffer_load_dwordx4 a[104:107], v242, s[24:27], s30 offen offset:2048 sc1
  v_mfma_f32_16x16x32_bf16 v[20:23], a[168:171], a[4:7], v[20:23]
  buffer_load_dwordx4 a[108:111], v242, s[24:27], s30 offen offset:3072 sc1
  v_mfma_f32_16x16x32_bf16 v[24:27], a[168:171], a[8:11], 0
  ds_read_b64_tr_b16 a[188:189], v227 offset:40960
  buffer_load_dwordx4 a[112:115], v243, s[24:27], s30 offen offset:0 sc1
  v_mfma_f32_16x16x32_bf16 v[24:27], a[172:175], a[24:27], v[24:27]
  buffer_load_dwordx4 a[116:119], v243, s[24:27], s30 offen offset:1024 sc1
  v_mfma_f32_16x16x32_bf16 v[28:31], a[172:175], a[28:31], 0
  ds_read_b64_tr_b16 a[190:191], v227 offset:41984
  buffer_load_dwordx4 a[120:123], v243, s[24:27], s30 offen offset:2048 sc1
  v_mfma_f32_16x16x32_bf16 v[28:31], a[168:171], a[12:15], v[28:31]
  s_waitcnt lgkmcnt(4)
  buffer_load_dwordx4 a[124:127], v243, s[24:27], s30 offen offset:3072 sc1
  s_add_u32 s30, s30, 8192
  v_mfma_f32_16x16x32_bf16 v[32:35], a[176:179], a[0:3], 0
  ds_read_b64_tr_b16 a[160:161], v228 offset:32768
  v_mfma_f32_16x16x32_bf16 v[32:35], a[180:183], a[16:19], v[32:35]
  v_mfma_f32_16x16x32_bf16 v[36:39], a[180:183], a[20:23], 0
  ds_read_b64_tr_b16 a[162:163], v228 offset:33792
  v_mfma_f32_16x16x32_bf16 v[36:39], a[176:179], a[4:7], v[36:39]
  v_mfma_f32_16x16x32_bf16 v[40:43], a[176:179], a[8:11], 0
  ds_read_b64_tr_b16 a[164:165], v228 offset:40960
  v_mfma_f32_16x16x32_bf16 v[40:43], a[180:183], a[24:27], v[40:43]
  v_mfma_f32_16x16x32_bf16 v[44:47], a[180:183], a[28:31], 0
  ds_read_b64_tr_b16 a[166:167], v228 offset:41984
  v_mfma_f32_16x16x32_bf16 v[44:47], a[176:179], a[12:15], v[44:47]
  s_waitcnt lgkmcnt(4)
  v_mfma_f32_16x16x32_bf16 v[48:51], a[184:187], a[0:3], 0
  ds_read_b64_tr_b16 a[168:169], v229 offset:32768
  v_mfma_f32_16x16x32_bf16 v[48:51], a[188:191], a[16:19], v[48:51]
  v_mfma_f32_16x16x32_bf16 v[52:55], a[188:191], a[20:23], 0
  ds_read_b64_tr_b16 a[170:171], v229 offset:33792
  v_mfma_f32_16x16x32_bf16 v[52:55], a[184:187], a[4:7], v[52:55]
  v_mfma_f32_16x16x32_bf16 v[56:59], a[184:187], a[8:11], 0
  ds_read_b64_tr_b16 a[172:173], v229 offset:40960
  v_mfma_f32_16x16x32_bf16 v[56:59], a[188:191], a[24:27], v[56:59]
  v_mfma_f32_16x16x32_bf16 v[60:63], a[188:191], a[28:31], 0
  ds_read_b64_tr_b16 a[174:175], v229 offset:41984
  v_mfma_f32_16x16x32_bf16 v[60:63], a[184:187], a[12:15], v[60:63]
  s_waitcnt lgkmcnt(4)
  v_mfma_f32_16x16x32_bf16 v[64:67], a[160:163], a[0:3], 0
  ds_read_b64_tr_b16 a[176:177], v230 offset:32768
  v_mfma_f32_16x16x32_bf16 v[64:67], a[164:167], a[16:19], v[64:67]
  v_mfma_f32_16x16x32_bf16 v[68:71], a[164:167], a[20:23], 0
  ds_read_b64_tr_b16 a[178:179], v230 offset:33792
  v_mfma_f32_16x16x32_bf16 v[68:71], a[160:163], a[4:7], v[68:71]
  v_mfma_f32_16x16x32_bf16 v[72:75], a[160:163], a[8:11], 0
  ds_read_b64_tr_b16 a[180:181], v230 offset:40960
  v_mfma_f32_16x16x32_bf16 v[72:75], a[164:167], a[24:27], v[72:75]
  v_mfma_f32_16x16x32_bf16 v[76:79], a[164:167], a[28:31], 0
  ds_read_b64_tr_b16 a[182:183], v230 offset:41984
  v_mfma_f32_16x16x32_bf16 v[76:79], a[160:163], a[12:15], v[76:79]
  s_waitcnt lgkmcnt(4)
  v_mfma_f32_16x16x32_bf16 v[80:83], a[168:171], a[0:3], 0
  ds_read_b64_tr_b16 a[184:185], v231 offset:32768
  v_mfma_f32_16x16x32_bf16 v[80:83], a[172:175], a[16:19], v[80:83]
  v_mfma_f32_16x16x32_bf16 v[84:87], a[172:175], a[20:23], 0
  ds_read_b64_tr_b16 a[186:187], v231 offset:33792
  v_mfma_f32_16x16x32_bf16 v[84:87], a[168:171], a[4:7], v[84:87]
  v_mfma_f32_16x16x32_bf16 v[88:91], a[168:171], a[8:11], 0
  ds_read_b64_tr_b16 a[188:189], v231 offset:40960
  v_mfma_f32_16x16x32_bf16 v[88:91], a[172:175], a[24:27], v[88:91]
  s_barrier
  v_mfma_f32_16x16x32_bf16 v[92:95], a[172:175], a[28:31], 0
  ds_read_b64_tr_b16 a[190:191], v231 offset:41984
  v_mfma_f32_16x16x32_bf16 v[92:95], a[168:171], a[12:15], v[92:95]
  s_waitcnt lgkmcnt(4)
  v_mfma_f32_16x16x32_bf16 v[96:99], a[176:179], a[0:3], 0
  ds_read_b64_tr_b16 a[160:161], v224 offset:49152
  v_mfma_f32_16x16x32_bf16 v[96:99], a[180:183], a[16:19], v[96:99]
  v_mfma_f32_16x16x32_bf16 v[100:103], a[180:183], a[20:23], 0
  ds_read_b64_tr_b16 a[162:163], v224 offset:50176
  v_mfma_f32_16x16x32_bf16 v[100:103], a[176:179], a[4:7], v[100:103]
  v_mfma_f32_16x16x32_bf16 v[104:107], a[176:179], a[8:11], 0
  ds_read_b64_tr_b16 a[164:165], v224 offset:57344
  v_mfma_f32_16x16x32_bf16 v[104:107], a[180:183], a[24:27], v[104:107]
  v_mfma_f32_16x16x32_bf16 v[108:111], a[180:183], a[28:31], 0
  ds_read_b64_tr_b16 a[166:167], v224 offset:58368
  v_mfma_f32_16x16x32_bf16 v[108:111], a[176:179], a[12:15], v[108:111]
  s_waitcnt lgkmcnt(4)
  v_mfma_f32_16x16x32_bf16 v[112:115], a[184:187], a[0:3], 0
  ds_read_b64_tr_b16 a[168:169], v225 offset:49152
  v_mfma_f32_16x16x32_bf16 v[112:115], a[188:191], a[16:19], v[112:115]
  v_mfma_f32_16x16x32_bf16 v[116:119], a[188:191], a[20:23], 0
  ds_read_b64_tr_b16 a[170:171], v225 offset:50176
  v_mfma_f32_16x16x32_bf16 v[116:119], a[184:187], a[4:7], v[116:119]
  v_mfma_f32_16x16x32_bf16 v[120:123], a[184:187], a[8:11], 0
  ds_read_b64_tr_b16 a[172:173], v225 offset:57344
  v_mfma_f32_16x16x32_bf16 v[120:123], a[188:191], a[24:27], v[120:123]
  v_mfma_f32_16x16x32_bf16 v[124:127], a[188:191], a[28:31], 0
  ds_read_b64_tr_b16 a[174:175], v225 offset:58368
  v_mfma_f32_16x16x32_bf16 v[124:127], a[184:187], a[12:15], v[124:127]
  s_waitcnt vmcnt(16) lgkmcnt(4)
  v_mfma_f32_16x16x32_bf16 v[0:3], a[160:163], a[32:35], v[0:3]
  ds_read_b64_tr_b16 a[176:177], v226 offset:49152
  v_lshlrev_b32 v137, 1, v242
  v_mfma_f32_16x16x32_bf16 v[0:3], a[164:167], a[48:51], v[0:3]
  buffer_load_dwordx4 a[0:3], v242, s[24:27], s30 offen offset:0 sc1
  v_mfma_f32_16x16x32_bf16 v[4:7], a[164:167], a[52:55], v[4:7]
  ds_read_b64_tr_b16 a[178:179], v226 offset:50176
  v_and_b32 v137, 0xe0, v137
  v_mfma_f32_16x16x32_bf16 v[4:7], a[160:163], a[36:39], v[4:7]
  buffer_load_dwordx4 a[4:7], v242, s[24:27], s30 offen offset:1024 sc1
  v_mfma_f32_16x16x32_bf16 v[8:11], a[160:163], a[40:43], v[8:11]
  ds_read_b64_tr_b16 a[180:181], v226 offset:57344
  buffer_load_dword v136, v137, s[44:47], 0 offen sc1
  v_mfma_f32_16x16x32_bf16 v[8:11], a[164:167], a[56:59], v[8:11]
  buffer_load_dwordx4 a[8:11], v242, s[24:27], s30 offen offset:2048 sc1
  v_mfma_f32_16x16x32_bf16 v[12:15], a[164:167], a[60:63], v[12:15]
  ds_read_b64_tr_b16 a[182:183], v226 offset:58368
  v_mfma_f32_16x16x32_bf16 v[12:15], a[160:163], a[44:47], v[12:15]
  s_waitcnt lgkmcnt(4)
  v_mfma_f32_16x16x32_bf16 v[16:19], a[168:171], a[32:35], v[16:19]
  ds_read_b64_tr_b16 a[184:185], v227 offset:49152
  v_mfma_f32_16x16x32_bf16 v[16:19], a[172:175], a[48:51], v[16:19]
  buffer_load_dwordx4 a[12:15], v242, s[24:27], s30 offen offset:3072 sc1
  v_mfma_f32_16x16x32_bf16 v[20:23], a[172:175], a[52:55], v[20:23]
  ds_read_b64_tr_b16 a[186:187], v227 offset:50176
  v_mfma_f32_16x16x32_bf16 v[20:23], a[168:171], a[36:39], v[20:23]
  buffer_load_dwordx4 a[16:19], v243, s[24:27], s30 offen offset:0 sc1
  v_mfma_f32_16x16x32_bf16 v[24:27], a[168:171], a[40:43], v[24:27]
  ds_read_b64_tr_b16 a[188:189], v227 offset:57344
  v_mfma_f32_16x16x32_bf16 v[24:27], a[172:175], a[56:59], v[24:27]
  buffer_load_dwordx4 a[20:23], v243, s[24:27], s30 offen offset:1024 sc1
  v_mfma_f32_16x16x32_bf16 v[28:31], a[172:175], a[60:63], v[28:31]
  ds_read_b64_tr_b16 a[190:191], v227 offset:58368
  v_mfma_f32_16x16x32_bf16 v[28:31], a[168:171], a[44:47], v[28:31]
  s_waitcnt lgkmcnt(4)
  v_mfma_f32_16x16x32_bf16 v[32:35], a[176:179], a[32:35], v[32:35]
  ds_read_b64_tr_b16 a[160:161], v228 offset:49152
  v_mfma_f32_16x16x32_bf16 v[32:35], a[180:183], a[48:51], v[32:35]
  buffer_load_dwordx4 a[24:27], v243, s[24:27], s30 offen offset:2048 sc1
  v_mfma_f32_16x16x32_bf16 v[36:39], a[180:183], a[52:55], v[36:39]
  ds_read_b64_tr_b16 a[162:163], v228 offset:50176
  v_mfma_f32_16x16x32_bf16 v[36:39], a[176:179], a[36:39], v[36:39]
  buffer_load_dwordx4 a[28:31], v243, s[24:27], s30 offen offset:3072 sc1
  v_mfma_f32_16x16x32_bf16 v[40:43], a[176:179], a[40:43], v[40:43]
  ds_read_b64_tr_b16 a[164:165], v228 offset:57344
  v_mfma_f32_16x16x32_bf16 v[40:43], a[180:183], a[56:59], v[40:43]
  s_add_u32 s30, s30, 8192
  v_mfma_f32_16x16x32_bf16 v[44:47], a[180:183], a[60:63], v[44:47]
  ds_read_b64_tr_b16 a[166:167], v228 offset:58368
  v_mfma_f32_16x16x32_bf16 v[44:47], a[176:179], a[44:47], v[44:47]
  s_waitcnt lgkmcnt(4)
  v_mfma_f32_16x16x32_bf16 v[48:51], a[184:187], a[32:35], v[48:51]
  ds_read_b64_tr_b16 a[168:169], v229 offset:49152
  v_mfma_f32_16x16x32_bf16 v[48:51], a[188:191], a[48:51], v[48:51]
  v_mfma_f32_16x16x32_bf16 v[52:55], a[188:191], a[52:55], v[52:55]
  ds_read_b64_tr_b16 a[170:171], v229 offset:50176
  v_mfma_f32_16x16x32_bf16 v[52:55], a[184:187], a[36:39], v[52:55]
  v_mfma_f32_16x16x32_bf16 v[56:59], a[184:187], a[40:43], v[56:59]
  ds_read_b64_tr_b16 a[172:173], v229 offset:57344
  v_mfma_f32_16x16x32_bf16 v[56:59], a[188:191], a[56:59], v[56:59]
  v_mfma_f32_16x16x32_bf16 v[60:63], a[188:191], a[60:63], v[60:63]
  ds_read_b64_tr_b16 a[174:175], v229 offset:58368
  v_mfma_f32_16x16x32_bf16 v[60:63], a[184:187], a[44:47], v[60:63]
  s_waitcnt lgkmcnt(4)
  v_mfma_f32_16x16x32_bf16 v[64:67], a[160:163], a[32:35], v[64:67]
  ds_read_b64_tr_b16 a[176:177], v230 offset:49152
  v_mfma_f32_16x16x32_bf16 v[64:67], a[164:167], a[48:51], v[64:67]
  v_mfma_f32_16x16x32_bf16 v[68:71], a[164:167], a[52:55], v[68:71]
  ds_read_b64_tr_b16 a[178:179], v230 offset:50176
  v_mfma_f32_16x16x32_bf16 v[68:71], a[160:163], a[36:39], v[68:71]
  v_mfma_f32_16x16x32_bf16 v[72:75], a[160:163], a[40:43], v[72:75]
  ds_read_b64_tr_b16 a[180:181], v230 offset:57344
  v_mfma_f32_16x16x32_bf16 v[72:75], a[164:167], a[56:59], v[72:75]
  v_mfma_f32_16x16x32_bf16 v[76:79], a[164:167], a[60:63], v[76:79]
  ds_read_b64_tr_b16 a[182:183], v230 offset:58368
  v_mfma_f32_16x16x32_bf16 v[76:79], a[160:163], a[44:47], v[76:79]
  s_waitcnt lgkmcnt(4)
  v_mfma_f32_16x16x32_bf16 v[80:83], a[168:171], a[32:35], v[80:83]
  ds_read_b64_tr_b16 a[184:185], v231 offset:49152
  v_mfma_f32_16x16x32_bf16 v[80:83], a[172:175], a[48:51], v[80:83]
  v_mfma_f32_16x16x32_bf16 v[84:87], a[172:175], a[52:55], v[84:87]
  ds_read_b64_tr_b16 a[186:187], v231 offset:50176
  v_mfma_f32_16x16x32_bf16 v[84:87], a[168:171], a[36:39], v[84:87]
  v_mfma_f32_16x16x32_bf16 v[88:91], a[168:171], a[40:43], v[88:91]
  ds_read_b64_tr_b16 a[188:189], v231 offset:57344
  v_mfma_f32_16x16x32_bf16 v[88:91], a[172:175], a[56:59], v[88:91]
  s_barrier
  v_mfma_f32_16x16x32_bf16 v[92:95], a[172:175], a[60:63], v[92:95]
  ds_read_b64_tr_b16 a[190:191], v231 offset:58368
  v_mfma_f32_16x16x32_bf16 v[92:95], a[168:171], a[44:47], v[92:95]
  s_waitcnt lgkmcnt(4)
  s_add_u32 m0, s28, 98304
  v_mfma_f32_16x16x32_bf16 v[96:99], a[176:179], a[32:35], v[96:99]
  ds_read_b64_tr_b16 a[160:161], v224 offset:0
  v_mfma_f32_16x16x32_bf16 v[96:99], a[180:183], a[48:51], v[96:99]
  buffer_load_dwordx4 v238, s[20:23], s31 offen offset:0 lds
  v_mfma_f32_16x16x32_bf16 v[100:103], a[180:183], a[52:55], v[100:103]
  ds_read_b64_tr_b16 a[162:163], v224 offset:1024
  v_mfma_f32_16x16x32_bf16 v[100:103], a[176:179], a[36:39], v[100:103]
  buffer_load_dwordx4 v239, s[20:23], s31 offen offset:1024 lds
  v_mfma_f32_16x16x32_bf16 v[104:107], a[176:179], a[40:43], v[104:107]
  ds_read_b64_tr_b16 a[164:165], v224 offset:8192
  v_mfma_f32_16x16x32_bf16 v[104:107], a[180:183], a[56:59], v[104:107]
  buffer_load_dwordx4 v240, s[20:23], s31 offen offset:2048 lds
  v_mfma_f32_16x16x32_bf16 v[108:111], a[180:183], a[60:63], v[108:111]
  ds_read_b64_tr_b16 a[166:167], v224 offset:9216
  v_mfma_f32_16x16x32_bf16 v[108:111], a[176:179], a[44:47], v[108:111]
  s_waitcnt lgkmcnt(4)
  v_mfma_f32_16x16x32_bf16 v[112:115], a[184:187], a[32:35], v[112:115]
  ds_read_b64_tr_b16 a[168:169], v225 offset:0
  v_mfma_f32_16x16x32_bf16 v[112:115], a[188:191], a[48:51], v[112:115]
  buffer_load_dwordx4 v241, s[20:23], s31 offen offset:3072 lds
  v_mfma_f32_16x16x32_bf16 v[116:119], a[188:191], a[52:55], v[116:119]
  ds_read_b64_tr_b16 a[170:171], v225 offset:1024
  v_mfma_f32_16x16x32_bf16 v[116:119], a[184:187], a[36:39], v[116:119]
  s_add_u32 s31, s31, 0x80000
  v_mfma_f32_16x16x32_bf16 v[120:123], a[184:187], a[40:43], v[120:123]
  ds_read_b64_tr_b16 a[172:173], v225 offset:8192
  v_mfma_f32_16x16x32_bf16 v[120:123], a[188:191], a[56:59], v[120:123]
  v_mfma_f32_16x16x32_bf16 v[124:127], a[188:191], a[60:63], v[124:127]
  ds_read_b64_tr_b16 a[174:175], v225 offset:9216
  v_mfma_f32_16x16x32_bf16 v[124:127], a[184:187], a[44:47], v[124:127]
  s_waitcnt vmcnt(21) lgkmcnt(4)
  v_mfma_f32_16x16x32_bf16 v[0:3], a[160:163], a[64:67], v[0:3]
  ds_read_b64_tr_b16 a[176:177], v226 offset:0
  v_mfma_f32_16x16x32_bf16 v[0:3], a[164:167], a[80:83], v[0:3]
  buffer_load_dwordx4 a[32:35], v242, s[24:27], s30 offen offset:0 sc1
  v_mfma_f32_16x16x32_bf16 v[4:7], a[164:167], a[84:87], v[4:7]
  ds_read_b64_tr_b16 a[178:179], v226 offset:1024
  v_mfma_f32_16x16x32_bf16 v[4:7], a[160:163], a[68:71], v[4:7]
  buffer_load_dwordx4 a[36:39], v242, s[24:27], s30 offen offset:1024 sc1
  v_mfma_f32_16x16x32_bf16 v[8:11], a[160:163], a[72:75], v[8:11]
  ds_read_b64_tr_b16 a[180:181], v226 offset:8192
  v_mfma_f32_16x16x32_bf16 v[8:11], a[164:167], a[88:91], v[8:11]
  buffer_load_dwordx4 a[40:43], v242, s[24:27], s30 offen offset:2048 sc1
  v_mfma_f32_16x16x32_bf16 v[12:15], a[164:167], a[92:95], v[12:15]
  ds_read_b64_tr_b16 a[182:183], v226 offset:9216
  v_mfma_f32_16x16x32_bf16 v[12:15], a[160:163], a[76:79], v[12:15]
  s_waitcnt lgkmcnt(4)
  v_mfma_f32_16x16x32_bf16 v[16:19], a[168:171], a[64:67], v[16:19]
  ds_read_b64_tr_b16 a[184:185], v227 offset:0
  v_mfma_f32_16x16x32_bf16 v[16:19], a[172:175], a[80:83], v[16:19]
  buffer_load_dwordx4 a[44:47], v242, s[24:27], s30 offen offset:3072 sc1
  v_mfma_f32_16x16x32_bf16 v[20:23], a[172:175], a[84:87], v[20:23]
  ds_read_b64_tr_b16 a[186:187], v227 offset:1024
  v_mfma_f32_16x16x32_bf16 v[20:23], a[168:171], a[68:71], v[20:23]
  buffer_load_dwordx4 a[48:51], v243, s[24:27], s30 offen offset:0 sc1
  v_mfma_f32_16x16x32_bf16 v[24:27], a[168:171], a[72:75], v[24:27]
  ds_read_b64_tr_b16 a[188:189], v227 offset:8192
  v_mfma_f32_16x16x32_bf16 v[24:27], a[172:175], a[88:91], v[24:27]
  buffer_load_dwordx4 a[52:55], v243, s[24:27], s30 offen offset:1024 sc1
  v_mfma_f32_16x16x32_bf16 v[28:31], a[172:175], a[92:95], v[28:31]
  ds_read_b64_tr_b16 a[190:191], v227 offset:9216
  v_mfma_f32_16x16x32_bf16 v[28:31], a[168:171], a[76:79], v[28:31]
  s_waitcnt lgkmcnt(4)
  v_mfma_f32_16x16x32_bf16 v[32:35], a[176:179], a[64:67], v[32:35]
  ds_read_b64_tr_b16 a[160:161], v228 offset:0
  v_mfma_f32_16x16x32_bf16 v[32:35], a[180:183], a[80:83], v[32:35]
  buffer_load_dwordx4 a[56:59], v243, s[24:27], s30 offen offset:2048 sc1
  v_mfma_f32_16x16x32_bf16 v[36:39], a[180:183], a[84:87], v[36:39]
  ds_read_b64_tr_b16 a[162:163], v228 offset:1024
  v_mfma_f32_16x16x32_bf16 v[36:39], a[176:179], a[68:71], v[36:39]
  buffer_load_dwordx4 a[60:63], v243, s[24:27], s30 offen offset:3072 sc1
  v_mfma_f32_16x16x32_bf16 v[40:43], a[176:179], a[72:75], v[40:43]
  ds_read_b64_tr_b16 a[164:165], v228 offset:8192
  v_mfma_f32_16x16x32_bf16 v[40:43], a[180:183], a[88:91], v[40:43]
  s_add_u32 s30, s30, 8192
  v_mfma_f32_16x16x32_bf16 v[44:47], a[180:183], a[92:95], v[44:47]
  ds_read_b64_tr_b16 a[166:167], v228 offset:9216
  v_mfma_f32_16x16x32_bf16 v[44:47], a[176:179], a[76:79], v[44:47]
  s_waitcnt lgkmcnt(4)
  v_mfma_f32_16x16x32_bf16 v[48:51], a[184:187], a[64:67], v[48:51]
  ds_read_b64_tr_b16 a[168:169], v229 offset:0
  v_mfma_f32_16x16x32_bf16 v[48:51], a[188:191], a[80:83], v[48:51]
  v_mfma_f32_16x16x32_bf16 v[52:55], a[188:191], a[84:87], v[52:55]
  ds_read_b64_tr_b16 a[170:171], v229 offset:1024
  v_mfma_f32_16x16x32_bf16 v[52:55], a[184:187], a[68:71], v[52:55]
  v_mfma_f32_16x16x32_bf16 v[56:59], a[184:187], a[72:75], v[56:59]
  ds_read_b64_tr_b16 a[172:173], v229 offset:8192
  v_mfma_f32_16x16x32_bf16 v[56:59], a[188:191], a[88:91], v[56:59]
  v_mfma_f32_16x16x32_bf16 v[60:63], a[188:191], a[92:95], v[60:63]
  ds_read_b64_tr_b16 a[174:175], v229 offset:9216
  v_mfma_f32_16x16x32_bf16 v[60:63], a[184:187], a[76:79], v[60:63]
  s_waitcnt lgkmcnt(4)
  v_mfma_f32_16x16x32_bf16 v[64:67], a[160:163], a[64:67], v[64:67]
  ds_read_b64_tr_b16 a[176:177], v230 offset:0
  v_mfma_f32_16x16x32_bf16 v[64:67], a[164:167], a[80:83], v[64:67]
  v_mfma_f32_16x16x32_bf16 v[68:71], a[164:167], a[84:87], v[68:71]
  ds_read_b64_tr_b16 a[178:179], v230 offset:1024
  v_mfma_f32_16x16x32_bf16 v[68:71], a[160:163], a[68:71], v[68:71]
  v_mfma_f32_16x16x32_bf16 v[72:75], a[160:163], a[72:75], v[72:75]
  ds_read_b64_tr_b16 a[180:181], v230 offset:8192
  v_mfma_f32_16x16x32_bf16 v[72:75], a[164:167], a[88:91], v[72:75]
  v_mfma_f32_16x16x32_bf16 v[76:79], a[164:167], a[92:95], v[76:79]
  ds_read_b64_tr_b16 a[182:183], v230 offset:9216
  v_mfma_f32_16x16x32_bf16 v[76:79], a[160:163], a[76:79], v[76:79]
  s_waitcnt lgkmcnt(4)
  v_mfma_f32_16x16x32_bf16 v[80:83], a[168:171], a[64:67], v[80:83]
  ds_read_b64_tr_b16 a[184:185], v231 offset:0
  v_mfma_f32_16x16x32_bf16 v[80:83], a[172:175], a[80:83], v[80:83]
  v_mfma_f32_16x16x32_bf16 v[84:87], a[172:175], a[84:87], v[84:87]
  ds_read_b64_tr_b16 a[186:187], v231 offset:1024
  v_mfma_f32_16x16x32_bf16 v[84:87], a[168:171], a[68:71], v[84:87]
  v_mfma_f32_16x16x32_bf16 v[88:91], a[168:171], a[72:75], v[88:91]
  ds_read_b64_tr_b16 a[188:189], v231 offset:8192
  v_mfma_f32_16x16x32_bf16 v[88:91], a[172:175], a[88:91], v[88:91]
  s_barrier
  v_mfma_f32_16x16x32_bf16 v[92:95], a[172:175], a[92:95], v[92:95]
  ds_read_b64_tr_b16 a[190:191], v231 offset:9216
  v_mfma_f32_16x16x32_bf16 v[92:95], a[168:171], a[76:79], v[92:95]
  s_waitcnt lgkmcnt(4)
  s_add_u32 m0, s28, 114688
  v_mfma_f32_16x16x32_bf16 v[96:99], a[176:179], a[64:67], v[96:99]
  ds_read_b64_tr_b16 a[160:161], v224 offset:16384
  v_mfma_f32_16x16x32_bf16 v[96:99], a[180:183], a[80:83], v[96:99]
  buffer_load_dwordx4 v238, s[20:23], s31 offen offset:0 lds
  v_mfma_f32_16x16x32_bf16 v[100:103], a[180:183], a[84:87], v[100:103]
  ds_read_b64_tr_b16 a[162:163], v224 offset:17408
  v_mfma_f32_16x16x32_bf16 v[100:103], a[176:179], a[68:71], v[100:103]
  buffer_load_dwordx4 v239, s[20:23], s31 offen offset:1024 lds
  v_mfma_f32_16x16x32_bf16 v[104:107], a[176:179], a[72:75], v[104:107]
  ds_read_b64_tr_b16 a[164:165], v224 offset:24576
  v_mfma_f32_16x16x32_bf16 v[104:107], a[180:183], a[88:91], v[104:107]
  buffer_load_dwordx4 v240, s[20:23], s31 offen offset:2048 lds
  v_mfma_f32_16x16x32_bf16 v[108:111], a[180:183], a[92:95], v[108:111]
  ds_read_b64_tr_b16 a[166:167], v224 offset:25600
  v_mfma_f32_16x16x32_bf16 v[108:111], a[176:179], a[76:79], v[108:111]
  s_waitcnt lgkmcnt(4)
  v_mfma_f32_16x16x32_bf16 v[112:115], a[184:187], a[64:67], v[112:115]
  ds_read_b64_tr_b16 a[168:169], v225 offset:16384
  v_mfma_f32_16x16x32_bf16 v[112:115], a[188:191], a[80:83], v[112:115]
  buffer_load_dwordx4 v241, s[20:23], s31 offen offset:3072 lds
  v_mfma_f32_16x16x32_bf16 v[116:119], a[188:191], a[84:87], v[116:119]
  ds_read_b64_tr_b16 a[170:171], v225 offset:17408
  v_mfma_f32_16x16x32_bf16 v[116:119], a[184:187], a[68:71], v[116:119]
  s_add_u32 s31, s31, 0x80000
  v_mfma_f32_16x16x32_bf16 v[120:123], a[184:187], a[72:75], v[120:123]
  ds_read_b64_tr_b16 a[172:173], v225 offset:24576
  v_mfma_f32_16x16x32_bf16 v[120:123], a[188:191], a[88:91], v[120:123]
  v_mfma_f32_16x16x32_bf16 v[124:127], a[188:191], a[92:95], v[124:127]
  ds_read_b64_tr_b16 a[174:175], v225 offset:25600
  v_mfma_f32_16x16x32_bf16 v[124:127], a[184:187], a[76:79], v[124:127]
  s_waitcnt vmcnt(25) lgkmcnt(4)
  s_waitcnt vmcnt(22)
  v_cmp_gt_u32 vcc, 32, v136
  s_nop 0
  s_cbranch_vccz front_keys
  s_mov_b32 s54, 32768
front_all:
  s_sleep 2
  buffer_load_dword v136, v137, s[44:47], 0 offen sc1
  s_waitcnt vmcnt(0)
  v_cmp_gt_u32 vcc, 32, v136
  s_nop 0
  s_cbranch_vccz front_keys
  s_sub_u32 s54, s54, 1
  s_cmp_lg_u32 s54, 0
  s_cbranch_scc1 front_all
front_keys:
  v_mfma_f32_16x16x32_bf16 v[0:3], a[160:163], a[96:99], v[0:3]
  ds_read_b64_tr_b16 a[176:177], v226 offset:16384
  s_lshl_b32 s35, s3, 11
  s_add_u32 s35, s35, 2621440
  buffer_load_dwordx4 v[128:131], v242, s[24:27], s35 offen sc1
  v_mfma_f32_16x16x32_bf16 v[0:3], a[164:167], a[112:115], v[0:3]
  buffer_load_dwordx4 a[64:67], v242, s[24:27], s30 offen offset:0 sc1
  v_mfma_f32_16x16x32_bf16 v[4:7], a[164:167], a[116:119], v[4:7]
  ds_read_b64_tr_b16 a[178:179], v226 offset:17408
  buffer_load_dwordx4 v[132:135], v242, s[24:27], s35 offen offset:1024 sc1
  v_mfma_f32_16x16x32_bf16 v[4:7], a[160:163], a[100:103], v[4:7]
  buffer_load_dwordx4 a[68:71], v242, s[24:27], s30 offen offset:1024 sc1
  v_mfma_f32_16x16x32_bf16 v[8:11], a[160:163], a[104:107], v[8:11]
  ds_read_b64_tr_b16 a[180:181], v226 offset:24576
  v_mfma_f32_16x16x32_bf16 v[8:11], a[164:167], a[120:123], v[8:11]
  buffer_load_dwordx4 a[72:75], v242, s[24:27], s30 offen offset:2048 sc1
  v_mfma_f32_16x16x32_bf16 v[12:15], a[164:167], a[124:127], v[12:15]
  ds_read_b64_tr_b16 a[182:183], v226 offset:25600
  v_mfma_f32_16x16x32_bf16 v[12:15], a[160:163], a[108:111], v[12:15]
  s_waitcnt lgkmcnt(4)
  v_mfma_f32_16x16x32_bf16 v[16:19], a[168:171], a[96:99], v[16:19]
  ds_read_b64_tr_b16 a[184:185], v227 offset:16384
  v_mfma_f32_16x16x32_bf16 v[16:19], a[172:175], a[112:115], v[16:19]
  buffer_load_dwordx4 a[76:79], v242, s[24:27], s30 offen offset:3072 sc1
  v_mfma_f32_16x16x32_bf16 v[20:23], a[172:175], a[116:119], v[20:23]
  ds_read_b64_tr_b16 a[186:187], v227 offset:17408
  v_mfma_f32_16x16x32_bf16 v[20:23], a[168:171], a[100:103], v[20:23]
  buffer_load_dwordx4 a[80:83], v243, s[24:27], s30 offen offset:0 sc1
  v_mfma_f32_16x16x32_bf16 v[24:27], a[168:171], a[104:107], v[24:27]
  ds_read_b64_tr_b16 a[188:189], v227 offset:24576
  v_mfma_f32_16x16x32_bf16 v[24:27], a[172:175], a[120:123], v[24:27]
  buffer_load_dwordx4 a[84:87], v243, s[24:27], s30 offen offset:1024 sc1
  v_mfma_f32_16x16x32_bf16 v[28:31], a[172:175], a[124:127], v[28:31]
  ds_read_b64_tr_b16 a[190:191], v227 offset:25600
  v_mfma_f32_16x16x32_bf16 v[28:31], a[168:171], a[108:111], v[28:31]
  s_waitcnt lgkmcnt(4)
  v_mfma_f32_16x16x32_bf16 v[32:35], a[176:179], a[96:99], v[32:35]
  ds_read_b64_tr_b16 a[160:161], v228 offset:16384
  v_mfma_f32_16x16x32_bf16 v[32:35], a[180:183], a[112:115], v[32:35]
  buffer_load_dwordx4 a[88:91], v243, s[24:27], s30 offen offset:2048 sc1
  v_mfma_f32_16x16x32_bf16 v[36:39], a[180:183], a[116:119], v[36:39]
  ds_read_b64_tr_b16 a[162:163], v228 offset:17408
  v_mfma_f32_16x16x32_bf16 v[36:39], a[176:179], a[100:103], v[36:39]
  buffer_load_dwordx4 a[92:95], v243, s[24:27], s30 offen offset:3072 sc1
  v_mfma_f32_16x16x32_bf16 v[40:43], a[176:179], a[104:107], v[40:43]
  ds_read_b64_tr_b16 a[164:165], v228 offset:24576
  v_mfma_f32_16x16x32_bf16 v[40:43], a[180:183], a[120:123], v[40:43]
  s_add_u32 s30, s30, 8192
  v_mfma_f32_16x16x32_bf16 v[44:47], a[180:183], a[124:127], v[44:47]
  ds_read_b64_tr_b16 a[166:167], v228 offset:25600
  v_mfma_f32_16x16x32_bf16 v[44:47], a[176:179], a[108:111], v[44:47]
  s_waitcnt lgkmcnt(4)
  v_mfma_f32_16x16x32_bf16 v[48:51], a[184:187], a[96:99], v[48:51]
  ds_read_b64_tr_b16 a[168:169], v229 offset:16384
  v_mfma_f32_16x16x32_bf16 v[48:51], a[188:191], a[112:115], v[48:51]
  v_mfma_f32_16x16x32_bf16 v[52:55], a[188:191], a[116:119], v[52:55]
  ds_read_b64_tr_b16 a[170:171], v229 offset:17408
  v_mfma_f32_16x16x32_bf16 v[52:55], a[184:187], a[100:103], v[52:55]
  v_mfma_f32_16x16x32_bf16 v[56:59], a[184:187], a[104:107], v[56:59]
  ds_read_b64_tr_b16 a[172:173], v229 offset:24576
  v_mfma_f32_16x16x32_bf16 v[56:59], a[188:191], a[120:123], v[56:59]
  v_mfma_f32_16x16x32_bf16 v[60:63], a[188:191], a[124:127], v[60:63]
  ds_read_b64_tr_b16 a[174:175], v229 offset:25600
  v_mfma_f32_16x16x32_bf16 v[60:63], a[184:187], a[108:111], v[60:63]
  s_waitcnt lgkmcnt(4)
  v_mfma_f32_16x16x32_bf16 v[64:67], a[160:163], a[96:99], v[64:67]
  ds_read_b64_tr_b16 a[176:177], v230 offset:16384
  v_mfma_f32_16x16x32_bf16 v[64:67], a[164:167], a[112:115], v[64:67]
  v_mfma_f32_16x16x32_bf16 v[68:71], a[164:167], a[116:119], v[68:71]
  ds_read_b64_tr_b16 a[178:179], v230 offset:17408
  v_mfma_f32_16x16x32_bf16 v[68:71], a[160:163], a[100:103], v[68:71]
  v_mfma_f32_16x16x32_bf16 v[72:75], a[160:163], a[104:107], v[72:75]
  ds_read_b64_tr_b16 a[180:181], v230 offset:24576
  v_mfma_f32_16x16x32_bf16 v[72:75], a[164:167], a[120:123], v[72:75]
  v_mfma_f32_16x16x32_bf16 v[76:79], a[164:167], a[124:127], v[76:79]
  ds_read_b64_tr_b16 a[182:183], v230 offset:25600
  v_mfma_f32_16x16x32_bf16 v[76:79], a[160:163], a[108:111], v[76:79]
  s_waitcnt lgkmcnt(4)
  v_mfma_f32_16x16x32_bf16 v[80:83], a[168:171], a[96:99], v[80:83]
  ds_read_b64_tr_b16 a[184:185], v231 offset:16384
  v_mfma_f32_16x16x32_bf16 v[80:83], a[172:175], a[112:115], v[80:83]
  v_mfma_f32_16x16x32_bf16 v[84:87], a[172:175], a[116:119], v[84:87]
  ds_read_b64_tr_b16 a[186:187], v231 offset:17408
  v_mfma_f32_16x16x32_bf16 v[84:87], a[168:171], a[100:103], v[84:87]
  s_waitcnt vmcnt(22)
  v_mfma_f32_16x16x32_bf16 v[88:91], a[168:171], a[104:107], v[88:91]
  ds_read_b64_tr_b16 a[188:189], v231 offset:24576
  v_mfma_f32_16x16x32_bf16 v[88:91], a[172:175], a[120:123], v[88:91]
  s_barrier
  v_mfma_f32_16x16x32_bf16 v[92:95], a[172:175], a[124:127], v[92:95]
  ds_read_b64_tr_b16 a[190:191], v231 offset:25600
  v_mfma_f32_16x16x32_bf16 v[92:95], a[168:171], a[108:111], v[92:95]
  s_waitcnt lgkmcnt(4)
  s_add_u32 m0, s28, 65536
  v_mfma_f32_16x16x32_bf16 v[96:99], a[176:179], a[96:99], v[96:99]
  ds_read_b64_tr_b16 a[160:161], v224 offset:32768
  v_mfma_f32_16x16x32_bf16 v[96:99], a[180:183], a[112:115], v[96:99]
  buffer_load_dwordx4 v238, s[20:23], s31 offen offset:0 lds
  v_mfma_f32_16x16x32_bf16 v[100:103], a[180:183], a[116:119], v[100:103]
  ds_read_b64_tr_b16 a[162:163], v224 offset:33792
  v_mfma_f32_16x16x32_bf16 v[100:103], a[176:179], a[100:103], v[100:103]
  buffer_load_dwordx4 v239, s[20:23], s31 offen offset:1024 lds
  v_mfma_f32_16x16x32_bf16 v[104:107], a[176:179], a[104:107], v[104:107]
  ds_read_b64_tr_b16 a[164:165], v224 offset:40960
  v_mfma_f32_16x16x32_bf16 v[104:107], a[180:183], a[120:123], v[104:107]
  buffer_load_dwordx4 v240, s[20:23], s31 offen offset:2048 lds
  v_mfma_f32_16x16x32_bf16 v[108:111], a[180:183], a[124:127], v[108:111]
  ds_read_b64_tr_b16 a[166:167], v224 offset:41984
  v_mfma_f32_16x16x32_bf16 v[108:111], a[176:179], a[108:111], v[108:111]
  s_waitcnt lgkmcnt(4)
  v_mfma_f32_16x16x32_bf16 v[112:115], a[184:187], a[96:99], v[112:115]
  ds_read_b64_tr_b16 a[168:169], v225 offset:32768
  v_mfma_f32_16x16x32_bf16 v[112:115], a[188:191], a[112:115], v[112:115]
  buffer_load_dwordx4 v241, s[20:23], s31 offen offset:3072 lds
  v_mfma_f32_16x16x32_bf16 v[116:119], a[188:191], a[116:119], v[116:119]
  ds_read_b64_tr_b16 a[170:171], v225 offset:33792
  v_mfma_f32_16x16x32_bf16 v[116:119], a[184:187], a[100:103], v[116:119]
  s_add_u32 s31, s31, 0x80000
  v_mfma_f32_16x16x32_bf16 v[120:123], a[184:187], a[104:107], v[120:123]
  ds_read_b64_tr_b16 a[172:173], v225 offset:40960
  v_mfma_f32_16x16x32_bf16 v[120:123], a[188:191], a[120:123], v[120:123]
  v_mfma_f32_16x16x32_bf16 v[124:127], a[188:191], a[124:127], v[124:127]
  ds_read_b64_tr_b16 a[174:175], v225 offset:41984
  v_mfma_f32_16x16x32_bf16 v[124:127], a[184:187], a[108:111], v[124:127]
  s_waitcnt lgkmcnt(4)
  v_mfma_f32_16x16x32_bf16 v[0:3], a[160:163], a[0:3], v[0:3]
  ds_read_b64_tr_b16 a[176:177], v226 offset:32768
  s_waitcnt vmcnt(11)
  s_mov_b32 s51, -1
  v_sub_u32 v137, s51, v128
  v_mfma_f32_16x16x32_bf16 v[0:3], a[164:167], a[16:19], v[0:3]
  buffer_load_dwordx4 a[96:99], v242, s[24:27], s30 offen offset:0 sc1
  v_mfma_f32_16x16x32_bf16 v[4:7], a[164:167], a[20:23], v[4:7]
  ds_read_b64_tr_b16 a[178:179], v226 offset:33792
  v_sub_u32 v138, s51, v129
  v_mfma_f32_16x16x32_bf16 v[4:7], a[160:163], a[4:7], v[4:7]
  buffer_load_dwordx4 a[100:103], v242, s[24:27], s30 offen offset:1024 sc1
  v_mfma_f32_16x16x32_bf16 v[8:11], a[160:163], a[8:11], v[8:11]
  ds_read_b64_tr_b16 a[180:181], v226 offset:40960
  v_min_u32 v136, v137, v138
  v_mfma_f32_16x16x32_bf16 v[8:11], a[164:167], a[24:27], v[8:11]
  buffer_load_dwordx4 a[104:107], v242, s[24:27], s30 offen offset:2048 sc1
  v_mfma_f32_16x16x32_bf16 v[12:15], a[164:167], a[28:31], v[12:15]
  ds_read_b64_tr_b16 a[182:183], v226 offset:41984
  v_sub_u32 v139, s51, v130
  v_mfma_f32_16x16x32_bf16 v[12:15], a[160:163], a[12:15], v[12:15]
  s_waitcnt lgkmcnt(4)
  v_sub_u32 v140, s51, v131
  v_min3_u32 v136, v136, v139, v140
  v_mfma_f32_16x16x32_bf16 v[16:19], a[168:171], a[0:3], v[16:19]
  ds_read_b64_tr_b16 a[184:185], v227 offset:32768
  v_sub_u32 v137, s51, v132
  v_mfma_f32_16x16x32_bf16 v[16:19], a[172:175], a[16:19], v[16:19]
  buffer_load_dwordx4 a[108:111], v242, s[24:27], s30 offen offset:3072 sc1
  v_mfma_f32_16x16x32_bf16 v[20:23], a[172:175], a[20:23], v[20:23]
  ds_read_b64_tr_b16 a[186:187], v227 offset:33792
  v_sub_u32 v138, s51, v133
  v_mfma_f32_16x16x32_bf16 v[20:23], a[168:171], a[4:7], v[20:23]
  buffer_load_dwordx4 a[112:115], v243, s[24:27], s30 offen offset:0 sc1
  v_mfma_f32_16x16x32_bf16 v[24:27], a[168:171], a[8:11], v[24:27]
  ds_read_b64_tr_b16 a[188:189], v227 offset:40960
  v_min3_u32 v136, v136, v137, v138
  v_mfma_f32_16x16x32_bf16 v[24:27], a[172:175], a[24:27], v[24:27]
  buffer_load_dwordx4 a[116:119], v243, s[24:27], s30 offen offset:1024 sc1
  v_mfma_f32_16x16x32_bf16 v[28:31], a[172:175], a[28:31], v[28:31]
  ds_read_b64_tr_b16 a[190:191], v227 offset:41984
  v_sub_u32 v139, s51, v134
  v_mfma_f32_16x16x32_bf16 v[28:31], a[168:171], a[12:15], v[28:31]
  s_waitcnt lgkmcnt(4)
  v_sub_u32 v140, s51, v135
  v_min3_u32 v136, v136, v139, v140
  v_mfma_f32_16x16x32_bf16 v[32:35], a[176:179], a[0:3], v[32:35]
  ds_read_b64_tr_b16 a[160:161], v228 offset:32768
  v_min_u32_dpp v136, v136, v136 row_ror:8 row_mask:0xf bank_mask:0xf
  v_mfma_f32_16x16x32_bf16 v[32:35], a[180:183], a[16:19], v[32:35]
  buffer_load_dwordx4 a[120:123], v243, s[24:27], s30 offen offset:2048 sc1
  v_mfma_f32_16x16x32_bf16 v[36:39], a[180:183], a[20:23], v[36:39]
  ds_read_b64_tr_b16 a[162:163], v228 offset:33792
  v_min_u32_dpp v136, v136, v136 row_ror:4 row_mask:0xf bank_mask:0xf
  v_mfma_f32_16x16x32_bf16 v[36:39], a[176:179], a[4:7], v[36:39]
  buffer_load_dwordx4 a[124:127], v243, s[24:27], s30 offen offset:3072 sc1
  v_mfma_f32_16x16x32_bf16 v[40:43], a[176:179], a[8:11], v[40:43]
  ds_read_b64_tr_b16 a[164:165], v228 offset:40960
  v_min_u32_dpp v136, v136, v136 row_ror:2 row_mask:0xf bank_mask:0xf
  v_mfma_f32_16x16x32_bf16 v[40:43], a[180:183], a[24:27], v[40:43]
  s_add_u32 s30, s30, 8192
  v_min_u32_dpp v136, v136, v136 row_ror:1 row_mask:0xf bank_mask:0xf
  v_mfma_f32_16x16x32_bf16 v[44:47], a[180:183], a[28:31], v[44:47]
  ds_read_b64_tr_b16 a[166:167], v228 offset:41984
  v_readlane_b32 s98, v136, 0
  v_mfma_f32_16x16x32_bf16 v[44:47], a[176:179], a[12:15], v[44:47]
  s_waitcnt lgkmcnt(4)
  v_readlane_b32 s99, v136, 16
  v_readlane_b32 s100, v136, 32
  v_mfma_f32_16x16x32_bf16 v[48:51], a[184:187], a[0:3], v[48:51]
  ds_read_b64_tr_b16 a[168:169], v229 offset:32768
  v_readlane_b32 s101, v136, 48
  v_mfma_f32_16x16x32_bf16 v[48:51], a[188:191], a[16:19], v[48:51]
  s_min_u32 s98, s98, s99
  s_min_u32 s100, s100, s101
  s_min_u32 s98, s98, s100
  s_sub_u32 s52, s51, s98
  s_sub_u32 s51, s52, 1
  v_sub_u32 v137, s51, v128
  v_sub_u32 v138, s51, v129
  v_mfma_f32_16x16x32_bf16 v[52:55], a[188:191], a[20:23], v[52:55]
  ds_read_b64_tr_b16 a[170:171], v229 offset:33792
  v_min_u32 v136, v137, v138
  v_mfma_f32_16x16x32_bf16 v[52:55], a[184:187], a[4:7], v[52:55]
  v_sub_u32 v139, s51, v130
  v_sub_u32 v140, s51, v131
  v_mfma_f32_16x16x32_bf16 v[56:59], a[184:187], a[8:11], v[56:59]
  ds_read_b64_tr_b16 a[172:173], v229 offset:40960
  v_min3_u32 v136, v136, v139, v140
  v_mfma_f32_16x16x32_bf16 v[56:59], a[188:191], a[24:27], v[56:59]
  v_sub_u32 v137, s51, v132
  v_sub_u32 v138, s51, v133
  v_mfma_f32_16x16x32_bf16 v[60:63], a[188:191], a[28:31], v[60:63]
  ds_read_b64_tr_b16 a[174:175], v229 offset:41984
  v_min3_u32 v136, v136, v137, v138
  v_mfma_f32_16x16x32_bf16 v[60:63], a[184:187], a[12:15], v[60:63]
  s_waitcnt lgkmcnt(4)
  v_sub_u32 v139, s51, v134
  v_sub_u32 v140, s51, v135
  v_mfma_f32_16x16x32_bf16 v[64:67], a[160:163], a[0:3], v[64:67]
  ds_read_b64_tr_b16 a[176:177], v230 offset:32768
  v_min3_u32 v136, v136, v139, v140
  v_mfma_f32_16x16x32_bf16 v[64:67], a[164:167], a[16:19], v[64:67]
  v_mfma_f32_16x16x32_bf16 v[68:71], a[164:167], a[20:23], v[68:71]
  ds_read_b64_tr_b16 a[178:179], v230 offset:33792
  v_min_u32_dpp v136, v136, v136 row_ror:8 row_mask:0xf bank_mask:0xf
  v_mfma_f32_16x16x32_bf16 v[68:71], a[160:163], a[4:7], v[68:71]
  v_mfma_f32_16x16x32_bf16 v[72:75], a[160:163], a[8:11], v[72:75]
  ds_read_b64_tr_b16 a[180:181], v230 offset:40960
  v_min_u32_dpp v136, v136, v136 row_ror:4 row_mask:0xf bank_mask:0xf
  v_mfma_f32_16x16x32_bf16 v[72:75], a[164:167], a[24:27], v[72:75]
  v_mfma_f32_16x16x32_bf16 v[76:79], a[164:167], a[28:31], v[76:79]
  ds_read_b64_tr_b16 a[182:183], v230 offset:41984
  v_min_u32_dpp v136, v136, v136 row_ror:2 row_mask:0xf bank_mask:0xf
  v_mfma_f32_16x16x32_bf16 v[76:79], a[160:163], a[12:15], v[76:79]
  s_waitcnt lgkmcnt(4)
  v_min_u32_dpp v136, v136, v136 row_ror:1 row_mask:0xf bank_mask:0xf
  v_mfma_f32_16x16x32_bf16 v[80:83], a[168:171], a[0:3], v[80:83]
  ds_read_b64_tr_b16 a[184:185], v231 offset:32768
  v_readlane_b32 s98, v136, 0
  v_mfma_f32_16x16x32_bf16 v[80:83], a[172:175], a[16:19], v[80:83]
  v_readlane_b32 s99, v136, 16
  v_readlane_b32 s100, v136, 32
  v_mfma_f32_16x16x32_bf16 v[84:87], a[172:175], a[20:23], v[84:87]
  ds_read_b64_tr_b16 a[186:187], v231 offset:33792
  v_readlane_b32 s101, v136, 48
  v_mfma_f32_16x16x32_bf16 v[84:87], a[168:171], a[4:7], v[84:87]
  s_min_u32 s98, s98, s99
  s_min_u32 s100, s100, s101
  s_min_u32 s98, s98, s100
  s_sub_u32 s53, s51, s98
  s_sub_u32 s51, s53, 1
  v_sub_u32 v137, s51, v128
  v_sub_u32 v138, s51, v129
  v_mfma_f32_16x16x32_bf16 v[88:91], a[168:171], a[8:11], v[88:91]
  ds_read_b64_tr_b16 a[188:189], v231 offset:40960
  v_min_u32 v136, v137, v138
  v_mfma_f32_16x16x32_bf16 v[88:91], a[172:175], a[24:27], v[88:91]
  s_barrier
  v_sub_u32 v139, s51, v130
  v_sub_u32 v140, s51, v131
  v_mfma_f32_16x16x32_bf16 v[92:95], a[172:175], a[28:31], v[92:95]
  ds_read_b64_tr_b16 a[190:191], v231 offset:41984
  v_min3_u32 v136, v136, v139, v140
  v_mfma_f32_16x16x32_bf16 v[92:95], a[168:171], a[12:15], v[92:95]
  s_waitcnt lgkmcnt(4)
  s_add_u32 m0, s28, 81920
  v_sub_u32 v137, s51, v132
  v_sub_u32 v138, s51, v133
  v_mfma_f32_16x16x32_bf16 v[96:99], a[176:179], a[0:3], v[96:99]
  ds_read_b64_tr_b16 a[160:161], v224 offset:49152
  v_min3_u32 v136, v136, v137, v138
  v_mfma_f32_16x16x32_bf16 v[96:99], a[180:183], a[16:19], v[96:99]
  buffer_load_dwordx4 v238, s[20:23], s31 offen offset:0 lds
  v_mfma_f32_16x16x32_bf16 v[100:103], a[180:183], a[20:23], v[100:103]
  ds_read_b64_tr_b16 a[162:163], v224 offset:50176
  v_sub_u32 v139, s51, v134
  v_mfma_f32_16x16x32_bf16 v[100:103], a[176:179], a[4:7], v[100:103]
  buffer_load_dwordx4 v239, s[20:23], s31 offen offset:1024 lds
  v_mfma_f32_16x16x32_bf16 v[104:107], a[176:179], a[8:11], v[104:107]
  ds_read_b64_tr_b16 a[164:165], v224 offset:57344
  v_sub_u32 v140, s51, v135
  v_mfma_f32_16x16x32_bf16 v[104:107], a[180:183], a[24:27], v[104:107]
  buffer_load_dwordx4 v240, s[20:23], s31 offen offset:2048 lds
  v_mfma_f32_16x16x32_bf16 v[108:111], a[180:183], a[28:31], v[108:111]
  ds_read_b64_tr_b16 a[166:167], v224 offset:58368
  v_min3_u32 v136, v136, v139, v140
  v_mfma_f32_16x16x32_bf16 v[108:111], a[176:179], a[12:15], v[108:111]
  s_waitcnt lgkmcnt(4)
  v_min_u32_dpp v136, v136, v136 row_ror:8 row_mask:0xf bank_mask:0xf
  v_mfma_f32_16x16x32_bf16 v[112:115], a[184:187], a[0:3], v[112:115]
  ds_read_b64_tr_b16 a[168:169], v225 offset:49152
  v_min_u32_dpp v136, v136, v136 row_ror:4 row_mask:0xf bank_mask:0xf
  v_mfma_f32_16x16x32_bf16 v[112:115], a[188:191], a[16:19], v[112:115]
  buffer_load_dwordx4 v241, s[20:23], s31 offen offset:3072 lds
  v_mfma_f32_16x16x32_bf16 v[116:119], a[188:191], a[20:23], v[116:119]
  ds_read_b64_tr_b16 a[170:171], v225 offset:50176
  v_min_u32_dpp v136, v136, v136 row_ror:2 row_mask:0xf bank_mask:0xf
  v_mfma_f32_16x16x32_bf16 v[116:119], a[184:187], a[4:7], v[116:119]
  s_add_u32 s31, s31, 0x80000
  v_min_u32_dpp v136, v136, v136 row_ror:1 row_mask:0xf bank_mask:0xf
  v_mfma_f32_16x16x32_bf16 v[120:123], a[184:187], a[8:11], v[120:123]
  ds_read_b64_tr_b16 a[172:173], v225 offset:57344
  v_readlane_b32 s98, v136, 0
  v_mfma_f32_16x16x32_bf16 v[120:123], a[188:191], a[24:27], v[120:123]
  v_readlane_b32 s99, v136, 16
  v_readlane_b32 s100, v136, 32
  v_mfma_f32_16x16x32_bf16 v[124:127], a[188:191], a[28:31], v[124:127]
  ds_read_b64_tr_b16 a[174:175], v225 offset:58368
  v_readlane_b32 s101, v136, 48
  v_mfma_f32_16x16x32_bf16 v[124:127], a[184:187], a[12:15], v[124:127]
  s_waitcnt lgkmcnt(4)
  s_min_u32 s98, s98, s99
  s_min_u32 s100, s100, s101
  s_min_u32 s98, s98, s100
  s_sub_u32 s54, s51, s98
  s_sub_u32 s51, s54, 1
  v_sub_u32 v137, s51, v128
  v_sub_u32 v138, s51, v129
  v_mfma_f32_16x16x32_bf16 v[0:3], a[160:163], a[32:35], v[0:3]
  ds_read_b64_tr_b16 a[176:177], v226 offset:49152
  v_min_u32 v136, v137, v138
  v_mfma_f32_16x16x32_bf16 v[0:3], a[164:167], a[48:51], v[0:3]
  buffer_load_dwordx4 a[0:3], v242, s[24:27], s30 offen offset:0 sc1
  v_mfma_f32_16x16x32_bf16 v[4:7], a[164:167], a[52:55], v[4:7]
  ds_read_b64_tr_b16 a[178:179], v226 offset:50176
  v_sub_u32 v139, s51, v130
  v_mfma_f32_16x16x32_bf16 v[4:7], a[160:163], a[36:39], v[4:7]
  buffer_load_dwordx4 a[4:7], v242, s[24:27], s30 offen offset:1024 sc1
  v_mfma_f32_16x16x32_bf16 v[8:11], a[160:163], a[40:43], v[8:11]
  ds_read_b64_tr_b16 a[180:181], v226 offset:57344
  v_sub_u32 v140, s51, v131
  v_mfma_f32_16x16x32_bf16 v[8:11], a[164:167], a[56:59], v[8:11]
  buffer_load_dwordx4 a[8:11], v242, s[24:27], s30 offen offset:2048 sc1
  v_mfma_f32_16x16x32_bf16 v[12:15], a[164:167], a[60:63], v[12:15]
  ds_read_b64_tr_b16 a[182:183], v226 offset:58368
  v_min3_u32 v136, v136, v139, v140
  v_mfma_f32_16x16x32_bf16 v[12:15], a[160:163], a[44:47], v[12:15]
  s_waitcnt lgkmcnt(4)
  v_sub_u32 v137, s51, v132
  v_sub_u32 v138, s51, v133
  v_mfma_f32_16x16x32_bf16 v[16:19], a[168:171], a[32:35], v[16:19]
  ds_read_b64_tr_b16 a[184:185], v227 offset:49152
  v_min3_u32 v136, v136, v137, v138
  v_mfma_f32_16x16x32_bf16 v[16:19], a[172:175], a[48:51], v[16:19]
  buffer_load_dwordx4 a[12:15], v242, s[24:27], s30 offen offset:3072 sc1
  v_mfma_f32_16x16x32_bf16 v[20:23], a[172:175], a[52:55], v[20:23]
  ds_read_b64_tr_b16 a[186:187], v227 offset:50176
  v_sub_u32 v139, s51, v134
  v_mfma_f32_16x16x32_bf16 v[20:23], a[168:171], a[36:39], v[20:23]
  buffer_load_dwordx4 a[16:19], v243, s[24:27], s30 offen offset:0 sc1
  v_mfma_f32_16x16x32_bf16 v[24:27], a[168:171], a[40:43], v[24:27]
  ds_read_b64_tr_b16 a[188:189], v227 offset:57344
  v_sub_u32 v140, s51, v135
  v_mfma_f32_16x16x32_bf16 v[24:27], a[172:175], a[56:59], v[24:27]
  buffer_load_dwordx4 a[20:23], v243, s[24:27], s30 offen offset:1024 sc1
  v_mfma_f32_16x16x32_bf16 v[28:31], a[172:175], a[60:63], v[28:31]
  ds_read_b64_tr_b16 a[190:191], v227 offset:58368
  v_min3_u32 v136, v136, v139, v140
  v_mfma_f32_16x16x32_bf16 v[28:31], a[168:171], a[44:47], v[28:31]
  s_waitcnt lgkmcnt(4)
  v_min_u32_dpp v136, v136, v136 row_ror:8 row_mask:0xf bank_mask:0xf
  v_mfma_f32_16x16x32_bf16 v[32:35], a[176:179], a[32:35], v[32:35]
  ds_read_b64_tr_b16 a[160:161], v228 offset:49152
  v_min_u32_dpp v136, v136, v136 row_ror:4 row_mask:0xf bank_mask:0xf
  v_mfma_f32_16x16x32_bf16 v[32:35], a[180:183], a[48:51], v[32:35]
  buffer_load_dwordx4 a[24:27], v243, s[24:27], s30 offen offset:2048 sc1
  v_mfma_f32_16x16x32_bf16 v[36:39], a[180:183], a[52:55], v[36:39]
  ds_read_b64_tr_b16 a[162:163], v228 offset:50176
  v_min_u32_dpp v136, v136, v136 row_ror:2 row_mask:0xf bank_mask:0xf
  v_mfma_f32_16x16x32_bf16 v[36:39], a[176:179], a[36:39], v[36:39]
  buffer_load_dwordx4 a[28:31], v243, s[24:27], s30 offen offset:3072 sc1
  v_mfma_f32_16x16x32_bf16 v[40:43], a[176:179], a[40:43], v[40:43]
  ds_read_b64_tr_b16 a[164:165], v228 offset:57344
  v_min_u32_dpp v136, v136, v136 row_ror:1 row_mask:0xf bank_mask:0xf
  v_mfma_f32_16x16x32_bf16 v[40:43], a[180:183], a[56:59], v[40:43]
  s_add_u32 s30, s30, 8192
  v_readlane_b32 s98, v136, 0
  v_readlane_b32 s99, v136, 16
  v_mfma_f32_16x16x32_bf16 v[44:47], a[180:183], a[60:63], v[44:47]
  ds_read_b64_tr_b16 a[166:167], v228 offset:58368
  v_readlane_b32 s100, v136, 32
  v_mfma_f32_16x16x32_bf16 v[44:47], a[176:179], a[44:47], v[44:47]
  s_waitcnt lgkmcnt(4)
  v_readlane_b32 s101, v136, 48
  v_mfma_f32_16x16x32_bf16 v[48:51], a[184:187], a[32:35], v[48:51]
  ds_read_b64_tr_b16 a[168:169], v229 offset:49152
  s_min_u32 s98, s98, s99
  s_min_u32 s100, s100, s101
  s_min_u32 s98, s98, s100
  s_sub_u32 s55, s51, s98
  s_sub_u32 s51, s55, 1
  v_sub_u32 v137, s51, v128
  v_mfma_f32_16x16x32_bf16 v[48:51], a[188:191], a[48:51], v[48:51]
  v_sub_u32 v138, s51, v129
  v_min_u32 v136, v137, v138
  v_mfma_f32_16x16x32_bf16 v[52:55], a[188:191], a[52:55], v[52:55]
  ds_read_b64_tr_b16 a[170:171], v229 offset:50176
  v_sub_u32 v139, s51, v130
  v_mfma_f32_16x16x32_bf16 v[52:55], a[184:187], a[36:39], v[52:55]
  v_sub_u32 v140, s51, v131
  v_min3_u32 v136, v136, v139, v140
  v_mfma_f32_16x16x32_bf16 v[56:59], a[184:187], a[40:43], v[56:59]
  ds_read_b64_tr_b16 a[172:173], v229 offset:57344
  v_sub_u32 v137, s51, v132
  v_mfma_f32_16x16x32_bf16 v[56:59], a[188:191], a[56:59], v[56:59]
  v_sub_u32 v138, s51, v133
  v_min3_u32 v136, v136, v137, v138
  v_mfma_f32_16x16x32_bf16 v[60:63], a[188:191], a[60:63], v[60:63]
  ds_read_b64_tr_b16 a[174:175], v229 offset:58368
  v_sub_u32 v139, s51, v134
  v_mfma_f32_16x16x32_bf16 v[60:63], a[184:187], a[44:47], v[60:63]
  s_waitcnt lgkmcnt(4)
  v_sub_u32 v140, s51, v135
  v_min3_u32 v136, v136, v139, v140
  v_mfma_f32_16x16x32_bf16 v[64:67], a[160:163], a[32:35], v[64:67]
  ds_read_b64_tr_b16 a[176:177], v230 offset:49152
  v_min_u32_dpp v136, v136, v136 row_ror:8 row_mask:0xf bank_mask:0xf
  v_mfma_f32_16x16x32_bf16 v[64:67], a[164:167], a[48:51], v[64:67]
  v_mfma_f32_16x16x32_bf16 v[68:71], a[164:167], a[52:55], v[68:71]
  ds_read_b64_tr_b16 a[178:179], v230 offset:50176
  v_min_u32_dpp v136, v136, v136 row_ror:4 row_mask:0xf bank_mask:0xf
  v_mfma_f32_16x16x32_bf16 v[68:71], a[160:163], a[36:39], v[68:71]
  v_mfma_f32_16x16x32_bf16 v[72:75], a[160:163], a[40:43], v[72:75]
  ds_read_b64_tr_b16 a[180:181], v230 offset:57344
  v_min_u32_dpp v136, v136, v136 row_ror:2 row_mask:0xf bank_mask:0xf
  v_mfma_f32_16x16x32_bf16 v[72:75], a[164:167], a[56:59], v[72:75]
  v_mfma_f32_16x16x32_bf16 v[76:79], a[164:167], a[60:63], v[76:79]
  ds_read_b64_tr_b16 a[182:183], v230 offset:58368
  v_min_u32_dpp v136, v136, v136 row_ror:1 row_mask:0xf bank_mask:0xf
  v_mfma_f32_16x16x32_bf16 v[76:79], a[160:163], a[44:47], v[76:79]
  s_waitcnt lgkmcnt(4)
  v_readlane_b32 s98, v136, 0
  v_readlane_b32 s99, v136, 16
  v_mfma_f32_16x16x32_bf16 v[80:83], a[168:171], a[32:35], v[80:83]
  ds_read_b64_tr_b16 a[184:185], v231 offset:49152
  v_readlane_b32 s100, v136, 32
  v_mfma_f32_16x16x32_bf16 v[80:83], a[172:175], a[48:51], v[80:83]
  v_readlane_b32 s101, v136, 48
  v_mfma_f32_16x16x32_bf16 v[84:87], a[172:175], a[52:55], v[84:87]
  ds_read_b64_tr_b16 a[186:187], v231 offset:50176
  s_min_u32 s98, s98, s99
  s_min_u32 s100, s100, s101
  s_min_u32 s98, s98, s100
  s_sub_u32 s56, s51, s98
  s_sub_u32 s51, s56, 1
  v_sub_u32 v137, s51, v128
  v_mfma_f32_16x16x32_bf16 v[84:87], a[168:171], a[36:39], v[84:87]
  s_waitcnt vmcnt(20)
  v_sub_u32 v138, s51, v129
  v_min_u32 v136, v137, v138
  v_mfma_f32_16x16x32_bf16 v[88:91], a[168:171], a[40:43], v[88:91]
  ds_read_b64_tr_b16 a[188:189], v231 offset:57344
  v_sub_u32 v139, s51, v130
  v_mfma_f32_16x16x32_bf16 v[88:91], a[172:175], a[56:59], v[88:91]
  s_barrier
  v_sub_u32 v140, s51, v131
  v_min3_u32 v136, v136, v139, v140
  v_mfma_f32_16x16x32_bf16 v[92:95], a[172:175], a[60:63], v[92:95]
  ds_read_b64_tr_b16 a[190:191], v231 offset:58368
  v_sub_u32 v137, s51, v132
  v_mfma_f32_16x16x32_bf16 v[92:95], a[168:171], a[44:47], v[92:95]
  s_waitcnt lgkmcnt(4)
  s_add_u32 m0, s28, 98304
  v_sub_u32 v138, s51, v133
  v_min3_u32 v136, v136, v137, v138
  v_mfma_f32_16x16x32_bf16 v[96:99], a[176:179], a[32:35], v[96:99]
  ds_read_b64_tr_b16 a[160:161], v224 offset:0
  v_sub_u32 v139, s51, v134
  v_mfma_f32_16x16x32_bf16 v[96:99], a[180:183], a[48:51], v[96:99]
  buffer_load_dwordx4 v238, s[20:23], s31 offen offset:0 lds
  v_mfma_f32_16x16x32_bf16 v[100:103], a[180:183], a[52:55], v[100:103]
  ds_read_b64_tr_b16 a[162:163], v224 offset:1024
  v_sub_u32 v140, s51, v135
  v_mfma_f32_16x16x32_bf16 v[100:103], a[176:179], a[36:39], v[100:103]
  buffer_load_dwordx4 v239, s[20:23], s31 offen offset:1024 lds
  v_mfma_f32_16x16x32_bf16 v[104:107], a[176:179], a[40:43], v[104:107]
  ds_read_b64_tr_b16 a[164:165], v224 offset:8192
  v_min3_u32 v136, v136, v139, v140
  v_mfma_f32_16x16x32_bf16 v[104:107], a[180:183], a[56:59], v[104:107]
  buffer_load_dwordx4 v240, s[20:23], s31 offen offset:2048 lds
  v_mfma_f32_16x16x32_bf16 v[108:111], a[180:183], a[60:63], v[108:111]
  ds_read_b64_tr_b16 a[166:167], v224 offset:9216
  v_min_u32_dpp v136, v136, v136 row_ror:8 row_mask:0xf bank_mask:0xf
  v_mfma_f32_16x16x32_bf16 v[108:111], a[176:179], a[44:47], v[108:111]
  s_waitcnt lgkmcnt(4)
  v_min_u32_dpp v136, v136, v136 row_ror:4 row_mask:0xf bank_mask:0xf
  v_mfma_f32_16x16x32_bf16 v[112:115], a[184:187], a[32:35], v[112:115]
  ds_read_b64_tr_b16 a[168:169], v225 offset:0
  v_min_u32_dpp v136, v136, v136 row_ror:2 row_mask:0xf bank_mask:0xf
  v_mfma_f32_16x16x32_bf16 v[112:115], a[188:191], a[48:51], v[112:115]
  buffer_load_dwordx4 v241, s[20:23], s31 offen offset:3072 lds
  v_mfma_f32_16x16x32_bf16 v[116:119], a[188:191], a[52:55], v[116:119]
  ds_read_b64_tr_b16 a[170:171], v225 offset:1024
  v_min_u32_dpp v136, v136, v136 row_ror:1 row_mask:0xf bank_mask:0xf
  v_mfma_f32_16x16x32_bf16 v[116:119], a[184:187], a[36:39], v[116:119]
  s_add_u32 s31, s31, 0x80000
  v_readlane_b32 s98, v136, 0
  v_readlane_b32 s99, v136, 16
  v_mfma_f32_16x16x32_bf16 v[120:123], a[184:187], a[40:43], v[120:123]
  ds_read_b64_tr_b16 a[172:173], v225 offset:8192
  v_readlane_b32 s100, v136, 32
  v_mfma_f32_16x16x32_bf16 v[120:123], a[188:191], a[56:59], v[120:123]
  v_readlane_b32 s101, v136, 48
  v_mfma_f32_16x16x32_bf16 v[124:127], a[188:191], a[60:63], v[124:127]
  ds_read_b64_tr_b16 a[174:175], v225 offset:9216
  s_min_u32 s98, s98, s99
  s_min_u32 s100, s100, s101
  s_min_u32 s98, s98, s100
  s_sub_u32 s57, s51, s98
  s_sub_u32 s51, s57, 1
  v_sub_u32 v137, s51, v128
  v_mfma_f32_16x16x32_bf16 v[124:127], a[184:187], a[44:47], v[124:127]
  s_waitcnt lgkmcnt(4)
  v_sub_u32 v138, s51, v129
  v_min_u32 v136, v137, v138
  v_mfma_f32_16x16x32_bf16 v[0:3], a[160:163], a[64:67], v[0:3]
  ds_read_b64_tr_b16 a[176:177], v226 offset:0
  v_sub_u32 v139, s51, v130
  v_mfma_f32_16x16x32_bf16 v[0:3], a[164:167], a[80:83], v[0:3]
  buffer_load_dwordx4 a[32:35], v242, s[24:27], s30 offen offset:0 sc1
  v_mfma_f32_16x16x32_bf16 v[4:7], a[164:167], a[84:87], v[4:7]
  ds_read_b64_tr_b16 a[178:179], v226 offset:1024
  v_sub_u32 v140, s51, v131
  v_mfma_f32_16x16x32_bf16 v[4:7], a[160:163], a[68:71], v[4:7]
  buffer_load_dwordx4 a[36:39], v242, s[24:27], s30 offen offset:1024 sc1
  v_mfma_f32_16x16x32_bf16 v[8:11], a[160:163], a[72:75], v[8:11]
  ds_read_b64_tr_b16 a[180:181], v226 offset:8192
  v_min3_u32 v136, v136, v139, v140
  v_mfma_f32_16x16x32_bf16 v[8:11], a[164:167], a[88:91], v[8:11]
  buffer_load_dwordx4 a[40:43], v242, s[24:27], s30 offen offset:2048 sc1
  v_mfma_f32_16x16x32_bf16 v[12:15], a[164:167], a[92:95], v[12:15]
  ds_read_b64_tr_b16 a[182:183], v226 offset:9216
  v_sub_u32 v137, s51, v132
  v_mfma_f32_16x16x32_bf16 v[12:15], a[160:163], a[76:79], v[12:15]
  s_waitcnt lgkmcnt(4)
  v_sub_u32 v138, s51, v133
  v_min3_u32 v136, v136, v137, v138
  v_mfma_f32_16x16x32_bf16 v[16:19], a[168:171], a[64:67], v[16:19]
  ds_read_b64_tr_b16 a[184:185], v227 offset:0
  v_sub_u32 v139, s51, v134
  v_mfma_f32_16x16x32_bf16 v[16:19], a[172:175], a[80:83], v[16:19]
  buffer_load_dwordx4 a[44:47], v242, s[24:27], s30 offen offset:3072 sc1
  v_mfma_f32_16x16x32_bf16 v[20:23], a[172:175], a[84:87], v[20:23]
  ds_read_b64_tr_b16 a[186:187], v227 offset:1024
  v_sub_u32 v140, s51, v135
  v_mfma_f32_16x16x32_bf16 v[20:23], a[168:171], a[68:71], v[20:23]
  buffer_load_dwordx4 a[48:51], v243, s[24:27], s30 offen offset:0 sc1
  v_mfma_f32_16x16x32_bf16 v[24:27], a[168:171], a[72:75], v[24:27]
  ds_read_b64_tr_b16 a[188:189], v227 offset:8192
  v_min3_u32 v136, v136, v139, v140
  v_mfma_f32_16x16x32_bf16 v[24:27], a[172:175], a[88:91], v[24:27]
  buffer_load_dwordx4 a[52:55], v243, s[24:27], s30 offen offset:1024 sc1
  v_mfma_f32_16x16x32_bf16 v[28:31], a[172:175], a[92:95], v[28:31]
  ds_read_b64_tr_b16 a[190:191], v227 offset:9216
  v_min_u32_dpp v136, v136, v136 row_ror:8 row_mask:0xf bank_mask:0xf
  v_mfma_f32_16x16x32_bf16 v[28:31], a[168:171], a[76:79], v[28:31]
  s_waitcnt lgkmcnt(4)
  v_min_u32_dpp v136, v136, v136 row_ror:4 row_mask:0xf bank_mask:0xf
  v_mfma_f32_16x16x32_bf16 v[32:35], a[176:179], a[64:67], v[32:35]
  ds_read_b64_tr_b16 a[160:161], v228 offset:0
  v_min_u32_dpp v136, v136, v136 row_ror:2 row_mask:0xf bank_mask:0xf
  v_mfma_f32_16x16x32_bf16 v[32:35], a[180:183], a[80:83], v[32:35]
  buffer_load_dwordx4 a[56:59], v243, s[24:27], s30 offen offset:2048 sc1
  v_mfma_f32_16x16x32_bf16 v[36:39], a[180:183], a[84:87], v[36:39]
  ds_read_b64_tr_b16 a[162:163], v228 offset:1024
  v_min_u32_dpp v136, v136, v136 row_ror:1 row_mask:0xf bank_mask:0xf
  v_mfma_f32_16x16x32_bf16 v[36:39], a[176:179], a[68:71], v[36:39]
  buffer_load_dwordx4 a[60:63], v243, s[24:27], s30 offen offset:3072 sc1
  v_mfma_f32_16x16x32_bf16 v[40:43], a[176:179], a[72:75], v[40:43]
  ds_read_b64_tr_b16 a[164:165], v228 offset:8192
  v_readlane_b32 s98, v136, 0
  v_mfma_f32_16x16x32_bf16 v[40:43], a[180:183], a[88:91], v[40:43]
  s_add_u32 s30, s30, 8192
  v_readlane_b32 s99, v136, 16
  v_readlane_b32 s100, v136, 32
  v_mfma_f32_16x16x32_bf16 v[44:47], a[180:183], a[92:95], v[44:47]
  ds_read_b64_tr_b16 a[166:167], v228 offset:9216
  v_readlane_b32 s101, v136, 48
  v_mfma_f32_16x16x32_bf16 v[44:47], a[176:179], a[76:79], v[44:47]
  s_waitcnt lgkmcnt(4)
  s_min_u32 s98, s98, s99
  s_min_u32 s100, s100, s101
  s_min_u32 s98, s98, s100
  s_sub_u32 s58, s51, s98
  s_sub_u32 s51, s58, 1
  v_sub_u32 v137, s51, v128
  v_sub_u32 v138, s51, v129
  v_mfma_f32_16x16x32_bf16 v[48:51], a[184:187], a[64:67], v[48:51]
  ds_read_b64_tr_b16 a[168:169], v229 offset:0
  v_min_u32 v136, v137, v138
  v_mfma_f32_16x16x32_bf16 v[48:51], a[188:191], a[80:83], v[48:51]
  v_sub_u32 v139, s51, v130
  v_sub_u32 v140, s51, v131
  v_mfma_f32_16x16x32_bf16 v[52:55], a[188:191], a[84:87], v[52:55]
  ds_read_b64_tr_b16 a[170:171], v229 offset:1024
  v_min3_u32 v136, v136, v139, v140
  v_mfma_f32_16x16x32_bf16 v[52:55], a[184:187], a[68:71], v[52:55]
  v_sub_u32 v137, s51, v132
  v_sub_u32 v138, s51, v133
  v_mfma_f32_16x16x32_bf16 v[56:59], a[184:187], a[72:75], v[56:59]
  ds_read_b64_tr_b16 a[172:173], v229 offset:8192
  v_min3_u32 v136, v136, v137, v138
  v_mfma_f32_16x16x32_bf16 v[56:59], a[188:191], a[88:91], v[56:59]
  v_sub_u32 v139, s51, v134
  v_sub_u32 v140, s51, v135
  v_mfma_f32_16x16x32_bf16 v[60:63], a[188:191], a[92:95], v[60:63]
  ds_read_b64_tr_b16 a[174:175], v229 offset:9216
  v_min3_u32 v136, v136, v139, v140
  v_mfma_f32_16x16x32_bf16 v[60:63], a[184:187], a[76:79], v[60:63]
  s_waitcnt lgkmcnt(4)
  v_min_u32_dpp v136, v136, v136 row_ror:8 row_mask:0xf bank_mask:0xf
  v_mfma_f32_16x16x32_bf16 v[64:67], a[160:163], a[64:67], v[64:67]
  ds_read_b64_tr_b16 a[176:177], v230 offset:0
  v_min_u32_dpp v136, v136, v136 row_ror:4 row_mask:0xf bank_mask:0xf
  v_mfma_f32_16x16x32_bf16 v[64:67], a[164:167], a[80:83], v[64:67]
  v_mfma_f32_16x16x32_bf16 v[68:71], a[164:167], a[84:87], v[68:71]
  ds_read_b64_tr_b16 a[178:179], v230 offset:1024
  v_min_u32_dpp v136, v136, v136 row_ror:2 row_mask:0xf bank_mask:0xf
  v_mfma_f32_16x16x32_bf16 v[68:71], a[160:163], a[68:71], v[68:71]
  v_mfma_f32_16x16x32_bf16 v[72:75], a[160:163], a[72:75], v[72:75]
  ds_read_b64_tr_b16 a[180:181], v230 offset:8192
  v_min_u32_dpp v136, v136, v136 row_ror:1 row_mask:0xf bank_mask:0xf
  v_mfma_f32_16x16x32_bf16 v[72:75], a[164:167], a[88:91], v[72:75]
  v_readlane_b32 s98, v136, 0
  v_readlane_b32 s99, v136, 16
  v_mfma_f32_16x16x32_bf16 v[76:79], a[164:167], a[92:95], v[76:79]
  ds_read_b64_tr_b16 a[182:183], v230 offset:9216
  v_readlane_b32 s100, v136, 32
  v_mfma_f32_16x16x32_bf16 v[76:79], a[160:163], a[76:79], v[76:79]
  s_waitcnt lgkmcnt(4)
  v_readlane_b32 s101, v136, 48
  v_mfma_f32_16x16x32_bf16 v[80:83], a[168:171], a[64:67], v[80:83]
  ds_read_b64_tr_b16 a[184:185], v231 offset:0
  s_min_u32 s98, s98, s99
  s_min_u32 s100, s100, s101
  s_min_u32 s98, s98, s100
  s_sub_u32 s59, s51, s98
  s_sub_u32 s51, s59, 1
  v_writelane_b32 v136, s52, 0
  v_mfma_f32_16x16x32_bf16 v[80:83], a[172:175], a[80:83], v[80:83]
  v_writelane_b32 v136, s53, 1
  v_writelane_b32 v136, s54, 2
  v_mfma_f32_16x16x32_bf16 v[84:87], a[172:175], a[84:87], v[84:87]
  ds_read_b64_tr_b16 a[186:187], v231 offset:1024
  v_writelane_b32 v136, s55, 3
  v_mfma_f32_16x16x32_bf16 v[84:87], a[168:171], a[68:71], v[84:87]
  s_waitcnt vmcnt(20)
  v_writelane_b32 v136, s56, 4
  v_writelane_b32 v136, s57, 5
  v_mfma_f32_16x16x32_bf16 v[88:91], a[168:171], a[72:75], v[88:91]
  ds_read_b64_tr_b16 a[188:189], v231 offset:8192
  v_writelane_b32 v136, s58, 6
  v_writelane_b32 v136, s59, 7
  s_lshl_b32 s35, s3, 8
  s_add_u32 s35, s35, 158720
  v_lshrrev_b32 v137, 2, v242
  v_add_u32 v137, s35, v137
  ds_write_b32 v137, v136
  s_waitcnt lgkmcnt(0)
  v_mfma_f32_16x16x32_bf16 v[88:91], a[172:175], a[88:91], v[88:91]
  s_barrier
  v_mfma_f32_16x16x32_bf16 v[92:95], a[172:175], a[92:95], v[92:95]
  ds_read_b64_tr_b16 a[190:191], v231 offset:9216
  v_mfma_f32_16x16x32_bf16 v[92:95], a[168:171], a[76:79], v[92:95]
  s_add_u32 m0, s28, 114688
  v_mfma_f32_16x16x32_bf16 v[96:99], a[176:179], a[64:67], v[96:99]
  ds_read_b64_tr_b16 a[160:161], v224 offset:16384
  v_mfma_f32_16x16x32_bf16 v[96:99], a[180:183], a[80:83], v[96:99]
  buffer_load_dwordx4 v238, s[20:23], s31 offen offset:0 lds
  v_mfma_f32_16x16x32_bf16 v[100:103], a[180:183], a[84:87], v[100:103]
  ds_read_b64_tr_b16 a[162:163], v224 offset:17408
  v_mfma_f32_16x16x32_bf16 v[100:103], a[176:179], a[68:71], v[100:103]
  buffer_load_dwordx4 v239, s[20:23], s31 offen offset:1024 lds
  v_mfma_f32_16x16x32_bf16 v[104:107], a[176:179], a[72:75], v[104:107]
  ds_read_b64_tr_b16 a[164:165], v224 offset:24576
  v_mfma_f32_16x16x32_bf16 v[104:107], a[180:183], a[88:91], v[104:107]
  buffer_load_dwordx4 v240, s[20:23], s31 offen offset:2048 lds
  v_mfma_f32_16x16x32_bf16 v[108:111], a[180:183], a[92:95], v[108:111]
  ds_read_b64_tr_b16 a[166:167], v224 offset:25600
  v_mfma_f32_16x16x32_bf16 v[108:111], a[176:179], a[76:79], v[108:111]
  s_waitcnt lgkmcnt(4)
  v_mfma_f32_16x16x32_bf16 v[112:115], a[184:187], a[64:67], v[112:115]
  ds_read_b64_tr_b16 a[168:169], v225 offset:16384
  v_mfma_f32_16x16x32_bf16 v[112:115], a[188:191], a[80:83], v[112:115]
  buffer_load_dwordx4 v241, s[20:23], s31 offen offset:3072 lds
  v_mfma_f32_16x16x32_bf16 v[116:119], a[188:191], a[84:87], v[116:119]
  ds_read_b64_tr_b16 a[170:171], v225 offset:17408
  v_mfma_f32_16x16x32_bf16 v[116:119], a[184:187], a[68:71], v[116:119]
  s_add_u32 s31, s31, 0x80000
  v_mfma_f32_16x16x32_bf16 v[120:123], a[184:187], a[72:75], v[120:123]
  ds_read_b64_tr_b16 a[172:173], v225 offset:24576
  v_mfma_f32_16x16x32_bf16 v[120:123], a[188:191], a[88:91], v[120:123]
  v_mfma_f32_16x16x32_bf16 v[124:127], a[188:191], a[92:95], v[124:127]
  ds_read_b64_tr_b16 a[174:175], v225 offset:25600
  v_mfma_f32_16x16x32_bf16 v[124:127], a[184:187], a[76:79], v[124:127]
  s_waitcnt lgkmcnt(4)
  v_mfma_f32_16x16x32_bf16 v[0:3], a[160:163], a[96:99], v[0:3]
  ds_read_b64_tr_b16 a[176:177], v226 offset:16384
  v_lshrrev_b32 v136, 4, v242
  v_mfma_f32_16x16x32_bf16 v[0:3], a[164:167], a[112:115], v[0:3]
  s_add_u32 m0, s28, 0
  v_bfe_u32 v137, v136, 3, 2
  v_and_b32 v138, 7, v136
  v_mfma_f32_16x16x32_bf16 v[4:7], a[164:167], a[116:119], v[4:7]
  ds_read_b64_tr_b16 a[178:179], v226 offset:17408
  v_lshlrev_b32 v137, 8, v137
  v_mfma_f32_16x16x32_bf16 v[4:7], a[160:163], a[100:103], v[4:7]
  buffer_load_dwordx4 v232, s[12:15], s29 offen offset:0 lds
  v_mfma_f32_16x16x32_bf16 v[8:11], a[160:163], a[104:107], v[8:11]
  ds_read_b64_tr_b16 a[180:181], v226 offset:24576
  v_lshl_add_u32 v137, v138, 2, v137
  v_mfma_f32_16x16x32_bf16 v[8:11], a[164:167], a[120:123], v[8:11]
  buffer_load_dwordx4 v233, s[12:15], s29 offen offset:1024 lds
  v_mfma_f32_16x16x32_bf16 v[12:15], a[164:167], a[124:127], v[12:15]
  ds_read_b64_tr_b16 a[182:183], v226 offset:25600
  v_add_u32 v137, 158720, v137
  v_mfma_f32_16x16x32_bf16 v[12:15], a[160:163], a[108:111], v[12:15]
  s_waitcnt lgkmcnt(4)
  ds_read_b32 v128, v137
  v_mfma_f32_16x16x32_bf16 v[16:19], a[168:171], a[96:99], v[16:19]
  ds_read_b64_tr_b16 a[184:185], v227 offset:16384
  v_mfma_f32_16x16x32_bf16 v[16:19], a[172:175], a[112:115], v[16:19]
  buffer_load_dwordx4 v234, s[12:15], s29 offen offset:2048 lds
  v_mfma_f32_16x16x32_bf16 v[20:23], a[172:175], a[116:119], v[20:23]
  ds_read_b64_tr_b16 a[186:187], v227 offset:17408
  v_mfma_f32_16x16x32_bf16 v[20:23], a[168:171], a[100:103], v[20:23]
  buffer_load_dwordx4 v235, s[12:15], s29 offen offset:3072 lds
  v_mfma_f32_16x16x32_bf16 v[24:27], a[168:171], a[104:107], v[24:27]
  ds_read_b64_tr_b16 a[188:189], v227 offset:24576
  v_mfma_f32_16x16x32_bf16 v[24:27], a[172:175], a[120:123], v[24:27]
  v_mfma_f32_16x16x32_bf16 v[28:31], a[172:175], a[124:127], v[28:31]
  ds_read_b64_tr_b16 a[190:191], v227 offset:25600
  v_mfma_f32_16x16x32_bf16 v[28:31], a[168:171], a[108:111], v[28:31]
  s_waitcnt lgkmcnt(5)
  s_waitcnt lgkmcnt(4)
  s_mov_b32 s51, -1
  v_sub_u32 v137, s51, v128
  v_mfma_f32_16x16x32_bf16 v[32:35], a[176:179], a[96:99], v[32:35]
  ds_read_b64_tr_b16 a[160:161], v228 offset:16384
  v_min_u32_dpp v137, v137, v137 row_ror:8 row_mask:0xf bank_mask:0xf
  v_mfma_f32_16x16x32_bf16 v[32:35], a[180:183], a[112:115], v[32:35]
  v_mfma_f32_16x16x32_bf16 v[36:39], a[180:183], a[116:119], v[36:39]
  ds_read_b64_tr_b16 a[162:163], v228 offset:17408
  v_min_u32_dpp v137, v137, v137 row_ror:4 row_mask:0xf bank_mask:0xf
  v_mfma_f32_16x16x32_bf16 v[36:39], a[176:179], a[100:103], v[36:39]
  v_mfma_f32_16x16x32_bf16 v[40:43], a[176:179], a[104:107], v[40:43]
  ds_read_b64_tr_b16 a[164:165], v228 offset:24576
  v_min_u32_dpp v137, v137, v137 row_ror:2 row_mask:0xf bank_mask:0xf
  v_mfma_f32_16x16x32_bf16 v[40:43], a[180:183], a[120:123], v[40:43]
  v_mfma_f32_16x16x32_bf16 v[44:47], a[180:183], a[124:127], v[44:47]
  ds_read_b64_tr_b16 a[166:167], v228 offset:25600
  v_min_u32_dpp v137, v137, v137 row_ror:1 row_mask:0xf bank_mask:0xf
  v_mfma_f32_16x16x32_bf16 v[44:47], a[176:179], a[108:111], v[44:47]
  s_waitcnt lgkmcnt(4)
  v_readlane_b32 s98, v137, 0
  v_readlane_b32 s99, v137, 16
  v_mfma_f32_16x16x32_bf16 v[48:51], a[184:187], a[96:99], v[48:51]
  ds_read_b64_tr_b16 a[168:169], v229 offset:16384
  s_min_u32 s98, s98, s99
  s_sub_u32 s52, s51, s98
  s_sub_u32 s51, s52, 1
  v_sub_u32 v137, s51, v128
  v_mfma_f32_16x16x32_bf16 v[48:51], a[188:191], a[112:115], v[48:51]
  v_mfma_f32_16x16x32_bf16 v[52:55], a[188:191], a[116:119], v[52:55]
  ds_read_b64_tr_b16 a[170:171], v229 offset:17408
  v_min_u32_dpp v137, v137, v137 row_ror:8 row_mask:0xf bank_mask:0xf
  v_mfma_f32_16x16x32_bf16 v[52:55], a[184:187], a[100:103], v[52:55]
  v_mfma_f32_16x16x32_bf16 v[56:59], a[184:187], a[104:107], v[56:59]
  ds_read_b64_tr_b16 a[172:173], v229 offset:24576
  v_min_u32_dpp v137, v137, v137 row_ror:4 row_mask:0xf bank_mask:0xf
  v_mfma_f32_16x16x32_bf16 v[56:59], a[188:191], a[120:123], v[56:59]
  v_mfma_f32_16x16x32_bf16 v[60:63], a[188:191], a[124:127], v[60:63]
  ds_read_b64_tr_b16 a[174:175], v229 offset:25600
  v_min_u32_dpp v137, v137, v137 row_ror:2 row_mask:0xf bank_mask:0xf
  v_mfma_f32_16x16x32_bf16 v[60:63], a[184:187], a[108:111], v[60:63]
  s_waitcnt lgkmcnt(4)
  v_min_u32_dpp v137, v137, v137 row_ror:1 row_mask:0xf bank_mask:0xf
  v_mfma_f32_16x16x32_bf16 v[64:67], a[160:163], a[96:99], v[64:67]
  ds_read_b64_tr_b16 a[176:177], v230 offset:16384
  v_readlane_b32 s98, v137, 0
  v_mfma_f32_16x16x32_bf16 v[64:67], a[164:167], a[112:115], v[64:67]
  v_readlane_b32 s99, v137, 16
  v_mfma_f32_16x16x32_bf16 v[68:71], a[164:167], a[116:119], v[68:71]
  ds_read_b64_tr_b16 a[178:179], v230 offset:17408
  s_min_u32 s98, s98, s99
  s_sub_u32 s53, s51, s98
  s_sub_u32 s51, s53, 1
  v_sub_u32 v137, s51, v128
  v_mfma_f32_16x16x32_bf16 v[68:71], a[160:163], a[100:103], v[68:71]
  v_mfma_f32_16x16x32_bf16 v[72:75], a[160:163], a[104:107], v[72:75]
  ds_read_b64_tr_b16 a[180:181], v230 offset:24576
  v_min_u32_dpp v137, v137, v137 row_ror:8 row_mask:0xf bank_mask:0xf
  v_mfma_f32_16x16x32_bf16 v[72:75], a[164:167], a[120:123], v[72:75]
  v_mfma_f32_16x16x32_bf16 v[76:79], a[164:167], a[124:127], v[76:79]
  ds_read_b64_tr_b16 a[182:183], v230 offset:25600
  v_min_u32_dpp v137, v137, v137 row_ror:4 row_mask:0xf bank_mask:0xf
  v_mfma_f32_16x16x32_bf16 v[76:79], a[160:163], a[108:111], v[76:79]
  s_waitcnt lgkmcnt(4)
  v_min_u32_dpp v137, v137, v137 row_ror:2 row_mask:0xf bank_mask:0xf
  v_mfma_f32_16x16x32_bf16 v[80:83], a[168:171], a[96:99], v[80:83]
  ds_read_b64_tr_b16 a[184:185], v231 offset:16384
  v_min_u32_dpp v137, v137, v137 row_ror:1 row_mask:0xf bank_mask:0xf
  v_mfma_f32_16x16x32_bf16 v[80:83], a[172:175], a[112:115], v[80:83]
  v_readlane_b32 s98, v137, 0
  v_readlane_b32 s99, v137, 16
  v_mfma_f32_16x16x32_bf16 v[84:87], a[172:175], a[116:119], v[84:87]
  ds_read_b64_tr_b16 a[186:187], v231 offset:17408
  s_min_u32 s98, s98, s99
  s_sub_u32 s54, s51, s98
  s_sub_u32 s51, s54, 1
  v_sub_u32 v137, s51, v128
  v_mfma_f32_16x16x32_bf16 v[84:87], a[168:171], a[100:103], v[84:87]
  s_waitcnt vmcnt(16)
  v_min_u32_dpp v137, v137, v137 row_ror:8 row_mask:0xf bank_mask:0xf
  v_mfma_f32_16x16x32_bf16 v[88:91], a[168:171], a[104:107], v[88:91]
  ds_read_b64_tr_b16 a[188:189], v231 offset:24576
  v_min_u32_dpp v137, v137, v137 row_ror:4 row_mask:0xf bank_mask:0xf
  v_mfma_f32_16x16x32_bf16 v[88:91], a[172:175], a[120:123], v[88:91]
  s_barrier
  v_min_u32_dpp v137, v137, v137 row_ror:2 row_mask:0xf bank_mask:0xf
  v_mfma_f32_16x16x32_bf16 v[92:95], a[172:175], a[124:127], v[92:95]
  ds_read_b64_tr_b16 a[190:191], v231 offset:25600
  v_min_u32_dpp v137, v137, v137 row_ror:1 row_mask:0xf bank_mask:0xf
  v_mfma_f32_16x16x32_bf16 v[92:95], a[168:171], a[108:111], v[92:95]
  s_waitcnt lgkmcnt(4)
  v_readlane_b32 s98, v137, 0
  v_readlane_b32 s99, v137, 16
  v_mfma_f32_16x16x32_bf16 v[96:99], a[176:179], a[96:99], v[96:99]
  ds_read_b64_tr_b16 a[160:161], v224 offset:32768
  s_min_u32 s98, s98, s99
  s_sub_u32 s55, s51, s98
  s_sub_u32 s51, s55, 1
  v_sub_u32 v137, s51, v128
  v_mfma_f32_16x16x32_bf16 v[96:99], a[180:183], a[112:115], v[96:99]
  v_mfma_f32_16x16x32_bf16 v[100:103], a[180:183], a[116:119], v[100:103]
  ds_read_b64_tr_b16 a[162:163], v224 offset:33792
  v_min_u32_dpp v137, v137, v137 row_ror:8 row_mask:0xf bank_mask:0xf
  v_mfma_f32_16x16x32_bf16 v[100:103], a[176:179], a[100:103], v[100:103]
  v_mfma_f32_16x16x32_bf16 v[104:107], a[176:179], a[104:107], v[104:107]
  ds_read_b64_tr_b16 a[164:165], v224 offset:40960
  v_min_u32_dpp v137, v137, v137 row_ror:4 row_mask:0xf bank_mask:0xf
  v_mfma_f32_16x16x32_bf16 v[104:107], a[180:183], a[120:123], v[104:107]
  v_mfma_f32_16x16x32_bf16 v[108:111], a[180:183], a[124:127], v[108:111]
  ds_read_b64_tr_b16 a[166:167], v224 offset:41984
  v_min_u32_dpp v137, v137, v137 row_ror:2 row_mask:0xf bank_mask:0xf
  v_mfma_f32_16x16x32_bf16 v[108:111], a[176:179], a[108:111], v[108:111]
  s_waitcnt lgkmcnt(4)
  v_min_u32_dpp v137, v137, v137 row_ror:1 row_mask:0xf bank_mask:0xf
  v_mfma_f32_16x16x32_bf16 v[112:115], a[184:187], a[96:99], v[112:115]
  ds_read_b64_tr_b16 a[168:169], v225 offset:32768
  v_readlane_b32 s98, v137, 0
  v_mfma_f32_16x16x32_bf16 v[112:115], a[188:191], a[112:115], v[112:115]
  v_readlane_b32 s99, v137, 16
  v_mfma_f32_16x16x32_bf16 v[116:119], a[188:191], a[116:119], v[116:119]
  ds_read_b64_tr_b16 a[170:171], v225 offset:33792
  s_min_u32 s98, s98, s99
  s_sub_u32 s56, s51, s98
  s_sub_u32 s51, s56, 1
  v_sub_u32 v137, s51, v128
  v_mfma_f32_16x16x32_bf16 v[116:119], a[184:187], a[100:103], v[116:119]
  v_mfma_f32_16x16x32_bf16 v[120:123], a[184:187], a[104:107], v[120:123]
  ds_read_b64_tr_b16 a[172:173], v225 offset:40960
  v_min_u32_dpp v137, v137, v137 row_ror:8 row_mask:0xf bank_mask:0xf
  v_mfma_f32_16x16x32_bf16 v[120:123], a[188:191], a[120:123], v[120:123]
  v_mfma_f32_16x16x32_bf16 v[124:127], a[188:191], a[124:127], v[124:127]
  ds_read_b64_tr_b16 a[174:175], v225 offset:41984
  v_min_u32_dpp v137, v137, v137 row_ror:4 row_mask:0xf bank_mask:0xf
  v_mfma_f32_16x16x32_bf16 v[124:127], a[184:187], a[108:111], v[124:127]
  s_waitcnt lgkmcnt(4)
  v_min_u32_dpp v137, v137, v137 row_ror:2 row_mask:0xf bank_mask:0xf
  v_mfma_f32_16x16x32_bf16 v[0:3], a[160:163], a[0:3], v[0:3]
  ds_read_b64_tr_b16 a[176:177], v226 offset:32768
  v_min_u32_dpp v137, v137, v137 row_ror:1 row_mask:0xf bank_mask:0xf
  v_mfma_f32_16x16x32_bf16 v[0:3], a[164:167], a[16:19], v[0:3]
  v_readlane_b32 s98, v137, 0
  v_readlane_b32 s99, v137, 16
  v_mfma_f32_16x16x32_bf16 v[4:7], a[164:167], a[20:23], v[4:7]
  ds_read_b64_tr_b16 a[178:179], v226 offset:33792
  s_min_u32 s98, s98, s99
  s_sub_u32 s57, s51, s98
  s_sub_u32 s51, s57, 1
  v_sub_u32 v137, s51, v128
  v_mfma_f32_16x16x32_bf16 v[4:7], a[160:163], a[4:7], v[4:7]
  v_mfma_f32_16x16x32_bf16 v[8:11], a[160:163], a[8:11], v[8:11]
  ds_read_b64_tr_b16 a[180:181], v226 offset:40960
  v_min_u32_dpp v137, v137, v137 row_ror:8 row_mask:0xf bank_mask:0xf
  v_mfma_f32_16x16x32_bf16 v[8:11], a[164:167], a[24:27], v[8:11]
  v_mfma_f32_16x16x32_bf16 v[12:15], a[164:167], a[28:31], v[12:15]
  ds_read_b64_tr_b16 a[182:183], v226 offset:41984
  v_min_u32_dpp v137, v137, v137 row_ror:4 row_mask:0xf bank_mask:0xf
  v_mfma_f32_16x16x32_bf16 v[12:15], a[160:163], a[12:15], v[12:15]
  s_waitcnt lgkmcnt(4)
  v_min_u32_dpp v137, v137, v137 row_ror:2 row_mask:0xf bank_mask:0xf
  v_mfma_f32_16x16x32_bf16 v[16:19], a[168:171], a[0:3], v[16:19]
  ds_read_b64_tr_b16 a[184:185], v227 offset:32768
  v_min_u32_dpp v137, v137, v137 row_ror:1 row_mask:0xf bank_mask:0xf
  v_mfma_f32_16x16x32_bf16 v[16:19], a[172:175], a[16:19], v[16:19]
  v_readlane_b32 s98, v137, 0
  v_readlane_b32 s99, v137, 16
  v_mfma_f32_16x16x32_bf16 v[20:23], a[172:175], a[20:23], v[20:23]
  ds_read_b64_tr_b16 a[186:187], v227 offset:33792
  s_min_u32 s98, s98, s99
  s_sub_u32 s58, s51, s98
  s_sub_u32 s51, s58, 1
  v_sub_u32 v137, s51, v128
  v_mfma_f32_16x16x32_bf16 v[20:23], a[168:171], a[4:7], v[20:23]
  v_mfma_f32_16x16x32_bf16 v[24:27], a[168:171], a[8:11], v[24:27]
  ds_read_b64_tr_b16 a[188:189], v227 offset:40960
  v_min_u32_dpp v137, v137, v137 row_ror:8 row_mask:0xf bank_mask:0xf
  v_mfma_f32_16x16x32_bf16 v[24:27], a[172:175], a[24:27], v[24:27]
  v_mfma_f32_16x16x32_bf16 v[28:31], a[172:175], a[28:31], v[28:31]
  ds_read_b64_tr_b16 a[190:191], v227 offset:41984
  v_min_u32_dpp v137, v137, v137 row_ror:4 row_mask:0xf bank_mask:0xf
  v_mfma_f32_16x16x32_bf16 v[28:31], a[168:171], a[12:15], v[28:31]
  s_waitcnt lgkmcnt(4)
  v_min_u32_dpp v137, v137, v137 row_ror:2 row_mask:0xf bank_mask:0xf
  v_mfma_f32_16x16x32_bf16 v[32:35], a[176:179], a[0:3], v[32:35]
  ds_read_b64_tr_b16 a[160:161], v228 offset:32768
  v_min_u32_dpp v137, v137, v137 row_ror:1 row_mask:0xf bank_mask:0xf
  v_mfma_f32_16x16x32_bf16 v[32:35], a[180:183], a[16:19], v[32:35]
  v_readlane_b32 s98, v137, 0
  v_readlane_b32 s99, v137, 16
  v_mfma_f32_16x16x32_bf16 v[36:39], a[180:183], a[20:23], v[36:39]
  ds_read_b64_tr_b16 a[162:163], v228 offset:33792
  s_min_u32 s98, s98, s99
  s_sub_u32 s59, s51, s98
  s_sub_u32 s51, s59, 1
  v_mov_b32 v128, 0
  v_mfma_f32_16x16x32_bf16 v[36:39], a[176:179], a[4:7], v[36:39]
  v_writelane_b32 v128, s52, 0
  v_writelane_b32 v128, s53, 1
  v_mfma_f32_16x16x32_bf16 v[40:43], a[176:179], a[8:11], v[40:43]
  ds_read_b64_tr_b16 a[164:165], v228 offset:40960
  v_writelane_b32 v128, s54, 2
  v_mfma_f32_16x16x32_bf16 v[40:43], a[180:183], a[24:27], v[40:43]
  v_writelane_b32 v128, s55, 3
  v_writelane_b32 v128, s56, 4
  v_mfma_f32_16x16x32_bf16 v[44:47], a[180:183], a[28:31], v[44:47]
  ds_read_b64_tr_b16 a[166:167], v228 offset:41984
  v_writelane_b32 v128, s57, 5
  v_mfma_f32_16x16x32_bf16 v[44:47], a[176:179], a[12:15], v[44:47]
  s_waitcnt lgkmcnt(4)
  v_writelane_b32 v128, s58, 6
  v_writelane_b32 v128, s59, 7
  v_mfma_f32_16x16x32_bf16 v[48:51], a[184:187], a[0:3], v[48:51]
  ds_read_b64_tr_b16 a[168:169], v229 offset:32768
  s_cmp_eq_u32 s2, 0
  s_cselect_b32 s35, 0, 1073741824
  v_lshrrev_b32 v137, 3, v136
  v_mfma_f32_16x16x32_bf16 v[48:51], a[188:191], a[16:19], v[48:51]
  v_lshlrev_b32 v137, 28, v137
  v_lshl_add_u32 v137, v136, 2, v137
  v_mfma_f32_16x16x32_bf16 v[52:55], a[188:191], a[20:23], v[52:55]
  ds_read_b64_tr_b16 a[170:171], v229 offset:33792
  v_or_b32 v137, s35, v137
  v_mfma_f32_16x16x32_bf16 v[52:55], a[184:187], a[4:7], v[52:55]
  s_mov_b32 s35, 2629632
  buffer_store_dword v128, v137, s[24:27], s35 offen
  v_mfma_f32_16x16x32_bf16 v[56:59], a[184:187], a[8:11], v[56:59]
  ds_read_b64_tr_b16 a[172:173], v229 offset:40960
  v_and_b32 v129, 0xffff, v128
  v_mfma_f32_16x16x32_bf16 v[56:59], a[188:191], a[24:27], v[56:59]
  v_sub_u32 v129, 0xffff, v129
  v_and_b32 v129, 0x7ff, v129
  v_mfma_f32_16x16x32_bf16 v[60:63], a[188:191], a[28:31], v[60:63]
  ds_read_b64_tr_b16 a[174:175], v229 offset:41984
  v_mov_b32 v130, v129
  v_mfma_f32_16x16x32_bf16 v[60:63], a[184:187], a[12:15], v[60:63]
  s_waitcnt lgkmcnt(4)
  v_permlane16_swap_b32 v129, v130
  v_mov_b32 v130, v129
  v_mfma_f32_16x16x32_bf16 v[64:67], a[160:163], a[0:3], v[64:67]
  ds_read_b64_tr_b16 a[176:177], v230 offset:32768
  v_permlane32_swap_b32 v129, v130
  v_mfma_f32_16x16x32_bf16 v[64:67], a[164:167], a[16:19], v[64:67]
  v_lshrrev_b32 v130, 6, v129
  v_mul_u32_u24 v130, 0x14000, v130
  v_mfma_f32_16x16x32_bf16 v[68:71], a[164:167], a[20:23], v[68:71]
  ds_read_b64_tr_b16 a[178:179], v230 offset:33792
  v_bfe_u32 v131, v129, 4, 2
  v_mfma_f32_16x16x32_bf16 v[68:71], a[160:163], a[4:7], v[68:71]
  v_lshl_add_u32 v130, v131, 10, v130
  v_and_b32 v131, 15, v129
  v_mfma_f32_16x16x32_bf16 v[72:75], a[160:163], a[8:11], v[72:75]
  ds_read_b64_tr_b16 a[180:181], v230 offset:40960
  v_lshl_add_u32 v130, v131, 4, v130
  v_mfma_f32_16x16x32_bf16 v[72:75], a[164:167], a[24:27], v[72:75]
  v_lshrrev_b32 v131, 4, v136
  v_lshl_add_u32 v243, v131, 8, v130
  v_mfma_f32_16x16x32_bf16 v[76:79], a[164:167], a[28:31], v[76:79]
  ds_read_b64_tr_b16 a[182:183], v230 offset:41984
  v_mfma_f32_16x16x32_bf16 v[76:79], a[160:163], a[12:15], v[76:79]
  s_waitcnt lgkmcnt(4)
  v_mfma_f32_16x16x32_bf16 v[80:83], a[168:171], a[0:3], v[80:83]
  ds_read_b64_tr_b16 a[184:185], v231 offset:32768
  v_mfma_f32_16x16x32_bf16 v[80:83], a[172:175], a[16:19], v[80:83]
  v_mfma_f32_16x16x32_bf16 v[84:87], a[172:175], a[20:23], v[84:87]
  ds_read_b64_tr_b16 a[186:187], v231 offset:33792
  v_mfma_f32_16x16x32_bf16 v[84:87], a[168:171], a[4:7], v[84:87]
  s_waitcnt vmcnt(5)
  v_mfma_f32_16x16x32_bf16 v[88:91], a[168:171], a[8:11], v[88:91]
  ds_read_b64_tr_b16 a[188:189], v231 offset:40960
  v_mfma_f32_16x16x32_bf16 v[88:91], a[172:175], a[24:27], v[88:91]
  s_barrier
  v_mfma_f32_16x16x32_bf16 v[92:95], a[172:175], a[28:31], v[92:95]
  ds_read_b64_tr_b16 a[190:191], v231 offset:41984
  v_mfma_f32_16x16x32_bf16 v[92:95], a[168:171], a[12:15], v[92:95]
  s_waitcnt lgkmcnt(4)
  v_mfma_f32_16x16x32_bf16 v[96:99], a[176:179], a[0:3], v[96:99]
  ds_read_b64_tr_b16 a[160:161], v224 offset:49152
  v_mfma_f32_16x16x32_bf16 v[96:99], a[180:183], a[16:19], v[96:99]
  v_mfma_f32_16x16x32_bf16 v[100:103], a[180:183], a[20:23], v[100:103]
  ds_read_b64_tr_b16 a[162:163], v224 offset:50176
  v_mfma_f32_16x16x32_bf16 v[100:103], a[176:179], a[4:7], v[100:103]
  v_mfma_f32_16x16x32_bf16 v[104:107], a[176:179], a[8:11], v[104:107]
  ds_read_b64_tr_b16 a[164:165], v224 offset:57344
  v_mfma_f32_16x16x32_bf16 v[104:107], a[180:183], a[24:27], v[104:107]
  v_mfma_f32_16x16x32_bf16 v[108:111], a[180:183], a[28:31], v[108:111]
  ds_read_b64_tr_b16 a[166:167], v224 offset:58368
  v_mfma_f32_16x16x32_bf16 v[108:111], a[176:179], a[12:15], v[108:111]
  s_waitcnt lgkmcnt(4)
  v_mfma_f32_16x16x32_bf16 v[112:115], a[184:187], a[0:3], v[112:115]
  ds_read_b64_tr_b16 a[168:169], v225 offset:49152
  v_mfma_f32_16x16x32_bf16 v[112:115], a[188:191], a[16:19], v[112:115]
  v_mfma_f32_16x16x32_bf16 v[116:119], a[188:191], a[20:23], v[116:119]
  ds_read_b64_tr_b16 a[170:171], v225 offset:50176
  v_mfma_f32_16x16x32_bf16 v[116:119], a[184:187], a[4:7], v[116:119]
  v_mfma_f32_16x16x32_bf16 v[120:123], a[184:187], a[8:11], v[120:123]
  ds_read_b64_tr_b16 a[172:173], v225 offset:57344
  v_mfma_f32_16x16x32_bf16 v[120:123], a[188:191], a[24:27], v[120:123]
  v_mfma_f32_16x16x32_bf16 v[124:127], a[188:191], a[28:31], v[124:127]
  ds_read_b64_tr_b16 a[174:175], v225 offset:58368
  v_mfma_f32_16x16x32_bf16 v[124:127], a[184:187], a[12:15], v[124:127]
  s_waitcnt lgkmcnt(4)
  v_mfma_f32_16x16x32_bf16 v[0:3], a[160:163], a[32:35], v[0:3]
  ds_read_b64_tr_b16 a[176:177], v226 offset:49152
  s_add_u32 m0, s28, 65536
  v_mfma_f32_16x16x32_bf16 v[0:3], a[164:167], a[48:51], v[0:3]
  buffer_load_dwordx4 v236, s[16:19], s29 offen offset:0 lds
  v_mfma_f32_16x16x32_bf16 v[4:7], a[164:167], a[52:55], v[4:7]
  ds_read_b64_tr_b16 a[178:179], v226 offset:50176
  v_mfma_f32_16x16x32_bf16 v[4:7], a[160:163], a[36:39], v[4:7]
  buffer_load_dwordx4 v237, s[16:19], s29 offen offset:1024 lds
  v_mfma_f32_16x16x32_bf16 v[8:11], a[160:163], a[40:43], v[8:11]
  ds_read_b64_tr_b16 a[180:181], v226 offset:57344
  v_mfma_f32_16x16x32_bf16 v[8:11], a[164:167], a[56:59], v[8:11]
  buffer_load_dwordx4 v236, s[16:19], s29 offen offset:2048 lds
  v_mfma_f32_16x16x32_bf16 v[12:15], a[164:167], a[60:63], v[12:15]
  ds_read_b64_tr_b16 a[182:183], v226 offset:58368
  v_mfma_f32_16x16x32_bf16 v[12:15], a[160:163], a[44:47], v[12:15]
  s_waitcnt lgkmcnt(4)
  v_mfma_f32_16x16x32_bf16 v[16:19], a[168:171], a[32:35], v[16:19]
  ds_read_b64_tr_b16 a[184:185], v227 offset:49152
  v_mfma_f32_16x16x32_bf16 v[16:19], a[172:175], a[48:51], v[16:19]
  buffer_load_dwordx4 v237, s[16:19], s29 offen offset:3072 lds
  v_mfma_f32_16x16x32_bf16 v[20:23], a[172:175], a[52:55], v[20:23]
  ds_read_b64_tr_b16 a[186:187], v227 offset:50176
  s_add_u32 s29, s29, 16384
  s_add_u32 m0, s28, 16384
  v_mfma_f32_16x16x32_bf16 v[20:23], a[168:171], a[36:39], v[20:23]
  buffer_load_dwordx4 v232, s[12:15], s29 offen offset:0 lds
  v_mfma_f32_16x16x32_bf16 v[24:27], a[168:171], a[40:43], v[24:27]
  ds_read_b64_tr_b16 a[188:189], v227 offset:57344
  v_mfma_f32_16x16x32_bf16 v[24:27], a[172:175], a[56:59], v[24:27]
  buffer_load_dwordx4 v233, s[12:15], s29 offen offset:1024 lds
  v_mfma_f32_16x16x32_bf16 v[28:31], a[172:175], a[60:63], v[28:31]
  ds_read_b64_tr_b16 a[190:191], v227 offset:58368
  v_mul_f32 v0, s34, v0
  v_mfma_f32_16x16x32_bf16 v[28:31], a[168:171], a[44:47], v[28:31]
  s_waitcnt lgkmcnt(4)
  v_mul_f32 v1, s34, v1
  v_mul_f32 v2, s34, v2
  v_mfma_f32_16x16x32_bf16 v[32:35], a[176:179], a[32:35], v[32:35]
  ds_read_b64_tr_b16 a[160:161], v228 offset:49152
  v_mul_f32 v3, s34, v3
  v_mfma_f32_16x16x32_bf16 v[32:35], a[180:183], a[48:51], v[32:35]
  buffer_load_dwordx4 v234, s[12:15], s29 offen offset:2048 lds
  v_mfma_f32_16x16x32_bf16 v[36:39], a[180:183], a[52:55], v[36:39]
  ds_read_b64_tr_b16 a[162:163], v228 offset:50176
  v_mul_f32 v16, s34, v16
  v_mfma_f32_16x16x32_bf16 v[36:39], a[176:179], a[36:39], v[36:39]
  buffer_load_dwordx4 v235, s[12:15], s29 offen offset:3072 lds
  v_mfma_f32_16x16x32_bf16 v[40:43], a[176:179], a[40:43], v[40:43]
  ds_read_b64_tr_b16 a[164:165], v228 offset:57344
  v_mul_f32 v17, s34, v17
  v_mfma_f32_16x16x32_bf16 v[40:43], a[180:183], a[56:59], v[40:43]
  v_mul_f32 v18, s34, v18
  v_mul_f32 v19, s34, v19
  v_mfma_f32_16x16x32_bf16 v[44:47], a[180:183], a[60:63], v[44:47]
  ds_read_b64_tr_b16 a[166:167], v228 offset:58368
  v_cvt_pk_bf16_f32 v128, v0, v1
  v_mfma_f32_16x16x32_bf16 v[44:47], a[176:179], a[44:47], v[44:47]
  s_waitcnt lgkmcnt(4)
  v_cvt_pk_bf16_f32 v129, v2, v3
  v_cvt_pk_bf16_f32 v130, v16, v17
  v_mfma_f32_16x16x32_bf16 v[48:51], a[184:187], a[32:35], v[48:51]
  ds_read_b64_tr_b16 a[168:169], v229 offset:49152
  v_cvt_pk_bf16_f32 v131, v18, v19
  v_mfma_f32_16x16x32_bf16 v[48:51], a[188:191], a[48:51], v[48:51]
  v_mul_f32 v4, s34, v4
  v_mul_f32 v5, s34, v5
  v_mfma_f32_16x16x32_bf16 v[52:55], a[188:191], a[52:55], v[52:55]
  ds_read_b64_tr_b16 a[170:171], v229 offset:50176
  v_mul_f32 v6, s34, v6
  v_mfma_f32_16x16x32_bf16 v[52:55], a[184:187], a[36:39], v[52:55]
  v_mul_f32 v7, s34, v7
  v_mul_f32 v20, s34, v20
  v_mfma_f32_16x16x32_bf16 v[56:59], a[184:187], a[40:43], v[56:59]
  ds_read_b64_tr_b16 a[172:173], v229 offset:57344
  v_mul_f32 v21, s34, v21
  v_mfma_f32_16x16x32_bf16 v[56:59], a[188:191], a[56:59], v[56:59]
  v_mul_f32 v22, s34, v22
  v_mul_f32 v23, s34, v23
  v_mfma_f32_16x16x32_bf16 v[60:63], a[188:191], a[60:63], v[60:63]
  ds_read_b64_tr_b16 a[174:175], v229 offset:58368
  v_cvt_pk_bf16_f32 v144, v4, v5
  v_mfma_f32_16x16x32_bf16 v[60:63], a[184:187], a[44:47], v[60:63]
  s_waitcnt lgkmcnt(4)
  v_cvt_pk_bf16_f32 v145, v6, v7
  v_cvt_pk_bf16_f32 v146, v20, v21
  v_mfma_f32_16x16x32_bf16 v[64:67], a[160:163], a[32:35], v[64:67]
  ds_read_b64_tr_b16 a[176:177], v230 offset:49152
  v_cvt_pk_bf16_f32 v147, v22, v23
  v_mfma_f32_16x16x32_bf16 v[64:67], a[164:167], a[48:51], v[64:67]
  v_permlane16_swap_b32 v128, v130
  v_permlane16_swap_b32 v129, v131
  v_mfma_f32_16x16x32_bf16 v[68:71], a[164:167], a[52:55], v[68:71]
  ds_read_b64_tr_b16 a[178:179], v230 offset:50176
  v_mul_f32 v8, s34, v8
  v_mfma_f32_16x16x32_bf16 v[68:71], a[160:163], a[36:39], v[68:71]
  v_mul_f32 v9, s34, v9
  v_mul_f32 v10, s34, v10
  v_mfma_f32_16x16x32_bf16 v[72:75], a[160:163], a[40:43], v[72:75]
  ds_read_b64_tr_b16 a[180:181], v230 offset:57344
  v_mul_f32 v11, s34, v11
  v_mfma_f32_16x16x32_bf16 v[72:75], a[164:167], a[56:59], v[72:75]
  v_mul_f32 v24, s34, v24
  v_mul_f32 v25, s34, v25
  v_mfma_f32_16x16x32_bf16 v[76:79], a[164:167], a[60:63], v[76:79]
  ds_read_b64_tr_b16 a[182:183], v230 offset:58368
  v_mul_f32 v26, s34, v26
  v_mfma_f32_16x16x32_bf16 v[76:79], a[160:163], a[44:47], v[76:79]
  s_waitcnt lgkmcnt(4)
  v_mul_f32 v27, s34, v27
  v_cvt_pk_bf16_f32 v160, v8, v9
  v_mfma_f32_16x16x32_bf16 v[80:83], a[168:171], a[32:35], v[80:83]
  ds_read_b64_tr_b16 a[184:185], v231 offset:49152
  v_cvt_pk_bf16_f32 v161, v10, v11
  v_mfma_f32_16x16x32_bf16 v[80:83], a[172:175], a[48:51], v[80:83]
  v_cvt_pk_bf16_f32 v162, v24, v25
  v_cvt_pk_bf16_f32 v163, v26, v27
  v_mfma_f32_16x16x32_bf16 v[84:87], a[172:175], a[52:55], v[84:87]
  ds_read_b64_tr_b16 a[186:187], v231 offset:50176
  v_permlane16_swap_b32 v144, v146
  v_mfma_f32_16x16x32_bf16 v[84:87], a[168:171], a[36:39], v[84:87]
  s_waitcnt vmcnt(9)
  v_permlane16_swap_b32 v145, v147
  v_mul_f32 v12, s34, v12
  v_mfma_f32_16x16x32_bf16 v[88:91], a[168:171], a[40:43], v[88:91]
  ds_read_b64_tr_b16 a[188:189], v231 offset:57344
  v_mul_f32 v13, s34, v13
  v_mfma_f32_16x16x32_bf16 v[88:91], a[172:175], a[56:59], v[88:91]
  s_barrier
  v_mul_f32 v14, s34, v14
  v_mul_f32 v15, s34, v15
  v_mfma_f32_16x16x32_bf16 v[92:95], a[172:175], a[60:63], v[92:95]
  ds_read_b64_tr_b16 a[190:191], v231 offset:58368
  v_mul_f32 v28, s34, v28
  v_mfma_f32_16x16x32_bf16 v[92:95], a[168:171], a[44:47], v[92:95]
  s_waitcnt lgkmcnt(4)
  v_mul_f32 v29, s34, v29
  v_mul_f32 v30, s34, v30
  v_mfma_f32_16x16x32_bf16 v[96:99], a[176:179], a[32:35], v[96:99]
  ds_read_b128 a[128:131], v212 offset:0
  v_mul_f32 v31, s34, v31
  v_mfma_f32_16x16x32_bf16 v[96:99], a[180:183], a[48:51], v[96:99]
  v_cvt_pk_bf16_f32 v176, v12, v13
  v_cvt_pk_bf16_f32 v177, v14, v15
  v_mfma_f32_16x16x32_bf16 v[100:103], a[180:183], a[52:55], v[100:103]
  ds_read_b128 a[132:135], v213 offset:0
  v_cvt_pk_bf16_f32 v178, v28, v29
  v_mfma_f32_16x16x32_bf16 v[100:103], a[176:179], a[36:39], v[100:103]
  v_cvt_pk_bf16_f32 v179, v30, v31
  v_permlane16_swap_b32 v160, v162
  v_mfma_f32_16x16x32_bf16 v[104:107], a[176:179], a[40:43], v[104:107]
  ds_read_b128 a[136:139], v214 offset:0
  v_permlane16_swap_b32 v161, v163
  v_mfma_f32_16x16x32_bf16 v[104:107], a[180:183], a[56:59], v[104:107]
  v_mul_f32 v32, s34, v32
  v_mul_f32 v33, s34, v33
  v_mfma_f32_16x16x32_bf16 v[108:111], a[180:183], a[60:63], v[108:111]
  ds_read_b128 a[140:143], v215 offset:0
  v_mul_f32 v34, s34, v34
  v_mfma_f32_16x16x32_bf16 v[108:111], a[176:179], a[44:47], v[108:111]
  s_waitcnt lgkmcnt(4)
  v_mul_f32 v35, s34, v35
  v_mul_f32 v48, s34, v48
  v_mfma_f32_16x16x32_bf16 v[112:115], a[184:187], a[32:35], v[112:115]
  v_mul_f32 v49, s34, v49
  v_mul_f32 v50, s34, v50
  v_mfma_f32_16x16x32_bf16 v[112:115], a[188:191], a[48:51], v[112:115]
  v_mul_f32 v51, s34, v51
  v_cvt_pk_bf16_f32 v132, v32, v33
  v_mfma_f32_16x16x32_bf16 v[116:119], a[188:191], a[52:55], v[116:119]
  v_cvt_pk_bf16_f32 v133, v34, v35
  v_cvt_pk_bf16_f32 v134, v48, v49
  v_mfma_f32_16x16x32_bf16 v[116:119], a[184:187], a[36:39], v[116:119]
  v_cvt_pk_bf16_f32 v135, v50, v51
  v_permlane16_swap_b32 v176, v178
  v_mfma_f32_16x16x32_bf16 v[120:123], a[184:187], a[40:43], v[120:123]
  v_permlane16_swap_b32 v177, v179
  v_mul_f32 v36, s34, v36
  v_mfma_f32_16x16x32_bf16 v[120:123], a[188:191], a[56:59], v[120:123]
  v_mul_f32 v37, s34, v37
  v_mul_f32 v38, s34, v38
  v_mfma_f32_16x16x32_bf16 v[124:127], a[188:191], a[60:63], v[124:127]
  v_mul_f32 v39, s34, v39
  v_mul_f32 v52, s34, v52
  v_mfma_f32_16x16x32_bf16 v[124:127], a[184:187], a[44:47], v[124:127]
  s_waitcnt lgkmcnt(0)
  v_mul_f32 v53, s34, v53
  v_mul_f32 v54, s34, v54
  v_mul_f32 v55, s34, v55
  v_cvt_pk_bf16_f32 v148, v36, v37
  v_cvt_pk_bf16_f32 v149, v38, v39
  v_cvt_pk_bf16_f32 v150, v52, v53
  v_cvt_pk_bf16_f32 v151, v54, v55
  v_permlane16_swap_b32 v132, v134
  v_permlane16_swap_b32 v133, v135
  v_pk_mul_f32 v[40:41], v[40:41], s[34:35] op_sel_hi:[1,0]
  v_pk_mul_f32 v[42:43], v[42:43], s[34:35] op_sel_hi:[1,0]
  v_pk_mul_f32 v[56:57], v[56:57], s[34:35] op_sel_hi:[1,0]
  v_pk_mul_f32 v[58:59], v[58:59], s[34:35] op_sel_hi:[1,0]
  v_cvt_pk_bf16_f32 v164, v40, v41
  v_cvt_pk_bf16_f32 v165, v42, v43
  v_cvt_pk_bf16_f32 v166, v56, v57
  v_cvt_pk_bf16_f32 v167, v58, v59
  v_permlane16_swap_b32 v148, v150
  v_permlane16_swap_b32 v149, v151
  v_pk_mul_f32 v[44:45], v[44:45], s[34:35] op_sel_hi:[1,0]
  v_pk_mul_f32 v[46:47], v[46:47], s[34:35] op_sel_hi:[1,0]
  v_pk_mul_f32 v[60:61], v[60:61], s[34:35] op_sel_hi:[1,0]
  v_pk_mul_f32 v[62:63], v[62:63], s[34:35] op_sel_hi:[1,0]
  v_cvt_pk_bf16_f32 v180, v44, v45
  v_cvt_pk_bf16_f32 v181, v46, v47
  v_cvt_pk_bf16_f32 v182, v60, v61
  v_cvt_pk_bf16_f32 v183, v62, v63
  v_permlane16_swap_b32 v164, v166
  v_permlane16_swap_b32 v165, v167
  v_pk_mul_f32 v[64:65], v[64:65], s[34:35] op_sel_hi:[1,0]
  v_pk_mul_f32 v[66:67], v[66:67], s[34:35] op_sel_hi:[1,0]
  v_pk_mul_f32 v[80:81], v[80:81], s[34:35] op_sel_hi:[1,0]
  v_pk_mul_f32 v[82:83], v[82:83], s[34:35] op_sel_hi:[1,0]
  v_cvt_pk_bf16_f32 v136, v64, v65
  v_cvt_pk_bf16_f32 v137, v66, v67
  v_cvt_pk_bf16_f32 v138, v80, v81
  v_cvt_pk_bf16_f32 v139, v82, v83
  v_permlane16_swap_b32 v180, v182
  v_permlane16_swap_b32 v181, v183
  v_pk_mul_f32 v[68:69], v[68:69], s[34:35] op_sel_hi:[1,0]
  v_pk_mul_f32 v[70:71], v[70:71], s[34:35] op_sel_hi:[1,0]
  v_pk_mul_f32 v[84:85], v[84:85], s[34:35] op_sel_hi:[1,0]
  v_pk_mul_f32 v[86:87], v[86:87], s[34:35] op_sel_hi:[1,0]
  v_cvt_pk_bf16_f32 v152, v68, v69
  v_cvt_pk_bf16_f32 v153, v70, v71
  v_cvt_pk_bf16_f32 v154, v84, v85
  v_cvt_pk_bf16_f32 v155, v86, v87
  v_permlane16_swap_b32 v136, v138
  v_permlane16_swap_b32 v137, v139
  v_pk_mul_f32 v[72:73], v[72:73], s[34:35] op_sel_hi:[1,0]
  v_pk_mul_f32 v[74:75], v[74:75], s[34:35] op_sel_hi:[1,0]
  v_pk_mul_f32 v[88:89], v[88:89], s[34:35] op_sel_hi:[1,0]
  v_pk_mul_f32 v[90:91], v[90:91], s[34:35] op_sel_hi:[1,0]
  v_cvt_pk_bf16_f32 v168, v72, v73
  v_cvt_pk_bf16_f32 v169, v74, v75
  v_cvt_pk_bf16_f32 v170, v88, v89
  v_cvt_pk_bf16_f32 v171, v90, v91
  v_permlane16_swap_b32 v152, v154
  v_permlane16_swap_b32 v153, v155
  v_pk_mul_f32 v[76:77], v[76:77], s[34:35] op_sel_hi:[1,0]
  v_pk_mul_f32 v[78:79], v[78:79], s[34:35] op_sel_hi:[1,0]
  v_pk_mul_f32 v[92:93], v[92:93], s[34:35] op_sel_hi:[1,0]
  v_pk_mul_f32 v[94:95], v[94:95], s[34:35] op_sel_hi:[1,0]
  v_cvt_pk_bf16_f32 v184, v76, v77
  v_cvt_pk_bf16_f32 v185, v78, v79
  v_cvt_pk_bf16_f32 v186, v92, v93
  v_cvt_pk_bf16_f32 v187, v94, v95
  v_permlane16_swap_b32 v168, v170
  v_permlane16_swap_b32 v169, v171
  v_pk_mul_f32 v[96:97], v[96:97], s[34:35] op_sel_hi:[1,0]
  v_pk_mul_f32 v[98:99], v[98:99], s[34:35] op_sel_hi:[1,0]
  v_pk_mul_f32 v[112:113], v[112:113], s[34:35] op_sel_hi:[1,0]
  v_pk_mul_f32 v[114:115], v[114:115], s[34:35] op_sel_hi:[1,0]
  v_cvt_pk_bf16_f32 v140, v96, v97
  v_cvt_pk_bf16_f32 v141, v98, v99
  v_cvt_pk_bf16_f32 v142, v112, v113
  v_cvt_pk_bf16_f32 v143, v114, v115
  v_permlane16_swap_b32 v184, v186
  v_permlane16_swap_b32 v185, v187
  v_pk_mul_f32 v[100:101], v[100:101], s[34:35] op_sel_hi:[1,0]
  v_pk_mul_f32 v[102:103], v[102:103], s[34:35] op_sel_hi:[1,0]
  v_pk_mul_f32 v[116:117], v[116:117], s[34:35] op_sel_hi:[1,0]
  v_pk_mul_f32 v[118:119], v[118:119], s[34:35] op_sel_hi:[1,0]
  v_cvt_pk_bf16_f32 v156, v100, v101
  v_cvt_pk_bf16_f32 v157, v102, v103
  v_cvt_pk_bf16_f32 v158, v116, v117
  v_cvt_pk_bf16_f32 v159, v118, v119
  v_permlane16_swap_b32 v140, v142
  v_permlane16_swap_b32 v141, v143
  v_pk_mul_f32 v[104:105], v[104:105], s[34:35] op_sel_hi:[1,0]
  v_pk_mul_f32 v[106:107], v[106:107], s[34:35] op_sel_hi:[1,0]
  v_pk_mul_f32 v[120:121], v[120:121], s[34:35] op_sel_hi:[1,0]
  v_pk_mul_f32 v[122:123], v[122:123], s[34:35] op_sel_hi:[1,0]
  v_cvt_pk_bf16_f32 v172, v104, v105
  v_cvt_pk_bf16_f32 v173, v106, v107
  v_cvt_pk_bf16_f32 v174, v120, v121
  v_cvt_pk_bf16_f32 v175, v122, v123
  v_permlane16_swap_b32 v156, v158
  v_permlane16_swap_b32 v157, v159
  v_pk_mul_f32 v[108:109], v[108:109], s[34:35] op_sel_hi:[1,0]
  v_pk_mul_f32 v[110:111], v[110:111], s[34:35] op_sel_hi:[1,0]
  v_pk_mul_f32 v[124:125], v[124:125], s[34:35] op_sel_hi:[1,0]
  v_pk_mul_f32 v[126:127], v[126:127], s[34:35] op_sel_hi:[1,0]
  v_cvt_pk_bf16_f32 v188, v108, v109
  v_cvt_pk_bf16_f32 v189, v110, v111
  v_cvt_pk_bf16_f32 v190, v124, v125
  v_cvt_pk_bf16_f32 v191, v126, v127
  v_permlane16_swap_b32 v172, v174
  v_permlane16_swap_b32 v173, v175
  v_permlane16_swap_b32 v188, v190
  v_permlane16_swap_b32 v189, v191
  v_mfma_f32_16x16x32_bf16 v[0:3], a[128:131], v[128:131], 0
  s_add_u32 m0, s28, 81920
  ds_read_b128 a[144:147], v212 offset:4096
  s_mov_b32 s20, s90
  s_mov_b32 s21, s91
  s_mov_b32 s22, 2211840
  s_mov_b32 s23, 0x20000
  s_mov_b32 s44, s92
  s_mov_b32 s45, s93
  s_mov_b32 s46, 2211840
  s_mov_b32 s47, 0x20000
  v_lshrrev_b32 v226, 4, v242
  v_mfma_f32_16x16x32_bf16 v[0:3], a[132:135], v[132:135], v[0:3]
  buffer_load_dwordx4 v236, s[16:19], s29 offen offset:0 lds
  v_mfma_f32_16x16x32_bf16 v[0:3], a[136:139], v[136:139], v[0:3]
  ds_read_b128 a[148:151], v213 offset:4096
  v_mul_u32_u24 v226, 0xd80, v226
  v_mfma_f32_16x16x32_bf16 v[0:3], a[140:143], v[140:143], v[0:3]
  buffer_load_dwordx4 v237, s[16:19], s29 offen offset:1024 lds
  s_mul_i32 s35, s3, 552960
  s_lshl_b32 s38, s33, 4
  s_add_u32 s35, s35, s38
  v_mfma_f32_16x16x32_bf16 v[8:11], a[140:143], v[156:159], 0
  ds_read_b128 a[152:155], v214 offset:4096
  v_mfma_f32_16x16x32_bf16 v[8:11], a[136:139], v[152:155], v[8:11]
  buffer_load_dwordx4 v236, s[16:19], s29 offen offset:2048 lds
  v_mfma_f32_16x16x32_bf16 v[8:11], a[132:135], v[148:151], v[8:11]
  ds_read_b128 a[156:159], v215 offset:4096
  v_mfma_f32_16x16x32_bf16 v[8:11], a[128:131], v[144:147], v[8:11]
  buffer_load_dwordx4 v237, s[16:19], s29 offen offset:3072 lds
  v_mfma_f32_16x16x32_bf16 v[16:19], a[128:131], v[160:163], 0
  s_add_u32 s29, s29, 16384
  s_add_u32 m0, s28, 32768
  v_mfma_f32_16x16x32_bf16 v[16:19], a[132:135], v[164:167], v[16:19]
  buffer_load_dwordx4 v232, s[12:15], s29 offen offset:0 lds
  v_mfma_f32_16x16x32_bf16 v[16:19], a[136:139], v[168:171], v[16:19]
  buffer_load_dwordx4 v233, s[12:15], s29 offen offset:1024 lds
  v_mfma_f32_16x16x32_bf16 v[16:19], a[140:143], v[172:175], v[16:19]
  v_max3_f32 v192, v0, v1, v2
  v_max3_f32 v196, v8, v9, v10
  v_mfma_f32_16x16x32_bf16 v[24:27], a[140:143], v[188:191], 0
  v_max_f32 v192, v192, v3
  v_max_f32 v196, v196, v11
  v_mfma_f32_16x16x32_bf16 v[24:27], a[136:139], v[184:187], v[24:27]
  v_mov_b32 v245, v192
  v_mov_b32 v246, v196
  v_mfma_f32_16x16x32_bf16 v[24:27], a[132:135], v[180:183], v[24:27]
  v_permlane16_swap_b32 v192, v245
  v_permlane16_swap_b32 v196, v246
  v_mfma_f32_16x16x32_bf16 v[24:27], a[128:131], v[176:179], v[24:27]
  s_waitcnt lgkmcnt(0)
  v_max_f32 v192, v192, v245
  v_max_f32 v196, v196, v246
  v_mfma_f32_16x16x32_bf16 v[4:7], a[144:147], v[128:131], 0
  ds_read_b128 a[128:131], v212 offset:8192
  v_mov_b32 v245, v192
  v_mfma_f32_16x16x32_bf16 v[4:7], a[148:151], v[132:135], v[4:7]
  v_mov_b32 v246, v196
  v_permlane32_swap_b32 v192, v245
  v_mfma_f32_16x16x32_bf16 v[4:7], a[152:155], v[136:139], v[4:7]
  ds_read_b128 a[132:135], v213 offset:8192
  v_permlane32_swap_b32 v196, v246
  v_mfma_f32_16x16x32_bf16 v[4:7], a[156:159], v[140:143], v[4:7]
  v_max_f32 v192, v192, v245
  v_max_f32 v196, v196, v246
  v_mfma_f32_16x16x32_bf16 v[12:15], a[156:159], v[156:159], 0
  ds_read_b128 a[136:139], v214 offset:8192
  v_sub_f32 v193, 0, v192
  v_mfma_f32_16x16x32_bf16 v[12:15], a[152:155], v[152:155], v[12:15]
  v_sub_f32 v197, 0, v196
  v_sub_f32 v194, 0, v192
  v_mfma_f32_16x16x32_bf16 v[12:15], a[148:151], v[148:151], v[12:15]
  ds_read_b128 a[140:143], v215 offset:8192
  v_sub_f32 v198, 0, v196
  v_mfma_f32_16x16x32_bf16 v[12:15], a[144:147], v[144:147], v[12:15]
  v_sub_f32 v195, 0, v192
  v_sub_f32 v199, 0, v196
  v_mfma_f32_16x16x32_bf16 v[20:23], a[144:147], v[160:163], 0
  buffer_load_dwordx4 v234, s[12:15], s29 offen offset:2048 lds
  v_mfma_f32_16x16x32_bf16 v[20:23], a[148:151], v[164:167], v[20:23]
  v_sub_f32 v192, 0, v192
  v_sub_f32 v196, 0, v196
  v_mfma_f32_16x16x32_bf16 v[20:23], a[152:155], v[168:171], v[20:23]
  buffer_load_dwordx4 v235, s[12:15], s29 offen offset:3072 lds
  v_mfma_f32_16x16x32_bf16 v[20:23], a[156:159], v[172:175], v[20:23]
  v_max3_f32 v200, v16, v17, v18
  v_max3_f32 v204, v24, v25, v26
  v_mfma_f32_16x16x32_bf16 v[28:31], a[156:159], v[188:191], 0
  v_max_f32 v200, v200, v19
  v_max_f32 v204, v204, v27
  v_mfma_f32_16x16x32_bf16 v[28:31], a[152:155], v[184:187], v[28:31]
  v_mov_b32 v247, v200
  v_mov_b32 v248, v204
  v_mfma_f32_16x16x32_bf16 v[28:31], a[148:151], v[180:183], v[28:31]
  v_permlane16_swap_b32 v200, v247
  v_permlane16_swap_b32 v204, v248
  v_max_f32 v200, v200, v247
  v_max_f32 v204, v204, v248
  v_mov_b32 v247, v200
  v_mov_b32 v248, v204
  s_nop 0
  v_permlane32_swap_b32 v200, v247
  v_permlane32_swap_b32 v204, v248
  v_max_f32 v200, v200, v247
  v_max_f32 v204, v204, v248
  v_sub_f32 v201, 0, v200
  v_sub_f32 v205, 0, v204
  v_sub_f32 v202, 0, v200
  v_sub_f32 v206, 0, v204
  v_sub_f32 v203, 0, v200
  v_sub_f32 v207, 0, v204
  v_sub_f32 v200, 0, v200
  v_sub_f32 v204, 0, v204
  v_mfma_f32_16x16x32_bf16 v[28:31], a[144:147], v[176:179], v[28:31]
  s_waitcnt lgkmcnt(0)
  v_add_f32 v0, v192, v0
  v_add_f32 v1, v192, v1
  v_mfma_f32_16x16x32_bf16 v[32:35], a[128:131], v[128:131], v[192:195]
  ds_read_b128 a[144:147], v212 offset:12288
  v_add_f32 v2, v192, v2
  v_mfma_f32_16x16x32_bf16 v[32:35], a[132:135], v[132:135], v[32:35]
  v_add_f32 v3, v192, v3
  v_mfma_f32_16x16x32_bf16 v[32:35], a[136:139], v[136:139], v[32:35]
  ds_read_b128 a[148:151], v213 offset:12288
  v_mfma_f32_16x16x32_bf16 v[32:35], a[140:143], v[140:143], v[32:35]
  v_exp_f32 v0, v0
  v_mfma_f32_16x16x32_bf16 v[40:43], a[140:143], v[156:159], v[196:199]
  ds_read_b128 a[152:155], v214 offset:12288
  v_mfma_f32_16x16x32_bf16 v[40:43], a[136:139], v[152:155], v[40:43]
  v_exp_f32 v1, v1
  v_mfma_f32_16x16x32_bf16 v[40:43], a[132:135], v[148:151], v[40:43]
  ds_read_b128 a[156:159], v215 offset:12288
  v_mfma_f32_16x16x32_bf16 v[40:43], a[128:131], v[144:147], v[40:43]
  v_exp_f32 v2, v2
  v_mfma_f32_16x16x32_bf16 v[48:51], a[128:131], v[160:163], v[200:203]
  s_add_u32 m0, s50, 0
  v_cvt_pk_bf16_f32 v0, v0, v1
  v_mfma_f32_16x16x32_bf16 v[48:51], a[132:135], v[164:167], v[48:51]
  v_exp_f32 v3, v3
  v_mfma_f32_16x16x32_bf16 v[48:51], a[136:139], v[168:171], v[48:51]
  v_add_f32 v8, v196, v8
  v_add_f32 v9, v196, v9
  v_mfma_f32_16x16x32_bf16 v[48:51], a[140:143], v[172:175], v[48:51]
  v_add_f32 v10, v196, v10
  v_add_f32 v11, v196, v11
  v_mfma_f32_16x16x32_bf16 v[56:59], a[140:143], v[188:191], v[204:207]
  v_exp_f32 v8, v8
  v_mfma_f32_16x16x32_bf16 v[56:59], a[136:139], v[184:187], v[56:59]
  v_exp_f32 v9, v9
  buffer_load_dwordx4 v226, s[20:23], s35 offen lds
  v_mfma_f32_16x16x32_bf16 v[56:59], a[132:135], v[180:183], v[56:59]
  v_exp_f32 v10, v10
  v_mfma_f32_16x16x32_bf16 v[56:59], a[128:131], v[176:179], v[56:59]
  s_waitcnt lgkmcnt(0)
  v_cvt_pk_bf16_f32 v8, v8, v9
  v_mfma_f32_16x16x32_bf16 v[36:39], a[144:147], v[128:131], v[192:195]
  s_waitcnt vmcnt(9)
  v_exp_f32 v11, v11
  v_mfma_f32_16x16x32_bf16 v[36:39], a[148:151], v[132:135], v[36:39]
  s_barrier
  v_cvt_pk_bf16_f32 v1, v2, v3
  v_add_f32 v16, v200, v16
  v_mfma_f32_16x16x32_bf16 v[36:39], a[152:155], v[136:139], v[36:39]
  ds_read_b128 a[128:131], v212 offset:16384
  v_add_f32 v17, v200, v17
  v_mfma_f32_16x16x32_bf16 v[36:39], a[156:159], v[140:143], v[36:39]
  v_add_f32 v18, v200, v18
  v_add_f32 v19, v200, v19
  v_mfma_f32_16x16x32_bf16 v[44:47], a[156:159], v[156:159], v[196:199]
  ds_read_b128 a[132:135], v213 offset:16384
  v_mfma_f32_16x16x32_bf16 v[44:47], a[152:155], v[152:155], v[44:47]
  v_exp_f32 v16, v16
  v_mfma_f32_16x16x32_bf16 v[44:47], a[148:151], v[148:151], v[44:47]
  ds_read_b128 a[136:139], v214 offset:16384
  v_mfma_f32_16x16x32_bf16 v[44:47], a[144:147], v[144:147], v[44:47]
  v_exp_f32 v17, v17
  v_mfma_f32_16x16x32_bf16 v[52:55], a[144:147], v[160:163], v[200:203]
  ds_read_b128 a[140:143], v215 offset:16384
  v_mfma_f32_16x16x32_bf16 v[52:55], a[148:151], v[164:167], v[52:55]
  v_exp_f32 v18, v18
  v_mfma_f32_16x16x32_bf16 v[52:55], a[152:155], v[168:171], v[52:55]
  v_cvt_pk_bf16_f32 v16, v16, v17
  v_mfma_f32_16x16x32_bf16 v[52:55], a[156:159], v[172:175], v[52:55]
  v_exp_f32 v19, v19
  v_mfma_f32_16x16x32_bf16 v[60:63], a[156:159], v[188:191], v[204:207]
  v_cvt_pk_bf16_f32 v9, v10, v11
  v_add_f32 v24, v204, v24
  v_mfma_f32_16x16x32_bf16 v[60:63], a[152:155], v[184:187], v[60:63]
  v_add_f32 v25, v204, v25
  v_add_f32 v26, v204, v26
  v_mfma_f32_16x16x32_bf16 v[60:63], a[148:151], v[180:183], v[60:63]
  v_add_f32 v27, v204, v27
  v_mfma_f32_16x16x32_bf16 v[60:63], a[144:147], v[176:179], v[60:63]
  s_waitcnt lgkmcnt(0)
  v_exp_f32 v24, v24
  v_exp_f32 v25, v25
  v_exp_f32 v26, v26
  v_cvt_pk_bf16_f32 v24, v24, v25
  v_exp_f32 v27, v27
  v_cvt_pk_bf16_f32 v17, v18, v19
  v_add_f32 v4, v192, v4
  v_add_f32 v5, v192, v5
  v_add_f32 v6, v192, v6
  v_add_f32 v7, v192, v7
  v_exp_f32 v4, v4
  v_exp_f32 v5, v5
  v_exp_f32 v6, v6
  v_cvt_pk_bf16_f32 v2, v4, v5
  v_exp_f32 v7, v7
  v_cvt_pk_bf16_f32 v25, v26, v27
  v_add_f32 v12, v196, v12
  v_add_f32 v13, v196, v13
  v_add_f32 v14, v196, v14
  v_add_f32 v15, v196, v15
  v_exp_f32 v12, v12
  v_exp_f32 v13, v13
  v_exp_f32 v14, v14
  v_cvt_pk_bf16_f32 v10, v12, v13
  v_exp_f32 v15, v15
  v_cvt_pk_bf16_f32 v3, v6, v7
  v_add_f32 v20, v200, v20
  v_add_f32 v21, v200, v21
  v_add_f32 v22, v200, v22
  v_add_f32 v23, v200, v23
  v_exp_f32 v20, v20
  v_exp_f32 v21, v21
  v_exp_f32 v22, v22
  v_cvt_pk_bf16_f32 v18, v20, v21
  v_exp_f32 v23, v23
  v_cvt_pk_bf16_f32 v11, v14, v15
  v_add_f32 v28, v204, v28
  v_add_f32 v29, v204, v29
  v_add_f32 v30, v204, v30
  v_add_f32 v31, v204, v31
  v_exp_f32 v28, v28
  v_exp_f32 v29, v29
  v_exp_f32 v30, v30
  v_cvt_pk_bf16_f32 v26, v28, v29
  v_exp_f32 v31, v31
  v_cvt_pk_bf16_f32 v19, v22, v23
  v_exp_f32 v32, v32
  v_exp_f32 v33, v33
  v_exp_f32 v34, v34
  v_cvt_pk_bf16_f32 v32, v32, v33
  v_exp_f32 v35, v35
  v_cvt_pk_bf16_f32 v27, v30, v31
  v_exp_f32 v40, v40
  v_exp_f32 v41, v41
  v_exp_f32 v42, v42
  v_cvt_pk_bf16_f32 v40, v40, v41
  v_exp_f32 v43, v43
  v_cvt_pk_bf16_f32 v33, v34, v35
  v_exp_f32 v48, v48
  v_exp_f32 v49, v49
  v_exp_f32 v50, v50
  v_cvt_pk_bf16_f32 v48, v48, v49
  v_exp_f32 v51, v51
  v_cvt_pk_bf16_f32 v41, v42, v43
  v_exp_f32 v56, v56
  v_exp_f32 v57, v57
  v_exp_f32 v58, v58
  v_cvt_pk_bf16_f32 v56, v56, v57
  v_exp_f32 v59, v59
  v_cvt_pk_bf16_f32 v49, v50, v51
  v_exp_f32 v36, v36
  v_exp_f32 v37, v37
  v_exp_f32 v38, v38
  v_cvt_pk_bf16_f32 v34, v36, v37
  v_exp_f32 v39, v39
  v_cvt_pk_bf16_f32 v57, v58, v59
  v_exp_f32 v44, v44
  v_exp_f32 v45, v45
  v_exp_f32 v46, v46
  v_cvt_pk_bf16_f32 v42, v44, v45
  v_exp_f32 v47, v47
  v_cvt_pk_bf16_f32 v35, v38, v39
  v_exp_f32 v52, v52
  v_exp_f32 v53, v53
  v_exp_f32 v54, v54
  v_cvt_pk_bf16_f32 v50, v52, v53
  v_exp_f32 v55, v55
  v_cvt_pk_bf16_f32 v43, v46, v47
  v_exp_f32 v60, v60
  v_exp_f32 v61, v61
  v_exp_f32 v62, v62
  v_cvt_pk_bf16_f32 v58, v60, v61
  v_exp_f32 v63, v63
  v_cvt_pk_bf16_f32 v51, v54, v55
  v_cvt_pk_bf16_f32 v59, v62, v63
  v_mfma_f32_16x16x32_bf16 v[64:67], a[128:131], v[128:131], v[192:195]
  s_add_u32 m0, s28, 98304
  v_mfma_f32_16x16x32_bf16 v[64:67], a[132:135], v[132:135], v[64:67]
  ds_read_b128 a[144:147], v212 offset:20480
  v_mfma_f32_16x16x32_bf16 v[64:67], a[136:139], v[136:139], v[64:67]
  buffer_load_dwordx4 v236, s[16:19], s29 offen offset:0 lds
  v_mfma_f32_16x16x32_bf16 v[64:67], a[140:143], v[140:143], v[64:67]
  ds_read_b128 a[148:151], v213 offset:20480
  v_mfma_f32_16x16x32_bf16 v[72:75], a[140:143], v[156:159], v[196:199]
  buffer_load_dwordx4 v237, s[16:19], s29 offen offset:1024 lds
  v_mfma_f32_16x16x32_bf16 v[72:75], a[136:139], v[152:155], v[72:75]
  ds_read_b128 a[152:155], v214 offset:20480
  v_mfma_f32_16x16x32_bf16 v[72:75], a[132:135], v[148:151], v[72:75]
  buffer_load_dwordx4 v236, s[16:19], s29 offen offset:2048 lds
  v_mfma_f32_16x16x32_bf16 v[72:75], a[128:131], v[144:147], v[72:75]
  ds_read_b128 a[156:159], v215 offset:20480
  v_mfma_f32_16x16x32_bf16 v[80:83], a[128:131], v[160:163], v[200:203]
  v_exp_f32 v64, v64
  v_mfma_f32_16x16x32_bf16 v[80:83], a[132:135], v[164:167], v[80:83]
  buffer_load_dwordx4 v237, s[16:19], s29 offen offset:3072 lds
  v_mfma_f32_16x16x32_bf16 v[80:83], a[136:139], v[168:171], v[80:83]
  s_add_u32 s29, s29, 16384
  v_exp_f32 v65, v65
  v_mfma_f32_16x16x32_bf16 v[80:83], a[140:143], v[172:175], v[80:83]
  v_cvt_pk_bf16_f32 v64, v64, v65
  v_mfma_f32_16x16x32_bf16 v[88:91], a[140:143], v[188:191], v[204:207]
  s_add_u32 m0, s28, 49152
  v_exp_f32 v66, v66
  v_mfma_f32_16x16x32_bf16 v[88:91], a[136:139], v[184:187], v[88:91]
  buffer_load_dwordx4 v232, s[12:15], s29 offen offset:0 lds
  v_mfma_f32_16x16x32_bf16 v[88:91], a[132:135], v[180:183], v[88:91]
  s_waitcnt lgkmcnt(0)
  v_exp_f32 v67, v67
  v_mfma_f32_16x16x32_bf16 v[88:91], a[128:131], v[176:179], v[88:91]
  v_cvt_pk_bf16_f32 v65, v66, v67
  v_mfma_f32_16x16x32_bf16 v[68:71], a[144:147], v[128:131], v[192:195]
  v_exp_f32 v72, v72
  v_mfma_f32_16x16x32_bf16 v[68:71], a[148:151], v[132:135], v[68:71]
  ds_read_b128 a[128:131], v212 offset:24576
  v_mfma_f32_16x16x32_bf16 v[68:71], a[152:155], v[136:139], v[68:71]
  v_exp_f32 v73, v73
  v_mfma_f32_16x16x32_bf16 v[68:71], a[156:159], v[140:143], v[68:71]
  ds_read_b128 a[132:135], v213 offset:24576
  v_cvt_pk_bf16_f32 v72, v72, v73
  v_mfma_f32_16x16x32_bf16 v[76:79], a[156:159], v[156:159], v[196:199]
  v_exp_f32 v74, v74
  v_mfma_f32_16x16x32_bf16 v[76:79], a[152:155], v[152:155], v[76:79]
  ds_read_b128 a[136:139], v214 offset:24576
  v_mfma_f32_16x16x32_bf16 v[76:79], a[148:151], v[148:151], v[76:79]
  v_exp_f32 v75, v75
  v_mfma_f32_16x16x32_bf16 v[76:79], a[144:147], v[144:147], v[76:79]
  ds_read_b128 a[140:143], v215 offset:24576
  v_cvt_pk_bf16_f32 v73, v74, v75
  v_mfma_f32_16x16x32_bf16 v[84:87], a[144:147], v[160:163], v[200:203]
  v_exp_f32 v80, v80
  v_mfma_f32_16x16x32_bf16 v[84:87], a[148:151], v[164:167], v[84:87]
  buffer_load_dwordx4 v233, s[12:15], s29 offen offset:1024 lds
  v_mfma_f32_16x16x32_bf16 v[84:87], a[152:155], v[168:171], v[84:87]
  v_exp_f32 v81, v81
  v_mfma_f32_16x16x32_bf16 v[84:87], a[156:159], v[172:175], v[84:87]
  v_cvt_pk_bf16_f32 v80, v80, v81
  v_mfma_f32_16x16x32_bf16 v[92:95], a[156:159], v[188:191], v[204:207]
  v_exp_f32 v82, v82
  v_mfma_f32_16x16x32_bf16 v[92:95], a[152:155], v[184:187], v[92:95]
  buffer_load_dwordx4 v234, s[12:15], s29 offen offset:2048 lds
  v_mfma_f32_16x16x32_bf16 v[92:95], a[148:151], v[180:183], v[92:95]
  s_waitcnt lgkmcnt(0)
  v_exp_f32 v83, v83
  v_mfma_f32_16x16x32_bf16 v[92:95], a[144:147], v[176:179], v[92:95]
  v_cvt_pk_bf16_f32 v81, v82, v83
  v_mfma_f32_16x16x32_bf16 v[96:99], a[128:131], v[128:131], v[192:195]
  v_exp_f32 v88, v88
  v_mfma_f32_16x16x32_bf16 v[96:99], a[132:135], v[132:135], v[96:99]
  ds_read_b128 a[144:147], v212 offset:28672
  v_mfma_f32_16x16x32_bf16 v[96:99], a[136:139], v[136:139], v[96:99]
  v_exp_f32 v89, v89
  v_mfma_f32_16x16x32_bf16 v[96:99], a[140:143], v[140:143], v[96:99]
  ds_read_b128 a[148:151], v213 offset:28672
  v_cvt_pk_bf16_f32 v88, v88, v89
  v_mfma_f32_16x16x32_bf16 v[104:107], a[140:143], v[156:159], v[196:199]
  v_exp_f32 v90, v90
  v_mfma_f32_16x16x32_bf16 v[104:107], a[136:139], v[152:155], v[104:107]
  ds_read_b128 a[152:155], v214 offset:28672
  v_mfma_f32_16x16x32_bf16 v[104:107], a[132:135], v[148:151], v[104:107]
  v_exp_f32 v91, v91
  v_mfma_f32_16x16x32_bf16 v[104:107], a[128:131], v[144:147], v[104:107]
  ds_read_b128 a[156:159], v215 offset:28672
  v_cvt_pk_bf16_f32 v89, v90, v91
  v_mfma_f32_16x16x32_bf16 v[112:115], a[128:131], v[160:163], v[200:203]
  v_exp_f32 v68, v68
  v_mfma_f32_16x16x32_bf16 v[112:115], a[132:135], v[164:167], v[112:115]
  buffer_load_dwordx4 v235, s[12:15], s29 offen offset:3072 lds
  v_mfma_f32_16x16x32_bf16 v[112:115], a[136:139], v[168:171], v[112:115]
  v_exp_f32 v69, v69
  v_mfma_f32_16x16x32_bf16 v[112:115], a[140:143], v[172:175], v[112:115]
  v_cvt_pk_bf16_f32 v66, v68, v69
  v_mfma_f32_16x16x32_bf16 v[120:123], a[140:143], v[188:191], v[204:207]
  v_exp_f32 v70, v70
  v_mfma_f32_16x16x32_bf16 v[120:123], a[136:139], v[184:187], v[120:123]
  s_add_u32 m0, s50, 3072
  v_mfma_f32_16x16x32_bf16 v[120:123], a[132:135], v[180:183], v[120:123]
  s_waitcnt lgkmcnt(0)
  v_exp_f32 v71, v71
  v_mfma_f32_16x16x32_bf16 v[120:123], a[128:131], v[176:179], v[120:123]
  buffer_load_dwordx4 v226, s[44:47], s35 offen lds
  s_add_u32 s35, s35, 221184
  v_cvt_pk_bf16_f32 v67, v70, v71
  v_mfma_f32_16x16x32_bf16 v[100:103], a[144:147], v[128:131], v[192:195]
  v_exp_f32 v76, v76
  v_mfma_f32_16x16x32_bf16 v[100:103], a[148:151], v[132:135], v[100:103]
  ds_read_b64_tr_b16 a[160:161], v216 offset:0
  v_mfma_f32_16x16x32_bf16 v[100:103], a[152:155], v[136:139], v[100:103]
  v_exp_f32 v77, v77
  v_mfma_f32_16x16x32_bf16 v[100:103], a[156:159], v[140:143], v[100:103]
  ds_read_b64_tr_b16 a[162:163], v216 offset:4096
  v_cvt_pk_bf16_f32 v74, v76, v77
  v_mfma_f32_16x16x32_bf16 v[108:111], a[156:159], v[156:159], v[196:199]
  v_exp_f32 v78, v78
  v_mfma_f32_16x16x32_bf16 v[108:111], a[152:155], v[152:155], v[108:111]
  ds_read_b64_tr_b16 a[164:165], v216 offset:8192
  v_mfma_f32_16x16x32_bf16 v[108:111], a[148:151], v[148:151], v[108:111]
  v_exp_f32 v79, v79
  v_mfma_f32_16x16x32_bf16 v[108:111], a[144:147], v[144:147], v[108:111]
  ds_read_b64_tr_b16 a[166:167], v216 offset:12288
  v_cvt_pk_bf16_f32 v75, v78, v79
  v_mfma_f32_16x16x32_bf16 v[116:119], a[144:147], v[160:163], v[200:203]
  v_exp_f32 v84, v84
  v_mfma_f32_16x16x32_bf16 v[116:119], a[148:151], v[164:167], v[116:119]
  ds_read_b64_tr_b16 a[168:169], v217 offset:0
  v_mfma_f32_16x16x32_bf16 v[116:119], a[152:155], v[168:171], v[116:119]
  v_exp_f32 v85, v85
  v_mfma_f32_16x16x32_bf16 v[116:119], a[156:159], v[172:175], v[116:119]
  ds_read_b64_tr_b16 a[170:171], v217 offset:4096
  v_cvt_pk_bf16_f32 v82, v84, v85
  v_mfma_f32_16x16x32_bf16 v[124:127], a[156:159], v[188:191], v[204:207]
  v_exp_f32 v86, v86
  v_mfma_f32_16x16x32_bf16 v[124:127], a[152:155], v[184:187], v[124:127]
  ds_read_b64_tr_b16 a[172:173], v217 offset:8192
  v_mfma_f32_16x16x32_bf16 v[124:127], a[148:151], v[180:183], v[124:127]
  v_exp_f32 v87, v87
  v_mfma_f32_16x16x32_bf16 v[124:127], a[144:147], v[176:179], v[124:127]
  ds_read_b64_tr_b16 a[174:175], v217 offset:12288
  v_cvt_pk_bf16_f32 v83, v86, v87
  v_mfma_f32_16x16x32_bf16 a[192:195], a[208:211], v[0:3], 0
  v_exp_f32 v92, v92
  v_mfma_f32_16x16x32_bf16 a[192:195], a[208:211], v[32:35], a[192:195]
  ds_read_b64_tr_b16 a[176:177], v218 offset:0
  v_mfma_f32_16x16x32_bf16 a[196:199], a[208:211], v[8:11], 0
  v_exp_f32 v93, v93
  v_mfma_f32_16x16x32_bf16 a[196:199], a[208:211], v[40:43], a[196:199]
  ds_read_b64_tr_b16 a[178:179], v218 offset:4096
  v_cvt_pk_bf16_f32 v90, v92, v93
  v_mfma_f32_16x16x32_bf16 a[200:203], a[208:211], v[16:19], 0
  v_exp_f32 v94, v94
  v_mfma_f32_16x16x32_bf16 a[200:203], a[208:211], v[48:51], a[200:203]
  ds_read_b64_tr_b16 a[180:181], v218 offset:8192
  v_mfma_f32_16x16x32_bf16 a[204:207], a[208:211], v[24:27], 0
  s_waitcnt lgkmcnt(7)
  v_exp_f32 v95, v95
  v_mfma_f32_16x16x32_bf16 a[204:207], a[208:211], v[56:59], a[204:207]
  ds_read_b64_tr_b16 a[182:183], v218 offset:12288
  v_cvt_pk_bf16_f32 v91, v94, v95
  v_mfma_f32_16x16x32_bf16 a[0:3], a[160:163], v[0:3], 0
  v_exp_f32 v96, v96
  v_mfma_f32_16x16x32_bf16 a[0:3], a[164:167], v[32:35], a[0:3]
  ds_read_b64_tr_b16 a[184:185], v219 offset:0
  v_mfma_f32_16x16x32_bf16 a[4:7], a[164:167], v[40:43], 0
  v_exp_f32 v97, v97
  v_mfma_f32_16x16x32_bf16 a[4:7], a[160:163], v[8:11], a[4:7]
  ds_read_b64_tr_b16 a[186:187], v219 offset:4096
  v_cvt_pk_bf16_f32 v96, v96, v97
  v_mfma_f32_16x16x32_bf16 a[8:11], a[160:163], v[16:19], 0
  v_exp_f32 v98, v98
  v_mfma_f32_16x16x32_bf16 a[8:11], a[164:167], v[48:51], a[8:11]
  ds_read_b64_tr_b16 a[188:189], v219 offset:8192
  v_mfma_f32_16x16x32_bf16 a[12:15], a[164:167], v[56:59], 0
  s_waitcnt lgkmcnt(7)
  v_exp_f32 v99, v99
  v_mfma_f32_16x16x32_bf16 a[12:15], a[160:163], v[24:27], a[12:15]
  ds_read_b64_tr_b16 a[190:191], v219 offset:12288
  v_cvt_pk_bf16_f32 v97, v98, v99
  v_mfma_f32_16x16x32_bf16 a[16:19], a[168:171], v[0:3], 0
  v_exp_f32 v104, v104
  v_mfma_f32_16x16x32_bf16 a[16:19], a[172:175], v[32:35], a[16:19]
  ds_read_b64_tr_b16 a[160:161], v220 offset:0
  v_mfma_f32_16x16x32_bf16 a[20:23], a[172:175], v[40:43], 0
  v_exp_f32 v105, v105
  v_mfma_f32_16x16x32_bf16 a[20:23], a[168:171], v[8:11], a[20:23]
  ds_read_b64_tr_b16 a[162:163], v220 offset:4096
  v_cvt_pk_bf16_f32 v104, v104, v105
  v_mfma_f32_16x16x32_bf16 a[24:27], a[168:171], v[16:19], 0
  v_exp_f32 v106, v106
  v_mfma_f32_16x16x32_bf16 a[24:27], a[172:175], v[48:51], a[24:27]
  ds_read_b64_tr_b16 a[164:165], v220 offset:8192
  v_mfma_f32_16x16x32_bf16 a[28:31], a[172:175], v[56:59], 0
  s_waitcnt lgkmcnt(7)
  v_exp_f32 v107, v107
  v_mfma_f32_16x16x32_bf16 a[28:31], a[168:171], v[24:27], a[28:31]
  ds_read_b64_tr_b16 a[166:167], v220 offset:12288
  v_cvt_pk_bf16_f32 v105, v106, v107
  v_mfma_f32_16x16x32_bf16 a[32:35], a[176:179], v[0:3], 0
  v_exp_f32 v112, v112
  v_mfma_f32_16x16x32_bf16 a[32:35], a[180:183], v[32:35], a[32:35]
  ds_read_b64_tr_b16 a[168:169], v221 offset:0
  v_mfma_f32_16x16x32_bf16 a[36:39], a[180:183], v[40:43], 0
  v_exp_f32 v113, v113
  v_mfma_f32_16x16x32_bf16 a[36:39], a[176:179], v[8:11], a[36:39]
  ds_read_b64_tr_b16 a[170:171], v221 offset:4096
  v_cvt_pk_bf16_f32 v112, v112, v113
  v_mfma_f32_16x16x32_bf16 a[40:43], a[176:179], v[16:19], 0
  v_exp_f32 v114, v114
  v_mfma_f32_16x16x32_bf16 a[40:43], a[180:183], v[48:51], a[40:43]
  ds_read_b64_tr_b16 a[172:173], v221 offset:8192
  v_mfma_f32_16x16x32_bf16 a[44:47], a[180:183], v[56:59], 0
  s_waitcnt lgkmcnt(7)
  v_exp_f32 v115, v115
  v_mfma_f32_16x16x32_bf16 a[44:47], a[176:179], v[24:27], a[44:47]
  ds_read_b64_tr_b16 a[174:175], v221 offset:12288
  v_cvt_pk_bf16_f32 v113, v114, v115
  v_mfma_f32_16x16x32_bf16 a[48:51], a[184:187], v[0:3], 0
  v_exp_f32 v120, v120
  v_mfma_f32_16x16x32_bf16 a[48:51], a[188:191], v[32:35], a[48:51]
  ds_read_b64_tr_b16 a[176:177], v222 offset:0
  v_mfma_f32_16x16x32_bf16 a[52:55], a[188:191], v[40:43], 0
  v_exp_f32 v121, v121
  v_mfma_f32_16x16x32_bf16 a[52:55], a[184:187], v[8:11], a[52:55]
  ds_read_b64_tr_b16 a[178:179], v222 offset:4096
  v_cvt_pk_bf16_f32 v120, v120, v121
  v_mfma_f32_16x16x32_bf16 a[56:59], a[184:187], v[16:19], 0
  v_exp_f32 v122, v122
  v_mfma_f32_16x16x32_bf16 a[56:59], a[188:191], v[48:51], a[56:59]
  ds_read_b64_tr_b16 a[180:181], v222 offset:8192
  v_mfma_f32_16x16x32_bf16 a[60:63], a[188:191], v[56:59], 0
  s_waitcnt lgkmcnt(7)
  v_exp_f32 v123, v123
  v_mfma_f32_16x16x32_bf16 a[60:63], a[184:187], v[24:27], a[60:63]
  ds_read_b64_tr_b16 a[182:183], v222 offset:12288
  v_cvt_pk_bf16_f32 v121, v122, v123
  v_mfma_f32_16x16x32_bf16 a[64:67], a[160:163], v[0:3], 0
  v_exp_f32 v100, v100
  v_mfma_f32_16x16x32_bf16 a[64:67], a[164:167], v[32:35], a[64:67]
  ds_read_b64_tr_b16 a[184:185], v223 offset:0
  v_mfma_f32_16x16x32_bf16 a[68:71], a[164:167], v[40:43], 0
  v_exp_f32 v101, v101
  v_mfma_f32_16x16x32_bf16 a[68:71], a[160:163], v[8:11], a[68:71]
  ds_read_b64_tr_b16 a[186:187], v223 offset:4096
  v_cvt_pk_bf16_f32 v98, v100, v101
  v_mfma_f32_16x16x32_bf16 a[72:75], a[160:163], v[16:19], 0
  v_exp_f32 v102, v102
  v_mfma_f32_16x16x32_bf16 a[72:75], a[164:167], v[48:51], a[72:75]
  ds_read_b64_tr_b16 a[188:189], v223 offset:8192
  v_mfma_f32_16x16x32_bf16 a[76:79], a[164:167], v[56:59], 0
  s_waitcnt lgkmcnt(7)
  v_exp_f32 v103, v103
  v_mfma_f32_16x16x32_bf16 a[76:79], a[160:163], v[24:27], a[76:79]
  ds_read_b64_tr_b16 a[190:191], v223 offset:12288
  v_cvt_pk_bf16_f32 v99, v102, v103
  v_mfma_f32_16x16x32_bf16 a[80:83], a[168:171], v[0:3], 0
  s_waitcnt vmcnt(10)
  v_exp_f32 v108, v108
  v_mfma_f32_16x16x32_bf16 a[80:83], a[172:175], v[32:35], a[80:83]
  v_mfma_f32_16x16x32_bf16 a[84:87], a[172:175], v[40:43], 0
  s_barrier
  v_exp_f32 v109, v109
  v_mfma_f32_16x16x32_bf16 a[84:87], a[168:171], v[8:11], a[84:87]
  ds_read_b128 a[128:131], v212 offset:32768
  v_cvt_pk_bf16_f32 v106, v108, v109
  v_mfma_f32_16x16x32_bf16 a[88:91], a[168:171], v[16:19], 0
  v_exp_f32 v110, v110
  v_mfma_f32_16x16x32_bf16 a[88:91], a[172:175], v[48:51], a[88:91]
  ds_read_b128 a[132:135], v213 offset:32768
  v_mfma_f32_16x16x32_bf16 a[92:95], a[172:175], v[56:59], 0
  s_waitcnt lgkmcnt(6)
  v_exp_f32 v111, v111
  v_mfma_f32_16x16x32_bf16 a[92:95], a[168:171], v[24:27], a[92:95]
  ds_read_b128 a[136:139], v214 offset:32768
  v_cvt_pk_bf16_f32 v107, v110, v111
  v_mfma_f32_16x16x32_bf16 a[96:99], a[176:179], v[0:3], 0
  s_mul_i32 s38, s3, 20480
  v_exp_f32 v116, v116
  v_mfma_f32_16x16x32_bf16 a[96:99], a[180:183], v[32:35], a[96:99]
  ds_read_b128 a[140:143], v215 offset:32768
  buffer_load_dwordx4 a[212:215], v243, s[24:27], s38 offen sc1
  s_add_u32 s38, s38, 4096
  v_mfma_f32_16x16x32_bf16 a[100:103], a[180:183], v[40:43], 0
  v_exp_f32 v117, v117
  v_mfma_f32_16x16x32_bf16 a[100:103], a[176:179], v[8:11], a[100:103]
  v_cvt_pk_bf16_f32 v114, v116, v117
  v_mfma_f32_16x16x32_bf16 a[104:107], a[176:179], v[16:19], 0
  v_exp_f32 v118, v118
  v_mfma_f32_16x16x32_bf16 a[104:107], a[180:183], v[48:51], a[104:107]
  v_mfma_f32_16x16x32_bf16 a[108:111], a[180:183], v[56:59], 0
  s_waitcnt lgkmcnt(4)
  v_exp_f32 v119, v119
  v_mfma_f32_16x16x32_bf16 a[108:111], a[176:179], v[24:27], a[108:111]
  v_cvt_pk_bf16_f32 v115, v118, v119
  v_mfma_f32_16x16x32_bf16 a[112:115], a[184:187], v[0:3], 0
  v_exp_f32 v124, v124
  v_mfma_f32_16x16x32_bf16 a[112:115], a[188:191], v[32:35], a[112:115]
  v_mfma_f32_16x16x32_bf16 a[116:119], a[188:191], v[40:43], 0
  v_exp_f32 v125, v125
  v_mfma_f32_16x16x32_bf16 a[116:119], a[184:187], v[8:11], a[116:119]
  v_cvt_pk_bf16_f32 v122, v124, v125
  v_mfma_f32_16x16x32_bf16 a[120:123], a[184:187], v[16:19], 0
  v_exp_f32 v126, v126
  v_mfma_f32_16x16x32_bf16 a[120:123], a[188:191], v[48:51], a[120:123]
  v_mfma_f32_16x16x32_bf16 a[124:127], a[188:191], v[56:59], 0
  s_waitcnt lgkmcnt(0)
  v_exp_f32 v127, v127
  v_mfma_f32_16x16x32_bf16 a[124:127], a[184:187], v[24:27], a[124:127]
  v_cvt_pk_bf16_f32 v123, v126, v127
  v_mfma_f32_16x16x32_bf16 v[0:3], a[128:131], v[128:131], v[192:195]
  s_add_u32 m0, s28, 114688
  v_mfma_f32_16x16x32_bf16 v[0:3], a[132:135], v[132:135], v[0:3]
  ds_read_b128 a[144:147], v212 offset:36864
  v_mfma_f32_16x16x32_bf16 v[0:3], a[136:139], v[136:139], v[0:3]
  buffer_load_dwordx4 v236, s[16:19], s29 offen offset:0 lds
  v_mfma_f32_16x16x32_bf16 v[0:3], a[140:143], v[140:143], v[0:3]
  ds_read_b128 a[148:151], v213 offset:36864
  v_mfma_f32_16x16x32_bf16 v[8:11], a[140:143], v[156:159], v[196:199]
  buffer_load_dwordx4 v237, s[16:19], s29 offen offset:1024 lds
  v_mfma_f32_16x16x32_bf16 v[8:11], a[136:139], v[152:155], v[8:11]
  ds_read_b128 a[152:155], v214 offset:36864
  v_mfma_f32_16x16x32_bf16 v[8:11], a[132:135], v[148:151], v[8:11]
  buffer_load_dwordx4 v236, s[16:19], s29 offen offset:2048 lds
  v_mfma_f32_16x16x32_bf16 v[8:11], a[128:131], v[144:147], v[8:11]
  ds_read_b128 a[156:159], v215 offset:36864
  v_mfma_f32_16x16x32_bf16 v[16:19], a[128:131], v[160:163], v[200:203]
  v_exp_f32 v0, v0
  v_mfma_f32_16x16x32_bf16 v[16:19], a[132:135], v[164:167], v[16:19]
  buffer_load_dwordx4 v237, s[16:19], s29 offen offset:3072 lds
  v_mfma_f32_16x16x32_bf16 v[16:19], a[136:139], v[168:171], v[16:19]
  s_add_u32 s29, s29, 16384
  v_exp_f32 v1, v1
  v_mfma_f32_16x16x32_bf16 v[16:19], a[140:143], v[172:175], v[16:19]
  v_cvt_pk_bf16_f32 v0, v0, v1
  v_mfma_f32_16x16x32_bf16 v[24:27], a[140:143], v[188:191], v[204:207]
  s_add_u32 m0, s28, 0
  v_exp_f32 v2, v2
  v_mfma_f32_16x16x32_bf16 v[24:27], a[136:139], v[184:187], v[24:27]
  buffer_load_dwordx4 v232, s[12:15], s29 offen offset:0 lds
  v_mfma_f32_16x16x32_bf16 v[24:27], a[132:135], v[180:183], v[24:27]
  s_waitcnt lgkmcnt(0)
  v_exp_f32 v3, v3
  v_mfma_f32_16x16x32_bf16 v[24:27], a[128:131], v[176:179], v[24:27]
  v_cvt_pk_bf16_f32 v1, v2, v3
  v_mfma_f32_16x16x32_bf16 v[4:7], a[144:147], v[128:131], v[192:195]
  v_exp_f32 v8, v8
  v_mfma_f32_16x16x32_bf16 v[4:7], a[148:151], v[132:135], v[4:7]
  ds_read_b128 a[128:131], v212 offset:40960
  v_mfma_f32_16x16x32_bf16 v[4:7], a[152:155], v[136:139], v[4:7]
  v_exp_f32 v9, v9
  v_mfma_f32_16x16x32_bf16 v[4:7], a[156:159], v[140:143], v[4:7]
  ds_read_b128 a[132:135], v213 offset:40960
  v_cvt_pk_bf16_f32 v8, v8, v9
  v_mfma_f32_16x16x32_bf16 v[12:15], a[156:159], v[156:159], v[196:199]
  v_exp_f32 v10, v10
  v_mfma_f32_16x16x32_bf16 v[12:15], a[152:155], v[152:155], v[12:15]
  ds_read_b128 a[136:139], v214 offset:40960
  v_mfma_f32_16x16x32_bf16 v[12:15], a[148:151], v[148:151], v[12:15]
  v_exp_f32 v11, v11
  v_mfma_f32_16x16x32_bf16 v[12:15], a[144:147], v[144:147], v[12:15]
  ds_read_b128 a[140:143], v215 offset:40960
  v_cvt_pk_bf16_f32 v9, v10, v11
  v_mfma_f32_16x16x32_bf16 v[20:23], a[144:147], v[160:163], v[200:203]
  v_exp_f32 v16, v16
  v_mfma_f32_16x16x32_bf16 v[20:23], a[148:151], v[164:167], v[20:23]
  buffer_load_dwordx4 v233, s[12:15], s29 offen offset:1024 lds
  v_mfma_f32_16x16x32_bf16 v[20:23], a[152:155], v[168:171], v[20:23]
  v_exp_f32 v17, v17
  v_mfma_f32_16x16x32_bf16 v[20:23], a[156:159], v[172:175], v[20:23]
  v_cvt_pk_bf16_f32 v16, v16, v17
  v_mfma_f32_16x16x32_bf16 v[28:31], a[156:159], v[188:191], v[204:207]
  v_exp_f32 v18, v18
  v_mfma_f32_16x16x32_bf16 v[28:31], a[152:155], v[184:187], v[28:31]
  buffer_load_dwordx4 v234, s[12:15], s29 offen offset:2048 lds
  v_mfma_f32_16x16x32_bf16 v[28:31], a[148:151], v[180:183], v[28:31]
  s_waitcnt lgkmcnt(0)
  v_exp_f32 v19, v19
  v_mfma_f32_16x16x32_bf16 v[28:31], a[144:147], v[176:179], v[28:31]
  v_cvt_pk_bf16_f32 v17, v18, v19
  v_mfma_f32_16x16x32_bf16 v[32:35], a[128:131], v[128:131], v[192:195]
  v_exp_f32 v24, v24
  v_mfma_f32_16x16x32_bf16 v[32:35], a[132:135], v[132:135], v[32:35]
  ds_read_b128 a[144:147], v212 offset:45056
  v_mfma_f32_16x16x32_bf16 v[32:35], a[136:139], v[136:139], v[32:35]
  v_exp_f32 v25, v25
  v_mfma_f32_16x16x32_bf16 v[32:35], a[140:143], v[140:143], v[32:35]
  ds_read_b128 a[148:151], v213 offset:45056
  v_cvt_pk_bf16_f32 v24, v24, v25
  v_mfma_f32_16x16x32_bf16 v[40:43], a[140:143], v[156:159], v[196:199]
  v_exp_f32 v26, v26
  v_mfma_f32_16x16x32_bf16 v[40:43], a[136:139], v[152:155], v[40:43]
  ds_read_b128 a[152:155], v214 offset:45056
  v_mfma_f32_16x16x32_bf16 v[40:43], a[132:135], v[148:151], v[40:43]
  v_exp_f32 v27, v27
  v_mfma_f32_16x16x32_bf16 v[40:43], a[128:131], v[144:147], v[40:43]
  ds_read_b128 a[156:159], v215 offset:45056
  v_cvt_pk_bf16_f32 v25, v26, v27
  v_mfma_f32_16x16x32_bf16 v[48:51], a[128:131], v[160:163], v[200:203]
  v_exp_f32 v4, v4
  v_mfma_f32_16x16x32_bf16 v[48:51], a[132:135], v[164:167], v[48:51]
  buffer_load_dwordx4 v235, s[12:15], s29 offen offset:3072 lds
  v_mfma_f32_16x16x32_bf16 v[48:51], a[136:139], v[168:171], v[48:51]
  v_exp_f32 v5, v5
  v_mfma_f32_16x16x32_bf16 v[48:51], a[140:143], v[172:175], v[48:51]
  v_cvt_pk_bf16_f32 v2, v4, v5
  v_mfma_f32_16x16x32_bf16 v[56:59], a[140:143], v[188:191], v[204:207]
  v_exp_f32 v6, v6
  v_mfma_f32_16x16x32_bf16 v[56:59], a[136:139], v[184:187], v[56:59]
  s_add_u32 m0, s50, 1024
  v_mfma_f32_16x16x32_bf16 v[56:59], a[132:135], v[180:183], v[56:59]
  s_waitcnt lgkmcnt(0)
  v_exp_f32 v7, v7
  v_mfma_f32_16x16x32_bf16 v[56:59], a[128:131], v[176:179], v[56:59]
  buffer_load_dwordx4 v226, s[20:23], s35 offen lds
  v_cvt_pk_bf16_f32 v3, v6, v7
  v_mfma_f32_16x16x32_bf16 v[36:39], a[144:147], v[128:131], v[192:195]
  v_exp_f32 v12, v12
  v_mfma_f32_16x16x32_bf16 v[36:39], a[148:151], v[132:135], v[36:39]
  ds_read_b64_tr_b16 a[160:161], v216 offset:16384
  v_mfma_f32_16x16x32_bf16 v[36:39], a[152:155], v[136:139], v[36:39]
  v_exp_f32 v13, v13
  v_mfma_f32_16x16x32_bf16 v[36:39], a[156:159], v[140:143], v[36:39]
  ds_read_b64_tr_b16 a[162:163], v216 offset:20480
  v_cvt_pk_bf16_f32 v10, v12, v13
  v_mfma_f32_16x16x32_bf16 v[44:47], a[156:159], v[156:159], v[196:199]
  v_exp_f32 v14, v14
  v_mfma_f32_16x16x32_bf16 v[44:47], a[152:155], v[152:155], v[44:47]
  ds_read_b64_tr_b16 a[164:165], v216 offset:24576
  v_mfma_f32_16x16x32_bf16 v[44:47], a[148:151], v[148:151], v[44:47]
  v_exp_f32 v15, v15
  v_mfma_f32_16x16x32_bf16 v[44:47], a[144:147], v[144:147], v[44:47]
  ds_read_b64_tr_b16 a[166:167], v216 offset:28672
  v_cvt_pk_bf16_f32 v11, v14, v15
  v_mfma_f32_16x16x32_bf16 v[52:55], a[144:147], v[160:163], v[200:203]
  v_exp_f32 v20, v20
  v_mfma_f32_16x16x32_bf16 v[52:55], a[148:151], v[164:167], v[52:55]
  ds_read_b64_tr_b16 a[168:169], v217 offset:16384
  v_mfma_f32_16x16x32_bf16 v[52:55], a[152:155], v[168:171], v[52:55]
  v_exp_f32 v21, v21
  v_mfma_f32_16x16x32_bf16 v[52:55], a[156:159], v[172:175], v[52:55]
  ds_read_b64_tr_b16 a[170:171], v217 offset:20480
  v_cvt_pk_bf16_f32 v18, v20, v21
  v_mfma_f32_16x16x32_bf16 v[60:63], a[156:159], v[188:191], v[204:207]
  v_exp_f32 v22, v22
  v_mfma_f32_16x16x32_bf16 v[60:63], a[152:155], v[184:187], v[60:63]
  ds_read_b64_tr_b16 a[172:173], v217 offset:24576
  v_mfma_f32_16x16x32_bf16 v[60:63], a[148:151], v[180:183], v[60:63]
  v_exp_f32 v23, v23
  v_mfma_f32_16x16x32_bf16 v[60:63], a[144:147], v[176:179], v[60:63]
  ds_read_b64_tr_b16 a[174:175], v217 offset:28672
  v_cvt_pk_bf16_f32 v19, v22, v23
  v_mfma_f32_16x16x32_bf16 a[192:195], a[208:211], v[64:67], a[192:195]
  v_exp_f32 v28, v28
  v_mfma_f32_16x16x32_bf16 a[192:195], a[208:211], v[96:99], a[192:195]
  ds_read_b64_tr_b16 a[176:177], v218 offset:16384
  v_mfma_f32_16x16x32_bf16 a[196:199], a[208:211], v[72:75], a[196:199]
  v_exp_f32 v29, v29
  v_mfma_f32_16x16x32_bf16 a[196:199], a[208:211], v[104:107], a[196:199]
  ds_read_b64_tr_b16 a[178:179], v218 offset:20480
  v_cvt_pk_bf16_f32 v26, v28, v29
  v_mfma_f32_16x16x32_bf16 a[200:203], a[208:211], v[80:83], a[200:203]
  v_exp_f32 v30, v30
  v_mfma_f32_16x16x32_bf16 a[200:203], a[208:211], v[112:115], a[200:203]
  ds_read_b64_tr_b16 a[180:181], v218 offset:24576
  v_mfma_f32_16x16x32_bf16 a[204:207], a[208:211], v[88:91], a[204:207]
  s_waitcnt lgkmcnt(7)
  v_exp_f32 v31, v31
  v_mfma_f32_16x16x32_bf16 a[204:207], a[208:211], v[120:123], a[204:207]
  ds_read_b64_tr_b16 a[182:183], v218 offset:28672
  v_cvt_pk_bf16_f32 v27, v30, v31
  v_mfma_f32_16x16x32_bf16 a[0:3], a[160:163], v[64:67], a[0:3]
  v_exp_f32 v32, v32
  v_mfma_f32_16x16x32_bf16 a[0:3], a[164:167], v[96:99], a[0:3]
  ds_read_b64_tr_b16 a[184:185], v219 offset:16384
  v_mfma_f32_16x16x32_bf16 a[4:7], a[164:167], v[104:107], a[4:7]
  v_exp_f32 v33, v33
  v_mfma_f32_16x16x32_bf16 a[4:7], a[160:163], v[72:75], a[4:7]
  ds_read_b64_tr_b16 a[186:187], v219 offset:20480
  v_cvt_pk_bf16_f32 v32, v32, v33
  v_mfma_f32_16x16x32_bf16 a[8:11], a[160:163], v[80:83], a[8:11]
  v_exp_f32 v34, v34
  v_mfma_f32_16x16x32_bf16 a[8:11], a[164:167], v[112:115], a[8:11]
  ds_read_b64_tr_b16 a[188:189], v219 offset:24576
  v_mfma_f32_16x16x32_bf16 a[12:15], a[164:167], v[120:123], a[12:15]
  s_waitcnt lgkmcnt(7)
  v_exp_f32 v35, v35
  v_mfma_f32_16x16x32_bf16 a[12:15], a[160:163], v[88:91], a[12:15]
  ds_read_b64_tr_b16 a[190:191], v219 offset:28672
  v_cvt_pk_bf16_f32 v33, v34, v35
  v_mfma_f32_16x16x32_bf16 a[16:19], a[168:171], v[64:67], a[16:19]
  v_exp_f32 v40, v40
  v_mfma_f32_16x16x32_bf16 a[16:19], a[172:175], v[96:99], a[16:19]
  ds_read_b64_tr_b16 a[160:161], v220 offset:16384
  v_mfma_f32_16x16x32_bf16 a[20:23], a[172:175], v[104:107], a[20:23]
  v_exp_f32 v41, v41
  v_mfma_f32_16x16x32_bf16 a[20:23], a[168:171], v[72:75], a[20:23]
  ds_read_b64_tr_b16 a[162:163], v220 offset:20480
  v_cvt_pk_bf16_f32 v40, v40, v41
  v_mfma_f32_16x16x32_bf16 a[24:27], a[168:171], v[80:83], a[24:27]
  v_exp_f32 v42, v42
  v_mfma_f32_16x16x32_bf16 a[24:27], a[172:175], v[112:115], a[24:27]
  ds_read_b64_tr_b16 a[164:165], v220 offset:24576
  v_mfma_f32_16x16x32_bf16 a[28:31], a[172:175], v[120:123], a[28:31]
  s_waitcnt lgkmcnt(7)
  v_exp_f32 v43, v43
  v_mfma_f32_16x16x32_bf16 a[28:31], a[168:171], v[88:91], a[28:31]
  ds_read_b64_tr_b16 a[166:167], v220 offset:28672
  v_cvt_pk_bf16_f32 v41, v42, v43
  v_mfma_f32_16x16x32_bf16 a[32:35], a[176:179], v[64:67], a[32:35]
  v_exp_f32 v48, v48
  v_mfma_f32_16x16x32_bf16 a[32:35], a[180:183], v[96:99], a[32:35]
  ds_read_b64_tr_b16 a[168:169], v221 offset:16384
  v_mfma_f32_16x16x32_bf16 a[36:39], a[180:183], v[104:107], a[36:39]
  v_exp_f32 v49, v49
  v_mfma_f32_16x16x32_bf16 a[36:39], a[176:179], v[72:75], a[36:39]
  ds_read_b64_tr_b16 a[170:171], v221 offset:20480
  v_cvt_pk_bf16_f32 v48, v48, v49
  v_mfma_f32_16x16x32_bf16 a[40:43], a[176:179], v[80:83], a[40:43]
  v_exp_f32 v50, v50
  v_mfma_f32_16x16x32_bf16 a[40:43], a[180:183], v[112:115], a[40:43]
  ds_read_b64_tr_b16 a[172:173], v221 offset:24576
  v_mfma_f32_16x16x32_bf16 a[44:47], a[180:183], v[120:123], a[44:47]
  s_waitcnt lgkmcnt(7)
  v_exp_f32 v51, v51
  v_mfma_f32_16x16x32_bf16 a[44:47], a[176:179], v[88:91], a[44:47]
  ds_read_b64_tr_b16 a[174:175], v221 offset:28672
  v_cvt_pk_bf16_f32 v49, v50, v51
  v_mfma_f32_16x16x32_bf16 a[48:51], a[184:187], v[64:67], a[48:51]
  v_exp_f32 v56, v56
  v_mfma_f32_16x16x32_bf16 a[48:51], a[188:191], v[96:99], a[48:51]
  ds_read_b64_tr_b16 a[176:177], v222 offset:16384
  v_mfma_f32_16x16x32_bf16 a[52:55], a[188:191], v[104:107], a[52:55]
  v_exp_f32 v57, v57
  v_mfma_f32_16x16x32_bf16 a[52:55], a[184:187], v[72:75], a[52:55]
  ds_read_b64_tr_b16 a[178:179], v222 offset:20480
  v_cvt_pk_bf16_f32 v56, v56, v57
  v_mfma_f32_16x16x32_bf16 a[56:59], a[184:187], v[80:83], a[56:59]
  v_exp_f32 v58, v58
  v_mfma_f32_16x16x32_bf16 a[56:59], a[188:191], v[112:115], a[56:59]
  ds_read_b64_tr_b16 a[180:181], v222 offset:24576
  v_mfma_f32_16x16x32_bf16 a[60:63], a[188:191], v[120:123], a[60:63]
  s_waitcnt lgkmcnt(7)
  v_exp_f32 v59, v59
  v_mfma_f32_16x16x32_bf16 a[60:63], a[184:187], v[88:91], a[60:63]
  ds_read_b64_tr_b16 a[182:183], v222 offset:28672
  v_cvt_pk_bf16_f32 v57, v58, v59
  v_mfma_f32_16x16x32_bf16 a[64:67], a[160:163], v[64:67], a[64:67]
  v_exp_f32 v36, v36
  v_mfma_f32_16x16x32_bf16 a[64:67], a[164:167], v[96:99], a[64:67]
  ds_read_b64_tr_b16 a[184:185], v223 offset:16384
  v_mfma_f32_16x16x32_bf16 a[68:71], a[164:167], v[104:107], a[68:71]
  v_exp_f32 v37, v37
  v_mfma_f32_16x16x32_bf16 a[68:71], a[160:163], v[72:75], a[68:71]
  ds_read_b64_tr_b16 a[186:187], v223 offset:20480
  v_cvt_pk_bf16_f32 v34, v36, v37
  v_mfma_f32_16x16x32_bf16 a[72:75], a[160:163], v[80:83], a[72:75]
  v_exp_f32 v38, v38
  v_mfma_f32_16x16x32_bf16 a[72:75], a[164:167], v[112:115], a[72:75]
  ds_read_b64_tr_b16 a[188:189], v223 offset:24576
  v_mfma_f32_16x16x32_bf16 a[76:79], a[164:167], v[120:123], a[76:79]
  s_waitcnt lgkmcnt(7)
  v_exp_f32 v39, v39
  v_mfma_f32_16x16x32_bf16 a[76:79], a[160:163], v[88:91], a[76:79]
  ds_read_b64_tr_b16 a[190:191], v223 offset:28672
  v_cvt_pk_bf16_f32 v35, v38, v39
  v_mfma_f32_16x16x32_bf16 a[80:83], a[168:171], v[64:67], a[80:83]
  s_waitcnt vmcnt(11)
  v_exp_f32 v44, v44
  v_mfma_f32_16x16x32_bf16 a[80:83], a[172:175], v[96:99], a[80:83]
  v_mfma_f32_16x16x32_bf16 a[84:87], a[172:175], v[104:107], a[84:87]
  s_barrier
  v_exp_f32 v45, v45
  v_mfma_f32_16x16x32_bf16 a[84:87], a[168:171], v[72:75], a[84:87]
  ds_read_b128 a[128:131], v212 offset:49152
  v_cvt_pk_bf16_f32 v42, v44, v45
  v_mfma_f32_16x16x32_bf16 a[88:91], a[168:171], v[80:83], a[88:91]
  v_exp_f32 v46, v46
  v_mfma_f32_16x16x32_bf16 a[88:91], a[172:175], v[112:115], a[88:91]
  ds_read_b128 a[132:135], v213 offset:49152
  v_mfma_f32_16x16x32_bf16 a[92:95], a[172:175], v[120:123], a[92:95]
  s_waitcnt lgkmcnt(6)
  v_exp_f32 v47, v47
  v_mfma_f32_16x16x32_bf16 a[92:95], a[168:171], v[88:91], a[92:95]
  ds_read_b128 a[136:139], v214 offset:49152
  v_cvt_pk_bf16_f32 v43, v46, v47
  v_mfma_f32_16x16x32_bf16 a[96:99], a[176:179], v[64:67], a[96:99]
  v_exp_f32 v52, v52
  v_mfma_f32_16x16x32_bf16 a[96:99], a[180:183], v[96:99], a[96:99]
  ds_read_b128 a[140:143], v215 offset:49152
  buffer_load_dwordx4 a[216:219], v243, s[24:27], s38 offen sc1
  s_add_u32 s38, s38, 4096
  v_mfma_f32_16x16x32_bf16 a[100:103], a[180:183], v[104:107], a[100:103]
  v_exp_f32 v53, v53
  v_mfma_f32_16x16x32_bf16 a[100:103], a[176:179], v[72:75], a[100:103]
  v_cvt_pk_bf16_f32 v50, v52, v53
  v_mfma_f32_16x16x32_bf16 a[104:107], a[176:179], v[80:83], a[104:107]
  v_exp_f32 v54, v54
  v_mfma_f32_16x16x32_bf16 a[104:107], a[180:183], v[112:115], a[104:107]
  v_mfma_f32_16x16x32_bf16 a[108:111], a[180:183], v[120:123], a[108:111]
  s_waitcnt lgkmcnt(4)
  v_exp_f32 v55, v55
  v_mfma_f32_16x16x32_bf16 a[108:111], a[176:179], v[88:91], a[108:111]
  v_cvt_pk_bf16_f32 v51, v54, v55
  v_mfma_f32_16x16x32_bf16 a[112:115], a[184:187], v[64:67], a[112:115]
  v_exp_f32 v60, v60
  v_mfma_f32_16x16x32_bf16 a[112:115], a[188:191], v[96:99], a[112:115]
  v_mfma_f32_16x16x32_bf16 a[116:119], a[188:191], v[104:107], a[116:119]
  v_exp_f32 v61, v61
  v_mfma_f32_16x16x32_bf16 a[116:119], a[184:187], v[72:75], a[116:119]
  v_cvt_pk_bf16_f32 v58, v60, v61
  v_mfma_f32_16x16x32_bf16 a[120:123], a[184:187], v[80:83], a[120:123]
  v_exp_f32 v62, v62
  v_mfma_f32_16x16x32_bf16 a[120:123], a[188:191], v[112:115], a[120:123]
  v_mfma_f32_16x16x32_bf16 a[124:127], a[188:191], v[120:123], a[124:127]
  s_waitcnt lgkmcnt(0)
  v_exp_f32 v63, v63
  v_mfma_f32_16x16x32_bf16 a[124:127], a[184:187], v[88:91], a[124:127]
  v_cvt_pk_bf16_f32 v59, v62, v63
  v_mfma_f32_16x16x32_bf16 v[64:67], a[128:131], v[128:131], v[192:195]
  s_add_u32 m0, s28, 65536
  v_mfma_f32_16x16x32_bf16 v[64:67], a[132:135], v[132:135], v[64:67]
  ds_read_b128 a[144:147], v212 offset:53248
  v_mfma_f32_16x16x32_bf16 v[64:67], a[136:139], v[136:139], v[64:67]
  buffer_load_dwordx4 v236, s[16:19], s29 offen offset:0 lds
  v_mfma_f32_16x16x32_bf16 v[64:67], a[140:143], v[140:143], v[64:67]
  ds_read_b128 a[148:151], v213 offset:53248
  v_mfma_f32_16x16x32_bf16 v[72:75], a[140:143], v[156:159], v[196:199]
  buffer_load_dwordx4 v237, s[16:19], s29 offen offset:1024 lds
  v_mfma_f32_16x16x32_bf16 v[72:75], a[136:139], v[152:155], v[72:75]
  ds_read_b128 a[152:155], v214 offset:53248
  v_mfma_f32_16x16x32_bf16 v[72:75], a[132:135], v[148:151], v[72:75]
  buffer_load_dwordx4 v236, s[16:19], s29 offen offset:2048 lds
  v_mfma_f32_16x16x32_bf16 v[72:75], a[128:131], v[144:147], v[72:75]
  ds_read_b128 a[156:159], v215 offset:53248
  v_mfma_f32_16x16x32_bf16 v[80:83], a[128:131], v[160:163], v[200:203]
  v_exp_f32 v64, v64
  v_mfma_f32_16x16x32_bf16 v[80:83], a[132:135], v[164:167], v[80:83]
  buffer_load_dwordx4 v237, s[16:19], s29 offen offset:3072 lds
  v_mfma_f32_16x16x32_bf16 v[80:83], a[136:139], v[168:171], v[80:83]
  s_add_u32 s29, s29, 16384
  v_exp_f32 v65, v65
  v_mfma_f32_16x16x32_bf16 v[80:83], a[140:143], v[172:175], v[80:83]
  v_cvt_pk_bf16_f32 v64, v64, v65
  v_mfma_f32_16x16x32_bf16 v[88:91], a[140:143], v[188:191], v[204:207]
  s_add_u32 m0, s28, 16384
  v_exp_f32 v66, v66
  v_mfma_f32_16x16x32_bf16 v[88:91], a[136:139], v[184:187], v[88:91]
  buffer_load_dwordx4 v232, s[12:15], s29 offen offset:0 lds
  v_mfma_f32_16x16x32_bf16 v[88:91], a[132:135], v[180:183], v[88:91]
  s_waitcnt lgkmcnt(0)
  v_exp_f32 v67, v67
  v_mfma_f32_16x16x32_bf16 v[88:91], a[128:131], v[176:179], v[88:91]
  v_cvt_pk_bf16_f32 v65, v66, v67
  v_mfma_f32_16x16x32_bf16 v[68:71], a[144:147], v[128:131], v[192:195]
  v_exp_f32 v72, v72
  v_mfma_f32_16x16x32_bf16 v[68:71], a[148:151], v[132:135], v[68:71]
  ds_read_b128 a[128:131], v212 offset:57344
  v_mfma_f32_16x16x32_bf16 v[68:71], a[152:155], v[136:139], v[68:71]
  v_exp_f32 v73, v73
  v_mfma_f32_16x16x32_bf16 v[68:71], a[156:159], v[140:143], v[68:71]
  ds_read_b128 a[132:135], v213 offset:57344
  v_cvt_pk_bf16_f32 v72, v72, v73
  v_mfma_f32_16x16x32_bf16 v[76:79], a[156:159], v[156:159], v[196:199]
  v_exp_f32 v74, v74
  v_mfma_f32_16x16x32_bf16 v[76:79], a[152:155], v[152:155], v[76:79]
  ds_read_b128 a[136:139], v214 offset:57344
  v_mfma_f32_16x16x32_bf16 v[76:79], a[148:151], v[148:151], v[76:79]
  v_exp_f32 v75, v75
  v_mfma_f32_16x16x32_bf16 v[76:79], a[144:147], v[144:147], v[76:79]
  ds_read_b128 a[140:143], v215 offset:57344
  v_cvt_pk_bf16_f32 v73, v74, v75
  v_mfma_f32_16x16x32_bf16 v[84:87], a[144:147], v[160:163], v[200:203]
  v_exp_f32 v80, v80
  v_mfma_f32_16x16x32_bf16 v[84:87], a[148:151], v[164:167], v[84:87]
  buffer_load_dwordx4 v233, s[12:15], s29 offen offset:1024 lds
  v_mfma_f32_16x16x32_bf16 v[84:87], a[152:155], v[168:171], v[84:87]
  v_exp_f32 v81, v81
  v_mfma_f32_16x16x32_bf16 v[84:87], a[156:159], v[172:175], v[84:87]
  v_cvt_pk_bf16_f32 v80, v80, v81
  v_mfma_f32_16x16x32_bf16 v[92:95], a[156:159], v[188:191], v[204:207]
  v_exp_f32 v82, v82
  v_mfma_f32_16x16x32_bf16 v[92:95], a[152:155], v[184:187], v[92:95]
  buffer_load_dwordx4 v234, s[12:15], s29 offen offset:2048 lds
  v_mfma_f32_16x16x32_bf16 v[92:95], a[148:151], v[180:183], v[92:95]
  s_waitcnt lgkmcnt(0)
  v_exp_f32 v83, v83
  v_mfma_f32_16x16x32_bf16 v[92:95], a[144:147], v[176:179], v[92:95]
  v_cvt_pk_bf16_f32 v81, v82, v83
  v_mfma_f32_16x16x32_bf16 v[96:99], a[128:131], v[128:131], v[192:195]
  v_exp_f32 v88, v88
  v_mfma_f32_16x16x32_bf16 v[96:99], a[132:135], v[132:135], v[96:99]
  ds_read_b128 a[144:147], v212 offset:61440
  v_mfma_f32_16x16x32_bf16 v[96:99], a[136:139], v[136:139], v[96:99]
  v_exp_f32 v89, v89
  v_mfma_f32_16x16x32_bf16 v[96:99], a[140:143], v[140:143], v[96:99]
  ds_read_b128 a[148:151], v213 offset:61440
  v_cvt_pk_bf16_f32 v88, v88, v89
  v_mfma_f32_16x16x32_bf16 v[104:107], a[140:143], v[156:159], v[196:199]
  v_exp_f32 v90, v90
  v_mfma_f32_16x16x32_bf16 v[104:107], a[136:139], v[152:155], v[104:107]
  ds_read_b128 a[152:155], v214 offset:61440
  v_mfma_f32_16x16x32_bf16 v[104:107], a[132:135], v[148:151], v[104:107]
  v_exp_f32 v91, v91
  v_mfma_f32_16x16x32_bf16 v[104:107], a[128:131], v[144:147], v[104:107]
  ds_read_b128 a[156:159], v215 offset:61440
  v_cvt_pk_bf16_f32 v89, v90, v91
  v_mfma_f32_16x16x32_bf16 v[112:115], a[128:131], v[160:163], v[200:203]
  v_exp_f32 v68, v68
  v_mfma_f32_16x16x32_bf16 v[112:115], a[132:135], v[164:167], v[112:115]
  buffer_load_dwordx4 v235, s[12:15], s29 offen offset:3072 lds
  v_mfma_f32_16x16x32_bf16 v[112:115], a[136:139], v[168:171], v[112:115]
  v_exp_f32 v69, v69
  v_mfma_f32_16x16x32_bf16 v[112:115], a[140:143], v[172:175], v[112:115]
  v_cvt_pk_bf16_f32 v66, v68, v69
  v_mfma_f32_16x16x32_bf16 v[120:123], a[140:143], v[188:191], v[204:207]
  v_exp_f32 v70, v70
  v_mfma_f32_16x16x32_bf16 v[120:123], a[136:139], v[184:187], v[120:123]
  s_add_u32 m0, s50, 4096
  v_mfma_f32_16x16x32_bf16 v[120:123], a[132:135], v[180:183], v[120:123]
  s_waitcnt lgkmcnt(0)
  v_exp_f32 v71, v71
  v_mfma_f32_16x16x32_bf16 v[120:123], a[128:131], v[176:179], v[120:123]
  buffer_load_dwordx4 v226, s[44:47], s35 offen lds
  s_add_u32 s35, s35, 221184
  v_cvt_pk_bf16_f32 v67, v70, v71
  v_mfma_f32_16x16x32_bf16 v[100:103], a[144:147], v[128:131], v[192:195]
  v_exp_f32 v76, v76
  v_mfma_f32_16x16x32_bf16 v[100:103], a[148:151], v[132:135], v[100:103]
  ds_read_b64_tr_b16 a[160:161], v216 offset:32768
  v_mfma_f32_16x16x32_bf16 v[100:103], a[152:155], v[136:139], v[100:103]
  v_exp_f32 v77, v77
  v_mfma_f32_16x16x32_bf16 v[100:103], a[156:159], v[140:143], v[100:103]
  ds_read_b64_tr_b16 a[162:163], v216 offset:36864
  v_cvt_pk_bf16_f32 v74, v76, v77
  v_mfma_f32_16x16x32_bf16 v[108:111], a[156:159], v[156:159], v[196:199]
  v_exp_f32 v78, v78
  v_mfma_f32_16x16x32_bf16 v[108:111], a[152:155], v[152:155], v[108:111]
  ds_read_b64_tr_b16 a[164:165], v216 offset:40960
  v_mfma_f32_16x16x32_bf16 v[108:111], a[148:151], v[148:151], v[108:111]
  v_exp_f32 v79, v79
  v_mfma_f32_16x16x32_bf16 v[108:111], a[144:147], v[144:147], v[108:111]
  ds_read_b64_tr_b16 a[166:167], v216 offset:45056
  v_cvt_pk_bf16_f32 v75, v78, v79
  v_mfma_f32_16x16x32_bf16 v[116:119], a[144:147], v[160:163], v[200:203]
  v_exp_f32 v84, v84
  v_mfma_f32_16x16x32_bf16 v[116:119], a[148:151], v[164:167], v[116:119]
  ds_read_b64_tr_b16 a[168:169], v217 offset:32768
  v_mfma_f32_16x16x32_bf16 v[116:119], a[152:155], v[168:171], v[116:119]
  v_exp_f32 v85, v85
  v_mfma_f32_16x16x32_bf16 v[116:119], a[156:159], v[172:175], v[116:119]
  ds_read_b64_tr_b16 a[170:171], v217 offset:36864
  v_cvt_pk_bf16_f32 v82, v84, v85
  v_mfma_f32_16x16x32_bf16 v[124:127], a[156:159], v[188:191], v[204:207]
  v_exp_f32 v86, v86
  v_mfma_f32_16x16x32_bf16 v[124:127], a[152:155], v[184:187], v[124:127]
  ds_read_b64_tr_b16 a[172:173], v217 offset:40960
  v_mfma_f32_16x16x32_bf16 v[124:127], a[148:151], v[180:183], v[124:127]
  v_exp_f32 v87, v87
  v_mfma_f32_16x16x32_bf16 v[124:127], a[144:147], v[176:179], v[124:127]
  ds_read_b64_tr_b16 a[174:175], v217 offset:45056
  v_cvt_pk_bf16_f32 v83, v86, v87
  v_mfma_f32_16x16x32_bf16 a[192:195], a[208:211], v[0:3], a[192:195]
  v_exp_f32 v92, v92
  v_mfma_f32_16x16x32_bf16 a[192:195], a[208:211], v[32:35], a[192:195]
  ds_read_b64_tr_b16 a[176:177], v218 offset:32768
  v_mfma_f32_16x16x32_bf16 a[196:199], a[208:211], v[8:11], a[196:199]
  v_exp_f32 v93, v93
  v_mfma_f32_16x16x32_bf16 a[196:199], a[208:211], v[40:43], a[196:199]
  ds_read_b64_tr_b16 a[178:179], v218 offset:36864
  v_cvt_pk_bf16_f32 v90, v92, v93
  v_mfma_f32_16x16x32_bf16 a[200:203], a[208:211], v[16:19], a[200:203]
  v_exp_f32 v94, v94
  v_mfma_f32_16x16x32_bf16 a[200:203], a[208:211], v[48:51], a[200:203]
  ds_read_b64_tr_b16 a[180:181], v218 offset:40960
  v_mfma_f32_16x16x32_bf16 a[204:207], a[208:211], v[24:27], a[204:207]
  s_waitcnt lgkmcnt(7)
  v_exp_f32 v95, v95
  v_mfma_f32_16x16x32_bf16 a[204:207], a[208:211], v[56:59], a[204:207]
  ds_read_b64_tr_b16 a[182:183], v218 offset:45056
  v_cvt_pk_bf16_f32 v91, v94, v95
  v_mfma_f32_16x16x32_bf16 a[0:3], a[160:163], v[0:3], a[0:3]
  v_exp_f32 v96, v96
  v_mfma_f32_16x16x32_bf16 a[0:3], a[164:167], v[32:35], a[0:3]
  ds_read_b64_tr_b16 a[184:185], v219 offset:32768
  v_mfma_f32_16x16x32_bf16 a[4:7], a[164:167], v[40:43], a[4:7]
  v_exp_f32 v97, v97
  v_mfma_f32_16x16x32_bf16 a[4:7], a[160:163], v[8:11], a[4:7]
  ds_read_b64_tr_b16 a[186:187], v219 offset:36864
  v_cvt_pk_bf16_f32 v96, v96, v97
  v_mfma_f32_16x16x32_bf16 a[8:11], a[160:163], v[16:19], a[8:11]
  v_exp_f32 v98, v98
  v_mfma_f32_16x16x32_bf16 a[8:11], a[164:167], v[48:51], a[8:11]
  ds_read_b64_tr_b16 a[188:189], v219 offset:40960
  v_mfma_f32_16x16x32_bf16 a[12:15], a[164:167], v[56:59], a[12:15]
  s_waitcnt lgkmcnt(7)
  v_exp_f32 v99, v99
  v_mfma_f32_16x16x32_bf16 a[12:15], a[160:163], v[24:27], a[12:15]
  ds_read_b64_tr_b16 a[190:191], v219 offset:45056
  v_cvt_pk_bf16_f32 v97, v98, v99
  v_mfma_f32_16x16x32_bf16 a[16:19], a[168:171], v[0:3], a[16:19]
  v_exp_f32 v104, v104
  v_mfma_f32_16x16x32_bf16 a[16:19], a[172:175], v[32:35], a[16:19]
  ds_read_b64_tr_b16 a[160:161], v220 offset:32768
  v_mfma_f32_16x16x32_bf16 a[20:23], a[172:175], v[40:43], a[20:23]
  v_exp_f32 v105, v105
  v_mfma_f32_16x16x32_bf16 a[20:23], a[168:171], v[8:11], a[20:23]
  ds_read_b64_tr_b16 a[162:163], v220 offset:36864
  v_cvt_pk_bf16_f32 v104, v104, v105
  v_mfma_f32_16x16x32_bf16 a[24:27], a[168:171], v[16:19], a[24:27]
  v_exp_f32 v106, v106
  v_mfma_f32_16x16x32_bf16 a[24:27], a[172:175], v[48:51], a[24:27]
  ds_read_b64_tr_b16 a[164:165], v220 offset:40960
  v_mfma_f32_16x16x32_bf16 a[28:31], a[172:175], v[56:59], a[28:31]
  s_waitcnt lgkmcnt(7)
  v_exp_f32 v107, v107
  v_mfma_f32_16x16x32_bf16 a[28:31], a[168:171], v[24:27], a[28:31]
  ds_read_b64_tr_b16 a[166:167], v220 offset:45056
  v_cvt_pk_bf16_f32 v105, v106, v107
  v_mfma_f32_16x16x32_bf16 a[32:35], a[176:179], v[0:3], a[32:35]
  v_exp_f32 v112, v112
  v_mfma_f32_16x16x32_bf16 a[32:35], a[180:183], v[32:35], a[32:35]
  ds_read_b64_tr_b16 a[168:169], v221 offset:32768
  v_mfma_f32_16x16x32_bf16 a[36:39], a[180:183], v[40:43], a[36:39]
  v_exp_f32 v113, v113
  v_mfma_f32_16x16x32_bf16 a[36:39], a[176:179], v[8:11], a[36:39]
  ds_read_b64_tr_b16 a[170:171], v221 offset:36864
  v_cvt_pk_bf16_f32 v112, v112, v113
  v_mfma_f32_16x16x32_bf16 a[40:43], a[176:179], v[16:19], a[40:43]
  v_exp_f32 v114, v114
  v_mfma_f32_16x16x32_bf16 a[40:43], a[180:183], v[48:51], a[40:43]
  ds_read_b64_tr_b16 a[172:173], v221 offset:40960
  v_mfma_f32_16x16x32_bf16 a[44:47], a[180:183], v[56:59], a[44:47]
  s_waitcnt lgkmcnt(7)
  v_exp_f32 v115, v115
  v_mfma_f32_16x16x32_bf16 a[44:47], a[176:179], v[24:27], a[44:47]
  ds_read_b64_tr_b16 a[174:175], v221 offset:45056
  v_cvt_pk_bf16_f32 v113, v114, v115
  v_mfma_f32_16x16x32_bf16 a[48:51], a[184:187], v[0:3], a[48:51]
  v_exp_f32 v120, v120
  v_mfma_f32_16x16x32_bf16 a[48:51], a[188:191], v[32:35], a[48:51]
  ds_read_b64_tr_b16 a[176:177], v222 offset:32768
  v_mfma_f32_16x16x32_bf16 a[52:55], a[188:191], v[40:43], a[52:55]
  v_exp_f32 v121, v121
  v_mfma_f32_16x16x32_bf16 a[52:55], a[184:187], v[8:11], a[52:55]
  ds_read_b64_tr_b16 a[178:179], v222 offset:36864
  v_cvt_pk_bf16_f32 v120, v120, v121
  v_mfma_f32_16x16x32_bf16 a[56:59], a[184:187], v[16:19], a[56:59]
  v_exp_f32 v122, v122
  v_mfma_f32_16x16x32_bf16 a[56:59], a[188:191], v[48:51], a[56:59]
  ds_read_b64_tr_b16 a[180:181], v222 offset:40960
  v_mfma_f32_16x16x32_bf16 a[60:63], a[188:191], v[56:59], a[60:63]
  s_waitcnt lgkmcnt(7)
  v_exp_f32 v123, v123
  v_mfma_f32_16x16x32_bf16 a[60:63], a[184:187], v[24:27], a[60:63]
  ds_read_b64_tr_b16 a[182:183], v222 offset:45056
  v_cvt_pk_bf16_f32 v121, v122, v123
  v_mfma_f32_16x16x32_bf16 a[64:67], a[160:163], v[0:3], a[64:67]
  v_exp_f32 v100, v100
  v_mfma_f32_16x16x32_bf16 a[64:67], a[164:167], v[32:35], a[64:67]
  ds_read_b64_tr_b16 a[184:185], v223 offset:32768
  v_mfma_f32_16x16x32_bf16 a[68:71], a[164:167], v[40:43], a[68:71]
  v_exp_f32 v101, v101
  v_mfma_f32_16x16x32_bf16 a[68:71], a[160:163], v[8:11], a[68:71]
  ds_read_b64_tr_b16 a[186:187], v223 offset:36864
  v_cvt_pk_bf16_f32 v98, v100, v101
  v_mfma_f32_16x16x32_bf16 a[72:75], a[160:163], v[16:19], a[72:75]
  v_exp_f32 v102, v102
  v_mfma_f32_16x16x32_bf16 a[72:75], a[164:167], v[48:51], a[72:75]
  ds_read_b64_tr_b16 a[188:189], v223 offset:40960
  v_mfma_f32_16x16x32_bf16 a[76:79], a[164:167], v[56:59], a[76:79]
  s_waitcnt lgkmcnt(7)
  v_exp_f32 v103, v103
  v_mfma_f32_16x16x32_bf16 a[76:79], a[160:163], v[24:27], a[76:79]
  ds_read_b64_tr_b16 a[190:191], v223 offset:45056
  v_cvt_pk_bf16_f32 v99, v102, v103
  v_mfma_f32_16x16x32_bf16 a[80:83], a[168:171], v[0:3], a[80:83]
  s_waitcnt vmcnt(11)
  v_exp_f32 v108, v108
  v_mfma_f32_16x16x32_bf16 a[80:83], a[172:175], v[32:35], a[80:83]
  v_mfma_f32_16x16x32_bf16 a[84:87], a[172:175], v[40:43], a[84:87]
  s_barrier
  v_exp_f32 v109, v109
  v_mfma_f32_16x16x32_bf16 a[84:87], a[168:171], v[8:11], a[84:87]
  ds_read_b128 a[128:131], v212 offset:0
  v_cvt_pk_bf16_f32 v106, v108, v109
  v_mfma_f32_16x16x32_bf16 a[88:91], a[168:171], v[16:19], a[88:91]
  v_exp_f32 v110, v110
  v_mfma_f32_16x16x32_bf16 a[88:91], a[172:175], v[48:51], a[88:91]
  ds_read_b128 a[132:135], v213 offset:0
  v_mfma_f32_16x16x32_bf16 a[92:95], a[172:175], v[56:59], a[92:95]
  s_waitcnt lgkmcnt(6)
  v_exp_f32 v111, v111
  v_mfma_f32_16x16x32_bf16 a[92:95], a[168:171], v[24:27], a[92:95]
  ds_read_b128 a[136:139], v214 offset:0
  v_cvt_pk_bf16_f32 v107, v110, v111
  v_mfma_f32_16x16x32_bf16 a[96:99], a[176:179], v[0:3], a[96:99]
  v_exp_f32 v116, v116
  v_mfma_f32_16x16x32_bf16 a[96:99], a[180:183], v[32:35], a[96:99]
  ds_read_b128 a[140:143], v215 offset:0
  buffer_load_dwordx4 a[220:223], v243, s[24:27], s38 offen sc1
  s_add_u32 s38, s38, 4096
  v_mfma_f32_16x16x32_bf16 a[100:103], a[180:183], v[40:43], a[100:103]
  v_exp_f32 v117, v117
  v_mfma_f32_16x16x32_bf16 a[100:103], a[176:179], v[8:11], a[100:103]
  v_cvt_pk_bf16_f32 v114, v116, v117
  v_mfma_f32_16x16x32_bf16 a[104:107], a[176:179], v[16:19], a[104:107]
  v_exp_f32 v118, v118
  v_mfma_f32_16x16x32_bf16 a[104:107], a[180:183], v[48:51], a[104:107]
  v_mfma_f32_16x16x32_bf16 a[108:111], a[180:183], v[56:59], a[108:111]
  s_waitcnt lgkmcnt(4)
  v_exp_f32 v119, v119
  v_mfma_f32_16x16x32_bf16 a[108:111], a[176:179], v[24:27], a[108:111]
  v_cvt_pk_bf16_f32 v115, v118, v119
  v_mfma_f32_16x16x32_bf16 a[112:115], a[184:187], v[0:3], a[112:115]
  v_exp_f32 v124, v124
  v_mfma_f32_16x16x32_bf16 a[112:115], a[188:191], v[32:35], a[112:115]
  v_mfma_f32_16x16x32_bf16 a[116:119], a[188:191], v[40:43], a[116:119]
  v_exp_f32 v125, v125
  v_mfma_f32_16x16x32_bf16 a[116:119], a[184:187], v[8:11], a[116:119]
  v_cvt_pk_bf16_f32 v122, v124, v125
  v_mfma_f32_16x16x32_bf16 a[120:123], a[184:187], v[16:19], a[120:123]
  v_exp_f32 v126, v126
  v_mfma_f32_16x16x32_bf16 a[120:123], a[188:191], v[48:51], a[120:123]
  v_mfma_f32_16x16x32_bf16 a[124:127], a[188:191], v[56:59], a[124:127]
  s_waitcnt lgkmcnt(0)
  v_exp_f32 v127, v127
  v_mfma_f32_16x16x32_bf16 a[124:127], a[184:187], v[24:27], a[124:127]
  v_cvt_pk_bf16_f32 v123, v126, v127
  v_mfma_f32_16x16x32_bf16 v[0:3], a[128:131], v[128:131], v[192:195]
  s_add_u32 m0, s28, 81920
  v_mfma_f32_16x16x32_bf16 v[0:3], a[132:135], v[132:135], v[0:3]
  ds_read_b128 a[144:147], v212 offset:4096
  v_mfma_f32_16x16x32_bf16 v[0:3], a[136:139], v[136:139], v[0:3]
  buffer_load_dwordx4 v236, s[16:19], s29 offen offset:0 lds
  v_mfma_f32_16x16x32_bf16 v[0:3], a[140:143], v[140:143], v[0:3]
  ds_read_b128 a[148:151], v213 offset:4096
  v_mfma_f32_16x16x32_bf16 v[8:11], a[140:143], v[156:159], v[196:199]
  buffer_load_dwordx4 v237, s[16:19], s29 offen offset:1024 lds
  v_mfma_f32_16x16x32_bf16 v[8:11], a[136:139], v[152:155], v[8:11]
  ds_read_b128 a[152:155], v214 offset:4096
  v_mfma_f32_16x16x32_bf16 v[8:11], a[132:135], v[148:151], v[8:11]
  buffer_load_dwordx4 v236, s[16:19], s29 offen offset:2048 lds
  v_mfma_f32_16x16x32_bf16 v[8:11], a[128:131], v[144:147], v[8:11]
  ds_read_b128 a[156:159], v215 offset:4096
  v_mfma_f32_16x16x32_bf16 v[16:19], a[128:131], v[160:163], v[200:203]
  v_exp_f32 v0, v0
  v_mfma_f32_16x16x32_bf16 v[16:19], a[132:135], v[164:167], v[16:19]
  buffer_load_dwordx4 v237, s[16:19], s29 offen offset:3072 lds
  v_mfma_f32_16x16x32_bf16 v[16:19], a[136:139], v[168:171], v[16:19]
  s_add_u32 s29, s29, 16384
  v_exp_f32 v1, v1
  v_mfma_f32_16x16x32_bf16 v[16:19], a[140:143], v[172:175], v[16:19]
  v_cvt_pk_bf16_f32 v0, v0, v1
  v_mfma_f32_16x16x32_bf16 v[24:27], a[140:143], v[188:191], v[204:207]
  s_add_u32 m0, s28, 32768
  v_exp_f32 v2, v2
  v_mfma_f32_16x16x32_bf16 v[24:27], a[136:139], v[184:187], v[24:27]
  buffer_load_dwordx4 v232, s[12:15], s29 offen offset:0 lds
  v_mfma_f32_16x16x32_bf16 v[24:27], a[132:135], v[180:183], v[24:27]
  s_waitcnt lgkmcnt(0)
  v_exp_f32 v3, v3
  v_mfma_f32_16x16x32_bf16 v[24:27], a[128:131], v[176:179], v[24:27]
  v_cvt_pk_bf16_f32 v1, v2, v3
  v_mfma_f32_16x16x32_bf16 v[4:7], a[144:147], v[128:131], v[192:195]
  v_exp_f32 v8, v8
  v_mfma_f32_16x16x32_bf16 v[4:7], a[148:151], v[132:135], v[4:7]
  ds_read_b128 a[128:131], v212 offset:8192
  v_mfma_f32_16x16x32_bf16 v[4:7], a[152:155], v[136:139], v[4:7]
  v_exp_f32 v9, v9
  v_mfma_f32_16x16x32_bf16 v[4:7], a[156:159], v[140:143], v[4:7]
  ds_read_b128 a[132:135], v213 offset:8192
  v_cvt_pk_bf16_f32 v8, v8, v9
  v_mfma_f32_16x16x32_bf16 v[12:15], a[156:159], v[156:159], v[196:199]
  v_exp_f32 v10, v10
  v_mfma_f32_16x16x32_bf16 v[12:15], a[152:155], v[152:155], v[12:15]
  ds_read_b128 a[136:139], v214 offset:8192
  v_mfma_f32_16x16x32_bf16 v[12:15], a[148:151], v[148:151], v[12:15]
  v_exp_f32 v11, v11
  v_mfma_f32_16x16x32_bf16 v[12:15], a[144:147], v[144:147], v[12:15]
  ds_read_b128 a[140:143], v215 offset:8192
  v_cvt_pk_bf16_f32 v9, v10, v11
  v_mfma_f32_16x16x32_bf16 v[20:23], a[144:147], v[160:163], v[200:203]
  v_exp_f32 v16, v16
  v_mfma_f32_16x16x32_bf16 v[20:23], a[148:151], v[164:167], v[20:23]
  buffer_load_dwordx4 v233, s[12:15], s29 offen offset:1024 lds
  v_mfma_f32_16x16x32_bf16 v[20:23], a[152:155], v[168:171], v[20:23]
  v_exp_f32 v17, v17
  v_mfma_f32_16x16x32_bf16 v[20:23], a[156:159], v[172:175], v[20:23]
  v_cvt_pk_bf16_f32 v16, v16, v17
  v_mfma_f32_16x16x32_bf16 v[28:31], a[156:159], v[188:191], v[204:207]
  v_exp_f32 v18, v18
  v_mfma_f32_16x16x32_bf16 v[28:31], a[152:155], v[184:187], v[28:31]
  buffer_load_dwordx4 v234, s[12:15], s29 offen offset:2048 lds
  v_mfma_f32_16x16x32_bf16 v[28:31], a[148:151], v[180:183], v[28:31]
  s_waitcnt lgkmcnt(0)
  v_exp_f32 v19, v19
  v_mfma_f32_16x16x32_bf16 v[28:31], a[144:147], v[176:179], v[28:31]
  v_cvt_pk_bf16_f32 v17, v18, v19
  v_mfma_f32_16x16x32_bf16 v[32:35], a[128:131], v[128:131], v[192:195]
  v_exp_f32 v24, v24
  v_mfma_f32_16x16x32_bf16 v[32:35], a[132:135], v[132:135], v[32:35]
  ds_read_b128 a[144:147], v212 offset:12288
  v_mfma_f32_16x16x32_bf16 v[32:35], a[136:139], v[136:139], v[32:35]
  v_exp_f32 v25, v25
  v_mfma_f32_16x16x32_bf16 v[32:35], a[140:143], v[140:143], v[32:35]
  ds_read_b128 a[148:151], v213 offset:12288
  v_cvt_pk_bf16_f32 v24, v24, v25
  v_mfma_f32_16x16x32_bf16 v[40:43], a[140:143], v[156:159], v[196:199]
  v_exp_f32 v26, v26
  v_mfma_f32_16x16x32_bf16 v[40:43], a[136:139], v[152:155], v[40:43]
  ds_read_b128 a[152:155], v214 offset:12288
  v_mfma_f32_16x16x32_bf16 v[40:43], a[132:135], v[148:151], v[40:43]
  v_exp_f32 v27, v27
  v_mfma_f32_16x16x32_bf16 v[40:43], a[128:131], v[144:147], v[40:43]
  ds_read_b128 a[156:159], v215 offset:12288
  v_cvt_pk_bf16_f32 v25, v26, v27
  v_mfma_f32_16x16x32_bf16 v[48:51], a[128:131], v[160:163], v[200:203]
  v_exp_f32 v4, v4
  v_mfma_f32_16x16x32_bf16 v[48:51], a[132:135], v[164:167], v[48:51]
  buffer_load_dwordx4 v235, s[12:15], s29 offen offset:3072 lds
  v_mfma_f32_16x16x32_bf16 v[48:51], a[136:139], v[168:171], v[48:51]
  v_exp_f32 v5, v5
  v_mfma_f32_16x16x32_bf16 v[48:51], a[140:143], v[172:175], v[48:51]
  v_cvt_pk_bf16_f32 v2, v4, v5
  v_mfma_f32_16x16x32_bf16 v[56:59], a[140:143], v[188:191], v[204:207]
  v_exp_f32 v6, v6
  v_mfma_f32_16x16x32_bf16 v[56:59], a[136:139], v[184:187], v[56:59]
  s_add_u32 m0, s50, 2048
  v_mfma_f32_16x16x32_bf16 v[56:59], a[132:135], v[180:183], v[56:59]
  s_waitcnt lgkmcnt(0)
  v_exp_f32 v7, v7
  v_mfma_f32_16x16x32_bf16 v[56:59], a[128:131], v[176:179], v[56:59]
  buffer_load_dwordx4 v226, s[20:23], s35 offen lds
  v_cvt_pk_bf16_f32 v3, v6, v7
  v_mfma_f32_16x16x32_bf16 v[36:39], a[144:147], v[128:131], v[192:195]
  v_exp_f32 v12, v12
  v_mfma_f32_16x16x32_bf16 v[36:39], a[148:151], v[132:135], v[36:39]
  ds_read_b64_tr_b16 a[160:161], v216 offset:49152
  v_mfma_f32_16x16x32_bf16 v[36:39], a[152:155], v[136:139], v[36:39]
  v_exp_f32 v13, v13
  v_mfma_f32_16x16x32_bf16 v[36:39], a[156:159], v[140:143], v[36:39]
  ds_read_b64_tr_b16 a[162:163], v216 offset:53248
  v_cvt_pk_bf16_f32 v10, v12, v13
  v_mfma_f32_16x16x32_bf16 v[44:47], a[156:159], v[156:159], v[196:199]
  v_exp_f32 v14, v14
  v_mfma_f32_16x16x32_bf16 v[44:47], a[152:155], v[152:155], v[44:47]
  ds_read_b64_tr_b16 a[164:165], v216 offset:57344
  v_mfma_f32_16x16x32_bf16 v[44:47], a[148:151], v[148:151], v[44:47]
  v_exp_f32 v15, v15
  v_mfma_f32_16x16x32_bf16 v[44:47], a[144:147], v[144:147], v[44:47]
  ds_read_b64_tr_b16 a[166:167], v216 offset:61440
  v_cvt_pk_bf16_f32 v11, v14, v15
  v_mfma_f32_16x16x32_bf16 v[52:55], a[144:147], v[160:163], v[200:203]
  v_exp_f32 v20, v20
  v_mfma_f32_16x16x32_bf16 v[52:55], a[148:151], v[164:167], v[52:55]
  ds_read_b64_tr_b16 a[168:169], v217 offset:49152
  v_mfma_f32_16x16x32_bf16 v[52:55], a[152:155], v[168:171], v[52:55]
  v_exp_f32 v21, v21
  v_mfma_f32_16x16x32_bf16 v[52:55], a[156:159], v[172:175], v[52:55]
  ds_read_b64_tr_b16 a[170:171], v217 offset:53248
  v_cvt_pk_bf16_f32 v18, v20, v21
  v_mfma_f32_16x16x32_bf16 v[60:63], a[156:159], v[188:191], v[204:207]
  v_exp_f32 v22, v22
  v_mfma_f32_16x16x32_bf16 v[60:63], a[152:155], v[184:187], v[60:63]
  ds_read_b64_tr_b16 a[172:173], v217 offset:57344
  v_mfma_f32_16x16x32_bf16 v[60:63], a[148:151], v[180:183], v[60:63]
  v_exp_f32 v23, v23
  v_mfma_f32_16x16x32_bf16 v[60:63], a[144:147], v[176:179], v[60:63]
  ds_read_b64_tr_b16 a[174:175], v217 offset:61440
  v_cvt_pk_bf16_f32 v19, v22, v23
  v_mfma_f32_16x16x32_bf16 a[192:195], a[208:211], v[64:67], a[192:195]
  v_exp_f32 v28, v28
  v_mfma_f32_16x16x32_bf16 a[192:195], a[208:211], v[96:99], a[192:195]
  ds_read_b64_tr_b16 a[176:177], v218 offset:49152
  v_mfma_f32_16x16x32_bf16 a[196:199], a[208:211], v[72:75], a[196:199]
  v_exp_f32 v29, v29
  v_mfma_f32_16x16x32_bf16 a[196:199], a[208:211], v[104:107], a[196:199]
  ds_read_b64_tr_b16 a[178:179], v218 offset:53248
  v_cvt_pk_bf16_f32 v26, v28, v29
  v_mfma_f32_16x16x32_bf16 a[200:203], a[208:211], v[80:83], a[200:203]
  v_exp_f32 v30, v30
  v_mfma_f32_16x16x32_bf16 a[200:203], a[208:211], v[112:115], a[200:203]
  ds_read_b64_tr_b16 a[180:181], v218 offset:57344
  v_mfma_f32_16x16x32_bf16 a[204:207], a[208:211], v[88:91], a[204:207]
  s_waitcnt lgkmcnt(7)
  v_exp_f32 v31, v31
  v_mfma_f32_16x16x32_bf16 a[204:207], a[208:211], v[120:123], a[204:207]
  ds_read_b64_tr_b16 a[182:183], v218 offset:61440
  v_cvt_pk_bf16_f32 v27, v30, v31
  v_mfma_f32_16x16x32_bf16 a[0:3], a[160:163], v[64:67], a[0:3]
  v_exp_f32 v32, v32
  v_mfma_f32_16x16x32_bf16 a[0:3], a[164:167], v[96:99], a[0:3]
  ds_read_b64_tr_b16 a[184:185], v219 offset:49152
  v_mfma_f32_16x16x32_bf16 a[4:7], a[164:167], v[104:107], a[4:7]
  v_exp_f32 v33, v33
  v_mfma_f32_16x16x32_bf16 a[4:7], a[160:163], v[72:75], a[4:7]
  ds_read_b64_tr_b16 a[186:187], v219 offset:53248
  v_cvt_pk_bf16_f32 v32, v32, v33
  v_mfma_f32_16x16x32_bf16 a[8:11], a[160:163], v[80:83], a[8:11]
  v_exp_f32 v34, v34
  v_mfma_f32_16x16x32_bf16 a[8:11], a[164:167], v[112:115], a[8:11]
  ds_read_b64_tr_b16 a[188:189], v219 offset:57344
  v_mfma_f32_16x16x32_bf16 a[12:15], a[164:167], v[120:123], a[12:15]
  s_waitcnt lgkmcnt(7)
  v_exp_f32 v35, v35
  v_mfma_f32_16x16x32_bf16 a[12:15], a[160:163], v[88:91], a[12:15]
  ds_read_b64_tr_b16 a[190:191], v219 offset:61440
  v_cvt_pk_bf16_f32 v33, v34, v35
  v_mfma_f32_16x16x32_bf16 a[16:19], a[168:171], v[64:67], a[16:19]
  v_exp_f32 v40, v40
  v_mfma_f32_16x16x32_bf16 a[16:19], a[172:175], v[96:99], a[16:19]
  ds_read_b64_tr_b16 a[160:161], v220 offset:49152
  v_mfma_f32_16x16x32_bf16 a[20:23], a[172:175], v[104:107], a[20:23]
  v_exp_f32 v41, v41
  v_mfma_f32_16x16x32_bf16 a[20:23], a[168:171], v[72:75], a[20:23]
  ds_read_b64_tr_b16 a[162:163], v220 offset:53248
  v_cvt_pk_bf16_f32 v40, v40, v41
  v_mfma_f32_16x16x32_bf16 a[24:27], a[168:171], v[80:83], a[24:27]
  v_exp_f32 v42, v42
  v_mfma_f32_16x16x32_bf16 a[24:27], a[172:175], v[112:115], a[24:27]
  ds_read_b64_tr_b16 a[164:165], v220 offset:57344
  v_mfma_f32_16x16x32_bf16 a[28:31], a[172:175], v[120:123], a[28:31]
  s_waitcnt lgkmcnt(7)
  v_exp_f32 v43, v43
  v_mfma_f32_16x16x32_bf16 a[28:31], a[168:171], v[88:91], a[28:31]
  ds_read_b64_tr_b16 a[166:167], v220 offset:61440
  v_cvt_pk_bf16_f32 v41, v42, v43
  v_mfma_f32_16x16x32_bf16 a[32:35], a[176:179], v[64:67], a[32:35]
  v_exp_f32 v48, v48
  v_mfma_f32_16x16x32_bf16 a[32:35], a[180:183], v[96:99], a[32:35]
  ds_read_b64_tr_b16 a[168:169], v221 offset:49152
  v_mfma_f32_16x16x32_bf16 a[36:39], a[180:183], v[104:107], a[36:39]
  v_exp_f32 v49, v49
  v_mfma_f32_16x16x32_bf16 a[36:39], a[176:179], v[72:75], a[36:39]
  ds_read_b64_tr_b16 a[170:171], v221 offset:53248
  v_cvt_pk_bf16_f32 v48, v48, v49
  v_mfma_f32_16x16x32_bf16 a[40:43], a[176:179], v[80:83], a[40:43]
  v_exp_f32 v50, v50
  v_mfma_f32_16x16x32_bf16 a[40:43], a[180:183], v[112:115], a[40:43]
  ds_read_b64_tr_b16 a[172:173], v221 offset:57344
  v_mfma_f32_16x16x32_bf16 a[44:47], a[180:183], v[120:123], a[44:47]
  s_waitcnt lgkmcnt(7)
  v_exp_f32 v51, v51
  v_mfma_f32_16x16x32_bf16 a[44:47], a[176:179], v[88:91], a[44:47]
  ds_read_b64_tr_b16 a[174:175], v221 offset:61440
  v_cvt_pk_bf16_f32 v49, v50, v51
  v_mfma_f32_16x16x32_bf16 a[48:51], a[184:187], v[64:67], a[48:51]
  v_exp_f32 v56, v56
  v_mfma_f32_16x16x32_bf16 a[48:51], a[188:191], v[96:99], a[48:51]
  ds_read_b64_tr_b16 a[176:177], v222 offset:49152
  v_mfma_f32_16x16x32_bf16 a[52:55], a[188:191], v[104:107], a[52:55]
  v_exp_f32 v57, v57
  v_mfma_f32_16x16x32_bf16 a[52:55], a[184:187], v[72:75], a[52:55]
  ds_read_b64_tr_b16 a[178:179], v222 offset:53248
  v_cvt_pk_bf16_f32 v56, v56, v57
  v_mfma_f32_16x16x32_bf16 a[56:59], a[184:187], v[80:83], a[56:59]
  v_exp_f32 v58, v58
  v_mfma_f32_16x16x32_bf16 a[56:59], a[188:191], v[112:115], a[56:59]
  ds_read_b64_tr_b16 a[180:181], v222 offset:57344
  v_mfma_f32_16x16x32_bf16 a[60:63], a[188:191], v[120:123], a[60:63]
  s_waitcnt lgkmcnt(7)
  v_exp_f32 v59, v59
  v_mfma_f32_16x16x32_bf16 a[60:63], a[184:187], v[88:91], a[60:63]
  ds_read_b64_tr_b16 a[182:183], v222 offset:61440
  v_cvt_pk_bf16_f32 v57, v58, v59
  v_mfma_f32_16x16x32_bf16 a[64:67], a[160:163], v[64:67], a[64:67]
  v_exp_f32 v36, v36
  v_mfma_f32_16x16x32_bf16 a[64:67], a[164:167], v[96:99], a[64:67]
  ds_read_b64_tr_b16 a[184:185], v223 offset:49152
  v_mfma_f32_16x16x32_bf16 a[68:71], a[164:167], v[104:107], a[68:71]
  v_exp_f32 v37, v37
  v_mfma_f32_16x16x32_bf16 a[68:71], a[160:163], v[72:75], a[68:71]
  ds_read_b64_tr_b16 a[186:187], v223 offset:53248
  v_cvt_pk_bf16_f32 v34, v36, v37
  v_mfma_f32_16x16x32_bf16 a[72:75], a[160:163], v[80:83], a[72:75]
  v_exp_f32 v38, v38
  v_mfma_f32_16x16x32_bf16 a[72:75], a[164:167], v[112:115], a[72:75]
  ds_read_b64_tr_b16 a[188:189], v223 offset:57344
  v_mfma_f32_16x16x32_bf16 a[76:79], a[164:167], v[120:123], a[76:79]
  s_waitcnt lgkmcnt(7)
  v_exp_f32 v39, v39
  v_mfma_f32_16x16x32_bf16 a[76:79], a[160:163], v[88:91], a[76:79]
  ds_read_b64_tr_b16 a[190:191], v223 offset:61440
  v_cvt_pk_bf16_f32 v35, v38, v39
  v_mfma_f32_16x16x32_bf16 a[80:83], a[168:171], v[64:67], a[80:83]
  s_waitcnt vmcnt(11)
  v_exp_f32 v44, v44
  v_mfma_f32_16x16x32_bf16 a[80:83], a[172:175], v[96:99], a[80:83]
  v_mfma_f32_16x16x32_bf16 a[84:87], a[172:175], v[104:107], a[84:87]
  s_barrier
  v_exp_f32 v45, v45
  v_mfma_f32_16x16x32_bf16 a[84:87], a[168:171], v[72:75], a[84:87]
  ds_read_b128 a[128:131], v212 offset:16384
  v_cvt_pk_bf16_f32 v42, v44, v45
  v_mfma_f32_16x16x32_bf16 a[88:91], a[168:171], v[80:83], a[88:91]
  v_exp_f32 v46, v46
  v_mfma_f32_16x16x32_bf16 a[88:91], a[172:175], v[112:115], a[88:91]
  ds_read_b128 a[132:135], v213 offset:16384
  v_mfma_f32_16x16x32_bf16 a[92:95], a[172:175], v[120:123], a[92:95]
  s_waitcnt lgkmcnt(6)
  v_exp_f32 v47, v47
  v_mfma_f32_16x16x32_bf16 a[92:95], a[168:171], v[88:91], a[92:95]
  ds_read_b128 a[136:139], v214 offset:16384
  v_cvt_pk_bf16_f32 v43, v46, v47
  v_mfma_f32_16x16x32_bf16 a[96:99], a[176:179], v[64:67], a[96:99]
  v_exp_f32 v52, v52
  v_mfma_f32_16x16x32_bf16 a[96:99], a[180:183], v[96:99], a[96:99]
  ds_read_b128 a[140:143], v215 offset:16384
  buffer_load_dwordx4 a[224:227], v243, s[24:27], s38 offen sc1
  s_add_u32 s38, s38, 4096
  v_mfma_f32_16x16x32_bf16 a[100:103], a[180:183], v[104:107], a[100:103]
  v_exp_f32 v53, v53
  v_mfma_f32_16x16x32_bf16 a[100:103], a[176:179], v[72:75], a[100:103]
  v_cvt_pk_bf16_f32 v50, v52, v53
  v_mfma_f32_16x16x32_bf16 a[104:107], a[176:179], v[80:83], a[104:107]
  v_exp_f32 v54, v54
  v_mfma_f32_16x16x32_bf16 a[104:107], a[180:183], v[112:115], a[104:107]
  v_mfma_f32_16x16x32_bf16 a[108:111], a[180:183], v[120:123], a[108:111]
  s_waitcnt lgkmcnt(4)
  v_exp_f32 v55, v55
  v_mfma_f32_16x16x32_bf16 a[108:111], a[176:179], v[88:91], a[108:111]
  v_cvt_pk_bf16_f32 v51, v54, v55
  v_mfma_f32_16x16x32_bf16 a[112:115], a[184:187], v[64:67], a[112:115]
  v_exp_f32 v60, v60
  v_mfma_f32_16x16x32_bf16 a[112:115], a[188:191], v[96:99], a[112:115]
  v_mfma_f32_16x16x32_bf16 a[116:119], a[188:191], v[104:107], a[116:119]
  v_exp_f32 v61, v61
  v_mfma_f32_16x16x32_bf16 a[116:119], a[184:187], v[72:75], a[116:119]
  v_cvt_pk_bf16_f32 v58, v60, v61
  v_mfma_f32_16x16x32_bf16 a[120:123], a[184:187], v[80:83], a[120:123]
  v_exp_f32 v62, v62
  v_mfma_f32_16x16x32_bf16 a[120:123], a[188:191], v[112:115], a[120:123]
  v_mfma_f32_16x16x32_bf16 a[124:127], a[188:191], v[120:123], a[124:127]
  s_waitcnt lgkmcnt(0)
  v_exp_f32 v63, v63
  v_mfma_f32_16x16x32_bf16 a[124:127], a[184:187], v[88:91], a[124:127]
  v_cvt_pk_bf16_f32 v59, v62, v63
  v_mfma_f32_16x16x32_bf16 v[64:67], a[128:131], v[128:131], v[192:195]
  s_add_u32 m0, s28, 98304
  v_mfma_f32_16x16x32_bf16 v[64:67], a[132:135], v[132:135], v[64:67]
  ds_read_b128 a[144:147], v212 offset:20480
  v_mfma_f32_16x16x32_bf16 v[64:67], a[136:139], v[136:139], v[64:67]
  buffer_load_dwordx4 v236, s[16:19], s29 offen offset:0 lds
  v_mfma_f32_16x16x32_bf16 v[64:67], a[140:143], v[140:143], v[64:67]
  ds_read_b128 a[148:151], v213 offset:20480
  v_mfma_f32_16x16x32_bf16 v[72:75], a[140:143], v[156:159], v[196:199]
  buffer_load_dwordx4 v237, s[16:19], s29 offen offset:1024 lds
  v_mfma_f32_16x16x32_bf16 v[72:75], a[136:139], v[152:155], v[72:75]
  ds_read_b128 a[152:155], v214 offset:20480
  v_mfma_f32_16x16x32_bf16 v[72:75], a[132:135], v[148:151], v[72:75]
  buffer_load_dwordx4 v236, s[16:19], s29 offen offset:2048 lds
  v_mfma_f32_16x16x32_bf16 v[72:75], a[128:131], v[144:147], v[72:75]
  ds_read_b128 a[156:159], v215 offset:20480
  v_mfma_f32_16x16x32_bf16 v[80:83], a[128:131], v[160:163], v[200:203]
  v_exp_f32 v64, v64
  v_mfma_f32_16x16x32_bf16 v[80:83], a[132:135], v[164:167], v[80:83]
  buffer_load_dwordx4 v237, s[16:19], s29 offen offset:3072 lds
  v_mfma_f32_16x16x32_bf16 v[80:83], a[136:139], v[168:171], v[80:83]
  s_add_u32 s29, s29, 16384
  v_exp_f32 v65, v65
  v_mfma_f32_16x16x32_bf16 v[80:83], a[140:143], v[172:175], v[80:83]
  v_cvt_pk_bf16_f32 v64, v64, v65
  v_mfma_f32_16x16x32_bf16 v[88:91], a[140:143], v[188:191], v[204:207]
  s_add_u32 m0, s28, 49152
  v_exp_f32 v66, v66
  v_mfma_f32_16x16x32_bf16 v[88:91], a[136:139], v[184:187], v[88:91]
  buffer_load_dwordx4 v232, s[12:15], s29 offen offset:0 lds
  v_mfma_f32_16x16x32_bf16 v[88:91], a[132:135], v[180:183], v[88:91]
  s_waitcnt lgkmcnt(0)
  v_exp_f32 v67, v67
  v_mfma_f32_16x16x32_bf16 v[88:91], a[128:131], v[176:179], v[88:91]
  v_cvt_pk_bf16_f32 v65, v66, v67
  v_mfma_f32_16x16x32_bf16 v[68:71], a[144:147], v[128:131], v[192:195]
  v_exp_f32 v72, v72
  v_mfma_f32_16x16x32_bf16 v[68:71], a[148:151], v[132:135], v[68:71]
  ds_read_b128 a[128:131], v212 offset:24576
  v_mfma_f32_16x16x32_bf16 v[68:71], a[152:155], v[136:139], v[68:71]
  v_exp_f32 v73, v73
  v_mfma_f32_16x16x32_bf16 v[68:71], a[156:159], v[140:143], v[68:71]
  ds_read_b128 a[132:135], v213 offset:24576
  v_cvt_pk_bf16_f32 v72, v72, v73
  v_mfma_f32_16x16x32_bf16 v[76:79], a[156:159], v[156:159], v[196:199]
  v_exp_f32 v74, v74
  v_mfma_f32_16x16x32_bf16 v[76:79], a[152:155], v[152:155], v[76:79]
  ds_read_b128 a[136:139], v214 offset:24576
  v_mfma_f32_16x16x32_bf16 v[76:79], a[148:151], v[148:151], v[76:79]
  v_exp_f32 v75, v75
  v_mfma_f32_16x16x32_bf16 v[76:79], a[144:147], v[144:147], v[76:79]
  ds_read_b128 a[140:143], v215 offset:24576
  v_cvt_pk_bf16_f32 v73, v74, v75
  v_mfma_f32_16x16x32_bf16 v[84:87], a[144:147], v[160:163], v[200:203]
  v_exp_f32 v80, v80
  v_mfma_f32_16x16x32_bf16 v[84:87], a[148:151], v[164:167], v[84:87]
  buffer_load_dwordx4 v233, s[12:15], s29 offen offset:1024 lds
  v_mfma_f32_16x16x32_bf16 v[84:87], a[152:155], v[168:171], v[84:87]
  v_exp_f32 v81, v81
  v_mfma_f32_16x16x32_bf16 v[84:87], a[156:159], v[172:175], v[84:87]
  v_cvt_pk_bf16_f32 v80, v80, v81
  v_mfma_f32_16x16x32_bf16 v[92:95], a[156:159], v[188:191], v[204:207]
  v_exp_f32 v82, v82
  v_mfma_f32_16x16x32_bf16 v[92:95], a[152:155], v[184:187], v[92:95]
  buffer_load_dwordx4 v234, s[12:15], s29 offen offset:2048 lds
  v_mfma_f32_16x16x32_bf16 v[92:95], a[148:151], v[180:183], v[92:95]
  s_waitcnt lgkmcnt(0)
  v_exp_f32 v83, v83
  v_mfma_f32_16x16x32_bf16 v[92:95], a[144:147], v[176:179], v[92:95]
  v_cvt_pk_bf16_f32 v81, v82, v83
  v_mfma_f32_16x16x32_bf16 v[96:99], a[128:131], v[128:131], v[192:195]
  v_exp_f32 v88, v88
  v_mfma_f32_16x16x32_bf16 v[96:99], a[132:135], v[132:135], v[96:99]
  ds_read_b128 a[144:147], v212 offset:28672
  v_mfma_f32_16x16x32_bf16 v[96:99], a[136:139], v[136:139], v[96:99]
  v_exp_f32 v89, v89
  v_mfma_f32_16x16x32_bf16 v[96:99], a[140:143], v[140:143], v[96:99]
  ds_read_b128 a[148:151], v213 offset:28672
  v_cvt_pk_bf16_f32 v88, v88, v89
  v_mfma_f32_16x16x32_bf16 v[104:107], a[140:143], v[156:159], v[196:199]
  v_exp_f32 v90, v90
  v_mfma_f32_16x16x32_bf16 v[104:107], a[136:139], v[152:155], v[104:107]
  ds_read_b128 a[152:155], v214 offset:28672
  v_mfma_f32_16x16x32_bf16 v[104:107], a[132:135], v[148:151], v[104:107]
  v_exp_f32 v91, v91
  v_mfma_f32_16x16x32_bf16 v[104:107], a[128:131], v[144:147], v[104:107]
  ds_read_b128 a[156:159], v215 offset:28672
  v_cvt_pk_bf16_f32 v89, v90, v91
  v_mfma_f32_16x16x32_bf16 v[112:115], a[128:131], v[160:163], v[200:203]
  v_exp_f32 v68, v68
  v_mfma_f32_16x16x32_bf16 v[112:115], a[132:135], v[164:167], v[112:115]
  buffer_load_dwordx4 v235, s[12:15], s29 offen offset:3072 lds
  v_mfma_f32_16x16x32_bf16 v[112:115], a[136:139], v[168:171], v[112:115]
  v_exp_f32 v69, v69
  v_mfma_f32_16x16x32_bf16 v[112:115], a[140:143], v[172:175], v[112:115]
  v_cvt_pk_bf16_f32 v66, v68, v69
  v_mfma_f32_16x16x32_bf16 v[120:123], a[140:143], v[188:191], v[204:207]
  v_exp_f32 v70, v70
  v_mfma_f32_16x16x32_bf16 v[120:123], a[136:139], v[184:187], v[120:123]
  s_add_u32 m0, s50, 5120
  v_mfma_f32_16x16x32_bf16 v[120:123], a[132:135], v[180:183], v[120:123]
  s_waitcnt lgkmcnt(0)
  v_exp_f32 v71, v71
  v_mfma_f32_16x16x32_bf16 v[120:123], a[128:131], v[176:179], v[120:123]
  buffer_load_dwordx4 v226, s[44:47], s35 offen lds
  s_add_u32 s35, s35, 221184
  v_cvt_pk_bf16_f32 v67, v70, v71
  v_mfma_f32_16x16x32_bf16 v[100:103], a[144:147], v[128:131], v[192:195]
  v_exp_f32 v76, v76
  v_mfma_f32_16x16x32_bf16 v[100:103], a[148:151], v[132:135], v[100:103]
  ds_read_b64_tr_b16 a[160:161], v216 offset:0
  v_mfma_f32_16x16x32_bf16 v[100:103], a[152:155], v[136:139], v[100:103]
  v_exp_f32 v77, v77
  v_mfma_f32_16x16x32_bf16 v[100:103], a[156:159], v[140:143], v[100:103]
  ds_read_b64_tr_b16 a[162:163], v216 offset:4096
  v_cvt_pk_bf16_f32 v74, v76, v77
  v_mfma_f32_16x16x32_bf16 v[108:111], a[156:159], v[156:159], v[196:199]
  v_exp_f32 v78, v78
  v_mfma_f32_16x16x32_bf16 v[108:111], a[152:155], v[152:155], v[108:111]
  ds_read_b64_tr_b16 a[164:165], v216 offset:8192
  v_mfma_f32_16x16x32_bf16 v[108:111], a[148:151], v[148:151], v[108:111]
  v_exp_f32 v79, v79
  v_mfma_f32_16x16x32_bf16 v[108:111], a[144:147], v[144:147], v[108:111]
  ds_read_b64_tr_b16 a[166:167], v216 offset:12288
  v_cvt_pk_bf16_f32 v75, v78, v79
  v_mfma_f32_16x16x32_bf16 v[116:119], a[144:147], v[160:163], v[200:203]
  v_exp_f32 v84, v84
  v_mfma_f32_16x16x32_bf16 v[116:119], a[148:151], v[164:167], v[116:119]
  ds_read_b64_tr_b16 a[168:169], v217 offset:0
  v_mfma_f32_16x16x32_bf16 v[116:119], a[152:155], v[168:171], v[116:119]
  v_exp_f32 v85, v85
  v_mfma_f32_16x16x32_bf16 v[116:119], a[156:159], v[172:175], v[116:119]
  ds_read_b64_tr_b16 a[170:171], v217 offset:4096
  v_cvt_pk_bf16_f32 v82, v84, v85
  v_mfma_f32_16x16x32_bf16 v[124:127], a[156:159], v[188:191], v[204:207]
  v_exp_f32 v86, v86
  v_mfma_f32_16x16x32_bf16 v[124:127], a[152:155], v[184:187], v[124:127]
  ds_read_b64_tr_b16 a[172:173], v217 offset:8192
  v_mfma_f32_16x16x32_bf16 v[124:127], a[148:151], v[180:183], v[124:127]
  v_exp_f32 v87, v87
  v_mfma_f32_16x16x32_bf16 v[124:127], a[144:147], v[176:179], v[124:127]
  ds_read_b64_tr_b16 a[174:175], v217 offset:12288
  v_cvt_pk_bf16_f32 v83, v86, v87
  v_mfma_f32_16x16x32_bf16 a[192:195], a[208:211], v[0:3], a[192:195]
  v_exp_f32 v92, v92
  v_mfma_f32_16x16x32_bf16 a[192:195], a[208:211], v[32:35], a[192:195]
  ds_read_b64_tr_b16 a[176:177], v218 offset:0
  v_mfma_f32_16x16x32_bf16 a[196:199], a[208:211], v[8:11], a[196:199]
  v_exp_f32 v93, v93
  v_mfma_f32_16x16x32_bf16 a[196:199], a[208:211], v[40:43], a[196:199]
  ds_read_b64_tr_b16 a[178:179], v218 offset:4096
  v_cvt_pk_bf16_f32 v90, v92, v93
  v_mfma_f32_16x16x32_bf16 a[200:203], a[208:211], v[16:19], a[200:203]
  v_exp_f32 v94, v94
  v_mfma_f32_16x16x32_bf16 a[200:203], a[208:211], v[48:51], a[200:203]
  ds_read_b64_tr_b16 a[180:181], v218 offset:8192
  v_mfma_f32_16x16x32_bf16 a[204:207], a[208:211], v[24:27], a[204:207]
  s_waitcnt lgkmcnt(7)
  v_exp_f32 v95, v95
  v_mfma_f32_16x16x32_bf16 a[204:207], a[208:211], v[56:59], a[204:207]
  ds_read_b64_tr_b16 a[182:183], v218 offset:12288
  v_cvt_pk_bf16_f32 v91, v94, v95
  v_mfma_f32_16x16x32_bf16 a[0:3], a[160:163], v[0:3], a[0:3]
  v_exp_f32 v96, v96
  v_mfma_f32_16x16x32_bf16 a[0:3], a[164:167], v[32:35], a[0:3]
  ds_read_b64_tr_b16 a[184:185], v219 offset:0
  v_mfma_f32_16x16x32_bf16 a[4:7], a[164:167], v[40:43], a[4:7]
  v_exp_f32 v97, v97
  v_mfma_f32_16x16x32_bf16 a[4:7], a[160:163], v[8:11], a[4:7]
  ds_read_b64_tr_b16 a[186:187], v219 offset:4096
  v_cvt_pk_bf16_f32 v96, v96, v97
  v_mfma_f32_16x16x32_bf16 a[8:11], a[160:163], v[16:19], a[8:11]
  v_exp_f32 v98, v98
  v_mfma_f32_16x16x32_bf16 a[8:11], a[164:167], v[48:51], a[8:11]
  ds_read_b64_tr_b16 a[188:189], v219 offset:8192
  v_mfma_f32_16x16x32_bf16 a[12:15], a[164:167], v[56:59], a[12:15]
  s_waitcnt lgkmcnt(7)
  v_exp_f32 v99, v99
  v_mfma_f32_16x16x32_bf16 a[12:15], a[160:163], v[24:27], a[12:15]
  ds_read_b64_tr_b16 a[190:191], v219 offset:12288
  v_cvt_pk_bf16_f32 v97, v98, v99
  v_mfma_f32_16x16x32_bf16 a[16:19], a[168:171], v[0:3], a[16:19]
  v_exp_f32 v104, v104
  v_mfma_f32_16x16x32_bf16 a[16:19], a[172:175], v[32:35], a[16:19]
  ds_read_b64_tr_b16 a[160:161], v220 offset:0
  v_mfma_f32_16x16x32_bf16 a[20:23], a[172:175], v[40:43], a[20:23]
  v_exp_f32 v105, v105
  v_mfma_f32_16x16x32_bf16 a[20:23], a[168:171], v[8:11], a[20:23]
  ds_read_b64_tr_b16 a[162:163], v220 offset:4096
  v_cvt_pk_bf16_f32 v104, v104, v105
  v_mfma_f32_16x16x32_bf16 a[24:27], a[168:171], v[16:19], a[24:27]
  v_exp_f32 v106, v106
  v_mfma_f32_16x16x32_bf16 a[24:27], a[172:175], v[48:51], a[24:27]
  ds_read_b64_tr_b16 a[164:165], v220 offset:8192
  v_mfma_f32_16x16x32_bf16 a[28:31], a[172:175], v[56:59], a[28:31]
  s_waitcnt lgkmcnt(7)
  v_exp_f32 v107, v107
  v_mfma_f32_16x16x32_bf16 a[28:31], a[168:171], v[24:27], a[28:31]
  ds_read_b64_tr_b16 a[166:167], v220 offset:12288
  v_cvt_pk_bf16_f32 v105, v106, v107
  v_mfma_f32_16x16x32_bf16 a[32:35], a[176:179], v[0:3], a[32:35]
  v_exp_f32 v112, v112
  v_mfma_f32_16x16x32_bf16 a[32:35], a[180:183], v[32:35], a[32:35]
  ds_read_b64_tr_b16 a[168:169], v221 offset:0
  v_mfma_f32_16x16x32_bf16 a[36:39], a[180:183], v[40:43], a[36:39]
  v_exp_f32 v113, v113
  v_mfma_f32_16x16x32_bf16 a[36:39], a[176:179], v[8:11], a[36:39]
  ds_read_b64_tr_b16 a[170:171], v221 offset:4096
  v_cvt_pk_bf16_f32 v112, v112, v113
  v_mfma_f32_16x16x32_bf16 a[40:43], a[176:179], v[16:19], a[40:43]
  v_exp_f32 v114, v114
  v_mfma_f32_16x16x32_bf16 a[40:43], a[180:183], v[48:51], a[40:43]
  ds_read_b64_tr_b16 a[172:173], v221 offset:8192
  v_mfma_f32_16x16x32_bf16 a[44:47], a[180:183], v[56:59], a[44:47]
  s_waitcnt lgkmcnt(7)
  v_exp_f32 v115, v115
  v_mfma_f32_16x16x32_bf16 a[44:47], a[176:179], v[24:27], a[44:47]
  ds_read_b64_tr_b16 a[174:175], v221 offset:12288
  v_cvt_pk_bf16_f32 v113, v114, v115
  v_mfma_f32_16x16x32_bf16 a[48:51], a[184:187], v[0:3], a[48:51]
  v_exp_f32 v120, v120
  v_mfma_f32_16x16x32_bf16 a[48:51], a[188:191], v[32:35], a[48:51]
  ds_read_b64_tr_b16 a[176:177], v222 offset:0
  v_mfma_f32_16x16x32_bf16 a[52:55], a[188:191], v[40:43], a[52:55]
  v_exp_f32 v121, v121
  v_mfma_f32_16x16x32_bf16 a[52:55], a[184:187], v[8:11], a[52:55]
  ds_read_b64_tr_b16 a[178:179], v222 offset:4096
  v_cvt_pk_bf16_f32 v120, v120, v121
  v_mfma_f32_16x16x32_bf16 a[56:59], a[184:187], v[16:19], a[56:59]
  v_exp_f32 v122, v122
  v_mfma_f32_16x16x32_bf16 a[56:59], a[188:191], v[48:51], a[56:59]
  ds_read_b64_tr_b16 a[180:181], v222 offset:8192
  v_mfma_f32_16x16x32_bf16 a[60:63], a[188:191], v[56:59], a[60:63]
  s_waitcnt lgkmcnt(7)
  v_exp_f32 v123, v123
  v_mfma_f32_16x16x32_bf16 a[60:63], a[184:187], v[24:27], a[60:63]
  ds_read_b64_tr_b16 a[182:183], v222 offset:12288
  v_cvt_pk_bf16_f32 v121, v122, v123
  v_mfma_f32_16x16x32_bf16 a[64:67], a[160:163], v[0:3], a[64:67]
  v_exp_f32 v100, v100
  v_mfma_f32_16x16x32_bf16 a[64:67], a[164:167], v[32:35], a[64:67]
  ds_read_b64_tr_b16 a[184:185], v223 offset:0
  v_mfma_f32_16x16x32_bf16 a[68:71], a[164:167], v[40:43], a[68:71]
  v_exp_f32 v101, v101
  v_mfma_f32_16x16x32_bf16 a[68:71], a[160:163], v[8:11], a[68:71]
  ds_read_b64_tr_b16 a[186:187], v223 offset:4096
  v_cvt_pk_bf16_f32 v98, v100, v101
  v_mfma_f32_16x16x32_bf16 a[72:75], a[160:163], v[16:19], a[72:75]
  v_exp_f32 v102, v102
  v_mfma_f32_16x16x32_bf16 a[72:75], a[164:167], v[48:51], a[72:75]
  ds_read_b64_tr_b16 a[188:189], v223 offset:8192
  v_mfma_f32_16x16x32_bf16 a[76:79], a[164:167], v[56:59], a[76:79]
  s_waitcnt lgkmcnt(7)
  v_exp_f32 v103, v103
  v_mfma_f32_16x16x32_bf16 a[76:79], a[160:163], v[24:27], a[76:79]
  ds_read_b64_tr_b16 a[190:191], v223 offset:12288
  v_cvt_pk_bf16_f32 v99, v102, v103
  v_mfma_f32_16x16x32_bf16 a[80:83], a[168:171], v[0:3], a[80:83]
  s_waitcnt vmcnt(11)
  v_exp_f32 v108, v108
  v_mfma_f32_16x16x32_bf16 a[80:83], a[172:175], v[32:35], a[80:83]
  v_mfma_f32_16x16x32_bf16 a[84:87], a[172:175], v[40:43], a[84:87]
  s_barrier
  v_exp_f32 v109, v109
  v_mfma_f32_16x16x32_bf16 a[84:87], a[168:171], v[8:11], a[84:87]
  ds_read_b128 a[128:131], v212 offset:32768
  v_cvt_pk_bf16_f32 v106, v108, v109
  v_mfma_f32_16x16x32_bf16 a[88:91], a[168:171], v[16:19], a[88:91]
  v_exp_f32 v110, v110
  v_mfma_f32_16x16x32_bf16 a[88:91], a[172:175], v[48:51], a[88:91]
  ds_read_b128 a[132:135], v213 offset:32768
  v_mfma_f32_16x16x32_bf16 a[92:95], a[172:175], v[56:59], a[92:95]
  s_waitcnt lgkmcnt(6)
  v_exp_f32 v111, v111
  v_mfma_f32_16x16x32_bf16 a[92:95], a[168:171], v[24:27], a[92:95]
  ds_read_b128 a[136:139], v214 offset:32768
  v_cvt_pk_bf16_f32 v107, v110, v111
  v_mfma_f32_16x16x32_bf16 a[96:99], a[176:179], v[0:3], a[96:99]
  v_exp_f32 v116, v116
  v_mfma_f32_16x16x32_bf16 a[96:99], a[180:183], v[32:35], a[96:99]
  ds_read_b128 a[140:143], v215 offset:32768
  buffer_load_dwordx4 a[228:231], v243, s[24:27], s38 offen sc1
  s_add_u32 s38, s38, 4096
  v_mfma_f32_16x16x32_bf16 a[100:103], a[180:183], v[40:43], a[100:103]
  v_exp_f32 v117, v117
  v_mfma_f32_16x16x32_bf16 a[100:103], a[176:179], v[8:11], a[100:103]
  v_cvt_pk_bf16_f32 v114, v116, v117
  v_mfma_f32_16x16x32_bf16 a[104:107], a[176:179], v[16:19], a[104:107]
  v_exp_f32 v118, v118
  v_mfma_f32_16x16x32_bf16 a[104:107], a[180:183], v[48:51], a[104:107]
  v_mfma_f32_16x16x32_bf16 a[108:111], a[180:183], v[56:59], a[108:111]
  s_waitcnt lgkmcnt(4)
  v_exp_f32 v119, v119
  v_mfma_f32_16x16x32_bf16 a[108:111], a[176:179], v[24:27], a[108:111]
  v_cvt_pk_bf16_f32 v115, v118, v119
  v_mfma_f32_16x16x32_bf16 a[112:115], a[184:187], v[0:3], a[112:115]
  v_exp_f32 v124, v124
  v_mfma_f32_16x16x32_bf16 a[112:115], a[188:191], v[32:35], a[112:115]
  v_mfma_f32_16x16x32_bf16 a[116:119], a[188:191], v[40:43], a[116:119]
  v_exp_f32 v125, v125
  v_mfma_f32_16x16x32_bf16 a[116:119], a[184:187], v[8:11], a[116:119]
  v_cvt_pk_bf16_f32 v122, v124, v125
  v_mfma_f32_16x16x32_bf16 a[120:123], a[184:187], v[16:19], a[120:123]
  v_exp_f32 v126, v126
  v_mfma_f32_16x16x32_bf16 a[120:123], a[188:191], v[48:51], a[120:123]
  v_mfma_f32_16x16x32_bf16 a[124:127], a[188:191], v[56:59], a[124:127]
  s_waitcnt lgkmcnt(0)
  v_exp_f32 v127, v127
  v_mfma_f32_16x16x32_bf16 a[124:127], a[184:187], v[24:27], a[124:127]
  v_cvt_pk_bf16_f32 v123, v126, v127
  v_mfma_f32_16x16x32_bf16 v[0:3], a[128:131], v[128:131], v[192:195]
  s_add_u32 m0, s28, 114688
  s_mov_b32 s20, s88
  s_mov_b32 s21, s89
  s_mov_b32 s22, 5242880
  s_mov_b32 s23, 0x20000
  v_lshrrev_b32 v208, 4, v242
  v_and_b32 v209, 1, v208
  v_mfma_f32_16x16x32_bf16 v[0:3], a[132:135], v[132:135], v[0:3]
  ds_read_b128 a[144:147], v212 offset:36864
  v_lshrrev_b32 v208, 1, v208
  v_mfma_f32_16x16x32_bf16 v[0:3], a[136:139], v[136:139], v[0:3]
  buffer_load_dwordx4 v236, s[16:19], s29 offen offset:0 lds
  v_mfma_f32_16x16x32_bf16 v[0:3], a[140:143], v[140:143], v[0:3]
  ds_read_b128 a[148:151], v213 offset:36864
  v_mul_u32_u24 v208, 0x500, v208
  v_mfma_f32_16x16x32_bf16 v[8:11], a[140:143], v[156:159], v[196:199]
  buffer_load_dwordx4 v237, s[16:19], s29 offen offset:1024 lds
  v_mfma_f32_16x16x32_bf16 v[8:11], a[136:139], v[152:155], v[8:11]
  ds_read_b128 a[152:155], v214 offset:36864
  v_lshl_add_u32 v208, v209, 4, v208
  v_mfma_f32_16x16x32_bf16 v[8:11], a[132:135], v[148:151], v[8:11]
  buffer_load_dwordx4 v236, s[16:19], s29 offen offset:2048 lds
  v_mfma_f32_16x16x32_bf16 v[8:11], a[128:131], v[144:147], v[8:11]
  ds_read_b128 a[156:159], v215 offset:36864
  v_lshrrev_b32 v209, 4, v242
  v_mfma_f32_16x16x32_bf16 v[16:19], a[128:131], v[160:163], v[200:203]
  v_exp_f32 v0, v0
  v_mfma_f32_16x16x32_bf16 v[16:19], a[132:135], v[164:167], v[16:19]
  buffer_load_dwordx4 v237, s[16:19], s29 offen offset:3072 lds
  v_mfma_f32_16x16x32_bf16 v[16:19], a[136:139], v[168:171], v[16:19]
  s_add_u32 s29, s29, 16384
  v_exp_f32 v1, v1
  v_mfma_f32_16x16x32_bf16 v[16:19], a[140:143], v[172:175], v[16:19]
  v_cvt_pk_bf16_f32 v0, v0, v1
  v_lshrrev_b32 v210, 5, v209
  v_mfma_f32_16x16x32_bf16 v[24:27], a[140:143], v[188:191], v[204:207]
  s_add_u32 m0, s28, 0
  v_exp_f32 v2, v2
  v_mfma_f32_16x16x32_bf16 v[24:27], a[136:139], v[184:187], v[24:27]
  buffer_load_dwordx4 v232, s[12:15], s29 offen offset:0 lds
  v_mfma_f32_16x16x32_bf16 v[24:27], a[132:135], v[180:183], v[24:27]
  s_waitcnt lgkmcnt(0)
  v_exp_f32 v3, v3
  v_mfma_f32_16x16x32_bf16 v[24:27], a[128:131], v[176:179], v[24:27]
  v_cvt_pk_bf16_f32 v1, v2, v3
  v_lshlrev_b32 v210, 30, v210
  v_mfma_f32_16x16x32_bf16 v[4:7], a[144:147], v[128:131], v[192:195]
  v_exp_f32 v8, v8
  v_mfma_f32_16x16x32_bf16 v[4:7], a[148:151], v[132:135], v[4:7]
  ds_read_b128 a[128:131], v212 offset:40960
  v_or_b32 v210, v210, v208
  v_mfma_f32_16x16x32_bf16 v[4:7], a[152:155], v[136:139], v[4:7]
  v_exp_f32 v9, v9
  v_mfma_f32_16x16x32_bf16 v[4:7], a[156:159], v[140:143], v[4:7]
  ds_read_b128 a[132:135], v213 offset:40960
  v_cvt_pk_bf16_f32 v8, v8, v9
  v_mfma_f32_16x16x32_bf16 v[12:15], a[156:159], v[156:159], v[196:199]
  v_exp_f32 v10, v10
  v_mfma_f32_16x16x32_bf16 v[12:15], a[152:155], v[152:155], v[12:15]
  ds_read_b128 a[136:139], v214 offset:40960
  v_bfe_u32 v211, v209, 2, 4
  v_mfma_f32_16x16x32_bf16 v[12:15], a[148:151], v[148:151], v[12:15]
  v_exp_f32 v11, v11
  v_mfma_f32_16x16x32_bf16 v[12:15], a[144:147], v[144:147], v[12:15]
  ds_read_b128 a[140:143], v215 offset:40960
  v_cvt_pk_bf16_f32 v9, v10, v11
  v_mfma_f32_16x16x32_bf16 v[20:23], a[144:147], v[160:163], v[200:203]
  v_exp_f32 v16, v16
  v_mfma_f32_16x16x32_bf16 v[20:23], a[148:151], v[164:167], v[20:23]
  buffer_load_dwordx4 v233, s[12:15], s29 offen offset:1024 lds
  v_mfma_f32_16x16x32_bf16 v[20:23], a[152:155], v[168:171], v[20:23]
  v_exp_f32 v17, v17
  v_mfma_f32_16x16x32_bf16 v[20:23], a[156:159], v[172:175], v[20:23]
  v_cvt_pk_bf16_f32 v16, v16, v17
  v_and_b32 v209, 3, v209
  v_mfma_f32_16x16x32_bf16 v[28:31], a[156:159], v[188:191], v[204:207]
  v_exp_f32 v18, v18
  v_mfma_f32_16x16x32_bf16 v[28:31], a[152:155], v[184:187], v[28:31]
  buffer_load_dwordx4 v234, s[12:15], s29 offen offset:2048 lds
  v_mfma_f32_16x16x32_bf16 v[28:31], a[148:151], v[180:183], v[28:31]
  s_waitcnt lgkmcnt(0)
  v_exp_f32 v19, v19
  v_mfma_f32_16x16x32_bf16 v[28:31], a[144:147], v[176:179], v[28:31]
  v_cvt_pk_bf16_f32 v17, v18, v19
  v_lshlrev_b32 v209, 3, v209
  v_mfma_f32_16x16x32_bf16 v[32:35], a[128:131], v[128:131], v[192:195]
  v_exp_f32 v24, v24
  v_mfma_f32_16x16x32_bf16 v[32:35], a[132:135], v[132:135], v[32:35]
  ds_read_b128 a[144:147], v212 offset:45056
  v_lshl_add_u32 v209, v211, 5, v209
  v_mfma_f32_16x16x32_bf16 v[32:35], a[136:139], v[136:139], v[32:35]
  v_exp_f32 v25, v25
  v_mfma_f32_16x16x32_bf16 v[32:35], a[140:143], v[140:143], v[32:35]
  ds_read_b128 a[148:151], v213 offset:45056
  v_cvt_pk_bf16_f32 v24, v24, v25
  v_mfma_f32_16x16x32_bf16 v[40:43], a[140:143], v[156:159], v[196:199]
  v_exp_f32 v26, v26
  v_mfma_f32_16x16x32_bf16 v[40:43], a[136:139], v[152:155], v[40:43]
  ds_read_b128 a[152:155], v214 offset:45056
  v_add_u32 v209, s50, v209
  v_mfma_f32_16x16x32_bf16 v[40:43], a[132:135], v[148:151], v[40:43]
  s_and_b32 s39, s2, 1
  s_lshl_b32 s39, s39, 2
  s_add_u32 s39, s39, s3
  s_lshr_b32 s31, s2, 1
  s_mul_i32 s30, s31, 40960
  s_mul_i32 s48, s39, 160
  s_add_u32 s30, s30, s48
  s_mul_i32 s31, s31, 5120
  s_mul_i32 s39, s39, 655360
  s_add_u32 s31, s31, s39
  s_add_u32 s31, s31, 3145728
  s_lshr_b32 s39, s2, 3
  s_min_u32 s39, s39, 29
  s_and_b32 s48, s2, 7
  s_mul_i32 s48, s48, 30
  s_add_u32 s39, s39, s48
  s_mul_i32 s98, s39, 1639
  s_lshr_b32 s98, s98, 16
  s_mul_i32 s99, s98, 40
  s_sub_u32 s99, s39, s99
  s_min_u32 s39, s3, 2
  s_mul_i32 s48, s98, 3
  s_add_u32 s48, s48, s39
  s_mul_i32 s100, s48, 122880
  s_lshl_b32 s39, s99, 5
  s_add_u32 s100, s100, s39
  s_mul_i32 s101, s48, 192
  s_add_u32 s101, s101, 2633728
  s_mov_b32 s51, s50
  v_exp_f32 v27, v27
  v_mfma_f32_16x16x32_bf16 v[40:43], a[128:131], v[144:147], v[40:43]
  ds_read_b128 a[156:159], v215 offset:45056
  v_cvt_pk_bf16_f32 v25, v26, v27
  v_mfma_f32_16x16x32_bf16 v[48:51], a[128:131], v[160:163], v[200:203]
  v_exp_f32 v4, v4
  v_mfma_f32_16x16x32_bf16 v[48:51], a[132:135], v[164:167], v[48:51]
  buffer_load_dwordx4 v235, s[12:15], s29 offen offset:3072 lds
  v_mfma_f32_16x16x32_bf16 v[48:51], a[136:139], v[168:171], v[48:51]
  v_exp_f32 v5, v5
  v_mfma_f32_16x16x32_bf16 v[48:51], a[140:143], v[172:175], v[48:51]
  v_cvt_pk_bf16_f32 v2, v4, v5
  v_mov_b32 v211, v242
  v_mfma_f32_16x16x32_bf16 v[56:59], a[140:143], v[188:191], v[204:207]
  s_mov_b32 s4, s94
  s_mov_b32 s5, s95
  s_mov_b32 s6, 2211840
  s_mov_b32 s7, 0x20000
  v_exp_f32 v6, v6
  v_mfma_f32_16x16x32_bf16 v[56:59], a[136:139], v[184:187], v[56:59]
  v_mfma_f32_16x16x32_bf16 v[56:59], a[132:135], v[180:183], v[56:59]
  s_waitcnt lgkmcnt(0)
  v_exp_f32 v7, v7
  v_mfma_f32_16x16x32_bf16 v[56:59], a[128:131], v[176:179], v[56:59]
  v_cvt_pk_bf16_f32 v3, v6, v7
  v_mfma_f32_16x16x32_bf16 v[36:39], a[144:147], v[128:131], v[192:195]
  v_exp_f32 v12, v12
  v_mfma_f32_16x16x32_bf16 v[36:39], a[148:151], v[132:135], v[36:39]
  ds_read_b64_tr_b16 a[160:161], v216 offset:16384
  v_mfma_f32_16x16x32_bf16 v[36:39], a[152:155], v[136:139], v[36:39]
  v_exp_f32 v13, v13
  v_mfma_f32_16x16x32_bf16 v[36:39], a[156:159], v[140:143], v[36:39]
  ds_read_b64_tr_b16 a[162:163], v216 offset:20480
  v_cvt_pk_bf16_f32 v10, v12, v13
  v_mfma_f32_16x16x32_bf16 v[44:47], a[156:159], v[156:159], v[196:199]
  v_exp_f32 v14, v14
  v_mfma_f32_16x16x32_bf16 v[44:47], a[152:155], v[152:155], v[44:47]
  ds_read_b64_tr_b16 a[164:165], v216 offset:24576
  v_mfma_f32_16x16x32_bf16 v[44:47], a[148:151], v[148:151], v[44:47]
  v_exp_f32 v15, v15
  v_mfma_f32_16x16x32_bf16 v[44:47], a[144:147], v[144:147], v[44:47]
  ds_read_b64_tr_b16 a[166:167], v216 offset:28672
  v_cvt_pk_bf16_f32 v11, v14, v15
  v_mfma_f32_16x16x32_bf16 v[52:55], a[144:147], v[160:163], v[200:203]
  v_exp_f32 v20, v20
  v_mfma_f32_16x16x32_bf16 v[52:55], a[148:151], v[164:167], v[52:55]
  ds_read_b64_tr_b16 a[168:169], v217 offset:16384
  v_mfma_f32_16x16x32_bf16 v[52:55], a[152:155], v[168:171], v[52:55]
  v_exp_f32 v21, v21
  v_mfma_f32_16x16x32_bf16 v[52:55], a[156:159], v[172:175], v[52:55]
  ds_read_b64_tr_b16 a[170:171], v217 offset:20480
  v_cvt_pk_bf16_f32 v18, v20, v21
  v_mfma_f32_16x16x32_bf16 v[60:63], a[156:159], v[188:191], v[204:207]
  v_exp_f32 v22, v22
  v_mfma_f32_16x16x32_bf16 v[60:63], a[152:155], v[184:187], v[60:63]
  ds_read_b64_tr_b16 a[172:173], v217 offset:24576
  v_mfma_f32_16x16x32_bf16 v[60:63], a[148:151], v[180:183], v[60:63]
  v_exp_f32 v23, v23
  v_mfma_f32_16x16x32_bf16 v[60:63], a[144:147], v[176:179], v[60:63]
  ds_read_b64_tr_b16 a[174:175], v217 offset:28672
  v_cvt_pk_bf16_f32 v19, v22, v23
  v_mfma_f32_16x16x32_bf16 a[192:195], a[208:211], v[64:67], a[192:195]
  v_exp_f32 v28, v28
  v_mfma_f32_16x16x32_bf16 a[192:195], a[208:211], v[96:99], a[192:195]
  ds_read_b64_tr_b16 a[176:177], v218 offset:16384
  v_mfma_f32_16x16x32_bf16 a[196:199], a[208:211], v[72:75], a[196:199]
  v_exp_f32 v29, v29
  v_mfma_f32_16x16x32_bf16 a[196:199], a[208:211], v[104:107], a[196:199]
  ds_read_b64_tr_b16 a[178:179], v218 offset:20480
  v_cvt_pk_bf16_f32 v26, v28, v29
  v_mfma_f32_16x16x32_bf16 a[200:203], a[208:211], v[80:83], a[200:203]
  v_exp_f32 v30, v30
  v_mfma_f32_16x16x32_bf16 a[200:203], a[208:211], v[112:115], a[200:203]
  ds_read_b64_tr_b16 a[180:181], v218 offset:24576
  v_mfma_f32_16x16x32_bf16 a[204:207], a[208:211], v[88:91], a[204:207]
  s_waitcnt lgkmcnt(7)
  v_exp_f32 v31, v31
  v_mfma_f32_16x16x32_bf16 a[204:207], a[208:211], v[120:123], a[204:207]
  ds_read_b64_tr_b16 a[182:183], v218 offset:28672
  v_cvt_pk_bf16_f32 v27, v30, v31
  v_mfma_f32_16x16x32_bf16 a[0:3], a[160:163], v[64:67], a[0:3]
  v_exp_f32 v32, v32
  v_mfma_f32_16x16x32_bf16 a[0:3], a[164:167], v[96:99], a[0:3]
  ds_read_b64_tr_b16 a[184:185], v219 offset:16384
  v_mfma_f32_16x16x32_bf16 a[4:7], a[164:167], v[104:107], a[4:7]
  v_exp_f32 v33, v33
  v_mfma_f32_16x16x32_bf16 a[4:7], a[160:163], v[72:75], a[4:7]
  ds_read_b64_tr_b16 a[186:187], v219 offset:20480
  v_cvt_pk_bf16_f32 v32, v32, v33
  v_mfma_f32_16x16x32_bf16 a[8:11], a[160:163], v[80:83], a[8:11]
  v_exp_f32 v34, v34
  v_mfma_f32_16x16x32_bf16 a[8:11], a[164:167], v[112:115], a[8:11]
  ds_read_b64_tr_b16 a[188:189], v219 offset:24576
  v_mfma_f32_16x16x32_bf16 a[12:15], a[164:167], v[120:123], a[12:15]
  s_waitcnt lgkmcnt(7)
  v_exp_f32 v35, v35
  v_mfma_f32_16x16x32_bf16 a[12:15], a[160:163], v[88:91], a[12:15]
  ds_read_b64_tr_b16 a[190:191], v219 offset:28672
  v_cvt_pk_bf16_f32 v33, v34, v35
  v_mfma_f32_16x16x32_bf16 a[16:19], a[168:171], v[64:67], a[16:19]
  v_exp_f32 v40, v40
  v_mfma_f32_16x16x32_bf16 a[16:19], a[172:175], v[96:99], a[16:19]
  ds_read_b64_tr_b16 a[160:161], v220 offset:16384
  v_mfma_f32_16x16x32_bf16 a[20:23], a[172:175], v[104:107], a[20:23]
  v_exp_f32 v41, v41
  v_mfma_f32_16x16x32_bf16 a[20:23], a[168:171], v[72:75], a[20:23]
  ds_read_b64_tr_b16 a[162:163], v220 offset:20480
  v_cvt_pk_bf16_f32 v40, v40, v41
  v_mfma_f32_16x16x32_bf16 a[24:27], a[168:171], v[80:83], a[24:27]
  v_exp_f32 v42, v42
  v_mfma_f32_16x16x32_bf16 a[24:27], a[172:175], v[112:115], a[24:27]
  ds_read_b64_tr_b16 a[164:165], v220 offset:24576
  v_mfma_f32_16x16x32_bf16 a[28:31], a[172:175], v[120:123], a[28:31]
  s_waitcnt lgkmcnt(7)
  v_exp_f32 v43, v43
  v_mfma_f32_16x16x32_bf16 a[28:31], a[168:171], v[88:91], a[28:31]
  ds_read_b64_tr_b16 a[166:167], v220 offset:28672
  v_cvt_pk_bf16_f32 v41, v42, v43
  v_mfma_f32_16x16x32_bf16 a[32:35], a[176:179], v[64:67], a[32:35]
  v_exp_f32 v48, v48
  v_mfma_f32_16x16x32_bf16 a[32:35], a[180:183], v[96:99], a[32:35]
  ds_read_b64_tr_b16 a[168:169], v221 offset:16384
  v_mfma_f32_16x16x32_bf16 a[36:39], a[180:183], v[104:107], a[36:39]
  v_exp_f32 v49, v49
  v_mfma_f32_16x16x32_bf16 a[36:39], a[176:179], v[72:75], a[36:39]
  ds_read_b64_tr_b16 a[170:171], v221 offset:20480
  v_cvt_pk_bf16_f32 v48, v48, v49
  v_mfma_f32_16x16x32_bf16 a[40:43], a[176:179], v[80:83], a[40:43]
  v_exp_f32 v50, v50
  v_mfma_f32_16x16x32_bf16 a[40:43], a[180:183], v[112:115], a[40:43]
  ds_read_b64_tr_b16 a[172:173], v221 offset:24576
  v_mfma_f32_16x16x32_bf16 a[44:47], a[180:183], v[120:123], a[44:47]
  s_waitcnt lgkmcnt(7)
  v_exp_f32 v51, v51
  v_mfma_f32_16x16x32_bf16 a[44:47], a[176:179], v[88:91], a[44:47]
  ds_read_b64_tr_b16 a[174:175], v221 offset:28672
  v_cvt_pk_bf16_f32 v49, v50, v51
  v_mfma_f32_16x16x32_bf16 a[48:51], a[184:187], v[64:67], a[48:51]
  v_exp_f32 v56, v56
  v_mfma_f32_16x16x32_bf16 a[48:51], a[188:191], v[96:99], a[48:51]
  ds_read_b64_tr_b16 a[176:177], v222 offset:16384
  v_mfma_f32_16x16x32_bf16 a[52:55], a[188:191], v[104:107], a[52:55]
  v_exp_f32 v57, v57
  v_mfma_f32_16x16x32_bf16 a[52:55], a[184:187], v[72:75], a[52:55]
  ds_read_b64_tr_b16 a[178:179], v222 offset:20480
  v_cvt_pk_bf16_f32 v56, v56, v57
  v_mfma_f32_16x16x32_bf16 a[56:59], a[184:187], v[80:83], a[56:59]
  v_exp_f32 v58, v58
  v_mfma_f32_16x16x32_bf16 a[56:59], a[188:191], v[112:115], a[56:59]
  ds_read_b64_tr_b16 a[180:181], v222 offset:24576
  v_mfma_f32_16x16x32_bf16 a[60:63], a[188:191], v[120:123], a[60:63]
  s_waitcnt lgkmcnt(7)
  v_exp_f32 v59, v59
  v_mfma_f32_16x16x32_bf16 a[60:63], a[184:187], v[88:91], a[60:63]
  ds_read_b64_tr_b16 a[182:183], v222 offset:28672
  v_cvt_pk_bf16_f32 v57, v58, v59
  v_mfma_f32_16x16x32_bf16 a[64:67], a[160:163], v[64:67], a[64:67]
  v_exp_f32 v36, v36
  v_mfma_f32_16x16x32_bf16 a[64:67], a[164:167], v[96:99], a[64:67]
  ds_read_b64_tr_b16 a[184:185], v223 offset:16384
  v_mfma_f32_16x16x32_bf16 a[68:71], a[164:167], v[104:107], a[68:71]
  v_exp_f32 v37, v37
  v_mfma_f32_16x16x32_bf16 a[68:71], a[160:163], v[72:75], a[68:71]
  ds_read_b64_tr_b16 a[186:187], v223 offset:20480
  v_cvt_pk_bf16_f32 v34, v36, v37
  v_mfma_f32_16x16x32_bf16 a[72:75], a[160:163], v[80:83], a[72:75]
  v_exp_f32 v38, v38
  v_mfma_f32_16x16x32_bf16 a[72:75], a[164:167], v[112:115], a[72:75]
  ds_read_b64_tr_b16 a[188:189], v223 offset:24576
  v_mfma_f32_16x16x32_bf16 a[76:79], a[164:167], v[120:123], a[76:79]
  s_waitcnt lgkmcnt(7)
  v_exp_f32 v39, v39
  v_mfma_f32_16x16x32_bf16 a[76:79], a[160:163], v[88:91], a[76:79]
  ds_read_b64_tr_b16 a[190:191], v223 offset:28672
  v_cvt_pk_bf16_f32 v35, v38, v39
  v_mfma_f32_16x16x32_bf16 a[80:83], a[168:171], v[64:67], a[80:83]
  s_waitcnt vmcnt(10)
  v_exp_f32 v44, v44
  v_mfma_f32_16x16x32_bf16 a[80:83], a[172:175], v[96:99], a[80:83]
  v_mfma_f32_16x16x32_bf16 a[84:87], a[172:175], v[104:107], a[84:87]
  s_barrier
  v_exp_f32 v45, v45
  v_mfma_f32_16x16x32_bf16 a[84:87], a[168:171], v[72:75], a[84:87]
  ds_read_b128 a[128:131], v212 offset:49152
  v_cvt_pk_bf16_f32 v42, v44, v45
  v_mfma_f32_16x16x32_bf16 a[88:91], a[168:171], v[80:83], a[88:91]
  v_exp_f32 v46, v46
  v_mfma_f32_16x16x32_bf16 a[88:91], a[172:175], v[112:115], a[88:91]
  ds_read_b128 a[132:135], v213 offset:49152
  v_mfma_f32_16x16x32_bf16 a[92:95], a[172:175], v[120:123], a[92:95]
  s_waitcnt lgkmcnt(6)
  v_exp_f32 v47, v47
  v_mfma_f32_16x16x32_bf16 a[92:95], a[168:171], v[88:91], a[92:95]
  ds_read_b128 a[136:139], v214 offset:49152
  v_cvt_pk_bf16_f32 v43, v46, v47
  v_mfma_f32_16x16x32_bf16 a[96:99], a[176:179], v[64:67], a[96:99]
  v_exp_f32 v52, v52
  v_mfma_f32_16x16x32_bf16 a[96:99], a[180:183], v[96:99], a[96:99]
  ds_read_b128 a[140:143], v215 offset:49152
  v_mfma_f32_16x16x32_bf16 a[100:103], a[180:183], v[104:107], a[100:103]
  v_exp_f32 v53, v53
  v_mfma_f32_16x16x32_bf16 a[100:103], a[176:179], v[72:75], a[100:103]
  v_cvt_pk_bf16_f32 v50, v52, v53
  v_mfma_f32_16x16x32_bf16 a[104:107], a[176:179], v[80:83], a[104:107]
  v_exp_f32 v54, v54
  v_mfma_f32_16x16x32_bf16 a[104:107], a[180:183], v[112:115], a[104:107]
  v_mfma_f32_16x16x32_bf16 a[108:111], a[180:183], v[120:123], a[108:111]
  s_waitcnt lgkmcnt(4)
  v_exp_f32 v55, v55
  v_mfma_f32_16x16x32_bf16 a[108:111], a[176:179], v[88:91], a[108:111]
  v_cvt_pk_bf16_f32 v51, v54, v55
  v_mfma_f32_16x16x32_bf16 a[112:115], a[184:187], v[64:67], a[112:115]
  v_exp_f32 v60, v60
  v_mfma_f32_16x16x32_bf16 a[112:115], a[188:191], v[96:99], a[112:115]
  v_mfma_f32_16x16x32_bf16 a[116:119], a[188:191], v[104:107], a[116:119]
  v_exp_f32 v61, v61
  v_mfma_f32_16x16x32_bf16 a[116:119], a[184:187], v[72:75], a[116:119]
  v_cvt_pk_bf16_f32 v58, v60, v61
  v_mfma_f32_16x16x32_bf16 a[120:123], a[184:187], v[80:83], a[120:123]
  v_exp_f32 v62, v62
  v_mfma_f32_16x16x32_bf16 a[120:123], a[188:191], v[112:115], a[120:123]
  v_mfma_f32_16x16x32_bf16 a[124:127], a[188:191], v[120:123], a[124:127]
  s_waitcnt lgkmcnt(0)
  v_exp_f32 v63, v63
  v_mfma_f32_16x16x32_bf16 a[124:127], a[184:187], v[88:91], a[124:127]
  v_cvt_pk_bf16_f32 v59, v62, v63
  v_mfma_f32_16x16x32_bf16 v[64:67], a[128:131], v[128:131], v[192:195]
  s_add_u32 m0, s28, 65536
  v_lshrrev_b32 v224, 4, v242
  v_lshrrev_b32 v225, 4, v224
  v_mfma_f32_16x16x32_bf16 v[64:67], a[132:135], v[132:135], v[64:67]
  ds_read_b128 a[144:147], v212 offset:53248
  v_bfe_u32 v226, v224, 2, 2
  v_mfma_f32_16x16x32_bf16 v[64:67], a[136:139], v[136:139], v[64:67]
  buffer_load_dwordx4 v236, s[16:19], s29 offen offset:0 lds
  v_mfma_f32_16x16x32_bf16 v[64:67], a[140:143], v[140:143], v[64:67]
  ds_read_b128 a[148:151], v213 offset:53248
  v_lshl_add_u32 v225, v225, 3, v226
  v_mfma_f32_16x16x32_bf16 v[72:75], a[140:143], v[156:159], v[196:199]
  buffer_load_dwordx4 v237, s[16:19], s29 offen offset:1024 lds
  v_mfma_f32_16x16x32_bf16 v[72:75], a[136:139], v[152:155], v[72:75]
  ds_read_b128 a[152:155], v214 offset:53248
  v_lshlrev_b32 v225, 4, v225
  v_mfma_f32_16x16x32_bf16 v[72:75], a[132:135], v[148:151], v[72:75]
  buffer_load_dwordx4 v236, s[16:19], s29 offen offset:2048 lds
  v_mfma_f32_16x16x32_bf16 v[72:75], a[128:131], v[144:147], v[72:75]
  ds_read_b128 a[156:159], v215 offset:53248
  v_bfe_u32 v226, v224, 1, 1
  v_mfma_f32_16x16x32_bf16 v[80:83], a[128:131], v[160:163], v[200:203]
  v_exp_f32 v64, v64
  v_mfma_f32_16x16x32_bf16 v[80:83], a[132:135], v[164:167], v[80:83]
  buffer_load_dwordx4 v237, s[16:19], s29 offen offset:3072 lds
  v_mfma_f32_16x16x32_bf16 v[80:83], a[136:139], v[168:171], v[80:83]
  s_add_u32 s29, s29, 16384
  v_exp_f32 v65, v65
  v_mfma_f32_16x16x32_bf16 v[80:83], a[140:143], v[172:175], v[80:83]
  v_cvt_pk_bf16_f32 v64, v64, v65
  v_mul_u32_u24 v226, 0xc00, v226
  v_mfma_f32_16x16x32_bf16 v[88:91], a[140:143], v[188:191], v[204:207]
  s_add_u32 m0, s28, 16384
  v_exp_f32 v66, v66
  v_mfma_f32_16x16x32_bf16 v[88:91], a[136:139], v[184:187], v[88:91]
  buffer_load_dwordx4 v232, s[12:15], s29 offen offset:0 lds
  v_mfma_f32_16x16x32_bf16 v[88:91], a[132:135], v[180:183], v[88:91]
  s_waitcnt lgkmcnt(0)
  v_exp_f32 v67, v67
  v_mfma_f32_16x16x32_bf16 v[88:91], a[128:131], v[176:179], v[88:91]
  v_cvt_pk_bf16_f32 v65, v66, v67
  v_add3_u32 v225, v225, v226, s50
  v_mfma_f32_16x16x32_bf16 v[68:71], a[144:147], v[128:131], v[192:195]
  v_exp_f32 v72, v72
  v_mfma_f32_16x16x32_bf16 v[68:71], a[148:151], v[132:135], v[68:71]
  ds_read_b128 a[128:131], v212 offset:57344
  v_and_b32 v226, 1, v224
  v_mfma_f32_16x16x32_bf16 v[68:71], a[152:155], v[136:139], v[68:71]
  v_exp_f32 v73, v73
  v_mfma_f32_16x16x32_bf16 v[68:71], a[156:159], v[140:143], v[68:71]
  ds_read_b128 a[132:135], v213 offset:57344
  v_cvt_pk_bf16_f32 v72, v72, v73
  v_mfma_f32_16x16x32_bf16 v[76:79], a[156:159], v[156:159], v[196:199]
  v_exp_f32 v74, v74
  v_mfma_f32_16x16x32_bf16 v[76:79], a[152:155], v[152:155], v[76:79]
  ds_read_b128 a[136:139], v214 offset:57344
  v_lshl_add_u32 v225, v226, 3, v225
  v_mfma_f32_16x16x32_bf16 v[76:79], a[148:151], v[148:151], v[76:79]
  s_waitcnt vmcnt(13)
  v_exp_f32 v75, v75
  v_mfma_f32_16x16x32_bf16 v[76:79], a[144:147], v[144:147], v[76:79]
  ds_read_b128 a[140:143], v215 offset:57344
  v_cvt_pk_bf16_f32 v73, v74, v75
  v_mfma_f32_16x16x32_bf16 v[84:87], a[144:147], v[160:163], v[200:203]
  v_exp_f32 v80, v80
  v_mfma_f32_16x16x32_bf16 v[84:87], a[148:151], v[164:167], v[84:87]
  buffer_load_dwordx4 v233, s[12:15], s29 offen offset:1024 lds
  v_mfma_f32_16x16x32_bf16 v[84:87], a[152:155], v[168:171], v[84:87]
  v_exp_f32 v81, v81
  v_mfma_f32_16x16x32_bf16 v[84:87], a[156:159], v[172:175], v[84:87]
  ds_read_b64_tr_b16 a[232:233], v225 offset:0
  v_cvt_pk_bf16_f32 v80, v80, v81
  v_mfma_f32_16x16x32_bf16 v[92:95], a[156:159], v[188:191], v[204:207]
  v_exp_f32 v82, v82
  v_mfma_f32_16x16x32_bf16 v[92:95], a[152:155], v[184:187], v[92:95]
  buffer_load_dwordx4 v234, s[12:15], s29 offen offset:2048 lds
  v_mfma_f32_16x16x32_bf16 v[92:95], a[148:151], v[180:183], v[92:95]
  s_waitcnt lgkmcnt(1)
  v_exp_f32 v83, v83
  v_mfma_f32_16x16x32_bf16 v[92:95], a[144:147], v[176:179], v[92:95]
  ds_read_b64_tr_b16 a[234:235], v225 offset:64
  v_cvt_pk_bf16_f32 v81, v82, v83
  v_mfma_f32_16x16x32_bf16 v[96:99], a[128:131], v[128:131], v[192:195]
  v_exp_f32 v88, v88
  v_mfma_f32_16x16x32_bf16 v[96:99], a[132:135], v[132:135], v[96:99]
  ds_read_b128 a[144:147], v212 offset:61440
  ds_read_b64_tr_b16 a[236:237], v225 offset:512
  v_mfma_f32_16x16x32_bf16 v[96:99], a[136:139], v[136:139], v[96:99]
  v_exp_f32 v89, v89
  v_mfma_f32_16x16x32_bf16 v[96:99], a[140:143], v[140:143], v[96:99]
  ds_read_b128 a[148:151], v213 offset:61440
  v_cvt_pk_bf16_f32 v88, v88, v89
  v_mfma_f32_16x16x32_bf16 v[104:107], a[140:143], v[156:159], v[196:199]
  v_exp_f32 v90, v90
  v_mfma_f32_16x16x32_bf16 v[104:107], a[136:139], v[152:155], v[104:107]
  ds_read_b128 a[152:155], v214 offset:61440
  ds_read_b64_tr_b16 a[238:239], v225 offset:576
  v_mfma_f32_16x16x32_bf16 v[104:107], a[132:135], v[148:151], v[104:107]
  v_exp_f32 v91, v91
  v_mfma_f32_16x16x32_bf16 v[104:107], a[128:131], v[144:147], v[104:107]
  ds_read_b128 a[156:159], v215 offset:61440
  v_cvt_pk_bf16_f32 v89, v90, v91
  v_mfma_f32_16x16x32_bf16 v[112:115], a[128:131], v[160:163], v[200:203]
  v_exp_f32 v68, v68
  v_mfma_f32_16x16x32_bf16 v[112:115], a[132:135], v[164:167], v[112:115]
  buffer_load_dwordx4 v235, s[12:15], s29 offen offset:3072 lds
  v_mfma_f32_16x16x32_bf16 v[112:115], a[136:139], v[168:171], v[112:115]
  v_exp_f32 v69, v69
  v_mfma_f32_16x16x32_bf16 v[112:115], a[140:143], v[172:175], v[112:115]
  ds_read_b64_tr_b16 a[240:241], v225 offset:1024
  v_cvt_pk_bf16_f32 v66, v68, v69
  v_mfma_f32_16x16x32_bf16 v[120:123], a[140:143], v[188:191], v[204:207]
  v_exp_f32 v70, v70
  v_mfma_f32_16x16x32_bf16 v[120:123], a[136:139], v[184:187], v[120:123]
  ds_read_b64_tr_b16 a[242:243], v225 offset:1088
  ds_read_b64_tr_b16 a[244:245], v225 offset:1536
  v_mfma_f32_16x16x32_bf16 v[120:123], a[132:135], v[180:183], v[120:123]
  s_waitcnt lgkmcnt(3)
  v_exp_f32 v71, v71
  v_mfma_f32_16x16x32_bf16 v[120:123], a[128:131], v[176:179], v[120:123]
  ds_read_b64_tr_b16 a[246:247], v225 offset:1600
  v_cvt_pk_bf16_f32 v67, v70, v71
  v_mfma_f32_16x16x32_bf16 v[100:103], a[144:147], v[128:131], v[192:195]
  v_exp_f32 v76, v76
  v_mfma_f32_16x16x32_bf16 v[100:103], a[148:151], v[132:135], v[100:103]
  ds_read_b64_tr_b16 a[160:161], v216 offset:32768
  ds_read_b64_tr_b16 a[248:249], v225 offset:2048
  v_mfma_f32_16x16x32_bf16 v[100:103], a[152:155], v[136:139], v[100:103]
  v_exp_f32 v77, v77
  v_mfma_f32_16x16x32_bf16 v[100:103], a[156:159], v[140:143], v[100:103]
  ds_read_b64_tr_b16 a[162:163], v216 offset:36864
  v_cvt_pk_bf16_f32 v74, v76, v77
  v_mfma_f32_16x16x32_bf16 v[108:111], a[156:159], v[156:159], v[196:199]
  v_exp_f32 v78, v78
  v_mfma_f32_16x16x32_bf16 v[108:111], a[152:155], v[152:155], v[108:111]
  ds_read_b64_tr_b16 a[164:165], v216 offset:40960
  ds_read_b64_tr_b16 a[250:251], v225 offset:2112
  v_mfma_f32_16x16x32_bf16 v[108:111], a[148:151], v[148:151], v[108:111]
  v_exp_f32 v79, v79
  v_mfma_f32_16x16x32_bf16 v[108:111], a[144:147], v[144:147], v[108:111]
  ds_read_b64_tr_b16 a[166:167], v216 offset:45056
  v_cvt_pk_bf16_f32 v75, v78, v79
  v_mfma_f32_16x16x32_bf16 v[116:119], a[144:147], v[160:163], v[200:203]
  v_exp_f32 v84, v84
  v_mfma_f32_16x16x32_bf16 v[116:119], a[148:151], v[164:167], v[116:119]
  ds_read_b64_tr_b16 a[168:169], v217 offset:32768
  v_mfma_f32_16x16x32_bf16 v[116:119], a[152:155], v[168:171], v[116:119]
  v_exp_f32 v85, v85
  v_mfma_f32_16x16x32_bf16 v[116:119], a[156:159], v[172:175], v[116:119]
  ds_read_b64_tr_b16 a[170:171], v217 offset:36864
  v_cvt_pk_bf16_f32 v82, v84, v85
  v_mfma_f32_16x16x32_bf16 v[124:127], a[156:159], v[188:191], v[204:207]
  v_exp_f32 v86, v86
  v_mfma_f32_16x16x32_bf16 v[124:127], a[152:155], v[184:187], v[124:127]
  ds_read_b64_tr_b16 a[172:173], v217 offset:40960
  s_waitcnt lgkmcnt(4)
  v_mfma_f32_16x16x32_bf16 v[228:231], a[232:235], a[212:215], 0
  v_mfma_f32_16x16x32_bf16 v[228:231], a[236:239], a[216:219], v[228:231]
  v_mfma_f32_16x16x32_bf16 v[228:231], a[240:243], a[220:223], v[228:231]
  v_mfma_f32_16x16x32_bf16 v[228:231], a[244:247], a[224:227], v[228:231]
  v_mfma_f32_16x16x32_bf16 v[228:231], a[248:251], a[228:231], v[228:231]
  v_mfma_f32_16x16x32_bf16 v[124:127], a[148:151], v[180:183], v[124:127]
  s_lshl_b32 s35, s3, 10
  s_add_u32 s35, s35, 159744
  v_exp_f32 v87, v87
  v_mfma_f32_16x16x32_bf16 v[124:127], a[144:147], v[176:179], v[124:127]
  ds_read_b64_tr_b16 a[174:175], v217 offset:45056
  v_cvt_pk_bf16_f32 v83, v86, v87
  v_mfma_f32_16x16x32_bf16 a[192:195], a[208:211], v[0:3], a[192:195]
  v_exp_f32 v92, v92
  v_mfma_f32_16x16x32_bf16 a[192:195], a[208:211], v[32:35], a[192:195]
  ds_read_b64_tr_b16 a[176:177], v218 offset:32768
  v_add_u32 v224, s35, v242
  v_mfma_f32_16x16x32_bf16 a[196:199], a[208:211], v[8:11], a[196:199]
  v_exp_f32 v93, v93
  v_mfma_f32_16x16x32_bf16 a[196:199], a[208:211], v[40:43], a[196:199]
  ds_read_b64_tr_b16 a[178:179], v218 offset:36864
  v_cvt_pk_bf16_f32 v90, v92, v93
  v_mfma_f32_16x16x32_bf16 a[200:203], a[208:211], v[16:19], a[200:203]
  v_exp_f32 v94, v94
  v_mfma_f32_16x16x32_bf16 a[200:203], a[208:211], v[48:51], a[200:203]
  ds_read_b64_tr_b16 a[180:181], v218 offset:40960
  ds_write_b128 v224, v[228:231]
  v_mfma_f32_16x16x32_bf16 a[204:207], a[208:211], v[24:27], a[204:207]
  s_waitcnt lgkmcnt(8)
  v_exp_f32 v95, v95
  v_mfma_f32_16x16x32_bf16 a[204:207], a[208:211], v[56:59], a[204:207]
  ds_read_b64_tr_b16 a[182:183], v218 offset:45056
  v_cvt_pk_bf16_f32 v91, v94, v95
  v_mfma_f32_16x16x32_bf16 a[0:3], a[160:163], v[0:3], a[0:3]
  v_exp_f32 v96, v96
  v_mfma_f32_16x16x32_bf16 a[0:3], a[164:167], v[32:35], a[0:3]
  ds_read_b64_tr_b16 a[184:185], v219 offset:32768
  v_mfma_f32_16x16x32_bf16 a[4:7], a[164:167], v[40:43], a[4:7]
  v_exp_f32 v97, v97
  v_mfma_f32_16x16x32_bf16 a[4:7], a[160:163], v[8:11], a[4:7]
  ds_read_b64_tr_b16 a[186:187], v219 offset:36864
  v_cvt_pk_bf16_f32 v96, v96, v97
  v_mfma_f32_16x16x32_bf16 a[8:11], a[160:163], v[16:19], a[8:11]
  v_exp_f32 v98, v98
  v_mfma_f32_16x16x32_bf16 a[8:11], a[164:167], v[48:51], a[8:11]
  ds_read_b64_tr_b16 a[188:189], v219 offset:40960
  s_waitcnt lgkmcnt(4)
  v_lshrrev_b32 v224, 4, v242
  v_mfma_f32_16x16x32_bf16 a[12:15], a[164:167], v[56:59], a[12:15]
  v_exp_f32 v99, v99
  v_mfma_f32_16x16x32_bf16 a[12:15], a[160:163], v[24:27], a[12:15]
  ds_read_b64_tr_b16 a[190:191], v219 offset:45056
  v_cvt_pk_bf16_f32 v97, v98, v99
  v_mfma_f32_16x16x32_bf16 a[16:19], a[168:171], v[0:3], a[16:19]
  v_exp_f32 v104, v104
  v_mfma_f32_16x16x32_bf16 a[16:19], a[172:175], v[32:35], a[16:19]
  ds_read_b64_tr_b16 a[160:161], v220 offset:32768
  v_bfe_u32 v225, v224, 2, 1
  v_mfma_f32_16x16x32_bf16 a[20:23], a[172:175], v[40:43], a[20:23]
  v_exp_f32 v105, v105
  v_mfma_f32_16x16x32_bf16 a[20:23], a[168:171], v[8:11], a[20:23]
  ds_read_b64_tr_b16 a[162:163], v220 offset:36864
  v_cvt_pk_bf16_f32 v104, v104, v105
  v_mfma_f32_16x16x32_bf16 a[24:27], a[168:171], v[16:19], a[24:27]
  v_exp_f32 v106, v106
  v_mfma_f32_16x16x32_bf16 a[24:27], a[172:175], v[48:51], a[24:27]
  ds_read_b64_tr_b16 a[164:165], v220 offset:40960
  v_lshlrev_b32 v225, 8, v225
  v_mfma_f32_16x16x32_bf16 a[28:31], a[172:175], v[56:59], a[28:31]
  s_waitcnt lgkmcnt(7)
  v_exp_f32 v107, v107
  v_mfma_f32_16x16x32_bf16 a[28:31], a[168:171], v[24:27], a[28:31]
  ds_read_b64_tr_b16 a[166:167], v220 offset:45056
  v_cvt_pk_bf16_f32 v105, v106, v107
  v_mfma_f32_16x16x32_bf16 a[32:35], a[176:179], v[0:3], a[32:35]
  v_exp_f32 v112, v112
  v_mfma_f32_16x16x32_bf16 a[32:35], a[180:183], v[32:35], a[32:35]
  ds_read_b64_tr_b16 a[168:169], v221 offset:32768
  v_lshrrev_b32 v226, 3, v224
  v_mfma_f32_16x16x32_bf16 a[36:39], a[180:183], v[40:43], a[36:39]
  v_exp_f32 v113, v113
  v_mfma_f32_16x16x32_bf16 a[36:39], a[176:179], v[8:11], a[36:39]
  ds_read_b64_tr_b16 a[170:171], v221 offset:36864
  v_cvt_pk_bf16_f32 v112, v112, v113
  v_mfma_f32_16x16x32_bf16 a[40:43], a[176:179], v[16:19], a[40:43]
  v_exp_f32 v114, v114
  v_mfma_f32_16x16x32_bf16 a[40:43], a[180:183], v[48:51], a[40:43]
  ds_read_b64_tr_b16 a[172:173], v221 offset:40960
  v_lshl_add_u32 v225, v226, 4, v225
  v_mfma_f32_16x16x32_bf16 a[44:47], a[180:183], v[56:59], a[44:47]
  s_waitcnt lgkmcnt(7)
  v_exp_f32 v115, v115
  v_mfma_f32_16x16x32_bf16 a[44:47], a[176:179], v[24:27], a[44:47]
  ds_read_b64_tr_b16 a[174:175], v221 offset:45056
  v_cvt_pk_bf16_f32 v113, v114, v115
  v_mfma_f32_16x16x32_bf16 a[48:51], a[184:187], v[0:3], a[48:51]
  v_exp_f32 v120, v120
  v_mfma_f32_16x16x32_bf16 a[48:51], a[188:191], v[32:35], a[48:51]
  ds_read_b64_tr_b16 a[176:177], v222 offset:32768
  v_and_b32 v227, 3, v224
  v_mfma_f32_16x16x32_bf16 a[52:55], a[188:191], v[40:43], a[52:55]
  v_exp_f32 v121, v121
  v_mfma_f32_16x16x32_bf16 a[52:55], a[184:187], v[8:11], a[52:55]
  ds_read_b64_tr_b16 a[178:179], v222 offset:36864
  v_cvt_pk_bf16_f32 v120, v120, v121
  v_mfma_f32_16x16x32_bf16 a[56:59], a[184:187], v[16:19], a[56:59]
  v_exp_f32 v122, v122
  v_mfma_f32_16x16x32_bf16 a[56:59], a[188:191], v[48:51], a[56:59]
  ds_read_b64_tr_b16 a[180:181], v222 offset:40960
  v_lshl_add_u32 v225, v227, 2, v225
  v_mfma_f32_16x16x32_bf16 a[60:63], a[188:191], v[56:59], a[60:63]
  s_waitcnt lgkmcnt(7)
  v_exp_f32 v123, v123
  v_mfma_f32_16x16x32_bf16 a[60:63], a[184:187], v[24:27], a[60:63]
  ds_read_b64_tr_b16 a[182:183], v222 offset:45056
  v_cvt_pk_bf16_f32 v121, v122, v123
  v_mfma_f32_16x16x32_bf16 a[64:67], a[160:163], v[0:3], a[64:67]
  v_exp_f32 v100, v100
  v_mfma_f32_16x16x32_bf16 a[64:67], a[164:167], v[32:35], a[64:67]
  ds_read_b64_tr_b16 a[184:185], v223 offset:32768
  v_add_u32 v225, 159744, v225
  v_mfma_f32_16x16x32_bf16 a[68:71], a[164:167], v[40:43], a[68:71]
  v_exp_f32 v101, v101
  v_mfma_f32_16x16x32_bf16 a[68:71], a[160:163], v[8:11], a[68:71]
  ds_read_b64_tr_b16 a[186:187], v223 offset:36864
  v_cvt_pk_bf16_f32 v98, v100, v101
  v_mfma_f32_16x16x32_bf16 a[72:75], a[160:163], v[16:19], a[72:75]
  v_exp_f32 v102, v102
  v_mfma_f32_16x16x32_bf16 a[72:75], a[164:167], v[48:51], a[72:75]
  ds_read_b64_tr_b16 a[188:189], v223 offset:40960
  v_mfma_f32_16x16x32_bf16 a[76:79], a[164:167], v[56:59], a[76:79]
  s_waitcnt lgkmcnt(7)
  v_exp_f32 v103, v103
  v_mfma_f32_16x16x32_bf16 a[76:79], a[160:163], v[24:27], a[76:79]
  ds_read_b64_tr_b16 a[190:191], v223 offset:45056
  v_cvt_pk_bf16_f32 v99, v102, v103
  v_mfma_f32_16x16x32_bf16 a[80:83], a[168:171], v[0:3], a[80:83]
  s_waitcnt vmcnt(8)
  v_exp_f32 v108, v108
  v_mfma_f32_16x16x32_bf16 a[80:83], a[172:175], v[32:35], a[80:83]
  v_mfma_f32_16x16x32_bf16 a[84:87], a[172:175], v[40:43], a[84:87]
  s_barrier
  v_exp_f32 v109, v109
  v_mfma_f32_16x16x32_bf16 a[84:87], a[168:171], v[8:11], a[84:87]
  ds_read_b128 a[128:131], v212 offset:0
  v_cvt_pk_bf16_f32 v106, v108, v109
  v_mfma_f32_16x16x32_bf16 a[88:91], a[168:171], v[16:19], a[88:91]
  v_exp_f32 v110, v110
  v_mfma_f32_16x16x32_bf16 a[88:91], a[172:175], v[48:51], a[88:91]
  ds_read_b128 a[132:135], v213 offset:0
  ds_read_b32 v228, v225 offset:0
  v_mfma_f32_16x16x32_bf16 a[92:95], a[172:175], v[56:59], a[92:95]
  s_waitcnt lgkmcnt(7)
  v_exp_f32 v111, v111
  v_mfma_f32_16x16x32_bf16 a[92:95], a[168:171], v[24:27], a[92:95]
  ds_read_b128 a[136:139], v214 offset:0
  v_cvt_pk_bf16_f32 v107, v110, v111
  v_mfma_f32_16x16x32_bf16 a[96:99], a[176:179], v[0:3], a[96:99]
  v_exp_f32 v116, v116
  v_mfma_f32_16x16x32_bf16 a[96:99], a[180:183], v[32:35], a[96:99]
  ds_read_b128 a[140:143], v215 offset:0
  ds_read_b32 v229, v225 offset:1024
  v_mfma_f32_16x16x32_bf16 a[100:103], a[180:183], v[40:43], a[100:103]
  v_exp_f32 v117, v117
  v_mfma_f32_16x16x32_bf16 a[100:103], a[176:179], v[8:11], a[100:103]
  ds_read_b32 v230, v225 offset:2048
  v_cvt_pk_bf16_f32 v114, v116, v117
  v_mfma_f32_16x16x32_bf16 a[104:107], a[176:179], v[16:19], a[104:107]
  v_exp_f32 v118, v118
  v_mfma_f32_16x16x32_bf16 a[104:107], a[180:183], v[48:51], a[104:107]
  ds_read_b32 v231, v225 offset:3072
  ds_read_b32 v238, v225 offset:512
  v_mfma_f32_16x16x32_bf16 a[108:111], a[180:183], v[56:59], a[108:111]
  s_waitcnt lgkmcnt(9)
  v_exp_f32 v119, v119
  v_mfma_f32_16x16x32_bf16 a[108:111], a[176:179], v[24:27], a[108:111]
  ds_read_b32 v239, v225 offset:1536
  v_cvt_pk_bf16_f32 v115, v118, v119
  v_mfma_f32_16x16x32_bf16 a[112:115], a[184:187], v[0:3], a[112:115]
  v_exp_f32 v124, v124
  v_mfma_f32_16x16x32_bf16 a[112:115], a[188:191], v[32:35], a[112:115]
  ds_read_b32 v240, v225 offset:2560
  ds_read_b32 v241, v225 offset:3584
  s_cmp_eq_u32 s3, 0
  s_cselect_b32 s35, 0, 1073741824
  v_mfma_f32_16x16x32_bf16 a[116:119], a[188:191], v[40:43], a[116:119]
  v_exp_f32 v125, v125
  v_mfma_f32_16x16x32_bf16 a[116:119], a[184:187], v[8:11], a[116:119]
  v_cvt_pk_bf16_f32 v122, v124, v125
  v_mul_u32_u24 v226, 0xd80, v226
  v_mfma_f32_16x16x32_bf16 a[120:123], a[184:187], v[16:19], a[120:123]
  v_exp_f32 v126, v126
  v_mfma_f32_16x16x32_bf16 a[120:123], a[188:191], v[48:51], a[120:123]
  v_and_b32 v227, 7, v224
  v_lshl_add_u32 v226, v227, 1, v226
  v_mfma_f32_16x16x32_bf16 a[124:127], a[188:191], v[56:59], a[124:127]
  s_waitcnt lgkmcnt(7)
  v_exp_f32 v127, v127
  v_mfma_f32_16x16x32_bf16 a[124:127], a[184:187], v[24:27], a[124:127]
  v_cvt_pk_bf16_f32 v123, v126, v127
  v_and_b32 v227, 1, v224
  v_lshl_add_u32 v226, v227, 30, v226
  v_or_b32 v226, s35, v226
  v_min_u32 v249, 1, v224
  v_lshlrev_b32 v249, 30, v249
  v_or_b32 v249, s35, v249
  v_mov_b32 v251, v249
  v_mov_b32 v250, 1
  s_mov_b32 s47, 2818048
  s_lshl_b32 s35, s33, 4
  s_add_u32 s35, s35, 2633728
  s_waitcnt lgkmcnt(0)
  v_add_f32 v228, v228, v229
  v_add_f32 v238, v238, v239
  v_add_f32 v230, v230, v231
  v_add_f32 v240, v240, v241
  v_add_f32 v228, v228, v230
  v_add_f32 v238, v238, v240
  v_cvt_pk_bf16_f32 v228, v228, v228
  v_cvt_pk_bf16_f32 v238, v238, v238
  v_lshlrev_b32 v228, 16, v228
  v_lshlrev_b32 v238, 16, v238
  v_mul_f32 v229, 0xbfb8aa3b, v228
  v_exp_f32 v229, v229
  s_nop 0
  v_add_f32 v229, 1.0, v229
  v_rcp_f32 v229, v229
  s_nop 0
  v_mul_f32 v228, v228, v229
  v_cvt_pk_bf16_f32 v228, v228, v228
  v_lshlrev_b32 v228, 16, v228
  v_mul_f32 v228, v228, v238
  s_nop 1
  v_mov_b32_dpp v229, v228 quad_perm:[1,0,3,2] row_mask:0xf bank_mask:0xf
  v_cvt_pk_bf16_f32 v228, v228, v229
  buffer_store_dword v228, v226, s[24:27], s35 offen sc1
  s_mov_b32 s32, 6
attn_loop:
  v_mfma_f32_16x16x32_bf16 v[0:3], a[128:131], v[128:131], v[192:195]
  s_add_u32 m0, s28, 81920
  v_mfma_f32_16x16x32_bf16 v[0:3], a[132:135], v[132:135], v[0:3]
  ds_read_b128 a[144:147], v212 offset:4096
  v_mfma_f32_16x16x32_bf16 v[0:3], a[136:139], v[136:139], v[0:3]
  buffer_load_dwordx4 v236, s[16:19], s29 offen offset:0 lds
  v_mfma_f32_16x16x32_bf16 v[0:3], a[140:143], v[140:143], v[0:3]
  ds_read_b128 a[148:151], v213 offset:4096
  v_mfma_f32_16x16x32_bf16 v[8:11], a[140:143], v[156:159], v[196:199]
  buffer_load_dwordx4 v237, s[16:19], s29 offen offset:1024 lds
  v_mfma_f32_16x16x32_bf16 v[8:11], a[136:139], v[152:155], v[8:11]
  ds_read_b128 a[152:155], v214 offset:4096
  v_mfma_f32_16x16x32_bf16 v[8:11], a[132:135], v[148:151], v[8:11]
  buffer_load_dwordx4 v236, s[16:19], s29 offen offset:2048 lds
  v_mfma_f32_16x16x32_bf16 v[8:11], a[128:131], v[144:147], v[8:11]
  ds_read_b128 a[156:159], v215 offset:4096
  v_mfma_f32_16x16x32_bf16 v[16:19], a[128:131], v[160:163], v[200:203]
  v_exp_f32 v0, v0
  v_mfma_f32_16x16x32_bf16 v[16:19], a[132:135], v[164:167], v[16:19]
  buffer_load_dwordx4 v237, s[16:19], s29 offen offset:3072 lds
  v_mfma_f32_16x16x32_bf16 v[16:19], a[136:139], v[168:171], v[16:19]
  s_add_u32 s29, s29, 16384
  v_exp_f32 v1, v1
  v_mfma_f32_16x16x32_bf16 v[16:19], a[140:143], v[172:175], v[16:19]
  v_cvt_pk_bf16_f32 v0, v0, v1
  v_mfma_f32_16x16x32_bf16 v[24:27], a[140:143], v[188:191], v[204:207]
  s_add_u32 m0, s28, 32768
  v_exp_f32 v2, v2
  v_mfma_f32_16x16x32_bf16 v[24:27], a[136:139], v[184:187], v[24:27]
  buffer_load_dwordx4 v232, s[12:15], s29 offen offset:0 lds
  v_mfma_f32_16x16x32_bf16 v[24:27], a[132:135], v[180:183], v[24:27]
  s_waitcnt lgkmcnt(0)
  v_exp_f32 v3, v3
  v_mfma_f32_16x16x32_bf16 v[24:27], a[128:131], v[176:179], v[24:27]
  v_cvt_pk_bf16_f32 v1, v2, v3
  v_mfma_f32_16x16x32_bf16 v[4:7], a[144:147], v[128:131], v[192:195]
  v_exp_f32 v8, v8
  v_mfma_f32_16x16x32_bf16 v[4:7], a[148:151], v[132:135], v[4:7]
  ds_read_b128 a[128:131], v212 offset:8192
  v_mfma_f32_16x16x32_bf16 v[4:7], a[152:155], v[136:139], v[4:7]
  v_exp_f32 v9, v9
  v_mfma_f32_16x16x32_bf16 v[4:7], a[156:159], v[140:143], v[4:7]
  ds_read_b128 a[132:135], v213 offset:8192
  v_cvt_pk_bf16_f32 v8, v8, v9
  v_mfma_f32_16x16x32_bf16 v[12:15], a[156:159], v[156:159], v[196:199]
  v_exp_f32 v10, v10
  v_mfma_f32_16x16x32_bf16 v[12:15], a[152:155], v[152:155], v[12:15]
  ds_read_b128 a[136:139], v214 offset:8192
  v_mfma_f32_16x16x32_bf16 v[12:15], a[148:151], v[148:151], v[12:15]
  v_exp_f32 v11, v11
  v_mfma_f32_16x16x32_bf16 v[12:15], a[144:147], v[144:147], v[12:15]
  ds_read_b128 a[140:143], v215 offset:8192
  v_cvt_pk_bf16_f32 v9, v10, v11
  v_mfma_f32_16x16x32_bf16 v[20:23], a[144:147], v[160:163], v[200:203]
  v_exp_f32 v16, v16
  v_mfma_f32_16x16x32_bf16 v[20:23], a[148:151], v[164:167], v[20:23]
  buffer_load_dwordx4 v233, s[12:15], s29 offen offset:1024 lds
  v_mfma_f32_16x16x32_bf16 v[20:23], a[152:155], v[168:171], v[20:23]
  v_exp_f32 v17, v17
  v_mfma_f32_16x16x32_bf16 v[20:23], a[156:159], v[172:175], v[20:23]
  v_cvt_pk_bf16_f32 v16, v16, v17
  v_mfma_f32_16x16x32_bf16 v[28:31], a[156:159], v[188:191], v[204:207]
  v_exp_f32 v18, v18
  v_mfma_f32_16x16x32_bf16 v[28:31], a[152:155], v[184:187], v[28:31]
  buffer_load_dwordx4 v234, s[12:15], s29 offen offset:2048 lds
  v_mfma_f32_16x16x32_bf16 v[28:31], a[148:151], v[180:183], v[28:31]
  s_waitcnt lgkmcnt(0)
  v_exp_f32 v19, v19
  v_mfma_f32_16x16x32_bf16 v[28:31], a[144:147], v[176:179], v[28:31]
  v_cvt_pk_bf16_f32 v17, v18, v19
  v_mfma_f32_16x16x32_bf16 v[32:35], a[128:131], v[128:131], v[192:195]
  v_exp_f32 v24, v24
  v_mfma_f32_16x16x32_bf16 v[32:35], a[132:135], v[132:135], v[32:35]
  ds_read_b128 a[144:147], v212 offset:12288
  v_mfma_f32_16x16x32_bf16 v[32:35], a[136:139], v[136:139], v[32:35]
  v_exp_f32 v25, v25
  v_mfma_f32_16x16x32_bf16 v[32:35], a[140:143], v[140:143], v[32:35]
  ds_read_b128 a[148:151], v213 offset:12288
  v_cvt_pk_bf16_f32 v24, v24, v25
  v_mfma_f32_16x16x32_bf16 v[40:43], a[140:143], v[156:159], v[196:199]
  v_exp_f32 v26, v26
  v_mfma_f32_16x16x32_bf16 v[40:43], a[136:139], v[152:155], v[40:43]
  ds_read_b128 a[152:155], v214 offset:12288
  v_mfma_f32_16x16x32_bf16 v[40:43], a[132:135], v[148:151], v[40:43]
  v_exp_f32 v27, v27
  v_mfma_f32_16x16x32_bf16 v[40:43], a[128:131], v[144:147], v[40:43]
  ds_read_b128 a[156:159], v215 offset:12288
  v_cvt_pk_bf16_f32 v25, v26, v27
  v_mfma_f32_16x16x32_bf16 v[48:51], a[128:131], v[160:163], v[200:203]
  v_exp_f32 v4, v4
  v_mfma_f32_16x16x32_bf16 v[48:51], a[132:135], v[164:167], v[48:51]
  buffer_load_dwordx4 v235, s[12:15], s29 offen offset:3072 lds
  v_mfma_f32_16x16x32_bf16 v[48:51], a[136:139], v[168:171], v[48:51]
  v_exp_f32 v5, v5
  v_mfma_f32_16x16x32_bf16 v[48:51], a[140:143], v[172:175], v[48:51]
  v_cvt_pk_bf16_f32 v2, v4, v5
  v_mfma_f32_16x16x32_bf16 v[56:59], a[140:143], v[188:191], v[204:207]
  s_add_u32 m0, s50, 4096
  v_exp_f32 v6, v6
  v_mfma_f32_16x16x32_bf16 v[56:59], a[136:139], v[184:187], v[56:59]
  buffer_load_dwordx4 v208, s[20:23], s30 offen lds
  s_add_u32 s30, s30, 32
  v_mfma_f32_16x16x32_bf16 v[56:59], a[132:135], v[180:183], v[56:59]
  s_waitcnt lgkmcnt(0)
  v_exp_f32 v7, v7
  v_mfma_f32_16x16x32_bf16 v[56:59], a[128:131], v[176:179], v[56:59]
  v_cvt_pk_bf16_f32 v3, v6, v7
  v_mfma_f32_16x16x32_bf16 v[36:39], a[144:147], v[128:131], v[192:195]
  v_exp_f32 v12, v12
  v_mfma_f32_16x16x32_bf16 v[36:39], a[148:151], v[132:135], v[36:39]
  ds_read_b64_tr_b16 a[160:161], v216 offset:49152
  v_mfma_f32_16x16x32_bf16 v[36:39], a[152:155], v[136:139], v[36:39]
  v_exp_f32 v13, v13
  v_mfma_f32_16x16x32_bf16 v[36:39], a[156:159], v[140:143], v[36:39]
  ds_read_b64_tr_b16 a[162:163], v216 offset:53248
  v_cvt_pk_bf16_f32 v10, v12, v13
  v_mfma_f32_16x16x32_bf16 v[44:47], a[156:159], v[156:159], v[196:199]
  v_exp_f32 v14, v14
  v_mfma_f32_16x16x32_bf16 v[44:47], a[152:155], v[152:155], v[44:47]
  ds_read_b64_tr_b16 a[164:165], v216 offset:57344
  v_mfma_f32_16x16x32_bf16 v[44:47], a[148:151], v[148:151], v[44:47]
  v_exp_f32 v15, v15
  v_mfma_f32_16x16x32_bf16 v[44:47], a[144:147], v[144:147], v[44:47]
  ds_read_b64_tr_b16 a[166:167], v216 offset:61440
  v_cvt_pk_bf16_f32 v11, v14, v15
  v_mfma_f32_16x16x32_bf16 v[52:55], a[144:147], v[160:163], v[200:203]
  v_exp_f32 v20, v20
  v_mfma_f32_16x16x32_bf16 v[52:55], a[148:151], v[164:167], v[52:55]
  ds_read_b64_tr_b16 a[168:169], v217 offset:49152
  v_mfma_f32_16x16x32_bf16 v[52:55], a[152:155], v[168:171], v[52:55]
  v_exp_f32 v21, v21
  v_mfma_f32_16x16x32_bf16 v[52:55], a[156:159], v[172:175], v[52:55]
  ds_read_b64_tr_b16 a[170:171], v217 offset:53248
  v_cvt_pk_bf16_f32 v18, v20, v21
  v_mfma_f32_16x16x32_bf16 v[60:63], a[156:159], v[188:191], v[204:207]
  v_exp_f32 v22, v22
  v_mfma_f32_16x16x32_bf16 v[60:63], a[152:155], v[184:187], v[60:63]
  ds_read_b64_tr_b16 a[172:173], v217 offset:57344
  v_mfma_f32_16x16x32_bf16 v[60:63], a[148:151], v[180:183], v[60:63]
  v_exp_f32 v23, v23
  v_mfma_f32_16x16x32_bf16 v[60:63], a[144:147], v[176:179], v[60:63]
  ds_read_b64_tr_b16 a[174:175], v217 offset:61440
  v_cvt_pk_bf16_f32 v19, v22, v23
  v_mfma_f32_16x16x32_bf16 a[192:195], a[208:211], v[64:67], a[192:195]
  v_exp_f32 v28, v28
  v_mfma_f32_16x16x32_bf16 a[192:195], a[208:211], v[96:99], a[192:195]
  ds_read_b64_tr_b16 a[176:177], v218 offset:49152
  v_mfma_f32_16x16x32_bf16 a[196:199], a[208:211], v[72:75], a[196:199]
  v_exp_f32 v29, v29
  v_mfma_f32_16x16x32_bf16 a[196:199], a[208:211], v[104:107], a[196:199]
  ds_read_b64_tr_b16 a[178:179], v218 offset:53248
  v_cvt_pk_bf16_f32 v26, v28, v29
  v_mfma_f32_16x16x32_bf16 a[200:203], a[208:211], v[80:83], a[200:203]
  v_exp_f32 v30, v30
  v_mfma_f32_16x16x32_bf16 a[200:203], a[208:211], v[112:115], a[200:203]
  ds_read_b64_tr_b16 a[180:181], v218 offset:57344
  v_mfma_f32_16x16x32_bf16 a[204:207], a[208:211], v[88:91], a[204:207]
  s_waitcnt lgkmcnt(7)
  v_exp_f32 v31, v31
  v_mfma_f32_16x16x32_bf16 a[204:207], a[208:211], v[120:123], a[204:207]
  ds_read_b64_tr_b16 a[182:183], v218 offset:61440
  v_cvt_pk_bf16_f32 v27, v30, v31
  v_mfma_f32_16x16x32_bf16 a[0:3], a[160:163], v[64:67], a[0:3]
  v_exp_f32 v32, v32
  v_mfma_f32_16x16x32_bf16 a[0:3], a[164:167], v[96:99], a[0:3]
  ds_read_b64_tr_b16 a[184:185], v219 offset:49152
  v_mfma_f32_16x16x32_bf16 a[4:7], a[164:167], v[104:107], a[4:7]
  v_exp_f32 v33, v33
  v_mfma_f32_16x16x32_bf16 a[4:7], a[160:163], v[72:75], a[4:7]
  ds_read_b64_tr_b16 a[186:187], v219 offset:53248
  v_cvt_pk_bf16_f32 v32, v32, v33
  v_mfma_f32_16x16x32_bf16 a[8:11], a[160:163], v[80:83], a[8:11]
  v_exp_f32 v34, v34
  v_mfma_f32_16x16x32_bf16 a[8:11], a[164:167], v[112:115], a[8:11]
  ds_read_b64_tr_b16 a[188:189], v219 offset:57344
  v_mfma_f32_16x16x32_bf16 a[12:15], a[164:167], v[120:123], a[12:15]
  s_waitcnt lgkmcnt(7)
  v_exp_f32 v35, v35
  v_mfma_f32_16x16x32_bf16 a[12:15], a[160:163], v[88:91], a[12:15]
  ds_read_b64_tr_b16 a[190:191], v219 offset:61440
  v_cvt_pk_bf16_f32 v33, v34, v35
  v_mfma_f32_16x16x32_bf16 a[16:19], a[168:171], v[64:67], a[16:19]
  v_exp_f32 v40, v40
  v_mfma_f32_16x16x32_bf16 a[16:19], a[172:175], v[96:99], a[16:19]
  ds_read_b64_tr_b16 a[160:161], v220 offset:49152
  v_mfma_f32_16x16x32_bf16 a[20:23], a[172:175], v[104:107], a[20:23]
  v_exp_f32 v41, v41
  v_mfma_f32_16x16x32_bf16 a[20:23], a[168:171], v[72:75], a[20:23]
  ds_read_b64_tr_b16 a[162:163], v220 offset:53248
  v_cvt_pk_bf16_f32 v40, v40, v41
  v_mfma_f32_16x16x32_bf16 a[24:27], a[168:171], v[80:83], a[24:27]
  v_exp_f32 v42, v42
  v_mfma_f32_16x16x32_bf16 a[24:27], a[172:175], v[112:115], a[24:27]
  ds_read_b64_tr_b16 a[164:165], v220 offset:57344
  v_mfma_f32_16x16x32_bf16 a[28:31], a[172:175], v[120:123], a[28:31]
  s_waitcnt lgkmcnt(7)
  v_exp_f32 v43, v43
  v_mfma_f32_16x16x32_bf16 a[28:31], a[168:171], v[88:91], a[28:31]
  ds_read_b64_tr_b16 a[166:167], v220 offset:61440
  v_cvt_pk_bf16_f32 v41, v42, v43
  v_mfma_f32_16x16x32_bf16 a[32:35], a[176:179], v[64:67], a[32:35]
  v_exp_f32 v48, v48
  v_mfma_f32_16x16x32_bf16 a[32:35], a[180:183], v[96:99], a[32:35]
  ds_read_b64_tr_b16 a[168:169], v221 offset:49152
  v_mfma_f32_16x16x32_bf16 a[36:39], a[180:183], v[104:107], a[36:39]
  v_exp_f32 v49, v49
  v_mfma_f32_16x16x32_bf16 a[36:39], a[176:179], v[72:75], a[36:39]
  ds_read_b64_tr_b16 a[170:171], v221 offset:53248
  v_cvt_pk_bf16_f32 v48, v48, v49
  v_mfma_f32_16x16x32_bf16 a[40:43], a[176:179], v[80:83], a[40:43]
  v_exp_f32 v50, v50
  v_mfma_f32_16x16x32_bf16 a[40:43], a[180:183], v[112:115], a[40:43]
  ds_read_b64_tr_b16 a[172:173], v221 offset:57344
  v_mfma_f32_16x16x32_bf16 a[44:47], a[180:183], v[120:123], a[44:47]
  s_waitcnt lgkmcnt(7)
  v_exp_f32 v51, v51
  v_mfma_f32_16x16x32_bf16 a[44:47], a[176:179], v[88:91], a[44:47]
  ds_read_b64_tr_b16 a[174:175], v221 offset:61440
  v_cvt_pk_bf16_f32 v49, v50, v51
  v_mfma_f32_16x16x32_bf16 a[48:51], a[184:187], v[64:67], a[48:51]
  v_exp_f32 v56, v56
  v_mfma_f32_16x16x32_bf16 a[48:51], a[188:191], v[96:99], a[48:51]
  ds_read_b64_tr_b16 a[176:177], v222 offset:49152
  v_mfma_f32_16x16x32_bf16 a[52:55], a[188:191], v[104:107], a[52:55]
  v_exp_f32 v57, v57
  v_mfma_f32_16x16x32_bf16 a[52:55], a[184:187], v[72:75], a[52:55]
  ds_read_b64_tr_b16 a[178:179], v222 offset:53248
  v_cvt_pk_bf16_f32 v56, v56, v57
  v_mfma_f32_16x16x32_bf16 a[56:59], a[184:187], v[80:83], a[56:59]
  v_exp_f32 v58, v58
  v_mfma_f32_16x16x32_bf16 a[56:59], a[188:191], v[112:115], a[56:59]
  ds_read_b64_tr_b16 a[180:181], v222 offset:57344
  v_mfma_f32_16x16x32_bf16 a[60:63], a[188:191], v[120:123], a[60:63]
  s_waitcnt lgkmcnt(7)
  v_exp_f32 v59, v59
  v_mfma_f32_16x16x32_bf16 a[60:63], a[184:187], v[88:91], a[60:63]
  ds_read_b64_tr_b16 a[182:183], v222 offset:61440
  v_cvt_pk_bf16_f32 v57, v58, v59
  v_mfma_f32_16x16x32_bf16 a[64:67], a[160:163], v[64:67], a[64:67]
  v_exp_f32 v36, v36
  v_mfma_f32_16x16x32_bf16 a[64:67], a[164:167], v[96:99], a[64:67]
  ds_read_b64_tr_b16 a[184:185], v223 offset:49152
  v_mfma_f32_16x16x32_bf16 a[68:71], a[164:167], v[104:107], a[68:71]
  v_exp_f32 v37, v37
  v_mfma_f32_16x16x32_bf16 a[68:71], a[160:163], v[72:75], a[68:71]
  ds_read_b64_tr_b16 a[186:187], v223 offset:53248
  v_cvt_pk_bf16_f32 v34, v36, v37
  v_mfma_f32_16x16x32_bf16 a[72:75], a[160:163], v[80:83], a[72:75]
  v_exp_f32 v38, v38
  v_mfma_f32_16x16x32_bf16 a[72:75], a[164:167], v[112:115], a[72:75]
  ds_read_b64_tr_b16 a[188:189], v223 offset:57344
  v_mfma_f32_16x16x32_bf16 a[76:79], a[164:167], v[120:123], a[76:79]
  s_waitcnt lgkmcnt(7)
  v_exp_f32 v39, v39
  v_mfma_f32_16x16x32_bf16 a[76:79], a[160:163], v[88:91], a[76:79]
  ds_read_b64_tr_b16 a[190:191], v223 offset:61440
  v_cvt_pk_bf16_f32 v35, v38, v39
  v_mfma_f32_16x16x32_bf16 a[80:83], a[168:171], v[64:67], a[80:83]
  s_waitcnt vmcnt(10)
  v_exp_f32 v44, v44
  v_mfma_f32_16x16x32_bf16 a[80:83], a[172:175], v[96:99], a[80:83]
  v_mfma_f32_16x16x32_bf16 a[84:87], a[172:175], v[104:107], a[84:87]
  s_barrier
  v_exp_f32 v45, v45
  v_mfma_f32_16x16x32_bf16 a[84:87], a[168:171], v[72:75], a[84:87]
  ds_read_b128 a[128:131], v212 offset:16384
  v_cvt_pk_bf16_f32 v42, v44, v45
  v_mfma_f32_16x16x32_bf16 a[88:91], a[168:171], v[80:83], a[88:91]
  v_exp_f32 v46, v46
  v_mfma_f32_16x16x32_bf16 a[88:91], a[172:175], v[112:115], a[88:91]
  ds_read_b128 a[132:135], v213 offset:16384
  v_mfma_f32_16x16x32_bf16 a[92:95], a[172:175], v[120:123], a[92:95]
  s_waitcnt lgkmcnt(6)
  v_exp_f32 v47, v47
  v_mfma_f32_16x16x32_bf16 a[92:95], a[168:171], v[88:91], a[92:95]
  ds_read_b128 a[136:139], v214 offset:16384
  v_cvt_pk_bf16_f32 v43, v46, v47
  v_mfma_f32_16x16x32_bf16 a[96:99], a[176:179], v[64:67], a[96:99]
  v_exp_f32 v52, v52
  v_mfma_f32_16x16x32_bf16 a[96:99], a[180:183], v[96:99], a[96:99]
  ds_read_b128 a[140:143], v215 offset:16384
  v_mfma_f32_16x16x32_bf16 a[100:103], a[180:183], v[104:107], a[100:103]
  v_exp_f32 v53, v53
  v_mfma_f32_16x16x32_bf16 a[100:103], a[176:179], v[72:75], a[100:103]
  v_cvt_pk_bf16_f32 v50, v52, v53
  v_mfma_f32_16x16x32_bf16 a[104:107], a[176:179], v[80:83], a[104:107]
  v_exp_f32 v54, v54
  v_mfma_f32_16x16x32_bf16 a[104:107], a[180:183], v[112:115], a[104:107]
  v_mfma_f32_16x16x32_bf16 a[108:111], a[180:183], v[120:123], a[108:111]
  s_waitcnt lgkmcnt(4)
  v_exp_f32 v55, v55
  v_mfma_f32_16x16x32_bf16 a[108:111], a[176:179], v[88:91], a[108:111]
  v_cvt_pk_bf16_f32 v51, v54, v55
  v_mfma_f32_16x16x32_bf16 a[112:115], a[184:187], v[64:67], a[112:115]
  v_exp_f32 v60, v60
  v_mfma_f32_16x16x32_bf16 a[112:115], a[188:191], v[96:99], a[112:115]
  v_mfma_f32_16x16x32_bf16 a[116:119], a[188:191], v[104:107], a[116:119]
  v_exp_f32 v61, v61
  v_mfma_f32_16x16x32_bf16 a[116:119], a[184:187], v[72:75], a[116:119]
  v_cvt_pk_bf16_f32 v58, v60, v61
  v_mfma_f32_16x16x32_bf16 a[120:123], a[184:187], v[80:83], a[120:123]
  v_exp_f32 v62, v62
  v_mfma_f32_16x16x32_bf16 a[120:123], a[188:191], v[112:115], a[120:123]
  v_mfma_f32_16x16x32_bf16 a[124:127], a[188:191], v[120:123], a[124:127]
  s_waitcnt lgkmcnt(0)
  v_exp_f32 v63, v63
  v_mfma_f32_16x16x32_bf16 a[124:127], a[184:187], v[88:91], a[124:127]
  v_cvt_pk_bf16_f32 v59, v62, v63
  v_mfma_f32_16x16x32_bf16 v[64:67], a[128:131], v[128:131], v[192:195]
  s_add_u32 m0, s28, 98304
  v_mfma_f32_16x16x32_bf16 v[64:67], a[132:135], v[132:135], v[64:67]
  ds_read_b128 a[144:147], v212 offset:20480
  v_mfma_f32_16x16x32_bf16 v[64:67], a[136:139], v[136:139], v[64:67]
  buffer_load_dwordx4 v236, s[16:19], s29 offen offset:0 lds
  v_mfma_f32_16x16x32_bf16 v[64:67], a[140:143], v[140:143], v[64:67]
  ds_read_b128 a[148:151], v213 offset:20480
  v_mfma_f32_16x16x32_bf16 v[72:75], a[140:143], v[156:159], v[196:199]
  buffer_load_dwordx4 v237, s[16:19], s29 offen offset:1024 lds
  v_mfma_f32_16x16x32_bf16 v[72:75], a[136:139], v[152:155], v[72:75]
  ds_read_b128 a[152:155], v214 offset:20480
  v_mfma_f32_16x16x32_bf16 v[72:75], a[132:135], v[148:151], v[72:75]
  buffer_load_dwordx4 v236, s[16:19], s29 offen offset:2048 lds
  v_mfma_f32_16x16x32_bf16 v[72:75], a[128:131], v[144:147], v[72:75]
  ds_read_b128 a[156:159], v215 offset:20480
  v_mfma_f32_16x16x32_bf16 v[80:83], a[128:131], v[160:163], v[200:203]
  v_exp_f32 v64, v64
  v_mfma_f32_16x16x32_bf16 v[80:83], a[132:135], v[164:167], v[80:83]
  buffer_load_dwordx4 v237, s[16:19], s29 offen offset:3072 lds
  v_mfma_f32_16x16x32_bf16 v[80:83], a[136:139], v[168:171], v[80:83]
  s_add_u32 s29, s29, 16384
  v_exp_f32 v65, v65
  v_mfma_f32_16x16x32_bf16 v[80:83], a[140:143], v[172:175], v[80:83]
  v_cvt_pk_bf16_f32 v64, v64, v65
  v_mfma_f32_16x16x32_bf16 v[88:91], a[140:143], v[188:191], v[204:207]
  s_add_u32 m0, s28, 49152
  v_exp_f32 v66, v66
  v_mfma_f32_16x16x32_bf16 v[88:91], a[136:139], v[184:187], v[88:91]
  buffer_load_dwordx4 v232, s[12:15], s29 offen offset:0 lds
  v_mfma_f32_16x16x32_bf16 v[88:91], a[132:135], v[180:183], v[88:91]
  s_waitcnt lgkmcnt(0)
  v_exp_f32 v67, v67
  v_mfma_f32_16x16x32_bf16 v[88:91], a[128:131], v[176:179], v[88:91]
  v_cvt_pk_bf16_f32 v65, v66, v67
  v_mfma_f32_16x16x32_bf16 v[68:71], a[144:147], v[128:131], v[192:195]
  v_exp_f32 v72, v72
  v_mfma_f32_16x16x32_bf16 v[68:71], a[148:151], v[132:135], v[68:71]
  ds_read_b128 a[128:131], v212 offset:24576
  v_mfma_f32_16x16x32_bf16 v[68:71], a[152:155], v[136:139], v[68:71]
  v_exp_f32 v73, v73
  v_mfma_f32_16x16x32_bf16 v[68:71], a[156:159], v[140:143], v[68:71]
  ds_read_b128 a[132:135], v213 offset:24576
  v_cvt_pk_bf16_f32 v72, v72, v73
  v_mfma_f32_16x16x32_bf16 v[76:79], a[156:159], v[156:159], v[196:199]
  v_exp_f32 v74, v74
  v_mfma_f32_16x16x32_bf16 v[76:79], a[152:155], v[152:155], v[76:79]
  ds_read_b128 a[136:139], v214 offset:24576
  v_mfma_f32_16x16x32_bf16 v[76:79], a[148:151], v[148:151], v[76:79]
  v_exp_f32 v75, v75
  v_mfma_f32_16x16x32_bf16 v[76:79], a[144:147], v[144:147], v[76:79]
  ds_read_b128 a[140:143], v215 offset:24576
  v_cvt_pk_bf16_f32 v73, v74, v75
  v_mfma_f32_16x16x32_bf16 v[84:87], a[144:147], v[160:163], v[200:203]
  v_exp_f32 v80, v80
  v_mfma_f32_16x16x32_bf16 v[84:87], a[148:151], v[164:167], v[84:87]
  buffer_load_dwordx4 v233, s[12:15], s29 offen offset:1024 lds
  v_mfma_f32_16x16x32_bf16 v[84:87], a[152:155], v[168:171], v[84:87]
  v_exp_f32 v81, v81
  v_mfma_f32_16x16x32_bf16 v[84:87], a[156:159], v[172:175], v[84:87]
  v_cvt_pk_bf16_f32 v80, v80, v81
  v_mfma_f32_16x16x32_bf16 v[92:95], a[156:159], v[188:191], v[204:207]
  v_exp_f32 v82, v82
  v_mfma_f32_16x16x32_bf16 v[92:95], a[152:155], v[184:187], v[92:95]
  buffer_load_dwordx4 v234, s[12:15], s29 offen offset:2048 lds
  v_mfma_f32_16x16x32_bf16 v[92:95], a[148:151], v[180:183], v[92:95]
  s_waitcnt lgkmcnt(0)
  v_exp_f32 v83, v83
  v_mfma_f32_16x16x32_bf16 v[92:95], a[144:147], v[176:179], v[92:95]
  v_cvt_pk_bf16_f32 v81, v82, v83
  v_mfma_f32_16x16x32_bf16 v[96:99], a[128:131], v[128:131], v[192:195]
  v_exp_f32 v88, v88
  v_mfma_f32_16x16x32_bf16 v[96:99], a[132:135], v[132:135], v[96:99]
  ds_read_b128 a[144:147], v212 offset:28672
  v_mfma_f32_16x16x32_bf16 v[96:99], a[136:139], v[136:139], v[96:99]
  v_exp_f32 v89, v89
  v_mfma_f32_16x16x32_bf16 v[96:99], a[140:143], v[140:143], v[96:99]
  ds_read_b128 a[148:151], v213 offset:28672
  v_cvt_pk_bf16_f32 v88, v88, v89
  v_mfma_f32_16x16x32_bf16 v[104:107], a[140:143], v[156:159], v[196:199]
  v_exp_f32 v90, v90
  v_mfma_f32_16x16x32_bf16 v[104:107], a[136:139], v[152:155], v[104:107]
  ds_read_b128 a[152:155], v214 offset:28672
  v_mfma_f32_16x16x32_bf16 v[104:107], a[132:135], v[148:151], v[104:107]
  v_exp_f32 v91, v91
  v_mfma_f32_16x16x32_bf16 v[104:107], a[128:131], v[144:147], v[104:107]
  ds_read_b128 a[156:159], v215 offset:28672
  v_cvt_pk_bf16_f32 v89, v90, v91
  v_mfma_f32_16x16x32_bf16 v[112:115], a[128:131], v[160:163], v[200:203]
  v_exp_f32 v68, v68
  v_mfma_f32_16x16x32_bf16 v[112:115], a[132:135], v[164:167], v[112:115]
  buffer_load_dwordx4 v235, s[12:15], s29 offen offset:3072 lds
  v_mfma_f32_16x16x32_bf16 v[112:115], a[136:139], v[168:171], v[112:115]
  v_exp_f32 v69, v69
  v_mfma_f32_16x16x32_bf16 v[112:115], a[140:143], v[172:175], v[112:115]
  v_cvt_pk_bf16_f32 v66, v68, v69
  v_mfma_f32_16x16x32_bf16 v[120:123], a[140:143], v[188:191], v[204:207]
  s_add_u32 m0, s50, 5120
  v_exp_f32 v70, v70
  v_mfma_f32_16x16x32_bf16 v[120:123], a[136:139], v[184:187], v[120:123]
  buffer_load_dwordx4 v208, s[20:23], s30 offen lds
  s_add_u32 s30, s30, 32
  v_mfma_f32_16x16x32_bf16 v[120:123], a[132:135], v[180:183], v[120:123]
  s_waitcnt lgkmcnt(0)
  v_exp_f32 v71, v71
  v_mfma_f32_16x16x32_bf16 v[120:123], a[128:131], v[176:179], v[120:123]
  v_cvt_pk_bf16_f32 v67, v70, v71
  v_mfma_f32_16x16x32_bf16 v[100:103], a[144:147], v[128:131], v[192:195]
  v_exp_f32 v76, v76
  v_mfma_f32_16x16x32_bf16 v[100:103], a[148:151], v[132:135], v[100:103]
  ds_read_b64_tr_b16 a[160:161], v216 offset:0
  v_mfma_f32_16x16x32_bf16 v[100:103], a[152:155], v[136:139], v[100:103]
  v_exp_f32 v77, v77
  v_mfma_f32_16x16x32_bf16 v[100:103], a[156:159], v[140:143], v[100:103]
  ds_read_b64_tr_b16 a[162:163], v216 offset:4096
  v_cvt_pk_bf16_f32 v74, v76, v77
  v_mfma_f32_16x16x32_bf16 v[108:111], a[156:159], v[156:159], v[196:199]
  v_exp_f32 v78, v78
  v_mfma_f32_16x16x32_bf16 v[108:111], a[152:155], v[152:155], v[108:111]
  ds_read_b64_tr_b16 a[164:165], v216 offset:8192
  v_mfma_f32_16x16x32_bf16 v[108:111], a[148:151], v[148:151], v[108:111]
  v_exp_f32 v79, v79
  v_mfma_f32_16x16x32_bf16 v[108:111], a[144:147], v[144:147], v[108:111]
  ds_read_b64_tr_b16 a[166:167], v216 offset:12288
  v_cvt_pk_bf16_f32 v75, v78, v79
  v_mfma_f32_16x16x32_bf16 v[116:119], a[144:147], v[160:163], v[200:203]
  v_exp_f32 v84, v84
  v_mfma_f32_16x16x32_bf16 v[116:119], a[148:151], v[164:167], v[116:119]
  ds_read_b64_tr_b16 a[168:169], v217 offset:0
  v_mfma_f32_16x16x32_bf16 v[116:119], a[152:155], v[168:171], v[116:119]
  v_exp_f32 v85, v85
  v_mfma_f32_16x16x32_bf16 v[116:119], a[156:159], v[172:175], v[116:119]
  ds_read_b64_tr_b16 a[170:171], v217 offset:4096
  v_cvt_pk_bf16_f32 v82, v84, v85
  v_mfma_f32_16x16x32_bf16 v[124:127], a[156:159], v[188:191], v[204:207]
  v_exp_f32 v86, v86
  v_mfma_f32_16x16x32_bf16 v[124:127], a[152:155], v[184:187], v[124:127]
  ds_read_b64_tr_b16 a[172:173], v217 offset:8192
  v_mfma_f32_16x16x32_bf16 v[124:127], a[148:151], v[180:183], v[124:127]
  v_exp_f32 v87, v87
  v_mfma_f32_16x16x32_bf16 v[124:127], a[144:147], v[176:179], v[124:127]
  ds_read_b64_tr_b16 a[174:175], v217 offset:12288
  v_cvt_pk_bf16_f32 v83, v86, v87
  v_mfma_f32_16x16x32_bf16 a[192:195], a[208:211], v[0:3], a[192:195]
  v_exp_f32 v92, v92
  v_mfma_f32_16x16x32_bf16 a[192:195], a[208:211], v[32:35], a[192:195]
  ds_read_b64_tr_b16 a[176:177], v218 offset:0
  v_mfma_f32_16x16x32_bf16 a[196:199], a[208:211], v[8:11], a[196:199]
  v_exp_f32 v93, v93
  v_mfma_f32_16x16x32_bf16 a[196:199], a[208:211], v[40:43], a[196:199]
  ds_read_b64_tr_b16 a[178:179], v218 offset:4096
  v_cvt_pk_bf16_f32 v90, v92, v93
  v_mfma_f32_16x16x32_bf16 a[200:203], a[208:211], v[16:19], a[200:203]
  v_exp_f32 v94, v94
  v_mfma_f32_16x16x32_bf16 a[200:203], a[208:211], v[48:51], a[200:203]
  ds_read_b64_tr_b16 a[180:181], v218 offset:8192
  v_mfma_f32_16x16x32_bf16 a[204:207], a[208:211], v[24:27], a[204:207]
  s_waitcnt lgkmcnt(7)
  v_exp_f32 v95, v95
  v_mfma_f32_16x16x32_bf16 a[204:207], a[208:211], v[56:59], a[204:207]
  ds_read_b64_tr_b16 a[182:183], v218 offset:12288
  v_cvt_pk_bf16_f32 v91, v94, v95
  v_mfma_f32_16x16x32_bf16 a[0:3], a[160:163], v[0:3], a[0:3]
  v_exp_f32 v96, v96
  v_mfma_f32_16x16x32_bf16 a[0:3], a[164:167], v[32:35], a[0:3]
  ds_read_b64_tr_b16 a[184:185], v219 offset:0
  v_mfma_f32_16x16x32_bf16 a[4:7], a[164:167], v[40:43], a[4:7]
  v_exp_f32 v97, v97
  v_mfma_f32_16x16x32_bf16 a[4:7], a[160:163], v[8:11], a[4:7]
  ds_read_b64_tr_b16 a[186:187], v219 offset:4096
  v_cvt_pk_bf16_f32 v96, v96, v97
  v_mfma_f32_16x16x32_bf16 a[8:11], a[160:163], v[16:19], a[8:11]
  v_exp_f32 v98, v98
  v_mfma_f32_16x16x32_bf16 a[8:11], a[164:167], v[48:51], a[8:11]
  ds_read_b64_tr_b16 a[188:189], v219 offset:8192
  v_mfma_f32_16x16x32_bf16 a[12:15], a[164:167], v[56:59], a[12:15]
  s_waitcnt lgkmcnt(7)
  v_exp_f32 v99, v99
  v_mfma_f32_16x16x32_bf16 a[12:15], a[160:163], v[24:27], a[12:15]
  ds_read_b64_tr_b16 a[190:191], v219 offset:12288
  v_cvt_pk_bf16_f32 v97, v98, v99
  v_mfma_f32_16x16x32_bf16 a[16:19], a[168:171], v[0:3], a[16:19]
  v_exp_f32 v104, v104
  v_mfma_f32_16x16x32_bf16 a[16:19], a[172:175], v[32:35], a[16:19]
  ds_read_b64_tr_b16 a[160:161], v220 offset:0
  v_mfma_f32_16x16x32_bf16 a[20:23], a[172:175], v[40:43], a[20:23]
  v_exp_f32 v105, v105
  v_mfma_f32_16x16x32_bf16 a[20:23], a[168:171], v[8:11], a[20:23]
  ds_read_b64_tr_b16 a[162:163], v220 offset:4096
  v_cvt_pk_bf16_f32 v104, v104, v105
  v_mfma_f32_16x16x32_bf16 a[24:27], a[168:171], v[16:19], a[24:27]
  v_exp_f32 v106, v106
  v_mfma_f32_16x16x32_bf16 a[24:27], a[172:175], v[48:51], a[24:27]
  ds_read_b64_tr_b16 a[164:165], v220 offset:8192
  v_mfma_f32_16x16x32_bf16 a[28:31], a[172:175], v[56:59], a[28:31]
  s_waitcnt lgkmcnt(7)
  v_exp_f32 v107, v107
  v_mfma_f32_16x16x32_bf16 a[28:31], a[168:171], v[24:27], a[28:31]
  ds_read_b64_tr_b16 a[166:167], v220 offset:12288
  v_cvt_pk_bf16_f32 v105, v106, v107
  v_mfma_f32_16x16x32_bf16 a[32:35], a[176:179], v[0:3], a[32:35]
  v_exp_f32 v112, v112
  v_mfma_f32_16x16x32_bf16 a[32:35], a[180:183], v[32:35], a[32:35]
  ds_read_b64_tr_b16 a[168:169], v221 offset:0
  v_mfma_f32_16x16x32_bf16 a[36:39], a[180:183], v[40:43], a[36:39]
  v_exp_f32 v113, v113
  v_mfma_f32_16x16x32_bf16 a[36:39], a[176:179], v[8:11], a[36:39]
  ds_read_b64_tr_b16 a[170:171], v221 offset:4096
  v_cvt_pk_bf16_f32 v112, v112, v113
  v_mfma_f32_16x16x32_bf16 a[40:43], a[176:179], v[16:19], a[40:43]
  v_exp_f32 v114, v114
  v_mfma_f32_16x16x32_bf16 a[40:43], a[180:183], v[48:51], a[40:43]
  ds_read_b64_tr_b16 a[172:173], v221 offset:8192
  v_mfma_f32_16x16x32_bf16 a[44:47], a[180:183], v[56:59], a[44:47]
  s_waitcnt lgkmcnt(7)
  v_exp_f32 v115, v115
  v_mfma_f32_16x16x32_bf16 a[44:47], a[176:179], v[24:27], a[44:47]
  ds_read_b64_tr_b16 a[174:175], v221 offset:12288
  v_cvt_pk_bf16_f32 v113, v114, v115
  v_mfma_f32_16x16x32_bf16 a[48:51], a[184:187], v[0:3], a[48:51]
  v_exp_f32 v120, v120
  v_mfma_f32_16x16x32_bf16 a[48:51], a[188:191], v[32:35], a[48:51]
  ds_read_b64_tr_b16 a[176:177], v222 offset:0
  v_mfma_f32_16x16x32_bf16 a[52:55], a[188:191], v[40:43], a[52:55]
  v_exp_f32 v121, v121
  v_mfma_f32_16x16x32_bf16 a[52:55], a[184:187], v[8:11], a[52:55]
  ds_read_b64_tr_b16 a[178:179], v222 offset:4096
  v_cvt_pk_bf16_f32 v120, v120, v121
  v_mfma_f32_16x16x32_bf16 a[56:59], a[184:187], v[16:19], a[56:59]
  v_exp_f32 v122, v122
  v_mfma_f32_16x16x32_bf16 a[56:59], a[188:191], v[48:51], a[56:59]
  ds_read_b64_tr_b16 a[180:181], v222 offset:8192
  v_mfma_f32_16x16x32_bf16 a[60:63], a[188:191], v[56:59], a[60:63]
  s_waitcnt lgkmcnt(7)
  v_exp_f32 v123, v123
  v_mfma_f32_16x16x32_bf16 a[60:63], a[184:187], v[24:27], a[60:63]
  ds_read_b64_tr_b16 a[182:183], v222 offset:12288
  v_cvt_pk_bf16_f32 v121, v122, v123
  v_mfma_f32_16x16x32_bf16 a[64:67], a[160:163], v[0:3], a[64:67]
  v_exp_f32 v100, v100
  v_mfma_f32_16x16x32_bf16 a[64:67], a[164:167], v[32:35], a[64:67]
  ds_read_b64_tr_b16 a[184:185], v223 offset:0
  v_mfma_f32_16x16x32_bf16 a[68:71], a[164:167], v[40:43], a[68:71]
  v_exp_f32 v101, v101
  v_mfma_f32_16x16x32_bf16 a[68:71], a[160:163], v[8:11], a[68:71]
  ds_read_b64_tr_b16 a[186:187], v223 offset:4096
  v_cvt_pk_bf16_f32 v98, v100, v101
  v_mfma_f32_16x16x32_bf16 a[72:75], a[160:163], v[16:19], a[72:75]
  v_exp_f32 v102, v102
  v_mfma_f32_16x16x32_bf16 a[72:75], a[164:167], v[48:51], a[72:75]
  ds_read_b64_tr_b16 a[188:189], v223 offset:8192
  v_mfma_f32_16x16x32_bf16 a[76:79], a[164:167], v[56:59], a[76:79]
  s_waitcnt lgkmcnt(7)
  v_exp_f32 v103, v103
  v_mfma_f32_16x16x32_bf16 a[76:79], a[160:163], v[24:27], a[76:79]
  ds_read_b64_tr_b16 a[190:191], v223 offset:12288
  v_cvt_pk_bf16_f32 v99, v102, v103
  v_mfma_f32_16x16x32_bf16 a[80:83], a[168:171], v[0:3], a[80:83]
  s_waitcnt vmcnt(10)
  v_exp_f32 v108, v108
  v_mfma_f32_16x16x32_bf16 a[80:83], a[172:175], v[32:35], a[80:83]
  v_mfma_f32_16x16x32_bf16 a[84:87], a[172:175], v[40:43], a[84:87]
  s_barrier
  v_exp_f32 v109, v109
  v_mfma_f32_16x16x32_bf16 a[84:87], a[168:171], v[8:11], a[84:87]
  ds_read_b128 a[128:131], v212 offset:32768
  v_cvt_pk_bf16_f32 v106, v108, v109
  v_mfma_f32_16x16x32_bf16 a[88:91], a[168:171], v[16:19], a[88:91]
  v_exp_f32 v110, v110
  v_mfma_f32_16x16x32_bf16 a[88:91], a[172:175], v[48:51], a[88:91]
  ds_read_b128 a[132:135], v213 offset:32768
  buffer_atomic_add v250, v249, s[24:27], s47 offen
  s_cmp_eq_u32 s32, 4
  s_cselect_b32 s39, 0, 1073741824
  v_mfma_f32_16x16x32_bf16 a[92:95], a[172:175], v[56:59], a[92:95]
  s_waitcnt lgkmcnt(6)
  v_exp_f32 v111, v111
  v_mfma_f32_16x16x32_bf16 a[92:95], a[168:171], v[24:27], a[92:95]
  ds_read_b128 a[136:139], v214 offset:32768
  v_cvt_pk_bf16_f32 v107, v110, v111
  v_mfma_f32_16x16x32_bf16 a[96:99], a[176:179], v[0:3], a[96:99]
  v_exp_f32 v116, v116
  v_mfma_f32_16x16x32_bf16 a[96:99], a[180:183], v[32:35], a[96:99]
  ds_read_b128 a[140:143], v215 offset:32768
  v_or_b32 v249, s39, v251
  v_mfma_f32_16x16x32_bf16 a[100:103], a[180:183], v[40:43], a[100:103]
  v_exp_f32 v117, v117
  v_mfma_f32_16x16x32_bf16 a[100:103], a[176:179], v[8:11], a[100:103]
  v_cvt_pk_bf16_f32 v114, v116, v117
  v_mfma_f32_16x16x32_bf16 a[104:107], a[176:179], v[16:19], a[104:107]
  v_exp_f32 v118, v118
  v_mfma_f32_16x16x32_bf16 a[104:107], a[180:183], v[48:51], a[104:107]
  v_mfma_f32_16x16x32_bf16 a[108:111], a[180:183], v[56:59], a[108:111]
  s_waitcnt lgkmcnt(4)
  v_exp_f32 v119, v119
  v_mfma_f32_16x16x32_bf16 a[108:111], a[176:179], v[24:27], a[108:111]
  v_cvt_pk_bf16_f32 v115, v118, v119
  v_mfma_f32_16x16x32_bf16 a[112:115], a[184:187], v[0:3], a[112:115]
  v_exp_f32 v124, v124
  v_mfma_f32_16x16x32_bf16 a[112:115], a[188:191], v[32:35], a[112:115]
  v_mfma_f32_16x16x32_bf16 a[116:119], a[188:191], v[40:43], a[116:119]
  v_exp_f32 v125, v125
  v_mfma_f32_16x16x32_bf16 a[116:119], a[184:187], v[8:11], a[116:119]
  v_cvt_pk_bf16_f32 v122, v124, v125
  v_mfma_f32_16x16x32_bf16 a[120:123], a[184:187], v[16:19], a[120:123]
  v_exp_f32 v126, v126
  v_mfma_f32_16x16x32_bf16 a[120:123], a[188:191], v[48:51], a[120:123]
  v_mfma_f32_16x16x32_bf16 a[124:127], a[188:191], v[56:59], a[124:127]
  s_waitcnt lgkmcnt(0)
  v_exp_f32 v127, v127
  v_mfma_f32_16x16x32_bf16 a[124:127], a[184:187], v[24:27], a[124:127]
  v_cvt_pk_bf16_f32 v123, v126, v127
  v_mfma_f32_16x16x32_bf16 v[0:3], a[128:131], v[128:131], v[192:195]
  s_add_u32 m0, s28, 114688
  v_mfma_f32_16x16x32_bf16 v[0:3], a[132:135], v[132:135], v[0:3]
  ds_read_b128 a[144:147], v212 offset:36864
  v_mfma_f32_16x16x32_bf16 v[0:3], a[136:139], v[136:139], v[0:3]
  buffer_load_dwordx4 v236, s[16:19], s29 offen offset:0 lds
  v_mfma_f32_16x16x32_bf16 v[0:3], a[140:143], v[140:143], v[0:3]
  ds_read_b128 a[148:151], v213 offset:36864
  v_mfma_f32_16x16x32_bf16 v[8:11], a[140:143], v[156:159], v[196:199]
  buffer_load_dwordx4 v237, s[16:19], s29 offen offset:1024 lds
  v_mfma_f32_16x16x32_bf16 v[8:11], a[136:139], v[152:155], v[8:11]
  ds_read_b128 a[152:155], v214 offset:36864
  v_mfma_f32_16x16x32_bf16 v[8:11], a[132:135], v[148:151], v[8:11]
  buffer_load_dwordx4 v236, s[16:19], s29 offen offset:2048 lds
  v_mfma_f32_16x16x32_bf16 v[8:11], a[128:131], v[144:147], v[8:11]
  ds_read_b128 a[156:159], v215 offset:36864
  v_mfma_f32_16x16x32_bf16 v[16:19], a[128:131], v[160:163], v[200:203]
  v_exp_f32 v0, v0
  v_mfma_f32_16x16x32_bf16 v[16:19], a[132:135], v[164:167], v[16:19]
  buffer_load_dwordx4 v237, s[16:19], s29 offen offset:3072 lds
  v_mfma_f32_16x16x32_bf16 v[16:19], a[136:139], v[168:171], v[16:19]
  s_add_u32 s29, s29, 16384
  v_exp_f32 v1, v1
  v_mfma_f32_16x16x32_bf16 v[16:19], a[140:143], v[172:175], v[16:19]
  v_cvt_pk_bf16_f32 v0, v0, v1
  v_mfma_f32_16x16x32_bf16 v[24:27], a[140:143], v[188:191], v[204:207]
  s_add_u32 m0, s28, 0
  v_exp_f32 v2, v2
  v_mfma_f32_16x16x32_bf16 v[24:27], a[136:139], v[184:187], v[24:27]
  buffer_load_dwordx4 v232, s[12:15], s29 offen offset:0 lds
  v_mfma_f32_16x16x32_bf16 v[24:27], a[132:135], v[180:183], v[24:27]
  s_waitcnt lgkmcnt(0)
  v_exp_f32 v3, v3
  v_mfma_f32_16x16x32_bf16 v[24:27], a[128:131], v[176:179], v[24:27]
  v_cvt_pk_bf16_f32 v1, v2, v3
  v_mfma_f32_16x16x32_bf16 v[4:7], a[144:147], v[128:131], v[192:195]
  v_exp_f32 v8, v8
  v_mfma_f32_16x16x32_bf16 v[4:7], a[148:151], v[132:135], v[4:7]
  ds_read_b128 a[128:131], v212 offset:40960
  v_mfma_f32_16x16x32_bf16 v[4:7], a[152:155], v[136:139], v[4:7]
  v_exp_f32 v9, v9
  v_mfma_f32_16x16x32_bf16 v[4:7], a[156:159], v[140:143], v[4:7]
  ds_read_b128 a[132:135], v213 offset:40960
  v_cvt_pk_bf16_f32 v8, v8, v9
  v_mfma_f32_16x16x32_bf16 v[12:15], a[156:159], v[156:159], v[196:199]
  v_exp_f32 v10, v10
  v_mfma_f32_16x16x32_bf16 v[12:15], a[152:155], v[152:155], v[12:15]
  ds_read_b128 a[136:139], v214 offset:40960
  v_mfma_f32_16x16x32_bf16 v[12:15], a[148:151], v[148:151], v[12:15]
  v_exp_f32 v11, v11
  v_mfma_f32_16x16x32_bf16 v[12:15], a[144:147], v[144:147], v[12:15]
  ds_read_b128 a[140:143], v215 offset:40960
  v_cvt_pk_bf16_f32 v9, v10, v11
  v_mfma_f32_16x16x32_bf16 v[20:23], a[144:147], v[160:163], v[200:203]
  v_exp_f32 v16, v16
  v_mfma_f32_16x16x32_bf16 v[20:23], a[148:151], v[164:167], v[20:23]
  buffer_load_dwordx4 v233, s[12:15], s29 offen offset:1024 lds
  v_mfma_f32_16x16x32_bf16 v[20:23], a[152:155], v[168:171], v[20:23]
  v_exp_f32 v17, v17
  v_mfma_f32_16x16x32_bf16 v[20:23], a[156:159], v[172:175], v[20:23]
  v_cvt_pk_bf16_f32 v16, v16, v17
  v_mfma_f32_16x16x32_bf16 v[28:31], a[156:159], v[188:191], v[204:207]
  v_exp_f32 v18, v18
  v_mfma_f32_16x16x32_bf16 v[28:31], a[152:155], v[184:187], v[28:31]
  buffer_load_dwordx4 v234, s[12:15], s29 offen offset:2048 lds
  v_mfma_f32_16x16x32_bf16 v[28:31], a[148:151], v[180:183], v[28:31]
  s_waitcnt lgkmcnt(0)
  v_exp_f32 v19, v19
  v_mfma_f32_16x16x32_bf16 v[28:31], a[144:147], v[176:179], v[28:31]
  v_cvt_pk_bf16_f32 v17, v18, v19
  v_mfma_f32_16x16x32_bf16 v[32:35], a[128:131], v[128:131], v[192:195]
  v_exp_f32 v24, v24
  v_mfma_f32_16x16x32_bf16 v[32:35], a[132:135], v[132:135], v[32:35]
  ds_read_b128 a[144:147], v212 offset:45056
  v_mfma_f32_16x16x32_bf16 v[32:35], a[136:139], v[136:139], v[32:35]
  v_exp_f32 v25, v25
  v_mfma_f32_16x16x32_bf16 v[32:35], a[140:143], v[140:143], v[32:35]
  ds_read_b128 a[148:151], v213 offset:45056
  v_cvt_pk_bf16_f32 v24, v24, v25
  v_mfma_f32_16x16x32_bf16 v[40:43], a[140:143], v[156:159], v[196:199]
  v_exp_f32 v26, v26
  v_mfma_f32_16x16x32_bf16 v[40:43], a[136:139], v[152:155], v[40:43]
  ds_read_b128 a[152:155], v214 offset:45056
  v_mfma_f32_16x16x32_bf16 v[40:43], a[132:135], v[148:151], v[40:43]
  v_exp_f32 v27, v27
  v_mfma_f32_16x16x32_bf16 v[40:43], a[128:131], v[144:147], v[40:43]
  ds_read_b128 a[156:159], v215 offset:45056
  v_cvt_pk_bf16_f32 v25, v26, v27
  v_mfma_f32_16x16x32_bf16 v[48:51], a[128:131], v[160:163], v[200:203]
  v_exp_f32 v4, v4
  v_mfma_f32_16x16x32_bf16 v[48:51], a[132:135], v[164:167], v[48:51]
  buffer_load_dwordx4 v235, s[12:15], s29 offen offset:3072 lds
  v_mfma_f32_16x16x32_bf16 v[48:51], a[136:139], v[168:171], v[48:51]
  v_exp_f32 v5, v5
  v_mfma_f32_16x16x32_bf16 v[48:51], a[140:143], v[172:175], v[48:51]
  v_cvt_pk_bf16_f32 v2, v4, v5
  v_mfma_f32_16x16x32_bf16 v[56:59], a[140:143], v[188:191], v[204:207]
  s_mov_b32 m0, s51
  v_exp_f32 v6, v6
  v_mfma_f32_16x16x32_bf16 v[56:59], a[136:139], v[184:187], v[56:59]
  buffer_load_dwordx4 v210, s[4:7], s100 offen lds
  s_add_u32 s100, s100, 20480
  s_add_u32 s51, s51, 512
  v_mfma_f32_16x16x32_bf16 v[56:59], a[132:135], v[180:183], v[56:59]
  s_waitcnt lgkmcnt(0)
  v_exp_f32 v7, v7
  v_mfma_f32_16x16x32_bf16 v[56:59], a[128:131], v[176:179], v[56:59]
  v_cvt_pk_bf16_f32 v3, v6, v7
  v_mfma_f32_16x16x32_bf16 v[36:39], a[144:147], v[128:131], v[192:195]
  v_exp_f32 v12, v12
  v_mfma_f32_16x16x32_bf16 v[36:39], a[148:151], v[132:135], v[36:39]
  ds_read_b64_tr_b16 a[160:161], v216 offset:16384
  v_mfma_f32_16x16x32_bf16 v[36:39], a[152:155], v[136:139], v[36:39]
  v_exp_f32 v13, v13
  v_mfma_f32_16x16x32_bf16 v[36:39], a[156:159], v[140:143], v[36:39]
  ds_read_b64_tr_b16 a[162:163], v216 offset:20480
  v_cvt_pk_bf16_f32 v10, v12, v13
  v_mfma_f32_16x16x32_bf16 v[44:47], a[156:159], v[156:159], v[196:199]
  v_exp_f32 v14, v14
  v_mfma_f32_16x16x32_bf16 v[44:47], a[152:155], v[152:155], v[44:47]
  ds_read_b64_tr_b16 a[164:165], v216 offset:24576
  v_mfma_f32_16x16x32_bf16 v[44:47], a[148:151], v[148:151], v[44:47]
  v_exp_f32 v15, v15
  v_mfma_f32_16x16x32_bf16 v[44:47], a[144:147], v[144:147], v[44:47]
  ds_read_b64_tr_b16 a[166:167], v216 offset:28672
  v_cvt_pk_bf16_f32 v11, v14, v15
  v_mfma_f32_16x16x32_bf16 v[52:55], a[144:147], v[160:163], v[200:203]
  v_exp_f32 v20, v20
  v_mfma_f32_16x16x32_bf16 v[52:55], a[148:151], v[164:167], v[52:55]
  ds_read_b64_tr_b16 a[168:169], v217 offset:16384
  v_mfma_f32_16x16x32_bf16 v[52:55], a[152:155], v[168:171], v[52:55]
  v_exp_f32 v21, v21
  v_mfma_f32_16x16x32_bf16 v[52:55], a[156:159], v[172:175], v[52:55]
  ds_read_b64_tr_b16 a[170:171], v217 offset:20480
  v_cvt_pk_bf16_f32 v18, v20, v21
  v_mfma_f32_16x16x32_bf16 v[60:63], a[156:159], v[188:191], v[204:207]
  v_exp_f32 v22, v22
  v_mfma_f32_16x16x32_bf16 v[60:63], a[152:155], v[184:187], v[60:63]
  ds_read_b64_tr_b16 a[172:173], v217 offset:24576
  v_mfma_f32_16x16x32_bf16 v[60:63], a[148:151], v[180:183], v[60:63]
  v_exp_f32 v23, v23
  v_mfma_f32_16x16x32_bf16 v[60:63], a[144:147], v[176:179], v[60:63]
  ds_read_b64_tr_b16 a[174:175], v217 offset:28672
  v_cvt_pk_bf16_f32 v19, v22, v23
  v_mfma_f32_16x16x32_bf16 a[192:195], a[208:211], v[64:67], a[192:195]
  v_exp_f32 v28, v28
  v_mfma_f32_16x16x32_bf16 a[192:195], a[208:211], v[96:99], a[192:195]
  ds_read_b64_tr_b16 a[176:177], v218 offset:16384
  v_mfma_f32_16x16x32_bf16 a[196:199], a[208:211], v[72:75], a[196:199]
  v_exp_f32 v29, v29
  v_mfma_f32_16x16x32_bf16 a[196:199], a[208:211], v[104:107], a[196:199]
  ds_read_b64_tr_b16 a[178:179], v218 offset:20480
  v_cvt_pk_bf16_f32 v26, v28, v29
  v_mfma_f32_16x16x32_bf16 a[200:203], a[208:211], v[80:83], a[200:203]
  v_exp_f32 v30, v30
  v_mfma_f32_16x16x32_bf16 a[200:203], a[208:211], v[112:115], a[200:203]
  ds_read_b64_tr_b16 a[180:181], v218 offset:24576
  v_mfma_f32_16x16x32_bf16 a[204:207], a[208:211], v[88:91], a[204:207]
  s_waitcnt lgkmcnt(7)
  v_exp_f32 v31, v31
  v_mfma_f32_16x16x32_bf16 a[204:207], a[208:211], v[120:123], a[204:207]
  ds_read_b64_tr_b16 a[182:183], v218 offset:28672
  v_cvt_pk_bf16_f32 v27, v30, v31
  v_mfma_f32_16x16x32_bf16 a[0:3], a[160:163], v[64:67], a[0:3]
  v_exp_f32 v32, v32
  v_mfma_f32_16x16x32_bf16 a[0:3], a[164:167], v[96:99], a[0:3]
  ds_read_b64_tr_b16 a[184:185], v219 offset:16384
  v_mfma_f32_16x16x32_bf16 a[4:7], a[164:167], v[104:107], a[4:7]
  v_exp_f32 v33, v33
  v_mfma_f32_16x16x32_bf16 a[4:7], a[160:163], v[72:75], a[4:7]
  ds_read_b64_tr_b16 a[186:187], v219 offset:20480
  v_cvt_pk_bf16_f32 v32, v32, v33
  v_mfma_f32_16x16x32_bf16 a[8:11], a[160:163], v[80:83], a[8:11]
  v_exp_f32 v34, v34
  v_mfma_f32_16x16x32_bf16 a[8:11], a[164:167], v[112:115], a[8:11]
  ds_read_b64_tr_b16 a[188:189], v219 offset:24576
  v_mfma_f32_16x16x32_bf16 a[12:15], a[164:167], v[120:123], a[12:15]
  s_waitcnt lgkmcnt(7)
  v_exp_f32 v35, v35
  v_mfma_f32_16x16x32_bf16 a[12:15], a[160:163], v[88:91], a[12:15]
  ds_read_b64_tr_b16 a[190:191], v219 offset:28672
  v_cvt_pk_bf16_f32 v33, v34, v35
  v_mfma_f32_16x16x32_bf16 a[16:19], a[168:171], v[64:67], a[16:19]
  v_exp_f32 v40, v40
  v_mfma_f32_16x16x32_bf16 a[16:19], a[172:175], v[96:99], a[16:19]
  ds_read_b64_tr_b16 a[160:161], v220 offset:16384
  v_mfma_f32_16x16x32_bf16 a[20:23], a[172:175], v[104:107], a[20:23]
  v_exp_f32 v41, v41
  v_mfma_f32_16x16x32_bf16 a[20:23], a[168:171], v[72:75], a[20:23]
  ds_read_b64_tr_b16 a[162:163], v220 offset:20480
  v_cvt_pk_bf16_f32 v40, v40, v41
  v_mfma_f32_16x16x32_bf16 a[24:27], a[168:171], v[80:83], a[24:27]
  v_exp_f32 v42, v42
  v_mfma_f32_16x16x32_bf16 a[24:27], a[172:175], v[112:115], a[24:27]
  ds_read_b64_tr_b16 a[164:165], v220 offset:24576
  v_mfma_f32_16x16x32_bf16 a[28:31], a[172:175], v[120:123], a[28:31]
  s_waitcnt lgkmcnt(7)
  v_exp_f32 v43, v43
  v_mfma_f32_16x16x32_bf16 a[28:31], a[168:171], v[88:91], a[28:31]
  ds_read_b64_tr_b16 a[166:167], v220 offset:28672
  v_cvt_pk_bf16_f32 v41, v42, v43
  v_mfma_f32_16x16x32_bf16 a[32:35], a[176:179], v[64:67], a[32:35]
  v_exp_f32 v48, v48
  v_mfma_f32_16x16x32_bf16 a[32:35], a[180:183], v[96:99], a[32:35]
  ds_read_b64_tr_b16 a[168:169], v221 offset:16384
  v_mfma_f32_16x16x32_bf16 a[36:39], a[180:183], v[104:107], a[36:39]
  v_exp_f32 v49, v49
  v_mfma_f32_16x16x32_bf16 a[36:39], a[176:179], v[72:75], a[36:39]
  ds_read_b64_tr_b16 a[170:171], v221 offset:20480
  v_cvt_pk_bf16_f32 v48, v48, v49
  v_mfma_f32_16x16x32_bf16 a[40:43], a[176:179], v[80:83], a[40:43]
  v_exp_f32 v50, v50
  v_mfma_f32_16x16x32_bf16 a[40:43], a[180:183], v[112:115], a[40:43]
  ds_read_b64_tr_b16 a[172:173], v221 offset:24576
  v_mfma_f32_16x16x32_bf16 a[44:47], a[180:183], v[120:123], a[44:47]
  s_waitcnt lgkmcnt(7)
  v_exp_f32 v51, v51
  v_mfma_f32_16x16x32_bf16 a[44:47], a[176:179], v[88:91], a[44:47]
  ds_read_b64_tr_b16 a[174:175], v221 offset:28672
  v_cvt_pk_bf16_f32 v49, v50, v51
  v_mfma_f32_16x16x32_bf16 a[48:51], a[184:187], v[64:67], a[48:51]
  v_exp_f32 v56, v56
  v_mfma_f32_16x16x32_bf16 a[48:51], a[188:191], v[96:99], a[48:51]
  ds_read_b64_tr_b16 a[176:177], v222 offset:16384
  v_mfma_f32_16x16x32_bf16 a[52:55], a[188:191], v[104:107], a[52:55]
  v_exp_f32 v57, v57
  v_mfma_f32_16x16x32_bf16 a[52:55], a[184:187], v[72:75], a[52:55]
  ds_read_b64_tr_b16 a[178:179], v222 offset:20480
  v_cvt_pk_bf16_f32 v56, v56, v57
  v_mfma_f32_16x16x32_bf16 a[56:59], a[184:187], v[80:83], a[56:59]
  v_exp_f32 v58, v58
  v_mfma_f32_16x16x32_bf16 a[56:59], a[188:191], v[112:115], a[56:59]
  ds_read_b64_tr_b16 a[180:181], v222 offset:24576
  v_mfma_f32_16x16x32_bf16 a[60:63], a[188:191], v[120:123], a[60:63]
  s_waitcnt lgkmcnt(7)
  v_exp_f32 v59, v59
  v_mfma_f32_16x16x32_bf16 a[60:63], a[184:187], v[88:91], a[60:63]
  ds_read_b64_tr_b16 a[182:183], v222 offset:28672
  v_cvt_pk_bf16_f32 v57, v58, v59
  v_mfma_f32_16x16x32_bf16 a[64:67], a[160:163], v[64:67], a[64:67]
  v_exp_f32 v36, v36
  v_mfma_f32_16x16x32_bf16 a[64:67], a[164:167], v[96:99], a[64:67]
  ds_read_b64_tr_b16 a[184:185], v223 offset:16384
  v_mfma_f32_16x16x32_bf16 a[68:71], a[164:167], v[104:107], a[68:71]
  v_exp_f32 v37, v37
  v_mfma_f32_16x16x32_bf16 a[68:71], a[160:163], v[72:75], a[68:71]
  ds_read_b64_tr_b16 a[186:187], v223 offset:20480
  v_cvt_pk_bf16_f32 v34, v36, v37
  v_mfma_f32_16x16x32_bf16 a[72:75], a[160:163], v[80:83], a[72:75]
  v_exp_f32 v38, v38
  v_mfma_f32_16x16x32_bf16 a[72:75], a[164:167], v[112:115], a[72:75]
  ds_read_b64_tr_b16 a[188:189], v223 offset:24576
  v_mfma_f32_16x16x32_bf16 a[76:79], a[164:167], v[120:123], a[76:79]
  s_waitcnt lgkmcnt(7)
  v_exp_f32 v39, v39
  v_mfma_f32_16x16x32_bf16 a[76:79], a[160:163], v[88:91], a[76:79]
  ds_read_b64_tr_b16 a[190:191], v223 offset:28672
  v_cvt_pk_bf16_f32 v35, v38, v39
  v_mfma_f32_16x16x32_bf16 a[80:83], a[168:171], v[64:67], a[80:83]
  s_waitcnt vmcnt(11)
  v_exp_f32 v44, v44
  v_mfma_f32_16x16x32_bf16 a[80:83], a[172:175], v[96:99], a[80:83]
  v_mfma_f32_16x16x32_bf16 a[84:87], a[172:175], v[104:107], a[84:87]
  s_barrier
  v_exp_f32 v45, v45
  v_mfma_f32_16x16x32_bf16 a[84:87], a[168:171], v[72:75], a[84:87]
  ds_read_b128 a[128:131], v212 offset:49152
  v_cvt_pk_bf16_f32 v42, v44, v45
  v_mfma_f32_16x16x32_bf16 a[88:91], a[168:171], v[80:83], a[88:91]
  v_exp_f32 v46, v46
  v_mfma_f32_16x16x32_bf16 a[88:91], a[172:175], v[112:115], a[88:91]
  ds_read_b128 a[132:135], v213 offset:49152
  ds_read_b64_tr_b16 a[232:233], v209 offset:4096
  v_mfma_f32_16x16x32_bf16 a[92:95], a[172:175], v[120:123], a[92:95]
  s_waitcnt lgkmcnt(7)
  v_exp_f32 v47, v47
  v_mfma_f32_16x16x32_bf16 a[92:95], a[168:171], v[88:91], a[92:95]
  ds_read_b128 a[136:139], v214 offset:49152
  v_cvt_pk_bf16_f32 v43, v46, v47
  v_mfma_f32_16x16x32_bf16 a[96:99], a[176:179], v[64:67], a[96:99]
  v_exp_f32 v52, v52
  v_mfma_f32_16x16x32_bf16 a[96:99], a[180:183], v[96:99], a[96:99]
  ds_read_b128 a[140:143], v215 offset:49152
  ds_read_b64_tr_b16 a[234:235], v209 offset:4608
  v_mfma_f32_16x16x32_bf16 a[100:103], a[180:183], v[104:107], a[100:103]
  v_exp_f32 v53, v53
  v_mfma_f32_16x16x32_bf16 a[100:103], a[176:179], v[72:75], a[100:103]
  v_cvt_pk_bf16_f32 v50, v52, v53
  v_mfma_f32_16x16x32_bf16 a[104:107], a[176:179], v[80:83], a[104:107]
  v_exp_f32 v54, v54
  v_mfma_f32_16x16x32_bf16 a[104:107], a[180:183], v[112:115], a[104:107]
  v_mfma_f32_16x16x32_bf16 a[108:111], a[180:183], v[120:123], a[108:111]
  s_waitcnt lgkmcnt(6)
  v_exp_f32 v55, v55
  v_mfma_f32_16x16x32_bf16 a[108:111], a[176:179], v[88:91], a[108:111]
  v_cvt_pk_bf16_f32 v51, v54, v55
  v_mfma_f32_16x16x32_bf16 a[112:115], a[184:187], v[64:67], a[112:115]
  v_exp_f32 v60, v60
  v_mfma_f32_16x16x32_bf16 a[112:115], a[188:191], v[96:99], a[112:115]
  s_waitcnt lgkmcnt(0)
  buffer_store_dwordx4 a[232:235], v211, s[24:27], s31 offen sc1
  s_add_u32 s31, s31, 1024
  s_cmp_gt_u32 s32, 4
  s_cselect_b32 s39, 0, 1073741824
  v_mfma_f32_16x16x32_bf16 a[116:119], a[188:191], v[104:107], a[116:119]
  v_exp_f32 v61, v61
  v_mfma_f32_16x16x32_bf16 a[116:119], a[184:187], v[72:75], a[116:119]
  v_cvt_pk_bf16_f32 v58, v60, v61
  v_or_b32 v211, s39, v211
  v_mfma_f32_16x16x32_bf16 a[120:123], a[184:187], v[80:83], a[120:123]
  v_exp_f32 v62, v62
  v_mfma_f32_16x16x32_bf16 a[120:123], a[188:191], v[112:115], a[120:123]
  v_or_b32 v208, s39, v208
  v_mfma_f32_16x16x32_bf16 a[124:127], a[188:191], v[120:123], a[124:127]
  v_exp_f32 v63, v63
  v_mfma_f32_16x16x32_bf16 a[124:127], a[184:187], v[88:91], a[124:127]
  v_cvt_pk_bf16_f32 v59, v62, v63
  v_mfma_f32_16x16x32_bf16 v[64:67], a[128:131], v[128:131], v[192:195]
  s_add_u32 m0, s28, 65536
  v_mfma_f32_16x16x32_bf16 v[64:67], a[132:135], v[132:135], v[64:67]
  ds_read_b128 a[144:147], v212 offset:53248
  v_mfma_f32_16x16x32_bf16 v[64:67], a[136:139], v[136:139], v[64:67]
  buffer_load_dwordx4 v236, s[16:19], s29 offen offset:0 lds
  v_mfma_f32_16x16x32_bf16 v[64:67], a[140:143], v[140:143], v[64:67]
  ds_read_b128 a[148:151], v213 offset:53248
  v_mfma_f32_16x16x32_bf16 v[72:75], a[140:143], v[156:159], v[196:199]
  buffer_load_dwordx4 v237, s[16:19], s29 offen offset:1024 lds
  v_mfma_f32_16x16x32_bf16 v[72:75], a[136:139], v[152:155], v[72:75]
  ds_read_b128 a[152:155], v214 offset:53248
  v_mfma_f32_16x16x32_bf16 v[72:75], a[132:135], v[148:151], v[72:75]
  buffer_load_dwordx4 v236, s[16:19], s29 offen offset:2048 lds
  v_mfma_f32_16x16x32_bf16 v[72:75], a[128:131], v[144:147], v[72:75]
  ds_read_b128 a[156:159], v215 offset:53248
  v_mfma_f32_16x16x32_bf16 v[80:83], a[128:131], v[160:163], v[200:203]
  v_exp_f32 v64, v64
  v_mfma_f32_16x16x32_bf16 v[80:83], a[132:135], v[164:167], v[80:83]
  buffer_load_dwordx4 v237, s[16:19], s29 offen offset:3072 lds
  v_mfma_f32_16x16x32_bf16 v[80:83], a[136:139], v[168:171], v[80:83]
  s_add_u32 s29, s29, 16384
  v_exp_f32 v65, v65
  v_mfma_f32_16x16x32_bf16 v[80:83], a[140:143], v[172:175], v[80:83]
  v_cvt_pk_bf16_f32 v64, v64, v65
  v_mfma_f32_16x16x32_bf16 v[88:91], a[140:143], v[188:191], v[204:207]
  s_add_u32 m0, s28, 16384
  v_exp_f32 v66, v66
  v_mfma_f32_16x16x32_bf16 v[88:91], a[136:139], v[184:187], v[88:91]
  buffer_load_dwordx4 v232, s[12:15], s29 offen offset:0 lds
  v_mfma_f32_16x16x32_bf16 v[88:91], a[132:135], v[180:183], v[88:91]
  s_waitcnt lgkmcnt(0)
  v_exp_f32 v67, v67
  v_mfma_f32_16x16x32_bf16 v[88:91], a[128:131], v[176:179], v[88:91]
  v_cvt_pk_bf16_f32 v65, v66, v67
  v_mfma_f32_16x16x32_bf16 v[68:71], a[144:147], v[128:131], v[192:195]
  v_exp_f32 v72, v72
  v_mfma_f32_16x16x32_bf16 v[68:71], a[148:151], v[132:135], v[68:71]
  ds_read_b128 a[128:131], v212 offset:57344
  v_mfma_f32_16x16x32_bf16 v[68:71], a[152:155], v[136:139], v[68:71]
  v_exp_f32 v73, v73
  v_mfma_f32_16x16x32_bf16 v[68:71], a[156:159], v[140:143], v[68:71]
  ds_read_b128 a[132:135], v213 offset:57344
  v_cvt_pk_bf16_f32 v72, v72, v73
  v_mfma_f32_16x16x32_bf16 v[76:79], a[156:159], v[156:159], v[196:199]
  v_exp_f32 v74, v74
  v_mfma_f32_16x16x32_bf16 v[76:79], a[152:155], v[152:155], v[76:79]
  ds_read_b128 a[136:139], v214 offset:57344
  v_mfma_f32_16x16x32_bf16 v[76:79], a[148:151], v[148:151], v[76:79]
  v_exp_f32 v75, v75
  v_mfma_f32_16x16x32_bf16 v[76:79], a[144:147], v[144:147], v[76:79]
  ds_read_b128 a[140:143], v215 offset:57344
  v_cvt_pk_bf16_f32 v73, v74, v75
  v_mfma_f32_16x16x32_bf16 v[84:87], a[144:147], v[160:163], v[200:203]
  v_exp_f32 v80, v80
  v_mfma_f32_16x16x32_bf16 v[84:87], a[148:151], v[164:167], v[84:87]
  buffer_load_dwordx4 v233, s[12:15], s29 offen offset:1024 lds
  v_mfma_f32_16x16x32_bf16 v[84:87], a[152:155], v[168:171], v[84:87]
  v_exp_f32 v81, v81
  v_mfma_f32_16x16x32_bf16 v[84:87], a[156:159], v[172:175], v[84:87]
  v_cvt_pk_bf16_f32 v80, v80, v81
  v_mfma_f32_16x16x32_bf16 v[92:95], a[156:159], v[188:191], v[204:207]
  v_exp_f32 v82, v82
  v_mfma_f32_16x16x32_bf16 v[92:95], a[152:155], v[184:187], v[92:95]
  buffer_load_dwordx4 v234, s[12:15], s29 offen offset:2048 lds
  v_mfma_f32_16x16x32_bf16 v[92:95], a[148:151], v[180:183], v[92:95]
  s_waitcnt lgkmcnt(0)
  v_exp_f32 v83, v83
  v_mfma_f32_16x16x32_bf16 v[92:95], a[144:147], v[176:179], v[92:95]
  v_cvt_pk_bf16_f32 v81, v82, v83
  v_mfma_f32_16x16x32_bf16 v[96:99], a[128:131], v[128:131], v[192:195]
  v_exp_f32 v88, v88
  v_mfma_f32_16x16x32_bf16 v[96:99], a[132:135], v[132:135], v[96:99]
  ds_read_b128 a[144:147], v212 offset:61440
  v_mfma_f32_16x16x32_bf16 v[96:99], a[136:139], v[136:139], v[96:99]
  v_exp_f32 v89, v89
  v_mfma_f32_16x16x32_bf16 v[96:99], a[140:143], v[140:143], v[96:99]
  ds_read_b128 a[148:151], v213 offset:61440
  v_cvt_pk_bf16_f32 v88, v88, v89
  v_mfma_f32_16x16x32_bf16 v[104:107], a[140:143], v[156:159], v[196:199]
  v_exp_f32 v90, v90
  v_mfma_f32_16x16x32_bf16 v[104:107], a[136:139], v[152:155], v[104:107]
  ds_read_b128 a[152:155], v214 offset:61440
  v_mfma_f32_16x16x32_bf16 v[104:107], a[132:135], v[148:151], v[104:107]
  v_exp_f32 v91, v91
  v_mfma_f32_16x16x32_bf16 v[104:107], a[128:131], v[144:147], v[104:107]
  ds_read_b128 a[156:159], v215 offset:61440
  v_cvt_pk_bf16_f32 v89, v90, v91
  v_mfma_f32_16x16x32_bf16 v[112:115], a[128:131], v[160:163], v[200:203]
  v_exp_f32 v68, v68
  v_mfma_f32_16x16x32_bf16 v[112:115], a[132:135], v[164:167], v[112:115]
  buffer_load_dwordx4 v235, s[12:15], s29 offen offset:3072 lds
  v_mfma_f32_16x16x32_bf16 v[112:115], a[136:139], v[168:171], v[112:115]
  v_exp_f32 v69, v69
  v_mfma_f32_16x16x32_bf16 v[112:115], a[140:143], v[172:175], v[112:115]
  v_cvt_pk_bf16_f32 v66, v68, v69
  v_mfma_f32_16x16x32_bf16 v[120:123], a[140:143], v[188:191], v[204:207]
  v_exp_f32 v70, v70
  v_mfma_f32_16x16x32_bf16 v[120:123], a[136:139], v[184:187], v[120:123]
  buffer_load_dword v254, off, s[24:27], s47 sc1
  v_mfma_f32_16x16x32_bf16 v[120:123], a[132:135], v[180:183], v[120:123]
  s_waitcnt lgkmcnt(0)
  v_exp_f32 v71, v71
  v_mfma_f32_16x16x32_bf16 v[120:123], a[128:131], v[176:179], v[120:123]
  v_cvt_pk_bf16_f32 v67, v70, v71
  v_mfma_f32_16x16x32_bf16 v[100:103], a[144:147], v[128:131], v[192:195]
  v_exp_f32 v76, v76
  v_mfma_f32_16x16x32_bf16 v[100:103], a[148:151], v[132:135], v[100:103]
  ds_read_b64_tr_b16 a[160:161], v216 offset:32768
  v_mfma_f32_16x16x32_bf16 v[100:103], a[152:155], v[136:139], v[100:103]
  v_exp_f32 v77, v77
  v_mfma_f32_16x16x32_bf16 v[100:103], a[156:159], v[140:143], v[100:103]
  ds_read_b64_tr_b16 a[162:163], v216 offset:36864
  v_cvt_pk_bf16_f32 v74, v76, v77
  v_mfma_f32_16x16x32_bf16 v[108:111], a[156:159], v[156:159], v[196:199]
  v_exp_f32 v78, v78
  v_mfma_f32_16x16x32_bf16 v[108:111], a[152:155], v[152:155], v[108:111]
  ds_read_b64_tr_b16 a[164:165], v216 offset:40960
  v_mfma_f32_16x16x32_bf16 v[108:111], a[148:151], v[148:151], v[108:111]
  v_exp_f32 v79, v79
  v_mfma_f32_16x16x32_bf16 v[108:111], a[144:147], v[144:147], v[108:111]
  ds_read_b64_tr_b16 a[166:167], v216 offset:45056
  v_cvt_pk_bf16_f32 v75, v78, v79
  v_mfma_f32_16x16x32_bf16 v[116:119], a[144:147], v[160:163], v[200:203]
  v_exp_f32 v84, v84
  v_mfma_f32_16x16x32_bf16 v[116:119], a[148:151], v[164:167], v[116:119]
  ds_read_b64_tr_b16 a[168:169], v217 offset:32768
  v_mfma_f32_16x16x32_bf16 v[116:119], a[152:155], v[168:171], v[116:119]
  v_exp_f32 v85, v85
  v_mfma_f32_16x16x32_bf16 v[116:119], a[156:159], v[172:175], v[116:119]
  ds_read_b64_tr_b16 a[170:171], v217 offset:36864
  v_cvt_pk_bf16_f32 v82, v84, v85
  v_mfma_f32_16x16x32_bf16 v[124:127], a[156:159], v[188:191], v[204:207]
  s_waitcnt vmcnt(20)
  v_exp_f32 v86, v86
  v_mfma_f32_16x16x32_bf16 v[124:127], a[152:155], v[184:187], v[124:127]
  ds_read_b64_tr_b16 a[172:173], v217 offset:40960
  ds_read_b64_tr_b16 a[232:233], v209 offset:5120
  v_mfma_f32_16x16x32_bf16 v[124:127], a[148:151], v[180:183], v[124:127]
  v_exp_f32 v87, v87
  v_mfma_f32_16x16x32_bf16 v[124:127], a[144:147], v[176:179], v[124:127]
  ds_read_b64_tr_b16 a[174:175], v217 offset:45056
  v_cvt_pk_bf16_f32 v83, v86, v87
  v_mfma_f32_16x16x32_bf16 a[192:195], a[208:211], v[0:3], a[192:195]
  v_exp_f32 v92, v92
  v_mfma_f32_16x16x32_bf16 a[192:195], a[208:211], v[32:35], a[192:195]
  ds_read_b64_tr_b16 a[176:177], v218 offset:32768
  ds_read_b64_tr_b16 a[234:235], v209 offset:5632
  v_mfma_f32_16x16x32_bf16 a[196:199], a[208:211], v[8:11], a[196:199]
  v_exp_f32 v93, v93
  v_mfma_f32_16x16x32_bf16 a[196:199], a[208:211], v[40:43], a[196:199]
  ds_read_b64_tr_b16 a[178:179], v218 offset:36864
  v_cvt_pk_bf16_f32 v90, v92, v93
  v_mfma_f32_16x16x32_bf16 a[200:203], a[208:211], v[16:19], a[200:203]
  v_exp_f32 v94, v94
  v_mfma_f32_16x16x32_bf16 a[200:203], a[208:211], v[48:51], a[200:203]
  ds_read_b64_tr_b16 a[180:181], v218 offset:40960
  v_mfma_f32_16x16x32_bf16 a[204:207], a[208:211], v[24:27], a[204:207]
  s_waitcnt lgkmcnt(9)
  v_exp_f32 v95, v95
  v_mfma_f32_16x16x32_bf16 a[204:207], a[208:211], v[56:59], a[204:207]
  ds_read_b64_tr_b16 a[182:183], v218 offset:45056
  v_cvt_pk_bf16_f32 v91, v94, v95
  v_mfma_f32_16x16x32_bf16 a[0:3], a[160:163], v[0:3], a[0:3]
  v_exp_f32 v96, v96
  v_mfma_f32_16x16x32_bf16 a[0:3], a[164:167], v[32:35], a[0:3]
  ds_read_b64_tr_b16 a[184:185], v219 offset:32768
  s_waitcnt lgkmcnt(4)
  buffer_store_dwordx4 a[232:235], v211, s[24:27], s31 offen sc1
  s_add_u32 s31, s31, 1024
  v_mfma_f32_16x16x32_bf16 a[4:7], a[164:167], v[40:43], a[4:7]
  v_exp_f32 v97, v97
  v_mfma_f32_16x16x32_bf16 a[4:7], a[160:163], v[8:11], a[4:7]
  ds_read_b64_tr_b16 a[186:187], v219 offset:36864
  v_cvt_pk_bf16_f32 v96, v96, v97
  v_mfma_f32_16x16x32_bf16 a[8:11], a[160:163], v[16:19], a[8:11]
  v_exp_f32 v98, v98
  v_mfma_f32_16x16x32_bf16 a[8:11], a[164:167], v[48:51], a[8:11]
  ds_read_b64_tr_b16 a[188:189], v219 offset:40960
  v_mfma_f32_16x16x32_bf16 a[12:15], a[164:167], v[56:59], a[12:15]
  v_exp_f32 v99, v99
  v_mfma_f32_16x16x32_bf16 a[12:15], a[160:163], v[24:27], a[12:15]
  ds_read_b64_tr_b16 a[190:191], v219 offset:45056
  v_cvt_pk_bf16_f32 v97, v98, v99
  v_mfma_f32_16x16x32_bf16 a[16:19], a[168:171], v[0:3], a[16:19]
  v_exp_f32 v104, v104
  v_mfma_f32_16x16x32_bf16 a[16:19], a[172:175], v[32:35], a[16:19]
  ds_read_b64_tr_b16 a[160:161], v220 offset:32768
  v_mfma_f32_16x16x32_bf16 a[20:23], a[172:175], v[40:43], a[20:23]
  v_exp_f32 v105, v105
  v_mfma_f32_16x16x32_bf16 a[20:23], a[168:171], v[8:11], a[20:23]
  ds_read_b64_tr_b16 a[162:163], v220 offset:36864
  v_cvt_pk_bf16_f32 v104, v104, v105
  v_mfma_f32_16x16x32_bf16 a[24:27], a[168:171], v[16:19], a[24:27]
  v_exp_f32 v106, v106
  v_mfma_f32_16x16x32_bf16 a[24:27], a[172:175], v[48:51], a[24:27]
  ds_read_b64_tr_b16 a[164:165], v220 offset:40960
  v_mfma_f32_16x16x32_bf16 a[28:31], a[172:175], v[56:59], a[28:31]
  s_waitcnt lgkmcnt(7)
  v_exp_f32 v107, v107
  v_mfma_f32_16x16x32_bf16 a[28:31], a[168:171], v[24:27], a[28:31]
  ds_read_b64_tr_b16 a[166:167], v220 offset:45056
  v_cvt_pk_bf16_f32 v105, v106, v107
  v_mfma_f32_16x16x32_bf16 a[32:35], a[176:179], v[0:3], a[32:35]
  v_exp_f32 v112, v112
  v_mfma_f32_16x16x32_bf16 a[32:35], a[180:183], v[32:35], a[32:35]
  ds_read_b64_tr_b16 a[168:169], v221 offset:32768
  v_mfma_f32_16x16x32_bf16 a[36:39], a[180:183], v[40:43], a[36:39]
  v_exp_f32 v113, v113
  v_mfma_f32_16x16x32_bf16 a[36:39], a[176:179], v[8:11], a[36:39]
  ds_read_b64_tr_b16 a[170:171], v221 offset:36864
  v_cvt_pk_bf16_f32 v112, v112, v113
  v_mfma_f32_16x16x32_bf16 a[40:43], a[176:179], v[16:19], a[40:43]
  v_exp_f32 v114, v114
  v_mfma_f32_16x16x32_bf16 a[40:43], a[180:183], v[48:51], a[40:43]
  ds_read_b64_tr_b16 a[172:173], v221 offset:40960
  v_mfma_f32_16x16x32_bf16 a[44:47], a[180:183], v[56:59], a[44:47]
  s_waitcnt lgkmcnt(7)
  v_exp_f32 v115, v115
  v_mfma_f32_16x16x32_bf16 a[44:47], a[176:179], v[24:27], a[44:47]
  ds_read_b64_tr_b16 a[174:175], v221 offset:45056
  v_cvt_pk_bf16_f32 v113, v114, v115
  v_mfma_f32_16x16x32_bf16 a[48:51], a[184:187], v[0:3], a[48:51]
  v_exp_f32 v120, v120
  v_mfma_f32_16x16x32_bf16 a[48:51], a[188:191], v[32:35], a[48:51]
  ds_read_b64_tr_b16 a[176:177], v222 offset:32768
  v_mfma_f32_16x16x32_bf16 a[52:55], a[188:191], v[40:43], a[52:55]
  v_exp_f32 v121, v121
  v_mfma_f32_16x16x32_bf16 a[52:55], a[184:187], v[8:11], a[52:55]
  ds_read_b64_tr_b16 a[178:179], v222 offset:36864
  v_cvt_pk_bf16_f32 v120, v120, v121
  v_mfma_f32_16x16x32_bf16 a[56:59], a[184:187], v[16:19], a[56:59]
  v_exp_f32 v122, v122
  v_mfma_f32_16x16x32_bf16 a[56:59], a[188:191], v[48:51], a[56:59]
  ds_read_b64_tr_b16 a[180:181], v222 offset:40960
  v_mfma_f32_16x16x32_bf16 a[60:63], a[188:191], v[56:59], a[60:63]
  s_waitcnt lgkmcnt(7)
  v_exp_f32 v123, v123
  v_mfma_f32_16x16x32_bf16 a[60:63], a[184:187], v[24:27], a[60:63]
  ds_read_b64_tr_b16 a[182:183], v222 offset:45056
  v_cvt_pk_bf16_f32 v121, v122, v123
  v_mfma_f32_16x16x32_bf16 a[64:67], a[160:163], v[0:3], a[64:67]
  v_exp_f32 v100, v100
  v_mfma_f32_16x16x32_bf16 a[64:67], a[164:167], v[32:35], a[64:67]
  ds_read_b64_tr_b16 a[184:185], v223 offset:32768
  v_mfma_f32_16x16x32_bf16 a[68:71], a[164:167], v[40:43], a[68:71]
  v_exp_f32 v101, v101
  v_mfma_f32_16x16x32_bf16 a[68:71], a[160:163], v[8:11], a[68:71]
  ds_read_b64_tr_b16 a[186:187], v223 offset:36864
  v_cvt_pk_bf16_f32 v98, v100, v101
  v_mfma_f32_16x16x32_bf16 a[72:75], a[160:163], v[16:19], a[72:75]
  v_exp_f32 v102, v102
  v_mfma_f32_16x16x32_bf16 a[72:75], a[164:167], v[48:51], a[72:75]
  ds_read_b64_tr_b16 a[188:189], v223 offset:40960
  v_mfma_f32_16x16x32_bf16 a[76:79], a[164:167], v[56:59], a[76:79]
  s_waitcnt lgkmcnt(7)
  v_exp_f32 v103, v103
  v_mfma_f32_16x16x32_bf16 a[76:79], a[160:163], v[24:27], a[76:79]
  ds_read_b64_tr_b16 a[190:191], v223 offset:45056
  v_cvt_pk_bf16_f32 v99, v102, v103
  v_mfma_f32_16x16x32_bf16 a[80:83], a[168:171], v[0:3], a[80:83]
  s_waitcnt vmcnt(12)
  v_exp_f32 v108, v108
  v_mfma_f32_16x16x32_bf16 a[80:83], a[172:175], v[32:35], a[80:83]
  v_mfma_f32_16x16x32_bf16 a[84:87], a[172:175], v[40:43], a[84:87]
  s_barrier
  v_exp_f32 v109, v109
  v_mfma_f32_16x16x32_bf16 a[84:87], a[168:171], v[8:11], a[84:87]
  ds_read_b128 a[128:131], v212 offset:0
  v_cvt_pk_bf16_f32 v106, v108, v109
  v_mfma_f32_16x16x32_bf16 a[88:91], a[168:171], v[16:19], a[88:91]
  v_exp_f32 v110, v110
  v_mfma_f32_16x16x32_bf16 a[88:91], a[172:175], v[48:51], a[88:91]
  ds_read_b128 a[132:135], v213 offset:0
  v_mfma_f32_16x16x32_bf16 a[92:95], a[172:175], v[56:59], a[92:95]
  s_waitcnt lgkmcnt(6)
  v_exp_f32 v111, v111
  v_mfma_f32_16x16x32_bf16 a[92:95], a[168:171], v[24:27], a[92:95]
  ds_read_b128 a[136:139], v214 offset:0
  v_cvt_pk_bf16_f32 v107, v110, v111
  v_mfma_f32_16x16x32_bf16 a[96:99], a[176:179], v[0:3], a[96:99]
  v_exp_f32 v116, v116
  v_mfma_f32_16x16x32_bf16 a[96:99], a[180:183], v[32:35], a[96:99]
  ds_read_b128 a[140:143], v215 offset:0
  v_mfma_f32_16x16x32_bf16 a[100:103], a[180:183], v[40:43], a[100:103]
  v_exp_f32 v117, v117
  v_mfma_f32_16x16x32_bf16 a[100:103], a[176:179], v[8:11], a[100:103]
  v_cvt_pk_bf16_f32 v114, v116, v117
  v_mfma_f32_16x16x32_bf16 a[104:107], a[176:179], v[16:19], a[104:107]
  v_exp_f32 v118, v118
  v_mfma_f32_16x16x32_bf16 a[104:107], a[180:183], v[48:51], a[104:107]
  v_mfma_f32_16x16x32_bf16 a[108:111], a[180:183], v[56:59], a[108:111]
  s_waitcnt lgkmcnt(4)
  v_exp_f32 v119, v119
  v_mfma_f32_16x16x32_bf16 a[108:111], a[176:179], v[24:27], a[108:111]
  v_cvt_pk_bf16_f32 v115, v118, v119
  v_mfma_f32_16x16x32_bf16 a[112:115], a[184:187], v[0:3], a[112:115]
  v_exp_f32 v124, v124
  v_mfma_f32_16x16x32_bf16 a[112:115], a[188:191], v[32:35], a[112:115]
  v_mfma_f32_16x16x32_bf16 a[116:119], a[188:191], v[40:43], a[116:119]
  s_sub_u32 s32, s32, 1
  v_exp_f32 v125, v125
  v_mfma_f32_16x16x32_bf16 a[116:119], a[184:187], v[8:11], a[116:119]
  v_cvt_pk_bf16_f32 v122, v124, v125
  v_mfma_f32_16x16x32_bf16 a[120:123], a[184:187], v[16:19], a[120:123]
  s_cmp_lg_u32 s32, 0
  v_exp_f32 v126, v126
  v_mfma_f32_16x16x32_bf16 a[120:123], a[188:191], v[48:51], a[120:123]
  v_mfma_f32_16x16x32_bf16 a[124:127], a[188:191], v[56:59], a[124:127]
  s_waitcnt lgkmcnt(0)
  v_exp_f32 v127, v127
  v_mfma_f32_16x16x32_bf16 a[124:127], a[184:187], v[24:27], a[124:127]
  v_cvt_pk_bf16_f32 v123, v126, v127
  s_cbranch_scc1 attn_loop
  ds_read_b64_tr_b16 a[160:161], v216 offset:49152
  ds_read_b64_tr_b16 a[162:163], v216 offset:53248
  ds_read_b64_tr_b16 a[164:165], v216 offset:57344
  ds_read_b64_tr_b16 a[166:167], v216 offset:61440
  ds_read_b64_tr_b16 a[168:169], v217 offset:49152
  ds_read_b64_tr_b16 a[170:171], v217 offset:53248
  ds_read_b64_tr_b16 a[172:173], v217 offset:57344
  ds_read_b64_tr_b16 a[174:175], v217 offset:61440
  s_waitcnt vmcnt(1)
  v_readfirstlane_b32 s38, v254
  s_nop 0
  s_cmp_ge_u32 s38, 512
  s_cbranch_scc1 attn_h_ready
  s_mov_b32 s39, 32768
attn_spin:
  s_sleep 4
  buffer_load_dword v254, off, s[24:27], s47 sc1
  s_waitcnt vmcnt(0)
  v_readfirstlane_b32 s38, v254
  s_nop 0
  s_cmp_ge_u32 s38, 512
  s_cbranch_scc1 attn_h_ready
  s_sub_u32 s39, s39, 1
  s_cmp_lg_u32 s39, 0
  s_cbranch_scc1 attn_spin
attn_h_ready:
  s_mov_b32 s48, 0x5d800000
  s_lshl_b32 s39, s3, 8
  v_mfma_f32_16x16x32_bf16 a[192:195], a[208:211], v[64:67], a[192:195]
  v_lshrrev_b32 v224, 4, v242
  v_and_b32 v225, 7, v224
  v_mfma_f32_16x16x32_bf16 a[192:195], a[208:211], v[96:99], a[192:195]
  v_mul_u32_u24 v225, 0xd80, v225
  v_lshrrev_b32 v224, 4, v224
  v_mfma_f32_16x16x32_bf16 a[196:199], a[208:211], v[72:75], a[196:199]
  v_lshl_add_u32 v225, v224, 4, v225
  v_mfma_f32_16x16x32_bf16 a[196:199], a[208:211], v[104:107], a[196:199]
  buffer_load_dwordx4 a[212:215], v225, s[24:27], s101 offen offset:0 sc1
  v_mfma_f32_16x16x32_bf16 a[200:203], a[208:211], v[80:83], a[200:203]
  buffer_load_dwordx4 a[216:219], v225, s[24:27], s101 offen offset:64 sc1
  v_mfma_f32_16x16x32_bf16 a[200:203], a[208:211], v[112:115], a[200:203]
  buffer_load_dwordx4 a[220:223], v225, s[24:27], s101 offen offset:128 sc1
  v_mfma_f32_16x16x32_bf16 a[204:207], a[208:211], v[88:91], a[204:207]
  v_mfma_f32_16x16x32_bf16 a[204:207], a[208:211], v[120:123], a[204:207]
  s_waitcnt lgkmcnt(4)
  v_mfma_f32_16x16x32_bf16 a[0:3], a[160:163], v[64:67], a[0:3]
  v_mfma_f32_16x16x32_bf16 a[0:3], a[164:167], v[96:99], a[0:3]
  ds_read_b64_tr_b16 a[176:177], v218 offset:49152
  v_mfma_f32_16x16x32_bf16 a[4:7], a[164:167], v[104:107], a[4:7]
  v_mfma_f32_16x16x32_bf16 a[4:7], a[160:163], v[72:75], a[4:7]
  ds_read_b64_tr_b16 a[178:179], v218 offset:53248
  v_accvgpr_read_b32 v208, a192
  v_mfma_f32_16x16x32_bf16 a[8:11], a[160:163], v[80:83], a[8:11]
  v_accvgpr_read_b32 v209, a196
  v_accvgpr_read_b32 v210, a200
  v_mfma_f32_16x16x32_bf16 a[8:11], a[164:167], v[112:115], a[8:11]
  ds_read_b64_tr_b16 a[180:181], v218 offset:57344
  v_accvgpr_read_b32 v211, a204
  v_mfma_f32_16x16x32_bf16 a[12:15], a[164:167], v[120:123], a[12:15]
  v_mov_b32 v245, v208
  v_mov_b32 v246, v209
  v_mfma_f32_16x16x32_bf16 a[12:15], a[160:163], v[88:91], a[12:15]
  ds_read_b64_tr_b16 a[182:183], v218 offset:61440
  s_waitcnt lgkmcnt(4)
  v_mov_b32 v247, v210
  v_mfma_f32_16x16x32_bf16 a[16:19], a[168:171], v[64:67], a[16:19]
  v_mov_b32 v248, v211
  v_permlane16_swap_b32 v208, v245
  v_mfma_f32_16x16x32_bf16 a[16:19], a[172:175], v[96:99], a[16:19]
  ds_read_b64_tr_b16 a[184:185], v219 offset:49152
  v_permlane16_swap_b32 v209, v246
  v_mfma_f32_16x16x32_bf16 a[20:23], a[172:175], v[104:107], a[20:23]
  v_permlane16_swap_b32 v210, v247
  v_permlane16_swap_b32 v211, v248
  v_mfma_f32_16x16x32_bf16 a[20:23], a[168:171], v[72:75], a[20:23]
  ds_read_b64_tr_b16 a[186:187], v219 offset:53248
  v_add_f32 v208, v208, v245
  v_mfma_f32_16x16x32_bf16 a[24:27], a[168:171], v[80:83], a[24:27]
  v_add_f32 v209, v209, v246
  v_add_f32 v210, v210, v247
  v_mfma_f32_16x16x32_bf16 a[24:27], a[172:175], v[112:115], a[24:27]
  ds_read_b64_tr_b16 a[188:189], v219 offset:57344
  v_add_f32 v211, v211, v248
  v_mfma_f32_16x16x32_bf16 a[28:31], a[172:175], v[120:123], a[28:31]
  v_mov_b32 v245, v208
  v_mov_b32 v246, v209
  v_mfma_f32_16x16x32_bf16 a[28:31], a[168:171], v[88:91], a[28:31]
  ds_read_b64_tr_b16 a[190:191], v219 offset:61440
  s_waitcnt lgkmcnt(4)
  v_mov_b32 v247, v210
  v_mfma_f32_16x16x32_bf16 a[32:35], a[176:179], v[64:67], a[32:35]
  v_mov_b32 v248, v211
  v_permlane32_swap_b32 v208, v245
  v_mfma_f32_16x16x32_bf16 a[32:35], a[180:183], v[96:99], a[32:35]
  ds_read_b64_tr_b16 a[160:161], v220 offset:49152
  v_permlane32_swap_b32 v209, v246
  v_mfma_f32_16x16x32_bf16 a[36:39], a[180:183], v[104:107], a[36:39]
  v_permlane32_swap_b32 v210, v247
  v_permlane32_swap_b32 v211, v248
  v_mfma_f32_16x16x32_bf16 a[36:39], a[176:179], v[72:75], a[36:39]
  ds_read_b64_tr_b16 a[162:163], v220 offset:53248
  v_add_f32 v208, v208, v245
  v_mfma_f32_16x16x32_bf16 a[40:43], a[176:179], v[80:83], a[40:43]
  v_add_f32 v209, v209, v246
  v_add_f32 v210, v210, v247
  v_mfma_f32_16x16x32_bf16 a[40:43], a[180:183], v[112:115], a[40:43]
  ds_read_b64_tr_b16 a[164:165], v220 offset:57344
  v_add_f32 v211, v211, v248
  v_mfma_f32_16x16x32_bf16 a[44:47], a[180:183], v[120:123], a[44:47]
  v_rcp_f32 v192, v208
  v_mfma_f32_16x16x32_bf16 a[44:47], a[176:179], v[88:91], a[44:47]
  ds_read_b64_tr_b16 a[166:167], v220 offset:61440
  s_waitcnt lgkmcnt(4)
  v_mfma_f32_16x16x32_bf16 a[48:51], a[184:187], v[64:67], a[48:51]
  v_rcp_f32 v196, v209
  v_mfma_f32_16x16x32_bf16 a[48:51], a[188:191], v[96:99], a[48:51]
  ds_read_b64_tr_b16 a[168:169], v221 offset:49152
  v_mfma_f32_16x16x32_bf16 a[52:55], a[188:191], v[104:107], a[52:55]
  v_rcp_f32 v200, v210
  v_mfma_f32_16x16x32_bf16 a[52:55], a[184:187], v[72:75], a[52:55]
  ds_read_b64_tr_b16 a[170:171], v221 offset:53248
  v_mfma_f32_16x16x32_bf16 a[56:59], a[184:187], v[80:83], a[56:59]
  v_rcp_f32 v204, v211
  v_mfma_f32_16x16x32_bf16 a[56:59], a[188:191], v[112:115], a[56:59]
  ds_read_b64_tr_b16 a[172:173], v221 offset:57344
  v_add_f32 v246, v208, v209
  v_mfma_f32_16x16x32_bf16 a[60:63], a[188:191], v[120:123], a[60:63]
  v_add_f32 v247, v210, v211
  v_add_f32 v246, v246, v247
  v_mfma_f32_16x16x32_bf16 a[60:63], a[184:187], v[88:91], a[60:63]
  ds_read_b64_tr_b16 a[174:175], v221 offset:61440
  s_waitcnt lgkmcnt(4)
  v_lshrrev_b32 v247, 2, v242
  v_mfma_f32_16x16x32_bf16 a[64:67], a[160:163], v[64:67], a[64:67]
  v_cmp_nlt_f32 vcc, v246, s48
  v_add_u32 v247, s39, v247
  v_mfma_f32_16x16x32_bf16 a[64:67], a[164:167], v[96:99], a[64:67]
  ds_read_b64_tr_b16 a[176:177], v222 offset:49152
  v_add_u32 v247, 157696, v247
  v_mfma_f32_16x16x32_bf16 a[68:71], a[164:167], v[104:107], a[68:71]
  v_cndmask_b32_e64 v245, 0, 1, vcc
  v_accvgpr_read_b32 v0, a0
  v_mfma_f32_16x16x32_bf16 a[68:71], a[160:163], v[72:75], a[68:71]
  ds_read_b64_tr_b16 a[178:179], v222 offset:53248
  v_accvgpr_read_b32 v1, a1
  v_mfma_f32_16x16x32_bf16 a[72:75], a[160:163], v[80:83], a[72:75]
  v_accvgpr_read_b32 v2, a2
  v_accvgpr_read_b32 v3, a3
  v_mfma_f32_16x16x32_bf16 a[72:75], a[164:167], v[112:115], a[72:75]
  ds_read_b64_tr_b16 a[180:181], v222 offset:57344
  v_accvgpr_read_b32 v4, a16
  v_mfma_f32_16x16x32_bf16 a[76:79], a[164:167], v[120:123], a[76:79]
  v_accvgpr_read_b32 v5, a17
  v_accvgpr_read_b32 v6, a18
  v_mfma_f32_16x16x32_bf16 a[76:79], a[160:163], v[88:91], a[76:79]
  ds_read_b64_tr_b16 a[182:183], v222 offset:61440
  s_waitcnt lgkmcnt(4)
  v_accvgpr_read_b32 v7, a19
  v_mfma_f32_16x16x32_bf16 a[80:83], a[168:171], v[64:67], a[80:83]
  v_mul_f32 v0, v0, v192
  v_mul_f32 v1, v1, v192
  v_mfma_f32_16x16x32_bf16 a[80:83], a[172:175], v[96:99], a[80:83]
  ds_read_b64_tr_b16 a[184:185], v223 offset:49152
  v_mul_f32 v2, v2, v192
  v_mfma_f32_16x16x32_bf16 a[84:87], a[172:175], v[104:107], a[84:87]
  v_mul_f32 v3, v3, v192
  v_mul_f32 v4, v4, v192
  v_mfma_f32_16x16x32_bf16 a[84:87], a[168:171], v[72:75], a[84:87]
  ds_read_b64_tr_b16 a[186:187], v223 offset:53248
  v_mul_f32 v5, v5, v192
  v_mfma_f32_16x16x32_bf16 a[88:91], a[168:171], v[80:83], a[88:91]
  v_mul_f32 v6, v6, v192
  v_mul_f32 v7, v7, v192
  v_mfma_f32_16x16x32_bf16 a[88:91], a[172:175], v[112:115], a[88:91]
  ds_read_b64_tr_b16 a[188:189], v223 offset:57344
  v_cvt_pk_bf16_f32 v0, v0, v1
  v_mfma_f32_16x16x32_bf16 a[92:95], a[172:175], v[120:123], a[92:95]
  v_cvt_pk_bf16_f32 v1, v2, v3
  v_cvt_pk_bf16_f32 v2, v4, v5
  v_mfma_f32_16x16x32_bf16 a[92:95], a[168:171], v[88:91], a[92:95]
  ds_read_b64_tr_b16 a[190:191], v223 offset:61440
  s_waitcnt lgkmcnt(4)
  v_cvt_pk_bf16_f32 v3, v6, v7
  v_mfma_f32_16x16x32_bf16 a[96:99], a[176:179], v[64:67], a[96:99]
  buffer_store_dwordx4 v[0:3], v244, s[24:27], s40 offen offset:0 sc1
  v_mfma_f32_16x16x32_bf16 a[96:99], a[180:183], v[96:99], a[96:99]
  v_accvgpr_read_b32 v8, a4
  v_accvgpr_read_b32 v9, a5
  v_mfma_f32_16x16x32_bf16 a[100:103], a[180:183], v[104:107], a[100:103]
  v_accvgpr_read_b32 v10, a6
  v_accvgpr_read_b32 v11, a7
  v_mfma_f32_16x16x32_bf16 a[100:103], a[176:179], v[72:75], a[100:103]
  v_accvgpr_read_b32 v12, a20
  v_accvgpr_read_b32 v13, a21
  v_mfma_f32_16x16x32_bf16 a[104:107], a[176:179], v[80:83], a[104:107]
  v_accvgpr_read_b32 v14, a22
  v_accvgpr_read_b32 v15, a23
  v_mfma_f32_16x16x32_bf16 a[104:107], a[180:183], v[112:115], a[104:107]
  v_mul_f32 v8, v8, v196
  v_mul_f32 v9, v9, v196
  v_mfma_f32_16x16x32_bf16 a[108:111], a[180:183], v[120:123], a[108:111]
  v_mul_f32 v10, v10, v196
  v_mul_f32 v11, v11, v196
  v_mfma_f32_16x16x32_bf16 a[108:111], a[176:179], v[88:91], a[108:111]
  s_waitcnt lgkmcnt(0)
  v_mul_f32 v12, v12, v196
  v_mul_f32 v13, v13, v196
  v_mfma_f32_16x16x32_bf16 a[112:115], a[184:187], v[64:67], a[112:115]
  v_mul_f32 v14, v14, v196
  v_mul_f32 v15, v15, v196
  v_mfma_f32_16x16x32_bf16 a[112:115], a[188:191], v[96:99], a[112:115]
  v_cvt_pk_bf16_f32 v8, v8, v9
  v_cvt_pk_bf16_f32 v9, v10, v11
  v_mfma_f32_16x16x32_bf16 a[116:119], a[188:191], v[104:107], a[116:119]
  v_cvt_pk_bf16_f32 v10, v12, v13
  v_cvt_pk_bf16_f32 v11, v14, v15
  v_mfma_f32_16x16x32_bf16 a[116:119], a[184:187], v[72:75], a[116:119]
  buffer_store_dwordx4 v[8:11], v244, s[24:27], s40 offen offset:2048 sc1
  v_mfma_f32_16x16x32_bf16 a[120:123], a[184:187], v[80:83], a[120:123]
  v_accvgpr_read_b32 v16, a8
  v_accvgpr_read_b32 v17, a9
  v_mfma_f32_16x16x32_bf16 a[120:123], a[188:191], v[112:115], a[120:123]
  v_accvgpr_read_b32 v18, a10
  v_accvgpr_read_b32 v19, a11
  v_mfma_f32_16x16x32_bf16 a[124:127], a[188:191], v[120:123], a[124:127]
  v_accvgpr_read_b32 v20, a24
  v_accvgpr_read_b32 v21, a25
  v_mfma_f32_16x16x32_bf16 a[124:127], a[184:187], v[88:91], a[124:127]
  v_accvgpr_read_b32 v22, a26
  v_accvgpr_read_b32 v23, a27
  v_pk_mul_f32 v[16:17], v[16:17], v[200:201] op_sel_hi:[1,0]
  v_pk_mul_f32 v[18:19], v[18:19], v[200:201] op_sel_hi:[1,0]
  v_pk_mul_f32 v[20:21], v[20:21], v[200:201] op_sel_hi:[1,0]
  v_pk_mul_f32 v[22:23], v[22:23], v[200:201] op_sel_hi:[1,0]
  v_cvt_pk_bf16_f32 v16, v16, v17
  v_cvt_pk_bf16_f32 v17, v18, v19
  v_cvt_pk_bf16_f32 v18, v20, v21
  v_cvt_pk_bf16_f32 v19, v22, v23
  buffer_store_dwordx4 v[16:19], v244, s[24:27], s41 offen offset:0 sc1
  v_accvgpr_read_b32 v24, a12
  v_accvgpr_read_b32 v25, a13
  v_accvgpr_read_b32 v26, a14
  v_accvgpr_read_b32 v27, a15
  v_accvgpr_read_b32 v28, a28
  v_accvgpr_read_b32 v29, a29
  v_accvgpr_read_b32 v30, a30
  v_accvgpr_read_b32 v31, a31
  v_pk_mul_f32 v[24:25], v[24:25], v[204:205] op_sel_hi:[1,0]
  v_pk_mul_f32 v[26:27], v[26:27], v[204:205] op_sel_hi:[1,0]
  v_pk_mul_f32 v[28:29], v[28:29], v[204:205] op_sel_hi:[1,0]
  v_pk_mul_f32 v[30:31], v[30:31], v[204:205] op_sel_hi:[1,0]
  v_cvt_pk_bf16_f32 v24, v24, v25
  v_cvt_pk_bf16_f32 v25, v26, v27
  v_cvt_pk_bf16_f32 v26, v28, v29
  v_cvt_pk_bf16_f32 v27, v30, v31
  buffer_store_dwordx4 v[24:27], v244, s[24:27], s41 offen offset:2048 sc1
  v_accvgpr_read_b32 v32, a32
  v_accvgpr_read_b32 v33, a33
  v_accvgpr_read_b32 v34, a34
  v_accvgpr_read_b32 v35, a35
  v_accvgpr_read_b32 v36, a48
  v_accvgpr_read_b32 v37, a49
  v_accvgpr_read_b32 v38, a50
  v_accvgpr_read_b32 v39, a51
  v_pk_mul_f32 v[32:33], v[32:33], v[192:193] op_sel_hi:[1,0]
  v_pk_mul_f32 v[34:35], v[34:35], v[192:193] op_sel_hi:[1,0]
  v_pk_mul_f32 v[36:37], v[36:37], v[192:193] op_sel_hi:[1,0]
  v_pk_mul_f32 v[38:39], v[38:39], v[192:193] op_sel_hi:[1,0]
  v_cvt_pk_bf16_f32 v32, v32, v33
  v_cvt_pk_bf16_f32 v33, v34, v35
  v_cvt_pk_bf16_f32 v34, v36, v37
  v_cvt_pk_bf16_f32 v35, v38, v39
  buffer_store_dwordx4 v[32:35], v244, s[24:27], s40 offen offset:1024 sc1
  v_accvgpr_read_b32 v40, a36
  v_accvgpr_read_b32 v41, a37
  v_accvgpr_read_b32 v42, a38
  v_accvgpr_read_b32 v43, a39
  v_accvgpr_read_b32 v44, a52
  v_accvgpr_read_b32 v45, a53
  v_accvgpr_read_b32 v46, a54
  v_accvgpr_read_b32 v47, a55
  v_pk_mul_f32 v[40:41], v[40:41], v[196:197] op_sel_hi:[1,0]
  v_pk_mul_f32 v[42:43], v[42:43], v[196:197] op_sel_hi:[1,0]
  v_pk_mul_f32 v[44:45], v[44:45], v[196:197] op_sel_hi:[1,0]
  v_pk_mul_f32 v[46:47], v[46:47], v[196:197] op_sel_hi:[1,0]
  v_cvt_pk_bf16_f32 v40, v40, v41
  v_cvt_pk_bf16_f32 v41, v42, v43
  v_cvt_pk_bf16_f32 v42, v44, v45
  v_cvt_pk_bf16_f32 v43, v46, v47
  buffer_store_dwordx4 v[40:43], v244, s[24:27], s40 offen offset:3072 sc1
  v_accvgpr_read_b32 v48, a40
  v_accvgpr_read_b32 v49, a41
  v_accvgpr_read_b32 v50, a42
  v_accvgpr_read_b32 v51, a43
  v_accvgpr_read_b32 v52, a56
  v_accvgpr_read_b32 v53, a57
  v_accvgpr_read_b32 v54, a58
  v_accvgpr_read_b32 v55, a59
  v_pk_mul_f32 v[48:49], v[48:49], v[200:201] op_sel_hi:[1,0]
  v_pk_mul_f32 v[50:51], v[50:51], v[200:201] op_sel_hi:[1,0]
  v_pk_mul_f32 v[52:53], v[52:53], v[200:201] op_sel_hi:[1,0]
  v_pk_mul_f32 v[54:55], v[54:55], v[200:201] op_sel_hi:[1,0]
  v_cvt_pk_bf16_f32 v48, v48, v49
  v_cvt_pk_bf16_f32 v49, v50, v51
  v_cvt_pk_bf16_f32 v50, v52, v53
  v_cvt_pk_bf16_f32 v51, v54, v55
  buffer_store_dwordx4 v[48:51], v244, s[24:27], s41 offen offset:1024 sc1
  v_accvgpr_read_b32 v56, a44
  v_accvgpr_read_b32 v57, a45
  v_accvgpr_read_b32 v58, a46
  v_accvgpr_read_b32 v59, a47
  v_accvgpr_read_b32 v60, a60
  v_accvgpr_read_b32 v61, a61
  v_accvgpr_read_b32 v62, a62
  v_accvgpr_read_b32 v63, a63
  v_pk_mul_f32 v[56:57], v[56:57], v[204:205] op_sel_hi:[1,0]
  v_pk_mul_f32 v[58:59], v[58:59], v[204:205] op_sel_hi:[1,0]
  v_pk_mul_f32 v[60:61], v[60:61], v[204:205] op_sel_hi:[1,0]
  v_pk_mul_f32 v[62:63], v[62:63], v[204:205] op_sel_hi:[1,0]
  v_cvt_pk_bf16_f32 v56, v56, v57
  v_cvt_pk_bf16_f32 v57, v58, v59
  v_cvt_pk_bf16_f32 v58, v60, v61
  v_cvt_pk_bf16_f32 v59, v62, v63
  buffer_store_dwordx4 v[56:59], v244, s[24:27], s41 offen offset:3072 sc1
  v_accvgpr_read_b32 v0, a64
  v_accvgpr_read_b32 v1, a65
  v_accvgpr_read_b32 v2, a66
  v_accvgpr_read_b32 v3, a67
  v_accvgpr_read_b32 v4, a80
  v_accvgpr_read_b32 v5, a81
  v_accvgpr_read_b32 v6, a82
  v_accvgpr_read_b32 v7, a83
  v_pk_mul_f32 v[0:1], v[0:1], v[192:193] op_sel_hi:[1,0]
  v_pk_mul_f32 v[2:3], v[2:3], v[192:193] op_sel_hi:[1,0]
  v_pk_mul_f32 v[4:5], v[4:5], v[192:193] op_sel_hi:[1,0]
  v_pk_mul_f32 v[6:7], v[6:7], v[192:193] op_sel_hi:[1,0]
  v_cvt_pk_bf16_f32 v0, v0, v1
  v_cvt_pk_bf16_f32 v1, v2, v3
  v_cvt_pk_bf16_f32 v2, v4, v5
  v_cvt_pk_bf16_f32 v3, v6, v7
  buffer_store_dwordx4 v[0:3], v244, s[24:27], s42 offen offset:0 sc1
  v_accvgpr_read_b32 v8, a68
  v_accvgpr_read_b32 v9, a69
  v_accvgpr_read_b32 v10, a70
  v_accvgpr_read_b32 v11, a71
  v_accvgpr_read_b32 v12, a84
  v_accvgpr_read_b32 v13, a85
  v_accvgpr_read_b32 v14, a86
  v_accvgpr_read_b32 v15, a87
  v_pk_mul_f32 v[8:9], v[8:9], v[196:197] op_sel_hi:[1,0]
  v_pk_mul_f32 v[10:11], v[10:11], v[196:197] op_sel_hi:[1,0]
  v_pk_mul_f32 v[12:13], v[12:13], v[196:197] op_sel_hi:[1,0]
  v_pk_mul_f32 v[14:15], v[14:15], v[196:197] op_sel_hi:[1,0]
  v_cvt_pk_bf16_f32 v8, v8, v9
  v_cvt_pk_bf16_f32 v9, v10, v11
  v_cvt_pk_bf16_f32 v10, v12, v13
  v_cvt_pk_bf16_f32 v11, v14, v15
  buffer_store_dwordx4 v[8:11], v244, s[24:27], s42 offen offset:2048 sc1
  v_accvgpr_read_b32 v16, a72
  v_accvgpr_read_b32 v17, a73
  v_accvgpr_read_b32 v18, a74
  v_accvgpr_read_b32 v19, a75
  v_accvgpr_read_b32 v20, a88
  v_accvgpr_read_b32 v21, a89
  v_accvgpr_read_b32 v22, a90
  v_accvgpr_read_b32 v23, a91
  v_pk_mul_f32 v[16:17], v[16:17], v[200:201] op_sel_hi:[1,0]
  v_pk_mul_f32 v[18:19], v[18:19], v[200:201] op_sel_hi:[1,0]
  v_pk_mul_f32 v[20:21], v[20:21], v[200:201] op_sel_hi:[1,0]
  v_pk_mul_f32 v[22:23], v[22:23], v[200:201] op_sel_hi:[1,0]
  v_cvt_pk_bf16_f32 v16, v16, v17
  v_cvt_pk_bf16_f32 v17, v18, v19
  v_cvt_pk_bf16_f32 v18, v20, v21
  v_cvt_pk_bf16_f32 v19, v22, v23
  buffer_store_dwordx4 v[16:19], v244, s[24:27], s43 offen offset:0 sc1
  v_accvgpr_read_b32 v24, a76
  v_accvgpr_read_b32 v25, a77
  v_accvgpr_read_b32 v26, a78
  v_accvgpr_read_b32 v27, a79
  v_accvgpr_read_b32 v28, a92
  v_accvgpr_read_b32 v29, a93
  v_accvgpr_read_b32 v30, a94
  v_accvgpr_read_b32 v31, a95
  v_pk_mul_f32 v[24:25], v[24:25], v[204:205] op_sel_hi:[1,0]
  v_pk_mul_f32 v[26:27], v[26:27], v[204:205] op_sel_hi:[1,0]
  v_pk_mul_f32 v[28:29], v[28:29], v[204:205] op_sel_hi:[1,0]
  v_pk_mul_f32 v[30:31], v[30:31], v[204:205] op_sel_hi:[1,0]
  v_cvt_pk_bf16_f32 v24, v24, v25
  v_cvt_pk_bf16_f32 v25, v26, v27
  v_cvt_pk_bf16_f32 v26, v28, v29
  v_cvt_pk_bf16_f32 v27, v30, v31
  buffer_store_dwordx4 v[24:27], v244, s[24:27], s43 offen offset:2048 sc1
  v_accvgpr_read_b32 v32, a96
  v_accvgpr_read_b32 v33, a97
  v_accvgpr_read_b32 v34, a98
  v_accvgpr_read_b32 v35, a99
  v_accvgpr_read_b32 v36, a112
  v_accvgpr_read_b32 v37, a113
  v_accvgpr_read_b32 v38, a114
  v_accvgpr_read_b32 v39, a115
  v_pk_mul_f32 v[32:33], v[32:33], v[192:193] op_sel_hi:[1,0]
  v_pk_mul_f32 v[34:35], v[34:35], v[192:193] op_sel_hi:[1,0]
  v_pk_mul_f32 v[36:37], v[36:37], v[192:193] op_sel_hi:[1,0]
  v_pk_mul_f32 v[38:39], v[38:39], v[192:193] op_sel_hi:[1,0]
  v_cvt_pk_bf16_f32 v32, v32, v33
  v_cvt_pk_bf16_f32 v33, v34, v35
  v_cvt_pk_bf16_f32 v34, v36, v37
  v_cvt_pk_bf16_f32 v35, v38, v39
  buffer_store_dwordx4 v[32:35], v244, s[24:27], s42 offen offset:1024 sc1
  v_accvgpr_read_b32 v40, a100
  v_accvgpr_read_b32 v41, a101
  v_accvgpr_read_b32 v42, a102
  v_accvgpr_read_b32 v43, a103
  v_accvgpr_read_b32 v44, a116
  v_accvgpr_read_b32 v45, a117
  v_accvgpr_read_b32 v46, a118
  v_accvgpr_read_b32 v47, a119
  v_pk_mul_f32 v[40:41], v[40:41], v[196:197] op_sel_hi:[1,0]
  v_pk_mul_f32 v[42:43], v[42:43], v[196:197] op_sel_hi:[1,0]
  v_pk_mul_f32 v[44:45], v[44:45], v[196:197] op_sel_hi:[1,0]
  v_pk_mul_f32 v[46:47], v[46:47], v[196:197] op_sel_hi:[1,0]
  v_cvt_pk_bf16_f32 v40, v40, v41
  v_cvt_pk_bf16_f32 v41, v42, v43
  v_cvt_pk_bf16_f32 v42, v44, v45
  v_cvt_pk_bf16_f32 v43, v46, v47
  buffer_store_dwordx4 v[40:43], v244, s[24:27], s42 offen offset:3072 sc1
  v_accvgpr_read_b32 v48, a104
  v_accvgpr_read_b32 v49, a105
  v_accvgpr_read_b32 v50, a106
  v_accvgpr_read_b32 v51, a107
  v_accvgpr_read_b32 v52, a120
  v_accvgpr_read_b32 v53, a121
  v_accvgpr_read_b32 v54, a122
  v_accvgpr_read_b32 v55, a123
  v_pk_mul_f32 v[48:49], v[48:49], v[200:201] op_sel_hi:[1,0]
  v_pk_mul_f32 v[50:51], v[50:51], v[200:201] op_sel_hi:[1,0]
  v_pk_mul_f32 v[52:53], v[52:53], v[200:201] op_sel_hi:[1,0]
  v_pk_mul_f32 v[54:55], v[54:55], v[200:201] op_sel_hi:[1,0]
  v_cvt_pk_bf16_f32 v48, v48, v49
  v_cvt_pk_bf16_f32 v49, v50, v51
  v_cvt_pk_bf16_f32 v50, v52, v53
  v_cvt_pk_bf16_f32 v51, v54, v55
  buffer_store_dwordx4 v[48:51], v244, s[24:27], s43 offen offset:1024 sc1
  v_accvgpr_read_b32 v56, a108
  v_accvgpr_read_b32 v57, a109
  v_accvgpr_read_b32 v58, a110
  v_accvgpr_read_b32 v59, a111
  v_accvgpr_read_b32 v60, a124
  v_accvgpr_read_b32 v61, a125
  v_accvgpr_read_b32 v62, a126
  v_accvgpr_read_b32 v63, a127
  v_pk_mul_f32 v[56:57], v[56:57], v[204:205] op_sel_hi:[1,0]
  v_pk_mul_f32 v[58:59], v[58:59], v[204:205] op_sel_hi:[1,0]
  v_pk_mul_f32 v[60:61], v[60:61], v[204:205] op_sel_hi:[1,0]
  v_pk_mul_f32 v[62:63], v[62:63], v[204:205] op_sel_hi:[1,0]
  v_cvt_pk_bf16_f32 v56, v56, v57
  v_cvt_pk_bf16_f32 v57, v58, v59
  v_cvt_pk_bf16_f32 v58, v60, v61
  v_cvt_pk_bf16_f32 v59, v62, v63
  buffer_store_dwordx4 v[56:59], v244, s[24:27], s43 offen offset:3072 sc1
  ds_write_b32 v247, v245
  v_lshrrev_b32 v224, 4, v242
  v_lshrrev_b32 v225, 4, v224
  v_bfe_u32 v226, v224, 2, 2
  v_lshl_add_u32 v225, v225, 3, v226
  v_lshlrev_b32 v225, 5, v225
  v_and_b32 v226, 3, v224
  v_lshl_add_u32 v225, v226, 3, v225
  v_add_u32 v225, s50, v225
  s_waitcnt vmcnt(16)
  ds_read_b64_tr_b16 a[232:233], v225 offset:0
  ds_read_b64_tr_b16 a[234:235], v225 offset:128
  ds_read_b64_tr_b16 a[236:237], v225 offset:1024
  ds_read_b64_tr_b16 a[238:239], v225 offset:1152
  ds_read_b64_tr_b16 a[240:241], v225 offset:2048
  ds_read_b64_tr_b16 a[242:243], v225 offset:2176
  s_waitcnt lgkmcnt(0)
  v_mfma_f32_16x16x32_bf16 v[228:231], a[232:235], a[212:215], 0
  v_mfma_f32_16x16x32_bf16 v[228:231], a[236:239], a[216:219], v[228:231]
  v_mfma_f32_16x16x32_bf16 v[228:231], a[240:243], a[220:223], v[228:231]
  s_lshl_b32 s35, s3, 10
  s_add_u32 s35, s35, 159744
  v_add_u32 v224, s35, v242
  s_nop 4
  ds_write_b128 v224, v[228:231]
  s_waitcnt lgkmcnt(0)
  v_lshlrev_b32 v246, 0, v242
  v_add_u32 v246, 157696, v246
  s_waitcnt lgkmcnt(0)
  s_barrier
  ds_read_b128 v[248:251], v246
  v_add_u32 v224, 159744, v242
  ds_read_b128 v[64:67], v224 offset:0
  ds_read_b128 v[68:71], v224 offset:1024
  ds_read_b128 v[72:75], v224 offset:2048
  v_lshrrev_b32 v224, 4, v242
  s_cmp_eq_u32 s3, 0
  s_cselect_b32 s35, 0, 1073741824
  v_and_b32 v225, 7, v224
  v_mul_u32_u24 v225, 0xa00, v225
  v_lshrrev_b32 v226, 4, v224
  v_lshl_add_u32 v225, v226, 4, v225
  v_bfe_u32 v226, v224, 3, 1
  v_lshl_add_u32 v225, v226, 30, v225
  v_or_b32 v225, s35, v225
  s_mul_i32 s35, s98, 20480
  s_lshl_b32 s38, s99, 6
  s_add_u32 s35, s35, s38
  s_add_u32 s35, s35, 2686976
  s_waitcnt lgkmcnt(1)
  v_add_f32 v64, v64, v68
  v_add_f32 v65, v65, v69
  v_add_f32 v66, v66, v70
  v_add_f32 v67, v67, v71
  s_waitcnt lgkmcnt(0)
  v_add_f32 v64, v64, v72
  v_add_f32 v65, v65, v73
  v_add_f32 v66, v66, v74
  v_add_f32 v67, v67, v75
  buffer_store_dwordx4 v[64:67], v225, s[24:27], s35 offen sc1
  v_or3_b32 v248, v248, v249, v250
  v_or_b32 v248, v248, v251
  v_cmp_ne_u32 vcc, 0, v248
  s_nop 0
  s_cbranch_vccnz attn_redo
tail_go:
  s_and_b32 s36, s2, 1
  s_bfe_u32 s28, s2, 0x20001
  s_lshl_b32 s28, s28, 2
  s_bfe_u32 s38, s2, 0x20003
  s_add_u32 s28, s28, s38
  s_lshr_b32 s29, s2, 5
  v_mov_b32 v114, v242
  v_add_u32 v115, 0x1000, v114
  v_add_u32 v116, 0x2000, v114
  s_lshl_b32 s38, s36, 2
  s_add_u32 s38, s38, s3
  s_mul_i32 s39, s38, 81920
  s_lshl_b32 s30, s38, 16
  s_mul_i32 s31, s29, 655360
  s_add_u32 s31, s31, s39
  s_add_u32 s31, s31, 3145728
  s_mul_i32 s33, s3, 24576
  s_add_u32 s33, s33, 4096
  s_add_u32 s4, s31, 0
  s_add_u32 s5, s31, 12288
  s_add_u32 s6, s31, 24576
  s_add_u32 s7, s31, 36864
  s_add_u32 s8, s31, 49152
  s_add_u32 s9, s31, 61440
  s_add_u32 s10, s31, 73728
  buffer_load_dwordx4 v[176:179], v114, s[24:27], s4 offen offset:0 sc1
  buffer_load_dwordx4 v[180:183], v114, s[24:27], s4 offen offset:1024 sc1
  buffer_load_dwordx4 v[184:187], v114, s[24:27], s4 offen offset:2048 sc1
  buffer_load_dwordx4 v[188:191], v114, s[24:27], s4 offen offset:3072 sc1
  buffer_load_dwordx4 v[192:195], v115, s[24:27], s4 offen offset:0 sc1
  buffer_load_dwordx4 v[196:199], v115, s[24:27], s4 offen offset:1024 sc1
  buffer_load_dwordx4 v[200:203], v115, s[24:27], s4 offen offset:2048 sc1
  buffer_load_dwordx4 v[204:207], v115, s[24:27], s4 offen offset:3072 sc1
  buffer_load_dwordx4 v[208:211], v116, s[24:27], s4 offen offset:0 sc1
  buffer_load_dwordx4 v[212:215], v116, s[24:27], s4 offen offset:1024 sc1
  buffer_load_dwordx4 v[216:219], v116, s[24:27], s4 offen offset:2048 sc1
  buffer_load_dwordx4 v[220:223], v116, s[24:27], s4 offen offset:3072 sc1
  buffer_load_dwordx4 v[224:227], v114, s[24:27], s5 offen offset:0 sc1
  buffer_load_dwordx4 v[228:231], v114, s[24:27], s5 offen offset:1024 sc1
  buffer_load_dwordx4 v[232:235], v114, s[24:27], s5 offen offset:2048 sc1
  buffer_load_dwordx4 v[236:239], v114, s[24:27], s5 offen offset:3072 sc1
  buffer_load_dwordx4 v[240:243], v115, s[24:27], s5 offen offset:0 sc1
  buffer_load_dwordx4 v[244:247], v115, s[24:27], s5 offen offset:1024 sc1
  buffer_load_dwordx4 v[248:251], v115, s[24:27], s5 offen offset:2048 sc1
  buffer_load_dwordx4 v[252:255], v115, s[24:27], s5 offen offset:3072 sc1
  buffer_load_dwordx4 a[0:3], v116, s[24:27], s5 offen offset:0 sc1
  buffer_load_dwordx4 a[4:7], v116, s[24:27], s5 offen offset:1024 sc1
  buffer_load_dwordx4 a[8:11], v116, s[24:27], s5 offen offset:2048 sc1
  buffer_load_dwordx4 a[12:15], v116, s[24:27], s5 offen offset:3072 sc1
  buffer_load_dwordx4 a[16:19], v114, s[24:27], s6 offen offset:0 sc1
  buffer_load_dwordx4 a[20:23], v114, s[24:27], s6 offen offset:1024 sc1
  buffer_load_dwordx4 a[24:27], v114, s[24:27], s6 offen offset:2048 sc1
  buffer_load_dwordx4 a[28:31], v114, s[24:27], s6 offen offset:3072 sc1
  buffer_load_dwordx4 a[32:35], v115, s[24:27], s6 offen offset:0 sc1
  buffer_load_dwordx4 a[36:39], v115, s[24:27], s6 offen offset:1024 sc1
  v_lshrrev_b32 v125, 4, v114
  v_and_b32 v126, 15, v125
  v_lshrrev_b32 v127, 4, v125
  s_add_u32 s38, s3, 0
  s_and_b32 s38, s38, 3
  s_lshl_b32 s38, s38, 11
  v_add_u32 v110, s38, v114
  s_sub_u32 s38, s3, 0
  s_and_b32 s38, s38, 3
  s_mul_i32 s38, s38, 15360
  s_add_u32 s38, s38, 102400
  v_add_u32 v118, s38, v114
  s_add_u32 s38, s3, 1
  s_and_b32 s38, s38, 3
  s_lshl_b32 s38, s38, 11
  v_add_u32 v111, s38, v114
  s_sub_u32 s38, s3, 1
  s_and_b32 s38, s38, 3
  s_mul_i32 s38, s38, 15360
  s_add_u32 s38, s38, 102400
  v_add_u32 v119, s38, v114
  s_add_u32 s38, s3, 2
  s_and_b32 s38, s38, 3
  s_lshl_b32 s38, s38, 11
  v_add_u32 v112, s38, v114
  s_sub_u32 s38, s3, 2
  s_and_b32 s38, s38, 3
  s_mul_i32 s38, s38, 15360
  s_add_u32 s38, s38, 107520
  v_add_u32 v120, s38, v114
  s_add_u32 s38, s3, 3
  s_and_b32 s38, s38, 3
  s_lshl_b32 s38, s38, 11
  v_add_u32 v113, s38, v114
  s_sub_u32 s38, s3, 3
  s_and_b32 s38, s38, 3
  s_mul_i32 s38, s38, 15360
  s_add_u32 s38, s38, 112640
  v_add_u32 v121, s38, v114
  v_add_u32 v122, s33, v114
  s_and_b32 s38, s28, 14
  s_add_u32 s38, s38, s36
  s_lshl_b32 s38, s38, 8
  s_add_u32 s38, s38, 2818304
  s_lshl_b32 s39, s29, 8
  s_add_u32 s39, s39, 2822400
  v_mov_b32 v133, s38
  v_writelane_b32 v133, s39, 1
  v_mov_b32 v134, 16
  v_writelane_b32 v134, 30, 1
  s_lshl_b32 s28, s28, 1
  s_add_u32 s28, s28, s36
  s_add_u32 s30, s30, 8388608
  s_lshl_b32 s38, s28, 19
  s_add_u32 s37, s30, s38
  s_xor_b32 s38, s38, 0x80000
  s_add_u32 s30, s30, s38
  s_lshl_b32 s40, s29, 5
  s_add_u32 s40, s40, s28
  s_lshl_b32 s38, s28, 6
  s_lshl_b32 s39, s3, 4
  s_add_u32 s38, s38, s39
  v_add_u32 v128, s38, v126
  v_mul_u32_u24 v117, 0x500, v128
  v_lshl_add_u32 v117, v127, 3, v117
  s_mul_i32 s38, s29, 160
  v_add_u32 v117, s38, v117
  s_mov_b32 s12, s60
  s_mov_b32 s13, s61
  s_mov_b32 s14, 2621440
  s_mov_b32 s15, 0x20000
  s_mov_b32 s16, s62
  s_mov_b32 s17, s63
  s_mov_b32 s18, 2621440
  s_mov_b32 s19, 0x20000
  s_mul_i32 s38, s28, 81920
  s_lshl_b32 s39, s3, 10
  s_add_u32 s38, s38, s39
  s_mul_i32 s39, s29, 10
  v_lshrrev_b32 v129, 1, v127
  v_add_u32 v129, s39, v129
  v_and_b32 v130, 1, v127
  v_lshlrev_b32 v130, 3, v130
  v_lshl_add_u32 v130, v126, 4, v130
  v_lshrrev_b32 v131, 2, v129
  v_lshl_add_u32 v131, v131, 12, v130
  v_and_b32 v132, 3, v129
  v_lshl_add_u32 v131, v132, 8, v131
  buffer_load_dwordx2 v[156:157], v131, s[24:27], s38 offen sc1
  v_add_u32 v129, 2, v129
  buffer_load_dwordx2 v[80:81], v117, s[12:15], 0 offen offset:0
  v_lshrrev_b32 v131, 2, v129
  v_lshl_add_u32 v131, v131, 12, v130
  v_and_b32 v132, 3, v129
  v_lshl_add_u32 v131, v132, 8, v131
  buffer_load_dwordx2 v[158:159], v131, s[24:27], s38 offen sc1
  v_add_u32 v129, 2, v129
  buffer_load_dwordx2 v[82:83], v117, s[12:15], 0 offen offset:32
  v_lshrrev_b32 v131, 2, v129
  v_lshl_add_u32 v131, v131, 12, v130
  v_and_b32 v132, 3, v129
  v_lshl_add_u32 v131, v132, 8, v131
  buffer_load_dwordx2 v[160:161], v131, s[24:27], s38 offen sc1
  v_add_u32 v129, 2, v129
  buffer_load_dwordx2 v[84:85], v117, s[12:15], 0 offen offset:64
  v_lshrrev_b32 v131, 2, v129
  v_lshl_add_u32 v131, v131, 12, v130
  v_and_b32 v132, 3, v129
  v_lshl_add_u32 v131, v132, 8, v131
  buffer_load_dwordx2 v[162:163], v131, s[24:27], s38 offen sc1
  v_add_u32 v129, 2, v129
  buffer_load_dwordx2 v[86:87], v117, s[12:15], 0 offen offset:96
  v_lshrrev_b32 v131, 2, v129
  v_lshl_add_u32 v131, v131, 12, v130
  v_and_b32 v132, 3, v129
  v_lshl_add_u32 v131, v132, 8, v131
  buffer_load_dwordx2 v[164:165], v131, s[24:27], s38 offen sc1
  v_add_u32 v129, 2, v129
  buffer_load_dwordx2 v[88:89], v117, s[12:15], 0 offen offset:128
  v_mov_b32 v123, 1073741824
  v_bfrev_b32 v124, 1
  v_sub_u32 v128, 0xffff, v128
  s_mov_b32 s34, 0xffff0000
  s_and_b32 s38, s52, 0xffff
  v_cmp_eq_u32 vcc, s38, v128
  v_mov_b32 v129, s52
  v_mov_b32 v130, 0
  v_cndmask_b32 v124, v124, v129, vcc
  v_cndmask_b32 v123, v123, v130, vcc
  s_and_b32 s38, s53, 0xffff
  v_cmp_eq_u32 vcc, s38, v128
  v_mov_b32 v129, s53
  v_mov_b32 v130, 2560
  v_cndmask_b32 v124, v124, v129, vcc
  v_cndmask_b32 v123, v123, v130, vcc
  s_and_b32 s38, s54, 0xffff
  v_cmp_eq_u32 vcc, s38, v128
  v_mov_b32 v129, s54
  v_mov_b32 v130, 5120
  v_cndmask_b32 v124, v124, v129, vcc
  v_cndmask_b32 v123, v123, v130, vcc
  s_and_b32 s38, s55, 0xffff
  v_cmp_eq_u32 vcc, s38, v128
  v_mov_b32 v129, s55
  v_mov_b32 v130, 7680
  v_cndmask_b32 v124, v124, v129, vcc
  v_cndmask_b32 v123, v123, v130, vcc
  s_and_b32 s38, s56, 0xffff
  v_cmp_eq_u32 vcc, s38, v128
  v_mov_b32 v129, s56
  v_mov_b32 v130, 10240
  v_cndmask_b32 v124, v124, v129, vcc
  v_cndmask_b32 v123, v123, v130, vcc
  s_and_b32 s38, s57, 0xffff
  v_cmp_eq_u32 vcc, s38, v128
  v_mov_b32 v129, s57
  v_mov_b32 v130, 12800
  v_cndmask_b32 v124, v124, v129, vcc
  v_cndmask_b32 v123, v123, v130, vcc
  s_and_b32 s38, s58, 0xffff
  v_cmp_eq_u32 vcc, s38, v128
  v_mov_b32 v129, s58
  v_mov_b32 v130, 15360
  v_cndmask_b32 v124, v124, v129, vcc
  v_cndmask_b32 v123, v123, v130, vcc
  s_and_b32 s38, s59, 0xffff
  v_cmp_eq_u32 vcc, s38, v128
  v_mov_b32 v129, s59
  v_mov_b32 v130, 17920
  v_cndmask_b32 v124, v124, v129, vcc
  v_cndmask_b32 v123, v123, v130, vcc
  v_lshl_add_u32 v123, v127, 4, v123
  s_mul_i32 s32, s29, 320
  s_add_u32 s32, s32, 2686976
  v_ashrrev_i32 v129, 31, v124
  v_not_b32 v129, v129
  v_or_b32 v129, 0x80000000, v129
  v_xor_b32 v124, v124, v129
  v_and_b32 v124, s34, v124
  v_mul_f32 v124, 0xbfb8aa3b, v124
  v_exp_f32 v124, v124
  s_nop 0
  v_add_f32 v124, 1.0, v124
  v_rcp_f32 v124, v124
  s_nop 0
  v_cvt_pk_bf16_f32 v124, v124, v124
  v_lshlrev_b32 v124, 16, v124
  s_xor_b32 s38, s40, 0
  s_lshl_b32 s38, s38, 2
  s_add_u32 s38, s38, s3
  s_lshl_b32 s38, s38, 13
  s_add_u32 s38, s38, 25165824
  s_add_u32 s39, s38, 4096
  buffer_load_dword v127, off, s[24:27], s39 offset:2048
  s_xor_b32 s38, s40, 1
  s_lshl_b32 s38, s38, 2
  s_add_u32 s38, s38, s3
  s_lshl_b32 s38, s38, 13
  s_add_u32 s38, s38, 25165824
  s_add_u32 s39, s38, 4096
  buffer_load_dword v127, off, s[24:27], s39 offset:2048
  s_bfe_u32 s38, s2, 0x40002
  s_lshl_b32 s38, s38, 8
  s_add_u32 s38, s38, 2818304
  s_mul_i32 s39, s99, 13108
  s_lshr_b32 s39, s39, 16
  s_lshl_b32 s39, s39, 8
  s_add_u32 s39, s39, 2822400
  s_cmp_lt_u32 s2, 240
  s_cselect_b32 s39, s39, 1073741824
  v_mov_b32 v135, 1073741824
  v_writelane_b32 v135, s38, 0
  v_writelane_b32 v135, s39, 1
  s_cmp_eq_u32 s3, 0
  s_cselect_b32 s38, 0, 1073741824
  v_or_b32 v135, s38, v135
  v_mov_b32 v129, 1
  s_waitcnt vmcnt(42)
  s_barrier
  buffer_atomic_add v129, v135, s[24:27], 0 offen
  buffer_load_dwordx4 a[40:43], v115, s[24:27], s6 offen offset:2048 sc1
  buffer_load_dwordx4 a[44:47], v115, s[24:27], s6 offen offset:3072 sc1
  buffer_load_dwordx4 a[48:51], v116, s[24:27], s6 offen offset:0 sc1
  buffer_load_dwordx4 a[52:55], v116, s[24:27], s6 offen offset:1024 sc1
  buffer_load_dwordx4 a[56:59], v116, s[24:27], s6 offen offset:2048 sc1
  buffer_load_dwordx4 a[60:63], v116, s[24:27], s6 offen offset:3072 sc1
  buffer_load_dwordx4 a[64:67], v114, s[24:27], s7 offen offset:0 sc1
  buffer_load_dwordx4 a[68:71], v114, s[24:27], s7 offen offset:1024 sc1
  buffer_load_dwordx4 a[72:75], v114, s[24:27], s7 offen offset:2048 sc1
  buffer_load_dwordx4 a[76:79], v114, s[24:27], s7 offen offset:3072 sc1
  buffer_load_dwordx4 a[80:83], v115, s[24:27], s7 offen offset:0 sc1
  buffer_load_dwordx4 a[84:87], v115, s[24:27], s7 offen offset:1024 sc1
  buffer_load_dwordx4 a[88:91], v115, s[24:27], s7 offen offset:2048 sc1
  buffer_load_dwordx4 a[92:95], v115, s[24:27], s7 offen offset:3072 sc1
  buffer_load_dwordx4 a[96:99], v116, s[24:27], s7 offen offset:0 sc1
  buffer_load_dwordx4 a[100:103], v116, s[24:27], s7 offen offset:1024 sc1
  buffer_load_dwordx4 a[104:107], v116, s[24:27], s7 offen offset:2048 sc1
  buffer_load_dwordx4 a[108:111], v116, s[24:27], s7 offen offset:3072 sc1
  buffer_load_dwordx4 a[112:115], v114, s[24:27], s8 offen offset:0 sc1
  s_waitcnt vmcnt(60)
  buffer_load_dwordx4 a[116:119], v114, s[24:27], s8 offen offset:1024 sc1
  buffer_load_dwordx4 a[120:123], v114, s[24:27], s8 offen offset:2048 sc1
  s_waitcnt vmcnt(60)
  buffer_load_dwordx4 a[124:127], v114, s[24:27], s8 offen offset:3072 sc1
  buffer_load_dwordx4 a[128:131], v115, s[24:27], s8 offen offset:0 sc1
  s_waitcnt vmcnt(60)
  buffer_load_dwordx4 a[132:135], v115, s[24:27], s8 offen offset:1024 sc1
  buffer_load_dwordx4 a[136:139], v115, s[24:27], s8 offen offset:2048 sc1
  s_waitcnt vmcnt(60)
  buffer_load_dwordx4 a[140:143], v115, s[24:27], s8 offen offset:3072 sc1
  s_add_u32 m0, s33, 0
  s_nop 0
  buffer_load_dwordx4 v116, s[24:27], s8 offen offset:0 sc1 lds
  s_add_u32 m0, s33, 0
  s_waitcnt vmcnt(60)
  buffer_load_dwordx4 v116, s[24:27], s8 offen offset:1024 sc1 lds
  s_add_u32 m0, s33, 0
  s_nop 0
  buffer_load_dwordx4 v116, s[24:27], s8 offen offset:2048 sc1 lds
  s_add_u32 m0, s33, 0
  s_waitcnt vmcnt(60)
  buffer_load_dwordx4 v116, s[24:27], s8 offen offset:3072 sc1 lds
  buffer_load_dword v128, v133, s[24:27], 0 offen sc1
  s_add_u32 m0, s33, 4096
  s_waitcnt vmcnt(60)
  buffer_load_dwordx4 v114, s[24:27], s9 offen offset:0 sc1 lds
  s_add_u32 m0, s33, 4096
  s_nop 0
  buffer_load_dwordx4 v114, s[24:27], s9 offen offset:1024 sc1 lds
  s_add_u32 m0, s33, 4096
  s_waitcnt vmcnt(60)
  buffer_load_dwordx4 v114, s[24:27], s9 offen offset:2048 sc1 lds
  s_add_u32 m0, s33, 4096
  s_nop 0
  buffer_load_dwordx4 v114, s[24:27], s9 offen offset:3072 sc1 lds
  s_add_u32 m0, s33, 8192
  s_waitcnt vmcnt(60)
  buffer_load_dwordx4 v115, s[24:27], s9 offen offset:0 sc1 lds
  s_add_u32 m0, s33, 8192
  s_nop 0
  buffer_load_dwordx4 v115, s[24:27], s9 offen offset:1024 sc1 lds
  s_add_u32 m0, s33, 8192
  s_waitcnt vmcnt(60)
  buffer_load_dwordx4 v115, s[24:27], s9 offen offset:2048 sc1 lds
  s_add_u32 m0, s33, 8192
  s_nop 0
  buffer_load_dwordx4 v115, s[24:27], s9 offen offset:3072 sc1 lds
  s_add_u32 m0, s33, 12288
  s_waitcnt vmcnt(60)
  buffer_load_dwordx4 v116, s[24:27], s9 offen offset:0 sc1 lds
  s_add_u32 m0, s33, 12288
  s_nop 0
  buffer_load_dwordx4 v116, s[24:27], s9 offen offset:1024 sc1 lds
  s_add_u32 m0, s33, 12288
  s_waitcnt vmcnt(60)
  buffer_load_dwordx4 v116, s[24:27], s9 offen offset:2048 sc1 lds
  s_add_u32 m0, s33, 12288
  s_nop 0
  buffer_load_dwordx4 v116, s[24:27], s9 offen offset:3072 sc1 lds
  s_add_u32 m0, s33, 16384
  s_waitcnt vmcnt(60)
  buffer_load_dwordx4 v114, s[24:27], s10 offen offset:0 sc1 lds
  s_add_u32 m0, s33, 16384
  s_nop 0
  buffer_load_dwordx4 v114, s[24:27], s10 offen offset:1024 sc1 lds
  s_add_u32 m0, s33, 16384
  s_waitcnt vmcnt(60)
  buffer_load_dwordx4 v114, s[24:27], s10 offen offset:2048 sc1 lds
  s_add_u32 m0, s33, 16384
  s_nop 0
  buffer_load_dwordx4 v114, s[24:27], s10 offen offset:3072 sc1 lds
  s_add_u32 m0, s33, 20480
  s_waitcnt vmcnt(60)
  buffer_load_dwordx4 v115, s[24:27], s10 offen offset:0 sc1 lds
  s_add_u32 m0, s33, 20480
  s_nop 0
  buffer_load_dwordx4 v115, s[24:27], s10 offen offset:1024 sc1 lds
  s_add_u32 m0, s33, 20480
  s_waitcnt vmcnt(60)
  buffer_load_dwordx4 v115, s[24:27], s10 offen offset:2048 sc1 lds
  s_add_u32 m0, s33, 20480
  s_nop 0
  buffer_load_dwordx4 v115, s[24:27], s10 offen offset:3072 sc1 lds
  v_lshlrev_b32 v90, 16, v156
  v_and_b32 v91, s34, v156
  v_lshlrev_b32 v92, 16, v157
  v_and_b32 v93, s34, v157
  s_waitcnt vmcnt(61)
  v_lshlrev_b32 v94, 16, v158
  v_and_b32 v95, s34, v158
  v_lshlrev_b32 v96, 16, v159
  v_and_b32 v97, s34, v159
  s_waitcnt vmcnt(59)
  v_lshlrev_b32 v98, 16, v160
  v_and_b32 v99, s34, v160
  v_lshlrev_b32 v100, 16, v161
  v_and_b32 v101, s34, v161
  s_waitcnt vmcnt(57)
  v_lshlrev_b32 v102, 16, v162
  v_and_b32 v103, s34, v162
  v_lshlrev_b32 v104, 16, v163
  v_and_b32 v105, s34, v163
  s_waitcnt vmcnt(55)
  v_lshlrev_b32 v106, 16, v164
  v_and_b32 v107, s34, v164
  v_lshlrev_b32 v108, 16, v165
  v_and_b32 v109, s34, v165
  v_mov_b32 v156, 0
  v_mov_b32 v157, 0
  v_mov_b32 v158, 0
  v_mov_b32 v159, 0
  v_mov_b32 v160, 0
  v_mov_b32 v161, 0
  v_mov_b32 v162, 0
  v_mov_b32 v163, 0
  v_mov_b32 v164, 0
  v_mov_b32 v165, 0
  v_mov_b32 v166, 0
  v_mov_b32 v167, 0
  v_mov_b32 v168, 0
  v_mov_b32 v169, 0
  v_mov_b32 v170, 0
  v_mov_b32 v171, 0
  v_mov_b32 v172, 0
  v_mov_b32 v173, 0
  v_mov_b32 v174, 0
  v_mov_b32 v175, 0
  s_waitcnt vmcnt(20)
  v_cmp_lt_u32 vcc, v128, v134
  s_nop 0
  s_cbranch_vccz tail_ready
  s_mov_b32 s35, 32768
tail_spin:
  s_sleep 2
  buffer_load_dword v128, v133, s[24:27], 0 offen sc1
  s_waitcnt vmcnt(0)
  v_cmp_lt_u32 vcc, v128, v134
  s_nop 0
  s_cbranch_vccz tail_ready
  s_sub_u32 s35, s35, 1
  s_cmp_lg_u32 s35, 0
  s_cbranch_scc1 tail_spin
tail_ready:
  buffer_load_dwordx4 a[144:147], v110, s[24:27], s30 offen offset:0 sc1
  buffer_load_dwordx4 a[148:151], v110, s[24:27], s30 offen offset:1024 sc1
  buffer_load_dwordx4 a[152:155], v111, s[24:27], s30 offen offset:0 sc1
  buffer_load_dwordx4 a[156:159], v111, s[24:27], s30 offen offset:1024 sc1
  buffer_load_dwordx4 a[160:163], v112, s[24:27], s30 offen offset:0 sc1
  buffer_load_dwordx4 a[164:167], v112, s[24:27], s30 offen offset:1024 sc1
  buffer_load_dwordx4 a[168:171], v113, s[24:27], s30 offen offset:0 sc1
  buffer_load_dwordx4 a[172:175], v113, s[24:27], s30 offen offset:1024 sc1
  s_add_u32 s30, s30, 8192
  buffer_load_dwordx4 a[176:179], v110, s[24:27], s30 offen offset:0 sc1
  buffer_load_dwordx4 a[180:183], v110, s[24:27], s30 offen offset:1024 sc1
  buffer_load_dwordx4 a[184:187], v111, s[24:27], s30 offen offset:0 sc1
  buffer_load_dwordx4 a[188:191], v111, s[24:27], s30 offen offset:1024 sc1
  v_cmp_gt_u32 vcc, 1073741824, v123
  s_nop 0
  s_and_saveexec_b64 s[42:43], vcc
  s_cbranch_execz tail_plain
  s_waitcnt vmcnt(30)
  buffer_load_dwordx4 v[156:159], v123, s[24:27], s32 offen offset:0 sc1
  buffer_load_dwordx4 v[160:163], v123, s[24:27], s32 offen offset:64 sc1
  buffer_load_dwordx4 v[164:167], v123, s[24:27], s32 offen offset:128 sc1
  buffer_load_dwordx4 v[168:171], v123, s[24:27], s32 offen offset:192 sc1
  buffer_load_dwordx4 v[172:175], v123, s[24:27], s32 offen offset:256 sc1
  s_add_u32 s32, s32, 20480
  buffer_load_dwordx4 v[136:139], v123, s[24:27], s32 offen offset:0 sc1
  buffer_load_dwordx4 v[140:143], v123, s[24:27], s32 offen offset:64 sc1
  buffer_load_dwordx4 v[144:147], v123, s[24:27], s32 offen offset:128 sc1
  buffer_load_dwordx4 v[148:151], v123, s[24:27], s32 offen offset:192 sc1
  buffer_load_dwordx4 v[152:155], v123, s[24:27], s32 offen offset:256 sc1
  s_add_u32 s32, s32, 20480
  buffer_load_dwordx4 v[0:3], v123, s[24:27], s32 offen offset:0 sc1
  buffer_load_dwordx4 v[4:7], v123, s[24:27], s32 offen offset:64 sc1
  buffer_load_dwordx4 v[8:11], v123, s[24:27], s32 offen offset:128 sc1
  buffer_load_dwordx4 v[12:15], v123, s[24:27], s32 offen offset:192 sc1
  buffer_load_dwordx4 v[16:19], v123, s[24:27], s32 offen offset:256 sc1
  s_add_u32 s32, s32, 20480
  buffer_load_dwordx4 v[20:23], v123, s[24:27], s32 offen offset:0 sc1
  buffer_load_dwordx4 v[24:27], v123, s[24:27], s32 offen offset:64 sc1
  buffer_load_dwordx4 v[28:31], v123, s[24:27], s32 offen offset:128 sc1
  buffer_load_dwordx4 v[32:35], v123, s[24:27], s32 offen offset:192 sc1
  buffer_load_dwordx4 v[36:39], v123, s[24:27], s32 offen offset:256 sc1
  s_add_u32 s32, s32, 20480
  buffer_load_dwordx4 v[40:43], v123, s[24:27], s32 offen offset:0 sc1
  buffer_load_dwordx4 v[44:47], v123, s[24:27], s32 offen offset:64 sc1
  buffer_load_dwordx4 v[48:51], v123, s[24:27], s32 offen offset:128 sc1
  buffer_load_dwordx4 v[52:55], v123, s[24:27], s32 offen offset:192 sc1
  buffer_load_dwordx4 v[56:59], v123, s[24:27], s32 offen offset:256 sc1
  s_add_u32 s32, s32, 20480
  buffer_load_dwordx4 v[60:63], v123, s[24:27], s32 offen offset:0 sc1
  buffer_load_dwordx4 v[64:67], v123, s[24:27], s32 offen offset:64 sc1
  buffer_load_dwordx4 v[68:71], v123, s[24:27], s32 offen offset:128 sc1
  buffer_load_dwordx4 v[72:75], v123, s[24:27], s32 offen offset:192 sc1
  buffer_load_dwordx4 v[76:79], v123, s[24:27], s32 offen offset:256 sc1
  s_add_u32 s32, s32, 20480
  s_waitcnt vmcnt(0)
  v_add_f32 v156, v156, v136
  v_add_f32 v157, v157, v137
  v_add_f32 v158, v158, v138
  v_add_f32 v159, v159, v139
  v_add_f32 v160, v160, v140
  v_add_f32 v161, v161, v141
  v_add_f32 v162, v162, v142
  v_add_f32 v163, v163, v143
  v_add_f32 v164, v164, v144
  v_add_f32 v165, v165, v145
  v_add_f32 v166, v166, v146
  v_add_f32 v167, v167, v147
  v_add_f32 v168, v168, v148
  v_add_f32 v169, v169, v149
  v_add_f32 v170, v170, v150
  v_add_f32 v171, v171, v151
  v_add_f32 v172, v172, v152
  v_add_f32 v173, v173, v153
  v_add_f32 v174, v174, v154
  v_add_f32 v175, v175, v155
  v_add_f32 v156, v156, v0
  v_add_f32 v157, v157, v1
  v_add_f32 v158, v158, v2
  v_add_f32 v159, v159, v3
  v_add_f32 v160, v160, v4
  v_add_f32 v161, v161, v5
  v_add_f32 v162, v162, v6
  v_add_f32 v163, v163, v7
  v_add_f32 v164, v164, v8
  v_add_f32 v165, v165, v9
  v_add_f32 v166, v166, v10
  v_add_f32 v167, v167, v11
  v_add_f32 v168, v168, v12
  v_add_f32 v169, v169, v13
  v_add_f32 v170, v170, v14
  v_add_f32 v171, v171, v15
  v_add_f32 v172, v172, v16
  v_add_f32 v173, v173, v17
  v_add_f32 v174, v174, v18
  v_add_f32 v175, v175, v19
  v_add_f32 v156, v156, v20
  v_add_f32 v157, v157, v21
  v_add_f32 v158, v158, v22
  v_add_f32 v159, v159, v23
  v_add_f32 v160, v160, v24
  v_add_f32 v161, v161, v25
  v_add_f32 v162, v162, v26
  v_add_f32 v163, v163, v27
  v_add_f32 v164, v164, v28
  v_add_f32 v165, v165, v29
  v_add_f32 v166, v166, v30
  v_add_f32 v167, v167, v31
  v_add_f32 v168, v168, v32
  v_add_f32 v169, v169, v33
  v_add_f32 v170, v170, v34
  v_add_f32 v171, v171, v35
  v_add_f32 v172, v172, v36
  v_add_f32 v173, v173, v37
  v_add_f32 v174, v174, v38
  v_add_f32 v175, v175, v39
  v_add_f32 v156, v156, v40
  v_add_f32 v157, v157, v41
  v_add_f32 v158, v158, v42
  v_add_f32 v159, v159, v43
  v_add_f32 v160, v160, v44
  v_add_f32 v161, v161, v45
  v_add_f32 v162, v162, v46
  v_add_f32 v163, v163, v47
  v_add_f32 v164, v164, v48
  v_add_f32 v165, v165, v49
  v_add_f32 v166, v166, v50
  v_add_f32 v167, v167, v51
  v_add_f32 v168, v168, v52
  v_add_f32 v169, v169, v53
  v_add_f32 v170, v170, v54
  v_add_f32 v171, v171, v55
  v_add_f32 v172, v172, v56
  v_add_f32 v173, v173, v57
  v_add_f32 v174, v174, v58
  v_add_f32 v175, v175, v59
  v_add_f32 v156, v156, v60
  v_add_f32 v157, v157, v61
  v_add_f32 v158, v158, v62
  v_add_f32 v159, v159, v63
  v_add_f32 v160, v160, v64
  v_add_f32 v161, v161, v65
  v_add_f32 v162, v162, v66
  v_add_f32 v163, v163, v67
  v_add_f32 v164, v164, v68
  v_add_f32 v165, v165, v69
  v_add_f32 v166, v166, v70
  v_add_f32 v167, v167, v71
  v_add_f32 v168, v168, v72
  v_add_f32 v169, v169, v73
  v_add_f32 v170, v170, v74
  v_add_f32 v171, v171, v75
  v_add_f32 v172, v172, v76
  v_add_f32 v173, v173, v77
  v_add_f32 v174, v174, v78
  v_add_f32 v175, v175, v79
tail_plain:
  s_mov_b64 exec, s[42:43]
  s_waitcnt vmcnt(4)
  v_mfma_f32_16x16x32_bf16 v[0:3], v[176:179], a[144:147], 0
  buffer_load_dwordx4 a[192:195], v112, s[24:27], s30 offen offset:0 sc1
  v_mfma_f32_16x16x32_bf16 v[0:3], v[196:199], a[148:151], v[0:3]
  buffer_load_dwordx4 a[196:199], v112, s[24:27], s30 offen offset:1024 sc1
  v_mfma_f32_16x16x32_bf16 v[4:7], v[196:199], a[156:159], 0
  buffer_load_dwordx4 a[200:203], v113, s[24:27], s30 offen offset:0 sc1
  v_mfma_f32_16x16x32_bf16 v[4:7], v[176:179], a[152:155], v[4:7]
  buffer_load_dwordx4 a[204:207], v113, s[24:27], s30 offen offset:1024 sc1
  s_add_u32 s30, s30, 8192
  v_mfma_f32_16x16x32_bf16 v[8:11], v[176:179], a[160:163], 0
  buffer_load_dwordx4 a[208:211], v110, s[24:27], s30 offen offset:0 sc1
  v_mfma_f32_16x16x32_bf16 v[8:11], v[196:199], a[164:167], v[8:11]
  buffer_load_dwordx4 a[212:215], v110, s[24:27], s30 offen offset:1024 sc1
  v_mfma_f32_16x16x32_bf16 v[12:15], v[196:199], a[172:175], 0
  v_cvt_pk_bf16_f32 v156, v156, v156
  v_cvt_pk_bf16_f32 v157, v157, v157
  v_mfma_f32_16x16x32_bf16 v[12:15], v[176:179], a[168:171], v[12:15]
  v_cvt_pk_bf16_f32 v158, v158, v158
  v_cvt_pk_bf16_f32 v159, v159, v159
  v_mfma_f32_16x16x32_bf16 v[16:19], v[180:183], a[144:147], 0
  buffer_load_dwordx4 a[216:219], v111, s[24:27], s30 offen offset:0 sc1
  v_mfma_f32_16x16x32_bf16 v[16:19], v[200:203], a[148:151], v[16:19]
  buffer_load_dwordx4 a[220:223], v111, s[24:27], s30 offen offset:1024 sc1
  v_mfma_f32_16x16x32_bf16 v[20:23], v[200:203], a[156:159], 0
  buffer_load_dwordx4 a[224:227], v112, s[24:27], s30 offen offset:0 sc1
  v_mfma_f32_16x16x32_bf16 v[20:23], v[180:183], a[152:155], v[20:23]
  buffer_load_dwordx4 a[228:231], v112, s[24:27], s30 offen offset:1024 sc1
  v_mfma_f32_16x16x32_bf16 v[24:27], v[180:183], a[160:163], 0
  buffer_load_dwordx4 a[232:235], v113, s[24:27], s30 offen offset:0 sc1
  v_mfma_f32_16x16x32_bf16 v[24:27], v[200:203], a[164:167], v[24:27]
  buffer_load_dwordx4 a[236:239], v113, s[24:27], s30 offen offset:1024 sc1
  v_mfma_f32_16x16x32_bf16 v[28:31], v[200:203], a[172:175], 0
  v_lshlrev_b32 v156, 16, v156
  v_lshlrev_b32 v157, 16, v157
  v_mfma_f32_16x16x32_bf16 v[28:31], v[180:183], a[168:171], v[28:31]
  v_lshlrev_b32 v158, 16, v158
  v_lshlrev_b32 v159, 16, v159
  v_mfma_f32_16x16x32_bf16 v[32:35], v[184:187], a[144:147], 0
  s_add_u32 s30, s30, 8192
  buffer_load_dwordx4 a[240:243], v110, s[24:27], s30 offen offset:0 sc1
  v_mfma_f32_16x16x32_bf16 v[32:35], v[204:207], a[148:151], v[32:35]
  buffer_load_dwordx4 a[244:247], v110, s[24:27], s30 offen offset:1024 sc1
  v_mfma_f32_16x16x32_bf16 v[36:39], v[204:207], a[156:159], 0
  buffer_load_dwordx4 a[248:251], v111, s[24:27], s30 offen offset:0 sc1
  v_mfma_f32_16x16x32_bf16 v[36:39], v[184:187], a[152:155], v[36:39]
  buffer_load_dwordx4 a[252:255], v111, s[24:27], s30 offen offset:1024 sc1
  v_mfma_f32_16x16x32_bf16 v[40:43], v[184:187], a[160:163], 0
  buffer_load_dwordx4 v[136:139], v112, s[24:27], s30 offen offset:0 sc1
  v_mfma_f32_16x16x32_bf16 v[40:43], v[204:207], a[164:167], v[40:43]
  buffer_load_dwordx4 v[140:143], v112, s[24:27], s30 offen offset:1024 sc1
  v_mfma_f32_16x16x32_bf16 v[44:47], v[204:207], a[172:175], 0
  v_mul_f32 v156, v156, v124
  v_mul_f32 v157, v157, v124
  v_mfma_f32_16x16x32_bf16 v[44:47], v[184:187], a[168:171], v[44:47]
  v_mul_f32 v158, v158, v124
  v_mul_f32 v159, v159, v124
  v_mfma_f32_16x16x32_bf16 v[48:51], v[188:191], a[144:147], 0
  buffer_load_dwordx4 v[144:147], v113, s[24:27], s30 offen offset:0 sc1
  v_mfma_f32_16x16x32_bf16 v[48:51], v[208:211], a[148:151], v[48:51]
  buffer_load_dwordx4 v[148:151], v113, s[24:27], s30 offen offset:1024 sc1
  s_add_u32 s30, s30, 8192
  v_mfma_f32_16x16x32_bf16 v[52:55], v[208:211], a[156:159], 0
  buffer_load_dwordx4 v[152:155], v110, s[24:27], s30 offen offset:0 sc1
  v_mfma_f32_16x16x32_bf16 v[52:55], v[188:191], a[152:155], v[52:55]
  v_cvt_pk_bf16_f32 v156, v156, v156
  v_cvt_pk_bf16_f32 v157, v157, v157
  v_mfma_f32_16x16x32_bf16 v[56:59], v[188:191], a[160:163], 0
  v_cvt_pk_bf16_f32 v158, v158, v158
  v_cvt_pk_bf16_f32 v159, v159, v159
  v_mfma_f32_16x16x32_bf16 v[56:59], v[208:211], a[164:167], v[56:59]
  v_lshlrev_b32 v156, 16, v156
  v_lshlrev_b32 v157, 16, v157
  v_mfma_f32_16x16x32_bf16 v[60:63], v[208:211], a[172:175], 0
  v_lshlrev_b32 v158, 16, v158
  v_lshlrev_b32 v159, 16, v159
  v_mfma_f32_16x16x32_bf16 v[60:63], v[188:191], a[168:171], v[60:63]
  v_add_f32 v90, v90, v156
  v_add_f32 v91, v91, v157
  v_mfma_f32_16x16x32_bf16 v[64:67], v[192:195], a[144:147], 0
  v_add_f32 v92, v92, v158
  v_add_f32 v93, v93, v159
  v_mfma_f32_16x16x32_bf16 v[64:67], v[212:215], a[148:151], v[64:67]
  v_cvt_pk_bf16_f32 v90, v90, v90
  v_cvt_pk_bf16_f32 v91, v91, v91
  v_mfma_f32_16x16x32_bf16 v[68:71], v[212:215], a[156:159], 0
  v_cvt_pk_bf16_f32 v92, v92, v92
  v_cvt_pk_bf16_f32 v93, v93, v93
  v_mfma_f32_16x16x32_bf16 v[68:71], v[192:195], a[152:155], v[68:71]
  v_lshlrev_b32 v90, 16, v90
  v_lshlrev_b32 v91, 16, v91
  v_mfma_f32_16x16x32_bf16 v[72:75], v[192:195], a[160:163], 0
  v_lshlrev_b32 v92, 16, v92
  v_lshlrev_b32 v93, 16, v93
  v_mfma_f32_16x16x32_bf16 v[72:75], v[212:215], a[164:167], v[72:75]
  v_mul_f32 v129, 0xbfb8aa3b, v90
  v_mul_f32 v130, 0xbfb8aa3b, v91
  v_mfma_f32_16x16x32_bf16 v[76:79], v[212:215], a[172:175], 0
  v_mul_f32 v131, 0xbfb8aa3b, v92
  v_mul_f32 v132, 0xbfb8aa3b, v93
  v_mfma_f32_16x16x32_bf16 v[76:79], v[192:195], a[168:171], v[76:79]
  v_exp_f32 v129, v129
  s_waitcnt vmcnt(17)
  v_mfma_f32_16x16x32_bf16 v[0:3], v[216:219], a[176:179], v[0:3]
  buffer_load_dwordx4 a[144:147], v110, s[24:27], s30 offen offset:1024 sc1
  v_mfma_f32_16x16x32_bf16 v[0:3], v[236:239], a[180:183], v[0:3]
  buffer_load_dwordx4 a[148:151], v111, s[24:27], s30 offen offset:0 sc1
  v_mfma_f32_16x16x32_bf16 v[4:7], v[236:239], a[188:191], v[4:7]
  buffer_load_dwordx4 a[152:155], v111, s[24:27], s30 offen offset:1024 sc1
  v_mfma_f32_16x16x32_bf16 v[4:7], v[216:219], a[184:187], v[4:7]
  buffer_load_dwordx4 a[156:159], v112, s[24:27], s30 offen offset:0 sc1
  v_mfma_f32_16x16x32_bf16 v[8:11], v[216:219], a[192:195], v[8:11]
  buffer_load_dwordx4 a[160:163], v112, s[24:27], s30 offen offset:1024 sc1
  v_mfma_f32_16x16x32_bf16 v[8:11], v[236:239], a[196:199], v[8:11]
  buffer_load_dwordx4 a[164:167], v113, s[24:27], s30 offen offset:0 sc1
  v_mfma_f32_16x16x32_bf16 v[12:15], v[236:239], a[204:207], v[12:15]
  v_exp_f32 v130, v130
  v_mfma_f32_16x16x32_bf16 v[12:15], v[216:219], a[200:203], v[12:15]
  v_exp_f32 v131, v131
  v_mfma_f32_16x16x32_bf16 v[16:19], v[220:223], a[176:179], v[16:19]
  buffer_load_dwordx4 a[168:171], v113, s[24:27], s30 offen offset:1024 sc1
  s_add_u32 s30, s30, 8192
  v_mfma_f32_16x16x32_bf16 v[16:19], v[240:243], a[180:183], v[16:19]
  buffer_load_dwordx4 a[172:175], v110, s[24:27], s30 offen offset:0 sc1
  v_mfma_f32_16x16x32_bf16 v[20:23], v[240:243], a[188:191], v[20:23]
  v_exp_f32 v132, v132
  v_mfma_f32_16x16x32_bf16 v[20:23], v[220:223], a[184:187], v[20:23]
  v_add_f32 v129, 1.0, v129
  v_add_f32 v130, 1.0, v130
  v_mfma_f32_16x16x32_bf16 v[24:27], v[220:223], a[192:195], v[24:27]
  v_add_f32 v131, 1.0, v131
  v_add_f32 v132, 1.0, v132
  v_mfma_f32_16x16x32_bf16 v[24:27], v[240:243], a[196:199], v[24:27]
  v_rcp_f32 v129, v129
  v_mfma_f32_16x16x32_bf16 v[28:31], v[240:243], a[204:207], v[28:31]
  v_rcp_f32 v130, v130
  v_mfma_f32_16x16x32_bf16 v[28:31], v[220:223], a[200:203], v[28:31]
  v_rcp_f32 v131, v131
  v_mfma_f32_16x16x32_bf16 v[32:35], v[224:227], a[176:179], v[32:35]
  v_rcp_f32 v132, v132
  v_mfma_f32_16x16x32_bf16 v[32:35], v[244:247], a[180:183], v[32:35]
  v_mul_f32 v90, v90, v129
  v_mul_f32 v91, v91, v130
  v_mfma_f32_16x16x32_bf16 v[36:39], v[244:247], a[188:191], v[36:39]
  v_mul_f32 v92, v92, v131
  v_mul_f32 v93, v93, v132
  v_mfma_f32_16x16x32_bf16 v[36:39], v[224:227], a[184:187], v[36:39]
  v_cvt_pk_bf16_f32 v90, v90, v90
  v_cvt_pk_bf16_f32 v91, v91, v91
  v_mfma_f32_16x16x32_bf16 v[40:43], v[224:227], a[192:195], v[40:43]
  v_cvt_pk_bf16_f32 v92, v92, v92
  v_cvt_pk_bf16_f32 v93, v93, v93
  v_mfma_f32_16x16x32_bf16 v[40:43], v[244:247], a[196:199], v[40:43]
  v_lshlrev_b32 v90, 16, v90
  v_lshlrev_b32 v91, 16, v91
  v_mfma_f32_16x16x32_bf16 v[44:47], v[244:247], a[204:207], v[44:47]
  v_lshlrev_b32 v92, 16, v92
  v_lshlrev_b32 v93, 16, v93
  v_mfma_f32_16x16x32_bf16 v[44:47], v[224:227], a[200:203], v[44:47]
  v_cvt_pk_bf16_f32 v160, v160, v160
  v_cvt_pk_bf16_f32 v161, v161, v161
  v_mfma_f32_16x16x32_bf16 v[48:51], v[228:231], a[176:179], v[48:51]
  v_cvt_pk_bf16_f32 v162, v162, v162
  v_cvt_pk_bf16_f32 v163, v163, v163
  v_mfma_f32_16x16x32_bf16 v[48:51], v[248:251], a[180:183], v[48:51]
  v_lshlrev_b32 v160, 16, v160
  v_lshlrev_b32 v161, 16, v161
  v_mfma_f32_16x16x32_bf16 v[52:55], v[248:251], a[188:191], v[52:55]
  v_lshlrev_b32 v162, 16, v162
  v_lshlrev_b32 v163, 16, v163
  v_mfma_f32_16x16x32_bf16 v[52:55], v[228:231], a[184:187], v[52:55]
  v_mul_f32 v160, v160, v124
  v_mul_f32 v161, v161, v124
  v_mfma_f32_16x16x32_bf16 v[56:59], v[228:231], a[192:195], v[56:59]
  v_mul_f32 v162, v162, v124
  v_mul_f32 v163, v163, v124
  v_mfma_f32_16x16x32_bf16 v[56:59], v[248:251], a[196:199], v[56:59]
  v_cvt_pk_bf16_f32 v160, v160, v160
  v_cvt_pk_bf16_f32 v161, v161, v161
  v_mfma_f32_16x16x32_bf16 v[60:63], v[248:251], a[204:207], v[60:63]
  v_cvt_pk_bf16_f32 v162, v162, v162
  v_cvt_pk_bf16_f32 v163, v163, v163
  v_mfma_f32_16x16x32_bf16 v[60:63], v[228:231], a[200:203], v[60:63]
  v_lshlrev_b32 v160, 16, v160
  v_lshlrev_b32 v161, 16, v161
  v_mfma_f32_16x16x32_bf16 v[64:67], v[232:235], a[176:179], v[64:67]
  v_lshlrev_b32 v162, 16, v162
  v_lshlrev_b32 v163, 16, v163
  v_mfma_f32_16x16x32_bf16 v[64:67], v[252:255], a[180:183], v[64:67]
  v_add_f32 v94, v94, v160
  v_add_f32 v95, v95, v161
  v_mfma_f32_16x16x32_bf16 v[68:71], v[252:255], a[188:191], v[68:71]
  v_add_f32 v96, v96, v162
  v_add_f32 v97, v97, v163
  v_mfma_f32_16x16x32_bf16 v[68:71], v[232:235], a[184:187], v[68:71]
  v_cvt_pk_bf16_f32 v94, v94, v94
  v_cvt_pk_bf16_f32 v95, v95, v95
  v_mfma_f32_16x16x32_bf16 v[72:75], v[232:235], a[192:195], v[72:75]
  v_cvt_pk_bf16_f32 v96, v96, v96
  v_cvt_pk_bf16_f32 v97, v97, v97
  v_mfma_f32_16x16x32_bf16 v[72:75], v[252:255], a[196:199], v[72:75]
  v_lshlrev_b32 v94, 16, v94
  v_lshlrev_b32 v95, 16, v95
  v_mfma_f32_16x16x32_bf16 v[76:79], v[252:255], a[204:207], v[76:79]
  v_lshlrev_b32 v96, 16, v96
  v_lshlrev_b32 v97, 16, v97
  v_mfma_f32_16x16x32_bf16 v[76:79], v[232:235], a[200:203], v[76:79]
  v_mul_f32 v129, 0xbfb8aa3b, v94
  v_mul_f32 v130, 0xbfb8aa3b, v95
  s_waitcnt vmcnt(17)
  v_mfma_f32_16x16x32_bf16 v[0:3], a[0:3], a[208:211], v[0:3]
  buffer_load_dwordx4 a[176:179], v110, s[24:27], s30 offen offset:1024 sc1
  v_mfma_f32_16x16x32_bf16 v[0:3], a[20:23], a[212:215], v[0:3]
  buffer_load_dwordx4 a[180:183], v111, s[24:27], s30 offen offset:0 sc1
  v_mfma_f32_16x16x32_bf16 v[4:7], a[20:23], a[220:223], v[4:7]
  buffer_load_dwordx4 a[184:187], v111, s[24:27], s30 offen offset:1024 sc1
  v_mfma_f32_16x16x32_bf16 v[4:7], a[0:3], a[216:219], v[4:7]
  buffer_load_dwordx4 a[188:191], v112, s[24:27], s30 offen offset:0 sc1
  v_mfma_f32_16x16x32_bf16 v[8:11], a[0:3], a[224:227], v[8:11]
  buffer_load_dwordx4 a[192:195], v112, s[24:27], s30 offen offset:1024 sc1
  v_mfma_f32_16x16x32_bf16 v[8:11], a[20:23], a[228:231], v[8:11]
  buffer_load_dwordx4 a[196:199], v113, s[24:27], s30 offen offset:0 sc1
  v_mfma_f32_16x16x32_bf16 v[12:15], a[20:23], a[236:239], v[12:15]
  v_mul_f32 v131, 0xbfb8aa3b, v96
  v_mul_f32 v132, 0xbfb8aa3b, v97
  v_mfma_f32_16x16x32_bf16 v[12:15], a[0:3], a[232:235], v[12:15]
  v_exp_f32 v129, v129
  v_mfma_f32_16x16x32_bf16 v[16:19], a[4:7], a[208:211], v[16:19]
  buffer_load_dwordx4 a[200:203], v113, s[24:27], s30 offen offset:1024 sc1
  s_add_u32 s30, s30, 8192
  v_mfma_f32_16x16x32_bf16 v[16:19], a[24:27], a[212:215], v[16:19]
  buffer_load_dwordx4 a[204:207], v110, s[24:27], s30 offen offset:0 sc1
  v_mfma_f32_16x16x32_bf16 v[20:23], a[24:27], a[220:223], v[20:23]
  v_exp_f32 v130, v130
  v_mfma_f32_16x16x32_bf16 v[20:23], a[4:7], a[216:219], v[20:23]
  v_exp_f32 v131, v131
  v_mfma_f32_16x16x32_bf16 v[24:27], a[4:7], a[224:227], v[24:27]
  v_exp_f32 v132, v132
  v_mfma_f32_16x16x32_bf16 v[24:27], a[24:27], a[228:231], v[24:27]
  v_add_f32 v129, 1.0, v129
  v_add_f32 v130, 1.0, v130
  v_mfma_f32_16x16x32_bf16 v[28:31], a[24:27], a[236:239], v[28:31]
  v_add_f32 v131, 1.0, v131
  v_add_f32 v132, 1.0, v132
  v_mfma_f32_16x16x32_bf16 v[28:31], a[4:7], a[232:235], v[28:31]
  v_rcp_f32 v129, v129
  v_mfma_f32_16x16x32_bf16 v[32:35], a[8:11], a[208:211], v[32:35]
  v_rcp_f32 v130, v130
  v_mfma_f32_16x16x32_bf16 v[32:35], a[28:31], a[212:215], v[32:35]
  v_rcp_f32 v131, v131
  v_mfma_f32_16x16x32_bf16 v[36:39], a[28:31], a[220:223], v[36:39]
  v_rcp_f32 v132, v132
  v_mfma_f32_16x16x32_bf16 v[36:39], a[8:11], a[216:219], v[36:39]
  v_mul_f32 v94, v94, v129
  v_mul_f32 v95, v95, v130
  v_mfma_f32_16x16x32_bf16 v[40:43], a[8:11], a[224:227], v[40:43]
  v_mul_f32 v96, v96, v131
  v_mul_f32 v97, v97, v132
  v_mfma_f32_16x16x32_bf16 v[40:43], a[28:31], a[228:231], v[40:43]
  v_cvt_pk_bf16_f32 v94, v94, v94
  v_cvt_pk_bf16_f32 v95, v95, v95
  v_mfma_f32_16x16x32_bf16 v[44:47], a[28:31], a[236:239], v[44:47]
  v_cvt_pk_bf16_f32 v96, v96, v96
  v_cvt_pk_bf16_f32 v97, v97, v97
  v_mfma_f32_16x16x32_bf16 v[44:47], a[8:11], a[232:235], v[44:47]
  v_lshlrev_b32 v94, 16, v94
  v_lshlrev_b32 v95, 16, v95
  v_mfma_f32_16x16x32_bf16 v[48:51], a[12:15], a[208:211], v[48:51]
  v_lshlrev_b32 v96, 16, v96
  v_lshlrev_b32 v97, 16, v97
  v_mfma_f32_16x16x32_bf16 v[48:51], a[32:35], a[212:215], v[48:51]
  v_cvt_pk_bf16_f32 v164, v164, v164
  v_cvt_pk_bf16_f32 v165, v165, v165
  v_mfma_f32_16x16x32_bf16 v[52:55], a[32:35], a[220:223], v[52:55]
  v_cvt_pk_bf16_f32 v166, v166, v166
  v_cvt_pk_bf16_f32 v167, v167, v167
  v_mfma_f32_16x16x32_bf16 v[52:55], a[12:15], a[216:219], v[52:55]
  v_lshlrev_b32 v164, 16, v164
  v_lshlrev_b32 v165, 16, v165
  v_mfma_f32_16x16x32_bf16 v[56:59], a[12:15], a[224:227], v[56:59]
  v_lshlrev_b32 v166, 16, v166
  v_lshlrev_b32 v167, 16, v167
  v_mfma_f32_16x16x32_bf16 v[56:59], a[32:35], a[228:231], v[56:59]
  v_mul_f32 v164, v164, v124
  v_mul_f32 v165, v165, v124
  v_mfma_f32_16x16x32_bf16 v[60:63], a[32:35], a[236:239], v[60:63]
  v_mul_f32 v166, v166, v124
  v_mul_f32 v167, v167, v124
  v_mfma_f32_16x16x32_bf16 v[60:63], a[12:15], a[232:235], v[60:63]
  v_cvt_pk_bf16_f32 v164, v164, v164
  v_cvt_pk_bf16_f32 v165, v165, v165
  v_mfma_f32_16x16x32_bf16 v[64:67], a[16:19], a[208:211], v[64:67]
  v_cvt_pk_bf16_f32 v166, v166, v166
  v_cvt_pk_bf16_f32 v167, v167, v167
  v_mfma_f32_16x16x32_bf16 v[64:67], a[36:39], a[212:215], v[64:67]
  v_lshlrev_b32 v164, 16, v164
  v_lshlrev_b32 v165, 16, v165
  v_mfma_f32_16x16x32_bf16 v[68:71], a[36:39], a[220:223], v[68:71]
  v_lshlrev_b32 v166, 16, v166
  v_lshlrev_b32 v167, 16, v167
  v_mfma_f32_16x16x32_bf16 v[68:71], a[16:19], a[216:219], v[68:71]
  v_add_f32 v98, v98, v164
  v_add_f32 v99, v99, v165
  v_mfma_f32_16x16x32_bf16 v[72:75], a[16:19], a[224:227], v[72:75]
  v_add_f32 v100, v100, v166
  v_add_f32 v101, v101, v167
  v_mfma_f32_16x16x32_bf16 v[72:75], a[36:39], a[228:231], v[72:75]
  v_cvt_pk_bf16_f32 v98, v98, v98
  v_cvt_pk_bf16_f32 v99, v99, v99
  v_mfma_f32_16x16x32_bf16 v[76:79], a[36:39], a[236:239], v[76:79]
  v_cvt_pk_bf16_f32 v100, v100, v100
  v_cvt_pk_bf16_f32 v101, v101, v101
  v_mfma_f32_16x16x32_bf16 v[76:79], a[16:19], a[232:235], v[76:79]
  v_lshlrev_b32 v98, 16, v98
  v_lshlrev_b32 v99, 16, v99
  s_waitcnt vmcnt(17)
  v_mfma_f32_16x16x32_bf16 v[0:3], a[40:43], a[240:243], v[0:3]
  buffer_load_dwordx4 a[208:211], v110, s[24:27], s30 offen offset:1024 sc1
  v_mfma_f32_16x16x32_bf16 v[0:3], a[60:63], a[244:247], v[0:3]
  buffer_load_dwordx4 a[212:215], v111, s[24:27], s30 offen offset:0 sc1
  v_mfma_f32_16x16x32_bf16 v[4:7], a[60:63], a[252:255], v[4:7]
  buffer_load_dwordx4 a[216:219], v111, s[24:27], s30 offen offset:1024 sc1
  v_mfma_f32_16x16x32_bf16 v[4:7], a[40:43], a[248:251], v[4:7]
  buffer_load_dwordx4 a[220:223], v112, s[24:27], s30 offen offset:0 sc1
  v_mfma_f32_16x16x32_bf16 v[8:11], a[40:43], v[136:139], v[8:11]
  buffer_load_dwordx4 a[224:227], v112, s[24:27], s30 offen offset:1024 sc1
  v_mfma_f32_16x16x32_bf16 v[8:11], a[60:63], v[140:143], v[8:11]
  buffer_load_dwordx4 a[228:231], v113, s[24:27], s30 offen offset:0 sc1
  v_mfma_f32_16x16x32_bf16 v[12:15], a[60:63], v[148:151], v[12:15]
  v_lshlrev_b32 v100, 16, v100
  v_lshlrev_b32 v101, 16, v101
  v_mfma_f32_16x16x32_bf16 v[12:15], a[40:43], v[144:147], v[12:15]
  v_mul_f32 v129, 0xbfb8aa3b, v98
  v_mul_f32 v130, 0xbfb8aa3b, v99
  v_mfma_f32_16x16x32_bf16 v[16:19], a[44:47], a[240:243], v[16:19]
  buffer_load_dwordx4 a[232:235], v113, s[24:27], s30 offen offset:1024 sc1
  s_add_u32 s30, s30, 8192
  v_mfma_f32_16x16x32_bf16 v[16:19], a[64:67], a[244:247], v[16:19]
  buffer_load_dwordx4 a[236:239], v110, s[24:27], s30 offen offset:0 sc1
  v_mfma_f32_16x16x32_bf16 v[20:23], a[64:67], a[252:255], v[20:23]
  v_mul_f32 v131, 0xbfb8aa3b, v100
  v_mul_f32 v132, 0xbfb8aa3b, v101
  v_mfma_f32_16x16x32_bf16 v[20:23], a[44:47], a[248:251], v[20:23]
  v_exp_f32 v129, v129
  v_mfma_f32_16x16x32_bf16 v[24:27], a[44:47], v[136:139], v[24:27]
  v_exp_f32 v130, v130
  v_mfma_f32_16x16x32_bf16 v[24:27], a[64:67], v[140:143], v[24:27]
  v_exp_f32 v131, v131
  v_mfma_f32_16x16x32_bf16 v[28:31], a[64:67], v[148:151], v[28:31]
  v_exp_f32 v132, v132
  v_mfma_f32_16x16x32_bf16 v[28:31], a[44:47], v[144:147], v[28:31]
  v_add_f32 v129, 1.0, v129
  v_add_f32 v130, 1.0, v130
  v_mfma_f32_16x16x32_bf16 v[32:35], a[48:51], a[240:243], v[32:35]
  v_add_f32 v131, 1.0, v131
  v_add_f32 v132, 1.0, v132
  v_mfma_f32_16x16x32_bf16 v[32:35], a[68:71], a[244:247], v[32:35]
  v_rcp_f32 v129, v129
  v_mfma_f32_16x16x32_bf16 v[36:39], a[68:71], a[252:255], v[36:39]
  v_rcp_f32 v130, v130
  v_mfma_f32_16x16x32_bf16 v[36:39], a[48:51], a[248:251], v[36:39]
  v_rcp_f32 v131, v131
  v_mfma_f32_16x16x32_bf16 v[40:43], a[48:51], v[136:139], v[40:43]
  v_rcp_f32 v132, v132
  v_mfma_f32_16x16x32_bf16 v[40:43], a[68:71], v[140:143], v[40:43]
  v_mul_f32 v98, v98, v129
  v_mul_f32 v99, v99, v130
  v_mfma_f32_16x16x32_bf16 v[44:47], a[68:71], v[148:151], v[44:47]
  v_mul_f32 v100, v100, v131
  v_mul_f32 v101, v101, v132
  v_mfma_f32_16x16x32_bf16 v[44:47], a[48:51], v[144:147], v[44:47]
  v_cvt_pk_bf16_f32 v98, v98, v98
  v_cvt_pk_bf16_f32 v99, v99, v99
  v_mfma_f32_16x16x32_bf16 v[48:51], a[52:55], a[240:243], v[48:51]
  v_cvt_pk_bf16_f32 v100, v100, v100
  v_cvt_pk_bf16_f32 v101, v101, v101
  v_mfma_f32_16x16x32_bf16 v[48:51], a[72:75], a[244:247], v[48:51]
  v_lshlrev_b32 v98, 16, v98
  v_lshlrev_b32 v99, 16, v99
  v_mfma_f32_16x16x32_bf16 v[52:55], a[72:75], a[252:255], v[52:55]
  v_lshlrev_b32 v100, 16, v100
  v_lshlrev_b32 v101, 16, v101
  v_mfma_f32_16x16x32_bf16 v[52:55], a[52:55], a[248:251], v[52:55]
  v_cvt_pk_bf16_f32 v168, v168, v168
  v_cvt_pk_bf16_f32 v169, v169, v169
  v_mfma_f32_16x16x32_bf16 v[56:59], a[52:55], v[136:139], v[56:59]
  v_cvt_pk_bf16_f32 v170, v170, v170
  v_cvt_pk_bf16_f32 v171, v171, v171
  v_mfma_f32_16x16x32_bf16 v[56:59], a[72:75], v[140:143], v[56:59]
  v_lshlrev_b32 v168, 16, v168
  v_lshlrev_b32 v169, 16, v169
  v_mfma_f32_16x16x32_bf16 v[60:63], a[72:75], v[148:151], v[60:63]
  v_lshlrev_b32 v170, 16, v170
  v_lshlrev_b32 v171, 16, v171
  v_mfma_f32_16x16x32_bf16 v[60:63], a[52:55], v[144:147], v[60:63]
  v_mul_f32 v168, v168, v124
  v_mul_f32 v169, v169, v124
  v_mfma_f32_16x16x32_bf16 v[64:67], a[56:59], a[240:243], v[64:67]
  v_mul_f32 v170, v170, v124
  v_mul_f32 v171, v171, v124
  v_mfma_f32_16x16x32_bf16 v[64:67], a[76:79], a[244:247], v[64:67]
  v_cvt_pk_bf16_f32 v168, v168, v168
  v_cvt_pk_bf16_f32 v169, v169, v169
  v_mfma_f32_16x16x32_bf16 v[68:71], a[76:79], a[252:255], v[68:71]
  v_cvt_pk_bf16_f32 v170, v170, v170
  v_cvt_pk_bf16_f32 v171, v171, v171
  v_mfma_f32_16x16x32_bf16 v[68:71], a[56:59], a[248:251], v[68:71]
  v_lshlrev_b32 v168, 16, v168
  v_lshlrev_b32 v169, 16, v169
  v_mfma_f32_16x16x32_bf16 v[72:75], a[56:59], v[136:139], v[72:75]
  v_lshlrev_b32 v170, 16, v170
  v_lshlrev_b32 v171, 16, v171
  v_mfma_f32_16x16x32_bf16 v[72:75], a[76:79], v[140:143], v[72:75]
  v_add_f32 v102, v102, v168
  v_add_f32 v103, v103, v169
  v_mfma_f32_16x16x32_bf16 v[76:79], a[76:79], v[148:151], v[76:79]
  v_add_f32 v104, v104, v170
  v_add_f32 v105, v105, v171
  v_mfma_f32_16x16x32_bf16 v[76:79], a[56:59], v[144:147], v[76:79]
  v_cvt_pk_bf16_f32 v102, v102, v102
  v_cvt_pk_bf16_f32 v103, v103, v103
  s_waitcnt vmcnt(17)
  v_mfma_f32_16x16x32_bf16 v[0:3], a[80:83], v[152:155], v[0:3]
  buffer_load_dwordx4 a[240:243], v110, s[24:27], s30 offen offset:1024 sc1
  v_mfma_f32_16x16x32_bf16 v[0:3], a[100:103], a[144:147], v[0:3]
  buffer_load_dwordx4 a[244:247], v111, s[24:27], s30 offen offset:0 sc1
  v_mfma_f32_16x16x32_bf16 v[4:7], a[100:103], a[152:155], v[4:7]
  buffer_load_dwordx4 a[248:251], v111, s[24:27], s30 offen offset:1024 sc1
  v_mfma_f32_16x16x32_bf16 v[4:7], a[80:83], a[148:151], v[4:7]
  buffer_load_dwordx4 a[252:255], v112, s[24:27], s30 offen offset:0 sc1
  v_mfma_f32_16x16x32_bf16 v[8:11], a[80:83], a[156:159], v[8:11]
  buffer_load_dwordx4 v[136:139], v112, s[24:27], s30 offen offset:1024 sc1
  v_mfma_f32_16x16x32_bf16 v[8:11], a[100:103], a[160:163], v[8:11]
  buffer_load_dwordx4 v[140:143], v113, s[24:27], s30 offen offset:0 sc1
  v_mfma_f32_16x16x32_bf16 v[12:15], a[100:103], a[168:171], v[12:15]
  v_cvt_pk_bf16_f32 v104, v104, v104
  v_cvt_pk_bf16_f32 v105, v105, v105
  v_mfma_f32_16x16x32_bf16 v[12:15], a[80:83], a[164:167], v[12:15]
  v_lshlrev_b32 v102, 16, v102
  v_lshlrev_b32 v103, 16, v103
  v_mfma_f32_16x16x32_bf16 v[16:19], a[84:87], v[152:155], v[16:19]
  v_lshlrev_b32 v104, 16, v104
  v_lshlrev_b32 v105, 16, v105
  v_mfma_f32_16x16x32_bf16 v[16:19], a[104:107], a[144:147], v[16:19]
  v_mul_f32 v129, 0xbfb8aa3b, v102
  v_mul_f32 v130, 0xbfb8aa3b, v103
  v_mfma_f32_16x16x32_bf16 v[20:23], a[104:107], a[152:155], v[20:23]
  v_mul_f32 v131, 0xbfb8aa3b, v104
  v_mul_f32 v132, 0xbfb8aa3b, v105
  v_mfma_f32_16x16x32_bf16 v[20:23], a[84:87], a[148:151], v[20:23]
  v_exp_f32 v129, v129
  v_mfma_f32_16x16x32_bf16 v[24:27], a[84:87], a[156:159], v[24:27]
  v_exp_f32 v130, v130
  v_mfma_f32_16x16x32_bf16 v[24:27], a[104:107], a[160:163], v[24:27]
  v_exp_f32 v131, v131
  v_mfma_f32_16x16x32_bf16 v[28:31], a[104:107], a[168:171], v[28:31]
  v_exp_f32 v132, v132
  v_mfma_f32_16x16x32_bf16 v[28:31], a[84:87], a[164:167], v[28:31]
  v_add_f32 v129, 1.0, v129
  v_add_f32 v130, 1.0, v130
  v_mfma_f32_16x16x32_bf16 v[32:35], a[88:91], v[152:155], v[32:35]
  v_add_f32 v131, 1.0, v131
  v_add_f32 v132, 1.0, v132
  v_mfma_f32_16x16x32_bf16 v[32:35], a[108:111], a[144:147], v[32:35]
  v_rcp_f32 v129, v129
  v_mfma_f32_16x16x32_bf16 v[36:39], a[108:111], a[152:155], v[36:39]
  v_rcp_f32 v130, v130
  v_mfma_f32_16x16x32_bf16 v[36:39], a[88:91], a[148:151], v[36:39]
  v_rcp_f32 v131, v131
  v_mfma_f32_16x16x32_bf16 v[40:43], a[88:91], a[156:159], v[40:43]
  v_rcp_f32 v132, v132
  v_mfma_f32_16x16x32_bf16 v[40:43], a[108:111], a[160:163], v[40:43]
  v_mul_f32 v102, v102, v129
  v_mul_f32 v103, v103, v130
  v_mfma_f32_16x16x32_bf16 v[44:47], a[108:111], a[168:171], v[44:47]
  v_mul_f32 v104, v104, v131
  v_mul_f32 v105, v105, v132
  v_mfma_f32_16x16x32_bf16 v[44:47], a[88:91], a[164:167], v[44:47]
  v_cvt_pk_bf16_f32 v102, v102, v102
  v_cvt_pk_bf16_f32 v103, v103, v103
  v_mfma_f32_16x16x32_bf16 v[48:51], a[92:95], v[152:155], v[48:51]
  v_cvt_pk_bf16_f32 v104, v104, v104
  v_cvt_pk_bf16_f32 v105, v105, v105
  v_mfma_f32_16x16x32_bf16 v[48:51], a[112:115], a[144:147], v[48:51]
  v_lshlrev_b32 v102, 16, v102
  v_lshlrev_b32 v103, 16, v103
  v_mfma_f32_16x16x32_bf16 v[52:55], a[112:115], a[152:155], v[52:55]
  v_lshlrev_b32 v104, 16, v104
  v_lshlrev_b32 v105, 16, v105
  v_mfma_f32_16x16x32_bf16 v[52:55], a[92:95], a[148:151], v[52:55]
  v_cvt_pk_bf16_f32 v172, v172, v172
  v_cvt_pk_bf16_f32 v173, v173, v173
  v_mfma_f32_16x16x32_bf16 v[56:59], a[92:95], a[156:159], v[56:59]
  v_cvt_pk_bf16_f32 v174, v174, v174
  v_cvt_pk_bf16_f32 v175, v175, v175
  v_mfma_f32_16x16x32_bf16 v[56:59], a[112:115], a[160:163], v[56:59]
  v_lshlrev_b32 v172, 16, v172
  v_lshlrev_b32 v173, 16, v173
  v_mfma_f32_16x16x32_bf16 v[60:63], a[112:115], a[168:171], v[60:63]
  v_lshlrev_b32 v174, 16, v174
  v_lshlrev_b32 v175, 16, v175
  v_mfma_f32_16x16x32_bf16 v[60:63], a[92:95], a[164:167], v[60:63]
  v_mul_f32 v172, v172, v124
  v_mul_f32 v173, v173, v124
  v_mfma_f32_16x16x32_bf16 v[64:67], a[96:99], v[152:155], v[64:67]
  v_mul_f32 v174, v174, v124
  v_mul_f32 v175, v175, v124
  v_mfma_f32_16x16x32_bf16 v[64:67], a[116:119], a[144:147], v[64:67]
  v_cvt_pk_bf16_f32 v172, v172, v172
  v_cvt_pk_bf16_f32 v173, v173, v173
  v_mfma_f32_16x16x32_bf16 v[68:71], a[116:119], a[152:155], v[68:71]
  v_cvt_pk_bf16_f32 v174, v174, v174
  v_cvt_pk_bf16_f32 v175, v175, v175
  v_mfma_f32_16x16x32_bf16 v[68:71], a[96:99], a[148:151], v[68:71]
  v_lshlrev_b32 v172, 16, v172
  v_lshlrev_b32 v173, 16, v173
  v_mfma_f32_16x16x32_bf16 v[72:75], a[96:99], a[156:159], v[72:75]
  v_lshlrev_b32 v174, 16, v174
  v_lshlrev_b32 v175, 16, v175
  v_mfma_f32_16x16x32_bf16 v[72:75], a[116:119], a[160:163], v[72:75]
  v_add_f32 v106, v106, v172
  v_add_f32 v107, v107, v173
  v_mfma_f32_16x16x32_bf16 v[76:79], a[116:119], a[168:171], v[76:79]
  v_add_f32 v108, v108, v174
  v_add_f32 v109, v109, v175
  v_mfma_f32_16x16x32_bf16 v[76:79], a[96:99], a[164:167], v[76:79]
  v_cvt_pk_bf16_f32 v106, v106, v106
  v_cvt_pk_bf16_f32 v107, v107, v107
  s_waitcnt vmcnt(15)
  v_mfma_f32_16x16x32_bf16 v[0:3], a[120:123], a[172:175], v[0:3]
  ds_read_b128 v[144:147], v122 offset:0
  v_cvt_pk_bf16_f32 v108, v108, v108
  v_mfma_f32_16x16x32_bf16 v[0:3], a[140:143], a[176:179], v[0:3]
  buffer_load_dwordx4 v[148:151], v113, s[24:27], s30 offen offset:1024 sc1
  s_mov_b32 s30, s37
  v_mfma_f32_16x16x32_bf16 v[4:7], a[140:143], a[184:187], v[4:7]
  buffer_load_dwordx4 v[152:155], v110, s[24:27], s30 offen offset:0 sc1
  v_mfma_f32_16x16x32_bf16 v[4:7], a[120:123], a[180:183], v[4:7]
  buffer_load_dwordx4 a[144:147], v110, s[24:27], s30 offen offset:1024 sc1
  v_mfma_f32_16x16x32_bf16 v[8:11], a[120:123], a[188:191], v[8:11]
  buffer_load_dwordx4 a[148:151], v111, s[24:27], s30 offen offset:0 sc1
  v_mfma_f32_16x16x32_bf16 v[8:11], a[140:143], a[192:195], v[8:11]
  buffer_load_dwordx4 a[152:155], v111, s[24:27], s30 offen offset:1024 sc1
  v_mfma_f32_16x16x32_bf16 v[12:15], a[140:143], a[200:203], v[12:15]
  buffer_load_dwordx4 a[156:159], v112, s[24:27], s30 offen offset:0 sc1
  v_mfma_f32_16x16x32_bf16 v[12:15], a[120:123], a[196:199], v[12:15]
  v_cvt_pk_bf16_f32 v109, v109, v109
  v_lshlrev_b32 v106, 16, v106
  s_waitcnt lgkmcnt(0)
  v_mfma_f32_16x16x32_bf16 v[16:19], a[124:127], a[172:175], v[16:19]
  ds_read_b128 a[160:163], v122 offset:1024
  v_lshlrev_b32 v107, 16, v107
  v_mfma_f32_16x16x32_bf16 v[16:19], v[144:147], a[176:179], v[16:19]
  v_lshlrev_b32 v108, 16, v108
  v_lshlrev_b32 v109, 16, v109
  v_mfma_f32_16x16x32_bf16 v[20:23], v[144:147], a[184:187], v[20:23]
  v_mul_f32 v129, 0xbfb8aa3b, v106
  v_mul_f32 v130, 0xbfb8aa3b, v107
  v_mfma_f32_16x16x32_bf16 v[20:23], a[124:127], a[180:183], v[20:23]
  v_mul_f32 v131, 0xbfb8aa3b, v108
  v_mul_f32 v132, 0xbfb8aa3b, v109
  v_mfma_f32_16x16x32_bf16 v[24:27], a[124:127], a[188:191], v[24:27]
  v_exp_f32 v129, v129
  v_mfma_f32_16x16x32_bf16 v[24:27], v[144:147], a[192:195], v[24:27]
  v_exp_f32 v130, v130
  v_mfma_f32_16x16x32_bf16 v[28:31], v[144:147], a[200:203], v[28:31]
  v_exp_f32 v131, v131
  v_mfma_f32_16x16x32_bf16 v[28:31], a[124:127], a[196:199], v[28:31]
  v_exp_f32 v132, v132
  s_waitcnt lgkmcnt(0)
  v_mfma_f32_16x16x32_bf16 v[32:35], a[128:131], a[172:175], v[32:35]
  ds_read_b128 a[164:167], v122 offset:2048
  v_add_f32 v129, 1.0, v129
  v_mfma_f32_16x16x32_bf16 v[32:35], a[160:163], a[176:179], v[32:35]
  v_add_f32 v130, 1.0, v130
  v_add_f32 v131, 1.0, v131
  v_mfma_f32_16x16x32_bf16 v[36:39], a[160:163], a[184:187], v[36:39]
  v_add_f32 v132, 1.0, v132
  v_rcp_f32 v129, v129
  v_mfma_f32_16x16x32_bf16 v[36:39], a[128:131], a[180:183], v[36:39]
  v_rcp_f32 v130, v130
  v_mfma_f32_16x16x32_bf16 v[40:43], a[128:131], a[188:191], v[40:43]
  v_rcp_f32 v131, v131
  v_mfma_f32_16x16x32_bf16 v[40:43], a[160:163], a[192:195], v[40:43]
  v_rcp_f32 v132, v132
  v_mfma_f32_16x16x32_bf16 v[44:47], a[160:163], a[200:203], v[44:47]
  v_mul_f32 v106, v106, v129
  v_mul_f32 v107, v107, v130
  v_mfma_f32_16x16x32_bf16 v[44:47], a[128:131], a[196:199], v[44:47]
  v_mul_f32 v108, v108, v131
  v_mul_f32 v109, v109, v132
  s_waitcnt lgkmcnt(0)
  v_mfma_f32_16x16x32_bf16 v[48:51], a[132:135], a[172:175], v[48:51]
  ds_read_b128 a[168:171], v122 offset:3072
  v_cvt_pk_bf16_f32 v106, v106, v106
  v_mfma_f32_16x16x32_bf16 v[48:51], a[164:167], a[176:179], v[48:51]
  v_cvt_pk_bf16_f32 v107, v107, v107
  v_cvt_pk_bf16_f32 v108, v108, v108
  v_mfma_f32_16x16x32_bf16 v[52:55], a[164:167], a[184:187], v[52:55]
  v_cvt_pk_bf16_f32 v109, v109, v109
  v_lshlrev_b32 v106, 16, v106
  v_mfma_f32_16x16x32_bf16 v[52:55], a[132:135], a[180:183], v[52:55]
  v_lshlrev_b32 v107, 16, v107
  v_lshlrev_b32 v108, 16, v108
  v_mfma_f32_16x16x32_bf16 v[56:59], a[132:135], a[188:191], v[56:59]
  v_lshlrev_b32 v109, 16, v109
  v_lshlrev_b32 v156, 16, v80
  v_mfma_f32_16x16x32_bf16 v[56:59], a[164:167], a[192:195], v[56:59]
  v_and_b32 v157, s34, v80
  v_lshlrev_b32 v158, 16, v81
  v_mfma_f32_16x16x32_bf16 v[60:63], a[164:167], a[200:203], v[60:63]
  v_and_b32 v159, s34, v81
  v_lshlrev_b32 v160, 16, v82
  v_mfma_f32_16x16x32_bf16 v[60:63], a[132:135], a[196:199], v[60:63]
  v_and_b32 v161, s34, v82
  v_lshlrev_b32 v162, 16, v83
  s_waitcnt lgkmcnt(0)
  v_mfma_f32_16x16x32_bf16 v[64:67], a[136:139], a[172:175], v[64:67]
  ds_read_b128 v[144:147], v122 offset:4096
  ds_read_b128 a[160:163], v122 offset:9216
  v_mfma_f32_16x16x32_bf16 v[64:67], a[168:171], a[176:179], v[64:67]
  v_and_b32 v163, s34, v83
  v_lshlrev_b32 v164, 16, v84
  v_mfma_f32_16x16x32_bf16 v[68:71], a[168:171], a[184:187], v[68:71]
  v_and_b32 v165, s34, v84
  v_lshlrev_b32 v166, 16, v85
  v_mfma_f32_16x16x32_bf16 v[68:71], a[136:139], a[180:183], v[68:71]
  v_and_b32 v167, s34, v85
  v_lshlrev_b32 v168, 16, v86
  v_mfma_f32_16x16x32_bf16 v[72:75], a[136:139], a[188:191], v[72:75]
  v_and_b32 v169, s34, v86
  v_lshlrev_b32 v170, 16, v87
  v_mfma_f32_16x16x32_bf16 v[72:75], a[168:171], a[192:195], v[72:75]
  v_and_b32 v171, s34, v87
  v_lshlrev_b32 v172, 16, v88
  v_mfma_f32_16x16x32_bf16 v[76:79], a[168:171], a[200:203], v[76:79]
  v_and_b32 v173, s34, v88
  v_lshlrev_b32 v174, 16, v89
  v_mfma_f32_16x16x32_bf16 v[76:79], a[136:139], a[196:199], v[76:79]
  v_and_b32 v175, s34, v89
  s_waitcnt vmcnt(13) lgkmcnt(0)
  v_mfma_f32_16x16x32_bf16 v[0:3], v[144:147], a[204:207], v[0:3]
  ds_read_b128 a[164:167], v122 offset:5120
  ds_read_b128 a[168:171], v122 offset:10240
  s_sub_u32 s41, s3, 1
  s_and_b32 s41, s41, 3
  s_mul_i32 s41, s41, 24576
  s_add_u32 s41, s41, 4096
  v_mfma_f32_16x16x32_bf16 v[0:3], a[160:163], a[208:211], v[0:3]
  buffer_load_dwordx4 a[172:175], v112, s[24:27], s30 offen offset:1024 sc1
  v_mfma_f32_16x16x32_bf16 v[4:7], a[160:163], a[216:219], v[4:7]
  buffer_load_dwordx4 a[176:179], v113, s[24:27], s30 offen offset:0 sc1
  v_mfma_f32_16x16x32_bf16 v[4:7], v[144:147], a[212:215], v[4:7]
  buffer_load_dwordx4 a[180:183], v113, s[24:27], s30 offen offset:1024 sc1
  s_add_u32 s30, s30, 8192
  v_mfma_f32_16x16x32_bf16 v[8:11], v[144:147], a[220:223], v[8:11]
  buffer_load_dwordx4 a[184:187], v110, s[24:27], s30 offen offset:0 sc1
  v_mfma_f32_16x16x32_bf16 v[8:11], a[160:163], a[224:227], v[8:11]
  buffer_load_dwordx4 a[188:191], v110, s[24:27], s30 offen offset:1024 sc1
  v_mfma_f32_16x16x32_bf16 v[12:15], a[160:163], a[232:235], v[12:15]
  buffer_load_dwordx4 a[192:195], v111, s[24:27], s30 offen offset:0 sc1
  v_mfma_f32_16x16x32_bf16 v[12:15], v[144:147], a[228:231], v[12:15]
  v_add_u32 v80, s41, v114
  s_waitcnt lgkmcnt(0)
  v_mfma_f32_16x16x32_bf16 v[16:19], a[164:167], a[204:207], v[16:19]
  ds_read_b128 a[196:199], v122 offset:6144
  ds_read_b128 a[200:203], v122 offset:11264
  s_sub_u32 s41, s3, 2
  s_and_b32 s41, s41, 3
  s_mul_i32 s41, s41, 24576
  s_add_u32 s41, s41, 9216
  v_mfma_f32_16x16x32_bf16 v[16:19], a[168:171], a[208:211], v[16:19]
  v_add_u32 v81, s41, v114
  v_mfma_f32_16x16x32_bf16 v[20:23], a[168:171], a[216:219], v[20:23]
  s_sub_u32 s41, s3, 3
  s_and_b32 s41, s41, 3
  s_mul_i32 s41, s41, 24576
  s_add_u32 s41, s41, 14336
  v_add_u32 v82, s41, v114
  v_mfma_f32_16x16x32_bf16 v[20:23], a[164:167], a[212:215], v[20:23]
  v_mfma_f32_16x16x32_bf16 v[24:27], a[164:167], a[220:223], v[24:27]
  v_mfma_f32_16x16x32_bf16 v[24:27], a[168:171], a[224:227], v[24:27]
  v_mfma_f32_16x16x32_bf16 v[28:31], a[168:171], a[232:235], v[28:31]
  v_mfma_f32_16x16x32_bf16 v[28:31], a[164:167], a[228:231], v[28:31]
  s_waitcnt lgkmcnt(0)
  v_mfma_f32_16x16x32_bf16 v[32:35], a[196:199], a[204:207], v[32:35]
  ds_read_b128 v[144:147], v122 offset:7168
  ds_read_b128 a[160:163], v122 offset:12288
  v_mfma_f32_16x16x32_bf16 v[32:35], a[200:203], a[208:211], v[32:35]
  v_mfma_f32_16x16x32_bf16 v[36:39], a[200:203], a[216:219], v[36:39]
  v_mfma_f32_16x16x32_bf16 v[36:39], a[196:199], a[212:215], v[36:39]
  v_mfma_f32_16x16x32_bf16 v[40:43], a[196:199], a[220:223], v[40:43]
  v_mfma_f32_16x16x32_bf16 v[40:43], a[200:203], a[224:227], v[40:43]
  v_mfma_f32_16x16x32_bf16 v[44:47], a[200:203], a[232:235], v[44:47]
  v_mfma_f32_16x16x32_bf16 v[44:47], a[196:199], a[228:231], v[44:47]
  s_waitcnt lgkmcnt(0)
  v_mfma_f32_16x16x32_bf16 v[48:51], v[144:147], a[204:207], v[48:51]
  ds_read_b128 a[164:167], v122 offset:8192
  ds_read_b128 a[168:171], v122 offset:13312
  v_mfma_f32_16x16x32_bf16 v[48:51], a[160:163], a[208:211], v[48:51]
  v_mfma_f32_16x16x32_bf16 v[52:55], a[160:163], a[216:219], v[52:55]
  v_mfma_f32_16x16x32_bf16 v[52:55], v[144:147], a[212:215], v[52:55]
  v_mfma_f32_16x16x32_bf16 v[56:59], v[144:147], a[220:223], v[56:59]
  v_mfma_f32_16x16x32_bf16 v[56:59], a[160:163], a[224:227], v[56:59]
  v_mfma_f32_16x16x32_bf16 v[60:63], a[160:163], a[232:235], v[60:63]
  v_mfma_f32_16x16x32_bf16 v[60:63], v[144:147], a[228:231], v[60:63]
  s_waitcnt lgkmcnt(0)
  v_mfma_f32_16x16x32_bf16 v[64:67], a[164:167], a[204:207], v[64:67]
  ds_read_b128 a[196:199], v122 offset:14336
  ds_read_b128 a[200:203], v122 offset:19456
  v_mfma_f32_16x16x32_bf16 v[64:67], a[168:171], a[208:211], v[64:67]
  v_mfma_f32_16x16x32_bf16 v[68:71], a[168:171], a[216:219], v[68:71]
  v_mfma_f32_16x16x32_bf16 v[68:71], a[164:167], a[212:215], v[68:71]
  v_mfma_f32_16x16x32_bf16 v[72:75], a[164:167], a[220:223], v[72:75]
  v_mfma_f32_16x16x32_bf16 v[72:75], a[168:171], a[224:227], v[72:75]
  v_mfma_f32_16x16x32_bf16 v[76:79], a[168:171], a[232:235], v[76:79]
  v_mfma_f32_16x16x32_bf16 v[76:79], a[164:167], a[228:231], v[76:79]
  s_waitcnt vmcnt(11) lgkmcnt(0)
  v_mfma_f32_16x16x32_bf16 v[0:3], a[196:199], a[236:239], v[0:3]
  ds_read_b128 v[144:147], v122 offset:15360
  ds_read_b128 a[160:163], v122 offset:20480
  s_xor_b32 s38, s40, 1
  s_lshl_b32 s38, s38, 2
  s_add_u32 s38, s38, s3
  s_lshl_b32 s38, s38, 13
  s_add_u32 s38, s38, 25165824
  s_add_u32 s39, s38, 4096
  v_mfma_f32_16x16x32_bf16 v[0:3], a[200:203], a[240:243], v[0:3]
  buffer_load_dwordx4 a[164:167], v111, s[24:27], s30 offen offset:1024 sc1
  v_mfma_f32_16x16x32_bf16 v[4:7], a[200:203], a[248:251], v[4:7]
  buffer_load_dwordx4 a[168:171], v112, s[24:27], s30 offen offset:0 sc1
  v_mfma_f32_16x16x32_bf16 v[4:7], a[196:199], a[244:247], v[4:7]
  buffer_load_dwordx4 a[204:207], v112, s[24:27], s30 offen offset:1024 sc1
  v_mfma_f32_16x16x32_bf16 v[8:11], a[196:199], a[252:255], v[8:11]
  buffer_load_dwordx4 a[208:211], v113, s[24:27], s30 offen offset:0 sc1
  v_mfma_f32_16x16x32_bf16 v[8:11], a[200:203], v[136:139], v[8:11]
  buffer_load_dwordx4 a[212:215], v113, s[24:27], s30 offen offset:1024 sc1
  s_add_u32 s30, s30, 8192
  v_mfma_f32_16x16x32_bf16 v[12:15], a[200:203], v[148:151], v[12:15]
  buffer_load_dwordx4 a[216:219], v110, s[24:27], s30 offen offset:0 sc1
  v_mfma_f32_16x16x32_bf16 v[12:15], a[196:199], v[140:143], v[12:15]
  s_waitcnt lgkmcnt(0)
  v_mfma_f32_16x16x32_bf16 v[16:19], v[144:147], a[236:239], v[16:19]
  ds_read_b128 a[220:223], v122 offset:16384
  ds_read_b128 a[224:227], v122 offset:21504
  v_mfma_f32_16x16x32_bf16 v[16:19], a[160:163], a[240:243], v[16:19]
  buffer_load_dwordx4 a[228:231], v110, s[24:27], s30 offen offset:1024 sc1
  v_mfma_f32_16x16x32_bf16 v[20:23], a[160:163], a[248:251], v[20:23]
  buffer_load_dwordx4 a[232:235], v111, s[24:27], s30 offen offset:0 sc1
  v_mfma_f32_16x16x32_bf16 v[20:23], v[144:147], a[244:247], v[20:23]
  ds_write_b128 v118, v[4:7] offset:0
  ds_write_b128 v118, v[8:11] offset:5120
  v_mfma_f32_16x16x32_bf16 v[24:27], v[144:147], a[252:255], v[24:27]
  ds_write_b128 v118, v[12:15] offset:10240
  v_mfma_f32_16x16x32_bf16 v[24:27], a[160:163], v[136:139], v[24:27]
  v_mfma_f32_16x16x32_bf16 v[28:31], a[160:163], v[148:151], v[28:31]
  v_mfma_f32_16x16x32_bf16 v[28:31], v[144:147], v[140:143], v[28:31]
  s_waitcnt lgkmcnt(3)
  v_mfma_f32_16x16x32_bf16 v[32:35], a[220:223], a[236:239], v[32:35]
  ds_read_b128 a[196:199], v122 offset:17408
  ds_read_b128 a[200:203], v122 offset:22528
  v_mfma_f32_16x16x32_bf16 v[32:35], a[224:227], a[240:243], v[32:35]
  ds_write_b128 v118, v[20:23] offset:1024
  ds_write_b128 v118, v[24:27] offset:6144
  v_mfma_f32_16x16x32_bf16 v[36:39], a[224:227], a[248:251], v[36:39]
  ds_write_b128 v118, v[28:31] offset:11264
  v_mfma_f32_16x16x32_bf16 v[36:39], a[220:223], a[244:247], v[36:39]
  v_mfma_f32_16x16x32_bf16 v[40:43], a[220:223], a[252:255], v[40:43]
  v_mfma_f32_16x16x32_bf16 v[40:43], a[224:227], v[136:139], v[40:43]
  v_mfma_f32_16x16x32_bf16 v[44:47], a[224:227], v[148:151], v[44:47]
  v_mfma_f32_16x16x32_bf16 v[44:47], a[220:223], v[140:143], v[44:47]
  s_waitcnt lgkmcnt(3)
  v_mfma_f32_16x16x32_bf16 v[48:51], a[196:199], a[236:239], v[48:51]
  ds_read_b128 v[144:147], v122 offset:18432
  ds_read_b128 a[160:163], v122 offset:23552
  v_mfma_f32_16x16x32_bf16 v[48:51], a[200:203], a[240:243], v[48:51]
  buffer_load_dwordx4 a[220:223], v111, s[24:27], s30 offen offset:1024 sc1
  v_mfma_f32_16x16x32_bf16 v[52:55], a[200:203], a[248:251], v[52:55]
  buffer_load_dwordx4 a[224:227], v112, s[24:27], s30 offen offset:0 sc1
  v_mfma_f32_16x16x32_bf16 v[52:55], a[196:199], a[244:247], v[52:55]
  ds_write_b128 v118, v[36:39] offset:2048
  ds_write_b128 v118, v[40:43] offset:7168
  v_mfma_f32_16x16x32_bf16 v[56:59], a[196:199], a[252:255], v[56:59]
  ds_write_b128 v118, v[44:47] offset:12288
  v_mfma_f32_16x16x32_bf16 v[56:59], a[200:203], v[136:139], v[56:59]
  v_mfma_f32_16x16x32_bf16 v[60:63], a[200:203], v[148:151], v[60:63]
  v_mfma_f32_16x16x32_bf16 v[60:63], a[196:199], v[140:143], v[60:63]
  s_waitcnt lgkmcnt(3)
  v_mfma_f32_16x16x32_bf16 v[64:67], v[144:147], a[236:239], v[64:67]
  buffer_load_dwordx4 a[196:199], v112, s[24:27], s30 offen offset:1024 sc1
  v_mfma_f32_16x16x32_bf16 v[64:67], a[160:163], a[240:243], v[64:67]
  buffer_load_dwordx4 a[200:203], v113, s[24:27], s30 offen offset:0 sc1
  v_mfma_f32_16x16x32_bf16 v[68:71], a[160:163], a[248:251], v[68:71]
  ds_write_b128 v118, v[52:55] offset:3072
  ds_write_b128 v118, v[56:59] offset:8192
  v_mfma_f32_16x16x32_bf16 v[68:71], v[144:147], a[244:247], v[68:71]
  ds_write_b128 v118, v[60:63] offset:13312
  v_mfma_f32_16x16x32_bf16 v[72:75], v[144:147], a[252:255], v[72:75]
  v_mfma_f32_16x16x32_bf16 v[72:75], a[160:163], v[136:139], v[72:75]
  v_mfma_f32_16x16x32_bf16 v[76:79], a[160:163], v[148:151], v[76:79]
  v_mfma_f32_16x16x32_bf16 v[76:79], v[144:147], v[140:143], v[76:79]
  s_nop 2
  ds_write_b128 v118, v[68:71] offset:4096
  s_nop 1
  ds_write_b128 v118, v[72:75] offset:9216
  s_nop 0
  ds_write_b128 v118, v[76:79] offset:14336
  buffer_load_dwordx4 v[144:147], v113, s[24:27], s30 offen offset:1024 sc1
  s_add_u32 s30, s30, 8192
  buffer_load_dwordx4 a[160:163], v110, s[24:27], s30 offen offset:0 sc1
  buffer_load_dwordx4 a[236:239], v110, s[24:27], s30 offen offset:1024 sc1
  buffer_load_dwordx4 a[240:243], v111, s[24:27], s30 offen offset:0 sc1
  buffer_load_dwordx4 a[244:247], v111, s[24:27], s30 offen offset:1024 sc1
  buffer_load_dwordx4 a[248:251], v112, s[24:27], s30 offen offset:0 sc1
  buffer_load_dwordx4 a[252:255], v112, s[24:27], s30 offen offset:1024 sc1
  buffer_load_dwordx4 v[136:139], v113, s[24:27], s30 offen offset:0 sc1
  buffer_load_dwordx4 v[140:143], v113, s[24:27], s30 offen offset:1024 sc1
  s_add_u32 s30, s30, 8192
  buffer_load_dwordx4 v[148:151], v110, s[24:27], s30 offen offset:0 sc1
  s_waitcnt lgkmcnt(0)
  s_barrier
  ds_read_b128 v[4:7], v119 offset:0
  ds_read_b128 v[8:11], v120 offset:0
  ds_read_b128 v[12:15], v121 offset:0
  ds_read_b128 v[20:23], v119 offset:1024
  ds_read_b128 v[24:27], v120 offset:1024
  ds_read_b128 v[28:31], v121 offset:1024
  ds_read_b128 v[36:39], v119 offset:2048
  ds_read_b128 v[40:43], v120 offset:2048
  ds_read_b128 v[44:47], v121 offset:2048
  ds_read_b128 v[52:55], v119 offset:3072
  ds_read_b128 v[56:59], v120 offset:3072
  ds_read_b128 v[60:63], v121 offset:3072
  ds_read_b128 v[68:71], v119 offset:4096
  ds_read_b128 v[72:75], v120 offset:4096
  ds_read_b128 v[76:79], v121 offset:4096
  s_waitcnt lgkmcnt(12)
  v_add_f32 v4, v4, v8
  v_add_f32 v5, v5, v9
  v_add_f32 v6, v6, v10
  v_add_f32 v7, v7, v11
  v_add_f32 v0, v0, v12
  v_add_f32 v1, v1, v13
  v_add_f32 v2, v2, v14
  v_add_f32 v3, v3, v15
  v_add_f32 v0, v0, v4
  v_add_f32 v1, v1, v5
  v_add_f32 v2, v2, v6
  v_add_f32 v3, v3, v7
  buffer_store_dwordx4 v[0:3], v114, s[24:27], s38 offen offset:0 sc1
  s_waitcnt vmcnt(26)
  s_nop 0
  v_mfma_f32_16x16x32_bf16 v[0:3], v[176:179], v[152:155], 0
  s_waitcnt lgkmcnt(9)
  v_add_f32 v20, v20, v24
  v_add_f32 v21, v21, v25
  v_mfma_f32_16x16x32_bf16 v[0:3], v[196:199], a[144:147], v[0:3]
  v_add_f32 v22, v22, v26
  v_add_f32 v23, v23, v27
  v_mfma_f32_16x16x32_bf16 v[4:7], v[196:199], a[152:155], 0
  v_add_f32 v16, v16, v28
  v_add_f32 v17, v17, v29
  v_mfma_f32_16x16x32_bf16 v[4:7], v[176:179], a[148:151], v[4:7]
  v_add_f32 v18, v18, v30
  v_add_f32 v19, v19, v31
  v_mfma_f32_16x16x32_bf16 v[8:11], v[176:179], a[156:159], 0
  v_add_f32 v16, v16, v20
  v_add_f32 v17, v17, v21
  v_mfma_f32_16x16x32_bf16 v[8:11], v[196:199], a[172:175], v[8:11]
  v_add_f32 v18, v18, v22
  v_add_f32 v19, v19, v23
  v_mfma_f32_16x16x32_bf16 v[12:15], v[196:199], a[180:183], 0
  buffer_store_dwordx4 v[16:19], v114, s[24:27], s38 offen offset:1024 sc1
  s_waitcnt lgkmcnt(6)
  v_mfma_f32_16x16x32_bf16 v[12:15], v[176:179], a[176:179], v[12:15]
  v_add_f32 v36, v36, v40
  v_add_f32 v37, v37, v41
  v_mfma_f32_16x16x32_bf16 v[16:19], v[180:183], v[152:155], 0
  buffer_load_dwordx4 v[176:179], v110, s[24:27], s30 offen offset:1024 sc1
  v_mfma_f32_16x16x32_bf16 v[16:19], v[200:203], a[144:147], v[16:19]
  buffer_load_dwordx4 v[196:199], v111, s[24:27], s30 offen offset:0 sc1
  v_mfma_f32_16x16x32_bf16 v[20:23], v[200:203], a[152:155], 0
  v_add_f32 v38, v38, v42
  v_add_f32 v39, v39, v43
  v_mfma_f32_16x16x32_bf16 v[20:23], v[180:183], a[148:151], v[20:23]
  v_add_f32 v32, v32, v44
  v_add_f32 v33, v33, v45
  v_mfma_f32_16x16x32_bf16 v[24:27], v[180:183], a[156:159], 0
  v_add_f32 v34, v34, v46
  v_add_f32 v35, v35, v47
  v_mfma_f32_16x16x32_bf16 v[24:27], v[200:203], a[172:175], v[24:27]
  v_add_f32 v32, v32, v36
  v_add_f32 v33, v33, v37
  v_mfma_f32_16x16x32_bf16 v[28:31], v[200:203], a[180:183], 0
  v_add_f32 v34, v34, v38
  v_add_f32 v35, v35, v39
  v_mfma_f32_16x16x32_bf16 v[28:31], v[180:183], a[176:179], v[28:31]
  buffer_store_dwordx4 v[32:35], v114, s[24:27], s38 offen offset:2048 sc1
  s_waitcnt lgkmcnt(3)
  s_nop 0
  v_mfma_f32_16x16x32_bf16 v[32:35], v[184:187], v[152:155], 0
  buffer_load_dwordx4 v[180:183], v111, s[24:27], s30 offen offset:1024 sc1
  v_mfma_f32_16x16x32_bf16 v[32:35], v[204:207], a[144:147], v[32:35]
  buffer_load_dwordx4 v[200:203], v112, s[24:27], s30 offen offset:0 sc1
  v_mfma_f32_16x16x32_bf16 v[36:39], v[204:207], a[152:155], 0
  v_add_f32 v52, v52, v56
  v_add_f32 v53, v53, v57
  v_mfma_f32_16x16x32_bf16 v[36:39], v[184:187], a[148:151], v[36:39]
  v_add_f32 v54, v54, v58
  v_add_f32 v55, v55, v59
  v_mfma_f32_16x16x32_bf16 v[40:43], v[184:187], a[156:159], 0
  v_add_f32 v48, v48, v60
  v_add_f32 v49, v49, v61
  v_mfma_f32_16x16x32_bf16 v[40:43], v[204:207], a[172:175], v[40:43]
  v_add_f32 v50, v50, v62
  v_add_f32 v51, v51, v63
  v_mfma_f32_16x16x32_bf16 v[44:47], v[204:207], a[180:183], 0
  v_add_f32 v48, v48, v52
  v_add_f32 v49, v49, v53
  v_mfma_f32_16x16x32_bf16 v[44:47], v[184:187], a[176:179], v[44:47]
  v_add_f32 v50, v50, v54
  v_add_f32 v51, v51, v55
  buffer_store_dwordx4 v[48:51], v114, s[24:27], s38 offen offset:3072 sc1
  s_nop 1
  v_mfma_f32_16x16x32_bf16 v[48:51], v[188:191], v[152:155], 0
  buffer_load_dwordx4 v[184:187], v112, s[24:27], s30 offen offset:1024 sc1
  s_waitcnt lgkmcnt(0)
  v_mfma_f32_16x16x32_bf16 v[48:51], v[208:211], a[144:147], v[48:51]
  buffer_load_dwordx4 v[204:207], v113, s[24:27], s30 offen offset:0 sc1
  v_mfma_f32_16x16x32_bf16 v[52:55], v[208:211], a[152:155], 0
  v_add_f32 v68, v68, v72
  v_add_f32 v69, v69, v73
  v_mfma_f32_16x16x32_bf16 v[52:55], v[188:191], a[148:151], v[52:55]
  v_add_f32 v70, v70, v74
  v_add_f32 v71, v71, v75
  v_mfma_f32_16x16x32_bf16 v[56:59], v[188:191], a[156:159], 0
  v_add_f32 v64, v64, v76
  v_add_f32 v65, v65, v77
  v_mfma_f32_16x16x32_bf16 v[56:59], v[208:211], a[172:175], v[56:59]
  v_add_f32 v66, v66, v78
  v_add_f32 v67, v67, v79
  v_mfma_f32_16x16x32_bf16 v[60:63], v[208:211], a[180:183], 0
  v_add_f32 v64, v64, v68
  v_add_f32 v65, v65, v69
  v_mfma_f32_16x16x32_bf16 v[60:63], v[188:191], a[176:179], v[60:63]
  v_add_f32 v66, v66, v70
  v_add_f32 v67, v67, v71
  buffer_store_dwordx4 v[64:67], v114, s[24:27], s39 offen offset:0 sc1
  s_nop 1
  v_mfma_f32_16x16x32_bf16 v[64:67], v[192:195], v[152:155], 0
  buffer_load_dwordx4 v[188:191], v113, s[24:27], s30 offen offset:1024 sc1
  s_add_u32 s30, s30, 8192
  s_xor_b32 s38, s40, 1
  s_lshl_b32 s38, s38, 7
  s_add_u32 s38, s38, 2834432
  v_mfma_f32_16x16x32_bf16 v[64:67], v[212:215], a[144:147], v[64:67]
  buffer_load_dwordx4 v[208:211], v110, s[24:27], s30 offen offset:0 sc1
  v_mfma_f32_16x16x32_bf16 v[68:71], v[212:215], a[152:155], 0
  v_mov_b32 v135, 1073741824
  v_writelane_b32 v135, s38, 0
  v_mfma_f32_16x16x32_bf16 v[68:71], v[192:195], a[148:151], v[68:71]
  v_mov_b32 v127, 1
  v_mfma_f32_16x16x32_bf16 v[72:75], v[192:195], a[156:159], 0
  s_xor_b32 s38, s38, 128
  v_mov_b32 v133, s38
  v_mov_b32 v134, 4
  v_mfma_f32_16x16x32_bf16 v[72:75], v[212:215], a[172:175], v[72:75]
  v_mfma_f32_16x16x32_bf16 v[76:79], v[212:215], a[180:183], 0
  v_mfma_f32_16x16x32_bf16 v[76:79], v[192:195], a[176:179], v[76:79]
  s_waitcnt vmcnt(30)
  v_mfma_f32_16x16x32_bf16 v[0:3], v[216:219], a[184:187], v[0:3]
  buffer_load_dwordx4 v[192:195], v110, s[24:27], s30 offen offset:1024 sc1
  v_mfma_f32_16x16x32_bf16 v[0:3], v[236:239], a[188:191], v[0:3]
  buffer_load_dwordx4 v[212:215], v111, s[24:27], s30 offen offset:0 sc1
  v_mfma_f32_16x16x32_bf16 v[4:7], v[236:239], a[164:167], v[4:7]
  buffer_load_dwordx4 a[144:147], v111, s[24:27], s30 offen offset:1024 sc1
  v_mfma_f32_16x16x32_bf16 v[4:7], v[216:219], a[192:195], v[4:7]
  buffer_load_dwordx4 a[148:151], v112, s[24:27], s30 offen offset:0 sc1
  v_mfma_f32_16x16x32_bf16 v[8:11], v[216:219], a[168:171], v[8:11]
  buffer_load_dwordx4 a[152:155], v112, s[24:27], s30 offen offset:1024 sc1
  v_mfma_f32_16x16x32_bf16 v[8:11], v[236:239], a[204:207], v[8:11]
  buffer_load_dwordx4 a[156:159], v113, s[24:27], s30 offen offset:0 sc1
  v_mfma_f32_16x16x32_bf16 v[12:15], v[236:239], a[212:215], v[12:15]
  v_mfma_f32_16x16x32_bf16 v[12:15], v[216:219], a[208:211], v[12:15]
  v_mfma_f32_16x16x32_bf16 v[16:19], v[220:223], a[184:187], v[16:19]
  buffer_load_dwordx4 a[172:175], v113, s[24:27], s30 offen offset:1024 sc1
  s_add_u32 s30, s30, 8192
  v_mfma_f32_16x16x32_bf16 v[16:19], v[240:243], a[188:191], v[16:19]
  buffer_load_dwordx4 a[176:179], v110, s[24:27], s30 offen offset:0 sc1
  v_mfma_f32_16x16x32_bf16 v[20:23], v[240:243], a[164:167], v[20:23]
  buffer_load_dwordx4 a[180:183], v110, s[24:27], s30 offen offset:1024 sc1
  v_mfma_f32_16x16x32_bf16 v[20:23], v[220:223], a[192:195], v[20:23]
  buffer_load_dwordx4 v[216:219], v111, s[24:27], s30 offen offset:0 sc1
  v_mfma_f32_16x16x32_bf16 v[24:27], v[220:223], a[168:171], v[24:27]
  buffer_load_dwordx4 v[236:239], v111, s[24:27], s30 offen offset:1024 sc1
  v_mfma_f32_16x16x32_bf16 v[24:27], v[240:243], a[204:207], v[24:27]
  v_mfma_f32_16x16x32_bf16 v[28:31], v[240:243], a[212:215], v[28:31]
  v_mfma_f32_16x16x32_bf16 v[28:31], v[220:223], a[208:211], v[28:31]
  v_mfma_f32_16x16x32_bf16 v[32:35], v[224:227], a[184:187], v[32:35]
  buffer_load_dwordx4 v[220:223], v112, s[24:27], s30 offen offset:0 sc1
  v_mfma_f32_16x16x32_bf16 v[32:35], v[244:247], a[188:191], v[32:35]
  buffer_load_dwordx4 v[240:243], v112, s[24:27], s30 offen offset:1024 sc1
  v_mfma_f32_16x16x32_bf16 v[36:39], v[244:247], a[164:167], v[36:39]
  v_mfma_f32_16x16x32_bf16 v[36:39], v[224:227], a[192:195], v[36:39]
  v_mfma_f32_16x16x32_bf16 v[40:43], v[224:227], a[168:171], v[40:43]
  v_mfma_f32_16x16x32_bf16 v[40:43], v[244:247], a[204:207], v[40:43]
  v_mfma_f32_16x16x32_bf16 v[44:47], v[244:247], a[212:215], v[44:47]
  v_mfma_f32_16x16x32_bf16 v[44:47], v[224:227], a[208:211], v[44:47]
  v_mfma_f32_16x16x32_bf16 v[48:51], v[228:231], a[184:187], v[48:51]
  buffer_load_dwordx4 v[224:227], v113, s[24:27], s30 offen offset:0 sc1
  v_mfma_f32_16x16x32_bf16 v[48:51], v[248:251], a[188:191], v[48:51]
  buffer_load_dwordx4 v[244:247], v113, s[24:27], s30 offen offset:1024 sc1
  s_add_u32 s30, s30, 8192
  v_mfma_f32_16x16x32_bf16 v[52:55], v[248:251], a[164:167], v[52:55]
  v_mfma_f32_16x16x32_bf16 v[52:55], v[228:231], a[192:195], v[52:55]
  v_mfma_f32_16x16x32_bf16 v[56:59], v[228:231], a[168:171], v[56:59]
  v_mfma_f32_16x16x32_bf16 v[56:59], v[248:251], a[204:207], v[56:59]
  v_mfma_f32_16x16x32_bf16 v[60:63], v[248:251], a[212:215], v[60:63]
  v_mfma_f32_16x16x32_bf16 v[60:63], v[228:231], a[208:211], v[60:63]
  v_mfma_f32_16x16x32_bf16 v[64:67], v[232:235], a[184:187], v[64:67]
  buffer_load_dwordx4 v[228:231], v110, s[24:27], s30 offen offset:0 sc1
  v_mfma_f32_16x16x32_bf16 v[64:67], v[252:255], a[188:191], v[64:67]
  buffer_load_dwordx4 v[248:251], v110, s[24:27], s30 offen offset:1024 sc1
  v_mfma_f32_16x16x32_bf16 v[68:71], v[252:255], a[164:167], v[68:71]
  v_mfma_f32_16x16x32_bf16 v[68:71], v[232:235], a[192:195], v[68:71]
  v_mfma_f32_16x16x32_bf16 v[72:75], v[232:235], a[168:171], v[72:75]
  v_mfma_f32_16x16x32_bf16 v[72:75], v[252:255], a[204:207], v[72:75]
  v_mfma_f32_16x16x32_bf16 v[76:79], v[252:255], a[212:215], v[76:79]
  v_mfma_f32_16x16x32_bf16 v[76:79], v[232:235], a[208:211], v[76:79]
  s_waitcnt vmcnt(39)
  v_mfma_f32_16x16x32_bf16 v[0:3], a[0:3], a[216:219], v[0:3]
  buffer_load_dwordx4 v[232:235], v111, s[24:27], s30 offen offset:0 sc1
  v_mfma_f32_16x16x32_bf16 v[0:3], a[20:23], a[228:231], v[0:3]
  buffer_load_dwordx4 v[252:255], v111, s[24:27], s30 offen offset:1024 sc1
  v_mfma_f32_16x16x32_bf16 v[4:7], a[20:23], a[220:223], v[4:7]
  buffer_load_dwordx4 a[184:187], v112, s[24:27], s30 offen offset:0 sc1
  v_mfma_f32_16x16x32_bf16 v[4:7], a[0:3], a[232:235], v[4:7]
  buffer_load_dwordx4 a[188:191], v112, s[24:27], s30 offen offset:1024 sc1
  v_mfma_f32_16x16x32_bf16 v[8:11], a[0:3], a[224:227], v[8:11]
  buffer_load_dwordx4 a[192:195], v113, s[24:27], s30 offen offset:0 sc1
  v_mfma_f32_16x16x32_bf16 v[8:11], a[20:23], a[196:199], v[8:11]
  buffer_load_dwordx4 a[164:167], v113, s[24:27], s30 offen offset:1024 sc1
  v_mfma_f32_16x16x32_bf16 v[12:15], a[20:23], v[144:147], v[12:15]
  v_mfma_f32_16x16x32_bf16 v[12:15], a[0:3], a[200:203], v[12:15]
  v_mfma_f32_16x16x32_bf16 v[16:19], a[4:7], a[216:219], v[16:19]
  s_add_u32 s30, s30, 8192
  v_mfma_f32_16x16x32_bf16 v[16:19], a[24:27], a[228:231], v[16:19]
  v_mfma_f32_16x16x32_bf16 v[20:23], a[24:27], a[220:223], v[20:23]
  v_mfma_f32_16x16x32_bf16 v[20:23], a[4:7], a[232:235], v[20:23]
  v_mfma_f32_16x16x32_bf16 v[24:27], a[4:7], a[224:227], v[24:27]
  v_mfma_f32_16x16x32_bf16 v[24:27], a[24:27], a[196:199], v[24:27]
  v_mfma_f32_16x16x32_bf16 v[28:31], a[24:27], v[144:147], v[28:31]
  v_mfma_f32_16x16x32_bf16 v[28:31], a[4:7], a[200:203], v[28:31]
  v_mfma_f32_16x16x32_bf16 v[32:35], a[8:11], a[216:219], v[32:35]
  v_mfma_f32_16x16x32_bf16 v[32:35], a[28:31], a[228:231], v[32:35]
  v_mfma_f32_16x16x32_bf16 v[36:39], a[28:31], a[220:223], v[36:39]
  v_mfma_f32_16x16x32_bf16 v[36:39], a[8:11], a[232:235], v[36:39]
  v_mfma_f32_16x16x32_bf16 v[40:43], a[8:11], a[224:227], v[40:43]
  v_mfma_f32_16x16x32_bf16 v[40:43], a[28:31], a[196:199], v[40:43]
  v_mfma_f32_16x16x32_bf16 v[44:47], a[28:31], v[144:147], v[44:47]
  v_mfma_f32_16x16x32_bf16 v[44:47], a[8:11], a[200:203], v[44:47]
  v_mfma_f32_16x16x32_bf16 v[48:51], a[12:15], a[216:219], v[48:51]
  v_mfma_f32_16x16x32_bf16 v[48:51], a[32:35], a[228:231], v[48:51]
  v_mfma_f32_16x16x32_bf16 v[52:55], a[32:35], a[220:223], v[52:55]
  v_mfma_f32_16x16x32_bf16 v[52:55], a[12:15], a[232:235], v[52:55]
  v_mfma_f32_16x16x32_bf16 v[56:59], a[12:15], a[224:227], v[56:59]
  v_mfma_f32_16x16x32_bf16 v[56:59], a[32:35], a[196:199], v[56:59]
  v_mfma_f32_16x16x32_bf16 v[60:63], a[32:35], v[144:147], v[60:63]
  v_mfma_f32_16x16x32_bf16 v[60:63], a[12:15], a[200:203], v[60:63]
  v_mfma_f32_16x16x32_bf16 v[64:67], a[16:19], a[216:219], v[64:67]
  v_mfma_f32_16x16x32_bf16 v[64:67], a[36:39], a[228:231], v[64:67]
  v_mfma_f32_16x16x32_bf16 v[68:71], a[36:39], a[220:223], v[68:71]
  v_mfma_f32_16x16x32_bf16 v[68:71], a[16:19], a[232:235], v[68:71]
  v_mfma_f32_16x16x32_bf16 v[72:75], a[16:19], a[224:227], v[72:75]
  v_mfma_f32_16x16x32_bf16 v[72:75], a[36:39], a[196:199], v[72:75]
  v_mfma_f32_16x16x32_bf16 v[76:79], a[36:39], v[144:147], v[76:79]
  v_mfma_f32_16x16x32_bf16 v[76:79], a[16:19], a[200:203], v[76:79]
  s_waitcnt vmcnt(37)
  v_mfma_f32_16x16x32_bf16 v[0:3], a[40:43], a[160:163], v[0:3]
  s_waitcnt vmcnt(25)
  buffer_atomic_add v127, v135, s[24:27], 0 offen
  v_mfma_f32_16x16x32_bf16 v[0:3], a[60:63], a[236:239], v[0:3]
  v_mfma_f32_16x16x32_bf16 v[4:7], a[60:63], a[244:247], v[4:7]
  v_mfma_f32_16x16x32_bf16 v[4:7], a[40:43], a[240:243], v[4:7]
  v_mfma_f32_16x16x32_bf16 v[8:11], a[40:43], a[248:251], v[8:11]
  v_mfma_f32_16x16x32_bf16 v[8:11], a[60:63], a[252:255], v[8:11]
  v_mfma_f32_16x16x32_bf16 v[12:15], a[60:63], v[140:143], v[12:15]
  v_mfma_f32_16x16x32_bf16 v[12:15], a[40:43], v[136:139], v[12:15]
  v_mfma_f32_16x16x32_bf16 v[16:19], a[44:47], a[160:163], v[16:19]
  v_mfma_f32_16x16x32_bf16 v[16:19], a[64:67], a[236:239], v[16:19]
  v_mfma_f32_16x16x32_bf16 v[20:23], a[64:67], a[244:247], v[20:23]
  v_mfma_f32_16x16x32_bf16 v[20:23], a[44:47], a[240:243], v[20:23]
  v_mfma_f32_16x16x32_bf16 v[24:27], a[44:47], a[248:251], v[24:27]
  v_mfma_f32_16x16x32_bf16 v[24:27], a[64:67], a[252:255], v[24:27]
  v_mfma_f32_16x16x32_bf16 v[28:31], a[64:67], v[140:143], v[28:31]
  v_mfma_f32_16x16x32_bf16 v[28:31], a[44:47], v[136:139], v[28:31]
  v_mfma_f32_16x16x32_bf16 v[32:35], a[48:51], a[160:163], v[32:35]
  v_mfma_f32_16x16x32_bf16 v[32:35], a[68:71], a[236:239], v[32:35]
  v_mfma_f32_16x16x32_bf16 v[36:39], a[68:71], a[244:247], v[36:39]
  v_mfma_f32_16x16x32_bf16 v[36:39], a[48:51], a[240:243], v[36:39]
  v_mfma_f32_16x16x32_bf16 v[40:43], a[48:51], a[248:251], v[40:43]
  v_mfma_f32_16x16x32_bf16 v[40:43], a[68:71], a[252:255], v[40:43]
  v_mfma_f32_16x16x32_bf16 v[44:47], a[68:71], v[140:143], v[44:47]
  v_mfma_f32_16x16x32_bf16 v[44:47], a[48:51], v[136:139], v[44:47]
  v_mfma_f32_16x16x32_bf16 v[48:51], a[52:55], a[160:163], v[48:51]
  v_mfma_f32_16x16x32_bf16 v[48:51], a[72:75], a[236:239], v[48:51]
  v_mfma_f32_16x16x32_bf16 v[52:55], a[72:75], a[244:247], v[52:55]
  v_mfma_f32_16x16x32_bf16 v[52:55], a[52:55], a[240:243], v[52:55]
  v_mfma_f32_16x16x32_bf16 v[56:59], a[52:55], a[248:251], v[56:59]
  v_mfma_f32_16x16x32_bf16 v[56:59], a[72:75], a[252:255], v[56:59]
  v_mfma_f32_16x16x32_bf16 v[60:63], a[72:75], v[140:143], v[60:63]
  v_mfma_f32_16x16x32_bf16 v[60:63], a[52:55], v[136:139], v[60:63]
  v_mfma_f32_16x16x32_bf16 v[64:67], a[56:59], a[160:163], v[64:67]
  v_mfma_f32_16x16x32_bf16 v[64:67], a[76:79], a[236:239], v[64:67]
  v_mfma_f32_16x16x32_bf16 v[68:71], a[76:79], a[244:247], v[68:71]
  v_mfma_f32_16x16x32_bf16 v[68:71], a[56:59], a[240:243], v[68:71]
  v_mfma_f32_16x16x32_bf16 v[72:75], a[56:59], a[248:251], v[72:75]
  v_mfma_f32_16x16x32_bf16 v[72:75], a[76:79], a[252:255], v[72:75]
  v_mfma_f32_16x16x32_bf16 v[76:79], a[76:79], v[140:143], v[76:79]
  v_mfma_f32_16x16x32_bf16 v[76:79], a[56:59], v[136:139], v[76:79]
  s_waitcnt vmcnt(25)
  v_mfma_f32_16x16x32_bf16 v[0:3], a[80:83], v[148:151], v[0:3]
  v_mfma_f32_16x16x32_bf16 v[0:3], a[100:103], v[176:179], v[0:3]
  v_mfma_f32_16x16x32_bf16 v[4:7], a[100:103], v[180:183], v[4:7]
  v_mfma_f32_16x16x32_bf16 v[4:7], a[80:83], v[196:199], v[4:7]
  v_mfma_f32_16x16x32_bf16 v[8:11], a[80:83], v[200:203], v[8:11]
  v_mfma_f32_16x16x32_bf16 v[8:11], a[100:103], v[184:187], v[8:11]
  v_mfma_f32_16x16x32_bf16 v[12:15], a[100:103], v[188:191], v[12:15]
  v_mfma_f32_16x16x32_bf16 v[12:15], a[80:83], v[204:207], v[12:15]
  v_mfma_f32_16x16x32_bf16 v[16:19], a[84:87], v[148:151], v[16:19]
  v_mfma_f32_16x16x32_bf16 v[16:19], a[104:107], v[176:179], v[16:19]
  v_mfma_f32_16x16x32_bf16 v[20:23], a[104:107], v[180:183], v[20:23]
  v_mfma_f32_16x16x32_bf16 v[20:23], a[84:87], v[196:199], v[20:23]
  v_mfma_f32_16x16x32_bf16 v[24:27], a[84:87], v[200:203], v[24:27]
  v_mfma_f32_16x16x32_bf16 v[24:27], a[104:107], v[184:187], v[24:27]
  v_mfma_f32_16x16x32_bf16 v[28:31], a[104:107], v[188:191], v[28:31]
  v_mfma_f32_16x16x32_bf16 v[28:31], a[84:87], v[204:207], v[28:31]
  v_mfma_f32_16x16x32_bf16 v[32:35], a[88:91], v[148:151], v[32:35]
  v_mfma_f32_16x16x32_bf16 v[32:35], a[108:111], v[176:179], v[32:35]
  v_mfma_f32_16x16x32_bf16 v[36:39], a[108:111], v[180:183], v[36:39]
  v_mfma_f32_16x16x32_bf16 v[36:39], a[88:91], v[196:199], v[36:39]
  v_mfma_f32_16x16x32_bf16 v[40:43], a[88:91], v[200:203], v[40:43]
  v_mfma_f32_16x16x32_bf16 v[40:43], a[108:111], v[184:187], v[40:43]
  v_mfma_f32_16x16x32_bf16 v[44:47], a[108:111], v[188:191], v[44:47]
  v_mfma_f32_16x16x32_bf16 v[44:47], a[88:91], v[204:207], v[44:47]
  v_mfma_f32_16x16x32_bf16 v[48:51], a[92:95], v[148:151], v[48:51]
  v_mfma_f32_16x16x32_bf16 v[48:51], a[112:115], v[176:179], v[48:51]
  v_mfma_f32_16x16x32_bf16 v[52:55], a[112:115], v[180:183], v[52:55]
  v_mfma_f32_16x16x32_bf16 v[52:55], a[92:95], v[196:199], v[52:55]
  v_mfma_f32_16x16x32_bf16 v[56:59], a[92:95], v[200:203], v[56:59]
  v_mfma_f32_16x16x32_bf16 v[56:59], a[112:115], v[184:187], v[56:59]
  v_mfma_f32_16x16x32_bf16 v[60:63], a[112:115], v[188:191], v[60:63]
  v_mfma_f32_16x16x32_bf16 v[60:63], a[92:95], v[204:207], v[60:63]
  v_mfma_f32_16x16x32_bf16 v[64:67], a[96:99], v[148:151], v[64:67]
  v_mfma_f32_16x16x32_bf16 v[64:67], a[116:119], v[176:179], v[64:67]
  v_mfma_f32_16x16x32_bf16 v[68:71], a[116:119], v[180:183], v[68:71]
  v_mfma_f32_16x16x32_bf16 v[68:71], a[96:99], v[196:199], v[68:71]
  v_mfma_f32_16x16x32_bf16 v[72:75], a[96:99], v[200:203], v[72:75]
  v_mfma_f32_16x16x32_bf16 v[72:75], a[116:119], v[184:187], v[72:75]
  v_mfma_f32_16x16x32_bf16 v[76:79], a[116:119], v[188:191], v[76:79]
  v_mfma_f32_16x16x32_bf16 v[76:79], a[96:99], v[204:207], v[76:79]
  s_waitcnt vmcnt(17)
  v_mfma_f32_16x16x32_bf16 v[0:3], a[120:123], v[208:211], v[0:3]
  ds_read_b128 a[168:171], v122 offset:0
  buffer_load_dword v128, v133, s[24:27], 0 offen sc1
  s_xor_b32 s38, s40, 0
  s_lshl_b32 s38, s38, 2
  s_add_u32 s38, s38, s3
  s_lshl_b32 s38, s38, 13
  s_add_u32 s38, s38, 25165824
  s_add_u32 s39, s38, 4096
  v_mfma_f32_16x16x32_bf16 v[0:3], a[140:143], v[192:195], v[0:3]
  v_mfma_f32_16x16x32_bf16 v[4:7], a[140:143], a[144:147], v[4:7]
  v_mfma_f32_16x16x32_bf16 v[4:7], a[120:123], v[212:215], v[4:7]
  v_mfma_f32_16x16x32_bf16 v[8:11], a[120:123], a[148:151], v[8:11]
  v_mfma_f32_16x16x32_bf16 v[8:11], a[140:143], a[152:155], v[8:11]
  v_mfma_f32_16x16x32_bf16 v[12:15], a[140:143], a[172:175], v[12:15]
  v_mfma_f32_16x16x32_bf16 v[12:15], a[120:123], a[156:159], v[12:15]
  s_waitcnt lgkmcnt(0)
  v_mfma_f32_16x16x32_bf16 v[16:19], a[124:127], v[208:211], v[16:19]
  ds_read_b128 a[204:207], v122 offset:1024
  v_mfma_f32_16x16x32_bf16 v[16:19], a[168:171], v[192:195], v[16:19]
  v_mfma_f32_16x16x32_bf16 v[20:23], a[168:171], a[144:147], v[20:23]
  v_mfma_f32_16x16x32_bf16 v[20:23], a[124:127], v[212:215], v[20:23]
  v_mfma_f32_16x16x32_bf16 v[24:27], a[124:127], a[148:151], v[24:27]
  v_mfma_f32_16x16x32_bf16 v[24:27], a[168:171], a[152:155], v[24:27]
  v_mfma_f32_16x16x32_bf16 v[28:31], a[168:171], a[172:175], v[28:31]
  v_mfma_f32_16x16x32_bf16 v[28:31], a[124:127], a[156:159], v[28:31]
  s_waitcnt lgkmcnt(0)
  v_mfma_f32_16x16x32_bf16 v[32:35], a[128:131], v[208:211], v[32:35]
  ds_read_b128 a[208:211], v122 offset:2048
  v_mfma_f32_16x16x32_bf16 v[32:35], a[204:207], v[192:195], v[32:35]
  v_mfma_f32_16x16x32_bf16 v[36:39], a[204:207], a[144:147], v[36:39]
  v_mfma_f32_16x16x32_bf16 v[36:39], a[128:131], v[212:215], v[36:39]
  v_mfma_f32_16x16x32_bf16 v[40:43], a[128:131], a[148:151], v[40:43]
  v_mfma_f32_16x16x32_bf16 v[40:43], a[204:207], a[152:155], v[40:43]
  v_mfma_f32_16x16x32_bf16 v[44:47], a[204:207], a[172:175], v[44:47]
  v_mfma_f32_16x16x32_bf16 v[44:47], a[128:131], a[156:159], v[44:47]
  s_waitcnt lgkmcnt(0)
  v_mfma_f32_16x16x32_bf16 v[48:51], a[132:135], v[208:211], v[48:51]
  ds_read_b128 a[212:215], v122 offset:3072
  v_mfma_f32_16x16x32_bf16 v[48:51], a[208:211], v[192:195], v[48:51]
  v_mfma_f32_16x16x32_bf16 v[52:55], a[208:211], a[144:147], v[52:55]
  v_mfma_f32_16x16x32_bf16 v[52:55], a[132:135], v[212:215], v[52:55]
  v_mfma_f32_16x16x32_bf16 v[56:59], a[132:135], a[148:151], v[56:59]
  v_mfma_f32_16x16x32_bf16 v[56:59], a[208:211], a[152:155], v[56:59]
  v_mfma_f32_16x16x32_bf16 v[60:63], a[208:211], a[172:175], v[60:63]
  v_mfma_f32_16x16x32_bf16 v[60:63], a[132:135], a[156:159], v[60:63]
  s_waitcnt lgkmcnt(0)
  v_mfma_f32_16x16x32_bf16 v[64:67], a[136:139], v[208:211], v[64:67]
  ds_read_b128 a[0:3], v122 offset:4096
  ds_read_b128 a[20:23], v122 offset:9216
  v_mfma_f32_16x16x32_bf16 v[64:67], a[212:215], v[192:195], v[64:67]
  v_mfma_f32_16x16x32_bf16 v[68:71], a[212:215], a[144:147], v[68:71]
  v_mfma_f32_16x16x32_bf16 v[68:71], a[136:139], v[212:215], v[68:71]
  v_mfma_f32_16x16x32_bf16 v[72:75], a[136:139], a[148:151], v[72:75]
  v_mfma_f32_16x16x32_bf16 v[72:75], a[212:215], a[152:155], v[72:75]
  v_mfma_f32_16x16x32_bf16 v[76:79], a[212:215], a[172:175], v[76:79]
  v_mfma_f32_16x16x32_bf16 v[76:79], a[136:139], a[156:159], v[76:79]
  s_waitcnt vmcnt(10) lgkmcnt(0)
  v_mfma_f32_16x16x32_bf16 v[0:3], a[0:3], a[176:179], v[0:3]
  ds_read_b128 a[4:7], v122 offset:5120
  ds_read_b128 a[24:27], v122 offset:10240
  v_mfma_f32_16x16x32_bf16 v[0:3], a[20:23], a[180:183], v[0:3]
  v_mfma_f32_16x16x32_bf16 v[4:7], a[20:23], v[236:239], v[4:7]
  v_mfma_f32_16x16x32_bf16 v[4:7], a[0:3], v[216:219], v[4:7]
  v_mfma_f32_16x16x32_bf16 v[8:11], a[0:3], v[220:223], v[8:11]
  v_mfma_f32_16x16x32_bf16 v[8:11], a[20:23], v[240:243], v[8:11]
  v_mfma_f32_16x16x32_bf16 v[12:15], a[20:23], v[244:247], v[12:15]
  v_mfma_f32_16x16x32_bf16 v[12:15], a[0:3], v[224:227], v[12:15]
  s_waitcnt lgkmcnt(0)
  v_mfma_f32_16x16x32_bf16 v[16:19], a[4:7], a[176:179], v[16:19]
  ds_read_b128 a[8:11], v122 offset:6144
  ds_read_b128 a[28:31], v122 offset:11264
  v_mfma_f32_16x16x32_bf16 v[16:19], a[24:27], a[180:183], v[16:19]
  v_mfma_f32_16x16x32_bf16 v[20:23], a[24:27], v[236:239], v[20:23]
  v_mfma_f32_16x16x32_bf16 v[20:23], a[4:7], v[216:219], v[20:23]
  v_mfma_f32_16x16x32_bf16 v[24:27], a[4:7], v[220:223], v[24:27]
  v_mfma_f32_16x16x32_bf16 v[24:27], a[24:27], v[240:243], v[24:27]
  v_mfma_f32_16x16x32_bf16 v[28:31], a[24:27], v[244:247], v[28:31]
  v_mfma_f32_16x16x32_bf16 v[28:31], a[4:7], v[224:227], v[28:31]
  s_waitcnt lgkmcnt(0)
  v_mfma_f32_16x16x32_bf16 v[32:35], a[8:11], a[176:179], v[32:35]
  ds_read_b128 a[12:15], v122 offset:7168
  ds_read_b128 a[32:35], v122 offset:12288
  v_mfma_f32_16x16x32_bf16 v[32:35], a[28:31], a[180:183], v[32:35]
  v_mfma_f32_16x16x32_bf16 v[36:39], a[28:31], v[236:239], v[36:39]
  v_mfma_f32_16x16x32_bf16 v[36:39], a[8:11], v[216:219], v[36:39]
  v_mfma_f32_16x16x32_bf16 v[40:43], a[8:11], v[220:223], v[40:43]
  v_mfma_f32_16x16x32_bf16 v[40:43], a[28:31], v[240:243], v[40:43]
  v_mfma_f32_16x16x32_bf16 v[44:47], a[28:31], v[244:247], v[44:47]
  v_mfma_f32_16x16x32_bf16 v[44:47], a[8:11], v[224:227], v[44:47]
  s_waitcnt lgkmcnt(0)
  v_mfma_f32_16x16x32_bf16 v[48:51], a[12:15], a[176:179], v[48:51]
  ds_read_b128 a[16:19], v122 offset:8192
  ds_read_b128 a[36:39], v122 offset:13312
  v_mfma_f32_16x16x32_bf16 v[48:51], a[32:35], a[180:183], v[48:51]
  v_mfma_f32_16x16x32_bf16 v[52:55], a[32:35], v[236:239], v[52:55]
  v_mfma_f32_16x16x32_bf16 v[52:55], a[12:15], v[216:219], v[52:55]
  v_mfma_f32_16x16x32_bf16 v[56:59], a[12:15], v[220:223], v[56:59]
  v_mfma_f32_16x16x32_bf16 v[56:59], a[32:35], v[240:243], v[56:59]
  v_mfma_f32_16x16x32_bf16 v[60:63], a[32:35], v[244:247], v[60:63]
  v_mfma_f32_16x16x32_bf16 v[60:63], a[12:15], v[224:227], v[60:63]
  s_waitcnt lgkmcnt(0)
  v_mfma_f32_16x16x32_bf16 v[64:67], a[16:19], a[176:179], v[64:67]
  ds_read_b128 a[216:219], v122 offset:14336
  ds_read_b128 a[228:231], v122 offset:19456
  v_mfma_f32_16x16x32_bf16 v[64:67], a[36:39], a[180:183], v[64:67]
  v_mfma_f32_16x16x32_bf16 v[68:71], a[36:39], v[236:239], v[68:71]
  v_mfma_f32_16x16x32_bf16 v[68:71], a[16:19], v[216:219], v[68:71]
  v_mfma_f32_16x16x32_bf16 v[72:75], a[16:19], v[220:223], v[72:75]
  v_mfma_f32_16x16x32_bf16 v[72:75], a[36:39], v[240:243], v[72:75]
  v_mfma_f32_16x16x32_bf16 v[76:79], a[36:39], v[244:247], v[76:79]
  v_mfma_f32_16x16x32_bf16 v[76:79], a[16:19], v[224:227], v[76:79]
  s_waitcnt vmcnt(0)
  v_cmp_lt_u32 vcc, v128, v134
  s_nop 0
  s_cbranch_vccz tail_partner
  s_mov_b32 s35, 32768
tail_spin2:
  s_sleep 2
  buffer_load_dword v128, v133, s[24:27], 0 offen sc1
  s_waitcnt vmcnt(0)
  v_cmp_lt_u32 vcc, v128, v134
  s_nop 0
  s_cbranch_vccz tail_partner
  s_sub_u32 s35, s35, 1
  s_cmp_lg_u32 s35, 0
  s_cbranch_scc1 tail_spin2
tail_partner:
  s_waitcnt lgkmcnt(0)
  v_mfma_f32_16x16x32_bf16 v[0:3], a[216:219], v[228:231], v[0:3]
  ds_read_b128 a[232:235], v122 offset:15360
  ds_read_b128 a[220:223], v122 offset:20480
  v_mfma_f32_16x16x32_bf16 v[0:3], a[228:231], v[248:251], v[0:3]
  buffer_load_dwordx4 v[136:139], v114, s[24:27], s38 offen offset:0 sc1
  v_mfma_f32_16x16x32_bf16 v[4:7], a[228:231], v[252:255], v[4:7]
  buffer_load_dwordx4 v[140:143], v114, s[24:27], s38 offen offset:1024 sc1
  v_mfma_f32_16x16x32_bf16 v[4:7], a[216:219], v[232:235], v[4:7]
  buffer_load_dwordx4 v[144:147], v114, s[24:27], s38 offen offset:2048 sc1
  v_mfma_f32_16x16x32_bf16 v[8:11], a[216:219], a[184:187], v[8:11]
  buffer_load_dwordx4 v[148:151], v114, s[24:27], s38 offen offset:3072 sc1
  v_mfma_f32_16x16x32_bf16 v[8:11], a[228:231], a[188:191], v[8:11]
  buffer_load_dwordx4 v[152:155], v114, s[24:27], s39 offen offset:0 sc1
  v_mfma_f32_16x16x32_bf16 v[12:15], a[228:231], a[164:167], v[12:15]
  v_mfma_f32_16x16x32_bf16 v[12:15], a[216:219], a[192:195], v[12:15]
  s_waitcnt lgkmcnt(0)
  v_mfma_f32_16x16x32_bf16 v[16:19], a[232:235], v[228:231], v[16:19]
  ds_read_b128 a[224:227], v122 offset:16384
  ds_read_b128 a[196:199], v122 offset:21504
  v_mfma_f32_16x16x32_bf16 v[16:19], a[220:223], v[248:251], v[16:19]
  ds_write_b128 v122, v[4:7] offset:0
  ds_write_b128 v122, v[8:11] offset:5120
  v_mfma_f32_16x16x32_bf16 v[20:23], a[220:223], v[252:255], v[20:23]
  ds_write_b128 v122, v[12:15] offset:10240
  v_mfma_f32_16x16x32_bf16 v[20:23], a[232:235], v[232:235], v[20:23]
  v_mfma_f32_16x16x32_bf16 v[24:27], a[232:235], a[184:187], v[24:27]
  v_mfma_f32_16x16x32_bf16 v[24:27], a[220:223], a[188:191], v[24:27]
  v_mfma_f32_16x16x32_bf16 v[28:31], a[220:223], a[164:167], v[28:31]
  v_mfma_f32_16x16x32_bf16 v[28:31], a[232:235], a[192:195], v[28:31]
  s_waitcnt lgkmcnt(3)
  v_mfma_f32_16x16x32_bf16 v[32:35], a[224:227], v[228:231], v[32:35]
  ds_read_b128 a[200:203], v122 offset:17408
  ds_read_b128 a[40:43], v122 offset:22528
  v_mfma_f32_16x16x32_bf16 v[32:35], a[196:199], v[248:251], v[32:35]
  ds_write_b128 v122, v[20:23] offset:1024
  ds_write_b128 v122, v[24:27] offset:6144
  v_mfma_f32_16x16x32_bf16 v[36:39], a[196:199], v[252:255], v[36:39]
  ds_write_b128 v122, v[28:31] offset:11264
  v_mfma_f32_16x16x32_bf16 v[36:39], a[224:227], v[232:235], v[36:39]
  v_mfma_f32_16x16x32_bf16 v[40:43], a[224:227], a[184:187], v[40:43]
  v_mfma_f32_16x16x32_bf16 v[40:43], a[196:199], a[188:191], v[40:43]
  v_mfma_f32_16x16x32_bf16 v[44:47], a[196:199], a[164:167], v[44:47]
  v_mfma_f32_16x16x32_bf16 v[44:47], a[224:227], a[192:195], v[44:47]
  s_waitcnt lgkmcnt(3)
  v_mfma_f32_16x16x32_bf16 v[48:51], a[200:203], v[228:231], v[48:51]
  ds_read_b128 a[60:63], v122 offset:18432
  ds_read_b128 a[44:47], v122 offset:23552
  v_mfma_f32_16x16x32_bf16 v[48:51], a[40:43], v[248:251], v[48:51]
  ds_write_b128 v122, v[36:39] offset:2048
  ds_write_b128 v122, v[40:43] offset:7168
  v_mfma_f32_16x16x32_bf16 v[52:55], a[40:43], v[252:255], v[52:55]
  ds_write_b128 v122, v[44:47] offset:12288
  v_mfma_f32_16x16x32_bf16 v[52:55], a[200:203], v[232:235], v[52:55]
  v_mfma_f32_16x16x32_bf16 v[56:59], a[200:203], a[184:187], v[56:59]
  v_mfma_f32_16x16x32_bf16 v[56:59], a[40:43], a[188:191], v[56:59]
  v_mfma_f32_16x16x32_bf16 v[60:63], a[40:43], a[164:167], v[60:63]
  v_mfma_f32_16x16x32_bf16 v[60:63], a[200:203], a[192:195], v[60:63]
  s_waitcnt lgkmcnt(3)
  v_mfma_f32_16x16x32_bf16 v[64:67], a[60:63], v[228:231], v[64:67]
  v_mfma_f32_16x16x32_bf16 v[64:67], a[44:47], v[248:251], v[64:67]
  v_mfma_f32_16x16x32_bf16 v[68:71], a[44:47], v[252:255], v[68:71]
  ds_write_b128 v122, v[52:55] offset:3072
  v_mfma_f32_16x16x32_bf16 v[68:71], a[60:63], v[232:235], v[68:71]
  ds_write_b128 v122, v[56:59] offset:8192
  v_mfma_f32_16x16x32_bf16 v[72:75], a[60:63], a[184:187], v[72:75]
  ds_write_b128 v122, v[60:63] offset:13312
  v_mfma_f32_16x16x32_bf16 v[72:75], a[44:47], a[188:191], v[72:75]
  v_mfma_f32_16x16x32_bf16 v[76:79], a[44:47], a[164:167], v[76:79]
  v_mfma_f32_16x16x32_bf16 v[76:79], a[60:63], a[192:195], v[76:79]
  s_nop 1
  ds_write_b128 v122, v[68:71] offset:4096
  s_nop 2
  ds_write_b128 v122, v[72:75] offset:9216
  s_nop 0
  ds_write_b128 v122, v[76:79] offset:14336
  s_waitcnt lgkmcnt(0)
  s_barrier
  ds_read_b128 v[4:7], v80 offset:0
  ds_read_b128 v[8:11], v81 offset:0
  ds_read_b128 v[12:15], v82 offset:0
  ds_read_b128 v[20:23], v80 offset:1024
  ds_read_b128 v[24:27], v81 offset:1024
  ds_read_b128 v[28:31], v82 offset:1024
  ds_read_b128 v[36:39], v80 offset:2048
  ds_read_b128 v[40:43], v81 offset:2048
  ds_read_b128 v[44:47], v82 offset:2048
  ds_read_b128 v[52:55], v80 offset:3072
  ds_read_b128 v[56:59], v81 offset:3072
  ds_read_b128 v[60:63], v82 offset:3072
  ds_read_b128 v[68:71], v80 offset:4096
  ds_read_b128 v[72:75], v81 offset:4096
  ds_read_b128 v[76:79], v82 offset:4096
  s_waitcnt vmcnt(4)
  v_add_f32 v0, v0, v136
  v_add_f32 v1, v1, v137
  v_add_f32 v2, v2, v138
  v_add_f32 v3, v3, v139
  s_waitcnt lgkmcnt(13)
  v_add_f32 v4, v4, v8
  v_add_f32 v5, v5, v9
  v_add_f32 v6, v6, v10
  v_add_f32 v7, v7, v11
  s_waitcnt lgkmcnt(12)
  v_add_f32 v0, v0, v12
  v_add_f32 v1, v1, v13
  v_add_f32 v2, v2, v14
  v_add_f32 v3, v3, v15
  v_add_f32 v0, v0, v4
  v_add_f32 v1, v1, v5
  v_add_f32 v2, v2, v6
  v_add_f32 v3, v3, v7
  v_cvt_pk_bf16_f32 v4, v0, v1
  v_cvt_pk_bf16_f32 v5, v2, v3
  v_lshlrev_b32 v0, 16, v4
  v_and_b32 v1, s34, v4
  v_lshlrev_b32 v2, 16, v5
  v_and_b32 v3, s34, v5
  v_mul_f32 v0, v0, v90
  v_mul_f32 v1, v1, v91
  v_mul_f32 v2, v2, v92
  v_mul_f32 v3, v3, v93
  v_cvt_pk_bf16_f32 v4, v0, v1
  v_cvt_pk_bf16_f32 v5, v2, v3
  v_lshlrev_b32 v0, 16, v4
  v_and_b32 v1, s34, v4
  v_lshlrev_b32 v2, 16, v5
  v_and_b32 v3, s34, v5
  v_add_f32 v0, v0, v156
  v_add_f32 v1, v1, v157
  v_add_f32 v2, v2, v158
  v_add_f32 v3, v3, v159
  v_cvt_pk_bf16_f32 v4, v0, v1
  v_cvt_pk_bf16_f32 v5, v2, v3
  buffer_store_dwordx2 v[4:5], v117, s[16:19], 0 offen offset:0
  s_waitcnt vmcnt(4)
  v_add_f32 v16, v16, v140
  v_add_f32 v17, v17, v141
  v_add_f32 v18, v18, v142
  v_add_f32 v19, v19, v143
  s_waitcnt lgkmcnt(10)
  v_add_f32 v20, v20, v24
  v_add_f32 v21, v21, v25
  v_add_f32 v22, v22, v26
  v_add_f32 v23, v23, v27
  s_waitcnt lgkmcnt(9)
  v_add_f32 v16, v16, v28
  v_add_f32 v17, v17, v29
  v_add_f32 v18, v18, v30
  v_add_f32 v19, v19, v31
  v_add_f32 v16, v16, v20
  v_add_f32 v17, v17, v21
  v_add_f32 v18, v18, v22
  v_add_f32 v19, v19, v23
  v_cvt_pk_bf16_f32 v20, v16, v17
  v_cvt_pk_bf16_f32 v21, v18, v19
  v_lshlrev_b32 v16, 16, v20
  v_and_b32 v17, s34, v20
  v_lshlrev_b32 v18, 16, v21
  v_and_b32 v19, s34, v21
  v_mul_f32 v16, v16, v94
  v_mul_f32 v17, v17, v95
  v_mul_f32 v18, v18, v96
  v_mul_f32 v19, v19, v97
  v_cvt_pk_bf16_f32 v20, v16, v17
  v_cvt_pk_bf16_f32 v21, v18, v19
  v_lshlrev_b32 v16, 16, v20
  v_and_b32 v17, s34, v20
  v_lshlrev_b32 v18, 16, v21
  v_and_b32 v19, s34, v21
  v_add_f32 v16, v16, v160
  v_add_f32 v17, v17, v161
  v_add_f32 v18, v18, v162
  v_add_f32 v19, v19, v163
  v_cvt_pk_bf16_f32 v20, v16, v17
  v_cvt_pk_bf16_f32 v21, v18, v19
  buffer_store_dwordx2 v[20:21], v117, s[16:19], 0 offen offset:32
  s_waitcnt vmcnt(4)
  v_add_f32 v32, v32, v144
  v_add_f32 v33, v33, v145
  v_add_f32 v34, v34, v146
  v_add_f32 v35, v35, v147
  s_waitcnt lgkmcnt(7)
  v_add_f32 v36, v36, v40
  v_add_f32 v37, v37, v41
  v_add_f32 v38, v38, v42
  v_add_f32 v39, v39, v43
  s_waitcnt lgkmcnt(6)
  v_add_f32 v32, v32, v44
  v_add_f32 v33, v33, v45
  v_add_f32 v34, v34, v46
  v_add_f32 v35, v35, v47
  v_add_f32 v32, v32, v36
  v_add_f32 v33, v33, v37
  v_add_f32 v34, v34, v38
  v_add_f32 v35, v35, v39
  v_cvt_pk_bf16_f32 v36, v32, v33
  v_cvt_pk_bf16_f32 v37, v34, v35
  v_lshlrev_b32 v32, 16, v36
  v_and_b32 v33, s34, v36
  v_lshlrev_b32 v34, 16, v37
  v_and_b32 v35, s34, v37
  v_mul_f32 v32, v32, v98
  v_mul_f32 v33, v33, v99
  v_mul_f32 v34, v34, v100
  v_mul_f32 v35, v35, v101
  v_cvt_pk_bf16_f32 v36, v32, v33
  v_cvt_pk_bf16_f32 v37, v34, v35
  v_lshlrev_b32 v32, 16, v36
  v_and_b32 v33, s34, v36
  v_lshlrev_b32 v34, 16, v37
  v_and_b32 v35, s34, v37
  v_add_f32 v32, v32, v164
  v_add_f32 v33, v33, v165
  v_add_f32 v34, v34, v166
  v_add_f32 v35, v35, v167
  v_cvt_pk_bf16_f32 v36, v32, v33
  v_cvt_pk_bf16_f32 v37, v34, v35
  buffer_store_dwordx2 v[36:37], v117, s[16:19], 0 offen offset:64
  s_waitcnt vmcnt(4)
  v_add_f32 v48, v48, v148
  v_add_f32 v49, v49, v149
  v_add_f32 v50, v50, v150
  v_add_f32 v51, v51, v151
  s_waitcnt lgkmcnt(4)
  v_add_f32 v52, v52, v56
  v_add_f32 v53, v53, v57
  v_add_f32 v54, v54, v58
  v_add_f32 v55, v55, v59
  s_waitcnt lgkmcnt(3)
  v_add_f32 v48, v48, v60
  v_add_f32 v49, v49, v61
  v_add_f32 v50, v50, v62
  v_add_f32 v51, v51, v63
  v_add_f32 v48, v48, v52
  v_add_f32 v49, v49, v53
  v_add_f32 v50, v50, v54
  v_add_f32 v51, v51, v55
  v_cvt_pk_bf16_f32 v52, v48, v49
  v_cvt_pk_bf16_f32 v53, v50, v51
  v_lshlrev_b32 v48, 16, v52
  v_and_b32 v49, s34, v52
  v_lshlrev_b32 v50, 16, v53
  v_and_b32 v51, s34, v53
  v_mul_f32 v48, v48, v102
  v_mul_f32 v49, v49, v103
  v_mul_f32 v50, v50, v104
  v_mul_f32 v51, v51, v105
  v_cvt_pk_bf16_f32 v52, v48, v49
  v_cvt_pk_bf16_f32 v53, v50, v51
  v_lshlrev_b32 v48, 16, v52
  v_and_b32 v49, s34, v52
  v_lshlrev_b32 v50, 16, v53
  v_and_b32 v51, s34, v53
  v_add_f32 v48, v48, v168
  v_add_f32 v49, v49, v169
  v_add_f32 v50, v50, v170
  v_add_f32 v51, v51, v171
  v_cvt_pk_bf16_f32 v52, v48, v49
  v_cvt_pk_bf16_f32 v53, v50, v51
  buffer_store_dwordx2 v[52:53], v117, s[16:19], 0 offen offset:96
  s_waitcnt vmcnt(4)
  v_add_f32 v64, v64, v152
  v_add_f32 v65, v65, v153
  v_add_f32 v66, v66, v154
  v_add_f32 v67, v67, v155
  s_waitcnt lgkmcnt(1)
  v_add_f32 v68, v68, v72
  v_add_f32 v69, v69, v73
  v_add_f32 v70, v70, v74
  v_add_f32 v71, v71, v75
  s_waitcnt lgkmcnt(0)
  v_add_f32 v64, v64, v76
  v_add_f32 v65, v65, v77
  v_add_f32 v66, v66, v78
  v_add_f32 v67, v67, v79
  v_add_f32 v64, v64, v68
  v_add_f32 v65, v65, v69
  v_add_f32 v66, v66, v70
  v_add_f32 v67, v67, v71
  v_cvt_pk_bf16_f32 v68, v64, v65
  v_cvt_pk_bf16_f32 v69, v66, v67
  v_lshlrev_b32 v64, 16, v68
  v_and_b32 v65, s34, v68
  v_lshlrev_b32 v66, 16, v69
  v_and_b32 v67, s34, v69
  v_mul_f32 v64, v64, v106
  v_mul_f32 v65, v65, v107
  v_mul_f32 v66, v66, v108
  v_mul_f32 v67, v67, v109
  v_cvt_pk_bf16_f32 v68, v64, v65
  v_cvt_pk_bf16_f32 v69, v66, v67
  v_lshlrev_b32 v64, 16, v68
  v_and_b32 v65, s34, v68
  v_lshlrev_b32 v66, 16, v69
  v_and_b32 v67, s34, v69
  v_add_f32 v64, v64, v172
  v_add_f32 v65, v65, v173
  v_add_f32 v66, v66, v174
  v_add_f32 v67, v67, v175
  v_cvt_pk_bf16_f32 v68, v64, v65
  v_cvt_pk_bf16_f32 v69, v66, v67
  buffer_store_dwordx2 v[68:69], v117, s[16:19], 0 offen offset:128
attn_end:
  s_endpgm
attn_redo:
  s_waitcnt vmcnt(0)
  v_accvgpr_write_b32 a0, 0
  v_accvgpr_write_b32 a1, 0
  v_accvgpr_write_b32 a2, 0
  v_accvgpr_write_b32 a3, 0
  v_accvgpr_write_b32 a4, 0
  v_accvgpr_write_b32 a5, 0
  v_accvgpr_write_b32 a6, 0
  v_accvgpr_write_b32 a7, 0
  v_accvgpr_write_b32 a8, 0
  v_accvgpr_write_b32 a9, 0
  v_accvgpr_write_b32 a10, 0
  v_accvgpr_write_b32 a11, 0
  v_accvgpr_write_b32 a12, 0
  v_accvgpr_write_b32 a13, 0
  v_accvgpr_write_b32 a14, 0
  v_accvgpr_write_b32 a15, 0
  v_accvgpr_write_b32 a16, 0
  v_accvgpr_write_b32 a17, 0
  v_accvgpr_write_b32 a18, 0
  v_accvgpr_write_b32 a19, 0
  v_accvgpr_write_b32 a20, 0
  v_accvgpr_write_b32 a21, 0
  v_accvgpr_write_b32 a22, 0
  v_accvgpr_write_b32 a23, 0
  v_accvgpr_write_b32 a24, 0
  v_accvgpr_write_b32 a25, 0
  v_accvgpr_write_b32 a26, 0
  v_accvgpr_write_b32 a27, 0
  v_accvgpr_write_b32 a28, 0
  v_accvgpr_write_b32 a29, 0
  v_accvgpr_write_b32 a30, 0
  v_accvgpr_write_b32 a31, 0
  v_accvgpr_write_b32 a32, 0
  v_accvgpr_write_b32 a33, 0
  v_accvgpr_write_b32 a34, 0
  v_accvgpr_write_b32 a35, 0
  v_accvgpr_write_b32 a36, 0
  v_accvgpr_write_b32 a37, 0
  v_accvgpr_write_b32 a38, 0
  v_accvgpr_write_b32 a39, 0
  v_accvgpr_write_b32 a40, 0
  v_accvgpr_write_b32 a41, 0
  v_accvgpr_write_b32 a42, 0
  v_accvgpr_write_b32 a43, 0
  v_accvgpr_write_b32 a44, 0
  v_accvgpr_write_b32 a45, 0
  v_accvgpr_write_b32 a46, 0
  v_accvgpr_write_b32 a47, 0
  v_accvgpr_write_b32 a48, 0
  v_accvgpr_write_b32 a49, 0
  v_accvgpr_write_b32 a50, 0
  v_accvgpr_write_b32 a51, 0
  v_accvgpr_write_b32 a52, 0
  v_accvgpr_write_b32 a53, 0
  v_accvgpr_write_b32 a54, 0
  v_accvgpr_write_b32 a55, 0
  v_accvgpr_write_b32 a56, 0
  v_accvgpr_write_b32 a57, 0
  v_accvgpr_write_b32 a58, 0
  v_accvgpr_write_b32 a59, 0
  v_accvgpr_write_b32 a60, 0
  v_accvgpr_write_b32 a61, 0
  v_accvgpr_write_b32 a62, 0
  v_accvgpr_write_b32 a63, 0
  v_accvgpr_write_b32 a64, 0
  v_accvgpr_write_b32 a65, 0
  v_accvgpr_write_b32 a66, 0
  v_accvgpr_write_b32 a67, 0
  v_accvgpr_write_b32 a68, 0
  v_accvgpr_write_b32 a69, 0
  v_accvgpr_write_b32 a70, 0
  v_accvgpr_write_b32 a71, 0
  v_accvgpr_write_b32 a72, 0
  v_accvgpr_write_b32 a73, 0
  v_accvgpr_write_b32 a74, 0
  v_accvgpr_write_b32 a75, 0
  v_accvgpr_write_b32 a76, 0
  v_accvgpr_write_b32 a77, 0
  v_accvgpr_write_b32 a78, 0
  v_accvgpr_write_b32 a79, 0
  v_accvgpr_write_b32 a80, 0
  v_accvgpr_write_b32 a81, 0
  v_accvgpr_write_b32 a82, 0
  v_accvgpr_write_b32 a83, 0
  v_accvgpr_write_b32 a84, 0
  v_accvgpr_write_b32 a85, 0
  v_accvgpr_write_b32 a86, 0
  v_accvgpr_write_b32 a87, 0
  v_accvgpr_write_b32 a88, 0
  v_accvgpr_write_b32 a89, 0
  v_accvgpr_write_b32 a90, 0
  v_accvgpr_write_b32 a91, 0
  v_accvgpr_write_b32 a92, 0
  v_accvgpr_write_b32 a93, 0
  v_accvgpr_write_b32 a94, 0
  v_accvgpr_write_b32 a95, 0
  v_accvgpr_write_b32 a96, 0
  v_accvgpr_write_b32 a97, 0
  v_accvgpr_write_b32 a98, 0
  v_accvgpr_write_b32 a99, 0
  v_accvgpr_write_b32 a100, 0
  v_accvgpr_write_b32 a101, 0
  v_accvgpr_write_b32 a102, 0
  v_accvgpr_write_b32 a103, 0
  v_accvgpr_write_b32 a104, 0
  v_accvgpr_write_b32 a105, 0
  v_accvgpr_write_b32 a106, 0
  v_accvgpr_write_b32 a107, 0
  v_accvgpr_write_b32 a108, 0
  v_accvgpr_write_b32 a109, 0
  v_accvgpr_write_b32 a110, 0
  v_accvgpr_write_b32 a111, 0
  v_accvgpr_write_b32 a112, 0
  v_accvgpr_write_b32 a113, 0
  v_accvgpr_write_b32 a114, 0
  v_accvgpr_write_b32 a115, 0
  v_accvgpr_write_b32 a116, 0
  v_accvgpr_write_b32 a117, 0
  v_accvgpr_write_b32 a118, 0
  v_accvgpr_write_b32 a119, 0
  v_accvgpr_write_b32 a120, 0
  v_accvgpr_write_b32 a121, 0
  v_accvgpr_write_b32 a122, 0
  v_accvgpr_write_b32 a123, 0
  v_accvgpr_write_b32 a124, 0
  v_accvgpr_write_b32 a125, 0
  v_accvgpr_write_b32 a126, 0
  v_accvgpr_write_b32 a127, 0
  v_mov_b32 v208, 0
  v_mov_b32 v249, 0xff800000
  v_mov_b32 v209, 0
  v_mov_b32 v250, 0xff800000
  v_mov_b32 v210, 0
  v_mov_b32 v251, 0xff800000
  v_mov_b32 v211, 0
  v_mov_b32 v252, 0xff800000
  s_mov_b32 s29, 0
attn_slow:
  s_barrier
  s_add_u32 m0, s28, 0
  s_nop 0
  buffer_load_dwordx4 v232, s[12:15], s29 offen offset:0 lds
  buffer_load_dwordx4 v233, s[12:15], s29 offen offset:1024 lds
  buffer_load_dwordx4 v234, s[12:15], s29 offen offset:2048 lds
  buffer_load_dwordx4 v235, s[12:15], s29 offen offset:3072 lds
  s_add_u32 m0, s28, 65536
  s_nop 0
  buffer_load_dwordx4 v236, s[16:19], s29 offen offset:0 lds
  buffer_load_dwordx4 v237, s[16:19], s29 offen offset:1024 lds
  buffer_load_dwordx4 v236, s[16:19], s29 offen offset:2048 lds
  buffer_load_dwordx4 v237, s[16:19], s29 offen offset:3072 lds
  s_waitcnt vmcnt(0)
  s_barrier
  ds_read_b128 a[128:131], v212 offset:0
  ds_read_b128 a[132:135], v213 offset:0
  ds_read_b128 a[136:139], v214 offset:0
  ds_read_b128 a[140:143], v215 offset:0
  s_waitcnt lgkmcnt(3)
  v_mfma_f32_16x16x32_bf16 v[0:3], a[128:131], v[128:131], 0
  s_waitcnt lgkmcnt(2)
  v_mfma_f32_16x16x32_bf16 v[0:3], a[132:135], v[132:135], v[0:3]
  s_waitcnt lgkmcnt(1)
  v_mfma_f32_16x16x32_bf16 v[0:3], a[136:139], v[136:139], v[0:3]
  s_waitcnt lgkmcnt(0)
  v_mfma_f32_16x16x32_bf16 v[0:3], a[140:143], v[140:143], v[0:3]
  v_mfma_f32_16x16x32_bf16 v[8:11], a[140:143], v[156:159], 0
  v_mfma_f32_16x16x32_bf16 v[8:11], a[136:139], v[152:155], v[8:11]
  v_mfma_f32_16x16x32_bf16 v[8:11], a[132:135], v[148:151], v[8:11]
  v_mfma_f32_16x16x32_bf16 v[8:11], a[128:131], v[144:147], v[8:11]
  v_mfma_f32_16x16x32_bf16 v[16:19], a[128:131], v[160:163], 0
  v_mfma_f32_16x16x32_bf16 v[16:19], a[132:135], v[164:167], v[16:19]
  v_mfma_f32_16x16x32_bf16 v[16:19], a[136:139], v[168:171], v[16:19]
  v_mfma_f32_16x16x32_bf16 v[16:19], a[140:143], v[172:175], v[16:19]
  v_mfma_f32_16x16x32_bf16 v[24:27], a[140:143], v[188:191], 0
  v_mfma_f32_16x16x32_bf16 v[24:27], a[136:139], v[184:187], v[24:27]
  v_mfma_f32_16x16x32_bf16 v[24:27], a[132:135], v[180:183], v[24:27]
  v_mfma_f32_16x16x32_bf16 v[24:27], a[128:131], v[176:179], v[24:27]
  ds_read_b128 a[144:147], v212 offset:4096
  ds_read_b128 a[148:151], v213 offset:4096
  ds_read_b128 a[152:155], v214 offset:4096
  ds_read_b128 a[156:159], v215 offset:4096
  s_waitcnt lgkmcnt(3)
  v_mfma_f32_16x16x32_bf16 v[4:7], a[144:147], v[128:131], 0
  s_waitcnt lgkmcnt(2)
  v_mfma_f32_16x16x32_bf16 v[4:7], a[148:151], v[132:135], v[4:7]
  s_waitcnt lgkmcnt(1)
  v_mfma_f32_16x16x32_bf16 v[4:7], a[152:155], v[136:139], v[4:7]
  s_waitcnt lgkmcnt(0)
  v_mfma_f32_16x16x32_bf16 v[4:7], a[156:159], v[140:143], v[4:7]
  v_mfma_f32_16x16x32_bf16 v[12:15], a[156:159], v[156:159], 0
  v_mfma_f32_16x16x32_bf16 v[12:15], a[152:155], v[152:155], v[12:15]
  v_mfma_f32_16x16x32_bf16 v[12:15], a[148:151], v[148:151], v[12:15]
  v_mfma_f32_16x16x32_bf16 v[12:15], a[144:147], v[144:147], v[12:15]
  v_mfma_f32_16x16x32_bf16 v[20:23], a[144:147], v[160:163], 0
  v_mfma_f32_16x16x32_bf16 v[20:23], a[148:151], v[164:167], v[20:23]
  v_mfma_f32_16x16x32_bf16 v[20:23], a[152:155], v[168:171], v[20:23]
  v_mfma_f32_16x16x32_bf16 v[20:23], a[156:159], v[172:175], v[20:23]
  v_mfma_f32_16x16x32_bf16 v[28:31], a[156:159], v[188:191], 0
  v_mfma_f32_16x16x32_bf16 v[28:31], a[152:155], v[184:187], v[28:31]
  v_mfma_f32_16x16x32_bf16 v[28:31], a[148:151], v[180:183], v[28:31]
  v_mfma_f32_16x16x32_bf16 v[28:31], a[144:147], v[176:179], v[28:31]
  ds_read_b128 a[128:131], v212 offset:8192
  ds_read_b128 a[132:135], v213 offset:8192
  ds_read_b128 a[136:139], v214 offset:8192
  ds_read_b128 a[140:143], v215 offset:8192
  s_waitcnt lgkmcnt(3)
  v_mfma_f32_16x16x32_bf16 v[32:35], a[128:131], v[128:131], 0
  s_waitcnt lgkmcnt(2)
  v_mfma_f32_16x16x32_bf16 v[32:35], a[132:135], v[132:135], v[32:35]
  s_waitcnt lgkmcnt(1)
  v_mfma_f32_16x16x32_bf16 v[32:35], a[136:139], v[136:139], v[32:35]
  s_waitcnt lgkmcnt(0)
  v_mfma_f32_16x16x32_bf16 v[32:35], a[140:143], v[140:143], v[32:35]
  v_mfma_f32_16x16x32_bf16 v[40:43], a[140:143], v[156:159], 0
  v_mfma_f32_16x16x32_bf16 v[40:43], a[136:139], v[152:155], v[40:43]
  v_mfma_f32_16x16x32_bf16 v[40:43], a[132:135], v[148:151], v[40:43]
  v_mfma_f32_16x16x32_bf16 v[40:43], a[128:131], v[144:147], v[40:43]
  v_mfma_f32_16x16x32_bf16 v[48:51], a[128:131], v[160:163], 0
  v_mfma_f32_16x16x32_bf16 v[48:51], a[132:135], v[164:167], v[48:51]
  v_mfma_f32_16x16x32_bf16 v[48:51], a[136:139], v[168:171], v[48:51]
  v_mfma_f32_16x16x32_bf16 v[48:51], a[140:143], v[172:175], v[48:51]
  v_mfma_f32_16x16x32_bf16 v[56:59], a[140:143], v[188:191], 0
  v_mfma_f32_16x16x32_bf16 v[56:59], a[136:139], v[184:187], v[56:59]
  v_mfma_f32_16x16x32_bf16 v[56:59], a[132:135], v[180:183], v[56:59]
  v_mfma_f32_16x16x32_bf16 v[56:59], a[128:131], v[176:179], v[56:59]
  ds_read_b128 a[144:147], v212 offset:12288
  ds_read_b128 a[148:151], v213 offset:12288
  ds_read_b128 a[152:155], v214 offset:12288
  ds_read_b128 a[156:159], v215 offset:12288
  s_waitcnt lgkmcnt(3)
  v_mfma_f32_16x16x32_bf16 v[36:39], a[144:147], v[128:131], 0
  s_waitcnt lgkmcnt(2)
  v_mfma_f32_16x16x32_bf16 v[36:39], a[148:151], v[132:135], v[36:39]
  s_waitcnt lgkmcnt(1)
  v_mfma_f32_16x16x32_bf16 v[36:39], a[152:155], v[136:139], v[36:39]
  s_waitcnt lgkmcnt(0)
  v_mfma_f32_16x16x32_bf16 v[36:39], a[156:159], v[140:143], v[36:39]
  v_mfma_f32_16x16x32_bf16 v[44:47], a[156:159], v[156:159], 0
  v_mfma_f32_16x16x32_bf16 v[44:47], a[152:155], v[152:155], v[44:47]
  v_mfma_f32_16x16x32_bf16 v[44:47], a[148:151], v[148:151], v[44:47]
  v_mfma_f32_16x16x32_bf16 v[44:47], a[144:147], v[144:147], v[44:47]
  v_mfma_f32_16x16x32_bf16 v[52:55], a[144:147], v[160:163], 0
  v_mfma_f32_16x16x32_bf16 v[52:55], a[148:151], v[164:167], v[52:55]
  v_mfma_f32_16x16x32_bf16 v[52:55], a[152:155], v[168:171], v[52:55]
  v_mfma_f32_16x16x32_bf16 v[52:55], a[156:159], v[172:175], v[52:55]
  v_mfma_f32_16x16x32_bf16 v[60:63], a[156:159], v[188:191], 0
  v_mfma_f32_16x16x32_bf16 v[60:63], a[152:155], v[184:187], v[60:63]
  v_mfma_f32_16x16x32_bf16 v[60:63], a[148:151], v[180:183], v[60:63]
  v_mfma_f32_16x16x32_bf16 v[60:63], a[144:147], v[176:179], v[60:63]
  v_mov_b32 v192, v249
  v_max3_f32 v192, v192, v0, v1
  v_max3_f32 v192, v192, v2, v3
  v_max3_f32 v192, v192, v4, v5
  v_max3_f32 v192, v192, v6, v7
  v_max3_f32 v192, v192, v32, v33
  v_max3_f32 v192, v192, v34, v35
  v_max3_f32 v192, v192, v36, v37
  v_max3_f32 v192, v192, v38, v39
  v_mov_b32 v245, v192
  s_nop 1
  v_permlane16_swap_b32 v192, v245
  v_max_f32 v192, v192, v245
  v_mov_b32 v245, v192
  s_nop 1
  v_permlane32_swap_b32 v192, v245
  v_max_f32 v192, v192, v245
  v_sub_f32 v193, v249, v192
  v_exp_f32 v193, v193
  v_mov_b32 v249, v192
  v_mul_f32 v208, v208, v193
  v_sub_f32 v0, v0, v192
  v_sub_f32 v1, v1, v192
  v_sub_f32 v2, v2, v192
  v_sub_f32 v3, v3, v192
  v_sub_f32 v4, v4, v192
  v_sub_f32 v5, v5, v192
  v_sub_f32 v6, v6, v192
  v_sub_f32 v7, v7, v192
  v_sub_f32 v32, v32, v192
  v_sub_f32 v33, v33, v192
  v_sub_f32 v34, v34, v192
  v_sub_f32 v35, v35, v192
  v_sub_f32 v36, v36, v192
  v_sub_f32 v37, v37, v192
  v_sub_f32 v38, v38, v192
  v_sub_f32 v39, v39, v192
  v_exp_f32 v0, v0
  v_exp_f32 v1, v1
  v_add_f32 v208, v208, v0
  v_exp_f32 v2, v2
  v_add_f32 v208, v208, v1
  v_cvt_pk_bf16_f32 v0, v0, v1
  v_exp_f32 v3, v3
  v_add_f32 v208, v208, v2
  v_add_f32 v208, v208, v3
  v_cvt_pk_bf16_f32 v1, v2, v3
  v_exp_f32 v4, v4
  v_exp_f32 v5, v5
  v_add_f32 v208, v208, v4
  v_exp_f32 v6, v6
  v_add_f32 v208, v208, v5
  v_cvt_pk_bf16_f32 v2, v4, v5
  v_exp_f32 v7, v7
  v_add_f32 v208, v208, v6
  v_add_f32 v208, v208, v7
  v_cvt_pk_bf16_f32 v3, v6, v7
  v_exp_f32 v32, v32
  v_exp_f32 v33, v33
  v_add_f32 v208, v208, v32
  v_exp_f32 v34, v34
  v_add_f32 v208, v208, v33
  v_cvt_pk_bf16_f32 v32, v32, v33
  v_exp_f32 v35, v35
  v_add_f32 v208, v208, v34
  v_add_f32 v208, v208, v35
  v_cvt_pk_bf16_f32 v33, v34, v35
  v_exp_f32 v36, v36
  v_exp_f32 v37, v37
  v_add_f32 v208, v208, v36
  v_exp_f32 v38, v38
  v_add_f32 v208, v208, v37
  v_cvt_pk_bf16_f32 v34, v36, v37
  v_exp_f32 v39, v39
  v_add_f32 v208, v208, v38
  v_add_f32 v208, v208, v39
  v_cvt_pk_bf16_f32 v35, v38, v39
  v_accvgpr_read_b32 v64, a0
  v_accvgpr_read_b32 v65, a1
  v_accvgpr_read_b32 v66, a2
  v_accvgpr_read_b32 v67, a3
  v_mul_f32 v64, v64, v193
  v_mul_f32 v65, v65, v193
  v_mul_f32 v66, v66, v193
  v_mul_f32 v67, v67, v193
  v_accvgpr_write_b32 a0, v64
  v_accvgpr_write_b32 a1, v65
  v_accvgpr_write_b32 a2, v66
  v_accvgpr_write_b32 a3, v67
  v_accvgpr_read_b32 v64, a16
  v_accvgpr_read_b32 v65, a17
  v_accvgpr_read_b32 v66, a18
  v_accvgpr_read_b32 v67, a19
  v_mul_f32 v64, v64, v193
  v_mul_f32 v65, v65, v193
  v_mul_f32 v66, v66, v193
  v_mul_f32 v67, v67, v193
  v_accvgpr_write_b32 a16, v64
  v_accvgpr_write_b32 a17, v65
  v_accvgpr_write_b32 a18, v66
  v_accvgpr_write_b32 a19, v67
  v_accvgpr_read_b32 v64, a32
  v_accvgpr_read_b32 v65, a33
  v_accvgpr_read_b32 v66, a34
  v_accvgpr_read_b32 v67, a35
  v_mul_f32 v64, v64, v193
  v_mul_f32 v65, v65, v193
  v_mul_f32 v66, v66, v193
  v_mul_f32 v67, v67, v193
  v_accvgpr_write_b32 a32, v64
  v_accvgpr_write_b32 a33, v65
  v_accvgpr_write_b32 a34, v66
  v_accvgpr_write_b32 a35, v67
  v_accvgpr_read_b32 v64, a48
  v_accvgpr_read_b32 v65, a49
  v_accvgpr_read_b32 v66, a50
  v_accvgpr_read_b32 v67, a51
  v_mul_f32 v64, v64, v193
  v_mul_f32 v65, v65, v193
  v_mul_f32 v66, v66, v193
  v_mul_f32 v67, v67, v193
  v_accvgpr_write_b32 a48, v64
  v_accvgpr_write_b32 a49, v65
  v_accvgpr_write_b32 a50, v66
  v_accvgpr_write_b32 a51, v67
  v_accvgpr_read_b32 v64, a64
  v_accvgpr_read_b32 v65, a65
  v_accvgpr_read_b32 v66, a66
  v_accvgpr_read_b32 v67, a67
  v_mul_f32 v64, v64, v193
  v_mul_f32 v65, v65, v193
  v_mul_f32 v66, v66, v193
  v_mul_f32 v67, v67, v193
  v_accvgpr_write_b32 a64, v64
  v_accvgpr_write_b32 a65, v65
  v_accvgpr_write_b32 a66, v66
  v_accvgpr_write_b32 a67, v67
  v_accvgpr_read_b32 v64, a80
  v_accvgpr_read_b32 v65, a81
  v_accvgpr_read_b32 v66, a82
  v_accvgpr_read_b32 v67, a83
  v_mul_f32 v64, v64, v193
  v_mul_f32 v65, v65, v193
  v_mul_f32 v66, v66, v193
  v_mul_f32 v67, v67, v193
  v_accvgpr_write_b32 a80, v64
  v_accvgpr_write_b32 a81, v65
  v_accvgpr_write_b32 a82, v66
  v_accvgpr_write_b32 a83, v67
  v_accvgpr_read_b32 v64, a96
  v_accvgpr_read_b32 v65, a97
  v_accvgpr_read_b32 v66, a98
  v_accvgpr_read_b32 v67, a99
  v_mul_f32 v64, v64, v193
  v_mul_f32 v65, v65, v193
  v_mul_f32 v66, v66, v193
  v_mul_f32 v67, v67, v193
  v_accvgpr_write_b32 a96, v64
  v_accvgpr_write_b32 a97, v65
  v_accvgpr_write_b32 a98, v66
  v_accvgpr_write_b32 a99, v67
  v_accvgpr_read_b32 v64, a112
  v_accvgpr_read_b32 v65, a113
  v_accvgpr_read_b32 v66, a114
  v_accvgpr_read_b32 v67, a115
  v_mul_f32 v64, v64, v193
  v_mul_f32 v65, v65, v193
  v_mul_f32 v66, v66, v193
  v_mul_f32 v67, v67, v193
  v_accvgpr_write_b32 a112, v64
  v_accvgpr_write_b32 a113, v65
  v_accvgpr_write_b32 a114, v66
  v_accvgpr_write_b32 a115, v67
  v_mov_b32 v196, v250
  v_max3_f32 v196, v196, v8, v9
  v_max3_f32 v196, v196, v10, v11
  v_max3_f32 v196, v196, v12, v13
  v_max3_f32 v196, v196, v14, v15
  v_max3_f32 v196, v196, v40, v41
  v_max3_f32 v196, v196, v42, v43
  v_max3_f32 v196, v196, v44, v45
  v_max3_f32 v196, v196, v46, v47
  v_mov_b32 v245, v196
  s_nop 1
  v_permlane16_swap_b32 v196, v245
  v_max_f32 v196, v196, v245
  v_mov_b32 v245, v196
  s_nop 1
  v_permlane32_swap_b32 v196, v245
  v_max_f32 v196, v196, v245
  v_sub_f32 v197, v250, v196
  v_exp_f32 v197, v197
  v_mov_b32 v250, v196
  v_mul_f32 v209, v209, v197
  v_sub_f32 v8, v8, v196
  v_sub_f32 v9, v9, v196
  v_sub_f32 v10, v10, v196
  v_sub_f32 v11, v11, v196
  v_sub_f32 v12, v12, v196
  v_sub_f32 v13, v13, v196
  v_sub_f32 v14, v14, v196
  v_sub_f32 v15, v15, v196
  v_sub_f32 v40, v40, v196
  v_sub_f32 v41, v41, v196
  v_sub_f32 v42, v42, v196
  v_sub_f32 v43, v43, v196
  v_sub_f32 v44, v44, v196
  v_sub_f32 v45, v45, v196
  v_sub_f32 v46, v46, v196
  v_sub_f32 v47, v47, v196
  v_exp_f32 v8, v8
  v_exp_f32 v9, v9
  v_add_f32 v209, v209, v8
  v_exp_f32 v10, v10
  v_add_f32 v209, v209, v9
  v_cvt_pk_bf16_f32 v8, v8, v9
  v_exp_f32 v11, v11
  v_add_f32 v209, v209, v10
  v_add_f32 v209, v209, v11
  v_cvt_pk_bf16_f32 v9, v10, v11
  v_exp_f32 v12, v12
  v_exp_f32 v13, v13
  v_add_f32 v209, v209, v12
  v_exp_f32 v14, v14
  v_add_f32 v209, v209, v13
  v_cvt_pk_bf16_f32 v10, v12, v13
  v_exp_f32 v15, v15
  v_add_f32 v209, v209, v14
  v_add_f32 v209, v209, v15
  v_cvt_pk_bf16_f32 v11, v14, v15
  v_exp_f32 v40, v40
  v_exp_f32 v41, v41
  v_add_f32 v209, v209, v40
  v_exp_f32 v42, v42
  v_add_f32 v209, v209, v41
  v_cvt_pk_bf16_f32 v40, v40, v41
  v_exp_f32 v43, v43
  v_add_f32 v209, v209, v42
  v_add_f32 v209, v209, v43
  v_cvt_pk_bf16_f32 v41, v42, v43
  v_exp_f32 v44, v44
  v_exp_f32 v45, v45
  v_add_f32 v209, v209, v44
  v_exp_f32 v46, v46
  v_add_f32 v209, v209, v45
  v_cvt_pk_bf16_f32 v42, v44, v45
  v_exp_f32 v47, v47
  v_add_f32 v209, v209, v46
  v_add_f32 v209, v209, v47
  v_cvt_pk_bf16_f32 v43, v46, v47
  v_accvgpr_read_b32 v64, a4
  v_accvgpr_read_b32 v65, a5
  v_accvgpr_read_b32 v66, a6
  v_accvgpr_read_b32 v67, a7
  v_mul_f32 v64, v64, v197
  v_mul_f32 v65, v65, v197
  v_mul_f32 v66, v66, v197
  v_mul_f32 v67, v67, v197
  v_accvgpr_write_b32 a4, v64
  v_accvgpr_write_b32 a5, v65
  v_accvgpr_write_b32 a6, v66
  v_accvgpr_write_b32 a7, v67
  v_accvgpr_read_b32 v64, a20
  v_accvgpr_read_b32 v65, a21
  v_accvgpr_read_b32 v66, a22
  v_accvgpr_read_b32 v67, a23
  v_mul_f32 v64, v64, v197
  v_mul_f32 v65, v65, v197
  v_mul_f32 v66, v66, v197
  v_mul_f32 v67, v67, v197
  v_accvgpr_write_b32 a20, v64
  v_accvgpr_write_b32 a21, v65
  v_accvgpr_write_b32 a22, v66
  v_accvgpr_write_b32 a23, v67
  v_accvgpr_read_b32 v64, a36
  v_accvgpr_read_b32 v65, a37
  v_accvgpr_read_b32 v66, a38
  v_accvgpr_read_b32 v67, a39
  v_mul_f32 v64, v64, v197
  v_mul_f32 v65, v65, v197
  v_mul_f32 v66, v66, v197
  v_mul_f32 v67, v67, v197
  v_accvgpr_write_b32 a36, v64
  v_accvgpr_write_b32 a37, v65
  v_accvgpr_write_b32 a38, v66
  v_accvgpr_write_b32 a39, v67
  v_accvgpr_read_b32 v64, a52
  v_accvgpr_read_b32 v65, a53
  v_accvgpr_read_b32 v66, a54
  v_accvgpr_read_b32 v67, a55
  v_mul_f32 v64, v64, v197
  v_mul_f32 v65, v65, v197
  v_mul_f32 v66, v66, v197
  v_mul_f32 v67, v67, v197
  v_accvgpr_write_b32 a52, v64
  v_accvgpr_write_b32 a53, v65
  v_accvgpr_write_b32 a54, v66
  v_accvgpr_write_b32 a55, v67
  v_accvgpr_read_b32 v64, a68
  v_accvgpr_read_b32 v65, a69
  v_accvgpr_read_b32 v66, a70
  v_accvgpr_read_b32 v67, a71
  v_mul_f32 v64, v64, v197
  v_mul_f32 v65, v65, v197
  v_mul_f32 v66, v66, v197
  v_mul_f32 v67, v67, v197
  v_accvgpr_write_b32 a68, v64
  v_accvgpr_write_b32 a69, v65
  v_accvgpr_write_b32 a70, v66
  v_accvgpr_write_b32 a71, v67
  v_accvgpr_read_b32 v64, a84
  v_accvgpr_read_b32 v65, a85
  v_accvgpr_read_b32 v66, a86
  v_accvgpr_read_b32 v67, a87
  v_mul_f32 v64, v64, v197
  v_mul_f32 v65, v65, v197
  v_mul_f32 v66, v66, v197
  v_mul_f32 v67, v67, v197
  v_accvgpr_write_b32 a84, v64
  v_accvgpr_write_b32 a85, v65
  v_accvgpr_write_b32 a86, v66
  v_accvgpr_write_b32 a87, v67
  v_accvgpr_read_b32 v64, a100
  v_accvgpr_read_b32 v65, a101
  v_accvgpr_read_b32 v66, a102
  v_accvgpr_read_b32 v67, a103
  v_mul_f32 v64, v64, v197
  v_mul_f32 v65, v65, v197
  v_mul_f32 v66, v66, v197
  v_mul_f32 v67, v67, v197
  v_accvgpr_write_b32 a100, v64
  v_accvgpr_write_b32 a101, v65
  v_accvgpr_write_b32 a102, v66
  v_accvgpr_write_b32 a103, v67
  v_accvgpr_read_b32 v64, a116
  v_accvgpr_read_b32 v65, a117
  v_accvgpr_read_b32 v66, a118
  v_accvgpr_read_b32 v67, a119
  v_mul_f32 v64, v64, v197
  v_mul_f32 v65, v65, v197
  v_mul_f32 v66, v66, v197
  v_mul_f32 v67, v67, v197
  v_accvgpr_write_b32 a116, v64
  v_accvgpr_write_b32 a117, v65
  v_accvgpr_write_b32 a118, v66
  v_accvgpr_write_b32 a119, v67
  v_mov_b32 v200, v251
  v_max3_f32 v200, v200, v16, v17
  v_max3_f32 v200, v200, v18, v19
  v_max3_f32 v200, v200, v20, v21
  v_max3_f32 v200, v200, v22, v23
  v_max3_f32 v200, v200, v48, v49
  v_max3_f32 v200, v200, v50, v51
  v_max3_f32 v200, v200, v52, v53
  v_max3_f32 v200, v200, v54, v55
  v_mov_b32 v245, v200
  s_nop 1
  v_permlane16_swap_b32 v200, v245
  v_max_f32 v200, v200, v245
  v_mov_b32 v245, v200
  s_nop 1
  v_permlane32_swap_b32 v200, v245
  v_max_f32 v200, v200, v245
  v_sub_f32 v201, v251, v200
  v_exp_f32 v201, v201
  v_mov_b32 v251, v200
  v_mul_f32 v210, v210, v201
  v_sub_f32 v16, v16, v200
  v_sub_f32 v17, v17, v200
  v_sub_f32 v18, v18, v200
  v_sub_f32 v19, v19, v200
  v_sub_f32 v20, v20, v200
  v_sub_f32 v21, v21, v200
  v_sub_f32 v22, v22, v200
  v_sub_f32 v23, v23, v200
  v_sub_f32 v48, v48, v200
  v_sub_f32 v49, v49, v200
  v_sub_f32 v50, v50, v200
  v_sub_f32 v51, v51, v200
  v_sub_f32 v52, v52, v200
  v_sub_f32 v53, v53, v200
  v_sub_f32 v54, v54, v200
  v_sub_f32 v55, v55, v200
  v_exp_f32 v16, v16
  v_exp_f32 v17, v17
  v_add_f32 v210, v210, v16
  v_exp_f32 v18, v18
  v_add_f32 v210, v210, v17
  v_cvt_pk_bf16_f32 v16, v16, v17
  v_exp_f32 v19, v19
  v_add_f32 v210, v210, v18
  v_add_f32 v210, v210, v19
  v_cvt_pk_bf16_f32 v17, v18, v19
  v_exp_f32 v20, v20
  v_exp_f32 v21, v21
  v_add_f32 v210, v210, v20
  v_exp_f32 v22, v22
  v_add_f32 v210, v210, v21
  v_cvt_pk_bf16_f32 v18, v20, v21
  v_exp_f32 v23, v23
  v_add_f32 v210, v210, v22
  v_add_f32 v210, v210, v23
  v_cvt_pk_bf16_f32 v19, v22, v23
  v_exp_f32 v48, v48
  v_exp_f32 v49, v49
  v_add_f32 v210, v210, v48
  v_exp_f32 v50, v50
  v_add_f32 v210, v210, v49
  v_cvt_pk_bf16_f32 v48, v48, v49
  v_exp_f32 v51, v51
  v_add_f32 v210, v210, v50
  v_add_f32 v210, v210, v51
  v_cvt_pk_bf16_f32 v49, v50, v51
  v_exp_f32 v52, v52
  v_exp_f32 v53, v53
  v_add_f32 v210, v210, v52
  v_exp_f32 v54, v54
  v_add_f32 v210, v210, v53
  v_cvt_pk_bf16_f32 v50, v52, v53
  v_exp_f32 v55, v55
  v_add_f32 v210, v210, v54
  v_add_f32 v210, v210, v55
  v_cvt_pk_bf16_f32 v51, v54, v55
  v_accvgpr_read_b32 v64, a8
  v_accvgpr_read_b32 v65, a9
  v_accvgpr_read_b32 v66, a10
  v_accvgpr_read_b32 v67, a11
  v_mul_f32 v64, v64, v201
  v_mul_f32 v65, v65, v201
  v_mul_f32 v66, v66, v201
  v_mul_f32 v67, v67, v201
  v_accvgpr_write_b32 a8, v64
  v_accvgpr_write_b32 a9, v65
  v_accvgpr_write_b32 a10, v66
  v_accvgpr_write_b32 a11, v67
  v_accvgpr_read_b32 v64, a24
  v_accvgpr_read_b32 v65, a25
  v_accvgpr_read_b32 v66, a26
  v_accvgpr_read_b32 v67, a27
  v_mul_f32 v64, v64, v201
  v_mul_f32 v65, v65, v201
  v_mul_f32 v66, v66, v201
  v_mul_f32 v67, v67, v201
  v_accvgpr_write_b32 a24, v64
  v_accvgpr_write_b32 a25, v65
  v_accvgpr_write_b32 a26, v66
  v_accvgpr_write_b32 a27, v67
  v_accvgpr_read_b32 v64, a40
  v_accvgpr_read_b32 v65, a41
  v_accvgpr_read_b32 v66, a42
  v_accvgpr_read_b32 v67, a43
  v_mul_f32 v64, v64, v201
  v_mul_f32 v65, v65, v201
  v_mul_f32 v66, v66, v201
  v_mul_f32 v67, v67, v201
  v_accvgpr_write_b32 a40, v64
  v_accvgpr_write_b32 a41, v65
  v_accvgpr_write_b32 a42, v66
  v_accvgpr_write_b32 a43, v67
  v_accvgpr_read_b32 v64, a56
  v_accvgpr_read_b32 v65, a57
  v_accvgpr_read_b32 v66, a58
  v_accvgpr_read_b32 v67, a59
  v_mul_f32 v64, v64, v201
  v_mul_f32 v65, v65, v201
  v_mul_f32 v66, v66, v201
  v_mul_f32 v67, v67, v201
  v_accvgpr_write_b32 a56, v64
  v_accvgpr_write_b32 a57, v65
  v_accvgpr_write_b32 a58, v66
  v_accvgpr_write_b32 a59, v67
  v_accvgpr_read_b32 v64, a72
  v_accvgpr_read_b32 v65, a73
  v_accvgpr_read_b32 v66, a74
  v_accvgpr_read_b32 v67, a75
  v_mul_f32 v64, v64, v201
  v_mul_f32 v65, v65, v201
  v_mul_f32 v66, v66, v201
  v_mul_f32 v67, v67, v201
  v_accvgpr_write_b32 a72, v64
  v_accvgpr_write_b32 a73, v65
  v_accvgpr_write_b32 a74, v66
  v_accvgpr_write_b32 a75, v67
  v_accvgpr_read_b32 v64, a88
  v_accvgpr_read_b32 v65, a89
  v_accvgpr_read_b32 v66, a90
  v_accvgpr_read_b32 v67, a91
  v_mul_f32 v64, v64, v201
  v_mul_f32 v65, v65, v201
  v_mul_f32 v66, v66, v201
  v_mul_f32 v67, v67, v201
  v_accvgpr_write_b32 a88, v64
  v_accvgpr_write_b32 a89, v65
  v_accvgpr_write_b32 a90, v66
  v_accvgpr_write_b32 a91, v67
  v_accvgpr_read_b32 v64, a104
  v_accvgpr_read_b32 v65, a105
  v_accvgpr_read_b32 v66, a106
  v_accvgpr_read_b32 v67, a107
  v_mul_f32 v64, v64, v201
  v_mul_f32 v65, v65, v201
  v_mul_f32 v66, v66, v201
  v_mul_f32 v67, v67, v201
  v_accvgpr_write_b32 a104, v64
  v_accvgpr_write_b32 a105, v65
  v_accvgpr_write_b32 a106, v66
  v_accvgpr_write_b32 a107, v67
  v_accvgpr_read_b32 v64, a120
  v_accvgpr_read_b32 v65, a121
  v_accvgpr_read_b32 v66, a122
  v_accvgpr_read_b32 v67, a123
  v_mul_f32 v64, v64, v201
  v_mul_f32 v65, v65, v201
  v_mul_f32 v66, v66, v201
  v_mul_f32 v67, v67, v201
  v_accvgpr_write_b32 a120, v64
  v_accvgpr_write_b32 a121, v65
  v_accvgpr_write_b32 a122, v66
  v_accvgpr_write_b32 a123, v67
  v_mov_b32 v204, v252
  v_max3_f32 v204, v204, v24, v25
  v_max3_f32 v204, v204, v26, v27
  v_max3_f32 v204, v204, v28, v29
  v_max3_f32 v204, v204, v30, v31
  v_max3_f32 v204, v204, v56, v57
  v_max3_f32 v204, v204, v58, v59
  v_max3_f32 v204, v204, v60, v61
  v_max3_f32 v204, v204, v62, v63
  v_mov_b32 v245, v204
  s_nop 1
  v_permlane16_swap_b32 v204, v245
  v_max_f32 v204, v204, v245
  v_mov_b32 v245, v204
  s_nop 1
  v_permlane32_swap_b32 v204, v245
  v_max_f32 v204, v204, v245
  v_sub_f32 v205, v252, v204
  v_exp_f32 v205, v205
  v_mov_b32 v252, v204
  v_mul_f32 v211, v211, v205
  v_sub_f32 v24, v24, v204
  v_sub_f32 v25, v25, v204
  v_sub_f32 v26, v26, v204
  v_sub_f32 v27, v27, v204
  v_sub_f32 v28, v28, v204
  v_sub_f32 v29, v29, v204
  v_sub_f32 v30, v30, v204
  v_sub_f32 v31, v31, v204
  v_sub_f32 v56, v56, v204
  v_sub_f32 v57, v57, v204
  v_sub_f32 v58, v58, v204
  v_sub_f32 v59, v59, v204
  v_sub_f32 v60, v60, v204
  v_sub_f32 v61, v61, v204
  v_sub_f32 v62, v62, v204
  v_sub_f32 v63, v63, v204
  v_exp_f32 v24, v24
  v_exp_f32 v25, v25
  v_add_f32 v211, v211, v24
  v_exp_f32 v26, v26
  v_add_f32 v211, v211, v25
  v_cvt_pk_bf16_f32 v24, v24, v25
  v_exp_f32 v27, v27
  v_add_f32 v211, v211, v26
  v_add_f32 v211, v211, v27
  v_cvt_pk_bf16_f32 v25, v26, v27
  v_exp_f32 v28, v28
  v_exp_f32 v29, v29
  v_add_f32 v211, v211, v28
  v_exp_f32 v30, v30
  v_add_f32 v211, v211, v29
  v_cvt_pk_bf16_f32 v26, v28, v29
  v_exp_f32 v31, v31
  v_add_f32 v211, v211, v30
  v_add_f32 v211, v211, v31
  v_cvt_pk_bf16_f32 v27, v30, v31
  v_exp_f32 v56, v56
  v_exp_f32 v57, v57
  v_add_f32 v211, v211, v56
  v_exp_f32 v58, v58
  v_add_f32 v211, v211, v57
  v_cvt_pk_bf16_f32 v56, v56, v57
  v_exp_f32 v59, v59
  v_add_f32 v211, v211, v58
  v_add_f32 v211, v211, v59
  v_cvt_pk_bf16_f32 v57, v58, v59
  v_exp_f32 v60, v60
  v_exp_f32 v61, v61
  v_add_f32 v211, v211, v60
  v_exp_f32 v62, v62
  v_add_f32 v211, v211, v61
  v_cvt_pk_bf16_f32 v58, v60, v61
  v_exp_f32 v63, v63
  v_add_f32 v211, v211, v62
  v_add_f32 v211, v211, v63
  v_cvt_pk_bf16_f32 v59, v62, v63
  v_accvgpr_read_b32 v64, a12
  v_accvgpr_read_b32 v65, a13
  v_accvgpr_read_b32 v66, a14
  v_accvgpr_read_b32 v67, a15
  v_mul_f32 v64, v64, v205
  v_mul_f32 v65, v65, v205
  v_mul_f32 v66, v66, v205
  v_mul_f32 v67, v67, v205
  v_accvgpr_write_b32 a12, v64
  v_accvgpr_write_b32 a13, v65
  v_accvgpr_write_b32 a14, v66
  v_accvgpr_write_b32 a15, v67
  v_accvgpr_read_b32 v64, a28
  v_accvgpr_read_b32 v65, a29
  v_accvgpr_read_b32 v66, a30
  v_accvgpr_read_b32 v67, a31
  v_mul_f32 v64, v64, v205
  v_mul_f32 v65, v65, v205
  v_mul_f32 v66, v66, v205
  v_mul_f32 v67, v67, v205
  v_accvgpr_write_b32 a28, v64
  v_accvgpr_write_b32 a29, v65
  v_accvgpr_write_b32 a30, v66
  v_accvgpr_write_b32 a31, v67
  v_accvgpr_read_b32 v64, a44
  v_accvgpr_read_b32 v65, a45
  v_accvgpr_read_b32 v66, a46
  v_accvgpr_read_b32 v67, a47
  v_mul_f32 v64, v64, v205
  v_mul_f32 v65, v65, v205
  v_mul_f32 v66, v66, v205
  v_mul_f32 v67, v67, v205
  v_accvgpr_write_b32 a44, v64
  v_accvgpr_write_b32 a45, v65
  v_accvgpr_write_b32 a46, v66
  v_accvgpr_write_b32 a47, v67
  v_accvgpr_read_b32 v64, a60
  v_accvgpr_read_b32 v65, a61
  v_accvgpr_read_b32 v66, a62
  v_accvgpr_read_b32 v67, a63
  v_mul_f32 v64, v64, v205
  v_mul_f32 v65, v65, v205
  v_mul_f32 v66, v66, v205
  v_mul_f32 v67, v67, v205
  v_accvgpr_write_b32 a60, v64
  v_accvgpr_write_b32 a61, v65
  v_accvgpr_write_b32 a62, v66
  v_accvgpr_write_b32 a63, v67
  v_accvgpr_read_b32 v64, a76
  v_accvgpr_read_b32 v65, a77
  v_accvgpr_read_b32 v66, a78
  v_accvgpr_read_b32 v67, a79
  v_mul_f32 v64, v64, v205
  v_mul_f32 v65, v65, v205
  v_mul_f32 v66, v66, v205
  v_mul_f32 v67, v67, v205
  v_accvgpr_write_b32 a76, v64
  v_accvgpr_write_b32 a77, v65
  v_accvgpr_write_b32 a78, v66
  v_accvgpr_write_b32 a79, v67
  v_accvgpr_read_b32 v64, a92
  v_accvgpr_read_b32 v65, a93
  v_accvgpr_read_b32 v66, a94
  v_accvgpr_read_b32 v67, a95
  v_mul_f32 v64, v64, v205
  v_mul_f32 v65, v65, v205
  v_mul_f32 v66, v66, v205
  v_mul_f32 v67, v67, v205
  v_accvgpr_write_b32 a92, v64
  v_accvgpr_write_b32 a93, v65
  v_accvgpr_write_b32 a94, v66
  v_accvgpr_write_b32 a95, v67
  v_accvgpr_read_b32 v64, a108
  v_accvgpr_read_b32 v65, a109
  v_accvgpr_read_b32 v66, a110
  v_accvgpr_read_b32 v67, a111
  v_mul_f32 v64, v64, v205
  v_mul_f32 v65, v65, v205
  v_mul_f32 v66, v66, v205
  v_mul_f32 v67, v67, v205
  v_accvgpr_write_b32 a108, v64
  v_accvgpr_write_b32 a109, v65
  v_accvgpr_write_b32 a110, v66
  v_accvgpr_write_b32 a111, v67
  v_accvgpr_read_b32 v64, a124
  v_accvgpr_read_b32 v65, a125
  v_accvgpr_read_b32 v66, a126
  v_accvgpr_read_b32 v67, a127
  v_mul_f32 v64, v64, v205
  v_mul_f32 v65, v65, v205
  v_mul_f32 v66, v66, v205
  v_mul_f32 v67, v67, v205
  v_accvgpr_write_b32 a124, v64
  v_accvgpr_write_b32 a125, v65
  v_accvgpr_write_b32 a126, v66
  v_accvgpr_write_b32 a127, v67
  ds_read_b64_tr_b16 a[160:161], v216 offset:0
  ds_read_b64_tr_b16 a[162:163], v216 offset:4096
  ds_read_b64_tr_b16 a[164:165], v216 offset:8192
  ds_read_b64_tr_b16 a[166:167], v216 offset:12288
  s_waitcnt lgkmcnt(2)
  v_mfma_f32_16x16x32_bf16 a[0:3], a[160:163], v[0:3], a[0:3]
  s_waitcnt lgkmcnt(0)
  v_mfma_f32_16x16x32_bf16 a[0:3], a[164:167], v[32:35], a[0:3]
  v_mfma_f32_16x16x32_bf16 a[4:7], a[164:167], v[40:43], a[4:7]
  v_mfma_f32_16x16x32_bf16 a[4:7], a[160:163], v[8:11], a[4:7]
  v_mfma_f32_16x16x32_bf16 a[8:11], a[160:163], v[16:19], a[8:11]
  v_mfma_f32_16x16x32_bf16 a[8:11], a[164:167], v[48:51], a[8:11]
  v_mfma_f32_16x16x32_bf16 a[12:15], a[164:167], v[56:59], a[12:15]
  v_mfma_f32_16x16x32_bf16 a[12:15], a[160:163], v[24:27], a[12:15]
  ds_read_b64_tr_b16 a[168:169], v217 offset:0
  ds_read_b64_tr_b16 a[170:171], v217 offset:4096
  ds_read_b64_tr_b16 a[172:173], v217 offset:8192
  ds_read_b64_tr_b16 a[174:175], v217 offset:12288
  s_waitcnt lgkmcnt(2)
  v_mfma_f32_16x16x32_bf16 a[16:19], a[168:171], v[0:3], a[16:19]
  s_waitcnt lgkmcnt(0)
  v_mfma_f32_16x16x32_bf16 a[16:19], a[172:175], v[32:35], a[16:19]
  v_mfma_f32_16x16x32_bf16 a[20:23], a[172:175], v[40:43], a[20:23]
  v_mfma_f32_16x16x32_bf16 a[20:23], a[168:171], v[8:11], a[20:23]
  v_mfma_f32_16x16x32_bf16 a[24:27], a[168:171], v[16:19], a[24:27]
  v_mfma_f32_16x16x32_bf16 a[24:27], a[172:175], v[48:51], a[24:27]
  v_mfma_f32_16x16x32_bf16 a[28:31], a[172:175], v[56:59], a[28:31]
  v_mfma_f32_16x16x32_bf16 a[28:31], a[168:171], v[24:27], a[28:31]
  ds_read_b64_tr_b16 a[176:177], v218 offset:0
  ds_read_b64_tr_b16 a[178:179], v218 offset:4096
  ds_read_b64_tr_b16 a[180:181], v218 offset:8192
  ds_read_b64_tr_b16 a[182:183], v218 offset:12288
  s_waitcnt lgkmcnt(2)
  v_mfma_f32_16x16x32_bf16 a[32:35], a[176:179], v[0:3], a[32:35]
  s_waitcnt lgkmcnt(0)
  v_mfma_f32_16x16x32_bf16 a[32:35], a[180:183], v[32:35], a[32:35]
  v_mfma_f32_16x16x32_bf16 a[36:39], a[180:183], v[40:43], a[36:39]
  v_mfma_f32_16x16x32_bf16 a[36:39], a[176:179], v[8:11], a[36:39]
  v_mfma_f32_16x16x32_bf16 a[40:43], a[176:179], v[16:19], a[40:43]
  v_mfma_f32_16x16x32_bf16 a[40:43], a[180:183], v[48:51], a[40:43]
  v_mfma_f32_16x16x32_bf16 a[44:47], a[180:183], v[56:59], a[44:47]
  v_mfma_f32_16x16x32_bf16 a[44:47], a[176:179], v[24:27], a[44:47]
  ds_read_b64_tr_b16 a[184:185], v219 offset:0
  ds_read_b64_tr_b16 a[186:187], v219 offset:4096
  ds_read_b64_tr_b16 a[188:189], v219 offset:8192
  ds_read_b64_tr_b16 a[190:191], v219 offset:12288
  s_waitcnt lgkmcnt(2)
  v_mfma_f32_16x16x32_bf16 a[48:51], a[184:187], v[0:3], a[48:51]
  s_waitcnt lgkmcnt(0)
  v_mfma_f32_16x16x32_bf16 a[48:51], a[188:191], v[32:35], a[48:51]
  v_mfma_f32_16x16x32_bf16 a[52:55], a[188:191], v[40:43], a[52:55]
  v_mfma_f32_16x16x32_bf16 a[52:55], a[184:187], v[8:11], a[52:55]
  v_mfma_f32_16x16x32_bf16 a[56:59], a[184:187], v[16:19], a[56:59]
  v_mfma_f32_16x16x32_bf16 a[56:59], a[188:191], v[48:51], a[56:59]
  v_mfma_f32_16x16x32_bf16 a[60:63], a[188:191], v[56:59], a[60:63]
  v_mfma_f32_16x16x32_bf16 a[60:63], a[184:187], v[24:27], a[60:63]
  ds_read_b64_tr_b16 a[160:161], v220 offset:0
  ds_read_b64_tr_b16 a[162:163], v220 offset:4096
  ds_read_b64_tr_b16 a[164:165], v220 offset:8192
  ds_read_b64_tr_b16 a[166:167], v220 offset:12288
  s_waitcnt lgkmcnt(2)
  v_mfma_f32_16x16x32_bf16 a[64:67], a[160:163], v[0:3], a[64:67]
  s_waitcnt lgkmcnt(0)
  v_mfma_f32_16x16x32_bf16 a[64:67], a[164:167], v[32:35], a[64:67]
  v_mfma_f32_16x16x32_bf16 a[68:71], a[164:167], v[40:43], a[68:71]
  v_mfma_f32_16x16x32_bf16 a[68:71], a[160:163], v[8:11], a[68:71]
  v_mfma_f32_16x16x32_bf16 a[72:75], a[160:163], v[16:19], a[72:75]
  v_mfma_f32_16x16x32_bf16 a[72:75], a[164:167], v[48:51], a[72:75]
  v_mfma_f32_16x16x32_bf16 a[76:79], a[164:167], v[56:59], a[76:79]
  v_mfma_f32_16x16x32_bf16 a[76:79], a[160:163], v[24:27], a[76:79]
  ds_read_b64_tr_b16 a[168:169], v221 offset:0
  ds_read_b64_tr_b16 a[170:171], v221 offset:4096
  ds_read_b64_tr_b16 a[172:173], v221 offset:8192
  ds_read_b64_tr_b16 a[174:175], v221 offset:12288
  s_waitcnt lgkmcnt(2)
  v_mfma_f32_16x16x32_bf16 a[80:83], a[168:171], v[0:3], a[80:83]
  s_waitcnt lgkmcnt(0)
  v_mfma_f32_16x16x32_bf16 a[80:83], a[172:175], v[32:35], a[80:83]
  v_mfma_f32_16x16x32_bf16 a[84:87], a[172:175], v[40:43], a[84:87]
  v_mfma_f32_16x16x32_bf16 a[84:87], a[168:171], v[8:11], a[84:87]
  v_mfma_f32_16x16x32_bf16 a[88:91], a[168:171], v[16:19], a[88:91]
  v_mfma_f32_16x16x32_bf16 a[88:91], a[172:175], v[48:51], a[88:91]
  v_mfma_f32_16x16x32_bf16 a[92:95], a[172:175], v[56:59], a[92:95]
  v_mfma_f32_16x16x32_bf16 a[92:95], a[168:171], v[24:27], a[92:95]
  ds_read_b64_tr_b16 a[176:177], v222 offset:0
  ds_read_b64_tr_b16 a[178:179], v222 offset:4096
  ds_read_b64_tr_b16 a[180:181], v222 offset:8192
  ds_read_b64_tr_b16 a[182:183], v222 offset:12288
  s_waitcnt lgkmcnt(2)
  v_mfma_f32_16x16x32_bf16 a[96:99], a[176:179], v[0:3], a[96:99]
  s_waitcnt lgkmcnt(0)
  v_mfma_f32_16x16x32_bf16 a[96:99], a[180:183], v[32:35], a[96:99]
  v_mfma_f32_16x16x32_bf16 a[100:103], a[180:183], v[40:43], a[100:103]
  v_mfma_f32_16x16x32_bf16 a[100:103], a[176:179], v[8:11], a[100:103]
  v_mfma_f32_16x16x32_bf16 a[104:107], a[176:179], v[16:19], a[104:107]
  v_mfma_f32_16x16x32_bf16 a[104:107], a[180:183], v[48:51], a[104:107]
  v_mfma_f32_16x16x32_bf16 a[108:111], a[180:183], v[56:59], a[108:111]
  v_mfma_f32_16x16x32_bf16 a[108:111], a[176:179], v[24:27], a[108:111]
  ds_read_b64_tr_b16 a[184:185], v223 offset:0
  ds_read_b64_tr_b16 a[186:187], v223 offset:4096
  ds_read_b64_tr_b16 a[188:189], v223 offset:8192
  ds_read_b64_tr_b16 a[190:191], v223 offset:12288
  s_waitcnt lgkmcnt(2)
  v_mfma_f32_16x16x32_bf16 a[112:115], a[184:187], v[0:3], a[112:115]
  s_waitcnt lgkmcnt(0)
  v_mfma_f32_16x16x32_bf16 a[112:115], a[188:191], v[32:35], a[112:115]
  v_mfma_f32_16x16x32_bf16 a[116:119], a[188:191], v[40:43], a[116:119]
  v_mfma_f32_16x16x32_bf16 a[116:119], a[184:187], v[8:11], a[116:119]
  v_mfma_f32_16x16x32_bf16 a[120:123], a[184:187], v[16:19], a[120:123]
  v_mfma_f32_16x16x32_bf16 a[120:123], a[188:191], v[48:51], a[120:123]
  v_mfma_f32_16x16x32_bf16 a[124:127], a[188:191], v[56:59], a[124:127]
  v_mfma_f32_16x16x32_bf16 a[124:127], a[184:187], v[24:27], a[124:127]
  s_add_u32 s29, s29, 16384
  s_cmp_lt_u32 s29, 524288
  s_cbranch_scc1 attn_slow
  v_mov_b32 v245, v208
  v_mov_b32 v246, v209
  v_mov_b32 v247, v210
  v_mov_b32 v248, v211
  v_permlane16_swap_b32 v208, v245
  v_permlane16_swap_b32 v209, v246
  v_permlane16_swap_b32 v210, v247
  v_permlane16_swap_b32 v211, v248
  v_add_f32 v208, v208, v245
  v_add_f32 v209, v209, v246
  v_add_f32 v210, v210, v247
  v_add_f32 v211, v211, v248
  v_mov_b32 v245, v208
  v_mov_b32 v246, v209
  v_mov_b32 v247, v210
  v_mov_b32 v248, v211
  v_permlane32_swap_b32 v208, v245
  v_permlane32_swap_b32 v209, v246
  v_permlane32_swap_b32 v210, v247
  v_permlane32_swap_b32 v211, v248
  v_add_f32 v208, v208, v245
  v_add_f32 v209, v209, v246
  v_add_f32 v210, v210, v247
  v_add_f32 v211, v211, v248
  v_rcp_f32 v192, v208
  v_rcp_f32 v196, v209
  v_rcp_f32 v200, v210
  v_rcp_f32 v204, v211
  v_accvgpr_read_b32 v0, a0
  v_accvgpr_read_b32 v1, a1
  v_accvgpr_read_b32 v2, a2
  v_accvgpr_read_b32 v3, a3
  v_accvgpr_read_b32 v4, a16
  v_accvgpr_read_b32 v5, a17
  v_accvgpr_read_b32 v6, a18
  v_accvgpr_read_b32 v7, a19
  v_mul_f32 v0, v0, v192
  v_mul_f32 v1, v1, v192
  v_mul_f32 v2, v2, v192
  v_mul_f32 v3, v3, v192
  v_mul_f32 v4, v4, v192
  v_mul_f32 v5, v5, v192
  v_mul_f32 v6, v6, v192
  v_mul_f32 v7, v7, v192
  v_cvt_pk_bf16_f32 v0, v0, v1
  v_cvt_pk_bf16_f32 v1, v2, v3
  v_cvt_pk_bf16_f32 v2, v4, v5
  v_cvt_pk_bf16_f32 v3, v6, v7
  buffer_store_dwordx4 v[0:3], v244, s[24:27], s40 offen offset:0 sc1
  v_accvgpr_read_b32 v8, a4
  v_accvgpr_read_b32 v9, a5
  v_accvgpr_read_b32 v10, a6
  v_accvgpr_read_b32 v11, a7
  v_accvgpr_read_b32 v12, a20
  v_accvgpr_read_b32 v13, a21
  v_accvgpr_read_b32 v14, a22
  v_accvgpr_read_b32 v15, a23
  v_mul_f32 v8, v8, v196
  v_mul_f32 v9, v9, v196
  v_mul_f32 v10, v10, v196
  v_mul_f32 v11, v11, v196
  v_mul_f32 v12, v12, v196
  v_mul_f32 v13, v13, v196
  v_mul_f32 v14, v14, v196
  v_mul_f32 v15, v15, v196
  v_cvt_pk_bf16_f32 v8, v8, v9
  v_cvt_pk_bf16_f32 v9, v10, v11
  v_cvt_pk_bf16_f32 v10, v12, v13
  v_cvt_pk_bf16_f32 v11, v14, v15
  buffer_store_dwordx4 v[8:11], v244, s[24:27], s40 offen offset:2048 sc1
  v_accvgpr_read_b32 v16, a8
  v_accvgpr_read_b32 v17, a9
  v_accvgpr_read_b32 v18, a10
  v_accvgpr_read_b32 v19, a11
  v_accvgpr_read_b32 v20, a24
  v_accvgpr_read_b32 v21, a25
  v_accvgpr_read_b32 v22, a26
  v_accvgpr_read_b32 v23, a27
  v_mul_f32 v16, v16, v200
  v_mul_f32 v17, v17, v200
  v_mul_f32 v18, v18, v200
  v_mul_f32 v19, v19, v200
  v_mul_f32 v20, v20, v200
  v_mul_f32 v21, v21, v200
  v_mul_f32 v22, v22, v200
  v_mul_f32 v23, v23, v200
  v_cvt_pk_bf16_f32 v16, v16, v17
  v_cvt_pk_bf16_f32 v17, v18, v19
  v_cvt_pk_bf16_f32 v18, v20, v21
  v_cvt_pk_bf16_f32 v19, v22, v23
  buffer_store_dwordx4 v[16:19], v244, s[24:27], s41 offen offset:0 sc1
  v_accvgpr_read_b32 v24, a12
  v_accvgpr_read_b32 v25, a13
  v_accvgpr_read_b32 v26, a14
  v_accvgpr_read_b32 v27, a15
  v_accvgpr_read_b32 v28, a28
  v_accvgpr_read_b32 v29, a29
  v_accvgpr_read_b32 v30, a30
  v_accvgpr_read_b32 v31, a31
  v_mul_f32 v24, v24, v204
  v_mul_f32 v25, v25, v204
  v_mul_f32 v26, v26, v204
  v_mul_f32 v27, v27, v204
  v_mul_f32 v28, v28, v204
  v_mul_f32 v29, v29, v204
  v_mul_f32 v30, v30, v204
  v_mul_f32 v31, v31, v204
  v_cvt_pk_bf16_f32 v24, v24, v25
  v_cvt_pk_bf16_f32 v25, v26, v27
  v_cvt_pk_bf16_f32 v26, v28, v29
  v_cvt_pk_bf16_f32 v27, v30, v31
  buffer_store_dwordx4 v[24:27], v244, s[24:27], s41 offen offset:2048 sc1
  v_accvgpr_read_b32 v32, a32
  v_accvgpr_read_b32 v33, a33
  v_accvgpr_read_b32 v34, a34
  v_accvgpr_read_b32 v35, a35
  v_accvgpr_read_b32 v36, a48
  v_accvgpr_read_b32 v37, a49
  v_accvgpr_read_b32 v38, a50
  v_accvgpr_read_b32 v39, a51
  v_mul_f32 v32, v32, v192
  v_mul_f32 v33, v33, v192
  v_mul_f32 v34, v34, v192
  v_mul_f32 v35, v35, v192
  v_mul_f32 v36, v36, v192
  v_mul_f32 v37, v37, v192
  v_mul_f32 v38, v38, v192
  v_mul_f32 v39, v39, v192
  v_cvt_pk_bf16_f32 v32, v32, v33
  v_cvt_pk_bf16_f32 v33, v34, v35
  v_cvt_pk_bf16_f32 v34, v36, v37
  v_cvt_pk_bf16_f32 v35, v38, v39
  buffer_store_dwordx4 v[32:35], v244, s[24:27], s40 offen offset:1024 sc1
  v_accvgpr_read_b32 v40, a36
  v_accvgpr_read_b32 v41, a37
  v_accvgpr_read_b32 v42, a38
  v_accvgpr_read_b32 v43, a39
  v_accvgpr_read_b32 v44, a52
  v_accvgpr_read_b32 v45, a53
  v_accvgpr_read_b32 v46, a54
  v_accvgpr_read_b32 v47, a55
  v_mul_f32 v40, v40, v196
  v_mul_f32 v41, v41, v196
  v_mul_f32 v42, v42, v196
  v_mul_f32 v43, v43, v196
  v_mul_f32 v44, v44, v196
  v_mul_f32 v45, v45, v196
  v_mul_f32 v46, v46, v196
  v_mul_f32 v47, v47, v196
  v_cvt_pk_bf16_f32 v40, v40, v41
  v_cvt_pk_bf16_f32 v41, v42, v43
  v_cvt_pk_bf16_f32 v42, v44, v45
  v_cvt_pk_bf16_f32 v43, v46, v47
  buffer_store_dwordx4 v[40:43], v244, s[24:27], s40 offen offset:3072 sc1
  v_accvgpr_read_b32 v48, a40
  v_accvgpr_read_b32 v49, a41
  v_accvgpr_read_b32 v50, a42
  v_accvgpr_read_b32 v51, a43
  v_accvgpr_read_b32 v52, a56
  v_accvgpr_read_b32 v53, a57
  v_accvgpr_read_b32 v54, a58
  v_accvgpr_read_b32 v55, a59
  v_mul_f32 v48, v48, v200
  v_mul_f32 v49, v49, v200
  v_mul_f32 v50, v50, v200
  v_mul_f32 v51, v51, v200
  v_mul_f32 v52, v52, v200
  v_mul_f32 v53, v53, v200
  v_mul_f32 v54, v54, v200
  v_mul_f32 v55, v55, v200
  v_cvt_pk_bf16_f32 v48, v48, v49
  v_cvt_pk_bf16_f32 v49, v50, v51
  v_cvt_pk_bf16_f32 v50, v52, v53
  v_cvt_pk_bf16_f32 v51, v54, v55
  buffer_store_dwordx4 v[48:51], v244, s[24:27], s41 offen offset:1024 sc1
  v_accvgpr_read_b32 v56, a44
  v_accvgpr_read_b32 v57, a45
  v_accvgpr_read_b32 v58, a46
  v_accvgpr_read_b32 v59, a47
  v_accvgpr_read_b32 v60, a60
  v_accvgpr_read_b32 v61, a61
  v_accvgpr_read_b32 v62, a62
  v_accvgpr_read_b32 v63, a63
  v_mul_f32 v56, v56, v204
  v_mul_f32 v57, v57, v204
  v_mul_f32 v58, v58, v204
  v_mul_f32 v59, v59, v204
  v_mul_f32 v60, v60, v204
  v_mul_f32 v61, v61, v204
  v_mul_f32 v62, v62, v204
  v_mul_f32 v63, v63, v204
  v_cvt_pk_bf16_f32 v56, v56, v57
  v_cvt_pk_bf16_f32 v57, v58, v59
  v_cvt_pk_bf16_f32 v58, v60, v61
  v_cvt_pk_bf16_f32 v59, v62, v63
  buffer_store_dwordx4 v[56:59], v244, s[24:27], s41 offen offset:3072 sc1
  v_accvgpr_read_b32 v0, a64
  v_accvgpr_read_b32 v1, a65
  v_accvgpr_read_b32 v2, a66
  v_accvgpr_read_b32 v3, a67
  v_accvgpr_read_b32 v4, a80
  v_accvgpr_read_b32 v5, a81
  v_accvgpr_read_b32 v6, a82
  v_accvgpr_read_b32 v7, a83
  v_mul_f32 v0, v0, v192
  v_mul_f32 v1, v1, v192
  v_mul_f32 v2, v2, v192
  v_mul_f32 v3, v3, v192
  v_mul_f32 v4, v4, v192
  v_mul_f32 v5, v5, v192
  v_mul_f32 v6, v6, v192
  v_mul_f32 v7, v7, v192
  v_cvt_pk_bf16_f32 v0, v0, v1
  v_cvt_pk_bf16_f32 v1, v2, v3
  v_cvt_pk_bf16_f32 v2, v4, v5
  v_cvt_pk_bf16_f32 v3, v6, v7
  buffer_store_dwordx4 v[0:3], v244, s[24:27], s42 offen offset:0 sc1
  v_accvgpr_read_b32 v8, a68
  v_accvgpr_read_b32 v9, a69
  v_accvgpr_read_b32 v10, a70
  v_accvgpr_read_b32 v11, a71
  v_accvgpr_read_b32 v12, a84
  v_accvgpr_read_b32 v13, a85
  v_accvgpr_read_b32 v14, a86
  v_accvgpr_read_b32 v15, a87
  v_mul_f32 v8, v8, v196
  v_mul_f32 v9, v9, v196
  v_mul_f32 v10, v10, v196
  v_mul_f32 v11, v11, v196
  v_mul_f32 v12, v12, v196
  v_mul_f32 v13, v13, v196
  v_mul_f32 v14, v14, v196
  v_mul_f32 v15, v15, v196
  v_cvt_pk_bf16_f32 v8, v8, v9
  v_cvt_pk_bf16_f32 v9, v10, v11
  v_cvt_pk_bf16_f32 v10, v12, v13
  v_cvt_pk_bf16_f32 v11, v14, v15
  buffer_store_dwordx4 v[8:11], v244, s[24:27], s42 offen offset:2048 sc1
  v_accvgpr_read_b32 v16, a72
  v_accvgpr_read_b32 v17, a73
  v_accvgpr_read_b32 v18, a74
  v_accvgpr_read_b32 v19, a75
  v_accvgpr_read_b32 v20, a88
  v_accvgpr_read_b32 v21, a89
  v_accvgpr_read_b32 v22, a90
  v_accvgpr_read_b32 v23, a91
  v_mul_f32 v16, v16, v200
  v_mul_f32 v17, v17, v200
  v_mul_f32 v18, v18, v200
  v_mul_f32 v19, v19, v200
  v_mul_f32 v20, v20, v200
  v_mul_f32 v21, v21, v200
  v_mul_f32 v22, v22, v200
  v_mul_f32 v23, v23, v200
  v_cvt_pk_bf16_f32 v16, v16, v17
  v_cvt_pk_bf16_f32 v17, v18, v19
  v_cvt_pk_bf16_f32 v18, v20, v21
  v_cvt_pk_bf16_f32 v19, v22, v23
  buffer_store_dwordx4 v[16:19], v244, s[24:27], s43 offen offset:0 sc1
  v_accvgpr_read_b32 v24, a76
  v_accvgpr_read_b32 v25, a77
  v_accvgpr_read_b32 v26, a78
  v_accvgpr_read_b32 v27, a79
  v_accvgpr_read_b32 v28, a92
  v_accvgpr_read_b32 v29, a93
  v_accvgpr_read_b32 v30, a94
  v_accvgpr_read_b32 v31, a95
  v_mul_f32 v24, v24, v204
  v_mul_f32 v25, v25, v204
  v_mul_f32 v26, v26, v204
  v_mul_f32 v27, v27, v204
  v_mul_f32 v28, v28, v204
  v_mul_f32 v29, v29, v204
  v_mul_f32 v30, v30, v204
  v_mul_f32 v31, v31, v204
  v_cvt_pk_bf16_f32 v24, v24, v25
  v_cvt_pk_bf16_f32 v25, v26, v27
  v_cvt_pk_bf16_f32 v26, v28, v29
  v_cvt_pk_bf16_f32 v27, v30, v31
  buffer_store_dwordx4 v[24:27], v244, s[24:27], s43 offen offset:2048 sc1
  v_accvgpr_read_b32 v32, a96
  v_accvgpr_read_b32 v33, a97
  v_accvgpr_read_b32 v34, a98
  v_accvgpr_read_b32 v35, a99
  v_accvgpr_read_b32 v36, a112
  v_accvgpr_read_b32 v37, a113
  v_accvgpr_read_b32 v38, a114
  v_accvgpr_read_b32 v39, a115
  v_mul_f32 v32, v32, v192
  v_mul_f32 v33, v33, v192
  v_mul_f32 v34, v34, v192
  v_mul_f32 v35, v35, v192
  v_mul_f32 v36, v36, v192
  v_mul_f32 v37, v37, v192
  v_mul_f32 v38, v38, v192
  v_mul_f32 v39, v39, v192
  v_cvt_pk_bf16_f32 v32, v32, v33
  v_cvt_pk_bf16_f32 v33, v34, v35
  v_cvt_pk_bf16_f32 v34, v36, v37
  v_cvt_pk_bf16_f32 v35, v38, v39
  buffer_store_dwordx4 v[32:35], v244, s[24:27], s42 offen offset:1024 sc1
  v_accvgpr_read_b32 v40, a100
  v_accvgpr_read_b32 v41, a101
  v_accvgpr_read_b32 v42, a102
  v_accvgpr_read_b32 v43, a103
  v_accvgpr_read_b32 v44, a116
  v_accvgpr_read_b32 v45, a117
  v_accvgpr_read_b32 v46, a118
  v_accvgpr_read_b32 v47, a119
  v_mul_f32 v40, v40, v196
  v_mul_f32 v41, v41, v196
  v_mul_f32 v42, v42, v196
  v_mul_f32 v43, v43, v196
  v_mul_f32 v44, v44, v196
  v_mul_f32 v45, v45, v196
  v_mul_f32 v46, v46, v196
  v_mul_f32 v47, v47, v196
  v_cvt_pk_bf16_f32 v40, v40, v41
  v_cvt_pk_bf16_f32 v41, v42, v43
  v_cvt_pk_bf16_f32 v42, v44, v45
  v_cvt_pk_bf16_f32 v43, v46, v47
  buffer_store_dwordx4 v[40:43], v244, s[24:27], s42 offen offset:3072 sc1
  v_accvgpr_read_b32 v48, a104
  v_accvgpr_read_b32 v49, a105
  v_accvgpr_read_b32 v50, a106
  v_accvgpr_read_b32 v51, a107
  v_accvgpr_read_b32 v52, a120
  v_accvgpr_read_b32 v53, a121
  v_accvgpr_read_b32 v54, a122
  v_accvgpr_read_b32 v55, a123
  v_mul_f32 v48, v48, v200
  v_mul_f32 v49, v49, v200
  v_mul_f32 v50, v50, v200
  v_mul_f32 v51, v51, v200
  v_mul_f32 v52, v52, v200
  v_mul_f32 v53, v53, v200
  v_mul_f32 v54, v54, v200
  v_mul_f32 v55, v55, v200
  v_cvt_pk_bf16_f32 v48, v48, v49
  v_cvt_pk_bf16_f32 v49, v50, v51
  v_cvt_pk_bf16_f32 v50, v52, v53
  v_cvt_pk_bf16_f32 v51, v54, v55
  buffer_store_dwordx4 v[48:51], v244, s[24:27], s43 offen offset:1024 sc1
  v_accvgpr_read_b32 v56, a108
  v_accvgpr_read_b32 v57, a109
  v_accvgpr_read_b32 v58, a110
  v_accvgpr_read_b32 v59, a111
  v_accvgpr_read_b32 v60, a124
  v_accvgpr_read_b32 v61, a125
  v_accvgpr_read_b32 v62, a126
  v_accvgpr_read_b32 v63, a127
  v_mul_f32 v56, v56, v204
  v_mul_f32 v57, v57, v204
  v_mul_f32 v58, v58, v204
  v_mul_f32 v59, v59, v204
  v_mul_f32 v60, v60, v204
  v_mul_f32 v61, v61, v204
  v_mul_f32 v62, v62, v204
  v_mul_f32 v63, v63, v204
  v_cvt_pk_bf16_f32 v56, v56, v57
  v_cvt_pk_bf16_f32 v57, v58, v59
  v_cvt_pk_bf16_f32 v58, v60, v61
  v_cvt_pk_bf16_f32 v59, v62, v63
  buffer_store_dwordx4 v[56:59], v244, s[24:27], s43 offen offset:3072 sc1
  s_branch tail_go
.section .rodata,"a"
.p2align 6
.amdhsa_kernel recurrent_scan__mha_block_cached__moe_arch_mod__prompt_kernel
  .amdhsa_next_free_vgpr 512
  .amdhsa_next_free_sgpr 102
  .amdhsa_accum_offset 256
  .amdhsa_group_segment_fixed_size 0
  .amdhsa_kernarg_size 104
  .amdhsa_user_sgpr_count 2
  .amdhsa_user_sgpr_kernarg_segment_ptr 1
  .amdhsa_system_sgpr_workgroup_id_x 1
.end_amdhsa_kernel
```

```asm
; @launch grid=(256,1,1) block=(256,1,1) lds=163840
.amdgcn_target "amdgcn-amd-amdhsa--gfx950"
.text
.globl recurrent_scan__mha_block_cached__moe_arch_mod__prompt_kernel
.p2align 8
.type recurrent_scan__mha_block_cached__moe_arch_mod__prompt_kernel,@function
recurrent_scan__mha_block_cached__moe_arch_mod__prompt_kernel:
  s_cmp_ge_u32 s2, 256
  s_cbranch_scc1 attn_end
  s_load_dwordx2 s[60:61], s[0:1], 0
  s_load_dwordx2 s[48:49], s[0:1], 48
  s_load_dwordx4 s[4:7], s[0:1], 8
  s_load_dwordx2 s[8:9], s[0:1], 24
  s_load_dwordx2 s[10:11], s[0:1], 96
  s_load_dwordx2 s[88:89], s[0:1], 32
  s_load_dwordx2 s[90:91], s[0:1], 56
  s_load_dwordx4 s[92:95], s[0:1], 64
  s_load_dwordx2 s[96:97], s[0:1], 88
  s_load_dwordx2 s[62:63], s[0:1], 80
  s_getpc_b64 s[98:99]
attn_hot_pc:
  s_add_u32 s98, s98, attn_hot-attn_hot_pc
  s_addc_u32 s99, s99, 0
  v_lshlrev_b32 v249, 7, v0
  v_min_u32 v249, attn_end-attn_hot-4, v249
  global_load_dword v255, v249, s[98:99]
  v_add_u32 v249, 0x8000, v249
  v_min_u32 v249, attn_end-attn_hot-4, v249
  global_load_dword v255, v249, s[98:99]
attn_hot:
  v_lshrrev_b32 v249, 6, v0
  v_and_b32 v0, 63, v0
  v_mov_b32 v245, v0
  v_readfirstlane_b32 s3, v249
  s_and_b32 s36, s2, 7
  s_lshl_b32 s36, s36, 2
  s_lshr_b32 s37, s2, 6
  s_add_u32 s36, s36, s37
  s_bfe_u32 s37, s2, 0x30003
  s_lshl_b32 s37, s37, 2
  s_add_u32 s37, s37, s3
  s_lshl_b32 s28, s3, 12
  v_lshrrev_b32 v248, 4, v245
  v_and_b32 v247, 15, v245
  s_lshl_b32 s38, s3, 17
  v_lshlrev_b32 v249, 13, v248
  v_add_u32 v249, s38, v249
  v_or_b32 v250, 0, v248
  v_lshlrev_b32 v250, 1, v250
  v_xor_b32 v250, v250, v247
  v_lshl_add_u32 v238, v250, 4, v249
  v_or_b32 v250, 0, v248
  v_lshlrev_b32 v250, 1, v250
  v_xor_b32 v250, v250, v247
  v_lshl_add_u32 v239, v250, 4, v249
  v_add_u32 v239, 31744, v239
  v_or_b32 v250, 4, v248
  v_lshlrev_b32 v250, 1, v250
  v_xor_b32 v250, v250, v247
  v_lshl_add_u32 v240, v250, 4, v249
  v_add_u32 v240, 63488, v240
  v_or_b32 v250, 4, v248
  v_lshlrev_b32 v250, 1, v250
  v_xor_b32 v250, v250, v247
  v_lshl_add_u32 v241, v250, 4, v249
  v_add_u32 v241, 95232, v241
  s_waitcnt lgkmcnt(0)
  s_add_u32 s58, s10, 2830336
  s_addc_u32 s59, s11, 0
  s_load_dword s59, s[58:59], 0
  s_mov_b32 s24, s10
  s_mov_b32 s25, s11
  s_mov_b32 s26, 33554432
  s_mov_b32 s27, 0x20000
  s_lshl_b32 s38, s36, 8
  s_add_u32 s20, s8, s38
  s_addc_u32 s21, s9, 0
  s_mov_b32 s22, 5242880
  s_mov_b32 s23, 0x20000
  s_sub_u32 s22, s22, s38
  s_cmp_ge_u32 s3, 2
  s_cbranch_scc1 front_fetch
  s_mov_b32 s12, s60
  s_mov_b32 s13, s61
  s_mov_b32 s14, 2621440
  s_mov_b32 s15, 0x20000
  s_mov_b32 s16, s48
  s_mov_b32 s17, s49
  s_mov_b32 s18, 1280
  s_mov_b32 s19, 0x20000
  s_lshr_b32 s52, s37, 2
  s_lshl_b32 s52, s52, 5
  s_add_u32 s52, s52, s36
  s_lshl_b32 s52, s52, 1
  s_add_u32 s52, s52, s3
  s_lshl_b32 s52, s52, 2
  s_mul_i32 s53, s52, 1280
  v_lshrrev_b32 v1, 4, v0
  v_and_b32 v2, 15, v0
  v_lshlrev_b32 v3, 4, v2
  v_mul_u32_u24 v4, 0x500, v1
  v_add_u32 v4, v4, v3
  buffer_load_dwordx4 v[8:11], v4, s[12:15], s53 offen offset:0
  buffer_load_dwordx4 v[12:15], v4, s[12:15], s53 offen offset:256
  buffer_load_dwordx4 v[16:19], v4, s[12:15], s53 offen offset:512
  buffer_load_dwordx4 v[20:23], v4, s[12:15], s53 offen offset:768
  buffer_load_dwordx4 v[24:27], v4, s[12:15], s53 offen offset:1024
  buffer_load_dwordx4 v[28:31], v3, s[16:19], 0 offen offset:0
  buffer_load_dwordx4 v[32:35], v3, s[16:19], 0 offen offset:256
  buffer_load_dwordx4 v[36:39], v3, s[16:19], 0 offen offset:512
  buffer_load_dwordx4 v[40:43], v3, s[16:19], 0 offen offset:768
  buffer_load_dwordx4 v[44:47], v3, s[16:19], 0 offen offset:1024
  v_mov_b32 v7, 0
  v_lshlrev_b32 v6, 26, v0
  s_lshl_b32 s53, s2, 7
  s_add_u32 s53, s53, 2834432
  buffer_store_dword v7, v6, s[24:27], s53 offen sc1
  v_lshlrev_b32 v6, 8, v0
  v_lshrrev_b32 v5, 5, v0
  v_lshl_add_u32 v6, v5, 26, v6
  s_cmp_eq_u32 s2, 0
  s_cselect_b32 s53, 0, 1073741824
  v_or_b32 v6, s53, v6
  s_mov_b32 s53, 2818048
  buffer_store_dword v7, v6, s[24:27], s53 offen sc1
  s_lshr_b32 s53, s52, 6
  s_mul_i32 s53, s53, 81920
  s_bfe_u32 s54, s52, 0x20004
  s_lshl_b32 s54, s54, 10
  s_add_u32 s53, s53, s54
  s_and_b32 s54, s52, 15
  s_lshl_b32 s54, s54, 4
  s_add_u32 s53, s53, s54
  v_lshrrev_b32 v5, 2, v2
  v_lshlrev_b32 v5, 12, v5
  v_and_b32 v6, 3, v2
  v_lshl_add_u32 v5, v6, 8, v5
  v_lshl_add_u32 v5, v1, 4, v5
  s_mov_b32 s56, 0xffff0000
  s_waitcnt vmcnt(11)
  v_lshlrev_b32 v48, 16, v8
  v_and_b32 v49, s56, v8
  v_lshlrev_b32 v50, 16, v9
  v_and_b32 v51, s56, v9
  v_lshlrev_b32 v52, 16, v10
  v_and_b32 v53, s56, v10
  v_lshlrev_b32 v54, 16, v11
  v_and_b32 v55, s56, v11
  s_waitcnt vmcnt(10)
  v_lshlrev_b32 v56, 16, v12
  v_and_b32 v57, s56, v12
  v_lshlrev_b32 v58, 16, v13
  v_and_b32 v59, s56, v13
  v_lshlrev_b32 v60, 16, v14
  v_and_b32 v61, s56, v14
  v_lshlrev_b32 v62, 16, v15
  v_and_b32 v63, s56, v15
  s_waitcnt vmcnt(9)
  v_lshlrev_b32 v64, 16, v16
  v_and_b32 v65, s56, v16
  v_lshlrev_b32 v66, 16, v17
  v_and_b32 v67, s56, v17
  v_lshlrev_b32 v68, 16, v18
  v_and_b32 v69, s56, v18
  v_lshlrev_b32 v70, 16, v19
  v_and_b32 v71, s56, v19
  s_waitcnt vmcnt(8)
  v_lshlrev_b32 v72, 16, v20
  v_and_b32 v73, s56, v20
  v_lshlrev_b32 v74, 16, v21
  v_and_b32 v75, s56, v21
  v_lshlrev_b32 v76, 16, v22
  v_and_b32 v77, s56, v22
  v_lshlrev_b32 v78, 16, v23
  v_and_b32 v79, s56, v23
  s_waitcnt vmcnt(7)
  v_lshlrev_b32 v80, 16, v24
  v_and_b32 v81, s56, v24
  v_lshlrev_b32 v82, 16, v25
  v_and_b32 v83, s56, v25
  v_lshlrev_b32 v84, 16, v26
  v_and_b32 v85, s56, v26
  v_lshlrev_b32 v86, 16, v27
  v_and_b32 v87, s56, v27
  v_pk_add_f32 v[88:89], v[48:49], v[50:51]
  v_pk_add_f32 v[90:91], v[52:53], v[54:55]
  v_pk_add_f32 v[88:89], v[88:89], v[56:57]
  v_pk_add_f32 v[90:91], v[90:91], v[58:59]
  v_pk_add_f32 v[88:89], v[88:89], v[60:61]
  v_pk_add_f32 v[90:91], v[90:91], v[62:63]
  v_pk_add_f32 v[88:89], v[88:89], v[64:65]
  v_pk_add_f32 v[90:91], v[90:91], v[66:67]
  v_pk_add_f32 v[88:89], v[88:89], v[68:69]
  v_pk_add_f32 v[90:91], v[90:91], v[70:71]
  v_pk_add_f32 v[88:89], v[88:89], v[72:73]
  v_pk_add_f32 v[90:91], v[90:91], v[74:75]
  v_pk_add_f32 v[88:89], v[88:89], v[76:77]
  v_pk_add_f32 v[90:91], v[90:91], v[78:79]
  v_pk_add_f32 v[88:89], v[88:89], v[80:81]
  v_pk_add_f32 v[90:91], v[90:91], v[82:83]
  v_pk_add_f32 v[88:89], v[88:89], v[84:85]
  v_pk_add_f32 v[90:91], v[90:91], v[86:87]
  v_pk_add_f32 v[88:89], v[88:89], v[90:91]
  v_add_f32 v92, v88, v89
  s_nop 1
  v_add_f32_dpp v92, v92, v92 row_ror:8 row_mask:0xf bank_mask:0xf
  s_nop 1
  v_add_f32_dpp v92, v92, v92 row_ror:4 row_mask:0xf bank_mask:0xf
  s_nop 1
  v_add_f32_dpp v92, v92, v92 row_ror:2 row_mask:0xf bank_mask:0xf
  s_nop 1
  v_add_f32_dpp v92, v92, v92 row_ror:1 row_mask:0xf bank_mask:0xf
  v_mul_f32 v92, 0x3acccccd, v92
  v_pk_add_f32 v[94:95], v[48:49], v[92:93] op_sel_hi:[1,0] neg_lo:[0,1] neg_hi:[0,1]
  v_pk_mul_f32 v[88:89], v[94:95], v[94:95]
  v_pk_add_f32 v[96:97], v[50:51], v[92:93] op_sel_hi:[1,0] neg_lo:[0,1] neg_hi:[0,1]
  v_pk_mul_f32 v[90:91], v[96:97], v[96:97]
  v_pk_add_f32 v[94:95], v[52:53], v[92:93] op_sel_hi:[1,0] neg_lo:[0,1] neg_hi:[0,1]
  v_pk_fma_f32 v[88:89], v[94:95], v[94:95], v[88:89]
  v_pk_add_f32 v[96:97], v[54:55], v[92:93] op_sel_hi:[1,0] neg_lo:[0,1] neg_hi:[0,1]
  v_pk_fma_f32 v[90:91], v[96:97], v[96:97], v[90:91]
  v_pk_add_f32 v[94:95], v[56:57], v[92:93] op_sel_hi:[1,0] neg_lo:[0,1] neg_hi:[0,1]
  v_pk_fma_f32 v[88:89], v[94:95], v[94:95], v[88:89]
  v_pk_add_f32 v[96:97], v[58:59], v[92:93] op_sel_hi:[1,0] neg_lo:[0,1] neg_hi:[0,1]
  v_pk_fma_f32 v[90:91], v[96:97], v[96:97], v[90:91]
  v_pk_add_f32 v[94:95], v[60:61], v[92:93] op_sel_hi:[1,0] neg_lo:[0,1] neg_hi:[0,1]
  v_pk_fma_f32 v[88:89], v[94:95], v[94:95], v[88:89]
  v_pk_add_f32 v[96:97], v[62:63], v[92:93] op_sel_hi:[1,0] neg_lo:[0,1] neg_hi:[0,1]
  v_pk_fma_f32 v[90:91], v[96:97], v[96:97], v[90:91]
  v_pk_add_f32 v[94:95], v[64:65], v[92:93] op_sel_hi:[1,0] neg_lo:[0,1] neg_hi:[0,1]
  v_pk_fma_f32 v[88:89], v[94:95], v[94:95], v[88:89]
  v_pk_add_f32 v[96:97], v[66:67], v[92:93] op_sel_hi:[1,0] neg_lo:[0,1] neg_hi:[0,1]
  v_pk_fma_f32 v[90:91], v[96:97], v[96:97], v[90:91]
  v_pk_add_f32 v[94:95], v[68:69], v[92:93] op_sel_hi:[1,0] neg_lo:[0,1] neg_hi:[0,1]
  v_pk_fma_f32 v[88:89], v[94:95], v[94:95], v[88:89]
  v_pk_add_f32 v[96:97], v[70:71], v[92:93] op_sel_hi:[1,0] neg_lo:[0,1] neg_hi:[0,1]
  v_pk_fma_f32 v[90:91], v[96:97], v[96:97], v[90:91]
  v_pk_add_f32 v[94:95], v[72:73], v[92:93] op_sel_hi:[1,0] neg_lo:[0,1] neg_hi:[0,1]
  v_pk_fma_f32 v[88:89], v[94:95], v[94:95], v[88:89]
  v_pk_add_f32 v[96:97], v[74:75], v[92:93] op_sel_hi:[1,0] neg_lo:[0,1] neg_hi:[0,1]
  v_pk_fma_f32 v[90:91], v[96:97], v[96:97], v[90:91]
  v_pk_add_f32 v[94:95], v[76:77], v[92:93] op_sel_hi:[1,0] neg_lo:[0,1] neg_hi:[0,1]
  v_pk_fma_f32 v[88:89], v[94:95], v[94:95], v[88:89]
  v_pk_add_f32 v[96:97], v[78:79], v[92:93] op_sel_hi:[1,0] neg_lo:[0,1] neg_hi:[0,1]
  v_pk_fma_f32 v[90:91], v[96:97], v[96:97], v[90:91]
  v_pk_add_f32 v[94:95], v[80:81], v[92:93] op_sel_hi:[1,0] neg_lo:[0,1] neg_hi:[0,1]
  v_pk_fma_f32 v[88:89], v[94:95], v[94:95], v[88:89]
  v_pk_add_f32 v[96:97], v[82:83], v[92:93] op_sel_hi:[1,0] neg_lo:[0,1] neg_hi:[0,1]
  v_pk_fma_f32 v[90:91], v[96:97], v[96:97], v[90:91]
  v_pk_add_f32 v[94:95], v[84:85], v[92:93] op_sel_hi:[1,0] neg_lo:[0,1] neg_hi:[0,1]
  v_pk_fma_f32 v[88:89], v[94:95], v[94:95], v[88:89]
  v_pk_add_f32 v[96:97], v[86:87], v[92:93] op_sel_hi:[1,0] neg_lo:[0,1] neg_hi:[0,1]
  v_pk_fma_f32 v[90:91], v[96:97], v[96:97], v[90:91]
  v_pk_add_f32 v[88:89], v[88:89], v[90:91]
  v_add_f32 v98, v88, v89
  s_nop 1
  v_add_f32_dpp v98, v98, v98 row_ror:8 row_mask:0xf bank_mask:0xf
  v_cvt_pk_bf16_f32 v92, v92, v92
  s_nop 0
  v_add_f32_dpp v98, v98, v98 row_ror:4 row_mask:0xf bank_mask:0xf
  v_lshlrev_b32 v92, 16, v92
  s_nop 0
  v_add_f32_dpp v98, v98, v98 row_ror:2 row_mask:0xf bank_mask:0xf
  s_nop 1
  v_add_f32_dpp v98, v98, v98 row_ror:1 row_mask:0xf bank_mask:0xf
  v_mul_f32 v98, 0x3acccccd, v98
  v_cvt_pk_bf16_f32 v98, v98, v98
  v_pk_add_f32 v[48:49], v[48:49], v[92:93] op_sel_hi:[1,0] neg_lo:[0,1] neg_hi:[0,1]
  v_lshlrev_b32 v98, 16, v98
  v_pk_add_f32 v[50:51], v[50:51], v[92:93] op_sel_hi:[1,0] neg_lo:[0,1] neg_hi:[0,1]
  v_add_f32 v98, 0x3727c5ac, v98
  v_pk_add_f32 v[52:53], v[52:53], v[92:93] op_sel_hi:[1,0] neg_lo:[0,1] neg_hi:[0,1]
  v_cvt_pk_bf16_f32 v98, v98, v98
  v_pk_add_f32 v[54:55], v[54:55], v[92:93] op_sel_hi:[1,0] neg_lo:[0,1] neg_hi:[0,1]
  v_lshlrev_b32 v98, 16, v98
  v_pk_add_f32 v[56:57], v[56:57], v[92:93] op_sel_hi:[1,0] neg_lo:[0,1] neg_hi:[0,1]
  v_sqrt_f32 v98, v98
  v_pk_add_f32 v[58:59], v[58:59], v[92:93] op_sel_hi:[1,0] neg_lo:[0,1] neg_hi:[0,1]
  v_cvt_pk_bf16_f32 v98, v98, v98
  v_pk_add_f32 v[60:61], v[60:61], v[92:93] op_sel_hi:[1,0] neg_lo:[0,1] neg_hi:[0,1]
  v_lshlrev_b32 v98, 16, v98
  v_pk_add_f32 v[62:63], v[62:63], v[92:93] op_sel_hi:[1,0] neg_lo:[0,1] neg_hi:[0,1]
  v_rcp_f32 v100, v98
  v_pk_add_f32 v[64:65], v[64:65], v[92:93] op_sel_hi:[1,0] neg_lo:[0,1] neg_hi:[0,1]
  v_pk_add_f32 v[66:67], v[66:67], v[92:93] op_sel_hi:[1,0] neg_lo:[0,1] neg_hi:[0,1]
  v_pk_add_f32 v[68:69], v[68:69], v[92:93] op_sel_hi:[1,0] neg_lo:[0,1] neg_hi:[0,1]
  v_pk_add_f32 v[70:71], v[70:71], v[92:93] op_sel_hi:[1,0] neg_lo:[0,1] neg_hi:[0,1]
  v_pk_add_f32 v[72:73], v[72:73], v[92:93] op_sel_hi:[1,0] neg_lo:[0,1] neg_hi:[0,1]
  v_pk_add_f32 v[74:75], v[74:75], v[92:93] op_sel_hi:[1,0] neg_lo:[0,1] neg_hi:[0,1]
  v_pk_add_f32 v[76:77], v[76:77], v[92:93] op_sel_hi:[1,0] neg_lo:[0,1] neg_hi:[0,1]
  v_pk_add_f32 v[78:79], v[78:79], v[92:93] op_sel_hi:[1,0] neg_lo:[0,1] neg_hi:[0,1]
  v_pk_add_f32 v[80:81], v[80:81], v[92:93] op_sel_hi:[1,0] neg_lo:[0,1] neg_hi:[0,1]
  v_pk_add_f32 v[82:83], v[82:83], v[92:93] op_sel_hi:[1,0] neg_lo:[0,1] neg_hi:[0,1]
  v_pk_add_f32 v[84:85], v[84:85], v[92:93] op_sel_hi:[1,0] neg_lo:[0,1] neg_hi:[0,1]
  v_pk_add_f32 v[86:87], v[86:87], v[92:93] op_sel_hi:[1,0] neg_lo:[0,1] neg_hi:[0,1]
  v_mov_b32 v104, 0
  v_mov_b32 v105, 0
  v_cvt_pk_bf16_f32 v8, v48, v49
  v_cvt_pk_bf16_f32 v9, v50, v51
  v_cvt_pk_bf16_f32 v10, v52, v53
  v_cvt_pk_bf16_f32 v11, v54, v55
  v_cvt_pk_bf16_f32 v12, v56, v57
  v_cvt_pk_bf16_f32 v13, v58, v59
  v_cvt_pk_bf16_f32 v14, v60, v61
  v_cvt_pk_bf16_f32 v15, v62, v63
  v_cvt_pk_bf16_f32 v16, v64, v65
  v_cvt_pk_bf16_f32 v17, v66, v67
  v_cvt_pk_bf16_f32 v18, v68, v69
  v_cvt_pk_bf16_f32 v19, v70, v71
  v_cvt_pk_bf16_f32 v20, v72, v73
  v_cvt_pk_bf16_f32 v21, v74, v75
  v_cvt_pk_bf16_f32 v22, v76, v77
  v_cvt_pk_bf16_f32 v23, v78, v79
  v_cvt_pk_bf16_f32 v24, v80, v81
  v_cvt_pk_bf16_f32 v25, v82, v83
  v_cvt_pk_bf16_f32 v26, v84, v85
  v_cvt_pk_bf16_f32 v27, v86, v87
  v_lshlrev_b32 v48, 16, v8
  v_and_b32 v49, s56, v8
  v_lshlrev_b32 v50, 16, v9
  v_and_b32 v51, s56, v9
  v_lshlrev_b32 v52, 16, v10
  v_and_b32 v53, s56, v10
  v_lshlrev_b32 v54, 16, v11
  v_and_b32 v55, s56, v11
  v_lshlrev_b32 v56, 16, v12
  v_and_b32 v57, s56, v12
  v_lshlrev_b32 v58, 16, v13
  v_and_b32 v59, s56, v13
  v_lshlrev_b32 v60, 16, v14
  v_and_b32 v61, s56, v14
  v_lshlrev_b32 v62, 16, v15
  v_and_b32 v63, s56, v15
  v_lshlrev_b32 v64, 16, v16
  v_and_b32 v65, s56, v16
  v_lshlrev_b32 v66, 16, v17
  v_and_b32 v67, s56, v17
  v_lshlrev_b32 v68, 16, v18
  v_and_b32 v69, s56, v18
  v_lshlrev_b32 v70, 16, v19
  v_and_b32 v71, s56, v19
  v_lshlrev_b32 v72, 16, v20
  v_and_b32 v73, s56, v20
  v_lshlrev_b32 v74, 16, v21
  v_and_b32 v75, s56, v21
  v_lshlrev_b32 v76, 16, v22
  v_and_b32 v77, s56, v22
  v_lshlrev_b32 v78, 16, v23
  v_and_b32 v79, s56, v23
  v_lshlrev_b32 v80, 16, v24
  v_and_b32 v81, s56, v24
  v_lshlrev_b32 v82, 16, v25
  v_and_b32 v83, s56, v25
  v_lshlrev_b32 v84, 16, v26
  v_and_b32 v85, s56, v26
  v_lshlrev_b32 v86, 16, v27
  v_and_b32 v87, s56, v27
  v_pk_mul_f32 v[48:49], v[48:49], v[100:101] op_sel_hi:[1,0]
  v_pk_mul_f32 v[50:51], v[50:51], v[100:101] op_sel_hi:[1,0]
  v_pk_mul_f32 v[52:53], v[52:53], v[100:101] op_sel_hi:[1,0]
  v_pk_mul_f32 v[54:55], v[54:55], v[100:101] op_sel_hi:[1,0]
  v_cvt_pk_bf16_f32 v8, v48, v49
  v_cvt_pk_bf16_f32 v9, v50, v51
  v_cvt_pk_bf16_f32 v10, v52, v53
  v_cvt_pk_bf16_f32 v11, v54, v55
  buffer_store_dwordx4 v[8:11], v5, s[24:27], s53 offen sc1
  s_add_u32 s53, s53, 16384
  v_pk_mul_f32 v[56:57], v[56:57], v[100:101] op_sel_hi:[1,0]
  v_pk_mul_f32 v[58:59], v[58:59], v[100:101] op_sel_hi:[1,0]
  v_pk_mul_f32 v[60:61], v[60:61], v[100:101] op_sel_hi:[1,0]
  v_pk_mul_f32 v[62:63], v[62:63], v[100:101] op_sel_hi:[1,0]
  v_cvt_pk_bf16_f32 v12, v56, v57
  v_cvt_pk_bf16_f32 v13, v58, v59
  v_cvt_pk_bf16_f32 v14, v60, v61
  v_cvt_pk_bf16_f32 v15, v62, v63
  buffer_store_dwordx4 v[12:15], v5, s[24:27], s53 offen sc1
  s_add_u32 s53, s53, 16384
  v_pk_mul_f32 v[64:65], v[64:65], v[100:101] op_sel_hi:[1,0]
  v_pk_mul_f32 v[66:67], v[66:67], v[100:101] op_sel_hi:[1,0]
  v_pk_mul_f32 v[68:69], v[68:69], v[100:101] op_sel_hi:[1,0]
  v_pk_mul_f32 v[70:71], v[70:71], v[100:101] op_sel_hi:[1,0]
  v_cvt_pk_bf16_f32 v16, v64, v65
  v_cvt_pk_bf16_f32 v17, v66, v67
  v_cvt_pk_bf16_f32 v18, v68, v69
  v_cvt_pk_bf16_f32 v19, v70, v71
  buffer_store_dwordx4 v[16:19], v5, s[24:27], s53 offen sc1
  s_add_u32 s53, s53, 16384
  v_pk_mul_f32 v[72:73], v[72:73], v[100:101] op_sel_hi:[1,0]
  v_pk_mul_f32 v[74:75], v[74:75], v[100:101] op_sel_hi:[1,0]
  v_pk_mul_f32 v[76:77], v[76:77], v[100:101] op_sel_hi:[1,0]
  v_pk_mul_f32 v[78:79], v[78:79], v[100:101] op_sel_hi:[1,0]
  v_cvt_pk_bf16_f32 v20, v72, v73
  v_cvt_pk_bf16_f32 v21, v74, v75
  v_cvt_pk_bf16_f32 v22, v76, v77
  v_cvt_pk_bf16_f32 v23, v78, v79
  buffer_store_dwordx4 v[20:23], v5, s[24:27], s53 offen sc1
  s_add_u32 s53, s53, 16384
  v_pk_mul_f32 v[80:81], v[80:81], v[100:101] op_sel_hi:[1,0]
  v_pk_mul_f32 v[82:83], v[82:83], v[100:101] op_sel_hi:[1,0]
  v_pk_mul_f32 v[84:85], v[84:85], v[100:101] op_sel_hi:[1,0]
  v_pk_mul_f32 v[86:87], v[86:87], v[100:101] op_sel_hi:[1,0]
  v_cvt_pk_bf16_f32 v24, v80, v81
  v_cvt_pk_bf16_f32 v25, v82, v83
  v_cvt_pk_bf16_f32 v26, v84, v85
  v_cvt_pk_bf16_f32 v27, v86, v87
  buffer_store_dwordx4 v[24:27], v5, s[24:27], s53 offen sc1
  s_add_u32 s53, s53, 16384
  s_waitcnt vmcnt(11)
  v_dot2_f32_bf16 v104, v8, v28, v104
  v_dot2_f32_bf16 v105, v9, v29, v105
  v_dot2_f32_bf16 v104, v10, v30, v104
  v_dot2_f32_bf16 v105, v11, v31, v105
  s_waitcnt vmcnt(10)
  v_dot2_f32_bf16 v104, v12, v32, v104
  v_dot2_f32_bf16 v105, v13, v33, v105
  v_dot2_f32_bf16 v104, v14, v34, v104
  v_dot2_f32_bf16 v105, v15, v35, v105
  s_waitcnt vmcnt(9)
  v_dot2_f32_bf16 v104, v16, v36, v104
  v_dot2_f32_bf16 v105, v17, v37, v105
  v_dot2_f32_bf16 v104, v18, v38, v104
  v_dot2_f32_bf16 v105, v19, v39, v105
  s_waitcnt vmcnt(8)
  v_dot2_f32_bf16 v104, v20, v40, v104
  v_dot2_f32_bf16 v105, v21, v41, v105
  v_dot2_f32_bf16 v104, v22, v42, v104
  v_dot2_f32_bf16 v105, v23, v43, v105
  s_waitcnt vmcnt(7)
  v_dot2_f32_bf16 v104, v24, v44, v104
  v_dot2_f32_bf16 v105, v25, v45, v105
  v_dot2_f32_bf16 v104, v26, v46, v104
  v_dot2_f32_bf16 v105, v27, v47, v105
  s_nop 2
  v_add_f32 v104, v104, v105
  s_nop 1
  v_add_f32_dpp v104, v104, v104 row_ror:8 row_mask:0xf bank_mask:0xf
  s_nop 1
  v_add_f32_dpp v104, v104, v104 row_ror:4 row_mask:0xf bank_mask:0xf
  s_nop 1
  v_add_f32_dpp v104, v104, v104 row_ror:2 row_mask:0xf bank_mask:0xf
  s_nop 1
  v_add_f32_dpp v104, v104, v104 row_ror:1 row_mask:0xf bank_mask:0xf
  v_cvt_pk_bf16_f32 v104, v104, v104
  v_lshlrev_b32 v104, 16, v104
  v_ashrrev_i32 v105, 31, v104
  v_or_b32 v105, 0x80000000, v105
  v_xor_b32 v104, v104, v105
  v_and_b32 v104, s56, v104
  v_add_u32 v6, s52, v1
  v_sub_u32 v7, 0xffff, v6
  v_or_b32 v104, v104, v7
  v_lshlrev_b32 v6, 2, v6
  v_lshl_add_u32 v6, v2, 26, v6
  s_mov_b32 s53, 2621440
  buffer_store_dword v104, v6, s[24:27], s53 offen sc1
  s_waitcnt vmcnt(0)
  s_branch front_join
front_fetch:
  v_subrev_u32 v16, 0x40000, v238
  v_subrev_u32 v17, 0x40000, v239
  v_subrev_u32 v18, 0x40000, v240
  v_subrev_u32 v19, 0x40000, v241
front_join:
  s_waitcnt lgkmcnt(0)
  s_barrier
  s_mul_i32 s55, s59, 0x9e3779b1
  s_add_u32 s55, s55, 0x7f4a7c15
  s_bfe_u32 s58, s2, 0x30003
  s_lshl_b32 s58, s58, 8
  s_add_u32 s58, s58, 2826240
  s_lshl_b32 s53, s36, 2
  s_lshl_b32 s54, s3, 26
  s_add_u32 s53, s53, s54
  v_min_u32 v1, 1, v0
  v_lshlrev_b32 v1, 28, v1
  v_add_u32 v1, s53, v1
  v_mov_b32 v2, s55
  buffer_store_dword v2, v1, s[24:27], s58 offen sc1
  s_cmp_lt_u32 s3, 2
  s_cbranch_scc1 front_addr
  s_mov_b32 s31, 0
  s_add_u32 m0, s28, 90112
  s_nop 0
  buffer_load_dwordx4 v16, s[20:23], s31 offen offset:0 lds
  buffer_load_dwordx4 v17, s[20:23], s31 offen offset:1024 lds
  buffer_load_dwordx4 v18, s[20:23], s31 offen offset:2048 lds
  buffer_load_dwordx4 v19, s[20:23], s31 offen offset:3072 lds
  s_add_u32 m0, s28, 98304
  s_nop 0
  buffer_load_dwordx4 v238, s[20:23], s31 offen offset:0 lds
  buffer_load_dwordx4 v239, s[20:23], s31 offen offset:1024 lds
  buffer_load_dwordx4 v240, s[20:23], s31 offen offset:2048 lds
  buffer_load_dwordx4 v241, s[20:23], s31 offen offset:3072 lds
  s_mov_b32 s31, 524288
  s_add_u32 m0, s28, 106496
  s_nop 0
  buffer_load_dwordx4 v16, s[20:23], s31 offen offset:0 lds
  buffer_load_dwordx4 v17, s[20:23], s31 offen offset:1024 lds
  buffer_load_dwordx4 v18, s[20:23], s31 offen offset:2048 lds
  buffer_load_dwordx4 v19, s[20:23], s31 offen offset:3072 lds
  s_add_u32 m0, s28, 114688
  s_nop 0
  buffer_load_dwordx4 v238, s[20:23], s31 offen offset:0 lds
  buffer_load_dwordx4 v239, s[20:23], s31 offen offset:1024 lds
  buffer_load_dwordx4 v240, s[20:23], s31 offen offset:2048 lds
  buffer_load_dwordx4 v241, s[20:23], s31 offen offset:3072 lds
  s_mov_b32 s31, 1048576
  s_add_u32 m0, s28, 24576
  s_nop 0
  buffer_load_dwordx4 v16, s[20:23], s31 offen offset:0 lds
  buffer_load_dwordx4 v17, s[20:23], s31 offen offset:1024 lds
  buffer_load_dwordx4 v18, s[20:23], s31 offen offset:2048 lds
  buffer_load_dwordx4 v19, s[20:23], s31 offen offset:3072 lds
  s_add_u32 m0, s28, 32768
  s_nop 0
  buffer_load_dwordx4 v238, s[20:23], s31 offen offset:0 lds
  buffer_load_dwordx4 v239, s[20:23], s31 offen offset:1024 lds
  buffer_load_dwordx4 v240, s[20:23], s31 offen offset:2048 lds
  buffer_load_dwordx4 v241, s[20:23], s31 offen offset:3072 lds
  s_mov_b32 s31, 1572864
  s_add_u32 m0, s28, 40960
  s_nop 0
  buffer_load_dwordx4 v16, s[20:23], s31 offen offset:0 lds
  buffer_load_dwordx4 v17, s[20:23], s31 offen offset:1024 lds
  buffer_load_dwordx4 v18, s[20:23], s31 offen offset:2048 lds
  buffer_load_dwordx4 v19, s[20:23], s31 offen offset:3072 lds
  s_add_u32 m0, s28, 49152
  s_nop 0
  buffer_load_dwordx4 v238, s[20:23], s31 offen offset:0 lds
  buffer_load_dwordx4 v239, s[20:23], s31 offen offset:1024 lds
  buffer_load_dwordx4 v240, s[20:23], s31 offen offset:2048 lds
  buffer_load_dwordx4 v241, s[20:23], s31 offen offset:3072 lds
  s_mov_b32 s31, 2097152
  s_add_u32 m0, s28, 8192
  s_nop 0
  buffer_load_dwordx4 v16, s[20:23], s31 offen offset:0 lds
  buffer_load_dwordx4 v17, s[20:23], s31 offen offset:1024 lds
  buffer_load_dwordx4 v18, s[20:23], s31 offen offset:2048 lds
  buffer_load_dwordx4 v19, s[20:23], s31 offen offset:3072 lds
  s_add_u32 m0, s28, 16384
  s_nop 0
  buffer_load_dwordx4 v238, s[20:23], s31 offen offset:0 lds
  buffer_load_dwordx4 v239, s[20:23], s31 offen offset:1024 lds
  buffer_load_dwordx4 v240, s[20:23], s31 offen offset:2048 lds
  buffer_load_dwordx4 v241, s[20:23], s31 offen offset:3072 lds
  s_mov_b32 s31, 2621440
  s_add_u32 m0, s28, -8192
  s_nop 0
  buffer_load_dwordx4 v16, s[20:23], s31 offen offset:0 lds
  buffer_load_dwordx4 v17, s[20:23], s31 offen offset:1024 lds
  buffer_load_dwordx4 v18, s[20:23], s31 offen offset:2048 lds
  buffer_load_dwordx4 v19, s[20:23], s31 offen offset:3072 lds
  s_add_u32 m0, s28, 0
  s_nop 0
  buffer_load_dwordx4 v238, s[20:23], s31 offen offset:0 lds
  buffer_load_dwordx4 v239, s[20:23], s31 offen offset:1024 lds
  buffer_load_dwordx4 v240, s[20:23], s31 offen offset:2048 lds
  buffer_load_dwordx4 v241, s[20:23], s31 offen offset:3072 lds
  s_and_b32 s53, s2, 7
  s_lshr_b32 s54, s2, 3
  s_lshl_b32 s54, s54, 1
  s_add_u32 s54, s54, s3
  s_sub_u32 s54, s54, 2
  s_lshl_b32 s52, s53, 21
  s_lshr_b32 s57, s54, 4
  s_lshl_b32 s57, s57, 19
  s_add_u32 s52, s52, s57
  s_add_u32 s12, s4, s52
  s_addc_u32 s13, s5, 0
  s_mov_b32 s14, 49152
  s_mov_b32 s15, 0x20000
  s_add_u32 s16, s6, s52
  s_addc_u32 s17, s7, 0
  s_mov_b32 s18, 32768
  s_mov_b32 s19, 0x20000
  s_and_b32 s57, s54, 15
  s_mul_i32 s52, s57, 3072
  s_lshl_b32 s57, s57, 11
  v_lshlrev_b32 v1, 7, v0
  v_lshrrev_b32 v2, 4, v0
  v_lshl_add_u32 v2, v2, 20, v1
  v_cmp_gt_u32 vcc, 24, v0
  v_mov_b32 v3, 0x100000
  s_nop 0
  v_cndmask_b32 v1, v3, v1, vcc
  buffer_load_dword v8, v1, s[12:15], s52 offen
  buffer_load_dword v8, v2, s[16:19], s57 offen
front_addr:
  s_mov_b32 s31, 3145728
  v_lshlrev_b32 v242, 4, v245
  v_add_u32 v243, 0x1000, v242
  s_mul_i32 s30, s37, 81920
  s_lshl_b32 s38, s36, 19
  s_add_u32 s12, s4, s38
  s_addc_u32 s13, s5, 0
  s_mov_b32 s14, 524288
  s_mov_b32 s15, 0x20000
  s_add_u32 s16, s6, s38
  s_addc_u32 s17, s7, 0
  s_mov_b32 s18, 524288
  s_mov_b32 s19, 0x20000
  v_lshlrev_b32 v249, 8, v248
  v_add_u32 v249, s28, v249
  v_add_u32 v250, 0, v248
  v_xor_b32 v250, v250, v247
  v_lshl_add_u32 v232, v250, 4, v249
  v_add_u32 v250, 4, v248
  v_xor_b32 v250, v250, v247
  v_lshl_add_u32 v233, v250, 4, v249
  v_add_u32 v250, 8, v248
  v_xor_b32 v250, v250, v247
  v_lshl_add_u32 v234, v250, 4, v249
  v_add_u32 v250, 12, v248
  v_xor_b32 v250, v250, v247
  v_lshl_add_u32 v235, v250, 4, v249
  v_add_u32 v250, 0, v248
  v_lshlrev_b32 v250, 1, v250
  v_xor_b32 v250, v250, v247
  v_lshl_add_u32 v236, v250, 4, v249
  v_add_u32 v250, 4, v248
  v_lshlrev_b32 v250, 1, v250
  v_xor_b32 v250, v250, v247
  v_lshl_add_u32 v237, v250, 4, v249
  v_lshrrev_b32 v249, 1, v248
  v_and_b32 v250, 1, v248
  v_lshl_or_b32 v249, v250, 1, v249
  v_xor_b32 v249, v249, v247
  v_lshlrev_b32 v249, 4, v249
  v_lshl_add_u32 v212, v247, 8, v249
  v_xor_b32 v213, 64, v212
  v_xor_b32 v214, 128, v212
  v_xor_b32 v215, 192, v212
  v_bfe_u32 v246, v245, 2, 2
  v_and_b32 v247, 3, v245
  v_lshlrev_b32 v247, 3, v247
  v_add_u32 v247, 65536, v247
  v_lshl_add_u32 v249, v248, 2, v246
  v_and_b32 v250, 7, v249
  v_lshl_add_u32 v250, v250, 5, v247
  v_lshl_add_u32 v216, v249, 8, v250
  v_lshl_add_u32 v249, v248, 3, v246
  v_and_b32 v250, 1, v248
  v_lshl_add_u32 v250, v250, 2, v246
  v_lshl_add_u32 v250, v250, 5, v247
  v_lshl_add_u32 v224, v249, 8, v250
  v_xor_b32 v217, 32, v216
  v_xor_b32 v225, 32, v224
  v_xor_b32 v218, 64, v216
  v_xor_b32 v226, 64, v224
  v_xor_b32 v219, 96, v216
  v_xor_b32 v227, 96, v224
  v_xor_b32 v220, 128, v216
  v_xor_b32 v228, 128, v224
  v_xor_b32 v221, 160, v216
  v_xor_b32 v229, 160, v224
  v_xor_b32 v222, 192, v216
  v_xor_b32 v230, 192, v224
  v_xor_b32 v223, 224, v216
  v_xor_b32 v231, 224, v224
  v_subrev_u32 v144, 65536, v224
  v_subrev_u32 v145, 65536, v225
  v_subrev_u32 v146, 65536, v226
  v_subrev_u32 v147, 65536, v227
  v_subrev_u32 v148, 65536, v228
  v_subrev_u32 v149, 65536, v229
  v_subrev_u32 v150, 65536, v230
  v_subrev_u32 v151, 65536, v231
  s_lshr_b32 s38, s2, 3
  s_min_u32 s38, s38, 26
  s_and_b32 s39, s2, 7
  s_mul_i32 s39, s39, 27
  s_add_u32 s33, s38, s39
  s_mul_i32 s50, s3, 6144
  s_add_u32 s50, s50, 133120
  v_mov_b32 v244, v242
  s_lshl_b32 s40, s37, 19
  s_lshl_b32 s38, s36, 14
  s_add_u32 s40, s40, s38
  s_add_u32 s40, s40, 8388608
  s_add_u32 s41, s40, 4096
  s_add_u32 s42, s40, 8192
  s_add_u32 s43, s40, 12288
  s_mov_b32 s34, 0x3e0293ee
  s_mov_b32 s29, 0
  v_and_b32 v249, 15, v245
  v_cmp_eq_u32 vcc, 0, v249
  v_mov_b32 v249, 0x3f803f80
  s_nop 0
  v_cndmask_b32 v249, 0, v249, vcc
  v_accvgpr_write_b32 a208, v249
  v_accvgpr_write_b32 a209, v249
  v_accvgpr_write_b32 a210, v249
  v_accvgpr_write_b32 a211, v249
  s_cmp_lg_u32 s3, 0
  s_cbranch_scc1 front_go
  v_and_b32 v2, 31, v0
  v_lshlrev_b32 v2, 2, v2
  s_mov_b32 s54, 32768
front_poll:
  buffer_load_dword v1, v2, s[24:27], s58 offen sc1
  s_waitcnt vmcnt(0)
  v_cmp_ne_u32 vcc, s55, v1
  s_nop 0
  s_cbranch_vccz front_go
  s_sleep 2
  s_sub_u32 s54, s54, 1
  s_cmp_lg_u32 s54, 0
  s_cbranch_scc1 front_poll
front_go:
  s_waitcnt vmcnt(42)
  s_barrier
  buffer_load_dwordx4 a[0:3], v242, s[24:27], s30 offen offset:0 sc1
  buffer_load_dwordx4 a[4:7], v242, s[24:27], s30 offen offset:1024 sc1
  buffer_load_dwordx4 a[8:11], v242, s[24:27], s30 offen offset:2048 sc1
  buffer_load_dwordx4 a[12:15], v242, s[24:27], s30 offen offset:3072 sc1
  buffer_load_dwordx4 a[16:19], v243, s[24:27], s30 offen offset:0 sc1
  buffer_load_dwordx4 a[20:23], v243, s[24:27], s30 offen offset:1024 sc1
  buffer_load_dwordx4 a[24:27], v243, s[24:27], s30 offen offset:2048 sc1
  buffer_load_dwordx4 a[28:31], v243, s[24:27], s30 offen offset:3072 sc1
  s_add_u32 s30, s30, 8192
  buffer_load_dwordx4 a[32:35], v242, s[24:27], s30 offen offset:0 sc1
  buffer_load_dwordx4 a[36:39], v242, s[24:27], s30 offen offset:1024 sc1
  buffer_load_dwordx4 a[40:43], v242, s[24:27], s30 offen offset:2048 sc1
  buffer_load_dwordx4 a[44:47], v242, s[24:27], s30 offen offset:3072 sc1
  buffer_load_dwordx4 a[48:51], v243, s[24:27], s30 offen offset:0 sc1
  buffer_load_dwordx4 a[52:55], v243, s[24:27], s30 offen offset:1024 sc1
  buffer_load_dwordx4 a[56:59], v243, s[24:27], s30 offen offset:2048 sc1
  buffer_load_dwordx4 a[60:63], v243, s[24:27], s30 offen offset:3072 sc1
  s_add_u32 s30, s30, 8192
  ds_read_b64_tr_b16 a[160:161], v224 offset:32768
  ds_read_b64_tr_b16 a[162:163], v224 offset:33792
  ds_read_b64_tr_b16 a[164:165], v224 offset:40960
  ds_read_b64_tr_b16 a[166:167], v224 offset:41984
  ds_read_b64_tr_b16 a[168:169], v225 offset:32768
  ds_read_b64_tr_b16 a[170:171], v225 offset:33792
  ds_read_b64_tr_b16 a[172:173], v225 offset:40960
  ds_read_b64_tr_b16 a[174:175], v225 offset:41984
  s_waitcnt vmcnt(8) lgkmcnt(4)
  v_mfma_f32_16x16x32_bf16 v[0:3], a[160:163], a[0:3], 0
  ds_read_b64_tr_b16 a[176:177], v226 offset:32768
  buffer_load_dwordx4 a[64:67], v242, s[24:27], s30 offen offset:0 sc1
  v_mfma_f32_16x16x32_bf16 v[0:3], a[164:167], a[16:19], v[0:3]
  buffer_load_dwordx4 a[68:71], v242, s[24:27], s30 offen offset:1024 sc1
  v_mfma_f32_16x16x32_bf16 v[4:7], a[164:167], a[20:23], 0
  ds_read_b64_tr_b16 a[178:179], v226 offset:33792
  buffer_load_dwordx4 a[72:75], v242, s[24:27], s30 offen offset:2048 sc1
  v_mfma_f32_16x16x32_bf16 v[4:7], a[160:163], a[4:7], v[4:7]
  buffer_load_dwordx4 a[76:79], v242, s[24:27], s30 offen offset:3072 sc1
  v_mfma_f32_16x16x32_bf16 v[8:11], a[160:163], a[8:11], 0
  ds_read_b64_tr_b16 a[180:181], v226 offset:40960
  buffer_load_dwordx4 a[80:83], v243, s[24:27], s30 offen offset:0 sc1
  v_mfma_f32_16x16x32_bf16 v[8:11], a[164:167], a[24:27], v[8:11]
  buffer_load_dwordx4 a[84:87], v243, s[24:27], s30 offen offset:1024 sc1
  v_mfma_f32_16x16x32_bf16 v[12:15], a[164:167], a[28:31], 0
  ds_read_b64_tr_b16 a[182:183], v226 offset:41984
  buffer_load_dwordx4 a[88:91], v243, s[24:27], s30 offen offset:2048 sc1
  v_mfma_f32_16x16x32_bf16 v[12:15], a[160:163], a[12:15], v[12:15]
  s_waitcnt lgkmcnt(4)
  buffer_load_dwordx4 a[92:95], v243, s[24:27], s30 offen offset:3072 sc1
  s_add_u32 s30, s30, 8192
  v_mfma_f32_16x16x32_bf16 v[16:19], a[168:171], a[0:3], 0
  ds_read_b64_tr_b16 a[184:185], v227 offset:32768
  buffer_load_dwordx4 a[96:99], v242, s[24:27], s30 offen offset:0 sc1
  v_mfma_f32_16x16x32_bf16 v[16:19], a[172:175], a[16:19], v[16:19]
  buffer_load_dwordx4 a[100:103], v242, s[24:27], s30 offen offset:1024 sc1
  v_mfma_f32_16x16x32_bf16 v[20:23], a[172:175], a[20:23], 0
  ds_read_b64_tr_b16 a[186:187], v227 offset:33792
  buffer_load_dwordx4 a[104:107], v242, s[24:27], s30 offen offset:2048 sc1
  v_mfma_f32_16x16x32_bf16 v[20:23], a[168:171], a[4:7], v[20:23]
  buffer_load_dwordx4 a[108:111], v242, s[24:27], s30 offen offset:3072 sc1
  v_mfma_f32_16x16x32_bf16 v[24:27], a[168:171], a[8:11], 0
  ds_read_b64_tr_b16 a[188:189], v227 offset:40960
  buffer_load_dwordx4 a[112:115], v243, s[24:27], s30 offen offset:0 sc1
  v_mfma_f32_16x16x32_bf16 v[24:27], a[172:175], a[24:27], v[24:27]
  buffer_load_dwordx4 a[116:119], v243, s[24:27], s30 offen offset:1024 sc1
  v_mfma_f32_16x16x32_bf16 v[28:31], a[172:175], a[28:31], 0
  ds_read_b64_tr_b16 a[190:191], v227 offset:41984
  buffer_load_dwordx4 a[120:123], v243, s[24:27], s30 offen offset:2048 sc1
  v_mfma_f32_16x16x32_bf16 v[28:31], a[168:171], a[12:15], v[28:31]
  s_waitcnt lgkmcnt(4)
  buffer_load_dwordx4 a[124:127], v243, s[24:27], s30 offen offset:3072 sc1
  s_add_u32 s30, s30, 8192
  v_mfma_f32_16x16x32_bf16 v[32:35], a[176:179], a[0:3], 0
  ds_read_b64_tr_b16 a[160:161], v228 offset:32768
  v_mfma_f32_16x16x32_bf16 v[32:35], a[180:183], a[16:19], v[32:35]
  v_mfma_f32_16x16x32_bf16 v[36:39], a[180:183], a[20:23], 0
  ds_read_b64_tr_b16 a[162:163], v228 offset:33792
  v_mfma_f32_16x16x32_bf16 v[36:39], a[176:179], a[4:7], v[36:39]
  v_mfma_f32_16x16x32_bf16 v[40:43], a[176:179], a[8:11], 0
  ds_read_b64_tr_b16 a[164:165], v228 offset:40960
  v_mfma_f32_16x16x32_bf16 v[40:43], a[180:183], a[24:27], v[40:43]
  v_mfma_f32_16x16x32_bf16 v[44:47], a[180:183], a[28:31], 0
  ds_read_b64_tr_b16 a[166:167], v228 offset:41984
  v_mfma_f32_16x16x32_bf16 v[44:47], a[176:179], a[12:15], v[44:47]
  s_waitcnt lgkmcnt(4)
  v_mfma_f32_16x16x32_bf16 v[48:51], a[184:187], a[0:3], 0
  ds_read_b64_tr_b16 a[168:169], v229 offset:32768
  v_mfma_f32_16x16x32_bf16 v[48:51], a[188:191], a[16:19], v[48:51]
  v_mfma_f32_16x16x32_bf16 v[52:55], a[188:191], a[20:23], 0
  ds_read_b64_tr_b16 a[170:171], v229 offset:33792
  v_mfma_f32_16x16x32_bf16 v[52:55], a[184:187], a[4:7], v[52:55]
  v_mfma_f32_16x16x32_bf16 v[56:59], a[184:187], a[8:11], 0
  ds_read_b64_tr_b16 a[172:173], v229 offset:40960
  v_mfma_f32_16x16x32_bf16 v[56:59], a[188:191], a[24:27], v[56:59]
  v_mfma_f32_16x16x32_bf16 v[60:63], a[188:191], a[28:31], 0
  ds_read_b64_tr_b16 a[174:175], v229 offset:41984
  v_mfma_f32_16x16x32_bf16 v[60:63], a[184:187], a[12:15], v[60:63]
  s_waitcnt lgkmcnt(4)
  v_mfma_f32_16x16x32_bf16 v[64:67], a[160:163], a[0:3], 0
  ds_read_b64_tr_b16 a[176:177], v230 offset:32768
  v_mfma_f32_16x16x32_bf16 v[64:67], a[164:167], a[16:19], v[64:67]
  v_mfma_f32_16x16x32_bf16 v[68:71], a[164:167], a[20:23], 0
  ds_read_b64_tr_b16 a[178:179], v230 offset:33792
  v_mfma_f32_16x16x32_bf16 v[68:71], a[160:163], a[4:7], v[68:71]
  v_mfma_f32_16x16x32_bf16 v[72:75], a[160:163], a[8:11], 0
  ds_read_b64_tr_b16 a[180:181], v230 offset:40960
  v_mfma_f32_16x16x32_bf16 v[72:75], a[164:167], a[24:27], v[72:75]
  v_mfma_f32_16x16x32_bf16 v[76:79], a[164:167], a[28:31], 0
  ds_read_b64_tr_b16 a[182:183], v230 offset:41984
  v_mfma_f32_16x16x32_bf16 v[76:79], a[160:163], a[12:15], v[76:79]
  s_waitcnt lgkmcnt(4)
  v_mfma_f32_16x16x32_bf16 v[80:83], a[168:171], a[0:3], 0
  ds_read_b64_tr_b16 a[184:185], v231 offset:32768
  v_mfma_f32_16x16x32_bf16 v[80:83], a[172:175], a[16:19], v[80:83]
  v_mfma_f32_16x16x32_bf16 v[84:87], a[172:175], a[20:23], 0
  ds_read_b64_tr_b16 a[186:187], v231 offset:33792
  v_mfma_f32_16x16x32_bf16 v[84:87], a[168:171], a[4:7], v[84:87]
  v_mfma_f32_16x16x32_bf16 v[88:91], a[168:171], a[8:11], 0
  ds_read_b64_tr_b16 a[188:189], v231 offset:40960
  v_mfma_f32_16x16x32_bf16 v[88:91], a[172:175], a[24:27], v[88:91]
  s_barrier
  v_mfma_f32_16x16x32_bf16 v[92:95], a[172:175], a[28:31], 0
  ds_read_b64_tr_b16 a[190:191], v231 offset:41984
  v_mfma_f32_16x16x32_bf16 v[92:95], a[168:171], a[12:15], v[92:95]
  s_waitcnt lgkmcnt(4)
  s_add_u32 m0, s28, 65536
  v_mfma_f32_16x16x32_bf16 v[96:99], a[176:179], a[0:3], 0
  ds_read_b64_tr_b16 a[160:161], v224 offset:49152
  v_mfma_f32_16x16x32_bf16 v[96:99], a[180:183], a[16:19], v[96:99]
  buffer_load_dwordx4 v238, s[20:23], s31 offen offset:0 lds
  v_mfma_f32_16x16x32_bf16 v[100:103], a[180:183], a[20:23], 0
  ds_read_b64_tr_b16 a[162:163], v224 offset:50176
  v_mfma_f32_16x16x32_bf16 v[100:103], a[176:179], a[4:7], v[100:103]
  buffer_load_dwordx4 v239, s[20:23], s31 offen offset:1024 lds
  v_mfma_f32_16x16x32_bf16 v[104:107], a[176:179], a[8:11], 0
  ds_read_b64_tr_b16 a[164:165], v224 offset:57344
  v_mfma_f32_16x16x32_bf16 v[104:107], a[180:183], a[24:27], v[104:107]
  buffer_load_dwordx4 v240, s[20:23], s31 offen offset:2048 lds
  v_mfma_f32_16x16x32_bf16 v[108:111], a[180:183], a[28:31], 0
  ds_read_b64_tr_b16 a[166:167], v224 offset:58368
  v_mfma_f32_16x16x32_bf16 v[108:111], a[176:179], a[12:15], v[108:111]
  s_waitcnt lgkmcnt(4)
  v_mfma_f32_16x16x32_bf16 v[112:115], a[184:187], a[0:3], 0
  ds_read_b64_tr_b16 a[168:169], v225 offset:49152
  v_mfma_f32_16x16x32_bf16 v[112:115], a[188:191], a[16:19], v[112:115]
  buffer_load_dwordx4 v241, s[20:23], s31 offen offset:3072 lds
  v_mfma_f32_16x16x32_bf16 v[116:119], a[188:191], a[20:23], 0
  ds_read_b64_tr_b16 a[170:171], v225 offset:50176
  v_mfma_f32_16x16x32_bf16 v[116:119], a[184:187], a[4:7], v[116:119]
  s_add_u32 s31, s31, 0x80000
  v_mfma_f32_16x16x32_bf16 v[120:123], a[184:187], a[8:11], 0
  ds_read_b64_tr_b16 a[172:173], v225 offset:57344
  v_mfma_f32_16x16x32_bf16 v[120:123], a[188:191], a[24:27], v[120:123]
  v_mfma_f32_16x16x32_bf16 v[124:127], a[188:191], a[28:31], 0
  ds_read_b64_tr_b16 a[174:175], v225 offset:58368
  v_mfma_f32_16x16x32_bf16 v[124:127], a[184:187], a[12:15], v[124:127]
  s_waitcnt vmcnt(20) lgkmcnt(4)
  v_mfma_f32_16x16x32_bf16 v[0:3], a[160:163], a[32:35], v[0:3]
  ds_read_b64_tr_b16 a[176:177], v226 offset:49152
  v_lshrrev_b32 v140, 7, v242
  v_mfma_f32_16x16x32_bf16 v[0:3], a[164:167], a[48:51], v[0:3]
  buffer_load_dwordx4 a[0:3], v242, s[24:27], s30 offen offset:0 sc1
  v_mfma_f32_16x16x32_bf16 v[4:7], a[164:167], a[52:55], v[4:7]
  ds_read_b64_tr_b16 a[178:179], v226 offset:50176
  v_lshlrev_b32 v140, 8, v140
  v_mfma_f32_16x16x32_bf16 v[4:7], a[160:163], a[36:39], v[4:7]
  buffer_load_dwordx4 a[4:7], v242, s[24:27], s30 offen offset:1024 sc1
  v_mfma_f32_16x16x32_bf16 v[8:11], a[160:163], a[40:43], v[8:11]
  ds_read_b64_tr_b16 a[180:181], v226 offset:57344
  v_and_b32 v136, 0x70, v242
  v_mfma_f32_16x16x32_bf16 v[8:11], a[164:167], a[56:59], v[8:11]
  buffer_load_dwordx4 a[8:11], v242, s[24:27], s30 offen offset:2048 sc1
  v_mfma_f32_16x16x32_bf16 v[12:15], a[164:167], a[60:63], v[12:15]
  ds_read_b64_tr_b16 a[182:183], v226 offset:58368
  v_add_u32 v140, v140, v136
  v_mfma_f32_16x16x32_bf16 v[12:15], a[160:163], a[44:47], v[12:15]
  s_waitcnt lgkmcnt(4)
  s_mov_b32 s58, 2826240
  buffer_load_dwordx4 v[136:139], v140, s[24:27], s58 offen sc1
  v_mfma_f32_16x16x32_bf16 v[16:19], a[168:171], a[32:35], v[16:19]
  ds_read_b64_tr_b16 a[184:185], v227 offset:49152
  v_mfma_f32_16x16x32_bf16 v[16:19], a[172:175], a[48:51], v[16:19]
  buffer_load_dwordx4 a[12:15], v242, s[24:27], s30 offen offset:3072 sc1
  v_mfma_f32_16x16x32_bf16 v[20:23], a[172:175], a[52:55], v[20:23]
  ds_read_b64_tr_b16 a[186:187], v227 offset:50176
  v_mfma_f32_16x16x32_bf16 v[20:23], a[168:171], a[36:39], v[20:23]
  buffer_load_dwordx4 a[16:19], v243, s[24:27], s30 offen offset:0 sc1
  v_mfma_f32_16x16x32_bf16 v[24:27], a[168:171], a[40:43], v[24:27]
  ds_read_b64_tr_b16 a[188:189], v227 offset:57344
  v_mfma_f32_16x16x32_bf16 v[24:27], a[172:175], a[56:59], v[24:27]
  buffer_load_dwordx4 a[20:23], v243, s[24:27], s30 offen offset:1024 sc1
  v_mfma_f32_16x16x32_bf16 v[28:31], a[172:175], a[60:63], v[28:31]
  ds_read_b64_tr_b16 a[190:191], v227 offset:58368
  v_mfma_f32_16x16x32_bf16 v[28:31], a[168:171], a[44:47], v[28:31]
  s_waitcnt lgkmcnt(4)
  v_mfma_f32_16x16x32_bf16 v[32:35], a[176:179], a[32:35], v[32:35]
  ds_read_b64_tr_b16 a[160:161], v228 offset:49152
  v_mfma_f32_16x16x32_bf16 v[32:35], a[180:183], a[48:51], v[32:35]
  buffer_load_dwordx4 a[24:27], v243, s[24:27], s30 offen offset:2048 sc1
  v_mfma_f32_16x16x32_bf16 v[36:39], a[180:183], a[52:55], v[36:39]
  ds_read_b64_tr_b16 a[162:163], v228 offset:50176
  v_mfma_f32_16x16x32_bf16 v[36:39], a[176:179], a[36:39], v[36:39]
  buffer_load_dwordx4 a[28:31], v243, s[24:27], s30 offen offset:3072 sc1
  v_mfma_f32_16x16x32_bf16 v[40:43], a[176:179], a[40:43], v[40:43]
  ds_read_b64_tr_b16 a[164:165], v228 offset:57344
  v_mfma_f32_16x16x32_bf16 v[40:43], a[180:183], a[56:59], v[40:43]
  s_add_u32 s30, s30, 8192
  v_mfma_f32_16x16x32_bf16 v[44:47], a[180:183], a[60:63], v[44:47]
  ds_read_b64_tr_b16 a[166:167], v228 offset:58368
  v_mfma_f32_16x16x32_bf16 v[44:47], a[176:179], a[44:47], v[44:47]
  s_waitcnt lgkmcnt(4)
  v_mfma_f32_16x16x32_bf16 v[48:51], a[184:187], a[32:35], v[48:51]
  ds_read_b64_tr_b16 a[168:169], v229 offset:49152
  v_mfma_f32_16x16x32_bf16 v[48:51], a[188:191], a[48:51], v[48:51]
  v_mfma_f32_16x16x32_bf16 v[52:55], a[188:191], a[52:55], v[52:55]
  ds_read_b64_tr_b16 a[170:171], v229 offset:50176
  v_mfma_f32_16x16x32_bf16 v[52:55], a[184:187], a[36:39], v[52:55]
  v_mfma_f32_16x16x32_bf16 v[56:59], a[184:187], a[40:43], v[56:59]
  ds_read_b64_tr_b16 a[172:173], v229 offset:57344
  v_mfma_f32_16x16x32_bf16 v[56:59], a[188:191], a[56:59], v[56:59]
  v_mfma_f32_16x16x32_bf16 v[60:63], a[188:191], a[60:63], v[60:63]
  ds_read_b64_tr_b16 a[174:175], v229 offset:58368
  v_mfma_f32_16x16x32_bf16 v[60:63], a[184:187], a[44:47], v[60:63]
  s_waitcnt lgkmcnt(4)
  v_mfma_f32_16x16x32_bf16 v[64:67], a[160:163], a[32:35], v[64:67]
  ds_read_b64_tr_b16 a[176:177], v230 offset:49152
  v_mfma_f32_16x16x32_bf16 v[64:67], a[164:167], a[48:51], v[64:67]
  v_mfma_f32_16x16x32_bf16 v[68:71], a[164:167], a[52:55], v[68:71]
  ds_read_b64_tr_b16 a[178:179], v230 offset:50176
  v_mfma_f32_16x16x32_bf16 v[68:71], a[160:163], a[36:39], v[68:71]
  v_mfma_f32_16x16x32_bf16 v[72:75], a[160:163], a[40:43], v[72:75]
  ds_read_b64_tr_b16 a[180:181], v230 offset:57344
  v_mfma_f32_16x16x32_bf16 v[72:75], a[164:167], a[56:59], v[72:75]
  v_mfma_f32_16x16x32_bf16 v[76:79], a[164:167], a[60:63], v[76:79]
  ds_read_b64_tr_b16 a[182:183], v230 offset:58368
  v_mfma_f32_16x16x32_bf16 v[76:79], a[160:163], a[44:47], v[76:79]
  s_waitcnt lgkmcnt(4)
  v_mfma_f32_16x16x32_bf16 v[80:83], a[168:171], a[32:35], v[80:83]
  ds_read_b64_tr_b16 a[184:185], v231 offset:49152
  v_mfma_f32_16x16x32_bf16 v[80:83], a[172:175], a[48:51], v[80:83]
  v_mfma_f32_16x16x32_bf16 v[84:87], a[172:175], a[52:55], v[84:87]
  ds_read_b64_tr_b16 a[186:187], v231 offset:50176
  v_mfma_f32_16x16x32_bf16 v[84:87], a[168:171], a[36:39], v[84:87]
  v_mfma_f32_16x16x32_bf16 v[88:91], a[168:171], a[40:43], v[88:91]
  ds_read_b64_tr_b16 a[188:189], v231 offset:57344
  v_mfma_f32_16x16x32_bf16 v[88:91], a[172:175], a[56:59], v[88:91]
  s_barrier
  v_mfma_f32_16x16x32_bf16 v[92:95], a[172:175], a[60:63], v[92:95]
  ds_read_b64_tr_b16 a[190:191], v231 offset:58368
  v_mfma_f32_16x16x32_bf16 v[92:95], a[168:171], a[44:47], v[92:95]
  s_waitcnt lgkmcnt(4)
  s_add_u32 m0, s28, 81920
  v_mfma_f32_16x16x32_bf16 v[96:99], a[176:179], a[32:35], v[96:99]
  ds_read_b64_tr_b16 a[160:161], v144 offset:32768
  v_mfma_f32_16x16x32_bf16 v[96:99], a[180:183], a[48:51], v[96:99]
  buffer_load_dwordx4 v238, s[20:23], s31 offen offset:0 lds
  v_mfma_f32_16x16x32_bf16 v[100:103], a[180:183], a[52:55], v[100:103]
  ds_read_b64_tr_b16 a[162:163], v144 offset:33792
  v_mfma_f32_16x16x32_bf16 v[100:103], a[176:179], a[36:39], v[100:103]
  buffer_load_dwordx4 v239, s[20:23], s31 offen offset:1024 lds
  v_mfma_f32_16x16x32_bf16 v[104:107], a[176:179], a[40:43], v[104:107]
  ds_read_b64_tr_b16 a[164:165], v144 offset:40960
  v_mfma_f32_16x16x32_bf16 v[104:107], a[180:183], a[56:59], v[104:107]
  buffer_load_dwordx4 v240, s[20:23], s31 offen offset:2048 lds
  v_mfma_f32_16x16x32_bf16 v[108:111], a[180:183], a[60:63], v[108:111]
  ds_read_b64_tr_b16 a[166:167], v144 offset:41984
  v_mfma_f32_16x16x32_bf16 v[108:111], a[176:179], a[44:47], v[108:111]
  s_waitcnt lgkmcnt(4)
  v_mfma_f32_16x16x32_bf16 v[112:115], a[184:187], a[32:35], v[112:115]
  ds_read_b64_tr_b16 a[168:169], v145 offset:32768
  v_mfma_f32_16x16x32_bf16 v[112:115], a[188:191], a[48:51], v[112:115]
  buffer_load_dwordx4 v241, s[20:23], s31 offen offset:3072 lds
  v_mfma_f32_16x16x32_bf16 v[116:119], a[188:191], a[52:55], v[116:119]
  ds_read_b64_tr_b16 a[170:171], v145 offset:33792
  v_mfma_f32_16x16x32_bf16 v[116:119], a[184:187], a[36:39], v[116:119]
  s_add_u32 s31, s31, 0x80000
  v_mfma_f32_16x16x32_bf16 v[120:123], a[184:187], a[40:43], v[120:123]
  ds_read_b64_tr_b16 a[172:173], v145 offset:40960
  v_mfma_f32_16x16x32_bf16 v[120:123], a[188:191], a[56:59], v[120:123]
  v_mfma_f32_16x16x32_bf16 v[124:127], a[188:191], a[60:63], v[124:127]
  ds_read_b64_tr_b16 a[174:175], v145 offset:41984
  v_mfma_f32_16x16x32_bf16 v[124:127], a[184:187], a[44:47], v[124:127]
  s_waitcnt vmcnt(25) lgkmcnt(4)
  v_mfma_f32_16x16x32_bf16 v[0:3], a[160:163], a[64:67], v[0:3]
  ds_read_b64_tr_b16 a[176:177], v146 offset:32768
  v_mfma_f32_16x16x32_bf16 v[0:3], a[164:167], a[80:83], v[0:3]
  buffer_load_dwordx4 a[32:35], v242, s[24:27], s30 offen offset:0 sc1
  v_mfma_f32_16x16x32_bf16 v[4:7], a[164:167], a[84:87], v[4:7]
  ds_read_b64_tr_b16 a[178:179], v146 offset:33792
  v_mfma_f32_16x16x32_bf16 v[4:7], a[160:163], a[68:71], v[4:7]
  buffer_load_dwordx4 a[36:39], v242, s[24:27], s30 offen offset:1024 sc1
  v_mfma_f32_16x16x32_bf16 v[8:11], a[160:163], a[72:75], v[8:11]
  ds_read_b64_tr_b16 a[180:181], v146 offset:40960
  v_mfma_f32_16x16x32_bf16 v[8:11], a[164:167], a[88:91], v[8:11]
  buffer_load_dwordx4 a[40:43], v242, s[24:27], s30 offen offset:2048 sc1
  v_mfma_f32_16x16x32_bf16 v[12:15], a[164:167], a[92:95], v[12:15]
  ds_read_b64_tr_b16 a[182:183], v146 offset:41984
  v_mfma_f32_16x16x32_bf16 v[12:15], a[160:163], a[76:79], v[12:15]
  s_waitcnt lgkmcnt(4)
  v_mfma_f32_16x16x32_bf16 v[16:19], a[168:171], a[64:67], v[16:19]
  ds_read_b64_tr_b16 a[184:185], v147 offset:32768
  v_mfma_f32_16x16x32_bf16 v[16:19], a[172:175], a[80:83], v[16:19]
  buffer_load_dwordx4 a[44:47], v242, s[24:27], s30 offen offset:3072 sc1
  v_mfma_f32_16x16x32_bf16 v[20:23], a[172:175], a[84:87], v[20:23]
  ds_read_b64_tr_b16 a[186:187], v147 offset:33792
  v_mfma_f32_16x16x32_bf16 v[20:23], a[168:171], a[68:71], v[20:23]
  buffer_load_dwordx4 a[48:51], v243, s[24:27], s30 offen offset:0 sc1
  v_mfma_f32_16x16x32_bf16 v[24:27], a[168:171], a[72:75], v[24:27]
  ds_read_b64_tr_b16 a[188:189], v147 offset:40960
  v_mfma_f32_16x16x32_bf16 v[24:27], a[172:175], a[88:91], v[24:27]
  buffer_load_dwordx4 a[52:55], v243, s[24:27], s30 offen offset:1024 sc1
  v_mfma_f32_16x16x32_bf16 v[28:31], a[172:175], a[92:95], v[28:31]
  ds_read_b64_tr_b16 a[190:191], v147 offset:41984
  v_mfma_f32_16x16x32_bf16 v[28:31], a[168:171], a[76:79], v[28:31]
  s_waitcnt lgkmcnt(4)
  v_mfma_f32_16x16x32_bf16 v[32:35], a[176:179], a[64:67], v[32:35]
  ds_read_b64_tr_b16 a[160:161], v148 offset:32768
  v_mfma_f32_16x16x32_bf16 v[32:35], a[180:183], a[80:83], v[32:35]
  buffer_load_dwordx4 a[56:59], v243, s[24:27], s30 offen offset:2048 sc1
  v_mfma_f32_16x16x32_bf16 v[36:39], a[180:183], a[84:87], v[36:39]
  ds_read_b64_tr_b16 a[162:163], v148 offset:33792
  v_mfma_f32_16x16x32_bf16 v[36:39], a[176:179], a[68:71], v[36:39]
  buffer_load_dwordx4 a[60:63], v243, s[24:27], s30 offen offset:3072 sc1
  v_mfma_f32_16x16x32_bf16 v[40:43], a[176:179], a[72:75], v[40:43]
  ds_read_b64_tr_b16 a[164:165], v148 offset:40960
  v_mfma_f32_16x16x32_bf16 v[40:43], a[180:183], a[88:91], v[40:43]
  s_add_u32 s30, s30, 8192
  v_mfma_f32_16x16x32_bf16 v[44:47], a[180:183], a[92:95], v[44:47]
  ds_read_b64_tr_b16 a[166:167], v148 offset:41984
  v_mfma_f32_16x16x32_bf16 v[44:47], a[176:179], a[76:79], v[44:47]
  s_waitcnt lgkmcnt(4)
  v_mfma_f32_16x16x32_bf16 v[48:51], a[184:187], a[64:67], v[48:51]
  ds_read_b64_tr_b16 a[168:169], v149 offset:32768
  v_mfma_f32_16x16x32_bf16 v[48:51], a[188:191], a[80:83], v[48:51]
  v_mfma_f32_16x16x32_bf16 v[52:55], a[188:191], a[84:87], v[52:55]
  ds_read_b64_tr_b16 a[170:171], v149 offset:33792
  v_mfma_f32_16x16x32_bf16 v[52:55], a[184:187], a[68:71], v[52:55]
  v_mfma_f32_16x16x32_bf16 v[56:59], a[184:187], a[72:75], v[56:59]
  ds_read_b64_tr_b16 a[172:173], v149 offset:40960
  v_mfma_f32_16x16x32_bf16 v[56:59], a[188:191], a[88:91], v[56:59]
  v_mfma_f32_16x16x32_bf16 v[60:63], a[188:191], a[92:95], v[60:63]
  ds_read_b64_tr_b16 a[174:175], v149 offset:41984
  v_mfma_f32_16x16x32_bf16 v[60:63], a[184:187], a[76:79], v[60:63]
  s_waitcnt lgkmcnt(4)
  v_mfma_f32_16x16x32_bf16 v[64:67], a[160:163], a[64:67], v[64:67]
  ds_read_b64_tr_b16 a[176:177], v150 offset:32768
  v_mfma_f32_16x16x32_bf16 v[64:67], a[164:167], a[80:83], v[64:67]
  v_mfma_f32_16x16x32_bf16 v[68:71], a[164:167], a[84:87], v[68:71]
  ds_read_b64_tr_b16 a[178:179], v150 offset:33792
  v_mfma_f32_16x16x32_bf16 v[68:71], a[160:163], a[68:71], v[68:71]
  v_mfma_f32_16x16x32_bf16 v[72:75], a[160:163], a[72:75], v[72:75]
  ds_read_b64_tr_b16 a[180:181], v150 offset:40960
  v_mfma_f32_16x16x32_bf16 v[72:75], a[164:167], a[88:91], v[72:75]
  v_mfma_f32_16x16x32_bf16 v[76:79], a[164:167], a[92:95], v[76:79]
  ds_read_b64_tr_b16 a[182:183], v150 offset:41984
  v_mfma_f32_16x16x32_bf16 v[76:79], a[160:163], a[76:79], v[76:79]
  s_waitcnt lgkmcnt(4)
  v_mfma_f32_16x16x32_bf16 v[80:83], a[168:171], a[64:67], v[80:83]
  ds_read_b64_tr_b16 a[184:185], v151 offset:32768
  v_mfma_f32_16x16x32_bf16 v[80:83], a[172:175], a[80:83], v[80:83]
  v_mfma_f32_16x16x32_bf16 v[84:87], a[172:175], a[84:87], v[84:87]
  ds_read_b64_tr_b16 a[186:187], v151 offset:33792
  v_mfma_f32_16x16x32_bf16 v[84:87], a[168:171], a[68:71], v[84:87]
  v_mfma_f32_16x16x32_bf16 v[88:91], a[168:171], a[72:75], v[88:91]
  ds_read_b64_tr_b16 a[188:189], v151 offset:40960
  v_mfma_f32_16x16x32_bf16 v[88:91], a[172:175], a[88:91], v[88:91]
  s_barrier
  v_mfma_f32_16x16x32_bf16 v[92:95], a[172:175], a[92:95], v[92:95]
  ds_read_b64_tr_b16 a[190:191], v151 offset:41984
  v_mfma_f32_16x16x32_bf16 v[92:95], a[168:171], a[76:79], v[92:95]
  s_waitcnt lgkmcnt(4)
  s_add_u32 m0, s28, 98304
  v_mfma_f32_16x16x32_bf16 v[96:99], a[176:179], a[64:67], v[96:99]
  ds_read_b64_tr_b16 a[160:161], v144 offset:49152
  v_mfma_f32_16x16x32_bf16 v[96:99], a[180:183], a[80:83], v[96:99]
  buffer_load_dwordx4 v238, s[20:23], s31 offen offset:0 lds
  v_mfma_f32_16x16x32_bf16 v[100:103], a[180:183], a[84:87], v[100:103]
  ds_read_b64_tr_b16 a[162:163], v144 offset:50176
  v_mfma_f32_16x16x32_bf16 v[100:103], a[176:179], a[68:71], v[100:103]
  buffer_load_dwordx4 v239, s[20:23], s31 offen offset:1024 lds
  v_mfma_f32_16x16x32_bf16 v[104:107], a[176:179], a[72:75], v[104:107]
  ds_read_b64_tr_b16 a[164:165], v144 offset:57344
  v_mfma_f32_16x16x32_bf16 v[104:107], a[180:183], a[88:91], v[104:107]
  buffer_load_dwordx4 v240, s[20:23], s31 offen offset:2048 lds
  v_mfma_f32_16x16x32_bf16 v[108:111], a[180:183], a[92:95], v[108:111]
  ds_read_b64_tr_b16 a[166:167], v144 offset:58368
  v_mfma_f32_16x16x32_bf16 v[108:111], a[176:179], a[76:79], v[108:111]
  s_waitcnt lgkmcnt(4)
  v_mfma_f32_16x16x32_bf16 v[112:115], a[184:187], a[64:67], v[112:115]
  ds_read_b64_tr_b16 a[168:169], v145 offset:49152
  v_mfma_f32_16x16x32_bf16 v[112:115], a[188:191], a[80:83], v[112:115]
  buffer_load_dwordx4 v241, s[20:23], s31 offen offset:3072 lds
  v_mfma_f32_16x16x32_bf16 v[116:119], a[188:191], a[84:87], v[116:119]
  ds_read_b64_tr_b16 a[170:171], v145 offset:50176
  v_mfma_f32_16x16x32_bf16 v[116:119], a[184:187], a[68:71], v[116:119]
  s_add_u32 s31, s31, 0x80000
  v_mfma_f32_16x16x32_bf16 v[120:123], a[184:187], a[72:75], v[120:123]
  ds_read_b64_tr_b16 a[172:173], v145 offset:57344
  v_mfma_f32_16x16x32_bf16 v[120:123], a[188:191], a[88:91], v[120:123]
  v_mfma_f32_16x16x32_bf16 v[124:127], a[188:191], a[92:95], v[124:127]
  ds_read_b64_tr_b16 a[174:175], v145 offset:58368
  v_mfma_f32_16x16x32_bf16 v[124:127], a[184:187], a[76:79], v[124:127]
  s_waitcnt vmcnt(29) lgkmcnt(4)
  s_waitcnt vmcnt(21)
  v_xor_b32 v136, s55, v136
  v_xor_b32 v137, s55, v137
  v_xor_b32 v138, s55, v138
  v_xor_b32 v139, s55, v139
  v_or3_b32 v136, v136, v137, v138
  v_or_b32 v136, v136, v139
  v_cmp_ne_u32 vcc, 0, v136
  s_nop 0
  s_cbranch_vccz front_keys
  s_mov_b32 s54, 32768
front_all:
  s_sleep 2
  buffer_load_dwordx4 v[136:139], v140, s[24:27], s58 offen sc1
  s_waitcnt vmcnt(0)
  v_xor_b32 v136, s55, v136
  v_xor_b32 v137, s55, v137
  v_xor_b32 v138, s55, v138
  v_xor_b32 v139, s55, v139
  v_or3_b32 v136, v136, v137, v138
  v_or_b32 v136, v136, v139
  v_cmp_ne_u32 vcc, 0, v136
  s_nop 0
  s_cbranch_vccz front_keys
  s_sub_u32 s54, s54, 1
  s_cmp_lg_u32 s54, 0
  s_cbranch_scc1 front_all
front_keys:
  v_mfma_f32_16x16x32_bf16 v[0:3], a[160:163], a[96:99], v[0:3]
  ds_read_b64_tr_b16 a[176:177], v146 offset:49152
  s_lshl_b32 s35, s3, 11
  s_add_u32 s35, s35, 2621440
  buffer_load_dwordx4 v[128:131], v242, s[24:27], s35 offen sc1
  v_mfma_f32_16x16x32_bf16 v[0:3], a[164:167], a[112:115], v[0:3]
  buffer_load_dwordx4 a[64:67], v242, s[24:27], s30 offen offset:0 sc1
  v_mfma_f32_16x16x32_bf16 v[4:7], a[164:167], a[116:119], v[4:7]
  ds_read_b64_tr_b16 a[178:179], v146 offset:50176
  buffer_load_dwordx4 v[132:135], v242, s[24:27], s35 offen offset:1024 sc1
  s_add_u32 s59, s59, 1
  s_or_b32 s54, s2, s3
  s_min_u32 s54, s54, 1
  s_lshl_b32 s54, s54, 28
  v_mfma_f32_16x16x32_bf16 v[4:7], a[160:163], a[100:103], v[4:7]
  buffer_load_dwordx4 a[68:71], v242, s[24:27], s30 offen offset:1024 sc1
  v_mfma_f32_16x16x32_bf16 v[8:11], a[160:163], a[104:107], v[8:11]
  ds_read_b64_tr_b16 a[180:181], v146 offset:57344
  v_lshlrev_b32 v137, 22, v242
  v_mfma_f32_16x16x32_bf16 v[8:11], a[164:167], a[120:123], v[8:11]
  buffer_load_dwordx4 a[72:75], v242, s[24:27], s30 offen offset:2048 sc1
  v_mfma_f32_16x16x32_bf16 v[12:15], a[164:167], a[124:127], v[12:15]
  ds_read_b64_tr_b16 a[182:183], v146 offset:58368
  v_or_b32 v137, s54, v137
  v_mfma_f32_16x16x32_bf16 v[12:15], a[160:163], a[108:111], v[12:15]
  s_waitcnt lgkmcnt(4)
  v_mov_b32 v136, s59
  v_mfma_f32_16x16x32_bf16 v[16:19], a[168:171], a[96:99], v[16:19]
  ds_read_b64_tr_b16 a[184:185], v147 offset:49152
  s_mov_b32 s58, 2830336
  buffer_store_dword v136, v137, s[24:27], s58 offen sc1
  v_mfma_f32_16x16x32_bf16 v[16:19], a[172:175], a[112:115], v[16:19]
  buffer_load_dwordx4 a[76:79], v242, s[24:27], s30 offen offset:3072 sc1
  v_mfma_f32_16x16x32_bf16 v[20:23], a[172:175], a[116:119], v[20:23]
  ds_read_b64_tr_b16 a[186:187], v147 offset:50176
  v_mfma_f32_16x16x32_bf16 v[20:23], a[168:171], a[100:103], v[20:23]
  buffer_load_dwordx4 a[80:83], v243, s[24:27], s30 offen offset:0 sc1
  v_mfma_f32_16x16x32_bf16 v[24:27], a[168:171], a[104:107], v[24:27]
  ds_read_b64_tr_b16 a[188:189], v147 offset:57344
  v_mfma_f32_16x16x32_bf16 v[24:27], a[172:175], a[120:123], v[24:27]
  buffer_load_dwordx4 a[84:87], v243, s[24:27], s30 offen offset:1024 sc1
  v_mfma_f32_16x16x32_bf16 v[28:31], a[172:175], a[124:127], v[28:31]
  ds_read_b64_tr_b16 a[190:191], v147 offset:58368
  v_mfma_f32_16x16x32_bf16 v[28:31], a[168:171], a[108:111], v[28:31]
  s_waitcnt lgkmcnt(4)
  v_mfma_f32_16x16x32_bf16 v[32:35], a[176:179], a[96:99], v[32:35]
  ds_read_b64_tr_b16 a[160:161], v148 offset:49152
  v_mfma_f32_16x16x32_bf16 v[32:35], a[180:183], a[112:115], v[32:35]
  buffer_load_dwordx4 a[88:91], v243, s[24:27], s30 offen offset:2048 sc1
  v_mfma_f32_16x16x32_bf16 v[36:39], a[180:183], a[116:119], v[36:39]
  ds_read_b64_tr_b16 a[162:163], v148 offset:50176
  v_mfma_f32_16x16x32_bf16 v[36:39], a[176:179], a[100:103], v[36:39]
  buffer_load_dwordx4 a[92:95], v243, s[24:27], s30 offen offset:3072 sc1
  v_mfma_f32_16x16x32_bf16 v[40:43], a[176:179], a[104:107], v[40:43]
  ds_read_b64_tr_b16 a[164:165], v148 offset:57344
  v_mfma_f32_16x16x32_bf16 v[40:43], a[180:183], a[120:123], v[40:43]
  s_add_u32 s30, s30, 8192
  v_mfma_f32_16x16x32_bf16 v[44:47], a[180:183], a[124:127], v[44:47]
  ds_read_b64_tr_b16 a[166:167], v148 offset:58368
  v_mfma_f32_16x16x32_bf16 v[44:47], a[176:179], a[108:111], v[44:47]
  s_waitcnt lgkmcnt(4)
  v_mfma_f32_16x16x32_bf16 v[48:51], a[184:187], a[96:99], v[48:51]
  ds_read_b64_tr_b16 a[168:169], v149 offset:49152
  v_mfma_f32_16x16x32_bf16 v[48:51], a[188:191], a[112:115], v[48:51]
  v_mfma_f32_16x16x32_bf16 v[52:55], a[188:191], a[116:119], v[52:55]
  ds_read_b64_tr_b16 a[170:171], v149 offset:50176
  v_mfma_f32_16x16x32_bf16 v[52:55], a[184:187], a[100:103], v[52:55]
  v_mfma_f32_16x16x32_bf16 v[56:59], a[184:187], a[104:107], v[56:59]
  ds_read_b64_tr_b16 a[172:173], v149 offset:57344
  v_mfma_f32_16x16x32_bf16 v[56:59], a[188:191], a[120:123], v[56:59]
  v_mfma_f32_16x16x32_bf16 v[60:63], a[188:191], a[124:127], v[60:63]
  ds_read_b64_tr_b16 a[174:175], v149 offset:58368
  v_mfma_f32_16x16x32_bf16 v[60:63], a[184:187], a[108:111], v[60:63]
  s_waitcnt lgkmcnt(4)
  v_mfma_f32_16x16x32_bf16 v[64:67], a[160:163], a[96:99], v[64:67]
  ds_read_b64_tr_b16 a[176:177], v150 offset:49152
  v_mfma_f32_16x16x32_bf16 v[64:67], a[164:167], a[112:115], v[64:67]
  v_mfma_f32_16x16x32_bf16 v[68:71], a[164:167], a[116:119], v[68:71]
  ds_read_b64_tr_b16 a[178:179], v150 offset:50176
  v_mfma_f32_16x16x32_bf16 v[68:71], a[160:163], a[100:103], v[68:71]
  v_mfma_f32_16x16x32_bf16 v[72:75], a[160:163], a[104:107], v[72:75]
  ds_read_b64_tr_b16 a[180:181], v150 offset:57344
  v_mfma_f32_16x16x32_bf16 v[72:75], a[164:167], a[120:123], v[72:75]
  v_mfma_f32_16x16x32_bf16 v[76:79], a[164:167], a[124:127], v[76:79]
  ds_read_b64_tr_b16 a[182:183], v150 offset:58368
  v_mfma_f32_16x16x32_bf16 v[76:79], a[160:163], a[108:111], v[76:79]
  s_waitcnt lgkmcnt(4)
  v_mfma_f32_16x16x32_bf16 v[80:83], a[168:171], a[96:99], v[80:83]
  ds_read_b64_tr_b16 a[184:185], v151 offset:49152
  v_mfma_f32_16x16x32_bf16 v[80:83], a[172:175], a[112:115], v[80:83]
  v_mfma_f32_16x16x32_bf16 v[84:87], a[172:175], a[116:119], v[84:87]
  ds_read_b64_tr_b16 a[186:187], v151 offset:50176
  v_mfma_f32_16x16x32_bf16 v[84:87], a[168:171], a[100:103], v[84:87]
  v_mfma_f32_16x16x32_bf16 v[88:91], a[168:171], a[104:107], v[88:91]
  ds_read_b64_tr_b16 a[188:189], v151 offset:57344
  v_mfma_f32_16x16x32_bf16 v[88:91], a[172:175], a[120:123], v[88:91]
  s_barrier
  v_mfma_f32_16x16x32_bf16 v[92:95], a[172:175], a[124:127], v[92:95]
  ds_read_b64_tr_b16 a[190:191], v151 offset:58368
  v_mfma_f32_16x16x32_bf16 v[92:95], a[168:171], a[108:111], v[92:95]
  s_waitcnt lgkmcnt(4)
  s_add_u32 m0, s28, 114688
  v_mfma_f32_16x16x32_bf16 v[96:99], a[176:179], a[96:99], v[96:99]
  ds_read_b64_tr_b16 a[160:161], v144 offset:16384
  v_mfma_f32_16x16x32_bf16 v[96:99], a[180:183], a[112:115], v[96:99]
  buffer_load_dwordx4 v238, s[20:23], s31 offen offset:0 lds
  v_mfma_f32_16x16x32_bf16 v[100:103], a[180:183], a[116:119], v[100:103]
  ds_read_b64_tr_b16 a[162:163], v144 offset:17408
  v_mfma_f32_16x16x32_bf16 v[100:103], a[176:179], a[100:103], v[100:103]
  buffer_load_dwordx4 v239, s[20:23], s31 offen offset:1024 lds
  v_mfma_f32_16x16x32_bf16 v[104:107], a[176:179], a[104:107], v[104:107]
  ds_read_b64_tr_b16 a[164:165], v144 offset:24576
  v_mfma_f32_16x16x32_bf16 v[104:107], a[180:183], a[120:123], v[104:107]
  buffer_load_dwordx4 v240, s[20:23], s31 offen offset:2048 lds
  v_mfma_f32_16x16x32_bf16 v[108:111], a[180:183], a[124:127], v[108:111]
  ds_read_b64_tr_b16 a[166:167], v144 offset:25600
  v_mfma_f32_16x16x32_bf16 v[108:111], a[176:179], a[108:111], v[108:111]
  s_waitcnt lgkmcnt(4)
  v_mfma_f32_16x16x32_bf16 v[112:115], a[184:187], a[96:99], v[112:115]
  ds_read_b64_tr_b16 a[168:169], v145 offset:16384
  v_mfma_f32_16x16x32_bf16 v[112:115], a[188:191], a[112:115], v[112:115]
  buffer_load_dwordx4 v241, s[20:23], s31 offen offset:3072 lds
  v_mfma_f32_16x16x32_bf16 v[116:119], a[188:191], a[116:119], v[116:119]
  ds_read_b64_tr_b16 a[170:171], v145 offset:17408
  v_mfma_f32_16x16x32_bf16 v[116:119], a[184:187], a[100:103], v[116:119]
  s_add_u32 s31, s31, 0x80000
  v_mfma_f32_16x16x32_bf16 v[120:123], a[184:187], a[104:107], v[120:123]
  ds_read_b64_tr_b16 a[172:173], v145 offset:24576
  v_mfma_f32_16x16x32_bf16 v[120:123], a[188:191], a[120:123], v[120:123]
  v_mfma_f32_16x16x32_bf16 v[124:127], a[188:191], a[124:127], v[124:127]
  ds_read_b64_tr_b16 a[174:175], v145 offset:25600
  v_mfma_f32_16x16x32_bf16 v[124:127], a[184:187], a[108:111], v[124:127]
  s_waitcnt vmcnt(31) lgkmcnt(4)
  v_mfma_f32_16x16x32_bf16 v[0:3], a[160:163], a[0:3], v[0:3]
  ds_read_b64_tr_b16 a[176:177], v146 offset:16384
  s_waitcnt vmcnt(12)
  s_mov_b32 s51, -1
  v_sub_u32 v137, s51, v128
  v_mfma_f32_16x16x32_bf16 v[0:3], a[164:167], a[16:19], v[0:3]
  buffer_load_dwordx4 a[96:99], v242, s[24:27], s30 offen offset:0 sc1
  v_mfma_f32_16x16x32_bf16 v[4:7], a[164:167], a[20:23], v[4:7]
  ds_read_b64_tr_b16 a[178:179], v146 offset:17408
  v_sub_u32 v138, s51, v129
  v_mfma_f32_16x16x32_bf16 v[4:7], a[160:163], a[4:7], v[4:7]
  buffer_load_dwordx4 a[100:103], v242, s[24:27], s30 offen offset:1024 sc1
  v_mfma_f32_16x16x32_bf16 v[8:11], a[160:163], a[8:11], v[8:11]
  ds_read_b64_tr_b16 a[180:181], v146 offset:24576
  v_min_u32 v136, v137, v138
  v_mfma_f32_16x16x32_bf16 v[8:11], a[164:167], a[24:27], v[8:11]
  buffer_load_dwordx4 a[104:107], v242, s[24:27], s30 offen offset:2048 sc1
  v_mfma_f32_16x16x32_bf16 v[12:15], a[164:167], a[28:31], v[12:15]
  ds_read_b64_tr_b16 a[182:183], v146 offset:25600
  v_sub_u32 v139, s51, v130
  v_mfma_f32_16x16x32_bf16 v[12:15], a[160:163], a[12:15], v[12:15]
  s_waitcnt lgkmcnt(4)
  v_sub_u32 v140, s51, v131
  v_min3_u32 v136, v136, v139, v140
  v_mfma_f32_16x16x32_bf16 v[16:19], a[168:171], a[0:3], v[16:19]
  ds_read_b64_tr_b16 a[184:185], v147 offset:16384
  v_sub_u32 v137, s51, v132
  v_mfma_f32_16x16x32_bf16 v[16:19], a[172:175], a[16:19], v[16:19]
  buffer_load_dwordx4 a[108:111], v242, s[24:27], s30 offen offset:3072 sc1
  v_mfma_f32_16x16x32_bf16 v[20:23], a[172:175], a[20:23], v[20:23]
  ds_read_b64_tr_b16 a[186:187], v147 offset:17408
  v_sub_u32 v138, s51, v133
  v_mfma_f32_16x16x32_bf16 v[20:23], a[168:171], a[4:7], v[20:23]
  buffer_load_dwordx4 a[112:115], v243, s[24:27], s30 offen offset:0 sc1
  v_mfma_f32_16x16x32_bf16 v[24:27], a[168:171], a[8:11], v[24:27]
  ds_read_b64_tr_b16 a[188:189], v147 offset:24576
  v_min3_u32 v136, v136, v137, v138
  v_mfma_f32_16x16x32_bf16 v[24:27], a[172:175], a[24:27], v[24:27]
  buffer_load_dwordx4 a[116:119], v243, s[24:27], s30 offen offset:1024 sc1
  v_mfma_f32_16x16x32_bf16 v[28:31], a[172:175], a[28:31], v[28:31]
  ds_read_b64_tr_b16 a[190:191], v147 offset:25600
  v_sub_u32 v139, s51, v134
  v_mfma_f32_16x16x32_bf16 v[28:31], a[168:171], a[12:15], v[28:31]
  s_waitcnt lgkmcnt(4)
  v_sub_u32 v140, s51, v135
  v_min3_u32 v136, v136, v139, v140
  v_mfma_f32_16x16x32_bf16 v[32:35], a[176:179], a[0:3], v[32:35]
  ds_read_b64_tr_b16 a[160:161], v148 offset:16384
  v_min_u32_dpp v136, v136, v136 row_ror:8 row_mask:0xf bank_mask:0xf
  v_mfma_f32_16x16x32_bf16 v[32:35], a[180:183], a[16:19], v[32:35]
  buffer_load_dwordx4 a[120:123], v243, s[24:27], s30 offen offset:2048 sc1
  v_mfma_f32_16x16x32_bf16 v[36:39], a[180:183], a[20:23], v[36:39]
  ds_read_b64_tr_b16 a[162:163], v148 offset:17408
  v_min_u32_dpp v136, v136, v136 row_ror:4 row_mask:0xf bank_mask:0xf
  v_mfma_f32_16x16x32_bf16 v[36:39], a[176:179], a[4:7], v[36:39]
  buffer_load_dwordx4 a[124:127], v243, s[24:27], s30 offen offset:3072 sc1
  v_mfma_f32_16x16x32_bf16 v[40:43], a[176:179], a[8:11], v[40:43]
  ds_read_b64_tr_b16 a[164:165], v148 offset:24576
  v_min_u32_dpp v136, v136, v136 row_ror:2 row_mask:0xf bank_mask:0xf
  v_mfma_f32_16x16x32_bf16 v[40:43], a[180:183], a[24:27], v[40:43]
  s_add_u32 s30, s30, 8192
  v_min_u32_dpp v136, v136, v136 row_ror:1 row_mask:0xf bank_mask:0xf
  v_mfma_f32_16x16x32_bf16 v[44:47], a[180:183], a[28:31], v[44:47]
  ds_read_b64_tr_b16 a[166:167], v148 offset:25600
  v_readlane_b32 s98, v136, 0
  v_mfma_f32_16x16x32_bf16 v[44:47], a[176:179], a[12:15], v[44:47]
  s_waitcnt lgkmcnt(4)
  v_readlane_b32 s99, v136, 16
  v_readlane_b32 s100, v136, 32
  v_mfma_f32_16x16x32_bf16 v[48:51], a[184:187], a[0:3], v[48:51]
  ds_read_b64_tr_b16 a[168:169], v149 offset:16384
  v_readlane_b32 s101, v136, 48
  v_mfma_f32_16x16x32_bf16 v[48:51], a[188:191], a[16:19], v[48:51]
  s_min_u32 s98, s98, s99
  s_min_u32 s100, s100, s101
  s_min_u32 s98, s98, s100
  s_sub_u32 s52, s51, s98
  s_sub_u32 s51, s52, 1
  v_sub_u32 v137, s51, v128
  v_sub_u32 v138, s51, v129
  v_mfma_f32_16x16x32_bf16 v[52:55], a[188:191], a[20:23], v[52:55]
  ds_read_b64_tr_b16 a[170:171], v149 offset:17408
  v_min_u32 v136, v137, v138
  v_mfma_f32_16x16x32_bf16 v[52:55], a[184:187], a[4:7], v[52:55]
  v_sub_u32 v139, s51, v130
  v_sub_u32 v140, s51, v131
  v_mfma_f32_16x16x32_bf16 v[56:59], a[184:187], a[8:11], v[56:59]
  ds_read_b64_tr_b16 a[172:173], v149 offset:24576
  v_min3_u32 v136, v136, v139, v140
  v_mfma_f32_16x16x32_bf16 v[56:59], a[188:191], a[24:27], v[56:59]
  v_sub_u32 v137, s51, v132
  v_sub_u32 v138, s51, v133
  v_mfma_f32_16x16x32_bf16 v[60:63], a[188:191], a[28:31], v[60:63]
  ds_read_b64_tr_b16 a[174:175], v149 offset:25600
  v_min3_u32 v136, v136, v137, v138
  v_mfma_f32_16x16x32_bf16 v[60:63], a[184:187], a[12:15], v[60:63]
  s_waitcnt lgkmcnt(4)
  v_sub_u32 v139, s51, v134
  v_sub_u32 v140, s51, v135
  v_mfma_f32_16x16x32_bf16 v[64:67], a[160:163], a[0:3], v[64:67]
  ds_read_b64_tr_b16 a[176:177], v150 offset:16384
  v_min3_u32 v136, v136, v139, v140
  v_mfma_f32_16x16x32_bf16 v[64:67], a[164:167], a[16:19], v[64:67]
  v_mfma_f32_16x16x32_bf16 v[68:71], a[164:167], a[20:23], v[68:71]
  ds_read_b64_tr_b16 a[178:179], v150 offset:17408
  v_min_u32_dpp v136, v136, v136 row_ror:8 row_mask:0xf bank_mask:0xf
  v_mfma_f32_16x16x32_bf16 v[68:71], a[160:163], a[4:7], v[68:71]
  v_mfma_f32_16x16x32_bf16 v[72:75], a[160:163], a[8:11], v[72:75]
  ds_read_b64_tr_b16 a[180:181], v150 offset:24576
  v_min_u32_dpp v136, v136, v136 row_ror:4 row_mask:0xf bank_mask:0xf
  v_mfma_f32_16x16x32_bf16 v[72:75], a[164:167], a[24:27], v[72:75]
  v_mfma_f32_16x16x32_bf16 v[76:79], a[164:167], a[28:31], v[76:79]
  ds_read_b64_tr_b16 a[182:183], v150 offset:25600
  v_min_u32_dpp v136, v136, v136 row_ror:2 row_mask:0xf bank_mask:0xf
  v_mfma_f32_16x16x32_bf16 v[76:79], a[160:163], a[12:15], v[76:79]
  s_waitcnt lgkmcnt(4)
  v_min_u32_dpp v136, v136, v136 row_ror:1 row_mask:0xf bank_mask:0xf
  v_mfma_f32_16x16x32_bf16 v[80:83], a[168:171], a[0:3], v[80:83]
  ds_read_b64_tr_b16 a[184:185], v151 offset:16384
  v_readlane_b32 s98, v136, 0
  v_mfma_f32_16x16x32_bf16 v[80:83], a[172:175], a[16:19], v[80:83]
  v_readlane_b32 s99, v136, 16
  v_readlane_b32 s100, v136, 32
  v_mfma_f32_16x16x32_bf16 v[84:87], a[172:175], a[20:23], v[84:87]
  ds_read_b64_tr_b16 a[186:187], v151 offset:17408
  v_readlane_b32 s101, v136, 48
  v_mfma_f32_16x16x32_bf16 v[84:87], a[168:171], a[4:7], v[84:87]
  s_min_u32 s98, s98, s99
  s_min_u32 s100, s100, s101
  s_min_u32 s98, s98, s100
  s_sub_u32 s53, s51, s98
  s_sub_u32 s51, s53, 1
  v_sub_u32 v137, s51, v128
  v_sub_u32 v138, s51, v129
  v_mfma_f32_16x16x32_bf16 v[88:91], a[168:171], a[8:11], v[88:91]
  ds_read_b64_tr_b16 a[188:189], v151 offset:24576
  v_min_u32 v136, v137, v138
  v_mfma_f32_16x16x32_bf16 v[88:91], a[172:175], a[24:27], v[88:91]
  s_barrier
  v_sub_u32 v139, s51, v130
  v_sub_u32 v140, s51, v131
  v_mfma_f32_16x16x32_bf16 v[92:95], a[172:175], a[28:31], v[92:95]
  ds_read_b64_tr_b16 a[190:191], v151 offset:25600
  v_min3_u32 v136, v136, v139, v140
  v_mfma_f32_16x16x32_bf16 v[92:95], a[168:171], a[12:15], v[92:95]
  s_waitcnt lgkmcnt(4)
  v_sub_u32 v137, s51, v132
  v_sub_u32 v138, s51, v133
  v_mfma_f32_16x16x32_bf16 v[96:99], a[176:179], a[0:3], v[96:99]
  ds_read_b64_tr_b16 a[160:161], v144 offset:0
  v_min3_u32 v136, v136, v137, v138
  v_mfma_f32_16x16x32_bf16 v[96:99], a[180:183], a[16:19], v[96:99]
  v_sub_u32 v139, s51, v134
  v_sub_u32 v140, s51, v135
  v_mfma_f32_16x16x32_bf16 v[100:103], a[180:183], a[20:23], v[100:103]
  ds_read_b64_tr_b16 a[162:163], v144 offset:1024
  v_min3_u32 v136, v136, v139, v140
  v_mfma_f32_16x16x32_bf16 v[100:103], a[176:179], a[4:7], v[100:103]
  v_mfma_f32_16x16x32_bf16 v[104:107], a[176:179], a[8:11], v[104:107]
  ds_read_b64_tr_b16 a[164:165], v144 offset:8192
  v_min_u32_dpp v136, v136, v136 row_ror:8 row_mask:0xf bank_mask:0xf
  v_mfma_f32_16x16x32_bf16 v[104:107], a[180:183], a[24:27], v[104:107]
  v_mfma_f32_16x16x32_bf16 v[108:111], a[180:183], a[28:31], v[108:111]
  ds_read_b64_tr_b16 a[166:167], v144 offset:9216
  v_min_u32_dpp v136, v136, v136 row_ror:4 row_mask:0xf bank_mask:0xf
  v_mfma_f32_16x16x32_bf16 v[108:111], a[176:179], a[12:15], v[108:111]
  s_waitcnt lgkmcnt(4)
  v_min_u32_dpp v136, v136, v136 row_ror:2 row_mask:0xf bank_mask:0xf
  v_mfma_f32_16x16x32_bf16 v[112:115], a[184:187], a[0:3], v[112:115]
  ds_read_b64_tr_b16 a[168:169], v145 offset:0
  v_min_u32_dpp v136, v136, v136 row_ror:1 row_mask:0xf bank_mask:0xf
  v_mfma_f32_16x16x32_bf16 v[112:115], a[188:191], a[16:19], v[112:115]
  v_readlane_b32 s98, v136, 0
  v_readlane_b32 s99, v136, 16
  v_mfma_f32_16x16x32_bf16 v[116:119], a[188:191], a[20:23], v[116:119]
  ds_read_b64_tr_b16 a[170:171], v145 offset:1024
  v_readlane_b32 s100, v136, 32
  v_mfma_f32_16x16x32_bf16 v[116:119], a[184:187], a[4:7], v[116:119]
  v_readlane_b32 s101, v136, 48
  v_mfma_f32_16x16x32_bf16 v[120:123], a[184:187], a[8:11], v[120:123]
  ds_read_b64_tr_b16 a[172:173], v145 offset:8192
  s_min_u32 s98, s98, s99
  s_min_u32 s100, s100, s101
  s_min_u32 s98, s98, s100
  s_sub_u32 s54, s51, s98
  s_sub_u32 s51, s54, 1
  v_sub_u32 v137, s51, v128
  v_mfma_f32_16x16x32_bf16 v[120:123], a[188:191], a[24:27], v[120:123]
  v_sub_u32 v138, s51, v129
  v_min_u32 v136, v137, v138
  v_mfma_f32_16x16x32_bf16 v[124:127], a[188:191], a[28:31], v[124:127]
  ds_read_b64_tr_b16 a[174:175], v145 offset:9216
  v_sub_u32 v139, s51, v130
  v_mfma_f32_16x16x32_bf16 v[124:127], a[184:187], a[12:15], v[124:127]
  s_waitcnt lgkmcnt(4)
  v_sub_u32 v140, s51, v131
  v_min3_u32 v136, v136, v139, v140
  v_mfma_f32_16x16x32_bf16 v[0:3], a[160:163], a[32:35], v[0:3]
  ds_read_b64_tr_b16 a[176:177], v146 offset:0
  v_sub_u32 v137, s51, v132
  v_mfma_f32_16x16x32_bf16 v[0:3], a[164:167], a[48:51], v[0:3]
  buffer_load_dwordx4 a[0:3], v242, s[24:27], s30 offen offset:0 sc1
  v_mfma_f32_16x16x32_bf16 v[4:7], a[164:167], a[52:55], v[4:7]
  ds_read_b64_tr_b16 a[178:179], v146 offset:1024
  v_sub_u32 v138, s51, v133
  v_mfma_f32_16x16x32_bf16 v[4:7], a[160:163], a[36:39], v[4:7]
  buffer_load_dwordx4 a[4:7], v242, s[24:27], s30 offen offset:1024 sc1
  v_mfma_f32_16x16x32_bf16 v[8:11], a[160:163], a[40:43], v[8:11]
  ds_read_b64_tr_b16 a[180:181], v146 offset:8192
  v_min3_u32 v136, v136, v137, v138
  v_mfma_f32_16x16x32_bf16 v[8:11], a[164:167], a[56:59], v[8:11]
  buffer_load_dwordx4 a[8:11], v242, s[24:27], s30 offen offset:2048 sc1
  v_mfma_f32_16x16x32_bf16 v[12:15], a[164:167], a[60:63], v[12:15]
  ds_read_b64_tr_b16 a[182:183], v146 offset:9216
  v_sub_u32 v139, s51, v134
  v_mfma_f32_16x16x32_bf16 v[12:15], a[160:163], a[44:47], v[12:15]
  s_waitcnt lgkmcnt(4)
  v_sub_u32 v140, s51, v135
  v_min3_u32 v136, v136, v139, v140
  v_mfma_f32_16x16x32_bf16 v[16:19], a[168:171], a[32:35], v[16:19]
  ds_read_b64_tr_b16 a[184:185], v147 offset:0
  v_min_u32_dpp v136, v136, v136 row_ror:8 row_mask:0xf bank_mask:0xf
  v_mfma_f32_16x16x32_bf16 v[16:19], a[172:175], a[48:51], v[16:19]
  buffer_load_dwordx4 a[12:15], v242, s[24:27], s30 offen offset:3072 sc1
  v_mfma_f32_16x16x32_bf16 v[20:23], a[172:175], a[52:55], v[20:23]
  ds_read_b64_tr_b16 a[186:187], v147 offset:1024
  v_min_u32_dpp v136, v136, v136 row_ror:4 row_mask:0xf bank_mask:0xf
  v_mfma_f32_16x16x32_bf16 v[20:23], a[168:171], a[36:39], v[20:23]
  buffer_load_dwordx4 a[16:19], v243, s[24:27], s30 offen offset:0 sc1
  v_mfma_f32_16x16x32_bf16 v[24:27], a[168:171], a[40:43], v[24:27]
  ds_read_b64_tr_b16 a[188:189], v147 offset:8192
  v_min_u32_dpp v136, v136, v136 row_ror:2 row_mask:0xf bank_mask:0xf
  v_mfma_f32_16x16x32_bf16 v[24:27], a[172:175], a[56:59], v[24:27]
  buffer_load_dwordx4 a[20:23], v243, s[24:27], s30 offen offset:1024 sc1
  v_mfma_f32_16x16x32_bf16 v[28:31], a[172:175], a[60:63], v[28:31]
  ds_read_b64_tr_b16 a[190:191], v147 offset:9216
  v_min_u32_dpp v136, v136, v136 row_ror:1 row_mask:0xf bank_mask:0xf
  v_mfma_f32_16x16x32_bf16 v[28:31], a[168:171], a[44:47], v[28:31]
  s_waitcnt lgkmcnt(4)
  v_readlane_b32 s98, v136, 0
  v_readlane_b32 s99, v136, 16
  v_mfma_f32_16x16x32_bf16 v[32:35], a[176:179], a[32:35], v[32:35]
  ds_read_b64_tr_b16 a[160:161], v148 offset:0
  v_readlane_b32 s100, v136, 32
  v_mfma_f32_16x16x32_bf16 v[32:35], a[180:183], a[48:51], v[32:35]
  buffer_load_dwordx4 a[24:27], v243, s[24:27], s30 offen offset:2048 sc1
  v_mfma_f32_16x16x32_bf16 v[36:39], a[180:183], a[52:55], v[36:39]
  ds_read_b64_tr_b16 a[162:163], v148 offset:1024
  v_readlane_b32 s101, v136, 48
  v_mfma_f32_16x16x32_bf16 v[36:39], a[176:179], a[36:39], v[36:39]
  buffer_load_dwordx4 a[28:31], v243, s[24:27], s30 offen offset:3072 sc1
  s_min_u32 s98, s98, s99
  s_min_u32 s100, s100, s101
  s_min_u32 s98, s98, s100
  s_sub_u32 s55, s51, s98
  s_sub_u32 s51, s55, 1
  v_mfma_f32_16x16x32_bf16 v[40:43], a[176:179], a[40:43], v[40:43]
  ds_read_b64_tr_b16 a[164:165], v148 offset:8192
  v_sub_u32 v137, s51, v128
  v_mfma_f32_16x16x32_bf16 v[40:43], a[180:183], a[56:59], v[40:43]
  s_add_u32 s30, s30, 8192
  v_sub_u32 v138, s51, v129
  v_min_u32 v136, v137, v138
  v_mfma_f32_16x16x32_bf16 v[44:47], a[180:183], a[60:63], v[44:47]
  ds_read_b64_tr_b16 a[166:167], v148 offset:9216
  v_sub_u32 v139, s51, v130
  v_mfma_f32_16x16x32_bf16 v[44:47], a[176:179], a[44:47], v[44:47]
  s_waitcnt lgkmcnt(4)
  v_sub_u32 v140, s51, v131
  v_min3_u32 v136, v136, v139, v140
  v_mfma_f32_16x16x32_bf16 v[48:51], a[184:187], a[32:35], v[48:51]
  ds_read_b64_tr_b16 a[168:169], v149 offset:0
  v_sub_u32 v137, s51, v132
  v_mfma_f32_16x16x32_bf16 v[48:51], a[188:191], a[48:51], v[48:51]
  v_sub_u32 v138, s51, v133
  v_min3_u32 v136, v136, v137, v138
  v_mfma_f32_16x16x32_bf16 v[52:55], a[188:191], a[52:55], v[52:55]
  ds_read_b64_tr_b16 a[170:171], v149 offset:1024
  v_sub_u32 v139, s51, v134
  v_mfma_f32_16x16x32_bf16 v[52:55], a[184:187], a[36:39], v[52:55]
  v_sub_u32 v140, s51, v135
  v_min3_u32 v136, v136, v139, v140
  v_mfma_f32_16x16x32_bf16 v[56:59], a[184:187], a[40:43], v[56:59]
  ds_read_b64_tr_b16 a[172:173], v149 offset:8192
  v_min_u32_dpp v136, v136, v136 row_ror:8 row_mask:0xf bank_mask:0xf
  v_mfma_f32_16x16x32_bf16 v[56:59], a[188:191], a[56:59], v[56:59]
  v_mfma_f32_16x16x32_bf16 v[60:63], a[188:191], a[60:63], v[60:63]
  ds_read_b64_tr_b16 a[174:175], v149 offset:9216
  v_min_u32_dpp v136, v136, v136 row_ror:4 row_mask:0xf bank_mask:0xf
  v_mfma_f32_16x16x32_bf16 v[60:63], a[184:187], a[44:47], v[60:63]
  s_waitcnt lgkmcnt(4)
  v_min_u32_dpp v136, v136, v136 row_ror:2 row_mask:0xf bank_mask:0xf
  v_mfma_f32_16x16x32_bf16 v[64:67], a[160:163], a[32:35], v[64:67]
  ds_read_b64_tr_b16 a[176:177], v150 offset:0
  v_min_u32_dpp v136, v136, v136 row_ror:1 row_mask:0xf bank_mask:0xf
  v_mfma_f32_16x16x32_bf16 v[64:67], a[164:167], a[48:51], v[64:67]
  v_readlane_b32 s98, v136, 0
  v_readlane_b32 s99, v136, 16
  v_mfma_f32_16x16x32_bf16 v[68:71], a[164:167], a[52:55], v[68:71]
  ds_read_b64_tr_b16 a[178:179], v150 offset:1024
  v_readlane_b32 s100, v136, 32
  v_mfma_f32_16x16x32_bf16 v[68:71], a[160:163], a[36:39], v[68:71]
  v_readlane_b32 s101, v136, 48
  v_mfma_f32_16x16x32_bf16 v[72:75], a[160:163], a[40:43], v[72:75]
  ds_read_b64_tr_b16 a[180:181], v150 offset:8192
  s_min_u32 s98, s98, s99
  s_min_u32 s100, s100, s101
  s_min_u32 s98, s98, s100
  s_sub_u32 s56, s51, s98
  s_sub_u32 s51, s56, 1
  v_sub_u32 v137, s51, v128
  v_mfma_f32_16x16x32_bf16 v[72:75], a[164:167], a[56:59], v[72:75]
  v_sub_u32 v138, s51, v129
  v_min_u32 v136, v137, v138
  v_mfma_f32_16x16x32_bf16 v[76:79], a[164:167], a[60:63], v[76:79]
  ds_read_b64_tr_b16 a[182:183], v150 offset:9216
  v_sub_u32 v139, s51, v130
  v_mfma_f32_16x16x32_bf16 v[76:79], a[160:163], a[44:47], v[76:79]
  s_waitcnt lgkmcnt(4)
  v_sub_u32 v140, s51, v131
  v_min3_u32 v136, v136, v139, v140
  v_mfma_f32_16x16x32_bf16 v[80:83], a[168:171], a[32:35], v[80:83]
  ds_read_b64_tr_b16 a[184:185], v151 offset:0
  v_sub_u32 v137, s51, v132
  v_mfma_f32_16x16x32_bf16 v[80:83], a[172:175], a[48:51], v[80:83]
  v_sub_u32 v138, s51, v133
  v_min3_u32 v136, v136, v137, v138
  v_mfma_f32_16x16x32_bf16 v[84:87], a[172:175], a[52:55], v[84:87]
  ds_read_b64_tr_b16 a[186:187], v151 offset:1024
  v_sub_u32 v139, s51, v134
  v_mfma_f32_16x16x32_bf16 v[84:87], a[168:171], a[36:39], v[84:87]
  v_sub_u32 v140, s51, v135
  v_min3_u32 v136, v136, v139, v140
  v_mfma_f32_16x16x32_bf16 v[88:91], a[168:171], a[40:43], v[88:91]
  ds_read_b64_tr_b16 a[188:189], v151 offset:8192
  v_min_u32_dpp v136, v136, v136 row_ror:8 row_mask:0xf bank_mask:0xf
  v_mfma_f32_16x16x32_bf16 v[88:91], a[172:175], a[56:59], v[88:91]
  s_barrier
  v_min_u32_dpp v136, v136, v136 row_ror:4 row_mask:0xf bank_mask:0xf
  v_mfma_f32_16x16x32_bf16 v[92:95], a[172:175], a[60:63], v[92:95]
  ds_read_b64_tr_b16 a[190:191], v151 offset:9216
  v_min_u32_dpp v136, v136, v136 row_ror:2 row_mask:0xf bank_mask:0xf
  v_mfma_f32_16x16x32_bf16 v[92:95], a[168:171], a[44:47], v[92:95]
  s_waitcnt lgkmcnt(4)
  v_min_u32_dpp v136, v136, v136 row_ror:1 row_mask:0xf bank_mask:0xf
  v_mfma_f32_16x16x32_bf16 v[96:99], a[176:179], a[32:35], v[96:99]
  ds_read_b64_tr_b16 a[160:161], v224 offset:0
  v_readlane_b32 s98, v136, 0
  v_mfma_f32_16x16x32_bf16 v[96:99], a[180:183], a[48:51], v[96:99]
  v_readlane_b32 s99, v136, 16
  v_readlane_b32 s100, v136, 32
  v_mfma_f32_16x16x32_bf16 v[100:103], a[180:183], a[52:55], v[100:103]
  ds_read_b64_tr_b16 a[162:163], v224 offset:1024
  v_readlane_b32 s101, v136, 48
  v_mfma_f32_16x16x32_bf16 v[100:103], a[176:179], a[36:39], v[100:103]
  s_min_u32 s98, s98, s99
  s_min_u32 s100, s100, s101
  s_min_u32 s98, s98, s100
  s_sub_u32 s57, s51, s98
  s_sub_u32 s51, s57, 1
  v_sub_u32 v137, s51, v128
  v_sub_u32 v138, s51, v129
  v_mfma_f32_16x16x32_bf16 v[104:107], a[176:179], a[40:43], v[104:107]
  ds_read_b64_tr_b16 a[164:165], v224 offset:8192
  v_min_u32 v136, v137, v138
  v_mfma_f32_16x16x32_bf16 v[104:107], a[180:183], a[56:59], v[104:107]
  v_sub_u32 v139, s51, v130
  v_sub_u32 v140, s51, v131
  v_mfma_f32_16x16x32_bf16 v[108:111], a[180:183], a[60:63], v[108:111]
  ds_read_b64_tr_b16 a[166:167], v224 offset:9216
  v_min3_u32 v136, v136, v139, v140
  v_mfma_f32_16x16x32_bf16 v[108:111], a[176:179], a[44:47], v[108:111]
  s_waitcnt lgkmcnt(4)
  v_sub_u32 v137, s51, v132
  v_sub_u32 v138, s51, v133
  v_mfma_f32_16x16x32_bf16 v[112:115], a[184:187], a[32:35], v[112:115]
  ds_read_b64_tr_b16 a[168:169], v225 offset:0
  v_min3_u32 v136, v136, v137, v138
  v_mfma_f32_16x16x32_bf16 v[112:115], a[188:191], a[48:51], v[112:115]
  v_sub_u32 v139, s51, v134
  v_sub_u32 v140, s51, v135
  v_mfma_f32_16x16x32_bf16 v[116:119], a[188:191], a[52:55], v[116:119]
  ds_read_b64_tr_b16 a[170:171], v225 offset:1024
  v_min3_u32 v136, v136, v139, v140
  v_mfma_f32_16x16x32_bf16 v[116:119], a[184:187], a[36:39], v[116:119]
  v_mfma_f32_16x16x32_bf16 v[120:123], a[184:187], a[40:43], v[120:123]
  ds_read_b64_tr_b16 a[172:173], v225 offset:8192
  v_min_u32_dpp v136, v136, v136 row_ror:8 row_mask:0xf bank_mask:0xf
  v_mfma_f32_16x16x32_bf16 v[120:123], a[188:191], a[56:59], v[120:123]
  v_mfma_f32_16x16x32_bf16 v[124:127], a[188:191], a[60:63], v[124:127]
  ds_read_b64_tr_b16 a[174:175], v225 offset:9216
  v_min_u32_dpp v136, v136, v136 row_ror:4 row_mask:0xf bank_mask:0xf
  v_mfma_f32_16x16x32_bf16 v[124:127], a[184:187], a[44:47], v[124:127]
  s_waitcnt vmcnt(20) lgkmcnt(4)
  v_min_u32_dpp v136, v136, v136 row_ror:2 row_mask:0xf bank_mask:0xf
  v_mfma_f32_16x16x32_bf16 v[0:3], a[160:163], a[64:67], v[0:3]
  ds_read_b64_tr_b16 a[176:177], v226 offset:0
  v_min_u32_dpp v136, v136, v136 row_ror:1 row_mask:0xf bank_mask:0xf
  v_mfma_f32_16x16x32_bf16 v[0:3], a[164:167], a[80:83], v[0:3]
  buffer_load_dwordx4 a[32:35], v242, s[24:27], s30 offen offset:0 sc1
  v_mfma_f32_16x16x32_bf16 v[4:7], a[164:167], a[84:87], v[4:7]
  ds_read_b64_tr_b16 a[178:179], v226 offset:1024
  v_readlane_b32 s98, v136, 0
  v_mfma_f32_16x16x32_bf16 v[4:7], a[160:163], a[68:71], v[4:7]
  buffer_load_dwordx4 a[36:39], v242, s[24:27], s30 offen offset:1024 sc1
  v_mfma_f32_16x16x32_bf16 v[8:11], a[160:163], a[72:75], v[8:11]
  ds_read_b64_tr_b16 a[180:181], v226 offset:8192
  v_readlane_b32 s99, v136, 16
  v_mfma_f32_16x16x32_bf16 v[8:11], a[164:167], a[88:91], v[8:11]
  buffer_load_dwordx4 a[40:43], v242, s[24:27], s30 offen offset:2048 sc1
  v_mfma_f32_16x16x32_bf16 v[12:15], a[164:167], a[92:95], v[12:15]
  ds_read_b64_tr_b16 a[182:183], v226 offset:9216
  v_readlane_b32 s100, v136, 32
  v_mfma_f32_16x16x32_bf16 v[12:15], a[160:163], a[76:79], v[12:15]
  s_waitcnt lgkmcnt(4)
  v_readlane_b32 s101, v136, 48
  v_mfma_f32_16x16x32_bf16 v[16:19], a[168:171], a[64:67], v[16:19]
  ds_read_b64_tr_b16 a[184:185], v227 offset:0
  s_min_u32 s98, s98, s99
  s_min_u32 s100, s100, s101
  s_min_u32 s98, s98, s100
  s_sub_u32 s58, s51, s98
  s_sub_u32 s51, s58, 1
  v_sub_u32 v137, s51, v128
  v_mfma_f32_16x16x32_bf16 v[16:19], a[172:175], a[80:83], v[16:19]
  buffer_load_dwordx4 a[44:47], v242, s[24:27], s30 offen offset:3072 sc1
  v_mfma_f32_16x16x32_bf16 v[20:23], a[172:175], a[84:87], v[20:23]
  ds_read_b64_tr_b16 a[186:187], v227 offset:1024
  v_sub_u32 v138, s51, v129
  v_mfma_f32_16x16x32_bf16 v[20:23], a[168:171], a[68:71], v[20:23]
  buffer_load_dwordx4 a[48:51], v243, s[24:27], s30 offen offset:0 sc1
  v_mfma_f32_16x16x32_bf16 v[24:27], a[168:171], a[72:75], v[24:27]
  ds_read_b64_tr_b16 a[188:189], v227 offset:8192
  v_min_u32 v136, v137, v138
  v_mfma_f32_16x16x32_bf16 v[24:27], a[172:175], a[88:91], v[24:27]
  buffer_load_dwordx4 a[52:55], v243, s[24:27], s30 offen offset:1024 sc1
  v_mfma_f32_16x16x32_bf16 v[28:31], a[172:175], a[92:95], v[28:31]
  ds_read_b64_tr_b16 a[190:191], v227 offset:9216
  v_sub_u32 v139, s51, v130
  v_mfma_f32_16x16x32_bf16 v[28:31], a[168:171], a[76:79], v[28:31]
  s_waitcnt lgkmcnt(4)
  v_sub_u32 v140, s51, v131
  v_min3_u32 v136, v136, v139, v140
  v_mfma_f32_16x16x32_bf16 v[32:35], a[176:179], a[64:67], v[32:35]
  ds_read_b64_tr_b16 a[160:161], v228 offset:0
  v_sub_u32 v137, s51, v132
  v_mfma_f32_16x16x32_bf16 v[32:35], a[180:183], a[80:83], v[32:35]
  buffer_load_dwordx4 a[56:59], v243, s[24:27], s30 offen offset:2048 sc1
  v_mfma_f32_16x16x32_bf16 v[36:39], a[180:183], a[84:87], v[36:39]
  ds_read_b64_tr_b16 a[162:163], v228 offset:1024
  v_sub_u32 v138, s51, v133
  v_mfma_f32_16x16x32_bf16 v[36:39], a[176:179], a[68:71], v[36:39]
  buffer_load_dwordx4 a[60:63], v243, s[24:27], s30 offen offset:3072 sc1
  v_mfma_f32_16x16x32_bf16 v[40:43], a[176:179], a[72:75], v[40:43]
  ds_read_b64_tr_b16 a[164:165], v228 offset:8192
  v_min3_u32 v136, v136, v137, v138
  v_mfma_f32_16x16x32_bf16 v[40:43], a[180:183], a[88:91], v[40:43]
  s_add_u32 s30, s30, 8192
  v_sub_u32 v139, s51, v134
  v_sub_u32 v140, s51, v135
  v_mfma_f32_16x16x32_bf16 v[44:47], a[180:183], a[92:95], v[44:47]
  ds_read_b64_tr_b16 a[166:167], v228 offset:9216
  v_min3_u32 v136, v136, v139, v140
  v_mfma_f32_16x16x32_bf16 v[44:47], a[176:179], a[76:79], v[44:47]
  s_waitcnt lgkmcnt(4)
  v_min_u32_dpp v136, v136, v136 row_ror:8 row_mask:0xf bank_mask:0xf
  v_mfma_f32_16x16x32_bf16 v[48:51], a[184:187], a[64:67], v[48:51]
  ds_read_b64_tr_b16 a[168:169], v229 offset:0
  v_min_u32_dpp v136, v136, v136 row_ror:4 row_mask:0xf bank_mask:0xf
  v_mfma_f32_16x16x32_bf16 v[48:51], a[188:191], a[80:83], v[48:51]
  v_mfma_f32_16x16x32_bf16 v[52:55], a[188:191], a[84:87], v[52:55]
  ds_read_b64_tr_b16 a[170:171], v229 offset:1024
  v_min_u32_dpp v136, v136, v136 row_ror:2 row_mask:0xf bank_mask:0xf
  v_mfma_f32_16x16x32_bf16 v[52:55], a[184:187], a[68:71], v[52:55]
  v_mfma_f32_16x16x32_bf16 v[56:59], a[184:187], a[72:75], v[56:59]
  ds_read_b64_tr_b16 a[172:173], v229 offset:8192
  v_min_u32_dpp v136, v136, v136 row_ror:1 row_mask:0xf bank_mask:0xf
  v_mfma_f32_16x16x32_bf16 v[56:59], a[188:191], a[88:91], v[56:59]
  v_readlane_b32 s98, v136, 0
  v_readlane_b32 s99, v136, 16
  v_mfma_f32_16x16x32_bf16 v[60:63], a[188:191], a[92:95], v[60:63]
  ds_read_b64_tr_b16 a[174:175], v229 offset:9216
  v_readlane_b32 s100, v136, 32
  v_mfma_f32_16x16x32_bf16 v[60:63], a[184:187], a[76:79], v[60:63]
  s_waitcnt lgkmcnt(4)
  v_readlane_b32 s101, v136, 48
  v_mfma_f32_16x16x32_bf16 v[64:67], a[160:163], a[64:67], v[64:67]
  ds_read_b64_tr_b16 a[176:177], v230 offset:0
  s_min_u32 s98, s98, s99
  s_min_u32 s100, s100, s101
  s_min_u32 s98, s98, s100
  s_sub_u32 s59, s51, s98
  s_sub_u32 s51, s59, 1
  v_writelane_b32 v136, s52, 0
  v_mfma_f32_16x16x32_bf16 v[64:67], a[164:167], a[80:83], v[64:67]
  v_writelane_b32 v136, s53, 1
  v_writelane_b32 v136, s54, 2
  v_mfma_f32_16x16x32_bf16 v[68:71], a[164:167], a[84:87], v[68:71]
  ds_read_b64_tr_b16 a[178:179], v230 offset:1024
  v_writelane_b32 v136, s55, 3
  v_mfma_f32_16x16x32_bf16 v[68:71], a[160:163], a[68:71], v[68:71]
  v_writelane_b32 v136, s56, 4
  v_writelane_b32 v136, s57, 5
  v_mfma_f32_16x16x32_bf16 v[72:75], a[160:163], a[72:75], v[72:75]
  ds_read_b64_tr_b16 a[180:181], v230 offset:8192
  v_writelane_b32 v136, s58, 6
  v_mfma_f32_16x16x32_bf16 v[72:75], a[164:167], a[88:91], v[72:75]
  v_writelane_b32 v136, s59, 7
  v_mfma_f32_16x16x32_bf16 v[76:79], a[164:167], a[92:95], v[76:79]
  ds_read_b64_tr_b16 a[182:183], v230 offset:9216
  s_lshl_b32 s35, s3, 8
  s_add_u32 s35, s35, 158720
  v_lshrrev_b32 v137, 2, v242
  v_mfma_f32_16x16x32_bf16 v[76:79], a[160:163], a[76:79], v[76:79]
  s_waitcnt lgkmcnt(4)
  v_add_u32 v137, s35, v137
  v_mfma_f32_16x16x32_bf16 v[80:83], a[168:171], a[64:67], v[80:83]
  ds_read_b64_tr_b16 a[184:185], v231 offset:0
  ds_write_b32 v137, v136
  v_mfma_f32_16x16x32_bf16 v[80:83], a[172:175], a[80:83], v[80:83]
  v_mfma_f32_16x16x32_bf16 v[84:87], a[172:175], a[84:87], v[84:87]
  ds_read_b64_tr_b16 a[186:187], v231 offset:1024
  v_mfma_f32_16x16x32_bf16 v[84:87], a[168:171], a[68:71], v[84:87]
  v_mfma_f32_16x16x32_bf16 v[88:91], a[168:171], a[72:75], v[88:91]
  ds_read_b64_tr_b16 a[188:189], v231 offset:8192
  s_waitcnt lgkmcnt(2)
  v_mfma_f32_16x16x32_bf16 v[88:91], a[172:175], a[88:91], v[88:91]
  s_barrier
  v_mfma_f32_16x16x32_bf16 v[92:95], a[172:175], a[92:95], v[92:95]
  ds_read_b64_tr_b16 a[190:191], v231 offset:9216
  v_mfma_f32_16x16x32_bf16 v[92:95], a[168:171], a[76:79], v[92:95]
  v_mfma_f32_16x16x32_bf16 v[96:99], a[176:179], a[64:67], v[96:99]
  ds_read_b64_tr_b16 a[160:161], v224 offset:16384
  v_mfma_f32_16x16x32_bf16 v[96:99], a[180:183], a[80:83], v[96:99]
  v_mfma_f32_16x16x32_bf16 v[100:103], a[180:183], a[84:87], v[100:103]
  ds_read_b64_tr_b16 a[162:163], v224 offset:17408
  v_mfma_f32_16x16x32_bf16 v[100:103], a[176:179], a[68:71], v[100:103]
  v_mfma_f32_16x16x32_bf16 v[104:107], a[176:179], a[72:75], v[104:107]
  ds_read_b64_tr_b16 a[164:165], v224 offset:24576
  v_mfma_f32_16x16x32_bf16 v[104:107], a[180:183], a[88:91], v[104:107]
  v_mfma_f32_16x16x32_bf16 v[108:111], a[180:183], a[92:95], v[108:111]
  ds_read_b64_tr_b16 a[166:167], v224 offset:25600
  v_mfma_f32_16x16x32_bf16 v[108:111], a[176:179], a[76:79], v[108:111]
  s_waitcnt lgkmcnt(4)
  v_mfma_f32_16x16x32_bf16 v[112:115], a[184:187], a[64:67], v[112:115]
  ds_read_b64_tr_b16 a[168:169], v225 offset:16384
  v_mfma_f32_16x16x32_bf16 v[112:115], a[188:191], a[80:83], v[112:115]
  v_mfma_f32_16x16x32_bf16 v[116:119], a[188:191], a[84:87], v[116:119]
  ds_read_b64_tr_b16 a[170:171], v225 offset:17408
  v_mfma_f32_16x16x32_bf16 v[116:119], a[184:187], a[68:71], v[116:119]
  v_mfma_f32_16x16x32_bf16 v[120:123], a[184:187], a[72:75], v[120:123]
  ds_read_b64_tr_b16 a[172:173], v225 offset:24576
  v_mfma_f32_16x16x32_bf16 v[120:123], a[188:191], a[88:91], v[120:123]
  v_mfma_f32_16x16x32_bf16 v[124:127], a[188:191], a[92:95], v[124:127]
  ds_read_b64_tr_b16 a[174:175], v225 offset:25600
  v_mfma_f32_16x16x32_bf16 v[124:127], a[184:187], a[76:79], v[124:127]
  s_waitcnt vmcnt(16) lgkmcnt(4)
  v_mfma_f32_16x16x32_bf16 v[0:3], a[160:163], a[96:99], v[0:3]
  ds_read_b64_tr_b16 a[176:177], v226 offset:16384
  v_lshrrev_b32 v136, 4, v242
  v_mfma_f32_16x16x32_bf16 v[0:3], a[164:167], a[112:115], v[0:3]
  s_add_u32 m0, s28, 0
  v_bfe_u32 v137, v136, 3, 2
  v_and_b32 v138, 7, v136
  v_mfma_f32_16x16x32_bf16 v[4:7], a[164:167], a[116:119], v[4:7]
  ds_read_b64_tr_b16 a[178:179], v226 offset:17408
  v_lshlrev_b32 v137, 8, v137
  v_mfma_f32_16x16x32_bf16 v[4:7], a[160:163], a[100:103], v[4:7]
  buffer_load_dwordx4 v232, s[12:15], s29 offen offset:0 lds
  v_mfma_f32_16x16x32_bf16 v[8:11], a[160:163], a[104:107], v[8:11]
  ds_read_b64_tr_b16 a[180:181], v226 offset:24576
  v_lshl_add_u32 v137, v138, 2, v137
  v_mfma_f32_16x16x32_bf16 v[8:11], a[164:167], a[120:123], v[8:11]
  buffer_load_dwordx4 v233, s[12:15], s29 offen offset:1024 lds
  v_mfma_f32_16x16x32_bf16 v[12:15], a[164:167], a[124:127], v[12:15]
  ds_read_b64_tr_b16 a[182:183], v226 offset:25600
  v_add_u32 v137, 158720, v137
  v_mfma_f32_16x16x32_bf16 v[12:15], a[160:163], a[108:111], v[12:15]
  s_waitcnt lgkmcnt(4)
  ds_read_b32 v128, v137
  v_mfma_f32_16x16x32_bf16 v[16:19], a[168:171], a[96:99], v[16:19]
  ds_read_b64_tr_b16 a[184:185], v227 offset:16384
  v_mfma_f32_16x16x32_bf16 v[16:19], a[172:175], a[112:115], v[16:19]
  buffer_load_dwordx4 v234, s[12:15], s29 offen offset:2048 lds
  v_mfma_f32_16x16x32_bf16 v[20:23], a[172:175], a[116:119], v[20:23]
  ds_read_b64_tr_b16 a[186:187], v227 offset:17408
  v_mfma_f32_16x16x32_bf16 v[20:23], a[168:171], a[100:103], v[20:23]
  buffer_load_dwordx4 v235, s[12:15], s29 offen offset:3072 lds
  v_mfma_f32_16x16x32_bf16 v[24:27], a[168:171], a[104:107], v[24:27]
  ds_read_b64_tr_b16 a[188:189], v227 offset:24576
  v_mfma_f32_16x16x32_bf16 v[24:27], a[172:175], a[120:123], v[24:27]
  v_mfma_f32_16x16x32_bf16 v[28:31], a[172:175], a[124:127], v[28:31]
  ds_read_b64_tr_b16 a[190:191], v227 offset:25600
  v_mfma_f32_16x16x32_bf16 v[28:31], a[168:171], a[108:111], v[28:31]
  s_waitcnt lgkmcnt(5)
  s_waitcnt lgkmcnt(4)
  s_mov_b32 s51, -1
  v_sub_u32 v137, s51, v128
  v_mfma_f32_16x16x32_bf16 v[32:35], a[176:179], a[96:99], v[32:35]
  ds_read_b64_tr_b16 a[160:161], v228 offset:16384
  v_min_u32_dpp v137, v137, v137 row_ror:8 row_mask:0xf bank_mask:0xf
  v_mfma_f32_16x16x32_bf16 v[32:35], a[180:183], a[112:115], v[32:35]
  v_mfma_f32_16x16x32_bf16 v[36:39], a[180:183], a[116:119], v[36:39]
  ds_read_b64_tr_b16 a[162:163], v228 offset:17408
  v_min_u32_dpp v137, v137, v137 row_ror:4 row_mask:0xf bank_mask:0xf
  v_mfma_f32_16x16x32_bf16 v[36:39], a[176:179], a[100:103], v[36:39]
  v_mfma_f32_16x16x32_bf16 v[40:43], a[176:179], a[104:107], v[40:43]
  ds_read_b64_tr_b16 a[164:165], v228 offset:24576
  v_min_u32_dpp v137, v137, v137 row_ror:2 row_mask:0xf bank_mask:0xf
  v_mfma_f32_16x16x32_bf16 v[40:43], a[180:183], a[120:123], v[40:43]
  v_mfma_f32_16x16x32_bf16 v[44:47], a[180:183], a[124:127], v[44:47]
  ds_read_b64_tr_b16 a[166:167], v228 offset:25600
  v_min_u32_dpp v137, v137, v137 row_ror:1 row_mask:0xf bank_mask:0xf
  v_mfma_f32_16x16x32_bf16 v[44:47], a[176:179], a[108:111], v[44:47]
  s_waitcnt lgkmcnt(4)
  v_readlane_b32 s98, v137, 0
  v_readlane_b32 s99, v137, 16
  v_mfma_f32_16x16x32_bf16 v[48:51], a[184:187], a[96:99], v[48:51]
  ds_read_b64_tr_b16 a[168:169], v229 offset:16384
  s_min_u32 s98, s98, s99
  s_sub_u32 s52, s51, s98
  s_sub_u32 s51, s52, 1
  v_sub_u32 v137, s51, v128
  v_mfma_f32_16x16x32_bf16 v[48:51], a[188:191], a[112:115], v[48:51]
  v_mfma_f32_16x16x32_bf16 v[52:55], a[188:191], a[116:119], v[52:55]
  ds_read_b64_tr_b16 a[170:171], v229 offset:17408
  v_min_u32_dpp v137, v137, v137 row_ror:8 row_mask:0xf bank_mask:0xf
  v_mfma_f32_16x16x32_bf16 v[52:55], a[184:187], a[100:103], v[52:55]
  v_mfma_f32_16x16x32_bf16 v[56:59], a[184:187], a[104:107], v[56:59]
  ds_read_b64_tr_b16 a[172:173], v229 offset:24576
  v_min_u32_dpp v137, v137, v137 row_ror:4 row_mask:0xf bank_mask:0xf
  v_mfma_f32_16x16x32_bf16 v[56:59], a[188:191], a[120:123], v[56:59]
  v_mfma_f32_16x16x32_bf16 v[60:63], a[188:191], a[124:127], v[60:63]
  ds_read_b64_tr_b16 a[174:175], v229 offset:25600
  v_min_u32_dpp v137, v137, v137 row_ror:2 row_mask:0xf bank_mask:0xf
  v_mfma_f32_16x16x32_bf16 v[60:63], a[184:187], a[108:111], v[60:63]
  s_waitcnt lgkmcnt(4)
  v_min_u32_dpp v137, v137, v137 row_ror:1 row_mask:0xf bank_mask:0xf
  v_mfma_f32_16x16x32_bf16 v[64:67], a[160:163], a[96:99], v[64:67]
  ds_read_b64_tr_b16 a[176:177], v230 offset:16384
  v_readlane_b32 s98, v137, 0
  v_mfma_f32_16x16x32_bf16 v[64:67], a[164:167], a[112:115], v[64:67]
  v_readlane_b32 s99, v137, 16
  v_mfma_f32_16x16x32_bf16 v[68:71], a[164:167], a[116:119], v[68:71]
  ds_read_b64_tr_b16 a[178:179], v230 offset:17408
  s_min_u32 s98, s98, s99
  s_sub_u32 s53, s51, s98
  s_sub_u32 s51, s53, 1
  v_sub_u32 v137, s51, v128
  v_mfma_f32_16x16x32_bf16 v[68:71], a[160:163], a[100:103], v[68:71]
  v_mfma_f32_16x16x32_bf16 v[72:75], a[160:163], a[104:107], v[72:75]
  ds_read_b64_tr_b16 a[180:181], v230 offset:24576
  v_min_u32_dpp v137, v137, v137 row_ror:8 row_mask:0xf bank_mask:0xf
  v_mfma_f32_16x16x32_bf16 v[72:75], a[164:167], a[120:123], v[72:75]
  v_mfma_f32_16x16x32_bf16 v[76:79], a[164:167], a[124:127], v[76:79]
  ds_read_b64_tr_b16 a[182:183], v230 offset:25600
  v_min_u32_dpp v137, v137, v137 row_ror:4 row_mask:0xf bank_mask:0xf
  v_mfma_f32_16x16x32_bf16 v[76:79], a[160:163], a[108:111], v[76:79]
  s_waitcnt lgkmcnt(4)
  v_min_u32_dpp v137, v137, v137 row_ror:2 row_mask:0xf bank_mask:0xf
  v_mfma_f32_16x16x32_bf16 v[80:83], a[168:171], a[96:99], v[80:83]
  ds_read_b64_tr_b16 a[184:185], v231 offset:16384
  v_min_u32_dpp v137, v137, v137 row_ror:1 row_mask:0xf bank_mask:0xf
  v_mfma_f32_16x16x32_bf16 v[80:83], a[172:175], a[112:115], v[80:83]
  v_readlane_b32 s98, v137, 0
  v_readlane_b32 s99, v137, 16
  v_mfma_f32_16x16x32_bf16 v[84:87], a[172:175], a[116:119], v[84:87]
  ds_read_b64_tr_b16 a[186:187], v231 offset:17408
  s_min_u32 s98, s98, s99
  s_sub_u32 s54, s51, s98
  s_sub_u32 s51, s54, 1
  v_sub_u32 v137, s51, v128
  v_mfma_f32_16x16x32_bf16 v[84:87], a[168:171], a[100:103], v[84:87]
  s_nop 0
  v_min_u32_dpp v137, v137, v137 row_ror:8 row_mask:0xf bank_mask:0xf
  v_mfma_f32_16x16x32_bf16 v[88:91], a[168:171], a[104:107], v[88:91]
  ds_read_b64_tr_b16 a[188:189], v231 offset:24576
  v_min_u32_dpp v137, v137, v137 row_ror:4 row_mask:0xf bank_mask:0xf
  v_mfma_f32_16x16x32_bf16 v[88:91], a[172:175], a[120:123], v[88:91]
  s_barrier
  v_min_u32_dpp v137, v137, v137 row_ror:2 row_mask:0xf bank_mask:0xf
  v_mfma_f32_16x16x32_bf16 v[92:95], a[172:175], a[124:127], v[92:95]
  ds_read_b64_tr_b16 a[190:191], v231 offset:25600
  v_min_u32_dpp v137, v137, v137 row_ror:1 row_mask:0xf bank_mask:0xf
  v_mfma_f32_16x16x32_bf16 v[92:95], a[168:171], a[108:111], v[92:95]
  s_waitcnt lgkmcnt(4)
  v_readlane_b32 s98, v137, 0
  v_readlane_b32 s99, v137, 16
  v_mfma_f32_16x16x32_bf16 v[96:99], a[176:179], a[96:99], v[96:99]
  ds_read_b64_tr_b16 a[160:161], v224 offset:32768
  s_min_u32 s98, s98, s99
  s_sub_u32 s55, s51, s98
  s_sub_u32 s51, s55, 1
  v_sub_u32 v137, s51, v128
  v_mfma_f32_16x16x32_bf16 v[96:99], a[180:183], a[112:115], v[96:99]
  v_mfma_f32_16x16x32_bf16 v[100:103], a[180:183], a[116:119], v[100:103]
  ds_read_b64_tr_b16 a[162:163], v224 offset:33792
  v_min_u32_dpp v137, v137, v137 row_ror:8 row_mask:0xf bank_mask:0xf
  v_mfma_f32_16x16x32_bf16 v[100:103], a[176:179], a[100:103], v[100:103]
  v_mfma_f32_16x16x32_bf16 v[104:107], a[176:179], a[104:107], v[104:107]
  ds_read_b64_tr_b16 a[164:165], v224 offset:40960
  v_min_u32_dpp v137, v137, v137 row_ror:4 row_mask:0xf bank_mask:0xf
  v_mfma_f32_16x16x32_bf16 v[104:107], a[180:183], a[120:123], v[104:107]
  v_mfma_f32_16x16x32_bf16 v[108:111], a[180:183], a[124:127], v[108:111]
  ds_read_b64_tr_b16 a[166:167], v224 offset:41984
  v_min_u32_dpp v137, v137, v137 row_ror:2 row_mask:0xf bank_mask:0xf
  v_mfma_f32_16x16x32_bf16 v[108:111], a[176:179], a[108:111], v[108:111]
  s_waitcnt lgkmcnt(4)
  v_min_u32_dpp v137, v137, v137 row_ror:1 row_mask:0xf bank_mask:0xf
  v_mfma_f32_16x16x32_bf16 v[112:115], a[184:187], a[96:99], v[112:115]
  ds_read_b64_tr_b16 a[168:169], v225 offset:32768
  v_readlane_b32 s98, v137, 0
  v_mfma_f32_16x16x32_bf16 v[112:115], a[188:191], a[112:115], v[112:115]
  v_readlane_b32 s99, v137, 16
  v_mfma_f32_16x16x32_bf16 v[116:119], a[188:191], a[116:119], v[116:119]
  ds_read_b64_tr_b16 a[170:171], v225 offset:33792
  s_min_u32 s98, s98, s99
  s_sub_u32 s56, s51, s98
  s_sub_u32 s51, s56, 1
  v_sub_u32 v137, s51, v128
  v_mfma_f32_16x16x32_bf16 v[116:119], a[184:187], a[100:103], v[116:119]
  v_mfma_f32_16x16x32_bf16 v[120:123], a[184:187], a[104:107], v[120:123]
  ds_read_b64_tr_b16 a[172:173], v225 offset:40960
  v_min_u32_dpp v137, v137, v137 row_ror:8 row_mask:0xf bank_mask:0xf
  v_mfma_f32_16x16x32_bf16 v[120:123], a[188:191], a[120:123], v[120:123]
  v_mfma_f32_16x16x32_bf16 v[124:127], a[188:191], a[124:127], v[124:127]
  ds_read_b64_tr_b16 a[174:175], v225 offset:41984
  v_min_u32_dpp v137, v137, v137 row_ror:4 row_mask:0xf bank_mask:0xf
  v_mfma_f32_16x16x32_bf16 v[124:127], a[184:187], a[108:111], v[124:127]
  s_waitcnt vmcnt(12) lgkmcnt(4)
  v_min_u32_dpp v137, v137, v137 row_ror:2 row_mask:0xf bank_mask:0xf
  v_mfma_f32_16x16x32_bf16 v[0:3], a[160:163], a[0:3], v[0:3]
  ds_read_b64_tr_b16 a[176:177], v226 offset:32768
  v_min_u32_dpp v137, v137, v137 row_ror:1 row_mask:0xf bank_mask:0xf
  v_mfma_f32_16x16x32_bf16 v[0:3], a[164:167], a[16:19], v[0:3]
  v_readlane_b32 s98, v137, 0
  v_readlane_b32 s99, v137, 16
  v_mfma_f32_16x16x32_bf16 v[4:7], a[164:167], a[20:23], v[4:7]
  ds_read_b64_tr_b16 a[178:179], v226 offset:33792
  s_min_u32 s98, s98, s99
  s_sub_u32 s57, s51, s98
  s_sub_u32 s51, s57, 1
  v_sub_u32 v137, s51, v128
  v_mfma_f32_16x16x32_bf16 v[4:7], a[160:163], a[4:7], v[4:7]
  v_mfma_f32_16x16x32_bf16 v[8:11], a[160:163], a[8:11], v[8:11]
  ds_read_b64_tr_b16 a[180:181], v226 offset:40960
  v_min_u32_dpp v137, v137, v137 row_ror:8 row_mask:0xf bank_mask:0xf
  v_mfma_f32_16x16x32_bf16 v[8:11], a[164:167], a[24:27], v[8:11]
  v_mfma_f32_16x16x32_bf16 v[12:15], a[164:167], a[28:31], v[12:15]
  ds_read_b64_tr_b16 a[182:183], v226 offset:41984
  v_min_u32_dpp v137, v137, v137 row_ror:4 row_mask:0xf bank_mask:0xf
  v_mfma_f32_16x16x32_bf16 v[12:15], a[160:163], a[12:15], v[12:15]
  s_waitcnt lgkmcnt(4)
  v_min_u32_dpp v137, v137, v137 row_ror:2 row_mask:0xf bank_mask:0xf
  v_mfma_f32_16x16x32_bf16 v[16:19], a[168:171], a[0:3], v[16:19]
  ds_read_b64_tr_b16 a[184:185], v227 offset:32768
  v_min_u32_dpp v137, v137, v137 row_ror:1 row_mask:0xf bank_mask:0xf
  v_mfma_f32_16x16x32_bf16 v[16:19], a[172:175], a[16:19], v[16:19]
  v_readlane_b32 s98, v137, 0
  v_readlane_b32 s99, v137, 16
  v_mfma_f32_16x16x32_bf16 v[20:23], a[172:175], a[20:23], v[20:23]
  ds_read_b64_tr_b16 a[186:187], v227 offset:33792
  s_min_u32 s98, s98, s99
  s_sub_u32 s58, s51, s98
  s_sub_u32 s51, s58, 1
  v_sub_u32 v137, s51, v128
  v_mfma_f32_16x16x32_bf16 v[20:23], a[168:171], a[4:7], v[20:23]
  v_mfma_f32_16x16x32_bf16 v[24:27], a[168:171], a[8:11], v[24:27]
  ds_read_b64_tr_b16 a[188:189], v227 offset:40960
  v_min_u32_dpp v137, v137, v137 row_ror:8 row_mask:0xf bank_mask:0xf
  v_mfma_f32_16x16x32_bf16 v[24:27], a[172:175], a[24:27], v[24:27]
  v_mfma_f32_16x16x32_bf16 v[28:31], a[172:175], a[28:31], v[28:31]
  ds_read_b64_tr_b16 a[190:191], v227 offset:41984
  v_min_u32_dpp v137, v137, v137 row_ror:4 row_mask:0xf bank_mask:0xf
  v_mfma_f32_16x16x32_bf16 v[28:31], a[168:171], a[12:15], v[28:31]
  s_waitcnt lgkmcnt(4)
  v_min_u32_dpp v137, v137, v137 row_ror:2 row_mask:0xf bank_mask:0xf
  v_mfma_f32_16x16x32_bf16 v[32:35], a[176:179], a[0:3], v[32:35]
  ds_read_b64_tr_b16 a[160:161], v228 offset:32768
  v_min_u32_dpp v137, v137, v137 row_ror:1 row_mask:0xf bank_mask:0xf
  v_mfma_f32_16x16x32_bf16 v[32:35], a[180:183], a[16:19], v[32:35]
  v_readlane_b32 s98, v137, 0
  v_readlane_b32 s99, v137, 16
  v_mfma_f32_16x16x32_bf16 v[36:39], a[180:183], a[20:23], v[36:39]
  ds_read_b64_tr_b16 a[162:163], v228 offset:33792
  s_min_u32 s98, s98, s99
  s_sub_u32 s59, s51, s98
  s_sub_u32 s51, s59, 1
  v_mov_b32 v128, 0
  v_mfma_f32_16x16x32_bf16 v[36:39], a[176:179], a[4:7], v[36:39]
  v_writelane_b32 v128, s52, 0
  v_writelane_b32 v128, s53, 1
  v_mfma_f32_16x16x32_bf16 v[40:43], a[176:179], a[8:11], v[40:43]
  ds_read_b64_tr_b16 a[164:165], v228 offset:40960
  v_writelane_b32 v128, s54, 2
  v_mfma_f32_16x16x32_bf16 v[40:43], a[180:183], a[24:27], v[40:43]
  v_writelane_b32 v128, s55, 3
  v_writelane_b32 v128, s56, 4
  v_mfma_f32_16x16x32_bf16 v[44:47], a[180:183], a[28:31], v[44:47]
  ds_read_b64_tr_b16 a[166:167], v228 offset:41984
  v_writelane_b32 v128, s57, 5
  v_mfma_f32_16x16x32_bf16 v[44:47], a[176:179], a[12:15], v[44:47]
  s_waitcnt lgkmcnt(4)
  v_writelane_b32 v128, s58, 6
  v_writelane_b32 v128, s59, 7
  v_mfma_f32_16x16x32_bf16 v[48:51], a[184:187], a[0:3], v[48:51]
  ds_read_b64_tr_b16 a[168:169], v229 offset:32768
  s_cmp_eq_u32 s2, 0
  s_cselect_b32 s35, 0, 1073741824
  v_lshrrev_b32 v137, 3, v136
  v_mfma_f32_16x16x32_bf16 v[48:51], a[188:191], a[16:19], v[48:51]
  v_lshlrev_b32 v137, 28, v137
  v_lshl_add_u32 v137, v136, 2, v137
  v_mfma_f32_16x16x32_bf16 v[52:55], a[188:191], a[20:23], v[52:55]
  ds_read_b64_tr_b16 a[170:171], v229 offset:33792
  v_or_b32 v137, s35, v137
  v_mfma_f32_16x16x32_bf16 v[52:55], a[184:187], a[4:7], v[52:55]
  s_mov_b32 s35, 2629632
  buffer_store_dword v128, v137, s[24:27], s35 offen
  v_mfma_f32_16x16x32_bf16 v[56:59], a[184:187], a[8:11], v[56:59]
  ds_read_b64_tr_b16 a[172:173], v229 offset:40960
  v_and_b32 v129, 0xffff, v128
  v_mfma_f32_16x16x32_bf16 v[56:59], a[188:191], a[24:27], v[56:59]
  v_sub_u32 v129, 0xffff, v129
  v_and_b32 v129, 0x7ff, v129
  v_mfma_f32_16x16x32_bf16 v[60:63], a[188:191], a[28:31], v[60:63]
  ds_read_b64_tr_b16 a[174:175], v229 offset:41984
  v_mov_b32 v130, v129
  v_mfma_f32_16x16x32_bf16 v[60:63], a[184:187], a[12:15], v[60:63]
  s_waitcnt lgkmcnt(4)
  v_permlane16_swap_b32 v129, v130
  v_mov_b32 v130, v129
  v_mfma_f32_16x16x32_bf16 v[64:67], a[160:163], a[0:3], v[64:67]
  ds_read_b64_tr_b16 a[176:177], v230 offset:32768
  v_permlane32_swap_b32 v129, v130
  v_mfma_f32_16x16x32_bf16 v[64:67], a[164:167], a[16:19], v[64:67]
  v_lshrrev_b32 v130, 6, v129
  v_mul_u32_u24 v130, 0x14000, v130
  v_mfma_f32_16x16x32_bf16 v[68:71], a[164:167], a[20:23], v[68:71]
  ds_read_b64_tr_b16 a[178:179], v230 offset:33792
  v_bfe_u32 v131, v129, 4, 2
  v_mfma_f32_16x16x32_bf16 v[68:71], a[160:163], a[4:7], v[68:71]
  v_lshl_add_u32 v130, v131, 10, v130
  v_and_b32 v131, 15, v129
  v_mfma_f32_16x16x32_bf16 v[72:75], a[160:163], a[8:11], v[72:75]
  ds_read_b64_tr_b16 a[180:181], v230 offset:40960
  v_lshl_add_u32 v130, v131, 4, v130
  v_mfma_f32_16x16x32_bf16 v[72:75], a[164:167], a[24:27], v[72:75]
  v_lshrrev_b32 v131, 4, v136
  v_lshl_add_u32 v243, v131, 8, v130
  v_mfma_f32_16x16x32_bf16 v[76:79], a[164:167], a[28:31], v[76:79]
  ds_read_b64_tr_b16 a[182:183], v230 offset:41984
  v_mfma_f32_16x16x32_bf16 v[76:79], a[160:163], a[12:15], v[76:79]
  s_waitcnt lgkmcnt(4)
  v_mfma_f32_16x16x32_bf16 v[80:83], a[168:171], a[0:3], v[80:83]
  ds_read_b64_tr_b16 a[184:185], v231 offset:32768
  v_mfma_f32_16x16x32_bf16 v[80:83], a[172:175], a[16:19], v[80:83]
  v_mfma_f32_16x16x32_bf16 v[84:87], a[172:175], a[20:23], v[84:87]
  ds_read_b64_tr_b16 a[186:187], v231 offset:33792
  v_mfma_f32_16x16x32_bf16 v[84:87], a[168:171], a[4:7], v[84:87]
  v_mfma_f32_16x16x32_bf16 v[88:91], a[168:171], a[8:11], v[88:91]
  ds_read_b64_tr_b16 a[188:189], v231 offset:40960
  v_mfma_f32_16x16x32_bf16 v[88:91], a[172:175], a[24:27], v[88:91]
  s_barrier
  v_mfma_f32_16x16x32_bf16 v[92:95], a[172:175], a[28:31], v[92:95]
  ds_read_b64_tr_b16 a[190:191], v231 offset:41984
  v_mfma_f32_16x16x32_bf16 v[92:95], a[168:171], a[12:15], v[92:95]
  s_waitcnt lgkmcnt(4)
  v_mfma_f32_16x16x32_bf16 v[96:99], a[176:179], a[0:3], v[96:99]
  ds_read_b64_tr_b16 a[160:161], v224 offset:49152
  v_mfma_f32_16x16x32_bf16 v[96:99], a[180:183], a[16:19], v[96:99]
  v_mfma_f32_16x16x32_bf16 v[100:103], a[180:183], a[20:23], v[100:103]
  ds_read_b64_tr_b16 a[162:163], v224 offset:50176
  v_mfma_f32_16x16x32_bf16 v[100:103], a[176:179], a[4:7], v[100:103]
  v_mfma_f32_16x16x32_bf16 v[104:107], a[176:179], a[8:11], v[104:107]
  ds_read_b64_tr_b16 a[164:165], v224 offset:57344
  v_mfma_f32_16x16x32_bf16 v[104:107], a[180:183], a[24:27], v[104:107]
  v_mfma_f32_16x16x32_bf16 v[108:111], a[180:183], a[28:31], v[108:111]
  ds_read_b64_tr_b16 a[166:167], v224 offset:58368
  v_mfma_f32_16x16x32_bf16 v[108:111], a[176:179], a[12:15], v[108:111]
  s_waitcnt lgkmcnt(4)
  v_mfma_f32_16x16x32_bf16 v[112:115], a[184:187], a[0:3], v[112:115]
  ds_read_b64_tr_b16 a[168:169], v225 offset:49152
  v_mfma_f32_16x16x32_bf16 v[112:115], a[188:191], a[16:19], v[112:115]
  v_mfma_f32_16x16x32_bf16 v[116:119], a[188:191], a[20:23], v[116:119]
  ds_read_b64_tr_b16 a[170:171], v225 offset:50176
  v_mfma_f32_16x16x32_bf16 v[116:119], a[184:187], a[4:7], v[116:119]
  v_mfma_f32_16x16x32_bf16 v[120:123], a[184:187], a[8:11], v[120:123]
  ds_read_b64_tr_b16 a[172:173], v225 offset:57344
  v_mfma_f32_16x16x32_bf16 v[120:123], a[188:191], a[24:27], v[120:123]
  v_mfma_f32_16x16x32_bf16 v[124:127], a[188:191], a[28:31], v[124:127]
  ds_read_b64_tr_b16 a[174:175], v225 offset:58368
  v_mfma_f32_16x16x32_bf16 v[124:127], a[184:187], a[12:15], v[124:127]
  s_waitcnt vmcnt(5) lgkmcnt(4)
  v_mfma_f32_16x16x32_bf16 v[0:3], a[160:163], a[32:35], v[0:3]
  ds_read_b64_tr_b16 a[176:177], v226 offset:49152
  s_add_u32 m0, s28, 65536
  v_mfma_f32_16x16x32_bf16 v[0:3], a[164:167], a[48:51], v[0:3]
  buffer_load_dwordx4 v236, s[16:19], s29 offen offset:0 lds
  v_mfma_f32_16x16x32_bf16 v[4:7], a[164:167], a[52:55], v[4:7]
  ds_read_b64_tr_b16 a[178:179], v226 offset:50176
  v_mfma_f32_16x16x32_bf16 v[4:7], a[160:163], a[36:39], v[4:7]
  buffer_load_dwordx4 v237, s[16:19], s29 offen offset:1024 lds
  v_mfma_f32_16x16x32_bf16 v[8:11], a[160:163], a[40:43], v[8:11]
  ds_read_b64_tr_b16 a[180:181], v226 offset:57344
  v_mfma_f32_16x16x32_bf16 v[8:11], a[164:167], a[56:59], v[8:11]
  buffer_load_dwordx4 v236, s[16:19], s29 offen offset:2048 lds
  v_mfma_f32_16x16x32_bf16 v[12:15], a[164:167], a[60:63], v[12:15]
  ds_read_b64_tr_b16 a[182:183], v226 offset:58368
  v_mfma_f32_16x16x32_bf16 v[12:15], a[160:163], a[44:47], v[12:15]
  s_waitcnt lgkmcnt(4)
  v_mfma_f32_16x16x32_bf16 v[16:19], a[168:171], a[32:35], v[16:19]
  ds_read_b64_tr_b16 a[184:185], v227 offset:49152
  v_mfma_f32_16x16x32_bf16 v[16:19], a[172:175], a[48:51], v[16:19]
  buffer_load_dwordx4 v237, s[16:19], s29 offen offset:3072 lds
  v_mfma_f32_16x16x32_bf16 v[20:23], a[172:175], a[52:55], v[20:23]
  ds_read_b64_tr_b16 a[186:187], v227 offset:50176
  s_add_u32 s29, s29, 16384
  s_add_u32 m0, s28, 16384
  v_mfma_f32_16x16x32_bf16 v[20:23], a[168:171], a[36:39], v[20:23]
  buffer_load_dwordx4 v232, s[12:15], s29 offen offset:0 lds
  v_mfma_f32_16x16x32_bf16 v[24:27], a[168:171], a[40:43], v[24:27]
  ds_read_b64_tr_b16 a[188:189], v227 offset:57344
  v_mfma_f32_16x16x32_bf16 v[24:27], a[172:175], a[56:59], v[24:27]
  buffer_load_dwordx4 v233, s[12:15], s29 offen offset:1024 lds
  v_mfma_f32_16x16x32_bf16 v[28:31], a[172:175], a[60:63], v[28:31]
  ds_read_b64_tr_b16 a[190:191], v227 offset:58368
  v_mul_f32 v0, s34, v0
  v_mfma_f32_16x16x32_bf16 v[28:31], a[168:171], a[44:47], v[28:31]
  s_waitcnt lgkmcnt(4)
  v_mul_f32 v1, s34, v1
  v_mul_f32 v2, s34, v2
  v_mfma_f32_16x16x32_bf16 v[32:35], a[176:179], a[32:35], v[32:35]
  ds_read_b64_tr_b16 a[160:161], v228 offset:49152
  v_mul_f32 v3, s34, v3
  v_mfma_f32_16x16x32_bf16 v[32:35], a[180:183], a[48:51], v[32:35]
  buffer_load_dwordx4 v234, s[12:15], s29 offen offset:2048 lds
  v_mfma_f32_16x16x32_bf16 v[36:39], a[180:183], a[52:55], v[36:39]
  ds_read_b64_tr_b16 a[162:163], v228 offset:50176
  v_mul_f32 v16, s34, v16
  v_mfma_f32_16x16x32_bf16 v[36:39], a[176:179], a[36:39], v[36:39]
  buffer_load_dwordx4 v235, s[12:15], s29 offen offset:3072 lds
  v_mfma_f32_16x16x32_bf16 v[40:43], a[176:179], a[40:43], v[40:43]
  ds_read_b64_tr_b16 a[164:165], v228 offset:57344
  v_mul_f32 v17, s34, v17
  v_mfma_f32_16x16x32_bf16 v[40:43], a[180:183], a[56:59], v[40:43]
  v_mul_f32 v18, s34, v18
  v_mul_f32 v19, s34, v19
  v_mfma_f32_16x16x32_bf16 v[44:47], a[180:183], a[60:63], v[44:47]
  ds_read_b64_tr_b16 a[166:167], v228 offset:58368
  v_cvt_pk_bf16_f32 v128, v0, v1
  v_mfma_f32_16x16x32_bf16 v[44:47], a[176:179], a[44:47], v[44:47]
  s_waitcnt lgkmcnt(4)
  v_cvt_pk_bf16_f32 v129, v2, v3
  v_cvt_pk_bf16_f32 v130, v16, v17
  v_mfma_f32_16x16x32_bf16 v[48:51], a[184:187], a[32:35], v[48:51]
  ds_read_b64_tr_b16 a[168:169], v229 offset:49152
  v_cvt_pk_bf16_f32 v131, v18, v19
  v_mfma_f32_16x16x32_bf16 v[48:51], a[188:191], a[48:51], v[48:51]
  v_mul_f32 v4, s34, v4
  v_mul_f32 v5, s34, v5
  v_mfma_f32_16x16x32_bf16 v[52:55], a[188:191], a[52:55], v[52:55]
  ds_read_b64_tr_b16 a[170:171], v229 offset:50176
  v_mul_f32 v6, s34, v6
  v_mfma_f32_16x16x32_bf16 v[52:55], a[184:187], a[36:39], v[52:55]
  v_mul_f32 v7, s34, v7
  v_mul_f32 v20, s34, v20
  v_mfma_f32_16x16x32_bf16 v[56:59], a[184:187], a[40:43], v[56:59]
  ds_read_b64_tr_b16 a[172:173], v229 offset:57344
  v_mul_f32 v21, s34, v21
  v_mfma_f32_16x16x32_bf16 v[56:59], a[188:191], a[56:59], v[56:59]
  v_mul_f32 v22, s34, v22
  v_mul_f32 v23, s34, v23
  v_mfma_f32_16x16x32_bf16 v[60:63], a[188:191], a[60:63], v[60:63]
  ds_read_b64_tr_b16 a[174:175], v229 offset:58368
  v_cvt_pk_bf16_f32 v144, v4, v5
  v_mfma_f32_16x16x32_bf16 v[60:63], a[184:187], a[44:47], v[60:63]
  s_waitcnt lgkmcnt(4)
  v_cvt_pk_bf16_f32 v145, v6, v7
  v_cvt_pk_bf16_f32 v146, v20, v21
  v_mfma_f32_16x16x32_bf16 v[64:67], a[160:163], a[32:35], v[64:67]
  ds_read_b64_tr_b16 a[176:177], v230 offset:49152
  v_cvt_pk_bf16_f32 v147, v22, v23
  v_mfma_f32_16x16x32_bf16 v[64:67], a[164:167], a[48:51], v[64:67]
  v_permlane16_swap_b32 v128, v130
  v_permlane16_swap_b32 v129, v131
  v_mfma_f32_16x16x32_bf16 v[68:71], a[164:167], a[52:55], v[68:71]
  ds_read_b64_tr_b16 a[178:179], v230 offset:50176
  v_mul_f32 v8, s34, v8
  v_mfma_f32_16x16x32_bf16 v[68:71], a[160:163], a[36:39], v[68:71]
  v_mul_f32 v9, s34, v9
  v_mul_f32 v10, s34, v10
  v_mfma_f32_16x16x32_bf16 v[72:75], a[160:163], a[40:43], v[72:75]
  ds_read_b64_tr_b16 a[180:181], v230 offset:57344
  v_mul_f32 v11, s34, v11
  v_mfma_f32_16x16x32_bf16 v[72:75], a[164:167], a[56:59], v[72:75]
  v_mul_f32 v24, s34, v24
  v_mul_f32 v25, s34, v25
  v_mfma_f32_16x16x32_bf16 v[76:79], a[164:167], a[60:63], v[76:79]
  ds_read_b64_tr_b16 a[182:183], v230 offset:58368
  v_mul_f32 v26, s34, v26
  v_mfma_f32_16x16x32_bf16 v[76:79], a[160:163], a[44:47], v[76:79]
  s_waitcnt lgkmcnt(4)
  v_mul_f32 v27, s34, v27
  v_cvt_pk_bf16_f32 v160, v8, v9
  v_mfma_f32_16x16x32_bf16 v[80:83], a[168:171], a[32:35], v[80:83]
  ds_read_b64_tr_b16 a[184:185], v231 offset:49152
  v_cvt_pk_bf16_f32 v161, v10, v11
  v_mfma_f32_16x16x32_bf16 v[80:83], a[172:175], a[48:51], v[80:83]
  v_cvt_pk_bf16_f32 v162, v24, v25
  v_cvt_pk_bf16_f32 v163, v26, v27
  v_mfma_f32_16x16x32_bf16 v[84:87], a[172:175], a[52:55], v[84:87]
  ds_read_b64_tr_b16 a[186:187], v231 offset:50176
  v_permlane16_swap_b32 v144, v146
  v_mfma_f32_16x16x32_bf16 v[84:87], a[168:171], a[36:39], v[84:87]
  s_waitcnt vmcnt(9)
  v_permlane16_swap_b32 v145, v147
  v_mul_f32 v12, s34, v12
  v_mfma_f32_16x16x32_bf16 v[88:91], a[168:171], a[40:43], v[88:91]
  ds_read_b64_tr_b16 a[188:189], v231 offset:57344
  v_mul_f32 v13, s34, v13
  v_mfma_f32_16x16x32_bf16 v[88:91], a[172:175], a[56:59], v[88:91]
  s_barrier
  v_mul_f32 v14, s34, v14
  v_mul_f32 v15, s34, v15
  v_mfma_f32_16x16x32_bf16 v[92:95], a[172:175], a[60:63], v[92:95]
  ds_read_b64_tr_b16 a[190:191], v231 offset:58368
  v_mul_f32 v28, s34, v28
  v_mfma_f32_16x16x32_bf16 v[92:95], a[168:171], a[44:47], v[92:95]
  s_waitcnt lgkmcnt(4)
  v_mul_f32 v29, s34, v29
  v_mul_f32 v30, s34, v30
  v_mfma_f32_16x16x32_bf16 v[96:99], a[176:179], a[32:35], v[96:99]
  ds_read_b128 a[128:131], v212 offset:0
  v_mul_f32 v31, s34, v31
  v_mfma_f32_16x16x32_bf16 v[96:99], a[180:183], a[48:51], v[96:99]
  v_cvt_pk_bf16_f32 v176, v12, v13
  v_cvt_pk_bf16_f32 v177, v14, v15
  v_mfma_f32_16x16x32_bf16 v[100:103], a[180:183], a[52:55], v[100:103]
  ds_read_b128 a[132:135], v213 offset:0
  v_cvt_pk_bf16_f32 v178, v28, v29
  v_mfma_f32_16x16x32_bf16 v[100:103], a[176:179], a[36:39], v[100:103]
  v_cvt_pk_bf16_f32 v179, v30, v31
  v_permlane16_swap_b32 v160, v162
  v_mfma_f32_16x16x32_bf16 v[104:107], a[176:179], a[40:43], v[104:107]
  ds_read_b128 a[136:139], v214 offset:0
  v_permlane16_swap_b32 v161, v163
  v_mfma_f32_16x16x32_bf16 v[104:107], a[180:183], a[56:59], v[104:107]
  v_mul_f32 v32, s34, v32
  v_mul_f32 v33, s34, v33
  v_mfma_f32_16x16x32_bf16 v[108:111], a[180:183], a[60:63], v[108:111]
  ds_read_b128 a[140:143], v215 offset:0
  v_mul_f32 v34, s34, v34
  v_mfma_f32_16x16x32_bf16 v[108:111], a[176:179], a[44:47], v[108:111]
  s_waitcnt lgkmcnt(4)
  v_mul_f32 v35, s34, v35
  v_mul_f32 v48, s34, v48
  v_mfma_f32_16x16x32_bf16 v[112:115], a[184:187], a[32:35], v[112:115]
  v_mul_f32 v49, s34, v49
  v_mul_f32 v50, s34, v50
  v_mfma_f32_16x16x32_bf16 v[112:115], a[188:191], a[48:51], v[112:115]
  v_mul_f32 v51, s34, v51
  v_cvt_pk_bf16_f32 v132, v32, v33
  v_mfma_f32_16x16x32_bf16 v[116:119], a[188:191], a[52:55], v[116:119]
  v_cvt_pk_bf16_f32 v133, v34, v35
  v_cvt_pk_bf16_f32 v134, v48, v49
  v_mfma_f32_16x16x32_bf16 v[116:119], a[184:187], a[36:39], v[116:119]
  v_cvt_pk_bf16_f32 v135, v50, v51
  v_permlane16_swap_b32 v176, v178
  v_mfma_f32_16x16x32_bf16 v[120:123], a[184:187], a[40:43], v[120:123]
  v_permlane16_swap_b32 v177, v179
  v_mul_f32 v36, s34, v36
  v_mfma_f32_16x16x32_bf16 v[120:123], a[188:191], a[56:59], v[120:123]
  v_mul_f32 v37, s34, v37
  v_mul_f32 v38, s34, v38
  v_mfma_f32_16x16x32_bf16 v[124:127], a[188:191], a[60:63], v[124:127]
  v_mul_f32 v39, s34, v39
  v_mul_f32 v52, s34, v52
  v_mfma_f32_16x16x32_bf16 v[124:127], a[184:187], a[44:47], v[124:127]
  s_waitcnt lgkmcnt(0)
  v_mul_f32 v53, s34, v53
  v_mul_f32 v54, s34, v54
  v_mul_f32 v55, s34, v55
  v_cvt_pk_bf16_f32 v148, v36, v37
  v_cvt_pk_bf16_f32 v149, v38, v39
  v_cvt_pk_bf16_f32 v150, v52, v53
  v_cvt_pk_bf16_f32 v151, v54, v55
  v_permlane16_swap_b32 v132, v134
  v_permlane16_swap_b32 v133, v135
  v_pk_mul_f32 v[40:41], v[40:41], s[34:35] op_sel_hi:[1,0]
  v_pk_mul_f32 v[42:43], v[42:43], s[34:35] op_sel_hi:[1,0]
  v_pk_mul_f32 v[56:57], v[56:57], s[34:35] op_sel_hi:[1,0]
  v_pk_mul_f32 v[58:59], v[58:59], s[34:35] op_sel_hi:[1,0]
  v_cvt_pk_bf16_f32 v164, v40, v41
  v_cvt_pk_bf16_f32 v165, v42, v43
  v_cvt_pk_bf16_f32 v166, v56, v57
  v_cvt_pk_bf16_f32 v167, v58, v59
  v_permlane16_swap_b32 v148, v150
  v_permlane16_swap_b32 v149, v151
  v_pk_mul_f32 v[44:45], v[44:45], s[34:35] op_sel_hi:[1,0]
  v_pk_mul_f32 v[46:47], v[46:47], s[34:35] op_sel_hi:[1,0]
  v_pk_mul_f32 v[60:61], v[60:61], s[34:35] op_sel_hi:[1,0]
  v_pk_mul_f32 v[62:63], v[62:63], s[34:35] op_sel_hi:[1,0]
  v_cvt_pk_bf16_f32 v180, v44, v45
  v_cvt_pk_bf16_f32 v181, v46, v47
  v_cvt_pk_bf16_f32 v182, v60, v61
  v_cvt_pk_bf16_f32 v183, v62, v63
  v_permlane16_swap_b32 v164, v166
  v_permlane16_swap_b32 v165, v167
  v_pk_mul_f32 v[64:65], v[64:65], s[34:35] op_sel_hi:[1,0]
  v_pk_mul_f32 v[66:67], v[66:67], s[34:35] op_sel_hi:[1,0]
  v_pk_mul_f32 v[80:81], v[80:81], s[34:35] op_sel_hi:[1,0]
  v_pk_mul_f32 v[82:83], v[82:83], s[34:35] op_sel_hi:[1,0]
  v_cvt_pk_bf16_f32 v136, v64, v65
  v_cvt_pk_bf16_f32 v137, v66, v67
  v_cvt_pk_bf16_f32 v138, v80, v81
  v_cvt_pk_bf16_f32 v139, v82, v83
  v_permlane16_swap_b32 v180, v182
  v_permlane16_swap_b32 v181, v183
  v_pk_mul_f32 v[68:69], v[68:69], s[34:35] op_sel_hi:[1,0]
  v_pk_mul_f32 v[70:71], v[70:71], s[34:35] op_sel_hi:[1,0]
  v_pk_mul_f32 v[84:85], v[84:85], s[34:35] op_sel_hi:[1,0]
  v_pk_mul_f32 v[86:87], v[86:87], s[34:35] op_sel_hi:[1,0]
  v_cvt_pk_bf16_f32 v152, v68, v69
  v_cvt_pk_bf16_f32 v153, v70, v71
  v_cvt_pk_bf16_f32 v154, v84, v85
  v_cvt_pk_bf16_f32 v155, v86, v87
  v_permlane16_swap_b32 v136, v138
  v_permlane16_swap_b32 v137, v139
  v_pk_mul_f32 v[72:73], v[72:73], s[34:35] op_sel_hi:[1,0]
  v_pk_mul_f32 v[74:75], v[74:75], s[34:35] op_sel_hi:[1,0]
  v_pk_mul_f32 v[88:89], v[88:89], s[34:35] op_sel_hi:[1,0]
  v_pk_mul_f32 v[90:91], v[90:91], s[34:35] op_sel_hi:[1,0]
  v_cvt_pk_bf16_f32 v168, v72, v73
  v_cvt_pk_bf16_f32 v169, v74, v75
  v_cvt_pk_bf16_f32 v170, v88, v89
  v_cvt_pk_bf16_f32 v171, v90, v91
  v_permlane16_swap_b32 v152, v154
  v_permlane16_swap_b32 v153, v155
  v_pk_mul_f32 v[76:77], v[76:77], s[34:35] op_sel_hi:[1,0]
  v_pk_mul_f32 v[78:79], v[78:79], s[34:35] op_sel_hi:[1,0]
  v_pk_mul_f32 v[92:93], v[92:93], s[34:35] op_sel_hi:[1,0]
  v_pk_mul_f32 v[94:95], v[94:95], s[34:35] op_sel_hi:[1,0]
  v_cvt_pk_bf16_f32 v184, v76, v77
  v_cvt_pk_bf16_f32 v185, v78, v79
  v_cvt_pk_bf16_f32 v186, v92, v93
  v_cvt_pk_bf16_f32 v187, v94, v95
  v_permlane16_swap_b32 v168, v170
  v_permlane16_swap_b32 v169, v171
  v_pk_mul_f32 v[96:97], v[96:97], s[34:35] op_sel_hi:[1,0]
  v_pk_mul_f32 v[98:99], v[98:99], s[34:35] op_sel_hi:[1,0]
  v_pk_mul_f32 v[112:113], v[112:113], s[34:35] op_sel_hi:[1,0]
  v_pk_mul_f32 v[114:115], v[114:115], s[34:35] op_sel_hi:[1,0]
  v_cvt_pk_bf16_f32 v140, v96, v97
  v_cvt_pk_bf16_f32 v141, v98, v99
  v_cvt_pk_bf16_f32 v142, v112, v113
  v_cvt_pk_bf16_f32 v143, v114, v115
  v_permlane16_swap_b32 v184, v186
  v_permlane16_swap_b32 v185, v187
  v_pk_mul_f32 v[100:101], v[100:101], s[34:35] op_sel_hi:[1,0]
  v_pk_mul_f32 v[102:103], v[102:103], s[34:35] op_sel_hi:[1,0]
  v_pk_mul_f32 v[116:117], v[116:117], s[34:35] op_sel_hi:[1,0]
  v_pk_mul_f32 v[118:119], v[118:119], s[34:35] op_sel_hi:[1,0]
  v_cvt_pk_bf16_f32 v156, v100, v101
  v_cvt_pk_bf16_f32 v157, v102, v103
  v_cvt_pk_bf16_f32 v158, v116, v117
  v_cvt_pk_bf16_f32 v159, v118, v119
  v_permlane16_swap_b32 v140, v142
  v_permlane16_swap_b32 v141, v143
  v_pk_mul_f32 v[104:105], v[104:105], s[34:35] op_sel_hi:[1,0]
  v_pk_mul_f32 v[106:107], v[106:107], s[34:35] op_sel_hi:[1,0]
  v_pk_mul_f32 v[120:121], v[120:121], s[34:35] op_sel_hi:[1,0]
  v_pk_mul_f32 v[122:123], v[122:123], s[34:35] op_sel_hi:[1,0]
  v_cvt_pk_bf16_f32 v172, v104, v105
  v_cvt_pk_bf16_f32 v173, v106, v107
  v_cvt_pk_bf16_f32 v174, v120, v121
  v_cvt_pk_bf16_f32 v175, v122, v123
  v_permlane16_swap_b32 v156, v158
  v_permlane16_swap_b32 v157, v159
  v_pk_mul_f32 v[108:109], v[108:109], s[34:35] op_sel_hi:[1,0]
  v_pk_mul_f32 v[110:111], v[110:111], s[34:35] op_sel_hi:[1,0]
  v_pk_mul_f32 v[124:125], v[124:125], s[34:35] op_sel_hi:[1,0]
  v_pk_mul_f32 v[126:127], v[126:127], s[34:35] op_sel_hi:[1,0]
  v_cvt_pk_bf16_f32 v188, v108, v109
  v_cvt_pk_bf16_f32 v189, v110, v111
  v_cvt_pk_bf16_f32 v190, v124, v125
  v_cvt_pk_bf16_f32 v191, v126, v127
  v_permlane16_swap_b32 v172, v174
  v_permlane16_swap_b32 v173, v175
  v_permlane16_swap_b32 v188, v190
  v_permlane16_swap_b32 v189, v191
  v_mfma_f32_16x16x32_bf16 v[0:3], a[128:131], v[128:131], 0
  s_add_u32 m0, s28, 81920
  ds_read_b128 a[144:147], v212 offset:4096
  s_mov_b32 s20, s90
  s_mov_b32 s21, s91
  s_mov_b32 s22, 2211840
  s_mov_b32 s23, 0x20000
  s_mov_b32 s44, s92
  s_mov_b32 s45, s93
  s_mov_b32 s46, 2211840
  s_mov_b32 s47, 0x20000
  v_lshrrev_b32 v226, 4, v242
  v_mfma_f32_16x16x32_bf16 v[0:3], a[132:135], v[132:135], v[0:3]
  buffer_load_dwordx4 v236, s[16:19], s29 offen offset:0 lds
  v_mfma_f32_16x16x32_bf16 v[0:3], a[136:139], v[136:139], v[0:3]
  ds_read_b128 a[148:151], v213 offset:4096
  v_mul_u32_u24 v226, 0xd80, v226
  v_mfma_f32_16x16x32_bf16 v[0:3], a[140:143], v[140:143], v[0:3]
  buffer_load_dwordx4 v237, s[16:19], s29 offen offset:1024 lds
  s_mul_i32 s35, s3, 552960
  s_lshl_b32 s38, s33, 4
  s_add_u32 s35, s35, s38
  v_mfma_f32_16x16x32_bf16 v[8:11], a[140:143], v[156:159], 0
  ds_read_b128 a[152:155], v214 offset:4096
  v_mfma_f32_16x16x32_bf16 v[8:11], a[136:139], v[152:155], v[8:11]
  buffer_load_dwordx4 v236, s[16:19], s29 offen offset:2048 lds
  v_mfma_f32_16x16x32_bf16 v[8:11], a[132:135], v[148:151], v[8:11]
  ds_read_b128 a[156:159], v215 offset:4096
  v_mfma_f32_16x16x32_bf16 v[8:11], a[128:131], v[144:147], v[8:11]
  buffer_load_dwordx4 v237, s[16:19], s29 offen offset:3072 lds
  v_mfma_f32_16x16x32_bf16 v[16:19], a[128:131], v[160:163], 0
  s_add_u32 s29, s29, 16384
  s_add_u32 m0, s28, 32768
  v_mfma_f32_16x16x32_bf16 v[16:19], a[132:135], v[164:167], v[16:19]
  buffer_load_dwordx4 v232, s[12:15], s29 offen offset:0 lds
  v_mfma_f32_16x16x32_bf16 v[16:19], a[136:139], v[168:171], v[16:19]
  buffer_load_dwordx4 v233, s[12:15], s29 offen offset:1024 lds
  v_mfma_f32_16x16x32_bf16 v[16:19], a[140:143], v[172:175], v[16:19]
  v_max3_f32 v192, v0, v1, v2
  v_max3_f32 v196, v8, v9, v10
  v_mfma_f32_16x16x32_bf16 v[24:27], a[140:143], v[188:191], 0
  v_max_f32 v192, v192, v3
  v_max_f32 v196, v196, v11
  v_mfma_f32_16x16x32_bf16 v[24:27], a[136:139], v[184:187], v[24:27]
  v_mov_b32 v245, v192
  v_mov_b32 v246, v196
  v_mfma_f32_16x16x32_bf16 v[24:27], a[132:135], v[180:183], v[24:27]
  v_permlane16_swap_b32 v192, v245
  v_permlane16_swap_b32 v196, v246
  v_mfma_f32_16x16x32_bf16 v[24:27], a[128:131], v[176:179], v[24:27]
  s_waitcnt lgkmcnt(0)
  v_max_f32 v192, v192, v245
  v_max_f32 v196, v196, v246
  v_mfma_f32_16x16x32_bf16 v[4:7], a[144:147], v[128:131], 0
  ds_read_b128 a[128:131], v212 offset:8192
  v_mov_b32 v245, v192
  v_mfma_f32_16x16x32_bf16 v[4:7], a[148:151], v[132:135], v[4:7]
  v_mov_b32 v246, v196
  v_permlane32_swap_b32 v192, v245
  v_mfma_f32_16x16x32_bf16 v[4:7], a[152:155], v[136:139], v[4:7]
  ds_read_b128 a[132:135], v213 offset:8192
  v_permlane32_swap_b32 v196, v246
  v_mfma_f32_16x16x32_bf16 v[4:7], a[156:159], v[140:143], v[4:7]
  v_max_f32 v192, v192, v245
  v_max_f32 v196, v196, v246
  v_mfma_f32_16x16x32_bf16 v[12:15], a[156:159], v[156:159], 0
  ds_read_b128 a[136:139], v214 offset:8192
  v_sub_f32 v193, 0, v192
  v_mfma_f32_16x16x32_bf16 v[12:15], a[152:155], v[152:155], v[12:15]
  v_sub_f32 v197, 0, v196
  v_sub_f32 v194, 0, v192
  v_mfma_f32_16x16x32_bf16 v[12:15], a[148:151], v[148:151], v[12:15]
  ds_read_b128 a[140:143], v215 offset:8192
  v_sub_f32 v198, 0, v196
  v_mfma_f32_16x16x32_bf16 v[12:15], a[144:147], v[144:147], v[12:15]
  v_sub_f32 v195, 0, v192
  v_sub_f32 v199, 0, v196
  v_mfma_f32_16x16x32_bf16 v[20:23], a[144:147], v[160:163], 0
  buffer_load_dwordx4 v234, s[12:15], s29 offen offset:2048 lds
  v_mfma_f32_16x16x32_bf16 v[20:23], a[148:151], v[164:167], v[20:23]
  v_sub_f32 v192, 0, v192
  v_sub_f32 v196, 0, v196
  v_mfma_f32_16x16x32_bf16 v[20:23], a[152:155], v[168:171], v[20:23]
  buffer_load_dwordx4 v235, s[12:15], s29 offen offset:3072 lds
  v_mfma_f32_16x16x32_bf16 v[20:23], a[156:159], v[172:175], v[20:23]
  v_max3_f32 v200, v16, v17, v18
  v_max3_f32 v204, v24, v25, v26
  v_mfma_f32_16x16x32_bf16 v[28:31], a[156:159], v[188:191], 0
  v_max_f32 v200, v200, v19
  v_max_f32 v204, v204, v27
  v_mfma_f32_16x16x32_bf16 v[28:31], a[152:155], v[184:187], v[28:31]
  v_mov_b32 v247, v200
  v_mov_b32 v248, v204
  v_mfma_f32_16x16x32_bf16 v[28:31], a[148:151], v[180:183], v[28:31]
  v_permlane16_swap_b32 v200, v247
  v_permlane16_swap_b32 v204, v248
  v_max_f32 v200, v200, v247
  v_max_f32 v204, v204, v248
  v_mov_b32 v247, v200
  v_mov_b32 v248, v204
  s_nop 0
  v_permlane32_swap_b32 v200, v247
  v_permlane32_swap_b32 v204, v248
  v_max_f32 v200, v200, v247
  v_max_f32 v204, v204, v248
  v_sub_f32 v201, 0, v200
  v_sub_f32 v205, 0, v204
  v_sub_f32 v202, 0, v200
  v_sub_f32 v206, 0, v204
  v_sub_f32 v203, 0, v200
  v_sub_f32 v207, 0, v204
  v_sub_f32 v200, 0, v200
  v_sub_f32 v204, 0, v204
  v_mfma_f32_16x16x32_bf16 v[28:31], a[144:147], v[176:179], v[28:31]
  s_waitcnt lgkmcnt(0)
  v_add_f32 v0, v192, v0
  v_add_f32 v1, v192, v1
  v_mfma_f32_16x16x32_bf16 v[32:35], a[128:131], v[128:131], v[192:195]
  ds_read_b128 a[144:147], v212 offset:12288
  v_add_f32 v2, v192, v2
  v_mfma_f32_16x16x32_bf16 v[32:35], a[132:135], v[132:135], v[32:35]
  v_add_f32 v3, v192, v3
  v_mfma_f32_16x16x32_bf16 v[32:35], a[136:139], v[136:139], v[32:35]
  ds_read_b128 a[148:151], v213 offset:12288
  v_mfma_f32_16x16x32_bf16 v[32:35], a[140:143], v[140:143], v[32:35]
  v_exp_f32 v0, v0
  v_mfma_f32_16x16x32_bf16 v[40:43], a[140:143], v[156:159], v[196:199]
  ds_read_b128 a[152:155], v214 offset:12288
  v_mfma_f32_16x16x32_bf16 v[40:43], a[136:139], v[152:155], v[40:43]
  v_exp_f32 v1, v1
  v_mfma_f32_16x16x32_bf16 v[40:43], a[132:135], v[148:151], v[40:43]
  ds_read_b128 a[156:159], v215 offset:12288
  v_mfma_f32_16x16x32_bf16 v[40:43], a[128:131], v[144:147], v[40:43]
  v_exp_f32 v2, v2
  v_mfma_f32_16x16x32_bf16 v[48:51], a[128:131], v[160:163], v[200:203]
  s_add_u32 m0, s50, 0
  v_cvt_pk_bf16_f32 v0, v0, v1
  v_mfma_f32_16x16x32_bf16 v[48:51], a[132:135], v[164:167], v[48:51]
  v_exp_f32 v3, v3
  v_mfma_f32_16x16x32_bf16 v[48:51], a[136:139], v[168:171], v[48:51]
  v_add_f32 v8, v196, v8
  v_add_f32 v9, v196, v9
  v_mfma_f32_16x16x32_bf16 v[48:51], a[140:143], v[172:175], v[48:51]
  v_add_f32 v10, v196, v10
  v_add_f32 v11, v196, v11
  v_mfma_f32_16x16x32_bf16 v[56:59], a[140:143], v[188:191], v[204:207]
  v_exp_f32 v8, v8
  v_mfma_f32_16x16x32_bf16 v[56:59], a[136:139], v[184:187], v[56:59]
  v_exp_f32 v9, v9
  buffer_load_dwordx4 v226, s[20:23], s35 offen lds
  v_mfma_f32_16x16x32_bf16 v[56:59], a[132:135], v[180:183], v[56:59]
  v_exp_f32 v10, v10
  v_mfma_f32_16x16x32_bf16 v[56:59], a[128:131], v[176:179], v[56:59]
  s_waitcnt lgkmcnt(0)
  v_cvt_pk_bf16_f32 v8, v8, v9
  v_mfma_f32_16x16x32_bf16 v[36:39], a[144:147], v[128:131], v[192:195]
  s_waitcnt vmcnt(9)
  v_exp_f32 v11, v11
  v_mfma_f32_16x16x32_bf16 v[36:39], a[148:151], v[132:135], v[36:39]
  s_barrier
  v_cvt_pk_bf16_f32 v1, v2, v3
  v_add_f32 v16, v200, v16
  v_mfma_f32_16x16x32_bf16 v[36:39], a[152:155], v[136:139], v[36:39]
  ds_read_b128 a[128:131], v212 offset:16384
  v_add_f32 v17, v200, v17
  v_mfma_f32_16x16x32_bf16 v[36:39], a[156:159], v[140:143], v[36:39]
  v_add_f32 v18, v200, v18
  v_add_f32 v19, v200, v19
  v_mfma_f32_16x16x32_bf16 v[44:47], a[156:159], v[156:159], v[196:199]
  ds_read_b128 a[132:135], v213 offset:16384
  v_mfma_f32_16x16x32_bf16 v[44:47], a[152:155], v[152:155], v[44:47]
  v_exp_f32 v16, v16
  v_mfma_f32_16x16x32_bf16 v[44:47], a[148:151], v[148:151], v[44:47]
  ds_read_b128 a[136:139], v214 offset:16384
  v_mfma_f32_16x16x32_bf16 v[44:47], a[144:147], v[144:147], v[44:47]
  v_exp_f32 v17, v17
  v_mfma_f32_16x16x32_bf16 v[52:55], a[144:147], v[160:163], v[200:203]
  ds_read_b128 a[140:143], v215 offset:16384
  v_mfma_f32_16x16x32_bf16 v[52:55], a[148:151], v[164:167], v[52:55]
  v_exp_f32 v18, v18
  v_mfma_f32_16x16x32_bf16 v[52:55], a[152:155], v[168:171], v[52:55]
  v_cvt_pk_bf16_f32 v16, v16, v17
  v_mfma_f32_16x16x32_bf16 v[52:55], a[156:159], v[172:175], v[52:55]
  v_exp_f32 v19, v19
  v_mfma_f32_16x16x32_bf16 v[60:63], a[156:159], v[188:191], v[204:207]
  v_cvt_pk_bf16_f32 v9, v10, v11
  v_add_f32 v24, v204, v24
  v_mfma_f32_16x16x32_bf16 v[60:63], a[152:155], v[184:187], v[60:63]
  v_add_f32 v25, v204, v25
  v_add_f32 v26, v204, v26
  v_mfma_f32_16x16x32_bf16 v[60:63], a[148:151], v[180:183], v[60:63]
  v_add_f32 v27, v204, v27
  v_mfma_f32_16x16x32_bf16 v[60:63], a[144:147], v[176:179], v[60:63]
  s_waitcnt lgkmcnt(0)
  v_exp_f32 v24, v24
  v_exp_f32 v25, v25
  v_exp_f32 v26, v26
  v_cvt_pk_bf16_f32 v24, v24, v25
  v_exp_f32 v27, v27
  v_cvt_pk_bf16_f32 v17, v18, v19
  v_add_f32 v4, v192, v4
  v_add_f32 v5, v192, v5
  v_add_f32 v6, v192, v6
  v_add_f32 v7, v192, v7
  v_exp_f32 v4, v4
  v_exp_f32 v5, v5
  v_exp_f32 v6, v6
  v_cvt_pk_bf16_f32 v2, v4, v5
  v_exp_f32 v7, v7
  v_cvt_pk_bf16_f32 v25, v26, v27
  v_add_f32 v12, v196, v12
  v_add_f32 v13, v196, v13
  v_add_f32 v14, v196, v14
  v_add_f32 v15, v196, v15
  v_exp_f32 v12, v12
  v_exp_f32 v13, v13
  v_exp_f32 v14, v14
  v_cvt_pk_bf16_f32 v10, v12, v13
  v_exp_f32 v15, v15
  v_cvt_pk_bf16_f32 v3, v6, v7
  v_add_f32 v20, v200, v20
  v_add_f32 v21, v200, v21
  v_add_f32 v22, v200, v22
  v_add_f32 v23, v200, v23
  v_exp_f32 v20, v20
  v_exp_f32 v21, v21
  v_exp_f32 v22, v22
  v_cvt_pk_bf16_f32 v18, v20, v21
  v_exp_f32 v23, v23
  v_cvt_pk_bf16_f32 v11, v14, v15
  v_add_f32 v28, v204, v28
  v_add_f32 v29, v204, v29
  v_add_f32 v30, v204, v30
  v_add_f32 v31, v204, v31
  v_exp_f32 v28, v28
  v_exp_f32 v29, v29
  v_exp_f32 v30, v30
  v_cvt_pk_bf16_f32 v26, v28, v29
  v_exp_f32 v31, v31
  v_cvt_pk_bf16_f32 v19, v22, v23
  v_exp_f32 v32, v32
  v_exp_f32 v33, v33
  v_exp_f32 v34, v34
  v_cvt_pk_bf16_f32 v32, v32, v33
  v_exp_f32 v35, v35
  v_cvt_pk_bf16_f32 v27, v30, v31
  v_exp_f32 v40, v40
  v_exp_f32 v41, v41
  v_exp_f32 v42, v42
  v_cvt_pk_bf16_f32 v40, v40, v41
  v_exp_f32 v43, v43
  v_cvt_pk_bf16_f32 v33, v34, v35
  v_exp_f32 v48, v48
  v_exp_f32 v49, v49
  v_exp_f32 v50, v50
  v_cvt_pk_bf16_f32 v48, v48, v49
  v_exp_f32 v51, v51
  v_cvt_pk_bf16_f32 v41, v42, v43
  v_exp_f32 v56, v56
  v_exp_f32 v57, v57
  v_exp_f32 v58, v58
  v_cvt_pk_bf16_f32 v56, v56, v57
  v_exp_f32 v59, v59
  v_cvt_pk_bf16_f32 v49, v50, v51
  v_exp_f32 v36, v36
  v_exp_f32 v37, v37
  v_exp_f32 v38, v38
  v_cvt_pk_bf16_f32 v34, v36, v37
  v_exp_f32 v39, v39
  v_cvt_pk_bf16_f32 v57, v58, v59
  v_exp_f32 v44, v44
  v_exp_f32 v45, v45
  v_exp_f32 v46, v46
  v_cvt_pk_bf16_f32 v42, v44, v45
  v_exp_f32 v47, v47
  v_cvt_pk_bf16_f32 v35, v38, v39
  v_exp_f32 v52, v52
  v_exp_f32 v53, v53
  v_exp_f32 v54, v54
  v_cvt_pk_bf16_f32 v50, v52, v53
  v_exp_f32 v55, v55
  v_cvt_pk_bf16_f32 v43, v46, v47
  v_exp_f32 v60, v60
  v_exp_f32 v61, v61
  v_exp_f32 v62, v62
  v_cvt_pk_bf16_f32 v58, v60, v61
  v_exp_f32 v63, v63
  v_cvt_pk_bf16_f32 v51, v54, v55
  v_cvt_pk_bf16_f32 v59, v62, v63
  v_mfma_f32_16x16x32_bf16 v[64:67], a[128:131], v[128:131], v[192:195]
  s_add_u32 m0, s28, 98304
  v_mfma_f32_16x16x32_bf16 v[64:67], a[132:135], v[132:135], v[64:67]
  ds_read_b128 a[144:147], v212 offset:20480
  v_mfma_f32_16x16x32_bf16 v[64:67], a[136:139], v[136:139], v[64:67]
  buffer_load_dwordx4 v236, s[16:19], s29 offen offset:0 lds
  v_mfma_f32_16x16x32_bf16 v[64:67], a[140:143], v[140:143], v[64:67]
  ds_read_b128 a[148:151], v213 offset:20480
  v_mfma_f32_16x16x32_bf16 v[72:75], a[140:143], v[156:159], v[196:199]
  buffer_load_dwordx4 v237, s[16:19], s29 offen offset:1024 lds
  v_mfma_f32_16x16x32_bf16 v[72:75], a[136:139], v[152:155], v[72:75]
  ds_read_b128 a[152:155], v214 offset:20480
  v_mfma_f32_16x16x32_bf16 v[72:75], a[132:135], v[148:151], v[72:75]
  buffer_load_dwordx4 v236, s[16:19], s29 offen offset:2048 lds
  v_mfma_f32_16x16x32_bf16 v[72:75], a[128:131], v[144:147], v[72:75]
  ds_read_b128 a[156:159], v215 offset:20480
  v_mfma_f32_16x16x32_bf16 v[80:83], a[128:131], v[160:163], v[200:203]
  v_exp_f32 v64, v64
  v_mfma_f32_16x16x32_bf16 v[80:83], a[132:135], v[164:167], v[80:83]
  buffer_load_dwordx4 v237, s[16:19], s29 offen offset:3072 lds
  v_mfma_f32_16x16x32_bf16 v[80:83], a[136:139], v[168:171], v[80:83]
  s_add_u32 s29, s29, 16384
  v_exp_f32 v65, v65
  v_mfma_f32_16x16x32_bf16 v[80:83], a[140:143], v[172:175], v[80:83]
  v_cvt_pk_bf16_f32 v64, v64, v65
  v_mfma_f32_16x16x32_bf16 v[88:91], a[140:143], v[188:191], v[204:207]
  s_add_u32 m0, s28, 49152
  v_exp_f32 v66, v66
  v_mfma_f32_16x16x32_bf16 v[88:91], a[136:139], v[184:187], v[88:91]
  buffer_load_dwordx4 v232, s[12:15], s29 offen offset:0 lds
  v_mfma_f32_16x16x32_bf16 v[88:91], a[132:135], v[180:183], v[88:91]
  s_waitcnt lgkmcnt(0)
  v_exp_f32 v67, v67
  v_mfma_f32_16x16x32_bf16 v[88:91], a[128:131], v[176:179], v[88:91]
  v_cvt_pk_bf16_f32 v65, v66, v67
  v_mfma_f32_16x16x32_bf16 v[68:71], a[144:147], v[128:131], v[192:195]
  v_exp_f32 v72, v72
  v_mfma_f32_16x16x32_bf16 v[68:71], a[148:151], v[132:135], v[68:71]
  ds_read_b128 a[128:131], v212 offset:24576
  v_mfma_f32_16x16x32_bf16 v[68:71], a[152:155], v[136:139], v[68:71]
  v_exp_f32 v73, v73
  v_mfma_f32_16x16x32_bf16 v[68:71], a[156:159], v[140:143], v[68:71]
  ds_read_b128 a[132:135], v213 offset:24576
  v_cvt_pk_bf16_f32 v72, v72, v73
  v_mfma_f32_16x16x32_bf16 v[76:79], a[156:159], v[156:159], v[196:199]
  v_exp_f32 v74, v74
  v_mfma_f32_16x16x32_bf16 v[76:79], a[152:155], v[152:155], v[76:79]
  ds_read_b128 a[136:139], v214 offset:24576
  v_mfma_f32_16x16x32_bf16 v[76:79], a[148:151], v[148:151], v[76:79]
  v_exp_f32 v75, v75
  v_mfma_f32_16x16x32_bf16 v[76:79], a[144:147], v[144:147], v[76:79]
  ds_read_b128 a[140:143], v215 offset:24576
  v_cvt_pk_bf16_f32 v73, v74, v75
  v_mfma_f32_16x16x32_bf16 v[84:87], a[144:147], v[160:163], v[200:203]
  v_exp_f32 v80, v80
  v_mfma_f32_16x16x32_bf16 v[84:87], a[148:151], v[164:167], v[84:87]
  buffer_load_dwordx4 v233, s[12:15], s29 offen offset:1024 lds
  v_mfma_f32_16x16x32_bf16 v[84:87], a[152:155], v[168:171], v[84:87]
  v_exp_f32 v81, v81
  v_mfma_f32_16x16x32_bf16 v[84:87], a[156:159], v[172:175], v[84:87]
  v_cvt_pk_bf16_f32 v80, v80, v81
  v_mfma_f32_16x16x32_bf16 v[92:95], a[156:159], v[188:191], v[204:207]
  v_exp_f32 v82, v82
  v_mfma_f32_16x16x32_bf16 v[92:95], a[152:155], v[184:187], v[92:95]
  buffer_load_dwordx4 v234, s[12:15], s29 offen offset:2048 lds
  v_mfma_f32_16x16x32_bf16 v[92:95], a[148:151], v[180:183], v[92:95]
  s_waitcnt lgkmcnt(0)
  v_exp_f32 v83, v83
  v_mfma_f32_16x16x32_bf16 v[92:95], a[144:147], v[176:179], v[92:95]
  v_cvt_pk_bf16_f32 v81, v82, v83
  v_mfma_f32_16x16x32_bf16 v[96:99], a[128:131], v[128:131], v[192:195]
  v_exp_f32 v88, v88
  v_mfma_f32_16x16x32_bf16 v[96:99], a[132:135], v[132:135], v[96:99]
  ds_read_b128 a[144:147], v212 offset:28672
  v_mfma_f32_16x16x32_bf16 v[96:99], a[136:139], v[136:139], v[96:99]
  v_exp_f32 v89, v89
  v_mfma_f32_16x16x32_bf16 v[96:99], a[140:143], v[140:143], v[96:99]
  ds_read_b128 a[148:151], v213 offset:28672
  v_cvt_pk_bf16_f32 v88, v88, v89
  v_mfma_f32_16x16x32_bf16 v[104:107], a[140:143], v[156:159], v[196:199]
  v_exp_f32 v90, v90
  v_mfma_f32_16x16x32_bf16 v[104:107], a[136:139], v[152:155], v[104:107]
  ds_read_b128 a[152:155], v214 offset:28672
  v_mfma_f32_16x16x32_bf16 v[104:107], a[132:135], v[148:151], v[104:107]
  v_exp_f32 v91, v91
  v_mfma_f32_16x16x32_bf16 v[104:107], a[128:131], v[144:147], v[104:107]
  ds_read_b128 a[156:159], v215 offset:28672
  v_cvt_pk_bf16_f32 v89, v90, v91
  v_mfma_f32_16x16x32_bf16 v[112:115], a[128:131], v[160:163], v[200:203]
  v_exp_f32 v68, v68
  v_mfma_f32_16x16x32_bf16 v[112:115], a[132:135], v[164:167], v[112:115]
  buffer_load_dwordx4 v235, s[12:15], s29 offen offset:3072 lds
  v_mfma_f32_16x16x32_bf16 v[112:115], a[136:139], v[168:171], v[112:115]
  v_exp_f32 v69, v69
  v_mfma_f32_16x16x32_bf16 v[112:115], a[140:143], v[172:175], v[112:115]
  v_cvt_pk_bf16_f32 v66, v68, v69
  v_mfma_f32_16x16x32_bf16 v[120:123], a[140:143], v[188:191], v[204:207]
  v_exp_f32 v70, v70
  v_mfma_f32_16x16x32_bf16 v[120:123], a[136:139], v[184:187], v[120:123]
  s_add_u32 m0, s50, 3072
  v_mfma_f32_16x16x32_bf16 v[120:123], a[132:135], v[180:183], v[120:123]
  s_waitcnt lgkmcnt(0)
  v_exp_f32 v71, v71
  v_mfma_f32_16x16x32_bf16 v[120:123], a[128:131], v[176:179], v[120:123]
  buffer_load_dwordx4 v226, s[44:47], s35 offen lds
  s_add_u32 s35, s35, 221184
  v_cvt_pk_bf16_f32 v67, v70, v71
  v_mfma_f32_16x16x32_bf16 v[100:103], a[144:147], v[128:131], v[192:195]
  v_exp_f32 v76, v76
  v_mfma_f32_16x16x32_bf16 v[100:103], a[148:151], v[132:135], v[100:103]
  ds_read_b64_tr_b16 a[160:161], v216 offset:0
  v_mfma_f32_16x16x32_bf16 v[100:103], a[152:155], v[136:139], v[100:103]
  v_exp_f32 v77, v77
  v_mfma_f32_16x16x32_bf16 v[100:103], a[156:159], v[140:143], v[100:103]
  ds_read_b64_tr_b16 a[162:163], v216 offset:4096
  v_cvt_pk_bf16_f32 v74, v76, v77
  v_mfma_f32_16x16x32_bf16 v[108:111], a[156:159], v[156:159], v[196:199]
  v_exp_f32 v78, v78
  v_mfma_f32_16x16x32_bf16 v[108:111], a[152:155], v[152:155], v[108:111]
  ds_read_b64_tr_b16 a[164:165], v216 offset:8192
  v_mfma_f32_16x16x32_bf16 v[108:111], a[148:151], v[148:151], v[108:111]
  v_exp_f32 v79, v79
  v_mfma_f32_16x16x32_bf16 v[108:111], a[144:147], v[144:147], v[108:111]
  ds_read_b64_tr_b16 a[166:167], v216 offset:12288
  v_cvt_pk_bf16_f32 v75, v78, v79
  v_mfma_f32_16x16x32_bf16 v[116:119], a[144:147], v[160:163], v[200:203]
  v_exp_f32 v84, v84
  v_mfma_f32_16x16x32_bf16 v[116:119], a[148:151], v[164:167], v[116:119]
  ds_read_b64_tr_b16 a[168:169], v217 offset:0
  v_mfma_f32_16x16x32_bf16 v[116:119], a[152:155], v[168:171], v[116:119]
  v_exp_f32 v85, v85
  v_mfma_f32_16x16x32_bf16 v[116:119], a[156:159], v[172:175], v[116:119]
  ds_read_b64_tr_b16 a[170:171], v217 offset:4096
  v_cvt_pk_bf16_f32 v82, v84, v85
  v_mfma_f32_16x16x32_bf16 v[124:127], a[156:159], v[188:191], v[204:207]
  v_exp_f32 v86, v86
  v_mfma_f32_16x16x32_bf16 v[124:127], a[152:155], v[184:187], v[124:127]
  ds_read_b64_tr_b16 a[172:173], v217 offset:8192
  v_mfma_f32_16x16x32_bf16 v[124:127], a[148:151], v[180:183], v[124:127]
  v_exp_f32 v87, v87
  v_mfma_f32_16x16x32_bf16 v[124:127], a[144:147], v[176:179], v[124:127]
  ds_read_b64_tr_b16 a[174:175], v217 offset:12288
  v_cvt_pk_bf16_f32 v83, v86, v87
  v_mfma_f32_16x16x32_bf16 a[192:195], a[208:211], v[0:3], 0
  v_exp_f32 v92, v92
  v_mfma_f32_16x16x32_bf16 a[192:195], a[208:211], v[32:35], a[192:195]
  ds_read_b64_tr_b16 a[176:177], v218 offset:0
  v_mfma_f32_16x16x32_bf16 a[196:199], a[208:211], v[8:11], 0
  v_exp_f32 v93, v93
  v_mfma_f32_16x16x32_bf16 a[196:199], a[208:211], v[40:43], a[196:199]
  ds_read_b64_tr_b16 a[178:179], v218 offset:4096
  v_cvt_pk_bf16_f32 v90, v92, v93
  v_mfma_f32_16x16x32_bf16 a[200:203], a[208:211], v[16:19], 0
  v_exp_f32 v94, v94
  v_mfma_f32_16x16x32_bf16 a[200:203], a[208:211], v[48:51], a[200:203]
  ds_read_b64_tr_b16 a[180:181], v218 offset:8192
  v_mfma_f32_16x16x32_bf16 a[204:207], a[208:211], v[24:27], 0
  s_waitcnt lgkmcnt(7)
  v_exp_f32 v95, v95
  v_mfma_f32_16x16x32_bf16 a[204:207], a[208:211], v[56:59], a[204:207]
  ds_read_b64_tr_b16 a[182:183], v218 offset:12288
  v_cvt_pk_bf16_f32 v91, v94, v95
  v_mfma_f32_16x16x32_bf16 a[0:3], a[160:163], v[0:3], 0
  v_exp_f32 v96, v96
  v_mfma_f32_16x16x32_bf16 a[0:3], a[164:167], v[32:35], a[0:3]
  ds_read_b64_tr_b16 a[184:185], v219 offset:0
  v_mfma_f32_16x16x32_bf16 a[4:7], a[164:167], v[40:43], 0
  v_exp_f32 v97, v97
  v_mfma_f32_16x16x32_bf16 a[4:7], a[160:163], v[8:11], a[4:7]
  ds_read_b64_tr_b16 a[186:187], v219 offset:4096
  v_cvt_pk_bf16_f32 v96, v96, v97
  v_mfma_f32_16x16x32_bf16 a[8:11], a[160:163], v[16:19], 0
  v_exp_f32 v98, v98
  v_mfma_f32_16x16x32_bf16 a[8:11], a[164:167], v[48:51], a[8:11]
  ds_read_b64_tr_b16 a[188:189], v219 offset:8192
  v_mfma_f32_16x16x32_bf16 a[12:15], a[164:167], v[56:59], 0
  s_waitcnt lgkmcnt(7)
  v_exp_f32 v99, v99
  v_mfma_f32_16x16x32_bf16 a[12:15], a[160:163], v[24:27], a[12:15]
  ds_read_b64_tr_b16 a[190:191], v219 offset:12288
  v_cvt_pk_bf16_f32 v97, v98, v99
  v_mfma_f32_16x16x32_bf16 a[16:19], a[168:171], v[0:3], 0
  v_exp_f32 v104, v104
  v_mfma_f32_16x16x32_bf16 a[16:19], a[172:175], v[32:35], a[16:19]
  ds_read_b64_tr_b16 a[160:161], v220 offset:0
  v_mfma_f32_16x16x32_bf16 a[20:23], a[172:175], v[40:43], 0
  v_exp_f32 v105, v105
  v_mfma_f32_16x16x32_bf16 a[20:23], a[168:171], v[8:11], a[20:23]
  ds_read_b64_tr_b16 a[162:163], v220 offset:4096
  v_cvt_pk_bf16_f32 v104, v104, v105
  v_mfma_f32_16x16x32_bf16 a[24:27], a[168:171], v[16:19], 0
  v_exp_f32 v106, v106
  v_mfma_f32_16x16x32_bf16 a[24:27], a[172:175], v[48:51], a[24:27]
  ds_read_b64_tr_b16 a[164:165], v220 offset:8192
  v_mfma_f32_16x16x32_bf16 a[28:31], a[172:175], v[56:59], 0
  s_waitcnt lgkmcnt(7)
  v_exp_f32 v107, v107
  v_mfma_f32_16x16x32_bf16 a[28:31], a[168:171], v[24:27], a[28:31]
  ds_read_b64_tr_b16 a[166:167], v220 offset:12288
  v_cvt_pk_bf16_f32 v105, v106, v107
  v_mfma_f32_16x16x32_bf16 a[32:35], a[176:179], v[0:3], 0
  v_exp_f32 v112, v112
  v_mfma_f32_16x16x32_bf16 a[32:35], a[180:183], v[32:35], a[32:35]
  ds_read_b64_tr_b16 a[168:169], v221 offset:0
  v_mfma_f32_16x16x32_bf16 a[36:39], a[180:183], v[40:43], 0
  v_exp_f32 v113, v113
  v_mfma_f32_16x16x32_bf16 a[36:39], a[176:179], v[8:11], a[36:39]
  ds_read_b64_tr_b16 a[170:171], v221 offset:4096
  v_cvt_pk_bf16_f32 v112, v112, v113
  v_mfma_f32_16x16x32_bf16 a[40:43], a[176:179], v[16:19], 0
  v_exp_f32 v114, v114
  v_mfma_f32_16x16x32_bf16 a[40:43], a[180:183], v[48:51], a[40:43]
  ds_read_b64_tr_b16 a[172:173], v221 offset:8192
  v_mfma_f32_16x16x32_bf16 a[44:47], a[180:183], v[56:59], 0
  s_waitcnt lgkmcnt(7)
  v_exp_f32 v115, v115
  v_mfma_f32_16x16x32_bf16 a[44:47], a[176:179], v[24:27], a[44:47]
  ds_read_b64_tr_b16 a[174:175], v221 offset:12288
  v_cvt_pk_bf16_f32 v113, v114, v115
  v_mfma_f32_16x16x32_bf16 a[48:51], a[184:187], v[0:3], 0
  v_exp_f32 v120, v120
  v_mfma_f32_16x16x32_bf16 a[48:51], a[188:191], v[32:35], a[48:51]
  ds_read_b64_tr_b16 a[176:177], v222 offset:0
  v_mfma_f32_16x16x32_bf16 a[52:55], a[188:191], v[40:43], 0
  v_exp_f32 v121, v121
  v_mfma_f32_16x16x32_bf16 a[52:55], a[184:187], v[8:11], a[52:55]
  ds_read_b64_tr_b16 a[178:179], v222 offset:4096
  v_cvt_pk_bf16_f32 v120, v120, v121
  v_mfma_f32_16x16x32_bf16 a[56:59], a[184:187], v[16:19], 0
  v_exp_f32 v122, v122
  v_mfma_f32_16x16x32_bf16 a[56:59], a[188:191], v[48:51], a[56:59]
  ds_read_b64_tr_b16 a[180:181], v222 offset:8192
  v_mfma_f32_16x16x32_bf16 a[60:63], a[188:191], v[56:59], 0
  s_waitcnt lgkmcnt(7)
  v_exp_f32 v123, v123
  v_mfma_f32_16x16x32_bf16 a[60:63], a[184:187], v[24:27], a[60:63]
  ds_read_b64_tr_b16 a[182:183], v222 offset:12288
  v_cvt_pk_bf16_f32 v121, v122, v123
  v_mfma_f32_16x16x32_bf16 a[64:67], a[160:163], v[0:3], 0
  v_exp_f32 v100, v100
  v_mfma_f32_16x16x32_bf16 a[64:67], a[164:167], v[32:35], a[64:67]
  ds_read_b64_tr_b16 a[184:185], v223 offset:0
  v_mfma_f32_16x16x32_bf16 a[68:71], a[164:167], v[40:43], 0
  v_exp_f32 v101, v101
  v_mfma_f32_16x16x32_bf16 a[68:71], a[160:163], v[8:11], a[68:71]
  ds_read_b64_tr_b16 a[186:187], v223 offset:4096
  v_cvt_pk_bf16_f32 v98, v100, v101
  v_mfma_f32_16x16x32_bf16 a[72:75], a[160:163], v[16:19], 0
  v_exp_f32 v102, v102
  v_mfma_f32_16x16x32_bf16 a[72:75], a[164:167], v[48:51], a[72:75]
  ds_read_b64_tr_b16 a[188:189], v223 offset:8192
  v_mfma_f32_16x16x32_bf16 a[76:79], a[164:167], v[56:59], 0
  s_waitcnt lgkmcnt(7)
  v_exp_f32 v103, v103
  v_mfma_f32_16x16x32_bf16 a[76:79], a[160:163], v[24:27], a[76:79]
  ds_read_b64_tr_b16 a[190:191], v223 offset:12288
  v_cvt_pk_bf16_f32 v99, v102, v103
  v_mfma_f32_16x16x32_bf16 a[80:83], a[168:171], v[0:3], 0
  s_waitcnt vmcnt(10)
  v_exp_f32 v108, v108
  v_mfma_f32_16x16x32_bf16 a[80:83], a[172:175], v[32:35], a[80:83]
  v_mfma_f32_16x16x32_bf16 a[84:87], a[172:175], v[40:43], 0
  s_barrier
  v_exp_f32 v109, v109
  v_mfma_f32_16x16x32_bf16 a[84:87], a[168:171], v[8:11], a[84:87]
  ds_read_b128 a[128:131], v212 offset:32768
  v_cvt_pk_bf16_f32 v106, v108, v109
  v_mfma_f32_16x16x32_bf16 a[88:91], a[168:171], v[16:19], 0
  v_exp_f32 v110, v110
  v_mfma_f32_16x16x32_bf16 a[88:91], a[172:175], v[48:51], a[88:91]
  ds_read_b128 a[132:135], v213 offset:32768
  v_mfma_f32_16x16x32_bf16 a[92:95], a[172:175], v[56:59], 0
  s_waitcnt lgkmcnt(6)
  v_exp_f32 v111, v111
  v_mfma_f32_16x16x32_bf16 a[92:95], a[168:171], v[24:27], a[92:95]
  ds_read_b128 a[136:139], v214 offset:32768
  v_cvt_pk_bf16_f32 v107, v110, v111
  v_mfma_f32_16x16x32_bf16 a[96:99], a[176:179], v[0:3], 0
  s_mul_i32 s38, s3, 20480
  v_exp_f32 v116, v116
  v_mfma_f32_16x16x32_bf16 a[96:99], a[180:183], v[32:35], a[96:99]
  ds_read_b128 a[140:143], v215 offset:32768
  buffer_load_dwordx4 a[212:215], v243, s[24:27], s38 offen sc1
  s_add_u32 s38, s38, 4096
  v_mfma_f32_16x16x32_bf16 a[100:103], a[180:183], v[40:43], 0
  v_exp_f32 v117, v117
  v_mfma_f32_16x16x32_bf16 a[100:103], a[176:179], v[8:11], a[100:103]
  v_cvt_pk_bf16_f32 v114, v116, v117
  v_mfma_f32_16x16x32_bf16 a[104:107], a[176:179], v[16:19], 0
  v_exp_f32 v118, v118
  v_mfma_f32_16x16x32_bf16 a[104:107], a[180:183], v[48:51], a[104:107]
  v_mfma_f32_16x16x32_bf16 a[108:111], a[180:183], v[56:59], 0
  s_waitcnt lgkmcnt(4)
  v_exp_f32 v119, v119
  v_mfma_f32_16x16x32_bf16 a[108:111], a[176:179], v[24:27], a[108:111]
  v_cvt_pk_bf16_f32 v115, v118, v119
  v_mfma_f32_16x16x32_bf16 a[112:115], a[184:187], v[0:3], 0
  v_exp_f32 v124, v124
  v_mfma_f32_16x16x32_bf16 a[112:115], a[188:191], v[32:35], a[112:115]
  v_mfma_f32_16x16x32_bf16 a[116:119], a[188:191], v[40:43], 0
  v_exp_f32 v125, v125
  v_mfma_f32_16x16x32_bf16 a[116:119], a[184:187], v[8:11], a[116:119]
  v_cvt_pk_bf16_f32 v122, v124, v125
  v_mfma_f32_16x16x32_bf16 a[120:123], a[184:187], v[16:19], 0
  v_exp_f32 v126, v126
  v_mfma_f32_16x16x32_bf16 a[120:123], a[188:191], v[48:51], a[120:123]
  v_mfma_f32_16x16x32_bf16 a[124:127], a[188:191], v[56:59], 0
  s_waitcnt lgkmcnt(0)
  v_exp_f32 v127, v127
  v_mfma_f32_16x16x32_bf16 a[124:127], a[184:187], v[24:27], a[124:127]
  v_cvt_pk_bf16_f32 v123, v126, v127
  v_mfma_f32_16x16x32_bf16 v[0:3], a[128:131], v[128:131], v[192:195]
  s_add_u32 m0, s28, 114688
  v_mfma_f32_16x16x32_bf16 v[0:3], a[132:135], v[132:135], v[0:3]
  ds_read_b128 a[144:147], v212 offset:36864
  v_mfma_f32_16x16x32_bf16 v[0:3], a[136:139], v[136:139], v[0:3]
  buffer_load_dwordx4 v236, s[16:19], s29 offen offset:0 lds
  v_mfma_f32_16x16x32_bf16 v[0:3], a[140:143], v[140:143], v[0:3]
  ds_read_b128 a[148:151], v213 offset:36864
  v_mfma_f32_16x16x32_bf16 v[8:11], a[140:143], v[156:159], v[196:199]
  buffer_load_dwordx4 v237, s[16:19], s29 offen offset:1024 lds
  v_mfma_f32_16x16x32_bf16 v[8:11], a[136:139], v[152:155], v[8:11]
  ds_read_b128 a[152:155], v214 offset:36864
  v_mfma_f32_16x16x32_bf16 v[8:11], a[132:135], v[148:151], v[8:11]
  buffer_load_dwordx4 v236, s[16:19], s29 offen offset:2048 lds
  v_mfma_f32_16x16x32_bf16 v[8:11], a[128:131], v[144:147], v[8:11]
  ds_read_b128 a[156:159], v215 offset:36864
  v_mfma_f32_16x16x32_bf16 v[16:19], a[128:131], v[160:163], v[200:203]
  v_exp_f32 v0, v0
  v_mfma_f32_16x16x32_bf16 v[16:19], a[132:135], v[164:167], v[16:19]
  buffer_load_dwordx4 v237, s[16:19], s29 offen offset:3072 lds
  v_mfma_f32_16x16x32_bf16 v[16:19], a[136:139], v[168:171], v[16:19]
  s_add_u32 s29, s29, 16384
  v_exp_f32 v1, v1
  v_mfma_f32_16x16x32_bf16 v[16:19], a[140:143], v[172:175], v[16:19]
  v_cvt_pk_bf16_f32 v0, v0, v1
  v_mfma_f32_16x16x32_bf16 v[24:27], a[140:143], v[188:191], v[204:207]
  s_add_u32 m0, s28, 0
  v_exp_f32 v2, v2
  v_mfma_f32_16x16x32_bf16 v[24:27], a[136:139], v[184:187], v[24:27]
  buffer_load_dwordx4 v232, s[12:15], s29 offen offset:0 lds
  v_mfma_f32_16x16x32_bf16 v[24:27], a[132:135], v[180:183], v[24:27]
  s_waitcnt lgkmcnt(0)
  v_exp_f32 v3, v3
  v_mfma_f32_16x16x32_bf16 v[24:27], a[128:131], v[176:179], v[24:27]
  v_cvt_pk_bf16_f32 v1, v2, v3
  v_mfma_f32_16x16x32_bf16 v[4:7], a[144:147], v[128:131], v[192:195]
  v_exp_f32 v8, v8
  v_mfma_f32_16x16x32_bf16 v[4:7], a[148:151], v[132:135], v[4:7]
  ds_read_b128 a[128:131], v212 offset:40960
  v_mfma_f32_16x16x32_bf16 v[4:7], a[152:155], v[136:139], v[4:7]
  v_exp_f32 v9, v9
  v_mfma_f32_16x16x32_bf16 v[4:7], a[156:159], v[140:143], v[4:7]
  ds_read_b128 a[132:135], v213 offset:40960
  v_cvt_pk_bf16_f32 v8, v8, v9
  v_mfma_f32_16x16x32_bf16 v[12:15], a[156:159], v[156:159], v[196:199]
  v_exp_f32 v10, v10
  v_mfma_f32_16x16x32_bf16 v[12:15], a[152:155], v[152:155], v[12:15]
  ds_read_b128 a[136:139], v214 offset:40960
  v_mfma_f32_16x16x32_bf16 v[12:15], a[148:151], v[148:151], v[12:15]
  v_exp_f32 v11, v11
  v_mfma_f32_16x16x32_bf16 v[12:15], a[144:147], v[144:147], v[12:15]
  ds_read_b128 a[140:143], v215 offset:40960
  v_cvt_pk_bf16_f32 v9, v10, v11
  v_mfma_f32_16x16x32_bf16 v[20:23], a[144:147], v[160:163], v[200:203]
  v_exp_f32 v16, v16
  v_mfma_f32_16x16x32_bf16 v[20:23], a[148:151], v[164:167], v[20:23]
  buffer_load_dwordx4 v233, s[12:15], s29 offen offset:1024 lds
  v_mfma_f32_16x16x32_bf16 v[20:23], a[152:155], v[168:171], v[20:23]
  v_exp_f32 v17, v17
  v_mfma_f32_16x16x32_bf16 v[20:23], a[156:159], v[172:175], v[20:23]
  v_cvt_pk_bf16_f32 v16, v16, v17
  v_mfma_f32_16x16x32_bf16 v[28:31], a[156:159], v[188:191], v[204:207]
  v_exp_f32 v18, v18
  v_mfma_f32_16x16x32_bf16 v[28:31], a[152:155], v[184:187], v[28:31]
  buffer_load_dwordx4 v234, s[12:15], s29 offen offset:2048 lds
  v_mfma_f32_16x16x32_bf16 v[28:31], a[148:151], v[180:183], v[28:31]
  s_waitcnt lgkmcnt(0)
  v_exp_f32 v19, v19
  v_mfma_f32_16x16x32_bf16 v[28:31], a[144:147], v[176:179], v[28:31]
  v_cvt_pk_bf16_f32 v17, v18, v19
  v_mfma_f32_16x16x32_bf16 v[32:35], a[128:131], v[128:131], v[192:195]
  v_exp_f32 v24, v24
  v_mfma_f32_16x16x32_bf16 v[32:35], a[132:135], v[132:135], v[32:35]
  ds_read_b128 a[144:147], v212 offset:45056
  v_mfma_f32_16x16x32_bf16 v[32:35], a[136:139], v[136:139], v[32:35]
  v_exp_f32 v25, v25
  v_mfma_f32_16x16x32_bf16 v[32:35], a[140:143], v[140:143], v[32:35]
  ds_read_b128 a[148:151], v213 offset:45056
  v_cvt_pk_bf16_f32 v24, v24, v25
  v_mfma_f32_16x16x32_bf16 v[40:43], a[140:143], v[156:159], v[196:199]
  v_exp_f32 v26, v26
  v_mfma_f32_16x16x32_bf16 v[40:43], a[136:139], v[152:155], v[40:43]
  ds_read_b128 a[152:155], v214 offset:45056
  v_mfma_f32_16x16x32_bf16 v[40:43], a[132:135], v[148:151], v[40:43]
  v_exp_f32 v27, v27
  v_mfma_f32_16x16x32_bf16 v[40:43], a[128:131], v[144:147], v[40:43]
  ds_read_b128 a[156:159], v215 offset:45056
  v_cvt_pk_bf16_f32 v25, v26, v27
  v_mfma_f32_16x16x32_bf16 v[48:51], a[128:131], v[160:163], v[200:203]
  v_exp_f32 v4, v4
  v_mfma_f32_16x16x32_bf16 v[48:51], a[132:135], v[164:167], v[48:51]
  buffer_load_dwordx4 v235, s[12:15], s29 offen offset:3072 lds
  v_mfma_f32_16x16x32_bf16 v[48:51], a[136:139], v[168:171], v[48:51]
  v_exp_f32 v5, v5
  v_mfma_f32_16x16x32_bf16 v[48:51], a[140:143], v[172:175], v[48:51]
  v_cvt_pk_bf16_f32 v2, v4, v5
  v_mfma_f32_16x16x32_bf16 v[56:59], a[140:143], v[188:191], v[204:207]
  v_exp_f32 v6, v6
  v_mfma_f32_16x16x32_bf16 v[56:59], a[136:139], v[184:187], v[56:59]
  s_add_u32 m0, s50, 1024
  v_mfma_f32_16x16x32_bf16 v[56:59], a[132:135], v[180:183], v[56:59]
  s_waitcnt lgkmcnt(0)
  v_exp_f32 v7, v7
  v_mfma_f32_16x16x32_bf16 v[56:59], a[128:131], v[176:179], v[56:59]
  buffer_load_dwordx4 v226, s[20:23], s35 offen lds
  v_cvt_pk_bf16_f32 v3, v6, v7
  v_mfma_f32_16x16x32_bf16 v[36:39], a[144:147], v[128:131], v[192:195]
  v_exp_f32 v12, v12
  v_mfma_f32_16x16x32_bf16 v[36:39], a[148:151], v[132:135], v[36:39]
  ds_read_b64_tr_b16 a[160:161], v216 offset:16384
  v_mfma_f32_16x16x32_bf16 v[36:39], a[152:155], v[136:139], v[36:39]
  v_exp_f32 v13, v13
  v_mfma_f32_16x16x32_bf16 v[36:39], a[156:159], v[140:143], v[36:39]
  ds_read_b64_tr_b16 a[162:163], v216 offset:20480
  v_cvt_pk_bf16_f32 v10, v12, v13
  v_mfma_f32_16x16x32_bf16 v[44:47], a[156:159], v[156:159], v[196:199]
  v_exp_f32 v14, v14
  v_mfma_f32_16x16x32_bf16 v[44:47], a[152:155], v[152:155], v[44:47]
  ds_read_b64_tr_b16 a[164:165], v216 offset:24576
  v_mfma_f32_16x16x32_bf16 v[44:47], a[148:151], v[148:151], v[44:47]
  v_exp_f32 v15, v15
  v_mfma_f32_16x16x32_bf16 v[44:47], a[144:147], v[144:147], v[44:47]
  ds_read_b64_tr_b16 a[166:167], v216 offset:28672
  v_cvt_pk_bf16_f32 v11, v14, v15
  v_mfma_f32_16x16x32_bf16 v[52:55], a[144:147], v[160:163], v[200:203]
  v_exp_f32 v20, v20
  v_mfma_f32_16x16x32_bf16 v[52:55], a[148:151], v[164:167], v[52:55]
  ds_read_b64_tr_b16 a[168:169], v217 offset:16384
  v_mfma_f32_16x16x32_bf16 v[52:55], a[152:155], v[168:171], v[52:55]
  v_exp_f32 v21, v21
  v_mfma_f32_16x16x32_bf16 v[52:55], a[156:159], v[172:175], v[52:55]
  ds_read_b64_tr_b16 a[170:171], v217 offset:20480
  v_cvt_pk_bf16_f32 v18, v20, v21
  v_mfma_f32_16x16x32_bf16 v[60:63], a[156:159], v[188:191], v[204:207]
  v_exp_f32 v22, v22
  v_mfma_f32_16x16x32_bf16 v[60:63], a[152:155], v[184:187], v[60:63]
  ds_read_b64_tr_b16 a[172:173], v217 offset:24576
  v_mfma_f32_16x16x32_bf16 v[60:63], a[148:151], v[180:183], v[60:63]
  v_exp_f32 v23, v23
  v_mfma_f32_16x16x32_bf16 v[60:63], a[144:147], v[176:179], v[60:63]
  ds_read_b64_tr_b16 a[174:175], v217 offset:28672
  v_cvt_pk_bf16_f32 v19, v22, v23
  v_mfma_f32_16x16x32_bf16 a[192:195], a[208:211], v[64:67], a[192:195]
  v_exp_f32 v28, v28
  v_mfma_f32_16x16x32_bf16 a[192:195], a[208:211], v[96:99], a[192:195]
  ds_read_b64_tr_b16 a[176:177], v218 offset:16384
  v_mfma_f32_16x16x32_bf16 a[196:199], a[208:211], v[72:75], a[196:199]
  v_exp_f32 v29, v29
  v_mfma_f32_16x16x32_bf16 a[196:199], a[208:211], v[104:107], a[196:199]
  ds_read_b64_tr_b16 a[178:179], v218 offset:20480
  v_cvt_pk_bf16_f32 v26, v28, v29
  v_mfma_f32_16x16x32_bf16 a[200:203], a[208:211], v[80:83], a[200:203]
  v_exp_f32 v30, v30
  v_mfma_f32_16x16x32_bf16 a[200:203], a[208:211], v[112:115], a[200:203]
  ds_read_b64_tr_b16 a[180:181], v218 offset:24576
  v_mfma_f32_16x16x32_bf16 a[204:207], a[208:211], v[88:91], a[204:207]
  s_waitcnt lgkmcnt(7)
  v_exp_f32 v31, v31
  v_mfma_f32_16x16x32_bf16 a[204:207], a[208:211], v[120:123], a[204:207]
  ds_read_b64_tr_b16 a[182:183], v218 offset:28672
  v_cvt_pk_bf16_f32 v27, v30, v31
  v_mfma_f32_16x16x32_bf16 a[0:3], a[160:163], v[64:67], a[0:3]
  v_exp_f32 v32, v32
  v_mfma_f32_16x16x32_bf16 a[0:3], a[164:167], v[96:99], a[0:3]
  ds_read_b64_tr_b16 a[184:185], v219 offset:16384
  v_mfma_f32_16x16x32_bf16 a[4:7], a[164:167], v[104:107], a[4:7]
  v_exp_f32 v33, v33
  v_mfma_f32_16x16x32_bf16 a[4:7], a[160:163], v[72:75], a[4:7]
  ds_read_b64_tr_b16 a[186:187], v219 offset:20480
  v_cvt_pk_bf16_f32 v32, v32, v33
  v_mfma_f32_16x16x32_bf16 a[8:11], a[160:163], v[80:83], a[8:11]
  v_exp_f32 v34, v34
  v_mfma_f32_16x16x32_bf16 a[8:11], a[164:167], v[112:115], a[8:11]
  ds_read_b64_tr_b16 a[188:189], v219 offset:24576
  v_mfma_f32_16x16x32_bf16 a[12:15], a[164:167], v[120:123], a[12:15]
  s_waitcnt lgkmcnt(7)
  v_exp_f32 v35, v35
  v_mfma_f32_16x16x32_bf16 a[12:15], a[160:163], v[88:91], a[12:15]
  ds_read_b64_tr_b16 a[190:191], v219 offset:28672
  v_cvt_pk_bf16_f32 v33, v34, v35
  v_mfma_f32_16x16x32_bf16 a[16:19], a[168:171], v[64:67], a[16:19]
  v_exp_f32 v40, v40
  v_mfma_f32_16x16x32_bf16 a[16:19], a[172:175], v[96:99], a[16:19]
  ds_read_b64_tr_b16 a[160:161], v220 offset:16384
  v_mfma_f32_16x16x32_bf16 a[20:23], a[172:175], v[104:107], a[20:23]
  v_exp_f32 v41, v41
  v_mfma_f32_16x16x32_bf16 a[20:23], a[168:171], v[72:75], a[20:23]
  ds_read_b64_tr_b16 a[162:163], v220 offset:20480
  v_cvt_pk_bf16_f32 v40, v40, v41
  v_mfma_f32_16x16x32_bf16 a[24:27], a[168:171], v[80:83], a[24:27]
  v_exp_f32 v42, v42
  v_mfma_f32_16x16x32_bf16 a[24:27], a[172:175], v[112:115], a[24:27]
  ds_read_b64_tr_b16 a[164:165], v220 offset:24576
  v_mfma_f32_16x16x32_bf16 a[28:31], a[172:175], v[120:123], a[28:31]
  s_waitcnt lgkmcnt(7)
  v_exp_f32 v43, v43
  v_mfma_f32_16x16x32_bf16 a[28:31], a[168:171], v[88:91], a[28:31]
  ds_read_b64_tr_b16 a[166:167], v220 offset:28672
  v_cvt_pk_bf16_f32 v41, v42, v43
  v_mfma_f32_16x16x32_bf16 a[32:35], a[176:179], v[64:67], a[32:35]
  v_exp_f32 v48, v48
  v_mfma_f32_16x16x32_bf16 a[32:35], a[180:183], v[96:99], a[32:35]
  ds_read_b64_tr_b16 a[168:169], v221 offset:16384
  v_mfma_f32_16x16x32_bf16 a[36:39], a[180:183], v[104:107], a[36:39]
  v_exp_f32 v49, v49
  v_mfma_f32_16x16x32_bf16 a[36:39], a[176:179], v[72:75], a[36:39]
  ds_read_b64_tr_b16 a[170:171], v221 offset:20480
  v_cvt_pk_bf16_f32 v48, v48, v49
  v_mfma_f32_16x16x32_bf16 a[40:43], a[176:179], v[80:83], a[40:43]
  v_exp_f32 v50, v50
  v_mfma_f32_16x16x32_bf16 a[40:43], a[180:183], v[112:115], a[40:43]
  ds_read_b64_tr_b16 a[172:173], v221 offset:24576
  v_mfma_f32_16x16x32_bf16 a[44:47], a[180:183], v[120:123], a[44:47]
  s_waitcnt lgkmcnt(7)
  v_exp_f32 v51, v51
  v_mfma_f32_16x16x32_bf16 a[44:47], a[176:179], v[88:91], a[44:47]
  ds_read_b64_tr_b16 a[174:175], v221 offset:28672
  v_cvt_pk_bf16_f32 v49, v50, v51
  v_mfma_f32_16x16x32_bf16 a[48:51], a[184:187], v[64:67], a[48:51]
  v_exp_f32 v56, v56
  v_mfma_f32_16x16x32_bf16 a[48:51], a[188:191], v[96:99], a[48:51]
  ds_read_b64_tr_b16 a[176:177], v222 offset:16384
  v_mfma_f32_16x16x32_bf16 a[52:55], a[188:191], v[104:107], a[52:55]
  v_exp_f32 v57, v57
  v_mfma_f32_16x16x32_bf16 a[52:55], a[184:187], v[72:75], a[52:55]
  ds_read_b64_tr_b16 a[178:179], v222 offset:20480
  v_cvt_pk_bf16_f32 v56, v56, v57
  v_mfma_f32_16x16x32_bf16 a[56:59], a[184:187], v[80:83], a[56:59]
  v_exp_f32 v58, v58
  v_mfma_f32_16x16x32_bf16 a[56:59], a[188:191], v[112:115], a[56:59]
  ds_read_b64_tr_b16 a[180:181], v222 offset:24576
  v_mfma_f32_16x16x32_bf16 a[60:63], a[188:191], v[120:123], a[60:63]
  s_waitcnt lgkmcnt(7)
  v_exp_f32 v59, v59
  v_mfma_f32_16x16x32_bf16 a[60:63], a[184:187], v[88:91], a[60:63]
  ds_read_b64_tr_b16 a[182:183], v222 offset:28672
  v_cvt_pk_bf16_f32 v57, v58, v59
  v_mfma_f32_16x16x32_bf16 a[64:67], a[160:163], v[64:67], a[64:67]
  v_exp_f32 v36, v36
  v_mfma_f32_16x16x32_bf16 a[64:67], a[164:167], v[96:99], a[64:67]
  ds_read_b64_tr_b16 a[184:185], v223 offset:16384
  v_mfma_f32_16x16x32_bf16 a[68:71], a[164:167], v[104:107], a[68:71]
  v_exp_f32 v37, v37
  v_mfma_f32_16x16x32_bf16 a[68:71], a[160:163], v[72:75], a[68:71]
  ds_read_b64_tr_b16 a[186:187], v223 offset:20480
  v_cvt_pk_bf16_f32 v34, v36, v37
  v_mfma_f32_16x16x32_bf16 a[72:75], a[160:163], v[80:83], a[72:75]
  v_exp_f32 v38, v38
  v_mfma_f32_16x16x32_bf16 a[72:75], a[164:167], v[112:115], a[72:75]
  ds_read_b64_tr_b16 a[188:189], v223 offset:24576
  v_mfma_f32_16x16x32_bf16 a[76:79], a[164:167], v[120:123], a[76:79]
  s_waitcnt lgkmcnt(7)
  v_exp_f32 v39, v39
  v_mfma_f32_16x16x32_bf16 a[76:79], a[160:163], v[88:91], a[76:79]
  ds_read_b64_tr_b16 a[190:191], v223 offset:28672
  v_cvt_pk_bf16_f32 v35, v38, v39
  v_mfma_f32_16x16x32_bf16 a[80:83], a[168:171], v[64:67], a[80:83]
  s_waitcnt vmcnt(11)
  v_exp_f32 v44, v44
  v_mfma_f32_16x16x32_bf16 a[80:83], a[172:175], v[96:99], a[80:83]
  v_mfma_f32_16x16x32_bf16 a[84:87], a[172:175], v[104:107], a[84:87]
  s_barrier
  v_exp_f32 v45, v45
  v_mfma_f32_16x16x32_bf16 a[84:87], a[168:171], v[72:75], a[84:87]
  ds_read_b128 a[128:131], v212 offset:49152
  v_cvt_pk_bf16_f32 v42, v44, v45
  v_mfma_f32_16x16x32_bf16 a[88:91], a[168:171], v[80:83], a[88:91]
  v_exp_f32 v46, v46
  v_mfma_f32_16x16x32_bf16 a[88:91], a[172:175], v[112:115], a[88:91]
  ds_read_b128 a[132:135], v213 offset:49152
  v_mfma_f32_16x16x32_bf16 a[92:95], a[172:175], v[120:123], a[92:95]
  s_waitcnt lgkmcnt(6)
  v_exp_f32 v47, v47
  v_mfma_f32_16x16x32_bf16 a[92:95], a[168:171], v[88:91], a[92:95]
  ds_read_b128 a[136:139], v214 offset:49152
  v_cvt_pk_bf16_f32 v43, v46, v47
  v_mfma_f32_16x16x32_bf16 a[96:99], a[176:179], v[64:67], a[96:99]
  v_exp_f32 v52, v52
  v_mfma_f32_16x16x32_bf16 a[96:99], a[180:183], v[96:99], a[96:99]
  ds_read_b128 a[140:143], v215 offset:49152
  buffer_load_dwordx4 a[216:219], v243, s[24:27], s38 offen sc1
  s_add_u32 s38, s38, 4096
  v_mfma_f32_16x16x32_bf16 a[100:103], a[180:183], v[104:107], a[100:103]
  v_exp_f32 v53, v53
  v_mfma_f32_16x16x32_bf16 a[100:103], a[176:179], v[72:75], a[100:103]
  v_cvt_pk_bf16_f32 v50, v52, v53
  v_mfma_f32_16x16x32_bf16 a[104:107], a[176:179], v[80:83], a[104:107]
  v_exp_f32 v54, v54
  v_mfma_f32_16x16x32_bf16 a[104:107], a[180:183], v[112:115], a[104:107]
  v_mfma_f32_16x16x32_bf16 a[108:111], a[180:183], v[120:123], a[108:111]
  s_waitcnt lgkmcnt(4)
  v_exp_f32 v55, v55
  v_mfma_f32_16x16x32_bf16 a[108:111], a[176:179], v[88:91], a[108:111]
  v_cvt_pk_bf16_f32 v51, v54, v55
  v_mfma_f32_16x16x32_bf16 a[112:115], a[184:187], v[64:67], a[112:115]
  v_exp_f32 v60, v60
  v_mfma_f32_16x16x32_bf16 a[112:115], a[188:191], v[96:99], a[112:115]
  v_mfma_f32_16x16x32_bf16 a[116:119], a[188:191], v[104:107], a[116:119]
  v_exp_f32 v61, v61
  v_mfma_f32_16x16x32_bf16 a[116:119], a[184:187], v[72:75], a[116:119]
  v_cvt_pk_bf16_f32 v58, v60, v61
  v_mfma_f32_16x16x32_bf16 a[120:123], a[184:187], v[80:83], a[120:123]
  v_exp_f32 v62, v62
  v_mfma_f32_16x16x32_bf16 a[120:123], a[188:191], v[112:115], a[120:123]
  v_mfma_f32_16x16x32_bf16 a[124:127], a[188:191], v[120:123], a[124:127]
  s_waitcnt lgkmcnt(0)
  v_exp_f32 v63, v63
  v_mfma_f32_16x16x32_bf16 a[124:127], a[184:187], v[88:91], a[124:127]
  v_cvt_pk_bf16_f32 v59, v62, v63
  v_mfma_f32_16x16x32_bf16 v[64:67], a[128:131], v[128:131], v[192:195]
  s_add_u32 m0, s28, 65536
  v_mfma_f32_16x16x32_bf16 v[64:67], a[132:135], v[132:135], v[64:67]
  ds_read_b128 a[144:147], v212 offset:53248
  v_mfma_f32_16x16x32_bf16 v[64:67], a[136:139], v[136:139], v[64:67]
  buffer_load_dwordx4 v236, s[16:19], s29 offen offset:0 lds
  v_mfma_f32_16x16x32_bf16 v[64:67], a[140:143], v[140:143], v[64:67]
  ds_read_b128 a[148:151], v213 offset:53248
  v_mfma_f32_16x16x32_bf16 v[72:75], a[140:143], v[156:159], v[196:199]
  buffer_load_dwordx4 v237, s[16:19], s29 offen offset:1024 lds
  v_mfma_f32_16x16x32_bf16 v[72:75], a[136:139], v[152:155], v[72:75]
  ds_read_b128 a[152:155], v214 offset:53248
  v_mfma_f32_16x16x32_bf16 v[72:75], a[132:135], v[148:151], v[72:75]
  buffer_load_dwordx4 v236, s[16:19], s29 offen offset:2048 lds
  v_mfma_f32_16x16x32_bf16 v[72:75], a[128:131], v[144:147], v[72:75]
  ds_read_b128 a[156:159], v215 offset:53248
  v_mfma_f32_16x16x32_bf16 v[80:83], a[128:131], v[160:163], v[200:203]
  v_exp_f32 v64, v64
  v_mfma_f32_16x16x32_bf16 v[80:83], a[132:135], v[164:167], v[80:83]
  buffer_load_dwordx4 v237, s[16:19], s29 offen offset:3072 lds
  v_mfma_f32_16x16x32_bf16 v[80:83], a[136:139], v[168:171], v[80:83]
  s_add_u32 s29, s29, 16384
  v_exp_f32 v65, v65
  v_mfma_f32_16x16x32_bf16 v[80:83], a[140:143], v[172:175], v[80:83]
  v_cvt_pk_bf16_f32 v64, v64, v65
  v_mfma_f32_16x16x32_bf16 v[88:91], a[140:143], v[188:191], v[204:207]
  s_add_u32 m0, s28, 16384
  v_exp_f32 v66, v66
  v_mfma_f32_16x16x32_bf16 v[88:91], a[136:139], v[184:187], v[88:91]
  buffer_load_dwordx4 v232, s[12:15], s29 offen offset:0 lds
  v_mfma_f32_16x16x32_bf16 v[88:91], a[132:135], v[180:183], v[88:91]
  s_waitcnt lgkmcnt(0)
  v_exp_f32 v67, v67
  v_mfma_f32_16x16x32_bf16 v[88:91], a[128:131], v[176:179], v[88:91]
  v_cvt_pk_bf16_f32 v65, v66, v67
  v_mfma_f32_16x16x32_bf16 v[68:71], a[144:147], v[128:131], v[192:195]
  v_exp_f32 v72, v72
  v_mfma_f32_16x16x32_bf16 v[68:71], a[148:151], v[132:135], v[68:71]
  ds_read_b128 a[128:131], v212 offset:57344
  v_mfma_f32_16x16x32_bf16 v[68:71], a[152:155], v[136:139], v[68:71]
  v_exp_f32 v73, v73
  v_mfma_f32_16x16x32_bf16 v[68:71], a[156:159], v[140:143], v[68:71]
  ds_read_b128 a[132:135], v213 offset:57344
  v_cvt_pk_bf16_f32 v72, v72, v73
  v_mfma_f32_16x16x32_bf16 v[76:79], a[156:159], v[156:159], v[196:199]
  v_exp_f32 v74, v74
  v_mfma_f32_16x16x32_bf16 v[76:79], a[152:155], v[152:155], v[76:79]
  ds_read_b128 a[136:139], v214 offset:57344
  v_mfma_f32_16x16x32_bf16 v[76:79], a[148:151], v[148:151], v[76:79]
  v_exp_f32 v75, v75
  v_mfma_f32_16x16x32_bf16 v[76:79], a[144:147], v[144:147], v[76:79]
  ds_read_b128 a[140:143], v215 offset:57344
  v_cvt_pk_bf16_f32 v73, v74, v75
  v_mfma_f32_16x16x32_bf16 v[84:87], a[144:147], v[160:163], v[200:203]
  v_exp_f32 v80, v80
  v_mfma_f32_16x16x32_bf16 v[84:87], a[148:151], v[164:167], v[84:87]
  buffer_load_dwordx4 v233, s[12:15], s29 offen offset:1024 lds
  v_mfma_f32_16x16x32_bf16 v[84:87], a[152:155], v[168:171], v[84:87]
  v_exp_f32 v81, v81
  v_mfma_f32_16x16x32_bf16 v[84:87], a[156:159], v[172:175], v[84:87]
  v_cvt_pk_bf16_f32 v80, v80, v81
  v_mfma_f32_16x16x32_bf16 v[92:95], a[156:159], v[188:191], v[204:207]
  v_exp_f32 v82, v82
  v_mfma_f32_16x16x32_bf16 v[92:95], a[152:155], v[184:187], v[92:95]
  buffer_load_dwordx4 v234, s[12:15], s29 offen offset:2048 lds
  v_mfma_f32_16x16x32_bf16 v[92:95], a[148:151], v[180:183], v[92:95]
  s_waitcnt lgkmcnt(0)
  v_exp_f32 v83, v83
  v_mfma_f32_16x16x32_bf16 v[92:95], a[144:147], v[176:179], v[92:95]
  v_cvt_pk_bf16_f32 v81, v82, v83
  v_mfma_f32_16x16x32_bf16 v[96:99], a[128:131], v[128:131], v[192:195]
  v_exp_f32 v88, v88
  v_mfma_f32_16x16x32_bf16 v[96:99], a[132:135], v[132:135], v[96:99]
  ds_read_b128 a[144:147], v212 offset:61440
  v_mfma_f32_16x16x32_bf16 v[96:99], a[136:139], v[136:139], v[96:99]
  v_exp_f32 v89, v89
  v_mfma_f32_16x16x32_bf16 v[96:99], a[140:143], v[140:143], v[96:99]
  ds_read_b128 a[148:151], v213 offset:61440
  v_cvt_pk_bf16_f32 v88, v88, v89
  v_mfma_f32_16x16x32_bf16 v[104:107], a[140:143], v[156:159], v[196:199]
  v_exp_f32 v90, v90
  v_mfma_f32_16x16x32_bf16 v[104:107], a[136:139], v[152:155], v[104:107]
  ds_read_b128 a[152:155], v214 offset:61440
  v_mfma_f32_16x16x32_bf16 v[104:107], a[132:135], v[148:151], v[104:107]
  v_exp_f32 v91, v91
  v_mfma_f32_16x16x32_bf16 v[104:107], a[128:131], v[144:147], v[104:107]
  ds_read_b128 a[156:159], v215 offset:61440
  v_cvt_pk_bf16_f32 v89, v90, v91
  v_mfma_f32_16x16x32_bf16 v[112:115], a[128:131], v[160:163], v[200:203]
  v_exp_f32 v68, v68
  v_mfma_f32_16x16x32_bf16 v[112:115], a[132:135], v[164:167], v[112:115]
  buffer_load_dwordx4 v235, s[12:15], s29 offen offset:3072 lds
  v_mfma_f32_16x16x32_bf16 v[112:115], a[136:139], v[168:171], v[112:115]
  v_exp_f32 v69, v69
  v_mfma_f32_16x16x32_bf16 v[112:115], a[140:143], v[172:175], v[112:115]
  v_cvt_pk_bf16_f32 v66, v68, v69
  v_mfma_f32_16x16x32_bf16 v[120:123], a[140:143], v[188:191], v[204:207]
  v_exp_f32 v70, v70
  v_mfma_f32_16x16x32_bf16 v[120:123], a[136:139], v[184:187], v[120:123]
  s_add_u32 m0, s50, 4096
  v_mfma_f32_16x16x32_bf16 v[120:123], a[132:135], v[180:183], v[120:123]
  s_waitcnt lgkmcnt(0)
  v_exp_f32 v71, v71
  v_mfma_f32_16x16x32_bf16 v[120:123], a[128:131], v[176:179], v[120:123]
  buffer_load_dwordx4 v226, s[44:47], s35 offen lds
  s_add_u32 s35, s35, 221184
  v_cvt_pk_bf16_f32 v67, v70, v71
  v_mfma_f32_16x16x32_bf16 v[100:103], a[144:147], v[128:131], v[192:195]
  v_exp_f32 v76, v76
  v_mfma_f32_16x16x32_bf16 v[100:103], a[148:151], v[132:135], v[100:103]
  ds_read_b64_tr_b16 a[160:161], v216 offset:32768
  v_mfma_f32_16x16x32_bf16 v[100:103], a[152:155], v[136:139], v[100:103]
  v_exp_f32 v77, v77
  v_mfma_f32_16x16x32_bf16 v[100:103], a[156:159], v[140:143], v[100:103]
  ds_read_b64_tr_b16 a[162:163], v216 offset:36864
  v_cvt_pk_bf16_f32 v74, v76, v77
  v_mfma_f32_16x16x32_bf16 v[108:111], a[156:159], v[156:159], v[196:199]
  v_exp_f32 v78, v78
  v_mfma_f32_16x16x32_bf16 v[108:111], a[152:155], v[152:155], v[108:111]
  ds_read_b64_tr_b16 a[164:165], v216 offset:40960
  v_mfma_f32_16x16x32_bf16 v[108:111], a[148:151], v[148:151], v[108:111]
  v_exp_f32 v79, v79
  v_mfma_f32_16x16x32_bf16 v[108:111], a[144:147], v[144:147], v[108:111]
  ds_read_b64_tr_b16 a[166:167], v216 offset:45056
  v_cvt_pk_bf16_f32 v75, v78, v79
  v_mfma_f32_16x16x32_bf16 v[116:119], a[144:147], v[160:163], v[200:203]
  v_exp_f32 v84, v84
  v_mfma_f32_16x16x32_bf16 v[116:119], a[148:151], v[164:167], v[116:119]
  ds_read_b64_tr_b16 a[168:169], v217 offset:32768
  v_mfma_f32_16x16x32_bf16 v[116:119], a[152:155], v[168:171], v[116:119]
  v_exp_f32 v85, v85
  v_mfma_f32_16x16x32_bf16 v[116:119], a[156:159], v[172:175], v[116:119]
  ds_read_b64_tr_b16 a[170:171], v217 offset:36864
  v_cvt_pk_bf16_f32 v82, v84, v85
  v_mfma_f32_16x16x32_bf16 v[124:127], a[156:159], v[188:191], v[204:207]
  v_exp_f32 v86, v86
  v_mfma_f32_16x16x32_bf16 v[124:127], a[152:155], v[184:187], v[124:127]
  ds_read_b64_tr_b16 a[172:173], v217 offset:40960
  v_mfma_f32_16x16x32_bf16 v[124:127], a[148:151], v[180:183], v[124:127]
  v_exp_f32 v87, v87
  v_mfma_f32_16x16x32_bf16 v[124:127], a[144:147], v[176:179], v[124:127]
  ds_read_b64_tr_b16 a[174:175], v217 offset:45056
  v_cvt_pk_bf16_f32 v83, v86, v87
  v_mfma_f32_16x16x32_bf16 a[192:195], a[208:211], v[0:3], a[192:195]
  v_exp_f32 v92, v92
  v_mfma_f32_16x16x32_bf16 a[192:195], a[208:211], v[32:35], a[192:195]
  ds_read_b64_tr_b16 a[176:177], v218 offset:32768
  v_mfma_f32_16x16x32_bf16 a[196:199], a[208:211], v[8:11], a[196:199]
  v_exp_f32 v93, v93
  v_mfma_f32_16x16x32_bf16 a[196:199], a[208:211], v[40:43], a[196:199]
  ds_read_b64_tr_b16 a[178:179], v218 offset:36864
  v_cvt_pk_bf16_f32 v90, v92, v93
  v_mfma_f32_16x16x32_bf16 a[200:203], a[208:211], v[16:19], a[200:203]
  v_exp_f32 v94, v94
  v_mfma_f32_16x16x32_bf16 a[200:203], a[208:211], v[48:51], a[200:203]
  ds_read_b64_tr_b16 a[180:181], v218 offset:40960
  v_mfma_f32_16x16x32_bf16 a[204:207], a[208:211], v[24:27], a[204:207]
  s_waitcnt lgkmcnt(7)
  v_exp_f32 v95, v95
  v_mfma_f32_16x16x32_bf16 a[204:207], a[208:211], v[56:59], a[204:207]
  ds_read_b64_tr_b16 a[182:183], v218 offset:45056
  v_cvt_pk_bf16_f32 v91, v94, v95
  v_mfma_f32_16x16x32_bf16 a[0:3], a[160:163], v[0:3], a[0:3]
  v_exp_f32 v96, v96
  v_mfma_f32_16x16x32_bf16 a[0:3], a[164:167], v[32:35], a[0:3]
  ds_read_b64_tr_b16 a[184:185], v219 offset:32768
  v_mfma_f32_16x16x32_bf16 a[4:7], a[164:167], v[40:43], a[4:7]
  v_exp_f32 v97, v97
  v_mfma_f32_16x16x32_bf16 a[4:7], a[160:163], v[8:11], a[4:7]
  ds_read_b64_tr_b16 a[186:187], v219 offset:36864
  v_cvt_pk_bf16_f32 v96, v96, v97
  v_mfma_f32_16x16x32_bf16 a[8:11], a[160:163], v[16:19], a[8:11]
  v_exp_f32 v98, v98
  v_mfma_f32_16x16x32_bf16 a[8:11], a[164:167], v[48:51], a[8:11]
  ds_read_b64_tr_b16 a[188:189], v219 offset:40960
  v_mfma_f32_16x16x32_bf16 a[12:15], a[164:167], v[56:59], a[12:15]
  s_waitcnt lgkmcnt(7)
  v_exp_f32 v99, v99
  v_mfma_f32_16x16x32_bf16 a[12:15], a[160:163], v[24:27], a[12:15]
  ds_read_b64_tr_b16 a[190:191], v219 offset:45056
  v_cvt_pk_bf16_f32 v97, v98, v99
  v_mfma_f32_16x16x32_bf16 a[16:19], a[168:171], v[0:3], a[16:19]
  v_exp_f32 v104, v104
  v_mfma_f32_16x16x32_bf16 a[16:19], a[172:175], v[32:35], a[16:19]
  ds_read_b64_tr_b16 a[160:161], v220 offset:32768
  v_mfma_f32_16x16x32_bf16 a[20:23], a[172:175], v[40:43], a[20:23]
  v_exp_f32 v105, v105
  v_mfma_f32_16x16x32_bf16 a[20:23], a[168:171], v[8:11], a[20:23]
  ds_read_b64_tr_b16 a[162:163], v220 offset:36864
  v_cvt_pk_bf16_f32 v104, v104, v105
  v_mfma_f32_16x16x32_bf16 a[24:27], a[168:171], v[16:19], a[24:27]
  v_exp_f32 v106, v106
  v_mfma_f32_16x16x32_bf16 a[24:27], a[172:175], v[48:51], a[24:27]
  ds_read_b64_tr_b16 a[164:165], v220 offset:40960
  v_mfma_f32_16x16x32_bf16 a[28:31], a[172:175], v[56:59], a[28:31]
  s_waitcnt lgkmcnt(7)
  v_exp_f32 v107, v107
  v_mfma_f32_16x16x32_bf16 a[28:31], a[168:171], v[24:27], a[28:31]
  ds_read_b64_tr_b16 a[166:167], v220 offset:45056
  v_cvt_pk_bf16_f32 v105, v106, v107
  v_mfma_f32_16x16x32_bf16 a[32:35], a[176:179], v[0:3], a[32:35]
  v_exp_f32 v112, v112
  v_mfma_f32_16x16x32_bf16 a[32:35], a[180:183], v[32:35], a[32:35]
  ds_read_b64_tr_b16 a[168:169], v221 offset:32768
  v_mfma_f32_16x16x32_bf16 a[36:39], a[180:183], v[40:43], a[36:39]
  v_exp_f32 v113, v113
  v_mfma_f32_16x16x32_bf16 a[36:39], a[176:179], v[8:11], a[36:39]
  ds_read_b64_tr_b16 a[170:171], v221 offset:36864
  v_cvt_pk_bf16_f32 v112, v112, v113
  v_mfma_f32_16x16x32_bf16 a[40:43], a[176:179], v[16:19], a[40:43]
  v_exp_f32 v114, v114
  v_mfma_f32_16x16x32_bf16 a[40:43], a[180:183], v[48:51], a[40:43]
  ds_read_b64_tr_b16 a[172:173], v221 offset:40960
  v_mfma_f32_16x16x32_bf16 a[44:47], a[180:183], v[56:59], a[44:47]
  s_waitcnt lgkmcnt(7)
  v_exp_f32 v115, v115
  v_mfma_f32_16x16x32_bf16 a[44:47], a[176:179], v[24:27], a[44:47]
  ds_read_b64_tr_b16 a[174:175], v221 offset:45056
  v_cvt_pk_bf16_f32 v113, v114, v115
  v_mfma_f32_16x16x32_bf16 a[48:51], a[184:187], v[0:3], a[48:51]
  v_exp_f32 v120, v120
  v_mfma_f32_16x16x32_bf16 a[48:51], a[188:191], v[32:35], a[48:51]
  ds_read_b64_tr_b16 a[176:177], v222 offset:32768
  v_mfma_f32_16x16x32_bf16 a[52:55], a[188:191], v[40:43], a[52:55]
  v_exp_f32 v121, v121
  v_mfma_f32_16x16x32_bf16 a[52:55], a[184:187], v[8:11], a[52:55]
  ds_read_b64_tr_b16 a[178:179], v222 offset:36864
  v_cvt_pk_bf16_f32 v120, v120, v121
  v_mfma_f32_16x16x32_bf16 a[56:59], a[184:187], v[16:19], a[56:59]
  v_exp_f32 v122, v122
  v_mfma_f32_16x16x32_bf16 a[56:59], a[188:191], v[48:51], a[56:59]
  ds_read_b64_tr_b16 a[180:181], v222 offset:40960
  v_mfma_f32_16x16x32_bf16 a[60:63], a[188:191], v[56:59], a[60:63]
  s_waitcnt lgkmcnt(7)
  v_exp_f32 v123, v123
  v_mfma_f32_16x16x32_bf16 a[60:63], a[184:187], v[24:27], a[60:63]
  ds_read_b64_tr_b16 a[182:183], v222 offset:45056
  v_cvt_pk_bf16_f32 v121, v122, v123
  v_mfma_f32_16x16x32_bf16 a[64:67], a[160:163], v[0:3], a[64:67]
  v_exp_f32 v100, v100
  v_mfma_f32_16x16x32_bf16 a[64:67], a[164:167], v[32:35], a[64:67]
  ds_read_b64_tr_b16 a[184:185], v223 offset:32768
  v_mfma_f32_16x16x32_bf16 a[68:71], a[164:167], v[40:43], a[68:71]
  v_exp_f32 v101, v101
  v_mfma_f32_16x16x32_bf16 a[68:71], a[160:163], v[8:11], a[68:71]
  ds_read_b64_tr_b16 a[186:187], v223 offset:36864
  v_cvt_pk_bf16_f32 v98, v100, v101
  v_mfma_f32_16x16x32_bf16 a[72:75], a[160:163], v[16:19], a[72:75]
  v_exp_f32 v102, v102
  v_mfma_f32_16x16x32_bf16 a[72:75], a[164:167], v[48:51], a[72:75]
  ds_read_b64_tr_b16 a[188:189], v223 offset:40960
  v_mfma_f32_16x16x32_bf16 a[76:79], a[164:167], v[56:59], a[76:79]
  s_waitcnt lgkmcnt(7)
  v_exp_f32 v103, v103
  v_mfma_f32_16x16x32_bf16 a[76:79], a[160:163], v[24:27], a[76:79]
  ds_read_b64_tr_b16 a[190:191], v223 offset:45056
  v_cvt_pk_bf16_f32 v99, v102, v103
  v_mfma_f32_16x16x32_bf16 a[80:83], a[168:171], v[0:3], a[80:83]
  s_waitcnt vmcnt(11)
  v_exp_f32 v108, v108
  v_mfma_f32_16x16x32_bf16 a[80:83], a[172:175], v[32:35], a[80:83]
  v_mfma_f32_16x16x32_bf16 a[84:87], a[172:175], v[40:43], a[84:87]
  s_barrier
  v_exp_f32 v109, v109
  v_mfma_f32_16x16x32_bf16 a[84:87], a[168:171], v[8:11], a[84:87]
  ds_read_b128 a[128:131], v212 offset:0
  v_cvt_pk_bf16_f32 v106, v108, v109
  v_mfma_f32_16x16x32_bf16 a[88:91], a[168:171], v[16:19], a[88:91]
  v_exp_f32 v110, v110
  v_mfma_f32_16x16x32_bf16 a[88:91], a[172:175], v[48:51], a[88:91]
  ds_read_b128 a[132:135], v213 offset:0
  v_mfma_f32_16x16x32_bf16 a[92:95], a[172:175], v[56:59], a[92:95]
  s_waitcnt lgkmcnt(6)
  v_exp_f32 v111, v111
  v_mfma_f32_16x16x32_bf16 a[92:95], a[168:171], v[24:27], a[92:95]
  ds_read_b128 a[136:139], v214 offset:0
  v_cvt_pk_bf16_f32 v107, v110, v111
  v_mfma_f32_16x16x32_bf16 a[96:99], a[176:179], v[0:3], a[96:99]
  v_exp_f32 v116, v116
  v_mfma_f32_16x16x32_bf16 a[96:99], a[180:183], v[32:35], a[96:99]
  ds_read_b128 a[140:143], v215 offset:0
  buffer_load_dwordx4 a[220:223], v243, s[24:27], s38 offen sc1
  s_add_u32 s38, s38, 4096
  v_mfma_f32_16x16x32_bf16 a[100:103], a[180:183], v[40:43], a[100:103]
  v_exp_f32 v117, v117
  v_mfma_f32_16x16x32_bf16 a[100:103], a[176:179], v[8:11], a[100:103]
  v_cvt_pk_bf16_f32 v114, v116, v117
  v_mfma_f32_16x16x32_bf16 a[104:107], a[176:179], v[16:19], a[104:107]
  v_exp_f32 v118, v118
  v_mfma_f32_16x16x32_bf16 a[104:107], a[180:183], v[48:51], a[104:107]
  v_mfma_f32_16x16x32_bf16 a[108:111], a[180:183], v[56:59], a[108:111]
  s_waitcnt lgkmcnt(4)
  v_exp_f32 v119, v119
  v_mfma_f32_16x16x32_bf16 a[108:111], a[176:179], v[24:27], a[108:111]
  v_cvt_pk_bf16_f32 v115, v118, v119
  v_mfma_f32_16x16x32_bf16 a[112:115], a[184:187], v[0:3], a[112:115]
  v_exp_f32 v124, v124
  v_mfma_f32_16x16x32_bf16 a[112:115], a[188:191], v[32:35], a[112:115]
  v_mfma_f32_16x16x32_bf16 a[116:119], a[188:191], v[40:43], a[116:119]
  v_exp_f32 v125, v125
  v_mfma_f32_16x16x32_bf16 a[116:119], a[184:187], v[8:11], a[116:119]
  v_cvt_pk_bf16_f32 v122, v124, v125
  v_mfma_f32_16x16x32_bf16 a[120:123], a[184:187], v[16:19], a[120:123]
  v_exp_f32 v126, v126
  v_mfma_f32_16x16x32_bf16 a[120:123], a[188:191], v[48:51], a[120:123]
  v_mfma_f32_16x16x32_bf16 a[124:127], a[188:191], v[56:59], a[124:127]
  s_waitcnt lgkmcnt(0)
  v_exp_f32 v127, v127
  v_mfma_f32_16x16x32_bf16 a[124:127], a[184:187], v[24:27], a[124:127]
  v_cvt_pk_bf16_f32 v123, v126, v127
  v_mfma_f32_16x16x32_bf16 v[0:3], a[128:131], v[128:131], v[192:195]
  s_add_u32 m0, s28, 81920
  v_mfma_f32_16x16x32_bf16 v[0:3], a[132:135], v[132:135], v[0:3]
  ds_read_b128 a[144:147], v212 offset:4096
  v_mfma_f32_16x16x32_bf16 v[0:3], a[136:139], v[136:139], v[0:3]
  buffer_load_dwordx4 v236, s[16:19], s29 offen offset:0 lds
  v_mfma_f32_16x16x32_bf16 v[0:3], a[140:143], v[140:143], v[0:3]
  ds_read_b128 a[148:151], v213 offset:4096
  v_mfma_f32_16x16x32_bf16 v[8:11], a[140:143], v[156:159], v[196:199]
  buffer_load_dwordx4 v237, s[16:19], s29 offen offset:1024 lds
  v_mfma_f32_16x16x32_bf16 v[8:11], a[136:139], v[152:155], v[8:11]
  ds_read_b128 a[152:155], v214 offset:4096
  v_mfma_f32_16x16x32_bf16 v[8:11], a[132:135], v[148:151], v[8:11]
  buffer_load_dwordx4 v236, s[16:19], s29 offen offset:2048 lds
  v_mfma_f32_16x16x32_bf16 v[8:11], a[128:131], v[144:147], v[8:11]
  ds_read_b128 a[156:159], v215 offset:4096
  v_mfma_f32_16x16x32_bf16 v[16:19], a[128:131], v[160:163], v[200:203]
  v_exp_f32 v0, v0
  v_mfma_f32_16x16x32_bf16 v[16:19], a[132:135], v[164:167], v[16:19]
  buffer_load_dwordx4 v237, s[16:19], s29 offen offset:3072 lds
  v_mfma_f32_16x16x32_bf16 v[16:19], a[136:139], v[168:171], v[16:19]
  s_add_u32 s29, s29, 16384
  v_exp_f32 v1, v1
  v_mfma_f32_16x16x32_bf16 v[16:19], a[140:143], v[172:175], v[16:19]
  v_cvt_pk_bf16_f32 v0, v0, v1
  v_mfma_f32_16x16x32_bf16 v[24:27], a[140:143], v[188:191], v[204:207]
  s_add_u32 m0, s28, 32768
  v_exp_f32 v2, v2
  v_mfma_f32_16x16x32_bf16 v[24:27], a[136:139], v[184:187], v[24:27]
  buffer_load_dwordx4 v232, s[12:15], s29 offen offset:0 lds
  v_mfma_f32_16x16x32_bf16 v[24:27], a[132:135], v[180:183], v[24:27]
  s_waitcnt lgkmcnt(0)
  v_exp_f32 v3, v3
  v_mfma_f32_16x16x32_bf16 v[24:27], a[128:131], v[176:179], v[24:27]
  v_cvt_pk_bf16_f32 v1, v2, v3
  v_mfma_f32_16x16x32_bf16 v[4:7], a[144:147], v[128:131], v[192:195]
  v_exp_f32 v8, v8
  v_mfma_f32_16x16x32_bf16 v[4:7], a[148:151], v[132:135], v[4:7]
  ds_read_b128 a[128:131], v212 offset:8192
  v_mfma_f32_16x16x32_bf16 v[4:7], a[152:155], v[136:139], v[4:7]
  v_exp_f32 v9, v9
  v_mfma_f32_16x16x32_bf16 v[4:7], a[156:159], v[140:143], v[4:7]
  ds_read_b128 a[132:135], v213 offset:8192
  v_cvt_pk_bf16_f32 v8, v8, v9
  v_mfma_f32_16x16x32_bf16 v[12:15], a[156:159], v[156:159], v[196:199]
  v_exp_f32 v10, v10
  v_mfma_f32_16x16x32_bf16 v[12:15], a[152:155], v[152:155], v[12:15]
  ds_read_b128 a[136:139], v214 offset:8192
  v_mfma_f32_16x16x32_bf16 v[12:15], a[148:151], v[148:151], v[12:15]
  v_exp_f32 v11, v11
  v_mfma_f32_16x16x32_bf16 v[12:15], a[144:147], v[144:147], v[12:15]
  ds_read_b128 a[140:143], v215 offset:8192
  v_cvt_pk_bf16_f32 v9, v10, v11
  v_mfma_f32_16x16x32_bf16 v[20:23], a[144:147], v[160:163], v[200:203]
  v_exp_f32 v16, v16
  v_mfma_f32_16x16x32_bf16 v[20:23], a[148:151], v[164:167], v[20:23]
  buffer_load_dwordx4 v233, s[12:15], s29 offen offset:1024 lds
  v_mfma_f32_16x16x32_bf16 v[20:23], a[152:155], v[168:171], v[20:23]
  v_exp_f32 v17, v17
  v_mfma_f32_16x16x32_bf16 v[20:23], a[156:159], v[172:175], v[20:23]
  v_cvt_pk_bf16_f32 v16, v16, v17
  v_mfma_f32_16x16x32_bf16 v[28:31], a[156:159], v[188:191], v[204:207]
  v_exp_f32 v18, v18
  v_mfma_f32_16x16x32_bf16 v[28:31], a[152:155], v[184:187], v[28:31]
  buffer_load_dwordx4 v234, s[12:15], s29 offen offset:2048 lds
  v_mfma_f32_16x16x32_bf16 v[28:31], a[148:151], v[180:183], v[28:31]
  s_waitcnt lgkmcnt(0)
  v_exp_f32 v19, v19
  v_mfma_f32_16x16x32_bf16 v[28:31], a[144:147], v[176:179], v[28:31]
  v_cvt_pk_bf16_f32 v17, v18, v19
  v_mfma_f32_16x16x32_bf16 v[32:35], a[128:131], v[128:131], v[192:195]
  v_exp_f32 v24, v24
  v_mfma_f32_16x16x32_bf16 v[32:35], a[132:135], v[132:135], v[32:35]
  ds_read_b128 a[144:147], v212 offset:12288
  v_mfma_f32_16x16x32_bf16 v[32:35], a[136:139], v[136:139], v[32:35]
  v_exp_f32 v25, v25
  v_mfma_f32_16x16x32_bf16 v[32:35], a[140:143], v[140:143], v[32:35]
  ds_read_b128 a[148:151], v213 offset:12288
  v_cvt_pk_bf16_f32 v24, v24, v25
  v_mfma_f32_16x16x32_bf16 v[40:43], a[140:143], v[156:159], v[196:199]
  v_exp_f32 v26, v26
  v_mfma_f32_16x16x32_bf16 v[40:43], a[136:139], v[152:155], v[40:43]
  ds_read_b128 a[152:155], v214 offset:12288
  v_mfma_f32_16x16x32_bf16 v[40:43], a[132:135], v[148:151], v[40:43]
  v_exp_f32 v27, v27
  v_mfma_f32_16x16x32_bf16 v[40:43], a[128:131], v[144:147], v[40:43]
  ds_read_b128 a[156:159], v215 offset:12288
  v_cvt_pk_bf16_f32 v25, v26, v27
  v_mfma_f32_16x16x32_bf16 v[48:51], a[128:131], v[160:163], v[200:203]
  v_exp_f32 v4, v4
  v_mfma_f32_16x16x32_bf16 v[48:51], a[132:135], v[164:167], v[48:51]
  buffer_load_dwordx4 v235, s[12:15], s29 offen offset:3072 lds
  v_mfma_f32_16x16x32_bf16 v[48:51], a[136:139], v[168:171], v[48:51]
  v_exp_f32 v5, v5
  v_mfma_f32_16x16x32_bf16 v[48:51], a[140:143], v[172:175], v[48:51]
  v_cvt_pk_bf16_f32 v2, v4, v5
  v_mfma_f32_16x16x32_bf16 v[56:59], a[140:143], v[188:191], v[204:207]
  v_exp_f32 v6, v6
  v_mfma_f32_16x16x32_bf16 v[56:59], a[136:139], v[184:187], v[56:59]
  s_add_u32 m0, s50, 2048
  v_mfma_f32_16x16x32_bf16 v[56:59], a[132:135], v[180:183], v[56:59]
  s_waitcnt lgkmcnt(0)
  v_exp_f32 v7, v7
  v_mfma_f32_16x16x32_bf16 v[56:59], a[128:131], v[176:179], v[56:59]
  buffer_load_dwordx4 v226, s[20:23], s35 offen lds
  v_cvt_pk_bf16_f32 v3, v6, v7
  v_mfma_f32_16x16x32_bf16 v[36:39], a[144:147], v[128:131], v[192:195]
  v_exp_f32 v12, v12
  v_mfma_f32_16x16x32_bf16 v[36:39], a[148:151], v[132:135], v[36:39]
  ds_read_b64_tr_b16 a[160:161], v216 offset:49152
  v_mfma_f32_16x16x32_bf16 v[36:39], a[152:155], v[136:139], v[36:39]
  v_exp_f32 v13, v13
  v_mfma_f32_16x16x32_bf16 v[36:39], a[156:159], v[140:143], v[36:39]
  ds_read_b64_tr_b16 a[162:163], v216 offset:53248
  v_cvt_pk_bf16_f32 v10, v12, v13
  v_mfma_f32_16x16x32_bf16 v[44:47], a[156:159], v[156:159], v[196:199]
  v_exp_f32 v14, v14
  v_mfma_f32_16x16x32_bf16 v[44:47], a[152:155], v[152:155], v[44:47]
  ds_read_b64_tr_b16 a[164:165], v216 offset:57344
  v_mfma_f32_16x16x32_bf16 v[44:47], a[148:151], v[148:151], v[44:47]
  v_exp_f32 v15, v15
  v_mfma_f32_16x16x32_bf16 v[44:47], a[144:147], v[144:147], v[44:47]
  ds_read_b64_tr_b16 a[166:167], v216 offset:61440
  v_cvt_pk_bf16_f32 v11, v14, v15
  v_mfma_f32_16x16x32_bf16 v[52:55], a[144:147], v[160:163], v[200:203]
  v_exp_f32 v20, v20
  v_mfma_f32_16x16x32_bf16 v[52:55], a[148:151], v[164:167], v[52:55]
  ds_read_b64_tr_b16 a[168:169], v217 offset:49152
  v_mfma_f32_16x16x32_bf16 v[52:55], a[152:155], v[168:171], v[52:55]
  v_exp_f32 v21, v21
  v_mfma_f32_16x16x32_bf16 v[52:55], a[156:159], v[172:175], v[52:55]
  ds_read_b64_tr_b16 a[170:171], v217 offset:53248
  v_cvt_pk_bf16_f32 v18, v20, v21
  v_mfma_f32_16x16x32_bf16 v[60:63], a[156:159], v[188:191], v[204:207]
  v_exp_f32 v22, v22
  v_mfma_f32_16x16x32_bf16 v[60:63], a[152:155], v[184:187], v[60:63]
  ds_read_b64_tr_b16 a[172:173], v217 offset:57344
  v_mfma_f32_16x16x32_bf16 v[60:63], a[148:151], v[180:183], v[60:63]
  v_exp_f32 v23, v23
  v_mfma_f32_16x16x32_bf16 v[60:63], a[144:147], v[176:179], v[60:63]
  ds_read_b64_tr_b16 a[174:175], v217 offset:61440
  v_cvt_pk_bf16_f32 v19, v22, v23
  v_mfma_f32_16x16x32_bf16 a[192:195], a[208:211], v[64:67], a[192:195]
  v_exp_f32 v28, v28
  v_mfma_f32_16x16x32_bf16 a[192:195], a[208:211], v[96:99], a[192:195]
  ds_read_b64_tr_b16 a[176:177], v218 offset:49152
  v_mfma_f32_16x16x32_bf16 a[196:199], a[208:211], v[72:75], a[196:199]
  v_exp_f32 v29, v29
  v_mfma_f32_16x16x32_bf16 a[196:199], a[208:211], v[104:107], a[196:199]
  ds_read_b64_tr_b16 a[178:179], v218 offset:53248
  v_cvt_pk_bf16_f32 v26, v28, v29
  v_mfma_f32_16x16x32_bf16 a[200:203], a[208:211], v[80:83], a[200:203]
  v_exp_f32 v30, v30
  v_mfma_f32_16x16x32_bf16 a[200:203], a[208:211], v[112:115], a[200:203]
  ds_read_b64_tr_b16 a[180:181], v218 offset:57344
  v_mfma_f32_16x16x32_bf16 a[204:207], a[208:211], v[88:91], a[204:207]
  s_waitcnt lgkmcnt(7)
  v_exp_f32 v31, v31
  v_mfma_f32_16x16x32_bf16 a[204:207], a[208:211], v[120:123], a[204:207]
  ds_read_b64_tr_b16 a[182:183], v218 offset:61440
  v_cvt_pk_bf16_f32 v27, v30, v31
  v_mfma_f32_16x16x32_bf16 a[0:3], a[160:163], v[64:67], a[0:3]
  v_exp_f32 v32, v32
  v_mfma_f32_16x16x32_bf16 a[0:3], a[164:167], v[96:99], a[0:3]
  ds_read_b64_tr_b16 a[184:185], v219 offset:49152
  v_mfma_f32_16x16x32_bf16 a[4:7], a[164:167], v[104:107], a[4:7]
  v_exp_f32 v33, v33
  v_mfma_f32_16x16x32_bf16 a[4:7], a[160:163], v[72:75], a[4:7]
  ds_read_b64_tr_b16 a[186:187], v219 offset:53248
  v_cvt_pk_bf16_f32 v32, v32, v33
  v_mfma_f32_16x16x32_bf16 a[8:11], a[160:163], v[80:83], a[8:11]
  v_exp_f32 v34, v34
  v_mfma_f32_16x16x32_bf16 a[8:11], a[164:167], v[112:115], a[8:11]
  ds_read_b64_tr_b16 a[188:189], v219 offset:57344
  v_mfma_f32_16x16x32_bf16 a[12:15], a[164:167], v[120:123], a[12:15]
  s_waitcnt lgkmcnt(7)
  v_exp_f32 v35, v35
  v_mfma_f32_16x16x32_bf16 a[12:15], a[160:163], v[88:91], a[12:15]
  ds_read_b64_tr_b16 a[190:191], v219 offset:61440
  v_cvt_pk_bf16_f32 v33, v34, v35
  v_mfma_f32_16x16x32_bf16 a[16:19], a[168:171], v[64:67], a[16:19]
  v_exp_f32 v40, v40
  v_mfma_f32_16x16x32_bf16 a[16:19], a[172:175], v[96:99], a[16:19]
  ds_read_b64_tr_b16 a[160:161], v220 offset:49152
  v_mfma_f32_16x16x32_bf16 a[20:23], a[172:175], v[104:107], a[20:23]
  v_exp_f32 v41, v41
  v_mfma_f32_16x16x32_bf16 a[20:23], a[168:171], v[72:75], a[20:23]
  ds_read_b64_tr_b16 a[162:163], v220 offset:53248
  v_cvt_pk_bf16_f32 v40, v40, v41
  v_mfma_f32_16x16x32_bf16 a[24:27], a[168:171], v[80:83], a[24:27]
  v_exp_f32 v42, v42
  v_mfma_f32_16x16x32_bf16 a[24:27], a[172:175], v[112:115], a[24:27]
  ds_read_b64_tr_b16 a[164:165], v220 offset:57344
  v_mfma_f32_16x16x32_bf16 a[28:31], a[172:175], v[120:123], a[28:31]
  s_waitcnt lgkmcnt(7)
  v_exp_f32 v43, v43
  v_mfma_f32_16x16x32_bf16 a[28:31], a[168:171], v[88:91], a[28:31]
  ds_read_b64_tr_b16 a[166:167], v220 offset:61440
  v_cvt_pk_bf16_f32 v41, v42, v43
  v_mfma_f32_16x16x32_bf16 a[32:35], a[176:179], v[64:67], a[32:35]
  v_exp_f32 v48, v48
  v_mfma_f32_16x16x32_bf16 a[32:35], a[180:183], v[96:99], a[32:35]
  ds_read_b64_tr_b16 a[168:169], v221 offset:49152
  v_mfma_f32_16x16x32_bf16 a[36:39], a[180:183], v[104:107], a[36:39]
  v_exp_f32 v49, v49
  v_mfma_f32_16x16x32_bf16 a[36:39], a[176:179], v[72:75], a[36:39]
  ds_read_b64_tr_b16 a[170:171], v221 offset:53248
  v_cvt_pk_bf16_f32 v48, v48, v49
  v_mfma_f32_16x16x32_bf16 a[40:43], a[176:179], v[80:83], a[40:43]
  v_exp_f32 v50, v50
  v_mfma_f32_16x16x32_bf16 a[40:43], a[180:183], v[112:115], a[40:43]
  ds_read_b64_tr_b16 a[172:173], v221 offset:57344
  v_mfma_f32_16x16x32_bf16 a[44:47], a[180:183], v[120:123], a[44:47]
  s_waitcnt lgkmcnt(7)
  v_exp_f32 v51, v51
  v_mfma_f32_16x16x32_bf16 a[44:47], a[176:179], v[88:91], a[44:47]
  ds_read_b64_tr_b16 a[174:175], v221 offset:61440
  v_cvt_pk_bf16_f32 v49, v50, v51
  v_mfma_f32_16x16x32_bf16 a[48:51], a[184:187], v[64:67], a[48:51]
  v_exp_f32 v56, v56
  v_mfma_f32_16x16x32_bf16 a[48:51], a[188:191], v[96:99], a[48:51]
  ds_read_b64_tr_b16 a[176:177], v222 offset:49152
  v_mfma_f32_16x16x32_bf16 a[52:55], a[188:191], v[104:107], a[52:55]
  v_exp_f32 v57, v57
  v_mfma_f32_16x16x32_bf16 a[52:55], a[184:187], v[72:75], a[52:55]
  ds_read_b64_tr_b16 a[178:179], v222 offset:53248
  v_cvt_pk_bf16_f32 v56, v56, v57
  v_mfma_f32_16x16x32_bf16 a[56:59], a[184:187], v[80:83], a[56:59]
  v_exp_f32 v58, v58
  v_mfma_f32_16x16x32_bf16 a[56:59], a[188:191], v[112:115], a[56:59]
  ds_read_b64_tr_b16 a[180:181], v222 offset:57344
  v_mfma_f32_16x16x32_bf16 a[60:63], a[188:191], v[120:123], a[60:63]
  s_waitcnt lgkmcnt(7)
  v_exp_f32 v59, v59
  v_mfma_f32_16x16x32_bf16 a[60:63], a[184:187], v[88:91], a[60:63]
  ds_read_b64_tr_b16 a[182:183], v222 offset:61440
  v_cvt_pk_bf16_f32 v57, v58, v59
  v_mfma_f32_16x16x32_bf16 a[64:67], a[160:163], v[64:67], a[64:67]
  v_exp_f32 v36, v36
  v_mfma_f32_16x16x32_bf16 a[64:67], a[164:167], v[96:99], a[64:67]
  ds_read_b64_tr_b16 a[184:185], v223 offset:49152
  v_mfma_f32_16x16x32_bf16 a[68:71], a[164:167], v[104:107], a[68:71]
  v_exp_f32 v37, v37
  v_mfma_f32_16x16x32_bf16 a[68:71], a[160:163], v[72:75], a[68:71]
  ds_read_b64_tr_b16 a[186:187], v223 offset:53248
  v_cvt_pk_bf16_f32 v34, v36, v37
  v_mfma_f32_16x16x32_bf16 a[72:75], a[160:163], v[80:83], a[72:75]
  v_exp_f32 v38, v38
  v_mfma_f32_16x16x32_bf16 a[72:75], a[164:167], v[112:115], a[72:75]
  ds_read_b64_tr_b16 a[188:189], v223 offset:57344
  v_mfma_f32_16x16x32_bf16 a[76:79], a[164:167], v[120:123], a[76:79]
  s_waitcnt lgkmcnt(7)
  v_exp_f32 v39, v39
  v_mfma_f32_16x16x32_bf16 a[76:79], a[160:163], v[88:91], a[76:79]
  ds_read_b64_tr_b16 a[190:191], v223 offset:61440
  v_cvt_pk_bf16_f32 v35, v38, v39
  v_mfma_f32_16x16x32_bf16 a[80:83], a[168:171], v[64:67], a[80:83]
  s_waitcnt vmcnt(11)
  v_exp_f32 v44, v44
  v_mfma_f32_16x16x32_bf16 a[80:83], a[172:175], v[96:99], a[80:83]
  v_mfma_f32_16x16x32_bf16 a[84:87], a[172:175], v[104:107], a[84:87]
  s_barrier
  v_exp_f32 v45, v45
  v_mfma_f32_16x16x32_bf16 a[84:87], a[168:171], v[72:75], a[84:87]
  ds_read_b128 a[128:131], v212 offset:16384
  v_cvt_pk_bf16_f32 v42, v44, v45
  v_mfma_f32_16x16x32_bf16 a[88:91], a[168:171], v[80:83], a[88:91]
  v_exp_f32 v46, v46
  v_mfma_f32_16x16x32_bf16 a[88:91], a[172:175], v[112:115], a[88:91]
  ds_read_b128 a[132:135], v213 offset:16384
  v_mfma_f32_16x16x32_bf16 a[92:95], a[172:175], v[120:123], a[92:95]
  s_waitcnt lgkmcnt(6)
  v_exp_f32 v47, v47
  v_mfma_f32_16x16x32_bf16 a[92:95], a[168:171], v[88:91], a[92:95]
  ds_read_b128 a[136:139], v214 offset:16384
  v_cvt_pk_bf16_f32 v43, v46, v47
  v_mfma_f32_16x16x32_bf16 a[96:99], a[176:179], v[64:67], a[96:99]
  v_exp_f32 v52, v52
  v_mfma_f32_16x16x32_bf16 a[96:99], a[180:183], v[96:99], a[96:99]
  ds_read_b128 a[140:143], v215 offset:16384
  buffer_load_dwordx4 a[224:227], v243, s[24:27], s38 offen sc1
  s_add_u32 s38, s38, 4096
  v_mfma_f32_16x16x32_bf16 a[100:103], a[180:183], v[104:107], a[100:103]
  v_exp_f32 v53, v53
  v_mfma_f32_16x16x32_bf16 a[100:103], a[176:179], v[72:75], a[100:103]
  v_cvt_pk_bf16_f32 v50, v52, v53
  v_mfma_f32_16x16x32_bf16 a[104:107], a[176:179], v[80:83], a[104:107]
  v_exp_f32 v54, v54
  v_mfma_f32_16x16x32_bf16 a[104:107], a[180:183], v[112:115], a[104:107]
  v_mfma_f32_16x16x32_bf16 a[108:111], a[180:183], v[120:123], a[108:111]
  s_waitcnt lgkmcnt(4)
  v_exp_f32 v55, v55
  v_mfma_f32_16x16x32_bf16 a[108:111], a[176:179], v[88:91], a[108:111]
  v_cvt_pk_bf16_f32 v51, v54, v55
  v_mfma_f32_16x16x32_bf16 a[112:115], a[184:187], v[64:67], a[112:115]
  v_exp_f32 v60, v60
  v_mfma_f32_16x16x32_bf16 a[112:115], a[188:191], v[96:99], a[112:115]
  v_mfma_f32_16x16x32_bf16 a[116:119], a[188:191], v[104:107], a[116:119]
  v_exp_f32 v61, v61
  v_mfma_f32_16x16x32_bf16 a[116:119], a[184:187], v[72:75], a[116:119]
  v_cvt_pk_bf16_f32 v58, v60, v61
  v_mfma_f32_16x16x32_bf16 a[120:123], a[184:187], v[80:83], a[120:123]
  v_exp_f32 v62, v62
  v_mfma_f32_16x16x32_bf16 a[120:123], a[188:191], v[112:115], a[120:123]
  v_mfma_f32_16x16x32_bf16 a[124:127], a[188:191], v[120:123], a[124:127]
  s_waitcnt lgkmcnt(0)
  v_exp_f32 v63, v63
  v_mfma_f32_16x16x32_bf16 a[124:127], a[184:187], v[88:91], a[124:127]
  v_cvt_pk_bf16_f32 v59, v62, v63
  v_mfma_f32_16x16x32_bf16 v[64:67], a[128:131], v[128:131], v[192:195]
  s_add_u32 m0, s28, 98304
  v_mfma_f32_16x16x32_bf16 v[64:67], a[132:135], v[132:135], v[64:67]
  ds_read_b128 a[144:147], v212 offset:20480
  v_mfma_f32_16x16x32_bf16 v[64:67], a[136:139], v[136:139], v[64:67]
  buffer_load_dwordx4 v236, s[16:19], s29 offen offset:0 lds
  v_mfma_f32_16x16x32_bf16 v[64:67], a[140:143], v[140:143], v[64:67]
  ds_read_b128 a[148:151], v213 offset:20480
  v_mfma_f32_16x16x32_bf16 v[72:75], a[140:143], v[156:159], v[196:199]
  buffer_load_dwordx4 v237, s[16:19], s29 offen offset:1024 lds
  v_mfma_f32_16x16x32_bf16 v[72:75], a[136:139], v[152:155], v[72:75]
  ds_read_b128 a[152:155], v214 offset:20480
  v_mfma_f32_16x16x32_bf16 v[72:75], a[132:135], v[148:151], v[72:75]
  buffer_load_dwordx4 v236, s[16:19], s29 offen offset:2048 lds
  v_mfma_f32_16x16x32_bf16 v[72:75], a[128:131], v[144:147], v[72:75]
  ds_read_b128 a[156:159], v215 offset:20480
  v_mfma_f32_16x16x32_bf16 v[80:83], a[128:131], v[160:163], v[200:203]
  v_exp_f32 v64, v64
  v_mfma_f32_16x16x32_bf16 v[80:83], a[132:135], v[164:167], v[80:83]
  buffer_load_dwordx4 v237, s[16:19], s29 offen offset:3072 lds
  v_mfma_f32_16x16x32_bf16 v[80:83], a[136:139], v[168:171], v[80:83]
  s_add_u32 s29, s29, 16384
  v_exp_f32 v65, v65
  v_mfma_f32_16x16x32_bf16 v[80:83], a[140:143], v[172:175], v[80:83]
  v_cvt_pk_bf16_f32 v64, v64, v65
  v_mfma_f32_16x16x32_bf16 v[88:91], a[140:143], v[188:191], v[204:207]
  s_add_u32 m0, s28, 49152
  v_exp_f32 v66, v66
  v_mfma_f32_16x16x32_bf16 v[88:91], a[136:139], v[184:187], v[88:91]
  buffer_load_dwordx4 v232, s[12:15], s29 offen offset:0 lds
  v_mfma_f32_16x16x32_bf16 v[88:91], a[132:135], v[180:183], v[88:91]
  s_waitcnt lgkmcnt(0)
  v_exp_f32 v67, v67
  v_mfma_f32_16x16x32_bf16 v[88:91], a[128:131], v[176:179], v[88:91]
  v_cvt_pk_bf16_f32 v65, v66, v67
  v_mfma_f32_16x16x32_bf16 v[68:71], a[144:147], v[128:131], v[192:195]
  v_exp_f32 v72, v72
  v_mfma_f32_16x16x32_bf16 v[68:71], a[148:151], v[132:135], v[68:71]
  ds_read_b128 a[128:131], v212 offset:24576
  v_mfma_f32_16x16x32_bf16 v[68:71], a[152:155], v[136:139], v[68:71]
  v_exp_f32 v73, v73
  v_mfma_f32_16x16x32_bf16 v[68:71], a[156:159], v[140:143], v[68:71]
  ds_read_b128 a[132:135], v213 offset:24576
  v_cvt_pk_bf16_f32 v72, v72, v73
  v_mfma_f32_16x16x32_bf16 v[76:79], a[156:159], v[156:159], v[196:199]
  v_exp_f32 v74, v74
  v_mfma_f32_16x16x32_bf16 v[76:79], a[152:155], v[152:155], v[76:79]
  ds_read_b128 a[136:139], v214 offset:24576
  v_mfma_f32_16x16x32_bf16 v[76:79], a[148:151], v[148:151], v[76:79]
  v_exp_f32 v75, v75
  v_mfma_f32_16x16x32_bf16 v[76:79], a[144:147], v[144:147], v[76:79]
  ds_read_b128 a[140:143], v215 offset:24576
  v_cvt_pk_bf16_f32 v73, v74, v75
  v_mfma_f32_16x16x32_bf16 v[84:87], a[144:147], v[160:163], v[200:203]
  v_exp_f32 v80, v80
  v_mfma_f32_16x16x32_bf16 v[84:87], a[148:151], v[164:167], v[84:87]
  buffer_load_dwordx4 v233, s[12:15], s29 offen offset:1024 lds
  v_mfma_f32_16x16x32_bf16 v[84:87], a[152:155], v[168:171], v[84:87]
  v_exp_f32 v81, v81
  v_mfma_f32_16x16x32_bf16 v[84:87], a[156:159], v[172:175], v[84:87]
  v_cvt_pk_bf16_f32 v80, v80, v81
  v_mfma_f32_16x16x32_bf16 v[92:95], a[156:159], v[188:191], v[204:207]
  v_exp_f32 v82, v82
  v_mfma_f32_16x16x32_bf16 v[92:95], a[152:155], v[184:187], v[92:95]
  buffer_load_dwordx4 v234, s[12:15], s29 offen offset:2048 lds
  v_mfma_f32_16x16x32_bf16 v[92:95], a[148:151], v[180:183], v[92:95]
  s_waitcnt lgkmcnt(0)
  v_exp_f32 v83, v83
  v_mfma_f32_16x16x32_bf16 v[92:95], a[144:147], v[176:179], v[92:95]
  v_cvt_pk_bf16_f32 v81, v82, v83
  v_mfma_f32_16x16x32_bf16 v[96:99], a[128:131], v[128:131], v[192:195]
  v_exp_f32 v88, v88
  v_mfma_f32_16x16x32_bf16 v[96:99], a[132:135], v[132:135], v[96:99]
  ds_read_b128 a[144:147], v212 offset:28672
  v_mfma_f32_16x16x32_bf16 v[96:99], a[136:139], v[136:139], v[96:99]
  v_exp_f32 v89, v89
  v_mfma_f32_16x16x32_bf16 v[96:99], a[140:143], v[140:143], v[96:99]
  ds_read_b128 a[148:151], v213 offset:28672
  v_cvt_pk_bf16_f32 v88, v88, v89
  v_mfma_f32_16x16x32_bf16 v[104:107], a[140:143], v[156:159], v[196:199]
  v_exp_f32 v90, v90
  v_mfma_f32_16x16x32_bf16 v[104:107], a[136:139], v[152:155], v[104:107]
  ds_read_b128 a[152:155], v214 offset:28672
  v_mfma_f32_16x16x32_bf16 v[104:107], a[132:135], v[148:151], v[104:107]
  v_exp_f32 v91, v91
  v_mfma_f32_16x16x32_bf16 v[104:107], a[128:131], v[144:147], v[104:107]
  ds_read_b128 a[156:159], v215 offset:28672
  v_cvt_pk_bf16_f32 v89, v90, v91
  v_mfma_f32_16x16x32_bf16 v[112:115], a[128:131], v[160:163], v[200:203]
  v_exp_f32 v68, v68
  v_mfma_f32_16x16x32_bf16 v[112:115], a[132:135], v[164:167], v[112:115]
  buffer_load_dwordx4 v235, s[12:15], s29 offen offset:3072 lds
  v_mfma_f32_16x16x32_bf16 v[112:115], a[136:139], v[168:171], v[112:115]
  v_exp_f32 v69, v69
  v_mfma_f32_16x16x32_bf16 v[112:115], a[140:143], v[172:175], v[112:115]
  v_cvt_pk_bf16_f32 v66, v68, v69
  v_mfma_f32_16x16x32_bf16 v[120:123], a[140:143], v[188:191], v[204:207]
  v_exp_f32 v70, v70
  v_mfma_f32_16x16x32_bf16 v[120:123], a[136:139], v[184:187], v[120:123]
  s_add_u32 m0, s50, 5120
  v_mfma_f32_16x16x32_bf16 v[120:123], a[132:135], v[180:183], v[120:123]
  s_waitcnt lgkmcnt(0)
  v_exp_f32 v71, v71
  v_mfma_f32_16x16x32_bf16 v[120:123], a[128:131], v[176:179], v[120:123]
  buffer_load_dwordx4 v226, s[44:47], s35 offen lds
  s_add_u32 s35, s35, 221184
  v_cvt_pk_bf16_f32 v67, v70, v71
  v_mfma_f32_16x16x32_bf16 v[100:103], a[144:147], v[128:131], v[192:195]
  v_exp_f32 v76, v76
  v_mfma_f32_16x16x32_bf16 v[100:103], a[148:151], v[132:135], v[100:103]
  ds_read_b64_tr_b16 a[160:161], v216 offset:0
  v_mfma_f32_16x16x32_bf16 v[100:103], a[152:155], v[136:139], v[100:103]
  v_exp_f32 v77, v77
  v_mfma_f32_16x16x32_bf16 v[100:103], a[156:159], v[140:143], v[100:103]
  ds_read_b64_tr_b16 a[162:163], v216 offset:4096
  v_cvt_pk_bf16_f32 v74, v76, v77
  v_mfma_f32_16x16x32_bf16 v[108:111], a[156:159], v[156:159], v[196:199]
  v_exp_f32 v78, v78
  v_mfma_f32_16x16x32_bf16 v[108:111], a[152:155], v[152:155], v[108:111]
  ds_read_b64_tr_b16 a[164:165], v216 offset:8192
  v_mfma_f32_16x16x32_bf16 v[108:111], a[148:151], v[148:151], v[108:111]
  v_exp_f32 v79, v79
  v_mfma_f32_16x16x32_bf16 v[108:111], a[144:147], v[144:147], v[108:111]
  ds_read_b64_tr_b16 a[166:167], v216 offset:12288
  v_cvt_pk_bf16_f32 v75, v78, v79
  v_mfma_f32_16x16x32_bf16 v[116:119], a[144:147], v[160:163], v[200:203]
  v_exp_f32 v84, v84
  v_mfma_f32_16x16x32_bf16 v[116:119], a[148:151], v[164:167], v[116:119]
  ds_read_b64_tr_b16 a[168:169], v217 offset:0
  v_mfma_f32_16x16x32_bf16 v[116:119], a[152:155], v[168:171], v[116:119]
  v_exp_f32 v85, v85
  v_mfma_f32_16x16x32_bf16 v[116:119], a[156:159], v[172:175], v[116:119]
  ds_read_b64_tr_b16 a[170:171], v217 offset:4096
  v_cvt_pk_bf16_f32 v82, v84, v85
  v_mfma_f32_16x16x32_bf16 v[124:127], a[156:159], v[188:191], v[204:207]
  v_exp_f32 v86, v86
  v_mfma_f32_16x16x32_bf16 v[124:127], a[152:155], v[184:187], v[124:127]
  ds_read_b64_tr_b16 a[172:173], v217 offset:8192
  v_mfma_f32_16x16x32_bf16 v[124:127], a[148:151], v[180:183], v[124:127]
  v_exp_f32 v87, v87
  v_mfma_f32_16x16x32_bf16 v[124:127], a[144:147], v[176:179], v[124:127]
  ds_read_b64_tr_b16 a[174:175], v217 offset:12288
  v_cvt_pk_bf16_f32 v83, v86, v87
  v_mfma_f32_16x16x32_bf16 a[192:195], a[208:211], v[0:3], a[192:195]
  v_exp_f32 v92, v92
  v_mfma_f32_16x16x32_bf16 a[192:195], a[208:211], v[32:35], a[192:195]
  ds_read_b64_tr_b16 a[176:177], v218 offset:0
  v_mfma_f32_16x16x32_bf16 a[196:199], a[208:211], v[8:11], a[196:199]
  v_exp_f32 v93, v93
  v_mfma_f32_16x16x32_bf16 a[196:199], a[208:211], v[40:43], a[196:199]
  ds_read_b64_tr_b16 a[178:179], v218 offset:4096
  v_cvt_pk_bf16_f32 v90, v92, v93
  v_mfma_f32_16x16x32_bf16 a[200:203], a[208:211], v[16:19], a[200:203]
  v_exp_f32 v94, v94
  v_mfma_f32_16x16x32_bf16 a[200:203], a[208:211], v[48:51], a[200:203]
  ds_read_b64_tr_b16 a[180:181], v218 offset:8192
  v_mfma_f32_16x16x32_bf16 a[204:207], a[208:211], v[24:27], a[204:207]
  s_waitcnt lgkmcnt(7)
  v_exp_f32 v95, v95
  v_mfma_f32_16x16x32_bf16 a[204:207], a[208:211], v[56:59], a[204:207]
  ds_read_b64_tr_b16 a[182:183], v218 offset:12288
  v_cvt_pk_bf16_f32 v91, v94, v95
  v_mfma_f32_16x16x32_bf16 a[0:3], a[160:163], v[0:3], a[0:3]
  v_exp_f32 v96, v96
  v_mfma_f32_16x16x32_bf16 a[0:3], a[164:167], v[32:35], a[0:3]
  ds_read_b64_tr_b16 a[184:185], v219 offset:0
  v_mfma_f32_16x16x32_bf16 a[4:7], a[164:167], v[40:43], a[4:7]
  v_exp_f32 v97, v97
  v_mfma_f32_16x16x32_bf16 a[4:7], a[160:163], v[8:11], a[4:7]
  ds_read_b64_tr_b16 a[186:187], v219 offset:4096
  v_cvt_pk_bf16_f32 v96, v96, v97
  v_mfma_f32_16x16x32_bf16 a[8:11], a[160:163], v[16:19], a[8:11]
  v_exp_f32 v98, v98
  v_mfma_f32_16x16x32_bf16 a[8:11], a[164:167], v[48:51], a[8:11]
  ds_read_b64_tr_b16 a[188:189], v219 offset:8192
  v_mfma_f32_16x16x32_bf16 a[12:15], a[164:167], v[56:59], a[12:15]
  s_waitcnt lgkmcnt(7)
  v_exp_f32 v99, v99
  v_mfma_f32_16x16x32_bf16 a[12:15], a[160:163], v[24:27], a[12:15]
  ds_read_b64_tr_b16 a[190:191], v219 offset:12288
  v_cvt_pk_bf16_f32 v97, v98, v99
  v_mfma_f32_16x16x32_bf16 a[16:19], a[168:171], v[0:3], a[16:19]
  v_exp_f32 v104, v104
  v_mfma_f32_16x16x32_bf16 a[16:19], a[172:175], v[32:35], a[16:19]
  ds_read_b64_tr_b16 a[160:161], v220 offset:0
  v_mfma_f32_16x16x32_bf16 a[20:23], a[172:175], v[40:43], a[20:23]
  v_exp_f32 v105, v105
  v_mfma_f32_16x16x32_bf16 a[20:23], a[168:171], v[8:11], a[20:23]
  ds_read_b64_tr_b16 a[162:163], v220 offset:4096
  v_cvt_pk_bf16_f32 v104, v104, v105
  v_mfma_f32_16x16x32_bf16 a[24:27], a[168:171], v[16:19], a[24:27]
  v_exp_f32 v106, v106
  v_mfma_f32_16x16x32_bf16 a[24:27], a[172:175], v[48:51], a[24:27]
  ds_read_b64_tr_b16 a[164:165], v220 offset:8192
  v_mfma_f32_16x16x32_bf16 a[28:31], a[172:175], v[56:59], a[28:31]
  s_waitcnt lgkmcnt(7)
  v_exp_f32 v107, v107
  v_mfma_f32_16x16x32_bf16 a[28:31], a[168:171], v[24:27], a[28:31]
  ds_read_b64_tr_b16 a[166:167], v220 offset:12288
  v_cvt_pk_bf16_f32 v105, v106, v107
  v_mfma_f32_16x16x32_bf16 a[32:35], a[176:179], v[0:3], a[32:35]
  v_exp_f32 v112, v112
  v_mfma_f32_16x16x32_bf16 a[32:35], a[180:183], v[32:35], a[32:35]
  ds_read_b64_tr_b16 a[168:169], v221 offset:0
  v_mfma_f32_16x16x32_bf16 a[36:39], a[180:183], v[40:43], a[36:39]
  v_exp_f32 v113, v113
  v_mfma_f32_16x16x32_bf16 a[36:39], a[176:179], v[8:11], a[36:39]
  ds_read_b64_tr_b16 a[170:171], v221 offset:4096
  v_cvt_pk_bf16_f32 v112, v112, v113
  v_mfma_f32_16x16x32_bf16 a[40:43], a[176:179], v[16:19], a[40:43]
  v_exp_f32 v114, v114
  v_mfma_f32_16x16x32_bf16 a[40:43], a[180:183], v[48:51], a[40:43]
  ds_read_b64_tr_b16 a[172:173], v221 offset:8192
  v_mfma_f32_16x16x32_bf16 a[44:47], a[180:183], v[56:59], a[44:47]
  s_waitcnt lgkmcnt(7)
  v_exp_f32 v115, v115
  v_mfma_f32_16x16x32_bf16 a[44:47], a[176:179], v[24:27], a[44:47]
  ds_read_b64_tr_b16 a[174:175], v221 offset:12288
  v_cvt_pk_bf16_f32 v113, v114, v115
  v_mfma_f32_16x16x32_bf16 a[48:51], a[184:187], v[0:3], a[48:51]
  v_exp_f32 v120, v120
  v_mfma_f32_16x16x32_bf16 a[48:51], a[188:191], v[32:35], a[48:51]
  ds_read_b64_tr_b16 a[176:177], v222 offset:0
  v_mfma_f32_16x16x32_bf16 a[52:55], a[188:191], v[40:43], a[52:55]
  v_exp_f32 v121, v121
  v_mfma_f32_16x16x32_bf16 a[52:55], a[184:187], v[8:11], a[52:55]
  ds_read_b64_tr_b16 a[178:179], v222 offset:4096
  v_cvt_pk_bf16_f32 v120, v120, v121
  v_mfma_f32_16x16x32_bf16 a[56:59], a[184:187], v[16:19], a[56:59]
  v_exp_f32 v122, v122
  v_mfma_f32_16x16x32_bf16 a[56:59], a[188:191], v[48:51], a[56:59]
  ds_read_b64_tr_b16 a[180:181], v222 offset:8192
  v_mfma_f32_16x16x32_bf16 a[60:63], a[188:191], v[56:59], a[60:63]
  s_waitcnt lgkmcnt(7)
  v_exp_f32 v123, v123
  v_mfma_f32_16x16x32_bf16 a[60:63], a[184:187], v[24:27], a[60:63]
  ds_read_b64_tr_b16 a[182:183], v222 offset:12288
  v_cvt_pk_bf16_f32 v121, v122, v123
  v_mfma_f32_16x16x32_bf16 a[64:67], a[160:163], v[0:3], a[64:67]
  v_exp_f32 v100, v100
  v_mfma_f32_16x16x32_bf16 a[64:67], a[164:167], v[32:35], a[64:67]
  ds_read_b64_tr_b16 a[184:185], v223 offset:0
  v_mfma_f32_16x16x32_bf16 a[68:71], a[164:167], v[40:43], a[68:71]
  v_exp_f32 v101, v101
  v_mfma_f32_16x16x32_bf16 a[68:71], a[160:163], v[8:11], a[68:71]
  ds_read_b64_tr_b16 a[186:187], v223 offset:4096
  v_cvt_pk_bf16_f32 v98, v100, v101
  v_mfma_f32_16x16x32_bf16 a[72:75], a[160:163], v[16:19], a[72:75]
  v_exp_f32 v102, v102
  v_mfma_f32_16x16x32_bf16 a[72:75], a[164:167], v[48:51], a[72:75]
  ds_read_b64_tr_b16 a[188:189], v223 offset:8192
  v_mfma_f32_16x16x32_bf16 a[76:79], a[164:167], v[56:59], a[76:79]
  s_waitcnt lgkmcnt(7)
  v_exp_f32 v103, v103
  v_mfma_f32_16x16x32_bf16 a[76:79], a[160:163], v[24:27], a[76:79]
  ds_read_b64_tr_b16 a[190:191], v223 offset:12288
  v_cvt_pk_bf16_f32 v99, v102, v103
  v_mfma_f32_16x16x32_bf16 a[80:83], a[168:171], v[0:3], a[80:83]
  s_waitcnt vmcnt(11)
  v_exp_f32 v108, v108
  v_mfma_f32_16x16x32_bf16 a[80:83], a[172:175], v[32:35], a[80:83]
  v_mfma_f32_16x16x32_bf16 a[84:87], a[172:175], v[40:43], a[84:87]
  s_barrier
  v_exp_f32 v109, v109
  v_mfma_f32_16x16x32_bf16 a[84:87], a[168:171], v[8:11], a[84:87]
  ds_read_b128 a[128:131], v212 offset:32768
  v_cvt_pk_bf16_f32 v106, v108, v109
  v_mfma_f32_16x16x32_bf16 a[88:91], a[168:171], v[16:19], a[88:91]
  v_exp_f32 v110, v110
  v_mfma_f32_16x16x32_bf16 a[88:91], a[172:175], v[48:51], a[88:91]
  ds_read_b128 a[132:135], v213 offset:32768
  v_mfma_f32_16x16x32_bf16 a[92:95], a[172:175], v[56:59], a[92:95]
  s_waitcnt lgkmcnt(6)
  v_exp_f32 v111, v111
  v_mfma_f32_16x16x32_bf16 a[92:95], a[168:171], v[24:27], a[92:95]
  ds_read_b128 a[136:139], v214 offset:32768
  v_cvt_pk_bf16_f32 v107, v110, v111
  v_mfma_f32_16x16x32_bf16 a[96:99], a[176:179], v[0:3], a[96:99]
  v_exp_f32 v116, v116
  v_mfma_f32_16x16x32_bf16 a[96:99], a[180:183], v[32:35], a[96:99]
  ds_read_b128 a[140:143], v215 offset:32768
  buffer_load_dwordx4 a[228:231], v243, s[24:27], s38 offen sc1
  s_add_u32 s38, s38, 4096
  v_mfma_f32_16x16x32_bf16 a[100:103], a[180:183], v[40:43], a[100:103]
  v_exp_f32 v117, v117
  v_mfma_f32_16x16x32_bf16 a[100:103], a[176:179], v[8:11], a[100:103]
  v_cvt_pk_bf16_f32 v114, v116, v117
  v_mfma_f32_16x16x32_bf16 a[104:107], a[176:179], v[16:19], a[104:107]
  v_exp_f32 v118, v118
  v_mfma_f32_16x16x32_bf16 a[104:107], a[180:183], v[48:51], a[104:107]
  v_mfma_f32_16x16x32_bf16 a[108:111], a[180:183], v[56:59], a[108:111]
  s_waitcnt lgkmcnt(4)
  v_exp_f32 v119, v119
  v_mfma_f32_16x16x32_bf16 a[108:111], a[176:179], v[24:27], a[108:111]
  v_cvt_pk_bf16_f32 v115, v118, v119
  v_mfma_f32_16x16x32_bf16 a[112:115], a[184:187], v[0:3], a[112:115]
  v_exp_f32 v124, v124
  v_mfma_f32_16x16x32_bf16 a[112:115], a[188:191], v[32:35], a[112:115]
  v_mfma_f32_16x16x32_bf16 a[116:119], a[188:191], v[40:43], a[116:119]
  v_exp_f32 v125, v125
  v_mfma_f32_16x16x32_bf16 a[116:119], a[184:187], v[8:11], a[116:119]
  v_cvt_pk_bf16_f32 v122, v124, v125
  v_mfma_f32_16x16x32_bf16 a[120:123], a[184:187], v[16:19], a[120:123]
  v_exp_f32 v126, v126
  v_mfma_f32_16x16x32_bf16 a[120:123], a[188:191], v[48:51], a[120:123]
  v_mfma_f32_16x16x32_bf16 a[124:127], a[188:191], v[56:59], a[124:127]
  s_waitcnt lgkmcnt(0)
  v_exp_f32 v127, v127
  v_mfma_f32_16x16x32_bf16 a[124:127], a[184:187], v[24:27], a[124:127]
  v_cvt_pk_bf16_f32 v123, v126, v127
  v_mfma_f32_16x16x32_bf16 v[0:3], a[128:131], v[128:131], v[192:195]
  s_add_u32 m0, s28, 114688
  s_mov_b32 s20, s88
  s_mov_b32 s21, s89
  s_mov_b32 s22, 5242880
  s_mov_b32 s23, 0x20000
  v_lshrrev_b32 v208, 4, v242
  v_and_b32 v209, 1, v208
  v_mfma_f32_16x16x32_bf16 v[0:3], a[132:135], v[132:135], v[0:3]
  ds_read_b128 a[144:147], v212 offset:36864
  v_lshrrev_b32 v208, 1, v208
  v_mfma_f32_16x16x32_bf16 v[0:3], a[136:139], v[136:139], v[0:3]
  buffer_load_dwordx4 v236, s[16:19], s29 offen offset:0 lds
  v_mfma_f32_16x16x32_bf16 v[0:3], a[140:143], v[140:143], v[0:3]
  ds_read_b128 a[148:151], v213 offset:36864
  v_mul_u32_u24 v208, 0x500, v208
  v_mfma_f32_16x16x32_bf16 v[8:11], a[140:143], v[156:159], v[196:199]
  buffer_load_dwordx4 v237, s[16:19], s29 offen offset:1024 lds
  v_mfma_f32_16x16x32_bf16 v[8:11], a[136:139], v[152:155], v[8:11]
  ds_read_b128 a[152:155], v214 offset:36864
  v_lshl_add_u32 v208, v209, 4, v208
  v_mfma_f32_16x16x32_bf16 v[8:11], a[132:135], v[148:151], v[8:11]
  buffer_load_dwordx4 v236, s[16:19], s29 offen offset:2048 lds
  v_mfma_f32_16x16x32_bf16 v[8:11], a[128:131], v[144:147], v[8:11]
  ds_read_b128 a[156:159], v215 offset:36864
  v_lshrrev_b32 v209, 4, v242
  v_mfma_f32_16x16x32_bf16 v[16:19], a[128:131], v[160:163], v[200:203]
  v_exp_f32 v0, v0
  v_mfma_f32_16x16x32_bf16 v[16:19], a[132:135], v[164:167], v[16:19]
  buffer_load_dwordx4 v237, s[16:19], s29 offen offset:3072 lds
  v_mfma_f32_16x16x32_bf16 v[16:19], a[136:139], v[168:171], v[16:19]
  s_add_u32 s29, s29, 16384
  v_exp_f32 v1, v1
  v_mfma_f32_16x16x32_bf16 v[16:19], a[140:143], v[172:175], v[16:19]
  v_cvt_pk_bf16_f32 v0, v0, v1
  v_lshrrev_b32 v210, 5, v209
  v_mfma_f32_16x16x32_bf16 v[24:27], a[140:143], v[188:191], v[204:207]
  s_add_u32 m0, s28, 0
  v_exp_f32 v2, v2
  v_mfma_f32_16x16x32_bf16 v[24:27], a[136:139], v[184:187], v[24:27]
  buffer_load_dwordx4 v232, s[12:15], s29 offen offset:0 lds
  v_mfma_f32_16x16x32_bf16 v[24:27], a[132:135], v[180:183], v[24:27]
  s_waitcnt lgkmcnt(0)
  v_exp_f32 v3, v3
  v_mfma_f32_16x16x32_bf16 v[24:27], a[128:131], v[176:179], v[24:27]
  v_cvt_pk_bf16_f32 v1, v2, v3
  v_lshlrev_b32 v210, 30, v210
  v_mfma_f32_16x16x32_bf16 v[4:7], a[144:147], v[128:131], v[192:195]
  v_exp_f32 v8, v8
  v_mfma_f32_16x16x32_bf16 v[4:7], a[148:151], v[132:135], v[4:7]
  ds_read_b128 a[128:131], v212 offset:40960
  v_or_b32 v210, v210, v208
  v_mfma_f32_16x16x32_bf16 v[4:7], a[152:155], v[136:139], v[4:7]
  v_exp_f32 v9, v9
  v_mfma_f32_16x16x32_bf16 v[4:7], a[156:159], v[140:143], v[4:7]
  ds_read_b128 a[132:135], v213 offset:40960
  v_cvt_pk_bf16_f32 v8, v8, v9
  v_mfma_f32_16x16x32_bf16 v[12:15], a[156:159], v[156:159], v[196:199]
  v_exp_f32 v10, v10
  v_mfma_f32_16x16x32_bf16 v[12:15], a[152:155], v[152:155], v[12:15]
  ds_read_b128 a[136:139], v214 offset:40960
  v_bfe_u32 v211, v209, 2, 4
  v_mfma_f32_16x16x32_bf16 v[12:15], a[148:151], v[148:151], v[12:15]
  v_exp_f32 v11, v11
  v_mfma_f32_16x16x32_bf16 v[12:15], a[144:147], v[144:147], v[12:15]
  ds_read_b128 a[140:143], v215 offset:40960
  v_cvt_pk_bf16_f32 v9, v10, v11
  v_mfma_f32_16x16x32_bf16 v[20:23], a[144:147], v[160:163], v[200:203]
  v_exp_f32 v16, v16
  v_mfma_f32_16x16x32_bf16 v[20:23], a[148:151], v[164:167], v[20:23]
  buffer_load_dwordx4 v233, s[12:15], s29 offen offset:1024 lds
  v_mfma_f32_16x16x32_bf16 v[20:23], a[152:155], v[168:171], v[20:23]
  v_exp_f32 v17, v17
  v_mfma_f32_16x16x32_bf16 v[20:23], a[156:159], v[172:175], v[20:23]
  v_cvt_pk_bf16_f32 v16, v16, v17
  v_and_b32 v209, 3, v209
  v_mfma_f32_16x16x32_bf16 v[28:31], a[156:159], v[188:191], v[204:207]
  v_exp_f32 v18, v18
  v_mfma_f32_16x16x32_bf16 v[28:31], a[152:155], v[184:187], v[28:31]
  buffer_load_dwordx4 v234, s[12:15], s29 offen offset:2048 lds
  v_mfma_f32_16x16x32_bf16 v[28:31], a[148:151], v[180:183], v[28:31]
  s_waitcnt lgkmcnt(0)
  v_exp_f32 v19, v19
  v_mfma_f32_16x16x32_bf16 v[28:31], a[144:147], v[176:179], v[28:31]
  v_cvt_pk_bf16_f32 v17, v18, v19
  v_lshlrev_b32 v209, 3, v209
  v_mfma_f32_16x16x32_bf16 v[32:35], a[128:131], v[128:131], v[192:195]
  v_exp_f32 v24, v24
  v_mfma_f32_16x16x32_bf16 v[32:35], a[132:135], v[132:135], v[32:35]
  ds_read_b128 a[144:147], v212 offset:45056
  v_lshl_add_u32 v209, v211, 5, v209
  v_mfma_f32_16x16x32_bf16 v[32:35], a[136:139], v[136:139], v[32:35]
  v_exp_f32 v25, v25
  v_mfma_f32_16x16x32_bf16 v[32:35], a[140:143], v[140:143], v[32:35]
  ds_read_b128 a[148:151], v213 offset:45056
  v_cvt_pk_bf16_f32 v24, v24, v25
  v_mfma_f32_16x16x32_bf16 v[40:43], a[140:143], v[156:159], v[196:199]
  v_exp_f32 v26, v26
  v_mfma_f32_16x16x32_bf16 v[40:43], a[136:139], v[152:155], v[40:43]
  ds_read_b128 a[152:155], v214 offset:45056
  v_add_u32 v209, s50, v209
  v_mfma_f32_16x16x32_bf16 v[40:43], a[132:135], v[148:151], v[40:43]
  s_and_b32 s39, s2, 1
  s_lshl_b32 s39, s39, 2
  s_add_u32 s39, s39, s3
  s_lshr_b32 s31, s2, 1
  s_mul_i32 s30, s31, 40960
  s_mul_i32 s48, s39, 160
  s_add_u32 s30, s30, s48
  s_mul_i32 s31, s31, 5120
  s_mul_i32 s39, s39, 655360
  s_add_u32 s31, s31, s39
  s_add_u32 s31, s31, 3145728
  s_lshr_b32 s39, s2, 3
  s_min_u32 s39, s39, 29
  s_and_b32 s48, s2, 7
  s_mul_i32 s48, s48, 30
  s_add_u32 s39, s39, s48
  s_mul_i32 s98, s39, 1639
  s_lshr_b32 s98, s98, 16
  s_mul_i32 s99, s98, 40
  s_sub_u32 s99, s39, s99
  s_min_u32 s39, s3, 2
  s_mul_i32 s48, s98, 3
  s_add_u32 s48, s48, s39
  s_mul_i32 s100, s48, 122880
  s_lshl_b32 s39, s99, 5
  s_add_u32 s100, s100, s39
  s_mul_i32 s101, s48, 192
  s_add_u32 s101, s101, 2633728
  s_mov_b32 s51, s50
  v_exp_f32 v27, v27
  v_mfma_f32_16x16x32_bf16 v[40:43], a[128:131], v[144:147], v[40:43]
  ds_read_b128 a[156:159], v215 offset:45056
  v_cvt_pk_bf16_f32 v25, v26, v27
  v_mfma_f32_16x16x32_bf16 v[48:51], a[128:131], v[160:163], v[200:203]
  v_exp_f32 v4, v4
  v_mfma_f32_16x16x32_bf16 v[48:51], a[132:135], v[164:167], v[48:51]
  buffer_load_dwordx4 v235, s[12:15], s29 offen offset:3072 lds
  v_mfma_f32_16x16x32_bf16 v[48:51], a[136:139], v[168:171], v[48:51]
  v_exp_f32 v5, v5
  v_mfma_f32_16x16x32_bf16 v[48:51], a[140:143], v[172:175], v[48:51]
  v_cvt_pk_bf16_f32 v2, v4, v5
  v_mov_b32 v211, v242
  v_mfma_f32_16x16x32_bf16 v[56:59], a[140:143], v[188:191], v[204:207]
  s_mov_b32 s4, s94
  s_mov_b32 s5, s95
  s_mov_b32 s6, 2211840
  s_mov_b32 s7, 0x20000
  v_exp_f32 v6, v6
  v_mfma_f32_16x16x32_bf16 v[56:59], a[136:139], v[184:187], v[56:59]
  v_mfma_f32_16x16x32_bf16 v[56:59], a[132:135], v[180:183], v[56:59]
  s_waitcnt lgkmcnt(0)
  v_exp_f32 v7, v7
  v_mfma_f32_16x16x32_bf16 v[56:59], a[128:131], v[176:179], v[56:59]
  v_cvt_pk_bf16_f32 v3, v6, v7
  v_mfma_f32_16x16x32_bf16 v[36:39], a[144:147], v[128:131], v[192:195]
  v_exp_f32 v12, v12
  v_mfma_f32_16x16x32_bf16 v[36:39], a[148:151], v[132:135], v[36:39]
  ds_read_b64_tr_b16 a[160:161], v216 offset:16384
  v_mfma_f32_16x16x32_bf16 v[36:39], a[152:155], v[136:139], v[36:39]
  v_exp_f32 v13, v13
  v_mfma_f32_16x16x32_bf16 v[36:39], a[156:159], v[140:143], v[36:39]
  ds_read_b64_tr_b16 a[162:163], v216 offset:20480
  v_cvt_pk_bf16_f32 v10, v12, v13
  v_mfma_f32_16x16x32_bf16 v[44:47], a[156:159], v[156:159], v[196:199]
  v_exp_f32 v14, v14
  v_mfma_f32_16x16x32_bf16 v[44:47], a[152:155], v[152:155], v[44:47]
  ds_read_b64_tr_b16 a[164:165], v216 offset:24576
  v_mfma_f32_16x16x32_bf16 v[44:47], a[148:151], v[148:151], v[44:47]
  v_exp_f32 v15, v15
  v_mfma_f32_16x16x32_bf16 v[44:47], a[144:147], v[144:147], v[44:47]
  ds_read_b64_tr_b16 a[166:167], v216 offset:28672
  v_cvt_pk_bf16_f32 v11, v14, v15
  v_mfma_f32_16x16x32_bf16 v[52:55], a[144:147], v[160:163], v[200:203]
  v_exp_f32 v20, v20
  v_mfma_f32_16x16x32_bf16 v[52:55], a[148:151], v[164:167], v[52:55]
  ds_read_b64_tr_b16 a[168:169], v217 offset:16384
  v_mfma_f32_16x16x32_bf16 v[52:55], a[152:155], v[168:171], v[52:55]
  v_exp_f32 v21, v21
  v_mfma_f32_16x16x32_bf16 v[52:55], a[156:159], v[172:175], v[52:55]
  ds_read_b64_tr_b16 a[170:171], v217 offset:20480
  v_cvt_pk_bf16_f32 v18, v20, v21
  v_mfma_f32_16x16x32_bf16 v[60:63], a[156:159], v[188:191], v[204:207]
  v_exp_f32 v22, v22
  v_mfma_f32_16x16x32_bf16 v[60:63], a[152:155], v[184:187], v[60:63]
  ds_read_b64_tr_b16 a[172:173], v217 offset:24576
  v_mfma_f32_16x16x32_bf16 v[60:63], a[148:151], v[180:183], v[60:63]
  v_exp_f32 v23, v23
  v_mfma_f32_16x16x32_bf16 v[60:63], a[144:147], v[176:179], v[60:63]
  ds_read_b64_tr_b16 a[174:175], v217 offset:28672
  v_cvt_pk_bf16_f32 v19, v22, v23
  v_mfma_f32_16x16x32_bf16 a[192:195], a[208:211], v[64:67], a[192:195]
  v_exp_f32 v28, v28
  v_mfma_f32_16x16x32_bf16 a[192:195], a[208:211], v[96:99], a[192:195]
  ds_read_b64_tr_b16 a[176:177], v218 offset:16384
  v_mfma_f32_16x16x32_bf16 a[196:199], a[208:211], v[72:75], a[196:199]
  v_exp_f32 v29, v29
  v_mfma_f32_16x16x32_bf16 a[196:199], a[208:211], v[104:107], a[196:199]
  ds_read_b64_tr_b16 a[178:179], v218 offset:20480
  v_cvt_pk_bf16_f32 v26, v28, v29
  v_mfma_f32_16x16x32_bf16 a[200:203], a[208:211], v[80:83], a[200:203]
  v_exp_f32 v30, v30
  v_mfma_f32_16x16x32_bf16 a[200:203], a[208:211], v[112:115], a[200:203]
  ds_read_b64_tr_b16 a[180:181], v218 offset:24576
  v_mfma_f32_16x16x32_bf16 a[204:207], a[208:211], v[88:91], a[204:207]
  s_waitcnt lgkmcnt(7)
  v_exp_f32 v31, v31
  v_mfma_f32_16x16x32_bf16 a[204:207], a[208:211], v[120:123], a[204:207]
  ds_read_b64_tr_b16 a[182:183], v218 offset:28672
  v_cvt_pk_bf16_f32 v27, v30, v31
  v_mfma_f32_16x16x32_bf16 a[0:3], a[160:163], v[64:67], a[0:3]
  v_exp_f32 v32, v32
  v_mfma_f32_16x16x32_bf16 a[0:3], a[164:167], v[96:99], a[0:3]
  ds_read_b64_tr_b16 a[184:185], v219 offset:16384
  v_mfma_f32_16x16x32_bf16 a[4:7], a[164:167], v[104:107], a[4:7]
  v_exp_f32 v33, v33
  v_mfma_f32_16x16x32_bf16 a[4:7], a[160:163], v[72:75], a[4:7]
  ds_read_b64_tr_b16 a[186:187], v219 offset:20480
  v_cvt_pk_bf16_f32 v32, v32, v33
  v_mfma_f32_16x16x32_bf16 a[8:11], a[160:163], v[80:83], a[8:11]
  v_exp_f32 v34, v34
  v_mfma_f32_16x16x32_bf16 a[8:11], a[164:167], v[112:115], a[8:11]
  ds_read_b64_tr_b16 a[188:189], v219 offset:24576
  v_mfma_f32_16x16x32_bf16 a[12:15], a[164:167], v[120:123], a[12:15]
  s_waitcnt lgkmcnt(7)
  v_exp_f32 v35, v35
  v_mfma_f32_16x16x32_bf16 a[12:15], a[160:163], v[88:91], a[12:15]
  ds_read_b64_tr_b16 a[190:191], v219 offset:28672
  v_cvt_pk_bf16_f32 v33, v34, v35
  v_mfma_f32_16x16x32_bf16 a[16:19], a[168:171], v[64:67], a[16:19]
  v_exp_f32 v40, v40
  v_mfma_f32_16x16x32_bf16 a[16:19], a[172:175], v[96:99], a[16:19]
  ds_read_b64_tr_b16 a[160:161], v220 offset:16384
  v_mfma_f32_16x16x32_bf16 a[20:23], a[172:175], v[104:107], a[20:23]
  v_exp_f32 v41, v41
  v_mfma_f32_16x16x32_bf16 a[20:23], a[168:171], v[72:75], a[20:23]
  ds_read_b64_tr_b16 a[162:163], v220 offset:20480
  v_cvt_pk_bf16_f32 v40, v40, v41
  v_mfma_f32_16x16x32_bf16 a[24:27], a[168:171], v[80:83], a[24:27]
  v_exp_f32 v42, v42
  v_mfma_f32_16x16x32_bf16 a[24:27], a[172:175], v[112:115], a[24:27]
  ds_read_b64_tr_b16 a[164:165], v220 offset:24576
  v_mfma_f32_16x16x32_bf16 a[28:31], a[172:175], v[120:123], a[28:31]
  s_waitcnt lgkmcnt(7)
  v_exp_f32 v43, v43
  v_mfma_f32_16x16x32_bf16 a[28:31], a[168:171], v[88:91], a[28:31]
  ds_read_b64_tr_b16 a[166:167], v220 offset:28672
  v_cvt_pk_bf16_f32 v41, v42, v43
  v_mfma_f32_16x16x32_bf16 a[32:35], a[176:179], v[64:67], a[32:35]
  v_exp_f32 v48, v48
  v_mfma_f32_16x16x32_bf16 a[32:35], a[180:183], v[96:99], a[32:35]
  ds_read_b64_tr_b16 a[168:169], v221 offset:16384
  v_mfma_f32_16x16x32_bf16 a[36:39], a[180:183], v[104:107], a[36:39]
  v_exp_f32 v49, v49
  v_mfma_f32_16x16x32_bf16 a[36:39], a[176:179], v[72:75], a[36:39]
  ds_read_b64_tr_b16 a[170:171], v221 offset:20480
  v_cvt_pk_bf16_f32 v48, v48, v49
  v_mfma_f32_16x16x32_bf16 a[40:43], a[176:179], v[80:83], a[40:43]
  v_exp_f32 v50, v50
  v_mfma_f32_16x16x32_bf16 a[40:43], a[180:183], v[112:115], a[40:43]
  ds_read_b64_tr_b16 a[172:173], v221 offset:24576
  v_mfma_f32_16x16x32_bf16 a[44:47], a[180:183], v[120:123], a[44:47]
  s_waitcnt lgkmcnt(7)
  v_exp_f32 v51, v51
  v_mfma_f32_16x16x32_bf16 a[44:47], a[176:179], v[88:91], a[44:47]
  ds_read_b64_tr_b16 a[174:175], v221 offset:28672
  v_cvt_pk_bf16_f32 v49, v50, v51
  v_mfma_f32_16x16x32_bf16 a[48:51], a[184:187], v[64:67], a[48:51]
  v_exp_f32 v56, v56
  v_mfma_f32_16x16x32_bf16 a[48:51], a[188:191], v[96:99], a[48:51]
  ds_read_b64_tr_b16 a[176:177], v222 offset:16384
  v_mfma_f32_16x16x32_bf16 a[52:55], a[188:191], v[104:107], a[52:55]
  v_exp_f32 v57, v57
  v_mfma_f32_16x16x32_bf16 a[52:55], a[184:187], v[72:75], a[52:55]
  ds_read_b64_tr_b16 a[178:179], v222 offset:20480
  v_cvt_pk_bf16_f32 v56, v56, v57
  v_mfma_f32_16x16x32_bf16 a[56:59], a[184:187], v[80:83], a[56:59]
  v_exp_f32 v58, v58
  v_mfma_f32_16x16x32_bf16 a[56:59], a[188:191], v[112:115], a[56:59]
  ds_read_b64_tr_b16 a[180:181], v222 offset:24576
  v_mfma_f32_16x16x32_bf16 a[60:63], a[188:191], v[120:123], a[60:63]
  s_waitcnt lgkmcnt(7)
  v_exp_f32 v59, v59
  v_mfma_f32_16x16x32_bf16 a[60:63], a[184:187], v[88:91], a[60:63]
  ds_read_b64_tr_b16 a[182:183], v222 offset:28672
  v_cvt_pk_bf16_f32 v57, v58, v59
  v_mfma_f32_16x16x32_bf16 a[64:67], a[160:163], v[64:67], a[64:67]
  v_exp_f32 v36, v36
  v_mfma_f32_16x16x32_bf16 a[64:67], a[164:167], v[96:99], a[64:67]
  ds_read_b64_tr_b16 a[184:185], v223 offset:16384
  v_mfma_f32_16x16x32_bf16 a[68:71], a[164:167], v[104:107], a[68:71]
  v_exp_f32 v37, v37
  v_mfma_f32_16x16x32_bf16 a[68:71], a[160:163], v[72:75], a[68:71]
  ds_read_b64_tr_b16 a[186:187], v223 offset:20480
  v_cvt_pk_bf16_f32 v34, v36, v37
  v_mfma_f32_16x16x32_bf16 a[72:75], a[160:163], v[80:83], a[72:75]
  v_exp_f32 v38, v38
  v_mfma_f32_16x16x32_bf16 a[72:75], a[164:167], v[112:115], a[72:75]
  ds_read_b64_tr_b16 a[188:189], v223 offset:24576
  v_mfma_f32_16x16x32_bf16 a[76:79], a[164:167], v[120:123], a[76:79]
  s_waitcnt lgkmcnt(7)
  v_exp_f32 v39, v39
  v_mfma_f32_16x16x32_bf16 a[76:79], a[160:163], v[88:91], a[76:79]
  ds_read_b64_tr_b16 a[190:191], v223 offset:28672
  v_cvt_pk_bf16_f32 v35, v38, v39
  v_mfma_f32_16x16x32_bf16 a[80:83], a[168:171], v[64:67], a[80:83]
  s_waitcnt vmcnt(10)
  v_exp_f32 v44, v44
  v_mfma_f32_16x16x32_bf16 a[80:83], a[172:175], v[96:99], a[80:83]
  v_mfma_f32_16x16x32_bf16 a[84:87], a[172:175], v[104:107], a[84:87]
  s_barrier
  v_exp_f32 v45, v45
  v_mfma_f32_16x16x32_bf16 a[84:87], a[168:171], v[72:75], a[84:87]
  ds_read_b128 a[128:131], v212 offset:49152
  v_cvt_pk_bf16_f32 v42, v44, v45
  v_mfma_f32_16x16x32_bf16 a[88:91], a[168:171], v[80:83], a[88:91]
  v_exp_f32 v46, v46
  v_mfma_f32_16x16x32_bf16 a[88:91], a[172:175], v[112:115], a[88:91]
  ds_read_b128 a[132:135], v213 offset:49152
  v_mfma_f32_16x16x32_bf16 a[92:95], a[172:175], v[120:123], a[92:95]
  s_waitcnt lgkmcnt(6)
  v_exp_f32 v47, v47
  v_mfma_f32_16x16x32_bf16 a[92:95], a[168:171], v[88:91], a[92:95]
  ds_read_b128 a[136:139], v214 offset:49152
  v_cvt_pk_bf16_f32 v43, v46, v47
  v_mfma_f32_16x16x32_bf16 a[96:99], a[176:179], v[64:67], a[96:99]
  v_exp_f32 v52, v52
  v_mfma_f32_16x16x32_bf16 a[96:99], a[180:183], v[96:99], a[96:99]
  ds_read_b128 a[140:143], v215 offset:49152
  v_mfma_f32_16x16x32_bf16 a[100:103], a[180:183], v[104:107], a[100:103]
  v_exp_f32 v53, v53
  v_mfma_f32_16x16x32_bf16 a[100:103], a[176:179], v[72:75], a[100:103]
  v_cvt_pk_bf16_f32 v50, v52, v53
  v_mfma_f32_16x16x32_bf16 a[104:107], a[176:179], v[80:83], a[104:107]
  v_exp_f32 v54, v54
  v_mfma_f32_16x16x32_bf16 a[104:107], a[180:183], v[112:115], a[104:107]
  v_mfma_f32_16x16x32_bf16 a[108:111], a[180:183], v[120:123], a[108:111]
  s_waitcnt lgkmcnt(4)
  v_exp_f32 v55, v55
  v_mfma_f32_16x16x32_bf16 a[108:111], a[176:179], v[88:91], a[108:111]
  v_cvt_pk_bf16_f32 v51, v54, v55
  v_mfma_f32_16x16x32_bf16 a[112:115], a[184:187], v[64:67], a[112:115]
  v_exp_f32 v60, v60
  v_mfma_f32_16x16x32_bf16 a[112:115], a[188:191], v[96:99], a[112:115]
  v_mfma_f32_16x16x32_bf16 a[116:119], a[188:191], v[104:107], a[116:119]
  v_exp_f32 v61, v61
  v_mfma_f32_16x16x32_bf16 a[116:119], a[184:187], v[72:75], a[116:119]
  v_cvt_pk_bf16_f32 v58, v60, v61
  v_mfma_f32_16x16x32_bf16 a[120:123], a[184:187], v[80:83], a[120:123]
  v_exp_f32 v62, v62
  v_mfma_f32_16x16x32_bf16 a[120:123], a[188:191], v[112:115], a[120:123]
  v_mfma_f32_16x16x32_bf16 a[124:127], a[188:191], v[120:123], a[124:127]
  s_waitcnt lgkmcnt(0)
  v_exp_f32 v63, v63
  v_mfma_f32_16x16x32_bf16 a[124:127], a[184:187], v[88:91], a[124:127]
  v_cvt_pk_bf16_f32 v59, v62, v63
  v_mfma_f32_16x16x32_bf16 v[64:67], a[128:131], v[128:131], v[192:195]
  s_add_u32 m0, s28, 65536
  v_lshrrev_b32 v224, 4, v242
  v_lshrrev_b32 v225, 4, v224
  v_mfma_f32_16x16x32_bf16 v[64:67], a[132:135], v[132:135], v[64:67]
  ds_read_b128 a[144:147], v212 offset:53248
  v_bfe_u32 v226, v224, 2, 2
  v_mfma_f32_16x16x32_bf16 v[64:67], a[136:139], v[136:139], v[64:67]
  buffer_load_dwordx4 v236, s[16:19], s29 offen offset:0 lds
  v_mfma_f32_16x16x32_bf16 v[64:67], a[140:143], v[140:143], v[64:67]
  ds_read_b128 a[148:151], v213 offset:53248
  v_lshl_add_u32 v225, v225, 3, v226
  v_mfma_f32_16x16x32_bf16 v[72:75], a[140:143], v[156:159], v[196:199]
  buffer_load_dwordx4 v237, s[16:19], s29 offen offset:1024 lds
  v_mfma_f32_16x16x32_bf16 v[72:75], a[136:139], v[152:155], v[72:75]
  ds_read_b128 a[152:155], v214 offset:53248
  v_lshlrev_b32 v225, 4, v225
  v_mfma_f32_16x16x32_bf16 v[72:75], a[132:135], v[148:151], v[72:75]
  buffer_load_dwordx4 v236, s[16:19], s29 offen offset:2048 lds
  v_mfma_f32_16x16x32_bf16 v[72:75], a[128:131], v[144:147], v[72:75]
  ds_read_b128 a[156:159], v215 offset:53248
  v_bfe_u32 v226, v224, 1, 1
  v_mfma_f32_16x16x32_bf16 v[80:83], a[128:131], v[160:163], v[200:203]
  v_exp_f32 v64, v64
  v_mfma_f32_16x16x32_bf16 v[80:83], a[132:135], v[164:167], v[80:83]
  buffer_load_dwordx4 v237, s[16:19], s29 offen offset:3072 lds
  v_mfma_f32_16x16x32_bf16 v[80:83], a[136:139], v[168:171], v[80:83]
  s_add_u32 s29, s29, 16384
  v_exp_f32 v65, v65
  v_mfma_f32_16x16x32_bf16 v[80:83], a[140:143], v[172:175], v[80:83]
  v_cvt_pk_bf16_f32 v64, v64, v65
  v_mul_u32_u24 v226, 0xc00, v226
  v_mfma_f32_16x16x32_bf16 v[88:91], a[140:143], v[188:191], v[204:207]
  s_add_u32 m0, s28, 16384
  v_exp_f32 v66, v66
  v_mfma_f32_16x16x32_bf16 v[88:91], a[136:139], v[184:187], v[88:91]
  buffer_load_dwordx4 v232, s[12:15], s29 offen offset:0 lds
  v_mfma_f32_16x16x32_bf16 v[88:91], a[132:135], v[180:183], v[88:91]
  s_waitcnt lgkmcnt(0)
  v_exp_f32 v67, v67
  v_mfma_f32_16x16x32_bf16 v[88:91], a[128:131], v[176:179], v[88:91]
  v_cvt_pk_bf16_f32 v65, v66, v67
  v_add3_u32 v225, v225, v226, s50
  v_mfma_f32_16x16x32_bf16 v[68:71], a[144:147], v[128:131], v[192:195]
  v_exp_f32 v72, v72
  v_mfma_f32_16x16x32_bf16 v[68:71], a[148:151], v[132:135], v[68:71]
  ds_read_b128 a[128:131], v212 offset:57344
  v_and_b32 v226, 1, v224
  v_mfma_f32_16x16x32_bf16 v[68:71], a[152:155], v[136:139], v[68:71]
  v_exp_f32 v73, v73
  v_mfma_f32_16x16x32_bf16 v[68:71], a[156:159], v[140:143], v[68:71]
  ds_read_b128 a[132:135], v213 offset:57344
  v_cvt_pk_bf16_f32 v72, v72, v73
  v_mfma_f32_16x16x32_bf16 v[76:79], a[156:159], v[156:159], v[196:199]
  v_exp_f32 v74, v74
  v_mfma_f32_16x16x32_bf16 v[76:79], a[152:155], v[152:155], v[76:79]
  ds_read_b128 a[136:139], v214 offset:57344
  v_lshl_add_u32 v225, v226, 3, v225
  v_mfma_f32_16x16x32_bf16 v[76:79], a[148:151], v[148:151], v[76:79]
  s_waitcnt vmcnt(13)
  v_exp_f32 v75, v75
  v_mfma_f32_16x16x32_bf16 v[76:79], a[144:147], v[144:147], v[76:79]
  ds_read_b128 a[140:143], v215 offset:57344
  v_cvt_pk_bf16_f32 v73, v74, v75
  v_mfma_f32_16x16x32_bf16 v[84:87], a[144:147], v[160:163], v[200:203]
  v_exp_f32 v80, v80
  v_mfma_f32_16x16x32_bf16 v[84:87], a[148:151], v[164:167], v[84:87]
  buffer_load_dwordx4 v233, s[12:15], s29 offen offset:1024 lds
  v_mfma_f32_16x16x32_bf16 v[84:87], a[152:155], v[168:171], v[84:87]
  v_exp_f32 v81, v81
  v_mfma_f32_16x16x32_bf16 v[84:87], a[156:159], v[172:175], v[84:87]
  ds_read_b64_tr_b16 a[232:233], v225 offset:0
  v_cvt_pk_bf16_f32 v80, v80, v81
  v_mfma_f32_16x16x32_bf16 v[92:95], a[156:159], v[188:191], v[204:207]
  v_exp_f32 v82, v82
  v_mfma_f32_16x16x32_bf16 v[92:95], a[152:155], v[184:187], v[92:95]
  buffer_load_dwordx4 v234, s[12:15], s29 offen offset:2048 lds
  v_mfma_f32_16x16x32_bf16 v[92:95], a[148:151], v[180:183], v[92:95]
  s_waitcnt lgkmcnt(1)
  v_exp_f32 v83, v83
  v_mfma_f32_16x16x32_bf16 v[92:95], a[144:147], v[176:179], v[92:95]
  ds_read_b64_tr_b16 a[234:235], v225 offset:64
  v_cvt_pk_bf16_f32 v81, v82, v83
  v_mfma_f32_16x16x32_bf16 v[96:99], a[128:131], v[128:131], v[192:195]
  v_exp_f32 v88, v88
  v_mfma_f32_16x16x32_bf16 v[96:99], a[132:135], v[132:135], v[96:99]
  ds_read_b128 a[144:147], v212 offset:61440
  ds_read_b64_tr_b16 a[236:237], v225 offset:512
  v_mfma_f32_16x16x32_bf16 v[96:99], a[136:139], v[136:139], v[96:99]
  v_exp_f32 v89, v89
  v_mfma_f32_16x16x32_bf16 v[96:99], a[140:143], v[140:143], v[96:99]
  ds_read_b128 a[148:151], v213 offset:61440
  v_cvt_pk_bf16_f32 v88, v88, v89
  v_mfma_f32_16x16x32_bf16 v[104:107], a[140:143], v[156:159], v[196:199]
  v_exp_f32 v90, v90
  v_mfma_f32_16x16x32_bf16 v[104:107], a[136:139], v[152:155], v[104:107]
  ds_read_b128 a[152:155], v214 offset:61440
  ds_read_b64_tr_b16 a[238:239], v225 offset:576
  v_mfma_f32_16x16x32_bf16 v[104:107], a[132:135], v[148:151], v[104:107]
  v_exp_f32 v91, v91
  v_mfma_f32_16x16x32_bf16 v[104:107], a[128:131], v[144:147], v[104:107]
  ds_read_b128 a[156:159], v215 offset:61440
  v_cvt_pk_bf16_f32 v89, v90, v91
  v_mfma_f32_16x16x32_bf16 v[112:115], a[128:131], v[160:163], v[200:203]
  v_exp_f32 v68, v68
  v_mfma_f32_16x16x32_bf16 v[112:115], a[132:135], v[164:167], v[112:115]
  buffer_load_dwordx4 v235, s[12:15], s29 offen offset:3072 lds
  v_mfma_f32_16x16x32_bf16 v[112:115], a[136:139], v[168:171], v[112:115]
  v_exp_f32 v69, v69
  v_mfma_f32_16x16x32_bf16 v[112:115], a[140:143], v[172:175], v[112:115]
  ds_read_b64_tr_b16 a[240:241], v225 offset:1024
  v_cvt_pk_bf16_f32 v66, v68, v69
  v_mfma_f32_16x16x32_bf16 v[120:123], a[140:143], v[188:191], v[204:207]
  v_exp_f32 v70, v70
  v_mfma_f32_16x16x32_bf16 v[120:123], a[136:139], v[184:187], v[120:123]
  ds_read_b64_tr_b16 a[242:243], v225 offset:1088
  ds_read_b64_tr_b16 a[244:245], v225 offset:1536
  v_mfma_f32_16x16x32_bf16 v[120:123], a[132:135], v[180:183], v[120:123]
  s_waitcnt lgkmcnt(3)
  v_exp_f32 v71, v71
  v_mfma_f32_16x16x32_bf16 v[120:123], a[128:131], v[176:179], v[120:123]
  ds_read_b64_tr_b16 a[246:247], v225 offset:1600
  v_cvt_pk_bf16_f32 v67, v70, v71
  v_mfma_f32_16x16x32_bf16 v[100:103], a[144:147], v[128:131], v[192:195]
  v_exp_f32 v76, v76
  v_mfma_f32_16x16x32_bf16 v[100:103], a[148:151], v[132:135], v[100:103]
  ds_read_b64_tr_b16 a[160:161], v216 offset:32768
  ds_read_b64_tr_b16 a[248:249], v225 offset:2048
  v_mfma_f32_16x16x32_bf16 v[100:103], a[152:155], v[136:139], v[100:103]
  v_exp_f32 v77, v77
  v_mfma_f32_16x16x32_bf16 v[100:103], a[156:159], v[140:143], v[100:103]
  ds_read_b64_tr_b16 a[162:163], v216 offset:36864
  v_cvt_pk_bf16_f32 v74, v76, v77
  v_mfma_f32_16x16x32_bf16 v[108:111], a[156:159], v[156:159], v[196:199]
  v_exp_f32 v78, v78
  v_mfma_f32_16x16x32_bf16 v[108:111], a[152:155], v[152:155], v[108:111]
  ds_read_b64_tr_b16 a[164:165], v216 offset:40960
  ds_read_b64_tr_b16 a[250:251], v225 offset:2112
  v_mfma_f32_16x16x32_bf16 v[108:111], a[148:151], v[148:151], v[108:111]
  v_exp_f32 v79, v79
  v_mfma_f32_16x16x32_bf16 v[108:111], a[144:147], v[144:147], v[108:111]
  ds_read_b64_tr_b16 a[166:167], v216 offset:45056
  v_cvt_pk_bf16_f32 v75, v78, v79
  v_mfma_f32_16x16x32_bf16 v[116:119], a[144:147], v[160:163], v[200:203]
  v_exp_f32 v84, v84
  v_mfma_f32_16x16x32_bf16 v[116:119], a[148:151], v[164:167], v[116:119]
  ds_read_b64_tr_b16 a[168:169], v217 offset:32768
  v_mfma_f32_16x16x32_bf16 v[116:119], a[152:155], v[168:171], v[116:119]
  v_exp_f32 v85, v85
  v_mfma_f32_16x16x32_bf16 v[116:119], a[156:159], v[172:175], v[116:119]
  ds_read_b64_tr_b16 a[170:171], v217 offset:36864
  v_cvt_pk_bf16_f32 v82, v84, v85
  v_mfma_f32_16x16x32_bf16 v[124:127], a[156:159], v[188:191], v[204:207]
  v_exp_f32 v86, v86
  v_mfma_f32_16x16x32_bf16 v[124:127], a[152:155], v[184:187], v[124:127]
  ds_read_b64_tr_b16 a[172:173], v217 offset:40960
  s_waitcnt lgkmcnt(4)
  v_mfma_f32_16x16x32_bf16 v[228:231], a[232:235], a[212:215], 0
  v_mfma_f32_16x16x32_bf16 v[228:231], a[236:239], a[216:219], v[228:231]
  v_mfma_f32_16x16x32_bf16 v[228:231], a[240:243], a[220:223], v[228:231]
  v_mfma_f32_16x16x32_bf16 v[228:231], a[244:247], a[224:227], v[228:231]
  v_mfma_f32_16x16x32_bf16 v[228:231], a[248:251], a[228:231], v[228:231]
  v_mfma_f32_16x16x32_bf16 v[124:127], a[148:151], v[180:183], v[124:127]
  s_lshl_b32 s35, s3, 10
  s_add_u32 s35, s35, 159744
  v_exp_f32 v87, v87
  v_mfma_f32_16x16x32_bf16 v[124:127], a[144:147], v[176:179], v[124:127]
  ds_read_b64_tr_b16 a[174:175], v217 offset:45056
  v_cvt_pk_bf16_f32 v83, v86, v87
  v_mfma_f32_16x16x32_bf16 a[192:195], a[208:211], v[0:3], a[192:195]
  v_exp_f32 v92, v92
  v_mfma_f32_16x16x32_bf16 a[192:195], a[208:211], v[32:35], a[192:195]
  ds_read_b64_tr_b16 a[176:177], v218 offset:32768
  v_add_u32 v224, s35, v242
  v_mfma_f32_16x16x32_bf16 a[196:199], a[208:211], v[8:11], a[196:199]
  v_exp_f32 v93, v93
  v_mfma_f32_16x16x32_bf16 a[196:199], a[208:211], v[40:43], a[196:199]
  ds_read_b64_tr_b16 a[178:179], v218 offset:36864
  v_cvt_pk_bf16_f32 v90, v92, v93
  v_mfma_f32_16x16x32_bf16 a[200:203], a[208:211], v[16:19], a[200:203]
  v_exp_f32 v94, v94
  v_mfma_f32_16x16x32_bf16 a[200:203], a[208:211], v[48:51], a[200:203]
  ds_read_b64_tr_b16 a[180:181], v218 offset:40960
  ds_write_b128 v224, v[228:231]
  v_mfma_f32_16x16x32_bf16 a[204:207], a[208:211], v[24:27], a[204:207]
  s_waitcnt lgkmcnt(8)
  v_exp_f32 v95, v95
  v_mfma_f32_16x16x32_bf16 a[204:207], a[208:211], v[56:59], a[204:207]
  ds_read_b64_tr_b16 a[182:183], v218 offset:45056
  v_cvt_pk_bf16_f32 v91, v94, v95
  v_mfma_f32_16x16x32_bf16 a[0:3], a[160:163], v[0:3], a[0:3]
  v_exp_f32 v96, v96
  v_mfma_f32_16x16x32_bf16 a[0:3], a[164:167], v[32:35], a[0:3]
  ds_read_b64_tr_b16 a[184:185], v219 offset:32768
  v_mfma_f32_16x16x32_bf16 a[4:7], a[164:167], v[40:43], a[4:7]
  v_exp_f32 v97, v97
  v_mfma_f32_16x16x32_bf16 a[4:7], a[160:163], v[8:11], a[4:7]
  ds_read_b64_tr_b16 a[186:187], v219 offset:36864
  v_cvt_pk_bf16_f32 v96, v96, v97
  v_mfma_f32_16x16x32_bf16 a[8:11], a[160:163], v[16:19], a[8:11]
  v_exp_f32 v98, v98
  v_mfma_f32_16x16x32_bf16 a[8:11], a[164:167], v[48:51], a[8:11]
  ds_read_b64_tr_b16 a[188:189], v219 offset:40960
  s_waitcnt lgkmcnt(4)
  v_lshrrev_b32 v224, 4, v242
  v_mfma_f32_16x16x32_bf16 a[12:15], a[164:167], v[56:59], a[12:15]
  v_exp_f32 v99, v99
  v_mfma_f32_16x16x32_bf16 a[12:15], a[160:163], v[24:27], a[12:15]
  ds_read_b64_tr_b16 a[190:191], v219 offset:45056
  v_cvt_pk_bf16_f32 v97, v98, v99
  v_mfma_f32_16x16x32_bf16 a[16:19], a[168:171], v[0:3], a[16:19]
  v_exp_f32 v104, v104
  v_mfma_f32_16x16x32_bf16 a[16:19], a[172:175], v[32:35], a[16:19]
  ds_read_b64_tr_b16 a[160:161], v220 offset:32768
  v_bfe_u32 v225, v224, 2, 1
  v_mfma_f32_16x16x32_bf16 a[20:23], a[172:175], v[40:43], a[20:23]
  v_exp_f32 v105, v105
  v_mfma_f32_16x16x32_bf16 a[20:23], a[168:171], v[8:11], a[20:23]
  ds_read_b64_tr_b16 a[162:163], v220 offset:36864
  v_cvt_pk_bf16_f32 v104, v104, v105
  v_mfma_f32_16x16x32_bf16 a[24:27], a[168:171], v[16:19], a[24:27]
  v_exp_f32 v106, v106
  v_mfma_f32_16x16x32_bf16 a[24:27], a[172:175], v[48:51], a[24:27]
  ds_read_b64_tr_b16 a[164:165], v220 offset:40960
  v_lshlrev_b32 v225, 8, v225
  v_mfma_f32_16x16x32_bf16 a[28:31], a[172:175], v[56:59], a[28:31]
  s_waitcnt lgkmcnt(7)
  v_exp_f32 v107, v107
  v_mfma_f32_16x16x32_bf16 a[28:31], a[168:171], v[24:27], a[28:31]
  ds_read_b64_tr_b16 a[166:167], v220 offset:45056
  v_cvt_pk_bf16_f32 v105, v106, v107
  v_mfma_f32_16x16x32_bf16 a[32:35], a[176:179], v[0:3], a[32:35]
  v_exp_f32 v112, v112
  v_mfma_f32_16x16x32_bf16 a[32:35], a[180:183], v[32:35], a[32:35]
  ds_read_b64_tr_b16 a[168:169], v221 offset:32768
  v_lshrrev_b32 v226, 3, v224
  v_mfma_f32_16x16x32_bf16 a[36:39], a[180:183], v[40:43], a[36:39]
  v_exp_f32 v113, v113
  v_mfma_f32_16x16x32_bf16 a[36:39], a[176:179], v[8:11], a[36:39]
  ds_read_b64_tr_b16 a[170:171], v221 offset:36864
  v_cvt_pk_bf16_f32 v112, v112, v113
  v_mfma_f32_16x16x32_bf16 a[40:43], a[176:179], v[16:19], a[40:43]
  v_exp_f32 v114, v114
  v_mfma_f32_16x16x32_bf16 a[40:43], a[180:183], v[48:51], a[40:43]
  ds_read_b64_tr_b16 a[172:173], v221 offset:40960
  v_lshl_add_u32 v225, v226, 4, v225
  v_mfma_f32_16x16x32_bf16 a[44:47], a[180:183], v[56:59], a[44:47]
  s_waitcnt lgkmcnt(7)
  v_exp_f32 v115, v115
  v_mfma_f32_16x16x32_bf16 a[44:47], a[176:179], v[24:27], a[44:47]
  ds_read_b64_tr_b16 a[174:175], v221 offset:45056
  v_cvt_pk_bf16_f32 v113, v114, v115
  v_mfma_f32_16x16x32_bf16 a[48:51], a[184:187], v[0:3], a[48:51]
  v_exp_f32 v120, v120
  v_mfma_f32_16x16x32_bf16 a[48:51], a[188:191], v[32:35], a[48:51]
  ds_read_b64_tr_b16 a[176:177], v222 offset:32768
  v_and_b32 v227, 3, v224
  v_mfma_f32_16x16x32_bf16 a[52:55], a[188:191], v[40:43], a[52:55]
  v_exp_f32 v121, v121
  v_mfma_f32_16x16x32_bf16 a[52:55], a[184:187], v[8:11], a[52:55]
  ds_read_b64_tr_b16 a[178:179], v222 offset:36864
  v_cvt_pk_bf16_f32 v120, v120, v121
  v_mfma_f32_16x16x32_bf16 a[56:59], a[184:187], v[16:19], a[56:59]
  v_exp_f32 v122, v122
  v_mfma_f32_16x16x32_bf16 a[56:59], a[188:191], v[48:51], a[56:59]
  ds_read_b64_tr_b16 a[180:181], v222 offset:40960
  v_lshl_add_u32 v225, v227, 2, v225
  v_mfma_f32_16x16x32_bf16 a[60:63], a[188:191], v[56:59], a[60:63]
  s_waitcnt lgkmcnt(7)
  v_exp_f32 v123, v123
  v_mfma_f32_16x16x32_bf16 a[60:63], a[184:187], v[24:27], a[60:63]
  ds_read_b64_tr_b16 a[182:183], v222 offset:45056
  v_cvt_pk_bf16_f32 v121, v122, v123
  v_mfma_f32_16x16x32_bf16 a[64:67], a[160:163], v[0:3], a[64:67]
  v_exp_f32 v100, v100
  v_mfma_f32_16x16x32_bf16 a[64:67], a[164:167], v[32:35], a[64:67]
  ds_read_b64_tr_b16 a[184:185], v223 offset:32768
  v_add_u32 v225, 159744, v225
  v_mfma_f32_16x16x32_bf16 a[68:71], a[164:167], v[40:43], a[68:71]
  v_exp_f32 v101, v101
  v_mfma_f32_16x16x32_bf16 a[68:71], a[160:163], v[8:11], a[68:71]
  ds_read_b64_tr_b16 a[186:187], v223 offset:36864
  v_cvt_pk_bf16_f32 v98, v100, v101
  v_mfma_f32_16x16x32_bf16 a[72:75], a[160:163], v[16:19], a[72:75]
  v_exp_f32 v102, v102
  v_mfma_f32_16x16x32_bf16 a[72:75], a[164:167], v[48:51], a[72:75]
  ds_read_b64_tr_b16 a[188:189], v223 offset:40960
  v_mfma_f32_16x16x32_bf16 a[76:79], a[164:167], v[56:59], a[76:79]
  s_waitcnt lgkmcnt(7)
  v_exp_f32 v103, v103
  v_mfma_f32_16x16x32_bf16 a[76:79], a[160:163], v[24:27], a[76:79]
  ds_read_b64_tr_b16 a[190:191], v223 offset:45056
  v_cvt_pk_bf16_f32 v99, v102, v103
  v_mfma_f32_16x16x32_bf16 a[80:83], a[168:171], v[0:3], a[80:83]
  s_waitcnt vmcnt(8)
  v_exp_f32 v108, v108
  v_mfma_f32_16x16x32_bf16 a[80:83], a[172:175], v[32:35], a[80:83]
  v_mfma_f32_16x16x32_bf16 a[84:87], a[172:175], v[40:43], a[84:87]
  s_barrier
  v_exp_f32 v109, v109
  v_mfma_f32_16x16x32_bf16 a[84:87], a[168:171], v[8:11], a[84:87]
  ds_read_b128 a[128:131], v212 offset:0
  v_cvt_pk_bf16_f32 v106, v108, v109
  v_mfma_f32_16x16x32_bf16 a[88:91], a[168:171], v[16:19], a[88:91]
  v_exp_f32 v110, v110
  v_mfma_f32_16x16x32_bf16 a[88:91], a[172:175], v[48:51], a[88:91]
  ds_read_b128 a[132:135], v213 offset:0
  ds_read_b32 v228, v225 offset:0
  v_mfma_f32_16x16x32_bf16 a[92:95], a[172:175], v[56:59], a[92:95]
  s_waitcnt lgkmcnt(7)
  v_exp_f32 v111, v111
  v_mfma_f32_16x16x32_bf16 a[92:95], a[168:171], v[24:27], a[92:95]
  ds_read_b128 a[136:139], v214 offset:0
  v_cvt_pk_bf16_f32 v107, v110, v111
  v_mfma_f32_16x16x32_bf16 a[96:99], a[176:179], v[0:3], a[96:99]
  v_exp_f32 v116, v116
  v_mfma_f32_16x16x32_bf16 a[96:99], a[180:183], v[32:35], a[96:99]
  ds_read_b128 a[140:143], v215 offset:0
  ds_read_b32 v229, v225 offset:1024
  v_mfma_f32_16x16x32_bf16 a[100:103], a[180:183], v[40:43], a[100:103]
  v_exp_f32 v117, v117
  v_mfma_f32_16x16x32_bf16 a[100:103], a[176:179], v[8:11], a[100:103]
  ds_read_b32 v230, v225 offset:2048
  v_cvt_pk_bf16_f32 v114, v116, v117
  v_mfma_f32_16x16x32_bf16 a[104:107], a[176:179], v[16:19], a[104:107]
  v_exp_f32 v118, v118
  v_mfma_f32_16x16x32_bf16 a[104:107], a[180:183], v[48:51], a[104:107]
  ds_read_b32 v231, v225 offset:3072
  ds_read_b32 v238, v225 offset:512
  v_mfma_f32_16x16x32_bf16 a[108:111], a[180:183], v[56:59], a[108:111]
  s_waitcnt lgkmcnt(9)
  v_exp_f32 v119, v119
  v_mfma_f32_16x16x32_bf16 a[108:111], a[176:179], v[24:27], a[108:111]
  ds_read_b32 v239, v225 offset:1536
  v_cvt_pk_bf16_f32 v115, v118, v119
  v_mfma_f32_16x16x32_bf16 a[112:115], a[184:187], v[0:3], a[112:115]
  v_exp_f32 v124, v124
  v_mfma_f32_16x16x32_bf16 a[112:115], a[188:191], v[32:35], a[112:115]
  ds_read_b32 v240, v225 offset:2560
  ds_read_b32 v241, v225 offset:3584
  s_cmp_eq_u32 s3, 0
  s_cselect_b32 s35, 0, 1073741824
  v_mfma_f32_16x16x32_bf16 a[116:119], a[188:191], v[40:43], a[116:119]
  v_exp_f32 v125, v125
  v_mfma_f32_16x16x32_bf16 a[116:119], a[184:187], v[8:11], a[116:119]
  v_cvt_pk_bf16_f32 v122, v124, v125
  v_mul_u32_u24 v226, 0xd80, v226
  v_mfma_f32_16x16x32_bf16 a[120:123], a[184:187], v[16:19], a[120:123]
  v_exp_f32 v126, v126
  v_mfma_f32_16x16x32_bf16 a[120:123], a[188:191], v[48:51], a[120:123]
  v_and_b32 v227, 7, v224
  v_lshl_add_u32 v226, v227, 1, v226
  v_mfma_f32_16x16x32_bf16 a[124:127], a[188:191], v[56:59], a[124:127]
  s_waitcnt lgkmcnt(7)
  v_exp_f32 v127, v127
  v_mfma_f32_16x16x32_bf16 a[124:127], a[184:187], v[24:27], a[124:127]
  v_cvt_pk_bf16_f32 v123, v126, v127
  v_and_b32 v227, 1, v224
  v_lshl_add_u32 v226, v227, 30, v226
  v_or_b32 v226, s35, v226
  v_min_u32 v249, 1, v224
  v_lshlrev_b32 v249, 30, v249
  v_or_b32 v249, s35, v249
  v_mov_b32 v251, v249
  v_mov_b32 v250, 1
  s_mov_b32 s47, 2818048
  s_lshl_b32 s35, s33, 4
  s_add_u32 s35, s35, 2633728
  s_waitcnt lgkmcnt(0)
  v_add_f32 v228, v228, v229
  v_add_f32 v238, v238, v239
  v_add_f32 v230, v230, v231
  v_add_f32 v240, v240, v241
  v_add_f32 v228, v228, v230
  v_add_f32 v238, v238, v240
  v_cvt_pk_bf16_f32 v228, v228, v228
  v_cvt_pk_bf16_f32 v238, v238, v238
  v_lshlrev_b32 v228, 16, v228
  v_lshlrev_b32 v238, 16, v238
  v_mul_f32 v229, 0xbfb8aa3b, v228
  v_exp_f32 v229, v229
  s_nop 0
  v_add_f32 v229, 1.0, v229
  v_rcp_f32 v229, v229
  s_nop 0
  v_mul_f32 v228, v228, v229
  v_cvt_pk_bf16_f32 v228, v228, v228
  v_lshlrev_b32 v228, 16, v228
  v_mul_f32 v228, v228, v238
  s_nop 1
  v_mov_b32_dpp v229, v228 quad_perm:[1,0,3,2] row_mask:0xf bank_mask:0xf
  v_cvt_pk_bf16_f32 v228, v228, v229
  buffer_store_dword v228, v226, s[24:27], s35 offen sc1
  s_mov_b32 s32, 6
attn_loop:
  v_mfma_f32_16x16x32_bf16 v[0:3], a[128:131], v[128:131], v[192:195]
  s_add_u32 m0, s28, 81920
  v_mfma_f32_16x16x32_bf16 v[0:3], a[132:135], v[132:135], v[0:3]
  ds_read_b128 a[144:147], v212 offset:4096
  v_mfma_f32_16x16x32_bf16 v[0:3], a[136:139], v[136:139], v[0:3]
  buffer_load_dwordx4 v236, s[16:19], s29 offen offset:0 lds
  v_mfma_f32_16x16x32_bf16 v[0:3], a[140:143], v[140:143], v[0:3]
  ds_read_b128 a[148:151], v213 offset:4096
  v_mfma_f32_16x16x32_bf16 v[8:11], a[140:143], v[156:159], v[196:199]
  buffer_load_dwordx4 v237, s[16:19], s29 offen offset:1024 lds
  v_mfma_f32_16x16x32_bf16 v[8:11], a[136:139], v[152:155], v[8:11]
  ds_read_b128 a[152:155], v214 offset:4096
  v_mfma_f32_16x16x32_bf16 v[8:11], a[132:135], v[148:151], v[8:11]
  buffer_load_dwordx4 v236, s[16:19], s29 offen offset:2048 lds
  v_mfma_f32_16x16x32_bf16 v[8:11], a[128:131], v[144:147], v[8:11]
  ds_read_b128 a[156:159], v215 offset:4096
  v_mfma_f32_16x16x32_bf16 v[16:19], a[128:131], v[160:163], v[200:203]
  v_exp_f32 v0, v0
  v_mfma_f32_16x16x32_bf16 v[16:19], a[132:135], v[164:167], v[16:19]
  buffer_load_dwordx4 v237, s[16:19], s29 offen offset:3072 lds
  v_mfma_f32_16x16x32_bf16 v[16:19], a[136:139], v[168:171], v[16:19]
  s_add_u32 s29, s29, 16384
  v_exp_f32 v1, v1
  v_mfma_f32_16x16x32_bf16 v[16:19], a[140:143], v[172:175], v[16:19]
  v_cvt_pk_bf16_f32 v0, v0, v1
  v_mfma_f32_16x16x32_bf16 v[24:27], a[140:143], v[188:191], v[204:207]
  s_add_u32 m0, s28, 32768
  v_exp_f32 v2, v2
  v_mfma_f32_16x16x32_bf16 v[24:27], a[136:139], v[184:187], v[24:27]
  buffer_load_dwordx4 v232, s[12:15], s29 offen offset:0 lds
  v_mfma_f32_16x16x32_bf16 v[24:27], a[132:135], v[180:183], v[24:27]
  s_waitcnt lgkmcnt(0)
  v_exp_f32 v3, v3
  v_mfma_f32_16x16x32_bf16 v[24:27], a[128:131], v[176:179], v[24:27]
  v_cvt_pk_bf16_f32 v1, v2, v3
  v_mfma_f32_16x16x32_bf16 v[4:7], a[144:147], v[128:131], v[192:195]
  v_exp_f32 v8, v8
  v_mfma_f32_16x16x32_bf16 v[4:7], a[148:151], v[132:135], v[4:7]
  ds_read_b128 a[128:131], v212 offset:8192
  v_mfma_f32_16x16x32_bf16 v[4:7], a[152:155], v[136:139], v[4:7]
  v_exp_f32 v9, v9
  v_mfma_f32_16x16x32_bf16 v[4:7], a[156:159], v[140:143], v[4:7]
  ds_read_b128 a[132:135], v213 offset:8192
  v_cvt_pk_bf16_f32 v8, v8, v9
  v_mfma_f32_16x16x32_bf16 v[12:15], a[156:159], v[156:159], v[196:199]
  v_exp_f32 v10, v10
  v_mfma_f32_16x16x32_bf16 v[12:15], a[152:155], v[152:155], v[12:15]
  ds_read_b128 a[136:139], v214 offset:8192
  v_mfma_f32_16x16x32_bf16 v[12:15], a[148:151], v[148:151], v[12:15]
  v_exp_f32 v11, v11
  v_mfma_f32_16x16x32_bf16 v[12:15], a[144:147], v[144:147], v[12:15]
  ds_read_b128 a[140:143], v215 offset:8192
  v_cvt_pk_bf16_f32 v9, v10, v11
  v_mfma_f32_16x16x32_bf16 v[20:23], a[144:147], v[160:163], v[200:203]
  v_exp_f32 v16, v16
  v_mfma_f32_16x16x32_bf16 v[20:23], a[148:151], v[164:167], v[20:23]
  buffer_load_dwordx4 v233, s[12:15], s29 offen offset:1024 lds
  v_mfma_f32_16x16x32_bf16 v[20:23], a[152:155], v[168:171], v[20:23]
  v_exp_f32 v17, v17
  v_mfma_f32_16x16x32_bf16 v[20:23], a[156:159], v[172:175], v[20:23]
  v_cvt_pk_bf16_f32 v16, v16, v17
  v_mfma_f32_16x16x32_bf16 v[28:31], a[156:159], v[188:191], v[204:207]
  v_exp_f32 v18, v18
  v_mfma_f32_16x16x32_bf16 v[28:31], a[152:155], v[184:187], v[28:31]
  buffer_load_dwordx4 v234, s[12:15], s29 offen offset:2048 lds
  v_mfma_f32_16x16x32_bf16 v[28:31], a[148:151], v[180:183], v[28:31]
  s_waitcnt lgkmcnt(0)
  v_exp_f32 v19, v19
  v_mfma_f32_16x16x32_bf16 v[28:31], a[144:147], v[176:179], v[28:31]
  v_cvt_pk_bf16_f32 v17, v18, v19
  v_mfma_f32_16x16x32_bf16 v[32:35], a[128:131], v[128:131], v[192:195]
  v_exp_f32 v24, v24
  v_mfma_f32_16x16x32_bf16 v[32:35], a[132:135], v[132:135], v[32:35]
  ds_read_b128 a[144:147], v212 offset:12288
  v_mfma_f32_16x16x32_bf16 v[32:35], a[136:139], v[136:139], v[32:35]
  v_exp_f32 v25, v25
  v_mfma_f32_16x16x32_bf16 v[32:35], a[140:143], v[140:143], v[32:35]
  ds_read_b128 a[148:151], v213 offset:12288
  v_cvt_pk_bf16_f32 v24, v24, v25
  v_mfma_f32_16x16x32_bf16 v[40:43], a[140:143], v[156:159], v[196:199]
  v_exp_f32 v26, v26
  v_mfma_f32_16x16x32_bf16 v[40:43], a[136:139], v[152:155], v[40:43]
  ds_read_b128 a[152:155], v214 offset:12288
  v_mfma_f32_16x16x32_bf16 v[40:43], a[132:135], v[148:151], v[40:43]
  v_exp_f32 v27, v27
  v_mfma_f32_16x16x32_bf16 v[40:43], a[128:131], v[144:147], v[40:43]
  ds_read_b128 a[156:159], v215 offset:12288
  v_cvt_pk_bf16_f32 v25, v26, v27
  v_mfma_f32_16x16x32_bf16 v[48:51], a[128:131], v[160:163], v[200:203]
  v_exp_f32 v4, v4
  v_mfma_f32_16x16x32_bf16 v[48:51], a[132:135], v[164:167], v[48:51]
  buffer_load_dwordx4 v235, s[12:15], s29 offen offset:3072 lds
  v_mfma_f32_16x16x32_bf16 v[48:51], a[136:139], v[168:171], v[48:51]
  v_exp_f32 v5, v5
  v_mfma_f32_16x16x32_bf16 v[48:51], a[140:143], v[172:175], v[48:51]
  v_cvt_pk_bf16_f32 v2, v4, v5
  v_mfma_f32_16x16x32_bf16 v[56:59], a[140:143], v[188:191], v[204:207]
  s_add_u32 m0, s50, 4096
  v_exp_f32 v6, v6
  v_mfma_f32_16x16x32_bf16 v[56:59], a[136:139], v[184:187], v[56:59]
  buffer_load_dwordx4 v208, s[20:23], s30 offen lds
  s_add_u32 s30, s30, 32
  v_mfma_f32_16x16x32_bf16 v[56:59], a[132:135], v[180:183], v[56:59]
  s_waitcnt lgkmcnt(0)
  v_exp_f32 v7, v7
  v_mfma_f32_16x16x32_bf16 v[56:59], a[128:131], v[176:179], v[56:59]
  v_cvt_pk_bf16_f32 v3, v6, v7
  v_mfma_f32_16x16x32_bf16 v[36:39], a[144:147], v[128:131], v[192:195]
  v_exp_f32 v12, v12
  v_mfma_f32_16x16x32_bf16 v[36:39], a[148:151], v[132:135], v[36:39]
  ds_read_b64_tr_b16 a[160:161], v216 offset:49152
  v_mfma_f32_16x16x32_bf16 v[36:39], a[152:155], v[136:139], v[36:39]
  v_exp_f32 v13, v13
  v_mfma_f32_16x16x32_bf16 v[36:39], a[156:159], v[140:143], v[36:39]
  ds_read_b64_tr_b16 a[162:163], v216 offset:53248
  v_cvt_pk_bf16_f32 v10, v12, v13
  v_mfma_f32_16x16x32_bf16 v[44:47], a[156:159], v[156:159], v[196:199]
  v_exp_f32 v14, v14
  v_mfma_f32_16x16x32_bf16 v[44:47], a[152:155], v[152:155], v[44:47]
  ds_read_b64_tr_b16 a[164:165], v216 offset:57344
  v_mfma_f32_16x16x32_bf16 v[44:47], a[148:151], v[148:151], v[44:47]
  v_exp_f32 v15, v15
  v_mfma_f32_16x16x32_bf16 v[44:47], a[144:147], v[144:147], v[44:47]
  ds_read_b64_tr_b16 a[166:167], v216 offset:61440
  v_cvt_pk_bf16_f32 v11, v14, v15
  v_mfma_f32_16x16x32_bf16 v[52:55], a[144:147], v[160:163], v[200:203]
  v_exp_f32 v20, v20
  v_mfma_f32_16x16x32_bf16 v[52:55], a[148:151], v[164:167], v[52:55]
  ds_read_b64_tr_b16 a[168:169], v217 offset:49152
  v_mfma_f32_16x16x32_bf16 v[52:55], a[152:155], v[168:171], v[52:55]
  v_exp_f32 v21, v21
  v_mfma_f32_16x16x32_bf16 v[52:55], a[156:159], v[172:175], v[52:55]
  ds_read_b64_tr_b16 a[170:171], v217 offset:53248
  v_cvt_pk_bf16_f32 v18, v20, v21
  v_mfma_f32_16x16x32_bf16 v[60:63], a[156:159], v[188:191], v[204:207]
  v_exp_f32 v22, v22
  v_mfma_f32_16x16x32_bf16 v[60:63], a[152:155], v[184:187], v[60:63]
  ds_read_b64_tr_b16 a[172:173], v217 offset:57344
  v_mfma_f32_16x16x32_bf16 v[60:63], a[148:151], v[180:183], v[60:63]
  v_exp_f32 v23, v23
  v_mfma_f32_16x16x32_bf16 v[60:63], a[144:147], v[176:179], v[60:63]
  ds_read_b64_tr_b16 a[174:175], v217 offset:61440
  v_cvt_pk_bf16_f32 v19, v22, v23
  v_mfma_f32_16x16x32_bf16 a[192:195], a[208:211], v[64:67], a[192:195]
  v_exp_f32 v28, v28
  v_mfma_f32_16x16x32_bf16 a[192:195], a[208:211], v[96:99], a[192:195]
  ds_read_b64_tr_b16 a[176:177], v218 offset:49152
  v_mfma_f32_16x16x32_bf16 a[196:199], a[208:211], v[72:75], a[196:199]
  v_exp_f32 v29, v29
  v_mfma_f32_16x16x32_bf16 a[196:199], a[208:211], v[104:107], a[196:199]
  ds_read_b64_tr_b16 a[178:179], v218 offset:53248
  v_cvt_pk_bf16_f32 v26, v28, v29
  v_mfma_f32_16x16x32_bf16 a[200:203], a[208:211], v[80:83], a[200:203]
  v_exp_f32 v30, v30
  v_mfma_f32_16x16x32_bf16 a[200:203], a[208:211], v[112:115], a[200:203]
  ds_read_b64_tr_b16 a[180:181], v218 offset:57344
  v_mfma_f32_16x16x32_bf16 a[204:207], a[208:211], v[88:91], a[204:207]
  s_waitcnt lgkmcnt(7)
  v_exp_f32 v31, v31
  v_mfma_f32_16x16x32_bf16 a[204:207], a[208:211], v[120:123], a[204:207]
  ds_read_b64_tr_b16 a[182:183], v218 offset:61440
  v_cvt_pk_bf16_f32 v27, v30, v31
  v_mfma_f32_16x16x32_bf16 a[0:3], a[160:163], v[64:67], a[0:3]
  v_exp_f32 v32, v32
  v_mfma_f32_16x16x32_bf16 a[0:3], a[164:167], v[96:99], a[0:3]
  ds_read_b64_tr_b16 a[184:185], v219 offset:49152
  v_mfma_f32_16x16x32_bf16 a[4:7], a[164:167], v[104:107], a[4:7]
  v_exp_f32 v33, v33
  v_mfma_f32_16x16x32_bf16 a[4:7], a[160:163], v[72:75], a[4:7]
  ds_read_b64_tr_b16 a[186:187], v219 offset:53248
  v_cvt_pk_bf16_f32 v32, v32, v33
  v_mfma_f32_16x16x32_bf16 a[8:11], a[160:163], v[80:83], a[8:11]
  v_exp_f32 v34, v34
  v_mfma_f32_16x16x32_bf16 a[8:11], a[164:167], v[112:115], a[8:11]
  ds_read_b64_tr_b16 a[188:189], v219 offset:57344
  v_mfma_f32_16x16x32_bf16 a[12:15], a[164:167], v[120:123], a[12:15]
  s_waitcnt lgkmcnt(7)
  v_exp_f32 v35, v35
  v_mfma_f32_16x16x32_bf16 a[12:15], a[160:163], v[88:91], a[12:15]
  ds_read_b64_tr_b16 a[190:191], v219 offset:61440
  v_cvt_pk_bf16_f32 v33, v34, v35
  v_mfma_f32_16x16x32_bf16 a[16:19], a[168:171], v[64:67], a[16:19]
  v_exp_f32 v40, v40
  v_mfma_f32_16x16x32_bf16 a[16:19], a[172:175], v[96:99], a[16:19]
  ds_read_b64_tr_b16 a[160:161], v220 offset:49152
  v_mfma_f32_16x16x32_bf16 a[20:23], a[172:175], v[104:107], a[20:23]
  v_exp_f32 v41, v41
  v_mfma_f32_16x16x32_bf16 a[20:23], a[168:171], v[72:75], a[20:23]
  ds_read_b64_tr_b16 a[162:163], v220 offset:53248
  v_cvt_pk_bf16_f32 v40, v40, v41
  v_mfma_f32_16x16x32_bf16 a[24:27], a[168:171], v[80:83], a[24:27]
  v_exp_f32 v42, v42
  v_mfma_f32_16x16x32_bf16 a[24:27], a[172:175], v[112:115], a[24:27]
  ds_read_b64_tr_b16 a[164:165], v220 offset:57344
  v_mfma_f32_16x16x32_bf16 a[28:31], a[172:175], v[120:123], a[28:31]
  s_waitcnt lgkmcnt(7)
  v_exp_f32 v43, v43
  v_mfma_f32_16x16x32_bf16 a[28:31], a[168:171], v[88:91], a[28:31]
  ds_read_b64_tr_b16 a[166:167], v220 offset:61440
  v_cvt_pk_bf16_f32 v41, v42, v43
  v_mfma_f32_16x16x32_bf16 a[32:35], a[176:179], v[64:67], a[32:35]
  v_exp_f32 v48, v48
  v_mfma_f32_16x16x32_bf16 a[32:35], a[180:183], v[96:99], a[32:35]
  ds_read_b64_tr_b16 a[168:169], v221 offset:49152
  v_mfma_f32_16x16x32_bf16 a[36:39], a[180:183], v[104:107], a[36:39]
  v_exp_f32 v49, v49
  v_mfma_f32_16x16x32_bf16 a[36:39], a[176:179], v[72:75], a[36:39]
  ds_read_b64_tr_b16 a[170:171], v221 offset:53248
  v_cvt_pk_bf16_f32 v48, v48, v49
  v_mfma_f32_16x16x32_bf16 a[40:43], a[176:179], v[80:83], a[40:43]
  v_exp_f32 v50, v50
  v_mfma_f32_16x16x32_bf16 a[40:43], a[180:183], v[112:115], a[40:43]
  ds_read_b64_tr_b16 a[172:173], v221 offset:57344
  v_mfma_f32_16x16x32_bf16 a[44:47], a[180:183], v[120:123], a[44:47]
  s_waitcnt lgkmcnt(7)
  v_exp_f32 v51, v51
  v_mfma_f32_16x16x32_bf16 a[44:47], a[176:179], v[88:91], a[44:47]
  ds_read_b64_tr_b16 a[174:175], v221 offset:61440
  v_cvt_pk_bf16_f32 v49, v50, v51
  v_mfma_f32_16x16x32_bf16 a[48:51], a[184:187], v[64:67], a[48:51]
  v_exp_f32 v56, v56
  v_mfma_f32_16x16x32_bf16 a[48:51], a[188:191], v[96:99], a[48:51]
  ds_read_b64_tr_b16 a[176:177], v222 offset:49152
  v_mfma_f32_16x16x32_bf16 a[52:55], a[188:191], v[104:107], a[52:55]
  v_exp_f32 v57, v57
  v_mfma_f32_16x16x32_bf16 a[52:55], a[184:187], v[72:75], a[52:55]
  ds_read_b64_tr_b16 a[178:179], v222 offset:53248
  v_cvt_pk_bf16_f32 v56, v56, v57
  v_mfma_f32_16x16x32_bf16 a[56:59], a[184:187], v[80:83], a[56:59]
  v_exp_f32 v58, v58
  v_mfma_f32_16x16x32_bf16 a[56:59], a[188:191], v[112:115], a[56:59]
  ds_read_b64_tr_b16 a[180:181], v222 offset:57344
  v_mfma_f32_16x16x32_bf16 a[60:63], a[188:191], v[120:123], a[60:63]
  s_waitcnt lgkmcnt(7)
  v_exp_f32 v59, v59
  v_mfma_f32_16x16x32_bf16 a[60:63], a[184:187], v[88:91], a[60:63]
  ds_read_b64_tr_b16 a[182:183], v222 offset:61440
  v_cvt_pk_bf16_f32 v57, v58, v59
  v_mfma_f32_16x16x32_bf16 a[64:67], a[160:163], v[64:67], a[64:67]
  v_exp_f32 v36, v36
  v_mfma_f32_16x16x32_bf16 a[64:67], a[164:167], v[96:99], a[64:67]
  ds_read_b64_tr_b16 a[184:185], v223 offset:49152
  v_mfma_f32_16x16x32_bf16 a[68:71], a[164:167], v[104:107], a[68:71]
  v_exp_f32 v37, v37
  v_mfma_f32_16x16x32_bf16 a[68:71], a[160:163], v[72:75], a[68:71]
  ds_read_b64_tr_b16 a[186:187], v223 offset:53248
  v_cvt_pk_bf16_f32 v34, v36, v37
  v_mfma_f32_16x16x32_bf16 a[72:75], a[160:163], v[80:83], a[72:75]
  v_exp_f32 v38, v38
  v_mfma_f32_16x16x32_bf16 a[72:75], a[164:167], v[112:115], a[72:75]
  ds_read_b64_tr_b16 a[188:189], v223 offset:57344
  v_mfma_f32_16x16x32_bf16 a[76:79], a[164:167], v[120:123], a[76:79]
  s_waitcnt lgkmcnt(7)
  v_exp_f32 v39, v39
  v_mfma_f32_16x16x32_bf16 a[76:79], a[160:163], v[88:91], a[76:79]
  ds_read_b64_tr_b16 a[190:191], v223 offset:61440
  v_cvt_pk_bf16_f32 v35, v38, v39
  v_mfma_f32_16x16x32_bf16 a[80:83], a[168:171], v[64:67], a[80:83]
  s_waitcnt vmcnt(10)
  v_exp_f32 v44, v44
  v_mfma_f32_16x16x32_bf16 a[80:83], a[172:175], v[96:99], a[80:83]
  v_mfma_f32_16x16x32_bf16 a[84:87], a[172:175], v[104:107], a[84:87]
  s_barrier
  v_exp_f32 v45, v45
  v_mfma_f32_16x16x32_bf16 a[84:87], a[168:171], v[72:75], a[84:87]
  ds_read_b128 a[128:131], v212 offset:16384
  v_cvt_pk_bf16_f32 v42, v44, v45
  v_mfma_f32_16x16x32_bf16 a[88:91], a[168:171], v[80:83], a[88:91]
  v_exp_f32 v46, v46
  v_mfma_f32_16x16x32_bf16 a[88:91], a[172:175], v[112:115], a[88:91]
  ds_read_b128 a[132:135], v213 offset:16384
  v_mfma_f32_16x16x32_bf16 a[92:95], a[172:175], v[120:123], a[92:95]
  s_waitcnt lgkmcnt(6)
  v_exp_f32 v47, v47
  v_mfma_f32_16x16x32_bf16 a[92:95], a[168:171], v[88:91], a[92:95]
  ds_read_b128 a[136:139], v214 offset:16384
  v_cvt_pk_bf16_f32 v43, v46, v47
  v_mfma_f32_16x16x32_bf16 a[96:99], a[176:179], v[64:67], a[96:99]
  v_exp_f32 v52, v52
  v_mfma_f32_16x16x32_bf16 a[96:99], a[180:183], v[96:99], a[96:99]
  ds_read_b128 a[140:143], v215 offset:16384
  v_mfma_f32_16x16x32_bf16 a[100:103], a[180:183], v[104:107], a[100:103]
  v_exp_f32 v53, v53
  v_mfma_f32_16x16x32_bf16 a[100:103], a[176:179], v[72:75], a[100:103]
  v_cvt_pk_bf16_f32 v50, v52, v53
  v_mfma_f32_16x16x32_bf16 a[104:107], a[176:179], v[80:83], a[104:107]
  v_exp_f32 v54, v54
  v_mfma_f32_16x16x32_bf16 a[104:107], a[180:183], v[112:115], a[104:107]
  v_mfma_f32_16x16x32_bf16 a[108:111], a[180:183], v[120:123], a[108:111]
  s_waitcnt lgkmcnt(4)
  v_exp_f32 v55, v55
  v_mfma_f32_16x16x32_bf16 a[108:111], a[176:179], v[88:91], a[108:111]
  v_cvt_pk_bf16_f32 v51, v54, v55
  v_mfma_f32_16x16x32_bf16 a[112:115], a[184:187], v[64:67], a[112:115]
  v_exp_f32 v60, v60
  v_mfma_f32_16x16x32_bf16 a[112:115], a[188:191], v[96:99], a[112:115]
  v_mfma_f32_16x16x32_bf16 a[116:119], a[188:191], v[104:107], a[116:119]
  v_exp_f32 v61, v61
  v_mfma_f32_16x16x32_bf16 a[116:119], a[184:187], v[72:75], a[116:119]
  v_cvt_pk_bf16_f32 v58, v60, v61
  v_mfma_f32_16x16x32_bf16 a[120:123], a[184:187], v[80:83], a[120:123]
  v_exp_f32 v62, v62
  v_mfma_f32_16x16x32_bf16 a[120:123], a[188:191], v[112:115], a[120:123]
  v_mfma_f32_16x16x32_bf16 a[124:127], a[188:191], v[120:123], a[124:127]
  s_waitcnt lgkmcnt(0)
  v_exp_f32 v63, v63
  v_mfma_f32_16x16x32_bf16 a[124:127], a[184:187], v[88:91], a[124:127]
  v_cvt_pk_bf16_f32 v59, v62, v63
  v_mfma_f32_16x16x32_bf16 v[64:67], a[128:131], v[128:131], v[192:195]
  s_add_u32 m0, s28, 98304
  v_mfma_f32_16x16x32_bf16 v[64:67], a[132:135], v[132:135], v[64:67]
  ds_read_b128 a[144:147], v212 offset:20480
  v_mfma_f32_16x16x32_bf16 v[64:67], a[136:139], v[136:139], v[64:67]
  buffer_load_dwordx4 v236, s[16:19], s29 offen offset:0 lds
  v_mfma_f32_16x16x32_bf16 v[64:67], a[140:143], v[140:143], v[64:67]
  ds_read_b128 a[148:151], v213 offset:20480
  v_mfma_f32_16x16x32_bf16 v[72:75], a[140:143], v[156:159], v[196:199]
  buffer_load_dwordx4 v237, s[16:19], s29 offen offset:1024 lds
  v_mfma_f32_16x16x32_bf16 v[72:75], a[136:139], v[152:155], v[72:75]
  ds_read_b128 a[152:155], v214 offset:20480
  v_mfma_f32_16x16x32_bf16 v[72:75], a[132:135], v[148:151], v[72:75]
  buffer_load_dwordx4 v236, s[16:19], s29 offen offset:2048 lds
  v_mfma_f32_16x16x32_bf16 v[72:75], a[128:131], v[144:147], v[72:75]
  ds_read_b128 a[156:159], v215 offset:20480
  v_mfma_f32_16x16x32_bf16 v[80:83], a[128:131], v[160:163], v[200:203]
  v_exp_f32 v64, v64
  v_mfma_f32_16x16x32_bf16 v[80:83], a[132:135], v[164:167], v[80:83]
  buffer_load_dwordx4 v237, s[16:19], s29 offen offset:3072 lds
  v_mfma_f32_16x16x32_bf16 v[80:83], a[136:139], v[168:171], v[80:83]
  s_add_u32 s29, s29, 16384
  v_exp_f32 v65, v65
  v_mfma_f32_16x16x32_bf16 v[80:83], a[140:143], v[172:175], v[80:83]
  v_cvt_pk_bf16_f32 v64, v64, v65
  v_mfma_f32_16x16x32_bf16 v[88:91], a[140:143], v[188:191], v[204:207]
  s_add_u32 m0, s28, 49152
  v_exp_f32 v66, v66
  v_mfma_f32_16x16x32_bf16 v[88:91], a[136:139], v[184:187], v[88:91]
  buffer_load_dwordx4 v232, s[12:15], s29 offen offset:0 lds
  v_mfma_f32_16x16x32_bf16 v[88:91], a[132:135], v[180:183], v[88:91]
  s_waitcnt lgkmcnt(0)
  v_exp_f32 v67, v67
  v_mfma_f32_16x16x32_bf16 v[88:91], a[128:131], v[176:179], v[88:91]
  v_cvt_pk_bf16_f32 v65, v66, v67
  v_mfma_f32_16x16x32_bf16 v[68:71], a[144:147], v[128:131], v[192:195]
  v_exp_f32 v72, v72
  v_mfma_f32_16x16x32_bf16 v[68:71], a[148:151], v[132:135], v[68:71]
  ds_read_b128 a[128:131], v212 offset:24576
  v_mfma_f32_16x16x32_bf16 v[68:71], a[152:155], v[136:139], v[68:71]
  v_exp_f32 v73, v73
  v_mfma_f32_16x16x32_bf16 v[68:71], a[156:159], v[140:143], v[68:71]
  ds_read_b128 a[132:135], v213 offset:24576
  v_cvt_pk_bf16_f32 v72, v72, v73
  v_mfma_f32_16x16x32_bf16 v[76:79], a[156:159], v[156:159], v[196:199]
  v_exp_f32 v74, v74
  v_mfma_f32_16x16x32_bf16 v[76:79], a[152:155], v[152:155], v[76:79]
  ds_read_b128 a[136:139], v214 offset:24576
  v_mfma_f32_16x16x32_bf16 v[76:79], a[148:151], v[148:151], v[76:79]
  v_exp_f32 v75, v75
  v_mfma_f32_16x16x32_bf16 v[76:79], a[144:147], v[144:147], v[76:79]
  ds_read_b128 a[140:143], v215 offset:24576
  v_cvt_pk_bf16_f32 v73, v74, v75
  v_mfma_f32_16x16x32_bf16 v[84:87], a[144:147], v[160:163], v[200:203]
  v_exp_f32 v80, v80
  v_mfma_f32_16x16x32_bf16 v[84:87], a[148:151], v[164:167], v[84:87]
  buffer_load_dwordx4 v233, s[12:15], s29 offen offset:1024 lds
  v_mfma_f32_16x16x32_bf16 v[84:87], a[152:155], v[168:171], v[84:87]
  v_exp_f32 v81, v81
  v_mfma_f32_16x16x32_bf16 v[84:87], a[156:159], v[172:175], v[84:87]
  v_cvt_pk_bf16_f32 v80, v80, v81
  v_mfma_f32_16x16x32_bf16 v[92:95], a[156:159], v[188:191], v[204:207]
  v_exp_f32 v82, v82
  v_mfma_f32_16x16x32_bf16 v[92:95], a[152:155], v[184:187], v[92:95]
  buffer_load_dwordx4 v234, s[12:15], s29 offen offset:2048 lds
  v_mfma_f32_16x16x32_bf16 v[92:95], a[148:151], v[180:183], v[92:95]
  s_waitcnt lgkmcnt(0)
  v_exp_f32 v83, v83
  v_mfma_f32_16x16x32_bf16 v[92:95], a[144:147], v[176:179], v[92:95]
  v_cvt_pk_bf16_f32 v81, v82, v83
  v_mfma_f32_16x16x32_bf16 v[96:99], a[128:131], v[128:131], v[192:195]
  v_exp_f32 v88, v88
  v_mfma_f32_16x16x32_bf16 v[96:99], a[132:135], v[132:135], v[96:99]
  ds_read_b128 a[144:147], v212 offset:28672
  v_mfma_f32_16x16x32_bf16 v[96:99], a[136:139], v[136:139], v[96:99]
  v_exp_f32 v89, v89
  v_mfma_f32_16x16x32_bf16 v[96:99], a[140:143], v[140:143], v[96:99]
  ds_read_b128 a[148:151], v213 offset:28672
  v_cvt_pk_bf16_f32 v88, v88, v89
  v_mfma_f32_16x16x32_bf16 v[104:107], a[140:143], v[156:159], v[196:199]
  v_exp_f32 v90, v90
  v_mfma_f32_16x16x32_bf16 v[104:107], a[136:139], v[152:155], v[104:107]
  ds_read_b128 a[152:155], v214 offset:28672
  v_mfma_f32_16x16x32_bf16 v[104:107], a[132:135], v[148:151], v[104:107]
  v_exp_f32 v91, v91
  v_mfma_f32_16x16x32_bf16 v[104:107], a[128:131], v[144:147], v[104:107]
  ds_read_b128 a[156:159], v215 offset:28672
  v_cvt_pk_bf16_f32 v89, v90, v91
  v_mfma_f32_16x16x32_bf16 v[112:115], a[128:131], v[160:163], v[200:203]
  v_exp_f32 v68, v68
  v_mfma_f32_16x16x32_bf16 v[112:115], a[132:135], v[164:167], v[112:115]
  buffer_load_dwordx4 v235, s[12:15], s29 offen offset:3072 lds
  v_mfma_f32_16x16x32_bf16 v[112:115], a[136:139], v[168:171], v[112:115]
  v_exp_f32 v69, v69
  v_mfma_f32_16x16x32_bf16 v[112:115], a[140:143], v[172:175], v[112:115]
  v_cvt_pk_bf16_f32 v66, v68, v69
  v_mfma_f32_16x16x32_bf16 v[120:123], a[140:143], v[188:191], v[204:207]
  s_add_u32 m0, s50, 5120
  v_exp_f32 v70, v70
  v_mfma_f32_16x16x32_bf16 v[120:123], a[136:139], v[184:187], v[120:123]
  buffer_load_dwordx4 v208, s[20:23], s30 offen lds
  s_add_u32 s30, s30, 32
  v_mfma_f32_16x16x32_bf16 v[120:123], a[132:135], v[180:183], v[120:123]
  s_waitcnt lgkmcnt(0)
  v_exp_f32 v71, v71
  v_mfma_f32_16x16x32_bf16 v[120:123], a[128:131], v[176:179], v[120:123]
  v_cvt_pk_bf16_f32 v67, v70, v71
  v_mfma_f32_16x16x32_bf16 v[100:103], a[144:147], v[128:131], v[192:195]
  v_exp_f32 v76, v76
  v_mfma_f32_16x16x32_bf16 v[100:103], a[148:151], v[132:135], v[100:103]
  ds_read_b64_tr_b16 a[160:161], v216 offset:0
  v_mfma_f32_16x16x32_bf16 v[100:103], a[152:155], v[136:139], v[100:103]
  v_exp_f32 v77, v77
  v_mfma_f32_16x16x32_bf16 v[100:103], a[156:159], v[140:143], v[100:103]
  ds_read_b64_tr_b16 a[162:163], v216 offset:4096
  v_cvt_pk_bf16_f32 v74, v76, v77
  v_mfma_f32_16x16x32_bf16 v[108:111], a[156:159], v[156:159], v[196:199]
  v_exp_f32 v78, v78
  v_mfma_f32_16x16x32_bf16 v[108:111], a[152:155], v[152:155], v[108:111]
  ds_read_b64_tr_b16 a[164:165], v216 offset:8192
  v_mfma_f32_16x16x32_bf16 v[108:111], a[148:151], v[148:151], v[108:111]
  v_exp_f32 v79, v79
  v_mfma_f32_16x16x32_bf16 v[108:111], a[144:147], v[144:147], v[108:111]
  ds_read_b64_tr_b16 a[166:167], v216 offset:12288
  v_cvt_pk_bf16_f32 v75, v78, v79
  v_mfma_f32_16x16x32_bf16 v[116:119], a[144:147], v[160:163], v[200:203]
  v_exp_f32 v84, v84
  v_mfma_f32_16x16x32_bf16 v[116:119], a[148:151], v[164:167], v[116:119]
  ds_read_b64_tr_b16 a[168:169], v217 offset:0
  v_mfma_f32_16x16x32_bf16 v[116:119], a[152:155], v[168:171], v[116:119]
  v_exp_f32 v85, v85
  v_mfma_f32_16x16x32_bf16 v[116:119], a[156:159], v[172:175], v[116:119]
  ds_read_b64_tr_b16 a[170:171], v217 offset:4096
  v_cvt_pk_bf16_f32 v82, v84, v85
  v_mfma_f32_16x16x32_bf16 v[124:127], a[156:159], v[188:191], v[204:207]
  v_exp_f32 v86, v86
  v_mfma_f32_16x16x32_bf16 v[124:127], a[152:155], v[184:187], v[124:127]
  ds_read_b64_tr_b16 a[172:173], v217 offset:8192
  v_mfma_f32_16x16x32_bf16 v[124:127], a[148:151], v[180:183], v[124:127]
  v_exp_f32 v87, v87
  v_mfma_f32_16x16x32_bf16 v[124:127], a[144:147], v[176:179], v[124:127]
  ds_read_b64_tr_b16 a[174:175], v217 offset:12288
  v_cvt_pk_bf16_f32 v83, v86, v87
  v_mfma_f32_16x16x32_bf16 a[192:195], a[208:211], v[0:3], a[192:195]
  v_exp_f32 v92, v92
  v_mfma_f32_16x16x32_bf16 a[192:195], a[208:211], v[32:35], a[192:195]
  ds_read_b64_tr_b16 a[176:177], v218 offset:0
  v_mfma_f32_16x16x32_bf16 a[196:199], a[208:211], v[8:11], a[196:199]
  v_exp_f32 v93, v93
  v_mfma_f32_16x16x32_bf16 a[196:199], a[208:211], v[40:43], a[196:199]
  ds_read_b64_tr_b16 a[178:179], v218 offset:4096
  v_cvt_pk_bf16_f32 v90, v92, v93
  v_mfma_f32_16x16x32_bf16 a[200:203], a[208:211], v[16:19], a[200:203]
  v_exp_f32 v94, v94
  v_mfma_f32_16x16x32_bf16 a[200:203], a[208:211], v[48:51], a[200:203]
  ds_read_b64_tr_b16 a[180:181], v218 offset:8192
  v_mfma_f32_16x16x32_bf16 a[204:207], a[208:211], v[24:27], a[204:207]
  s_waitcnt lgkmcnt(7)
  v_exp_f32 v95, v95
  v_mfma_f32_16x16x32_bf16 a[204:207], a[208:211], v[56:59], a[204:207]
  ds_read_b64_tr_b16 a[182:183], v218 offset:12288
  v_cvt_pk_bf16_f32 v91, v94, v95
  v_mfma_f32_16x16x32_bf16 a[0:3], a[160:163], v[0:3], a[0:3]
  v_exp_f32 v96, v96
  v_mfma_f32_16x16x32_bf16 a[0:3], a[164:167], v[32:35], a[0:3]
  ds_read_b64_tr_b16 a[184:185], v219 offset:0
  v_mfma_f32_16x16x32_bf16 a[4:7], a[164:167], v[40:43], a[4:7]
  v_exp_f32 v97, v97
  v_mfma_f32_16x16x32_bf16 a[4:7], a[160:163], v[8:11], a[4:7]
  ds_read_b64_tr_b16 a[186:187], v219 offset:4096
  v_cvt_pk_bf16_f32 v96, v96, v97
  v_mfma_f32_16x16x32_bf16 a[8:11], a[160:163], v[16:19], a[8:11]
  v_exp_f32 v98, v98
  v_mfma_f32_16x16x32_bf16 a[8:11], a[164:167], v[48:51], a[8:11]
  ds_read_b64_tr_b16 a[188:189], v219 offset:8192
  v_mfma_f32_16x16x32_bf16 a[12:15], a[164:167], v[56:59], a[12:15]
  s_waitcnt lgkmcnt(7)
  v_exp_f32 v99, v99
  v_mfma_f32_16x16x32_bf16 a[12:15], a[160:163], v[24:27], a[12:15]
  ds_read_b64_tr_b16 a[190:191], v219 offset:12288
  v_cvt_pk_bf16_f32 v97, v98, v99
  v_mfma_f32_16x16x32_bf16 a[16:19], a[168:171], v[0:3], a[16:19]
  v_exp_f32 v104, v104
  v_mfma_f32_16x16x32_bf16 a[16:19], a[172:175], v[32:35], a[16:19]
  ds_read_b64_tr_b16 a[160:161], v220 offset:0
  v_mfma_f32_16x16x32_bf16 a[20:23], a[172:175], v[40:43], a[20:23]
  v_exp_f32 v105, v105
  v_mfma_f32_16x16x32_bf16 a[20:23], a[168:171], v[8:11], a[20:23]
  ds_read_b64_tr_b16 a[162:163], v220 offset:4096
  v_cvt_pk_bf16_f32 v104, v104, v105
  v_mfma_f32_16x16x32_bf16 a[24:27], a[168:171], v[16:19], a[24:27]
  v_exp_f32 v106, v106
  v_mfma_f32_16x16x32_bf16 a[24:27], a[172:175], v[48:51], a[24:27]
  ds_read_b64_tr_b16 a[164:165], v220 offset:8192
  v_mfma_f32_16x16x32_bf16 a[28:31], a[172:175], v[56:59], a[28:31]
  s_waitcnt lgkmcnt(7)
  v_exp_f32 v107, v107
  v_mfma_f32_16x16x32_bf16 a[28:31], a[168:171], v[24:27], a[28:31]
  ds_read_b64_tr_b16 a[166:167], v220 offset:12288
  v_cvt_pk_bf16_f32 v105, v106, v107
  v_mfma_f32_16x16x32_bf16 a[32:35], a[176:179], v[0:3], a[32:35]
  v_exp_f32 v112, v112
  v_mfma_f32_16x16x32_bf16 a[32:35], a[180:183], v[32:35], a[32:35]
  ds_read_b64_tr_b16 a[168:169], v221 offset:0
  v_mfma_f32_16x16x32_bf16 a[36:39], a[180:183], v[40:43], a[36:39]
  v_exp_f32 v113, v113
  v_mfma_f32_16x16x32_bf16 a[36:39], a[176:179], v[8:11], a[36:39]
  ds_read_b64_tr_b16 a[170:171], v221 offset:4096
  v_cvt_pk_bf16_f32 v112, v112, v113
  v_mfma_f32_16x16x32_bf16 a[40:43], a[176:179], v[16:19], a[40:43]
  v_exp_f32 v114, v114
  v_mfma_f32_16x16x32_bf16 a[40:43], a[180:183], v[48:51], a[40:43]
  ds_read_b64_tr_b16 a[172:173], v221 offset:8192
  v_mfma_f32_16x16x32_bf16 a[44:47], a[180:183], v[56:59], a[44:47]
  s_waitcnt lgkmcnt(7)
  v_exp_f32 v115, v115
  v_mfma_f32_16x16x32_bf16 a[44:47], a[176:179], v[24:27], a[44:47]
  ds_read_b64_tr_b16 a[174:175], v221 offset:12288
  v_cvt_pk_bf16_f32 v113, v114, v115
  v_mfma_f32_16x16x32_bf16 a[48:51], a[184:187], v[0:3], a[48:51]
  v_exp_f32 v120, v120
  v_mfma_f32_16x16x32_bf16 a[48:51], a[188:191], v[32:35], a[48:51]
  ds_read_b64_tr_b16 a[176:177], v222 offset:0
  v_mfma_f32_16x16x32_bf16 a[52:55], a[188:191], v[40:43], a[52:55]
  v_exp_f32 v121, v121
  v_mfma_f32_16x16x32_bf16 a[52:55], a[184:187], v[8:11], a[52:55]
  ds_read_b64_tr_b16 a[178:179], v222 offset:4096
  v_cvt_pk_bf16_f32 v120, v120, v121
  v_mfma_f32_16x16x32_bf16 a[56:59], a[184:187], v[16:19], a[56:59]
  v_exp_f32 v122, v122
  v_mfma_f32_16x16x32_bf16 a[56:59], a[188:191], v[48:51], a[56:59]
  ds_read_b64_tr_b16 a[180:181], v222 offset:8192
  v_mfma_f32_16x16x32_bf16 a[60:63], a[188:191], v[56:59], a[60:63]
  s_waitcnt lgkmcnt(7)
  v_exp_f32 v123, v123
  v_mfma_f32_16x16x32_bf16 a[60:63], a[184:187], v[24:27], a[60:63]
  ds_read_b64_tr_b16 a[182:183], v222 offset:12288
  v_cvt_pk_bf16_f32 v121, v122, v123
  v_mfma_f32_16x16x32_bf16 a[64:67], a[160:163], v[0:3], a[64:67]
  v_exp_f32 v100, v100
  v_mfma_f32_16x16x32_bf16 a[64:67], a[164:167], v[32:35], a[64:67]
  ds_read_b64_tr_b16 a[184:185], v223 offset:0
  v_mfma_f32_16x16x32_bf16 a[68:71], a[164:167], v[40:43], a[68:71]
  v_exp_f32 v101, v101
  v_mfma_f32_16x16x32_bf16 a[68:71], a[160:163], v[8:11], a[68:71]
  ds_read_b64_tr_b16 a[186:187], v223 offset:4096
  v_cvt_pk_bf16_f32 v98, v100, v101
  v_mfma_f32_16x16x32_bf16 a[72:75], a[160:163], v[16:19], a[72:75]
  v_exp_f32 v102, v102
  v_mfma_f32_16x16x32_bf16 a[72:75], a[164:167], v[48:51], a[72:75]
  ds_read_b64_tr_b16 a[188:189], v223 offset:8192
  v_mfma_f32_16x16x32_bf16 a[76:79], a[164:167], v[56:59], a[76:79]
  s_waitcnt lgkmcnt(7)
  v_exp_f32 v103, v103
  v_mfma_f32_16x16x32_bf16 a[76:79], a[160:163], v[24:27], a[76:79]
  ds_read_b64_tr_b16 a[190:191], v223 offset:12288
  v_cvt_pk_bf16_f32 v99, v102, v103
  v_mfma_f32_16x16x32_bf16 a[80:83], a[168:171], v[0:3], a[80:83]
  s_waitcnt vmcnt(10)
  v_exp_f32 v108, v108
  v_mfma_f32_16x16x32_bf16 a[80:83], a[172:175], v[32:35], a[80:83]
  v_mfma_f32_16x16x32_bf16 a[84:87], a[172:175], v[40:43], a[84:87]
  s_barrier
  v_exp_f32 v109, v109
  v_mfma_f32_16x16x32_bf16 a[84:87], a[168:171], v[8:11], a[84:87]
  ds_read_b128 a[128:131], v212 offset:32768
  v_cvt_pk_bf16_f32 v106, v108, v109
  v_mfma_f32_16x16x32_bf16 a[88:91], a[168:171], v[16:19], a[88:91]
  v_exp_f32 v110, v110
  v_mfma_f32_16x16x32_bf16 a[88:91], a[172:175], v[48:51], a[88:91]
  ds_read_b128 a[132:135], v213 offset:32768
  buffer_atomic_add v250, v249, s[24:27], s47 offen
  s_cmp_eq_u32 s32, 4
  s_cselect_b32 s39, 0, 1073741824
  v_mfma_f32_16x16x32_bf16 a[92:95], a[172:175], v[56:59], a[92:95]
  s_waitcnt lgkmcnt(6)
  v_exp_f32 v111, v111
  v_mfma_f32_16x16x32_bf16 a[92:95], a[168:171], v[24:27], a[92:95]
  ds_read_b128 a[136:139], v214 offset:32768
  v_cvt_pk_bf16_f32 v107, v110, v111
  v_mfma_f32_16x16x32_bf16 a[96:99], a[176:179], v[0:3], a[96:99]
  v_exp_f32 v116, v116
  v_mfma_f32_16x16x32_bf16 a[96:99], a[180:183], v[32:35], a[96:99]
  ds_read_b128 a[140:143], v215 offset:32768
  v_or_b32 v249, s39, v251
  v_mfma_f32_16x16x32_bf16 a[100:103], a[180:183], v[40:43], a[100:103]
  v_exp_f32 v117, v117
  v_mfma_f32_16x16x32_bf16 a[100:103], a[176:179], v[8:11], a[100:103]
  v_cvt_pk_bf16_f32 v114, v116, v117
  v_mfma_f32_16x16x32_bf16 a[104:107], a[176:179], v[16:19], a[104:107]
  v_exp_f32 v118, v118
  v_mfma_f32_16x16x32_bf16 a[104:107], a[180:183], v[48:51], a[104:107]
  v_mfma_f32_16x16x32_bf16 a[108:111], a[180:183], v[56:59], a[108:111]
  s_waitcnt lgkmcnt(4)
  v_exp_f32 v119, v119
  v_mfma_f32_16x16x32_bf16 a[108:111], a[176:179], v[24:27], a[108:111]
  v_cvt_pk_bf16_f32 v115, v118, v119
  v_mfma_f32_16x16x32_bf16 a[112:115], a[184:187], v[0:3], a[112:115]
  v_exp_f32 v124, v124
  v_mfma_f32_16x16x32_bf16 a[112:115], a[188:191], v[32:35], a[112:115]
  v_mfma_f32_16x16x32_bf16 a[116:119], a[188:191], v[40:43], a[116:119]
  v_exp_f32 v125, v125
  v_mfma_f32_16x16x32_bf16 a[116:119], a[184:187], v[8:11], a[116:119]
  v_cvt_pk_bf16_f32 v122, v124, v125
  v_mfma_f32_16x16x32_bf16 a[120:123], a[184:187], v[16:19], a[120:123]
  v_exp_f32 v126, v126
  v_mfma_f32_16x16x32_bf16 a[120:123], a[188:191], v[48:51], a[120:123]
  v_mfma_f32_16x16x32_bf16 a[124:127], a[188:191], v[56:59], a[124:127]
  s_waitcnt lgkmcnt(0)
  v_exp_f32 v127, v127
  v_mfma_f32_16x16x32_bf16 a[124:127], a[184:187], v[24:27], a[124:127]
  v_cvt_pk_bf16_f32 v123, v126, v127
  v_mfma_f32_16x16x32_bf16 v[0:3], a[128:131], v[128:131], v[192:195]
  s_add_u32 m0, s28, 114688
  v_mfma_f32_16x16x32_bf16 v[0:3], a[132:135], v[132:135], v[0:3]
  ds_read_b128 a[144:147], v212 offset:36864
  v_mfma_f32_16x16x32_bf16 v[0:3], a[136:139], v[136:139], v[0:3]
  buffer_load_dwordx4 v236, s[16:19], s29 offen offset:0 lds
  v_mfma_f32_16x16x32_bf16 v[0:3], a[140:143], v[140:143], v[0:3]
  ds_read_b128 a[148:151], v213 offset:36864
  v_mfma_f32_16x16x32_bf16 v[8:11], a[140:143], v[156:159], v[196:199]
  buffer_load_dwordx4 v237, s[16:19], s29 offen offset:1024 lds
  v_mfma_f32_16x16x32_bf16 v[8:11], a[136:139], v[152:155], v[8:11]
  ds_read_b128 a[152:155], v214 offset:36864
  v_mfma_f32_16x16x32_bf16 v[8:11], a[132:135], v[148:151], v[8:11]
  buffer_load_dwordx4 v236, s[16:19], s29 offen offset:2048 lds
  v_mfma_f32_16x16x32_bf16 v[8:11], a[128:131], v[144:147], v[8:11]
  ds_read_b128 a[156:159], v215 offset:36864
  v_mfma_f32_16x16x32_bf16 v[16:19], a[128:131], v[160:163], v[200:203]
  v_exp_f32 v0, v0
  v_mfma_f32_16x16x32_bf16 v[16:19], a[132:135], v[164:167], v[16:19]
  buffer_load_dwordx4 v237, s[16:19], s29 offen offset:3072 lds
  v_mfma_f32_16x16x32_bf16 v[16:19], a[136:139], v[168:171], v[16:19]
  s_add_u32 s29, s29, 16384
  v_exp_f32 v1, v1
  v_mfma_f32_16x16x32_bf16 v[16:19], a[140:143], v[172:175], v[16:19]
  v_cvt_pk_bf16_f32 v0, v0, v1
  v_mfma_f32_16x16x32_bf16 v[24:27], a[140:143], v[188:191], v[204:207]
  s_add_u32 m0, s28, 0
  v_exp_f32 v2, v2
  v_mfma_f32_16x16x32_bf16 v[24:27], a[136:139], v[184:187], v[24:27]
  buffer_load_dwordx4 v232, s[12:15], s29 offen offset:0 lds
  v_mfma_f32_16x16x32_bf16 v[24:27], a[132:135], v[180:183], v[24:27]
  s_waitcnt lgkmcnt(0)
  v_exp_f32 v3, v3
  v_mfma_f32_16x16x32_bf16 v[24:27], a[128:131], v[176:179], v[24:27]
  v_cvt_pk_bf16_f32 v1, v2, v3
  v_mfma_f32_16x16x32_bf16 v[4:7], a[144:147], v[128:131], v[192:195]
  v_exp_f32 v8, v8
  v_mfma_f32_16x16x32_bf16 v[4:7], a[148:151], v[132:135], v[4:7]
  ds_read_b128 a[128:131], v212 offset:40960
  v_mfma_f32_16x16x32_bf16 v[4:7], a[152:155], v[136:139], v[4:7]
  v_exp_f32 v9, v9
  v_mfma_f32_16x16x32_bf16 v[4:7], a[156:159], v[140:143], v[4:7]
  ds_read_b128 a[132:135], v213 offset:40960
  v_cvt_pk_bf16_f32 v8, v8, v9
  v_mfma_f32_16x16x32_bf16 v[12:15], a[156:159], v[156:159], v[196:199]
  v_exp_f32 v10, v10
  v_mfma_f32_16x16x32_bf16 v[12:15], a[152:155], v[152:155], v[12:15]
  ds_read_b128 a[136:139], v214 offset:40960
  v_mfma_f32_16x16x32_bf16 v[12:15], a[148:151], v[148:151], v[12:15]
  v_exp_f32 v11, v11
  v_mfma_f32_16x16x32_bf16 v[12:15], a[144:147], v[144:147], v[12:15]
  ds_read_b128 a[140:143], v215 offset:40960
  v_cvt_pk_bf16_f32 v9, v10, v11
  v_mfma_f32_16x16x32_bf16 v[20:23], a[144:147], v[160:163], v[200:203]
  v_exp_f32 v16, v16
  v_mfma_f32_16x16x32_bf16 v[20:23], a[148:151], v[164:167], v[20:23]
  buffer_load_dwordx4 v233, s[12:15], s29 offen offset:1024 lds
  v_mfma_f32_16x16x32_bf16 v[20:23], a[152:155], v[168:171], v[20:23]
  v_exp_f32 v17, v17
  v_mfma_f32_16x16x32_bf16 v[20:23], a[156:159], v[172:175], v[20:23]
  v_cvt_pk_bf16_f32 v16, v16, v17
  v_mfma_f32_16x16x32_bf16 v[28:31], a[156:159], v[188:191], v[204:207]
  v_exp_f32 v18, v18
  v_mfma_f32_16x16x32_bf16 v[28:31], a[152:155], v[184:187], v[28:31]
  buffer_load_dwordx4 v234, s[12:15], s29 offen offset:2048 lds
  v_mfma_f32_16x16x32_bf16 v[28:31], a[148:151], v[180:183], v[28:31]
  s_waitcnt lgkmcnt(0)
  v_exp_f32 v19, v19
  v_mfma_f32_16x16x32_bf16 v[28:31], a[144:147], v[176:179], v[28:31]
  v_cvt_pk_bf16_f32 v17, v18, v19
  v_mfma_f32_16x16x32_bf16 v[32:35], a[128:131], v[128:131], v[192:195]
  v_exp_f32 v24, v24
  v_mfma_f32_16x16x32_bf16 v[32:35], a[132:135], v[132:135], v[32:35]
  ds_read_b128 a[144:147], v212 offset:45056
  v_mfma_f32_16x16x32_bf16 v[32:35], a[136:139], v[136:139], v[32:35]
  v_exp_f32 v25, v25
  v_mfma_f32_16x16x32_bf16 v[32:35], a[140:143], v[140:143], v[32:35]
  ds_read_b128 a[148:151], v213 offset:45056
  v_cvt_pk_bf16_f32 v24, v24, v25
  v_mfma_f32_16x16x32_bf16 v[40:43], a[140:143], v[156:159], v[196:199]
  v_exp_f32 v26, v26
  v_mfma_f32_16x16x32_bf16 v[40:43], a[136:139], v[152:155], v[40:43]
  ds_read_b128 a[152:155], v214 offset:45056
  v_mfma_f32_16x16x32_bf16 v[40:43], a[132:135], v[148:151], v[40:43]
  v_exp_f32 v27, v27
  v_mfma_f32_16x16x32_bf16 v[40:43], a[128:131], v[144:147], v[40:43]
  ds_read_b128 a[156:159], v215 offset:45056
  v_cvt_pk_bf16_f32 v25, v26, v27
  v_mfma_f32_16x16x32_bf16 v[48:51], a[128:131], v[160:163], v[200:203]
  v_exp_f32 v4, v4
  v_mfma_f32_16x16x32_bf16 v[48:51], a[132:135], v[164:167], v[48:51]
  buffer_load_dwordx4 v235, s[12:15], s29 offen offset:3072 lds
  v_mfma_f32_16x16x32_bf16 v[48:51], a[136:139], v[168:171], v[48:51]
  v_exp_f32 v5, v5
  v_mfma_f32_16x16x32_bf16 v[48:51], a[140:143], v[172:175], v[48:51]
  v_cvt_pk_bf16_f32 v2, v4, v5
  v_mfma_f32_16x16x32_bf16 v[56:59], a[140:143], v[188:191], v[204:207]
  s_mov_b32 m0, s51
  v_exp_f32 v6, v6
  v_mfma_f32_16x16x32_bf16 v[56:59], a[136:139], v[184:187], v[56:59]
  buffer_load_dwordx4 v210, s[4:7], s100 offen lds
  s_add_u32 s100, s100, 20480
  s_add_u32 s51, s51, 512
  v_mfma_f32_16x16x32_bf16 v[56:59], a[132:135], v[180:183], v[56:59]
  s_waitcnt lgkmcnt(0)
  v_exp_f32 v7, v7
  v_mfma_f32_16x16x32_bf16 v[56:59], a[128:131], v[176:179], v[56:59]
  v_cvt_pk_bf16_f32 v3, v6, v7
  v_mfma_f32_16x16x32_bf16 v[36:39], a[144:147], v[128:131], v[192:195]
  v_exp_f32 v12, v12
  v_mfma_f32_16x16x32_bf16 v[36:39], a[148:151], v[132:135], v[36:39]
  ds_read_b64_tr_b16 a[160:161], v216 offset:16384
  v_mfma_f32_16x16x32_bf16 v[36:39], a[152:155], v[136:139], v[36:39]
  v_exp_f32 v13, v13
  v_mfma_f32_16x16x32_bf16 v[36:39], a[156:159], v[140:143], v[36:39]
  ds_read_b64_tr_b16 a[162:163], v216 offset:20480
  v_cvt_pk_bf16_f32 v10, v12, v13
  v_mfma_f32_16x16x32_bf16 v[44:47], a[156:159], v[156:159], v[196:199]
  v_exp_f32 v14, v14
  v_mfma_f32_16x16x32_bf16 v[44:47], a[152:155], v[152:155], v[44:47]
  ds_read_b64_tr_b16 a[164:165], v216 offset:24576
  v_mfma_f32_16x16x32_bf16 v[44:47], a[148:151], v[148:151], v[44:47]
  v_exp_f32 v15, v15
  v_mfma_f32_16x16x32_bf16 v[44:47], a[144:147], v[144:147], v[44:47]
  ds_read_b64_tr_b16 a[166:167], v216 offset:28672
  v_cvt_pk_bf16_f32 v11, v14, v15
  v_mfma_f32_16x16x32_bf16 v[52:55], a[144:147], v[160:163], v[200:203]
  v_exp_f32 v20, v20
  v_mfma_f32_16x16x32_bf16 v[52:55], a[148:151], v[164:167], v[52:55]
  ds_read_b64_tr_b16 a[168:169], v217 offset:16384
  v_mfma_f32_16x16x32_bf16 v[52:55], a[152:155], v[168:171], v[52:55]
  v_exp_f32 v21, v21
  v_mfma_f32_16x16x32_bf16 v[52:55], a[156:159], v[172:175], v[52:55]
  ds_read_b64_tr_b16 a[170:171], v217 offset:20480
  v_cvt_pk_bf16_f32 v18, v20, v21
  v_mfma_f32_16x16x32_bf16 v[60:63], a[156:159], v[188:191], v[204:207]
  v_exp_f32 v22, v22
  v_mfma_f32_16x16x32_bf16 v[60:63], a[152:155], v[184:187], v[60:63]
  ds_read_b64_tr_b16 a[172:173], v217 offset:24576
  v_mfma_f32_16x16x32_bf16 v[60:63], a[148:151], v[180:183], v[60:63]
  v_exp_f32 v23, v23
  v_mfma_f32_16x16x32_bf16 v[60:63], a[144:147], v[176:179], v[60:63]
  ds_read_b64_tr_b16 a[174:175], v217 offset:28672
  v_cvt_pk_bf16_f32 v19, v22, v23
  v_mfma_f32_16x16x32_bf16 a[192:195], a[208:211], v[64:67], a[192:195]
  v_exp_f32 v28, v28
  v_mfma_f32_16x16x32_bf16 a[192:195], a[208:211], v[96:99], a[192:195]
  ds_read_b64_tr_b16 a[176:177], v218 offset:16384
  v_mfma_f32_16x16x32_bf16 a[196:199], a[208:211], v[72:75], a[196:199]
  v_exp_f32 v29, v29
  v_mfma_f32_16x16x32_bf16 a[196:199], a[208:211], v[104:107], a[196:199]
  ds_read_b64_tr_b16 a[178:179], v218 offset:20480
  v_cvt_pk_bf16_f32 v26, v28, v29
  v_mfma_f32_16x16x32_bf16 a[200:203], a[208:211], v[80:83], a[200:203]
  v_exp_f32 v30, v30
  v_mfma_f32_16x16x32_bf16 a[200:203], a[208:211], v[112:115], a[200:203]
  ds_read_b64_tr_b16 a[180:181], v218 offset:24576
  v_mfma_f32_16x16x32_bf16 a[204:207], a[208:211], v[88:91], a[204:207]
  s_waitcnt lgkmcnt(7)
  v_exp_f32 v31, v31
  v_mfma_f32_16x16x32_bf16 a[204:207], a[208:211], v[120:123], a[204:207]
  ds_read_b64_tr_b16 a[182:183], v218 offset:28672
  v_cvt_pk_bf16_f32 v27, v30, v31
  v_mfma_f32_16x16x32_bf16 a[0:3], a[160:163], v[64:67], a[0:3]
  v_exp_f32 v32, v32
  v_mfma_f32_16x16x32_bf16 a[0:3], a[164:167], v[96:99], a[0:3]
  ds_read_b64_tr_b16 a[184:185], v219 offset:16384
  v_mfma_f32_16x16x32_bf16 a[4:7], a[164:167], v[104:107], a[4:7]
  v_exp_f32 v33, v33
  v_mfma_f32_16x16x32_bf16 a[4:7], a[160:163], v[72:75], a[4:7]
  ds_read_b64_tr_b16 a[186:187], v219 offset:20480
  v_cvt_pk_bf16_f32 v32, v32, v33
  v_mfma_f32_16x16x32_bf16 a[8:11], a[160:163], v[80:83], a[8:11]
  v_exp_f32 v34, v34
  v_mfma_f32_16x16x32_bf16 a[8:11], a[164:167], v[112:115], a[8:11]
  ds_read_b64_tr_b16 a[188:189], v219 offset:24576
  v_mfma_f32_16x16x32_bf16 a[12:15], a[164:167], v[120:123], a[12:15]
  s_waitcnt lgkmcnt(7)
  v_exp_f32 v35, v35
  v_mfma_f32_16x16x32_bf16 a[12:15], a[160:163], v[88:91], a[12:15]
  ds_read_b64_tr_b16 a[190:191], v219 offset:28672
  v_cvt_pk_bf16_f32 v33, v34, v35
  v_mfma_f32_16x16x32_bf16 a[16:19], a[168:171], v[64:67], a[16:19]
  v_exp_f32 v40, v40
  v_mfma_f32_16x16x32_bf16 a[16:19], a[172:175], v[96:99], a[16:19]
  ds_read_b64_tr_b16 a[160:161], v220 offset:16384
  v_mfma_f32_16x16x32_bf16 a[20:23], a[172:175], v[104:107], a[20:23]
  v_exp_f32 v41, v41
  v_mfma_f32_16x16x32_bf16 a[20:23], a[168:171], v[72:75], a[20:23]
  ds_read_b64_tr_b16 a[162:163], v220 offset:20480
  v_cvt_pk_bf16_f32 v40, v40, v41
  v_mfma_f32_16x16x32_bf16 a[24:27], a[168:171], v[80:83], a[24:27]
  v_exp_f32 v42, v42
  v_mfma_f32_16x16x32_bf16 a[24:27], a[172:175], v[112:115], a[24:27]
  ds_read_b64_tr_b16 a[164:165], v220 offset:24576
  v_mfma_f32_16x16x32_bf16 a[28:31], a[172:175], v[120:123], a[28:31]
  s_waitcnt lgkmcnt(7)
  v_exp_f32 v43, v43
  v_mfma_f32_16x16x32_bf16 a[28:31], a[168:171], v[88:91], a[28:31]
  ds_read_b64_tr_b16 a[166:167], v220 offset:28672
  v_cvt_pk_bf16_f32 v41, v42, v43
  v_mfma_f32_16x16x32_bf16 a[32:35], a[176:179], v[64:67], a[32:35]
  v_exp_f32 v48, v48
  v_mfma_f32_16x16x32_bf16 a[32:35], a[180:183], v[96:99], a[32:35]
  ds_read_b64_tr_b16 a[168:169], v221 offset:16384
  v_mfma_f32_16x16x32_bf16 a[36:39], a[180:183], v[104:107], a[36:39]
  v_exp_f32 v49, v49
  v_mfma_f32_16x16x32_bf16 a[36:39], a[176:179], v[72:75], a[36:39]
  ds_read_b64_tr_b16 a[170:171], v221 offset:20480
  v_cvt_pk_bf16_f32 v48, v48, v49
  v_mfma_f32_16x16x32_bf16 a[40:43], a[176:179], v[80:83], a[40:43]
  v_exp_f32 v50, v50
  v_mfma_f32_16x16x32_bf16 a[40:43], a[180:183], v[112:115], a[40:43]
  ds_read_b64_tr_b16 a[172:173], v221 offset:24576
  v_mfma_f32_16x16x32_bf16 a[44:47], a[180:183], v[120:123], a[44:47]
  s_waitcnt lgkmcnt(7)
  v_exp_f32 v51, v51
  v_mfma_f32_16x16x32_bf16 a[44:47], a[176:179], v[88:91], a[44:47]
  ds_read_b64_tr_b16 a[174:175], v221 offset:28672
  v_cvt_pk_bf16_f32 v49, v50, v51
  v_mfma_f32_16x16x32_bf16 a[48:51], a[184:187], v[64:67], a[48:51]
  v_exp_f32 v56, v56
  v_mfma_f32_16x16x32_bf16 a[48:51], a[188:191], v[96:99], a[48:51]
  ds_read_b64_tr_b16 a[176:177], v222 offset:16384
  v_mfma_f32_16x16x32_bf16 a[52:55], a[188:191], v[104:107], a[52:55]
  v_exp_f32 v57, v57
  v_mfma_f32_16x16x32_bf16 a[52:55], a[184:187], v[72:75], a[52:55]
  ds_read_b64_tr_b16 a[178:179], v222 offset:20480
  v_cvt_pk_bf16_f32 v56, v56, v57
  v_mfma_f32_16x16x32_bf16 a[56:59], a[184:187], v[80:83], a[56:59]
  v_exp_f32 v58, v58
  v_mfma_f32_16x16x32_bf16 a[56:59], a[188:191], v[112:115], a[56:59]
  ds_read_b64_tr_b16 a[180:181], v222 offset:24576
  v_mfma_f32_16x16x32_bf16 a[60:63], a[188:191], v[120:123], a[60:63]
  s_waitcnt lgkmcnt(7)
  v_exp_f32 v59, v59
  v_mfma_f32_16x16x32_bf16 a[60:63], a[184:187], v[88:91], a[60:63]
  ds_read_b64_tr_b16 a[182:183], v222 offset:28672
  v_cvt_pk_bf16_f32 v57, v58, v59
  v_mfma_f32_16x16x32_bf16 a[64:67], a[160:163], v[64:67], a[64:67]
  v_exp_f32 v36, v36
  v_mfma_f32_16x16x32_bf16 a[64:67], a[164:167], v[96:99], a[64:67]
  ds_read_b64_tr_b16 a[184:185], v223 offset:16384
  v_mfma_f32_16x16x32_bf16 a[68:71], a[164:167], v[104:107], a[68:71]
  v_exp_f32 v37, v37
  v_mfma_f32_16x16x32_bf16 a[68:71], a[160:163], v[72:75], a[68:71]
  ds_read_b64_tr_b16 a[186:187], v223 offset:20480
  v_cvt_pk_bf16_f32 v34, v36, v37
  v_mfma_f32_16x16x32_bf16 a[72:75], a[160:163], v[80:83], a[72:75]
  v_exp_f32 v38, v38
  v_mfma_f32_16x16x32_bf16 a[72:75], a[164:167], v[112:115], a[72:75]
  ds_read_b64_tr_b16 a[188:189], v223 offset:24576
  v_mfma_f32_16x16x32_bf16 a[76:79], a[164:167], v[120:123], a[76:79]
  s_waitcnt lgkmcnt(7)
  v_exp_f32 v39, v39
  v_mfma_f32_16x16x32_bf16 a[76:79], a[160:163], v[88:91], a[76:79]
  ds_read_b64_tr_b16 a[190:191], v223 offset:28672
  v_cvt_pk_bf16_f32 v35, v38, v39
  v_mfma_f32_16x16x32_bf16 a[80:83], a[168:171], v[64:67], a[80:83]
  s_waitcnt vmcnt(11)
  v_exp_f32 v44, v44
  v_mfma_f32_16x16x32_bf16 a[80:83], a[172:175], v[96:99], a[80:83]
  v_mfma_f32_16x16x32_bf16 a[84:87], a[172:175], v[104:107], a[84:87]
  s_barrier
  v_exp_f32 v45, v45
  v_mfma_f32_16x16x32_bf16 a[84:87], a[168:171], v[72:75], a[84:87]
  ds_read_b128 a[128:131], v212 offset:49152
  v_cvt_pk_bf16_f32 v42, v44, v45
  v_mfma_f32_16x16x32_bf16 a[88:91], a[168:171], v[80:83], a[88:91]
  v_exp_f32 v46, v46
  v_mfma_f32_16x16x32_bf16 a[88:91], a[172:175], v[112:115], a[88:91]
  ds_read_b128 a[132:135], v213 offset:49152
  ds_read_b64_tr_b16 a[232:233], v209 offset:4096
  v_mfma_f32_16x16x32_bf16 a[92:95], a[172:175], v[120:123], a[92:95]
  s_waitcnt lgkmcnt(7)
  v_exp_f32 v47, v47
  v_mfma_f32_16x16x32_bf16 a[92:95], a[168:171], v[88:91], a[92:95]
  ds_read_b128 a[136:139], v214 offset:49152
  v_cvt_pk_bf16_f32 v43, v46, v47
  v_mfma_f32_16x16x32_bf16 a[96:99], a[176:179], v[64:67], a[96:99]
  v_exp_f32 v52, v52
  v_mfma_f32_16x16x32_bf16 a[96:99], a[180:183], v[96:99], a[96:99]
  ds_read_b128 a[140:143], v215 offset:49152
  ds_read_b64_tr_b16 a[234:235], v209 offset:4608
  v_mfma_f32_16x16x32_bf16 a[100:103], a[180:183], v[104:107], a[100:103]
  v_exp_f32 v53, v53
  v_mfma_f32_16x16x32_bf16 a[100:103], a[176:179], v[72:75], a[100:103]
  v_cvt_pk_bf16_f32 v50, v52, v53
  v_mfma_f32_16x16x32_bf16 a[104:107], a[176:179], v[80:83], a[104:107]
  v_exp_f32 v54, v54
  v_mfma_f32_16x16x32_bf16 a[104:107], a[180:183], v[112:115], a[104:107]
  v_mfma_f32_16x16x32_bf16 a[108:111], a[180:183], v[120:123], a[108:111]
  s_waitcnt lgkmcnt(6)
  v_exp_f32 v55, v55
  v_mfma_f32_16x16x32_bf16 a[108:111], a[176:179], v[88:91], a[108:111]
  v_cvt_pk_bf16_f32 v51, v54, v55
  v_mfma_f32_16x16x32_bf16 a[112:115], a[184:187], v[64:67], a[112:115]
  v_exp_f32 v60, v60
  v_mfma_f32_16x16x32_bf16 a[112:115], a[188:191], v[96:99], a[112:115]
  s_waitcnt lgkmcnt(0)
  buffer_store_dwordx4 a[232:235], v211, s[24:27], s31 offen sc1
  s_add_u32 s31, s31, 1024
  s_cmp_gt_u32 s32, 4
  s_cselect_b32 s39, 0, 1073741824
  v_mfma_f32_16x16x32_bf16 a[116:119], a[188:191], v[104:107], a[116:119]
  v_exp_f32 v61, v61
  v_mfma_f32_16x16x32_bf16 a[116:119], a[184:187], v[72:75], a[116:119]
  v_cvt_pk_bf16_f32 v58, v60, v61
  v_or_b32 v211, s39, v211
  v_mfma_f32_16x16x32_bf16 a[120:123], a[184:187], v[80:83], a[120:123]
  v_exp_f32 v62, v62
  v_mfma_f32_16x16x32_bf16 a[120:123], a[188:191], v[112:115], a[120:123]
  v_or_b32 v208, s39, v208
  v_mfma_f32_16x16x32_bf16 a[124:127], a[188:191], v[120:123], a[124:127]
  v_exp_f32 v63, v63
  v_mfma_f32_16x16x32_bf16 a[124:127], a[184:187], v[88:91], a[124:127]
  v_cvt_pk_bf16_f32 v59, v62, v63
  v_mfma_f32_16x16x32_bf16 v[64:67], a[128:131], v[128:131], v[192:195]
  s_add_u32 m0, s28, 65536
  v_mfma_f32_16x16x32_bf16 v[64:67], a[132:135], v[132:135], v[64:67]
  ds_read_b128 a[144:147], v212 offset:53248
  v_mfma_f32_16x16x32_bf16 v[64:67], a[136:139], v[136:139], v[64:67]
  buffer_load_dwordx4 v236, s[16:19], s29 offen offset:0 lds
  v_mfma_f32_16x16x32_bf16 v[64:67], a[140:143], v[140:143], v[64:67]
  ds_read_b128 a[148:151], v213 offset:53248
  v_mfma_f32_16x16x32_bf16 v[72:75], a[140:143], v[156:159], v[196:199]
  buffer_load_dwordx4 v237, s[16:19], s29 offen offset:1024 lds
  v_mfma_f32_16x16x32_bf16 v[72:75], a[136:139], v[152:155], v[72:75]
  ds_read_b128 a[152:155], v214 offset:53248
  v_mfma_f32_16x16x32_bf16 v[72:75], a[132:135], v[148:151], v[72:75]
  buffer_load_dwordx4 v236, s[16:19], s29 offen offset:2048 lds
  v_mfma_f32_16x16x32_bf16 v[72:75], a[128:131], v[144:147], v[72:75]
  ds_read_b128 a[156:159], v215 offset:53248
  v_mfma_f32_16x16x32_bf16 v[80:83], a[128:131], v[160:163], v[200:203]
  v_exp_f32 v64, v64
  v_mfma_f32_16x16x32_bf16 v[80:83], a[132:135], v[164:167], v[80:83]
  buffer_load_dwordx4 v237, s[16:19], s29 offen offset:3072 lds
  v_mfma_f32_16x16x32_bf16 v[80:83], a[136:139], v[168:171], v[80:83]
  s_add_u32 s29, s29, 16384
  v_exp_f32 v65, v65
  v_mfma_f32_16x16x32_bf16 v[80:83], a[140:143], v[172:175], v[80:83]
  v_cvt_pk_bf16_f32 v64, v64, v65
  v_mfma_f32_16x16x32_bf16 v[88:91], a[140:143], v[188:191], v[204:207]
  s_add_u32 m0, s28, 16384
  v_exp_f32 v66, v66
  v_mfma_f32_16x16x32_bf16 v[88:91], a[136:139], v[184:187], v[88:91]
  buffer_load_dwordx4 v232, s[12:15], s29 offen offset:0 lds
  v_mfma_f32_16x16x32_bf16 v[88:91], a[132:135], v[180:183], v[88:91]
  s_waitcnt lgkmcnt(0)
  v_exp_f32 v67, v67
  v_mfma_f32_16x16x32_bf16 v[88:91], a[128:131], v[176:179], v[88:91]
  v_cvt_pk_bf16_f32 v65, v66, v67
  v_mfma_f32_16x16x32_bf16 v[68:71], a[144:147], v[128:131], v[192:195]
  v_exp_f32 v72, v72
  v_mfma_f32_16x16x32_bf16 v[68:71], a[148:151], v[132:135], v[68:71]
  ds_read_b128 a[128:131], v212 offset:57344
  v_mfma_f32_16x16x32_bf16 v[68:71], a[152:155], v[136:139], v[68:71]
  v_exp_f32 v73, v73
  v_mfma_f32_16x16x32_bf16 v[68:71], a[156:159], v[140:143], v[68:71]
  ds_read_b128 a[132:135], v213 offset:57344
  v_cvt_pk_bf16_f32 v72, v72, v73
  v_mfma_f32_16x16x32_bf16 v[76:79], a[156:159], v[156:159], v[196:199]
  v_exp_f32 v74, v74
  v_mfma_f32_16x16x32_bf16 v[76:79], a[152:155], v[152:155], v[76:79]
  ds_read_b128 a[136:139], v214 offset:57344
  v_mfma_f32_16x16x32_bf16 v[76:79], a[148:151], v[148:151], v[76:79]
  v_exp_f32 v75, v75
  v_mfma_f32_16x16x32_bf16 v[76:79], a[144:147], v[144:147], v[76:79]
  ds_read_b128 a[140:143], v215 offset:57344
  v_cvt_pk_bf16_f32 v73, v74, v75
  v_mfma_f32_16x16x32_bf16 v[84:87], a[144:147], v[160:163], v[200:203]
  v_exp_f32 v80, v80
  v_mfma_f32_16x16x32_bf16 v[84:87], a[148:151], v[164:167], v[84:87]
  buffer_load_dwordx4 v233, s[12:15], s29 offen offset:1024 lds
  v_mfma_f32_16x16x32_bf16 v[84:87], a[152:155], v[168:171], v[84:87]
  v_exp_f32 v81, v81
  v_mfma_f32_16x16x32_bf16 v[84:87], a[156:159], v[172:175], v[84:87]
  v_cvt_pk_bf16_f32 v80, v80, v81
  v_mfma_f32_16x16x32_bf16 v[92:95], a[156:159], v[188:191], v[204:207]
  v_exp_f32 v82, v82
  v_mfma_f32_16x16x32_bf16 v[92:95], a[152:155], v[184:187], v[92:95]
  buffer_load_dwordx4 v234, s[12:15], s29 offen offset:2048 lds
  v_mfma_f32_16x16x32_bf16 v[92:95], a[148:151], v[180:183], v[92:95]
  s_waitcnt lgkmcnt(0)
  v_exp_f32 v83, v83
  v_mfma_f32_16x16x32_bf16 v[92:95], a[144:147], v[176:179], v[92:95]
  v_cvt_pk_bf16_f32 v81, v82, v83
  v_mfma_f32_16x16x32_bf16 v[96:99], a[128:131], v[128:131], v[192:195]
  v_exp_f32 v88, v88
  v_mfma_f32_16x16x32_bf16 v[96:99], a[132:135], v[132:135], v[96:99]
  ds_read_b128 a[144:147], v212 offset:61440
  v_mfma_f32_16x16x32_bf16 v[96:99], a[136:139], v[136:139], v[96:99]
  v_exp_f32 v89, v89
  v_mfma_f32_16x16x32_bf16 v[96:99], a[140:143], v[140:143], v[96:99]
  ds_read_b128 a[148:151], v213 offset:61440
  v_cvt_pk_bf16_f32 v88, v88, v89
  v_mfma_f32_16x16x32_bf16 v[104:107], a[140:143], v[156:159], v[196:199]
  v_exp_f32 v90, v90
  v_mfma_f32_16x16x32_bf16 v[104:107], a[136:139], v[152:155], v[104:107]
  ds_read_b128 a[152:155], v214 offset:61440
  v_mfma_f32_16x16x32_bf16 v[104:107], a[132:135], v[148:151], v[104:107]
  v_exp_f32 v91, v91
  v_mfma_f32_16x16x32_bf16 v[104:107], a[128:131], v[144:147], v[104:107]
  ds_read_b128 a[156:159], v215 offset:61440
  v_cvt_pk_bf16_f32 v89, v90, v91
  v_mfma_f32_16x16x32_bf16 v[112:115], a[128:131], v[160:163], v[200:203]
  v_exp_f32 v68, v68
  v_mfma_f32_16x16x32_bf16 v[112:115], a[132:135], v[164:167], v[112:115]
  buffer_load_dwordx4 v235, s[12:15], s29 offen offset:3072 lds
  v_mfma_f32_16x16x32_bf16 v[112:115], a[136:139], v[168:171], v[112:115]
  v_exp_f32 v69, v69
  v_mfma_f32_16x16x32_bf16 v[112:115], a[140:143], v[172:175], v[112:115]
  v_cvt_pk_bf16_f32 v66, v68, v69
  v_mfma_f32_16x16x32_bf16 v[120:123], a[140:143], v[188:191], v[204:207]
  v_exp_f32 v70, v70
  v_mfma_f32_16x16x32_bf16 v[120:123], a[136:139], v[184:187], v[120:123]
  buffer_load_dword v254, off, s[24:27], s47 sc1
  v_mfma_f32_16x16x32_bf16 v[120:123], a[132:135], v[180:183], v[120:123]
  s_waitcnt lgkmcnt(0)
  v_exp_f32 v71, v71
  v_mfma_f32_16x16x32_bf16 v[120:123], a[128:131], v[176:179], v[120:123]
  v_cvt_pk_bf16_f32 v67, v70, v71
  v_mfma_f32_16x16x32_bf16 v[100:103], a[144:147], v[128:131], v[192:195]
  v_exp_f32 v76, v76
  v_mfma_f32_16x16x32_bf16 v[100:103], a[148:151], v[132:135], v[100:103]
  ds_read_b64_tr_b16 a[160:161], v216 offset:32768
  v_mfma_f32_16x16x32_bf16 v[100:103], a[152:155], v[136:139], v[100:103]
  v_exp_f32 v77, v77
  v_mfma_f32_16x16x32_bf16 v[100:103], a[156:159], v[140:143], v[100:103]
  ds_read_b64_tr_b16 a[162:163], v216 offset:36864
  v_cvt_pk_bf16_f32 v74, v76, v77
  v_mfma_f32_16x16x32_bf16 v[108:111], a[156:159], v[156:159], v[196:199]
  v_exp_f32 v78, v78
  v_mfma_f32_16x16x32_bf16 v[108:111], a[152:155], v[152:155], v[108:111]
  ds_read_b64_tr_b16 a[164:165], v216 offset:40960
  v_mfma_f32_16x16x32_bf16 v[108:111], a[148:151], v[148:151], v[108:111]
  v_exp_f32 v79, v79
  v_mfma_f32_16x16x32_bf16 v[108:111], a[144:147], v[144:147], v[108:111]
  ds_read_b64_tr_b16 a[166:167], v216 offset:45056
  v_cvt_pk_bf16_f32 v75, v78, v79
  v_mfma_f32_16x16x32_bf16 v[116:119], a[144:147], v[160:163], v[200:203]
  v_exp_f32 v84, v84
  v_mfma_f32_16x16x32_bf16 v[116:119], a[148:151], v[164:167], v[116:119]
  ds_read_b64_tr_b16 a[168:169], v217 offset:32768
  v_mfma_f32_16x16x32_bf16 v[116:119], a[152:155], v[168:171], v[116:119]
  v_exp_f32 v85, v85
  v_mfma_f32_16x16x32_bf16 v[116:119], a[156:159], v[172:175], v[116:119]
  ds_read_b64_tr_b16 a[170:171], v217 offset:36864
  v_cvt_pk_bf16_f32 v82, v84, v85
  v_mfma_f32_16x16x32_bf16 v[124:127], a[156:159], v[188:191], v[204:207]
  s_waitcnt vmcnt(20)
  v_exp_f32 v86, v86
  v_mfma_f32_16x16x32_bf16 v[124:127], a[152:155], v[184:187], v[124:127]
  ds_read_b64_tr_b16 a[172:173], v217 offset:40960
  ds_read_b64_tr_b16 a[232:233], v209 offset:5120
  v_mfma_f32_16x16x32_bf16 v[124:127], a[148:151], v[180:183], v[124:127]
  v_exp_f32 v87, v87
  v_mfma_f32_16x16x32_bf16 v[124:127], a[144:147], v[176:179], v[124:127]
  ds_read_b64_tr_b16 a[174:175], v217 offset:45056
  v_cvt_pk_bf16_f32 v83, v86, v87
  v_mfma_f32_16x16x32_bf16 a[192:195], a[208:211], v[0:3], a[192:195]
  v_exp_f32 v92, v92
  v_mfma_f32_16x16x32_bf16 a[192:195], a[208:211], v[32:35], a[192:195]
  ds_read_b64_tr_b16 a[176:177], v218 offset:32768
  ds_read_b64_tr_b16 a[234:235], v209 offset:5632
  v_mfma_f32_16x16x32_bf16 a[196:199], a[208:211], v[8:11], a[196:199]
  v_exp_f32 v93, v93
  v_mfma_f32_16x16x32_bf16 a[196:199], a[208:211], v[40:43], a[196:199]
  ds_read_b64_tr_b16 a[178:179], v218 offset:36864
  v_cvt_pk_bf16_f32 v90, v92, v93
  v_mfma_f32_16x16x32_bf16 a[200:203], a[208:211], v[16:19], a[200:203]
  v_exp_f32 v94, v94
  v_mfma_f32_16x16x32_bf16 a[200:203], a[208:211], v[48:51], a[200:203]
  ds_read_b64_tr_b16 a[180:181], v218 offset:40960
  v_mfma_f32_16x16x32_bf16 a[204:207], a[208:211], v[24:27], a[204:207]
  s_waitcnt lgkmcnt(9)
  v_exp_f32 v95, v95
  v_mfma_f32_16x16x32_bf16 a[204:207], a[208:211], v[56:59], a[204:207]
  ds_read_b64_tr_b16 a[182:183], v218 offset:45056
  v_cvt_pk_bf16_f32 v91, v94, v95
  v_mfma_f32_16x16x32_bf16 a[0:3], a[160:163], v[0:3], a[0:3]
  v_exp_f32 v96, v96
  v_mfma_f32_16x16x32_bf16 a[0:3], a[164:167], v[32:35], a[0:3]
  ds_read_b64_tr_b16 a[184:185], v219 offset:32768
  s_waitcnt lgkmcnt(4)
  buffer_store_dwordx4 a[232:235], v211, s[24:27], s31 offen sc1
  s_add_u32 s31, s31, 1024
  v_mfma_f32_16x16x32_bf16 a[4:7], a[164:167], v[40:43], a[4:7]
  v_exp_f32 v97, v97
  v_mfma_f32_16x16x32_bf16 a[4:7], a[160:163], v[8:11], a[4:7]
  ds_read_b64_tr_b16 a[186:187], v219 offset:36864
  v_cvt_pk_bf16_f32 v96, v96, v97
  v_mfma_f32_16x16x32_bf16 a[8:11], a[160:163], v[16:19], a[8:11]
  v_exp_f32 v98, v98
  v_mfma_f32_16x16x32_bf16 a[8:11], a[164:167], v[48:51], a[8:11]
  ds_read_b64_tr_b16 a[188:189], v219 offset:40960
  v_mfma_f32_16x16x32_bf16 a[12:15], a[164:167], v[56:59], a[12:15]
  v_exp_f32 v99, v99
  v_mfma_f32_16x16x32_bf16 a[12:15], a[160:163], v[24:27], a[12:15]
  ds_read_b64_tr_b16 a[190:191], v219 offset:45056
  v_cvt_pk_bf16_f32 v97, v98, v99
  v_mfma_f32_16x16x32_bf16 a[16:19], a[168:171], v[0:3], a[16:19]
  v_exp_f32 v104, v104
  v_mfma_f32_16x16x32_bf16 a[16:19], a[172:175], v[32:35], a[16:19]
  ds_read_b64_tr_b16 a[160:161], v220 offset:32768
  v_mfma_f32_16x16x32_bf16 a[20:23], a[172:175], v[40:43], a[20:23]
  v_exp_f32 v105, v105
  v_mfma_f32_16x16x32_bf16 a[20:23], a[168:171], v[8:11], a[20:23]
  ds_read_b64_tr_b16 a[162:163], v220 offset:36864
  v_cvt_pk_bf16_f32 v104, v104, v105
  v_mfma_f32_16x16x32_bf16 a[24:27], a[168:171], v[16:19], a[24:27]
  v_exp_f32 v106, v106
  v_mfma_f32_16x16x32_bf16 a[24:27], a[172:175], v[48:51], a[24:27]
  ds_read_b64_tr_b16 a[164:165], v220 offset:40960
  v_mfma_f32_16x16x32_bf16 a[28:31], a[172:175], v[56:59], a[28:31]
  s_waitcnt lgkmcnt(7)
  v_exp_f32 v107, v107
  v_mfma_f32_16x16x32_bf16 a[28:31], a[168:171], v[24:27], a[28:31]
  ds_read_b64_tr_b16 a[166:167], v220 offset:45056
  v_cvt_pk_bf16_f32 v105, v106, v107
  v_mfma_f32_16x16x32_bf16 a[32:35], a[176:179], v[0:3], a[32:35]
  v_exp_f32 v112, v112
  v_mfma_f32_16x16x32_bf16 a[32:35], a[180:183], v[32:35], a[32:35]
  ds_read_b64_tr_b16 a[168:169], v221 offset:32768
  v_mfma_f32_16x16x32_bf16 a[36:39], a[180:183], v[40:43], a[36:39]
  v_exp_f32 v113, v113
  v_mfma_f32_16x16x32_bf16 a[36:39], a[176:179], v[8:11], a[36:39]
  ds_read_b64_tr_b16 a[170:171], v221 offset:36864
  v_cvt_pk_bf16_f32 v112, v112, v113
  v_mfma_f32_16x16x32_bf16 a[40:43], a[176:179], v[16:19], a[40:43]
  v_exp_f32 v114, v114
  v_mfma_f32_16x16x32_bf16 a[40:43], a[180:183], v[48:51], a[40:43]
  ds_read_b64_tr_b16 a[172:173], v221 offset:40960
  v_mfma_f32_16x16x32_bf16 a[44:47], a[180:183], v[56:59], a[44:47]
  s_waitcnt lgkmcnt(7)
  v_exp_f32 v115, v115
  v_mfma_f32_16x16x32_bf16 a[44:47], a[176:179], v[24:27], a[44:47]
  ds_read_b64_tr_b16 a[174:175], v221 offset:45056
  v_cvt_pk_bf16_f32 v113, v114, v115
  v_mfma_f32_16x16x32_bf16 a[48:51], a[184:187], v[0:3], a[48:51]
  v_exp_f32 v120, v120
  v_mfma_f32_16x16x32_bf16 a[48:51], a[188:191], v[32:35], a[48:51]
  ds_read_b64_tr_b16 a[176:177], v222 offset:32768
  v_mfma_f32_16x16x32_bf16 a[52:55], a[188:191], v[40:43], a[52:55]
  v_exp_f32 v121, v121
  v_mfma_f32_16x16x32_bf16 a[52:55], a[184:187], v[8:11], a[52:55]
  ds_read_b64_tr_b16 a[178:179], v222 offset:36864
  v_cvt_pk_bf16_f32 v120, v120, v121
  v_mfma_f32_16x16x32_bf16 a[56:59], a[184:187], v[16:19], a[56:59]
  v_exp_f32 v122, v122
  v_mfma_f32_16x16x32_bf16 a[56:59], a[188:191], v[48:51], a[56:59]
  ds_read_b64_tr_b16 a[180:181], v222 offset:40960
  v_mfma_f32_16x16x32_bf16 a[60:63], a[188:191], v[56:59], a[60:63]
  s_waitcnt lgkmcnt(7)
  v_exp_f32 v123, v123
  v_mfma_f32_16x16x32_bf16 a[60:63], a[184:187], v[24:27], a[60:63]
  ds_read_b64_tr_b16 a[182:183], v222 offset:45056
  v_cvt_pk_bf16_f32 v121, v122, v123
  v_mfma_f32_16x16x32_bf16 a[64:67], a[160:163], v[0:3], a[64:67]
  v_exp_f32 v100, v100
  v_mfma_f32_16x16x32_bf16 a[64:67], a[164:167], v[32:35], a[64:67]
  ds_read_b64_tr_b16 a[184:185], v223 offset:32768
  v_mfma_f32_16x16x32_bf16 a[68:71], a[164:167], v[40:43], a[68:71]
  v_exp_f32 v101, v101
  v_mfma_f32_16x16x32_bf16 a[68:71], a[160:163], v[8:11], a[68:71]
  ds_read_b64_tr_b16 a[186:187], v223 offset:36864
  v_cvt_pk_bf16_f32 v98, v100, v101
  v_mfma_f32_16x16x32_bf16 a[72:75], a[160:163], v[16:19], a[72:75]
  v_exp_f32 v102, v102
  v_mfma_f32_16x16x32_bf16 a[72:75], a[164:167], v[48:51], a[72:75]
  ds_read_b64_tr_b16 a[188:189], v223 offset:40960
  v_mfma_f32_16x16x32_bf16 a[76:79], a[164:167], v[56:59], a[76:79]
  s_waitcnt lgkmcnt(7)
  v_exp_f32 v103, v103
  v_mfma_f32_16x16x32_bf16 a[76:79], a[160:163], v[24:27], a[76:79]
  ds_read_b64_tr_b16 a[190:191], v223 offset:45056
  v_cvt_pk_bf16_f32 v99, v102, v103
  v_mfma_f32_16x16x32_bf16 a[80:83], a[168:171], v[0:3], a[80:83]
  s_waitcnt vmcnt(12)
  v_exp_f32 v108, v108
  v_mfma_f32_16x16x32_bf16 a[80:83], a[172:175], v[32:35], a[80:83]
  v_mfma_f32_16x16x32_bf16 a[84:87], a[172:175], v[40:43], a[84:87]
  s_barrier
  v_exp_f32 v109, v109
  v_mfma_f32_16x16x32_bf16 a[84:87], a[168:171], v[8:11], a[84:87]
  ds_read_b128 a[128:131], v212 offset:0
  v_cvt_pk_bf16_f32 v106, v108, v109
  v_mfma_f32_16x16x32_bf16 a[88:91], a[168:171], v[16:19], a[88:91]
  v_exp_f32 v110, v110
  v_mfma_f32_16x16x32_bf16 a[88:91], a[172:175], v[48:51], a[88:91]
  ds_read_b128 a[132:135], v213 offset:0
  v_mfma_f32_16x16x32_bf16 a[92:95], a[172:175], v[56:59], a[92:95]
  s_waitcnt lgkmcnt(6)
  v_exp_f32 v111, v111
  v_mfma_f32_16x16x32_bf16 a[92:95], a[168:171], v[24:27], a[92:95]
  ds_read_b128 a[136:139], v214 offset:0
  v_cvt_pk_bf16_f32 v107, v110, v111
  v_mfma_f32_16x16x32_bf16 a[96:99], a[176:179], v[0:3], a[96:99]
  v_exp_f32 v116, v116
  v_mfma_f32_16x16x32_bf16 a[96:99], a[180:183], v[32:35], a[96:99]
  ds_read_b128 a[140:143], v215 offset:0
  v_mfma_f32_16x16x32_bf16 a[100:103], a[180:183], v[40:43], a[100:103]
  v_exp_f32 v117, v117
  v_mfma_f32_16x16x32_bf16 a[100:103], a[176:179], v[8:11], a[100:103]
  v_cvt_pk_bf16_f32 v114, v116, v117
  v_mfma_f32_16x16x32_bf16 a[104:107], a[176:179], v[16:19], a[104:107]
  v_exp_f32 v118, v118
  v_mfma_f32_16x16x32_bf16 a[104:107], a[180:183], v[48:51], a[104:107]
  v_mfma_f32_16x16x32_bf16 a[108:111], a[180:183], v[56:59], a[108:111]
  s_waitcnt lgkmcnt(4)
  v_exp_f32 v119, v119
  v_mfma_f32_16x16x32_bf16 a[108:111], a[176:179], v[24:27], a[108:111]
  v_cvt_pk_bf16_f32 v115, v118, v119
  v_mfma_f32_16x16x32_bf16 a[112:115], a[184:187], v[0:3], a[112:115]
  v_exp_f32 v124, v124
  v_mfma_f32_16x16x32_bf16 a[112:115], a[188:191], v[32:35], a[112:115]
  v_mfma_f32_16x16x32_bf16 a[116:119], a[188:191], v[40:43], a[116:119]
  s_sub_u32 s32, s32, 1
  v_exp_f32 v125, v125
  v_mfma_f32_16x16x32_bf16 a[116:119], a[184:187], v[8:11], a[116:119]
  v_cvt_pk_bf16_f32 v122, v124, v125
  v_mfma_f32_16x16x32_bf16 a[120:123], a[184:187], v[16:19], a[120:123]
  s_cmp_lg_u32 s32, 0
  v_exp_f32 v126, v126
  v_mfma_f32_16x16x32_bf16 a[120:123], a[188:191], v[48:51], a[120:123]
  v_mfma_f32_16x16x32_bf16 a[124:127], a[188:191], v[56:59], a[124:127]
  s_waitcnt lgkmcnt(0)
  v_exp_f32 v127, v127
  v_mfma_f32_16x16x32_bf16 a[124:127], a[184:187], v[24:27], a[124:127]
  v_cvt_pk_bf16_f32 v123, v126, v127
  s_cbranch_scc1 attn_loop
  ds_read_b64_tr_b16 a[160:161], v216 offset:49152
  ds_read_b64_tr_b16 a[162:163], v216 offset:53248
  ds_read_b64_tr_b16 a[164:165], v216 offset:57344
  ds_read_b64_tr_b16 a[166:167], v216 offset:61440
  ds_read_b64_tr_b16 a[168:169], v217 offset:49152
  ds_read_b64_tr_b16 a[170:171], v217 offset:53248
  ds_read_b64_tr_b16 a[172:173], v217 offset:57344
  ds_read_b64_tr_b16 a[174:175], v217 offset:61440
  s_waitcnt vmcnt(1)
  v_readfirstlane_b32 s38, v254
  s_nop 0
  s_cmp_ge_u32 s38, 512
  s_cbranch_scc1 attn_h_ready
  s_mov_b32 s39, 32768
attn_spin:
  s_sleep 4
  buffer_load_dword v254, off, s[24:27], s47 sc1
  s_waitcnt vmcnt(0)
  v_readfirstlane_b32 s38, v254
  s_nop 0
  s_cmp_ge_u32 s38, 512
  s_cbranch_scc1 attn_h_ready
  s_sub_u32 s39, s39, 1
  s_cmp_lg_u32 s39, 0
  s_cbranch_scc1 attn_spin
attn_h_ready:
  s_mov_b32 s48, 0x5d800000
  s_lshl_b32 s39, s3, 8
  v_mfma_f32_16x16x32_bf16 a[192:195], a[208:211], v[64:67], a[192:195]
  v_lshrrev_b32 v224, 4, v242
  v_and_b32 v225, 7, v224
  v_mfma_f32_16x16x32_bf16 a[192:195], a[208:211], v[96:99], a[192:195]
  v_mul_u32_u24 v225, 0xd80, v225
  v_lshrrev_b32 v224, 4, v224
  v_mfma_f32_16x16x32_bf16 a[196:199], a[208:211], v[72:75], a[196:199]
  v_lshl_add_u32 v225, v224, 4, v225
  v_mfma_f32_16x16x32_bf16 a[196:199], a[208:211], v[104:107], a[196:199]
  buffer_load_dwordx4 a[212:215], v225, s[24:27], s101 offen offset:0 sc1
  v_mfma_f32_16x16x32_bf16 a[200:203], a[208:211], v[80:83], a[200:203]
  buffer_load_dwordx4 a[216:219], v225, s[24:27], s101 offen offset:64 sc1
  v_mfma_f32_16x16x32_bf16 a[200:203], a[208:211], v[112:115], a[200:203]
  buffer_load_dwordx4 a[220:223], v225, s[24:27], s101 offen offset:128 sc1
  v_mfma_f32_16x16x32_bf16 a[204:207], a[208:211], v[88:91], a[204:207]
  v_mfma_f32_16x16x32_bf16 a[204:207], a[208:211], v[120:123], a[204:207]
  s_waitcnt lgkmcnt(4)
  v_mfma_f32_16x16x32_bf16 a[0:3], a[160:163], v[64:67], a[0:3]
  v_mfma_f32_16x16x32_bf16 a[0:3], a[164:167], v[96:99], a[0:3]
  ds_read_b64_tr_b16 a[176:177], v218 offset:49152
  v_mfma_f32_16x16x32_bf16 a[4:7], a[164:167], v[104:107], a[4:7]
  v_mfma_f32_16x16x32_bf16 a[4:7], a[160:163], v[72:75], a[4:7]
  ds_read_b64_tr_b16 a[178:179], v218 offset:53248
  v_accvgpr_read_b32 v208, a192
  v_mfma_f32_16x16x32_bf16 a[8:11], a[160:163], v[80:83], a[8:11]
  v_accvgpr_read_b32 v209, a196
  v_accvgpr_read_b32 v210, a200
  v_mfma_f32_16x16x32_bf16 a[8:11], a[164:167], v[112:115], a[8:11]
  ds_read_b64_tr_b16 a[180:181], v218 offset:57344
  v_accvgpr_read_b32 v211, a204
  v_mfma_f32_16x16x32_bf16 a[12:15], a[164:167], v[120:123], a[12:15]
  v_mov_b32 v245, v208
  v_mov_b32 v246, v209
  v_mfma_f32_16x16x32_bf16 a[12:15], a[160:163], v[88:91], a[12:15]
  ds_read_b64_tr_b16 a[182:183], v218 offset:61440
  s_waitcnt lgkmcnt(4)
  v_mov_b32 v247, v210
  v_mfma_f32_16x16x32_bf16 a[16:19], a[168:171], v[64:67], a[16:19]
  v_mov_b32 v248, v211
  v_permlane16_swap_b32 v208, v245
  v_mfma_f32_16x16x32_bf16 a[16:19], a[172:175], v[96:99], a[16:19]
  ds_read_b64_tr_b16 a[184:185], v219 offset:49152
  v_permlane16_swap_b32 v209, v246
  v_mfma_f32_16x16x32_bf16 a[20:23], a[172:175], v[104:107], a[20:23]
  v_permlane16_swap_b32 v210, v247
  v_permlane16_swap_b32 v211, v248
  v_mfma_f32_16x16x32_bf16 a[20:23], a[168:171], v[72:75], a[20:23]
  ds_read_b64_tr_b16 a[186:187], v219 offset:53248
  v_add_f32 v208, v208, v245
  v_mfma_f32_16x16x32_bf16 a[24:27], a[168:171], v[80:83], a[24:27]
  v_add_f32 v209, v209, v246
  v_add_f32 v210, v210, v247
  v_mfma_f32_16x16x32_bf16 a[24:27], a[172:175], v[112:115], a[24:27]
  ds_read_b64_tr_b16 a[188:189], v219 offset:57344
  v_add_f32 v211, v211, v248
  v_mfma_f32_16x16x32_bf16 a[28:31], a[172:175], v[120:123], a[28:31]
  v_mov_b32 v245, v208
  v_mov_b32 v246, v209
  v_mfma_f32_16x16x32_bf16 a[28:31], a[168:171], v[88:91], a[28:31]
  ds_read_b64_tr_b16 a[190:191], v219 offset:61440
  s_waitcnt lgkmcnt(4)
  v_mov_b32 v247, v210
  v_mfma_f32_16x16x32_bf16 a[32:35], a[176:179], v[64:67], a[32:35]
  v_mov_b32 v248, v211
  v_permlane32_swap_b32 v208, v245
  v_mfma_f32_16x16x32_bf16 a[32:35], a[180:183], v[96:99], a[32:35]
  ds_read_b64_tr_b16 a[160:161], v220 offset:49152
  v_permlane32_swap_b32 v209, v246
  v_mfma_f32_16x16x32_bf16 a[36:39], a[180:183], v[104:107], a[36:39]
  v_permlane32_swap_b32 v210, v247
  v_permlane32_swap_b32 v211, v248
  v_mfma_f32_16x16x32_bf16 a[36:39], a[176:179], v[72:75], a[36:39]
  ds_read_b64_tr_b16 a[162:163], v220 offset:53248
  v_add_f32 v208, v208, v245
  v_mfma_f32_16x16x32_bf16 a[40:43], a[176:179], v[80:83], a[40:43]
  v_add_f32 v209, v209, v246
  v_add_f32 v210, v210, v247
  v_mfma_f32_16x16x32_bf16 a[40:43], a[180:183], v[112:115], a[40:43]
  ds_read_b64_tr_b16 a[164:165], v220 offset:57344
  v_add_f32 v211, v211, v248
  v_mfma_f32_16x16x32_bf16 a[44:47], a[180:183], v[120:123], a[44:47]
  v_rcp_f32 v192, v208
  v_mfma_f32_16x16x32_bf16 a[44:47], a[176:179], v[88:91], a[44:47]
  ds_read_b64_tr_b16 a[166:167], v220 offset:61440
  s_waitcnt lgkmcnt(4)
  v_mfma_f32_16x16x32_bf16 a[48:51], a[184:187], v[64:67], a[48:51]
  v_rcp_f32 v196, v209
  v_mfma_f32_16x16x32_bf16 a[48:51], a[188:191], v[96:99], a[48:51]
  ds_read_b64_tr_b16 a[168:169], v221 offset:49152
  v_mfma_f32_16x16x32_bf16 a[52:55], a[188:191], v[104:107], a[52:55]
  v_rcp_f32 v200, v210
  v_mfma_f32_16x16x32_bf16 a[52:55], a[184:187], v[72:75], a[52:55]
  ds_read_b64_tr_b16 a[170:171], v221 offset:53248
  v_mfma_f32_16x16x32_bf16 a[56:59], a[184:187], v[80:83], a[56:59]
  v_rcp_f32 v204, v211
  v_mfma_f32_16x16x32_bf16 a[56:59], a[188:191], v[112:115], a[56:59]
  ds_read_b64_tr_b16 a[172:173], v221 offset:57344
  v_add_f32 v246, v208, v209
  v_mfma_f32_16x16x32_bf16 a[60:63], a[188:191], v[120:123], a[60:63]
  v_add_f32 v247, v210, v211
  v_add_f32 v246, v246, v247
  v_mfma_f32_16x16x32_bf16 a[60:63], a[184:187], v[88:91], a[60:63]
  ds_read_b64_tr_b16 a[174:175], v221 offset:61440
  s_waitcnt lgkmcnt(4)
  v_lshrrev_b32 v247, 2, v242
  v_mfma_f32_16x16x32_bf16 a[64:67], a[160:163], v[64:67], a[64:67]
  v_cmp_nlt_f32 vcc, v246, s48
  v_add_u32 v247, s39, v247
  v_mfma_f32_16x16x32_bf16 a[64:67], a[164:167], v[96:99], a[64:67]
  ds_read_b64_tr_b16 a[176:177], v222 offset:49152
  v_add_u32 v247, 157696, v247
  v_mfma_f32_16x16x32_bf16 a[68:71], a[164:167], v[104:107], a[68:71]
  v_cndmask_b32_e64 v245, 0, 1, vcc
  v_accvgpr_read_b32 v0, a0
  v_mfma_f32_16x16x32_bf16 a[68:71], a[160:163], v[72:75], a[68:71]
  ds_read_b64_tr_b16 a[178:179], v222 offset:53248
  v_accvgpr_read_b32 v1, a1
  v_mfma_f32_16x16x32_bf16 a[72:75], a[160:163], v[80:83], a[72:75]
  v_accvgpr_read_b32 v2, a2
  v_accvgpr_read_b32 v3, a3
  v_mfma_f32_16x16x32_bf16 a[72:75], a[164:167], v[112:115], a[72:75]
  ds_read_b64_tr_b16 a[180:181], v222 offset:57344
  v_accvgpr_read_b32 v4, a16
  v_mfma_f32_16x16x32_bf16 a[76:79], a[164:167], v[120:123], a[76:79]
  v_accvgpr_read_b32 v5, a17
  v_accvgpr_read_b32 v6, a18
  v_mfma_f32_16x16x32_bf16 a[76:79], a[160:163], v[88:91], a[76:79]
  ds_read_b64_tr_b16 a[182:183], v222 offset:61440
  s_waitcnt lgkmcnt(4)
  v_accvgpr_read_b32 v7, a19
  v_mfma_f32_16x16x32_bf16 a[80:83], a[168:171], v[64:67], a[80:83]
  v_mul_f32 v0, v0, v192
  v_mul_f32 v1, v1, v192
  v_mfma_f32_16x16x32_bf16 a[80:83], a[172:175], v[96:99], a[80:83]
  ds_read_b64_tr_b16 a[184:185], v223 offset:49152
  v_mul_f32 v2, v2, v192
  v_mfma_f32_16x16x32_bf16 a[84:87], a[172:175], v[104:107], a[84:87]
  v_mul_f32 v3, v3, v192
  v_mul_f32 v4, v4, v192
  v_mfma_f32_16x16x32_bf16 a[84:87], a[168:171], v[72:75], a[84:87]
  ds_read_b64_tr_b16 a[186:187], v223 offset:53248
  v_mul_f32 v5, v5, v192
  v_mfma_f32_16x16x32_bf16 a[88:91], a[168:171], v[80:83], a[88:91]
  v_mul_f32 v6, v6, v192
  v_mul_f32 v7, v7, v192
  v_mfma_f32_16x16x32_bf16 a[88:91], a[172:175], v[112:115], a[88:91]
  ds_read_b64_tr_b16 a[188:189], v223 offset:57344
  v_cvt_pk_bf16_f32 v0, v0, v1
  v_mfma_f32_16x16x32_bf16 a[92:95], a[172:175], v[120:123], a[92:95]
  v_cvt_pk_bf16_f32 v1, v2, v3
  v_cvt_pk_bf16_f32 v2, v4, v5
  v_mfma_f32_16x16x32_bf16 a[92:95], a[168:171], v[88:91], a[92:95]
  ds_read_b64_tr_b16 a[190:191], v223 offset:61440
  s_waitcnt lgkmcnt(4)
  v_cvt_pk_bf16_f32 v3, v6, v7
  v_mfma_f32_16x16x32_bf16 a[96:99], a[176:179], v[64:67], a[96:99]
  buffer_store_dwordx4 v[0:3], v244, s[24:27], s40 offen offset:0 sc1
  v_mfma_f32_16x16x32_bf16 a[96:99], a[180:183], v[96:99], a[96:99]
  v_accvgpr_read_b32 v8, a4
  v_accvgpr_read_b32 v9, a5
  v_mfma_f32_16x16x32_bf16 a[100:103], a[180:183], v[104:107], a[100:103]
  v_accvgpr_read_b32 v10, a6
  v_accvgpr_read_b32 v11, a7
  v_mfma_f32_16x16x32_bf16 a[100:103], a[176:179], v[72:75], a[100:103]
  v_accvgpr_read_b32 v12, a20
  v_accvgpr_read_b32 v13, a21
  v_mfma_f32_16x16x32_bf16 a[104:107], a[176:179], v[80:83], a[104:107]
  v_accvgpr_read_b32 v14, a22
  v_accvgpr_read_b32 v15, a23
  v_mfma_f32_16x16x32_bf16 a[104:107], a[180:183], v[112:115], a[104:107]
  v_mul_f32 v8, v8, v196
  v_mul_f32 v9, v9, v196
  v_mfma_f32_16x16x32_bf16 a[108:111], a[180:183], v[120:123], a[108:111]
  v_mul_f32 v10, v10, v196
  v_mul_f32 v11, v11, v196
  v_mfma_f32_16x16x32_bf16 a[108:111], a[176:179], v[88:91], a[108:111]
  s_waitcnt lgkmcnt(0)
  v_mul_f32 v12, v12, v196
  v_mul_f32 v13, v13, v196
  v_mfma_f32_16x16x32_bf16 a[112:115], a[184:187], v[64:67], a[112:115]
  v_mul_f32 v14, v14, v196
  v_mul_f32 v15, v15, v196
  v_mfma_f32_16x16x32_bf16 a[112:115], a[188:191], v[96:99], a[112:115]
  v_cvt_pk_bf16_f32 v8, v8, v9
  v_cvt_pk_bf16_f32 v9, v10, v11
  v_mfma_f32_16x16x32_bf16 a[116:119], a[188:191], v[104:107], a[116:119]
  v_cvt_pk_bf16_f32 v10, v12, v13
  v_cvt_pk_bf16_f32 v11, v14, v15
  v_mfma_f32_16x16x32_bf16 a[116:119], a[184:187], v[72:75], a[116:119]
  buffer_store_dwordx4 v[8:11], v244, s[24:27], s40 offen offset:2048 sc1
  v_mfma_f32_16x16x32_bf16 a[120:123], a[184:187], v[80:83], a[120:123]
  v_accvgpr_read_b32 v16, a8
  v_accvgpr_read_b32 v17, a9
  v_mfma_f32_16x16x32_bf16 a[120:123], a[188:191], v[112:115], a[120:123]
  v_accvgpr_read_b32 v18, a10
  v_accvgpr_read_b32 v19, a11
  v_mfma_f32_16x16x32_bf16 a[124:127], a[188:191], v[120:123], a[124:127]
  v_accvgpr_read_b32 v20, a24
  v_accvgpr_read_b32 v21, a25
  v_mfma_f32_16x16x32_bf16 a[124:127], a[184:187], v[88:91], a[124:127]
  v_accvgpr_read_b32 v22, a26
  v_accvgpr_read_b32 v23, a27
  v_pk_mul_f32 v[16:17], v[16:17], v[200:201] op_sel_hi:[1,0]
  v_pk_mul_f32 v[18:19], v[18:19], v[200:201] op_sel_hi:[1,0]
  v_pk_mul_f32 v[20:21], v[20:21], v[200:201] op_sel_hi:[1,0]
  v_pk_mul_f32 v[22:23], v[22:23], v[200:201] op_sel_hi:[1,0]
  v_cvt_pk_bf16_f32 v16, v16, v17
  v_cvt_pk_bf16_f32 v17, v18, v19
  v_cvt_pk_bf16_f32 v18, v20, v21
  v_cvt_pk_bf16_f32 v19, v22, v23
  buffer_store_dwordx4 v[16:19], v244, s[24:27], s41 offen offset:0 sc1
  v_accvgpr_read_b32 v24, a12
  v_accvgpr_read_b32 v25, a13
  v_accvgpr_read_b32 v26, a14
  v_accvgpr_read_b32 v27, a15
  v_accvgpr_read_b32 v28, a28
  v_accvgpr_read_b32 v29, a29
  v_accvgpr_read_b32 v30, a30
  v_accvgpr_read_b32 v31, a31
  v_pk_mul_f32 v[24:25], v[24:25], v[204:205] op_sel_hi:[1,0]
  v_pk_mul_f32 v[26:27], v[26:27], v[204:205] op_sel_hi:[1,0]
  v_pk_mul_f32 v[28:29], v[28:29], v[204:205] op_sel_hi:[1,0]
  v_pk_mul_f32 v[30:31], v[30:31], v[204:205] op_sel_hi:[1,0]
  v_cvt_pk_bf16_f32 v24, v24, v25
  v_cvt_pk_bf16_f32 v25, v26, v27
  v_cvt_pk_bf16_f32 v26, v28, v29
  v_cvt_pk_bf16_f32 v27, v30, v31
  buffer_store_dwordx4 v[24:27], v244, s[24:27], s41 offen offset:2048 sc1
  v_accvgpr_read_b32 v32, a32
  v_accvgpr_read_b32 v33, a33
  v_accvgpr_read_b32 v34, a34
  v_accvgpr_read_b32 v35, a35
  v_accvgpr_read_b32 v36, a48
  v_accvgpr_read_b32 v37, a49
  v_accvgpr_read_b32 v38, a50
  v_accvgpr_read_b32 v39, a51
  v_pk_mul_f32 v[32:33], v[32:33], v[192:193] op_sel_hi:[1,0]
  v_pk_mul_f32 v[34:35], v[34:35], v[192:193] op_sel_hi:[1,0]
  v_pk_mul_f32 v[36:37], v[36:37], v[192:193] op_sel_hi:[1,0]
  v_pk_mul_f32 v[38:39], v[38:39], v[192:193] op_sel_hi:[1,0]
  v_cvt_pk_bf16_f32 v32, v32, v33
  v_cvt_pk_bf16_f32 v33, v34, v35
  v_cvt_pk_bf16_f32 v34, v36, v37
  v_cvt_pk_bf16_f32 v35, v38, v39
  buffer_store_dwordx4 v[32:35], v244, s[24:27], s40 offen offset:1024 sc1
  v_accvgpr_read_b32 v40, a36
  v_accvgpr_read_b32 v41, a37
  v_accvgpr_read_b32 v42, a38
  v_accvgpr_read_b32 v43, a39
  v_accvgpr_read_b32 v44, a52
  v_accvgpr_read_b32 v45, a53
  v_accvgpr_read_b32 v46, a54
  v_accvgpr_read_b32 v47, a55
  v_pk_mul_f32 v[40:41], v[40:41], v[196:197] op_sel_hi:[1,0]
  v_pk_mul_f32 v[42:43], v[42:43], v[196:197] op_sel_hi:[1,0]
  v_pk_mul_f32 v[44:45], v[44:45], v[196:197] op_sel_hi:[1,0]
  v_pk_mul_f32 v[46:47], v[46:47], v[196:197] op_sel_hi:[1,0]
  v_cvt_pk_bf16_f32 v40, v40, v41
  v_cvt_pk_bf16_f32 v41, v42, v43
  v_cvt_pk_bf16_f32 v42, v44, v45
  v_cvt_pk_bf16_f32 v43, v46, v47
  buffer_store_dwordx4 v[40:43], v244, s[24:27], s40 offen offset:3072 sc1
  v_accvgpr_read_b32 v48, a40
  v_accvgpr_read_b32 v49, a41
  v_accvgpr_read_b32 v50, a42
  v_accvgpr_read_b32 v51, a43
  v_accvgpr_read_b32 v52, a56
  v_accvgpr_read_b32 v53, a57
  v_accvgpr_read_b32 v54, a58
  v_accvgpr_read_b32 v55, a59
  v_pk_mul_f32 v[48:49], v[48:49], v[200:201] op_sel_hi:[1,0]
  v_pk_mul_f32 v[50:51], v[50:51], v[200:201] op_sel_hi:[1,0]
  v_pk_mul_f32 v[52:53], v[52:53], v[200:201] op_sel_hi:[1,0]
  v_pk_mul_f32 v[54:55], v[54:55], v[200:201] op_sel_hi:[1,0]
  v_cvt_pk_bf16_f32 v48, v48, v49
  v_cvt_pk_bf16_f32 v49, v50, v51
  v_cvt_pk_bf16_f32 v50, v52, v53
  v_cvt_pk_bf16_f32 v51, v54, v55
  buffer_store_dwordx4 v[48:51], v244, s[24:27], s41 offen offset:1024 sc1
  v_accvgpr_read_b32 v56, a44
  v_accvgpr_read_b32 v57, a45
  v_accvgpr_read_b32 v58, a46
  v_accvgpr_read_b32 v59, a47
  v_accvgpr_read_b32 v60, a60
  v_accvgpr_read_b32 v61, a61
  v_accvgpr_read_b32 v62, a62
  v_accvgpr_read_b32 v63, a63
  v_pk_mul_f32 v[56:57], v[56:57], v[204:205] op_sel_hi:[1,0]
  v_pk_mul_f32 v[58:59], v[58:59], v[204:205] op_sel_hi:[1,0]
  v_pk_mul_f32 v[60:61], v[60:61], v[204:205] op_sel_hi:[1,0]
  v_pk_mul_f32 v[62:63], v[62:63], v[204:205] op_sel_hi:[1,0]
  v_cvt_pk_bf16_f32 v56, v56, v57
  v_cvt_pk_bf16_f32 v57, v58, v59
  v_cvt_pk_bf16_f32 v58, v60, v61
  v_cvt_pk_bf16_f32 v59, v62, v63
  buffer_store_dwordx4 v[56:59], v244, s[24:27], s41 offen offset:3072 sc1
  v_accvgpr_read_b32 v0, a64
  v_accvgpr_read_b32 v1, a65
  v_accvgpr_read_b32 v2, a66
  v_accvgpr_read_b32 v3, a67
  v_accvgpr_read_b32 v4, a80
  v_accvgpr_read_b32 v5, a81
  v_accvgpr_read_b32 v6, a82
  v_accvgpr_read_b32 v7, a83
  v_pk_mul_f32 v[0:1], v[0:1], v[192:193] op_sel_hi:[1,0]
  v_pk_mul_f32 v[2:3], v[2:3], v[192:193] op_sel_hi:[1,0]
  v_pk_mul_f32 v[4:5], v[4:5], v[192:193] op_sel_hi:[1,0]
  v_pk_mul_f32 v[6:7], v[6:7], v[192:193] op_sel_hi:[1,0]
  v_cvt_pk_bf16_f32 v0, v0, v1
  v_cvt_pk_bf16_f32 v1, v2, v3
  v_cvt_pk_bf16_f32 v2, v4, v5
  v_cvt_pk_bf16_f32 v3, v6, v7
  buffer_store_dwordx4 v[0:3], v244, s[24:27], s42 offen offset:0 sc1
  v_accvgpr_read_b32 v8, a68
  v_accvgpr_read_b32 v9, a69
  v_accvgpr_read_b32 v10, a70
  v_accvgpr_read_b32 v11, a71
  v_accvgpr_read_b32 v12, a84
  v_accvgpr_read_b32 v13, a85
  v_accvgpr_read_b32 v14, a86
  v_accvgpr_read_b32 v15, a87
  v_pk_mul_f32 v[8:9], v[8:9], v[196:197] op_sel_hi:[1,0]
  v_pk_mul_f32 v[10:11], v[10:11], v[196:197] op_sel_hi:[1,0]
  v_pk_mul_f32 v[12:13], v[12:13], v[196:197] op_sel_hi:[1,0]
  v_pk_mul_f32 v[14:15], v[14:15], v[196:197] op_sel_hi:[1,0]
  v_cvt_pk_bf16_f32 v8, v8, v9
  v_cvt_pk_bf16_f32 v9, v10, v11
  v_cvt_pk_bf16_f32 v10, v12, v13
  v_cvt_pk_bf16_f32 v11, v14, v15
  buffer_store_dwordx4 v[8:11], v244, s[24:27], s42 offen offset:2048 sc1
  v_accvgpr_read_b32 v16, a72
  v_accvgpr_read_b32 v17, a73
  v_accvgpr_read_b32 v18, a74
  v_accvgpr_read_b32 v19, a75
  v_accvgpr_read_b32 v20, a88
  v_accvgpr_read_b32 v21, a89
  v_accvgpr_read_b32 v22, a90
  v_accvgpr_read_b32 v23, a91
  v_pk_mul_f32 v[16:17], v[16:17], v[200:201] op_sel_hi:[1,0]
  v_pk_mul_f32 v[18:19], v[18:19], v[200:201] op_sel_hi:[1,0]
  v_pk_mul_f32 v[20:21], v[20:21], v[200:201] op_sel_hi:[1,0]
  v_pk_mul_f32 v[22:23], v[22:23], v[200:201] op_sel_hi:[1,0]
  v_cvt_pk_bf16_f32 v16, v16, v17
  v_cvt_pk_bf16_f32 v17, v18, v19
  v_cvt_pk_bf16_f32 v18, v20, v21
  v_cvt_pk_bf16_f32 v19, v22, v23
  buffer_store_dwordx4 v[16:19], v244, s[24:27], s43 offen offset:0 sc1
  v_accvgpr_read_b32 v24, a76
  v_accvgpr_read_b32 v25, a77
  v_accvgpr_read_b32 v26, a78
  v_accvgpr_read_b32 v27, a79
  v_accvgpr_read_b32 v28, a92
  v_accvgpr_read_b32 v29, a93
  v_accvgpr_read_b32 v30, a94
  v_accvgpr_read_b32 v31, a95
  v_pk_mul_f32 v[24:25], v[24:25], v[204:205] op_sel_hi:[1,0]
  v_pk_mul_f32 v[26:27], v[26:27], v[204:205] op_sel_hi:[1,0]
  v_pk_mul_f32 v[28:29], v[28:29], v[204:205] op_sel_hi:[1,0]
  v_pk_mul_f32 v[30:31], v[30:31], v[204:205] op_sel_hi:[1,0]
  v_cvt_pk_bf16_f32 v24, v24, v25
  v_cvt_pk_bf16_f32 v25, v26, v27
  v_cvt_pk_bf16_f32 v26, v28, v29
  v_cvt_pk_bf16_f32 v27, v30, v31
  buffer_store_dwordx4 v[24:27], v244, s[24:27], s43 offen offset:2048 sc1
  v_accvgpr_read_b32 v32, a96
  v_accvgpr_read_b32 v33, a97
  v_accvgpr_read_b32 v34, a98
  v_accvgpr_read_b32 v35, a99
  v_accvgpr_read_b32 v36, a112
  v_accvgpr_read_b32 v37, a113
  v_accvgpr_read_b32 v38, a114
  v_accvgpr_read_b32 v39, a115
  v_pk_mul_f32 v[32:33], v[32:33], v[192:193] op_sel_hi:[1,0]
  v_pk_mul_f32 v[34:35], v[34:35], v[192:193] op_sel_hi:[1,0]
  v_pk_mul_f32 v[36:37], v[36:37], v[192:193] op_sel_hi:[1,0]
  v_pk_mul_f32 v[38:39], v[38:39], v[192:193] op_sel_hi:[1,0]
  v_cvt_pk_bf16_f32 v32, v32, v33
  v_cvt_pk_bf16_f32 v33, v34, v35
  v_cvt_pk_bf16_f32 v34, v36, v37
  v_cvt_pk_bf16_f32 v35, v38, v39
  buffer_store_dwordx4 v[32:35], v244, s[24:27], s42 offen offset:1024 sc1
  v_accvgpr_read_b32 v40, a100
  v_accvgpr_read_b32 v41, a101
  v_accvgpr_read_b32 v42, a102
  v_accvgpr_read_b32 v43, a103
  v_accvgpr_read_b32 v44, a116
  v_accvgpr_read_b32 v45, a117
  v_accvgpr_read_b32 v46, a118
  v_accvgpr_read_b32 v47, a119
  v_pk_mul_f32 v[40:41], v[40:41], v[196:197] op_sel_hi:[1,0]
  v_pk_mul_f32 v[42:43], v[42:43], v[196:197] op_sel_hi:[1,0]
  v_pk_mul_f32 v[44:45], v[44:45], v[196:197] op_sel_hi:[1,0]
  v_pk_mul_f32 v[46:47], v[46:47], v[196:197] op_sel_hi:[1,0]
  v_cvt_pk_bf16_f32 v40, v40, v41
  v_cvt_pk_bf16_f32 v41, v42, v43
  v_cvt_pk_bf16_f32 v42, v44, v45
  v_cvt_pk_bf16_f32 v43, v46, v47
  buffer_store_dwordx4 v[40:43], v244, s[24:27], s42 offen offset:3072 sc1
  v_accvgpr_read_b32 v48, a104
  v_accvgpr_read_b32 v49, a105
  v_accvgpr_read_b32 v50, a106
  v_accvgpr_read_b32 v51, a107
  v_accvgpr_read_b32 v52, a120
  v_accvgpr_read_b32 v53, a121
  v_accvgpr_read_b32 v54, a122
  v_accvgpr_read_b32 v55, a123
  v_pk_mul_f32 v[48:49], v[48:49], v[200:201] op_sel_hi:[1,0]
  v_pk_mul_f32 v[50:51], v[50:51], v[200:201] op_sel_hi:[1,0]
  v_pk_mul_f32 v[52:53], v[52:53], v[200:201] op_sel_hi:[1,0]
  v_pk_mul_f32 v[54:55], v[54:55], v[200:201] op_sel_hi:[1,0]
  v_cvt_pk_bf16_f32 v48, v48, v49
  v_cvt_pk_bf16_f32 v49, v50, v51
  v_cvt_pk_bf16_f32 v50, v52, v53
  v_cvt_pk_bf16_f32 v51, v54, v55
  buffer_store_dwordx4 v[48:51], v244, s[24:27], s43 offen offset:1024 sc1
  v_accvgpr_read_b32 v56, a108
  v_accvgpr_read_b32 v57, a109
  v_accvgpr_read_b32 v58, a110
  v_accvgpr_read_b32 v59, a111
  v_accvgpr_read_b32 v60, a124
  v_accvgpr_read_b32 v61, a125
  v_accvgpr_read_b32 v62, a126
  v_accvgpr_read_b32 v63, a127
  v_pk_mul_f32 v[56:57], v[56:57], v[204:205] op_sel_hi:[1,0]
  v_pk_mul_f32 v[58:59], v[58:59], v[204:205] op_sel_hi:[1,0]
  v_pk_mul_f32 v[60:61], v[60:61], v[204:205] op_sel_hi:[1,0]
  v_pk_mul_f32 v[62:63], v[62:63], v[204:205] op_sel_hi:[1,0]
  v_cvt_pk_bf16_f32 v56, v56, v57
  v_cvt_pk_bf16_f32 v57, v58, v59
  v_cvt_pk_bf16_f32 v58, v60, v61
  v_cvt_pk_bf16_f32 v59, v62, v63
  buffer_store_dwordx4 v[56:59], v244, s[24:27], s43 offen offset:3072 sc1
  ds_write_b32 v247, v245
  v_lshrrev_b32 v224, 4, v242
  v_lshrrev_b32 v225, 4, v224
  v_bfe_u32 v226, v224, 2, 2
  v_lshl_add_u32 v225, v225, 3, v226
  v_lshlrev_b32 v225, 5, v225
  v_and_b32 v226, 3, v224
  v_lshl_add_u32 v225, v226, 3, v225
  v_add_u32 v225, s50, v225
  s_waitcnt vmcnt(16)
  ds_read_b64_tr_b16 a[232:233], v225 offset:0
  ds_read_b64_tr_b16 a[234:235], v225 offset:128
  ds_read_b64_tr_b16 a[236:237], v225 offset:1024
  ds_read_b64_tr_b16 a[238:239], v225 offset:1152
  ds_read_b64_tr_b16 a[240:241], v225 offset:2048
  ds_read_b64_tr_b16 a[242:243], v225 offset:2176
  s_waitcnt lgkmcnt(0)
  v_mfma_f32_16x16x32_bf16 v[228:231], a[232:235], a[212:215], 0
  v_mfma_f32_16x16x32_bf16 v[228:231], a[236:239], a[216:219], v[228:231]
  v_mfma_f32_16x16x32_bf16 v[228:231], a[240:243], a[220:223], v[228:231]
  s_lshl_b32 s35, s3, 10
  s_add_u32 s35, s35, 159744
  v_add_u32 v224, s35, v242
  s_nop 4
  ds_write_b128 v224, v[228:231]
  s_waitcnt lgkmcnt(0)
  v_lshlrev_b32 v246, 0, v242
  v_add_u32 v246, 157696, v246
  s_waitcnt lgkmcnt(0)
  s_barrier
  ds_read_b128 v[248:251], v246
  v_add_u32 v224, 159744, v242
  ds_read_b128 v[64:67], v224 offset:0
  ds_read_b128 v[68:71], v224 offset:1024
  ds_read_b128 v[72:75], v224 offset:2048
  v_lshrrev_b32 v224, 4, v242
  s_cmp_eq_u32 s3, 0
  s_cselect_b32 s35, 0, 1073741824
  v_and_b32 v225, 7, v224
  v_mul_u32_u24 v225, 0xa00, v225
  v_lshrrev_b32 v226, 4, v224
  v_lshl_add_u32 v225, v226, 4, v225
  v_bfe_u32 v226, v224, 3, 1
  v_lshl_add_u32 v225, v226, 30, v225
  v_or_b32 v225, s35, v225
  s_mul_i32 s35, s98, 20480
  s_lshl_b32 s38, s99, 6
  s_add_u32 s35, s35, s38
  s_add_u32 s35, s35, 2686976
  s_waitcnt lgkmcnt(1)
  v_add_f32 v64, v64, v68
  v_add_f32 v65, v65, v69
  v_add_f32 v66, v66, v70
  v_add_f32 v67, v67, v71
  s_waitcnt lgkmcnt(0)
  v_add_f32 v64, v64, v72
  v_add_f32 v65, v65, v73
  v_add_f32 v66, v66, v74
  v_add_f32 v67, v67, v75
  buffer_store_dwordx4 v[64:67], v225, s[24:27], s35 offen sc1
  v_or3_b32 v248, v248, v249, v250
  v_or_b32 v248, v248, v251
  v_cmp_ne_u32 vcc, 0, v248
  s_nop 0
  s_cbranch_vccnz attn_redo
tail_go:
  s_and_b32 s36, s2, 1
  s_bfe_u32 s28, s2, 0x20001
  s_lshl_b32 s28, s28, 2
  s_bfe_u32 s38, s2, 0x20003
  s_add_u32 s28, s28, s38
  s_lshr_b32 s29, s2, 5
  v_mov_b32 v114, v242
  v_add_u32 v115, 0x1000, v114
  v_add_u32 v116, 0x2000, v114
  s_lshl_b32 s38, s36, 2
  s_add_u32 s38, s38, s3
  s_mul_i32 s39, s38, 81920
  s_lshl_b32 s30, s38, 16
  s_mul_i32 s31, s29, 655360
  s_add_u32 s31, s31, s39
  s_add_u32 s31, s31, 3145728
  s_mul_i32 s33, s3, 24576
  s_add_u32 s33, s33, 4096
  s_add_u32 s4, s31, 0
  s_add_u32 s5, s31, 12288
  s_add_u32 s6, s31, 24576
  s_add_u32 s7, s31, 36864
  s_add_u32 s8, s31, 49152
  s_add_u32 s9, s31, 61440
  s_add_u32 s10, s31, 73728
  buffer_load_dwordx4 v[176:179], v114, s[24:27], s4 offen offset:0 sc1
  buffer_load_dwordx4 v[180:183], v114, s[24:27], s4 offen offset:1024 sc1
  buffer_load_dwordx4 v[184:187], v114, s[24:27], s4 offen offset:2048 sc1
  buffer_load_dwordx4 v[188:191], v114, s[24:27], s4 offen offset:3072 sc1
  buffer_load_dwordx4 v[192:195], v115, s[24:27], s4 offen offset:0 sc1
  buffer_load_dwordx4 v[196:199], v115, s[24:27], s4 offen offset:1024 sc1
  buffer_load_dwordx4 v[200:203], v115, s[24:27], s4 offen offset:2048 sc1
  buffer_load_dwordx4 v[204:207], v115, s[24:27], s4 offen offset:3072 sc1
  buffer_load_dwordx4 v[208:211], v116, s[24:27], s4 offen offset:0 sc1
  buffer_load_dwordx4 v[212:215], v116, s[24:27], s4 offen offset:1024 sc1
  buffer_load_dwordx4 v[216:219], v116, s[24:27], s4 offen offset:2048 sc1
  buffer_load_dwordx4 v[220:223], v116, s[24:27], s4 offen offset:3072 sc1
  buffer_load_dwordx4 v[224:227], v114, s[24:27], s5 offen offset:0 sc1
  buffer_load_dwordx4 v[228:231], v114, s[24:27], s5 offen offset:1024 sc1
  buffer_load_dwordx4 v[232:235], v114, s[24:27], s5 offen offset:2048 sc1
  buffer_load_dwordx4 v[236:239], v114, s[24:27], s5 offen offset:3072 sc1
  buffer_load_dwordx4 v[240:243], v115, s[24:27], s5 offen offset:0 sc1
  buffer_load_dwordx4 v[244:247], v115, s[24:27], s5 offen offset:1024 sc1
  buffer_load_dwordx4 v[248:251], v115, s[24:27], s5 offen offset:2048 sc1
  buffer_load_dwordx4 v[252:255], v115, s[24:27], s5 offen offset:3072 sc1
  buffer_load_dwordx4 a[0:3], v116, s[24:27], s5 offen offset:0 sc1
  buffer_load_dwordx4 a[4:7], v116, s[24:27], s5 offen offset:1024 sc1
  buffer_load_dwordx4 a[8:11], v116, s[24:27], s5 offen offset:2048 sc1
  buffer_load_dwordx4 a[12:15], v116, s[24:27], s5 offen offset:3072 sc1
  buffer_load_dwordx4 a[16:19], v114, s[24:27], s6 offen offset:0 sc1
  buffer_load_dwordx4 a[20:23], v114, s[24:27], s6 offen offset:1024 sc1
  buffer_load_dwordx4 a[24:27], v114, s[24:27], s6 offen offset:2048 sc1
  buffer_load_dwordx4 a[28:31], v114, s[24:27], s6 offen offset:3072 sc1
  buffer_load_dwordx4 a[32:35], v115, s[24:27], s6 offen offset:0 sc1
  buffer_load_dwordx4 a[36:39], v115, s[24:27], s6 offen offset:1024 sc1
  v_lshrrev_b32 v125, 4, v114
  v_and_b32 v126, 15, v125
  v_lshrrev_b32 v127, 4, v125
  s_add_u32 s38, s3, 0
  s_and_b32 s38, s38, 3
  s_lshl_b32 s38, s38, 11
  v_add_u32 v110, s38, v114
  s_sub_u32 s38, s3, 0
  s_and_b32 s38, s38, 3
  s_mul_i32 s38, s38, 15360
  s_add_u32 s38, s38, 102400
  v_add_u32 v118, s38, v114
  s_add_u32 s38, s3, 1
  s_and_b32 s38, s38, 3
  s_lshl_b32 s38, s38, 11
  v_add_u32 v111, s38, v114
  s_sub_u32 s38, s3, 1
  s_and_b32 s38, s38, 3
  s_mul_i32 s38, s38, 15360
  s_add_u32 s38, s38, 102400
  v_add_u32 v119, s38, v114
  s_add_u32 s38, s3, 2
  s_and_b32 s38, s38, 3
  s_lshl_b32 s38, s38, 11
  v_add_u32 v112, s38, v114
  s_sub_u32 s38, s3, 2
  s_and_b32 s38, s38, 3
  s_mul_i32 s38, s38, 15360
  s_add_u32 s38, s38, 107520
  v_add_u32 v120, s38, v114
  s_add_u32 s38, s3, 3
  s_and_b32 s38, s38, 3
  s_lshl_b32 s38, s38, 11
  v_add_u32 v113, s38, v114
  s_sub_u32 s38, s3, 3
  s_and_b32 s38, s38, 3
  s_mul_i32 s38, s38, 15360
  s_add_u32 s38, s38, 112640
  v_add_u32 v121, s38, v114
  v_add_u32 v122, s33, v114
  s_and_b32 s38, s28, 14
  s_add_u32 s38, s38, s36
  s_lshl_b32 s38, s38, 8
  s_add_u32 s38, s38, 2818304
  s_lshl_b32 s39, s29, 8
  s_add_u32 s39, s39, 2822400
  v_mov_b32 v133, s38
  v_writelane_b32 v133, s39, 1
  v_mov_b32 v134, 16
  v_writelane_b32 v134, 30, 1
  s_lshl_b32 s28, s28, 1
  s_add_u32 s28, s28, s36
  s_add_u32 s30, s30, 8388608
  s_lshl_b32 s38, s28, 19
  s_add_u32 s37, s30, s38
  s_xor_b32 s38, s38, 0x80000
  s_add_u32 s30, s30, s38
  s_lshl_b32 s40, s29, 5
  s_add_u32 s40, s40, s28
  s_lshl_b32 s38, s28, 6
  s_lshl_b32 s39, s3, 4
  s_add_u32 s38, s38, s39
  v_add_u32 v128, s38, v126
  v_mul_u32_u24 v117, 0x500, v128
  v_lshl_add_u32 v117, v127, 3, v117
  s_mul_i32 s38, s29, 160
  v_add_u32 v117, s38, v117
  s_mov_b32 s12, s60
  s_mov_b32 s13, s61
  s_mov_b32 s14, 2621440
  s_mov_b32 s15, 0x20000
  s_mov_b32 s16, s62
  s_mov_b32 s17, s63
  s_mov_b32 s18, 2621440
  s_mov_b32 s19, 0x20000
  s_mul_i32 s38, s28, 81920
  s_lshl_b32 s39, s3, 10
  s_add_u32 s38, s38, s39
  s_mul_i32 s39, s29, 10
  v_lshrrev_b32 v129, 1, v127
  v_add_u32 v129, s39, v129
  v_and_b32 v130, 1, v127
  v_lshlrev_b32 v130, 3, v130
  v_lshl_add_u32 v130, v126, 4, v130
  v_lshrrev_b32 v131, 2, v129
  v_lshl_add_u32 v131, v131, 12, v130
  v_and_b32 v132, 3, v129
  v_lshl_add_u32 v131, v132, 8, v131
  buffer_load_dwordx2 v[156:157], v131, s[24:27], s38 offen sc1
  v_add_u32 v129, 2, v129
  buffer_load_dwordx2 v[80:81], v117, s[12:15], 0 offen offset:0
  v_lshrrev_b32 v131, 2, v129
  v_lshl_add_u32 v131, v131, 12, v130
  v_and_b32 v132, 3, v129
  v_lshl_add_u32 v131, v132, 8, v131
  buffer_load_dwordx2 v[158:159], v131, s[24:27], s38 offen sc1
  v_add_u32 v129, 2, v129
  buffer_load_dwordx2 v[82:83], v117, s[12:15], 0 offen offset:32
  v_lshrrev_b32 v131, 2, v129
  v_lshl_add_u32 v131, v131, 12, v130
  v_and_b32 v132, 3, v129
  v_lshl_add_u32 v131, v132, 8, v131
  buffer_load_dwordx2 v[160:161], v131, s[24:27], s38 offen sc1
  v_add_u32 v129, 2, v129
  buffer_load_dwordx2 v[84:85], v117, s[12:15], 0 offen offset:64
  v_lshrrev_b32 v131, 2, v129
  v_lshl_add_u32 v131, v131, 12, v130
  v_and_b32 v132, 3, v129
  v_lshl_add_u32 v131, v132, 8, v131
  buffer_load_dwordx2 v[162:163], v131, s[24:27], s38 offen sc1
  v_add_u32 v129, 2, v129
  buffer_load_dwordx2 v[86:87], v117, s[12:15], 0 offen offset:96
  v_lshrrev_b32 v131, 2, v129
  v_lshl_add_u32 v131, v131, 12, v130
  v_and_b32 v132, 3, v129
  v_lshl_add_u32 v131, v132, 8, v131
  buffer_load_dwordx2 v[164:165], v131, s[24:27], s38 offen sc1
  v_add_u32 v129, 2, v129
  buffer_load_dwordx2 v[88:89], v117, s[12:15], 0 offen offset:128
  v_mov_b32 v123, 1073741824
  v_bfrev_b32 v124, 1
  v_sub_u32 v128, 0xffff, v128
  s_mov_b32 s34, 0xffff0000
  s_and_b32 s38, s52, 0xffff
  v_cmp_eq_u32 vcc, s38, v128
  v_mov_b32 v129, s52
  v_mov_b32 v130, 0
  v_cndmask_b32 v124, v124, v129, vcc
  v_cndmask_b32 v123, v123, v130, vcc
  s_and_b32 s38, s53, 0xffff
  v_cmp_eq_u32 vcc, s38, v128
  v_mov_b32 v129, s53
  v_mov_b32 v130, 2560
  v_cndmask_b32 v124, v124, v129, vcc
  v_cndmask_b32 v123, v123, v130, vcc
  s_and_b32 s38, s54, 0xffff
  v_cmp_eq_u32 vcc, s38, v128
  v_mov_b32 v129, s54
  v_mov_b32 v130, 5120
  v_cndmask_b32 v124, v124, v129, vcc
  v_cndmask_b32 v123, v123, v130, vcc
  s_and_b32 s38, s55, 0xffff
  v_cmp_eq_u32 vcc, s38, v128
  v_mov_b32 v129, s55
  v_mov_b32 v130, 7680
  v_cndmask_b32 v124, v124, v129, vcc
  v_cndmask_b32 v123, v123, v130, vcc
  s_and_b32 s38, s56, 0xffff
  v_cmp_eq_u32 vcc, s38, v128
  v_mov_b32 v129, s56
  v_mov_b32 v130, 10240
  v_cndmask_b32 v124, v124, v129, vcc
  v_cndmask_b32 v123, v123, v130, vcc
  s_and_b32 s38, s57, 0xffff
  v_cmp_eq_u32 vcc, s38, v128
  v_mov_b32 v129, s57
  v_mov_b32 v130, 12800
  v_cndmask_b32 v124, v124, v129, vcc
  v_cndmask_b32 v123, v123, v130, vcc
  s_and_b32 s38, s58, 0xffff
  v_cmp_eq_u32 vcc, s38, v128
  v_mov_b32 v129, s58
  v_mov_b32 v130, 15360
  v_cndmask_b32 v124, v124, v129, vcc
  v_cndmask_b32 v123, v123, v130, vcc
  s_and_b32 s38, s59, 0xffff
  v_cmp_eq_u32 vcc, s38, v128
  v_mov_b32 v129, s59
  v_mov_b32 v130, 17920
  v_cndmask_b32 v124, v124, v129, vcc
  v_cndmask_b32 v123, v123, v130, vcc
  v_lshl_add_u32 v123, v127, 4, v123
  s_mul_i32 s32, s29, 320
  s_add_u32 s32, s32, 2686976
  v_ashrrev_i32 v129, 31, v124
  v_not_b32 v129, v129
  v_or_b32 v129, 0x80000000, v129
  v_xor_b32 v124, v124, v129
  v_and_b32 v124, s34, v124
  v_mul_f32 v124, 0xbfb8aa3b, v124
  v_exp_f32 v124, v124
  s_nop 0
  v_add_f32 v124, 1.0, v124
  v_rcp_f32 v124, v124
  s_nop 0
  v_cvt_pk_bf16_f32 v124, v124, v124
  v_lshlrev_b32 v124, 16, v124
  s_xor_b32 s38, s40, 0
  s_lshl_b32 s38, s38, 2
  s_add_u32 s38, s38, s3
  s_lshl_b32 s38, s38, 13
  s_add_u32 s38, s38, 25165824
  s_add_u32 s39, s38, 4096
  buffer_load_dword v127, off, s[24:27], s39 offset:2048
  s_xor_b32 s38, s40, 1
  s_lshl_b32 s38, s38, 2
  s_add_u32 s38, s38, s3
  s_lshl_b32 s38, s38, 13
  s_add_u32 s38, s38, 25165824
  s_add_u32 s39, s38, 4096
  buffer_load_dword v127, off, s[24:27], s39 offset:2048
  s_bfe_u32 s38, s2, 0x40002
  s_lshl_b32 s38, s38, 8
  s_add_u32 s38, s38, 2818304
  s_mul_i32 s39, s99, 13108
  s_lshr_b32 s39, s39, 16
  s_lshl_b32 s39, s39, 8
  s_add_u32 s39, s39, 2822400
  s_cmp_lt_u32 s2, 240
  s_cselect_b32 s39, s39, 1073741824
  v_mov_b32 v135, 1073741824
  v_writelane_b32 v135, s38, 0
  v_writelane_b32 v135, s39, 1
  s_cmp_eq_u32 s3, 0
  s_cselect_b32 s38, 0, 1073741824
  v_or_b32 v135, s38, v135
  v_mov_b32 v129, 1
  s_waitcnt vmcnt(42)
  s_barrier
  buffer_atomic_add v129, v135, s[24:27], 0 offen
  buffer_load_dwordx4 a[40:43], v115, s[24:27], s6 offen offset:2048 sc1
  buffer_load_dwordx4 a[44:47], v115, s[24:27], s6 offen offset:3072 sc1
  buffer_load_dwordx4 a[48:51], v116, s[24:27], s6 offen offset:0 sc1
  buffer_load_dwordx4 a[52:55], v116, s[24:27], s6 offen offset:1024 sc1
  buffer_load_dwordx4 a[56:59], v116, s[24:27], s6 offen offset:2048 sc1
  buffer_load_dwordx4 a[60:63], v116, s[24:27], s6 offen offset:3072 sc1
  buffer_load_dwordx4 a[64:67], v114, s[24:27], s7 offen offset:0 sc1
  buffer_load_dwordx4 a[68:71], v114, s[24:27], s7 offen offset:1024 sc1
  buffer_load_dwordx4 a[72:75], v114, s[24:27], s7 offen offset:2048 sc1
  buffer_load_dwordx4 a[76:79], v114, s[24:27], s7 offen offset:3072 sc1
  buffer_load_dwordx4 a[80:83], v115, s[24:27], s7 offen offset:0 sc1
  buffer_load_dwordx4 a[84:87], v115, s[24:27], s7 offen offset:1024 sc1
  buffer_load_dwordx4 a[88:91], v115, s[24:27], s7 offen offset:2048 sc1
  buffer_load_dwordx4 a[92:95], v115, s[24:27], s7 offen offset:3072 sc1
  buffer_load_dwordx4 a[96:99], v116, s[24:27], s7 offen offset:0 sc1
  buffer_load_dwordx4 a[100:103], v116, s[24:27], s7 offen offset:1024 sc1
  buffer_load_dwordx4 a[104:107], v116, s[24:27], s7 offen offset:2048 sc1
  buffer_load_dwordx4 a[108:111], v116, s[24:27], s7 offen offset:3072 sc1
  buffer_load_dwordx4 a[112:115], v114, s[24:27], s8 offen offset:0 sc1
  s_waitcnt vmcnt(60)
  buffer_load_dwordx4 a[116:119], v114, s[24:27], s8 offen offset:1024 sc1
  buffer_load_dwordx4 a[120:123], v114, s[24:27], s8 offen offset:2048 sc1
  s_waitcnt vmcnt(60)
  buffer_load_dwordx4 a[124:127], v114, s[24:27], s8 offen offset:3072 sc1
  buffer_load_dwordx4 a[128:131], v115, s[24:27], s8 offen offset:0 sc1
  s_waitcnt vmcnt(60)
  buffer_load_dwordx4 a[132:135], v115, s[24:27], s8 offen offset:1024 sc1
  buffer_load_dwordx4 a[136:139], v115, s[24:27], s8 offen offset:2048 sc1
  s_waitcnt vmcnt(60)
  buffer_load_dwordx4 a[140:143], v115, s[24:27], s8 offen offset:3072 sc1
  s_add_u32 m0, s33, 0
  s_nop 0
  buffer_load_dwordx4 v116, s[24:27], s8 offen offset:0 sc1 lds
  s_add_u32 m0, s33, 0
  s_waitcnt vmcnt(60)
  buffer_load_dwordx4 v116, s[24:27], s8 offen offset:1024 sc1 lds
  s_add_u32 m0, s33, 0
  s_nop 0
  buffer_load_dwordx4 v116, s[24:27], s8 offen offset:2048 sc1 lds
  s_add_u32 m0, s33, 0
  s_waitcnt vmcnt(60)
  buffer_load_dwordx4 v116, s[24:27], s8 offen offset:3072 sc1 lds
  buffer_load_dword v128, v133, s[24:27], 0 offen sc1
  s_add_u32 m0, s33, 4096
  s_waitcnt vmcnt(60)
  buffer_load_dwordx4 v114, s[24:27], s9 offen offset:0 sc1 lds
  s_add_u32 m0, s33, 4096
  s_nop 0
  buffer_load_dwordx4 v114, s[24:27], s9 offen offset:1024 sc1 lds
  s_add_u32 m0, s33, 4096
  s_waitcnt vmcnt(60)
  buffer_load_dwordx4 v114, s[24:27], s9 offen offset:2048 sc1 lds
  s_add_u32 m0, s33, 4096
  s_nop 0
  buffer_load_dwordx4 v114, s[24:27], s9 offen offset:3072 sc1 lds
  s_add_u32 m0, s33, 8192
  s_waitcnt vmcnt(60)
  buffer_load_dwordx4 v115, s[24:27], s9 offen offset:0 sc1 lds
  s_add_u32 m0, s33, 8192
  s_nop 0
  buffer_load_dwordx4 v115, s[24:27], s9 offen offset:1024 sc1 lds
  s_add_u32 m0, s33, 8192
  s_waitcnt vmcnt(60)
  buffer_load_dwordx4 v115, s[24:27], s9 offen offset:2048 sc1 lds
  s_add_u32 m0, s33, 8192
  s_nop 0
  buffer_load_dwordx4 v115, s[24:27], s9 offen offset:3072 sc1 lds
  s_add_u32 m0, s33, 12288
  s_waitcnt vmcnt(60)
  buffer_load_dwordx4 v116, s[24:27], s9 offen offset:0 sc1 lds
  s_add_u32 m0, s33, 12288
  s_nop 0
  buffer_load_dwordx4 v116, s[24:27], s9 offen offset:1024 sc1 lds
  s_add_u32 m0, s33, 12288
  s_waitcnt vmcnt(60)
  buffer_load_dwordx4 v116, s[24:27], s9 offen offset:2048 sc1 lds
  s_add_u32 m0, s33, 12288
  s_nop 0
  buffer_load_dwordx4 v116, s[24:27], s9 offen offset:3072 sc1 lds
  s_add_u32 m0, s33, 16384
  s_waitcnt vmcnt(60)
  buffer_load_dwordx4 v114, s[24:27], s10 offen offset:0 sc1 lds
  s_add_u32 m0, s33, 16384
  s_nop 0
  buffer_load_dwordx4 v114, s[24:27], s10 offen offset:1024 sc1 lds
  s_add_u32 m0, s33, 16384
  s_waitcnt vmcnt(60)
  buffer_load_dwordx4 v114, s[24:27], s10 offen offset:2048 sc1 lds
  s_add_u32 m0, s33, 16384
  s_nop 0
  buffer_load_dwordx4 v114, s[24:27], s10 offen offset:3072 sc1 lds
  s_add_u32 m0, s33, 20480
  s_waitcnt vmcnt(60)
  buffer_load_dwordx4 v115, s[24:27], s10 offen offset:0 sc1 lds
  s_add_u32 m0, s33, 20480
  s_nop 0
  buffer_load_dwordx4 v115, s[24:27], s10 offen offset:1024 sc1 lds
  s_add_u32 m0, s33, 20480
  s_waitcnt vmcnt(60)
  buffer_load_dwordx4 v115, s[24:27], s10 offen offset:2048 sc1 lds
  s_add_u32 m0, s33, 20480
  s_nop 0
  buffer_load_dwordx4 v115, s[24:27], s10 offen offset:3072 sc1 lds
  v_lshlrev_b32 v90, 16, v156
  v_and_b32 v91, s34, v156
  v_lshlrev_b32 v92, 16, v157
  v_and_b32 v93, s34, v157
  s_waitcnt vmcnt(61)
  v_lshlrev_b32 v94, 16, v158
  v_and_b32 v95, s34, v158
  v_lshlrev_b32 v96, 16, v159
  v_and_b32 v97, s34, v159
  s_waitcnt vmcnt(59)
  v_lshlrev_b32 v98, 16, v160
  v_and_b32 v99, s34, v160
  v_lshlrev_b32 v100, 16, v161
  v_and_b32 v101, s34, v161
  s_waitcnt vmcnt(57)
  v_lshlrev_b32 v102, 16, v162
  v_and_b32 v103, s34, v162
  v_lshlrev_b32 v104, 16, v163
  v_and_b32 v105, s34, v163
  s_waitcnt vmcnt(55)
  v_lshlrev_b32 v106, 16, v164
  v_and_b32 v107, s34, v164
  v_lshlrev_b32 v108, 16, v165
  v_and_b32 v109, s34, v165
  v_mov_b32 v156, 0
  v_mov_b32 v157, 0
  v_mov_b32 v158, 0
  v_mov_b32 v159, 0
  v_mov_b32 v160, 0
  v_mov_b32 v161, 0
  v_mov_b32 v162, 0
  v_mov_b32 v163, 0
  v_mov_b32 v164, 0
  v_mov_b32 v165, 0
  v_mov_b32 v166, 0
  v_mov_b32 v167, 0
  v_mov_b32 v168, 0
  v_mov_b32 v169, 0
  v_mov_b32 v170, 0
  v_mov_b32 v171, 0
  v_mov_b32 v172, 0
  v_mov_b32 v173, 0
  v_mov_b32 v174, 0
  v_mov_b32 v175, 0
  s_waitcnt vmcnt(20)
  v_cmp_lt_u32 vcc, v128, v134
  s_nop 0
  s_cbranch_vccz tail_ready
  s_mov_b32 s35, 32768
tail_spin:
  s_sleep 2
  buffer_load_dword v128, v133, s[24:27], 0 offen sc1
  s_waitcnt vmcnt(0)
  v_cmp_lt_u32 vcc, v128, v134
  s_nop 0
  s_cbranch_vccz tail_ready
  s_sub_u32 s35, s35, 1
  s_cmp_lg_u32 s35, 0
  s_cbranch_scc1 tail_spin
tail_ready:
  buffer_load_dwordx4 a[144:147], v110, s[24:27], s30 offen offset:0 sc1
  buffer_load_dwordx4 a[148:151], v110, s[24:27], s30 offen offset:1024 sc1
  buffer_load_dwordx4 a[152:155], v111, s[24:27], s30 offen offset:0 sc1
  buffer_load_dwordx4 a[156:159], v111, s[24:27], s30 offen offset:1024 sc1
  buffer_load_dwordx4 a[160:163], v112, s[24:27], s30 offen offset:0 sc1
  buffer_load_dwordx4 a[164:167], v112, s[24:27], s30 offen offset:1024 sc1
  buffer_load_dwordx4 a[168:171], v113, s[24:27], s30 offen offset:0 sc1
  buffer_load_dwordx4 a[172:175], v113, s[24:27], s30 offen offset:1024 sc1
  s_add_u32 s30, s30, 8192
  buffer_load_dwordx4 a[176:179], v110, s[24:27], s30 offen offset:0 sc1
  buffer_load_dwordx4 a[180:183], v110, s[24:27], s30 offen offset:1024 sc1
  buffer_load_dwordx4 a[184:187], v111, s[24:27], s30 offen offset:0 sc1
  buffer_load_dwordx4 a[188:191], v111, s[24:27], s30 offen offset:1024 sc1
  v_cmp_gt_u32 vcc, 1073741824, v123
  s_nop 0
  s_and_saveexec_b64 s[42:43], vcc
  s_cbranch_execz tail_plain
  s_waitcnt vmcnt(30)
  buffer_load_dwordx4 v[156:159], v123, s[24:27], s32 offen offset:0 sc1
  buffer_load_dwordx4 v[160:163], v123, s[24:27], s32 offen offset:64 sc1
  buffer_load_dwordx4 v[164:167], v123, s[24:27], s32 offen offset:128 sc1
  buffer_load_dwordx4 v[168:171], v123, s[24:27], s32 offen offset:192 sc1
  buffer_load_dwordx4 v[172:175], v123, s[24:27], s32 offen offset:256 sc1
  s_add_u32 s32, s32, 20480
  buffer_load_dwordx4 v[136:139], v123, s[24:27], s32 offen offset:0 sc1
  buffer_load_dwordx4 v[140:143], v123, s[24:27], s32 offen offset:64 sc1
  buffer_load_dwordx4 v[144:147], v123, s[24:27], s32 offen offset:128 sc1
  buffer_load_dwordx4 v[148:151], v123, s[24:27], s32 offen offset:192 sc1
  buffer_load_dwordx4 v[152:155], v123, s[24:27], s32 offen offset:256 sc1
  s_add_u32 s32, s32, 20480
  buffer_load_dwordx4 v[0:3], v123, s[24:27], s32 offen offset:0 sc1
  buffer_load_dwordx4 v[4:7], v123, s[24:27], s32 offen offset:64 sc1
  buffer_load_dwordx4 v[8:11], v123, s[24:27], s32 offen offset:128 sc1
  buffer_load_dwordx4 v[12:15], v123, s[24:27], s32 offen offset:192 sc1
  buffer_load_dwordx4 v[16:19], v123, s[24:27], s32 offen offset:256 sc1
  s_add_u32 s32, s32, 20480
  buffer_load_dwordx4 v[20:23], v123, s[24:27], s32 offen offset:0 sc1
  buffer_load_dwordx4 v[24:27], v123, s[24:27], s32 offen offset:64 sc1
  buffer_load_dwordx4 v[28:31], v123, s[24:27], s32 offen offset:128 sc1
  buffer_load_dwordx4 v[32:35], v123, s[24:27], s32 offen offset:192 sc1
  buffer_load_dwordx4 v[36:39], v123, s[24:27], s32 offen offset:256 sc1
  s_add_u32 s32, s32, 20480
  buffer_load_dwordx4 v[40:43], v123, s[24:27], s32 offen offset:0 sc1
  buffer_load_dwordx4 v[44:47], v123, s[24:27], s32 offen offset:64 sc1
  buffer_load_dwordx4 v[48:51], v123, s[24:27], s32 offen offset:128 sc1
  buffer_load_dwordx4 v[52:55], v123, s[24:27], s32 offen offset:192 sc1
  buffer_load_dwordx4 v[56:59], v123, s[24:27], s32 offen offset:256 sc1
  s_add_u32 s32, s32, 20480
  buffer_load_dwordx4 v[60:63], v123, s[24:27], s32 offen offset:0 sc1
  buffer_load_dwordx4 v[64:67], v123, s[24:27], s32 offen offset:64 sc1
  buffer_load_dwordx4 v[68:71], v123, s[24:27], s32 offen offset:128 sc1
  buffer_load_dwordx4 v[72:75], v123, s[24:27], s32 offen offset:192 sc1
  buffer_load_dwordx4 v[76:79], v123, s[24:27], s32 offen offset:256 sc1
  s_add_u32 s32, s32, 20480
  s_waitcnt vmcnt(0)
  v_add_f32 v156, v156, v136
  v_add_f32 v157, v157, v137
  v_add_f32 v158, v158, v138
  v_add_f32 v159, v159, v139
  v_add_f32 v160, v160, v140
  v_add_f32 v161, v161, v141
  v_add_f32 v162, v162, v142
  v_add_f32 v163, v163, v143
  v_add_f32 v164, v164, v144
  v_add_f32 v165, v165, v145
  v_add_f32 v166, v166, v146
  v_add_f32 v167, v167, v147
  v_add_f32 v168, v168, v148
  v_add_f32 v169, v169, v149
  v_add_f32 v170, v170, v150
  v_add_f32 v171, v171, v151
  v_add_f32 v172, v172, v152
  v_add_f32 v173, v173, v153
  v_add_f32 v174, v174, v154
  v_add_f32 v175, v175, v155
  v_add_f32 v156, v156, v0
  v_add_f32 v157, v157, v1
  v_add_f32 v158, v158, v2
  v_add_f32 v159, v159, v3
  v_add_f32 v160, v160, v4
  v_add_f32 v161, v161, v5
  v_add_f32 v162, v162, v6
  v_add_f32 v163, v163, v7
  v_add_f32 v164, v164, v8
  v_add_f32 v165, v165, v9
  v_add_f32 v166, v166, v10
  v_add_f32 v167, v167, v11
  v_add_f32 v168, v168, v12
  v_add_f32 v169, v169, v13
  v_add_f32 v170, v170, v14
  v_add_f32 v171, v171, v15
  v_add_f32 v172, v172, v16
  v_add_f32 v173, v173, v17
  v_add_f32 v174, v174, v18
  v_add_f32 v175, v175, v19
  v_add_f32 v156, v156, v20
  v_add_f32 v157, v157, v21
  v_add_f32 v158, v158, v22
  v_add_f32 v159, v159, v23
  v_add_f32 v160, v160, v24
  v_add_f32 v161, v161, v25
  v_add_f32 v162, v162, v26
  v_add_f32 v163, v163, v27
  v_add_f32 v164, v164, v28
  v_add_f32 v165, v165, v29
  v_add_f32 v166, v166, v30
  v_add_f32 v167, v167, v31
  v_add_f32 v168, v168, v32
  v_add_f32 v169, v169, v33
  v_add_f32 v170, v170, v34
  v_add_f32 v171, v171, v35
  v_add_f32 v172, v172, v36
  v_add_f32 v173, v173, v37
  v_add_f32 v174, v174, v38
  v_add_f32 v175, v175, v39
  v_add_f32 v156, v156, v40
  v_add_f32 v157, v157, v41
  v_add_f32 v158, v158, v42
  v_add_f32 v159, v159, v43
  v_add_f32 v160, v160, v44
  v_add_f32 v161, v161, v45
  v_add_f32 v162, v162, v46
  v_add_f32 v163, v163, v47
  v_add_f32 v164, v164, v48
  v_add_f32 v165, v165, v49
  v_add_f32 v166, v166, v50
  v_add_f32 v167, v167, v51
  v_add_f32 v168, v168, v52
  v_add_f32 v169, v169, v53
  v_add_f32 v170, v170, v54
  v_add_f32 v171, v171, v55
  v_add_f32 v172, v172, v56
  v_add_f32 v173, v173, v57
  v_add_f32 v174, v174, v58
  v_add_f32 v175, v175, v59
  v_add_f32 v156, v156, v60
  v_add_f32 v157, v157, v61
  v_add_f32 v158, v158, v62
  v_add_f32 v159, v159, v63
  v_add_f32 v160, v160, v64
  v_add_f32 v161, v161, v65
  v_add_f32 v162, v162, v66
  v_add_f32 v163, v163, v67
  v_add_f32 v164, v164, v68
  v_add_f32 v165, v165, v69
  v_add_f32 v166, v166, v70
  v_add_f32 v167, v167, v71
  v_add_f32 v168, v168, v72
  v_add_f32 v169, v169, v73
  v_add_f32 v170, v170, v74
  v_add_f32 v171, v171, v75
  v_add_f32 v172, v172, v76
  v_add_f32 v173, v173, v77
  v_add_f32 v174, v174, v78
  v_add_f32 v175, v175, v79
tail_plain:
  s_mov_b64 exec, s[42:43]
  s_waitcnt vmcnt(4)
  v_mfma_f32_16x16x32_bf16 v[0:3], v[176:179], a[144:147], 0
  buffer_load_dwordx4 a[192:195], v112, s[24:27], s30 offen offset:0 sc1
  v_mfma_f32_16x16x32_bf16 v[0:3], v[196:199], a[148:151], v[0:3]
  v_cvt_pk_bf16_f32 v156, v156, v156
  v_cvt_pk_bf16_f32 v157, v157, v157
  v_mfma_f32_16x16x32_bf16 v[4:7], v[196:199], a[156:159], 0
  v_cvt_pk_bf16_f32 v158, v158, v158
  v_cvt_pk_bf16_f32 v159, v159, v159
  v_mfma_f32_16x16x32_bf16 v[4:7], v[176:179], a[152:155], v[4:7]
  v_lshlrev_b32 v156, 16, v156
  v_lshlrev_b32 v157, 16, v157
  v_mfma_f32_16x16x32_bf16 v[8:11], v[176:179], a[160:163], 0
  buffer_load_dwordx4 a[196:199], v112, s[24:27], s30 offen offset:1024 sc1
  v_mfma_f32_16x16x32_bf16 v[8:11], v[196:199], a[164:167], v[8:11]
  v_lshlrev_b32 v158, 16, v158
  v_lshlrev_b32 v159, 16, v159
  v_mfma_f32_16x16x32_bf16 v[12:15], v[196:199], a[172:175], 0
  v_mul_f32 v156, v156, v124
  v_mul_f32 v157, v157, v124
  v_mfma_f32_16x16x32_bf16 v[12:15], v[176:179], a[168:171], v[12:15]
  v_mul_f32 v158, v158, v124
  v_mul_f32 v159, v159, v124
  v_mfma_f32_16x16x32_bf16 v[16:19], v[180:183], a[144:147], 0
  buffer_load_dwordx4 a[200:203], v113, s[24:27], s30 offen offset:0 sc1
  v_mfma_f32_16x16x32_bf16 v[16:19], v[200:203], a[148:151], v[16:19]
  v_cvt_pk_bf16_f32 v156, v156, v156
  v_cvt_pk_bf16_f32 v157, v157, v157
  v_mfma_f32_16x16x32_bf16 v[20:23], v[200:203], a[156:159], 0
  v_cvt_pk_bf16_f32 v158, v158, v158
  v_cvt_pk_bf16_f32 v159, v159, v159
  v_mfma_f32_16x16x32_bf16 v[20:23], v[180:183], a[152:155], v[20:23]
  v_lshlrev_b32 v156, 16, v156
  v_lshlrev_b32 v157, 16, v157
  v_mfma_f32_16x16x32_bf16 v[24:27], v[180:183], a[160:163], 0
  buffer_load_dwordx4 a[204:207], v113, s[24:27], s30 offen offset:1024 sc1
  v_mfma_f32_16x16x32_bf16 v[24:27], v[200:203], a[164:167], v[24:27]
  v_lshlrev_b32 v158, 16, v158
  v_lshlrev_b32 v159, 16, v159
  v_mfma_f32_16x16x32_bf16 v[28:31], v[200:203], a[172:175], 0
  v_add_f32 v90, v90, v156
  v_add_f32 v91, v91, v157
  v_mfma_f32_16x16x32_bf16 v[28:31], v[180:183], a[168:171], v[28:31]
  v_add_f32 v92, v92, v158
  v_add_f32 v93, v93, v159
  v_mfma_f32_16x16x32_bf16 v[32:35], v[184:187], a[144:147], 0
  s_add_u32 s30, s30, 8192
  buffer_load_dwordx4 a[208:211], v110, s[24:27], s30 offen offset:0 sc1
  v_mfma_f32_16x16x32_bf16 v[32:35], v[204:207], a[148:151], v[32:35]
  v_cvt_pk_bf16_f32 v90, v90, v90
  v_cvt_pk_bf16_f32 v91, v91, v91
  v_mfma_f32_16x16x32_bf16 v[36:39], v[204:207], a[156:159], 0
  v_cvt_pk_bf16_f32 v92, v92, v92
  v_cvt_pk_bf16_f32 v93, v93, v93
  v_mfma_f32_16x16x32_bf16 v[36:39], v[184:187], a[152:155], v[36:39]
  v_lshlrev_b32 v90, 16, v90
  v_lshlrev_b32 v91, 16, v91
  v_mfma_f32_16x16x32_bf16 v[40:43], v[184:187], a[160:163], 0
  buffer_load_dwordx4 a[212:215], v110, s[24:27], s30 offen offset:1024 sc1
  v_mfma_f32_16x16x32_bf16 v[40:43], v[204:207], a[164:167], v[40:43]
  v_lshlrev_b32 v92, 16, v92
  v_lshlrev_b32 v93, 16, v93
  v_mfma_f32_16x16x32_bf16 v[44:47], v[204:207], a[172:175], 0
  v_mul_f32 v129, 0xbfb8aa3b, v90
  v_mul_f32 v130, 0xbfb8aa3b, v91
  v_mfma_f32_16x16x32_bf16 v[44:47], v[184:187], a[168:171], v[44:47]
  v_mul_f32 v131, 0xbfb8aa3b, v92
  v_mul_f32 v132, 0xbfb8aa3b, v93
  v_mfma_f32_16x16x32_bf16 v[48:51], v[188:191], a[144:147], 0
  buffer_load_dwordx4 a[216:219], v111, s[24:27], s30 offen offset:0 sc1
  v_mfma_f32_16x16x32_bf16 v[48:51], v[208:211], a[148:151], v[48:51]
  v_exp_f32 v129, v129
  v_mfma_f32_16x16x32_bf16 v[52:55], v[208:211], a[156:159], 0
  v_exp_f32 v130, v130
  v_mfma_f32_16x16x32_bf16 v[52:55], v[188:191], a[152:155], v[52:55]
  v_exp_f32 v131, v131
  v_mfma_f32_16x16x32_bf16 v[56:59], v[188:191], a[160:163], 0
  buffer_load_dwordx4 a[220:223], v111, s[24:27], s30 offen offset:1024 sc1
  v_mfma_f32_16x16x32_bf16 v[56:59], v[208:211], a[164:167], v[56:59]
  v_exp_f32 v132, v132
  v_mfma_f32_16x16x32_bf16 v[60:63], v[208:211], a[172:175], 0
  v_add_f32 v129, 1.0, v129
  v_add_f32 v130, 1.0, v130
  v_mfma_f32_16x16x32_bf16 v[60:63], v[188:191], a[168:171], v[60:63]
  v_add_f32 v131, 1.0, v131
  v_add_f32 v132, 1.0, v132
  v_mfma_f32_16x16x32_bf16 v[64:67], v[192:195], a[144:147], 0
  buffer_load_dwordx4 a[224:227], v112, s[24:27], s30 offen offset:0 sc1
  v_mfma_f32_16x16x32_bf16 v[64:67], v[212:215], a[148:151], v[64:67]
  v_rcp_f32 v129, v129
  v_mfma_f32_16x16x32_bf16 v[68:71], v[212:215], a[156:159], 0
  v_rcp_f32 v130, v130
  v_mfma_f32_16x16x32_bf16 v[68:71], v[192:195], a[152:155], v[68:71]
  v_rcp_f32 v131, v131
  v_mfma_f32_16x16x32_bf16 v[72:75], v[192:195], a[160:163], 0
  buffer_load_dwordx4 a[228:231], v112, s[24:27], s30 offen offset:1024 sc1
  v_mfma_f32_16x16x32_bf16 v[72:75], v[212:215], a[164:167], v[72:75]
  v_rcp_f32 v132, v132
  v_mfma_f32_16x16x32_bf16 v[76:79], v[212:215], a[172:175], 0
  v_mul_f32 v90, v90, v129
  v_mul_f32 v91, v91, v130
  v_mfma_f32_16x16x32_bf16 v[76:79], v[192:195], a[168:171], v[76:79]
  v_mul_f32 v92, v92, v131
  v_mul_f32 v93, v93, v132
  s_waitcnt vmcnt(6)
  v_mfma_f32_16x16x32_bf16 v[0:3], v[216:219], a[176:179], v[0:3]
  buffer_load_dwordx4 a[232:235], v113, s[24:27], s30 offen offset:0 sc1
  v_mfma_f32_16x16x32_bf16 v[0:3], v[236:239], a[180:183], v[0:3]
  v_cvt_pk_bf16_f32 v90, v90, v90
  v_cvt_pk_bf16_f32 v91, v91, v91
  v_mfma_f32_16x16x32_bf16 v[4:7], v[236:239], a[188:191], v[4:7]
  v_cvt_pk_bf16_f32 v92, v92, v92
  v_cvt_pk_bf16_f32 v93, v93, v93
  v_mfma_f32_16x16x32_bf16 v[4:7], v[216:219], a[184:187], v[4:7]
  v_lshlrev_b32 v90, 16, v90
  v_lshlrev_b32 v91, 16, v91
  v_mfma_f32_16x16x32_bf16 v[8:11], v[216:219], a[192:195], v[8:11]
  buffer_load_dwordx4 a[236:239], v113, s[24:27], s30 offen offset:1024 sc1
  v_mfma_f32_16x16x32_bf16 v[8:11], v[236:239], a[196:199], v[8:11]
  v_lshlrev_b32 v92, 16, v92
  v_lshlrev_b32 v93, 16, v93
  v_mfma_f32_16x16x32_bf16 v[12:15], v[236:239], a[204:207], v[12:15]
  v_cvt_pk_bf16_f32 v160, v160, v160
  v_cvt_pk_bf16_f32 v161, v161, v161
  v_mfma_f32_16x16x32_bf16 v[12:15], v[216:219], a[200:203], v[12:15]
  v_cvt_pk_bf16_f32 v162, v162, v162
  v_cvt_pk_bf16_f32 v163, v163, v163
  v_mfma_f32_16x16x32_bf16 v[16:19], v[220:223], a[176:179], v[16:19]
  s_add_u32 s30, s30, 8192
  buffer_load_dwordx4 a[240:243], v110, s[24:27], s30 offen offset:0 sc1
  v_mfma_f32_16x16x32_bf16 v[16:19], v[240:243], a[180:183], v[16:19]
  v_lshlrev_b32 v160, 16, v160
  v_lshlrev_b32 v161, 16, v161
  v_mfma_f32_16x16x32_bf16 v[20:23], v[240:243], a[188:191], v[20:23]
  v_lshlrev_b32 v162, 16, v162
  v_lshlrev_b32 v163, 16, v163
  v_mfma_f32_16x16x32_bf16 v[20:23], v[220:223], a[184:187], v[20:23]
  v_mul_f32 v160, v160, v124
  v_mul_f32 v161, v161, v124
  v_mfma_f32_16x16x32_bf16 v[24:27], v[220:223], a[192:195], v[24:27]
  buffer_load_dwordx4 a[244:247], v110, s[24:27], s30 offen offset:1024 sc1
  v_mfma_f32_16x16x32_bf16 v[24:27], v[240:243], a[196:199], v[24:27]
  v_mul_f32 v162, v162, v124
  v_mul_f32 v163, v163, v124
  v_mfma_f32_16x16x32_bf16 v[28:31], v[240:243], a[204:207], v[28:31]
  v_cvt_pk_bf16_f32 v160, v160, v160
  v_cvt_pk_bf16_f32 v161, v161, v161
  v_mfma_f32_16x16x32_bf16 v[28:31], v[220:223], a[200:203], v[28:31]
  v_cvt_pk_bf16_f32 v162, v162, v162
  v_cvt_pk_bf16_f32 v163, v163, v163
  v_mfma_f32_16x16x32_bf16 v[32:35], v[224:227], a[176:179], v[32:35]
  buffer_load_dwordx4 a[248:251], v111, s[24:27], s30 offen offset:0 sc1
  v_mfma_f32_16x16x32_bf16 v[32:35], v[244:247], a[180:183], v[32:35]
  v_lshlrev_b32 v160, 16, v160
  v_lshlrev_b32 v161, 16, v161
  v_mfma_f32_16x16x32_bf16 v[36:39], v[244:247], a[188:191], v[36:39]
  v_lshlrev_b32 v162, 16, v162
  v_lshlrev_b32 v163, 16, v163
  v_mfma_f32_16x16x32_bf16 v[36:39], v[224:227], a[184:187], v[36:39]
  v_add_f32 v94, v94, v160
  v_add_f32 v95, v95, v161
  v_mfma_f32_16x16x32_bf16 v[40:43], v[224:227], a[192:195], v[40:43]
  buffer_load_dwordx4 a[252:255], v111, s[24:27], s30 offen offset:1024 sc1
  v_mfma_f32_16x16x32_bf16 v[40:43], v[244:247], a[196:199], v[40:43]
  v_add_f32 v96, v96, v162
  v_add_f32 v97, v97, v163
  v_mfma_f32_16x16x32_bf16 v[44:47], v[244:247], a[204:207], v[44:47]
  v_cvt_pk_bf16_f32 v94, v94, v94
  v_cvt_pk_bf16_f32 v95, v95, v95
  v_mfma_f32_16x16x32_bf16 v[44:47], v[224:227], a[200:203], v[44:47]
  v_cvt_pk_bf16_f32 v96, v96, v96
  v_cvt_pk_bf16_f32 v97, v97, v97
  v_mfma_f32_16x16x32_bf16 v[48:51], v[228:231], a[176:179], v[48:51]
  buffer_load_dwordx4 v[136:139], v112, s[24:27], s30 offen offset:0 sc1
  v_mfma_f32_16x16x32_bf16 v[48:51], v[248:251], a[180:183], v[48:51]
  v_lshlrev_b32 v94, 16, v94
  v_lshlrev_b32 v95, 16, v95
  v_mfma_f32_16x16x32_bf16 v[52:55], v[248:251], a[188:191], v[52:55]
  v_lshlrev_b32 v96, 16, v96
  v_lshlrev_b32 v97, 16, v97
  v_mfma_f32_16x16x32_bf16 v[52:55], v[228:231], a[184:187], v[52:55]
  v_mul_f32 v129, 0xbfb8aa3b, v94
  v_mul_f32 v130, 0xbfb8aa3b, v95
  v_mfma_f32_16x16x32_bf16 v[56:59], v[228:231], a[192:195], v[56:59]
  buffer_load_dwordx4 v[140:143], v112, s[24:27], s30 offen offset:1024 sc1
  v_mfma_f32_16x16x32_bf16 v[56:59], v[248:251], a[196:199], v[56:59]
  v_mul_f32 v131, 0xbfb8aa3b, v96
  v_mul_f32 v132, 0xbfb8aa3b, v97
  v_mfma_f32_16x16x32_bf16 v[60:63], v[248:251], a[204:207], v[60:63]
  v_exp_f32 v129, v129
  v_mfma_f32_16x16x32_bf16 v[60:63], v[228:231], a[200:203], v[60:63]
  v_exp_f32 v130, v130
  v_mfma_f32_16x16x32_bf16 v[64:67], v[232:235], a[176:179], v[64:67]
  buffer_load_dwordx4 v[144:147], v113, s[24:27], s30 offen offset:0 sc1
  v_mfma_f32_16x16x32_bf16 v[64:67], v[252:255], a[180:183], v[64:67]
  v_exp_f32 v131, v131
  v_mfma_f32_16x16x32_bf16 v[68:71], v[252:255], a[188:191], v[68:71]
  v_exp_f32 v132, v132
  v_mfma_f32_16x16x32_bf16 v[68:71], v[232:235], a[184:187], v[68:71]
  v_add_f32 v129, 1.0, v129
  v_add_f32 v130, 1.0, v130
  v_mfma_f32_16x16x32_bf16 v[72:75], v[232:235], a[192:195], v[72:75]
  buffer_load_dwordx4 v[148:151], v113, s[24:27], s30 offen offset:1024 sc1
  v_mfma_f32_16x16x32_bf16 v[72:75], v[252:255], a[196:199], v[72:75]
  v_add_f32 v131, 1.0, v131
  v_add_f32 v132, 1.0, v132
  v_mfma_f32_16x16x32_bf16 v[76:79], v[252:255], a[204:207], v[76:79]
  v_rcp_f32 v129, v129
  v_mfma_f32_16x16x32_bf16 v[76:79], v[232:235], a[200:203], v[76:79]
  v_rcp_f32 v130, v130
  s_waitcnt vmcnt(8)
  v_mfma_f32_16x16x32_bf16 v[0:3], a[0:3], a[208:211], v[0:3]
  s_add_u32 s30, s30, 8192
  buffer_load_dwordx4 v[152:155], v110, s[24:27], s30 offen offset:0 sc1
  v_mfma_f32_16x16x32_bf16 v[0:3], a[20:23], a[212:215], v[0:3]
  v_rcp_f32 v131, v131
  v_mfma_f32_16x16x32_bf16 v[4:7], a[20:23], a[220:223], v[4:7]
  v_rcp_f32 v132, v132
  v_mfma_f32_16x16x32_bf16 v[4:7], a[0:3], a[216:219], v[4:7]
  v_mul_f32 v94, v94, v129
  v_mul_f32 v95, v95, v130
  v_mfma_f32_16x16x32_bf16 v[8:11], a[0:3], a[224:227], v[8:11]
  buffer_load_dwordx4 a[144:147], v110, s[24:27], s30 offen offset:1024 sc1
  v_mfma_f32_16x16x32_bf16 v[8:11], a[20:23], a[228:231], v[8:11]
  v_mul_f32 v96, v96, v131
  v_mul_f32 v97, v97, v132
  v_mfma_f32_16x16x32_bf16 v[12:15], a[20:23], a[236:239], v[12:15]
  v_cvt_pk_bf16_f32 v94, v94, v94
  v_cvt_pk_bf16_f32 v95, v95, v95
  v_mfma_f32_16x16x32_bf16 v[12:15], a[0:3], a[232:235], v[12:15]
  v_cvt_pk_bf16_f32 v96, v96, v96
  v_cvt_pk_bf16_f32 v97, v97, v97
  v_mfma_f32_16x16x32_bf16 v[16:19], a[4:7], a[208:211], v[16:19]
  buffer_load_dwordx4 a[148:151], v111, s[24:27], s30 offen offset:0 sc1
  v_mfma_f32_16x16x32_bf16 v[16:19], a[24:27], a[212:215], v[16:19]
  v_lshlrev_b32 v94, 16, v94
  v_lshlrev_b32 v95, 16, v95
  v_mfma_f32_16x16x32_bf16 v[20:23], a[24:27], a[220:223], v[20:23]
  v_lshlrev_b32 v96, 16, v96
  v_lshlrev_b32 v97, 16, v97
  v_mfma_f32_16x16x32_bf16 v[20:23], a[4:7], a[216:219], v[20:23]
  v_cvt_pk_bf16_f32 v164, v164, v164
  v_cvt_pk_bf16_f32 v165, v165, v165
  v_mfma_f32_16x16x32_bf16 v[24:27], a[4:7], a[224:227], v[24:27]
  buffer_load_dwordx4 a[152:155], v111, s[24:27], s30 offen offset:1024 sc1
  v_mfma_f32_16x16x32_bf16 v[24:27], a[24:27], a[228:231], v[24:27]
  v_cvt_pk_bf16_f32 v166, v166, v166
  v_cvt_pk_bf16_f32 v167, v167, v167
  v_mfma_f32_16x16x32_bf16 v[28:31], a[24:27], a[236:239], v[28:31]
  v_lshlrev_b32 v164, 16, v164
  v_lshlrev_b32 v165, 16, v165
  v_mfma_f32_16x16x32_bf16 v[28:31], a[4:7], a[232:235], v[28:31]
  v_lshlrev_b32 v166, 16, v166
  v_lshlrev_b32 v167, 16, v167
  v_mfma_f32_16x16x32_bf16 v[32:35], a[8:11], a[208:211], v[32:35]
  buffer_load_dwordx4 a[156:159], v112, s[24:27], s30 offen offset:0 sc1
  v_mfma_f32_16x16x32_bf16 v[32:35], a[28:31], a[212:215], v[32:35]
  v_mul_f32 v164, v164, v124
  v_mul_f32 v165, v165, v124
  v_mfma_f32_16x16x32_bf16 v[36:39], a[28:31], a[220:223], v[36:39]
  v_mul_f32 v166, v166, v124
  v_mul_f32 v167, v167, v124
  v_mfma_f32_16x16x32_bf16 v[36:39], a[8:11], a[216:219], v[36:39]
  v_cvt_pk_bf16_f32 v164, v164, v164
  v_cvt_pk_bf16_f32 v165, v165, v165
  v_mfma_f32_16x16x32_bf16 v[40:43], a[8:11], a[224:227], v[40:43]
  buffer_load_dwordx4 a[160:163], v112, s[24:27], s30 offen offset:1024 sc1
  v_mfma_f32_16x16x32_bf16 v[40:43], a[28:31], a[228:231], v[40:43]
  v_cvt_pk_bf16_f32 v166, v166, v166
  v_cvt_pk_bf16_f32 v167, v167, v167
  v_mfma_f32_16x16x32_bf16 v[44:47], a[28:31], a[236:239], v[44:47]
  v_lshlrev_b32 v164, 16, v164
  v_lshlrev_b32 v165, 16, v165
  v_mfma_f32_16x16x32_bf16 v[44:47], a[8:11], a[232:235], v[44:47]
  v_lshlrev_b32 v166, 16, v166
  v_lshlrev_b32 v167, 16, v167
  v_mfma_f32_16x16x32_bf16 v[48:51], a[12:15], a[208:211], v[48:51]
  buffer_load_dwordx4 a[164:167], v113, s[24:27], s30 offen offset:0 sc1
  v_mfma_f32_16x16x32_bf16 v[48:51], a[32:35], a[212:215], v[48:51]
  v_add_f32 v98, v98, v164
  v_add_f32 v99, v99, v165
  v_mfma_f32_16x16x32_bf16 v[52:55], a[32:35], a[220:223], v[52:55]
  v_add_f32 v100, v100, v166
  v_add_f32 v101, v101, v167
  v_mfma_f32_16x16x32_bf16 v[52:55], a[12:15], a[216:219], v[52:55]
  v_cvt_pk_bf16_f32 v98, v98, v98
  v_cvt_pk_bf16_f32 v99, v99, v99
  v_mfma_f32_16x16x32_bf16 v[56:59], a[12:15], a[224:227], v[56:59]
  buffer_load_dwordx4 a[168:171], v113, s[24:27], s30 offen offset:1024 sc1
  v_mfma_f32_16x16x32_bf16 v[56:59], a[32:35], a[228:231], v[56:59]
  v_cvt_pk_bf16_f32 v100, v100, v100
  v_cvt_pk_bf16_f32 v101, v101, v101
  v_mfma_f32_16x16x32_bf16 v[60:63], a[32:35], a[236:239], v[60:63]
  v_lshlrev_b32 v98, 16, v98
  v_lshlrev_b32 v99, 16, v99
  v_mfma_f32_16x16x32_bf16 v[60:63], a[12:15], a[232:235], v[60:63]
  v_lshlrev_b32 v100, 16, v100
  v_lshlrev_b32 v101, 16, v101
  v_mfma_f32_16x16x32_bf16 v[64:67], a[16:19], a[208:211], v[64:67]
  s_add_u32 s30, s30, 8192
  buffer_load_dwordx4 a[172:175], v110, s[24:27], s30 offen offset:0 sc1
  v_mfma_f32_16x16x32_bf16 v[64:67], a[36:39], a[212:215], v[64:67]
  v_mul_f32 v129, 0xbfb8aa3b, v98
  v_mul_f32 v130, 0xbfb8aa3b, v99
  v_mfma_f32_16x16x32_bf16 v[68:71], a[36:39], a[220:223], v[68:71]
  v_mul_f32 v131, 0xbfb8aa3b, v100
  v_mul_f32 v132, 0xbfb8aa3b, v101
  v_mfma_f32_16x16x32_bf16 v[68:71], a[16:19], a[216:219], v[68:71]
  v_exp_f32 v129, v129
  v_mfma_f32_16x16x32_bf16 v[72:75], a[16:19], a[224:227], v[72:75]
  buffer_load_dwordx4 a[176:179], v110, s[24:27], s30 offen offset:1024 sc1
  v_mfma_f32_16x16x32_bf16 v[72:75], a[36:39], a[228:231], v[72:75]
  v_exp_f32 v130, v130
  v_mfma_f32_16x16x32_bf16 v[76:79], a[36:39], a[236:239], v[76:79]
  v_exp_f32 v131, v131
  v_mfma_f32_16x16x32_bf16 v[76:79], a[16:19], a[232:235], v[76:79]
  v_exp_f32 v132, v132
  s_waitcnt vmcnt(10)
  v_mfma_f32_16x16x32_bf16 v[0:3], a[40:43], a[240:243], v[0:3]
  buffer_load_dwordx4 a[180:183], v111, s[24:27], s30 offen offset:0 sc1
  v_mfma_f32_16x16x32_bf16 v[0:3], a[60:63], a[244:247], v[0:3]
  v_add_f32 v129, 1.0, v129
  v_add_f32 v130, 1.0, v130
  v_mfma_f32_16x16x32_bf16 v[4:7], a[60:63], a[252:255], v[4:7]
  v_add_f32 v131, 1.0, v131
  v_add_f32 v132, 1.0, v132
  v_mfma_f32_16x16x32_bf16 v[4:7], a[40:43], a[248:251], v[4:7]
  v_rcp_f32 v129, v129
  v_mfma_f32_16x16x32_bf16 v[8:11], a[40:43], v[136:139], v[8:11]
  buffer_load_dwordx4 a[184:187], v111, s[24:27], s30 offen offset:1024 sc1
  v_mfma_f32_16x16x32_bf16 v[8:11], a[60:63], v[140:143], v[8:11]
  v_rcp_f32 v130, v130
  v_mfma_f32_16x16x32_bf16 v[12:15], a[60:63], v[148:151], v[12:15]
  v_rcp_f32 v131, v131
  v_mfma_f32_16x16x32_bf16 v[12:15], a[40:43], v[144:147], v[12:15]
  v_rcp_f32 v132, v132
  v_mfma_f32_16x16x32_bf16 v[16:19], a[44:47], a[240:243], v[16:19]
  buffer_load_dwordx4 a[188:191], v112, s[24:27], s30 offen offset:0 sc1
  v_mfma_f32_16x16x32_bf16 v[16:19], a[64:67], a[244:247], v[16:19]
  v_mul_f32 v98, v98, v129
  v_mul_f32 v99, v99, v130
  v_mfma_f32_16x16x32_bf16 v[20:23], a[64:67], a[252:255], v[20:23]
  v_mul_f32 v100, v100, v131
  v_mul_f32 v101, v101, v132
  v_mfma_f32_16x16x32_bf16 v[20:23], a[44:47], a[248:251], v[20:23]
  v_cvt_pk_bf16_f32 v98, v98, v98
  v_cvt_pk_bf16_f32 v99, v99, v99
  v_mfma_f32_16x16x32_bf16 v[24:27], a[44:47], v[136:139], v[24:27]
  buffer_load_dwordx4 a[192:195], v112, s[24:27], s30 offen offset:1024 sc1
  v_mfma_f32_16x16x32_bf16 v[24:27], a[64:67], v[140:143], v[24:27]
  v_cvt_pk_bf16_f32 v100, v100, v100
  v_cvt_pk_bf16_f32 v101, v101, v101
  v_mfma_f32_16x16x32_bf16 v[28:31], a[64:67], v[148:151], v[28:31]
  v_lshlrev_b32 v98, 16, v98
  v_lshlrev_b32 v99, 16, v99
  v_mfma_f32_16x16x32_bf16 v[28:31], a[44:47], v[144:147], v[28:31]
  v_lshlrev_b32 v100, 16, v100
  v_lshlrev_b32 v101, 16, v101
  v_mfma_f32_16x16x32_bf16 v[32:35], a[48:51], a[240:243], v[32:35]
  buffer_load_dwordx4 a[196:199], v113, s[24:27], s30 offen offset:0 sc1
  v_mfma_f32_16x16x32_bf16 v[32:35], a[68:71], a[244:247], v[32:35]
  v_cvt_pk_bf16_f32 v168, v168, v168
  v_cvt_pk_bf16_f32 v169, v169, v169
  v_mfma_f32_16x16x32_bf16 v[36:39], a[68:71], a[252:255], v[36:39]
  v_cvt_pk_bf16_f32 v170, v170, v170
  v_cvt_pk_bf16_f32 v171, v171, v171
  v_mfma_f32_16x16x32_bf16 v[36:39], a[48:51], a[248:251], v[36:39]
  v_lshlrev_b32 v168, 16, v168
  v_lshlrev_b32 v169, 16, v169
  v_mfma_f32_16x16x32_bf16 v[40:43], a[48:51], v[136:139], v[40:43]
  buffer_load_dwordx4 a[200:203], v113, s[24:27], s30 offen offset:1024 sc1
  v_mfma_f32_16x16x32_bf16 v[40:43], a[68:71], v[140:143], v[40:43]
  v_lshlrev_b32 v170, 16, v170
  v_lshlrev_b32 v171, 16, v171
  v_mfma_f32_16x16x32_bf16 v[44:47], a[68:71], v[148:151], v[44:47]
  v_mul_f32 v168, v168, v124
  v_mul_f32 v169, v169, v124
  v_mfma_f32_16x16x32_bf16 v[44:47], a[48:51], v[144:147], v[44:47]
  v_mul_f32 v170, v170, v124
  v_mul_f32 v171, v171, v124
  v_mfma_f32_16x16x32_bf16 v[48:51], a[52:55], a[240:243], v[48:51]
  s_add_u32 s30, s30, 8192
  buffer_load_dwordx4 a[204:207], v110, s[24:27], s30 offen offset:0 sc1
  v_mfma_f32_16x16x32_bf16 v[48:51], a[72:75], a[244:247], v[48:51]
  v_cvt_pk_bf16_f32 v168, v168, v168
  v_cvt_pk_bf16_f32 v169, v169, v169
  v_mfma_f32_16x16x32_bf16 v[52:55], a[72:75], a[252:255], v[52:55]
  v_cvt_pk_bf16_f32 v170, v170, v170
  v_cvt_pk_bf16_f32 v171, v171, v171
  v_mfma_f32_16x16x32_bf16 v[52:55], a[52:55], a[248:251], v[52:55]
  v_lshlrev_b32 v168, 16, v168
  v_lshlrev_b32 v169, 16, v169
  v_mfma_f32_16x16x32_bf16 v[56:59], a[52:55], v[136:139], v[56:59]
  buffer_load_dwordx4 a[208:211], v110, s[24:27], s30 offen offset:1024 sc1
  v_mfma_f32_16x16x32_bf16 v[56:59], a[72:75], v[140:143], v[56:59]
  v_lshlrev_b32 v170, 16, v170
  v_lshlrev_b32 v171, 16, v171
  v_mfma_f32_16x16x32_bf16 v[60:63], a[72:75], v[148:151], v[60:63]
  v_add_f32 v102, v102, v168
  v_add_f32 v103, v103, v169
  v_mfma_f32_16x16x32_bf16 v[60:63], a[52:55], v[144:147], v[60:63]
  v_add_f32 v104, v104, v170
  v_add_f32 v105, v105, v171
  v_mfma_f32_16x16x32_bf16 v[64:67], a[56:59], a[240:243], v[64:67]
  buffer_load_dwordx4 a[212:215], v111, s[24:27], s30 offen offset:0 sc1
  v_mfma_f32_16x16x32_bf16 v[64:67], a[76:79], a[244:247], v[64:67]
  v_cvt_pk_bf16_f32 v102, v102, v102
  v_cvt_pk_bf16_f32 v103, v103, v103
  v_mfma_f32_16x16x32_bf16 v[68:71], a[76:79], a[252:255], v[68:71]
  v_cvt_pk_bf16_f32 v104, v104, v104
  v_cvt_pk_bf16_f32 v105, v105, v105
  v_mfma_f32_16x16x32_bf16 v[68:71], a[56:59], a[248:251], v[68:71]
  v_lshlrev_b32 v102, 16, v102
  v_lshlrev_b32 v103, 16, v103
  v_mfma_f32_16x16x32_bf16 v[72:75], a[56:59], v[136:139], v[72:75]
  buffer_load_dwordx4 a[216:219], v111, s[24:27], s30 offen offset:1024 sc1
  v_mfma_f32_16x16x32_bf16 v[72:75], a[76:79], v[140:143], v[72:75]
  v_lshlrev_b32 v104, 16, v104
  v_lshlrev_b32 v105, 16, v105
  v_mfma_f32_16x16x32_bf16 v[76:79], a[76:79], v[148:151], v[76:79]
  v_mul_f32 v129, 0xbfb8aa3b, v102
  v_mul_f32 v130, 0xbfb8aa3b, v103
  v_mfma_f32_16x16x32_bf16 v[76:79], a[56:59], v[144:147], v[76:79]
  v_mul_f32 v131, 0xbfb8aa3b, v104
  v_mul_f32 v132, 0xbfb8aa3b, v105
  s_waitcnt vmcnt(12)
  v_mfma_f32_16x16x32_bf16 v[0:3], a[80:83], v[152:155], v[0:3]
  buffer_load_dwordx4 a[220:223], v112, s[24:27], s30 offen offset:0 sc1
  v_mfma_f32_16x16x32_bf16 v[0:3], a[100:103], a[144:147], v[0:3]
  v_exp_f32 v129, v129
  v_mfma_f32_16x16x32_bf16 v[4:7], a[100:103], a[152:155], v[4:7]
  v_exp_f32 v130, v130
  v_mfma_f32_16x16x32_bf16 v[4:7], a[80:83], a[148:151], v[4:7]
  v_exp_f32 v131, v131
  v_mfma_f32_16x16x32_bf16 v[8:11], a[80:83], a[156:159], v[8:11]
  buffer_load_dwordx4 a[224:227], v112, s[24:27], s30 offen offset:1024 sc1
  v_mfma_f32_16x16x32_bf16 v[8:11], a[100:103], a[160:163], v[8:11]
  v_exp_f32 v132, v132
  v_mfma_f32_16x16x32_bf16 v[12:15], a[100:103], a[168:171], v[12:15]
  v_add_f32 v129, 1.0, v129
  v_add_f32 v130, 1.0, v130
  v_mfma_f32_16x16x32_bf16 v[12:15], a[80:83], a[164:167], v[12:15]
  v_add_f32 v131, 1.0, v131
  v_add_f32 v132, 1.0, v132
  v_mfma_f32_16x16x32_bf16 v[16:19], a[84:87], v[152:155], v[16:19]
  buffer_load_dwordx4 a[228:231], v113, s[24:27], s30 offen offset:0 sc1
  v_mfma_f32_16x16x32_bf16 v[16:19], a[104:107], a[144:147], v[16:19]
  v_rcp_f32 v129, v129
  v_mfma_f32_16x16x32_bf16 v[20:23], a[104:107], a[152:155], v[20:23]
  v_rcp_f32 v130, v130
  v_mfma_f32_16x16x32_bf16 v[20:23], a[84:87], a[148:151], v[20:23]
  v_rcp_f32 v131, v131
  v_mfma_f32_16x16x32_bf16 v[24:27], a[84:87], a[156:159], v[24:27]
  buffer_load_dwordx4 a[232:235], v113, s[24:27], s30 offen offset:1024 sc1
  v_mfma_f32_16x16x32_bf16 v[24:27], a[104:107], a[160:163], v[24:27]
  v_rcp_f32 v132, v132
  v_mfma_f32_16x16x32_bf16 v[28:31], a[104:107], a[168:171], v[28:31]
  v_mul_f32 v102, v102, v129
  v_mul_f32 v103, v103, v130
  v_mfma_f32_16x16x32_bf16 v[28:31], a[84:87], a[164:167], v[28:31]
  v_mul_f32 v104, v104, v131
  v_mul_f32 v105, v105, v132
  v_mfma_f32_16x16x32_bf16 v[32:35], a[88:91], v[152:155], v[32:35]
  s_add_u32 s30, s30, 8192
  buffer_load_dwordx4 a[236:239], v110, s[24:27], s30 offen offset:0 sc1
  v_mfma_f32_16x16x32_bf16 v[32:35], a[108:111], a[144:147], v[32:35]
  v_cvt_pk_bf16_f32 v102, v102, v102
  v_cvt_pk_bf16_f32 v103, v103, v103
  v_mfma_f32_16x16x32_bf16 v[36:39], a[108:111], a[152:155], v[36:39]
  v_cvt_pk_bf16_f32 v104, v104, v104
  v_cvt_pk_bf16_f32 v105, v105, v105
  v_mfma_f32_16x16x32_bf16 v[36:39], a[88:91], a[148:151], v[36:39]
  v_lshlrev_b32 v102, 16, v102
  v_lshlrev_b32 v103, 16, v103
  v_mfma_f32_16x16x32_bf16 v[40:43], a[88:91], a[156:159], v[40:43]
  buffer_load_dwordx4 a[240:243], v110, s[24:27], s30 offen offset:1024 sc1
  v_mfma_f32_16x16x32_bf16 v[40:43], a[108:111], a[160:163], v[40:43]
  v_lshlrev_b32 v104, 16, v104
  v_lshlrev_b32 v105, 16, v105
  v_mfma_f32_16x16x32_bf16 v[44:47], a[108:111], a[168:171], v[44:47]
  v_cvt_pk_bf16_f32 v172, v172, v172
  v_cvt_pk_bf16_f32 v173, v173, v173
  v_mfma_f32_16x16x32_bf16 v[44:47], a[88:91], a[164:167], v[44:47]
  v_cvt_pk_bf16_f32 v174, v174, v174
  v_cvt_pk_bf16_f32 v175, v175, v175
  v_mfma_f32_16x16x32_bf16 v[48:51], a[92:95], v[152:155], v[48:51]
  buffer_load_dwordx4 a[244:247], v111, s[24:27], s30 offen offset:0 sc1
  v_mfma_f32_16x16x32_bf16 v[48:51], a[112:115], a[144:147], v[48:51]
  v_lshlrev_b32 v172, 16, v172
  v_lshlrev_b32 v173, 16, v173
  v_mfma_f32_16x16x32_bf16 v[52:55], a[112:115], a[152:155], v[52:55]
  v_lshlrev_b32 v174, 16, v174
  v_lshlrev_b32 v175, 16, v175
  v_mfma_f32_16x16x32_bf16 v[52:55], a[92:95], a[148:151], v[52:55]
  v_mul_f32 v172, v172, v124
  v_mul_f32 v173, v173, v124
  v_mfma_f32_16x16x32_bf16 v[56:59], a[92:95], a[156:159], v[56:59]
  buffer_load_dwordx4 a[248:251], v111, s[24:27], s30 offen offset:1024 sc1
  v_mfma_f32_16x16x32_bf16 v[56:59], a[112:115], a[160:163], v[56:59]
  v_mul_f32 v174, v174, v124
  v_mul_f32 v175, v175, v124
  v_mfma_f32_16x16x32_bf16 v[60:63], a[112:115], a[168:171], v[60:63]
  v_cvt_pk_bf16_f32 v172, v172, v172
  v_cvt_pk_bf16_f32 v173, v173, v173
  v_mfma_f32_16x16x32_bf16 v[60:63], a[92:95], a[164:167], v[60:63]
  v_cvt_pk_bf16_f32 v174, v174, v174
  v_cvt_pk_bf16_f32 v175, v175, v175
  v_mfma_f32_16x16x32_bf16 v[64:67], a[96:99], v[152:155], v[64:67]
  ds_read_b128 a[252:255], v122 offset:0
  v_lshlrev_b32 v172, 16, v172
  v_mfma_f32_16x16x32_bf16 v[64:67], a[116:119], a[144:147], v[64:67]
  buffer_load_dwordx4 v[136:139], v112, s[24:27], s30 offen offset:0 sc1
  v_mfma_f32_16x16x32_bf16 v[68:71], a[116:119], a[152:155], v[68:71]
  v_lshlrev_b32 v173, 16, v173
  v_lshlrev_b32 v174, 16, v174
  v_mfma_f32_16x16x32_bf16 v[68:71], a[96:99], a[148:151], v[68:71]
  v_lshlrev_b32 v175, 16, v175
  v_add_f32 v106, v106, v172
  v_mfma_f32_16x16x32_bf16 v[72:75], a[96:99], a[156:159], v[72:75]
  buffer_load_dwordx4 v[140:143], v112, s[24:27], s30 offen offset:1024 sc1
  v_mfma_f32_16x16x32_bf16 v[72:75], a[116:119], a[160:163], v[72:75]
  v_add_f32 v107, v107, v173
  v_add_f32 v108, v108, v174
  v_mfma_f32_16x16x32_bf16 v[76:79], a[116:119], a[168:171], v[76:79]
  v_add_f32 v109, v109, v175
  v_cvt_pk_bf16_f32 v106, v106, v106
  v_mfma_f32_16x16x32_bf16 v[76:79], a[96:99], a[164:167], v[76:79]
  v_cvt_pk_bf16_f32 v107, v107, v107
  v_cvt_pk_bf16_f32 v108, v108, v108
  s_waitcnt vmcnt(14)
  v_mfma_f32_16x16x32_bf16 v[0:3], a[120:123], a[172:175], v[0:3]
  ds_read_b128 v[144:147], v122 offset:1024
  v_cvt_pk_bf16_f32 v109, v109, v109
  v_mfma_f32_16x16x32_bf16 v[0:3], a[140:143], a[176:179], v[0:3]
  buffer_load_dwordx4 v[148:151], v113, s[24:27], s30 offen offset:0 sc1
  v_mfma_f32_16x16x32_bf16 v[4:7], a[140:143], a[184:187], v[4:7]
  v_lshlrev_b32 v106, 16, v106
  v_lshlrev_b32 v107, 16, v107
  v_mfma_f32_16x16x32_bf16 v[4:7], a[120:123], a[180:183], v[4:7]
  v_lshlrev_b32 v108, 16, v108
  v_lshlrev_b32 v109, 16, v109
  v_mfma_f32_16x16x32_bf16 v[8:11], a[120:123], a[188:191], v[8:11]
  buffer_load_dwordx4 v[152:155], v113, s[24:27], s30 offen offset:1024 sc1
  v_mfma_f32_16x16x32_bf16 v[8:11], a[140:143], a[192:195], v[8:11]
  v_mul_f32 v129, 0xbfb8aa3b, v106
  v_mul_f32 v130, 0xbfb8aa3b, v107
  v_mfma_f32_16x16x32_bf16 v[12:15], a[140:143], a[200:203], v[12:15]
  v_mul_f32 v131, 0xbfb8aa3b, v108
  v_mul_f32 v132, 0xbfb8aa3b, v109
  v_mfma_f32_16x16x32_bf16 v[12:15], a[120:123], a[196:199], v[12:15]
  v_exp_f32 v129, v129
  s_waitcnt lgkmcnt(1)
  v_mfma_f32_16x16x32_bf16 v[16:19], a[124:127], a[172:175], v[16:19]
  ds_read_b128 a[144:147], v122 offset:2048
  s_mov_b32 s30, s37
  v_exp_f32 v130, v130
  v_mfma_f32_16x16x32_bf16 v[16:19], a[252:255], a[176:179], v[16:19]
  buffer_load_dwordx4 a[148:151], v110, s[24:27], s30 offen offset:0 sc1
  v_mfma_f32_16x16x32_bf16 v[20:23], a[252:255], a[184:187], v[20:23]
  v_exp_f32 v131, v131
  v_mfma_f32_16x16x32_bf16 v[20:23], a[124:127], a[180:183], v[20:23]
  v_exp_f32 v132, v132
  v_mfma_f32_16x16x32_bf16 v[24:27], a[124:127], a[188:191], v[24:27]
  buffer_load_dwordx4 a[152:155], v110, s[24:27], s30 offen offset:1024 sc1
  v_mfma_f32_16x16x32_bf16 v[24:27], a[252:255], a[192:195], v[24:27]
  v_add_f32 v129, 1.0, v129
  v_add_f32 v130, 1.0, v130
  v_mfma_f32_16x16x32_bf16 v[28:31], a[252:255], a[200:203], v[28:31]
  v_add_f32 v131, 1.0, v131
  v_add_f32 v132, 1.0, v132
  v_mfma_f32_16x16x32_bf16 v[28:31], a[124:127], a[196:199], v[28:31]
  v_rcp_f32 v129, v129
  s_waitcnt lgkmcnt(1)
  v_mfma_f32_16x16x32_bf16 v[32:35], a[128:131], a[172:175], v[32:35]
  ds_read_b128 a[156:159], v122 offset:3072
  v_rcp_f32 v130, v130
  v_mfma_f32_16x16x32_bf16 v[32:35], v[144:147], a[176:179], v[32:35]
  buffer_load_dwordx4 a[160:163], v111, s[24:27], s30 offen offset:0 sc1
  v_mfma_f32_16x16x32_bf16 v[36:39], v[144:147], a[184:187], v[36:39]
  v_rcp_f32 v131, v131
  v_mfma_f32_16x16x32_bf16 v[36:39], a[128:131], a[180:183], v[36:39]
  v_rcp_f32 v132, v132
  v_mfma_f32_16x16x32_bf16 v[40:43], a[128:131], a[188:191], v[40:43]
  buffer_load_dwordx4 a[164:167], v111, s[24:27], s30 offen offset:1024 sc1
  v_mfma_f32_16x16x32_bf16 v[40:43], v[144:147], a[192:195], v[40:43]
  v_mul_f32 v106, v106, v129
  v_mul_f32 v107, v107, v130
  v_mfma_f32_16x16x32_bf16 v[44:47], v[144:147], a[200:203], v[44:47]
  v_mul_f32 v108, v108, v131
  v_mul_f32 v109, v109, v132
  v_mfma_f32_16x16x32_bf16 v[44:47], a[128:131], a[196:199], v[44:47]
  v_cvt_pk_bf16_f32 v106, v106, v106
  v_cvt_pk_bf16_f32 v107, v107, v107
  s_waitcnt lgkmcnt(1)
  v_mfma_f32_16x16x32_bf16 v[48:51], a[132:135], a[172:175], v[48:51]
  ds_read_b128 a[168:171], v122 offset:4096
  ds_read_b128 a[252:255], v122 offset:9216
  v_mfma_f32_16x16x32_bf16 v[48:51], a[144:147], a[176:179], v[48:51]
  v_cvt_pk_bf16_f32 v108, v108, v108
  v_cvt_pk_bf16_f32 v109, v109, v109
  v_mfma_f32_16x16x32_bf16 v[52:55], a[144:147], a[184:187], v[52:55]
  v_lshlrev_b32 v106, 16, v106
  v_lshlrev_b32 v107, 16, v107
  v_mfma_f32_16x16x32_bf16 v[52:55], a[132:135], a[180:183], v[52:55]
  v_lshlrev_b32 v108, 16, v108
  v_lshlrev_b32 v109, 16, v109
  v_mfma_f32_16x16x32_bf16 v[56:59], a[132:135], a[188:191], v[56:59]
  v_lshlrev_b32 v156, 16, v80
  v_and_b32 v157, s34, v80
  v_mfma_f32_16x16x32_bf16 v[56:59], a[144:147], a[192:195], v[56:59]
  v_lshlrev_b32 v158, 16, v81
  v_and_b32 v159, s34, v81
  v_mfma_f32_16x16x32_bf16 v[60:63], a[144:147], a[200:203], v[60:63]
  v_lshlrev_b32 v160, 16, v82
  v_and_b32 v161, s34, v82
  v_mfma_f32_16x16x32_bf16 v[60:63], a[132:135], a[196:199], v[60:63]
  v_lshlrev_b32 v162, 16, v83
  v_and_b32 v163, s34, v83
  s_waitcnt lgkmcnt(2)
  v_mfma_f32_16x16x32_bf16 v[64:67], a[136:139], a[172:175], v[64:67]
  ds_read_b128 v[144:147], v122 offset:5120
  ds_read_b128 a[144:147], v122 offset:10240
  v_mfma_f32_16x16x32_bf16 v[64:67], a[156:159], a[176:179], v[64:67]
  v_lshlrev_b32 v164, 16, v84
  v_and_b32 v165, s34, v84
  v_mfma_f32_16x16x32_bf16 v[68:71], a[156:159], a[184:187], v[68:71]
  v_lshlrev_b32 v166, 16, v85
  v_and_b32 v167, s34, v85
  v_mfma_f32_16x16x32_bf16 v[68:71], a[136:139], a[180:183], v[68:71]
  v_lshlrev_b32 v168, 16, v86
  v_and_b32 v169, s34, v86
  v_mfma_f32_16x16x32_bf16 v[72:75], a[136:139], a[188:191], v[72:75]
  v_lshlrev_b32 v170, 16, v87
  v_and_b32 v171, s34, v87
  v_mfma_f32_16x16x32_bf16 v[72:75], a[156:159], a[192:195], v[72:75]
  v_lshlrev_b32 v172, 16, v88
  v_and_b32 v173, s34, v88
  v_mfma_f32_16x16x32_bf16 v[76:79], a[156:159], a[200:203], v[76:79]
  v_lshlrev_b32 v174, 16, v89
  v_and_b32 v175, s34, v89
  v_mfma_f32_16x16x32_bf16 v[76:79], a[136:139], a[196:199], v[76:79]
  s_sub_u32 s41, s3, 1
  s_and_b32 s41, s41, 3
  s_mul_i32 s41, s41, 24576
  s_add_u32 s41, s41, 4096
  v_add_u32 v80, s41, v114
  s_waitcnt vmcnt(12) lgkmcnt(2)
  v_mfma_f32_16x16x32_bf16 v[0:3], a[168:171], a[204:207], v[0:3]
  ds_read_b128 a[156:159], v122 offset:6144
  ds_read_b128 a[172:175], v122 offset:11264
  s_sub_u32 s41, s3, 2
  s_and_b32 s41, s41, 3
  s_mul_i32 s41, s41, 24576
  s_add_u32 s41, s41, 9216
  v_mfma_f32_16x16x32_bf16 v[0:3], a[252:255], a[208:211], v[0:3]
  buffer_load_dwordx4 a[176:179], v112, s[24:27], s30 offen offset:0 sc1
  v_mfma_f32_16x16x32_bf16 v[4:7], a[252:255], a[216:219], v[4:7]
  v_add_u32 v81, s41, v114
  v_mfma_f32_16x16x32_bf16 v[4:7], a[168:171], a[212:215], v[4:7]
  s_sub_u32 s41, s3, 3
  s_and_b32 s41, s41, 3
  s_mul_i32 s41, s41, 24576
  s_add_u32 s41, s41, 14336
  v_add_u32 v82, s41, v114
  v_mfma_f32_16x16x32_bf16 v[8:11], a[168:171], a[220:223], v[8:11]
  buffer_load_dwordx4 a[180:183], v112, s[24:27], s30 offen offset:1024 sc1
  v_mfma_f32_16x16x32_bf16 v[8:11], a[252:255], a[224:227], v[8:11]
  v_mfma_f32_16x16x32_bf16 v[12:15], a[252:255], a[232:235], v[12:15]
  v_mfma_f32_16x16x32_bf16 v[12:15], a[168:171], a[228:231], v[12:15]
  s_waitcnt lgkmcnt(2)
  v_mfma_f32_16x16x32_bf16 v[16:19], v[144:147], a[204:207], v[16:19]
  ds_read_b128 a[184:187], v122 offset:7168
  ds_read_b128 a[188:191], v122 offset:12288
  v_mfma_f32_16x16x32_bf16 v[16:19], a[144:147], a[208:211], v[16:19]
  buffer_load_dwordx4 a[192:195], v113, s[24:27], s30 offen offset:0 sc1
  v_mfma_f32_16x16x32_bf16 v[20:23], a[144:147], a[216:219], v[20:23]
  v_mfma_f32_16x16x32_bf16 v[20:23], v[144:147], a[212:215], v[20:23]
  v_mfma_f32_16x16x32_bf16 v[24:27], v[144:147], a[220:223], v[24:27]
  buffer_load_dwordx4 a[196:199], v113, s[24:27], s30 offen offset:1024 sc1
  v_mfma_f32_16x16x32_bf16 v[24:27], a[144:147], a[224:227], v[24:27]
  v_mfma_f32_16x16x32_bf16 v[28:31], a[144:147], a[232:235], v[28:31]
  v_mfma_f32_16x16x32_bf16 v[28:31], v[144:147], a[228:231], v[28:31]
  s_waitcnt lgkmcnt(2)
  v_mfma_f32_16x16x32_bf16 v[32:35], a[156:159], a[204:207], v[32:35]
  ds_read_b128 a[200:203], v122 offset:8192
  ds_read_b128 a[168:171], v122 offset:13312
  s_add_u32 s30, s30, 8192
  v_mfma_f32_16x16x32_bf16 v[32:35], a[172:175], a[208:211], v[32:35]
  buffer_load_dwordx4 a[252:255], v110, s[24:27], s30 offen offset:0 sc1
  v_mfma_f32_16x16x32_bf16 v[36:39], a[172:175], a[216:219], v[36:39]
  v_mfma_f32_16x16x32_bf16 v[36:39], a[156:159], a[212:215], v[36:39]
  v_mfma_f32_16x16x32_bf16 v[40:43], a[156:159], a[220:223], v[40:43]
  v_mfma_f32_16x16x32_bf16 v[40:43], a[172:175], a[224:227], v[40:43]
  v_mfma_f32_16x16x32_bf16 v[44:47], a[172:175], a[232:235], v[44:47]
  v_mfma_f32_16x16x32_bf16 v[44:47], a[156:159], a[228:231], v[44:47]
  s_waitcnt lgkmcnt(2)
  v_mfma_f32_16x16x32_bf16 v[48:51], a[184:187], a[204:207], v[48:51]
  ds_read_b128 v[144:147], v122 offset:14336
  ds_read_b128 a[144:147], v122 offset:19456
  v_mfma_f32_16x16x32_bf16 v[48:51], a[188:191], a[208:211], v[48:51]
  v_mfma_f32_16x16x32_bf16 v[52:55], a[188:191], a[216:219], v[52:55]
  v_mfma_f32_16x16x32_bf16 v[52:55], a[184:187], a[212:215], v[52:55]
  v_mfma_f32_16x16x32_bf16 v[56:59], a[184:187], a[220:223], v[56:59]
  v_mfma_f32_16x16x32_bf16 v[56:59], a[188:191], a[224:227], v[56:59]
  v_mfma_f32_16x16x32_bf16 v[60:63], a[188:191], a[232:235], v[60:63]
  v_mfma_f32_16x16x32_bf16 v[60:63], a[184:187], a[228:231], v[60:63]
  s_waitcnt lgkmcnt(2)
  v_mfma_f32_16x16x32_bf16 v[64:67], a[200:203], a[204:207], v[64:67]
  ds_read_b128 a[156:159], v122 offset:15360
  ds_read_b128 a[172:175], v122 offset:20480
  v_mfma_f32_16x16x32_bf16 v[64:67], a[168:171], a[208:211], v[64:67]
  v_mfma_f32_16x16x32_bf16 v[68:71], a[168:171], a[216:219], v[68:71]
  v_mfma_f32_16x16x32_bf16 v[68:71], a[200:203], a[212:215], v[68:71]
  v_mfma_f32_16x16x32_bf16 v[72:75], a[200:203], a[220:223], v[72:75]
  v_mfma_f32_16x16x32_bf16 v[72:75], a[168:171], a[224:227], v[72:75]
  v_mfma_f32_16x16x32_bf16 v[76:79], a[168:171], a[232:235], v[76:79]
  v_mfma_f32_16x16x32_bf16 v[76:79], a[200:203], a[228:231], v[76:79]
  s_waitcnt vmcnt(9) lgkmcnt(2)
  v_mfma_f32_16x16x32_bf16 v[0:3], v[144:147], a[236:239], v[0:3]
  ds_read_b128 a[184:187], v122 offset:16384
  ds_read_b128 a[188:191], v122 offset:21504
  s_xor_b32 s38, s40, 1
  s_lshl_b32 s38, s38, 2
  s_add_u32 s38, s38, s3
  s_lshl_b32 s38, s38, 13
  s_add_u32 s38, s38, 25165824
  s_add_u32 s39, s38, 4096
  v_mfma_f32_16x16x32_bf16 v[0:3], a[144:147], a[240:243], v[0:3]
  buffer_load_dwordx4 a[200:203], v110, s[24:27], s30 offen offset:1024 sc1
  v_mfma_f32_16x16x32_bf16 v[4:7], a[144:147], a[248:251], v[4:7]
  v_mfma_f32_16x16x32_bf16 v[4:7], v[144:147], a[244:247], v[4:7]
  v_mfma_f32_16x16x32_bf16 v[8:11], v[144:147], v[136:139], v[8:11]
  buffer_load_dwordx4 a[168:171], v111, s[24:27], s30 offen offset:0 sc1
  v_mfma_f32_16x16x32_bf16 v[8:11], a[144:147], v[140:143], v[8:11]
  v_mfma_f32_16x16x32_bf16 v[12:15], a[144:147], v[152:155], v[12:15]
  v_mfma_f32_16x16x32_bf16 v[12:15], v[144:147], v[148:151], v[12:15]
  s_waitcnt lgkmcnt(2)
  v_mfma_f32_16x16x32_bf16 v[16:19], a[156:159], a[236:239], v[16:19]
  ds_read_b128 a[204:207], v122 offset:17408
  ds_read_b128 a[208:211], v122 offset:22528
  v_mfma_f32_16x16x32_bf16 v[16:19], a[172:175], a[240:243], v[16:19]
  buffer_load_dwordx4 a[212:215], v111, s[24:27], s30 offen offset:1024 sc1
  v_mfma_f32_16x16x32_bf16 v[20:23], a[172:175], a[248:251], v[20:23]
  ds_write_b128 v118, v[4:7] offset:0
  ds_write_b128 v118, v[8:11] offset:5120
  v_mfma_f32_16x16x32_bf16 v[20:23], a[156:159], a[244:247], v[20:23]
  ds_write_b128 v118, v[12:15] offset:10240
  v_mfma_f32_16x16x32_bf16 v[24:27], a[156:159], v[136:139], v[24:27]
  buffer_load_dwordx4 a[216:219], v112, s[24:27], s30 offen offset:0 sc1
  v_mfma_f32_16x16x32_bf16 v[24:27], a[172:175], v[140:143], v[24:27]
  v_mfma_f32_16x16x32_bf16 v[28:31], a[172:175], v[152:155], v[28:31]
  v_mfma_f32_16x16x32_bf16 v[28:31], a[156:159], v[148:151], v[28:31]
  s_waitcnt lgkmcnt(5)
  v_mfma_f32_16x16x32_bf16 v[32:35], a[184:187], a[236:239], v[32:35]
  ds_read_b128 a[220:223], v122 offset:18432
  ds_read_b128 a[224:227], v122 offset:23552
  v_mfma_f32_16x16x32_bf16 v[32:35], a[188:191], a[240:243], v[32:35]
  buffer_load_dwordx4 a[228:231], v112, s[24:27], s30 offen offset:1024 sc1
  v_mfma_f32_16x16x32_bf16 v[36:39], a[188:191], a[248:251], v[36:39]
  ds_write_b128 v118, v[20:23] offset:1024
  ds_write_b128 v118, v[24:27] offset:6144
  v_mfma_f32_16x16x32_bf16 v[36:39], a[184:187], a[244:247], v[36:39]
  ds_write_b128 v118, v[28:31] offset:11264
  v_mfma_f32_16x16x32_bf16 v[40:43], a[184:187], v[136:139], v[40:43]
  buffer_load_dwordx4 a[232:235], v113, s[24:27], s30 offen offset:0 sc1
  v_mfma_f32_16x16x32_bf16 v[40:43], a[188:191], v[140:143], v[40:43]
  v_mfma_f32_16x16x32_bf16 v[44:47], a[188:191], v[152:155], v[44:47]
  v_mfma_f32_16x16x32_bf16 v[44:47], a[184:187], v[148:151], v[44:47]
  s_waitcnt lgkmcnt(8)
  v_mfma_f32_16x16x32_bf16 v[48:51], a[204:207], a[236:239], v[48:51]
  buffer_load_dwordx4 v[144:147], v113, s[24:27], s30 offen offset:1024 sc1
  v_mfma_f32_16x16x32_bf16 v[48:51], a[208:211], a[240:243], v[48:51]
  ds_write_b128 v118, v[36:39] offset:2048
  v_mfma_f32_16x16x32_bf16 v[52:55], a[208:211], a[248:251], v[52:55]
  ds_write_b128 v118, v[40:43] offset:7168
  v_mfma_f32_16x16x32_bf16 v[52:55], a[204:207], a[244:247], v[52:55]
  ds_write_b128 v118, v[44:47] offset:12288
  v_mfma_f32_16x16x32_bf16 v[56:59], a[204:207], v[136:139], v[56:59]
  s_add_u32 s30, s30, 8192
  buffer_load_dwordx4 a[144:147], v110, s[24:27], s30 offen offset:0 sc1
  v_mfma_f32_16x16x32_bf16 v[56:59], a[208:211], v[140:143], v[56:59]
  v_mfma_f32_16x16x32_bf16 v[60:63], a[208:211], v[152:155], v[60:63]
  v_mfma_f32_16x16x32_bf16 v[60:63], a[204:207], v[148:151], v[60:63]
  s_waitcnt lgkmcnt(6)
  v_mfma_f32_16x16x32_bf16 v[64:67], a[220:223], a[236:239], v[64:67]
  buffer_load_dwordx4 a[156:159], v110, s[24:27], s30 offen offset:1024 sc1
  v_mfma_f32_16x16x32_bf16 v[64:67], a[224:227], a[240:243], v[64:67]
  ds_write_b128 v118, v[52:55] offset:3072
  v_mfma_f32_16x16x32_bf16 v[68:71], a[224:227], a[248:251], v[68:71]
  ds_write_b128 v118, v[56:59] offset:8192
  v_mfma_f32_16x16x32_bf16 v[68:71], a[220:223], a[244:247], v[68:71]
  ds_write_b128 v118, v[60:63] offset:13312
  v_mfma_f32_16x16x32_bf16 v[72:75], a[220:223], v[136:139], v[72:75]
  buffer_load_dwordx4 a[172:175], v111, s[24:27], s30 offen offset:0 sc1
  v_mfma_f32_16x16x32_bf16 v[72:75], a[224:227], v[140:143], v[72:75]
  v_mfma_f32_16x16x32_bf16 v[76:79], a[224:227], v[152:155], v[76:79]
  v_mfma_f32_16x16x32_bf16 v[76:79], a[220:223], v[148:151], v[76:79]
  s_nop 1
  ds_write_b128 v118, v[68:71] offset:4096
  s_nop 2
  ds_write_b128 v118, v[72:75] offset:9216
  s_nop 0
  ds_write_b128 v118, v[76:79] offset:14336
  buffer_load_dwordx4 a[184:187], v111, s[24:27], s30 offen offset:1024 sc1
  buffer_load_dwordx4 a[188:191], v112, s[24:27], s30 offen offset:0 sc1
  buffer_load_dwordx4 a[204:207], v112, s[24:27], s30 offen offset:1024 sc1
  buffer_load_dwordx4 a[208:211], v113, s[24:27], s30 offen offset:0 sc1
  buffer_load_dwordx4 a[220:223], v113, s[24:27], s30 offen offset:1024 sc1
  s_add_u32 s30, s30, 8192
  buffer_load_dwordx4 a[224:227], v110, s[24:27], s30 offen offset:0 sc1
  buffer_load_dwordx4 a[236:239], v110, s[24:27], s30 offen offset:1024 sc1
  buffer_load_dwordx4 a[240:243], v111, s[24:27], s30 offen offset:0 sc1
  buffer_load_dwordx4 a[244:247], v111, s[24:27], s30 offen offset:1024 sc1
  buffer_load_dwordx4 a[248:251], v112, s[24:27], s30 offen offset:0 sc1
  buffer_load_dwordx4 v[136:139], v112, s[24:27], s30 offen offset:1024 sc1
  buffer_load_dwordx4 v[140:143], v113, s[24:27], s30 offen offset:0 sc1
  buffer_load_dwordx4 v[148:151], v113, s[24:27], s30 offen offset:1024 sc1
  s_add_u32 s30, s30, 8192
  buffer_load_dwordx4 v[152:155], v110, s[24:27], s30 offen offset:0 sc1
  s_waitcnt lgkmcnt(0)
  s_barrier
  ds_read_b128 v[4:7], v119 offset:0
  ds_read_b128 v[8:11], v120 offset:0
  ds_read_b128 v[12:15], v121 offset:0
  ds_read_b128 v[20:23], v119 offset:1024
  ds_read_b128 v[24:27], v120 offset:1024
  ds_read_b128 v[28:31], v121 offset:1024
  ds_read_b128 v[36:39], v119 offset:2048
  ds_read_b128 v[40:43], v120 offset:2048
  ds_read_b128 v[44:47], v121 offset:2048
  ds_read_b128 v[52:55], v119 offset:3072
  ds_read_b128 v[56:59], v120 offset:3072
  ds_read_b128 v[60:63], v121 offset:3072
  ds_read_b128 v[68:71], v119 offset:4096
  ds_read_b128 v[72:75], v120 offset:4096
  ds_read_b128 v[76:79], v121 offset:4096
  s_waitcnt lgkmcnt(12)
  v_add_f32 v4, v4, v8
  v_add_f32 v5, v5, v9
  v_add_f32 v6, v6, v10
  v_add_f32 v7, v7, v11
  v_add_f32 v0, v0, v12
  v_add_f32 v1, v1, v13
  v_add_f32 v2, v2, v14
  v_add_f32 v3, v3, v15
  v_add_f32 v0, v0, v4
  v_add_f32 v1, v1, v5
  v_add_f32 v2, v2, v6
  v_add_f32 v3, v3, v7
  buffer_store_dwordx4 v[0:3], v114, s[24:27], s38 offen offset:0 sc1
  s_waitcnt vmcnt(26)
  s_nop 0
  v_mfma_f32_16x16x32_bf16 v[0:3], v[176:179], a[148:151], 0
  s_waitcnt lgkmcnt(9)
  v_add_f32 v20, v20, v24
  v_add_f32 v21, v21, v25
  v_mfma_f32_16x16x32_bf16 v[0:3], v[196:199], a[152:155], v[0:3]
  v_add_f32 v22, v22, v26
  v_add_f32 v23, v23, v27
  v_mfma_f32_16x16x32_bf16 v[4:7], v[196:199], a[164:167], 0
  v_add_f32 v16, v16, v28
  v_add_f32 v17, v17, v29
  v_mfma_f32_16x16x32_bf16 v[4:7], v[176:179], a[160:163], v[4:7]
  v_add_f32 v18, v18, v30
  v_add_f32 v19, v19, v31
  v_mfma_f32_16x16x32_bf16 v[8:11], v[176:179], a[176:179], 0
  v_add_f32 v16, v16, v20
  v_add_f32 v17, v17, v21
  v_mfma_f32_16x16x32_bf16 v[8:11], v[196:199], a[180:183], v[8:11]
  v_add_f32 v18, v18, v22
  v_add_f32 v19, v19, v23
  v_mfma_f32_16x16x32_bf16 v[12:15], v[196:199], a[196:199], 0
  buffer_store_dwordx4 v[16:19], v114, s[24:27], s38 offen offset:1024 sc1
  s_waitcnt lgkmcnt(6)
  v_mfma_f32_16x16x32_bf16 v[12:15], v[176:179], a[192:195], v[12:15]
  v_add_f32 v36, v36, v40
  v_add_f32 v37, v37, v41
  v_mfma_f32_16x16x32_bf16 v[16:19], v[180:183], a[148:151], 0
  buffer_load_dwordx4 v[176:179], v110, s[24:27], s30 offen offset:1024 sc1
  v_mfma_f32_16x16x32_bf16 v[16:19], v[200:203], a[152:155], v[16:19]
  v_add_f32 v38, v38, v42
  v_add_f32 v39, v39, v43
  v_mfma_f32_16x16x32_bf16 v[20:23], v[200:203], a[164:167], 0
  v_add_f32 v32, v32, v44
  v_add_f32 v33, v33, v45
  v_mfma_f32_16x16x32_bf16 v[20:23], v[180:183], a[160:163], v[20:23]
  v_add_f32 v34, v34, v46
  v_add_f32 v35, v35, v47
  v_mfma_f32_16x16x32_bf16 v[24:27], v[180:183], a[176:179], 0
  buffer_load_dwordx4 v[196:199], v111, s[24:27], s30 offen offset:0 sc1
  v_mfma_f32_16x16x32_bf16 v[24:27], v[200:203], a[180:183], v[24:27]
  v_add_f32 v32, v32, v36
  v_add_f32 v33, v33, v37
  v_mfma_f32_16x16x32_bf16 v[28:31], v[200:203], a[196:199], 0
  v_add_f32 v34, v34, v38
  v_add_f32 v35, v35, v39
  v_mfma_f32_16x16x32_bf16 v[28:31], v[180:183], a[192:195], v[28:31]
  buffer_store_dwordx4 v[32:35], v114, s[24:27], s38 offen offset:2048 sc1
  s_waitcnt lgkmcnt(3)
  s_nop 0
  v_mfma_f32_16x16x32_bf16 v[32:35], v[184:187], a[148:151], 0
  buffer_load_dwordx4 v[180:183], v111, s[24:27], s30 offen offset:1024 sc1
  v_mfma_f32_16x16x32_bf16 v[32:35], v[204:207], a[152:155], v[32:35]
  v_add_f32 v52, v52, v56
  v_add_f32 v53, v53, v57
  v_mfma_f32_16x16x32_bf16 v[36:39], v[204:207], a[164:167], 0
  v_add_f32 v54, v54, v58
  v_add_f32 v55, v55, v59
  v_mfma_f32_16x16x32_bf16 v[36:39], v[184:187], a[160:163], v[36:39]
  v_add_f32 v48, v48, v60
  v_add_f32 v49, v49, v61
  v_mfma_f32_16x16x32_bf16 v[40:43], v[184:187], a[176:179], 0
  buffer_load_dwordx4 v[200:203], v112, s[24:27], s30 offen offset:0 sc1
  v_mfma_f32_16x16x32_bf16 v[40:43], v[204:207], a[180:183], v[40:43]
  v_add_f32 v50, v50, v62
  v_add_f32 v51, v51, v63
  v_mfma_f32_16x16x32_bf16 v[44:47], v[204:207], a[196:199], 0
  v_add_f32 v48, v48, v52
  v_add_f32 v49, v49, v53
  v_mfma_f32_16x16x32_bf16 v[44:47], v[184:187], a[192:195], v[44:47]
  v_add_f32 v50, v50, v54
  v_add_f32 v51, v51, v55
  buffer_store_dwordx4 v[48:51], v114, s[24:27], s38 offen offset:3072 sc1
  s_nop 1
  v_mfma_f32_16x16x32_bf16 v[48:51], v[188:191], a[148:151], 0
  buffer_load_dwordx4 v[184:187], v112, s[24:27], s30 offen offset:1024 sc1
  s_waitcnt lgkmcnt(0)
  v_mfma_f32_16x16x32_bf16 v[48:51], v[208:211], a[152:155], v[48:51]
  v_add_f32 v68, v68, v72
  v_add_f32 v69, v69, v73
  v_mfma_f32_16x16x32_bf16 v[52:55], v[208:211], a[164:167], 0
  v_add_f32 v70, v70, v74
  v_add_f32 v71, v71, v75
  v_mfma_f32_16x16x32_bf16 v[52:55], v[188:191], a[160:163], v[52:55]
  v_add_f32 v64, v64, v76
  v_add_f32 v65, v65, v77
  v_mfma_f32_16x16x32_bf16 v[56:59], v[188:191], a[176:179], 0
  buffer_load_dwordx4 v[204:207], v113, s[24:27], s30 offen offset:0 sc1
  v_mfma_f32_16x16x32_bf16 v[56:59], v[208:211], a[180:183], v[56:59]
  v_add_f32 v66, v66, v78
  v_add_f32 v67, v67, v79
  v_mfma_f32_16x16x32_bf16 v[60:63], v[208:211], a[196:199], 0
  v_add_f32 v64, v64, v68
  v_add_f32 v65, v65, v69
  v_mfma_f32_16x16x32_bf16 v[60:63], v[188:191], a[192:195], v[60:63]
  v_add_f32 v66, v66, v70
  v_add_f32 v67, v67, v71
  buffer_store_dwordx4 v[64:67], v114, s[24:27], s39 offen offset:0 sc1
  s_nop 1
  v_mfma_f32_16x16x32_bf16 v[64:67], v[192:195], a[148:151], 0
  buffer_load_dwordx4 v[188:191], v113, s[24:27], s30 offen offset:1024 sc1
  s_xor_b32 s38, s40, 1
  s_lshl_b32 s38, s38, 7
  s_add_u32 s38, s38, 2834432
  v_mfma_f32_16x16x32_bf16 v[64:67], v[212:215], a[152:155], v[64:67]
  v_mov_b32 v135, 1073741824
  v_writelane_b32 v135, s38, 0
  v_mfma_f32_16x16x32_bf16 v[68:71], v[212:215], a[164:167], 0
  v_mov_b32 v127, 1
  v_mfma_f32_16x16x32_bf16 v[68:71], v[192:195], a[160:163], v[68:71]
  s_xor_b32 s38, s38, 128
  v_mov_b32 v133, s38
  v_mov_b32 v134, 4
  v_mfma_f32_16x16x32_bf16 v[72:75], v[192:195], a[176:179], 0
  s_add_u32 s30, s30, 8192
  buffer_load_dwordx4 v[208:211], v110, s[24:27], s30 offen offset:0 sc1
  v_mfma_f32_16x16x32_bf16 v[72:75], v[212:215], a[180:183], v[72:75]
  v_mfma_f32_16x16x32_bf16 v[76:79], v[212:215], a[196:199], 0
  v_mfma_f32_16x16x32_bf16 v[76:79], v[192:195], a[192:195], v[76:79]
  s_waitcnt vmcnt(30)
  v_mfma_f32_16x16x32_bf16 v[0:3], v[216:219], a[252:255], v[0:3]
  buffer_load_dwordx4 v[192:195], v110, s[24:27], s30 offen offset:1024 sc1
  v_mfma_f32_16x16x32_bf16 v[0:3], v[236:239], a[200:203], v[0:3]
  v_mfma_f32_16x16x32_bf16 v[4:7], v[236:239], a[212:215], v[4:7]
  v_mfma_f32_16x16x32_bf16 v[4:7], v[216:219], a[168:171], v[4:7]
  v_mfma_f32_16x16x32_bf16 v[8:11], v[216:219], a[216:219], v[8:11]
  buffer_load_dwordx4 v[212:215], v111, s[24:27], s30 offen offset:0 sc1
  v_mfma_f32_16x16x32_bf16 v[8:11], v[236:239], a[228:231], v[8:11]
  v_mfma_f32_16x16x32_bf16 v[12:15], v[236:239], v[144:147], v[12:15]
  v_mfma_f32_16x16x32_bf16 v[12:15], v[216:219], a[232:235], v[12:15]
  v_mfma_f32_16x16x32_bf16 v[16:19], v[220:223], a[252:255], v[16:19]
  buffer_load_dwordx4 a[148:151], v111, s[24:27], s30 offen offset:1024 sc1
  v_mfma_f32_16x16x32_bf16 v[16:19], v[240:243], a[200:203], v[16:19]
  v_mfma_f32_16x16x32_bf16 v[20:23], v[240:243], a[212:215], v[20:23]
  v_mfma_f32_16x16x32_bf16 v[20:23], v[220:223], a[168:171], v[20:23]
  v_mfma_f32_16x16x32_bf16 v[24:27], v[220:223], a[216:219], v[24:27]
  buffer_load_dwordx4 a[152:155], v112, s[24:27], s30 offen offset:0 sc1
  v_mfma_f32_16x16x32_bf16 v[24:27], v[240:243], a[228:231], v[24:27]
  v_mfma_f32_16x16x32_bf16 v[28:31], v[240:243], v[144:147], v[28:31]
  v_mfma_f32_16x16x32_bf16 v[28:31], v[220:223], a[232:235], v[28:31]
  v_mfma_f32_16x16x32_bf16 v[32:35], v[224:227], a[252:255], v[32:35]
  buffer_load_dwordx4 a[160:163], v112, s[24:27], s30 offen offset:1024 sc1
  v_mfma_f32_16x16x32_bf16 v[32:35], v[244:247], a[200:203], v[32:35]
  v_mfma_f32_16x16x32_bf16 v[36:39], v[244:247], a[212:215], v[36:39]
  v_mfma_f32_16x16x32_bf16 v[36:39], v[224:227], a[168:171], v[36:39]
  v_mfma_f32_16x16x32_bf16 v[40:43], v[224:227], a[216:219], v[40:43]
  buffer_load_dwordx4 a[164:167], v113, s[24:27], s30 offen offset:0 sc1
  v_mfma_f32_16x16x32_bf16 v[40:43], v[244:247], a[228:231], v[40:43]
  v_mfma_f32_16x16x32_bf16 v[44:47], v[244:247], v[144:147], v[44:47]
  v_mfma_f32_16x16x32_bf16 v[44:47], v[224:227], a[232:235], v[44:47]
  v_mfma_f32_16x16x32_bf16 v[48:51], v[228:231], a[252:255], v[48:51]
  buffer_load_dwordx4 a[176:179], v113, s[24:27], s30 offen offset:1024 sc1
  v_mfma_f32_16x16x32_bf16 v[48:51], v[248:251], a[200:203], v[48:51]
  v_mfma_f32_16x16x32_bf16 v[52:55], v[248:251], a[212:215], v[52:55]
  v_mfma_f32_16x16x32_bf16 v[52:55], v[228:231], a[168:171], v[52:55]
  v_mfma_f32_16x16x32_bf16 v[56:59], v[228:231], a[216:219], v[56:59]
  s_add_u32 s30, s30, 8192
  buffer_load_dwordx4 a[180:183], v110, s[24:27], s30 offen offset:0 sc1
  v_mfma_f32_16x16x32_bf16 v[56:59], v[248:251], a[228:231], v[56:59]
  v_mfma_f32_16x16x32_bf16 v[60:63], v[248:251], v[144:147], v[60:63]
  v_mfma_f32_16x16x32_bf16 v[60:63], v[228:231], a[232:235], v[60:63]
  v_mfma_f32_16x16x32_bf16 v[64:67], v[232:235], a[252:255], v[64:67]
  buffer_load_dwordx4 a[192:195], v110, s[24:27], s30 offen offset:1024 sc1
  v_mfma_f32_16x16x32_bf16 v[64:67], v[252:255], a[200:203], v[64:67]
  v_mfma_f32_16x16x32_bf16 v[68:71], v[252:255], a[212:215], v[68:71]
  v_mfma_f32_16x16x32_bf16 v[68:71], v[232:235], a[168:171], v[68:71]
  v_mfma_f32_16x16x32_bf16 v[72:75], v[232:235], a[216:219], v[72:75]
  buffer_load_dwordx4 a[196:199], v111, s[24:27], s30 offen offset:0 sc1
  v_mfma_f32_16x16x32_bf16 v[72:75], v[252:255], a[228:231], v[72:75]
  v_mfma_f32_16x16x32_bf16 v[76:79], v[252:255], v[144:147], v[76:79]
  v_mfma_f32_16x16x32_bf16 v[76:79], v[232:235], a[232:235], v[76:79]
  s_waitcnt vmcnt(32)
  v_mfma_f32_16x16x32_bf16 v[0:3], a[0:3], a[144:147], v[0:3]
  buffer_load_dwordx4 v[216:219], v111, s[24:27], s30 offen offset:1024 sc1
  v_mfma_f32_16x16x32_bf16 v[0:3], a[20:23], a[156:159], v[0:3]
  v_mfma_f32_16x16x32_bf16 v[4:7], a[20:23], a[184:187], v[4:7]
  v_mfma_f32_16x16x32_bf16 v[4:7], a[0:3], a[172:175], v[4:7]
  v_mfma_f32_16x16x32_bf16 v[8:11], a[0:3], a[188:191], v[8:11]
  buffer_load_dwordx4 v[236:239], v112, s[24:27], s30 offen offset:0 sc1
  v_mfma_f32_16x16x32_bf16 v[8:11], a[20:23], a[204:207], v[8:11]
  v_mfma_f32_16x16x32_bf16 v[12:15], a[20:23], a[220:223], v[12:15]
  v_mfma_f32_16x16x32_bf16 v[12:15], a[0:3], a[208:211], v[12:15]
  v_mfma_f32_16x16x32_bf16 v[16:19], a[4:7], a[144:147], v[16:19]
  buffer_load_dwordx4 v[220:223], v112, s[24:27], s30 offen offset:1024 sc1
  v_mfma_f32_16x16x32_bf16 v[16:19], a[24:27], a[156:159], v[16:19]
  v_mfma_f32_16x16x32_bf16 v[20:23], a[24:27], a[184:187], v[20:23]
  v_mfma_f32_16x16x32_bf16 v[20:23], a[4:7], a[172:175], v[20:23]
  v_mfma_f32_16x16x32_bf16 v[24:27], a[4:7], a[188:191], v[24:27]
  buffer_load_dwordx4 v[240:243], v113, s[24:27], s30 offen offset:0 sc1
  v_mfma_f32_16x16x32_bf16 v[24:27], a[24:27], a[204:207], v[24:27]
  v_mfma_f32_16x16x32_bf16 v[28:31], a[24:27], a[220:223], v[28:31]
  v_mfma_f32_16x16x32_bf16 v[28:31], a[4:7], a[208:211], v[28:31]
  v_mfma_f32_16x16x32_bf16 v[32:35], a[8:11], a[144:147], v[32:35]
  buffer_load_dwordx4 v[224:227], v113, s[24:27], s30 offen offset:1024 sc1
  v_mfma_f32_16x16x32_bf16 v[32:35], a[28:31], a[156:159], v[32:35]
  v_mfma_f32_16x16x32_bf16 v[36:39], a[28:31], a[184:187], v[36:39]
  v_mfma_f32_16x16x32_bf16 v[36:39], a[8:11], a[172:175], v[36:39]
  v_mfma_f32_16x16x32_bf16 v[40:43], a[8:11], a[188:191], v[40:43]
  s_add_u32 s30, s30, 8192
  buffer_load_dwordx4 v[244:247], v110, s[24:27], s30 offen offset:0 sc1
  v_mfma_f32_16x16x32_bf16 v[40:43], a[28:31], a[204:207], v[40:43]
  v_mfma_f32_16x16x32_bf16 v[44:47], a[28:31], a[220:223], v[44:47]
  v_mfma_f32_16x16x32_bf16 v[44:47], a[8:11], a[208:211], v[44:47]
  v_mfma_f32_16x16x32_bf16 v[48:51], a[12:15], a[144:147], v[48:51]
  buffer_load_dwordx4 v[228:231], v110, s[24:27], s30 offen offset:1024 sc1
  v_mfma_f32_16x16x32_bf16 v[48:51], a[32:35], a[156:159], v[48:51]
  v_mfma_f32_16x16x32_bf16 v[52:55], a[32:35], a[184:187], v[52:55]
  v_mfma_f32_16x16x32_bf16 v[52:55], a[12:15], a[172:175], v[52:55]
  v_mfma_f32_16x16x32_bf16 v[56:59], a[12:15], a[188:191], v[56:59]
  buffer_load_dwordx4 v[248:251], v111, s[24:27], s30 offen offset:0 sc1
  v_mfma_f32_16x16x32_bf16 v[56:59], a[32:35], a[204:207], v[56:59]
  v_mfma_f32_16x16x32_bf16 v[60:63], a[32:35], a[220:223], v[60:63]
  v_mfma_f32_16x16x32_bf16 v[60:63], a[12:15], a[208:211], v[60:63]
  v_mfma_f32_16x16x32_bf16 v[64:67], a[16:19], a[144:147], v[64:67]
  buffer_load_dwordx4 v[232:235], v111, s[24:27], s30 offen offset:1024 sc1
  v_mfma_f32_16x16x32_bf16 v[64:67], a[36:39], a[156:159], v[64:67]
  v_mfma_f32_16x16x32_bf16 v[68:71], a[36:39], a[184:187], v[68:71]
  v_mfma_f32_16x16x32_bf16 v[68:71], a[16:19], a[172:175], v[68:71]
  v_mfma_f32_16x16x32_bf16 v[72:75], a[16:19], a[188:191], v[72:75]
  buffer_load_dwordx4 v[252:255], v112, s[24:27], s30 offen offset:0 sc1
  v_mfma_f32_16x16x32_bf16 v[72:75], a[36:39], a[204:207], v[72:75]
  v_mfma_f32_16x16x32_bf16 v[76:79], a[36:39], a[220:223], v[76:79]
  v_mfma_f32_16x16x32_bf16 v[76:79], a[16:19], a[208:211], v[76:79]
  s_waitcnt vmcnt(34)
  v_mfma_f32_16x16x32_bf16 v[0:3], a[40:43], a[224:227], v[0:3]
  buffer_load_dwordx4 a[252:255], v112, s[24:27], s30 offen offset:1024 sc1
  s_waitcnt vmcnt(23)
  v_mfma_f32_16x16x32_bf16 v[0:3], a[60:63], a[236:239], v[0:3]
  buffer_atomic_add v127, v135, s[24:27], 0 offen
  v_mfma_f32_16x16x32_bf16 v[4:7], a[60:63], a[244:247], v[4:7]
  v_mfma_f32_16x16x32_bf16 v[4:7], a[40:43], a[240:243], v[4:7]
  v_mfma_f32_16x16x32_bf16 v[8:11], a[40:43], a[248:251], v[8:11]
  buffer_load_dwordx4 a[200:203], v113, s[24:27], s30 offen offset:0 sc1
  v_mfma_f32_16x16x32_bf16 v[8:11], a[60:63], v[136:139], v[8:11]
  v_mfma_f32_16x16x32_bf16 v[12:15], a[60:63], v[148:151], v[12:15]
  v_mfma_f32_16x16x32_bf16 v[12:15], a[40:43], v[140:143], v[12:15]
  v_mfma_f32_16x16x32_bf16 v[16:19], a[44:47], a[224:227], v[16:19]
  buffer_load_dwordx4 a[168:171], v113, s[24:27], s30 offen offset:1024 sc1
  v_mfma_f32_16x16x32_bf16 v[16:19], a[64:67], a[236:239], v[16:19]
  v_mfma_f32_16x16x32_bf16 v[20:23], a[64:67], a[244:247], v[20:23]
  v_mfma_f32_16x16x32_bf16 v[20:23], a[44:47], a[240:243], v[20:23]
  v_mfma_f32_16x16x32_bf16 v[24:27], a[44:47], a[248:251], v[24:27]
  s_add_u32 s30, s30, 8192
  v_mfma_f32_16x16x32_bf16 v[24:27], a[64:67], v[136:139], v[24:27]
  v_mfma_f32_16x16x32_bf16 v[28:31], a[64:67], v[148:151], v[28:31]
  v_mfma_f32_16x16x32_bf16 v[28:31], a[44:47], v[140:143], v[28:31]
  v_mfma_f32_16x16x32_bf16 v[32:35], a[48:51], a[224:227], v[32:35]
  v_mfma_f32_16x16x32_bf16 v[32:35], a[68:71], a[236:239], v[32:35]
  v_mfma_f32_16x16x32_bf16 v[36:39], a[68:71], a[244:247], v[36:39]
  v_mfma_f32_16x16x32_bf16 v[36:39], a[48:51], a[240:243], v[36:39]
  v_mfma_f32_16x16x32_bf16 v[40:43], a[48:51], a[248:251], v[40:43]
  v_mfma_f32_16x16x32_bf16 v[40:43], a[68:71], v[136:139], v[40:43]
  v_mfma_f32_16x16x32_bf16 v[44:47], a[68:71], v[148:151], v[44:47]
  v_mfma_f32_16x16x32_bf16 v[44:47], a[48:51], v[140:143], v[44:47]
  v_mfma_f32_16x16x32_bf16 v[48:51], a[52:55], a[224:227], v[48:51]
  v_mfma_f32_16x16x32_bf16 v[48:51], a[72:75], a[236:239], v[48:51]
  v_mfma_f32_16x16x32_bf16 v[52:55], a[72:75], a[244:247], v[52:55]
  v_mfma_f32_16x16x32_bf16 v[52:55], a[52:55], a[240:243], v[52:55]
  v_mfma_f32_16x16x32_bf16 v[56:59], a[52:55], a[248:251], v[56:59]
  v_mfma_f32_16x16x32_bf16 v[56:59], a[72:75], v[136:139], v[56:59]
  v_mfma_f32_16x16x32_bf16 v[60:63], a[72:75], v[148:151], v[60:63]
  v_mfma_f32_16x16x32_bf16 v[60:63], a[52:55], v[140:143], v[60:63]
  v_mfma_f32_16x16x32_bf16 v[64:67], a[56:59], a[224:227], v[64:67]
  v_mfma_f32_16x16x32_bf16 v[64:67], a[76:79], a[236:239], v[64:67]
  v_mfma_f32_16x16x32_bf16 v[68:71], a[76:79], a[244:247], v[68:71]
  v_mfma_f32_16x16x32_bf16 v[68:71], a[56:59], a[240:243], v[68:71]
  v_mfma_f32_16x16x32_bf16 v[72:75], a[56:59], a[248:251], v[72:75]
  v_mfma_f32_16x16x32_bf16 v[72:75], a[76:79], v[136:139], v[72:75]
  v_mfma_f32_16x16x32_bf16 v[76:79], a[76:79], v[148:151], v[76:79]
  v_mfma_f32_16x16x32_bf16 v[76:79], a[56:59], v[140:143], v[76:79]
  s_waitcnt vmcnt(25)
  v_mfma_f32_16x16x32_bf16 v[0:3], a[80:83], v[152:155], v[0:3]
  v_mfma_f32_16x16x32_bf16 v[0:3], a[100:103], v[176:179], v[0:3]
  v_mfma_f32_16x16x32_bf16 v[4:7], a[100:103], v[180:183], v[4:7]
  v_mfma_f32_16x16x32_bf16 v[4:7], a[80:83], v[196:199], v[4:7]
  v_mfma_f32_16x16x32_bf16 v[8:11], a[80:83], v[200:203], v[8:11]
  v_mfma_f32_16x16x32_bf16 v[8:11], a[100:103], v[184:187], v[8:11]
  v_mfma_f32_16x16x32_bf16 v[12:15], a[100:103], v[188:191], v[12:15]
  v_mfma_f32_16x16x32_bf16 v[12:15], a[80:83], v[204:207], v[12:15]
  v_mfma_f32_16x16x32_bf16 v[16:19], a[84:87], v[152:155], v[16:19]
  v_mfma_f32_16x16x32_bf16 v[16:19], a[104:107], v[176:179], v[16:19]
  v_mfma_f32_16x16x32_bf16 v[20:23], a[104:107], v[180:183], v[20:23]
  v_mfma_f32_16x16x32_bf16 v[20:23], a[84:87], v[196:199], v[20:23]
  v_mfma_f32_16x16x32_bf16 v[24:27], a[84:87], v[200:203], v[24:27]
  v_mfma_f32_16x16x32_bf16 v[24:27], a[104:107], v[184:187], v[24:27]
  v_mfma_f32_16x16x32_bf16 v[28:31], a[104:107], v[188:191], v[28:31]
  v_mfma_f32_16x16x32_bf16 v[28:31], a[84:87], v[204:207], v[28:31]
  v_mfma_f32_16x16x32_bf16 v[32:35], a[88:91], v[152:155], v[32:35]
  v_mfma_f32_16x16x32_bf16 v[32:35], a[108:111], v[176:179], v[32:35]
  v_mfma_f32_16x16x32_bf16 v[36:39], a[108:111], v[180:183], v[36:39]
  v_mfma_f32_16x16x32_bf16 v[36:39], a[88:91], v[196:199], v[36:39]
  v_mfma_f32_16x16x32_bf16 v[40:43], a[88:91], v[200:203], v[40:43]
  v_mfma_f32_16x16x32_bf16 v[40:43], a[108:111], v[184:187], v[40:43]
  v_mfma_f32_16x16x32_bf16 v[44:47], a[108:111], v[188:191], v[44:47]
  v_mfma_f32_16x16x32_bf16 v[44:47], a[88:91], v[204:207], v[44:47]
  v_mfma_f32_16x16x32_bf16 v[48:51], a[92:95], v[152:155], v[48:51]
  v_mfma_f32_16x16x32_bf16 v[48:51], a[112:115], v[176:179], v[48:51]
  v_mfma_f32_16x16x32_bf16 v[52:55], a[112:115], v[180:183], v[52:55]
  v_mfma_f32_16x16x32_bf16 v[52:55], a[92:95], v[196:199], v[52:55]
  v_mfma_f32_16x16x32_bf16 v[56:59], a[92:95], v[200:203], v[56:59]
  v_mfma_f32_16x16x32_bf16 v[56:59], a[112:115], v[184:187], v[56:59]
  v_mfma_f32_16x16x32_bf16 v[60:63], a[112:115], v[188:191], v[60:63]
  v_mfma_f32_16x16x32_bf16 v[60:63], a[92:95], v[204:207], v[60:63]
  v_mfma_f32_16x16x32_bf16 v[64:67], a[96:99], v[152:155], v[64:67]
  ds_read_b128 a[212:215], v122 offset:0
  v_mfma_f32_16x16x32_bf16 v[64:67], a[116:119], v[176:179], v[64:67]
  v_mfma_f32_16x16x32_bf16 v[68:71], a[116:119], v[180:183], v[68:71]
  v_mfma_f32_16x16x32_bf16 v[68:71], a[96:99], v[196:199], v[68:71]
  v_mfma_f32_16x16x32_bf16 v[72:75], a[96:99], v[200:203], v[72:75]
  v_mfma_f32_16x16x32_bf16 v[72:75], a[116:119], v[184:187], v[72:75]
  v_mfma_f32_16x16x32_bf16 v[76:79], a[116:119], v[188:191], v[76:79]
  v_mfma_f32_16x16x32_bf16 v[76:79], a[96:99], v[204:207], v[76:79]
  s_waitcnt vmcnt(17)
  v_mfma_f32_16x16x32_bf16 v[0:3], a[120:123], v[208:211], v[0:3]
  ds_read_b128 a[216:219], v122 offset:1024
  buffer_load_dword v128, v133, s[24:27], 0 offen sc1
  s_xor_b32 s38, s40, 0
  s_lshl_b32 s38, s38, 2
  s_add_u32 s38, s38, s3
  s_lshl_b32 s38, s38, 13
  s_add_u32 s38, s38, 25165824
  s_add_u32 s39, s38, 4096
  v_mfma_f32_16x16x32_bf16 v[0:3], a[140:143], v[192:195], v[0:3]
  v_mfma_f32_16x16x32_bf16 v[4:7], a[140:143], a[148:151], v[4:7]
  v_mfma_f32_16x16x32_bf16 v[4:7], a[120:123], v[212:215], v[4:7]
  v_mfma_f32_16x16x32_bf16 v[8:11], a[120:123], a[152:155], v[8:11]
  v_mfma_f32_16x16x32_bf16 v[8:11], a[140:143], a[160:163], v[8:11]
  v_mfma_f32_16x16x32_bf16 v[12:15], a[140:143], a[176:179], v[12:15]
  v_mfma_f32_16x16x32_bf16 v[12:15], a[120:123], a[164:167], v[12:15]
  s_waitcnt lgkmcnt(1)
  v_mfma_f32_16x16x32_bf16 v[16:19], a[124:127], v[208:211], v[16:19]
  ds_read_b128 a[228:231], v122 offset:2048
  v_mfma_f32_16x16x32_bf16 v[16:19], a[212:215], v[192:195], v[16:19]
  v_mfma_f32_16x16x32_bf16 v[20:23], a[212:215], a[148:151], v[20:23]
  v_mfma_f32_16x16x32_bf16 v[20:23], a[124:127], v[212:215], v[20:23]
  v_mfma_f32_16x16x32_bf16 v[24:27], a[124:127], a[152:155], v[24:27]
  v_mfma_f32_16x16x32_bf16 v[24:27], a[212:215], a[160:163], v[24:27]
  v_mfma_f32_16x16x32_bf16 v[28:31], a[212:215], a[176:179], v[28:31]
  v_mfma_f32_16x16x32_bf16 v[28:31], a[124:127], a[164:167], v[28:31]
  s_waitcnt lgkmcnt(1)
  v_mfma_f32_16x16x32_bf16 v[32:35], a[128:131], v[208:211], v[32:35]
  ds_read_b128 a[232:235], v122 offset:3072
  v_mfma_f32_16x16x32_bf16 v[32:35], a[216:219], v[192:195], v[32:35]
  v_mfma_f32_16x16x32_bf16 v[36:39], a[216:219], a[148:151], v[36:39]
  v_mfma_f32_16x16x32_bf16 v[36:39], a[128:131], v[212:215], v[36:39]
  v_mfma_f32_16x16x32_bf16 v[40:43], a[128:131], a[152:155], v[40:43]
  v_mfma_f32_16x16x32_bf16 v[40:43], a[216:219], a[160:163], v[40:43]
  v_mfma_f32_16x16x32_bf16 v[44:47], a[216:219], a[176:179], v[44:47]
  v_mfma_f32_16x16x32_bf16 v[44:47], a[128:131], a[164:167], v[44:47]
  s_waitcnt lgkmcnt(1)
  v_mfma_f32_16x16x32_bf16 v[48:51], a[132:135], v[208:211], v[48:51]
  ds_read_b128 a[0:3], v122 offset:4096
  ds_read_b128 a[20:23], v122 offset:9216
  v_mfma_f32_16x16x32_bf16 v[48:51], a[228:231], v[192:195], v[48:51]
  v_mfma_f32_16x16x32_bf16 v[52:55], a[228:231], a[148:151], v[52:55]
  v_mfma_f32_16x16x32_bf16 v[52:55], a[132:135], v[212:215], v[52:55]
  v_mfma_f32_16x16x32_bf16 v[56:59], a[132:135], a[152:155], v[56:59]
  v_mfma_f32_16x16x32_bf16 v[56:59], a[228:231], a[160:163], v[56:59]
  v_mfma_f32_16x16x32_bf16 v[60:63], a[228:231], a[176:179], v[60:63]
  v_mfma_f32_16x16x32_bf16 v[60:63], a[132:135], a[164:167], v[60:63]
  s_waitcnt lgkmcnt(2)
  v_mfma_f32_16x16x32_bf16 v[64:67], a[136:139], v[208:211], v[64:67]
  ds_read_b128 a[4:7], v122 offset:5120
  ds_read_b128 a[24:27], v122 offset:10240
  v_mfma_f32_16x16x32_bf16 v[64:67], a[232:235], v[192:195], v[64:67]
  v_mfma_f32_16x16x32_bf16 v[68:71], a[232:235], a[148:151], v[68:71]
  v_mfma_f32_16x16x32_bf16 v[68:71], a[136:139], v[212:215], v[68:71]
  v_mfma_f32_16x16x32_bf16 v[72:75], a[136:139], a[152:155], v[72:75]
  v_mfma_f32_16x16x32_bf16 v[72:75], a[232:235], a[160:163], v[72:75]
  v_mfma_f32_16x16x32_bf16 v[76:79], a[232:235], a[176:179], v[76:79]
  v_mfma_f32_16x16x32_bf16 v[76:79], a[136:139], a[164:167], v[76:79]
  s_waitcnt vmcnt(10) lgkmcnt(2)
  v_mfma_f32_16x16x32_bf16 v[0:3], a[0:3], a[180:183], v[0:3]
  ds_read_b128 a[8:11], v122 offset:6144
  ds_read_b128 a[28:31], v122 offset:11264
  v_mfma_f32_16x16x32_bf16 v[0:3], a[20:23], a[192:195], v[0:3]
  v_mfma_f32_16x16x32_bf16 v[4:7], a[20:23], v[216:219], v[4:7]
  v_mfma_f32_16x16x32_bf16 v[4:7], a[0:3], a[196:199], v[4:7]
  v_mfma_f32_16x16x32_bf16 v[8:11], a[0:3], v[236:239], v[8:11]
  v_mfma_f32_16x16x32_bf16 v[8:11], a[20:23], v[220:223], v[8:11]
  v_mfma_f32_16x16x32_bf16 v[12:15], a[20:23], v[224:227], v[12:15]
  v_mfma_f32_16x16x32_bf16 v[12:15], a[0:3], v[240:243], v[12:15]
  s_waitcnt lgkmcnt(2)
  v_mfma_f32_16x16x32_bf16 v[16:19], a[4:7], a[180:183], v[16:19]
  ds_read_b128 a[12:15], v122 offset:7168
  ds_read_b128 a[32:35], v122 offset:12288
  v_mfma_f32_16x16x32_bf16 v[16:19], a[24:27], a[192:195], v[16:19]
  v_mfma_f32_16x16x32_bf16 v[20:23], a[24:27], v[216:219], v[20:23]
  v_mfma_f32_16x16x32_bf16 v[20:23], a[4:7], a[196:199], v[20:23]
  v_mfma_f32_16x16x32_bf16 v[24:27], a[4:7], v[236:239], v[24:27]
  v_mfma_f32_16x16x32_bf16 v[24:27], a[24:27], v[220:223], v[24:27]
  v_mfma_f32_16x16x32_bf16 v[28:31], a[24:27], v[224:227], v[28:31]
  v_mfma_f32_16x16x32_bf16 v[28:31], a[4:7], v[240:243], v[28:31]
  s_waitcnt lgkmcnt(2)
  v_mfma_f32_16x16x32_bf16 v[32:35], a[8:11], a[180:183], v[32:35]
  ds_read_b128 a[16:19], v122 offset:8192
  ds_read_b128 a[36:39], v122 offset:13312
  v_mfma_f32_16x16x32_bf16 v[32:35], a[28:31], a[192:195], v[32:35]
  v_mfma_f32_16x16x32_bf16 v[36:39], a[28:31], v[216:219], v[36:39]
  v_mfma_f32_16x16x32_bf16 v[36:39], a[8:11], a[196:199], v[36:39]
  v_mfma_f32_16x16x32_bf16 v[40:43], a[8:11], v[236:239], v[40:43]
  v_mfma_f32_16x16x32_bf16 v[40:43], a[28:31], v[220:223], v[40:43]
  v_mfma_f32_16x16x32_bf16 v[44:47], a[28:31], v[224:227], v[44:47]
  v_mfma_f32_16x16x32_bf16 v[44:47], a[8:11], v[240:243], v[44:47]
  s_waitcnt lgkmcnt(2)
  v_mfma_f32_16x16x32_bf16 v[48:51], a[12:15], a[180:183], v[48:51]
  ds_read_b128 a[144:147], v122 offset:14336
  ds_read_b128 a[156:159], v122 offset:19456
  v_mfma_f32_16x16x32_bf16 v[48:51], a[32:35], a[192:195], v[48:51]
  v_mfma_f32_16x16x32_bf16 v[52:55], a[32:35], v[216:219], v[52:55]
  v_mfma_f32_16x16x32_bf16 v[52:55], a[12:15], a[196:199], v[52:55]
  v_mfma_f32_16x16x32_bf16 v[56:59], a[12:15], v[236:239], v[56:59]
  v_mfma_f32_16x16x32_bf16 v[56:59], a[32:35], v[220:223], v[56:59]
  v_mfma_f32_16x16x32_bf16 v[60:63], a[32:35], v[224:227], v[60:63]
  v_mfma_f32_16x16x32_bf16 v[60:63], a[12:15], v[240:243], v[60:63]
  s_waitcnt lgkmcnt(2)
  v_mfma_f32_16x16x32_bf16 v[64:67], a[16:19], a[180:183], v[64:67]
  ds_read_b128 a[172:175], v122 offset:15360
  ds_read_b128 a[184:187], v122 offset:20480
  v_mfma_f32_16x16x32_bf16 v[64:67], a[36:39], a[192:195], v[64:67]
  v_mfma_f32_16x16x32_bf16 v[68:71], a[36:39], v[216:219], v[68:71]
  v_mfma_f32_16x16x32_bf16 v[68:71], a[16:19], a[196:199], v[68:71]
  v_mfma_f32_16x16x32_bf16 v[72:75], a[16:19], v[236:239], v[72:75]
  v_mfma_f32_16x16x32_bf16 v[72:75], a[36:39], v[220:223], v[72:75]
  v_mfma_f32_16x16x32_bf16 v[76:79], a[36:39], v[224:227], v[76:79]
  v_mfma_f32_16x16x32_bf16 v[76:79], a[16:19], v[240:243], v[76:79]
  s_waitcnt vmcnt(0)
  v_cmp_lt_u32 vcc, v128, v134
  s_nop 0
  s_cbranch_vccz tail_partner
  s_mov_b32 s35, 32768
tail_spin2:
  s_sleep 2
  buffer_load_dword v128, v133, s[24:27], 0 offen sc1
  s_waitcnt vmcnt(0)
  v_cmp_lt_u32 vcc, v128, v134
  s_nop 0
  s_cbranch_vccz tail_partner
  s_sub_u32 s35, s35, 1
  s_cmp_lg_u32 s35, 0
  s_cbranch_scc1 tail_spin2
tail_partner:
  s_waitcnt lgkmcnt(2)
  v_mfma_f32_16x16x32_bf16 v[0:3], a[144:147], v[244:247], v[0:3]
  ds_read_b128 a[188:191], v122 offset:16384
  ds_read_b128 a[204:207], v122 offset:21504
  v_mfma_f32_16x16x32_bf16 v[0:3], a[156:159], v[228:231], v[0:3]
  buffer_load_dwordx4 v[136:139], v114, s[24:27], s38 offen offset:0 sc1
  v_mfma_f32_16x16x32_bf16 v[4:7], a[156:159], v[232:235], v[4:7]
  buffer_load_dwordx4 v[140:143], v114, s[24:27], s38 offen offset:1024 sc1
  v_mfma_f32_16x16x32_bf16 v[4:7], a[144:147], v[248:251], v[4:7]
  buffer_load_dwordx4 v[144:147], v114, s[24:27], s38 offen offset:2048 sc1
  v_mfma_f32_16x16x32_bf16 v[8:11], a[144:147], v[252:255], v[8:11]
  buffer_load_dwordx4 v[148:151], v114, s[24:27], s38 offen offset:3072 sc1
  v_mfma_f32_16x16x32_bf16 v[8:11], a[156:159], a[252:255], v[8:11]
  buffer_load_dwordx4 v[152:155], v114, s[24:27], s39 offen offset:0 sc1
  v_mfma_f32_16x16x32_bf16 v[12:15], a[156:159], a[168:171], v[12:15]
  v_mfma_f32_16x16x32_bf16 v[12:15], a[144:147], a[200:203], v[12:15]
  s_waitcnt lgkmcnt(2)
  v_mfma_f32_16x16x32_bf16 v[16:19], a[172:175], v[244:247], v[16:19]
  ds_read_b128 a[208:211], v122 offset:17408
  ds_read_b128 a[220:223], v122 offset:22528
  v_mfma_f32_16x16x32_bf16 v[16:19], a[184:187], v[228:231], v[16:19]
  ds_write_b128 v122, v[4:7] offset:0
  ds_write_b128 v122, v[8:11] offset:5120
  v_mfma_f32_16x16x32_bf16 v[20:23], a[184:187], v[232:235], v[20:23]
  ds_write_b128 v122, v[12:15] offset:10240
  v_mfma_f32_16x16x32_bf16 v[20:23], a[172:175], v[248:251], v[20:23]
  v_mfma_f32_16x16x32_bf16 v[24:27], a[172:175], v[252:255], v[24:27]
  v_mfma_f32_16x16x32_bf16 v[24:27], a[184:187], a[252:255], v[24:27]
  v_mfma_f32_16x16x32_bf16 v[28:31], a[184:187], a[168:171], v[28:31]
  v_mfma_f32_16x16x32_bf16 v[28:31], a[172:175], a[200:203], v[28:31]
  s_waitcnt lgkmcnt(5)
  v_mfma_f32_16x16x32_bf16 v[32:35], a[188:191], v[244:247], v[32:35]
  ds_read_b128 a[40:43], v122 offset:18432
  ds_read_b128 a[60:63], v122 offset:23552
  v_mfma_f32_16x16x32_bf16 v[32:35], a[204:207], v[228:231], v[32:35]
  ds_write_b128 v122, v[20:23] offset:1024
  ds_write_b128 v122, v[24:27] offset:6144
  v_mfma_f32_16x16x32_bf16 v[36:39], a[204:207], v[232:235], v[36:39]
  ds_write_b128 v122, v[28:31] offset:11264
  v_mfma_f32_16x16x32_bf16 v[36:39], a[188:191], v[248:251], v[36:39]
  v_mfma_f32_16x16x32_bf16 v[40:43], a[188:191], v[252:255], v[40:43]
  v_mfma_f32_16x16x32_bf16 v[40:43], a[204:207], a[252:255], v[40:43]
  v_mfma_f32_16x16x32_bf16 v[44:47], a[204:207], a[168:171], v[44:47]
  v_mfma_f32_16x16x32_bf16 v[44:47], a[188:191], a[200:203], v[44:47]
  s_waitcnt lgkmcnt(8)
  v_mfma_f32_16x16x32_bf16 v[48:51], a[208:211], v[244:247], v[48:51]
  v_mfma_f32_16x16x32_bf16 v[48:51], a[220:223], v[228:231], v[48:51]
  v_mfma_f32_16x16x32_bf16 v[52:55], a[220:223], v[232:235], v[52:55]
  ds_write_b128 v122, v[36:39] offset:2048
  v_mfma_f32_16x16x32_bf16 v[52:55], a[208:211], v[248:251], v[52:55]
  ds_write_b128 v122, v[40:43] offset:7168
  v_mfma_f32_16x16x32_bf16 v[56:59], a[208:211], v[252:255], v[56:59]
  ds_write_b128 v122, v[44:47] offset:12288
  v_mfma_f32_16x16x32_bf16 v[56:59], a[220:223], a[252:255], v[56:59]
  v_mfma_f32_16x16x32_bf16 v[60:63], a[220:223], a[168:171], v[60:63]
  v_mfma_f32_16x16x32_bf16 v[60:63], a[208:211], a[200:203], v[60:63]
  s_waitcnt lgkmcnt(6)
  v_mfma_f32_16x16x32_bf16 v[64:67], a[40:43], v[244:247], v[64:67]
  ds_write_b128 v122, v[52:55] offset:3072
  v_mfma_f32_16x16x32_bf16 v[64:67], a[60:63], v[228:231], v[64:67]
  v_mfma_f32_16x16x32_bf16 v[68:71], a[60:63], v[232:235], v[68:71]
  v_mfma_f32_16x16x32_bf16 v[68:71], a[40:43], v[248:251], v[68:71]
  ds_write_b128 v122, v[56:59] offset:8192
  v_mfma_f32_16x16x32_bf16 v[72:75], a[40:43], v[252:255], v[72:75]
  ds_write_b128 v122, v[60:63] offset:13312
  v_mfma_f32_16x16x32_bf16 v[72:75], a[60:63], a[252:255], v[72:75]
  v_mfma_f32_16x16x32_bf16 v[76:79], a[60:63], a[168:171], v[76:79]
  v_mfma_f32_16x16x32_bf16 v[76:79], a[40:43], a[200:203], v[76:79]
  s_nop 1
  ds_write_b128 v122, v[68:71] offset:4096
  s_nop 2
  ds_write_b128 v122, v[72:75] offset:9216
  s_nop 0
  ds_write_b128 v122, v[76:79] offset:14336
  s_waitcnt lgkmcnt(0)
  s_barrier
  ds_read_b128 v[4:7], v80 offset:0
  ds_read_b128 v[8:11], v81 offset:0
  ds_read_b128 v[12:15], v82 offset:0
  ds_read_b128 v[20:23], v80 offset:1024
  ds_read_b128 v[24:27], v81 offset:1024
  ds_read_b128 v[28:31], v82 offset:1024
  ds_read_b128 v[36:39], v80 offset:2048
  ds_read_b128 v[40:43], v81 offset:2048
  ds_read_b128 v[44:47], v82 offset:2048
  ds_read_b128 v[52:55], v80 offset:3072
  ds_read_b128 v[56:59], v81 offset:3072
  ds_read_b128 v[60:63], v82 offset:3072
  ds_read_b128 v[68:71], v80 offset:4096
  ds_read_b128 v[72:75], v81 offset:4096
  ds_read_b128 v[76:79], v82 offset:4096
  s_waitcnt vmcnt(4)
  v_add_f32 v0, v0, v136
  v_add_f32 v1, v1, v137
  v_add_f32 v2, v2, v138
  v_add_f32 v3, v3, v139
  s_waitcnt lgkmcnt(13)
  v_add_f32 v4, v4, v8
  v_add_f32 v5, v5, v9
  v_add_f32 v6, v6, v10
  v_add_f32 v7, v7, v11
  s_waitcnt lgkmcnt(12)
  v_add_f32 v0, v0, v12
  v_add_f32 v1, v1, v13
  v_add_f32 v2, v2, v14
  v_add_f32 v3, v3, v15
  v_add_f32 v0, v0, v4
  v_add_f32 v1, v1, v5
  v_add_f32 v2, v2, v6
  v_add_f32 v3, v3, v7
  v_cvt_pk_bf16_f32 v4, v0, v1
  v_cvt_pk_bf16_f32 v5, v2, v3
  v_lshlrev_b32 v0, 16, v4
  v_and_b32 v1, s34, v4
  v_lshlrev_b32 v2, 16, v5
  v_and_b32 v3, s34, v5
  v_mul_f32 v0, v0, v90
  v_mul_f32 v1, v1, v91
  v_mul_f32 v2, v2, v92
  v_mul_f32 v3, v3, v93
  v_cvt_pk_bf16_f32 v4, v0, v1
  v_cvt_pk_bf16_f32 v5, v2, v3
  v_lshlrev_b32 v0, 16, v4
  v_and_b32 v1, s34, v4
  v_lshlrev_b32 v2, 16, v5
  v_and_b32 v3, s34, v5
  v_add_f32 v0, v0, v156
  v_add_f32 v1, v1, v157
  v_add_f32 v2, v2, v158
  v_add_f32 v3, v3, v159
  v_cvt_pk_bf16_f32 v4, v0, v1
  v_cvt_pk_bf16_f32 v5, v2, v3
  buffer_store_dwordx2 v[4:5], v117, s[16:19], 0 offen offset:0
  s_waitcnt vmcnt(4)
  v_add_f32 v16, v16, v140
  v_add_f32 v17, v17, v141
  v_add_f32 v18, v18, v142
  v_add_f32 v19, v19, v143
  s_waitcnt lgkmcnt(10)
  v_add_f32 v20, v20, v24
  v_add_f32 v21, v21, v25
  v_add_f32 v22, v22, v26
  v_add_f32 v23, v23, v27
  s_waitcnt lgkmcnt(9)
  v_add_f32 v16, v16, v28
  v_add_f32 v17, v17, v29
  v_add_f32 v18, v18, v30
  v_add_f32 v19, v19, v31
  v_add_f32 v16, v16, v20
  v_add_f32 v17, v17, v21
  v_add_f32 v18, v18, v22
  v_add_f32 v19, v19, v23
  v_cvt_pk_bf16_f32 v20, v16, v17
  v_cvt_pk_bf16_f32 v21, v18, v19
  v_lshlrev_b32 v16, 16, v20
  v_and_b32 v17, s34, v20
  v_lshlrev_b32 v18, 16, v21
  v_and_b32 v19, s34, v21
  v_mul_f32 v16, v16, v94
  v_mul_f32 v17, v17, v95
  v_mul_f32 v18, v18, v96
  v_mul_f32 v19, v19, v97
  v_cvt_pk_bf16_f32 v20, v16, v17
  v_cvt_pk_bf16_f32 v21, v18, v19
  v_lshlrev_b32 v16, 16, v20
  v_and_b32 v17, s34, v20
  v_lshlrev_b32 v18, 16, v21
  v_and_b32 v19, s34, v21
  v_add_f32 v16, v16, v160
  v_add_f32 v17, v17, v161
  v_add_f32 v18, v18, v162
  v_add_f32 v19, v19, v163
  v_cvt_pk_bf16_f32 v20, v16, v17
  v_cvt_pk_bf16_f32 v21, v18, v19
  buffer_store_dwordx2 v[20:21], v117, s[16:19], 0 offen offset:32
  s_waitcnt vmcnt(4)
  v_add_f32 v32, v32, v144
  v_add_f32 v33, v33, v145
  v_add_f32 v34, v34, v146
  v_add_f32 v35, v35, v147
  s_waitcnt lgkmcnt(7)
  v_add_f32 v36, v36, v40
  v_add_f32 v37, v37, v41
  v_add_f32 v38, v38, v42
  v_add_f32 v39, v39, v43
  s_waitcnt lgkmcnt(6)
  v_add_f32 v32, v32, v44
  v_add_f32 v33, v33, v45
  v_add_f32 v34, v34, v46
  v_add_f32 v35, v35, v47
  v_add_f32 v32, v32, v36
  v_add_f32 v33, v33, v37
  v_add_f32 v34, v34, v38
  v_add_f32 v35, v35, v39
  v_cvt_pk_bf16_f32 v36, v32, v33
  v_cvt_pk_bf16_f32 v37, v34, v35
  v_lshlrev_b32 v32, 16, v36
  v_and_b32 v33, s34, v36
  v_lshlrev_b32 v34, 16, v37
  v_and_b32 v35, s34, v37
  v_mul_f32 v32, v32, v98
  v_mul_f32 v33, v33, v99
  v_mul_f32 v34, v34, v100
  v_mul_f32 v35, v35, v101
  v_cvt_pk_bf16_f32 v36, v32, v33
  v_cvt_pk_bf16_f32 v37, v34, v35
  v_lshlrev_b32 v32, 16, v36
  v_and_b32 v33, s34, v36
  v_lshlrev_b32 v34, 16, v37
  v_and_b32 v35, s34, v37
  v_add_f32 v32, v32, v164
  v_add_f32 v33, v33, v165
  v_add_f32 v34, v34, v166
  v_add_f32 v35, v35, v167
  v_cvt_pk_bf16_f32 v36, v32, v33
  v_cvt_pk_bf16_f32 v37, v34, v35
  buffer_store_dwordx2 v[36:37], v117, s[16:19], 0 offen offset:64
  s_waitcnt vmcnt(4)
  v_add_f32 v48, v48, v148
  v_add_f32 v49, v49, v149
  v_add_f32 v50, v50, v150
  v_add_f32 v51, v51, v151
  s_waitcnt lgkmcnt(4)
  v_add_f32 v52, v52, v56
  v_add_f32 v53, v53, v57
  v_add_f32 v54, v54, v58
  v_add_f32 v55, v55, v59
  s_waitcnt lgkmcnt(3)
  v_add_f32 v48, v48, v60
  v_add_f32 v49, v49, v61
  v_add_f32 v50, v50, v62
  v_add_f32 v51, v51, v63
  v_add_f32 v48, v48, v52
  v_add_f32 v49, v49, v53
  v_add_f32 v50, v50, v54
  v_add_f32 v51, v51, v55
  v_cvt_pk_bf16_f32 v52, v48, v49
  v_cvt_pk_bf16_f32 v53, v50, v51
  v_lshlrev_b32 v48, 16, v52
  v_and_b32 v49, s34, v52
  v_lshlrev_b32 v50, 16, v53
  v_and_b32 v51, s34, v53
  v_mul_f32 v48, v48, v102
  v_mul_f32 v49, v49, v103
  v_mul_f32 v50, v50, v104
  v_mul_f32 v51, v51, v105
  v_cvt_pk_bf16_f32 v52, v48, v49
  v_cvt_pk_bf16_f32 v53, v50, v51
  v_lshlrev_b32 v48, 16, v52
  v_and_b32 v49, s34, v52
  v_lshlrev_b32 v50, 16, v53
  v_and_b32 v51, s34, v53
  v_add_f32 v48, v48, v168
  v_add_f32 v49, v49, v169
  v_add_f32 v50, v50, v170
  v_add_f32 v51, v51, v171
  v_cvt_pk_bf16_f32 v52, v48, v49
  v_cvt_pk_bf16_f32 v53, v50, v51
  buffer_store_dwordx2 v[52:53], v117, s[16:19], 0 offen offset:96
  s_waitcnt vmcnt(4)
  v_add_f32 v64, v64, v152
  v_add_f32 v65, v65, v153
  v_add_f32 v66, v66, v154
  v_add_f32 v67, v67, v155
  s_waitcnt lgkmcnt(1)
  v_add_f32 v68, v68, v72
  v_add_f32 v69, v69, v73
  v_add_f32 v70, v70, v74
  v_add_f32 v71, v71, v75
  s_waitcnt lgkmcnt(0)
  v_add_f32 v64, v64, v76
  v_add_f32 v65, v65, v77
  v_add_f32 v66, v66, v78
  v_add_f32 v67, v67, v79
  v_add_f32 v64, v64, v68
  v_add_f32 v65, v65, v69
  v_add_f32 v66, v66, v70
  v_add_f32 v67, v67, v71
  v_cvt_pk_bf16_f32 v68, v64, v65
  v_cvt_pk_bf16_f32 v69, v66, v67
  v_lshlrev_b32 v64, 16, v68
  v_and_b32 v65, s34, v68
  v_lshlrev_b32 v66, 16, v69
  v_and_b32 v67, s34, v69
  v_mul_f32 v64, v64, v106
  v_mul_f32 v65, v65, v107
  v_mul_f32 v66, v66, v108
  v_mul_f32 v67, v67, v109
  v_cvt_pk_bf16_f32 v68, v64, v65
  v_cvt_pk_bf16_f32 v69, v66, v67
  v_lshlrev_b32 v64, 16, v68
  v_and_b32 v65, s34, v68
  v_lshlrev_b32 v66, 16, v69
  v_and_b32 v67, s34, v69
  v_add_f32 v64, v64, v172
  v_add_f32 v65, v65, v173
  v_add_f32 v66, v66, v174
  v_add_f32 v67, v67, v175
  v_cvt_pk_bf16_f32 v68, v64, v65
  v_cvt_pk_bf16_f32 v69, v66, v67
  buffer_store_dwordx2 v[68:69], v117, s[16:19], 0 offen offset:128
attn_end:
  s_endpgm
attn_redo:
  s_waitcnt vmcnt(0)
  v_accvgpr_write_b32 a0, 0
  v_accvgpr_write_b32 a1, 0
  v_accvgpr_write_b32 a2, 0
  v_accvgpr_write_b32 a3, 0
  v_accvgpr_write_b32 a4, 0
  v_accvgpr_write_b32 a5, 0
  v_accvgpr_write_b32 a6, 0
  v_accvgpr_write_b32 a7, 0
  v_accvgpr_write_b32 a8, 0
  v_accvgpr_write_b32 a9, 0
  v_accvgpr_write_b32 a10, 0
  v_accvgpr_write_b32 a11, 0
  v_accvgpr_write_b32 a12, 0
  v_accvgpr_write_b32 a13, 0
  v_accvgpr_write_b32 a14, 0
  v_accvgpr_write_b32 a15, 0
  v_accvgpr_write_b32 a16, 0
  v_accvgpr_write_b32 a17, 0
  v_accvgpr_write_b32 a18, 0
  v_accvgpr_write_b32 a19, 0
  v_accvgpr_write_b32 a20, 0
  v_accvgpr_write_b32 a21, 0
  v_accvgpr_write_b32 a22, 0
  v_accvgpr_write_b32 a23, 0
  v_accvgpr_write_b32 a24, 0
  v_accvgpr_write_b32 a25, 0
  v_accvgpr_write_b32 a26, 0
  v_accvgpr_write_b32 a27, 0
  v_accvgpr_write_b32 a28, 0
  v_accvgpr_write_b32 a29, 0
  v_accvgpr_write_b32 a30, 0
  v_accvgpr_write_b32 a31, 0
  v_accvgpr_write_b32 a32, 0
  v_accvgpr_write_b32 a33, 0
  v_accvgpr_write_b32 a34, 0
  v_accvgpr_write_b32 a35, 0
  v_accvgpr_write_b32 a36, 0
  v_accvgpr_write_b32 a37, 0
  v_accvgpr_write_b32 a38, 0
  v_accvgpr_write_b32 a39, 0
  v_accvgpr_write_b32 a40, 0
  v_accvgpr_write_b32 a41, 0
  v_accvgpr_write_b32 a42, 0
  v_accvgpr_write_b32 a43, 0
  v_accvgpr_write_b32 a44, 0
  v_accvgpr_write_b32 a45, 0
  v_accvgpr_write_b32 a46, 0
  v_accvgpr_write_b32 a47, 0
  v_accvgpr_write_b32 a48, 0
  v_accvgpr_write_b32 a49, 0
  v_accvgpr_write_b32 a50, 0
  v_accvgpr_write_b32 a51, 0
  v_accvgpr_write_b32 a52, 0
  v_accvgpr_write_b32 a53, 0
  v_accvgpr_write_b32 a54, 0
  v_accvgpr_write_b32 a55, 0
  v_accvgpr_write_b32 a56, 0
  v_accvgpr_write_b32 a57, 0
  v_accvgpr_write_b32 a58, 0
  v_accvgpr_write_b32 a59, 0
  v_accvgpr_write_b32 a60, 0
  v_accvgpr_write_b32 a61, 0
  v_accvgpr_write_b32 a62, 0
  v_accvgpr_write_b32 a63, 0
  v_accvgpr_write_b32 a64, 0
  v_accvgpr_write_b32 a65, 0
  v_accvgpr_write_b32 a66, 0
  v_accvgpr_write_b32 a67, 0
  v_accvgpr_write_b32 a68, 0
  v_accvgpr_write_b32 a69, 0
  v_accvgpr_write_b32 a70, 0
  v_accvgpr_write_b32 a71, 0
  v_accvgpr_write_b32 a72, 0
  v_accvgpr_write_b32 a73, 0
  v_accvgpr_write_b32 a74, 0
  v_accvgpr_write_b32 a75, 0
  v_accvgpr_write_b32 a76, 0
  v_accvgpr_write_b32 a77, 0
  v_accvgpr_write_b32 a78, 0
  v_accvgpr_write_b32 a79, 0
  v_accvgpr_write_b32 a80, 0
  v_accvgpr_write_b32 a81, 0
  v_accvgpr_write_b32 a82, 0
  v_accvgpr_write_b32 a83, 0
  v_accvgpr_write_b32 a84, 0
  v_accvgpr_write_b32 a85, 0
  v_accvgpr_write_b32 a86, 0
  v_accvgpr_write_b32 a87, 0
  v_accvgpr_write_b32 a88, 0
  v_accvgpr_write_b32 a89, 0
  v_accvgpr_write_b32 a90, 0
  v_accvgpr_write_b32 a91, 0
  v_accvgpr_write_b32 a92, 0
  v_accvgpr_write_b32 a93, 0
  v_accvgpr_write_b32 a94, 0
  v_accvgpr_write_b32 a95, 0
  v_accvgpr_write_b32 a96, 0
  v_accvgpr_write_b32 a97, 0
  v_accvgpr_write_b32 a98, 0
  v_accvgpr_write_b32 a99, 0
  v_accvgpr_write_b32 a100, 0
  v_accvgpr_write_b32 a101, 0
  v_accvgpr_write_b32 a102, 0
  v_accvgpr_write_b32 a103, 0
  v_accvgpr_write_b32 a104, 0
  v_accvgpr_write_b32 a105, 0
  v_accvgpr_write_b32 a106, 0
  v_accvgpr_write_b32 a107, 0
  v_accvgpr_write_b32 a108, 0
  v_accvgpr_write_b32 a109, 0
  v_accvgpr_write_b32 a110, 0
  v_accvgpr_write_b32 a111, 0
  v_accvgpr_write_b32 a112, 0
  v_accvgpr_write_b32 a113, 0
  v_accvgpr_write_b32 a114, 0
  v_accvgpr_write_b32 a115, 0
  v_accvgpr_write_b32 a116, 0
  v_accvgpr_write_b32 a117, 0
  v_accvgpr_write_b32 a118, 0
  v_accvgpr_write_b32 a119, 0
  v_accvgpr_write_b32 a120, 0
  v_accvgpr_write_b32 a121, 0
  v_accvgpr_write_b32 a122, 0
  v_accvgpr_write_b32 a123, 0
  v_accvgpr_write_b32 a124, 0
  v_accvgpr_write_b32 a125, 0
  v_accvgpr_write_b32 a126, 0
  v_accvgpr_write_b32 a127, 0
  v_mov_b32 v208, 0
  v_mov_b32 v249, 0xff800000
  v_mov_b32 v209, 0
  v_mov_b32 v250, 0xff800000
  v_mov_b32 v210, 0
  v_mov_b32 v251, 0xff800000
  v_mov_b32 v211, 0
  v_mov_b32 v252, 0xff800000
  s_mov_b32 s29, 0
attn_slow:
  s_barrier
  s_add_u32 m0, s28, 0
  s_nop 0
  buffer_load_dwordx4 v232, s[12:15], s29 offen offset:0 lds
  buffer_load_dwordx4 v233, s[12:15], s29 offen offset:1024 lds
  buffer_load_dwordx4 v234, s[12:15], s29 offen offset:2048 lds
  buffer_load_dwordx4 v235, s[12:15], s29 offen offset:3072 lds
  s_add_u32 m0, s28, 65536
  s_nop 0
  buffer_load_dwordx4 v236, s[16:19], s29 offen offset:0 lds
  buffer_load_dwordx4 v237, s[16:19], s29 offen offset:1024 lds
  buffer_load_dwordx4 v236, s[16:19], s29 offen offset:2048 lds
  buffer_load_dwordx4 v237, s[16:19], s29 offen offset:3072 lds
  s_waitcnt vmcnt(0)
  s_barrier
  ds_read_b128 a[128:131], v212 offset:0
  ds_read_b128 a[132:135], v213 offset:0
  ds_read_b128 a[136:139], v214 offset:0
  ds_read_b128 a[140:143], v215 offset:0
  s_waitcnt lgkmcnt(3)
  v_mfma_f32_16x16x32_bf16 v[0:3], a[128:131], v[128:131], 0
  s_waitcnt lgkmcnt(2)
  v_mfma_f32_16x16x32_bf16 v[0:3], a[132:135], v[132:135], v[0:3]
  s_waitcnt lgkmcnt(1)
  v_mfma_f32_16x16x32_bf16 v[0:3], a[136:139], v[136:139], v[0:3]
  s_waitcnt lgkmcnt(0)
  v_mfma_f32_16x16x32_bf16 v[0:3], a[140:143], v[140:143], v[0:3]
  v_mfma_f32_16x16x32_bf16 v[8:11], a[140:143], v[156:159], 0
  v_mfma_f32_16x16x32_bf16 v[8:11], a[136:139], v[152:155], v[8:11]
  v_mfma_f32_16x16x32_bf16 v[8:11], a[132:135], v[148:151], v[8:11]
  v_mfma_f32_16x16x32_bf16 v[8:11], a[128:131], v[144:147], v[8:11]
  v_mfma_f32_16x16x32_bf16 v[16:19], a[128:131], v[160:163], 0
  v_mfma_f32_16x16x32_bf16 v[16:19], a[132:135], v[164:167], v[16:19]
  v_mfma_f32_16x16x32_bf16 v[16:19], a[136:139], v[168:171], v[16:19]
  v_mfma_f32_16x16x32_bf16 v[16:19], a[140:143], v[172:175], v[16:19]
  v_mfma_f32_16x16x32_bf16 v[24:27], a[140:143], v[188:191], 0
  v_mfma_f32_16x16x32_bf16 v[24:27], a[136:139], v[184:187], v[24:27]
  v_mfma_f32_16x16x32_bf16 v[24:27], a[132:135], v[180:183], v[24:27]
  v_mfma_f32_16x16x32_bf16 v[24:27], a[128:131], v[176:179], v[24:27]
  ds_read_b128 a[144:147], v212 offset:4096
  ds_read_b128 a[148:151], v213 offset:4096
  ds_read_b128 a[152:155], v214 offset:4096
  ds_read_b128 a[156:159], v215 offset:4096
  s_waitcnt lgkmcnt(3)
  v_mfma_f32_16x16x32_bf16 v[4:7], a[144:147], v[128:131], 0
  s_waitcnt lgkmcnt(2)
  v_mfma_f32_16x16x32_bf16 v[4:7], a[148:151], v[132:135], v[4:7]
  s_waitcnt lgkmcnt(1)
  v_mfma_f32_16x16x32_bf16 v[4:7], a[152:155], v[136:139], v[4:7]
  s_waitcnt lgkmcnt(0)
  v_mfma_f32_16x16x32_bf16 v[4:7], a[156:159], v[140:143], v[4:7]
  v_mfma_f32_16x16x32_bf16 v[12:15], a[156:159], v[156:159], 0
  v_mfma_f32_16x16x32_bf16 v[12:15], a[152:155], v[152:155], v[12:15]
  v_mfma_f32_16x16x32_bf16 v[12:15], a[148:151], v[148:151], v[12:15]
  v_mfma_f32_16x16x32_bf16 v[12:15], a[144:147], v[144:147], v[12:15]
  v_mfma_f32_16x16x32_bf16 v[20:23], a[144:147], v[160:163], 0
  v_mfma_f32_16x16x32_bf16 v[20:23], a[148:151], v[164:167], v[20:23]
  v_mfma_f32_16x16x32_bf16 v[20:23], a[152:155], v[168:171], v[20:23]
  v_mfma_f32_16x16x32_bf16 v[20:23], a[156:159], v[172:175], v[20:23]
  v_mfma_f32_16x16x32_bf16 v[28:31], a[156:159], v[188:191], 0
  v_mfma_f32_16x16x32_bf16 v[28:31], a[152:155], v[184:187], v[28:31]
  v_mfma_f32_16x16x32_bf16 v[28:31], a[148:151], v[180:183], v[28:31]
  v_mfma_f32_16x16x32_bf16 v[28:31], a[144:147], v[176:179], v[28:31]
  ds_read_b128 a[128:131], v212 offset:8192
  ds_read_b128 a[132:135], v213 offset:8192
  ds_read_b128 a[136:139], v214 offset:8192
  ds_read_b128 a[140:143], v215 offset:8192
  s_waitcnt lgkmcnt(3)
  v_mfma_f32_16x16x32_bf16 v[32:35], a[128:131], v[128:131], 0
  s_waitcnt lgkmcnt(2)
  v_mfma_f32_16x16x32_bf16 v[32:35], a[132:135], v[132:135], v[32:35]
  s_waitcnt lgkmcnt(1)
  v_mfma_f32_16x16x32_bf16 v[32:35], a[136:139], v[136:139], v[32:35]
  s_waitcnt lgkmcnt(0)
  v_mfma_f32_16x16x32_bf16 v[32:35], a[140:143], v[140:143], v[32:35]
  v_mfma_f32_16x16x32_bf16 v[40:43], a[140:143], v[156:159], 0
  v_mfma_f32_16x16x32_bf16 v[40:43], a[136:139], v[152:155], v[40:43]
  v_mfma_f32_16x16x32_bf16 v[40:43], a[132:135], v[148:151], v[40:43]
  v_mfma_f32_16x16x32_bf16 v[40:43], a[128:131], v[144:147], v[40:43]
  v_mfma_f32_16x16x32_bf16 v[48:51], a[128:131], v[160:163], 0
  v_mfma_f32_16x16x32_bf16 v[48:51], a[132:135], v[164:167], v[48:51]
  v_mfma_f32_16x16x32_bf16 v[48:51], a[136:139], v[168:171], v[48:51]
  v_mfma_f32_16x16x32_bf16 v[48:51], a[140:143], v[172:175], v[48:51]
  v_mfma_f32_16x16x32_bf16 v[56:59], a[140:143], v[188:191], 0
  v_mfma_f32_16x16x32_bf16 v[56:59], a[136:139], v[184:187], v[56:59]
  v_mfma_f32_16x16x32_bf16 v[56:59], a[132:135], v[180:183], v[56:59]
  v_mfma_f32_16x16x32_bf16 v[56:59], a[128:131], v[176:179], v[56:59]
  ds_read_b128 a[144:147], v212 offset:12288
  ds_read_b128 a[148:151], v213 offset:12288
  ds_read_b128 a[152:155], v214 offset:12288
  ds_read_b128 a[156:159], v215 offset:12288
  s_waitcnt lgkmcnt(3)
  v_mfma_f32_16x16x32_bf16 v[36:39], a[144:147], v[128:131], 0
  s_waitcnt lgkmcnt(2)
  v_mfma_f32_16x16x32_bf16 v[36:39], a[148:151], v[132:135], v[36:39]
  s_waitcnt lgkmcnt(1)
  v_mfma_f32_16x16x32_bf16 v[36:39], a[152:155], v[136:139], v[36:39]
  s_waitcnt lgkmcnt(0)
  v_mfma_f32_16x16x32_bf16 v[36:39], a[156:159], v[140:143], v[36:39]
  v_mfma_f32_16x16x32_bf16 v[44:47], a[156:159], v[156:159], 0
  v_mfma_f32_16x16x32_bf16 v[44:47], a[152:155], v[152:155], v[44:47]
  v_mfma_f32_16x16x32_bf16 v[44:47], a[148:151], v[148:151], v[44:47]
  v_mfma_f32_16x16x32_bf16 v[44:47], a[144:147], v[144:147], v[44:47]
  v_mfma_f32_16x16x32_bf16 v[52:55], a[144:147], v[160:163], 0
  v_mfma_f32_16x16x32_bf16 v[52:55], a[148:151], v[164:167], v[52:55]
  v_mfma_f32_16x16x32_bf16 v[52:55], a[152:155], v[168:171], v[52:55]
  v_mfma_f32_16x16x32_bf16 v[52:55], a[156:159], v[172:175], v[52:55]
  v_mfma_f32_16x16x32_bf16 v[60:63], a[156:159], v[188:191], 0
  v_mfma_f32_16x16x32_bf16 v[60:63], a[152:155], v[184:187], v[60:63]
  v_mfma_f32_16x16x32_bf16 v[60:63], a[148:151], v[180:183], v[60:63]
  v_mfma_f32_16x16x32_bf16 v[60:63], a[144:147], v[176:179], v[60:63]
  v_mov_b32 v192, v249
  v_max3_f32 v192, v192, v0, v1
  v_max3_f32 v192, v192, v2, v3
  v_max3_f32 v192, v192, v4, v5
  v_max3_f32 v192, v192, v6, v7
  v_max3_f32 v192, v192, v32, v33
  v_max3_f32 v192, v192, v34, v35
  v_max3_f32 v192, v192, v36, v37
  v_max3_f32 v192, v192, v38, v39
  v_mov_b32 v245, v192
  s_nop 1
  v_permlane16_swap_b32 v192, v245
  v_max_f32 v192, v192, v245
  v_mov_b32 v245, v192
  s_nop 1
  v_permlane32_swap_b32 v192, v245
  v_max_f32 v192, v192, v245
  v_sub_f32 v193, v249, v192
  v_exp_f32 v193, v193
  v_mov_b32 v249, v192
  v_mul_f32 v208, v208, v193
  v_sub_f32 v0, v0, v192
  v_sub_f32 v1, v1, v192
  v_sub_f32 v2, v2, v192
  v_sub_f32 v3, v3, v192
  v_sub_f32 v4, v4, v192
  v_sub_f32 v5, v5, v192
  v_sub_f32 v6, v6, v192
  v_sub_f32 v7, v7, v192
  v_sub_f32 v32, v32, v192
  v_sub_f32 v33, v33, v192
  v_sub_f32 v34, v34, v192
  v_sub_f32 v35, v35, v192
  v_sub_f32 v36, v36, v192
  v_sub_f32 v37, v37, v192
  v_sub_f32 v38, v38, v192
  v_sub_f32 v39, v39, v192
  v_exp_f32 v0, v0
  v_exp_f32 v1, v1
  v_add_f32 v208, v208, v0
  v_exp_f32 v2, v2
  v_add_f32 v208, v208, v1
  v_cvt_pk_bf16_f32 v0, v0, v1
  v_exp_f32 v3, v3
  v_add_f32 v208, v208, v2
  v_add_f32 v208, v208, v3
  v_cvt_pk_bf16_f32 v1, v2, v3
  v_exp_f32 v4, v4
  v_exp_f32 v5, v5
  v_add_f32 v208, v208, v4
  v_exp_f32 v6, v6
  v_add_f32 v208, v208, v5
  v_cvt_pk_bf16_f32 v2, v4, v5
  v_exp_f32 v7, v7
  v_add_f32 v208, v208, v6
  v_add_f32 v208, v208, v7
  v_cvt_pk_bf16_f32 v3, v6, v7
  v_exp_f32 v32, v32
  v_exp_f32 v33, v33
  v_add_f32 v208, v208, v32
  v_exp_f32 v34, v34
  v_add_f32 v208, v208, v33
  v_cvt_pk_bf16_f32 v32, v32, v33
  v_exp_f32 v35, v35
  v_add_f32 v208, v208, v34
  v_add_f32 v208, v208, v35
  v_cvt_pk_bf16_f32 v33, v34, v35
  v_exp_f32 v36, v36
  v_exp_f32 v37, v37
  v_add_f32 v208, v208, v36
  v_exp_f32 v38, v38
  v_add_f32 v208, v208, v37
  v_cvt_pk_bf16_f32 v34, v36, v37
  v_exp_f32 v39, v39
  v_add_f32 v208, v208, v38
  v_add_f32 v208, v208, v39
  v_cvt_pk_bf16_f32 v35, v38, v39
  v_accvgpr_read_b32 v64, a0
  v_accvgpr_read_b32 v65, a1
  v_accvgpr_read_b32 v66, a2
  v_accvgpr_read_b32 v67, a3
  v_mul_f32 v64, v64, v193
  v_mul_f32 v65, v65, v193
  v_mul_f32 v66, v66, v193
  v_mul_f32 v67, v67, v193
  v_accvgpr_write_b32 a0, v64
  v_accvgpr_write_b32 a1, v65
  v_accvgpr_write_b32 a2, v66
  v_accvgpr_write_b32 a3, v67
  v_accvgpr_read_b32 v64, a16
  v_accvgpr_read_b32 v65, a17
  v_accvgpr_read_b32 v66, a18
  v_accvgpr_read_b32 v67, a19
  v_mul_f32 v64, v64, v193
  v_mul_f32 v65, v65, v193
  v_mul_f32 v66, v66, v193
  v_mul_f32 v67, v67, v193
  v_accvgpr_write_b32 a16, v64
  v_accvgpr_write_b32 a17, v65
  v_accvgpr_write_b32 a18, v66
  v_accvgpr_write_b32 a19, v67
  v_accvgpr_read_b32 v64, a32
  v_accvgpr_read_b32 v65, a33
  v_accvgpr_read_b32 v66, a34
  v_accvgpr_read_b32 v67, a35
  v_mul_f32 v64, v64, v193
  v_mul_f32 v65, v65, v193
  v_mul_f32 v66, v66, v193
  v_mul_f32 v67, v67, v193
  v_accvgpr_write_b32 a32, v64
  v_accvgpr_write_b32 a33, v65
  v_accvgpr_write_b32 a34, v66
  v_accvgpr_write_b32 a35, v67
  v_accvgpr_read_b32 v64, a48
  v_accvgpr_read_b32 v65, a49
  v_accvgpr_read_b32 v66, a50
  v_accvgpr_read_b32 v67, a51
  v_mul_f32 v64, v64, v193
  v_mul_f32 v65, v65, v193
  v_mul_f32 v66, v66, v193
  v_mul_f32 v67, v67, v193
  v_accvgpr_write_b32 a48, v64
  v_accvgpr_write_b32 a49, v65
  v_accvgpr_write_b32 a50, v66
  v_accvgpr_write_b32 a51, v67
  v_accvgpr_read_b32 v64, a64
  v_accvgpr_read_b32 v65, a65
  v_accvgpr_read_b32 v66, a66
  v_accvgpr_read_b32 v67, a67
  v_mul_f32 v64, v64, v193
  v_mul_f32 v65, v65, v193
  v_mul_f32 v66, v66, v193
  v_mul_f32 v67, v67, v193
  v_accvgpr_write_b32 a64, v64
  v_accvgpr_write_b32 a65, v65
  v_accvgpr_write_b32 a66, v66
  v_accvgpr_write_b32 a67, v67
  v_accvgpr_read_b32 v64, a80
  v_accvgpr_read_b32 v65, a81
  v_accvgpr_read_b32 v66, a82
  v_accvgpr_read_b32 v67, a83
  v_mul_f32 v64, v64, v193
  v_mul_f32 v65, v65, v193
  v_mul_f32 v66, v66, v193
  v_mul_f32 v67, v67, v193
  v_accvgpr_write_b32 a80, v64
  v_accvgpr_write_b32 a81, v65
  v_accvgpr_write_b32 a82, v66
  v_accvgpr_write_b32 a83, v67
  v_accvgpr_read_b32 v64, a96
  v_accvgpr_read_b32 v65, a97
  v_accvgpr_read_b32 v66, a98
  v_accvgpr_read_b32 v67, a99
  v_mul_f32 v64, v64, v193
  v_mul_f32 v65, v65, v193
  v_mul_f32 v66, v66, v193
  v_mul_f32 v67, v67, v193
  v_accvgpr_write_b32 a96, v64
  v_accvgpr_write_b32 a97, v65
  v_accvgpr_write_b32 a98, v66
  v_accvgpr_write_b32 a99, v67
  v_accvgpr_read_b32 v64, a112
  v_accvgpr_read_b32 v65, a113
  v_accvgpr_read_b32 v66, a114
  v_accvgpr_read_b32 v67, a115
  v_mul_f32 v64, v64, v193
  v_mul_f32 v65, v65, v193
  v_mul_f32 v66, v66, v193
  v_mul_f32 v67, v67, v193
  v_accvgpr_write_b32 a112, v64
  v_accvgpr_write_b32 a113, v65
  v_accvgpr_write_b32 a114, v66
  v_accvgpr_write_b32 a115, v67
  v_mov_b32 v196, v250
  v_max3_f32 v196, v196, v8, v9
  v_max3_f32 v196, v196, v10, v11
  v_max3_f32 v196, v196, v12, v13
  v_max3_f32 v196, v196, v14, v15
  v_max3_f32 v196, v196, v40, v41
  v_max3_f32 v196, v196, v42, v43
  v_max3_f32 v196, v196, v44, v45
  v_max3_f32 v196, v196, v46, v47
  v_mov_b32 v245, v196
  s_nop 1
  v_permlane16_swap_b32 v196, v245
  v_max_f32 v196, v196, v245
  v_mov_b32 v245, v196
  s_nop 1
  v_permlane32_swap_b32 v196, v245
  v_max_f32 v196, v196, v245
  v_sub_f32 v197, v250, v196
  v_exp_f32 v197, v197
  v_mov_b32 v250, v196
  v_mul_f32 v209, v209, v197
  v_sub_f32 v8, v8, v196
  v_sub_f32 v9, v9, v196
  v_sub_f32 v10, v10, v196
  v_sub_f32 v11, v11, v196
  v_sub_f32 v12, v12, v196
  v_sub_f32 v13, v13, v196
  v_sub_f32 v14, v14, v196
  v_sub_f32 v15, v15, v196
  v_sub_f32 v40, v40, v196
  v_sub_f32 v41, v41, v196
  v_sub_f32 v42, v42, v196
  v_sub_f32 v43, v43, v196
  v_sub_f32 v44, v44, v196
  v_sub_f32 v45, v45, v196
  v_sub_f32 v46, v46, v196
  v_sub_f32 v47, v47, v196
  v_exp_f32 v8, v8
  v_exp_f32 v9, v9
  v_add_f32 v209, v209, v8
  v_exp_f32 v10, v10
  v_add_f32 v209, v209, v9
  v_cvt_pk_bf16_f32 v8, v8, v9
  v_exp_f32 v11, v11
  v_add_f32 v209, v209, v10
  v_add_f32 v209, v209, v11
  v_cvt_pk_bf16_f32 v9, v10, v11
  v_exp_f32 v12, v12
  v_exp_f32 v13, v13
  v_add_f32 v209, v209, v12
  v_exp_f32 v14, v14
  v_add_f32 v209, v209, v13
  v_cvt_pk_bf16_f32 v10, v12, v13
  v_exp_f32 v15, v15
  v_add_f32 v209, v209, v14
  v_add_f32 v209, v209, v15
  v_cvt_pk_bf16_f32 v11, v14, v15
  v_exp_f32 v40, v40
  v_exp_f32 v41, v41
  v_add_f32 v209, v209, v40
  v_exp_f32 v42, v42
  v_add_f32 v209, v209, v41
  v_cvt_pk_bf16_f32 v40, v40, v41
  v_exp_f32 v43, v43
  v_add_f32 v209, v209, v42
  v_add_f32 v209, v209, v43
  v_cvt_pk_bf16_f32 v41, v42, v43
  v_exp_f32 v44, v44
  v_exp_f32 v45, v45
  v_add_f32 v209, v209, v44
  v_exp_f32 v46, v46
  v_add_f32 v209, v209, v45
  v_cvt_pk_bf16_f32 v42, v44, v45
  v_exp_f32 v47, v47
  v_add_f32 v209, v209, v46
  v_add_f32 v209, v209, v47
  v_cvt_pk_bf16_f32 v43, v46, v47
  v_accvgpr_read_b32 v64, a4
  v_accvgpr_read_b32 v65, a5
  v_accvgpr_read_b32 v66, a6
  v_accvgpr_read_b32 v67, a7
  v_mul_f32 v64, v64, v197
  v_mul_f32 v65, v65, v197
  v_mul_f32 v66, v66, v197
  v_mul_f32 v67, v67, v197
  v_accvgpr_write_b32 a4, v64
  v_accvgpr_write_b32 a5, v65
  v_accvgpr_write_b32 a6, v66
  v_accvgpr_write_b32 a7, v67
  v_accvgpr_read_b32 v64, a20
  v_accvgpr_read_b32 v65, a21
  v_accvgpr_read_b32 v66, a22
  v_accvgpr_read_b32 v67, a23
  v_mul_f32 v64, v64, v197
  v_mul_f32 v65, v65, v197
  v_mul_f32 v66, v66, v197
  v_mul_f32 v67, v67, v197
  v_accvgpr_write_b32 a20, v64
  v_accvgpr_write_b32 a21, v65
  v_accvgpr_write_b32 a22, v66
  v_accvgpr_write_b32 a23, v67
  v_accvgpr_read_b32 v64, a36
  v_accvgpr_read_b32 v65, a37
  v_accvgpr_read_b32 v66, a38
  v_accvgpr_read_b32 v67, a39
  v_mul_f32 v64, v64, v197
  v_mul_f32 v65, v65, v197
  v_mul_f32 v66, v66, v197
  v_mul_f32 v67, v67, v197
  v_accvgpr_write_b32 a36, v64
  v_accvgpr_write_b32 a37, v65
  v_accvgpr_write_b32 a38, v66
  v_accvgpr_write_b32 a39, v67
  v_accvgpr_read_b32 v64, a52
  v_accvgpr_read_b32 v65, a53
  v_accvgpr_read_b32 v66, a54
  v_accvgpr_read_b32 v67, a55
  v_mul_f32 v64, v64, v197
  v_mul_f32 v65, v65, v197
  v_mul_f32 v66, v66, v197
  v_mul_f32 v67, v67, v197
  v_accvgpr_write_b32 a52, v64
  v_accvgpr_write_b32 a53, v65
  v_accvgpr_write_b32 a54, v66
  v_accvgpr_write_b32 a55, v67
  v_accvgpr_read_b32 v64, a68
  v_accvgpr_read_b32 v65, a69
  v_accvgpr_read_b32 v66, a70
  v_accvgpr_read_b32 v67, a71
  v_mul_f32 v64, v64, v197
  v_mul_f32 v65, v65, v197
  v_mul_f32 v66, v66, v197
  v_mul_f32 v67, v67, v197
  v_accvgpr_write_b32 a68, v64
  v_accvgpr_write_b32 a69, v65
  v_accvgpr_write_b32 a70, v66
  v_accvgpr_write_b32 a71, v67
  v_accvgpr_read_b32 v64, a84
  v_accvgpr_read_b32 v65, a85
  v_accvgpr_read_b32 v66, a86
  v_accvgpr_read_b32 v67, a87
  v_mul_f32 v64, v64, v197
  v_mul_f32 v65, v65, v197
  v_mul_f32 v66, v66, v197
  v_mul_f32 v67, v67, v197
  v_accvgpr_write_b32 a84, v64
  v_accvgpr_write_b32 a85, v65
  v_accvgpr_write_b32 a86, v66
  v_accvgpr_write_b32 a87, v67
  v_accvgpr_read_b32 v64, a100
  v_accvgpr_read_b32 v65, a101
  v_accvgpr_read_b32 v66, a102
  v_accvgpr_read_b32 v67, a103
  v_mul_f32 v64, v64, v197
  v_mul_f32 v65, v65, v197
  v_mul_f32 v66, v66, v197
  v_mul_f32 v67, v67, v197
  v_accvgpr_write_b32 a100, v64
  v_accvgpr_write_b32 a101, v65
  v_accvgpr_write_b32 a102, v66
  v_accvgpr_write_b32 a103, v67
  v_accvgpr_read_b32 v64, a116
  v_accvgpr_read_b32 v65, a117
  v_accvgpr_read_b32 v66, a118
  v_accvgpr_read_b32 v67, a119
  v_mul_f32 v64, v64, v197
  v_mul_f32 v65, v65, v197
  v_mul_f32 v66, v66, v197
  v_mul_f32 v67, v67, v197
  v_accvgpr_write_b32 a116, v64
  v_accvgpr_write_b32 a117, v65
  v_accvgpr_write_b32 a118, v66
  v_accvgpr_write_b32 a119, v67
  v_mov_b32 v200, v251
  v_max3_f32 v200, v200, v16, v17
  v_max3_f32 v200, v200, v18, v19
  v_max3_f32 v200, v200, v20, v21
  v_max3_f32 v200, v200, v22, v23
  v_max3_f32 v200, v200, v48, v49
  v_max3_f32 v200, v200, v50, v51
  v_max3_f32 v200, v200, v52, v53
  v_max3_f32 v200, v200, v54, v55
  v_mov_b32 v245, v200
  s_nop 1
  v_permlane16_swap_b32 v200, v245
  v_max_f32 v200, v200, v245
  v_mov_b32 v245, v200
  s_nop 1
  v_permlane32_swap_b32 v200, v245
  v_max_f32 v200, v200, v245
  v_sub_f32 v201, v251, v200
  v_exp_f32 v201, v201
  v_mov_b32 v251, v200
  v_mul_f32 v210, v210, v201
  v_sub_f32 v16, v16, v200
  v_sub_f32 v17, v17, v200
  v_sub_f32 v18, v18, v200
  v_sub_f32 v19, v19, v200
  v_sub_f32 v20, v20, v200
  v_sub_f32 v21, v21, v200
  v_sub_f32 v22, v22, v200
  v_sub_f32 v23, v23, v200
  v_sub_f32 v48, v48, v200
  v_sub_f32 v49, v49, v200
  v_sub_f32 v50, v50, v200
  v_sub_f32 v51, v51, v200
  v_sub_f32 v52, v52, v200
  v_sub_f32 v53, v53, v200
  v_sub_f32 v54, v54, v200
  v_sub_f32 v55, v55, v200
  v_exp_f32 v16, v16
  v_exp_f32 v17, v17
  v_add_f32 v210, v210, v16
  v_exp_f32 v18, v18
  v_add_f32 v210, v210, v17
  v_cvt_pk_bf16_f32 v16, v16, v17
  v_exp_f32 v19, v19
  v_add_f32 v210, v210, v18
  v_add_f32 v210, v210, v19
  v_cvt_pk_bf16_f32 v17, v18, v19
  v_exp_f32 v20, v20
  v_exp_f32 v21, v21
  v_add_f32 v210, v210, v20
  v_exp_f32 v22, v22
  v_add_f32 v210, v210, v21
  v_cvt_pk_bf16_f32 v18, v20, v21
  v_exp_f32 v23, v23
  v_add_f32 v210, v210, v22
  v_add_f32 v210, v210, v23
  v_cvt_pk_bf16_f32 v19, v22, v23
  v_exp_f32 v48, v48
  v_exp_f32 v49, v49
  v_add_f32 v210, v210, v48
  v_exp_f32 v50, v50
  v_add_f32 v210, v210, v49
  v_cvt_pk_bf16_f32 v48, v48, v49
  v_exp_f32 v51, v51
  v_add_f32 v210, v210, v50
  v_add_f32 v210, v210, v51
  v_cvt_pk_bf16_f32 v49, v50, v51
  v_exp_f32 v52, v52
  v_exp_f32 v53, v53
  v_add_f32 v210, v210, v52
  v_exp_f32 v54, v54
  v_add_f32 v210, v210, v53
  v_cvt_pk_bf16_f32 v50, v52, v53
  v_exp_f32 v55, v55
  v_add_f32 v210, v210, v54
  v_add_f32 v210, v210, v55
  v_cvt_pk_bf16_f32 v51, v54, v55
  v_accvgpr_read_b32 v64, a8
  v_accvgpr_read_b32 v65, a9
  v_accvgpr_read_b32 v66, a10
  v_accvgpr_read_b32 v67, a11
  v_mul_f32 v64, v64, v201
  v_mul_f32 v65, v65, v201
  v_mul_f32 v66, v66, v201
  v_mul_f32 v67, v67, v201
  v_accvgpr_write_b32 a8, v64
  v_accvgpr_write_b32 a9, v65
  v_accvgpr_write_b32 a10, v66
  v_accvgpr_write_b32 a11, v67
  v_accvgpr_read_b32 v64, a24
  v_accvgpr_read_b32 v65, a25
  v_accvgpr_read_b32 v66, a26
  v_accvgpr_read_b32 v67, a27
  v_mul_f32 v64, v64, v201
  v_mul_f32 v65, v65, v201
  v_mul_f32 v66, v66, v201
  v_mul_f32 v67, v67, v201
  v_accvgpr_write_b32 a24, v64
  v_accvgpr_write_b32 a25, v65
  v_accvgpr_write_b32 a26, v66
  v_accvgpr_write_b32 a27, v67
  v_accvgpr_read_b32 v64, a40
  v_accvgpr_read_b32 v65, a41
  v_accvgpr_read_b32 v66, a42
  v_accvgpr_read_b32 v67, a43
  v_mul_f32 v64, v64, v201
  v_mul_f32 v65, v65, v201
  v_mul_f32 v66, v66, v201
  v_mul_f32 v67, v67, v201
  v_accvgpr_write_b32 a40, v64
  v_accvgpr_write_b32 a41, v65
  v_accvgpr_write_b32 a42, v66
  v_accvgpr_write_b32 a43, v67
  v_accvgpr_read_b32 v64, a56
  v_accvgpr_read_b32 v65, a57
  v_accvgpr_read_b32 v66, a58
  v_accvgpr_read_b32 v67, a59
  v_mul_f32 v64, v64, v201
  v_mul_f32 v65, v65, v201
  v_mul_f32 v66, v66, v201
  v_mul_f32 v67, v67, v201
  v_accvgpr_write_b32 a56, v64
  v_accvgpr_write_b32 a57, v65
  v_accvgpr_write_b32 a58, v66
  v_accvgpr_write_b32 a59, v67
  v_accvgpr_read_b32 v64, a72
  v_accvgpr_read_b32 v65, a73
  v_accvgpr_read_b32 v66, a74
  v_accvgpr_read_b32 v67, a75
  v_mul_f32 v64, v64, v201
  v_mul_f32 v65, v65, v201
  v_mul_f32 v66, v66, v201
  v_mul_f32 v67, v67, v201
  v_accvgpr_write_b32 a72, v64
  v_accvgpr_write_b32 a73, v65
  v_accvgpr_write_b32 a74, v66
  v_accvgpr_write_b32 a75, v67
  v_accvgpr_read_b32 v64, a88
  v_accvgpr_read_b32 v65, a89
  v_accvgpr_read_b32 v66, a90
  v_accvgpr_read_b32 v67, a91
  v_mul_f32 v64, v64, v201
  v_mul_f32 v65, v65, v201
  v_mul_f32 v66, v66, v201
  v_mul_f32 v67, v67, v201
  v_accvgpr_write_b32 a88, v64
  v_accvgpr_write_b32 a89, v65
  v_accvgpr_write_b32 a90, v66
  v_accvgpr_write_b32 a91, v67
  v_accvgpr_read_b32 v64, a104
  v_accvgpr_read_b32 v65, a105
  v_accvgpr_read_b32 v66, a106
  v_accvgpr_read_b32 v67, a107
  v_mul_f32 v64, v64, v201
  v_mul_f32 v65, v65, v201
  v_mul_f32 v66, v66, v201
  v_mul_f32 v67, v67, v201
  v_accvgpr_write_b32 a104, v64
  v_accvgpr_write_b32 a105, v65
  v_accvgpr_write_b32 a106, v66
  v_accvgpr_write_b32 a107, v67
  v_accvgpr_read_b32 v64, a120
  v_accvgpr_read_b32 v65, a121
  v_accvgpr_read_b32 v66, a122
  v_accvgpr_read_b32 v67, a123
  v_mul_f32 v64, v64, v201
  v_mul_f32 v65, v65, v201
  v_mul_f32 v66, v66, v201
  v_mul_f32 v67, v67, v201
  v_accvgpr_write_b32 a120, v64
  v_accvgpr_write_b32 a121, v65
  v_accvgpr_write_b32 a122, v66
  v_accvgpr_write_b32 a123, v67
  v_mov_b32 v204, v252
  v_max3_f32 v204, v204, v24, v25
  v_max3_f32 v204, v204, v26, v27
  v_max3_f32 v204, v204, v28, v29
  v_max3_f32 v204, v204, v30, v31
  v_max3_f32 v204, v204, v56, v57
  v_max3_f32 v204, v204, v58, v59
  v_max3_f32 v204, v204, v60, v61
  v_max3_f32 v204, v204, v62, v63
  v_mov_b32 v245, v204
  s_nop 1
  v_permlane16_swap_b32 v204, v245
  v_max_f32 v204, v204, v245
  v_mov_b32 v245, v204
  s_nop 1
  v_permlane32_swap_b32 v204, v245
  v_max_f32 v204, v204, v245
  v_sub_f32 v205, v252, v204
  v_exp_f32 v205, v205
  v_mov_b32 v252, v204
  v_mul_f32 v211, v211, v205
  v_sub_f32 v24, v24, v204
  v_sub_f32 v25, v25, v204
  v_sub_f32 v26, v26, v204
  v_sub_f32 v27, v27, v204
  v_sub_f32 v28, v28, v204
  v_sub_f32 v29, v29, v204
  v_sub_f32 v30, v30, v204
  v_sub_f32 v31, v31, v204
  v_sub_f32 v56, v56, v204
  v_sub_f32 v57, v57, v204
  v_sub_f32 v58, v58, v204
  v_sub_f32 v59, v59, v204
  v_sub_f32 v60, v60, v204
  v_sub_f32 v61, v61, v204
  v_sub_f32 v62, v62, v204
  v_sub_f32 v63, v63, v204
  v_exp_f32 v24, v24
  v_exp_f32 v25, v25
  v_add_f32 v211, v211, v24
  v_exp_f32 v26, v26
  v_add_f32 v211, v211, v25
  v_cvt_pk_bf16_f32 v24, v24, v25
  v_exp_f32 v27, v27
  v_add_f32 v211, v211, v26
  v_add_f32 v211, v211, v27
  v_cvt_pk_bf16_f32 v25, v26, v27
  v_exp_f32 v28, v28
  v_exp_f32 v29, v29
  v_add_f32 v211, v211, v28
  v_exp_f32 v30, v30
  v_add_f32 v211, v211, v29
  v_cvt_pk_bf16_f32 v26, v28, v29
  v_exp_f32 v31, v31
  v_add_f32 v211, v211, v30
  v_add_f32 v211, v211, v31
  v_cvt_pk_bf16_f32 v27, v30, v31
  v_exp_f32 v56, v56
  v_exp_f32 v57, v57
  v_add_f32 v211, v211, v56
  v_exp_f32 v58, v58
  v_add_f32 v211, v211, v57
  v_cvt_pk_bf16_f32 v56, v56, v57
  v_exp_f32 v59, v59
  v_add_f32 v211, v211, v58
  v_add_f32 v211, v211, v59
  v_cvt_pk_bf16_f32 v57, v58, v59
  v_exp_f32 v60, v60
  v_exp_f32 v61, v61
  v_add_f32 v211, v211, v60
  v_exp_f32 v62, v62
  v_add_f32 v211, v211, v61
  v_cvt_pk_bf16_f32 v58, v60, v61
  v_exp_f32 v63, v63
  v_add_f32 v211, v211, v62
  v_add_f32 v211, v211, v63
  v_cvt_pk_bf16_f32 v59, v62, v63
  v_accvgpr_read_b32 v64, a12
  v_accvgpr_read_b32 v65, a13
  v_accvgpr_read_b32 v66, a14
  v_accvgpr_read_b32 v67, a15
  v_mul_f32 v64, v64, v205
  v_mul_f32 v65, v65, v205
  v_mul_f32 v66, v66, v205
  v_mul_f32 v67, v67, v205
  v_accvgpr_write_b32 a12, v64
  v_accvgpr_write_b32 a13, v65
  v_accvgpr_write_b32 a14, v66
  v_accvgpr_write_b32 a15, v67
  v_accvgpr_read_b32 v64, a28
  v_accvgpr_read_b32 v65, a29
  v_accvgpr_read_b32 v66, a30
  v_accvgpr_read_b32 v67, a31
  v_mul_f32 v64, v64, v205
  v_mul_f32 v65, v65, v205
  v_mul_f32 v66, v66, v205
  v_mul_f32 v67, v67, v205
  v_accvgpr_write_b32 a28, v64
  v_accvgpr_write_b32 a29, v65
  v_accvgpr_write_b32 a30, v66
  v_accvgpr_write_b32 a31, v67
  v_accvgpr_read_b32 v64, a44
  v_accvgpr_read_b32 v65, a45
  v_accvgpr_read_b32 v66, a46
  v_accvgpr_read_b32 v67, a47
  v_mul_f32 v64, v64, v205
  v_mul_f32 v65, v65, v205
  v_mul_f32 v66, v66, v205
  v_mul_f32 v67, v67, v205
  v_accvgpr_write_b32 a44, v64
  v_accvgpr_write_b32 a45, v65
  v_accvgpr_write_b32 a46, v66
  v_accvgpr_write_b32 a47, v67
  v_accvgpr_read_b32 v64, a60
  v_accvgpr_read_b32 v65, a61
  v_accvgpr_read_b32 v66, a62
  v_accvgpr_read_b32 v67, a63
  v_mul_f32 v64, v64, v205
  v_mul_f32 v65, v65, v205
  v_mul_f32 v66, v66, v205
  v_mul_f32 v67, v67, v205
  v_accvgpr_write_b32 a60, v64
  v_accvgpr_write_b32 a61, v65
  v_accvgpr_write_b32 a62, v66
  v_accvgpr_write_b32 a63, v67
  v_accvgpr_read_b32 v64, a76
  v_accvgpr_read_b32 v65, a77
  v_accvgpr_read_b32 v66, a78
  v_accvgpr_read_b32 v67, a79
  v_mul_f32 v64, v64, v205
  v_mul_f32 v65, v65, v205
  v_mul_f32 v66, v66, v205
  v_mul_f32 v67, v67, v205
  v_accvgpr_write_b32 a76, v64
  v_accvgpr_write_b32 a77, v65
  v_accvgpr_write_b32 a78, v66
  v_accvgpr_write_b32 a79, v67
  v_accvgpr_read_b32 v64, a92
  v_accvgpr_read_b32 v65, a93
  v_accvgpr_read_b32 v66, a94
  v_accvgpr_read_b32 v67, a95
  v_mul_f32 v64, v64, v205
  v_mul_f32 v65, v65, v205
  v_mul_f32 v66, v66, v205
  v_mul_f32 v67, v67, v205
  v_accvgpr_write_b32 a92, v64
  v_accvgpr_write_b32 a93, v65
  v_accvgpr_write_b32 a94, v66
  v_accvgpr_write_b32 a95, v67
  v_accvgpr_read_b32 v64, a108
  v_accvgpr_read_b32 v65, a109
  v_accvgpr_read_b32 v66, a110
  v_accvgpr_read_b32 v67, a111
  v_mul_f32 v64, v64, v205
  v_mul_f32 v65, v65, v205
  v_mul_f32 v66, v66, v205
  v_mul_f32 v67, v67, v205
  v_accvgpr_write_b32 a108, v64
  v_accvgpr_write_b32 a109, v65
  v_accvgpr_write_b32 a110, v66
  v_accvgpr_write_b32 a111, v67
  v_accvgpr_read_b32 v64, a124
  v_accvgpr_read_b32 v65, a125
  v_accvgpr_read_b32 v66, a126
  v_accvgpr_read_b32 v67, a127
  v_mul_f32 v64, v64, v205
  v_mul_f32 v65, v65, v205
  v_mul_f32 v66, v66, v205
  v_mul_f32 v67, v67, v205
  v_accvgpr_write_b32 a124, v64
  v_accvgpr_write_b32 a125, v65
  v_accvgpr_write_b32 a126, v66
  v_accvgpr_write_b32 a127, v67
  ds_read_b64_tr_b16 a[160:161], v216 offset:0
  ds_read_b64_tr_b16 a[162:163], v216 offset:4096
  ds_read_b64_tr_b16 a[164:165], v216 offset:8192
  ds_read_b64_tr_b16 a[166:167], v216 offset:12288
  s_waitcnt lgkmcnt(2)
  v_mfma_f32_16x16x32_bf16 a[0:3], a[160:163], v[0:3], a[0:3]
  s_waitcnt lgkmcnt(0)
  v_mfma_f32_16x16x32_bf16 a[0:3], a[164:167], v[32:35], a[0:3]
  v_mfma_f32_16x16x32_bf16 a[4:7], a[164:167], v[40:43], a[4:7]
  v_mfma_f32_16x16x32_bf16 a[4:7], a[160:163], v[8:11], a[4:7]
  v_mfma_f32_16x16x32_bf16 a[8:11], a[160:163], v[16:19], a[8:11]
  v_mfma_f32_16x16x32_bf16 a[8:11], a[164:167], v[48:51], a[8:11]
  v_mfma_f32_16x16x32_bf16 a[12:15], a[164:167], v[56:59], a[12:15]
  v_mfma_f32_16x16x32_bf16 a[12:15], a[160:163], v[24:27], a[12:15]
  ds_read_b64_tr_b16 a[168:169], v217 offset:0
  ds_read_b64_tr_b16 a[170:171], v217 offset:4096
  ds_read_b64_tr_b16 a[172:173], v217 offset:8192
  ds_read_b64_tr_b16 a[174:175], v217 offset:12288
  s_waitcnt lgkmcnt(2)
  v_mfma_f32_16x16x32_bf16 a[16:19], a[168:171], v[0:3], a[16:19]
  s_waitcnt lgkmcnt(0)
  v_mfma_f32_16x16x32_bf16 a[16:19], a[172:175], v[32:35], a[16:19]
  v_mfma_f32_16x16x32_bf16 a[20:23], a[172:175], v[40:43], a[20:23]
  v_mfma_f32_16x16x32_bf16 a[20:23], a[168:171], v[8:11], a[20:23]
  v_mfma_f32_16x16x32_bf16 a[24:27], a[168:171], v[16:19], a[24:27]
  v_mfma_f32_16x16x32_bf16 a[24:27], a[172:175], v[48:51], a[24:27]
  v_mfma_f32_16x16x32_bf16 a[28:31], a[172:175], v[56:59], a[28:31]
  v_mfma_f32_16x16x32_bf16 a[28:31], a[168:171], v[24:27], a[28:31]
  ds_read_b64_tr_b16 a[176:177], v218 offset:0
  ds_read_b64_tr_b16 a[178:179], v218 offset:4096
  ds_read_b64_tr_b16 a[180:181], v218 offset:8192
  ds_read_b64_tr_b16 a[182:183], v218 offset:12288
  s_waitcnt lgkmcnt(2)
  v_mfma_f32_16x16x32_bf16 a[32:35], a[176:179], v[0:3], a[32:35]
  s_waitcnt lgkmcnt(0)
  v_mfma_f32_16x16x32_bf16 a[32:35], a[180:183], v[32:35], a[32:35]
  v_mfma_f32_16x16x32_bf16 a[36:39], a[180:183], v[40:43], a[36:39]
  v_mfma_f32_16x16x32_bf16 a[36:39], a[176:179], v[8:11], a[36:39]
  v_mfma_f32_16x16x32_bf16 a[40:43], a[176:179], v[16:19], a[40:43]
  v_mfma_f32_16x16x32_bf16 a[40:43], a[180:183], v[48:51], a[40:43]
  v_mfma_f32_16x16x32_bf16 a[44:47], a[180:183], v[56:59], a[44:47]
  v_mfma_f32_16x16x32_bf16 a[44:47], a[176:179], v[24:27], a[44:47]
  ds_read_b64_tr_b16 a[184:185], v219 offset:0
  ds_read_b64_tr_b16 a[186:187], v219 offset:4096
  ds_read_b64_tr_b16 a[188:189], v219 offset:8192
  ds_read_b64_tr_b16 a[190:191], v219 offset:12288
  s_waitcnt lgkmcnt(2)
  v_mfma_f32_16x16x32_bf16 a[48:51], a[184:187], v[0:3], a[48:51]
  s_waitcnt lgkmcnt(0)
  v_mfma_f32_16x16x32_bf16 a[48:51], a[188:191], v[32:35], a[48:51]
  v_mfma_f32_16x16x32_bf16 a[52:55], a[188:191], v[40:43], a[52:55]
  v_mfma_f32_16x16x32_bf16 a[52:55], a[184:187], v[8:11], a[52:55]
  v_mfma_f32_16x16x32_bf16 a[56:59], a[184:187], v[16:19], a[56:59]
  v_mfma_f32_16x16x32_bf16 a[56:59], a[188:191], v[48:51], a[56:59]
  v_mfma_f32_16x16x32_bf16 a[60:63], a[188:191], v[56:59], a[60:63]
  v_mfma_f32_16x16x32_bf16 a[60:63], a[184:187], v[24:27], a[60:63]
  ds_read_b64_tr_b16 a[160:161], v220 offset:0
  ds_read_b64_tr_b16 a[162:163], v220 offset:4096
  ds_read_b64_tr_b16 a[164:165], v220 offset:8192
  ds_read_b64_tr_b16 a[166:167], v220 offset:12288
  s_waitcnt lgkmcnt(2)
  v_mfma_f32_16x16x32_bf16 a[64:67], a[160:163], v[0:3], a[64:67]
  s_waitcnt lgkmcnt(0)
  v_mfma_f32_16x16x32_bf16 a[64:67], a[164:167], v[32:35], a[64:67]
  v_mfma_f32_16x16x32_bf16 a[68:71], a[164:167], v[40:43], a[68:71]
  v_mfma_f32_16x16x32_bf16 a[68:71], a[160:163], v[8:11], a[68:71]
  v_mfma_f32_16x16x32_bf16 a[72:75], a[160:163], v[16:19], a[72:75]
  v_mfma_f32_16x16x32_bf16 a[72:75], a[164:167], v[48:51], a[72:75]
  v_mfma_f32_16x16x32_bf16 a[76:79], a[164:167], v[56:59], a[76:79]
  v_mfma_f32_16x16x32_bf16 a[76:79], a[160:163], v[24:27], a[76:79]
  ds_read_b64_tr_b16 a[168:169], v221 offset:0
  ds_read_b64_tr_b16 a[170:171], v221 offset:4096
  ds_read_b64_tr_b16 a[172:173], v221 offset:8192
  ds_read_b64_tr_b16 a[174:175], v221 offset:12288
  s_waitcnt lgkmcnt(2)
  v_mfma_f32_16x16x32_bf16 a[80:83], a[168:171], v[0:3], a[80:83]
  s_waitcnt lgkmcnt(0)
  v_mfma_f32_16x16x32_bf16 a[80:83], a[172:175], v[32:35], a[80:83]
  v_mfma_f32_16x16x32_bf16 a[84:87], a[172:175], v[40:43], a[84:87]
  v_mfma_f32_16x16x32_bf16 a[84:87], a[168:171], v[8:11], a[84:87]
  v_mfma_f32_16x16x32_bf16 a[88:91], a[168:171], v[16:19], a[88:91]
  v_mfma_f32_16x16x32_bf16 a[88:91], a[172:175], v[48:51], a[88:91]
  v_mfma_f32_16x16x32_bf16 a[92:95], a[172:175], v[56:59], a[92:95]
  v_mfma_f32_16x16x32_bf16 a[92:95], a[168:171], v[24:27], a[92:95]
  ds_read_b64_tr_b16 a[176:177], v222 offset:0
  ds_read_b64_tr_b16 a[178:179], v222 offset:4096
  ds_read_b64_tr_b16 a[180:181], v222 offset:8192
  ds_read_b64_tr_b16 a[182:183], v222 offset:12288
  s_waitcnt lgkmcnt(2)
  v_mfma_f32_16x16x32_bf16 a[96:99], a[176:179], v[0:3], a[96:99]
  s_waitcnt lgkmcnt(0)
  v_mfma_f32_16x16x32_bf16 a[96:99], a[180:183], v[32:35], a[96:99]
  v_mfma_f32_16x16x32_bf16 a[100:103], a[180:183], v[40:43], a[100:103]
  v_mfma_f32_16x16x32_bf16 a[100:103], a[176:179], v[8:11], a[100:103]
  v_mfma_f32_16x16x32_bf16 a[104:107], a[176:179], v[16:19], a[104:107]
  v_mfma_f32_16x16x32_bf16 a[104:107], a[180:183], v[48:51], a[104:107]
  v_mfma_f32_16x16x32_bf16 a[108:111], a[180:183], v[56:59], a[108:111]
  v_mfma_f32_16x16x32_bf16 a[108:111], a[176:179], v[24:27], a[108:111]
  ds_read_b64_tr_b16 a[184:185], v223 offset:0
  ds_read_b64_tr_b16 a[186:187], v223 offset:4096
  ds_read_b64_tr_b16 a[188:189], v223 offset:8192
  ds_read_b64_tr_b16 a[190:191], v223 offset:12288
  s_waitcnt lgkmcnt(2)
  v_mfma_f32_16x16x32_bf16 a[112:115], a[184:187], v[0:3], a[112:115]
  s_waitcnt lgkmcnt(0)
  v_mfma_f32_16x16x32_bf16 a[112:115], a[188:191], v[32:35], a[112:115]
  v_mfma_f32_16x16x32_bf16 a[116:119], a[188:191], v[40:43], a[116:119]
  v_mfma_f32_16x16x32_bf16 a[116:119], a[184:187], v[8:11], a[116:119]
  v_mfma_f32_16x16x32_bf16 a[120:123], a[184:187], v[16:19], a[120:123]
  v_mfma_f32_16x16x32_bf16 a[120:123], a[188:191], v[48:51], a[120:123]
  v_mfma_f32_16x16x32_bf16 a[124:127], a[188:191], v[56:59], a[124:127]
  v_mfma_f32_16x16x32_bf16 a[124:127], a[184:187], v[24:27], a[124:127]
  s_add_u32 s29, s29, 16384
  s_cmp_lt_u32 s29, 524288
  s_cbranch_scc1 attn_slow
  v_mov_b32 v245, v208
  v_mov_b32 v246, v209
  v_mov_b32 v247, v210
  v_mov_b32 v248, v211
  v_permlane16_swap_b32 v208, v245
  v_permlane16_swap_b32 v209, v246
  v_permlane16_swap_b32 v210, v247
  v_permlane16_swap_b32 v211, v248
  v_add_f32 v208, v208, v245
  v_add_f32 v209, v209, v246
  v_add_f32 v210, v210, v247
  v_add_f32 v211, v211, v248
  v_mov_b32 v245, v208
  v_mov_b32 v246, v209
  v_mov_b32 v247, v210
  v_mov_b32 v248, v211
  v_permlane32_swap_b32 v208, v245
  v_permlane32_swap_b32 v209, v246
  v_permlane32_swap_b32 v210, v247
  v_permlane32_swap_b32 v211, v248
  v_add_f32 v208, v208, v245
  v_add_f32 v209, v209, v246
  v_add_f32 v210, v210, v247
  v_add_f32 v211, v211, v248
  v_rcp_f32 v192, v208
  v_rcp_f32 v196, v209
  v_rcp_f32 v200, v210
  v_rcp_f32 v204, v211
  v_accvgpr_read_b32 v0, a0
  v_accvgpr_read_b32 v1, a1
  v_accvgpr_read_b32 v2, a2
  v_accvgpr_read_b32 v3, a3
  v_accvgpr_read_b32 v4, a16
  v_accvgpr_read_b32 v5, a17
  v_accvgpr_read_b32 v6, a18
  v_accvgpr_read_b32 v7, a19
  v_mul_f32 v0, v0, v192
  v_mul_f32 v1, v1, v192
  v_mul_f32 v2, v2, v192
  v_mul_f32 v3, v3, v192
  v_mul_f32 v4, v4, v192
  v_mul_f32 v5, v5, v192
  v_mul_f32 v6, v6, v192
  v_mul_f32 v7, v7, v192
  v_cvt_pk_bf16_f32 v0, v0, v1
  v_cvt_pk_bf16_f32 v1, v2, v3
  v_cvt_pk_bf16_f32 v2, v4, v5
  v_cvt_pk_bf16_f32 v3, v6, v7
  buffer_store_dwordx4 v[0:3], v244, s[24:27], s40 offen offset:0 sc1
  v_accvgpr_read_b32 v8, a4
  v_accvgpr_read_b32 v9, a5
  v_accvgpr_read_b32 v10, a6
  v_accvgpr_read_b32 v11, a7
  v_accvgpr_read_b32 v12, a20
  v_accvgpr_read_b32 v13, a21
  v_accvgpr_read_b32 v14, a22
  v_accvgpr_read_b32 v15, a23
  v_mul_f32 v8, v8, v196
  v_mul_f32 v9, v9, v196
  v_mul_f32 v10, v10, v196
  v_mul_f32 v11, v11, v196
  v_mul_f32 v12, v12, v196
  v_mul_f32 v13, v13, v196
  v_mul_f32 v14, v14, v196
  v_mul_f32 v15, v15, v196
  v_cvt_pk_bf16_f32 v8, v8, v9
  v_cvt_pk_bf16_f32 v9, v10, v11
  v_cvt_pk_bf16_f32 v10, v12, v13
  v_cvt_pk_bf16_f32 v11, v14, v15
  buffer_store_dwordx4 v[8:11], v244, s[24:27], s40 offen offset:2048 sc1
  v_accvgpr_read_b32 v16, a8
  v_accvgpr_read_b32 v17, a9
  v_accvgpr_read_b32 v18, a10
  v_accvgpr_read_b32 v19, a11
  v_accvgpr_read_b32 v20, a24
  v_accvgpr_read_b32 v21, a25
  v_accvgpr_read_b32 v22, a26
  v_accvgpr_read_b32 v23, a27
  v_mul_f32 v16, v16, v200
  v_mul_f32 v17, v17, v200
  v_mul_f32 v18, v18, v200
  v_mul_f32 v19, v19, v200
  v_mul_f32 v20, v20, v200
  v_mul_f32 v21, v21, v200
  v_mul_f32 v22, v22, v200
  v_mul_f32 v23, v23, v200
  v_cvt_pk_bf16_f32 v16, v16, v17
  v_cvt_pk_bf16_f32 v17, v18, v19
  v_cvt_pk_bf16_f32 v18, v20, v21
  v_cvt_pk_bf16_f32 v19, v22, v23
  buffer_store_dwordx4 v[16:19], v244, s[24:27], s41 offen offset:0 sc1
  v_accvgpr_read_b32 v24, a12
  v_accvgpr_read_b32 v25, a13
  v_accvgpr_read_b32 v26, a14
  v_accvgpr_read_b32 v27, a15
  v_accvgpr_read_b32 v28, a28
  v_accvgpr_read_b32 v29, a29
  v_accvgpr_read_b32 v30, a30
  v_accvgpr_read_b32 v31, a31
  v_mul_f32 v24, v24, v204
  v_mul_f32 v25, v25, v204
  v_mul_f32 v26, v26, v204
  v_mul_f32 v27, v27, v204
  v_mul_f32 v28, v28, v204
  v_mul_f32 v29, v29, v204
  v_mul_f32 v30, v30, v204
  v_mul_f32 v31, v31, v204
  v_cvt_pk_bf16_f32 v24, v24, v25
  v_cvt_pk_bf16_f32 v25, v26, v27
  v_cvt_pk_bf16_f32 v26, v28, v29
  v_cvt_pk_bf16_f32 v27, v30, v31
  buffer_store_dwordx4 v[24:27], v244, s[24:27], s41 offen offset:2048 sc1
  v_accvgpr_read_b32 v32, a32
  v_accvgpr_read_b32 v33, a33
  v_accvgpr_read_b32 v34, a34
  v_accvgpr_read_b32 v35, a35
  v_accvgpr_read_b32 v36, a48
  v_accvgpr_read_b32 v37, a49
  v_accvgpr_read_b32 v38, a50
  v_accvgpr_read_b32 v39, a51
  v_mul_f32 v32, v32, v192
  v_mul_f32 v33, v33, v192
  v_mul_f32 v34, v34, v192
  v_mul_f32 v35, v35, v192
  v_mul_f32 v36, v36, v192
  v_mul_f32 v37, v37, v192
  v_mul_f32 v38, v38, v192
  v_mul_f32 v39, v39, v192
  v_cvt_pk_bf16_f32 v32, v32, v33
  v_cvt_pk_bf16_f32 v33, v34, v35
  v_cvt_pk_bf16_f32 v34, v36, v37
  v_cvt_pk_bf16_f32 v35, v38, v39
  buffer_store_dwordx4 v[32:35], v244, s[24:27], s40 offen offset:1024 sc1
  v_accvgpr_read_b32 v40, a36
  v_accvgpr_read_b32 v41, a37
  v_accvgpr_read_b32 v42, a38
  v_accvgpr_read_b32 v43, a39
  v_accvgpr_read_b32 v44, a52
  v_accvgpr_read_b32 v45, a53
  v_accvgpr_read_b32 v46, a54
  v_accvgpr_read_b32 v47, a55
  v_mul_f32 v40, v40, v196
  v_mul_f32 v41, v41, v196
  v_mul_f32 v42, v42, v196
  v_mul_f32 v43, v43, v196
  v_mul_f32 v44, v44, v196
  v_mul_f32 v45, v45, v196
  v_mul_f32 v46, v46, v196
  v_mul_f32 v47, v47, v196
  v_cvt_pk_bf16_f32 v40, v40, v41
  v_cvt_pk_bf16_f32 v41, v42, v43
  v_cvt_pk_bf16_f32 v42, v44, v45
  v_cvt_pk_bf16_f32 v43, v46, v47
  buffer_store_dwordx4 v[40:43], v244, s[24:27], s40 offen offset:3072 sc1
  v_accvgpr_read_b32 v48, a40
  v_accvgpr_read_b32 v49, a41
  v_accvgpr_read_b32 v50, a42
  v_accvgpr_read_b32 v51, a43
  v_accvgpr_read_b32 v52, a56
  v_accvgpr_read_b32 v53, a57
  v_accvgpr_read_b32 v54, a58
  v_accvgpr_read_b32 v55, a59
  v_mul_f32 v48, v48, v200
  v_mul_f32 v49, v49, v200
  v_mul_f32 v50, v50, v200
  v_mul_f32 v51, v51, v200
  v_mul_f32 v52, v52, v200
  v_mul_f32 v53, v53, v200
  v_mul_f32 v54, v54, v200
  v_mul_f32 v55, v55, v200
  v_cvt_pk_bf16_f32 v48, v48, v49
  v_cvt_pk_bf16_f32 v49, v50, v51
  v_cvt_pk_bf16_f32 v50, v52, v53
  v_cvt_pk_bf16_f32 v51, v54, v55
  buffer_store_dwordx4 v[48:51], v244, s[24:27], s41 offen offset:1024 sc1
  v_accvgpr_read_b32 v56, a44
  v_accvgpr_read_b32 v57, a45
  v_accvgpr_read_b32 v58, a46
  v_accvgpr_read_b32 v59, a47
  v_accvgpr_read_b32 v60, a60
  v_accvgpr_read_b32 v61, a61
  v_accvgpr_read_b32 v62, a62
  v_accvgpr_read_b32 v63, a63
  v_mul_f32 v56, v56, v204
  v_mul_f32 v57, v57, v204
  v_mul_f32 v58, v58, v204
  v_mul_f32 v59, v59, v204
  v_mul_f32 v60, v60, v204
  v_mul_f32 v61, v61, v204
  v_mul_f32 v62, v62, v204
  v_mul_f32 v63, v63, v204
  v_cvt_pk_bf16_f32 v56, v56, v57
  v_cvt_pk_bf16_f32 v57, v58, v59
  v_cvt_pk_bf16_f32 v58, v60, v61
  v_cvt_pk_bf16_f32 v59, v62, v63
  buffer_store_dwordx4 v[56:59], v244, s[24:27], s41 offen offset:3072 sc1
  v_accvgpr_read_b32 v0, a64
  v_accvgpr_read_b32 v1, a65
  v_accvgpr_read_b32 v2, a66
  v_accvgpr_read_b32 v3, a67
  v_accvgpr_read_b32 v4, a80
  v_accvgpr_read_b32 v5, a81
  v_accvgpr_read_b32 v6, a82
  v_accvgpr_read_b32 v7, a83
  v_mul_f32 v0, v0, v192
  v_mul_f32 v1, v1, v192
  v_mul_f32 v2, v2, v192
  v_mul_f32 v3, v3, v192
  v_mul_f32 v4, v4, v192
  v_mul_f32 v5, v5, v192
  v_mul_f32 v6, v6, v192
  v_mul_f32 v7, v7, v192
  v_cvt_pk_bf16_f32 v0, v0, v1
  v_cvt_pk_bf16_f32 v1, v2, v3
  v_cvt_pk_bf16_f32 v2, v4, v5
  v_cvt_pk_bf16_f32 v3, v6, v7
  buffer_store_dwordx4 v[0:3], v244, s[24:27], s42 offen offset:0 sc1
  v_accvgpr_read_b32 v8, a68
  v_accvgpr_read_b32 v9, a69
  v_accvgpr_read_b32 v10, a70
  v_accvgpr_read_b32 v11, a71
  v_accvgpr_read_b32 v12, a84
  v_accvgpr_read_b32 v13, a85
  v_accvgpr_read_b32 v14, a86
  v_accvgpr_read_b32 v15, a87
  v_mul_f32 v8, v8, v196
  v_mul_f32 v9, v9, v196
  v_mul_f32 v10, v10, v196
  v_mul_f32 v11, v11, v196
  v_mul_f32 v12, v12, v196
  v_mul_f32 v13, v13, v196
  v_mul_f32 v14, v14, v196
  v_mul_f32 v15, v15, v196
  v_cvt_pk_bf16_f32 v8, v8, v9
  v_cvt_pk_bf16_f32 v9, v10, v11
  v_cvt_pk_bf16_f32 v10, v12, v13
  v_cvt_pk_bf16_f32 v11, v14, v15
  buffer_store_dwordx4 v[8:11], v244, s[24:27], s42 offen offset:2048 sc1
  v_accvgpr_read_b32 v16, a72
  v_accvgpr_read_b32 v17, a73
  v_accvgpr_read_b32 v18, a74
  v_accvgpr_read_b32 v19, a75
  v_accvgpr_read_b32 v20, a88
  v_accvgpr_read_b32 v21, a89
  v_accvgpr_read_b32 v22, a90
  v_accvgpr_read_b32 v23, a91
  v_mul_f32 v16, v16, v200
  v_mul_f32 v17, v17, v200
  v_mul_f32 v18, v18, v200
  v_mul_f32 v19, v19, v200
  v_mul_f32 v20, v20, v200
  v_mul_f32 v21, v21, v200
  v_mul_f32 v22, v22, v200
  v_mul_f32 v23, v23, v200
  v_cvt_pk_bf16_f32 v16, v16, v17
  v_cvt_pk_bf16_f32 v17, v18, v19
  v_cvt_pk_bf16_f32 v18, v20, v21
  v_cvt_pk_bf16_f32 v19, v22, v23
  buffer_store_dwordx4 v[16:19], v244, s[24:27], s43 offen offset:0 sc1
  v_accvgpr_read_b32 v24, a76
  v_accvgpr_read_b32 v25, a77
  v_accvgpr_read_b32 v26, a78
  v_accvgpr_read_b32 v27, a79
  v_accvgpr_read_b32 v28, a92
  v_accvgpr_read_b32 v29, a93
  v_accvgpr_read_b32 v30, a94
  v_accvgpr_read_b32 v31, a95
  v_mul_f32 v24, v24, v204
  v_mul_f32 v25, v25, v204
  v_mul_f32 v26, v26, v204
  v_mul_f32 v27, v27, v204
  v_mul_f32 v28, v28, v204
  v_mul_f32 v29, v29, v204
  v_mul_f32 v30, v30, v204
  v_mul_f32 v31, v31, v204
  v_cvt_pk_bf16_f32 v24, v24, v25
  v_cvt_pk_bf16_f32 v25, v26, v27
  v_cvt_pk_bf16_f32 v26, v28, v29
  v_cvt_pk_bf16_f32 v27, v30, v31
  buffer_store_dwordx4 v[24:27], v244, s[24:27], s43 offen offset:2048 sc1
  v_accvgpr_read_b32 v32, a96
  v_accvgpr_read_b32 v33, a97
  v_accvgpr_read_b32 v34, a98
  v_accvgpr_read_b32 v35, a99
  v_accvgpr_read_b32 v36, a112
  v_accvgpr_read_b32 v37, a113
  v_accvgpr_read_b32 v38, a114
  v_accvgpr_read_b32 v39, a115
  v_mul_f32 v32, v32, v192
  v_mul_f32 v33, v33, v192
  v_mul_f32 v34, v34, v192
  v_mul_f32 v35, v35, v192
  v_mul_f32 v36, v36, v192
  v_mul_f32 v37, v37, v192
  v_mul_f32 v38, v38, v192
  v_mul_f32 v39, v39, v192
  v_cvt_pk_bf16_f32 v32, v32, v33
  v_cvt_pk_bf16_f32 v33, v34, v35
  v_cvt_pk_bf16_f32 v34, v36, v37
  v_cvt_pk_bf16_f32 v35, v38, v39
  buffer_store_dwordx4 v[32:35], v244, s[24:27], s42 offen offset:1024 sc1
  v_accvgpr_read_b32 v40, a100
  v_accvgpr_read_b32 v41, a101
  v_accvgpr_read_b32 v42, a102
  v_accvgpr_read_b32 v43, a103
  v_accvgpr_read_b32 v44, a116
  v_accvgpr_read_b32 v45, a117
  v_accvgpr_read_b32 v46, a118
  v_accvgpr_read_b32 v47, a119
  v_mul_f32 v40, v40, v196
  v_mul_f32 v41, v41, v196
  v_mul_f32 v42, v42, v196
  v_mul_f32 v43, v43, v196
  v_mul_f32 v44, v44, v196
  v_mul_f32 v45, v45, v196
  v_mul_f32 v46, v46, v196
  v_mul_f32 v47, v47, v196
  v_cvt_pk_bf16_f32 v40, v40, v41
  v_cvt_pk_bf16_f32 v41, v42, v43
  v_cvt_pk_bf16_f32 v42, v44, v45
  v_cvt_pk_bf16_f32 v43, v46, v47
  buffer_store_dwordx4 v[40:43], v244, s[24:27], s42 offen offset:3072 sc1
  v_accvgpr_read_b32 v48, a104
  v_accvgpr_read_b32 v49, a105
  v_accvgpr_read_b32 v50, a106
  v_accvgpr_read_b32 v51, a107
  v_accvgpr_read_b32 v52, a120
  v_accvgpr_read_b32 v53, a121
  v_accvgpr_read_b32 v54, a122
  v_accvgpr_read_b32 v55, a123
  v_mul_f32 v48, v48, v200
  v_mul_f32 v49, v49, v200
  v_mul_f32 v50, v50, v200
  v_mul_f32 v51, v51, v200
  v_mul_f32 v52, v52, v200
  v_mul_f32 v53, v53, v200
  v_mul_f32 v54, v54, v200
  v_mul_f32 v55, v55, v200
  v_cvt_pk_bf16_f32 v48, v48, v49
  v_cvt_pk_bf16_f32 v49, v50, v51
  v_cvt_pk_bf16_f32 v50, v52, v53
  v_cvt_pk_bf16_f32 v51, v54, v55
  buffer_store_dwordx4 v[48:51], v244, s[24:27], s43 offen offset:1024 sc1
  v_accvgpr_read_b32 v56, a108
  v_accvgpr_read_b32 v57, a109
  v_accvgpr_read_b32 v58, a110
  v_accvgpr_read_b32 v59, a111
  v_accvgpr_read_b32 v60, a124
  v_accvgpr_read_b32 v61, a125
  v_accvgpr_read_b32 v62, a126
  v_accvgpr_read_b32 v63, a127
  v_mul_f32 v56, v56, v204
  v_mul_f32 v57, v57, v204
  v_mul_f32 v58, v58, v204
  v_mul_f32 v59, v59, v204
  v_mul_f32 v60, v60, v204
  v_mul_f32 v61, v61, v204
  v_mul_f32 v62, v62, v204
  v_mul_f32 v63, v63, v204
  v_cvt_pk_bf16_f32 v56, v56, v57
  v_cvt_pk_bf16_f32 v57, v58, v59
  v_cvt_pk_bf16_f32 v58, v60, v61
  v_cvt_pk_bf16_f32 v59, v62, v63
  buffer_store_dwordx4 v[56:59], v244, s[24:27], s43 offen offset:3072 sc1
  s_branch tail_go
.section .rodata,"a"
.p2align 6
.amdhsa_kernel recurrent_scan__mha_block_cached__moe_arch_mod__prompt_kernel
  .amdhsa_next_free_vgpr 512
  .amdhsa_next_free_sgpr 102
  .amdhsa_accum_offset 256
  .amdhsa_group_segment_fixed_size 0
  .amdhsa_kernarg_size 104
  .amdhsa_user_sgpr_count 2
  .amdhsa_user_sgpr_kernarg_segment_ptr 1
  .amdhsa_system_sgpr_workgroup_id_x 1
.end_amdhsa_kernel
```

```asm
; @launch grid=(256,1,1) block=(256,1,1) lds=163840
.amdgcn_target "amdgcn-amd-amdhsa--gfx950"
.text
.globl recurrent_scan__mha_block_cached__moe_arch_mod__prompt_kernel
.p2align 8
.type recurrent_scan__mha_block_cached__moe_arch_mod__prompt_kernel,@function
recurrent_scan__mha_block_cached__moe_arch_mod__prompt_kernel:
  s_cmp_ge_u32 s2, 256
  s_cbranch_scc1 attn_end
  s_load_dwordx2 s[60:61], s[0:1], 0
  s_load_dwordx2 s[48:49], s[0:1], 48
  s_load_dwordx4 s[4:7], s[0:1], 8
  s_load_dwordx2 s[8:9], s[0:1], 24
  s_load_dwordx2 s[10:11], s[0:1], 96
  s_load_dwordx2 s[88:89], s[0:1], 32
  s_load_dwordx2 s[90:91], s[0:1], 56
  s_load_dwordx4 s[92:95], s[0:1], 64
  s_load_dwordx2 s[96:97], s[0:1], 88
  s_load_dwordx2 s[62:63], s[0:1], 80
  s_getpc_b64 s[98:99]
attn_hot_pc:
  s_add_u32 s98, s98, attn_hot-attn_hot_pc
  s_addc_u32 s99, s99, 0
  v_lshlrev_b32 v249, 7, v0
  v_min_u32 v249, attn_end-attn_hot-4, v249
  global_load_dword v255, v249, s[98:99]
  v_add_u32 v249, 0x8000, v249
  v_min_u32 v249, attn_end-attn_hot-4, v249
  global_load_dword v255, v249, s[98:99]
attn_hot:
  v_lshrrev_b32 v249, 6, v0
  v_and_b32 v0, 63, v0
  v_mov_b32 v245, v0
  v_readfirstlane_b32 s3, v249
  s_and_b32 s36, s2, 7
  s_lshl_b32 s36, s36, 2
  s_lshr_b32 s37, s2, 6
  s_add_u32 s36, s36, s37
  s_bfe_u32 s37, s2, 0x30003
  s_lshl_b32 s37, s37, 2
  s_add_u32 s37, s37, s3
  s_lshl_b32 s28, s3, 12
  v_lshrrev_b32 v248, 4, v245
  v_and_b32 v247, 15, v245
  s_lshl_b32 s38, s3, 17
  v_lshlrev_b32 v249, 13, v248
  v_add_u32 v249, s38, v249
  v_or_b32 v250, 0, v248
  v_lshlrev_b32 v250, 1, v250
  v_xor_b32 v250, v250, v247
  v_lshl_add_u32 v238, v250, 4, v249
  v_or_b32 v250, 0, v248
  v_lshlrev_b32 v250, 1, v250
  v_xor_b32 v250, v250, v247
  v_lshl_add_u32 v239, v250, 4, v249
  v_add_u32 v239, 31744, v239
  v_or_b32 v250, 4, v248
  v_lshlrev_b32 v250, 1, v250
  v_xor_b32 v250, v250, v247
  v_lshl_add_u32 v240, v250, 4, v249
  v_add_u32 v240, 63488, v240
  v_or_b32 v250, 4, v248
  v_lshlrev_b32 v250, 1, v250
  v_xor_b32 v250, v250, v247
  v_lshl_add_u32 v241, v250, 4, v249
  v_add_u32 v241, 95232, v241
  s_waitcnt lgkmcnt(0)
  s_add_u32 s58, s10, 2830336
  s_addc_u32 s59, s11, 0
  s_load_dword s59, s[58:59], 0
  s_mov_b32 s24, s10
  s_mov_b32 s25, s11
  s_mov_b32 s26, 33554432
  s_mov_b32 s27, 0x20000
  s_lshl_b32 s38, s36, 8
  s_add_u32 s20, s8, s38
  s_addc_u32 s21, s9, 0
  s_mov_b32 s22, 5242880
  s_mov_b32 s23, 0x20000
  s_sub_u32 s22, s22, s38
  s_cmp_ge_u32 s3, 2
  s_cbranch_scc1 front_fetch
  s_mov_b32 s12, s60
  s_mov_b32 s13, s61
  s_mov_b32 s14, 2621440
  s_mov_b32 s15, 0x20000
  s_mov_b32 s16, s48
  s_mov_b32 s17, s49
  s_mov_b32 s18, 1280
  s_mov_b32 s19, 0x20000
  s_lshr_b32 s52, s37, 2
  s_lshl_b32 s52, s52, 5
  s_add_u32 s52, s52, s36
  s_lshl_b32 s52, s52, 1
  s_add_u32 s52, s52, s3
  s_lshl_b32 s52, s52, 2
  s_mul_i32 s53, s52, 1280
  v_lshrrev_b32 v1, 4, v0
  v_and_b32 v2, 15, v0
  v_lshlrev_b32 v3, 4, v2
  v_mul_u32_u24 v4, 0x500, v1
  v_add_u32 v4, v4, v3
  buffer_load_dwordx4 v[8:11], v4, s[12:15], s53 offen offset:0
  buffer_load_dwordx4 v[12:15], v4, s[12:15], s53 offen offset:256
  buffer_load_dwordx4 v[16:19], v4, s[12:15], s53 offen offset:512
  buffer_load_dwordx4 v[20:23], v4, s[12:15], s53 offen offset:768
  buffer_load_dwordx4 v[24:27], v4, s[12:15], s53 offen offset:1024
  buffer_load_dwordx4 v[28:31], v3, s[16:19], 0 offen offset:0
  buffer_load_dwordx4 v[32:35], v3, s[16:19], 0 offen offset:256
  buffer_load_dwordx4 v[36:39], v3, s[16:19], 0 offen offset:512
  buffer_load_dwordx4 v[40:43], v3, s[16:19], 0 offen offset:768
  buffer_load_dwordx4 v[44:47], v3, s[16:19], 0 offen offset:1024
  v_mov_b32 v7, 0
  v_lshlrev_b32 v6, 26, v0
  s_lshl_b32 s53, s2, 7
  s_add_u32 s53, s53, 2834432
  buffer_store_dword v7, v6, s[24:27], s53 offen sc1
  v_lshlrev_b32 v6, 8, v0
  v_lshrrev_b32 v5, 5, v0
  v_lshl_add_u32 v6, v5, 26, v6
  s_cmp_eq_u32 s2, 0
  s_cselect_b32 s53, 0, 1073741824
  v_or_b32 v6, s53, v6
  s_mov_b32 s53, 2818048
  buffer_store_dword v7, v6, s[24:27], s53 offen sc1
  s_lshr_b32 s53, s52, 6
  s_mul_i32 s53, s53, 81920
  s_bfe_u32 s54, s52, 0x20004
  s_lshl_b32 s54, s54, 10
  s_add_u32 s53, s53, s54
  s_and_b32 s54, s52, 15
  s_lshl_b32 s54, s54, 4
  s_add_u32 s53, s53, s54
  v_lshrrev_b32 v5, 2, v2
  v_lshlrev_b32 v5, 12, v5
  v_and_b32 v6, 3, v2
  v_lshl_add_u32 v5, v6, 8, v5
  v_lshl_add_u32 v5, v1, 4, v5
  s_mov_b32 s56, 0xffff0000
  s_waitcnt vmcnt(11)
  v_lshlrev_b32 v48, 16, v8
  v_and_b32 v49, s56, v8
  v_lshlrev_b32 v50, 16, v9
  v_and_b32 v51, s56, v9
  v_lshlrev_b32 v52, 16, v10
  v_and_b32 v53, s56, v10
  v_lshlrev_b32 v54, 16, v11
  v_and_b32 v55, s56, v11
  s_waitcnt vmcnt(10)
  v_lshlrev_b32 v56, 16, v12
  v_and_b32 v57, s56, v12
  v_lshlrev_b32 v58, 16, v13
  v_and_b32 v59, s56, v13
  v_lshlrev_b32 v60, 16, v14
  v_and_b32 v61, s56, v14
  v_lshlrev_b32 v62, 16, v15
  v_and_b32 v63, s56, v15
  s_waitcnt vmcnt(9)
  v_lshlrev_b32 v64, 16, v16
  v_and_b32 v65, s56, v16
  v_lshlrev_b32 v66, 16, v17
  v_and_b32 v67, s56, v17
  v_lshlrev_b32 v68, 16, v18
  v_and_b32 v69, s56, v18
  v_lshlrev_b32 v70, 16, v19
  v_and_b32 v71, s56, v19
  s_waitcnt vmcnt(8)
  v_lshlrev_b32 v72, 16, v20
  v_and_b32 v73, s56, v20
  v_lshlrev_b32 v74, 16, v21
  v_and_b32 v75, s56, v21
  v_lshlrev_b32 v76, 16, v22
  v_and_b32 v77, s56, v22
  v_lshlrev_b32 v78, 16, v23
  v_and_b32 v79, s56, v23
  s_waitcnt vmcnt(7)
  v_lshlrev_b32 v80, 16, v24
  v_and_b32 v81, s56, v24
  v_lshlrev_b32 v82, 16, v25
  v_and_b32 v83, s56, v25
  v_lshlrev_b32 v84, 16, v26
  v_and_b32 v85, s56, v26
  v_lshlrev_b32 v86, 16, v27
  v_and_b32 v87, s56, v27
  v_pk_add_f32 v[88:89], v[48:49], v[50:51]
  v_pk_add_f32 v[90:91], v[52:53], v[54:55]
  v_pk_add_f32 v[88:89], v[88:89], v[56:57]
  v_pk_add_f32 v[90:91], v[90:91], v[58:59]
  v_pk_add_f32 v[88:89], v[88:89], v[60:61]
  v_pk_add_f32 v[90:91], v[90:91], v[62:63]
  v_pk_add_f32 v[88:89], v[88:89], v[64:65]
  v_pk_add_f32 v[90:91], v[90:91], v[66:67]
  v_pk_add_f32 v[88:89], v[88:89], v[68:69]
  v_pk_add_f32 v[90:91], v[90:91], v[70:71]
  v_pk_add_f32 v[88:89], v[88:89], v[72:73]
  v_pk_add_f32 v[90:91], v[90:91], v[74:75]
  v_pk_add_f32 v[88:89], v[88:89], v[76:77]
  v_pk_add_f32 v[90:91], v[90:91], v[78:79]
  v_pk_add_f32 v[88:89], v[88:89], v[80:81]
  v_pk_add_f32 v[90:91], v[90:91], v[82:83]
  v_pk_add_f32 v[88:89], v[88:89], v[84:85]
  v_pk_add_f32 v[90:91], v[90:91], v[86:87]
  v_pk_add_f32 v[88:89], v[88:89], v[90:91]
  v_add_f32 v92, v88, v89
  s_nop 1
  v_add_f32_dpp v92, v92, v92 row_ror:8 row_mask:0xf bank_mask:0xf
  s_nop 1
  v_add_f32_dpp v92, v92, v92 row_ror:4 row_mask:0xf bank_mask:0xf
  s_nop 1
  v_add_f32_dpp v92, v92, v92 row_ror:2 row_mask:0xf bank_mask:0xf
  s_nop 1
  v_add_f32_dpp v92, v92, v92 row_ror:1 row_mask:0xf bank_mask:0xf
  v_mul_f32 v92, 0x3acccccd, v92
  v_pk_add_f32 v[94:95], v[48:49], v[92:93] op_sel_hi:[1,0] neg_lo:[0,1] neg_hi:[0,1]
  v_pk_mul_f32 v[88:89], v[94:95], v[94:95]
  v_pk_add_f32 v[96:97], v[50:51], v[92:93] op_sel_hi:[1,0] neg_lo:[0,1] neg_hi:[0,1]
  v_pk_mul_f32 v[90:91], v[96:97], v[96:97]
  v_pk_add_f32 v[94:95], v[52:53], v[92:93] op_sel_hi:[1,0] neg_lo:[0,1] neg_hi:[0,1]
  v_pk_fma_f32 v[88:89], v[94:95], v[94:95], v[88:89]
  v_pk_add_f32 v[96:97], v[54:55], v[92:93] op_sel_hi:[1,0] neg_lo:[0,1] neg_hi:[0,1]
  v_pk_fma_f32 v[90:91], v[96:97], v[96:97], v[90:91]
  v_pk_add_f32 v[94:95], v[56:57], v[92:93] op_sel_hi:[1,0] neg_lo:[0,1] neg_hi:[0,1]
  v_pk_fma_f32 v[88:89], v[94:95], v[94:95], v[88:89]
  v_pk_add_f32 v[96:97], v[58:59], v[92:93] op_sel_hi:[1,0] neg_lo:[0,1] neg_hi:[0,1]
  v_pk_fma_f32 v[90:91], v[96:97], v[96:97], v[90:91]
  v_pk_add_f32 v[94:95], v[60:61], v[92:93] op_sel_hi:[1,0] neg_lo:[0,1] neg_hi:[0,1]
  v_pk_fma_f32 v[88:89], v[94:95], v[94:95], v[88:89]
  v_pk_add_f32 v[96:97], v[62:63], v[92:93] op_sel_hi:[1,0] neg_lo:[0,1] neg_hi:[0,1]
  v_pk_fma_f32 v[90:91], v[96:97], v[96:97], v[90:91]
  v_pk_add_f32 v[94:95], v[64:65], v[92:93] op_sel_hi:[1,0] neg_lo:[0,1] neg_hi:[0,1]
  v_pk_fma_f32 v[88:89], v[94:95], v[94:95], v[88:89]
  v_pk_add_f32 v[96:97], v[66:67], v[92:93] op_sel_hi:[1,0] neg_lo:[0,1] neg_hi:[0,1]
  v_pk_fma_f32 v[90:91], v[96:97], v[96:97], v[90:91]
  v_pk_add_f32 v[94:95], v[68:69], v[92:93] op_sel_hi:[1,0] neg_lo:[0,1] neg_hi:[0,1]
  v_pk_fma_f32 v[88:89], v[94:95], v[94:95], v[88:89]
  v_pk_add_f32 v[96:97], v[70:71], v[92:93] op_sel_hi:[1,0] neg_lo:[0,1] neg_hi:[0,1]
  v_pk_fma_f32 v[90:91], v[96:97], v[96:97], v[90:91]
  v_pk_add_f32 v[94:95], v[72:73], v[92:93] op_sel_hi:[1,0] neg_lo:[0,1] neg_hi:[0,1]
  v_pk_fma_f32 v[88:89], v[94:95], v[94:95], v[88:89]
  v_pk_add_f32 v[96:97], v[74:75], v[92:93] op_sel_hi:[1,0] neg_lo:[0,1] neg_hi:[0,1]
  v_pk_fma_f32 v[90:91], v[96:97], v[96:97], v[90:91]
  v_pk_add_f32 v[94:95], v[76:77], v[92:93] op_sel_hi:[1,0] neg_lo:[0,1] neg_hi:[0,1]
  v_pk_fma_f32 v[88:89], v[94:95], v[94:95], v[88:89]
  v_pk_add_f32 v[96:97], v[78:79], v[92:93] op_sel_hi:[1,0] neg_lo:[0,1] neg_hi:[0,1]
  v_pk_fma_f32 v[90:91], v[96:97], v[96:97], v[90:91]
  v_pk_add_f32 v[94:95], v[80:81], v[92:93] op_sel_hi:[1,0] neg_lo:[0,1] neg_hi:[0,1]
  v_pk_fma_f32 v[88:89], v[94:95], v[94:95], v[88:89]
  v_pk_add_f32 v[96:97], v[82:83], v[92:93] op_sel_hi:[1,0] neg_lo:[0,1] neg_hi:[0,1]
  v_pk_fma_f32 v[90:91], v[96:97], v[96:97], v[90:91]
  v_pk_add_f32 v[94:95], v[84:85], v[92:93] op_sel_hi:[1,0] neg_lo:[0,1] neg_hi:[0,1]
  v_pk_fma_f32 v[88:89], v[94:95], v[94:95], v[88:89]
  v_pk_add_f32 v[96:97], v[86:87], v[92:93] op_sel_hi:[1,0] neg_lo:[0,1] neg_hi:[0,1]
  v_pk_fma_f32 v[90:91], v[96:97], v[96:97], v[90:91]
  v_pk_add_f32 v[88:89], v[88:89], v[90:91]
  v_add_f32 v98, v88, v89
  s_nop 1
  v_add_f32_dpp v98, v98, v98 row_ror:8 row_mask:0xf bank_mask:0xf
  v_cvt_pk_bf16_f32 v92, v92, v92
  s_nop 0
  v_add_f32_dpp v98, v98, v98 row_ror:4 row_mask:0xf bank_mask:0xf
  v_lshlrev_b32 v92, 16, v92
  s_nop 0
  v_add_f32_dpp v98, v98, v98 row_ror:2 row_mask:0xf bank_mask:0xf
  s_nop 1
  v_add_f32_dpp v98, v98, v98 row_ror:1 row_mask:0xf bank_mask:0xf
  v_mul_f32 v98, 0x3acccccd, v98
  v_cvt_pk_bf16_f32 v98, v98, v98
  v_pk_add_f32 v[48:49], v[48:49], v[92:93] op_sel_hi:[1,0] neg_lo:[0,1] neg_hi:[0,1]
  v_lshlrev_b32 v98, 16, v98
  v_pk_add_f32 v[50:51], v[50:51], v[92:93] op_sel_hi:[1,0] neg_lo:[0,1] neg_hi:[0,1]
  v_add_f32 v98, 0x3727c5ac, v98
  v_pk_add_f32 v[52:53], v[52:53], v[92:93] op_sel_hi:[1,0] neg_lo:[0,1] neg_hi:[0,1]
  v_cvt_pk_bf16_f32 v98, v98, v98
  v_pk_add_f32 v[54:55], v[54:55], v[92:93] op_sel_hi:[1,0] neg_lo:[0,1] neg_hi:[0,1]
  v_lshlrev_b32 v98, 16, v98
  v_pk_add_f32 v[56:57], v[56:57], v[92:93] op_sel_hi:[1,0] neg_lo:[0,1] neg_hi:[0,1]
  v_sqrt_f32 v98, v98
  v_pk_add_f32 v[58:59], v[58:59], v[92:93] op_sel_hi:[1,0] neg_lo:[0,1] neg_hi:[0,1]
  v_cvt_pk_bf16_f32 v98, v98, v98
  v_pk_add_f32 v[60:61], v[60:61], v[92:93] op_sel_hi:[1,0] neg_lo:[0,1] neg_hi:[0,1]
  v_lshlrev_b32 v98, 16, v98
  v_pk_add_f32 v[62:63], v[62:63], v[92:93] op_sel_hi:[1,0] neg_lo:[0,1] neg_hi:[0,1]
  v_rcp_f32 v100, v98
  v_pk_add_f32 v[64:65], v[64:65], v[92:93] op_sel_hi:[1,0] neg_lo:[0,1] neg_hi:[0,1]
  v_pk_add_f32 v[66:67], v[66:67], v[92:93] op_sel_hi:[1,0] neg_lo:[0,1] neg_hi:[0,1]
  v_pk_add_f32 v[68:69], v[68:69], v[92:93] op_sel_hi:[1,0] neg_lo:[0,1] neg_hi:[0,1]
  v_pk_add_f32 v[70:71], v[70:71], v[92:93] op_sel_hi:[1,0] neg_lo:[0,1] neg_hi:[0,1]
  v_pk_add_f32 v[72:73], v[72:73], v[92:93] op_sel_hi:[1,0] neg_lo:[0,1] neg_hi:[0,1]
  v_pk_add_f32 v[74:75], v[74:75], v[92:93] op_sel_hi:[1,0] neg_lo:[0,1] neg_hi:[0,1]
  v_pk_add_f32 v[76:77], v[76:77], v[92:93] op_sel_hi:[1,0] neg_lo:[0,1] neg_hi:[0,1]
  v_pk_add_f32 v[78:79], v[78:79], v[92:93] op_sel_hi:[1,0] neg_lo:[0,1] neg_hi:[0,1]
  v_pk_add_f32 v[80:81], v[80:81], v[92:93] op_sel_hi:[1,0] neg_lo:[0,1] neg_hi:[0,1]
  v_pk_add_f32 v[82:83], v[82:83], v[92:93] op_sel_hi:[1,0] neg_lo:[0,1] neg_hi:[0,1]
  v_pk_add_f32 v[84:85], v[84:85], v[92:93] op_sel_hi:[1,0] neg_lo:[0,1] neg_hi:[0,1]
  v_pk_add_f32 v[86:87], v[86:87], v[92:93] op_sel_hi:[1,0] neg_lo:[0,1] neg_hi:[0,1]
  v_mov_b32 v104, 0
  v_mov_b32 v105, 0
  v_cvt_pk_bf16_f32 v8, v48, v49
  v_cvt_pk_bf16_f32 v9, v50, v51
  v_cvt_pk_bf16_f32 v10, v52, v53
  v_cvt_pk_bf16_f32 v11, v54, v55
  v_cvt_pk_bf16_f32 v12, v56, v57
  v_cvt_pk_bf16_f32 v13, v58, v59
  v_cvt_pk_bf16_f32 v14, v60, v61
  v_cvt_pk_bf16_f32 v15, v62, v63
  v_cvt_pk_bf16_f32 v16, v64, v65
  v_cvt_pk_bf16_f32 v17, v66, v67
  v_cvt_pk_bf16_f32 v18, v68, v69
  v_cvt_pk_bf16_f32 v19, v70, v71
  v_cvt_pk_bf16_f32 v20, v72, v73
  v_cvt_pk_bf16_f32 v21, v74, v75
  v_cvt_pk_bf16_f32 v22, v76, v77
  v_cvt_pk_bf16_f32 v23, v78, v79
  v_cvt_pk_bf16_f32 v24, v80, v81
  v_cvt_pk_bf16_f32 v25, v82, v83
  v_cvt_pk_bf16_f32 v26, v84, v85
  v_cvt_pk_bf16_f32 v27, v86, v87
  v_lshlrev_b32 v48, 16, v8
  v_and_b32 v49, s56, v8
  v_lshlrev_b32 v50, 16, v9
  v_and_b32 v51, s56, v9
  v_lshlrev_b32 v52, 16, v10
  v_and_b32 v53, s56, v10
  v_lshlrev_b32 v54, 16, v11
  v_and_b32 v55, s56, v11
  v_lshlrev_b32 v56, 16, v12
  v_and_b32 v57, s56, v12
  v_lshlrev_b32 v58, 16, v13
  v_and_b32 v59, s56, v13
  v_lshlrev_b32 v60, 16, v14
  v_and_b32 v61, s56, v14
  v_lshlrev_b32 v62, 16, v15
  v_and_b32 v63, s56, v15
  v_lshlrev_b32 v64, 16, v16
  v_and_b32 v65, s56, v16
  v_lshlrev_b32 v66, 16, v17
  v_and_b32 v67, s56, v17
  v_lshlrev_b32 v68, 16, v18
  v_and_b32 v69, s56, v18
  v_lshlrev_b32 v70, 16, v19
  v_and_b32 v71, s56, v19
  v_lshlrev_b32 v72, 16, v20
  v_and_b32 v73, s56, v20
  v_lshlrev_b32 v74, 16, v21
  v_and_b32 v75, s56, v21
  v_lshlrev_b32 v76, 16, v22
  v_and_b32 v77, s56, v22
  v_lshlrev_b32 v78, 16, v23
  v_and_b32 v79, s56, v23
  v_lshlrev_b32 v80, 16, v24
  v_and_b32 v81, s56, v24
  v_lshlrev_b32 v82, 16, v25
  v_and_b32 v83, s56, v25
  v_lshlrev_b32 v84, 16, v26
  v_and_b32 v85, s56, v26
  v_lshlrev_b32 v86, 16, v27
  v_and_b32 v87, s56, v27
  v_pk_mul_f32 v[48:49], v[48:49], v[100:101] op_sel_hi:[1,0]
  v_pk_mul_f32 v[50:51], v[50:51], v[100:101] op_sel_hi:[1,0]
  v_pk_mul_f32 v[52:53], v[52:53], v[100:101] op_sel_hi:[1,0]
  v_pk_mul_f32 v[54:55], v[54:55], v[100:101] op_sel_hi:[1,0]
  v_cvt_pk_bf16_f32 v8, v48, v49
  v_cvt_pk_bf16_f32 v9, v50, v51
  v_cvt_pk_bf16_f32 v10, v52, v53
  v_cvt_pk_bf16_f32 v11, v54, v55
  buffer_store_dwordx4 v[8:11], v5, s[24:27], s53 offen sc1
  s_add_u32 s53, s53, 16384
  v_pk_mul_f32 v[56:57], v[56:57], v[100:101] op_sel_hi:[1,0]
  v_pk_mul_f32 v[58:59], v[58:59], v[100:101] op_sel_hi:[1,0]
  v_pk_mul_f32 v[60:61], v[60:61], v[100:101] op_sel_hi:[1,0]
  v_pk_mul_f32 v[62:63], v[62:63], v[100:101] op_sel_hi:[1,0]
  v_cvt_pk_bf16_f32 v12, v56, v57
  v_cvt_pk_bf16_f32 v13, v58, v59
  v_cvt_pk_bf16_f32 v14, v60, v61
  v_cvt_pk_bf16_f32 v15, v62, v63
  buffer_store_dwordx4 v[12:15], v5, s[24:27], s53 offen sc1
  s_add_u32 s53, s53, 16384
  v_pk_mul_f32 v[64:65], v[64:65], v[100:101] op_sel_hi:[1,0]
  v_pk_mul_f32 v[66:67], v[66:67], v[100:101] op_sel_hi:[1,0]
  v_pk_mul_f32 v[68:69], v[68:69], v[100:101] op_sel_hi:[1,0]
  v_pk_mul_f32 v[70:71], v[70:71], v[100:101] op_sel_hi:[1,0]
  v_cvt_pk_bf16_f32 v16, v64, v65
  v_cvt_pk_bf16_f32 v17, v66, v67
  v_cvt_pk_bf16_f32 v18, v68, v69
  v_cvt_pk_bf16_f32 v19, v70, v71
  buffer_store_dwordx4 v[16:19], v5, s[24:27], s53 offen sc1
  s_add_u32 s53, s53, 16384
  v_pk_mul_f32 v[72:73], v[72:73], v[100:101] op_sel_hi:[1,0]
  v_pk_mul_f32 v[74:75], v[74:75], v[100:101] op_sel_hi:[1,0]
  v_pk_mul_f32 v[76:77], v[76:77], v[100:101] op_sel_hi:[1,0]
  v_pk_mul_f32 v[78:79], v[78:79], v[100:101] op_sel_hi:[1,0]
  v_cvt_pk_bf16_f32 v20, v72, v73
  v_cvt_pk_bf16_f32 v21, v74, v75
  v_cvt_pk_bf16_f32 v22, v76, v77
  v_cvt_pk_bf16_f32 v23, v78, v79
  buffer_store_dwordx4 v[20:23], v5, s[24:27], s53 offen sc1
  s_add_u32 s53, s53, 16384
  v_pk_mul_f32 v[80:81], v[80:81], v[100:101] op_sel_hi:[1,0]
  v_pk_mul_f32 v[82:83], v[82:83], v[100:101] op_sel_hi:[1,0]
  v_pk_mul_f32 v[84:85], v[84:85], v[100:101] op_sel_hi:[1,0]
  v_pk_mul_f32 v[86:87], v[86:87], v[100:101] op_sel_hi:[1,0]
  v_cvt_pk_bf16_f32 v24, v80, v81
  v_cvt_pk_bf16_f32 v25, v82, v83
  v_cvt_pk_bf16_f32 v26, v84, v85
  v_cvt_pk_bf16_f32 v27, v86, v87
  buffer_store_dwordx4 v[24:27], v5, s[24:27], s53 offen sc1
  s_add_u32 s53, s53, 16384
  s_waitcnt vmcnt(11)
  v_dot2_f32_bf16 v104, v8, v28, v104
  v_dot2_f32_bf16 v105, v9, v29, v105
  v_dot2_f32_bf16 v104, v10, v30, v104
  v_dot2_f32_bf16 v105, v11, v31, v105
  s_waitcnt vmcnt(10)
  v_dot2_f32_bf16 v104, v12, v32, v104
  v_dot2_f32_bf16 v105, v13, v33, v105
  v_dot2_f32_bf16 v104, v14, v34, v104
  v_dot2_f32_bf16 v105, v15, v35, v105
  s_waitcnt vmcnt(9)
  v_dot2_f32_bf16 v104, v16, v36, v104
  v_dot2_f32_bf16 v105, v17, v37, v105
  v_dot2_f32_bf16 v104, v18, v38, v104
  v_dot2_f32_bf16 v105, v19, v39, v105
  s_waitcnt vmcnt(8)
  v_dot2_f32_bf16 v104, v20, v40, v104
  v_dot2_f32_bf16 v105, v21, v41, v105
  v_dot2_f32_bf16 v104, v22, v42, v104
  v_dot2_f32_bf16 v105, v23, v43, v105
  s_waitcnt vmcnt(7)
  v_dot2_f32_bf16 v104, v24, v44, v104
  v_dot2_f32_bf16 v105, v25, v45, v105
  v_dot2_f32_bf16 v104, v26, v46, v104
  v_dot2_f32_bf16 v105, v27, v47, v105
  s_nop 2
  v_add_f32 v104, v104, v105
  s_nop 1
  v_add_f32_dpp v104, v104, v104 row_ror:8 row_mask:0xf bank_mask:0xf
  s_nop 1
  v_add_f32_dpp v104, v104, v104 row_ror:4 row_mask:0xf bank_mask:0xf
  s_nop 1
  v_add_f32_dpp v104, v104, v104 row_ror:2 row_mask:0xf bank_mask:0xf
  s_nop 1
  v_add_f32_dpp v104, v104, v104 row_ror:1 row_mask:0xf bank_mask:0xf
  v_cvt_pk_bf16_f32 v104, v104, v104
  v_lshlrev_b32 v104, 16, v104
  v_ashrrev_i32 v105, 31, v104
  v_or_b32 v105, 0x80000000, v105
  v_xor_b32 v104, v104, v105
  v_and_b32 v104, s56, v104
  v_add_u32 v6, s52, v1
  v_sub_u32 v7, 0xffff, v6
  v_or_b32 v104, v104, v7
  v_lshlrev_b32 v6, 2, v6
  v_lshl_add_u32 v6, v2, 26, v6
  s_mov_b32 s53, 2621440
  buffer_store_dword v104, v6, s[24:27], s53 offen sc1
  s_waitcnt vmcnt(0)
  s_branch front_join
front_fetch:
  v_subrev_u32 v16, 0x40000, v238
  v_subrev_u32 v17, 0x40000, v239
  v_subrev_u32 v18, 0x40000, v240
  v_subrev_u32 v19, 0x40000, v241
front_join:
  s_waitcnt lgkmcnt(0)
  s_barrier
  s_mul_i32 s55, s59, 0x9e3779b1
  s_add_u32 s55, s55, 0x7f4a7c15
  s_bfe_u32 s58, s2, 0x30003
  s_lshl_b32 s58, s58, 8
  s_add_u32 s58, s58, 2826240
  s_lshl_b32 s53, s36, 2
  s_lshl_b32 s54, s3, 26
  s_add_u32 s53, s53, s54
  v_min_u32 v1, 1, v0
  v_lshlrev_b32 v1, 28, v1
  v_add_u32 v1, s53, v1
  v_mov_b32 v2, s55
  buffer_store_dword v2, v1, s[24:27], s58 offen sc1
  s_cmp_lt_u32 s3, 2
  s_cbranch_scc1 front_addr
  s_mov_b32 s31, 0
  s_add_u32 m0, s28, 90112
  s_nop 0
  buffer_load_dwordx4 v16, s[20:23], s31 offen offset:0 lds
  buffer_load_dwordx4 v17, s[20:23], s31 offen offset:1024 lds
  buffer_load_dwordx4 v18, s[20:23], s31 offen offset:2048 lds
  buffer_load_dwordx4 v19, s[20:23], s31 offen offset:3072 lds
  s_add_u32 m0, s28, 98304
  s_nop 0
  buffer_load_dwordx4 v238, s[20:23], s31 offen offset:0 lds
  buffer_load_dwordx4 v239, s[20:23], s31 offen offset:1024 lds
  buffer_load_dwordx4 v240, s[20:23], s31 offen offset:2048 lds
  buffer_load_dwordx4 v241, s[20:23], s31 offen offset:3072 lds
  s_mov_b32 s31, 524288
  s_add_u32 m0, s28, 106496
  s_nop 0
  buffer_load_dwordx4 v16, s[20:23], s31 offen offset:0 lds
  buffer_load_dwordx4 v17, s[20:23], s31 offen offset:1024 lds
  buffer_load_dwordx4 v18, s[20:23], s31 offen offset:2048 lds
  buffer_load_dwordx4 v19, s[20:23], s31 offen offset:3072 lds
  s_add_u32 m0, s28, 114688
  s_nop 0
  buffer_load_dwordx4 v238, s[20:23], s31 offen offset:0 lds
  buffer_load_dwordx4 v239, s[20:23], s31 offen offset:1024 lds
  buffer_load_dwordx4 v240, s[20:23], s31 offen offset:2048 lds
  buffer_load_dwordx4 v241, s[20:23], s31 offen offset:3072 lds
  s_mov_b32 s31, 1048576
  s_add_u32 m0, s28, 24576
  s_nop 0
  buffer_load_dwordx4 v16, s[20:23], s31 offen offset:0 lds
  buffer_load_dwordx4 v17, s[20:23], s31 offen offset:1024 lds
  buffer_load_dwordx4 v18, s[20:23], s31 offen offset:2048 lds
  buffer_load_dwordx4 v19, s[20:23], s31 offen offset:3072 lds
  s_add_u32 m0, s28, 32768
  s_nop 0
  buffer_load_dwordx4 v238, s[20:23], s31 offen offset:0 lds
  buffer_load_dwordx4 v239, s[20:23], s31 offen offset:1024 lds
  buffer_load_dwordx4 v240, s[20:23], s31 offen offset:2048 lds
  buffer_load_dwordx4 v241, s[20:23], s31 offen offset:3072 lds
  s_mov_b32 s31, 1572864
  s_add_u32 m0, s28, 40960
  s_nop 0
  buffer_load_dwordx4 v16, s[20:23], s31 offen offset:0 lds
  buffer_load_dwordx4 v17, s[20:23], s31 offen offset:1024 lds
  buffer_load_dwordx4 v18, s[20:23], s31 offen offset:2048 lds
  buffer_load_dwordx4 v19, s[20:23], s31 offen offset:3072 lds
  s_add_u32 m0, s28, 49152
  s_nop 0
  buffer_load_dwordx4 v238, s[20:23], s31 offen offset:0 lds
  buffer_load_dwordx4 v239, s[20:23], s31 offen offset:1024 lds
  buffer_load_dwordx4 v240, s[20:23], s31 offen offset:2048 lds
  buffer_load_dwordx4 v241, s[20:23], s31 offen offset:3072 lds
front_addr:
  s_mov_b32 s31, 2097152
  v_lshlrev_b32 v242, 4, v245
  v_add_u32 v243, 0x1000, v242
  s_mul_i32 s30, s37, 81920
  s_lshl_b32 s38, s36, 19
  s_add_u32 s12, s4, s38
  s_addc_u32 s13, s5, 0
  s_mov_b32 s14, 524288
  s_mov_b32 s15, 0x20000
  s_add_u32 s16, s6, s38
  s_addc_u32 s17, s7, 0
  s_mov_b32 s18, 524288
  s_mov_b32 s19, 0x20000
  v_lshlrev_b32 v249, 8, v248
  v_add_u32 v249, s28, v249
  v_add_u32 v250, 0, v248
  v_xor_b32 v250, v250, v247
  v_lshl_add_u32 v232, v250, 4, v249
  v_add_u32 v250, 4, v248
  v_xor_b32 v250, v250, v247
  v_lshl_add_u32 v233, v250, 4, v249
  v_add_u32 v250, 8, v248
  v_xor_b32 v250, v250, v247
  v_lshl_add_u32 v234, v250, 4, v249
  v_add_u32 v250, 12, v248
  v_xor_b32 v250, v250, v247
  v_lshl_add_u32 v235, v250, 4, v249
  v_add_u32 v250, 0, v248
  v_lshlrev_b32 v250, 1, v250
  v_xor_b32 v250, v250, v247
  v_lshl_add_u32 v236, v250, 4, v249
  v_add_u32 v250, 4, v248
  v_lshlrev_b32 v250, 1, v250
  v_xor_b32 v250, v250, v247
  v_lshl_add_u32 v237, v250, 4, v249
  v_lshrrev_b32 v249, 1, v248
  v_and_b32 v250, 1, v248
  v_lshl_or_b32 v249, v250, 1, v249
  v_xor_b32 v249, v249, v247
  v_lshlrev_b32 v249, 4, v249
  v_lshl_add_u32 v212, v247, 8, v249
  v_xor_b32 v213, 64, v212
  v_xor_b32 v214, 128, v212
  v_xor_b32 v215, 192, v212
  v_bfe_u32 v246, v245, 2, 2
  v_and_b32 v247, 3, v245
  v_lshlrev_b32 v247, 3, v247
  v_add_u32 v247, 65536, v247
  v_lshl_add_u32 v249, v248, 2, v246
  v_and_b32 v250, 7, v249
  v_lshl_add_u32 v250, v250, 5, v247
  v_lshl_add_u32 v216, v249, 8, v250
  v_lshl_add_u32 v249, v248, 3, v246
  v_and_b32 v250, 1, v248
  v_lshl_add_u32 v250, v250, 2, v246
  v_lshl_add_u32 v250, v250, 5, v247
  v_lshl_add_u32 v224, v249, 8, v250
  v_xor_b32 v217, 32, v216
  v_xor_b32 v225, 32, v224
  v_xor_b32 v218, 64, v216
  v_xor_b32 v226, 64, v224
  v_xor_b32 v219, 96, v216
  v_xor_b32 v227, 96, v224
  v_xor_b32 v220, 128, v216
  v_xor_b32 v228, 128, v224
  v_xor_b32 v221, 160, v216
  v_xor_b32 v229, 160, v224
  v_xor_b32 v222, 192, v216
  v_xor_b32 v230, 192, v224
  v_xor_b32 v223, 224, v216
  v_xor_b32 v231, 224, v224
  v_subrev_u32 v144, 65536, v224
  v_subrev_u32 v145, 65536, v225
  v_subrev_u32 v146, 65536, v226
  v_subrev_u32 v147, 65536, v227
  v_subrev_u32 v148, 65536, v228
  v_subrev_u32 v149, 65536, v229
  v_subrev_u32 v150, 65536, v230
  v_subrev_u32 v151, 65536, v231
  s_lshr_b32 s38, s2, 3
  s_min_u32 s38, s38, 26
  s_and_b32 s39, s2, 7
  s_mul_i32 s39, s39, 27
  s_add_u32 s33, s38, s39
  s_mul_i32 s50, s3, 6144
  s_add_u32 s50, s50, 133120
  v_mov_b32 v244, v242
  s_lshl_b32 s40, s37, 19
  s_lshl_b32 s38, s36, 14
  s_add_u32 s40, s40, s38
  s_add_u32 s40, s40, 8388608
  s_add_u32 s41, s40, 4096
  s_add_u32 s42, s40, 8192
  s_add_u32 s43, s40, 12288
  s_mov_b32 s34, 0x3e0293ee
  s_mov_b32 s29, 0
  v_and_b32 v249, 15, v245
  v_cmp_eq_u32 vcc, 0, v249
  v_mov_b32 v249, 0x3f803f80
  s_nop 0
  v_cndmask_b32 v249, 0, v249, vcc
  v_accvgpr_write_b32 a208, v249
  v_accvgpr_write_b32 a209, v249
  v_accvgpr_write_b32 a210, v249
  v_accvgpr_write_b32 a211, v249
  s_cmp_lg_u32 s3, 0
  s_cbranch_scc1 front_go
  v_and_b32 v2, 31, v0
  v_lshlrev_b32 v2, 2, v2
  s_mov_b32 s54, 32768
front_poll:
  buffer_load_dword v1, v2, s[24:27], s58 offen sc1
  s_waitcnt vmcnt(0)
  v_cmp_ne_u32 vcc, s55, v1
  s_nop 0
  s_cbranch_vccz front_go
  s_sleep 2
  s_sub_u32 s54, s54, 1
  s_cmp_lg_u32 s54, 0
  s_cbranch_scc1 front_poll
front_go:
  s_waitcnt vmcnt(24)
  s_barrier
  buffer_load_dwordx4 a[0:3], v242, s[24:27], s30 offen offset:0 sc1
  buffer_load_dwordx4 a[4:7], v242, s[24:27], s30 offen offset:1024 sc1
  buffer_load_dwordx4 a[8:11], v242, s[24:27], s30 offen offset:2048 sc1
  buffer_load_dwordx4 a[12:15], v242, s[24:27], s30 offen offset:3072 sc1
  buffer_load_dwordx4 a[16:19], v243, s[24:27], s30 offen offset:0 sc1
  buffer_load_dwordx4 a[20:23], v243, s[24:27], s30 offen offset:1024 sc1
  buffer_load_dwordx4 a[24:27], v243, s[24:27], s30 offen offset:2048 sc1
  buffer_load_dwordx4 a[28:31], v243, s[24:27], s30 offen offset:3072 sc1
  s_add_u32 s30, s30, 8192
  buffer_load_dwordx4 a[32:35], v242, s[24:27], s30 offen offset:0 sc1
  buffer_load_dwordx4 a[36:39], v242, s[24:27], s30 offen offset:1024 sc1
  buffer_load_dwordx4 a[40:43], v242, s[24:27], s30 offen offset:2048 sc1
  buffer_load_dwordx4 a[44:47], v242, s[24:27], s30 offen offset:3072 sc1
  buffer_load_dwordx4 a[48:51], v243, s[24:27], s30 offen offset:0 sc1
  buffer_load_dwordx4 a[52:55], v243, s[24:27], s30 offen offset:1024 sc1
  buffer_load_dwordx4 a[56:59], v243, s[24:27], s30 offen offset:2048 sc1
  buffer_load_dwordx4 a[60:63], v243, s[24:27], s30 offen offset:3072 sc1
  s_add_u32 s30, s30, 8192
  v_lshrrev_b32 v140, 7, v242
  v_lshlrev_b32 v140, 8, v140
  v_and_b32 v136, 0x70, v242
  v_add_u32 v140, v140, v136
  s_mov_b32 s58, 2826240
  buffer_load_dwordx4 v[136:139], v140, s[24:27], s58 offen sc1
  ds_read_b64_tr_b16 a[160:161], v224 offset:32768
  ds_read_b64_tr_b16 a[162:163], v224 offset:33792
  ds_read_b64_tr_b16 a[164:165], v224 offset:40960
  ds_read_b64_tr_b16 a[166:167], v224 offset:41984
  ds_read_b64_tr_b16 a[168:169], v225 offset:32768
  ds_read_b64_tr_b16 a[170:171], v225 offset:33792
  ds_read_b64_tr_b16 a[172:173], v225 offset:40960
  ds_read_b64_tr_b16 a[174:175], v225 offset:41984
  s_waitcnt vmcnt(9) lgkmcnt(4)
  v_mfma_f32_16x16x32_bf16 v[0:3], a[160:163], a[0:3], 0
  ds_read_b64_tr_b16 a[176:177], v226 offset:32768
  v_mfma_f32_16x16x32_bf16 v[0:3], a[164:167], a[16:19], v[0:3]
  buffer_load_dwordx4 a[64:67], v242, s[24:27], s30 offen offset:0 sc1
  v_mfma_f32_16x16x32_bf16 v[4:7], a[164:167], a[20:23], 0
  ds_read_b64_tr_b16 a[178:179], v226 offset:33792
  v_mfma_f32_16x16x32_bf16 v[4:7], a[160:163], a[4:7], v[4:7]
  buffer_load_dwordx4 a[68:71], v242, s[24:27], s30 offen offset:1024 sc1
  v_mfma_f32_16x16x32_bf16 v[8:11], a[160:163], a[8:11], 0
  ds_read_b64_tr_b16 a[180:181], v226 offset:40960
  v_mfma_f32_16x16x32_bf16 v[8:11], a[164:167], a[24:27], v[8:11]
  v_mfma_f32_16x16x32_bf16 v[12:15], a[164:167], a[28:31], 0
  ds_read_b64_tr_b16 a[182:183], v226 offset:41984
  v_mfma_f32_16x16x32_bf16 v[12:15], a[160:163], a[12:15], v[12:15]
  s_waitcnt lgkmcnt(4)
  buffer_load_dwordx4 a[72:75], v242, s[24:27], s30 offen offset:2048 sc1
  v_mfma_f32_16x16x32_bf16 v[16:19], a[168:171], a[0:3], 0
  ds_read_b64_tr_b16 a[184:185], v227 offset:32768
  v_mfma_f32_16x16x32_bf16 v[16:19], a[172:175], a[16:19], v[16:19]
  v_mfma_f32_16x16x32_bf16 v[20:23], a[172:175], a[20:23], 0
  ds_read_b64_tr_b16 a[186:187], v227 offset:33792
  v_mfma_f32_16x16x32_bf16 v[20:23], a[168:171], a[4:7], v[20:23]
  buffer_load_dwordx4 a[76:79], v242, s[24:27], s30 offen offset:3072 sc1
  v_mfma_f32_16x16x32_bf16 v[24:27], a[168:171], a[8:11], 0
  ds_read_b64_tr_b16 a[188:189], v227 offset:40960
  v_mfma_f32_16x16x32_bf16 v[24:27], a[172:175], a[24:27], v[24:27]
  buffer_load_dwordx4 a[80:83], v243, s[24:27], s30 offen offset:0 sc1
  v_mfma_f32_16x16x32_bf16 v[28:31], a[172:175], a[28:31], 0
  ds_read_b64_tr_b16 a[190:191], v227 offset:41984
  v_mfma_f32_16x16x32_bf16 v[28:31], a[168:171], a[12:15], v[28:31]
  s_waitcnt lgkmcnt(4)
  v_mfma_f32_16x16x32_bf16 v[32:35], a[176:179], a[0:3], 0
  ds_read_b64_tr_b16 a[160:161], v228 offset:32768
  v_mfma_f32_16x16x32_bf16 v[32:35], a[180:183], a[16:19], v[32:35]
  buffer_load_dwordx4 a[84:87], v243, s[24:27], s30 offen offset:1024 sc1
  v_mfma_f32_16x16x32_bf16 v[36:39], a[180:183], a[20:23], 0
  ds_read_b64_tr_b16 a[162:163], v228 offset:33792
  v_mfma_f32_16x16x32_bf16 v[36:39], a[176:179], a[4:7], v[36:39]
  v_mfma_f32_16x16x32_bf16 v[40:43], a[176:179], a[8:11], 0
  ds_read_b64_tr_b16 a[164:165], v228 offset:40960
  v_mfma_f32_16x16x32_bf16 v[40:43], a[180:183], a[24:27], v[40:43]
  buffer_load_dwordx4 a[88:91], v243, s[24:27], s30 offen offset:2048 sc1
  v_mfma_f32_16x16x32_bf16 v[44:47], a[180:183], a[28:31], 0
  ds_read_b64_tr_b16 a[166:167], v228 offset:41984
  v_mfma_f32_16x16x32_bf16 v[44:47], a[176:179], a[12:15], v[44:47]
  s_waitcnt lgkmcnt(4)
  buffer_load_dwordx4 a[92:95], v243, s[24:27], s30 offen offset:3072 sc1
  v_mfma_f32_16x16x32_bf16 v[48:51], a[184:187], a[0:3], 0
  ds_read_b64_tr_b16 a[168:169], v229 offset:32768
  v_mfma_f32_16x16x32_bf16 v[48:51], a[188:191], a[16:19], v[48:51]
  v_mfma_f32_16x16x32_bf16 v[52:55], a[188:191], a[20:23], 0
  ds_read_b64_tr_b16 a[170:171], v229 offset:33792
  v_mfma_f32_16x16x32_bf16 v[52:55], a[184:187], a[4:7], v[52:55]
  s_add_u32 s30, s30, 8192
  v_mfma_f32_16x16x32_bf16 v[56:59], a[184:187], a[8:11], 0
  ds_read_b64_tr_b16 a[172:173], v229 offset:40960
  v_mfma_f32_16x16x32_bf16 v[56:59], a[188:191], a[24:27], v[56:59]
  v_mfma_f32_16x16x32_bf16 v[60:63], a[188:191], a[28:31], 0
  ds_read_b64_tr_b16 a[174:175], v229 offset:41984
  v_mfma_f32_16x16x32_bf16 v[60:63], a[184:187], a[12:15], v[60:63]
  s_waitcnt lgkmcnt(4)
  buffer_load_dwordx4 a[96:99], v242, s[24:27], s30 offen offset:0 sc1
  v_mfma_f32_16x16x32_bf16 v[64:67], a[160:163], a[0:3], 0
  ds_read_b64_tr_b16 a[176:177], v230 offset:32768
  v_mfma_f32_16x16x32_bf16 v[64:67], a[164:167], a[16:19], v[64:67]
  buffer_load_dwordx4 a[100:103], v242, s[24:27], s30 offen offset:1024 sc1
  v_mfma_f32_16x16x32_bf16 v[68:71], a[164:167], a[20:23], 0
  ds_read_b64_tr_b16 a[178:179], v230 offset:33792
  v_mfma_f32_16x16x32_bf16 v[68:71], a[160:163], a[4:7], v[68:71]
  v_mfma_f32_16x16x32_bf16 v[72:75], a[160:163], a[8:11], 0
  ds_read_b64_tr_b16 a[180:181], v230 offset:40960
  v_mfma_f32_16x16x32_bf16 v[72:75], a[164:167], a[24:27], v[72:75]
  buffer_load_dwordx4 a[104:107], v242, s[24:27], s30 offen offset:2048 sc1
  v_mfma_f32_16x16x32_bf16 v[76:79], a[164:167], a[28:31], 0
  ds_read_b64_tr_b16 a[182:183], v230 offset:41984
  v_mfma_f32_16x16x32_bf16 v[76:79], a[160:163], a[12:15], v[76:79]
  s_waitcnt lgkmcnt(4)
  v_mfma_f32_16x16x32_bf16 v[80:83], a[168:171], a[0:3], 0
  ds_read_b64_tr_b16 a[184:185], v231 offset:32768
  v_mfma_f32_16x16x32_bf16 v[80:83], a[172:175], a[16:19], v[80:83]
  buffer_load_dwordx4 a[108:111], v242, s[24:27], s30 offen offset:3072 sc1
  v_mfma_f32_16x16x32_bf16 v[84:87], a[172:175], a[20:23], 0
  ds_read_b64_tr_b16 a[186:187], v231 offset:33792
  v_mfma_f32_16x16x32_bf16 v[84:87], a[168:171], a[4:7], v[84:87]
  buffer_load_dwordx4 a[112:115], v243, s[24:27], s30 offen offset:0 sc1
  v_mfma_f32_16x16x32_bf16 v[88:91], a[168:171], a[8:11], 0
  ds_read_b64_tr_b16 a[188:189], v231 offset:40960
  v_mfma_f32_16x16x32_bf16 v[88:91], a[172:175], a[24:27], v[88:91]
  s_barrier
  v_mfma_f32_16x16x32_bf16 v[92:95], a[172:175], a[28:31], 0
  ds_read_b64_tr_b16 a[190:191], v231 offset:41984
  v_mfma_f32_16x16x32_bf16 v[92:95], a[168:171], a[12:15], v[92:95]
  s_waitcnt lgkmcnt(4)
  buffer_load_dwordx4 a[116:119], v243, s[24:27], s30 offen offset:1024 sc1
  v_mfma_f32_16x16x32_bf16 v[96:99], a[176:179], a[0:3], 0
  ds_read_b64_tr_b16 a[160:161], v224 offset:49152
  v_mfma_f32_16x16x32_bf16 v[96:99], a[180:183], a[16:19], v[96:99]
  v_mfma_f32_16x16x32_bf16 v[100:103], a[180:183], a[20:23], 0
  ds_read_b64_tr_b16 a[162:163], v224 offset:50176
  v_mfma_f32_16x16x32_bf16 v[100:103], a[176:179], a[4:7], v[100:103]
  buffer_load_dwordx4 a[120:123], v243, s[24:27], s30 offen offset:2048 sc1
  v_mfma_f32_16x16x32_bf16 v[104:107], a[176:179], a[8:11], 0
  ds_read_b64_tr_b16 a[164:165], v224 offset:57344
  v_mfma_f32_16x16x32_bf16 v[104:107], a[180:183], a[24:27], v[104:107]
  buffer_load_dwordx4 a[124:127], v243, s[24:27], s30 offen offset:3072 sc1
  v_mfma_f32_16x16x32_bf16 v[108:111], a[180:183], a[28:31], 0
  ds_read_b64_tr_b16 a[166:167], v224 offset:58368
  v_mfma_f32_16x16x32_bf16 v[108:111], a[176:179], a[12:15], v[108:111]
  s_waitcnt lgkmcnt(4)
  v_mfma_f32_16x16x32_bf16 v[112:115], a[184:187], a[0:3], 0
  ds_read_b64_tr_b16 a[168:169], v225 offset:49152
  v_mfma_f32_16x16x32_bf16 v[112:115], a[188:191], a[16:19], v[112:115]
  s_add_u32 s30, s30, 8192
  v_mfma_f32_16x16x32_bf16 v[116:119], a[188:191], a[20:23], 0
  ds_read_b64_tr_b16 a[170:171], v225 offset:50176
  v_mfma_f32_16x16x32_bf16 v[116:119], a[184:187], a[4:7], v[116:119]
  v_mfma_f32_16x16x32_bf16 v[120:123], a[184:187], a[8:11], 0
  ds_read_b64_tr_b16 a[172:173], v225 offset:57344
  v_mfma_f32_16x16x32_bf16 v[120:123], a[188:191], a[24:27], v[120:123]
  v_mfma_f32_16x16x32_bf16 v[124:127], a[188:191], a[28:31], 0
  ds_read_b64_tr_b16 a[174:175], v225 offset:58368
  v_mfma_f32_16x16x32_bf16 v[124:127], a[184:187], a[12:15], v[124:127]
  s_waitcnt vmcnt(17) lgkmcnt(4)
  v_mfma_f32_16x16x32_bf16 v[0:3], a[160:163], a[32:35], v[0:3]
  ds_read_b64_tr_b16 a[176:177], v226 offset:49152
  v_mfma_f32_16x16x32_bf16 v[0:3], a[164:167], a[48:51], v[0:3]
  buffer_load_dwordx4 a[0:3], v242, s[24:27], s30 offen offset:0 sc1
  v_mfma_f32_16x16x32_bf16 v[4:7], a[164:167], a[52:55], v[4:7]
  ds_read_b64_tr_b16 a[178:179], v226 offset:50176
  v_mfma_f32_16x16x32_bf16 v[4:7], a[160:163], a[36:39], v[4:7]
  v_mfma_f32_16x16x32_bf16 v[8:11], a[160:163], a[40:43], v[8:11]
  ds_read_b64_tr_b16 a[180:181], v226 offset:57344
  s_add_u32 m0, s28, 16384
  v_mfma_f32_16x16x32_bf16 v[8:11], a[164:167], a[56:59], v[8:11]
  buffer_load_dwordx4 v238, s[20:23], s31 offen offset:0 lds
  v_mfma_f32_16x16x32_bf16 v[12:15], a[164:167], a[60:63], v[12:15]
  ds_read_b64_tr_b16 a[182:183], v226 offset:58368
  v_mfma_f32_16x16x32_bf16 v[12:15], a[160:163], a[44:47], v[12:15]
  s_waitcnt lgkmcnt(4)
  v_mfma_f32_16x16x32_bf16 v[16:19], a[168:171], a[32:35], v[16:19]
  ds_read_b64_tr_b16 a[184:185], v227 offset:49152
  v_mfma_f32_16x16x32_bf16 v[16:19], a[172:175], a[48:51], v[16:19]
  buffer_load_dwordx4 a[4:7], v242, s[24:27], s30 offen offset:1024 sc1
  v_mfma_f32_16x16x32_bf16 v[20:23], a[172:175], a[52:55], v[20:23]
  ds_read_b64_tr_b16 a[186:187], v227 offset:50176
  v_mfma_f32_16x16x32_bf16 v[20:23], a[168:171], a[36:39], v[20:23]
  v_mfma_f32_16x16x32_bf16 v[24:27], a[168:171], a[40:43], v[24:27]
  ds_read_b64_tr_b16 a[188:189], v227 offset:57344
  v_mfma_f32_16x16x32_bf16 v[24:27], a[172:175], a[56:59], v[24:27]
  v_mfma_f32_16x16x32_bf16 v[28:31], a[172:175], a[60:63], v[28:31]
  ds_read_b64_tr_b16 a[190:191], v227 offset:58368
  v_mfma_f32_16x16x32_bf16 v[28:31], a[168:171], a[44:47], v[28:31]
  s_waitcnt lgkmcnt(4)
  v_mfma_f32_16x16x32_bf16 v[32:35], a[176:179], a[32:35], v[32:35]
  ds_read_b64_tr_b16 a[160:161], v228 offset:49152
  v_mfma_f32_16x16x32_bf16 v[32:35], a[180:183], a[48:51], v[32:35]
  buffer_load_dwordx4 a[8:11], v242, s[24:27], s30 offen offset:2048 sc1
  v_mfma_f32_16x16x32_bf16 v[36:39], a[180:183], a[52:55], v[36:39]
  ds_read_b64_tr_b16 a[162:163], v228 offset:50176
  v_mfma_f32_16x16x32_bf16 v[36:39], a[176:179], a[36:39], v[36:39]
  v_mfma_f32_16x16x32_bf16 v[40:43], a[176:179], a[40:43], v[40:43]
  ds_read_b64_tr_b16 a[164:165], v228 offset:57344
  v_mfma_f32_16x16x32_bf16 v[40:43], a[180:183], a[56:59], v[40:43]
  buffer_load_dwordx4 v239, s[20:23], s31 offen offset:1024 lds
  v_mfma_f32_16x16x32_bf16 v[44:47], a[180:183], a[60:63], v[44:47]
  ds_read_b64_tr_b16 a[166:167], v228 offset:58368
  v_mfma_f32_16x16x32_bf16 v[44:47], a[176:179], a[44:47], v[44:47]
  s_waitcnt lgkmcnt(4)
  v_mfma_f32_16x16x32_bf16 v[48:51], a[184:187], a[32:35], v[48:51]
  ds_read_b64_tr_b16 a[168:169], v229 offset:49152
  v_mfma_f32_16x16x32_bf16 v[48:51], a[188:191], a[48:51], v[48:51]
  buffer_load_dwordx4 a[12:15], v242, s[24:27], s30 offen offset:3072 sc1
  v_mfma_f32_16x16x32_bf16 v[52:55], a[188:191], a[52:55], v[52:55]
  ds_read_b64_tr_b16 a[170:171], v229 offset:50176
  v_mfma_f32_16x16x32_bf16 v[52:55], a[184:187], a[36:39], v[52:55]
  v_mfma_f32_16x16x32_bf16 v[56:59], a[184:187], a[40:43], v[56:59]
  ds_read_b64_tr_b16 a[172:173], v229 offset:57344
  v_mfma_f32_16x16x32_bf16 v[56:59], a[188:191], a[56:59], v[56:59]
  v_mfma_f32_16x16x32_bf16 v[60:63], a[188:191], a[60:63], v[60:63]
  ds_read_b64_tr_b16 a[174:175], v229 offset:58368
  v_mfma_f32_16x16x32_bf16 v[60:63], a[184:187], a[44:47], v[60:63]
  s_waitcnt lgkmcnt(4)
  v_mfma_f32_16x16x32_bf16 v[64:67], a[160:163], a[32:35], v[64:67]
  ds_read_b64_tr_b16 a[176:177], v230 offset:49152
  v_mfma_f32_16x16x32_bf16 v[64:67], a[164:167], a[48:51], v[64:67]
  buffer_load_dwordx4 a[16:19], v243, s[24:27], s30 offen offset:0 sc1
  v_mfma_f32_16x16x32_bf16 v[68:71], a[164:167], a[52:55], v[68:71]
  ds_read_b64_tr_b16 a[178:179], v230 offset:50176
  v_mfma_f32_16x16x32_bf16 v[68:71], a[160:163], a[36:39], v[68:71]
  v_mfma_f32_16x16x32_bf16 v[72:75], a[160:163], a[40:43], v[72:75]
  ds_read_b64_tr_b16 a[180:181], v230 offset:57344
  v_mfma_f32_16x16x32_bf16 v[72:75], a[164:167], a[56:59], v[72:75]
  buffer_load_dwordx4 v240, s[20:23], s31 offen offset:2048 lds
  v_mfma_f32_16x16x32_bf16 v[76:79], a[164:167], a[60:63], v[76:79]
  ds_read_b64_tr_b16 a[182:183], v230 offset:58368
  v_mfma_f32_16x16x32_bf16 v[76:79], a[160:163], a[44:47], v[76:79]
  s_waitcnt lgkmcnt(4)
  v_mfma_f32_16x16x32_bf16 v[80:83], a[168:171], a[32:35], v[80:83]
  ds_read_b64_tr_b16 a[184:185], v231 offset:49152
  v_mfma_f32_16x16x32_bf16 v[80:83], a[172:175], a[48:51], v[80:83]
  buffer_load_dwordx4 a[20:23], v243, s[24:27], s30 offen offset:1024 sc1
  v_mfma_f32_16x16x32_bf16 v[84:87], a[172:175], a[52:55], v[84:87]
  ds_read_b64_tr_b16 a[186:187], v231 offset:50176
  v_mfma_f32_16x16x32_bf16 v[84:87], a[168:171], a[36:39], v[84:87]
  v_mfma_f32_16x16x32_bf16 v[88:91], a[168:171], a[40:43], v[88:91]
  ds_read_b64_tr_b16 a[188:189], v231 offset:57344
  v_mfma_f32_16x16x32_bf16 v[88:91], a[172:175], a[56:59], v[88:91]
  s_barrier
  v_mfma_f32_16x16x32_bf16 v[92:95], a[172:175], a[60:63], v[92:95]
  ds_read_b64_tr_b16 a[190:191], v231 offset:58368
  v_mfma_f32_16x16x32_bf16 v[92:95], a[168:171], a[44:47], v[92:95]
  s_waitcnt lgkmcnt(4)
  v_mfma_f32_16x16x32_bf16 v[96:99], a[176:179], a[32:35], v[96:99]
  ds_read_b64_tr_b16 a[160:161], v144 offset:32768
  v_mfma_f32_16x16x32_bf16 v[96:99], a[180:183], a[48:51], v[96:99]
  buffer_load_dwordx4 a[24:27], v243, s[24:27], s30 offen offset:2048 sc1
  v_mfma_f32_16x16x32_bf16 v[100:103], a[180:183], a[52:55], v[100:103]
  ds_read_b64_tr_b16 a[162:163], v144 offset:33792
  v_mfma_f32_16x16x32_bf16 v[100:103], a[176:179], a[36:39], v[100:103]
  v_mfma_f32_16x16x32_bf16 v[104:107], a[176:179], a[40:43], v[104:107]
  ds_read_b64_tr_b16 a[164:165], v144 offset:40960
  v_mfma_f32_16x16x32_bf16 v[104:107], a[180:183], a[56:59], v[104:107]
  buffer_load_dwordx4 v241, s[20:23], s31 offen offset:3072 lds
  s_add_u32 s31, s31, 0x80000
  v_mfma_f32_16x16x32_bf16 v[108:111], a[180:183], a[60:63], v[108:111]
  ds_read_b64_tr_b16 a[166:167], v144 offset:41984
  v_mfma_f32_16x16x32_bf16 v[108:111], a[176:179], a[44:47], v[108:111]
  s_waitcnt lgkmcnt(4)
  v_mfma_f32_16x16x32_bf16 v[112:115], a[184:187], a[32:35], v[112:115]
  ds_read_b64_tr_b16 a[168:169], v145 offset:32768
  v_mfma_f32_16x16x32_bf16 v[112:115], a[188:191], a[48:51], v[112:115]
  buffer_load_dwordx4 a[28:31], v243, s[24:27], s30 offen offset:3072 sc1
  s_add_u32 s30, s30, 8192
  v_mfma_f32_16x16x32_bf16 v[116:119], a[188:191], a[52:55], v[116:119]
  ds_read_b64_tr_b16 a[170:171], v145 offset:33792
  v_mfma_f32_16x16x32_bf16 v[116:119], a[184:187], a[36:39], v[116:119]
  v_mfma_f32_16x16x32_bf16 v[120:123], a[184:187], a[40:43], v[120:123]
  ds_read_b64_tr_b16 a[172:173], v145 offset:40960
  v_mfma_f32_16x16x32_bf16 v[120:123], a[188:191], a[56:59], v[120:123]
  v_mfma_f32_16x16x32_bf16 v[124:127], a[188:191], a[60:63], v[124:127]
  ds_read_b64_tr_b16 a[174:175], v145 offset:41984
  v_mfma_f32_16x16x32_bf16 v[124:127], a[184:187], a[44:47], v[124:127]
  s_waitcnt vmcnt(20) lgkmcnt(4)
  v_xor_b32 v136, s55, v136
  v_xor_b32 v137, s55, v137
  v_xor_b32 v138, s55, v138
  v_xor_b32 v139, s55, v139
  v_or3_b32 v136, v136, v137, v138
  v_or_b32 v136, v136, v139
  v_cmp_ne_u32 vcc, 0, v136
  s_nop 0
  s_cbranch_vccz front_keys
  s_mov_b32 s54, 32768
front_all:
  s_sleep 2
  buffer_load_dwordx4 v[136:139], v140, s[24:27], s58 offen sc1
  s_waitcnt vmcnt(0)
  v_xor_b32 v136, s55, v136
  v_xor_b32 v137, s55, v137
  v_xor_b32 v138, s55, v138
  v_xor_b32 v139, s55, v139
  v_or3_b32 v136, v136, v137, v138
  v_or_b32 v136, v136, v139
  v_cmp_ne_u32 vcc, 0, v136
  s_nop 0
  s_cbranch_vccz front_keys
  s_sub_u32 s54, s54, 1
  s_cmp_lg_u32 s54, 0
  s_cbranch_scc1 front_all
front_keys:
  s_lshl_b32 s35, s3, 11
  s_add_u32 s35, s35, 2621440
  buffer_load_dwordx4 v[128:131], v242, s[24:27], s35 offen sc1
  buffer_load_dwordx4 v[132:135], v242, s[24:27], s35 offen offset:1024 sc1
  v_mfma_f32_16x16x32_bf16 v[0:3], a[160:163], a[64:67], v[0:3]
  ds_read_b64_tr_b16 a[176:177], v146 offset:32768
  s_add_u32 s59, s59, 1
  s_or_b32 s54, s2, s3
  v_mfma_f32_16x16x32_bf16 v[0:3], a[164:167], a[80:83], v[0:3]
  buffer_load_dwordx4 a[32:35], v242, s[24:27], s30 offen offset:0 sc1
  s_min_u32 s54, s54, 1
  s_lshl_b32 s54, s54, 28
  v_mfma_f32_16x16x32_bf16 v[4:7], a[164:167], a[84:87], v[4:7]
  ds_read_b64_tr_b16 a[178:179], v146 offset:33792
  v_lshlrev_b32 v137, 22, v242
  v_mfma_f32_16x16x32_bf16 v[4:7], a[160:163], a[68:71], v[4:7]
  v_or_b32 v137, s54, v137
  v_mov_b32 v136, s59
  v_mfma_f32_16x16x32_bf16 v[8:11], a[160:163], a[72:75], v[8:11]
  ds_read_b64_tr_b16 a[180:181], v146 offset:40960
  s_add_u32 m0, s28, 0
  s_mov_b32 s58, 2830336
  buffer_store_dword v136, v137, s[24:27], s58 offen sc1
  v_mfma_f32_16x16x32_bf16 v[8:11], a[164:167], a[88:91], v[8:11]
  buffer_load_dwordx4 v238, s[20:23], s31 offen offset:0 lds
  v_mfma_f32_16x16x32_bf16 v[12:15], a[164:167], a[92:95], v[12:15]
  ds_read_b64_tr_b16 a[182:183], v146 offset:41984
  v_mfma_f32_16x16x32_bf16 v[12:15], a[160:163], a[76:79], v[12:15]
  s_waitcnt lgkmcnt(4)
  v_mfma_f32_16x16x32_bf16 v[16:19], a[168:171], a[64:67], v[16:19]
  ds_read_b64_tr_b16 a[184:185], v147 offset:32768
  v_mfma_f32_16x16x32_bf16 v[16:19], a[172:175], a[80:83], v[16:19]
  buffer_load_dwordx4 a[36:39], v242, s[24:27], s30 offen offset:1024 sc1
  v_mfma_f32_16x16x32_bf16 v[20:23], a[172:175], a[84:87], v[20:23]
  ds_read_b64_tr_b16 a[186:187], v147 offset:33792
  v_mfma_f32_16x16x32_bf16 v[20:23], a[168:171], a[68:71], v[20:23]
  v_mfma_f32_16x16x32_bf16 v[24:27], a[168:171], a[72:75], v[24:27]
  ds_read_b64_tr_b16 a[188:189], v147 offset:40960
  v_mfma_f32_16x16x32_bf16 v[24:27], a[172:175], a[88:91], v[24:27]
  v_mfma_f32_16x16x32_bf16 v[28:31], a[172:175], a[92:95], v[28:31]
  ds_read_b64_tr_b16 a[190:191], v147 offset:41984
  v_mfma_f32_16x16x32_bf16 v[28:31], a[168:171], a[76:79], v[28:31]
  s_waitcnt lgkmcnt(4)
  v_mfma_f32_16x16x32_bf16 v[32:35], a[176:179], a[64:67], v[32:35]
  ds_read_b64_tr_b16 a[160:161], v148 offset:32768
  v_mfma_f32_16x16x32_bf16 v[32:35], a[180:183], a[80:83], v[32:35]
  buffer_load_dwordx4 a[40:43], v242, s[24:27], s30 offen offset:2048 sc1
  v_mfma_f32_16x16x32_bf16 v[36:39], a[180:183], a[84:87], v[36:39]
  ds_read_b64_tr_b16 a[162:163], v148 offset:33792
  v_mfma_f32_16x16x32_bf16 v[36:39], a[176:179], a[68:71], v[36:39]
  v_mfma_f32_16x16x32_bf16 v[40:43], a[176:179], a[72:75], v[40:43]
  ds_read_b64_tr_b16 a[164:165], v148 offset:40960
  v_mfma_f32_16x16x32_bf16 v[40:43], a[180:183], a[88:91], v[40:43]
  buffer_load_dwordx4 v239, s[20:23], s31 offen offset:1024 lds
  v_mfma_f32_16x16x32_bf16 v[44:47], a[180:183], a[92:95], v[44:47]
  ds_read_b64_tr_b16 a[166:167], v148 offset:41984
  v_mfma_f32_16x16x32_bf16 v[44:47], a[176:179], a[76:79], v[44:47]
  s_waitcnt lgkmcnt(4)
  v_mfma_f32_16x16x32_bf16 v[48:51], a[184:187], a[64:67], v[48:51]
  ds_read_b64_tr_b16 a[168:169], v149 offset:32768
  v_mfma_f32_16x16x32_bf16 v[48:51], a[188:191], a[80:83], v[48:51]
  buffer_load_dwordx4 a[44:47], v242, s[24:27], s30 offen offset:3072 sc1
  v_mfma_f32_16x16x32_bf16 v[52:55], a[188:191], a[84:87], v[52:55]
  ds_read_b64_tr_b16 a[170:171], v149 offset:33792
  v_mfma_f32_16x16x32_bf16 v[52:55], a[184:187], a[68:71], v[52:55]
  v_mfma_f32_16x16x32_bf16 v[56:59], a[184:187], a[72:75], v[56:59]
  ds_read_b64_tr_b16 a[172:173], v149 offset:40960
  v_mfma_f32_16x16x32_bf16 v[56:59], a[188:191], a[88:91], v[56:59]
  v_mfma_f32_16x16x32_bf16 v[60:63], a[188:191], a[92:95], v[60:63]
  ds_read_b64_tr_b16 a[174:175], v149 offset:41984
  v_mfma_f32_16x16x32_bf16 v[60:63], a[184:187], a[76:79], v[60:63]
  s_waitcnt lgkmcnt(4)
  v_mfma_f32_16x16x32_bf16 v[64:67], a[160:163], a[64:67], v[64:67]
  ds_read_b64_tr_b16 a[176:177], v150 offset:32768
  v_mfma_f32_16x16x32_bf16 v[64:67], a[164:167], a[80:83], v[64:67]
  buffer_load_dwordx4 a[48:51], v243, s[24:27], s30 offen offset:0 sc1
  v_mfma_f32_16x16x32_bf16 v[68:71], a[164:167], a[84:87], v[68:71]
  ds_read_b64_tr_b16 a[178:179], v150 offset:33792
  v_mfma_f32_16x16x32_bf16 v[68:71], a[160:163], a[68:71], v[68:71]
  v_mfma_f32_16x16x32_bf16 v[72:75], a[160:163], a[72:75], v[72:75]
  ds_read_b64_tr_b16 a[180:181], v150 offset:40960
  v_mfma_f32_16x16x32_bf16 v[72:75], a[164:167], a[88:91], v[72:75]
  buffer_load_dwordx4 v240, s[20:23], s31 offen offset:2048 lds
  v_mfma_f32_16x16x32_bf16 v[76:79], a[164:167], a[92:95], v[76:79]
  ds_read_b64_tr_b16 a[182:183], v150 offset:41984
  v_mfma_f32_16x16x32_bf16 v[76:79], a[160:163], a[76:79], v[76:79]
  s_waitcnt lgkmcnt(4)
  v_mfma_f32_16x16x32_bf16 v[80:83], a[168:171], a[64:67], v[80:83]
  ds_read_b64_tr_b16 a[184:185], v151 offset:32768
  v_mfma_f32_16x16x32_bf16 v[80:83], a[172:175], a[80:83], v[80:83]
  buffer_load_dwordx4 a[52:55], v243, s[24:27], s30 offen offset:1024 sc1
  v_mfma_f32_16x16x32_bf16 v[84:87], a[172:175], a[84:87], v[84:87]
  ds_read_b64_tr_b16 a[186:187], v151 offset:33792
  v_mfma_f32_16x16x32_bf16 v[84:87], a[168:171], a[68:71], v[84:87]
  v_mfma_f32_16x16x32_bf16 v[88:91], a[168:171], a[72:75], v[88:91]
  ds_read_b64_tr_b16 a[188:189], v151 offset:40960
  v_mfma_f32_16x16x32_bf16 v[88:91], a[172:175], a[88:91], v[88:91]
  s_barrier
  v_mfma_f32_16x16x32_bf16 v[92:95], a[172:175], a[92:95], v[92:95]
  ds_read_b64_tr_b16 a[190:191], v151 offset:41984
  v_mfma_f32_16x16x32_bf16 v[92:95], a[168:171], a[76:79], v[92:95]
  s_waitcnt lgkmcnt(4)
  v_mfma_f32_16x16x32_bf16 v[96:99], a[176:179], a[64:67], v[96:99]
  ds_read_b64_tr_b16 a[160:161], v144 offset:49152
  v_mfma_f32_16x16x32_bf16 v[96:99], a[180:183], a[80:83], v[96:99]
  buffer_load_dwordx4 a[56:59], v243, s[24:27], s30 offen offset:2048 sc1
  v_mfma_f32_16x16x32_bf16 v[100:103], a[180:183], a[84:87], v[100:103]
  ds_read_b64_tr_b16 a[162:163], v144 offset:50176
  v_mfma_f32_16x16x32_bf16 v[100:103], a[176:179], a[68:71], v[100:103]
  v_mfma_f32_16x16x32_bf16 v[104:107], a[176:179], a[72:75], v[104:107]
  ds_read_b64_tr_b16 a[164:165], v144 offset:57344
  v_mfma_f32_16x16x32_bf16 v[104:107], a[180:183], a[88:91], v[104:107]
  buffer_load_dwordx4 v241, s[20:23], s31 offen offset:3072 lds
  s_add_u32 s31, s31, 0x80000
  v_mfma_f32_16x16x32_bf16 v[108:111], a[180:183], a[92:95], v[108:111]
  ds_read_b64_tr_b16 a[166:167], v144 offset:58368
  v_mfma_f32_16x16x32_bf16 v[108:111], a[176:179], a[76:79], v[108:111]
  s_waitcnt lgkmcnt(4)
  v_mfma_f32_16x16x32_bf16 v[112:115], a[184:187], a[64:67], v[112:115]
  ds_read_b64_tr_b16 a[168:169], v145 offset:49152
  v_mfma_f32_16x16x32_bf16 v[112:115], a[188:191], a[80:83], v[112:115]
  buffer_load_dwordx4 a[60:63], v243, s[24:27], s30 offen offset:3072 sc1
  s_add_u32 s30, s30, 8192
  v_mfma_f32_16x16x32_bf16 v[116:119], a[188:191], a[84:87], v[116:119]
  ds_read_b64_tr_b16 a[170:171], v145 offset:50176
  v_mfma_f32_16x16x32_bf16 v[116:119], a[184:187], a[68:71], v[116:119]
  v_mfma_f32_16x16x32_bf16 v[120:123], a[184:187], a[72:75], v[120:123]
  ds_read_b64_tr_b16 a[172:173], v145 offset:57344
  v_mfma_f32_16x16x32_bf16 v[120:123], a[188:191], a[88:91], v[120:123]
  v_mfma_f32_16x16x32_bf16 v[124:127], a[188:191], a[92:95], v[124:127]
  ds_read_b64_tr_b16 a[174:175], v145 offset:58368
  v_mfma_f32_16x16x32_bf16 v[124:127], a[184:187], a[76:79], v[124:127]
  s_waitcnt vmcnt(27) lgkmcnt(4)
  v_mfma_f32_16x16x32_bf16 v[0:3], a[160:163], a[96:99], v[0:3]
  ds_read_b64_tr_b16 a[176:177], v146 offset:49152
  v_mfma_f32_16x16x32_bf16 v[0:3], a[164:167], a[112:115], v[0:3]
  buffer_load_dwordx4 a[64:67], v242, s[24:27], s30 offen offset:0 sc1
  v_mfma_f32_16x16x32_bf16 v[4:7], a[164:167], a[116:119], v[4:7]
  ds_read_b64_tr_b16 a[178:179], v146 offset:50176
  v_mfma_f32_16x16x32_bf16 v[4:7], a[160:163], a[100:103], v[4:7]
  v_mfma_f32_16x16x32_bf16 v[8:11], a[160:163], a[104:107], v[8:11]
  ds_read_b64_tr_b16 a[180:181], v146 offset:57344
  s_add_u32 m0, s28, 65536
  v_mfma_f32_16x16x32_bf16 v[8:11], a[164:167], a[120:123], v[8:11]
  buffer_load_dwordx4 v238, s[20:23], s31 offen offset:0 lds
  v_mfma_f32_16x16x32_bf16 v[12:15], a[164:167], a[124:127], v[12:15]
  ds_read_b64_tr_b16 a[182:183], v146 offset:58368
  v_mfma_f32_16x16x32_bf16 v[12:15], a[160:163], a[108:111], v[12:15]
  s_waitcnt lgkmcnt(4)
  v_mfma_f32_16x16x32_bf16 v[16:19], a[168:171], a[96:99], v[16:19]
  ds_read_b64_tr_b16 a[184:185], v147 offset:49152
  v_mfma_f32_16x16x32_bf16 v[16:19], a[172:175], a[112:115], v[16:19]
  buffer_load_dwordx4 a[68:71], v242, s[24:27], s30 offen offset:1024 sc1
  v_mfma_f32_16x16x32_bf16 v[20:23], a[172:175], a[116:119], v[20:23]
  ds_read_b64_tr_b16 a[186:187], v147 offset:50176
  v_mfma_f32_16x16x32_bf16 v[20:23], a[168:171], a[100:103], v[20:23]
  v_mfma_f32_16x16x32_bf16 v[24:27], a[168:171], a[104:107], v[24:27]
  ds_read_b64_tr_b16 a[188:189], v147 offset:57344
  v_mfma_f32_16x16x32_bf16 v[24:27], a[172:175], a[120:123], v[24:27]
  v_mfma_f32_16x16x32_bf16 v[28:31], a[172:175], a[124:127], v[28:31]
  ds_read_b64_tr_b16 a[190:191], v147 offset:58368
  v_mfma_f32_16x16x32_bf16 v[28:31], a[168:171], a[108:111], v[28:31]
  s_waitcnt lgkmcnt(4)
  v_mfma_f32_16x16x32_bf16 v[32:35], a[176:179], a[96:99], v[32:35]
  ds_read_b64_tr_b16 a[160:161], v148 offset:49152
  v_mfma_f32_16x16x32_bf16 v[32:35], a[180:183], a[112:115], v[32:35]
  buffer_load_dwordx4 a[72:75], v242, s[24:27], s30 offen offset:2048 sc1
  v_mfma_f32_16x16x32_bf16 v[36:39], a[180:183], a[116:119], v[36:39]
  ds_read_b64_tr_b16 a[162:163], v148 offset:50176
  v_mfma_f32_16x16x32_bf16 v[36:39], a[176:179], a[100:103], v[36:39]
  v_mfma_f32_16x16x32_bf16 v[40:43], a[176:179], a[104:107], v[40:43]
  ds_read_b64_tr_b16 a[164:165], v148 offset:57344
  v_mfma_f32_16x16x32_bf16 v[40:43], a[180:183], a[120:123], v[40:43]
  buffer_load_dwordx4 v239, s[20:23], s31 offen offset:1024 lds
  v_mfma_f32_16x16x32_bf16 v[44:47], a[180:183], a[124:127], v[44:47]
  ds_read_b64_tr_b16 a[166:167], v148 offset:58368
  v_mfma_f32_16x16x32_bf16 v[44:47], a[176:179], a[108:111], v[44:47]
  s_waitcnt lgkmcnt(4)
  v_mfma_f32_16x16x32_bf16 v[48:51], a[184:187], a[96:99], v[48:51]
  ds_read_b64_tr_b16 a[168:169], v149 offset:49152
  v_mfma_f32_16x16x32_bf16 v[48:51], a[188:191], a[112:115], v[48:51]
  buffer_load_dwordx4 a[76:79], v242, s[24:27], s30 offen offset:3072 sc1
  v_mfma_f32_16x16x32_bf16 v[52:55], a[188:191], a[116:119], v[52:55]
  ds_read_b64_tr_b16 a[170:171], v149 offset:50176
  v_mfma_f32_16x16x32_bf16 v[52:55], a[184:187], a[100:103], v[52:55]
  v_mfma_f32_16x16x32_bf16 v[56:59], a[184:187], a[104:107], v[56:59]
  ds_read_b64_tr_b16 a[172:173], v149 offset:57344
  v_mfma_f32_16x16x32_bf16 v[56:59], a[188:191], a[120:123], v[56:59]
  v_mfma_f32_16x16x32_bf16 v[60:63], a[188:191], a[124:127], v[60:63]
  ds_read_b64_tr_b16 a[174:175], v149 offset:58368
  v_mfma_f32_16x16x32_bf16 v[60:63], a[184:187], a[108:111], v[60:63]
  s_waitcnt lgkmcnt(4)
  v_mfma_f32_16x16x32_bf16 v[64:67], a[160:163], a[96:99], v[64:67]
  ds_read_b64_tr_b16 a[176:177], v150 offset:49152
  v_mfma_f32_16x16x32_bf16 v[64:67], a[164:167], a[112:115], v[64:67]
  buffer_load_dwordx4 a[80:83], v243, s[24:27], s30 offen offset:0 sc1
  v_mfma_f32_16x16x32_bf16 v[68:71], a[164:167], a[116:119], v[68:71]
  ds_read_b64_tr_b16 a[178:179], v150 offset:50176
  v_mfma_f32_16x16x32_bf16 v[68:71], a[160:163], a[100:103], v[68:71]
  v_mfma_f32_16x16x32_bf16 v[72:75], a[160:163], a[104:107], v[72:75]
  ds_read_b64_tr_b16 a[180:181], v150 offset:57344
  v_mfma_f32_16x16x32_bf16 v[72:75], a[164:167], a[120:123], v[72:75]
  buffer_load_dwordx4 v240, s[20:23], s31 offen offset:2048 lds
  v_mfma_f32_16x16x32_bf16 v[76:79], a[164:167], a[124:127], v[76:79]
  ds_read_b64_tr_b16 a[182:183], v150 offset:58368
  v_mfma_f32_16x16x32_bf16 v[76:79], a[160:163], a[108:111], v[76:79]
  s_waitcnt lgkmcnt(4)
  v_mfma_f32_16x16x32_bf16 v[80:83], a[168:171], a[96:99], v[80:83]
  ds_read_b64_tr_b16 a[184:185], v151 offset:49152
  v_mfma_f32_16x16x32_bf16 v[80:83], a[172:175], a[112:115], v[80:83]
  buffer_load_dwordx4 a[84:87], v243, s[24:27], s30 offen offset:1024 sc1
  v_mfma_f32_16x16x32_bf16 v[84:87], a[172:175], a[116:119], v[84:87]
  ds_read_b64_tr_b16 a[186:187], v151 offset:50176
  v_mfma_f32_16x16x32_bf16 v[84:87], a[168:171], a[100:103], v[84:87]
  s_waitcnt vmcnt(25)
  v_mfma_f32_16x16x32_bf16 v[88:91], a[168:171], a[104:107], v[88:91]
  ds_read_b64_tr_b16 a[188:189], v151 offset:57344
  v_mfma_f32_16x16x32_bf16 v[88:91], a[172:175], a[120:123], v[88:91]
  s_barrier
  v_mfma_f32_16x16x32_bf16 v[92:95], a[172:175], a[124:127], v[92:95]
  ds_read_b64_tr_b16 a[190:191], v151 offset:58368
  v_mfma_f32_16x16x32_bf16 v[92:95], a[168:171], a[108:111], v[92:95]
  s_waitcnt lgkmcnt(4)
  v_mfma_f32_16x16x32_bf16 v[96:99], a[176:179], a[96:99], v[96:99]
  ds_read_b64_tr_b16 a[160:161], v144 offset:16384
  v_mfma_f32_16x16x32_bf16 v[96:99], a[180:183], a[112:115], v[96:99]
  buffer_load_dwordx4 a[88:91], v243, s[24:27], s30 offen offset:2048 sc1
  v_mfma_f32_16x16x32_bf16 v[100:103], a[180:183], a[116:119], v[100:103]
  ds_read_b64_tr_b16 a[162:163], v144 offset:17408
  v_mfma_f32_16x16x32_bf16 v[100:103], a[176:179], a[100:103], v[100:103]
  v_mfma_f32_16x16x32_bf16 v[104:107], a[176:179], a[104:107], v[104:107]
  ds_read_b64_tr_b16 a[164:165], v144 offset:24576
  v_mfma_f32_16x16x32_bf16 v[104:107], a[180:183], a[120:123], v[104:107]
  buffer_load_dwordx4 v241, s[20:23], s31 offen offset:3072 lds
  s_add_u32 s31, s31, 0x80000
  v_mfma_f32_16x16x32_bf16 v[108:111], a[180:183], a[124:127], v[108:111]
  ds_read_b64_tr_b16 a[166:167], v144 offset:25600
  v_mfma_f32_16x16x32_bf16 v[108:111], a[176:179], a[108:111], v[108:111]
  s_waitcnt lgkmcnt(4)
  v_mfma_f32_16x16x32_bf16 v[112:115], a[184:187], a[96:99], v[112:115]
  ds_read_b64_tr_b16 a[168:169], v145 offset:16384
  v_mfma_f32_16x16x32_bf16 v[112:115], a[188:191], a[112:115], v[112:115]
  buffer_load_dwordx4 a[92:95], v243, s[24:27], s30 offen offset:3072 sc1
  s_add_u32 s30, s30, 8192
  v_mfma_f32_16x16x32_bf16 v[116:119], a[188:191], a[116:119], v[116:119]
  ds_read_b64_tr_b16 a[170:171], v145 offset:17408
  v_mfma_f32_16x16x32_bf16 v[116:119], a[184:187], a[100:103], v[116:119]
  v_mfma_f32_16x16x32_bf16 v[120:123], a[184:187], a[104:107], v[120:123]
  ds_read_b64_tr_b16 a[172:173], v145 offset:24576
  v_mfma_f32_16x16x32_bf16 v[120:123], a[188:191], a[120:123], v[120:123]
  v_mfma_f32_16x16x32_bf16 v[124:127], a[188:191], a[124:127], v[124:127]
  ds_read_b64_tr_b16 a[174:175], v145 offset:25600
  v_mfma_f32_16x16x32_bf16 v[124:127], a[184:187], a[108:111], v[124:127]
  s_waitcnt vmcnt(27) lgkmcnt(4)
  v_mfma_f32_16x16x32_bf16 v[0:3], a[160:163], a[0:3], v[0:3]
  ds_read_b64_tr_b16 a[176:177], v146 offset:16384
  s_waitcnt vmcnt(25)
  s_mov_b32 s51, -1
  v_sub_u32 v137, s51, v128
  v_mfma_f32_16x16x32_bf16 v[0:3], a[164:167], a[16:19], v[0:3]
  buffer_load_dwordx4 a[96:99], v242, s[24:27], s30 offen offset:0 sc1
  v_mfma_f32_16x16x32_bf16 v[4:7], a[164:167], a[20:23], v[4:7]
  ds_read_b64_tr_b16 a[178:179], v146 offset:17408
  v_sub_u32 v138, s51, v129
  v_mfma_f32_16x16x32_bf16 v[4:7], a[160:163], a[4:7], v[4:7]
  v_min_u32 v136, v137, v138
  v_sub_u32 v139, s51, v130
  v_mfma_f32_16x16x32_bf16 v[8:11], a[160:163], a[8:11], v[8:11]
  ds_read_b64_tr_b16 a[180:181], v146 offset:24576
  s_add_u32 m0, s28, 81920
  v_sub_u32 v140, s51, v131
  v_mfma_f32_16x16x32_bf16 v[8:11], a[164:167], a[24:27], v[8:11]
  buffer_load_dwordx4 v238, s[20:23], s31 offen offset:0 lds
  v_mfma_f32_16x16x32_bf16 v[12:15], a[164:167], a[28:31], v[12:15]
  ds_read_b64_tr_b16 a[182:183], v146 offset:25600
  v_min3_u32 v136, v136, v139, v140
  v_mfma_f32_16x16x32_bf16 v[12:15], a[160:163], a[12:15], v[12:15]
  s_waitcnt lgkmcnt(4)
  v_sub_u32 v137, s51, v132
  v_sub_u32 v138, s51, v133
  v_mfma_f32_16x16x32_bf16 v[16:19], a[168:171], a[0:3], v[16:19]
  ds_read_b64_tr_b16 a[184:185], v147 offset:16384
  v_min3_u32 v136, v136, v137, v138
  v_mfma_f32_16x16x32_bf16 v[16:19], a[172:175], a[16:19], v[16:19]
  buffer_load_dwordx4 a[100:103], v242, s[24:27], s30 offen offset:1024 sc1
  v_mfma_f32_16x16x32_bf16 v[20:23], a[172:175], a[20:23], v[20:23]
  ds_read_b64_tr_b16 a[186:187], v147 offset:17408
  v_sub_u32 v139, s51, v134
  v_mfma_f32_16x16x32_bf16 v[20:23], a[168:171], a[4:7], v[20:23]
  v_sub_u32 v140, s51, v135
  v_min3_u32 v136, v136, v139, v140
  v_mfma_f32_16x16x32_bf16 v[24:27], a[168:171], a[8:11], v[24:27]
  ds_read_b64_tr_b16 a[188:189], v147 offset:24576
  v_min_u32_dpp v136, v136, v136 row_ror:8 row_mask:0xf bank_mask:0xf
  v_mfma_f32_16x16x32_bf16 v[24:27], a[172:175], a[24:27], v[24:27]
  v_mfma_f32_16x16x32_bf16 v[28:31], a[172:175], a[28:31], v[28:31]
  ds_read_b64_tr_b16 a[190:191], v147 offset:25600
  v_min_u32_dpp v136, v136, v136 row_ror:4 row_mask:0xf bank_mask:0xf
  v_mfma_f32_16x16x32_bf16 v[28:31], a[168:171], a[12:15], v[28:31]
  s_waitcnt lgkmcnt(4)
  v_min_u32_dpp v136, v136, v136 row_ror:2 row_mask:0xf bank_mask:0xf
  v_mfma_f32_16x16x32_bf16 v[32:35], a[176:179], a[0:3], v[32:35]
  ds_read_b64_tr_b16 a[160:161], v148 offset:16384
  v_min_u32_dpp v136, v136, v136 row_ror:1 row_mask:0xf bank_mask:0xf
  v_mfma_f32_16x16x32_bf16 v[32:35], a[180:183], a[16:19], v[32:35]
  buffer_load_dwordx4 a[104:107], v242, s[24:27], s30 offen offset:2048 sc1
  v_mfma_f32_16x16x32_bf16 v[36:39], a[180:183], a[20:23], v[36:39]
  ds_read_b64_tr_b16 a[162:163], v148 offset:17408
  v_readlane_b32 s98, v136, 0
  v_mfma_f32_16x16x32_bf16 v[36:39], a[176:179], a[4:7], v[36:39]
  v_readlane_b32 s99, v136, 16
  v_readlane_b32 s100, v136, 32
  v_mfma_f32_16x16x32_bf16 v[40:43], a[176:179], a[8:11], v[40:43]
  ds_read_b64_tr_b16 a[164:165], v148 offset:24576
  v_readlane_b32 s101, v136, 48
  v_mfma_f32_16x16x32_bf16 v[40:43], a[180:183], a[24:27], v[40:43]
  buffer_load_dwordx4 v239, s[20:23], s31 offen offset:1024 lds
  s_min_u32 s98, s98, s99
  s_min_u32 s100, s100, s101
  v_mfma_f32_16x16x32_bf16 v[44:47], a[180:183], a[28:31], v[44:47]
  ds_read_b64_tr_b16 a[166:167], v148 offset:25600
  s_min_u32 s98, s98, s100
  s_sub_u32 s52, s51, s98
  v_mfma_f32_16x16x32_bf16 v[44:47], a[176:179], a[12:15], v[44:47]
  s_waitcnt lgkmcnt(4)
  s_sub_u32 s51, s52, 1
  v_sub_u32 v137, s51, v128
  v_sub_u32 v138, s51, v129
  v_mfma_f32_16x16x32_bf16 v[48:51], a[184:187], a[0:3], v[48:51]
  ds_read_b64_tr_b16 a[168:169], v149 offset:16384
  v_min_u32 v136, v137, v138
  v_mfma_f32_16x16x32_bf16 v[48:51], a[188:191], a[16:19], v[48:51]
  buffer_load_dwordx4 a[108:111], v242, s[24:27], s30 offen offset:3072 sc1
  v_mfma_f32_16x16x32_bf16 v[52:55], a[188:191], a[20:23], v[52:55]
  ds_read_b64_tr_b16 a[170:171], v149 offset:17408
  v_sub_u32 v139, s51, v130
  v_mfma_f32_16x16x32_bf16 v[52:55], a[184:187], a[4:7], v[52:55]
  v_sub_u32 v140, s51, v131
  v_min3_u32 v136, v136, v139, v140
  v_mfma_f32_16x16x32_bf16 v[56:59], a[184:187], a[8:11], v[56:59]
  ds_read_b64_tr_b16 a[172:173], v149 offset:24576
  v_sub_u32 v137, s51, v132
  v_mfma_f32_16x16x32_bf16 v[56:59], a[188:191], a[24:27], v[56:59]
  v_sub_u32 v138, s51, v133
  v_min3_u32 v136, v136, v137, v138
  v_mfma_f32_16x16x32_bf16 v[60:63], a[188:191], a[28:31], v[60:63]
  ds_read_b64_tr_b16 a[174:175], v149 offset:25600
  v_sub_u32 v139, s51, v134
  v_mfma_f32_16x16x32_bf16 v[60:63], a[184:187], a[12:15], v[60:63]
  s_waitcnt lgkmcnt(4)
  v_sub_u32 v140, s51, v135
  v_min3_u32 v136, v136, v139, v140
  v_mfma_f32_16x16x32_bf16 v[64:67], a[160:163], a[0:3], v[64:67]
  ds_read_b64_tr_b16 a[176:177], v150 offset:16384
  v_min_u32_dpp v136, v136, v136 row_ror:8 row_mask:0xf bank_mask:0xf
  v_mfma_f32_16x16x32_bf16 v[64:67], a[164:167], a[16:19], v[64:67]
  buffer_load_dwordx4 a[112:115], v243, s[24:27], s30 offen offset:0 sc1
  v_mfma_f32_16x16x32_bf16 v[68:71], a[164:167], a[20:23], v[68:71]
  ds_read_b64_tr_b16 a[178:179], v150 offset:17408
  v_min_u32_dpp v136, v136, v136 row_ror:4 row_mask:0xf bank_mask:0xf
  v_mfma_f32_16x16x32_bf16 v[68:71], a[160:163], a[4:7], v[68:71]
  v_mfma_f32_16x16x32_bf16 v[72:75], a[160:163], a[8:11], v[72:75]
  ds_read_b64_tr_b16 a[180:181], v150 offset:24576
  v_min_u32_dpp v136, v136, v136 row_ror:2 row_mask:0xf bank_mask:0xf
  v_mfma_f32_16x16x32_bf16 v[72:75], a[164:167], a[24:27], v[72:75]
  buffer_load_dwordx4 v240, s[20:23], s31 offen offset:2048 lds
  v_mfma_f32_16x16x32_bf16 v[76:79], a[164:167], a[28:31], v[76:79]
  ds_read_b64_tr_b16 a[182:183], v150 offset:25600
  v_min_u32_dpp v136, v136, v136 row_ror:1 row_mask:0xf bank_mask:0xf
  v_mfma_f32_16x16x32_bf16 v[76:79], a[160:163], a[12:15], v[76:79]
  s_waitcnt lgkmcnt(4)
  v_readlane_b32 s98, v136, 0
  v_readlane_b32 s99, v136, 16
  v_mfma_f32_16x16x32_bf16 v[80:83], a[168:171], a[0:3], v[80:83]
  ds_read_b64_tr_b16 a[184:185], v151 offset:16384
  v_readlane_b32 s100, v136, 32
  v_mfma_f32_16x16x32_bf16 v[80:83], a[172:175], a[16:19], v[80:83]
  buffer_load_dwordx4 a[116:119], v243, s[24:27], s30 offen offset:1024 sc1
  v_mfma_f32_16x16x32_bf16 v[84:87], a[172:175], a[20:23], v[84:87]
  ds_read_b64_tr_b16 a[186:187], v151 offset:17408
  v_readlane_b32 s101, v136, 48
  v_mfma_f32_16x16x32_bf16 v[84:87], a[168:171], a[4:7], v[84:87]
  s_waitcnt vmcnt(22)
  s_min_u32 s98, s98, s99
  v_mfma_f32_16x16x32_bf16 v[88:91], a[168:171], a[8:11], v[88:91]
  ds_read_b64_tr_b16 a[188:189], v151 offset:24576
  s_min_u32 s100, s100, s101
  s_min_u32 s98, s98, s100
  v_mfma_f32_16x16x32_bf16 v[88:91], a[172:175], a[24:27], v[88:91]
  s_barrier
  s_sub_u32 s53, s51, s98
  v_mfma_f32_16x16x32_bf16 v[92:95], a[172:175], a[28:31], v[92:95]
  ds_read_b64_tr_b16 a[190:191], v151 offset:25600
  s_sub_u32 s51, s53, 1
  v_sub_u32 v137, s51, v128
  v_mfma_f32_16x16x32_bf16 v[92:95], a[168:171], a[12:15], v[92:95]
  s_waitcnt lgkmcnt(4)
  v_sub_u32 v138, s51, v129
  v_min_u32 v136, v137, v138
  v_mfma_f32_16x16x32_bf16 v[96:99], a[176:179], a[0:3], v[96:99]
  ds_read_b64_tr_b16 a[160:161], v144 offset:0
  v_sub_u32 v139, s51, v130
  v_mfma_f32_16x16x32_bf16 v[96:99], a[180:183], a[16:19], v[96:99]
  buffer_load_dwordx4 a[120:123], v243, s[24:27], s30 offen offset:2048 sc1
  v_mfma_f32_16x16x32_bf16 v[100:103], a[180:183], a[20:23], v[100:103]
  ds_read_b64_tr_b16 a[162:163], v144 offset:1024
  v_sub_u32 v140, s51, v131
  v_mfma_f32_16x16x32_bf16 v[100:103], a[176:179], a[4:7], v[100:103]
  v_min3_u32 v136, v136, v139, v140
  v_sub_u32 v137, s51, v132
  v_mfma_f32_16x16x32_bf16 v[104:107], a[176:179], a[8:11], v[104:107]
  ds_read_b64_tr_b16 a[164:165], v144 offset:8192
  v_sub_u32 v138, s51, v133
  v_mfma_f32_16x16x32_bf16 v[104:107], a[180:183], a[24:27], v[104:107]
  buffer_load_dwordx4 v241, s[20:23], s31 offen offset:3072 lds
  s_add_u32 s31, s31, 0x80000
  v_mfma_f32_16x16x32_bf16 v[108:111], a[180:183], a[28:31], v[108:111]
  ds_read_b64_tr_b16 a[166:167], v144 offset:9216
  v_min3_u32 v136, v136, v137, v138
  v_mfma_f32_16x16x32_bf16 v[108:111], a[176:179], a[12:15], v[108:111]
  s_waitcnt lgkmcnt(4)
  v_sub_u32 v139, s51, v134
  v_sub_u32 v140, s51, v135
  v_mfma_f32_16x16x32_bf16 v[112:115], a[184:187], a[0:3], v[112:115]
  ds_read_b64_tr_b16 a[168:169], v145 offset:0
  v_min3_u32 v136, v136, v139, v140
  v_mfma_f32_16x16x32_bf16 v[112:115], a[188:191], a[16:19], v[112:115]
  buffer_load_dwordx4 a[124:127], v243, s[24:27], s30 offen offset:3072 sc1
  s_add_u32 s30, s30, 8192
  v_mfma_f32_16x16x32_bf16 v[116:119], a[188:191], a[20:23], v[116:119]
  ds_read_b64_tr_b16 a[170:171], v145 offset:1024
  v_min_u32_dpp v136, v136, v136 row_ror:8 row_mask:0xf bank_mask:0xf
  v_mfma_f32_16x16x32_bf16 v[116:119], a[184:187], a[4:7], v[116:119]
  v_mfma_f32_16x16x32_bf16 v[120:123], a[184:187], a[8:11], v[120:123]
  ds_read_b64_tr_b16 a[172:173], v145 offset:8192
  v_min_u32_dpp v136, v136, v136 row_ror:4 row_mask:0xf bank_mask:0xf
  v_mfma_f32_16x16x32_bf16 v[120:123], a[188:191], a[24:27], v[120:123]
  v_mfma_f32_16x16x32_bf16 v[124:127], a[188:191], a[28:31], v[124:127]
  ds_read_b64_tr_b16 a[174:175], v145 offset:9216
  v_min_u32_dpp v136, v136, v136 row_ror:2 row_mask:0xf bank_mask:0xf
  v_mfma_f32_16x16x32_bf16 v[124:127], a[184:187], a[12:15], v[124:127]
  s_waitcnt vmcnt(24) lgkmcnt(4)
  v_min_u32_dpp v136, v136, v136 row_ror:1 row_mask:0xf bank_mask:0xf
  v_mfma_f32_16x16x32_bf16 v[0:3], a[160:163], a[32:35], v[0:3]
  ds_read_b64_tr_b16 a[176:177], v146 offset:0
  v_readlane_b32 s98, v136, 0
  v_mfma_f32_16x16x32_bf16 v[0:3], a[164:167], a[48:51], v[0:3]
  buffer_load_dwordx4 a[0:3], v242, s[24:27], s30 offen offset:0 sc1
  v_mfma_f32_16x16x32_bf16 v[4:7], a[164:167], a[52:55], v[4:7]
  ds_read_b64_tr_b16 a[178:179], v146 offset:1024
  v_readlane_b32 s99, v136, 16
  v_mfma_f32_16x16x32_bf16 v[4:7], a[160:163], a[36:39], v[4:7]
  v_readlane_b32 s100, v136, 32
  v_readlane_b32 s101, v136, 48
  v_mfma_f32_16x16x32_bf16 v[8:11], a[160:163], a[40:43], v[8:11]
  ds_read_b64_tr_b16 a[180:181], v146 offset:8192
  s_add_u32 m0, s28, 98304
  s_min_u32 s98, s98, s99
  v_mfma_f32_16x16x32_bf16 v[8:11], a[164:167], a[56:59], v[8:11]
  buffer_load_dwordx4 v238, s[20:23], s31 offen offset:0 lds
  s_min_u32 s100, s100, s101
  s_min_u32 s98, s98, s100
  v_mfma_f32_16x16x32_bf16 v[12:15], a[164:167], a[60:63], v[12:15]
  ds_read_b64_tr_b16 a[182:183], v146 offset:9216
  s_sub_u32 s54, s51, s98
  s_sub_u32 s51, s54, 1
  v_sub_u32 v137, s51, v128
  v_mfma_f32_16x16x32_bf16 v[12:15], a[160:163], a[44:47], v[12:15]
  s_waitcnt lgkmcnt(4)
  v_sub_u32 v138, s51, v129
  v_min_u32 v136, v137, v138
  v_mfma_f32_16x16x32_bf16 v[16:19], a[168:171], a[32:35], v[16:19]
  ds_read_b64_tr_b16 a[184:185], v147 offset:0
  v_sub_u32 v139, s51, v130
  v_mfma_f32_16x16x32_bf16 v[16:19], a[172:175], a[48:51], v[16:19]
  buffer_load_dwordx4 a[4:7], v242, s[24:27], s30 offen offset:1024 sc1
  v_mfma_f32_16x16x32_bf16 v[20:23], a[172:175], a[52:55], v[20:23]
  ds_read_b64_tr_b16 a[186:187], v147 offset:1024
  v_sub_u32 v140, s51, v131
  v_mfma_f32_16x16x32_bf16 v[20:23], a[168:171], a[36:39], v[20:23]
  v_min3_u32 v136, v136, v139, v140
  v_sub_u32 v137, s51, v132
  v_mfma_f32_16x16x32_bf16 v[24:27], a[168:171], a[40:43], v[24:27]
  ds_read_b64_tr_b16 a[188:189], v147 offset:8192
  v_sub_u32 v138, s51, v133
  v_mfma_f32_16x16x32_bf16 v[24:27], a[172:175], a[56:59], v[24:27]
  v_min3_u32 v136, v136, v137, v138
  v_sub_u32 v139, s51, v134
  v_mfma_f32_16x16x32_bf16 v[28:31], a[172:175], a[60:63], v[28:31]
  ds_read_b64_tr_b16 a[190:191], v147 offset:9216
  v_sub_u32 v140, s51, v135
  v_mfma_f32_16x16x32_bf16 v[28:31], a[168:171], a[44:47], v[28:31]
  s_waitcnt lgkmcnt(4)
  v_min3_u32 v136, v136, v139, v140
  v_mfma_f32_16x16x32_bf16 v[32:35], a[176:179], a[32:35], v[32:35]
  ds_read_b64_tr_b16 a[160:161], v148 offset:0
  v_min_u32_dpp v136, v136, v136 row_ror:8 row_mask:0xf bank_mask:0xf
  v_mfma_f32_16x16x32_bf16 v[32:35], a[180:183], a[48:51], v[32:35]
  buffer_load_dwordx4 a[8:11], v242, s[24:27], s30 offen offset:2048 sc1
  v_mfma_f32_16x16x32_bf16 v[36:39], a[180:183], a[52:55], v[36:39]
  ds_read_b64_tr_b16 a[162:163], v148 offset:1024
  v_min_u32_dpp v136, v136, v136 row_ror:4 row_mask:0xf bank_mask:0xf
  v_mfma_f32_16x16x32_bf16 v[36:39], a[176:179], a[36:39], v[36:39]
  v_mfma_f32_16x16x32_bf16 v[40:43], a[176:179], a[40:43], v[40:43]
  ds_read_b64_tr_b16 a[164:165], v148 offset:8192
  v_min_u32_dpp v136, v136, v136 row_ror:2 row_mask:0xf bank_mask:0xf
  v_mfma_f32_16x16x32_bf16 v[40:43], a[180:183], a[56:59], v[40:43]
  buffer_load_dwordx4 v239, s[20:23], s31 offen offset:1024 lds
  v_mfma_f32_16x16x32_bf16 v[44:47], a[180:183], a[60:63], v[44:47]
  ds_read_b64_tr_b16 a[166:167], v148 offset:9216
  v_min_u32_dpp v136, v136, v136 row_ror:1 row_mask:0xf bank_mask:0xf
  v_mfma_f32_16x16x32_bf16 v[44:47], a[176:179], a[44:47], v[44:47]
  s_waitcnt lgkmcnt(4)
  v_readlane_b32 s98, v136, 0
  v_readlane_b32 s99, v136, 16
  v_mfma_f32_16x16x32_bf16 v[48:51], a[184:187], a[32:35], v[48:51]
  ds_read_b64_tr_b16 a[168:169], v149 offset:0
  v_readlane_b32 s100, v136, 32
  v_mfma_f32_16x16x32_bf16 v[48:51], a[188:191], a[48:51], v[48:51]
  buffer_load_dwordx4 a[12:15], v242, s[24:27], s30 offen offset:3072 sc1
  v_mfma_f32_16x16x32_bf16 v[52:55], a[188:191], a[52:55], v[52:55]
  ds_read_b64_tr_b16 a[170:171], v149 offset:1024
  v_readlane_b32 s101, v136, 48
  v_mfma_f32_16x16x32_bf16 v[52:55], a[184:187], a[36:39], v[52:55]
  s_min_u32 s98, s98, s99
  s_min_u32 s100, s100, s101
  v_mfma_f32_16x16x32_bf16 v[56:59], a[184:187], a[40:43], v[56:59]
  ds_read_b64_tr_b16 a[172:173], v149 offset:8192
  s_min_u32 s98, s98, s100
  s_sub_u32 s55, s51, s98
  v_mfma_f32_16x16x32_bf16 v[56:59], a[188:191], a[56:59], v[56:59]
  s_sub_u32 s51, s55, 1
  v_sub_u32 v137, s51, v128
  v_sub_u32 v138, s51, v129
  v_mfma_f32_16x16x32_bf16 v[60:63], a[188:191], a[60:63], v[60:63]
  ds_read_b64_tr_b16 a[174:175], v149 offset:9216
  v_min_u32 v136, v137, v138
  v_mfma_f32_16x16x32_bf16 v[60:63], a[184:187], a[44:47], v[60:63]
  s_waitcnt lgkmcnt(4)
  v_sub_u32 v139, s51, v130
  v_sub_u32 v140, s51, v131
  v_mfma_f32_16x16x32_bf16 v[64:67], a[160:163], a[32:35], v[64:67]
  ds_read_b64_tr_b16 a[176:177], v150 offset:0
  v_min3_u32 v136, v136, v139, v140
  v_mfma_f32_16x16x32_bf16 v[64:67], a[164:167], a[48:51], v[64:67]
  buffer_load_dwordx4 a[16:19], v243, s[24:27], s30 offen offset:0 sc1
  v_mfma_f32_16x16x32_bf16 v[68:71], a[164:167], a[52:55], v[68:71]
  ds_read_b64_tr_b16 a[178:179], v150 offset:1024
  v_sub_u32 v137, s51, v132
  v_mfma_f32_16x16x32_bf16 v[68:71], a[160:163], a[36:39], v[68:71]
  v_sub_u32 v138, s51, v133
  v_min3_u32 v136, v136, v137, v138
  v_mfma_f32_16x16x32_bf16 v[72:75], a[160:163], a[40:43], v[72:75]
  ds_read_b64_tr_b16 a[180:181], v150 offset:8192
  v_sub_u32 v139, s51, v134
  v_mfma_f32_16x16x32_bf16 v[72:75], a[164:167], a[56:59], v[72:75]
  buffer_load_dwordx4 v240, s[20:23], s31 offen offset:2048 lds
  v_mfma_f32_16x16x32_bf16 v[76:79], a[164:167], a[60:63], v[76:79]
  ds_read_b64_tr_b16 a[182:183], v150 offset:9216
  v_sub_u32 v140, s51, v135
  v_mfma_f32_16x16x32_bf16 v[76:79], a[160:163], a[44:47], v[76:79]
  s_waitcnt lgkmcnt(4)
  v_min3_u32 v136, v136, v139, v140
  v_mfma_f32_16x16x32_bf16 v[80:83], a[168:171], a[32:35], v[80:83]
  ds_read_b64_tr_b16 a[184:185], v151 offset:0
  v_min_u32_dpp v136, v136, v136 row_ror:8 row_mask:0xf bank_mask:0xf
  v_mfma_f32_16x16x32_bf16 v[80:83], a[172:175], a[48:51], v[80:83]
  buffer_load_dwordx4 a[20:23], v243, s[24:27], s30 offen offset:1024 sc1
  v_mfma_f32_16x16x32_bf16 v[84:87], a[172:175], a[52:55], v[84:87]
  ds_read_b64_tr_b16 a[186:187], v151 offset:1024
  v_min_u32_dpp v136, v136, v136 row_ror:4 row_mask:0xf bank_mask:0xf
  v_mfma_f32_16x16x32_bf16 v[84:87], a[168:171], a[36:39], v[84:87]
  s_waitcnt vmcnt(22)
  v_min_u32_dpp v136, v136, v136 row_ror:2 row_mask:0xf bank_mask:0xf
  v_mfma_f32_16x16x32_bf16 v[88:91], a[168:171], a[40:43], v[88:91]
  ds_read_b64_tr_b16 a[188:189], v151 offset:8192
  v_min_u32_dpp v136, v136, v136 row_ror:1 row_mask:0xf bank_mask:0xf
  v_mfma_f32_16x16x32_bf16 v[88:91], a[172:175], a[56:59], v[88:91]
  s_barrier
  v_readlane_b32 s98, v136, 0
  v_readlane_b32 s99, v136, 16
  v_mfma_f32_16x16x32_bf16 v[92:95], a[172:175], a[60:63], v[92:95]
  ds_read_b64_tr_b16 a[190:191], v151 offset:9216
  v_readlane_b32 s100, v136, 32
  v_mfma_f32_16x16x32_bf16 v[92:95], a[168:171], a[44:47], v[92:95]
  s_waitcnt lgkmcnt(4)
  v_readlane_b32 s101, v136, 48
  v_mfma_f32_16x16x32_bf16 v[96:99], a[176:179], a[32:35], v[96:99]
  ds_read_b64_tr_b16 a[160:161], v224 offset:0
  s_min_u32 s98, s98, s99
  s_min_u32 s100, s100, s101
  v_mfma_f32_16x16x32_bf16 v[96:99], a[180:183], a[48:51], v[96:99]
  buffer_load_dwordx4 a[24:27], v243, s[24:27], s30 offen offset:2048 sc1
  s_min_u32 s98, s98, s100
  s_sub_u32 s56, s51, s98
  v_mfma_f32_16x16x32_bf16 v[100:103], a[180:183], a[52:55], v[100:103]
  ds_read_b64_tr_b16 a[162:163], v224 offset:1024
  s_sub_u32 s51, s56, 1
  v_sub_u32 v137, s51, v128
  v_mfma_f32_16x16x32_bf16 v[100:103], a[176:179], a[36:39], v[100:103]
  v_sub_u32 v138, s51, v129
  v_min_u32 v136, v137, v138
  v_mfma_f32_16x16x32_bf16 v[104:107], a[176:179], a[40:43], v[104:107]
  ds_read_b64_tr_b16 a[164:165], v224 offset:8192
  v_sub_u32 v139, s51, v130
  v_mfma_f32_16x16x32_bf16 v[104:107], a[180:183], a[56:59], v[104:107]
  buffer_load_dwordx4 v241, s[20:23], s31 offen offset:3072 lds
  s_add_u32 s31, s31, 0x80000
  v_mfma_f32_16x16x32_bf16 v[108:111], a[180:183], a[60:63], v[108:111]
  ds_read_b64_tr_b16 a[166:167], v224 offset:9216
  v_sub_u32 v140, s51, v131
  v_mfma_f32_16x16x32_bf16 v[108:111], a[176:179], a[44:47], v[108:111]
  s_waitcnt lgkmcnt(4)
  v_min3_u32 v136, v136, v139, v140
  v_sub_u32 v137, s51, v132
  v_mfma_f32_16x16x32_bf16 v[112:115], a[184:187], a[32:35], v[112:115]
  ds_read_b64_tr_b16 a[168:169], v225 offset:0
  v_sub_u32 v138, s51, v133
  v_mfma_f32_16x16x32_bf16 v[112:115], a[188:191], a[48:51], v[112:115]
  buffer_load_dwordx4 a[28:31], v243, s[24:27], s30 offen offset:3072 sc1
  s_add_u32 s30, s30, 8192
  v_mfma_f32_16x16x32_bf16 v[116:119], a[188:191], a[52:55], v[116:119]
  ds_read_b64_tr_b16 a[170:171], v225 offset:1024
  v_min3_u32 v136, v136, v137, v138
  v_mfma_f32_16x16x32_bf16 v[116:119], a[184:187], a[36:39], v[116:119]
  v_sub_u32 v139, s51, v134
  v_sub_u32 v140, s51, v135
  v_mfma_f32_16x16x32_bf16 v[120:123], a[184:187], a[40:43], v[120:123]
  ds_read_b64_tr_b16 a[172:173], v225 offset:8192
  v_min3_u32 v136, v136, v139, v140
  v_mfma_f32_16x16x32_bf16 v[120:123], a[188:191], a[56:59], v[120:123]
  v_mfma_f32_16x16x32_bf16 v[124:127], a[188:191], a[60:63], v[124:127]
  ds_read_b64_tr_b16 a[174:175], v225 offset:9216
  v_min_u32_dpp v136, v136, v136 row_ror:8 row_mask:0xf bank_mask:0xf
  v_mfma_f32_16x16x32_bf16 v[124:127], a[184:187], a[44:47], v[124:127]
  s_waitcnt vmcnt(24) lgkmcnt(4)
  v_min_u32_dpp v136, v136, v136 row_ror:4 row_mask:0xf bank_mask:0xf
  v_mfma_f32_16x16x32_bf16 v[0:3], a[160:163], a[64:67], v[0:3]
  ds_read_b64_tr_b16 a[176:177], v226 offset:0
  v_min_u32_dpp v136, v136, v136 row_ror:2 row_mask:0xf bank_mask:0xf
  v_mfma_f32_16x16x32_bf16 v[0:3], a[164:167], a[80:83], v[0:3]
  buffer_load_dwordx4 a[32:35], v242, s[24:27], s30 offen offset:0 sc1
  v_mfma_f32_16x16x32_bf16 v[4:7], a[164:167], a[84:87], v[4:7]
  ds_read_b64_tr_b16 a[178:179], v226 offset:1024
  v_min_u32_dpp v136, v136, v136 row_ror:1 row_mask:0xf bank_mask:0xf
  v_mfma_f32_16x16x32_bf16 v[4:7], a[160:163], a[68:71], v[4:7]
  v_readlane_b32 s98, v136, 0
  v_readlane_b32 s99, v136, 16
  v_mfma_f32_16x16x32_bf16 v[8:11], a[160:163], a[72:75], v[8:11]
  ds_read_b64_tr_b16 a[180:181], v226 offset:8192
  s_add_u32 m0, s28, 114688
  v_readlane_b32 s100, v136, 32
  v_mfma_f32_16x16x32_bf16 v[8:11], a[164:167], a[88:91], v[8:11]
  buffer_load_dwordx4 v238, s[20:23], s31 offen offset:0 lds
  v_mfma_f32_16x16x32_bf16 v[12:15], a[164:167], a[92:95], v[12:15]
  ds_read_b64_tr_b16 a[182:183], v226 offset:9216
  v_readlane_b32 s101, v136, 48
  v_mfma_f32_16x16x32_bf16 v[12:15], a[160:163], a[76:79], v[12:15]
  s_waitcnt lgkmcnt(4)
  s_min_u32 s98, s98, s99
  v_mfma_f32_16x16x32_bf16 v[16:19], a[168:171], a[64:67], v[16:19]
  ds_read_b64_tr_b16 a[184:185], v227 offset:0
  s_min_u32 s100, s100, s101
  s_min_u32 s98, s98, s100
  v_mfma_f32_16x16x32_bf16 v[16:19], a[172:175], a[80:83], v[16:19]
  buffer_load_dwordx4 a[36:39], v242, s[24:27], s30 offen offset:1024 sc1
  s_sub_u32 s57, s51, s98
  s_sub_u32 s51, s57, 1
  v_mfma_f32_16x16x32_bf16 v[20:23], a[172:175], a[84:87], v[20:23]
  ds_read_b64_tr_b16 a[186:187], v227 offset:1024
  v_sub_u32 v137, s51, v128
  v_mfma_f32_16x16x32_bf16 v[20:23], a[168:171], a[68:71], v[20:23]
  v_sub_u32 v138, s51, v129
  v_min_u32 v136, v137, v138
  v_mfma_f32_16x16x32_bf16 v[24:27], a[168:171], a[72:75], v[24:27]
  ds_read_b64_tr_b16 a[188:189], v227 offset:8192
  v_sub_u32 v139, s51, v130
  v_mfma_f32_16x16x32_bf16 v[24:27], a[172:175], a[88:91], v[24:27]
  v_sub_u32 v140, s51, v131
  v_min3_u32 v136, v136, v139, v140
  v_mfma_f32_16x16x32_bf16 v[28:31], a[172:175], a[92:95], v[28:31]
  ds_read_b64_tr_b16 a[190:191], v227 offset:9216
  v_sub_u32 v137, s51, v132
  v_mfma_f32_16x16x32_bf16 v[28:31], a[168:171], a[76:79], v[28:31]
  s_waitcnt lgkmcnt(4)
  v_sub_u32 v138, s51, v133
  v_min3_u32 v136, v136, v137, v138
  v_mfma_f32_16x16x32_bf16 v[32:35], a[176:179], a[64:67], v[32:35]
  ds_read_b64_tr_b16 a[160:161], v228 offset:0
  v_sub_u32 v139, s51, v134
  v_mfma_f32_16x16x32_bf16 v[32:35], a[180:183], a[80:83], v[32:35]
  buffer_load_dwordx4 a[40:43], v242, s[24:27], s30 offen offset:2048 sc1
  v_mfma_f32_16x16x32_bf16 v[36:39], a[180:183], a[84:87], v[36:39]
  ds_read_b64_tr_b16 a[162:163], v228 offset:1024
  v_sub_u32 v140, s51, v135
  v_mfma_f32_16x16x32_bf16 v[36:39], a[176:179], a[68:71], v[36:39]
  v_min3_u32 v136, v136, v139, v140
  v_mfma_f32_16x16x32_bf16 v[40:43], a[176:179], a[72:75], v[40:43]
  ds_read_b64_tr_b16 a[164:165], v228 offset:8192
  v_min_u32_dpp v136, v136, v136 row_ror:8 row_mask:0xf bank_mask:0xf
  v_mfma_f32_16x16x32_bf16 v[40:43], a[180:183], a[88:91], v[40:43]
  buffer_load_dwordx4 v239, s[20:23], s31 offen offset:1024 lds
  v_mfma_f32_16x16x32_bf16 v[44:47], a[180:183], a[92:95], v[44:47]
  ds_read_b64_tr_b16 a[166:167], v228 offset:9216
  v_min_u32_dpp v136, v136, v136 row_ror:4 row_mask:0xf bank_mask:0xf
  v_mfma_f32_16x16x32_bf16 v[44:47], a[176:179], a[76:79], v[44:47]
  s_waitcnt lgkmcnt(4)
  v_min_u32_dpp v136, v136, v136 row_ror:2 row_mask:0xf bank_mask:0xf
  v_mfma_f32_16x16x32_bf16 v[48:51], a[184:187], a[64:67], v[48:51]
  ds_read_b64_tr_b16 a[168:169], v229 offset:0
  v_min_u32_dpp v136, v136, v136 row_ror:1 row_mask:0xf bank_mask:0xf
  v_mfma_f32_16x16x32_bf16 v[48:51], a[188:191], a[80:83], v[48:51]
  buffer_load_dwordx4 a[44:47], v242, s[24:27], s30 offen offset:3072 sc1
  v_mfma_f32_16x16x32_bf16 v[52:55], a[188:191], a[84:87], v[52:55]
  ds_read_b64_tr_b16 a[170:171], v229 offset:1024
  v_readlane_b32 s98, v136, 0
  v_mfma_f32_16x16x32_bf16 v[52:55], a[184:187], a[68:71], v[52:55]
  v_readlane_b32 s99, v136, 16
  v_readlane_b32 s100, v136, 32
  v_mfma_f32_16x16x32_bf16 v[56:59], a[184:187], a[72:75], v[56:59]
  ds_read_b64_tr_b16 a[172:173], v229 offset:8192
  v_readlane_b32 s101, v136, 48
  v_mfma_f32_16x16x32_bf16 v[56:59], a[188:191], a[88:91], v[56:59]
  s_min_u32 s98, s98, s99
  s_min_u32 s100, s100, s101
  v_mfma_f32_16x16x32_bf16 v[60:63], a[188:191], a[92:95], v[60:63]
  ds_read_b64_tr_b16 a[174:175], v229 offset:9216
  s_min_u32 s98, s98, s100
  s_sub_u32 s58, s51, s98
  v_mfma_f32_16x16x32_bf16 v[60:63], a[184:187], a[76:79], v[60:63]
  s_waitcnt lgkmcnt(4)
  s_sub_u32 s51, s58, 1
  v_sub_u32 v137, s51, v128
  v_sub_u32 v138, s51, v129
  v_mfma_f32_16x16x32_bf16 v[64:67], a[160:163], a[64:67], v[64:67]
  ds_read_b64_tr_b16 a[176:177], v230 offset:0
  v_min_u32 v136, v137, v138
  v_mfma_f32_16x16x32_bf16 v[64:67], a[164:167], a[80:83], v[64:67]
  buffer_load_dwordx4 a[48:51], v243, s[24:27], s30 offen offset:0 sc1
  v_mfma_f32_16x16x32_bf16 v[68:71], a[164:167], a[84:87], v[68:71]
  ds_read_b64_tr_b16 a[178:179], v230 offset:1024
  v_sub_u32 v139, s51, v130
  v_mfma_f32_16x16x32_bf16 v[68:71], a[160:163], a[68:71], v[68:71]
  v_sub_u32 v140, s51, v131
  v_min3_u32 v136, v136, v139, v140
  v_mfma_f32_16x16x32_bf16 v[72:75], a[160:163], a[72:75], v[72:75]
  ds_read_b64_tr_b16 a[180:181], v230 offset:8192
  v_sub_u32 v137, s51, v132
  v_mfma_f32_16x16x32_bf16 v[72:75], a[164:167], a[88:91], v[72:75]
  buffer_load_dwordx4 v240, s[20:23], s31 offen offset:2048 lds
  v_mfma_f32_16x16x32_bf16 v[76:79], a[164:167], a[92:95], v[76:79]
  ds_read_b64_tr_b16 a[182:183], v230 offset:9216
  v_sub_u32 v138, s51, v133
  v_mfma_f32_16x16x32_bf16 v[76:79], a[160:163], a[76:79], v[76:79]
  s_waitcnt lgkmcnt(4)
  v_min3_u32 v136, v136, v137, v138
  v_sub_u32 v139, s51, v134
  v_mfma_f32_16x16x32_bf16 v[80:83], a[168:171], a[64:67], v[80:83]
  ds_read_b64_tr_b16 a[184:185], v231 offset:0
  v_sub_u32 v140, s51, v135
  v_mfma_f32_16x16x32_bf16 v[80:83], a[172:175], a[80:83], v[80:83]
  buffer_load_dwordx4 a[52:55], v243, s[24:27], s30 offen offset:1024 sc1
  v_mfma_f32_16x16x32_bf16 v[84:87], a[172:175], a[84:87], v[84:87]
  ds_read_b64_tr_b16 a[186:187], v231 offset:1024
  v_min3_u32 v136, v136, v139, v140
  v_mfma_f32_16x16x32_bf16 v[84:87], a[168:171], a[68:71], v[84:87]
  s_waitcnt vmcnt(22)
  v_min_u32_dpp v136, v136, v136 row_ror:8 row_mask:0xf bank_mask:0xf
  v_mfma_f32_16x16x32_bf16 v[88:91], a[168:171], a[72:75], v[88:91]
  ds_read_b64_tr_b16 a[188:189], v231 offset:8192
  v_min_u32_dpp v136, v136, v136 row_ror:4 row_mask:0xf bank_mask:0xf
  s_nop 1
  v_min_u32_dpp v136, v136, v136 row_ror:2 row_mask:0xf bank_mask:0xf
  s_nop 1
  v_min_u32_dpp v136, v136, v136 row_ror:1 row_mask:0xf bank_mask:0xf
  s_nop 0
  v_readlane_b32 s98, v136, 0
  v_readlane_b32 s99, v136, 16
  v_readlane_b32 s100, v136, 32
  v_readlane_b32 s101, v136, 48
  s_min_u32 s98, s98, s99
  s_min_u32 s100, s100, s101
  s_min_u32 s98, s98, s100
  s_sub_u32 s59, s51, s98
  s_sub_u32 s51, s59, 1
  v_writelane_b32 v136, s52, 0
  v_writelane_b32 v136, s53, 1
  v_writelane_b32 v136, s54, 2
  v_writelane_b32 v136, s55, 3
  v_writelane_b32 v136, s56, 4
  v_writelane_b32 v136, s57, 5
  v_writelane_b32 v136, s58, 6
  v_writelane_b32 v136, s59, 7
  s_lshl_b32 s35, s3, 8
  s_add_u32 s35, s35, 158720
  v_lshrrev_b32 v137, 2, v242
  v_add_u32 v137, s35, v137
  ds_write_b32 v137, v136
  s_waitcnt lgkmcnt(0)
  v_mfma_f32_16x16x32_bf16 v[88:91], a[172:175], a[88:91], v[88:91]
  s_barrier
  v_mfma_f32_16x16x32_bf16 v[92:95], a[172:175], a[92:95], v[92:95]
  ds_read_b64_tr_b16 a[190:191], v231 offset:9216
  v_mfma_f32_16x16x32_bf16 v[92:95], a[168:171], a[76:79], v[92:95]
  v_mfma_f32_16x16x32_bf16 v[96:99], a[176:179], a[64:67], v[96:99]
  ds_read_b64_tr_b16 a[160:161], v224 offset:16384
  v_mfma_f32_16x16x32_bf16 v[96:99], a[180:183], a[80:83], v[96:99]
  buffer_load_dwordx4 a[56:59], v243, s[24:27], s30 offen offset:2048 sc1
  v_mfma_f32_16x16x32_bf16 v[100:103], a[180:183], a[84:87], v[100:103]
  ds_read_b64_tr_b16 a[162:163], v224 offset:17408
  v_mfma_f32_16x16x32_bf16 v[100:103], a[176:179], a[68:71], v[100:103]
  v_mfma_f32_16x16x32_bf16 v[104:107], a[176:179], a[72:75], v[104:107]
  ds_read_b64_tr_b16 a[164:165], v224 offset:24576
  v_mfma_f32_16x16x32_bf16 v[104:107], a[180:183], a[88:91], v[104:107]
  buffer_load_dwordx4 v241, s[20:23], s31 offen offset:3072 lds
  s_add_u32 s31, s31, 0x80000
  v_mfma_f32_16x16x32_bf16 v[108:111], a[180:183], a[92:95], v[108:111]
  ds_read_b64_tr_b16 a[166:167], v224 offset:25600
  v_mfma_f32_16x16x32_bf16 v[108:111], a[176:179], a[76:79], v[108:111]
  s_waitcnt lgkmcnt(4)
  v_mfma_f32_16x16x32_bf16 v[112:115], a[184:187], a[64:67], v[112:115]
  ds_read_b64_tr_b16 a[168:169], v225 offset:16384
  v_mfma_f32_16x16x32_bf16 v[112:115], a[188:191], a[80:83], v[112:115]
  buffer_load_dwordx4 a[60:63], v243, s[24:27], s30 offen offset:3072 sc1
  s_add_u32 s30, s30, 8192
  v_mfma_f32_16x16x32_bf16 v[116:119], a[188:191], a[84:87], v[116:119]
  ds_read_b64_tr_b16 a[170:171], v225 offset:17408
  v_mfma_f32_16x16x32_bf16 v[116:119], a[184:187], a[68:71], v[116:119]
  v_mfma_f32_16x16x32_bf16 v[120:123], a[184:187], a[72:75], v[120:123]
  ds_read_b64_tr_b16 a[172:173], v225 offset:24576
  v_mfma_f32_16x16x32_bf16 v[120:123], a[188:191], a[88:91], v[120:123]
  v_mfma_f32_16x16x32_bf16 v[124:127], a[188:191], a[92:95], v[124:127]
  ds_read_b64_tr_b16 a[174:175], v225 offset:25600
  v_mfma_f32_16x16x32_bf16 v[124:127], a[184:187], a[76:79], v[124:127]
  s_waitcnt vmcnt(24) lgkmcnt(4)
  v_mfma_f32_16x16x32_bf16 v[0:3], a[160:163], a[96:99], v[0:3]
  ds_read_b64_tr_b16 a[176:177], v226 offset:16384
  v_lshrrev_b32 v136, 4, v242
  v_mfma_f32_16x16x32_bf16 v[0:3], a[164:167], a[112:115], v[0:3]
  v_bfe_u32 v137, v136, 3, 2
  v_and_b32 v138, 7, v136
  v_mfma_f32_16x16x32_bf16 v[4:7], a[164:167], a[116:119], v[4:7]
  ds_read_b64_tr_b16 a[178:179], v226 offset:17408
  v_lshlrev_b32 v137, 8, v137
  v_mfma_f32_16x16x32_bf16 v[4:7], a[160:163], a[100:103], v[4:7]
  v_lshl_add_u32 v137, v138, 2, v137
  v_add_u32 v137, 158720, v137
  v_mfma_f32_16x16x32_bf16 v[8:11], a[160:163], a[104:107], v[8:11]
  ds_read_b64_tr_b16 a[180:181], v226 offset:24576
  s_add_u32 m0, s28, 0
  ds_read_b32 v128, v137
  v_mfma_f32_16x16x32_bf16 v[8:11], a[164:167], a[120:123], v[8:11]
  buffer_load_dwordx4 v232, s[12:15], s29 offen offset:0 lds
  v_mfma_f32_16x16x32_bf16 v[12:15], a[164:167], a[124:127], v[12:15]
  ds_read_b64_tr_b16 a[182:183], v226 offset:25600
  v_mfma_f32_16x16x32_bf16 v[12:15], a[160:163], a[108:111], v[12:15]
  s_waitcnt lgkmcnt(5)
  v_mfma_f32_16x16x32_bf16 v[16:19], a[168:171], a[96:99], v[16:19]
  ds_read_b64_tr_b16 a[184:185], v227 offset:16384
  v_mfma_f32_16x16x32_bf16 v[16:19], a[172:175], a[112:115], v[16:19]
  v_mfma_f32_16x16x32_bf16 v[20:23], a[172:175], a[116:119], v[20:23]
  ds_read_b64_tr_b16 a[186:187], v227 offset:17408
  v_mfma_f32_16x16x32_bf16 v[20:23], a[168:171], a[100:103], v[20:23]
  v_mfma_f32_16x16x32_bf16 v[24:27], a[168:171], a[104:107], v[24:27]
  ds_read_b64_tr_b16 a[188:189], v227 offset:24576
  s_waitcnt lgkmcnt(4)
  s_mov_b32 s51, -1
  v_sub_u32 v137, s51, v128
  v_mfma_f32_16x16x32_bf16 v[24:27], a[172:175], a[120:123], v[24:27]
  v_mfma_f32_16x16x32_bf16 v[28:31], a[172:175], a[124:127], v[28:31]
  ds_read_b64_tr_b16 a[190:191], v227 offset:25600
  v_min_u32_dpp v137, v137, v137 row_ror:8 row_mask:0xf bank_mask:0xf
  v_mfma_f32_16x16x32_bf16 v[28:31], a[168:171], a[108:111], v[28:31]
  s_waitcnt lgkmcnt(4)
  v_min_u32_dpp v137, v137, v137 row_ror:4 row_mask:0xf bank_mask:0xf
  v_mfma_f32_16x16x32_bf16 v[32:35], a[176:179], a[96:99], v[32:35]
  ds_read_b64_tr_b16 a[160:161], v228 offset:16384
  v_min_u32_dpp v137, v137, v137 row_ror:2 row_mask:0xf bank_mask:0xf
  v_mfma_f32_16x16x32_bf16 v[32:35], a[180:183], a[112:115], v[32:35]
  v_mfma_f32_16x16x32_bf16 v[36:39], a[180:183], a[116:119], v[36:39]
  ds_read_b64_tr_b16 a[162:163], v228 offset:17408
  v_min_u32_dpp v137, v137, v137 row_ror:1 row_mask:0xf bank_mask:0xf
  v_mfma_f32_16x16x32_bf16 v[36:39], a[176:179], a[100:103], v[36:39]
  v_readlane_b32 s98, v137, 0
  v_readlane_b32 s99, v137, 16
  v_mfma_f32_16x16x32_bf16 v[40:43], a[176:179], a[104:107], v[40:43]
  ds_read_b64_tr_b16 a[164:165], v228 offset:24576
  s_min_u32 s98, s98, s99
  s_sub_u32 s52, s51, s98
  v_mfma_f32_16x16x32_bf16 v[40:43], a[180:183], a[120:123], v[40:43]
  buffer_load_dwordx4 v233, s[12:15], s29 offen offset:1024 lds
  s_sub_u32 s51, s52, 1
  v_mfma_f32_16x16x32_bf16 v[44:47], a[180:183], a[124:127], v[44:47]
  ds_read_b64_tr_b16 a[166:167], v228 offset:25600
  v_sub_u32 v137, s51, v128
  v_mfma_f32_16x16x32_bf16 v[44:47], a[176:179], a[108:111], v[44:47]
  s_waitcnt lgkmcnt(4)
  v_min_u32_dpp v137, v137, v137 row_ror:8 row_mask:0xf bank_mask:0xf
  v_mfma_f32_16x16x32_bf16 v[48:51], a[184:187], a[96:99], v[48:51]
  ds_read_b64_tr_b16 a[168:169], v229 offset:16384
  v_min_u32_dpp v137, v137, v137 row_ror:4 row_mask:0xf bank_mask:0xf
  v_mfma_f32_16x16x32_bf16 v[48:51], a[188:191], a[112:115], v[48:51]
  v_mfma_f32_16x16x32_bf16 v[52:55], a[188:191], a[116:119], v[52:55]
  ds_read_b64_tr_b16 a[170:171], v229 offset:17408
  v_min_u32_dpp v137, v137, v137 row_ror:2 row_mask:0xf bank_mask:0xf
  v_mfma_f32_16x16x32_bf16 v[52:55], a[184:187], a[100:103], v[52:55]
  v_mfma_f32_16x16x32_bf16 v[56:59], a[184:187], a[104:107], v[56:59]
  ds_read_b64_tr_b16 a[172:173], v229 offset:24576
  v_min_u32_dpp v137, v137, v137 row_ror:1 row_mask:0xf bank_mask:0xf
  v_mfma_f32_16x16x32_bf16 v[56:59], a[188:191], a[120:123], v[56:59]
  v_readlane_b32 s98, v137, 0
  v_readlane_b32 s99, v137, 16
  v_mfma_f32_16x16x32_bf16 v[60:63], a[188:191], a[124:127], v[60:63]
  ds_read_b64_tr_b16 a[174:175], v229 offset:25600
  s_min_u32 s98, s98, s99
  s_sub_u32 s53, s51, s98
  v_mfma_f32_16x16x32_bf16 v[60:63], a[184:187], a[108:111], v[60:63]
  s_waitcnt lgkmcnt(4)
  s_sub_u32 s51, s53, 1
  v_sub_u32 v137, s51, v128
  v_mfma_f32_16x16x32_bf16 v[64:67], a[160:163], a[96:99], v[64:67]
  ds_read_b64_tr_b16 a[176:177], v230 offset:16384
  v_min_u32_dpp v137, v137, v137 row_ror:8 row_mask:0xf bank_mask:0xf
  v_mfma_f32_16x16x32_bf16 v[64:67], a[164:167], a[112:115], v[64:67]
  v_mfma_f32_16x16x32_bf16 v[68:71], a[164:167], a[116:119], v[68:71]
  ds_read_b64_tr_b16 a[178:179], v230 offset:17408
  v_min_u32_dpp v137, v137, v137 row_ror:4 row_mask:0xf bank_mask:0xf
  v_mfma_f32_16x16x32_bf16 v[68:71], a[160:163], a[100:103], v[68:71]
  v_mfma_f32_16x16x32_bf16 v[72:75], a[160:163], a[104:107], v[72:75]
  ds_read_b64_tr_b16 a[180:181], v230 offset:24576
  v_min_u32_dpp v137, v137, v137 row_ror:2 row_mask:0xf bank_mask:0xf
  v_mfma_f32_16x16x32_bf16 v[72:75], a[164:167], a[120:123], v[72:75]
  buffer_load_dwordx4 v234, s[12:15], s29 offen offset:2048 lds
  v_mfma_f32_16x16x32_bf16 v[76:79], a[164:167], a[124:127], v[76:79]
  ds_read_b64_tr_b16 a[182:183], v230 offset:25600
  v_min_u32_dpp v137, v137, v137 row_ror:1 row_mask:0xf bank_mask:0xf
  v_mfma_f32_16x16x32_bf16 v[76:79], a[160:163], a[108:111], v[76:79]
  s_waitcnt lgkmcnt(4)
  v_readlane_b32 s98, v137, 0
  v_readlane_b32 s99, v137, 16
  v_mfma_f32_16x16x32_bf16 v[80:83], a[168:171], a[96:99], v[80:83]
  ds_read_b64_tr_b16 a[184:185], v231 offset:16384
  s_min_u32 s98, s98, s99
  s_sub_u32 s54, s51, s98
  v_mfma_f32_16x16x32_bf16 v[80:83], a[172:175], a[112:115], v[80:83]
  s_sub_u32 s51, s54, 1
  v_sub_u32 v137, s51, v128
  v_mfma_f32_16x16x32_bf16 v[84:87], a[172:175], a[116:119], v[84:87]
  ds_read_b64_tr_b16 a[186:187], v231 offset:17408
  v_min_u32_dpp v137, v137, v137 row_ror:8 row_mask:0xf bank_mask:0xf
  v_mfma_f32_16x16x32_bf16 v[84:87], a[168:171], a[100:103], v[84:87]
  s_waitcnt vmcnt(16)
  v_min_u32_dpp v137, v137, v137 row_ror:4 row_mask:0xf bank_mask:0xf
  v_mfma_f32_16x16x32_bf16 v[88:91], a[168:171], a[104:107], v[88:91]
  ds_read_b64_tr_b16 a[188:189], v231 offset:24576
  v_min_u32_dpp v137, v137, v137 row_ror:2 row_mask:0xf bank_mask:0xf
  v_mfma_f32_16x16x32_bf16 v[88:91], a[172:175], a[120:123], v[88:91]
  s_barrier
  v_min_u32_dpp v137, v137, v137 row_ror:1 row_mask:0xf bank_mask:0xf
  v_mfma_f32_16x16x32_bf16 v[92:95], a[172:175], a[124:127], v[92:95]
  ds_read_b64_tr_b16 a[190:191], v231 offset:25600
  v_readlane_b32 s98, v137, 0
  v_mfma_f32_16x16x32_bf16 v[92:95], a[168:171], a[108:111], v[92:95]
  s_waitcnt lgkmcnt(4)
  v_readlane_b32 s99, v137, 16
  v_mfma_f32_16x16x32_bf16 v[96:99], a[176:179], a[96:99], v[96:99]
  ds_read_b64_tr_b16 a[160:161], v224 offset:32768
  s_min_u32 s98, s98, s99
  s_sub_u32 s55, s51, s98
  v_mfma_f32_16x16x32_bf16 v[96:99], a[180:183], a[112:115], v[96:99]
  s_sub_u32 s51, s55, 1
  v_sub_u32 v137, s51, v128
  v_mfma_f32_16x16x32_bf16 v[100:103], a[180:183], a[116:119], v[100:103]
  ds_read_b64_tr_b16 a[162:163], v224 offset:33792
  v_min_u32_dpp v137, v137, v137 row_ror:8 row_mask:0xf bank_mask:0xf
  v_mfma_f32_16x16x32_bf16 v[100:103], a[176:179], a[100:103], v[100:103]
  v_mfma_f32_16x16x32_bf16 v[104:107], a[176:179], a[104:107], v[104:107]
  ds_read_b64_tr_b16 a[164:165], v224 offset:40960
  v_min_u32_dpp v137, v137, v137 row_ror:4 row_mask:0xf bank_mask:0xf
  v_mfma_f32_16x16x32_bf16 v[104:107], a[180:183], a[120:123], v[104:107]
  buffer_load_dwordx4 v235, s[12:15], s29 offen offset:3072 lds
  v_mfma_f32_16x16x32_bf16 v[108:111], a[180:183], a[124:127], v[108:111]
  ds_read_b64_tr_b16 a[166:167], v224 offset:41984
  v_min_u32_dpp v137, v137, v137 row_ror:2 row_mask:0xf bank_mask:0xf
  v_mfma_f32_16x16x32_bf16 v[108:111], a[176:179], a[108:111], v[108:111]
  s_waitcnt lgkmcnt(4)
  v_min_u32_dpp v137, v137, v137 row_ror:1 row_mask:0xf bank_mask:0xf
  v_mfma_f32_16x16x32_bf16 v[112:115], a[184:187], a[96:99], v[112:115]
  ds_read_b64_tr_b16 a[168:169], v225 offset:32768
  v_readlane_b32 s98, v137, 0
  v_mfma_f32_16x16x32_bf16 v[112:115], a[188:191], a[112:115], v[112:115]
  v_readlane_b32 s99, v137, 16
  v_mfma_f32_16x16x32_bf16 v[116:119], a[188:191], a[116:119], v[116:119]
  ds_read_b64_tr_b16 a[170:171], v225 offset:33792
  s_min_u32 s98, s98, s99
  s_sub_u32 s56, s51, s98
  v_mfma_f32_16x16x32_bf16 v[116:119], a[184:187], a[100:103], v[116:119]
  s_sub_u32 s51, s56, 1
  v_sub_u32 v137, s51, v128
  v_mfma_f32_16x16x32_bf16 v[120:123], a[184:187], a[104:107], v[120:123]
  ds_read_b64_tr_b16 a[172:173], v225 offset:40960
  v_min_u32_dpp v137, v137, v137 row_ror:8 row_mask:0xf bank_mask:0xf
  v_mfma_f32_16x16x32_bf16 v[120:123], a[188:191], a[120:123], v[120:123]
  v_mfma_f32_16x16x32_bf16 v[124:127], a[188:191], a[124:127], v[124:127]
  ds_read_b64_tr_b16 a[174:175], v225 offset:41984
  v_min_u32_dpp v137, v137, v137 row_ror:4 row_mask:0xf bank_mask:0xf
  v_mfma_f32_16x16x32_bf16 v[124:127], a[184:187], a[108:111], v[124:127]
  s_waitcnt vmcnt(16) lgkmcnt(4)
  v_min_u32_dpp v137, v137, v137 row_ror:2 row_mask:0xf bank_mask:0xf
  v_mfma_f32_16x16x32_bf16 v[0:3], a[160:163], a[0:3], v[0:3]
  ds_read_b64_tr_b16 a[176:177], v226 offset:32768
  v_min_u32_dpp v137, v137, v137 row_ror:1 row_mask:0xf bank_mask:0xf
  v_mfma_f32_16x16x32_bf16 v[0:3], a[164:167], a[16:19], v[0:3]
  v_readlane_b32 s98, v137, 0
  v_readlane_b32 s99, v137, 16
  v_mfma_f32_16x16x32_bf16 v[4:7], a[164:167], a[20:23], v[4:7]
  ds_read_b64_tr_b16 a[178:179], v226 offset:33792
  s_min_u32 s98, s98, s99
  s_sub_u32 s57, s51, s98
  v_mfma_f32_16x16x32_bf16 v[4:7], a[160:163], a[4:7], v[4:7]
  s_sub_u32 s51, s57, 1
  v_sub_u32 v137, s51, v128
  v_mfma_f32_16x16x32_bf16 v[8:11], a[160:163], a[8:11], v[8:11]
  ds_read_b64_tr_b16 a[180:181], v226 offset:40960
  s_add_u32 m0, s28, 65536
  v_min_u32_dpp v137, v137, v137 row_ror:8 row_mask:0xf bank_mask:0xf
  v_mfma_f32_16x16x32_bf16 v[8:11], a[164:167], a[24:27], v[8:11]
  buffer_load_dwordx4 v236, s[16:19], s29 offen offset:0 lds
  v_mfma_f32_16x16x32_bf16 v[12:15], a[164:167], a[28:31], v[12:15]
  ds_read_b64_tr_b16 a[182:183], v226 offset:41984
  v_min_u32_dpp v137, v137, v137 row_ror:4 row_mask:0xf bank_mask:0xf
  v_mfma_f32_16x16x32_bf16 v[12:15], a[160:163], a[12:15], v[12:15]
  s_waitcnt lgkmcnt(4)
  v_min_u32_dpp v137, v137, v137 row_ror:2 row_mask:0xf bank_mask:0xf
  v_mfma_f32_16x16x32_bf16 v[16:19], a[168:171], a[0:3], v[16:19]
  ds_read_b64_tr_b16 a[184:185], v227 offset:32768
  v_min_u32_dpp v137, v137, v137 row_ror:1 row_mask:0xf bank_mask:0xf
  v_mfma_f32_16x16x32_bf16 v[16:19], a[172:175], a[16:19], v[16:19]
  v_readlane_b32 s98, v137, 0
  v_readlane_b32 s99, v137, 16
  v_mfma_f32_16x16x32_bf16 v[20:23], a[172:175], a[20:23], v[20:23]
  ds_read_b64_tr_b16 a[186:187], v227 offset:33792
  s_min_u32 s98, s98, s99
  s_sub_u32 s58, s51, s98
  v_mfma_f32_16x16x32_bf16 v[20:23], a[168:171], a[4:7], v[20:23]
  s_sub_u32 s51, s58, 1
  v_sub_u32 v137, s51, v128
  v_mfma_f32_16x16x32_bf16 v[24:27], a[168:171], a[8:11], v[24:27]
  ds_read_b64_tr_b16 a[188:189], v227 offset:40960
  v_min_u32_dpp v137, v137, v137 row_ror:8 row_mask:0xf bank_mask:0xf
  v_mfma_f32_16x16x32_bf16 v[24:27], a[172:175], a[24:27], v[24:27]
  v_mfma_f32_16x16x32_bf16 v[28:31], a[172:175], a[28:31], v[28:31]
  ds_read_b64_tr_b16 a[190:191], v227 offset:41984
  v_min_u32_dpp v137, v137, v137 row_ror:4 row_mask:0xf bank_mask:0xf
  v_mfma_f32_16x16x32_bf16 v[28:31], a[168:171], a[12:15], v[28:31]
  s_waitcnt lgkmcnt(4)
  v_min_u32_dpp v137, v137, v137 row_ror:2 row_mask:0xf bank_mask:0xf
  v_mfma_f32_16x16x32_bf16 v[32:35], a[176:179], a[0:3], v[32:35]
  ds_read_b64_tr_b16 a[160:161], v228 offset:32768
  v_min_u32_dpp v137, v137, v137 row_ror:1 row_mask:0xf bank_mask:0xf
  v_mfma_f32_16x16x32_bf16 v[32:35], a[180:183], a[16:19], v[32:35]
  v_readlane_b32 s98, v137, 0
  v_readlane_b32 s99, v137, 16
  v_mfma_f32_16x16x32_bf16 v[36:39], a[180:183], a[20:23], v[36:39]
  ds_read_b64_tr_b16 a[162:163], v228 offset:33792
  s_min_u32 s98, s98, s99
  s_sub_u32 s59, s51, s98
  v_mfma_f32_16x16x32_bf16 v[36:39], a[176:179], a[4:7], v[36:39]
  s_sub_u32 s51, s59, 1
  v_mov_b32 v128, 0
  v_writelane_b32 v128, s52, 0
  v_mfma_f32_16x16x32_bf16 v[40:43], a[176:179], a[8:11], v[40:43]
  ds_read_b64_tr_b16 a[164:165], v228 offset:40960
  v_writelane_b32 v128, s53, 1
  v_mfma_f32_16x16x32_bf16 v[40:43], a[180:183], a[24:27], v[40:43]
  buffer_load_dwordx4 v237, s[16:19], s29 offen offset:1024 lds
  v_mfma_f32_16x16x32_bf16 v[44:47], a[180:183], a[28:31], v[44:47]
  ds_read_b64_tr_b16 a[166:167], v228 offset:41984
  v_writelane_b32 v128, s54, 2
  v_mfma_f32_16x16x32_bf16 v[44:47], a[176:179], a[12:15], v[44:47]
  s_waitcnt lgkmcnt(4)
  v_writelane_b32 v128, s55, 3
  v_writelane_b32 v128, s56, 4
  v_mfma_f32_16x16x32_bf16 v[48:51], a[184:187], a[0:3], v[48:51]
  ds_read_b64_tr_b16 a[168:169], v229 offset:32768
  v_writelane_b32 v128, s57, 5
  v_mfma_f32_16x16x32_bf16 v[48:51], a[188:191], a[16:19], v[48:51]
  v_writelane_b32 v128, s58, 6
  v_writelane_b32 v128, s59, 7
  v_mfma_f32_16x16x32_bf16 v[52:55], a[188:191], a[20:23], v[52:55]
  ds_read_b64_tr_b16 a[170:171], v229 offset:33792
  s_min_u32 s39, s2, 1
  s_lshl_b32 s39, s39, 30
  v_lshrrev_b32 v137, 3, v136
  v_mfma_f32_16x16x32_bf16 v[52:55], a[184:187], a[4:7], v[52:55]
  v_lshlrev_b32 v137, 28, v137
  v_lshl_add_u32 v137, v136, 2, v137
  v_mfma_f32_16x16x32_bf16 v[56:59], a[184:187], a[8:11], v[56:59]
  ds_read_b64_tr_b16 a[172:173], v229 offset:40960
  v_or_b32 v137, s39, v137
  v_mfma_f32_16x16x32_bf16 v[56:59], a[188:191], a[24:27], v[56:59]
  s_mov_b32 s39, 2629632
  buffer_store_dword v128, v137, s[24:27], s39 offen
  v_mfma_f32_16x16x32_bf16 v[60:63], a[188:191], a[28:31], v[60:63]
  ds_read_b64_tr_b16 a[174:175], v229 offset:41984
  v_and_b32 v129, 0xffff, v128
  v_mfma_f32_16x16x32_bf16 v[60:63], a[184:187], a[12:15], v[60:63]
  s_waitcnt lgkmcnt(4)
  v_sub_u32 v129, 0xffff, v129
  v_and_b32 v129, 0x7ff, v129
  v_mfma_f32_16x16x32_bf16 v[64:67], a[160:163], a[0:3], v[64:67]
  ds_read_b64_tr_b16 a[176:177], v230 offset:32768
  v_mov_b32 v130, v129
  v_mfma_f32_16x16x32_bf16 v[64:67], a[164:167], a[16:19], v[64:67]
  v_mfma_f32_16x16x32_bf16 v[68:71], a[164:167], a[20:23], v[68:71]
  ds_read_b64_tr_b16 a[178:179], v230 offset:33792
  v_permlane16_swap_b32 v129, v130
  v_mfma_f32_16x16x32_bf16 v[68:71], a[160:163], a[4:7], v[68:71]
  v_mov_b32 v130, v129
  v_mfma_f32_16x16x32_bf16 v[72:75], a[160:163], a[8:11], v[72:75]
  ds_read_b64_tr_b16 a[180:181], v230 offset:40960
  v_permlane32_swap_b32 v129, v130
  v_mfma_f32_16x16x32_bf16 v[72:75], a[164:167], a[24:27], v[72:75]
  buffer_load_dwordx4 v236, s[16:19], s29 offen offset:2048 lds
  v_mfma_f32_16x16x32_bf16 v[76:79], a[164:167], a[28:31], v[76:79]
  ds_read_b64_tr_b16 a[182:183], v230 offset:41984
  v_lshrrev_b32 v130, 6, v129
  v_mfma_f32_16x16x32_bf16 v[76:79], a[160:163], a[12:15], v[76:79]
  s_waitcnt lgkmcnt(4)
  v_mul_u32_u24 v130, 0x14000, v130
  v_bfe_u32 v131, v129, 4, 2
  v_mfma_f32_16x16x32_bf16 v[80:83], a[168:171], a[0:3], v[80:83]
  ds_read_b64_tr_b16 a[184:185], v231 offset:32768
  v_lshl_add_u32 v130, v131, 10, v130
  v_mfma_f32_16x16x32_bf16 v[80:83], a[172:175], a[16:19], v[80:83]
  v_and_b32 v131, 15, v129
  v_lshl_add_u32 v130, v131, 4, v130
  v_mfma_f32_16x16x32_bf16 v[84:87], a[172:175], a[20:23], v[84:87]
  ds_read_b64_tr_b16 a[186:187], v231 offset:33792
  v_lshrrev_b32 v131, 4, v136
  v_mfma_f32_16x16x32_bf16 v[84:87], a[168:171], a[4:7], v[84:87]
  s_waitcnt vmcnt(9)
  v_lshl_add_u32 v243, v131, 8, v130
  v_mfma_f32_16x16x32_bf16 v[88:91], a[168:171], a[8:11], v[88:91]
  ds_read_b64_tr_b16 a[188:189], v231 offset:40960
  v_mfma_f32_16x16x32_bf16 v[88:91], a[172:175], a[24:27], v[88:91]
  s_barrier
  v_mfma_f32_16x16x32_bf16 v[92:95], a[172:175], a[28:31], v[92:95]
  ds_read_b64_tr_b16 a[190:191], v231 offset:41984
  v_mfma_f32_16x16x32_bf16 v[92:95], a[168:171], a[12:15], v[92:95]
  s_waitcnt lgkmcnt(4)
  v_mfma_f32_16x16x32_bf16 v[96:99], a[176:179], a[0:3], v[96:99]
  ds_read_b64_tr_b16 a[160:161], v224 offset:49152
  v_mfma_f32_16x16x32_bf16 v[96:99], a[180:183], a[16:19], v[96:99]
  v_mfma_f32_16x16x32_bf16 v[100:103], a[180:183], a[20:23], v[100:103]
  ds_read_b64_tr_b16 a[162:163], v224 offset:50176
  v_mfma_f32_16x16x32_bf16 v[100:103], a[176:179], a[4:7], v[100:103]
  v_mfma_f32_16x16x32_bf16 v[104:107], a[176:179], a[8:11], v[104:107]
  ds_read_b64_tr_b16 a[164:165], v224 offset:57344
  v_mfma_f32_16x16x32_bf16 v[104:107], a[180:183], a[24:27], v[104:107]
  buffer_load_dwordx4 v237, s[16:19], s29 offen offset:3072 lds
  s_add_u32 s29, s29, 16384
  v_mfma_f32_16x16x32_bf16 v[108:111], a[180:183], a[28:31], v[108:111]
  ds_read_b64_tr_b16 a[166:167], v224 offset:58368
  v_mfma_f32_16x16x32_bf16 v[108:111], a[176:179], a[12:15], v[108:111]
  s_waitcnt lgkmcnt(4)
  v_mfma_f32_16x16x32_bf16 v[112:115], a[184:187], a[0:3], v[112:115]
  ds_read_b64_tr_b16 a[168:169], v225 offset:49152
  v_mfma_f32_16x16x32_bf16 v[112:115], a[188:191], a[16:19], v[112:115]
  v_mfma_f32_16x16x32_bf16 v[116:119], a[188:191], a[20:23], v[116:119]
  ds_read_b64_tr_b16 a[170:171], v225 offset:50176
  v_mfma_f32_16x16x32_bf16 v[116:119], a[184:187], a[4:7], v[116:119]
  v_mfma_f32_16x16x32_bf16 v[120:123], a[184:187], a[8:11], v[120:123]
  ds_read_b64_tr_b16 a[172:173], v225 offset:57344
  v_mfma_f32_16x16x32_bf16 v[120:123], a[188:191], a[24:27], v[120:123]
  v_mfma_f32_16x16x32_bf16 v[124:127], a[188:191], a[28:31], v[124:127]
  ds_read_b64_tr_b16 a[174:175], v225 offset:58368
  v_mfma_f32_16x16x32_bf16 v[124:127], a[184:187], a[12:15], v[124:127]
  s_waitcnt vmcnt(9) lgkmcnt(4)
  v_mfma_f32_16x16x32_bf16 v[0:3], a[160:163], a[32:35], v[0:3]
  ds_read_b64_tr_b16 a[176:177], v226 offset:49152
  s_add_u32 m0, s28, 16384
  v_mfma_f32_16x16x32_bf16 v[0:3], a[164:167], a[48:51], v[0:3]
  buffer_load_dwordx4 v232, s[12:15], s29 offen offset:0 lds
  v_mfma_f32_16x16x32_bf16 v[4:7], a[164:167], a[52:55], v[4:7]
  ds_read_b64_tr_b16 a[178:179], v226 offset:50176
  v_mfma_f32_16x16x32_bf16 v[4:7], a[160:163], a[36:39], v[4:7]
  v_mfma_f32_16x16x32_bf16 v[8:11], a[160:163], a[40:43], v[8:11]
  ds_read_b64_tr_b16 a[180:181], v226 offset:57344
  v_mfma_f32_16x16x32_bf16 v[8:11], a[164:167], a[56:59], v[8:11]
  buffer_load_dwordx4 v233, s[12:15], s29 offen offset:1024 lds
  v_mfma_f32_16x16x32_bf16 v[12:15], a[164:167], a[60:63], v[12:15]
  ds_read_b64_tr_b16 a[182:183], v226 offset:58368
  v_mfma_f32_16x16x32_bf16 v[12:15], a[160:163], a[44:47], v[12:15]
  s_waitcnt lgkmcnt(4)
  v_mfma_f32_16x16x32_bf16 v[16:19], a[168:171], a[32:35], v[16:19]
  ds_read_b64_tr_b16 a[184:185], v227 offset:49152
  v_mfma_f32_16x16x32_bf16 v[16:19], a[172:175], a[48:51], v[16:19]
  buffer_load_dwordx4 v234, s[12:15], s29 offen offset:2048 lds
  v_mfma_f32_16x16x32_bf16 v[20:23], a[172:175], a[52:55], v[20:23]
  ds_read_b64_tr_b16 a[186:187], v227 offset:50176
  v_mfma_f32_16x16x32_bf16 v[20:23], a[168:171], a[36:39], v[20:23]
  buffer_load_dwordx4 v235, s[12:15], s29 offen offset:3072 lds
  v_mfma_f32_16x16x32_bf16 v[24:27], a[168:171], a[40:43], v[24:27]
  ds_read_b64_tr_b16 a[188:189], v227 offset:57344
  v_mfma_f32_16x16x32_bf16 v[24:27], a[172:175], a[56:59], v[24:27]
  v_mul_f32 v0, s34, v0
  v_mul_f32 v1, s34, v1
  v_mfma_f32_16x16x32_bf16 v[28:31], a[172:175], a[60:63], v[28:31]
  ds_read_b64_tr_b16 a[190:191], v227 offset:58368
  v_mul_f32 v2, s34, v2
  v_mfma_f32_16x16x32_bf16 v[28:31], a[168:171], a[44:47], v[28:31]
  s_waitcnt lgkmcnt(4)
  v_mul_f32 v3, s34, v3
  v_mul_f32 v16, s34, v16
  v_mfma_f32_16x16x32_bf16 v[32:35], a[176:179], a[32:35], v[32:35]
  ds_read_b64_tr_b16 a[160:161], v228 offset:49152
  v_mul_f32 v17, s34, v17
  v_mfma_f32_16x16x32_bf16 v[32:35], a[180:183], a[48:51], v[32:35]
  v_mul_f32 v18, s34, v18
  v_mul_f32 v19, s34, v19
  v_mfma_f32_16x16x32_bf16 v[36:39], a[180:183], a[52:55], v[36:39]
  ds_read_b64_tr_b16 a[162:163], v228 offset:50176
  v_cvt_pk_bf16_f32 v128, v0, v1
  v_mfma_f32_16x16x32_bf16 v[36:39], a[176:179], a[36:39], v[36:39]
  v_cvt_pk_bf16_f32 v129, v2, v3
  v_cvt_pk_bf16_f32 v130, v16, v17
  v_mfma_f32_16x16x32_bf16 v[40:43], a[176:179], a[40:43], v[40:43]
  ds_read_b64_tr_b16 a[164:165], v228 offset:57344
  v_cvt_pk_bf16_f32 v131, v18, v19
  v_mfma_f32_16x16x32_bf16 v[40:43], a[180:183], a[56:59], v[40:43]
  v_mul_f32 v4, s34, v4
  v_mul_f32 v5, s34, v5
  v_mfma_f32_16x16x32_bf16 v[44:47], a[180:183], a[60:63], v[44:47]
  ds_read_b64_tr_b16 a[166:167], v228 offset:58368
  v_mul_f32 v6, s34, v6
  v_mfma_f32_16x16x32_bf16 v[44:47], a[176:179], a[44:47], v[44:47]
  s_waitcnt lgkmcnt(4)
  v_mul_f32 v7, s34, v7
  v_mul_f32 v20, s34, v20
  v_mfma_f32_16x16x32_bf16 v[48:51], a[184:187], a[32:35], v[48:51]
  ds_read_b64_tr_b16 a[168:169], v229 offset:49152
  v_mul_f32 v21, s34, v21
  v_mfma_f32_16x16x32_bf16 v[48:51], a[188:191], a[48:51], v[48:51]
  v_mul_f32 v22, s34, v22
  v_mul_f32 v23, s34, v23
  v_mfma_f32_16x16x32_bf16 v[52:55], a[188:191], a[52:55], v[52:55]
  ds_read_b64_tr_b16 a[170:171], v229 offset:50176
  v_cvt_pk_bf16_f32 v144, v4, v5
  v_mfma_f32_16x16x32_bf16 v[52:55], a[184:187], a[36:39], v[52:55]
  v_cvt_pk_bf16_f32 v145, v6, v7
  v_cvt_pk_bf16_f32 v146, v20, v21
  v_mfma_f32_16x16x32_bf16 v[56:59], a[184:187], a[40:43], v[56:59]
  ds_read_b64_tr_b16 a[172:173], v229 offset:57344
  v_cvt_pk_bf16_f32 v147, v22, v23
  v_mfma_f32_16x16x32_bf16 v[56:59], a[188:191], a[56:59], v[56:59]
  v_permlane16_swap_b32 v128, v130
  v_permlane16_swap_b32 v129, v131
  v_mfma_f32_16x16x32_bf16 v[60:63], a[188:191], a[60:63], v[60:63]
  ds_read_b64_tr_b16 a[174:175], v229 offset:58368
  v_mul_f32 v8, s34, v8
  v_mfma_f32_16x16x32_bf16 v[60:63], a[184:187], a[44:47], v[60:63]
  s_waitcnt lgkmcnt(4)
  v_mul_f32 v9, s34, v9
  v_mul_f32 v10, s34, v10
  v_mfma_f32_16x16x32_bf16 v[64:67], a[160:163], a[32:35], v[64:67]
  ds_read_b64_tr_b16 a[176:177], v230 offset:49152
  v_mul_f32 v11, s34, v11
  v_mfma_f32_16x16x32_bf16 v[64:67], a[164:167], a[48:51], v[64:67]
  v_mul_f32 v24, s34, v24
  v_mul_f32 v25, s34, v25
  v_mfma_f32_16x16x32_bf16 v[68:71], a[164:167], a[52:55], v[68:71]
  ds_read_b64_tr_b16 a[178:179], v230 offset:50176
  v_mul_f32 v26, s34, v26
  v_mfma_f32_16x16x32_bf16 v[68:71], a[160:163], a[36:39], v[68:71]
  v_mul_f32 v27, s34, v27
  v_cvt_pk_bf16_f32 v160, v8, v9
  v_mfma_f32_16x16x32_bf16 v[72:75], a[160:163], a[40:43], v[72:75]
  ds_read_b64_tr_b16 a[180:181], v230 offset:57344
  v_cvt_pk_bf16_f32 v161, v10, v11
  v_mfma_f32_16x16x32_bf16 v[72:75], a[164:167], a[56:59], v[72:75]
  v_cvt_pk_bf16_f32 v162, v24, v25
  v_cvt_pk_bf16_f32 v163, v26, v27
  v_mfma_f32_16x16x32_bf16 v[76:79], a[164:167], a[60:63], v[76:79]
  ds_read_b64_tr_b16 a[182:183], v230 offset:58368
  v_permlane16_swap_b32 v144, v146
  v_mfma_f32_16x16x32_bf16 v[76:79], a[160:163], a[44:47], v[76:79]
  s_waitcnt lgkmcnt(4)
  v_permlane16_swap_b32 v145, v147
  v_mul_f32 v12, s34, v12
  v_mfma_f32_16x16x32_bf16 v[80:83], a[168:171], a[32:35], v[80:83]
  ds_read_b64_tr_b16 a[184:185], v231 offset:49152
  v_mul_f32 v13, s34, v13
  v_mfma_f32_16x16x32_bf16 v[80:83], a[172:175], a[48:51], v[80:83]
  v_mul_f32 v14, s34, v14
  v_mul_f32 v15, s34, v15
  v_mfma_f32_16x16x32_bf16 v[84:87], a[172:175], a[52:55], v[84:87]
  ds_read_b64_tr_b16 a[186:187], v231 offset:50176
  v_mul_f32 v28, s34, v28
  v_mfma_f32_16x16x32_bf16 v[84:87], a[168:171], a[36:39], v[84:87]
  s_waitcnt vmcnt(9)
  v_mul_f32 v29, s34, v29
  v_mul_f32 v30, s34, v30
  v_mfma_f32_16x16x32_bf16 v[88:91], a[168:171], a[40:43], v[88:91]
  ds_read_b64_tr_b16 a[188:189], v231 offset:57344
  v_mul_f32 v31, s34, v31
  v_mfma_f32_16x16x32_bf16 v[88:91], a[172:175], a[56:59], v[88:91]
  s_barrier
  v_cvt_pk_bf16_f32 v176, v12, v13
  v_cvt_pk_bf16_f32 v177, v14, v15
  v_mfma_f32_16x16x32_bf16 v[92:95], a[172:175], a[60:63], v[92:95]
  ds_read_b64_tr_b16 a[190:191], v231 offset:58368
  v_cvt_pk_bf16_f32 v178, v28, v29
  v_mfma_f32_16x16x32_bf16 v[92:95], a[168:171], a[44:47], v[92:95]
  s_waitcnt lgkmcnt(4)
  v_cvt_pk_bf16_f32 v179, v30, v31
  v_permlane16_swap_b32 v160, v162
  v_mfma_f32_16x16x32_bf16 v[96:99], a[176:179], a[32:35], v[96:99]
  ds_read_b128 a[128:131], v212 offset:0
  v_permlane16_swap_b32 v161, v163
  v_mfma_f32_16x16x32_bf16 v[96:99], a[180:183], a[48:51], v[96:99]
  v_mul_f32 v32, s34, v32
  v_mul_f32 v33, s34, v33
  v_mfma_f32_16x16x32_bf16 v[100:103], a[180:183], a[52:55], v[100:103]
  ds_read_b128 a[132:135], v213 offset:0
  v_mul_f32 v34, s34, v34
  v_mfma_f32_16x16x32_bf16 v[100:103], a[176:179], a[36:39], v[100:103]
  v_mul_f32 v35, s34, v35
  v_mul_f32 v48, s34, v48
  v_mfma_f32_16x16x32_bf16 v[104:107], a[176:179], a[40:43], v[104:107]
  ds_read_b128 a[136:139], v214 offset:0
  v_mul_f32 v49, s34, v49
  v_mfma_f32_16x16x32_bf16 v[104:107], a[180:183], a[56:59], v[104:107]
  v_mul_f32 v50, s34, v50
  v_mul_f32 v51, s34, v51
  v_mfma_f32_16x16x32_bf16 v[108:111], a[180:183], a[60:63], v[108:111]
  ds_read_b128 a[140:143], v215 offset:0
  v_cvt_pk_bf16_f32 v132, v32, v33
  v_mfma_f32_16x16x32_bf16 v[108:111], a[176:179], a[44:47], v[108:111]
  s_waitcnt lgkmcnt(4)
  v_cvt_pk_bf16_f32 v133, v34, v35
  v_cvt_pk_bf16_f32 v134, v48, v49
  v_mfma_f32_16x16x32_bf16 v[112:115], a[184:187], a[32:35], v[112:115]
  v_cvt_pk_bf16_f32 v135, v50, v51
  v_permlane16_swap_b32 v176, v178
  v_mfma_f32_16x16x32_bf16 v[112:115], a[188:191], a[48:51], v[112:115]
  v_permlane16_swap_b32 v177, v179
  v_mul_f32 v36, s34, v36
  v_mfma_f32_16x16x32_bf16 v[116:119], a[188:191], a[52:55], v[116:119]
  v_mul_f32 v37, s34, v37
  v_mul_f32 v38, s34, v38
  v_mfma_f32_16x16x32_bf16 v[116:119], a[184:187], a[36:39], v[116:119]
  v_mul_f32 v39, s34, v39
  v_mul_f32 v52, s34, v52
  v_mfma_f32_16x16x32_bf16 v[120:123], a[184:187], a[40:43], v[120:123]
  v_mul_f32 v53, s34, v53
  v_mul_f32 v54, s34, v54
  v_mfma_f32_16x16x32_bf16 v[120:123], a[188:191], a[56:59], v[120:123]
  v_mul_f32 v55, s34, v55
  v_cvt_pk_bf16_f32 v148, v36, v37
  v_mfma_f32_16x16x32_bf16 v[124:127], a[188:191], a[60:63], v[124:127]
  v_cvt_pk_bf16_f32 v149, v38, v39
  v_cvt_pk_bf16_f32 v150, v52, v53
  v_mfma_f32_16x16x32_bf16 v[124:127], a[184:187], a[44:47], v[124:127]
  s_waitcnt lgkmcnt(0)
  v_cvt_pk_bf16_f32 v151, v54, v55
  v_permlane16_swap_b32 v132, v134
  v_permlane16_swap_b32 v133, v135
  v_pk_mul_f32 v[40:41], v[40:41], s[34:35] op_sel_hi:[1,0]
  v_pk_mul_f32 v[42:43], v[42:43], s[34:35] op_sel_hi:[1,0]
  v_pk_mul_f32 v[56:57], v[56:57], s[34:35] op_sel_hi:[1,0]
  v_pk_mul_f32 v[58:59], v[58:59], s[34:35] op_sel_hi:[1,0]
  v_cvt_pk_bf16_f32 v164, v40, v41
  v_cvt_pk_bf16_f32 v165, v42, v43
  v_cvt_pk_bf16_f32 v166, v56, v57
  v_cvt_pk_bf16_f32 v167, v58, v59
  v_permlane16_swap_b32 v148, v150
  v_permlane16_swap_b32 v149, v151
  v_pk_mul_f32 v[44:45], v[44:45], s[34:35] op_sel_hi:[1,0]
  v_pk_mul_f32 v[46:47], v[46:47], s[34:35] op_sel_hi:[1,0]
  v_pk_mul_f32 v[60:61], v[60:61], s[34:35] op_sel_hi:[1,0]
  v_pk_mul_f32 v[62:63], v[62:63], s[34:35] op_sel_hi:[1,0]
  v_cvt_pk_bf16_f32 v180, v44, v45
  v_cvt_pk_bf16_f32 v181, v46, v47
  v_cvt_pk_bf16_f32 v182, v60, v61
  v_cvt_pk_bf16_f32 v183, v62, v63
  v_permlane16_swap_b32 v164, v166
  v_permlane16_swap_b32 v165, v167
  v_pk_mul_f32 v[64:65], v[64:65], s[34:35] op_sel_hi:[1,0]
  v_pk_mul_f32 v[66:67], v[66:67], s[34:35] op_sel_hi:[1,0]
  v_pk_mul_f32 v[80:81], v[80:81], s[34:35] op_sel_hi:[1,0]
  v_pk_mul_f32 v[82:83], v[82:83], s[34:35] op_sel_hi:[1,0]
  v_cvt_pk_bf16_f32 v136, v64, v65
  v_cvt_pk_bf16_f32 v137, v66, v67
  v_cvt_pk_bf16_f32 v138, v80, v81
  v_cvt_pk_bf16_f32 v139, v82, v83
  v_permlane16_swap_b32 v180, v182
  v_permlane16_swap_b32 v181, v183
  v_pk_mul_f32 v[68:69], v[68:69], s[34:35] op_sel_hi:[1,0]
  v_pk_mul_f32 v[70:71], v[70:71], s[34:35] op_sel_hi:[1,0]
  v_pk_mul_f32 v[84:85], v[84:85], s[34:35] op_sel_hi:[1,0]
  v_pk_mul_f32 v[86:87], v[86:87], s[34:35] op_sel_hi:[1,0]
  v_cvt_pk_bf16_f32 v152, v68, v69
  v_cvt_pk_bf16_f32 v153, v70, v71
  v_cvt_pk_bf16_f32 v154, v84, v85
  v_cvt_pk_bf16_f32 v155, v86, v87
  v_permlane16_swap_b32 v136, v138
  v_permlane16_swap_b32 v137, v139
  v_pk_mul_f32 v[72:73], v[72:73], s[34:35] op_sel_hi:[1,0]
  v_pk_mul_f32 v[74:75], v[74:75], s[34:35] op_sel_hi:[1,0]
  v_pk_mul_f32 v[88:89], v[88:89], s[34:35] op_sel_hi:[1,0]
  v_pk_mul_f32 v[90:91], v[90:91], s[34:35] op_sel_hi:[1,0]
  v_cvt_pk_bf16_f32 v168, v72, v73
  v_cvt_pk_bf16_f32 v169, v74, v75
  v_cvt_pk_bf16_f32 v170, v88, v89
  v_cvt_pk_bf16_f32 v171, v90, v91
  v_permlane16_swap_b32 v152, v154
  v_permlane16_swap_b32 v153, v155
  v_pk_mul_f32 v[76:77], v[76:77], s[34:35] op_sel_hi:[1,0]
  v_pk_mul_f32 v[78:79], v[78:79], s[34:35] op_sel_hi:[1,0]
  v_pk_mul_f32 v[92:93], v[92:93], s[34:35] op_sel_hi:[1,0]
  v_pk_mul_f32 v[94:95], v[94:95], s[34:35] op_sel_hi:[1,0]
  v_cvt_pk_bf16_f32 v184, v76, v77
  v_cvt_pk_bf16_f32 v185, v78, v79
  v_cvt_pk_bf16_f32 v186, v92, v93
  v_cvt_pk_bf16_f32 v187, v94, v95
  v_permlane16_swap_b32 v168, v170
  v_permlane16_swap_b32 v169, v171
  v_pk_mul_f32 v[96:97], v[96:97], s[34:35] op_sel_hi:[1,0]
  v_pk_mul_f32 v[98:99], v[98:99], s[34:35] op_sel_hi:[1,0]
  v_pk_mul_f32 v[112:113], v[112:113], s[34:35] op_sel_hi:[1,0]
  v_pk_mul_f32 v[114:115], v[114:115], s[34:35] op_sel_hi:[1,0]
  v_cvt_pk_bf16_f32 v140, v96, v97
  v_cvt_pk_bf16_f32 v141, v98, v99
  v_cvt_pk_bf16_f32 v142, v112, v113
  v_cvt_pk_bf16_f32 v143, v114, v115
  v_permlane16_swap_b32 v184, v186
  v_permlane16_swap_b32 v185, v187
  v_pk_mul_f32 v[100:101], v[100:101], s[34:35] op_sel_hi:[1,0]
  v_pk_mul_f32 v[102:103], v[102:103], s[34:35] op_sel_hi:[1,0]
  v_pk_mul_f32 v[116:117], v[116:117], s[34:35] op_sel_hi:[1,0]
  v_pk_mul_f32 v[118:119], v[118:119], s[34:35] op_sel_hi:[1,0]
  v_cvt_pk_bf16_f32 v156, v100, v101
  v_cvt_pk_bf16_f32 v157, v102, v103
  v_cvt_pk_bf16_f32 v158, v116, v117
  v_cvt_pk_bf16_f32 v159, v118, v119
  v_permlane16_swap_b32 v140, v142
  v_permlane16_swap_b32 v141, v143
  v_pk_mul_f32 v[104:105], v[104:105], s[34:35] op_sel_hi:[1,0]
  v_pk_mul_f32 v[106:107], v[106:107], s[34:35] op_sel_hi:[1,0]
  v_pk_mul_f32 v[120:121], v[120:121], s[34:35] op_sel_hi:[1,0]
  v_pk_mul_f32 v[122:123], v[122:123], s[34:35] op_sel_hi:[1,0]
  v_cvt_pk_bf16_f32 v172, v104, v105
  v_cvt_pk_bf16_f32 v173, v106, v107
  v_cvt_pk_bf16_f32 v174, v120, v121
  v_cvt_pk_bf16_f32 v175, v122, v123
  v_permlane16_swap_b32 v156, v158
  v_permlane16_swap_b32 v157, v159
  v_pk_mul_f32 v[108:109], v[108:109], s[34:35] op_sel_hi:[1,0]
  v_pk_mul_f32 v[110:111], v[110:111], s[34:35] op_sel_hi:[1,0]
  v_pk_mul_f32 v[124:125], v[124:125], s[34:35] op_sel_hi:[1,0]
  v_pk_mul_f32 v[126:127], v[126:127], s[34:35] op_sel_hi:[1,0]
  v_cvt_pk_bf16_f32 v188, v108, v109
  v_cvt_pk_bf16_f32 v189, v110, v111
  v_cvt_pk_bf16_f32 v190, v124, v125
  v_cvt_pk_bf16_f32 v191, v126, v127
  v_permlane16_swap_b32 v172, v174
  v_permlane16_swap_b32 v173, v175
  v_permlane16_swap_b32 v188, v190
  v_permlane16_swap_b32 v189, v191
  v_mfma_f32_16x16x32_bf16 v[0:3], a[128:131], v[128:131], 0
  s_add_u32 m0, s28, 81920
  ds_read_b128 a[144:147], v212 offset:4096
  s_mov_b32 s20, s90
  v_mfma_f32_16x16x32_bf16 v[0:3], a[132:135], v[132:135], v[0:3]
  buffer_load_dwordx4 v236, s[16:19], s29 offen offset:0 lds
  s_mov_b32 s21, s91
  s_mov_b32 s22, 2211840
  v_mfma_f32_16x16x32_bf16 v[0:3], a[136:139], v[136:139], v[0:3]
  ds_read_b128 a[148:151], v213 offset:4096
  s_mov_b32 s23, 0x20000
  s_mov_b32 s44, s92
  v_mfma_f32_16x16x32_bf16 v[0:3], a[140:143], v[140:143], v[0:3]
  buffer_load_dwordx4 v237, s[16:19], s29 offen offset:1024 lds
  s_mov_b32 s45, s93
  s_mov_b32 s46, 2211840
  v_mfma_f32_16x16x32_bf16 v[8:11], a[140:143], v[156:159], 0
  ds_read_b128 a[152:155], v214 offset:4096
  s_mov_b32 s47, 0x20000
  v_lshrrev_b32 v226, 4, v242
  v_mfma_f32_16x16x32_bf16 v[8:11], a[136:139], v[152:155], v[8:11]
  buffer_load_dwordx4 v236, s[16:19], s29 offen offset:2048 lds
  v_mfma_f32_16x16x32_bf16 v[8:11], a[132:135], v[148:151], v[8:11]
  ds_read_b128 a[156:159], v215 offset:4096
  v_mul_u32_u24 v226, 0xd80, v226
  v_mfma_f32_16x16x32_bf16 v[8:11], a[128:131], v[144:147], v[8:11]
  buffer_load_dwordx4 v237, s[16:19], s29 offen offset:3072 lds
  s_mul_i32 s35, s3, 552960
  s_lshl_b32 s38, s33, 4
  v_mfma_f32_16x16x32_bf16 v[16:19], a[128:131], v[160:163], 0
  s_add_u32 s29, s29, 16384
  s_add_u32 m0, s28, 32768
  v_mfma_f32_16x16x32_bf16 v[16:19], a[132:135], v[164:167], v[16:19]
  buffer_load_dwordx4 v232, s[12:15], s29 offen offset:0 lds
  s_add_u32 s35, s35, s38
  v_mfma_f32_16x16x32_bf16 v[16:19], a[136:139], v[168:171], v[16:19]
  buffer_load_dwordx4 v233, s[12:15], s29 offen offset:1024 lds
  v_mfma_f32_16x16x32_bf16 v[16:19], a[140:143], v[172:175], v[16:19]
  v_max3_f32 v192, v0, v1, v2
  v_max3_f32 v196, v8, v9, v10
  v_mfma_f32_16x16x32_bf16 v[24:27], a[140:143], v[188:191], 0
  v_max_f32 v192, v192, v3
  v_max_f32 v196, v196, v11
  v_mfma_f32_16x16x32_bf16 v[24:27], a[136:139], v[184:187], v[24:27]
  v_mov_b32 v245, v192
  v_mov_b32 v246, v196
  v_mfma_f32_16x16x32_bf16 v[24:27], a[132:135], v[180:183], v[24:27]
  v_permlane16_swap_b32 v192, v245
  v_permlane16_swap_b32 v196, v246
  v_mfma_f32_16x16x32_bf16 v[24:27], a[128:131], v[176:179], v[24:27]
  s_waitcnt lgkmcnt(0)
  v_max_f32 v192, v192, v245
  v_max_f32 v196, v196, v246
  v_mfma_f32_16x16x32_bf16 v[4:7], a[144:147], v[128:131], 0
  ds_read_b128 a[128:131], v212 offset:8192
  v_mov_b32 v245, v192
  v_mfma_f32_16x16x32_bf16 v[4:7], a[148:151], v[132:135], v[4:7]
  v_mov_b32 v246, v196
  v_permlane32_swap_b32 v192, v245
  v_mfma_f32_16x16x32_bf16 v[4:7], a[152:155], v[136:139], v[4:7]
  ds_read_b128 a[132:135], v213 offset:8192
  v_permlane32_swap_b32 v196, v246
  v_mfma_f32_16x16x32_bf16 v[4:7], a[156:159], v[140:143], v[4:7]
  v_max_f32 v192, v192, v245
  v_max_f32 v196, v196, v246
  v_mfma_f32_16x16x32_bf16 v[12:15], a[156:159], v[156:159], 0
  ds_read_b128 a[136:139], v214 offset:8192
  v_sub_f32 v193, 0, v192
  v_mfma_f32_16x16x32_bf16 v[12:15], a[152:155], v[152:155], v[12:15]
  v_sub_f32 v197, 0, v196
  v_sub_f32 v194, 0, v192
  v_mfma_f32_16x16x32_bf16 v[12:15], a[148:151], v[148:151], v[12:15]
  ds_read_b128 a[140:143], v215 offset:8192
  v_sub_f32 v198, 0, v196
  v_mfma_f32_16x16x32_bf16 v[12:15], a[144:147], v[144:147], v[12:15]
  v_sub_f32 v195, 0, v192
  v_sub_f32 v199, 0, v196
  v_mfma_f32_16x16x32_bf16 v[20:23], a[144:147], v[160:163], 0
  buffer_load_dwordx4 v234, s[12:15], s29 offen offset:2048 lds
  v_mfma_f32_16x16x32_bf16 v[20:23], a[148:151], v[164:167], v[20:23]
  v_sub_f32 v192, 0, v192
  v_sub_f32 v196, 0, v196
  v_mfma_f32_16x16x32_bf16 v[20:23], a[152:155], v[168:171], v[20:23]
  buffer_load_dwordx4 v235, s[12:15], s29 offen offset:3072 lds
  v_mfma_f32_16x16x32_bf16 v[20:23], a[156:159], v[172:175], v[20:23]
  v_max3_f32 v200, v16, v17, v18
  v_max3_f32 v204, v24, v25, v26
  v_mfma_f32_16x16x32_bf16 v[28:31], a[156:159], v[188:191], 0
  v_max_f32 v200, v200, v19
  v_max_f32 v204, v204, v27
  v_mfma_f32_16x16x32_bf16 v[28:31], a[152:155], v[184:187], v[28:31]
  v_mov_b32 v247, v200
  v_mov_b32 v248, v204
  v_mfma_f32_16x16x32_bf16 v[28:31], a[148:151], v[180:183], v[28:31]
  v_permlane16_swap_b32 v200, v247
  v_permlane16_swap_b32 v204, v248
  v_max_f32 v200, v200, v247
  v_max_f32 v204, v204, v248
  v_mov_b32 v247, v200
  v_mov_b32 v248, v204
  s_nop 0
  v_permlane32_swap_b32 v200, v247
  v_permlane32_swap_b32 v204, v248
  v_max_f32 v200, v200, v247
  v_max_f32 v204, v204, v248
  v_sub_f32 v201, 0, v200
  v_sub_f32 v205, 0, v204
  v_sub_f32 v202, 0, v200
  v_sub_f32 v206, 0, v204
  v_sub_f32 v203, 0, v200
  v_sub_f32 v207, 0, v204
  v_sub_f32 v200, 0, v200
  v_sub_f32 v204, 0, v204
  v_mfma_f32_16x16x32_bf16 v[28:31], a[144:147], v[176:179], v[28:31]
  s_waitcnt lgkmcnt(0)
  v_add_f32 v0, v192, v0
  v_add_f32 v1, v192, v1
  v_mfma_f32_16x16x32_bf16 v[32:35], a[128:131], v[128:131], v[192:195]
  ds_read_b128 a[144:147], v212 offset:12288
  v_add_f32 v2, v192, v2
  v_mfma_f32_16x16x32_bf16 v[32:35], a[132:135], v[132:135], v[32:35]
  v_add_f32 v3, v192, v3
  v_mfma_f32_16x16x32_bf16 v[32:35], a[136:139], v[136:139], v[32:35]
  ds_read_b128 a[148:151], v213 offset:12288
  v_mfma_f32_16x16x32_bf16 v[32:35], a[140:143], v[140:143], v[32:35]
  v_exp_f32 v0, v0
  v_mfma_f32_16x16x32_bf16 v[40:43], a[140:143], v[156:159], v[196:199]
  ds_read_b128 a[152:155], v214 offset:12288
  v_mfma_f32_16x16x32_bf16 v[40:43], a[136:139], v[152:155], v[40:43]
  v_exp_f32 v1, v1
  v_mfma_f32_16x16x32_bf16 v[40:43], a[132:135], v[148:151], v[40:43]
  ds_read_b128 a[156:159], v215 offset:12288
  v_mfma_f32_16x16x32_bf16 v[40:43], a[128:131], v[144:147], v[40:43]
  v_exp_f32 v2, v2
  v_mfma_f32_16x16x32_bf16 v[48:51], a[128:131], v[160:163], v[200:203]
  s_add_u32 m0, s50, 0
  v_cvt_pk_bf16_f32 v0, v0, v1
  v_mfma_f32_16x16x32_bf16 v[48:51], a[132:135], v[164:167], v[48:51]
  v_exp_f32 v3, v3
  v_mfma_f32_16x16x32_bf16 v[48:51], a[136:139], v[168:171], v[48:51]
  v_add_f32 v8, v196, v8
  v_add_f32 v9, v196, v9
  v_mfma_f32_16x16x32_bf16 v[48:51], a[140:143], v[172:175], v[48:51]
  v_add_f32 v10, v196, v10
  v_add_f32 v11, v196, v11
  v_mfma_f32_16x16x32_bf16 v[56:59], a[140:143], v[188:191], v[204:207]
  v_exp_f32 v8, v8
  v_mfma_f32_16x16x32_bf16 v[56:59], a[136:139], v[184:187], v[56:59]
  v_exp_f32 v9, v9
  buffer_load_dwordx4 v226, s[20:23], s35 offen lds
  v_mfma_f32_16x16x32_bf16 v[56:59], a[132:135], v[180:183], v[56:59]
  v_exp_f32 v10, v10
  v_mfma_f32_16x16x32_bf16 v[56:59], a[128:131], v[176:179], v[56:59]
  s_waitcnt lgkmcnt(0)
  v_cvt_pk_bf16_f32 v8, v8, v9
  v_mfma_f32_16x16x32_bf16 v[36:39], a[144:147], v[128:131], v[192:195]
  s_waitcnt vmcnt(9)
  v_exp_f32 v11, v11
  v_mfma_f32_16x16x32_bf16 v[36:39], a[148:151], v[132:135], v[36:39]
  s_barrier
  v_cvt_pk_bf16_f32 v1, v2, v3
  v_add_f32 v16, v200, v16
  v_mfma_f32_16x16x32_bf16 v[36:39], a[152:155], v[136:139], v[36:39]
  ds_read_b128 a[128:131], v212 offset:16384
  v_add_f32 v17, v200, v17
  v_mfma_f32_16x16x32_bf16 v[36:39], a[156:159], v[140:143], v[36:39]
  v_add_f32 v18, v200, v18
  v_add_f32 v19, v200, v19
  v_mfma_f32_16x16x32_bf16 v[44:47], a[156:159], v[156:159], v[196:199]
  ds_read_b128 a[132:135], v213 offset:16384
  v_mfma_f32_16x16x32_bf16 v[44:47], a[152:155], v[152:155], v[44:47]
  v_exp_f32 v16, v16
  v_mfma_f32_16x16x32_bf16 v[44:47], a[148:151], v[148:151], v[44:47]
  ds_read_b128 a[136:139], v214 offset:16384
  v_mfma_f32_16x16x32_bf16 v[44:47], a[144:147], v[144:147], v[44:47]
  v_exp_f32 v17, v17
  v_mfma_f32_16x16x32_bf16 v[52:55], a[144:147], v[160:163], v[200:203]
  ds_read_b128 a[140:143], v215 offset:16384
  v_mfma_f32_16x16x32_bf16 v[52:55], a[148:151], v[164:167], v[52:55]
  v_exp_f32 v18, v18
  v_mfma_f32_16x16x32_bf16 v[52:55], a[152:155], v[168:171], v[52:55]
  v_cvt_pk_bf16_f32 v16, v16, v17
  v_mfma_f32_16x16x32_bf16 v[52:55], a[156:159], v[172:175], v[52:55]
  v_exp_f32 v19, v19
  v_mfma_f32_16x16x32_bf16 v[60:63], a[156:159], v[188:191], v[204:207]
  v_cvt_pk_bf16_f32 v9, v10, v11
  v_add_f32 v24, v204, v24
  v_mfma_f32_16x16x32_bf16 v[60:63], a[152:155], v[184:187], v[60:63]
  v_add_f32 v25, v204, v25
  v_add_f32 v26, v204, v26
  v_mfma_f32_16x16x32_bf16 v[60:63], a[148:151], v[180:183], v[60:63]
  v_add_f32 v27, v204, v27
  v_mfma_f32_16x16x32_bf16 v[60:63], a[144:147], v[176:179], v[60:63]
  s_waitcnt lgkmcnt(0)
  v_exp_f32 v24, v24
  v_exp_f32 v25, v25
  v_exp_f32 v26, v26
  v_cvt_pk_bf16_f32 v24, v24, v25
  v_exp_f32 v27, v27
  v_cvt_pk_bf16_f32 v17, v18, v19
  v_add_f32 v4, v192, v4
  v_add_f32 v5, v192, v5
  v_add_f32 v6, v192, v6
  v_add_f32 v7, v192, v7
  v_exp_f32 v4, v4
  v_exp_f32 v5, v5
  v_exp_f32 v6, v6
  v_cvt_pk_bf16_f32 v2, v4, v5
  v_exp_f32 v7, v7
  v_cvt_pk_bf16_f32 v25, v26, v27
  v_add_f32 v12, v196, v12
  v_add_f32 v13, v196, v13
  v_add_f32 v14, v196, v14
  v_add_f32 v15, v196, v15
  v_exp_f32 v12, v12
  v_exp_f32 v13, v13
  v_exp_f32 v14, v14
  v_cvt_pk_bf16_f32 v10, v12, v13
  v_exp_f32 v15, v15
  v_cvt_pk_bf16_f32 v3, v6, v7
  v_add_f32 v20, v200, v20
  v_add_f32 v21, v200, v21
  v_add_f32 v22, v200, v22
  v_add_f32 v23, v200, v23
  v_exp_f32 v20, v20
  v_exp_f32 v21, v21
  v_exp_f32 v22, v22
  v_cvt_pk_bf16_f32 v18, v20, v21
  v_exp_f32 v23, v23
  v_cvt_pk_bf16_f32 v11, v14, v15
  v_add_f32 v28, v204, v28
  v_add_f32 v29, v204, v29
  v_add_f32 v30, v204, v30
  v_add_f32 v31, v204, v31
  v_exp_f32 v28, v28
  v_exp_f32 v29, v29
  v_exp_f32 v30, v30
  v_cvt_pk_bf16_f32 v26, v28, v29
  v_exp_f32 v31, v31
  v_cvt_pk_bf16_f32 v19, v22, v23
  v_exp_f32 v32, v32
  v_exp_f32 v33, v33
  v_exp_f32 v34, v34
  v_cvt_pk_bf16_f32 v32, v32, v33
  v_exp_f32 v35, v35
  v_cvt_pk_bf16_f32 v27, v30, v31
  v_exp_f32 v40, v40
  v_exp_f32 v41, v41
  v_exp_f32 v42, v42
  v_cvt_pk_bf16_f32 v40, v40, v41
  v_exp_f32 v43, v43
  v_cvt_pk_bf16_f32 v33, v34, v35
  v_exp_f32 v48, v48
  v_exp_f32 v49, v49
  v_exp_f32 v50, v50
  v_cvt_pk_bf16_f32 v48, v48, v49
  v_exp_f32 v51, v51
  v_cvt_pk_bf16_f32 v41, v42, v43
  v_exp_f32 v56, v56
  v_exp_f32 v57, v57
  v_exp_f32 v58, v58
  v_cvt_pk_bf16_f32 v56, v56, v57
  v_exp_f32 v59, v59
  v_cvt_pk_bf16_f32 v49, v50, v51
  v_exp_f32 v36, v36
  v_exp_f32 v37, v37
  v_exp_f32 v38, v38
  v_cvt_pk_bf16_f32 v34, v36, v37
  v_exp_f32 v39, v39
  v_cvt_pk_bf16_f32 v57, v58, v59
  v_exp_f32 v44, v44
  v_exp_f32 v45, v45
  v_exp_f32 v46, v46
  v_cvt_pk_bf16_f32 v42, v44, v45
  v_exp_f32 v47, v47
  v_cvt_pk_bf16_f32 v35, v38, v39
  v_exp_f32 v52, v52
  v_exp_f32 v53, v53
  v_exp_f32 v54, v54
  v_cvt_pk_bf16_f32 v50, v52, v53
  v_exp_f32 v55, v55
  v_cvt_pk_bf16_f32 v43, v46, v47
  v_exp_f32 v60, v60
  v_exp_f32 v61, v61
  v_exp_f32 v62, v62
  v_cvt_pk_bf16_f32 v58, v60, v61
  v_exp_f32 v63, v63
  v_cvt_pk_bf16_f32 v51, v54, v55
  v_cvt_pk_bf16_f32 v59, v62, v63
  v_mfma_f32_16x16x32_bf16 v[64:67], a[128:131], v[128:131], v[192:195]
  s_add_u32 m0, s28, 98304
  v_mfma_f32_16x16x32_bf16 v[64:67], a[132:135], v[132:135], v[64:67]
  ds_read_b128 a[144:147], v212 offset:20480
  v_mfma_f32_16x16x32_bf16 v[64:67], a[136:139], v[136:139], v[64:67]
  buffer_load_dwordx4 v236, s[16:19], s29 offen offset:0 lds
  v_mfma_f32_16x16x32_bf16 v[64:67], a[140:143], v[140:143], v[64:67]
  ds_read_b128 a[148:151], v213 offset:20480
  v_mfma_f32_16x16x32_bf16 v[72:75], a[140:143], v[156:159], v[196:199]
  buffer_load_dwordx4 v237, s[16:19], s29 offen offset:1024 lds
  v_mfma_f32_16x16x32_bf16 v[72:75], a[136:139], v[152:155], v[72:75]
  ds_read_b128 a[152:155], v214 offset:20480
  v_mfma_f32_16x16x32_bf16 v[72:75], a[132:135], v[148:151], v[72:75]
  buffer_load_dwordx4 v236, s[16:19], s29 offen offset:2048 lds
  v_mfma_f32_16x16x32_bf16 v[72:75], a[128:131], v[144:147], v[72:75]
  ds_read_b128 a[156:159], v215 offset:20480
  v_mfma_f32_16x16x32_bf16 v[80:83], a[128:131], v[160:163], v[200:203]
  v_exp_f32 v64, v64
  v_mfma_f32_16x16x32_bf16 v[80:83], a[132:135], v[164:167], v[80:83]
  buffer_load_dwordx4 v237, s[16:19], s29 offen offset:3072 lds
  v_mfma_f32_16x16x32_bf16 v[80:83], a[136:139], v[168:171], v[80:83]
  s_add_u32 s29, s29, 16384
  v_exp_f32 v65, v65
  v_mfma_f32_16x16x32_bf16 v[80:83], a[140:143], v[172:175], v[80:83]
  v_cvt_pk_bf16_f32 v64, v64, v65
  v_mfma_f32_16x16x32_bf16 v[88:91], a[140:143], v[188:191], v[204:207]
  s_add_u32 m0, s28, 49152
  v_exp_f32 v66, v66
  v_mfma_f32_16x16x32_bf16 v[88:91], a[136:139], v[184:187], v[88:91]
  buffer_load_dwordx4 v232, s[12:15], s29 offen offset:0 lds
  v_mfma_f32_16x16x32_bf16 v[88:91], a[132:135], v[180:183], v[88:91]
  s_waitcnt lgkmcnt(0)
  v_exp_f32 v67, v67
  v_mfma_f32_16x16x32_bf16 v[88:91], a[128:131], v[176:179], v[88:91]
  v_cvt_pk_bf16_f32 v65, v66, v67
  v_mfma_f32_16x16x32_bf16 v[68:71], a[144:147], v[128:131], v[192:195]
  v_exp_f32 v72, v72
  v_mfma_f32_16x16x32_bf16 v[68:71], a[148:151], v[132:135], v[68:71]
  ds_read_b128 a[128:131], v212 offset:24576
  v_mfma_f32_16x16x32_bf16 v[68:71], a[152:155], v[136:139], v[68:71]
  v_exp_f32 v73, v73
  v_mfma_f32_16x16x32_bf16 v[68:71], a[156:159], v[140:143], v[68:71]
  ds_read_b128 a[132:135], v213 offset:24576
  v_cvt_pk_bf16_f32 v72, v72, v73
  v_mfma_f32_16x16x32_bf16 v[76:79], a[156:159], v[156:159], v[196:199]
  v_exp_f32 v74, v74
  v_mfma_f32_16x16x32_bf16 v[76:79], a[152:155], v[152:155], v[76:79]
  ds_read_b128 a[136:139], v214 offset:24576
  v_mfma_f32_16x16x32_bf16 v[76:79], a[148:151], v[148:151], v[76:79]
  v_exp_f32 v75, v75
  v_mfma_f32_16x16x32_bf16 v[76:79], a[144:147], v[144:147], v[76:79]
  ds_read_b128 a[140:143], v215 offset:24576
  v_cvt_pk_bf16_f32 v73, v74, v75
  v_mfma_f32_16x16x32_bf16 v[84:87], a[144:147], v[160:163], v[200:203]
  v_exp_f32 v80, v80
  v_mfma_f32_16x16x32_bf16 v[84:87], a[148:151], v[164:167], v[84:87]
  buffer_load_dwordx4 v233, s[12:15], s29 offen offset:1024 lds
  v_mfma_f32_16x16x32_bf16 v[84:87], a[152:155], v[168:171], v[84:87]
  v_exp_f32 v81, v81
  v_mfma_f32_16x16x32_bf16 v[84:87], a[156:159], v[172:175], v[84:87]
  v_cvt_pk_bf16_f32 v80, v80, v81
  v_mfma_f32_16x16x32_bf16 v[92:95], a[156:159], v[188:191], v[204:207]
  v_exp_f32 v82, v82
  v_mfma_f32_16x16x32_bf16 v[92:95], a[152:155], v[184:187], v[92:95]
  buffer_load_dwordx4 v234, s[12:15], s29 offen offset:2048 lds
  v_mfma_f32_16x16x32_bf16 v[92:95], a[148:151], v[180:183], v[92:95]
  s_waitcnt lgkmcnt(0)
  v_exp_f32 v83, v83
  v_mfma_f32_16x16x32_bf16 v[92:95], a[144:147], v[176:179], v[92:95]
  v_cvt_pk_bf16_f32 v81, v82, v83
  v_mfma_f32_16x16x32_bf16 v[96:99], a[128:131], v[128:131], v[192:195]
  v_exp_f32 v88, v88
  v_mfma_f32_16x16x32_bf16 v[96:99], a[132:135], v[132:135], v[96:99]
  ds_read_b128 a[144:147], v212 offset:28672
  v_mfma_f32_16x16x32_bf16 v[96:99], a[136:139], v[136:139], v[96:99]
  v_exp_f32 v89, v89
  v_mfma_f32_16x16x32_bf16 v[96:99], a[140:143], v[140:143], v[96:99]
  ds_read_b128 a[148:151], v213 offset:28672
  v_cvt_pk_bf16_f32 v88, v88, v89
  v_mfma_f32_16x16x32_bf16 v[104:107], a[140:143], v[156:159], v[196:199]
  v_exp_f32 v90, v90
  v_mfma_f32_16x16x32_bf16 v[104:107], a[136:139], v[152:155], v[104:107]
  ds_read_b128 a[152:155], v214 offset:28672
  v_mfma_f32_16x16x32_bf16 v[104:107], a[132:135], v[148:151], v[104:107]
  v_exp_f32 v91, v91
  v_mfma_f32_16x16x32_bf16 v[104:107], a[128:131], v[144:147], v[104:107]
  ds_read_b128 a[156:159], v215 offset:28672
  v_cvt_pk_bf16_f32 v89, v90, v91
  v_mfma_f32_16x16x32_bf16 v[112:115], a[128:131], v[160:163], v[200:203]
  v_exp_f32 v68, v68
  v_mfma_f32_16x16x32_bf16 v[112:115], a[132:135], v[164:167], v[112:115]
  buffer_load_dwordx4 v235, s[12:15], s29 offen offset:3072 lds
  v_mfma_f32_16x16x32_bf16 v[112:115], a[136:139], v[168:171], v[112:115]
  v_exp_f32 v69, v69
  v_mfma_f32_16x16x32_bf16 v[112:115], a[140:143], v[172:175], v[112:115]
  v_cvt_pk_bf16_f32 v66, v68, v69
  v_mfma_f32_16x16x32_bf16 v[120:123], a[140:143], v[188:191], v[204:207]
  v_exp_f32 v70, v70
  v_mfma_f32_16x16x32_bf16 v[120:123], a[136:139], v[184:187], v[120:123]
  s_add_u32 m0, s50, 3072
  v_mfma_f32_16x16x32_bf16 v[120:123], a[132:135], v[180:183], v[120:123]
  s_waitcnt lgkmcnt(0)
  v_exp_f32 v71, v71
  v_mfma_f32_16x16x32_bf16 v[120:123], a[128:131], v[176:179], v[120:123]
  buffer_load_dwordx4 v226, s[44:47], s35 offen lds
  s_add_u32 s35, s35, 221184
  v_cvt_pk_bf16_f32 v67, v70, v71
  v_mfma_f32_16x16x32_bf16 v[100:103], a[144:147], v[128:131], v[192:195]
  v_exp_f32 v76, v76
  v_mfma_f32_16x16x32_bf16 v[100:103], a[148:151], v[132:135], v[100:103]
  ds_read_b64_tr_b16 a[160:161], v216 offset:0
  v_mfma_f32_16x16x32_bf16 v[100:103], a[152:155], v[136:139], v[100:103]
  v_exp_f32 v77, v77
  v_mfma_f32_16x16x32_bf16 v[100:103], a[156:159], v[140:143], v[100:103]
  ds_read_b64_tr_b16 a[162:163], v216 offset:4096
  v_cvt_pk_bf16_f32 v74, v76, v77
  v_mfma_f32_16x16x32_bf16 v[108:111], a[156:159], v[156:159], v[196:199]
  v_exp_f32 v78, v78
  v_mfma_f32_16x16x32_bf16 v[108:111], a[152:155], v[152:155], v[108:111]
  ds_read_b64_tr_b16 a[164:165], v216 offset:8192
  v_mfma_f32_16x16x32_bf16 v[108:111], a[148:151], v[148:151], v[108:111]
  v_exp_f32 v79, v79
  v_mfma_f32_16x16x32_bf16 v[108:111], a[144:147], v[144:147], v[108:111]
  ds_read_b64_tr_b16 a[166:167], v216 offset:12288
  v_cvt_pk_bf16_f32 v75, v78, v79
  v_mfma_f32_16x16x32_bf16 v[116:119], a[144:147], v[160:163], v[200:203]
  v_exp_f32 v84, v84
  v_mfma_f32_16x16x32_bf16 v[116:119], a[148:151], v[164:167], v[116:119]
  ds_read_b64_tr_b16 a[168:169], v217 offset:0
  v_mfma_f32_16x16x32_bf16 v[116:119], a[152:155], v[168:171], v[116:119]
  v_exp_f32 v85, v85
  v_mfma_f32_16x16x32_bf16 v[116:119], a[156:159], v[172:175], v[116:119]
  ds_read_b64_tr_b16 a[170:171], v217 offset:4096
  v_cvt_pk_bf16_f32 v82, v84, v85
  v_mfma_f32_16x16x32_bf16 v[124:127], a[156:159], v[188:191], v[204:207]
  v_exp_f32 v86, v86
  v_mfma_f32_16x16x32_bf16 v[124:127], a[152:155], v[184:187], v[124:127]
  ds_read_b64_tr_b16 a[172:173], v217 offset:8192
  v_mfma_f32_16x16x32_bf16 v[124:127], a[148:151], v[180:183], v[124:127]
  v_exp_f32 v87, v87
  v_mfma_f32_16x16x32_bf16 v[124:127], a[144:147], v[176:179], v[124:127]
  ds_read_b64_tr_b16 a[174:175], v217 offset:12288
  v_cvt_pk_bf16_f32 v83, v86, v87
  v_mfma_f32_16x16x32_bf16 a[192:195], a[208:211], v[0:3], 0
  v_exp_f32 v92, v92
  v_mfma_f32_16x16x32_bf16 a[192:195], a[208:211], v[32:35], a[192:195]
  ds_read_b64_tr_b16 a[176:177], v218 offset:0
  v_mfma_f32_16x16x32_bf16 a[196:199], a[208:211], v[8:11], 0
  v_exp_f32 v93, v93
  v_mfma_f32_16x16x32_bf16 a[196:199], a[208:211], v[40:43], a[196:199]
  ds_read_b64_tr_b16 a[178:179], v218 offset:4096
  v_cvt_pk_bf16_f32 v90, v92, v93
  v_mfma_f32_16x16x32_bf16 a[200:203], a[208:211], v[16:19], 0
  v_exp_f32 v94, v94
  v_mfma_f32_16x16x32_bf16 a[200:203], a[208:211], v[48:51], a[200:203]
  ds_read_b64_tr_b16 a[180:181], v218 offset:8192
  v_mfma_f32_16x16x32_bf16 a[204:207], a[208:211], v[24:27], 0
  s_waitcnt lgkmcnt(7)
  v_exp_f32 v95, v95
  v_mfma_f32_16x16x32_bf16 a[204:207], a[208:211], v[56:59], a[204:207]
  ds_read_b64_tr_b16 a[182:183], v218 offset:12288
  v_cvt_pk_bf16_f32 v91, v94, v95
  v_mfma_f32_16x16x32_bf16 a[0:3], a[160:163], v[0:3], 0
  v_exp_f32 v96, v96
  v_mfma_f32_16x16x32_bf16 a[0:3], a[164:167], v[32:35], a[0:3]
  ds_read_b64_tr_b16 a[184:185], v219 offset:0
  v_mfma_f32_16x16x32_bf16 a[4:7], a[164:167], v[40:43], 0
  v_exp_f32 v97, v97
  v_mfma_f32_16x16x32_bf16 a[4:7], a[160:163], v[8:11], a[4:7]
  ds_read_b64_tr_b16 a[186:187], v219 offset:4096
  v_cvt_pk_bf16_f32 v96, v96, v97
  v_mfma_f32_16x16x32_bf16 a[8:11], a[160:163], v[16:19], 0
  v_exp_f32 v98, v98
  v_mfma_f32_16x16x32_bf16 a[8:11], a[164:167], v[48:51], a[8:11]
  ds_read_b64_tr_b16 a[188:189], v219 offset:8192
  v_mfma_f32_16x16x32_bf16 a[12:15], a[164:167], v[56:59], 0
  s_waitcnt lgkmcnt(7)
  v_exp_f32 v99, v99
  v_mfma_f32_16x16x32_bf16 a[12:15], a[160:163], v[24:27], a[12:15]
  ds_read_b64_tr_b16 a[190:191], v219 offset:12288
  v_cvt_pk_bf16_f32 v97, v98, v99
  v_mfma_f32_16x16x32_bf16 a[16:19], a[168:171], v[0:3], 0
  v_exp_f32 v104, v104
  v_mfma_f32_16x16x32_bf16 a[16:19], a[172:175], v[32:35], a[16:19]
  ds_read_b64_tr_b16 a[160:161], v220 offset:0
  v_mfma_f32_16x16x32_bf16 a[20:23], a[172:175], v[40:43], 0
  v_exp_f32 v105, v105
  v_mfma_f32_16x16x32_bf16 a[20:23], a[168:171], v[8:11], a[20:23]
  ds_read_b64_tr_b16 a[162:163], v220 offset:4096
  v_cvt_pk_bf16_f32 v104, v104, v105
  v_mfma_f32_16x16x32_bf16 a[24:27], a[168:171], v[16:19], 0
  v_exp_f32 v106, v106
  v_mfma_f32_16x16x32_bf16 a[24:27], a[172:175], v[48:51], a[24:27]
  ds_read_b64_tr_b16 a[164:165], v220 offset:8192
  v_mfma_f32_16x16x32_bf16 a[28:31], a[172:175], v[56:59], 0
  s_waitcnt lgkmcnt(7)
  v_exp_f32 v107, v107
  v_mfma_f32_16x16x32_bf16 a[28:31], a[168:171], v[24:27], a[28:31]
  ds_read_b64_tr_b16 a[166:167], v220 offset:12288
  v_cvt_pk_bf16_f32 v105, v106, v107
  v_mfma_f32_16x16x32_bf16 a[32:35], a[176:179], v[0:3], 0
  v_exp_f32 v112, v112
  v_mfma_f32_16x16x32_bf16 a[32:35], a[180:183], v[32:35], a[32:35]
  ds_read_b64_tr_b16 a[168:169], v221 offset:0
  v_mfma_f32_16x16x32_bf16 a[36:39], a[180:183], v[40:43], 0
  v_exp_f32 v113, v113
  v_mfma_f32_16x16x32_bf16 a[36:39], a[176:179], v[8:11], a[36:39]
  ds_read_b64_tr_b16 a[170:171], v221 offset:4096
  v_cvt_pk_bf16_f32 v112, v112, v113
  v_mfma_f32_16x16x32_bf16 a[40:43], a[176:179], v[16:19], 0
  v_exp_f32 v114, v114
  v_mfma_f32_16x16x32_bf16 a[40:43], a[180:183], v[48:51], a[40:43]
  ds_read_b64_tr_b16 a[172:173], v221 offset:8192
  v_mfma_f32_16x16x32_bf16 a[44:47], a[180:183], v[56:59], 0
  s_waitcnt lgkmcnt(7)
  v_exp_f32 v115, v115
  v_mfma_f32_16x16x32_bf16 a[44:47], a[176:179], v[24:27], a[44:47]
  ds_read_b64_tr_b16 a[174:175], v221 offset:12288
  v_cvt_pk_bf16_f32 v113, v114, v115
  v_mfma_f32_16x16x32_bf16 a[48:51], a[184:187], v[0:3], 0
  v_exp_f32 v120, v120
  v_mfma_f32_16x16x32_bf16 a[48:51], a[188:191], v[32:35], a[48:51]
  ds_read_b64_tr_b16 a[176:177], v222 offset:0
  v_mfma_f32_16x16x32_bf16 a[52:55], a[188:191], v[40:43], 0
  v_exp_f32 v121, v121
  v_mfma_f32_16x16x32_bf16 a[52:55], a[184:187], v[8:11], a[52:55]
  ds_read_b64_tr_b16 a[178:179], v222 offset:4096
  v_cvt_pk_bf16_f32 v120, v120, v121
  v_mfma_f32_16x16x32_bf16 a[56:59], a[184:187], v[16:19], 0
  v_exp_f32 v122, v122
  v_mfma_f32_16x16x32_bf16 a[56:59], a[188:191], v[48:51], a[56:59]
  ds_read_b64_tr_b16 a[180:181], v222 offset:8192
  v_mfma_f32_16x16x32_bf16 a[60:63], a[188:191], v[56:59], 0
  s_waitcnt lgkmcnt(7)
  v_exp_f32 v123, v123
  v_mfma_f32_16x16x32_bf16 a[60:63], a[184:187], v[24:27], a[60:63]
  ds_read_b64_tr_b16 a[182:183], v222 offset:12288
  v_cvt_pk_bf16_f32 v121, v122, v123
  v_mfma_f32_16x16x32_bf16 a[64:67], a[160:163], v[0:3], 0
  v_exp_f32 v100, v100
  v_mfma_f32_16x16x32_bf16 a[64:67], a[164:167], v[32:35], a[64:67]
  ds_read_b64_tr_b16 a[184:185], v223 offset:0
  v_mfma_f32_16x16x32_bf16 a[68:71], a[164:167], v[40:43], 0
  v_exp_f32 v101, v101
  v_mfma_f32_16x16x32_bf16 a[68:71], a[160:163], v[8:11], a[68:71]
  ds_read_b64_tr_b16 a[186:187], v223 offset:4096
  v_cvt_pk_bf16_f32 v98, v100, v101
  v_mfma_f32_16x16x32_bf16 a[72:75], a[160:163], v[16:19], 0
  v_exp_f32 v102, v102
  v_mfma_f32_16x16x32_bf16 a[72:75], a[164:167], v[48:51], a[72:75]
  ds_read_b64_tr_b16 a[188:189], v223 offset:8192
  v_mfma_f32_16x16x32_bf16 a[76:79], a[164:167], v[56:59], 0
  s_waitcnt lgkmcnt(7)
  v_exp_f32 v103, v103
  v_mfma_f32_16x16x32_bf16 a[76:79], a[160:163], v[24:27], a[76:79]
  ds_read_b64_tr_b16 a[190:191], v223 offset:12288
  v_cvt_pk_bf16_f32 v99, v102, v103
  v_mfma_f32_16x16x32_bf16 a[80:83], a[168:171], v[0:3], 0
  s_waitcnt vmcnt(10)
  v_exp_f32 v108, v108
  v_mfma_f32_16x16x32_bf16 a[80:83], a[172:175], v[32:35], a[80:83]
  v_mfma_f32_16x16x32_bf16 a[84:87], a[172:175], v[40:43], 0
  s_barrier
  v_exp_f32 v109, v109
  v_mfma_f32_16x16x32_bf16 a[84:87], a[168:171], v[8:11], a[84:87]
  ds_read_b128 a[128:131], v212 offset:32768
  v_cvt_pk_bf16_f32 v106, v108, v109
  v_mfma_f32_16x16x32_bf16 a[88:91], a[168:171], v[16:19], 0
  v_exp_f32 v110, v110
  v_mfma_f32_16x16x32_bf16 a[88:91], a[172:175], v[48:51], a[88:91]
  ds_read_b128 a[132:135], v213 offset:32768
  v_mfma_f32_16x16x32_bf16 a[92:95], a[172:175], v[56:59], 0
  s_waitcnt lgkmcnt(6)
  v_exp_f32 v111, v111
  v_mfma_f32_16x16x32_bf16 a[92:95], a[168:171], v[24:27], a[92:95]
  ds_read_b128 a[136:139], v214 offset:32768
  v_cvt_pk_bf16_f32 v107, v110, v111
  v_mfma_f32_16x16x32_bf16 a[96:99], a[176:179], v[0:3], 0
  s_mul_i32 s38, s3, 20480
  v_exp_f32 v116, v116
  v_mfma_f32_16x16x32_bf16 a[96:99], a[180:183], v[32:35], a[96:99]
  ds_read_b128 a[140:143], v215 offset:32768
  buffer_load_dwordx4 a[212:215], v243, s[24:27], s38 offen sc1
  s_add_u32 s38, s38, 4096
  v_mfma_f32_16x16x32_bf16 a[100:103], a[180:183], v[40:43], 0
  v_exp_f32 v117, v117
  v_mfma_f32_16x16x32_bf16 a[100:103], a[176:179], v[8:11], a[100:103]
  v_cvt_pk_bf16_f32 v114, v116, v117
  v_mfma_f32_16x16x32_bf16 a[104:107], a[176:179], v[16:19], 0
  v_exp_f32 v118, v118
  v_mfma_f32_16x16x32_bf16 a[104:107], a[180:183], v[48:51], a[104:107]
  v_mfma_f32_16x16x32_bf16 a[108:111], a[180:183], v[56:59], 0
  s_waitcnt lgkmcnt(4)
  v_exp_f32 v119, v119
  v_mfma_f32_16x16x32_bf16 a[108:111], a[176:179], v[24:27], a[108:111]
  v_cvt_pk_bf16_f32 v115, v118, v119
  v_mfma_f32_16x16x32_bf16 a[112:115], a[184:187], v[0:3], 0
  v_exp_f32 v124, v124
  v_mfma_f32_16x16x32_bf16 a[112:115], a[188:191], v[32:35], a[112:115]
  v_mfma_f32_16x16x32_bf16 a[116:119], a[188:191], v[40:43], 0
  v_exp_f32 v125, v125
  v_mfma_f32_16x16x32_bf16 a[116:119], a[184:187], v[8:11], a[116:119]
  v_cvt_pk_bf16_f32 v122, v124, v125
  v_mfma_f32_16x16x32_bf16 a[120:123], a[184:187], v[16:19], 0
  v_exp_f32 v126, v126
  v_mfma_f32_16x16x32_bf16 a[120:123], a[188:191], v[48:51], a[120:123]
  v_mfma_f32_16x16x32_bf16 a[124:127], a[188:191], v[56:59], 0
  s_waitcnt lgkmcnt(0)
  v_exp_f32 v127, v127
  v_mfma_f32_16x16x32_bf16 a[124:127], a[184:187], v[24:27], a[124:127]
  v_cvt_pk_bf16_f32 v123, v126, v127
  v_mfma_f32_16x16x32_bf16 v[0:3], a[128:131], v[128:131], v[192:195]
  s_add_u32 m0, s28, 114688
  v_mfma_f32_16x16x32_bf16 v[0:3], a[132:135], v[132:135], v[0:3]
  ds_read_b128 a[144:147], v212 offset:36864
  v_mfma_f32_16x16x32_bf16 v[0:3], a[136:139], v[136:139], v[0:3]
  buffer_load_dwordx4 v236, s[16:19], s29 offen offset:0 lds
  v_mfma_f32_16x16x32_bf16 v[0:3], a[140:143], v[140:143], v[0:3]
  ds_read_b128 a[148:151], v213 offset:36864
  v_mfma_f32_16x16x32_bf16 v[8:11], a[140:143], v[156:159], v[196:199]
  buffer_load_dwordx4 v237, s[16:19], s29 offen offset:1024 lds
  v_mfma_f32_16x16x32_bf16 v[8:11], a[136:139], v[152:155], v[8:11]
  ds_read_b128 a[152:155], v214 offset:36864
  v_mfma_f32_16x16x32_bf16 v[8:11], a[132:135], v[148:151], v[8:11]
  buffer_load_dwordx4 v236, s[16:19], s29 offen offset:2048 lds
  v_mfma_f32_16x16x32_bf16 v[8:11], a[128:131], v[144:147], v[8:11]
  ds_read_b128 a[156:159], v215 offset:36864
  v_mfma_f32_16x16x32_bf16 v[16:19], a[128:131], v[160:163], v[200:203]
  v_exp_f32 v0, v0
  v_mfma_f32_16x16x32_bf16 v[16:19], a[132:135], v[164:167], v[16:19]
  buffer_load_dwordx4 v237, s[16:19], s29 offen offset:3072 lds
  v_mfma_f32_16x16x32_bf16 v[16:19], a[136:139], v[168:171], v[16:19]
  s_add_u32 s29, s29, 16384
  v_exp_f32 v1, v1
  v_mfma_f32_16x16x32_bf16 v[16:19], a[140:143], v[172:175], v[16:19]
  v_cvt_pk_bf16_f32 v0, v0, v1
  v_mfma_f32_16x16x32_bf16 v[24:27], a[140:143], v[188:191], v[204:207]
  s_add_u32 m0, s28, 0
  v_exp_f32 v2, v2
  v_mfma_f32_16x16x32_bf16 v[24:27], a[136:139], v[184:187], v[24:27]
  buffer_load_dwordx4 v232, s[12:15], s29 offen offset:0 lds
  v_mfma_f32_16x16x32_bf16 v[24:27], a[132:135], v[180:183], v[24:27]
  s_waitcnt lgkmcnt(0)
  v_exp_f32 v3, v3
  v_mfma_f32_16x16x32_bf16 v[24:27], a[128:131], v[176:179], v[24:27]
  v_cvt_pk_bf16_f32 v1, v2, v3
  v_mfma_f32_16x16x32_bf16 v[4:7], a[144:147], v[128:131], v[192:195]
  v_exp_f32 v8, v8
  v_mfma_f32_16x16x32_bf16 v[4:7], a[148:151], v[132:135], v[4:7]
  ds_read_b128 a[128:131], v212 offset:40960
  v_mfma_f32_16x16x32_bf16 v[4:7], a[152:155], v[136:139], v[4:7]
  v_exp_f32 v9, v9
  v_mfma_f32_16x16x32_bf16 v[4:7], a[156:159], v[140:143], v[4:7]
  ds_read_b128 a[132:135], v213 offset:40960
  v_cvt_pk_bf16_f32 v8, v8, v9
  v_mfma_f32_16x16x32_bf16 v[12:15], a[156:159], v[156:159], v[196:199]
  v_exp_f32 v10, v10
  v_mfma_f32_16x16x32_bf16 v[12:15], a[152:155], v[152:155], v[12:15]
  ds_read_b128 a[136:139], v214 offset:40960
  v_mfma_f32_16x16x32_bf16 v[12:15], a[148:151], v[148:151], v[12:15]
  v_exp_f32 v11, v11
  v_mfma_f32_16x16x32_bf16 v[12:15], a[144:147], v[144:147], v[12:15]
  ds_read_b128 a[140:143], v215 offset:40960
  v_cvt_pk_bf16_f32 v9, v10, v11
  v_mfma_f32_16x16x32_bf16 v[20:23], a[144:147], v[160:163], v[200:203]
  v_exp_f32 v16, v16
  v_mfma_f32_16x16x32_bf16 v[20:23], a[148:151], v[164:167], v[20:23]
  buffer_load_dwordx4 v233, s[12:15], s29 offen offset:1024 lds
  v_mfma_f32_16x16x32_bf16 v[20:23], a[152:155], v[168:171], v[20:23]
  v_exp_f32 v17, v17
  v_mfma_f32_16x16x32_bf16 v[20:23], a[156:159], v[172:175], v[20:23]
  v_cvt_pk_bf16_f32 v16, v16, v17
  v_mfma_f32_16x16x32_bf16 v[28:31], a[156:159], v[188:191], v[204:207]
  v_exp_f32 v18, v18
  v_mfma_f32_16x16x32_bf16 v[28:31], a[152:155], v[184:187], v[28:31]
  buffer_load_dwordx4 v234, s[12:15], s29 offen offset:2048 lds
  v_mfma_f32_16x16x32_bf16 v[28:31], a[148:151], v[180:183], v[28:31]
  s_waitcnt lgkmcnt(0)
  v_exp_f32 v19, v19
  v_mfma_f32_16x16x32_bf16 v[28:31], a[144:147], v[176:179], v[28:31]
  v_cvt_pk_bf16_f32 v17, v18, v19
  v_mfma_f32_16x16x32_bf16 v[32:35], a[128:131], v[128:131], v[192:195]
  v_exp_f32 v24, v24
  v_mfma_f32_16x16x32_bf16 v[32:35], a[132:135], v[132:135], v[32:35]
  ds_read_b128 a[144:147], v212 offset:45056
  v_mfma_f32_16x16x32_bf16 v[32:35], a[136:139], v[136:139], v[32:35]
  v_exp_f32 v25, v25
  v_mfma_f32_16x16x32_bf16 v[32:35], a[140:143], v[140:143], v[32:35]
  ds_read_b128 a[148:151], v213 offset:45056
  v_cvt_pk_bf16_f32 v24, v24, v25
  v_mfma_f32_16x16x32_bf16 v[40:43], a[140:143], v[156:159], v[196:199]
  v_exp_f32 v26, v26
  v_mfma_f32_16x16x32_bf16 v[40:43], a[136:139], v[152:155], v[40:43]
  ds_read_b128 a[152:155], v214 offset:45056
  v_mfma_f32_16x16x32_bf16 v[40:43], a[132:135], v[148:151], v[40:43]
  v_exp_f32 v27, v27
  v_mfma_f32_16x16x32_bf16 v[40:43], a[128:131], v[144:147], v[40:43]
  ds_read_b128 a[156:159], v215 offset:45056
  v_cvt_pk_bf16_f32 v25, v26, v27
  v_mfma_f32_16x16x32_bf16 v[48:51], a[128:131], v[160:163], v[200:203]
  v_exp_f32 v4, v4
  v_mfma_f32_16x16x32_bf16 v[48:51], a[132:135], v[164:167], v[48:51]
  buffer_load_dwordx4 v235, s[12:15], s29 offen offset:3072 lds
  v_mfma_f32_16x16x32_bf16 v[48:51], a[136:139], v[168:171], v[48:51]
  v_exp_f32 v5, v5
  v_mfma_f32_16x16x32_bf16 v[48:51], a[140:143], v[172:175], v[48:51]
  v_cvt_pk_bf16_f32 v2, v4, v5
  v_mfma_f32_16x16x32_bf16 v[56:59], a[140:143], v[188:191], v[204:207]
  v_exp_f32 v6, v6
  v_mfma_f32_16x16x32_bf16 v[56:59], a[136:139], v[184:187], v[56:59]
  s_add_u32 m0, s50, 1024
  v_mfma_f32_16x16x32_bf16 v[56:59], a[132:135], v[180:183], v[56:59]
  s_waitcnt lgkmcnt(0)
  v_exp_f32 v7, v7
  v_mfma_f32_16x16x32_bf16 v[56:59], a[128:131], v[176:179], v[56:59]
  buffer_load_dwordx4 v226, s[20:23], s35 offen lds
  v_cvt_pk_bf16_f32 v3, v6, v7
  v_mfma_f32_16x16x32_bf16 v[36:39], a[144:147], v[128:131], v[192:195]
  v_exp_f32 v12, v12
  v_mfma_f32_16x16x32_bf16 v[36:39], a[148:151], v[132:135], v[36:39]
  ds_read_b64_tr_b16 a[160:161], v216 offset:16384
  v_mfma_f32_16x16x32_bf16 v[36:39], a[152:155], v[136:139], v[36:39]
  v_exp_f32 v13, v13
  v_mfma_f32_16x16x32_bf16 v[36:39], a[156:159], v[140:143], v[36:39]
  ds_read_b64_tr_b16 a[162:163], v216 offset:20480
  v_cvt_pk_bf16_f32 v10, v12, v13
  v_mfma_f32_16x16x32_bf16 v[44:47], a[156:159], v[156:159], v[196:199]
  v_exp_f32 v14, v14
  v_mfma_f32_16x16x32_bf16 v[44:47], a[152:155], v[152:155], v[44:47]
  ds_read_b64_tr_b16 a[164:165], v216 offset:24576
  v_mfma_f32_16x16x32_bf16 v[44:47], a[148:151], v[148:151], v[44:47]
  v_exp_f32 v15, v15
  v_mfma_f32_16x16x32_bf16 v[44:47], a[144:147], v[144:147], v[44:47]
  ds_read_b64_tr_b16 a[166:167], v216 offset:28672
  v_cvt_pk_bf16_f32 v11, v14, v15
  v_mfma_f32_16x16x32_bf16 v[52:55], a[144:147], v[160:163], v[200:203]
  v_exp_f32 v20, v20
  v_mfma_f32_16x16x32_bf16 v[52:55], a[148:151], v[164:167], v[52:55]
  ds_read_b64_tr_b16 a[168:169], v217 offset:16384
  v_mfma_f32_16x16x32_bf16 v[52:55], a[152:155], v[168:171], v[52:55]
  v_exp_f32 v21, v21
  v_mfma_f32_16x16x32_bf16 v[52:55], a[156:159], v[172:175], v[52:55]
  ds_read_b64_tr_b16 a[170:171], v217 offset:20480
  v_cvt_pk_bf16_f32 v18, v20, v21
  v_mfma_f32_16x16x32_bf16 v[60:63], a[156:159], v[188:191], v[204:207]
  v_exp_f32 v22, v22
  v_mfma_f32_16x16x32_bf16 v[60:63], a[152:155], v[184:187], v[60:63]
  ds_read_b64_tr_b16 a[172:173], v217 offset:24576
  v_mfma_f32_16x16x32_bf16 v[60:63], a[148:151], v[180:183], v[60:63]
  v_exp_f32 v23, v23
  v_mfma_f32_16x16x32_bf16 v[60:63], a[144:147], v[176:179], v[60:63]
  ds_read_b64_tr_b16 a[174:175], v217 offset:28672
  v_cvt_pk_bf16_f32 v19, v22, v23
  v_mfma_f32_16x16x32_bf16 a[192:195], a[208:211], v[64:67], a[192:195]
  v_exp_f32 v28, v28
  v_mfma_f32_16x16x32_bf16 a[192:195], a[208:211], v[96:99], a[192:195]
  ds_read_b64_tr_b16 a[176:177], v218 offset:16384
  v_mfma_f32_16x16x32_bf16 a[196:199], a[208:211], v[72:75], a[196:199]
  v_exp_f32 v29, v29
  v_mfma_f32_16x16x32_bf16 a[196:199], a[208:211], v[104:107], a[196:199]
  ds_read_b64_tr_b16 a[178:179], v218 offset:20480
  v_cvt_pk_bf16_f32 v26, v28, v29
  v_mfma_f32_16x16x32_bf16 a[200:203], a[208:211], v[80:83], a[200:203]
  v_exp_f32 v30, v30
  v_mfma_f32_16x16x32_bf16 a[200:203], a[208:211], v[112:115], a[200:203]
  ds_read_b64_tr_b16 a[180:181], v218 offset:24576
  v_mfma_f32_16x16x32_bf16 a[204:207], a[208:211], v[88:91], a[204:207]
  s_waitcnt lgkmcnt(7)
  v_exp_f32 v31, v31
  v_mfma_f32_16x16x32_bf16 a[204:207], a[208:211], v[120:123], a[204:207]
  ds_read_b64_tr_b16 a[182:183], v218 offset:28672
  v_cvt_pk_bf16_f32 v27, v30, v31
  v_mfma_f32_16x16x32_bf16 a[0:3], a[160:163], v[64:67], a[0:3]
  v_exp_f32 v32, v32
  v_mfma_f32_16x16x32_bf16 a[0:3], a[164:167], v[96:99], a[0:3]
  ds_read_b64_tr_b16 a[184:185], v219 offset:16384
  v_mfma_f32_16x16x32_bf16 a[4:7], a[164:167], v[104:107], a[4:7]
  v_exp_f32 v33, v33
  v_mfma_f32_16x16x32_bf16 a[4:7], a[160:163], v[72:75], a[4:7]
  ds_read_b64_tr_b16 a[186:187], v219 offset:20480
  v_cvt_pk_bf16_f32 v32, v32, v33
  v_mfma_f32_16x16x32_bf16 a[8:11], a[160:163], v[80:83], a[8:11]
  v_exp_f32 v34, v34
  v_mfma_f32_16x16x32_bf16 a[8:11], a[164:167], v[112:115], a[8:11]
  ds_read_b64_tr_b16 a[188:189], v219 offset:24576
  v_mfma_f32_16x16x32_bf16 a[12:15], a[164:167], v[120:123], a[12:15]
  s_waitcnt lgkmcnt(7)
  v_exp_f32 v35, v35
  v_mfma_f32_16x16x32_bf16 a[12:15], a[160:163], v[88:91], a[12:15]
  ds_read_b64_tr_b16 a[190:191], v219 offset:28672
  v_cvt_pk_bf16_f32 v33, v34, v35
  v_mfma_f32_16x16x32_bf16 a[16:19], a[168:171], v[64:67], a[16:19]
  v_exp_f32 v40, v40
  v_mfma_f32_16x16x32_bf16 a[16:19], a[172:175], v[96:99], a[16:19]
  ds_read_b64_tr_b16 a[160:161], v220 offset:16384
  v_mfma_f32_16x16x32_bf16 a[20:23], a[172:175], v[104:107], a[20:23]
  v_exp_f32 v41, v41
  v_mfma_f32_16x16x32_bf16 a[20:23], a[168:171], v[72:75], a[20:23]
  ds_read_b64_tr_b16 a[162:163], v220 offset:20480
  v_cvt_pk_bf16_f32 v40, v40, v41
  v_mfma_f32_16x16x32_bf16 a[24:27], a[168:171], v[80:83], a[24:27]
  v_exp_f32 v42, v42
  v_mfma_f32_16x16x32_bf16 a[24:27], a[172:175], v[112:115], a[24:27]
  ds_read_b64_tr_b16 a[164:165], v220 offset:24576
  v_mfma_f32_16x16x32_bf16 a[28:31], a[172:175], v[120:123], a[28:31]
  s_waitcnt lgkmcnt(7)
  v_exp_f32 v43, v43
  v_mfma_f32_16x16x32_bf16 a[28:31], a[168:171], v[88:91], a[28:31]
  ds_read_b64_tr_b16 a[166:167], v220 offset:28672
  v_cvt_pk_bf16_f32 v41, v42, v43
  v_mfma_f32_16x16x32_bf16 a[32:35], a[176:179], v[64:67], a[32:35]
  v_exp_f32 v48, v48
  v_mfma_f32_16x16x32_bf16 a[32:35], a[180:183], v[96:99], a[32:35]
  ds_read_b64_tr_b16 a[168:169], v221 offset:16384
  v_mfma_f32_16x16x32_bf16 a[36:39], a[180:183], v[104:107], a[36:39]
  v_exp_f32 v49, v49
  v_mfma_f32_16x16x32_bf16 a[36:39], a[176:179], v[72:75], a[36:39]
  ds_read_b64_tr_b16 a[170:171], v221 offset:20480
  v_cvt_pk_bf16_f32 v48, v48, v49
  v_mfma_f32_16x16x32_bf16 a[40:43], a[176:179], v[80:83], a[40:43]
  v_exp_f32 v50, v50
  v_mfma_f32_16x16x32_bf16 a[40:43], a[180:183], v[112:115], a[40:43]
  ds_read_b64_tr_b16 a[172:173], v221 offset:24576
  v_mfma_f32_16x16x32_bf16 a[44:47], a[180:183], v[120:123], a[44:47]
  s_waitcnt lgkmcnt(7)
  v_exp_f32 v51, v51
  v_mfma_f32_16x16x32_bf16 a[44:47], a[176:179], v[88:91], a[44:47]
  ds_read_b64_tr_b16 a[174:175], v221 offset:28672
  v_cvt_pk_bf16_f32 v49, v50, v51
  v_mfma_f32_16x16x32_bf16 a[48:51], a[184:187], v[64:67], a[48:51]
  v_exp_f32 v56, v56
  v_mfma_f32_16x16x32_bf16 a[48:51], a[188:191], v[96:99], a[48:51]
  ds_read_b64_tr_b16 a[176:177], v222 offset:16384
  v_mfma_f32_16x16x32_bf16 a[52:55], a[188:191], v[104:107], a[52:55]
  v_exp_f32 v57, v57
  v_mfma_f32_16x16x32_bf16 a[52:55], a[184:187], v[72:75], a[52:55]
  ds_read_b64_tr_b16 a[178:179], v222 offset:20480
  v_cvt_pk_bf16_f32 v56, v56, v57
  v_mfma_f32_16x16x32_bf16 a[56:59], a[184:187], v[80:83], a[56:59]
  v_exp_f32 v58, v58
  v_mfma_f32_16x16x32_bf16 a[56:59], a[188:191], v[112:115], a[56:59]
  ds_read_b64_tr_b16 a[180:181], v222 offset:24576
  v_mfma_f32_16x16x32_bf16 a[60:63], a[188:191], v[120:123], a[60:63]
  s_waitcnt lgkmcnt(7)
  v_exp_f32 v59, v59
  v_mfma_f32_16x16x32_bf16 a[60:63], a[184:187], v[88:91], a[60:63]
  ds_read_b64_tr_b16 a[182:183], v222 offset:28672
  v_cvt_pk_bf16_f32 v57, v58, v59
  v_mfma_f32_16x16x32_bf16 a[64:67], a[160:163], v[64:67], a[64:67]
  v_exp_f32 v36, v36
  v_mfma_f32_16x16x32_bf16 a[64:67], a[164:167], v[96:99], a[64:67]
  ds_read_b64_tr_b16 a[184:185], v223 offset:16384
  v_mfma_f32_16x16x32_bf16 a[68:71], a[164:167], v[104:107], a[68:71]
  v_exp_f32 v37, v37
  v_mfma_f32_16x16x32_bf16 a[68:71], a[160:163], v[72:75], a[68:71]
  ds_read_b64_tr_b16 a[186:187], v223 offset:20480
  v_cvt_pk_bf16_f32 v34, v36, v37
  v_mfma_f32_16x16x32_bf16 a[72:75], a[160:163], v[80:83], a[72:75]
  v_exp_f32 v38, v38
  v_mfma_f32_16x16x32_bf16 a[72:75], a[164:167], v[112:115], a[72:75]
  ds_read_b64_tr_b16 a[188:189], v223 offset:24576
  v_mfma_f32_16x16x32_bf16 a[76:79], a[164:167], v[120:123], a[76:79]
  s_waitcnt lgkmcnt(7)
  v_exp_f32 v39, v39
  v_mfma_f32_16x16x32_bf16 a[76:79], a[160:163], v[88:91], a[76:79]
  ds_read_b64_tr_b16 a[190:191], v223 offset:28672
  v_cvt_pk_bf16_f32 v35, v38, v39
  v_mfma_f32_16x16x32_bf16 a[80:83], a[168:171], v[64:67], a[80:83]
  s_waitcnt vmcnt(11)
  v_exp_f32 v44, v44
  v_mfma_f32_16x16x32_bf16 a[80:83], a[172:175], v[96:99], a[80:83]
  v_mfma_f32_16x16x32_bf16 a[84:87], a[172:175], v[104:107], a[84:87]
  s_barrier
  v_exp_f32 v45, v45
  v_mfma_f32_16x16x32_bf16 a[84:87], a[168:171], v[72:75], a[84:87]
  ds_read_b128 a[128:131], v212 offset:49152
  v_cvt_pk_bf16_f32 v42, v44, v45
  v_mfma_f32_16x16x32_bf16 a[88:91], a[168:171], v[80:83], a[88:91]
  v_exp_f32 v46, v46
  v_mfma_f32_16x16x32_bf16 a[88:91], a[172:175], v[112:115], a[88:91]
  ds_read_b128 a[132:135], v213 offset:49152
  v_mfma_f32_16x16x32_bf16 a[92:95], a[172:175], v[120:123], a[92:95]
  s_waitcnt lgkmcnt(6)
  v_exp_f32 v47, v47
  v_mfma_f32_16x16x32_bf16 a[92:95], a[168:171], v[88:91], a[92:95]
  ds_read_b128 a[136:139], v214 offset:49152
  v_cvt_pk_bf16_f32 v43, v46, v47
  v_mfma_f32_16x16x32_bf16 a[96:99], a[176:179], v[64:67], a[96:99]
  v_exp_f32 v52, v52
  v_mfma_f32_16x16x32_bf16 a[96:99], a[180:183], v[96:99], a[96:99]
  ds_read_b128 a[140:143], v215 offset:49152
  buffer_load_dwordx4 a[216:219], v243, s[24:27], s38 offen sc1
  s_add_u32 s38, s38, 4096
  v_mfma_f32_16x16x32_bf16 a[100:103], a[180:183], v[104:107], a[100:103]
  v_exp_f32 v53, v53
  v_mfma_f32_16x16x32_bf16 a[100:103], a[176:179], v[72:75], a[100:103]
  v_cvt_pk_bf16_f32 v50, v52, v53
  v_mfma_f32_16x16x32_bf16 a[104:107], a[176:179], v[80:83], a[104:107]
  v_exp_f32 v54, v54
  v_mfma_f32_16x16x32_bf16 a[104:107], a[180:183], v[112:115], a[104:107]
  v_mfma_f32_16x16x32_bf16 a[108:111], a[180:183], v[120:123], a[108:111]
  s_waitcnt lgkmcnt(4)
  v_exp_f32 v55, v55
  v_mfma_f32_16x16x32_bf16 a[108:111], a[176:179], v[88:91], a[108:111]
  v_cvt_pk_bf16_f32 v51, v54, v55
  v_mfma_f32_16x16x32_bf16 a[112:115], a[184:187], v[64:67], a[112:115]
  v_exp_f32 v60, v60
  v_mfma_f32_16x16x32_bf16 a[112:115], a[188:191], v[96:99], a[112:115]
  v_mfma_f32_16x16x32_bf16 a[116:119], a[188:191], v[104:107], a[116:119]
  v_exp_f32 v61, v61
  v_mfma_f32_16x16x32_bf16 a[116:119], a[184:187], v[72:75], a[116:119]
  v_cvt_pk_bf16_f32 v58, v60, v61
  v_mfma_f32_16x16x32_bf16 a[120:123], a[184:187], v[80:83], a[120:123]
  v_exp_f32 v62, v62
  v_mfma_f32_16x16x32_bf16 a[120:123], a[188:191], v[112:115], a[120:123]
  v_mfma_f32_16x16x32_bf16 a[124:127], a[188:191], v[120:123], a[124:127]
  s_waitcnt lgkmcnt(0)
  v_exp_f32 v63, v63
  v_mfma_f32_16x16x32_bf16 a[124:127], a[184:187], v[88:91], a[124:127]
  v_cvt_pk_bf16_f32 v59, v62, v63
  v_mfma_f32_16x16x32_bf16 v[64:67], a[128:131], v[128:131], v[192:195]
  s_add_u32 m0, s28, 65536
  v_mfma_f32_16x16x32_bf16 v[64:67], a[132:135], v[132:135], v[64:67]
  ds_read_b128 a[144:147], v212 offset:53248
  v_mfma_f32_16x16x32_bf16 v[64:67], a[136:139], v[136:139], v[64:67]
  buffer_load_dwordx4 v236, s[16:19], s29 offen offset:0 lds
  v_mfma_f32_16x16x32_bf16 v[64:67], a[140:143], v[140:143], v[64:67]
  ds_read_b128 a[148:151], v213 offset:53248
  v_mfma_f32_16x16x32_bf16 v[72:75], a[140:143], v[156:159], v[196:199]
  buffer_load_dwordx4 v237, s[16:19], s29 offen offset:1024 lds
  v_mfma_f32_16x16x32_bf16 v[72:75], a[136:139], v[152:155], v[72:75]
  ds_read_b128 a[152:155], v214 offset:53248
  v_mfma_f32_16x16x32_bf16 v[72:75], a[132:135], v[148:151], v[72:75]
  buffer_load_dwordx4 v236, s[16:19], s29 offen offset:2048 lds
  v_mfma_f32_16x16x32_bf16 v[72:75], a[128:131], v[144:147], v[72:75]
  ds_read_b128 a[156:159], v215 offset:53248
  v_mfma_f32_16x16x32_bf16 v[80:83], a[128:131], v[160:163], v[200:203]
  v_exp_f32 v64, v64
  v_mfma_f32_16x16x32_bf16 v[80:83], a[132:135], v[164:167], v[80:83]
  buffer_load_dwordx4 v237, s[16:19], s29 offen offset:3072 lds
  v_mfma_f32_16x16x32_bf16 v[80:83], a[136:139], v[168:171], v[80:83]
  s_add_u32 s29, s29, 16384
  v_exp_f32 v65, v65
  v_mfma_f32_16x16x32_bf16 v[80:83], a[140:143], v[172:175], v[80:83]
  v_cvt_pk_bf16_f32 v64, v64, v65
  v_mfma_f32_16x16x32_bf16 v[88:91], a[140:143], v[188:191], v[204:207]
  s_add_u32 m0, s28, 16384
  v_exp_f32 v66, v66
  v_mfma_f32_16x16x32_bf16 v[88:91], a[136:139], v[184:187], v[88:91]
  buffer_load_dwordx4 v232, s[12:15], s29 offen offset:0 lds
  v_mfma_f32_16x16x32_bf16 v[88:91], a[132:135], v[180:183], v[88:91]
  s_waitcnt lgkmcnt(0)
  v_exp_f32 v67, v67
  v_mfma_f32_16x16x32_bf16 v[88:91], a[128:131], v[176:179], v[88:91]
  v_cvt_pk_bf16_f32 v65, v66, v67
  v_mfma_f32_16x16x32_bf16 v[68:71], a[144:147], v[128:131], v[192:195]
  v_exp_f32 v72, v72
  v_mfma_f32_16x16x32_bf16 v[68:71], a[148:151], v[132:135], v[68:71]
  ds_read_b128 a[128:131], v212 offset:57344
  v_mfma_f32_16x16x32_bf16 v[68:71], a[152:155], v[136:139], v[68:71]
  v_exp_f32 v73, v73
  v_mfma_f32_16x16x32_bf16 v[68:71], a[156:159], v[140:143], v[68:71]
  ds_read_b128 a[132:135], v213 offset:57344
  v_cvt_pk_bf16_f32 v72, v72, v73
  v_mfma_f32_16x16x32_bf16 v[76:79], a[156:159], v[156:159], v[196:199]
  v_exp_f32 v74, v74
  v_mfma_f32_16x16x32_bf16 v[76:79], a[152:155], v[152:155], v[76:79]
  ds_read_b128 a[136:139], v214 offset:57344
  v_mfma_f32_16x16x32_bf16 v[76:79], a[148:151], v[148:151], v[76:79]
  v_exp_f32 v75, v75
  v_mfma_f32_16x16x32_bf16 v[76:79], a[144:147], v[144:147], v[76:79]
  ds_read_b128 a[140:143], v215 offset:57344
  v_cvt_pk_bf16_f32 v73, v74, v75
  v_mfma_f32_16x16x32_bf16 v[84:87], a[144:147], v[160:163], v[200:203]
  v_exp_f32 v80, v80
  v_mfma_f32_16x16x32_bf16 v[84:87], a[148:151], v[164:167], v[84:87]
  buffer_load_dwordx4 v233, s[12:15], s29 offen offset:1024 lds
  v_mfma_f32_16x16x32_bf16 v[84:87], a[152:155], v[168:171], v[84:87]
  v_exp_f32 v81, v81
  v_mfma_f32_16x16x32_bf16 v[84:87], a[156:159], v[172:175], v[84:87]
  v_cvt_pk_bf16_f32 v80, v80, v81
  v_mfma_f32_16x16x32_bf16 v[92:95], a[156:159], v[188:191], v[204:207]
  v_exp_f32 v82, v82
  v_mfma_f32_16x16x32_bf16 v[92:95], a[152:155], v[184:187], v[92:95]
  buffer_load_dwordx4 v234, s[12:15], s29 offen offset:2048 lds
  v_mfma_f32_16x16x32_bf16 v[92:95], a[148:151], v[180:183], v[92:95]
  s_waitcnt lgkmcnt(0)
  v_exp_f32 v83, v83
  v_mfma_f32_16x16x32_bf16 v[92:95], a[144:147], v[176:179], v[92:95]
  v_cvt_pk_bf16_f32 v81, v82, v83
  v_mfma_f32_16x16x32_bf16 v[96:99], a[128:131], v[128:131], v[192:195]
  v_exp_f32 v88, v88
  v_mfma_f32_16x16x32_bf16 v[96:99], a[132:135], v[132:135], v[96:99]
  ds_read_b128 a[144:147], v212 offset:61440
  v_mfma_f32_16x16x32_bf16 v[96:99], a[136:139], v[136:139], v[96:99]
  v_exp_f32 v89, v89
  v_mfma_f32_16x16x32_bf16 v[96:99], a[140:143], v[140:143], v[96:99]
  ds_read_b128 a[148:151], v213 offset:61440
  v_cvt_pk_bf16_f32 v88, v88, v89
  v_mfma_f32_16x16x32_bf16 v[104:107], a[140:143], v[156:159], v[196:199]
  v_exp_f32 v90, v90
  v_mfma_f32_16x16x32_bf16 v[104:107], a[136:139], v[152:155], v[104:107]
  ds_read_b128 a[152:155], v214 offset:61440
  v_mfma_f32_16x16x32_bf16 v[104:107], a[132:135], v[148:151], v[104:107]
  v_exp_f32 v91, v91
  v_mfma_f32_16x16x32_bf16 v[104:107], a[128:131], v[144:147], v[104:107]
  ds_read_b128 a[156:159], v215 offset:61440
  v_cvt_pk_bf16_f32 v89, v90, v91
  v_mfma_f32_16x16x32_bf16 v[112:115], a[128:131], v[160:163], v[200:203]
  v_exp_f32 v68, v68
  v_mfma_f32_16x16x32_bf16 v[112:115], a[132:135], v[164:167], v[112:115]
  buffer_load_dwordx4 v235, s[12:15], s29 offen offset:3072 lds
  v_mfma_f32_16x16x32_bf16 v[112:115], a[136:139], v[168:171], v[112:115]
  v_exp_f32 v69, v69
  v_mfma_f32_16x16x32_bf16 v[112:115], a[140:143], v[172:175], v[112:115]
  v_cvt_pk_bf16_f32 v66, v68, v69
  v_mfma_f32_16x16x32_bf16 v[120:123], a[140:143], v[188:191], v[204:207]
  v_exp_f32 v70, v70
  v_mfma_f32_16x16x32_bf16 v[120:123], a[136:139], v[184:187], v[120:123]
  s_add_u32 m0, s50, 4096
  v_mfma_f32_16x16x32_bf16 v[120:123], a[132:135], v[180:183], v[120:123]
  s_waitcnt lgkmcnt(0)
  v_exp_f32 v71, v71
  v_mfma_f32_16x16x32_bf16 v[120:123], a[128:131], v[176:179], v[120:123]
  buffer_load_dwordx4 v226, s[44:47], s35 offen lds
  s_add_u32 s35, s35, 221184
  v_cvt_pk_bf16_f32 v67, v70, v71
  v_mfma_f32_16x16x32_bf16 v[100:103], a[144:147], v[128:131], v[192:195]
  v_exp_f32 v76, v76
  v_mfma_f32_16x16x32_bf16 v[100:103], a[148:151], v[132:135], v[100:103]
  ds_read_b64_tr_b16 a[160:161], v216 offset:32768
  v_mfma_f32_16x16x32_bf16 v[100:103], a[152:155], v[136:139], v[100:103]
  v_exp_f32 v77, v77
  v_mfma_f32_16x16x32_bf16 v[100:103], a[156:159], v[140:143], v[100:103]
  ds_read_b64_tr_b16 a[162:163], v216 offset:36864
  v_cvt_pk_bf16_f32 v74, v76, v77
  v_mfma_f32_16x16x32_bf16 v[108:111], a[156:159], v[156:159], v[196:199]
  v_exp_f32 v78, v78
  v_mfma_f32_16x16x32_bf16 v[108:111], a[152:155], v[152:155], v[108:111]
  ds_read_b64_tr_b16 a[164:165], v216 offset:40960
  v_mfma_f32_16x16x32_bf16 v[108:111], a[148:151], v[148:151], v[108:111]
  v_exp_f32 v79, v79
  v_mfma_f32_16x16x32_bf16 v[108:111], a[144:147], v[144:147], v[108:111]
  ds_read_b64_tr_b16 a[166:167], v216 offset:45056
  v_cvt_pk_bf16_f32 v75, v78, v79
  v_mfma_f32_16x16x32_bf16 v[116:119], a[144:147], v[160:163], v[200:203]
  v_exp_f32 v84, v84
  v_mfma_f32_16x16x32_bf16 v[116:119], a[148:151], v[164:167], v[116:119]
  ds_read_b64_tr_b16 a[168:169], v217 offset:32768
  v_mfma_f32_16x16x32_bf16 v[116:119], a[152:155], v[168:171], v[116:119]
  v_exp_f32 v85, v85
  v_mfma_f32_16x16x32_bf16 v[116:119], a[156:159], v[172:175], v[116:119]
  ds_read_b64_tr_b16 a[170:171], v217 offset:36864
  v_cvt_pk_bf16_f32 v82, v84, v85
  v_mfma_f32_16x16x32_bf16 v[124:127], a[156:159], v[188:191], v[204:207]
  v_exp_f32 v86, v86
  v_mfma_f32_16x16x32_bf16 v[124:127], a[152:155], v[184:187], v[124:127]
  ds_read_b64_tr_b16 a[172:173], v217 offset:40960
  v_mfma_f32_16x16x32_bf16 v[124:127], a[148:151], v[180:183], v[124:127]
  v_exp_f32 v87, v87
  v_mfma_f32_16x16x32_bf16 v[124:127], a[144:147], v[176:179], v[124:127]
  ds_read_b64_tr_b16 a[174:175], v217 offset:45056
  v_cvt_pk_bf16_f32 v83, v86, v87
  v_mfma_f32_16x16x32_bf16 a[192:195], a[208:211], v[0:3], a[192:195]
  v_exp_f32 v92, v92
  v_mfma_f32_16x16x32_bf16 a[192:195], a[208:211], v[32:35], a[192:195]
  ds_read_b64_tr_b16 a[176:177], v218 offset:32768
  v_mfma_f32_16x16x32_bf16 a[196:199], a[208:211], v[8:11], a[196:199]
  v_exp_f32 v93, v93
  v_mfma_f32_16x16x32_bf16 a[196:199], a[208:211], v[40:43], a[196:199]
  ds_read_b64_tr_b16 a[178:179], v218 offset:36864
  v_cvt_pk_bf16_f32 v90, v92, v93
  v_mfma_f32_16x16x32_bf16 a[200:203], a[208:211], v[16:19], a[200:203]
  v_exp_f32 v94, v94
  v_mfma_f32_16x16x32_bf16 a[200:203], a[208:211], v[48:51], a[200:203]
  ds_read_b64_tr_b16 a[180:181], v218 offset:40960
  v_mfma_f32_16x16x32_bf16 a[204:207], a[208:211], v[24:27], a[204:207]
  s_waitcnt lgkmcnt(7)
  v_exp_f32 v95, v95
  v_mfma_f32_16x16x32_bf16 a[204:207], a[208:211], v[56:59], a[204:207]
  ds_read_b64_tr_b16 a[182:183], v218 offset:45056
  v_cvt_pk_bf16_f32 v91, v94, v95
  v_mfma_f32_16x16x32_bf16 a[0:3], a[160:163], v[0:3], a[0:3]
  v_exp_f32 v96, v96
  v_mfma_f32_16x16x32_bf16 a[0:3], a[164:167], v[32:35], a[0:3]
  ds_read_b64_tr_b16 a[184:185], v219 offset:32768
  v_mfma_f32_16x16x32_bf16 a[4:7], a[164:167], v[40:43], a[4:7]
  v_exp_f32 v97, v97
  v_mfma_f32_16x16x32_bf16 a[4:7], a[160:163], v[8:11], a[4:7]
  ds_read_b64_tr_b16 a[186:187], v219 offset:36864
  v_cvt_pk_bf16_f32 v96, v96, v97
  v_mfma_f32_16x16x32_bf16 a[8:11], a[160:163], v[16:19], a[8:11]
  v_exp_f32 v98, v98
  v_mfma_f32_16x16x32_bf16 a[8:11], a[164:167], v[48:51], a[8:11]
  ds_read_b64_tr_b16 a[188:189], v219 offset:40960
  v_mfma_f32_16x16x32_bf16 a[12:15], a[164:167], v[56:59], a[12:15]
  s_waitcnt lgkmcnt(7)
  v_exp_f32 v99, v99
  v_mfma_f32_16x16x32_bf16 a[12:15], a[160:163], v[24:27], a[12:15]
  ds_read_b64_tr_b16 a[190:191], v219 offset:45056
  v_cvt_pk_bf16_f32 v97, v98, v99
  v_mfma_f32_16x16x32_bf16 a[16:19], a[168:171], v[0:3], a[16:19]
  v_exp_f32 v104, v104
  v_mfma_f32_16x16x32_bf16 a[16:19], a[172:175], v[32:35], a[16:19]
  ds_read_b64_tr_b16 a[160:161], v220 offset:32768
  v_mfma_f32_16x16x32_bf16 a[20:23], a[172:175], v[40:43], a[20:23]
  v_exp_f32 v105, v105
  v_mfma_f32_16x16x32_bf16 a[20:23], a[168:171], v[8:11], a[20:23]
  ds_read_b64_tr_b16 a[162:163], v220 offset:36864
  v_cvt_pk_bf16_f32 v104, v104, v105
  v_mfma_f32_16x16x32_bf16 a[24:27], a[168:171], v[16:19], a[24:27]
  v_exp_f32 v106, v106
  v_mfma_f32_16x16x32_bf16 a[24:27], a[172:175], v[48:51], a[24:27]
  ds_read_b64_tr_b16 a[164:165], v220 offset:40960
  v_mfma_f32_16x16x32_bf16 a[28:31], a[172:175], v[56:59], a[28:31]
  s_waitcnt lgkmcnt(7)
  v_exp_f32 v107, v107
  v_mfma_f32_16x16x32_bf16 a[28:31], a[168:171], v[24:27], a[28:31]
  ds_read_b64_tr_b16 a[166:167], v220 offset:45056
  v_cvt_pk_bf16_f32 v105, v106, v107
  v_mfma_f32_16x16x32_bf16 a[32:35], a[176:179], v[0:3], a[32:35]
  v_exp_f32 v112, v112
  v_mfma_f32_16x16x32_bf16 a[32:35], a[180:183], v[32:35], a[32:35]
  ds_read_b64_tr_b16 a[168:169], v221 offset:32768
  v_mfma_f32_16x16x32_bf16 a[36:39], a[180:183], v[40:43], a[36:39]
  v_exp_f32 v113, v113
  v_mfma_f32_16x16x32_bf16 a[36:39], a[176:179], v[8:11], a[36:39]
  ds_read_b64_tr_b16 a[170:171], v221 offset:36864
  v_cvt_pk_bf16_f32 v112, v112, v113
  v_mfma_f32_16x16x32_bf16 a[40:43], a[176:179], v[16:19], a[40:43]
  v_exp_f32 v114, v114
  v_mfma_f32_16x16x32_bf16 a[40:43], a[180:183], v[48:51], a[40:43]
  ds_read_b64_tr_b16 a[172:173], v221 offset:40960
  v_mfma_f32_16x16x32_bf16 a[44:47], a[180:183], v[56:59], a[44:47]
  s_waitcnt lgkmcnt(7)
  v_exp_f32 v115, v115
  v_mfma_f32_16x16x32_bf16 a[44:47], a[176:179], v[24:27], a[44:47]
  ds_read_b64_tr_b16 a[174:175], v221 offset:45056
  v_cvt_pk_bf16_f32 v113, v114, v115
  v_mfma_f32_16x16x32_bf16 a[48:51], a[184:187], v[0:3], a[48:51]
  v_exp_f32 v120, v120
  v_mfma_f32_16x16x32_bf16 a[48:51], a[188:191], v[32:35], a[48:51]
  ds_read_b64_tr_b16 a[176:177], v222 offset:32768
  v_mfma_f32_16x16x32_bf16 a[52:55], a[188:191], v[40:43], a[52:55]
  v_exp_f32 v121, v121
  v_mfma_f32_16x16x32_bf16 a[52:55], a[184:187], v[8:11], a[52:55]
  ds_read_b64_tr_b16 a[178:179], v222 offset:36864
  v_cvt_pk_bf16_f32 v120, v120, v121
  v_mfma_f32_16x16x32_bf16 a[56:59], a[184:187], v[16:19], a[56:59]
  v_exp_f32 v122, v122
  v_mfma_f32_16x16x32_bf16 a[56:59], a[188:191], v[48:51], a[56:59]
  ds_read_b64_tr_b16 a[180:181], v222 offset:40960
  v_mfma_f32_16x16x32_bf16 a[60:63], a[188:191], v[56:59], a[60:63]
  s_waitcnt lgkmcnt(7)
  v_exp_f32 v123, v123
  v_mfma_f32_16x16x32_bf16 a[60:63], a[184:187], v[24:27], a[60:63]
  ds_read_b64_tr_b16 a[182:183], v222 offset:45056
  v_cvt_pk_bf16_f32 v121, v122, v123
  v_mfma_f32_16x16x32_bf16 a[64:67], a[160:163], v[0:3], a[64:67]
  v_exp_f32 v100, v100
  v_mfma_f32_16x16x32_bf16 a[64:67], a[164:167], v[32:35], a[64:67]
  ds_read_b64_tr_b16 a[184:185], v223 offset:32768
  v_mfma_f32_16x16x32_bf16 a[68:71], a[164:167], v[40:43], a[68:71]
  v_exp_f32 v101, v101
  v_mfma_f32_16x16x32_bf16 a[68:71], a[160:163], v[8:11], a[68:71]
  ds_read_b64_tr_b16 a[186:187], v223 offset:36864
  v_cvt_pk_bf16_f32 v98, v100, v101
  v_mfma_f32_16x16x32_bf16 a[72:75], a[160:163], v[16:19], a[72:75]
  v_exp_f32 v102, v102
  v_mfma_f32_16x16x32_bf16 a[72:75], a[164:167], v[48:51], a[72:75]
  ds_read_b64_tr_b16 a[188:189], v223 offset:40960
  v_mfma_f32_16x16x32_bf16 a[76:79], a[164:167], v[56:59], a[76:79]
  s_waitcnt lgkmcnt(7)
  v_exp_f32 v103, v103
  v_mfma_f32_16x16x32_bf16 a[76:79], a[160:163], v[24:27], a[76:79]
  ds_read_b64_tr_b16 a[190:191], v223 offset:45056
  v_cvt_pk_bf16_f32 v99, v102, v103
  v_mfma_f32_16x16x32_bf16 a[80:83], a[168:171], v[0:3], a[80:83]
  s_waitcnt vmcnt(11)
  v_exp_f32 v108, v108
  v_mfma_f32_16x16x32_bf16 a[80:83], a[172:175], v[32:35], a[80:83]
  v_mfma_f32_16x16x32_bf16 a[84:87], a[172:175], v[40:43], a[84:87]
  s_barrier
  v_exp_f32 v109, v109
  v_mfma_f32_16x16x32_bf16 a[84:87], a[168:171], v[8:11], a[84:87]
  ds_read_b128 a[128:131], v212 offset:0
  v_cvt_pk_bf16_f32 v106, v108, v109
  v_mfma_f32_16x16x32_bf16 a[88:91], a[168:171], v[16:19], a[88:91]
  v_exp_f32 v110, v110
  v_mfma_f32_16x16x32_bf16 a[88:91], a[172:175], v[48:51], a[88:91]
  ds_read_b128 a[132:135], v213 offset:0
  v_mfma_f32_16x16x32_bf16 a[92:95], a[172:175], v[56:59], a[92:95]
  s_waitcnt lgkmcnt(6)
  v_exp_f32 v111, v111
  v_mfma_f32_16x16x32_bf16 a[92:95], a[168:171], v[24:27], a[92:95]
  ds_read_b128 a[136:139], v214 offset:0
  v_cvt_pk_bf16_f32 v107, v110, v111
  v_mfma_f32_16x16x32_bf16 a[96:99], a[176:179], v[0:3], a[96:99]
  v_exp_f32 v116, v116
  v_mfma_f32_16x16x32_bf16 a[96:99], a[180:183], v[32:35], a[96:99]
  ds_read_b128 a[140:143], v215 offset:0
  buffer_load_dwordx4 a[220:223], v243, s[24:27], s38 offen sc1
  s_add_u32 s38, s38, 4096
  v_mfma_f32_16x16x32_bf16 a[100:103], a[180:183], v[40:43], a[100:103]
  v_exp_f32 v117, v117
  v_mfma_f32_16x16x32_bf16 a[100:103], a[176:179], v[8:11], a[100:103]
  v_cvt_pk_bf16_f32 v114, v116, v117
  v_mfma_f32_16x16x32_bf16 a[104:107], a[176:179], v[16:19], a[104:107]
  v_exp_f32 v118, v118
  v_mfma_f32_16x16x32_bf16 a[104:107], a[180:183], v[48:51], a[104:107]
  v_mfma_f32_16x16x32_bf16 a[108:111], a[180:183], v[56:59], a[108:111]
  s_waitcnt lgkmcnt(4)
  v_exp_f32 v119, v119
  v_mfma_f32_16x16x32_bf16 a[108:111], a[176:179], v[24:27], a[108:111]
  v_cvt_pk_bf16_f32 v115, v118, v119
  v_mfma_f32_16x16x32_bf16 a[112:115], a[184:187], v[0:3], a[112:115]
  v_exp_f32 v124, v124
  v_mfma_f32_16x16x32_bf16 a[112:115], a[188:191], v[32:35], a[112:115]
  v_mfma_f32_16x16x32_bf16 a[116:119], a[188:191], v[40:43], a[116:119]
  v_exp_f32 v125, v125
  v_mfma_f32_16x16x32_bf16 a[116:119], a[184:187], v[8:11], a[116:119]
  v_cvt_pk_bf16_f32 v122, v124, v125
  v_mfma_f32_16x16x32_bf16 a[120:123], a[184:187], v[16:19], a[120:123]
  v_exp_f32 v126, v126
  v_mfma_f32_16x16x32_bf16 a[120:123], a[188:191], v[48:51], a[120:123]
  v_mfma_f32_16x16x32_bf16 a[124:127], a[188:191], v[56:59], a[124:127]
  s_waitcnt lgkmcnt(0)
  v_exp_f32 v127, v127
  v_mfma_f32_16x16x32_bf16 a[124:127], a[184:187], v[24:27], a[124:127]
  v_cvt_pk_bf16_f32 v123, v126, v127
  v_mfma_f32_16x16x32_bf16 v[0:3], a[128:131], v[128:131], v[192:195]
  s_add_u32 m0, s28, 81920
  v_mfma_f32_16x16x32_bf16 v[0:3], a[132:135], v[132:135], v[0:3]
  ds_read_b128 a[144:147], v212 offset:4096
  v_mfma_f32_16x16x32_bf16 v[0:3], a[136:139], v[136:139], v[0:3]
  buffer_load_dwordx4 v236, s[16:19], s29 offen offset:0 lds
  v_mfma_f32_16x16x32_bf16 v[0:3], a[140:143], v[140:143], v[0:3]
  ds_read_b128 a[148:151], v213 offset:4096
  v_mfma_f32_16x16x32_bf16 v[8:11], a[140:143], v[156:159], v[196:199]
  buffer_load_dwordx4 v237, s[16:19], s29 offen offset:1024 lds
  v_mfma_f32_16x16x32_bf16 v[8:11], a[136:139], v[152:155], v[8:11]
  ds_read_b128 a[152:155], v214 offset:4096
  v_mfma_f32_16x16x32_bf16 v[8:11], a[132:135], v[148:151], v[8:11]
  buffer_load_dwordx4 v236, s[16:19], s29 offen offset:2048 lds
  v_mfma_f32_16x16x32_bf16 v[8:11], a[128:131], v[144:147], v[8:11]
  ds_read_b128 a[156:159], v215 offset:4096
  v_mfma_f32_16x16x32_bf16 v[16:19], a[128:131], v[160:163], v[200:203]
  v_exp_f32 v0, v0
  v_mfma_f32_16x16x32_bf16 v[16:19], a[132:135], v[164:167], v[16:19]
  buffer_load_dwordx4 v237, s[16:19], s29 offen offset:3072 lds
  v_mfma_f32_16x16x32_bf16 v[16:19], a[136:139], v[168:171], v[16:19]
  s_add_u32 s29, s29, 16384
  v_exp_f32 v1, v1
  v_mfma_f32_16x16x32_bf16 v[16:19], a[140:143], v[172:175], v[16:19]
  v_cvt_pk_bf16_f32 v0, v0, v1
  v_mfma_f32_16x16x32_bf16 v[24:27], a[140:143], v[188:191], v[204:207]
  s_add_u32 m0, s28, 32768
  v_exp_f32 v2, v2
  v_mfma_f32_16x16x32_bf16 v[24:27], a[136:139], v[184:187], v[24:27]
  buffer_load_dwordx4 v232, s[12:15], s29 offen offset:0 lds
  v_mfma_f32_16x16x32_bf16 v[24:27], a[132:135], v[180:183], v[24:27]
  s_waitcnt lgkmcnt(0)
  v_exp_f32 v3, v3
  v_mfma_f32_16x16x32_bf16 v[24:27], a[128:131], v[176:179], v[24:27]
  v_cvt_pk_bf16_f32 v1, v2, v3
  v_mfma_f32_16x16x32_bf16 v[4:7], a[144:147], v[128:131], v[192:195]
  v_exp_f32 v8, v8
  v_mfma_f32_16x16x32_bf16 v[4:7], a[148:151], v[132:135], v[4:7]
  ds_read_b128 a[128:131], v212 offset:8192
  v_mfma_f32_16x16x32_bf16 v[4:7], a[152:155], v[136:139], v[4:7]
  v_exp_f32 v9, v9
  v_mfma_f32_16x16x32_bf16 v[4:7], a[156:159], v[140:143], v[4:7]
  ds_read_b128 a[132:135], v213 offset:8192
  v_cvt_pk_bf16_f32 v8, v8, v9
  v_mfma_f32_16x16x32_bf16 v[12:15], a[156:159], v[156:159], v[196:199]
  v_exp_f32 v10, v10
  v_mfma_f32_16x16x32_bf16 v[12:15], a[152:155], v[152:155], v[12:15]
  ds_read_b128 a[136:139], v214 offset:8192
  v_mfma_f32_16x16x32_bf16 v[12:15], a[148:151], v[148:151], v[12:15]
  v_exp_f32 v11, v11
  v_mfma_f32_16x16x32_bf16 v[12:15], a[144:147], v[144:147], v[12:15]
  ds_read_b128 a[140:143], v215 offset:8192
  v_cvt_pk_bf16_f32 v9, v10, v11
  v_mfma_f32_16x16x32_bf16 v[20:23], a[144:147], v[160:163], v[200:203]
  v_exp_f32 v16, v16
  v_mfma_f32_16x16x32_bf16 v[20:23], a[148:151], v[164:167], v[20:23]
  buffer_load_dwordx4 v233, s[12:15], s29 offen offset:1024 lds
  v_mfma_f32_16x16x32_bf16 v[20:23], a[152:155], v[168:171], v[20:23]
  v_exp_f32 v17, v17
  v_mfma_f32_16x16x32_bf16 v[20:23], a[156:159], v[172:175], v[20:23]
  v_cvt_pk_bf16_f32 v16, v16, v17
  v_mfma_f32_16x16x32_bf16 v[28:31], a[156:159], v[188:191], v[204:207]
  v_exp_f32 v18, v18
  v_mfma_f32_16x16x32_bf16 v[28:31], a[152:155], v[184:187], v[28:31]
  buffer_load_dwordx4 v234, s[12:15], s29 offen offset:2048 lds
  v_mfma_f32_16x16x32_bf16 v[28:31], a[148:151], v[180:183], v[28:31]
  s_waitcnt lgkmcnt(0)
  v_exp_f32 v19, v19
  v_mfma_f32_16x16x32_bf16 v[28:31], a[144:147], v[176:179], v[28:31]
  v_cvt_pk_bf16_f32 v17, v18, v19
  v_mfma_f32_16x16x32_bf16 v[32:35], a[128:131], v[128:131], v[192:195]
  v_exp_f32 v24, v24
  v_mfma_f32_16x16x32_bf16 v[32:35], a[132:135], v[132:135], v[32:35]
  ds_read_b128 a[144:147], v212 offset:12288
  v_mfma_f32_16x16x32_bf16 v[32:35], a[136:139], v[136:139], v[32:35]
  v_exp_f32 v25, v25
  v_mfma_f32_16x16x32_bf16 v[32:35], a[140:143], v[140:143], v[32:35]
  ds_read_b128 a[148:151], v213 offset:12288
  v_cvt_pk_bf16_f32 v24, v24, v25
  v_mfma_f32_16x16x32_bf16 v[40:43], a[140:143], v[156:159], v[196:199]
  v_exp_f32 v26, v26
  v_mfma_f32_16x16x32_bf16 v[40:43], a[136:139], v[152:155], v[40:43]
  ds_read_b128 a[152:155], v214 offset:12288
  v_mfma_f32_16x16x32_bf16 v[40:43], a[132:135], v[148:151], v[40:43]
  v_exp_f32 v27, v27
  v_mfma_f32_16x16x32_bf16 v[40:43], a[128:131], v[144:147], v[40:43]
  ds_read_b128 a[156:159], v215 offset:12288
  v_cvt_pk_bf16_f32 v25, v26, v27
  v_mfma_f32_16x16x32_bf16 v[48:51], a[128:131], v[160:163], v[200:203]
  v_exp_f32 v4, v4
  v_mfma_f32_16x16x32_bf16 v[48:51], a[132:135], v[164:167], v[48:51]
  buffer_load_dwordx4 v235, s[12:15], s29 offen offset:3072 lds
  v_mfma_f32_16x16x32_bf16 v[48:51], a[136:139], v[168:171], v[48:51]
  v_exp_f32 v5, v5
  v_mfma_f32_16x16x32_bf16 v[48:51], a[140:143], v[172:175], v[48:51]
  v_cvt_pk_bf16_f32 v2, v4, v5
  v_mfma_f32_16x16x32_bf16 v[56:59], a[140:143], v[188:191], v[204:207]
  v_exp_f32 v6, v6
  v_mfma_f32_16x16x32_bf16 v[56:59], a[136:139], v[184:187], v[56:59]
  s_add_u32 m0, s50, 2048
  v_mfma_f32_16x16x32_bf16 v[56:59], a[132:135], v[180:183], v[56:59]
  s_waitcnt lgkmcnt(0)
  v_exp_f32 v7, v7
  v_mfma_f32_16x16x32_bf16 v[56:59], a[128:131], v[176:179], v[56:59]
  buffer_load_dwordx4 v226, s[20:23], s35 offen lds
  v_cvt_pk_bf16_f32 v3, v6, v7
  v_mfma_f32_16x16x32_bf16 v[36:39], a[144:147], v[128:131], v[192:195]
  v_exp_f32 v12, v12
  v_mfma_f32_16x16x32_bf16 v[36:39], a[148:151], v[132:135], v[36:39]
  ds_read_b64_tr_b16 a[160:161], v216 offset:49152
  v_mfma_f32_16x16x32_bf16 v[36:39], a[152:155], v[136:139], v[36:39]
  v_exp_f32 v13, v13
  v_mfma_f32_16x16x32_bf16 v[36:39], a[156:159], v[140:143], v[36:39]
  ds_read_b64_tr_b16 a[162:163], v216 offset:53248
  v_cvt_pk_bf16_f32 v10, v12, v13
  v_mfma_f32_16x16x32_bf16 v[44:47], a[156:159], v[156:159], v[196:199]
  v_exp_f32 v14, v14
  v_mfma_f32_16x16x32_bf16 v[44:47], a[152:155], v[152:155], v[44:47]
  ds_read_b64_tr_b16 a[164:165], v216 offset:57344
  v_mfma_f32_16x16x32_bf16 v[44:47], a[148:151], v[148:151], v[44:47]
  v_exp_f32 v15, v15
  v_mfma_f32_16x16x32_bf16 v[44:47], a[144:147], v[144:147], v[44:47]
  ds_read_b64_tr_b16 a[166:167], v216 offset:61440
  v_cvt_pk_bf16_f32 v11, v14, v15
  v_mfma_f32_16x16x32_bf16 v[52:55], a[144:147], v[160:163], v[200:203]
  v_exp_f32 v20, v20
  v_mfma_f32_16x16x32_bf16 v[52:55], a[148:151], v[164:167], v[52:55]
  ds_read_b64_tr_b16 a[168:169], v217 offset:49152
  v_mfma_f32_16x16x32_bf16 v[52:55], a[152:155], v[168:171], v[52:55]
  v_exp_f32 v21, v21
  v_mfma_f32_16x16x32_bf16 v[52:55], a[156:159], v[172:175], v[52:55]
  ds_read_b64_tr_b16 a[170:171], v217 offset:53248
  v_cvt_pk_bf16_f32 v18, v20, v21
  v_mfma_f32_16x16x32_bf16 v[60:63], a[156:159], v[188:191], v[204:207]
  v_exp_f32 v22, v22
  v_mfma_f32_16x16x32_bf16 v[60:63], a[152:155], v[184:187], v[60:63]
  ds_read_b64_tr_b16 a[172:173], v217 offset:57344
  v_mfma_f32_16x16x32_bf16 v[60:63], a[148:151], v[180:183], v[60:63]
  v_exp_f32 v23, v23
  v_mfma_f32_16x16x32_bf16 v[60:63], a[144:147], v[176:179], v[60:63]
  ds_read_b64_tr_b16 a[174:175], v217 offset:61440
  v_cvt_pk_bf16_f32 v19, v22, v23
  v_mfma_f32_16x16x32_bf16 a[192:195], a[208:211], v[64:67], a[192:195]
  v_exp_f32 v28, v28
  v_mfma_f32_16x16x32_bf16 a[192:195], a[208:211], v[96:99], a[192:195]
  ds_read_b64_tr_b16 a[176:177], v218 offset:49152
  v_mfma_f32_16x16x32_bf16 a[196:199], a[208:211], v[72:75], a[196:199]
  v_exp_f32 v29, v29
  v_mfma_f32_16x16x32_bf16 a[196:199], a[208:211], v[104:107], a[196:199]
  ds_read_b64_tr_b16 a[178:179], v218 offset:53248
  v_cvt_pk_bf16_f32 v26, v28, v29
  v_mfma_f32_16x16x32_bf16 a[200:203], a[208:211], v[80:83], a[200:203]
  v_exp_f32 v30, v30
  v_mfma_f32_16x16x32_bf16 a[200:203], a[208:211], v[112:115], a[200:203]
  ds_read_b64_tr_b16 a[180:181], v218 offset:57344
  v_mfma_f32_16x16x32_bf16 a[204:207], a[208:211], v[88:91], a[204:207]
  s_waitcnt lgkmcnt(7)
  v_exp_f32 v31, v31
  v_mfma_f32_16x16x32_bf16 a[204:207], a[208:211], v[120:123], a[204:207]
  ds_read_b64_tr_b16 a[182:183], v218 offset:61440
  v_cvt_pk_bf16_f32 v27, v30, v31
  v_mfma_f32_16x16x32_bf16 a[0:3], a[160:163], v[64:67], a[0:3]
  v_exp_f32 v32, v32
  v_mfma_f32_16x16x32_bf16 a[0:3], a[164:167], v[96:99], a[0:3]
  ds_read_b64_tr_b16 a[184:185], v219 offset:49152
  v_mfma_f32_16x16x32_bf16 a[4:7], a[164:167], v[104:107], a[4:7]
  v_exp_f32 v33, v33
  v_mfma_f32_16x16x32_bf16 a[4:7], a[160:163], v[72:75], a[4:7]
  ds_read_b64_tr_b16 a[186:187], v219 offset:53248
  v_cvt_pk_bf16_f32 v32, v32, v33
  v_mfma_f32_16x16x32_bf16 a[8:11], a[160:163], v[80:83], a[8:11]
  v_exp_f32 v34, v34
  v_mfma_f32_16x16x32_bf16 a[8:11], a[164:167], v[112:115], a[8:11]
  ds_read_b64_tr_b16 a[188:189], v219 offset:57344
  v_mfma_f32_16x16x32_bf16 a[12:15], a[164:167], v[120:123], a[12:15]
  s_waitcnt lgkmcnt(7)
  v_exp_f32 v35, v35
  v_mfma_f32_16x16x32_bf16 a[12:15], a[160:163], v[88:91], a[12:15]
  ds_read_b64_tr_b16 a[190:191], v219 offset:61440
  v_cvt_pk_bf16_f32 v33, v34, v35
  v_mfma_f32_16x16x32_bf16 a[16:19], a[168:171], v[64:67], a[16:19]
  v_exp_f32 v40, v40
  v_mfma_f32_16x16x32_bf16 a[16:19], a[172:175], v[96:99], a[16:19]
  ds_read_b64_tr_b16 a[160:161], v220 offset:49152
  v_mfma_f32_16x16x32_bf16 a[20:23], a[172:175], v[104:107], a[20:23]
  v_exp_f32 v41, v41
  v_mfma_f32_16x16x32_bf16 a[20:23], a[168:171], v[72:75], a[20:23]
  ds_read_b64_tr_b16 a[162:163], v220 offset:53248
  v_cvt_pk_bf16_f32 v40, v40, v41
  v_mfma_f32_16x16x32_bf16 a[24:27], a[168:171], v[80:83], a[24:27]
  v_exp_f32 v42, v42
  v_mfma_f32_16x16x32_bf16 a[24:27], a[172:175], v[112:115], a[24:27]
  ds_read_b64_tr_b16 a[164:165], v220 offset:57344
  v_mfma_f32_16x16x32_bf16 a[28:31], a[172:175], v[120:123], a[28:31]
  s_waitcnt lgkmcnt(7)
  v_exp_f32 v43, v43
  v_mfma_f32_16x16x32_bf16 a[28:31], a[168:171], v[88:91], a[28:31]
  ds_read_b64_tr_b16 a[166:167], v220 offset:61440
  v_cvt_pk_bf16_f32 v41, v42, v43
  v_mfma_f32_16x16x32_bf16 a[32:35], a[176:179], v[64:67], a[32:35]
  v_exp_f32 v48, v48
  v_mfma_f32_16x16x32_bf16 a[32:35], a[180:183], v[96:99], a[32:35]
  ds_read_b64_tr_b16 a[168:169], v221 offset:49152
  v_mfma_f32_16x16x32_bf16 a[36:39], a[180:183], v[104:107], a[36:39]
  v_exp_f32 v49, v49
  v_mfma_f32_16x16x32_bf16 a[36:39], a[176:179], v[72:75], a[36:39]
  ds_read_b64_tr_b16 a[170:171], v221 offset:53248
  v_cvt_pk_bf16_f32 v48, v48, v49
  v_mfma_f32_16x16x32_bf16 a[40:43], a[176:179], v[80:83], a[40:43]
  v_exp_f32 v50, v50
  v_mfma_f32_16x16x32_bf16 a[40:43], a[180:183], v[112:115], a[40:43]
  ds_read_b64_tr_b16 a[172:173], v221 offset:57344
  v_mfma_f32_16x16x32_bf16 a[44:47], a[180:183], v[120:123], a[44:47]
  s_waitcnt lgkmcnt(7)
  v_exp_f32 v51, v51
  v_mfma_f32_16x16x32_bf16 a[44:47], a[176:179], v[88:91], a[44:47]
  ds_read_b64_tr_b16 a[174:175], v221 offset:61440
  v_cvt_pk_bf16_f32 v49, v50, v51
  v_mfma_f32_16x16x32_bf16 a[48:51], a[184:187], v[64:67], a[48:51]
  v_exp_f32 v56, v56
  v_mfma_f32_16x16x32_bf16 a[48:51], a[188:191], v[96:99], a[48:51]
  ds_read_b64_tr_b16 a[176:177], v222 offset:49152
  v_mfma_f32_16x16x32_bf16 a[52:55], a[188:191], v[104:107], a[52:55]
  v_exp_f32 v57, v57
  v_mfma_f32_16x16x32_bf16 a[52:55], a[184:187], v[72:75], a[52:55]
  ds_read_b64_tr_b16 a[178:179], v222 offset:53248
  v_cvt_pk_bf16_f32 v56, v56, v57
  v_mfma_f32_16x16x32_bf16 a[56:59], a[184:187], v[80:83], a[56:59]
  v_exp_f32 v58, v58
  v_mfma_f32_16x16x32_bf16 a[56:59], a[188:191], v[112:115], a[56:59]
  ds_read_b64_tr_b16 a[180:181], v222 offset:57344
  v_mfma_f32_16x16x32_bf16 a[60:63], a[188:191], v[120:123], a[60:63]
  s_waitcnt lgkmcnt(7)
  v_exp_f32 v59, v59
  v_mfma_f32_16x16x32_bf16 a[60:63], a[184:187], v[88:91], a[60:63]
  ds_read_b64_tr_b16 a[182:183], v222 offset:61440
  v_cvt_pk_bf16_f32 v57, v58, v59
  v_mfma_f32_16x16x32_bf16 a[64:67], a[160:163], v[64:67], a[64:67]
  v_exp_f32 v36, v36
  v_mfma_f32_16x16x32_bf16 a[64:67], a[164:167], v[96:99], a[64:67]
  ds_read_b64_tr_b16 a[184:185], v223 offset:49152
  v_mfma_f32_16x16x32_bf16 a[68:71], a[164:167], v[104:107], a[68:71]
  v_exp_f32 v37, v37
  v_mfma_f32_16x16x32_bf16 a[68:71], a[160:163], v[72:75], a[68:71]
  ds_read_b64_tr_b16 a[186:187], v223 offset:53248
  v_cvt_pk_bf16_f32 v34, v36, v37
  v_mfma_f32_16x16x32_bf16 a[72:75], a[160:163], v[80:83], a[72:75]
  v_exp_f32 v38, v38
  v_mfma_f32_16x16x32_bf16 a[72:75], a[164:167], v[112:115], a[72:75]
  ds_read_b64_tr_b16 a[188:189], v223 offset:57344
  v_mfma_f32_16x16x32_bf16 a[76:79], a[164:167], v[120:123], a[76:79]
  s_waitcnt lgkmcnt(7)
  v_exp_f32 v39, v39
  v_mfma_f32_16x16x32_bf16 a[76:79], a[160:163], v[88:91], a[76:79]
  ds_read_b64_tr_b16 a[190:191], v223 offset:61440
  v_cvt_pk_bf16_f32 v35, v38, v39
  v_mfma_f32_16x16x32_bf16 a[80:83], a[168:171], v[64:67], a[80:83]
  s_waitcnt vmcnt(11)
  v_exp_f32 v44, v44
  v_mfma_f32_16x16x32_bf16 a[80:83], a[172:175], v[96:99], a[80:83]
  v_mfma_f32_16x16x32_bf16 a[84:87], a[172:175], v[104:107], a[84:87]
  s_barrier
  v_exp_f32 v45, v45
  v_mfma_f32_16x16x32_bf16 a[84:87], a[168:171], v[72:75], a[84:87]
  ds_read_b128 a[128:131], v212 offset:16384
  v_cvt_pk_bf16_f32 v42, v44, v45
  v_mfma_f32_16x16x32_bf16 a[88:91], a[168:171], v[80:83], a[88:91]
  v_exp_f32 v46, v46
  v_mfma_f32_16x16x32_bf16 a[88:91], a[172:175], v[112:115], a[88:91]
  ds_read_b128 a[132:135], v213 offset:16384
  v_mfma_f32_16x16x32_bf16 a[92:95], a[172:175], v[120:123], a[92:95]
  s_waitcnt lgkmcnt(6)
  v_exp_f32 v47, v47
  v_mfma_f32_16x16x32_bf16 a[92:95], a[168:171], v[88:91], a[92:95]
  ds_read_b128 a[136:139], v214 offset:16384
  v_cvt_pk_bf16_f32 v43, v46, v47
  v_mfma_f32_16x16x32_bf16 a[96:99], a[176:179], v[64:67], a[96:99]
  v_exp_f32 v52, v52
  v_mfma_f32_16x16x32_bf16 a[96:99], a[180:183], v[96:99], a[96:99]
  ds_read_b128 a[140:143], v215 offset:16384
  buffer_load_dwordx4 a[224:227], v243, s[24:27], s38 offen sc1
  s_add_u32 s38, s38, 4096
  v_mfma_f32_16x16x32_bf16 a[100:103], a[180:183], v[104:107], a[100:103]
  v_exp_f32 v53, v53
  v_mfma_f32_16x16x32_bf16 a[100:103], a[176:179], v[72:75], a[100:103]
  v_cvt_pk_bf16_f32 v50, v52, v53
  v_mfma_f32_16x16x32_bf16 a[104:107], a[176:179], v[80:83], a[104:107]
  v_exp_f32 v54, v54
  v_mfma_f32_16x16x32_bf16 a[104:107], a[180:183], v[112:115], a[104:107]
  v_mfma_f32_16x16x32_bf16 a[108:111], a[180:183], v[120:123], a[108:111]
  s_waitcnt lgkmcnt(4)
  v_exp_f32 v55, v55
  v_mfma_f32_16x16x32_bf16 a[108:111], a[176:179], v[88:91], a[108:111]
  v_cvt_pk_bf16_f32 v51, v54, v55
  v_mfma_f32_16x16x32_bf16 a[112:115], a[184:187], v[64:67], a[112:115]
  v_exp_f32 v60, v60
  v_mfma_f32_16x16x32_bf16 a[112:115], a[188:191], v[96:99], a[112:115]
  v_mfma_f32_16x16x32_bf16 a[116:119], a[188:191], v[104:107], a[116:119]
  v_exp_f32 v61, v61
  v_mfma_f32_16x16x32_bf16 a[116:119], a[184:187], v[72:75], a[116:119]
  v_cvt_pk_bf16_f32 v58, v60, v61
  v_mfma_f32_16x16x32_bf16 a[120:123], a[184:187], v[80:83], a[120:123]
  v_exp_f32 v62, v62
  v_mfma_f32_16x16x32_bf16 a[120:123], a[188:191], v[112:115], a[120:123]
  v_mfma_f32_16x16x32_bf16 a[124:127], a[188:191], v[120:123], a[124:127]
  s_waitcnt lgkmcnt(0)
  v_exp_f32 v63, v63
  v_mfma_f32_16x16x32_bf16 a[124:127], a[184:187], v[88:91], a[124:127]
  v_cvt_pk_bf16_f32 v59, v62, v63
  v_mfma_f32_16x16x32_bf16 v[64:67], a[128:131], v[128:131], v[192:195]
  s_add_u32 m0, s28, 98304
  v_mfma_f32_16x16x32_bf16 v[64:67], a[132:135], v[132:135], v[64:67]
  ds_read_b128 a[144:147], v212 offset:20480
  v_mfma_f32_16x16x32_bf16 v[64:67], a[136:139], v[136:139], v[64:67]
  buffer_load_dwordx4 v236, s[16:19], s29 offen offset:0 lds
  v_mfma_f32_16x16x32_bf16 v[64:67], a[140:143], v[140:143], v[64:67]
  ds_read_b128 a[148:151], v213 offset:20480
  v_mfma_f32_16x16x32_bf16 v[72:75], a[140:143], v[156:159], v[196:199]
  buffer_load_dwordx4 v237, s[16:19], s29 offen offset:1024 lds
  v_mfma_f32_16x16x32_bf16 v[72:75], a[136:139], v[152:155], v[72:75]
  ds_read_b128 a[152:155], v214 offset:20480
  v_mfma_f32_16x16x32_bf16 v[72:75], a[132:135], v[148:151], v[72:75]
  buffer_load_dwordx4 v236, s[16:19], s29 offen offset:2048 lds
  v_mfma_f32_16x16x32_bf16 v[72:75], a[128:131], v[144:147], v[72:75]
  ds_read_b128 a[156:159], v215 offset:20480
  v_mfma_f32_16x16x32_bf16 v[80:83], a[128:131], v[160:163], v[200:203]
  v_exp_f32 v64, v64
  v_mfma_f32_16x16x32_bf16 v[80:83], a[132:135], v[164:167], v[80:83]
  buffer_load_dwordx4 v237, s[16:19], s29 offen offset:3072 lds
  v_mfma_f32_16x16x32_bf16 v[80:83], a[136:139], v[168:171], v[80:83]
  s_add_u32 s29, s29, 16384
  v_exp_f32 v65, v65
  v_mfma_f32_16x16x32_bf16 v[80:83], a[140:143], v[172:175], v[80:83]
  v_cvt_pk_bf16_f32 v64, v64, v65
  v_mfma_f32_16x16x32_bf16 v[88:91], a[140:143], v[188:191], v[204:207]
  s_add_u32 m0, s28, 49152
  v_exp_f32 v66, v66
  v_mfma_f32_16x16x32_bf16 v[88:91], a[136:139], v[184:187], v[88:91]
  buffer_load_dwordx4 v232, s[12:15], s29 offen offset:0 lds
  v_mfma_f32_16x16x32_bf16 v[88:91], a[132:135], v[180:183], v[88:91]
  s_waitcnt lgkmcnt(0)
  v_exp_f32 v67, v67
  v_mfma_f32_16x16x32_bf16 v[88:91], a[128:131], v[176:179], v[88:91]
  v_cvt_pk_bf16_f32 v65, v66, v67
  v_mfma_f32_16x16x32_bf16 v[68:71], a[144:147], v[128:131], v[192:195]
  v_exp_f32 v72, v72
  v_mfma_f32_16x16x32_bf16 v[68:71], a[148:151], v[132:135], v[68:71]
  ds_read_b128 a[128:131], v212 offset:24576
  v_mfma_f32_16x16x32_bf16 v[68:71], a[152:155], v[136:139], v[68:71]
  v_exp_f32 v73, v73
  v_mfma_f32_16x16x32_bf16 v[68:71], a[156:159], v[140:143], v[68:71]
  ds_read_b128 a[132:135], v213 offset:24576
  v_cvt_pk_bf16_f32 v72, v72, v73
  v_mfma_f32_16x16x32_bf16 v[76:79], a[156:159], v[156:159], v[196:199]
  v_exp_f32 v74, v74
  v_mfma_f32_16x16x32_bf16 v[76:79], a[152:155], v[152:155], v[76:79]
  ds_read_b128 a[136:139], v214 offset:24576
  v_mfma_f32_16x16x32_bf16 v[76:79], a[148:151], v[148:151], v[76:79]
  v_exp_f32 v75, v75
  v_mfma_f32_16x16x32_bf16 v[76:79], a[144:147], v[144:147], v[76:79]
  ds_read_b128 a[140:143], v215 offset:24576
  v_cvt_pk_bf16_f32 v73, v74, v75
  v_mfma_f32_16x16x32_bf16 v[84:87], a[144:147], v[160:163], v[200:203]
  v_exp_f32 v80, v80
  v_mfma_f32_16x16x32_bf16 v[84:87], a[148:151], v[164:167], v[84:87]
  buffer_load_dwordx4 v233, s[12:15], s29 offen offset:1024 lds
  v_mfma_f32_16x16x32_bf16 v[84:87], a[152:155], v[168:171], v[84:87]
  v_exp_f32 v81, v81
  v_mfma_f32_16x16x32_bf16 v[84:87], a[156:159], v[172:175], v[84:87]
  v_cvt_pk_bf16_f32 v80, v80, v81
  v_mfma_f32_16x16x32_bf16 v[92:95], a[156:159], v[188:191], v[204:207]
  v_exp_f32 v82, v82
  v_mfma_f32_16x16x32_bf16 v[92:95], a[152:155], v[184:187], v[92:95]
  buffer_load_dwordx4 v234, s[12:15], s29 offen offset:2048 lds
  v_mfma_f32_16x16x32_bf16 v[92:95], a[148:151], v[180:183], v[92:95]
  s_waitcnt lgkmcnt(0)
  v_exp_f32 v83, v83
  v_mfma_f32_16x16x32_bf16 v[92:95], a[144:147], v[176:179], v[92:95]
  v_cvt_pk_bf16_f32 v81, v82, v83
  v_mfma_f32_16x16x32_bf16 v[96:99], a[128:131], v[128:131], v[192:195]
  v_exp_f32 v88, v88
  v_mfma_f32_16x16x32_bf16 v[96:99], a[132:135], v[132:135], v[96:99]
  ds_read_b128 a[144:147], v212 offset:28672
  v_mfma_f32_16x16x32_bf16 v[96:99], a[136:139], v[136:139], v[96:99]
  v_exp_f32 v89, v89
  v_mfma_f32_16x16x32_bf16 v[96:99], a[140:143], v[140:143], v[96:99]
  ds_read_b128 a[148:151], v213 offset:28672
  v_cvt_pk_bf16_f32 v88, v88, v89
  v_mfma_f32_16x16x32_bf16 v[104:107], a[140:143], v[156:159], v[196:199]
  v_exp_f32 v90, v90
  v_mfma_f32_16x16x32_bf16 v[104:107], a[136:139], v[152:155], v[104:107]
  ds_read_b128 a[152:155], v214 offset:28672
  v_mfma_f32_16x16x32_bf16 v[104:107], a[132:135], v[148:151], v[104:107]
  v_exp_f32 v91, v91
  v_mfma_f32_16x16x32_bf16 v[104:107], a[128:131], v[144:147], v[104:107]
  ds_read_b128 a[156:159], v215 offset:28672
  v_cvt_pk_bf16_f32 v89, v90, v91
  v_mfma_f32_16x16x32_bf16 v[112:115], a[128:131], v[160:163], v[200:203]
  v_exp_f32 v68, v68
  v_mfma_f32_16x16x32_bf16 v[112:115], a[132:135], v[164:167], v[112:115]
  buffer_load_dwordx4 v235, s[12:15], s29 offen offset:3072 lds
  v_mfma_f32_16x16x32_bf16 v[112:115], a[136:139], v[168:171], v[112:115]
  v_exp_f32 v69, v69
  v_mfma_f32_16x16x32_bf16 v[112:115], a[140:143], v[172:175], v[112:115]
  v_cvt_pk_bf16_f32 v66, v68, v69
  v_mfma_f32_16x16x32_bf16 v[120:123], a[140:143], v[188:191], v[204:207]
  v_exp_f32 v70, v70
  v_mfma_f32_16x16x32_bf16 v[120:123], a[136:139], v[184:187], v[120:123]
  s_add_u32 m0, s50, 5120
  v_mfma_f32_16x16x32_bf16 v[120:123], a[132:135], v[180:183], v[120:123]
  s_waitcnt lgkmcnt(0)
  v_exp_f32 v71, v71
  v_mfma_f32_16x16x32_bf16 v[120:123], a[128:131], v[176:179], v[120:123]
  buffer_load_dwordx4 v226, s[44:47], s35 offen lds
  s_add_u32 s35, s35, 221184
  v_cvt_pk_bf16_f32 v67, v70, v71
  v_mfma_f32_16x16x32_bf16 v[100:103], a[144:147], v[128:131], v[192:195]
  v_exp_f32 v76, v76
  v_mfma_f32_16x16x32_bf16 v[100:103], a[148:151], v[132:135], v[100:103]
  ds_read_b64_tr_b16 a[160:161], v216 offset:0
  v_mfma_f32_16x16x32_bf16 v[100:103], a[152:155], v[136:139], v[100:103]
  v_exp_f32 v77, v77
  v_mfma_f32_16x16x32_bf16 v[100:103], a[156:159], v[140:143], v[100:103]
  ds_read_b64_tr_b16 a[162:163], v216 offset:4096
  v_cvt_pk_bf16_f32 v74, v76, v77
  v_mfma_f32_16x16x32_bf16 v[108:111], a[156:159], v[156:159], v[196:199]
  v_exp_f32 v78, v78
  v_mfma_f32_16x16x32_bf16 v[108:111], a[152:155], v[152:155], v[108:111]
  ds_read_b64_tr_b16 a[164:165], v216 offset:8192
  v_mfma_f32_16x16x32_bf16 v[108:111], a[148:151], v[148:151], v[108:111]
  v_exp_f32 v79, v79
  v_mfma_f32_16x16x32_bf16 v[108:111], a[144:147], v[144:147], v[108:111]
  ds_read_b64_tr_b16 a[166:167], v216 offset:12288
  v_cvt_pk_bf16_f32 v75, v78, v79
  v_mfma_f32_16x16x32_bf16 v[116:119], a[144:147], v[160:163], v[200:203]
  v_exp_f32 v84, v84
  v_mfma_f32_16x16x32_bf16 v[116:119], a[148:151], v[164:167], v[116:119]
  ds_read_b64_tr_b16 a[168:169], v217 offset:0
  v_mfma_f32_16x16x32_bf16 v[116:119], a[152:155], v[168:171], v[116:119]
  v_exp_f32 v85, v85
  v_mfma_f32_16x16x32_bf16 v[116:119], a[156:159], v[172:175], v[116:119]
  ds_read_b64_tr_b16 a[170:171], v217 offset:4096
  v_cvt_pk_bf16_f32 v82, v84, v85
  v_mfma_f32_16x16x32_bf16 v[124:127], a[156:159], v[188:191], v[204:207]
  v_exp_f32 v86, v86
  v_mfma_f32_16x16x32_bf16 v[124:127], a[152:155], v[184:187], v[124:127]
  ds_read_b64_tr_b16 a[172:173], v217 offset:8192
  v_mfma_f32_16x16x32_bf16 v[124:127], a[148:151], v[180:183], v[124:127]
  v_exp_f32 v87, v87
  v_mfma_f32_16x16x32_bf16 v[124:127], a[144:147], v[176:179], v[124:127]
  ds_read_b64_tr_b16 a[174:175], v217 offset:12288
  v_cvt_pk_bf16_f32 v83, v86, v87
  v_mfma_f32_16x16x32_bf16 a[192:195], a[208:211], v[0:3], a[192:195]
  v_exp_f32 v92, v92
  v_mfma_f32_16x16x32_bf16 a[192:195], a[208:211], v[32:35], a[192:195]
  ds_read_b64_tr_b16 a[176:177], v218 offset:0
  v_mfma_f32_16x16x32_bf16 a[196:199], a[208:211], v[8:11], a[196:199]
  v_exp_f32 v93, v93
  v_mfma_f32_16x16x32_bf16 a[196:199], a[208:211], v[40:43], a[196:199]
  ds_read_b64_tr_b16 a[178:179], v218 offset:4096
  v_cvt_pk_bf16_f32 v90, v92, v93
  v_mfma_f32_16x16x32_bf16 a[200:203], a[208:211], v[16:19], a[200:203]
  v_exp_f32 v94, v94
  v_mfma_f32_16x16x32_bf16 a[200:203], a[208:211], v[48:51], a[200:203]
  ds_read_b64_tr_b16 a[180:181], v218 offset:8192
  v_mfma_f32_16x16x32_bf16 a[204:207], a[208:211], v[24:27], a[204:207]
  s_waitcnt lgkmcnt(7)
  v_exp_f32 v95, v95
  v_mfma_f32_16x16x32_bf16 a[204:207], a[208:211], v[56:59], a[204:207]
  ds_read_b64_tr_b16 a[182:183], v218 offset:12288
  v_cvt_pk_bf16_f32 v91, v94, v95
  v_mfma_f32_16x16x32_bf16 a[0:3], a[160:163], v[0:3], a[0:3]
  v_exp_f32 v96, v96
  v_mfma_f32_16x16x32_bf16 a[0:3], a[164:167], v[32:35], a[0:3]
  ds_read_b64_tr_b16 a[184:185], v219 offset:0
  v_mfma_f32_16x16x32_bf16 a[4:7], a[164:167], v[40:43], a[4:7]
  v_exp_f32 v97, v97
  v_mfma_f32_16x16x32_bf16 a[4:7], a[160:163], v[8:11], a[4:7]
  ds_read_b64_tr_b16 a[186:187], v219 offset:4096
  v_cvt_pk_bf16_f32 v96, v96, v97
  v_mfma_f32_16x16x32_bf16 a[8:11], a[160:163], v[16:19], a[8:11]
  v_exp_f32 v98, v98
  v_mfma_f32_16x16x32_bf16 a[8:11], a[164:167], v[48:51], a[8:11]
  ds_read_b64_tr_b16 a[188:189], v219 offset:8192
  v_mfma_f32_16x16x32_bf16 a[12:15], a[164:167], v[56:59], a[12:15]
  s_waitcnt lgkmcnt(7)
  v_exp_f32 v99, v99
  v_mfma_f32_16x16x32_bf16 a[12:15], a[160:163], v[24:27], a[12:15]
  ds_read_b64_tr_b16 a[190:191], v219 offset:12288
  v_cvt_pk_bf16_f32 v97, v98, v99
  v_mfma_f32_16x16x32_bf16 a[16:19], a[168:171], v[0:3], a[16:19]
  v_exp_f32 v104, v104
  v_mfma_f32_16x16x32_bf16 a[16:19], a[172:175], v[32:35], a[16:19]
  ds_read_b64_tr_b16 a[160:161], v220 offset:0
  v_mfma_f32_16x16x32_bf16 a[20:23], a[172:175], v[40:43], a[20:23]
  v_exp_f32 v105, v105
  v_mfma_f32_16x16x32_bf16 a[20:23], a[168:171], v[8:11], a[20:23]
  ds_read_b64_tr_b16 a[162:163], v220 offset:4096
  v_cvt_pk_bf16_f32 v104, v104, v105
  v_mfma_f32_16x16x32_bf16 a[24:27], a[168:171], v[16:19], a[24:27]
  v_exp_f32 v106, v106
  v_mfma_f32_16x16x32_bf16 a[24:27], a[172:175], v[48:51], a[24:27]
  ds_read_b64_tr_b16 a[164:165], v220 offset:8192
  v_mfma_f32_16x16x32_bf16 a[28:31], a[172:175], v[56:59], a[28:31]
  s_waitcnt lgkmcnt(7)
  v_exp_f32 v107, v107
  v_mfma_f32_16x16x32_bf16 a[28:31], a[168:171], v[24:27], a[28:31]
  ds_read_b64_tr_b16 a[166:167], v220 offset:12288
  v_cvt_pk_bf16_f32 v105, v106, v107
  v_mfma_f32_16x16x32_bf16 a[32:35], a[176:179], v[0:3], a[32:35]
  v_exp_f32 v112, v112
  v_mfma_f32_16x16x32_bf16 a[32:35], a[180:183], v[32:35], a[32:35]
  ds_read_b64_tr_b16 a[168:169], v221 offset:0
  v_mfma_f32_16x16x32_bf16 a[36:39], a[180:183], v[40:43], a[36:39]
  v_exp_f32 v113, v113
  v_mfma_f32_16x16x32_bf16 a[36:39], a[176:179], v[8:11], a[36:39]
  ds_read_b64_tr_b16 a[170:171], v221 offset:4096
  v_cvt_pk_bf16_f32 v112, v112, v113
  v_mfma_f32_16x16x32_bf16 a[40:43], a[176:179], v[16:19], a[40:43]
  v_exp_f32 v114, v114
  v_mfma_f32_16x16x32_bf16 a[40:43], a[180:183], v[48:51], a[40:43]
  ds_read_b64_tr_b16 a[172:173], v221 offset:8192
  v_mfma_f32_16x16x32_bf16 a[44:47], a[180:183], v[56:59], a[44:47]
  s_waitcnt lgkmcnt(7)
  v_exp_f32 v115, v115
  v_mfma_f32_16x16x32_bf16 a[44:47], a[176:179], v[24:27], a[44:47]
  ds_read_b64_tr_b16 a[174:175], v221 offset:12288
  v_cvt_pk_bf16_f32 v113, v114, v115
  v_mfma_f32_16x16x32_bf16 a[48:51], a[184:187], v[0:3], a[48:51]
  v_exp_f32 v120, v120
  v_mfma_f32_16x16x32_bf16 a[48:51], a[188:191], v[32:35], a[48:51]
  ds_read_b64_tr_b16 a[176:177], v222 offset:0
  v_mfma_f32_16x16x32_bf16 a[52:55], a[188:191], v[40:43], a[52:55]
  v_exp_f32 v121, v121
  v_mfma_f32_16x16x32_bf16 a[52:55], a[184:187], v[8:11], a[52:55]
  ds_read_b64_tr_b16 a[178:179], v222 offset:4096
  v_cvt_pk_bf16_f32 v120, v120, v121
  v_mfma_f32_16x16x32_bf16 a[56:59], a[184:187], v[16:19], a[56:59]
  v_exp_f32 v122, v122
  v_mfma_f32_16x16x32_bf16 a[56:59], a[188:191], v[48:51], a[56:59]
  ds_read_b64_tr_b16 a[180:181], v222 offset:8192
  v_mfma_f32_16x16x32_bf16 a[60:63], a[188:191], v[56:59], a[60:63]
  s_waitcnt lgkmcnt(7)
  v_exp_f32 v123, v123
  v_mfma_f32_16x16x32_bf16 a[60:63], a[184:187], v[24:27], a[60:63]
  ds_read_b64_tr_b16 a[182:183], v222 offset:12288
  v_cvt_pk_bf16_f32 v121, v122, v123
  v_mfma_f32_16x16x32_bf16 a[64:67], a[160:163], v[0:3], a[64:67]
  v_exp_f32 v100, v100
  v_mfma_f32_16x16x32_bf16 a[64:67], a[164:167], v[32:35], a[64:67]
  ds_read_b64_tr_b16 a[184:185], v223 offset:0
  v_mfma_f32_16x16x32_bf16 a[68:71], a[164:167], v[40:43], a[68:71]
  v_exp_f32 v101, v101
  v_mfma_f32_16x16x32_bf16 a[68:71], a[160:163], v[8:11], a[68:71]
  ds_read_b64_tr_b16 a[186:187], v223 offset:4096
  v_cvt_pk_bf16_f32 v98, v100, v101
  v_mfma_f32_16x16x32_bf16 a[72:75], a[160:163], v[16:19], a[72:75]
  v_exp_f32 v102, v102
  v_mfma_f32_16x16x32_bf16 a[72:75], a[164:167], v[48:51], a[72:75]
  ds_read_b64_tr_b16 a[188:189], v223 offset:8192
  v_mfma_f32_16x16x32_bf16 a[76:79], a[164:167], v[56:59], a[76:79]
  s_waitcnt lgkmcnt(7)
  v_exp_f32 v103, v103
  v_mfma_f32_16x16x32_bf16 a[76:79], a[160:163], v[24:27], a[76:79]
  ds_read_b64_tr_b16 a[190:191], v223 offset:12288
  v_cvt_pk_bf16_f32 v99, v102, v103
  v_mfma_f32_16x16x32_bf16 a[80:83], a[168:171], v[0:3], a[80:83]
  s_waitcnt vmcnt(11)
  v_exp_f32 v108, v108
  v_mfma_f32_16x16x32_bf16 a[80:83], a[172:175], v[32:35], a[80:83]
  v_mfma_f32_16x16x32_bf16 a[84:87], a[172:175], v[40:43], a[84:87]
  s_barrier
  v_exp_f32 v109, v109
  v_mfma_f32_16x16x32_bf16 a[84:87], a[168:171], v[8:11], a[84:87]
  ds_read_b128 a[128:131], v212 offset:32768
  v_cvt_pk_bf16_f32 v106, v108, v109
  v_mfma_f32_16x16x32_bf16 a[88:91], a[168:171], v[16:19], a[88:91]
  v_exp_f32 v110, v110
  v_mfma_f32_16x16x32_bf16 a[88:91], a[172:175], v[48:51], a[88:91]
  ds_read_b128 a[132:135], v213 offset:32768
  v_mfma_f32_16x16x32_bf16 a[92:95], a[172:175], v[56:59], a[92:95]
  s_waitcnt lgkmcnt(6)
  v_exp_f32 v111, v111
  v_mfma_f32_16x16x32_bf16 a[92:95], a[168:171], v[24:27], a[92:95]
  ds_read_b128 a[136:139], v214 offset:32768
  v_cvt_pk_bf16_f32 v107, v110, v111
  v_mfma_f32_16x16x32_bf16 a[96:99], a[176:179], v[0:3], a[96:99]
  v_exp_f32 v116, v116
  v_mfma_f32_16x16x32_bf16 a[96:99], a[180:183], v[32:35], a[96:99]
  ds_read_b128 a[140:143], v215 offset:32768
  buffer_load_dwordx4 a[228:231], v243, s[24:27], s38 offen sc1
  s_add_u32 s38, s38, 4096
  v_mfma_f32_16x16x32_bf16 a[100:103], a[180:183], v[40:43], a[100:103]
  v_exp_f32 v117, v117
  v_mfma_f32_16x16x32_bf16 a[100:103], a[176:179], v[8:11], a[100:103]
  v_cvt_pk_bf16_f32 v114, v116, v117
  v_mfma_f32_16x16x32_bf16 a[104:107], a[176:179], v[16:19], a[104:107]
  v_exp_f32 v118, v118
  v_mfma_f32_16x16x32_bf16 a[104:107], a[180:183], v[48:51], a[104:107]
  v_mfma_f32_16x16x32_bf16 a[108:111], a[180:183], v[56:59], a[108:111]
  s_waitcnt lgkmcnt(4)
  v_exp_f32 v119, v119
  v_mfma_f32_16x16x32_bf16 a[108:111], a[176:179], v[24:27], a[108:111]
  v_cvt_pk_bf16_f32 v115, v118, v119
  v_mfma_f32_16x16x32_bf16 a[112:115], a[184:187], v[0:3], a[112:115]
  v_exp_f32 v124, v124
  v_mfma_f32_16x16x32_bf16 a[112:115], a[188:191], v[32:35], a[112:115]
  v_mfma_f32_16x16x32_bf16 a[116:119], a[188:191], v[40:43], a[116:119]
  v_exp_f32 v125, v125
  v_mfma_f32_16x16x32_bf16 a[116:119], a[184:187], v[8:11], a[116:119]
  v_cvt_pk_bf16_f32 v122, v124, v125
  v_mfma_f32_16x16x32_bf16 a[120:123], a[184:187], v[16:19], a[120:123]
  v_exp_f32 v126, v126
  v_mfma_f32_16x16x32_bf16 a[120:123], a[188:191], v[48:51], a[120:123]
  v_mfma_f32_16x16x32_bf16 a[124:127], a[188:191], v[56:59], a[124:127]
  s_waitcnt lgkmcnt(0)
  v_exp_f32 v127, v127
  v_mfma_f32_16x16x32_bf16 a[124:127], a[184:187], v[24:27], a[124:127]
  v_cvt_pk_bf16_f32 v123, v126, v127
  v_mfma_f32_16x16x32_bf16 v[0:3], a[128:131], v[128:131], v[192:195]
  s_add_u32 m0, s28, 114688
  s_mov_b32 s20, s88
  v_mfma_f32_16x16x32_bf16 v[0:3], a[132:135], v[132:135], v[0:3]
  ds_read_b128 a[144:147], v212 offset:36864
  s_mov_b32 s21, s89
  s_mov_b32 s22, 5242880
  v_mfma_f32_16x16x32_bf16 v[0:3], a[136:139], v[136:139], v[0:3]
  buffer_load_dwordx4 v236, s[16:19], s29 offen offset:0 lds
  s_mov_b32 s23, 0x20000
  v_mfma_f32_16x16x32_bf16 v[0:3], a[140:143], v[140:143], v[0:3]
  ds_read_b128 a[148:151], v213 offset:36864
  v_lshrrev_b32 v208, 4, v242
  v_mfma_f32_16x16x32_bf16 v[8:11], a[140:143], v[156:159], v[196:199]
  buffer_load_dwordx4 v237, s[16:19], s29 offen offset:1024 lds
  v_mfma_f32_16x16x32_bf16 v[8:11], a[136:139], v[152:155], v[8:11]
  ds_read_b128 a[152:155], v214 offset:36864
  v_and_b32 v209, 1, v208
  v_mfma_f32_16x16x32_bf16 v[8:11], a[132:135], v[148:151], v[8:11]
  buffer_load_dwordx4 v236, s[16:19], s29 offen offset:2048 lds
  v_mfma_f32_16x16x32_bf16 v[8:11], a[128:131], v[144:147], v[8:11]
  ds_read_b128 a[156:159], v215 offset:36864
  v_lshrrev_b32 v208, 1, v208
  v_mfma_f32_16x16x32_bf16 v[16:19], a[128:131], v[160:163], v[200:203]
  v_exp_f32 v0, v0
  v_mfma_f32_16x16x32_bf16 v[16:19], a[132:135], v[164:167], v[16:19]
  buffer_load_dwordx4 v237, s[16:19], s29 offen offset:3072 lds
  v_mfma_f32_16x16x32_bf16 v[16:19], a[136:139], v[168:171], v[16:19]
  s_add_u32 s29, s29, 16384
  v_exp_f32 v1, v1
  v_mfma_f32_16x16x32_bf16 v[16:19], a[140:143], v[172:175], v[16:19]
  v_cvt_pk_bf16_f32 v0, v0, v1
  v_mul_u32_u24 v208, 0x500, v208
  v_mfma_f32_16x16x32_bf16 v[24:27], a[140:143], v[188:191], v[204:207]
  s_add_u32 m0, s28, 0
  v_exp_f32 v2, v2
  v_mfma_f32_16x16x32_bf16 v[24:27], a[136:139], v[184:187], v[24:27]
  buffer_load_dwordx4 v232, s[12:15], s29 offen offset:0 lds
  v_mfma_f32_16x16x32_bf16 v[24:27], a[132:135], v[180:183], v[24:27]
  s_waitcnt lgkmcnt(0)
  v_exp_f32 v3, v3
  v_mfma_f32_16x16x32_bf16 v[24:27], a[128:131], v[176:179], v[24:27]
  v_cvt_pk_bf16_f32 v1, v2, v3
  v_lshl_add_u32 v208, v209, 4, v208
  v_mfma_f32_16x16x32_bf16 v[4:7], a[144:147], v[128:131], v[192:195]
  v_exp_f32 v8, v8
  v_mfma_f32_16x16x32_bf16 v[4:7], a[148:151], v[132:135], v[4:7]
  ds_read_b128 a[128:131], v212 offset:40960
  v_lshrrev_b32 v209, 4, v242
  v_mfma_f32_16x16x32_bf16 v[4:7], a[152:155], v[136:139], v[4:7]
  v_exp_f32 v9, v9
  v_mfma_f32_16x16x32_bf16 v[4:7], a[156:159], v[140:143], v[4:7]
  ds_read_b128 a[132:135], v213 offset:40960
  v_cvt_pk_bf16_f32 v8, v8, v9
  v_mfma_f32_16x16x32_bf16 v[12:15], a[156:159], v[156:159], v[196:199]
  v_exp_f32 v10, v10
  v_mfma_f32_16x16x32_bf16 v[12:15], a[152:155], v[152:155], v[12:15]
  ds_read_b128 a[136:139], v214 offset:40960
  v_lshrrev_b32 v210, 5, v209
  v_mfma_f32_16x16x32_bf16 v[12:15], a[148:151], v[148:151], v[12:15]
  v_exp_f32 v11, v11
  v_mfma_f32_16x16x32_bf16 v[12:15], a[144:147], v[144:147], v[12:15]
  ds_read_b128 a[140:143], v215 offset:40960
  v_cvt_pk_bf16_f32 v9, v10, v11
  v_mfma_f32_16x16x32_bf16 v[20:23], a[144:147], v[160:163], v[200:203]
  v_exp_f32 v16, v16
  v_mfma_f32_16x16x32_bf16 v[20:23], a[148:151], v[164:167], v[20:23]
  buffer_load_dwordx4 v233, s[12:15], s29 offen offset:1024 lds
  v_mfma_f32_16x16x32_bf16 v[20:23], a[152:155], v[168:171], v[20:23]
  v_exp_f32 v17, v17
  v_mfma_f32_16x16x32_bf16 v[20:23], a[156:159], v[172:175], v[20:23]
  v_cvt_pk_bf16_f32 v16, v16, v17
  v_lshlrev_b32 v210, 30, v210
  v_mfma_f32_16x16x32_bf16 v[28:31], a[156:159], v[188:191], v[204:207]
  v_exp_f32 v18, v18
  v_mfma_f32_16x16x32_bf16 v[28:31], a[152:155], v[184:187], v[28:31]
  buffer_load_dwordx4 v234, s[12:15], s29 offen offset:2048 lds
  v_mfma_f32_16x16x32_bf16 v[28:31], a[148:151], v[180:183], v[28:31]
  s_waitcnt lgkmcnt(0)
  v_exp_f32 v19, v19
  v_mfma_f32_16x16x32_bf16 v[28:31], a[144:147], v[176:179], v[28:31]
  v_cvt_pk_bf16_f32 v17, v18, v19
  v_or_b32 v210, v210, v208
  v_mfma_f32_16x16x32_bf16 v[32:35], a[128:131], v[128:131], v[192:195]
  v_exp_f32 v24, v24
  v_mfma_f32_16x16x32_bf16 v[32:35], a[132:135], v[132:135], v[32:35]
  ds_read_b128 a[144:147], v212 offset:45056
  v_bfe_u32 v211, v209, 2, 4
  v_mfma_f32_16x16x32_bf16 v[32:35], a[136:139], v[136:139], v[32:35]
  v_exp_f32 v25, v25
  v_mfma_f32_16x16x32_bf16 v[32:35], a[140:143], v[140:143], v[32:35]
  ds_read_b128 a[148:151], v213 offset:45056
  v_cvt_pk_bf16_f32 v24, v24, v25
  v_mfma_f32_16x16x32_bf16 v[40:43], a[140:143], v[156:159], v[196:199]
  v_exp_f32 v26, v26
  v_mfma_f32_16x16x32_bf16 v[40:43], a[136:139], v[152:155], v[40:43]
  ds_read_b128 a[152:155], v214 offset:45056
  v_and_b32 v209, 3, v209
  v_mfma_f32_16x16x32_bf16 v[40:43], a[132:135], v[148:151], v[40:43]
  v_exp_f32 v27, v27
  v_mfma_f32_16x16x32_bf16 v[40:43], a[128:131], v[144:147], v[40:43]
  ds_read_b128 a[156:159], v215 offset:45056
  v_cvt_pk_bf16_f32 v25, v26, v27
  v_mfma_f32_16x16x32_bf16 v[48:51], a[128:131], v[160:163], v[200:203]
  v_exp_f32 v4, v4
  v_mfma_f32_16x16x32_bf16 v[48:51], a[132:135], v[164:167], v[48:51]
  buffer_load_dwordx4 v235, s[12:15], s29 offen offset:3072 lds
  v_mfma_f32_16x16x32_bf16 v[48:51], a[136:139], v[168:171], v[48:51]
  v_exp_f32 v5, v5
  v_mfma_f32_16x16x32_bf16 v[48:51], a[140:143], v[172:175], v[48:51]
  v_cvt_pk_bf16_f32 v2, v4, v5
  v_lshlrev_b32 v209, 3, v209
  v_mfma_f32_16x16x32_bf16 v[56:59], a[140:143], v[188:191], v[204:207]
  v_exp_f32 v6, v6
  v_mfma_f32_16x16x32_bf16 v[56:59], a[136:139], v[184:187], v[56:59]
  v_lshl_add_u32 v209, v211, 5, v209
  v_add_u32 v209, s50, v209
  v_mfma_f32_16x16x32_bf16 v[56:59], a[132:135], v[180:183], v[56:59]
  s_waitcnt lgkmcnt(0)
  s_and_b32 s39, s2, 1
  v_exp_f32 v7, v7
  v_mfma_f32_16x16x32_bf16 v[56:59], a[128:131], v[176:179], v[56:59]
  s_lshl_b32 s39, s39, 2
  s_add_u32 s39, s39, s3
  v_cvt_pk_bf16_f32 v3, v6, v7
  v_mfma_f32_16x16x32_bf16 v[36:39], a[144:147], v[128:131], v[192:195]
  s_lshr_b32 s31, s2, 1
  s_mul_i32 s30, s31, 40960
  v_exp_f32 v12, v12
  v_mfma_f32_16x16x32_bf16 v[36:39], a[148:151], v[132:135], v[36:39]
  ds_read_b64_tr_b16 a[160:161], v216 offset:16384
  s_mul_i32 s48, s39, 160
  s_add_u32 s30, s30, s48
  v_mfma_f32_16x16x32_bf16 v[36:39], a[152:155], v[136:139], v[36:39]
  s_mul_i32 s31, s31, 5120
  s_mul_i32 s39, s39, 655360
  v_exp_f32 v13, v13
  v_mfma_f32_16x16x32_bf16 v[36:39], a[156:159], v[140:143], v[36:39]
  ds_read_b64_tr_b16 a[162:163], v216 offset:20480
  s_add_u32 s31, s31, s39
  s_add_u32 s31, s31, 3145728
  v_cvt_pk_bf16_f32 v10, v12, v13
  v_mfma_f32_16x16x32_bf16 v[44:47], a[156:159], v[156:159], v[196:199]
  s_lshr_b32 s39, s2, 3
  s_min_u32 s39, s39, 29
  v_exp_f32 v14, v14
  v_mfma_f32_16x16x32_bf16 v[44:47], a[152:155], v[152:155], v[44:47]
  ds_read_b64_tr_b16 a[164:165], v216 offset:24576
  s_and_b32 s48, s2, 7
  s_mul_i32 s48, s48, 30
  v_mfma_f32_16x16x32_bf16 v[44:47], a[148:151], v[148:151], v[44:47]
  s_add_u32 s39, s39, s48
  s_mul_i32 s98, s39, 1639
  v_exp_f32 v15, v15
  v_mfma_f32_16x16x32_bf16 v[44:47], a[144:147], v[144:147], v[44:47]
  ds_read_b64_tr_b16 a[166:167], v216 offset:28672
  s_lshr_b32 s98, s98, 16
  s_mul_i32 s99, s98, 40
  v_cvt_pk_bf16_f32 v11, v14, v15
  v_mfma_f32_16x16x32_bf16 v[52:55], a[144:147], v[160:163], v[200:203]
  s_sub_u32 s99, s39, s99
  s_min_u32 s39, s3, 2
  v_exp_f32 v20, v20
  v_mfma_f32_16x16x32_bf16 v[52:55], a[148:151], v[164:167], v[52:55]
  ds_read_b64_tr_b16 a[168:169], v217 offset:16384
  s_mul_i32 s48, s98, 3
  s_add_u32 s48, s48, s39
  v_mfma_f32_16x16x32_bf16 v[52:55], a[152:155], v[168:171], v[52:55]
  s_mul_i32 s100, s48, 122880
  s_lshl_b32 s39, s99, 5
  v_exp_f32 v21, v21
  v_mfma_f32_16x16x32_bf16 v[52:55], a[156:159], v[172:175], v[52:55]
  ds_read_b64_tr_b16 a[170:171], v217 offset:20480
  s_add_u32 s100, s100, s39
  s_mul_i32 s101, s48, 192
  v_cvt_pk_bf16_f32 v18, v20, v21
  v_mfma_f32_16x16x32_bf16 v[60:63], a[156:159], v[188:191], v[204:207]
  s_add_u32 s101, s101, 2633728
  s_mov_b32 s51, s50
  v_exp_f32 v22, v22
  v_mfma_f32_16x16x32_bf16 v[60:63], a[152:155], v[184:187], v[60:63]
  ds_read_b64_tr_b16 a[172:173], v217 offset:24576
  v_mov_b32 v211, v242
  v_mfma_f32_16x16x32_bf16 v[60:63], a[148:151], v[180:183], v[60:63]
  s_mov_b32 s4, s94
  s_mov_b32 s5, s95
  v_exp_f32 v23, v23
  v_mfma_f32_16x16x32_bf16 v[60:63], a[144:147], v[176:179], v[60:63]
  ds_read_b64_tr_b16 a[174:175], v217 offset:28672
  s_mov_b32 s6, 2211840
  s_mov_b32 s7, 0x20000
  v_cvt_pk_bf16_f32 v19, v22, v23
  v_mfma_f32_16x16x32_bf16 a[192:195], a[208:211], v[64:67], a[192:195]
  v_exp_f32 v28, v28
  v_mfma_f32_16x16x32_bf16 a[192:195], a[208:211], v[96:99], a[192:195]
  ds_read_b64_tr_b16 a[176:177], v218 offset:16384
  v_mfma_f32_16x16x32_bf16 a[196:199], a[208:211], v[72:75], a[196:199]
  v_exp_f32 v29, v29
  v_mfma_f32_16x16x32_bf16 a[196:199], a[208:211], v[104:107], a[196:199]
  ds_read_b64_tr_b16 a[178:179], v218 offset:20480
  v_cvt_pk_bf16_f32 v26, v28, v29
  v_mfma_f32_16x16x32_bf16 a[200:203], a[208:211], v[80:83], a[200:203]
  v_exp_f32 v30, v30
  v_mfma_f32_16x16x32_bf16 a[200:203], a[208:211], v[112:115], a[200:203]
  ds_read_b64_tr_b16 a[180:181], v218 offset:24576
  v_mfma_f32_16x16x32_bf16 a[204:207], a[208:211], v[88:91], a[204:207]
  s_waitcnt lgkmcnt(7)
  v_exp_f32 v31, v31
  v_mfma_f32_16x16x32_bf16 a[204:207], a[208:211], v[120:123], a[204:207]
  ds_read_b64_tr_b16 a[182:183], v218 offset:28672
  v_cvt_pk_bf16_f32 v27, v30, v31
  v_mfma_f32_16x16x32_bf16 a[0:3], a[160:163], v[64:67], a[0:3]
  v_exp_f32 v32, v32
  v_mfma_f32_16x16x32_bf16 a[0:3], a[164:167], v[96:99], a[0:3]
  ds_read_b64_tr_b16 a[184:185], v219 offset:16384
  v_mfma_f32_16x16x32_bf16 a[4:7], a[164:167], v[104:107], a[4:7]
  v_exp_f32 v33, v33
  v_mfma_f32_16x16x32_bf16 a[4:7], a[160:163], v[72:75], a[4:7]
  ds_read_b64_tr_b16 a[186:187], v219 offset:20480
  v_cvt_pk_bf16_f32 v32, v32, v33
  v_mfma_f32_16x16x32_bf16 a[8:11], a[160:163], v[80:83], a[8:11]
  v_exp_f32 v34, v34
  v_mfma_f32_16x16x32_bf16 a[8:11], a[164:167], v[112:115], a[8:11]
  ds_read_b64_tr_b16 a[188:189], v219 offset:24576
  v_mfma_f32_16x16x32_bf16 a[12:15], a[164:167], v[120:123], a[12:15]
  s_waitcnt lgkmcnt(7)
  v_exp_f32 v35, v35
  v_mfma_f32_16x16x32_bf16 a[12:15], a[160:163], v[88:91], a[12:15]
  ds_read_b64_tr_b16 a[190:191], v219 offset:28672
  v_cvt_pk_bf16_f32 v33, v34, v35
  v_mfma_f32_16x16x32_bf16 a[16:19], a[168:171], v[64:67], a[16:19]
  v_exp_f32 v40, v40
  v_mfma_f32_16x16x32_bf16 a[16:19], a[172:175], v[96:99], a[16:19]
  ds_read_b64_tr_b16 a[160:161], v220 offset:16384
  v_mfma_f32_16x16x32_bf16 a[20:23], a[172:175], v[104:107], a[20:23]
  v_exp_f32 v41, v41
  v_mfma_f32_16x16x32_bf16 a[20:23], a[168:171], v[72:75], a[20:23]
  ds_read_b64_tr_b16 a[162:163], v220 offset:20480
  v_cvt_pk_bf16_f32 v40, v40, v41
  v_mfma_f32_16x16x32_bf16 a[24:27], a[168:171], v[80:83], a[24:27]
  v_exp_f32 v42, v42
  v_mfma_f32_16x16x32_bf16 a[24:27], a[172:175], v[112:115], a[24:27]
  ds_read_b64_tr_b16 a[164:165], v220 offset:24576
  v_mfma_f32_16x16x32_bf16 a[28:31], a[172:175], v[120:123], a[28:31]
  s_waitcnt lgkmcnt(7)
  v_exp_f32 v43, v43
  v_mfma_f32_16x16x32_bf16 a[28:31], a[168:171], v[88:91], a[28:31]
  ds_read_b64_tr_b16 a[166:167], v220 offset:28672
  v_cvt_pk_bf16_f32 v41, v42, v43
  v_mfma_f32_16x16x32_bf16 a[32:35], a[176:179], v[64:67], a[32:35]
  v_exp_f32 v48, v48
  v_mfma_f32_16x16x32_bf16 a[32:35], a[180:183], v[96:99], a[32:35]
  ds_read_b64_tr_b16 a[168:169], v221 offset:16384
  v_mfma_f32_16x16x32_bf16 a[36:39], a[180:183], v[104:107], a[36:39]
  v_exp_f32 v49, v49
  v_mfma_f32_16x16x32_bf16 a[36:39], a[176:179], v[72:75], a[36:39]
  ds_read_b64_tr_b16 a[170:171], v221 offset:20480
  v_cvt_pk_bf16_f32 v48, v48, v49
  v_mfma_f32_16x16x32_bf16 a[40:43], a[176:179], v[80:83], a[40:43]
  v_exp_f32 v50, v50
  v_mfma_f32_16x16x32_bf16 a[40:43], a[180:183], v[112:115], a[40:43]
  ds_read_b64_tr_b16 a[172:173], v221 offset:24576
  v_mfma_f32_16x16x32_bf16 a[44:47], a[180:183], v[120:123], a[44:47]
  s_waitcnt lgkmcnt(7)
  v_exp_f32 v51, v51
  v_mfma_f32_16x16x32_bf16 a[44:47], a[176:179], v[88:91], a[44:47]
  ds_read_b64_tr_b16 a[174:175], v221 offset:28672
  v_cvt_pk_bf16_f32 v49, v50, v51
  v_mfma_f32_16x16x32_bf16 a[48:51], a[184:187], v[64:67], a[48:51]
  v_exp_f32 v56, v56
  v_mfma_f32_16x16x32_bf16 a[48:51], a[188:191], v[96:99], a[48:51]
  ds_read_b64_tr_b16 a[176:177], v222 offset:16384
  v_mfma_f32_16x16x32_bf16 a[52:55], a[188:191], v[104:107], a[52:55]
  v_exp_f32 v57, v57
  v_mfma_f32_16x16x32_bf16 a[52:55], a[184:187], v[72:75], a[52:55]
  ds_read_b64_tr_b16 a[178:179], v222 offset:20480
  v_cvt_pk_bf16_f32 v56, v56, v57
  v_mfma_f32_16x16x32_bf16 a[56:59], a[184:187], v[80:83], a[56:59]
  v_exp_f32 v58, v58
  v_mfma_f32_16x16x32_bf16 a[56:59], a[188:191], v[112:115], a[56:59]
  ds_read_b64_tr_b16 a[180:181], v222 offset:24576
  v_mfma_f32_16x16x32_bf16 a[60:63], a[188:191], v[120:123], a[60:63]
  s_waitcnt lgkmcnt(7)
  v_exp_f32 v59, v59
  v_mfma_f32_16x16x32_bf16 a[60:63], a[184:187], v[88:91], a[60:63]
  ds_read_b64_tr_b16 a[182:183], v222 offset:28672
  v_cvt_pk_bf16_f32 v57, v58, v59
  v_mfma_f32_16x16x32_bf16 a[64:67], a[160:163], v[64:67], a[64:67]
  v_exp_f32 v36, v36
  v_mfma_f32_16x16x32_bf16 a[64:67], a[164:167], v[96:99], a[64:67]
  ds_read_b64_tr_b16 a[184:185], v223 offset:16384
  v_mfma_f32_16x16x32_bf16 a[68:71], a[164:167], v[104:107], a[68:71]
  v_exp_f32 v37, v37
  v_mfma_f32_16x16x32_bf16 a[68:71], a[160:163], v[72:75], a[68:71]
  ds_read_b64_tr_b16 a[186:187], v223 offset:20480
  v_cvt_pk_bf16_f32 v34, v36, v37
  v_mfma_f32_16x16x32_bf16 a[72:75], a[160:163], v[80:83], a[72:75]
  v_exp_f32 v38, v38
  v_mfma_f32_16x16x32_bf16 a[72:75], a[164:167], v[112:115], a[72:75]
  ds_read_b64_tr_b16 a[188:189], v223 offset:24576
  v_mfma_f32_16x16x32_bf16 a[76:79], a[164:167], v[120:123], a[76:79]
  s_waitcnt lgkmcnt(7)
  v_exp_f32 v39, v39
  v_mfma_f32_16x16x32_bf16 a[76:79], a[160:163], v[88:91], a[76:79]
  ds_read_b64_tr_b16 a[190:191], v223 offset:28672
  v_cvt_pk_bf16_f32 v35, v38, v39
  v_mfma_f32_16x16x32_bf16 a[80:83], a[168:171], v[64:67], a[80:83]
  s_waitcnt vmcnt(10)
  v_exp_f32 v44, v44
  v_mfma_f32_16x16x32_bf16 a[80:83], a[172:175], v[96:99], a[80:83]
  v_mfma_f32_16x16x32_bf16 a[84:87], a[172:175], v[104:107], a[84:87]
  s_barrier
  v_exp_f32 v45, v45
  v_mfma_f32_16x16x32_bf16 a[84:87], a[168:171], v[72:75], a[84:87]
  ds_read_b128 a[128:131], v212 offset:49152
  v_cvt_pk_bf16_f32 v42, v44, v45
  v_mfma_f32_16x16x32_bf16 a[88:91], a[168:171], v[80:83], a[88:91]
  v_exp_f32 v46, v46
  v_mfma_f32_16x16x32_bf16 a[88:91], a[172:175], v[112:115], a[88:91]
  ds_read_b128 a[132:135], v213 offset:49152
  v_mfma_f32_16x16x32_bf16 a[92:95], a[172:175], v[120:123], a[92:95]
  s_waitcnt lgkmcnt(6)
  v_exp_f32 v47, v47
  v_mfma_f32_16x16x32_bf16 a[92:95], a[168:171], v[88:91], a[92:95]
  ds_read_b128 a[136:139], v214 offset:49152
  v_cvt_pk_bf16_f32 v43, v46, v47
  v_mfma_f32_16x16x32_bf16 a[96:99], a[176:179], v[64:67], a[96:99]
  v_exp_f32 v52, v52
  v_mfma_f32_16x16x32_bf16 a[96:99], a[180:183], v[96:99], a[96:99]
  ds_read_b128 a[140:143], v215 offset:49152
  v_mfma_f32_16x16x32_bf16 a[100:103], a[180:183], v[104:107], a[100:103]
  v_exp_f32 v53, v53
  v_mfma_f32_16x16x32_bf16 a[100:103], a[176:179], v[72:75], a[100:103]
  v_cvt_pk_bf16_f32 v50, v52, v53
  v_mfma_f32_16x16x32_bf16 a[104:107], a[176:179], v[80:83], a[104:107]
  v_exp_f32 v54, v54
  v_mfma_f32_16x16x32_bf16 a[104:107], a[180:183], v[112:115], a[104:107]
  v_mfma_f32_16x16x32_bf16 a[108:111], a[180:183], v[120:123], a[108:111]
  s_waitcnt lgkmcnt(4)
  v_exp_f32 v55, v55
  v_mfma_f32_16x16x32_bf16 a[108:111], a[176:179], v[88:91], a[108:111]
  v_cvt_pk_bf16_f32 v51, v54, v55
  v_mfma_f32_16x16x32_bf16 a[112:115], a[184:187], v[64:67], a[112:115]
  v_exp_f32 v60, v60
  v_mfma_f32_16x16x32_bf16 a[112:115], a[188:191], v[96:99], a[112:115]
  v_mfma_f32_16x16x32_bf16 a[116:119], a[188:191], v[104:107], a[116:119]
  v_exp_f32 v61, v61
  v_mfma_f32_16x16x32_bf16 a[116:119], a[184:187], v[72:75], a[116:119]
  v_cvt_pk_bf16_f32 v58, v60, v61
  v_mfma_f32_16x16x32_bf16 a[120:123], a[184:187], v[80:83], a[120:123]
  v_exp_f32 v62, v62
  v_mfma_f32_16x16x32_bf16 a[120:123], a[188:191], v[112:115], a[120:123]
  v_mfma_f32_16x16x32_bf16 a[124:127], a[188:191], v[120:123], a[124:127]
  s_waitcnt lgkmcnt(0)
  v_exp_f32 v63, v63
  v_mfma_f32_16x16x32_bf16 a[124:127], a[184:187], v[88:91], a[124:127]
  v_cvt_pk_bf16_f32 v59, v62, v63
  v_mfma_f32_16x16x32_bf16 v[64:67], a[128:131], v[128:131], v[192:195]
  s_add_u32 m0, s28, 65536
  v_lshrrev_b32 v224, 4, v242
  v_lshrrev_b32 v225, 4, v224
  v_mfma_f32_16x16x32_bf16 v[64:67], a[132:135], v[132:135], v[64:67]
  ds_read_b128 a[144:147], v212 offset:53248
  v_bfe_u32 v226, v224, 2, 2
  v_mfma_f32_16x16x32_bf16 v[64:67], a[136:139], v[136:139], v[64:67]
  buffer_load_dwordx4 v236, s[16:19], s29 offen offset:0 lds
  v_mfma_f32_16x16x32_bf16 v[64:67], a[140:143], v[140:143], v[64:67]
  ds_read_b128 a[148:151], v213 offset:53248
  v_lshl_add_u32 v225, v225, 3, v226
  v_mfma_f32_16x16x32_bf16 v[72:75], a[140:143], v[156:159], v[196:199]
  buffer_load_dwordx4 v237, s[16:19], s29 offen offset:1024 lds
  v_mfma_f32_16x16x32_bf16 v[72:75], a[136:139], v[152:155], v[72:75]
  ds_read_b128 a[152:155], v214 offset:53248
  v_lshlrev_b32 v225, 4, v225
  v_mfma_f32_16x16x32_bf16 v[72:75], a[132:135], v[148:151], v[72:75]
  buffer_load_dwordx4 v236, s[16:19], s29 offen offset:2048 lds
  v_mfma_f32_16x16x32_bf16 v[72:75], a[128:131], v[144:147], v[72:75]
  ds_read_b128 a[156:159], v215 offset:53248
  v_bfe_u32 v226, v224, 1, 1
  v_mfma_f32_16x16x32_bf16 v[80:83], a[128:131], v[160:163], v[200:203]
  v_exp_f32 v64, v64
  v_mfma_f32_16x16x32_bf16 v[80:83], a[132:135], v[164:167], v[80:83]
  buffer_load_dwordx4 v237, s[16:19], s29 offen offset:3072 lds
  v_mfma_f32_16x16x32_bf16 v[80:83], a[136:139], v[168:171], v[80:83]
  s_add_u32 s29, s29, 16384
  v_exp_f32 v65, v65
  v_mfma_f32_16x16x32_bf16 v[80:83], a[140:143], v[172:175], v[80:83]
  v_cvt_pk_bf16_f32 v64, v64, v65
  v_mul_u32_u24 v226, 0xc00, v226
  v_mfma_f32_16x16x32_bf16 v[88:91], a[140:143], v[188:191], v[204:207]
  s_add_u32 m0, s28, 16384
  v_exp_f32 v66, v66
  v_mfma_f32_16x16x32_bf16 v[88:91], a[136:139], v[184:187], v[88:91]
  buffer_load_dwordx4 v232, s[12:15], s29 offen offset:0 lds
  v_mfma_f32_16x16x32_bf16 v[88:91], a[132:135], v[180:183], v[88:91]
  s_waitcnt lgkmcnt(0)
  v_exp_f32 v67, v67
  v_mfma_f32_16x16x32_bf16 v[88:91], a[128:131], v[176:179], v[88:91]
  v_cvt_pk_bf16_f32 v65, v66, v67
  v_add3_u32 v225, v225, v226, s50
  v_mfma_f32_16x16x32_bf16 v[68:71], a[144:147], v[128:131], v[192:195]
  v_exp_f32 v72, v72
  v_mfma_f32_16x16x32_bf16 v[68:71], a[148:151], v[132:135], v[68:71]
  ds_read_b128 a[128:131], v212 offset:57344
  v_and_b32 v226, 1, v224
  v_mfma_f32_16x16x32_bf16 v[68:71], a[152:155], v[136:139], v[68:71]
  v_exp_f32 v73, v73
  v_mfma_f32_16x16x32_bf16 v[68:71], a[156:159], v[140:143], v[68:71]
  ds_read_b128 a[132:135], v213 offset:57344
  v_cvt_pk_bf16_f32 v72, v72, v73
  v_mfma_f32_16x16x32_bf16 v[76:79], a[156:159], v[156:159], v[196:199]
  v_exp_f32 v74, v74
  v_mfma_f32_16x16x32_bf16 v[76:79], a[152:155], v[152:155], v[76:79]
  ds_read_b128 a[136:139], v214 offset:57344
  v_lshl_add_u32 v225, v226, 3, v225
  v_mfma_f32_16x16x32_bf16 v[76:79], a[148:151], v[148:151], v[76:79]
  s_waitcnt vmcnt(13)
  v_exp_f32 v75, v75
  v_mfma_f32_16x16x32_bf16 v[76:79], a[144:147], v[144:147], v[76:79]
  ds_read_b128 a[140:143], v215 offset:57344
  v_cvt_pk_bf16_f32 v73, v74, v75
  v_mfma_f32_16x16x32_bf16 v[84:87], a[144:147], v[160:163], v[200:203]
  v_exp_f32 v80, v80
  v_mfma_f32_16x16x32_bf16 v[84:87], a[148:151], v[164:167], v[84:87]
  buffer_load_dwordx4 v233, s[12:15], s29 offen offset:1024 lds
  v_mfma_f32_16x16x32_bf16 v[84:87], a[152:155], v[168:171], v[84:87]
  v_exp_f32 v81, v81
  v_mfma_f32_16x16x32_bf16 v[84:87], a[156:159], v[172:175], v[84:87]
  ds_read_b64_tr_b16 a[232:233], v225 offset:0
  v_cvt_pk_bf16_f32 v80, v80, v81
  v_mfma_f32_16x16x32_bf16 v[92:95], a[156:159], v[188:191], v[204:207]
  v_exp_f32 v82, v82
  v_mfma_f32_16x16x32_bf16 v[92:95], a[152:155], v[184:187], v[92:95]
  buffer_load_dwordx4 v234, s[12:15], s29 offen offset:2048 lds
  v_mfma_f32_16x16x32_bf16 v[92:95], a[148:151], v[180:183], v[92:95]
  s_waitcnt lgkmcnt(1)
  v_exp_f32 v83, v83
  v_mfma_f32_16x16x32_bf16 v[92:95], a[144:147], v[176:179], v[92:95]
  ds_read_b64_tr_b16 a[234:235], v225 offset:64
  v_cvt_pk_bf16_f32 v81, v82, v83
  v_mfma_f32_16x16x32_bf16 v[96:99], a[128:131], v[128:131], v[192:195]
  v_exp_f32 v88, v88
  v_mfma_f32_16x16x32_bf16 v[96:99], a[132:135], v[132:135], v[96:99]
  ds_read_b128 a[144:147], v212 offset:61440
  ds_read_b64_tr_b16 a[236:237], v225 offset:512
  v_mfma_f32_16x16x32_bf16 v[96:99], a[136:139], v[136:139], v[96:99]
  v_exp_f32 v89, v89
  v_mfma_f32_16x16x32_bf16 v[96:99], a[140:143], v[140:143], v[96:99]
  ds_read_b128 a[148:151], v213 offset:61440
  v_cvt_pk_bf16_f32 v88, v88, v89
  v_mfma_f32_16x16x32_bf16 v[104:107], a[140:143], v[156:159], v[196:199]
  v_exp_f32 v90, v90
  v_mfma_f32_16x16x32_bf16 v[104:107], a[136:139], v[152:155], v[104:107]
  ds_read_b128 a[152:155], v214 offset:61440
  ds_read_b64_tr_b16 a[238:239], v225 offset:576
  v_mfma_f32_16x16x32_bf16 v[104:107], a[132:135], v[148:151], v[104:107]
  v_exp_f32 v91, v91
  v_mfma_f32_16x16x32_bf16 v[104:107], a[128:131], v[144:147], v[104:107]
  ds_read_b128 a[156:159], v215 offset:61440
  v_cvt_pk_bf16_f32 v89, v90, v91
  v_mfma_f32_16x16x32_bf16 v[112:115], a[128:131], v[160:163], v[200:203]
  v_exp_f32 v68, v68
  v_mfma_f32_16x16x32_bf16 v[112:115], a[132:135], v[164:167], v[112:115]
  buffer_load_dwordx4 v235, s[12:15], s29 offen offset:3072 lds
  v_mfma_f32_16x16x32_bf16 v[112:115], a[136:139], v[168:171], v[112:115]
  v_exp_f32 v69, v69
  v_mfma_f32_16x16x32_bf16 v[112:115], a[140:143], v[172:175], v[112:115]
  ds_read_b64_tr_b16 a[240:241], v225 offset:1024
  v_cvt_pk_bf16_f32 v66, v68, v69
  v_mfma_f32_16x16x32_bf16 v[120:123], a[140:143], v[188:191], v[204:207]
  v_exp_f32 v70, v70
  v_mfma_f32_16x16x32_bf16 v[120:123], a[136:139], v[184:187], v[120:123]
  ds_read_b64_tr_b16 a[242:243], v225 offset:1088
  ds_read_b64_tr_b16 a[244:245], v225 offset:1536
  v_mfma_f32_16x16x32_bf16 v[120:123], a[132:135], v[180:183], v[120:123]
  s_waitcnt lgkmcnt(3)
  v_exp_f32 v71, v71
  v_mfma_f32_16x16x32_bf16 v[120:123], a[128:131], v[176:179], v[120:123]
  ds_read_b64_tr_b16 a[246:247], v225 offset:1600
  v_cvt_pk_bf16_f32 v67, v70, v71
  v_mfma_f32_16x16x32_bf16 v[100:103], a[144:147], v[128:131], v[192:195]
  v_exp_f32 v76, v76
  v_mfma_f32_16x16x32_bf16 v[100:103], a[148:151], v[132:135], v[100:103]
  ds_read_b64_tr_b16 a[160:161], v216 offset:32768
  ds_read_b64_tr_b16 a[248:249], v225 offset:2048
  v_mfma_f32_16x16x32_bf16 v[100:103], a[152:155], v[136:139], v[100:103]
  v_exp_f32 v77, v77
  v_mfma_f32_16x16x32_bf16 v[100:103], a[156:159], v[140:143], v[100:103]
  ds_read_b64_tr_b16 a[162:163], v216 offset:36864
  v_cvt_pk_bf16_f32 v74, v76, v77
  v_mfma_f32_16x16x32_bf16 v[108:111], a[156:159], v[156:159], v[196:199]
  v_exp_f32 v78, v78
  v_mfma_f32_16x16x32_bf16 v[108:111], a[152:155], v[152:155], v[108:111]
  ds_read_b64_tr_b16 a[164:165], v216 offset:40960
  ds_read_b64_tr_b16 a[250:251], v225 offset:2112
  v_mfma_f32_16x16x32_bf16 v[108:111], a[148:151], v[148:151], v[108:111]
  v_exp_f32 v79, v79
  v_mfma_f32_16x16x32_bf16 v[108:111], a[144:147], v[144:147], v[108:111]
  ds_read_b64_tr_b16 a[166:167], v216 offset:45056
  v_cvt_pk_bf16_f32 v75, v78, v79
  v_mfma_f32_16x16x32_bf16 v[116:119], a[144:147], v[160:163], v[200:203]
  v_exp_f32 v84, v84
  v_mfma_f32_16x16x32_bf16 v[116:119], a[148:151], v[164:167], v[116:119]
  ds_read_b64_tr_b16 a[168:169], v217 offset:32768
  v_mfma_f32_16x16x32_bf16 v[116:119], a[152:155], v[168:171], v[116:119]
  v_exp_f32 v85, v85
  v_mfma_f32_16x16x32_bf16 v[116:119], a[156:159], v[172:175], v[116:119]
  ds_read_b64_tr_b16 a[170:171], v217 offset:36864
  v_cvt_pk_bf16_f32 v82, v84, v85
  v_mfma_f32_16x16x32_bf16 v[124:127], a[156:159], v[188:191], v[204:207]
  v_exp_f32 v86, v86
  v_mfma_f32_16x16x32_bf16 v[124:127], a[152:155], v[184:187], v[124:127]
  ds_read_b64_tr_b16 a[172:173], v217 offset:40960
  s_waitcnt lgkmcnt(4)
  v_mfma_f32_16x16x32_bf16 v[228:231], a[232:235], a[212:215], 0
  v_mfma_f32_16x16x32_bf16 v[228:231], a[236:239], a[216:219], v[228:231]
  v_mfma_f32_16x16x32_bf16 v[228:231], a[240:243], a[220:223], v[228:231]
  v_mfma_f32_16x16x32_bf16 v[228:231], a[244:247], a[224:227], v[228:231]
  v_mfma_f32_16x16x32_bf16 v[228:231], a[248:251], a[228:231], v[228:231]
  v_mfma_f32_16x16x32_bf16 v[124:127], a[148:151], v[180:183], v[124:127]
  s_lshl_b32 s35, s3, 10
  s_add_u32 s35, s35, 159744
  v_exp_f32 v87, v87
  v_mfma_f32_16x16x32_bf16 v[124:127], a[144:147], v[176:179], v[124:127]
  ds_read_b64_tr_b16 a[174:175], v217 offset:45056
  v_cvt_pk_bf16_f32 v83, v86, v87
  v_mfma_f32_16x16x32_bf16 a[192:195], a[208:211], v[0:3], a[192:195]
  v_exp_f32 v92, v92
  v_mfma_f32_16x16x32_bf16 a[192:195], a[208:211], v[32:35], a[192:195]
  ds_read_b64_tr_b16 a[176:177], v218 offset:32768
  v_add_u32 v224, s35, v242
  v_mfma_f32_16x16x32_bf16 a[196:199], a[208:211], v[8:11], a[196:199]
  v_exp_f32 v93, v93
  v_mfma_f32_16x16x32_bf16 a[196:199], a[208:211], v[40:43], a[196:199]
  ds_read_b64_tr_b16 a[178:179], v218 offset:36864
  v_cvt_pk_bf16_f32 v90, v92, v93
  v_mfma_f32_16x16x32_bf16 a[200:203], a[208:211], v[16:19], a[200:203]
  v_exp_f32 v94, v94
  v_mfma_f32_16x16x32_bf16 a[200:203], a[208:211], v[48:51], a[200:203]
  ds_read_b64_tr_b16 a[180:181], v218 offset:40960
  ds_write_b128 v224, v[228:231]
  v_mfma_f32_16x16x32_bf16 a[204:207], a[208:211], v[24:27], a[204:207]
  s_waitcnt lgkmcnt(8)
  v_exp_f32 v95, v95
  v_mfma_f32_16x16x32_bf16 a[204:207], a[208:211], v[56:59], a[204:207]
  ds_read_b64_tr_b16 a[182:183], v218 offset:45056
  v_cvt_pk_bf16_f32 v91, v94, v95
  v_mfma_f32_16x16x32_bf16 a[0:3], a[160:163], v[0:3], a[0:3]
  v_exp_f32 v96, v96
  v_mfma_f32_16x16x32_bf16 a[0:3], a[164:167], v[32:35], a[0:3]
  ds_read_b64_tr_b16 a[184:185], v219 offset:32768
  v_mfma_f32_16x16x32_bf16 a[4:7], a[164:167], v[40:43], a[4:7]
  v_exp_f32 v97, v97
  v_mfma_f32_16x16x32_bf16 a[4:7], a[160:163], v[8:11], a[4:7]
  ds_read_b64_tr_b16 a[186:187], v219 offset:36864
  v_cvt_pk_bf16_f32 v96, v96, v97
  v_mfma_f32_16x16x32_bf16 a[8:11], a[160:163], v[16:19], a[8:11]
  v_exp_f32 v98, v98
  v_mfma_f32_16x16x32_bf16 a[8:11], a[164:167], v[48:51], a[8:11]
  ds_read_b64_tr_b16 a[188:189], v219 offset:40960
  s_waitcnt lgkmcnt(4)
  s_mov_b32 m0, s51
  v_mfma_f32_16x16x32_bf16 a[12:15], a[164:167], v[56:59], a[12:15]
  v_exp_f32 v99, v99
  v_mfma_f32_16x16x32_bf16 a[12:15], a[160:163], v[24:27], a[12:15]
  ds_read_b64_tr_b16 a[190:191], v219 offset:45056
  v_cvt_pk_bf16_f32 v97, v98, v99
  v_mfma_f32_16x16x32_bf16 a[16:19], a[168:171], v[0:3], a[16:19]
  v_exp_f32 v104, v104
  v_mfma_f32_16x16x32_bf16 a[16:19], a[172:175], v[32:35], a[16:19]
  ds_read_b64_tr_b16 a[160:161], v220 offset:32768
  buffer_load_dwordx4 v210, s[4:7], s100 offen lds
  s_add_u32 s100, s100, 20480
  s_add_u32 s51, s51, 512
  v_mfma_f32_16x16x32_bf16 a[20:23], a[172:175], v[40:43], a[20:23]
  v_exp_f32 v105, v105
  v_mfma_f32_16x16x32_bf16 a[20:23], a[168:171], v[8:11], a[20:23]
  ds_read_b64_tr_b16 a[162:163], v220 offset:36864
  v_cvt_pk_bf16_f32 v104, v104, v105
  v_mfma_f32_16x16x32_bf16 a[24:27], a[168:171], v[16:19], a[24:27]
  v_exp_f32 v106, v106
  v_mfma_f32_16x16x32_bf16 a[24:27], a[172:175], v[48:51], a[24:27]
  ds_read_b64_tr_b16 a[164:165], v220 offset:40960
  v_lshrrev_b32 v224, 4, v242
  v_mfma_f32_16x16x32_bf16 a[28:31], a[172:175], v[56:59], a[28:31]
  s_waitcnt lgkmcnt(7)
  v_exp_f32 v107, v107
  v_mfma_f32_16x16x32_bf16 a[28:31], a[168:171], v[24:27], a[28:31]
  ds_read_b64_tr_b16 a[166:167], v220 offset:45056
  v_cvt_pk_bf16_f32 v105, v106, v107
  v_mfma_f32_16x16x32_bf16 a[32:35], a[176:179], v[0:3], a[32:35]
  v_exp_f32 v112, v112
  v_mfma_f32_16x16x32_bf16 a[32:35], a[180:183], v[32:35], a[32:35]
  ds_read_b64_tr_b16 a[168:169], v221 offset:32768
  v_bfe_u32 v225, v224, 2, 1
  v_mfma_f32_16x16x32_bf16 a[36:39], a[180:183], v[40:43], a[36:39]
  v_exp_f32 v113, v113
  v_mfma_f32_16x16x32_bf16 a[36:39], a[176:179], v[8:11], a[36:39]
  ds_read_b64_tr_b16 a[170:171], v221 offset:36864
  v_cvt_pk_bf16_f32 v112, v112, v113
  v_mfma_f32_16x16x32_bf16 a[40:43], a[176:179], v[16:19], a[40:43]
  v_exp_f32 v114, v114
  v_mfma_f32_16x16x32_bf16 a[40:43], a[180:183], v[48:51], a[40:43]
  ds_read_b64_tr_b16 a[172:173], v221 offset:40960
  v_lshlrev_b32 v225, 8, v225
  v_mfma_f32_16x16x32_bf16 a[44:47], a[180:183], v[56:59], a[44:47]
  s_waitcnt lgkmcnt(7)
  v_exp_f32 v115, v115
  v_mfma_f32_16x16x32_bf16 a[44:47], a[176:179], v[24:27], a[44:47]
  ds_read_b64_tr_b16 a[174:175], v221 offset:45056
  v_cvt_pk_bf16_f32 v113, v114, v115
  v_mfma_f32_16x16x32_bf16 a[48:51], a[184:187], v[0:3], a[48:51]
  v_exp_f32 v120, v120
  v_mfma_f32_16x16x32_bf16 a[48:51], a[188:191], v[32:35], a[48:51]
  ds_read_b64_tr_b16 a[176:177], v222 offset:32768
  v_lshrrev_b32 v226, 3, v224
  v_mfma_f32_16x16x32_bf16 a[52:55], a[188:191], v[40:43], a[52:55]
  v_exp_f32 v121, v121
  v_mfma_f32_16x16x32_bf16 a[52:55], a[184:187], v[8:11], a[52:55]
  ds_read_b64_tr_b16 a[178:179], v222 offset:36864
  v_cvt_pk_bf16_f32 v120, v120, v121
  v_mfma_f32_16x16x32_bf16 a[56:59], a[184:187], v[16:19], a[56:59]
  v_exp_f32 v122, v122
  v_mfma_f32_16x16x32_bf16 a[56:59], a[188:191], v[48:51], a[56:59]
  ds_read_b64_tr_b16 a[180:181], v222 offset:40960
  v_lshl_add_u32 v225, v226, 4, v225
  v_mfma_f32_16x16x32_bf16 a[60:63], a[188:191], v[56:59], a[60:63]
  s_waitcnt lgkmcnt(7)
  v_exp_f32 v123, v123
  v_mfma_f32_16x16x32_bf16 a[60:63], a[184:187], v[24:27], a[60:63]
  ds_read_b64_tr_b16 a[182:183], v222 offset:45056
  v_cvt_pk_bf16_f32 v121, v122, v123
  v_mfma_f32_16x16x32_bf16 a[64:67], a[160:163], v[0:3], a[64:67]
  v_exp_f32 v100, v100
  v_mfma_f32_16x16x32_bf16 a[64:67], a[164:167], v[32:35], a[64:67]
  ds_read_b64_tr_b16 a[184:185], v223 offset:32768
  v_and_b32 v227, 3, v224
  v_mfma_f32_16x16x32_bf16 a[68:71], a[164:167], v[40:43], a[68:71]
  v_exp_f32 v101, v101
  v_mfma_f32_16x16x32_bf16 a[68:71], a[160:163], v[8:11], a[68:71]
  ds_read_b64_tr_b16 a[186:187], v223 offset:36864
  v_cvt_pk_bf16_f32 v98, v100, v101
  v_mfma_f32_16x16x32_bf16 a[72:75], a[160:163], v[16:19], a[72:75]
  v_exp_f32 v102, v102
  v_mfma_f32_16x16x32_bf16 a[72:75], a[164:167], v[48:51], a[72:75]
  ds_read_b64_tr_b16 a[188:189], v223 offset:40960
  v_lshl_add_u32 v225, v227, 2, v225
  v_mfma_f32_16x16x32_bf16 a[76:79], a[164:167], v[56:59], a[76:79]
  s_waitcnt lgkmcnt(7)
  v_exp_f32 v103, v103
  v_mfma_f32_16x16x32_bf16 a[76:79], a[160:163], v[24:27], a[76:79]
  ds_read_b64_tr_b16 a[190:191], v223 offset:45056
  v_cvt_pk_bf16_f32 v99, v102, v103
  v_mfma_f32_16x16x32_bf16 a[80:83], a[168:171], v[0:3], a[80:83]
  s_waitcnt vmcnt(9)
  v_exp_f32 v108, v108
  v_mfma_f32_16x16x32_bf16 a[80:83], a[172:175], v[32:35], a[80:83]
  v_add_u32 v225, 159744, v225
  v_mfma_f32_16x16x32_bf16 a[84:87], a[172:175], v[40:43], a[84:87]
  s_barrier
  v_exp_f32 v109, v109
  v_mfma_f32_16x16x32_bf16 a[84:87], a[168:171], v[8:11], a[84:87]
  ds_read_b128 a[128:131], v212 offset:0
  v_cvt_pk_bf16_f32 v106, v108, v109
  v_mfma_f32_16x16x32_bf16 a[88:91], a[168:171], v[16:19], a[88:91]
  v_exp_f32 v110, v110
  v_mfma_f32_16x16x32_bf16 a[88:91], a[172:175], v[48:51], a[88:91]
  ds_read_b128 a[132:135], v213 offset:0
  ds_read_b32 v228, v225 offset:0
  v_mfma_f32_16x16x32_bf16 a[92:95], a[172:175], v[56:59], a[92:95]
  s_waitcnt lgkmcnt(7)
  v_exp_f32 v111, v111
  v_mfma_f32_16x16x32_bf16 a[92:95], a[168:171], v[24:27], a[92:95]
  ds_read_b128 a[136:139], v214 offset:0
  v_cvt_pk_bf16_f32 v107, v110, v111
  v_mfma_f32_16x16x32_bf16 a[96:99], a[176:179], v[0:3], a[96:99]
  v_exp_f32 v116, v116
  v_mfma_f32_16x16x32_bf16 a[96:99], a[180:183], v[32:35], a[96:99]
  ds_read_b128 a[140:143], v215 offset:0
  ds_read_b32 v229, v225 offset:1024
  v_mfma_f32_16x16x32_bf16 a[100:103], a[180:183], v[40:43], a[100:103]
  v_exp_f32 v117, v117
  v_mfma_f32_16x16x32_bf16 a[100:103], a[176:179], v[8:11], a[100:103]
  ds_read_b32 v230, v225 offset:2048
  v_cvt_pk_bf16_f32 v114, v116, v117
  v_mfma_f32_16x16x32_bf16 a[104:107], a[176:179], v[16:19], a[104:107]
  v_exp_f32 v118, v118
  v_mfma_f32_16x16x32_bf16 a[104:107], a[180:183], v[48:51], a[104:107]
  ds_read_b32 v231, v225 offset:3072
  ds_read_b32 v238, v225 offset:512
  v_mfma_f32_16x16x32_bf16 a[108:111], a[180:183], v[56:59], a[108:111]
  s_waitcnt lgkmcnt(9)
  v_exp_f32 v119, v119
  v_mfma_f32_16x16x32_bf16 a[108:111], a[176:179], v[24:27], a[108:111]
  ds_read_b32 v239, v225 offset:1536
  v_cvt_pk_bf16_f32 v115, v118, v119
  v_mfma_f32_16x16x32_bf16 a[112:115], a[184:187], v[0:3], a[112:115]
  v_exp_f32 v124, v124
  v_mfma_f32_16x16x32_bf16 a[112:115], a[188:191], v[32:35], a[112:115]
  ds_read_b32 v240, v225 offset:2560
  ds_read_b32 v241, v225 offset:3584
  s_cmp_eq_u32 s3, 0
  s_cselect_b32 s35, 0, 1073741824
  v_mfma_f32_16x16x32_bf16 a[116:119], a[188:191], v[40:43], a[116:119]
  v_exp_f32 v125, v125
  v_mfma_f32_16x16x32_bf16 a[116:119], a[184:187], v[8:11], a[116:119]
  v_cvt_pk_bf16_f32 v122, v124, v125
  v_mul_u32_u24 v226, 0xd80, v226
  v_mfma_f32_16x16x32_bf16 a[120:123], a[184:187], v[16:19], a[120:123]
  v_exp_f32 v126, v126
  v_mfma_f32_16x16x32_bf16 a[120:123], a[188:191], v[48:51], a[120:123]
  v_and_b32 v227, 7, v224
  v_lshl_add_u32 v226, v227, 1, v226
  v_mfma_f32_16x16x32_bf16 a[124:127], a[188:191], v[56:59], a[124:127]
  s_waitcnt lgkmcnt(7)
  v_exp_f32 v127, v127
  v_mfma_f32_16x16x32_bf16 a[124:127], a[184:187], v[24:27], a[124:127]
  v_cvt_pk_bf16_f32 v123, v126, v127
  v_and_b32 v227, 1, v224
  v_lshl_add_u32 v226, v227, 30, v226
  v_or_b32 v226, s35, v226
  v_min_u32 v249, 1, v224
  v_lshlrev_b32 v249, 30, v249
  v_or_b32 v249, s35, v249
  v_mov_b32 v251, v249
  v_mov_b32 v250, 1
  s_mov_b32 s47, 2818048
  s_lshl_b32 s35, s33, 4
  s_add_u32 s35, s35, 2633728
  s_waitcnt lgkmcnt(0)
  v_add_f32 v228, v228, v229
  v_add_f32 v238, v238, v239
  v_add_f32 v230, v230, v231
  v_add_f32 v240, v240, v241
  v_add_f32 v228, v228, v230
  v_add_f32 v238, v238, v240
  v_cvt_pk_bf16_f32 v228, v228, v228
  v_cvt_pk_bf16_f32 v238, v238, v238
  v_lshlrev_b32 v228, 16, v228
  v_lshlrev_b32 v238, 16, v238
  v_mul_f32 v229, 0xbfb8aa3b, v228
  v_exp_f32 v229, v229
  s_nop 0
  v_add_f32 v229, 1.0, v229
  v_rcp_f32 v229, v229
  s_nop 0
  v_mul_f32 v228, v228, v229
  v_cvt_pk_bf16_f32 v228, v228, v228
  v_lshlrev_b32 v228, 16, v228
  v_mul_f32 v228, v228, v238
  s_nop 1
  v_mov_b32_dpp v229, v228 quad_perm:[1,0,3,2] row_mask:0xf bank_mask:0xf
  v_cvt_pk_bf16_f32 v228, v228, v229
  buffer_store_dword v228, v226, s[24:27], s35 offen sc1
  s_mov_b32 s32, 5
attn_loop:
  v_mfma_f32_16x16x32_bf16 v[0:3], a[128:131], v[128:131], v[192:195]
  s_add_u32 m0, s28, 81920
  v_mfma_f32_16x16x32_bf16 v[0:3], a[132:135], v[132:135], v[0:3]
  ds_read_b128 a[144:147], v212 offset:4096
  v_mfma_f32_16x16x32_bf16 v[0:3], a[136:139], v[136:139], v[0:3]
  buffer_load_dwordx4 v236, s[16:19], s29 offen offset:0 lds
  v_mfma_f32_16x16x32_bf16 v[0:3], a[140:143], v[140:143], v[0:3]
  ds_read_b128 a[148:151], v213 offset:4096
  v_mfma_f32_16x16x32_bf16 v[8:11], a[140:143], v[156:159], v[196:199]
  buffer_load_dwordx4 v237, s[16:19], s29 offen offset:1024 lds
  v_mfma_f32_16x16x32_bf16 v[8:11], a[136:139], v[152:155], v[8:11]
  ds_read_b128 a[152:155], v214 offset:4096
  v_mfma_f32_16x16x32_bf16 v[8:11], a[132:135], v[148:151], v[8:11]
  buffer_load_dwordx4 v236, s[16:19], s29 offen offset:2048 lds
  v_mfma_f32_16x16x32_bf16 v[8:11], a[128:131], v[144:147], v[8:11]
  ds_read_b128 a[156:159], v215 offset:4096
  v_mfma_f32_16x16x32_bf16 v[16:19], a[128:131], v[160:163], v[200:203]
  v_exp_f32 v0, v0
  v_mfma_f32_16x16x32_bf16 v[16:19], a[132:135], v[164:167], v[16:19]
  buffer_load_dwordx4 v237, s[16:19], s29 offen offset:3072 lds
  v_mfma_f32_16x16x32_bf16 v[16:19], a[136:139], v[168:171], v[16:19]
  s_add_u32 s29, s29, 16384
  v_exp_f32 v1, v1
  v_mfma_f32_16x16x32_bf16 v[16:19], a[140:143], v[172:175], v[16:19]
  v_cvt_pk_bf16_f32 v0, v0, v1
  v_mfma_f32_16x16x32_bf16 v[24:27], a[140:143], v[188:191], v[204:207]
  s_add_u32 m0, s28, 32768
  v_exp_f32 v2, v2
  v_mfma_f32_16x16x32_bf16 v[24:27], a[136:139], v[184:187], v[24:27]
  buffer_load_dwordx4 v232, s[12:15], s29 offen offset:0 lds
  v_mfma_f32_16x16x32_bf16 v[24:27], a[132:135], v[180:183], v[24:27]
  s_waitcnt lgkmcnt(0)
  v_exp_f32 v3, v3
  v_mfma_f32_16x16x32_bf16 v[24:27], a[128:131], v[176:179], v[24:27]
  v_cvt_pk_bf16_f32 v1, v2, v3
  v_mfma_f32_16x16x32_bf16 v[4:7], a[144:147], v[128:131], v[192:195]
  v_exp_f32 v8, v8
  v_mfma_f32_16x16x32_bf16 v[4:7], a[148:151], v[132:135], v[4:7]
  ds_read_b128 a[128:131], v212 offset:8192
  v_mfma_f32_16x16x32_bf16 v[4:7], a[152:155], v[136:139], v[4:7]
  v_exp_f32 v9, v9
  v_mfma_f32_16x16x32_bf16 v[4:7], a[156:159], v[140:143], v[4:7]
  ds_read_b128 a[132:135], v213 offset:8192
  v_cvt_pk_bf16_f32 v8, v8, v9
  v_mfma_f32_16x16x32_bf16 v[12:15], a[156:159], v[156:159], v[196:199]
  v_exp_f32 v10, v10
  v_mfma_f32_16x16x32_bf16 v[12:15], a[152:155], v[152:155], v[12:15]
  ds_read_b128 a[136:139], v214 offset:8192
  v_mfma_f32_16x16x32_bf16 v[12:15], a[148:151], v[148:151], v[12:15]
  v_exp_f32 v11, v11
  v_mfma_f32_16x16x32_bf16 v[12:15], a[144:147], v[144:147], v[12:15]
  ds_read_b128 a[140:143], v215 offset:8192
  v_cvt_pk_bf16_f32 v9, v10, v11
  v_mfma_f32_16x16x32_bf16 v[20:23], a[144:147], v[160:163], v[200:203]
  v_exp_f32 v16, v16
  v_mfma_f32_16x16x32_bf16 v[20:23], a[148:151], v[164:167], v[20:23]
  buffer_load_dwordx4 v233, s[12:15], s29 offen offset:1024 lds
  v_mfma_f32_16x16x32_bf16 v[20:23], a[152:155], v[168:171], v[20:23]
  v_exp_f32 v17, v17
  v_mfma_f32_16x16x32_bf16 v[20:23], a[156:159], v[172:175], v[20:23]
  v_cvt_pk_bf16_f32 v16, v16, v17
  v_mfma_f32_16x16x32_bf16 v[28:31], a[156:159], v[188:191], v[204:207]
  v_exp_f32 v18, v18
  v_mfma_f32_16x16x32_bf16 v[28:31], a[152:155], v[184:187], v[28:31]
  buffer_load_dwordx4 v234, s[12:15], s29 offen offset:2048 lds
  v_mfma_f32_16x16x32_bf16 v[28:31], a[148:151], v[180:183], v[28:31]
  s_waitcnt lgkmcnt(0)
  v_exp_f32 v19, v19
  v_mfma_f32_16x16x32_bf16 v[28:31], a[144:147], v[176:179], v[28:31]
  v_cvt_pk_bf16_f32 v17, v18, v19
  v_mfma_f32_16x16x32_bf16 v[32:35], a[128:131], v[128:131], v[192:195]
  v_exp_f32 v24, v24
  v_mfma_f32_16x16x32_bf16 v[32:35], a[132:135], v[132:135], v[32:35]
  ds_read_b128 a[144:147], v212 offset:12288
  v_mfma_f32_16x16x32_bf16 v[32:35], a[136:139], v[136:139], v[32:35]
  v_exp_f32 v25, v25
  v_mfma_f32_16x16x32_bf16 v[32:35], a[140:143], v[140:143], v[32:35]
  ds_read_b128 a[148:151], v213 offset:12288
  v_cvt_pk_bf16_f32 v24, v24, v25
  v_mfma_f32_16x16x32_bf16 v[40:43], a[140:143], v[156:159], v[196:199]
  v_exp_f32 v26, v26
  v_mfma_f32_16x16x32_bf16 v[40:43], a[136:139], v[152:155], v[40:43]
  ds_read_b128 a[152:155], v214 offset:12288
  v_mfma_f32_16x16x32_bf16 v[40:43], a[132:135], v[148:151], v[40:43]
  v_exp_f32 v27, v27
  v_mfma_f32_16x16x32_bf16 v[40:43], a[128:131], v[144:147], v[40:43]
  ds_read_b128 a[156:159], v215 offset:12288
  v_cvt_pk_bf16_f32 v25, v26, v27
  v_mfma_f32_16x16x32_bf16 v[48:51], a[128:131], v[160:163], v[200:203]
  v_exp_f32 v4, v4
  v_mfma_f32_16x16x32_bf16 v[48:51], a[132:135], v[164:167], v[48:51]
  buffer_load_dwordx4 v235, s[12:15], s29 offen offset:3072 lds
  v_mfma_f32_16x16x32_bf16 v[48:51], a[136:139], v[168:171], v[48:51]
  v_exp_f32 v5, v5
  v_mfma_f32_16x16x32_bf16 v[48:51], a[140:143], v[172:175], v[48:51]
  v_cvt_pk_bf16_f32 v2, v4, v5
  v_mfma_f32_16x16x32_bf16 v[56:59], a[140:143], v[188:191], v[204:207]
  s_add_u32 m0, s50, 4096
  v_exp_f32 v6, v6
  v_mfma_f32_16x16x32_bf16 v[56:59], a[136:139], v[184:187], v[56:59]
  buffer_load_dwordx4 v208, s[20:23], s30 offen lds
  s_add_u32 s30, s30, 32
  v_mfma_f32_16x16x32_bf16 v[56:59], a[132:135], v[180:183], v[56:59]
  s_waitcnt lgkmcnt(0)
  v_exp_f32 v7, v7
  v_mfma_f32_16x16x32_bf16 v[56:59], a[128:131], v[176:179], v[56:59]
  v_cvt_pk_bf16_f32 v3, v6, v7
  v_mfma_f32_16x16x32_bf16 v[36:39], a[144:147], v[128:131], v[192:195]
  v_exp_f32 v12, v12
  v_mfma_f32_16x16x32_bf16 v[36:39], a[148:151], v[132:135], v[36:39]
  ds_read_b64_tr_b16 a[160:161], v216 offset:49152
  v_mfma_f32_16x16x32_bf16 v[36:39], a[152:155], v[136:139], v[36:39]
  v_exp_f32 v13, v13
  v_mfma_f32_16x16x32_bf16 v[36:39], a[156:159], v[140:143], v[36:39]
  ds_read_b64_tr_b16 a[162:163], v216 offset:53248
  v_cvt_pk_bf16_f32 v10, v12, v13
  v_mfma_f32_16x16x32_bf16 v[44:47], a[156:159], v[156:159], v[196:199]
  v_exp_f32 v14, v14
  v_mfma_f32_16x16x32_bf16 v[44:47], a[152:155], v[152:155], v[44:47]
  ds_read_b64_tr_b16 a[164:165], v216 offset:57344
  v_mfma_f32_16x16x32_bf16 v[44:47], a[148:151], v[148:151], v[44:47]
  v_exp_f32 v15, v15
  v_mfma_f32_16x16x32_bf16 v[44:47], a[144:147], v[144:147], v[44:47]
  ds_read_b64_tr_b16 a[166:167], v216 offset:61440
  v_cvt_pk_bf16_f32 v11, v14, v15
  v_mfma_f32_16x16x32_bf16 v[52:55], a[144:147], v[160:163], v[200:203]
  v_exp_f32 v20, v20
  v_mfma_f32_16x16x32_bf16 v[52:55], a[148:151], v[164:167], v[52:55]
  ds_read_b64_tr_b16 a[168:169], v217 offset:49152
  v_mfma_f32_16x16x32_bf16 v[52:55], a[152:155], v[168:171], v[52:55]
  v_exp_f32 v21, v21
  v_mfma_f32_16x16x32_bf16 v[52:55], a[156:159], v[172:175], v[52:55]
  ds_read_b64_tr_b16 a[170:171], v217 offset:53248
  v_cvt_pk_bf16_f32 v18, v20, v21
  v_mfma_f32_16x16x32_bf16 v[60:63], a[156:159], v[188:191], v[204:207]
  v_exp_f32 v22, v22
  v_mfma_f32_16x16x32_bf16 v[60:63], a[152:155], v[184:187], v[60:63]
  ds_read_b64_tr_b16 a[172:173], v217 offset:57344
  v_mfma_f32_16x16x32_bf16 v[60:63], a[148:151], v[180:183], v[60:63]
  v_exp_f32 v23, v23
  v_mfma_f32_16x16x32_bf16 v[60:63], a[144:147], v[176:179], v[60:63]
  ds_read_b64_tr_b16 a[174:175], v217 offset:61440
  v_cvt_pk_bf16_f32 v19, v22, v23
  v_mfma_f32_16x16x32_bf16 a[192:195], a[208:211], v[64:67], a[192:195]
  v_exp_f32 v28, v28
  v_mfma_f32_16x16x32_bf16 a[192:195], a[208:211], v[96:99], a[192:195]
  ds_read_b64_tr_b16 a[176:177], v218 offset:49152
  v_mfma_f32_16x16x32_bf16 a[196:199], a[208:211], v[72:75], a[196:199]
  v_exp_f32 v29, v29
  v_mfma_f32_16x16x32_bf16 a[196:199], a[208:211], v[104:107], a[196:199]
  ds_read_b64_tr_b16 a[178:179], v218 offset:53248
  v_cvt_pk_bf16_f32 v26, v28, v29
  v_mfma_f32_16x16x32_bf16 a[200:203], a[208:211], v[80:83], a[200:203]
  v_exp_f32 v30, v30
  v_mfma_f32_16x16x32_bf16 a[200:203], a[208:211], v[112:115], a[200:203]
  ds_read_b64_tr_b16 a[180:181], v218 offset:57344
  v_mfma_f32_16x16x32_bf16 a[204:207], a[208:211], v[88:91], a[204:207]
  s_waitcnt lgkmcnt(7)
  v_exp_f32 v31, v31
  v_mfma_f32_16x16x32_bf16 a[204:207], a[208:211], v[120:123], a[204:207]
  ds_read_b64_tr_b16 a[182:183], v218 offset:61440
  v_cvt_pk_bf16_f32 v27, v30, v31
  v_mfma_f32_16x16x32_bf16 a[0:3], a[160:163], v[64:67], a[0:3]
  v_exp_f32 v32, v32
  v_mfma_f32_16x16x32_bf16 a[0:3], a[164:167], v[96:99], a[0:3]
  ds_read_b64_tr_b16 a[184:185], v219 offset:49152
  v_mfma_f32_16x16x32_bf16 a[4:7], a[164:167], v[104:107], a[4:7]
  v_exp_f32 v33, v33
  v_mfma_f32_16x16x32_bf16 a[4:7], a[160:163], v[72:75], a[4:7]
  ds_read_b64_tr_b16 a[186:187], v219 offset:53248
  v_cvt_pk_bf16_f32 v32, v32, v33
  v_mfma_f32_16x16x32_bf16 a[8:11], a[160:163], v[80:83], a[8:11]
  v_exp_f32 v34, v34
  v_mfma_f32_16x16x32_bf16 a[8:11], a[164:167], v[112:115], a[8:11]
  ds_read_b64_tr_b16 a[188:189], v219 offset:57344
  v_mfma_f32_16x16x32_bf16 a[12:15], a[164:167], v[120:123], a[12:15]
  s_waitcnt lgkmcnt(7)
  v_exp_f32 v35, v35
  v_mfma_f32_16x16x32_bf16 a[12:15], a[160:163], v[88:91], a[12:15]
  ds_read_b64_tr_b16 a[190:191], v219 offset:61440
  v_cvt_pk_bf16_f32 v33, v34, v35
  v_mfma_f32_16x16x32_bf16 a[16:19], a[168:171], v[64:67], a[16:19]
  v_exp_f32 v40, v40
  v_mfma_f32_16x16x32_bf16 a[16:19], a[172:175], v[96:99], a[16:19]
  ds_read_b64_tr_b16 a[160:161], v220 offset:49152
  v_mfma_f32_16x16x32_bf16 a[20:23], a[172:175], v[104:107], a[20:23]
  v_exp_f32 v41, v41
  v_mfma_f32_16x16x32_bf16 a[20:23], a[168:171], v[72:75], a[20:23]
  ds_read_b64_tr_b16 a[162:163], v220 offset:53248
  v_cvt_pk_bf16_f32 v40, v40, v41
  v_mfma_f32_16x16x32_bf16 a[24:27], a[168:171], v[80:83], a[24:27]
  v_exp_f32 v42, v42
  v_mfma_f32_16x16x32_bf16 a[24:27], a[172:175], v[112:115], a[24:27]
  ds_read_b64_tr_b16 a[164:165], v220 offset:57344
  v_mfma_f32_16x16x32_bf16 a[28:31], a[172:175], v[120:123], a[28:31]
  s_waitcnt lgkmcnt(7)
  v_exp_f32 v43, v43
  v_mfma_f32_16x16x32_bf16 a[28:31], a[168:171], v[88:91], a[28:31]
  ds_read_b64_tr_b16 a[166:167], v220 offset:61440
  v_cvt_pk_bf16_f32 v41, v42, v43
  v_mfma_f32_16x16x32_bf16 a[32:35], a[176:179], v[64:67], a[32:35]
  v_exp_f32 v48, v48
  v_mfma_f32_16x16x32_bf16 a[32:35], a[180:183], v[96:99], a[32:35]
  ds_read_b64_tr_b16 a[168:169], v221 offset:49152
  v_mfma_f32_16x16x32_bf16 a[36:39], a[180:183], v[104:107], a[36:39]
  v_exp_f32 v49, v49
  v_mfma_f32_16x16x32_bf16 a[36:39], a[176:179], v[72:75], a[36:39]
  ds_read_b64_tr_b16 a[170:171], v221 offset:53248
  v_cvt_pk_bf16_f32 v48, v48, v49
  v_mfma_f32_16x16x32_bf16 a[40:43], a[176:179], v[80:83], a[40:43]
  v_exp_f32 v50, v50
  v_mfma_f32_16x16x32_bf16 a[40:43], a[180:183], v[112:115], a[40:43]
  ds_read_b64_tr_b16 a[172:173], v221 offset:57344
  v_mfma_f32_16x16x32_bf16 a[44:47], a[180:183], v[120:123], a[44:47]
  s_waitcnt lgkmcnt(7)
  v_exp_f32 v51, v51
  v_mfma_f32_16x16x32_bf16 a[44:47], a[176:179], v[88:91], a[44:47]
  ds_read_b64_tr_b16 a[174:175], v221 offset:61440
  v_cvt_pk_bf16_f32 v49, v50, v51
  v_mfma_f32_16x16x32_bf16 a[48:51], a[184:187], v[64:67], a[48:51]
  v_exp_f32 v56, v56
  v_mfma_f32_16x16x32_bf16 a[48:51], a[188:191], v[96:99], a[48:51]
  ds_read_b64_tr_b16 a[176:177], v222 offset:49152
  v_mfma_f32_16x16x32_bf16 a[52:55], a[188:191], v[104:107], a[52:55]
  v_exp_f32 v57, v57
  v_mfma_f32_16x16x32_bf16 a[52:55], a[184:187], v[72:75], a[52:55]
  ds_read_b64_tr_b16 a[178:179], v222 offset:53248
  v_cvt_pk_bf16_f32 v56, v56, v57
  v_mfma_f32_16x16x32_bf16 a[56:59], a[184:187], v[80:83], a[56:59]
  v_exp_f32 v58, v58
  v_mfma_f32_16x16x32_bf16 a[56:59], a[188:191], v[112:115], a[56:59]
  ds_read_b64_tr_b16 a[180:181], v222 offset:57344
  v_mfma_f32_16x16x32_bf16 a[60:63], a[188:191], v[120:123], a[60:63]
  s_waitcnt lgkmcnt(7)
  v_exp_f32 v59, v59
  v_mfma_f32_16x16x32_bf16 a[60:63], a[184:187], v[88:91], a[60:63]
  ds_read_b64_tr_b16 a[182:183], v222 offset:61440
  v_cvt_pk_bf16_f32 v57, v58, v59
  v_mfma_f32_16x16x32_bf16 a[64:67], a[160:163], v[64:67], a[64:67]
  v_exp_f32 v36, v36
  v_mfma_f32_16x16x32_bf16 a[64:67], a[164:167], v[96:99], a[64:67]
  ds_read_b64_tr_b16 a[184:185], v223 offset:49152
  v_mfma_f32_16x16x32_bf16 a[68:71], a[164:167], v[104:107], a[68:71]
  v_exp_f32 v37, v37
  v_mfma_f32_16x16x32_bf16 a[68:71], a[160:163], v[72:75], a[68:71]
  ds_read_b64_tr_b16 a[186:187], v223 offset:53248
  v_cvt_pk_bf16_f32 v34, v36, v37
  v_mfma_f32_16x16x32_bf16 a[72:75], a[160:163], v[80:83], a[72:75]
  v_exp_f32 v38, v38
  v_mfma_f32_16x16x32_bf16 a[72:75], a[164:167], v[112:115], a[72:75]
  ds_read_b64_tr_b16 a[188:189], v223 offset:57344
  v_mfma_f32_16x16x32_bf16 a[76:79], a[164:167], v[120:123], a[76:79]
  s_waitcnt lgkmcnt(7)
  v_exp_f32 v39, v39
  v_mfma_f32_16x16x32_bf16 a[76:79], a[160:163], v[88:91], a[76:79]
  ds_read_b64_tr_b16 a[190:191], v223 offset:61440
  v_cvt_pk_bf16_f32 v35, v38, v39
  v_mfma_f32_16x16x32_bf16 a[80:83], a[168:171], v[64:67], a[80:83]
  s_waitcnt vmcnt(11)
  v_exp_f32 v44, v44
  v_mfma_f32_16x16x32_bf16 a[80:83], a[172:175], v[96:99], a[80:83]
  v_mfma_f32_16x16x32_bf16 a[84:87], a[172:175], v[104:107], a[84:87]
  s_barrier
  v_exp_f32 v45, v45
  v_mfma_f32_16x16x32_bf16 a[84:87], a[168:171], v[72:75], a[84:87]
  ds_read_b128 a[128:131], v212 offset:16384
  v_cvt_pk_bf16_f32 v42, v44, v45
  v_mfma_f32_16x16x32_bf16 a[88:91], a[168:171], v[80:83], a[88:91]
  v_exp_f32 v46, v46
  v_mfma_f32_16x16x32_bf16 a[88:91], a[172:175], v[112:115], a[88:91]
  ds_read_b128 a[132:135], v213 offset:16384
  v_mfma_f32_16x16x32_bf16 a[92:95], a[172:175], v[120:123], a[92:95]
  s_waitcnt lgkmcnt(6)
  v_exp_f32 v47, v47
  v_mfma_f32_16x16x32_bf16 a[92:95], a[168:171], v[88:91], a[92:95]
  ds_read_b128 a[136:139], v214 offset:16384
  v_cvt_pk_bf16_f32 v43, v46, v47
  v_mfma_f32_16x16x32_bf16 a[96:99], a[176:179], v[64:67], a[96:99]
  v_exp_f32 v52, v52
  v_mfma_f32_16x16x32_bf16 a[96:99], a[180:183], v[96:99], a[96:99]
  ds_read_b128 a[140:143], v215 offset:16384
  v_mfma_f32_16x16x32_bf16 a[100:103], a[180:183], v[104:107], a[100:103]
  v_exp_f32 v53, v53
  v_mfma_f32_16x16x32_bf16 a[100:103], a[176:179], v[72:75], a[100:103]
  v_cvt_pk_bf16_f32 v50, v52, v53
  v_mfma_f32_16x16x32_bf16 a[104:107], a[176:179], v[80:83], a[104:107]
  v_exp_f32 v54, v54
  v_mfma_f32_16x16x32_bf16 a[104:107], a[180:183], v[112:115], a[104:107]
  v_mfma_f32_16x16x32_bf16 a[108:111], a[180:183], v[120:123], a[108:111]
  s_waitcnt lgkmcnt(4)
  v_exp_f32 v55, v55
  v_mfma_f32_16x16x32_bf16 a[108:111], a[176:179], v[88:91], a[108:111]
  v_cvt_pk_bf16_f32 v51, v54, v55
  v_mfma_f32_16x16x32_bf16 a[112:115], a[184:187], v[64:67], a[112:115]
  v_exp_f32 v60, v60
  v_mfma_f32_16x16x32_bf16 a[112:115], a[188:191], v[96:99], a[112:115]
  v_mfma_f32_16x16x32_bf16 a[116:119], a[188:191], v[104:107], a[116:119]
  v_exp_f32 v61, v61
  v_mfma_f32_16x16x32_bf16 a[116:119], a[184:187], v[72:75], a[116:119]
  v_cvt_pk_bf16_f32 v58, v60, v61
  v_mfma_f32_16x16x32_bf16 a[120:123], a[184:187], v[80:83], a[120:123]
  v_exp_f32 v62, v62
  v_mfma_f32_16x16x32_bf16 a[120:123], a[188:191], v[112:115], a[120:123]
  v_mfma_f32_16x16x32_bf16 a[124:127], a[188:191], v[120:123], a[124:127]
  s_waitcnt lgkmcnt(0)
  v_exp_f32 v63, v63
  v_mfma_f32_16x16x32_bf16 a[124:127], a[184:187], v[88:91], a[124:127]
  v_cvt_pk_bf16_f32 v59, v62, v63
  v_mfma_f32_16x16x32_bf16 v[64:67], a[128:131], v[128:131], v[192:195]
  s_add_u32 m0, s28, 98304
  v_mfma_f32_16x16x32_bf16 v[64:67], a[132:135], v[132:135], v[64:67]
  ds_read_b128 a[144:147], v212 offset:20480
  v_mfma_f32_16x16x32_bf16 v[64:67], a[136:139], v[136:139], v[64:67]
  buffer_load_dwordx4 v236, s[16:19], s29 offen offset:0 lds
  v_mfma_f32_16x16x32_bf16 v[64:67], a[140:143], v[140:143], v[64:67]
  ds_read_b128 a[148:151], v213 offset:20480
  v_mfma_f32_16x16x32_bf16 v[72:75], a[140:143], v[156:159], v[196:199]
  buffer_load_dwordx4 v237, s[16:19], s29 offen offset:1024 lds
  v_mfma_f32_16x16x32_bf16 v[72:75], a[136:139], v[152:155], v[72:75]
  ds_read_b128 a[152:155], v214 offset:20480
  v_mfma_f32_16x16x32_bf16 v[72:75], a[132:135], v[148:151], v[72:75]
  buffer_load_dwordx4 v236, s[16:19], s29 offen offset:2048 lds
  v_mfma_f32_16x16x32_bf16 v[72:75], a[128:131], v[144:147], v[72:75]
  ds_read_b128 a[156:159], v215 offset:20480
  v_mfma_f32_16x16x32_bf16 v[80:83], a[128:131], v[160:163], v[200:203]
  v_exp_f32 v64, v64
  v_mfma_f32_16x16x32_bf16 v[80:83], a[132:135], v[164:167], v[80:83]
  buffer_load_dwordx4 v237, s[16:19], s29 offen offset:3072 lds
  v_mfma_f32_16x16x32_bf16 v[80:83], a[136:139], v[168:171], v[80:83]
  s_add_u32 s29, s29, 16384
  v_exp_f32 v65, v65
  v_mfma_f32_16x16x32_bf16 v[80:83], a[140:143], v[172:175], v[80:83]
  v_cvt_pk_bf16_f32 v64, v64, v65
  v_mfma_f32_16x16x32_bf16 v[88:91], a[140:143], v[188:191], v[204:207]
  s_add_u32 m0, s28, 49152
  v_exp_f32 v66, v66
  v_mfma_f32_16x16x32_bf16 v[88:91], a[136:139], v[184:187], v[88:91]
  buffer_load_dwordx4 v232, s[12:15], s29 offen offset:0 lds
  v_mfma_f32_16x16x32_bf16 v[88:91], a[132:135], v[180:183], v[88:91]
  s_waitcnt lgkmcnt(0)
  v_exp_f32 v67, v67
  v_mfma_f32_16x16x32_bf16 v[88:91], a[128:131], v[176:179], v[88:91]
  v_cvt_pk_bf16_f32 v65, v66, v67
  v_mfma_f32_16x16x32_bf16 v[68:71], a[144:147], v[128:131], v[192:195]
  v_exp_f32 v72, v72
  v_mfma_f32_16x16x32_bf16 v[68:71], a[148:151], v[132:135], v[68:71]
  ds_read_b128 a[128:131], v212 offset:24576
  v_mfma_f32_16x16x32_bf16 v[68:71], a[152:155], v[136:139], v[68:71]
  v_exp_f32 v73, v73
  v_mfma_f32_16x16x32_bf16 v[68:71], a[156:159], v[140:143], v[68:71]
  ds_read_b128 a[132:135], v213 offset:24576
  v_cvt_pk_bf16_f32 v72, v72, v73
  v_mfma_f32_16x16x32_bf16 v[76:79], a[156:159], v[156:159], v[196:199]
  v_exp_f32 v74, v74
  v_mfma_f32_16x16x32_bf16 v[76:79], a[152:155], v[152:155], v[76:79]
  ds_read_b128 a[136:139], v214 offset:24576
  v_mfma_f32_16x16x32_bf16 v[76:79], a[148:151], v[148:151], v[76:79]
  v_exp_f32 v75, v75
  v_mfma_f32_16x16x32_bf16 v[76:79], a[144:147], v[144:147], v[76:79]
  ds_read_b128 a[140:143], v215 offset:24576
  v_cvt_pk_bf16_f32 v73, v74, v75
  v_mfma_f32_16x16x32_bf16 v[84:87], a[144:147], v[160:163], v[200:203]
  v_exp_f32 v80, v80
  v_mfma_f32_16x16x32_bf16 v[84:87], a[148:151], v[164:167], v[84:87]
  buffer_load_dwordx4 v233, s[12:15], s29 offen offset:1024 lds
  v_mfma_f32_16x16x32_bf16 v[84:87], a[152:155], v[168:171], v[84:87]
  v_exp_f32 v81, v81
  v_mfma_f32_16x16x32_bf16 v[84:87], a[156:159], v[172:175], v[84:87]
  v_cvt_pk_bf16_f32 v80, v80, v81
  v_mfma_f32_16x16x32_bf16 v[92:95], a[156:159], v[188:191], v[204:207]
  v_exp_f32 v82, v82
  v_mfma_f32_16x16x32_bf16 v[92:95], a[152:155], v[184:187], v[92:95]
  buffer_load_dwordx4 v234, s[12:15], s29 offen offset:2048 lds
  v_mfma_f32_16x16x32_bf16 v[92:95], a[148:151], v[180:183], v[92:95]
  s_waitcnt lgkmcnt(0)
  v_exp_f32 v83, v83
  v_mfma_f32_16x16x32_bf16 v[92:95], a[144:147], v[176:179], v[92:95]
  v_cvt_pk_bf16_f32 v81, v82, v83
  v_mfma_f32_16x16x32_bf16 v[96:99], a[128:131], v[128:131], v[192:195]
  v_exp_f32 v88, v88
  v_mfma_f32_16x16x32_bf16 v[96:99], a[132:135], v[132:135], v[96:99]
  ds_read_b128 a[144:147], v212 offset:28672
  v_mfma_f32_16x16x32_bf16 v[96:99], a[136:139], v[136:139], v[96:99]
  v_exp_f32 v89, v89
  v_mfma_f32_16x16x32_bf16 v[96:99], a[140:143], v[140:143], v[96:99]
  ds_read_b128 a[148:151], v213 offset:28672
  v_cvt_pk_bf16_f32 v88, v88, v89
  v_mfma_f32_16x16x32_bf16 v[104:107], a[140:143], v[156:159], v[196:199]
  v_exp_f32 v90, v90
  v_mfma_f32_16x16x32_bf16 v[104:107], a[136:139], v[152:155], v[104:107]
  ds_read_b128 a[152:155], v214 offset:28672
  v_mfma_f32_16x16x32_bf16 v[104:107], a[132:135], v[148:151], v[104:107]
  v_exp_f32 v91, v91
  v_mfma_f32_16x16x32_bf16 v[104:107], a[128:131], v[144:147], v[104:107]
  ds_read_b128 a[156:159], v215 offset:28672
  v_cvt_pk_bf16_f32 v89, v90, v91
  v_mfma_f32_16x16x32_bf16 v[112:115], a[128:131], v[160:163], v[200:203]
  v_exp_f32 v68, v68
  v_mfma_f32_16x16x32_bf16 v[112:115], a[132:135], v[164:167], v[112:115]
  buffer_load_dwordx4 v235, s[12:15], s29 offen offset:3072 lds
  v_mfma_f32_16x16x32_bf16 v[112:115], a[136:139], v[168:171], v[112:115]
  v_exp_f32 v69, v69
  v_mfma_f32_16x16x32_bf16 v[112:115], a[140:143], v[172:175], v[112:115]
  v_cvt_pk_bf16_f32 v66, v68, v69
  v_mfma_f32_16x16x32_bf16 v[120:123], a[140:143], v[188:191], v[204:207]
  s_add_u32 m0, s50, 5120
  v_exp_f32 v70, v70
  v_mfma_f32_16x16x32_bf16 v[120:123], a[136:139], v[184:187], v[120:123]
  buffer_load_dwordx4 v208, s[20:23], s30 offen lds
  s_add_u32 s30, s30, 32
  v_mfma_f32_16x16x32_bf16 v[120:123], a[132:135], v[180:183], v[120:123]
  s_waitcnt lgkmcnt(0)
  v_exp_f32 v71, v71
  v_mfma_f32_16x16x32_bf16 v[120:123], a[128:131], v[176:179], v[120:123]
  v_cvt_pk_bf16_f32 v67, v70, v71
  v_mfma_f32_16x16x32_bf16 v[100:103], a[144:147], v[128:131], v[192:195]
  v_exp_f32 v76, v76
  v_mfma_f32_16x16x32_bf16 v[100:103], a[148:151], v[132:135], v[100:103]
  ds_read_b64_tr_b16 a[160:161], v216 offset:0
  v_mfma_f32_16x16x32_bf16 v[100:103], a[152:155], v[136:139], v[100:103]
  v_exp_f32 v77, v77
  v_mfma_f32_16x16x32_bf16 v[100:103], a[156:159], v[140:143], v[100:103]
  ds_read_b64_tr_b16 a[162:163], v216 offset:4096
  v_cvt_pk_bf16_f32 v74, v76, v77
  v_mfma_f32_16x16x32_bf16 v[108:111], a[156:159], v[156:159], v[196:199]
  v_exp_f32 v78, v78
  v_mfma_f32_16x16x32_bf16 v[108:111], a[152:155], v[152:155], v[108:111]
  ds_read_b64_tr_b16 a[164:165], v216 offset:8192
  v_mfma_f32_16x16x32_bf16 v[108:111], a[148:151], v[148:151], v[108:111]
  v_exp_f32 v79, v79
  v_mfma_f32_16x16x32_bf16 v[108:111], a[144:147], v[144:147], v[108:111]
  ds_read_b64_tr_b16 a[166:167], v216 offset:12288
  v_cvt_pk_bf16_f32 v75, v78, v79
  v_mfma_f32_16x16x32_bf16 v[116:119], a[144:147], v[160:163], v[200:203]
  v_exp_f32 v84, v84
  v_mfma_f32_16x16x32_bf16 v[116:119], a[148:151], v[164:167], v[116:119]
  ds_read_b64_tr_b16 a[168:169], v217 offset:0
  v_mfma_f32_16x16x32_bf16 v[116:119], a[152:155], v[168:171], v[116:119]
  v_exp_f32 v85, v85
  v_mfma_f32_16x16x32_bf16 v[116:119], a[156:159], v[172:175], v[116:119]
  ds_read_b64_tr_b16 a[170:171], v217 offset:4096
  v_cvt_pk_bf16_f32 v82, v84, v85
  v_mfma_f32_16x16x32_bf16 v[124:127], a[156:159], v[188:191], v[204:207]
  v_exp_f32 v86, v86
  v_mfma_f32_16x16x32_bf16 v[124:127], a[152:155], v[184:187], v[124:127]
  ds_read_b64_tr_b16 a[172:173], v217 offset:8192
  v_mfma_f32_16x16x32_bf16 v[124:127], a[148:151], v[180:183], v[124:127]
  v_exp_f32 v87, v87
  v_mfma_f32_16x16x32_bf16 v[124:127], a[144:147], v[176:179], v[124:127]
  ds_read_b64_tr_b16 a[174:175], v217 offset:12288
  v_cvt_pk_bf16_f32 v83, v86, v87
  v_mfma_f32_16x16x32_bf16 a[192:195], a[208:211], v[0:3], a[192:195]
  v_exp_f32 v92, v92
  v_mfma_f32_16x16x32_bf16 a[192:195], a[208:211], v[32:35], a[192:195]
  ds_read_b64_tr_b16 a[176:177], v218 offset:0
  v_mfma_f32_16x16x32_bf16 a[196:199], a[208:211], v[8:11], a[196:199]
  v_exp_f32 v93, v93
  v_mfma_f32_16x16x32_bf16 a[196:199], a[208:211], v[40:43], a[196:199]
  ds_read_b64_tr_b16 a[178:179], v218 offset:4096
  v_cvt_pk_bf16_f32 v90, v92, v93
  v_mfma_f32_16x16x32_bf16 a[200:203], a[208:211], v[16:19], a[200:203]
  v_exp_f32 v94, v94
  v_mfma_f32_16x16x32_bf16 a[200:203], a[208:211], v[48:51], a[200:203]
  ds_read_b64_tr_b16 a[180:181], v218 offset:8192
  v_mfma_f32_16x16x32_bf16 a[204:207], a[208:211], v[24:27], a[204:207]
  s_waitcnt lgkmcnt(7)
  v_exp_f32 v95, v95
  v_mfma_f32_16x16x32_bf16 a[204:207], a[208:211], v[56:59], a[204:207]
  ds_read_b64_tr_b16 a[182:183], v218 offset:12288
  v_cvt_pk_bf16_f32 v91, v94, v95
  v_mfma_f32_16x16x32_bf16 a[0:3], a[160:163], v[0:3], a[0:3]
  v_exp_f32 v96, v96
  v_mfma_f32_16x16x32_bf16 a[0:3], a[164:167], v[32:35], a[0:3]
  ds_read_b64_tr_b16 a[184:185], v219 offset:0
  v_mfma_f32_16x16x32_bf16 a[4:7], a[164:167], v[40:43], a[4:7]
  v_exp_f32 v97, v97
  v_mfma_f32_16x16x32_bf16 a[4:7], a[160:163], v[8:11], a[4:7]
  ds_read_b64_tr_b16 a[186:187], v219 offset:4096
  v_cvt_pk_bf16_f32 v96, v96, v97
  v_mfma_f32_16x16x32_bf16 a[8:11], a[160:163], v[16:19], a[8:11]
  v_exp_f32 v98, v98
  v_mfma_f32_16x16x32_bf16 a[8:11], a[164:167], v[48:51], a[8:11]
  ds_read_b64_tr_b16 a[188:189], v219 offset:8192
  v_mfma_f32_16x16x32_bf16 a[12:15], a[164:167], v[56:59], a[12:15]
  s_waitcnt lgkmcnt(7)
  v_exp_f32 v99, v99
  v_mfma_f32_16x16x32_bf16 a[12:15], a[160:163], v[24:27], a[12:15]
  ds_read_b64_tr_b16 a[190:191], v219 offset:12288
  v_cvt_pk_bf16_f32 v97, v98, v99
  v_mfma_f32_16x16x32_bf16 a[16:19], a[168:171], v[0:3], a[16:19]
  v_exp_f32 v104, v104
  v_mfma_f32_16x16x32_bf16 a[16:19], a[172:175], v[32:35], a[16:19]
  ds_read_b64_tr_b16 a[160:161], v220 offset:0
  v_mfma_f32_16x16x32_bf16 a[20:23], a[172:175], v[40:43], a[20:23]
  v_exp_f32 v105, v105
  v_mfma_f32_16x16x32_bf16 a[20:23], a[168:171], v[8:11], a[20:23]
  ds_read_b64_tr_b16 a[162:163], v220 offset:4096
  v_cvt_pk_bf16_f32 v104, v104, v105
  v_mfma_f32_16x16x32_bf16 a[24:27], a[168:171], v[16:19], a[24:27]
  v_exp_f32 v106, v106
  v_mfma_f32_16x16x32_bf16 a[24:27], a[172:175], v[48:51], a[24:27]
  ds_read_b64_tr_b16 a[164:165], v220 offset:8192
  v_mfma_f32_16x16x32_bf16 a[28:31], a[172:175], v[56:59], a[28:31]
  s_waitcnt lgkmcnt(7)
  v_exp_f32 v107, v107
  v_mfma_f32_16x16x32_bf16 a[28:31], a[168:171], v[24:27], a[28:31]
  ds_read_b64_tr_b16 a[166:167], v220 offset:12288
  v_cvt_pk_bf16_f32 v105, v106, v107
  v_mfma_f32_16x16x32_bf16 a[32:35], a[176:179], v[0:3], a[32:35]
  v_exp_f32 v112, v112
  v_mfma_f32_16x16x32_bf16 a[32:35], a[180:183], v[32:35], a[32:35]
  ds_read_b64_tr_b16 a[168:169], v221 offset:0
  v_mfma_f32_16x16x32_bf16 a[36:39], a[180:183], v[40:43], a[36:39]
  v_exp_f32 v113, v113
  v_mfma_f32_16x16x32_bf16 a[36:39], a[176:179], v[8:11], a[36:39]
  ds_read_b64_tr_b16 a[170:171], v221 offset:4096
  v_cvt_pk_bf16_f32 v112, v112, v113
  v_mfma_f32_16x16x32_bf16 a[40:43], a[176:179], v[16:19], a[40:43]
  v_exp_f32 v114, v114
  v_mfma_f32_16x16x32_bf16 a[40:43], a[180:183], v[48:51], a[40:43]
  ds_read_b64_tr_b16 a[172:173], v221 offset:8192
  v_mfma_f32_16x16x32_bf16 a[44:47], a[180:183], v[56:59], a[44:47]
  s_waitcnt lgkmcnt(7)
  v_exp_f32 v115, v115
  v_mfma_f32_16x16x32_bf16 a[44:47], a[176:179], v[24:27], a[44:47]
  ds_read_b64_tr_b16 a[174:175], v221 offset:12288
  v_cvt_pk_bf16_f32 v113, v114, v115
  v_mfma_f32_16x16x32_bf16 a[48:51], a[184:187], v[0:3], a[48:51]
  v_exp_f32 v120, v120
  v_mfma_f32_16x16x32_bf16 a[48:51], a[188:191], v[32:35], a[48:51]
  ds_read_b64_tr_b16 a[176:177], v222 offset:0
  v_mfma_f32_16x16x32_bf16 a[52:55], a[188:191], v[40:43], a[52:55]
  v_exp_f32 v121, v121
  v_mfma_f32_16x16x32_bf16 a[52:55], a[184:187], v[8:11], a[52:55]
  ds_read_b64_tr_b16 a[178:179], v222 offset:4096
  v_cvt_pk_bf16_f32 v120, v120, v121
  v_mfma_f32_16x16x32_bf16 a[56:59], a[184:187], v[16:19], a[56:59]
  v_exp_f32 v122, v122
  v_mfma_f32_16x16x32_bf16 a[56:59], a[188:191], v[48:51], a[56:59]
  ds_read_b64_tr_b16 a[180:181], v222 offset:8192
  v_mfma_f32_16x16x32_bf16 a[60:63], a[188:191], v[56:59], a[60:63]
  s_waitcnt lgkmcnt(7)
  v_exp_f32 v123, v123
  v_mfma_f32_16x16x32_bf16 a[60:63], a[184:187], v[24:27], a[60:63]
  ds_read_b64_tr_b16 a[182:183], v222 offset:12288
  v_cvt_pk_bf16_f32 v121, v122, v123
  v_mfma_f32_16x16x32_bf16 a[64:67], a[160:163], v[0:3], a[64:67]
  v_exp_f32 v100, v100
  v_mfma_f32_16x16x32_bf16 a[64:67], a[164:167], v[32:35], a[64:67]
  ds_read_b64_tr_b16 a[184:185], v223 offset:0
  v_mfma_f32_16x16x32_bf16 a[68:71], a[164:167], v[40:43], a[68:71]
  v_exp_f32 v101, v101
  v_mfma_f32_16x16x32_bf16 a[68:71], a[160:163], v[8:11], a[68:71]
  ds_read_b64_tr_b16 a[186:187], v223 offset:4096
  v_cvt_pk_bf16_f32 v98, v100, v101
  v_mfma_f32_16x16x32_bf16 a[72:75], a[160:163], v[16:19], a[72:75]
  v_exp_f32 v102, v102
  v_mfma_f32_16x16x32_bf16 a[72:75], a[164:167], v[48:51], a[72:75]
  ds_read_b64_tr_b16 a[188:189], v223 offset:8192
  v_mfma_f32_16x16x32_bf16 a[76:79], a[164:167], v[56:59], a[76:79]
  s_waitcnt lgkmcnt(7)
  v_exp_f32 v103, v103
  v_mfma_f32_16x16x32_bf16 a[76:79], a[160:163], v[24:27], a[76:79]
  ds_read_b64_tr_b16 a[190:191], v223 offset:12288
  v_cvt_pk_bf16_f32 v99, v102, v103
  v_mfma_f32_16x16x32_bf16 a[80:83], a[168:171], v[0:3], a[80:83]
  s_waitcnt vmcnt(10)
  v_exp_f32 v108, v108
  v_mfma_f32_16x16x32_bf16 a[80:83], a[172:175], v[32:35], a[80:83]
  v_mfma_f32_16x16x32_bf16 a[84:87], a[172:175], v[40:43], a[84:87]
  s_barrier
  v_exp_f32 v109, v109
  v_mfma_f32_16x16x32_bf16 a[84:87], a[168:171], v[8:11], a[84:87]
  ds_read_b128 a[128:131], v212 offset:32768
  v_cvt_pk_bf16_f32 v106, v108, v109
  v_mfma_f32_16x16x32_bf16 a[88:91], a[168:171], v[16:19], a[88:91]
  v_exp_f32 v110, v110
  v_mfma_f32_16x16x32_bf16 a[88:91], a[172:175], v[48:51], a[88:91]
  ds_read_b128 a[132:135], v213 offset:32768
  buffer_atomic_add v250, v249, s[24:27], s47 offen
  s_cmp_eq_u32 s32, 3
  s_cselect_b32 s39, 0, 1073741824
  v_mfma_f32_16x16x32_bf16 a[92:95], a[172:175], v[56:59], a[92:95]
  s_waitcnt lgkmcnt(6)
  v_exp_f32 v111, v111
  v_mfma_f32_16x16x32_bf16 a[92:95], a[168:171], v[24:27], a[92:95]
  ds_read_b128 a[136:139], v214 offset:32768
  v_cvt_pk_bf16_f32 v107, v110, v111
  v_mfma_f32_16x16x32_bf16 a[96:99], a[176:179], v[0:3], a[96:99]
  v_exp_f32 v116, v116
  v_mfma_f32_16x16x32_bf16 a[96:99], a[180:183], v[32:35], a[96:99]
  ds_read_b128 a[140:143], v215 offset:32768
  v_or_b32 v249, s39, v251
  v_mfma_f32_16x16x32_bf16 a[100:103], a[180:183], v[40:43], a[100:103]
  v_exp_f32 v117, v117
  v_mfma_f32_16x16x32_bf16 a[100:103], a[176:179], v[8:11], a[100:103]
  v_cvt_pk_bf16_f32 v114, v116, v117
  v_mfma_f32_16x16x32_bf16 a[104:107], a[176:179], v[16:19], a[104:107]
  v_exp_f32 v118, v118
  v_mfma_f32_16x16x32_bf16 a[104:107], a[180:183], v[48:51], a[104:107]
  v_mfma_f32_16x16x32_bf16 a[108:111], a[180:183], v[56:59], a[108:111]
  s_waitcnt lgkmcnt(4)
  v_exp_f32 v119, v119
  v_mfma_f32_16x16x32_bf16 a[108:111], a[176:179], v[24:27], a[108:111]
  v_cvt_pk_bf16_f32 v115, v118, v119
  v_mfma_f32_16x16x32_bf16 a[112:115], a[184:187], v[0:3], a[112:115]
  v_exp_f32 v124, v124
  v_mfma_f32_16x16x32_bf16 a[112:115], a[188:191], v[32:35], a[112:115]
  v_mfma_f32_16x16x32_bf16 a[116:119], a[188:191], v[40:43], a[116:119]
  v_exp_f32 v125, v125
  v_mfma_f32_16x16x32_bf16 a[116:119], a[184:187], v[8:11], a[116:119]
  v_cvt_pk_bf16_f32 v122, v124, v125
  v_mfma_f32_16x16x32_bf16 a[120:123], a[184:187], v[16:19], a[120:123]
  v_exp_f32 v126, v126
  v_mfma_f32_16x16x32_bf16 a[120:123], a[188:191], v[48:51], a[120:123]
  v_mfma_f32_16x16x32_bf16 a[124:127], a[188:191], v[56:59], a[124:127]
  s_waitcnt lgkmcnt(0)
  v_exp_f32 v127, v127
  v_mfma_f32_16x16x32_bf16 a[124:127], a[184:187], v[24:27], a[124:127]
  v_cvt_pk_bf16_f32 v123, v126, v127
  v_mfma_f32_16x16x32_bf16 v[0:3], a[128:131], v[128:131], v[192:195]
  s_add_u32 m0, s28, 114688
  v_mfma_f32_16x16x32_bf16 v[0:3], a[132:135], v[132:135], v[0:3]
  ds_read_b128 a[144:147], v212 offset:36864
  v_mfma_f32_16x16x32_bf16 v[0:3], a[136:139], v[136:139], v[0:3]
  buffer_load_dwordx4 v236, s[16:19], s29 offen offset:0 lds
  v_mfma_f32_16x16x32_bf16 v[0:3], a[140:143], v[140:143], v[0:3]
  ds_read_b128 a[148:151], v213 offset:36864
  v_mfma_f32_16x16x32_bf16 v[8:11], a[140:143], v[156:159], v[196:199]
  buffer_load_dwordx4 v237, s[16:19], s29 offen offset:1024 lds
  v_mfma_f32_16x16x32_bf16 v[8:11], a[136:139], v[152:155], v[8:11]
  ds_read_b128 a[152:155], v214 offset:36864
  v_mfma_f32_16x16x32_bf16 v[8:11], a[132:135], v[148:151], v[8:11]
  buffer_load_dwordx4 v236, s[16:19], s29 offen offset:2048 lds
  v_mfma_f32_16x16x32_bf16 v[8:11], a[128:131], v[144:147], v[8:11]
  ds_read_b128 a[156:159], v215 offset:36864
  v_mfma_f32_16x16x32_bf16 v[16:19], a[128:131], v[160:163], v[200:203]
  v_exp_f32 v0, v0
  v_mfma_f32_16x16x32_bf16 v[16:19], a[132:135], v[164:167], v[16:19]
  buffer_load_dwordx4 v237, s[16:19], s29 offen offset:3072 lds
  v_mfma_f32_16x16x32_bf16 v[16:19], a[136:139], v[168:171], v[16:19]
  s_add_u32 s29, s29, 16384
  v_exp_f32 v1, v1
  v_mfma_f32_16x16x32_bf16 v[16:19], a[140:143], v[172:175], v[16:19]
  v_cvt_pk_bf16_f32 v0, v0, v1
  v_mfma_f32_16x16x32_bf16 v[24:27], a[140:143], v[188:191], v[204:207]
  s_add_u32 m0, s28, 0
  v_exp_f32 v2, v2
  v_mfma_f32_16x16x32_bf16 v[24:27], a[136:139], v[184:187], v[24:27]
  buffer_load_dwordx4 v232, s[12:15], s29 offen offset:0 lds
  v_mfma_f32_16x16x32_bf16 v[24:27], a[132:135], v[180:183], v[24:27]
  s_waitcnt lgkmcnt(0)
  v_exp_f32 v3, v3
  v_mfma_f32_16x16x32_bf16 v[24:27], a[128:131], v[176:179], v[24:27]
  v_cvt_pk_bf16_f32 v1, v2, v3
  v_mfma_f32_16x16x32_bf16 v[4:7], a[144:147], v[128:131], v[192:195]
  v_exp_f32 v8, v8
  v_mfma_f32_16x16x32_bf16 v[4:7], a[148:151], v[132:135], v[4:7]
  ds_read_b128 a[128:131], v212 offset:40960
  v_mfma_f32_16x16x32_bf16 v[4:7], a[152:155], v[136:139], v[4:7]
  v_exp_f32 v9, v9
  v_mfma_f32_16x16x32_bf16 v[4:7], a[156:159], v[140:143], v[4:7]
  ds_read_b128 a[132:135], v213 offset:40960
  v_cvt_pk_bf16_f32 v8, v8, v9
  v_mfma_f32_16x16x32_bf16 v[12:15], a[156:159], v[156:159], v[196:199]
  v_exp_f32 v10, v10
  v_mfma_f32_16x16x32_bf16 v[12:15], a[152:155], v[152:155], v[12:15]
  ds_read_b128 a[136:139], v214 offset:40960
  v_mfma_f32_16x16x32_bf16 v[12:15], a[148:151], v[148:151], v[12:15]
  v_exp_f32 v11, v11
  v_mfma_f32_16x16x32_bf16 v[12:15], a[144:147], v[144:147], v[12:15]
  ds_read_b128 a[140:143], v215 offset:40960
  v_cvt_pk_bf16_f32 v9, v10, v11
  v_mfma_f32_16x16x32_bf16 v[20:23], a[144:147], v[160:163], v[200:203]
  v_exp_f32 v16, v16
  v_mfma_f32_16x16x32_bf16 v[20:23], a[148:151], v[164:167], v[20:23]
  buffer_load_dwordx4 v233, s[12:15], s29 offen offset:1024 lds
  v_mfma_f32_16x16x32_bf16 v[20:23], a[152:155], v[168:171], v[20:23]
  v_exp_f32 v17, v17
  v_mfma_f32_16x16x32_bf16 v[20:23], a[156:159], v[172:175], v[20:23]
  v_cvt_pk_bf16_f32 v16, v16, v17
  v_mfma_f32_16x16x32_bf16 v[28:31], a[156:159], v[188:191], v[204:207]
  v_exp_f32 v18, v18
  v_mfma_f32_16x16x32_bf16 v[28:31], a[152:155], v[184:187], v[28:31]
  buffer_load_dwordx4 v234, s[12:15], s29 offen offset:2048 lds
  v_mfma_f32_16x16x32_bf16 v[28:31], a[148:151], v[180:183], v[28:31]
  s_waitcnt lgkmcnt(0)
  v_exp_f32 v19, v19
  v_mfma_f32_16x16x32_bf16 v[28:31], a[144:147], v[176:179], v[28:31]
  v_cvt_pk_bf16_f32 v17, v18, v19
  v_mfma_f32_16x16x32_bf16 v[32:35], a[128:131], v[128:131], v[192:195]
  v_exp_f32 v24, v24
  v_mfma_f32_16x16x32_bf16 v[32:35], a[132:135], v[132:135], v[32:35]
  ds_read_b128 a[144:147], v212 offset:45056
  v_mfma_f32_16x16x32_bf16 v[32:35], a[136:139], v[136:139], v[32:35]
  v_exp_f32 v25, v25
  v_mfma_f32_16x16x32_bf16 v[32:35], a[140:143], v[140:143], v[32:35]
  ds_read_b128 a[148:151], v213 offset:45056
  v_cvt_pk_bf16_f32 v24, v24, v25
  v_mfma_f32_16x16x32_bf16 v[40:43], a[140:143], v[156:159], v[196:199]
  v_exp_f32 v26, v26
  v_mfma_f32_16x16x32_bf16 v[40:43], a[136:139], v[152:155], v[40:43]
  ds_read_b128 a[152:155], v214 offset:45056
  v_mfma_f32_16x16x32_bf16 v[40:43], a[132:135], v[148:151], v[40:43]
  v_exp_f32 v27, v27
  v_mfma_f32_16x16x32_bf16 v[40:43], a[128:131], v[144:147], v[40:43]
  ds_read_b128 a[156:159], v215 offset:45056
  v_cvt_pk_bf16_f32 v25, v26, v27
  v_mfma_f32_16x16x32_bf16 v[48:51], a[128:131], v[160:163], v[200:203]
  v_exp_f32 v4, v4
  v_mfma_f32_16x16x32_bf16 v[48:51], a[132:135], v[164:167], v[48:51]
  buffer_load_dwordx4 v235, s[12:15], s29 offen offset:3072 lds
  v_mfma_f32_16x16x32_bf16 v[48:51], a[136:139], v[168:171], v[48:51]
  v_exp_f32 v5, v5
  v_mfma_f32_16x16x32_bf16 v[48:51], a[140:143], v[172:175], v[48:51]
  v_cvt_pk_bf16_f32 v2, v4, v5
  v_mfma_f32_16x16x32_bf16 v[56:59], a[140:143], v[188:191], v[204:207]
  s_mov_b32 m0, s51
  v_exp_f32 v6, v6
  v_mfma_f32_16x16x32_bf16 v[56:59], a[136:139], v[184:187], v[56:59]
  buffer_load_dwordx4 v210, s[4:7], s100 offen lds
  s_add_u32 s100, s100, 20480
  s_add_u32 s51, s51, 512
  v_mfma_f32_16x16x32_bf16 v[56:59], a[132:135], v[180:183], v[56:59]
  s_waitcnt lgkmcnt(0)
  v_exp_f32 v7, v7
  v_mfma_f32_16x16x32_bf16 v[56:59], a[128:131], v[176:179], v[56:59]
  v_cvt_pk_bf16_f32 v3, v6, v7
  v_mfma_f32_16x16x32_bf16 v[36:39], a[144:147], v[128:131], v[192:195]
  v_exp_f32 v12, v12
  v_mfma_f32_16x16x32_bf16 v[36:39], a[148:151], v[132:135], v[36:39]
  ds_read_b64_tr_b16 a[160:161], v216 offset:16384
  v_mfma_f32_16x16x32_bf16 v[36:39], a[152:155], v[136:139], v[36:39]
  v_exp_f32 v13, v13
  v_mfma_f32_16x16x32_bf16 v[36:39], a[156:159], v[140:143], v[36:39]
  ds_read_b64_tr_b16 a[162:163], v216 offset:20480
  v_cvt_pk_bf16_f32 v10, v12, v13
  v_mfma_f32_16x16x32_bf16 v[44:47], a[156:159], v[156:159], v[196:199]
  v_exp_f32 v14, v14
  v_mfma_f32_16x16x32_bf16 v[44:47], a[152:155], v[152:155], v[44:47]
  ds_read_b64_tr_b16 a[164:165], v216 offset:24576
  v_mfma_f32_16x16x32_bf16 v[44:47], a[148:151], v[148:151], v[44:47]
  v_exp_f32 v15, v15
  v_mfma_f32_16x16x32_bf16 v[44:47], a[144:147], v[144:147], v[44:47]
  ds_read_b64_tr_b16 a[166:167], v216 offset:28672
  v_cvt_pk_bf16_f32 v11, v14, v15
  v_mfma_f32_16x16x32_bf16 v[52:55], a[144:147], v[160:163], v[200:203]
  v_exp_f32 v20, v20
  v_mfma_f32_16x16x32_bf16 v[52:55], a[148:151], v[164:167], v[52:55]
  ds_read_b64_tr_b16 a[168:169], v217 offset:16384
  v_mfma_f32_16x16x32_bf16 v[52:55], a[152:155], v[168:171], v[52:55]
  v_exp_f32 v21, v21
  v_mfma_f32_16x16x32_bf16 v[52:55], a[156:159], v[172:175], v[52:55]
  ds_read_b64_tr_b16 a[170:171], v217 offset:20480
  v_cvt_pk_bf16_f32 v18, v20, v21
  v_mfma_f32_16x16x32_bf16 v[60:63], a[156:159], v[188:191], v[204:207]
  v_exp_f32 v22, v22
  v_mfma_f32_16x16x32_bf16 v[60:63], a[152:155], v[184:187], v[60:63]
  ds_read_b64_tr_b16 a[172:173], v217 offset:24576
  v_mfma_f32_16x16x32_bf16 v[60:63], a[148:151], v[180:183], v[60:63]
  v_exp_f32 v23, v23
  v_mfma_f32_16x16x32_bf16 v[60:63], a[144:147], v[176:179], v[60:63]
  ds_read_b64_tr_b16 a[174:175], v217 offset:28672
  v_cvt_pk_bf16_f32 v19, v22, v23
  v_mfma_f32_16x16x32_bf16 a[192:195], a[208:211], v[64:67], a[192:195]
  v_exp_f32 v28, v28
  v_mfma_f32_16x16x32_bf16 a[192:195], a[208:211], v[96:99], a[192:195]
  ds_read_b64_tr_b16 a[176:177], v218 offset:16384
  v_mfma_f32_16x16x32_bf16 a[196:199], a[208:211], v[72:75], a[196:199]
  v_exp_f32 v29, v29
  v_mfma_f32_16x16x32_bf16 a[196:199], a[208:211], v[104:107], a[196:199]
  ds_read_b64_tr_b16 a[178:179], v218 offset:20480
  v_cvt_pk_bf16_f32 v26, v28, v29
  v_mfma_f32_16x16x32_bf16 a[200:203], a[208:211], v[80:83], a[200:203]
  v_exp_f32 v30, v30
  v_mfma_f32_16x16x32_bf16 a[200:203], a[208:211], v[112:115], a[200:203]
  ds_read_b64_tr_b16 a[180:181], v218 offset:24576
  v_mfma_f32_16x16x32_bf16 a[204:207], a[208:211], v[88:91], a[204:207]
  s_waitcnt lgkmcnt(7)
  v_exp_f32 v31, v31
  v_mfma_f32_16x16x32_bf16 a[204:207], a[208:211], v[120:123], a[204:207]
  ds_read_b64_tr_b16 a[182:183], v218 offset:28672
  v_cvt_pk_bf16_f32 v27, v30, v31
  v_mfma_f32_16x16x32_bf16 a[0:3], a[160:163], v[64:67], a[0:3]
  v_exp_f32 v32, v32
  v_mfma_f32_16x16x32_bf16 a[0:3], a[164:167], v[96:99], a[0:3]
  ds_read_b64_tr_b16 a[184:185], v219 offset:16384
  v_mfma_f32_16x16x32_bf16 a[4:7], a[164:167], v[104:107], a[4:7]
  v_exp_f32 v33, v33
  v_mfma_f32_16x16x32_bf16 a[4:7], a[160:163], v[72:75], a[4:7]
  ds_read_b64_tr_b16 a[186:187], v219 offset:20480
  v_cvt_pk_bf16_f32 v32, v32, v33
  v_mfma_f32_16x16x32_bf16 a[8:11], a[160:163], v[80:83], a[8:11]
  v_exp_f32 v34, v34
  v_mfma_f32_16x16x32_bf16 a[8:11], a[164:167], v[112:115], a[8:11]
  ds_read_b64_tr_b16 a[188:189], v219 offset:24576
  v_mfma_f32_16x16x32_bf16 a[12:15], a[164:167], v[120:123], a[12:15]
  s_waitcnt lgkmcnt(7)
  v_exp_f32 v35, v35
  v_mfma_f32_16x16x32_bf16 a[12:15], a[160:163], v[88:91], a[12:15]
  ds_read_b64_tr_b16 a[190:191], v219 offset:28672
  v_cvt_pk_bf16_f32 v33, v34, v35
  v_mfma_f32_16x16x32_bf16 a[16:19], a[168:171], v[64:67], a[16:19]
  v_exp_f32 v40, v40
  v_mfma_f32_16x16x32_bf16 a[16:19], a[172:175], v[96:99], a[16:19]
  ds_read_b64_tr_b16 a[160:161], v220 offset:16384
  v_mfma_f32_16x16x32_bf16 a[20:23], a[172:175], v[104:107], a[20:23]
  v_exp_f32 v41, v41
  v_mfma_f32_16x16x32_bf16 a[20:23], a[168:171], v[72:75], a[20:23]
  ds_read_b64_tr_b16 a[162:163], v220 offset:20480
  v_cvt_pk_bf16_f32 v40, v40, v41
  v_mfma_f32_16x16x32_bf16 a[24:27], a[168:171], v[80:83], a[24:27]
  v_exp_f32 v42, v42
  v_mfma_f32_16x16x32_bf16 a[24:27], a[172:175], v[112:115], a[24:27]
  ds_read_b64_tr_b16 a[164:165], v220 offset:24576
  v_mfma_f32_16x16x32_bf16 a[28:31], a[172:175], v[120:123], a[28:31]
  s_waitcnt lgkmcnt(7)
  v_exp_f32 v43, v43
  v_mfma_f32_16x16x32_bf16 a[28:31], a[168:171], v[88:91], a[28:31]
  ds_read_b64_tr_b16 a[166:167], v220 offset:28672
  v_cvt_pk_bf16_f32 v41, v42, v43
  v_mfma_f32_16x16x32_bf16 a[32:35], a[176:179], v[64:67], a[32:35]
  v_exp_f32 v48, v48
  v_mfma_f32_16x16x32_bf16 a[32:35], a[180:183], v[96:99], a[32:35]
  ds_read_b64_tr_b16 a[168:169], v221 offset:16384
  v_mfma_f32_16x16x32_bf16 a[36:39], a[180:183], v[104:107], a[36:39]
  v_exp_f32 v49, v49
  v_mfma_f32_16x16x32_bf16 a[36:39], a[176:179], v[72:75], a[36:39]
  ds_read_b64_tr_b16 a[170:171], v221 offset:20480
  v_cvt_pk_bf16_f32 v48, v48, v49
  v_mfma_f32_16x16x32_bf16 a[40:43], a[176:179], v[80:83], a[40:43]
  v_exp_f32 v50, v50
  v_mfma_f32_16x16x32_bf16 a[40:43], a[180:183], v[112:115], a[40:43]
  ds_read_b64_tr_b16 a[172:173], v221 offset:24576
  v_mfma_f32_16x16x32_bf16 a[44:47], a[180:183], v[120:123], a[44:47]
  s_waitcnt lgkmcnt(7)
  v_exp_f32 v51, v51
  v_mfma_f32_16x16x32_bf16 a[44:47], a[176:179], v[88:91], a[44:47]
  ds_read_b64_tr_b16 a[174:175], v221 offset:28672
  v_cvt_pk_bf16_f32 v49, v50, v51
  v_mfma_f32_16x16x32_bf16 a[48:51], a[184:187], v[64:67], a[48:51]
  v_exp_f32 v56, v56
  v_mfma_f32_16x16x32_bf16 a[48:51], a[188:191], v[96:99], a[48:51]
  ds_read_b64_tr_b16 a[176:177], v222 offset:16384
  v_mfma_f32_16x16x32_bf16 a[52:55], a[188:191], v[104:107], a[52:55]
  v_exp_f32 v57, v57
  v_mfma_f32_16x16x32_bf16 a[52:55], a[184:187], v[72:75], a[52:55]
  ds_read_b64_tr_b16 a[178:179], v222 offset:20480
  v_cvt_pk_bf16_f32 v56, v56, v57
  v_mfma_f32_16x16x32_bf16 a[56:59], a[184:187], v[80:83], a[56:59]
  v_exp_f32 v58, v58
  v_mfma_f32_16x16x32_bf16 a[56:59], a[188:191], v[112:115], a[56:59]
  ds_read_b64_tr_b16 a[180:181], v222 offset:24576
  v_mfma_f32_16x16x32_bf16 a[60:63], a[188:191], v[120:123], a[60:63]
  s_waitcnt lgkmcnt(7)
  v_exp_f32 v59, v59
  v_mfma_f32_16x16x32_bf16 a[60:63], a[184:187], v[88:91], a[60:63]
  ds_read_b64_tr_b16 a[182:183], v222 offset:28672
  v_cvt_pk_bf16_f32 v57, v58, v59
  v_mfma_f32_16x16x32_bf16 a[64:67], a[160:163], v[64:67], a[64:67]
  v_exp_f32 v36, v36
  v_mfma_f32_16x16x32_bf16 a[64:67], a[164:167], v[96:99], a[64:67]
  ds_read_b64_tr_b16 a[184:185], v223 offset:16384
  v_mfma_f32_16x16x32_bf16 a[68:71], a[164:167], v[104:107], a[68:71]
  v_exp_f32 v37, v37
  v_mfma_f32_16x16x32_bf16 a[68:71], a[160:163], v[72:75], a[68:71]
  ds_read_b64_tr_b16 a[186:187], v223 offset:20480
  v_cvt_pk_bf16_f32 v34, v36, v37
  v_mfma_f32_16x16x32_bf16 a[72:75], a[160:163], v[80:83], a[72:75]
  v_exp_f32 v38, v38
  v_mfma_f32_16x16x32_bf16 a[72:75], a[164:167], v[112:115], a[72:75]
  ds_read_b64_tr_b16 a[188:189], v223 offset:24576
  v_mfma_f32_16x16x32_bf16 a[76:79], a[164:167], v[120:123], a[76:79]
  s_waitcnt lgkmcnt(7)
  v_exp_f32 v39, v39
  v_mfma_f32_16x16x32_bf16 a[76:79], a[160:163], v[88:91], a[76:79]
  ds_read_b64_tr_b16 a[190:191], v223 offset:28672
  v_cvt_pk_bf16_f32 v35, v38, v39
  v_mfma_f32_16x16x32_bf16 a[80:83], a[168:171], v[64:67], a[80:83]
  s_waitcnt vmcnt(11)
  v_exp_f32 v44, v44
  v_mfma_f32_16x16x32_bf16 a[80:83], a[172:175], v[96:99], a[80:83]
  v_mfma_f32_16x16x32_bf16 a[84:87], a[172:175], v[104:107], a[84:87]
  s_barrier
  v_exp_f32 v45, v45
  v_mfma_f32_16x16x32_bf16 a[84:87], a[168:171], v[72:75], a[84:87]
  ds_read_b128 a[128:131], v212 offset:49152
  v_cvt_pk_bf16_f32 v42, v44, v45
  v_mfma_f32_16x16x32_bf16 a[88:91], a[168:171], v[80:83], a[88:91]
  v_exp_f32 v46, v46
  v_mfma_f32_16x16x32_bf16 a[88:91], a[172:175], v[112:115], a[88:91]
  ds_read_b128 a[132:135], v213 offset:49152
  ds_read_b64_tr_b16 a[232:233], v209 offset:4096
  v_mfma_f32_16x16x32_bf16 a[92:95], a[172:175], v[120:123], a[92:95]
  s_waitcnt lgkmcnt(7)
  v_exp_f32 v47, v47
  v_mfma_f32_16x16x32_bf16 a[92:95], a[168:171], v[88:91], a[92:95]
  ds_read_b128 a[136:139], v214 offset:49152
  v_cvt_pk_bf16_f32 v43, v46, v47
  v_mfma_f32_16x16x32_bf16 a[96:99], a[176:179], v[64:67], a[96:99]
  v_exp_f32 v52, v52
  v_mfma_f32_16x16x32_bf16 a[96:99], a[180:183], v[96:99], a[96:99]
  ds_read_b128 a[140:143], v215 offset:49152
  ds_read_b64_tr_b16 a[234:235], v209 offset:4608
  v_mfma_f32_16x16x32_bf16 a[100:103], a[180:183], v[104:107], a[100:103]
  v_exp_f32 v53, v53
  v_mfma_f32_16x16x32_bf16 a[100:103], a[176:179], v[72:75], a[100:103]
  v_cvt_pk_bf16_f32 v50, v52, v53
  v_mfma_f32_16x16x32_bf16 a[104:107], a[176:179], v[80:83], a[104:107]
  v_exp_f32 v54, v54
  v_mfma_f32_16x16x32_bf16 a[104:107], a[180:183], v[112:115], a[104:107]
  v_mfma_f32_16x16x32_bf16 a[108:111], a[180:183], v[120:123], a[108:111]
  s_waitcnt lgkmcnt(6)
  v_exp_f32 v55, v55
  v_mfma_f32_16x16x32_bf16 a[108:111], a[176:179], v[88:91], a[108:111]
  v_cvt_pk_bf16_f32 v51, v54, v55
  v_mfma_f32_16x16x32_bf16 a[112:115], a[184:187], v[64:67], a[112:115]
  v_exp_f32 v60, v60
  v_mfma_f32_16x16x32_bf16 a[112:115], a[188:191], v[96:99], a[112:115]
  s_waitcnt lgkmcnt(0)
  buffer_store_dwordx4 a[232:235], v211, s[24:27], s31 offen sc1
  s_add_u32 s31, s31, 1024
  v_mfma_f32_16x16x32_bf16 a[116:119], a[188:191], v[104:107], a[116:119]
  s_cmp_gt_u32 s32, 3
  s_cselect_b32 s39, 0, 1073741824
  v_exp_f32 v61, v61
  v_mfma_f32_16x16x32_bf16 a[116:119], a[184:187], v[72:75], a[116:119]
  v_cvt_pk_bf16_f32 v58, v60, v61
  v_or_b32 v211, s39, v211
  v_mfma_f32_16x16x32_bf16 a[120:123], a[184:187], v[80:83], a[120:123]
  v_exp_f32 v62, v62
  v_mfma_f32_16x16x32_bf16 a[120:123], a[188:191], v[112:115], a[120:123]
  v_or_b32 v208, s39, v208
  v_mfma_f32_16x16x32_bf16 a[124:127], a[188:191], v[120:123], a[124:127]
  v_exp_f32 v63, v63
  v_mfma_f32_16x16x32_bf16 a[124:127], a[184:187], v[88:91], a[124:127]
  v_cvt_pk_bf16_f32 v59, v62, v63
  v_mfma_f32_16x16x32_bf16 v[64:67], a[128:131], v[128:131], v[192:195]
  s_add_u32 m0, s28, 65536
  v_mfma_f32_16x16x32_bf16 v[64:67], a[132:135], v[132:135], v[64:67]
  ds_read_b128 a[144:147], v212 offset:53248
  v_mfma_f32_16x16x32_bf16 v[64:67], a[136:139], v[136:139], v[64:67]
  buffer_load_dwordx4 v236, s[16:19], s29 offen offset:0 lds
  v_mfma_f32_16x16x32_bf16 v[64:67], a[140:143], v[140:143], v[64:67]
  ds_read_b128 a[148:151], v213 offset:53248
  v_mfma_f32_16x16x32_bf16 v[72:75], a[140:143], v[156:159], v[196:199]
  buffer_load_dwordx4 v237, s[16:19], s29 offen offset:1024 lds
  v_mfma_f32_16x16x32_bf16 v[72:75], a[136:139], v[152:155], v[72:75]
  ds_read_b128 a[152:155], v214 offset:53248
  v_mfma_f32_16x16x32_bf16 v[72:75], a[132:135], v[148:151], v[72:75]
  buffer_load_dwordx4 v236, s[16:19], s29 offen offset:2048 lds
  v_mfma_f32_16x16x32_bf16 v[72:75], a[128:131], v[144:147], v[72:75]
  ds_read_b128 a[156:159], v215 offset:53248
  v_mfma_f32_16x16x32_bf16 v[80:83], a[128:131], v[160:163], v[200:203]
  v_exp_f32 v64, v64
  v_mfma_f32_16x16x32_bf16 v[80:83], a[132:135], v[164:167], v[80:83]
  buffer_load_dwordx4 v237, s[16:19], s29 offen offset:3072 lds
  v_mfma_f32_16x16x32_bf16 v[80:83], a[136:139], v[168:171], v[80:83]
  s_add_u32 s29, s29, 16384
  v_exp_f32 v65, v65
  v_mfma_f32_16x16x32_bf16 v[80:83], a[140:143], v[172:175], v[80:83]
  v_cvt_pk_bf16_f32 v64, v64, v65
  v_mfma_f32_16x16x32_bf16 v[88:91], a[140:143], v[188:191], v[204:207]
  s_add_u32 m0, s28, 16384
  v_exp_f32 v66, v66
  v_mfma_f32_16x16x32_bf16 v[88:91], a[136:139], v[184:187], v[88:91]
  buffer_load_dwordx4 v232, s[12:15], s29 offen offset:0 lds
  v_mfma_f32_16x16x32_bf16 v[88:91], a[132:135], v[180:183], v[88:91]
  s_waitcnt lgkmcnt(0)
  v_exp_f32 v67, v67
  v_mfma_f32_16x16x32_bf16 v[88:91], a[128:131], v[176:179], v[88:91]
  v_cvt_pk_bf16_f32 v65, v66, v67
  v_mfma_f32_16x16x32_bf16 v[68:71], a[144:147], v[128:131], v[192:195]
  v_exp_f32 v72, v72
  v_mfma_f32_16x16x32_bf16 v[68:71], a[148:151], v[132:135], v[68:71]
  ds_read_b128 a[128:131], v212 offset:57344
  v_mfma_f32_16x16x32_bf16 v[68:71], a[152:155], v[136:139], v[68:71]
  v_exp_f32 v73, v73
  v_mfma_f32_16x16x32_bf16 v[68:71], a[156:159], v[140:143], v[68:71]
  ds_read_b128 a[132:135], v213 offset:57344
  v_cvt_pk_bf16_f32 v72, v72, v73
  v_mfma_f32_16x16x32_bf16 v[76:79], a[156:159], v[156:159], v[196:199]
  v_exp_f32 v74, v74
  v_mfma_f32_16x16x32_bf16 v[76:79], a[152:155], v[152:155], v[76:79]
  ds_read_b128 a[136:139], v214 offset:57344
  v_mfma_f32_16x16x32_bf16 v[76:79], a[148:151], v[148:151], v[76:79]
  v_exp_f32 v75, v75
  v_mfma_f32_16x16x32_bf16 v[76:79], a[144:147], v[144:147], v[76:79]
  ds_read_b128 a[140:143], v215 offset:57344
  v_cvt_pk_bf16_f32 v73, v74, v75
  v_mfma_f32_16x16x32_bf16 v[84:87], a[144:147], v[160:163], v[200:203]
  v_exp_f32 v80, v80
  v_mfma_f32_16x16x32_bf16 v[84:87], a[148:151], v[164:167], v[84:87]
  buffer_load_dwordx4 v233, s[12:15], s29 offen offset:1024 lds
  v_mfma_f32_16x16x32_bf16 v[84:87], a[152:155], v[168:171], v[84:87]
  v_exp_f32 v81, v81
  v_mfma_f32_16x16x32_bf16 v[84:87], a[156:159], v[172:175], v[84:87]
  v_cvt_pk_bf16_f32 v80, v80, v81
  v_mfma_f32_16x16x32_bf16 v[92:95], a[156:159], v[188:191], v[204:207]
  v_exp_f32 v82, v82
  v_mfma_f32_16x16x32_bf16 v[92:95], a[152:155], v[184:187], v[92:95]
  buffer_load_dwordx4 v234, s[12:15], s29 offen offset:2048 lds
  v_mfma_f32_16x16x32_bf16 v[92:95], a[148:151], v[180:183], v[92:95]
  s_waitcnt lgkmcnt(0)
  v_exp_f32 v83, v83
  v_mfma_f32_16x16x32_bf16 v[92:95], a[144:147], v[176:179], v[92:95]
  v_cvt_pk_bf16_f32 v81, v82, v83
  v_mfma_f32_16x16x32_bf16 v[96:99], a[128:131], v[128:131], v[192:195]
  v_exp_f32 v88, v88
  v_mfma_f32_16x16x32_bf16 v[96:99], a[132:135], v[132:135], v[96:99]
  ds_read_b128 a[144:147], v212 offset:61440
  v_mfma_f32_16x16x32_bf16 v[96:99], a[136:139], v[136:139], v[96:99]
  v_exp_f32 v89, v89
  v_mfma_f32_16x16x32_bf16 v[96:99], a[140:143], v[140:143], v[96:99]
  ds_read_b128 a[148:151], v213 offset:61440
  v_cvt_pk_bf16_f32 v88, v88, v89
  v_mfma_f32_16x16x32_bf16 v[104:107], a[140:143], v[156:159], v[196:199]
  v_exp_f32 v90, v90
  v_mfma_f32_16x16x32_bf16 v[104:107], a[136:139], v[152:155], v[104:107]
  ds_read_b128 a[152:155], v214 offset:61440
  v_mfma_f32_16x16x32_bf16 v[104:107], a[132:135], v[148:151], v[104:107]
  v_exp_f32 v91, v91
  v_mfma_f32_16x16x32_bf16 v[104:107], a[128:131], v[144:147], v[104:107]
  ds_read_b128 a[156:159], v215 offset:61440
  v_cvt_pk_bf16_f32 v89, v90, v91
  v_mfma_f32_16x16x32_bf16 v[112:115], a[128:131], v[160:163], v[200:203]
  v_exp_f32 v68, v68
  v_mfma_f32_16x16x32_bf16 v[112:115], a[132:135], v[164:167], v[112:115]
  buffer_load_dwordx4 v235, s[12:15], s29 offen offset:3072 lds
  v_mfma_f32_16x16x32_bf16 v[112:115], a[136:139], v[168:171], v[112:115]
  v_exp_f32 v69, v69
  v_mfma_f32_16x16x32_bf16 v[112:115], a[140:143], v[172:175], v[112:115]
  v_cvt_pk_bf16_f32 v66, v68, v69
  v_mfma_f32_16x16x32_bf16 v[120:123], a[140:143], v[188:191], v[204:207]
  v_exp_f32 v70, v70
  v_mfma_f32_16x16x32_bf16 v[120:123], a[136:139], v[184:187], v[120:123]
  buffer_load_dword v254, off, s[24:27], s47 sc1
  v_mfma_f32_16x16x32_bf16 v[120:123], a[132:135], v[180:183], v[120:123]
  s_waitcnt lgkmcnt(0)
  v_exp_f32 v71, v71
  v_mfma_f32_16x16x32_bf16 v[120:123], a[128:131], v[176:179], v[120:123]
  v_cvt_pk_bf16_f32 v67, v70, v71
  v_mfma_f32_16x16x32_bf16 v[100:103], a[144:147], v[128:131], v[192:195]
  v_exp_f32 v76, v76
  v_mfma_f32_16x16x32_bf16 v[100:103], a[148:151], v[132:135], v[100:103]
  ds_read_b64_tr_b16 a[160:161], v216 offset:32768
  v_mfma_f32_16x16x32_bf16 v[100:103], a[152:155], v[136:139], v[100:103]
  v_exp_f32 v77, v77
  v_mfma_f32_16x16x32_bf16 v[100:103], a[156:159], v[140:143], v[100:103]
  ds_read_b64_tr_b16 a[162:163], v216 offset:36864
  v_cvt_pk_bf16_f32 v74, v76, v77
  v_mfma_f32_16x16x32_bf16 v[108:111], a[156:159], v[156:159], v[196:199]
  v_exp_f32 v78, v78
  v_mfma_f32_16x16x32_bf16 v[108:111], a[152:155], v[152:155], v[108:111]
  ds_read_b64_tr_b16 a[164:165], v216 offset:40960
  v_mfma_f32_16x16x32_bf16 v[108:111], a[148:151], v[148:151], v[108:111]
  v_exp_f32 v79, v79
  v_mfma_f32_16x16x32_bf16 v[108:111], a[144:147], v[144:147], v[108:111]
  ds_read_b64_tr_b16 a[166:167], v216 offset:45056
  v_cvt_pk_bf16_f32 v75, v78, v79
  v_mfma_f32_16x16x32_bf16 v[116:119], a[144:147], v[160:163], v[200:203]
  v_exp_f32 v84, v84
  v_mfma_f32_16x16x32_bf16 v[116:119], a[148:151], v[164:167], v[116:119]
  ds_read_b64_tr_b16 a[168:169], v217 offset:32768
  v_mfma_f32_16x16x32_bf16 v[116:119], a[152:155], v[168:171], v[116:119]
  v_exp_f32 v85, v85
  v_mfma_f32_16x16x32_bf16 v[116:119], a[156:159], v[172:175], v[116:119]
  ds_read_b64_tr_b16 a[170:171], v217 offset:36864
  v_cvt_pk_bf16_f32 v82, v84, v85
  v_mfma_f32_16x16x32_bf16 v[124:127], a[156:159], v[188:191], v[204:207]
  s_waitcnt vmcnt(20)
  v_exp_f32 v86, v86
  v_mfma_f32_16x16x32_bf16 v[124:127], a[152:155], v[184:187], v[124:127]
  ds_read_b64_tr_b16 a[172:173], v217 offset:40960
  ds_read_b64_tr_b16 a[232:233], v209 offset:5120
  v_mfma_f32_16x16x32_bf16 v[124:127], a[148:151], v[180:183], v[124:127]
  v_exp_f32 v87, v87
  v_mfma_f32_16x16x32_bf16 v[124:127], a[144:147], v[176:179], v[124:127]
  ds_read_b64_tr_b16 a[174:175], v217 offset:45056
  v_cvt_pk_bf16_f32 v83, v86, v87
  v_mfma_f32_16x16x32_bf16 a[192:195], a[208:211], v[0:3], a[192:195]
  v_exp_f32 v92, v92
  v_mfma_f32_16x16x32_bf16 a[192:195], a[208:211], v[32:35], a[192:195]
  ds_read_b64_tr_b16 a[176:177], v218 offset:32768
  ds_read_b64_tr_b16 a[234:235], v209 offset:5632
  v_mfma_f32_16x16x32_bf16 a[196:199], a[208:211], v[8:11], a[196:199]
  v_exp_f32 v93, v93
  v_mfma_f32_16x16x32_bf16 a[196:199], a[208:211], v[40:43], a[196:199]
  ds_read_b64_tr_b16 a[178:179], v218 offset:36864
  v_cvt_pk_bf16_f32 v90, v92, v93
  v_mfma_f32_16x16x32_bf16 a[200:203], a[208:211], v[16:19], a[200:203]
  v_exp_f32 v94, v94
  v_mfma_f32_16x16x32_bf16 a[200:203], a[208:211], v[48:51], a[200:203]
  ds_read_b64_tr_b16 a[180:181], v218 offset:40960
  v_mfma_f32_16x16x32_bf16 a[204:207], a[208:211], v[24:27], a[204:207]
  s_waitcnt lgkmcnt(9)
  v_exp_f32 v95, v95
  v_mfma_f32_16x16x32_bf16 a[204:207], a[208:211], v[56:59], a[204:207]
  ds_read_b64_tr_b16 a[182:183], v218 offset:45056
  v_cvt_pk_bf16_f32 v91, v94, v95
  v_mfma_f32_16x16x32_bf16 a[0:3], a[160:163], v[0:3], a[0:3]
  v_exp_f32 v96, v96
  v_mfma_f32_16x16x32_bf16 a[0:3], a[164:167], v[32:35], a[0:3]
  ds_read_b64_tr_b16 a[184:185], v219 offset:32768
  s_waitcnt lgkmcnt(4)
  buffer_store_dwordx4 a[232:235], v211, s[24:27], s31 offen sc1
  s_add_u32 s31, s31, 1024
  v_mfma_f32_16x16x32_bf16 a[4:7], a[164:167], v[40:43], a[4:7]
  v_exp_f32 v97, v97
  v_mfma_f32_16x16x32_bf16 a[4:7], a[160:163], v[8:11], a[4:7]
  ds_read_b64_tr_b16 a[186:187], v219 offset:36864
  v_cvt_pk_bf16_f32 v96, v96, v97
  v_mfma_f32_16x16x32_bf16 a[8:11], a[160:163], v[16:19], a[8:11]
  v_exp_f32 v98, v98
  v_mfma_f32_16x16x32_bf16 a[8:11], a[164:167], v[48:51], a[8:11]
  ds_read_b64_tr_b16 a[188:189], v219 offset:40960
  v_mfma_f32_16x16x32_bf16 a[12:15], a[164:167], v[56:59], a[12:15]
  v_exp_f32 v99, v99
  v_mfma_f32_16x16x32_bf16 a[12:15], a[160:163], v[24:27], a[12:15]
  ds_read_b64_tr_b16 a[190:191], v219 offset:45056
  v_cvt_pk_bf16_f32 v97, v98, v99
  v_mfma_f32_16x16x32_bf16 a[16:19], a[168:171], v[0:3], a[16:19]
  v_exp_f32 v104, v104
  v_mfma_f32_16x16x32_bf16 a[16:19], a[172:175], v[32:35], a[16:19]
  ds_read_b64_tr_b16 a[160:161], v220 offset:32768
  v_mfma_f32_16x16x32_bf16 a[20:23], a[172:175], v[40:43], a[20:23]
  v_exp_f32 v105, v105
  v_mfma_f32_16x16x32_bf16 a[20:23], a[168:171], v[8:11], a[20:23]
  ds_read_b64_tr_b16 a[162:163], v220 offset:36864
  v_cvt_pk_bf16_f32 v104, v104, v105
  v_mfma_f32_16x16x32_bf16 a[24:27], a[168:171], v[16:19], a[24:27]
  v_exp_f32 v106, v106
  v_mfma_f32_16x16x32_bf16 a[24:27], a[172:175], v[48:51], a[24:27]
  ds_read_b64_tr_b16 a[164:165], v220 offset:40960
  v_mfma_f32_16x16x32_bf16 a[28:31], a[172:175], v[56:59], a[28:31]
  s_waitcnt lgkmcnt(7)
  v_exp_f32 v107, v107
  v_mfma_f32_16x16x32_bf16 a[28:31], a[168:171], v[24:27], a[28:31]
  ds_read_b64_tr_b16 a[166:167], v220 offset:45056
  v_cvt_pk_bf16_f32 v105, v106, v107
  v_mfma_f32_16x16x32_bf16 a[32:35], a[176:179], v[0:3], a[32:35]
  v_exp_f32 v112, v112
  v_mfma_f32_16x16x32_bf16 a[32:35], a[180:183], v[32:35], a[32:35]
  ds_read_b64_tr_b16 a[168:169], v221 offset:32768
  v_mfma_f32_16x16x32_bf16 a[36:39], a[180:183], v[40:43], a[36:39]
  v_exp_f32 v113, v113
  v_mfma_f32_16x16x32_bf16 a[36:39], a[176:179], v[8:11], a[36:39]
  ds_read_b64_tr_b16 a[170:171], v221 offset:36864
  v_cvt_pk_bf16_f32 v112, v112, v113
  v_mfma_f32_16x16x32_bf16 a[40:43], a[176:179], v[16:19], a[40:43]
  v_exp_f32 v114, v114
  v_mfma_f32_16x16x32_bf16 a[40:43], a[180:183], v[48:51], a[40:43]
  ds_read_b64_tr_b16 a[172:173], v221 offset:40960
  v_mfma_f32_16x16x32_bf16 a[44:47], a[180:183], v[56:59], a[44:47]
  s_waitcnt lgkmcnt(7)
  v_exp_f32 v115, v115
  v_mfma_f32_16x16x32_bf16 a[44:47], a[176:179], v[24:27], a[44:47]
  ds_read_b64_tr_b16 a[174:175], v221 offset:45056
  v_cvt_pk_bf16_f32 v113, v114, v115
  v_mfma_f32_16x16x32_bf16 a[48:51], a[184:187], v[0:3], a[48:51]
  v_exp_f32 v120, v120
  v_mfma_f32_16x16x32_bf16 a[48:51], a[188:191], v[32:35], a[48:51]
  ds_read_b64_tr_b16 a[176:177], v222 offset:32768
  v_mfma_f32_16x16x32_bf16 a[52:55], a[188:191], v[40:43], a[52:55]
  v_exp_f32 v121, v121
  v_mfma_f32_16x16x32_bf16 a[52:55], a[184:187], v[8:11], a[52:55]
  ds_read_b64_tr_b16 a[178:179], v222 offset:36864
  v_cvt_pk_bf16_f32 v120, v120, v121
  v_mfma_f32_16x16x32_bf16 a[56:59], a[184:187], v[16:19], a[56:59]
  v_exp_f32 v122, v122
  v_mfma_f32_16x16x32_bf16 a[56:59], a[188:191], v[48:51], a[56:59]
  ds_read_b64_tr_b16 a[180:181], v222 offset:40960
  v_mfma_f32_16x16x32_bf16 a[60:63], a[188:191], v[56:59], a[60:63]
  s_waitcnt lgkmcnt(7)
  v_exp_f32 v123, v123
  v_mfma_f32_16x16x32_bf16 a[60:63], a[184:187], v[24:27], a[60:63]
  ds_read_b64_tr_b16 a[182:183], v222 offset:45056
  v_cvt_pk_bf16_f32 v121, v122, v123
  v_mfma_f32_16x16x32_bf16 a[64:67], a[160:163], v[0:3], a[64:67]
  v_exp_f32 v100, v100
  v_mfma_f32_16x16x32_bf16 a[64:67], a[164:167], v[32:35], a[64:67]
  ds_read_b64_tr_b16 a[184:185], v223 offset:32768
  v_mfma_f32_16x16x32_bf16 a[68:71], a[164:167], v[40:43], a[68:71]
  v_exp_f32 v101, v101
  v_mfma_f32_16x16x32_bf16 a[68:71], a[160:163], v[8:11], a[68:71]
  ds_read_b64_tr_b16 a[186:187], v223 offset:36864
  v_cvt_pk_bf16_f32 v98, v100, v101
  v_mfma_f32_16x16x32_bf16 a[72:75], a[160:163], v[16:19], a[72:75]
  v_exp_f32 v102, v102
  v_mfma_f32_16x16x32_bf16 a[72:75], a[164:167], v[48:51], a[72:75]
  ds_read_b64_tr_b16 a[188:189], v223 offset:40960
  v_mfma_f32_16x16x32_bf16 a[76:79], a[164:167], v[56:59], a[76:79]
  s_waitcnt lgkmcnt(7)
  v_exp_f32 v103, v103
  v_mfma_f32_16x16x32_bf16 a[76:79], a[160:163], v[24:27], a[76:79]
  ds_read_b64_tr_b16 a[190:191], v223 offset:45056
  v_cvt_pk_bf16_f32 v99, v102, v103
  v_mfma_f32_16x16x32_bf16 a[80:83], a[168:171], v[0:3], a[80:83]
  s_waitcnt vmcnt(12)
  v_exp_f32 v108, v108
  v_mfma_f32_16x16x32_bf16 a[80:83], a[172:175], v[32:35], a[80:83]
  v_mfma_f32_16x16x32_bf16 a[84:87], a[172:175], v[40:43], a[84:87]
  s_barrier
  v_exp_f32 v109, v109
  v_mfma_f32_16x16x32_bf16 a[84:87], a[168:171], v[8:11], a[84:87]
  ds_read_b128 a[128:131], v212 offset:0
  v_cvt_pk_bf16_f32 v106, v108, v109
  v_mfma_f32_16x16x32_bf16 a[88:91], a[168:171], v[16:19], a[88:91]
  v_exp_f32 v110, v110
  v_mfma_f32_16x16x32_bf16 a[88:91], a[172:175], v[48:51], a[88:91]
  ds_read_b128 a[132:135], v213 offset:0
  v_mfma_f32_16x16x32_bf16 a[92:95], a[172:175], v[56:59], a[92:95]
  s_waitcnt lgkmcnt(6)
  v_exp_f32 v111, v111
  v_mfma_f32_16x16x32_bf16 a[92:95], a[168:171], v[24:27], a[92:95]
  ds_read_b128 a[136:139], v214 offset:0
  v_cvt_pk_bf16_f32 v107, v110, v111
  v_mfma_f32_16x16x32_bf16 a[96:99], a[176:179], v[0:3], a[96:99]
  v_exp_f32 v116, v116
  v_mfma_f32_16x16x32_bf16 a[96:99], a[180:183], v[32:35], a[96:99]
  ds_read_b128 a[140:143], v215 offset:0
  v_mfma_f32_16x16x32_bf16 a[100:103], a[180:183], v[40:43], a[100:103]
  v_exp_f32 v117, v117
  v_mfma_f32_16x16x32_bf16 a[100:103], a[176:179], v[8:11], a[100:103]
  v_cvt_pk_bf16_f32 v114, v116, v117
  v_mfma_f32_16x16x32_bf16 a[104:107], a[176:179], v[16:19], a[104:107]
  v_exp_f32 v118, v118
  v_mfma_f32_16x16x32_bf16 a[104:107], a[180:183], v[48:51], a[104:107]
  v_mfma_f32_16x16x32_bf16 a[108:111], a[180:183], v[56:59], a[108:111]
  s_waitcnt lgkmcnt(4)
  v_exp_f32 v119, v119
  v_mfma_f32_16x16x32_bf16 a[108:111], a[176:179], v[24:27], a[108:111]
  v_cvt_pk_bf16_f32 v115, v118, v119
  v_mfma_f32_16x16x32_bf16 a[112:115], a[184:187], v[0:3], a[112:115]
  v_exp_f32 v124, v124
  v_mfma_f32_16x16x32_bf16 a[112:115], a[188:191], v[32:35], a[112:115]
  v_mfma_f32_16x16x32_bf16 a[116:119], a[188:191], v[40:43], a[116:119]
  s_sub_u32 s32, s32, 1
  v_exp_f32 v125, v125
  v_mfma_f32_16x16x32_bf16 a[116:119], a[184:187], v[8:11], a[116:119]
  v_cvt_pk_bf16_f32 v122, v124, v125
  v_mfma_f32_16x16x32_bf16 a[120:123], a[184:187], v[16:19], a[120:123]
  s_cmp_lg_u32 s32, 0
  v_exp_f32 v126, v126
  v_mfma_f32_16x16x32_bf16 a[120:123], a[188:191], v[48:51], a[120:123]
  v_mfma_f32_16x16x32_bf16 a[124:127], a[188:191], v[56:59], a[124:127]
  s_waitcnt lgkmcnt(0)
  v_exp_f32 v127, v127
  v_mfma_f32_16x16x32_bf16 a[124:127], a[184:187], v[24:27], a[124:127]
  v_cvt_pk_bf16_f32 v123, v126, v127
  s_cbranch_scc1 attn_loop
  s_waitcnt vmcnt(1)
  v_readfirstlane_b32 s38, v254
  s_nop 0
  s_cmp_ge_u32 s38, 512
  s_cbranch_scc1 attn_h_ready
  s_mov_b32 s39, 32768
attn_spin:
  s_sleep 4
  buffer_load_dword v254, off, s[24:27], s47 sc1
  s_waitcnt vmcnt(0)
  v_readfirstlane_b32 s38, v254
  s_nop 0
  s_cmp_ge_u32 s38, 512
  s_cbranch_scc1 attn_h_ready
  s_sub_u32 s39, s39, 1
  s_cmp_lg_u32 s39, 0
  s_cbranch_scc1 attn_spin
attn_h_ready:
  v_mfma_f32_16x16x32_bf16 v[0:3], a[128:131], v[128:131], v[192:195]
  s_add_u32 m0, s28, 81920
  s_and_b32 s38, s2, 1
  v_lshrrev_b32 v224, 4, v242
  v_and_b32 v225, 7, v224
  v_mfma_f32_16x16x32_bf16 v[0:3], a[132:135], v[132:135], v[0:3]
  ds_read_b128 a[144:147], v212 offset:4096
  s_lshl_b32 s38, s38, 2
  s_add_u32 s38, s38, s3
  v_mul_u32_u24 v225, 0xd80, v225
  v_mfma_f32_16x16x32_bf16 v[0:3], a[136:139], v[136:139], v[0:3]
  buffer_load_dwordx4 v236, s[16:19], s29 offen offset:0 lds
  s_mul_i32 s38, s38, 81920
  s_lshr_b32 s39, s2, 5
  v_mfma_f32_16x16x32_bf16 v[0:3], a[140:143], v[140:143], v[0:3]
  ds_read_b128 a[148:151], v213 offset:4096
  s_mul_i32 s39, s39, 655360
  s_add_u32 s38, s38, s39
  v_lshrrev_b32 v224, 4, v224
  v_mfma_f32_16x16x32_bf16 v[8:11], a[140:143], v[156:159], v[196:199]
  buffer_load_dwordx4 v237, s[16:19], s29 offen offset:1024 lds
  s_add_u32 s4, s38, 3145728
  s_add_u32 s5, s4, 12288
  v_mfma_f32_16x16x32_bf16 v[8:11], a[136:139], v[152:155], v[8:11]
  ds_read_b128 a[152:155], v214 offset:4096
  s_add_u32 s6, s4, 24576
  s_add_u32 s7, s4, 36864
  v_lshl_add_u32 v225, v224, 4, v225
  v_mfma_f32_16x16x32_bf16 v[8:11], a[132:135], v[148:151], v[8:11]
  buffer_load_dwordx4 v236, s[16:19], s29 offen offset:2048 lds
  s_add_u32 s8, s4, 49152
  s_add_u32 s9, s4, 61440
  v_mfma_f32_16x16x32_bf16 v[8:11], a[128:131], v[144:147], v[8:11]
  ds_read_b128 a[156:159], v215 offset:4096
  buffer_load_dwordx4 a[212:215], v225, s[24:27], s101 offen offset:0 sc1
  s_add_u32 s10, s4, 73728
  v_mfma_f32_16x16x32_bf16 v[16:19], a[128:131], v[160:163], v[200:203]
  v_exp_f32 v0, v0
  v_mfma_f32_16x16x32_bf16 v[16:19], a[132:135], v[164:167], v[16:19]
  buffer_load_dwordx4 v237, s[16:19], s29 offen offset:3072 lds
  v_mfma_f32_16x16x32_bf16 v[16:19], a[136:139], v[168:171], v[16:19]
  s_add_u32 s29, s29, 16384
  v_exp_f32 v1, v1
  v_mfma_f32_16x16x32_bf16 v[16:19], a[140:143], v[172:175], v[16:19]
  buffer_load_dwordx4 a[216:219], v225, s[24:27], s101 offen offset:64 sc1
  v_cvt_pk_bf16_f32 v0, v0, v1
  v_mfma_f32_16x16x32_bf16 v[24:27], a[140:143], v[188:191], v[204:207]
  s_add_u32 m0, s28, 32768
  v_exp_f32 v2, v2
  v_mfma_f32_16x16x32_bf16 v[24:27], a[136:139], v[184:187], v[24:27]
  buffer_load_dwordx4 v232, s[12:15], s29 offen offset:0 lds
  v_mfma_f32_16x16x32_bf16 v[24:27], a[132:135], v[180:183], v[24:27]
  s_waitcnt lgkmcnt(0)
  v_exp_f32 v3, v3
  v_mfma_f32_16x16x32_bf16 v[24:27], a[128:131], v[176:179], v[24:27]
  buffer_load_dwordx4 a[220:223], v225, s[24:27], s101 offen offset:128 sc1
  v_cvt_pk_bf16_f32 v1, v2, v3
  v_mfma_f32_16x16x32_bf16 v[4:7], a[144:147], v[128:131], v[192:195]
  v_exp_f32 v8, v8
  v_mfma_f32_16x16x32_bf16 v[4:7], a[148:151], v[132:135], v[4:7]
  ds_read_b128 a[128:131], v212 offset:8192
  v_add_u32 v252, 4096, v242
  v_mfma_f32_16x16x32_bf16 v[4:7], a[152:155], v[136:139], v[4:7]
  v_exp_f32 v9, v9
  v_mfma_f32_16x16x32_bf16 v[4:7], a[156:159], v[140:143], v[4:7]
  ds_read_b128 a[132:135], v213 offset:8192
  v_cvt_pk_bf16_f32 v8, v8, v9
  v_mfma_f32_16x16x32_bf16 v[12:15], a[156:159], v[156:159], v[196:199]
  v_exp_f32 v10, v10
  v_mfma_f32_16x16x32_bf16 v[12:15], a[152:155], v[152:155], v[12:15]
  ds_read_b128 a[136:139], v214 offset:8192
  v_add_u32 v253, 8192, v242
  v_mfma_f32_16x16x32_bf16 v[12:15], a[148:151], v[148:151], v[12:15]
  v_exp_f32 v11, v11
  v_mfma_f32_16x16x32_bf16 v[12:15], a[144:147], v[144:147], v[12:15]
  ds_read_b128 a[140:143], v215 offset:8192
  v_cvt_pk_bf16_f32 v9, v10, v11
  v_mfma_f32_16x16x32_bf16 v[20:23], a[144:147], v[160:163], v[200:203]
  v_exp_f32 v16, v16
  v_mfma_f32_16x16x32_bf16 v[20:23], a[148:151], v[164:167], v[20:23]
  buffer_load_dwordx4 v233, s[12:15], s29 offen offset:1024 lds
  v_mfma_f32_16x16x32_bf16 v[20:23], a[152:155], v[168:171], v[20:23]
  v_exp_f32 v17, v17
  v_mfma_f32_16x16x32_bf16 v[20:23], a[156:159], v[172:175], v[20:23]
  v_cvt_pk_bf16_f32 v16, v16, v17
  v_mfma_f32_16x16x32_bf16 v[28:31], a[156:159], v[188:191], v[204:207]
  v_exp_f32 v18, v18
  v_mfma_f32_16x16x32_bf16 v[28:31], a[152:155], v[184:187], v[28:31]
  buffer_load_dwordx4 v234, s[12:15], s29 offen offset:2048 lds
  v_mfma_f32_16x16x32_bf16 v[28:31], a[148:151], v[180:183], v[28:31]
  s_waitcnt lgkmcnt(0)
  v_exp_f32 v19, v19
  v_mfma_f32_16x16x32_bf16 v[28:31], a[144:147], v[176:179], v[28:31]
  v_cvt_pk_bf16_f32 v17, v18, v19
  v_mfma_f32_16x16x32_bf16 v[32:35], a[128:131], v[128:131], v[192:195]
  v_exp_f32 v24, v24
  v_mfma_f32_16x16x32_bf16 v[32:35], a[132:135], v[132:135], v[32:35]
  ds_read_b128 a[144:147], v212 offset:12288
  v_mfma_f32_16x16x32_bf16 v[32:35], a[136:139], v[136:139], v[32:35]
  v_exp_f32 v25, v25
  v_mfma_f32_16x16x32_bf16 v[32:35], a[140:143], v[140:143], v[32:35]
  ds_read_b128 a[148:151], v213 offset:12288
  v_cvt_pk_bf16_f32 v24, v24, v25
  v_mfma_f32_16x16x32_bf16 v[40:43], a[140:143], v[156:159], v[196:199]
  v_exp_f32 v26, v26
  v_mfma_f32_16x16x32_bf16 v[40:43], a[136:139], v[152:155], v[40:43]
  ds_read_b128 a[152:155], v214 offset:12288
  v_mfma_f32_16x16x32_bf16 v[40:43], a[132:135], v[148:151], v[40:43]
  v_exp_f32 v27, v27
  v_mfma_f32_16x16x32_bf16 v[40:43], a[128:131], v[144:147], v[40:43]
  ds_read_b128 a[156:159], v215 offset:12288
  v_cvt_pk_bf16_f32 v25, v26, v27
  v_mfma_f32_16x16x32_bf16 v[48:51], a[128:131], v[160:163], v[200:203]
  v_exp_f32 v4, v4
  v_mfma_f32_16x16x32_bf16 v[48:51], a[132:135], v[164:167], v[48:51]
  buffer_load_dwordx4 v235, s[12:15], s29 offen offset:3072 lds
  v_mfma_f32_16x16x32_bf16 v[48:51], a[136:139], v[168:171], v[48:51]
  v_exp_f32 v5, v5
  v_mfma_f32_16x16x32_bf16 v[48:51], a[140:143], v[172:175], v[48:51]
  v_cvt_pk_bf16_f32 v2, v4, v5
  v_mfma_f32_16x16x32_bf16 v[56:59], a[140:143], v[188:191], v[204:207]
  v_exp_f32 v6, v6
  v_mfma_f32_16x16x32_bf16 v[56:59], a[136:139], v[184:187], v[56:59]
  v_mfma_f32_16x16x32_bf16 v[56:59], a[132:135], v[180:183], v[56:59]
  s_waitcnt lgkmcnt(0)
  v_exp_f32 v7, v7
  v_mfma_f32_16x16x32_bf16 v[56:59], a[128:131], v[176:179], v[56:59]
  v_cvt_pk_bf16_f32 v3, v6, v7
  v_mfma_f32_16x16x32_bf16 v[36:39], a[144:147], v[128:131], v[192:195]
  v_exp_f32 v12, v12
  v_mfma_f32_16x16x32_bf16 v[36:39], a[148:151], v[132:135], v[36:39]
  ds_read_b64_tr_b16 a[160:161], v216 offset:49152
  v_mfma_f32_16x16x32_bf16 v[36:39], a[152:155], v[136:139], v[36:39]
  v_exp_f32 v13, v13
  v_mfma_f32_16x16x32_bf16 v[36:39], a[156:159], v[140:143], v[36:39]
  ds_read_b64_tr_b16 a[162:163], v216 offset:53248
  v_cvt_pk_bf16_f32 v10, v12, v13
  v_mfma_f32_16x16x32_bf16 v[44:47], a[156:159], v[156:159], v[196:199]
  v_exp_f32 v14, v14
  v_mfma_f32_16x16x32_bf16 v[44:47], a[152:155], v[152:155], v[44:47]
  ds_read_b64_tr_b16 a[164:165], v216 offset:57344
  v_mfma_f32_16x16x32_bf16 v[44:47], a[148:151], v[148:151], v[44:47]
  v_exp_f32 v15, v15
  v_mfma_f32_16x16x32_bf16 v[44:47], a[144:147], v[144:147], v[44:47]
  ds_read_b64_tr_b16 a[166:167], v216 offset:61440
  v_cvt_pk_bf16_f32 v11, v14, v15
  v_mfma_f32_16x16x32_bf16 v[52:55], a[144:147], v[160:163], v[200:203]
  v_exp_f32 v20, v20
  v_mfma_f32_16x16x32_bf16 v[52:55], a[148:151], v[164:167], v[52:55]
  ds_read_b64_tr_b16 a[168:169], v217 offset:49152
  v_mfma_f32_16x16x32_bf16 v[52:55], a[152:155], v[168:171], v[52:55]
  v_exp_f32 v21, v21
  v_mfma_f32_16x16x32_bf16 v[52:55], a[156:159], v[172:175], v[52:55]
  ds_read_b64_tr_b16 a[170:171], v217 offset:53248
  v_cvt_pk_bf16_f32 v18, v20, v21
  v_mfma_f32_16x16x32_bf16 v[60:63], a[156:159], v[188:191], v[204:207]
  v_exp_f32 v22, v22
  v_mfma_f32_16x16x32_bf16 v[60:63], a[152:155], v[184:187], v[60:63]
  ds_read_b64_tr_b16 a[172:173], v217 offset:57344
  v_mfma_f32_16x16x32_bf16 v[60:63], a[148:151], v[180:183], v[60:63]
  v_exp_f32 v23, v23
  v_mfma_f32_16x16x32_bf16 v[60:63], a[144:147], v[176:179], v[60:63]
  ds_read_b64_tr_b16 a[174:175], v217 offset:61440
  v_cvt_pk_bf16_f32 v19, v22, v23
  v_mfma_f32_16x16x32_bf16 a[192:195], a[208:211], v[64:67], a[192:195]
  v_exp_f32 v28, v28
  v_mfma_f32_16x16x32_bf16 a[192:195], a[208:211], v[96:99], a[192:195]
  ds_read_b64_tr_b16 a[176:177], v218 offset:49152
  v_mfma_f32_16x16x32_bf16 a[196:199], a[208:211], v[72:75], a[196:199]
  v_exp_f32 v29, v29
  v_mfma_f32_16x16x32_bf16 a[196:199], a[208:211], v[104:107], a[196:199]
  ds_read_b64_tr_b16 a[178:179], v218 offset:53248
  v_cvt_pk_bf16_f32 v26, v28, v29
  v_mfma_f32_16x16x32_bf16 a[200:203], a[208:211], v[80:83], a[200:203]
  v_exp_f32 v30, v30
  v_mfma_f32_16x16x32_bf16 a[200:203], a[208:211], v[112:115], a[200:203]
  ds_read_b64_tr_b16 a[180:181], v218 offset:57344
  v_mfma_f32_16x16x32_bf16 a[204:207], a[208:211], v[88:91], a[204:207]
  s_waitcnt lgkmcnt(7)
  v_exp_f32 v31, v31
  v_mfma_f32_16x16x32_bf16 a[204:207], a[208:211], v[120:123], a[204:207]
  ds_read_b64_tr_b16 a[182:183], v218 offset:61440
  v_cvt_pk_bf16_f32 v27, v30, v31
  v_mfma_f32_16x16x32_bf16 a[0:3], a[160:163], v[64:67], a[0:3]
  v_exp_f32 v32, v32
  v_mfma_f32_16x16x32_bf16 a[0:3], a[164:167], v[96:99], a[0:3]
  ds_read_b64_tr_b16 a[184:185], v219 offset:49152
  v_mfma_f32_16x16x32_bf16 a[4:7], a[164:167], v[104:107], a[4:7]
  v_exp_f32 v33, v33
  v_mfma_f32_16x16x32_bf16 a[4:7], a[160:163], v[72:75], a[4:7]
  ds_read_b64_tr_b16 a[186:187], v219 offset:53248
  v_cvt_pk_bf16_f32 v32, v32, v33
  v_mfma_f32_16x16x32_bf16 a[8:11], a[160:163], v[80:83], a[8:11]
  v_exp_f32 v34, v34
  v_mfma_f32_16x16x32_bf16 a[8:11], a[164:167], v[112:115], a[8:11]
  ds_read_b64_tr_b16 a[188:189], v219 offset:57344
  v_mfma_f32_16x16x32_bf16 a[12:15], a[164:167], v[120:123], a[12:15]
  s_waitcnt lgkmcnt(7)
  v_exp_f32 v35, v35
  v_mfma_f32_16x16x32_bf16 a[12:15], a[160:163], v[88:91], a[12:15]
  ds_read_b64_tr_b16 a[190:191], v219 offset:61440
  v_cvt_pk_bf16_f32 v33, v34, v35
  v_mfma_f32_16x16x32_bf16 a[16:19], a[168:171], v[64:67], a[16:19]
  v_exp_f32 v40, v40
  v_mfma_f32_16x16x32_bf16 a[16:19], a[172:175], v[96:99], a[16:19]
  ds_read_b64_tr_b16 a[160:161], v220 offset:49152
  v_mfma_f32_16x16x32_bf16 a[20:23], a[172:175], v[104:107], a[20:23]
  v_exp_f32 v41, v41
  v_mfma_f32_16x16x32_bf16 a[20:23], a[168:171], v[72:75], a[20:23]
  ds_read_b64_tr_b16 a[162:163], v220 offset:53248
  v_cvt_pk_bf16_f32 v40, v40, v41
  v_mfma_f32_16x16x32_bf16 a[24:27], a[168:171], v[80:83], a[24:27]
  v_exp_f32 v42, v42
  v_mfma_f32_16x16x32_bf16 a[24:27], a[172:175], v[112:115], a[24:27]
  ds_read_b64_tr_b16 a[164:165], v220 offset:57344
  v_mfma_f32_16x16x32_bf16 a[28:31], a[172:175], v[120:123], a[28:31]
  s_waitcnt lgkmcnt(7)
  v_exp_f32 v43, v43
  v_mfma_f32_16x16x32_bf16 a[28:31], a[168:171], v[88:91], a[28:31]
  ds_read_b64_tr_b16 a[166:167], v220 offset:61440
  v_cvt_pk_bf16_f32 v41, v42, v43
  v_mfma_f32_16x16x32_bf16 a[32:35], a[176:179], v[64:67], a[32:35]
  v_exp_f32 v48, v48
  v_mfma_f32_16x16x32_bf16 a[32:35], a[180:183], v[96:99], a[32:35]
  ds_read_b64_tr_b16 a[168:169], v221 offset:49152
  v_mfma_f32_16x16x32_bf16 a[36:39], a[180:183], v[104:107], a[36:39]
  v_exp_f32 v49, v49
  v_mfma_f32_16x16x32_bf16 a[36:39], a[176:179], v[72:75], a[36:39]
  ds_read_b64_tr_b16 a[170:171], v221 offset:53248
  v_cvt_pk_bf16_f32 v48, v48, v49
  v_mfma_f32_16x16x32_bf16 a[40:43], a[176:179], v[80:83], a[40:43]
  v_exp_f32 v50, v50
  v_mfma_f32_16x16x32_bf16 a[40:43], a[180:183], v[112:115], a[40:43]
  ds_read_b64_tr_b16 a[172:173], v221 offset:57344
  v_mfma_f32_16x16x32_bf16 a[44:47], a[180:183], v[120:123], a[44:47]
  s_waitcnt lgkmcnt(7)
  v_exp_f32 v51, v51
  v_mfma_f32_16x16x32_bf16 a[44:47], a[176:179], v[88:91], a[44:47]
  ds_read_b64_tr_b16 a[174:175], v221 offset:61440
  v_cvt_pk_bf16_f32 v49, v50, v51
  v_mfma_f32_16x16x32_bf16 a[48:51], a[184:187], v[64:67], a[48:51]
  v_exp_f32 v56, v56
  v_mfma_f32_16x16x32_bf16 a[48:51], a[188:191], v[96:99], a[48:51]
  ds_read_b64_tr_b16 a[176:177], v222 offset:49152
  v_mfma_f32_16x16x32_bf16 a[52:55], a[188:191], v[104:107], a[52:55]
  v_exp_f32 v57, v57
  v_mfma_f32_16x16x32_bf16 a[52:55], a[184:187], v[72:75], a[52:55]
  ds_read_b64_tr_b16 a[178:179], v222 offset:53248
  v_cvt_pk_bf16_f32 v56, v56, v57
  v_mfma_f32_16x16x32_bf16 a[56:59], a[184:187], v[80:83], a[56:59]
  v_exp_f32 v58, v58
  v_mfma_f32_16x16x32_bf16 a[56:59], a[188:191], v[112:115], a[56:59]
  ds_read_b64_tr_b16 a[180:181], v222 offset:57344
  v_mfma_f32_16x16x32_bf16 a[60:63], a[188:191], v[120:123], a[60:63]
  s_waitcnt lgkmcnt(7)
  v_exp_f32 v59, v59
  v_mfma_f32_16x16x32_bf16 a[60:63], a[184:187], v[88:91], a[60:63]
  ds_read_b64_tr_b16 a[182:183], v222 offset:61440
  v_cvt_pk_bf16_f32 v57, v58, v59
  v_mfma_f32_16x16x32_bf16 a[64:67], a[160:163], v[64:67], a[64:67]
  v_exp_f32 v36, v36
  v_mfma_f32_16x16x32_bf16 a[64:67], a[164:167], v[96:99], a[64:67]
  ds_read_b64_tr_b16 a[184:185], v223 offset:49152
  v_mfma_f32_16x16x32_bf16 a[68:71], a[164:167], v[104:107], a[68:71]
  v_exp_f32 v37, v37
  v_mfma_f32_16x16x32_bf16 a[68:71], a[160:163], v[72:75], a[68:71]
  ds_read_b64_tr_b16 a[186:187], v223 offset:53248
  v_cvt_pk_bf16_f32 v34, v36, v37
  v_mfma_f32_16x16x32_bf16 a[72:75], a[160:163], v[80:83], a[72:75]
  v_exp_f32 v38, v38
  v_mfma_f32_16x16x32_bf16 a[72:75], a[164:167], v[112:115], a[72:75]
  ds_read_b64_tr_b16 a[188:189], v223 offset:57344
  v_mfma_f32_16x16x32_bf16 a[76:79], a[164:167], v[120:123], a[76:79]
  s_waitcnt lgkmcnt(7)
  v_exp_f32 v39, v39
  v_mfma_f32_16x16x32_bf16 a[76:79], a[160:163], v[88:91], a[76:79]
  ds_read_b64_tr_b16 a[190:191], v223 offset:61440
  v_cvt_pk_bf16_f32 v35, v38, v39
  v_mfma_f32_16x16x32_bf16 a[80:83], a[168:171], v[64:67], a[80:83]
  v_exp_f32 v44, v44
  v_mfma_f32_16x16x32_bf16 a[80:83], a[172:175], v[96:99], a[80:83]
  v_mfma_f32_16x16x32_bf16 a[84:87], a[172:175], v[104:107], a[84:87]
  s_barrier
  v_exp_f32 v45, v45
  v_mfma_f32_16x16x32_bf16 a[84:87], a[168:171], v[72:75], a[84:87]
  ds_read_b128 a[128:131], v212 offset:16384
  v_cvt_pk_bf16_f32 v42, v44, v45
  v_mfma_f32_16x16x32_bf16 a[88:91], a[168:171], v[80:83], a[88:91]
  v_exp_f32 v46, v46
  v_mfma_f32_16x16x32_bf16 a[88:91], a[172:175], v[112:115], a[88:91]
  ds_read_b128 a[132:135], v213 offset:16384
  v_mfma_f32_16x16x32_bf16 a[92:95], a[172:175], v[120:123], a[92:95]
  s_waitcnt lgkmcnt(6)
  v_exp_f32 v47, v47
  v_mfma_f32_16x16x32_bf16 a[92:95], a[168:171], v[88:91], a[92:95]
  ds_read_b128 a[136:139], v214 offset:16384
  v_cvt_pk_bf16_f32 v43, v46, v47
  v_mfma_f32_16x16x32_bf16 a[96:99], a[176:179], v[64:67], a[96:99]
  v_exp_f32 v52, v52
  v_mfma_f32_16x16x32_bf16 a[96:99], a[180:183], v[96:99], a[96:99]
  ds_read_b128 a[140:143], v215 offset:16384
  v_mfma_f32_16x16x32_bf16 a[100:103], a[180:183], v[104:107], a[100:103]
  v_exp_f32 v53, v53
  v_mfma_f32_16x16x32_bf16 a[100:103], a[176:179], v[72:75], a[100:103]
  v_cvt_pk_bf16_f32 v50, v52, v53
  v_mfma_f32_16x16x32_bf16 a[104:107], a[176:179], v[80:83], a[104:107]
  v_exp_f32 v54, v54
  v_mfma_f32_16x16x32_bf16 a[104:107], a[180:183], v[112:115], a[104:107]
  v_mfma_f32_16x16x32_bf16 a[108:111], a[180:183], v[120:123], a[108:111]
  s_waitcnt lgkmcnt(4)
  v_exp_f32 v55, v55
  v_mfma_f32_16x16x32_bf16 a[108:111], a[176:179], v[88:91], a[108:111]
  v_cvt_pk_bf16_f32 v51, v54, v55
  v_mfma_f32_16x16x32_bf16 a[112:115], a[184:187], v[64:67], a[112:115]
  v_exp_f32 v60, v60
  v_mfma_f32_16x16x32_bf16 a[112:115], a[188:191], v[96:99], a[112:115]
  v_mfma_f32_16x16x32_bf16 a[116:119], a[188:191], v[104:107], a[116:119]
  v_exp_f32 v61, v61
  v_mfma_f32_16x16x32_bf16 a[116:119], a[184:187], v[72:75], a[116:119]
  v_cvt_pk_bf16_f32 v58, v60, v61
  v_mfma_f32_16x16x32_bf16 a[120:123], a[184:187], v[80:83], a[120:123]
  v_exp_f32 v62, v62
  v_mfma_f32_16x16x32_bf16 a[120:123], a[188:191], v[112:115], a[120:123]
  v_mfma_f32_16x16x32_bf16 a[124:127], a[188:191], v[120:123], a[124:127]
  s_waitcnt lgkmcnt(0)
  v_exp_f32 v63, v63
  v_mfma_f32_16x16x32_bf16 a[124:127], a[184:187], v[88:91], a[124:127]
  v_cvt_pk_bf16_f32 v59, v62, v63
  v_mfma_f32_16x16x32_bf16 v[64:67], a[128:131], v[128:131], v[192:195]
  s_add_u32 m0, s28, 98304
  v_mfma_f32_16x16x32_bf16 v[64:67], a[132:135], v[132:135], v[64:67]
  ds_read_b128 a[144:147], v212 offset:20480
  v_mfma_f32_16x16x32_bf16 v[64:67], a[136:139], v[136:139], v[64:67]
  buffer_load_dwordx4 v236, s[16:19], s29 offen offset:0 lds
  v_mfma_f32_16x16x32_bf16 v[64:67], a[140:143], v[140:143], v[64:67]
  ds_read_b128 a[148:151], v213 offset:20480
  v_mfma_f32_16x16x32_bf16 v[72:75], a[140:143], v[156:159], v[196:199]
  buffer_load_dwordx4 v237, s[16:19], s29 offen offset:1024 lds
  v_mfma_f32_16x16x32_bf16 v[72:75], a[136:139], v[152:155], v[72:75]
  ds_read_b128 a[152:155], v214 offset:20480
  v_mfma_f32_16x16x32_bf16 v[72:75], a[132:135], v[148:151], v[72:75]
  buffer_load_dwordx4 v236, s[16:19], s29 offen offset:2048 lds
  v_mfma_f32_16x16x32_bf16 v[72:75], a[128:131], v[144:147], v[72:75]
  ds_read_b128 a[156:159], v215 offset:20480
  v_mfma_f32_16x16x32_bf16 v[80:83], a[128:131], v[160:163], v[200:203]
  v_exp_f32 v64, v64
  v_mfma_f32_16x16x32_bf16 v[80:83], a[132:135], v[164:167], v[80:83]
  buffer_load_dwordx4 v237, s[16:19], s29 offen offset:3072 lds
  v_mfma_f32_16x16x32_bf16 v[80:83], a[136:139], v[168:171], v[80:83]
  s_add_u32 s29, s29, 16384
  v_exp_f32 v65, v65
  v_mfma_f32_16x16x32_bf16 v[80:83], a[140:143], v[172:175], v[80:83]
  v_cvt_pk_bf16_f32 v64, v64, v65
  v_mfma_f32_16x16x32_bf16 v[88:91], a[140:143], v[188:191], v[204:207]
  s_add_u32 m0, s28, 49152
  v_exp_f32 v66, v66
  v_mfma_f32_16x16x32_bf16 v[88:91], a[136:139], v[184:187], v[88:91]
  buffer_load_dwordx4 v232, s[12:15], s29 offen offset:0 lds
  v_mfma_f32_16x16x32_bf16 v[88:91], a[132:135], v[180:183], v[88:91]
  s_waitcnt lgkmcnt(0)
  v_exp_f32 v67, v67
  v_mfma_f32_16x16x32_bf16 v[88:91], a[128:131], v[176:179], v[88:91]
  v_cvt_pk_bf16_f32 v65, v66, v67
  v_mfma_f32_16x16x32_bf16 v[68:71], a[144:147], v[128:131], v[192:195]
  v_exp_f32 v72, v72
  v_mfma_f32_16x16x32_bf16 v[68:71], a[148:151], v[132:135], v[68:71]
  ds_read_b128 a[128:131], v212 offset:24576
  v_mfma_f32_16x16x32_bf16 v[68:71], a[152:155], v[136:139], v[68:71]
  v_exp_f32 v73, v73
  v_mfma_f32_16x16x32_bf16 v[68:71], a[156:159], v[140:143], v[68:71]
  ds_read_b128 a[132:135], v213 offset:24576
  v_cvt_pk_bf16_f32 v72, v72, v73
  v_mfma_f32_16x16x32_bf16 v[76:79], a[156:159], v[156:159], v[196:199]
  v_exp_f32 v74, v74
  v_mfma_f32_16x16x32_bf16 v[76:79], a[152:155], v[152:155], v[76:79]
  ds_read_b128 a[136:139], v214 offset:24576
  v_lshrrev_b32 v224, 4, v242
  v_mfma_f32_16x16x32_bf16 v[76:79], a[148:151], v[148:151], v[76:79]
  v_exp_f32 v75, v75
  v_mfma_f32_16x16x32_bf16 v[76:79], a[144:147], v[144:147], v[76:79]
  ds_read_b128 a[140:143], v215 offset:24576
  v_cvt_pk_bf16_f32 v73, v74, v75
  v_mfma_f32_16x16x32_bf16 v[84:87], a[144:147], v[160:163], v[200:203]
  v_exp_f32 v80, v80
  v_mfma_f32_16x16x32_bf16 v[84:87], a[148:151], v[164:167], v[84:87]
  buffer_load_dwordx4 v233, s[12:15], s29 offen offset:1024 lds
  v_mfma_f32_16x16x32_bf16 v[84:87], a[152:155], v[168:171], v[84:87]
  v_exp_f32 v81, v81
  v_mfma_f32_16x16x32_bf16 v[84:87], a[156:159], v[172:175], v[84:87]
  v_cvt_pk_bf16_f32 v80, v80, v81
  v_lshrrev_b32 v225, 4, v224
  v_mfma_f32_16x16x32_bf16 v[92:95], a[156:159], v[188:191], v[204:207]
  v_exp_f32 v82, v82
  v_mfma_f32_16x16x32_bf16 v[92:95], a[152:155], v[184:187], v[92:95]
  buffer_load_dwordx4 v234, s[12:15], s29 offen offset:2048 lds
  v_mfma_f32_16x16x32_bf16 v[92:95], a[148:151], v[180:183], v[92:95]
  s_waitcnt lgkmcnt(0)
  v_exp_f32 v83, v83
  v_mfma_f32_16x16x32_bf16 v[92:95], a[144:147], v[176:179], v[92:95]
  v_cvt_pk_bf16_f32 v81, v82, v83
  v_bfe_u32 v226, v224, 2, 2
  v_mfma_f32_16x16x32_bf16 v[96:99], a[128:131], v[128:131], v[192:195]
  v_exp_f32 v88, v88
  v_mfma_f32_16x16x32_bf16 v[96:99], a[132:135], v[132:135], v[96:99]
  ds_read_b128 a[144:147], v212 offset:28672
  v_lshl_add_u32 v225, v225, 3, v226
  v_mfma_f32_16x16x32_bf16 v[96:99], a[136:139], v[136:139], v[96:99]
  v_exp_f32 v89, v89
  v_mfma_f32_16x16x32_bf16 v[96:99], a[140:143], v[140:143], v[96:99]
  ds_read_b128 a[148:151], v213 offset:28672
  v_cvt_pk_bf16_f32 v88, v88, v89
  v_mfma_f32_16x16x32_bf16 v[104:107], a[140:143], v[156:159], v[196:199]
  v_exp_f32 v90, v90
  v_mfma_f32_16x16x32_bf16 v[104:107], a[136:139], v[152:155], v[104:107]
  ds_read_b128 a[152:155], v214 offset:28672
  v_lshlrev_b32 v225, 5, v225
  v_mfma_f32_16x16x32_bf16 v[104:107], a[132:135], v[148:151], v[104:107]
  v_exp_f32 v91, v91
  v_mfma_f32_16x16x32_bf16 v[104:107], a[128:131], v[144:147], v[104:107]
  ds_read_b128 a[156:159], v215 offset:28672
  v_cvt_pk_bf16_f32 v89, v90, v91
  v_mfma_f32_16x16x32_bf16 v[112:115], a[128:131], v[160:163], v[200:203]
  v_exp_f32 v68, v68
  v_mfma_f32_16x16x32_bf16 v[112:115], a[132:135], v[164:167], v[112:115]
  buffer_load_dwordx4 v235, s[12:15], s29 offen offset:3072 lds
  v_mfma_f32_16x16x32_bf16 v[112:115], a[136:139], v[168:171], v[112:115]
  v_exp_f32 v69, v69
  v_mfma_f32_16x16x32_bf16 v[112:115], a[140:143], v[172:175], v[112:115]
  v_cvt_pk_bf16_f32 v66, v68, v69
  v_and_b32 v226, 3, v224
  v_mfma_f32_16x16x32_bf16 v[120:123], a[140:143], v[188:191], v[204:207]
  v_exp_f32 v70, v70
  v_mfma_f32_16x16x32_bf16 v[120:123], a[136:139], v[184:187], v[120:123]
  s_add_u32 m0, s28, 0
  v_lshl_add_u32 v225, v226, 3, v225
  v_add_u32 v225, s50, v225
  v_mfma_f32_16x16x32_bf16 v[120:123], a[132:135], v[180:183], v[120:123]
  s_waitcnt lgkmcnt(0)
  s_waitcnt vmcnt(11)
  v_exp_f32 v71, v71
  v_mfma_f32_16x16x32_bf16 v[120:123], a[128:131], v[176:179], v[120:123]
  ds_read_b64_tr_b16 a[232:233], v225 offset:0
  v_cvt_pk_bf16_f32 v67, v70, v71
  v_mfma_f32_16x16x32_bf16 v[100:103], a[144:147], v[128:131], v[192:195]
  v_exp_f32 v76, v76
  v_mfma_f32_16x16x32_bf16 v[100:103], a[148:151], v[132:135], v[100:103]
  ds_read_b64_tr_b16 a[160:161], v216 offset:0
  ds_read_b64_tr_b16 a[234:235], v225 offset:128
  v_mfma_f32_16x16x32_bf16 v[100:103], a[152:155], v[136:139], v[100:103]
  v_exp_f32 v77, v77
  v_mfma_f32_16x16x32_bf16 v[100:103], a[156:159], v[140:143], v[100:103]
  ds_read_b64_tr_b16 a[162:163], v216 offset:4096
  v_cvt_pk_bf16_f32 v74, v76, v77
  v_mfma_f32_16x16x32_bf16 v[108:111], a[156:159], v[156:159], v[196:199]
  v_exp_f32 v78, v78
  v_mfma_f32_16x16x32_bf16 v[108:111], a[152:155], v[152:155], v[108:111]
  ds_read_b64_tr_b16 a[164:165], v216 offset:8192
  ds_read_b64_tr_b16 a[236:237], v225 offset:1024
  v_mfma_f32_16x16x32_bf16 v[108:111], a[148:151], v[148:151], v[108:111]
  v_exp_f32 v79, v79
  v_mfma_f32_16x16x32_bf16 v[108:111], a[144:147], v[144:147], v[108:111]
  ds_read_b64_tr_b16 a[166:167], v216 offset:12288
  v_cvt_pk_bf16_f32 v75, v78, v79
  v_mfma_f32_16x16x32_bf16 v[116:119], a[144:147], v[160:163], v[200:203]
  v_exp_f32 v84, v84
  v_mfma_f32_16x16x32_bf16 v[116:119], a[148:151], v[164:167], v[116:119]
  ds_read_b64_tr_b16 a[168:169], v217 offset:0
  ds_read_b64_tr_b16 a[238:239], v225 offset:1152
  v_mfma_f32_16x16x32_bf16 v[116:119], a[152:155], v[168:171], v[116:119]
  v_exp_f32 v85, v85
  v_mfma_f32_16x16x32_bf16 v[116:119], a[156:159], v[172:175], v[116:119]
  ds_read_b64_tr_b16 a[170:171], v217 offset:4096
  v_cvt_pk_bf16_f32 v82, v84, v85
  v_mfma_f32_16x16x32_bf16 v[124:127], a[156:159], v[188:191], v[204:207]
  v_exp_f32 v86, v86
  v_mfma_f32_16x16x32_bf16 v[124:127], a[152:155], v[184:187], v[124:127]
  ds_read_b64_tr_b16 a[172:173], v217 offset:8192
  ds_read_b64_tr_b16 a[240:241], v225 offset:2048
  v_mfma_f32_16x16x32_bf16 v[124:127], a[148:151], v[180:183], v[124:127]
  v_exp_f32 v87, v87
  v_mfma_f32_16x16x32_bf16 v[124:127], a[144:147], v[176:179], v[124:127]
  ds_read_b64_tr_b16 a[174:175], v217 offset:12288
  v_cvt_pk_bf16_f32 v83, v86, v87
  v_mfma_f32_16x16x32_bf16 a[192:195], a[208:211], v[0:3], a[192:195]
  v_exp_f32 v92, v92
  v_mfma_f32_16x16x32_bf16 a[192:195], a[208:211], v[32:35], a[192:195]
  ds_read_b64_tr_b16 a[176:177], v218 offset:0
  ds_read_b64_tr_b16 a[242:243], v225 offset:2176
  v_mfma_f32_16x16x32_bf16 a[196:199], a[208:211], v[8:11], a[196:199]
  v_exp_f32 v93, v93
  v_mfma_f32_16x16x32_bf16 a[196:199], a[208:211], v[40:43], a[196:199]
  ds_read_b64_tr_b16 a[178:179], v218 offset:4096
  v_cvt_pk_bf16_f32 v90, v92, v93
  v_mfma_f32_16x16x32_bf16 a[200:203], a[208:211], v[16:19], a[200:203]
  v_exp_f32 v94, v94
  v_mfma_f32_16x16x32_bf16 a[200:203], a[208:211], v[48:51], a[200:203]
  ds_read_b64_tr_b16 a[180:181], v218 offset:8192
  buffer_load_dwordx4 v253, s[24:27], s8 offen offset:0 sc1 lds
  v_mfma_f32_16x16x32_bf16 a[204:207], a[208:211], v[24:27], a[204:207]
  s_waitcnt lgkmcnt(10)
  v_exp_f32 v95, v95
  v_mfma_f32_16x16x32_bf16 a[204:207], a[208:211], v[56:59], a[204:207]
  ds_read_b64_tr_b16 a[182:183], v218 offset:12288
  v_cvt_pk_bf16_f32 v91, v94, v95
  v_mfma_f32_16x16x32_bf16 a[0:3], a[160:163], v[0:3], a[0:3]
  v_exp_f32 v96, v96
  v_mfma_f32_16x16x32_bf16 a[0:3], a[164:167], v[32:35], a[0:3]
  ds_read_b64_tr_b16 a[184:185], v219 offset:0
  s_waitcnt lgkmcnt(4)
  buffer_load_dwordx4 v253, s[24:27], s8 offen offset:1024 sc1 lds
  v_mfma_f32_16x16x32_bf16 v[228:231], a[232:235], a[212:215], 0
  v_mfma_f32_16x16x32_bf16 v[228:231], a[236:239], a[216:219], v[228:231]
  v_mfma_f32_16x16x32_bf16 v[228:231], a[240:243], a[220:223], v[228:231]
  v_mfma_f32_16x16x32_bf16 a[4:7], a[164:167], v[40:43], a[4:7]
  s_lshl_b32 s35, s3, 10
  s_add_u32 s35, s35, 159744
  v_exp_f32 v97, v97
  v_mfma_f32_16x16x32_bf16 a[4:7], a[160:163], v[8:11], a[4:7]
  ds_read_b64_tr_b16 a[186:187], v219 offset:4096
  v_cvt_pk_bf16_f32 v96, v96, v97
  v_mfma_f32_16x16x32_bf16 a[8:11], a[160:163], v[16:19], a[8:11]
  v_exp_f32 v98, v98
  v_mfma_f32_16x16x32_bf16 a[8:11], a[164:167], v[48:51], a[8:11]
  ds_read_b64_tr_b16 a[188:189], v219 offset:8192
  buffer_load_dwordx4 v253, s[24:27], s8 offen offset:2048 sc1 lds
  v_mfma_f32_16x16x32_bf16 a[12:15], a[164:167], v[56:59], a[12:15]
  v_exp_f32 v99, v99
  v_mfma_f32_16x16x32_bf16 a[12:15], a[160:163], v[24:27], a[12:15]
  ds_read_b64_tr_b16 a[190:191], v219 offset:12288
  v_cvt_pk_bf16_f32 v97, v98, v99
  v_mfma_f32_16x16x32_bf16 a[16:19], a[168:171], v[0:3], a[16:19]
  v_exp_f32 v104, v104
  v_mfma_f32_16x16x32_bf16 a[16:19], a[172:175], v[32:35], a[16:19]
  ds_read_b64_tr_b16 a[160:161], v220 offset:0
  buffer_load_dwordx4 v253, s[24:27], s8 offen offset:3072 sc1 lds
  v_mfma_f32_16x16x32_bf16 a[20:23], a[172:175], v[40:43], a[20:23]
  v_exp_f32 v105, v105
  v_mfma_f32_16x16x32_bf16 a[20:23], a[168:171], v[8:11], a[20:23]
  ds_read_b64_tr_b16 a[162:163], v220 offset:4096
  v_cvt_pk_bf16_f32 v104, v104, v105
  v_mfma_f32_16x16x32_bf16 a[24:27], a[168:171], v[16:19], a[24:27]
  v_exp_f32 v106, v106
  v_mfma_f32_16x16x32_bf16 a[24:27], a[172:175], v[48:51], a[24:27]
  ds_read_b64_tr_b16 a[164:165], v220 offset:8192
  v_add_u32 v224, s35, v242
  v_mfma_f32_16x16x32_bf16 a[28:31], a[172:175], v[56:59], a[28:31]
  s_waitcnt lgkmcnt(7)
  v_exp_f32 v107, v107
  v_mfma_f32_16x16x32_bf16 a[28:31], a[168:171], v[24:27], a[28:31]
  ds_read_b64_tr_b16 a[166:167], v220 offset:12288
  v_cvt_pk_bf16_f32 v105, v106, v107
  v_mfma_f32_16x16x32_bf16 a[32:35], a[176:179], v[0:3], a[32:35]
  v_exp_f32 v112, v112
  v_mfma_f32_16x16x32_bf16 a[32:35], a[180:183], v[32:35], a[32:35]
  ds_read_b64_tr_b16 a[168:169], v221 offset:0
  ds_write_b128 v224, v[228:231]
  v_mfma_f32_16x16x32_bf16 a[36:39], a[180:183], v[40:43], a[36:39]
  v_exp_f32 v113, v113
  v_mfma_f32_16x16x32_bf16 a[36:39], a[176:179], v[8:11], a[36:39]
  ds_read_b64_tr_b16 a[170:171], v221 offset:4096
  v_cvt_pk_bf16_f32 v112, v112, v113
  v_mfma_f32_16x16x32_bf16 a[40:43], a[176:179], v[16:19], a[40:43]
  v_exp_f32 v114, v114
  v_mfma_f32_16x16x32_bf16 a[40:43], a[180:183], v[48:51], a[40:43]
  ds_read_b64_tr_b16 a[172:173], v221 offset:8192
  v_mfma_f32_16x16x32_bf16 a[44:47], a[180:183], v[56:59], a[44:47]
  s_waitcnt lgkmcnt(8)
  v_exp_f32 v115, v115
  v_mfma_f32_16x16x32_bf16 a[44:47], a[176:179], v[24:27], a[44:47]
  ds_read_b64_tr_b16 a[174:175], v221 offset:12288
  v_cvt_pk_bf16_f32 v113, v114, v115
  v_mfma_f32_16x16x32_bf16 a[48:51], a[184:187], v[0:3], a[48:51]
  v_exp_f32 v120, v120
  v_mfma_f32_16x16x32_bf16 a[48:51], a[188:191], v[32:35], a[48:51]
  ds_read_b64_tr_b16 a[176:177], v222 offset:0
  s_waitcnt lgkmcnt(4)
  v_mfma_f32_16x16x32_bf16 a[52:55], a[188:191], v[40:43], a[52:55]
  v_exp_f32 v121, v121
  v_mfma_f32_16x16x32_bf16 a[52:55], a[184:187], v[8:11], a[52:55]
  ds_read_b64_tr_b16 a[178:179], v222 offset:4096
  v_cvt_pk_bf16_f32 v120, v120, v121
  v_mfma_f32_16x16x32_bf16 a[56:59], a[184:187], v[16:19], a[56:59]
  v_exp_f32 v122, v122
  v_mfma_f32_16x16x32_bf16 a[56:59], a[188:191], v[48:51], a[56:59]
  ds_read_b64_tr_b16 a[180:181], v222 offset:8192
  v_mfma_f32_16x16x32_bf16 a[60:63], a[188:191], v[56:59], a[60:63]
  v_exp_f32 v123, v123
  v_mfma_f32_16x16x32_bf16 a[60:63], a[184:187], v[24:27], a[60:63]
  ds_read_b64_tr_b16 a[182:183], v222 offset:12288
  v_cvt_pk_bf16_f32 v121, v122, v123
  v_mfma_f32_16x16x32_bf16 a[64:67], a[160:163], v[0:3], a[64:67]
  v_exp_f32 v100, v100
  v_mfma_f32_16x16x32_bf16 a[64:67], a[164:167], v[32:35], a[64:67]
  ds_read_b64_tr_b16 a[184:185], v223 offset:0
  v_mfma_f32_16x16x32_bf16 a[68:71], a[164:167], v[40:43], a[68:71]
  v_exp_f32 v101, v101
  v_mfma_f32_16x16x32_bf16 a[68:71], a[160:163], v[8:11], a[68:71]
  ds_read_b64_tr_b16 a[186:187], v223 offset:4096
  v_cvt_pk_bf16_f32 v98, v100, v101
  v_mfma_f32_16x16x32_bf16 a[72:75], a[160:163], v[16:19], a[72:75]
  v_exp_f32 v102, v102
  v_mfma_f32_16x16x32_bf16 a[72:75], a[164:167], v[48:51], a[72:75]
  ds_read_b64_tr_b16 a[188:189], v223 offset:8192
  v_mfma_f32_16x16x32_bf16 a[76:79], a[164:167], v[56:59], a[76:79]
  s_waitcnt lgkmcnt(7)
  v_exp_f32 v103, v103
  v_mfma_f32_16x16x32_bf16 a[76:79], a[160:163], v[24:27], a[76:79]
  ds_read_b64_tr_b16 a[190:191], v223 offset:12288
  v_cvt_pk_bf16_f32 v99, v102, v103
  v_mfma_f32_16x16x32_bf16 a[80:83], a[168:171], v[0:3], a[80:83]
  s_waitcnt vmcnt(12)
  v_exp_f32 v108, v108
  v_mfma_f32_16x16x32_bf16 a[80:83], a[172:175], v[32:35], a[80:83]
  v_mfma_f32_16x16x32_bf16 a[84:87], a[172:175], v[40:43], a[84:87]
  s_barrier
  v_exp_f32 v109, v109
  v_mfma_f32_16x16x32_bf16 a[84:87], a[168:171], v[8:11], a[84:87]
  ds_read_b128 a[128:131], v212 offset:32768
  v_cvt_pk_bf16_f32 v106, v108, v109
  v_mfma_f32_16x16x32_bf16 a[88:91], a[168:171], v[16:19], a[88:91]
  v_exp_f32 v110, v110
  v_mfma_f32_16x16x32_bf16 a[88:91], a[172:175], v[48:51], a[88:91]
  ds_read_b128 a[132:135], v213 offset:32768
  v_mfma_f32_16x16x32_bf16 a[92:95], a[172:175], v[56:59], a[92:95]
  s_waitcnt lgkmcnt(6)
  v_exp_f32 v111, v111
  v_mfma_f32_16x16x32_bf16 a[92:95], a[168:171], v[24:27], a[92:95]
  ds_read_b128 a[136:139], v214 offset:32768
  v_cvt_pk_bf16_f32 v107, v110, v111
  v_mfma_f32_16x16x32_bf16 a[96:99], a[176:179], v[0:3], a[96:99]
  v_exp_f32 v116, v116
  v_mfma_f32_16x16x32_bf16 a[96:99], a[180:183], v[32:35], a[96:99]
  ds_read_b128 a[140:143], v215 offset:32768
  v_mfma_f32_16x16x32_bf16 a[100:103], a[180:183], v[40:43], a[100:103]
  v_exp_f32 v117, v117
  v_mfma_f32_16x16x32_bf16 a[100:103], a[176:179], v[8:11], a[100:103]
  v_cvt_pk_bf16_f32 v114, v116, v117
  v_mfma_f32_16x16x32_bf16 a[104:107], a[176:179], v[16:19], a[104:107]
  v_exp_f32 v118, v118
  v_mfma_f32_16x16x32_bf16 a[104:107], a[180:183], v[48:51], a[104:107]
  v_mfma_f32_16x16x32_bf16 a[108:111], a[180:183], v[56:59], a[108:111]
  s_waitcnt lgkmcnt(4)
  v_exp_f32 v119, v119
  v_mfma_f32_16x16x32_bf16 a[108:111], a[176:179], v[24:27], a[108:111]
  v_cvt_pk_bf16_f32 v115, v118, v119
  v_mfma_f32_16x16x32_bf16 a[112:115], a[184:187], v[0:3], a[112:115]
  v_exp_f32 v124, v124
  v_mfma_f32_16x16x32_bf16 a[112:115], a[188:191], v[32:35], a[112:115]
  v_mfma_f32_16x16x32_bf16 a[116:119], a[188:191], v[40:43], a[116:119]
  v_exp_f32 v125, v125
  v_mfma_f32_16x16x32_bf16 a[116:119], a[184:187], v[8:11], a[116:119]
  v_cvt_pk_bf16_f32 v122, v124, v125
  v_mfma_f32_16x16x32_bf16 a[120:123], a[184:187], v[16:19], a[120:123]
  v_exp_f32 v126, v126
  v_mfma_f32_16x16x32_bf16 a[120:123], a[188:191], v[48:51], a[120:123]
  v_mfma_f32_16x16x32_bf16 a[124:127], a[188:191], v[56:59], a[124:127]
  s_waitcnt lgkmcnt(0)
  v_exp_f32 v127, v127
  v_mfma_f32_16x16x32_bf16 a[124:127], a[184:187], v[24:27], a[124:127]
  v_cvt_pk_bf16_f32 v123, v126, v127
  v_mfma_f32_16x16x32_bf16 v[0:3], a[128:131], v[128:131], v[192:195]
  s_add_u32 m0, s28, 114688
  v_add_u32 v224, 159744, v242
  v_mfma_f32_16x16x32_bf16 v[0:3], a[132:135], v[132:135], v[0:3]
  ds_read_b128 a[144:147], v212 offset:36864
  ds_read_b128 v[228:231], v224 offset:0
  v_mfma_f32_16x16x32_bf16 v[0:3], a[136:139], v[136:139], v[0:3]
  buffer_load_dwordx4 v236, s[16:19], s29 offen offset:0 lds
  v_mfma_f32_16x16x32_bf16 v[0:3], a[140:143], v[140:143], v[0:3]
  ds_read_b128 a[148:151], v213 offset:36864
  ds_read_b128 v[238:241], v224 offset:1024
  v_mfma_f32_16x16x32_bf16 v[8:11], a[140:143], v[156:159], v[196:199]
  buffer_load_dwordx4 v237, s[16:19], s29 offen offset:1024 lds
  v_mfma_f32_16x16x32_bf16 v[8:11], a[136:139], v[152:155], v[8:11]
  ds_read_b128 a[152:155], v214 offset:36864
  ds_read_b128 v[208:211], v224 offset:2048
  v_mfma_f32_16x16x32_bf16 v[8:11], a[132:135], v[148:151], v[8:11]
  buffer_load_dwordx4 v236, s[16:19], s29 offen offset:2048 lds
  v_mfma_f32_16x16x32_bf16 v[8:11], a[128:131], v[144:147], v[8:11]
  ds_read_b128 a[156:159], v215 offset:36864
  v_lshrrev_b32 v224, 4, v242
  v_mfma_f32_16x16x32_bf16 v[16:19], a[128:131], v[160:163], v[200:203]
  s_min_u32 s35, s3, 1
  s_lshl_b32 s35, s35, 30
  v_exp_f32 v0, v0
  v_mfma_f32_16x16x32_bf16 v[16:19], a[132:135], v[164:167], v[16:19]
  buffer_load_dwordx4 v237, s[16:19], s29 offen offset:3072 lds
  v_mfma_f32_16x16x32_bf16 v[16:19], a[136:139], v[168:171], v[16:19]
  s_add_u32 s29, s29, 16384
  v_exp_f32 v1, v1
  v_mfma_f32_16x16x32_bf16 v[16:19], a[140:143], v[172:175], v[16:19]
  v_cvt_pk_bf16_f32 v0, v0, v1
  v_and_b32 v225, 7, v224
  v_mfma_f32_16x16x32_bf16 v[24:27], a[140:143], v[188:191], v[204:207]
  s_add_u32 m0, s28, 16384
  v_exp_f32 v2, v2
  v_mfma_f32_16x16x32_bf16 v[24:27], a[136:139], v[184:187], v[24:27]
  buffer_load_dwordx4 v242, s[24:27], s9 offen offset:0 sc1 lds
  v_mfma_f32_16x16x32_bf16 v[24:27], a[132:135], v[180:183], v[24:27]
  s_waitcnt lgkmcnt(0)
  v_exp_f32 v3, v3
  v_mfma_f32_16x16x32_bf16 v[24:27], a[128:131], v[176:179], v[24:27]
  v_cvt_pk_bf16_f32 v1, v2, v3
  v_mul_u32_u24 v225, 0xa00, v225
  v_mfma_f32_16x16x32_bf16 v[4:7], a[144:147], v[128:131], v[192:195]
  v_exp_f32 v8, v8
  v_mfma_f32_16x16x32_bf16 v[4:7], a[148:151], v[132:135], v[4:7]
  ds_read_b128 a[128:131], v212 offset:40960
  v_lshrrev_b32 v226, 4, v224
  v_mfma_f32_16x16x32_bf16 v[4:7], a[152:155], v[136:139], v[4:7]
  v_exp_f32 v9, v9
  v_mfma_f32_16x16x32_bf16 v[4:7], a[156:159], v[140:143], v[4:7]
  ds_read_b128 a[132:135], v213 offset:40960
  v_cvt_pk_bf16_f32 v8, v8, v9
  v_mfma_f32_16x16x32_bf16 v[12:15], a[156:159], v[156:159], v[196:199]
  v_exp_f32 v10, v10
  v_mfma_f32_16x16x32_bf16 v[12:15], a[152:155], v[152:155], v[12:15]
  ds_read_b128 a[136:139], v214 offset:40960
  v_lshl_add_u32 v225, v226, 4, v225
  v_mfma_f32_16x16x32_bf16 v[12:15], a[148:151], v[148:151], v[12:15]
  v_exp_f32 v11, v11
  v_mfma_f32_16x16x32_bf16 v[12:15], a[144:147], v[144:147], v[12:15]
  ds_read_b128 a[140:143], v215 offset:40960
  v_cvt_pk_bf16_f32 v9, v10, v11
  v_mfma_f32_16x16x32_bf16 v[20:23], a[144:147], v[160:163], v[200:203]
  v_exp_f32 v16, v16
  v_mfma_f32_16x16x32_bf16 v[20:23], a[148:151], v[164:167], v[20:23]
  buffer_load_dwordx4 v242, s[24:27], s9 offen offset:1024 sc1 lds
  v_mfma_f32_16x16x32_bf16 v[20:23], a[152:155], v[168:171], v[20:23]
  v_exp_f32 v17, v17
  v_mfma_f32_16x16x32_bf16 v[20:23], a[156:159], v[172:175], v[20:23]
  v_cvt_pk_bf16_f32 v16, v16, v17
  v_bfe_u32 v226, v224, 3, 1
  v_mfma_f32_16x16x32_bf16 v[28:31], a[156:159], v[188:191], v[204:207]
  v_exp_f32 v18, v18
  v_mfma_f32_16x16x32_bf16 v[28:31], a[152:155], v[184:187], v[28:31]
  buffer_load_dwordx4 v242, s[24:27], s9 offen offset:2048 sc1 lds
  v_mfma_f32_16x16x32_bf16 v[28:31], a[148:151], v[180:183], v[28:31]
  s_waitcnt lgkmcnt(0)
  v_exp_f32 v19, v19
  v_mfma_f32_16x16x32_bf16 v[28:31], a[144:147], v[176:179], v[28:31]
  v_cvt_pk_bf16_f32 v17, v18, v19
  v_lshl_add_u32 v225, v226, 30, v225
  v_mfma_f32_16x16x32_bf16 v[32:35], a[128:131], v[128:131], v[192:195]
  v_exp_f32 v24, v24
  v_mfma_f32_16x16x32_bf16 v[32:35], a[132:135], v[132:135], v[32:35]
  ds_read_b128 a[144:147], v212 offset:45056
  v_or_b32 v225, s35, v225
  v_mfma_f32_16x16x32_bf16 v[32:35], a[136:139], v[136:139], v[32:35]
  s_mul_i32 s35, s98, 20480
  s_lshl_b32 s38, s99, 6
  v_exp_f32 v25, v25
  v_mfma_f32_16x16x32_bf16 v[32:35], a[140:143], v[140:143], v[32:35]
  ds_read_b128 a[148:151], v213 offset:45056
  s_add_u32 s35, s35, s38
  s_add_u32 s35, s35, 2686976
  v_cvt_pk_bf16_f32 v24, v24, v25
  v_mfma_f32_16x16x32_bf16 v[40:43], a[140:143], v[156:159], v[196:199]
  v_exp_f32 v26, v26
  v_mfma_f32_16x16x32_bf16 v[40:43], a[136:139], v[152:155], v[40:43]
  ds_read_b128 a[152:155], v214 offset:45056
  v_add_f32 v228, v228, v238
  v_mfma_f32_16x16x32_bf16 v[40:43], a[132:135], v[148:151], v[40:43]
  v_exp_f32 v27, v27
  v_mfma_f32_16x16x32_bf16 v[40:43], a[128:131], v[144:147], v[40:43]
  ds_read_b128 a[156:159], v215 offset:45056
  v_cvt_pk_bf16_f32 v25, v26, v27
  v_mfma_f32_16x16x32_bf16 v[48:51], a[128:131], v[160:163], v[200:203]
  v_exp_f32 v4, v4
  v_mfma_f32_16x16x32_bf16 v[48:51], a[132:135], v[164:167], v[48:51]
  buffer_load_dwordx4 v242, s[24:27], s9 offen offset:3072 sc1 lds
  v_mfma_f32_16x16x32_bf16 v[48:51], a[136:139], v[168:171], v[48:51]
  v_exp_f32 v5, v5
  v_mfma_f32_16x16x32_bf16 v[48:51], a[140:143], v[172:175], v[48:51]
  v_cvt_pk_bf16_f32 v2, v4, v5
  v_add_f32 v229, v229, v239
  v_mfma_f32_16x16x32_bf16 v[56:59], a[140:143], v[188:191], v[204:207]
  v_exp_f32 v6, v6
  v_mfma_f32_16x16x32_bf16 v[56:59], a[136:139], v[184:187], v[56:59]
  buffer_load_dwordx4 a[212:215], v242, s[24:27], s4 offen offset:0 sc1
  v_mfma_f32_16x16x32_bf16 v[56:59], a[132:135], v[180:183], v[56:59]
  s_waitcnt lgkmcnt(0)
  v_exp_f32 v7, v7
  v_mfma_f32_16x16x32_bf16 v[56:59], a[128:131], v[176:179], v[56:59]
  v_cvt_pk_bf16_f32 v3, v6, v7
  v_add_f32 v230, v230, v240
  v_mfma_f32_16x16x32_bf16 v[36:39], a[144:147], v[128:131], v[192:195]
  v_exp_f32 v12, v12
  v_mfma_f32_16x16x32_bf16 v[36:39], a[148:151], v[132:135], v[36:39]
  ds_read_b64_tr_b16 a[160:161], v216 offset:16384
  v_add_f32 v231, v231, v241
  v_mfma_f32_16x16x32_bf16 v[36:39], a[152:155], v[136:139], v[36:39]
  v_exp_f32 v13, v13
  v_mfma_f32_16x16x32_bf16 v[36:39], a[156:159], v[140:143], v[36:39]
  ds_read_b64_tr_b16 a[162:163], v216 offset:20480
  v_cvt_pk_bf16_f32 v10, v12, v13
  v_mfma_f32_16x16x32_bf16 v[44:47], a[156:159], v[156:159], v[196:199]
  v_exp_f32 v14, v14
  v_mfma_f32_16x16x32_bf16 v[44:47], a[152:155], v[152:155], v[44:47]
  ds_read_b64_tr_b16 a[164:165], v216 offset:24576
  buffer_load_dwordx4 a[216:219], v242, s[24:27], s4 offen offset:1024 sc1
  v_mfma_f32_16x16x32_bf16 v[44:47], a[148:151], v[148:151], v[44:47]
  v_exp_f32 v15, v15
  v_mfma_f32_16x16x32_bf16 v[44:47], a[144:147], v[144:147], v[44:47]
  ds_read_b64_tr_b16 a[166:167], v216 offset:28672
  v_cvt_pk_bf16_f32 v11, v14, v15
  v_mfma_f32_16x16x32_bf16 v[52:55], a[144:147], v[160:163], v[200:203]
  v_exp_f32 v20, v20
  v_mfma_f32_16x16x32_bf16 v[52:55], a[148:151], v[164:167], v[52:55]
  ds_read_b64_tr_b16 a[168:169], v217 offset:16384
  v_add_f32 v228, v228, v208
  v_mfma_f32_16x16x32_bf16 v[52:55], a[152:155], v[168:171], v[52:55]
  v_exp_f32 v21, v21
  v_mfma_f32_16x16x32_bf16 v[52:55], a[156:159], v[172:175], v[52:55]
  ds_read_b64_tr_b16 a[170:171], v217 offset:20480
  v_cvt_pk_bf16_f32 v18, v20, v21
  v_mfma_f32_16x16x32_bf16 v[60:63], a[156:159], v[188:191], v[204:207]
  v_exp_f32 v22, v22
  v_mfma_f32_16x16x32_bf16 v[60:63], a[152:155], v[184:187], v[60:63]
  ds_read_b64_tr_b16 a[172:173], v217 offset:24576
  buffer_load_dwordx4 a[220:223], v242, s[24:27], s4 offen offset:2048 sc1
  v_mfma_f32_16x16x32_bf16 v[60:63], a[148:151], v[180:183], v[60:63]
  v_exp_f32 v23, v23
  v_mfma_f32_16x16x32_bf16 v[60:63], a[144:147], v[176:179], v[60:63]
  ds_read_b64_tr_b16 a[174:175], v217 offset:28672
  v_cvt_pk_bf16_f32 v19, v22, v23
  v_mfma_f32_16x16x32_bf16 a[192:195], a[208:211], v[64:67], a[192:195]
  v_exp_f32 v28, v28
  v_mfma_f32_16x16x32_bf16 a[192:195], a[208:211], v[96:99], a[192:195]
  ds_read_b64_tr_b16 a[176:177], v218 offset:16384
  v_add_f32 v229, v229, v209
  v_mfma_f32_16x16x32_bf16 a[196:199], a[208:211], v[72:75], a[196:199]
  v_exp_f32 v29, v29
  v_mfma_f32_16x16x32_bf16 a[196:199], a[208:211], v[104:107], a[196:199]
  ds_read_b64_tr_b16 a[178:179], v218 offset:20480
  v_cvt_pk_bf16_f32 v26, v28, v29
  v_mfma_f32_16x16x32_bf16 a[200:203], a[208:211], v[80:83], a[200:203]
  v_exp_f32 v30, v30
  v_mfma_f32_16x16x32_bf16 a[200:203], a[208:211], v[112:115], a[200:203]
  ds_read_b64_tr_b16 a[180:181], v218 offset:24576
  buffer_load_dwordx4 a[224:227], v242, s[24:27], s4 offen offset:3072 sc1
  v_mfma_f32_16x16x32_bf16 a[204:207], a[208:211], v[88:91], a[204:207]
  s_waitcnt lgkmcnt(7)
  v_exp_f32 v31, v31
  v_mfma_f32_16x16x32_bf16 a[204:207], a[208:211], v[120:123], a[204:207]
  ds_read_b64_tr_b16 a[182:183], v218 offset:28672
  v_cvt_pk_bf16_f32 v27, v30, v31
  v_mfma_f32_16x16x32_bf16 a[0:3], a[160:163], v[64:67], a[0:3]
  v_exp_f32 v32, v32
  v_mfma_f32_16x16x32_bf16 a[0:3], a[164:167], v[96:99], a[0:3]
  ds_read_b64_tr_b16 a[184:185], v219 offset:16384
  v_add_f32 v230, v230, v210
  v_mfma_f32_16x16x32_bf16 a[4:7], a[164:167], v[104:107], a[4:7]
  v_exp_f32 v33, v33
  v_mfma_f32_16x16x32_bf16 a[4:7], a[160:163], v[72:75], a[4:7]
  ds_read_b64_tr_b16 a[186:187], v219 offset:20480
  v_cvt_pk_bf16_f32 v32, v32, v33
  v_mfma_f32_16x16x32_bf16 a[8:11], a[160:163], v[80:83], a[8:11]
  v_exp_f32 v34, v34
  v_mfma_f32_16x16x32_bf16 a[8:11], a[164:167], v[112:115], a[8:11]
  ds_read_b64_tr_b16 a[188:189], v219 offset:24576
  buffer_load_dwordx4 a[228:231], v252, s[24:27], s4 offen offset:0 sc1
  v_mfma_f32_16x16x32_bf16 a[12:15], a[164:167], v[120:123], a[12:15]
  s_waitcnt lgkmcnt(7)
  v_exp_f32 v35, v35
  v_mfma_f32_16x16x32_bf16 a[12:15], a[160:163], v[88:91], a[12:15]
  ds_read_b64_tr_b16 a[190:191], v219 offset:28672
  v_cvt_pk_bf16_f32 v33, v34, v35
  v_mfma_f32_16x16x32_bf16 a[16:19], a[168:171], v[64:67], a[16:19]
  v_exp_f32 v40, v40
  v_mfma_f32_16x16x32_bf16 a[16:19], a[172:175], v[96:99], a[16:19]
  ds_read_b64_tr_b16 a[160:161], v220 offset:16384
  v_add_f32 v231, v231, v211
  v_mfma_f32_16x16x32_bf16 a[20:23], a[172:175], v[104:107], a[20:23]
  v_exp_f32 v41, v41
  v_mfma_f32_16x16x32_bf16 a[20:23], a[168:171], v[72:75], a[20:23]
  ds_read_b64_tr_b16 a[162:163], v220 offset:20480
  v_cvt_pk_bf16_f32 v40, v40, v41
  v_mfma_f32_16x16x32_bf16 a[24:27], a[168:171], v[80:83], a[24:27]
  v_exp_f32 v42, v42
  v_mfma_f32_16x16x32_bf16 a[24:27], a[172:175], v[112:115], a[24:27]
  ds_read_b64_tr_b16 a[164:165], v220 offset:24576
  buffer_store_dwordx4 v[228:231], v225, s[24:27], s35 offen sc1
  v_mfma_f32_16x16x32_bf16 a[28:31], a[172:175], v[120:123], a[28:31]
  s_waitcnt lgkmcnt(7)
  v_exp_f32 v43, v43
  v_mfma_f32_16x16x32_bf16 a[28:31], a[168:171], v[88:91], a[28:31]
  ds_read_b64_tr_b16 a[166:167], v220 offset:28672
  v_cvt_pk_bf16_f32 v41, v42, v43
  v_mfma_f32_16x16x32_bf16 a[32:35], a[176:179], v[64:67], a[32:35]
  v_exp_f32 v48, v48
  v_mfma_f32_16x16x32_bf16 a[32:35], a[180:183], v[96:99], a[32:35]
  ds_read_b64_tr_b16 a[168:169], v221 offset:16384
  buffer_load_dwordx4 a[232:235], v252, s[24:27], s4 offen offset:1024 sc1
  v_mfma_f32_16x16x32_bf16 a[36:39], a[180:183], v[104:107], a[36:39]
  v_exp_f32 v49, v49
  v_mfma_f32_16x16x32_bf16 a[36:39], a[176:179], v[72:75], a[36:39]
  ds_read_b64_tr_b16 a[170:171], v221 offset:20480
  v_cvt_pk_bf16_f32 v48, v48, v49
  v_mfma_f32_16x16x32_bf16 a[40:43], a[176:179], v[80:83], a[40:43]
  v_exp_f32 v50, v50
  v_mfma_f32_16x16x32_bf16 a[40:43], a[180:183], v[112:115], a[40:43]
  ds_read_b64_tr_b16 a[172:173], v221 offset:24576
  v_mfma_f32_16x16x32_bf16 a[44:47], a[180:183], v[120:123], a[44:47]
  s_waitcnt lgkmcnt(7)
  v_exp_f32 v51, v51
  v_mfma_f32_16x16x32_bf16 a[44:47], a[176:179], v[88:91], a[44:47]
  ds_read_b64_tr_b16 a[174:175], v221 offset:28672
  v_cvt_pk_bf16_f32 v49, v50, v51
  v_mfma_f32_16x16x32_bf16 a[48:51], a[184:187], v[64:67], a[48:51]
  v_exp_f32 v56, v56
  v_mfma_f32_16x16x32_bf16 a[48:51], a[188:191], v[96:99], a[48:51]
  ds_read_b64_tr_b16 a[176:177], v222 offset:16384
  v_mfma_f32_16x16x32_bf16 a[52:55], a[188:191], v[104:107], a[52:55]
  v_exp_f32 v57, v57
  v_mfma_f32_16x16x32_bf16 a[52:55], a[184:187], v[72:75], a[52:55]
  ds_read_b64_tr_b16 a[178:179], v222 offset:20480
  v_cvt_pk_bf16_f32 v56, v56, v57
  v_mfma_f32_16x16x32_bf16 a[56:59], a[184:187], v[80:83], a[56:59]
  v_exp_f32 v58, v58
  v_mfma_f32_16x16x32_bf16 a[56:59], a[188:191], v[112:115], a[56:59]
  ds_read_b64_tr_b16 a[180:181], v222 offset:24576
  v_mfma_f32_16x16x32_bf16 a[60:63], a[188:191], v[120:123], a[60:63]
  s_waitcnt lgkmcnt(7)
  v_exp_f32 v59, v59
  v_mfma_f32_16x16x32_bf16 a[60:63], a[184:187], v[88:91], a[60:63]
  ds_read_b64_tr_b16 a[182:183], v222 offset:28672
  v_cvt_pk_bf16_f32 v57, v58, v59
  v_mfma_f32_16x16x32_bf16 a[64:67], a[160:163], v[64:67], a[64:67]
  v_exp_f32 v36, v36
  v_mfma_f32_16x16x32_bf16 a[64:67], a[164:167], v[96:99], a[64:67]
  ds_read_b64_tr_b16 a[184:185], v223 offset:16384
  v_mfma_f32_16x16x32_bf16 a[68:71], a[164:167], v[104:107], a[68:71]
  v_exp_f32 v37, v37
  v_mfma_f32_16x16x32_bf16 a[68:71], a[160:163], v[72:75], a[68:71]
  ds_read_b64_tr_b16 a[186:187], v223 offset:20480
  v_cvt_pk_bf16_f32 v34, v36, v37
  v_mfma_f32_16x16x32_bf16 a[72:75], a[160:163], v[80:83], a[72:75]
  v_exp_f32 v38, v38
  v_mfma_f32_16x16x32_bf16 a[72:75], a[164:167], v[112:115], a[72:75]
  ds_read_b64_tr_b16 a[188:189], v223 offset:24576
  v_mfma_f32_16x16x32_bf16 a[76:79], a[164:167], v[120:123], a[76:79]
  s_waitcnt lgkmcnt(7)
  v_exp_f32 v39, v39
  v_mfma_f32_16x16x32_bf16 a[76:79], a[160:163], v[88:91], a[76:79]
  ds_read_b64_tr_b16 a[190:191], v223 offset:28672
  v_cvt_pk_bf16_f32 v35, v38, v39
  v_mfma_f32_16x16x32_bf16 a[80:83], a[168:171], v[64:67], a[80:83]
  s_waitcnt vmcnt(19)
  v_exp_f32 v44, v44
  v_mfma_f32_16x16x32_bf16 a[80:83], a[172:175], v[96:99], a[80:83]
  v_mfma_f32_16x16x32_bf16 a[84:87], a[172:175], v[104:107], a[84:87]
  s_barrier
  v_exp_f32 v45, v45
  v_mfma_f32_16x16x32_bf16 a[84:87], a[168:171], v[72:75], a[84:87]
  ds_read_b128 a[128:131], v212 offset:49152
  v_cvt_pk_bf16_f32 v42, v44, v45
  v_mfma_f32_16x16x32_bf16 a[88:91], a[168:171], v[80:83], a[88:91]
  v_exp_f32 v46, v46
  v_mfma_f32_16x16x32_bf16 a[88:91], a[172:175], v[112:115], a[88:91]
  ds_read_b128 a[132:135], v213 offset:49152
  v_mfma_f32_16x16x32_bf16 a[92:95], a[172:175], v[120:123], a[92:95]
  s_waitcnt lgkmcnt(6)
  v_exp_f32 v47, v47
  v_mfma_f32_16x16x32_bf16 a[92:95], a[168:171], v[88:91], a[92:95]
  ds_read_b128 a[136:139], v214 offset:49152
  v_cvt_pk_bf16_f32 v43, v46, v47
  v_mfma_f32_16x16x32_bf16 a[96:99], a[176:179], v[64:67], a[96:99]
  v_exp_f32 v52, v52
  v_mfma_f32_16x16x32_bf16 a[96:99], a[180:183], v[96:99], a[96:99]
  ds_read_b128 a[140:143], v215 offset:49152
  v_mfma_f32_16x16x32_bf16 a[100:103], a[180:183], v[104:107], a[100:103]
  v_exp_f32 v53, v53
  v_mfma_f32_16x16x32_bf16 a[100:103], a[176:179], v[72:75], a[100:103]
  v_cvt_pk_bf16_f32 v50, v52, v53
  v_mfma_f32_16x16x32_bf16 a[104:107], a[176:179], v[80:83], a[104:107]
  v_exp_f32 v54, v54
  v_mfma_f32_16x16x32_bf16 a[104:107], a[180:183], v[112:115], a[104:107]
  v_mfma_f32_16x16x32_bf16 a[108:111], a[180:183], v[120:123], a[108:111]
  s_waitcnt lgkmcnt(4)
  v_exp_f32 v55, v55
  v_mfma_f32_16x16x32_bf16 a[108:111], a[176:179], v[88:91], a[108:111]
  v_cvt_pk_bf16_f32 v51, v54, v55
  v_mfma_f32_16x16x32_bf16 a[112:115], a[184:187], v[64:67], a[112:115]
  v_exp_f32 v60, v60
  v_mfma_f32_16x16x32_bf16 a[112:115], a[188:191], v[96:99], a[112:115]
  v_mfma_f32_16x16x32_bf16 a[116:119], a[188:191], v[104:107], a[116:119]
  v_exp_f32 v61, v61
  v_mfma_f32_16x16x32_bf16 a[116:119], a[184:187], v[72:75], a[116:119]
  v_cvt_pk_bf16_f32 v58, v60, v61
  v_mfma_f32_16x16x32_bf16 a[120:123], a[184:187], v[80:83], a[120:123]
  v_exp_f32 v62, v62
  v_mfma_f32_16x16x32_bf16 a[120:123], a[188:191], v[112:115], a[120:123]
  v_mfma_f32_16x16x32_bf16 a[124:127], a[188:191], v[120:123], a[124:127]
  s_waitcnt lgkmcnt(0)
  v_exp_f32 v63, v63
  v_mfma_f32_16x16x32_bf16 a[124:127], a[184:187], v[88:91], a[124:127]
  v_cvt_pk_bf16_f32 v59, v62, v63
  v_mfma_f32_16x16x32_bf16 v[64:67], a[128:131], v[128:131], v[192:195]
  s_add_u32 m0, s28, 65536
  v_mfma_f32_16x16x32_bf16 v[64:67], a[132:135], v[132:135], v[64:67]
  ds_read_b128 a[144:147], v212 offset:53248
  v_mfma_f32_16x16x32_bf16 v[64:67], a[136:139], v[136:139], v[64:67]
  buffer_load_dwordx4 v253, s[24:27], s9 offen offset:0 sc1 lds
  v_mfma_f32_16x16x32_bf16 v[64:67], a[140:143], v[140:143], v[64:67]
  ds_read_b128 a[148:151], v213 offset:53248
  v_mfma_f32_16x16x32_bf16 v[72:75], a[140:143], v[156:159], v[196:199]
  buffer_load_dwordx4 v253, s[24:27], s9 offen offset:1024 sc1 lds
  v_mfma_f32_16x16x32_bf16 v[72:75], a[136:139], v[152:155], v[72:75]
  ds_read_b128 a[152:155], v214 offset:53248
  v_mfma_f32_16x16x32_bf16 v[72:75], a[132:135], v[148:151], v[72:75]
  buffer_load_dwordx4 v253, s[24:27], s9 offen offset:2048 sc1 lds
  v_mfma_f32_16x16x32_bf16 v[72:75], a[128:131], v[144:147], v[72:75]
  ds_read_b128 a[156:159], v215 offset:53248
  v_mfma_f32_16x16x32_bf16 v[80:83], a[128:131], v[160:163], v[200:203]
  v_exp_f32 v64, v64
  v_mfma_f32_16x16x32_bf16 v[80:83], a[132:135], v[164:167], v[80:83]
  buffer_load_dwordx4 v253, s[24:27], s9 offen offset:3072 sc1 lds
  v_mfma_f32_16x16x32_bf16 v[80:83], a[136:139], v[168:171], v[80:83]
  s_add_u32 s29, s29, 16384
  v_exp_f32 v65, v65
  v_mfma_f32_16x16x32_bf16 v[80:83], a[140:143], v[172:175], v[80:83]
  v_cvt_pk_bf16_f32 v64, v64, v65
  v_mfma_f32_16x16x32_bf16 v[88:91], a[140:143], v[188:191], v[204:207]
  s_add_u32 m0, s28, 32768
  v_exp_f32 v66, v66
  v_mfma_f32_16x16x32_bf16 v[88:91], a[136:139], v[184:187], v[88:91]
  buffer_load_dwordx4 v252, s[24:27], s9 offen offset:0 sc1 lds
  v_mfma_f32_16x16x32_bf16 v[88:91], a[132:135], v[180:183], v[88:91]
  s_waitcnt lgkmcnt(0)
  v_exp_f32 v67, v67
  v_mfma_f32_16x16x32_bf16 v[88:91], a[128:131], v[176:179], v[88:91]
  v_cvt_pk_bf16_f32 v65, v66, v67
  v_mfma_f32_16x16x32_bf16 v[68:71], a[144:147], v[128:131], v[192:195]
  v_exp_f32 v72, v72
  v_mfma_f32_16x16x32_bf16 v[68:71], a[148:151], v[132:135], v[68:71]
  ds_read_b128 a[128:131], v212 offset:57344
  v_mfma_f32_16x16x32_bf16 v[68:71], a[152:155], v[136:139], v[68:71]
  v_exp_f32 v73, v73
  v_mfma_f32_16x16x32_bf16 v[68:71], a[156:159], v[140:143], v[68:71]
  ds_read_b128 a[132:135], v213 offset:57344
  v_cvt_pk_bf16_f32 v72, v72, v73
  v_mfma_f32_16x16x32_bf16 v[76:79], a[156:159], v[156:159], v[196:199]
  v_exp_f32 v74, v74
  v_mfma_f32_16x16x32_bf16 v[76:79], a[152:155], v[152:155], v[76:79]
  ds_read_b128 a[136:139], v214 offset:57344
  v_mfma_f32_16x16x32_bf16 v[76:79], a[148:151], v[148:151], v[76:79]
  v_exp_f32 v75, v75
  v_mfma_f32_16x16x32_bf16 v[76:79], a[144:147], v[144:147], v[76:79]
  ds_read_b128 a[140:143], v215 offset:57344
  v_cvt_pk_bf16_f32 v73, v74, v75
  v_mfma_f32_16x16x32_bf16 v[84:87], a[144:147], v[160:163], v[200:203]
  v_exp_f32 v80, v80
  v_mfma_f32_16x16x32_bf16 v[84:87], a[148:151], v[164:167], v[84:87]
  buffer_load_dwordx4 v252, s[24:27], s9 offen offset:1024 sc1 lds
  v_mfma_f32_16x16x32_bf16 v[84:87], a[152:155], v[168:171], v[84:87]
  v_exp_f32 v81, v81
  v_mfma_f32_16x16x32_bf16 v[84:87], a[156:159], v[172:175], v[84:87]
  v_cvt_pk_bf16_f32 v80, v80, v81
  v_mfma_f32_16x16x32_bf16 v[92:95], a[156:159], v[188:191], v[204:207]
  v_exp_f32 v82, v82
  v_mfma_f32_16x16x32_bf16 v[92:95], a[152:155], v[184:187], v[92:95]
  buffer_load_dwordx4 v252, s[24:27], s9 offen offset:2048 sc1 lds
  v_mfma_f32_16x16x32_bf16 v[92:95], a[148:151], v[180:183], v[92:95]
  s_waitcnt lgkmcnt(0)
  v_exp_f32 v83, v83
  v_mfma_f32_16x16x32_bf16 v[92:95], a[144:147], v[176:179], v[92:95]
  v_cvt_pk_bf16_f32 v81, v82, v83
  v_mfma_f32_16x16x32_bf16 v[96:99], a[128:131], v[128:131], v[192:195]
  v_exp_f32 v88, v88
  v_mfma_f32_16x16x32_bf16 v[96:99], a[132:135], v[132:135], v[96:99]
  ds_read_b128 a[144:147], v212 offset:61440
  v_mfma_f32_16x16x32_bf16 v[96:99], a[136:139], v[136:139], v[96:99]
  v_exp_f32 v89, v89
  v_mfma_f32_16x16x32_bf16 v[96:99], a[140:143], v[140:143], v[96:99]
  ds_read_b128 a[148:151], v213 offset:61440
  v_cvt_pk_bf16_f32 v88, v88, v89
  v_mfma_f32_16x16x32_bf16 v[104:107], a[140:143], v[156:159], v[196:199]
  v_exp_f32 v90, v90
  v_mfma_f32_16x16x32_bf16 v[104:107], a[136:139], v[152:155], v[104:107]
  ds_read_b128 a[152:155], v214 offset:61440
  v_mfma_f32_16x16x32_bf16 v[104:107], a[132:135], v[148:151], v[104:107]
  v_exp_f32 v91, v91
  v_mfma_f32_16x16x32_bf16 v[104:107], a[128:131], v[144:147], v[104:107]
  ds_read_b128 a[156:159], v215 offset:61440
  v_cvt_pk_bf16_f32 v89, v90, v91
  v_mfma_f32_16x16x32_bf16 v[112:115], a[128:131], v[160:163], v[200:203]
  v_exp_f32 v68, v68
  v_mfma_f32_16x16x32_bf16 v[112:115], a[132:135], v[164:167], v[112:115]
  buffer_load_dwordx4 v252, s[24:27], s9 offen offset:3072 sc1 lds
  v_mfma_f32_16x16x32_bf16 v[112:115], a[136:139], v[168:171], v[112:115]
  v_exp_f32 v69, v69
  v_mfma_f32_16x16x32_bf16 v[112:115], a[140:143], v[172:175], v[112:115]
  v_cvt_pk_bf16_f32 v66, v68, v69
  v_mfma_f32_16x16x32_bf16 v[120:123], a[140:143], v[188:191], v[204:207]
  v_exp_f32 v70, v70
  v_mfma_f32_16x16x32_bf16 v[120:123], a[136:139], v[184:187], v[120:123]
  buffer_load_dwordx4 a[236:239], v252, s[24:27], s4 offen offset:2048 sc1
  v_mfma_f32_16x16x32_bf16 v[120:123], a[132:135], v[180:183], v[120:123]
  s_waitcnt lgkmcnt(0)
  v_exp_f32 v71, v71
  v_mfma_f32_16x16x32_bf16 v[120:123], a[128:131], v[176:179], v[120:123]
  v_cvt_pk_bf16_f32 v67, v70, v71
  v_mfma_f32_16x16x32_bf16 v[100:103], a[144:147], v[128:131], v[192:195]
  v_exp_f32 v76, v76
  v_mfma_f32_16x16x32_bf16 v[100:103], a[148:151], v[132:135], v[100:103]
  ds_read_b64_tr_b16 a[160:161], v216 offset:32768
  v_mfma_f32_16x16x32_bf16 v[100:103], a[152:155], v[136:139], v[100:103]
  v_exp_f32 v77, v77
  v_mfma_f32_16x16x32_bf16 v[100:103], a[156:159], v[140:143], v[100:103]
  ds_read_b64_tr_b16 a[162:163], v216 offset:36864
  v_cvt_pk_bf16_f32 v74, v76, v77
  v_mfma_f32_16x16x32_bf16 v[108:111], a[156:159], v[156:159], v[196:199]
  v_exp_f32 v78, v78
  v_mfma_f32_16x16x32_bf16 v[108:111], a[152:155], v[152:155], v[108:111]
  ds_read_b64_tr_b16 a[164:165], v216 offset:40960
  buffer_load_dwordx4 a[240:243], v252, s[24:27], s4 offen offset:3072 sc1
  v_mfma_f32_16x16x32_bf16 v[108:111], a[148:151], v[148:151], v[108:111]
  v_exp_f32 v79, v79
  v_mfma_f32_16x16x32_bf16 v[108:111], a[144:147], v[144:147], v[108:111]
  ds_read_b64_tr_b16 a[166:167], v216 offset:45056
  v_cvt_pk_bf16_f32 v75, v78, v79
  v_mfma_f32_16x16x32_bf16 v[116:119], a[144:147], v[160:163], v[200:203]
  v_exp_f32 v84, v84
  v_mfma_f32_16x16x32_bf16 v[116:119], a[148:151], v[164:167], v[116:119]
  ds_read_b64_tr_b16 a[168:169], v217 offset:32768
  v_mfma_f32_16x16x32_bf16 v[116:119], a[152:155], v[168:171], v[116:119]
  v_exp_f32 v85, v85
  v_mfma_f32_16x16x32_bf16 v[116:119], a[156:159], v[172:175], v[116:119]
  ds_read_b64_tr_b16 a[170:171], v217 offset:36864
  v_cvt_pk_bf16_f32 v82, v84, v85
  v_mfma_f32_16x16x32_bf16 v[124:127], a[156:159], v[188:191], v[204:207]
  v_exp_f32 v86, v86
  v_mfma_f32_16x16x32_bf16 v[124:127], a[152:155], v[184:187], v[124:127]
  ds_read_b64_tr_b16 a[172:173], v217 offset:40960
  buffer_load_dwordx4 a[244:247], v253, s[24:27], s4 offen offset:0 sc1
  v_mfma_f32_16x16x32_bf16 v[124:127], a[148:151], v[180:183], v[124:127]
  v_exp_f32 v87, v87
  v_mfma_f32_16x16x32_bf16 v[124:127], a[144:147], v[176:179], v[124:127]
  ds_read_b64_tr_b16 a[174:175], v217 offset:45056
  v_cvt_pk_bf16_f32 v83, v86, v87
  v_mfma_f32_16x16x32_bf16 a[192:195], a[208:211], v[0:3], a[192:195]
  v_exp_f32 v92, v92
  v_mfma_f32_16x16x32_bf16 a[192:195], a[208:211], v[32:35], a[192:195]
  ds_read_b64_tr_b16 a[176:177], v218 offset:32768
  v_mfma_f32_16x16x32_bf16 a[196:199], a[208:211], v[8:11], a[196:199]
  v_exp_f32 v93, v93
  v_mfma_f32_16x16x32_bf16 a[196:199], a[208:211], v[40:43], a[196:199]
  ds_read_b64_tr_b16 a[178:179], v218 offset:36864
  v_cvt_pk_bf16_f32 v90, v92, v93
  v_mfma_f32_16x16x32_bf16 a[200:203], a[208:211], v[16:19], a[200:203]
  v_exp_f32 v94, v94
  v_mfma_f32_16x16x32_bf16 a[200:203], a[208:211], v[48:51], a[200:203]
  ds_read_b64_tr_b16 a[180:181], v218 offset:40960
  buffer_load_dwordx4 a[248:251], v253, s[24:27], s4 offen offset:1024 sc1
  v_mfma_f32_16x16x32_bf16 a[204:207], a[208:211], v[24:27], a[204:207]
  s_waitcnt lgkmcnt(7)
  v_exp_f32 v95, v95
  v_mfma_f32_16x16x32_bf16 a[204:207], a[208:211], v[56:59], a[204:207]
  ds_read_b64_tr_b16 a[182:183], v218 offset:45056
  v_cvt_pk_bf16_f32 v91, v94, v95
  v_mfma_f32_16x16x32_bf16 a[0:3], a[160:163], v[0:3], a[0:3]
  v_exp_f32 v96, v96
  v_mfma_f32_16x16x32_bf16 a[0:3], a[164:167], v[32:35], a[0:3]
  ds_read_b64_tr_b16 a[184:185], v219 offset:32768
  v_mfma_f32_16x16x32_bf16 a[4:7], a[164:167], v[40:43], a[4:7]
  v_exp_f32 v97, v97
  v_mfma_f32_16x16x32_bf16 a[4:7], a[160:163], v[8:11], a[4:7]
  ds_read_b64_tr_b16 a[186:187], v219 offset:36864
  v_cvt_pk_bf16_f32 v96, v96, v97
  v_mfma_f32_16x16x32_bf16 a[8:11], a[160:163], v[16:19], a[8:11]
  v_exp_f32 v98, v98
  v_mfma_f32_16x16x32_bf16 a[8:11], a[164:167], v[48:51], a[8:11]
  ds_read_b64_tr_b16 a[188:189], v219 offset:40960
  buffer_load_dwordx4 a[252:255], v253, s[24:27], s4 offen offset:2048 sc1
  v_mfma_f32_16x16x32_bf16 a[12:15], a[164:167], v[56:59], a[12:15]
  s_waitcnt lgkmcnt(7)
  v_exp_f32 v99, v99
  v_mfma_f32_16x16x32_bf16 a[12:15], a[160:163], v[24:27], a[12:15]
  ds_read_b64_tr_b16 a[190:191], v219 offset:45056
  v_cvt_pk_bf16_f32 v97, v98, v99
  v_mfma_f32_16x16x32_bf16 a[16:19], a[168:171], v[0:3], a[16:19]
  v_exp_f32 v104, v104
  v_mfma_f32_16x16x32_bf16 a[16:19], a[172:175], v[32:35], a[16:19]
  ds_read_b64_tr_b16 a[160:161], v220 offset:32768
  v_mfma_f32_16x16x32_bf16 a[20:23], a[172:175], v[40:43], a[20:23]
  v_exp_f32 v105, v105
  v_mfma_f32_16x16x32_bf16 a[20:23], a[168:171], v[8:11], a[20:23]
  ds_read_b64_tr_b16 a[162:163], v220 offset:36864
  v_cvt_pk_bf16_f32 v104, v104, v105
  v_mfma_f32_16x16x32_bf16 a[24:27], a[168:171], v[16:19], a[24:27]
  v_exp_f32 v106, v106
  v_mfma_f32_16x16x32_bf16 a[24:27], a[172:175], v[48:51], a[24:27]
  ds_read_b64_tr_b16 a[164:165], v220 offset:40960
  v_mfma_f32_16x16x32_bf16 a[28:31], a[172:175], v[56:59], a[28:31]
  s_waitcnt lgkmcnt(7)
  v_exp_f32 v107, v107
  v_mfma_f32_16x16x32_bf16 a[28:31], a[168:171], v[24:27], a[28:31]
  ds_read_b64_tr_b16 a[166:167], v220 offset:45056
  v_cvt_pk_bf16_f32 v105, v106, v107
  v_mfma_f32_16x16x32_bf16 a[32:35], a[176:179], v[0:3], a[32:35]
  v_exp_f32 v112, v112
  v_mfma_f32_16x16x32_bf16 a[32:35], a[180:183], v[32:35], a[32:35]
  ds_read_b64_tr_b16 a[168:169], v221 offset:32768
  v_mfma_f32_16x16x32_bf16 a[36:39], a[180:183], v[40:43], a[36:39]
  v_exp_f32 v113, v113
  v_mfma_f32_16x16x32_bf16 a[36:39], a[176:179], v[8:11], a[36:39]
  ds_read_b64_tr_b16 a[170:171], v221 offset:36864
  v_cvt_pk_bf16_f32 v112, v112, v113
  v_mfma_f32_16x16x32_bf16 a[40:43], a[176:179], v[16:19], a[40:43]
  v_exp_f32 v114, v114
  v_mfma_f32_16x16x32_bf16 a[40:43], a[180:183], v[48:51], a[40:43]
  ds_read_b64_tr_b16 a[172:173], v221 offset:40960
  v_mfma_f32_16x16x32_bf16 a[44:47], a[180:183], v[56:59], a[44:47]
  s_waitcnt lgkmcnt(7)
  v_exp_f32 v115, v115
  v_mfma_f32_16x16x32_bf16 a[44:47], a[176:179], v[24:27], a[44:47]
  ds_read_b64_tr_b16 a[174:175], v221 offset:45056
  v_cvt_pk_bf16_f32 v113, v114, v115
  v_mfma_f32_16x16x32_bf16 a[48:51], a[184:187], v[0:3], a[48:51]
  v_exp_f32 v120, v120
  v_mfma_f32_16x16x32_bf16 a[48:51], a[188:191], v[32:35], a[48:51]
  ds_read_b64_tr_b16 a[176:177], v222 offset:32768
  v_mfma_f32_16x16x32_bf16 a[52:55], a[188:191], v[40:43], a[52:55]
  v_exp_f32 v121, v121
  v_mfma_f32_16x16x32_bf16 a[52:55], a[184:187], v[8:11], a[52:55]
  ds_read_b64_tr_b16 a[178:179], v222 offset:36864
  v_cvt_pk_bf16_f32 v120, v120, v121
  v_mfma_f32_16x16x32_bf16 a[56:59], a[184:187], v[16:19], a[56:59]
  v_exp_f32 v122, v122
  v_mfma_f32_16x16x32_bf16 a[56:59], a[188:191], v[48:51], a[56:59]
  ds_read_b64_tr_b16 a[180:181], v222 offset:40960
  v_mfma_f32_16x16x32_bf16 a[60:63], a[188:191], v[56:59], a[60:63]
  s_waitcnt lgkmcnt(7)
  v_exp_f32 v123, v123
  v_mfma_f32_16x16x32_bf16 a[60:63], a[184:187], v[24:27], a[60:63]
  ds_read_b64_tr_b16 a[182:183], v222 offset:45056
  v_cvt_pk_bf16_f32 v121, v122, v123
  v_mfma_f32_16x16x32_bf16 a[64:67], a[160:163], v[0:3], a[64:67]
  v_exp_f32 v100, v100
  v_mfma_f32_16x16x32_bf16 a[64:67], a[164:167], v[32:35], a[64:67]
  ds_read_b64_tr_b16 a[184:185], v223 offset:32768
  v_mfma_f32_16x16x32_bf16 a[68:71], a[164:167], v[40:43], a[68:71]
  v_exp_f32 v101, v101
  v_mfma_f32_16x16x32_bf16 a[68:71], a[160:163], v[8:11], a[68:71]
  ds_read_b64_tr_b16 a[186:187], v223 offset:36864
  v_cvt_pk_bf16_f32 v98, v100, v101
  v_mfma_f32_16x16x32_bf16 a[72:75], a[160:163], v[16:19], a[72:75]
  v_exp_f32 v102, v102
  v_mfma_f32_16x16x32_bf16 a[72:75], a[164:167], v[48:51], a[72:75]
  ds_read_b64_tr_b16 a[188:189], v223 offset:40960
  v_mfma_f32_16x16x32_bf16 a[76:79], a[164:167], v[56:59], a[76:79]
  s_waitcnt lgkmcnt(7)
  v_exp_f32 v103, v103
  v_mfma_f32_16x16x32_bf16 a[76:79], a[160:163], v[24:27], a[76:79]
  ds_read_b64_tr_b16 a[190:191], v223 offset:45056
  v_cvt_pk_bf16_f32 v99, v102, v103
  v_mfma_f32_16x16x32_bf16 a[80:83], a[168:171], v[0:3], a[80:83]
  s_waitcnt vmcnt(14)
  v_exp_f32 v108, v108
  v_mfma_f32_16x16x32_bf16 a[80:83], a[172:175], v[32:35], a[80:83]
  v_mfma_f32_16x16x32_bf16 a[84:87], a[172:175], v[40:43], a[84:87]
  s_barrier
  v_exp_f32 v109, v109
  v_mfma_f32_16x16x32_bf16 a[84:87], a[168:171], v[8:11], a[84:87]
  s_mul_i32 s39, s99, 13108
  s_lshr_b32 s39, s39, 16
  v_cvt_pk_bf16_f32 v106, v108, v109
  v_mfma_f32_16x16x32_bf16 a[88:91], a[168:171], v[16:19], a[88:91]
  s_lshl_b32 s39, s39, 8
  s_add_u32 s39, s39, 2822400
  v_exp_f32 v110, v110
  v_mfma_f32_16x16x32_bf16 a[88:91], a[172:175], v[48:51], a[88:91]
  s_cmp_lt_u32 s2, 240
  s_cselect_b32 s48, 0, 1073741824
  v_or_b32 v249, s48, v251
  v_mfma_f32_16x16x32_bf16 a[92:95], a[172:175], v[56:59], a[92:95]
  s_waitcnt lgkmcnt(4)
  v_exp_f32 v111, v111
  v_mfma_f32_16x16x32_bf16 a[92:95], a[168:171], v[24:27], a[92:95]
  buffer_atomic_add v250, v249, s[24:27], s39 offen
  v_cvt_pk_bf16_f32 v107, v110, v111
  v_mfma_f32_16x16x32_bf16 a[96:99], a[176:179], v[0:3], a[96:99]
  v_exp_f32 v116, v116
  v_mfma_f32_16x16x32_bf16 a[96:99], a[180:183], v[32:35], a[96:99]
  v_mfma_f32_16x16x32_bf16 a[100:103], a[180:183], v[40:43], a[100:103]
  v_exp_f32 v117, v117
  v_mfma_f32_16x16x32_bf16 a[100:103], a[176:179], v[8:11], a[100:103]
  v_cvt_pk_bf16_f32 v114, v116, v117
  v_mfma_f32_16x16x32_bf16 a[104:107], a[176:179], v[16:19], a[104:107]
  v_exp_f32 v118, v118
  v_mfma_f32_16x16x32_bf16 a[104:107], a[180:183], v[48:51], a[104:107]
  v_mfma_f32_16x16x32_bf16 a[108:111], a[180:183], v[56:59], a[108:111]
  s_waitcnt lgkmcnt(0)
  v_exp_f32 v119, v119
  v_mfma_f32_16x16x32_bf16 a[108:111], a[176:179], v[24:27], a[108:111]
  v_cvt_pk_bf16_f32 v115, v118, v119
  v_mfma_f32_16x16x32_bf16 a[112:115], a[184:187], v[0:3], a[112:115]
  v_exp_f32 v124, v124
  v_mfma_f32_16x16x32_bf16 a[112:115], a[188:191], v[32:35], a[112:115]
  v_mfma_f32_16x16x32_bf16 a[116:119], a[188:191], v[40:43], a[116:119]
  v_exp_f32 v125, v125
  v_mfma_f32_16x16x32_bf16 a[116:119], a[184:187], v[8:11], a[116:119]
  v_cvt_pk_bf16_f32 v122, v124, v125
  v_mfma_f32_16x16x32_bf16 a[120:123], a[184:187], v[16:19], a[120:123]
  v_exp_f32 v126, v126
  v_mfma_f32_16x16x32_bf16 a[120:123], a[188:191], v[48:51], a[120:123]
  v_mfma_f32_16x16x32_bf16 a[124:127], a[188:191], v[56:59], a[124:127]
  v_exp_f32 v127, v127
  v_mfma_f32_16x16x32_bf16 a[124:127], a[184:187], v[24:27], a[124:127]
  v_cvt_pk_bf16_f32 v123, v126, v127
  ds_read_b64_tr_b16 a[160:161], v216 offset:49152
  ds_read_b64_tr_b16 a[162:163], v216 offset:53248
  ds_read_b64_tr_b16 a[164:165], v216 offset:57344
  ds_read_b64_tr_b16 a[166:167], v216 offset:61440
  ds_read_b64_tr_b16 a[168:169], v217 offset:49152
  ds_read_b64_tr_b16 a[170:171], v217 offset:53248
  ds_read_b64_tr_b16 a[172:173], v217 offset:57344
  ds_read_b64_tr_b16 a[174:175], v217 offset:61440
  s_mov_b32 s48, 0x5d800000
  s_lshl_b32 s39, s3, 8
  v_mfma_f32_16x16x32_bf16 a[192:195], a[208:211], v[64:67], a[192:195]
  s_add_u32 m0, s28, 81920
  v_mfma_f32_16x16x32_bf16 a[192:195], a[208:211], v[96:99], a[192:195]
  v_mfma_f32_16x16x32_bf16 a[196:199], a[208:211], v[72:75], a[196:199]
  buffer_load_dwordx4 v242, s[24:27], s10 offen offset:0 sc1 lds
  v_mfma_f32_16x16x32_bf16 a[196:199], a[208:211], v[104:107], a[196:199]
  v_mfma_f32_16x16x32_bf16 a[200:203], a[208:211], v[80:83], a[200:203]
  buffer_load_dwordx4 v242, s[24:27], s10 offen offset:1024 sc1 lds
  v_mfma_f32_16x16x32_bf16 a[200:203], a[208:211], v[112:115], a[200:203]
  v_mfma_f32_16x16x32_bf16 a[204:207], a[208:211], v[88:91], a[204:207]
  buffer_load_dwordx4 v242, s[24:27], s10 offen offset:2048 sc1 lds
  v_mfma_f32_16x16x32_bf16 a[204:207], a[208:211], v[120:123], a[204:207]
  s_waitcnt lgkmcnt(4)
  v_mfma_f32_16x16x32_bf16 a[0:3], a[160:163], v[64:67], a[0:3]
  buffer_load_dwordx4 v242, s[24:27], s10 offen offset:3072 sc1 lds
  v_mfma_f32_16x16x32_bf16 a[0:3], a[164:167], v[96:99], a[0:3]
  ds_read_b64_tr_b16 a[176:177], v218 offset:49152
  v_mfma_f32_16x16x32_bf16 a[4:7], a[164:167], v[104:107], a[4:7]
  buffer_load_dwordx4 a[128:131], v253, s[24:27], s4 offen offset:3072 sc1
  v_mfma_f32_16x16x32_bf16 a[4:7], a[160:163], v[72:75], a[4:7]
  ds_read_b64_tr_b16 a[178:179], v218 offset:53248
  v_accvgpr_read_b32 v208, a192
  v_mfma_f32_16x16x32_bf16 a[8:11], a[160:163], v[80:83], a[8:11]
  v_accvgpr_read_b32 v209, a196
  v_accvgpr_read_b32 v210, a200
  v_mfma_f32_16x16x32_bf16 a[8:11], a[164:167], v[112:115], a[8:11]
  ds_read_b64_tr_b16 a[180:181], v218 offset:57344
  v_accvgpr_read_b32 v211, a204
  v_mfma_f32_16x16x32_bf16 a[12:15], a[164:167], v[120:123], a[12:15]
  v_mov_b32 v245, v208
  v_mov_b32 v246, v209
  v_mfma_f32_16x16x32_bf16 a[12:15], a[160:163], v[88:91], a[12:15]
  ds_read_b64_tr_b16 a[182:183], v218 offset:61440
  s_waitcnt lgkmcnt(4)
  v_mov_b32 v247, v210
  v_mfma_f32_16x16x32_bf16 a[16:19], a[168:171], v[64:67], a[16:19]
  v_mov_b32 v248, v211
  v_permlane16_swap_b32 v208, v245
  v_mfma_f32_16x16x32_bf16 a[16:19], a[172:175], v[96:99], a[16:19]
  ds_read_b64_tr_b16 a[184:185], v219 offset:49152
  v_permlane16_swap_b32 v209, v246
  v_mfma_f32_16x16x32_bf16 a[20:23], a[172:175], v[104:107], a[20:23]
  v_permlane16_swap_b32 v210, v247
  v_permlane16_swap_b32 v211, v248
  v_mfma_f32_16x16x32_bf16 a[20:23], a[168:171], v[72:75], a[20:23]
  ds_read_b64_tr_b16 a[186:187], v219 offset:53248
  v_add_f32 v208, v208, v245
  v_mfma_f32_16x16x32_bf16 a[24:27], a[168:171], v[80:83], a[24:27]
  v_add_f32 v209, v209, v246
  v_add_f32 v210, v210, v247
  v_mfma_f32_16x16x32_bf16 a[24:27], a[172:175], v[112:115], a[24:27]
  ds_read_b64_tr_b16 a[188:189], v219 offset:57344
  v_add_f32 v211, v211, v248
  v_mfma_f32_16x16x32_bf16 a[28:31], a[172:175], v[120:123], a[28:31]
  v_mov_b32 v245, v208
  v_mov_b32 v246, v209
  v_mfma_f32_16x16x32_bf16 a[28:31], a[168:171], v[88:91], a[28:31]
  ds_read_b64_tr_b16 a[190:191], v219 offset:61440
  s_waitcnt lgkmcnt(4)
  v_mov_b32 v247, v210
  v_mfma_f32_16x16x32_bf16 a[32:35], a[176:179], v[64:67], a[32:35]
  v_mov_b32 v248, v211
  v_permlane32_swap_b32 v208, v245
  v_mfma_f32_16x16x32_bf16 a[32:35], a[180:183], v[96:99], a[32:35]
  ds_read_b64_tr_b16 a[160:161], v220 offset:49152
  v_permlane32_swap_b32 v209, v246
  v_mfma_f32_16x16x32_bf16 a[36:39], a[180:183], v[104:107], a[36:39]
  v_permlane32_swap_b32 v210, v247
  v_permlane32_swap_b32 v211, v248
  v_mfma_f32_16x16x32_bf16 a[36:39], a[176:179], v[72:75], a[36:39]
  ds_read_b64_tr_b16 a[162:163], v220 offset:53248
  v_add_f32 v208, v208, v245
  v_mfma_f32_16x16x32_bf16 a[40:43], a[176:179], v[80:83], a[40:43]
  v_add_f32 v209, v209, v246
  v_add_f32 v210, v210, v247
  v_mfma_f32_16x16x32_bf16 a[40:43], a[180:183], v[112:115], a[40:43]
  ds_read_b64_tr_b16 a[164:165], v220 offset:57344
  v_add_f32 v211, v211, v248
  buffer_load_dwordx4 a[132:135], v242, s[24:27], s5 offen offset:0 sc1
  buffer_load_dwordx4 a[136:139], v242, s[24:27], s5 offen offset:1024 sc1
  buffer_load_dwordx4 a[140:143], v242, s[24:27], s5 offen offset:2048 sc1
  buffer_load_dwordx4 a[144:147], v242, s[24:27], s5 offen offset:3072 sc1
  buffer_load_dwordx4 a[148:151], v252, s[24:27], s5 offen offset:0 sc1
  buffer_load_dwordx4 a[152:155], v252, s[24:27], s5 offen offset:1024 sc1
  buffer_load_dwordx4 a[156:159], v252, s[24:27], s5 offen offset:2048 sc1
  v_mfma_f32_16x16x32_bf16 a[44:47], a[180:183], v[120:123], a[44:47]
  v_rcp_f32 v192, v208
  v_mfma_f32_16x16x32_bf16 a[44:47], a[176:179], v[88:91], a[44:47]
  ds_read_b64_tr_b16 a[166:167], v220 offset:61440
  s_waitcnt lgkmcnt(4)
  v_mfma_f32_16x16x32_bf16 a[48:51], a[184:187], v[64:67], a[48:51]
  v_rcp_f32 v196, v209
  v_mfma_f32_16x16x32_bf16 a[48:51], a[188:191], v[96:99], a[48:51]
  ds_read_b64_tr_b16 a[168:169], v221 offset:49152
  v_mfma_f32_16x16x32_bf16 a[52:55], a[188:191], v[104:107], a[52:55]
  v_rcp_f32 v200, v210
  v_mfma_f32_16x16x32_bf16 a[52:55], a[184:187], v[72:75], a[52:55]
  ds_read_b64_tr_b16 a[170:171], v221 offset:53248
  v_mfma_f32_16x16x32_bf16 a[56:59], a[184:187], v[80:83], a[56:59]
  v_rcp_f32 v204, v211
  v_mfma_f32_16x16x32_bf16 a[56:59], a[188:191], v[112:115], a[56:59]
  ds_read_b64_tr_b16 a[172:173], v221 offset:57344
  v_add_f32 v246, v208, v209
  v_mfma_f32_16x16x32_bf16 a[60:63], a[188:191], v[120:123], a[60:63]
  v_add_f32 v247, v210, v211
  v_add_f32 v246, v246, v247
  v_mfma_f32_16x16x32_bf16 a[60:63], a[184:187], v[88:91], a[60:63]
  ds_read_b64_tr_b16 a[174:175], v221 offset:61440
  s_waitcnt lgkmcnt(4)
  v_lshrrev_b32 v247, 2, v242
  v_mfma_f32_16x16x32_bf16 a[64:67], a[160:163], v[64:67], a[64:67]
  v_cmp_nlt_f32 vcc, v246, s48
  v_add_u32 v247, s39, v247
  v_mfma_f32_16x16x32_bf16 a[64:67], a[164:167], v[96:99], a[64:67]
  ds_read_b64_tr_b16 a[176:177], v222 offset:49152
  v_add_u32 v247, 157696, v247
  v_mfma_f32_16x16x32_bf16 a[68:71], a[164:167], v[104:107], a[68:71]
  v_cndmask_b32_e64 v245, 0, 1, vcc
  v_accvgpr_read_b32 v0, a0
  v_mfma_f32_16x16x32_bf16 a[68:71], a[160:163], v[72:75], a[68:71]
  ds_read_b64_tr_b16 a[178:179], v222 offset:53248
  v_accvgpr_read_b32 v1, a1
  v_mfma_f32_16x16x32_bf16 a[72:75], a[160:163], v[80:83], a[72:75]
  v_accvgpr_read_b32 v2, a2
  v_accvgpr_read_b32 v3, a3
  v_mfma_f32_16x16x32_bf16 a[72:75], a[164:167], v[112:115], a[72:75]
  ds_read_b64_tr_b16 a[180:181], v222 offset:57344
  v_accvgpr_read_b32 v4, a16
  v_mfma_f32_16x16x32_bf16 a[76:79], a[164:167], v[120:123], a[76:79]
  v_accvgpr_read_b32 v5, a17
  v_accvgpr_read_b32 v6, a18
  v_mfma_f32_16x16x32_bf16 a[76:79], a[160:163], v[88:91], a[76:79]
  ds_read_b64_tr_b16 a[182:183], v222 offset:61440
  s_waitcnt lgkmcnt(4)
  v_accvgpr_read_b32 v7, a19
  v_mfma_f32_16x16x32_bf16 a[80:83], a[168:171], v[64:67], a[80:83]
  v_mul_f32 v0, v0, v192
  v_mul_f32 v1, v1, v192
  v_mfma_f32_16x16x32_bf16 a[80:83], a[172:175], v[96:99], a[80:83]
  ds_read_b64_tr_b16 a[184:185], v223 offset:49152
  v_mul_f32 v2, v2, v192
  v_mfma_f32_16x16x32_bf16 a[84:87], a[172:175], v[104:107], a[84:87]
  v_mul_f32 v3, v3, v192
  v_mul_f32 v4, v4, v192
  v_mfma_f32_16x16x32_bf16 a[84:87], a[168:171], v[72:75], a[84:87]
  ds_read_b64_tr_b16 a[186:187], v223 offset:53248
  v_mul_f32 v5, v5, v192
  v_mfma_f32_16x16x32_bf16 a[88:91], a[168:171], v[80:83], a[88:91]
  v_mul_f32 v6, v6, v192
  v_mul_f32 v7, v7, v192
  v_mfma_f32_16x16x32_bf16 a[88:91], a[172:175], v[112:115], a[88:91]
  ds_read_b64_tr_b16 a[188:189], v223 offset:57344
  v_cvt_pk_bf16_f32 v0, v0, v1
  v_mfma_f32_16x16x32_bf16 a[92:95], a[172:175], v[120:123], a[92:95]
  v_cvt_pk_bf16_f32 v1, v2, v3
  v_cvt_pk_bf16_f32 v2, v4, v5
  v_mfma_f32_16x16x32_bf16 a[92:95], a[168:171], v[88:91], a[92:95]
  ds_read_b64_tr_b16 a[190:191], v223 offset:61440
  s_waitcnt lgkmcnt(4)
  v_cvt_pk_bf16_f32 v3, v6, v7
  v_mfma_f32_16x16x32_bf16 a[96:99], a[176:179], v[64:67], a[96:99]
  buffer_store_dwordx4 v[0:3], v244, s[24:27], s40 offen offset:0 sc1
  v_mfma_f32_16x16x32_bf16 a[96:99], a[180:183], v[96:99], a[96:99]
  v_accvgpr_read_b32 v8, a4
  v_accvgpr_read_b32 v9, a5
  v_mfma_f32_16x16x32_bf16 a[100:103], a[180:183], v[104:107], a[100:103]
  v_accvgpr_read_b32 v10, a6
  v_accvgpr_read_b32 v11, a7
  v_mfma_f32_16x16x32_bf16 a[100:103], a[176:179], v[72:75], a[100:103]
  v_accvgpr_read_b32 v12, a20
  v_accvgpr_read_b32 v13, a21
  v_mfma_f32_16x16x32_bf16 a[104:107], a[176:179], v[80:83], a[104:107]
  v_accvgpr_read_b32 v14, a22
  v_accvgpr_read_b32 v15, a23
  v_mfma_f32_16x16x32_bf16 a[104:107], a[180:183], v[112:115], a[104:107]
  v_mul_f32 v8, v8, v196
  v_mul_f32 v9, v9, v196
  v_mfma_f32_16x16x32_bf16 a[108:111], a[180:183], v[120:123], a[108:111]
  v_mul_f32 v10, v10, v196
  v_mul_f32 v11, v11, v196
  v_mfma_f32_16x16x32_bf16 a[108:111], a[176:179], v[88:91], a[108:111]
  s_waitcnt lgkmcnt(0)
  v_mul_f32 v12, v12, v196
  v_mul_f32 v13, v13, v196
  v_mfma_f32_16x16x32_bf16 a[112:115], a[184:187], v[64:67], a[112:115]
  v_mul_f32 v14, v14, v196
  v_mul_f32 v15, v15, v196
  v_mfma_f32_16x16x32_bf16 a[112:115], a[188:191], v[96:99], a[112:115]
  v_cvt_pk_bf16_f32 v8, v8, v9
  v_cvt_pk_bf16_f32 v9, v10, v11
  v_mfma_f32_16x16x32_bf16 a[116:119], a[188:191], v[104:107], a[116:119]
  v_cvt_pk_bf16_f32 v10, v12, v13
  v_cvt_pk_bf16_f32 v11, v14, v15
  v_mfma_f32_16x16x32_bf16 a[116:119], a[184:187], v[72:75], a[116:119]
  buffer_store_dwordx4 v[8:11], v244, s[24:27], s40 offen offset:2048 sc1
  v_mfma_f32_16x16x32_bf16 a[120:123], a[184:187], v[80:83], a[120:123]
  v_accvgpr_read_b32 v16, a8
  v_accvgpr_read_b32 v17, a9
  v_mfma_f32_16x16x32_bf16 a[120:123], a[188:191], v[112:115], a[120:123]
  v_accvgpr_read_b32 v18, a10
  v_accvgpr_read_b32 v19, a11
  v_mfma_f32_16x16x32_bf16 a[124:127], a[188:191], v[120:123], a[124:127]
  v_accvgpr_read_b32 v20, a24
  v_accvgpr_read_b32 v21, a25
  v_mfma_f32_16x16x32_bf16 a[124:127], a[184:187], v[88:91], a[124:127]
  v_accvgpr_read_b32 v22, a26
  v_accvgpr_read_b32 v23, a27
  v_pk_mul_f32 v[16:17], v[16:17], v[200:201] op_sel_hi:[1,0]
  v_pk_mul_f32 v[18:19], v[18:19], v[200:201] op_sel_hi:[1,0]
  v_pk_mul_f32 v[20:21], v[20:21], v[200:201] op_sel_hi:[1,0]
  v_pk_mul_f32 v[22:23], v[22:23], v[200:201] op_sel_hi:[1,0]
  v_cvt_pk_bf16_f32 v16, v16, v17
  v_cvt_pk_bf16_f32 v17, v18, v19
  v_cvt_pk_bf16_f32 v18, v20, v21
  v_cvt_pk_bf16_f32 v19, v22, v23
  buffer_store_dwordx4 v[16:19], v244, s[24:27], s41 offen offset:0 sc1
  v_accvgpr_read_b32 v24, a12
  v_accvgpr_read_b32 v25, a13
  v_accvgpr_read_b32 v26, a14
  v_accvgpr_read_b32 v27, a15
  v_accvgpr_read_b32 v28, a28
  v_accvgpr_read_b32 v29, a29
  v_accvgpr_read_b32 v30, a30
  v_accvgpr_read_b32 v31, a31
  v_pk_mul_f32 v[24:25], v[24:25], v[204:205] op_sel_hi:[1,0]
  v_pk_mul_f32 v[26:27], v[26:27], v[204:205] op_sel_hi:[1,0]
  v_pk_mul_f32 v[28:29], v[28:29], v[204:205] op_sel_hi:[1,0]
  v_pk_mul_f32 v[30:31], v[30:31], v[204:205] op_sel_hi:[1,0]
  v_cvt_pk_bf16_f32 v24, v24, v25
  v_cvt_pk_bf16_f32 v25, v26, v27
  v_cvt_pk_bf16_f32 v26, v28, v29
  v_cvt_pk_bf16_f32 v27, v30, v31
  buffer_store_dwordx4 v[24:27], v244, s[24:27], s41 offen offset:2048 sc1
  v_accvgpr_read_b32 v32, a32
  v_accvgpr_read_b32 v33, a33
  v_accvgpr_read_b32 v34, a34
  v_accvgpr_read_b32 v35, a35
  v_accvgpr_read_b32 v36, a48
  v_accvgpr_read_b32 v37, a49
  v_accvgpr_read_b32 v38, a50
  v_accvgpr_read_b32 v39, a51
  v_pk_mul_f32 v[32:33], v[32:33], v[192:193] op_sel_hi:[1,0]
  v_pk_mul_f32 v[34:35], v[34:35], v[192:193] op_sel_hi:[1,0]
  v_pk_mul_f32 v[36:37], v[36:37], v[192:193] op_sel_hi:[1,0]
  v_pk_mul_f32 v[38:39], v[38:39], v[192:193] op_sel_hi:[1,0]
  v_cvt_pk_bf16_f32 v32, v32, v33
  v_cvt_pk_bf16_f32 v33, v34, v35
  v_cvt_pk_bf16_f32 v34, v36, v37
  v_cvt_pk_bf16_f32 v35, v38, v39
  buffer_store_dwordx4 v[32:35], v244, s[24:27], s40 offen offset:1024 sc1
  v_accvgpr_read_b32 v40, a36
  v_accvgpr_read_b32 v41, a37
  v_accvgpr_read_b32 v42, a38
  v_accvgpr_read_b32 v43, a39
  v_accvgpr_read_b32 v44, a52
  v_accvgpr_read_b32 v45, a53
  v_accvgpr_read_b32 v46, a54
  v_accvgpr_read_b32 v47, a55
  v_pk_mul_f32 v[40:41], v[40:41], v[196:197] op_sel_hi:[1,0]
  v_pk_mul_f32 v[42:43], v[42:43], v[196:197] op_sel_hi:[1,0]
  v_pk_mul_f32 v[44:45], v[44:45], v[196:197] op_sel_hi:[1,0]
  v_pk_mul_f32 v[46:47], v[46:47], v[196:197] op_sel_hi:[1,0]
  v_cvt_pk_bf16_f32 v40, v40, v41
  v_cvt_pk_bf16_f32 v41, v42, v43
  v_cvt_pk_bf16_f32 v42, v44, v45
  v_cvt_pk_bf16_f32 v43, v46, v47
  buffer_store_dwordx4 v[40:43], v244, s[24:27], s40 offen offset:3072 sc1
  v_accvgpr_read_b32 v48, a40
  v_accvgpr_read_b32 v49, a41
  v_accvgpr_read_b32 v50, a42
  v_accvgpr_read_b32 v51, a43
  v_accvgpr_read_b32 v52, a56
  v_accvgpr_read_b32 v53, a57
  v_accvgpr_read_b32 v54, a58
  v_accvgpr_read_b32 v55, a59
  v_pk_mul_f32 v[48:49], v[48:49], v[200:201] op_sel_hi:[1,0]
  v_pk_mul_f32 v[50:51], v[50:51], v[200:201] op_sel_hi:[1,0]
  v_pk_mul_f32 v[52:53], v[52:53], v[200:201] op_sel_hi:[1,0]
  v_pk_mul_f32 v[54:55], v[54:55], v[200:201] op_sel_hi:[1,0]
  v_cvt_pk_bf16_f32 v48, v48, v49
  v_cvt_pk_bf16_f32 v49, v50, v51
  v_cvt_pk_bf16_f32 v50, v52, v53
  v_cvt_pk_bf16_f32 v51, v54, v55
  buffer_store_dwordx4 v[48:51], v244, s[24:27], s41 offen offset:1024 sc1
  v_accvgpr_read_b32 v56, a44
  v_accvgpr_read_b32 v57, a45
  v_accvgpr_read_b32 v58, a46
  v_accvgpr_read_b32 v59, a47
  v_accvgpr_read_b32 v60, a60
  v_accvgpr_read_b32 v61, a61
  v_accvgpr_read_b32 v62, a62
  v_accvgpr_read_b32 v63, a63
  v_pk_mul_f32 v[56:57], v[56:57], v[204:205] op_sel_hi:[1,0]
  v_pk_mul_f32 v[58:59], v[58:59], v[204:205] op_sel_hi:[1,0]
  v_pk_mul_f32 v[60:61], v[60:61], v[204:205] op_sel_hi:[1,0]
  v_pk_mul_f32 v[62:63], v[62:63], v[204:205] op_sel_hi:[1,0]
  v_cvt_pk_bf16_f32 v56, v56, v57
  v_cvt_pk_bf16_f32 v57, v58, v59
  v_cvt_pk_bf16_f32 v58, v60, v61
  v_cvt_pk_bf16_f32 v59, v62, v63
  buffer_store_dwordx4 v[56:59], v244, s[24:27], s41 offen offset:3072 sc1
  v_accvgpr_read_b32 v0, a64
  v_accvgpr_read_b32 v1, a65
  v_accvgpr_read_b32 v2, a66
  v_accvgpr_read_b32 v3, a67
  v_accvgpr_read_b32 v4, a80
  v_accvgpr_read_b32 v5, a81
  v_accvgpr_read_b32 v6, a82
  v_accvgpr_read_b32 v7, a83
  v_pk_mul_f32 v[0:1], v[0:1], v[192:193] op_sel_hi:[1,0]
  v_pk_mul_f32 v[2:3], v[2:3], v[192:193] op_sel_hi:[1,0]
  v_pk_mul_f32 v[4:5], v[4:5], v[192:193] op_sel_hi:[1,0]
  v_pk_mul_f32 v[6:7], v[6:7], v[192:193] op_sel_hi:[1,0]
  v_cvt_pk_bf16_f32 v0, v0, v1
  v_cvt_pk_bf16_f32 v1, v2, v3
  v_cvt_pk_bf16_f32 v2, v4, v5
  v_cvt_pk_bf16_f32 v3, v6, v7
  buffer_store_dwordx4 v[0:3], v244, s[24:27], s42 offen offset:0 sc1
  v_accvgpr_read_b32 v8, a68
  v_accvgpr_read_b32 v9, a69
  v_accvgpr_read_b32 v10, a70
  v_accvgpr_read_b32 v11, a71
  v_accvgpr_read_b32 v12, a84
  v_accvgpr_read_b32 v13, a85
  v_accvgpr_read_b32 v14, a86
  v_accvgpr_read_b32 v15, a87
  v_pk_mul_f32 v[8:9], v[8:9], v[196:197] op_sel_hi:[1,0]
  v_pk_mul_f32 v[10:11], v[10:11], v[196:197] op_sel_hi:[1,0]
  v_pk_mul_f32 v[12:13], v[12:13], v[196:197] op_sel_hi:[1,0]
  v_pk_mul_f32 v[14:15], v[14:15], v[196:197] op_sel_hi:[1,0]
  v_cvt_pk_bf16_f32 v8, v8, v9
  v_cvt_pk_bf16_f32 v9, v10, v11
  v_cvt_pk_bf16_f32 v10, v12, v13
  v_cvt_pk_bf16_f32 v11, v14, v15
  buffer_store_dwordx4 v[8:11], v244, s[24:27], s42 offen offset:2048 sc1
  v_accvgpr_read_b32 v16, a72
  v_accvgpr_read_b32 v17, a73
  v_accvgpr_read_b32 v18, a74
  v_accvgpr_read_b32 v19, a75
  v_accvgpr_read_b32 v20, a88
  v_accvgpr_read_b32 v21, a89
  v_accvgpr_read_b32 v22, a90
  v_accvgpr_read_b32 v23, a91
  v_pk_mul_f32 v[16:17], v[16:17], v[200:201] op_sel_hi:[1,0]
  v_pk_mul_f32 v[18:19], v[18:19], v[200:201] op_sel_hi:[1,0]
  v_pk_mul_f32 v[20:21], v[20:21], v[200:201] op_sel_hi:[1,0]
  v_pk_mul_f32 v[22:23], v[22:23], v[200:201] op_sel_hi:[1,0]
  v_cvt_pk_bf16_f32 v16, v16, v17
  v_cvt_pk_bf16_f32 v17, v18, v19
  v_cvt_pk_bf16_f32 v18, v20, v21
  v_cvt_pk_bf16_f32 v19, v22, v23
  buffer_store_dwordx4 v[16:19], v244, s[24:27], s43 offen offset:0 sc1
  v_accvgpr_read_b32 v24, a76
  v_accvgpr_read_b32 v25, a77
  v_accvgpr_read_b32 v26, a78
  v_accvgpr_read_b32 v27, a79
  v_accvgpr_read_b32 v28, a92
  v_accvgpr_read_b32 v29, a93
  v_accvgpr_read_b32 v30, a94
  v_accvgpr_read_b32 v31, a95
  v_pk_mul_f32 v[24:25], v[24:25], v[204:205] op_sel_hi:[1,0]
  v_pk_mul_f32 v[26:27], v[26:27], v[204:205] op_sel_hi:[1,0]
  v_pk_mul_f32 v[28:29], v[28:29], v[204:205] op_sel_hi:[1,0]
  v_pk_mul_f32 v[30:31], v[30:31], v[204:205] op_sel_hi:[1,0]
  v_cvt_pk_bf16_f32 v24, v24, v25
  v_cvt_pk_bf16_f32 v25, v26, v27
  v_cvt_pk_bf16_f32 v26, v28, v29
  v_cvt_pk_bf16_f32 v27, v30, v31
  buffer_store_dwordx4 v[24:27], v244, s[24:27], s43 offen offset:2048 sc1
  v_accvgpr_read_b32 v32, a96
  v_accvgpr_read_b32 v33, a97
  v_accvgpr_read_b32 v34, a98
  v_accvgpr_read_b32 v35, a99
  v_accvgpr_read_b32 v36, a112
  v_accvgpr_read_b32 v37, a113
  v_accvgpr_read_b32 v38, a114
  v_accvgpr_read_b32 v39, a115
  v_pk_mul_f32 v[32:33], v[32:33], v[192:193] op_sel_hi:[1,0]
  v_pk_mul_f32 v[34:35], v[34:35], v[192:193] op_sel_hi:[1,0]
  v_pk_mul_f32 v[36:37], v[36:37], v[192:193] op_sel_hi:[1,0]
  v_pk_mul_f32 v[38:39], v[38:39], v[192:193] op_sel_hi:[1,0]
  v_cvt_pk_bf16_f32 v32, v32, v33
  v_cvt_pk_bf16_f32 v33, v34, v35
  v_cvt_pk_bf16_f32 v34, v36, v37
  v_cvt_pk_bf16_f32 v35, v38, v39
  buffer_store_dwordx4 v[32:35], v244, s[24:27], s42 offen offset:1024 sc1
  v_accvgpr_read_b32 v40, a100
  v_accvgpr_read_b32 v41, a101
  v_accvgpr_read_b32 v42, a102
  v_accvgpr_read_b32 v43, a103
  v_accvgpr_read_b32 v44, a116
  v_accvgpr_read_b32 v45, a117
  v_accvgpr_read_b32 v46, a118
  v_accvgpr_read_b32 v47, a119
  v_pk_mul_f32 v[40:41], v[40:41], v[196:197] op_sel_hi:[1,0]
  v_pk_mul_f32 v[42:43], v[42:43], v[196:197] op_sel_hi:[1,0]
  v_pk_mul_f32 v[44:45], v[44:45], v[196:197] op_sel_hi:[1,0]
  v_pk_mul_f32 v[46:47], v[46:47], v[196:197] op_sel_hi:[1,0]
  v_cvt_pk_bf16_f32 v40, v40, v41
  v_cvt_pk_bf16_f32 v41, v42, v43
  v_cvt_pk_bf16_f32 v42, v44, v45
  v_cvt_pk_bf16_f32 v43, v46, v47
  buffer_store_dwordx4 v[40:43], v244, s[24:27], s42 offen offset:3072 sc1
  v_accvgpr_read_b32 v48, a104
  v_accvgpr_read_b32 v49, a105
  v_accvgpr_read_b32 v50, a106
  v_accvgpr_read_b32 v51, a107
  v_accvgpr_read_b32 v52, a120
  v_accvgpr_read_b32 v53, a121
  v_accvgpr_read_b32 v54, a122
  v_accvgpr_read_b32 v55, a123
  v_pk_mul_f32 v[48:49], v[48:49], v[200:201] op_sel_hi:[1,0]
  v_pk_mul_f32 v[50:51], v[50:51], v[200:201] op_sel_hi:[1,0]
  v_pk_mul_f32 v[52:53], v[52:53], v[200:201] op_sel_hi:[1,0]
  v_pk_mul_f32 v[54:55], v[54:55], v[200:201] op_sel_hi:[1,0]
  v_cvt_pk_bf16_f32 v48, v48, v49
  v_cvt_pk_bf16_f32 v49, v50, v51
  v_cvt_pk_bf16_f32 v50, v52, v53
  v_cvt_pk_bf16_f32 v51, v54, v55
  buffer_store_dwordx4 v[48:51], v244, s[24:27], s43 offen offset:1024 sc1
  v_accvgpr_read_b32 v56, a108
  v_accvgpr_read_b32 v57, a109
  v_accvgpr_read_b32 v58, a110
  v_accvgpr_read_b32 v59, a111
  v_accvgpr_read_b32 v60, a124
  v_accvgpr_read_b32 v61, a125
  v_accvgpr_read_b32 v62, a126
  v_accvgpr_read_b32 v63, a127
  v_pk_mul_f32 v[56:57], v[56:57], v[204:205] op_sel_hi:[1,0]
  v_pk_mul_f32 v[58:59], v[58:59], v[204:205] op_sel_hi:[1,0]
  v_pk_mul_f32 v[60:61], v[60:61], v[204:205] op_sel_hi:[1,0]
  v_pk_mul_f32 v[62:63], v[62:63], v[204:205] op_sel_hi:[1,0]
  v_cvt_pk_bf16_f32 v56, v56, v57
  v_cvt_pk_bf16_f32 v57, v58, v59
  v_cvt_pk_bf16_f32 v58, v60, v61
  v_cvt_pk_bf16_f32 v59, v62, v63
  buffer_store_dwordx4 v[56:59], v244, s[24:27], s43 offen offset:3072 sc1
  ds_write_b32 v247, v245
  buffer_load_dwordx4 a[0:3], v252, s[24:27], s5 offen offset:3072 sc1
  buffer_load_dwordx4 a[4:7], v253, s[24:27], s5 offen offset:0 sc1
  buffer_load_dwordx4 a[8:11], v253, s[24:27], s5 offen offset:1024 sc1
  buffer_load_dwordx4 a[12:15], v253, s[24:27], s5 offen offset:2048 sc1
  buffer_load_dwordx4 a[16:19], v253, s[24:27], s5 offen offset:3072 sc1
  buffer_load_dwordx4 a[20:23], v242, s[24:27], s6 offen offset:0 sc1
  buffer_load_dwordx4 a[24:27], v242, s[24:27], s6 offen offset:1024 sc1
  buffer_load_dwordx4 a[28:31], v242, s[24:27], s6 offen offset:2048 sc1
  buffer_load_dwordx4 a[32:35], v242, s[24:27], s6 offen offset:3072 sc1
  buffer_load_dwordx4 a[36:39], v252, s[24:27], s6 offen offset:0 sc1
  buffer_load_dwordx4 a[40:43], v252, s[24:27], s6 offen offset:1024 sc1
  buffer_load_dwordx4 a[44:47], v252, s[24:27], s6 offen offset:2048 sc1
  buffer_load_dwordx4 a[48:51], v252, s[24:27], s6 offen offset:3072 sc1
  buffer_load_dwordx4 a[52:55], v253, s[24:27], s6 offen offset:0 sc1
  s_bfe_u32 s39, s2, 0x40002
  s_lshl_b32 s39, s39, 8
  s_add_u32 s39, s39, 2818304
  s_lshl_b32 s38, s3, 26
  v_lshlrev_b32 v64, 22, v242
  v_or_b32 v64, s38, v64
  v_mov_b32 v65, 1
  v_add_u32 v246, 157696, v242
  s_waitcnt vmcnt(14) lgkmcnt(0)
  s_barrier
  ds_read_b128 v[68:71], v246
  s_waitcnt lgkmcnt(0)
  v_or3_b32 v68, v68, v69, v70
  v_or_b32 v68, v68, v71
  v_cmp_ne_u32 vcc, 0, v68
  s_nop 0
  s_cbranch_vccnz attn_redo
tail_go:
  buffer_atomic_add v65, v64, s[24:27], s39 offen
  s_and_b32 s36, s2, 1
  s_bfe_u32 s31, s2, 0x20001
  s_lshl_b32 s31, s31, 2
  s_bfe_u32 s38, s2, 0x20003
  s_add_u32 s31, s31, s38
  s_lshr_b32 s29, s2, 5
  v_mov_b32 v114, v242
  v_add_u32 v115, 0x1000, v114
  v_add_u32 v116, 0x2000, v114
  s_lshl_b32 s38, s36, 2
  s_add_u32 s38, s38, s3
  s_lshl_b32 s30, s38, 16
  buffer_load_dwordx4 a[56:59], v116, s[24:27], s6 offen offset:1024 sc1
  buffer_load_dwordx4 a[60:63], v116, s[24:27], s6 offen offset:2048 sc1
  buffer_load_dwordx4 a[64:67], v116, s[24:27], s6 offen offset:3072 sc1
  buffer_load_dwordx4 a[68:71], v114, s[24:27], s7 offen offset:0 sc1
  buffer_load_dwordx4 a[72:75], v114, s[24:27], s7 offen offset:1024 sc1
  buffer_load_dwordx4 a[76:79], v114, s[24:27], s7 offen offset:2048 sc1
  buffer_load_dwordx4 a[80:83], v114, s[24:27], s7 offen offset:3072 sc1
  buffer_load_dwordx4 a[84:87], v115, s[24:27], s7 offen offset:0 sc1
  buffer_load_dwordx4 a[88:91], v115, s[24:27], s7 offen offset:1024 sc1
  buffer_load_dwordx4 a[92:95], v115, s[24:27], s7 offen offset:2048 sc1
  buffer_load_dwordx4 a[96:99], v115, s[24:27], s7 offen offset:3072 sc1
  buffer_load_dwordx4 a[100:103], v116, s[24:27], s7 offen offset:0 sc1
  v_lshrrev_b32 v125, 4, v114
  v_and_b32 v126, 15, v125
  v_lshrrev_b32 v127, 4, v125
  s_add_u32 s38, s3, 0
  s_and_b32 s38, s38, 3
  s_lshl_b32 s38, s38, 11
  v_add_u32 v110, s38, v114
  s_sub_u32 s38, s3, 0
  s_and_b32 s38, s38, 3
  s_mul_i32 s38, s38, 15360
  s_add_u32 s38, s38, 98304
  v_add_u32 v118, s38, v114
  s_add_u32 s38, s3, 1
  s_and_b32 s38, s38, 3
  s_lshl_b32 s38, s38, 11
  v_add_u32 v111, s38, v114
  s_sub_u32 s38, s3, 1
  s_and_b32 s38, s38, 3
  s_mul_i32 s38, s38, 15360
  s_add_u32 s38, s38, 98304
  v_add_u32 v119, s38, v114
  s_add_u32 s38, s3, 2
  s_and_b32 s38, s38, 3
  s_lshl_b32 s38, s38, 11
  v_add_u32 v112, s38, v114
  s_sub_u32 s38, s3, 2
  s_and_b32 s38, s38, 3
  s_mul_i32 s38, s38, 15360
  s_add_u32 s38, s38, 98304
  v_add_u32 v120, s38, v114
  s_add_u32 s38, s3, 3
  s_and_b32 s38, s38, 3
  s_lshl_b32 s38, s38, 11
  v_add_u32 v113, s38, v114
  s_sub_u32 s38, s3, 3
  s_and_b32 s38, s38, 3
  s_mul_i32 s38, s38, 15360
  s_add_u32 s38, s38, 98304
  v_add_u32 v121, s38, v114
  v_add_u32 v122, s28, v114
  v_add_u32 v135, 0x10000, v122
  s_and_b32 s38, s31, 14
  s_add_u32 s38, s38, s36
  s_lshl_b32 s38, s38, 8
  s_add_u32 s38, s38, 2818304
  s_lshl_b32 s39, s29, 8
  s_add_u32 s39, s39, 2822400
  v_mov_b32 v133, s38
  v_writelane_b32 v133, s39, 1
  v_mov_b32 v134, 16
  v_writelane_b32 v134, 30, 1
  s_lshl_b32 s31, s31, 1
  s_add_u32 s31, s31, s36
  s_add_u32 s30, s30, 8388608
  s_lshl_b32 s38, s31, 19
  s_add_u32 s37, s30, s38
  s_xor_b32 s38, s38, 0x80000
  s_add_u32 s30, s30, s38
  s_lshl_b32 s40, s29, 5
  s_add_u32 s40, s40, s31
  s_lshl_b32 s38, s31, 6
  s_lshl_b32 s39, s3, 4
  s_add_u32 s38, s38, s39
  v_add_u32 v128, s38, v126
  v_mul_u32_u24 v117, 0x500, v128
  v_lshl_add_u32 v117, v127, 3, v117
  s_mul_i32 s38, s29, 160
  v_add_u32 v117, s38, v117
  s_mov_b32 s12, s60
  s_mov_b32 s13, s61
  s_mov_b32 s14, 2621440
  s_mov_b32 s15, 0x20000
  s_mov_b32 s16, s62
  s_mov_b32 s17, s63
  s_mov_b32 s18, 2621440
  s_mov_b32 s19, 0x20000
  s_mul_i32 s38, s31, 81920
  s_lshl_b32 s39, s3, 10
  s_add_u32 s38, s38, s39
  s_mul_i32 s39, s29, 10
  v_lshrrev_b32 v129, 1, v127
  v_add_u32 v129, s39, v129
  v_and_b32 v130, 1, v127
  v_lshlrev_b32 v130, 3, v130
  v_lshl_add_u32 v130, v126, 4, v130
  v_lshrrev_b32 v131, 2, v129
  v_lshl_add_u32 v131, v131, 12, v130
  v_and_b32 v132, 3, v129
  v_lshl_add_u32 v131, v132, 8, v131
  buffer_load_dwordx2 v[156:157], v131, s[24:27], s38 offen sc1
  v_add_u32 v129, 2, v129
  buffer_load_dwordx2 v[80:81], v117, s[12:15], 0 offen offset:0
  v_lshrrev_b32 v131, 2, v129
  v_lshl_add_u32 v131, v131, 12, v130
  v_and_b32 v132, 3, v129
  v_lshl_add_u32 v131, v132, 8, v131
  buffer_load_dwordx2 v[158:159], v131, s[24:27], s38 offen sc1
  v_add_u32 v129, 2, v129
  buffer_load_dwordx2 v[82:83], v117, s[12:15], 0 offen offset:32
  v_lshrrev_b32 v131, 2, v129
  v_lshl_add_u32 v131, v131, 12, v130
  v_and_b32 v132, 3, v129
  v_lshl_add_u32 v131, v132, 8, v131
  buffer_load_dwordx2 v[160:161], v131, s[24:27], s38 offen sc1
  v_add_u32 v129, 2, v129
  buffer_load_dwordx2 v[84:85], v117, s[12:15], 0 offen offset:64
  v_lshrrev_b32 v131, 2, v129
  v_lshl_add_u32 v131, v131, 12, v130
  v_and_b32 v132, 3, v129
  v_lshl_add_u32 v131, v132, 8, v131
  buffer_load_dwordx2 v[162:163], v131, s[24:27], s38 offen sc1
  v_add_u32 v129, 2, v129
  buffer_load_dwordx2 v[86:87], v117, s[12:15], 0 offen offset:96
  v_lshrrev_b32 v131, 2, v129
  v_lshl_add_u32 v131, v131, 12, v130
  v_and_b32 v132, 3, v129
  v_lshl_add_u32 v131, v132, 8, v131
  buffer_load_dwordx2 v[164:165], v131, s[24:27], s38 offen sc1
  v_add_u32 v129, 2, v129
  buffer_load_dwordx2 v[88:89], v117, s[12:15], 0 offen offset:128
  v_mov_b32 v123, 1073741824
  v_bfrev_b32 v124, 1
  v_sub_u32 v128, 0xffff, v128
  s_mov_b32 s34, 0xffff0000
  s_and_b32 s38, s52, 0xffff
  v_cmp_eq_u32 vcc, s38, v128
  v_mov_b32 v129, s52
  v_mov_b32 v130, 0
  v_cndmask_b32 v124, v124, v129, vcc
  v_cndmask_b32 v123, v123, v130, vcc
  s_and_b32 s38, s53, 0xffff
  v_cmp_eq_u32 vcc, s38, v128
  v_mov_b32 v129, s53
  v_mov_b32 v130, 2560
  v_cndmask_b32 v124, v124, v129, vcc
  v_cndmask_b32 v123, v123, v130, vcc
  s_and_b32 s38, s54, 0xffff
  v_cmp_eq_u32 vcc, s38, v128
  v_mov_b32 v129, s54
  v_mov_b32 v130, 5120
  v_cndmask_b32 v124, v124, v129, vcc
  v_cndmask_b32 v123, v123, v130, vcc
  s_and_b32 s38, s55, 0xffff
  v_cmp_eq_u32 vcc, s38, v128
  v_mov_b32 v129, s55
  v_mov_b32 v130, 7680
  v_cndmask_b32 v124, v124, v129, vcc
  v_cndmask_b32 v123, v123, v130, vcc
  s_and_b32 s38, s56, 0xffff
  v_cmp_eq_u32 vcc, s38, v128
  v_mov_b32 v129, s56
  v_mov_b32 v130, 10240
  v_cndmask_b32 v124, v124, v129, vcc
  v_cndmask_b32 v123, v123, v130, vcc
  s_and_b32 s38, s57, 0xffff
  v_cmp_eq_u32 vcc, s38, v128
  v_mov_b32 v129, s57
  v_mov_b32 v130, 12800
  v_cndmask_b32 v124, v124, v129, vcc
  v_cndmask_b32 v123, v123, v130, vcc
  s_and_b32 s38, s58, 0xffff
  v_cmp_eq_u32 vcc, s38, v128
  v_mov_b32 v129, s58
  v_mov_b32 v130, 15360
  v_cndmask_b32 v124, v124, v129, vcc
  v_cndmask_b32 v123, v123, v130, vcc
  s_and_b32 s38, s59, 0xffff
  v_cmp_eq_u32 vcc, s38, v128
  v_mov_b32 v129, s59
  v_mov_b32 v130, 17920
  v_cndmask_b32 v124, v124, v129, vcc
  v_cndmask_b32 v123, v123, v130, vcc
  v_lshl_add_u32 v123, v127, 4, v123
  s_mul_i32 s32, s29, 320
  s_add_u32 s32, s32, 2686976
  v_ashrrev_i32 v129, 31, v124
  v_not_b32 v129, v129
  v_or_b32 v129, 0x80000000, v129
  v_xor_b32 v124, v124, v129
  v_and_b32 v124, s34, v124
  v_mul_f32 v124, 0xbfb8aa3b, v124
  v_exp_f32 v124, v124
  s_nop 0
  v_add_f32 v124, 1.0, v124
  v_rcp_f32 v124, v124
  s_nop 0
  v_cvt_pk_bf16_f32 v124, v124, v124
  v_lshlrev_b32 v124, 16, v124
  s_xor_b32 s38, s40, 0
  s_lshl_b32 s38, s38, 2
  s_add_u32 s38, s38, s3
  s_lshl_b32 s38, s38, 13
  s_add_u32 s38, s38, 25165824
  s_add_u32 s39, s38, 4096
  buffer_load_dword v127, off, s[24:27], s39 offset:2048
  s_xor_b32 s38, s40, 1
  s_lshl_b32 s38, s38, 2
  s_add_u32 s38, s38, s3
  s_lshl_b32 s38, s38, 13
  s_add_u32 s38, s38, 25165824
  s_add_u32 s39, s38, 4096
  buffer_load_dword v127, off, s[24:27], s39 offset:2048
  buffer_load_dword v128, v133, s[24:27], 0 offen sc1
  buffer_load_dwordx4 a[104:107], v116, s[24:27], s7 offen offset:1024 sc1
  buffer_load_dwordx4 a[108:111], v116, s[24:27], s7 offen offset:2048 sc1
  buffer_load_dwordx4 a[112:115], v116, s[24:27], s7 offen offset:3072 sc1
  buffer_load_dwordx4 a[116:119], v114, s[24:27], s8 offen offset:0 sc1
  buffer_load_dwordx4 a[120:123], v114, s[24:27], s8 offen offset:1024 sc1
  buffer_load_dwordx4 a[124:127], v114, s[24:27], s8 offen offset:2048 sc1
  buffer_load_dwordx4 a[160:163], v114, s[24:27], s8 offen offset:3072 sc1
  buffer_load_dwordx4 a[164:167], v115, s[24:27], s8 offen offset:0 sc1
  buffer_load_dwordx4 a[168:171], v115, s[24:27], s8 offen offset:1024 sc1
  buffer_load_dwordx4 a[172:175], v115, s[24:27], s8 offen offset:2048 sc1
  buffer_load_dwordx4 a[176:179], v115, s[24:27], s8 offen offset:3072 sc1
  s_add_u32 m0, s28, 49152
  s_nop 0
  buffer_load_dwordx4 v115, s[24:27], s10 offen offset:0 sc1 lds
  buffer_load_dwordx4 v115, s[24:27], s10 offen offset:1024 sc1 lds
  buffer_load_dwordx4 v115, s[24:27], s10 offen offset:2048 sc1 lds
  buffer_load_dwordx4 v115, s[24:27], s10 offen offset:3072 sc1 lds
  s_waitcnt vmcnt(27)
  v_lshlrev_b32 v90, 16, v156
  v_and_b32 v91, s34, v156
  v_lshlrev_b32 v92, 16, v157
  v_and_b32 v93, s34, v157
  s_waitcnt vmcnt(25)
  v_lshlrev_b32 v94, 16, v158
  v_and_b32 v95, s34, v158
  v_lshlrev_b32 v96, 16, v159
  v_and_b32 v97, s34, v159
  s_waitcnt vmcnt(23)
  v_lshlrev_b32 v98, 16, v160
  v_and_b32 v99, s34, v160
  v_lshlrev_b32 v100, 16, v161
  v_and_b32 v101, s34, v161
  s_waitcnt vmcnt(21)
  v_lshlrev_b32 v102, 16, v162
  v_and_b32 v103, s34, v162
  v_lshlrev_b32 v104, 16, v163
  v_and_b32 v105, s34, v163
  s_waitcnt vmcnt(19)
  v_lshlrev_b32 v106, 16, v164
  v_and_b32 v107, s34, v164
  v_lshlrev_b32 v108, 16, v165
  v_and_b32 v109, s34, v165
  v_mov_b32 v156, 0
  v_mov_b32 v157, 0
  v_mov_b32 v158, 0
  v_mov_b32 v159, 0
  v_mov_b32 v160, 0
  v_mov_b32 v161, 0
  v_mov_b32 v162, 0
  v_mov_b32 v163, 0
  v_mov_b32 v164, 0
  v_mov_b32 v165, 0
  v_mov_b32 v166, 0
  v_mov_b32 v167, 0
  v_mov_b32 v168, 0
  v_mov_b32 v169, 0
  v_mov_b32 v170, 0
  v_mov_b32 v171, 0
  v_mov_b32 v172, 0
  v_mov_b32 v173, 0
  v_mov_b32 v174, 0
  v_mov_b32 v175, 0
  s_waitcnt vmcnt(15)
  v_cmp_lt_u32 vcc, v128, v134
  s_nop 0
  s_cbranch_vccz tail_ready
  s_mov_b32 s35, 32768
tail_spin:
  s_sleep 2
  buffer_load_dword v128, v133, s[24:27], 0 offen sc1
  s_waitcnt vmcnt(0)
  v_cmp_lt_u32 vcc, v128, v134
  s_nop 0
  s_cbranch_vccz tail_ready
  s_sub_u32 s35, s35, 1
  s_cmp_lg_u32 s35, 0
  s_cbranch_scc1 tail_spin
tail_ready:
  buffer_load_dwordx4 a[180:183], v110, s[24:27], s30 offen offset:0 sc1
  buffer_load_dwordx4 a[184:187], v110, s[24:27], s30 offen offset:1024 sc1
  buffer_load_dwordx4 a[188:191], v111, s[24:27], s30 offen offset:0 sc1
  buffer_load_dwordx4 a[192:195], v111, s[24:27], s30 offen offset:1024 sc1
  buffer_load_dwordx4 a[196:199], v112, s[24:27], s30 offen offset:0 sc1
  buffer_load_dwordx4 a[200:203], v112, s[24:27], s30 offen offset:1024 sc1
  buffer_load_dwordx4 a[204:207], v113, s[24:27], s30 offen offset:0 sc1
  buffer_load_dwordx4 a[208:211], v113, s[24:27], s30 offen offset:1024 sc1
  s_add_u32 s30, s30, 8192
  buffer_load_dwordx4 v[176:179], v110, s[24:27], s30 offen offset:0 sc1
  buffer_load_dwordx4 v[180:183], v110, s[24:27], s30 offen offset:1024 sc1
  buffer_load_dwordx4 v[184:187], v111, s[24:27], s30 offen offset:0 sc1
  buffer_load_dwordx4 v[188:191], v111, s[24:27], s30 offen offset:1024 sc1
  v_cmp_gt_u32 vcc, 1073741824, v123
  s_nop 0
  s_and_saveexec_b64 s[42:43], vcc
  s_cbranch_execz tail_plain
  s_waitcnt vmcnt(30)
  buffer_load_dwordx4 v[156:159], v123, s[24:27], s32 offen offset:0 sc1
  buffer_load_dwordx4 v[160:163], v123, s[24:27], s32 offen offset:64 sc1
  buffer_load_dwordx4 v[164:167], v123, s[24:27], s32 offen offset:128 sc1
  buffer_load_dwordx4 v[168:171], v123, s[24:27], s32 offen offset:192 sc1
  buffer_load_dwordx4 v[172:175], v123, s[24:27], s32 offen offset:256 sc1
  s_add_u32 s32, s32, 20480
  buffer_load_dwordx4 v[136:139], v123, s[24:27], s32 offen offset:0 sc1
  buffer_load_dwordx4 v[140:143], v123, s[24:27], s32 offen offset:64 sc1
  buffer_load_dwordx4 v[144:147], v123, s[24:27], s32 offen offset:128 sc1
  buffer_load_dwordx4 v[148:151], v123, s[24:27], s32 offen offset:192 sc1
  buffer_load_dwordx4 v[152:155], v123, s[24:27], s32 offen offset:256 sc1
  s_add_u32 s32, s32, 20480
  buffer_load_dwordx4 v[0:3], v123, s[24:27], s32 offen offset:0 sc1
  buffer_load_dwordx4 v[4:7], v123, s[24:27], s32 offen offset:64 sc1
  buffer_load_dwordx4 v[8:11], v123, s[24:27], s32 offen offset:128 sc1
  buffer_load_dwordx4 v[12:15], v123, s[24:27], s32 offen offset:192 sc1
  buffer_load_dwordx4 v[16:19], v123, s[24:27], s32 offen offset:256 sc1
  s_add_u32 s32, s32, 20480
  buffer_load_dwordx4 v[20:23], v123, s[24:27], s32 offen offset:0 sc1
  buffer_load_dwordx4 v[24:27], v123, s[24:27], s32 offen offset:64 sc1
  buffer_load_dwordx4 v[28:31], v123, s[24:27], s32 offen offset:128 sc1
  buffer_load_dwordx4 v[32:35], v123, s[24:27], s32 offen offset:192 sc1
  buffer_load_dwordx4 v[36:39], v123, s[24:27], s32 offen offset:256 sc1
  s_add_u32 s32, s32, 20480
  buffer_load_dwordx4 v[40:43], v123, s[24:27], s32 offen offset:0 sc1
  buffer_load_dwordx4 v[44:47], v123, s[24:27], s32 offen offset:64 sc1
  buffer_load_dwordx4 v[48:51], v123, s[24:27], s32 offen offset:128 sc1
  buffer_load_dwordx4 v[52:55], v123, s[24:27], s32 offen offset:192 sc1
  buffer_load_dwordx4 v[56:59], v123, s[24:27], s32 offen offset:256 sc1
  s_add_u32 s32, s32, 20480
  buffer_load_dwordx4 v[60:63], v123, s[24:27], s32 offen offset:0 sc1
  buffer_load_dwordx4 v[64:67], v123, s[24:27], s32 offen offset:64 sc1
  buffer_load_dwordx4 v[68:71], v123, s[24:27], s32 offen offset:128 sc1
  buffer_load_dwordx4 v[72:75], v123, s[24:27], s32 offen offset:192 sc1
  buffer_load_dwordx4 v[76:79], v123, s[24:27], s32 offen offset:256 sc1
  s_add_u32 s32, s32, 20480
  s_waitcnt vmcnt(0)
  v_add_f32 v156, v156, v136
  v_add_f32 v157, v157, v137
  v_add_f32 v158, v158, v138
  v_add_f32 v159, v159, v139
  v_add_f32 v160, v160, v140
  v_add_f32 v161, v161, v141
  v_add_f32 v162, v162, v142
  v_add_f32 v163, v163, v143
  v_add_f32 v164, v164, v144
  v_add_f32 v165, v165, v145
  v_add_f32 v166, v166, v146
  v_add_f32 v167, v167, v147
  v_add_f32 v168, v168, v148
  v_add_f32 v169, v169, v149
  v_add_f32 v170, v170, v150
  v_add_f32 v171, v171, v151
  v_add_f32 v172, v172, v152
  v_add_f32 v173, v173, v153
  v_add_f32 v174, v174, v154
  v_add_f32 v175, v175, v155
  v_add_f32 v156, v156, v0
  v_add_f32 v157, v157, v1
  v_add_f32 v158, v158, v2
  v_add_f32 v159, v159, v3
  v_add_f32 v160, v160, v4
  v_add_f32 v161, v161, v5
  v_add_f32 v162, v162, v6
  v_add_f32 v163, v163, v7
  v_add_f32 v164, v164, v8
  v_add_f32 v165, v165, v9
  v_add_f32 v166, v166, v10
  v_add_f32 v167, v167, v11
  v_add_f32 v168, v168, v12
  v_add_f32 v169, v169, v13
  v_add_f32 v170, v170, v14
  v_add_f32 v171, v171, v15
  v_add_f32 v172, v172, v16
  v_add_f32 v173, v173, v17
  v_add_f32 v174, v174, v18
  v_add_f32 v175, v175, v19
  v_add_f32 v156, v156, v20
  v_add_f32 v157, v157, v21
  v_add_f32 v158, v158, v22
  v_add_f32 v159, v159, v23
  v_add_f32 v160, v160, v24
  v_add_f32 v161, v161, v25
  v_add_f32 v162, v162, v26
  v_add_f32 v163, v163, v27
  v_add_f32 v164, v164, v28
  v_add_f32 v165, v165, v29
  v_add_f32 v166, v166, v30
  v_add_f32 v167, v167, v31
  v_add_f32 v168, v168, v32
  v_add_f32 v169, v169, v33
  v_add_f32 v170, v170, v34
  v_add_f32 v171, v171, v35
  v_add_f32 v172, v172, v36
  v_add_f32 v173, v173, v37
  v_add_f32 v174, v174, v38
  v_add_f32 v175, v175, v39
  v_add_f32 v156, v156, v40
  v_add_f32 v157, v157, v41
  v_add_f32 v158, v158, v42
  v_add_f32 v159, v159, v43
  v_add_f32 v160, v160, v44
  v_add_f32 v161, v161, v45
  v_add_f32 v162, v162, v46
  v_add_f32 v163, v163, v47
  v_add_f32 v164, v164, v48
  v_add_f32 v165, v165, v49
  v_add_f32 v166, v166, v50
  v_add_f32 v167, v167, v51
  v_add_f32 v168, v168, v52
  v_add_f32 v169, v169, v53
  v_add_f32 v170, v170, v54
  v_add_f32 v171, v171, v55
  v_add_f32 v172, v172, v56
  v_add_f32 v173, v173, v57
  v_add_f32 v174, v174, v58
  v_add_f32 v175, v175, v59
  v_add_f32 v156, v156, v60
  v_add_f32 v157, v157, v61
  v_add_f32 v158, v158, v62
  v_add_f32 v159, v159, v63
  v_add_f32 v160, v160, v64
  v_add_f32 v161, v161, v65
  v_add_f32 v162, v162, v66
  v_add_f32 v163, v163, v67
  v_add_f32 v164, v164, v68
  v_add_f32 v165, v165, v69
  v_add_f32 v166, v166, v70
  v_add_f32 v167, v167, v71
  v_add_f32 v168, v168, v72
  v_add_f32 v169, v169, v73
  v_add_f32 v170, v170, v74
  v_add_f32 v171, v171, v75
  v_add_f32 v172, v172, v76
  v_add_f32 v173, v173, v77
  v_add_f32 v174, v174, v78
  v_add_f32 v175, v175, v79
tail_plain:
  s_mov_b64 exec, s[42:43]
  s_waitcnt vmcnt(4)
  v_mfma_f32_16x16x32_bf16 v[0:3], a[212:215], a[180:183], 0
  buffer_load_dwordx4 v[192:195], v112, s[24:27], s30 offen offset:0 sc1
  v_mfma_f32_16x16x32_bf16 v[0:3], a[232:235], a[184:187], v[0:3]
  v_cvt_pk_bf16_f32 v156, v156, v156
  v_cvt_pk_bf16_f32 v157, v157, v157
  v_mfma_f32_16x16x32_bf16 v[4:7], a[232:235], a[192:195], 0
  v_cvt_pk_bf16_f32 v158, v158, v158
  v_cvt_pk_bf16_f32 v159, v159, v159
  v_mfma_f32_16x16x32_bf16 v[4:7], a[212:215], a[188:191], v[4:7]
  v_lshlrev_b32 v156, 16, v156
  v_lshlrev_b32 v157, 16, v157
  v_mfma_f32_16x16x32_bf16 v[8:11], a[212:215], a[196:199], 0
  buffer_load_dwordx4 v[196:199], v112, s[24:27], s30 offen offset:1024 sc1
  v_mfma_f32_16x16x32_bf16 v[8:11], a[232:235], a[200:203], v[8:11]
  v_lshlrev_b32 v158, 16, v158
  v_lshlrev_b32 v159, 16, v159
  v_mfma_f32_16x16x32_bf16 v[12:15], a[232:235], a[208:211], 0
  v_mul_f32 v156, v156, v124
  v_mul_f32 v157, v157, v124
  v_mfma_f32_16x16x32_bf16 v[12:15], a[212:215], a[204:207], v[12:15]
  v_mul_f32 v158, v158, v124
  v_mul_f32 v159, v159, v124
  v_mfma_f32_16x16x32_bf16 v[16:19], a[216:219], a[180:183], 0
  buffer_load_dwordx4 v[200:203], v113, s[24:27], s30 offen offset:0 sc1
  v_mfma_f32_16x16x32_bf16 v[16:19], a[236:239], a[184:187], v[16:19]
  v_cvt_pk_bf16_f32 v156, v156, v156
  v_cvt_pk_bf16_f32 v157, v157, v157
  v_mfma_f32_16x16x32_bf16 v[20:23], a[236:239], a[192:195], 0
  v_cvt_pk_bf16_f32 v158, v158, v158
  v_cvt_pk_bf16_f32 v159, v159, v159
  v_mfma_f32_16x16x32_bf16 v[20:23], a[216:219], a[188:191], v[20:23]
  v_lshlrev_b32 v156, 16, v156
  v_lshlrev_b32 v157, 16, v157
  v_mfma_f32_16x16x32_bf16 v[24:27], a[216:219], a[196:199], 0
  buffer_load_dwordx4 v[204:207], v113, s[24:27], s30 offen offset:1024 sc1
  v_mfma_f32_16x16x32_bf16 v[24:27], a[236:239], a[200:203], v[24:27]
  v_lshlrev_b32 v158, 16, v158
  v_lshlrev_b32 v159, 16, v159
  v_mfma_f32_16x16x32_bf16 v[28:31], a[236:239], a[208:211], 0
  v_add_f32 v90, v90, v156
  v_add_f32 v91, v91, v157
  v_mfma_f32_16x16x32_bf16 v[28:31], a[216:219], a[204:207], v[28:31]
  v_add_f32 v92, v92, v158
  v_add_f32 v93, v93, v159
  v_mfma_f32_16x16x32_bf16 v[32:35], a[220:223], a[180:183], 0
  s_add_u32 s30, s30, 8192
  buffer_load_dwordx4 v[208:211], v110, s[24:27], s30 offen offset:0 sc1
  v_mfma_f32_16x16x32_bf16 v[32:35], a[240:243], a[184:187], v[32:35]
  v_cvt_pk_bf16_f32 v90, v90, v90
  v_cvt_pk_bf16_f32 v91, v91, v91
  v_mfma_f32_16x16x32_bf16 v[36:39], a[240:243], a[192:195], 0
  v_cvt_pk_bf16_f32 v92, v92, v92
  v_cvt_pk_bf16_f32 v93, v93, v93
  v_mfma_f32_16x16x32_bf16 v[36:39], a[220:223], a[188:191], v[36:39]
  v_lshlrev_b32 v90, 16, v90
  v_lshlrev_b32 v91, 16, v91
  v_mfma_f32_16x16x32_bf16 v[40:43], a[220:223], a[196:199], 0
  buffer_load_dwordx4 v[212:215], v110, s[24:27], s30 offen offset:1024 sc1
  v_mfma_f32_16x16x32_bf16 v[40:43], a[240:243], a[200:203], v[40:43]
  v_lshlrev_b32 v92, 16, v92
  v_lshlrev_b32 v93, 16, v93
  v_mfma_f32_16x16x32_bf16 v[44:47], a[240:243], a[208:211], 0
  v_mul_f32 v129, 0xbfb8aa3b, v90
  v_mul_f32 v130, 0xbfb8aa3b, v91
  v_mfma_f32_16x16x32_bf16 v[44:47], a[220:223], a[204:207], v[44:47]
  v_mul_f32 v131, 0xbfb8aa3b, v92
  v_mul_f32 v132, 0xbfb8aa3b, v93
  v_mfma_f32_16x16x32_bf16 v[48:51], a[224:227], a[180:183], 0
  buffer_load_dwordx4 v[216:219], v111, s[24:27], s30 offen offset:0 sc1
  v_mfma_f32_16x16x32_bf16 v[48:51], a[244:247], a[184:187], v[48:51]
  v_exp_f32 v129, v129
  v_mfma_f32_16x16x32_bf16 v[52:55], a[244:247], a[192:195], 0
  v_exp_f32 v130, v130
  v_mfma_f32_16x16x32_bf16 v[52:55], a[224:227], a[188:191], v[52:55]
  v_exp_f32 v131, v131
  v_mfma_f32_16x16x32_bf16 v[56:59], a[224:227], a[196:199], 0
  buffer_load_dwordx4 v[220:223], v111, s[24:27], s30 offen offset:1024 sc1
  v_mfma_f32_16x16x32_bf16 v[56:59], a[244:247], a[200:203], v[56:59]
  v_exp_f32 v132, v132
  v_mfma_f32_16x16x32_bf16 v[60:63], a[244:247], a[208:211], 0
  v_add_f32 v129, 1.0, v129
  v_add_f32 v130, 1.0, v130
  v_mfma_f32_16x16x32_bf16 v[60:63], a[224:227], a[204:207], v[60:63]
  v_add_f32 v131, 1.0, v131
  v_add_f32 v132, 1.0, v132
  v_mfma_f32_16x16x32_bf16 v[64:67], a[228:231], a[180:183], 0
  buffer_load_dwordx4 v[224:227], v112, s[24:27], s30 offen offset:0 sc1
  v_mfma_f32_16x16x32_bf16 v[64:67], a[248:251], a[184:187], v[64:67]
  v_rcp_f32 v129, v129
  v_mfma_f32_16x16x32_bf16 v[68:71], a[248:251], a[192:195], 0
  v_rcp_f32 v130, v130
  v_mfma_f32_16x16x32_bf16 v[68:71], a[228:231], a[188:191], v[68:71]
  v_rcp_f32 v131, v131
  v_mfma_f32_16x16x32_bf16 v[72:75], a[228:231], a[196:199], 0
  buffer_load_dwordx4 v[228:231], v112, s[24:27], s30 offen offset:1024 sc1
  v_mfma_f32_16x16x32_bf16 v[72:75], a[248:251], a[200:203], v[72:75]
  v_rcp_f32 v132, v132
  v_mfma_f32_16x16x32_bf16 v[76:79], a[248:251], a[208:211], 0
  v_mul_f32 v90, v90, v129
  v_mul_f32 v91, v91, v130
  v_mfma_f32_16x16x32_bf16 v[76:79], a[228:231], a[204:207], v[76:79]
  v_mul_f32 v92, v92, v131
  v_mul_f32 v93, v93, v132
  s_waitcnt vmcnt(6)
  v_mfma_f32_16x16x32_bf16 v[0:3], a[252:255], v[176:179], v[0:3]
  buffer_load_dwordx4 v[232:235], v113, s[24:27], s30 offen offset:0 sc1
  v_mfma_f32_16x16x32_bf16 v[0:3], a[144:147], v[180:183], v[0:3]
  v_cvt_pk_bf16_f32 v90, v90, v90
  v_cvt_pk_bf16_f32 v91, v91, v91
  v_mfma_f32_16x16x32_bf16 v[4:7], a[144:147], v[188:191], v[4:7]
  v_cvt_pk_bf16_f32 v92, v92, v92
  v_cvt_pk_bf16_f32 v93, v93, v93
  v_mfma_f32_16x16x32_bf16 v[4:7], a[252:255], v[184:187], v[4:7]
  v_lshlrev_b32 v90, 16, v90
  v_lshlrev_b32 v91, 16, v91
  v_mfma_f32_16x16x32_bf16 v[8:11], a[252:255], v[192:195], v[8:11]
  buffer_load_dwordx4 v[236:239], v113, s[24:27], s30 offen offset:1024 sc1
  v_mfma_f32_16x16x32_bf16 v[8:11], a[144:147], v[196:199], v[8:11]
  v_lshlrev_b32 v92, 16, v92
  v_lshlrev_b32 v93, 16, v93
  v_mfma_f32_16x16x32_bf16 v[12:15], a[144:147], v[204:207], v[12:15]
  v_cvt_pk_bf16_f32 v160, v160, v160
  v_cvt_pk_bf16_f32 v161, v161, v161
  v_mfma_f32_16x16x32_bf16 v[12:15], a[252:255], v[200:203], v[12:15]
  v_cvt_pk_bf16_f32 v162, v162, v162
  v_cvt_pk_bf16_f32 v163, v163, v163
  v_mfma_f32_16x16x32_bf16 v[16:19], a[128:131], v[176:179], v[16:19]
  s_add_u32 s30, s30, 8192
  buffer_load_dwordx4 v[240:243], v110, s[24:27], s30 offen offset:0 sc1
  v_mfma_f32_16x16x32_bf16 v[16:19], a[148:151], v[180:183], v[16:19]
  v_lshlrev_b32 v160, 16, v160
  v_lshlrev_b32 v161, 16, v161
  v_mfma_f32_16x16x32_bf16 v[20:23], a[148:151], v[188:191], v[20:23]
  v_lshlrev_b32 v162, 16, v162
  v_lshlrev_b32 v163, 16, v163
  v_mfma_f32_16x16x32_bf16 v[20:23], a[128:131], v[184:187], v[20:23]
  v_mul_f32 v160, v160, v124
  v_mul_f32 v161, v161, v124
  v_mfma_f32_16x16x32_bf16 v[24:27], a[128:131], v[192:195], v[24:27]
  buffer_load_dwordx4 v[244:247], v110, s[24:27], s30 offen offset:1024 sc1
  v_mfma_f32_16x16x32_bf16 v[24:27], a[148:151], v[196:199], v[24:27]
  v_mul_f32 v162, v162, v124
  v_mul_f32 v163, v163, v124
  v_mfma_f32_16x16x32_bf16 v[28:31], a[148:151], v[204:207], v[28:31]
  v_cvt_pk_bf16_f32 v160, v160, v160
  v_cvt_pk_bf16_f32 v161, v161, v161
  v_mfma_f32_16x16x32_bf16 v[28:31], a[128:131], v[200:203], v[28:31]
  v_cvt_pk_bf16_f32 v162, v162, v162
  v_cvt_pk_bf16_f32 v163, v163, v163
  v_mfma_f32_16x16x32_bf16 v[32:35], a[132:135], v[176:179], v[32:35]
  buffer_load_dwordx4 v[248:251], v111, s[24:27], s30 offen offset:0 sc1
  v_mfma_f32_16x16x32_bf16 v[32:35], a[152:155], v[180:183], v[32:35]
  v_lshlrev_b32 v160, 16, v160
  v_lshlrev_b32 v161, 16, v161
  v_mfma_f32_16x16x32_bf16 v[36:39], a[152:155], v[188:191], v[36:39]
  v_lshlrev_b32 v162, 16, v162
  v_lshlrev_b32 v163, 16, v163
  v_mfma_f32_16x16x32_bf16 v[36:39], a[132:135], v[184:187], v[36:39]
  v_add_f32 v94, v94, v160
  v_add_f32 v95, v95, v161
  v_mfma_f32_16x16x32_bf16 v[40:43], a[132:135], v[192:195], v[40:43]
  buffer_load_dwordx4 v[252:255], v111, s[24:27], s30 offen offset:1024 sc1
  v_mfma_f32_16x16x32_bf16 v[40:43], a[152:155], v[196:199], v[40:43]
  v_add_f32 v96, v96, v162
  v_add_f32 v97, v97, v163
  v_mfma_f32_16x16x32_bf16 v[44:47], a[152:155], v[204:207], v[44:47]
  v_cvt_pk_bf16_f32 v94, v94, v94
  v_cvt_pk_bf16_f32 v95, v95, v95
  v_mfma_f32_16x16x32_bf16 v[44:47], a[132:135], v[200:203], v[44:47]
  v_cvt_pk_bf16_f32 v96, v96, v96
  v_cvt_pk_bf16_f32 v97, v97, v97
  v_mfma_f32_16x16x32_bf16 v[48:51], a[136:139], v[176:179], v[48:51]
  buffer_load_dwordx4 v[136:139], v112, s[24:27], s30 offen offset:0 sc1
  v_mfma_f32_16x16x32_bf16 v[48:51], a[156:159], v[180:183], v[48:51]
  v_lshlrev_b32 v94, 16, v94
  v_lshlrev_b32 v95, 16, v95
  v_mfma_f32_16x16x32_bf16 v[52:55], a[156:159], v[188:191], v[52:55]
  v_lshlrev_b32 v96, 16, v96
  v_lshlrev_b32 v97, 16, v97
  v_mfma_f32_16x16x32_bf16 v[52:55], a[136:139], v[184:187], v[52:55]
  v_mul_f32 v129, 0xbfb8aa3b, v94
  v_mul_f32 v130, 0xbfb8aa3b, v95
  v_mfma_f32_16x16x32_bf16 v[56:59], a[136:139], v[192:195], v[56:59]
  buffer_load_dwordx4 v[140:143], v112, s[24:27], s30 offen offset:1024 sc1
  v_mfma_f32_16x16x32_bf16 v[56:59], a[156:159], v[196:199], v[56:59]
  v_mul_f32 v131, 0xbfb8aa3b, v96
  v_mul_f32 v132, 0xbfb8aa3b, v97
  v_mfma_f32_16x16x32_bf16 v[60:63], a[156:159], v[204:207], v[60:63]
  v_exp_f32 v129, v129
  v_mfma_f32_16x16x32_bf16 v[60:63], a[136:139], v[200:203], v[60:63]
  v_exp_f32 v130, v130
  v_mfma_f32_16x16x32_bf16 v[64:67], a[140:143], v[176:179], v[64:67]
  buffer_load_dwordx4 v[144:147], v113, s[24:27], s30 offen offset:0 sc1
  v_mfma_f32_16x16x32_bf16 v[64:67], a[0:3], v[180:183], v[64:67]
  v_exp_f32 v131, v131
  v_mfma_f32_16x16x32_bf16 v[68:71], a[0:3], v[188:191], v[68:71]
  v_exp_f32 v132, v132
  v_mfma_f32_16x16x32_bf16 v[68:71], a[140:143], v[184:187], v[68:71]
  v_add_f32 v129, 1.0, v129
  v_add_f32 v130, 1.0, v130
  v_mfma_f32_16x16x32_bf16 v[72:75], a[140:143], v[192:195], v[72:75]
  buffer_load_dwordx4 v[148:151], v113, s[24:27], s30 offen offset:1024 sc1
  v_mfma_f32_16x16x32_bf16 v[72:75], a[0:3], v[196:199], v[72:75]
  v_add_f32 v131, 1.0, v131
  v_add_f32 v132, 1.0, v132
  v_mfma_f32_16x16x32_bf16 v[76:79], a[0:3], v[204:207], v[76:79]
  v_rcp_f32 v129, v129
  v_mfma_f32_16x16x32_bf16 v[76:79], a[140:143], v[200:203], v[76:79]
  v_rcp_f32 v130, v130
  s_waitcnt vmcnt(8)
  v_mfma_f32_16x16x32_bf16 v[0:3], a[4:7], v[208:211], v[0:3]
  s_add_u32 s30, s30, 8192
  buffer_load_dwordx4 v[152:155], v110, s[24:27], s30 offen offset:0 sc1
  v_mfma_f32_16x16x32_bf16 v[0:3], a[24:27], v[212:215], v[0:3]
  v_rcp_f32 v131, v131
  v_mfma_f32_16x16x32_bf16 v[4:7], a[24:27], v[220:223], v[4:7]
  v_rcp_f32 v132, v132
  v_mfma_f32_16x16x32_bf16 v[4:7], a[4:7], v[216:219], v[4:7]
  v_mul_f32 v94, v94, v129
  v_mul_f32 v95, v95, v130
  v_mfma_f32_16x16x32_bf16 v[8:11], a[4:7], v[224:227], v[8:11]
  buffer_load_dwordx4 a[180:183], v110, s[24:27], s30 offen offset:1024 sc1
  v_mfma_f32_16x16x32_bf16 v[8:11], a[24:27], v[228:231], v[8:11]
  v_mul_f32 v96, v96, v131
  v_mul_f32 v97, v97, v132
  v_mfma_f32_16x16x32_bf16 v[12:15], a[24:27], v[236:239], v[12:15]
  v_cvt_pk_bf16_f32 v94, v94, v94
  v_cvt_pk_bf16_f32 v95, v95, v95
  v_mfma_f32_16x16x32_bf16 v[12:15], a[4:7], v[232:235], v[12:15]
  v_cvt_pk_bf16_f32 v96, v96, v96
  v_cvt_pk_bf16_f32 v97, v97, v97
  v_mfma_f32_16x16x32_bf16 v[16:19], a[8:11], v[208:211], v[16:19]
  buffer_load_dwordx4 a[184:187], v111, s[24:27], s30 offen offset:0 sc1
  v_mfma_f32_16x16x32_bf16 v[16:19], a[28:31], v[212:215], v[16:19]
  v_lshlrev_b32 v94, 16, v94
  v_lshlrev_b32 v95, 16, v95
  v_mfma_f32_16x16x32_bf16 v[20:23], a[28:31], v[220:223], v[20:23]
  v_lshlrev_b32 v96, 16, v96
  v_lshlrev_b32 v97, 16, v97
  v_mfma_f32_16x16x32_bf16 v[20:23], a[8:11], v[216:219], v[20:23]
  v_cvt_pk_bf16_f32 v164, v164, v164
  v_cvt_pk_bf16_f32 v165, v165, v165
  v_mfma_f32_16x16x32_bf16 v[24:27], a[8:11], v[224:227], v[24:27]
  buffer_load_dwordx4 a[188:191], v111, s[24:27], s30 offen offset:1024 sc1
  v_mfma_f32_16x16x32_bf16 v[24:27], a[28:31], v[228:231], v[24:27]
  v_cvt_pk_bf16_f32 v166, v166, v166
  v_cvt_pk_bf16_f32 v167, v167, v167
  v_mfma_f32_16x16x32_bf16 v[28:31], a[28:31], v[236:239], v[28:31]
  v_lshlrev_b32 v164, 16, v164
  v_lshlrev_b32 v165, 16, v165
  v_mfma_f32_16x16x32_bf16 v[28:31], a[8:11], v[232:235], v[28:31]
  v_lshlrev_b32 v166, 16, v166
  v_lshlrev_b32 v167, 16, v167
  v_mfma_f32_16x16x32_bf16 v[32:35], a[12:15], v[208:211], v[32:35]
  buffer_load_dwordx4 a[192:195], v112, s[24:27], s30 offen offset:0 sc1
  v_mfma_f32_16x16x32_bf16 v[32:35], a[32:35], v[212:215], v[32:35]
  v_mul_f32 v164, v164, v124
  v_mul_f32 v165, v165, v124
  v_mfma_f32_16x16x32_bf16 v[36:39], a[32:35], v[220:223], v[36:39]
  v_mul_f32 v166, v166, v124
  v_mul_f32 v167, v167, v124
  v_mfma_f32_16x16x32_bf16 v[36:39], a[12:15], v[216:219], v[36:39]
  v_cvt_pk_bf16_f32 v164, v164, v164
  v_cvt_pk_bf16_f32 v165, v165, v165
  v_mfma_f32_16x16x32_bf16 v[40:43], a[12:15], v[224:227], v[40:43]
  buffer_load_dwordx4 a[196:199], v112, s[24:27], s30 offen offset:1024 sc1
  v_mfma_f32_16x16x32_bf16 v[40:43], a[32:35], v[228:231], v[40:43]
  v_cvt_pk_bf16_f32 v166, v166, v166
  v_cvt_pk_bf16_f32 v167, v167, v167
  v_mfma_f32_16x16x32_bf16 v[44:47], a[32:35], v[236:239], v[44:47]
  v_lshlrev_b32 v164, 16, v164
  v_lshlrev_b32 v165, 16, v165
  v_mfma_f32_16x16x32_bf16 v[44:47], a[12:15], v[232:235], v[44:47]
  v_lshlrev_b32 v166, 16, v166
  v_lshlrev_b32 v167, 16, v167
  v_mfma_f32_16x16x32_bf16 v[48:51], a[16:19], v[208:211], v[48:51]
  buffer_load_dwordx4 a[200:203], v113, s[24:27], s30 offen offset:0 sc1
  v_mfma_f32_16x16x32_bf16 v[48:51], a[36:39], v[212:215], v[48:51]
  v_add_f32 v98, v98, v164
  v_add_f32 v99, v99, v165
  v_mfma_f32_16x16x32_bf16 v[52:55], a[36:39], v[220:223], v[52:55]
  v_add_f32 v100, v100, v166
  v_add_f32 v101, v101, v167
  v_mfma_f32_16x16x32_bf16 v[52:55], a[16:19], v[216:219], v[52:55]
  v_cvt_pk_bf16_f32 v98, v98, v98
  v_cvt_pk_bf16_f32 v99, v99, v99
  v_mfma_f32_16x16x32_bf16 v[56:59], a[16:19], v[224:227], v[56:59]
  buffer_load_dwordx4 a[204:207], v113, s[24:27], s30 offen offset:1024 sc1
  v_mfma_f32_16x16x32_bf16 v[56:59], a[36:39], v[228:231], v[56:59]
  v_cvt_pk_bf16_f32 v100, v100, v100
  v_cvt_pk_bf16_f32 v101, v101, v101
  v_mfma_f32_16x16x32_bf16 v[60:63], a[36:39], v[236:239], v[60:63]
  v_lshlrev_b32 v98, 16, v98
  v_lshlrev_b32 v99, 16, v99
  v_mfma_f32_16x16x32_bf16 v[60:63], a[16:19], v[232:235], v[60:63]
  v_lshlrev_b32 v100, 16, v100
  v_lshlrev_b32 v101, 16, v101
  v_mfma_f32_16x16x32_bf16 v[64:67], a[20:23], v[208:211], v[64:67]
  s_add_u32 s30, s30, 8192
  buffer_load_dwordx4 a[208:211], v110, s[24:27], s30 offen offset:0 sc1
  v_mfma_f32_16x16x32_bf16 v[64:67], a[40:43], v[212:215], v[64:67]
  v_mul_f32 v129, 0xbfb8aa3b, v98
  v_mul_f32 v130, 0xbfb8aa3b, v99
  v_mfma_f32_16x16x32_bf16 v[68:71], a[40:43], v[220:223], v[68:71]
  v_mul_f32 v131, 0xbfb8aa3b, v100
  v_mul_f32 v132, 0xbfb8aa3b, v101
  v_mfma_f32_16x16x32_bf16 v[68:71], a[20:23], v[216:219], v[68:71]
  v_exp_f32 v129, v129
  v_mfma_f32_16x16x32_bf16 v[72:75], a[20:23], v[224:227], v[72:75]
  buffer_load_dwordx4 v[176:179], v110, s[24:27], s30 offen offset:1024 sc1
  v_mfma_f32_16x16x32_bf16 v[72:75], a[40:43], v[228:231], v[72:75]
  v_exp_f32 v130, v130
  v_mfma_f32_16x16x32_bf16 v[76:79], a[40:43], v[236:239], v[76:79]
  v_exp_f32 v131, v131
  v_mfma_f32_16x16x32_bf16 v[76:79], a[20:23], v[232:235], v[76:79]
  v_exp_f32 v132, v132
  s_waitcnt vmcnt(10)
  v_mfma_f32_16x16x32_bf16 v[0:3], a[44:47], v[240:243], v[0:3]
  buffer_load_dwordx4 v[180:183], v111, s[24:27], s30 offen offset:0 sc1
  v_mfma_f32_16x16x32_bf16 v[0:3], a[64:67], v[244:247], v[0:3]
  v_add_f32 v129, 1.0, v129
  v_add_f32 v130, 1.0, v130
  v_mfma_f32_16x16x32_bf16 v[4:7], a[64:67], v[252:255], v[4:7]
  v_add_f32 v131, 1.0, v131
  v_add_f32 v132, 1.0, v132
  v_mfma_f32_16x16x32_bf16 v[4:7], a[44:47], v[248:251], v[4:7]
  v_rcp_f32 v129, v129
  v_mfma_f32_16x16x32_bf16 v[8:11], a[44:47], v[136:139], v[8:11]
  buffer_load_dwordx4 v[184:187], v111, s[24:27], s30 offen offset:1024 sc1
  v_mfma_f32_16x16x32_bf16 v[8:11], a[64:67], v[140:143], v[8:11]
  v_rcp_f32 v130, v130
  v_mfma_f32_16x16x32_bf16 v[12:15], a[64:67], v[148:151], v[12:15]
  v_rcp_f32 v131, v131
  v_mfma_f32_16x16x32_bf16 v[12:15], a[44:47], v[144:147], v[12:15]
  v_rcp_f32 v132, v132
  v_mfma_f32_16x16x32_bf16 v[16:19], a[48:51], v[240:243], v[16:19]
  buffer_load_dwordx4 v[188:191], v112, s[24:27], s30 offen offset:0 sc1
  v_mfma_f32_16x16x32_bf16 v[16:19], a[68:71], v[244:247], v[16:19]
  v_mul_f32 v98, v98, v129
  v_mul_f32 v99, v99, v130
  v_mfma_f32_16x16x32_bf16 v[20:23], a[68:71], v[252:255], v[20:23]
  v_mul_f32 v100, v100, v131
  v_mul_f32 v101, v101, v132
  v_mfma_f32_16x16x32_bf16 v[20:23], a[48:51], v[248:251], v[20:23]
  v_cvt_pk_bf16_f32 v98, v98, v98
  v_cvt_pk_bf16_f32 v99, v99, v99
  v_mfma_f32_16x16x32_bf16 v[24:27], a[48:51], v[136:139], v[24:27]
  buffer_load_dwordx4 v[192:195], v112, s[24:27], s30 offen offset:1024 sc1
  v_mfma_f32_16x16x32_bf16 v[24:27], a[68:71], v[140:143], v[24:27]
  v_cvt_pk_bf16_f32 v100, v100, v100
  v_cvt_pk_bf16_f32 v101, v101, v101
  v_mfma_f32_16x16x32_bf16 v[28:31], a[68:71], v[148:151], v[28:31]
  v_lshlrev_b32 v98, 16, v98
  v_lshlrev_b32 v99, 16, v99
  v_mfma_f32_16x16x32_bf16 v[28:31], a[48:51], v[144:147], v[28:31]
  v_lshlrev_b32 v100, 16, v100
  v_lshlrev_b32 v101, 16, v101
  v_mfma_f32_16x16x32_bf16 v[32:35], a[52:55], v[240:243], v[32:35]
  buffer_load_dwordx4 v[196:199], v113, s[24:27], s30 offen offset:0 sc1
  v_mfma_f32_16x16x32_bf16 v[32:35], a[72:75], v[244:247], v[32:35]
  v_cvt_pk_bf16_f32 v168, v168, v168
  v_cvt_pk_bf16_f32 v169, v169, v169
  v_mfma_f32_16x16x32_bf16 v[36:39], a[72:75], v[252:255], v[36:39]
  v_cvt_pk_bf16_f32 v170, v170, v170
  v_cvt_pk_bf16_f32 v171, v171, v171
  v_mfma_f32_16x16x32_bf16 v[36:39], a[52:55], v[248:251], v[36:39]
  v_lshlrev_b32 v168, 16, v168
  v_lshlrev_b32 v169, 16, v169
  v_mfma_f32_16x16x32_bf16 v[40:43], a[52:55], v[136:139], v[40:43]
  buffer_load_dwordx4 v[200:203], v113, s[24:27], s30 offen offset:1024 sc1
  v_mfma_f32_16x16x32_bf16 v[40:43], a[72:75], v[140:143], v[40:43]
  v_lshlrev_b32 v170, 16, v170
  v_lshlrev_b32 v171, 16, v171
  v_mfma_f32_16x16x32_bf16 v[44:47], a[72:75], v[148:151], v[44:47]
  v_mul_f32 v168, v168, v124
  v_mul_f32 v169, v169, v124
  v_mfma_f32_16x16x32_bf16 v[44:47], a[52:55], v[144:147], v[44:47]
  v_mul_f32 v170, v170, v124
  v_mul_f32 v171, v171, v124
  v_mfma_f32_16x16x32_bf16 v[48:51], a[56:59], v[240:243], v[48:51]
  s_add_u32 s30, s30, 8192
  buffer_load_dwordx4 v[204:207], v110, s[24:27], s30 offen offset:0 sc1
  v_mfma_f32_16x16x32_bf16 v[48:51], a[76:79], v[244:247], v[48:51]
  v_cvt_pk_bf16_f32 v168, v168, v168
  v_cvt_pk_bf16_f32 v169, v169, v169
  v_mfma_f32_16x16x32_bf16 v[52:55], a[76:79], v[252:255], v[52:55]
  v_cvt_pk_bf16_f32 v170, v170, v170
  v_cvt_pk_bf16_f32 v171, v171, v171
  v_mfma_f32_16x16x32_bf16 v[52:55], a[56:59], v[248:251], v[52:55]
  v_lshlrev_b32 v168, 16, v168
  v_lshlrev_b32 v169, 16, v169
  v_mfma_f32_16x16x32_bf16 v[56:59], a[56:59], v[136:139], v[56:59]
  buffer_load_dwordx4 v[208:211], v110, s[24:27], s30 offen offset:1024 sc1
  v_mfma_f32_16x16x32_bf16 v[56:59], a[76:79], v[140:143], v[56:59]
  v_lshlrev_b32 v170, 16, v170
  v_lshlrev_b32 v171, 16, v171
  v_mfma_f32_16x16x32_bf16 v[60:63], a[76:79], v[148:151], v[60:63]
  v_add_f32 v102, v102, v168
  v_add_f32 v103, v103, v169
  v_mfma_f32_16x16x32_bf16 v[60:63], a[56:59], v[144:147], v[60:63]
  v_add_f32 v104, v104, v170
  v_add_f32 v105, v105, v171
  v_mfma_f32_16x16x32_bf16 v[64:67], a[60:63], v[240:243], v[64:67]
  buffer_load_dwordx4 v[212:215], v111, s[24:27], s30 offen offset:0 sc1
  v_mfma_f32_16x16x32_bf16 v[64:67], a[80:83], v[244:247], v[64:67]
  v_cvt_pk_bf16_f32 v102, v102, v102
  v_cvt_pk_bf16_f32 v103, v103, v103
  v_mfma_f32_16x16x32_bf16 v[68:71], a[80:83], v[252:255], v[68:71]
  v_cvt_pk_bf16_f32 v104, v104, v104
  v_cvt_pk_bf16_f32 v105, v105, v105
  v_mfma_f32_16x16x32_bf16 v[68:71], a[60:63], v[248:251], v[68:71]
  v_lshlrev_b32 v102, 16, v102
  v_lshlrev_b32 v103, 16, v103
  v_mfma_f32_16x16x32_bf16 v[72:75], a[60:63], v[136:139], v[72:75]
  buffer_load_dwordx4 v[216:219], v111, s[24:27], s30 offen offset:1024 sc1
  v_mfma_f32_16x16x32_bf16 v[72:75], a[80:83], v[140:143], v[72:75]
  v_lshlrev_b32 v104, 16, v104
  v_lshlrev_b32 v105, 16, v105
  v_mfma_f32_16x16x32_bf16 v[76:79], a[80:83], v[148:151], v[76:79]
  v_mul_f32 v129, 0xbfb8aa3b, v102
  v_mul_f32 v130, 0xbfb8aa3b, v103
  v_mfma_f32_16x16x32_bf16 v[76:79], a[60:63], v[144:147], v[76:79]
  v_mul_f32 v131, 0xbfb8aa3b, v104
  v_mul_f32 v132, 0xbfb8aa3b, v105
  s_waitcnt vmcnt(12)
  v_mfma_f32_16x16x32_bf16 v[0:3], a[84:87], v[152:155], v[0:3]
  buffer_load_dwordx4 v[220:223], v112, s[24:27], s30 offen offset:0 sc1
  v_mfma_f32_16x16x32_bf16 v[0:3], a[104:107], a[180:183], v[0:3]
  v_exp_f32 v129, v129
  v_mfma_f32_16x16x32_bf16 v[4:7], a[104:107], a[188:191], v[4:7]
  v_exp_f32 v130, v130
  v_mfma_f32_16x16x32_bf16 v[4:7], a[84:87], a[184:187], v[4:7]
  v_exp_f32 v131, v131
  v_mfma_f32_16x16x32_bf16 v[8:11], a[84:87], a[192:195], v[8:11]
  buffer_load_dwordx4 v[224:227], v112, s[24:27], s30 offen offset:1024 sc1
  v_mfma_f32_16x16x32_bf16 v[8:11], a[104:107], a[196:199], v[8:11]
  v_exp_f32 v132, v132
  v_mfma_f32_16x16x32_bf16 v[12:15], a[104:107], a[204:207], v[12:15]
  v_add_f32 v129, 1.0, v129
  v_add_f32 v130, 1.0, v130
  v_mfma_f32_16x16x32_bf16 v[12:15], a[84:87], a[200:203], v[12:15]
  v_add_f32 v131, 1.0, v131
  v_add_f32 v132, 1.0, v132
  v_mfma_f32_16x16x32_bf16 v[16:19], a[88:91], v[152:155], v[16:19]
  buffer_load_dwordx4 v[228:231], v113, s[24:27], s30 offen offset:0 sc1
  v_mfma_f32_16x16x32_bf16 v[16:19], a[108:111], a[180:183], v[16:19]
  v_rcp_f32 v129, v129
  v_mfma_f32_16x16x32_bf16 v[20:23], a[108:111], a[188:191], v[20:23]
  v_rcp_f32 v130, v130
  v_mfma_f32_16x16x32_bf16 v[20:23], a[88:91], a[184:187], v[20:23]
  v_rcp_f32 v131, v131
  v_mfma_f32_16x16x32_bf16 v[24:27], a[88:91], a[192:195], v[24:27]
  buffer_load_dwordx4 v[232:235], v113, s[24:27], s30 offen offset:1024 sc1
  v_mfma_f32_16x16x32_bf16 v[24:27], a[108:111], a[196:199], v[24:27]
  v_rcp_f32 v132, v132
  v_mfma_f32_16x16x32_bf16 v[28:31], a[108:111], a[204:207], v[28:31]
  v_mul_f32 v102, v102, v129
  v_mul_f32 v103, v103, v130
  v_mfma_f32_16x16x32_bf16 v[28:31], a[88:91], a[200:203], v[28:31]
  v_mul_f32 v104, v104, v131
  v_mul_f32 v105, v105, v132
  v_mfma_f32_16x16x32_bf16 v[32:35], a[92:95], v[152:155], v[32:35]
  s_add_u32 s30, s30, 8192
  buffer_load_dwordx4 v[236:239], v110, s[24:27], s30 offen offset:0 sc1
  v_mfma_f32_16x16x32_bf16 v[32:35], a[112:115], a[180:183], v[32:35]
  v_cvt_pk_bf16_f32 v102, v102, v102
  v_cvt_pk_bf16_f32 v103, v103, v103
  v_mfma_f32_16x16x32_bf16 v[36:39], a[112:115], a[188:191], v[36:39]
  v_cvt_pk_bf16_f32 v104, v104, v104
  v_cvt_pk_bf16_f32 v105, v105, v105
  v_mfma_f32_16x16x32_bf16 v[36:39], a[92:95], a[184:187], v[36:39]
  v_lshlrev_b32 v102, 16, v102
  v_lshlrev_b32 v103, 16, v103
  v_mfma_f32_16x16x32_bf16 v[40:43], a[92:95], a[192:195], v[40:43]
  buffer_load_dwordx4 v[240:243], v110, s[24:27], s30 offen offset:1024 sc1
  v_mfma_f32_16x16x32_bf16 v[40:43], a[112:115], a[196:199], v[40:43]
  v_lshlrev_b32 v104, 16, v104
  v_lshlrev_b32 v105, 16, v105
  v_mfma_f32_16x16x32_bf16 v[44:47], a[112:115], a[204:207], v[44:47]
  v_cvt_pk_bf16_f32 v172, v172, v172
  v_cvt_pk_bf16_f32 v173, v173, v173
  v_mfma_f32_16x16x32_bf16 v[44:47], a[92:95], a[200:203], v[44:47]
  v_cvt_pk_bf16_f32 v174, v174, v174
  v_cvt_pk_bf16_f32 v175, v175, v175
  v_mfma_f32_16x16x32_bf16 v[48:51], a[96:99], v[152:155], v[48:51]
  buffer_load_dwordx4 v[244:247], v111, s[24:27], s30 offen offset:0 sc1
  v_mfma_f32_16x16x32_bf16 v[48:51], a[116:119], a[180:183], v[48:51]
  v_lshlrev_b32 v172, 16, v172
  v_lshlrev_b32 v173, 16, v173
  v_mfma_f32_16x16x32_bf16 v[52:55], a[116:119], a[188:191], v[52:55]
  v_lshlrev_b32 v174, 16, v174
  v_lshlrev_b32 v175, 16, v175
  v_mfma_f32_16x16x32_bf16 v[52:55], a[96:99], a[184:187], v[52:55]
  v_mul_f32 v172, v172, v124
  v_mul_f32 v173, v173, v124
  v_mfma_f32_16x16x32_bf16 v[56:59], a[96:99], a[192:195], v[56:59]
  buffer_load_dwordx4 v[248:251], v111, s[24:27], s30 offen offset:1024 sc1
  v_mfma_f32_16x16x32_bf16 v[56:59], a[116:119], a[196:199], v[56:59]
  v_mul_f32 v174, v174, v124
  v_mul_f32 v175, v175, v124
  v_mfma_f32_16x16x32_bf16 v[60:63], a[116:119], a[204:207], v[60:63]
  v_cvt_pk_bf16_f32 v172, v172, v172
  v_cvt_pk_bf16_f32 v173, v173, v173
  v_mfma_f32_16x16x32_bf16 v[60:63], a[96:99], a[200:203], v[60:63]
  v_cvt_pk_bf16_f32 v174, v174, v174
  v_cvt_pk_bf16_f32 v175, v175, v175
  v_mfma_f32_16x16x32_bf16 v[64:67], a[100:103], v[152:155], v[64:67]
  ds_read_b128 v[252:255], v122 offset:0
  v_lshlrev_b32 v172, 16, v172
  v_mfma_f32_16x16x32_bf16 v[64:67], a[120:123], a[180:183], v[64:67]
  buffer_load_dwordx4 v[136:139], v112, s[24:27], s30 offen offset:0 sc1
  v_mfma_f32_16x16x32_bf16 v[68:71], a[120:123], a[188:191], v[68:71]
  v_lshlrev_b32 v173, 16, v173
  v_lshlrev_b32 v174, 16, v174
  v_mfma_f32_16x16x32_bf16 v[68:71], a[100:103], a[184:187], v[68:71]
  v_lshlrev_b32 v175, 16, v175
  v_add_f32 v106, v106, v172
  v_mfma_f32_16x16x32_bf16 v[72:75], a[100:103], a[192:195], v[72:75]
  buffer_load_dwordx4 v[140:143], v112, s[24:27], s30 offen offset:1024 sc1
  v_mfma_f32_16x16x32_bf16 v[72:75], a[120:123], a[196:199], v[72:75]
  v_add_f32 v107, v107, v173
  v_add_f32 v108, v108, v174
  v_mfma_f32_16x16x32_bf16 v[76:79], a[120:123], a[204:207], v[76:79]
  v_add_f32 v109, v109, v175
  v_cvt_pk_bf16_f32 v106, v106, v106
  v_mfma_f32_16x16x32_bf16 v[76:79], a[100:103], a[200:203], v[76:79]
  v_cvt_pk_bf16_f32 v107, v107, v107
  v_cvt_pk_bf16_f32 v108, v108, v108
  s_waitcnt vmcnt(14)
  v_mfma_f32_16x16x32_bf16 v[0:3], a[124:127], a[208:211], v[0:3]
  ds_read_b128 v[144:147], v122 offset:1024
  v_cvt_pk_bf16_f32 v109, v109, v109
  v_mfma_f32_16x16x32_bf16 v[0:3], a[176:179], v[176:179], v[0:3]
  buffer_load_dwordx4 v[148:151], v113, s[24:27], s30 offen offset:0 sc1
  v_mfma_f32_16x16x32_bf16 v[4:7], a[176:179], v[184:187], v[4:7]
  v_lshlrev_b32 v106, 16, v106
  v_lshlrev_b32 v107, 16, v107
  v_mfma_f32_16x16x32_bf16 v[4:7], a[124:127], v[180:183], v[4:7]
  v_lshlrev_b32 v108, 16, v108
  v_lshlrev_b32 v109, 16, v109
  v_mfma_f32_16x16x32_bf16 v[8:11], a[124:127], v[188:191], v[8:11]
  buffer_load_dwordx4 v[152:155], v113, s[24:27], s30 offen offset:1024 sc1
  v_mfma_f32_16x16x32_bf16 v[8:11], a[176:179], v[192:195], v[8:11]
  v_mul_f32 v129, 0xbfb8aa3b, v106
  v_mul_f32 v130, 0xbfb8aa3b, v107
  v_mfma_f32_16x16x32_bf16 v[12:15], a[176:179], v[200:203], v[12:15]
  v_mul_f32 v131, 0xbfb8aa3b, v108
  v_mul_f32 v132, 0xbfb8aa3b, v109
  v_mfma_f32_16x16x32_bf16 v[12:15], a[124:127], v[196:199], v[12:15]
  v_exp_f32 v129, v129
  s_waitcnt lgkmcnt(1)
  v_mfma_f32_16x16x32_bf16 v[16:19], a[160:163], a[208:211], v[16:19]
  ds_read_b128 a[180:183], v122 offset:2048
  s_mov_b32 s30, s37
  v_exp_f32 v130, v130
  v_mfma_f32_16x16x32_bf16 v[16:19], v[252:255], v[176:179], v[16:19]
  buffer_load_dwordx4 a[184:187], v110, s[24:27], s30 offen offset:0 sc1
  v_mfma_f32_16x16x32_bf16 v[20:23], v[252:255], v[184:187], v[20:23]
  v_exp_f32 v131, v131
  v_mfma_f32_16x16x32_bf16 v[20:23], a[160:163], v[180:183], v[20:23]
  v_exp_f32 v132, v132
  v_mfma_f32_16x16x32_bf16 v[24:27], a[160:163], v[188:191], v[24:27]
  buffer_load_dwordx4 a[188:191], v110, s[24:27], s30 offen offset:1024 sc1
  v_mfma_f32_16x16x32_bf16 v[24:27], v[252:255], v[192:195], v[24:27]
  v_add_f32 v129, 1.0, v129
  v_add_f32 v130, 1.0, v130
  v_mfma_f32_16x16x32_bf16 v[28:31], v[252:255], v[200:203], v[28:31]
  v_add_f32 v131, 1.0, v131
  v_add_f32 v132, 1.0, v132
  v_mfma_f32_16x16x32_bf16 v[28:31], a[160:163], v[196:199], v[28:31]
  v_rcp_f32 v129, v129
  s_waitcnt lgkmcnt(1)
  v_mfma_f32_16x16x32_bf16 v[32:35], a[164:167], a[208:211], v[32:35]
  ds_read_b128 a[192:195], v122 offset:3072
  v_rcp_f32 v130, v130
  v_mfma_f32_16x16x32_bf16 v[32:35], v[144:147], v[176:179], v[32:35]
  buffer_load_dwordx4 a[196:199], v111, s[24:27], s30 offen offset:0 sc1
  v_mfma_f32_16x16x32_bf16 v[36:39], v[144:147], v[184:187], v[36:39]
  v_rcp_f32 v131, v131
  v_mfma_f32_16x16x32_bf16 v[36:39], a[164:167], v[180:183], v[36:39]
  v_rcp_f32 v132, v132
  v_mfma_f32_16x16x32_bf16 v[40:43], a[164:167], v[188:191], v[40:43]
  buffer_load_dwordx4 a[200:203], v111, s[24:27], s30 offen offset:1024 sc1
  v_mfma_f32_16x16x32_bf16 v[40:43], v[144:147], v[192:195], v[40:43]
  v_mul_f32 v106, v106, v129
  v_mul_f32 v107, v107, v130
  v_mfma_f32_16x16x32_bf16 v[44:47], v[144:147], v[200:203], v[44:47]
  v_mul_f32 v108, v108, v131
  v_mul_f32 v109, v109, v132
  v_mfma_f32_16x16x32_bf16 v[44:47], a[164:167], v[196:199], v[44:47]
  v_cvt_pk_bf16_f32 v106, v106, v106
  v_cvt_pk_bf16_f32 v107, v107, v107
  s_waitcnt lgkmcnt(1)
  v_mfma_f32_16x16x32_bf16 v[48:51], a[168:171], a[208:211], v[48:51]
  ds_read_b128 a[204:207], v122 offset:16384
  ds_read_b128 v[252:255], v122 offset:33792
  v_mfma_f32_16x16x32_bf16 v[48:51], a[180:183], v[176:179], v[48:51]
  v_cvt_pk_bf16_f32 v108, v108, v108
  v_cvt_pk_bf16_f32 v109, v109, v109
  v_mfma_f32_16x16x32_bf16 v[52:55], a[180:183], v[184:187], v[52:55]
  v_lshlrev_b32 v106, 16, v106
  v_lshlrev_b32 v107, 16, v107
  v_mfma_f32_16x16x32_bf16 v[52:55], a[168:171], v[180:183], v[52:55]
  v_lshlrev_b32 v108, 16, v108
  v_lshlrev_b32 v109, 16, v109
  v_mfma_f32_16x16x32_bf16 v[56:59], a[168:171], v[188:191], v[56:59]
  v_lshlrev_b32 v156, 16, v80
  v_and_b32 v157, s34, v80
  v_mfma_f32_16x16x32_bf16 v[56:59], a[180:183], v[192:195], v[56:59]
  v_lshlrev_b32 v158, 16, v81
  v_and_b32 v159, s34, v81
  v_mfma_f32_16x16x32_bf16 v[60:63], a[180:183], v[200:203], v[60:63]
  v_lshlrev_b32 v160, 16, v82
  v_and_b32 v161, s34, v82
  v_mfma_f32_16x16x32_bf16 v[60:63], a[168:171], v[196:199], v[60:63]
  v_lshlrev_b32 v162, 16, v83
  v_and_b32 v163, s34, v83
  s_waitcnt lgkmcnt(2)
  v_mfma_f32_16x16x32_bf16 v[64:67], a[172:175], a[208:211], v[64:67]
  ds_read_b128 v[144:147], v122 offset:17408
  ds_read_b128 a[180:183], v122 offset:34816
  v_mfma_f32_16x16x32_bf16 v[64:67], a[192:195], v[176:179], v[64:67]
  v_lshlrev_b32 v164, 16, v84
  v_and_b32 v165, s34, v84
  v_mfma_f32_16x16x32_bf16 v[68:71], a[192:195], v[184:187], v[68:71]
  v_lshlrev_b32 v166, 16, v85
  v_and_b32 v167, s34, v85
  v_mfma_f32_16x16x32_bf16 v[68:71], a[172:175], v[180:183], v[68:71]
  v_lshlrev_b32 v168, 16, v86
  v_and_b32 v169, s34, v86
  v_mfma_f32_16x16x32_bf16 v[72:75], a[172:175], v[188:191], v[72:75]
  v_lshlrev_b32 v170, 16, v87
  v_and_b32 v171, s34, v87
  v_mfma_f32_16x16x32_bf16 v[72:75], a[192:195], v[192:195], v[72:75]
  v_lshlrev_b32 v172, 16, v88
  v_and_b32 v173, s34, v88
  v_mfma_f32_16x16x32_bf16 v[76:79], a[192:195], v[200:203], v[76:79]
  v_lshlrev_b32 v174, 16, v89
  v_and_b32 v175, s34, v89
  v_mfma_f32_16x16x32_bf16 v[76:79], a[172:175], v[196:199], v[76:79]
  s_sub_u32 s41, s3, 1
  s_and_b32 s41, s41, 3
  s_waitcnt vmcnt(12) lgkmcnt(2)
  v_mfma_f32_16x16x32_bf16 v[0:3], a[204:207], v[204:207], v[0:3]
  ds_read_b128 a[192:195], v122 offset:18432
  ds_read_b128 a[208:211], v122 offset:35840
  v_mfma_f32_16x16x32_bf16 v[0:3], v[252:255], v[208:211], v[0:3]
  buffer_load_dwordx4 v[176:179], v112, s[24:27], s30 offen offset:0 sc1
  s_lshl_b32 s41, s41, 12
  v_mfma_f32_16x16x32_bf16 v[4:7], v[252:255], v[216:219], v[4:7]
  v_add_u32 v80, s41, v114
  v_mfma_f32_16x16x32_bf16 v[4:7], a[204:207], v[212:215], v[4:7]
  s_sub_u32 s41, s3, 2
  s_and_b32 s41, s41, 3
  v_mfma_f32_16x16x32_bf16 v[8:11], a[204:207], v[220:223], v[8:11]
  buffer_load_dwordx4 v[180:183], v112, s[24:27], s30 offen offset:1024 sc1
  s_lshl_b32 s41, s41, 12
  v_mfma_f32_16x16x32_bf16 v[8:11], v[252:255], v[224:227], v[8:11]
  v_add_u32 v81, s41, v114
  v_mfma_f32_16x16x32_bf16 v[12:15], v[252:255], v[232:235], v[12:15]
  s_sub_u32 s41, s3, 3
  s_and_b32 s41, s41, 3
  v_mfma_f32_16x16x32_bf16 v[12:15], a[204:207], v[228:231], v[12:15]
  s_lshl_b32 s41, s41, 12
  v_add_u32 v82, s41, v114
  s_waitcnt lgkmcnt(2)
  v_mfma_f32_16x16x32_bf16 v[16:19], v[144:147], v[204:207], v[16:19]
  ds_read_b128 v[184:187], v122 offset:19456
  ds_read_b128 v[188:191], v135 offset:0
  v_mfma_f32_16x16x32_bf16 v[16:19], a[180:183], v[208:211], v[16:19]
  buffer_load_dwordx4 v[192:195], v113, s[24:27], s30 offen offset:0 sc1
  v_mfma_f32_16x16x32_bf16 v[20:23], a[180:183], v[216:219], v[20:23]
  v_mfma_f32_16x16x32_bf16 v[20:23], v[144:147], v[212:215], v[20:23]
  v_mfma_f32_16x16x32_bf16 v[24:27], v[144:147], v[220:223], v[24:27]
  buffer_load_dwordx4 v[196:199], v113, s[24:27], s30 offen offset:1024 sc1
  v_mfma_f32_16x16x32_bf16 v[24:27], a[180:183], v[224:227], v[24:27]
  v_mfma_f32_16x16x32_bf16 v[28:31], a[180:183], v[232:235], v[28:31]
  v_mfma_f32_16x16x32_bf16 v[28:31], v[144:147], v[228:231], v[28:31]
  s_waitcnt lgkmcnt(2)
  v_mfma_f32_16x16x32_bf16 v[32:35], a[192:195], v[204:207], v[32:35]
  ds_read_b128 v[200:203], v122 offset:32768
  ds_read_b128 a[204:207], v135 offset:1024
  s_add_u32 s30, s30, 8192
  v_mfma_f32_16x16x32_bf16 v[32:35], a[208:211], v[208:211], v[32:35]
  buffer_load_dwordx4 v[252:255], v110, s[24:27], s30 offen offset:0 sc1
  v_mfma_f32_16x16x32_bf16 v[36:39], a[208:211], v[216:219], v[36:39]
  v_mfma_f32_16x16x32_bf16 v[36:39], a[192:195], v[212:215], v[36:39]
  v_mfma_f32_16x16x32_bf16 v[40:43], a[192:195], v[220:223], v[40:43]
  v_mfma_f32_16x16x32_bf16 v[40:43], a[208:211], v[224:227], v[40:43]
  v_mfma_f32_16x16x32_bf16 v[44:47], a[208:211], v[232:235], v[44:47]
  v_mfma_f32_16x16x32_bf16 v[44:47], a[192:195], v[228:231], v[44:47]
  s_waitcnt lgkmcnt(2)
  v_mfma_f32_16x16x32_bf16 v[48:51], v[184:187], v[204:207], v[48:51]
  ds_read_b128 v[144:147], v135 offset:2048
  ds_read_b128 a[180:183], v135 offset:19456
  v_mfma_f32_16x16x32_bf16 v[48:51], v[188:191], v[208:211], v[48:51]
  v_mfma_f32_16x16x32_bf16 v[52:55], v[188:191], v[216:219], v[52:55]
  v_mfma_f32_16x16x32_bf16 v[52:55], v[184:187], v[212:215], v[52:55]
  v_mfma_f32_16x16x32_bf16 v[56:59], v[184:187], v[220:223], v[56:59]
  v_mfma_f32_16x16x32_bf16 v[56:59], v[188:191], v[224:227], v[56:59]
  v_mfma_f32_16x16x32_bf16 v[60:63], v[188:191], v[232:235], v[60:63]
  v_mfma_f32_16x16x32_bf16 v[60:63], v[184:187], v[228:231], v[60:63]
  s_waitcnt lgkmcnt(2)
  v_mfma_f32_16x16x32_bf16 v[64:67], v[200:203], v[204:207], v[64:67]
  ds_read_b128 a[192:195], v135 offset:3072
  ds_read_b128 a[208:211], v122 offset:49152
  v_mfma_f32_16x16x32_bf16 v[64:67], a[204:207], v[208:211], v[64:67]
  v_mfma_f32_16x16x32_bf16 v[68:71], a[204:207], v[216:219], v[68:71]
  v_mfma_f32_16x16x32_bf16 v[68:71], v[200:203], v[212:215], v[68:71]
  v_mfma_f32_16x16x32_bf16 v[72:75], v[200:203], v[220:223], v[72:75]
  v_mfma_f32_16x16x32_bf16 v[72:75], a[204:207], v[224:227], v[72:75]
  v_mfma_f32_16x16x32_bf16 v[76:79], a[204:207], v[232:235], v[76:79]
  v_mfma_f32_16x16x32_bf16 v[76:79], v[200:203], v[228:231], v[76:79]
  s_waitcnt vmcnt(9) lgkmcnt(2)
  v_mfma_f32_16x16x32_bf16 v[0:3], v[144:147], v[236:239], v[0:3]
  ds_read_b128 v[184:187], v135 offset:16384
  ds_read_b128 v[188:191], v122 offset:50176
  v_mfma_f32_16x16x32_bf16 v[0:3], a[180:183], v[240:243], v[0:3]
  buffer_load_dwordx4 v[200:203], v110, s[24:27], s30 offen offset:1024 sc1
  s_xor_b32 s38, s40, 1
  s_lshl_b32 s38, s38, 2
  v_mfma_f32_16x16x32_bf16 v[4:7], a[180:183], v[248:251], v[4:7]
  s_add_u32 s38, s38, s3
  s_lshl_b32 s38, s38, 13
  v_mfma_f32_16x16x32_bf16 v[4:7], v[144:147], v[244:247], v[4:7]
  s_add_u32 s38, s38, 25165824
  s_add_u32 s39, s38, 4096
  v_mfma_f32_16x16x32_bf16 v[8:11], v[144:147], v[136:139], v[8:11]
  buffer_load_dwordx4 a[204:207], v111, s[24:27], s30 offen offset:0 sc1
  v_mfma_f32_16x16x32_bf16 v[8:11], a[180:183], v[140:143], v[8:11]
  v_mfma_f32_16x16x32_bf16 v[12:15], a[180:183], v[152:155], v[12:15]
  v_mfma_f32_16x16x32_bf16 v[12:15], v[144:147], v[148:151], v[12:15]
  s_waitcnt lgkmcnt(2)
  v_mfma_f32_16x16x32_bf16 v[16:19], a[192:195], v[236:239], v[16:19]
  ds_read_b128 v[204:207], v135 offset:17408
  ds_read_b128 v[208:211], v122 offset:51200
  v_mfma_f32_16x16x32_bf16 v[16:19], a[208:211], v[240:243], v[16:19]
  buffer_load_dwordx4 v[212:215], v111, s[24:27], s30 offen offset:1024 sc1
  v_mfma_f32_16x16x32_bf16 v[20:23], a[208:211], v[248:251], v[20:23]
  ds_write_b128 v118, v[4:7] offset:0
  ds_write_b128 v118, v[8:11] offset:5120
  v_mfma_f32_16x16x32_bf16 v[20:23], a[192:195], v[244:247], v[20:23]
  ds_write_b128 v118, v[12:15] offset:10240
  v_mfma_f32_16x16x32_bf16 v[24:27], a[192:195], v[136:139], v[24:27]
  buffer_load_dwordx4 v[216:219], v112, s[24:27], s30 offen offset:0 sc1
  v_mfma_f32_16x16x32_bf16 v[24:27], a[208:211], v[140:143], v[24:27]
  v_mfma_f32_16x16x32_bf16 v[28:31], a[208:211], v[152:155], v[28:31]
  v_mfma_f32_16x16x32_bf16 v[28:31], a[192:195], v[148:151], v[28:31]
  s_waitcnt lgkmcnt(5)
  v_mfma_f32_16x16x32_bf16 v[32:35], v[184:187], v[236:239], v[32:35]
  ds_read_b128 v[220:223], v135 offset:18432
  ds_read_b128 v[224:227], v122 offset:52224
  v_mfma_f32_16x16x32_bf16 v[32:35], v[188:191], v[240:243], v[32:35]
  buffer_load_dwordx4 v[228:231], v112, s[24:27], s30 offen offset:1024 sc1
  v_mfma_f32_16x16x32_bf16 v[36:39], v[188:191], v[248:251], v[36:39]
  ds_write_b128 v118, v[20:23] offset:1024
  ds_write_b128 v118, v[24:27] offset:6144
  v_mfma_f32_16x16x32_bf16 v[36:39], v[184:187], v[244:247], v[36:39]
  ds_write_b128 v118, v[28:31] offset:11264
  v_mfma_f32_16x16x32_bf16 v[40:43], v[184:187], v[136:139], v[40:43]
  buffer_load_dwordx4 v[232:235], v113, s[24:27], s30 offen offset:0 sc1
  v_mfma_f32_16x16x32_bf16 v[40:43], v[188:191], v[140:143], v[40:43]
  v_mfma_f32_16x16x32_bf16 v[44:47], v[188:191], v[152:155], v[44:47]
  v_mfma_f32_16x16x32_bf16 v[44:47], v[184:187], v[148:151], v[44:47]
  s_waitcnt lgkmcnt(8)
  v_mfma_f32_16x16x32_bf16 v[48:51], v[204:207], v[236:239], v[48:51]
  buffer_load_dwordx4 v[144:147], v113, s[24:27], s30 offen offset:1024 sc1
  v_mfma_f32_16x16x32_bf16 v[48:51], v[208:211], v[240:243], v[48:51]
  ds_write_b128 v118, v[36:39] offset:2048
  v_mfma_f32_16x16x32_bf16 v[52:55], v[208:211], v[248:251], v[52:55]
  ds_write_b128 v118, v[40:43] offset:7168
  v_mfma_f32_16x16x32_bf16 v[52:55], v[204:207], v[244:247], v[52:55]
  ds_write_b128 v118, v[44:47] offset:12288
  v_mfma_f32_16x16x32_bf16 v[56:59], v[204:207], v[136:139], v[56:59]
  s_add_u32 s30, s30, 8192
  buffer_load_dwordx4 a[180:183], v110, s[24:27], s30 offen offset:0 sc1
  v_mfma_f32_16x16x32_bf16 v[56:59], v[208:211], v[140:143], v[56:59]
  v_mfma_f32_16x16x32_bf16 v[60:63], v[208:211], v[152:155], v[60:63]
  v_mfma_f32_16x16x32_bf16 v[60:63], v[204:207], v[148:151], v[60:63]
  s_waitcnt lgkmcnt(6)
  v_mfma_f32_16x16x32_bf16 v[64:67], v[220:223], v[236:239], v[64:67]
  buffer_load_dwordx4 a[192:195], v110, s[24:27], s30 offen offset:1024 sc1
  v_mfma_f32_16x16x32_bf16 v[64:67], v[224:227], v[240:243], v[64:67]
  ds_write_b128 v118, v[52:55] offset:3072
  v_mfma_f32_16x16x32_bf16 v[68:71], v[224:227], v[248:251], v[68:71]
  ds_write_b128 v118, v[56:59] offset:8192
  v_mfma_f32_16x16x32_bf16 v[68:71], v[220:223], v[244:247], v[68:71]
  ds_write_b128 v118, v[60:63] offset:13312
  v_mfma_f32_16x16x32_bf16 v[72:75], v[220:223], v[136:139], v[72:75]
  buffer_load_dwordx4 a[208:211], v111, s[24:27], s30 offen offset:0 sc1
  v_mfma_f32_16x16x32_bf16 v[72:75], v[224:227], v[140:143], v[72:75]
  v_mfma_f32_16x16x32_bf16 v[76:79], v[224:227], v[152:155], v[76:79]
  v_mfma_f32_16x16x32_bf16 v[76:79], v[220:223], v[148:151], v[76:79]
  s_nop 1
  ds_write_b128 v118, v[68:71] offset:4096
  s_nop 2
  ds_write_b128 v118, v[72:75] offset:9216
  s_nop 0
  ds_write_b128 v118, v[76:79] offset:14336
  buffer_load_dwordx4 v[184:187], v111, s[24:27], s30 offen offset:1024 sc1
  buffer_load_dwordx4 v[188:191], v112, s[24:27], s30 offen offset:0 sc1
  buffer_load_dwordx4 v[204:207], v112, s[24:27], s30 offen offset:1024 sc1
  buffer_load_dwordx4 v[208:211], v113, s[24:27], s30 offen offset:0 sc1
  buffer_load_dwordx4 v[220:223], v113, s[24:27], s30 offen offset:1024 sc1
  s_add_u32 s30, s30, 8192
  buffer_load_dwordx4 v[224:227], v110, s[24:27], s30 offen offset:0 sc1
  buffer_load_dwordx4 v[236:239], v110, s[24:27], s30 offen offset:1024 sc1
  buffer_load_dwordx4 v[240:243], v111, s[24:27], s30 offen offset:0 sc1
  buffer_load_dwordx4 v[244:247], v111, s[24:27], s30 offen offset:1024 sc1
  buffer_load_dwordx4 v[248:251], v112, s[24:27], s30 offen offset:0 sc1
  buffer_load_dwordx4 v[136:139], v112, s[24:27], s30 offen offset:1024 sc1
  buffer_load_dwordx4 v[140:143], v113, s[24:27], s30 offen offset:0 sc1
  buffer_load_dwordx4 v[148:151], v113, s[24:27], s30 offen offset:1024 sc1
  s_add_u32 s30, s30, 8192
  buffer_load_dwordx4 v[152:155], v110, s[24:27], s30 offen offset:0 sc1
  s_waitcnt lgkmcnt(0)
  s_barrier
  ds_read_b128 v[4:7], v119 offset:0
  ds_read_b128 v[8:11], v120 offset:5120
  ds_read_b128 v[12:15], v121 offset:10240
  ds_read_b128 v[20:23], v119 offset:1024
  ds_read_b128 v[24:27], v120 offset:6144
  ds_read_b128 v[28:31], v121 offset:11264
  ds_read_b128 v[36:39], v119 offset:2048
  ds_read_b128 v[40:43], v120 offset:7168
  ds_read_b128 v[44:47], v121 offset:12288
  ds_read_b128 v[52:55], v119 offset:3072
  ds_read_b128 v[56:59], v120 offset:8192
  ds_read_b128 v[60:63], v121 offset:13312
  ds_read_b128 v[68:71], v119 offset:4096
  ds_read_b128 v[72:75], v120 offset:9216
  ds_read_b128 v[76:79], v121 offset:14336
  s_waitcnt lgkmcnt(12)
  v_add_f32 v4, v4, v8
  v_add_f32 v5, v5, v9
  v_add_f32 v6, v6, v10
  v_add_f32 v7, v7, v11
  v_add_f32 v0, v0, v12
  v_add_f32 v1, v1, v13
  v_add_f32 v2, v2, v14
  v_add_f32 v3, v3, v15
  v_add_f32 v0, v0, v4
  v_add_f32 v1, v1, v5
  v_add_f32 v2, v2, v6
  v_add_f32 v3, v3, v7
  buffer_store_dwordx4 v[0:3], v114, s[24:27], s38 offen offset:0 sc1
  s_waitcnt vmcnt(26)
  s_nop 0
  v_mfma_f32_16x16x32_bf16 v[0:3], a[212:215], a[184:187], 0
  s_waitcnt lgkmcnt(9)
  v_add_f32 v20, v20, v24
  v_add_f32 v21, v21, v25
  v_mfma_f32_16x16x32_bf16 v[0:3], a[232:235], a[188:191], v[0:3]
  v_add_f32 v22, v22, v26
  v_add_f32 v23, v23, v27
  v_mfma_f32_16x16x32_bf16 v[4:7], a[232:235], a[200:203], 0
  v_add_f32 v16, v16, v28
  v_add_f32 v17, v17, v29
  v_mfma_f32_16x16x32_bf16 v[4:7], a[212:215], a[196:199], v[4:7]
  v_add_f32 v18, v18, v30
  v_add_f32 v19, v19, v31
  v_mfma_f32_16x16x32_bf16 v[8:11], a[212:215], v[176:179], 0
  v_add_f32 v16, v16, v20
  v_add_f32 v17, v17, v21
  v_mfma_f32_16x16x32_bf16 v[8:11], a[232:235], v[180:183], v[8:11]
  v_add_f32 v18, v18, v22
  v_add_f32 v19, v19, v23
  v_mfma_f32_16x16x32_bf16 v[12:15], a[232:235], v[196:199], 0
  buffer_store_dwordx4 v[16:19], v114, s[24:27], s38 offen offset:1024 sc1
  s_waitcnt lgkmcnt(6)
  v_mfma_f32_16x16x32_bf16 v[12:15], a[212:215], v[192:195], v[12:15]
  v_add_f32 v36, v36, v40
  v_add_f32 v37, v37, v41
  v_mfma_f32_16x16x32_bf16 v[16:19], a[216:219], a[184:187], 0
  buffer_load_dwordx4 a[212:215], v110, s[24:27], s30 offen offset:1024 sc1
  v_mfma_f32_16x16x32_bf16 v[16:19], a[236:239], a[188:191], v[16:19]
  v_add_f32 v38, v38, v42
  v_add_f32 v39, v39, v43
  v_mfma_f32_16x16x32_bf16 v[20:23], a[236:239], a[200:203], 0
  v_add_f32 v32, v32, v44
  v_add_f32 v33, v33, v45
  v_mfma_f32_16x16x32_bf16 v[20:23], a[216:219], a[196:199], v[20:23]
  v_add_f32 v34, v34, v46
  v_add_f32 v35, v35, v47
  v_mfma_f32_16x16x32_bf16 v[24:27], a[216:219], v[176:179], 0
  buffer_load_dwordx4 a[232:235], v111, s[24:27], s30 offen offset:0 sc1
  v_mfma_f32_16x16x32_bf16 v[24:27], a[236:239], v[180:183], v[24:27]
  v_add_f32 v32, v32, v36
  v_add_f32 v33, v33, v37
  v_mfma_f32_16x16x32_bf16 v[28:31], a[236:239], v[196:199], 0
  v_add_f32 v34, v34, v38
  v_add_f32 v35, v35, v39
  v_mfma_f32_16x16x32_bf16 v[28:31], a[216:219], v[192:195], v[28:31]
  buffer_store_dwordx4 v[32:35], v114, s[24:27], s38 offen offset:2048 sc1
  s_waitcnt lgkmcnt(3)
  s_nop 0
  v_mfma_f32_16x16x32_bf16 v[32:35], a[220:223], a[184:187], 0
  buffer_load_dwordx4 a[216:219], v111, s[24:27], s30 offen offset:1024 sc1
  v_mfma_f32_16x16x32_bf16 v[32:35], a[240:243], a[188:191], v[32:35]
  v_add_f32 v52, v52, v56
  v_add_f32 v53, v53, v57
  v_mfma_f32_16x16x32_bf16 v[36:39], a[240:243], a[200:203], 0
  v_add_f32 v54, v54, v58
  v_add_f32 v55, v55, v59
  v_mfma_f32_16x16x32_bf16 v[36:39], a[220:223], a[196:199], v[36:39]
  v_add_f32 v48, v48, v60
  v_add_f32 v49, v49, v61
  v_mfma_f32_16x16x32_bf16 v[40:43], a[220:223], v[176:179], 0
  buffer_load_dwordx4 a[236:239], v112, s[24:27], s30 offen offset:0 sc1
  v_mfma_f32_16x16x32_bf16 v[40:43], a[240:243], v[180:183], v[40:43]
  v_add_f32 v50, v50, v62
  v_add_f32 v51, v51, v63
  v_mfma_f32_16x16x32_bf16 v[44:47], a[240:243], v[196:199], 0
  v_add_f32 v48, v48, v52
  v_add_f32 v49, v49, v53
  v_mfma_f32_16x16x32_bf16 v[44:47], a[220:223], v[192:195], v[44:47]
  v_add_f32 v50, v50, v54
  v_add_f32 v51, v51, v55
  buffer_store_dwordx4 v[48:51], v114, s[24:27], s38 offen offset:3072 sc1
  s_nop 1
  v_mfma_f32_16x16x32_bf16 v[48:51], a[224:227], a[184:187], 0
  buffer_load_dwordx4 a[220:223], v112, s[24:27], s30 offen offset:1024 sc1
  s_waitcnt lgkmcnt(0)
  v_mfma_f32_16x16x32_bf16 v[48:51], a[244:247], a[188:191], v[48:51]
  v_add_f32 v68, v68, v72
  v_add_f32 v69, v69, v73
  v_mfma_f32_16x16x32_bf16 v[52:55], a[244:247], a[200:203], 0
  v_add_f32 v70, v70, v74
  v_add_f32 v71, v71, v75
  v_mfma_f32_16x16x32_bf16 v[52:55], a[224:227], a[196:199], v[52:55]
  v_add_f32 v64, v64, v76
  v_add_f32 v65, v65, v77
  v_mfma_f32_16x16x32_bf16 v[56:59], a[224:227], v[176:179], 0
  buffer_load_dwordx4 a[240:243], v113, s[24:27], s30 offen offset:0 sc1
  v_mfma_f32_16x16x32_bf16 v[56:59], a[244:247], v[180:183], v[56:59]
  v_add_f32 v66, v66, v78
  v_add_f32 v67, v67, v79
  v_mfma_f32_16x16x32_bf16 v[60:63], a[244:247], v[196:199], 0
  v_add_f32 v64, v64, v68
  v_add_f32 v65, v65, v69
  v_mfma_f32_16x16x32_bf16 v[60:63], a[224:227], v[192:195], v[60:63]
  v_add_f32 v66, v66, v70
  v_add_f32 v67, v67, v71
  buffer_store_dwordx4 v[64:67], v114, s[24:27], s39 offen offset:0 sc1
  s_nop 1
  v_mfma_f32_16x16x32_bf16 v[64:67], a[228:231], a[184:187], 0
  buffer_load_dwordx4 a[224:227], v113, s[24:27], s30 offen offset:1024 sc1
  s_xor_b32 s38, s40, 1
  s_lshl_b32 s38, s38, 7
  v_mfma_f32_16x16x32_bf16 v[64:67], a[248:251], a[188:191], v[64:67]
  s_add_u32 s38, s38, 2834432
  v_mov_b32 v126, 1073741824
  v_writelane_b32 v126, s38, 0
  v_mfma_f32_16x16x32_bf16 v[68:71], a[248:251], a[200:203], 0
  v_mov_b32 v127, 1
  v_mfma_f32_16x16x32_bf16 v[68:71], a[228:231], a[196:199], v[68:71]
  s_xor_b32 s38, s38, 128
  v_mov_b32 v133, s38
  v_mov_b32 v134, 4
  v_mfma_f32_16x16x32_bf16 v[72:75], a[228:231], v[176:179], 0
  s_add_u32 s30, s30, 8192
  buffer_load_dwordx4 a[244:247], v110, s[24:27], s30 offen offset:0 sc1
  v_mfma_f32_16x16x32_bf16 v[72:75], a[248:251], v[180:183], v[72:75]
  v_mfma_f32_16x16x32_bf16 v[76:79], a[248:251], v[196:199], 0
  v_mfma_f32_16x16x32_bf16 v[76:79], a[228:231], v[192:195], v[76:79]
  s_waitcnt vmcnt(30)
  v_mfma_f32_16x16x32_bf16 v[0:3], a[252:255], v[252:255], v[0:3]
  buffer_load_dwordx4 a[228:231], v110, s[24:27], s30 offen offset:1024 sc1
  v_mfma_f32_16x16x32_bf16 v[0:3], a[144:147], v[200:203], v[0:3]
  v_mfma_f32_16x16x32_bf16 v[4:7], a[144:147], v[212:215], v[4:7]
  v_mfma_f32_16x16x32_bf16 v[4:7], a[252:255], a[204:207], v[4:7]
  v_mfma_f32_16x16x32_bf16 v[8:11], a[252:255], v[216:219], v[8:11]
  buffer_load_dwordx4 a[248:251], v111, s[24:27], s30 offen offset:0 sc1
  v_mfma_f32_16x16x32_bf16 v[8:11], a[144:147], v[228:231], v[8:11]
  v_mfma_f32_16x16x32_bf16 v[12:15], a[144:147], v[144:147], v[12:15]
  v_mfma_f32_16x16x32_bf16 v[12:15], a[252:255], v[232:235], v[12:15]
  v_mfma_f32_16x16x32_bf16 v[16:19], a[128:131], v[252:255], v[16:19]
  buffer_load_dwordx4 a[184:187], v111, s[24:27], s30 offen offset:1024 sc1
  v_mfma_f32_16x16x32_bf16 v[16:19], a[148:151], v[200:203], v[16:19]
  v_mfma_f32_16x16x32_bf16 v[20:23], a[148:151], v[212:215], v[20:23]
  v_mfma_f32_16x16x32_bf16 v[20:23], a[128:131], a[204:207], v[20:23]
  v_mfma_f32_16x16x32_bf16 v[24:27], a[128:131], v[216:219], v[24:27]
  buffer_load_dwordx4 a[188:191], v112, s[24:27], s30 offen offset:0 sc1
  v_mfma_f32_16x16x32_bf16 v[24:27], a[148:151], v[228:231], v[24:27]
  v_mfma_f32_16x16x32_bf16 v[28:31], a[148:151], v[144:147], v[28:31]
  v_mfma_f32_16x16x32_bf16 v[28:31], a[128:131], v[232:235], v[28:31]
  v_mfma_f32_16x16x32_bf16 v[32:35], a[132:135], v[252:255], v[32:35]
  buffer_load_dwordx4 a[196:199], v112, s[24:27], s30 offen offset:1024 sc1
  v_mfma_f32_16x16x32_bf16 v[32:35], a[152:155], v[200:203], v[32:35]
  v_mfma_f32_16x16x32_bf16 v[36:39], a[152:155], v[212:215], v[36:39]
  v_mfma_f32_16x16x32_bf16 v[36:39], a[132:135], a[204:207], v[36:39]
  v_mfma_f32_16x16x32_bf16 v[40:43], a[132:135], v[216:219], v[40:43]
  buffer_load_dwordx4 a[200:203], v113, s[24:27], s30 offen offset:0 sc1
  v_mfma_f32_16x16x32_bf16 v[40:43], a[152:155], v[228:231], v[40:43]
  v_mfma_f32_16x16x32_bf16 v[44:47], a[152:155], v[144:147], v[44:47]
  v_mfma_f32_16x16x32_bf16 v[44:47], a[132:135], v[232:235], v[44:47]
  v_mfma_f32_16x16x32_bf16 v[48:51], a[136:139], v[252:255], v[48:51]
  buffer_load_dwordx4 v[176:179], v113, s[24:27], s30 offen offset:1024 sc1
  v_mfma_f32_16x16x32_bf16 v[48:51], a[156:159], v[200:203], v[48:51]
  v_mfma_f32_16x16x32_bf16 v[52:55], a[156:159], v[212:215], v[52:55]
  v_mfma_f32_16x16x32_bf16 v[52:55], a[136:139], a[204:207], v[52:55]
  v_mfma_f32_16x16x32_bf16 v[56:59], a[136:139], v[216:219], v[56:59]
  s_add_u32 s30, s30, 8192
  buffer_load_dwordx4 v[180:183], v110, s[24:27], s30 offen offset:0 sc1
  v_mfma_f32_16x16x32_bf16 v[56:59], a[156:159], v[228:231], v[56:59]
  v_mfma_f32_16x16x32_bf16 v[60:63], a[156:159], v[144:147], v[60:63]
  v_mfma_f32_16x16x32_bf16 v[60:63], a[136:139], v[232:235], v[60:63]
  v_mfma_f32_16x16x32_bf16 v[64:67], a[140:143], v[252:255], v[64:67]
  buffer_load_dwordx4 v[192:195], v110, s[24:27], s30 offen offset:1024 sc1
  v_mfma_f32_16x16x32_bf16 v[64:67], a[0:3], v[200:203], v[64:67]
  v_mfma_f32_16x16x32_bf16 v[68:71], a[0:3], v[212:215], v[68:71]
  v_mfma_f32_16x16x32_bf16 v[68:71], a[140:143], a[204:207], v[68:71]
  v_mfma_f32_16x16x32_bf16 v[72:75], a[140:143], v[216:219], v[72:75]
  buffer_load_dwordx4 v[196:199], v111, s[24:27], s30 offen offset:0 sc1
  v_mfma_f32_16x16x32_bf16 v[72:75], a[0:3], v[228:231], v[72:75]
  v_mfma_f32_16x16x32_bf16 v[76:79], a[0:3], v[144:147], v[76:79]
  v_mfma_f32_16x16x32_bf16 v[76:79], a[140:143], v[232:235], v[76:79]
  s_waitcnt vmcnt(32)
  v_mfma_f32_16x16x32_bf16 v[0:3], a[4:7], a[180:183], v[0:3]
  buffer_load_dwordx4 a[252:255], v111, s[24:27], s30 offen offset:1024 sc1
  v_mfma_f32_16x16x32_bf16 v[0:3], a[24:27], a[192:195], v[0:3]
  v_mfma_f32_16x16x32_bf16 v[4:7], a[24:27], v[184:187], v[4:7]
  v_mfma_f32_16x16x32_bf16 v[4:7], a[4:7], a[208:211], v[4:7]
  v_mfma_f32_16x16x32_bf16 v[8:11], a[4:7], v[188:191], v[8:11]
  buffer_load_dwordx4 a[144:147], v112, s[24:27], s30 offen offset:0 sc1
  v_mfma_f32_16x16x32_bf16 v[8:11], a[24:27], v[204:207], v[8:11]
  v_mfma_f32_16x16x32_bf16 v[12:15], a[24:27], v[220:223], v[12:15]
  v_mfma_f32_16x16x32_bf16 v[12:15], a[4:7], v[208:211], v[12:15]
  v_mfma_f32_16x16x32_bf16 v[16:19], a[8:11], a[180:183], v[16:19]
  buffer_load_dwordx4 a[128:131], v112, s[24:27], s30 offen offset:1024 sc1
  v_mfma_f32_16x16x32_bf16 v[16:19], a[28:31], a[192:195], v[16:19]
  v_mfma_f32_16x16x32_bf16 v[20:23], a[28:31], v[184:187], v[20:23]
  v_mfma_f32_16x16x32_bf16 v[20:23], a[8:11], a[208:211], v[20:23]
  v_mfma_f32_16x16x32_bf16 v[24:27], a[8:11], v[188:191], v[24:27]
  buffer_load_dwordx4 a[148:151], v113, s[24:27], s30 offen offset:0 sc1
  v_mfma_f32_16x16x32_bf16 v[24:27], a[28:31], v[204:207], v[24:27]
  v_mfma_f32_16x16x32_bf16 v[28:31], a[28:31], v[220:223], v[28:31]
  v_mfma_f32_16x16x32_bf16 v[28:31], a[8:11], v[208:211], v[28:31]
  v_mfma_f32_16x16x32_bf16 v[32:35], a[12:15], a[180:183], v[32:35]
  buffer_load_dwordx4 a[132:135], v113, s[24:27], s30 offen offset:1024 sc1
  v_mfma_f32_16x16x32_bf16 v[32:35], a[32:35], a[192:195], v[32:35]
  v_mfma_f32_16x16x32_bf16 v[36:39], a[32:35], v[184:187], v[36:39]
  v_mfma_f32_16x16x32_bf16 v[36:39], a[12:15], a[208:211], v[36:39]
  v_mfma_f32_16x16x32_bf16 v[40:43], a[12:15], v[188:191], v[40:43]
  s_add_u32 s30, s30, 8192
  buffer_load_dwordx4 a[152:155], v110, s[24:27], s30 offen offset:0 sc1
  v_mfma_f32_16x16x32_bf16 v[40:43], a[32:35], v[204:207], v[40:43]
  v_mfma_f32_16x16x32_bf16 v[44:47], a[32:35], v[220:223], v[44:47]
  v_mfma_f32_16x16x32_bf16 v[44:47], a[12:15], v[208:211], v[44:47]
  v_mfma_f32_16x16x32_bf16 v[48:51], a[16:19], a[180:183], v[48:51]
  buffer_load_dwordx4 a[136:139], v110, s[24:27], s30 offen offset:1024 sc1
  v_mfma_f32_16x16x32_bf16 v[48:51], a[36:39], a[192:195], v[48:51]
  v_mfma_f32_16x16x32_bf16 v[52:55], a[36:39], v[184:187], v[52:55]
  v_mfma_f32_16x16x32_bf16 v[52:55], a[16:19], a[208:211], v[52:55]
  v_mfma_f32_16x16x32_bf16 v[56:59], a[16:19], v[188:191], v[56:59]
  buffer_load_dwordx4 a[156:159], v111, s[24:27], s30 offen offset:0 sc1
  v_mfma_f32_16x16x32_bf16 v[56:59], a[36:39], v[204:207], v[56:59]
  v_mfma_f32_16x16x32_bf16 v[60:63], a[36:39], v[220:223], v[60:63]
  v_mfma_f32_16x16x32_bf16 v[60:63], a[16:19], v[208:211], v[60:63]
  v_mfma_f32_16x16x32_bf16 v[64:67], a[20:23], a[180:183], v[64:67]
  buffer_load_dwordx4 a[140:143], v111, s[24:27], s30 offen offset:1024 sc1
  v_mfma_f32_16x16x32_bf16 v[64:67], a[40:43], a[192:195], v[64:67]
  v_mfma_f32_16x16x32_bf16 v[68:71], a[40:43], v[184:187], v[68:71]
  v_mfma_f32_16x16x32_bf16 v[68:71], a[20:23], a[208:211], v[68:71]
  v_mfma_f32_16x16x32_bf16 v[72:75], a[20:23], v[188:191], v[72:75]
  buffer_load_dwordx4 a[0:3], v112, s[24:27], s30 offen offset:0 sc1
  v_mfma_f32_16x16x32_bf16 v[72:75], a[40:43], v[204:207], v[72:75]
  v_mfma_f32_16x16x32_bf16 v[76:79], a[40:43], v[220:223], v[76:79]
  v_mfma_f32_16x16x32_bf16 v[76:79], a[20:23], v[208:211], v[76:79]
  s_waitcnt vmcnt(34)
  v_mfma_f32_16x16x32_bf16 v[0:3], a[44:47], v[224:227], v[0:3]
  buffer_load_dwordx4 v[252:255], v112, s[24:27], s30 offen offset:1024 sc1
  s_waitcnt vmcnt(23)
  v_mfma_f32_16x16x32_bf16 v[0:3], a[64:67], v[236:239], v[0:3]
  buffer_atomic_add v127, v126, s[24:27], 0 offen
  v_mfma_f32_16x16x32_bf16 v[4:7], a[64:67], v[244:247], v[4:7]
  v_mfma_f32_16x16x32_bf16 v[4:7], a[44:47], v[240:243], v[4:7]
  v_mfma_f32_16x16x32_bf16 v[8:11], a[44:47], v[248:251], v[8:11]
  buffer_load_dwordx4 v[200:203], v113, s[24:27], s30 offen offset:0 sc1
  v_mfma_f32_16x16x32_bf16 v[8:11], a[64:67], v[136:139], v[8:11]
  v_mfma_f32_16x16x32_bf16 v[12:15], a[64:67], v[148:151], v[12:15]
  v_mfma_f32_16x16x32_bf16 v[12:15], a[44:47], v[140:143], v[12:15]
  v_mfma_f32_16x16x32_bf16 v[16:19], a[48:51], v[224:227], v[16:19]
  buffer_load_dwordx4 a[204:207], v113, s[24:27], s30 offen offset:1024 sc1
  v_mfma_f32_16x16x32_bf16 v[16:19], a[68:71], v[236:239], v[16:19]
  v_mfma_f32_16x16x32_bf16 v[20:23], a[68:71], v[244:247], v[20:23]
  v_mfma_f32_16x16x32_bf16 v[20:23], a[48:51], v[240:243], v[20:23]
  v_mfma_f32_16x16x32_bf16 v[24:27], a[48:51], v[248:251], v[24:27]
  s_add_u32 s30, s30, 8192
  v_mfma_f32_16x16x32_bf16 v[24:27], a[68:71], v[136:139], v[24:27]
  v_mfma_f32_16x16x32_bf16 v[28:31], a[68:71], v[148:151], v[28:31]
  v_mfma_f32_16x16x32_bf16 v[28:31], a[48:51], v[140:143], v[28:31]
  v_mfma_f32_16x16x32_bf16 v[32:35], a[52:55], v[224:227], v[32:35]
  v_mfma_f32_16x16x32_bf16 v[32:35], a[72:75], v[236:239], v[32:35]
  v_mfma_f32_16x16x32_bf16 v[36:39], a[72:75], v[244:247], v[36:39]
  v_mfma_f32_16x16x32_bf16 v[36:39], a[52:55], v[240:243], v[36:39]
  v_mfma_f32_16x16x32_bf16 v[40:43], a[52:55], v[248:251], v[40:43]
  v_mfma_f32_16x16x32_bf16 v[40:43], a[72:75], v[136:139], v[40:43]
  v_mfma_f32_16x16x32_bf16 v[44:47], a[72:75], v[148:151], v[44:47]
  v_mfma_f32_16x16x32_bf16 v[44:47], a[52:55], v[140:143], v[44:47]
  v_mfma_f32_16x16x32_bf16 v[48:51], a[56:59], v[224:227], v[48:51]
  v_mfma_f32_16x16x32_bf16 v[48:51], a[76:79], v[236:239], v[48:51]
  v_mfma_f32_16x16x32_bf16 v[52:55], a[76:79], v[244:247], v[52:55]
  v_mfma_f32_16x16x32_bf16 v[52:55], a[56:59], v[240:243], v[52:55]
  v_mfma_f32_16x16x32_bf16 v[56:59], a[56:59], v[248:251], v[56:59]
  v_mfma_f32_16x16x32_bf16 v[56:59], a[76:79], v[136:139], v[56:59]
  v_mfma_f32_16x16x32_bf16 v[60:63], a[76:79], v[148:151], v[60:63]
  v_mfma_f32_16x16x32_bf16 v[60:63], a[56:59], v[140:143], v[60:63]
  v_mfma_f32_16x16x32_bf16 v[64:67], a[60:63], v[224:227], v[64:67]
  v_mfma_f32_16x16x32_bf16 v[64:67], a[80:83], v[236:239], v[64:67]
  v_mfma_f32_16x16x32_bf16 v[68:71], a[80:83], v[244:247], v[68:71]
  v_mfma_f32_16x16x32_bf16 v[68:71], a[60:63], v[240:243], v[68:71]
  v_mfma_f32_16x16x32_bf16 v[72:75], a[60:63], v[248:251], v[72:75]
  v_mfma_f32_16x16x32_bf16 v[72:75], a[80:83], v[136:139], v[72:75]
  v_mfma_f32_16x16x32_bf16 v[76:79], a[80:83], v[148:151], v[76:79]
  v_mfma_f32_16x16x32_bf16 v[76:79], a[60:63], v[140:143], v[76:79]
  s_waitcnt vmcnt(25)
  v_mfma_f32_16x16x32_bf16 v[0:3], a[84:87], v[152:155], v[0:3]
  v_mfma_f32_16x16x32_bf16 v[0:3], a[104:107], a[212:215], v[0:3]
  v_mfma_f32_16x16x32_bf16 v[4:7], a[104:107], a[216:219], v[4:7]
  v_mfma_f32_16x16x32_bf16 v[4:7], a[84:87], a[232:235], v[4:7]
  v_mfma_f32_16x16x32_bf16 v[8:11], a[84:87], a[236:239], v[8:11]
  v_mfma_f32_16x16x32_bf16 v[8:11], a[104:107], a[220:223], v[8:11]
  v_mfma_f32_16x16x32_bf16 v[12:15], a[104:107], a[224:227], v[12:15]
  v_mfma_f32_16x16x32_bf16 v[12:15], a[84:87], a[240:243], v[12:15]
  v_mfma_f32_16x16x32_bf16 v[16:19], a[88:91], v[152:155], v[16:19]
  v_mfma_f32_16x16x32_bf16 v[16:19], a[108:111], a[212:215], v[16:19]
  v_mfma_f32_16x16x32_bf16 v[20:23], a[108:111], a[216:219], v[20:23]
  v_mfma_f32_16x16x32_bf16 v[20:23], a[88:91], a[232:235], v[20:23]
  v_mfma_f32_16x16x32_bf16 v[24:27], a[88:91], a[236:239], v[24:27]
  v_mfma_f32_16x16x32_bf16 v[24:27], a[108:111], a[220:223], v[24:27]
  v_mfma_f32_16x16x32_bf16 v[28:31], a[108:111], a[224:227], v[28:31]
  v_mfma_f32_16x16x32_bf16 v[28:31], a[88:91], a[240:243], v[28:31]
  v_mfma_f32_16x16x32_bf16 v[32:35], a[92:95], v[152:155], v[32:35]
  v_mfma_f32_16x16x32_bf16 v[32:35], a[112:115], a[212:215], v[32:35]
  v_mfma_f32_16x16x32_bf16 v[36:39], a[112:115], a[216:219], v[36:39]
  v_mfma_f32_16x16x32_bf16 v[36:39], a[92:95], a[232:235], v[36:39]
  v_mfma_f32_16x16x32_bf16 v[40:43], a[92:95], a[236:239], v[40:43]
  v_mfma_f32_16x16x32_bf16 v[40:43], a[112:115], a[220:223], v[40:43]
  v_mfma_f32_16x16x32_bf16 v[44:47], a[112:115], a[224:227], v[44:47]
  v_mfma_f32_16x16x32_bf16 v[44:47], a[92:95], a[240:243], v[44:47]
  v_mfma_f32_16x16x32_bf16 v[48:51], a[96:99], v[152:155], v[48:51]
  v_mfma_f32_16x16x32_bf16 v[48:51], a[116:119], a[212:215], v[48:51]
  v_mfma_f32_16x16x32_bf16 v[52:55], a[116:119], a[216:219], v[52:55]
  v_mfma_f32_16x16x32_bf16 v[52:55], a[96:99], a[232:235], v[52:55]
  v_mfma_f32_16x16x32_bf16 v[56:59], a[96:99], a[236:239], v[56:59]
  v_mfma_f32_16x16x32_bf16 v[56:59], a[116:119], a[220:223], v[56:59]
  v_mfma_f32_16x16x32_bf16 v[60:63], a[116:119], a[224:227], v[60:63]
  v_mfma_f32_16x16x32_bf16 v[60:63], a[96:99], a[240:243], v[60:63]
  v_mfma_f32_16x16x32_bf16 v[64:67], a[100:103], v[152:155], v[64:67]
  ds_read_b128 v[212:215], v122 offset:0
  v_mfma_f32_16x16x32_bf16 v[64:67], a[120:123], a[212:215], v[64:67]
  v_mfma_f32_16x16x32_bf16 v[68:71], a[120:123], a[216:219], v[68:71]
  v_mfma_f32_16x16x32_bf16 v[68:71], a[100:103], a[232:235], v[68:71]
  v_mfma_f32_16x16x32_bf16 v[72:75], a[100:103], a[236:239], v[72:75]
  v_mfma_f32_16x16x32_bf16 v[72:75], a[120:123], a[220:223], v[72:75]
  v_mfma_f32_16x16x32_bf16 v[76:79], a[120:123], a[224:227], v[76:79]
  v_mfma_f32_16x16x32_bf16 v[76:79], a[100:103], a[240:243], v[76:79]
  s_waitcnt vmcnt(17)
  v_mfma_f32_16x16x32_bf16 v[0:3], a[124:127], a[244:247], v[0:3]
  ds_read_b128 v[216:219], v122 offset:1024
  buffer_load_dword v128, v133, s[24:27], 0 offen sc1
  s_xor_b32 s38, s40, 0
  s_lshl_b32 s38, s38, 2
  v_mfma_f32_16x16x32_bf16 v[0:3], a[176:179], a[228:231], v[0:3]
  s_add_u32 s38, s38, s3
  s_lshl_b32 s38, s38, 13
  v_mfma_f32_16x16x32_bf16 v[4:7], a[176:179], a[184:187], v[4:7]
  s_add_u32 s38, s38, 25165824
  s_add_u32 s39, s38, 4096
  v_mfma_f32_16x16x32_bf16 v[4:7], a[124:127], a[248:251], v[4:7]
  v_mfma_f32_16x16x32_bf16 v[8:11], a[124:127], a[188:191], v[8:11]
  v_mfma_f32_16x16x32_bf16 v[8:11], a[176:179], a[196:199], v[8:11]
  v_mfma_f32_16x16x32_bf16 v[12:15], a[176:179], v[176:179], v[12:15]
  v_mfma_f32_16x16x32_bf16 v[12:15], a[124:127], a[200:203], v[12:15]
  s_waitcnt lgkmcnt(1)
  v_mfma_f32_16x16x32_bf16 v[16:19], a[160:163], a[244:247], v[16:19]
  ds_read_b128 v[228:231], v122 offset:2048
  v_mfma_f32_16x16x32_bf16 v[16:19], v[212:215], a[228:231], v[16:19]
  v_mfma_f32_16x16x32_bf16 v[20:23], v[212:215], a[184:187], v[20:23]
  v_mfma_f32_16x16x32_bf16 v[20:23], a[160:163], a[248:251], v[20:23]
  v_mfma_f32_16x16x32_bf16 v[24:27], a[160:163], a[188:191], v[24:27]
  v_mfma_f32_16x16x32_bf16 v[24:27], v[212:215], a[196:199], v[24:27]
  v_mfma_f32_16x16x32_bf16 v[28:31], v[212:215], v[176:179], v[28:31]
  v_mfma_f32_16x16x32_bf16 v[28:31], a[160:163], a[200:203], v[28:31]
  s_waitcnt lgkmcnt(1)
  v_mfma_f32_16x16x32_bf16 v[32:35], a[164:167], a[244:247], v[32:35]
  ds_read_b128 v[232:235], v122 offset:3072
  v_mfma_f32_16x16x32_bf16 v[32:35], v[216:219], a[228:231], v[32:35]
  v_mfma_f32_16x16x32_bf16 v[36:39], v[216:219], a[184:187], v[36:39]
  v_mfma_f32_16x16x32_bf16 v[36:39], a[164:167], a[248:251], v[36:39]
  v_mfma_f32_16x16x32_bf16 v[40:43], a[164:167], a[188:191], v[40:43]
  v_mfma_f32_16x16x32_bf16 v[40:43], v[216:219], a[196:199], v[40:43]
  v_mfma_f32_16x16x32_bf16 v[44:47], v[216:219], v[176:179], v[44:47]
  v_mfma_f32_16x16x32_bf16 v[44:47], a[164:167], a[200:203], v[44:47]
  s_waitcnt lgkmcnt(1)
  v_mfma_f32_16x16x32_bf16 v[48:51], a[168:171], a[244:247], v[48:51]
  ds_read_b128 a[4:7], v122 offset:16384
  ds_read_b128 a[24:27], v122 offset:33792
  v_mfma_f32_16x16x32_bf16 v[48:51], v[228:231], a[228:231], v[48:51]
  v_mfma_f32_16x16x32_bf16 v[52:55], v[228:231], a[184:187], v[52:55]
  v_mfma_f32_16x16x32_bf16 v[52:55], a[168:171], a[248:251], v[52:55]
  v_mfma_f32_16x16x32_bf16 v[56:59], a[168:171], a[188:191], v[56:59]
  v_mfma_f32_16x16x32_bf16 v[56:59], v[228:231], a[196:199], v[56:59]
  v_mfma_f32_16x16x32_bf16 v[60:63], v[228:231], v[176:179], v[60:63]
  v_mfma_f32_16x16x32_bf16 v[60:63], a[168:171], a[200:203], v[60:63]
  s_waitcnt lgkmcnt(2)
  v_mfma_f32_16x16x32_bf16 v[64:67], a[172:175], a[244:247], v[64:67]
  ds_read_b128 a[8:11], v122 offset:17408
  ds_read_b128 a[28:31], v122 offset:34816
  v_mfma_f32_16x16x32_bf16 v[64:67], v[232:235], a[228:231], v[64:67]
  v_mfma_f32_16x16x32_bf16 v[68:71], v[232:235], a[184:187], v[68:71]
  v_mfma_f32_16x16x32_bf16 v[68:71], a[172:175], a[248:251], v[68:71]
  v_mfma_f32_16x16x32_bf16 v[72:75], a[172:175], a[188:191], v[72:75]
  v_mfma_f32_16x16x32_bf16 v[72:75], v[232:235], a[196:199], v[72:75]
  v_mfma_f32_16x16x32_bf16 v[76:79], v[232:235], v[176:179], v[76:79]
  v_mfma_f32_16x16x32_bf16 v[76:79], a[172:175], a[200:203], v[76:79]
  s_waitcnt vmcnt(10) lgkmcnt(2)
  v_mfma_f32_16x16x32_bf16 v[0:3], a[4:7], v[180:183], v[0:3]
  ds_read_b128 a[12:15], v122 offset:18432
  ds_read_b128 a[32:35], v122 offset:35840
  v_mfma_f32_16x16x32_bf16 v[0:3], a[24:27], v[192:195], v[0:3]
  v_mfma_f32_16x16x32_bf16 v[4:7], a[24:27], a[252:255], v[4:7]
  v_mfma_f32_16x16x32_bf16 v[4:7], a[4:7], v[196:199], v[4:7]
  v_mfma_f32_16x16x32_bf16 v[8:11], a[4:7], a[144:147], v[8:11]
  v_mfma_f32_16x16x32_bf16 v[8:11], a[24:27], a[128:131], v[8:11]
  v_mfma_f32_16x16x32_bf16 v[12:15], a[24:27], a[132:135], v[12:15]
  v_mfma_f32_16x16x32_bf16 v[12:15], a[4:7], a[148:151], v[12:15]
  s_waitcnt lgkmcnt(2)
  v_mfma_f32_16x16x32_bf16 v[16:19], a[8:11], v[180:183], v[16:19]
  ds_read_b128 a[16:19], v122 offset:19456
  ds_read_b128 a[36:39], v135 offset:0
  v_mfma_f32_16x16x32_bf16 v[16:19], a[28:31], v[192:195], v[16:19]
  v_mfma_f32_16x16x32_bf16 v[20:23], a[28:31], a[252:255], v[20:23]
  v_mfma_f32_16x16x32_bf16 v[20:23], a[8:11], v[196:199], v[20:23]
  v_mfma_f32_16x16x32_bf16 v[24:27], a[8:11], a[144:147], v[24:27]
  v_mfma_f32_16x16x32_bf16 v[24:27], a[28:31], a[128:131], v[24:27]
  v_mfma_f32_16x16x32_bf16 v[28:31], a[28:31], a[132:135], v[28:31]
  v_mfma_f32_16x16x32_bf16 v[28:31], a[8:11], a[148:151], v[28:31]
  s_waitcnt lgkmcnt(2)
  v_mfma_f32_16x16x32_bf16 v[32:35], a[12:15], v[180:183], v[32:35]
  ds_read_b128 a[20:23], v122 offset:32768
  ds_read_b128 a[40:43], v135 offset:1024
  v_mfma_f32_16x16x32_bf16 v[32:35], a[32:35], v[192:195], v[32:35]
  v_mfma_f32_16x16x32_bf16 v[36:39], a[32:35], a[252:255], v[36:39]
  v_mfma_f32_16x16x32_bf16 v[36:39], a[12:15], v[196:199], v[36:39]
  v_mfma_f32_16x16x32_bf16 v[40:43], a[12:15], a[144:147], v[40:43]
  v_mfma_f32_16x16x32_bf16 v[40:43], a[32:35], a[128:131], v[40:43]
  v_mfma_f32_16x16x32_bf16 v[44:47], a[32:35], a[132:135], v[44:47]
  v_mfma_f32_16x16x32_bf16 v[44:47], a[12:15], a[148:151], v[44:47]
  s_waitcnt lgkmcnt(2)
  v_mfma_f32_16x16x32_bf16 v[48:51], a[16:19], v[180:183], v[48:51]
  ds_read_b128 a[180:183], v135 offset:2048
  ds_read_b128 a[192:195], v135 offset:19456
  v_mfma_f32_16x16x32_bf16 v[48:51], a[36:39], v[192:195], v[48:51]
  v_mfma_f32_16x16x32_bf16 v[52:55], a[36:39], a[252:255], v[52:55]
  v_mfma_f32_16x16x32_bf16 v[52:55], a[16:19], v[196:199], v[52:55]
  v_mfma_f32_16x16x32_bf16 v[56:59], a[16:19], a[144:147], v[56:59]
  v_mfma_f32_16x16x32_bf16 v[56:59], a[36:39], a[128:131], v[56:59]
  v_mfma_f32_16x16x32_bf16 v[60:63], a[36:39], a[132:135], v[60:63]
  v_mfma_f32_16x16x32_bf16 v[60:63], a[16:19], a[148:151], v[60:63]
  s_waitcnt lgkmcnt(2)
  v_mfma_f32_16x16x32_bf16 v[64:67], a[20:23], v[180:183], v[64:67]
  ds_read_b128 a[208:211], v135 offset:3072
  ds_read_b128 v[184:187], v122 offset:49152
  v_mfma_f32_16x16x32_bf16 v[64:67], a[40:43], v[192:195], v[64:67]
  v_mfma_f32_16x16x32_bf16 v[68:71], a[40:43], a[252:255], v[68:71]
  v_mfma_f32_16x16x32_bf16 v[68:71], a[20:23], v[196:199], v[68:71]
  v_mfma_f32_16x16x32_bf16 v[72:75], a[20:23], a[144:147], v[72:75]
  v_mfma_f32_16x16x32_bf16 v[72:75], a[40:43], a[128:131], v[72:75]
  v_mfma_f32_16x16x32_bf16 v[76:79], a[40:43], a[132:135], v[76:79]
  v_mfma_f32_16x16x32_bf16 v[76:79], a[20:23], a[148:151], v[76:79]
  s_waitcnt vmcnt(0)
  v_cmp_lt_u32 vcc, v128, v134
  s_nop 0
  s_cbranch_vccz tail_partner
  s_mov_b32 s35, 32768
tail_spin2:
  s_sleep 2
  buffer_load_dword v128, v133, s[24:27], 0 offen sc1
  s_waitcnt vmcnt(0)
  v_cmp_lt_u32 vcc, v128, v134
  s_nop 0
  s_cbranch_vccz tail_partner
  s_sub_u32 s35, s35, 1
  s_cmp_lg_u32 s35, 0
  s_cbranch_scc1 tail_spin2
tail_partner:
  s_waitcnt lgkmcnt(2)
  v_mfma_f32_16x16x32_bf16 v[0:3], a[180:183], a[152:155], v[0:3]
  ds_read_b128 v[188:191], v135 offset:16384
  ds_read_b128 v[204:207], v122 offset:50176
  v_mfma_f32_16x16x32_bf16 v[0:3], a[192:195], a[136:139], v[0:3]
  buffer_load_dwordx4 v[136:139], v114, s[24:27], s38 offen offset:0 sc1
  v_mfma_f32_16x16x32_bf16 v[4:7], a[192:195], a[140:143], v[4:7]
  buffer_load_dwordx4 v[140:143], v114, s[24:27], s38 offen offset:1024 sc1
  v_mfma_f32_16x16x32_bf16 v[4:7], a[180:183], a[156:159], v[4:7]
  buffer_load_dwordx4 v[144:147], v114, s[24:27], s38 offen offset:2048 sc1
  v_mfma_f32_16x16x32_bf16 v[8:11], a[180:183], a[0:3], v[8:11]
  buffer_load_dwordx4 v[148:151], v114, s[24:27], s38 offen offset:3072 sc1
  v_mfma_f32_16x16x32_bf16 v[8:11], a[192:195], v[252:255], v[8:11]
  buffer_load_dwordx4 v[152:155], v114, s[24:27], s39 offen offset:0 sc1
  v_mfma_f32_16x16x32_bf16 v[12:15], a[192:195], a[204:207], v[12:15]
  v_mfma_f32_16x16x32_bf16 v[12:15], a[180:183], v[200:203], v[12:15]
  s_waitcnt lgkmcnt(2)
  v_mfma_f32_16x16x32_bf16 v[16:19], a[208:211], a[152:155], v[16:19]
  ds_read_b128 v[208:211], v135 offset:17408
  ds_read_b128 v[220:223], v122 offset:51200
  v_mfma_f32_16x16x32_bf16 v[16:19], v[184:187], a[136:139], v[16:19]
  ds_write_b128 v122, v[4:7] offset:0
  ds_write_b128 v122, v[8:11] offset:17408
  v_mfma_f32_16x16x32_bf16 v[20:23], v[184:187], a[140:143], v[20:23]
  ds_write_b128 v122, v[12:15] offset:34816
  v_mfma_f32_16x16x32_bf16 v[20:23], a[208:211], a[156:159], v[20:23]
  v_mfma_f32_16x16x32_bf16 v[24:27], a[208:211], a[0:3], v[24:27]
  v_mfma_f32_16x16x32_bf16 v[24:27], v[184:187], v[252:255], v[24:27]
  v_mfma_f32_16x16x32_bf16 v[28:31], v[184:187], a[204:207], v[28:31]
  v_mfma_f32_16x16x32_bf16 v[28:31], a[208:211], v[200:203], v[28:31]
  s_waitcnt lgkmcnt(5)
  v_mfma_f32_16x16x32_bf16 v[32:35], v[188:191], a[152:155], v[32:35]
  ds_read_b128 a[44:47], v135 offset:18432
  ds_read_b128 a[64:67], v122 offset:52224
  v_mfma_f32_16x16x32_bf16 v[32:35], v[204:207], a[136:139], v[32:35]
  ds_write_b128 v122, v[20:23] offset:1024
  ds_write_b128 v122, v[24:27] offset:18432
  v_mfma_f32_16x16x32_bf16 v[36:39], v[204:207], a[140:143], v[36:39]
  ds_write_b128 v122, v[28:31] offset:35840
  v_mfma_f32_16x16x32_bf16 v[36:39], v[188:191], a[156:159], v[36:39]
  v_mfma_f32_16x16x32_bf16 v[40:43], v[188:191], a[0:3], v[40:43]
  v_mfma_f32_16x16x32_bf16 v[40:43], v[204:207], v[252:255], v[40:43]
  v_mfma_f32_16x16x32_bf16 v[44:47], v[204:207], a[204:207], v[44:47]
  v_mfma_f32_16x16x32_bf16 v[44:47], v[188:191], v[200:203], v[44:47]
  s_waitcnt lgkmcnt(8)
  v_mfma_f32_16x16x32_bf16 v[48:51], v[208:211], a[152:155], v[48:51]
  v_mfma_f32_16x16x32_bf16 v[48:51], v[220:223], a[136:139], v[48:51]
  v_mfma_f32_16x16x32_bf16 v[52:55], v[220:223], a[140:143], v[52:55]
  ds_write_b128 v122, v[36:39] offset:2048
  v_mfma_f32_16x16x32_bf16 v[52:55], v[208:211], a[156:159], v[52:55]
  ds_write_b128 v122, v[40:43] offset:19456
  v_mfma_f32_16x16x32_bf16 v[56:59], v[208:211], a[0:3], v[56:59]
  ds_write_b128 v122, v[44:47] offset:49152
  v_mfma_f32_16x16x32_bf16 v[56:59], v[220:223], v[252:255], v[56:59]
  v_mfma_f32_16x16x32_bf16 v[60:63], v[220:223], a[204:207], v[60:63]
  v_mfma_f32_16x16x32_bf16 v[60:63], v[208:211], v[200:203], v[60:63]
  s_waitcnt lgkmcnt(6)
  v_mfma_f32_16x16x32_bf16 v[64:67], a[44:47], a[152:155], v[64:67]
  ds_write_b128 v122, v[52:55] offset:3072
  v_mfma_f32_16x16x32_bf16 v[64:67], a[64:67], a[136:139], v[64:67]
  v_mfma_f32_16x16x32_bf16 v[68:71], a[64:67], a[140:143], v[68:71]
  v_mfma_f32_16x16x32_bf16 v[68:71], a[44:47], a[156:159], v[68:71]
  ds_write_b128 v122, v[56:59] offset:32768
  v_mfma_f32_16x16x32_bf16 v[72:75], a[44:47], a[0:3], v[72:75]
  ds_write_b128 v122, v[60:63] offset:50176
  v_mfma_f32_16x16x32_bf16 v[72:75], a[64:67], v[252:255], v[72:75]
  v_mfma_f32_16x16x32_bf16 v[76:79], a[64:67], a[204:207], v[76:79]
  v_mfma_f32_16x16x32_bf16 v[76:79], a[44:47], v[200:203], v[76:79]
  s_nop 1
  ds_write_b128 v122, v[68:71] offset:16384
  s_nop 2
  ds_write_b128 v122, v[72:75] offset:33792
  s_nop 0
  ds_write_b128 v122, v[76:79] offset:51200
  s_waitcnt lgkmcnt(0)
  s_barrier
  ds_read_b128 v[4:7], v80 offset:0
  ds_read_b128 v[8:11], v81 offset:17408
  ds_read_b128 v[12:15], v82 offset:34816
  ds_read_b128 v[20:23], v80 offset:1024
  ds_read_b128 v[24:27], v81 offset:18432
  ds_read_b128 v[28:31], v82 offset:35840
  ds_read_b128 v[36:39], v80 offset:2048
  ds_read_b128 v[40:43], v81 offset:19456
  ds_read_b128 v[44:47], v82 offset:49152
  ds_read_b128 v[52:55], v80 offset:3072
  ds_read_b128 v[56:59], v81 offset:32768
  ds_read_b128 v[60:63], v82 offset:50176
  ds_read_b128 v[68:71], v80 offset:16384
  ds_read_b128 v[72:75], v81 offset:33792
  ds_read_b128 v[76:79], v82 offset:51200
  s_waitcnt vmcnt(4)
  v_add_f32 v0, v0, v136
  v_add_f32 v1, v1, v137
  v_add_f32 v2, v2, v138
  v_add_f32 v3, v3, v139
  s_waitcnt lgkmcnt(13)
  v_add_f32 v4, v4, v8
  v_add_f32 v5, v5, v9
  v_add_f32 v6, v6, v10
  v_add_f32 v7, v7, v11
  s_waitcnt lgkmcnt(12)
  v_add_f32 v0, v0, v12
  v_add_f32 v1, v1, v13
  v_add_f32 v2, v2, v14
  v_add_f32 v3, v3, v15
  v_add_f32 v0, v0, v4
  v_add_f32 v1, v1, v5
  v_add_f32 v2, v2, v6
  v_add_f32 v3, v3, v7
  v_cvt_pk_bf16_f32 v4, v0, v1
  v_cvt_pk_bf16_f32 v5, v2, v3
  v_lshlrev_b32 v0, 16, v4
  v_and_b32 v1, s34, v4
  v_lshlrev_b32 v2, 16, v5
  v_and_b32 v3, s34, v5
  v_mul_f32 v0, v0, v90
  v_mul_f32 v1, v1, v91
  v_mul_f32 v2, v2, v92
  v_mul_f32 v3, v3, v93
  v_cvt_pk_bf16_f32 v4, v0, v1
  v_cvt_pk_bf16_f32 v5, v2, v3
  v_lshlrev_b32 v0, 16, v4
  v_and_b32 v1, s34, v4
  v_lshlrev_b32 v2, 16, v5
  v_and_b32 v3, s34, v5
  v_add_f32 v0, v0, v156
  v_add_f32 v1, v1, v157
  v_add_f32 v2, v2, v158
  v_add_f32 v3, v3, v159
  v_cvt_pk_bf16_f32 v4, v0, v1
  v_cvt_pk_bf16_f32 v5, v2, v3
  buffer_store_dwordx2 v[4:5], v117, s[16:19], 0 offen offset:0
  s_waitcnt vmcnt(4)
  v_add_f32 v16, v16, v140
  v_add_f32 v17, v17, v141
  v_add_f32 v18, v18, v142
  v_add_f32 v19, v19, v143
  s_waitcnt lgkmcnt(10)
  v_add_f32 v20, v20, v24
  v_add_f32 v21, v21, v25
  v_add_f32 v22, v22, v26
  v_add_f32 v23, v23, v27
  s_waitcnt lgkmcnt(9)
  v_add_f32 v16, v16, v28
  v_add_f32 v17, v17, v29
  v_add_f32 v18, v18, v30
  v_add_f32 v19, v19, v31
  v_add_f32 v16, v16, v20
  v_add_f32 v17, v17, v21
  v_add_f32 v18, v18, v22
  v_add_f32 v19, v19, v23
  v_cvt_pk_bf16_f32 v20, v16, v17
  v_cvt_pk_bf16_f32 v21, v18, v19
  v_lshlrev_b32 v16, 16, v20
  v_and_b32 v17, s34, v20
  v_lshlrev_b32 v18, 16, v21
  v_and_b32 v19, s34, v21
  v_mul_f32 v16, v16, v94
  v_mul_f32 v17, v17, v95
  v_mul_f32 v18, v18, v96
  v_mul_f32 v19, v19, v97
  v_cvt_pk_bf16_f32 v20, v16, v17
  v_cvt_pk_bf16_f32 v21, v18, v19
  v_lshlrev_b32 v16, 16, v20
  v_and_b32 v17, s34, v20
  v_lshlrev_b32 v18, 16, v21
  v_and_b32 v19, s34, v21
  v_add_f32 v16, v16, v160
  v_add_f32 v17, v17, v161
  v_add_f32 v18, v18, v162
  v_add_f32 v19, v19, v163
  v_cvt_pk_bf16_f32 v20, v16, v17
  v_cvt_pk_bf16_f32 v21, v18, v19
  buffer_store_dwordx2 v[20:21], v117, s[16:19], 0 offen offset:32
  s_waitcnt vmcnt(4)
  v_add_f32 v32, v32, v144
  v_add_f32 v33, v33, v145
  v_add_f32 v34, v34, v146
  v_add_f32 v35, v35, v147
  s_waitcnt lgkmcnt(7)
  v_add_f32 v36, v36, v40
  v_add_f32 v37, v37, v41
  v_add_f32 v38, v38, v42
  v_add_f32 v39, v39, v43
  s_waitcnt lgkmcnt(6)
  v_add_f32 v32, v32, v44
  v_add_f32 v33, v33, v45
  v_add_f32 v34, v34, v46
  v_add_f32 v35, v35, v47
  v_add_f32 v32, v32, v36
  v_add_f32 v33, v33, v37
  v_add_f32 v34, v34, v38
  v_add_f32 v35, v35, v39
  v_cvt_pk_bf16_f32 v36, v32, v33
  v_cvt_pk_bf16_f32 v37, v34, v35
  v_lshlrev_b32 v32, 16, v36
  v_and_b32 v33, s34, v36
  v_lshlrev_b32 v34, 16, v37
  v_and_b32 v35, s34, v37
  v_mul_f32 v32, v32, v98
  v_mul_f32 v33, v33, v99
  v_mul_f32 v34, v34, v100
  v_mul_f32 v35, v35, v101
  v_cvt_pk_bf16_f32 v36, v32, v33
  v_cvt_pk_bf16_f32 v37, v34, v35
  v_lshlrev_b32 v32, 16, v36
  v_and_b32 v33, s34, v36
  v_lshlrev_b32 v34, 16, v37
  v_and_b32 v35, s34, v37
  v_add_f32 v32, v32, v164
  v_add_f32 v33, v33, v165
  v_add_f32 v34, v34, v166
  v_add_f32 v35, v35, v167
  v_cvt_pk_bf16_f32 v36, v32, v33
  v_cvt_pk_bf16_f32 v37, v34, v35
  buffer_store_dwordx2 v[36:37], v117, s[16:19], 0 offen offset:64
  s_waitcnt vmcnt(4)
  v_add_f32 v48, v48, v148
  v_add_f32 v49, v49, v149
  v_add_f32 v50, v50, v150
  v_add_f32 v51, v51, v151
  s_waitcnt lgkmcnt(4)
  v_add_f32 v52, v52, v56
  v_add_f32 v53, v53, v57
  v_add_f32 v54, v54, v58
  v_add_f32 v55, v55, v59
  s_waitcnt lgkmcnt(3)
  v_add_f32 v48, v48, v60
  v_add_f32 v49, v49, v61
  v_add_f32 v50, v50, v62
  v_add_f32 v51, v51, v63
  v_add_f32 v48, v48, v52
  v_add_f32 v49, v49, v53
  v_add_f32 v50, v50, v54
  v_add_f32 v51, v51, v55
  v_cvt_pk_bf16_f32 v52, v48, v49
  v_cvt_pk_bf16_f32 v53, v50, v51
  v_lshlrev_b32 v48, 16, v52
  v_and_b32 v49, s34, v52
  v_lshlrev_b32 v50, 16, v53
  v_and_b32 v51, s34, v53
  v_mul_f32 v48, v48, v102
  v_mul_f32 v49, v49, v103
  v_mul_f32 v50, v50, v104
  v_mul_f32 v51, v51, v105
  v_cvt_pk_bf16_f32 v52, v48, v49
  v_cvt_pk_bf16_f32 v53, v50, v51
  v_lshlrev_b32 v48, 16, v52
  v_and_b32 v49, s34, v52
  v_lshlrev_b32 v50, 16, v53
  v_and_b32 v51, s34, v53
  v_add_f32 v48, v48, v168
  v_add_f32 v49, v49, v169
  v_add_f32 v50, v50, v170
  v_add_f32 v51, v51, v171
  v_cvt_pk_bf16_f32 v52, v48, v49
  v_cvt_pk_bf16_f32 v53, v50, v51
  buffer_store_dwordx2 v[52:53], v117, s[16:19], 0 offen offset:96
  s_waitcnt vmcnt(4)
  v_add_f32 v64, v64, v152
  v_add_f32 v65, v65, v153
  v_add_f32 v66, v66, v154
  v_add_f32 v67, v67, v155
  s_waitcnt lgkmcnt(1)
  v_add_f32 v68, v68, v72
  v_add_f32 v69, v69, v73
  v_add_f32 v70, v70, v74
  v_add_f32 v71, v71, v75
  s_waitcnt lgkmcnt(0)
  v_add_f32 v64, v64, v76
  v_add_f32 v65, v65, v77
  v_add_f32 v66, v66, v78
  v_add_f32 v67, v67, v79
  v_add_f32 v64, v64, v68
  v_add_f32 v65, v65, v69
  v_add_f32 v66, v66, v70
  v_add_f32 v67, v67, v71
  v_cvt_pk_bf16_f32 v68, v64, v65
  v_cvt_pk_bf16_f32 v69, v66, v67
  v_lshlrev_b32 v64, 16, v68
  v_and_b32 v65, s34, v68
  v_lshlrev_b32 v66, 16, v69
  v_and_b32 v67, s34, v69
  v_mul_f32 v64, v64, v106
  v_mul_f32 v65, v65, v107
  v_mul_f32 v66, v66, v108
  v_mul_f32 v67, v67, v109
  v_cvt_pk_bf16_f32 v68, v64, v65
  v_cvt_pk_bf16_f32 v69, v66, v67
  v_lshlrev_b32 v64, 16, v68
  v_and_b32 v65, s34, v68
  v_lshlrev_b32 v66, 16, v69
  v_and_b32 v67, s34, v69
  v_add_f32 v64, v64, v172
  v_add_f32 v65, v65, v173
  v_add_f32 v66, v66, v174
  v_add_f32 v67, v67, v175
  v_cvt_pk_bf16_f32 v68, v64, v65
  v_cvt_pk_bf16_f32 v69, v66, v67
  buffer_store_dwordx2 v[68:69], v117, s[16:19], 0 offen offset:128
attn_end:
  s_endpgm
attn_redo:
  s_waitcnt vmcnt(0)
  v_accvgpr_write_b32 a0, 0
  v_accvgpr_write_b32 a1, 0
  v_accvgpr_write_b32 a2, 0
  v_accvgpr_write_b32 a3, 0
  v_accvgpr_write_b32 a4, 0
  v_accvgpr_write_b32 a5, 0
  v_accvgpr_write_b32 a6, 0
  v_accvgpr_write_b32 a7, 0
  v_accvgpr_write_b32 a8, 0
  v_accvgpr_write_b32 a9, 0
  v_accvgpr_write_b32 a10, 0
  v_accvgpr_write_b32 a11, 0
  v_accvgpr_write_b32 a12, 0
  v_accvgpr_write_b32 a13, 0
  v_accvgpr_write_b32 a14, 0
  v_accvgpr_write_b32 a15, 0
  v_accvgpr_write_b32 a16, 0
  v_accvgpr_write_b32 a17, 0
  v_accvgpr_write_b32 a18, 0
  v_accvgpr_write_b32 a19, 0
  v_accvgpr_write_b32 a20, 0
  v_accvgpr_write_b32 a21, 0
  v_accvgpr_write_b32 a22, 0
  v_accvgpr_write_b32 a23, 0
  v_accvgpr_write_b32 a24, 0
  v_accvgpr_write_b32 a25, 0
  v_accvgpr_write_b32 a26, 0
  v_accvgpr_write_b32 a27, 0
  v_accvgpr_write_b32 a28, 0
  v_accvgpr_write_b32 a29, 0
  v_accvgpr_write_b32 a30, 0
  v_accvgpr_write_b32 a31, 0
  v_accvgpr_write_b32 a32, 0
  v_accvgpr_write_b32 a33, 0
  v_accvgpr_write_b32 a34, 0
  v_accvgpr_write_b32 a35, 0
  v_accvgpr_write_b32 a36, 0
  v_accvgpr_write_b32 a37, 0
  v_accvgpr_write_b32 a38, 0
  v_accvgpr_write_b32 a39, 0
  v_accvgpr_write_b32 a40, 0
  v_accvgpr_write_b32 a41, 0
  v_accvgpr_write_b32 a42, 0
  v_accvgpr_write_b32 a43, 0
  v_accvgpr_write_b32 a44, 0
  v_accvgpr_write_b32 a45, 0
  v_accvgpr_write_b32 a46, 0
  v_accvgpr_write_b32 a47, 0
  v_accvgpr_write_b32 a48, 0
  v_accvgpr_write_b32 a49, 0
  v_accvgpr_write_b32 a50, 0
  v_accvgpr_write_b32 a51, 0
  v_accvgpr_write_b32 a52, 0
  v_accvgpr_write_b32 a53, 0
  v_accvgpr_write_b32 a54, 0
  v_accvgpr_write_b32 a55, 0
  v_accvgpr_write_b32 a56, 0
  v_accvgpr_write_b32 a57, 0
  v_accvgpr_write_b32 a58, 0
  v_accvgpr_write_b32 a59, 0
  v_accvgpr_write_b32 a60, 0
  v_accvgpr_write_b32 a61, 0
  v_accvgpr_write_b32 a62, 0
  v_accvgpr_write_b32 a63, 0
  v_accvgpr_write_b32 a64, 0
  v_accvgpr_write_b32 a65, 0
  v_accvgpr_write_b32 a66, 0
  v_accvgpr_write_b32 a67, 0
  v_accvgpr_write_b32 a68, 0
  v_accvgpr_write_b32 a69, 0
  v_accvgpr_write_b32 a70, 0
  v_accvgpr_write_b32 a71, 0
  v_accvgpr_write_b32 a72, 0
  v_accvgpr_write_b32 a73, 0
  v_accvgpr_write_b32 a74, 0
  v_accvgpr_write_b32 a75, 0
  v_accvgpr_write_b32 a76, 0
  v_accvgpr_write_b32 a77, 0
  v_accvgpr_write_b32 a78, 0
  v_accvgpr_write_b32 a79, 0
  v_accvgpr_write_b32 a80, 0
  v_accvgpr_write_b32 a81, 0
  v_accvgpr_write_b32 a82, 0
  v_accvgpr_write_b32 a83, 0
  v_accvgpr_write_b32 a84, 0
  v_accvgpr_write_b32 a85, 0
  v_accvgpr_write_b32 a86, 0
  v_accvgpr_write_b32 a87, 0
  v_accvgpr_write_b32 a88, 0
  v_accvgpr_write_b32 a89, 0
  v_accvgpr_write_b32 a90, 0
  v_accvgpr_write_b32 a91, 0
  v_accvgpr_write_b32 a92, 0
  v_accvgpr_write_b32 a93, 0
  v_accvgpr_write_b32 a94, 0
  v_accvgpr_write_b32 a95, 0
  v_accvgpr_write_b32 a96, 0
  v_accvgpr_write_b32 a97, 0
  v_accvgpr_write_b32 a98, 0
  v_accvgpr_write_b32 a99, 0
  v_accvgpr_write_b32 a100, 0
  v_accvgpr_write_b32 a101, 0
  v_accvgpr_write_b32 a102, 0
  v_accvgpr_write_b32 a103, 0
  v_accvgpr_write_b32 a104, 0
  v_accvgpr_write_b32 a105, 0
  v_accvgpr_write_b32 a106, 0
  v_accvgpr_write_b32 a107, 0
  v_accvgpr_write_b32 a108, 0
  v_accvgpr_write_b32 a109, 0
  v_accvgpr_write_b32 a110, 0
  v_accvgpr_write_b32 a111, 0
  v_accvgpr_write_b32 a112, 0
  v_accvgpr_write_b32 a113, 0
  v_accvgpr_write_b32 a114, 0
  v_accvgpr_write_b32 a115, 0
  v_accvgpr_write_b32 a116, 0
  v_accvgpr_write_b32 a117, 0
  v_accvgpr_write_b32 a118, 0
  v_accvgpr_write_b32 a119, 0
  v_accvgpr_write_b32 a120, 0
  v_accvgpr_write_b32 a121, 0
  v_accvgpr_write_b32 a122, 0
  v_accvgpr_write_b32 a123, 0
  v_accvgpr_write_b32 a124, 0
  v_accvgpr_write_b32 a125, 0
  v_accvgpr_write_b32 a126, 0
  v_accvgpr_write_b32 a127, 0
  v_mov_b32 v208, 0
  v_mov_b32 v249, 0xff800000
  v_mov_b32 v209, 0
  v_mov_b32 v250, 0xff800000
  v_mov_b32 v210, 0
  v_mov_b32 v251, 0xff800000
  v_mov_b32 v211, 0
  v_mov_b32 v252, 0xff800000
  s_mov_b32 s29, 0
attn_slow:
  s_barrier
  s_add_u32 m0, s28, 49152
  s_nop 0
  buffer_load_dwordx4 v232, s[12:15], s29 offen offset:0 lds
  buffer_load_dwordx4 v233, s[12:15], s29 offen offset:1024 lds
  buffer_load_dwordx4 v234, s[12:15], s29 offen offset:2048 lds
  buffer_load_dwordx4 v235, s[12:15], s29 offen offset:3072 lds
  s_add_u32 m0, s28, 114688
  s_nop 0
  buffer_load_dwordx4 v236, s[16:19], s29 offen offset:0 lds
  buffer_load_dwordx4 v237, s[16:19], s29 offen offset:1024 lds
  buffer_load_dwordx4 v236, s[16:19], s29 offen offset:2048 lds
  buffer_load_dwordx4 v237, s[16:19], s29 offen offset:3072 lds
  s_waitcnt vmcnt(0)
  s_barrier
  ds_read_b128 a[128:131], v212 offset:49152
  ds_read_b128 a[132:135], v213 offset:49152
  ds_read_b128 a[136:139], v214 offset:49152
  ds_read_b128 a[140:143], v215 offset:49152
  s_waitcnt lgkmcnt(3)
  v_mfma_f32_16x16x32_bf16 v[0:3], a[128:131], v[128:131], 0
  s_waitcnt lgkmcnt(2)
  v_mfma_f32_16x16x32_bf16 v[0:3], a[132:135], v[132:135], v[0:3]
  s_waitcnt lgkmcnt(1)
  v_mfma_f32_16x16x32_bf16 v[0:3], a[136:139], v[136:139], v[0:3]
  s_waitcnt lgkmcnt(0)
  v_mfma_f32_16x16x32_bf16 v[0:3], a[140:143], v[140:143], v[0:3]
  v_mfma_f32_16x16x32_bf16 v[8:11], a[140:143], v[156:159], 0
  v_mfma_f32_16x16x32_bf16 v[8:11], a[136:139], v[152:155], v[8:11]
  v_mfma_f32_16x16x32_bf16 v[8:11], a[132:135], v[148:151], v[8:11]
  v_mfma_f32_16x16x32_bf16 v[8:11], a[128:131], v[144:147], v[8:11]
  v_mfma_f32_16x16x32_bf16 v[16:19], a[128:131], v[160:163], 0
  v_mfma_f32_16x16x32_bf16 v[16:19], a[132:135], v[164:167], v[16:19]
  v_mfma_f32_16x16x32_bf16 v[16:19], a[136:139], v[168:171], v[16:19]
  v_mfma_f32_16x16x32_bf16 v[16:19], a[140:143], v[172:175], v[16:19]
  v_mfma_f32_16x16x32_bf16 v[24:27], a[140:143], v[188:191], 0
  v_mfma_f32_16x16x32_bf16 v[24:27], a[136:139], v[184:187], v[24:27]
  v_mfma_f32_16x16x32_bf16 v[24:27], a[132:135], v[180:183], v[24:27]
  v_mfma_f32_16x16x32_bf16 v[24:27], a[128:131], v[176:179], v[24:27]
  ds_read_b128 a[144:147], v212 offset:53248
  ds_read_b128 a[148:151], v213 offset:53248
  ds_read_b128 a[152:155], v214 offset:53248
  ds_read_b128 a[156:159], v215 offset:53248
  s_waitcnt lgkmcnt(3)
  v_mfma_f32_16x16x32_bf16 v[4:7], a[144:147], v[128:131], 0
  s_waitcnt lgkmcnt(2)
  v_mfma_f32_16x16x32_bf16 v[4:7], a[148:151], v[132:135], v[4:7]
  s_waitcnt lgkmcnt(1)
  v_mfma_f32_16x16x32_bf16 v[4:7], a[152:155], v[136:139], v[4:7]
  s_waitcnt lgkmcnt(0)
  v_mfma_f32_16x16x32_bf16 v[4:7], a[156:159], v[140:143], v[4:7]
  v_mfma_f32_16x16x32_bf16 v[12:15], a[156:159], v[156:159], 0
  v_mfma_f32_16x16x32_bf16 v[12:15], a[152:155], v[152:155], v[12:15]
  v_mfma_f32_16x16x32_bf16 v[12:15], a[148:151], v[148:151], v[12:15]
  v_mfma_f32_16x16x32_bf16 v[12:15], a[144:147], v[144:147], v[12:15]
  v_mfma_f32_16x16x32_bf16 v[20:23], a[144:147], v[160:163], 0
  v_mfma_f32_16x16x32_bf16 v[20:23], a[148:151], v[164:167], v[20:23]
  v_mfma_f32_16x16x32_bf16 v[20:23], a[152:155], v[168:171], v[20:23]
  v_mfma_f32_16x16x32_bf16 v[20:23], a[156:159], v[172:175], v[20:23]
  v_mfma_f32_16x16x32_bf16 v[28:31], a[156:159], v[188:191], 0
  v_mfma_f32_16x16x32_bf16 v[28:31], a[152:155], v[184:187], v[28:31]
  v_mfma_f32_16x16x32_bf16 v[28:31], a[148:151], v[180:183], v[28:31]
  v_mfma_f32_16x16x32_bf16 v[28:31], a[144:147], v[176:179], v[28:31]
  ds_read_b128 a[128:131], v212 offset:57344
  ds_read_b128 a[132:135], v213 offset:57344
  ds_read_b128 a[136:139], v214 offset:57344
  ds_read_b128 a[140:143], v215 offset:57344
  s_waitcnt lgkmcnt(3)
  v_mfma_f32_16x16x32_bf16 v[32:35], a[128:131], v[128:131], 0
  s_waitcnt lgkmcnt(2)
  v_mfma_f32_16x16x32_bf16 v[32:35], a[132:135], v[132:135], v[32:35]
  s_waitcnt lgkmcnt(1)
  v_mfma_f32_16x16x32_bf16 v[32:35], a[136:139], v[136:139], v[32:35]
  s_waitcnt lgkmcnt(0)
  v_mfma_f32_16x16x32_bf16 v[32:35], a[140:143], v[140:143], v[32:35]
  v_mfma_f32_16x16x32_bf16 v[40:43], a[140:143], v[156:159], 0
  v_mfma_f32_16x16x32_bf16 v[40:43], a[136:139], v[152:155], v[40:43]
  v_mfma_f32_16x16x32_bf16 v[40:43], a[132:135], v[148:151], v[40:43]
  v_mfma_f32_16x16x32_bf16 v[40:43], a[128:131], v[144:147], v[40:43]
  v_mfma_f32_16x16x32_bf16 v[48:51], a[128:131], v[160:163], 0
  v_mfma_f32_16x16x32_bf16 v[48:51], a[132:135], v[164:167], v[48:51]
  v_mfma_f32_16x16x32_bf16 v[48:51], a[136:139], v[168:171], v[48:51]
  v_mfma_f32_16x16x32_bf16 v[48:51], a[140:143], v[172:175], v[48:51]
  v_mfma_f32_16x16x32_bf16 v[56:59], a[140:143], v[188:191], 0
  v_mfma_f32_16x16x32_bf16 v[56:59], a[136:139], v[184:187], v[56:59]
  v_mfma_f32_16x16x32_bf16 v[56:59], a[132:135], v[180:183], v[56:59]
  v_mfma_f32_16x16x32_bf16 v[56:59], a[128:131], v[176:179], v[56:59]
  ds_read_b128 a[144:147], v212 offset:61440
  ds_read_b128 a[148:151], v213 offset:61440
  ds_read_b128 a[152:155], v214 offset:61440
  ds_read_b128 a[156:159], v215 offset:61440
  s_waitcnt lgkmcnt(3)
  v_mfma_f32_16x16x32_bf16 v[36:39], a[144:147], v[128:131], 0
  s_waitcnt lgkmcnt(2)
  v_mfma_f32_16x16x32_bf16 v[36:39], a[148:151], v[132:135], v[36:39]
  s_waitcnt lgkmcnt(1)
  v_mfma_f32_16x16x32_bf16 v[36:39], a[152:155], v[136:139], v[36:39]
  s_waitcnt lgkmcnt(0)
  v_mfma_f32_16x16x32_bf16 v[36:39], a[156:159], v[140:143], v[36:39]
  v_mfma_f32_16x16x32_bf16 v[44:47], a[156:159], v[156:159], 0
  v_mfma_f32_16x16x32_bf16 v[44:47], a[152:155], v[152:155], v[44:47]
  v_mfma_f32_16x16x32_bf16 v[44:47], a[148:151], v[148:151], v[44:47]
  v_mfma_f32_16x16x32_bf16 v[44:47], a[144:147], v[144:147], v[44:47]
  v_mfma_f32_16x16x32_bf16 v[52:55], a[144:147], v[160:163], 0
  v_mfma_f32_16x16x32_bf16 v[52:55], a[148:151], v[164:167], v[52:55]
  v_mfma_f32_16x16x32_bf16 v[52:55], a[152:155], v[168:171], v[52:55]
  v_mfma_f32_16x16x32_bf16 v[52:55], a[156:159], v[172:175], v[52:55]
  v_mfma_f32_16x16x32_bf16 v[60:63], a[156:159], v[188:191], 0
  v_mfma_f32_16x16x32_bf16 v[60:63], a[152:155], v[184:187], v[60:63]
  v_mfma_f32_16x16x32_bf16 v[60:63], a[148:151], v[180:183], v[60:63]
  v_mfma_f32_16x16x32_bf16 v[60:63], a[144:147], v[176:179], v[60:63]
  v_mov_b32 v192, v249
  v_max3_f32 v192, v192, v0, v1
  v_max3_f32 v192, v192, v2, v3
  v_max3_f32 v192, v192, v4, v5
  v_max3_f32 v192, v192, v6, v7
  v_max3_f32 v192, v192, v32, v33
  v_max3_f32 v192, v192, v34, v35
  v_max3_f32 v192, v192, v36, v37
  v_max3_f32 v192, v192, v38, v39
  v_mov_b32 v245, v192
  s_nop 1
  v_permlane16_swap_b32 v192, v245
  v_max_f32 v192, v192, v245
  v_mov_b32 v245, v192
  s_nop 1
  v_permlane32_swap_b32 v192, v245
  v_max_f32 v192, v192, v245
  v_sub_f32 v193, v249, v192
  v_exp_f32 v193, v193
  v_mov_b32 v249, v192
  v_mul_f32 v208, v208, v193
  v_sub_f32 v0, v0, v192
  v_sub_f32 v1, v1, v192
  v_sub_f32 v2, v2, v192
  v_sub_f32 v3, v3, v192
  v_sub_f32 v4, v4, v192
  v_sub_f32 v5, v5, v192
  v_sub_f32 v6, v6, v192
  v_sub_f32 v7, v7, v192
  v_sub_f32 v32, v32, v192
  v_sub_f32 v33, v33, v192
  v_sub_f32 v34, v34, v192
  v_sub_f32 v35, v35, v192
  v_sub_f32 v36, v36, v192
  v_sub_f32 v37, v37, v192
  v_sub_f32 v38, v38, v192
  v_sub_f32 v39, v39, v192
  v_exp_f32 v0, v0
  v_exp_f32 v1, v1
  v_add_f32 v208, v208, v0
  v_exp_f32 v2, v2
  v_add_f32 v208, v208, v1
  v_cvt_pk_bf16_f32 v0, v0, v1
  v_exp_f32 v3, v3
  v_add_f32 v208, v208, v2
  v_add_f32 v208, v208, v3
  v_cvt_pk_bf16_f32 v1, v2, v3
  v_exp_f32 v4, v4
  v_exp_f32 v5, v5
  v_add_f32 v208, v208, v4
  v_exp_f32 v6, v6
  v_add_f32 v208, v208, v5
  v_cvt_pk_bf16_f32 v2, v4, v5
  v_exp_f32 v7, v7
  v_add_f32 v208, v208, v6
  v_add_f32 v208, v208, v7
  v_cvt_pk_bf16_f32 v3, v6, v7
  v_exp_f32 v32, v32
  v_exp_f32 v33, v33
  v_add_f32 v208, v208, v32
  v_exp_f32 v34, v34
  v_add_f32 v208, v208, v33
  v_cvt_pk_bf16_f32 v32, v32, v33
  v_exp_f32 v35, v35
  v_add_f32 v208, v208, v34
  v_add_f32 v208, v208, v35
  v_cvt_pk_bf16_f32 v33, v34, v35
  v_exp_f32 v36, v36
  v_exp_f32 v37, v37
  v_add_f32 v208, v208, v36
  v_exp_f32 v38, v38
  v_add_f32 v208, v208, v37
  v_cvt_pk_bf16_f32 v34, v36, v37
  v_exp_f32 v39, v39
  v_add_f32 v208, v208, v38
  v_add_f32 v208, v208, v39
  v_cvt_pk_bf16_f32 v35, v38, v39
  v_accvgpr_read_b32 v64, a0
  v_accvgpr_read_b32 v65, a1
  v_accvgpr_read_b32 v66, a2
  v_accvgpr_read_b32 v67, a3
  v_mul_f32 v64, v64, v193
  v_mul_f32 v65, v65, v193
  v_mul_f32 v66, v66, v193
  v_mul_f32 v67, v67, v193
  v_accvgpr_write_b32 a0, v64
  v_accvgpr_write_b32 a1, v65
  v_accvgpr_write_b32 a2, v66
  v_accvgpr_write_b32 a3, v67
  v_accvgpr_read_b32 v64, a16
  v_accvgpr_read_b32 v65, a17
  v_accvgpr_read_b32 v66, a18
  v_accvgpr_read_b32 v67, a19
  v_mul_f32 v64, v64, v193
  v_mul_f32 v65, v65, v193
  v_mul_f32 v66, v66, v193
  v_mul_f32 v67, v67, v193
  v_accvgpr_write_b32 a16, v64
  v_accvgpr_write_b32 a17, v65
  v_accvgpr_write_b32 a18, v66
  v_accvgpr_write_b32 a19, v67
  v_accvgpr_read_b32 v64, a32
  v_accvgpr_read_b32 v65, a33
  v_accvgpr_read_b32 v66, a34
  v_accvgpr_read_b32 v67, a35
  v_mul_f32 v64, v64, v193
  v_mul_f32 v65, v65, v193
  v_mul_f32 v66, v66, v193
  v_mul_f32 v67, v67, v193
  v_accvgpr_write_b32 a32, v64
  v_accvgpr_write_b32 a33, v65
  v_accvgpr_write_b32 a34, v66
  v_accvgpr_write_b32 a35, v67
  v_accvgpr_read_b32 v64, a48
  v_accvgpr_read_b32 v65, a49
  v_accvgpr_read_b32 v66, a50
  v_accvgpr_read_b32 v67, a51
  v_mul_f32 v64, v64, v193
  v_mul_f32 v65, v65, v193
  v_mul_f32 v66, v66, v193
  v_mul_f32 v67, v67, v193
  v_accvgpr_write_b32 a48, v64
  v_accvgpr_write_b32 a49, v65
  v_accvgpr_write_b32 a50, v66
  v_accvgpr_write_b32 a51, v67
  v_accvgpr_read_b32 v64, a64
  v_accvgpr_read_b32 v65, a65
  v_accvgpr_read_b32 v66, a66
  v_accvgpr_read_b32 v67, a67
  v_mul_f32 v64, v64, v193
  v_mul_f32 v65, v65, v193
  v_mul_f32 v66, v66, v193
  v_mul_f32 v67, v67, v193
  v_accvgpr_write_b32 a64, v64
  v_accvgpr_write_b32 a65, v65
  v_accvgpr_write_b32 a66, v66
  v_accvgpr_write_b32 a67, v67
  v_accvgpr_read_b32 v64, a80
  v_accvgpr_read_b32 v65, a81
  v_accvgpr_read_b32 v66, a82
  v_accvgpr_read_b32 v67, a83
  v_mul_f32 v64, v64, v193
  v_mul_f32 v65, v65, v193
  v_mul_f32 v66, v66, v193
  v_mul_f32 v67, v67, v193
  v_accvgpr_write_b32 a80, v64
  v_accvgpr_write_b32 a81, v65
  v_accvgpr_write_b32 a82, v66
  v_accvgpr_write_b32 a83, v67
  v_accvgpr_read_b32 v64, a96
  v_accvgpr_read_b32 v65, a97
  v_accvgpr_read_b32 v66, a98
  v_accvgpr_read_b32 v67, a99
  v_mul_f32 v64, v64, v193
  v_mul_f32 v65, v65, v193
  v_mul_f32 v66, v66, v193
  v_mul_f32 v67, v67, v193
  v_accvgpr_write_b32 a96, v64
  v_accvgpr_write_b32 a97, v65
  v_accvgpr_write_b32 a98, v66
  v_accvgpr_write_b32 a99, v67
  v_accvgpr_read_b32 v64, a112
  v_accvgpr_read_b32 v65, a113
  v_accvgpr_read_b32 v66, a114
  v_accvgpr_read_b32 v67, a115
  v_mul_f32 v64, v64, v193
  v_mul_f32 v65, v65, v193
  v_mul_f32 v66, v66, v193
  v_mul_f32 v67, v67, v193
  v_accvgpr_write_b32 a112, v64
  v_accvgpr_write_b32 a113, v65
  v_accvgpr_write_b32 a114, v66
  v_accvgpr_write_b32 a115, v67
  v_mov_b32 v196, v250
  v_max3_f32 v196, v196, v8, v9
  v_max3_f32 v196, v196, v10, v11
  v_max3_f32 v196, v196, v12, v13
  v_max3_f32 v196, v196, v14, v15
  v_max3_f32 v196, v196, v40, v41
  v_max3_f32 v196, v196, v42, v43
  v_max3_f32 v196, v196, v44, v45
  v_max3_f32 v196, v196, v46, v47
  v_mov_b32 v245, v196
  s_nop 1
  v_permlane16_swap_b32 v196, v245
  v_max_f32 v196, v196, v245
  v_mov_b32 v245, v196
  s_nop 1
  v_permlane32_swap_b32 v196, v245
  v_max_f32 v196, v196, v245
  v_sub_f32 v197, v250, v196
  v_exp_f32 v197, v197
  v_mov_b32 v250, v196
  v_mul_f32 v209, v209, v197
  v_sub_f32 v8, v8, v196
  v_sub_f32 v9, v9, v196
  v_sub_f32 v10, v10, v196
  v_sub_f32 v11, v11, v196
  v_sub_f32 v12, v12, v196
  v_sub_f32 v13, v13, v196
  v_sub_f32 v14, v14, v196
  v_sub_f32 v15, v15, v196
  v_sub_f32 v40, v40, v196
  v_sub_f32 v41, v41, v196
  v_sub_f32 v42, v42, v196
  v_sub_f32 v43, v43, v196
  v_sub_f32 v44, v44, v196
  v_sub_f32 v45, v45, v196
  v_sub_f32 v46, v46, v196
  v_sub_f32 v47, v47, v196
  v_exp_f32 v8, v8
  v_exp_f32 v9, v9
  v_add_f32 v209, v209, v8
  v_exp_f32 v10, v10
  v_add_f32 v209, v209, v9
  v_cvt_pk_bf16_f32 v8, v8, v9
  v_exp_f32 v11, v11
  v_add_f32 v209, v209, v10
  v_add_f32 v209, v209, v11
  v_cvt_pk_bf16_f32 v9, v10, v11
  v_exp_f32 v12, v12
  v_exp_f32 v13, v13
  v_add_f32 v209, v209, v12
  v_exp_f32 v14, v14
  v_add_f32 v209, v209, v13
  v_cvt_pk_bf16_f32 v10, v12, v13
  v_exp_f32 v15, v15
  v_add_f32 v209, v209, v14
  v_add_f32 v209, v209, v15
  v_cvt_pk_bf16_f32 v11, v14, v15
  v_exp_f32 v40, v40
  v_exp_f32 v41, v41
  v_add_f32 v209, v209, v40
  v_exp_f32 v42, v42
  v_add_f32 v209, v209, v41
  v_cvt_pk_bf16_f32 v40, v40, v41
  v_exp_f32 v43, v43
  v_add_f32 v209, v209, v42
  v_add_f32 v209, v209, v43
  v_cvt_pk_bf16_f32 v41, v42, v43
  v_exp_f32 v44, v44
  v_exp_f32 v45, v45
  v_add_f32 v209, v209, v44
  v_exp_f32 v46, v46
  v_add_f32 v209, v209, v45
  v_cvt_pk_bf16_f32 v42, v44, v45
  v_exp_f32 v47, v47
  v_add_f32 v209, v209, v46
  v_add_f32 v209, v209, v47
  v_cvt_pk_bf16_f32 v43, v46, v47
  v_accvgpr_read_b32 v64, a4
  v_accvgpr_read_b32 v65, a5
  v_accvgpr_read_b32 v66, a6
  v_accvgpr_read_b32 v67, a7
  v_mul_f32 v64, v64, v197
  v_mul_f32 v65, v65, v197
  v_mul_f32 v66, v66, v197
  v_mul_f32 v67, v67, v197
  v_accvgpr_write_b32 a4, v64
  v_accvgpr_write_b32 a5, v65
  v_accvgpr_write_b32 a6, v66
  v_accvgpr_write_b32 a7, v67
  v_accvgpr_read_b32 v64, a20
  v_accvgpr_read_b32 v65, a21
  v_accvgpr_read_b32 v66, a22
  v_accvgpr_read_b32 v67, a23
  v_mul_f32 v64, v64, v197
  v_mul_f32 v65, v65, v197
  v_mul_f32 v66, v66, v197
  v_mul_f32 v67, v67, v197
  v_accvgpr_write_b32 a20, v64
  v_accvgpr_write_b32 a21, v65
  v_accvgpr_write_b32 a22, v66
  v_accvgpr_write_b32 a23, v67
  v_accvgpr_read_b32 v64, a36
  v_accvgpr_read_b32 v65, a37
  v_accvgpr_read_b32 v66, a38
  v_accvgpr_read_b32 v67, a39
  v_mul_f32 v64, v64, v197
  v_mul_f32 v65, v65, v197
  v_mul_f32 v66, v66, v197
  v_mul_f32 v67, v67, v197
  v_accvgpr_write_b32 a36, v64
  v_accvgpr_write_b32 a37, v65
  v_accvgpr_write_b32 a38, v66
  v_accvgpr_write_b32 a39, v67
  v_accvgpr_read_b32 v64, a52
  v_accvgpr_read_b32 v65, a53
  v_accvgpr_read_b32 v66, a54
  v_accvgpr_read_b32 v67, a55
  v_mul_f32 v64, v64, v197
  v_mul_f32 v65, v65, v197
  v_mul_f32 v66, v66, v197
  v_mul_f32 v67, v67, v197
  v_accvgpr_write_b32 a52, v64
  v_accvgpr_write_b32 a53, v65
  v_accvgpr_write_b32 a54, v66
  v_accvgpr_write_b32 a55, v67
  v_accvgpr_read_b32 v64, a68
  v_accvgpr_read_b32 v65, a69
  v_accvgpr_read_b32 v66, a70
  v_accvgpr_read_b32 v67, a71
  v_mul_f32 v64, v64, v197
  v_mul_f32 v65, v65, v197
  v_mul_f32 v66, v66, v197
  v_mul_f32 v67, v67, v197
  v_accvgpr_write_b32 a68, v64
  v_accvgpr_write_b32 a69, v65
  v_accvgpr_write_b32 a70, v66
  v_accvgpr_write_b32 a71, v67
  v_accvgpr_read_b32 v64, a84
  v_accvgpr_read_b32 v65, a85
  v_accvgpr_read_b32 v66, a86
  v_accvgpr_read_b32 v67, a87
  v_mul_f32 v64, v64, v197
  v_mul_f32 v65, v65, v197
  v_mul_f32 v66, v66, v197
  v_mul_f32 v67, v67, v197
  v_accvgpr_write_b32 a84, v64
  v_accvgpr_write_b32 a85, v65
  v_accvgpr_write_b32 a86, v66
  v_accvgpr_write_b32 a87, v67
  v_accvgpr_read_b32 v64, a100
  v_accvgpr_read_b32 v65, a101
  v_accvgpr_read_b32 v66, a102
  v_accvgpr_read_b32 v67, a103
  v_mul_f32 v64, v64, v197
  v_mul_f32 v65, v65, v197
  v_mul_f32 v66, v66, v197
  v_mul_f32 v67, v67, v197
  v_accvgpr_write_b32 a100, v64
  v_accvgpr_write_b32 a101, v65
  v_accvgpr_write_b32 a102, v66
  v_accvgpr_write_b32 a103, v67
  v_accvgpr_read_b32 v64, a116
  v_accvgpr_read_b32 v65, a117
  v_accvgpr_read_b32 v66, a118
  v_accvgpr_read_b32 v67, a119
  v_mul_f32 v64, v64, v197
  v_mul_f32 v65, v65, v197
  v_mul_f32 v66, v66, v197
  v_mul_f32 v67, v67, v197
  v_accvgpr_write_b32 a116, v64
  v_accvgpr_write_b32 a117, v65
  v_accvgpr_write_b32 a118, v66
  v_accvgpr_write_b32 a119, v67
  v_mov_b32 v200, v251
  v_max3_f32 v200, v200, v16, v17
  v_max3_f32 v200, v200, v18, v19
  v_max3_f32 v200, v200, v20, v21
  v_max3_f32 v200, v200, v22, v23
  v_max3_f32 v200, v200, v48, v49
  v_max3_f32 v200, v200, v50, v51
  v_max3_f32 v200, v200, v52, v53
  v_max3_f32 v200, v200, v54, v55
  v_mov_b32 v245, v200
  s_nop 1
  v_permlane16_swap_b32 v200, v245
  v_max_f32 v200, v200, v245
  v_mov_b32 v245, v200
  s_nop 1
  v_permlane32_swap_b32 v200, v245
  v_max_f32 v200, v200, v245
  v_sub_f32 v201, v251, v200
  v_exp_f32 v201, v201
  v_mov_b32 v251, v200
  v_mul_f32 v210, v210, v201
  v_sub_f32 v16, v16, v200
  v_sub_f32 v17, v17, v200
  v_sub_f32 v18, v18, v200
  v_sub_f32 v19, v19, v200
  v_sub_f32 v20, v20, v200
  v_sub_f32 v21, v21, v200
  v_sub_f32 v22, v22, v200
  v_sub_f32 v23, v23, v200
  v_sub_f32 v48, v48, v200
  v_sub_f32 v49, v49, v200
  v_sub_f32 v50, v50, v200
  v_sub_f32 v51, v51, v200
  v_sub_f32 v52, v52, v200
  v_sub_f32 v53, v53, v200
  v_sub_f32 v54, v54, v200
  v_sub_f32 v55, v55, v200
  v_exp_f32 v16, v16
  v_exp_f32 v17, v17
  v_add_f32 v210, v210, v16
  v_exp_f32 v18, v18
  v_add_f32 v210, v210, v17
  v_cvt_pk_bf16_f32 v16, v16, v17
  v_exp_f32 v19, v19
  v_add_f32 v210, v210, v18
  v_add_f32 v210, v210, v19
  v_cvt_pk_bf16_f32 v17, v18, v19
  v_exp_f32 v20, v20
  v_exp_f32 v21, v21
  v_add_f32 v210, v210, v20
  v_exp_f32 v22, v22
  v_add_f32 v210, v210, v21
  v_cvt_pk_bf16_f32 v18, v20, v21
  v_exp_f32 v23, v23
  v_add_f32 v210, v210, v22
  v_add_f32 v210, v210, v23
  v_cvt_pk_bf16_f32 v19, v22, v23
  v_exp_f32 v48, v48
  v_exp_f32 v49, v49
  v_add_f32 v210, v210, v48
  v_exp_f32 v50, v50
  v_add_f32 v210, v210, v49
  v_cvt_pk_bf16_f32 v48, v48, v49
  v_exp_f32 v51, v51
  v_add_f32 v210, v210, v50
  v_add_f32 v210, v210, v51
  v_cvt_pk_bf16_f32 v49, v50, v51
  v_exp_f32 v52, v52
  v_exp_f32 v53, v53
  v_add_f32 v210, v210, v52
  v_exp_f32 v54, v54
  v_add_f32 v210, v210, v53
  v_cvt_pk_bf16_f32 v50, v52, v53
  v_exp_f32 v55, v55
  v_add_f32 v210, v210, v54
  v_add_f32 v210, v210, v55
  v_cvt_pk_bf16_f32 v51, v54, v55
  v_accvgpr_read_b32 v64, a8
  v_accvgpr_read_b32 v65, a9
  v_accvgpr_read_b32 v66, a10
  v_accvgpr_read_b32 v67, a11
  v_mul_f32 v64, v64, v201
  v_mul_f32 v65, v65, v201
  v_mul_f32 v66, v66, v201
  v_mul_f32 v67, v67, v201
  v_accvgpr_write_b32 a8, v64
  v_accvgpr_write_b32 a9, v65
  v_accvgpr_write_b32 a10, v66
  v_accvgpr_write_b32 a11, v67
  v_accvgpr_read_b32 v64, a24
  v_accvgpr_read_b32 v65, a25
  v_accvgpr_read_b32 v66, a26
  v_accvgpr_read_b32 v67, a27
  v_mul_f32 v64, v64, v201
  v_mul_f32 v65, v65, v201
  v_mul_f32 v66, v66, v201
  v_mul_f32 v67, v67, v201
  v_accvgpr_write_b32 a24, v64
  v_accvgpr_write_b32 a25, v65
  v_accvgpr_write_b32 a26, v66
  v_accvgpr_write_b32 a27, v67
  v_accvgpr_read_b32 v64, a40
  v_accvgpr_read_b32 v65, a41
  v_accvgpr_read_b32 v66, a42
  v_accvgpr_read_b32 v67, a43
  v_mul_f32 v64, v64, v201
  v_mul_f32 v65, v65, v201
  v_mul_f32 v66, v66, v201
  v_mul_f32 v67, v67, v201
  v_accvgpr_write_b32 a40, v64
  v_accvgpr_write_b32 a41, v65
  v_accvgpr_write_b32 a42, v66
  v_accvgpr_write_b32 a43, v67
  v_accvgpr_read_b32 v64, a56
  v_accvgpr_read_b32 v65, a57
  v_accvgpr_read_b32 v66, a58
  v_accvgpr_read_b32 v67, a59
  v_mul_f32 v64, v64, v201
  v_mul_f32 v65, v65, v201
  v_mul_f32 v66, v66, v201
  v_mul_f32 v67, v67, v201
  v_accvgpr_write_b32 a56, v64
  v_accvgpr_write_b32 a57, v65
  v_accvgpr_write_b32 a58, v66
  v_accvgpr_write_b32 a59, v67
  v_accvgpr_read_b32 v64, a72
  v_accvgpr_read_b32 v65, a73
  v_accvgpr_read_b32 v66, a74
  v_accvgpr_read_b32 v67, a75
  v_mul_f32 v64, v64, v201
  v_mul_f32 v65, v65, v201
  v_mul_f32 v66, v66, v201
  v_mul_f32 v67, v67, v201
  v_accvgpr_write_b32 a72, v64
  v_accvgpr_write_b32 a73, v65
  v_accvgpr_write_b32 a74, v66
  v_accvgpr_write_b32 a75, v67
  v_accvgpr_read_b32 v64, a88
  v_accvgpr_read_b32 v65, a89
  v_accvgpr_read_b32 v66, a90
  v_accvgpr_read_b32 v67, a91
  v_mul_f32 v64, v64, v201
  v_mul_f32 v65, v65, v201
  v_mul_f32 v66, v66, v201
  v_mul_f32 v67, v67, v201
  v_accvgpr_write_b32 a88, v64
  v_accvgpr_write_b32 a89, v65
  v_accvgpr_write_b32 a90, v66
  v_accvgpr_write_b32 a91, v67
  v_accvgpr_read_b32 v64, a104
  v_accvgpr_read_b32 v65, a105
  v_accvgpr_read_b32 v66, a106
  v_accvgpr_read_b32 v67, a107
  v_mul_f32 v64, v64, v201
  v_mul_f32 v65, v65, v201
  v_mul_f32 v66, v66, v201
  v_mul_f32 v67, v67, v201
  v_accvgpr_write_b32 a104, v64
  v_accvgpr_write_b32 a105, v65
  v_accvgpr_write_b32 a106, v66
  v_accvgpr_write_b32 a107, v67
  v_accvgpr_read_b32 v64, a120
  v_accvgpr_read_b32 v65, a121
  v_accvgpr_read_b32 v66, a122
  v_accvgpr_read_b32 v67, a123
  v_mul_f32 v64, v64, v201
  v_mul_f32 v65, v65, v201
  v_mul_f32 v66, v66, v201
  v_mul_f32 v67, v67, v201
  v_accvgpr_write_b32 a120, v64
  v_accvgpr_write_b32 a121, v65
  v_accvgpr_write_b32 a122, v66
  v_accvgpr_write_b32 a123, v67
  v_mov_b32 v204, v252
  v_max3_f32 v204, v204, v24, v25
  v_max3_f32 v204, v204, v26, v27
  v_max3_f32 v204, v204, v28, v29
  v_max3_f32 v204, v204, v30, v31
  v_max3_f32 v204, v204, v56, v57
  v_max3_f32 v204, v204, v58, v59
  v_max3_f32 v204, v204, v60, v61
  v_max3_f32 v204, v204, v62, v63
  v_mov_b32 v245, v204
  s_nop 1
  v_permlane16_swap_b32 v204, v245
  v_max_f32 v204, v204, v245
  v_mov_b32 v245, v204
  s_nop 1
  v_permlane32_swap_b32 v204, v245
  v_max_f32 v204, v204, v245
  v_sub_f32 v205, v252, v204
  v_exp_f32 v205, v205
  v_mov_b32 v252, v204
  v_mul_f32 v211, v211, v205
  v_sub_f32 v24, v24, v204
  v_sub_f32 v25, v25, v204
  v_sub_f32 v26, v26, v204
  v_sub_f32 v27, v27, v204
  v_sub_f32 v28, v28, v204
  v_sub_f32 v29, v29, v204
  v_sub_f32 v30, v30, v204
  v_sub_f32 v31, v31, v204
  v_sub_f32 v56, v56, v204
  v_sub_f32 v57, v57, v204
  v_sub_f32 v58, v58, v204
  v_sub_f32 v59, v59, v204
  v_sub_f32 v60, v60, v204
  v_sub_f32 v61, v61, v204
  v_sub_f32 v62, v62, v204
  v_sub_f32 v63, v63, v204
  v_exp_f32 v24, v24
  v_exp_f32 v25, v25
  v_add_f32 v211, v211, v24
  v_exp_f32 v26, v26
  v_add_f32 v211, v211, v25
  v_cvt_pk_bf16_f32 v24, v24, v25
  v_exp_f32 v27, v27
  v_add_f32 v211, v211, v26
  v_add_f32 v211, v211, v27
  v_cvt_pk_bf16_f32 v25, v26, v27
  v_exp_f32 v28, v28
  v_exp_f32 v29, v29
  v_add_f32 v211, v211, v28
  v_exp_f32 v30, v30
  v_add_f32 v211, v211, v29
  v_cvt_pk_bf16_f32 v26, v28, v29
  v_exp_f32 v31, v31
  v_add_f32 v211, v211, v30
  v_add_f32 v211, v211, v31
  v_cvt_pk_bf16_f32 v27, v30, v31
  v_exp_f32 v56, v56
  v_exp_f32 v57, v57
  v_add_f32 v211, v211, v56
  v_exp_f32 v58, v58
  v_add_f32 v211, v211, v57
  v_cvt_pk_bf16_f32 v56, v56, v57
  v_exp_f32 v59, v59
  v_add_f32 v211, v211, v58
  v_add_f32 v211, v211, v59
  v_cvt_pk_bf16_f32 v57, v58, v59
  v_exp_f32 v60, v60
  v_exp_f32 v61, v61
  v_add_f32 v211, v211, v60
  v_exp_f32 v62, v62
  v_add_f32 v211, v211, v61
  v_cvt_pk_bf16_f32 v58, v60, v61
  v_exp_f32 v63, v63
  v_add_f32 v211, v211, v62
  v_add_f32 v211, v211, v63
  v_cvt_pk_bf16_f32 v59, v62, v63
  v_accvgpr_read_b32 v64, a12
  v_accvgpr_read_b32 v65, a13
  v_accvgpr_read_b32 v66, a14
  v_accvgpr_read_b32 v67, a15
  v_mul_f32 v64, v64, v205
  v_mul_f32 v65, v65, v205
  v_mul_f32 v66, v66, v205
  v_mul_f32 v67, v67, v205
  v_accvgpr_write_b32 a12, v64
  v_accvgpr_write_b32 a13, v65
  v_accvgpr_write_b32 a14, v66
  v_accvgpr_write_b32 a15, v67
  v_accvgpr_read_b32 v64, a28
  v_accvgpr_read_b32 v65, a29
  v_accvgpr_read_b32 v66, a30
  v_accvgpr_read_b32 v67, a31
  v_mul_f32 v64, v64, v205
  v_mul_f32 v65, v65, v205
  v_mul_f32 v66, v66, v205
  v_mul_f32 v67, v67, v205
  v_accvgpr_write_b32 a28, v64
  v_accvgpr_write_b32 a29, v65
  v_accvgpr_write_b32 a30, v66
  v_accvgpr_write_b32 a31, v67
  v_accvgpr_read_b32 v64, a44
  v_accvgpr_read_b32 v65, a45
  v_accvgpr_read_b32 v66, a46
  v_accvgpr_read_b32 v67, a47
  v_mul_f32 v64, v64, v205
  v_mul_f32 v65, v65, v205
  v_mul_f32 v66, v66, v205
  v_mul_f32 v67, v67, v205
  v_accvgpr_write_b32 a44, v64
  v_accvgpr_write_b32 a45, v65
  v_accvgpr_write_b32 a46, v66
  v_accvgpr_write_b32 a47, v67
  v_accvgpr_read_b32 v64, a60
  v_accvgpr_read_b32 v65, a61
  v_accvgpr_read_b32 v66, a62
  v_accvgpr_read_b32 v67, a63
  v_mul_f32 v64, v64, v205
  v_mul_f32 v65, v65, v205
  v_mul_f32 v66, v66, v205
  v_mul_f32 v67, v67, v205
  v_accvgpr_write_b32 a60, v64
  v_accvgpr_write_b32 a61, v65
  v_accvgpr_write_b32 a62, v66
  v_accvgpr_write_b32 a63, v67
  v_accvgpr_read_b32 v64, a76
  v_accvgpr_read_b32 v65, a77
  v_accvgpr_read_b32 v66, a78
  v_accvgpr_read_b32 v67, a79
  v_mul_f32 v64, v64, v205
  v_mul_f32 v65, v65, v205
  v_mul_f32 v66, v66, v205
  v_mul_f32 v67, v67, v205
  v_accvgpr_write_b32 a76, v64
  v_accvgpr_write_b32 a77, v65
  v_accvgpr_write_b32 a78, v66
  v_accvgpr_write_b32 a79, v67
  v_accvgpr_read_b32 v64, a92
  v_accvgpr_read_b32 v65, a93
  v_accvgpr_read_b32 v66, a94
  v_accvgpr_read_b32 v67, a95
  v_mul_f32 v64, v64, v205
  v_mul_f32 v65, v65, v205
  v_mul_f32 v66, v66, v205
  v_mul_f32 v67, v67, v205
  v_accvgpr_write_b32 a92, v64
  v_accvgpr_write_b32 a93, v65
  v_accvgpr_write_b32 a94, v66
  v_accvgpr_write_b32 a95, v67
  v_accvgpr_read_b32 v64, a108
  v_accvgpr_read_b32 v65, a109
  v_accvgpr_read_b32 v66, a110
  v_accvgpr_read_b32 v67, a111
  v_mul_f32 v64, v64, v205
  v_mul_f32 v65, v65, v205
  v_mul_f32 v66, v66, v205
  v_mul_f32 v67, v67, v205
  v_accvgpr_write_b32 a108, v64
  v_accvgpr_write_b32 a109, v65
  v_accvgpr_write_b32 a110, v66
  v_accvgpr_write_b32 a111, v67
  v_accvgpr_read_b32 v64, a124
  v_accvgpr_read_b32 v65, a125
  v_accvgpr_read_b32 v66, a126
  v_accvgpr_read_b32 v67, a127
  v_mul_f32 v64, v64, v205
  v_mul_f32 v65, v65, v205
  v_mul_f32 v66, v66, v205
  v_mul_f32 v67, v67, v205
  v_accvgpr_write_b32 a124, v64
  v_accvgpr_write_b32 a125, v65
  v_accvgpr_write_b32 a126, v66
  v_accvgpr_write_b32 a127, v67
  ds_read_b64_tr_b16 a[160:161], v216 offset:49152
  ds_read_b64_tr_b16 a[162:163], v216 offset:53248
  ds_read_b64_tr_b16 a[164:165], v216 offset:57344
  ds_read_b64_tr_b16 a[166:167], v216 offset:61440
  s_waitcnt lgkmcnt(2)
  v_mfma_f32_16x16x32_bf16 a[0:3], a[160:163], v[0:3], a[0:3]
  s_waitcnt lgkmcnt(0)
  v_mfma_f32_16x16x32_bf16 a[0:3], a[164:167], v[32:35], a[0:3]
  v_mfma_f32_16x16x32_bf16 a[4:7], a[164:167], v[40:43], a[4:7]
  v_mfma_f32_16x16x32_bf16 a[4:7], a[160:163], v[8:11], a[4:7]
  v_mfma_f32_16x16x32_bf16 a[8:11], a[160:163], v[16:19], a[8:11]
  v_mfma_f32_16x16x32_bf16 a[8:11], a[164:167], v[48:51], a[8:11]
  v_mfma_f32_16x16x32_bf16 a[12:15], a[164:167], v[56:59], a[12:15]
  v_mfma_f32_16x16x32_bf16 a[12:15], a[160:163], v[24:27], a[12:15]
  ds_read_b64_tr_b16 a[168:169], v217 offset:49152
  ds_read_b64_tr_b16 a[170:171], v217 offset:53248
  ds_read_b64_tr_b16 a[172:173], v217 offset:57344
  ds_read_b64_tr_b16 a[174:175], v217 offset:61440
  s_waitcnt lgkmcnt(2)
  v_mfma_f32_16x16x32_bf16 a[16:19], a[168:171], v[0:3], a[16:19]
  s_waitcnt lgkmcnt(0)
  v_mfma_f32_16x16x32_bf16 a[16:19], a[172:175], v[32:35], a[16:19]
  v_mfma_f32_16x16x32_bf16 a[20:23], a[172:175], v[40:43], a[20:23]
  v_mfma_f32_16x16x32_bf16 a[20:23], a[168:171], v[8:11], a[20:23]
  v_mfma_f32_16x16x32_bf16 a[24:27], a[168:171], v[16:19], a[24:27]
  v_mfma_f32_16x16x32_bf16 a[24:27], a[172:175], v[48:51], a[24:27]
  v_mfma_f32_16x16x32_bf16 a[28:31], a[172:175], v[56:59], a[28:31]
  v_mfma_f32_16x16x32_bf16 a[28:31], a[168:171], v[24:27], a[28:31]
  ds_read_b64_tr_b16 a[176:177], v218 offset:49152
  ds_read_b64_tr_b16 a[178:179], v218 offset:53248
  ds_read_b64_tr_b16 a[180:181], v218 offset:57344
  ds_read_b64_tr_b16 a[182:183], v218 offset:61440
  s_waitcnt lgkmcnt(2)
  v_mfma_f32_16x16x32_bf16 a[32:35], a[176:179], v[0:3], a[32:35]
  s_waitcnt lgkmcnt(0)
  v_mfma_f32_16x16x32_bf16 a[32:35], a[180:183], v[32:35], a[32:35]
  v_mfma_f32_16x16x32_bf16 a[36:39], a[180:183], v[40:43], a[36:39]
  v_mfma_f32_16x16x32_bf16 a[36:39], a[176:179], v[8:11], a[36:39]
  v_mfma_f32_16x16x32_bf16 a[40:43], a[176:179], v[16:19], a[40:43]
  v_mfma_f32_16x16x32_bf16 a[40:43], a[180:183], v[48:51], a[40:43]
  v_mfma_f32_16x16x32_bf16 a[44:47], a[180:183], v[56:59], a[44:47]
  v_mfma_f32_16x16x32_bf16 a[44:47], a[176:179], v[24:27], a[44:47]
  ds_read_b64_tr_b16 a[184:185], v219 offset:49152
  ds_read_b64_tr_b16 a[186:187], v219 offset:53248
  ds_read_b64_tr_b16 a[188:189], v219 offset:57344
  ds_read_b64_tr_b16 a[190:191], v219 offset:61440
  s_waitcnt lgkmcnt(2)
  v_mfma_f32_16x16x32_bf16 a[48:51], a[184:187], v[0:3], a[48:51]
  s_waitcnt lgkmcnt(0)
  v_mfma_f32_16x16x32_bf16 a[48:51], a[188:191], v[32:35], a[48:51]
  v_mfma_f32_16x16x32_bf16 a[52:55], a[188:191], v[40:43], a[52:55]
  v_mfma_f32_16x16x32_bf16 a[52:55], a[184:187], v[8:11], a[52:55]
  v_mfma_f32_16x16x32_bf16 a[56:59], a[184:187], v[16:19], a[56:59]
  v_mfma_f32_16x16x32_bf16 a[56:59], a[188:191], v[48:51], a[56:59]
  v_mfma_f32_16x16x32_bf16 a[60:63], a[188:191], v[56:59], a[60:63]
  v_mfma_f32_16x16x32_bf16 a[60:63], a[184:187], v[24:27], a[60:63]
  ds_read_b64_tr_b16 a[160:161], v220 offset:49152
  ds_read_b64_tr_b16 a[162:163], v220 offset:53248
  ds_read_b64_tr_b16 a[164:165], v220 offset:57344
  ds_read_b64_tr_b16 a[166:167], v220 offset:61440
  s_waitcnt lgkmcnt(2)
  v_mfma_f32_16x16x32_bf16 a[64:67], a[160:163], v[0:3], a[64:67]
  s_waitcnt lgkmcnt(0)
  v_mfma_f32_16x16x32_bf16 a[64:67], a[164:167], v[32:35], a[64:67]
  v_mfma_f32_16x16x32_bf16 a[68:71], a[164:167], v[40:43], a[68:71]
  v_mfma_f32_16x16x32_bf16 a[68:71], a[160:163], v[8:11], a[68:71]
  v_mfma_f32_16x16x32_bf16 a[72:75], a[160:163], v[16:19], a[72:75]
  v_mfma_f32_16x16x32_bf16 a[72:75], a[164:167], v[48:51], a[72:75]
  v_mfma_f32_16x16x32_bf16 a[76:79], a[164:167], v[56:59], a[76:79]
  v_mfma_f32_16x16x32_bf16 a[76:79], a[160:163], v[24:27], a[76:79]
  ds_read_b64_tr_b16 a[168:169], v221 offset:49152
  ds_read_b64_tr_b16 a[170:171], v221 offset:53248
  ds_read_b64_tr_b16 a[172:173], v221 offset:57344
  ds_read_b64_tr_b16 a[174:175], v221 offset:61440
  s_waitcnt lgkmcnt(2)
  v_mfma_f32_16x16x32_bf16 a[80:83], a[168:171], v[0:3], a[80:83]
  s_waitcnt lgkmcnt(0)
  v_mfma_f32_16x16x32_bf16 a[80:83], a[172:175], v[32:35], a[80:83]
  v_mfma_f32_16x16x32_bf16 a[84:87], a[172:175], v[40:43], a[84:87]
  v_mfma_f32_16x16x32_bf16 a[84:87], a[168:171], v[8:11], a[84:87]
  v_mfma_f32_16x16x32_bf16 a[88:91], a[168:171], v[16:19], a[88:91]
  v_mfma_f32_16x16x32_bf16 a[88:91], a[172:175], v[48:51], a[88:91]
  v_mfma_f32_16x16x32_bf16 a[92:95], a[172:175], v[56:59], a[92:95]
  v_mfma_f32_16x16x32_bf16 a[92:95], a[168:171], v[24:27], a[92:95]
  ds_read_b64_tr_b16 a[176:177], v222 offset:49152
  ds_read_b64_tr_b16 a[178:179], v222 offset:53248
  ds_read_b64_tr_b16 a[180:181], v222 offset:57344
  ds_read_b64_tr_b16 a[182:183], v222 offset:61440
  s_waitcnt lgkmcnt(2)
  v_mfma_f32_16x16x32_bf16 a[96:99], a[176:179], v[0:3], a[96:99]
  s_waitcnt lgkmcnt(0)
  v_mfma_f32_16x16x32_bf16 a[96:99], a[180:183], v[32:35], a[96:99]
  v_mfma_f32_16x16x32_bf16 a[100:103], a[180:183], v[40:43], a[100:103]
  v_mfma_f32_16x16x32_bf16 a[100:103], a[176:179], v[8:11], a[100:103]
  v_mfma_f32_16x16x32_bf16 a[104:107], a[176:179], v[16:19], a[104:107]
  v_mfma_f32_16x16x32_bf16 a[104:107], a[180:183], v[48:51], a[104:107]
  v_mfma_f32_16x16x32_bf16 a[108:111], a[180:183], v[56:59], a[108:111]
  v_mfma_f32_16x16x32_bf16 a[108:111], a[176:179], v[24:27], a[108:111]
  ds_read_b64_tr_b16 a[184:185], v223 offset:49152
  ds_read_b64_tr_b16 a[186:187], v223 offset:53248
  ds_read_b64_tr_b16 a[188:189], v223 offset:57344
  ds_read_b64_tr_b16 a[190:191], v223 offset:61440
  s_waitcnt lgkmcnt(2)
  v_mfma_f32_16x16x32_bf16 a[112:115], a[184:187], v[0:3], a[112:115]
  s_waitcnt lgkmcnt(0)
  v_mfma_f32_16x16x32_bf16 a[112:115], a[188:191], v[32:35], a[112:115]
  v_mfma_f32_16x16x32_bf16 a[116:119], a[188:191], v[40:43], a[116:119]
  v_mfma_f32_16x16x32_bf16 a[116:119], a[184:187], v[8:11], a[116:119]
  v_mfma_f32_16x16x32_bf16 a[120:123], a[184:187], v[16:19], a[120:123]
  v_mfma_f32_16x16x32_bf16 a[120:123], a[188:191], v[48:51], a[120:123]
  v_mfma_f32_16x16x32_bf16 a[124:127], a[188:191], v[56:59], a[124:127]
  v_mfma_f32_16x16x32_bf16 a[124:127], a[184:187], v[24:27], a[124:127]
  s_add_u32 s29, s29, 16384
  s_cmp_lt_u32 s29, 524288
  s_cbranch_scc1 attn_slow
  v_mov_b32 v245, v208
  v_mov_b32 v246, v209
  v_mov_b32 v247, v210
  v_mov_b32 v248, v211
  v_permlane16_swap_b32 v208, v245
  v_permlane16_swap_b32 v209, v246
  v_permlane16_swap_b32 v210, v247
  v_permlane16_swap_b32 v211, v248
  v_add_f32 v208, v208, v245
  v_add_f32 v209, v209, v246
  v_add_f32 v210, v210, v247
  v_add_f32 v211, v211, v248
  v_mov_b32 v245, v208
  v_mov_b32 v246, v209
  v_mov_b32 v247, v210
  v_mov_b32 v248, v211
  v_permlane32_swap_b32 v208, v245
  v_permlane32_swap_b32 v209, v246
  v_permlane32_swap_b32 v210, v247
  v_permlane32_swap_b32 v211, v248
  v_add_f32 v208, v208, v245
  v_add_f32 v209, v209, v246
  v_add_f32 v210, v210, v247
  v_add_f32 v211, v211, v248
  v_rcp_f32 v192, v208
  v_rcp_f32 v196, v209
  v_rcp_f32 v200, v210
  v_rcp_f32 v204, v211
  v_accvgpr_read_b32 v0, a0
  v_accvgpr_read_b32 v1, a1
  v_accvgpr_read_b32 v2, a2
  v_accvgpr_read_b32 v3, a3
  v_accvgpr_read_b32 v4, a16
  v_accvgpr_read_b32 v5, a17
  v_accvgpr_read_b32 v6, a18
  v_accvgpr_read_b32 v7, a19
  v_mul_f32 v0, v0, v192
  v_mul_f32 v1, v1, v192
  v_mul_f32 v2, v2, v192
  v_mul_f32 v3, v3, v192
  v_mul_f32 v4, v4, v192
  v_mul_f32 v5, v5, v192
  v_mul_f32 v6, v6, v192
  v_mul_f32 v7, v7, v192
  v_cvt_pk_bf16_f32 v0, v0, v1
  v_cvt_pk_bf16_f32 v1, v2, v3
  v_cvt_pk_bf16_f32 v2, v4, v5
  v_cvt_pk_bf16_f32 v3, v6, v7
  buffer_store_dwordx4 v[0:3], v244, s[24:27], s40 offen offset:0 sc1
  v_accvgpr_read_b32 v8, a4
  v_accvgpr_read_b32 v9, a5
  v_accvgpr_read_b32 v10, a6
  v_accvgpr_read_b32 v11, a7
  v_accvgpr_read_b32 v12, a20
  v_accvgpr_read_b32 v13, a21
  v_accvgpr_read_b32 v14, a22
  v_accvgpr_read_b32 v15, a23
  v_mul_f32 v8, v8, v196
  v_mul_f32 v9, v9, v196
  v_mul_f32 v10, v10, v196
  v_mul_f32 v11, v11, v196
  v_mul_f32 v12, v12, v196
  v_mul_f32 v13, v13, v196
  v_mul_f32 v14, v14, v196
  v_mul_f32 v15, v15, v196
  v_cvt_pk_bf16_f32 v8, v8, v9
  v_cvt_pk_bf16_f32 v9, v10, v11
  v_cvt_pk_bf16_f32 v10, v12, v13
  v_cvt_pk_bf16_f32 v11, v14, v15
  buffer_store_dwordx4 v[8:11], v244, s[24:27], s40 offen offset:2048 sc1
  v_accvgpr_read_b32 v16, a8
  v_accvgpr_read_b32 v17, a9
  v_accvgpr_read_b32 v18, a10
  v_accvgpr_read_b32 v19, a11
  v_accvgpr_read_b32 v20, a24
  v_accvgpr_read_b32 v21, a25
  v_accvgpr_read_b32 v22, a26
  v_accvgpr_read_b32 v23, a27
  v_mul_f32 v16, v16, v200
  v_mul_f32 v17, v17, v200
  v_mul_f32 v18, v18, v200
  v_mul_f32 v19, v19, v200
  v_mul_f32 v20, v20, v200
  v_mul_f32 v21, v21, v200
  v_mul_f32 v22, v22, v200
  v_mul_f32 v23, v23, v200
  v_cvt_pk_bf16_f32 v16, v16, v17
  v_cvt_pk_bf16_f32 v17, v18, v19
  v_cvt_pk_bf16_f32 v18, v20, v21
  v_cvt_pk_bf16_f32 v19, v22, v23
  buffer_store_dwordx4 v[16:19], v244, s[24:27], s41 offen offset:0 sc1
  v_accvgpr_read_b32 v24, a12
  v_accvgpr_read_b32 v25, a13
  v_accvgpr_read_b32 v26, a14
  v_accvgpr_read_b32 v27, a15
  v_accvgpr_read_b32 v28, a28
  v_accvgpr_read_b32 v29, a29
  v_accvgpr_read_b32 v30, a30
  v_accvgpr_read_b32 v31, a31
  v_mul_f32 v24, v24, v204
  v_mul_f32 v25, v25, v204
  v_mul_f32 v26, v26, v204
  v_mul_f32 v27, v27, v204
  v_mul_f32 v28, v28, v204
  v_mul_f32 v29, v29, v204
  v_mul_f32 v30, v30, v204
  v_mul_f32 v31, v31, v204
  v_cvt_pk_bf16_f32 v24, v24, v25
  v_cvt_pk_bf16_f32 v25, v26, v27
  v_cvt_pk_bf16_f32 v26, v28, v29
  v_cvt_pk_bf16_f32 v27, v30, v31
  buffer_store_dwordx4 v[24:27], v244, s[24:27], s41 offen offset:2048 sc1
  v_accvgpr_read_b32 v32, a32
  v_accvgpr_read_b32 v33, a33
  v_accvgpr_read_b32 v34, a34
  v_accvgpr_read_b32 v35, a35
  v_accvgpr_read_b32 v36, a48
  v_accvgpr_read_b32 v37, a49
  v_accvgpr_read_b32 v38, a50
  v_accvgpr_read_b32 v39, a51
  v_mul_f32 v32, v32, v192
  v_mul_f32 v33, v33, v192
  v_mul_f32 v34, v34, v192
  v_mul_f32 v35, v35, v192
  v_mul_f32 v36, v36, v192
  v_mul_f32 v37, v37, v192
  v_mul_f32 v38, v38, v192
  v_mul_f32 v39, v39, v192
  v_cvt_pk_bf16_f32 v32, v32, v33
  v_cvt_pk_bf16_f32 v33, v34, v35
  v_cvt_pk_bf16_f32 v34, v36, v37
  v_cvt_pk_bf16_f32 v35, v38, v39
  buffer_store_dwordx4 v[32:35], v244, s[24:27], s40 offen offset:1024 sc1
  v_accvgpr_read_b32 v40, a36
  v_accvgpr_read_b32 v41, a37
  v_accvgpr_read_b32 v42, a38
  v_accvgpr_read_b32 v43, a39
  v_accvgpr_read_b32 v44, a52
  v_accvgpr_read_b32 v45, a53
  v_accvgpr_read_b32 v46, a54
  v_accvgpr_read_b32 v47, a55
  v_mul_f32 v40, v40, v196
  v_mul_f32 v41, v41, v196
  v_mul_f32 v42, v42, v196
  v_mul_f32 v43, v43, v196
  v_mul_f32 v44, v44, v196
  v_mul_f32 v45, v45, v196
  v_mul_f32 v46, v46, v196
  v_mul_f32 v47, v47, v196
  v_cvt_pk_bf16_f32 v40, v40, v41
  v_cvt_pk_bf16_f32 v41, v42, v43
  v_cvt_pk_bf16_f32 v42, v44, v45
  v_cvt_pk_bf16_f32 v43, v46, v47
  buffer_store_dwordx4 v[40:43], v244, s[24:27], s40 offen offset:3072 sc1
  v_accvgpr_read_b32 v48, a40
  v_accvgpr_read_b32 v49, a41
  v_accvgpr_read_b32 v50, a42
  v_accvgpr_read_b32 v51, a43
  v_accvgpr_read_b32 v52, a56
  v_accvgpr_read_b32 v53, a57
  v_accvgpr_read_b32 v54, a58
  v_accvgpr_read_b32 v55, a59
  v_mul_f32 v48, v48, v200
  v_mul_f32 v49, v49, v200
  v_mul_f32 v50, v50, v200
  v_mul_f32 v51, v51, v200
  v_mul_f32 v52, v52, v200
  v_mul_f32 v53, v53, v200
  v_mul_f32 v54, v54, v200
  v_mul_f32 v55, v55, v200
  v_cvt_pk_bf16_f32 v48, v48, v49
  v_cvt_pk_bf16_f32 v49, v50, v51
  v_cvt_pk_bf16_f32 v50, v52, v53
  v_cvt_pk_bf16_f32 v51, v54, v55
  buffer_store_dwordx4 v[48:51], v244, s[24:27], s41 offen offset:1024 sc1
  v_accvgpr_read_b32 v56, a44
  v_accvgpr_read_b32 v57, a45
  v_accvgpr_read_b32 v58, a46
  v_accvgpr_read_b32 v59, a47
  v_accvgpr_read_b32 v60, a60
  v_accvgpr_read_b32 v61, a61
  v_accvgpr_read_b32 v62, a62
  v_accvgpr_read_b32 v63, a63
  v_mul_f32 v56, v56, v204
  v_mul_f32 v57, v57, v204
  v_mul_f32 v58, v58, v204
  v_mul_f32 v59, v59, v204
  v_mul_f32 v60, v60, v204
  v_mul_f32 v61, v61, v204
  v_mul_f32 v62, v62, v204
  v_mul_f32 v63, v63, v204
  v_cvt_pk_bf16_f32 v56, v56, v57
  v_cvt_pk_bf16_f32 v57, v58, v59
  v_cvt_pk_bf16_f32 v58, v60, v61
  v_cvt_pk_bf16_f32 v59, v62, v63
  buffer_store_dwordx4 v[56:59], v244, s[24:27], s41 offen offset:3072 sc1
  v_accvgpr_read_b32 v0, a64
  v_accvgpr_read_b32 v1, a65
  v_accvgpr_read_b32 v2, a66
  v_accvgpr_read_b32 v3, a67
  v_accvgpr_read_b32 v4, a80
  v_accvgpr_read_b32 v5, a81
  v_accvgpr_read_b32 v6, a82
  v_accvgpr_read_b32 v7, a83
  v_mul_f32 v0, v0, v192
  v_mul_f32 v1, v1, v192
  v_mul_f32 v2, v2, v192
  v_mul_f32 v3, v3, v192
  v_mul_f32 v4, v4, v192
  v_mul_f32 v5, v5, v192
  v_mul_f32 v6, v6, v192
  v_mul_f32 v7, v7, v192
  v_cvt_pk_bf16_f32 v0, v0, v1
  v_cvt_pk_bf16_f32 v1, v2, v3
  v_cvt_pk_bf16_f32 v2, v4, v5
  v_cvt_pk_bf16_f32 v3, v6, v7
  buffer_store_dwordx4 v[0:3], v244, s[24:27], s42 offen offset:0 sc1
  v_accvgpr_read_b32 v8, a68
  v_accvgpr_read_b32 v9, a69
  v_accvgpr_read_b32 v10, a70
  v_accvgpr_read_b32 v11, a71
  v_accvgpr_read_b32 v12, a84
  v_accvgpr_read_b32 v13, a85
  v_accvgpr_read_b32 v14, a86
  v_accvgpr_read_b32 v15, a87
  v_mul_f32 v8, v8, v196
  v_mul_f32 v9, v9, v196
  v_mul_f32 v10, v10, v196
  v_mul_f32 v11, v11, v196
  v_mul_f32 v12, v12, v196
  v_mul_f32 v13, v13, v196
  v_mul_f32 v14, v14, v196
  v_mul_f32 v15, v15, v196
  v_cvt_pk_bf16_f32 v8, v8, v9
  v_cvt_pk_bf16_f32 v9, v10, v11
  v_cvt_pk_bf16_f32 v10, v12, v13
  v_cvt_pk_bf16_f32 v11, v14, v15
  buffer_store_dwordx4 v[8:11], v244, s[24:27], s42 offen offset:2048 sc1
  v_accvgpr_read_b32 v16, a72
  v_accvgpr_read_b32 v17, a73
  v_accvgpr_read_b32 v18, a74
  v_accvgpr_read_b32 v19, a75
  v_accvgpr_read_b32 v20, a88
  v_accvgpr_read_b32 v21, a89
  v_accvgpr_read_b32 v22, a90
  v_accvgpr_read_b32 v23, a91
  v_mul_f32 v16, v16, v200
  v_mul_f32 v17, v17, v200
  v_mul_f32 v18, v18, v200
  v_mul_f32 v19, v19, v200
  v_mul_f32 v20, v20, v200
  v_mul_f32 v21, v21, v200
  v_mul_f32 v22, v22, v200
  v_mul_f32 v23, v23, v200
  v_cvt_pk_bf16_f32 v16, v16, v17
  v_cvt_pk_bf16_f32 v17, v18, v19
  v_cvt_pk_bf16_f32 v18, v20, v21
  v_cvt_pk_bf16_f32 v19, v22, v23
  buffer_store_dwordx4 v[16:19], v244, s[24:27], s43 offen offset:0 sc1
  v_accvgpr_read_b32 v24, a76
  v_accvgpr_read_b32 v25, a77
  v_accvgpr_read_b32 v26, a78
  v_accvgpr_read_b32 v27, a79
  v_accvgpr_read_b32 v28, a92
  v_accvgpr_read_b32 v29, a93
  v_accvgpr_read_b32 v30, a94
  v_accvgpr_read_b32 v31, a95
  v_mul_f32 v24, v24, v204
  v_mul_f32 v25, v25, v204
  v_mul_f32 v26, v26, v204
  v_mul_f32 v27, v27, v204
  v_mul_f32 v28, v28, v204
  v_mul_f32 v29, v29, v204
  v_mul_f32 v30, v30, v204
  v_mul_f32 v31, v31, v204
  v_cvt_pk_bf16_f32 v24, v24, v25
  v_cvt_pk_bf16_f32 v25, v26, v27
  v_cvt_pk_bf16_f32 v26, v28, v29
  v_cvt_pk_bf16_f32 v27, v30, v31
  buffer_store_dwordx4 v[24:27], v244, s[24:27], s43 offen offset:2048 sc1
  v_accvgpr_read_b32 v32, a96
  v_accvgpr_read_b32 v33, a97
  v_accvgpr_read_b32 v34, a98
  v_accvgpr_read_b32 v35, a99
  v_accvgpr_read_b32 v36, a112
  v_accvgpr_read_b32 v37, a113
  v_accvgpr_read_b32 v38, a114
  v_accvgpr_read_b32 v39, a115
  v_mul_f32 v32, v32, v192
  v_mul_f32 v33, v33, v192
  v_mul_f32 v34, v34, v192
  v_mul_f32 v35, v35, v192
  v_mul_f32 v36, v36, v192
  v_mul_f32 v37, v37, v192
  v_mul_f32 v38, v38, v192
  v_mul_f32 v39, v39, v192
  v_cvt_pk_bf16_f32 v32, v32, v33
  v_cvt_pk_bf16_f32 v33, v34, v35
  v_cvt_pk_bf16_f32 v34, v36, v37
  v_cvt_pk_bf16_f32 v35, v38, v39
  buffer_store_dwordx4 v[32:35], v244, s[24:27], s42 offen offset:1024 sc1
  v_accvgpr_read_b32 v40, a100
  v_accvgpr_read_b32 v41, a101
  v_accvgpr_read_b32 v42, a102
  v_accvgpr_read_b32 v43, a103
  v_accvgpr_read_b32 v44, a116
  v_accvgpr_read_b32 v45, a117
  v_accvgpr_read_b32 v46, a118
  v_accvgpr_read_b32 v47, a119
  v_mul_f32 v40, v40, v196
  v_mul_f32 v41, v41, v196
  v_mul_f32 v42, v42, v196
  v_mul_f32 v43, v43, v196
  v_mul_f32 v44, v44, v196
  v_mul_f32 v45, v45, v196
  v_mul_f32 v46, v46, v196
  v_mul_f32 v47, v47, v196
  v_cvt_pk_bf16_f32 v40, v40, v41
  v_cvt_pk_bf16_f32 v41, v42, v43
  v_cvt_pk_bf16_f32 v42, v44, v45
  v_cvt_pk_bf16_f32 v43, v46, v47
  buffer_store_dwordx4 v[40:43], v244, s[24:27], s42 offen offset:3072 sc1
  v_accvgpr_read_b32 v48, a104
  v_accvgpr_read_b32 v49, a105
  v_accvgpr_read_b32 v50, a106
  v_accvgpr_read_b32 v51, a107
  v_accvgpr_read_b32 v52, a120
  v_accvgpr_read_b32 v53, a121
  v_accvgpr_read_b32 v54, a122
  v_accvgpr_read_b32 v55, a123
  v_mul_f32 v48, v48, v200
  v_mul_f32 v49, v49, v200
  v_mul_f32 v50, v50, v200
  v_mul_f32 v51, v51, v200
  v_mul_f32 v52, v52, v200
  v_mul_f32 v53, v53, v200
  v_mul_f32 v54, v54, v200
  v_mul_f32 v55, v55, v200
  v_cvt_pk_bf16_f32 v48, v48, v49
  v_cvt_pk_bf16_f32 v49, v50, v51
  v_cvt_pk_bf16_f32 v50, v52, v53
  v_cvt_pk_bf16_f32 v51, v54, v55
  buffer_store_dwordx4 v[48:51], v244, s[24:27], s43 offen offset:1024 sc1
  v_accvgpr_read_b32 v56, a108
  v_accvgpr_read_b32 v57, a109
  v_accvgpr_read_b32 v58, a110
  v_accvgpr_read_b32 v59, a111
  v_accvgpr_read_b32 v60, a124
  v_accvgpr_read_b32 v61, a125
  v_accvgpr_read_b32 v62, a126
  v_accvgpr_read_b32 v63, a127
  v_mul_f32 v56, v56, v204
  v_mul_f32 v57, v57, v204
  v_mul_f32 v58, v58, v204
  v_mul_f32 v59, v59, v204
  v_mul_f32 v60, v60, v204
  v_mul_f32 v61, v61, v204
  v_mul_f32 v62, v62, v204
  v_mul_f32 v63, v63, v204
  v_cvt_pk_bf16_f32 v56, v56, v57
  v_cvt_pk_bf16_f32 v57, v58, v59
  v_cvt_pk_bf16_f32 v58, v60, v61
  v_cvt_pk_bf16_f32 v59, v62, v63
  buffer_store_dwordx4 v[56:59], v244, s[24:27], s43 offen offset:3072 sc1
  v_add_u32 v252, 4096, v242
  v_add_u32 v253, 8192, v242
  buffer_load_dwordx4 a[128:131], v253, s[24:27], s4 offen offset:3072 sc1
  buffer_load_dwordx4 a[132:135], v242, s[24:27], s5 offen offset:0 sc1
  buffer_load_dwordx4 a[136:139], v242, s[24:27], s5 offen offset:1024 sc1
  buffer_load_dwordx4 a[140:143], v242, s[24:27], s5 offen offset:2048 sc1
  buffer_load_dwordx4 a[144:147], v242, s[24:27], s5 offen offset:3072 sc1
  buffer_load_dwordx4 a[148:151], v252, s[24:27], s5 offen offset:0 sc1
  buffer_load_dwordx4 a[152:155], v252, s[24:27], s5 offen offset:1024 sc1
  buffer_load_dwordx4 a[156:159], v252, s[24:27], s5 offen offset:2048 sc1
  buffer_load_dwordx4 a[0:3], v252, s[24:27], s5 offen offset:3072 sc1
  buffer_load_dwordx4 a[4:7], v253, s[24:27], s5 offen offset:0 sc1
  buffer_load_dwordx4 a[8:11], v253, s[24:27], s5 offen offset:1024 sc1
  buffer_load_dwordx4 a[12:15], v253, s[24:27], s5 offen offset:2048 sc1
  buffer_load_dwordx4 a[16:19], v253, s[24:27], s5 offen offset:3072 sc1
  buffer_load_dwordx4 a[20:23], v242, s[24:27], s6 offen offset:0 sc1
  buffer_load_dwordx4 a[24:27], v242, s[24:27], s6 offen offset:1024 sc1
  buffer_load_dwordx4 a[28:31], v242, s[24:27], s6 offen offset:2048 sc1
  buffer_load_dwordx4 a[32:35], v242, s[24:27], s6 offen offset:3072 sc1
  buffer_load_dwordx4 a[36:39], v252, s[24:27], s6 offen offset:0 sc1
  buffer_load_dwordx4 a[40:43], v252, s[24:27], s6 offen offset:1024 sc1
  buffer_load_dwordx4 a[44:47], v252, s[24:27], s6 offen offset:2048 sc1
  buffer_load_dwordx4 a[48:51], v252, s[24:27], s6 offen offset:3072 sc1
  buffer_load_dwordx4 a[52:55], v253, s[24:27], s6 offen offset:0 sc1
  s_bfe_u32 s39, s2, 0x40002
  s_lshl_b32 s39, s39, 8
  s_add_u32 s39, s39, 2818304
  s_lshl_b32 s38, s3, 26
  v_lshlrev_b32 v64, 22, v242
  v_or_b32 v64, s38, v64
  v_mov_b32 v65, 1
  s_waitcnt vmcnt(0)
  s_barrier
  s_branch tail_go
.section .rodata,"a"
.p2align 6
.amdhsa_kernel recurrent_scan__mha_block_cached__moe_arch_mod__prompt_kernel
  .amdhsa_next_free_vgpr 512
  .amdhsa_next_free_sgpr 102
  .amdhsa_accum_offset 256
  .amdhsa_group_segment_fixed_size 0
  .amdhsa_kernarg_size 104
  .amdhsa_user_sgpr_count 2
  .amdhsa_user_sgpr_kernarg_segment_ptr 1
  .amdhsa_system_sgpr_workgroup_id_x 1
.end_amdhsa_kernel
```

```asm
; @launch grid=(256,1,1) block=(256,1,1) lds=163840
.amdgcn_target "amdgcn-amd-amdhsa--gfx950"
.text
.globl recurrent_scan__mha_block_cached__moe_arch_mod__prompt_kernel
.p2align 8
.type recurrent_scan__mha_block_cached__moe_arch_mod__prompt_kernel,@function
recurrent_scan__mha_block_cached__moe_arch_mod__prompt_kernel:
  s_cmp_ge_u32 s2, 256
  s_cbranch_scc1 attn_end
  s_load_dwordx2 s[60:61], s[0:1], 0
  s_load_dwordx2 s[48:49], s[0:1], 48
  s_load_dwordx4 s[4:7], s[0:1], 8
  s_load_dwordx2 s[8:9], s[0:1], 24
  s_load_dwordx2 s[10:11], s[0:1], 96
  s_load_dwordx2 s[88:89], s[0:1], 32
  s_load_dwordx2 s[90:91], s[0:1], 56
  s_load_dwordx4 s[92:95], s[0:1], 64
  s_load_dwordx2 s[96:97], s[0:1], 88
  s_load_dwordx2 s[62:63], s[0:1], 80
  s_getpc_b64 s[98:99]
attn_hot_pc:
  s_add_u32 s98, s98, attn_hot-attn_hot_pc
  s_addc_u32 s99, s99, 0
  v_lshlrev_b32 v249, 7, v0
  v_min_u32 v249, attn_end-attn_hot-4, v249
  global_load_dword v255, v249, s[98:99]
  v_add_u32 v249, 0x8000, v249
  v_min_u32 v249, attn_end-attn_hot-4, v249
  global_load_dword v255, v249, s[98:99]
attn_hot:
  v_lshrrev_b32 v249, 6, v0
  v_and_b32 v0, 63, v0
  v_mov_b32 v245, v0
  v_readfirstlane_b32 s3, v249
  s_and_b32 s36, s2, 7
  s_lshl_b32 s36, s36, 2
  s_lshr_b32 s37, s2, 6
  s_add_u32 s36, s36, s37
  s_bfe_u32 s37, s2, 0x30003
  s_lshl_b32 s37, s37, 2
  s_add_u32 s37, s37, s3
  s_lshl_b32 s28, s3, 12
  v_lshrrev_b32 v248, 4, v245
  v_and_b32 v247, 15, v245
  s_lshl_b32 s38, s3, 17
  v_lshlrev_b32 v249, 13, v248
  v_add_u32 v249, s38, v249
  v_or_b32 v250, 0, v248
  v_lshlrev_b32 v250, 1, v250
  v_xor_b32 v250, v250, v247
  v_lshl_add_u32 v238, v250, 4, v249
  v_or_b32 v250, 0, v248
  v_lshlrev_b32 v250, 1, v250
  v_xor_b32 v250, v250, v247
  v_lshl_add_u32 v239, v250, 4, v249
  v_add_u32 v239, 31744, v239
  v_or_b32 v250, 4, v248
  v_lshlrev_b32 v250, 1, v250
  v_xor_b32 v250, v250, v247
  v_lshl_add_u32 v240, v250, 4, v249
  v_add_u32 v240, 63488, v240
  v_or_b32 v250, 4, v248
  v_lshlrev_b32 v250, 1, v250
  v_xor_b32 v250, v250, v247
  v_lshl_add_u32 v241, v250, 4, v249
  v_add_u32 v241, 95232, v241
  s_waitcnt lgkmcnt(0)
  s_add_u32 s58, s10, 2830336
  s_addc_u32 s59, s11, 0
  s_load_dword s59, s[58:59], 0
  s_mov_b32 s24, s10
  s_mov_b32 s25, s11
  s_mov_b32 s26, 33554432
  s_mov_b32 s27, 0x20000
  s_lshl_b32 s38, s36, 8
  s_add_u32 s20, s8, s38
  s_addc_u32 s21, s9, 0
  s_mov_b32 s22, 5242880
  s_mov_b32 s23, 0x20000
  s_sub_u32 s22, s22, s38
  s_cmp_ge_u32 s3, 2
  s_cbranch_scc1 front_fetch
  s_mov_b32 s12, s60
  s_mov_b32 s13, s61
  s_mov_b32 s14, 2621440
  s_mov_b32 s15, 0x20000
  s_mov_b32 s16, s48
  s_mov_b32 s17, s49
  s_mov_b32 s18, 1280
  s_mov_b32 s19, 0x20000
  s_lshr_b32 s52, s37, 2
  s_lshl_b32 s52, s52, 5
  s_add_u32 s52, s52, s36
  s_lshl_b32 s52, s52, 1
  s_add_u32 s52, s52, s3
  s_lshl_b32 s52, s52, 2
  s_mul_i32 s53, s52, 1280
  v_lshrrev_b32 v1, 4, v0
  v_and_b32 v2, 15, v0
  v_lshlrev_b32 v3, 4, v2
  v_mul_u32_u24 v4, 0x500, v1
  v_add_u32 v4, v4, v3
  buffer_load_dwordx4 v[8:11], v4, s[12:15], s53 offen offset:0
  buffer_load_dwordx4 v[12:15], v4, s[12:15], s53 offen offset:256
  buffer_load_dwordx4 v[16:19], v4, s[12:15], s53 offen offset:512
  buffer_load_dwordx4 v[20:23], v4, s[12:15], s53 offen offset:768
  buffer_load_dwordx4 v[24:27], v4, s[12:15], s53 offen offset:1024
  buffer_load_dwordx4 v[28:31], v3, s[16:19], 0 offen offset:0
  buffer_load_dwordx4 v[32:35], v3, s[16:19], 0 offen offset:256
  buffer_load_dwordx4 v[36:39], v3, s[16:19], 0 offen offset:512
  buffer_load_dwordx4 v[40:43], v3, s[16:19], 0 offen offset:768
  buffer_load_dwordx4 v[44:47], v3, s[16:19], 0 offen offset:1024
  v_mov_b32 v7, 0
  v_lshlrev_b32 v6, 26, v0
  s_lshl_b32 s53, s2, 7
  s_add_u32 s53, s53, 2834432
  buffer_store_dword v7, v6, s[24:27], s53 offen sc1
  v_lshlrev_b32 v6, 8, v0
  v_lshrrev_b32 v5, 5, v0
  v_lshl_add_u32 v6, v5, 26, v6
  s_cmp_eq_u32 s2, 0
  s_cselect_b32 s53, 0, 1073741824
  v_or_b32 v6, s53, v6
  s_mov_b32 s53, 2818048
  buffer_store_dword v7, v6, s[24:27], s53 offen sc1
  s_lshr_b32 s53, s52, 6
  s_mul_i32 s53, s53, 81920
  s_bfe_u32 s54, s52, 0x20004
  s_lshl_b32 s54, s54, 10
  s_add_u32 s53, s53, s54
  s_and_b32 s54, s52, 15
  s_lshl_b32 s54, s54, 4
  s_add_u32 s53, s53, s54
  v_lshrrev_b32 v5, 2, v2
  v_lshlrev_b32 v5, 12, v5
  v_and_b32 v6, 3, v2
  v_lshl_add_u32 v5, v6, 8, v5
  v_lshl_add_u32 v5, v1, 4, v5
  s_mov_b32 s56, 0xffff0000
  s_waitcnt vmcnt(11)
  v_lshlrev_b32 v48, 16, v8
  v_and_b32 v49, s56, v8
  v_lshlrev_b32 v50, 16, v9
  v_and_b32 v51, s56, v9
  v_lshlrev_b32 v52, 16, v10
  v_and_b32 v53, s56, v10
  v_lshlrev_b32 v54, 16, v11
  v_and_b32 v55, s56, v11
  s_waitcnt vmcnt(10)
  v_lshlrev_b32 v56, 16, v12
  v_and_b32 v57, s56, v12
  v_lshlrev_b32 v58, 16, v13
  v_and_b32 v59, s56, v13
  v_lshlrev_b32 v60, 16, v14
  v_and_b32 v61, s56, v14
  v_lshlrev_b32 v62, 16, v15
  v_and_b32 v63, s56, v15
  s_waitcnt vmcnt(9)
  v_lshlrev_b32 v64, 16, v16
  v_and_b32 v65, s56, v16
  v_lshlrev_b32 v66, 16, v17
  v_and_b32 v67, s56, v17
  v_lshlrev_b32 v68, 16, v18
  v_and_b32 v69, s56, v18
  v_lshlrev_b32 v70, 16, v19
  v_and_b32 v71, s56, v19
  s_waitcnt vmcnt(8)
  v_lshlrev_b32 v72, 16, v20
  v_and_b32 v73, s56, v20
  v_lshlrev_b32 v74, 16, v21
  v_and_b32 v75, s56, v21
  v_lshlrev_b32 v76, 16, v22
  v_and_b32 v77, s56, v22
  v_lshlrev_b32 v78, 16, v23
  v_and_b32 v79, s56, v23
  s_waitcnt vmcnt(7)
  v_lshlrev_b32 v80, 16, v24
  v_and_b32 v81, s56, v24
  v_lshlrev_b32 v82, 16, v25
  v_and_b32 v83, s56, v25
  v_lshlrev_b32 v84, 16, v26
  v_and_b32 v85, s56, v26
  v_lshlrev_b32 v86, 16, v27
  v_and_b32 v87, s56, v27
  v_pk_add_f32 v[88:89], v[48:49], v[50:51]
  v_pk_add_f32 v[90:91], v[52:53], v[54:55]
  v_pk_add_f32 v[88:89], v[88:89], v[56:57]
  v_pk_add_f32 v[90:91], v[90:91], v[58:59]
  v_pk_add_f32 v[88:89], v[88:89], v[60:61]
  v_pk_add_f32 v[90:91], v[90:91], v[62:63]
  v_pk_add_f32 v[88:89], v[88:89], v[64:65]
  v_pk_add_f32 v[90:91], v[90:91], v[66:67]
  v_pk_add_f32 v[88:89], v[88:89], v[68:69]
  v_pk_add_f32 v[90:91], v[90:91], v[70:71]
  v_pk_add_f32 v[88:89], v[88:89], v[72:73]
  v_pk_add_f32 v[90:91], v[90:91], v[74:75]
  v_pk_add_f32 v[88:89], v[88:89], v[76:77]
  v_pk_add_f32 v[90:91], v[90:91], v[78:79]
  v_pk_add_f32 v[88:89], v[88:89], v[80:81]
  v_pk_add_f32 v[90:91], v[90:91], v[82:83]
  v_pk_add_f32 v[88:89], v[88:89], v[84:85]
  v_pk_add_f32 v[90:91], v[90:91], v[86:87]
  v_pk_add_f32 v[88:89], v[88:89], v[90:91]
  v_add_f32 v92, v88, v89
  s_nop 1
  v_add_f32_dpp v92, v92, v92 row_ror:8 row_mask:0xf bank_mask:0xf
  s_nop 1
  v_add_f32_dpp v92, v92, v92 row_ror:4 row_mask:0xf bank_mask:0xf
  s_nop 1
  v_add_f32_dpp v92, v92, v92 row_ror:2 row_mask:0xf bank_mask:0xf
  s_nop 1
  v_add_f32_dpp v92, v92, v92 row_ror:1 row_mask:0xf bank_mask:0xf
  v_mul_f32 v92, 0x3acccccd, v92
  v_pk_add_f32 v[94:95], v[48:49], v[92:93] op_sel_hi:[1,0] neg_lo:[0,1] neg_hi:[0,1]
  v_pk_mul_f32 v[88:89], v[94:95], v[94:95]
  v_pk_add_f32 v[96:97], v[50:51], v[92:93] op_sel_hi:[1,0] neg_lo:[0,1] neg_hi:[0,1]
  v_pk_mul_f32 v[90:91], v[96:97], v[96:97]
  v_pk_add_f32 v[94:95], v[52:53], v[92:93] op_sel_hi:[1,0] neg_lo:[0,1] neg_hi:[0,1]
  v_pk_fma_f32 v[88:89], v[94:95], v[94:95], v[88:89]
  v_pk_add_f32 v[96:97], v[54:55], v[92:93] op_sel_hi:[1,0] neg_lo:[0,1] neg_hi:[0,1]
  v_pk_fma_f32 v[90:91], v[96:97], v[96:97], v[90:91]
  v_pk_add_f32 v[94:95], v[56:57], v[92:93] op_sel_hi:[1,0] neg_lo:[0,1] neg_hi:[0,1]
  v_pk_fma_f32 v[88:89], v[94:95], v[94:95], v[88:89]
  v_pk_add_f32 v[96:97], v[58:59], v[92:93] op_sel_hi:[1,0] neg_lo:[0,1] neg_hi:[0,1]
  v_pk_fma_f32 v[90:91], v[96:97], v[96:97], v[90:91]
  v_pk_add_f32 v[94:95], v[60:61], v[92:93] op_sel_hi:[1,0] neg_lo:[0,1] neg_hi:[0,1]
  v_pk_fma_f32 v[88:89], v[94:95], v[94:95], v[88:89]
  v_pk_add_f32 v[96:97], v[62:63], v[92:93] op_sel_hi:[1,0] neg_lo:[0,1] neg_hi:[0,1]
  v_pk_fma_f32 v[90:91], v[96:97], v[96:97], v[90:91]
  v_pk_add_f32 v[94:95], v[64:65], v[92:93] op_sel_hi:[1,0] neg_lo:[0,1] neg_hi:[0,1]
  v_pk_fma_f32 v[88:89], v[94:95], v[94:95], v[88:89]
  v_pk_add_f32 v[96:97], v[66:67], v[92:93] op_sel_hi:[1,0] neg_lo:[0,1] neg_hi:[0,1]
  v_pk_fma_f32 v[90:91], v[96:97], v[96:97], v[90:91]
  v_pk_add_f32 v[94:95], v[68:69], v[92:93] op_sel_hi:[1,0] neg_lo:[0,1] neg_hi:[0,1]
  v_pk_fma_f32 v[88:89], v[94:95], v[94:95], v[88:89]
  v_pk_add_f32 v[96:97], v[70:71], v[92:93] op_sel_hi:[1,0] neg_lo:[0,1] neg_hi:[0,1]
  v_pk_fma_f32 v[90:91], v[96:97], v[96:97], v[90:91]
  v_pk_add_f32 v[94:95], v[72:73], v[92:93] op_sel_hi:[1,0] neg_lo:[0,1] neg_hi:[0,1]
  v_pk_fma_f32 v[88:89], v[94:95], v[94:95], v[88:89]
  v_pk_add_f32 v[96:97], v[74:75], v[92:93] op_sel_hi:[1,0] neg_lo:[0,1] neg_hi:[0,1]
  v_pk_fma_f32 v[90:91], v[96:97], v[96:97], v[90:91]
  v_pk_add_f32 v[94:95], v[76:77], v[92:93] op_sel_hi:[1,0] neg_lo:[0,1] neg_hi:[0,1]
  v_pk_fma_f32 v[88:89], v[94:95], v[94:95], v[88:89]
  v_pk_add_f32 v[96:97], v[78:79], v[92:93] op_sel_hi:[1,0] neg_lo:[0,1] neg_hi:[0,1]
  v_pk_fma_f32 v[90:91], v[96:97], v[96:97], v[90:91]
  v_pk_add_f32 v[94:95], v[80:81], v[92:93] op_sel_hi:[1,0] neg_lo:[0,1] neg_hi:[0,1]
  v_pk_fma_f32 v[88:89], v[94:95], v[94:95], v[88:89]
  v_pk_add_f32 v[96:97], v[82:83], v[92:93] op_sel_hi:[1,0] neg_lo:[0,1] neg_hi:[0,1]
  v_pk_fma_f32 v[90:91], v[96:97], v[96:97], v[90:91]
  v_pk_add_f32 v[94:95], v[84:85], v[92:93] op_sel_hi:[1,0] neg_lo:[0,1] neg_hi:[0,1]
  v_pk_fma_f32 v[88:89], v[94:95], v[94:95], v[88:89]
  v_pk_add_f32 v[96:97], v[86:87], v[92:93] op_sel_hi:[1,0] neg_lo:[0,1] neg_hi:[0,1]
  v_pk_fma_f32 v[90:91], v[96:97], v[96:97], v[90:91]
  v_pk_add_f32 v[88:89], v[88:89], v[90:91]
  v_add_f32 v98, v88, v89
  s_nop 1
  v_add_f32_dpp v98, v98, v98 row_ror:8 row_mask:0xf bank_mask:0xf
  v_cvt_pk_bf16_f32 v92, v92, v92
  s_nop 0
  v_add_f32_dpp v98, v98, v98 row_ror:4 row_mask:0xf bank_mask:0xf
  v_lshlrev_b32 v92, 16, v92
  s_nop 0
  v_add_f32_dpp v98, v98, v98 row_ror:2 row_mask:0xf bank_mask:0xf
  s_nop 1
  v_add_f32_dpp v98, v98, v98 row_ror:1 row_mask:0xf bank_mask:0xf
  v_mul_f32 v98, 0x3acccccd, v98
  v_cvt_pk_bf16_f32 v98, v98, v98
  v_pk_add_f32 v[48:49], v[48:49], v[92:93] op_sel_hi:[1,0] neg_lo:[0,1] neg_hi:[0,1]
  v_lshlrev_b32 v98, 16, v98
  v_pk_add_f32 v[50:51], v[50:51], v[92:93] op_sel_hi:[1,0] neg_lo:[0,1] neg_hi:[0,1]
  v_add_f32 v98, 0x3727c5ac, v98
  v_pk_add_f32 v[52:53], v[52:53], v[92:93] op_sel_hi:[1,0] neg_lo:[0,1] neg_hi:[0,1]
  v_cvt_pk_bf16_f32 v98, v98, v98
  v_pk_add_f32 v[54:55], v[54:55], v[92:93] op_sel_hi:[1,0] neg_lo:[0,1] neg_hi:[0,1]
  v_lshlrev_b32 v98, 16, v98
  v_pk_add_f32 v[56:57], v[56:57], v[92:93] op_sel_hi:[1,0] neg_lo:[0,1] neg_hi:[0,1]
  v_sqrt_f32 v98, v98
  v_pk_add_f32 v[58:59], v[58:59], v[92:93] op_sel_hi:[1,0] neg_lo:[0,1] neg_hi:[0,1]
  v_cvt_pk_bf16_f32 v98, v98, v98
  v_pk_add_f32 v[60:61], v[60:61], v[92:93] op_sel_hi:[1,0] neg_lo:[0,1] neg_hi:[0,1]
  v_lshlrev_b32 v98, 16, v98
  v_pk_add_f32 v[62:63], v[62:63], v[92:93] op_sel_hi:[1,0] neg_lo:[0,1] neg_hi:[0,1]
  v_rcp_f32 v100, v98
  v_pk_add_f32 v[64:65], v[64:65], v[92:93] op_sel_hi:[1,0] neg_lo:[0,1] neg_hi:[0,1]
  v_pk_add_f32 v[66:67], v[66:67], v[92:93] op_sel_hi:[1,0] neg_lo:[0,1] neg_hi:[0,1]
  v_pk_add_f32 v[68:69], v[68:69], v[92:93] op_sel_hi:[1,0] neg_lo:[0,1] neg_hi:[0,1]
  v_pk_add_f32 v[70:71], v[70:71], v[92:93] op_sel_hi:[1,0] neg_lo:[0,1] neg_hi:[0,1]
  v_pk_add_f32 v[72:73], v[72:73], v[92:93] op_sel_hi:[1,0] neg_lo:[0,1] neg_hi:[0,1]
  v_pk_add_f32 v[74:75], v[74:75], v[92:93] op_sel_hi:[1,0] neg_lo:[0,1] neg_hi:[0,1]
  v_pk_add_f32 v[76:77], v[76:77], v[92:93] op_sel_hi:[1,0] neg_lo:[0,1] neg_hi:[0,1]
  v_pk_add_f32 v[78:79], v[78:79], v[92:93] op_sel_hi:[1,0] neg_lo:[0,1] neg_hi:[0,1]
  v_pk_add_f32 v[80:81], v[80:81], v[92:93] op_sel_hi:[1,0] neg_lo:[0,1] neg_hi:[0,1]
  v_pk_add_f32 v[82:83], v[82:83], v[92:93] op_sel_hi:[1,0] neg_lo:[0,1] neg_hi:[0,1]
  v_pk_add_f32 v[84:85], v[84:85], v[92:93] op_sel_hi:[1,0] neg_lo:[0,1] neg_hi:[0,1]
  v_pk_add_f32 v[86:87], v[86:87], v[92:93] op_sel_hi:[1,0] neg_lo:[0,1] neg_hi:[0,1]
  v_mov_b32 v104, 0
  v_mov_b32 v105, 0
  v_cvt_pk_bf16_f32 v8, v48, v49
  v_cvt_pk_bf16_f32 v9, v50, v51
  v_cvt_pk_bf16_f32 v10, v52, v53
  v_cvt_pk_bf16_f32 v11, v54, v55
  v_cvt_pk_bf16_f32 v12, v56, v57
  v_cvt_pk_bf16_f32 v13, v58, v59
  v_cvt_pk_bf16_f32 v14, v60, v61
  v_cvt_pk_bf16_f32 v15, v62, v63
  v_cvt_pk_bf16_f32 v16, v64, v65
  v_cvt_pk_bf16_f32 v17, v66, v67
  v_cvt_pk_bf16_f32 v18, v68, v69
  v_cvt_pk_bf16_f32 v19, v70, v71
  v_cvt_pk_bf16_f32 v20, v72, v73
  v_cvt_pk_bf16_f32 v21, v74, v75
  v_cvt_pk_bf16_f32 v22, v76, v77
  v_cvt_pk_bf16_f32 v23, v78, v79
  v_cvt_pk_bf16_f32 v24, v80, v81
  v_cvt_pk_bf16_f32 v25, v82, v83
  v_cvt_pk_bf16_f32 v26, v84, v85
  v_cvt_pk_bf16_f32 v27, v86, v87
  v_lshlrev_b32 v48, 16, v8
  v_and_b32 v49, s56, v8
  v_lshlrev_b32 v50, 16, v9
  v_and_b32 v51, s56, v9
  v_lshlrev_b32 v52, 16, v10
  v_and_b32 v53, s56, v10
  v_lshlrev_b32 v54, 16, v11
  v_and_b32 v55, s56, v11
  v_lshlrev_b32 v56, 16, v12
  v_and_b32 v57, s56, v12
  v_lshlrev_b32 v58, 16, v13
  v_and_b32 v59, s56, v13
  v_lshlrev_b32 v60, 16, v14
  v_and_b32 v61, s56, v14
  v_lshlrev_b32 v62, 16, v15
  v_and_b32 v63, s56, v15
  v_lshlrev_b32 v64, 16, v16
  v_and_b32 v65, s56, v16
  v_lshlrev_b32 v66, 16, v17
  v_and_b32 v67, s56, v17
  v_lshlrev_b32 v68, 16, v18
  v_and_b32 v69, s56, v18
  v_lshlrev_b32 v70, 16, v19
  v_and_b32 v71, s56, v19
  v_lshlrev_b32 v72, 16, v20
  v_and_b32 v73, s56, v20
  v_lshlrev_b32 v74, 16, v21
  v_and_b32 v75, s56, v21
  v_lshlrev_b32 v76, 16, v22
  v_and_b32 v77, s56, v22
  v_lshlrev_b32 v78, 16, v23
  v_and_b32 v79, s56, v23
  v_lshlrev_b32 v80, 16, v24
  v_and_b32 v81, s56, v24
  v_lshlrev_b32 v82, 16, v25
  v_and_b32 v83, s56, v25
  v_lshlrev_b32 v84, 16, v26
  v_and_b32 v85, s56, v26
  v_lshlrev_b32 v86, 16, v27
  v_and_b32 v87, s56, v27
  v_pk_mul_f32 v[48:49], v[48:49], v[100:101] op_sel_hi:[1,0]
  v_pk_mul_f32 v[50:51], v[50:51], v[100:101] op_sel_hi:[1,0]
  v_pk_mul_f32 v[52:53], v[52:53], v[100:101] op_sel_hi:[1,0]
  v_pk_mul_f32 v[54:55], v[54:55], v[100:101] op_sel_hi:[1,0]
  v_cvt_pk_bf16_f32 v8, v48, v49
  v_cvt_pk_bf16_f32 v9, v50, v51
  v_cvt_pk_bf16_f32 v10, v52, v53
  v_cvt_pk_bf16_f32 v11, v54, v55
  buffer_store_dwordx4 v[8:11], v5, s[24:27], s53 offen sc1
  s_add_u32 s53, s53, 16384
  v_pk_mul_f32 v[56:57], v[56:57], v[100:101] op_sel_hi:[1,0]
  v_pk_mul_f32 v[58:59], v[58:59], v[100:101] op_sel_hi:[1,0]
  v_pk_mul_f32 v[60:61], v[60:61], v[100:101] op_sel_hi:[1,0]
  v_pk_mul_f32 v[62:63], v[62:63], v[100:101] op_sel_hi:[1,0]
  v_cvt_pk_bf16_f32 v12, v56, v57
  v_cvt_pk_bf16_f32 v13, v58, v59
  v_cvt_pk_bf16_f32 v14, v60, v61
  v_cvt_pk_bf16_f32 v15, v62, v63
  buffer_store_dwordx4 v[12:15], v5, s[24:27], s53 offen sc1
  s_add_u32 s53, s53, 16384
  v_pk_mul_f32 v[64:65], v[64:65], v[100:101] op_sel_hi:[1,0]
  v_pk_mul_f32 v[66:67], v[66:67], v[100:101] op_sel_hi:[1,0]
  v_pk_mul_f32 v[68:69], v[68:69], v[100:101] op_sel_hi:[1,0]
  v_pk_mul_f32 v[70:71], v[70:71], v[100:101] op_sel_hi:[1,0]
  v_cvt_pk_bf16_f32 v16, v64, v65
  v_cvt_pk_bf16_f32 v17, v66, v67
  v_cvt_pk_bf16_f32 v18, v68, v69
  v_cvt_pk_bf16_f32 v19, v70, v71
  buffer_store_dwordx4 v[16:19], v5, s[24:27], s53 offen sc1
  s_add_u32 s53, s53, 16384
  v_pk_mul_f32 v[72:73], v[72:73], v[100:101] op_sel_hi:[1,0]
  v_pk_mul_f32 v[74:75], v[74:75], v[100:101] op_sel_hi:[1,0]
  v_pk_mul_f32 v[76:77], v[76:77], v[100:101] op_sel_hi:[1,0]
  v_pk_mul_f32 v[78:79], v[78:79], v[100:101] op_sel_hi:[1,0]
  v_cvt_pk_bf16_f32 v20, v72, v73
  v_cvt_pk_bf16_f32 v21, v74, v75
  v_cvt_pk_bf16_f32 v22, v76, v77
  v_cvt_pk_bf16_f32 v23, v78, v79
  buffer_store_dwordx4 v[20:23], v5, s[24:27], s53 offen sc1
  s_add_u32 s53, s53, 16384
  v_pk_mul_f32 v[80:81], v[80:81], v[100:101] op_sel_hi:[1,0]
  v_pk_mul_f32 v[82:83], v[82:83], v[100:101] op_sel_hi:[1,0]
  v_pk_mul_f32 v[84:85], v[84:85], v[100:101] op_sel_hi:[1,0]
  v_pk_mul_f32 v[86:87], v[86:87], v[100:101] op_sel_hi:[1,0]
  v_cvt_pk_bf16_f32 v24, v80, v81
  v_cvt_pk_bf16_f32 v25, v82, v83
  v_cvt_pk_bf16_f32 v26, v84, v85
  v_cvt_pk_bf16_f32 v27, v86, v87
  buffer_store_dwordx4 v[24:27], v5, s[24:27], s53 offen sc1
  s_add_u32 s53, s53, 16384
  s_waitcnt vmcnt(11)
  v_dot2_f32_bf16 v104, v8, v28, v104
  v_dot2_f32_bf16 v105, v9, v29, v105
  v_dot2_f32_bf16 v104, v10, v30, v104
  v_dot2_f32_bf16 v105, v11, v31, v105
  s_waitcnt vmcnt(10)
  v_dot2_f32_bf16 v104, v12, v32, v104
  v_dot2_f32_bf16 v105, v13, v33, v105
  v_dot2_f32_bf16 v104, v14, v34, v104
  v_dot2_f32_bf16 v105, v15, v35, v105
  s_waitcnt vmcnt(9)
  v_dot2_f32_bf16 v104, v16, v36, v104
  v_dot2_f32_bf16 v105, v17, v37, v105
  v_dot2_f32_bf16 v104, v18, v38, v104
  v_dot2_f32_bf16 v105, v19, v39, v105
  s_waitcnt vmcnt(8)
  v_dot2_f32_bf16 v104, v20, v40, v104
  v_dot2_f32_bf16 v105, v21, v41, v105
  v_dot2_f32_bf16 v104, v22, v42, v104
  v_dot2_f32_bf16 v105, v23, v43, v105
  s_waitcnt vmcnt(7)
  v_dot2_f32_bf16 v104, v24, v44, v104
  v_dot2_f32_bf16 v105, v25, v45, v105
  v_dot2_f32_bf16 v104, v26, v46, v104
  v_dot2_f32_bf16 v105, v27, v47, v105
  s_nop 2
  v_add_f32 v104, v104, v105
  s_nop 1
  v_add_f32_dpp v104, v104, v104 row_ror:8 row_mask:0xf bank_mask:0xf
  s_nop 1
  v_add_f32_dpp v104, v104, v104 row_ror:4 row_mask:0xf bank_mask:0xf
  s_nop 1
  v_add_f32_dpp v104, v104, v104 row_ror:2 row_mask:0xf bank_mask:0xf
  s_nop 1
  v_add_f32_dpp v104, v104, v104 row_ror:1 row_mask:0xf bank_mask:0xf
  v_cvt_pk_bf16_f32 v104, v104, v104
  v_lshlrev_b32 v104, 16, v104
  v_ashrrev_i32 v105, 31, v104
  v_or_b32 v105, 0x80000000, v105
  v_xor_b32 v104, v104, v105
  v_and_b32 v104, s56, v104
  v_add_u32 v6, s52, v1
  v_sub_u32 v7, 0xffff, v6
  v_or_b32 v104, v104, v7
  v_lshlrev_b32 v6, 2, v6
  v_lshl_add_u32 v6, v2, 26, v6
  s_mov_b32 s53, 2621440
  buffer_store_dword v104, v6, s[24:27], s53 offen sc1
  s_waitcnt vmcnt(0)
  s_branch front_join
front_fetch:
  v_subrev_u32 v16, 0x40000, v238
  v_subrev_u32 v17, 0x40000, v239
  v_subrev_u32 v18, 0x40000, v240
  v_subrev_u32 v19, 0x40000, v241
front_join:
  s_waitcnt lgkmcnt(0)
  s_barrier
  s_mul_i32 s55, s59, 0x9e3779b1
  s_add_u32 s55, s55, 0x7f4a7c15
  s_bfe_u32 s58, s2, 0x30003
  s_lshl_b32 s58, s58, 8
  s_add_u32 s58, s58, 2826240
  s_lshl_b32 s53, s36, 2
  s_lshl_b32 s54, s3, 26
  s_add_u32 s53, s53, s54
  v_min_u32 v1, 1, v0
  v_lshlrev_b32 v1, 28, v1
  v_add_u32 v1, s53, v1
  v_mov_b32 v2, s55
  buffer_store_dword v2, v1, s[24:27], s58 offen sc1
  s_cmp_lt_u32 s3, 2
  s_cbranch_scc1 front_addr
  s_mov_b32 s31, 0
  s_add_u32 m0, s28, 90112
  s_nop 0
  buffer_load_dwordx4 v16, s[20:23], s31 offen offset:0 lds
  buffer_load_dwordx4 v17, s[20:23], s31 offen offset:1024 lds
  buffer_load_dwordx4 v18, s[20:23], s31 offen offset:2048 lds
  buffer_load_dwordx4 v19, s[20:23], s31 offen offset:3072 lds
  s_add_u32 m0, s28, 98304
  s_nop 0
  buffer_load_dwordx4 v238, s[20:23], s31 offen offset:0 lds
  buffer_load_dwordx4 v239, s[20:23], s31 offen offset:1024 lds
  buffer_load_dwordx4 v240, s[20:23], s31 offen offset:2048 lds
  buffer_load_dwordx4 v241, s[20:23], s31 offen offset:3072 lds
  s_mov_b32 s31, 524288
  s_add_u32 m0, s28, 106496
  s_nop 0
  buffer_load_dwordx4 v16, s[20:23], s31 offen offset:0 lds
  buffer_load_dwordx4 v17, s[20:23], s31 offen offset:1024 lds
  buffer_load_dwordx4 v18, s[20:23], s31 offen offset:2048 lds
  buffer_load_dwordx4 v19, s[20:23], s31 offen offset:3072 lds
  s_add_u32 m0, s28, 114688
  s_nop 0
  buffer_load_dwordx4 v238, s[20:23], s31 offen offset:0 lds
  buffer_load_dwordx4 v239, s[20:23], s31 offen offset:1024 lds
  buffer_load_dwordx4 v240, s[20:23], s31 offen offset:2048 lds
  buffer_load_dwordx4 v241, s[20:23], s31 offen offset:3072 lds
  s_mov_b32 s31, 1048576
  s_add_u32 m0, s28, 24576
  s_nop 0
  buffer_load_dwordx4 v16, s[20:23], s31 offen offset:0 lds
  buffer_load_dwordx4 v17, s[20:23], s31 offen offset:1024 lds
  buffer_load_dwordx4 v18, s[20:23], s31 offen offset:2048 lds
  buffer_load_dwordx4 v19, s[20:23], s31 offen offset:3072 lds
  s_add_u32 m0, s28, 32768
  s_nop 0
  buffer_load_dwordx4 v238, s[20:23], s31 offen offset:0 lds
  buffer_load_dwordx4 v239, s[20:23], s31 offen offset:1024 lds
  buffer_load_dwordx4 v240, s[20:23], s31 offen offset:2048 lds
  buffer_load_dwordx4 v241, s[20:23], s31 offen offset:3072 lds
  s_mov_b32 s31, 1572864
  s_add_u32 m0, s28, 40960
  s_nop 0
  buffer_load_dwordx4 v16, s[20:23], s31 offen offset:0 lds
  buffer_load_dwordx4 v17, s[20:23], s31 offen offset:1024 lds
  buffer_load_dwordx4 v18, s[20:23], s31 offen offset:2048 lds
  buffer_load_dwordx4 v19, s[20:23], s31 offen offset:3072 lds
  s_add_u32 m0, s28, 49152
  s_nop 0
  buffer_load_dwordx4 v238, s[20:23], s31 offen offset:0 lds
  buffer_load_dwordx4 v239, s[20:23], s31 offen offset:1024 lds
  buffer_load_dwordx4 v240, s[20:23], s31 offen offset:2048 lds
  buffer_load_dwordx4 v241, s[20:23], s31 offen offset:3072 lds
front_addr:
  s_mov_b32 s31, 2097152
  v_lshlrev_b32 v242, 4, v245
  v_add_u32 v243, 0x1000, v242
  s_mul_i32 s30, s37, 81920
  s_lshl_b32 s38, s36, 19
  s_add_u32 s12, s4, s38
  s_addc_u32 s13, s5, 0
  s_mov_b32 s14, 524288
  s_mov_b32 s15, 0x20000
  s_add_u32 s16, s6, s38
  s_addc_u32 s17, s7, 0
  s_mov_b32 s18, 524288
  s_mov_b32 s19, 0x20000
  v_lshlrev_b32 v249, 8, v248
  v_add_u32 v249, s28, v249
  v_add_u32 v250, 0, v248
  v_xor_b32 v250, v250, v247
  v_lshl_add_u32 v232, v250, 4, v249
  v_add_u32 v250, 4, v248
  v_xor_b32 v250, v250, v247
  v_lshl_add_u32 v233, v250, 4, v249
  v_add_u32 v250, 8, v248
  v_xor_b32 v250, v250, v247
  v_lshl_add_u32 v234, v250, 4, v249
  v_add_u32 v250, 12, v248
  v_xor_b32 v250, v250, v247
  v_lshl_add_u32 v235, v250, 4, v249
  v_add_u32 v250, 0, v248
  v_lshlrev_b32 v250, 1, v250
  v_xor_b32 v250, v250, v247
  v_lshl_add_u32 v236, v250, 4, v249
  v_add_u32 v250, 4, v248
  v_lshlrev_b32 v250, 1, v250
  v_xor_b32 v250, v250, v247
  v_lshl_add_u32 v237, v250, 4, v249
  v_lshrrev_b32 v249, 1, v248
  v_and_b32 v250, 1, v248
  v_lshl_or_b32 v249, v250, 1, v249
  v_xor_b32 v249, v249, v247
  v_lshlrev_b32 v249, 4, v249
  v_lshl_add_u32 v212, v247, 8, v249
  v_xor_b32 v213, 64, v212
  v_xor_b32 v214, 128, v212
  v_xor_b32 v215, 192, v212
  v_bfe_u32 v246, v245, 2, 2
  v_and_b32 v247, 3, v245
  v_lshlrev_b32 v247, 3, v247
  v_add_u32 v247, 65536, v247
  v_lshl_add_u32 v249, v248, 2, v246
  v_and_b32 v250, 7, v249
  v_lshl_add_u32 v250, v250, 5, v247
  v_lshl_add_u32 v216, v249, 8, v250
  v_lshl_add_u32 v249, v248, 3, v246
  v_and_b32 v250, 1, v248
  v_lshl_add_u32 v250, v250, 2, v246
  v_lshl_add_u32 v250, v250, 5, v247
  v_lshl_add_u32 v224, v249, 8, v250
  v_xor_b32 v217, 32, v216
  v_xor_b32 v225, 32, v224
  v_xor_b32 v218, 64, v216
  v_xor_b32 v226, 64, v224
  v_xor_b32 v219, 96, v216
  v_xor_b32 v227, 96, v224
  v_xor_b32 v220, 128, v216
  v_xor_b32 v228, 128, v224
  v_xor_b32 v221, 160, v216
  v_xor_b32 v229, 160, v224
  v_xor_b32 v222, 192, v216
  v_xor_b32 v230, 192, v224
  v_xor_b32 v223, 224, v216
  v_xor_b32 v231, 224, v224
  v_subrev_u32 v144, 65536, v224
  v_subrev_u32 v145, 65536, v225
  v_subrev_u32 v146, 65536, v226
  v_subrev_u32 v147, 65536, v227
  v_subrev_u32 v148, 65536, v228
  v_subrev_u32 v149, 65536, v229
  v_subrev_u32 v150, 65536, v230
  v_subrev_u32 v151, 65536, v231
  s_lshr_b32 s38, s2, 3
  s_min_u32 s38, s38, 26
  s_and_b32 s39, s2, 7
  s_mul_i32 s39, s39, 27
  s_add_u32 s33, s38, s39
  s_mul_i32 s50, s3, 6144
  s_add_u32 s50, s50, 133120
  v_mov_b32 v244, v242
  s_lshl_b32 s40, s37, 19
  s_lshl_b32 s38, s36, 14
  s_add_u32 s40, s40, s38
  s_add_u32 s40, s40, 8388608
  s_add_u32 s41, s40, 4096
  s_add_u32 s42, s40, 8192
  s_add_u32 s43, s40, 12288
  s_mov_b32 s34, 0x3e0293ee
  s_mov_b32 s29, 0
  v_and_b32 v249, 15, v245
  v_cmp_eq_u32 vcc, 0, v249
  v_mov_b32 v249, 0x3f803f80
  s_nop 0
  v_cndmask_b32 v249, 0, v249, vcc
  v_accvgpr_write_b32 a208, v249
  v_accvgpr_write_b32 a209, v249
  v_accvgpr_write_b32 a210, v249
  v_accvgpr_write_b32 a211, v249
  s_cmp_lg_u32 s3, 0
  s_cbranch_scc1 front_go
  v_and_b32 v2, 31, v0
  v_lshlrev_b32 v2, 2, v2
  s_mov_b32 s54, 32768
front_poll:
  buffer_load_dword v1, v2, s[24:27], s58 offen sc1
  s_waitcnt vmcnt(0)
  v_cmp_ne_u32 vcc, s55, v1
  s_nop 0
  s_cbranch_vccz front_go
  s_sleep 2
  s_sub_u32 s54, s54, 1
  s_cmp_lg_u32 s54, 0
  s_cbranch_scc1 front_poll
front_go:
  s_waitcnt vmcnt(24)
  s_barrier
  buffer_load_dwordx4 a[0:3], v242, s[24:27], s30 offen offset:0 sc1
  buffer_load_dwordx4 a[4:7], v242, s[24:27], s30 offen offset:1024 sc1
  buffer_load_dwordx4 a[8:11], v242, s[24:27], s30 offen offset:2048 sc1
  buffer_load_dwordx4 a[12:15], v242, s[24:27], s30 offen offset:3072 sc1
  buffer_load_dwordx4 a[16:19], v243, s[24:27], s30 offen offset:0 sc1
  buffer_load_dwordx4 a[20:23], v243, s[24:27], s30 offen offset:1024 sc1
  buffer_load_dwordx4 a[24:27], v243, s[24:27], s30 offen offset:2048 sc1
  buffer_load_dwordx4 a[28:31], v243, s[24:27], s30 offen offset:3072 sc1
  s_add_u32 s30, s30, 8192
  buffer_load_dwordx4 a[32:35], v242, s[24:27], s30 offen offset:0 sc1
  buffer_load_dwordx4 a[36:39], v242, s[24:27], s30 offen offset:1024 sc1
  buffer_load_dwordx4 a[40:43], v242, s[24:27], s30 offen offset:2048 sc1
  buffer_load_dwordx4 a[44:47], v242, s[24:27], s30 offen offset:3072 sc1
  buffer_load_dwordx4 a[48:51], v243, s[24:27], s30 offen offset:0 sc1
  buffer_load_dwordx4 a[52:55], v243, s[24:27], s30 offen offset:1024 sc1
  buffer_load_dwordx4 a[56:59], v243, s[24:27], s30 offen offset:2048 sc1
  buffer_load_dwordx4 a[60:63], v243, s[24:27], s30 offen offset:3072 sc1
  s_add_u32 s30, s30, 8192
  v_lshrrev_b32 v140, 7, v242
  v_lshlrev_b32 v140, 8, v140
  v_and_b32 v136, 0x70, v242
  v_add_u32 v140, v140, v136
  s_mov_b32 s58, 2826240
  buffer_load_dwordx4 v[136:139], v140, s[24:27], s58 offen sc1
  ds_read_b64_tr_b16 a[160:161], v224 offset:32768
  ds_read_b64_tr_b16 a[162:163], v224 offset:33792
  ds_read_b64_tr_b16 a[164:165], v224 offset:40960
  ds_read_b64_tr_b16 a[166:167], v224 offset:41984
  ds_read_b64_tr_b16 a[168:169], v225 offset:32768
  ds_read_b64_tr_b16 a[170:171], v225 offset:33792
  ds_read_b64_tr_b16 a[172:173], v225 offset:40960
  ds_read_b64_tr_b16 a[174:175], v225 offset:41984
  s_waitcnt vmcnt(9) lgkmcnt(4)
  v_mfma_f32_16x16x32_bf16 v[0:3], a[160:163], a[0:3], 0
  ds_read_b64_tr_b16 a[176:177], v226 offset:32768
  v_mfma_f32_16x16x32_bf16 v[0:3], a[164:167], a[16:19], v[0:3]
  buffer_load_dwordx4 a[64:67], v242, s[24:27], s30 offen offset:0 sc1
  v_mfma_f32_16x16x32_bf16 v[4:7], a[164:167], a[20:23], 0
  ds_read_b64_tr_b16 a[178:179], v226 offset:33792
  v_mfma_f32_16x16x32_bf16 v[4:7], a[160:163], a[4:7], v[4:7]
  buffer_load_dwordx4 a[68:71], v242, s[24:27], s30 offen offset:1024 sc1
  v_mfma_f32_16x16x32_bf16 v[8:11], a[160:163], a[8:11], 0
  ds_read_b64_tr_b16 a[180:181], v226 offset:40960
  v_mfma_f32_16x16x32_bf16 v[8:11], a[164:167], a[24:27], v[8:11]
  v_mfma_f32_16x16x32_bf16 v[12:15], a[164:167], a[28:31], 0
  ds_read_b64_tr_b16 a[182:183], v226 offset:41984
  v_mfma_f32_16x16x32_bf16 v[12:15], a[160:163], a[12:15], v[12:15]
  s_waitcnt lgkmcnt(4)
  buffer_load_dwordx4 a[72:75], v242, s[24:27], s30 offen offset:2048 sc1
  v_mfma_f32_16x16x32_bf16 v[16:19], a[168:171], a[0:3], 0
  ds_read_b64_tr_b16 a[184:185], v227 offset:32768
  v_mfma_f32_16x16x32_bf16 v[16:19], a[172:175], a[16:19], v[16:19]
  v_mfma_f32_16x16x32_bf16 v[20:23], a[172:175], a[20:23], 0
  ds_read_b64_tr_b16 a[186:187], v227 offset:33792
  v_mfma_f32_16x16x32_bf16 v[20:23], a[168:171], a[4:7], v[20:23]
  buffer_load_dwordx4 a[76:79], v242, s[24:27], s30 offen offset:3072 sc1
  v_mfma_f32_16x16x32_bf16 v[24:27], a[168:171], a[8:11], 0
  ds_read_b64_tr_b16 a[188:189], v227 offset:40960
  v_mfma_f32_16x16x32_bf16 v[24:27], a[172:175], a[24:27], v[24:27]
  buffer_load_dwordx4 a[80:83], v243, s[24:27], s30 offen offset:0 sc1
  v_mfma_f32_16x16x32_bf16 v[28:31], a[172:175], a[28:31], 0
  ds_read_b64_tr_b16 a[190:191], v227 offset:41984
  v_mfma_f32_16x16x32_bf16 v[28:31], a[168:171], a[12:15], v[28:31]
  s_waitcnt lgkmcnt(4)
  v_mfma_f32_16x16x32_bf16 v[32:35], a[176:179], a[0:3], 0
  ds_read_b64_tr_b16 a[160:161], v228 offset:32768
  v_mfma_f32_16x16x32_bf16 v[32:35], a[180:183], a[16:19], v[32:35]
  buffer_load_dwordx4 a[84:87], v243, s[24:27], s30 offen offset:1024 sc1
  v_mfma_f32_16x16x32_bf16 v[36:39], a[180:183], a[20:23], 0
  ds_read_b64_tr_b16 a[162:163], v228 offset:33792
  v_mfma_f32_16x16x32_bf16 v[36:39], a[176:179], a[4:7], v[36:39]
  v_mfma_f32_16x16x32_bf16 v[40:43], a[176:179], a[8:11], 0
  ds_read_b64_tr_b16 a[164:165], v228 offset:40960
  v_mfma_f32_16x16x32_bf16 v[40:43], a[180:183], a[24:27], v[40:43]
  buffer_load_dwordx4 a[88:91], v243, s[24:27], s30 offen offset:2048 sc1
  v_mfma_f32_16x16x32_bf16 v[44:47], a[180:183], a[28:31], 0
  ds_read_b64_tr_b16 a[166:167], v228 offset:41984
  v_mfma_f32_16x16x32_bf16 v[44:47], a[176:179], a[12:15], v[44:47]
  s_waitcnt lgkmcnt(4)
  buffer_load_dwordx4 a[92:95], v243, s[24:27], s30 offen offset:3072 sc1
  v_mfma_f32_16x16x32_bf16 v[48:51], a[184:187], a[0:3], 0
  ds_read_b64_tr_b16 a[168:169], v229 offset:32768
  v_mfma_f32_16x16x32_bf16 v[48:51], a[188:191], a[16:19], v[48:51]
  v_mfma_f32_16x16x32_bf16 v[52:55], a[188:191], a[20:23], 0
  ds_read_b64_tr_b16 a[170:171], v229 offset:33792
  v_mfma_f32_16x16x32_bf16 v[52:55], a[184:187], a[4:7], v[52:55]
  s_add_u32 s30, s30, 8192
  v_mfma_f32_16x16x32_bf16 v[56:59], a[184:187], a[8:11], 0
  ds_read_b64_tr_b16 a[172:173], v229 offset:40960
  v_mfma_f32_16x16x32_bf16 v[56:59], a[188:191], a[24:27], v[56:59]
  v_mfma_f32_16x16x32_bf16 v[60:63], a[188:191], a[28:31], 0
  ds_read_b64_tr_b16 a[174:175], v229 offset:41984
  v_mfma_f32_16x16x32_bf16 v[60:63], a[184:187], a[12:15], v[60:63]
  s_waitcnt lgkmcnt(4)
  buffer_load_dwordx4 a[96:99], v242, s[24:27], s30 offen offset:0 sc1
  v_mfma_f32_16x16x32_bf16 v[64:67], a[160:163], a[0:3], 0
  ds_read_b64_tr_b16 a[176:177], v230 offset:32768
  v_mfma_f32_16x16x32_bf16 v[64:67], a[164:167], a[16:19], v[64:67]
  buffer_load_dwordx4 a[100:103], v242, s[24:27], s30 offen offset:1024 sc1
  v_mfma_f32_16x16x32_bf16 v[68:71], a[164:167], a[20:23], 0
  ds_read_b64_tr_b16 a[178:179], v230 offset:33792
  v_mfma_f32_16x16x32_bf16 v[68:71], a[160:163], a[4:7], v[68:71]
  v_mfma_f32_16x16x32_bf16 v[72:75], a[160:163], a[8:11], 0
  ds_read_b64_tr_b16 a[180:181], v230 offset:40960
  v_mfma_f32_16x16x32_bf16 v[72:75], a[164:167], a[24:27], v[72:75]
  buffer_load_dwordx4 a[104:107], v242, s[24:27], s30 offen offset:2048 sc1
  v_mfma_f32_16x16x32_bf16 v[76:79], a[164:167], a[28:31], 0
  ds_read_b64_tr_b16 a[182:183], v230 offset:41984
  v_mfma_f32_16x16x32_bf16 v[76:79], a[160:163], a[12:15], v[76:79]
  s_waitcnt lgkmcnt(4)
  v_mfma_f32_16x16x32_bf16 v[80:83], a[168:171], a[0:3], 0
  ds_read_b64_tr_b16 a[184:185], v231 offset:32768
  v_mfma_f32_16x16x32_bf16 v[80:83], a[172:175], a[16:19], v[80:83]
  buffer_load_dwordx4 a[108:111], v242, s[24:27], s30 offen offset:3072 sc1
  v_mfma_f32_16x16x32_bf16 v[84:87], a[172:175], a[20:23], 0
  ds_read_b64_tr_b16 a[186:187], v231 offset:33792
  v_mfma_f32_16x16x32_bf16 v[84:87], a[168:171], a[4:7], v[84:87]
  buffer_load_dwordx4 a[112:115], v243, s[24:27], s30 offen offset:0 sc1
  v_mfma_f32_16x16x32_bf16 v[88:91], a[168:171], a[8:11], 0
  ds_read_b64_tr_b16 a[188:189], v231 offset:40960
  v_mfma_f32_16x16x32_bf16 v[88:91], a[172:175], a[24:27], v[88:91]
  s_barrier
  v_mfma_f32_16x16x32_bf16 v[92:95], a[172:175], a[28:31], 0
  ds_read_b64_tr_b16 a[190:191], v231 offset:41984
  v_mfma_f32_16x16x32_bf16 v[92:95], a[168:171], a[12:15], v[92:95]
  s_waitcnt lgkmcnt(4)
  buffer_load_dwordx4 a[116:119], v243, s[24:27], s30 offen offset:1024 sc1
  v_mfma_f32_16x16x32_bf16 v[96:99], a[176:179], a[0:3], 0
  ds_read_b64_tr_b16 a[160:161], v224 offset:49152
  v_mfma_f32_16x16x32_bf16 v[96:99], a[180:183], a[16:19], v[96:99]
  v_mfma_f32_16x16x32_bf16 v[100:103], a[180:183], a[20:23], 0
  ds_read_b64_tr_b16 a[162:163], v224 offset:50176
  v_mfma_f32_16x16x32_bf16 v[100:103], a[176:179], a[4:7], v[100:103]
  buffer_load_dwordx4 a[120:123], v243, s[24:27], s30 offen offset:2048 sc1
  v_mfma_f32_16x16x32_bf16 v[104:107], a[176:179], a[8:11], 0
  ds_read_b64_tr_b16 a[164:165], v224 offset:57344
  v_mfma_f32_16x16x32_bf16 v[104:107], a[180:183], a[24:27], v[104:107]
  buffer_load_dwordx4 a[124:127], v243, s[24:27], s30 offen offset:3072 sc1
  v_mfma_f32_16x16x32_bf16 v[108:111], a[180:183], a[28:31], 0
  ds_read_b64_tr_b16 a[166:167], v224 offset:58368
  v_mfma_f32_16x16x32_bf16 v[108:111], a[176:179], a[12:15], v[108:111]
  s_waitcnt lgkmcnt(4)
  v_mfma_f32_16x16x32_bf16 v[112:115], a[184:187], a[0:3], 0
  ds_read_b64_tr_b16 a[168:169], v225 offset:49152
  v_mfma_f32_16x16x32_bf16 v[112:115], a[188:191], a[16:19], v[112:115]
  s_add_u32 s30, s30, 8192
  v_mfma_f32_16x16x32_bf16 v[116:119], a[188:191], a[20:23], 0
  ds_read_b64_tr_b16 a[170:171], v225 offset:50176
  v_mfma_f32_16x16x32_bf16 v[116:119], a[184:187], a[4:7], v[116:119]
  v_mfma_f32_16x16x32_bf16 v[120:123], a[184:187], a[8:11], 0
  ds_read_b64_tr_b16 a[172:173], v225 offset:57344
  v_mfma_f32_16x16x32_bf16 v[120:123], a[188:191], a[24:27], v[120:123]
  v_mfma_f32_16x16x32_bf16 v[124:127], a[188:191], a[28:31], 0
  ds_read_b64_tr_b16 a[174:175], v225 offset:58368
  v_mfma_f32_16x16x32_bf16 v[124:127], a[184:187], a[12:15], v[124:127]
  s_waitcnt vmcnt(17) lgkmcnt(4)
  v_mfma_f32_16x16x32_bf16 v[0:3], a[160:163], a[32:35], v[0:3]
  ds_read_b64_tr_b16 a[176:177], v226 offset:49152
  v_mfma_f32_16x16x32_bf16 v[0:3], a[164:167], a[48:51], v[0:3]
  buffer_load_dwordx4 a[0:3], v242, s[24:27], s30 offen offset:0 sc1
  v_mfma_f32_16x16x32_bf16 v[4:7], a[164:167], a[52:55], v[4:7]
  ds_read_b64_tr_b16 a[178:179], v226 offset:50176
  v_mfma_f32_16x16x32_bf16 v[4:7], a[160:163], a[36:39], v[4:7]
  v_mfma_f32_16x16x32_bf16 v[8:11], a[160:163], a[40:43], v[8:11]
  ds_read_b64_tr_b16 a[180:181], v226 offset:57344
  s_add_u32 m0, s28, 16384
  v_mfma_f32_16x16x32_bf16 v[8:11], a[164:167], a[56:59], v[8:11]
  buffer_load_dwordx4 v238, s[20:23], s31 offen offset:0 lds
  v_mfma_f32_16x16x32_bf16 v[12:15], a[164:167], a[60:63], v[12:15]
  ds_read_b64_tr_b16 a[182:183], v226 offset:58368
  v_mfma_f32_16x16x32_bf16 v[12:15], a[160:163], a[44:47], v[12:15]
  s_waitcnt lgkmcnt(4)
  v_mfma_f32_16x16x32_bf16 v[16:19], a[168:171], a[32:35], v[16:19]
  ds_read_b64_tr_b16 a[184:185], v227 offset:49152
  v_mfma_f32_16x16x32_bf16 v[16:19], a[172:175], a[48:51], v[16:19]
  buffer_load_dwordx4 a[4:7], v242, s[24:27], s30 offen offset:1024 sc1
  v_mfma_f32_16x16x32_bf16 v[20:23], a[172:175], a[52:55], v[20:23]
  ds_read_b64_tr_b16 a[186:187], v227 offset:50176
  v_mfma_f32_16x16x32_bf16 v[20:23], a[168:171], a[36:39], v[20:23]
  v_mfma_f32_16x16x32_bf16 v[24:27], a[168:171], a[40:43], v[24:27]
  ds_read_b64_tr_b16 a[188:189], v227 offset:57344
  v_mfma_f32_16x16x32_bf16 v[24:27], a[172:175], a[56:59], v[24:27]
  v_mfma_f32_16x16x32_bf16 v[28:31], a[172:175], a[60:63], v[28:31]
  ds_read_b64_tr_b16 a[190:191], v227 offset:58368
  v_mfma_f32_16x16x32_bf16 v[28:31], a[168:171], a[44:47], v[28:31]
  s_waitcnt lgkmcnt(4)
  v_mfma_f32_16x16x32_bf16 v[32:35], a[176:179], a[32:35], v[32:35]
  ds_read_b64_tr_b16 a[160:161], v228 offset:49152
  v_mfma_f32_16x16x32_bf16 v[32:35], a[180:183], a[48:51], v[32:35]
  buffer_load_dwordx4 a[8:11], v242, s[24:27], s30 offen offset:2048 sc1
  v_mfma_f32_16x16x32_bf16 v[36:39], a[180:183], a[52:55], v[36:39]
  ds_read_b64_tr_b16 a[162:163], v228 offset:50176
  v_mfma_f32_16x16x32_bf16 v[36:39], a[176:179], a[36:39], v[36:39]
  v_mfma_f32_16x16x32_bf16 v[40:43], a[176:179], a[40:43], v[40:43]
  ds_read_b64_tr_b16 a[164:165], v228 offset:57344
  v_mfma_f32_16x16x32_bf16 v[40:43], a[180:183], a[56:59], v[40:43]
  buffer_load_dwordx4 v239, s[20:23], s31 offen offset:1024 lds
  v_mfma_f32_16x16x32_bf16 v[44:47], a[180:183], a[60:63], v[44:47]
  ds_read_b64_tr_b16 a[166:167], v228 offset:58368
  v_mfma_f32_16x16x32_bf16 v[44:47], a[176:179], a[44:47], v[44:47]
  s_waitcnt lgkmcnt(4)
  v_mfma_f32_16x16x32_bf16 v[48:51], a[184:187], a[32:35], v[48:51]
  ds_read_b64_tr_b16 a[168:169], v229 offset:49152
  v_mfma_f32_16x16x32_bf16 v[48:51], a[188:191], a[48:51], v[48:51]
  buffer_load_dwordx4 a[12:15], v242, s[24:27], s30 offen offset:3072 sc1
  v_mfma_f32_16x16x32_bf16 v[52:55], a[188:191], a[52:55], v[52:55]
  ds_read_b64_tr_b16 a[170:171], v229 offset:50176
  v_mfma_f32_16x16x32_bf16 v[52:55], a[184:187], a[36:39], v[52:55]
  v_mfma_f32_16x16x32_bf16 v[56:59], a[184:187], a[40:43], v[56:59]
  ds_read_b64_tr_b16 a[172:173], v229 offset:57344
  v_mfma_f32_16x16x32_bf16 v[56:59], a[188:191], a[56:59], v[56:59]
  v_mfma_f32_16x16x32_bf16 v[60:63], a[188:191], a[60:63], v[60:63]
  ds_read_b64_tr_b16 a[174:175], v229 offset:58368
  v_mfma_f32_16x16x32_bf16 v[60:63], a[184:187], a[44:47], v[60:63]
  s_waitcnt lgkmcnt(4)
  v_mfma_f32_16x16x32_bf16 v[64:67], a[160:163], a[32:35], v[64:67]
  ds_read_b64_tr_b16 a[176:177], v230 offset:49152
  v_mfma_f32_16x16x32_bf16 v[64:67], a[164:167], a[48:51], v[64:67]
  buffer_load_dwordx4 a[16:19], v243, s[24:27], s30 offen offset:0 sc1
  v_mfma_f32_16x16x32_bf16 v[68:71], a[164:167], a[52:55], v[68:71]
  ds_read_b64_tr_b16 a[178:179], v230 offset:50176
  v_mfma_f32_16x16x32_bf16 v[68:71], a[160:163], a[36:39], v[68:71]
  v_mfma_f32_16x16x32_bf16 v[72:75], a[160:163], a[40:43], v[72:75]
  ds_read_b64_tr_b16 a[180:181], v230 offset:57344
  v_mfma_f32_16x16x32_bf16 v[72:75], a[164:167], a[56:59], v[72:75]
  buffer_load_dwordx4 v240, s[20:23], s31 offen offset:2048 lds
  v_mfma_f32_16x16x32_bf16 v[76:79], a[164:167], a[60:63], v[76:79]
  ds_read_b64_tr_b16 a[182:183], v230 offset:58368
  v_mfma_f32_16x16x32_bf16 v[76:79], a[160:163], a[44:47], v[76:79]
  s_waitcnt lgkmcnt(4)
  v_mfma_f32_16x16x32_bf16 v[80:83], a[168:171], a[32:35], v[80:83]
  ds_read_b64_tr_b16 a[184:185], v231 offset:49152
  v_mfma_f32_16x16x32_bf16 v[80:83], a[172:175], a[48:51], v[80:83]
  buffer_load_dwordx4 a[20:23], v243, s[24:27], s30 offen offset:1024 sc1
  v_mfma_f32_16x16x32_bf16 v[84:87], a[172:175], a[52:55], v[84:87]
  ds_read_b64_tr_b16 a[186:187], v231 offset:50176
  v_mfma_f32_16x16x32_bf16 v[84:87], a[168:171], a[36:39], v[84:87]
  v_mfma_f32_16x16x32_bf16 v[88:91], a[168:171], a[40:43], v[88:91]
  ds_read_b64_tr_b16 a[188:189], v231 offset:57344
  v_mfma_f32_16x16x32_bf16 v[88:91], a[172:175], a[56:59], v[88:91]
  s_barrier
  v_mfma_f32_16x16x32_bf16 v[92:95], a[172:175], a[60:63], v[92:95]
  ds_read_b64_tr_b16 a[190:191], v231 offset:58368
  v_mfma_f32_16x16x32_bf16 v[92:95], a[168:171], a[44:47], v[92:95]
  s_waitcnt lgkmcnt(4)
  v_mfma_f32_16x16x32_bf16 v[96:99], a[176:179], a[32:35], v[96:99]
  ds_read_b64_tr_b16 a[160:161], v144 offset:32768
  v_mfma_f32_16x16x32_bf16 v[96:99], a[180:183], a[48:51], v[96:99]
  buffer_load_dwordx4 a[24:27], v243, s[24:27], s30 offen offset:2048 sc1
  v_mfma_f32_16x16x32_bf16 v[100:103], a[180:183], a[52:55], v[100:103]
  ds_read_b64_tr_b16 a[162:163], v144 offset:33792
  v_mfma_f32_16x16x32_bf16 v[100:103], a[176:179], a[36:39], v[100:103]
  v_mfma_f32_16x16x32_bf16 v[104:107], a[176:179], a[40:43], v[104:107]
  ds_read_b64_tr_b16 a[164:165], v144 offset:40960
  v_mfma_f32_16x16x32_bf16 v[104:107], a[180:183], a[56:59], v[104:107]
  buffer_load_dwordx4 v241, s[20:23], s31 offen offset:3072 lds
  s_add_u32 s31, s31, 0x80000
  v_mfma_f32_16x16x32_bf16 v[108:111], a[180:183], a[60:63], v[108:111]
  ds_read_b64_tr_b16 a[166:167], v144 offset:41984
  v_mfma_f32_16x16x32_bf16 v[108:111], a[176:179], a[44:47], v[108:111]
  s_waitcnt lgkmcnt(4)
  v_mfma_f32_16x16x32_bf16 v[112:115], a[184:187], a[32:35], v[112:115]
  ds_read_b64_tr_b16 a[168:169], v145 offset:32768
  v_mfma_f32_16x16x32_bf16 v[112:115], a[188:191], a[48:51], v[112:115]
  buffer_load_dwordx4 a[28:31], v243, s[24:27], s30 offen offset:3072 sc1
  s_add_u32 s30, s30, 8192
  v_mfma_f32_16x16x32_bf16 v[116:119], a[188:191], a[52:55], v[116:119]
  ds_read_b64_tr_b16 a[170:171], v145 offset:33792
  v_mfma_f32_16x16x32_bf16 v[116:119], a[184:187], a[36:39], v[116:119]
  v_mfma_f32_16x16x32_bf16 v[120:123], a[184:187], a[40:43], v[120:123]
  ds_read_b64_tr_b16 a[172:173], v145 offset:40960
  v_mfma_f32_16x16x32_bf16 v[120:123], a[188:191], a[56:59], v[120:123]
  v_mfma_f32_16x16x32_bf16 v[124:127], a[188:191], a[60:63], v[124:127]
  ds_read_b64_tr_b16 a[174:175], v145 offset:41984
  v_mfma_f32_16x16x32_bf16 v[124:127], a[184:187], a[44:47], v[124:127]
  s_waitcnt vmcnt(20) lgkmcnt(4)
  v_xor_b32 v136, s55, v136
  v_xor_b32 v137, s55, v137
  v_xor_b32 v138, s55, v138
  v_xor_b32 v139, s55, v139
  v_or3_b32 v136, v136, v137, v138
  v_or_b32 v136, v136, v139
  v_cmp_ne_u32 vcc, 0, v136
  s_nop 0
  s_cbranch_vccz front_keys
  s_mov_b32 s54, 32768
front_all:
  s_sleep 2
  buffer_load_dwordx4 v[136:139], v140, s[24:27], s58 offen sc1
  s_waitcnt vmcnt(0)
  v_xor_b32 v136, s55, v136
  v_xor_b32 v137, s55, v137
  v_xor_b32 v138, s55, v138
  v_xor_b32 v139, s55, v139
  v_or3_b32 v136, v136, v137, v138
  v_or_b32 v136, v136, v139
  v_cmp_ne_u32 vcc, 0, v136
  s_nop 0
  s_cbranch_vccz front_keys
  s_sub_u32 s54, s54, 1
  s_cmp_lg_u32 s54, 0
  s_cbranch_scc1 front_all
front_keys:
  s_lshl_b32 s35, s3, 11
  s_add_u32 s35, s35, 2621440
  buffer_load_dwordx4 v[128:131], v242, s[24:27], s35 offen sc1
  buffer_load_dwordx4 v[132:135], v242, s[24:27], s35 offen offset:1024 sc1
  v_mfma_f32_16x16x32_bf16 v[0:3], a[160:163], a[64:67], v[0:3]
  ds_read_b64_tr_b16 a[176:177], v146 offset:32768
  s_add_u32 s59, s59, 1
  s_or_b32 s54, s2, s3
  s_min_u32 s54, s54, 1
  v_mfma_f32_16x16x32_bf16 v[0:3], a[164:167], a[80:83], v[0:3]
  buffer_load_dwordx4 a[32:35], v242, s[24:27], s30 offen offset:0 sc1
  s_lshl_b32 s54, s54, 28
  v_mfma_f32_16x16x32_bf16 v[4:7], a[164:167], a[84:87], v[4:7]
  ds_read_b64_tr_b16 a[178:179], v146 offset:33792
  v_lshlrev_b32 v137, 22, v242
  v_mfma_f32_16x16x32_bf16 v[4:7], a[160:163], a[68:71], v[4:7]
  v_or_b32 v137, s54, v137
  v_mov_b32 v136, s59
  v_mfma_f32_16x16x32_bf16 v[8:11], a[160:163], a[72:75], v[8:11]
  ds_read_b64_tr_b16 a[180:181], v146 offset:40960
  s_add_u32 m0, s28, 0
  s_mov_b32 s58, 2830336
  buffer_store_dword v136, v137, s[24:27], s58 offen sc1
  v_mfma_f32_16x16x32_bf16 v[8:11], a[164:167], a[88:91], v[8:11]
  buffer_load_dwordx4 v238, s[20:23], s31 offen offset:0 lds
  v_mfma_f32_16x16x32_bf16 v[12:15], a[164:167], a[92:95], v[12:15]
  ds_read_b64_tr_b16 a[182:183], v146 offset:41984
  v_mfma_f32_16x16x32_bf16 v[12:15], a[160:163], a[76:79], v[12:15]
  s_waitcnt lgkmcnt(4)
  v_mfma_f32_16x16x32_bf16 v[16:19], a[168:171], a[64:67], v[16:19]
  ds_read_b64_tr_b16 a[184:185], v147 offset:32768
  v_mfma_f32_16x16x32_bf16 v[16:19], a[172:175], a[80:83], v[16:19]
  buffer_load_dwordx4 a[36:39], v242, s[24:27], s30 offen offset:1024 sc1
  v_mfma_f32_16x16x32_bf16 v[20:23], a[172:175], a[84:87], v[20:23]
  ds_read_b64_tr_b16 a[186:187], v147 offset:33792
  v_mfma_f32_16x16x32_bf16 v[20:23], a[168:171], a[68:71], v[20:23]
  v_mfma_f32_16x16x32_bf16 v[24:27], a[168:171], a[72:75], v[24:27]
  ds_read_b64_tr_b16 a[188:189], v147 offset:40960
  v_mfma_f32_16x16x32_bf16 v[24:27], a[172:175], a[88:91], v[24:27]
  v_mfma_f32_16x16x32_bf16 v[28:31], a[172:175], a[92:95], v[28:31]
  ds_read_b64_tr_b16 a[190:191], v147 offset:41984
  v_mfma_f32_16x16x32_bf16 v[28:31], a[168:171], a[76:79], v[28:31]
  s_waitcnt lgkmcnt(4)
  v_mfma_f32_16x16x32_bf16 v[32:35], a[176:179], a[64:67], v[32:35]
  ds_read_b64_tr_b16 a[160:161], v148 offset:32768
  v_mfma_f32_16x16x32_bf16 v[32:35], a[180:183], a[80:83], v[32:35]
  buffer_load_dwordx4 a[40:43], v242, s[24:27], s30 offen offset:2048 sc1
  v_mfma_f32_16x16x32_bf16 v[36:39], a[180:183], a[84:87], v[36:39]
  ds_read_b64_tr_b16 a[162:163], v148 offset:33792
  v_mfma_f32_16x16x32_bf16 v[36:39], a[176:179], a[68:71], v[36:39]
  v_mfma_f32_16x16x32_bf16 v[40:43], a[176:179], a[72:75], v[40:43]
  ds_read_b64_tr_b16 a[164:165], v148 offset:40960
  v_mfma_f32_16x16x32_bf16 v[40:43], a[180:183], a[88:91], v[40:43]
  buffer_load_dwordx4 v239, s[20:23], s31 offen offset:1024 lds
  v_mfma_f32_16x16x32_bf16 v[44:47], a[180:183], a[92:95], v[44:47]
  ds_read_b64_tr_b16 a[166:167], v148 offset:41984
  v_mfma_f32_16x16x32_bf16 v[44:47], a[176:179], a[76:79], v[44:47]
  s_waitcnt lgkmcnt(4)
  v_mfma_f32_16x16x32_bf16 v[48:51], a[184:187], a[64:67], v[48:51]
  ds_read_b64_tr_b16 a[168:169], v149 offset:32768
  v_mfma_f32_16x16x32_bf16 v[48:51], a[188:191], a[80:83], v[48:51]
  buffer_load_dwordx4 a[44:47], v242, s[24:27], s30 offen offset:3072 sc1
  v_mfma_f32_16x16x32_bf16 v[52:55], a[188:191], a[84:87], v[52:55]
  ds_read_b64_tr_b16 a[170:171], v149 offset:33792
  v_mfma_f32_16x16x32_bf16 v[52:55], a[184:187], a[68:71], v[52:55]
  v_mfma_f32_16x16x32_bf16 v[56:59], a[184:187], a[72:75], v[56:59]
  ds_read_b64_tr_b16 a[172:173], v149 offset:40960
  v_mfma_f32_16x16x32_bf16 v[56:59], a[188:191], a[88:91], v[56:59]
  v_mfma_f32_16x16x32_bf16 v[60:63], a[188:191], a[92:95], v[60:63]
  ds_read_b64_tr_b16 a[174:175], v149 offset:41984
  v_mfma_f32_16x16x32_bf16 v[60:63], a[184:187], a[76:79], v[60:63]
  s_waitcnt lgkmcnt(4)
  v_mfma_f32_16x16x32_bf16 v[64:67], a[160:163], a[64:67], v[64:67]
  ds_read_b64_tr_b16 a[176:177], v150 offset:32768
  v_mfma_f32_16x16x32_bf16 v[64:67], a[164:167], a[80:83], v[64:67]
  buffer_load_dwordx4 a[48:51], v243, s[24:27], s30 offen offset:0 sc1
  v_mfma_f32_16x16x32_bf16 v[68:71], a[164:167], a[84:87], v[68:71]
  ds_read_b64_tr_b16 a[178:179], v150 offset:33792
  v_mfma_f32_16x16x32_bf16 v[68:71], a[160:163], a[68:71], v[68:71]
  v_mfma_f32_16x16x32_bf16 v[72:75], a[160:163], a[72:75], v[72:75]
  ds_read_b64_tr_b16 a[180:181], v150 offset:40960
  v_mfma_f32_16x16x32_bf16 v[72:75], a[164:167], a[88:91], v[72:75]
  buffer_load_dwordx4 v240, s[20:23], s31 offen offset:2048 lds
  v_mfma_f32_16x16x32_bf16 v[76:79], a[164:167], a[92:95], v[76:79]
  ds_read_b64_tr_b16 a[182:183], v150 offset:41984
  v_mfma_f32_16x16x32_bf16 v[76:79], a[160:163], a[76:79], v[76:79]
  s_waitcnt lgkmcnt(4)
  v_mfma_f32_16x16x32_bf16 v[80:83], a[168:171], a[64:67], v[80:83]
  ds_read_b64_tr_b16 a[184:185], v151 offset:32768
  v_mfma_f32_16x16x32_bf16 v[80:83], a[172:175], a[80:83], v[80:83]
  buffer_load_dwordx4 a[52:55], v243, s[24:27], s30 offen offset:1024 sc1
  v_mfma_f32_16x16x32_bf16 v[84:87], a[172:175], a[84:87], v[84:87]
  ds_read_b64_tr_b16 a[186:187], v151 offset:33792
  v_mfma_f32_16x16x32_bf16 v[84:87], a[168:171], a[68:71], v[84:87]
  v_mfma_f32_16x16x32_bf16 v[88:91], a[168:171], a[72:75], v[88:91]
  ds_read_b64_tr_b16 a[188:189], v151 offset:40960
  v_mfma_f32_16x16x32_bf16 v[88:91], a[172:175], a[88:91], v[88:91]
  s_barrier
  v_mfma_f32_16x16x32_bf16 v[92:95], a[172:175], a[92:95], v[92:95]
  ds_read_b64_tr_b16 a[190:191], v151 offset:41984
  v_mfma_f32_16x16x32_bf16 v[92:95], a[168:171], a[76:79], v[92:95]
  s_waitcnt lgkmcnt(4)
  v_mfma_f32_16x16x32_bf16 v[96:99], a[176:179], a[64:67], v[96:99]
  ds_read_b64_tr_b16 a[160:161], v144 offset:49152
  v_mfma_f32_16x16x32_bf16 v[96:99], a[180:183], a[80:83], v[96:99]
  buffer_load_dwordx4 a[56:59], v243, s[24:27], s30 offen offset:2048 sc1
  v_mfma_f32_16x16x32_bf16 v[100:103], a[180:183], a[84:87], v[100:103]
  ds_read_b64_tr_b16 a[162:163], v144 offset:50176
  v_mfma_f32_16x16x32_bf16 v[100:103], a[176:179], a[68:71], v[100:103]
  v_mfma_f32_16x16x32_bf16 v[104:107], a[176:179], a[72:75], v[104:107]
  ds_read_b64_tr_b16 a[164:165], v144 offset:57344
  v_mfma_f32_16x16x32_bf16 v[104:107], a[180:183], a[88:91], v[104:107]
  buffer_load_dwordx4 v241, s[20:23], s31 offen offset:3072 lds
  s_add_u32 s31, s31, 0x80000
  v_mfma_f32_16x16x32_bf16 v[108:111], a[180:183], a[92:95], v[108:111]
  ds_read_b64_tr_b16 a[166:167], v144 offset:58368
  v_mfma_f32_16x16x32_bf16 v[108:111], a[176:179], a[76:79], v[108:111]
  s_waitcnt lgkmcnt(4)
  v_mfma_f32_16x16x32_bf16 v[112:115], a[184:187], a[64:67], v[112:115]
  ds_read_b64_tr_b16 a[168:169], v145 offset:49152
  v_mfma_f32_16x16x32_bf16 v[112:115], a[188:191], a[80:83], v[112:115]
  buffer_load_dwordx4 a[60:63], v243, s[24:27], s30 offen offset:3072 sc1
  s_add_u32 s30, s30, 8192
  v_mfma_f32_16x16x32_bf16 v[116:119], a[188:191], a[84:87], v[116:119]
  ds_read_b64_tr_b16 a[170:171], v145 offset:50176
  v_mfma_f32_16x16x32_bf16 v[116:119], a[184:187], a[68:71], v[116:119]
  v_mfma_f32_16x16x32_bf16 v[120:123], a[184:187], a[72:75], v[120:123]
  ds_read_b64_tr_b16 a[172:173], v145 offset:57344
  v_mfma_f32_16x16x32_bf16 v[120:123], a[188:191], a[88:91], v[120:123]
  v_mfma_f32_16x16x32_bf16 v[124:127], a[188:191], a[92:95], v[124:127]
  ds_read_b64_tr_b16 a[174:175], v145 offset:58368
  v_mfma_f32_16x16x32_bf16 v[124:127], a[184:187], a[76:79], v[124:127]
  s_waitcnt vmcnt(27) lgkmcnt(4)
  v_mfma_f32_16x16x32_bf16 v[0:3], a[160:163], a[96:99], v[0:3]
  ds_read_b64_tr_b16 a[176:177], v146 offset:49152
  v_mfma_f32_16x16x32_bf16 v[0:3], a[164:167], a[112:115], v[0:3]
  buffer_load_dwordx4 a[64:67], v242, s[24:27], s30 offen offset:0 sc1
  v_mfma_f32_16x16x32_bf16 v[4:7], a[164:167], a[116:119], v[4:7]
  ds_read_b64_tr_b16 a[178:179], v146 offset:50176
  v_mfma_f32_16x16x32_bf16 v[4:7], a[160:163], a[100:103], v[4:7]
  v_mfma_f32_16x16x32_bf16 v[8:11], a[160:163], a[104:107], v[8:11]
  ds_read_b64_tr_b16 a[180:181], v146 offset:57344
  s_add_u32 m0, s28, 65536
  v_mfma_f32_16x16x32_bf16 v[8:11], a[164:167], a[120:123], v[8:11]
  buffer_load_dwordx4 v238, s[20:23], s31 offen offset:0 lds
  v_mfma_f32_16x16x32_bf16 v[12:15], a[164:167], a[124:127], v[12:15]
  ds_read_b64_tr_b16 a[182:183], v146 offset:58368
  v_mfma_f32_16x16x32_bf16 v[12:15], a[160:163], a[108:111], v[12:15]
  s_waitcnt lgkmcnt(4)
  v_mfma_f32_16x16x32_bf16 v[16:19], a[168:171], a[96:99], v[16:19]
  ds_read_b64_tr_b16 a[184:185], v147 offset:49152
  v_mfma_f32_16x16x32_bf16 v[16:19], a[172:175], a[112:115], v[16:19]
  buffer_load_dwordx4 a[68:71], v242, s[24:27], s30 offen offset:1024 sc1
  v_mfma_f32_16x16x32_bf16 v[20:23], a[172:175], a[116:119], v[20:23]
  ds_read_b64_tr_b16 a[186:187], v147 offset:50176
  v_mfma_f32_16x16x32_bf16 v[20:23], a[168:171], a[100:103], v[20:23]
  v_mfma_f32_16x16x32_bf16 v[24:27], a[168:171], a[104:107], v[24:27]
  ds_read_b64_tr_b16 a[188:189], v147 offset:57344
  v_mfma_f32_16x16x32_bf16 v[24:27], a[172:175], a[120:123], v[24:27]
  v_mfma_f32_16x16x32_bf16 v[28:31], a[172:175], a[124:127], v[28:31]
  ds_read_b64_tr_b16 a[190:191], v147 offset:58368
  v_mfma_f32_16x16x32_bf16 v[28:31], a[168:171], a[108:111], v[28:31]
  s_waitcnt lgkmcnt(4)
  v_mfma_f32_16x16x32_bf16 v[32:35], a[176:179], a[96:99], v[32:35]
  ds_read_b64_tr_b16 a[160:161], v148 offset:49152
  v_mfma_f32_16x16x32_bf16 v[32:35], a[180:183], a[112:115], v[32:35]
  buffer_load_dwordx4 a[72:75], v242, s[24:27], s30 offen offset:2048 sc1
  v_mfma_f32_16x16x32_bf16 v[36:39], a[180:183], a[116:119], v[36:39]
  ds_read_b64_tr_b16 a[162:163], v148 offset:50176
  v_mfma_f32_16x16x32_bf16 v[36:39], a[176:179], a[100:103], v[36:39]
  v_mfma_f32_16x16x32_bf16 v[40:43], a[176:179], a[104:107], v[40:43]
  ds_read_b64_tr_b16 a[164:165], v148 offset:57344
  v_mfma_f32_16x16x32_bf16 v[40:43], a[180:183], a[120:123], v[40:43]
  buffer_load_dwordx4 v239, s[20:23], s31 offen offset:1024 lds
  v_mfma_f32_16x16x32_bf16 v[44:47], a[180:183], a[124:127], v[44:47]
  ds_read_b64_tr_b16 a[166:167], v148 offset:58368
  v_mfma_f32_16x16x32_bf16 v[44:47], a[176:179], a[108:111], v[44:47]
  s_waitcnt lgkmcnt(4)
  v_mfma_f32_16x16x32_bf16 v[48:51], a[184:187], a[96:99], v[48:51]
  ds_read_b64_tr_b16 a[168:169], v149 offset:49152
  v_mfma_f32_16x16x32_bf16 v[48:51], a[188:191], a[112:115], v[48:51]
  buffer_load_dwordx4 a[76:79], v242, s[24:27], s30 offen offset:3072 sc1
  v_mfma_f32_16x16x32_bf16 v[52:55], a[188:191], a[116:119], v[52:55]
  ds_read_b64_tr_b16 a[170:171], v149 offset:50176
  v_mfma_f32_16x16x32_bf16 v[52:55], a[184:187], a[100:103], v[52:55]
  v_mfma_f32_16x16x32_bf16 v[56:59], a[184:187], a[104:107], v[56:59]
  ds_read_b64_tr_b16 a[172:173], v149 offset:57344
  v_mfma_f32_16x16x32_bf16 v[56:59], a[188:191], a[120:123], v[56:59]
  v_mfma_f32_16x16x32_bf16 v[60:63], a[188:191], a[124:127], v[60:63]
  ds_read_b64_tr_b16 a[174:175], v149 offset:58368
  v_mfma_f32_16x16x32_bf16 v[60:63], a[184:187], a[108:111], v[60:63]
  s_waitcnt lgkmcnt(4)
  v_mfma_f32_16x16x32_bf16 v[64:67], a[160:163], a[96:99], v[64:67]
  ds_read_b64_tr_b16 a[176:177], v150 offset:49152
  v_mfma_f32_16x16x32_bf16 v[64:67], a[164:167], a[112:115], v[64:67]
  buffer_load_dwordx4 a[80:83], v243, s[24:27], s30 offen offset:0 sc1
  v_mfma_f32_16x16x32_bf16 v[68:71], a[164:167], a[116:119], v[68:71]
  ds_read_b64_tr_b16 a[178:179], v150 offset:50176
  v_mfma_f32_16x16x32_bf16 v[68:71], a[160:163], a[100:103], v[68:71]
  v_mfma_f32_16x16x32_bf16 v[72:75], a[160:163], a[104:107], v[72:75]
  ds_read_b64_tr_b16 a[180:181], v150 offset:57344
  v_mfma_f32_16x16x32_bf16 v[72:75], a[164:167], a[120:123], v[72:75]
  buffer_load_dwordx4 v240, s[20:23], s31 offen offset:2048 lds
  v_mfma_f32_16x16x32_bf16 v[76:79], a[164:167], a[124:127], v[76:79]
  ds_read_b64_tr_b16 a[182:183], v150 offset:58368
  v_mfma_f32_16x16x32_bf16 v[76:79], a[160:163], a[108:111], v[76:79]
  s_waitcnt lgkmcnt(4)
  v_mfma_f32_16x16x32_bf16 v[80:83], a[168:171], a[96:99], v[80:83]
  ds_read_b64_tr_b16 a[184:185], v151 offset:49152
  v_mfma_f32_16x16x32_bf16 v[80:83], a[172:175], a[112:115], v[80:83]
  buffer_load_dwordx4 a[84:87], v243, s[24:27], s30 offen offset:1024 sc1
  v_mfma_f32_16x16x32_bf16 v[84:87], a[172:175], a[116:119], v[84:87]
  ds_read_b64_tr_b16 a[186:187], v151 offset:50176
  v_mfma_f32_16x16x32_bf16 v[84:87], a[168:171], a[100:103], v[84:87]
  s_waitcnt vmcnt(25)
  v_mfma_f32_16x16x32_bf16 v[88:91], a[168:171], a[104:107], v[88:91]
  ds_read_b64_tr_b16 a[188:189], v151 offset:57344
  v_mfma_f32_16x16x32_bf16 v[88:91], a[172:175], a[120:123], v[88:91]
  s_barrier
  v_mfma_f32_16x16x32_bf16 v[92:95], a[172:175], a[124:127], v[92:95]
  ds_read_b64_tr_b16 a[190:191], v151 offset:58368
  v_mfma_f32_16x16x32_bf16 v[92:95], a[168:171], a[108:111], v[92:95]
  s_waitcnt lgkmcnt(4)
  v_mfma_f32_16x16x32_bf16 v[96:99], a[176:179], a[96:99], v[96:99]
  ds_read_b64_tr_b16 a[160:161], v144 offset:16384
  v_mfma_f32_16x16x32_bf16 v[96:99], a[180:183], a[112:115], v[96:99]
  buffer_load_dwordx4 a[88:91], v243, s[24:27], s30 offen offset:2048 sc1
  v_mfma_f32_16x16x32_bf16 v[100:103], a[180:183], a[116:119], v[100:103]
  ds_read_b64_tr_b16 a[162:163], v144 offset:17408
  v_mfma_f32_16x16x32_bf16 v[100:103], a[176:179], a[100:103], v[100:103]
  v_mfma_f32_16x16x32_bf16 v[104:107], a[176:179], a[104:107], v[104:107]
  ds_read_b64_tr_b16 a[164:165], v144 offset:24576
  v_mfma_f32_16x16x32_bf16 v[104:107], a[180:183], a[120:123], v[104:107]
  buffer_load_dwordx4 v241, s[20:23], s31 offen offset:3072 lds
  s_add_u32 s31, s31, 0x80000
  v_mfma_f32_16x16x32_bf16 v[108:111], a[180:183], a[124:127], v[108:111]
  ds_read_b64_tr_b16 a[166:167], v144 offset:25600
  v_mfma_f32_16x16x32_bf16 v[108:111], a[176:179], a[108:111], v[108:111]
  s_waitcnt lgkmcnt(4)
  v_mfma_f32_16x16x32_bf16 v[112:115], a[184:187], a[96:99], v[112:115]
  ds_read_b64_tr_b16 a[168:169], v145 offset:16384
  v_mfma_f32_16x16x32_bf16 v[112:115], a[188:191], a[112:115], v[112:115]
  buffer_load_dwordx4 a[92:95], v243, s[24:27], s30 offen offset:3072 sc1
  s_add_u32 s30, s30, 8192
  v_mfma_f32_16x16x32_bf16 v[116:119], a[188:191], a[116:119], v[116:119]
  ds_read_b64_tr_b16 a[170:171], v145 offset:17408
  v_mfma_f32_16x16x32_bf16 v[116:119], a[184:187], a[100:103], v[116:119]
  v_mfma_f32_16x16x32_bf16 v[120:123], a[184:187], a[104:107], v[120:123]
  ds_read_b64_tr_b16 a[172:173], v145 offset:24576
  v_mfma_f32_16x16x32_bf16 v[120:123], a[188:191], a[120:123], v[120:123]
  v_mfma_f32_16x16x32_bf16 v[124:127], a[188:191], a[124:127], v[124:127]
  ds_read_b64_tr_b16 a[174:175], v145 offset:25600
  v_mfma_f32_16x16x32_bf16 v[124:127], a[184:187], a[108:111], v[124:127]
  s_waitcnt vmcnt(27) lgkmcnt(4)
  v_mfma_f32_16x16x32_bf16 v[0:3], a[160:163], a[0:3], v[0:3]
  ds_read_b64_tr_b16 a[176:177], v146 offset:16384
  s_waitcnt vmcnt(25)
  s_mov_b32 s51, -1
  v_sub_u32 v137, s51, v128
  v_mfma_f32_16x16x32_bf16 v[0:3], a[164:167], a[16:19], v[0:3]
  buffer_load_dwordx4 a[96:99], v242, s[24:27], s30 offen offset:0 sc1
  v_mfma_f32_16x16x32_bf16 v[4:7], a[164:167], a[20:23], v[4:7]
  ds_read_b64_tr_b16 a[178:179], v146 offset:17408
  v_sub_u32 v138, s51, v129
  v_mfma_f32_16x16x32_bf16 v[4:7], a[160:163], a[4:7], v[4:7]
  v_min_u32 v136, v137, v138
  v_sub_u32 v139, s51, v130
  v_mfma_f32_16x16x32_bf16 v[8:11], a[160:163], a[8:11], v[8:11]
  ds_read_b64_tr_b16 a[180:181], v146 offset:24576
  s_add_u32 m0, s28, 81920
  v_sub_u32 v140, s51, v131
  v_mfma_f32_16x16x32_bf16 v[8:11], a[164:167], a[24:27], v[8:11]
  buffer_load_dwordx4 v238, s[20:23], s31 offen offset:0 lds
  v_mfma_f32_16x16x32_bf16 v[12:15], a[164:167], a[28:31], v[12:15]
  ds_read_b64_tr_b16 a[182:183], v146 offset:25600
  v_min3_u32 v136, v136, v139, v140
  v_mfma_f32_16x16x32_bf16 v[12:15], a[160:163], a[12:15], v[12:15]
  s_waitcnt lgkmcnt(4)
  v_sub_u32 v137, s51, v132
  v_sub_u32 v138, s51, v133
  v_mfma_f32_16x16x32_bf16 v[16:19], a[168:171], a[0:3], v[16:19]
  ds_read_b64_tr_b16 a[184:185], v147 offset:16384
  v_min3_u32 v136, v136, v137, v138
  v_mfma_f32_16x16x32_bf16 v[16:19], a[172:175], a[16:19], v[16:19]
  buffer_load_dwordx4 a[100:103], v242, s[24:27], s30 offen offset:1024 sc1
  v_mfma_f32_16x16x32_bf16 v[20:23], a[172:175], a[20:23], v[20:23]
  ds_read_b64_tr_b16 a[186:187], v147 offset:17408
  v_sub_u32 v139, s51, v134
  v_mfma_f32_16x16x32_bf16 v[20:23], a[168:171], a[4:7], v[20:23]
  v_sub_u32 v140, s51, v135
  v_min3_u32 v136, v136, v139, v140
  v_mfma_f32_16x16x32_bf16 v[24:27], a[168:171], a[8:11], v[24:27]
  ds_read_b64_tr_b16 a[188:189], v147 offset:24576
  v_min_u32_dpp v136, v136, v136 row_ror:8 row_mask:0xf bank_mask:0xf
  v_mfma_f32_16x16x32_bf16 v[24:27], a[172:175], a[24:27], v[24:27]
  v_mfma_f32_16x16x32_bf16 v[28:31], a[172:175], a[28:31], v[28:31]
  ds_read_b64_tr_b16 a[190:191], v147 offset:25600
  v_min_u32_dpp v136, v136, v136 row_ror:4 row_mask:0xf bank_mask:0xf
  v_mfma_f32_16x16x32_bf16 v[28:31], a[168:171], a[12:15], v[28:31]
  s_waitcnt lgkmcnt(4)
  v_min_u32_dpp v136, v136, v136 row_ror:2 row_mask:0xf bank_mask:0xf
  v_mfma_f32_16x16x32_bf16 v[32:35], a[176:179], a[0:3], v[32:35]
  ds_read_b64_tr_b16 a[160:161], v148 offset:16384
  v_min_u32_dpp v136, v136, v136 row_ror:1 row_mask:0xf bank_mask:0xf
  v_mfma_f32_16x16x32_bf16 v[32:35], a[180:183], a[16:19], v[32:35]
  buffer_load_dwordx4 a[104:107], v242, s[24:27], s30 offen offset:2048 sc1
  v_mfma_f32_16x16x32_bf16 v[36:39], a[180:183], a[20:23], v[36:39]
  ds_read_b64_tr_b16 a[162:163], v148 offset:17408
  v_readlane_b32 s98, v136, 0
  v_mfma_f32_16x16x32_bf16 v[36:39], a[176:179], a[4:7], v[36:39]
  v_readlane_b32 s99, v136, 16
  v_readlane_b32 s100, v136, 32
  v_mfma_f32_16x16x32_bf16 v[40:43], a[176:179], a[8:11], v[40:43]
  ds_read_b64_tr_b16 a[164:165], v148 offset:24576
  v_readlane_b32 s101, v136, 48
  v_mfma_f32_16x16x32_bf16 v[40:43], a[180:183], a[24:27], v[40:43]
  buffer_load_dwordx4 v239, s[20:23], s31 offen offset:1024 lds
  s_min_u32 s98, s98, s99
  s_min_u32 s100, s100, s101
  s_min_u32 s98, s98, s100
  v_mfma_f32_16x16x32_bf16 v[44:47], a[180:183], a[28:31], v[44:47]
  ds_read_b64_tr_b16 a[166:167], v148 offset:25600
  s_sub_u32 s52, s51, s98
  s_sub_u32 s51, s52, 1
  v_sub_u32 v137, s51, v128
  v_mfma_f32_16x16x32_bf16 v[44:47], a[176:179], a[12:15], v[44:47]
  s_waitcnt lgkmcnt(4)
  v_sub_u32 v138, s51, v129
  v_min_u32 v136, v137, v138
  v_mfma_f32_16x16x32_bf16 v[48:51], a[184:187], a[0:3], v[48:51]
  ds_read_b64_tr_b16 a[168:169], v149 offset:16384
  v_sub_u32 v139, s51, v130
  v_mfma_f32_16x16x32_bf16 v[48:51], a[188:191], a[16:19], v[48:51]
  buffer_load_dwordx4 a[108:111], v242, s[24:27], s30 offen offset:3072 sc1
  v_mfma_f32_16x16x32_bf16 v[52:55], a[188:191], a[20:23], v[52:55]
  ds_read_b64_tr_b16 a[170:171], v149 offset:17408
  v_sub_u32 v140, s51, v131
  v_mfma_f32_16x16x32_bf16 v[52:55], a[184:187], a[4:7], v[52:55]
  v_min3_u32 v136, v136, v139, v140
  v_sub_u32 v137, s51, v132
  v_mfma_f32_16x16x32_bf16 v[56:59], a[184:187], a[8:11], v[56:59]
  ds_read_b64_tr_b16 a[172:173], v149 offset:24576
  v_sub_u32 v138, s51, v133
  v_mfma_f32_16x16x32_bf16 v[56:59], a[188:191], a[24:27], v[56:59]
  v_min3_u32 v136, v136, v137, v138
  v_sub_u32 v139, s51, v134
  v_mfma_f32_16x16x32_bf16 v[60:63], a[188:191], a[28:31], v[60:63]
  ds_read_b64_tr_b16 a[174:175], v149 offset:25600
  v_sub_u32 v140, s51, v135
  v_mfma_f32_16x16x32_bf16 v[60:63], a[184:187], a[12:15], v[60:63]
  s_waitcnt lgkmcnt(4)
  v_min3_u32 v136, v136, v139, v140
  v_mfma_f32_16x16x32_bf16 v[64:67], a[160:163], a[0:3], v[64:67]
  ds_read_b64_tr_b16 a[176:177], v150 offset:16384
  v_min_u32_dpp v136, v136, v136 row_ror:8 row_mask:0xf bank_mask:0xf
  v_mfma_f32_16x16x32_bf16 v[64:67], a[164:167], a[16:19], v[64:67]
  buffer_load_dwordx4 a[112:115], v243, s[24:27], s30 offen offset:0 sc1
  v_mfma_f32_16x16x32_bf16 v[68:71], a[164:167], a[20:23], v[68:71]
  ds_read_b64_tr_b16 a[178:179], v150 offset:17408
  v_min_u32_dpp v136, v136, v136 row_ror:4 row_mask:0xf bank_mask:0xf
  v_mfma_f32_16x16x32_bf16 v[68:71], a[160:163], a[4:7], v[68:71]
  v_mfma_f32_16x16x32_bf16 v[72:75], a[160:163], a[8:11], v[72:75]
  ds_read_b64_tr_b16 a[180:181], v150 offset:24576
  v_min_u32_dpp v136, v136, v136 row_ror:2 row_mask:0xf bank_mask:0xf
  v_mfma_f32_16x16x32_bf16 v[72:75], a[164:167], a[24:27], v[72:75]
  buffer_load_dwordx4 v240, s[20:23], s31 offen offset:2048 lds
  v_mfma_f32_16x16x32_bf16 v[76:79], a[164:167], a[28:31], v[76:79]
  ds_read_b64_tr_b16 a[182:183], v150 offset:25600
  v_min_u32_dpp v136, v136, v136 row_ror:1 row_mask:0xf bank_mask:0xf
  v_mfma_f32_16x16x32_bf16 v[76:79], a[160:163], a[12:15], v[76:79]
  s_waitcnt lgkmcnt(4)
  v_readlane_b32 s98, v136, 0
  v_readlane_b32 s99, v136, 16
  v_mfma_f32_16x16x32_bf16 v[80:83], a[168:171], a[0:3], v[80:83]
  ds_read_b64_tr_b16 a[184:185], v151 offset:16384
  v_readlane_b32 s100, v136, 32
  v_mfma_f32_16x16x32_bf16 v[80:83], a[172:175], a[16:19], v[80:83]
  buffer_load_dwordx4 a[116:119], v243, s[24:27], s30 offen offset:1024 sc1
  v_mfma_f32_16x16x32_bf16 v[84:87], a[172:175], a[20:23], v[84:87]
  ds_read_b64_tr_b16 a[186:187], v151 offset:17408
  v_readlane_b32 s101, v136, 48
  v_mfma_f32_16x16x32_bf16 v[84:87], a[168:171], a[4:7], v[84:87]
  s_waitcnt vmcnt(22)
  s_min_u32 s98, s98, s99
  s_min_u32 s100, s100, s101
  v_mfma_f32_16x16x32_bf16 v[88:91], a[168:171], a[8:11], v[88:91]
  ds_read_b64_tr_b16 a[188:189], v151 offset:24576
  s_min_u32 s98, s98, s100
  s_sub_u32 s53, s51, s98
  s_sub_u32 s51, s53, 1
  v_sub_u32 v137, s51, v128
  v_mfma_f32_16x16x32_bf16 v[88:91], a[172:175], a[24:27], v[88:91]
  s_barrier
  v_sub_u32 v138, s51, v129
  v_min_u32 v136, v137, v138
  v_mfma_f32_16x16x32_bf16 v[92:95], a[172:175], a[28:31], v[92:95]
  ds_read_b64_tr_b16 a[190:191], v151 offset:25600
  v_sub_u32 v139, s51, v130
  v_mfma_f32_16x16x32_bf16 v[92:95], a[168:171], a[12:15], v[92:95]
  s_waitcnt lgkmcnt(4)
  v_sub_u32 v140, s51, v131
  v_min3_u32 v136, v136, v139, v140
  v_mfma_f32_16x16x32_bf16 v[96:99], a[176:179], a[0:3], v[96:99]
  ds_read_b64_tr_b16 a[160:161], v144 offset:0
  v_sub_u32 v137, s51, v132
  v_mfma_f32_16x16x32_bf16 v[96:99], a[180:183], a[16:19], v[96:99]
  buffer_load_dwordx4 a[120:123], v243, s[24:27], s30 offen offset:2048 sc1
  v_mfma_f32_16x16x32_bf16 v[100:103], a[180:183], a[20:23], v[100:103]
  ds_read_b64_tr_b16 a[162:163], v144 offset:1024
  v_sub_u32 v138, s51, v133
  v_mfma_f32_16x16x32_bf16 v[100:103], a[176:179], a[4:7], v[100:103]
  v_min3_u32 v136, v136, v137, v138
  v_sub_u32 v139, s51, v134
  v_mfma_f32_16x16x32_bf16 v[104:107], a[176:179], a[8:11], v[104:107]
  ds_read_b64_tr_b16 a[164:165], v144 offset:8192
  v_sub_u32 v140, s51, v135
  v_mfma_f32_16x16x32_bf16 v[104:107], a[180:183], a[24:27], v[104:107]
  buffer_load_dwordx4 v241, s[20:23], s31 offen offset:3072 lds
  s_add_u32 s31, s31, 0x80000
  v_mfma_f32_16x16x32_bf16 v[108:111], a[180:183], a[28:31], v[108:111]
  ds_read_b64_tr_b16 a[166:167], v144 offset:9216
  v_min3_u32 v136, v136, v139, v140
  v_mfma_f32_16x16x32_bf16 v[108:111], a[176:179], a[12:15], v[108:111]
  s_waitcnt lgkmcnt(4)
  v_min_u32_dpp v136, v136, v136 row_ror:8 row_mask:0xf bank_mask:0xf
  v_mfma_f32_16x16x32_bf16 v[112:115], a[184:187], a[0:3], v[112:115]
  ds_read_b64_tr_b16 a[168:169], v145 offset:0
  v_min_u32_dpp v136, v136, v136 row_ror:4 row_mask:0xf bank_mask:0xf
  v_mfma_f32_16x16x32_bf16 v[112:115], a[188:191], a[16:19], v[112:115]
  buffer_load_dwordx4 a[124:127], v243, s[24:27], s30 offen offset:3072 sc1
  s_add_u32 s30, s30, 8192
  v_mfma_f32_16x16x32_bf16 v[116:119], a[188:191], a[20:23], v[116:119]
  ds_read_b64_tr_b16 a[170:171], v145 offset:1024
  v_min_u32_dpp v136, v136, v136 row_ror:2 row_mask:0xf bank_mask:0xf
  v_mfma_f32_16x16x32_bf16 v[116:119], a[184:187], a[4:7], v[116:119]
  v_mfma_f32_16x16x32_bf16 v[120:123], a[184:187], a[8:11], v[120:123]
  ds_read_b64_tr_b16 a[172:173], v145 offset:8192
  v_min_u32_dpp v136, v136, v136 row_ror:1 row_mask:0xf bank_mask:0xf
  v_mfma_f32_16x16x32_bf16 v[120:123], a[188:191], a[24:27], v[120:123]
  v_readlane_b32 s98, v136, 0
  v_readlane_b32 s99, v136, 16
  v_mfma_f32_16x16x32_bf16 v[124:127], a[188:191], a[28:31], v[124:127]
  ds_read_b64_tr_b16 a[174:175], v145 offset:9216
  v_readlane_b32 s100, v136, 32
  v_mfma_f32_16x16x32_bf16 v[124:127], a[184:187], a[12:15], v[124:127]
  s_waitcnt vmcnt(24) lgkmcnt(4)
  v_readlane_b32 s101, v136, 48
  v_mfma_f32_16x16x32_bf16 v[0:3], a[160:163], a[32:35], v[0:3]
  ds_read_b64_tr_b16 a[176:177], v146 offset:0
  s_min_u32 s98, s98, s99
  s_min_u32 s100, s100, s101
  s_min_u32 s98, s98, s100
  v_mfma_f32_16x16x32_bf16 v[0:3], a[164:167], a[48:51], v[0:3]
  buffer_load_dwordx4 a[0:3], v242, s[24:27], s30 offen offset:0 sc1
  s_sub_u32 s54, s51, s98
  s_sub_u32 s51, s54, 1
  v_mfma_f32_16x16x32_bf16 v[4:7], a[164:167], a[52:55], v[4:7]
  ds_read_b64_tr_b16 a[178:179], v146 offset:1024
  v_sub_u32 v137, s51, v128
  v_mfma_f32_16x16x32_bf16 v[4:7], a[160:163], a[36:39], v[4:7]
  v_sub_u32 v138, s51, v129
  v_min_u32 v136, v137, v138
  v_mfma_f32_16x16x32_bf16 v[8:11], a[160:163], a[40:43], v[8:11]
  ds_read_b64_tr_b16 a[180:181], v146 offset:8192
  s_add_u32 m0, s28, 98304
  v_sub_u32 v139, s51, v130
  v_mfma_f32_16x16x32_bf16 v[8:11], a[164:167], a[56:59], v[8:11]
  buffer_load_dwordx4 v238, s[20:23], s31 offen offset:0 lds
  v_mfma_f32_16x16x32_bf16 v[12:15], a[164:167], a[60:63], v[12:15]
  ds_read_b64_tr_b16 a[182:183], v146 offset:9216
  v_sub_u32 v140, s51, v131
  v_mfma_f32_16x16x32_bf16 v[12:15], a[160:163], a[44:47], v[12:15]
  s_waitcnt lgkmcnt(4)
  v_min3_u32 v136, v136, v139, v140
  v_sub_u32 v137, s51, v132
  v_mfma_f32_16x16x32_bf16 v[16:19], a[168:171], a[32:35], v[16:19]
  ds_read_b64_tr_b16 a[184:185], v147 offset:0
  v_sub_u32 v138, s51, v133
  v_mfma_f32_16x16x32_bf16 v[16:19], a[172:175], a[48:51], v[16:19]
  buffer_load_dwordx4 a[4:7], v242, s[24:27], s30 offen offset:1024 sc1
  v_mfma_f32_16x16x32_bf16 v[20:23], a[172:175], a[52:55], v[20:23]
  ds_read_b64_tr_b16 a[186:187], v147 offset:1024
  v_min3_u32 v136, v136, v137, v138
  v_mfma_f32_16x16x32_bf16 v[20:23], a[168:171], a[36:39], v[20:23]
  v_sub_u32 v139, s51, v134
  v_sub_u32 v140, s51, v135
  v_mfma_f32_16x16x32_bf16 v[24:27], a[168:171], a[40:43], v[24:27]
  ds_read_b64_tr_b16 a[188:189], v147 offset:8192
  v_min3_u32 v136, v136, v139, v140
  v_mfma_f32_16x16x32_bf16 v[24:27], a[172:175], a[56:59], v[24:27]
  v_mfma_f32_16x16x32_bf16 v[28:31], a[172:175], a[60:63], v[28:31]
  ds_read_b64_tr_b16 a[190:191], v147 offset:9216
  v_min_u32_dpp v136, v136, v136 row_ror:8 row_mask:0xf bank_mask:0xf
  v_mfma_f32_16x16x32_bf16 v[28:31], a[168:171], a[44:47], v[28:31]
  s_waitcnt lgkmcnt(4)
  v_min_u32_dpp v136, v136, v136 row_ror:4 row_mask:0xf bank_mask:0xf
  v_mfma_f32_16x16x32_bf16 v[32:35], a[176:179], a[32:35], v[32:35]
  ds_read_b64_tr_b16 a[160:161], v148 offset:0
  v_min_u32_dpp v136, v136, v136 row_ror:2 row_mask:0xf bank_mask:0xf
  v_mfma_f32_16x16x32_bf16 v[32:35], a[180:183], a[48:51], v[32:35]
  buffer_load_dwordx4 a[8:11], v242, s[24:27], s30 offen offset:2048 sc1
  v_mfma_f32_16x16x32_bf16 v[36:39], a[180:183], a[52:55], v[36:39]
  ds_read_b64_tr_b16 a[162:163], v148 offset:1024
  v_min_u32_dpp v136, v136, v136 row_ror:1 row_mask:0xf bank_mask:0xf
  v_mfma_f32_16x16x32_bf16 v[36:39], a[176:179], a[36:39], v[36:39]
  v_readlane_b32 s98, v136, 0
  v_readlane_b32 s99, v136, 16
  v_mfma_f32_16x16x32_bf16 v[40:43], a[176:179], a[40:43], v[40:43]
  ds_read_b64_tr_b16 a[164:165], v148 offset:8192
  v_readlane_b32 s100, v136, 32
  v_mfma_f32_16x16x32_bf16 v[40:43], a[180:183], a[56:59], v[40:43]
  buffer_load_dwordx4 v239, s[20:23], s31 offen offset:1024 lds
  v_mfma_f32_16x16x32_bf16 v[44:47], a[180:183], a[60:63], v[44:47]
  ds_read_b64_tr_b16 a[166:167], v148 offset:9216
  v_readlane_b32 s101, v136, 48
  v_mfma_f32_16x16x32_bf16 v[44:47], a[176:179], a[44:47], v[44:47]
  s_waitcnt lgkmcnt(4)
  s_min_u32 s98, s98, s99
  s_min_u32 s100, s100, s101
  v_mfma_f32_16x16x32_bf16 v[48:51], a[184:187], a[32:35], v[48:51]
  ds_read_b64_tr_b16 a[168:169], v149 offset:0
  s_min_u32 s98, s98, s100
  s_sub_u32 s55, s51, s98
  s_sub_u32 s51, s55, 1
  v_sub_u32 v137, s51, v128
  v_mfma_f32_16x16x32_bf16 v[48:51], a[188:191], a[48:51], v[48:51]
  buffer_load_dwordx4 a[12:15], v242, s[24:27], s30 offen offset:3072 sc1
  v_mfma_f32_16x16x32_bf16 v[52:55], a[188:191], a[52:55], v[52:55]
  ds_read_b64_tr_b16 a[170:171], v149 offset:1024
  v_sub_u32 v138, s51, v129
  v_mfma_f32_16x16x32_bf16 v[52:55], a[184:187], a[36:39], v[52:55]
  v_min_u32 v136, v137, v138
  v_sub_u32 v139, s51, v130
  v_mfma_f32_16x16x32_bf16 v[56:59], a[184:187], a[40:43], v[56:59]
  ds_read_b64_tr_b16 a[172:173], v149 offset:8192
  v_sub_u32 v140, s51, v131
  v_mfma_f32_16x16x32_bf16 v[56:59], a[188:191], a[56:59], v[56:59]
  v_min3_u32 v136, v136, v139, v140
  v_sub_u32 v137, s51, v132
  v_mfma_f32_16x16x32_bf16 v[60:63], a[188:191], a[60:63], v[60:63]
  ds_read_b64_tr_b16 a[174:175], v149 offset:9216
  v_sub_u32 v138, s51, v133
  v_mfma_f32_16x16x32_bf16 v[60:63], a[184:187], a[44:47], v[60:63]
  s_waitcnt lgkmcnt(4)
  v_min3_u32 v136, v136, v137, v138
  v_sub_u32 v139, s51, v134
  v_mfma_f32_16x16x32_bf16 v[64:67], a[160:163], a[32:35], v[64:67]
  ds_read_b64_tr_b16 a[176:177], v150 offset:0
  v_sub_u32 v140, s51, v135
  v_mfma_f32_16x16x32_bf16 v[64:67], a[164:167], a[48:51], v[64:67]
  buffer_load_dwordx4 a[16:19], v243, s[24:27], s30 offen offset:0 sc1
  v_mfma_f32_16x16x32_bf16 v[68:71], a[164:167], a[52:55], v[68:71]
  ds_read_b64_tr_b16 a[178:179], v150 offset:1024
  v_min3_u32 v136, v136, v139, v140
  v_mfma_f32_16x16x32_bf16 v[68:71], a[160:163], a[36:39], v[68:71]
  v_mfma_f32_16x16x32_bf16 v[72:75], a[160:163], a[40:43], v[72:75]
  ds_read_b64_tr_b16 a[180:181], v150 offset:8192
  v_min_u32_dpp v136, v136, v136 row_ror:8 row_mask:0xf bank_mask:0xf
  v_mfma_f32_16x16x32_bf16 v[72:75], a[164:167], a[56:59], v[72:75]
  buffer_load_dwordx4 v240, s[20:23], s31 offen offset:2048 lds
  v_mfma_f32_16x16x32_bf16 v[76:79], a[164:167], a[60:63], v[76:79]
  ds_read_b64_tr_b16 a[182:183], v150 offset:9216
  v_min_u32_dpp v136, v136, v136 row_ror:4 row_mask:0xf bank_mask:0xf
  v_mfma_f32_16x16x32_bf16 v[76:79], a[160:163], a[44:47], v[76:79]
  s_waitcnt lgkmcnt(4)
  v_min_u32_dpp v136, v136, v136 row_ror:2 row_mask:0xf bank_mask:0xf
  v_mfma_f32_16x16x32_bf16 v[80:83], a[168:171], a[32:35], v[80:83]
  ds_read_b64_tr_b16 a[184:185], v151 offset:0
  v_min_u32_dpp v136, v136, v136 row_ror:1 row_mask:0xf bank_mask:0xf
  v_mfma_f32_16x16x32_bf16 v[80:83], a[172:175], a[48:51], v[80:83]
  buffer_load_dwordx4 a[20:23], v243, s[24:27], s30 offen offset:1024 sc1
  v_mfma_f32_16x16x32_bf16 v[84:87], a[172:175], a[52:55], v[84:87]
  ds_read_b64_tr_b16 a[186:187], v151 offset:1024
  v_readlane_b32 s98, v136, 0
  v_mfma_f32_16x16x32_bf16 v[84:87], a[168:171], a[36:39], v[84:87]
  s_waitcnt vmcnt(22)
  v_readlane_b32 s99, v136, 16
  v_readlane_b32 s100, v136, 32
  v_mfma_f32_16x16x32_bf16 v[88:91], a[168:171], a[40:43], v[88:91]
  ds_read_b64_tr_b16 a[188:189], v151 offset:8192
  v_readlane_b32 s101, v136, 48
  v_mfma_f32_16x16x32_bf16 v[88:91], a[172:175], a[56:59], v[88:91]
  s_barrier
  s_min_u32 s98, s98, s99
  s_min_u32 s100, s100, s101
  v_mfma_f32_16x16x32_bf16 v[92:95], a[172:175], a[60:63], v[92:95]
  ds_read_b64_tr_b16 a[190:191], v151 offset:9216
  s_min_u32 s98, s98, s100
  s_sub_u32 s56, s51, s98
  s_sub_u32 s51, s56, 1
  v_sub_u32 v137, s51, v128
  v_mfma_f32_16x16x32_bf16 v[92:95], a[168:171], a[44:47], v[92:95]
  s_waitcnt lgkmcnt(4)
  v_sub_u32 v138, s51, v129
  v_min_u32 v136, v137, v138
  v_mfma_f32_16x16x32_bf16 v[96:99], a[176:179], a[32:35], v[96:99]
  ds_read_b64_tr_b16 a[160:161], v224 offset:0
  v_sub_u32 v139, s51, v130
  v_mfma_f32_16x16x32_bf16 v[96:99], a[180:183], a[48:51], v[96:99]
  buffer_load_dwordx4 a[24:27], v243, s[24:27], s30 offen offset:2048 sc1
  v_mfma_f32_16x16x32_bf16 v[100:103], a[180:183], a[52:55], v[100:103]
  ds_read_b64_tr_b16 a[162:163], v224 offset:1024
  v_sub_u32 v140, s51, v131
  v_mfma_f32_16x16x32_bf16 v[100:103], a[176:179], a[36:39], v[100:103]
  v_min3_u32 v136, v136, v139, v140
  v_sub_u32 v137, s51, v132
  v_mfma_f32_16x16x32_bf16 v[104:107], a[176:179], a[40:43], v[104:107]
  ds_read_b64_tr_b16 a[164:165], v224 offset:8192
  v_sub_u32 v138, s51, v133
  v_mfma_f32_16x16x32_bf16 v[104:107], a[180:183], a[56:59], v[104:107]
  buffer_load_dwordx4 v241, s[20:23], s31 offen offset:3072 lds
  s_add_u32 s31, s31, 0x80000
  v_mfma_f32_16x16x32_bf16 v[108:111], a[180:183], a[60:63], v[108:111]
  ds_read_b64_tr_b16 a[166:167], v224 offset:9216
  v_min3_u32 v136, v136, v137, v138
  v_mfma_f32_16x16x32_bf16 v[108:111], a[176:179], a[44:47], v[108:111]
  s_waitcnt lgkmcnt(4)
  v_sub_u32 v139, s51, v134
  v_sub_u32 v140, s51, v135
  v_mfma_f32_16x16x32_bf16 v[112:115], a[184:187], a[32:35], v[112:115]
  ds_read_b64_tr_b16 a[168:169], v225 offset:0
  v_min3_u32 v136, v136, v139, v140
  v_mfma_f32_16x16x32_bf16 v[112:115], a[188:191], a[48:51], v[112:115]
  buffer_load_dwordx4 a[28:31], v243, s[24:27], s30 offen offset:3072 sc1
  s_add_u32 s30, s30, 8192
  v_mfma_f32_16x16x32_bf16 v[116:119], a[188:191], a[52:55], v[116:119]
  ds_read_b64_tr_b16 a[170:171], v225 offset:1024
  v_min_u32_dpp v136, v136, v136 row_ror:8 row_mask:0xf bank_mask:0xf
  v_mfma_f32_16x16x32_bf16 v[116:119], a[184:187], a[36:39], v[116:119]
  v_mfma_f32_16x16x32_bf16 v[120:123], a[184:187], a[40:43], v[120:123]
  ds_read_b64_tr_b16 a[172:173], v225 offset:8192
  v_min_u32_dpp v136, v136, v136 row_ror:4 row_mask:0xf bank_mask:0xf
  v_mfma_f32_16x16x32_bf16 v[120:123], a[188:191], a[56:59], v[120:123]
  v_mfma_f32_16x16x32_bf16 v[124:127], a[188:191], a[60:63], v[124:127]
  ds_read_b64_tr_b16 a[174:175], v225 offset:9216
  v_min_u32_dpp v136, v136, v136 row_ror:2 row_mask:0xf bank_mask:0xf
  v_mfma_f32_16x16x32_bf16 v[124:127], a[184:187], a[44:47], v[124:127]
  s_waitcnt vmcnt(24) lgkmcnt(4)
  v_min_u32_dpp v136, v136, v136 row_ror:1 row_mask:0xf bank_mask:0xf
  v_mfma_f32_16x16x32_bf16 v[0:3], a[160:163], a[64:67], v[0:3]
  ds_read_b64_tr_b16 a[176:177], v226 offset:0
  v_readlane_b32 s98, v136, 0
  v_mfma_f32_16x16x32_bf16 v[0:3], a[164:167], a[80:83], v[0:3]
  buffer_load_dwordx4 a[32:35], v242, s[24:27], s30 offen offset:0 sc1
  v_mfma_f32_16x16x32_bf16 v[4:7], a[164:167], a[84:87], v[4:7]
  ds_read_b64_tr_b16 a[178:179], v226 offset:1024
  v_readlane_b32 s99, v136, 16
  v_mfma_f32_16x16x32_bf16 v[4:7], a[160:163], a[68:71], v[4:7]
  v_readlane_b32 s100, v136, 32
  v_readlane_b32 s101, v136, 48
  v_mfma_f32_16x16x32_bf16 v[8:11], a[160:163], a[72:75], v[8:11]
  ds_read_b64_tr_b16 a[180:181], v226 offset:8192
  s_add_u32 m0, s28, 114688
  s_min_u32 s98, s98, s99
  s_min_u32 s100, s100, s101
  v_mfma_f32_16x16x32_bf16 v[8:11], a[164:167], a[88:91], v[8:11]
  buffer_load_dwordx4 v238, s[20:23], s31 offen offset:0 lds
  s_min_u32 s98, s98, s100
  s_sub_u32 s57, s51, s98
  s_sub_u32 s51, s57, 1
  v_mfma_f32_16x16x32_bf16 v[12:15], a[164:167], a[92:95], v[12:15]
  ds_read_b64_tr_b16 a[182:183], v226 offset:9216
  v_sub_u32 v137, s51, v128
  v_mfma_f32_16x16x32_bf16 v[12:15], a[160:163], a[76:79], v[12:15]
  s_waitcnt lgkmcnt(4)
  v_sub_u32 v138, s51, v129
  v_min_u32 v136, v137, v138
  v_mfma_f32_16x16x32_bf16 v[16:19], a[168:171], a[64:67], v[16:19]
  ds_read_b64_tr_b16 a[184:185], v227 offset:0
  v_sub_u32 v139, s51, v130
  v_mfma_f32_16x16x32_bf16 v[16:19], a[172:175], a[80:83], v[16:19]
  buffer_load_dwordx4 a[36:39], v242, s[24:27], s30 offen offset:1024 sc1
  v_mfma_f32_16x16x32_bf16 v[20:23], a[172:175], a[84:87], v[20:23]
  ds_read_b64_tr_b16 a[186:187], v227 offset:1024
  v_sub_u32 v140, s51, v131
  v_mfma_f32_16x16x32_bf16 v[20:23], a[168:171], a[68:71], v[20:23]
  v_min3_u32 v136, v136, v139, v140
  v_sub_u32 v137, s51, v132
  v_mfma_f32_16x16x32_bf16 v[24:27], a[168:171], a[72:75], v[24:27]
  ds_read_b64_tr_b16 a[188:189], v227 offset:8192
  v_sub_u32 v138, s51, v133
  v_mfma_f32_16x16x32_bf16 v[24:27], a[172:175], a[88:91], v[24:27]
  v_min3_u32 v136, v136, v137, v138
  v_sub_u32 v139, s51, v134
  v_mfma_f32_16x16x32_bf16 v[28:31], a[172:175], a[92:95], v[28:31]
  ds_read_b64_tr_b16 a[190:191], v227 offset:9216
  v_sub_u32 v140, s51, v135
  v_mfma_f32_16x16x32_bf16 v[28:31], a[168:171], a[76:79], v[28:31]
  s_waitcnt lgkmcnt(4)
  v_min3_u32 v136, v136, v139, v140
  v_mfma_f32_16x16x32_bf16 v[32:35], a[176:179], a[64:67], v[32:35]
  ds_read_b64_tr_b16 a[160:161], v228 offset:0
  v_min_u32_dpp v136, v136, v136 row_ror:8 row_mask:0xf bank_mask:0xf
  v_mfma_f32_16x16x32_bf16 v[32:35], a[180:183], a[80:83], v[32:35]
  buffer_load_dwordx4 a[40:43], v242, s[24:27], s30 offen offset:2048 sc1
  v_mfma_f32_16x16x32_bf16 v[36:39], a[180:183], a[84:87], v[36:39]
  ds_read_b64_tr_b16 a[162:163], v228 offset:1024
  v_min_u32_dpp v136, v136, v136 row_ror:4 row_mask:0xf bank_mask:0xf
  v_mfma_f32_16x16x32_bf16 v[36:39], a[176:179], a[68:71], v[36:39]
  v_mfma_f32_16x16x32_bf16 v[40:43], a[176:179], a[72:75], v[40:43]
  ds_read_b64_tr_b16 a[164:165], v228 offset:8192
  v_min_u32_dpp v136, v136, v136 row_ror:2 row_mask:0xf bank_mask:0xf
  v_mfma_f32_16x16x32_bf16 v[40:43], a[180:183], a[88:91], v[40:43]
  buffer_load_dwordx4 v239, s[20:23], s31 offen offset:1024 lds
  v_mfma_f32_16x16x32_bf16 v[44:47], a[180:183], a[92:95], v[44:47]
  ds_read_b64_tr_b16 a[166:167], v228 offset:9216
  v_min_u32_dpp v136, v136, v136 row_ror:1 row_mask:0xf bank_mask:0xf
  v_mfma_f32_16x16x32_bf16 v[44:47], a[176:179], a[76:79], v[44:47]
  s_waitcnt lgkmcnt(4)
  v_readlane_b32 s98, v136, 0
  v_readlane_b32 s99, v136, 16
  v_mfma_f32_16x16x32_bf16 v[48:51], a[184:187], a[64:67], v[48:51]
  ds_read_b64_tr_b16 a[168:169], v229 offset:0
  v_readlane_b32 s100, v136, 32
  v_mfma_f32_16x16x32_bf16 v[48:51], a[188:191], a[80:83], v[48:51]
  buffer_load_dwordx4 a[44:47], v242, s[24:27], s30 offen offset:3072 sc1
  v_mfma_f32_16x16x32_bf16 v[52:55], a[188:191], a[84:87], v[52:55]
  ds_read_b64_tr_b16 a[170:171], v229 offset:1024
  v_readlane_b32 s101, v136, 48
  v_mfma_f32_16x16x32_bf16 v[52:55], a[184:187], a[68:71], v[52:55]
  s_min_u32 s98, s98, s99
  s_min_u32 s100, s100, s101
  s_min_u32 s98, s98, s100
  v_mfma_f32_16x16x32_bf16 v[56:59], a[184:187], a[72:75], v[56:59]
  ds_read_b64_tr_b16 a[172:173], v229 offset:8192
  s_sub_u32 s58, s51, s98
  s_sub_u32 s51, s58, 1
  v_sub_u32 v137, s51, v128
  v_mfma_f32_16x16x32_bf16 v[56:59], a[188:191], a[88:91], v[56:59]
  v_sub_u32 v138, s51, v129
  v_min_u32 v136, v137, v138
  v_mfma_f32_16x16x32_bf16 v[60:63], a[188:191], a[92:95], v[60:63]
  ds_read_b64_tr_b16 a[174:175], v229 offset:9216
  v_sub_u32 v139, s51, v130
  v_mfma_f32_16x16x32_bf16 v[60:63], a[184:187], a[76:79], v[60:63]
  s_waitcnt lgkmcnt(4)
  v_sub_u32 v140, s51, v131
  v_min3_u32 v136, v136, v139, v140
  v_mfma_f32_16x16x32_bf16 v[64:67], a[160:163], a[64:67], v[64:67]
  ds_read_b64_tr_b16 a[176:177], v230 offset:0
  v_sub_u32 v137, s51, v132
  v_mfma_f32_16x16x32_bf16 v[64:67], a[164:167], a[80:83], v[64:67]
  buffer_load_dwordx4 a[48:51], v243, s[24:27], s30 offen offset:0 sc1
  v_mfma_f32_16x16x32_bf16 v[68:71], a[164:167], a[84:87], v[68:71]
  ds_read_b64_tr_b16 a[178:179], v230 offset:1024
  v_sub_u32 v138, s51, v133
  v_mfma_f32_16x16x32_bf16 v[68:71], a[160:163], a[68:71], v[68:71]
  v_min3_u32 v136, v136, v137, v138
  v_sub_u32 v139, s51, v134
  v_mfma_f32_16x16x32_bf16 v[72:75], a[160:163], a[72:75], v[72:75]
  ds_read_b64_tr_b16 a[180:181], v230 offset:8192
  v_sub_u32 v140, s51, v135
  v_mfma_f32_16x16x32_bf16 v[72:75], a[164:167], a[88:91], v[72:75]
  buffer_load_dwordx4 v240, s[20:23], s31 offen offset:2048 lds
  v_mfma_f32_16x16x32_bf16 v[76:79], a[164:167], a[92:95], v[76:79]
  ds_read_b64_tr_b16 a[182:183], v230 offset:9216
  v_min3_u32 v136, v136, v139, v140
  v_mfma_f32_16x16x32_bf16 v[76:79], a[160:163], a[76:79], v[76:79]
  s_waitcnt lgkmcnt(4)
  v_min_u32_dpp v136, v136, v136 row_ror:8 row_mask:0xf bank_mask:0xf
  v_mfma_f32_16x16x32_bf16 v[80:83], a[168:171], a[64:67], v[80:83]
  ds_read_b64_tr_b16 a[184:185], v231 offset:0
  v_min_u32_dpp v136, v136, v136 row_ror:4 row_mask:0xf bank_mask:0xf
  v_mfma_f32_16x16x32_bf16 v[80:83], a[172:175], a[80:83], v[80:83]
  buffer_load_dwordx4 a[52:55], v243, s[24:27], s30 offen offset:1024 sc1
  v_mfma_f32_16x16x32_bf16 v[84:87], a[172:175], a[84:87], v[84:87]
  ds_read_b64_tr_b16 a[186:187], v231 offset:1024
  v_min_u32_dpp v136, v136, v136 row_ror:2 row_mask:0xf bank_mask:0xf
  v_mfma_f32_16x16x32_bf16 v[84:87], a[168:171], a[68:71], v[84:87]
  s_waitcnt vmcnt(22)
  v_min_u32_dpp v136, v136, v136 row_ror:1 row_mask:0xf bank_mask:0xf
  v_mfma_f32_16x16x32_bf16 v[88:91], a[168:171], a[72:75], v[88:91]
  ds_read_b64_tr_b16 a[188:189], v231 offset:8192
  v_readlane_b32 s98, v136, 0
  v_readlane_b32 s99, v136, 16
  v_readlane_b32 s100, v136, 32
  v_readlane_b32 s101, v136, 48
  s_min_u32 s98, s98, s99
  s_min_u32 s100, s100, s101
  s_min_u32 s98, s98, s100
  s_sub_u32 s59, s51, s98
  s_sub_u32 s51, s59, 1
  v_writelane_b32 v136, s52, 0
  v_writelane_b32 v136, s53, 1
  v_writelane_b32 v136, s54, 2
  v_writelane_b32 v136, s55, 3
  v_writelane_b32 v136, s56, 4
  v_writelane_b32 v136, s57, 5
  v_writelane_b32 v136, s58, 6
  v_writelane_b32 v136, s59, 7
  s_lshl_b32 s35, s3, 8
  s_add_u32 s35, s35, 158720
  v_lshrrev_b32 v137, 2, v242
  v_add_u32 v137, s35, v137
  ds_write_b32 v137, v136
  s_waitcnt lgkmcnt(0)
  v_mfma_f32_16x16x32_bf16 v[88:91], a[172:175], a[88:91], v[88:91]
  s_barrier
  v_mfma_f32_16x16x32_bf16 v[92:95], a[172:175], a[92:95], v[92:95]
  ds_read_b64_tr_b16 a[190:191], v231 offset:9216
  v_mfma_f32_16x16x32_bf16 v[92:95], a[168:171], a[76:79], v[92:95]
  v_mfma_f32_16x16x32_bf16 v[96:99], a[176:179], a[64:67], v[96:99]
  ds_read_b64_tr_b16 a[160:161], v224 offset:16384
  v_mfma_f32_16x16x32_bf16 v[96:99], a[180:183], a[80:83], v[96:99]
  buffer_load_dwordx4 a[56:59], v243, s[24:27], s30 offen offset:2048 sc1
  v_mfma_f32_16x16x32_bf16 v[100:103], a[180:183], a[84:87], v[100:103]
  ds_read_b64_tr_b16 a[162:163], v224 offset:17408
  v_mfma_f32_16x16x32_bf16 v[100:103], a[176:179], a[68:71], v[100:103]
  v_mfma_f32_16x16x32_bf16 v[104:107], a[176:179], a[72:75], v[104:107]
  ds_read_b64_tr_b16 a[164:165], v224 offset:24576
  v_mfma_f32_16x16x32_bf16 v[104:107], a[180:183], a[88:91], v[104:107]
  buffer_load_dwordx4 v241, s[20:23], s31 offen offset:3072 lds
  s_add_u32 s31, s31, 0x80000
  v_mfma_f32_16x16x32_bf16 v[108:111], a[180:183], a[92:95], v[108:111]
  ds_read_b64_tr_b16 a[166:167], v224 offset:25600
  v_mfma_f32_16x16x32_bf16 v[108:111], a[176:179], a[76:79], v[108:111]
  s_waitcnt lgkmcnt(4)
  v_mfma_f32_16x16x32_bf16 v[112:115], a[184:187], a[64:67], v[112:115]
  ds_read_b64_tr_b16 a[168:169], v225 offset:16384
  v_mfma_f32_16x16x32_bf16 v[112:115], a[188:191], a[80:83], v[112:115]
  buffer_load_dwordx4 a[60:63], v243, s[24:27], s30 offen offset:3072 sc1
  s_add_u32 s30, s30, 8192
  v_mfma_f32_16x16x32_bf16 v[116:119], a[188:191], a[84:87], v[116:119]
  ds_read_b64_tr_b16 a[170:171], v225 offset:17408
  v_mfma_f32_16x16x32_bf16 v[116:119], a[184:187], a[68:71], v[116:119]
  v_mfma_f32_16x16x32_bf16 v[120:123], a[184:187], a[72:75], v[120:123]
  ds_read_b64_tr_b16 a[172:173], v225 offset:24576
  v_mfma_f32_16x16x32_bf16 v[120:123], a[188:191], a[88:91], v[120:123]
  v_mfma_f32_16x16x32_bf16 v[124:127], a[188:191], a[92:95], v[124:127]
  ds_read_b64_tr_b16 a[174:175], v225 offset:25600
  v_mfma_f32_16x16x32_bf16 v[124:127], a[184:187], a[76:79], v[124:127]
  s_waitcnt vmcnt(24) lgkmcnt(4)
  v_mfma_f32_16x16x32_bf16 v[0:3], a[160:163], a[96:99], v[0:3]
  ds_read_b64_tr_b16 a[176:177], v226 offset:16384
  v_lshrrev_b32 v136, 4, v242
  v_mfma_f32_16x16x32_bf16 v[0:3], a[164:167], a[112:115], v[0:3]
  v_bfe_u32 v137, v136, 3, 2
  v_and_b32 v138, 7, v136
  v_mfma_f32_16x16x32_bf16 v[4:7], a[164:167], a[116:119], v[4:7]
  ds_read_b64_tr_b16 a[178:179], v226 offset:17408
  v_lshlrev_b32 v137, 8, v137
  v_mfma_f32_16x16x32_bf16 v[4:7], a[160:163], a[100:103], v[4:7]
  v_lshl_add_u32 v137, v138, 2, v137
  v_add_u32 v137, 158720, v137
  v_mfma_f32_16x16x32_bf16 v[8:11], a[160:163], a[104:107], v[8:11]
  ds_read_b64_tr_b16 a[180:181], v226 offset:24576
  s_add_u32 m0, s28, 0
  ds_read_b32 v128, v137
  v_mfma_f32_16x16x32_bf16 v[8:11], a[164:167], a[120:123], v[8:11]
  buffer_load_dwordx4 v232, s[12:15], s29 offen offset:0 lds
  v_mfma_f32_16x16x32_bf16 v[12:15], a[164:167], a[124:127], v[12:15]
  ds_read_b64_tr_b16 a[182:183], v226 offset:25600
  v_mfma_f32_16x16x32_bf16 v[12:15], a[160:163], a[108:111], v[12:15]
  s_waitcnt lgkmcnt(5)
  v_mfma_f32_16x16x32_bf16 v[16:19], a[168:171], a[96:99], v[16:19]
  ds_read_b64_tr_b16 a[184:185], v227 offset:16384
  v_mfma_f32_16x16x32_bf16 v[16:19], a[172:175], a[112:115], v[16:19]
  v_mfma_f32_16x16x32_bf16 v[20:23], a[172:175], a[116:119], v[20:23]
  ds_read_b64_tr_b16 a[186:187], v227 offset:17408
  v_mfma_f32_16x16x32_bf16 v[20:23], a[168:171], a[100:103], v[20:23]
  v_mfma_f32_16x16x32_bf16 v[24:27], a[168:171], a[104:107], v[24:27]
  ds_read_b64_tr_b16 a[188:189], v227 offset:24576
  s_waitcnt lgkmcnt(4)
  s_mov_b32 s51, -1
  v_sub_u32 v137, s51, v128
  v_mfma_f32_16x16x32_bf16 v[24:27], a[172:175], a[120:123], v[24:27]
  v_mfma_f32_16x16x32_bf16 v[28:31], a[172:175], a[124:127], v[28:31]
  ds_read_b64_tr_b16 a[190:191], v227 offset:25600
  v_min_u32_dpp v137, v137, v137 row_ror:8 row_mask:0xf bank_mask:0xf
  v_mfma_f32_16x16x32_bf16 v[28:31], a[168:171], a[108:111], v[28:31]
  s_waitcnt lgkmcnt(4)
  v_min_u32_dpp v137, v137, v137 row_ror:4 row_mask:0xf bank_mask:0xf
  v_mfma_f32_16x16x32_bf16 v[32:35], a[176:179], a[96:99], v[32:35]
  ds_read_b64_tr_b16 a[160:161], v228 offset:16384
  v_min_u32_dpp v137, v137, v137 row_ror:2 row_mask:0xf bank_mask:0xf
  v_mfma_f32_16x16x32_bf16 v[32:35], a[180:183], a[112:115], v[32:35]
  v_mfma_f32_16x16x32_bf16 v[36:39], a[180:183], a[116:119], v[36:39]
  ds_read_b64_tr_b16 a[162:163], v228 offset:17408
  v_min_u32_dpp v137, v137, v137 row_ror:1 row_mask:0xf bank_mask:0xf
  v_mfma_f32_16x16x32_bf16 v[36:39], a[176:179], a[100:103], v[36:39]
  v_readlane_b32 s98, v137, 0
  v_readlane_b32 s99, v137, 16
  v_mfma_f32_16x16x32_bf16 v[40:43], a[176:179], a[104:107], v[40:43]
  ds_read_b64_tr_b16 a[164:165], v228 offset:24576
  s_min_u32 s98, s98, s99
  s_sub_u32 s52, s51, s98
  s_sub_u32 s51, s52, 1
  v_sub_u32 v137, s51, v128
  v_mfma_f32_16x16x32_bf16 v[40:43], a[180:183], a[120:123], v[40:43]
  buffer_load_dwordx4 v233, s[12:15], s29 offen offset:1024 lds
  v_mfma_f32_16x16x32_bf16 v[44:47], a[180:183], a[124:127], v[44:47]
  ds_read_b64_tr_b16 a[166:167], v228 offset:25600
  v_min_u32_dpp v137, v137, v137 row_ror:8 row_mask:0xf bank_mask:0xf
  v_mfma_f32_16x16x32_bf16 v[44:47], a[176:179], a[108:111], v[44:47]
  s_waitcnt lgkmcnt(4)
  v_min_u32_dpp v137, v137, v137 row_ror:4 row_mask:0xf bank_mask:0xf
  v_mfma_f32_16x16x32_bf16 v[48:51], a[184:187], a[96:99], v[48:51]
  ds_read_b64_tr_b16 a[168:169], v229 offset:16384
  v_min_u32_dpp v137, v137, v137 row_ror:2 row_mask:0xf bank_mask:0xf
  v_mfma_f32_16x16x32_bf16 v[48:51], a[188:191], a[112:115], v[48:51]
  v_mfma_f32_16x16x32_bf16 v[52:55], a[188:191], a[116:119], v[52:55]
  ds_read_b64_tr_b16 a[170:171], v229 offset:17408
  v_min_u32_dpp v137, v137, v137 row_ror:1 row_mask:0xf bank_mask:0xf
  v_mfma_f32_16x16x32_bf16 v[52:55], a[184:187], a[100:103], v[52:55]
  v_readlane_b32 s98, v137, 0
  v_readlane_b32 s99, v137, 16
  v_mfma_f32_16x16x32_bf16 v[56:59], a[184:187], a[104:107], v[56:59]
  ds_read_b64_tr_b16 a[172:173], v229 offset:24576
  s_min_u32 s98, s98, s99
  s_sub_u32 s53, s51, s98
  s_sub_u32 s51, s53, 1
  v_sub_u32 v137, s51, v128
  v_mfma_f32_16x16x32_bf16 v[56:59], a[188:191], a[120:123], v[56:59]
  v_mfma_f32_16x16x32_bf16 v[60:63], a[188:191], a[124:127], v[60:63]
  ds_read_b64_tr_b16 a[174:175], v229 offset:25600
  v_min_u32_dpp v137, v137, v137 row_ror:8 row_mask:0xf bank_mask:0xf
  v_mfma_f32_16x16x32_bf16 v[60:63], a[184:187], a[108:111], v[60:63]
  s_waitcnt lgkmcnt(4)
  v_min_u32_dpp v137, v137, v137 row_ror:4 row_mask:0xf bank_mask:0xf
  v_mfma_f32_16x16x32_bf16 v[64:67], a[160:163], a[96:99], v[64:67]
  ds_read_b64_tr_b16 a[176:177], v230 offset:16384
  v_min_u32_dpp v137, v137, v137 row_ror:2 row_mask:0xf bank_mask:0xf
  v_mfma_f32_16x16x32_bf16 v[64:67], a[164:167], a[112:115], v[64:67]
  v_mfma_f32_16x16x32_bf16 v[68:71], a[164:167], a[116:119], v[68:71]
  ds_read_b64_tr_b16 a[178:179], v230 offset:17408
  v_min_u32_dpp v137, v137, v137 row_ror:1 row_mask:0xf bank_mask:0xf
  v_mfma_f32_16x16x32_bf16 v[68:71], a[160:163], a[100:103], v[68:71]
  v_readlane_b32 s98, v137, 0
  v_readlane_b32 s99, v137, 16
  v_mfma_f32_16x16x32_bf16 v[72:75], a[160:163], a[104:107], v[72:75]
  ds_read_b64_tr_b16 a[180:181], v230 offset:24576
  s_min_u32 s98, s98, s99
  s_sub_u32 s54, s51, s98
  s_sub_u32 s51, s54, 1
  v_sub_u32 v137, s51, v128
  v_mfma_f32_16x16x32_bf16 v[72:75], a[164:167], a[120:123], v[72:75]
  buffer_load_dwordx4 v234, s[12:15], s29 offen offset:2048 lds
  v_mfma_f32_16x16x32_bf16 v[76:79], a[164:167], a[124:127], v[76:79]
  ds_read_b64_tr_b16 a[182:183], v230 offset:25600
  v_min_u32_dpp v137, v137, v137 row_ror:8 row_mask:0xf bank_mask:0xf
  v_mfma_f32_16x16x32_bf16 v[76:79], a[160:163], a[108:111], v[76:79]
  s_waitcnt lgkmcnt(4)
  v_min_u32_dpp v137, v137, v137 row_ror:4 row_mask:0xf bank_mask:0xf
  v_mfma_f32_16x16x32_bf16 v[80:83], a[168:171], a[96:99], v[80:83]
  ds_read_b64_tr_b16 a[184:185], v231 offset:16384
  v_min_u32_dpp v137, v137, v137 row_ror:2 row_mask:0xf bank_mask:0xf
  v_mfma_f32_16x16x32_bf16 v[80:83], a[172:175], a[112:115], v[80:83]
  v_mfma_f32_16x16x32_bf16 v[84:87], a[172:175], a[116:119], v[84:87]
  ds_read_b64_tr_b16 a[186:187], v231 offset:17408
  v_min_u32_dpp v137, v137, v137 row_ror:1 row_mask:0xf bank_mask:0xf
  v_mfma_f32_16x16x32_bf16 v[84:87], a[168:171], a[100:103], v[84:87]
  s_waitcnt vmcnt(16)
  v_readlane_b32 s98, v137, 0
  v_readlane_b32 s99, v137, 16
  v_mfma_f32_16x16x32_bf16 v[88:91], a[168:171], a[104:107], v[88:91]
  ds_read_b64_tr_b16 a[188:189], v231 offset:24576
  s_min_u32 s98, s98, s99
  s_sub_u32 s55, s51, s98
  s_sub_u32 s51, s55, 1
  v_sub_u32 v137, s51, v128
  v_mfma_f32_16x16x32_bf16 v[88:91], a[172:175], a[120:123], v[88:91]
  s_barrier
  v_min_u32_dpp v137, v137, v137 row_ror:8 row_mask:0xf bank_mask:0xf
  v_mfma_f32_16x16x32_bf16 v[92:95], a[172:175], a[124:127], v[92:95]
  ds_read_b64_tr_b16 a[190:191], v231 offset:25600
  v_min_u32_dpp v137, v137, v137 row_ror:4 row_mask:0xf bank_mask:0xf
  v_mfma_f32_16x16x32_bf16 v[92:95], a[168:171], a[108:111], v[92:95]
  s_waitcnt lgkmcnt(4)
  v_min_u32_dpp v137, v137, v137 row_ror:2 row_mask:0xf bank_mask:0xf
  v_mfma_f32_16x16x32_bf16 v[96:99], a[176:179], a[96:99], v[96:99]
  ds_read_b64_tr_b16 a[160:161], v224 offset:32768
  v_min_u32_dpp v137, v137, v137 row_ror:1 row_mask:0xf bank_mask:0xf
  v_mfma_f32_16x16x32_bf16 v[96:99], a[180:183], a[112:115], v[96:99]
  v_readlane_b32 s98, v137, 0
  v_readlane_b32 s99, v137, 16
  v_mfma_f32_16x16x32_bf16 v[100:103], a[180:183], a[116:119], v[100:103]
  ds_read_b64_tr_b16 a[162:163], v224 offset:33792
  s_min_u32 s98, s98, s99
  s_sub_u32 s56, s51, s98
  s_sub_u32 s51, s56, 1
  v_sub_u32 v137, s51, v128
  v_mfma_f32_16x16x32_bf16 v[100:103], a[176:179], a[100:103], v[100:103]
  v_mfma_f32_16x16x32_bf16 v[104:107], a[176:179], a[104:107], v[104:107]
  ds_read_b64_tr_b16 a[164:165], v224 offset:40960
  v_min_u32_dpp v137, v137, v137 row_ror:8 row_mask:0xf bank_mask:0xf
  v_mfma_f32_16x16x32_bf16 v[104:107], a[180:183], a[120:123], v[104:107]
  buffer_load_dwordx4 v235, s[12:15], s29 offen offset:3072 lds
  v_mfma_f32_16x16x32_bf16 v[108:111], a[180:183], a[124:127], v[108:111]
  ds_read_b64_tr_b16 a[166:167], v224 offset:41984
  v_min_u32_dpp v137, v137, v137 row_ror:4 row_mask:0xf bank_mask:0xf
  v_mfma_f32_16x16x32_bf16 v[108:111], a[176:179], a[108:111], v[108:111]
  s_waitcnt lgkmcnt(4)
  v_min_u32_dpp v137, v137, v137 row_ror:2 row_mask:0xf bank_mask:0xf
  v_mfma_f32_16x16x32_bf16 v[112:115], a[184:187], a[96:99], v[112:115]
  ds_read_b64_tr_b16 a[168:169], v225 offset:32768
  v_min_u32_dpp v137, v137, v137 row_ror:1 row_mask:0xf bank_mask:0xf
  v_mfma_f32_16x16x32_bf16 v[112:115], a[188:191], a[112:115], v[112:115]
  v_readlane_b32 s98, v137, 0
  v_readlane_b32 s99, v137, 16
  v_mfma_f32_16x16x32_bf16 v[116:119], a[188:191], a[116:119], v[116:119]
  ds_read_b64_tr_b16 a[170:171], v225 offset:33792
  s_min_u32 s98, s98, s99
  s_sub_u32 s57, s51, s98
  s_sub_u32 s51, s57, 1
  v_sub_u32 v137, s51, v128
  v_mfma_f32_16x16x32_bf16 v[116:119], a[184:187], a[100:103], v[116:119]
  v_mfma_f32_16x16x32_bf16 v[120:123], a[184:187], a[104:107], v[120:123]
  ds_read_b64_tr_b16 a[172:173], v225 offset:40960
  v_min_u32_dpp v137, v137, v137 row_ror:8 row_mask:0xf bank_mask:0xf
  v_mfma_f32_16x16x32_bf16 v[120:123], a[188:191], a[120:123], v[120:123]
  v_mfma_f32_16x16x32_bf16 v[124:127], a[188:191], a[124:127], v[124:127]
  ds_read_b64_tr_b16 a[174:175], v225 offset:41984
  v_min_u32_dpp v137, v137, v137 row_ror:4 row_mask:0xf bank_mask:0xf
  v_mfma_f32_16x16x32_bf16 v[124:127], a[184:187], a[108:111], v[124:127]
  s_waitcnt vmcnt(16) lgkmcnt(4)
  v_min_u32_dpp v137, v137, v137 row_ror:2 row_mask:0xf bank_mask:0xf
  v_mfma_f32_16x16x32_bf16 v[0:3], a[160:163], a[0:3], v[0:3]
  ds_read_b64_tr_b16 a[176:177], v226 offset:32768
  v_min_u32_dpp v137, v137, v137 row_ror:1 row_mask:0xf bank_mask:0xf
  v_mfma_f32_16x16x32_bf16 v[0:3], a[164:167], a[16:19], v[0:3]
  v_readlane_b32 s98, v137, 0
  v_readlane_b32 s99, v137, 16
  v_mfma_f32_16x16x32_bf16 v[4:7], a[164:167], a[20:23], v[4:7]
  ds_read_b64_tr_b16 a[178:179], v226 offset:33792
  s_min_u32 s98, s98, s99
  s_sub_u32 s58, s51, s98
  s_sub_u32 s51, s58, 1
  v_sub_u32 v137, s51, v128
  v_mfma_f32_16x16x32_bf16 v[4:7], a[160:163], a[4:7], v[4:7]
  v_mfma_f32_16x16x32_bf16 v[8:11], a[160:163], a[8:11], v[8:11]
  ds_read_b64_tr_b16 a[180:181], v226 offset:40960
  s_add_u32 m0, s28, 65536
  v_min_u32_dpp v137, v137, v137 row_ror:8 row_mask:0xf bank_mask:0xf
  v_mfma_f32_16x16x32_bf16 v[8:11], a[164:167], a[24:27], v[8:11]
  buffer_load_dwordx4 v236, s[16:19], s29 offen offset:0 lds
  v_mfma_f32_16x16x32_bf16 v[12:15], a[164:167], a[28:31], v[12:15]
  ds_read_b64_tr_b16 a[182:183], v226 offset:41984
  v_min_u32_dpp v137, v137, v137 row_ror:4 row_mask:0xf bank_mask:0xf
  v_mfma_f32_16x16x32_bf16 v[12:15], a[160:163], a[12:15], v[12:15]
  s_waitcnt lgkmcnt(4)
  v_min_u32_dpp v137, v137, v137 row_ror:2 row_mask:0xf bank_mask:0xf
  v_mfma_f32_16x16x32_bf16 v[16:19], a[168:171], a[0:3], v[16:19]
  ds_read_b64_tr_b16 a[184:185], v227 offset:32768
  v_min_u32_dpp v137, v137, v137 row_ror:1 row_mask:0xf bank_mask:0xf
  v_mfma_f32_16x16x32_bf16 v[16:19], a[172:175], a[16:19], v[16:19]
  v_readlane_b32 s98, v137, 0
  v_readlane_b32 s99, v137, 16
  v_mfma_f32_16x16x32_bf16 v[20:23], a[172:175], a[20:23], v[20:23]
  ds_read_b64_tr_b16 a[186:187], v227 offset:33792
  s_min_u32 s98, s98, s99
  s_sub_u32 s59, s51, s98
  s_sub_u32 s51, s59, 1
  v_mov_b32 v128, 0
  v_mfma_f32_16x16x32_bf16 v[20:23], a[168:171], a[4:7], v[20:23]
  v_writelane_b32 v128, s52, 0
  v_writelane_b32 v128, s53, 1
  v_mfma_f32_16x16x32_bf16 v[24:27], a[168:171], a[8:11], v[24:27]
  ds_read_b64_tr_b16 a[188:189], v227 offset:40960
  v_writelane_b32 v128, s54, 2
  v_mfma_f32_16x16x32_bf16 v[24:27], a[172:175], a[24:27], v[24:27]
  v_writelane_b32 v128, s55, 3
  v_writelane_b32 v128, s56, 4
  v_mfma_f32_16x16x32_bf16 v[28:31], a[172:175], a[28:31], v[28:31]
  ds_read_b64_tr_b16 a[190:191], v227 offset:41984
  v_writelane_b32 v128, s57, 5
  v_mfma_f32_16x16x32_bf16 v[28:31], a[168:171], a[12:15], v[28:31]
  s_waitcnt lgkmcnt(4)
  v_writelane_b32 v128, s58, 6
  v_writelane_b32 v128, s59, 7
  v_mfma_f32_16x16x32_bf16 v[32:35], a[176:179], a[0:3], v[32:35]
  ds_read_b64_tr_b16 a[160:161], v228 offset:32768
  v_and_b32 v129, 0xffff, v128
  v_mfma_f32_16x16x32_bf16 v[32:35], a[180:183], a[16:19], v[32:35]
  v_sub_u32 v129, 0xffff, v129
  v_and_b32 v129, 0x7ff, v129
  v_mfma_f32_16x16x32_bf16 v[36:39], a[180:183], a[20:23], v[36:39]
  ds_read_b64_tr_b16 a[162:163], v228 offset:33792
  v_mov_b32 v130, v129
  v_mfma_f32_16x16x32_bf16 v[36:39], a[176:179], a[4:7], v[36:39]
  v_mfma_f32_16x16x32_bf16 v[40:43], a[176:179], a[8:11], v[40:43]
  ds_read_b64_tr_b16 a[164:165], v228 offset:40960
  v_permlane16_swap_b32 v129, v130
  v_mfma_f32_16x16x32_bf16 v[40:43], a[180:183], a[24:27], v[40:43]
  buffer_load_dwordx4 v237, s[16:19], s29 offen offset:1024 lds
  v_mfma_f32_16x16x32_bf16 v[44:47], a[180:183], a[28:31], v[44:47]
  ds_read_b64_tr_b16 a[166:167], v228 offset:41984
  v_mov_b32 v130, v129
  v_mfma_f32_16x16x32_bf16 v[44:47], a[176:179], a[12:15], v[44:47]
  s_waitcnt lgkmcnt(4)
  v_permlane32_swap_b32 v129, v130
  v_lshrrev_b32 v130, 6, v129
  v_mfma_f32_16x16x32_bf16 v[48:51], a[184:187], a[0:3], v[48:51]
  ds_read_b64_tr_b16 a[168:169], v229 offset:32768
  v_mul_u32_u24 v130, 0x14000, v130
  v_mfma_f32_16x16x32_bf16 v[48:51], a[188:191], a[16:19], v[48:51]
  v_bfe_u32 v131, v129, 4, 2
  v_lshl_add_u32 v130, v131, 10, v130
  v_mfma_f32_16x16x32_bf16 v[52:55], a[188:191], a[20:23], v[52:55]
  ds_read_b64_tr_b16 a[170:171], v229 offset:33792
  v_and_b32 v131, 15, v129
  v_mfma_f32_16x16x32_bf16 v[52:55], a[184:187], a[4:7], v[52:55]
  v_lshl_add_u32 v130, v131, 4, v130
  v_lshrrev_b32 v131, 4, v136
  v_mfma_f32_16x16x32_bf16 v[56:59], a[184:187], a[8:11], v[56:59]
  ds_read_b64_tr_b16 a[172:173], v229 offset:40960
  v_lshl_add_u32 v243, v131, 8, v130
  v_mfma_f32_16x16x32_bf16 v[56:59], a[188:191], a[24:27], v[56:59]
  v_mfma_f32_16x16x32_bf16 v[60:63], a[188:191], a[28:31], v[60:63]
  ds_read_b64_tr_b16 a[174:175], v229 offset:41984
  v_mfma_f32_16x16x32_bf16 v[60:63], a[184:187], a[12:15], v[60:63]
  s_waitcnt lgkmcnt(4)
  v_mfma_f32_16x16x32_bf16 v[64:67], a[160:163], a[0:3], v[64:67]
  ds_read_b64_tr_b16 a[176:177], v230 offset:32768
  v_mfma_f32_16x16x32_bf16 v[64:67], a[164:167], a[16:19], v[64:67]
  v_mfma_f32_16x16x32_bf16 v[68:71], a[164:167], a[20:23], v[68:71]
  ds_read_b64_tr_b16 a[178:179], v230 offset:33792
  v_mfma_f32_16x16x32_bf16 v[68:71], a[160:163], a[4:7], v[68:71]
  v_mfma_f32_16x16x32_bf16 v[72:75], a[160:163], a[8:11], v[72:75]
  ds_read_b64_tr_b16 a[180:181], v230 offset:40960
  v_mfma_f32_16x16x32_bf16 v[72:75], a[164:167], a[24:27], v[72:75]
  buffer_load_dwordx4 v236, s[16:19], s29 offen offset:2048 lds
  v_mfma_f32_16x16x32_bf16 v[76:79], a[164:167], a[28:31], v[76:79]
  ds_read_b64_tr_b16 a[182:183], v230 offset:41984
  v_mfma_f32_16x16x32_bf16 v[76:79], a[160:163], a[12:15], v[76:79]
  s_waitcnt lgkmcnt(4)
  v_mfma_f32_16x16x32_bf16 v[80:83], a[168:171], a[0:3], v[80:83]
  ds_read_b64_tr_b16 a[184:185], v231 offset:32768
  v_mfma_f32_16x16x32_bf16 v[80:83], a[172:175], a[16:19], v[80:83]
  v_mfma_f32_16x16x32_bf16 v[84:87], a[172:175], a[20:23], v[84:87]
  ds_read_b64_tr_b16 a[186:187], v231 offset:33792
  v_mfma_f32_16x16x32_bf16 v[84:87], a[168:171], a[4:7], v[84:87]
  s_waitcnt vmcnt(8)
  v_mfma_f32_16x16x32_bf16 v[88:91], a[168:171], a[8:11], v[88:91]
  ds_read_b64_tr_b16 a[188:189], v231 offset:40960
  v_mfma_f32_16x16x32_bf16 v[88:91], a[172:175], a[24:27], v[88:91]
  s_barrier
  v_mfma_f32_16x16x32_bf16 v[92:95], a[172:175], a[28:31], v[92:95]
  ds_read_b64_tr_b16 a[190:191], v231 offset:41984
  v_mfma_f32_16x16x32_bf16 v[92:95], a[168:171], a[12:15], v[92:95]
  s_waitcnt lgkmcnt(4)
  v_mfma_f32_16x16x32_bf16 v[96:99], a[176:179], a[0:3], v[96:99]
  ds_read_b64_tr_b16 a[160:161], v224 offset:49152
  v_mfma_f32_16x16x32_bf16 v[96:99], a[180:183], a[16:19], v[96:99]
  v_mfma_f32_16x16x32_bf16 v[100:103], a[180:183], a[20:23], v[100:103]
  ds_read_b64_tr_b16 a[162:163], v224 offset:50176
  v_mfma_f32_16x16x32_bf16 v[100:103], a[176:179], a[4:7], v[100:103]
  v_mfma_f32_16x16x32_bf16 v[104:107], a[176:179], a[8:11], v[104:107]
  ds_read_b64_tr_b16 a[164:165], v224 offset:57344
  v_mfma_f32_16x16x32_bf16 v[104:107], a[180:183], a[24:27], v[104:107]
  buffer_load_dwordx4 v237, s[16:19], s29 offen offset:3072 lds
  s_add_u32 s29, s29, 16384
  v_mfma_f32_16x16x32_bf16 v[108:111], a[180:183], a[28:31], v[108:111]
  ds_read_b64_tr_b16 a[166:167], v224 offset:58368
  v_mfma_f32_16x16x32_bf16 v[108:111], a[176:179], a[12:15], v[108:111]
  s_waitcnt lgkmcnt(4)
  v_mfma_f32_16x16x32_bf16 v[112:115], a[184:187], a[0:3], v[112:115]
  ds_read_b64_tr_b16 a[168:169], v225 offset:49152
  v_mfma_f32_16x16x32_bf16 v[112:115], a[188:191], a[16:19], v[112:115]
  v_mfma_f32_16x16x32_bf16 v[116:119], a[188:191], a[20:23], v[116:119]
  ds_read_b64_tr_b16 a[170:171], v225 offset:50176
  v_mfma_f32_16x16x32_bf16 v[116:119], a[184:187], a[4:7], v[116:119]
  v_mfma_f32_16x16x32_bf16 v[120:123], a[184:187], a[8:11], v[120:123]
  ds_read_b64_tr_b16 a[172:173], v225 offset:57344
  v_mfma_f32_16x16x32_bf16 v[120:123], a[188:191], a[24:27], v[120:123]
  v_mfma_f32_16x16x32_bf16 v[124:127], a[188:191], a[28:31], v[124:127]
  ds_read_b64_tr_b16 a[174:175], v225 offset:58368
  v_mfma_f32_16x16x32_bf16 v[124:127], a[184:187], a[12:15], v[124:127]
  s_waitcnt vmcnt(8) lgkmcnt(4)
  v_mfma_f32_16x16x32_bf16 v[0:3], a[160:163], a[32:35], v[0:3]
  ds_read_b64_tr_b16 a[176:177], v226 offset:49152
  s_add_u32 m0, s28, 16384
  v_mfma_f32_16x16x32_bf16 v[0:3], a[164:167], a[48:51], v[0:3]
  buffer_load_dwordx4 v232, s[12:15], s29 offen offset:0 lds
  v_mfma_f32_16x16x32_bf16 v[4:7], a[164:167], a[52:55], v[4:7]
  ds_read_b64_tr_b16 a[178:179], v226 offset:50176
  v_mfma_f32_16x16x32_bf16 v[4:7], a[160:163], a[36:39], v[4:7]
  v_mfma_f32_16x16x32_bf16 v[8:11], a[160:163], a[40:43], v[8:11]
  ds_read_b64_tr_b16 a[180:181], v226 offset:57344
  v_mfma_f32_16x16x32_bf16 v[8:11], a[164:167], a[56:59], v[8:11]
  buffer_load_dwordx4 v233, s[12:15], s29 offen offset:1024 lds
  v_mfma_f32_16x16x32_bf16 v[12:15], a[164:167], a[60:63], v[12:15]
  ds_read_b64_tr_b16 a[182:183], v226 offset:58368
  v_mfma_f32_16x16x32_bf16 v[12:15], a[160:163], a[44:47], v[12:15]
  s_waitcnt lgkmcnt(4)
  v_mfma_f32_16x16x32_bf16 v[16:19], a[168:171], a[32:35], v[16:19]
  ds_read_b64_tr_b16 a[184:185], v227 offset:49152
  v_mfma_f32_16x16x32_bf16 v[16:19], a[172:175], a[48:51], v[16:19]
  buffer_load_dwordx4 v234, s[12:15], s29 offen offset:2048 lds
  v_mfma_f32_16x16x32_bf16 v[20:23], a[172:175], a[52:55], v[20:23]
  ds_read_b64_tr_b16 a[186:187], v227 offset:50176
  v_mfma_f32_16x16x32_bf16 v[20:23], a[168:171], a[36:39], v[20:23]
  buffer_load_dwordx4 v235, s[12:15], s29 offen offset:3072 lds
  v_mfma_f32_16x16x32_bf16 v[24:27], a[168:171], a[40:43], v[24:27]
  ds_read_b64_tr_b16 a[188:189], v227 offset:57344
  v_mfma_f32_16x16x32_bf16 v[24:27], a[172:175], a[56:59], v[24:27]
  v_mul_f32 v0, s34, v0
  v_mul_f32 v1, s34, v1
  v_mfma_f32_16x16x32_bf16 v[28:31], a[172:175], a[60:63], v[28:31]
  ds_read_b64_tr_b16 a[190:191], v227 offset:58368
  v_mul_f32 v2, s34, v2
  v_mfma_f32_16x16x32_bf16 v[28:31], a[168:171], a[44:47], v[28:31]
  s_waitcnt lgkmcnt(4)
  v_mul_f32 v3, s34, v3
  v_mul_f32 v16, s34, v16
  v_mfma_f32_16x16x32_bf16 v[32:35], a[176:179], a[32:35], v[32:35]
  ds_read_b64_tr_b16 a[160:161], v228 offset:49152
  v_mul_f32 v17, s34, v17
  v_mfma_f32_16x16x32_bf16 v[32:35], a[180:183], a[48:51], v[32:35]
  v_mul_f32 v18, s34, v18
  v_mul_f32 v19, s34, v19
  v_mfma_f32_16x16x32_bf16 v[36:39], a[180:183], a[52:55], v[36:39]
  ds_read_b64_tr_b16 a[162:163], v228 offset:50176
  v_cvt_pk_bf16_f32 v128, v0, v1
  v_mfma_f32_16x16x32_bf16 v[36:39], a[176:179], a[36:39], v[36:39]
  v_cvt_pk_bf16_f32 v129, v2, v3
  v_cvt_pk_bf16_f32 v130, v16, v17
  v_mfma_f32_16x16x32_bf16 v[40:43], a[176:179], a[40:43], v[40:43]
  ds_read_b64_tr_b16 a[164:165], v228 offset:57344
  v_cvt_pk_bf16_f32 v131, v18, v19
  v_mfma_f32_16x16x32_bf16 v[40:43], a[180:183], a[56:59], v[40:43]
  v_mul_f32 v4, s34, v4
  v_mul_f32 v5, s34, v5
  v_mfma_f32_16x16x32_bf16 v[44:47], a[180:183], a[60:63], v[44:47]
  ds_read_b64_tr_b16 a[166:167], v228 offset:58368
  v_mul_f32 v6, s34, v6
  v_mfma_f32_16x16x32_bf16 v[44:47], a[176:179], a[44:47], v[44:47]
  s_waitcnt lgkmcnt(4)
  v_mul_f32 v7, s34, v7
  v_mul_f32 v20, s34, v20
  v_mfma_f32_16x16x32_bf16 v[48:51], a[184:187], a[32:35], v[48:51]
  ds_read_b64_tr_b16 a[168:169], v229 offset:49152
  v_mul_f32 v21, s34, v21
  v_mfma_f32_16x16x32_bf16 v[48:51], a[188:191], a[48:51], v[48:51]
  v_mul_f32 v22, s34, v22
  v_mul_f32 v23, s34, v23
  v_mfma_f32_16x16x32_bf16 v[52:55], a[188:191], a[52:55], v[52:55]
  ds_read_b64_tr_b16 a[170:171], v229 offset:50176
  v_cvt_pk_bf16_f32 v144, v4, v5
  v_mfma_f32_16x16x32_bf16 v[52:55], a[184:187], a[36:39], v[52:55]
  v_cvt_pk_bf16_f32 v145, v6, v7
  v_cvt_pk_bf16_f32 v146, v20, v21
  v_mfma_f32_16x16x32_bf16 v[56:59], a[184:187], a[40:43], v[56:59]
  ds_read_b64_tr_b16 a[172:173], v229 offset:57344
  v_cvt_pk_bf16_f32 v147, v22, v23
  v_mfma_f32_16x16x32_bf16 v[56:59], a[188:191], a[56:59], v[56:59]
  v_permlane16_swap_b32 v128, v130
  v_permlane16_swap_b32 v129, v131
  v_mfma_f32_16x16x32_bf16 v[60:63], a[188:191], a[60:63], v[60:63]
  ds_read_b64_tr_b16 a[174:175], v229 offset:58368
  v_mul_f32 v8, s34, v8
  v_mfma_f32_16x16x32_bf16 v[60:63], a[184:187], a[44:47], v[60:63]
  s_waitcnt lgkmcnt(4)
  v_mul_f32 v9, s34, v9
  v_mul_f32 v10, s34, v10
  v_mfma_f32_16x16x32_bf16 v[64:67], a[160:163], a[32:35], v[64:67]
  ds_read_b64_tr_b16 a[176:177], v230 offset:49152
  v_mul_f32 v11, s34, v11
  v_mfma_f32_16x16x32_bf16 v[64:67], a[164:167], a[48:51], v[64:67]
  v_mul_f32 v24, s34, v24
  v_mul_f32 v25, s34, v25
  v_mfma_f32_16x16x32_bf16 v[68:71], a[164:167], a[52:55], v[68:71]
  ds_read_b64_tr_b16 a[178:179], v230 offset:50176
  v_mul_f32 v26, s34, v26
  v_mfma_f32_16x16x32_bf16 v[68:71], a[160:163], a[36:39], v[68:71]
  v_mul_f32 v27, s34, v27
  v_cvt_pk_bf16_f32 v160, v8, v9
  v_mfma_f32_16x16x32_bf16 v[72:75], a[160:163], a[40:43], v[72:75]
  ds_read_b64_tr_b16 a[180:181], v230 offset:57344
  v_cvt_pk_bf16_f32 v161, v10, v11
  v_mfma_f32_16x16x32_bf16 v[72:75], a[164:167], a[56:59], v[72:75]
  v_cvt_pk_bf16_f32 v162, v24, v25
  v_cvt_pk_bf16_f32 v163, v26, v27
  v_mfma_f32_16x16x32_bf16 v[76:79], a[164:167], a[60:63], v[76:79]
  ds_read_b64_tr_b16 a[182:183], v230 offset:58368
  v_permlane16_swap_b32 v144, v146
  v_mfma_f32_16x16x32_bf16 v[76:79], a[160:163], a[44:47], v[76:79]
  s_waitcnt lgkmcnt(4)
  v_permlane16_swap_b32 v145, v147
  v_mul_f32 v12, s34, v12
  v_mfma_f32_16x16x32_bf16 v[80:83], a[168:171], a[32:35], v[80:83]
  ds_read_b64_tr_b16 a[184:185], v231 offset:49152
  v_mul_f32 v13, s34, v13
  v_mfma_f32_16x16x32_bf16 v[80:83], a[172:175], a[48:51], v[80:83]
  v_mul_f32 v14, s34, v14
  v_mul_f32 v15, s34, v15
  v_mfma_f32_16x16x32_bf16 v[84:87], a[172:175], a[52:55], v[84:87]
  ds_read_b64_tr_b16 a[186:187], v231 offset:50176
  v_mul_f32 v28, s34, v28
  v_mfma_f32_16x16x32_bf16 v[84:87], a[168:171], a[36:39], v[84:87]
  s_waitcnt vmcnt(8)
  v_mul_f32 v29, s34, v29
  v_mul_f32 v30, s34, v30
  v_mfma_f32_16x16x32_bf16 v[88:91], a[168:171], a[40:43], v[88:91]
  ds_read_b64_tr_b16 a[188:189], v231 offset:57344
  v_mul_f32 v31, s34, v31
  v_mfma_f32_16x16x32_bf16 v[88:91], a[172:175], a[56:59], v[88:91]
  s_barrier
  v_cvt_pk_bf16_f32 v176, v12, v13
  v_cvt_pk_bf16_f32 v177, v14, v15
  v_mfma_f32_16x16x32_bf16 v[92:95], a[172:175], a[60:63], v[92:95]
  ds_read_b64_tr_b16 a[190:191], v231 offset:58368
  v_cvt_pk_bf16_f32 v178, v28, v29
  v_mfma_f32_16x16x32_bf16 v[92:95], a[168:171], a[44:47], v[92:95]
  s_waitcnt lgkmcnt(4)
  v_cvt_pk_bf16_f32 v179, v30, v31
  v_permlane16_swap_b32 v160, v162
  v_mfma_f32_16x16x32_bf16 v[96:99], a[176:179], a[32:35], v[96:99]
  ds_read_b128 a[128:131], v212 offset:0
  v_permlane16_swap_b32 v161, v163
  v_mfma_f32_16x16x32_bf16 v[96:99], a[180:183], a[48:51], v[96:99]
  v_mul_f32 v32, s34, v32
  v_mul_f32 v33, s34, v33
  v_mfma_f32_16x16x32_bf16 v[100:103], a[180:183], a[52:55], v[100:103]
  ds_read_b128 a[132:135], v213 offset:0
  v_mul_f32 v34, s34, v34
  v_mfma_f32_16x16x32_bf16 v[100:103], a[176:179], a[36:39], v[100:103]
  v_mul_f32 v35, s34, v35
  v_mul_f32 v48, s34, v48
  v_mfma_f32_16x16x32_bf16 v[104:107], a[176:179], a[40:43], v[104:107]
  ds_read_b128 a[136:139], v214 offset:0
  v_mul_f32 v49, s34, v49
  v_mfma_f32_16x16x32_bf16 v[104:107], a[180:183], a[56:59], v[104:107]
  v_mul_f32 v50, s34, v50
  v_mul_f32 v51, s34, v51
  v_mfma_f32_16x16x32_bf16 v[108:111], a[180:183], a[60:63], v[108:111]
  ds_read_b128 a[140:143], v215 offset:0
  v_cvt_pk_bf16_f32 v132, v32, v33
  v_mfma_f32_16x16x32_bf16 v[108:111], a[176:179], a[44:47], v[108:111]
  s_waitcnt lgkmcnt(4)
  v_cvt_pk_bf16_f32 v133, v34, v35
  v_cvt_pk_bf16_f32 v134, v48, v49
  v_mfma_f32_16x16x32_bf16 v[112:115], a[184:187], a[32:35], v[112:115]
  v_cvt_pk_bf16_f32 v135, v50, v51
  v_permlane16_swap_b32 v176, v178
  v_mfma_f32_16x16x32_bf16 v[112:115], a[188:191], a[48:51], v[112:115]
  v_permlane16_swap_b32 v177, v179
  v_mul_f32 v36, s34, v36
  v_mfma_f32_16x16x32_bf16 v[116:119], a[188:191], a[52:55], v[116:119]
  v_mul_f32 v37, s34, v37
  v_mul_f32 v38, s34, v38
  v_mfma_f32_16x16x32_bf16 v[116:119], a[184:187], a[36:39], v[116:119]
  v_mul_f32 v39, s34, v39
  v_mul_f32 v52, s34, v52
  v_mfma_f32_16x16x32_bf16 v[120:123], a[184:187], a[40:43], v[120:123]
  v_mul_f32 v53, s34, v53
  v_mul_f32 v54, s34, v54
  v_mfma_f32_16x16x32_bf16 v[120:123], a[188:191], a[56:59], v[120:123]
  v_mul_f32 v55, s34, v55
  v_cvt_pk_bf16_f32 v148, v36, v37
  v_mfma_f32_16x16x32_bf16 v[124:127], a[188:191], a[60:63], v[124:127]
  v_cvt_pk_bf16_f32 v149, v38, v39
  v_cvt_pk_bf16_f32 v150, v52, v53
  v_mfma_f32_16x16x32_bf16 v[124:127], a[184:187], a[44:47], v[124:127]
  s_waitcnt lgkmcnt(0)
  v_cvt_pk_bf16_f32 v151, v54, v55
  v_permlane16_swap_b32 v132, v134
  v_permlane16_swap_b32 v133, v135
  v_pk_mul_f32 v[40:41], v[40:41], s[34:35] op_sel_hi:[1,0]
  v_pk_mul_f32 v[42:43], v[42:43], s[34:35] op_sel_hi:[1,0]
  v_pk_mul_f32 v[56:57], v[56:57], s[34:35] op_sel_hi:[1,0]
  v_pk_mul_f32 v[58:59], v[58:59], s[34:35] op_sel_hi:[1,0]
  v_cvt_pk_bf16_f32 v164, v40, v41
  v_cvt_pk_bf16_f32 v165, v42, v43
  v_cvt_pk_bf16_f32 v166, v56, v57
  v_cvt_pk_bf16_f32 v167, v58, v59
  v_permlane16_swap_b32 v148, v150
  v_permlane16_swap_b32 v149, v151
  v_pk_mul_f32 v[44:45], v[44:45], s[34:35] op_sel_hi:[1,0]
  v_pk_mul_f32 v[46:47], v[46:47], s[34:35] op_sel_hi:[1,0]
  v_pk_mul_f32 v[60:61], v[60:61], s[34:35] op_sel_hi:[1,0]
  v_pk_mul_f32 v[62:63], v[62:63], s[34:35] op_sel_hi:[1,0]
  v_cvt_pk_bf16_f32 v180, v44, v45
  v_cvt_pk_bf16_f32 v181, v46, v47
  v_cvt_pk_bf16_f32 v182, v60, v61
  v_cvt_pk_bf16_f32 v183, v62, v63
  v_permlane16_swap_b32 v164, v166
  v_permlane16_swap_b32 v165, v167
  v_pk_mul_f32 v[64:65], v[64:65], s[34:35] op_sel_hi:[1,0]
  v_pk_mul_f32 v[66:67], v[66:67], s[34:35] op_sel_hi:[1,0]
  v_pk_mul_f32 v[80:81], v[80:81], s[34:35] op_sel_hi:[1,0]
  v_pk_mul_f32 v[82:83], v[82:83], s[34:35] op_sel_hi:[1,0]
  v_cvt_pk_bf16_f32 v136, v64, v65
  v_cvt_pk_bf16_f32 v137, v66, v67
  v_cvt_pk_bf16_f32 v138, v80, v81
  v_cvt_pk_bf16_f32 v139, v82, v83
  v_permlane16_swap_b32 v180, v182
  v_permlane16_swap_b32 v181, v183
  v_pk_mul_f32 v[68:69], v[68:69], s[34:35] op_sel_hi:[1,0]
  v_pk_mul_f32 v[70:71], v[70:71], s[34:35] op_sel_hi:[1,0]
  v_pk_mul_f32 v[84:85], v[84:85], s[34:35] op_sel_hi:[1,0]
  v_pk_mul_f32 v[86:87], v[86:87], s[34:35] op_sel_hi:[1,0]
  v_cvt_pk_bf16_f32 v152, v68, v69
  v_cvt_pk_bf16_f32 v153, v70, v71
  v_cvt_pk_bf16_f32 v154, v84, v85
  v_cvt_pk_bf16_f32 v155, v86, v87
  v_permlane16_swap_b32 v136, v138
  v_permlane16_swap_b32 v137, v139
  v_pk_mul_f32 v[72:73], v[72:73], s[34:35] op_sel_hi:[1,0]
  v_pk_mul_f32 v[74:75], v[74:75], s[34:35] op_sel_hi:[1,0]
  v_pk_mul_f32 v[88:89], v[88:89], s[34:35] op_sel_hi:[1,0]
  v_pk_mul_f32 v[90:91], v[90:91], s[34:35] op_sel_hi:[1,0]
  v_cvt_pk_bf16_f32 v168, v72, v73
  v_cvt_pk_bf16_f32 v169, v74, v75
  v_cvt_pk_bf16_f32 v170, v88, v89
  v_cvt_pk_bf16_f32 v171, v90, v91
  v_permlane16_swap_b32 v152, v154
  v_permlane16_swap_b32 v153, v155
  v_pk_mul_f32 v[76:77], v[76:77], s[34:35] op_sel_hi:[1,0]
  v_pk_mul_f32 v[78:79], v[78:79], s[34:35] op_sel_hi:[1,0]
  v_pk_mul_f32 v[92:93], v[92:93], s[34:35] op_sel_hi:[1,0]
  v_pk_mul_f32 v[94:95], v[94:95], s[34:35] op_sel_hi:[1,0]
  v_cvt_pk_bf16_f32 v184, v76, v77
  v_cvt_pk_bf16_f32 v185, v78, v79
  v_cvt_pk_bf16_f32 v186, v92, v93
  v_cvt_pk_bf16_f32 v187, v94, v95
  v_permlane16_swap_b32 v168, v170
  v_permlane16_swap_b32 v169, v171
  v_pk_mul_f32 v[96:97], v[96:97], s[34:35] op_sel_hi:[1,0]
  v_pk_mul_f32 v[98:99], v[98:99], s[34:35] op_sel_hi:[1,0]
  v_pk_mul_f32 v[112:113], v[112:113], s[34:35] op_sel_hi:[1,0]
  v_pk_mul_f32 v[114:115], v[114:115], s[34:35] op_sel_hi:[1,0]
  v_cvt_pk_bf16_f32 v140, v96, v97
  v_cvt_pk_bf16_f32 v141, v98, v99
  v_cvt_pk_bf16_f32 v142, v112, v113
  v_cvt_pk_bf16_f32 v143, v114, v115
  v_permlane16_swap_b32 v184, v186
  v_permlane16_swap_b32 v185, v187
  v_pk_mul_f32 v[100:101], v[100:101], s[34:35] op_sel_hi:[1,0]
  v_pk_mul_f32 v[102:103], v[102:103], s[34:35] op_sel_hi:[1,0]
  v_pk_mul_f32 v[116:117], v[116:117], s[34:35] op_sel_hi:[1,0]
  v_pk_mul_f32 v[118:119], v[118:119], s[34:35] op_sel_hi:[1,0]
  v_cvt_pk_bf16_f32 v156, v100, v101
  v_cvt_pk_bf16_f32 v157, v102, v103
  v_cvt_pk_bf16_f32 v158, v116, v117
  v_cvt_pk_bf16_f32 v159, v118, v119
  v_permlane16_swap_b32 v140, v142
  v_permlane16_swap_b32 v141, v143
  v_pk_mul_f32 v[104:105], v[104:105], s[34:35] op_sel_hi:[1,0]
  v_pk_mul_f32 v[106:107], v[106:107], s[34:35] op_sel_hi:[1,0]
  v_pk_mul_f32 v[120:121], v[120:121], s[34:35] op_sel_hi:[1,0]
  v_pk_mul_f32 v[122:123], v[122:123], s[34:35] op_sel_hi:[1,0]
  v_cvt_pk_bf16_f32 v172, v104, v105
  v_cvt_pk_bf16_f32 v173, v106, v107
  v_cvt_pk_bf16_f32 v174, v120, v121
  v_cvt_pk_bf16_f32 v175, v122, v123
  v_permlane16_swap_b32 v156, v158
  v_permlane16_swap_b32 v157, v159
  v_pk_mul_f32 v[108:109], v[108:109], s[34:35] op_sel_hi:[1,0]
  v_pk_mul_f32 v[110:111], v[110:111], s[34:35] op_sel_hi:[1,0]
  v_pk_mul_f32 v[124:125], v[124:125], s[34:35] op_sel_hi:[1,0]
  v_pk_mul_f32 v[126:127], v[126:127], s[34:35] op_sel_hi:[1,0]
  v_cvt_pk_bf16_f32 v188, v108, v109
  v_cvt_pk_bf16_f32 v189, v110, v111
  v_cvt_pk_bf16_f32 v190, v124, v125
  v_cvt_pk_bf16_f32 v191, v126, v127
  v_permlane16_swap_b32 v172, v174
  v_permlane16_swap_b32 v173, v175
  v_permlane16_swap_b32 v188, v190
  v_permlane16_swap_b32 v189, v191
  v_mfma_f32_16x16x32_bf16 v[0:3], a[128:131], v[128:131], 0
  s_add_u32 m0, s28, 81920
  ds_read_b128 a[144:147], v212 offset:4096
  s_mov_b32 s20, s90
  s_mov_b32 s21, s91
  v_mfma_f32_16x16x32_bf16 v[0:3], a[132:135], v[132:135], v[0:3]
  buffer_load_dwordx4 v236, s[16:19], s29 offen offset:0 lds
  s_mov_b32 s22, 2211840
  s_mov_b32 s23, 0x20000
  s_mov_b32 s44, s92
  v_mfma_f32_16x16x32_bf16 v[0:3], a[136:139], v[136:139], v[0:3]
  ds_read_b128 a[148:151], v213 offset:4096
  s_mov_b32 s45, s93
  s_mov_b32 s46, 2211840
  s_mov_b32 s47, 0x20000
  v_lshrrev_b32 v253, 4, v242
  v_mfma_f32_16x16x32_bf16 v[0:3], a[140:143], v[140:143], v[0:3]
  buffer_load_dwordx4 v237, s[16:19], s29 offen offset:1024 lds
  v_mfma_f32_16x16x32_bf16 v[8:11], a[140:143], v[156:159], 0
  ds_read_b128 a[152:155], v214 offset:4096
  v_mul_u32_u24 v253, 0xd80, v253
  v_mfma_f32_16x16x32_bf16 v[8:11], a[136:139], v[152:155], v[8:11]
  buffer_load_dwordx4 v236, s[16:19], s29 offen offset:2048 lds
  s_mul_i32 s35, s3, 552960
  s_lshl_b32 s38, s33, 4
  s_add_u32 s35, s35, s38
  v_mfma_f32_16x16x32_bf16 v[8:11], a[132:135], v[148:151], v[8:11]
  ds_read_b128 a[156:159], v215 offset:4096
  v_mfma_f32_16x16x32_bf16 v[8:11], a[128:131], v[144:147], v[8:11]
  buffer_load_dwordx4 v237, s[16:19], s29 offen offset:3072 lds
  v_mfma_f32_16x16x32_bf16 v[16:19], a[128:131], v[160:163], 0
  s_add_u32 s29, s29, 16384
  s_add_u32 m0, s28, 32768
  v_mfma_f32_16x16x32_bf16 v[16:19], a[132:135], v[164:167], v[16:19]
  buffer_load_dwordx4 v232, s[12:15], s29 offen offset:0 lds
  v_mfma_f32_16x16x32_bf16 v[16:19], a[136:139], v[168:171], v[16:19]
  buffer_load_dwordx4 v233, s[12:15], s29 offen offset:1024 lds
  v_mfma_f32_16x16x32_bf16 v[16:19], a[140:143], v[172:175], v[16:19]
  v_max3_f32 v192, v0, v1, v2
  v_max3_f32 v196, v8, v9, v10
  v_mfma_f32_16x16x32_bf16 v[24:27], a[140:143], v[188:191], 0
  v_max_f32 v192, v192, v3
  v_max_f32 v196, v196, v11
  v_mfma_f32_16x16x32_bf16 v[24:27], a[136:139], v[184:187], v[24:27]
  v_mov_b32 v245, v192
  v_mov_b32 v246, v196
  v_mfma_f32_16x16x32_bf16 v[24:27], a[132:135], v[180:183], v[24:27]
  v_permlane16_swap_b32 v192, v245
  v_permlane16_swap_b32 v196, v246
  v_mfma_f32_16x16x32_bf16 v[24:27], a[128:131], v[176:179], v[24:27]
  s_waitcnt lgkmcnt(0)
  v_max_f32 v192, v192, v245
  v_max_f32 v196, v196, v246
  v_mfma_f32_16x16x32_bf16 v[4:7], a[144:147], v[128:131], 0
  ds_read_b128 a[128:131], v212 offset:8192
  v_mov_b32 v245, v192
  v_mfma_f32_16x16x32_bf16 v[4:7], a[148:151], v[132:135], v[4:7]
  v_mov_b32 v246, v196
  v_permlane32_swap_b32 v192, v245
  v_mfma_f32_16x16x32_bf16 v[4:7], a[152:155], v[136:139], v[4:7]
  ds_read_b128 a[132:135], v213 offset:8192
  v_permlane32_swap_b32 v196, v246
  v_mfma_f32_16x16x32_bf16 v[4:7], a[156:159], v[140:143], v[4:7]
  v_max_f32 v192, v192, v245
  v_max_f32 v196, v196, v246
  v_mfma_f32_16x16x32_bf16 v[12:15], a[156:159], v[156:159], 0
  ds_read_b128 a[136:139], v214 offset:8192
  v_sub_f32 v193, 0, v192
  v_mfma_f32_16x16x32_bf16 v[12:15], a[152:155], v[152:155], v[12:15]
  v_sub_f32 v197, 0, v196
  v_sub_f32 v194, 0, v192
  v_mfma_f32_16x16x32_bf16 v[12:15], a[148:151], v[148:151], v[12:15]
  ds_read_b128 a[140:143], v215 offset:8192
  v_sub_f32 v198, 0, v196
  v_mfma_f32_16x16x32_bf16 v[12:15], a[144:147], v[144:147], v[12:15]
  v_sub_f32 v195, 0, v192
  v_sub_f32 v199, 0, v196
  v_mfma_f32_16x16x32_bf16 v[20:23], a[144:147], v[160:163], 0
  buffer_load_dwordx4 v234, s[12:15], s29 offen offset:2048 lds
  v_mfma_f32_16x16x32_bf16 v[20:23], a[148:151], v[164:167], v[20:23]
  v_sub_f32 v192, 0, v192
  v_sub_f32 v196, 0, v196
  v_mfma_f32_16x16x32_bf16 v[20:23], a[152:155], v[168:171], v[20:23]
  buffer_load_dwordx4 v235, s[12:15], s29 offen offset:3072 lds
  v_mfma_f32_16x16x32_bf16 v[20:23], a[156:159], v[172:175], v[20:23]
  v_max3_f32 v200, v16, v17, v18
  v_max3_f32 v204, v24, v25, v26
  v_mfma_f32_16x16x32_bf16 v[28:31], a[156:159], v[188:191], 0
  v_max_f32 v200, v200, v19
  v_max_f32 v204, v204, v27
  v_mfma_f32_16x16x32_bf16 v[28:31], a[152:155], v[184:187], v[28:31]
  v_mov_b32 v247, v200
  v_mov_b32 v248, v204
  v_mfma_f32_16x16x32_bf16 v[28:31], a[148:151], v[180:183], v[28:31]
  v_permlane16_swap_b32 v200, v247
  v_permlane16_swap_b32 v204, v248
  v_max_f32 v200, v200, v247
  v_max_f32 v204, v204, v248
  v_mov_b32 v247, v200
  v_mov_b32 v248, v204
  s_nop 0
  v_permlane32_swap_b32 v200, v247
  v_permlane32_swap_b32 v204, v248
  v_max_f32 v200, v200, v247
  v_max_f32 v204, v204, v248
  v_sub_f32 v201, 0, v200
  v_sub_f32 v205, 0, v204
  v_sub_f32 v202, 0, v200
  v_sub_f32 v206, 0, v204
  v_sub_f32 v203, 0, v200
  v_sub_f32 v207, 0, v204
  v_sub_f32 v200, 0, v200
  v_sub_f32 v204, 0, v204
  v_mfma_f32_16x16x32_bf16 v[28:31], a[144:147], v[176:179], v[28:31]
  s_waitcnt lgkmcnt(0)
  v_add_f32 v0, v192, v0
  v_add_f32 v1, v192, v1
  v_mfma_f32_16x16x32_bf16 v[32:35], a[128:131], v[128:131], v[192:195]
  ds_read_b128 a[144:147], v212 offset:12288
  v_add_f32 v2, v192, v2
  v_mfma_f32_16x16x32_bf16 v[32:35], a[132:135], v[132:135], v[32:35]
  v_add_f32 v3, v192, v3
  v_mfma_f32_16x16x32_bf16 v[32:35], a[136:139], v[136:139], v[32:35]
  ds_read_b128 a[148:151], v213 offset:12288
  v_mfma_f32_16x16x32_bf16 v[32:35], a[140:143], v[140:143], v[32:35]
  v_exp_f32 v0, v0
  v_mfma_f32_16x16x32_bf16 v[40:43], a[140:143], v[156:159], v[196:199]
  ds_read_b128 a[152:155], v214 offset:12288
  v_mfma_f32_16x16x32_bf16 v[40:43], a[136:139], v[152:155], v[40:43]
  v_exp_f32 v1, v1
  v_mfma_f32_16x16x32_bf16 v[40:43], a[132:135], v[148:151], v[40:43]
  ds_read_b128 a[156:159], v215 offset:12288
  v_mfma_f32_16x16x32_bf16 v[40:43], a[128:131], v[144:147], v[40:43]
  v_exp_f32 v2, v2
  v_mfma_f32_16x16x32_bf16 v[48:51], a[128:131], v[160:163], v[200:203]
  s_add_u32 m0, s50, 0
  v_cvt_pk_bf16_f32 v0, v0, v1
  v_mfma_f32_16x16x32_bf16 v[48:51], a[132:135], v[164:167], v[48:51]
  v_exp_f32 v3, v3
  v_mfma_f32_16x16x32_bf16 v[48:51], a[136:139], v[168:171], v[48:51]
  v_add_f32 v8, v196, v8
  v_add_f32 v9, v196, v9
  v_mfma_f32_16x16x32_bf16 v[48:51], a[140:143], v[172:175], v[48:51]
  v_add_f32 v10, v196, v10
  v_add_f32 v11, v196, v11
  v_mfma_f32_16x16x32_bf16 v[56:59], a[140:143], v[188:191], v[204:207]
  v_exp_f32 v8, v8
  v_mfma_f32_16x16x32_bf16 v[56:59], a[136:139], v[184:187], v[56:59]
  v_exp_f32 v9, v9
  buffer_load_dwordx4 v253, s[20:23], s35 offen lds
  v_mfma_f32_16x16x32_bf16 v[56:59], a[132:135], v[180:183], v[56:59]
  v_exp_f32 v10, v10
  v_mfma_f32_16x16x32_bf16 v[56:59], a[128:131], v[176:179], v[56:59]
  s_waitcnt lgkmcnt(0)
  v_cvt_pk_bf16_f32 v8, v8, v9
  v_mfma_f32_16x16x32_bf16 v[36:39], a[144:147], v[128:131], v[192:195]
  s_waitcnt vmcnt(9)
  v_exp_f32 v11, v11
  v_mfma_f32_16x16x32_bf16 v[36:39], a[148:151], v[132:135], v[36:39]
  s_barrier
  v_cvt_pk_bf16_f32 v1, v2, v3
  v_add_f32 v16, v200, v16
  v_mfma_f32_16x16x32_bf16 v[36:39], a[152:155], v[136:139], v[36:39]
  ds_read_b128 a[128:131], v212 offset:16384
  v_add_f32 v17, v200, v17
  v_mfma_f32_16x16x32_bf16 v[36:39], a[156:159], v[140:143], v[36:39]
  v_add_f32 v18, v200, v18
  v_add_f32 v19, v200, v19
  v_mfma_f32_16x16x32_bf16 v[44:47], a[156:159], v[156:159], v[196:199]
  ds_read_b128 a[132:135], v213 offset:16384
  v_mfma_f32_16x16x32_bf16 v[44:47], a[152:155], v[152:155], v[44:47]
  v_exp_f32 v16, v16
  v_mfma_f32_16x16x32_bf16 v[44:47], a[148:151], v[148:151], v[44:47]
  ds_read_b128 a[136:139], v214 offset:16384
  v_mfma_f32_16x16x32_bf16 v[44:47], a[144:147], v[144:147], v[44:47]
  v_exp_f32 v17, v17
  v_mfma_f32_16x16x32_bf16 v[52:55], a[144:147], v[160:163], v[200:203]
  ds_read_b128 a[140:143], v215 offset:16384
  v_mfma_f32_16x16x32_bf16 v[52:55], a[148:151], v[164:167], v[52:55]
  v_exp_f32 v18, v18
  v_mfma_f32_16x16x32_bf16 v[52:55], a[152:155], v[168:171], v[52:55]
  v_cvt_pk_bf16_f32 v16, v16, v17
  v_mfma_f32_16x16x32_bf16 v[52:55], a[156:159], v[172:175], v[52:55]
  v_exp_f32 v19, v19
  v_mfma_f32_16x16x32_bf16 v[60:63], a[156:159], v[188:191], v[204:207]
  v_cvt_pk_bf16_f32 v9, v10, v11
  v_add_f32 v24, v204, v24
  v_mfma_f32_16x16x32_bf16 v[60:63], a[152:155], v[184:187], v[60:63]
  v_add_f32 v25, v204, v25
  v_add_f32 v26, v204, v26
  v_mfma_f32_16x16x32_bf16 v[60:63], a[148:151], v[180:183], v[60:63]
  v_add_f32 v27, v204, v27
  v_mfma_f32_16x16x32_bf16 v[60:63], a[144:147], v[176:179], v[60:63]
  s_waitcnt lgkmcnt(0)
  v_exp_f32 v24, v24
  v_exp_f32 v25, v25
  v_exp_f32 v26, v26
  v_cvt_pk_bf16_f32 v24, v24, v25
  v_exp_f32 v27, v27
  v_cvt_pk_bf16_f32 v17, v18, v19
  v_add_f32 v4, v192, v4
  v_add_f32 v5, v192, v5
  v_add_f32 v6, v192, v6
  v_add_f32 v7, v192, v7
  v_exp_f32 v4, v4
  v_exp_f32 v5, v5
  v_exp_f32 v6, v6
  v_cvt_pk_bf16_f32 v2, v4, v5
  v_exp_f32 v7, v7
  v_cvt_pk_bf16_f32 v25, v26, v27
  v_add_f32 v12, v196, v12
  v_add_f32 v13, v196, v13
  v_add_f32 v14, v196, v14
  v_add_f32 v15, v196, v15
  v_exp_f32 v12, v12
  v_exp_f32 v13, v13
  v_exp_f32 v14, v14
  v_cvt_pk_bf16_f32 v10, v12, v13
  v_exp_f32 v15, v15
  v_cvt_pk_bf16_f32 v3, v6, v7
  v_add_f32 v20, v200, v20
  v_add_f32 v21, v200, v21
  v_add_f32 v22, v200, v22
  v_add_f32 v23, v200, v23
  v_exp_f32 v20, v20
  v_exp_f32 v21, v21
  v_exp_f32 v22, v22
  v_cvt_pk_bf16_f32 v18, v20, v21
  v_exp_f32 v23, v23
  v_cvt_pk_bf16_f32 v11, v14, v15
  v_add_f32 v28, v204, v28
  v_add_f32 v29, v204, v29
  v_add_f32 v30, v204, v30
  v_add_f32 v31, v204, v31
  v_exp_f32 v28, v28
  v_exp_f32 v29, v29
  v_exp_f32 v30, v30
  v_cvt_pk_bf16_f32 v26, v28, v29
  v_exp_f32 v31, v31
  v_cvt_pk_bf16_f32 v19, v22, v23
  v_exp_f32 v32, v32
  v_exp_f32 v33, v33
  v_exp_f32 v34, v34
  v_cvt_pk_bf16_f32 v32, v32, v33
  v_exp_f32 v35, v35
  v_cvt_pk_bf16_f32 v27, v30, v31
  v_exp_f32 v40, v40
  v_exp_f32 v41, v41
  v_exp_f32 v42, v42
  v_cvt_pk_bf16_f32 v40, v40, v41
  v_exp_f32 v43, v43
  v_cvt_pk_bf16_f32 v33, v34, v35
  v_exp_f32 v48, v48
  v_exp_f32 v49, v49
  v_exp_f32 v50, v50
  v_cvt_pk_bf16_f32 v48, v48, v49
  v_exp_f32 v51, v51
  v_cvt_pk_bf16_f32 v41, v42, v43
  v_exp_f32 v56, v56
  v_exp_f32 v57, v57
  v_exp_f32 v58, v58
  v_cvt_pk_bf16_f32 v56, v56, v57
  v_exp_f32 v59, v59
  v_cvt_pk_bf16_f32 v49, v50, v51
  v_exp_f32 v36, v36
  v_exp_f32 v37, v37
  v_exp_f32 v38, v38
  v_cvt_pk_bf16_f32 v34, v36, v37
  v_exp_f32 v39, v39
  v_cvt_pk_bf16_f32 v57, v58, v59
  v_exp_f32 v44, v44
  v_exp_f32 v45, v45
  v_exp_f32 v46, v46
  v_cvt_pk_bf16_f32 v42, v44, v45
  v_exp_f32 v47, v47
  v_cvt_pk_bf16_f32 v35, v38, v39
  v_exp_f32 v52, v52
  v_exp_f32 v53, v53
  v_exp_f32 v54, v54
  v_cvt_pk_bf16_f32 v50, v52, v53
  v_exp_f32 v55, v55
  v_cvt_pk_bf16_f32 v43, v46, v47
  v_exp_f32 v60, v60
  v_exp_f32 v61, v61
  v_exp_f32 v62, v62
  v_cvt_pk_bf16_f32 v58, v60, v61
  v_exp_f32 v63, v63
  v_cvt_pk_bf16_f32 v51, v54, v55
  v_cvt_pk_bf16_f32 v59, v62, v63
  v_mfma_f32_16x16x32_bf16 v[64:67], a[128:131], v[128:131], v[192:195]
  s_add_u32 m0, s28, 98304
  v_mfma_f32_16x16x32_bf16 v[64:67], a[132:135], v[132:135], v[64:67]
  ds_read_b128 a[144:147], v212 offset:20480
  v_mfma_f32_16x16x32_bf16 v[64:67], a[136:139], v[136:139], v[64:67]
  buffer_load_dwordx4 v236, s[16:19], s29 offen offset:0 lds
  v_mfma_f32_16x16x32_bf16 v[64:67], a[140:143], v[140:143], v[64:67]
  ds_read_b128 a[148:151], v213 offset:20480
  v_mfma_f32_16x16x32_bf16 v[72:75], a[140:143], v[156:159], v[196:199]
  buffer_load_dwordx4 v237, s[16:19], s29 offen offset:1024 lds
  v_mfma_f32_16x16x32_bf16 v[72:75], a[136:139], v[152:155], v[72:75]
  ds_read_b128 a[152:155], v214 offset:20480
  v_mfma_f32_16x16x32_bf16 v[72:75], a[132:135], v[148:151], v[72:75]
  buffer_load_dwordx4 v236, s[16:19], s29 offen offset:2048 lds
  v_mfma_f32_16x16x32_bf16 v[72:75], a[128:131], v[144:147], v[72:75]
  ds_read_b128 a[156:159], v215 offset:20480
  v_mfma_f32_16x16x32_bf16 v[80:83], a[128:131], v[160:163], v[200:203]
  v_exp_f32 v64, v64
  v_mfma_f32_16x16x32_bf16 v[80:83], a[132:135], v[164:167], v[80:83]
  buffer_load_dwordx4 v237, s[16:19], s29 offen offset:3072 lds
  v_mfma_f32_16x16x32_bf16 v[80:83], a[136:139], v[168:171], v[80:83]
  s_add_u32 s29, s29, 16384
  v_exp_f32 v65, v65
  v_mfma_f32_16x16x32_bf16 v[80:83], a[140:143], v[172:175], v[80:83]
  v_cvt_pk_bf16_f32 v64, v64, v65
  v_mfma_f32_16x16x32_bf16 v[88:91], a[140:143], v[188:191], v[204:207]
  s_add_u32 m0, s28, 49152
  v_exp_f32 v66, v66
  v_mfma_f32_16x16x32_bf16 v[88:91], a[136:139], v[184:187], v[88:91]
  buffer_load_dwordx4 v232, s[12:15], s29 offen offset:0 lds
  v_mfma_f32_16x16x32_bf16 v[88:91], a[132:135], v[180:183], v[88:91]
  s_waitcnt lgkmcnt(0)
  v_exp_f32 v67, v67
  v_mfma_f32_16x16x32_bf16 v[88:91], a[128:131], v[176:179], v[88:91]
  v_cvt_pk_bf16_f32 v65, v66, v67
  v_mfma_f32_16x16x32_bf16 v[68:71], a[144:147], v[128:131], v[192:195]
  v_exp_f32 v72, v72
  v_mfma_f32_16x16x32_bf16 v[68:71], a[148:151], v[132:135], v[68:71]
  ds_read_b128 a[128:131], v212 offset:24576
  v_mfma_f32_16x16x32_bf16 v[68:71], a[152:155], v[136:139], v[68:71]
  v_exp_f32 v73, v73
  v_mfma_f32_16x16x32_bf16 v[68:71], a[156:159], v[140:143], v[68:71]
  ds_read_b128 a[132:135], v213 offset:24576
  v_cvt_pk_bf16_f32 v72, v72, v73
  v_mfma_f32_16x16x32_bf16 v[76:79], a[156:159], v[156:159], v[196:199]
  v_exp_f32 v74, v74
  v_mfma_f32_16x16x32_bf16 v[76:79], a[152:155], v[152:155], v[76:79]
  ds_read_b128 a[136:139], v214 offset:24576
  v_mfma_f32_16x16x32_bf16 v[76:79], a[148:151], v[148:151], v[76:79]
  v_exp_f32 v75, v75
  v_mfma_f32_16x16x32_bf16 v[76:79], a[144:147], v[144:147], v[76:79]
  ds_read_b128 a[140:143], v215 offset:24576
  v_cvt_pk_bf16_f32 v73, v74, v75
  v_mfma_f32_16x16x32_bf16 v[84:87], a[144:147], v[160:163], v[200:203]
  v_exp_f32 v80, v80
  v_mfma_f32_16x16x32_bf16 v[84:87], a[148:151], v[164:167], v[84:87]
  buffer_load_dwordx4 v233, s[12:15], s29 offen offset:1024 lds
  v_mfma_f32_16x16x32_bf16 v[84:87], a[152:155], v[168:171], v[84:87]
  v_exp_f32 v81, v81
  v_mfma_f32_16x16x32_bf16 v[84:87], a[156:159], v[172:175], v[84:87]
  v_cvt_pk_bf16_f32 v80, v80, v81
  v_mfma_f32_16x16x32_bf16 v[92:95], a[156:159], v[188:191], v[204:207]
  v_exp_f32 v82, v82
  v_mfma_f32_16x16x32_bf16 v[92:95], a[152:155], v[184:187], v[92:95]
  buffer_load_dwordx4 v234, s[12:15], s29 offen offset:2048 lds
  v_mfma_f32_16x16x32_bf16 v[92:95], a[148:151], v[180:183], v[92:95]
  s_waitcnt lgkmcnt(0)
  v_exp_f32 v83, v83
  v_mfma_f32_16x16x32_bf16 v[92:95], a[144:147], v[176:179], v[92:95]
  v_cvt_pk_bf16_f32 v81, v82, v83
  v_mfma_f32_16x16x32_bf16 v[96:99], a[128:131], v[128:131], v[192:195]
  v_exp_f32 v88, v88
  v_mfma_f32_16x16x32_bf16 v[96:99], a[132:135], v[132:135], v[96:99]
  ds_read_b128 a[144:147], v212 offset:28672
  v_mfma_f32_16x16x32_bf16 v[96:99], a[136:139], v[136:139], v[96:99]
  v_exp_f32 v89, v89
  v_mfma_f32_16x16x32_bf16 v[96:99], a[140:143], v[140:143], v[96:99]
  ds_read_b128 a[148:151], v213 offset:28672
  v_cvt_pk_bf16_f32 v88, v88, v89
  v_mfma_f32_16x16x32_bf16 v[104:107], a[140:143], v[156:159], v[196:199]
  v_exp_f32 v90, v90
  v_mfma_f32_16x16x32_bf16 v[104:107], a[136:139], v[152:155], v[104:107]
  ds_read_b128 a[152:155], v214 offset:28672
  v_mfma_f32_16x16x32_bf16 v[104:107], a[132:135], v[148:151], v[104:107]
  v_exp_f32 v91, v91
  v_mfma_f32_16x16x32_bf16 v[104:107], a[128:131], v[144:147], v[104:107]
  ds_read_b128 a[156:159], v215 offset:28672
  v_cvt_pk_bf16_f32 v89, v90, v91
  v_mfma_f32_16x16x32_bf16 v[112:115], a[128:131], v[160:163], v[200:203]
  v_exp_f32 v68, v68
  v_mfma_f32_16x16x32_bf16 v[112:115], a[132:135], v[164:167], v[112:115]
  buffer_load_dwordx4 v235, s[12:15], s29 offen offset:3072 lds
  v_mfma_f32_16x16x32_bf16 v[112:115], a[136:139], v[168:171], v[112:115]
  v_exp_f32 v69, v69
  v_mfma_f32_16x16x32_bf16 v[112:115], a[140:143], v[172:175], v[112:115]
  v_cvt_pk_bf16_f32 v66, v68, v69
  v_mfma_f32_16x16x32_bf16 v[120:123], a[140:143], v[188:191], v[204:207]
  v_exp_f32 v70, v70
  v_mfma_f32_16x16x32_bf16 v[120:123], a[136:139], v[184:187], v[120:123]
  s_add_u32 m0, s50, 3072
  v_mfma_f32_16x16x32_bf16 v[120:123], a[132:135], v[180:183], v[120:123]
  s_waitcnt lgkmcnt(0)
  v_exp_f32 v71, v71
  v_mfma_f32_16x16x32_bf16 v[120:123], a[128:131], v[176:179], v[120:123]
  buffer_load_dwordx4 v253, s[44:47], s35 offen lds
  s_add_u32 s35, s35, 221184
  v_cvt_pk_bf16_f32 v67, v70, v71
  v_mfma_f32_16x16x32_bf16 v[100:103], a[144:147], v[128:131], v[192:195]
  v_exp_f32 v76, v76
  v_mfma_f32_16x16x32_bf16 v[100:103], a[148:151], v[132:135], v[100:103]
  ds_read_b64_tr_b16 a[160:161], v216 offset:0
  v_mfma_f32_16x16x32_bf16 v[100:103], a[152:155], v[136:139], v[100:103]
  v_exp_f32 v77, v77
  v_mfma_f32_16x16x32_bf16 v[100:103], a[156:159], v[140:143], v[100:103]
  ds_read_b64_tr_b16 a[162:163], v216 offset:4096
  v_cvt_pk_bf16_f32 v74, v76, v77
  v_mfma_f32_16x16x32_bf16 v[108:111], a[156:159], v[156:159], v[196:199]
  v_exp_f32 v78, v78
  v_mfma_f32_16x16x32_bf16 v[108:111], a[152:155], v[152:155], v[108:111]
  ds_read_b64_tr_b16 a[164:165], v216 offset:8192
  v_mfma_f32_16x16x32_bf16 v[108:111], a[148:151], v[148:151], v[108:111]
  v_exp_f32 v79, v79
  v_mfma_f32_16x16x32_bf16 v[108:111], a[144:147], v[144:147], v[108:111]
  ds_read_b64_tr_b16 a[166:167], v216 offset:12288
  v_cvt_pk_bf16_f32 v75, v78, v79
  v_mfma_f32_16x16x32_bf16 v[116:119], a[144:147], v[160:163], v[200:203]
  v_exp_f32 v84, v84
  v_mfma_f32_16x16x32_bf16 v[116:119], a[148:151], v[164:167], v[116:119]
  ds_read_b64_tr_b16 a[168:169], v217 offset:0
  v_mfma_f32_16x16x32_bf16 v[116:119], a[152:155], v[168:171], v[116:119]
  v_exp_f32 v85, v85
  v_mfma_f32_16x16x32_bf16 v[116:119], a[156:159], v[172:175], v[116:119]
  ds_read_b64_tr_b16 a[170:171], v217 offset:4096
  v_cvt_pk_bf16_f32 v82, v84, v85
  v_mfma_f32_16x16x32_bf16 v[124:127], a[156:159], v[188:191], v[204:207]
  v_exp_f32 v86, v86
  v_mfma_f32_16x16x32_bf16 v[124:127], a[152:155], v[184:187], v[124:127]
  ds_read_b64_tr_b16 a[172:173], v217 offset:8192
  v_mfma_f32_16x16x32_bf16 v[124:127], a[148:151], v[180:183], v[124:127]
  v_exp_f32 v87, v87
  v_mfma_f32_16x16x32_bf16 v[124:127], a[144:147], v[176:179], v[124:127]
  ds_read_b64_tr_b16 a[174:175], v217 offset:12288
  v_cvt_pk_bf16_f32 v83, v86, v87
  v_mfma_f32_16x16x32_bf16 a[192:195], a[208:211], v[0:3], 0
  v_exp_f32 v92, v92
  v_mfma_f32_16x16x32_bf16 a[192:195], a[208:211], v[32:35], a[192:195]
  ds_read_b64_tr_b16 a[176:177], v218 offset:0
  v_mfma_f32_16x16x32_bf16 a[196:199], a[208:211], v[8:11], 0
  v_exp_f32 v93, v93
  v_mfma_f32_16x16x32_bf16 a[196:199], a[208:211], v[40:43], a[196:199]
  ds_read_b64_tr_b16 a[178:179], v218 offset:4096
  v_cvt_pk_bf16_f32 v90, v92, v93
  v_mfma_f32_16x16x32_bf16 a[200:203], a[208:211], v[16:19], 0
  v_exp_f32 v94, v94
  v_mfma_f32_16x16x32_bf16 a[200:203], a[208:211], v[48:51], a[200:203]
  ds_read_b64_tr_b16 a[180:181], v218 offset:8192
  v_mfma_f32_16x16x32_bf16 a[204:207], a[208:211], v[24:27], 0
  s_waitcnt lgkmcnt(7)
  v_exp_f32 v95, v95
  v_mfma_f32_16x16x32_bf16 a[204:207], a[208:211], v[56:59], a[204:207]
  ds_read_b64_tr_b16 a[182:183], v218 offset:12288
  v_cvt_pk_bf16_f32 v91, v94, v95
  v_mfma_f32_16x16x32_bf16 a[0:3], a[160:163], v[0:3], 0
  v_exp_f32 v96, v96
  v_mfma_f32_16x16x32_bf16 a[0:3], a[164:167], v[32:35], a[0:3]
  ds_read_b64_tr_b16 a[184:185], v219 offset:0
  v_mfma_f32_16x16x32_bf16 a[4:7], a[164:167], v[40:43], 0
  v_exp_f32 v97, v97
  v_mfma_f32_16x16x32_bf16 a[4:7], a[160:163], v[8:11], a[4:7]
  ds_read_b64_tr_b16 a[186:187], v219 offset:4096
  v_cvt_pk_bf16_f32 v96, v96, v97
  v_mfma_f32_16x16x32_bf16 a[8:11], a[160:163], v[16:19], 0
  v_exp_f32 v98, v98
  v_mfma_f32_16x16x32_bf16 a[8:11], a[164:167], v[48:51], a[8:11]
  ds_read_b64_tr_b16 a[188:189], v219 offset:8192
  v_mfma_f32_16x16x32_bf16 a[12:15], a[164:167], v[56:59], 0
  s_waitcnt lgkmcnt(7)
  v_exp_f32 v99, v99
  v_mfma_f32_16x16x32_bf16 a[12:15], a[160:163], v[24:27], a[12:15]
  ds_read_b64_tr_b16 a[190:191], v219 offset:12288
  v_cvt_pk_bf16_f32 v97, v98, v99
  v_mfma_f32_16x16x32_bf16 a[16:19], a[168:171], v[0:3], 0
  v_exp_f32 v104, v104
  v_mfma_f32_16x16x32_bf16 a[16:19], a[172:175], v[32:35], a[16:19]
  ds_read_b64_tr_b16 a[160:161], v220 offset:0
  v_mfma_f32_16x16x32_bf16 a[20:23], a[172:175], v[40:43], 0
  v_exp_f32 v105, v105
  v_mfma_f32_16x16x32_bf16 a[20:23], a[168:171], v[8:11], a[20:23]
  ds_read_b64_tr_b16 a[162:163], v220 offset:4096
  v_cvt_pk_bf16_f32 v104, v104, v105
  v_mfma_f32_16x16x32_bf16 a[24:27], a[168:171], v[16:19], 0
  v_exp_f32 v106, v106
  v_mfma_f32_16x16x32_bf16 a[24:27], a[172:175], v[48:51], a[24:27]
  ds_read_b64_tr_b16 a[164:165], v220 offset:8192
  v_mfma_f32_16x16x32_bf16 a[28:31], a[172:175], v[56:59], 0
  s_waitcnt lgkmcnt(7)
  v_exp_f32 v107, v107
  v_mfma_f32_16x16x32_bf16 a[28:31], a[168:171], v[24:27], a[28:31]
  ds_read_b64_tr_b16 a[166:167], v220 offset:12288
  v_cvt_pk_bf16_f32 v105, v106, v107
  v_mfma_f32_16x16x32_bf16 a[32:35], a[176:179], v[0:3], 0
  v_exp_f32 v112, v112
  v_mfma_f32_16x16x32_bf16 a[32:35], a[180:183], v[32:35], a[32:35]
  ds_read_b64_tr_b16 a[168:169], v221 offset:0
  v_mfma_f32_16x16x32_bf16 a[36:39], a[180:183], v[40:43], 0
  v_exp_f32 v113, v113
  v_mfma_f32_16x16x32_bf16 a[36:39], a[176:179], v[8:11], a[36:39]
  ds_read_b64_tr_b16 a[170:171], v221 offset:4096
  v_cvt_pk_bf16_f32 v112, v112, v113
  v_mfma_f32_16x16x32_bf16 a[40:43], a[176:179], v[16:19], 0
  v_exp_f32 v114, v114
  v_mfma_f32_16x16x32_bf16 a[40:43], a[180:183], v[48:51], a[40:43]
  ds_read_b64_tr_b16 a[172:173], v221 offset:8192
  v_mfma_f32_16x16x32_bf16 a[44:47], a[180:183], v[56:59], 0
  s_waitcnt lgkmcnt(7)
  v_exp_f32 v115, v115
  v_mfma_f32_16x16x32_bf16 a[44:47], a[176:179], v[24:27], a[44:47]
  ds_read_b64_tr_b16 a[174:175], v221 offset:12288
  v_cvt_pk_bf16_f32 v113, v114, v115
  v_mfma_f32_16x16x32_bf16 a[48:51], a[184:187], v[0:3], 0
  v_exp_f32 v120, v120
  v_mfma_f32_16x16x32_bf16 a[48:51], a[188:191], v[32:35], a[48:51]
  ds_read_b64_tr_b16 a[176:177], v222 offset:0
  v_mfma_f32_16x16x32_bf16 a[52:55], a[188:191], v[40:43], 0
  v_exp_f32 v121, v121
  v_mfma_f32_16x16x32_bf16 a[52:55], a[184:187], v[8:11], a[52:55]
  ds_read_b64_tr_b16 a[178:179], v222 offset:4096
  v_cvt_pk_bf16_f32 v120, v120, v121
  v_mfma_f32_16x16x32_bf16 a[56:59], a[184:187], v[16:19], 0
  v_exp_f32 v122, v122
  v_mfma_f32_16x16x32_bf16 a[56:59], a[188:191], v[48:51], a[56:59]
  ds_read_b64_tr_b16 a[180:181], v222 offset:8192
  v_mfma_f32_16x16x32_bf16 a[60:63], a[188:191], v[56:59], 0
  s_waitcnt lgkmcnt(7)
  v_exp_f32 v123, v123
  v_mfma_f32_16x16x32_bf16 a[60:63], a[184:187], v[24:27], a[60:63]
  ds_read_b64_tr_b16 a[182:183], v222 offset:12288
  v_cvt_pk_bf16_f32 v121, v122, v123
  v_mfma_f32_16x16x32_bf16 a[64:67], a[160:163], v[0:3], 0
  v_exp_f32 v100, v100
  v_mfma_f32_16x16x32_bf16 a[64:67], a[164:167], v[32:35], a[64:67]
  ds_read_b64_tr_b16 a[184:185], v223 offset:0
  v_mfma_f32_16x16x32_bf16 a[68:71], a[164:167], v[40:43], 0
  v_exp_f32 v101, v101
  v_mfma_f32_16x16x32_bf16 a[68:71], a[160:163], v[8:11], a[68:71]
  ds_read_b64_tr_b16 a[186:187], v223 offset:4096
  v_cvt_pk_bf16_f32 v98, v100, v101
  v_mfma_f32_16x16x32_bf16 a[72:75], a[160:163], v[16:19], 0
  v_exp_f32 v102, v102
  v_mfma_f32_16x16x32_bf16 a[72:75], a[164:167], v[48:51], a[72:75]
  ds_read_b64_tr_b16 a[188:189], v223 offset:8192
  v_mfma_f32_16x16x32_bf16 a[76:79], a[164:167], v[56:59], 0
  s_waitcnt lgkmcnt(7)
  v_exp_f32 v103, v103
  v_mfma_f32_16x16x32_bf16 a[76:79], a[160:163], v[24:27], a[76:79]
  ds_read_b64_tr_b16 a[190:191], v223 offset:12288
  v_cvt_pk_bf16_f32 v99, v102, v103
  v_mfma_f32_16x16x32_bf16 a[80:83], a[168:171], v[0:3], 0
  s_waitcnt vmcnt(10)
  v_exp_f32 v108, v108
  v_mfma_f32_16x16x32_bf16 a[80:83], a[172:175], v[32:35], a[80:83]
  v_mfma_f32_16x16x32_bf16 a[84:87], a[172:175], v[40:43], 0
  s_barrier
  v_exp_f32 v109, v109
  v_mfma_f32_16x16x32_bf16 a[84:87], a[168:171], v[8:11], a[84:87]
  ds_read_b128 a[128:131], v212 offset:32768
  v_cvt_pk_bf16_f32 v106, v108, v109
  v_mfma_f32_16x16x32_bf16 a[88:91], a[168:171], v[16:19], 0
  v_exp_f32 v110, v110
  v_mfma_f32_16x16x32_bf16 a[88:91], a[172:175], v[48:51], a[88:91]
  ds_read_b128 a[132:135], v213 offset:32768
  v_mfma_f32_16x16x32_bf16 a[92:95], a[172:175], v[56:59], 0
  s_waitcnt lgkmcnt(6)
  v_exp_f32 v111, v111
  v_mfma_f32_16x16x32_bf16 a[92:95], a[168:171], v[24:27], a[92:95]
  ds_read_b128 a[136:139], v214 offset:32768
  v_cvt_pk_bf16_f32 v107, v110, v111
  v_mfma_f32_16x16x32_bf16 a[96:99], a[176:179], v[0:3], 0
  s_mul_i32 s38, s3, 20480
  v_exp_f32 v116, v116
  v_mfma_f32_16x16x32_bf16 a[96:99], a[180:183], v[32:35], a[96:99]
  ds_read_b128 a[140:143], v215 offset:32768
  buffer_load_dwordx4 a[212:215], v243, s[24:27], s38 offen sc1
  s_add_u32 s38, s38, 4096
  v_mfma_f32_16x16x32_bf16 a[100:103], a[180:183], v[40:43], 0
  v_exp_f32 v117, v117
  v_mfma_f32_16x16x32_bf16 a[100:103], a[176:179], v[8:11], a[100:103]
  v_cvt_pk_bf16_f32 v114, v116, v117
  v_mfma_f32_16x16x32_bf16 a[104:107], a[176:179], v[16:19], 0
  v_exp_f32 v118, v118
  v_mfma_f32_16x16x32_bf16 a[104:107], a[180:183], v[48:51], a[104:107]
  v_mfma_f32_16x16x32_bf16 a[108:111], a[180:183], v[56:59], 0
  s_waitcnt lgkmcnt(4)
  v_exp_f32 v119, v119
  v_mfma_f32_16x16x32_bf16 a[108:111], a[176:179], v[24:27], a[108:111]
  v_cvt_pk_bf16_f32 v115, v118, v119
  v_mfma_f32_16x16x32_bf16 a[112:115], a[184:187], v[0:3], 0
  v_exp_f32 v124, v124
  v_mfma_f32_16x16x32_bf16 a[112:115], a[188:191], v[32:35], a[112:115]
  v_mfma_f32_16x16x32_bf16 a[116:119], a[188:191], v[40:43], 0
  v_exp_f32 v125, v125
  v_mfma_f32_16x16x32_bf16 a[116:119], a[184:187], v[8:11], a[116:119]
  v_cvt_pk_bf16_f32 v122, v124, v125
  v_mfma_f32_16x16x32_bf16 a[120:123], a[184:187], v[16:19], 0
  v_exp_f32 v126, v126
  v_mfma_f32_16x16x32_bf16 a[120:123], a[188:191], v[48:51], a[120:123]
  v_mfma_f32_16x16x32_bf16 a[124:127], a[188:191], v[56:59], 0
  s_waitcnt lgkmcnt(0)
  v_exp_f32 v127, v127
  v_mfma_f32_16x16x32_bf16 a[124:127], a[184:187], v[24:27], a[124:127]
  v_cvt_pk_bf16_f32 v123, v126, v127
  v_mfma_f32_16x16x32_bf16 v[0:3], a[128:131], v[128:131], v[192:195]
  s_add_u32 m0, s28, 114688
  v_mfma_f32_16x16x32_bf16 v[0:3], a[132:135], v[132:135], v[0:3]
  ds_read_b128 a[144:147], v212 offset:36864
  v_mfma_f32_16x16x32_bf16 v[0:3], a[136:139], v[136:139], v[0:3]
  buffer_load_dwordx4 v236, s[16:19], s29 offen offset:0 lds
  v_mfma_f32_16x16x32_bf16 v[0:3], a[140:143], v[140:143], v[0:3]
  ds_read_b128 a[148:151], v213 offset:36864
  v_mfma_f32_16x16x32_bf16 v[8:11], a[140:143], v[156:159], v[196:199]
  buffer_load_dwordx4 v237, s[16:19], s29 offen offset:1024 lds
  v_mfma_f32_16x16x32_bf16 v[8:11], a[136:139], v[152:155], v[8:11]
  ds_read_b128 a[152:155], v214 offset:36864
  v_mfma_f32_16x16x32_bf16 v[8:11], a[132:135], v[148:151], v[8:11]
  buffer_load_dwordx4 v236, s[16:19], s29 offen offset:2048 lds
  v_mfma_f32_16x16x32_bf16 v[8:11], a[128:131], v[144:147], v[8:11]
  ds_read_b128 a[156:159], v215 offset:36864
  v_mfma_f32_16x16x32_bf16 v[16:19], a[128:131], v[160:163], v[200:203]
  v_exp_f32 v0, v0
  v_mfma_f32_16x16x32_bf16 v[16:19], a[132:135], v[164:167], v[16:19]
  buffer_load_dwordx4 v237, s[16:19], s29 offen offset:3072 lds
  v_mfma_f32_16x16x32_bf16 v[16:19], a[136:139], v[168:171], v[16:19]
  s_add_u32 s29, s29, 16384
  v_exp_f32 v1, v1
  v_mfma_f32_16x16x32_bf16 v[16:19], a[140:143], v[172:175], v[16:19]
  v_cvt_pk_bf16_f32 v0, v0, v1
  v_mfma_f32_16x16x32_bf16 v[24:27], a[140:143], v[188:191], v[204:207]
  s_add_u32 m0, s28, 0
  v_exp_f32 v2, v2
  v_mfma_f32_16x16x32_bf16 v[24:27], a[136:139], v[184:187], v[24:27]
  buffer_load_dwordx4 v232, s[12:15], s29 offen offset:0 lds
  v_mfma_f32_16x16x32_bf16 v[24:27], a[132:135], v[180:183], v[24:27]
  s_waitcnt lgkmcnt(0)
  v_exp_f32 v3, v3
  v_mfma_f32_16x16x32_bf16 v[24:27], a[128:131], v[176:179], v[24:27]
  v_cvt_pk_bf16_f32 v1, v2, v3
  v_mfma_f32_16x16x32_bf16 v[4:7], a[144:147], v[128:131], v[192:195]
  v_exp_f32 v8, v8
  v_mfma_f32_16x16x32_bf16 v[4:7], a[148:151], v[132:135], v[4:7]
  ds_read_b128 a[128:131], v212 offset:40960
  v_mfma_f32_16x16x32_bf16 v[4:7], a[152:155], v[136:139], v[4:7]
  v_exp_f32 v9, v9
  v_mfma_f32_16x16x32_bf16 v[4:7], a[156:159], v[140:143], v[4:7]
  ds_read_b128 a[132:135], v213 offset:40960
  v_cvt_pk_bf16_f32 v8, v8, v9
  v_mfma_f32_16x16x32_bf16 v[12:15], a[156:159], v[156:159], v[196:199]
  v_exp_f32 v10, v10
  v_mfma_f32_16x16x32_bf16 v[12:15], a[152:155], v[152:155], v[12:15]
  ds_read_b128 a[136:139], v214 offset:40960
  v_mfma_f32_16x16x32_bf16 v[12:15], a[148:151], v[148:151], v[12:15]
  v_exp_f32 v11, v11
  v_mfma_f32_16x16x32_bf16 v[12:15], a[144:147], v[144:147], v[12:15]
  ds_read_b128 a[140:143], v215 offset:40960
  v_cvt_pk_bf16_f32 v9, v10, v11
  v_mfma_f32_16x16x32_bf16 v[20:23], a[144:147], v[160:163], v[200:203]
  v_exp_f32 v16, v16
  v_mfma_f32_16x16x32_bf16 v[20:23], a[148:151], v[164:167], v[20:23]
  buffer_load_dwordx4 v233, s[12:15], s29 offen offset:1024 lds
  v_mfma_f32_16x16x32_bf16 v[20:23], a[152:155], v[168:171], v[20:23]
  v_exp_f32 v17, v17
  v_mfma_f32_16x16x32_bf16 v[20:23], a[156:159], v[172:175], v[20:23]
  v_cvt_pk_bf16_f32 v16, v16, v17
  v_mfma_f32_16x16x32_bf16 v[28:31], a[156:159], v[188:191], v[204:207]
  v_exp_f32 v18, v18
  v_mfma_f32_16x16x32_bf16 v[28:31], a[152:155], v[184:187], v[28:31]
  buffer_load_dwordx4 v234, s[12:15], s29 offen offset:2048 lds
  v_mfma_f32_16x16x32_bf16 v[28:31], a[148:151], v[180:183], v[28:31]
  s_waitcnt lgkmcnt(0)
  v_exp_f32 v19, v19
  v_mfma_f32_16x16x32_bf16 v[28:31], a[144:147], v[176:179], v[28:31]
  v_cvt_pk_bf16_f32 v17, v18, v19
  v_mfma_f32_16x16x32_bf16 v[32:35], a[128:131], v[128:131], v[192:195]
  v_exp_f32 v24, v24
  v_mfma_f32_16x16x32_bf16 v[32:35], a[132:135], v[132:135], v[32:35]
  ds_read_b128 a[144:147], v212 offset:45056
  v_mfma_f32_16x16x32_bf16 v[32:35], a[136:139], v[136:139], v[32:35]
  v_exp_f32 v25, v25
  v_mfma_f32_16x16x32_bf16 v[32:35], a[140:143], v[140:143], v[32:35]
  ds_read_b128 a[148:151], v213 offset:45056
  v_cvt_pk_bf16_f32 v24, v24, v25
  v_mfma_f32_16x16x32_bf16 v[40:43], a[140:143], v[156:159], v[196:199]
  v_exp_f32 v26, v26
  v_mfma_f32_16x16x32_bf16 v[40:43], a[136:139], v[152:155], v[40:43]
  ds_read_b128 a[152:155], v214 offset:45056
  v_mfma_f32_16x16x32_bf16 v[40:43], a[132:135], v[148:151], v[40:43]
  v_exp_f32 v27, v27
  v_mfma_f32_16x16x32_bf16 v[40:43], a[128:131], v[144:147], v[40:43]
  ds_read_b128 a[156:159], v215 offset:45056
  v_cvt_pk_bf16_f32 v25, v26, v27
  v_mfma_f32_16x16x32_bf16 v[48:51], a[128:131], v[160:163], v[200:203]
  v_exp_f32 v4, v4
  v_mfma_f32_16x16x32_bf16 v[48:51], a[132:135], v[164:167], v[48:51]
  buffer_load_dwordx4 v235, s[12:15], s29 offen offset:3072 lds
  v_mfma_f32_16x16x32_bf16 v[48:51], a[136:139], v[168:171], v[48:51]
  v_exp_f32 v5, v5
  v_mfma_f32_16x16x32_bf16 v[48:51], a[140:143], v[172:175], v[48:51]
  v_cvt_pk_bf16_f32 v2, v4, v5
  v_mfma_f32_16x16x32_bf16 v[56:59], a[140:143], v[188:191], v[204:207]
  v_exp_f32 v6, v6
  v_mfma_f32_16x16x32_bf16 v[56:59], a[136:139], v[184:187], v[56:59]
  s_add_u32 m0, s50, 1024
  v_mfma_f32_16x16x32_bf16 v[56:59], a[132:135], v[180:183], v[56:59]
  s_waitcnt lgkmcnt(0)
  v_exp_f32 v7, v7
  v_mfma_f32_16x16x32_bf16 v[56:59], a[128:131], v[176:179], v[56:59]
  buffer_load_dwordx4 v253, s[20:23], s35 offen lds
  v_cvt_pk_bf16_f32 v3, v6, v7
  v_mfma_f32_16x16x32_bf16 v[36:39], a[144:147], v[128:131], v[192:195]
  v_exp_f32 v12, v12
  v_mfma_f32_16x16x32_bf16 v[36:39], a[148:151], v[132:135], v[36:39]
  ds_read_b64_tr_b16 a[160:161], v216 offset:16384
  v_mfma_f32_16x16x32_bf16 v[36:39], a[152:155], v[136:139], v[36:39]
  v_exp_f32 v13, v13
  v_mfma_f32_16x16x32_bf16 v[36:39], a[156:159], v[140:143], v[36:39]
  ds_read_b64_tr_b16 a[162:163], v216 offset:20480
  v_cvt_pk_bf16_f32 v10, v12, v13
  v_mfma_f32_16x16x32_bf16 v[44:47], a[156:159], v[156:159], v[196:199]
  v_exp_f32 v14, v14
  v_mfma_f32_16x16x32_bf16 v[44:47], a[152:155], v[152:155], v[44:47]
  ds_read_b64_tr_b16 a[164:165], v216 offset:24576
  v_mfma_f32_16x16x32_bf16 v[44:47], a[148:151], v[148:151], v[44:47]
  v_exp_f32 v15, v15
  v_mfma_f32_16x16x32_bf16 v[44:47], a[144:147], v[144:147], v[44:47]
  ds_read_b64_tr_b16 a[166:167], v216 offset:28672
  v_cvt_pk_bf16_f32 v11, v14, v15
  v_mfma_f32_16x16x32_bf16 v[52:55], a[144:147], v[160:163], v[200:203]
  v_exp_f32 v20, v20
  v_mfma_f32_16x16x32_bf16 v[52:55], a[148:151], v[164:167], v[52:55]
  ds_read_b64_tr_b16 a[168:169], v217 offset:16384
  v_mfma_f32_16x16x32_bf16 v[52:55], a[152:155], v[168:171], v[52:55]
  v_exp_f32 v21, v21
  v_mfma_f32_16x16x32_bf16 v[52:55], a[156:159], v[172:175], v[52:55]
  ds_read_b64_tr_b16 a[170:171], v217 offset:20480
  v_cvt_pk_bf16_f32 v18, v20, v21
  v_mfma_f32_16x16x32_bf16 v[60:63], a[156:159], v[188:191], v[204:207]
  v_exp_f32 v22, v22
  v_mfma_f32_16x16x32_bf16 v[60:63], a[152:155], v[184:187], v[60:63]
  ds_read_b64_tr_b16 a[172:173], v217 offset:24576
  v_mfma_f32_16x16x32_bf16 v[60:63], a[148:151], v[180:183], v[60:63]
  v_exp_f32 v23, v23
  v_mfma_f32_16x16x32_bf16 v[60:63], a[144:147], v[176:179], v[60:63]
  ds_read_b64_tr_b16 a[174:175], v217 offset:28672
  v_cvt_pk_bf16_f32 v19, v22, v23
  v_mfma_f32_16x16x32_bf16 a[192:195], a[208:211], v[64:67], a[192:195]
  v_exp_f32 v28, v28
  v_mfma_f32_16x16x32_bf16 a[192:195], a[208:211], v[96:99], a[192:195]
  ds_read_b64_tr_b16 a[176:177], v218 offset:16384
  v_mfma_f32_16x16x32_bf16 a[196:199], a[208:211], v[72:75], a[196:199]
  v_exp_f32 v29, v29
  v_mfma_f32_16x16x32_bf16 a[196:199], a[208:211], v[104:107], a[196:199]
  ds_read_b64_tr_b16 a[178:179], v218 offset:20480
  v_cvt_pk_bf16_f32 v26, v28, v29
  v_mfma_f32_16x16x32_bf16 a[200:203], a[208:211], v[80:83], a[200:203]
  v_exp_f32 v30, v30
  v_mfma_f32_16x16x32_bf16 a[200:203], a[208:211], v[112:115], a[200:203]
  ds_read_b64_tr_b16 a[180:181], v218 offset:24576
  v_mfma_f32_16x16x32_bf16 a[204:207], a[208:211], v[88:91], a[204:207]
  s_waitcnt lgkmcnt(7)
  v_exp_f32 v31, v31
  v_mfma_f32_16x16x32_bf16 a[204:207], a[208:211], v[120:123], a[204:207]
  ds_read_b64_tr_b16 a[182:183], v218 offset:28672
  v_cvt_pk_bf16_f32 v27, v30, v31
  v_mfma_f32_16x16x32_bf16 a[0:3], a[160:163], v[64:67], a[0:3]
  v_exp_f32 v32, v32
  v_mfma_f32_16x16x32_bf16 a[0:3], a[164:167], v[96:99], a[0:3]
  ds_read_b64_tr_b16 a[184:185], v219 offset:16384
  v_mfma_f32_16x16x32_bf16 a[4:7], a[164:167], v[104:107], a[4:7]
  v_exp_f32 v33, v33
  v_mfma_f32_16x16x32_bf16 a[4:7], a[160:163], v[72:75], a[4:7]
  ds_read_b64_tr_b16 a[186:187], v219 offset:20480
  v_cvt_pk_bf16_f32 v32, v32, v33
  v_mfma_f32_16x16x32_bf16 a[8:11], a[160:163], v[80:83], a[8:11]
  v_exp_f32 v34, v34
  v_mfma_f32_16x16x32_bf16 a[8:11], a[164:167], v[112:115], a[8:11]
  ds_read_b64_tr_b16 a[188:189], v219 offset:24576
  v_mfma_f32_16x16x32_bf16 a[12:15], a[164:167], v[120:123], a[12:15]
  s_waitcnt lgkmcnt(7)
  v_exp_f32 v35, v35
  v_mfma_f32_16x16x32_bf16 a[12:15], a[160:163], v[88:91], a[12:15]
  ds_read_b64_tr_b16 a[190:191], v219 offset:28672
  v_cvt_pk_bf16_f32 v33, v34, v35
  v_mfma_f32_16x16x32_bf16 a[16:19], a[168:171], v[64:67], a[16:19]
  v_exp_f32 v40, v40
  v_mfma_f32_16x16x32_bf16 a[16:19], a[172:175], v[96:99], a[16:19]
  ds_read_b64_tr_b16 a[160:161], v220 offset:16384
  v_mfma_f32_16x16x32_bf16 a[20:23], a[172:175], v[104:107], a[20:23]
  v_exp_f32 v41, v41
  v_mfma_f32_16x16x32_bf16 a[20:23], a[168:171], v[72:75], a[20:23]
  ds_read_b64_tr_b16 a[162:163], v220 offset:20480
  v_cvt_pk_bf16_f32 v40, v40, v41
  v_mfma_f32_16x16x32_bf16 a[24:27], a[168:171], v[80:83], a[24:27]
  v_exp_f32 v42, v42
  v_mfma_f32_16x16x32_bf16 a[24:27], a[172:175], v[112:115], a[24:27]
  ds_read_b64_tr_b16 a[164:165], v220 offset:24576
  v_mfma_f32_16x16x32_bf16 a[28:31], a[172:175], v[120:123], a[28:31]
  s_waitcnt lgkmcnt(7)
  v_exp_f32 v43, v43
  v_mfma_f32_16x16x32_bf16 a[28:31], a[168:171], v[88:91], a[28:31]
  ds_read_b64_tr_b16 a[166:167], v220 offset:28672
  v_cvt_pk_bf16_f32 v41, v42, v43
  v_mfma_f32_16x16x32_bf16 a[32:35], a[176:179], v[64:67], a[32:35]
  v_exp_f32 v48, v48
  v_mfma_f32_16x16x32_bf16 a[32:35], a[180:183], v[96:99], a[32:35]
  ds_read_b64_tr_b16 a[168:169], v221 offset:16384
  v_mfma_f32_16x16x32_bf16 a[36:39], a[180:183], v[104:107], a[36:39]
  v_exp_f32 v49, v49
  v_mfma_f32_16x16x32_bf16 a[36:39], a[176:179], v[72:75], a[36:39]
  ds_read_b64_tr_b16 a[170:171], v221 offset:20480
  v_cvt_pk_bf16_f32 v48, v48, v49
  v_mfma_f32_16x16x32_bf16 a[40:43], a[176:179], v[80:83], a[40:43]
  v_exp_f32 v50, v50
  v_mfma_f32_16x16x32_bf16 a[40:43], a[180:183], v[112:115], a[40:43]
  ds_read_b64_tr_b16 a[172:173], v221 offset:24576
  v_mfma_f32_16x16x32_bf16 a[44:47], a[180:183], v[120:123], a[44:47]
  s_waitcnt lgkmcnt(7)
  v_exp_f32 v51, v51
  v_mfma_f32_16x16x32_bf16 a[44:47], a[176:179], v[88:91], a[44:47]
  ds_read_b64_tr_b16 a[174:175], v221 offset:28672
  v_cvt_pk_bf16_f32 v49, v50, v51
  v_mfma_f32_16x16x32_bf16 a[48:51], a[184:187], v[64:67], a[48:51]
  v_exp_f32 v56, v56
  v_mfma_f32_16x16x32_bf16 a[48:51], a[188:191], v[96:99], a[48:51]
  ds_read_b64_tr_b16 a[176:177], v222 offset:16384
  v_mfma_f32_16x16x32_bf16 a[52:55], a[188:191], v[104:107], a[52:55]
  v_exp_f32 v57, v57
  v_mfma_f32_16x16x32_bf16 a[52:55], a[184:187], v[72:75], a[52:55]
  ds_read_b64_tr_b16 a[178:179], v222 offset:20480
  v_cvt_pk_bf16_f32 v56, v56, v57
  v_mfma_f32_16x16x32_bf16 a[56:59], a[184:187], v[80:83], a[56:59]
  v_exp_f32 v58, v58
  v_mfma_f32_16x16x32_bf16 a[56:59], a[188:191], v[112:115], a[56:59]
  ds_read_b64_tr_b16 a[180:181], v222 offset:24576
  v_mfma_f32_16x16x32_bf16 a[60:63], a[188:191], v[120:123], a[60:63]
  s_waitcnt lgkmcnt(7)
  v_exp_f32 v59, v59
  v_mfma_f32_16x16x32_bf16 a[60:63], a[184:187], v[88:91], a[60:63]
  ds_read_b64_tr_b16 a[182:183], v222 offset:28672
  v_cvt_pk_bf16_f32 v57, v58, v59
  v_mfma_f32_16x16x32_bf16 a[64:67], a[160:163], v[64:67], a[64:67]
  v_exp_f32 v36, v36
  v_mfma_f32_16x16x32_bf16 a[64:67], a[164:167], v[96:99], a[64:67]
  ds_read_b64_tr_b16 a[184:185], v223 offset:16384
  v_mfma_f32_16x16x32_bf16 a[68:71], a[164:167], v[104:107], a[68:71]
  v_exp_f32 v37, v37
  v_mfma_f32_16x16x32_bf16 a[68:71], a[160:163], v[72:75], a[68:71]
  ds_read_b64_tr_b16 a[186:187], v223 offset:20480
  v_cvt_pk_bf16_f32 v34, v36, v37
  v_mfma_f32_16x16x32_bf16 a[72:75], a[160:163], v[80:83], a[72:75]
  v_exp_f32 v38, v38
  v_mfma_f32_16x16x32_bf16 a[72:75], a[164:167], v[112:115], a[72:75]
  ds_read_b64_tr_b16 a[188:189], v223 offset:24576
  v_mfma_f32_16x16x32_bf16 a[76:79], a[164:167], v[120:123], a[76:79]
  s_waitcnt lgkmcnt(7)
  v_exp_f32 v39, v39
  v_mfma_f32_16x16x32_bf16 a[76:79], a[160:163], v[88:91], a[76:79]
  ds_read_b64_tr_b16 a[190:191], v223 offset:28672
  v_cvt_pk_bf16_f32 v35, v38, v39
  v_mfma_f32_16x16x32_bf16 a[80:83], a[168:171], v[64:67], a[80:83]
  s_waitcnt vmcnt(11)
  v_exp_f32 v44, v44
  v_mfma_f32_16x16x32_bf16 a[80:83], a[172:175], v[96:99], a[80:83]
  v_mfma_f32_16x16x32_bf16 a[84:87], a[172:175], v[104:107], a[84:87]
  s_barrier
  v_exp_f32 v45, v45
  v_mfma_f32_16x16x32_bf16 a[84:87], a[168:171], v[72:75], a[84:87]
  ds_read_b128 a[128:131], v212 offset:49152
  v_cvt_pk_bf16_f32 v42, v44, v45
  v_mfma_f32_16x16x32_bf16 a[88:91], a[168:171], v[80:83], a[88:91]
  v_exp_f32 v46, v46
  v_mfma_f32_16x16x32_bf16 a[88:91], a[172:175], v[112:115], a[88:91]
  ds_read_b128 a[132:135], v213 offset:49152
  v_mfma_f32_16x16x32_bf16 a[92:95], a[172:175], v[120:123], a[92:95]
  s_waitcnt lgkmcnt(6)
  v_exp_f32 v47, v47
  v_mfma_f32_16x16x32_bf16 a[92:95], a[168:171], v[88:91], a[92:95]
  ds_read_b128 a[136:139], v214 offset:49152
  v_cvt_pk_bf16_f32 v43, v46, v47
  v_mfma_f32_16x16x32_bf16 a[96:99], a[176:179], v[64:67], a[96:99]
  v_exp_f32 v52, v52
  v_mfma_f32_16x16x32_bf16 a[96:99], a[180:183], v[96:99], a[96:99]
  ds_read_b128 a[140:143], v215 offset:49152
  buffer_load_dwordx4 a[216:219], v243, s[24:27], s38 offen sc1
  s_add_u32 s38, s38, 4096
  v_mfma_f32_16x16x32_bf16 a[100:103], a[180:183], v[104:107], a[100:103]
  v_exp_f32 v53, v53
  v_mfma_f32_16x16x32_bf16 a[100:103], a[176:179], v[72:75], a[100:103]
  v_cvt_pk_bf16_f32 v50, v52, v53
  v_mfma_f32_16x16x32_bf16 a[104:107], a[176:179], v[80:83], a[104:107]
  v_exp_f32 v54, v54
  v_mfma_f32_16x16x32_bf16 a[104:107], a[180:183], v[112:115], a[104:107]
  v_mfma_f32_16x16x32_bf16 a[108:111], a[180:183], v[120:123], a[108:111]
  s_waitcnt lgkmcnt(4)
  v_exp_f32 v55, v55
  v_mfma_f32_16x16x32_bf16 a[108:111], a[176:179], v[88:91], a[108:111]
  v_cvt_pk_bf16_f32 v51, v54, v55
  v_mfma_f32_16x16x32_bf16 a[112:115], a[184:187], v[64:67], a[112:115]
  v_exp_f32 v60, v60
  v_mfma_f32_16x16x32_bf16 a[112:115], a[188:191], v[96:99], a[112:115]
  v_mfma_f32_16x16x32_bf16 a[116:119], a[188:191], v[104:107], a[116:119]
  v_exp_f32 v61, v61
  v_mfma_f32_16x16x32_bf16 a[116:119], a[184:187], v[72:75], a[116:119]
  v_cvt_pk_bf16_f32 v58, v60, v61
  v_mfma_f32_16x16x32_bf16 a[120:123], a[184:187], v[80:83], a[120:123]
  v_exp_f32 v62, v62
  v_mfma_f32_16x16x32_bf16 a[120:123], a[188:191], v[112:115], a[120:123]
  v_mfma_f32_16x16x32_bf16 a[124:127], a[188:191], v[120:123], a[124:127]
  s_waitcnt lgkmcnt(0)
  v_exp_f32 v63, v63
  v_mfma_f32_16x16x32_bf16 a[124:127], a[184:187], v[88:91], a[124:127]
  v_cvt_pk_bf16_f32 v59, v62, v63
  v_mfma_f32_16x16x32_bf16 v[64:67], a[128:131], v[128:131], v[192:195]
  s_add_u32 m0, s28, 65536
  v_mfma_f32_16x16x32_bf16 v[64:67], a[132:135], v[132:135], v[64:67]
  ds_read_b128 a[144:147], v212 offset:53248
  v_mfma_f32_16x16x32_bf16 v[64:67], a[136:139], v[136:139], v[64:67]
  buffer_load_dwordx4 v236, s[16:19], s29 offen offset:0 lds
  v_mfma_f32_16x16x32_bf16 v[64:67], a[140:143], v[140:143], v[64:67]
  ds_read_b128 a[148:151], v213 offset:53248
  v_mfma_f32_16x16x32_bf16 v[72:75], a[140:143], v[156:159], v[196:199]
  buffer_load_dwordx4 v237, s[16:19], s29 offen offset:1024 lds
  v_mfma_f32_16x16x32_bf16 v[72:75], a[136:139], v[152:155], v[72:75]
  ds_read_b128 a[152:155], v214 offset:53248
  v_mfma_f32_16x16x32_bf16 v[72:75], a[132:135], v[148:151], v[72:75]
  buffer_load_dwordx4 v236, s[16:19], s29 offen offset:2048 lds
  v_mfma_f32_16x16x32_bf16 v[72:75], a[128:131], v[144:147], v[72:75]
  ds_read_b128 a[156:159], v215 offset:53248
  v_mfma_f32_16x16x32_bf16 v[80:83], a[128:131], v[160:163], v[200:203]
  v_exp_f32 v64, v64
  v_mfma_f32_16x16x32_bf16 v[80:83], a[132:135], v[164:167], v[80:83]
  buffer_load_dwordx4 v237, s[16:19], s29 offen offset:3072 lds
  v_mfma_f32_16x16x32_bf16 v[80:83], a[136:139], v[168:171], v[80:83]
  s_add_u32 s29, s29, 16384
  v_exp_f32 v65, v65
  v_mfma_f32_16x16x32_bf16 v[80:83], a[140:143], v[172:175], v[80:83]
  v_cvt_pk_bf16_f32 v64, v64, v65
  v_mfma_f32_16x16x32_bf16 v[88:91], a[140:143], v[188:191], v[204:207]
  s_add_u32 m0, s28, 16384
  v_exp_f32 v66, v66
  v_mfma_f32_16x16x32_bf16 v[88:91], a[136:139], v[184:187], v[88:91]
  buffer_load_dwordx4 v232, s[12:15], s29 offen offset:0 lds
  v_mfma_f32_16x16x32_bf16 v[88:91], a[132:135], v[180:183], v[88:91]
  s_waitcnt lgkmcnt(0)
  v_exp_f32 v67, v67
  v_mfma_f32_16x16x32_bf16 v[88:91], a[128:131], v[176:179], v[88:91]
  v_cvt_pk_bf16_f32 v65, v66, v67
  v_mfma_f32_16x16x32_bf16 v[68:71], a[144:147], v[128:131], v[192:195]
  v_exp_f32 v72, v72
  v_mfma_f32_16x16x32_bf16 v[68:71], a[148:151], v[132:135], v[68:71]
  ds_read_b128 a[128:131], v212 offset:57344
  v_mfma_f32_16x16x32_bf16 v[68:71], a[152:155], v[136:139], v[68:71]
  v_exp_f32 v73, v73
  v_mfma_f32_16x16x32_bf16 v[68:71], a[156:159], v[140:143], v[68:71]
  ds_read_b128 a[132:135], v213 offset:57344
  v_cvt_pk_bf16_f32 v72, v72, v73
  v_mfma_f32_16x16x32_bf16 v[76:79], a[156:159], v[156:159], v[196:199]
  v_exp_f32 v74, v74
  v_mfma_f32_16x16x32_bf16 v[76:79], a[152:155], v[152:155], v[76:79]
  ds_read_b128 a[136:139], v214 offset:57344
  v_mfma_f32_16x16x32_bf16 v[76:79], a[148:151], v[148:151], v[76:79]
  v_exp_f32 v75, v75
  v_mfma_f32_16x16x32_bf16 v[76:79], a[144:147], v[144:147], v[76:79]
  ds_read_b128 a[140:143], v215 offset:57344
  v_cvt_pk_bf16_f32 v73, v74, v75
  v_mfma_f32_16x16x32_bf16 v[84:87], a[144:147], v[160:163], v[200:203]
  v_exp_f32 v80, v80
  v_mfma_f32_16x16x32_bf16 v[84:87], a[148:151], v[164:167], v[84:87]
  buffer_load_dwordx4 v233, s[12:15], s29 offen offset:1024 lds
  v_mfma_f32_16x16x32_bf16 v[84:87], a[152:155], v[168:171], v[84:87]
  v_exp_f32 v81, v81
  v_mfma_f32_16x16x32_bf16 v[84:87], a[156:159], v[172:175], v[84:87]
  v_cvt_pk_bf16_f32 v80, v80, v81
  v_mfma_f32_16x16x32_bf16 v[92:95], a[156:159], v[188:191], v[204:207]
  v_exp_f32 v82, v82
  v_mfma_f32_16x16x32_bf16 v[92:95], a[152:155], v[184:187], v[92:95]
  buffer_load_dwordx4 v234, s[12:15], s29 offen offset:2048 lds
  v_mfma_f32_16x16x32_bf16 v[92:95], a[148:151], v[180:183], v[92:95]
  s_waitcnt lgkmcnt(0)
  v_exp_f32 v83, v83
  v_mfma_f32_16x16x32_bf16 v[92:95], a[144:147], v[176:179], v[92:95]
  v_cvt_pk_bf16_f32 v81, v82, v83
  v_mfma_f32_16x16x32_bf16 v[96:99], a[128:131], v[128:131], v[192:195]
  v_exp_f32 v88, v88
  v_mfma_f32_16x16x32_bf16 v[96:99], a[132:135], v[132:135], v[96:99]
  ds_read_b128 a[144:147], v212 offset:61440
  v_mfma_f32_16x16x32_bf16 v[96:99], a[136:139], v[136:139], v[96:99]
  v_exp_f32 v89, v89
  v_mfma_f32_16x16x32_bf16 v[96:99], a[140:143], v[140:143], v[96:99]
  ds_read_b128 a[148:151], v213 offset:61440
  v_cvt_pk_bf16_f32 v88, v88, v89
  v_mfma_f32_16x16x32_bf16 v[104:107], a[140:143], v[156:159], v[196:199]
  v_exp_f32 v90, v90
  v_mfma_f32_16x16x32_bf16 v[104:107], a[136:139], v[152:155], v[104:107]
  ds_read_b128 a[152:155], v214 offset:61440
  v_mfma_f32_16x16x32_bf16 v[104:107], a[132:135], v[148:151], v[104:107]
  v_exp_f32 v91, v91
  v_mfma_f32_16x16x32_bf16 v[104:107], a[128:131], v[144:147], v[104:107]
  ds_read_b128 a[156:159], v215 offset:61440
  v_cvt_pk_bf16_f32 v89, v90, v91
  v_mfma_f32_16x16x32_bf16 v[112:115], a[128:131], v[160:163], v[200:203]
  v_exp_f32 v68, v68
  v_mfma_f32_16x16x32_bf16 v[112:115], a[132:135], v[164:167], v[112:115]
  buffer_load_dwordx4 v235, s[12:15], s29 offen offset:3072 lds
  v_mfma_f32_16x16x32_bf16 v[112:115], a[136:139], v[168:171], v[112:115]
  v_exp_f32 v69, v69
  v_mfma_f32_16x16x32_bf16 v[112:115], a[140:143], v[172:175], v[112:115]
  v_cvt_pk_bf16_f32 v66, v68, v69
  v_mfma_f32_16x16x32_bf16 v[120:123], a[140:143], v[188:191], v[204:207]
  v_exp_f32 v70, v70
  v_mfma_f32_16x16x32_bf16 v[120:123], a[136:139], v[184:187], v[120:123]
  s_add_u32 m0, s50, 4096
  v_mfma_f32_16x16x32_bf16 v[120:123], a[132:135], v[180:183], v[120:123]
  s_waitcnt lgkmcnt(0)
  v_exp_f32 v71, v71
  v_mfma_f32_16x16x32_bf16 v[120:123], a[128:131], v[176:179], v[120:123]
  buffer_load_dwordx4 v253, s[44:47], s35 offen lds
  s_add_u32 s35, s35, 221184
  v_cvt_pk_bf16_f32 v67, v70, v71
  v_mfma_f32_16x16x32_bf16 v[100:103], a[144:147], v[128:131], v[192:195]
  v_exp_f32 v76, v76
  v_mfma_f32_16x16x32_bf16 v[100:103], a[148:151], v[132:135], v[100:103]
  ds_read_b64_tr_b16 a[160:161], v216 offset:32768
  v_lshrrev_b32 v254, 4, v242
  v_mfma_f32_16x16x32_bf16 v[100:103], a[152:155], v[136:139], v[100:103]
  v_exp_f32 v77, v77
  v_mfma_f32_16x16x32_bf16 v[100:103], a[156:159], v[140:143], v[100:103]
  ds_read_b64_tr_b16 a[162:163], v216 offset:36864
  v_cvt_pk_bf16_f32 v74, v76, v77
  v_mfma_f32_16x16x32_bf16 v[108:111], a[156:159], v[156:159], v[196:199]
  v_exp_f32 v78, v78
  v_mfma_f32_16x16x32_bf16 v[108:111], a[152:155], v[152:155], v[108:111]
  ds_read_b64_tr_b16 a[164:165], v216 offset:40960
  v_lshrrev_b32 v254, 5, v254
  v_mfma_f32_16x16x32_bf16 v[108:111], a[148:151], v[148:151], v[108:111]
  v_exp_f32 v79, v79
  v_mfma_f32_16x16x32_bf16 v[108:111], a[144:147], v[144:147], v[108:111]
  ds_read_b64_tr_b16 a[166:167], v216 offset:45056
  v_cvt_pk_bf16_f32 v75, v78, v79
  v_mfma_f32_16x16x32_bf16 v[116:119], a[144:147], v[160:163], v[200:203]
  v_exp_f32 v84, v84
  v_mfma_f32_16x16x32_bf16 v[116:119], a[148:151], v[164:167], v[116:119]
  ds_read_b64_tr_b16 a[168:169], v217 offset:32768
  v_lshl_add_u32 v253, v254, 30, v253
  v_mfma_f32_16x16x32_bf16 v[116:119], a[152:155], v[168:171], v[116:119]
  v_exp_f32 v85, v85
  v_mfma_f32_16x16x32_bf16 v[116:119], a[156:159], v[172:175], v[116:119]
  ds_read_b64_tr_b16 a[170:171], v217 offset:36864
  v_cvt_pk_bf16_f32 v82, v84, v85
  v_mfma_f32_16x16x32_bf16 v[124:127], a[156:159], v[188:191], v[204:207]
  v_exp_f32 v86, v86
  v_mfma_f32_16x16x32_bf16 v[124:127], a[152:155], v[184:187], v[124:127]
  ds_read_b64_tr_b16 a[172:173], v217 offset:40960
  v_mfma_f32_16x16x32_bf16 v[124:127], a[148:151], v[180:183], v[124:127]
  v_exp_f32 v87, v87
  v_mfma_f32_16x16x32_bf16 v[124:127], a[144:147], v[176:179], v[124:127]
  ds_read_b64_tr_b16 a[174:175], v217 offset:45056
  v_cvt_pk_bf16_f32 v83, v86, v87
  v_mfma_f32_16x16x32_bf16 a[192:195], a[208:211], v[0:3], a[192:195]
  v_exp_f32 v92, v92
  v_mfma_f32_16x16x32_bf16 a[192:195], a[208:211], v[32:35], a[192:195]
  ds_read_b64_tr_b16 a[176:177], v218 offset:32768
  v_mfma_f32_16x16x32_bf16 a[196:199], a[208:211], v[8:11], a[196:199]
  v_exp_f32 v93, v93
  v_mfma_f32_16x16x32_bf16 a[196:199], a[208:211], v[40:43], a[196:199]
  ds_read_b64_tr_b16 a[178:179], v218 offset:36864
  v_cvt_pk_bf16_f32 v90, v92, v93
  v_mfma_f32_16x16x32_bf16 a[200:203], a[208:211], v[16:19], a[200:203]
  v_exp_f32 v94, v94
  v_mfma_f32_16x16x32_bf16 a[200:203], a[208:211], v[48:51], a[200:203]
  ds_read_b64_tr_b16 a[180:181], v218 offset:40960
  v_mfma_f32_16x16x32_bf16 a[204:207], a[208:211], v[24:27], a[204:207]
  s_waitcnt lgkmcnt(7)
  v_exp_f32 v95, v95
  v_mfma_f32_16x16x32_bf16 a[204:207], a[208:211], v[56:59], a[204:207]
  ds_read_b64_tr_b16 a[182:183], v218 offset:45056
  v_cvt_pk_bf16_f32 v91, v94, v95
  v_mfma_f32_16x16x32_bf16 a[0:3], a[160:163], v[0:3], a[0:3]
  v_exp_f32 v96, v96
  v_mfma_f32_16x16x32_bf16 a[0:3], a[164:167], v[32:35], a[0:3]
  ds_read_b64_tr_b16 a[184:185], v219 offset:32768
  v_mfma_f32_16x16x32_bf16 a[4:7], a[164:167], v[40:43], a[4:7]
  v_exp_f32 v97, v97
  v_mfma_f32_16x16x32_bf16 a[4:7], a[160:163], v[8:11], a[4:7]
  ds_read_b64_tr_b16 a[186:187], v219 offset:36864
  v_cvt_pk_bf16_f32 v96, v96, v97
  v_mfma_f32_16x16x32_bf16 a[8:11], a[160:163], v[16:19], a[8:11]
  v_exp_f32 v98, v98
  v_mfma_f32_16x16x32_bf16 a[8:11], a[164:167], v[48:51], a[8:11]
  ds_read_b64_tr_b16 a[188:189], v219 offset:40960
  v_mfma_f32_16x16x32_bf16 a[12:15], a[164:167], v[56:59], a[12:15]
  s_waitcnt lgkmcnt(7)
  v_exp_f32 v99, v99
  v_mfma_f32_16x16x32_bf16 a[12:15], a[160:163], v[24:27], a[12:15]
  ds_read_b64_tr_b16 a[190:191], v219 offset:45056
  v_cvt_pk_bf16_f32 v97, v98, v99
  v_mfma_f32_16x16x32_bf16 a[16:19], a[168:171], v[0:3], a[16:19]
  v_exp_f32 v104, v104
  v_mfma_f32_16x16x32_bf16 a[16:19], a[172:175], v[32:35], a[16:19]
  ds_read_b64_tr_b16 a[160:161], v220 offset:32768
  v_mfma_f32_16x16x32_bf16 a[20:23], a[172:175], v[40:43], a[20:23]
  v_exp_f32 v105, v105
  v_mfma_f32_16x16x32_bf16 a[20:23], a[168:171], v[8:11], a[20:23]
  ds_read_b64_tr_b16 a[162:163], v220 offset:36864
  v_cvt_pk_bf16_f32 v104, v104, v105
  v_mfma_f32_16x16x32_bf16 a[24:27], a[168:171], v[16:19], a[24:27]
  v_exp_f32 v106, v106
  v_mfma_f32_16x16x32_bf16 a[24:27], a[172:175], v[48:51], a[24:27]
  ds_read_b64_tr_b16 a[164:165], v220 offset:40960
  v_mfma_f32_16x16x32_bf16 a[28:31], a[172:175], v[56:59], a[28:31]
  s_waitcnt lgkmcnt(7)
  v_exp_f32 v107, v107
  v_mfma_f32_16x16x32_bf16 a[28:31], a[168:171], v[24:27], a[28:31]
  ds_read_b64_tr_b16 a[166:167], v220 offset:45056
  v_cvt_pk_bf16_f32 v105, v106, v107
  v_mfma_f32_16x16x32_bf16 a[32:35], a[176:179], v[0:3], a[32:35]
  v_exp_f32 v112, v112
  v_mfma_f32_16x16x32_bf16 a[32:35], a[180:183], v[32:35], a[32:35]
  ds_read_b64_tr_b16 a[168:169], v221 offset:32768
  v_mfma_f32_16x16x32_bf16 a[36:39], a[180:183], v[40:43], a[36:39]
  v_exp_f32 v113, v113
  v_mfma_f32_16x16x32_bf16 a[36:39], a[176:179], v[8:11], a[36:39]
  ds_read_b64_tr_b16 a[170:171], v221 offset:36864
  v_cvt_pk_bf16_f32 v112, v112, v113
  v_mfma_f32_16x16x32_bf16 a[40:43], a[176:179], v[16:19], a[40:43]
  v_exp_f32 v114, v114
  v_mfma_f32_16x16x32_bf16 a[40:43], a[180:183], v[48:51], a[40:43]
  ds_read_b64_tr_b16 a[172:173], v221 offset:40960
  v_mfma_f32_16x16x32_bf16 a[44:47], a[180:183], v[56:59], a[44:47]
  s_waitcnt lgkmcnt(7)
  v_exp_f32 v115, v115
  v_mfma_f32_16x16x32_bf16 a[44:47], a[176:179], v[24:27], a[44:47]
  ds_read_b64_tr_b16 a[174:175], v221 offset:45056
  v_cvt_pk_bf16_f32 v113, v114, v115
  v_mfma_f32_16x16x32_bf16 a[48:51], a[184:187], v[0:3], a[48:51]
  v_exp_f32 v120, v120
  v_mfma_f32_16x16x32_bf16 a[48:51], a[188:191], v[32:35], a[48:51]
  ds_read_b64_tr_b16 a[176:177], v222 offset:32768
  v_mfma_f32_16x16x32_bf16 a[52:55], a[188:191], v[40:43], a[52:55]
  v_exp_f32 v121, v121
  v_mfma_f32_16x16x32_bf16 a[52:55], a[184:187], v[8:11], a[52:55]
  ds_read_b64_tr_b16 a[178:179], v222 offset:36864
  v_cvt_pk_bf16_f32 v120, v120, v121
  v_mfma_f32_16x16x32_bf16 a[56:59], a[184:187], v[16:19], a[56:59]
  v_exp_f32 v122, v122
  v_mfma_f32_16x16x32_bf16 a[56:59], a[188:191], v[48:51], a[56:59]
  ds_read_b64_tr_b16 a[180:181], v222 offset:40960
  v_mfma_f32_16x16x32_bf16 a[60:63], a[188:191], v[56:59], a[60:63]
  s_waitcnt lgkmcnt(7)
  v_exp_f32 v123, v123
  v_mfma_f32_16x16x32_bf16 a[60:63], a[184:187], v[24:27], a[60:63]
  ds_read_b64_tr_b16 a[182:183], v222 offset:45056
  v_cvt_pk_bf16_f32 v121, v122, v123
  v_mfma_f32_16x16x32_bf16 a[64:67], a[160:163], v[0:3], a[64:67]
  v_exp_f32 v100, v100
  v_mfma_f32_16x16x32_bf16 a[64:67], a[164:167], v[32:35], a[64:67]
  ds_read_b64_tr_b16 a[184:185], v223 offset:32768
  v_mfma_f32_16x16x32_bf16 a[68:71], a[164:167], v[40:43], a[68:71]
  v_exp_f32 v101, v101
  v_mfma_f32_16x16x32_bf16 a[68:71], a[160:163], v[8:11], a[68:71]
  ds_read_b64_tr_b16 a[186:187], v223 offset:36864
  v_cvt_pk_bf16_f32 v98, v100, v101
  v_mfma_f32_16x16x32_bf16 a[72:75], a[160:163], v[16:19], a[72:75]
  v_exp_f32 v102, v102
  v_mfma_f32_16x16x32_bf16 a[72:75], a[164:167], v[48:51], a[72:75]
  ds_read_b64_tr_b16 a[188:189], v223 offset:40960
  v_mfma_f32_16x16x32_bf16 a[76:79], a[164:167], v[56:59], a[76:79]
  s_waitcnt lgkmcnt(7)
  v_exp_f32 v103, v103
  v_mfma_f32_16x16x32_bf16 a[76:79], a[160:163], v[24:27], a[76:79]
  ds_read_b64_tr_b16 a[190:191], v223 offset:45056
  v_cvt_pk_bf16_f32 v99, v102, v103
  v_mfma_f32_16x16x32_bf16 a[80:83], a[168:171], v[0:3], a[80:83]
  s_waitcnt vmcnt(11)
  v_exp_f32 v108, v108
  v_mfma_f32_16x16x32_bf16 a[80:83], a[172:175], v[32:35], a[80:83]
  v_mfma_f32_16x16x32_bf16 a[84:87], a[172:175], v[40:43], a[84:87]
  s_barrier
  v_exp_f32 v109, v109
  v_mfma_f32_16x16x32_bf16 a[84:87], a[168:171], v[8:11], a[84:87]
  ds_read_b128 a[128:131], v212 offset:0
  v_cvt_pk_bf16_f32 v106, v108, v109
  v_mfma_f32_16x16x32_bf16 a[88:91], a[168:171], v[16:19], a[88:91]
  v_exp_f32 v110, v110
  v_mfma_f32_16x16x32_bf16 a[88:91], a[172:175], v[48:51], a[88:91]
  ds_read_b128 a[132:135], v213 offset:0
  v_mfma_f32_16x16x32_bf16 a[92:95], a[172:175], v[56:59], a[92:95]
  s_waitcnt lgkmcnt(6)
  v_exp_f32 v111, v111
  v_mfma_f32_16x16x32_bf16 a[92:95], a[168:171], v[24:27], a[92:95]
  ds_read_b128 a[136:139], v214 offset:0
  v_cvt_pk_bf16_f32 v107, v110, v111
  v_mfma_f32_16x16x32_bf16 a[96:99], a[176:179], v[0:3], a[96:99]
  v_exp_f32 v116, v116
  v_mfma_f32_16x16x32_bf16 a[96:99], a[180:183], v[32:35], a[96:99]
  ds_read_b128 a[140:143], v215 offset:0
  buffer_load_dwordx4 a[220:223], v243, s[24:27], s38 offen sc1
  s_add_u32 s38, s38, 4096
  v_mfma_f32_16x16x32_bf16 a[100:103], a[180:183], v[40:43], a[100:103]
  v_exp_f32 v117, v117
  v_mfma_f32_16x16x32_bf16 a[100:103], a[176:179], v[8:11], a[100:103]
  v_cvt_pk_bf16_f32 v114, v116, v117
  v_mfma_f32_16x16x32_bf16 a[104:107], a[176:179], v[16:19], a[104:107]
  v_exp_f32 v118, v118
  v_mfma_f32_16x16x32_bf16 a[104:107], a[180:183], v[48:51], a[104:107]
  v_mfma_f32_16x16x32_bf16 a[108:111], a[180:183], v[56:59], a[108:111]
  s_waitcnt lgkmcnt(4)
  v_exp_f32 v119, v119
  v_mfma_f32_16x16x32_bf16 a[108:111], a[176:179], v[24:27], a[108:111]
  v_cvt_pk_bf16_f32 v115, v118, v119
  v_mfma_f32_16x16x32_bf16 a[112:115], a[184:187], v[0:3], a[112:115]
  v_exp_f32 v124, v124
  v_mfma_f32_16x16x32_bf16 a[112:115], a[188:191], v[32:35], a[112:115]
  v_mfma_f32_16x16x32_bf16 a[116:119], a[188:191], v[40:43], a[116:119]
  v_exp_f32 v125, v125
  v_mfma_f32_16x16x32_bf16 a[116:119], a[184:187], v[8:11], a[116:119]
  v_cvt_pk_bf16_f32 v122, v124, v125
  v_mfma_f32_16x16x32_bf16 a[120:123], a[184:187], v[16:19], a[120:123]
  v_exp_f32 v126, v126
  v_mfma_f32_16x16x32_bf16 a[120:123], a[188:191], v[48:51], a[120:123]
  v_mfma_f32_16x16x32_bf16 a[124:127], a[188:191], v[56:59], a[124:127]
  s_waitcnt lgkmcnt(0)
  v_exp_f32 v127, v127
  v_mfma_f32_16x16x32_bf16 a[124:127], a[184:187], v[24:27], a[124:127]
  v_cvt_pk_bf16_f32 v123, v126, v127
  v_mfma_f32_16x16x32_bf16 v[0:3], a[128:131], v[128:131], v[192:195]
  s_add_u32 m0, s28, 81920
  v_mfma_f32_16x16x32_bf16 v[0:3], a[132:135], v[132:135], v[0:3]
  ds_read_b128 a[144:147], v212 offset:4096
  v_mfma_f32_16x16x32_bf16 v[0:3], a[136:139], v[136:139], v[0:3]
  buffer_load_dwordx4 v236, s[16:19], s29 offen offset:0 lds
  v_mfma_f32_16x16x32_bf16 v[0:3], a[140:143], v[140:143], v[0:3]
  ds_read_b128 a[148:151], v213 offset:4096
  v_mfma_f32_16x16x32_bf16 v[8:11], a[140:143], v[156:159], v[196:199]
  buffer_load_dwordx4 v237, s[16:19], s29 offen offset:1024 lds
  v_mfma_f32_16x16x32_bf16 v[8:11], a[136:139], v[152:155], v[8:11]
  ds_read_b128 a[152:155], v214 offset:4096
  v_mfma_f32_16x16x32_bf16 v[8:11], a[132:135], v[148:151], v[8:11]
  buffer_load_dwordx4 v236, s[16:19], s29 offen offset:2048 lds
  v_mfma_f32_16x16x32_bf16 v[8:11], a[128:131], v[144:147], v[8:11]
  ds_read_b128 a[156:159], v215 offset:4096
  v_mfma_f32_16x16x32_bf16 v[16:19], a[128:131], v[160:163], v[200:203]
  v_exp_f32 v0, v0
  v_mfma_f32_16x16x32_bf16 v[16:19], a[132:135], v[164:167], v[16:19]
  buffer_load_dwordx4 v237, s[16:19], s29 offen offset:3072 lds
  v_mfma_f32_16x16x32_bf16 v[16:19], a[136:139], v[168:171], v[16:19]
  s_add_u32 s29, s29, 16384
  v_exp_f32 v1, v1
  v_mfma_f32_16x16x32_bf16 v[16:19], a[140:143], v[172:175], v[16:19]
  v_cvt_pk_bf16_f32 v0, v0, v1
  v_mfma_f32_16x16x32_bf16 v[24:27], a[140:143], v[188:191], v[204:207]
  s_add_u32 m0, s28, 32768
  v_exp_f32 v2, v2
  v_mfma_f32_16x16x32_bf16 v[24:27], a[136:139], v[184:187], v[24:27]
  buffer_load_dwordx4 v232, s[12:15], s29 offen offset:0 lds
  v_mfma_f32_16x16x32_bf16 v[24:27], a[132:135], v[180:183], v[24:27]
  s_waitcnt lgkmcnt(0)
  v_exp_f32 v3, v3
  v_mfma_f32_16x16x32_bf16 v[24:27], a[128:131], v[176:179], v[24:27]
  v_cvt_pk_bf16_f32 v1, v2, v3
  v_mfma_f32_16x16x32_bf16 v[4:7], a[144:147], v[128:131], v[192:195]
  v_exp_f32 v8, v8
  v_mfma_f32_16x16x32_bf16 v[4:7], a[148:151], v[132:135], v[4:7]
  ds_read_b128 a[128:131], v212 offset:8192
  v_mfma_f32_16x16x32_bf16 v[4:7], a[152:155], v[136:139], v[4:7]
  v_exp_f32 v9, v9
  v_mfma_f32_16x16x32_bf16 v[4:7], a[156:159], v[140:143], v[4:7]
  ds_read_b128 a[132:135], v213 offset:8192
  v_cvt_pk_bf16_f32 v8, v8, v9
  v_mfma_f32_16x16x32_bf16 v[12:15], a[156:159], v[156:159], v[196:199]
  v_exp_f32 v10, v10
  v_mfma_f32_16x16x32_bf16 v[12:15], a[152:155], v[152:155], v[12:15]
  ds_read_b128 a[136:139], v214 offset:8192
  v_mfma_f32_16x16x32_bf16 v[12:15], a[148:151], v[148:151], v[12:15]
  v_exp_f32 v11, v11
  v_mfma_f32_16x16x32_bf16 v[12:15], a[144:147], v[144:147], v[12:15]
  ds_read_b128 a[140:143], v215 offset:8192
  v_cvt_pk_bf16_f32 v9, v10, v11
  v_mfma_f32_16x16x32_bf16 v[20:23], a[144:147], v[160:163], v[200:203]
  v_exp_f32 v16, v16
  v_mfma_f32_16x16x32_bf16 v[20:23], a[148:151], v[164:167], v[20:23]
  buffer_load_dwordx4 v233, s[12:15], s29 offen offset:1024 lds
  v_mfma_f32_16x16x32_bf16 v[20:23], a[152:155], v[168:171], v[20:23]
  v_exp_f32 v17, v17
  v_mfma_f32_16x16x32_bf16 v[20:23], a[156:159], v[172:175], v[20:23]
  v_cvt_pk_bf16_f32 v16, v16, v17
  v_mfma_f32_16x16x32_bf16 v[28:31], a[156:159], v[188:191], v[204:207]
  v_exp_f32 v18, v18
  v_mfma_f32_16x16x32_bf16 v[28:31], a[152:155], v[184:187], v[28:31]
  buffer_load_dwordx4 v234, s[12:15], s29 offen offset:2048 lds
  v_mfma_f32_16x16x32_bf16 v[28:31], a[148:151], v[180:183], v[28:31]
  s_waitcnt lgkmcnt(0)
  v_exp_f32 v19, v19
  v_mfma_f32_16x16x32_bf16 v[28:31], a[144:147], v[176:179], v[28:31]
  v_cvt_pk_bf16_f32 v17, v18, v19
  v_mfma_f32_16x16x32_bf16 v[32:35], a[128:131], v[128:131], v[192:195]
  v_exp_f32 v24, v24
  v_mfma_f32_16x16x32_bf16 v[32:35], a[132:135], v[132:135], v[32:35]
  ds_read_b128 a[144:147], v212 offset:12288
  v_mfma_f32_16x16x32_bf16 v[32:35], a[136:139], v[136:139], v[32:35]
  v_exp_f32 v25, v25
  v_mfma_f32_16x16x32_bf16 v[32:35], a[140:143], v[140:143], v[32:35]
  ds_read_b128 a[148:151], v213 offset:12288
  v_cvt_pk_bf16_f32 v24, v24, v25
  v_mfma_f32_16x16x32_bf16 v[40:43], a[140:143], v[156:159], v[196:199]
  v_exp_f32 v26, v26
  v_mfma_f32_16x16x32_bf16 v[40:43], a[136:139], v[152:155], v[40:43]
  ds_read_b128 a[152:155], v214 offset:12288
  v_mfma_f32_16x16x32_bf16 v[40:43], a[132:135], v[148:151], v[40:43]
  v_exp_f32 v27, v27
  v_mfma_f32_16x16x32_bf16 v[40:43], a[128:131], v[144:147], v[40:43]
  ds_read_b128 a[156:159], v215 offset:12288
  v_cvt_pk_bf16_f32 v25, v26, v27
  v_mfma_f32_16x16x32_bf16 v[48:51], a[128:131], v[160:163], v[200:203]
  v_exp_f32 v4, v4
  v_mfma_f32_16x16x32_bf16 v[48:51], a[132:135], v[164:167], v[48:51]
  buffer_load_dwordx4 v235, s[12:15], s29 offen offset:3072 lds
  v_mfma_f32_16x16x32_bf16 v[48:51], a[136:139], v[168:171], v[48:51]
  v_exp_f32 v5, v5
  v_mfma_f32_16x16x32_bf16 v[48:51], a[140:143], v[172:175], v[48:51]
  v_cvt_pk_bf16_f32 v2, v4, v5
  v_mfma_f32_16x16x32_bf16 v[56:59], a[140:143], v[188:191], v[204:207]
  v_exp_f32 v6, v6
  v_mfma_f32_16x16x32_bf16 v[56:59], a[136:139], v[184:187], v[56:59]
  s_add_u32 m0, s50, 2048
  v_mfma_f32_16x16x32_bf16 v[56:59], a[132:135], v[180:183], v[56:59]
  s_waitcnt lgkmcnt(0)
  v_exp_f32 v7, v7
  v_mfma_f32_16x16x32_bf16 v[56:59], a[128:131], v[176:179], v[56:59]
  buffer_load_dwordx4 v253, s[20:23], s35 offen lds
  v_cvt_pk_bf16_f32 v3, v6, v7
  v_mfma_f32_16x16x32_bf16 v[36:39], a[144:147], v[128:131], v[192:195]
  v_exp_f32 v12, v12
  v_mfma_f32_16x16x32_bf16 v[36:39], a[148:151], v[132:135], v[36:39]
  ds_read_b64_tr_b16 a[160:161], v216 offset:49152
  v_mfma_f32_16x16x32_bf16 v[36:39], a[152:155], v[136:139], v[36:39]
  v_exp_f32 v13, v13
  v_mfma_f32_16x16x32_bf16 v[36:39], a[156:159], v[140:143], v[36:39]
  ds_read_b64_tr_b16 a[162:163], v216 offset:53248
  v_cvt_pk_bf16_f32 v10, v12, v13
  v_mfma_f32_16x16x32_bf16 v[44:47], a[156:159], v[156:159], v[196:199]
  v_exp_f32 v14, v14
  v_mfma_f32_16x16x32_bf16 v[44:47], a[152:155], v[152:155], v[44:47]
  ds_read_b64_tr_b16 a[164:165], v216 offset:57344
  v_mfma_f32_16x16x32_bf16 v[44:47], a[148:151], v[148:151], v[44:47]
  v_exp_f32 v15, v15
  v_mfma_f32_16x16x32_bf16 v[44:47], a[144:147], v[144:147], v[44:47]
  ds_read_b64_tr_b16 a[166:167], v216 offset:61440
  v_cvt_pk_bf16_f32 v11, v14, v15
  v_mfma_f32_16x16x32_bf16 v[52:55], a[144:147], v[160:163], v[200:203]
  v_exp_f32 v20, v20
  v_mfma_f32_16x16x32_bf16 v[52:55], a[148:151], v[164:167], v[52:55]
  ds_read_b64_tr_b16 a[168:169], v217 offset:49152
  v_mfma_f32_16x16x32_bf16 v[52:55], a[152:155], v[168:171], v[52:55]
  v_exp_f32 v21, v21
  v_mfma_f32_16x16x32_bf16 v[52:55], a[156:159], v[172:175], v[52:55]
  ds_read_b64_tr_b16 a[170:171], v217 offset:53248
  v_cvt_pk_bf16_f32 v18, v20, v21
  v_mfma_f32_16x16x32_bf16 v[60:63], a[156:159], v[188:191], v[204:207]
  v_exp_f32 v22, v22
  v_mfma_f32_16x16x32_bf16 v[60:63], a[152:155], v[184:187], v[60:63]
  ds_read_b64_tr_b16 a[172:173], v217 offset:57344
  v_mfma_f32_16x16x32_bf16 v[60:63], a[148:151], v[180:183], v[60:63]
  v_exp_f32 v23, v23
  v_mfma_f32_16x16x32_bf16 v[60:63], a[144:147], v[176:179], v[60:63]
  ds_read_b64_tr_b16 a[174:175], v217 offset:61440
  v_cvt_pk_bf16_f32 v19, v22, v23
  v_mfma_f32_16x16x32_bf16 a[192:195], a[208:211], v[64:67], a[192:195]
  v_exp_f32 v28, v28
  v_mfma_f32_16x16x32_bf16 a[192:195], a[208:211], v[96:99], a[192:195]
  ds_read_b64_tr_b16 a[176:177], v218 offset:49152
  v_mfma_f32_16x16x32_bf16 a[196:199], a[208:211], v[72:75], a[196:199]
  v_exp_f32 v29, v29
  v_mfma_f32_16x16x32_bf16 a[196:199], a[208:211], v[104:107], a[196:199]
  ds_read_b64_tr_b16 a[178:179], v218 offset:53248
  v_cvt_pk_bf16_f32 v26, v28, v29
  v_mfma_f32_16x16x32_bf16 a[200:203], a[208:211], v[80:83], a[200:203]
  v_exp_f32 v30, v30
  v_mfma_f32_16x16x32_bf16 a[200:203], a[208:211], v[112:115], a[200:203]
  ds_read_b64_tr_b16 a[180:181], v218 offset:57344
  v_mfma_f32_16x16x32_bf16 a[204:207], a[208:211], v[88:91], a[204:207]
  s_waitcnt lgkmcnt(7)
  v_exp_f32 v31, v31
  v_mfma_f32_16x16x32_bf16 a[204:207], a[208:211], v[120:123], a[204:207]
  ds_read_b64_tr_b16 a[182:183], v218 offset:61440
  v_cvt_pk_bf16_f32 v27, v30, v31
  v_mfma_f32_16x16x32_bf16 a[0:3], a[160:163], v[64:67], a[0:3]
  v_exp_f32 v32, v32
  v_mfma_f32_16x16x32_bf16 a[0:3], a[164:167], v[96:99], a[0:3]
  ds_read_b64_tr_b16 a[184:185], v219 offset:49152
  v_mfma_f32_16x16x32_bf16 a[4:7], a[164:167], v[104:107], a[4:7]
  v_exp_f32 v33, v33
  v_mfma_f32_16x16x32_bf16 a[4:7], a[160:163], v[72:75], a[4:7]
  ds_read_b64_tr_b16 a[186:187], v219 offset:53248
  v_cvt_pk_bf16_f32 v32, v32, v33
  v_mfma_f32_16x16x32_bf16 a[8:11], a[160:163], v[80:83], a[8:11]
  v_exp_f32 v34, v34
  v_mfma_f32_16x16x32_bf16 a[8:11], a[164:167], v[112:115], a[8:11]
  ds_read_b64_tr_b16 a[188:189], v219 offset:57344
  v_mfma_f32_16x16x32_bf16 a[12:15], a[164:167], v[120:123], a[12:15]
  s_waitcnt lgkmcnt(7)
  v_exp_f32 v35, v35
  v_mfma_f32_16x16x32_bf16 a[12:15], a[160:163], v[88:91], a[12:15]
  ds_read_b64_tr_b16 a[190:191], v219 offset:61440
  v_cvt_pk_bf16_f32 v33, v34, v35
  v_mfma_f32_16x16x32_bf16 a[16:19], a[168:171], v[64:67], a[16:19]
  v_exp_f32 v40, v40
  v_mfma_f32_16x16x32_bf16 a[16:19], a[172:175], v[96:99], a[16:19]
  ds_read_b64_tr_b16 a[160:161], v220 offset:49152
  v_mfma_f32_16x16x32_bf16 a[20:23], a[172:175], v[104:107], a[20:23]
  v_exp_f32 v41, v41
  v_mfma_f32_16x16x32_bf16 a[20:23], a[168:171], v[72:75], a[20:23]
  ds_read_b64_tr_b16 a[162:163], v220 offset:53248
  v_cvt_pk_bf16_f32 v40, v40, v41
  v_mfma_f32_16x16x32_bf16 a[24:27], a[168:171], v[80:83], a[24:27]
  v_exp_f32 v42, v42
  v_mfma_f32_16x16x32_bf16 a[24:27], a[172:175], v[112:115], a[24:27]
  ds_read_b64_tr_b16 a[164:165], v220 offset:57344
  v_mfma_f32_16x16x32_bf16 a[28:31], a[172:175], v[120:123], a[28:31]
  s_waitcnt lgkmcnt(7)
  v_exp_f32 v43, v43
  v_mfma_f32_16x16x32_bf16 a[28:31], a[168:171], v[88:91], a[28:31]
  ds_read_b64_tr_b16 a[166:167], v220 offset:61440
  v_cvt_pk_bf16_f32 v41, v42, v43
  v_mfma_f32_16x16x32_bf16 a[32:35], a[176:179], v[64:67], a[32:35]
  v_exp_f32 v48, v48
  v_mfma_f32_16x16x32_bf16 a[32:35], a[180:183], v[96:99], a[32:35]
  ds_read_b64_tr_b16 a[168:169], v221 offset:49152
  v_mfma_f32_16x16x32_bf16 a[36:39], a[180:183], v[104:107], a[36:39]
  v_exp_f32 v49, v49
  v_mfma_f32_16x16x32_bf16 a[36:39], a[176:179], v[72:75], a[36:39]
  ds_read_b64_tr_b16 a[170:171], v221 offset:53248
  v_cvt_pk_bf16_f32 v48, v48, v49
  v_mfma_f32_16x16x32_bf16 a[40:43], a[176:179], v[80:83], a[40:43]
  v_exp_f32 v50, v50
  v_mfma_f32_16x16x32_bf16 a[40:43], a[180:183], v[112:115], a[40:43]
  ds_read_b64_tr_b16 a[172:173], v221 offset:57344
  v_mfma_f32_16x16x32_bf16 a[44:47], a[180:183], v[120:123], a[44:47]
  s_waitcnt lgkmcnt(7)
  v_exp_f32 v51, v51
  v_mfma_f32_16x16x32_bf16 a[44:47], a[176:179], v[88:91], a[44:47]
  ds_read_b64_tr_b16 a[174:175], v221 offset:61440
  v_cvt_pk_bf16_f32 v49, v50, v51
  v_mfma_f32_16x16x32_bf16 a[48:51], a[184:187], v[64:67], a[48:51]
  v_exp_f32 v56, v56
  v_mfma_f32_16x16x32_bf16 a[48:51], a[188:191], v[96:99], a[48:51]
  ds_read_b64_tr_b16 a[176:177], v222 offset:49152
  v_mfma_f32_16x16x32_bf16 a[52:55], a[188:191], v[104:107], a[52:55]
  v_exp_f32 v57, v57
  v_mfma_f32_16x16x32_bf16 a[52:55], a[184:187], v[72:75], a[52:55]
  ds_read_b64_tr_b16 a[178:179], v222 offset:53248
  v_cvt_pk_bf16_f32 v56, v56, v57
  v_mfma_f32_16x16x32_bf16 a[56:59], a[184:187], v[80:83], a[56:59]
  v_exp_f32 v58, v58
  v_mfma_f32_16x16x32_bf16 a[56:59], a[188:191], v[112:115], a[56:59]
  ds_read_b64_tr_b16 a[180:181], v222 offset:57344
  v_mfma_f32_16x16x32_bf16 a[60:63], a[188:191], v[120:123], a[60:63]
  s_waitcnt lgkmcnt(7)
  v_exp_f32 v59, v59
  v_mfma_f32_16x16x32_bf16 a[60:63], a[184:187], v[88:91], a[60:63]
  ds_read_b64_tr_b16 a[182:183], v222 offset:61440
  v_cvt_pk_bf16_f32 v57, v58, v59
  v_mfma_f32_16x16x32_bf16 a[64:67], a[160:163], v[64:67], a[64:67]
  v_exp_f32 v36, v36
  v_mfma_f32_16x16x32_bf16 a[64:67], a[164:167], v[96:99], a[64:67]
  ds_read_b64_tr_b16 a[184:185], v223 offset:49152
  v_mfma_f32_16x16x32_bf16 a[68:71], a[164:167], v[104:107], a[68:71]
  v_exp_f32 v37, v37
  v_mfma_f32_16x16x32_bf16 a[68:71], a[160:163], v[72:75], a[68:71]
  ds_read_b64_tr_b16 a[186:187], v223 offset:53248
  v_cvt_pk_bf16_f32 v34, v36, v37
  v_mfma_f32_16x16x32_bf16 a[72:75], a[160:163], v[80:83], a[72:75]
  v_exp_f32 v38, v38
  v_mfma_f32_16x16x32_bf16 a[72:75], a[164:167], v[112:115], a[72:75]
  ds_read_b64_tr_b16 a[188:189], v223 offset:57344
  v_mfma_f32_16x16x32_bf16 a[76:79], a[164:167], v[120:123], a[76:79]
  s_waitcnt lgkmcnt(7)
  v_exp_f32 v39, v39
  v_mfma_f32_16x16x32_bf16 a[76:79], a[160:163], v[88:91], a[76:79]
  ds_read_b64_tr_b16 a[190:191], v223 offset:61440
  v_cvt_pk_bf16_f32 v35, v38, v39
  v_mfma_f32_16x16x32_bf16 a[80:83], a[168:171], v[64:67], a[80:83]
  s_waitcnt vmcnt(11)
  v_exp_f32 v44, v44
  v_mfma_f32_16x16x32_bf16 a[80:83], a[172:175], v[96:99], a[80:83]
  v_mfma_f32_16x16x32_bf16 a[84:87], a[172:175], v[104:107], a[84:87]
  s_barrier
  v_exp_f32 v45, v45
  v_mfma_f32_16x16x32_bf16 a[84:87], a[168:171], v[72:75], a[84:87]
  ds_read_b128 a[128:131], v212 offset:16384
  v_cvt_pk_bf16_f32 v42, v44, v45
  v_mfma_f32_16x16x32_bf16 a[88:91], a[168:171], v[80:83], a[88:91]
  v_exp_f32 v46, v46
  v_mfma_f32_16x16x32_bf16 a[88:91], a[172:175], v[112:115], a[88:91]
  ds_read_b128 a[132:135], v213 offset:16384
  v_mfma_f32_16x16x32_bf16 a[92:95], a[172:175], v[120:123], a[92:95]
  s_waitcnt lgkmcnt(6)
  v_exp_f32 v47, v47
  v_mfma_f32_16x16x32_bf16 a[92:95], a[168:171], v[88:91], a[92:95]
  ds_read_b128 a[136:139], v214 offset:16384
  v_cvt_pk_bf16_f32 v43, v46, v47
  v_mfma_f32_16x16x32_bf16 a[96:99], a[176:179], v[64:67], a[96:99]
  v_exp_f32 v52, v52
  v_mfma_f32_16x16x32_bf16 a[96:99], a[180:183], v[96:99], a[96:99]
  ds_read_b128 a[140:143], v215 offset:16384
  buffer_load_dwordx4 a[224:227], v243, s[24:27], s38 offen sc1
  s_add_u32 s38, s38, 4096
  v_mfma_f32_16x16x32_bf16 a[100:103], a[180:183], v[104:107], a[100:103]
  v_exp_f32 v53, v53
  v_mfma_f32_16x16x32_bf16 a[100:103], a[176:179], v[72:75], a[100:103]
  v_cvt_pk_bf16_f32 v50, v52, v53
  v_mfma_f32_16x16x32_bf16 a[104:107], a[176:179], v[80:83], a[104:107]
  v_exp_f32 v54, v54
  v_mfma_f32_16x16x32_bf16 a[104:107], a[180:183], v[112:115], a[104:107]
  v_mfma_f32_16x16x32_bf16 a[108:111], a[180:183], v[120:123], a[108:111]
  s_waitcnt lgkmcnt(4)
  v_exp_f32 v55, v55
  v_mfma_f32_16x16x32_bf16 a[108:111], a[176:179], v[88:91], a[108:111]
  v_cvt_pk_bf16_f32 v51, v54, v55
  v_mfma_f32_16x16x32_bf16 a[112:115], a[184:187], v[64:67], a[112:115]
  v_exp_f32 v60, v60
  v_mfma_f32_16x16x32_bf16 a[112:115], a[188:191], v[96:99], a[112:115]
  v_mfma_f32_16x16x32_bf16 a[116:119], a[188:191], v[104:107], a[116:119]
  v_exp_f32 v61, v61
  v_mfma_f32_16x16x32_bf16 a[116:119], a[184:187], v[72:75], a[116:119]
  v_cvt_pk_bf16_f32 v58, v60, v61
  v_mfma_f32_16x16x32_bf16 a[120:123], a[184:187], v[80:83], a[120:123]
  v_exp_f32 v62, v62
  v_mfma_f32_16x16x32_bf16 a[120:123], a[188:191], v[112:115], a[120:123]
  v_mfma_f32_16x16x32_bf16 a[124:127], a[188:191], v[120:123], a[124:127]
  s_waitcnt lgkmcnt(0)
  v_exp_f32 v63, v63
  v_mfma_f32_16x16x32_bf16 a[124:127], a[184:187], v[88:91], a[124:127]
  v_cvt_pk_bf16_f32 v59, v62, v63
  v_mfma_f32_16x16x32_bf16 v[64:67], a[128:131], v[128:131], v[192:195]
  s_add_u32 m0, s28, 98304
  v_mfma_f32_16x16x32_bf16 v[64:67], a[132:135], v[132:135], v[64:67]
  ds_read_b128 a[144:147], v212 offset:20480
  v_mfma_f32_16x16x32_bf16 v[64:67], a[136:139], v[136:139], v[64:67]
  buffer_load_dwordx4 v236, s[16:19], s29 offen offset:0 lds
  v_mfma_f32_16x16x32_bf16 v[64:67], a[140:143], v[140:143], v[64:67]
  ds_read_b128 a[148:151], v213 offset:20480
  v_mfma_f32_16x16x32_bf16 v[72:75], a[140:143], v[156:159], v[196:199]
  buffer_load_dwordx4 v237, s[16:19], s29 offen offset:1024 lds
  v_mfma_f32_16x16x32_bf16 v[72:75], a[136:139], v[152:155], v[72:75]
  ds_read_b128 a[152:155], v214 offset:20480
  v_mfma_f32_16x16x32_bf16 v[72:75], a[132:135], v[148:151], v[72:75]
  buffer_load_dwordx4 v236, s[16:19], s29 offen offset:2048 lds
  v_mfma_f32_16x16x32_bf16 v[72:75], a[128:131], v[144:147], v[72:75]
  ds_read_b128 a[156:159], v215 offset:20480
  v_mfma_f32_16x16x32_bf16 v[80:83], a[128:131], v[160:163], v[200:203]
  v_exp_f32 v64, v64
  v_mfma_f32_16x16x32_bf16 v[80:83], a[132:135], v[164:167], v[80:83]
  buffer_load_dwordx4 v237, s[16:19], s29 offen offset:3072 lds
  v_mfma_f32_16x16x32_bf16 v[80:83], a[136:139], v[168:171], v[80:83]
  s_add_u32 s29, s29, 16384
  v_exp_f32 v65, v65
  v_mfma_f32_16x16x32_bf16 v[80:83], a[140:143], v[172:175], v[80:83]
  v_cvt_pk_bf16_f32 v64, v64, v65
  v_mfma_f32_16x16x32_bf16 v[88:91], a[140:143], v[188:191], v[204:207]
  s_add_u32 m0, s28, 49152
  v_exp_f32 v66, v66
  v_mfma_f32_16x16x32_bf16 v[88:91], a[136:139], v[184:187], v[88:91]
  buffer_load_dwordx4 v232, s[12:15], s29 offen offset:0 lds
  v_mfma_f32_16x16x32_bf16 v[88:91], a[132:135], v[180:183], v[88:91]
  s_waitcnt lgkmcnt(0)
  v_exp_f32 v67, v67
  v_mfma_f32_16x16x32_bf16 v[88:91], a[128:131], v[176:179], v[88:91]
  v_cvt_pk_bf16_f32 v65, v66, v67
  v_mfma_f32_16x16x32_bf16 v[68:71], a[144:147], v[128:131], v[192:195]
  v_exp_f32 v72, v72
  v_mfma_f32_16x16x32_bf16 v[68:71], a[148:151], v[132:135], v[68:71]
  ds_read_b128 a[128:131], v212 offset:24576
  v_mfma_f32_16x16x32_bf16 v[68:71], a[152:155], v[136:139], v[68:71]
  v_exp_f32 v73, v73
  v_mfma_f32_16x16x32_bf16 v[68:71], a[156:159], v[140:143], v[68:71]
  ds_read_b128 a[132:135], v213 offset:24576
  v_cvt_pk_bf16_f32 v72, v72, v73
  v_mfma_f32_16x16x32_bf16 v[76:79], a[156:159], v[156:159], v[196:199]
  v_exp_f32 v74, v74
  v_mfma_f32_16x16x32_bf16 v[76:79], a[152:155], v[152:155], v[76:79]
  ds_read_b128 a[136:139], v214 offset:24576
  v_mfma_f32_16x16x32_bf16 v[76:79], a[148:151], v[148:151], v[76:79]
  v_exp_f32 v75, v75
  v_mfma_f32_16x16x32_bf16 v[76:79], a[144:147], v[144:147], v[76:79]
  ds_read_b128 a[140:143], v215 offset:24576
  v_cvt_pk_bf16_f32 v73, v74, v75
  v_mfma_f32_16x16x32_bf16 v[84:87], a[144:147], v[160:163], v[200:203]
  v_exp_f32 v80, v80
  v_mfma_f32_16x16x32_bf16 v[84:87], a[148:151], v[164:167], v[84:87]
  buffer_load_dwordx4 v233, s[12:15], s29 offen offset:1024 lds
  v_mfma_f32_16x16x32_bf16 v[84:87], a[152:155], v[168:171], v[84:87]
  v_exp_f32 v81, v81
  v_mfma_f32_16x16x32_bf16 v[84:87], a[156:159], v[172:175], v[84:87]
  v_cvt_pk_bf16_f32 v80, v80, v81
  v_mfma_f32_16x16x32_bf16 v[92:95], a[156:159], v[188:191], v[204:207]
  v_exp_f32 v82, v82
  v_mfma_f32_16x16x32_bf16 v[92:95], a[152:155], v[184:187], v[92:95]
  buffer_load_dwordx4 v234, s[12:15], s29 offen offset:2048 lds
  v_mfma_f32_16x16x32_bf16 v[92:95], a[148:151], v[180:183], v[92:95]
  s_waitcnt lgkmcnt(0)
  v_exp_f32 v83, v83
  v_mfma_f32_16x16x32_bf16 v[92:95], a[144:147], v[176:179], v[92:95]
  v_cvt_pk_bf16_f32 v81, v82, v83
  v_mfma_f32_16x16x32_bf16 v[96:99], a[128:131], v[128:131], v[192:195]
  v_exp_f32 v88, v88
  v_mfma_f32_16x16x32_bf16 v[96:99], a[132:135], v[132:135], v[96:99]
  ds_read_b128 a[144:147], v212 offset:28672
  v_mfma_f32_16x16x32_bf16 v[96:99], a[136:139], v[136:139], v[96:99]
  v_exp_f32 v89, v89
  v_mfma_f32_16x16x32_bf16 v[96:99], a[140:143], v[140:143], v[96:99]
  ds_read_b128 a[148:151], v213 offset:28672
  v_cvt_pk_bf16_f32 v88, v88, v89
  v_mfma_f32_16x16x32_bf16 v[104:107], a[140:143], v[156:159], v[196:199]
  v_exp_f32 v90, v90
  v_mfma_f32_16x16x32_bf16 v[104:107], a[136:139], v[152:155], v[104:107]
  ds_read_b128 a[152:155], v214 offset:28672
  v_mfma_f32_16x16x32_bf16 v[104:107], a[132:135], v[148:151], v[104:107]
  v_exp_f32 v91, v91
  v_mfma_f32_16x16x32_bf16 v[104:107], a[128:131], v[144:147], v[104:107]
  ds_read_b128 a[156:159], v215 offset:28672
  v_cvt_pk_bf16_f32 v89, v90, v91
  v_mfma_f32_16x16x32_bf16 v[112:115], a[128:131], v[160:163], v[200:203]
  v_exp_f32 v68, v68
  v_mfma_f32_16x16x32_bf16 v[112:115], a[132:135], v[164:167], v[112:115]
  buffer_load_dwordx4 v235, s[12:15], s29 offen offset:3072 lds
  v_mfma_f32_16x16x32_bf16 v[112:115], a[136:139], v[168:171], v[112:115]
  v_exp_f32 v69, v69
  v_mfma_f32_16x16x32_bf16 v[112:115], a[140:143], v[172:175], v[112:115]
  v_cvt_pk_bf16_f32 v66, v68, v69
  v_mfma_f32_16x16x32_bf16 v[120:123], a[140:143], v[188:191], v[204:207]
  v_exp_f32 v70, v70
  v_mfma_f32_16x16x32_bf16 v[120:123], a[136:139], v[184:187], v[120:123]
  s_add_u32 m0, s50, 5120
  v_mfma_f32_16x16x32_bf16 v[120:123], a[132:135], v[180:183], v[120:123]
  s_waitcnt lgkmcnt(0)
  v_exp_f32 v71, v71
  v_mfma_f32_16x16x32_bf16 v[120:123], a[128:131], v[176:179], v[120:123]
  buffer_load_dwordx4 v253, s[44:47], s35 offen lds
  s_add_u32 s35, s35, 221184
  v_cvt_pk_bf16_f32 v67, v70, v71
  v_mfma_f32_16x16x32_bf16 v[100:103], a[144:147], v[128:131], v[192:195]
  v_exp_f32 v76, v76
  v_mfma_f32_16x16x32_bf16 v[100:103], a[148:151], v[132:135], v[100:103]
  ds_read_b64_tr_b16 a[160:161], v216 offset:0
  v_mfma_f32_16x16x32_bf16 v[100:103], a[152:155], v[136:139], v[100:103]
  v_exp_f32 v77, v77
  v_mfma_f32_16x16x32_bf16 v[100:103], a[156:159], v[140:143], v[100:103]
  ds_read_b64_tr_b16 a[162:163], v216 offset:4096
  v_cvt_pk_bf16_f32 v74, v76, v77
  v_mfma_f32_16x16x32_bf16 v[108:111], a[156:159], v[156:159], v[196:199]
  v_exp_f32 v78, v78
  v_mfma_f32_16x16x32_bf16 v[108:111], a[152:155], v[152:155], v[108:111]
  ds_read_b64_tr_b16 a[164:165], v216 offset:8192
  v_mfma_f32_16x16x32_bf16 v[108:111], a[148:151], v[148:151], v[108:111]
  v_exp_f32 v79, v79
  v_mfma_f32_16x16x32_bf16 v[108:111], a[144:147], v[144:147], v[108:111]
  ds_read_b64_tr_b16 a[166:167], v216 offset:12288
  v_cvt_pk_bf16_f32 v75, v78, v79
  v_mfma_f32_16x16x32_bf16 v[116:119], a[144:147], v[160:163], v[200:203]
  v_exp_f32 v84, v84
  v_mfma_f32_16x16x32_bf16 v[116:119], a[148:151], v[164:167], v[116:119]
  ds_read_b64_tr_b16 a[168:169], v217 offset:0
  v_mfma_f32_16x16x32_bf16 v[116:119], a[152:155], v[168:171], v[116:119]
  v_exp_f32 v85, v85
  v_mfma_f32_16x16x32_bf16 v[116:119], a[156:159], v[172:175], v[116:119]
  ds_read_b64_tr_b16 a[170:171], v217 offset:4096
  v_cvt_pk_bf16_f32 v82, v84, v85
  v_mfma_f32_16x16x32_bf16 v[124:127], a[156:159], v[188:191], v[204:207]
  v_exp_f32 v86, v86
  v_mfma_f32_16x16x32_bf16 v[124:127], a[152:155], v[184:187], v[124:127]
  ds_read_b64_tr_b16 a[172:173], v217 offset:8192
  v_mfma_f32_16x16x32_bf16 v[124:127], a[148:151], v[180:183], v[124:127]
  v_exp_f32 v87, v87
  v_mfma_f32_16x16x32_bf16 v[124:127], a[144:147], v[176:179], v[124:127]
  ds_read_b64_tr_b16 a[174:175], v217 offset:12288
  v_cvt_pk_bf16_f32 v83, v86, v87
  v_mfma_f32_16x16x32_bf16 a[192:195], a[208:211], v[0:3], a[192:195]
  v_exp_f32 v92, v92
  v_mfma_f32_16x16x32_bf16 a[192:195], a[208:211], v[32:35], a[192:195]
  ds_read_b64_tr_b16 a[176:177], v218 offset:0
  v_mfma_f32_16x16x32_bf16 a[196:199], a[208:211], v[8:11], a[196:199]
  v_exp_f32 v93, v93
  v_mfma_f32_16x16x32_bf16 a[196:199], a[208:211], v[40:43], a[196:199]
  ds_read_b64_tr_b16 a[178:179], v218 offset:4096
  v_cvt_pk_bf16_f32 v90, v92, v93
  v_mfma_f32_16x16x32_bf16 a[200:203], a[208:211], v[16:19], a[200:203]
  v_exp_f32 v94, v94
  v_mfma_f32_16x16x32_bf16 a[200:203], a[208:211], v[48:51], a[200:203]
  ds_read_b64_tr_b16 a[180:181], v218 offset:8192
  v_mfma_f32_16x16x32_bf16 a[204:207], a[208:211], v[24:27], a[204:207]
  s_waitcnt lgkmcnt(7)
  v_exp_f32 v95, v95
  v_mfma_f32_16x16x32_bf16 a[204:207], a[208:211], v[56:59], a[204:207]
  ds_read_b64_tr_b16 a[182:183], v218 offset:12288
  v_cvt_pk_bf16_f32 v91, v94, v95
  v_mfma_f32_16x16x32_bf16 a[0:3], a[160:163], v[0:3], a[0:3]
  v_exp_f32 v96, v96
  v_mfma_f32_16x16x32_bf16 a[0:3], a[164:167], v[32:35], a[0:3]
  ds_read_b64_tr_b16 a[184:185], v219 offset:0
  v_mfma_f32_16x16x32_bf16 a[4:7], a[164:167], v[40:43], a[4:7]
  v_exp_f32 v97, v97
  v_mfma_f32_16x16x32_bf16 a[4:7], a[160:163], v[8:11], a[4:7]
  ds_read_b64_tr_b16 a[186:187], v219 offset:4096
  v_cvt_pk_bf16_f32 v96, v96, v97
  v_mfma_f32_16x16x32_bf16 a[8:11], a[160:163], v[16:19], a[8:11]
  v_exp_f32 v98, v98
  v_mfma_f32_16x16x32_bf16 a[8:11], a[164:167], v[48:51], a[8:11]
  ds_read_b64_tr_b16 a[188:189], v219 offset:8192
  v_mfma_f32_16x16x32_bf16 a[12:15], a[164:167], v[56:59], a[12:15]
  s_waitcnt lgkmcnt(7)
  v_exp_f32 v99, v99
  v_mfma_f32_16x16x32_bf16 a[12:15], a[160:163], v[24:27], a[12:15]
  ds_read_b64_tr_b16 a[190:191], v219 offset:12288
  v_cvt_pk_bf16_f32 v97, v98, v99
  v_mfma_f32_16x16x32_bf16 a[16:19], a[168:171], v[0:3], a[16:19]
  v_exp_f32 v104, v104
  v_mfma_f32_16x16x32_bf16 a[16:19], a[172:175], v[32:35], a[16:19]
  ds_read_b64_tr_b16 a[160:161], v220 offset:0
  v_mfma_f32_16x16x32_bf16 a[20:23], a[172:175], v[40:43], a[20:23]
  v_exp_f32 v105, v105
  v_mfma_f32_16x16x32_bf16 a[20:23], a[168:171], v[8:11], a[20:23]
  ds_read_b64_tr_b16 a[162:163], v220 offset:4096
  v_cvt_pk_bf16_f32 v104, v104, v105
  v_mfma_f32_16x16x32_bf16 a[24:27], a[168:171], v[16:19], a[24:27]
  v_exp_f32 v106, v106
  v_mfma_f32_16x16x32_bf16 a[24:27], a[172:175], v[48:51], a[24:27]
  ds_read_b64_tr_b16 a[164:165], v220 offset:8192
  v_mfma_f32_16x16x32_bf16 a[28:31], a[172:175], v[56:59], a[28:31]
  s_waitcnt lgkmcnt(7)
  v_exp_f32 v107, v107
  v_mfma_f32_16x16x32_bf16 a[28:31], a[168:171], v[24:27], a[28:31]
  ds_read_b64_tr_b16 a[166:167], v220 offset:12288
  v_cvt_pk_bf16_f32 v105, v106, v107
  v_mfma_f32_16x16x32_bf16 a[32:35], a[176:179], v[0:3], a[32:35]
  v_exp_f32 v112, v112
  v_mfma_f32_16x16x32_bf16 a[32:35], a[180:183], v[32:35], a[32:35]
  ds_read_b64_tr_b16 a[168:169], v221 offset:0
  v_mfma_f32_16x16x32_bf16 a[36:39], a[180:183], v[40:43], a[36:39]
  v_exp_f32 v113, v113
  v_mfma_f32_16x16x32_bf16 a[36:39], a[176:179], v[8:11], a[36:39]
  ds_read_b64_tr_b16 a[170:171], v221 offset:4096
  v_cvt_pk_bf16_f32 v112, v112, v113
  v_mfma_f32_16x16x32_bf16 a[40:43], a[176:179], v[16:19], a[40:43]
  v_exp_f32 v114, v114
  v_mfma_f32_16x16x32_bf16 a[40:43], a[180:183], v[48:51], a[40:43]
  ds_read_b64_tr_b16 a[172:173], v221 offset:8192
  v_mfma_f32_16x16x32_bf16 a[44:47], a[180:183], v[56:59], a[44:47]
  s_waitcnt lgkmcnt(7)
  v_exp_f32 v115, v115
  v_mfma_f32_16x16x32_bf16 a[44:47], a[176:179], v[24:27], a[44:47]
  ds_read_b64_tr_b16 a[174:175], v221 offset:12288
  v_cvt_pk_bf16_f32 v113, v114, v115
  v_mfma_f32_16x16x32_bf16 a[48:51], a[184:187], v[0:3], a[48:51]
  v_exp_f32 v120, v120
  v_mfma_f32_16x16x32_bf16 a[48:51], a[188:191], v[32:35], a[48:51]
  ds_read_b64_tr_b16 a[176:177], v222 offset:0
  v_mfma_f32_16x16x32_bf16 a[52:55], a[188:191], v[40:43], a[52:55]
  v_exp_f32 v121, v121
  v_mfma_f32_16x16x32_bf16 a[52:55], a[184:187], v[8:11], a[52:55]
  ds_read_b64_tr_b16 a[178:179], v222 offset:4096
  v_cvt_pk_bf16_f32 v120, v120, v121
  v_mfma_f32_16x16x32_bf16 a[56:59], a[184:187], v[16:19], a[56:59]
  v_exp_f32 v122, v122
  v_mfma_f32_16x16x32_bf16 a[56:59], a[188:191], v[48:51], a[56:59]
  ds_read_b64_tr_b16 a[180:181], v222 offset:8192
  v_mfma_f32_16x16x32_bf16 a[60:63], a[188:191], v[56:59], a[60:63]
  s_waitcnt lgkmcnt(7)
  v_exp_f32 v123, v123
  v_mfma_f32_16x16x32_bf16 a[60:63], a[184:187], v[24:27], a[60:63]
  ds_read_b64_tr_b16 a[182:183], v222 offset:12288
  v_cvt_pk_bf16_f32 v121, v122, v123
  v_mfma_f32_16x16x32_bf16 a[64:67], a[160:163], v[0:3], a[64:67]
  v_exp_f32 v100, v100
  v_mfma_f32_16x16x32_bf16 a[64:67], a[164:167], v[32:35], a[64:67]
  ds_read_b64_tr_b16 a[184:185], v223 offset:0
  v_mfma_f32_16x16x32_bf16 a[68:71], a[164:167], v[40:43], a[68:71]
  v_exp_f32 v101, v101
  v_mfma_f32_16x16x32_bf16 a[68:71], a[160:163], v[8:11], a[68:71]
  ds_read_b64_tr_b16 a[186:187], v223 offset:4096
  v_cvt_pk_bf16_f32 v98, v100, v101
  v_mfma_f32_16x16x32_bf16 a[72:75], a[160:163], v[16:19], a[72:75]
  v_exp_f32 v102, v102
  v_mfma_f32_16x16x32_bf16 a[72:75], a[164:167], v[48:51], a[72:75]
  ds_read_b64_tr_b16 a[188:189], v223 offset:8192
  v_mfma_f32_16x16x32_bf16 a[76:79], a[164:167], v[56:59], a[76:79]
  s_waitcnt lgkmcnt(7)
  v_exp_f32 v103, v103
  v_mfma_f32_16x16x32_bf16 a[76:79], a[160:163], v[24:27], a[76:79]
  ds_read_b64_tr_b16 a[190:191], v223 offset:12288
  v_cvt_pk_bf16_f32 v99, v102, v103
  v_mfma_f32_16x16x32_bf16 a[80:83], a[168:171], v[0:3], a[80:83]
  s_waitcnt vmcnt(11)
  v_exp_f32 v108, v108
  v_mfma_f32_16x16x32_bf16 a[80:83], a[172:175], v[32:35], a[80:83]
  v_mfma_f32_16x16x32_bf16 a[84:87], a[172:175], v[40:43], a[84:87]
  s_barrier
  v_exp_f32 v109, v109
  v_mfma_f32_16x16x32_bf16 a[84:87], a[168:171], v[8:11], a[84:87]
  ds_read_b128 a[128:131], v212 offset:32768
  v_cvt_pk_bf16_f32 v106, v108, v109
  v_mfma_f32_16x16x32_bf16 a[88:91], a[168:171], v[16:19], a[88:91]
  v_exp_f32 v110, v110
  v_mfma_f32_16x16x32_bf16 a[88:91], a[172:175], v[48:51], a[88:91]
  ds_read_b128 a[132:135], v213 offset:32768
  v_mfma_f32_16x16x32_bf16 a[92:95], a[172:175], v[56:59], a[92:95]
  s_waitcnt lgkmcnt(6)
  v_exp_f32 v111, v111
  v_mfma_f32_16x16x32_bf16 a[92:95], a[168:171], v[24:27], a[92:95]
  ds_read_b128 a[136:139], v214 offset:32768
  v_cvt_pk_bf16_f32 v107, v110, v111
  v_mfma_f32_16x16x32_bf16 a[96:99], a[176:179], v[0:3], a[96:99]
  v_exp_f32 v116, v116
  v_mfma_f32_16x16x32_bf16 a[96:99], a[180:183], v[32:35], a[96:99]
  ds_read_b128 a[140:143], v215 offset:32768
  buffer_load_dwordx4 a[228:231], v243, s[24:27], s38 offen sc1
  s_add_u32 s38, s38, 4096
  v_mfma_f32_16x16x32_bf16 a[100:103], a[180:183], v[40:43], a[100:103]
  v_exp_f32 v117, v117
  v_mfma_f32_16x16x32_bf16 a[100:103], a[176:179], v[8:11], a[100:103]
  v_cvt_pk_bf16_f32 v114, v116, v117
  v_mfma_f32_16x16x32_bf16 a[104:107], a[176:179], v[16:19], a[104:107]
  v_exp_f32 v118, v118
  v_mfma_f32_16x16x32_bf16 a[104:107], a[180:183], v[48:51], a[104:107]
  v_mfma_f32_16x16x32_bf16 a[108:111], a[180:183], v[56:59], a[108:111]
  s_waitcnt lgkmcnt(4)
  v_exp_f32 v119, v119
  v_mfma_f32_16x16x32_bf16 a[108:111], a[176:179], v[24:27], a[108:111]
  v_cvt_pk_bf16_f32 v115, v118, v119
  v_mfma_f32_16x16x32_bf16 a[112:115], a[184:187], v[0:3], a[112:115]
  v_exp_f32 v124, v124
  v_mfma_f32_16x16x32_bf16 a[112:115], a[188:191], v[32:35], a[112:115]
  v_mfma_f32_16x16x32_bf16 a[116:119], a[188:191], v[40:43], a[116:119]
  v_exp_f32 v125, v125
  v_mfma_f32_16x16x32_bf16 a[116:119], a[184:187], v[8:11], a[116:119]
  v_cvt_pk_bf16_f32 v122, v124, v125
  v_mfma_f32_16x16x32_bf16 a[120:123], a[184:187], v[16:19], a[120:123]
  v_exp_f32 v126, v126
  v_mfma_f32_16x16x32_bf16 a[120:123], a[188:191], v[48:51], a[120:123]
  v_mfma_f32_16x16x32_bf16 a[124:127], a[188:191], v[56:59], a[124:127]
  s_waitcnt lgkmcnt(0)
  v_exp_f32 v127, v127
  v_mfma_f32_16x16x32_bf16 a[124:127], a[184:187], v[24:27], a[124:127]
  v_cvt_pk_bf16_f32 v123, v126, v127
  v_mfma_f32_16x16x32_bf16 v[0:3], a[128:131], v[128:131], v[192:195]
  s_add_u32 m0, s28, 114688
  s_mov_b32 s20, s88
  s_mov_b32 s21, s89
  v_mfma_f32_16x16x32_bf16 v[0:3], a[132:135], v[132:135], v[0:3]
  ds_read_b128 a[144:147], v212 offset:36864
  s_mov_b32 s22, 5242880
  s_mov_b32 s23, 0x20000
  v_lshrrev_b32 v208, 4, v242
  v_mfma_f32_16x16x32_bf16 v[0:3], a[136:139], v[136:139], v[0:3]
  buffer_load_dwordx4 v236, s[16:19], s29 offen offset:0 lds
  v_mfma_f32_16x16x32_bf16 v[0:3], a[140:143], v[140:143], v[0:3]
  ds_read_b128 a[148:151], v213 offset:36864
  v_and_b32 v209, 1, v208
  v_mfma_f32_16x16x32_bf16 v[8:11], a[140:143], v[156:159], v[196:199]
  buffer_load_dwordx4 v237, s[16:19], s29 offen offset:1024 lds
  v_mfma_f32_16x16x32_bf16 v[8:11], a[136:139], v[152:155], v[8:11]
  ds_read_b128 a[152:155], v214 offset:36864
  v_lshrrev_b32 v208, 1, v208
  v_mfma_f32_16x16x32_bf16 v[8:11], a[132:135], v[148:151], v[8:11]
  buffer_load_dwordx4 v236, s[16:19], s29 offen offset:2048 lds
  v_mfma_f32_16x16x32_bf16 v[8:11], a[128:131], v[144:147], v[8:11]
  ds_read_b128 a[156:159], v215 offset:36864
  v_mul_u32_u24 v208, 0x500, v208
  v_mfma_f32_16x16x32_bf16 v[16:19], a[128:131], v[160:163], v[200:203]
  v_exp_f32 v0, v0
  v_mfma_f32_16x16x32_bf16 v[16:19], a[132:135], v[164:167], v[16:19]
  buffer_load_dwordx4 v237, s[16:19], s29 offen offset:3072 lds
  v_mfma_f32_16x16x32_bf16 v[16:19], a[136:139], v[168:171], v[16:19]
  s_add_u32 s29, s29, 16384
  v_exp_f32 v1, v1
  v_mfma_f32_16x16x32_bf16 v[16:19], a[140:143], v[172:175], v[16:19]
  v_cvt_pk_bf16_f32 v0, v0, v1
  v_lshl_add_u32 v208, v209, 4, v208
  v_mfma_f32_16x16x32_bf16 v[24:27], a[140:143], v[188:191], v[204:207]
  s_add_u32 m0, s28, 0
  v_exp_f32 v2, v2
  v_mfma_f32_16x16x32_bf16 v[24:27], a[136:139], v[184:187], v[24:27]
  buffer_load_dwordx4 v232, s[12:15], s29 offen offset:0 lds
  v_mfma_f32_16x16x32_bf16 v[24:27], a[132:135], v[180:183], v[24:27]
  s_waitcnt lgkmcnt(0)
  v_exp_f32 v3, v3
  v_mfma_f32_16x16x32_bf16 v[24:27], a[128:131], v[176:179], v[24:27]
  v_cvt_pk_bf16_f32 v1, v2, v3
  v_lshrrev_b32 v209, 4, v242
  v_mfma_f32_16x16x32_bf16 v[4:7], a[144:147], v[128:131], v[192:195]
  v_exp_f32 v8, v8
  v_mfma_f32_16x16x32_bf16 v[4:7], a[148:151], v[132:135], v[4:7]
  ds_read_b128 a[128:131], v212 offset:40960
  v_lshrrev_b32 v210, 5, v209
  v_mfma_f32_16x16x32_bf16 v[4:7], a[152:155], v[136:139], v[4:7]
  v_exp_f32 v9, v9
  v_mfma_f32_16x16x32_bf16 v[4:7], a[156:159], v[140:143], v[4:7]
  ds_read_b128 a[132:135], v213 offset:40960
  v_cvt_pk_bf16_f32 v8, v8, v9
  v_mfma_f32_16x16x32_bf16 v[12:15], a[156:159], v[156:159], v[196:199]
  v_exp_f32 v10, v10
  v_mfma_f32_16x16x32_bf16 v[12:15], a[152:155], v[152:155], v[12:15]
  ds_read_b128 a[136:139], v214 offset:40960
  v_lshlrev_b32 v210, 30, v210
  v_mfma_f32_16x16x32_bf16 v[12:15], a[148:151], v[148:151], v[12:15]
  v_exp_f32 v11, v11
  v_mfma_f32_16x16x32_bf16 v[12:15], a[144:147], v[144:147], v[12:15]
  ds_read_b128 a[140:143], v215 offset:40960
  v_cvt_pk_bf16_f32 v9, v10, v11
  v_mfma_f32_16x16x32_bf16 v[20:23], a[144:147], v[160:163], v[200:203]
  v_exp_f32 v16, v16
  v_mfma_f32_16x16x32_bf16 v[20:23], a[148:151], v[164:167], v[20:23]
  buffer_load_dwordx4 v233, s[12:15], s29 offen offset:1024 lds
  v_mfma_f32_16x16x32_bf16 v[20:23], a[152:155], v[168:171], v[20:23]
  v_exp_f32 v17, v17
  v_mfma_f32_16x16x32_bf16 v[20:23], a[156:159], v[172:175], v[20:23]
  v_cvt_pk_bf16_f32 v16, v16, v17
  v_or_b32 v210, v210, v208
  v_mfma_f32_16x16x32_bf16 v[28:31], a[156:159], v[188:191], v[204:207]
  v_exp_f32 v18, v18
  v_mfma_f32_16x16x32_bf16 v[28:31], a[152:155], v[184:187], v[28:31]
  buffer_load_dwordx4 v234, s[12:15], s29 offen offset:2048 lds
  v_mfma_f32_16x16x32_bf16 v[28:31], a[148:151], v[180:183], v[28:31]
  s_waitcnt lgkmcnt(0)
  v_exp_f32 v19, v19
  v_mfma_f32_16x16x32_bf16 v[28:31], a[144:147], v[176:179], v[28:31]
  v_cvt_pk_bf16_f32 v17, v18, v19
  v_bfe_u32 v211, v209, 2, 4
  v_mfma_f32_16x16x32_bf16 v[32:35], a[128:131], v[128:131], v[192:195]
  v_exp_f32 v24, v24
  v_mfma_f32_16x16x32_bf16 v[32:35], a[132:135], v[132:135], v[32:35]
  ds_read_b128 a[144:147], v212 offset:45056
  v_and_b32 v209, 3, v209
  v_mfma_f32_16x16x32_bf16 v[32:35], a[136:139], v[136:139], v[32:35]
  v_exp_f32 v25, v25
  v_mfma_f32_16x16x32_bf16 v[32:35], a[140:143], v[140:143], v[32:35]
  ds_read_b128 a[148:151], v213 offset:45056
  v_cvt_pk_bf16_f32 v24, v24, v25
  v_mfma_f32_16x16x32_bf16 v[40:43], a[140:143], v[156:159], v[196:199]
  v_exp_f32 v26, v26
  v_mfma_f32_16x16x32_bf16 v[40:43], a[136:139], v[152:155], v[40:43]
  ds_read_b128 a[152:155], v214 offset:45056
  v_lshlrev_b32 v209, 3, v209
  v_mfma_f32_16x16x32_bf16 v[40:43], a[132:135], v[148:151], v[40:43]
  v_exp_f32 v27, v27
  v_mfma_f32_16x16x32_bf16 v[40:43], a[128:131], v[144:147], v[40:43]
  ds_read_b128 a[156:159], v215 offset:45056
  v_cvt_pk_bf16_f32 v25, v26, v27
  v_mfma_f32_16x16x32_bf16 v[48:51], a[128:131], v[160:163], v[200:203]
  v_exp_f32 v4, v4
  v_mfma_f32_16x16x32_bf16 v[48:51], a[132:135], v[164:167], v[48:51]
  buffer_load_dwordx4 v235, s[12:15], s29 offen offset:3072 lds
  v_mfma_f32_16x16x32_bf16 v[48:51], a[136:139], v[168:171], v[48:51]
  v_exp_f32 v5, v5
  v_mfma_f32_16x16x32_bf16 v[48:51], a[140:143], v[172:175], v[48:51]
  v_cvt_pk_bf16_f32 v2, v4, v5
  v_lshl_add_u32 v209, v211, 5, v209
  v_mfma_f32_16x16x32_bf16 v[56:59], a[140:143], v[188:191], v[204:207]
  v_exp_f32 v6, v6
  v_mfma_f32_16x16x32_bf16 v[56:59], a[136:139], v[184:187], v[56:59]
  v_add_u32 v209, s50, v209
  v_mfma_f32_16x16x32_bf16 v[56:59], a[132:135], v[180:183], v[56:59]
  s_waitcnt lgkmcnt(0)
  s_and_b32 s39, s2, 1
  s_lshl_b32 s39, s39, 2
  v_exp_f32 v7, v7
  v_mfma_f32_16x16x32_bf16 v[56:59], a[128:131], v[176:179], v[56:59]
  s_add_u32 s39, s39, s3
  s_lshr_b32 s31, s2, 1
  s_mul_i32 s30, s31, 40960
  v_cvt_pk_bf16_f32 v3, v6, v7
  v_mfma_f32_16x16x32_bf16 v[36:39], a[144:147], v[128:131], v[192:195]
  s_mul_i32 s48, s39, 160
  s_add_u32 s30, s30, s48
  s_mul_i32 s31, s31, 5120
  v_exp_f32 v12, v12
  v_mfma_f32_16x16x32_bf16 v[36:39], a[148:151], v[132:135], v[36:39]
  ds_read_b64_tr_b16 a[160:161], v216 offset:16384
  s_mul_i32 s39, s39, 655360
  s_add_u32 s31, s31, s39
  s_add_u32 s31, s31, 3145728
  v_mfma_f32_16x16x32_bf16 v[36:39], a[152:155], v[136:139], v[36:39]
  s_lshr_b32 s39, s2, 3
  s_min_u32 s39, s39, 29
  s_and_b32 s48, s2, 7
  v_exp_f32 v13, v13
  v_mfma_f32_16x16x32_bf16 v[36:39], a[156:159], v[140:143], v[36:39]
  ds_read_b64_tr_b16 a[162:163], v216 offset:20480
  s_mul_i32 s48, s48, 30
  s_add_u32 s39, s39, s48
  s_mul_i32 s98, s39, 1639
  v_cvt_pk_bf16_f32 v10, v12, v13
  v_mfma_f32_16x16x32_bf16 v[44:47], a[156:159], v[156:159], v[196:199]
  s_lshr_b32 s98, s98, 16
  s_mul_i32 s99, s98, 40
  s_sub_u32 s99, s39, s99
  v_exp_f32 v14, v14
  v_mfma_f32_16x16x32_bf16 v[44:47], a[152:155], v[152:155], v[44:47]
  ds_read_b64_tr_b16 a[164:165], v216 offset:24576
  s_min_u32 s39, s3, 2
  s_mul_i32 s48, s98, 3
  s_add_u32 s48, s48, s39
  v_mfma_f32_16x16x32_bf16 v[44:47], a[148:151], v[148:151], v[44:47]
  s_mul_i32 s100, s48, 122880
  s_lshl_b32 s39, s99, 5
  s_add_u32 s100, s100, s39
  v_exp_f32 v15, v15
  v_mfma_f32_16x16x32_bf16 v[44:47], a[144:147], v[144:147], v[44:47]
  ds_read_b64_tr_b16 a[166:167], v216 offset:28672
  s_mul_i32 s101, s48, 192
  s_add_u32 s101, s101, 2633728
  s_mov_b32 s51, s50
  v_cvt_pk_bf16_f32 v11, v14, v15
  v_mfma_f32_16x16x32_bf16 v[52:55], a[144:147], v[160:163], v[200:203]
  v_exp_f32 v20, v20
  v_mfma_f32_16x16x32_bf16 v[52:55], a[148:151], v[164:167], v[52:55]
  ds_read_b64_tr_b16 a[168:169], v217 offset:16384
  v_mov_b32 v211, v242
  v_mfma_f32_16x16x32_bf16 v[52:55], a[152:155], v[168:171], v[52:55]
  s_mov_b32 s4, s94
  s_mov_b32 s5, s95
  s_mov_b32 s6, 2211840
  v_exp_f32 v21, v21
  v_mfma_f32_16x16x32_bf16 v[52:55], a[156:159], v[172:175], v[52:55]
  ds_read_b64_tr_b16 a[170:171], v217 offset:20480
  s_mov_b32 s7, 0x20000
  v_cvt_pk_bf16_f32 v18, v20, v21
  v_mfma_f32_16x16x32_bf16 v[60:63], a[156:159], v[188:191], v[204:207]
  v_exp_f32 v22, v22
  v_mfma_f32_16x16x32_bf16 v[60:63], a[152:155], v[184:187], v[60:63]
  ds_read_b64_tr_b16 a[172:173], v217 offset:24576
  v_mfma_f32_16x16x32_bf16 v[60:63], a[148:151], v[180:183], v[60:63]
  v_exp_f32 v23, v23
  v_mfma_f32_16x16x32_bf16 v[60:63], a[144:147], v[176:179], v[60:63]
  ds_read_b64_tr_b16 a[174:175], v217 offset:28672
  v_cvt_pk_bf16_f32 v19, v22, v23
  v_mfma_f32_16x16x32_bf16 a[192:195], a[208:211], v[64:67], a[192:195]
  v_exp_f32 v28, v28
  v_mfma_f32_16x16x32_bf16 a[192:195], a[208:211], v[96:99], a[192:195]
  ds_read_b64_tr_b16 a[176:177], v218 offset:16384
  v_mfma_f32_16x16x32_bf16 a[196:199], a[208:211], v[72:75], a[196:199]
  v_exp_f32 v29, v29
  v_mfma_f32_16x16x32_bf16 a[196:199], a[208:211], v[104:107], a[196:199]
  ds_read_b64_tr_b16 a[178:179], v218 offset:20480
  v_cvt_pk_bf16_f32 v26, v28, v29
  v_mfma_f32_16x16x32_bf16 a[200:203], a[208:211], v[80:83], a[200:203]
  v_exp_f32 v30, v30
  v_mfma_f32_16x16x32_bf16 a[200:203], a[208:211], v[112:115], a[200:203]
  ds_read_b64_tr_b16 a[180:181], v218 offset:24576
  v_mfma_f32_16x16x32_bf16 a[204:207], a[208:211], v[88:91], a[204:207]
  s_waitcnt lgkmcnt(7)
  v_exp_f32 v31, v31
  v_mfma_f32_16x16x32_bf16 a[204:207], a[208:211], v[120:123], a[204:207]
  ds_read_b64_tr_b16 a[182:183], v218 offset:28672
  v_cvt_pk_bf16_f32 v27, v30, v31
  v_mfma_f32_16x16x32_bf16 a[0:3], a[160:163], v[64:67], a[0:3]
  v_exp_f32 v32, v32
  v_mfma_f32_16x16x32_bf16 a[0:3], a[164:167], v[96:99], a[0:3]
  ds_read_b64_tr_b16 a[184:185], v219 offset:16384
  v_mfma_f32_16x16x32_bf16 a[4:7], a[164:167], v[104:107], a[4:7]
  v_exp_f32 v33, v33
  v_mfma_f32_16x16x32_bf16 a[4:7], a[160:163], v[72:75], a[4:7]
  ds_read_b64_tr_b16 a[186:187], v219 offset:20480
  v_cvt_pk_bf16_f32 v32, v32, v33
  v_mfma_f32_16x16x32_bf16 a[8:11], a[160:163], v[80:83], a[8:11]
  v_exp_f32 v34, v34
  v_mfma_f32_16x16x32_bf16 a[8:11], a[164:167], v[112:115], a[8:11]
  ds_read_b64_tr_b16 a[188:189], v219 offset:24576
  v_mfma_f32_16x16x32_bf16 a[12:15], a[164:167], v[120:123], a[12:15]
  s_waitcnt lgkmcnt(7)
  v_exp_f32 v35, v35
  v_mfma_f32_16x16x32_bf16 a[12:15], a[160:163], v[88:91], a[12:15]
  ds_read_b64_tr_b16 a[190:191], v219 offset:28672
  v_cvt_pk_bf16_f32 v33, v34, v35
  v_mfma_f32_16x16x32_bf16 a[16:19], a[168:171], v[64:67], a[16:19]
  v_exp_f32 v40, v40
  v_mfma_f32_16x16x32_bf16 a[16:19], a[172:175], v[96:99], a[16:19]
  ds_read_b64_tr_b16 a[160:161], v220 offset:16384
  v_mfma_f32_16x16x32_bf16 a[20:23], a[172:175], v[104:107], a[20:23]
  v_exp_f32 v41, v41
  v_mfma_f32_16x16x32_bf16 a[20:23], a[168:171], v[72:75], a[20:23]
  ds_read_b64_tr_b16 a[162:163], v220 offset:20480
  v_cvt_pk_bf16_f32 v40, v40, v41
  v_mfma_f32_16x16x32_bf16 a[24:27], a[168:171], v[80:83], a[24:27]
  v_exp_f32 v42, v42
  v_mfma_f32_16x16x32_bf16 a[24:27], a[172:175], v[112:115], a[24:27]
  ds_read_b64_tr_b16 a[164:165], v220 offset:24576
  v_mfma_f32_16x16x32_bf16 a[28:31], a[172:175], v[120:123], a[28:31]
  s_waitcnt lgkmcnt(7)
  v_exp_f32 v43, v43
  v_mfma_f32_16x16x32_bf16 a[28:31], a[168:171], v[88:91], a[28:31]
  ds_read_b64_tr_b16 a[166:167], v220 offset:28672
  v_cvt_pk_bf16_f32 v41, v42, v43
  v_mfma_f32_16x16x32_bf16 a[32:35], a[176:179], v[64:67], a[32:35]
  v_exp_f32 v48, v48
  v_mfma_f32_16x16x32_bf16 a[32:35], a[180:183], v[96:99], a[32:35]
  ds_read_b64_tr_b16 a[168:169], v221 offset:16384
  v_mfma_f32_16x16x32_bf16 a[36:39], a[180:183], v[104:107], a[36:39]
  v_exp_f32 v49, v49
  v_mfma_f32_16x16x32_bf16 a[36:39], a[176:179], v[72:75], a[36:39]
  ds_read_b64_tr_b16 a[170:171], v221 offset:20480
  v_cvt_pk_bf16_f32 v48, v48, v49
  v_mfma_f32_16x16x32_bf16 a[40:43], a[176:179], v[80:83], a[40:43]
  v_exp_f32 v50, v50
  v_mfma_f32_16x16x32_bf16 a[40:43], a[180:183], v[112:115], a[40:43]
  ds_read_b64_tr_b16 a[172:173], v221 offset:24576
  v_mfma_f32_16x16x32_bf16 a[44:47], a[180:183], v[120:123], a[44:47]
  s_waitcnt lgkmcnt(7)
  v_exp_f32 v51, v51
  v_mfma_f32_16x16x32_bf16 a[44:47], a[176:179], v[88:91], a[44:47]
  ds_read_b64_tr_b16 a[174:175], v221 offset:28672
  v_cvt_pk_bf16_f32 v49, v50, v51
  v_mfma_f32_16x16x32_bf16 a[48:51], a[184:187], v[64:67], a[48:51]
  v_exp_f32 v56, v56
  v_mfma_f32_16x16x32_bf16 a[48:51], a[188:191], v[96:99], a[48:51]
  ds_read_b64_tr_b16 a[176:177], v222 offset:16384
  v_mfma_f32_16x16x32_bf16 a[52:55], a[188:191], v[104:107], a[52:55]
  v_exp_f32 v57, v57
  v_mfma_f32_16x16x32_bf16 a[52:55], a[184:187], v[72:75], a[52:55]
  ds_read_b64_tr_b16 a[178:179], v222 offset:20480
  v_cvt_pk_bf16_f32 v56, v56, v57
  v_mfma_f32_16x16x32_bf16 a[56:59], a[184:187], v[80:83], a[56:59]
  v_exp_f32 v58, v58
  v_mfma_f32_16x16x32_bf16 a[56:59], a[188:191], v[112:115], a[56:59]
  ds_read_b64_tr_b16 a[180:181], v222 offset:24576
  v_mfma_f32_16x16x32_bf16 a[60:63], a[188:191], v[120:123], a[60:63]
  s_waitcnt lgkmcnt(7)
  v_exp_f32 v59, v59
  v_mfma_f32_16x16x32_bf16 a[60:63], a[184:187], v[88:91], a[60:63]
  ds_read_b64_tr_b16 a[182:183], v222 offset:28672
  v_cvt_pk_bf16_f32 v57, v58, v59
  v_mfma_f32_16x16x32_bf16 a[64:67], a[160:163], v[64:67], a[64:67]
  v_exp_f32 v36, v36
  v_mfma_f32_16x16x32_bf16 a[64:67], a[164:167], v[96:99], a[64:67]
  ds_read_b64_tr_b16 a[184:185], v223 offset:16384
  v_mfma_f32_16x16x32_bf16 a[68:71], a[164:167], v[104:107], a[68:71]
  v_exp_f32 v37, v37
  v_mfma_f32_16x16x32_bf16 a[68:71], a[160:163], v[72:75], a[68:71]
  ds_read_b64_tr_b16 a[186:187], v223 offset:20480
  v_cvt_pk_bf16_f32 v34, v36, v37
  v_mfma_f32_16x16x32_bf16 a[72:75], a[160:163], v[80:83], a[72:75]
  v_exp_f32 v38, v38
  v_mfma_f32_16x16x32_bf16 a[72:75], a[164:167], v[112:115], a[72:75]
  ds_read_b64_tr_b16 a[188:189], v223 offset:24576
  v_mfma_f32_16x16x32_bf16 a[76:79], a[164:167], v[120:123], a[76:79]
  s_waitcnt lgkmcnt(7)
  v_exp_f32 v39, v39
  v_mfma_f32_16x16x32_bf16 a[76:79], a[160:163], v[88:91], a[76:79]
  ds_read_b64_tr_b16 a[190:191], v223 offset:28672
  v_cvt_pk_bf16_f32 v35, v38, v39
  v_mfma_f32_16x16x32_bf16 a[80:83], a[168:171], v[64:67], a[80:83]
  s_waitcnt vmcnt(10)
  v_exp_f32 v44, v44
  v_mfma_f32_16x16x32_bf16 a[80:83], a[172:175], v[96:99], a[80:83]
  v_mfma_f32_16x16x32_bf16 a[84:87], a[172:175], v[104:107], a[84:87]
  s_barrier
  v_exp_f32 v45, v45
  v_mfma_f32_16x16x32_bf16 a[84:87], a[168:171], v[72:75], a[84:87]
  ds_read_b128 a[128:131], v212 offset:49152
  v_cvt_pk_bf16_f32 v42, v44, v45
  v_mfma_f32_16x16x32_bf16 a[88:91], a[168:171], v[80:83], a[88:91]
  v_exp_f32 v46, v46
  v_mfma_f32_16x16x32_bf16 a[88:91], a[172:175], v[112:115], a[88:91]
  ds_read_b128 a[132:135], v213 offset:49152
  v_mfma_f32_16x16x32_bf16 a[92:95], a[172:175], v[120:123], a[92:95]
  s_waitcnt lgkmcnt(6)
  v_exp_f32 v47, v47
  v_mfma_f32_16x16x32_bf16 a[92:95], a[168:171], v[88:91], a[92:95]
  ds_read_b128 a[136:139], v214 offset:49152
  v_cvt_pk_bf16_f32 v43, v46, v47
  v_mfma_f32_16x16x32_bf16 a[96:99], a[176:179], v[64:67], a[96:99]
  v_exp_f32 v52, v52
  v_mfma_f32_16x16x32_bf16 a[96:99], a[180:183], v[96:99], a[96:99]
  ds_read_b128 a[140:143], v215 offset:49152
  v_mfma_f32_16x16x32_bf16 a[100:103], a[180:183], v[104:107], a[100:103]
  v_exp_f32 v53, v53
  v_mfma_f32_16x16x32_bf16 a[100:103], a[176:179], v[72:75], a[100:103]
  v_cvt_pk_bf16_f32 v50, v52, v53
  v_mfma_f32_16x16x32_bf16 a[104:107], a[176:179], v[80:83], a[104:107]
  v_exp_f32 v54, v54
  v_mfma_f32_16x16x32_bf16 a[104:107], a[180:183], v[112:115], a[104:107]
  v_mfma_f32_16x16x32_bf16 a[108:111], a[180:183], v[120:123], a[108:111]
  s_waitcnt lgkmcnt(4)
  v_exp_f32 v55, v55
  v_mfma_f32_16x16x32_bf16 a[108:111], a[176:179], v[88:91], a[108:111]
  v_cvt_pk_bf16_f32 v51, v54, v55
  v_mfma_f32_16x16x32_bf16 a[112:115], a[184:187], v[64:67], a[112:115]
  v_exp_f32 v60, v60
  v_mfma_f32_16x16x32_bf16 a[112:115], a[188:191], v[96:99], a[112:115]
  v_mfma_f32_16x16x32_bf16 a[116:119], a[188:191], v[104:107], a[116:119]
  v_exp_f32 v61, v61
  v_mfma_f32_16x16x32_bf16 a[116:119], a[184:187], v[72:75], a[116:119]
  v_cvt_pk_bf16_f32 v58, v60, v61
  v_mfma_f32_16x16x32_bf16 a[120:123], a[184:187], v[80:83], a[120:123]
  v_exp_f32 v62, v62
  v_mfma_f32_16x16x32_bf16 a[120:123], a[188:191], v[112:115], a[120:123]
  v_mfma_f32_16x16x32_bf16 a[124:127], a[188:191], v[120:123], a[124:127]
  s_waitcnt lgkmcnt(0)
  v_exp_f32 v63, v63
  v_mfma_f32_16x16x32_bf16 a[124:127], a[184:187], v[88:91], a[124:127]
  v_cvt_pk_bf16_f32 v59, v62, v63
  v_mfma_f32_16x16x32_bf16 v[64:67], a[128:131], v[128:131], v[192:195]
  s_add_u32 m0, s28, 65536
  v_lshrrev_b32 v224, 4, v242
  v_lshrrev_b32 v225, 4, v224
  v_mfma_f32_16x16x32_bf16 v[64:67], a[132:135], v[132:135], v[64:67]
  ds_read_b128 a[144:147], v212 offset:53248
  v_bfe_u32 v226, v224, 2, 2
  v_mfma_f32_16x16x32_bf16 v[64:67], a[136:139], v[136:139], v[64:67]
  buffer_load_dwordx4 v236, s[16:19], s29 offen offset:0 lds
  v_mfma_f32_16x16x32_bf16 v[64:67], a[140:143], v[140:143], v[64:67]
  ds_read_b128 a[148:151], v213 offset:53248
  v_lshl_add_u32 v225, v225, 3, v226
  v_mfma_f32_16x16x32_bf16 v[72:75], a[140:143], v[156:159], v[196:199]
  buffer_load_dwordx4 v237, s[16:19], s29 offen offset:1024 lds
  v_mfma_f32_16x16x32_bf16 v[72:75], a[136:139], v[152:155], v[72:75]
  ds_read_b128 a[152:155], v214 offset:53248
  v_lshlrev_b32 v225, 4, v225
  v_mfma_f32_16x16x32_bf16 v[72:75], a[132:135], v[148:151], v[72:75]
  buffer_load_dwordx4 v236, s[16:19], s29 offen offset:2048 lds
  v_mfma_f32_16x16x32_bf16 v[72:75], a[128:131], v[144:147], v[72:75]
  ds_read_b128 a[156:159], v215 offset:53248
  v_bfe_u32 v226, v224, 1, 1
  v_mfma_f32_16x16x32_bf16 v[80:83], a[128:131], v[160:163], v[200:203]
  v_exp_f32 v64, v64
  v_mfma_f32_16x16x32_bf16 v[80:83], a[132:135], v[164:167], v[80:83]
  buffer_load_dwordx4 v237, s[16:19], s29 offen offset:3072 lds
  v_mfma_f32_16x16x32_bf16 v[80:83], a[136:139], v[168:171], v[80:83]
  s_add_u32 s29, s29, 16384
  v_exp_f32 v65, v65
  v_mfma_f32_16x16x32_bf16 v[80:83], a[140:143], v[172:175], v[80:83]
  v_cvt_pk_bf16_f32 v64, v64, v65
  v_mul_u32_u24 v226, 0xc00, v226
  v_mfma_f32_16x16x32_bf16 v[88:91], a[140:143], v[188:191], v[204:207]
  s_add_u32 m0, s28, 16384
  v_exp_f32 v66, v66
  v_mfma_f32_16x16x32_bf16 v[88:91], a[136:139], v[184:187], v[88:91]
  buffer_load_dwordx4 v232, s[12:15], s29 offen offset:0 lds
  v_mfma_f32_16x16x32_bf16 v[88:91], a[132:135], v[180:183], v[88:91]
  s_waitcnt lgkmcnt(0)
  v_exp_f32 v67, v67
  v_mfma_f32_16x16x32_bf16 v[88:91], a[128:131], v[176:179], v[88:91]
  v_cvt_pk_bf16_f32 v65, v66, v67
  v_add3_u32 v225, v225, v226, s50
  v_mfma_f32_16x16x32_bf16 v[68:71], a[144:147], v[128:131], v[192:195]
  v_exp_f32 v72, v72
  v_mfma_f32_16x16x32_bf16 v[68:71], a[148:151], v[132:135], v[68:71]
  ds_read_b128 a[128:131], v212 offset:57344
  v_and_b32 v226, 1, v224
  v_mfma_f32_16x16x32_bf16 v[68:71], a[152:155], v[136:139], v[68:71]
  v_exp_f32 v73, v73
  v_mfma_f32_16x16x32_bf16 v[68:71], a[156:159], v[140:143], v[68:71]
  ds_read_b128 a[132:135], v213 offset:57344
  v_cvt_pk_bf16_f32 v72, v72, v73
  v_mfma_f32_16x16x32_bf16 v[76:79], a[156:159], v[156:159], v[196:199]
  v_exp_f32 v74, v74
  v_mfma_f32_16x16x32_bf16 v[76:79], a[152:155], v[152:155], v[76:79]
  ds_read_b128 a[136:139], v214 offset:57344
  v_lshl_add_u32 v225, v226, 3, v225
  v_mfma_f32_16x16x32_bf16 v[76:79], a[148:151], v[148:151], v[76:79]
  s_waitcnt vmcnt(13)
  v_exp_f32 v75, v75
  v_mfma_f32_16x16x32_bf16 v[76:79], a[144:147], v[144:147], v[76:79]
  ds_read_b128 a[140:143], v215 offset:57344
  v_cvt_pk_bf16_f32 v73, v74, v75
  v_mfma_f32_16x16x32_bf16 v[84:87], a[144:147], v[160:163], v[200:203]
  v_exp_f32 v80, v80
  v_mfma_f32_16x16x32_bf16 v[84:87], a[148:151], v[164:167], v[84:87]
  buffer_load_dwordx4 v233, s[12:15], s29 offen offset:1024 lds
  v_mfma_f32_16x16x32_bf16 v[84:87], a[152:155], v[168:171], v[84:87]
  v_exp_f32 v81, v81
  v_mfma_f32_16x16x32_bf16 v[84:87], a[156:159], v[172:175], v[84:87]
  ds_read_b64_tr_b16 a[232:233], v225 offset:0
  v_cvt_pk_bf16_f32 v80, v80, v81
  v_mfma_f32_16x16x32_bf16 v[92:95], a[156:159], v[188:191], v[204:207]
  v_exp_f32 v82, v82
  v_mfma_f32_16x16x32_bf16 v[92:95], a[152:155], v[184:187], v[92:95]
  buffer_load_dwordx4 v234, s[12:15], s29 offen offset:2048 lds
  v_mfma_f32_16x16x32_bf16 v[92:95], a[148:151], v[180:183], v[92:95]
  s_waitcnt lgkmcnt(1)
  v_exp_f32 v83, v83
  v_mfma_f32_16x16x32_bf16 v[92:95], a[144:147], v[176:179], v[92:95]
  ds_read_b64_tr_b16 a[234:235], v225 offset:64
  v_cvt_pk_bf16_f32 v81, v82, v83
  v_mfma_f32_16x16x32_bf16 v[96:99], a[128:131], v[128:131], v[192:195]
  v_exp_f32 v88, v88
  v_mfma_f32_16x16x32_bf16 v[96:99], a[132:135], v[132:135], v[96:99]
  ds_read_b128 a[144:147], v212 offset:61440
  ds_read_b64_tr_b16 a[236:237], v225 offset:512
  v_mfma_f32_16x16x32_bf16 v[96:99], a[136:139], v[136:139], v[96:99]
  v_exp_f32 v89, v89
  v_mfma_f32_16x16x32_bf16 v[96:99], a[140:143], v[140:143], v[96:99]
  ds_read_b128 a[148:151], v213 offset:61440
  v_cvt_pk_bf16_f32 v88, v88, v89
  v_mfma_f32_16x16x32_bf16 v[104:107], a[140:143], v[156:159], v[196:199]
  v_exp_f32 v90, v90
  v_mfma_f32_16x16x32_bf16 v[104:107], a[136:139], v[152:155], v[104:107]
  ds_read_b128 a[152:155], v214 offset:61440
  ds_read_b64_tr_b16 a[238:239], v225 offset:576
  v_mfma_f32_16x16x32_bf16 v[104:107], a[132:135], v[148:151], v[104:107]
  v_exp_f32 v91, v91
  v_mfma_f32_16x16x32_bf16 v[104:107], a[128:131], v[144:147], v[104:107]
  ds_read_b128 a[156:159], v215 offset:61440
  v_cvt_pk_bf16_f32 v89, v90, v91
  v_mfma_f32_16x16x32_bf16 v[112:115], a[128:131], v[160:163], v[200:203]
  v_exp_f32 v68, v68
  v_mfma_f32_16x16x32_bf16 v[112:115], a[132:135], v[164:167], v[112:115]
  buffer_load_dwordx4 v235, s[12:15], s29 offen offset:3072 lds
  v_mfma_f32_16x16x32_bf16 v[112:115], a[136:139], v[168:171], v[112:115]
  v_exp_f32 v69, v69
  v_mfma_f32_16x16x32_bf16 v[112:115], a[140:143], v[172:175], v[112:115]
  ds_read_b64_tr_b16 a[240:241], v225 offset:1024
  v_cvt_pk_bf16_f32 v66, v68, v69
  v_mfma_f32_16x16x32_bf16 v[120:123], a[140:143], v[188:191], v[204:207]
  v_exp_f32 v70, v70
  v_mfma_f32_16x16x32_bf16 v[120:123], a[136:139], v[184:187], v[120:123]
  ds_read_b64_tr_b16 a[242:243], v225 offset:1088
  ds_read_b64_tr_b16 a[244:245], v225 offset:1536
  v_mfma_f32_16x16x32_bf16 v[120:123], a[132:135], v[180:183], v[120:123]
  s_waitcnt lgkmcnt(3)
  v_exp_f32 v71, v71
  v_mfma_f32_16x16x32_bf16 v[120:123], a[128:131], v[176:179], v[120:123]
  ds_read_b64_tr_b16 a[246:247], v225 offset:1600
  v_cvt_pk_bf16_f32 v67, v70, v71
  v_mfma_f32_16x16x32_bf16 v[100:103], a[144:147], v[128:131], v[192:195]
  v_exp_f32 v76, v76
  v_mfma_f32_16x16x32_bf16 v[100:103], a[148:151], v[132:135], v[100:103]
  ds_read_b64_tr_b16 a[160:161], v216 offset:32768
  ds_read_b64_tr_b16 a[248:249], v225 offset:2048
  v_mfma_f32_16x16x32_bf16 v[100:103], a[152:155], v[136:139], v[100:103]
  v_exp_f32 v77, v77
  v_mfma_f32_16x16x32_bf16 v[100:103], a[156:159], v[140:143], v[100:103]
  ds_read_b64_tr_b16 a[162:163], v216 offset:36864
  v_cvt_pk_bf16_f32 v74, v76, v77
  v_mfma_f32_16x16x32_bf16 v[108:111], a[156:159], v[156:159], v[196:199]
  v_exp_f32 v78, v78
  v_mfma_f32_16x16x32_bf16 v[108:111], a[152:155], v[152:155], v[108:111]
  ds_read_b64_tr_b16 a[164:165], v216 offset:40960
  ds_read_b64_tr_b16 a[250:251], v225 offset:2112
  v_mfma_f32_16x16x32_bf16 v[108:111], a[148:151], v[148:151], v[108:111]
  v_exp_f32 v79, v79
  v_mfma_f32_16x16x32_bf16 v[108:111], a[144:147], v[144:147], v[108:111]
  ds_read_b64_tr_b16 a[166:167], v216 offset:45056
  v_cvt_pk_bf16_f32 v75, v78, v79
  v_mfma_f32_16x16x32_bf16 v[116:119], a[144:147], v[160:163], v[200:203]
  v_exp_f32 v84, v84
  v_mfma_f32_16x16x32_bf16 v[116:119], a[148:151], v[164:167], v[116:119]
  ds_read_b64_tr_b16 a[168:169], v217 offset:32768
  v_mfma_f32_16x16x32_bf16 v[116:119], a[152:155], v[168:171], v[116:119]
  v_exp_f32 v85, v85
  v_mfma_f32_16x16x32_bf16 v[116:119], a[156:159], v[172:175], v[116:119]
  ds_read_b64_tr_b16 a[170:171], v217 offset:36864
  v_cvt_pk_bf16_f32 v82, v84, v85
  v_mfma_f32_16x16x32_bf16 v[124:127], a[156:159], v[188:191], v[204:207]
  v_exp_f32 v86, v86
  v_mfma_f32_16x16x32_bf16 v[124:127], a[152:155], v[184:187], v[124:127]
  ds_read_b64_tr_b16 a[172:173], v217 offset:40960
  s_waitcnt lgkmcnt(4)
  v_mfma_f32_16x16x32_bf16 v[228:231], a[232:235], a[212:215], 0
  v_mfma_f32_16x16x32_bf16 v[228:231], a[236:239], a[216:219], v[228:231]
  v_mfma_f32_16x16x32_bf16 v[228:231], a[240:243], a[220:223], v[228:231]
  v_mfma_f32_16x16x32_bf16 v[228:231], a[244:247], a[224:227], v[228:231]
  v_mfma_f32_16x16x32_bf16 v[228:231], a[248:251], a[228:231], v[228:231]
  v_mfma_f32_16x16x32_bf16 v[124:127], a[148:151], v[180:183], v[124:127]
  s_lshl_b32 s35, s3, 10
  s_add_u32 s35, s35, 159744
  v_exp_f32 v87, v87
  v_mfma_f32_16x16x32_bf16 v[124:127], a[144:147], v[176:179], v[124:127]
  ds_read_b64_tr_b16 a[174:175], v217 offset:45056
  v_cvt_pk_bf16_f32 v83, v86, v87
  v_mfma_f32_16x16x32_bf16 a[192:195], a[208:211], v[0:3], a[192:195]
  v_exp_f32 v92, v92
  v_mfma_f32_16x16x32_bf16 a[192:195], a[208:211], v[32:35], a[192:195]
  ds_read_b64_tr_b16 a[176:177], v218 offset:32768
  v_add_u32 v224, s35, v242
  v_mfma_f32_16x16x32_bf16 a[196:199], a[208:211], v[8:11], a[196:199]
  v_exp_f32 v93, v93
  v_mfma_f32_16x16x32_bf16 a[196:199], a[208:211], v[40:43], a[196:199]
  ds_read_b64_tr_b16 a[178:179], v218 offset:36864
  v_cvt_pk_bf16_f32 v90, v92, v93
  v_mfma_f32_16x16x32_bf16 a[200:203], a[208:211], v[16:19], a[200:203]
  v_exp_f32 v94, v94
  v_mfma_f32_16x16x32_bf16 a[200:203], a[208:211], v[48:51], a[200:203]
  ds_read_b64_tr_b16 a[180:181], v218 offset:40960
  ds_write_b128 v224, v[228:231]
  v_mfma_f32_16x16x32_bf16 a[204:207], a[208:211], v[24:27], a[204:207]
  s_waitcnt lgkmcnt(8)
  v_exp_f32 v95, v95
  v_mfma_f32_16x16x32_bf16 a[204:207], a[208:211], v[56:59], a[204:207]
  ds_read_b64_tr_b16 a[182:183], v218 offset:45056
  v_cvt_pk_bf16_f32 v91, v94, v95
  v_mfma_f32_16x16x32_bf16 a[0:3], a[160:163], v[0:3], a[0:3]
  v_exp_f32 v96, v96
  v_mfma_f32_16x16x32_bf16 a[0:3], a[164:167], v[32:35], a[0:3]
  ds_read_b64_tr_b16 a[184:185], v219 offset:32768
  v_mfma_f32_16x16x32_bf16 a[4:7], a[164:167], v[40:43], a[4:7]
  v_exp_f32 v97, v97
  v_mfma_f32_16x16x32_bf16 a[4:7], a[160:163], v[8:11], a[4:7]
  ds_read_b64_tr_b16 a[186:187], v219 offset:36864
  v_cvt_pk_bf16_f32 v96, v96, v97
  v_mfma_f32_16x16x32_bf16 a[8:11], a[160:163], v[16:19], a[8:11]
  v_exp_f32 v98, v98
  v_mfma_f32_16x16x32_bf16 a[8:11], a[164:167], v[48:51], a[8:11]
  ds_read_b64_tr_b16 a[188:189], v219 offset:40960
  s_waitcnt lgkmcnt(4)
  s_mov_b32 m0, s51
  v_mfma_f32_16x16x32_bf16 a[12:15], a[164:167], v[56:59], a[12:15]
  v_exp_f32 v99, v99
  v_mfma_f32_16x16x32_bf16 a[12:15], a[160:163], v[24:27], a[12:15]
  ds_read_b64_tr_b16 a[190:191], v219 offset:45056
  v_cvt_pk_bf16_f32 v97, v98, v99
  v_mfma_f32_16x16x32_bf16 a[16:19], a[168:171], v[0:3], a[16:19]
  v_exp_f32 v104, v104
  v_mfma_f32_16x16x32_bf16 a[16:19], a[172:175], v[32:35], a[16:19]
  ds_read_b64_tr_b16 a[160:161], v220 offset:32768
  buffer_load_dwordx4 v210, s[4:7], s100 offen lds
  s_add_u32 s100, s100, 20480
  s_add_u32 s51, s51, 512
  v_mfma_f32_16x16x32_bf16 a[20:23], a[172:175], v[40:43], a[20:23]
  v_exp_f32 v105, v105
  v_mfma_f32_16x16x32_bf16 a[20:23], a[168:171], v[8:11], a[20:23]
  ds_read_b64_tr_b16 a[162:163], v220 offset:36864
  v_cvt_pk_bf16_f32 v104, v104, v105
  v_mfma_f32_16x16x32_bf16 a[24:27], a[168:171], v[16:19], a[24:27]
  v_exp_f32 v106, v106
  v_mfma_f32_16x16x32_bf16 a[24:27], a[172:175], v[48:51], a[24:27]
  ds_read_b64_tr_b16 a[164:165], v220 offset:40960
  v_lshrrev_b32 v224, 4, v242
  v_mfma_f32_16x16x32_bf16 a[28:31], a[172:175], v[56:59], a[28:31]
  s_waitcnt lgkmcnt(7)
  v_exp_f32 v107, v107
  v_mfma_f32_16x16x32_bf16 a[28:31], a[168:171], v[24:27], a[28:31]
  ds_read_b64_tr_b16 a[166:167], v220 offset:45056
  v_cvt_pk_bf16_f32 v105, v106, v107
  v_mfma_f32_16x16x32_bf16 a[32:35], a[176:179], v[0:3], a[32:35]
  v_exp_f32 v112, v112
  v_mfma_f32_16x16x32_bf16 a[32:35], a[180:183], v[32:35], a[32:35]
  ds_read_b64_tr_b16 a[168:169], v221 offset:32768
  v_bfe_u32 v225, v224, 2, 1
  v_mfma_f32_16x16x32_bf16 a[36:39], a[180:183], v[40:43], a[36:39]
  v_exp_f32 v113, v113
  v_mfma_f32_16x16x32_bf16 a[36:39], a[176:179], v[8:11], a[36:39]
  ds_read_b64_tr_b16 a[170:171], v221 offset:36864
  v_cvt_pk_bf16_f32 v112, v112, v113
  v_mfma_f32_16x16x32_bf16 a[40:43], a[176:179], v[16:19], a[40:43]
  v_exp_f32 v114, v114
  v_mfma_f32_16x16x32_bf16 a[40:43], a[180:183], v[48:51], a[40:43]
  ds_read_b64_tr_b16 a[172:173], v221 offset:40960
  v_lshlrev_b32 v225, 8, v225
  v_mfma_f32_16x16x32_bf16 a[44:47], a[180:183], v[56:59], a[44:47]
  s_waitcnt lgkmcnt(7)
  v_exp_f32 v115, v115
  v_mfma_f32_16x16x32_bf16 a[44:47], a[176:179], v[24:27], a[44:47]
  ds_read_b64_tr_b16 a[174:175], v221 offset:45056
  v_cvt_pk_bf16_f32 v113, v114, v115
  v_mfma_f32_16x16x32_bf16 a[48:51], a[184:187], v[0:3], a[48:51]
  v_exp_f32 v120, v120
  v_mfma_f32_16x16x32_bf16 a[48:51], a[188:191], v[32:35], a[48:51]
  ds_read_b64_tr_b16 a[176:177], v222 offset:32768
  v_lshrrev_b32 v226, 3, v224
  v_mfma_f32_16x16x32_bf16 a[52:55], a[188:191], v[40:43], a[52:55]
  v_exp_f32 v121, v121
  v_mfma_f32_16x16x32_bf16 a[52:55], a[184:187], v[8:11], a[52:55]
  ds_read_b64_tr_b16 a[178:179], v222 offset:36864
  v_cvt_pk_bf16_f32 v120, v120, v121
  v_mfma_f32_16x16x32_bf16 a[56:59], a[184:187], v[16:19], a[56:59]
  v_exp_f32 v122, v122
  v_mfma_f32_16x16x32_bf16 a[56:59], a[188:191], v[48:51], a[56:59]
  ds_read_b64_tr_b16 a[180:181], v222 offset:40960
  v_lshl_add_u32 v225, v226, 4, v225
  v_mfma_f32_16x16x32_bf16 a[60:63], a[188:191], v[56:59], a[60:63]
  s_waitcnt lgkmcnt(7)
  v_exp_f32 v123, v123
  v_mfma_f32_16x16x32_bf16 a[60:63], a[184:187], v[24:27], a[60:63]
  ds_read_b64_tr_b16 a[182:183], v222 offset:45056
  v_cvt_pk_bf16_f32 v121, v122, v123
  v_mfma_f32_16x16x32_bf16 a[64:67], a[160:163], v[0:3], a[64:67]
  v_exp_f32 v100, v100
  v_mfma_f32_16x16x32_bf16 a[64:67], a[164:167], v[32:35], a[64:67]
  ds_read_b64_tr_b16 a[184:185], v223 offset:32768
  v_and_b32 v227, 3, v224
  v_mfma_f32_16x16x32_bf16 a[68:71], a[164:167], v[40:43], a[68:71]
  v_exp_f32 v101, v101
  v_mfma_f32_16x16x32_bf16 a[68:71], a[160:163], v[8:11], a[68:71]
  ds_read_b64_tr_b16 a[186:187], v223 offset:36864
  v_cvt_pk_bf16_f32 v98, v100, v101
  v_mfma_f32_16x16x32_bf16 a[72:75], a[160:163], v[16:19], a[72:75]
  v_exp_f32 v102, v102
  v_mfma_f32_16x16x32_bf16 a[72:75], a[164:167], v[48:51], a[72:75]
  ds_read_b64_tr_b16 a[188:189], v223 offset:40960
  v_lshl_add_u32 v225, v227, 2, v225
  v_mfma_f32_16x16x32_bf16 a[76:79], a[164:167], v[56:59], a[76:79]
  s_waitcnt lgkmcnt(7)
  v_exp_f32 v103, v103
  v_mfma_f32_16x16x32_bf16 a[76:79], a[160:163], v[24:27], a[76:79]
  ds_read_b64_tr_b16 a[190:191], v223 offset:45056
  v_cvt_pk_bf16_f32 v99, v102, v103
  v_mfma_f32_16x16x32_bf16 a[80:83], a[168:171], v[0:3], a[80:83]
  s_waitcnt vmcnt(9)
  v_exp_f32 v108, v108
  v_mfma_f32_16x16x32_bf16 a[80:83], a[172:175], v[32:35], a[80:83]
  v_add_u32 v225, 159744, v225
  v_mfma_f32_16x16x32_bf16 a[84:87], a[172:175], v[40:43], a[84:87]
  s_barrier
  v_exp_f32 v109, v109
  v_mfma_f32_16x16x32_bf16 a[84:87], a[168:171], v[8:11], a[84:87]
  ds_read_b128 a[128:131], v212 offset:0
  v_cvt_pk_bf16_f32 v106, v108, v109
  v_mfma_f32_16x16x32_bf16 a[88:91], a[168:171], v[16:19], a[88:91]
  v_exp_f32 v110, v110
  v_mfma_f32_16x16x32_bf16 a[88:91], a[172:175], v[48:51], a[88:91]
  ds_read_b128 a[132:135], v213 offset:0
  ds_read_b32 v228, v225 offset:0
  v_mfma_f32_16x16x32_bf16 a[92:95], a[172:175], v[56:59], a[92:95]
  s_waitcnt lgkmcnt(7)
  v_exp_f32 v111, v111
  v_mfma_f32_16x16x32_bf16 a[92:95], a[168:171], v[24:27], a[92:95]
  ds_read_b128 a[136:139], v214 offset:0
  v_cvt_pk_bf16_f32 v107, v110, v111
  v_mfma_f32_16x16x32_bf16 a[96:99], a[176:179], v[0:3], a[96:99]
  v_exp_f32 v116, v116
  v_mfma_f32_16x16x32_bf16 a[96:99], a[180:183], v[32:35], a[96:99]
  ds_read_b128 a[140:143], v215 offset:0
  ds_read_b32 v229, v225 offset:1024
  v_mfma_f32_16x16x32_bf16 a[100:103], a[180:183], v[40:43], a[100:103]
  v_exp_f32 v117, v117
  v_mfma_f32_16x16x32_bf16 a[100:103], a[176:179], v[8:11], a[100:103]
  ds_read_b32 v230, v225 offset:2048
  v_cvt_pk_bf16_f32 v114, v116, v117
  v_mfma_f32_16x16x32_bf16 a[104:107], a[176:179], v[16:19], a[104:107]
  v_exp_f32 v118, v118
  v_mfma_f32_16x16x32_bf16 a[104:107], a[180:183], v[48:51], a[104:107]
  ds_read_b32 v231, v225 offset:3072
  ds_read_b32 v238, v225 offset:512
  v_mfma_f32_16x16x32_bf16 a[108:111], a[180:183], v[56:59], a[108:111]
  s_waitcnt lgkmcnt(9)
  v_exp_f32 v119, v119
  v_mfma_f32_16x16x32_bf16 a[108:111], a[176:179], v[24:27], a[108:111]
  ds_read_b32 v239, v225 offset:1536
  v_cvt_pk_bf16_f32 v115, v118, v119
  v_mfma_f32_16x16x32_bf16 a[112:115], a[184:187], v[0:3], a[112:115]
  v_exp_f32 v124, v124
  v_mfma_f32_16x16x32_bf16 a[112:115], a[188:191], v[32:35], a[112:115]
  ds_read_b32 v240, v225 offset:2560
  ds_read_b32 v241, v225 offset:3584
  s_cmp_eq_u32 s3, 0
  s_cselect_b32 s35, 0, 1073741824
  v_mfma_f32_16x16x32_bf16 a[116:119], a[188:191], v[40:43], a[116:119]
  v_exp_f32 v125, v125
  v_mfma_f32_16x16x32_bf16 a[116:119], a[184:187], v[8:11], a[116:119]
  v_cvt_pk_bf16_f32 v122, v124, v125
  v_mul_u32_u24 v226, 0xd80, v226
  v_mfma_f32_16x16x32_bf16 a[120:123], a[184:187], v[16:19], a[120:123]
  v_exp_f32 v126, v126
  v_mfma_f32_16x16x32_bf16 a[120:123], a[188:191], v[48:51], a[120:123]
  v_and_b32 v227, 7, v224
  v_lshl_add_u32 v226, v227, 1, v226
  v_mfma_f32_16x16x32_bf16 a[124:127], a[188:191], v[56:59], a[124:127]
  s_waitcnt lgkmcnt(7)
  v_exp_f32 v127, v127
  v_mfma_f32_16x16x32_bf16 a[124:127], a[184:187], v[24:27], a[124:127]
  v_cvt_pk_bf16_f32 v123, v126, v127
  v_and_b32 v227, 1, v224
  v_lshl_add_u32 v226, v227, 30, v226
  v_or_b32 v226, s35, v226
  v_min_u32 v249, 1, v224
  v_lshlrev_b32 v249, 30, v249
  v_or_b32 v249, s35, v249
  v_mov_b32 v251, v249
  v_mov_b32 v250, 1
  s_mov_b32 s47, 2818048
  s_lshl_b32 s35, s33, 4
  s_add_u32 s35, s35, 2633728
  s_waitcnt lgkmcnt(0)
  v_add_f32 v228, v228, v229
  v_add_f32 v238, v238, v239
  v_add_f32 v230, v230, v231
  v_add_f32 v240, v240, v241
  v_add_f32 v228, v228, v230
  v_add_f32 v238, v238, v240
  v_cvt_pk_bf16_f32 v228, v228, v228
  v_cvt_pk_bf16_f32 v238, v238, v238
  v_lshlrev_b32 v228, 16, v228
  v_lshlrev_b32 v238, 16, v238
  v_mul_f32 v229, 0xbfb8aa3b, v228
  v_exp_f32 v229, v229
  s_nop 0
  v_add_f32 v229, 1.0, v229
  v_rcp_f32 v229, v229
  s_nop 0
  v_mul_f32 v228, v228, v229
  v_cvt_pk_bf16_f32 v228, v228, v228
  v_lshlrev_b32 v228, 16, v228
  v_mul_f32 v228, v228, v238
  s_nop 1
  v_mov_b32_dpp v229, v228 quad_perm:[1,0,3,2] row_mask:0xf bank_mask:0xf
  v_cvt_pk_bf16_f32 v228, v228, v229
  buffer_store_dword v228, v226, s[24:27], s35 offen sc1
  s_mov_b32 s32, 5
attn_loop:
  v_mfma_f32_16x16x32_bf16 v[0:3], a[128:131], v[128:131], v[192:195]
  s_add_u32 m0, s28, 81920
  v_mfma_f32_16x16x32_bf16 v[0:3], a[132:135], v[132:135], v[0:3]
  ds_read_b128 a[144:147], v212 offset:4096
  v_mfma_f32_16x16x32_bf16 v[0:3], a[136:139], v[136:139], v[0:3]
  buffer_load_dwordx4 v236, s[16:19], s29 offen offset:0 lds
  v_mfma_f32_16x16x32_bf16 v[0:3], a[140:143], v[140:143], v[0:3]
  ds_read_b128 a[148:151], v213 offset:4096
  v_mfma_f32_16x16x32_bf16 v[8:11], a[140:143], v[156:159], v[196:199]
  buffer_load_dwordx4 v237, s[16:19], s29 offen offset:1024 lds
  v_mfma_f32_16x16x32_bf16 v[8:11], a[136:139], v[152:155], v[8:11]
  ds_read_b128 a[152:155], v214 offset:4096
  v_mfma_f32_16x16x32_bf16 v[8:11], a[132:135], v[148:151], v[8:11]
  buffer_load_dwordx4 v236, s[16:19], s29 offen offset:2048 lds
  v_mfma_f32_16x16x32_bf16 v[8:11], a[128:131], v[144:147], v[8:11]
  ds_read_b128 a[156:159], v215 offset:4096
  v_mfma_f32_16x16x32_bf16 v[16:19], a[128:131], v[160:163], v[200:203]
  v_exp_f32 v0, v0
  v_mfma_f32_16x16x32_bf16 v[16:19], a[132:135], v[164:167], v[16:19]
  buffer_load_dwordx4 v237, s[16:19], s29 offen offset:3072 lds
  v_mfma_f32_16x16x32_bf16 v[16:19], a[136:139], v[168:171], v[16:19]
  s_add_u32 s29, s29, 16384
  v_exp_f32 v1, v1
  v_mfma_f32_16x16x32_bf16 v[16:19], a[140:143], v[172:175], v[16:19]
  v_cvt_pk_bf16_f32 v0, v0, v1
  v_mfma_f32_16x16x32_bf16 v[24:27], a[140:143], v[188:191], v[204:207]
  s_add_u32 m0, s28, 32768
  v_exp_f32 v2, v2
  v_mfma_f32_16x16x32_bf16 v[24:27], a[136:139], v[184:187], v[24:27]
  buffer_load_dwordx4 v232, s[12:15], s29 offen offset:0 lds
  v_mfma_f32_16x16x32_bf16 v[24:27], a[132:135], v[180:183], v[24:27]
  s_waitcnt lgkmcnt(0)
  v_exp_f32 v3, v3
  v_mfma_f32_16x16x32_bf16 v[24:27], a[128:131], v[176:179], v[24:27]
  v_cvt_pk_bf16_f32 v1, v2, v3
  v_mfma_f32_16x16x32_bf16 v[4:7], a[144:147], v[128:131], v[192:195]
  v_exp_f32 v8, v8
  v_mfma_f32_16x16x32_bf16 v[4:7], a[148:151], v[132:135], v[4:7]
  ds_read_b128 a[128:131], v212 offset:8192
  v_mfma_f32_16x16x32_bf16 v[4:7], a[152:155], v[136:139], v[4:7]
  v_exp_f32 v9, v9
  v_mfma_f32_16x16x32_bf16 v[4:7], a[156:159], v[140:143], v[4:7]
  ds_read_b128 a[132:135], v213 offset:8192
  v_cvt_pk_bf16_f32 v8, v8, v9
  v_mfma_f32_16x16x32_bf16 v[12:15], a[156:159], v[156:159], v[196:199]
  v_exp_f32 v10, v10
  v_mfma_f32_16x16x32_bf16 v[12:15], a[152:155], v[152:155], v[12:15]
  ds_read_b128 a[136:139], v214 offset:8192
  v_mfma_f32_16x16x32_bf16 v[12:15], a[148:151], v[148:151], v[12:15]
  v_exp_f32 v11, v11
  v_mfma_f32_16x16x32_bf16 v[12:15], a[144:147], v[144:147], v[12:15]
  ds_read_b128 a[140:143], v215 offset:8192
  v_cvt_pk_bf16_f32 v9, v10, v11
  v_mfma_f32_16x16x32_bf16 v[20:23], a[144:147], v[160:163], v[200:203]
  v_exp_f32 v16, v16
  v_mfma_f32_16x16x32_bf16 v[20:23], a[148:151], v[164:167], v[20:23]
  buffer_load_dwordx4 v233, s[12:15], s29 offen offset:1024 lds
  v_mfma_f32_16x16x32_bf16 v[20:23], a[152:155], v[168:171], v[20:23]
  v_exp_f32 v17, v17
  v_mfma_f32_16x16x32_bf16 v[20:23], a[156:159], v[172:175], v[20:23]
  v_cvt_pk_bf16_f32 v16, v16, v17
  v_mfma_f32_16x16x32_bf16 v[28:31], a[156:159], v[188:191], v[204:207]
  v_exp_f32 v18, v18
  v_mfma_f32_16x16x32_bf16 v[28:31], a[152:155], v[184:187], v[28:31]
  buffer_load_dwordx4 v234, s[12:15], s29 offen offset:2048 lds
  v_mfma_f32_16x16x32_bf16 v[28:31], a[148:151], v[180:183], v[28:31]
  s_waitcnt lgkmcnt(0)
  v_exp_f32 v19, v19
  v_mfma_f32_16x16x32_bf16 v[28:31], a[144:147], v[176:179], v[28:31]
  v_cvt_pk_bf16_f32 v17, v18, v19
  v_mfma_f32_16x16x32_bf16 v[32:35], a[128:131], v[128:131], v[192:195]
  v_exp_f32 v24, v24
  v_mfma_f32_16x16x32_bf16 v[32:35], a[132:135], v[132:135], v[32:35]
  ds_read_b128 a[144:147], v212 offset:12288
  v_mfma_f32_16x16x32_bf16 v[32:35], a[136:139], v[136:139], v[32:35]
  v_exp_f32 v25, v25
  v_mfma_f32_16x16x32_bf16 v[32:35], a[140:143], v[140:143], v[32:35]
  ds_read_b128 a[148:151], v213 offset:12288
  v_cvt_pk_bf16_f32 v24, v24, v25
  v_mfma_f32_16x16x32_bf16 v[40:43], a[140:143], v[156:159], v[196:199]
  v_exp_f32 v26, v26
  v_mfma_f32_16x16x32_bf16 v[40:43], a[136:139], v[152:155], v[40:43]
  ds_read_b128 a[152:155], v214 offset:12288
  v_mfma_f32_16x16x32_bf16 v[40:43], a[132:135], v[148:151], v[40:43]
  v_exp_f32 v27, v27
  v_mfma_f32_16x16x32_bf16 v[40:43], a[128:131], v[144:147], v[40:43]
  ds_read_b128 a[156:159], v215 offset:12288
  v_cvt_pk_bf16_f32 v25, v26, v27
  v_mfma_f32_16x16x32_bf16 v[48:51], a[128:131], v[160:163], v[200:203]
  v_exp_f32 v4, v4
  v_mfma_f32_16x16x32_bf16 v[48:51], a[132:135], v[164:167], v[48:51]
  buffer_load_dwordx4 v235, s[12:15], s29 offen offset:3072 lds
  v_mfma_f32_16x16x32_bf16 v[48:51], a[136:139], v[168:171], v[48:51]
  v_exp_f32 v5, v5
  v_mfma_f32_16x16x32_bf16 v[48:51], a[140:143], v[172:175], v[48:51]
  v_cvt_pk_bf16_f32 v2, v4, v5
  v_mfma_f32_16x16x32_bf16 v[56:59], a[140:143], v[188:191], v[204:207]
  s_add_u32 m0, s50, 4096
  v_exp_f32 v6, v6
  v_mfma_f32_16x16x32_bf16 v[56:59], a[136:139], v[184:187], v[56:59]
  buffer_load_dwordx4 v208, s[20:23], s30 offen lds
  s_add_u32 s30, s30, 32
  v_mfma_f32_16x16x32_bf16 v[56:59], a[132:135], v[180:183], v[56:59]
  s_waitcnt lgkmcnt(0)
  v_exp_f32 v7, v7
  v_mfma_f32_16x16x32_bf16 v[56:59], a[128:131], v[176:179], v[56:59]
  v_cvt_pk_bf16_f32 v3, v6, v7
  v_mfma_f32_16x16x32_bf16 v[36:39], a[144:147], v[128:131], v[192:195]
  v_exp_f32 v12, v12
  v_mfma_f32_16x16x32_bf16 v[36:39], a[148:151], v[132:135], v[36:39]
  ds_read_b64_tr_b16 a[160:161], v216 offset:49152
  v_mfma_f32_16x16x32_bf16 v[36:39], a[152:155], v[136:139], v[36:39]
  v_exp_f32 v13, v13
  v_mfma_f32_16x16x32_bf16 v[36:39], a[156:159], v[140:143], v[36:39]
  ds_read_b64_tr_b16 a[162:163], v216 offset:53248
  v_cvt_pk_bf16_f32 v10, v12, v13
  v_mfma_f32_16x16x32_bf16 v[44:47], a[156:159], v[156:159], v[196:199]
  v_exp_f32 v14, v14
  v_mfma_f32_16x16x32_bf16 v[44:47], a[152:155], v[152:155], v[44:47]
  ds_read_b64_tr_b16 a[164:165], v216 offset:57344
  v_mfma_f32_16x16x32_bf16 v[44:47], a[148:151], v[148:151], v[44:47]
  v_exp_f32 v15, v15
  v_mfma_f32_16x16x32_bf16 v[44:47], a[144:147], v[144:147], v[44:47]
  ds_read_b64_tr_b16 a[166:167], v216 offset:61440
  v_cvt_pk_bf16_f32 v11, v14, v15
  v_mfma_f32_16x16x32_bf16 v[52:55], a[144:147], v[160:163], v[200:203]
  v_exp_f32 v20, v20
  v_mfma_f32_16x16x32_bf16 v[52:55], a[148:151], v[164:167], v[52:55]
  ds_read_b64_tr_b16 a[168:169], v217 offset:49152
  v_mfma_f32_16x16x32_bf16 v[52:55], a[152:155], v[168:171], v[52:55]
  v_exp_f32 v21, v21
  v_mfma_f32_16x16x32_bf16 v[52:55], a[156:159], v[172:175], v[52:55]
  ds_read_b64_tr_b16 a[170:171], v217 offset:53248
  v_cvt_pk_bf16_f32 v18, v20, v21
  v_mfma_f32_16x16x32_bf16 v[60:63], a[156:159], v[188:191], v[204:207]
  v_exp_f32 v22, v22
  v_mfma_f32_16x16x32_bf16 v[60:63], a[152:155], v[184:187], v[60:63]
  ds_read_b64_tr_b16 a[172:173], v217 offset:57344
  v_mfma_f32_16x16x32_bf16 v[60:63], a[148:151], v[180:183], v[60:63]
  v_exp_f32 v23, v23
  v_mfma_f32_16x16x32_bf16 v[60:63], a[144:147], v[176:179], v[60:63]
  ds_read_b64_tr_b16 a[174:175], v217 offset:61440
  v_cvt_pk_bf16_f32 v19, v22, v23
  v_mfma_f32_16x16x32_bf16 a[192:195], a[208:211], v[64:67], a[192:195]
  v_exp_f32 v28, v28
  v_mfma_f32_16x16x32_bf16 a[192:195], a[208:211], v[96:99], a[192:195]
  ds_read_b64_tr_b16 a[176:177], v218 offset:49152
  v_mfma_f32_16x16x32_bf16 a[196:199], a[208:211], v[72:75], a[196:199]
  v_exp_f32 v29, v29
  v_mfma_f32_16x16x32_bf16 a[196:199], a[208:211], v[104:107], a[196:199]
  ds_read_b64_tr_b16 a[178:179], v218 offset:53248
  v_cvt_pk_bf16_f32 v26, v28, v29
  v_mfma_f32_16x16x32_bf16 a[200:203], a[208:211], v[80:83], a[200:203]
  v_exp_f32 v30, v30
  v_mfma_f32_16x16x32_bf16 a[200:203], a[208:211], v[112:115], a[200:203]
  ds_read_b64_tr_b16 a[180:181], v218 offset:57344
  v_mfma_f32_16x16x32_bf16 a[204:207], a[208:211], v[88:91], a[204:207]
  s_waitcnt lgkmcnt(7)
  v_exp_f32 v31, v31
  v_mfma_f32_16x16x32_bf16 a[204:207], a[208:211], v[120:123], a[204:207]
  ds_read_b64_tr_b16 a[182:183], v218 offset:61440
  v_cvt_pk_bf16_f32 v27, v30, v31
  v_mfma_f32_16x16x32_bf16 a[0:3], a[160:163], v[64:67], a[0:3]
  v_exp_f32 v32, v32
  v_mfma_f32_16x16x32_bf16 a[0:3], a[164:167], v[96:99], a[0:3]
  ds_read_b64_tr_b16 a[184:185], v219 offset:49152
  v_mfma_f32_16x16x32_bf16 a[4:7], a[164:167], v[104:107], a[4:7]
  v_exp_f32 v33, v33
  v_mfma_f32_16x16x32_bf16 a[4:7], a[160:163], v[72:75], a[4:7]
  ds_read_b64_tr_b16 a[186:187], v219 offset:53248
  v_cvt_pk_bf16_f32 v32, v32, v33
  v_mfma_f32_16x16x32_bf16 a[8:11], a[160:163], v[80:83], a[8:11]
  v_exp_f32 v34, v34
  v_mfma_f32_16x16x32_bf16 a[8:11], a[164:167], v[112:115], a[8:11]
  ds_read_b64_tr_b16 a[188:189], v219 offset:57344
  v_mfma_f32_16x16x32_bf16 a[12:15], a[164:167], v[120:123], a[12:15]
  s_waitcnt lgkmcnt(7)
  v_exp_f32 v35, v35
  v_mfma_f32_16x16x32_bf16 a[12:15], a[160:163], v[88:91], a[12:15]
  ds_read_b64_tr_b16 a[190:191], v219 offset:61440
  v_cvt_pk_bf16_f32 v33, v34, v35
  v_mfma_f32_16x16x32_bf16 a[16:19], a[168:171], v[64:67], a[16:19]
  v_exp_f32 v40, v40
  v_mfma_f32_16x16x32_bf16 a[16:19], a[172:175], v[96:99], a[16:19]
  ds_read_b64_tr_b16 a[160:161], v220 offset:49152
  v_mfma_f32_16x16x32_bf16 a[20:23], a[172:175], v[104:107], a[20:23]
  v_exp_f32 v41, v41
  v_mfma_f32_16x16x32_bf16 a[20:23], a[168:171], v[72:75], a[20:23]
  ds_read_b64_tr_b16 a[162:163], v220 offset:53248
  v_cvt_pk_bf16_f32 v40, v40, v41
  v_mfma_f32_16x16x32_bf16 a[24:27], a[168:171], v[80:83], a[24:27]
  v_exp_f32 v42, v42
  v_mfma_f32_16x16x32_bf16 a[24:27], a[172:175], v[112:115], a[24:27]
  ds_read_b64_tr_b16 a[164:165], v220 offset:57344
  v_mfma_f32_16x16x32_bf16 a[28:31], a[172:175], v[120:123], a[28:31]
  s_waitcnt lgkmcnt(7)
  v_exp_f32 v43, v43
  v_mfma_f32_16x16x32_bf16 a[28:31], a[168:171], v[88:91], a[28:31]
  ds_read_b64_tr_b16 a[166:167], v220 offset:61440
  v_cvt_pk_bf16_f32 v41, v42, v43
  v_mfma_f32_16x16x32_bf16 a[32:35], a[176:179], v[64:67], a[32:35]
  v_exp_f32 v48, v48
  v_mfma_f32_16x16x32_bf16 a[32:35], a[180:183], v[96:99], a[32:35]
  ds_read_b64_tr_b16 a[168:169], v221 offset:49152
  v_mfma_f32_16x16x32_bf16 a[36:39], a[180:183], v[104:107], a[36:39]
  v_exp_f32 v49, v49
  v_mfma_f32_16x16x32_bf16 a[36:39], a[176:179], v[72:75], a[36:39]
  ds_read_b64_tr_b16 a[170:171], v221 offset:53248
  v_cvt_pk_bf16_f32 v48, v48, v49
  v_mfma_f32_16x16x32_bf16 a[40:43], a[176:179], v[80:83], a[40:43]
  v_exp_f32 v50, v50
  v_mfma_f32_16x16x32_bf16 a[40:43], a[180:183], v[112:115], a[40:43]
  ds_read_b64_tr_b16 a[172:173], v221 offset:57344
  v_mfma_f32_16x16x32_bf16 a[44:47], a[180:183], v[120:123], a[44:47]
  s_waitcnt lgkmcnt(7)
  v_exp_f32 v51, v51
  v_mfma_f32_16x16x32_bf16 a[44:47], a[176:179], v[88:91], a[44:47]
  ds_read_b64_tr_b16 a[174:175], v221 offset:61440
  v_cvt_pk_bf16_f32 v49, v50, v51
  v_mfma_f32_16x16x32_bf16 a[48:51], a[184:187], v[64:67], a[48:51]
  v_exp_f32 v56, v56
  v_mfma_f32_16x16x32_bf16 a[48:51], a[188:191], v[96:99], a[48:51]
  ds_read_b64_tr_b16 a[176:177], v222 offset:49152
  v_mfma_f32_16x16x32_bf16 a[52:55], a[188:191], v[104:107], a[52:55]
  v_exp_f32 v57, v57
  v_mfma_f32_16x16x32_bf16 a[52:55], a[184:187], v[72:75], a[52:55]
  ds_read_b64_tr_b16 a[178:179], v222 offset:53248
  v_cvt_pk_bf16_f32 v56, v56, v57
  v_mfma_f32_16x16x32_bf16 a[56:59], a[184:187], v[80:83], a[56:59]
  v_exp_f32 v58, v58
  v_mfma_f32_16x16x32_bf16 a[56:59], a[188:191], v[112:115], a[56:59]
  ds_read_b64_tr_b16 a[180:181], v222 offset:57344
  v_mfma_f32_16x16x32_bf16 a[60:63], a[188:191], v[120:123], a[60:63]
  s_waitcnt lgkmcnt(7)
  v_exp_f32 v59, v59
  v_mfma_f32_16x16x32_bf16 a[60:63], a[184:187], v[88:91], a[60:63]
  ds_read_b64_tr_b16 a[182:183], v222 offset:61440
  v_cvt_pk_bf16_f32 v57, v58, v59
  v_mfma_f32_16x16x32_bf16 a[64:67], a[160:163], v[64:67], a[64:67]
  v_exp_f32 v36, v36
  v_mfma_f32_16x16x32_bf16 a[64:67], a[164:167], v[96:99], a[64:67]
  ds_read_b64_tr_b16 a[184:185], v223 offset:49152
  v_mfma_f32_16x16x32_bf16 a[68:71], a[164:167], v[104:107], a[68:71]
  v_exp_f32 v37, v37
  v_mfma_f32_16x16x32_bf16 a[68:71], a[160:163], v[72:75], a[68:71]
  ds_read_b64_tr_b16 a[186:187], v223 offset:53248
  v_cvt_pk_bf16_f32 v34, v36, v37
  v_mfma_f32_16x16x32_bf16 a[72:75], a[160:163], v[80:83], a[72:75]
  v_exp_f32 v38, v38
  v_mfma_f32_16x16x32_bf16 a[72:75], a[164:167], v[112:115], a[72:75]
  ds_read_b64_tr_b16 a[188:189], v223 offset:57344
  v_mfma_f32_16x16x32_bf16 a[76:79], a[164:167], v[120:123], a[76:79]
  s_waitcnt lgkmcnt(7)
  v_exp_f32 v39, v39
  v_mfma_f32_16x16x32_bf16 a[76:79], a[160:163], v[88:91], a[76:79]
  ds_read_b64_tr_b16 a[190:191], v223 offset:61440
  v_cvt_pk_bf16_f32 v35, v38, v39
  v_mfma_f32_16x16x32_bf16 a[80:83], a[168:171], v[64:67], a[80:83]
  s_waitcnt vmcnt(11)
  v_exp_f32 v44, v44
  v_mfma_f32_16x16x32_bf16 a[80:83], a[172:175], v[96:99], a[80:83]
  v_mfma_f32_16x16x32_bf16 a[84:87], a[172:175], v[104:107], a[84:87]
  s_barrier
  v_exp_f32 v45, v45
  v_mfma_f32_16x16x32_bf16 a[84:87], a[168:171], v[72:75], a[84:87]
  ds_read_b128 a[128:131], v212 offset:16384
  v_cvt_pk_bf16_f32 v42, v44, v45
  v_mfma_f32_16x16x32_bf16 a[88:91], a[168:171], v[80:83], a[88:91]
  v_exp_f32 v46, v46
  v_mfma_f32_16x16x32_bf16 a[88:91], a[172:175], v[112:115], a[88:91]
  ds_read_b128 a[132:135], v213 offset:16384
  v_mfma_f32_16x16x32_bf16 a[92:95], a[172:175], v[120:123], a[92:95]
  s_waitcnt lgkmcnt(6)
  v_exp_f32 v47, v47
  v_mfma_f32_16x16x32_bf16 a[92:95], a[168:171], v[88:91], a[92:95]
  ds_read_b128 a[136:139], v214 offset:16384
  v_cvt_pk_bf16_f32 v43, v46, v47
  v_mfma_f32_16x16x32_bf16 a[96:99], a[176:179], v[64:67], a[96:99]
  v_exp_f32 v52, v52
  v_mfma_f32_16x16x32_bf16 a[96:99], a[180:183], v[96:99], a[96:99]
  ds_read_b128 a[140:143], v215 offset:16384
  v_mfma_f32_16x16x32_bf16 a[100:103], a[180:183], v[104:107], a[100:103]
  v_exp_f32 v53, v53
  v_mfma_f32_16x16x32_bf16 a[100:103], a[176:179], v[72:75], a[100:103]
  v_cvt_pk_bf16_f32 v50, v52, v53
  v_mfma_f32_16x16x32_bf16 a[104:107], a[176:179], v[80:83], a[104:107]
  v_exp_f32 v54, v54
  v_mfma_f32_16x16x32_bf16 a[104:107], a[180:183], v[112:115], a[104:107]
  v_mfma_f32_16x16x32_bf16 a[108:111], a[180:183], v[120:123], a[108:111]
  s_waitcnt lgkmcnt(4)
  v_exp_f32 v55, v55
  v_mfma_f32_16x16x32_bf16 a[108:111], a[176:179], v[88:91], a[108:111]
  v_cvt_pk_bf16_f32 v51, v54, v55
  v_mfma_f32_16x16x32_bf16 a[112:115], a[184:187], v[64:67], a[112:115]
  v_exp_f32 v60, v60
  v_mfma_f32_16x16x32_bf16 a[112:115], a[188:191], v[96:99], a[112:115]
  v_mfma_f32_16x16x32_bf16 a[116:119], a[188:191], v[104:107], a[116:119]
  v_exp_f32 v61, v61
  v_mfma_f32_16x16x32_bf16 a[116:119], a[184:187], v[72:75], a[116:119]
  v_cvt_pk_bf16_f32 v58, v60, v61
  v_mfma_f32_16x16x32_bf16 a[120:123], a[184:187], v[80:83], a[120:123]
  v_exp_f32 v62, v62
  v_mfma_f32_16x16x32_bf16 a[120:123], a[188:191], v[112:115], a[120:123]
  v_mfma_f32_16x16x32_bf16 a[124:127], a[188:191], v[120:123], a[124:127]
  s_waitcnt lgkmcnt(0)
  v_exp_f32 v63, v63
  v_mfma_f32_16x16x32_bf16 a[124:127], a[184:187], v[88:91], a[124:127]
  v_cvt_pk_bf16_f32 v59, v62, v63
  v_mfma_f32_16x16x32_bf16 v[64:67], a[128:131], v[128:131], v[192:195]
  s_add_u32 m0, s28, 98304
  v_mfma_f32_16x16x32_bf16 v[64:67], a[132:135], v[132:135], v[64:67]
  ds_read_b128 a[144:147], v212 offset:20480
  v_mfma_f32_16x16x32_bf16 v[64:67], a[136:139], v[136:139], v[64:67]
  buffer_load_dwordx4 v236, s[16:19], s29 offen offset:0 lds
  v_mfma_f32_16x16x32_bf16 v[64:67], a[140:143], v[140:143], v[64:67]
  ds_read_b128 a[148:151], v213 offset:20480
  v_mfma_f32_16x16x32_bf16 v[72:75], a[140:143], v[156:159], v[196:199]
  buffer_load_dwordx4 v237, s[16:19], s29 offen offset:1024 lds
  v_mfma_f32_16x16x32_bf16 v[72:75], a[136:139], v[152:155], v[72:75]
  ds_read_b128 a[152:155], v214 offset:20480
  v_mfma_f32_16x16x32_bf16 v[72:75], a[132:135], v[148:151], v[72:75]
  buffer_load_dwordx4 v236, s[16:19], s29 offen offset:2048 lds
  v_mfma_f32_16x16x32_bf16 v[72:75], a[128:131], v[144:147], v[72:75]
  ds_read_b128 a[156:159], v215 offset:20480
  v_mfma_f32_16x16x32_bf16 v[80:83], a[128:131], v[160:163], v[200:203]
  v_exp_f32 v64, v64
  v_mfma_f32_16x16x32_bf16 v[80:83], a[132:135], v[164:167], v[80:83]
  buffer_load_dwordx4 v237, s[16:19], s29 offen offset:3072 lds
  v_mfma_f32_16x16x32_bf16 v[80:83], a[136:139], v[168:171], v[80:83]
  s_add_u32 s29, s29, 16384
  v_exp_f32 v65, v65
  v_mfma_f32_16x16x32_bf16 v[80:83], a[140:143], v[172:175], v[80:83]
  v_cvt_pk_bf16_f32 v64, v64, v65
  v_mfma_f32_16x16x32_bf16 v[88:91], a[140:143], v[188:191], v[204:207]
  s_add_u32 m0, s28, 49152
  v_exp_f32 v66, v66
  v_mfma_f32_16x16x32_bf16 v[88:91], a[136:139], v[184:187], v[88:91]
  buffer_load_dwordx4 v232, s[12:15], s29 offen offset:0 lds
  v_mfma_f32_16x16x32_bf16 v[88:91], a[132:135], v[180:183], v[88:91]
  s_waitcnt lgkmcnt(0)
  v_exp_f32 v67, v67
  v_mfma_f32_16x16x32_bf16 v[88:91], a[128:131], v[176:179], v[88:91]
  v_cvt_pk_bf16_f32 v65, v66, v67
  v_mfma_f32_16x16x32_bf16 v[68:71], a[144:147], v[128:131], v[192:195]
  v_exp_f32 v72, v72
  v_mfma_f32_16x16x32_bf16 v[68:71], a[148:151], v[132:135], v[68:71]
  ds_read_b128 a[128:131], v212 offset:24576
  v_mfma_f32_16x16x32_bf16 v[68:71], a[152:155], v[136:139], v[68:71]
  v_exp_f32 v73, v73
  v_mfma_f32_16x16x32_bf16 v[68:71], a[156:159], v[140:143], v[68:71]
  ds_read_b128 a[132:135], v213 offset:24576
  v_cvt_pk_bf16_f32 v72, v72, v73
  v_mfma_f32_16x16x32_bf16 v[76:79], a[156:159], v[156:159], v[196:199]
  v_exp_f32 v74, v74
  v_mfma_f32_16x16x32_bf16 v[76:79], a[152:155], v[152:155], v[76:79]
  ds_read_b128 a[136:139], v214 offset:24576
  v_mfma_f32_16x16x32_bf16 v[76:79], a[148:151], v[148:151], v[76:79]
  v_exp_f32 v75, v75
  v_mfma_f32_16x16x32_bf16 v[76:79], a[144:147], v[144:147], v[76:79]
  ds_read_b128 a[140:143], v215 offset:24576
  v_cvt_pk_bf16_f32 v73, v74, v75
  v_mfma_f32_16x16x32_bf16 v[84:87], a[144:147], v[160:163], v[200:203]
  v_exp_f32 v80, v80
  v_mfma_f32_16x16x32_bf16 v[84:87], a[148:151], v[164:167], v[84:87]
  buffer_load_dwordx4 v233, s[12:15], s29 offen offset:1024 lds
  v_mfma_f32_16x16x32_bf16 v[84:87], a[152:155], v[168:171], v[84:87]
  v_exp_f32 v81, v81
  v_mfma_f32_16x16x32_bf16 v[84:87], a[156:159], v[172:175], v[84:87]
  v_cvt_pk_bf16_f32 v80, v80, v81
  v_mfma_f32_16x16x32_bf16 v[92:95], a[156:159], v[188:191], v[204:207]
  v_exp_f32 v82, v82
  v_mfma_f32_16x16x32_bf16 v[92:95], a[152:155], v[184:187], v[92:95]
  buffer_load_dwordx4 v234, s[12:15], s29 offen offset:2048 lds
  v_mfma_f32_16x16x32_bf16 v[92:95], a[148:151], v[180:183], v[92:95]
  s_waitcnt lgkmcnt(0)
  v_exp_f32 v83, v83
  v_mfma_f32_16x16x32_bf16 v[92:95], a[144:147], v[176:179], v[92:95]
  v_cvt_pk_bf16_f32 v81, v82, v83
  v_mfma_f32_16x16x32_bf16 v[96:99], a[128:131], v[128:131], v[192:195]
  v_exp_f32 v88, v88
  v_mfma_f32_16x16x32_bf16 v[96:99], a[132:135], v[132:135], v[96:99]
  ds_read_b128 a[144:147], v212 offset:28672
  v_mfma_f32_16x16x32_bf16 v[96:99], a[136:139], v[136:139], v[96:99]
  v_exp_f32 v89, v89
  v_mfma_f32_16x16x32_bf16 v[96:99], a[140:143], v[140:143], v[96:99]
  ds_read_b128 a[148:151], v213 offset:28672
  v_cvt_pk_bf16_f32 v88, v88, v89
  v_mfma_f32_16x16x32_bf16 v[104:107], a[140:143], v[156:159], v[196:199]
  v_exp_f32 v90, v90
  v_mfma_f32_16x16x32_bf16 v[104:107], a[136:139], v[152:155], v[104:107]
  ds_read_b128 a[152:155], v214 offset:28672
  v_mfma_f32_16x16x32_bf16 v[104:107], a[132:135], v[148:151], v[104:107]
  v_exp_f32 v91, v91
  v_mfma_f32_16x16x32_bf16 v[104:107], a[128:131], v[144:147], v[104:107]
  ds_read_b128 a[156:159], v215 offset:28672
  v_cvt_pk_bf16_f32 v89, v90, v91
  v_mfma_f32_16x16x32_bf16 v[112:115], a[128:131], v[160:163], v[200:203]
  v_exp_f32 v68, v68
  v_mfma_f32_16x16x32_bf16 v[112:115], a[132:135], v[164:167], v[112:115]
  buffer_load_dwordx4 v235, s[12:15], s29 offen offset:3072 lds
  v_mfma_f32_16x16x32_bf16 v[112:115], a[136:139], v[168:171], v[112:115]
  v_exp_f32 v69, v69
  v_mfma_f32_16x16x32_bf16 v[112:115], a[140:143], v[172:175], v[112:115]
  v_cvt_pk_bf16_f32 v66, v68, v69
  v_mfma_f32_16x16x32_bf16 v[120:123], a[140:143], v[188:191], v[204:207]
  s_add_u32 m0, s50, 5120
  v_exp_f32 v70, v70
  v_mfma_f32_16x16x32_bf16 v[120:123], a[136:139], v[184:187], v[120:123]
  buffer_load_dwordx4 v208, s[20:23], s30 offen lds
  s_add_u32 s30, s30, 32
  v_mfma_f32_16x16x32_bf16 v[120:123], a[132:135], v[180:183], v[120:123]
  s_waitcnt lgkmcnt(0)
  v_exp_f32 v71, v71
  v_mfma_f32_16x16x32_bf16 v[120:123], a[128:131], v[176:179], v[120:123]
  v_cvt_pk_bf16_f32 v67, v70, v71
  v_mfma_f32_16x16x32_bf16 v[100:103], a[144:147], v[128:131], v[192:195]
  v_exp_f32 v76, v76
  v_mfma_f32_16x16x32_bf16 v[100:103], a[148:151], v[132:135], v[100:103]
  ds_read_b64_tr_b16 a[160:161], v216 offset:0
  v_mfma_f32_16x16x32_bf16 v[100:103], a[152:155], v[136:139], v[100:103]
  v_exp_f32 v77, v77
  v_mfma_f32_16x16x32_bf16 v[100:103], a[156:159], v[140:143], v[100:103]
  ds_read_b64_tr_b16 a[162:163], v216 offset:4096
  v_cvt_pk_bf16_f32 v74, v76, v77
  v_mfma_f32_16x16x32_bf16 v[108:111], a[156:159], v[156:159], v[196:199]
  v_exp_f32 v78, v78
  v_mfma_f32_16x16x32_bf16 v[108:111], a[152:155], v[152:155], v[108:111]
  ds_read_b64_tr_b16 a[164:165], v216 offset:8192
  v_mfma_f32_16x16x32_bf16 v[108:111], a[148:151], v[148:151], v[108:111]
  v_exp_f32 v79, v79
  v_mfma_f32_16x16x32_bf16 v[108:111], a[144:147], v[144:147], v[108:111]
  ds_read_b64_tr_b16 a[166:167], v216 offset:12288
  v_cvt_pk_bf16_f32 v75, v78, v79
  v_mfma_f32_16x16x32_bf16 v[116:119], a[144:147], v[160:163], v[200:203]
  v_exp_f32 v84, v84
  v_mfma_f32_16x16x32_bf16 v[116:119], a[148:151], v[164:167], v[116:119]
  ds_read_b64_tr_b16 a[168:169], v217 offset:0
  v_mfma_f32_16x16x32_bf16 v[116:119], a[152:155], v[168:171], v[116:119]
  v_exp_f32 v85, v85
  v_mfma_f32_16x16x32_bf16 v[116:119], a[156:159], v[172:175], v[116:119]
  ds_read_b64_tr_b16 a[170:171], v217 offset:4096
  v_cvt_pk_bf16_f32 v82, v84, v85
  v_mfma_f32_16x16x32_bf16 v[124:127], a[156:159], v[188:191], v[204:207]
  v_exp_f32 v86, v86
  v_mfma_f32_16x16x32_bf16 v[124:127], a[152:155], v[184:187], v[124:127]
  ds_read_b64_tr_b16 a[172:173], v217 offset:8192
  v_mfma_f32_16x16x32_bf16 v[124:127], a[148:151], v[180:183], v[124:127]
  v_exp_f32 v87, v87
  v_mfma_f32_16x16x32_bf16 v[124:127], a[144:147], v[176:179], v[124:127]
  ds_read_b64_tr_b16 a[174:175], v217 offset:12288
  v_cvt_pk_bf16_f32 v83, v86, v87
  v_mfma_f32_16x16x32_bf16 a[192:195], a[208:211], v[0:3], a[192:195]
  v_exp_f32 v92, v92
  v_mfma_f32_16x16x32_bf16 a[192:195], a[208:211], v[32:35], a[192:195]
  ds_read_b64_tr_b16 a[176:177], v218 offset:0
  v_mfma_f32_16x16x32_bf16 a[196:199], a[208:211], v[8:11], a[196:199]
  v_exp_f32 v93, v93
  v_mfma_f32_16x16x32_bf16 a[196:199], a[208:211], v[40:43], a[196:199]
  ds_read_b64_tr_b16 a[178:179], v218 offset:4096
  v_cvt_pk_bf16_f32 v90, v92, v93
  v_mfma_f32_16x16x32_bf16 a[200:203], a[208:211], v[16:19], a[200:203]
  v_exp_f32 v94, v94
  v_mfma_f32_16x16x32_bf16 a[200:203], a[208:211], v[48:51], a[200:203]
  ds_read_b64_tr_b16 a[180:181], v218 offset:8192
  v_mfma_f32_16x16x32_bf16 a[204:207], a[208:211], v[24:27], a[204:207]
  s_waitcnt lgkmcnt(7)
  v_exp_f32 v95, v95
  v_mfma_f32_16x16x32_bf16 a[204:207], a[208:211], v[56:59], a[204:207]
  ds_read_b64_tr_b16 a[182:183], v218 offset:12288
  v_cvt_pk_bf16_f32 v91, v94, v95
  v_mfma_f32_16x16x32_bf16 a[0:3], a[160:163], v[0:3], a[0:3]
  v_exp_f32 v96, v96
  v_mfma_f32_16x16x32_bf16 a[0:3], a[164:167], v[32:35], a[0:3]
  ds_read_b64_tr_b16 a[184:185], v219 offset:0
  v_mfma_f32_16x16x32_bf16 a[4:7], a[164:167], v[40:43], a[4:7]
  v_exp_f32 v97, v97
  v_mfma_f32_16x16x32_bf16 a[4:7], a[160:163], v[8:11], a[4:7]
  ds_read_b64_tr_b16 a[186:187], v219 offset:4096
  v_cvt_pk_bf16_f32 v96, v96, v97
  v_mfma_f32_16x16x32_bf16 a[8:11], a[160:163], v[16:19], a[8:11]
  v_exp_f32 v98, v98
  v_mfma_f32_16x16x32_bf16 a[8:11], a[164:167], v[48:51], a[8:11]
  ds_read_b64_tr_b16 a[188:189], v219 offset:8192
  v_mfma_f32_16x16x32_bf16 a[12:15], a[164:167], v[56:59], a[12:15]
  s_waitcnt lgkmcnt(7)
  v_exp_f32 v99, v99
  v_mfma_f32_16x16x32_bf16 a[12:15], a[160:163], v[24:27], a[12:15]
  ds_read_b64_tr_b16 a[190:191], v219 offset:12288
  v_cvt_pk_bf16_f32 v97, v98, v99
  v_mfma_f32_16x16x32_bf16 a[16:19], a[168:171], v[0:3], a[16:19]
  v_exp_f32 v104, v104
  v_mfma_f32_16x16x32_bf16 a[16:19], a[172:175], v[32:35], a[16:19]
  ds_read_b64_tr_b16 a[160:161], v220 offset:0
  v_mfma_f32_16x16x32_bf16 a[20:23], a[172:175], v[40:43], a[20:23]
  v_exp_f32 v105, v105
  v_mfma_f32_16x16x32_bf16 a[20:23], a[168:171], v[8:11], a[20:23]
  ds_read_b64_tr_b16 a[162:163], v220 offset:4096
  v_cvt_pk_bf16_f32 v104, v104, v105
  v_mfma_f32_16x16x32_bf16 a[24:27], a[168:171], v[16:19], a[24:27]
  v_exp_f32 v106, v106
  v_mfma_f32_16x16x32_bf16 a[24:27], a[172:175], v[48:51], a[24:27]
  ds_read_b64_tr_b16 a[164:165], v220 offset:8192
  v_mfma_f32_16x16x32_bf16 a[28:31], a[172:175], v[56:59], a[28:31]
  s_waitcnt lgkmcnt(7)
  v_exp_f32 v107, v107
  v_mfma_f32_16x16x32_bf16 a[28:31], a[168:171], v[24:27], a[28:31]
  ds_read_b64_tr_b16 a[166:167], v220 offset:12288
  v_cvt_pk_bf16_f32 v105, v106, v107
  v_mfma_f32_16x16x32_bf16 a[32:35], a[176:179], v[0:3], a[32:35]
  v_exp_f32 v112, v112
  v_mfma_f32_16x16x32_bf16 a[32:35], a[180:183], v[32:35], a[32:35]
  ds_read_b64_tr_b16 a[168:169], v221 offset:0
  v_mfma_f32_16x16x32_bf16 a[36:39], a[180:183], v[40:43], a[36:39]
  v_exp_f32 v113, v113
  v_mfma_f32_16x16x32_bf16 a[36:39], a[176:179], v[8:11], a[36:39]
  ds_read_b64_tr_b16 a[170:171], v221 offset:4096
  v_cvt_pk_bf16_f32 v112, v112, v113
  v_mfma_f32_16x16x32_bf16 a[40:43], a[176:179], v[16:19], a[40:43]
  v_exp_f32 v114, v114
  v_mfma_f32_16x16x32_bf16 a[40:43], a[180:183], v[48:51], a[40:43]
  ds_read_b64_tr_b16 a[172:173], v221 offset:8192
  v_mfma_f32_16x16x32_bf16 a[44:47], a[180:183], v[56:59], a[44:47]
  s_waitcnt lgkmcnt(7)
  v_exp_f32 v115, v115
  v_mfma_f32_16x16x32_bf16 a[44:47], a[176:179], v[24:27], a[44:47]
  ds_read_b64_tr_b16 a[174:175], v221 offset:12288
  v_cvt_pk_bf16_f32 v113, v114, v115
  v_mfma_f32_16x16x32_bf16 a[48:51], a[184:187], v[0:3], a[48:51]
  v_exp_f32 v120, v120
  v_mfma_f32_16x16x32_bf16 a[48:51], a[188:191], v[32:35], a[48:51]
  ds_read_b64_tr_b16 a[176:177], v222 offset:0
  v_mfma_f32_16x16x32_bf16 a[52:55], a[188:191], v[40:43], a[52:55]
  v_exp_f32 v121, v121
  v_mfma_f32_16x16x32_bf16 a[52:55], a[184:187], v[8:11], a[52:55]
  ds_read_b64_tr_b16 a[178:179], v222 offset:4096
  v_cvt_pk_bf16_f32 v120, v120, v121
  v_mfma_f32_16x16x32_bf16 a[56:59], a[184:187], v[16:19], a[56:59]
  v_exp_f32 v122, v122
  v_mfma_f32_16x16x32_bf16 a[56:59], a[188:191], v[48:51], a[56:59]
  ds_read_b64_tr_b16 a[180:181], v222 offset:8192
  v_mfma_f32_16x16x32_bf16 a[60:63], a[188:191], v[56:59], a[60:63]
  s_waitcnt lgkmcnt(7)
  v_exp_f32 v123, v123
  v_mfma_f32_16x16x32_bf16 a[60:63], a[184:187], v[24:27], a[60:63]
  ds_read_b64_tr_b16 a[182:183], v222 offset:12288
  v_cvt_pk_bf16_f32 v121, v122, v123
  v_mfma_f32_16x16x32_bf16 a[64:67], a[160:163], v[0:3], a[64:67]
  v_exp_f32 v100, v100
  v_mfma_f32_16x16x32_bf16 a[64:67], a[164:167], v[32:35], a[64:67]
  ds_read_b64_tr_b16 a[184:185], v223 offset:0
  v_mfma_f32_16x16x32_bf16 a[68:71], a[164:167], v[40:43], a[68:71]
  v_exp_f32 v101, v101
  v_mfma_f32_16x16x32_bf16 a[68:71], a[160:163], v[8:11], a[68:71]
  ds_read_b64_tr_b16 a[186:187], v223 offset:4096
  v_cvt_pk_bf16_f32 v98, v100, v101
  v_mfma_f32_16x16x32_bf16 a[72:75], a[160:163], v[16:19], a[72:75]
  v_exp_f32 v102, v102
  v_mfma_f32_16x16x32_bf16 a[72:75], a[164:167], v[48:51], a[72:75]
  ds_read_b64_tr_b16 a[188:189], v223 offset:8192
  v_mfma_f32_16x16x32_bf16 a[76:79], a[164:167], v[56:59], a[76:79]
  s_waitcnt lgkmcnt(7)
  v_exp_f32 v103, v103
  v_mfma_f32_16x16x32_bf16 a[76:79], a[160:163], v[24:27], a[76:79]
  ds_read_b64_tr_b16 a[190:191], v223 offset:12288
  v_cvt_pk_bf16_f32 v99, v102, v103
  v_mfma_f32_16x16x32_bf16 a[80:83], a[168:171], v[0:3], a[80:83]
  s_waitcnt vmcnt(10)
  v_exp_f32 v108, v108
  v_mfma_f32_16x16x32_bf16 a[80:83], a[172:175], v[32:35], a[80:83]
  v_mfma_f32_16x16x32_bf16 a[84:87], a[172:175], v[40:43], a[84:87]
  s_barrier
  v_exp_f32 v109, v109
  v_mfma_f32_16x16x32_bf16 a[84:87], a[168:171], v[8:11], a[84:87]
  ds_read_b128 a[128:131], v212 offset:32768
  v_cvt_pk_bf16_f32 v106, v108, v109
  v_mfma_f32_16x16x32_bf16 a[88:91], a[168:171], v[16:19], a[88:91]
  v_exp_f32 v110, v110
  v_mfma_f32_16x16x32_bf16 a[88:91], a[172:175], v[48:51], a[88:91]
  ds_read_b128 a[132:135], v213 offset:32768
  buffer_atomic_add v250, v249, s[24:27], s47 offen
  s_cmp_eq_u32 s32, 3
  s_cselect_b32 s39, 0, 1073741824
  v_mfma_f32_16x16x32_bf16 a[92:95], a[172:175], v[56:59], a[92:95]
  s_waitcnt lgkmcnt(6)
  v_exp_f32 v111, v111
  v_mfma_f32_16x16x32_bf16 a[92:95], a[168:171], v[24:27], a[92:95]
  ds_read_b128 a[136:139], v214 offset:32768
  v_cvt_pk_bf16_f32 v107, v110, v111
  v_mfma_f32_16x16x32_bf16 a[96:99], a[176:179], v[0:3], a[96:99]
  v_exp_f32 v116, v116
  v_mfma_f32_16x16x32_bf16 a[96:99], a[180:183], v[32:35], a[96:99]
  ds_read_b128 a[140:143], v215 offset:32768
  v_or_b32 v249, s39, v251
  v_mfma_f32_16x16x32_bf16 a[100:103], a[180:183], v[40:43], a[100:103]
  v_exp_f32 v117, v117
  v_mfma_f32_16x16x32_bf16 a[100:103], a[176:179], v[8:11], a[100:103]
  v_cvt_pk_bf16_f32 v114, v116, v117
  v_mfma_f32_16x16x32_bf16 a[104:107], a[176:179], v[16:19], a[104:107]
  v_exp_f32 v118, v118
  v_mfma_f32_16x16x32_bf16 a[104:107], a[180:183], v[48:51], a[104:107]
  v_mfma_f32_16x16x32_bf16 a[108:111], a[180:183], v[56:59], a[108:111]
  s_waitcnt lgkmcnt(4)
  v_exp_f32 v119, v119
  v_mfma_f32_16x16x32_bf16 a[108:111], a[176:179], v[24:27], a[108:111]
  v_cvt_pk_bf16_f32 v115, v118, v119
  v_mfma_f32_16x16x32_bf16 a[112:115], a[184:187], v[0:3], a[112:115]
  v_exp_f32 v124, v124
  v_mfma_f32_16x16x32_bf16 a[112:115], a[188:191], v[32:35], a[112:115]
  v_mfma_f32_16x16x32_bf16 a[116:119], a[188:191], v[40:43], a[116:119]
  v_exp_f32 v125, v125
  v_mfma_f32_16x16x32_bf16 a[116:119], a[184:187], v[8:11], a[116:119]
  v_cvt_pk_bf16_f32 v122, v124, v125
  v_mfma_f32_16x16x32_bf16 a[120:123], a[184:187], v[16:19], a[120:123]
  v_exp_f32 v126, v126
  v_mfma_f32_16x16x32_bf16 a[120:123], a[188:191], v[48:51], a[120:123]
  v_mfma_f32_16x16x32_bf16 a[124:127], a[188:191], v[56:59], a[124:127]
  s_waitcnt lgkmcnt(0)
  v_exp_f32 v127, v127
  v_mfma_f32_16x16x32_bf16 a[124:127], a[184:187], v[24:27], a[124:127]
  v_cvt_pk_bf16_f32 v123, v126, v127
  v_mfma_f32_16x16x32_bf16 v[0:3], a[128:131], v[128:131], v[192:195]
  s_add_u32 m0, s28, 114688
  v_mfma_f32_16x16x32_bf16 v[0:3], a[132:135], v[132:135], v[0:3]
  ds_read_b128 a[144:147], v212 offset:36864
  v_mfma_f32_16x16x32_bf16 v[0:3], a[136:139], v[136:139], v[0:3]
  buffer_load_dwordx4 v236, s[16:19], s29 offen offset:0 lds
  v_mfma_f32_16x16x32_bf16 v[0:3], a[140:143], v[140:143], v[0:3]
  ds_read_b128 a[148:151], v213 offset:36864
  v_mfma_f32_16x16x32_bf16 v[8:11], a[140:143], v[156:159], v[196:199]
  buffer_load_dwordx4 v237, s[16:19], s29 offen offset:1024 lds
  v_mfma_f32_16x16x32_bf16 v[8:11], a[136:139], v[152:155], v[8:11]
  ds_read_b128 a[152:155], v214 offset:36864
  v_mfma_f32_16x16x32_bf16 v[8:11], a[132:135], v[148:151], v[8:11]
  buffer_load_dwordx4 v236, s[16:19], s29 offen offset:2048 lds
  v_mfma_f32_16x16x32_bf16 v[8:11], a[128:131], v[144:147], v[8:11]
  ds_read_b128 a[156:159], v215 offset:36864
  v_mfma_f32_16x16x32_bf16 v[16:19], a[128:131], v[160:163], v[200:203]
  v_exp_f32 v0, v0
  v_mfma_f32_16x16x32_bf16 v[16:19], a[132:135], v[164:167], v[16:19]
  buffer_load_dwordx4 v237, s[16:19], s29 offen offset:3072 lds
  v_mfma_f32_16x16x32_bf16 v[16:19], a[136:139], v[168:171], v[16:19]
  s_add_u32 s29, s29, 16384
  v_exp_f32 v1, v1
  v_mfma_f32_16x16x32_bf16 v[16:19], a[140:143], v[172:175], v[16:19]
  v_cvt_pk_bf16_f32 v0, v0, v1
  v_mfma_f32_16x16x32_bf16 v[24:27], a[140:143], v[188:191], v[204:207]
  s_add_u32 m0, s28, 0
  v_exp_f32 v2, v2
  v_mfma_f32_16x16x32_bf16 v[24:27], a[136:139], v[184:187], v[24:27]
  buffer_load_dwordx4 v232, s[12:15], s29 offen offset:0 lds
  v_mfma_f32_16x16x32_bf16 v[24:27], a[132:135], v[180:183], v[24:27]
  s_waitcnt lgkmcnt(0)
  v_exp_f32 v3, v3
  v_mfma_f32_16x16x32_bf16 v[24:27], a[128:131], v[176:179], v[24:27]
  v_cvt_pk_bf16_f32 v1, v2, v3
  v_mfma_f32_16x16x32_bf16 v[4:7], a[144:147], v[128:131], v[192:195]
  v_exp_f32 v8, v8
  v_mfma_f32_16x16x32_bf16 v[4:7], a[148:151], v[132:135], v[4:7]
  ds_read_b128 a[128:131], v212 offset:40960
  v_mfma_f32_16x16x32_bf16 v[4:7], a[152:155], v[136:139], v[4:7]
  v_exp_f32 v9, v9
  v_mfma_f32_16x16x32_bf16 v[4:7], a[156:159], v[140:143], v[4:7]
  ds_read_b128 a[132:135], v213 offset:40960
  v_cvt_pk_bf16_f32 v8, v8, v9
  v_mfma_f32_16x16x32_bf16 v[12:15], a[156:159], v[156:159], v[196:199]
  v_exp_f32 v10, v10
  v_mfma_f32_16x16x32_bf16 v[12:15], a[152:155], v[152:155], v[12:15]
  ds_read_b128 a[136:139], v214 offset:40960
  v_mfma_f32_16x16x32_bf16 v[12:15], a[148:151], v[148:151], v[12:15]
  v_exp_f32 v11, v11
  v_mfma_f32_16x16x32_bf16 v[12:15], a[144:147], v[144:147], v[12:15]
  ds_read_b128 a[140:143], v215 offset:40960
  v_cvt_pk_bf16_f32 v9, v10, v11
  v_mfma_f32_16x16x32_bf16 v[20:23], a[144:147], v[160:163], v[200:203]
  v_exp_f32 v16, v16
  v_mfma_f32_16x16x32_bf16 v[20:23], a[148:151], v[164:167], v[20:23]
  buffer_load_dwordx4 v233, s[12:15], s29 offen offset:1024 lds
  v_mfma_f32_16x16x32_bf16 v[20:23], a[152:155], v[168:171], v[20:23]
  v_exp_f32 v17, v17
  v_mfma_f32_16x16x32_bf16 v[20:23], a[156:159], v[172:175], v[20:23]
  v_cvt_pk_bf16_f32 v16, v16, v17
  v_mfma_f32_16x16x32_bf16 v[28:31], a[156:159], v[188:191], v[204:207]
  v_exp_f32 v18, v18
  v_mfma_f32_16x16x32_bf16 v[28:31], a[152:155], v[184:187], v[28:31]
  buffer_load_dwordx4 v234, s[12:15], s29 offen offset:2048 lds
  v_mfma_f32_16x16x32_bf16 v[28:31], a[148:151], v[180:183], v[28:31]
  s_waitcnt lgkmcnt(0)
  v_exp_f32 v19, v19
  v_mfma_f32_16x16x32_bf16 v[28:31], a[144:147], v[176:179], v[28:31]
  v_cvt_pk_bf16_f32 v17, v18, v19
  v_mfma_f32_16x16x32_bf16 v[32:35], a[128:131], v[128:131], v[192:195]
  v_exp_f32 v24, v24
  v_mfma_f32_16x16x32_bf16 v[32:35], a[132:135], v[132:135], v[32:35]
  ds_read_b128 a[144:147], v212 offset:45056
  v_mfma_f32_16x16x32_bf16 v[32:35], a[136:139], v[136:139], v[32:35]
  v_exp_f32 v25, v25
  v_mfma_f32_16x16x32_bf16 v[32:35], a[140:143], v[140:143], v[32:35]
  ds_read_b128 a[148:151], v213 offset:45056
  v_cvt_pk_bf16_f32 v24, v24, v25
  v_mfma_f32_16x16x32_bf16 v[40:43], a[140:143], v[156:159], v[196:199]
  v_exp_f32 v26, v26
  v_mfma_f32_16x16x32_bf16 v[40:43], a[136:139], v[152:155], v[40:43]
  ds_read_b128 a[152:155], v214 offset:45056
  v_mfma_f32_16x16x32_bf16 v[40:43], a[132:135], v[148:151], v[40:43]
  v_exp_f32 v27, v27
  v_mfma_f32_16x16x32_bf16 v[40:43], a[128:131], v[144:147], v[40:43]
  ds_read_b128 a[156:159], v215 offset:45056
  v_cvt_pk_bf16_f32 v25, v26, v27
  v_mfma_f32_16x16x32_bf16 v[48:51], a[128:131], v[160:163], v[200:203]
  v_exp_f32 v4, v4
  v_mfma_f32_16x16x32_bf16 v[48:51], a[132:135], v[164:167], v[48:51]
  buffer_load_dwordx4 v235, s[12:15], s29 offen offset:3072 lds
  v_mfma_f32_16x16x32_bf16 v[48:51], a[136:139], v[168:171], v[48:51]
  v_exp_f32 v5, v5
  v_mfma_f32_16x16x32_bf16 v[48:51], a[140:143], v[172:175], v[48:51]
  v_cvt_pk_bf16_f32 v2, v4, v5
  v_mfma_f32_16x16x32_bf16 v[56:59], a[140:143], v[188:191], v[204:207]
  s_mov_b32 m0, s51
  v_exp_f32 v6, v6
  v_mfma_f32_16x16x32_bf16 v[56:59], a[136:139], v[184:187], v[56:59]
  buffer_load_dwordx4 v210, s[4:7], s100 offen lds
  s_add_u32 s100, s100, 20480
  s_add_u32 s51, s51, 512
  v_mfma_f32_16x16x32_bf16 v[56:59], a[132:135], v[180:183], v[56:59]
  s_waitcnt lgkmcnt(0)
  v_exp_f32 v7, v7
  v_mfma_f32_16x16x32_bf16 v[56:59], a[128:131], v[176:179], v[56:59]
  v_cvt_pk_bf16_f32 v3, v6, v7
  v_mfma_f32_16x16x32_bf16 v[36:39], a[144:147], v[128:131], v[192:195]
  v_exp_f32 v12, v12
  v_mfma_f32_16x16x32_bf16 v[36:39], a[148:151], v[132:135], v[36:39]
  ds_read_b64_tr_b16 a[160:161], v216 offset:16384
  v_mfma_f32_16x16x32_bf16 v[36:39], a[152:155], v[136:139], v[36:39]
  v_exp_f32 v13, v13
  v_mfma_f32_16x16x32_bf16 v[36:39], a[156:159], v[140:143], v[36:39]
  ds_read_b64_tr_b16 a[162:163], v216 offset:20480
  v_cvt_pk_bf16_f32 v10, v12, v13
  v_mfma_f32_16x16x32_bf16 v[44:47], a[156:159], v[156:159], v[196:199]
  v_exp_f32 v14, v14
  v_mfma_f32_16x16x32_bf16 v[44:47], a[152:155], v[152:155], v[44:47]
  ds_read_b64_tr_b16 a[164:165], v216 offset:24576
  v_mfma_f32_16x16x32_bf16 v[44:47], a[148:151], v[148:151], v[44:47]
  v_exp_f32 v15, v15
  v_mfma_f32_16x16x32_bf16 v[44:47], a[144:147], v[144:147], v[44:47]
  ds_read_b64_tr_b16 a[166:167], v216 offset:28672
  v_cvt_pk_bf16_f32 v11, v14, v15
  v_mfma_f32_16x16x32_bf16 v[52:55], a[144:147], v[160:163], v[200:203]
  v_exp_f32 v20, v20
  v_mfma_f32_16x16x32_bf16 v[52:55], a[148:151], v[164:167], v[52:55]
  ds_read_b64_tr_b16 a[168:169], v217 offset:16384
  v_mfma_f32_16x16x32_bf16 v[52:55], a[152:155], v[168:171], v[52:55]
  v_exp_f32 v21, v21
  v_mfma_f32_16x16x32_bf16 v[52:55], a[156:159], v[172:175], v[52:55]
  ds_read_b64_tr_b16 a[170:171], v217 offset:20480
  v_cvt_pk_bf16_f32 v18, v20, v21
  v_mfma_f32_16x16x32_bf16 v[60:63], a[156:159], v[188:191], v[204:207]
  v_exp_f32 v22, v22
  v_mfma_f32_16x16x32_bf16 v[60:63], a[152:155], v[184:187], v[60:63]
  ds_read_b64_tr_b16 a[172:173], v217 offset:24576
  v_mfma_f32_16x16x32_bf16 v[60:63], a[148:151], v[180:183], v[60:63]
  v_exp_f32 v23, v23
  v_mfma_f32_16x16x32_bf16 v[60:63], a[144:147], v[176:179], v[60:63]
  ds_read_b64_tr_b16 a[174:175], v217 offset:28672
  v_cvt_pk_bf16_f32 v19, v22, v23
  v_mfma_f32_16x16x32_bf16 a[192:195], a[208:211], v[64:67], a[192:195]
  v_exp_f32 v28, v28
  v_mfma_f32_16x16x32_bf16 a[192:195], a[208:211], v[96:99], a[192:195]
  ds_read_b64_tr_b16 a[176:177], v218 offset:16384
  v_mfma_f32_16x16x32_bf16 a[196:199], a[208:211], v[72:75], a[196:199]
  v_exp_f32 v29, v29
  v_mfma_f32_16x16x32_bf16 a[196:199], a[208:211], v[104:107], a[196:199]
  ds_read_b64_tr_b16 a[178:179], v218 offset:20480
  v_cvt_pk_bf16_f32 v26, v28, v29
  v_mfma_f32_16x16x32_bf16 a[200:203], a[208:211], v[80:83], a[200:203]
  v_exp_f32 v30, v30
  v_mfma_f32_16x16x32_bf16 a[200:203], a[208:211], v[112:115], a[200:203]
  ds_read_b64_tr_b16 a[180:181], v218 offset:24576
  v_mfma_f32_16x16x32_bf16 a[204:207], a[208:211], v[88:91], a[204:207]
  s_waitcnt lgkmcnt(7)
  v_exp_f32 v31, v31
  v_mfma_f32_16x16x32_bf16 a[204:207], a[208:211], v[120:123], a[204:207]
  ds_read_b64_tr_b16 a[182:183], v218 offset:28672
  v_cvt_pk_bf16_f32 v27, v30, v31
  v_mfma_f32_16x16x32_bf16 a[0:3], a[160:163], v[64:67], a[0:3]
  v_exp_f32 v32, v32
  v_mfma_f32_16x16x32_bf16 a[0:3], a[164:167], v[96:99], a[0:3]
  ds_read_b64_tr_b16 a[184:185], v219 offset:16384
  v_mfma_f32_16x16x32_bf16 a[4:7], a[164:167], v[104:107], a[4:7]
  v_exp_f32 v33, v33
  v_mfma_f32_16x16x32_bf16 a[4:7], a[160:163], v[72:75], a[4:7]
  ds_read_b64_tr_b16 a[186:187], v219 offset:20480
  v_cvt_pk_bf16_f32 v32, v32, v33
  v_mfma_f32_16x16x32_bf16 a[8:11], a[160:163], v[80:83], a[8:11]
  v_exp_f32 v34, v34
  v_mfma_f32_16x16x32_bf16 a[8:11], a[164:167], v[112:115], a[8:11]
  ds_read_b64_tr_b16 a[188:189], v219 offset:24576
  v_mfma_f32_16x16x32_bf16 a[12:15], a[164:167], v[120:123], a[12:15]
  s_waitcnt lgkmcnt(7)
  v_exp_f32 v35, v35
  v_mfma_f32_16x16x32_bf16 a[12:15], a[160:163], v[88:91], a[12:15]
  ds_read_b64_tr_b16 a[190:191], v219 offset:28672
  v_cvt_pk_bf16_f32 v33, v34, v35
  v_mfma_f32_16x16x32_bf16 a[16:19], a[168:171], v[64:67], a[16:19]
  v_exp_f32 v40, v40
  v_mfma_f32_16x16x32_bf16 a[16:19], a[172:175], v[96:99], a[16:19]
  ds_read_b64_tr_b16 a[160:161], v220 offset:16384
  v_mfma_f32_16x16x32_bf16 a[20:23], a[172:175], v[104:107], a[20:23]
  v_exp_f32 v41, v41
  v_mfma_f32_16x16x32_bf16 a[20:23], a[168:171], v[72:75], a[20:23]
  ds_read_b64_tr_b16 a[162:163], v220 offset:20480
  v_cvt_pk_bf16_f32 v40, v40, v41
  v_mfma_f32_16x16x32_bf16 a[24:27], a[168:171], v[80:83], a[24:27]
  v_exp_f32 v42, v42
  v_mfma_f32_16x16x32_bf16 a[24:27], a[172:175], v[112:115], a[24:27]
  ds_read_b64_tr_b16 a[164:165], v220 offset:24576
  v_mfma_f32_16x16x32_bf16 a[28:31], a[172:175], v[120:123], a[28:31]
  s_waitcnt lgkmcnt(7)
  v_exp_f32 v43, v43
  v_mfma_f32_16x16x32_bf16 a[28:31], a[168:171], v[88:91], a[28:31]
  ds_read_b64_tr_b16 a[166:167], v220 offset:28672
  v_cvt_pk_bf16_f32 v41, v42, v43
  v_mfma_f32_16x16x32_bf16 a[32:35], a[176:179], v[64:67], a[32:35]
  v_exp_f32 v48, v48
  v_mfma_f32_16x16x32_bf16 a[32:35], a[180:183], v[96:99], a[32:35]
  ds_read_b64_tr_b16 a[168:169], v221 offset:16384
  v_mfma_f32_16x16x32_bf16 a[36:39], a[180:183], v[104:107], a[36:39]
  v_exp_f32 v49, v49
  v_mfma_f32_16x16x32_bf16 a[36:39], a[176:179], v[72:75], a[36:39]
  ds_read_b64_tr_b16 a[170:171], v221 offset:20480
  v_cvt_pk_bf16_f32 v48, v48, v49
  v_mfma_f32_16x16x32_bf16 a[40:43], a[176:179], v[80:83], a[40:43]
  v_exp_f32 v50, v50
  v_mfma_f32_16x16x32_bf16 a[40:43], a[180:183], v[112:115], a[40:43]
  ds_read_b64_tr_b16 a[172:173], v221 offset:24576
  v_mfma_f32_16x16x32_bf16 a[44:47], a[180:183], v[120:123], a[44:47]
  s_waitcnt lgkmcnt(7)
  v_exp_f32 v51, v51
  v_mfma_f32_16x16x32_bf16 a[44:47], a[176:179], v[88:91], a[44:47]
  ds_read_b64_tr_b16 a[174:175], v221 offset:28672
  v_cvt_pk_bf16_f32 v49, v50, v51
  v_mfma_f32_16x16x32_bf16 a[48:51], a[184:187], v[64:67], a[48:51]
  v_exp_f32 v56, v56
  v_mfma_f32_16x16x32_bf16 a[48:51], a[188:191], v[96:99], a[48:51]
  ds_read_b64_tr_b16 a[176:177], v222 offset:16384
  v_mfma_f32_16x16x32_bf16 a[52:55], a[188:191], v[104:107], a[52:55]
  v_exp_f32 v57, v57
  v_mfma_f32_16x16x32_bf16 a[52:55], a[184:187], v[72:75], a[52:55]
  ds_read_b64_tr_b16 a[178:179], v222 offset:20480
  v_cvt_pk_bf16_f32 v56, v56, v57
  v_mfma_f32_16x16x32_bf16 a[56:59], a[184:187], v[80:83], a[56:59]
  v_exp_f32 v58, v58
  v_mfma_f32_16x16x32_bf16 a[56:59], a[188:191], v[112:115], a[56:59]
  ds_read_b64_tr_b16 a[180:181], v222 offset:24576
  v_mfma_f32_16x16x32_bf16 a[60:63], a[188:191], v[120:123], a[60:63]
  s_waitcnt lgkmcnt(7)
  v_exp_f32 v59, v59
  v_mfma_f32_16x16x32_bf16 a[60:63], a[184:187], v[88:91], a[60:63]
  ds_read_b64_tr_b16 a[182:183], v222 offset:28672
  v_cvt_pk_bf16_f32 v57, v58, v59
  v_mfma_f32_16x16x32_bf16 a[64:67], a[160:163], v[64:67], a[64:67]
  v_exp_f32 v36, v36
  v_mfma_f32_16x16x32_bf16 a[64:67], a[164:167], v[96:99], a[64:67]
  ds_read_b64_tr_b16 a[184:185], v223 offset:16384
  v_mfma_f32_16x16x32_bf16 a[68:71], a[164:167], v[104:107], a[68:71]
  v_exp_f32 v37, v37
  v_mfma_f32_16x16x32_bf16 a[68:71], a[160:163], v[72:75], a[68:71]
  ds_read_b64_tr_b16 a[186:187], v223 offset:20480
  v_cvt_pk_bf16_f32 v34, v36, v37
  v_mfma_f32_16x16x32_bf16 a[72:75], a[160:163], v[80:83], a[72:75]
  v_exp_f32 v38, v38
  v_mfma_f32_16x16x32_bf16 a[72:75], a[164:167], v[112:115], a[72:75]
  ds_read_b64_tr_b16 a[188:189], v223 offset:24576
  v_mfma_f32_16x16x32_bf16 a[76:79], a[164:167], v[120:123], a[76:79]
  s_waitcnt lgkmcnt(7)
  v_exp_f32 v39, v39
  v_mfma_f32_16x16x32_bf16 a[76:79], a[160:163], v[88:91], a[76:79]
  ds_read_b64_tr_b16 a[190:191], v223 offset:28672
  v_cvt_pk_bf16_f32 v35, v38, v39
  v_mfma_f32_16x16x32_bf16 a[80:83], a[168:171], v[64:67], a[80:83]
  s_waitcnt vmcnt(11)
  v_exp_f32 v44, v44
  v_mfma_f32_16x16x32_bf16 a[80:83], a[172:175], v[96:99], a[80:83]
  v_mfma_f32_16x16x32_bf16 a[84:87], a[172:175], v[104:107], a[84:87]
  s_barrier
  v_exp_f32 v45, v45
  v_mfma_f32_16x16x32_bf16 a[84:87], a[168:171], v[72:75], a[84:87]
  ds_read_b128 a[128:131], v212 offset:49152
  v_cvt_pk_bf16_f32 v42, v44, v45
  v_mfma_f32_16x16x32_bf16 a[88:91], a[168:171], v[80:83], a[88:91]
  v_exp_f32 v46, v46
  v_mfma_f32_16x16x32_bf16 a[88:91], a[172:175], v[112:115], a[88:91]
  ds_read_b128 a[132:135], v213 offset:49152
  ds_read_b64_tr_b16 a[232:233], v209 offset:4096
  v_mfma_f32_16x16x32_bf16 a[92:95], a[172:175], v[120:123], a[92:95]
  s_waitcnt lgkmcnt(7)
  v_exp_f32 v47, v47
  v_mfma_f32_16x16x32_bf16 a[92:95], a[168:171], v[88:91], a[92:95]
  ds_read_b128 a[136:139], v214 offset:49152
  v_cvt_pk_bf16_f32 v43, v46, v47
  v_mfma_f32_16x16x32_bf16 a[96:99], a[176:179], v[64:67], a[96:99]
  v_exp_f32 v52, v52
  v_mfma_f32_16x16x32_bf16 a[96:99], a[180:183], v[96:99], a[96:99]
  ds_read_b128 a[140:143], v215 offset:49152
  ds_read_b64_tr_b16 a[234:235], v209 offset:4608
  v_mfma_f32_16x16x32_bf16 a[100:103], a[180:183], v[104:107], a[100:103]
  v_exp_f32 v53, v53
  v_mfma_f32_16x16x32_bf16 a[100:103], a[176:179], v[72:75], a[100:103]
  v_cvt_pk_bf16_f32 v50, v52, v53
  v_mfma_f32_16x16x32_bf16 a[104:107], a[176:179], v[80:83], a[104:107]
  v_exp_f32 v54, v54
  v_mfma_f32_16x16x32_bf16 a[104:107], a[180:183], v[112:115], a[104:107]
  v_mfma_f32_16x16x32_bf16 a[108:111], a[180:183], v[120:123], a[108:111]
  s_waitcnt lgkmcnt(6)
  v_exp_f32 v55, v55
  v_mfma_f32_16x16x32_bf16 a[108:111], a[176:179], v[88:91], a[108:111]
  v_cvt_pk_bf16_f32 v51, v54, v55
  v_mfma_f32_16x16x32_bf16 a[112:115], a[184:187], v[64:67], a[112:115]
  v_exp_f32 v60, v60
  v_mfma_f32_16x16x32_bf16 a[112:115], a[188:191], v[96:99], a[112:115]
  s_waitcnt lgkmcnt(0)
  buffer_store_dwordx4 a[232:235], v211, s[24:27], s31 offen sc1
  s_add_u32 s31, s31, 1024
  s_cmp_gt_u32 s32, 3
  v_mfma_f32_16x16x32_bf16 a[116:119], a[188:191], v[104:107], a[116:119]
  s_cselect_b32 s39, 0, 1073741824
  v_exp_f32 v61, v61
  v_mfma_f32_16x16x32_bf16 a[116:119], a[184:187], v[72:75], a[116:119]
  v_cvt_pk_bf16_f32 v58, v60, v61
  v_or_b32 v211, s39, v211
  v_mfma_f32_16x16x32_bf16 a[120:123], a[184:187], v[80:83], a[120:123]
  v_exp_f32 v62, v62
  v_mfma_f32_16x16x32_bf16 a[120:123], a[188:191], v[112:115], a[120:123]
  v_or_b32 v208, s39, v208
  v_mfma_f32_16x16x32_bf16 a[124:127], a[188:191], v[120:123], a[124:127]
  v_exp_f32 v63, v63
  v_mfma_f32_16x16x32_bf16 a[124:127], a[184:187], v[88:91], a[124:127]
  v_cvt_pk_bf16_f32 v59, v62, v63
  v_mfma_f32_16x16x32_bf16 v[64:67], a[128:131], v[128:131], v[192:195]
  s_add_u32 m0, s28, 65536
  v_mfma_f32_16x16x32_bf16 v[64:67], a[132:135], v[132:135], v[64:67]
  ds_read_b128 a[144:147], v212 offset:53248
  v_mfma_f32_16x16x32_bf16 v[64:67], a[136:139], v[136:139], v[64:67]
  buffer_load_dwordx4 v236, s[16:19], s29 offen offset:0 lds
  v_mfma_f32_16x16x32_bf16 v[64:67], a[140:143], v[140:143], v[64:67]
  ds_read_b128 a[148:151], v213 offset:53248
  v_mfma_f32_16x16x32_bf16 v[72:75], a[140:143], v[156:159], v[196:199]
  buffer_load_dwordx4 v237, s[16:19], s29 offen offset:1024 lds
  v_mfma_f32_16x16x32_bf16 v[72:75], a[136:139], v[152:155], v[72:75]
  ds_read_b128 a[152:155], v214 offset:53248
  v_mfma_f32_16x16x32_bf16 v[72:75], a[132:135], v[148:151], v[72:75]
  buffer_load_dwordx4 v236, s[16:19], s29 offen offset:2048 lds
  v_mfma_f32_16x16x32_bf16 v[72:75], a[128:131], v[144:147], v[72:75]
  ds_read_b128 a[156:159], v215 offset:53248
  v_mfma_f32_16x16x32_bf16 v[80:83], a[128:131], v[160:163], v[200:203]
  v_exp_f32 v64, v64
  v_mfma_f32_16x16x32_bf16 v[80:83], a[132:135], v[164:167], v[80:83]
  buffer_load_dwordx4 v237, s[16:19], s29 offen offset:3072 lds
  v_mfma_f32_16x16x32_bf16 v[80:83], a[136:139], v[168:171], v[80:83]
  s_add_u32 s29, s29, 16384
  v_exp_f32 v65, v65
  v_mfma_f32_16x16x32_bf16 v[80:83], a[140:143], v[172:175], v[80:83]
  v_cvt_pk_bf16_f32 v64, v64, v65
  v_mfma_f32_16x16x32_bf16 v[88:91], a[140:143], v[188:191], v[204:207]
  s_add_u32 m0, s28, 16384
  v_exp_f32 v66, v66
  v_mfma_f32_16x16x32_bf16 v[88:91], a[136:139], v[184:187], v[88:91]
  buffer_load_dwordx4 v232, s[12:15], s29 offen offset:0 lds
  v_mfma_f32_16x16x32_bf16 v[88:91], a[132:135], v[180:183], v[88:91]
  s_waitcnt lgkmcnt(0)
  v_exp_f32 v67, v67
  v_mfma_f32_16x16x32_bf16 v[88:91], a[128:131], v[176:179], v[88:91]
  v_cvt_pk_bf16_f32 v65, v66, v67
  v_mfma_f32_16x16x32_bf16 v[68:71], a[144:147], v[128:131], v[192:195]
  v_exp_f32 v72, v72
  v_mfma_f32_16x16x32_bf16 v[68:71], a[148:151], v[132:135], v[68:71]
  ds_read_b128 a[128:131], v212 offset:57344
  v_mfma_f32_16x16x32_bf16 v[68:71], a[152:155], v[136:139], v[68:71]
  v_exp_f32 v73, v73
  v_mfma_f32_16x16x32_bf16 v[68:71], a[156:159], v[140:143], v[68:71]
  ds_read_b128 a[132:135], v213 offset:57344
  v_cvt_pk_bf16_f32 v72, v72, v73
  v_mfma_f32_16x16x32_bf16 v[76:79], a[156:159], v[156:159], v[196:199]
  v_exp_f32 v74, v74
  v_mfma_f32_16x16x32_bf16 v[76:79], a[152:155], v[152:155], v[76:79]
  ds_read_b128 a[136:139], v214 offset:57344
  v_mfma_f32_16x16x32_bf16 v[76:79], a[148:151], v[148:151], v[76:79]
  v_exp_f32 v75, v75
  v_mfma_f32_16x16x32_bf16 v[76:79], a[144:147], v[144:147], v[76:79]
  ds_read_b128 a[140:143], v215 offset:57344
  v_cvt_pk_bf16_f32 v73, v74, v75
  v_mfma_f32_16x16x32_bf16 v[84:87], a[144:147], v[160:163], v[200:203]
  v_exp_f32 v80, v80
  v_mfma_f32_16x16x32_bf16 v[84:87], a[148:151], v[164:167], v[84:87]
  buffer_load_dwordx4 v233, s[12:15], s29 offen offset:1024 lds
  v_mfma_f32_16x16x32_bf16 v[84:87], a[152:155], v[168:171], v[84:87]
  v_exp_f32 v81, v81
  v_mfma_f32_16x16x32_bf16 v[84:87], a[156:159], v[172:175], v[84:87]
  v_cvt_pk_bf16_f32 v80, v80, v81
  v_mfma_f32_16x16x32_bf16 v[92:95], a[156:159], v[188:191], v[204:207]
  v_exp_f32 v82, v82
  v_mfma_f32_16x16x32_bf16 v[92:95], a[152:155], v[184:187], v[92:95]
  buffer_load_dwordx4 v234, s[12:15], s29 offen offset:2048 lds
  v_mfma_f32_16x16x32_bf16 v[92:95], a[148:151], v[180:183], v[92:95]
  s_waitcnt lgkmcnt(0)
  v_exp_f32 v83, v83
  v_mfma_f32_16x16x32_bf16 v[92:95], a[144:147], v[176:179], v[92:95]
  v_cvt_pk_bf16_f32 v81, v82, v83
  v_mfma_f32_16x16x32_bf16 v[96:99], a[128:131], v[128:131], v[192:195]
  v_exp_f32 v88, v88
  v_mfma_f32_16x16x32_bf16 v[96:99], a[132:135], v[132:135], v[96:99]
  ds_read_b128 a[144:147], v212 offset:61440
  v_mfma_f32_16x16x32_bf16 v[96:99], a[136:139], v[136:139], v[96:99]
  v_exp_f32 v89, v89
  v_mfma_f32_16x16x32_bf16 v[96:99], a[140:143], v[140:143], v[96:99]
  ds_read_b128 a[148:151], v213 offset:61440
  v_cvt_pk_bf16_f32 v88, v88, v89
  v_mfma_f32_16x16x32_bf16 v[104:107], a[140:143], v[156:159], v[196:199]
  v_exp_f32 v90, v90
  v_mfma_f32_16x16x32_bf16 v[104:107], a[136:139], v[152:155], v[104:107]
  ds_read_b128 a[152:155], v214 offset:61440
  v_mfma_f32_16x16x32_bf16 v[104:107], a[132:135], v[148:151], v[104:107]
  v_exp_f32 v91, v91
  v_mfma_f32_16x16x32_bf16 v[104:107], a[128:131], v[144:147], v[104:107]
  ds_read_b128 a[156:159], v215 offset:61440
  v_cvt_pk_bf16_f32 v89, v90, v91
  v_mfma_f32_16x16x32_bf16 v[112:115], a[128:131], v[160:163], v[200:203]
  v_exp_f32 v68, v68
  v_mfma_f32_16x16x32_bf16 v[112:115], a[132:135], v[164:167], v[112:115]
  buffer_load_dwordx4 v235, s[12:15], s29 offen offset:3072 lds
  v_mfma_f32_16x16x32_bf16 v[112:115], a[136:139], v[168:171], v[112:115]
  v_exp_f32 v69, v69
  v_mfma_f32_16x16x32_bf16 v[112:115], a[140:143], v[172:175], v[112:115]
  v_cvt_pk_bf16_f32 v66, v68, v69
  v_mfma_f32_16x16x32_bf16 v[120:123], a[140:143], v[188:191], v[204:207]
  v_exp_f32 v70, v70
  v_mfma_f32_16x16x32_bf16 v[120:123], a[136:139], v[184:187], v[120:123]
  buffer_load_dword v254, off, s[24:27], s47 sc1
  v_mfma_f32_16x16x32_bf16 v[120:123], a[132:135], v[180:183], v[120:123]
  s_waitcnt lgkmcnt(0)
  v_exp_f32 v71, v71
  v_mfma_f32_16x16x32_bf16 v[120:123], a[128:131], v[176:179], v[120:123]
  v_cvt_pk_bf16_f32 v67, v70, v71
  v_mfma_f32_16x16x32_bf16 v[100:103], a[144:147], v[128:131], v[192:195]
  v_exp_f32 v76, v76
  v_mfma_f32_16x16x32_bf16 v[100:103], a[148:151], v[132:135], v[100:103]
  ds_read_b64_tr_b16 a[160:161], v216 offset:32768
  v_mfma_f32_16x16x32_bf16 v[100:103], a[152:155], v[136:139], v[100:103]
  v_exp_f32 v77, v77
  v_mfma_f32_16x16x32_bf16 v[100:103], a[156:159], v[140:143], v[100:103]
  ds_read_b64_tr_b16 a[162:163], v216 offset:36864
  v_cvt_pk_bf16_f32 v74, v76, v77
  v_mfma_f32_16x16x32_bf16 v[108:111], a[156:159], v[156:159], v[196:199]
  v_exp_f32 v78, v78
  v_mfma_f32_16x16x32_bf16 v[108:111], a[152:155], v[152:155], v[108:111]
  ds_read_b64_tr_b16 a[164:165], v216 offset:40960
  v_mfma_f32_16x16x32_bf16 v[108:111], a[148:151], v[148:151], v[108:111]
  v_exp_f32 v79, v79
  v_mfma_f32_16x16x32_bf16 v[108:111], a[144:147], v[144:147], v[108:111]
  ds_read_b64_tr_b16 a[166:167], v216 offset:45056
  v_cvt_pk_bf16_f32 v75, v78, v79
  v_mfma_f32_16x16x32_bf16 v[116:119], a[144:147], v[160:163], v[200:203]
  v_exp_f32 v84, v84
  v_mfma_f32_16x16x32_bf16 v[116:119], a[148:151], v[164:167], v[116:119]
  ds_read_b64_tr_b16 a[168:169], v217 offset:32768
  v_mfma_f32_16x16x32_bf16 v[116:119], a[152:155], v[168:171], v[116:119]
  v_exp_f32 v85, v85
  v_mfma_f32_16x16x32_bf16 v[116:119], a[156:159], v[172:175], v[116:119]
  ds_read_b64_tr_b16 a[170:171], v217 offset:36864
  v_cvt_pk_bf16_f32 v82, v84, v85
  v_mfma_f32_16x16x32_bf16 v[124:127], a[156:159], v[188:191], v[204:207]
  s_waitcnt vmcnt(20)
  v_exp_f32 v86, v86
  v_mfma_f32_16x16x32_bf16 v[124:127], a[152:155], v[184:187], v[124:127]
  ds_read_b64_tr_b16 a[172:173], v217 offset:40960
  ds_read_b64_tr_b16 a[232:233], v209 offset:5120
  v_mfma_f32_16x16x32_bf16 v[124:127], a[148:151], v[180:183], v[124:127]
  v_exp_f32 v87, v87
  v_mfma_f32_16x16x32_bf16 v[124:127], a[144:147], v[176:179], v[124:127]
  ds_read_b64_tr_b16 a[174:175], v217 offset:45056
  v_cvt_pk_bf16_f32 v83, v86, v87
  v_mfma_f32_16x16x32_bf16 a[192:195], a[208:211], v[0:3], a[192:195]
  v_exp_f32 v92, v92
  v_mfma_f32_16x16x32_bf16 a[192:195], a[208:211], v[32:35], a[192:195]
  ds_read_b64_tr_b16 a[176:177], v218 offset:32768
  ds_read_b64_tr_b16 a[234:235], v209 offset:5632
  v_mfma_f32_16x16x32_bf16 a[196:199], a[208:211], v[8:11], a[196:199]
  v_exp_f32 v93, v93
  v_mfma_f32_16x16x32_bf16 a[196:199], a[208:211], v[40:43], a[196:199]
  ds_read_b64_tr_b16 a[178:179], v218 offset:36864
  v_cvt_pk_bf16_f32 v90, v92, v93
  v_mfma_f32_16x16x32_bf16 a[200:203], a[208:211], v[16:19], a[200:203]
  v_exp_f32 v94, v94
  v_mfma_f32_16x16x32_bf16 a[200:203], a[208:211], v[48:51], a[200:203]
  ds_read_b64_tr_b16 a[180:181], v218 offset:40960
  v_mfma_f32_16x16x32_bf16 a[204:207], a[208:211], v[24:27], a[204:207]
  s_waitcnt lgkmcnt(9)
  v_exp_f32 v95, v95
  v_mfma_f32_16x16x32_bf16 a[204:207], a[208:211], v[56:59], a[204:207]
  ds_read_b64_tr_b16 a[182:183], v218 offset:45056
  v_cvt_pk_bf16_f32 v91, v94, v95
  v_mfma_f32_16x16x32_bf16 a[0:3], a[160:163], v[0:3], a[0:3]
  v_exp_f32 v96, v96
  v_mfma_f32_16x16x32_bf16 a[0:3], a[164:167], v[32:35], a[0:3]
  ds_read_b64_tr_b16 a[184:185], v219 offset:32768
  s_waitcnt lgkmcnt(4)
  buffer_store_dwordx4 a[232:235], v211, s[24:27], s31 offen sc1
  s_add_u32 s31, s31, 1024
  v_mfma_f32_16x16x32_bf16 a[4:7], a[164:167], v[40:43], a[4:7]
  v_exp_f32 v97, v97
  v_mfma_f32_16x16x32_bf16 a[4:7], a[160:163], v[8:11], a[4:7]
  ds_read_b64_tr_b16 a[186:187], v219 offset:36864
  v_cvt_pk_bf16_f32 v96, v96, v97
  v_mfma_f32_16x16x32_bf16 a[8:11], a[160:163], v[16:19], a[8:11]
  v_exp_f32 v98, v98
  v_mfma_f32_16x16x32_bf16 a[8:11], a[164:167], v[48:51], a[8:11]
  ds_read_b64_tr_b16 a[188:189], v219 offset:40960
  v_mfma_f32_16x16x32_bf16 a[12:15], a[164:167], v[56:59], a[12:15]
  v_exp_f32 v99, v99
  v_mfma_f32_16x16x32_bf16 a[12:15], a[160:163], v[24:27], a[12:15]
  ds_read_b64_tr_b16 a[190:191], v219 offset:45056
  v_cvt_pk_bf16_f32 v97, v98, v99
  v_mfma_f32_16x16x32_bf16 a[16:19], a[168:171], v[0:3], a[16:19]
  v_exp_f32 v104, v104
  v_mfma_f32_16x16x32_bf16 a[16:19], a[172:175], v[32:35], a[16:19]
  ds_read_b64_tr_b16 a[160:161], v220 offset:32768
  v_mfma_f32_16x16x32_bf16 a[20:23], a[172:175], v[40:43], a[20:23]
  v_exp_f32 v105, v105
  v_mfma_f32_16x16x32_bf16 a[20:23], a[168:171], v[8:11], a[20:23]
  ds_read_b64_tr_b16 a[162:163], v220 offset:36864
  v_cvt_pk_bf16_f32 v104, v104, v105
  v_mfma_f32_16x16x32_bf16 a[24:27], a[168:171], v[16:19], a[24:27]
  v_exp_f32 v106, v106
  v_mfma_f32_16x16x32_bf16 a[24:27], a[172:175], v[48:51], a[24:27]
  ds_read_b64_tr_b16 a[164:165], v220 offset:40960
  v_mfma_f32_16x16x32_bf16 a[28:31], a[172:175], v[56:59], a[28:31]
  s_waitcnt lgkmcnt(7)
  v_exp_f32 v107, v107
  v_mfma_f32_16x16x32_bf16 a[28:31], a[168:171], v[24:27], a[28:31]
  ds_read_b64_tr_b16 a[166:167], v220 offset:45056
  v_cvt_pk_bf16_f32 v105, v106, v107
  v_mfma_f32_16x16x32_bf16 a[32:35], a[176:179], v[0:3], a[32:35]
  v_exp_f32 v112, v112
  v_mfma_f32_16x16x32_bf16 a[32:35], a[180:183], v[32:35], a[32:35]
  ds_read_b64_tr_b16 a[168:169], v221 offset:32768
  v_mfma_f32_16x16x32_bf16 a[36:39], a[180:183], v[40:43], a[36:39]
  v_exp_f32 v113, v113
  v_mfma_f32_16x16x32_bf16 a[36:39], a[176:179], v[8:11], a[36:39]
  ds_read_b64_tr_b16 a[170:171], v221 offset:36864
  v_cvt_pk_bf16_f32 v112, v112, v113
  v_mfma_f32_16x16x32_bf16 a[40:43], a[176:179], v[16:19], a[40:43]
  v_exp_f32 v114, v114
  v_mfma_f32_16x16x32_bf16 a[40:43], a[180:183], v[48:51], a[40:43]
  ds_read_b64_tr_b16 a[172:173], v221 offset:40960
  v_mfma_f32_16x16x32_bf16 a[44:47], a[180:183], v[56:59], a[44:47]
  s_waitcnt lgkmcnt(7)
  v_exp_f32 v115, v115
  v_mfma_f32_16x16x32_bf16 a[44:47], a[176:179], v[24:27], a[44:47]
  ds_read_b64_tr_b16 a[174:175], v221 offset:45056
  v_cvt_pk_bf16_f32 v113, v114, v115
  v_mfma_f32_16x16x32_bf16 a[48:51], a[184:187], v[0:3], a[48:51]
  v_exp_f32 v120, v120
  v_mfma_f32_16x16x32_bf16 a[48:51], a[188:191], v[32:35], a[48:51]
  ds_read_b64_tr_b16 a[176:177], v222 offset:32768
  v_mfma_f32_16x16x32_bf16 a[52:55], a[188:191], v[40:43], a[52:55]
  v_exp_f32 v121, v121
  v_mfma_f32_16x16x32_bf16 a[52:55], a[184:187], v[8:11], a[52:55]
  ds_read_b64_tr_b16 a[178:179], v222 offset:36864
  v_cvt_pk_bf16_f32 v120, v120, v121
  v_mfma_f32_16x16x32_bf16 a[56:59], a[184:187], v[16:19], a[56:59]
  v_exp_f32 v122, v122
  v_mfma_f32_16x16x32_bf16 a[56:59], a[188:191], v[48:51], a[56:59]
  ds_read_b64_tr_b16 a[180:181], v222 offset:40960
  v_mfma_f32_16x16x32_bf16 a[60:63], a[188:191], v[56:59], a[60:63]
  s_waitcnt lgkmcnt(7)
  v_exp_f32 v123, v123
  v_mfma_f32_16x16x32_bf16 a[60:63], a[184:187], v[24:27], a[60:63]
  ds_read_b64_tr_b16 a[182:183], v222 offset:45056
  v_cvt_pk_bf16_f32 v121, v122, v123
  v_mfma_f32_16x16x32_bf16 a[64:67], a[160:163], v[0:3], a[64:67]
  v_exp_f32 v100, v100
  v_mfma_f32_16x16x32_bf16 a[64:67], a[164:167], v[32:35], a[64:67]
  ds_read_b64_tr_b16 a[184:185], v223 offset:32768
  v_mfma_f32_16x16x32_bf16 a[68:71], a[164:167], v[40:43], a[68:71]
  v_exp_f32 v101, v101
  v_mfma_f32_16x16x32_bf16 a[68:71], a[160:163], v[8:11], a[68:71]
  ds_read_b64_tr_b16 a[186:187], v223 offset:36864
  v_cvt_pk_bf16_f32 v98, v100, v101
  v_mfma_f32_16x16x32_bf16 a[72:75], a[160:163], v[16:19], a[72:75]
  v_exp_f32 v102, v102
  v_mfma_f32_16x16x32_bf16 a[72:75], a[164:167], v[48:51], a[72:75]
  ds_read_b64_tr_b16 a[188:189], v223 offset:40960
  v_mfma_f32_16x16x32_bf16 a[76:79], a[164:167], v[56:59], a[76:79]
  s_waitcnt lgkmcnt(7)
  v_exp_f32 v103, v103
  v_mfma_f32_16x16x32_bf16 a[76:79], a[160:163], v[24:27], a[76:79]
  ds_read_b64_tr_b16 a[190:191], v223 offset:45056
  v_cvt_pk_bf16_f32 v99, v102, v103
  v_mfma_f32_16x16x32_bf16 a[80:83], a[168:171], v[0:3], a[80:83]
  s_waitcnt vmcnt(12)
  v_exp_f32 v108, v108
  v_mfma_f32_16x16x32_bf16 a[80:83], a[172:175], v[32:35], a[80:83]
  v_mfma_f32_16x16x32_bf16 a[84:87], a[172:175], v[40:43], a[84:87]
  s_barrier
  v_exp_f32 v109, v109
  v_mfma_f32_16x16x32_bf16 a[84:87], a[168:171], v[8:11], a[84:87]
  ds_read_b128 a[128:131], v212 offset:0
  v_cvt_pk_bf16_f32 v106, v108, v109
  v_mfma_f32_16x16x32_bf16 a[88:91], a[168:171], v[16:19], a[88:91]
  v_exp_f32 v110, v110
  v_mfma_f32_16x16x32_bf16 a[88:91], a[172:175], v[48:51], a[88:91]
  ds_read_b128 a[132:135], v213 offset:0
  v_mfma_f32_16x16x32_bf16 a[92:95], a[172:175], v[56:59], a[92:95]
  s_waitcnt lgkmcnt(6)
  v_exp_f32 v111, v111
  v_mfma_f32_16x16x32_bf16 a[92:95], a[168:171], v[24:27], a[92:95]
  ds_read_b128 a[136:139], v214 offset:0
  v_cvt_pk_bf16_f32 v107, v110, v111
  v_mfma_f32_16x16x32_bf16 a[96:99], a[176:179], v[0:3], a[96:99]
  v_exp_f32 v116, v116
  v_mfma_f32_16x16x32_bf16 a[96:99], a[180:183], v[32:35], a[96:99]
  ds_read_b128 a[140:143], v215 offset:0
  v_mfma_f32_16x16x32_bf16 a[100:103], a[180:183], v[40:43], a[100:103]
  v_exp_f32 v117, v117
  v_mfma_f32_16x16x32_bf16 a[100:103], a[176:179], v[8:11], a[100:103]
  v_cvt_pk_bf16_f32 v114, v116, v117
  v_mfma_f32_16x16x32_bf16 a[104:107], a[176:179], v[16:19], a[104:107]
  v_exp_f32 v118, v118
  v_mfma_f32_16x16x32_bf16 a[104:107], a[180:183], v[48:51], a[104:107]
  v_mfma_f32_16x16x32_bf16 a[108:111], a[180:183], v[56:59], a[108:111]
  s_waitcnt lgkmcnt(4)
  v_exp_f32 v119, v119
  v_mfma_f32_16x16x32_bf16 a[108:111], a[176:179], v[24:27], a[108:111]
  v_cvt_pk_bf16_f32 v115, v118, v119
  v_mfma_f32_16x16x32_bf16 a[112:115], a[184:187], v[0:3], a[112:115]
  v_exp_f32 v124, v124
  v_mfma_f32_16x16x32_bf16 a[112:115], a[188:191], v[32:35], a[112:115]
  v_mfma_f32_16x16x32_bf16 a[116:119], a[188:191], v[40:43], a[116:119]
  s_sub_u32 s32, s32, 1
  v_exp_f32 v125, v125
  v_mfma_f32_16x16x32_bf16 a[116:119], a[184:187], v[8:11], a[116:119]
  v_cvt_pk_bf16_f32 v122, v124, v125
  v_mfma_f32_16x16x32_bf16 a[120:123], a[184:187], v[16:19], a[120:123]
  s_cmp_lg_u32 s32, 0
  v_exp_f32 v126, v126
  v_mfma_f32_16x16x32_bf16 a[120:123], a[188:191], v[48:51], a[120:123]
  v_mfma_f32_16x16x32_bf16 a[124:127], a[188:191], v[56:59], a[124:127]
  s_waitcnt lgkmcnt(0)
  v_exp_f32 v127, v127
  v_mfma_f32_16x16x32_bf16 a[124:127], a[184:187], v[24:27], a[124:127]
  v_cvt_pk_bf16_f32 v123, v126, v127
  s_cbranch_scc1 attn_loop
  s_waitcnt vmcnt(1)
  v_readfirstlane_b32 s38, v254
  s_nop 0
  s_cmp_ge_u32 s38, 512
  s_cbranch_scc1 attn_h_ready
  s_mov_b32 s39, 32768
attn_spin:
  s_sleep 4
  buffer_load_dword v254, off, s[24:27], s47 sc1
  s_waitcnt vmcnt(0)
  v_readfirstlane_b32 s38, v254
  s_nop 0
  s_cmp_ge_u32 s38, 512
  s_cbranch_scc1 attn_h_ready
  s_sub_u32 s39, s39, 1
  s_cmp_lg_u32 s39, 0
  s_cbranch_scc1 attn_spin
attn_h_ready:
  v_mfma_f32_16x16x32_bf16 v[0:3], a[128:131], v[128:131], v[192:195]
  s_add_u32 m0, s28, 81920
  s_and_b32 s38, s2, 1
  s_lshl_b32 s38, s38, 2
  v_lshrrev_b32 v224, 4, v242
  v_and_b32 v225, 7, v224
  v_mfma_f32_16x16x32_bf16 v[0:3], a[132:135], v[132:135], v[0:3]
  ds_read_b128 a[144:147], v212 offset:4096
  s_add_u32 s38, s38, s3
  s_mul_i32 s38, s38, 81920
  s_lshr_b32 s39, s2, 5
  v_mul_u32_u24 v225, 0xd80, v225
  v_mfma_f32_16x16x32_bf16 v[0:3], a[136:139], v[136:139], v[0:3]
  buffer_load_dwordx4 v236, s[16:19], s29 offen offset:0 lds
  s_mul_i32 s39, s39, 655360
  s_add_u32 s38, s38, s39
  s_add_u32 s4, s38, 3145728
  v_mfma_f32_16x16x32_bf16 v[0:3], a[140:143], v[140:143], v[0:3]
  ds_read_b128 a[148:151], v213 offset:4096
  s_add_u32 s5, s4, 12288
  s_add_u32 s6, s4, 24576
  s_add_u32 s7, s4, 36864
  v_lshrrev_b32 v224, 4, v224
  v_mfma_f32_16x16x32_bf16 v[8:11], a[140:143], v[156:159], v[196:199]
  buffer_load_dwordx4 v237, s[16:19], s29 offen offset:1024 lds
  s_add_u32 s8, s4, 49152
  s_add_u32 s9, s4, 61440
  s_add_u32 s10, s4, 73728
  v_mfma_f32_16x16x32_bf16 v[8:11], a[136:139], v[152:155], v[8:11]
  ds_read_b128 a[152:155], v214 offset:4096
  v_lshl_add_u32 v225, v224, 4, v225
  v_mfma_f32_16x16x32_bf16 v[8:11], a[132:135], v[148:151], v[8:11]
  buffer_load_dwordx4 v236, s[16:19], s29 offen offset:2048 lds
  v_mfma_f32_16x16x32_bf16 v[8:11], a[128:131], v[144:147], v[8:11]
  ds_read_b128 a[156:159], v215 offset:4096
  buffer_load_dwordx4 a[212:215], v225, s[24:27], s101 offen offset:0 sc1
  v_mfma_f32_16x16x32_bf16 v[16:19], a[128:131], v[160:163], v[200:203]
  v_exp_f32 v0, v0
  v_mfma_f32_16x16x32_bf16 v[16:19], a[132:135], v[164:167], v[16:19]
  buffer_load_dwordx4 v237, s[16:19], s29 offen offset:3072 lds
  v_mfma_f32_16x16x32_bf16 v[16:19], a[136:139], v[168:171], v[16:19]
  s_add_u32 s29, s29, 16384
  v_exp_f32 v1, v1
  v_mfma_f32_16x16x32_bf16 v[16:19], a[140:143], v[172:175], v[16:19]
  buffer_load_dwordx4 a[216:219], v225, s[24:27], s101 offen offset:64 sc1
  v_cvt_pk_bf16_f32 v0, v0, v1
  v_mfma_f32_16x16x32_bf16 v[24:27], a[140:143], v[188:191], v[204:207]
  s_add_u32 m0, s28, 32768
  v_exp_f32 v2, v2
  v_mfma_f32_16x16x32_bf16 v[24:27], a[136:139], v[184:187], v[24:27]
  buffer_load_dwordx4 v232, s[12:15], s29 offen offset:0 lds
  v_mfma_f32_16x16x32_bf16 v[24:27], a[132:135], v[180:183], v[24:27]
  s_waitcnt lgkmcnt(0)
  v_exp_f32 v3, v3
  v_mfma_f32_16x16x32_bf16 v[24:27], a[128:131], v[176:179], v[24:27]
  buffer_load_dwordx4 a[220:223], v225, s[24:27], s101 offen offset:128 sc1
  v_cvt_pk_bf16_f32 v1, v2, v3
  v_mfma_f32_16x16x32_bf16 v[4:7], a[144:147], v[128:131], v[192:195]
  v_exp_f32 v8, v8
  v_mfma_f32_16x16x32_bf16 v[4:7], a[148:151], v[132:135], v[4:7]
  ds_read_b128 a[128:131], v212 offset:8192
  v_add_u32 v252, 4096, v242
  v_mfma_f32_16x16x32_bf16 v[4:7], a[152:155], v[136:139], v[4:7]
  v_exp_f32 v9, v9
  v_mfma_f32_16x16x32_bf16 v[4:7], a[156:159], v[140:143], v[4:7]
  ds_read_b128 a[132:135], v213 offset:8192
  v_cvt_pk_bf16_f32 v8, v8, v9
  v_mfma_f32_16x16x32_bf16 v[12:15], a[156:159], v[156:159], v[196:199]
  v_exp_f32 v10, v10
  v_mfma_f32_16x16x32_bf16 v[12:15], a[152:155], v[152:155], v[12:15]
  ds_read_b128 a[136:139], v214 offset:8192
  v_add_u32 v253, 8192, v242
  v_mfma_f32_16x16x32_bf16 v[12:15], a[148:151], v[148:151], v[12:15]
  v_exp_f32 v11, v11
  v_mfma_f32_16x16x32_bf16 v[12:15], a[144:147], v[144:147], v[12:15]
  ds_read_b128 a[140:143], v215 offset:8192
  v_cvt_pk_bf16_f32 v9, v10, v11
  v_mfma_f32_16x16x32_bf16 v[20:23], a[144:147], v[160:163], v[200:203]
  v_exp_f32 v16, v16
  v_mfma_f32_16x16x32_bf16 v[20:23], a[148:151], v[164:167], v[20:23]
  buffer_load_dwordx4 v233, s[12:15], s29 offen offset:1024 lds
  v_mfma_f32_16x16x32_bf16 v[20:23], a[152:155], v[168:171], v[20:23]
  v_exp_f32 v17, v17
  v_mfma_f32_16x16x32_bf16 v[20:23], a[156:159], v[172:175], v[20:23]
  v_cvt_pk_bf16_f32 v16, v16, v17
  v_mfma_f32_16x16x32_bf16 v[28:31], a[156:159], v[188:191], v[204:207]
  v_exp_f32 v18, v18
  v_mfma_f32_16x16x32_bf16 v[28:31], a[152:155], v[184:187], v[28:31]
  buffer_load_dwordx4 v234, s[12:15], s29 offen offset:2048 lds
  v_mfma_f32_16x16x32_bf16 v[28:31], a[148:151], v[180:183], v[28:31]
  s_waitcnt lgkmcnt(0)
  v_exp_f32 v19, v19
  v_mfma_f32_16x16x32_bf16 v[28:31], a[144:147], v[176:179], v[28:31]
  v_cvt_pk_bf16_f32 v17, v18, v19
  v_mfma_f32_16x16x32_bf16 v[32:35], a[128:131], v[128:131], v[192:195]
  v_exp_f32 v24, v24
  v_mfma_f32_16x16x32_bf16 v[32:35], a[132:135], v[132:135], v[32:35]
  ds_read_b128 a[144:147], v212 offset:12288
  v_mfma_f32_16x16x32_bf16 v[32:35], a[136:139], v[136:139], v[32:35]
  v_exp_f32 v25, v25
  v_mfma_f32_16x16x32_bf16 v[32:35], a[140:143], v[140:143], v[32:35]
  ds_read_b128 a[148:151], v213 offset:12288
  v_cvt_pk_bf16_f32 v24, v24, v25
  v_mfma_f32_16x16x32_bf16 v[40:43], a[140:143], v[156:159], v[196:199]
  v_exp_f32 v26, v26
  v_mfma_f32_16x16x32_bf16 v[40:43], a[136:139], v[152:155], v[40:43]
  ds_read_b128 a[152:155], v214 offset:12288
  v_mfma_f32_16x16x32_bf16 v[40:43], a[132:135], v[148:151], v[40:43]
  v_exp_f32 v27, v27
  v_mfma_f32_16x16x32_bf16 v[40:43], a[128:131], v[144:147], v[40:43]
  ds_read_b128 a[156:159], v215 offset:12288
  v_cvt_pk_bf16_f32 v25, v26, v27
  v_mfma_f32_16x16x32_bf16 v[48:51], a[128:131], v[160:163], v[200:203]
  v_exp_f32 v4, v4
  v_mfma_f32_16x16x32_bf16 v[48:51], a[132:135], v[164:167], v[48:51]
  buffer_load_dwordx4 v235, s[12:15], s29 offen offset:3072 lds
  v_mfma_f32_16x16x32_bf16 v[48:51], a[136:139], v[168:171], v[48:51]
  v_exp_f32 v5, v5
  v_mfma_f32_16x16x32_bf16 v[48:51], a[140:143], v[172:175], v[48:51]
  v_cvt_pk_bf16_f32 v2, v4, v5
  v_mfma_f32_16x16x32_bf16 v[56:59], a[140:143], v[188:191], v[204:207]
  v_exp_f32 v6, v6
  v_mfma_f32_16x16x32_bf16 v[56:59], a[136:139], v[184:187], v[56:59]
  v_mfma_f32_16x16x32_bf16 v[56:59], a[132:135], v[180:183], v[56:59]
  s_waitcnt lgkmcnt(0)
  v_exp_f32 v7, v7
  v_mfma_f32_16x16x32_bf16 v[56:59], a[128:131], v[176:179], v[56:59]
  v_cvt_pk_bf16_f32 v3, v6, v7
  v_mfma_f32_16x16x32_bf16 v[36:39], a[144:147], v[128:131], v[192:195]
  v_exp_f32 v12, v12
  v_mfma_f32_16x16x32_bf16 v[36:39], a[148:151], v[132:135], v[36:39]
  ds_read_b64_tr_b16 a[160:161], v216 offset:49152
  v_mfma_f32_16x16x32_bf16 v[36:39], a[152:155], v[136:139], v[36:39]
  v_exp_f32 v13, v13
  v_mfma_f32_16x16x32_bf16 v[36:39], a[156:159], v[140:143], v[36:39]
  ds_read_b64_tr_b16 a[162:163], v216 offset:53248
  v_cvt_pk_bf16_f32 v10, v12, v13
  v_mfma_f32_16x16x32_bf16 v[44:47], a[156:159], v[156:159], v[196:199]
  v_exp_f32 v14, v14
  v_mfma_f32_16x16x32_bf16 v[44:47], a[152:155], v[152:155], v[44:47]
  ds_read_b64_tr_b16 a[164:165], v216 offset:57344
  v_mfma_f32_16x16x32_bf16 v[44:47], a[148:151], v[148:151], v[44:47]
  v_exp_f32 v15, v15
  v_mfma_f32_16x16x32_bf16 v[44:47], a[144:147], v[144:147], v[44:47]
  ds_read_b64_tr_b16 a[166:167], v216 offset:61440
  v_cvt_pk_bf16_f32 v11, v14, v15
  v_mfma_f32_16x16x32_bf16 v[52:55], a[144:147], v[160:163], v[200:203]
  v_exp_f32 v20, v20
  v_mfma_f32_16x16x32_bf16 v[52:55], a[148:151], v[164:167], v[52:55]
  ds_read_b64_tr_b16 a[168:169], v217 offset:49152
  v_mfma_f32_16x16x32_bf16 v[52:55], a[152:155], v[168:171], v[52:55]
  v_exp_f32 v21, v21
  v_mfma_f32_16x16x32_bf16 v[52:55], a[156:159], v[172:175], v[52:55]
  ds_read_b64_tr_b16 a[170:171], v217 offset:53248
  v_cvt_pk_bf16_f32 v18, v20, v21
  v_mfma_f32_16x16x32_bf16 v[60:63], a[156:159], v[188:191], v[204:207]
  v_exp_f32 v22, v22
  v_mfma_f32_16x16x32_bf16 v[60:63], a[152:155], v[184:187], v[60:63]
  ds_read_b64_tr_b16 a[172:173], v217 offset:57344
  v_mfma_f32_16x16x32_bf16 v[60:63], a[148:151], v[180:183], v[60:63]
  v_exp_f32 v23, v23
  v_mfma_f32_16x16x32_bf16 v[60:63], a[144:147], v[176:179], v[60:63]
  ds_read_b64_tr_b16 a[174:175], v217 offset:61440
  v_cvt_pk_bf16_f32 v19, v22, v23
  v_mfma_f32_16x16x32_bf16 a[192:195], a[208:211], v[64:67], a[192:195]
  v_exp_f32 v28, v28
  v_mfma_f32_16x16x32_bf16 a[192:195], a[208:211], v[96:99], a[192:195]
  ds_read_b64_tr_b16 a[176:177], v218 offset:49152
  v_mfma_f32_16x16x32_bf16 a[196:199], a[208:211], v[72:75], a[196:199]
  v_exp_f32 v29, v29
  v_mfma_f32_16x16x32_bf16 a[196:199], a[208:211], v[104:107], a[196:199]
  ds_read_b64_tr_b16 a[178:179], v218 offset:53248
  v_cvt_pk_bf16_f32 v26, v28, v29
  v_mfma_f32_16x16x32_bf16 a[200:203], a[208:211], v[80:83], a[200:203]
  v_exp_f32 v30, v30
  v_mfma_f32_16x16x32_bf16 a[200:203], a[208:211], v[112:115], a[200:203]
  ds_read_b64_tr_b16 a[180:181], v218 offset:57344
  v_mfma_f32_16x16x32_bf16 a[204:207], a[208:211], v[88:91], a[204:207]
  s_waitcnt lgkmcnt(7)
  v_exp_f32 v31, v31
  v_mfma_f32_16x16x32_bf16 a[204:207], a[208:211], v[120:123], a[204:207]
  ds_read_b64_tr_b16 a[182:183], v218 offset:61440
  v_cvt_pk_bf16_f32 v27, v30, v31
  v_mfma_f32_16x16x32_bf16 a[0:3], a[160:163], v[64:67], a[0:3]
  v_exp_f32 v32, v32
  v_mfma_f32_16x16x32_bf16 a[0:3], a[164:167], v[96:99], a[0:3]
  ds_read_b64_tr_b16 a[184:185], v219 offset:49152
  v_mfma_f32_16x16x32_bf16 a[4:7], a[164:167], v[104:107], a[4:7]
  v_exp_f32 v33, v33
  v_mfma_f32_16x16x32_bf16 a[4:7], a[160:163], v[72:75], a[4:7]
  ds_read_b64_tr_b16 a[186:187], v219 offset:53248
  v_cvt_pk_bf16_f32 v32, v32, v33
  v_mfma_f32_16x16x32_bf16 a[8:11], a[160:163], v[80:83], a[8:11]
  v_exp_f32 v34, v34
  v_mfma_f32_16x16x32_bf16 a[8:11], a[164:167], v[112:115], a[8:11]
  ds_read_b64_tr_b16 a[188:189], v219 offset:57344
  v_mfma_f32_16x16x32_bf16 a[12:15], a[164:167], v[120:123], a[12:15]
  s_waitcnt lgkmcnt(7)
  v_exp_f32 v35, v35
  v_mfma_f32_16x16x32_bf16 a[12:15], a[160:163], v[88:91], a[12:15]
  ds_read_b64_tr_b16 a[190:191], v219 offset:61440
  v_cvt_pk_bf16_f32 v33, v34, v35
  v_mfma_f32_16x16x32_bf16 a[16:19], a[168:171], v[64:67], a[16:19]
  v_exp_f32 v40, v40
  v_mfma_f32_16x16x32_bf16 a[16:19], a[172:175], v[96:99], a[16:19]
  ds_read_b64_tr_b16 a[160:161], v220 offset:49152
  v_mfma_f32_16x16x32_bf16 a[20:23], a[172:175], v[104:107], a[20:23]
  v_exp_f32 v41, v41
  v_mfma_f32_16x16x32_bf16 a[20:23], a[168:171], v[72:75], a[20:23]
  ds_read_b64_tr_b16 a[162:163], v220 offset:53248
  v_cvt_pk_bf16_f32 v40, v40, v41
  v_mfma_f32_16x16x32_bf16 a[24:27], a[168:171], v[80:83], a[24:27]
  v_exp_f32 v42, v42
  v_mfma_f32_16x16x32_bf16 a[24:27], a[172:175], v[112:115], a[24:27]
  ds_read_b64_tr_b16 a[164:165], v220 offset:57344
  v_mfma_f32_16x16x32_bf16 a[28:31], a[172:175], v[120:123], a[28:31]
  s_waitcnt lgkmcnt(7)
  v_exp_f32 v43, v43
  v_mfma_f32_16x16x32_bf16 a[28:31], a[168:171], v[88:91], a[28:31]
  ds_read_b64_tr_b16 a[166:167], v220 offset:61440
  v_cvt_pk_bf16_f32 v41, v42, v43
  v_mfma_f32_16x16x32_bf16 a[32:35], a[176:179], v[64:67], a[32:35]
  v_exp_f32 v48, v48
  v_mfma_f32_16x16x32_bf16 a[32:35], a[180:183], v[96:99], a[32:35]
  ds_read_b64_tr_b16 a[168:169], v221 offset:49152
  v_mfma_f32_16x16x32_bf16 a[36:39], a[180:183], v[104:107], a[36:39]
  v_exp_f32 v49, v49
  v_mfma_f32_16x16x32_bf16 a[36:39], a[176:179], v[72:75], a[36:39]
  ds_read_b64_tr_b16 a[170:171], v221 offset:53248
  v_cvt_pk_bf16_f32 v48, v48, v49
  v_mfma_f32_16x16x32_bf16 a[40:43], a[176:179], v[80:83], a[40:43]
  v_exp_f32 v50, v50
  v_mfma_f32_16x16x32_bf16 a[40:43], a[180:183], v[112:115], a[40:43]
  ds_read_b64_tr_b16 a[172:173], v221 offset:57344
  v_mfma_f32_16x16x32_bf16 a[44:47], a[180:183], v[120:123], a[44:47]
  s_waitcnt lgkmcnt(7)
  v_exp_f32 v51, v51
  v_mfma_f32_16x16x32_bf16 a[44:47], a[176:179], v[88:91], a[44:47]
  ds_read_b64_tr_b16 a[174:175], v221 offset:61440
  v_cvt_pk_bf16_f32 v49, v50, v51
  v_mfma_f32_16x16x32_bf16 a[48:51], a[184:187], v[64:67], a[48:51]
  v_exp_f32 v56, v56
  v_mfma_f32_16x16x32_bf16 a[48:51], a[188:191], v[96:99], a[48:51]
  ds_read_b64_tr_b16 a[176:177], v222 offset:49152
  v_mfma_f32_16x16x32_bf16 a[52:55], a[188:191], v[104:107], a[52:55]
  v_exp_f32 v57, v57
  v_mfma_f32_16x16x32_bf16 a[52:55], a[184:187], v[72:75], a[52:55]
  ds_read_b64_tr_b16 a[178:179], v222 offset:53248
  v_cvt_pk_bf16_f32 v56, v56, v57
  v_mfma_f32_16x16x32_bf16 a[56:59], a[184:187], v[80:83], a[56:59]
  v_exp_f32 v58, v58
  v_mfma_f32_16x16x32_bf16 a[56:59], a[188:191], v[112:115], a[56:59]
  ds_read_b64_tr_b16 a[180:181], v222 offset:57344
  v_mfma_f32_16x16x32_bf16 a[60:63], a[188:191], v[120:123], a[60:63]
  s_waitcnt lgkmcnt(7)
  v_exp_f32 v59, v59
  v_mfma_f32_16x16x32_bf16 a[60:63], a[184:187], v[88:91], a[60:63]
  ds_read_b64_tr_b16 a[182:183], v222 offset:61440
  v_cvt_pk_bf16_f32 v57, v58, v59
  v_mfma_f32_16x16x32_bf16 a[64:67], a[160:163], v[64:67], a[64:67]
  v_exp_f32 v36, v36
  v_mfma_f32_16x16x32_bf16 a[64:67], a[164:167], v[96:99], a[64:67]
  ds_read_b64_tr_b16 a[184:185], v223 offset:49152
  v_mfma_f32_16x16x32_bf16 a[68:71], a[164:167], v[104:107], a[68:71]
  v_exp_f32 v37, v37
  v_mfma_f32_16x16x32_bf16 a[68:71], a[160:163], v[72:75], a[68:71]
  ds_read_b64_tr_b16 a[186:187], v223 offset:53248
  v_cvt_pk_bf16_f32 v34, v36, v37
  v_mfma_f32_16x16x32_bf16 a[72:75], a[160:163], v[80:83], a[72:75]
  v_exp_f32 v38, v38
  v_mfma_f32_16x16x32_bf16 a[72:75], a[164:167], v[112:115], a[72:75]
  ds_read_b64_tr_b16 a[188:189], v223 offset:57344
  v_mfma_f32_16x16x32_bf16 a[76:79], a[164:167], v[120:123], a[76:79]
  s_waitcnt lgkmcnt(7)
  v_exp_f32 v39, v39
  v_mfma_f32_16x16x32_bf16 a[76:79], a[160:163], v[88:91], a[76:79]
  ds_read_b64_tr_b16 a[190:191], v223 offset:61440
  v_cvt_pk_bf16_f32 v35, v38, v39
  v_mfma_f32_16x16x32_bf16 a[80:83], a[168:171], v[64:67], a[80:83]
  v_exp_f32 v44, v44
  v_mfma_f32_16x16x32_bf16 a[80:83], a[172:175], v[96:99], a[80:83]
  v_mfma_f32_16x16x32_bf16 a[84:87], a[172:175], v[104:107], a[84:87]
  s_barrier
  v_exp_f32 v45, v45
  v_mfma_f32_16x16x32_bf16 a[84:87], a[168:171], v[72:75], a[84:87]
  ds_read_b128 a[128:131], v212 offset:16384
  v_cvt_pk_bf16_f32 v42, v44, v45
  v_mfma_f32_16x16x32_bf16 a[88:91], a[168:171], v[80:83], a[88:91]
  v_exp_f32 v46, v46
  v_mfma_f32_16x16x32_bf16 a[88:91], a[172:175], v[112:115], a[88:91]
  ds_read_b128 a[132:135], v213 offset:16384
  v_mfma_f32_16x16x32_bf16 a[92:95], a[172:175], v[120:123], a[92:95]
  s_waitcnt lgkmcnt(6)
  v_exp_f32 v47, v47
  v_mfma_f32_16x16x32_bf16 a[92:95], a[168:171], v[88:91], a[92:95]
  ds_read_b128 a[136:139], v214 offset:16384
  v_cvt_pk_bf16_f32 v43, v46, v47
  v_mfma_f32_16x16x32_bf16 a[96:99], a[176:179], v[64:67], a[96:99]
  v_exp_f32 v52, v52
  v_mfma_f32_16x16x32_bf16 a[96:99], a[180:183], v[96:99], a[96:99]
  ds_read_b128 a[140:143], v215 offset:16384
  v_mfma_f32_16x16x32_bf16 a[100:103], a[180:183], v[104:107], a[100:103]
  v_exp_f32 v53, v53
  v_mfma_f32_16x16x32_bf16 a[100:103], a[176:179], v[72:75], a[100:103]
  v_cvt_pk_bf16_f32 v50, v52, v53
  v_mfma_f32_16x16x32_bf16 a[104:107], a[176:179], v[80:83], a[104:107]
  v_exp_f32 v54, v54
  v_mfma_f32_16x16x32_bf16 a[104:107], a[180:183], v[112:115], a[104:107]
  v_mfma_f32_16x16x32_bf16 a[108:111], a[180:183], v[120:123], a[108:111]
  s_waitcnt lgkmcnt(4)
  v_exp_f32 v55, v55
  v_mfma_f32_16x16x32_bf16 a[108:111], a[176:179], v[88:91], a[108:111]
  v_cvt_pk_bf16_f32 v51, v54, v55
  v_mfma_f32_16x16x32_bf16 a[112:115], a[184:187], v[64:67], a[112:115]
  v_exp_f32 v60, v60
  v_mfma_f32_16x16x32_bf16 a[112:115], a[188:191], v[96:99], a[112:115]
  v_mfma_f32_16x16x32_bf16 a[116:119], a[188:191], v[104:107], a[116:119]
  v_exp_f32 v61, v61
  v_mfma_f32_16x16x32_bf16 a[116:119], a[184:187], v[72:75], a[116:119]
  v_cvt_pk_bf16_f32 v58, v60, v61
  v_mfma_f32_16x16x32_bf16 a[120:123], a[184:187], v[80:83], a[120:123]
  v_exp_f32 v62, v62
  v_mfma_f32_16x16x32_bf16 a[120:123], a[188:191], v[112:115], a[120:123]
  v_mfma_f32_16x16x32_bf16 a[124:127], a[188:191], v[120:123], a[124:127]
  s_waitcnt lgkmcnt(0)
  v_exp_f32 v63, v63
  v_mfma_f32_16x16x32_bf16 a[124:127], a[184:187], v[88:91], a[124:127]
  v_cvt_pk_bf16_f32 v59, v62, v63
  v_mfma_f32_16x16x32_bf16 v[64:67], a[128:131], v[128:131], v[192:195]
  s_add_u32 m0, s28, 98304
  v_mfma_f32_16x16x32_bf16 v[64:67], a[132:135], v[132:135], v[64:67]
  ds_read_b128 a[144:147], v212 offset:20480
  v_mfma_f32_16x16x32_bf16 v[64:67], a[136:139], v[136:139], v[64:67]
  buffer_load_dwordx4 v236, s[16:19], s29 offen offset:0 lds
  v_mfma_f32_16x16x32_bf16 v[64:67], a[140:143], v[140:143], v[64:67]
  ds_read_b128 a[148:151], v213 offset:20480
  v_mfma_f32_16x16x32_bf16 v[72:75], a[140:143], v[156:159], v[196:199]
  buffer_load_dwordx4 v237, s[16:19], s29 offen offset:1024 lds
  v_mfma_f32_16x16x32_bf16 v[72:75], a[136:139], v[152:155], v[72:75]
  ds_read_b128 a[152:155], v214 offset:20480
  v_mfma_f32_16x16x32_bf16 v[72:75], a[132:135], v[148:151], v[72:75]
  buffer_load_dwordx4 v236, s[16:19], s29 offen offset:2048 lds
  v_mfma_f32_16x16x32_bf16 v[72:75], a[128:131], v[144:147], v[72:75]
  ds_read_b128 a[156:159], v215 offset:20480
  v_mfma_f32_16x16x32_bf16 v[80:83], a[128:131], v[160:163], v[200:203]
  v_exp_f32 v64, v64
  v_mfma_f32_16x16x32_bf16 v[80:83], a[132:135], v[164:167], v[80:83]
  buffer_load_dwordx4 v237, s[16:19], s29 offen offset:3072 lds
  v_mfma_f32_16x16x32_bf16 v[80:83], a[136:139], v[168:171], v[80:83]
  s_add_u32 s29, s29, 16384
  v_exp_f32 v65, v65
  v_mfma_f32_16x16x32_bf16 v[80:83], a[140:143], v[172:175], v[80:83]
  v_cvt_pk_bf16_f32 v64, v64, v65
  v_mfma_f32_16x16x32_bf16 v[88:91], a[140:143], v[188:191], v[204:207]
  s_add_u32 m0, s28, 49152
  v_exp_f32 v66, v66
  v_mfma_f32_16x16x32_bf16 v[88:91], a[136:139], v[184:187], v[88:91]
  buffer_load_dwordx4 v232, s[12:15], s29 offen offset:0 lds
  v_mfma_f32_16x16x32_bf16 v[88:91], a[132:135], v[180:183], v[88:91]
  s_waitcnt lgkmcnt(0)
  v_exp_f32 v67, v67
  v_mfma_f32_16x16x32_bf16 v[88:91], a[128:131], v[176:179], v[88:91]
  v_cvt_pk_bf16_f32 v65, v66, v67
  v_mfma_f32_16x16x32_bf16 v[68:71], a[144:147], v[128:131], v[192:195]
  v_exp_f32 v72, v72
  v_mfma_f32_16x16x32_bf16 v[68:71], a[148:151], v[132:135], v[68:71]
  ds_read_b128 a[128:131], v212 offset:24576
  v_mfma_f32_16x16x32_bf16 v[68:71], a[152:155], v[136:139], v[68:71]
  v_exp_f32 v73, v73
  v_mfma_f32_16x16x32_bf16 v[68:71], a[156:159], v[140:143], v[68:71]
  ds_read_b128 a[132:135], v213 offset:24576
  v_cvt_pk_bf16_f32 v72, v72, v73
  v_mfma_f32_16x16x32_bf16 v[76:79], a[156:159], v[156:159], v[196:199]
  v_exp_f32 v74, v74
  v_mfma_f32_16x16x32_bf16 v[76:79], a[152:155], v[152:155], v[76:79]
  ds_read_b128 a[136:139], v214 offset:24576
  v_lshrrev_b32 v224, 4, v242
  v_mfma_f32_16x16x32_bf16 v[76:79], a[148:151], v[148:151], v[76:79]
  v_exp_f32 v75, v75
  v_mfma_f32_16x16x32_bf16 v[76:79], a[144:147], v[144:147], v[76:79]
  ds_read_b128 a[140:143], v215 offset:24576
  v_cvt_pk_bf16_f32 v73, v74, v75
  v_mfma_f32_16x16x32_bf16 v[84:87], a[144:147], v[160:163], v[200:203]
  v_exp_f32 v80, v80
  v_mfma_f32_16x16x32_bf16 v[84:87], a[148:151], v[164:167], v[84:87]
  buffer_load_dwordx4 v233, s[12:15], s29 offen offset:1024 lds
  v_mfma_f32_16x16x32_bf16 v[84:87], a[152:155], v[168:171], v[84:87]
  v_exp_f32 v81, v81
  v_mfma_f32_16x16x32_bf16 v[84:87], a[156:159], v[172:175], v[84:87]
  v_cvt_pk_bf16_f32 v80, v80, v81
  v_lshrrev_b32 v225, 4, v224
  v_mfma_f32_16x16x32_bf16 v[92:95], a[156:159], v[188:191], v[204:207]
  v_exp_f32 v82, v82
  v_mfma_f32_16x16x32_bf16 v[92:95], a[152:155], v[184:187], v[92:95]
  buffer_load_dwordx4 v234, s[12:15], s29 offen offset:2048 lds
  v_mfma_f32_16x16x32_bf16 v[92:95], a[148:151], v[180:183], v[92:95]
  s_waitcnt lgkmcnt(0)
  v_exp_f32 v83, v83
  v_mfma_f32_16x16x32_bf16 v[92:95], a[144:147], v[176:179], v[92:95]
  v_cvt_pk_bf16_f32 v81, v82, v83
  v_bfe_u32 v226, v224, 2, 2
  v_mfma_f32_16x16x32_bf16 v[96:99], a[128:131], v[128:131], v[192:195]
  v_exp_f32 v88, v88
  v_mfma_f32_16x16x32_bf16 v[96:99], a[132:135], v[132:135], v[96:99]
  ds_read_b128 a[144:147], v212 offset:28672
  v_lshl_add_u32 v225, v225, 3, v226
  v_mfma_f32_16x16x32_bf16 v[96:99], a[136:139], v[136:139], v[96:99]
  v_exp_f32 v89, v89
  v_mfma_f32_16x16x32_bf16 v[96:99], a[140:143], v[140:143], v[96:99]
  ds_read_b128 a[148:151], v213 offset:28672
  v_cvt_pk_bf16_f32 v88, v88, v89
  v_mfma_f32_16x16x32_bf16 v[104:107], a[140:143], v[156:159], v[196:199]
  v_exp_f32 v90, v90
  v_mfma_f32_16x16x32_bf16 v[104:107], a[136:139], v[152:155], v[104:107]
  ds_read_b128 a[152:155], v214 offset:28672
  v_lshlrev_b32 v225, 5, v225
  v_mfma_f32_16x16x32_bf16 v[104:107], a[132:135], v[148:151], v[104:107]
  v_exp_f32 v91, v91
  v_mfma_f32_16x16x32_bf16 v[104:107], a[128:131], v[144:147], v[104:107]
  ds_read_b128 a[156:159], v215 offset:28672
  v_cvt_pk_bf16_f32 v89, v90, v91
  v_mfma_f32_16x16x32_bf16 v[112:115], a[128:131], v[160:163], v[200:203]
  v_exp_f32 v68, v68
  v_mfma_f32_16x16x32_bf16 v[112:115], a[132:135], v[164:167], v[112:115]
  buffer_load_dwordx4 v235, s[12:15], s29 offen offset:3072 lds
  v_mfma_f32_16x16x32_bf16 v[112:115], a[136:139], v[168:171], v[112:115]
  v_exp_f32 v69, v69
  v_mfma_f32_16x16x32_bf16 v[112:115], a[140:143], v[172:175], v[112:115]
  v_cvt_pk_bf16_f32 v66, v68, v69
  v_and_b32 v226, 3, v224
  v_mfma_f32_16x16x32_bf16 v[120:123], a[140:143], v[188:191], v[204:207]
  v_exp_f32 v70, v70
  v_mfma_f32_16x16x32_bf16 v[120:123], a[136:139], v[184:187], v[120:123]
  s_add_u32 m0, s28, 0
  v_lshl_add_u32 v225, v226, 3, v225
  v_add_u32 v225, s50, v225
  v_mfma_f32_16x16x32_bf16 v[120:123], a[132:135], v[180:183], v[120:123]
  s_waitcnt lgkmcnt(0)
  s_waitcnt vmcnt(11)
  v_exp_f32 v71, v71
  v_mfma_f32_16x16x32_bf16 v[120:123], a[128:131], v[176:179], v[120:123]
  ds_read_b64_tr_b16 a[232:233], v225 offset:0
  v_cvt_pk_bf16_f32 v67, v70, v71
  v_mfma_f32_16x16x32_bf16 v[100:103], a[144:147], v[128:131], v[192:195]
  v_exp_f32 v76, v76
  v_mfma_f32_16x16x32_bf16 v[100:103], a[148:151], v[132:135], v[100:103]
  ds_read_b64_tr_b16 a[160:161], v216 offset:0
  ds_read_b64_tr_b16 a[234:235], v225 offset:128
  v_mfma_f32_16x16x32_bf16 v[100:103], a[152:155], v[136:139], v[100:103]
  v_exp_f32 v77, v77
  v_mfma_f32_16x16x32_bf16 v[100:103], a[156:159], v[140:143], v[100:103]
  ds_read_b64_tr_b16 a[162:163], v216 offset:4096
  v_cvt_pk_bf16_f32 v74, v76, v77
  v_mfma_f32_16x16x32_bf16 v[108:111], a[156:159], v[156:159], v[196:199]
  v_exp_f32 v78, v78
  v_mfma_f32_16x16x32_bf16 v[108:111], a[152:155], v[152:155], v[108:111]
  ds_read_b64_tr_b16 a[164:165], v216 offset:8192
  ds_read_b64_tr_b16 a[236:237], v225 offset:1024
  v_mfma_f32_16x16x32_bf16 v[108:111], a[148:151], v[148:151], v[108:111]
  v_exp_f32 v79, v79
  v_mfma_f32_16x16x32_bf16 v[108:111], a[144:147], v[144:147], v[108:111]
  ds_read_b64_tr_b16 a[166:167], v216 offset:12288
  v_cvt_pk_bf16_f32 v75, v78, v79
  v_mfma_f32_16x16x32_bf16 v[116:119], a[144:147], v[160:163], v[200:203]
  v_exp_f32 v84, v84
  v_mfma_f32_16x16x32_bf16 v[116:119], a[148:151], v[164:167], v[116:119]
  ds_read_b64_tr_b16 a[168:169], v217 offset:0
  ds_read_b64_tr_b16 a[238:239], v225 offset:1152
  v_mfma_f32_16x16x32_bf16 v[116:119], a[152:155], v[168:171], v[116:119]
  v_exp_f32 v85, v85
  v_mfma_f32_16x16x32_bf16 v[116:119], a[156:159], v[172:175], v[116:119]
  ds_read_b64_tr_b16 a[170:171], v217 offset:4096
  v_cvt_pk_bf16_f32 v82, v84, v85
  v_mfma_f32_16x16x32_bf16 v[124:127], a[156:159], v[188:191], v[204:207]
  v_exp_f32 v86, v86
  v_mfma_f32_16x16x32_bf16 v[124:127], a[152:155], v[184:187], v[124:127]
  ds_read_b64_tr_b16 a[172:173], v217 offset:8192
  ds_read_b64_tr_b16 a[240:241], v225 offset:2048
  v_mfma_f32_16x16x32_bf16 v[124:127], a[148:151], v[180:183], v[124:127]
  v_exp_f32 v87, v87
  v_mfma_f32_16x16x32_bf16 v[124:127], a[144:147], v[176:179], v[124:127]
  ds_read_b64_tr_b16 a[174:175], v217 offset:12288
  v_cvt_pk_bf16_f32 v83, v86, v87
  v_mfma_f32_16x16x32_bf16 a[192:195], a[208:211], v[0:3], a[192:195]
  v_exp_f32 v92, v92
  v_mfma_f32_16x16x32_bf16 a[192:195], a[208:211], v[32:35], a[192:195]
  ds_read_b64_tr_b16 a[176:177], v218 offset:0
  ds_read_b64_tr_b16 a[242:243], v225 offset:2176
  v_mfma_f32_16x16x32_bf16 a[196:199], a[208:211], v[8:11], a[196:199]
  v_exp_f32 v93, v93
  v_mfma_f32_16x16x32_bf16 a[196:199], a[208:211], v[40:43], a[196:199]
  ds_read_b64_tr_b16 a[178:179], v218 offset:4096
  v_cvt_pk_bf16_f32 v90, v92, v93
  v_mfma_f32_16x16x32_bf16 a[200:203], a[208:211], v[16:19], a[200:203]
  v_exp_f32 v94, v94
  v_mfma_f32_16x16x32_bf16 a[200:203], a[208:211], v[48:51], a[200:203]
  ds_read_b64_tr_b16 a[180:181], v218 offset:8192
  buffer_load_dwordx4 v253, s[24:27], s8 offen offset:0 sc1 lds
  v_mfma_f32_16x16x32_bf16 a[204:207], a[208:211], v[24:27], a[204:207]
  s_waitcnt lgkmcnt(10)
  v_exp_f32 v95, v95
  v_mfma_f32_16x16x32_bf16 a[204:207], a[208:211], v[56:59], a[204:207]
  ds_read_b64_tr_b16 a[182:183], v218 offset:12288
  v_cvt_pk_bf16_f32 v91, v94, v95
  v_mfma_f32_16x16x32_bf16 a[0:3], a[160:163], v[0:3], a[0:3]
  v_exp_f32 v96, v96
  v_mfma_f32_16x16x32_bf16 a[0:3], a[164:167], v[32:35], a[0:3]
  ds_read_b64_tr_b16 a[184:185], v219 offset:0
  s_waitcnt lgkmcnt(4)
  buffer_load_dwordx4 v253, s[24:27], s8 offen offset:1024 sc1 lds
  v_mfma_f32_16x16x32_bf16 v[228:231], a[232:235], a[212:215], 0
  v_mfma_f32_16x16x32_bf16 v[228:231], a[236:239], a[216:219], v[228:231]
  v_mfma_f32_16x16x32_bf16 v[228:231], a[240:243], a[220:223], v[228:231]
  v_mfma_f32_16x16x32_bf16 a[4:7], a[164:167], v[40:43], a[4:7]
  s_lshl_b32 s35, s3, 10
  s_add_u32 s35, s35, 159744
  v_exp_f32 v97, v97
  v_mfma_f32_16x16x32_bf16 a[4:7], a[160:163], v[8:11], a[4:7]
  ds_read_b64_tr_b16 a[186:187], v219 offset:4096
  v_cvt_pk_bf16_f32 v96, v96, v97
  v_mfma_f32_16x16x32_bf16 a[8:11], a[160:163], v[16:19], a[8:11]
  v_exp_f32 v98, v98
  v_mfma_f32_16x16x32_bf16 a[8:11], a[164:167], v[48:51], a[8:11]
  ds_read_b64_tr_b16 a[188:189], v219 offset:8192
  buffer_load_dwordx4 v253, s[24:27], s8 offen offset:2048 sc1 lds
  v_mfma_f32_16x16x32_bf16 a[12:15], a[164:167], v[56:59], a[12:15]
  v_exp_f32 v99, v99
  v_mfma_f32_16x16x32_bf16 a[12:15], a[160:163], v[24:27], a[12:15]
  ds_read_b64_tr_b16 a[190:191], v219 offset:12288
  v_cvt_pk_bf16_f32 v97, v98, v99
  v_mfma_f32_16x16x32_bf16 a[16:19], a[168:171], v[0:3], a[16:19]
  v_exp_f32 v104, v104
  v_mfma_f32_16x16x32_bf16 a[16:19], a[172:175], v[32:35], a[16:19]
  ds_read_b64_tr_b16 a[160:161], v220 offset:0
  buffer_load_dwordx4 v253, s[24:27], s8 offen offset:3072 sc1 lds
  v_mfma_f32_16x16x32_bf16 a[20:23], a[172:175], v[40:43], a[20:23]
  v_exp_f32 v105, v105
  v_mfma_f32_16x16x32_bf16 a[20:23], a[168:171], v[8:11], a[20:23]
  ds_read_b64_tr_b16 a[162:163], v220 offset:4096
  v_cvt_pk_bf16_f32 v104, v104, v105
  v_mfma_f32_16x16x32_bf16 a[24:27], a[168:171], v[16:19], a[24:27]
  v_exp_f32 v106, v106
  v_mfma_f32_16x16x32_bf16 a[24:27], a[172:175], v[48:51], a[24:27]
  ds_read_b64_tr_b16 a[164:165], v220 offset:8192
  v_add_u32 v224, s35, v242
  v_mfma_f32_16x16x32_bf16 a[28:31], a[172:175], v[56:59], a[28:31]
  s_waitcnt lgkmcnt(7)
  v_exp_f32 v107, v107
  v_mfma_f32_16x16x32_bf16 a[28:31], a[168:171], v[24:27], a[28:31]
  ds_read_b64_tr_b16 a[166:167], v220 offset:12288
  v_cvt_pk_bf16_f32 v105, v106, v107
  v_mfma_f32_16x16x32_bf16 a[32:35], a[176:179], v[0:3], a[32:35]
  v_exp_f32 v112, v112
  v_mfma_f32_16x16x32_bf16 a[32:35], a[180:183], v[32:35], a[32:35]
  ds_read_b64_tr_b16 a[168:169], v221 offset:0
  ds_write_b128 v224, v[228:231]
  v_mfma_f32_16x16x32_bf16 a[36:39], a[180:183], v[40:43], a[36:39]
  v_exp_f32 v113, v113
  v_mfma_f32_16x16x32_bf16 a[36:39], a[176:179], v[8:11], a[36:39]
  ds_read_b64_tr_b16 a[170:171], v221 offset:4096
  v_cvt_pk_bf16_f32 v112, v112, v113
  v_mfma_f32_16x16x32_bf16 a[40:43], a[176:179], v[16:19], a[40:43]
  v_exp_f32 v114, v114
  v_mfma_f32_16x16x32_bf16 a[40:43], a[180:183], v[48:51], a[40:43]
  ds_read_b64_tr_b16 a[172:173], v221 offset:8192
  v_mfma_f32_16x16x32_bf16 a[44:47], a[180:183], v[56:59], a[44:47]
  s_waitcnt lgkmcnt(8)
  v_exp_f32 v115, v115
  v_mfma_f32_16x16x32_bf16 a[44:47], a[176:179], v[24:27], a[44:47]
  ds_read_b64_tr_b16 a[174:175], v221 offset:12288
  v_cvt_pk_bf16_f32 v113, v114, v115
  v_mfma_f32_16x16x32_bf16 a[48:51], a[184:187], v[0:3], a[48:51]
  v_exp_f32 v120, v120
  v_mfma_f32_16x16x32_bf16 a[48:51], a[188:191], v[32:35], a[48:51]
  ds_read_b64_tr_b16 a[176:177], v222 offset:0
  s_waitcnt lgkmcnt(4)
  v_mfma_f32_16x16x32_bf16 a[52:55], a[188:191], v[40:43], a[52:55]
  v_exp_f32 v121, v121
  v_mfma_f32_16x16x32_bf16 a[52:55], a[184:187], v[8:11], a[52:55]
  ds_read_b64_tr_b16 a[178:179], v222 offset:4096
  v_cvt_pk_bf16_f32 v120, v120, v121
  v_mfma_f32_16x16x32_bf16 a[56:59], a[184:187], v[16:19], a[56:59]
  v_exp_f32 v122, v122
  v_mfma_f32_16x16x32_bf16 a[56:59], a[188:191], v[48:51], a[56:59]
  ds_read_b64_tr_b16 a[180:181], v222 offset:8192
  v_mfma_f32_16x16x32_bf16 a[60:63], a[188:191], v[56:59], a[60:63]
  v_exp_f32 v123, v123
  v_mfma_f32_16x16x32_bf16 a[60:63], a[184:187], v[24:27], a[60:63]
  ds_read_b64_tr_b16 a[182:183], v222 offset:12288
  v_cvt_pk_bf16_f32 v121, v122, v123
  v_mfma_f32_16x16x32_bf16 a[64:67], a[160:163], v[0:3], a[64:67]
  v_exp_f32 v100, v100
  v_mfma_f32_16x16x32_bf16 a[64:67], a[164:167], v[32:35], a[64:67]
  ds_read_b64_tr_b16 a[184:185], v223 offset:0
  v_mfma_f32_16x16x32_bf16 a[68:71], a[164:167], v[40:43], a[68:71]
  v_exp_f32 v101, v101
  v_mfma_f32_16x16x32_bf16 a[68:71], a[160:163], v[8:11], a[68:71]
  ds_read_b64_tr_b16 a[186:187], v223 offset:4096
  v_cvt_pk_bf16_f32 v98, v100, v101
  v_mfma_f32_16x16x32_bf16 a[72:75], a[160:163], v[16:19], a[72:75]
  v_exp_f32 v102, v102
  v_mfma_f32_16x16x32_bf16 a[72:75], a[164:167], v[48:51], a[72:75]
  ds_read_b64_tr_b16 a[188:189], v223 offset:8192
  v_mfma_f32_16x16x32_bf16 a[76:79], a[164:167], v[56:59], a[76:79]
  s_waitcnt lgkmcnt(7)
  v_exp_f32 v103, v103
  v_mfma_f32_16x16x32_bf16 a[76:79], a[160:163], v[24:27], a[76:79]
  ds_read_b64_tr_b16 a[190:191], v223 offset:12288
  v_cvt_pk_bf16_f32 v99, v102, v103
  v_mfma_f32_16x16x32_bf16 a[80:83], a[168:171], v[0:3], a[80:83]
  s_waitcnt vmcnt(12)
  v_exp_f32 v108, v108
  v_mfma_f32_16x16x32_bf16 a[80:83], a[172:175], v[32:35], a[80:83]
  v_mfma_f32_16x16x32_bf16 a[84:87], a[172:175], v[40:43], a[84:87]
  s_barrier
  v_exp_f32 v109, v109
  v_mfma_f32_16x16x32_bf16 a[84:87], a[168:171], v[8:11], a[84:87]
  ds_read_b128 a[128:131], v212 offset:32768
  v_cvt_pk_bf16_f32 v106, v108, v109
  v_mfma_f32_16x16x32_bf16 a[88:91], a[168:171], v[16:19], a[88:91]
  v_exp_f32 v110, v110
  v_mfma_f32_16x16x32_bf16 a[88:91], a[172:175], v[48:51], a[88:91]
  ds_read_b128 a[132:135], v213 offset:32768
  v_mfma_f32_16x16x32_bf16 a[92:95], a[172:175], v[56:59], a[92:95]
  s_waitcnt lgkmcnt(6)
  v_exp_f32 v111, v111
  v_mfma_f32_16x16x32_bf16 a[92:95], a[168:171], v[24:27], a[92:95]
  ds_read_b128 a[136:139], v214 offset:32768
  v_cvt_pk_bf16_f32 v107, v110, v111
  v_mfma_f32_16x16x32_bf16 a[96:99], a[176:179], v[0:3], a[96:99]
  v_exp_f32 v116, v116
  v_mfma_f32_16x16x32_bf16 a[96:99], a[180:183], v[32:35], a[96:99]
  ds_read_b128 a[140:143], v215 offset:32768
  v_mfma_f32_16x16x32_bf16 a[100:103], a[180:183], v[40:43], a[100:103]
  v_exp_f32 v117, v117
  v_mfma_f32_16x16x32_bf16 a[100:103], a[176:179], v[8:11], a[100:103]
  v_cvt_pk_bf16_f32 v114, v116, v117
  v_mfma_f32_16x16x32_bf16 a[104:107], a[176:179], v[16:19], a[104:107]
  v_exp_f32 v118, v118
  v_mfma_f32_16x16x32_bf16 a[104:107], a[180:183], v[48:51], a[104:107]
  v_mfma_f32_16x16x32_bf16 a[108:111], a[180:183], v[56:59], a[108:111]
  s_waitcnt lgkmcnt(4)
  v_exp_f32 v119, v119
  v_mfma_f32_16x16x32_bf16 a[108:111], a[176:179], v[24:27], a[108:111]
  v_cvt_pk_bf16_f32 v115, v118, v119
  v_mfma_f32_16x16x32_bf16 a[112:115], a[184:187], v[0:3], a[112:115]
  v_exp_f32 v124, v124
  v_mfma_f32_16x16x32_bf16 a[112:115], a[188:191], v[32:35], a[112:115]
  v_mfma_f32_16x16x32_bf16 a[116:119], a[188:191], v[40:43], a[116:119]
  v_exp_f32 v125, v125
  v_mfma_f32_16x16x32_bf16 a[116:119], a[184:187], v[8:11], a[116:119]
  v_cvt_pk_bf16_f32 v122, v124, v125
  v_mfma_f32_16x16x32_bf16 a[120:123], a[184:187], v[16:19], a[120:123]
  v_exp_f32 v126, v126
  v_mfma_f32_16x16x32_bf16 a[120:123], a[188:191], v[48:51], a[120:123]
  v_mfma_f32_16x16x32_bf16 a[124:127], a[188:191], v[56:59], a[124:127]
  s_waitcnt lgkmcnt(0)
  v_exp_f32 v127, v127
  v_mfma_f32_16x16x32_bf16 a[124:127], a[184:187], v[24:27], a[124:127]
  v_cvt_pk_bf16_f32 v123, v126, v127
  v_mfma_f32_16x16x32_bf16 v[0:3], a[128:131], v[128:131], v[192:195]
  s_add_u32 m0, s28, 114688
  v_add_u32 v224, 159744, v242
  v_mfma_f32_16x16x32_bf16 v[0:3], a[132:135], v[132:135], v[0:3]
  ds_read_b128 a[144:147], v212 offset:36864
  ds_read_b128 v[228:231], v224 offset:0
  v_mfma_f32_16x16x32_bf16 v[0:3], a[136:139], v[136:139], v[0:3]
  buffer_load_dwordx4 v236, s[16:19], s29 offen offset:0 lds
  v_mfma_f32_16x16x32_bf16 v[0:3], a[140:143], v[140:143], v[0:3]
  ds_read_b128 a[148:151], v213 offset:36864
  ds_read_b128 v[238:241], v224 offset:1024
  v_mfma_f32_16x16x32_bf16 v[8:11], a[140:143], v[156:159], v[196:199]
  buffer_load_dwordx4 v237, s[16:19], s29 offen offset:1024 lds
  v_mfma_f32_16x16x32_bf16 v[8:11], a[136:139], v[152:155], v[8:11]
  ds_read_b128 a[152:155], v214 offset:36864
  ds_read_b128 v[208:211], v224 offset:2048
  v_mfma_f32_16x16x32_bf16 v[8:11], a[132:135], v[148:151], v[8:11]
  buffer_load_dwordx4 v236, s[16:19], s29 offen offset:2048 lds
  v_mfma_f32_16x16x32_bf16 v[8:11], a[128:131], v[144:147], v[8:11]
  ds_read_b128 a[156:159], v215 offset:36864
  v_lshrrev_b32 v224, 4, v242
  v_mfma_f32_16x16x32_bf16 v[16:19], a[128:131], v[160:163], v[200:203]
  s_min_u32 s35, s3, 1
  s_lshl_b32 s35, s35, 30
  v_exp_f32 v0, v0
  v_mfma_f32_16x16x32_bf16 v[16:19], a[132:135], v[164:167], v[16:19]
  buffer_load_dwordx4 v237, s[16:19], s29 offen offset:3072 lds
  v_mfma_f32_16x16x32_bf16 v[16:19], a[136:139], v[168:171], v[16:19]
  s_add_u32 s29, s29, 16384
  v_exp_f32 v1, v1
  v_mfma_f32_16x16x32_bf16 v[16:19], a[140:143], v[172:175], v[16:19]
  v_cvt_pk_bf16_f32 v0, v0, v1
  v_and_b32 v225, 7, v224
  v_mfma_f32_16x16x32_bf16 v[24:27], a[140:143], v[188:191], v[204:207]
  s_add_u32 m0, s28, 16384
  v_exp_f32 v2, v2
  v_mfma_f32_16x16x32_bf16 v[24:27], a[136:139], v[184:187], v[24:27]
  buffer_load_dwordx4 v242, s[24:27], s9 offen offset:0 sc1 lds
  v_mfma_f32_16x16x32_bf16 v[24:27], a[132:135], v[180:183], v[24:27]
  s_waitcnt lgkmcnt(0)
  v_exp_f32 v3, v3
  v_mfma_f32_16x16x32_bf16 v[24:27], a[128:131], v[176:179], v[24:27]
  v_cvt_pk_bf16_f32 v1, v2, v3
  v_mul_u32_u24 v225, 0xa00, v225
  v_mfma_f32_16x16x32_bf16 v[4:7], a[144:147], v[128:131], v[192:195]
  v_exp_f32 v8, v8
  v_mfma_f32_16x16x32_bf16 v[4:7], a[148:151], v[132:135], v[4:7]
  ds_read_b128 a[128:131], v212 offset:40960
  v_lshrrev_b32 v226, 4, v224
  v_mfma_f32_16x16x32_bf16 v[4:7], a[152:155], v[136:139], v[4:7]
  v_exp_f32 v9, v9
  v_mfma_f32_16x16x32_bf16 v[4:7], a[156:159], v[140:143], v[4:7]
  ds_read_b128 a[132:135], v213 offset:40960
  v_cvt_pk_bf16_f32 v8, v8, v9
  v_mfma_f32_16x16x32_bf16 v[12:15], a[156:159], v[156:159], v[196:199]
  v_exp_f32 v10, v10
  v_mfma_f32_16x16x32_bf16 v[12:15], a[152:155], v[152:155], v[12:15]
  ds_read_b128 a[136:139], v214 offset:40960
  v_lshl_add_u32 v225, v226, 4, v225
  v_mfma_f32_16x16x32_bf16 v[12:15], a[148:151], v[148:151], v[12:15]
  v_exp_f32 v11, v11
  v_mfma_f32_16x16x32_bf16 v[12:15], a[144:147], v[144:147], v[12:15]
  ds_read_b128 a[140:143], v215 offset:40960
  v_cvt_pk_bf16_f32 v9, v10, v11
  v_mfma_f32_16x16x32_bf16 v[20:23], a[144:147], v[160:163], v[200:203]
  v_exp_f32 v16, v16
  v_mfma_f32_16x16x32_bf16 v[20:23], a[148:151], v[164:167], v[20:23]
  buffer_load_dwordx4 v242, s[24:27], s9 offen offset:1024 sc1 lds
  v_mfma_f32_16x16x32_bf16 v[20:23], a[152:155], v[168:171], v[20:23]
  v_exp_f32 v17, v17
  v_mfma_f32_16x16x32_bf16 v[20:23], a[156:159], v[172:175], v[20:23]
  v_cvt_pk_bf16_f32 v16, v16, v17
  v_bfe_u32 v226, v224, 3, 1
  v_mfma_f32_16x16x32_bf16 v[28:31], a[156:159], v[188:191], v[204:207]
  v_exp_f32 v18, v18
  v_mfma_f32_16x16x32_bf16 v[28:31], a[152:155], v[184:187], v[28:31]
  buffer_load_dwordx4 v242, s[24:27], s9 offen offset:2048 sc1 lds
  v_mfma_f32_16x16x32_bf16 v[28:31], a[148:151], v[180:183], v[28:31]
  s_waitcnt lgkmcnt(0)
  v_exp_f32 v19, v19
  v_mfma_f32_16x16x32_bf16 v[28:31], a[144:147], v[176:179], v[28:31]
  v_cvt_pk_bf16_f32 v17, v18, v19
  v_lshl_add_u32 v225, v226, 30, v225
  v_mfma_f32_16x16x32_bf16 v[32:35], a[128:131], v[128:131], v[192:195]
  v_exp_f32 v24, v24
  v_mfma_f32_16x16x32_bf16 v[32:35], a[132:135], v[132:135], v[32:35]
  ds_read_b128 a[144:147], v212 offset:45056
  v_or_b32 v225, s35, v225
  v_mfma_f32_16x16x32_bf16 v[32:35], a[136:139], v[136:139], v[32:35]
  s_mul_i32 s35, s98, 20480
  s_lshl_b32 s38, s99, 6
  s_add_u32 s35, s35, s38
  v_exp_f32 v25, v25
  v_mfma_f32_16x16x32_bf16 v[32:35], a[140:143], v[140:143], v[32:35]
  ds_read_b128 a[148:151], v213 offset:45056
  s_add_u32 s35, s35, 2686976
  v_cvt_pk_bf16_f32 v24, v24, v25
  v_mfma_f32_16x16x32_bf16 v[40:43], a[140:143], v[156:159], v[196:199]
  v_exp_f32 v26, v26
  v_mfma_f32_16x16x32_bf16 v[40:43], a[136:139], v[152:155], v[40:43]
  ds_read_b128 a[152:155], v214 offset:45056
  v_add_f32 v228, v228, v238
  v_mfma_f32_16x16x32_bf16 v[40:43], a[132:135], v[148:151], v[40:43]
  v_exp_f32 v27, v27
  v_mfma_f32_16x16x32_bf16 v[40:43], a[128:131], v[144:147], v[40:43]
  ds_read_b128 a[156:159], v215 offset:45056
  v_cvt_pk_bf16_f32 v25, v26, v27
  v_mfma_f32_16x16x32_bf16 v[48:51], a[128:131], v[160:163], v[200:203]
  v_exp_f32 v4, v4
  v_mfma_f32_16x16x32_bf16 v[48:51], a[132:135], v[164:167], v[48:51]
  buffer_load_dwordx4 v242, s[24:27], s9 offen offset:3072 sc1 lds
  v_mfma_f32_16x16x32_bf16 v[48:51], a[136:139], v[168:171], v[48:51]
  v_exp_f32 v5, v5
  v_mfma_f32_16x16x32_bf16 v[48:51], a[140:143], v[172:175], v[48:51]
  v_cvt_pk_bf16_f32 v2, v4, v5
  v_add_f32 v229, v229, v239
  v_mfma_f32_16x16x32_bf16 v[56:59], a[140:143], v[188:191], v[204:207]
  v_exp_f32 v6, v6
  v_mfma_f32_16x16x32_bf16 v[56:59], a[136:139], v[184:187], v[56:59]
  buffer_load_dwordx4 a[212:215], v242, s[24:27], s4 offen offset:0 sc1
  v_mfma_f32_16x16x32_bf16 v[56:59], a[132:135], v[180:183], v[56:59]
  s_waitcnt lgkmcnt(0)
  v_exp_f32 v7, v7
  v_mfma_f32_16x16x32_bf16 v[56:59], a[128:131], v[176:179], v[56:59]
  v_cvt_pk_bf16_f32 v3, v6, v7
  v_add_f32 v230, v230, v240
  v_mfma_f32_16x16x32_bf16 v[36:39], a[144:147], v[128:131], v[192:195]
  v_exp_f32 v12, v12
  v_mfma_f32_16x16x32_bf16 v[36:39], a[148:151], v[132:135], v[36:39]
  ds_read_b64_tr_b16 a[160:161], v216 offset:16384
  v_add_f32 v231, v231, v241
  v_mfma_f32_16x16x32_bf16 v[36:39], a[152:155], v[136:139], v[36:39]
  v_exp_f32 v13, v13
  v_mfma_f32_16x16x32_bf16 v[36:39], a[156:159], v[140:143], v[36:39]
  ds_read_b64_tr_b16 a[162:163], v216 offset:20480
  v_cvt_pk_bf16_f32 v10, v12, v13
  v_mfma_f32_16x16x32_bf16 v[44:47], a[156:159], v[156:159], v[196:199]
  v_exp_f32 v14, v14
  v_mfma_f32_16x16x32_bf16 v[44:47], a[152:155], v[152:155], v[44:47]
  ds_read_b64_tr_b16 a[164:165], v216 offset:24576
  buffer_load_dwordx4 a[216:219], v242, s[24:27], s4 offen offset:1024 sc1
  v_mfma_f32_16x16x32_bf16 v[44:47], a[148:151], v[148:151], v[44:47]
  v_exp_f32 v15, v15
  v_mfma_f32_16x16x32_bf16 v[44:47], a[144:147], v[144:147], v[44:47]
  ds_read_b64_tr_b16 a[166:167], v216 offset:28672
  v_cvt_pk_bf16_f32 v11, v14, v15
  v_mfma_f32_16x16x32_bf16 v[52:55], a[144:147], v[160:163], v[200:203]
  v_exp_f32 v20, v20
  v_mfma_f32_16x16x32_bf16 v[52:55], a[148:151], v[164:167], v[52:55]
  ds_read_b64_tr_b16 a[168:169], v217 offset:16384
  v_add_f32 v228, v228, v208
  v_mfma_f32_16x16x32_bf16 v[52:55], a[152:155], v[168:171], v[52:55]
  v_exp_f32 v21, v21
  v_mfma_f32_16x16x32_bf16 v[52:55], a[156:159], v[172:175], v[52:55]
  ds_read_b64_tr_b16 a[170:171], v217 offset:20480
  v_cvt_pk_bf16_f32 v18, v20, v21
  v_mfma_f32_16x16x32_bf16 v[60:63], a[156:159], v[188:191], v[204:207]
  v_exp_f32 v22, v22
  v_mfma_f32_16x16x32_bf16 v[60:63], a[152:155], v[184:187], v[60:63]
  ds_read_b64_tr_b16 a[172:173], v217 offset:24576
  buffer_load_dwordx4 a[220:223], v242, s[24:27], s4 offen offset:2048 sc1
  v_mfma_f32_16x16x32_bf16 v[60:63], a[148:151], v[180:183], v[60:63]
  v_exp_f32 v23, v23
  v_mfma_f32_16x16x32_bf16 v[60:63], a[144:147], v[176:179], v[60:63]
  ds_read_b64_tr_b16 a[174:175], v217 offset:28672
  v_cvt_pk_bf16_f32 v19, v22, v23
  v_mfma_f32_16x16x32_bf16 a[192:195], a[208:211], v[64:67], a[192:195]
  v_exp_f32 v28, v28
  v_mfma_f32_16x16x32_bf16 a[192:195], a[208:211], v[96:99], a[192:195]
  ds_read_b64_tr_b16 a[176:177], v218 offset:16384
  v_add_f32 v229, v229, v209
  v_mfma_f32_16x16x32_bf16 a[196:199], a[208:211], v[72:75], a[196:199]
  v_exp_f32 v29, v29
  v_mfma_f32_16x16x32_bf16 a[196:199], a[208:211], v[104:107], a[196:199]
  ds_read_b64_tr_b16 a[178:179], v218 offset:20480
  v_cvt_pk_bf16_f32 v26, v28, v29
  v_mfma_f32_16x16x32_bf16 a[200:203], a[208:211], v[80:83], a[200:203]
  v_exp_f32 v30, v30
  v_mfma_f32_16x16x32_bf16 a[200:203], a[208:211], v[112:115], a[200:203]
  ds_read_b64_tr_b16 a[180:181], v218 offset:24576
  buffer_load_dwordx4 a[224:227], v242, s[24:27], s4 offen offset:3072 sc1
  v_mfma_f32_16x16x32_bf16 a[204:207], a[208:211], v[88:91], a[204:207]
  s_waitcnt lgkmcnt(7)
  v_exp_f32 v31, v31
  v_mfma_f32_16x16x32_bf16 a[204:207], a[208:211], v[120:123], a[204:207]
  ds_read_b64_tr_b16 a[182:183], v218 offset:28672
  v_cvt_pk_bf16_f32 v27, v30, v31
  v_mfma_f32_16x16x32_bf16 a[0:3], a[160:163], v[64:67], a[0:3]
  v_exp_f32 v32, v32
  v_mfma_f32_16x16x32_bf16 a[0:3], a[164:167], v[96:99], a[0:3]
  ds_read_b64_tr_b16 a[184:185], v219 offset:16384
  v_add_f32 v230, v230, v210
  v_mfma_f32_16x16x32_bf16 a[4:7], a[164:167], v[104:107], a[4:7]
  v_exp_f32 v33, v33
  v_mfma_f32_16x16x32_bf16 a[4:7], a[160:163], v[72:75], a[4:7]
  ds_read_b64_tr_b16 a[186:187], v219 offset:20480
  v_cvt_pk_bf16_f32 v32, v32, v33
  v_mfma_f32_16x16x32_bf16 a[8:11], a[160:163], v[80:83], a[8:11]
  v_exp_f32 v34, v34
  v_mfma_f32_16x16x32_bf16 a[8:11], a[164:167], v[112:115], a[8:11]
  ds_read_b64_tr_b16 a[188:189], v219 offset:24576
  buffer_load_dwordx4 a[228:231], v252, s[24:27], s4 offen offset:0 sc1
  v_mfma_f32_16x16x32_bf16 a[12:15], a[164:167], v[120:123], a[12:15]
  s_waitcnt lgkmcnt(7)
  v_exp_f32 v35, v35
  v_mfma_f32_16x16x32_bf16 a[12:15], a[160:163], v[88:91], a[12:15]
  ds_read_b64_tr_b16 a[190:191], v219 offset:28672
  v_cvt_pk_bf16_f32 v33, v34, v35
  v_mfma_f32_16x16x32_bf16 a[16:19], a[168:171], v[64:67], a[16:19]
  v_exp_f32 v40, v40
  v_mfma_f32_16x16x32_bf16 a[16:19], a[172:175], v[96:99], a[16:19]
  ds_read_b64_tr_b16 a[160:161], v220 offset:16384
  v_add_f32 v231, v231, v211
  v_mfma_f32_16x16x32_bf16 a[20:23], a[172:175], v[104:107], a[20:23]
  v_exp_f32 v41, v41
  v_mfma_f32_16x16x32_bf16 a[20:23], a[168:171], v[72:75], a[20:23]
  ds_read_b64_tr_b16 a[162:163], v220 offset:20480
  v_cvt_pk_bf16_f32 v40, v40, v41
  v_mfma_f32_16x16x32_bf16 a[24:27], a[168:171], v[80:83], a[24:27]
  v_exp_f32 v42, v42
  v_mfma_f32_16x16x32_bf16 a[24:27], a[172:175], v[112:115], a[24:27]
  ds_read_b64_tr_b16 a[164:165], v220 offset:24576
  buffer_store_dwordx4 v[228:231], v225, s[24:27], s35 offen sc1
  v_mfma_f32_16x16x32_bf16 a[28:31], a[172:175], v[120:123], a[28:31]
  s_waitcnt lgkmcnt(7)
  v_exp_f32 v43, v43
  v_mfma_f32_16x16x32_bf16 a[28:31], a[168:171], v[88:91], a[28:31]
  ds_read_b64_tr_b16 a[166:167], v220 offset:28672
  v_cvt_pk_bf16_f32 v41, v42, v43
  v_mfma_f32_16x16x32_bf16 a[32:35], a[176:179], v[64:67], a[32:35]
  v_exp_f32 v48, v48
  v_mfma_f32_16x16x32_bf16 a[32:35], a[180:183], v[96:99], a[32:35]
  ds_read_b64_tr_b16 a[168:169], v221 offset:16384
  buffer_load_dwordx4 a[232:235], v252, s[24:27], s4 offen offset:1024 sc1
  v_mfma_f32_16x16x32_bf16 a[36:39], a[180:183], v[104:107], a[36:39]
  v_exp_f32 v49, v49
  v_mfma_f32_16x16x32_bf16 a[36:39], a[176:179], v[72:75], a[36:39]
  ds_read_b64_tr_b16 a[170:171], v221 offset:20480
  v_cvt_pk_bf16_f32 v48, v48, v49
  v_mfma_f32_16x16x32_bf16 a[40:43], a[176:179], v[80:83], a[40:43]
  v_exp_f32 v50, v50
  v_mfma_f32_16x16x32_bf16 a[40:43], a[180:183], v[112:115], a[40:43]
  ds_read_b64_tr_b16 a[172:173], v221 offset:24576
  v_mfma_f32_16x16x32_bf16 a[44:47], a[180:183], v[120:123], a[44:47]
  s_waitcnt lgkmcnt(7)
  v_exp_f32 v51, v51
  v_mfma_f32_16x16x32_bf16 a[44:47], a[176:179], v[88:91], a[44:47]
  ds_read_b64_tr_b16 a[174:175], v221 offset:28672
  v_cvt_pk_bf16_f32 v49, v50, v51
  v_mfma_f32_16x16x32_bf16 a[48:51], a[184:187], v[64:67], a[48:51]
  v_exp_f32 v56, v56
  v_mfma_f32_16x16x32_bf16 a[48:51], a[188:191], v[96:99], a[48:51]
  ds_read_b64_tr_b16 a[176:177], v222 offset:16384
  v_mfma_f32_16x16x32_bf16 a[52:55], a[188:191], v[104:107], a[52:55]
  v_exp_f32 v57, v57
  v_mfma_f32_16x16x32_bf16 a[52:55], a[184:187], v[72:75], a[52:55]
  ds_read_b64_tr_b16 a[178:179], v222 offset:20480
  v_cvt_pk_bf16_f32 v56, v56, v57
  v_mfma_f32_16x16x32_bf16 a[56:59], a[184:187], v[80:83], a[56:59]
  v_exp_f32 v58, v58
  v_mfma_f32_16x16x32_bf16 a[56:59], a[188:191], v[112:115], a[56:59]
  ds_read_b64_tr_b16 a[180:181], v222 offset:24576
  v_mfma_f32_16x16x32_bf16 a[60:63], a[188:191], v[120:123], a[60:63]
  s_waitcnt lgkmcnt(7)
  v_exp_f32 v59, v59
  v_mfma_f32_16x16x32_bf16 a[60:63], a[184:187], v[88:91], a[60:63]
  ds_read_b64_tr_b16 a[182:183], v222 offset:28672
  v_cvt_pk_bf16_f32 v57, v58, v59
  v_mfma_f32_16x16x32_bf16 a[64:67], a[160:163], v[64:67], a[64:67]
  v_exp_f32 v36, v36
  v_mfma_f32_16x16x32_bf16 a[64:67], a[164:167], v[96:99], a[64:67]
  ds_read_b64_tr_b16 a[184:185], v223 offset:16384
  v_mfma_f32_16x16x32_bf16 a[68:71], a[164:167], v[104:107], a[68:71]
  v_exp_f32 v37, v37
  v_mfma_f32_16x16x32_bf16 a[68:71], a[160:163], v[72:75], a[68:71]
  ds_read_b64_tr_b16 a[186:187], v223 offset:20480
  v_cvt_pk_bf16_f32 v34, v36, v37
  v_mfma_f32_16x16x32_bf16 a[72:75], a[160:163], v[80:83], a[72:75]
  v_exp_f32 v38, v38
  v_mfma_f32_16x16x32_bf16 a[72:75], a[164:167], v[112:115], a[72:75]
  ds_read_b64_tr_b16 a[188:189], v223 offset:24576
  v_mfma_f32_16x16x32_bf16 a[76:79], a[164:167], v[120:123], a[76:79]
  s_waitcnt lgkmcnt(7)
  v_exp_f32 v39, v39
  v_mfma_f32_16x16x32_bf16 a[76:79], a[160:163], v[88:91], a[76:79]
  ds_read_b64_tr_b16 a[190:191], v223 offset:28672
  v_cvt_pk_bf16_f32 v35, v38, v39
  v_mfma_f32_16x16x32_bf16 a[80:83], a[168:171], v[64:67], a[80:83]
  s_waitcnt vmcnt(19)
  v_exp_f32 v44, v44
  v_mfma_f32_16x16x32_bf16 a[80:83], a[172:175], v[96:99], a[80:83]
  v_mfma_f32_16x16x32_bf16 a[84:87], a[172:175], v[104:107], a[84:87]
  s_barrier
  v_exp_f32 v45, v45
  v_mfma_f32_16x16x32_bf16 a[84:87], a[168:171], v[72:75], a[84:87]
  ds_read_b128 a[128:131], v212 offset:49152
  v_cvt_pk_bf16_f32 v42, v44, v45
  v_mfma_f32_16x16x32_bf16 a[88:91], a[168:171], v[80:83], a[88:91]
  v_exp_f32 v46, v46
  v_mfma_f32_16x16x32_bf16 a[88:91], a[172:175], v[112:115], a[88:91]
  ds_read_b128 a[132:135], v213 offset:49152
  v_mfma_f32_16x16x32_bf16 a[92:95], a[172:175], v[120:123], a[92:95]
  s_waitcnt lgkmcnt(6)
  v_exp_f32 v47, v47
  v_mfma_f32_16x16x32_bf16 a[92:95], a[168:171], v[88:91], a[92:95]
  ds_read_b128 a[136:139], v214 offset:49152
  v_cvt_pk_bf16_f32 v43, v46, v47
  v_mfma_f32_16x16x32_bf16 a[96:99], a[176:179], v[64:67], a[96:99]
  v_exp_f32 v52, v52
  v_mfma_f32_16x16x32_bf16 a[96:99], a[180:183], v[96:99], a[96:99]
  ds_read_b128 a[140:143], v215 offset:49152
  v_mfma_f32_16x16x32_bf16 a[100:103], a[180:183], v[104:107], a[100:103]
  v_exp_f32 v53, v53
  v_mfma_f32_16x16x32_bf16 a[100:103], a[176:179], v[72:75], a[100:103]
  v_cvt_pk_bf16_f32 v50, v52, v53
  v_mfma_f32_16x16x32_bf16 a[104:107], a[176:179], v[80:83], a[104:107]
  v_exp_f32 v54, v54
  v_mfma_f32_16x16x32_bf16 a[104:107], a[180:183], v[112:115], a[104:107]
  v_mfma_f32_16x16x32_bf16 a[108:111], a[180:183], v[120:123], a[108:111]
  s_waitcnt lgkmcnt(4)
  v_exp_f32 v55, v55
  v_mfma_f32_16x16x32_bf16 a[108:111], a[176:179], v[88:91], a[108:111]
  v_cvt_pk_bf16_f32 v51, v54, v55
  v_mfma_f32_16x16x32_bf16 a[112:115], a[184:187], v[64:67], a[112:115]
  v_exp_f32 v60, v60
  v_mfma_f32_16x16x32_bf16 a[112:115], a[188:191], v[96:99], a[112:115]
  v_mfma_f32_16x16x32_bf16 a[116:119], a[188:191], v[104:107], a[116:119]
  v_exp_f32 v61, v61
  v_mfma_f32_16x16x32_bf16 a[116:119], a[184:187], v[72:75], a[116:119]
  v_cvt_pk_bf16_f32 v58, v60, v61
  v_mfma_f32_16x16x32_bf16 a[120:123], a[184:187], v[80:83], a[120:123]
  v_exp_f32 v62, v62
  v_mfma_f32_16x16x32_bf16 a[120:123], a[188:191], v[112:115], a[120:123]
  v_mfma_f32_16x16x32_bf16 a[124:127], a[188:191], v[120:123], a[124:127]
  s_waitcnt lgkmcnt(0)
  v_exp_f32 v63, v63
  v_mfma_f32_16x16x32_bf16 a[124:127], a[184:187], v[88:91], a[124:127]
  v_cvt_pk_bf16_f32 v59, v62, v63
  v_mfma_f32_16x16x32_bf16 v[64:67], a[128:131], v[128:131], v[192:195]
  s_add_u32 m0, s28, 65536
  v_mfma_f32_16x16x32_bf16 v[64:67], a[132:135], v[132:135], v[64:67]
  ds_read_b128 a[144:147], v212 offset:53248
  v_mfma_f32_16x16x32_bf16 v[64:67], a[136:139], v[136:139], v[64:67]
  buffer_load_dwordx4 v253, s[24:27], s9 offen offset:0 sc1 lds
  v_mfma_f32_16x16x32_bf16 v[64:67], a[140:143], v[140:143], v[64:67]
  ds_read_b128 a[148:151], v213 offset:53248
  v_mfma_f32_16x16x32_bf16 v[72:75], a[140:143], v[156:159], v[196:199]
  buffer_load_dwordx4 v253, s[24:27], s9 offen offset:1024 sc1 lds
  v_mfma_f32_16x16x32_bf16 v[72:75], a[136:139], v[152:155], v[72:75]
  ds_read_b128 a[152:155], v214 offset:53248
  v_mfma_f32_16x16x32_bf16 v[72:75], a[132:135], v[148:151], v[72:75]
  buffer_load_dwordx4 v253, s[24:27], s9 offen offset:2048 sc1 lds
  v_mfma_f32_16x16x32_bf16 v[72:75], a[128:131], v[144:147], v[72:75]
  ds_read_b128 a[156:159], v215 offset:53248
  v_mfma_f32_16x16x32_bf16 v[80:83], a[128:131], v[160:163], v[200:203]
  v_exp_f32 v64, v64
  v_mfma_f32_16x16x32_bf16 v[80:83], a[132:135], v[164:167], v[80:83]
  buffer_load_dwordx4 v253, s[24:27], s9 offen offset:3072 sc1 lds
  v_mfma_f32_16x16x32_bf16 v[80:83], a[136:139], v[168:171], v[80:83]
  s_add_u32 s29, s29, 16384
  v_exp_f32 v65, v65
  v_mfma_f32_16x16x32_bf16 v[80:83], a[140:143], v[172:175], v[80:83]
  v_cvt_pk_bf16_f32 v64, v64, v65
  v_mfma_f32_16x16x32_bf16 v[88:91], a[140:143], v[188:191], v[204:207]
  s_add_u32 m0, s28, 32768
  v_exp_f32 v66, v66
  v_mfma_f32_16x16x32_bf16 v[88:91], a[136:139], v[184:187], v[88:91]
  buffer_load_dwordx4 v252, s[24:27], s9 offen offset:0 sc1 lds
  v_mfma_f32_16x16x32_bf16 v[88:91], a[132:135], v[180:183], v[88:91]
  s_waitcnt lgkmcnt(0)
  v_exp_f32 v67, v67
  v_mfma_f32_16x16x32_bf16 v[88:91], a[128:131], v[176:179], v[88:91]
  v_cvt_pk_bf16_f32 v65, v66, v67
  v_mfma_f32_16x16x32_bf16 v[68:71], a[144:147], v[128:131], v[192:195]
  v_exp_f32 v72, v72
  v_mfma_f32_16x16x32_bf16 v[68:71], a[148:151], v[132:135], v[68:71]
  ds_read_b128 a[128:131], v212 offset:57344
  v_mfma_f32_16x16x32_bf16 v[68:71], a[152:155], v[136:139], v[68:71]
  v_exp_f32 v73, v73
  v_mfma_f32_16x16x32_bf16 v[68:71], a[156:159], v[140:143], v[68:71]
  ds_read_b128 a[132:135], v213 offset:57344
  v_cvt_pk_bf16_f32 v72, v72, v73
  v_mfma_f32_16x16x32_bf16 v[76:79], a[156:159], v[156:159], v[196:199]
  v_exp_f32 v74, v74
  v_mfma_f32_16x16x32_bf16 v[76:79], a[152:155], v[152:155], v[76:79]
  ds_read_b128 a[136:139], v214 offset:57344
  v_mfma_f32_16x16x32_bf16 v[76:79], a[148:151], v[148:151], v[76:79]
  v_exp_f32 v75, v75
  v_mfma_f32_16x16x32_bf16 v[76:79], a[144:147], v[144:147], v[76:79]
  ds_read_b128 a[140:143], v215 offset:57344
  v_cvt_pk_bf16_f32 v73, v74, v75
  v_mfma_f32_16x16x32_bf16 v[84:87], a[144:147], v[160:163], v[200:203]
  v_exp_f32 v80, v80
  v_mfma_f32_16x16x32_bf16 v[84:87], a[148:151], v[164:167], v[84:87]
  buffer_load_dwordx4 v252, s[24:27], s9 offen offset:1024 sc1 lds
  v_mfma_f32_16x16x32_bf16 v[84:87], a[152:155], v[168:171], v[84:87]
  v_exp_f32 v81, v81
  v_mfma_f32_16x16x32_bf16 v[84:87], a[156:159], v[172:175], v[84:87]
  v_cvt_pk_bf16_f32 v80, v80, v81
  v_mfma_f32_16x16x32_bf16 v[92:95], a[156:159], v[188:191], v[204:207]
  v_exp_f32 v82, v82
  v_mfma_f32_16x16x32_bf16 v[92:95], a[152:155], v[184:187], v[92:95]
  buffer_load_dwordx4 v252, s[24:27], s9 offen offset:2048 sc1 lds
  v_mfma_f32_16x16x32_bf16 v[92:95], a[148:151], v[180:183], v[92:95]
  s_waitcnt lgkmcnt(0)
  v_exp_f32 v83, v83
  v_mfma_f32_16x16x32_bf16 v[92:95], a[144:147], v[176:179], v[92:95]
  v_cvt_pk_bf16_f32 v81, v82, v83
  v_mfma_f32_16x16x32_bf16 v[96:99], a[128:131], v[128:131], v[192:195]
  v_exp_f32 v88, v88
  v_mfma_f32_16x16x32_bf16 v[96:99], a[132:135], v[132:135], v[96:99]
  ds_read_b128 a[144:147], v212 offset:61440
  v_mfma_f32_16x16x32_bf16 v[96:99], a[136:139], v[136:139], v[96:99]
  v_exp_f32 v89, v89
  v_mfma_f32_16x16x32_bf16 v[96:99], a[140:143], v[140:143], v[96:99]
  ds_read_b128 a[148:151], v213 offset:61440
  v_cvt_pk_bf16_f32 v88, v88, v89
  v_mfma_f32_16x16x32_bf16 v[104:107], a[140:143], v[156:159], v[196:199]
  v_exp_f32 v90, v90
  v_mfma_f32_16x16x32_bf16 v[104:107], a[136:139], v[152:155], v[104:107]
  ds_read_b128 a[152:155], v214 offset:61440
  v_mfma_f32_16x16x32_bf16 v[104:107], a[132:135], v[148:151], v[104:107]
  v_exp_f32 v91, v91
  v_mfma_f32_16x16x32_bf16 v[104:107], a[128:131], v[144:147], v[104:107]
  ds_read_b128 a[156:159], v215 offset:61440
  v_cvt_pk_bf16_f32 v89, v90, v91
  v_mfma_f32_16x16x32_bf16 v[112:115], a[128:131], v[160:163], v[200:203]
  v_exp_f32 v68, v68
  v_mfma_f32_16x16x32_bf16 v[112:115], a[132:135], v[164:167], v[112:115]
  buffer_load_dwordx4 v252, s[24:27], s9 offen offset:3072 sc1 lds
  v_mfma_f32_16x16x32_bf16 v[112:115], a[136:139], v[168:171], v[112:115]
  v_exp_f32 v69, v69
  v_mfma_f32_16x16x32_bf16 v[112:115], a[140:143], v[172:175], v[112:115]
  v_cvt_pk_bf16_f32 v66, v68, v69
  v_mfma_f32_16x16x32_bf16 v[120:123], a[140:143], v[188:191], v[204:207]
  v_exp_f32 v70, v70
  v_mfma_f32_16x16x32_bf16 v[120:123], a[136:139], v[184:187], v[120:123]
  buffer_load_dwordx4 a[236:239], v252, s[24:27], s4 offen offset:2048 sc1
  v_mfma_f32_16x16x32_bf16 v[120:123], a[132:135], v[180:183], v[120:123]
  s_waitcnt lgkmcnt(0)
  v_exp_f32 v71, v71
  v_mfma_f32_16x16x32_bf16 v[120:123], a[128:131], v[176:179], v[120:123]
  v_cvt_pk_bf16_f32 v67, v70, v71
  v_mfma_f32_16x16x32_bf16 v[100:103], a[144:147], v[128:131], v[192:195]
  v_exp_f32 v76, v76
  v_mfma_f32_16x16x32_bf16 v[100:103], a[148:151], v[132:135], v[100:103]
  ds_read_b64_tr_b16 a[160:161], v216 offset:32768
  v_mfma_f32_16x16x32_bf16 v[100:103], a[152:155], v[136:139], v[100:103]
  v_exp_f32 v77, v77
  v_mfma_f32_16x16x32_bf16 v[100:103], a[156:159], v[140:143], v[100:103]
  ds_read_b64_tr_b16 a[162:163], v216 offset:36864
  v_cvt_pk_bf16_f32 v74, v76, v77
  v_mfma_f32_16x16x32_bf16 v[108:111], a[156:159], v[156:159], v[196:199]
  v_exp_f32 v78, v78
  v_mfma_f32_16x16x32_bf16 v[108:111], a[152:155], v[152:155], v[108:111]
  ds_read_b64_tr_b16 a[164:165], v216 offset:40960
  buffer_load_dwordx4 a[240:243], v252, s[24:27], s4 offen offset:3072 sc1
  v_mfma_f32_16x16x32_bf16 v[108:111], a[148:151], v[148:151], v[108:111]
  v_exp_f32 v79, v79
  v_mfma_f32_16x16x32_bf16 v[108:111], a[144:147], v[144:147], v[108:111]
  ds_read_b64_tr_b16 a[166:167], v216 offset:45056
  v_cvt_pk_bf16_f32 v75, v78, v79
  v_mfma_f32_16x16x32_bf16 v[116:119], a[144:147], v[160:163], v[200:203]
  v_exp_f32 v84, v84
  v_mfma_f32_16x16x32_bf16 v[116:119], a[148:151], v[164:167], v[116:119]
  ds_read_b64_tr_b16 a[168:169], v217 offset:32768
  v_mfma_f32_16x16x32_bf16 v[116:119], a[152:155], v[168:171], v[116:119]
  v_exp_f32 v85, v85
  v_mfma_f32_16x16x32_bf16 v[116:119], a[156:159], v[172:175], v[116:119]
  ds_read_b64_tr_b16 a[170:171], v217 offset:36864
  v_cvt_pk_bf16_f32 v82, v84, v85
  v_mfma_f32_16x16x32_bf16 v[124:127], a[156:159], v[188:191], v[204:207]
  v_exp_f32 v86, v86
  v_mfma_f32_16x16x32_bf16 v[124:127], a[152:155], v[184:187], v[124:127]
  ds_read_b64_tr_b16 a[172:173], v217 offset:40960
  buffer_load_dwordx4 a[244:247], v253, s[24:27], s4 offen offset:0 sc1
  v_mfma_f32_16x16x32_bf16 v[124:127], a[148:151], v[180:183], v[124:127]
  v_exp_f32 v87, v87
  v_mfma_f32_16x16x32_bf16 v[124:127], a[144:147], v[176:179], v[124:127]
  ds_read_b64_tr_b16 a[174:175], v217 offset:45056
  v_cvt_pk_bf16_f32 v83, v86, v87
  v_mfma_f32_16x16x32_bf16 a[192:195], a[208:211], v[0:3], a[192:195]
  v_exp_f32 v92, v92
  v_mfma_f32_16x16x32_bf16 a[192:195], a[208:211], v[32:35], a[192:195]
  ds_read_b64_tr_b16 a[176:177], v218 offset:32768
  v_mfma_f32_16x16x32_bf16 a[196:199], a[208:211], v[8:11], a[196:199]
  v_exp_f32 v93, v93
  v_mfma_f32_16x16x32_bf16 a[196:199], a[208:211], v[40:43], a[196:199]
  ds_read_b64_tr_b16 a[178:179], v218 offset:36864
  v_cvt_pk_bf16_f32 v90, v92, v93
  v_mfma_f32_16x16x32_bf16 a[200:203], a[208:211], v[16:19], a[200:203]
  v_exp_f32 v94, v94
  v_mfma_f32_16x16x32_bf16 a[200:203], a[208:211], v[48:51], a[200:203]
  ds_read_b64_tr_b16 a[180:181], v218 offset:40960
  buffer_load_dwordx4 a[248:251], v253, s[24:27], s4 offen offset:1024 sc1
  v_mfma_f32_16x16x32_bf16 a[204:207], a[208:211], v[24:27], a[204:207]
  s_waitcnt lgkmcnt(7)
  v_exp_f32 v95, v95
  v_mfma_f32_16x16x32_bf16 a[204:207], a[208:211], v[56:59], a[204:207]
  ds_read_b64_tr_b16 a[182:183], v218 offset:45056
  v_cvt_pk_bf16_f32 v91, v94, v95
  v_mfma_f32_16x16x32_bf16 a[0:3], a[160:163], v[0:3], a[0:3]
  v_exp_f32 v96, v96
  v_mfma_f32_16x16x32_bf16 a[0:3], a[164:167], v[32:35], a[0:3]
  ds_read_b64_tr_b16 a[184:185], v219 offset:32768
  v_mfma_f32_16x16x32_bf16 a[4:7], a[164:167], v[40:43], a[4:7]
  v_exp_f32 v97, v97
  v_mfma_f32_16x16x32_bf16 a[4:7], a[160:163], v[8:11], a[4:7]
  ds_read_b64_tr_b16 a[186:187], v219 offset:36864
  v_cvt_pk_bf16_f32 v96, v96, v97
  v_mfma_f32_16x16x32_bf16 a[8:11], a[160:163], v[16:19], a[8:11]
  v_exp_f32 v98, v98
  v_mfma_f32_16x16x32_bf16 a[8:11], a[164:167], v[48:51], a[8:11]
  ds_read_b64_tr_b16 a[188:189], v219 offset:40960
  buffer_load_dwordx4 a[252:255], v253, s[24:27], s4 offen offset:2048 sc1
  v_mfma_f32_16x16x32_bf16 a[12:15], a[164:167], v[56:59], a[12:15]
  s_waitcnt lgkmcnt(7)
  v_exp_f32 v99, v99
  v_mfma_f32_16x16x32_bf16 a[12:15], a[160:163], v[24:27], a[12:15]
  ds_read_b64_tr_b16 a[190:191], v219 offset:45056
  v_cvt_pk_bf16_f32 v97, v98, v99
  v_mfma_f32_16x16x32_bf16 a[16:19], a[168:171], v[0:3], a[16:19]
  v_exp_f32 v104, v104
  v_mfma_f32_16x16x32_bf16 a[16:19], a[172:175], v[32:35], a[16:19]
  ds_read_b64_tr_b16 a[160:161], v220 offset:32768
  v_mfma_f32_16x16x32_bf16 a[20:23], a[172:175], v[40:43], a[20:23]
  v_exp_f32 v105, v105
  v_mfma_f32_16x16x32_bf16 a[20:23], a[168:171], v[8:11], a[20:23]
  ds_read_b64_tr_b16 a[162:163], v220 offset:36864
  v_cvt_pk_bf16_f32 v104, v104, v105
  v_mfma_f32_16x16x32_bf16 a[24:27], a[168:171], v[16:19], a[24:27]
  v_exp_f32 v106, v106
  v_mfma_f32_16x16x32_bf16 a[24:27], a[172:175], v[48:51], a[24:27]
  ds_read_b64_tr_b16 a[164:165], v220 offset:40960
  v_mfma_f32_16x16x32_bf16 a[28:31], a[172:175], v[56:59], a[28:31]
  s_waitcnt lgkmcnt(7)
  v_exp_f32 v107, v107
  v_mfma_f32_16x16x32_bf16 a[28:31], a[168:171], v[24:27], a[28:31]
  ds_read_b64_tr_b16 a[166:167], v220 offset:45056
  v_cvt_pk_bf16_f32 v105, v106, v107
  v_mfma_f32_16x16x32_bf16 a[32:35], a[176:179], v[0:3], a[32:35]
  v_exp_f32 v112, v112
  v_mfma_f32_16x16x32_bf16 a[32:35], a[180:183], v[32:35], a[32:35]
  ds_read_b64_tr_b16 a[168:169], v221 offset:32768
  v_mfma_f32_16x16x32_bf16 a[36:39], a[180:183], v[40:43], a[36:39]
  v_exp_f32 v113, v113
  v_mfma_f32_16x16x32_bf16 a[36:39], a[176:179], v[8:11], a[36:39]
  ds_read_b64_tr_b16 a[170:171], v221 offset:36864
  v_cvt_pk_bf16_f32 v112, v112, v113
  v_mfma_f32_16x16x32_bf16 a[40:43], a[176:179], v[16:19], a[40:43]
  v_exp_f32 v114, v114
  v_mfma_f32_16x16x32_bf16 a[40:43], a[180:183], v[48:51], a[40:43]
  ds_read_b64_tr_b16 a[172:173], v221 offset:40960
  v_mfma_f32_16x16x32_bf16 a[44:47], a[180:183], v[56:59], a[44:47]
  s_waitcnt lgkmcnt(7)
  v_exp_f32 v115, v115
  v_mfma_f32_16x16x32_bf16 a[44:47], a[176:179], v[24:27], a[44:47]
  ds_read_b64_tr_b16 a[174:175], v221 offset:45056
  v_cvt_pk_bf16_f32 v113, v114, v115
  v_mfma_f32_16x16x32_bf16 a[48:51], a[184:187], v[0:3], a[48:51]
  v_exp_f32 v120, v120
  v_mfma_f32_16x16x32_bf16 a[48:51], a[188:191], v[32:35], a[48:51]
  ds_read_b64_tr_b16 a[176:177], v222 offset:32768
  v_mfma_f32_16x16x32_bf16 a[52:55], a[188:191], v[40:43], a[52:55]
  v_exp_f32 v121, v121
  v_mfma_f32_16x16x32_bf16 a[52:55], a[184:187], v[8:11], a[52:55]
  ds_read_b64_tr_b16 a[178:179], v222 offset:36864
  v_cvt_pk_bf16_f32 v120, v120, v121
  v_mfma_f32_16x16x32_bf16 a[56:59], a[184:187], v[16:19], a[56:59]
  v_exp_f32 v122, v122
  v_mfma_f32_16x16x32_bf16 a[56:59], a[188:191], v[48:51], a[56:59]
  ds_read_b64_tr_b16 a[180:181], v222 offset:40960
  v_mfma_f32_16x16x32_bf16 a[60:63], a[188:191], v[56:59], a[60:63]
  s_waitcnt lgkmcnt(7)
  v_exp_f32 v123, v123
  v_mfma_f32_16x16x32_bf16 a[60:63], a[184:187], v[24:27], a[60:63]
  ds_read_b64_tr_b16 a[182:183], v222 offset:45056
  v_cvt_pk_bf16_f32 v121, v122, v123
  v_mfma_f32_16x16x32_bf16 a[64:67], a[160:163], v[0:3], a[64:67]
  v_exp_f32 v100, v100
  v_mfma_f32_16x16x32_bf16 a[64:67], a[164:167], v[32:35], a[64:67]
  ds_read_b64_tr_b16 a[184:185], v223 offset:32768
  v_mfma_f32_16x16x32_bf16 a[68:71], a[164:167], v[40:43], a[68:71]
  v_exp_f32 v101, v101
  v_mfma_f32_16x16x32_bf16 a[68:71], a[160:163], v[8:11], a[68:71]
  ds_read_b64_tr_b16 a[186:187], v223 offset:36864
  v_cvt_pk_bf16_f32 v98, v100, v101
  v_mfma_f32_16x16x32_bf16 a[72:75], a[160:163], v[16:19], a[72:75]
  v_exp_f32 v102, v102
  v_mfma_f32_16x16x32_bf16 a[72:75], a[164:167], v[48:51], a[72:75]
  ds_read_b64_tr_b16 a[188:189], v223 offset:40960
  v_mfma_f32_16x16x32_bf16 a[76:79], a[164:167], v[56:59], a[76:79]
  s_waitcnt lgkmcnt(7)
  v_exp_f32 v103, v103
  v_mfma_f32_16x16x32_bf16 a[76:79], a[160:163], v[24:27], a[76:79]
  ds_read_b64_tr_b16 a[190:191], v223 offset:45056
  v_cvt_pk_bf16_f32 v99, v102, v103
  v_mfma_f32_16x16x32_bf16 a[80:83], a[168:171], v[0:3], a[80:83]
  s_waitcnt vmcnt(14)
  v_exp_f32 v108, v108
  v_mfma_f32_16x16x32_bf16 a[80:83], a[172:175], v[32:35], a[80:83]
  v_mfma_f32_16x16x32_bf16 a[84:87], a[172:175], v[40:43], a[84:87]
  s_barrier
  v_exp_f32 v109, v109
  v_mfma_f32_16x16x32_bf16 a[84:87], a[168:171], v[8:11], a[84:87]
  s_mul_i32 s39, s99, 13108
  s_lshr_b32 s39, s39, 16
  s_lshl_b32 s39, s39, 8
  v_cvt_pk_bf16_f32 v106, v108, v109
  v_mfma_f32_16x16x32_bf16 a[88:91], a[168:171], v[16:19], a[88:91]
  s_add_u32 s39, s39, 2822400
  s_cmp_lt_u32 s2, 240
  s_cselect_b32 s48, 0, 1073741824
  v_exp_f32 v110, v110
  v_mfma_f32_16x16x32_bf16 a[88:91], a[172:175], v[48:51], a[88:91]
  v_or_b32 v249, s48, v251
  v_mfma_f32_16x16x32_bf16 a[92:95], a[172:175], v[56:59], a[92:95]
  s_waitcnt lgkmcnt(4)
  v_exp_f32 v111, v111
  v_mfma_f32_16x16x32_bf16 a[92:95], a[168:171], v[24:27], a[92:95]
  buffer_atomic_add v250, v249, s[24:27], s39 offen
  v_cvt_pk_bf16_f32 v107, v110, v111
  v_mfma_f32_16x16x32_bf16 a[96:99], a[176:179], v[0:3], a[96:99]
  v_exp_f32 v116, v116
  v_mfma_f32_16x16x32_bf16 a[96:99], a[180:183], v[32:35], a[96:99]
  v_mfma_f32_16x16x32_bf16 a[100:103], a[180:183], v[40:43], a[100:103]
  v_exp_f32 v117, v117
  v_mfma_f32_16x16x32_bf16 a[100:103], a[176:179], v[8:11], a[100:103]
  v_cvt_pk_bf16_f32 v114, v116, v117
  v_mfma_f32_16x16x32_bf16 a[104:107], a[176:179], v[16:19], a[104:107]
  v_exp_f32 v118, v118
  v_mfma_f32_16x16x32_bf16 a[104:107], a[180:183], v[48:51], a[104:107]
  v_mfma_f32_16x16x32_bf16 a[108:111], a[180:183], v[56:59], a[108:111]
  s_waitcnt lgkmcnt(0)
  v_exp_f32 v119, v119
  v_mfma_f32_16x16x32_bf16 a[108:111], a[176:179], v[24:27], a[108:111]
  v_cvt_pk_bf16_f32 v115, v118, v119
  v_mfma_f32_16x16x32_bf16 a[112:115], a[184:187], v[0:3], a[112:115]
  v_exp_f32 v124, v124
  v_mfma_f32_16x16x32_bf16 a[112:115], a[188:191], v[32:35], a[112:115]
  v_mfma_f32_16x16x32_bf16 a[116:119], a[188:191], v[40:43], a[116:119]
  v_exp_f32 v125, v125
  v_mfma_f32_16x16x32_bf16 a[116:119], a[184:187], v[8:11], a[116:119]
  v_cvt_pk_bf16_f32 v122, v124, v125
  v_mfma_f32_16x16x32_bf16 a[120:123], a[184:187], v[16:19], a[120:123]
  v_exp_f32 v126, v126
  v_mfma_f32_16x16x32_bf16 a[120:123], a[188:191], v[48:51], a[120:123]
  v_mfma_f32_16x16x32_bf16 a[124:127], a[188:191], v[56:59], a[124:127]
  v_exp_f32 v127, v127
  v_mfma_f32_16x16x32_bf16 a[124:127], a[184:187], v[24:27], a[124:127]
  v_cvt_pk_bf16_f32 v123, v126, v127
  ds_read_b64_tr_b16 a[160:161], v216 offset:49152
  ds_read_b64_tr_b16 a[162:163], v216 offset:53248
  ds_read_b64_tr_b16 a[164:165], v216 offset:57344
  ds_read_b64_tr_b16 a[166:167], v216 offset:61440
  ds_read_b64_tr_b16 a[168:169], v217 offset:49152
  ds_read_b64_tr_b16 a[170:171], v217 offset:53248
  ds_read_b64_tr_b16 a[172:173], v217 offset:57344
  ds_read_b64_tr_b16 a[174:175], v217 offset:61440
  s_mov_b32 s48, 0x5d800000
  s_lshl_b32 s39, s3, 8
  v_mfma_f32_16x16x32_bf16 a[192:195], a[208:211], v[64:67], a[192:195]
  s_add_u32 m0, s28, 81920
  v_mfma_f32_16x16x32_bf16 a[192:195], a[208:211], v[96:99], a[192:195]
  v_mfma_f32_16x16x32_bf16 a[196:199], a[208:211], v[72:75], a[196:199]
  buffer_load_dwordx4 v242, s[24:27], s10 offen offset:0 sc1 lds
  v_mfma_f32_16x16x32_bf16 a[196:199], a[208:211], v[104:107], a[196:199]
  v_mfma_f32_16x16x32_bf16 a[200:203], a[208:211], v[80:83], a[200:203]
  buffer_load_dwordx4 v242, s[24:27], s10 offen offset:1024 sc1 lds
  v_mfma_f32_16x16x32_bf16 a[200:203], a[208:211], v[112:115], a[200:203]
  v_mfma_f32_16x16x32_bf16 a[204:207], a[208:211], v[88:91], a[204:207]
  buffer_load_dwordx4 v242, s[24:27], s10 offen offset:2048 sc1 lds
  v_mfma_f32_16x16x32_bf16 a[204:207], a[208:211], v[120:123], a[204:207]
  s_waitcnt lgkmcnt(4)
  v_mfma_f32_16x16x32_bf16 a[0:3], a[160:163], v[64:67], a[0:3]
  buffer_load_dwordx4 v242, s[24:27], s10 offen offset:3072 sc1 lds
  v_mfma_f32_16x16x32_bf16 a[0:3], a[164:167], v[96:99], a[0:3]
  ds_read_b64_tr_b16 a[176:177], v218 offset:49152
  v_mfma_f32_16x16x32_bf16 a[4:7], a[164:167], v[104:107], a[4:7]
  buffer_load_dwordx4 a[128:131], v253, s[24:27], s4 offen offset:3072 sc1
  v_mfma_f32_16x16x32_bf16 a[4:7], a[160:163], v[72:75], a[4:7]
  ds_read_b64_tr_b16 a[178:179], v218 offset:53248
  v_accvgpr_read_b32 v208, a192
  v_mfma_f32_16x16x32_bf16 a[8:11], a[160:163], v[80:83], a[8:11]
  v_accvgpr_read_b32 v209, a196
  v_accvgpr_read_b32 v210, a200
  v_mfma_f32_16x16x32_bf16 a[8:11], a[164:167], v[112:115], a[8:11]
  ds_read_b64_tr_b16 a[180:181], v218 offset:57344
  v_accvgpr_read_b32 v211, a204
  v_mfma_f32_16x16x32_bf16 a[12:15], a[164:167], v[120:123], a[12:15]
  v_mov_b32 v245, v208
  v_mov_b32 v246, v209
  v_mfma_f32_16x16x32_bf16 a[12:15], a[160:163], v[88:91], a[12:15]
  ds_read_b64_tr_b16 a[182:183], v218 offset:61440
  s_waitcnt lgkmcnt(4)
  v_mov_b32 v247, v210
  v_mfma_f32_16x16x32_bf16 a[16:19], a[168:171], v[64:67], a[16:19]
  v_mov_b32 v248, v211
  v_permlane16_swap_b32 v208, v245
  v_mfma_f32_16x16x32_bf16 a[16:19], a[172:175], v[96:99], a[16:19]
  ds_read_b64_tr_b16 a[184:185], v219 offset:49152
  v_permlane16_swap_b32 v209, v246
  v_mfma_f32_16x16x32_bf16 a[20:23], a[172:175], v[104:107], a[20:23]
  v_permlane16_swap_b32 v210, v247
  v_permlane16_swap_b32 v211, v248
  v_mfma_f32_16x16x32_bf16 a[20:23], a[168:171], v[72:75], a[20:23]
  ds_read_b64_tr_b16 a[186:187], v219 offset:53248
  v_add_f32 v208, v208, v245
  v_mfma_f32_16x16x32_bf16 a[24:27], a[168:171], v[80:83], a[24:27]
  v_add_f32 v209, v209, v246
  v_add_f32 v210, v210, v247
  v_mfma_f32_16x16x32_bf16 a[24:27], a[172:175], v[112:115], a[24:27]
  ds_read_b64_tr_b16 a[188:189], v219 offset:57344
  v_add_f32 v211, v211, v248
  v_mfma_f32_16x16x32_bf16 a[28:31], a[172:175], v[120:123], a[28:31]
  v_mov_b32 v245, v208
  v_mov_b32 v246, v209
  v_mfma_f32_16x16x32_bf16 a[28:31], a[168:171], v[88:91], a[28:31]
  ds_read_b64_tr_b16 a[190:191], v219 offset:61440
  s_waitcnt lgkmcnt(4)
  v_mov_b32 v247, v210
  v_mfma_f32_16x16x32_bf16 a[32:35], a[176:179], v[64:67], a[32:35]
  v_mov_b32 v248, v211
  v_permlane32_swap_b32 v208, v245
  v_mfma_f32_16x16x32_bf16 a[32:35], a[180:183], v[96:99], a[32:35]
  ds_read_b64_tr_b16 a[160:161], v220 offset:49152
  v_permlane32_swap_b32 v209, v246
  v_mfma_f32_16x16x32_bf16 a[36:39], a[180:183], v[104:107], a[36:39]
  v_permlane32_swap_b32 v210, v247
  v_permlane32_swap_b32 v211, v248
  v_mfma_f32_16x16x32_bf16 a[36:39], a[176:179], v[72:75], a[36:39]
  ds_read_b64_tr_b16 a[162:163], v220 offset:53248
  v_add_f32 v208, v208, v245
  v_mfma_f32_16x16x32_bf16 a[40:43], a[176:179], v[80:83], a[40:43]
  v_add_f32 v209, v209, v246
  v_add_f32 v210, v210, v247
  v_mfma_f32_16x16x32_bf16 a[40:43], a[180:183], v[112:115], a[40:43]
  ds_read_b64_tr_b16 a[164:165], v220 offset:57344
  v_add_f32 v211, v211, v248
  buffer_load_dwordx4 a[132:135], v242, s[24:27], s5 offen offset:0 sc1
  buffer_load_dwordx4 a[136:139], v242, s[24:27], s5 offen offset:1024 sc1
  buffer_load_dwordx4 a[140:143], v242, s[24:27], s5 offen offset:2048 sc1
  buffer_load_dwordx4 a[144:147], v242, s[24:27], s5 offen offset:3072 sc1
  buffer_load_dwordx4 a[148:151], v252, s[24:27], s5 offen offset:0 sc1
  buffer_load_dwordx4 a[152:155], v252, s[24:27], s5 offen offset:1024 sc1
  buffer_load_dwordx4 a[156:159], v252, s[24:27], s5 offen offset:2048 sc1
  v_mfma_f32_16x16x32_bf16 a[44:47], a[180:183], v[120:123], a[44:47]
  v_rcp_f32 v192, v208
  v_mfma_f32_16x16x32_bf16 a[44:47], a[176:179], v[88:91], a[44:47]
  ds_read_b64_tr_b16 a[166:167], v220 offset:61440
  s_waitcnt lgkmcnt(4)
  v_mfma_f32_16x16x32_bf16 a[48:51], a[184:187], v[64:67], a[48:51]
  v_rcp_f32 v196, v209
  v_mfma_f32_16x16x32_bf16 a[48:51], a[188:191], v[96:99], a[48:51]
  ds_read_b64_tr_b16 a[168:169], v221 offset:49152
  v_mfma_f32_16x16x32_bf16 a[52:55], a[188:191], v[104:107], a[52:55]
  v_rcp_f32 v200, v210
  v_mfma_f32_16x16x32_bf16 a[52:55], a[184:187], v[72:75], a[52:55]
  ds_read_b64_tr_b16 a[170:171], v221 offset:53248
  v_mfma_f32_16x16x32_bf16 a[56:59], a[184:187], v[80:83], a[56:59]
  v_rcp_f32 v204, v211
  v_mfma_f32_16x16x32_bf16 a[56:59], a[188:191], v[112:115], a[56:59]
  ds_read_b64_tr_b16 a[172:173], v221 offset:57344
  v_add_f32 v246, v208, v209
  v_mfma_f32_16x16x32_bf16 a[60:63], a[188:191], v[120:123], a[60:63]
  v_add_f32 v247, v210, v211
  v_add_f32 v246, v246, v247
  v_mfma_f32_16x16x32_bf16 a[60:63], a[184:187], v[88:91], a[60:63]
  ds_read_b64_tr_b16 a[174:175], v221 offset:61440
  s_waitcnt lgkmcnt(4)
  v_lshrrev_b32 v247, 2, v242
  v_mfma_f32_16x16x32_bf16 a[64:67], a[160:163], v[64:67], a[64:67]
  v_cmp_nlt_f32 vcc, v246, s48
  v_add_u32 v247, s39, v247
  v_mfma_f32_16x16x32_bf16 a[64:67], a[164:167], v[96:99], a[64:67]
  ds_read_b64_tr_b16 a[176:177], v222 offset:49152
  v_add_u32 v247, 157696, v247
  v_mfma_f32_16x16x32_bf16 a[68:71], a[164:167], v[104:107], a[68:71]
  v_cndmask_b32_e64 v245, 0, 1, vcc
  v_accvgpr_read_b32 v0, a0
  v_mfma_f32_16x16x32_bf16 a[68:71], a[160:163], v[72:75], a[68:71]
  ds_read_b64_tr_b16 a[178:179], v222 offset:53248
  v_accvgpr_read_b32 v1, a1
  v_mfma_f32_16x16x32_bf16 a[72:75], a[160:163], v[80:83], a[72:75]
  v_accvgpr_read_b32 v2, a2
  v_accvgpr_read_b32 v3, a3
  v_mfma_f32_16x16x32_bf16 a[72:75], a[164:167], v[112:115], a[72:75]
  ds_read_b64_tr_b16 a[180:181], v222 offset:57344
  v_accvgpr_read_b32 v4, a16
  v_mfma_f32_16x16x32_bf16 a[76:79], a[164:167], v[120:123], a[76:79]
  v_accvgpr_read_b32 v5, a17
  v_accvgpr_read_b32 v6, a18
  v_mfma_f32_16x16x32_bf16 a[76:79], a[160:163], v[88:91], a[76:79]
  ds_read_b64_tr_b16 a[182:183], v222 offset:61440
  s_waitcnt lgkmcnt(4)
  v_accvgpr_read_b32 v7, a19
  v_mfma_f32_16x16x32_bf16 a[80:83], a[168:171], v[64:67], a[80:83]
  v_mul_f32 v0, v0, v192
  v_mul_f32 v1, v1, v192
  v_mfma_f32_16x16x32_bf16 a[80:83], a[172:175], v[96:99], a[80:83]
  ds_read_b64_tr_b16 a[184:185], v223 offset:49152
  v_mul_f32 v2, v2, v192
  v_mfma_f32_16x16x32_bf16 a[84:87], a[172:175], v[104:107], a[84:87]
  v_mul_f32 v3, v3, v192
  v_mul_f32 v4, v4, v192
  v_mfma_f32_16x16x32_bf16 a[84:87], a[168:171], v[72:75], a[84:87]
  ds_read_b64_tr_b16 a[186:187], v223 offset:53248
  v_mul_f32 v5, v5, v192
  v_mfma_f32_16x16x32_bf16 a[88:91], a[168:171], v[80:83], a[88:91]
  v_mul_f32 v6, v6, v192
  v_mul_f32 v7, v7, v192
  v_mfma_f32_16x16x32_bf16 a[88:91], a[172:175], v[112:115], a[88:91]
  ds_read_b64_tr_b16 a[188:189], v223 offset:57344
  v_cvt_pk_bf16_f32 v0, v0, v1
  v_mfma_f32_16x16x32_bf16 a[92:95], a[172:175], v[120:123], a[92:95]
  v_cvt_pk_bf16_f32 v1, v2, v3
  v_cvt_pk_bf16_f32 v2, v4, v5
  v_mfma_f32_16x16x32_bf16 a[92:95], a[168:171], v[88:91], a[92:95]
  ds_read_b64_tr_b16 a[190:191], v223 offset:61440
  s_waitcnt lgkmcnt(4)
  v_cvt_pk_bf16_f32 v3, v6, v7
  v_mfma_f32_16x16x32_bf16 a[96:99], a[176:179], v[64:67], a[96:99]
  buffer_store_dwordx4 v[0:3], v244, s[24:27], s40 offen offset:0 sc1
  v_mfma_f32_16x16x32_bf16 a[96:99], a[180:183], v[96:99], a[96:99]
  v_accvgpr_read_b32 v8, a4
  v_accvgpr_read_b32 v9, a5
  v_mfma_f32_16x16x32_bf16 a[100:103], a[180:183], v[104:107], a[100:103]
  v_accvgpr_read_b32 v10, a6
  v_accvgpr_read_b32 v11, a7
  v_mfma_f32_16x16x32_bf16 a[100:103], a[176:179], v[72:75], a[100:103]
  v_accvgpr_read_b32 v12, a20
  v_accvgpr_read_b32 v13, a21
  v_mfma_f32_16x16x32_bf16 a[104:107], a[176:179], v[80:83], a[104:107]
  v_accvgpr_read_b32 v14, a22
  v_accvgpr_read_b32 v15, a23
  v_mfma_f32_16x16x32_bf16 a[104:107], a[180:183], v[112:115], a[104:107]
  v_mul_f32 v8, v8, v196
  v_mul_f32 v9, v9, v196
  v_mfma_f32_16x16x32_bf16 a[108:111], a[180:183], v[120:123], a[108:111]
  v_mul_f32 v10, v10, v196
  v_mul_f32 v11, v11, v196
  v_mfma_f32_16x16x32_bf16 a[108:111], a[176:179], v[88:91], a[108:111]
  s_waitcnt lgkmcnt(0)
  v_mul_f32 v12, v12, v196
  v_mul_f32 v13, v13, v196
  v_mfma_f32_16x16x32_bf16 a[112:115], a[184:187], v[64:67], a[112:115]
  v_mul_f32 v14, v14, v196
  v_mul_f32 v15, v15, v196
  v_mfma_f32_16x16x32_bf16 a[112:115], a[188:191], v[96:99], a[112:115]
  v_cvt_pk_bf16_f32 v8, v8, v9
  v_cvt_pk_bf16_f32 v9, v10, v11
  v_mfma_f32_16x16x32_bf16 a[116:119], a[188:191], v[104:107], a[116:119]
  v_cvt_pk_bf16_f32 v10, v12, v13
  v_cvt_pk_bf16_f32 v11, v14, v15
  v_mfma_f32_16x16x32_bf16 a[116:119], a[184:187], v[72:75], a[116:119]
  buffer_store_dwordx4 v[8:11], v244, s[24:27], s40 offen offset:2048 sc1
  v_mfma_f32_16x16x32_bf16 a[120:123], a[184:187], v[80:83], a[120:123]
  v_accvgpr_read_b32 v16, a8
  v_accvgpr_read_b32 v17, a9
  v_mfma_f32_16x16x32_bf16 a[120:123], a[188:191], v[112:115], a[120:123]
  v_accvgpr_read_b32 v18, a10
  v_accvgpr_read_b32 v19, a11
  v_mfma_f32_16x16x32_bf16 a[124:127], a[188:191], v[120:123], a[124:127]
  v_accvgpr_read_b32 v20, a24
  v_accvgpr_read_b32 v21, a25
  v_mfma_f32_16x16x32_bf16 a[124:127], a[184:187], v[88:91], a[124:127]
  v_accvgpr_read_b32 v22, a26
  v_accvgpr_read_b32 v23, a27
  v_pk_mul_f32 v[16:17], v[16:17], v[200:201] op_sel_hi:[1,0]
  v_pk_mul_f32 v[18:19], v[18:19], v[200:201] op_sel_hi:[1,0]
  v_pk_mul_f32 v[20:21], v[20:21], v[200:201] op_sel_hi:[1,0]
  v_pk_mul_f32 v[22:23], v[22:23], v[200:201] op_sel_hi:[1,0]
  v_cvt_pk_bf16_f32 v16, v16, v17
  v_cvt_pk_bf16_f32 v17, v18, v19
  v_cvt_pk_bf16_f32 v18, v20, v21
  v_cvt_pk_bf16_f32 v19, v22, v23
  buffer_store_dwordx4 v[16:19], v244, s[24:27], s41 offen offset:0 sc1
  v_accvgpr_read_b32 v24, a12
  v_accvgpr_read_b32 v25, a13
  v_accvgpr_read_b32 v26, a14
  v_accvgpr_read_b32 v27, a15
  v_accvgpr_read_b32 v28, a28
  v_accvgpr_read_b32 v29, a29
  v_accvgpr_read_b32 v30, a30
  v_accvgpr_read_b32 v31, a31
  v_pk_mul_f32 v[24:25], v[24:25], v[204:205] op_sel_hi:[1,0]
  v_pk_mul_f32 v[26:27], v[26:27], v[204:205] op_sel_hi:[1,0]
  v_pk_mul_f32 v[28:29], v[28:29], v[204:205] op_sel_hi:[1,0]
  v_pk_mul_f32 v[30:31], v[30:31], v[204:205] op_sel_hi:[1,0]
  v_cvt_pk_bf16_f32 v24, v24, v25
  v_cvt_pk_bf16_f32 v25, v26, v27
  v_cvt_pk_bf16_f32 v26, v28, v29
  v_cvt_pk_bf16_f32 v27, v30, v31
  buffer_store_dwordx4 v[24:27], v244, s[24:27], s41 offen offset:2048 sc1
  v_accvgpr_read_b32 v32, a32
  v_accvgpr_read_b32 v33, a33
  v_accvgpr_read_b32 v34, a34
  v_accvgpr_read_b32 v35, a35
  v_accvgpr_read_b32 v36, a48
  v_accvgpr_read_b32 v37, a49
  v_accvgpr_read_b32 v38, a50
  v_accvgpr_read_b32 v39, a51
  v_pk_mul_f32 v[32:33], v[32:33], v[192:193] op_sel_hi:[1,0]
  v_pk_mul_f32 v[34:35], v[34:35], v[192:193] op_sel_hi:[1,0]
  v_pk_mul_f32 v[36:37], v[36:37], v[192:193] op_sel_hi:[1,0]
  v_pk_mul_f32 v[38:39], v[38:39], v[192:193] op_sel_hi:[1,0]
  v_cvt_pk_bf16_f32 v32, v32, v33
  v_cvt_pk_bf16_f32 v33, v34, v35
  v_cvt_pk_bf16_f32 v34, v36, v37
  v_cvt_pk_bf16_f32 v35, v38, v39
  buffer_store_dwordx4 v[32:35], v244, s[24:27], s40 offen offset:1024 sc1
  v_accvgpr_read_b32 v40, a36
  v_accvgpr_read_b32 v41, a37
  v_accvgpr_read_b32 v42, a38
  v_accvgpr_read_b32 v43, a39
  v_accvgpr_read_b32 v44, a52
  v_accvgpr_read_b32 v45, a53
  v_accvgpr_read_b32 v46, a54
  v_accvgpr_read_b32 v47, a55
  v_pk_mul_f32 v[40:41], v[40:41], v[196:197] op_sel_hi:[1,0]
  v_pk_mul_f32 v[42:43], v[42:43], v[196:197] op_sel_hi:[1,0]
  v_pk_mul_f32 v[44:45], v[44:45], v[196:197] op_sel_hi:[1,0]
  v_pk_mul_f32 v[46:47], v[46:47], v[196:197] op_sel_hi:[1,0]
  v_cvt_pk_bf16_f32 v40, v40, v41
  v_cvt_pk_bf16_f32 v41, v42, v43
  v_cvt_pk_bf16_f32 v42, v44, v45
  v_cvt_pk_bf16_f32 v43, v46, v47
  buffer_store_dwordx4 v[40:43], v244, s[24:27], s40 offen offset:3072 sc1
  v_accvgpr_read_b32 v48, a40
  v_accvgpr_read_b32 v49, a41
  v_accvgpr_read_b32 v50, a42
  v_accvgpr_read_b32 v51, a43
  v_accvgpr_read_b32 v52, a56
  v_accvgpr_read_b32 v53, a57
  v_accvgpr_read_b32 v54, a58
  v_accvgpr_read_b32 v55, a59
  v_pk_mul_f32 v[48:49], v[48:49], v[200:201] op_sel_hi:[1,0]
  v_pk_mul_f32 v[50:51], v[50:51], v[200:201] op_sel_hi:[1,0]
  v_pk_mul_f32 v[52:53], v[52:53], v[200:201] op_sel_hi:[1,0]
  v_pk_mul_f32 v[54:55], v[54:55], v[200:201] op_sel_hi:[1,0]
  v_cvt_pk_bf16_f32 v48, v48, v49
  v_cvt_pk_bf16_f32 v49, v50, v51
  v_cvt_pk_bf16_f32 v50, v52, v53
  v_cvt_pk_bf16_f32 v51, v54, v55
  buffer_store_dwordx4 v[48:51], v244, s[24:27], s41 offen offset:1024 sc1
  v_accvgpr_read_b32 v56, a44
  v_accvgpr_read_b32 v57, a45
  v_accvgpr_read_b32 v58, a46
  v_accvgpr_read_b32 v59, a47
  v_accvgpr_read_b32 v60, a60
  v_accvgpr_read_b32 v61, a61
  v_accvgpr_read_b32 v62, a62
  v_accvgpr_read_b32 v63, a63
  v_pk_mul_f32 v[56:57], v[56:57], v[204:205] op_sel_hi:[1,0]
  v_pk_mul_f32 v[58:59], v[58:59], v[204:205] op_sel_hi:[1,0]
  v_pk_mul_f32 v[60:61], v[60:61], v[204:205] op_sel_hi:[1,0]
  v_pk_mul_f32 v[62:63], v[62:63], v[204:205] op_sel_hi:[1,0]
  v_cvt_pk_bf16_f32 v56, v56, v57
  v_cvt_pk_bf16_f32 v57, v58, v59
  v_cvt_pk_bf16_f32 v58, v60, v61
  v_cvt_pk_bf16_f32 v59, v62, v63
  buffer_store_dwordx4 v[56:59], v244, s[24:27], s41 offen offset:3072 sc1
  v_accvgpr_read_b32 v0, a64
  v_accvgpr_read_b32 v1, a65
  v_accvgpr_read_b32 v2, a66
  v_accvgpr_read_b32 v3, a67
  v_accvgpr_read_b32 v4, a80
  v_accvgpr_read_b32 v5, a81
  v_accvgpr_read_b32 v6, a82
  v_accvgpr_read_b32 v7, a83
  v_pk_mul_f32 v[0:1], v[0:1], v[192:193] op_sel_hi:[1,0]
  v_pk_mul_f32 v[2:3], v[2:3], v[192:193] op_sel_hi:[1,0]
  v_pk_mul_f32 v[4:5], v[4:5], v[192:193] op_sel_hi:[1,0]
  v_pk_mul_f32 v[6:7], v[6:7], v[192:193] op_sel_hi:[1,0]
  v_cvt_pk_bf16_f32 v0, v0, v1
  v_cvt_pk_bf16_f32 v1, v2, v3
  v_cvt_pk_bf16_f32 v2, v4, v5
  v_cvt_pk_bf16_f32 v3, v6, v7
  buffer_store_dwordx4 v[0:3], v244, s[24:27], s42 offen offset:0 sc1
  v_accvgpr_read_b32 v8, a68
  v_accvgpr_read_b32 v9, a69
  v_accvgpr_read_b32 v10, a70
  v_accvgpr_read_b32 v11, a71
  v_accvgpr_read_b32 v12, a84
  v_accvgpr_read_b32 v13, a85
  v_accvgpr_read_b32 v14, a86
  v_accvgpr_read_b32 v15, a87
  v_pk_mul_f32 v[8:9], v[8:9], v[196:197] op_sel_hi:[1,0]
  v_pk_mul_f32 v[10:11], v[10:11], v[196:197] op_sel_hi:[1,0]
  v_pk_mul_f32 v[12:13], v[12:13], v[196:197] op_sel_hi:[1,0]
  v_pk_mul_f32 v[14:15], v[14:15], v[196:197] op_sel_hi:[1,0]
  v_cvt_pk_bf16_f32 v8, v8, v9
  v_cvt_pk_bf16_f32 v9, v10, v11
  v_cvt_pk_bf16_f32 v10, v12, v13
  v_cvt_pk_bf16_f32 v11, v14, v15
  buffer_store_dwordx4 v[8:11], v244, s[24:27], s42 offen offset:2048 sc1
  v_accvgpr_read_b32 v16, a72
  v_accvgpr_read_b32 v17, a73
  v_accvgpr_read_b32 v18, a74
  v_accvgpr_read_b32 v19, a75
  v_accvgpr_read_b32 v20, a88
  v_accvgpr_read_b32 v21, a89
  v_accvgpr_read_b32 v22, a90
  v_accvgpr_read_b32 v23, a91
  v_pk_mul_f32 v[16:17], v[16:17], v[200:201] op_sel_hi:[1,0]
  v_pk_mul_f32 v[18:19], v[18:19], v[200:201] op_sel_hi:[1,0]
  v_pk_mul_f32 v[20:21], v[20:21], v[200:201] op_sel_hi:[1,0]
  v_pk_mul_f32 v[22:23], v[22:23], v[200:201] op_sel_hi:[1,0]
  v_cvt_pk_bf16_f32 v16, v16, v17
  v_cvt_pk_bf16_f32 v17, v18, v19
  v_cvt_pk_bf16_f32 v18, v20, v21
  v_cvt_pk_bf16_f32 v19, v22, v23
  buffer_store_dwordx4 v[16:19], v244, s[24:27], s43 offen offset:0 sc1
  v_accvgpr_read_b32 v24, a76
  v_accvgpr_read_b32 v25, a77
  v_accvgpr_read_b32 v26, a78
  v_accvgpr_read_b32 v27, a79
  v_accvgpr_read_b32 v28, a92
  v_accvgpr_read_b32 v29, a93
  v_accvgpr_read_b32 v30, a94
  v_accvgpr_read_b32 v31, a95
  v_pk_mul_f32 v[24:25], v[24:25], v[204:205] op_sel_hi:[1,0]
  v_pk_mul_f32 v[26:27], v[26:27], v[204:205] op_sel_hi:[1,0]
  v_pk_mul_f32 v[28:29], v[28:29], v[204:205] op_sel_hi:[1,0]
  v_pk_mul_f32 v[30:31], v[30:31], v[204:205] op_sel_hi:[1,0]
  v_cvt_pk_bf16_f32 v24, v24, v25
  v_cvt_pk_bf16_f32 v25, v26, v27
  v_cvt_pk_bf16_f32 v26, v28, v29
  v_cvt_pk_bf16_f32 v27, v30, v31
  buffer_store_dwordx4 v[24:27], v244, s[24:27], s43 offen offset:2048 sc1
  v_accvgpr_read_b32 v32, a96
  v_accvgpr_read_b32 v33, a97
  v_accvgpr_read_b32 v34, a98
  v_accvgpr_read_b32 v35, a99
  v_accvgpr_read_b32 v36, a112
  v_accvgpr_read_b32 v37, a113
  v_accvgpr_read_b32 v38, a114
  v_accvgpr_read_b32 v39, a115
  v_pk_mul_f32 v[32:33], v[32:33], v[192:193] op_sel_hi:[1,0]
  v_pk_mul_f32 v[34:35], v[34:35], v[192:193] op_sel_hi:[1,0]
  v_pk_mul_f32 v[36:37], v[36:37], v[192:193] op_sel_hi:[1,0]
  v_pk_mul_f32 v[38:39], v[38:39], v[192:193] op_sel_hi:[1,0]
  v_cvt_pk_bf16_f32 v32, v32, v33
  v_cvt_pk_bf16_f32 v33, v34, v35
  v_cvt_pk_bf16_f32 v34, v36, v37
  v_cvt_pk_bf16_f32 v35, v38, v39
  buffer_store_dwordx4 v[32:35], v244, s[24:27], s42 offen offset:1024 sc1
  v_accvgpr_read_b32 v40, a100
  v_accvgpr_read_b32 v41, a101
  v_accvgpr_read_b32 v42, a102
  v_accvgpr_read_b32 v43, a103
  v_accvgpr_read_b32 v44, a116
  v_accvgpr_read_b32 v45, a117
  v_accvgpr_read_b32 v46, a118
  v_accvgpr_read_b32 v47, a119
  v_pk_mul_f32 v[40:41], v[40:41], v[196:197] op_sel_hi:[1,0]
  v_pk_mul_f32 v[42:43], v[42:43], v[196:197] op_sel_hi:[1,0]
  v_pk_mul_f32 v[44:45], v[44:45], v[196:197] op_sel_hi:[1,0]
  v_pk_mul_f32 v[46:47], v[46:47], v[196:197] op_sel_hi:[1,0]
  v_cvt_pk_bf16_f32 v40, v40, v41
  v_cvt_pk_bf16_f32 v41, v42, v43
  v_cvt_pk_bf16_f32 v42, v44, v45
  v_cvt_pk_bf16_f32 v43, v46, v47
  buffer_store_dwordx4 v[40:43], v244, s[24:27], s42 offen offset:3072 sc1
  v_accvgpr_read_b32 v48, a104
  v_accvgpr_read_b32 v49, a105
  v_accvgpr_read_b32 v50, a106
  v_accvgpr_read_b32 v51, a107
  v_accvgpr_read_b32 v52, a120
  v_accvgpr_read_b32 v53, a121
  v_accvgpr_read_b32 v54, a122
  v_accvgpr_read_b32 v55, a123
  v_pk_mul_f32 v[48:49], v[48:49], v[200:201] op_sel_hi:[1,0]
  v_pk_mul_f32 v[50:51], v[50:51], v[200:201] op_sel_hi:[1,0]
  v_pk_mul_f32 v[52:53], v[52:53], v[200:201] op_sel_hi:[1,0]
  v_pk_mul_f32 v[54:55], v[54:55], v[200:201] op_sel_hi:[1,0]
  v_cvt_pk_bf16_f32 v48, v48, v49
  v_cvt_pk_bf16_f32 v49, v50, v51
  v_cvt_pk_bf16_f32 v50, v52, v53
  v_cvt_pk_bf16_f32 v51, v54, v55
  buffer_store_dwordx4 v[48:51], v244, s[24:27], s43 offen offset:1024 sc1
  v_accvgpr_read_b32 v56, a108
  v_accvgpr_read_b32 v57, a109
  v_accvgpr_read_b32 v58, a110
  v_accvgpr_read_b32 v59, a111
  v_accvgpr_read_b32 v60, a124
  v_accvgpr_read_b32 v61, a125
  v_accvgpr_read_b32 v62, a126
  v_accvgpr_read_b32 v63, a127
  v_pk_mul_f32 v[56:57], v[56:57], v[204:205] op_sel_hi:[1,0]
  v_pk_mul_f32 v[58:59], v[58:59], v[204:205] op_sel_hi:[1,0]
  v_pk_mul_f32 v[60:61], v[60:61], v[204:205] op_sel_hi:[1,0]
  v_pk_mul_f32 v[62:63], v[62:63], v[204:205] op_sel_hi:[1,0]
  v_cvt_pk_bf16_f32 v56, v56, v57
  v_cvt_pk_bf16_f32 v57, v58, v59
  v_cvt_pk_bf16_f32 v58, v60, v61
  v_cvt_pk_bf16_f32 v59, v62, v63
  buffer_store_dwordx4 v[56:59], v244, s[24:27], s43 offen offset:3072 sc1
  ds_write_b32 v247, v245
  buffer_load_dwordx4 a[0:3], v252, s[24:27], s5 offen offset:3072 sc1
  buffer_load_dwordx4 a[4:7], v253, s[24:27], s5 offen offset:0 sc1
  buffer_load_dwordx4 a[8:11], v253, s[24:27], s5 offen offset:1024 sc1
  buffer_load_dwordx4 a[12:15], v253, s[24:27], s5 offen offset:2048 sc1
  buffer_load_dwordx4 a[16:19], v253, s[24:27], s5 offen offset:3072 sc1
  buffer_load_dwordx4 a[20:23], v242, s[24:27], s6 offen offset:0 sc1
  buffer_load_dwordx4 a[24:27], v242, s[24:27], s6 offen offset:1024 sc1
  buffer_load_dwordx4 a[28:31], v242, s[24:27], s6 offen offset:2048 sc1
  buffer_load_dwordx4 a[32:35], v242, s[24:27], s6 offen offset:3072 sc1
  buffer_load_dwordx4 a[36:39], v252, s[24:27], s6 offen offset:0 sc1
  buffer_load_dwordx4 a[40:43], v252, s[24:27], s6 offen offset:1024 sc1
  buffer_load_dwordx4 a[44:47], v252, s[24:27], s6 offen offset:2048 sc1
  buffer_load_dwordx4 a[48:51], v252, s[24:27], s6 offen offset:3072 sc1
  buffer_load_dwordx4 a[52:55], v253, s[24:27], s6 offen offset:0 sc1
  s_bfe_u32 s39, s2, 0x40002
  s_lshl_b32 s39, s39, 8
  s_add_u32 s39, s39, 2818304
  s_lshl_b32 s38, s3, 26
  v_lshlrev_b32 v64, 22, v242
  v_or_b32 v64, s38, v64
  v_mov_b32 v65, 1
  v_add_u32 v246, 157696, v242
  s_waitcnt vmcnt(14) lgkmcnt(0)
  s_barrier
  ds_read_b128 v[68:71], v246
  s_waitcnt lgkmcnt(0)
  v_or3_b32 v68, v68, v69, v70
  v_or_b32 v68, v68, v71
  v_cmp_ne_u32 vcc, 0, v68
  s_nop 0
  s_cbranch_vccnz attn_redo
tail_go:
  buffer_atomic_add v65, v64, s[24:27], s39 offen
  s_and_b32 s36, s2, 1
  s_bfe_u32 s31, s2, 0x20001
  s_lshl_b32 s31, s31, 2
  s_bfe_u32 s38, s2, 0x20003
  s_add_u32 s31, s31, s38
  s_lshr_b32 s29, s2, 5
  v_mov_b32 v114, v242
  v_add_u32 v115, 0x1000, v114
  v_add_u32 v116, 0x2000, v114
  s_lshl_b32 s38, s36, 2
  s_add_u32 s38, s38, s3
  s_lshl_b32 s30, s38, 16
  buffer_load_dwordx4 a[56:59], v116, s[24:27], s6 offen offset:1024 sc1
  buffer_load_dwordx4 a[60:63], v116, s[24:27], s6 offen offset:2048 sc1
  buffer_load_dwordx4 a[64:67], v116, s[24:27], s6 offen offset:3072 sc1
  buffer_load_dwordx4 a[68:71], v114, s[24:27], s7 offen offset:0 sc1
  buffer_load_dwordx4 a[72:75], v114, s[24:27], s7 offen offset:1024 sc1
  buffer_load_dwordx4 a[76:79], v114, s[24:27], s7 offen offset:2048 sc1
  v_lshrrev_b32 v125, 4, v114
  v_and_b32 v126, 15, v125
  v_lshrrev_b32 v127, 4, v125
  s_add_u32 s38, s3, 0
  s_and_b32 s38, s38, 3
  s_lshl_b32 s38, s38, 11
  v_add_u32 v110, s38, v114
  s_sub_u32 s38, s3, 0
  s_and_b32 s38, s38, 3
  s_mul_i32 s38, s38, 15360
  s_add_u32 s38, s38, 98304
  v_add_u32 v118, s38, v114
  s_add_u32 s38, s3, 1
  s_and_b32 s38, s38, 3
  s_lshl_b32 s38, s38, 11
  v_add_u32 v111, s38, v114
  s_sub_u32 s38, s3, 1
  s_and_b32 s38, s38, 3
  s_mul_i32 s38, s38, 15360
  s_add_u32 s38, s38, 98304
  v_add_u32 v119, s38, v114
  s_add_u32 s38, s3, 2
  s_and_b32 s38, s38, 3
  s_lshl_b32 s38, s38, 11
  v_add_u32 v112, s38, v114
  s_sub_u32 s38, s3, 2
  s_and_b32 s38, s38, 3
  s_mul_i32 s38, s38, 15360
  s_add_u32 s38, s38, 98304
  v_add_u32 v120, s38, v114
  s_add_u32 s38, s3, 3
  s_and_b32 s38, s38, 3
  s_lshl_b32 s38, s38, 11
  v_add_u32 v113, s38, v114
  s_sub_u32 s38, s3, 3
  s_and_b32 s38, s38, 3
  s_mul_i32 s38, s38, 15360
  s_add_u32 s38, s38, 98304
  v_add_u32 v121, s38, v114
  v_add_u32 v122, s28, v114
  v_add_u32 v135, 0x10000, v122
  s_and_b32 s38, s31, 14
  s_add_u32 s38, s38, s36
  s_lshl_b32 s38, s38, 8
  s_add_u32 s38, s38, 2818304
  s_lshl_b32 s39, s29, 8
  s_add_u32 s39, s39, 2822400
  v_mov_b32 v133, s38
  v_writelane_b32 v133, s39, 1
  v_mov_b32 v134, 16
  v_writelane_b32 v134, 30, 1
  s_lshl_b32 s31, s31, 1
  s_add_u32 s31, s31, s36
  s_add_u32 s30, s30, 8388608
  s_lshl_b32 s38, s31, 19
  s_add_u32 s37, s30, s38
  s_xor_b32 s38, s38, 0x80000
  s_add_u32 s30, s30, s38
  s_lshl_b32 s40, s29, 5
  s_add_u32 s40, s40, s31
  s_lshl_b32 s38, s31, 6
  s_lshl_b32 s39, s3, 4
  s_add_u32 s38, s38, s39
  v_add_u32 v128, s38, v126
  v_mul_u32_u24 v117, 0x500, v128
  v_lshl_add_u32 v117, v127, 3, v117
  s_mul_i32 s38, s29, 160
  v_add_u32 v117, s38, v117
  s_mov_b32 s12, s60
  s_mov_b32 s13, s61
  s_mov_b32 s14, 2621440
  s_mov_b32 s15, 0x20000
  s_mov_b32 s16, s62
  s_mov_b32 s17, s63
  s_mov_b32 s18, 2621440
  s_mov_b32 s19, 0x20000
  s_mul_i32 s38, s31, 81920
  s_lshl_b32 s39, s3, 10
  s_add_u32 s38, s38, s39
  s_mul_i32 s39, s29, 10
  v_lshrrev_b32 v129, 1, v127
  v_add_u32 v129, s39, v129
  v_and_b32 v130, 1, v127
  v_lshlrev_b32 v130, 3, v130
  v_lshl_add_u32 v130, v126, 4, v130
  v_lshrrev_b32 v131, 2, v129
  v_lshl_add_u32 v131, v131, 12, v130
  v_and_b32 v132, 3, v129
  v_lshl_add_u32 v131, v132, 8, v131
  buffer_load_dwordx2 v[156:157], v131, s[24:27], s38 offen sc1
  v_add_u32 v129, 2, v129
  buffer_load_dwordx2 v[80:81], v117, s[12:15], 0 offen offset:0
  v_lshrrev_b32 v131, 2, v129
  v_lshl_add_u32 v131, v131, 12, v130
  v_and_b32 v132, 3, v129
  v_lshl_add_u32 v131, v132, 8, v131
  buffer_load_dwordx2 v[158:159], v131, s[24:27], s38 offen sc1
  v_add_u32 v129, 2, v129
  buffer_load_dwordx2 v[82:83], v117, s[12:15], 0 offen offset:32
  v_lshrrev_b32 v131, 2, v129
  v_lshl_add_u32 v131, v131, 12, v130
  v_and_b32 v132, 3, v129
  v_lshl_add_u32 v131, v132, 8, v131
  buffer_load_dwordx2 v[160:161], v131, s[24:27], s38 offen sc1
  v_add_u32 v129, 2, v129
  buffer_load_dwordx2 v[84:85], v117, s[12:15], 0 offen offset:64
  v_lshrrev_b32 v131, 2, v129
  v_lshl_add_u32 v131, v131, 12, v130
  v_and_b32 v132, 3, v129
  v_lshl_add_u32 v131, v132, 8, v131
  buffer_load_dwordx2 v[162:163], v131, s[24:27], s38 offen sc1
  v_add_u32 v129, 2, v129
  buffer_load_dwordx2 v[86:87], v117, s[12:15], 0 offen offset:96
  v_lshrrev_b32 v131, 2, v129
  v_lshl_add_u32 v131, v131, 12, v130
  v_and_b32 v132, 3, v129
  v_lshl_add_u32 v131, v132, 8, v131
  buffer_load_dwordx2 v[164:165], v131, s[24:27], s38 offen sc1
  v_add_u32 v129, 2, v129
  buffer_load_dwordx2 v[88:89], v117, s[12:15], 0 offen offset:128
  v_mov_b32 v123, 1073741824
  v_bfrev_b32 v124, 1
  v_sub_u32 v128, 0xffff, v128
  s_mov_b32 s34, 0xffff0000
  s_and_b32 s38, s52, 0xffff
  v_cmp_eq_u32 vcc, s38, v128
  v_mov_b32 v129, s52
  v_mov_b32 v130, 0
  v_cndmask_b32 v124, v124, v129, vcc
  v_cndmask_b32 v123, v123, v130, vcc
  s_and_b32 s38, s53, 0xffff
  v_cmp_eq_u32 vcc, s38, v128
  v_mov_b32 v129, s53
  v_mov_b32 v130, 2560
  v_cndmask_b32 v124, v124, v129, vcc
  v_cndmask_b32 v123, v123, v130, vcc
  s_and_b32 s38, s54, 0xffff
  v_cmp_eq_u32 vcc, s38, v128
  v_mov_b32 v129, s54
  v_mov_b32 v130, 5120
  v_cndmask_b32 v124, v124, v129, vcc
  v_cndmask_b32 v123, v123, v130, vcc
  s_and_b32 s38, s55, 0xffff
  v_cmp_eq_u32 vcc, s38, v128
  v_mov_b32 v129, s55
  v_mov_b32 v130, 7680
  v_cndmask_b32 v124, v124, v129, vcc
  v_cndmask_b32 v123, v123, v130, vcc
  s_and_b32 s38, s56, 0xffff
  v_cmp_eq_u32 vcc, s38, v128
  v_mov_b32 v129, s56
  v_mov_b32 v130, 10240
  v_cndmask_b32 v124, v124, v129, vcc
  v_cndmask_b32 v123, v123, v130, vcc
  s_and_b32 s38, s57, 0xffff
  v_cmp_eq_u32 vcc, s38, v128
  v_mov_b32 v129, s57
  v_mov_b32 v130, 12800
  v_cndmask_b32 v124, v124, v129, vcc
  v_cndmask_b32 v123, v123, v130, vcc
  s_and_b32 s38, s58, 0xffff
  v_cmp_eq_u32 vcc, s38, v128
  v_mov_b32 v129, s58
  v_mov_b32 v130, 15360
  v_cndmask_b32 v124, v124, v129, vcc
  v_cndmask_b32 v123, v123, v130, vcc
  s_and_b32 s38, s59, 0xffff
  v_cmp_eq_u32 vcc, s38, v128
  v_mov_b32 v129, s59
  v_mov_b32 v130, 17920
  v_cndmask_b32 v124, v124, v129, vcc
  v_cndmask_b32 v123, v123, v130, vcc
  v_lshl_add_u32 v123, v127, 4, v123
  s_mul_i32 s32, s29, 320
  s_add_u32 s32, s32, 2686976
  v_ashrrev_i32 v129, 31, v124
  v_not_b32 v129, v129
  v_or_b32 v129, 0x80000000, v129
  v_xor_b32 v124, v124, v129
  v_and_b32 v124, s34, v124
  v_mul_f32 v124, 0xbfb8aa3b, v124
  v_exp_f32 v124, v124
  s_nop 0
  v_add_f32 v124, 1.0, v124
  v_rcp_f32 v124, v124
  s_nop 0
  v_cvt_pk_bf16_f32 v124, v124, v124
  v_lshlrev_b32 v124, 16, v124
  buffer_load_dword v128, v133, s[24:27], 0 offen sc1
  buffer_load_dwordx4 a[80:83], v114, s[24:27], s7 offen offset:3072 sc1
  buffer_load_dwordx4 a[84:87], v115, s[24:27], s7 offen offset:0 sc1
  buffer_load_dwordx4 a[88:91], v115, s[24:27], s7 offen offset:1024 sc1
  buffer_load_dwordx4 a[92:95], v115, s[24:27], s7 offen offset:2048 sc1
  buffer_load_dwordx4 a[96:99], v115, s[24:27], s7 offen offset:3072 sc1
  buffer_load_dwordx4 a[100:103], v116, s[24:27], s7 offen offset:0 sc1
  s_waitcnt vmcnt(16)
  v_lshlrev_b32 v90, 16, v156
  v_and_b32 v91, s34, v156
  v_lshlrev_b32 v92, 16, v157
  v_and_b32 v93, s34, v157
  s_waitcnt vmcnt(14)
  v_lshlrev_b32 v94, 16, v158
  v_and_b32 v95, s34, v158
  v_lshlrev_b32 v96, 16, v159
  v_and_b32 v97, s34, v159
  s_waitcnt vmcnt(12)
  v_lshlrev_b32 v98, 16, v160
  v_and_b32 v99, s34, v160
  v_lshlrev_b32 v100, 16, v161
  v_and_b32 v101, s34, v161
  s_waitcnt vmcnt(10)
  v_lshlrev_b32 v102, 16, v162
  v_and_b32 v103, s34, v162
  v_lshlrev_b32 v104, 16, v163
  v_and_b32 v105, s34, v163
  s_waitcnt vmcnt(8)
  v_lshlrev_b32 v106, 16, v164
  v_and_b32 v107, s34, v164
  v_lshlrev_b32 v108, 16, v165
  v_and_b32 v109, s34, v165
  v_mov_b32 v156, 0
  v_mov_b32 v157, 0
  v_mov_b32 v158, 0
  v_mov_b32 v159, 0
  v_mov_b32 v160, 0
  v_mov_b32 v161, 0
  v_mov_b32 v162, 0
  v_mov_b32 v163, 0
  v_mov_b32 v164, 0
  v_mov_b32 v165, 0
  v_mov_b32 v166, 0
  v_mov_b32 v167, 0
  v_mov_b32 v168, 0
  v_mov_b32 v169, 0
  v_mov_b32 v170, 0
  v_mov_b32 v171, 0
  v_mov_b32 v172, 0
  v_mov_b32 v173, 0
  v_mov_b32 v174, 0
  v_mov_b32 v175, 0
  s_waitcnt vmcnt(6)
  v_cmp_lt_u32 vcc, v128, v134
  s_nop 0
  s_cbranch_vccz tail_ready
  s_mov_b32 s35, 32768
tail_spin:
  s_sleep 2
  buffer_load_dword v128, v133, s[24:27], 0 offen sc1
  s_waitcnt vmcnt(0)
  v_cmp_lt_u32 vcc, v128, v134
  s_nop 0
  s_cbranch_vccz tail_ready
  s_sub_u32 s35, s35, 1
  s_cmp_lg_u32 s35, 0
  s_cbranch_scc1 tail_spin
tail_ready:
  buffer_load_dwordx4 a[180:183], v110, s[24:27], s30 offen offset:0 sc1
  buffer_load_dwordx4 a[184:187], v110, s[24:27], s30 offen offset:1024 sc1
  buffer_load_dwordx4 a[188:191], v111, s[24:27], s30 offen offset:0 sc1
  buffer_load_dwordx4 a[192:195], v111, s[24:27], s30 offen offset:1024 sc1
  buffer_load_dwordx4 a[196:199], v112, s[24:27], s30 offen offset:0 sc1
  buffer_load_dwordx4 a[200:203], v112, s[24:27], s30 offen offset:1024 sc1
  buffer_load_dwordx4 a[204:207], v113, s[24:27], s30 offen offset:0 sc1
  buffer_load_dwordx4 a[208:211], v113, s[24:27], s30 offen offset:1024 sc1
  v_cmp_gt_u32 vcc, 1073741824, v123
  s_nop 0
  s_and_saveexec_b64 s[42:43], vcc
  s_cbranch_execz tail_plain
  s_waitcnt vmcnt(30)
  buffer_load_dwordx4 v[156:159], v123, s[24:27], s32 offen offset:0 sc1
  buffer_load_dwordx4 v[160:163], v123, s[24:27], s32 offen offset:64 sc1
  buffer_load_dwordx4 v[164:167], v123, s[24:27], s32 offen offset:128 sc1
  buffer_load_dwordx4 v[168:171], v123, s[24:27], s32 offen offset:192 sc1
  buffer_load_dwordx4 v[172:175], v123, s[24:27], s32 offen offset:256 sc1
  s_add_u32 s32, s32, 20480
  buffer_load_dwordx4 v[136:139], v123, s[24:27], s32 offen offset:0 sc1
  buffer_load_dwordx4 v[140:143], v123, s[24:27], s32 offen offset:64 sc1
  buffer_load_dwordx4 v[144:147], v123, s[24:27], s32 offen offset:128 sc1
  buffer_load_dwordx4 v[148:151], v123, s[24:27], s32 offen offset:192 sc1
  buffer_load_dwordx4 v[152:155], v123, s[24:27], s32 offen offset:256 sc1
  s_add_u32 s32, s32, 20480
  buffer_load_dwordx4 v[0:3], v123, s[24:27], s32 offen offset:0 sc1
  buffer_load_dwordx4 v[4:7], v123, s[24:27], s32 offen offset:64 sc1
  buffer_load_dwordx4 v[8:11], v123, s[24:27], s32 offen offset:128 sc1
  buffer_load_dwordx4 v[12:15], v123, s[24:27], s32 offen offset:192 sc1
  buffer_load_dwordx4 v[16:19], v123, s[24:27], s32 offen offset:256 sc1
  s_add_u32 s32, s32, 20480
  buffer_load_dwordx4 v[20:23], v123, s[24:27], s32 offen offset:0 sc1
  buffer_load_dwordx4 v[24:27], v123, s[24:27], s32 offen offset:64 sc1
  buffer_load_dwordx4 v[28:31], v123, s[24:27], s32 offen offset:128 sc1
  buffer_load_dwordx4 v[32:35], v123, s[24:27], s32 offen offset:192 sc1
  buffer_load_dwordx4 v[36:39], v123, s[24:27], s32 offen offset:256 sc1
  s_add_u32 s32, s32, 20480
  buffer_load_dwordx4 v[40:43], v123, s[24:27], s32 offen offset:0 sc1
  buffer_load_dwordx4 v[44:47], v123, s[24:27], s32 offen offset:64 sc1
  buffer_load_dwordx4 v[48:51], v123, s[24:27], s32 offen offset:128 sc1
  buffer_load_dwordx4 v[52:55], v123, s[24:27], s32 offen offset:192 sc1
  buffer_load_dwordx4 v[56:59], v123, s[24:27], s32 offen offset:256 sc1
  s_add_u32 s32, s32, 20480
  buffer_load_dwordx4 v[60:63], v123, s[24:27], s32 offen offset:0 sc1
  buffer_load_dwordx4 v[64:67], v123, s[24:27], s32 offen offset:64 sc1
  buffer_load_dwordx4 v[68:71], v123, s[24:27], s32 offen offset:128 sc1
  buffer_load_dwordx4 v[72:75], v123, s[24:27], s32 offen offset:192 sc1
  buffer_load_dwordx4 v[76:79], v123, s[24:27], s32 offen offset:256 sc1
  s_add_u32 s32, s32, 20480
  s_waitcnt vmcnt(0)
  v_add_f32 v156, v156, v136
  v_add_f32 v157, v157, v137
  v_add_f32 v158, v158, v138
  v_add_f32 v159, v159, v139
  v_add_f32 v160, v160, v140
  v_add_f32 v161, v161, v141
  v_add_f32 v162, v162, v142
  v_add_f32 v163, v163, v143
  v_add_f32 v164, v164, v144
  v_add_f32 v165, v165, v145
  v_add_f32 v166, v166, v146
  v_add_f32 v167, v167, v147
  v_add_f32 v168, v168, v148
  v_add_f32 v169, v169, v149
  v_add_f32 v170, v170, v150
  v_add_f32 v171, v171, v151
  v_add_f32 v172, v172, v152
  v_add_f32 v173, v173, v153
  v_add_f32 v174, v174, v154
  v_add_f32 v175, v175, v155
  v_add_f32 v156, v156, v0
  v_add_f32 v157, v157, v1
  v_add_f32 v158, v158, v2
  v_add_f32 v159, v159, v3
  v_add_f32 v160, v160, v4
  v_add_f32 v161, v161, v5
  v_add_f32 v162, v162, v6
  v_add_f32 v163, v163, v7
  v_add_f32 v164, v164, v8
  v_add_f32 v165, v165, v9
  v_add_f32 v166, v166, v10
  v_add_f32 v167, v167, v11
  v_add_f32 v168, v168, v12
  v_add_f32 v169, v169, v13
  v_add_f32 v170, v170, v14
  v_add_f32 v171, v171, v15
  v_add_f32 v172, v172, v16
  v_add_f32 v173, v173, v17
  v_add_f32 v174, v174, v18
  v_add_f32 v175, v175, v19
  v_add_f32 v156, v156, v20
  v_add_f32 v157, v157, v21
  v_add_f32 v158, v158, v22
  v_add_f32 v159, v159, v23
  v_add_f32 v160, v160, v24
  v_add_f32 v161, v161, v25
  v_add_f32 v162, v162, v26
  v_add_f32 v163, v163, v27
  v_add_f32 v164, v164, v28
  v_add_f32 v165, v165, v29
  v_add_f32 v166, v166, v30
  v_add_f32 v167, v167, v31
  v_add_f32 v168, v168, v32
  v_add_f32 v169, v169, v33
  v_add_f32 v170, v170, v34
  v_add_f32 v171, v171, v35
  v_add_f32 v172, v172, v36
  v_add_f32 v173, v173, v37
  v_add_f32 v174, v174, v38
  v_add_f32 v175, v175, v39
  v_add_f32 v156, v156, v40
  v_add_f32 v157, v157, v41
  v_add_f32 v158, v158, v42
  v_add_f32 v159, v159, v43
  v_add_f32 v160, v160, v44
  v_add_f32 v161, v161, v45
  v_add_f32 v162, v162, v46
  v_add_f32 v163, v163, v47
  v_add_f32 v164, v164, v48
  v_add_f32 v165, v165, v49
  v_add_f32 v166, v166, v50
  v_add_f32 v167, v167, v51
  v_add_f32 v168, v168, v52
  v_add_f32 v169, v169, v53
  v_add_f32 v170, v170, v54
  v_add_f32 v171, v171, v55
  v_add_f32 v172, v172, v56
  v_add_f32 v173, v173, v57
  v_add_f32 v174, v174, v58
  v_add_f32 v175, v175, v59
  v_add_f32 v156, v156, v60
  v_add_f32 v157, v157, v61
  v_add_f32 v158, v158, v62
  v_add_f32 v159, v159, v63
  v_add_f32 v160, v160, v64
  v_add_f32 v161, v161, v65
  v_add_f32 v162, v162, v66
  v_add_f32 v163, v163, v67
  v_add_f32 v164, v164, v68
  v_add_f32 v165, v165, v69
  v_add_f32 v166, v166, v70
  v_add_f32 v167, v167, v71
  v_add_f32 v168, v168, v72
  v_add_f32 v169, v169, v73
  v_add_f32 v170, v170, v74
  v_add_f32 v171, v171, v75
  v_add_f32 v172, v172, v76
  v_add_f32 v173, v173, v77
  v_add_f32 v174, v174, v78
  v_add_f32 v175, v175, v79
tail_plain:
  s_mov_b64 exec, s[42:43]
  s_waitcnt vmcnt(0)
  v_mfma_f32_16x16x32_bf16 v[0:3], a[212:215], a[180:183], 0
  s_add_u32 s30, s30, 8192
  buffer_load_dwordx4 v[176:179], v110, s[24:27], s30 offen offset:0 sc1
  v_mfma_f32_16x16x32_bf16 v[0:3], a[232:235], a[184:187], v[0:3]
  v_cvt_pk_bf16_f32 v156, v156, v156
  v_cvt_pk_bf16_f32 v157, v157, v157
  v_mfma_f32_16x16x32_bf16 v[4:7], a[232:235], a[192:195], 0
  buffer_load_dwordx4 a[104:107], v116, s[24:27], s7 offen offset:1024 sc1
  v_mfma_f32_16x16x32_bf16 v[4:7], a[212:215], a[188:191], v[4:7]
  v_cvt_pk_bf16_f32 v158, v158, v158
  v_cvt_pk_bf16_f32 v159, v159, v159
  v_mfma_f32_16x16x32_bf16 v[8:11], a[212:215], a[196:199], 0
  buffer_load_dwordx4 v[180:183], v110, s[24:27], s30 offen offset:1024 sc1
  v_mfma_f32_16x16x32_bf16 v[8:11], a[232:235], a[200:203], v[8:11]
  v_lshlrev_b32 v156, 16, v156
  v_lshlrev_b32 v157, 16, v157
  v_mfma_f32_16x16x32_bf16 v[12:15], a[232:235], a[208:211], 0
  v_lshlrev_b32 v158, 16, v158
  v_lshlrev_b32 v159, 16, v159
  v_mfma_f32_16x16x32_bf16 v[12:15], a[212:215], a[204:207], v[12:15]
  v_mul_f32 v156, v156, v124
  v_mul_f32 v157, v157, v124
  v_mfma_f32_16x16x32_bf16 v[16:19], a[216:219], a[180:183], 0
  buffer_load_dwordx4 v[184:187], v111, s[24:27], s30 offen offset:0 sc1
  v_mfma_f32_16x16x32_bf16 v[16:19], a[236:239], a[184:187], v[16:19]
  v_mul_f32 v158, v158, v124
  v_mul_f32 v159, v159, v124
  v_mfma_f32_16x16x32_bf16 v[20:23], a[236:239], a[192:195], 0
  buffer_load_dwordx4 a[108:111], v116, s[24:27], s7 offen offset:2048 sc1
  v_mfma_f32_16x16x32_bf16 v[20:23], a[216:219], a[188:191], v[20:23]
  v_cvt_pk_bf16_f32 v156, v156, v156
  v_cvt_pk_bf16_f32 v157, v157, v157
  v_mfma_f32_16x16x32_bf16 v[24:27], a[216:219], a[196:199], 0
  buffer_load_dwordx4 v[188:191], v111, s[24:27], s30 offen offset:1024 sc1
  v_mfma_f32_16x16x32_bf16 v[24:27], a[236:239], a[200:203], v[24:27]
  v_cvt_pk_bf16_f32 v158, v158, v158
  v_cvt_pk_bf16_f32 v159, v159, v159
  v_mfma_f32_16x16x32_bf16 v[28:31], a[236:239], a[208:211], 0
  v_lshlrev_b32 v156, 16, v156
  v_lshlrev_b32 v157, 16, v157
  v_mfma_f32_16x16x32_bf16 v[28:31], a[216:219], a[204:207], v[28:31]
  v_lshlrev_b32 v158, 16, v158
  v_lshlrev_b32 v159, 16, v159
  v_mfma_f32_16x16x32_bf16 v[32:35], a[220:223], a[180:183], 0
  buffer_load_dwordx4 v[192:195], v112, s[24:27], s30 offen offset:0 sc1
  v_mfma_f32_16x16x32_bf16 v[32:35], a[240:243], a[184:187], v[32:35]
  v_add_f32 v90, v90, v156
  v_add_f32 v91, v91, v157
  v_mfma_f32_16x16x32_bf16 v[36:39], a[240:243], a[192:195], 0
  buffer_load_dwordx4 a[112:115], v116, s[24:27], s7 offen offset:3072 sc1
  v_mfma_f32_16x16x32_bf16 v[36:39], a[220:223], a[188:191], v[36:39]
  v_add_f32 v92, v92, v158
  v_add_f32 v93, v93, v159
  v_mfma_f32_16x16x32_bf16 v[40:43], a[220:223], a[196:199], 0
  buffer_load_dwordx4 v[196:199], v112, s[24:27], s30 offen offset:1024 sc1
  v_mfma_f32_16x16x32_bf16 v[40:43], a[240:243], a[200:203], v[40:43]
  v_cvt_pk_bf16_f32 v90, v90, v90
  v_cvt_pk_bf16_f32 v91, v91, v91
  v_mfma_f32_16x16x32_bf16 v[44:47], a[240:243], a[208:211], 0
  v_cvt_pk_bf16_f32 v92, v92, v92
  v_cvt_pk_bf16_f32 v93, v93, v93
  v_mfma_f32_16x16x32_bf16 v[44:47], a[220:223], a[204:207], v[44:47]
  v_lshlrev_b32 v90, 16, v90
  v_lshlrev_b32 v91, 16, v91
  v_mfma_f32_16x16x32_bf16 v[48:51], a[224:227], a[180:183], 0
  buffer_load_dwordx4 v[200:203], v113, s[24:27], s30 offen offset:0 sc1
  v_mfma_f32_16x16x32_bf16 v[48:51], a[244:247], a[184:187], v[48:51]
  v_lshlrev_b32 v92, 16, v92
  v_lshlrev_b32 v93, 16, v93
  v_mfma_f32_16x16x32_bf16 v[52:55], a[244:247], a[192:195], 0
  buffer_load_dwordx4 a[116:119], v114, s[24:27], s8 offen offset:0 sc1
  v_mfma_f32_16x16x32_bf16 v[52:55], a[224:227], a[188:191], v[52:55]
  v_mul_f32 v129, 0xbfb8aa3b, v90
  v_mul_f32 v130, 0xbfb8aa3b, v91
  v_mfma_f32_16x16x32_bf16 v[56:59], a[224:227], a[196:199], 0
  buffer_load_dwordx4 v[204:207], v113, s[24:27], s30 offen offset:1024 sc1
  v_mfma_f32_16x16x32_bf16 v[56:59], a[244:247], a[200:203], v[56:59]
  v_mul_f32 v131, 0xbfb8aa3b, v92
  v_mul_f32 v132, 0xbfb8aa3b, v93
  v_mfma_f32_16x16x32_bf16 v[60:63], a[244:247], a[208:211], 0
  v_exp_f32 v129, v129
  v_mfma_f32_16x16x32_bf16 v[60:63], a[224:227], a[204:207], v[60:63]
  v_exp_f32 v130, v130
  v_mfma_f32_16x16x32_bf16 v[64:67], a[228:231], a[180:183], 0
  s_add_u32 s30, s30, 8192
  buffer_load_dwordx4 v[208:211], v110, s[24:27], s30 offen offset:0 sc1
  v_mfma_f32_16x16x32_bf16 v[64:67], a[248:251], a[184:187], v[64:67]
  v_exp_f32 v131, v131
  v_mfma_f32_16x16x32_bf16 v[68:71], a[248:251], a[192:195], 0
  buffer_load_dwordx4 a[120:123], v114, s[24:27], s8 offen offset:1024 sc1
  v_mfma_f32_16x16x32_bf16 v[68:71], a[228:231], a[188:191], v[68:71]
  v_exp_f32 v132, v132
  v_mfma_f32_16x16x32_bf16 v[72:75], a[228:231], a[196:199], 0
  buffer_load_dwordx4 v[212:215], v110, s[24:27], s30 offen offset:1024 sc1
  v_mfma_f32_16x16x32_bf16 v[72:75], a[248:251], a[200:203], v[72:75]
  v_add_f32 v129, 1.0, v129
  v_add_f32 v130, 1.0, v130
  v_mfma_f32_16x16x32_bf16 v[76:79], a[248:251], a[208:211], 0
  v_add_f32 v131, 1.0, v131
  v_add_f32 v132, 1.0, v132
  v_mfma_f32_16x16x32_bf16 v[76:79], a[228:231], a[204:207], v[76:79]
  v_rcp_f32 v129, v129
  s_waitcnt vmcnt(3)
  v_mfma_f32_16x16x32_bf16 v[0:3], a[252:255], v[176:179], v[0:3]
  buffer_load_dwordx4 v[216:219], v111, s[24:27], s30 offen offset:0 sc1
  v_mfma_f32_16x16x32_bf16 v[0:3], a[144:147], v[180:183], v[0:3]
  v_rcp_f32 v130, v130
  v_mfma_f32_16x16x32_bf16 v[4:7], a[144:147], v[188:191], v[4:7]
  buffer_load_dwordx4 a[124:127], v114, s[24:27], s8 offen offset:2048 sc1
  v_mfma_f32_16x16x32_bf16 v[4:7], a[252:255], v[184:187], v[4:7]
  v_rcp_f32 v131, v131
  v_mfma_f32_16x16x32_bf16 v[8:11], a[252:255], v[192:195], v[8:11]
  buffer_load_dwordx4 v[220:223], v111, s[24:27], s30 offen offset:1024 sc1
  v_mfma_f32_16x16x32_bf16 v[8:11], a[144:147], v[196:199], v[8:11]
  v_rcp_f32 v132, v132
  v_mfma_f32_16x16x32_bf16 v[12:15], a[144:147], v[204:207], v[12:15]
  v_mul_f32 v90, v90, v129
  v_mul_f32 v91, v91, v130
  v_mfma_f32_16x16x32_bf16 v[12:15], a[252:255], v[200:203], v[12:15]
  v_mul_f32 v92, v92, v131
  v_mul_f32 v93, v93, v132
  v_mfma_f32_16x16x32_bf16 v[16:19], a[128:131], v[176:179], v[16:19]
  buffer_load_dwordx4 v[224:227], v112, s[24:27], s30 offen offset:0 sc1
  v_mfma_f32_16x16x32_bf16 v[16:19], a[148:151], v[180:183], v[16:19]
  v_cvt_pk_bf16_f32 v90, v90, v90
  v_cvt_pk_bf16_f32 v91, v91, v91
  v_mfma_f32_16x16x32_bf16 v[20:23], a[148:151], v[188:191], v[20:23]
  buffer_load_dwordx4 a[160:163], v114, s[24:27], s8 offen offset:3072 sc1
  v_mfma_f32_16x16x32_bf16 v[20:23], a[128:131], v[184:187], v[20:23]
  v_cvt_pk_bf16_f32 v92, v92, v92
  v_cvt_pk_bf16_f32 v93, v93, v93
  v_mfma_f32_16x16x32_bf16 v[24:27], a[128:131], v[192:195], v[24:27]
  buffer_load_dwordx4 v[228:231], v112, s[24:27], s30 offen offset:1024 sc1
  v_mfma_f32_16x16x32_bf16 v[24:27], a[148:151], v[196:199], v[24:27]
  v_lshlrev_b32 v90, 16, v90
  v_lshlrev_b32 v91, 16, v91
  v_mfma_f32_16x16x32_bf16 v[28:31], a[148:151], v[204:207], v[28:31]
  v_lshlrev_b32 v92, 16, v92
  v_lshlrev_b32 v93, 16, v93
  v_mfma_f32_16x16x32_bf16 v[28:31], a[128:131], v[200:203], v[28:31]
  v_cvt_pk_bf16_f32 v160, v160, v160
  v_cvt_pk_bf16_f32 v161, v161, v161
  v_mfma_f32_16x16x32_bf16 v[32:35], a[132:135], v[176:179], v[32:35]
  buffer_load_dwordx4 v[232:235], v113, s[24:27], s30 offen offset:0 sc1
  v_mfma_f32_16x16x32_bf16 v[32:35], a[152:155], v[180:183], v[32:35]
  v_cvt_pk_bf16_f32 v162, v162, v162
  v_cvt_pk_bf16_f32 v163, v163, v163
  v_mfma_f32_16x16x32_bf16 v[36:39], a[152:155], v[188:191], v[36:39]
  buffer_load_dwordx4 a[164:167], v115, s[24:27], s8 offen offset:0 sc1
  v_mfma_f32_16x16x32_bf16 v[36:39], a[132:135], v[184:187], v[36:39]
  v_lshlrev_b32 v160, 16, v160
  v_lshlrev_b32 v161, 16, v161
  v_mfma_f32_16x16x32_bf16 v[40:43], a[132:135], v[192:195], v[40:43]
  buffer_load_dwordx4 v[236:239], v113, s[24:27], s30 offen offset:1024 sc1
  v_mfma_f32_16x16x32_bf16 v[40:43], a[152:155], v[196:199], v[40:43]
  v_lshlrev_b32 v162, 16, v162
  v_lshlrev_b32 v163, 16, v163
  v_mfma_f32_16x16x32_bf16 v[44:47], a[152:155], v[204:207], v[44:47]
  v_mul_f32 v160, v160, v124
  v_mul_f32 v161, v161, v124
  v_mfma_f32_16x16x32_bf16 v[44:47], a[132:135], v[200:203], v[44:47]
  v_mul_f32 v162, v162, v124
  v_mul_f32 v163, v163, v124
  v_mfma_f32_16x16x32_bf16 v[48:51], a[136:139], v[176:179], v[48:51]
  s_add_u32 s30, s30, 8192
  buffer_load_dwordx4 v[240:243], v110, s[24:27], s30 offen offset:0 sc1
  v_mfma_f32_16x16x32_bf16 v[48:51], a[156:159], v[180:183], v[48:51]
  v_cvt_pk_bf16_f32 v160, v160, v160
  v_cvt_pk_bf16_f32 v161, v161, v161
  v_mfma_f32_16x16x32_bf16 v[52:55], a[156:159], v[188:191], v[52:55]
  buffer_load_dwordx4 a[168:171], v115, s[24:27], s8 offen offset:1024 sc1
  v_mfma_f32_16x16x32_bf16 v[52:55], a[136:139], v[184:187], v[52:55]
  v_cvt_pk_bf16_f32 v162, v162, v162
  v_cvt_pk_bf16_f32 v163, v163, v163
  v_mfma_f32_16x16x32_bf16 v[56:59], a[136:139], v[192:195], v[56:59]
  buffer_load_dwordx4 v[244:247], v110, s[24:27], s30 offen offset:1024 sc1
  v_mfma_f32_16x16x32_bf16 v[56:59], a[156:159], v[196:199], v[56:59]
  v_lshlrev_b32 v160, 16, v160
  v_lshlrev_b32 v161, 16, v161
  v_mfma_f32_16x16x32_bf16 v[60:63], a[156:159], v[204:207], v[60:63]
  v_lshlrev_b32 v162, 16, v162
  v_lshlrev_b32 v163, 16, v163
  v_mfma_f32_16x16x32_bf16 v[60:63], a[136:139], v[200:203], v[60:63]
  v_add_f32 v94, v94, v160
  v_add_f32 v95, v95, v161
  v_mfma_f32_16x16x32_bf16 v[64:67], a[140:143], v[176:179], v[64:67]
  buffer_load_dwordx4 v[248:251], v111, s[24:27], s30 offen offset:0 sc1
  v_mfma_f32_16x16x32_bf16 v[64:67], a[0:3], v[180:183], v[64:67]
  v_add_f32 v96, v96, v162
  v_add_f32 v97, v97, v163
  v_mfma_f32_16x16x32_bf16 v[68:71], a[0:3], v[188:191], v[68:71]
  buffer_load_dwordx4 a[172:175], v115, s[24:27], s8 offen offset:2048 sc1
  v_mfma_f32_16x16x32_bf16 v[68:71], a[140:143], v[184:187], v[68:71]
  v_cvt_pk_bf16_f32 v94, v94, v94
  v_cvt_pk_bf16_f32 v95, v95, v95
  v_mfma_f32_16x16x32_bf16 v[72:75], a[140:143], v[192:195], v[72:75]
  buffer_load_dwordx4 v[252:255], v111, s[24:27], s30 offen offset:1024 sc1
  v_mfma_f32_16x16x32_bf16 v[72:75], a[0:3], v[196:199], v[72:75]
  v_cvt_pk_bf16_f32 v96, v96, v96
  v_cvt_pk_bf16_f32 v97, v97, v97
  v_mfma_f32_16x16x32_bf16 v[76:79], a[0:3], v[204:207], v[76:79]
  v_lshlrev_b32 v94, 16, v94
  v_lshlrev_b32 v95, 16, v95
  v_mfma_f32_16x16x32_bf16 v[76:79], a[140:143], v[200:203], v[76:79]
  v_lshlrev_b32 v96, 16, v96
  v_lshlrev_b32 v97, 16, v97
  s_waitcnt vmcnt(6)
  v_mfma_f32_16x16x32_bf16 v[0:3], a[4:7], v[208:211], v[0:3]
  buffer_load_dwordx4 v[136:139], v112, s[24:27], s30 offen offset:0 sc1
  v_mfma_f32_16x16x32_bf16 v[0:3], a[24:27], v[212:215], v[0:3]
  v_mul_f32 v129, 0xbfb8aa3b, v94
  v_mul_f32 v130, 0xbfb8aa3b, v95
  v_mfma_f32_16x16x32_bf16 v[4:7], a[24:27], v[220:223], v[4:7]
  buffer_load_dwordx4 a[176:179], v115, s[24:27], s8 offen offset:3072 sc1
  v_mfma_f32_16x16x32_bf16 v[4:7], a[4:7], v[216:219], v[4:7]
  v_mul_f32 v131, 0xbfb8aa3b, v96
  v_mul_f32 v132, 0xbfb8aa3b, v97
  v_mfma_f32_16x16x32_bf16 v[8:11], a[4:7], v[224:227], v[8:11]
  buffer_load_dwordx4 v[140:143], v112, s[24:27], s30 offen offset:1024 sc1
  v_mfma_f32_16x16x32_bf16 v[8:11], a[24:27], v[228:231], v[8:11]
  v_exp_f32 v129, v129
  v_mfma_f32_16x16x32_bf16 v[12:15], a[24:27], v[236:239], v[12:15]
  v_exp_f32 v130, v130
  v_mfma_f32_16x16x32_bf16 v[12:15], a[4:7], v[232:235], v[12:15]
  v_exp_f32 v131, v131
  v_mfma_f32_16x16x32_bf16 v[16:19], a[8:11], v[208:211], v[16:19]
  buffer_load_dwordx4 v[144:147], v113, s[24:27], s30 offen offset:0 sc1
  v_mfma_f32_16x16x32_bf16 v[16:19], a[28:31], v[212:215], v[16:19]
  v_exp_f32 v132, v132
  v_mfma_f32_16x16x32_bf16 v[20:23], a[28:31], v[220:223], v[20:23]
  s_add_u32 m0, s28, 49152
  s_nop 0
  buffer_load_dwordx4 v115, s[24:27], s10 offen offset:0 sc1 lds
  v_mfma_f32_16x16x32_bf16 v[20:23], a[8:11], v[216:219], v[20:23]
  buffer_load_dwordx4 v115, s[24:27], s10 offen offset:1024 sc1 lds
  v_mfma_f32_16x16x32_bf16 v[24:27], a[8:11], v[224:227], v[24:27]
  buffer_load_dwordx4 v115, s[24:27], s10 offen offset:2048 sc1 lds
  v_mfma_f32_16x16x32_bf16 v[24:27], a[28:31], v[228:231], v[24:27]
  buffer_load_dwordx4 v115, s[24:27], s10 offen offset:3072 sc1 lds
  v_mfma_f32_16x16x32_bf16 v[28:31], a[28:31], v[236:239], v[28:31]
  buffer_load_dwordx4 v[148:151], v113, s[24:27], s30 offen offset:1024 sc1
  v_mfma_f32_16x16x32_bf16 v[28:31], a[8:11], v[232:235], v[28:31]
  v_add_f32 v129, 1.0, v129
  v_add_f32 v130, 1.0, v130
  v_mfma_f32_16x16x32_bf16 v[32:35], a[12:15], v[208:211], v[32:35]
  s_add_u32 s30, s30, 8192
  buffer_load_dwordx4 v[152:155], v110, s[24:27], s30 offen offset:0 sc1
  v_mfma_f32_16x16x32_bf16 v[32:35], a[32:35], v[212:215], v[32:35]
  v_add_f32 v131, 1.0, v131
  v_add_f32 v132, 1.0, v132
  v_mfma_f32_16x16x32_bf16 v[36:39], a[32:35], v[220:223], v[36:39]
  v_rcp_f32 v129, v129
  v_mfma_f32_16x16x32_bf16 v[36:39], a[12:15], v[216:219], v[36:39]
  v_rcp_f32 v130, v130
  v_mfma_f32_16x16x32_bf16 v[40:43], a[12:15], v[224:227], v[40:43]
  buffer_load_dwordx4 a[180:183], v110, s[24:27], s30 offen offset:1024 sc1
  v_mfma_f32_16x16x32_bf16 v[40:43], a[32:35], v[228:231], v[40:43]
  v_rcp_f32 v131, v131
  v_mfma_f32_16x16x32_bf16 v[44:47], a[32:35], v[236:239], v[44:47]
  v_rcp_f32 v132, v132
  v_mfma_f32_16x16x32_bf16 v[44:47], a[12:15], v[232:235], v[44:47]
  v_mul_f32 v94, v94, v129
  v_mul_f32 v95, v95, v130
  v_mfma_f32_16x16x32_bf16 v[48:51], a[16:19], v[208:211], v[48:51]
  buffer_load_dwordx4 a[184:187], v111, s[24:27], s30 offen offset:0 sc1
  v_mfma_f32_16x16x32_bf16 v[48:51], a[36:39], v[212:215], v[48:51]
  v_mul_f32 v96, v96, v131
  v_mul_f32 v97, v97, v132
  v_mfma_f32_16x16x32_bf16 v[52:55], a[36:39], v[220:223], v[52:55]
  v_cvt_pk_bf16_f32 v94, v94, v94
  v_cvt_pk_bf16_f32 v95, v95, v95
  v_mfma_f32_16x16x32_bf16 v[52:55], a[16:19], v[216:219], v[52:55]
  v_cvt_pk_bf16_f32 v96, v96, v96
  v_cvt_pk_bf16_f32 v97, v97, v97
  v_mfma_f32_16x16x32_bf16 v[56:59], a[16:19], v[224:227], v[56:59]
  buffer_load_dwordx4 a[188:191], v111, s[24:27], s30 offen offset:1024 sc1
  v_mfma_f32_16x16x32_bf16 v[56:59], a[36:39], v[228:231], v[56:59]
  v_lshlrev_b32 v94, 16, v94
  v_lshlrev_b32 v95, 16, v95
  v_mfma_f32_16x16x32_bf16 v[60:63], a[36:39], v[236:239], v[60:63]
  v_lshlrev_b32 v96, 16, v96
  v_lshlrev_b32 v97, 16, v97
  v_mfma_f32_16x16x32_bf16 v[60:63], a[16:19], v[232:235], v[60:63]
  v_cvt_pk_bf16_f32 v164, v164, v164
  v_cvt_pk_bf16_f32 v165, v165, v165
  v_mfma_f32_16x16x32_bf16 v[64:67], a[20:23], v[208:211], v[64:67]
  buffer_load_dwordx4 a[192:195], v112, s[24:27], s30 offen offset:0 sc1
  v_mfma_f32_16x16x32_bf16 v[64:67], a[40:43], v[212:215], v[64:67]
  v_cvt_pk_bf16_f32 v166, v166, v166
  v_cvt_pk_bf16_f32 v167, v167, v167
  v_mfma_f32_16x16x32_bf16 v[68:71], a[40:43], v[220:223], v[68:71]
  v_lshlrev_b32 v164, 16, v164
  v_lshlrev_b32 v165, 16, v165
  v_mfma_f32_16x16x32_bf16 v[68:71], a[20:23], v[216:219], v[68:71]
  v_lshlrev_b32 v166, 16, v166
  v_lshlrev_b32 v167, 16, v167
  v_mfma_f32_16x16x32_bf16 v[72:75], a[20:23], v[224:227], v[72:75]
  buffer_load_dwordx4 a[196:199], v112, s[24:27], s30 offen offset:1024 sc1
  v_mfma_f32_16x16x32_bf16 v[72:75], a[40:43], v[228:231], v[72:75]
  v_mul_f32 v164, v164, v124
  v_mul_f32 v165, v165, v124
  v_mfma_f32_16x16x32_bf16 v[76:79], a[40:43], v[236:239], v[76:79]
  v_mul_f32 v166, v166, v124
  v_mul_f32 v167, v167, v124
  v_mfma_f32_16x16x32_bf16 v[76:79], a[20:23], v[232:235], v[76:79]
  v_cvt_pk_bf16_f32 v164, v164, v164
  v_cvt_pk_bf16_f32 v165, v165, v165
  s_waitcnt vmcnt(6)
  v_mfma_f32_16x16x32_bf16 v[0:3], a[44:47], v[240:243], v[0:3]
  buffer_load_dwordx4 a[200:203], v113, s[24:27], s30 offen offset:0 sc1
  v_mfma_f32_16x16x32_bf16 v[0:3], a[64:67], v[244:247], v[0:3]
  v_cvt_pk_bf16_f32 v166, v166, v166
  v_cvt_pk_bf16_f32 v167, v167, v167
  v_mfma_f32_16x16x32_bf16 v[4:7], a[64:67], v[252:255], v[4:7]
  v_lshlrev_b32 v164, 16, v164
  v_lshlrev_b32 v165, 16, v165
  v_mfma_f32_16x16x32_bf16 v[4:7], a[44:47], v[248:251], v[4:7]
  v_lshlrev_b32 v166, 16, v166
  v_lshlrev_b32 v167, 16, v167
  v_mfma_f32_16x16x32_bf16 v[8:11], a[44:47], v[136:139], v[8:11]
  buffer_load_dwordx4 a[204:207], v113, s[24:27], s30 offen offset:1024 sc1
  v_mfma_f32_16x16x32_bf16 v[8:11], a[64:67], v[140:143], v[8:11]
  v_add_f32 v98, v98, v164
  v_add_f32 v99, v99, v165
  v_mfma_f32_16x16x32_bf16 v[12:15], a[64:67], v[148:151], v[12:15]
  v_add_f32 v100, v100, v166
  v_add_f32 v101, v101, v167
  v_mfma_f32_16x16x32_bf16 v[12:15], a[44:47], v[144:147], v[12:15]
  v_cvt_pk_bf16_f32 v98, v98, v98
  v_cvt_pk_bf16_f32 v99, v99, v99
  v_mfma_f32_16x16x32_bf16 v[16:19], a[48:51], v[240:243], v[16:19]
  s_add_u32 s30, s30, 8192
  buffer_load_dwordx4 a[208:211], v110, s[24:27], s30 offen offset:0 sc1
  v_mfma_f32_16x16x32_bf16 v[16:19], a[68:71], v[244:247], v[16:19]
  v_cvt_pk_bf16_f32 v100, v100, v100
  v_cvt_pk_bf16_f32 v101, v101, v101
  v_mfma_f32_16x16x32_bf16 v[20:23], a[68:71], v[252:255], v[20:23]
  v_lshlrev_b32 v98, 16, v98
  v_lshlrev_b32 v99, 16, v99
  v_mfma_f32_16x16x32_bf16 v[20:23], a[48:51], v[248:251], v[20:23]
  v_lshlrev_b32 v100, 16, v100
  v_lshlrev_b32 v101, 16, v101
  v_mfma_f32_16x16x32_bf16 v[24:27], a[48:51], v[136:139], v[24:27]
  buffer_load_dwordx4 v[176:179], v110, s[24:27], s30 offen offset:1024 sc1
  v_mfma_f32_16x16x32_bf16 v[24:27], a[68:71], v[140:143], v[24:27]
  v_mul_f32 v129, 0xbfb8aa3b, v98
  v_mul_f32 v130, 0xbfb8aa3b, v99
  v_mfma_f32_16x16x32_bf16 v[28:31], a[68:71], v[148:151], v[28:31]
  v_mul_f32 v131, 0xbfb8aa3b, v100
  v_mul_f32 v132, 0xbfb8aa3b, v101
  v_mfma_f32_16x16x32_bf16 v[28:31], a[48:51], v[144:147], v[28:31]
  v_exp_f32 v129, v129
  v_mfma_f32_16x16x32_bf16 v[32:35], a[52:55], v[240:243], v[32:35]
  buffer_load_dwordx4 v[180:183], v111, s[24:27], s30 offen offset:0 sc1
  v_mfma_f32_16x16x32_bf16 v[32:35], a[72:75], v[244:247], v[32:35]
  v_exp_f32 v130, v130
  v_mfma_f32_16x16x32_bf16 v[36:39], a[72:75], v[252:255], v[36:39]
  v_exp_f32 v131, v131
  v_mfma_f32_16x16x32_bf16 v[36:39], a[52:55], v[248:251], v[36:39]
  v_exp_f32 v132, v132
  v_mfma_f32_16x16x32_bf16 v[40:43], a[52:55], v[136:139], v[40:43]
  buffer_load_dwordx4 v[184:187], v111, s[24:27], s30 offen offset:1024 sc1
  v_mfma_f32_16x16x32_bf16 v[40:43], a[72:75], v[140:143], v[40:43]
  v_add_f32 v129, 1.0, v129
  v_add_f32 v130, 1.0, v130
  v_mfma_f32_16x16x32_bf16 v[44:47], a[72:75], v[148:151], v[44:47]
  v_add_f32 v131, 1.0, v131
  v_add_f32 v132, 1.0, v132
  v_mfma_f32_16x16x32_bf16 v[44:47], a[52:55], v[144:147], v[44:47]
  v_rcp_f32 v129, v129
  v_mfma_f32_16x16x32_bf16 v[48:51], a[56:59], v[240:243], v[48:51]
  buffer_load_dwordx4 v[188:191], v112, s[24:27], s30 offen offset:0 sc1
  v_mfma_f32_16x16x32_bf16 v[48:51], a[76:79], v[244:247], v[48:51]
  v_rcp_f32 v130, v130
  v_mfma_f32_16x16x32_bf16 v[52:55], a[76:79], v[252:255], v[52:55]
  v_rcp_f32 v131, v131
  v_mfma_f32_16x16x32_bf16 v[52:55], a[56:59], v[248:251], v[52:55]
  v_rcp_f32 v132, v132
  v_mfma_f32_16x16x32_bf16 v[56:59], a[56:59], v[136:139], v[56:59]
  buffer_load_dwordx4 v[192:195], v112, s[24:27], s30 offen offset:1024 sc1
  v_mfma_f32_16x16x32_bf16 v[56:59], a[76:79], v[140:143], v[56:59]
  v_mul_f32 v98, v98, v129
  v_mul_f32 v99, v99, v130
  v_mfma_f32_16x16x32_bf16 v[60:63], a[76:79], v[148:151], v[60:63]
  v_mul_f32 v100, v100, v131
  v_mul_f32 v101, v101, v132
  v_mfma_f32_16x16x32_bf16 v[60:63], a[56:59], v[144:147], v[60:63]
  v_cvt_pk_bf16_f32 v98, v98, v98
  v_cvt_pk_bf16_f32 v99, v99, v99
  v_mfma_f32_16x16x32_bf16 v[64:67], a[60:63], v[240:243], v[64:67]
  buffer_load_dwordx4 v[196:199], v113, s[24:27], s30 offen offset:0 sc1
  v_mfma_f32_16x16x32_bf16 v[64:67], a[80:83], v[244:247], v[64:67]
  v_cvt_pk_bf16_f32 v100, v100, v100
  v_cvt_pk_bf16_f32 v101, v101, v101
  v_mfma_f32_16x16x32_bf16 v[68:71], a[80:83], v[252:255], v[68:71]
  v_lshlrev_b32 v98, 16, v98
  v_lshlrev_b32 v99, 16, v99
  v_mfma_f32_16x16x32_bf16 v[68:71], a[60:63], v[248:251], v[68:71]
  v_lshlrev_b32 v100, 16, v100
  v_lshlrev_b32 v101, 16, v101
  v_mfma_f32_16x16x32_bf16 v[72:75], a[60:63], v[136:139], v[72:75]
  buffer_load_dwordx4 v[200:203], v113, s[24:27], s30 offen offset:1024 sc1
  v_mfma_f32_16x16x32_bf16 v[72:75], a[80:83], v[140:143], v[72:75]
  v_cvt_pk_bf16_f32 v168, v168, v168
  v_cvt_pk_bf16_f32 v169, v169, v169
  v_mfma_f32_16x16x32_bf16 v[76:79], a[80:83], v[148:151], v[76:79]
  v_cvt_pk_bf16_f32 v170, v170, v170
  v_cvt_pk_bf16_f32 v171, v171, v171
  v_mfma_f32_16x16x32_bf16 v[76:79], a[60:63], v[144:147], v[76:79]
  v_lshlrev_b32 v168, 16, v168
  v_lshlrev_b32 v169, 16, v169
  s_waitcnt vmcnt(8)
  v_mfma_f32_16x16x32_bf16 v[0:3], a[84:87], v[152:155], v[0:3]
  s_add_u32 s30, s30, 8192
  buffer_load_dwordx4 v[204:207], v110, s[24:27], s30 offen offset:0 sc1
  v_mfma_f32_16x16x32_bf16 v[0:3], a[104:107], a[180:183], v[0:3]
  v_lshlrev_b32 v170, 16, v170
  v_lshlrev_b32 v171, 16, v171
  v_mfma_f32_16x16x32_bf16 v[4:7], a[104:107], a[188:191], v[4:7]
  v_mul_f32 v168, v168, v124
  v_mul_f32 v169, v169, v124
  v_mfma_f32_16x16x32_bf16 v[4:7], a[84:87], a[184:187], v[4:7]
  v_mul_f32 v170, v170, v124
  v_mul_f32 v171, v171, v124
  v_mfma_f32_16x16x32_bf16 v[8:11], a[84:87], a[192:195], v[8:11]
  buffer_load_dwordx4 v[208:211], v110, s[24:27], s30 offen offset:1024 sc1
  v_mfma_f32_16x16x32_bf16 v[8:11], a[104:107], a[196:199], v[8:11]
  v_cvt_pk_bf16_f32 v168, v168, v168
  v_cvt_pk_bf16_f32 v169, v169, v169
  v_mfma_f32_16x16x32_bf16 v[12:15], a[104:107], a[204:207], v[12:15]
  v_cvt_pk_bf16_f32 v170, v170, v170
  v_cvt_pk_bf16_f32 v171, v171, v171
  v_mfma_f32_16x16x32_bf16 v[12:15], a[84:87], a[200:203], v[12:15]
  v_lshlrev_b32 v168, 16, v168
  v_lshlrev_b32 v169, 16, v169
  v_mfma_f32_16x16x32_bf16 v[16:19], a[88:91], v[152:155], v[16:19]
  buffer_load_dwordx4 v[212:215], v111, s[24:27], s30 offen offset:0 sc1
  v_mfma_f32_16x16x32_bf16 v[16:19], a[108:111], a[180:183], v[16:19]
  v_lshlrev_b32 v170, 16, v170
  v_lshlrev_b32 v171, 16, v171
  v_mfma_f32_16x16x32_bf16 v[20:23], a[108:111], a[188:191], v[20:23]
  v_add_f32 v102, v102, v168
  v_add_f32 v103, v103, v169
  v_mfma_f32_16x16x32_bf16 v[20:23], a[88:91], a[184:187], v[20:23]
  v_add_f32 v104, v104, v170
  v_add_f32 v105, v105, v171
  v_mfma_f32_16x16x32_bf16 v[24:27], a[88:91], a[192:195], v[24:27]
  buffer_load_dwordx4 v[216:219], v111, s[24:27], s30 offen offset:1024 sc1
  v_mfma_f32_16x16x32_bf16 v[24:27], a[108:111], a[196:199], v[24:27]
  v_cvt_pk_bf16_f32 v102, v102, v102
  v_cvt_pk_bf16_f32 v103, v103, v103
  v_mfma_f32_16x16x32_bf16 v[28:31], a[108:111], a[204:207], v[28:31]
  v_cvt_pk_bf16_f32 v104, v104, v104
  v_cvt_pk_bf16_f32 v105, v105, v105
  v_mfma_f32_16x16x32_bf16 v[28:31], a[88:91], a[200:203], v[28:31]
  v_lshlrev_b32 v102, 16, v102
  v_lshlrev_b32 v103, 16, v103
  v_mfma_f32_16x16x32_bf16 v[32:35], a[92:95], v[152:155], v[32:35]
  buffer_load_dwordx4 v[220:223], v112, s[24:27], s30 offen offset:0 sc1
  v_mfma_f32_16x16x32_bf16 v[32:35], a[112:115], a[180:183], v[32:35]
  v_lshlrev_b32 v104, 16, v104
  v_lshlrev_b32 v105, 16, v105
  v_mfma_f32_16x16x32_bf16 v[36:39], a[112:115], a[188:191], v[36:39]
  v_mul_f32 v129, 0xbfb8aa3b, v102
  v_mul_f32 v130, 0xbfb8aa3b, v103
  v_mfma_f32_16x16x32_bf16 v[36:39], a[92:95], a[184:187], v[36:39]
  v_mul_f32 v131, 0xbfb8aa3b, v104
  v_mul_f32 v132, 0xbfb8aa3b, v105
  v_mfma_f32_16x16x32_bf16 v[40:43], a[92:95], a[192:195], v[40:43]
  buffer_load_dwordx4 v[224:227], v112, s[24:27], s30 offen offset:1024 sc1
  v_mfma_f32_16x16x32_bf16 v[40:43], a[112:115], a[196:199], v[40:43]
  v_exp_f32 v129, v129
  v_mfma_f32_16x16x32_bf16 v[44:47], a[112:115], a[204:207], v[44:47]
  v_exp_f32 v130, v130
  v_mfma_f32_16x16x32_bf16 v[44:47], a[92:95], a[200:203], v[44:47]
  v_exp_f32 v131, v131
  v_mfma_f32_16x16x32_bf16 v[48:51], a[96:99], v[152:155], v[48:51]
  buffer_load_dwordx4 v[228:231], v113, s[24:27], s30 offen offset:0 sc1
  v_mfma_f32_16x16x32_bf16 v[48:51], a[116:119], a[180:183], v[48:51]
  v_exp_f32 v132, v132
  v_mfma_f32_16x16x32_bf16 v[52:55], a[116:119], a[188:191], v[52:55]
  v_add_f32 v129, 1.0, v129
  v_add_f32 v130, 1.0, v130
  v_mfma_f32_16x16x32_bf16 v[52:55], a[96:99], a[184:187], v[52:55]
  v_add_f32 v131, 1.0, v131
  v_add_f32 v132, 1.0, v132
  v_mfma_f32_16x16x32_bf16 v[56:59], a[96:99], a[192:195], v[56:59]
  buffer_load_dwordx4 v[232:235], v113, s[24:27], s30 offen offset:1024 sc1
  v_mfma_f32_16x16x32_bf16 v[56:59], a[116:119], a[196:199], v[56:59]
  v_rcp_f32 v129, v129
  v_mfma_f32_16x16x32_bf16 v[60:63], a[116:119], a[204:207], v[60:63]
  v_rcp_f32 v130, v130
  v_mfma_f32_16x16x32_bf16 v[60:63], a[96:99], a[200:203], v[60:63]
  v_rcp_f32 v131, v131
  v_mfma_f32_16x16x32_bf16 v[64:67], a[100:103], v[152:155], v[64:67]
  ds_read_b128 v[236:239], v122 offset:0
  s_add_u32 s30, s30, 8192
  v_rcp_f32 v132, v132
  v_mfma_f32_16x16x32_bf16 v[64:67], a[120:123], a[180:183], v[64:67]
  buffer_load_dwordx4 v[240:243], v110, s[24:27], s30 offen offset:0 sc1
  v_mfma_f32_16x16x32_bf16 v[68:71], a[120:123], a[188:191], v[68:71]
  v_mul_f32 v102, v102, v129
  v_mul_f32 v103, v103, v130
  v_mfma_f32_16x16x32_bf16 v[68:71], a[100:103], a[184:187], v[68:71]
  v_mul_f32 v104, v104, v131
  v_mul_f32 v105, v105, v132
  v_mfma_f32_16x16x32_bf16 v[72:75], a[100:103], a[192:195], v[72:75]
  buffer_load_dwordx4 v[244:247], v110, s[24:27], s30 offen offset:1024 sc1
  v_mfma_f32_16x16x32_bf16 v[72:75], a[120:123], a[196:199], v[72:75]
  v_cvt_pk_bf16_f32 v102, v102, v102
  v_cvt_pk_bf16_f32 v103, v103, v103
  v_mfma_f32_16x16x32_bf16 v[76:79], a[120:123], a[204:207], v[76:79]
  v_cvt_pk_bf16_f32 v104, v104, v104
  v_cvt_pk_bf16_f32 v105, v105, v105
  v_mfma_f32_16x16x32_bf16 v[76:79], a[100:103], a[200:203], v[76:79]
  v_lshlrev_b32 v102, 16, v102
  v_lshlrev_b32 v103, 16, v103
  s_waitcnt vmcnt(10)
  v_mfma_f32_16x16x32_bf16 v[0:3], a[124:127], a[208:211], v[0:3]
  ds_read_b128 v[248:251], v122 offset:1024
  v_lshlrev_b32 v104, 16, v104
  v_mfma_f32_16x16x32_bf16 v[0:3], a[176:179], v[176:179], v[0:3]
  buffer_load_dwordx4 v[252:255], v111, s[24:27], s30 offen offset:0 sc1
  v_mfma_f32_16x16x32_bf16 v[4:7], a[176:179], v[184:187], v[4:7]
  v_lshlrev_b32 v105, 16, v105
  v_cvt_pk_bf16_f32 v172, v172, v172
  v_mfma_f32_16x16x32_bf16 v[4:7], a[124:127], v[180:183], v[4:7]
  v_cvt_pk_bf16_f32 v173, v173, v173
  v_cvt_pk_bf16_f32 v174, v174, v174
  v_mfma_f32_16x16x32_bf16 v[8:11], a[124:127], v[188:191], v[8:11]
  buffer_load_dwordx4 v[136:139], v111, s[24:27], s30 offen offset:1024 sc1
  v_mfma_f32_16x16x32_bf16 v[8:11], a[176:179], v[192:195], v[8:11]
  v_cvt_pk_bf16_f32 v175, v175, v175
  v_lshlrev_b32 v172, 16, v172
  v_mfma_f32_16x16x32_bf16 v[12:15], a[176:179], v[200:203], v[12:15]
  v_lshlrev_b32 v173, 16, v173
  v_lshlrev_b32 v174, 16, v174
  v_mfma_f32_16x16x32_bf16 v[12:15], a[124:127], v[196:199], v[12:15]
  v_lshlrev_b32 v175, 16, v175
  v_mul_f32 v172, v172, v124
  s_waitcnt lgkmcnt(1)
  v_mfma_f32_16x16x32_bf16 v[16:19], a[160:163], a[208:211], v[16:19]
  ds_read_b128 v[140:143], v122 offset:2048
  v_mul_f32 v173, v173, v124
  v_mfma_f32_16x16x32_bf16 v[16:19], v[236:239], v[176:179], v[16:19]
  buffer_load_dwordx4 v[144:147], v112, s[24:27], s30 offen offset:0 sc1
  v_mfma_f32_16x16x32_bf16 v[20:23], v[236:239], v[184:187], v[20:23]
  v_mul_f32 v174, v174, v124
  v_mul_f32 v175, v175, v124
  v_mfma_f32_16x16x32_bf16 v[20:23], a[160:163], v[180:183], v[20:23]
  v_cvt_pk_bf16_f32 v172, v172, v172
  v_cvt_pk_bf16_f32 v173, v173, v173
  v_mfma_f32_16x16x32_bf16 v[24:27], a[160:163], v[188:191], v[24:27]
  buffer_load_dwordx4 v[148:151], v112, s[24:27], s30 offen offset:1024 sc1
  v_mfma_f32_16x16x32_bf16 v[24:27], v[236:239], v[192:195], v[24:27]
  v_cvt_pk_bf16_f32 v174, v174, v174
  v_cvt_pk_bf16_f32 v175, v175, v175
  v_mfma_f32_16x16x32_bf16 v[28:31], v[236:239], v[200:203], v[28:31]
  v_lshlrev_b32 v172, 16, v172
  v_lshlrev_b32 v173, 16, v173
  v_mfma_f32_16x16x32_bf16 v[28:31], a[160:163], v[196:199], v[28:31]
  v_lshlrev_b32 v174, 16, v174
  v_lshlrev_b32 v175, 16, v175
  s_waitcnt lgkmcnt(1)
  v_mfma_f32_16x16x32_bf16 v[32:35], a[164:167], a[208:211], v[32:35]
  ds_read_b128 v[152:155], v122 offset:3072
  v_add_f32 v106, v106, v172
  v_mfma_f32_16x16x32_bf16 v[32:35], v[248:251], v[176:179], v[32:35]
  buffer_load_dwordx4 a[180:183], v113, s[24:27], s30 offen offset:0 sc1
  v_mfma_f32_16x16x32_bf16 v[36:39], v[248:251], v[184:187], v[36:39]
  v_add_f32 v107, v107, v173
  v_add_f32 v108, v108, v174
  v_mfma_f32_16x16x32_bf16 v[36:39], a[164:167], v[180:183], v[36:39]
  v_add_f32 v109, v109, v175
  v_cvt_pk_bf16_f32 v106, v106, v106
  v_mfma_f32_16x16x32_bf16 v[40:43], a[164:167], v[188:191], v[40:43]
  buffer_load_dwordx4 a[184:187], v113, s[24:27], s30 offen offset:1024 sc1
  v_mfma_f32_16x16x32_bf16 v[40:43], v[248:251], v[192:195], v[40:43]
  v_cvt_pk_bf16_f32 v107, v107, v107
  v_cvt_pk_bf16_f32 v108, v108, v108
  v_mfma_f32_16x16x32_bf16 v[44:47], v[248:251], v[200:203], v[44:47]
  v_cvt_pk_bf16_f32 v109, v109, v109
  v_lshlrev_b32 v106, 16, v106
  v_mfma_f32_16x16x32_bf16 v[44:47], a[164:167], v[196:199], v[44:47]
  v_lshlrev_b32 v107, 16, v107
  v_lshlrev_b32 v108, 16, v108
  s_waitcnt lgkmcnt(1)
  v_mfma_f32_16x16x32_bf16 v[48:51], a[168:171], a[208:211], v[48:51]
  ds_read_b128 a[188:191], v122 offset:16384
  ds_read_b128 a[192:195], v122 offset:33792
  s_mov_b32 s30, s37
  v_mfma_f32_16x16x32_bf16 v[48:51], v[140:143], v[176:179], v[48:51]
  buffer_load_dwordx4 a[196:199], v110, s[24:27], s30 offen offset:0 sc1
  v_mfma_f32_16x16x32_bf16 v[52:55], v[140:143], v[184:187], v[52:55]
  v_lshlrev_b32 v109, 16, v109
  v_mul_f32 v129, 0xbfb8aa3b, v106
  v_mfma_f32_16x16x32_bf16 v[52:55], a[168:171], v[180:183], v[52:55]
  v_mul_f32 v130, 0xbfb8aa3b, v107
  v_mul_f32 v131, 0xbfb8aa3b, v108
  v_mfma_f32_16x16x32_bf16 v[56:59], a[168:171], v[188:191], v[56:59]
  buffer_load_dwordx4 a[200:203], v110, s[24:27], s30 offen offset:1024 sc1
  v_mfma_f32_16x16x32_bf16 v[56:59], v[140:143], v[192:195], v[56:59]
  v_mul_f32 v132, 0xbfb8aa3b, v109
  v_exp_f32 v129, v129
  v_mfma_f32_16x16x32_bf16 v[60:63], v[140:143], v[200:203], v[60:63]
  v_exp_f32 v130, v130
  v_mfma_f32_16x16x32_bf16 v[60:63], a[168:171], v[196:199], v[60:63]
  v_exp_f32 v131, v131
  s_waitcnt lgkmcnt(2)
  v_mfma_f32_16x16x32_bf16 v[64:67], a[172:175], a[208:211], v[64:67]
  ds_read_b128 a[204:207], v122 offset:17408
  ds_read_b128 v[236:239], v122 offset:34816
  v_mfma_f32_16x16x32_bf16 v[64:67], v[152:155], v[176:179], v[64:67]
  v_exp_f32 v132, v132
  v_mfma_f32_16x16x32_bf16 v[68:71], v[152:155], v[184:187], v[68:71]
  v_add_f32 v129, 1.0, v129
  v_add_f32 v130, 1.0, v130
  v_mfma_f32_16x16x32_bf16 v[68:71], a[172:175], v[180:183], v[68:71]
  v_add_f32 v131, 1.0, v131
  v_add_f32 v132, 1.0, v132
  v_mfma_f32_16x16x32_bf16 v[72:75], a[172:175], v[188:191], v[72:75]
  v_rcp_f32 v129, v129
  v_mfma_f32_16x16x32_bf16 v[72:75], v[152:155], v[192:195], v[72:75]
  v_rcp_f32 v130, v130
  v_mfma_f32_16x16x32_bf16 v[76:79], v[152:155], v[200:203], v[76:79]
  v_rcp_f32 v131, v131
  v_mfma_f32_16x16x32_bf16 v[76:79], a[172:175], v[196:199], v[76:79]
  v_rcp_f32 v132, v132
  s_waitcnt vmcnt(10) lgkmcnt(2)
  v_mfma_f32_16x16x32_bf16 v[0:3], a[188:191], v[204:207], v[0:3]
  ds_read_b128 v[248:251], v122 offset:18432
  ds_read_b128 v[140:143], v122 offset:35840
  v_mfma_f32_16x16x32_bf16 v[0:3], a[192:195], v[208:211], v[0:3]
  buffer_load_dwordx4 v[152:155], v111, s[24:27], s30 offen offset:0 sc1
  v_mfma_f32_16x16x32_bf16 v[4:7], a[192:195], v[216:219], v[4:7]
  v_mul_f32 v106, v106, v129
  v_mul_f32 v107, v107, v130
  v_mfma_f32_16x16x32_bf16 v[4:7], a[188:191], v[212:215], v[4:7]
  v_mul_f32 v108, v108, v131
  v_mul_f32 v109, v109, v132
  v_mfma_f32_16x16x32_bf16 v[8:11], a[188:191], v[220:223], v[8:11]
  buffer_load_dwordx4 a[208:211], v111, s[24:27], s30 offen offset:1024 sc1
  v_mfma_f32_16x16x32_bf16 v[8:11], a[192:195], v[224:227], v[8:11]
  v_cvt_pk_bf16_f32 v106, v106, v106
  v_cvt_pk_bf16_f32 v107, v107, v107
  v_mfma_f32_16x16x32_bf16 v[12:15], a[192:195], v[232:235], v[12:15]
  v_cvt_pk_bf16_f32 v108, v108, v108
  v_cvt_pk_bf16_f32 v109, v109, v109
  v_mfma_f32_16x16x32_bf16 v[12:15], a[188:191], v[228:231], v[12:15]
  v_lshlrev_b32 v106, 16, v106
  v_lshlrev_b32 v107, 16, v107
  s_waitcnt lgkmcnt(2)
  v_mfma_f32_16x16x32_bf16 v[16:19], a[204:207], v[204:207], v[16:19]
  ds_read_b128 v[176:179], v122 offset:19456
  ds_read_b128 v[180:183], v135 offset:0
  v_mfma_f32_16x16x32_bf16 v[16:19], v[236:239], v[208:211], v[16:19]
  buffer_load_dwordx4 v[184:187], v112, s[24:27], s30 offen offset:0 sc1
  v_mfma_f32_16x16x32_bf16 v[20:23], v[236:239], v[216:219], v[20:23]
  v_lshlrev_b32 v108, 16, v108
  v_lshlrev_b32 v109, 16, v109
  v_mfma_f32_16x16x32_bf16 v[20:23], a[204:207], v[212:215], v[20:23]
  v_lshlrev_b32 v156, 16, v80
  v_and_b32 v157, s34, v80
  v_mfma_f32_16x16x32_bf16 v[24:27], a[204:207], v[220:223], v[24:27]
  buffer_load_dwordx4 v[188:191], v112, s[24:27], s30 offen offset:1024 sc1
  v_mfma_f32_16x16x32_bf16 v[24:27], v[236:239], v[224:227], v[24:27]
  v_lshlrev_b32 v158, 16, v81
  v_and_b32 v159, s34, v81
  v_mfma_f32_16x16x32_bf16 v[28:31], v[236:239], v[232:235], v[28:31]
  v_lshlrev_b32 v160, 16, v82
  v_and_b32 v161, s34, v82
  v_mfma_f32_16x16x32_bf16 v[28:31], a[204:207], v[228:231], v[28:31]
  v_lshlrev_b32 v162, 16, v83
  v_and_b32 v163, s34, v83
  s_waitcnt lgkmcnt(2)
  v_mfma_f32_16x16x32_bf16 v[32:35], v[248:251], v[204:207], v[32:35]
  ds_read_b128 v[192:195], v122 offset:32768
  ds_read_b128 v[196:199], v135 offset:1024
  v_mfma_f32_16x16x32_bf16 v[32:35], v[140:143], v[208:211], v[32:35]
  buffer_load_dwordx4 v[200:203], v113, s[24:27], s30 offen offset:0 sc1
  v_mfma_f32_16x16x32_bf16 v[36:39], v[140:143], v[216:219], v[36:39]
  v_lshlrev_b32 v164, 16, v84
  v_and_b32 v165, s34, v84
  v_mfma_f32_16x16x32_bf16 v[36:39], v[248:251], v[212:215], v[36:39]
  v_lshlrev_b32 v166, 16, v85
  v_and_b32 v167, s34, v85
  v_mfma_f32_16x16x32_bf16 v[40:43], v[248:251], v[220:223], v[40:43]
  buffer_load_dwordx4 a[188:191], v113, s[24:27], s30 offen offset:1024 sc1
  v_mfma_f32_16x16x32_bf16 v[40:43], v[140:143], v[224:227], v[40:43]
  v_lshlrev_b32 v168, 16, v86
  v_and_b32 v169, s34, v86
  v_mfma_f32_16x16x32_bf16 v[44:47], v[140:143], v[232:235], v[44:47]
  v_lshlrev_b32 v170, 16, v87
  v_and_b32 v171, s34, v87
  v_mfma_f32_16x16x32_bf16 v[44:47], v[248:251], v[228:231], v[44:47]
  v_lshlrev_b32 v172, 16, v88
  v_and_b32 v173, s34, v88
  s_waitcnt lgkmcnt(2)
  v_mfma_f32_16x16x32_bf16 v[48:51], v[176:179], v[204:207], v[48:51]
  ds_read_b128 a[192:195], v135 offset:2048
  ds_read_b128 a[204:207], v135 offset:19456
  s_add_u32 s30, s30, 8192
  v_mfma_f32_16x16x32_bf16 v[48:51], v[180:183], v[208:211], v[48:51]
  buffer_load_dwordx4 v[236:239], v110, s[24:27], s30 offen offset:0 sc1
  v_mfma_f32_16x16x32_bf16 v[52:55], v[180:183], v[216:219], v[52:55]
  v_lshlrev_b32 v174, 16, v89
  v_and_b32 v175, s34, v89
  v_mfma_f32_16x16x32_bf16 v[52:55], v[176:179], v[212:215], v[52:55]
  s_sub_u32 s41, s3, 1
  s_and_b32 s41, s41, 3
  s_lshl_b32 s41, s41, 12
  v_add_u32 v80, s41, v114
  v_mfma_f32_16x16x32_bf16 v[56:59], v[176:179], v[220:223], v[56:59]
  s_sub_u32 s41, s3, 2
  s_and_b32 s41, s41, 3
  s_lshl_b32 s41, s41, 12
  v_add_u32 v81, s41, v114
  v_mfma_f32_16x16x32_bf16 v[56:59], v[180:183], v[224:227], v[56:59]
  s_sub_u32 s41, s3, 3
  s_and_b32 s41, s41, 3
  s_lshl_b32 s41, s41, 12
  v_add_u32 v82, s41, v114
  v_bfe_u32 v129, v114, 8, 1
  v_mfma_f32_16x16x32_bf16 v[60:63], v[180:183], v[232:235], v[60:63]
  v_mul_u32_u24 v129, 24, v129
  v_add_u32 v83, v117, v129
  v_mfma_f32_16x16x32_bf16 v[60:63], v[176:179], v[228:231], v[60:63]
  s_waitcnt lgkmcnt(2)
  v_mfma_f32_16x16x32_bf16 v[64:67], v[192:195], v[204:207], v[64:67]
  ds_read_b128 v[248:251], v135 offset:3072
  ds_read_b128 v[140:143], v122 offset:49152
  v_mfma_f32_16x16x32_bf16 v[64:67], v[196:199], v[208:211], v[64:67]
  v_mfma_f32_16x16x32_bf16 v[68:71], v[196:199], v[216:219], v[68:71]
  v_mfma_f32_16x16x32_bf16 v[68:71], v[192:195], v[212:215], v[68:71]
  v_mfma_f32_16x16x32_bf16 v[72:75], v[192:195], v[220:223], v[72:75]
  v_mfma_f32_16x16x32_bf16 v[72:75], v[196:199], v[224:227], v[72:75]
  v_mfma_f32_16x16x32_bf16 v[76:79], v[196:199], v[232:235], v[76:79]
  v_mfma_f32_16x16x32_bf16 v[76:79], v[192:195], v[228:231], v[76:79]
  s_waitcnt vmcnt(9) lgkmcnt(2)
  v_mfma_f32_16x16x32_bf16 v[0:3], a[192:195], v[240:243], v[0:3]
  ds_read_b128 v[176:179], v135 offset:16384
  ds_read_b128 v[180:183], v122 offset:50176
  s_xor_b32 s38, s40, 1
  v_mfma_f32_16x16x32_bf16 v[0:3], a[204:207], v[244:247], v[0:3]
  buffer_load_dwordx4 v[192:195], v110, s[24:27], s30 offen offset:1024 sc1
  s_lshl_b32 s38, s38, 2
  s_add_u32 s38, s38, s3
  s_lshl_b32 s38, s38, 13
  v_mfma_f32_16x16x32_bf16 v[4:7], a[204:207], v[136:139], v[4:7]
  s_add_u32 s38, s38, 25165824
  s_add_u32 s39, s38, 4096
  v_mfma_f32_16x16x32_bf16 v[4:7], a[192:195], v[252:255], v[4:7]
  v_mfma_f32_16x16x32_bf16 v[8:11], a[192:195], v[144:147], v[8:11]
  buffer_load_dwordx4 v[196:199], v111, s[24:27], s30 offen offset:0 sc1
  v_mfma_f32_16x16x32_bf16 v[8:11], a[204:207], v[148:151], v[8:11]
  v_mfma_f32_16x16x32_bf16 v[12:15], a[204:207], a[184:187], v[12:15]
  v_mfma_f32_16x16x32_bf16 v[12:15], a[192:195], a[180:183], v[12:15]
  s_waitcnt lgkmcnt(2)
  v_mfma_f32_16x16x32_bf16 v[16:19], v[248:251], v[240:243], v[16:19]
  ds_read_b128 v[204:207], v135 offset:17408
  ds_read_b128 v[208:211], v122 offset:51200
  v_mfma_f32_16x16x32_bf16 v[16:19], v[140:143], v[244:247], v[16:19]
  buffer_load_dwordx4 v[212:215], v111, s[24:27], s30 offen offset:1024 sc1
  v_mfma_f32_16x16x32_bf16 v[20:23], v[140:143], v[136:139], v[20:23]
  ds_write_b128 v118, v[4:7] offset:0
  ds_write_b128 v118, v[8:11] offset:5120
  v_mfma_f32_16x16x32_bf16 v[20:23], v[248:251], v[252:255], v[20:23]
  ds_write_b128 v118, v[12:15] offset:10240
  v_mfma_f32_16x16x32_bf16 v[24:27], v[248:251], v[144:147], v[24:27]
  buffer_load_dwordx4 v[216:219], v112, s[24:27], s30 offen offset:0 sc1
  v_mfma_f32_16x16x32_bf16 v[24:27], v[140:143], v[148:151], v[24:27]
  v_mfma_f32_16x16x32_bf16 v[28:31], v[140:143], a[184:187], v[28:31]
  v_mfma_f32_16x16x32_bf16 v[28:31], v[248:251], a[180:183], v[28:31]
  s_waitcnt lgkmcnt(5)
  v_mfma_f32_16x16x32_bf16 v[32:35], v[176:179], v[240:243], v[32:35]
  ds_read_b128 v[220:223], v135 offset:18432
  ds_read_b128 v[224:227], v122 offset:52224
  v_mfma_f32_16x16x32_bf16 v[32:35], v[180:183], v[244:247], v[32:35]
  buffer_load_dwordx4 v[228:231], v112, s[24:27], s30 offen offset:1024 sc1
  v_mfma_f32_16x16x32_bf16 v[36:39], v[180:183], v[136:139], v[36:39]
  ds_write_b128 v118, v[20:23] offset:1024
  ds_write_b128 v118, v[24:27] offset:6144
  v_mfma_f32_16x16x32_bf16 v[36:39], v[176:179], v[252:255], v[36:39]
  ds_write_b128 v118, v[28:31] offset:11264
  v_mfma_f32_16x16x32_bf16 v[40:43], v[176:179], v[144:147], v[40:43]
  buffer_load_dwordx4 v[232:235], v113, s[24:27], s30 offen offset:0 sc1
  v_mfma_f32_16x16x32_bf16 v[40:43], v[180:183], v[148:151], v[40:43]
  v_mfma_f32_16x16x32_bf16 v[44:47], v[180:183], a[184:187], v[44:47]
  v_mfma_f32_16x16x32_bf16 v[44:47], v[176:179], a[180:183], v[44:47]
  s_waitcnt lgkmcnt(8)
  v_mfma_f32_16x16x32_bf16 v[48:51], v[204:207], v[240:243], v[48:51]
  buffer_load_dwordx4 a[192:195], v113, s[24:27], s30 offen offset:1024 sc1
  v_mfma_f32_16x16x32_bf16 v[48:51], v[208:211], v[244:247], v[48:51]
  ds_write_b128 v118, v[36:39] offset:2048
  v_mfma_f32_16x16x32_bf16 v[52:55], v[208:211], v[136:139], v[52:55]
  ds_write_b128 v118, v[40:43] offset:7168
  v_mfma_f32_16x16x32_bf16 v[52:55], v[204:207], v[252:255], v[52:55]
  ds_write_b128 v118, v[44:47] offset:12288
  v_mfma_f32_16x16x32_bf16 v[56:59], v[204:207], v[144:147], v[56:59]
  s_add_u32 s30, s30, 8192
  buffer_load_dwordx4 a[204:207], v110, s[24:27], s30 offen offset:0 sc1
  v_mfma_f32_16x16x32_bf16 v[56:59], v[208:211], v[148:151], v[56:59]
  v_mfma_f32_16x16x32_bf16 v[60:63], v[208:211], a[184:187], v[60:63]
  v_mfma_f32_16x16x32_bf16 v[60:63], v[204:207], a[180:183], v[60:63]
  s_waitcnt lgkmcnt(6)
  v_mfma_f32_16x16x32_bf16 v[64:67], v[220:223], v[240:243], v[64:67]
  buffer_load_dwordx4 v[248:251], v110, s[24:27], s30 offen offset:1024 sc1
  v_mfma_f32_16x16x32_bf16 v[64:67], v[224:227], v[244:247], v[64:67]
  ds_write_b128 v118, v[52:55] offset:3072
  v_mfma_f32_16x16x32_bf16 v[68:71], v[224:227], v[136:139], v[68:71]
  ds_write_b128 v118, v[56:59] offset:8192
  v_mfma_f32_16x16x32_bf16 v[68:71], v[220:223], v[252:255], v[68:71]
  ds_write_b128 v118, v[60:63] offset:13312
  v_mfma_f32_16x16x32_bf16 v[72:75], v[220:223], v[144:147], v[72:75]
  buffer_load_dwordx4 v[140:143], v111, s[24:27], s30 offen offset:0 sc1
  v_mfma_f32_16x16x32_bf16 v[72:75], v[224:227], v[148:151], v[72:75]
  v_mfma_f32_16x16x32_bf16 v[76:79], v[224:227], a[184:187], v[76:79]
  v_mfma_f32_16x16x32_bf16 v[76:79], v[220:223], a[180:183], v[76:79]
  s_nop 1
  ds_write_b128 v118, v[68:71] offset:4096
  s_nop 2
  ds_write_b128 v118, v[72:75] offset:9216
  s_nop 0
  ds_write_b128 v118, v[76:79] offset:14336
  buffer_load_dwordx4 v[176:179], v111, s[24:27], s30 offen offset:1024 sc1
  buffer_load_dwordx4 v[180:183], v112, s[24:27], s30 offen offset:0 sc1
  buffer_load_dwordx4 v[204:207], v112, s[24:27], s30 offen offset:1024 sc1
  buffer_load_dwordx4 v[208:211], v113, s[24:27], s30 offen offset:0 sc1
  buffer_load_dwordx4 v[220:223], v113, s[24:27], s30 offen offset:1024 sc1
  s_add_u32 s30, s30, 8192
  buffer_load_dwordx4 v[224:227], v110, s[24:27], s30 offen offset:0 sc1
  buffer_load_dwordx4 v[240:243], v110, s[24:27], s30 offen offset:1024 sc1
  buffer_load_dwordx4 v[244:247], v111, s[24:27], s30 offen offset:0 sc1
  buffer_load_dwordx4 v[252:255], v111, s[24:27], s30 offen offset:1024 sc1
  buffer_load_dwordx4 v[136:139], v112, s[24:27], s30 offen offset:0 sc1
  buffer_load_dwordx4 v[144:147], v112, s[24:27], s30 offen offset:1024 sc1
  buffer_load_dwordx4 v[148:151], v113, s[24:27], s30 offen offset:0 sc1
  buffer_load_dwordx4 a[180:183], v113, s[24:27], s30 offen offset:1024 sc1
  s_add_u32 s30, s30, 8192
  buffer_load_dwordx4 a[184:187], v110, s[24:27], s30 offen offset:0 sc1
  s_waitcnt lgkmcnt(0)
  s_barrier
  ds_read_b128 v[4:7], v119 offset:0
  ds_read_b128 v[8:11], v120 offset:5120
  ds_read_b128 v[12:15], v121 offset:10240
  ds_read_b128 v[20:23], v119 offset:1024
  ds_read_b128 v[24:27], v120 offset:6144
  ds_read_b128 v[28:31], v121 offset:11264
  ds_read_b128 v[36:39], v119 offset:2048
  ds_read_b128 v[40:43], v120 offset:7168
  ds_read_b128 v[44:47], v121 offset:12288
  ds_read_b128 v[52:55], v119 offset:3072
  ds_read_b128 v[56:59], v120 offset:8192
  ds_read_b128 v[60:63], v121 offset:13312
  ds_read_b128 v[68:71], v119 offset:4096
  ds_read_b128 v[72:75], v120 offset:9216
  ds_read_b128 v[76:79], v121 offset:14336
  s_waitcnt lgkmcnt(12)
  v_add_f32 v4, v4, v8
  v_add_f32 v5, v5, v9
  v_add_f32 v6, v6, v10
  v_add_f32 v7, v7, v11
  v_add_f32 v0, v0, v12
  v_add_f32 v1, v1, v13
  v_add_f32 v2, v2, v14
  v_add_f32 v3, v3, v15
  v_add_f32 v0, v0, v4
  v_add_f32 v1, v1, v5
  v_add_f32 v2, v2, v6
  v_add_f32 v3, v3, v7
  buffer_store_dwordx4 v[0:3], v114, s[24:27], s38 offen offset:0 sc1
  s_waitcnt vmcnt(26)
  s_nop 0
  v_mfma_f32_16x16x32_bf16 v[0:3], a[212:215], a[196:199], 0
  s_waitcnt lgkmcnt(9)
  v_add_f32 v20, v20, v24
  v_add_f32 v21, v21, v25
  v_mfma_f32_16x16x32_bf16 v[0:3], a[232:235], a[200:203], v[0:3]
  v_add_f32 v22, v22, v26
  v_add_f32 v23, v23, v27
  v_mfma_f32_16x16x32_bf16 v[4:7], a[232:235], a[208:211], 0
  v_add_f32 v16, v16, v28
  v_add_f32 v17, v17, v29
  v_mfma_f32_16x16x32_bf16 v[4:7], a[212:215], v[152:155], v[4:7]
  v_add_f32 v18, v18, v30
  v_add_f32 v19, v19, v31
  v_mfma_f32_16x16x32_bf16 v[8:11], a[212:215], v[184:187], 0
  v_add_f32 v16, v16, v20
  v_add_f32 v17, v17, v21
  v_mfma_f32_16x16x32_bf16 v[8:11], a[232:235], v[188:191], v[8:11]
  v_add_f32 v18, v18, v22
  v_add_f32 v19, v19, v23
  v_mfma_f32_16x16x32_bf16 v[12:15], a[232:235], a[188:191], 0
  buffer_store_dwordx4 v[16:19], v114, s[24:27], s38 offen offset:1024 sc1
  s_waitcnt lgkmcnt(6)
  v_mfma_f32_16x16x32_bf16 v[12:15], a[212:215], v[200:203], v[12:15]
  v_add_f32 v36, v36, v40
  v_add_f32 v37, v37, v41
  v_mfma_f32_16x16x32_bf16 v[16:19], a[216:219], a[196:199], 0
  buffer_load_dwordx4 a[212:215], v110, s[24:27], s30 offen offset:1024 sc1
  v_mfma_f32_16x16x32_bf16 v[16:19], a[236:239], a[200:203], v[16:19]
  v_add_f32 v38, v38, v42
  v_add_f32 v39, v39, v43
  v_mfma_f32_16x16x32_bf16 v[20:23], a[236:239], a[208:211], 0
  v_add_f32 v32, v32, v44
  v_add_f32 v33, v33, v45
  v_mfma_f32_16x16x32_bf16 v[20:23], a[216:219], v[152:155], v[20:23]
  v_add_f32 v34, v34, v46
  v_add_f32 v35, v35, v47
  v_mfma_f32_16x16x32_bf16 v[24:27], a[216:219], v[184:187], 0
  buffer_load_dwordx4 a[232:235], v111, s[24:27], s30 offen offset:0 sc1
  v_mfma_f32_16x16x32_bf16 v[24:27], a[236:239], v[188:191], v[24:27]
  v_add_f32 v32, v32, v36
  v_add_f32 v33, v33, v37
  v_mfma_f32_16x16x32_bf16 v[28:31], a[236:239], a[188:191], 0
  v_add_f32 v34, v34, v38
  v_add_f32 v35, v35, v39
  v_mfma_f32_16x16x32_bf16 v[28:31], a[216:219], v[200:203], v[28:31]
  buffer_store_dwordx4 v[32:35], v114, s[24:27], s38 offen offset:2048 sc1
  s_waitcnt lgkmcnt(3)
  s_nop 0
  v_mfma_f32_16x16x32_bf16 v[32:35], a[220:223], a[196:199], 0
  buffer_load_dwordx4 a[216:219], v111, s[24:27], s30 offen offset:1024 sc1
  v_mfma_f32_16x16x32_bf16 v[32:35], a[240:243], a[200:203], v[32:35]
  v_add_f32 v52, v52, v56
  v_add_f32 v53, v53, v57
  v_mfma_f32_16x16x32_bf16 v[36:39], a[240:243], a[208:211], 0
  v_add_f32 v54, v54, v58
  v_add_f32 v55, v55, v59
  v_mfma_f32_16x16x32_bf16 v[36:39], a[220:223], v[152:155], v[36:39]
  v_add_f32 v48, v48, v60
  v_add_f32 v49, v49, v61
  v_mfma_f32_16x16x32_bf16 v[40:43], a[220:223], v[184:187], 0
  buffer_load_dwordx4 a[236:239], v112, s[24:27], s30 offen offset:0 sc1
  v_mfma_f32_16x16x32_bf16 v[40:43], a[240:243], v[188:191], v[40:43]
  v_add_f32 v50, v50, v62
  v_add_f32 v51, v51, v63
  v_mfma_f32_16x16x32_bf16 v[44:47], a[240:243], a[188:191], 0
  v_add_f32 v48, v48, v52
  v_add_f32 v49, v49, v53
  v_mfma_f32_16x16x32_bf16 v[44:47], a[220:223], v[200:203], v[44:47]
  v_add_f32 v50, v50, v54
  v_add_f32 v51, v51, v55
  buffer_store_dwordx4 v[48:51], v114, s[24:27], s38 offen offset:3072 sc1
  s_nop 1
  v_mfma_f32_16x16x32_bf16 v[48:51], a[224:227], a[196:199], 0
  buffer_load_dwordx4 a[220:223], v112, s[24:27], s30 offen offset:1024 sc1
  s_waitcnt lgkmcnt(0)
  v_mfma_f32_16x16x32_bf16 v[48:51], a[244:247], a[200:203], v[48:51]
  v_add_f32 v68, v68, v72
  v_add_f32 v69, v69, v73
  v_mfma_f32_16x16x32_bf16 v[52:55], a[244:247], a[208:211], 0
  v_add_f32 v70, v70, v74
  v_add_f32 v71, v71, v75
  v_mfma_f32_16x16x32_bf16 v[52:55], a[224:227], v[152:155], v[52:55]
  v_add_f32 v64, v64, v76
  v_add_f32 v65, v65, v77
  v_mfma_f32_16x16x32_bf16 v[56:59], a[224:227], v[184:187], 0
  buffer_load_dwordx4 a[240:243], v113, s[24:27], s30 offen offset:0 sc1
  v_mfma_f32_16x16x32_bf16 v[56:59], a[244:247], v[188:191], v[56:59]
  v_add_f32 v66, v66, v78
  v_add_f32 v67, v67, v79
  v_mfma_f32_16x16x32_bf16 v[60:63], a[244:247], a[188:191], 0
  v_add_f32 v64, v64, v68
  v_add_f32 v65, v65, v69
  v_mfma_f32_16x16x32_bf16 v[60:63], a[224:227], v[200:203], v[60:63]
  v_add_f32 v66, v66, v70
  v_add_f32 v67, v67, v71
  buffer_store_dwordx4 v[64:67], v114, s[24:27], s39 offen offset:0 sc1
  s_nop 1
  v_mfma_f32_16x16x32_bf16 v[64:67], a[228:231], a[196:199], 0
  buffer_load_dwordx4 a[224:227], v113, s[24:27], s30 offen offset:1024 sc1
  s_xor_b32 s38, s40, 1
  s_lshl_b32 s38, s38, 7
  s_add_u32 s38, s38, 2834432
  v_mfma_f32_16x16x32_bf16 v[64:67], a[248:251], a[200:203], v[64:67]
  v_mov_b32 v126, 1073741824
  v_writelane_b32 v126, s38, 0
  v_mfma_f32_16x16x32_bf16 v[68:71], a[248:251], a[208:211], 0
  v_mov_b32 v127, 1
  v_mfma_f32_16x16x32_bf16 v[68:71], a[228:231], v[152:155], v[68:71]
  s_xor_b32 s38, s38, 128
  v_mov_b32 v133, s38
  v_mov_b32 v134, 4
  v_mfma_f32_16x16x32_bf16 v[72:75], a[228:231], v[184:187], 0
  s_add_u32 s30, s30, 8192
  buffer_load_dwordx4 a[244:247], v110, s[24:27], s30 offen offset:0 sc1
  v_mfma_f32_16x16x32_bf16 v[72:75], a[248:251], v[188:191], v[72:75]
  v_mfma_f32_16x16x32_bf16 v[76:79], a[248:251], a[188:191], 0
  v_mfma_f32_16x16x32_bf16 v[76:79], a[228:231], v[200:203], v[76:79]
  s_waitcnt vmcnt(30)
  v_mfma_f32_16x16x32_bf16 v[0:3], a[252:255], v[236:239], v[0:3]
  buffer_load_dwordx4 a[228:231], v110, s[24:27], s30 offen offset:1024 sc1
  v_mfma_f32_16x16x32_bf16 v[0:3], a[144:147], v[192:195], v[0:3]
  v_mfma_f32_16x16x32_bf16 v[4:7], a[144:147], v[212:215], v[4:7]
  v_mfma_f32_16x16x32_bf16 v[4:7], a[252:255], v[196:199], v[4:7]
  v_mfma_f32_16x16x32_bf16 v[8:11], a[252:255], v[216:219], v[8:11]
  buffer_load_dwordx4 a[248:251], v111, s[24:27], s30 offen offset:0 sc1
  v_mfma_f32_16x16x32_bf16 v[8:11], a[144:147], v[228:231], v[8:11]
  v_mfma_f32_16x16x32_bf16 v[12:15], a[144:147], a[192:195], v[12:15]
  v_mfma_f32_16x16x32_bf16 v[12:15], a[252:255], v[232:235], v[12:15]
  v_mfma_f32_16x16x32_bf16 v[16:19], a[128:131], v[236:239], v[16:19]
  buffer_load_dwordx4 a[196:199], v111, s[24:27], s30 offen offset:1024 sc1
  v_mfma_f32_16x16x32_bf16 v[16:19], a[148:151], v[192:195], v[16:19]
  v_mfma_f32_16x16x32_bf16 v[20:23], a[148:151], v[212:215], v[20:23]
  v_mfma_f32_16x16x32_bf16 v[20:23], a[128:131], v[196:199], v[20:23]
  v_mfma_f32_16x16x32_bf16 v[24:27], a[128:131], v[216:219], v[24:27]
  buffer_load_dwordx4 a[200:203], v112, s[24:27], s30 offen offset:0 sc1
  v_mfma_f32_16x16x32_bf16 v[24:27], a[148:151], v[228:231], v[24:27]
  v_mfma_f32_16x16x32_bf16 v[28:31], a[148:151], a[192:195], v[28:31]
  v_mfma_f32_16x16x32_bf16 v[28:31], a[128:131], v[232:235], v[28:31]
  v_mfma_f32_16x16x32_bf16 v[32:35], a[132:135], v[236:239], v[32:35]
  buffer_load_dwordx4 a[208:211], v112, s[24:27], s30 offen offset:1024 sc1
  v_mfma_f32_16x16x32_bf16 v[32:35], a[152:155], v[192:195], v[32:35]
  v_mfma_f32_16x16x32_bf16 v[36:39], a[152:155], v[212:215], v[36:39]
  v_mfma_f32_16x16x32_bf16 v[36:39], a[132:135], v[196:199], v[36:39]
  v_mfma_f32_16x16x32_bf16 v[40:43], a[132:135], v[216:219], v[40:43]
  buffer_load_dwordx4 v[184:187], v113, s[24:27], s30 offen offset:0 sc1
  v_mfma_f32_16x16x32_bf16 v[40:43], a[152:155], v[228:231], v[40:43]
  v_mfma_f32_16x16x32_bf16 v[44:47], a[152:155], a[192:195], v[44:47]
  v_mfma_f32_16x16x32_bf16 v[44:47], a[132:135], v[232:235], v[44:47]
  v_mfma_f32_16x16x32_bf16 v[48:51], a[136:139], v[236:239], v[48:51]
  buffer_load_dwordx4 v[188:191], v113, s[24:27], s30 offen offset:1024 sc1
  v_mfma_f32_16x16x32_bf16 v[48:51], a[156:159], v[192:195], v[48:51]
  v_mfma_f32_16x16x32_bf16 v[52:55], a[156:159], v[212:215], v[52:55]
  v_mfma_f32_16x16x32_bf16 v[52:55], a[136:139], v[196:199], v[52:55]
  v_mfma_f32_16x16x32_bf16 v[56:59], a[136:139], v[216:219], v[56:59]
  s_add_u32 s30, s30, 8192
  buffer_load_dwordx4 v[200:203], v110, s[24:27], s30 offen offset:0 sc1
  v_mfma_f32_16x16x32_bf16 v[56:59], a[156:159], v[228:231], v[56:59]
  v_mfma_f32_16x16x32_bf16 v[60:63], a[156:159], a[192:195], v[60:63]
  v_mfma_f32_16x16x32_bf16 v[60:63], a[136:139], v[232:235], v[60:63]
  v_mfma_f32_16x16x32_bf16 v[64:67], a[140:143], v[236:239], v[64:67]
  buffer_load_dwordx4 a[188:191], v110, s[24:27], s30 offen offset:1024 sc1
  v_mfma_f32_16x16x32_bf16 v[64:67], a[0:3], v[192:195], v[64:67]
  v_mfma_f32_16x16x32_bf16 v[68:71], a[0:3], v[212:215], v[68:71]
  v_mfma_f32_16x16x32_bf16 v[68:71], a[140:143], v[196:199], v[68:71]
  v_mfma_f32_16x16x32_bf16 v[72:75], a[140:143], v[216:219], v[72:75]
  buffer_load_dwordx4 a[252:255], v111, s[24:27], s30 offen offset:0 sc1
  v_mfma_f32_16x16x32_bf16 v[72:75], a[0:3], v[228:231], v[72:75]
  v_mfma_f32_16x16x32_bf16 v[76:79], a[0:3], a[192:195], v[76:79]
  v_mfma_f32_16x16x32_bf16 v[76:79], a[140:143], v[232:235], v[76:79]
  s_waitcnt vmcnt(32)
  v_mfma_f32_16x16x32_bf16 v[0:3], a[4:7], a[204:207], v[0:3]
  buffer_load_dwordx4 a[144:147], v111, s[24:27], s30 offen offset:1024 sc1
  v_mfma_f32_16x16x32_bf16 v[0:3], a[24:27], v[248:251], v[0:3]
  v_mfma_f32_16x16x32_bf16 v[4:7], a[24:27], v[176:179], v[4:7]
  v_mfma_f32_16x16x32_bf16 v[4:7], a[4:7], v[140:143], v[4:7]
  v_mfma_f32_16x16x32_bf16 v[8:11], a[4:7], v[180:183], v[8:11]
  buffer_load_dwordx4 a[128:131], v112, s[24:27], s30 offen offset:0 sc1
  v_mfma_f32_16x16x32_bf16 v[8:11], a[24:27], v[204:207], v[8:11]
  v_mfma_f32_16x16x32_bf16 v[12:15], a[24:27], v[220:223], v[12:15]
  v_mfma_f32_16x16x32_bf16 v[12:15], a[4:7], v[208:211], v[12:15]
  v_mfma_f32_16x16x32_bf16 v[16:19], a[8:11], a[204:207], v[16:19]
  buffer_load_dwordx4 a[148:151], v112, s[24:27], s30 offen offset:1024 sc1
  v_mfma_f32_16x16x32_bf16 v[16:19], a[28:31], v[248:251], v[16:19]
  v_mfma_f32_16x16x32_bf16 v[20:23], a[28:31], v[176:179], v[20:23]
  v_mfma_f32_16x16x32_bf16 v[20:23], a[8:11], v[140:143], v[20:23]
  v_mfma_f32_16x16x32_bf16 v[24:27], a[8:11], v[180:183], v[24:27]
  buffer_load_dwordx4 a[132:135], v113, s[24:27], s30 offen offset:0 sc1
  v_mfma_f32_16x16x32_bf16 v[24:27], a[28:31], v[204:207], v[24:27]
  v_mfma_f32_16x16x32_bf16 v[28:31], a[28:31], v[220:223], v[28:31]
  v_mfma_f32_16x16x32_bf16 v[28:31], a[8:11], v[208:211], v[28:31]
  v_mfma_f32_16x16x32_bf16 v[32:35], a[12:15], a[204:207], v[32:35]
  buffer_load_dwordx4 a[152:155], v113, s[24:27], s30 offen offset:1024 sc1
  v_mfma_f32_16x16x32_bf16 v[32:35], a[32:35], v[248:251], v[32:35]
  v_mfma_f32_16x16x32_bf16 v[36:39], a[32:35], v[176:179], v[36:39]
  v_mfma_f32_16x16x32_bf16 v[36:39], a[12:15], v[140:143], v[36:39]
  v_mfma_f32_16x16x32_bf16 v[40:43], a[12:15], v[180:183], v[40:43]
  s_add_u32 s30, s30, 8192
  buffer_load_dwordx4 a[136:139], v110, s[24:27], s30 offen offset:0 sc1
  v_mfma_f32_16x16x32_bf16 v[40:43], a[32:35], v[204:207], v[40:43]
  v_mfma_f32_16x16x32_bf16 v[44:47], a[32:35], v[220:223], v[44:47]
  v_mfma_f32_16x16x32_bf16 v[44:47], a[12:15], v[208:211], v[44:47]
  v_mfma_f32_16x16x32_bf16 v[48:51], a[16:19], a[204:207], v[48:51]
  buffer_load_dwordx4 a[156:159], v110, s[24:27], s30 offen offset:1024 sc1
  v_mfma_f32_16x16x32_bf16 v[48:51], a[36:39], v[248:251], v[48:51]
  v_mfma_f32_16x16x32_bf16 v[52:55], a[36:39], v[176:179], v[52:55]
  v_mfma_f32_16x16x32_bf16 v[52:55], a[16:19], v[140:143], v[52:55]
  v_mfma_f32_16x16x32_bf16 v[56:59], a[16:19], v[180:183], v[56:59]
  buffer_load_dwordx4 a[140:143], v111, s[24:27], s30 offen offset:0 sc1
  v_mfma_f32_16x16x32_bf16 v[56:59], a[36:39], v[204:207], v[56:59]
  v_mfma_f32_16x16x32_bf16 v[60:63], a[36:39], v[220:223], v[60:63]
  v_mfma_f32_16x16x32_bf16 v[60:63], a[16:19], v[208:211], v[60:63]
  v_mfma_f32_16x16x32_bf16 v[64:67], a[20:23], a[204:207], v[64:67]
  buffer_load_dwordx4 a[0:3], v111, s[24:27], s30 offen offset:1024 sc1
  v_mfma_f32_16x16x32_bf16 v[64:67], a[40:43], v[248:251], v[64:67]
  v_mfma_f32_16x16x32_bf16 v[68:71], a[40:43], v[176:179], v[68:71]
  v_mfma_f32_16x16x32_bf16 v[68:71], a[20:23], v[140:143], v[68:71]
  v_mfma_f32_16x16x32_bf16 v[72:75], a[20:23], v[180:183], v[72:75]
  buffer_load_dwordx4 v[236:239], v112, s[24:27], s30 offen offset:0 sc1
  v_mfma_f32_16x16x32_bf16 v[72:75], a[40:43], v[204:207], v[72:75]
  v_mfma_f32_16x16x32_bf16 v[76:79], a[40:43], v[220:223], v[76:79]
  v_mfma_f32_16x16x32_bf16 v[76:79], a[20:23], v[208:211], v[76:79]
  s_waitcnt vmcnt(34)
  v_mfma_f32_16x16x32_bf16 v[0:3], a[44:47], v[224:227], v[0:3]
  buffer_load_dwordx4 v[192:195], v112, s[24:27], s30 offen offset:1024 sc1
  s_waitcnt vmcnt(23)
  v_mfma_f32_16x16x32_bf16 v[0:3], a[64:67], v[240:243], v[0:3]
  buffer_atomic_add v127, v126, s[24:27], 0 offen
  v_mfma_f32_16x16x32_bf16 v[4:7], a[64:67], v[252:255], v[4:7]
  v_mfma_f32_16x16x32_bf16 v[4:7], a[44:47], v[244:247], v[4:7]
  v_mfma_f32_16x16x32_bf16 v[8:11], a[44:47], v[136:139], v[8:11]
  buffer_load_dwordx4 v[196:199], v113, s[24:27], s30 offen offset:0 sc1
  v_mfma_f32_16x16x32_bf16 v[8:11], a[64:67], v[144:147], v[8:11]
  v_mfma_f32_16x16x32_bf16 v[12:15], a[64:67], a[180:183], v[12:15]
  v_mfma_f32_16x16x32_bf16 v[12:15], a[44:47], v[148:151], v[12:15]
  v_mfma_f32_16x16x32_bf16 v[16:19], a[48:51], v[224:227], v[16:19]
  buffer_load_dwordx4 v[212:215], v113, s[24:27], s30 offen offset:1024 sc1
  v_mfma_f32_16x16x32_bf16 v[16:19], a[68:71], v[240:243], v[16:19]
  v_mfma_f32_16x16x32_bf16 v[20:23], a[68:71], v[252:255], v[20:23]
  v_mfma_f32_16x16x32_bf16 v[20:23], a[48:51], v[244:247], v[20:23]
  v_mfma_f32_16x16x32_bf16 v[24:27], a[48:51], v[136:139], v[24:27]
  s_add_u32 s30, s30, 8192
  v_mfma_f32_16x16x32_bf16 v[24:27], a[68:71], v[144:147], v[24:27]
  v_mfma_f32_16x16x32_bf16 v[28:31], a[68:71], a[180:183], v[28:31]
  v_mfma_f32_16x16x32_bf16 v[28:31], a[48:51], v[148:151], v[28:31]
  v_mfma_f32_16x16x32_bf16 v[32:35], a[52:55], v[224:227], v[32:35]
  v_mfma_f32_16x16x32_bf16 v[32:35], a[72:75], v[240:243], v[32:35]
  v_mfma_f32_16x16x32_bf16 v[36:39], a[72:75], v[252:255], v[36:39]
  v_mfma_f32_16x16x32_bf16 v[36:39], a[52:55], v[244:247], v[36:39]
  v_mfma_f32_16x16x32_bf16 v[40:43], a[52:55], v[136:139], v[40:43]
  v_mfma_f32_16x16x32_bf16 v[40:43], a[72:75], v[144:147], v[40:43]
  v_mfma_f32_16x16x32_bf16 v[44:47], a[72:75], a[180:183], v[44:47]
  v_mfma_f32_16x16x32_bf16 v[44:47], a[52:55], v[148:151], v[44:47]
  v_mfma_f32_16x16x32_bf16 v[48:51], a[56:59], v[224:227], v[48:51]
  v_mfma_f32_16x16x32_bf16 v[48:51], a[76:79], v[240:243], v[48:51]
  v_mfma_f32_16x16x32_bf16 v[52:55], a[76:79], v[252:255], v[52:55]
  v_mfma_f32_16x16x32_bf16 v[52:55], a[56:59], v[244:247], v[52:55]
  v_mfma_f32_16x16x32_bf16 v[56:59], a[56:59], v[136:139], v[56:59]
  v_mfma_f32_16x16x32_bf16 v[56:59], a[76:79], v[144:147], v[56:59]
  v_mfma_f32_16x16x32_bf16 v[60:63], a[76:79], a[180:183], v[60:63]
  v_mfma_f32_16x16x32_bf16 v[60:63], a[56:59], v[148:151], v[60:63]
  v_mfma_f32_16x16x32_bf16 v[64:67], a[60:63], v[224:227], v[64:67]
  v_mfma_f32_16x16x32_bf16 v[64:67], a[80:83], v[240:243], v[64:67]
  v_mfma_f32_16x16x32_bf16 v[68:71], a[80:83], v[252:255], v[68:71]
  v_mfma_f32_16x16x32_bf16 v[68:71], a[60:63], v[244:247], v[68:71]
  v_mfma_f32_16x16x32_bf16 v[72:75], a[60:63], v[136:139], v[72:75]
  v_mfma_f32_16x16x32_bf16 v[72:75], a[80:83], v[144:147], v[72:75]
  v_mfma_f32_16x16x32_bf16 v[76:79], a[80:83], a[180:183], v[76:79]
  v_mfma_f32_16x16x32_bf16 v[76:79], a[60:63], v[148:151], v[76:79]
  s_waitcnt vmcnt(25)
  v_mfma_f32_16x16x32_bf16 v[0:3], a[84:87], a[184:187], v[0:3]
  v_mfma_f32_16x16x32_bf16 v[0:3], a[104:107], a[212:215], v[0:3]
  v_mfma_f32_16x16x32_bf16 v[4:7], a[104:107], a[216:219], v[4:7]
  v_mfma_f32_16x16x32_bf16 v[4:7], a[84:87], a[232:235], v[4:7]
  v_mfma_f32_16x16x32_bf16 v[8:11], a[84:87], a[236:239], v[8:11]
  v_mfma_f32_16x16x32_bf16 v[8:11], a[104:107], a[220:223], v[8:11]
  v_mfma_f32_16x16x32_bf16 v[12:15], a[104:107], a[224:227], v[12:15]
  v_mfma_f32_16x16x32_bf16 v[12:15], a[84:87], a[240:243], v[12:15]
  v_mfma_f32_16x16x32_bf16 v[16:19], a[88:91], a[184:187], v[16:19]
  v_mfma_f32_16x16x32_bf16 v[16:19], a[108:111], a[212:215], v[16:19]
  v_mfma_f32_16x16x32_bf16 v[20:23], a[108:111], a[216:219], v[20:23]
  v_mfma_f32_16x16x32_bf16 v[20:23], a[88:91], a[232:235], v[20:23]
  v_mfma_f32_16x16x32_bf16 v[24:27], a[88:91], a[236:239], v[24:27]
  v_mfma_f32_16x16x32_bf16 v[24:27], a[108:111], a[220:223], v[24:27]
  v_mfma_f32_16x16x32_bf16 v[28:31], a[108:111], a[224:227], v[28:31]
  v_mfma_f32_16x16x32_bf16 v[28:31], a[88:91], a[240:243], v[28:31]
  v_mfma_f32_16x16x32_bf16 v[32:35], a[92:95], a[184:187], v[32:35]
  v_mfma_f32_16x16x32_bf16 v[32:35], a[112:115], a[212:215], v[32:35]
  v_mfma_f32_16x16x32_bf16 v[36:39], a[112:115], a[216:219], v[36:39]
  v_mfma_f32_16x16x32_bf16 v[36:39], a[92:95], a[232:235], v[36:39]
  v_mfma_f32_16x16x32_bf16 v[40:43], a[92:95], a[236:239], v[40:43]
  v_mfma_f32_16x16x32_bf16 v[40:43], a[112:115], a[220:223], v[40:43]
  v_mfma_f32_16x16x32_bf16 v[44:47], a[112:115], a[224:227], v[44:47]
  v_mfma_f32_16x16x32_bf16 v[44:47], a[92:95], a[240:243], v[44:47]
  v_mfma_f32_16x16x32_bf16 v[48:51], a[96:99], a[184:187], v[48:51]
  v_mfma_f32_16x16x32_bf16 v[48:51], a[116:119], a[212:215], v[48:51]
  v_mfma_f32_16x16x32_bf16 v[52:55], a[116:119], a[216:219], v[52:55]
  v_mfma_f32_16x16x32_bf16 v[52:55], a[96:99], a[232:235], v[52:55]
  v_mfma_f32_16x16x32_bf16 v[56:59], a[96:99], a[236:239], v[56:59]
  v_mfma_f32_16x16x32_bf16 v[56:59], a[116:119], a[220:223], v[56:59]
  v_mfma_f32_16x16x32_bf16 v[60:63], a[116:119], a[224:227], v[60:63]
  v_mfma_f32_16x16x32_bf16 v[60:63], a[96:99], a[240:243], v[60:63]
  v_mfma_f32_16x16x32_bf16 v[64:67], a[100:103], a[184:187], v[64:67]
  ds_read_b128 v[216:219], v122 offset:0
  v_mfma_f32_16x16x32_bf16 v[64:67], a[120:123], a[212:215], v[64:67]
  v_mfma_f32_16x16x32_bf16 v[68:71], a[120:123], a[216:219], v[68:71]
  v_mfma_f32_16x16x32_bf16 v[68:71], a[100:103], a[232:235], v[68:71]
  v_mfma_f32_16x16x32_bf16 v[72:75], a[100:103], a[236:239], v[72:75]
  v_mfma_f32_16x16x32_bf16 v[72:75], a[120:123], a[220:223], v[72:75]
  v_mfma_f32_16x16x32_bf16 v[76:79], a[120:123], a[224:227], v[76:79]
  v_mfma_f32_16x16x32_bf16 v[76:79], a[100:103], a[240:243], v[76:79]
  s_waitcnt vmcnt(17)
  v_mfma_f32_16x16x32_bf16 v[0:3], a[124:127], a[244:247], v[0:3]
  ds_read_b128 v[228:231], v122 offset:1024
  buffer_load_dword v128, v133, s[24:27], 0 offen sc1
  s_xor_b32 s38, s40, 0
  s_lshl_b32 s38, s38, 2
  s_add_u32 s38, s38, s3
  v_mfma_f32_16x16x32_bf16 v[0:3], a[176:179], a[228:231], v[0:3]
  s_lshl_b32 s38, s38, 13
  s_add_u32 s38, s38, 25165824
  s_add_u32 s39, s38, 4096
  v_mfma_f32_16x16x32_bf16 v[4:7], a[176:179], a[196:199], v[4:7]
  v_mfma_f32_16x16x32_bf16 v[4:7], a[124:127], a[248:251], v[4:7]
  v_mfma_f32_16x16x32_bf16 v[8:11], a[124:127], a[200:203], v[8:11]
  v_mfma_f32_16x16x32_bf16 v[8:11], a[176:179], a[208:211], v[8:11]
  v_mfma_f32_16x16x32_bf16 v[12:15], a[176:179], v[188:191], v[12:15]
  v_mfma_f32_16x16x32_bf16 v[12:15], a[124:127], v[184:187], v[12:15]
  s_waitcnt lgkmcnt(1)
  v_mfma_f32_16x16x32_bf16 v[16:19], a[160:163], a[244:247], v[16:19]
  ds_read_b128 v[232:235], v122 offset:2048
  v_mfma_f32_16x16x32_bf16 v[16:19], v[216:219], a[228:231], v[16:19]
  v_mfma_f32_16x16x32_bf16 v[20:23], v[216:219], a[196:199], v[20:23]
  v_mfma_f32_16x16x32_bf16 v[20:23], a[160:163], a[248:251], v[20:23]
  v_mfma_f32_16x16x32_bf16 v[24:27], a[160:163], a[200:203], v[24:27]
  v_mfma_f32_16x16x32_bf16 v[24:27], v[216:219], a[208:211], v[24:27]
  v_mfma_f32_16x16x32_bf16 v[28:31], v[216:219], v[188:191], v[28:31]
  v_mfma_f32_16x16x32_bf16 v[28:31], a[160:163], v[184:187], v[28:31]
  s_waitcnt lgkmcnt(1)
  v_mfma_f32_16x16x32_bf16 v[32:35], a[164:167], a[244:247], v[32:35]
  ds_read_b128 a[192:195], v122 offset:3072
  v_mfma_f32_16x16x32_bf16 v[32:35], v[228:231], a[228:231], v[32:35]
  v_mfma_f32_16x16x32_bf16 v[36:39], v[228:231], a[196:199], v[36:39]
  v_mfma_f32_16x16x32_bf16 v[36:39], a[164:167], a[248:251], v[36:39]
  v_mfma_f32_16x16x32_bf16 v[40:43], a[164:167], a[200:203], v[40:43]
  v_mfma_f32_16x16x32_bf16 v[40:43], v[228:231], a[208:211], v[40:43]
  v_mfma_f32_16x16x32_bf16 v[44:47], v[228:231], v[188:191], v[44:47]
  v_mfma_f32_16x16x32_bf16 v[44:47], a[164:167], v[184:187], v[44:47]
  s_waitcnt lgkmcnt(1)
  v_mfma_f32_16x16x32_bf16 v[48:51], a[168:171], a[244:247], v[48:51]
  ds_read_b128 a[4:7], v122 offset:16384
  ds_read_b128 a[24:27], v122 offset:33792
  v_mfma_f32_16x16x32_bf16 v[48:51], v[232:235], a[228:231], v[48:51]
  v_mfma_f32_16x16x32_bf16 v[52:55], v[232:235], a[196:199], v[52:55]
  v_mfma_f32_16x16x32_bf16 v[52:55], a[168:171], a[248:251], v[52:55]
  v_mfma_f32_16x16x32_bf16 v[56:59], a[168:171], a[200:203], v[56:59]
  v_mfma_f32_16x16x32_bf16 v[56:59], v[232:235], a[208:211], v[56:59]
  v_mfma_f32_16x16x32_bf16 v[60:63], v[232:235], v[188:191], v[60:63]
  v_mfma_f32_16x16x32_bf16 v[60:63], a[168:171], v[184:187], v[60:63]
  s_waitcnt lgkmcnt(2)
  v_mfma_f32_16x16x32_bf16 v[64:67], a[172:175], a[244:247], v[64:67]
  ds_read_b128 a[8:11], v122 offset:17408
  ds_read_b128 a[28:31], v122 offset:34816
  v_mfma_f32_16x16x32_bf16 v[64:67], a[192:195], a[228:231], v[64:67]
  v_mfma_f32_16x16x32_bf16 v[68:71], a[192:195], a[196:199], v[68:71]
  v_mfma_f32_16x16x32_bf16 v[68:71], a[172:175], a[248:251], v[68:71]
  v_mfma_f32_16x16x32_bf16 v[72:75], a[172:175], a[200:203], v[72:75]
  v_mfma_f32_16x16x32_bf16 v[72:75], a[192:195], a[208:211], v[72:75]
  v_mfma_f32_16x16x32_bf16 v[76:79], a[192:195], v[188:191], v[76:79]
  v_mfma_f32_16x16x32_bf16 v[76:79], a[172:175], v[184:187], v[76:79]
  s_waitcnt vmcnt(10) lgkmcnt(2)
  v_mfma_f32_16x16x32_bf16 v[0:3], a[4:7], v[200:203], v[0:3]
  ds_read_b128 a[12:15], v122 offset:18432
  ds_read_b128 a[32:35], v122 offset:35840
  v_mfma_f32_16x16x32_bf16 v[0:3], a[24:27], a[188:191], v[0:3]
  v_mfma_f32_16x16x32_bf16 v[4:7], a[24:27], a[144:147], v[4:7]
  v_mfma_f32_16x16x32_bf16 v[4:7], a[4:7], a[252:255], v[4:7]
  v_mfma_f32_16x16x32_bf16 v[8:11], a[4:7], a[128:131], v[8:11]
  v_mfma_f32_16x16x32_bf16 v[8:11], a[24:27], a[148:151], v[8:11]
  v_mfma_f32_16x16x32_bf16 v[12:15], a[24:27], a[152:155], v[12:15]
  v_mfma_f32_16x16x32_bf16 v[12:15], a[4:7], a[132:135], v[12:15]
  s_waitcnt lgkmcnt(2)
  v_mfma_f32_16x16x32_bf16 v[16:19], a[8:11], v[200:203], v[16:19]
  ds_read_b128 a[16:19], v122 offset:19456
  ds_read_b128 a[36:39], v135 offset:0
  v_mfma_f32_16x16x32_bf16 v[16:19], a[28:31], a[188:191], v[16:19]
  v_mfma_f32_16x16x32_bf16 v[20:23], a[28:31], a[144:147], v[20:23]
  v_mfma_f32_16x16x32_bf16 v[20:23], a[8:11], a[252:255], v[20:23]
  v_mfma_f32_16x16x32_bf16 v[24:27], a[8:11], a[128:131], v[24:27]
  v_mfma_f32_16x16x32_bf16 v[24:27], a[28:31], a[148:151], v[24:27]
  v_mfma_f32_16x16x32_bf16 v[28:31], a[28:31], a[152:155], v[28:31]
  v_mfma_f32_16x16x32_bf16 v[28:31], a[8:11], a[132:135], v[28:31]
  s_waitcnt lgkmcnt(2)
  v_mfma_f32_16x16x32_bf16 v[32:35], a[12:15], v[200:203], v[32:35]
  ds_read_b128 a[20:23], v122 offset:32768
  ds_read_b128 a[40:43], v135 offset:1024
  v_mfma_f32_16x16x32_bf16 v[32:35], a[32:35], a[188:191], v[32:35]
  v_mfma_f32_16x16x32_bf16 v[36:39], a[32:35], a[144:147], v[36:39]
  v_mfma_f32_16x16x32_bf16 v[36:39], a[12:15], a[252:255], v[36:39]
  v_mfma_f32_16x16x32_bf16 v[40:43], a[12:15], a[128:131], v[40:43]
  v_mfma_f32_16x16x32_bf16 v[40:43], a[32:35], a[148:151], v[40:43]
  v_mfma_f32_16x16x32_bf16 v[44:47], a[32:35], a[152:155], v[44:47]
  v_mfma_f32_16x16x32_bf16 v[44:47], a[12:15], a[132:135], v[44:47]
  s_waitcnt lgkmcnt(2)
  v_mfma_f32_16x16x32_bf16 v[48:51], a[16:19], v[200:203], v[48:51]
  ds_read_b128 a[204:207], v135 offset:2048
  ds_read_b128 v[248:251], v135 offset:19456
  v_mfma_f32_16x16x32_bf16 v[48:51], a[36:39], a[188:191], v[48:51]
  v_mfma_f32_16x16x32_bf16 v[52:55], a[36:39], a[144:147], v[52:55]
  v_mfma_f32_16x16x32_bf16 v[52:55], a[16:19], a[252:255], v[52:55]
  v_mfma_f32_16x16x32_bf16 v[56:59], a[16:19], a[128:131], v[56:59]
  v_mfma_f32_16x16x32_bf16 v[56:59], a[36:39], a[148:151], v[56:59]
  v_mfma_f32_16x16x32_bf16 v[60:63], a[36:39], a[152:155], v[60:63]
  v_mfma_f32_16x16x32_bf16 v[60:63], a[16:19], a[132:135], v[60:63]
  s_waitcnt lgkmcnt(2)
  v_mfma_f32_16x16x32_bf16 v[64:67], a[20:23], v[200:203], v[64:67]
  ds_read_b128 v[176:179], v135 offset:3072
  ds_read_b128 v[180:183], v122 offset:49152
  v_mfma_f32_16x16x32_bf16 v[64:67], a[40:43], a[188:191], v[64:67]
  v_mfma_f32_16x16x32_bf16 v[68:71], a[40:43], a[144:147], v[68:71]
  v_mfma_f32_16x16x32_bf16 v[68:71], a[20:23], a[252:255], v[68:71]
  v_mfma_f32_16x16x32_bf16 v[72:75], a[20:23], a[128:131], v[72:75]
  v_mfma_f32_16x16x32_bf16 v[72:75], a[40:43], a[148:151], v[72:75]
  v_mfma_f32_16x16x32_bf16 v[76:79], a[40:43], a[152:155], v[76:79]
  v_mfma_f32_16x16x32_bf16 v[76:79], a[20:23], a[132:135], v[76:79]
  s_waitcnt vmcnt(0)
  v_cmp_lt_u32 vcc, v128, v134
  s_nop 0
  s_cbranch_vccz tail_partner
  s_mov_b32 s35, 32768
tail_spin2:
  s_sleep 2
  buffer_load_dword v128, v133, s[24:27], 0 offen sc1
  s_waitcnt vmcnt(0)
  v_cmp_lt_u32 vcc, v128, v134
  s_nop 0
  s_cbranch_vccz tail_partner
  s_sub_u32 s35, s35, 1
  s_cmp_lg_u32 s35, 0
  s_cbranch_scc1 tail_spin2
tail_partner:
  s_waitcnt lgkmcnt(2)
  v_mfma_f32_16x16x32_bf16 v[0:3], a[204:207], a[136:139], v[0:3]
  ds_read_b128 v[204:207], v135 offset:16384
  ds_read_b128 v[208:211], v122 offset:50176
  v_mfma_f32_16x16x32_bf16 v[0:3], v[248:251], a[156:159], v[0:3]
  buffer_load_dwordx4 v[136:139], v114, s[24:27], s38 offen offset:0 sc1
  v_mfma_f32_16x16x32_bf16 v[4:7], v[248:251], a[0:3], v[4:7]
  buffer_load_dwordx4 v[140:143], v114, s[24:27], s38 offen offset:1024 sc1
  v_mfma_f32_16x16x32_bf16 v[4:7], a[204:207], a[140:143], v[4:7]
  buffer_load_dwordx4 v[144:147], v114, s[24:27], s38 offen offset:2048 sc1
  v_mfma_f32_16x16x32_bf16 v[8:11], a[204:207], v[236:239], v[8:11]
  buffer_load_dwordx4 v[148:151], v114, s[24:27], s38 offen offset:3072 sc1
  v_mfma_f32_16x16x32_bf16 v[8:11], v[248:251], v[192:195], v[8:11]
  buffer_load_dwordx4 v[152:155], v114, s[24:27], s39 offen offset:0 sc1
  v_mfma_f32_16x16x32_bf16 v[12:15], v[248:251], v[212:215], v[12:15]
  v_mfma_f32_16x16x32_bf16 v[12:15], a[204:207], v[196:199], v[12:15]
  s_waitcnt lgkmcnt(2)
  v_mfma_f32_16x16x32_bf16 v[16:19], v[176:179], a[136:139], v[16:19]
  ds_read_b128 v[220:223], v135 offset:17408
  ds_read_b128 a[44:47], v122 offset:51200
  v_mfma_f32_16x16x32_bf16 v[16:19], v[180:183], a[156:159], v[16:19]
  ds_write_b128 v122, v[4:7] offset:0
  ds_write_b128 v122, v[8:11] offset:17408
  v_mfma_f32_16x16x32_bf16 v[20:23], v[180:183], a[0:3], v[20:23]
  ds_write_b128 v122, v[12:15] offset:34816
  v_mfma_f32_16x16x32_bf16 v[20:23], v[176:179], a[140:143], v[20:23]
  v_mfma_f32_16x16x32_bf16 v[24:27], v[176:179], v[236:239], v[24:27]
  v_mfma_f32_16x16x32_bf16 v[24:27], v[180:183], v[192:195], v[24:27]
  v_mfma_f32_16x16x32_bf16 v[28:31], v[180:183], v[212:215], v[28:31]
  v_mfma_f32_16x16x32_bf16 v[28:31], v[176:179], v[196:199], v[28:31]
  s_waitcnt lgkmcnt(5)
  v_mfma_f32_16x16x32_bf16 v[32:35], v[204:207], a[136:139], v[32:35]
  ds_read_b128 a[64:67], v135 offset:18432
  ds_read_b128 a[48:51], v122 offset:52224
  v_mfma_f32_16x16x32_bf16 v[32:35], v[208:211], a[156:159], v[32:35]
  ds_write_b128 v122, v[20:23] offset:1024
  ds_write_b128 v122, v[24:27] offset:18432
  v_mfma_f32_16x16x32_bf16 v[36:39], v[208:211], a[0:3], v[36:39]
  ds_write_b128 v122, v[28:31] offset:35840
  v_mfma_f32_16x16x32_bf16 v[36:39], v[204:207], a[140:143], v[36:39]
  v_mfma_f32_16x16x32_bf16 v[40:43], v[204:207], v[236:239], v[40:43]
  v_mfma_f32_16x16x32_bf16 v[40:43], v[208:211], v[192:195], v[40:43]
  v_mfma_f32_16x16x32_bf16 v[44:47], v[208:211], v[212:215], v[44:47]
  v_mfma_f32_16x16x32_bf16 v[44:47], v[204:207], v[196:199], v[44:47]
  s_waitcnt lgkmcnt(8)
  v_mfma_f32_16x16x32_bf16 v[48:51], v[220:223], a[136:139], v[48:51]
  v_mfma_f32_16x16x32_bf16 v[48:51], a[44:47], a[156:159], v[48:51]
  v_mfma_f32_16x16x32_bf16 v[52:55], a[44:47], a[0:3], v[52:55]
  ds_write_b128 v122, v[36:39] offset:2048
  v_mfma_f32_16x16x32_bf16 v[52:55], v[220:223], a[140:143], v[52:55]
  ds_write_b128 v122, v[40:43] offset:19456
  v_mfma_f32_16x16x32_bf16 v[56:59], v[220:223], v[236:239], v[56:59]
  ds_write_b128 v122, v[44:47] offset:49152
  v_mfma_f32_16x16x32_bf16 v[56:59], a[44:47], v[192:195], v[56:59]
  v_mfma_f32_16x16x32_bf16 v[60:63], a[44:47], v[212:215], v[60:63]
  v_mfma_f32_16x16x32_bf16 v[60:63], v[220:223], v[196:199], v[60:63]
  s_waitcnt lgkmcnt(6)
  v_mfma_f32_16x16x32_bf16 v[64:67], a[64:67], a[136:139], v[64:67]
  ds_write_b128 v122, v[52:55] offset:3072
  v_mfma_f32_16x16x32_bf16 v[64:67], a[48:51], a[156:159], v[64:67]
  v_mfma_f32_16x16x32_bf16 v[68:71], a[48:51], a[0:3], v[68:71]
  v_mfma_f32_16x16x32_bf16 v[68:71], a[64:67], a[140:143], v[68:71]
  ds_write_b128 v122, v[56:59] offset:32768
  v_mfma_f32_16x16x32_bf16 v[72:75], a[64:67], v[236:239], v[72:75]
  ds_write_b128 v122, v[60:63] offset:50176
  v_mfma_f32_16x16x32_bf16 v[72:75], a[48:51], v[192:195], v[72:75]
  v_mfma_f32_16x16x32_bf16 v[76:79], a[48:51], v[212:215], v[76:79]
  v_mfma_f32_16x16x32_bf16 v[76:79], a[64:67], v[196:199], v[76:79]
  s_nop 1
  ds_write_b128 v122, v[68:71] offset:16384
  s_nop 2
  ds_write_b128 v122, v[72:75] offset:33792
  s_nop 0
  ds_write_b128 v122, v[76:79] offset:51200
  s_waitcnt lgkmcnt(0)
  s_barrier
  ds_read_b128 v[4:7], v80 offset:0
  ds_read_b128 v[8:11], v81 offset:17408
  ds_read_b128 v[12:15], v82 offset:34816
  ds_read_b128 v[20:23], v80 offset:1024
  ds_read_b128 v[24:27], v81 offset:18432
  ds_read_b128 v[28:31], v82 offset:35840
  ds_read_b128 v[36:39], v80 offset:2048
  ds_read_b128 v[40:43], v81 offset:19456
  ds_read_b128 v[44:47], v82 offset:49152
  ds_read_b128 v[52:55], v80 offset:3072
  ds_read_b128 v[56:59], v81 offset:32768
  ds_read_b128 v[60:63], v82 offset:50176
  ds_read_b128 v[68:71], v80 offset:16384
  ds_read_b128 v[72:75], v81 offset:33792
  ds_read_b128 v[76:79], v82 offset:51200
  s_waitcnt vmcnt(4)
  v_add_f32 v0, v0, v136
  v_add_f32 v1, v1, v137
  v_add_f32 v2, v2, v138
  v_add_f32 v3, v3, v139
  s_waitcnt lgkmcnt(13)
  v_add_f32 v4, v4, v8
  v_add_f32 v5, v5, v9
  v_add_f32 v6, v6, v10
  v_add_f32 v7, v7, v11
  s_waitcnt lgkmcnt(12)
  v_add_f32 v0, v0, v12
  v_add_f32 v1, v1, v13
  v_add_f32 v2, v2, v14
  v_add_f32 v3, v3, v15
  v_add_f32 v0, v0, v4
  v_add_f32 v1, v1, v5
  v_add_f32 v2, v2, v6
  v_add_f32 v3, v3, v7
  v_cvt_pk_bf16_f32 v4, v0, v1
  v_cvt_pk_bf16_f32 v5, v2, v3
  v_lshlrev_b32 v0, 16, v4
  v_and_b32 v1, s34, v4
  v_lshlrev_b32 v2, 16, v5
  v_and_b32 v3, s34, v5
  v_mul_f32 v0, v0, v90
  v_mul_f32 v1, v1, v91
  v_mul_f32 v2, v2, v92
  v_mul_f32 v3, v3, v93
  v_cvt_pk_bf16_f32 v4, v0, v1
  v_cvt_pk_bf16_f32 v5, v2, v3
  v_lshlrev_b32 v0, 16, v4
  v_and_b32 v1, s34, v4
  v_lshlrev_b32 v2, 16, v5
  v_and_b32 v3, s34, v5
  v_add_f32 v0, v0, v156
  v_add_f32 v1, v1, v157
  v_add_f32 v2, v2, v158
  v_add_f32 v3, v3, v159
  v_cvt_pk_bf16_f32 v4, v0, v1
  v_cvt_pk_bf16_f32 v5, v2, v3
  s_waitcnt vmcnt(3)
  v_add_f32 v16, v16, v140
  v_add_f32 v17, v17, v141
  v_add_f32 v18, v18, v142
  v_add_f32 v19, v19, v143
  s_waitcnt lgkmcnt(10)
  v_add_f32 v20, v20, v24
  v_add_f32 v21, v21, v25
  v_add_f32 v22, v22, v26
  v_add_f32 v23, v23, v27
  s_waitcnt lgkmcnt(9)
  v_add_f32 v16, v16, v28
  v_add_f32 v17, v17, v29
  v_add_f32 v18, v18, v30
  v_add_f32 v19, v19, v31
  v_add_f32 v16, v16, v20
  v_add_f32 v17, v17, v21
  v_add_f32 v18, v18, v22
  v_add_f32 v19, v19, v23
  v_cvt_pk_bf16_f32 v20, v16, v17
  v_cvt_pk_bf16_f32 v21, v18, v19
  v_lshlrev_b32 v16, 16, v20
  v_and_b32 v17, s34, v20
  v_lshlrev_b32 v18, 16, v21
  v_and_b32 v19, s34, v21
  v_mul_f32 v16, v16, v94
  v_mul_f32 v17, v17, v95
  v_mul_f32 v18, v18, v96
  v_mul_f32 v19, v19, v97
  v_cvt_pk_bf16_f32 v20, v16, v17
  v_cvt_pk_bf16_f32 v21, v18, v19
  v_lshlrev_b32 v16, 16, v20
  v_and_b32 v17, s34, v20
  v_lshlrev_b32 v18, 16, v21
  v_and_b32 v19, s34, v21
  v_add_f32 v16, v16, v160
  v_add_f32 v17, v17, v161
  v_add_f32 v18, v18, v162
  v_add_f32 v19, v19, v163
  v_cvt_pk_bf16_f32 v6, v16, v17
  v_cvt_pk_bf16_f32 v7, v18, v19
  s_nop 0
  v_permlane16_swap_b32 v4, v6
  v_permlane16_swap_b32 v5, v7
  buffer_store_dwordx4 v[4:7], v83, s[16:19], 0 offen offset:0
  s_waitcnt vmcnt(3)
  v_add_f32 v32, v32, v144
  v_add_f32 v33, v33, v145
  v_add_f32 v34, v34, v146
  v_add_f32 v35, v35, v147
  s_waitcnt lgkmcnt(7)
  v_add_f32 v36, v36, v40
  v_add_f32 v37, v37, v41
  v_add_f32 v38, v38, v42
  v_add_f32 v39, v39, v43
  s_waitcnt lgkmcnt(6)
  v_add_f32 v32, v32, v44
  v_add_f32 v33, v33, v45
  v_add_f32 v34, v34, v46
  v_add_f32 v35, v35, v47
  v_add_f32 v32, v32, v36
  v_add_f32 v33, v33, v37
  v_add_f32 v34, v34, v38
  v_add_f32 v35, v35, v39
  v_cvt_pk_bf16_f32 v36, v32, v33
  v_cvt_pk_bf16_f32 v37, v34, v35
  v_lshlrev_b32 v32, 16, v36
  v_and_b32 v33, s34, v36
  v_lshlrev_b32 v34, 16, v37
  v_and_b32 v35, s34, v37
  v_mul_f32 v32, v32, v98
  v_mul_f32 v33, v33, v99
  v_mul_f32 v34, v34, v100
  v_mul_f32 v35, v35, v101
  v_cvt_pk_bf16_f32 v36, v32, v33
  v_cvt_pk_bf16_f32 v37, v34, v35
  v_lshlrev_b32 v32, 16, v36
  v_and_b32 v33, s34, v36
  v_lshlrev_b32 v34, 16, v37
  v_and_b32 v35, s34, v37
  v_add_f32 v32, v32, v164
  v_add_f32 v33, v33, v165
  v_add_f32 v34, v34, v166
  v_add_f32 v35, v35, v167
  v_cvt_pk_bf16_f32 v36, v32, v33
  v_cvt_pk_bf16_f32 v37, v34, v35
  s_waitcnt vmcnt(2)
  v_add_f32 v48, v48, v148
  v_add_f32 v49, v49, v149
  v_add_f32 v50, v50, v150
  v_add_f32 v51, v51, v151
  s_waitcnt lgkmcnt(4)
  v_add_f32 v52, v52, v56
  v_add_f32 v53, v53, v57
  v_add_f32 v54, v54, v58
  v_add_f32 v55, v55, v59
  s_waitcnt lgkmcnt(3)
  v_add_f32 v48, v48, v60
  v_add_f32 v49, v49, v61
  v_add_f32 v50, v50, v62
  v_add_f32 v51, v51, v63
  v_add_f32 v48, v48, v52
  v_add_f32 v49, v49, v53
  v_add_f32 v50, v50, v54
  v_add_f32 v51, v51, v55
  v_cvt_pk_bf16_f32 v52, v48, v49
  v_cvt_pk_bf16_f32 v53, v50, v51
  v_lshlrev_b32 v48, 16, v52
  v_and_b32 v49, s34, v52
  v_lshlrev_b32 v50, 16, v53
  v_and_b32 v51, s34, v53
  v_mul_f32 v48, v48, v102
  v_mul_f32 v49, v49, v103
  v_mul_f32 v50, v50, v104
  v_mul_f32 v51, v51, v105
  v_cvt_pk_bf16_f32 v52, v48, v49
  v_cvt_pk_bf16_f32 v53, v50, v51
  v_lshlrev_b32 v48, 16, v52
  v_and_b32 v49, s34, v52
  v_lshlrev_b32 v50, 16, v53
  v_and_b32 v51, s34, v53
  v_add_f32 v48, v48, v168
  v_add_f32 v49, v49, v169
  v_add_f32 v50, v50, v170
  v_add_f32 v51, v51, v171
  v_cvt_pk_bf16_f32 v38, v48, v49
  v_cvt_pk_bf16_f32 v39, v50, v51
  s_nop 0
  v_permlane16_swap_b32 v36, v38
  v_permlane16_swap_b32 v37, v39
  buffer_store_dwordx4 v[36:39], v83, s[16:19], 0 offen offset:64
  s_waitcnt vmcnt(2)
  v_add_f32 v64, v64, v152
  v_add_f32 v65, v65, v153
  v_add_f32 v66, v66, v154
  v_add_f32 v67, v67, v155
  s_waitcnt lgkmcnt(1)
  v_add_f32 v68, v68, v72
  v_add_f32 v69, v69, v73
  v_add_f32 v70, v70, v74
  v_add_f32 v71, v71, v75
  s_waitcnt lgkmcnt(0)
  v_add_f32 v64, v64, v76
  v_add_f32 v65, v65, v77
  v_add_f32 v66, v66, v78
  v_add_f32 v67, v67, v79
  v_add_f32 v64, v64, v68
  v_add_f32 v65, v65, v69
  v_add_f32 v66, v66, v70
  v_add_f32 v67, v67, v71
  v_cvt_pk_bf16_f32 v68, v64, v65
  v_cvt_pk_bf16_f32 v69, v66, v67
  v_lshlrev_b32 v64, 16, v68
  v_and_b32 v65, s34, v68
  v_lshlrev_b32 v66, 16, v69
  v_and_b32 v67, s34, v69
  v_mul_f32 v64, v64, v106
  v_mul_f32 v65, v65, v107
  v_mul_f32 v66, v66, v108
  v_mul_f32 v67, v67, v109
  v_cvt_pk_bf16_f32 v68, v64, v65
  v_cvt_pk_bf16_f32 v69, v66, v67
  v_lshlrev_b32 v64, 16, v68
  v_and_b32 v65, s34, v68
  v_lshlrev_b32 v66, 16, v69
  v_and_b32 v67, s34, v69
  v_add_f32 v64, v64, v172
  v_add_f32 v65, v65, v173
  v_add_f32 v66, v66, v174
  v_add_f32 v67, v67, v175
  v_cvt_pk_bf16_f32 v68, v64, v65
  v_cvt_pk_bf16_f32 v69, v66, v67
  buffer_store_dwordx2 v[68:69], v117, s[16:19], 0 offen offset:128
attn_end:
  s_endpgm
attn_redo:
  s_waitcnt vmcnt(0)
  v_accvgpr_write_b32 a0, 0
  v_accvgpr_write_b32 a1, 0
  v_accvgpr_write_b32 a2, 0
  v_accvgpr_write_b32 a3, 0
  v_accvgpr_write_b32 a4, 0
  v_accvgpr_write_b32 a5, 0
  v_accvgpr_write_b32 a6, 0
  v_accvgpr_write_b32 a7, 0
  v_accvgpr_write_b32 a8, 0
  v_accvgpr_write_b32 a9, 0
  v_accvgpr_write_b32 a10, 0
  v_accvgpr_write_b32 a11, 0
  v_accvgpr_write_b32 a12, 0
  v_accvgpr_write_b32 a13, 0
  v_accvgpr_write_b32 a14, 0
  v_accvgpr_write_b32 a15, 0
  v_accvgpr_write_b32 a16, 0
  v_accvgpr_write_b32 a17, 0
  v_accvgpr_write_b32 a18, 0
  v_accvgpr_write_b32 a19, 0
  v_accvgpr_write_b32 a20, 0
  v_accvgpr_write_b32 a21, 0
  v_accvgpr_write_b32 a22, 0
  v_accvgpr_write_b32 a23, 0
  v_accvgpr_write_b32 a24, 0
  v_accvgpr_write_b32 a25, 0
  v_accvgpr_write_b32 a26, 0
  v_accvgpr_write_b32 a27, 0
  v_accvgpr_write_b32 a28, 0
  v_accvgpr_write_b32 a29, 0
  v_accvgpr_write_b32 a30, 0
  v_accvgpr_write_b32 a31, 0
  v_accvgpr_write_b32 a32, 0
  v_accvgpr_write_b32 a33, 0
  v_accvgpr_write_b32 a34, 0
  v_accvgpr_write_b32 a35, 0
  v_accvgpr_write_b32 a36, 0
  v_accvgpr_write_b32 a37, 0
  v_accvgpr_write_b32 a38, 0
  v_accvgpr_write_b32 a39, 0
  v_accvgpr_write_b32 a40, 0
  v_accvgpr_write_b32 a41, 0
  v_accvgpr_write_b32 a42, 0
  v_accvgpr_write_b32 a43, 0
  v_accvgpr_write_b32 a44, 0
  v_accvgpr_write_b32 a45, 0
  v_accvgpr_write_b32 a46, 0
  v_accvgpr_write_b32 a47, 0
  v_accvgpr_write_b32 a48, 0
  v_accvgpr_write_b32 a49, 0
  v_accvgpr_write_b32 a50, 0
  v_accvgpr_write_b32 a51, 0
  v_accvgpr_write_b32 a52, 0
  v_accvgpr_write_b32 a53, 0
  v_accvgpr_write_b32 a54, 0
  v_accvgpr_write_b32 a55, 0
  v_accvgpr_write_b32 a56, 0
  v_accvgpr_write_b32 a57, 0
  v_accvgpr_write_b32 a58, 0
  v_accvgpr_write_b32 a59, 0
  v_accvgpr_write_b32 a60, 0
  v_accvgpr_write_b32 a61, 0
  v_accvgpr_write_b32 a62, 0
  v_accvgpr_write_b32 a63, 0
  v_accvgpr_write_b32 a64, 0
  v_accvgpr_write_b32 a65, 0
  v_accvgpr_write_b32 a66, 0
  v_accvgpr_write_b32 a67, 0
  v_accvgpr_write_b32 a68, 0
  v_accvgpr_write_b32 a69, 0
  v_accvgpr_write_b32 a70, 0
  v_accvgpr_write_b32 a71, 0
  v_accvgpr_write_b32 a72, 0
  v_accvgpr_write_b32 a73, 0
  v_accvgpr_write_b32 a74, 0
  v_accvgpr_write_b32 a75, 0
  v_accvgpr_write_b32 a76, 0
  v_accvgpr_write_b32 a77, 0
  v_accvgpr_write_b32 a78, 0
  v_accvgpr_write_b32 a79, 0
  v_accvgpr_write_b32 a80, 0
  v_accvgpr_write_b32 a81, 0
  v_accvgpr_write_b32 a82, 0
  v_accvgpr_write_b32 a83, 0
  v_accvgpr_write_b32 a84, 0
  v_accvgpr_write_b32 a85, 0
  v_accvgpr_write_b32 a86, 0
  v_accvgpr_write_b32 a87, 0
  v_accvgpr_write_b32 a88, 0
  v_accvgpr_write_b32 a89, 0
  v_accvgpr_write_b32 a90, 0
  v_accvgpr_write_b32 a91, 0
  v_accvgpr_write_b32 a92, 0
  v_accvgpr_write_b32 a93, 0
  v_accvgpr_write_b32 a94, 0
  v_accvgpr_write_b32 a95, 0
  v_accvgpr_write_b32 a96, 0
  v_accvgpr_write_b32 a97, 0
  v_accvgpr_write_b32 a98, 0
  v_accvgpr_write_b32 a99, 0
  v_accvgpr_write_b32 a100, 0
  v_accvgpr_write_b32 a101, 0
  v_accvgpr_write_b32 a102, 0
  v_accvgpr_write_b32 a103, 0
  v_accvgpr_write_b32 a104, 0
  v_accvgpr_write_b32 a105, 0
  v_accvgpr_write_b32 a106, 0
  v_accvgpr_write_b32 a107, 0
  v_accvgpr_write_b32 a108, 0
  v_accvgpr_write_b32 a109, 0
  v_accvgpr_write_b32 a110, 0
  v_accvgpr_write_b32 a111, 0
  v_accvgpr_write_b32 a112, 0
  v_accvgpr_write_b32 a113, 0
  v_accvgpr_write_b32 a114, 0
  v_accvgpr_write_b32 a115, 0
  v_accvgpr_write_b32 a116, 0
  v_accvgpr_write_b32 a117, 0
  v_accvgpr_write_b32 a118, 0
  v_accvgpr_write_b32 a119, 0
  v_accvgpr_write_b32 a120, 0
  v_accvgpr_write_b32 a121, 0
  v_accvgpr_write_b32 a122, 0
  v_accvgpr_write_b32 a123, 0
  v_accvgpr_write_b32 a124, 0
  v_accvgpr_write_b32 a125, 0
  v_accvgpr_write_b32 a126, 0
  v_accvgpr_write_b32 a127, 0
  v_mov_b32 v208, 0
  v_mov_b32 v249, 0xff800000
  v_mov_b32 v209, 0
  v_mov_b32 v250, 0xff800000
  v_mov_b32 v210, 0
  v_mov_b32 v251, 0xff800000
  v_mov_b32 v211, 0
  v_mov_b32 v252, 0xff800000
  s_mov_b32 s29, 0
attn_slow:
  s_barrier
  s_add_u32 m0, s28, 49152
  s_nop 0
  buffer_load_dwordx4 v232, s[12:15], s29 offen offset:0 lds
  buffer_load_dwordx4 v233, s[12:15], s29 offen offset:1024 lds
  buffer_load_dwordx4 v234, s[12:15], s29 offen offset:2048 lds
  buffer_load_dwordx4 v235, s[12:15], s29 offen offset:3072 lds
  s_add_u32 m0, s28, 114688
  s_nop 0
  buffer_load_dwordx4 v236, s[16:19], s29 offen offset:0 lds
  buffer_load_dwordx4 v237, s[16:19], s29 offen offset:1024 lds
  buffer_load_dwordx4 v236, s[16:19], s29 offen offset:2048 lds
  buffer_load_dwordx4 v237, s[16:19], s29 offen offset:3072 lds
  s_waitcnt vmcnt(0)
  s_barrier
  ds_read_b128 a[128:131], v212 offset:49152
  ds_read_b128 a[132:135], v213 offset:49152
  ds_read_b128 a[136:139], v214 offset:49152
  ds_read_b128 a[140:143], v215 offset:49152
  s_waitcnt lgkmcnt(3)
  v_mfma_f32_16x16x32_bf16 v[0:3], a[128:131], v[128:131], 0
  s_waitcnt lgkmcnt(2)
  v_mfma_f32_16x16x32_bf16 v[0:3], a[132:135], v[132:135], v[0:3]
  s_waitcnt lgkmcnt(1)
  v_mfma_f32_16x16x32_bf16 v[0:3], a[136:139], v[136:139], v[0:3]
  s_waitcnt lgkmcnt(0)
  v_mfma_f32_16x16x32_bf16 v[0:3], a[140:143], v[140:143], v[0:3]
  v_mfma_f32_16x16x32_bf16 v[8:11], a[140:143], v[156:159], 0
  v_mfma_f32_16x16x32_bf16 v[8:11], a[136:139], v[152:155], v[8:11]
  v_mfma_f32_16x16x32_bf16 v[8:11], a[132:135], v[148:151], v[8:11]
  v_mfma_f32_16x16x32_bf16 v[8:11], a[128:131], v[144:147], v[8:11]
  v_mfma_f32_16x16x32_bf16 v[16:19], a[128:131], v[160:163], 0
  v_mfma_f32_16x16x32_bf16 v[16:19], a[132:135], v[164:167], v[16:19]
  v_mfma_f32_16x16x32_bf16 v[16:19], a[136:139], v[168:171], v[16:19]
  v_mfma_f32_16x16x32_bf16 v[16:19], a[140:143], v[172:175], v[16:19]
  v_mfma_f32_16x16x32_bf16 v[24:27], a[140:143], v[188:191], 0
  v_mfma_f32_16x16x32_bf16 v[24:27], a[136:139], v[184:187], v[24:27]
  v_mfma_f32_16x16x32_bf16 v[24:27], a[132:135], v[180:183], v[24:27]
  v_mfma_f32_16x16x32_bf16 v[24:27], a[128:131], v[176:179], v[24:27]
  ds_read_b128 a[144:147], v212 offset:53248
  ds_read_b128 a[148:151], v213 offset:53248
  ds_read_b128 a[152:155], v214 offset:53248
  ds_read_b128 a[156:159], v215 offset:53248
  s_waitcnt lgkmcnt(3)
  v_mfma_f32_16x16x32_bf16 v[4:7], a[144:147], v[128:131], 0
  s_waitcnt lgkmcnt(2)
  v_mfma_f32_16x16x32_bf16 v[4:7], a[148:151], v[132:135], v[4:7]
  s_waitcnt lgkmcnt(1)
  v_mfma_f32_16x16x32_bf16 v[4:7], a[152:155], v[136:139], v[4:7]
  s_waitcnt lgkmcnt(0)
  v_mfma_f32_16x16x32_bf16 v[4:7], a[156:159], v[140:143], v[4:7]
  v_mfma_f32_16x16x32_bf16 v[12:15], a[156:159], v[156:159], 0
  v_mfma_f32_16x16x32_bf16 v[12:15], a[152:155], v[152:155], v[12:15]
  v_mfma_f32_16x16x32_bf16 v[12:15], a[148:151], v[148:151], v[12:15]
  v_mfma_f32_16x16x32_bf16 v[12:15], a[144:147], v[144:147], v[12:15]
  v_mfma_f32_16x16x32_bf16 v[20:23], a[144:147], v[160:163], 0
  v_mfma_f32_16x16x32_bf16 v[20:23], a[148:151], v[164:167], v[20:23]
  v_mfma_f32_16x16x32_bf16 v[20:23], a[152:155], v[168:171], v[20:23]
  v_mfma_f32_16x16x32_bf16 v[20:23], a[156:159], v[172:175], v[20:23]
  v_mfma_f32_16x16x32_bf16 v[28:31], a[156:159], v[188:191], 0
  v_mfma_f32_16x16x32_bf16 v[28:31], a[152:155], v[184:187], v[28:31]
  v_mfma_f32_16x16x32_bf16 v[28:31], a[148:151], v[180:183], v[28:31]
  v_mfma_f32_16x16x32_bf16 v[28:31], a[144:147], v[176:179], v[28:31]
  ds_read_b128 a[128:131], v212 offset:57344
  ds_read_b128 a[132:135], v213 offset:57344
  ds_read_b128 a[136:139], v214 offset:57344
  ds_read_b128 a[140:143], v215 offset:57344
  s_waitcnt lgkmcnt(3)
  v_mfma_f32_16x16x32_bf16 v[32:35], a[128:131], v[128:131], 0
  s_waitcnt lgkmcnt(2)
  v_mfma_f32_16x16x32_bf16 v[32:35], a[132:135], v[132:135], v[32:35]
  s_waitcnt lgkmcnt(1)
  v_mfma_f32_16x16x32_bf16 v[32:35], a[136:139], v[136:139], v[32:35]
  s_waitcnt lgkmcnt(0)
  v_mfma_f32_16x16x32_bf16 v[32:35], a[140:143], v[140:143], v[32:35]
  v_mfma_f32_16x16x32_bf16 v[40:43], a[140:143], v[156:159], 0
  v_mfma_f32_16x16x32_bf16 v[40:43], a[136:139], v[152:155], v[40:43]
  v_mfma_f32_16x16x32_bf16 v[40:43], a[132:135], v[148:151], v[40:43]
  v_mfma_f32_16x16x32_bf16 v[40:43], a[128:131], v[144:147], v[40:43]
  v_mfma_f32_16x16x32_bf16 v[48:51], a[128:131], v[160:163], 0
  v_mfma_f32_16x16x32_bf16 v[48:51], a[132:135], v[164:167], v[48:51]
  v_mfma_f32_16x16x32_bf16 v[48:51], a[136:139], v[168:171], v[48:51]
  v_mfma_f32_16x16x32_bf16 v[48:51], a[140:143], v[172:175], v[48:51]
  v_mfma_f32_16x16x32_bf16 v[56:59], a[140:143], v[188:191], 0
  v_mfma_f32_16x16x32_bf16 v[56:59], a[136:139], v[184:187], v[56:59]
  v_mfma_f32_16x16x32_bf16 v[56:59], a[132:135], v[180:183], v[56:59]
  v_mfma_f32_16x16x32_bf16 v[56:59], a[128:131], v[176:179], v[56:59]
  ds_read_b128 a[144:147], v212 offset:61440
  ds_read_b128 a[148:151], v213 offset:61440
  ds_read_b128 a[152:155], v214 offset:61440
  ds_read_b128 a[156:159], v215 offset:61440
  s_waitcnt lgkmcnt(3)
  v_mfma_f32_16x16x32_bf16 v[36:39], a[144:147], v[128:131], 0
  s_waitcnt lgkmcnt(2)
  v_mfma_f32_16x16x32_bf16 v[36:39], a[148:151], v[132:135], v[36:39]
  s_waitcnt lgkmcnt(1)
  v_mfma_f32_16x16x32_bf16 v[36:39], a[152:155], v[136:139], v[36:39]
  s_waitcnt lgkmcnt(0)
  v_mfma_f32_16x16x32_bf16 v[36:39], a[156:159], v[140:143], v[36:39]
  v_mfma_f32_16x16x32_bf16 v[44:47], a[156:159], v[156:159], 0
  v_mfma_f32_16x16x32_bf16 v[44:47], a[152:155], v[152:155], v[44:47]
  v_mfma_f32_16x16x32_bf16 v[44:47], a[148:151], v[148:151], v[44:47]
  v_mfma_f32_16x16x32_bf16 v[44:47], a[144:147], v[144:147], v[44:47]
  v_mfma_f32_16x16x32_bf16 v[52:55], a[144:147], v[160:163], 0
  v_mfma_f32_16x16x32_bf16 v[52:55], a[148:151], v[164:167], v[52:55]
  v_mfma_f32_16x16x32_bf16 v[52:55], a[152:155], v[168:171], v[52:55]
  v_mfma_f32_16x16x32_bf16 v[52:55], a[156:159], v[172:175], v[52:55]
  v_mfma_f32_16x16x32_bf16 v[60:63], a[156:159], v[188:191], 0
  v_mfma_f32_16x16x32_bf16 v[60:63], a[152:155], v[184:187], v[60:63]
  v_mfma_f32_16x16x32_bf16 v[60:63], a[148:151], v[180:183], v[60:63]
  v_mfma_f32_16x16x32_bf16 v[60:63], a[144:147], v[176:179], v[60:63]
  v_mov_b32 v192, v249
  v_max3_f32 v192, v192, v0, v1
  v_max3_f32 v192, v192, v2, v3
  v_max3_f32 v192, v192, v4, v5
  v_max3_f32 v192, v192, v6, v7
  v_max3_f32 v192, v192, v32, v33
  v_max3_f32 v192, v192, v34, v35
  v_max3_f32 v192, v192, v36, v37
  v_max3_f32 v192, v192, v38, v39
  v_mov_b32 v245, v192
  s_nop 1
  v_permlane16_swap_b32 v192, v245
  v_max_f32 v192, v192, v245
  v_mov_b32 v245, v192
  s_nop 1
  v_permlane32_swap_b32 v192, v245
  v_max_f32 v192, v192, v245
  v_sub_f32 v193, v249, v192
  v_exp_f32 v193, v193
  v_mov_b32 v249, v192
  v_mul_f32 v208, v208, v193
  v_sub_f32 v0, v0, v192
  v_sub_f32 v1, v1, v192
  v_sub_f32 v2, v2, v192
  v_sub_f32 v3, v3, v192
  v_sub_f32 v4, v4, v192
  v_sub_f32 v5, v5, v192
  v_sub_f32 v6, v6, v192
  v_sub_f32 v7, v7, v192
  v_sub_f32 v32, v32, v192
  v_sub_f32 v33, v33, v192
  v_sub_f32 v34, v34, v192
  v_sub_f32 v35, v35, v192
  v_sub_f32 v36, v36, v192
  v_sub_f32 v37, v37, v192
  v_sub_f32 v38, v38, v192
  v_sub_f32 v39, v39, v192
  v_exp_f32 v0, v0
  v_exp_f32 v1, v1
  v_add_f32 v208, v208, v0
  v_exp_f32 v2, v2
  v_add_f32 v208, v208, v1
  v_cvt_pk_bf16_f32 v0, v0, v1
  v_exp_f32 v3, v3
  v_add_f32 v208, v208, v2
  v_add_f32 v208, v208, v3
  v_cvt_pk_bf16_f32 v1, v2, v3
  v_exp_f32 v4, v4
  v_exp_f32 v5, v5
  v_add_f32 v208, v208, v4
  v_exp_f32 v6, v6
  v_add_f32 v208, v208, v5
  v_cvt_pk_bf16_f32 v2, v4, v5
  v_exp_f32 v7, v7
  v_add_f32 v208, v208, v6
  v_add_f32 v208, v208, v7
  v_cvt_pk_bf16_f32 v3, v6, v7
  v_exp_f32 v32, v32
  v_exp_f32 v33, v33
  v_add_f32 v208, v208, v32
  v_exp_f32 v34, v34
  v_add_f32 v208, v208, v33
  v_cvt_pk_bf16_f32 v32, v32, v33
  v_exp_f32 v35, v35
  v_add_f32 v208, v208, v34
  v_add_f32 v208, v208, v35
  v_cvt_pk_bf16_f32 v33, v34, v35
  v_exp_f32 v36, v36
  v_exp_f32 v37, v37
  v_add_f32 v208, v208, v36
  v_exp_f32 v38, v38
  v_add_f32 v208, v208, v37
  v_cvt_pk_bf16_f32 v34, v36, v37
  v_exp_f32 v39, v39
  v_add_f32 v208, v208, v38
  v_add_f32 v208, v208, v39
  v_cvt_pk_bf16_f32 v35, v38, v39
  v_accvgpr_read_b32 v64, a0
  v_accvgpr_read_b32 v65, a1
  v_accvgpr_read_b32 v66, a2
  v_accvgpr_read_b32 v67, a3
  v_mul_f32 v64, v64, v193
  v_mul_f32 v65, v65, v193
  v_mul_f32 v66, v66, v193
  v_mul_f32 v67, v67, v193
  v_accvgpr_write_b32 a0, v64
  v_accvgpr_write_b32 a1, v65
  v_accvgpr_write_b32 a2, v66
  v_accvgpr_write_b32 a3, v67
  v_accvgpr_read_b32 v64, a16
  v_accvgpr_read_b32 v65, a17
  v_accvgpr_read_b32 v66, a18
  v_accvgpr_read_b32 v67, a19
  v_mul_f32 v64, v64, v193
  v_mul_f32 v65, v65, v193
  v_mul_f32 v66, v66, v193
  v_mul_f32 v67, v67, v193
  v_accvgpr_write_b32 a16, v64
  v_accvgpr_write_b32 a17, v65
  v_accvgpr_write_b32 a18, v66
  v_accvgpr_write_b32 a19, v67
  v_accvgpr_read_b32 v64, a32
  v_accvgpr_read_b32 v65, a33
  v_accvgpr_read_b32 v66, a34
  v_accvgpr_read_b32 v67, a35
  v_mul_f32 v64, v64, v193
  v_mul_f32 v65, v65, v193
  v_mul_f32 v66, v66, v193
  v_mul_f32 v67, v67, v193
  v_accvgpr_write_b32 a32, v64
  v_accvgpr_write_b32 a33, v65
  v_accvgpr_write_b32 a34, v66
  v_accvgpr_write_b32 a35, v67
  v_accvgpr_read_b32 v64, a48
  v_accvgpr_read_b32 v65, a49
  v_accvgpr_read_b32 v66, a50
  v_accvgpr_read_b32 v67, a51
  v_mul_f32 v64, v64, v193
  v_mul_f32 v65, v65, v193
  v_mul_f32 v66, v66, v193
  v_mul_f32 v67, v67, v193
  v_accvgpr_write_b32 a48, v64
  v_accvgpr_write_b32 a49, v65
  v_accvgpr_write_b32 a50, v66
  v_accvgpr_write_b32 a51, v67
  v_accvgpr_read_b32 v64, a64
  v_accvgpr_read_b32 v65, a65
  v_accvgpr_read_b32 v66, a66
  v_accvgpr_read_b32 v67, a67
  v_mul_f32 v64, v64, v193
  v_mul_f32 v65, v65, v193
  v_mul_f32 v66, v66, v193
  v_mul_f32 v67, v67, v193
  v_accvgpr_write_b32 a64, v64
  v_accvgpr_write_b32 a65, v65
  v_accvgpr_write_b32 a66, v66
  v_accvgpr_write_b32 a67, v67
  v_accvgpr_read_b32 v64, a80
  v_accvgpr_read_b32 v65, a81
  v_accvgpr_read_b32 v66, a82
  v_accvgpr_read_b32 v67, a83
  v_mul_f32 v64, v64, v193
  v_mul_f32 v65, v65, v193
  v_mul_f32 v66, v66, v193
  v_mul_f32 v67, v67, v193
  v_accvgpr_write_b32 a80, v64
  v_accvgpr_write_b32 a81, v65
  v_accvgpr_write_b32 a82, v66
  v_accvgpr_write_b32 a83, v67
  v_accvgpr_read_b32 v64, a96
  v_accvgpr_read_b32 v65, a97
  v_accvgpr_read_b32 v66, a98
  v_accvgpr_read_b32 v67, a99
  v_mul_f32 v64, v64, v193
  v_mul_f32 v65, v65, v193
  v_mul_f32 v66, v66, v193
  v_mul_f32 v67, v67, v193
  v_accvgpr_write_b32 a96, v64
  v_accvgpr_write_b32 a97, v65
  v_accvgpr_write_b32 a98, v66
  v_accvgpr_write_b32 a99, v67
  v_accvgpr_read_b32 v64, a112
  v_accvgpr_read_b32 v65, a113
  v_accvgpr_read_b32 v66, a114
  v_accvgpr_read_b32 v67, a115
  v_mul_f32 v64, v64, v193
  v_mul_f32 v65, v65, v193
  v_mul_f32 v66, v66, v193
  v_mul_f32 v67, v67, v193
  v_accvgpr_write_b32 a112, v64
  v_accvgpr_write_b32 a113, v65
  v_accvgpr_write_b32 a114, v66
  v_accvgpr_write_b32 a115, v67
  v_mov_b32 v196, v250
  v_max3_f32 v196, v196, v8, v9
  v_max3_f32 v196, v196, v10, v11
  v_max3_f32 v196, v196, v12, v13
  v_max3_f32 v196, v196, v14, v15
  v_max3_f32 v196, v196, v40, v41
  v_max3_f32 v196, v196, v42, v43
  v_max3_f32 v196, v196, v44, v45
  v_max3_f32 v196, v196, v46, v47
  v_mov_b32 v245, v196
  s_nop 1
  v_permlane16_swap_b32 v196, v245
  v_max_f32 v196, v196, v245
  v_mov_b32 v245, v196
  s_nop 1
  v_permlane32_swap_b32 v196, v245
  v_max_f32 v196, v196, v245
  v_sub_f32 v197, v250, v196
  v_exp_f32 v197, v197
  v_mov_b32 v250, v196
  v_mul_f32 v209, v209, v197
  v_sub_f32 v8, v8, v196
  v_sub_f32 v9, v9, v196
  v_sub_f32 v10, v10, v196
  v_sub_f32 v11, v11, v196
  v_sub_f32 v12, v12, v196
  v_sub_f32 v13, v13, v196
  v_sub_f32 v14, v14, v196
  v_sub_f32 v15, v15, v196
  v_sub_f32 v40, v40, v196
  v_sub_f32 v41, v41, v196
  v_sub_f32 v42, v42, v196
  v_sub_f32 v43, v43, v196
  v_sub_f32 v44, v44, v196
  v_sub_f32 v45, v45, v196
  v_sub_f32 v46, v46, v196
  v_sub_f32 v47, v47, v196
  v_exp_f32 v8, v8
  v_exp_f32 v9, v9
  v_add_f32 v209, v209, v8
  v_exp_f32 v10, v10
  v_add_f32 v209, v209, v9
  v_cvt_pk_bf16_f32 v8, v8, v9
  v_exp_f32 v11, v11
  v_add_f32 v209, v209, v10
  v_add_f32 v209, v209, v11
  v_cvt_pk_bf16_f32 v9, v10, v11
  v_exp_f32 v12, v12
  v_exp_f32 v13, v13
  v_add_f32 v209, v209, v12
  v_exp_f32 v14, v14
  v_add_f32 v209, v209, v13
  v_cvt_pk_bf16_f32 v10, v12, v13
  v_exp_f32 v15, v15
  v_add_f32 v209, v209, v14
  v_add_f32 v209, v209, v15
  v_cvt_pk_bf16_f32 v11, v14, v15
  v_exp_f32 v40, v40
  v_exp_f32 v41, v41
  v_add_f32 v209, v209, v40
  v_exp_f32 v42, v42
  v_add_f32 v209, v209, v41
  v_cvt_pk_bf16_f32 v40, v40, v41
  v_exp_f32 v43, v43
  v_add_f32 v209, v209, v42
  v_add_f32 v209, v209, v43
  v_cvt_pk_bf16_f32 v41, v42, v43
  v_exp_f32 v44, v44
  v_exp_f32 v45, v45
  v_add_f32 v209, v209, v44
  v_exp_f32 v46, v46
  v_add_f32 v209, v209, v45
  v_cvt_pk_bf16_f32 v42, v44, v45
  v_exp_f32 v47, v47
  v_add_f32 v209, v209, v46
  v_add_f32 v209, v209, v47
  v_cvt_pk_bf16_f32 v43, v46, v47
  v_accvgpr_read_b32 v64, a4
  v_accvgpr_read_b32 v65, a5
  v_accvgpr_read_b32 v66, a6
  v_accvgpr_read_b32 v67, a7
  v_mul_f32 v64, v64, v197
  v_mul_f32 v65, v65, v197
  v_mul_f32 v66, v66, v197
  v_mul_f32 v67, v67, v197
  v_accvgpr_write_b32 a4, v64
  v_accvgpr_write_b32 a5, v65
  v_accvgpr_write_b32 a6, v66
  v_accvgpr_write_b32 a7, v67
  v_accvgpr_read_b32 v64, a20
  v_accvgpr_read_b32 v65, a21
  v_accvgpr_read_b32 v66, a22
  v_accvgpr_read_b32 v67, a23
  v_mul_f32 v64, v64, v197
  v_mul_f32 v65, v65, v197
  v_mul_f32 v66, v66, v197
  v_mul_f32 v67, v67, v197
  v_accvgpr_write_b32 a20, v64
  v_accvgpr_write_b32 a21, v65
  v_accvgpr_write_b32 a22, v66
  v_accvgpr_write_b32 a23, v67
  v_accvgpr_read_b32 v64, a36
  v_accvgpr_read_b32 v65, a37
  v_accvgpr_read_b32 v66, a38
  v_accvgpr_read_b32 v67, a39
  v_mul_f32 v64, v64, v197
  v_mul_f32 v65, v65, v197
  v_mul_f32 v66, v66, v197
  v_mul_f32 v67, v67, v197
  v_accvgpr_write_b32 a36, v64
  v_accvgpr_write_b32 a37, v65
  v_accvgpr_write_b32 a38, v66
  v_accvgpr_write_b32 a39, v67
  v_accvgpr_read_b32 v64, a52
  v_accvgpr_read_b32 v65, a53
  v_accvgpr_read_b32 v66, a54
  v_accvgpr_read_b32 v67, a55
  v_mul_f32 v64, v64, v197
  v_mul_f32 v65, v65, v197
  v_mul_f32 v66, v66, v197
  v_mul_f32 v67, v67, v197
  v_accvgpr_write_b32 a52, v64
  v_accvgpr_write_b32 a53, v65
  v_accvgpr_write_b32 a54, v66
  v_accvgpr_write_b32 a55, v67
  v_accvgpr_read_b32 v64, a68
  v_accvgpr_read_b32 v65, a69
  v_accvgpr_read_b32 v66, a70
  v_accvgpr_read_b32 v67, a71
  v_mul_f32 v64, v64, v197
  v_mul_f32 v65, v65, v197
  v_mul_f32 v66, v66, v197
  v_mul_f32 v67, v67, v197
  v_accvgpr_write_b32 a68, v64
  v_accvgpr_write_b32 a69, v65
  v_accvgpr_write_b32 a70, v66
  v_accvgpr_write_b32 a71, v67
  v_accvgpr_read_b32 v64, a84
  v_accvgpr_read_b32 v65, a85
  v_accvgpr_read_b32 v66, a86
  v_accvgpr_read_b32 v67, a87
  v_mul_f32 v64, v64, v197
  v_mul_f32 v65, v65, v197
  v_mul_f32 v66, v66, v197
  v_mul_f32 v67, v67, v197
  v_accvgpr_write_b32 a84, v64
  v_accvgpr_write_b32 a85, v65
  v_accvgpr_write_b32 a86, v66
  v_accvgpr_write_b32 a87, v67
  v_accvgpr_read_b32 v64, a100
  v_accvgpr_read_b32 v65, a101
  v_accvgpr_read_b32 v66, a102
  v_accvgpr_read_b32 v67, a103
  v_mul_f32 v64, v64, v197
  v_mul_f32 v65, v65, v197
  v_mul_f32 v66, v66, v197
  v_mul_f32 v67, v67, v197
  v_accvgpr_write_b32 a100, v64
  v_accvgpr_write_b32 a101, v65
  v_accvgpr_write_b32 a102, v66
  v_accvgpr_write_b32 a103, v67
  v_accvgpr_read_b32 v64, a116
  v_accvgpr_read_b32 v65, a117
  v_accvgpr_read_b32 v66, a118
  v_accvgpr_read_b32 v67, a119
  v_mul_f32 v64, v64, v197
  v_mul_f32 v65, v65, v197
  v_mul_f32 v66, v66, v197
  v_mul_f32 v67, v67, v197
  v_accvgpr_write_b32 a116, v64
  v_accvgpr_write_b32 a117, v65
  v_accvgpr_write_b32 a118, v66
  v_accvgpr_write_b32 a119, v67
  v_mov_b32 v200, v251
  v_max3_f32 v200, v200, v16, v17
  v_max3_f32 v200, v200, v18, v19
  v_max3_f32 v200, v200, v20, v21
  v_max3_f32 v200, v200, v22, v23
  v_max3_f32 v200, v200, v48, v49
  v_max3_f32 v200, v200, v50, v51
  v_max3_f32 v200, v200, v52, v53
  v_max3_f32 v200, v200, v54, v55
  v_mov_b32 v245, v200
  s_nop 1
  v_permlane16_swap_b32 v200, v245
  v_max_f32 v200, v200, v245
  v_mov_b32 v245, v200
  s_nop 1
  v_permlane32_swap_b32 v200, v245
  v_max_f32 v200, v200, v245
  v_sub_f32 v201, v251, v200
  v_exp_f32 v201, v201
  v_mov_b32 v251, v200
  v_mul_f32 v210, v210, v201
  v_sub_f32 v16, v16, v200
  v_sub_f32 v17, v17, v200
  v_sub_f32 v18, v18, v200
  v_sub_f32 v19, v19, v200
  v_sub_f32 v20, v20, v200
  v_sub_f32 v21, v21, v200
  v_sub_f32 v22, v22, v200
  v_sub_f32 v23, v23, v200
  v_sub_f32 v48, v48, v200
  v_sub_f32 v49, v49, v200
  v_sub_f32 v50, v50, v200
  v_sub_f32 v51, v51, v200
  v_sub_f32 v52, v52, v200
  v_sub_f32 v53, v53, v200
  v_sub_f32 v54, v54, v200
  v_sub_f32 v55, v55, v200
  v_exp_f32 v16, v16
  v_exp_f32 v17, v17
  v_add_f32 v210, v210, v16
  v_exp_f32 v18, v18
  v_add_f32 v210, v210, v17
  v_cvt_pk_bf16_f32 v16, v16, v17
  v_exp_f32 v19, v19
  v_add_f32 v210, v210, v18
  v_add_f32 v210, v210, v19
  v_cvt_pk_bf16_f32 v17, v18, v19
  v_exp_f32 v20, v20
  v_exp_f32 v21, v21
  v_add_f32 v210, v210, v20
  v_exp_f32 v22, v22
  v_add_f32 v210, v210, v21
  v_cvt_pk_bf16_f32 v18, v20, v21
  v_exp_f32 v23, v23
  v_add_f32 v210, v210, v22
  v_add_f32 v210, v210, v23
  v_cvt_pk_bf16_f32 v19, v22, v23
  v_exp_f32 v48, v48
  v_exp_f32 v49, v49
  v_add_f32 v210, v210, v48
  v_exp_f32 v50, v50
  v_add_f32 v210, v210, v49
  v_cvt_pk_bf16_f32 v48, v48, v49
  v_exp_f32 v51, v51
  v_add_f32 v210, v210, v50
  v_add_f32 v210, v210, v51
  v_cvt_pk_bf16_f32 v49, v50, v51
  v_exp_f32 v52, v52
  v_exp_f32 v53, v53
  v_add_f32 v210, v210, v52
  v_exp_f32 v54, v54
  v_add_f32 v210, v210, v53
  v_cvt_pk_bf16_f32 v50, v52, v53
  v_exp_f32 v55, v55
  v_add_f32 v210, v210, v54
  v_add_f32 v210, v210, v55
  v_cvt_pk_bf16_f32 v51, v54, v55
  v_accvgpr_read_b32 v64, a8
  v_accvgpr_read_b32 v65, a9
  v_accvgpr_read_b32 v66, a10
  v_accvgpr_read_b32 v67, a11
  v_mul_f32 v64, v64, v201
  v_mul_f32 v65, v65, v201
  v_mul_f32 v66, v66, v201
  v_mul_f32 v67, v67, v201
  v_accvgpr_write_b32 a8, v64
  v_accvgpr_write_b32 a9, v65
  v_accvgpr_write_b32 a10, v66
  v_accvgpr_write_b32 a11, v67
  v_accvgpr_read_b32 v64, a24
  v_accvgpr_read_b32 v65, a25
  v_accvgpr_read_b32 v66, a26
  v_accvgpr_read_b32 v67, a27
  v_mul_f32 v64, v64, v201
  v_mul_f32 v65, v65, v201
  v_mul_f32 v66, v66, v201
  v_mul_f32 v67, v67, v201
  v_accvgpr_write_b32 a24, v64
  v_accvgpr_write_b32 a25, v65
  v_accvgpr_write_b32 a26, v66
  v_accvgpr_write_b32 a27, v67
  v_accvgpr_read_b32 v64, a40
  v_accvgpr_read_b32 v65, a41
  v_accvgpr_read_b32 v66, a42
  v_accvgpr_read_b32 v67, a43
  v_mul_f32 v64, v64, v201
  v_mul_f32 v65, v65, v201
  v_mul_f32 v66, v66, v201
  v_mul_f32 v67, v67, v201
  v_accvgpr_write_b32 a40, v64
  v_accvgpr_write_b32 a41, v65
  v_accvgpr_write_b32 a42, v66
  v_accvgpr_write_b32 a43, v67
  v_accvgpr_read_b32 v64, a56
  v_accvgpr_read_b32 v65, a57
  v_accvgpr_read_b32 v66, a58
  v_accvgpr_read_b32 v67, a59
  v_mul_f32 v64, v64, v201
  v_mul_f32 v65, v65, v201
  v_mul_f32 v66, v66, v201
  v_mul_f32 v67, v67, v201
  v_accvgpr_write_b32 a56, v64
  v_accvgpr_write_b32 a57, v65
  v_accvgpr_write_b32 a58, v66
  v_accvgpr_write_b32 a59, v67
  v_accvgpr_read_b32 v64, a72
  v_accvgpr_read_b32 v65, a73
  v_accvgpr_read_b32 v66, a74
  v_accvgpr_read_b32 v67, a75
  v_mul_f32 v64, v64, v201
  v_mul_f32 v65, v65, v201
  v_mul_f32 v66, v66, v201
  v_mul_f32 v67, v67, v201
  v_accvgpr_write_b32 a72, v64
  v_accvgpr_write_b32 a73, v65
  v_accvgpr_write_b32 a74, v66
  v_accvgpr_write_b32 a75, v67
  v_accvgpr_read_b32 v64, a88
  v_accvgpr_read_b32 v65, a89
  v_accvgpr_read_b32 v66, a90
  v_accvgpr_read_b32 v67, a91
  v_mul_f32 v64, v64, v201
  v_mul_f32 v65, v65, v201
  v_mul_f32 v66, v66, v201
  v_mul_f32 v67, v67, v201
  v_accvgpr_write_b32 a88, v64
  v_accvgpr_write_b32 a89, v65
  v_accvgpr_write_b32 a90, v66
  v_accvgpr_write_b32 a91, v67
  v_accvgpr_read_b32 v64, a104
  v_accvgpr_read_b32 v65, a105
  v_accvgpr_read_b32 v66, a106
  v_accvgpr_read_b32 v67, a107
  v_mul_f32 v64, v64, v201
  v_mul_f32 v65, v65, v201
  v_mul_f32 v66, v66, v201
  v_mul_f32 v67, v67, v201
  v_accvgpr_write_b32 a104, v64
  v_accvgpr_write_b32 a105, v65
  v_accvgpr_write_b32 a106, v66
  v_accvgpr_write_b32 a107, v67
  v_accvgpr_read_b32 v64, a120
  v_accvgpr_read_b32 v65, a121
  v_accvgpr_read_b32 v66, a122
  v_accvgpr_read_b32 v67, a123
  v_mul_f32 v64, v64, v201
  v_mul_f32 v65, v65, v201
  v_mul_f32 v66, v66, v201
  v_mul_f32 v67, v67, v201
  v_accvgpr_write_b32 a120, v64
  v_accvgpr_write_b32 a121, v65
  v_accvgpr_write_b32 a122, v66
  v_accvgpr_write_b32 a123, v67
  v_mov_b32 v204, v252
  v_max3_f32 v204, v204, v24, v25
  v_max3_f32 v204, v204, v26, v27
  v_max3_f32 v204, v204, v28, v29
  v_max3_f32 v204, v204, v30, v31
  v_max3_f32 v204, v204, v56, v57
  v_max3_f32 v204, v204, v58, v59
  v_max3_f32 v204, v204, v60, v61
  v_max3_f32 v204, v204, v62, v63
  v_mov_b32 v245, v204
  s_nop 1
  v_permlane16_swap_b32 v204, v245
  v_max_f32 v204, v204, v245
  v_mov_b32 v245, v204
  s_nop 1
  v_permlane32_swap_b32 v204, v245
  v_max_f32 v204, v204, v245
  v_sub_f32 v205, v252, v204
  v_exp_f32 v205, v205
  v_mov_b32 v252, v204
  v_mul_f32 v211, v211, v205
  v_sub_f32 v24, v24, v204
  v_sub_f32 v25, v25, v204
  v_sub_f32 v26, v26, v204
  v_sub_f32 v27, v27, v204
  v_sub_f32 v28, v28, v204
  v_sub_f32 v29, v29, v204
  v_sub_f32 v30, v30, v204
  v_sub_f32 v31, v31, v204
  v_sub_f32 v56, v56, v204
  v_sub_f32 v57, v57, v204
  v_sub_f32 v58, v58, v204
  v_sub_f32 v59, v59, v204
  v_sub_f32 v60, v60, v204
  v_sub_f32 v61, v61, v204
  v_sub_f32 v62, v62, v204
  v_sub_f32 v63, v63, v204
  v_exp_f32 v24, v24
  v_exp_f32 v25, v25
  v_add_f32 v211, v211, v24
  v_exp_f32 v26, v26
  v_add_f32 v211, v211, v25
  v_cvt_pk_bf16_f32 v24, v24, v25
  v_exp_f32 v27, v27
  v_add_f32 v211, v211, v26
  v_add_f32 v211, v211, v27
  v_cvt_pk_bf16_f32 v25, v26, v27
  v_exp_f32 v28, v28
  v_exp_f32 v29, v29
  v_add_f32 v211, v211, v28
  v_exp_f32 v30, v30
  v_add_f32 v211, v211, v29
  v_cvt_pk_bf16_f32 v26, v28, v29
  v_exp_f32 v31, v31
  v_add_f32 v211, v211, v30
  v_add_f32 v211, v211, v31
  v_cvt_pk_bf16_f32 v27, v30, v31
  v_exp_f32 v56, v56
  v_exp_f32 v57, v57
  v_add_f32 v211, v211, v56
  v_exp_f32 v58, v58
  v_add_f32 v211, v211, v57
  v_cvt_pk_bf16_f32 v56, v56, v57
  v_exp_f32 v59, v59
  v_add_f32 v211, v211, v58
  v_add_f32 v211, v211, v59
  v_cvt_pk_bf16_f32 v57, v58, v59
  v_exp_f32 v60, v60
  v_exp_f32 v61, v61
  v_add_f32 v211, v211, v60
  v_exp_f32 v62, v62
  v_add_f32 v211, v211, v61
  v_cvt_pk_bf16_f32 v58, v60, v61
  v_exp_f32 v63, v63
  v_add_f32 v211, v211, v62
  v_add_f32 v211, v211, v63
  v_cvt_pk_bf16_f32 v59, v62, v63
  v_accvgpr_read_b32 v64, a12
  v_accvgpr_read_b32 v65, a13
  v_accvgpr_read_b32 v66, a14
  v_accvgpr_read_b32 v67, a15
  v_mul_f32 v64, v64, v205
  v_mul_f32 v65, v65, v205
  v_mul_f32 v66, v66, v205
  v_mul_f32 v67, v67, v205
  v_accvgpr_write_b32 a12, v64
  v_accvgpr_write_b32 a13, v65
  v_accvgpr_write_b32 a14, v66
  v_accvgpr_write_b32 a15, v67
  v_accvgpr_read_b32 v64, a28
  v_accvgpr_read_b32 v65, a29
  v_accvgpr_read_b32 v66, a30
  v_accvgpr_read_b32 v67, a31
  v_mul_f32 v64, v64, v205
  v_mul_f32 v65, v65, v205
  v_mul_f32 v66, v66, v205
  v_mul_f32 v67, v67, v205
  v_accvgpr_write_b32 a28, v64
  v_accvgpr_write_b32 a29, v65
  v_accvgpr_write_b32 a30, v66
  v_accvgpr_write_b32 a31, v67
  v_accvgpr_read_b32 v64, a44
  v_accvgpr_read_b32 v65, a45
  v_accvgpr_read_b32 v66, a46
  v_accvgpr_read_b32 v67, a47
  v_mul_f32 v64, v64, v205
  v_mul_f32 v65, v65, v205
  v_mul_f32 v66, v66, v205
  v_mul_f32 v67, v67, v205
  v_accvgpr_write_b32 a44, v64
  v_accvgpr_write_b32 a45, v65
  v_accvgpr_write_b32 a46, v66
  v_accvgpr_write_b32 a47, v67
  v_accvgpr_read_b32 v64, a60
  v_accvgpr_read_b32 v65, a61
  v_accvgpr_read_b32 v66, a62
  v_accvgpr_read_b32 v67, a63
  v_mul_f32 v64, v64, v205
  v_mul_f32 v65, v65, v205
  v_mul_f32 v66, v66, v205
  v_mul_f32 v67, v67, v205
  v_accvgpr_write_b32 a60, v64
  v_accvgpr_write_b32 a61, v65
  v_accvgpr_write_b32 a62, v66
  v_accvgpr_write_b32 a63, v67
  v_accvgpr_read_b32 v64, a76
  v_accvgpr_read_b32 v65, a77
  v_accvgpr_read_b32 v66, a78
  v_accvgpr_read_b32 v67, a79
  v_mul_f32 v64, v64, v205
  v_mul_f32 v65, v65, v205
  v_mul_f32 v66, v66, v205
  v_mul_f32 v67, v67, v205
  v_accvgpr_write_b32 a76, v64
  v_accvgpr_write_b32 a77, v65
  v_accvgpr_write_b32 a78, v66
  v_accvgpr_write_b32 a79, v67
  v_accvgpr_read_b32 v64, a92
  v_accvgpr_read_b32 v65, a93
  v_accvgpr_read_b32 v66, a94
  v_accvgpr_read_b32 v67, a95
  v_mul_f32 v64, v64, v205
  v_mul_f32 v65, v65, v205
  v_mul_f32 v66, v66, v205
  v_mul_f32 v67, v67, v205
  v_accvgpr_write_b32 a92, v64
  v_accvgpr_write_b32 a93, v65
  v_accvgpr_write_b32 a94, v66
  v_accvgpr_write_b32 a95, v67
  v_accvgpr_read_b32 v64, a108
  v_accvgpr_read_b32 v65, a109
  v_accvgpr_read_b32 v66, a110
  v_accvgpr_read_b32 v67, a111
  v_mul_f32 v64, v64, v205
  v_mul_f32 v65, v65, v205
  v_mul_f32 v66, v66, v205
  v_mul_f32 v67, v67, v205
  v_accvgpr_write_b32 a108, v64
  v_accvgpr_write_b32 a109, v65
  v_accvgpr_write_b32 a110, v66
  v_accvgpr_write_b32 a111, v67
  v_accvgpr_read_b32 v64, a124
  v_accvgpr_read_b32 v65, a125
  v_accvgpr_read_b32 v66, a126
  v_accvgpr_read_b32 v67, a127
  v_mul_f32 v64, v64, v205
  v_mul_f32 v65, v65, v205
  v_mul_f32 v66, v66, v205
  v_mul_f32 v67, v67, v205
  v_accvgpr_write_b32 a124, v64
  v_accvgpr_write_b32 a125, v65
  v_accvgpr_write_b32 a126, v66
  v_accvgpr_write_b32 a127, v67
  ds_read_b64_tr_b16 a[160:161], v216 offset:49152
  ds_read_b64_tr_b16 a[162:163], v216 offset:53248
  ds_read_b64_tr_b16 a[164:165], v216 offset:57344
  ds_read_b64_tr_b16 a[166:167], v216 offset:61440
  s_waitcnt lgkmcnt(2)
  v_mfma_f32_16x16x32_bf16 a[0:3], a[160:163], v[0:3], a[0:3]
  s_waitcnt lgkmcnt(0)
  v_mfma_f32_16x16x32_bf16 a[0:3], a[164:167], v[32:35], a[0:3]
  v_mfma_f32_16x16x32_bf16 a[4:7], a[164:167], v[40:43], a[4:7]
  v_mfma_f32_16x16x32_bf16 a[4:7], a[160:163], v[8:11], a[4:7]
  v_mfma_f32_16x16x32_bf16 a[8:11], a[160:163], v[16:19], a[8:11]
  v_mfma_f32_16x16x32_bf16 a[8:11], a[164:167], v[48:51], a[8:11]
  v_mfma_f32_16x16x32_bf16 a[12:15], a[164:167], v[56:59], a[12:15]
  v_mfma_f32_16x16x32_bf16 a[12:15], a[160:163], v[24:27], a[12:15]
  ds_read_b64_tr_b16 a[168:169], v217 offset:49152
  ds_read_b64_tr_b16 a[170:171], v217 offset:53248
  ds_read_b64_tr_b16 a[172:173], v217 offset:57344
  ds_read_b64_tr_b16 a[174:175], v217 offset:61440
  s_waitcnt lgkmcnt(2)
  v_mfma_f32_16x16x32_bf16 a[16:19], a[168:171], v[0:3], a[16:19]
  s_waitcnt lgkmcnt(0)
  v_mfma_f32_16x16x32_bf16 a[16:19], a[172:175], v[32:35], a[16:19]
  v_mfma_f32_16x16x32_bf16 a[20:23], a[172:175], v[40:43], a[20:23]
  v_mfma_f32_16x16x32_bf16 a[20:23], a[168:171], v[8:11], a[20:23]
  v_mfma_f32_16x16x32_bf16 a[24:27], a[168:171], v[16:19], a[24:27]
  v_mfma_f32_16x16x32_bf16 a[24:27], a[172:175], v[48:51], a[24:27]
  v_mfma_f32_16x16x32_bf16 a[28:31], a[172:175], v[56:59], a[28:31]
  v_mfma_f32_16x16x32_bf16 a[28:31], a[168:171], v[24:27], a[28:31]
  ds_read_b64_tr_b16 a[176:177], v218 offset:49152
  ds_read_b64_tr_b16 a[178:179], v218 offset:53248
  ds_read_b64_tr_b16 a[180:181], v218 offset:57344
  ds_read_b64_tr_b16 a[182:183], v218 offset:61440
  s_waitcnt lgkmcnt(2)
  v_mfma_f32_16x16x32_bf16 a[32:35], a[176:179], v[0:3], a[32:35]
  s_waitcnt lgkmcnt(0)
  v_mfma_f32_16x16x32_bf16 a[32:35], a[180:183], v[32:35], a[32:35]
  v_mfma_f32_16x16x32_bf16 a[36:39], a[180:183], v[40:43], a[36:39]
  v_mfma_f32_16x16x32_bf16 a[36:39], a[176:179], v[8:11], a[36:39]
  v_mfma_f32_16x16x32_bf16 a[40:43], a[176:179], v[16:19], a[40:43]
  v_mfma_f32_16x16x32_bf16 a[40:43], a[180:183], v[48:51], a[40:43]
  v_mfma_f32_16x16x32_bf16 a[44:47], a[180:183], v[56:59], a[44:47]
  v_mfma_f32_16x16x32_bf16 a[44:47], a[176:179], v[24:27], a[44:47]
  ds_read_b64_tr_b16 a[184:185], v219 offset:49152
  ds_read_b64_tr_b16 a[186:187], v219 offset:53248
  ds_read_b64_tr_b16 a[188:189], v219 offset:57344
  ds_read_b64_tr_b16 a[190:191], v219 offset:61440
  s_waitcnt lgkmcnt(2)
  v_mfma_f32_16x16x32_bf16 a[48:51], a[184:187], v[0:3], a[48:51]
  s_waitcnt lgkmcnt(0)
  v_mfma_f32_16x16x32_bf16 a[48:51], a[188:191], v[32:35], a[48:51]
  v_mfma_f32_16x16x32_bf16 a[52:55], a[188:191], v[40:43], a[52:55]
  v_mfma_f32_16x16x32_bf16 a[52:55], a[184:187], v[8:11], a[52:55]
  v_mfma_f32_16x16x32_bf16 a[56:59], a[184:187], v[16:19], a[56:59]
  v_mfma_f32_16x16x32_bf16 a[56:59], a[188:191], v[48:51], a[56:59]
  v_mfma_f32_16x16x32_bf16 a[60:63], a[188:191], v[56:59], a[60:63]
  v_mfma_f32_16x16x32_bf16 a[60:63], a[184:187], v[24:27], a[60:63]
  ds_read_b64_tr_b16 a[160:161], v220 offset:49152
  ds_read_b64_tr_b16 a[162:163], v220 offset:53248
  ds_read_b64_tr_b16 a[164:165], v220 offset:57344
  ds_read_b64_tr_b16 a[166:167], v220 offset:61440
  s_waitcnt lgkmcnt(2)
  v_mfma_f32_16x16x32_bf16 a[64:67], a[160:163], v[0:3], a[64:67]
  s_waitcnt lgkmcnt(0)
  v_mfma_f32_16x16x32_bf16 a[64:67], a[164:167], v[32:35], a[64:67]
  v_mfma_f32_16x16x32_bf16 a[68:71], a[164:167], v[40:43], a[68:71]
  v_mfma_f32_16x16x32_bf16 a[68:71], a[160:163], v[8:11], a[68:71]
  v_mfma_f32_16x16x32_bf16 a[72:75], a[160:163], v[16:19], a[72:75]
  v_mfma_f32_16x16x32_bf16 a[72:75], a[164:167], v[48:51], a[72:75]
  v_mfma_f32_16x16x32_bf16 a[76:79], a[164:167], v[56:59], a[76:79]
  v_mfma_f32_16x16x32_bf16 a[76:79], a[160:163], v[24:27], a[76:79]
  ds_read_b64_tr_b16 a[168:169], v221 offset:49152
  ds_read_b64_tr_b16 a[170:171], v221 offset:53248
  ds_read_b64_tr_b16 a[172:173], v221 offset:57344
  ds_read_b64_tr_b16 a[174:175], v221 offset:61440
  s_waitcnt lgkmcnt(2)
  v_mfma_f32_16x16x32_bf16 a[80:83], a[168:171], v[0:3], a[80:83]
  s_waitcnt lgkmcnt(0)
  v_mfma_f32_16x16x32_bf16 a[80:83], a[172:175], v[32:35], a[80:83]
  v_mfma_f32_16x16x32_bf16 a[84:87], a[172:175], v[40:43], a[84:87]
  v_mfma_f32_16x16x32_bf16 a[84:87], a[168:171], v[8:11], a[84:87]
  v_mfma_f32_16x16x32_bf16 a[88:91], a[168:171], v[16:19], a[88:91]
  v_mfma_f32_16x16x32_bf16 a[88:91], a[172:175], v[48:51], a[88:91]
  v_mfma_f32_16x16x32_bf16 a[92:95], a[172:175], v[56:59], a[92:95]
  v_mfma_f32_16x16x32_bf16 a[92:95], a[168:171], v[24:27], a[92:95]
  ds_read_b64_tr_b16 a[176:177], v222 offset:49152
  ds_read_b64_tr_b16 a[178:179], v222 offset:53248
  ds_read_b64_tr_b16 a[180:181], v222 offset:57344
  ds_read_b64_tr_b16 a[182:183], v222 offset:61440
  s_waitcnt lgkmcnt(2)
  v_mfma_f32_16x16x32_bf16 a[96:99], a[176:179], v[0:3], a[96:99]
  s_waitcnt lgkmcnt(0)
  v_mfma_f32_16x16x32_bf16 a[96:99], a[180:183], v[32:35], a[96:99]
  v_mfma_f32_16x16x32_bf16 a[100:103], a[180:183], v[40:43], a[100:103]
  v_mfma_f32_16x16x32_bf16 a[100:103], a[176:179], v[8:11], a[100:103]
  v_mfma_f32_16x16x32_bf16 a[104:107], a[176:179], v[16:19], a[104:107]
  v_mfma_f32_16x16x32_bf16 a[104:107], a[180:183], v[48:51], a[104:107]
  v_mfma_f32_16x16x32_bf16 a[108:111], a[180:183], v[56:59], a[108:111]
  v_mfma_f32_16x16x32_bf16 a[108:111], a[176:179], v[24:27], a[108:111]
  ds_read_b64_tr_b16 a[184:185], v223 offset:49152
  ds_read_b64_tr_b16 a[186:187], v223 offset:53248
  ds_read_b64_tr_b16 a[188:189], v223 offset:57344
  ds_read_b64_tr_b16 a[190:191], v223 offset:61440
  s_waitcnt lgkmcnt(2)
  v_mfma_f32_16x16x32_bf16 a[112:115], a[184:187], v[0:3], a[112:115]
  s_waitcnt lgkmcnt(0)
  v_mfma_f32_16x16x32_bf16 a[112:115], a[188:191], v[32:35], a[112:115]
  v_mfma_f32_16x16x32_bf16 a[116:119], a[188:191], v[40:43], a[116:119]
  v_mfma_f32_16x16x32_bf16 a[116:119], a[184:187], v[8:11], a[116:119]
  v_mfma_f32_16x16x32_bf16 a[120:123], a[184:187], v[16:19], a[120:123]
  v_mfma_f32_16x16x32_bf16 a[120:123], a[188:191], v[48:51], a[120:123]
  v_mfma_f32_16x16x32_bf16 a[124:127], a[188:191], v[56:59], a[124:127]
  v_mfma_f32_16x16x32_bf16 a[124:127], a[184:187], v[24:27], a[124:127]
  s_add_u32 s29, s29, 16384
  s_cmp_lt_u32 s29, 524288
  s_cbranch_scc1 attn_slow
  v_mov_b32 v245, v208
  v_mov_b32 v246, v209
  v_mov_b32 v247, v210
  v_mov_b32 v248, v211
  v_permlane16_swap_b32 v208, v245
  v_permlane16_swap_b32 v209, v246
  v_permlane16_swap_b32 v210, v247
  v_permlane16_swap_b32 v211, v248
  v_add_f32 v208, v208, v245
  v_add_f32 v209, v209, v246
  v_add_f32 v210, v210, v247
  v_add_f32 v211, v211, v248
  v_mov_b32 v245, v208
  v_mov_b32 v246, v209
  v_mov_b32 v247, v210
  v_mov_b32 v248, v211
  v_permlane32_swap_b32 v208, v245
  v_permlane32_swap_b32 v209, v246
  v_permlane32_swap_b32 v210, v247
  v_permlane32_swap_b32 v211, v248
  v_add_f32 v208, v208, v245
  v_add_f32 v209, v209, v246
  v_add_f32 v210, v210, v247
  v_add_f32 v211, v211, v248
  v_rcp_f32 v192, v208
  v_rcp_f32 v196, v209
  v_rcp_f32 v200, v210
  v_rcp_f32 v204, v211
  v_accvgpr_read_b32 v0, a0
  v_accvgpr_read_b32 v1, a1
  v_accvgpr_read_b32 v2, a2
  v_accvgpr_read_b32 v3, a3
  v_accvgpr_read_b32 v4, a16
  v_accvgpr_read_b32 v5, a17
  v_accvgpr_read_b32 v6, a18
  v_accvgpr_read_b32 v7, a19
  v_mul_f32 v0, v0, v192
  v_mul_f32 v1, v1, v192
  v_mul_f32 v2, v2, v192
  v_mul_f32 v3, v3, v192
  v_mul_f32 v4, v4, v192
  v_mul_f32 v5, v5, v192
  v_mul_f32 v6, v6, v192
  v_mul_f32 v7, v7, v192
  v_cvt_pk_bf16_f32 v0, v0, v1
  v_cvt_pk_bf16_f32 v1, v2, v3
  v_cvt_pk_bf16_f32 v2, v4, v5
  v_cvt_pk_bf16_f32 v3, v6, v7
  buffer_store_dwordx4 v[0:3], v244, s[24:27], s40 offen offset:0 sc1
  v_accvgpr_read_b32 v8, a4
  v_accvgpr_read_b32 v9, a5
  v_accvgpr_read_b32 v10, a6
  v_accvgpr_read_b32 v11, a7
  v_accvgpr_read_b32 v12, a20
  v_accvgpr_read_b32 v13, a21
  v_accvgpr_read_b32 v14, a22
  v_accvgpr_read_b32 v15, a23
  v_mul_f32 v8, v8, v196
  v_mul_f32 v9, v9, v196
  v_mul_f32 v10, v10, v196
  v_mul_f32 v11, v11, v196
  v_mul_f32 v12, v12, v196
  v_mul_f32 v13, v13, v196
  v_mul_f32 v14, v14, v196
  v_mul_f32 v15, v15, v196
  v_cvt_pk_bf16_f32 v8, v8, v9
  v_cvt_pk_bf16_f32 v9, v10, v11
  v_cvt_pk_bf16_f32 v10, v12, v13
  v_cvt_pk_bf16_f32 v11, v14, v15
  buffer_store_dwordx4 v[8:11], v244, s[24:27], s40 offen offset:2048 sc1
  v_accvgpr_read_b32 v16, a8
  v_accvgpr_read_b32 v17, a9
  v_accvgpr_read_b32 v18, a10
  v_accvgpr_read_b32 v19, a11
  v_accvgpr_read_b32 v20, a24
  v_accvgpr_read_b32 v21, a25
  v_accvgpr_read_b32 v22, a26
  v_accvgpr_read_b32 v23, a27
  v_mul_f32 v16, v16, v200
  v_mul_f32 v17, v17, v200
  v_mul_f32 v18, v18, v200
  v_mul_f32 v19, v19, v200
  v_mul_f32 v20, v20, v200
  v_mul_f32 v21, v21, v200
  v_mul_f32 v22, v22, v200
  v_mul_f32 v23, v23, v200
  v_cvt_pk_bf16_f32 v16, v16, v17
  v_cvt_pk_bf16_f32 v17, v18, v19
  v_cvt_pk_bf16_f32 v18, v20, v21
  v_cvt_pk_bf16_f32 v19, v22, v23
  buffer_store_dwordx4 v[16:19], v244, s[24:27], s41 offen offset:0 sc1
  v_accvgpr_read_b32 v24, a12
  v_accvgpr_read_b32 v25, a13
  v_accvgpr_read_b32 v26, a14
  v_accvgpr_read_b32 v27, a15
  v_accvgpr_read_b32 v28, a28
  v_accvgpr_read_b32 v29, a29
  v_accvgpr_read_b32 v30, a30
  v_accvgpr_read_b32 v31, a31
  v_mul_f32 v24, v24, v204
  v_mul_f32 v25, v25, v204
  v_mul_f32 v26, v26, v204
  v_mul_f32 v27, v27, v204
  v_mul_f32 v28, v28, v204
  v_mul_f32 v29, v29, v204
  v_mul_f32 v30, v30, v204
  v_mul_f32 v31, v31, v204
  v_cvt_pk_bf16_f32 v24, v24, v25
  v_cvt_pk_bf16_f32 v25, v26, v27
  v_cvt_pk_bf16_f32 v26, v28, v29
  v_cvt_pk_bf16_f32 v27, v30, v31
  buffer_store_dwordx4 v[24:27], v244, s[24:27], s41 offen offset:2048 sc1
  v_accvgpr_read_b32 v32, a32
  v_accvgpr_read_b32 v33, a33
  v_accvgpr_read_b32 v34, a34
  v_accvgpr_read_b32 v35, a35
  v_accvgpr_read_b32 v36, a48
  v_accvgpr_read_b32 v37, a49
  v_accvgpr_read_b32 v38, a50
  v_accvgpr_read_b32 v39, a51
  v_mul_f32 v32, v32, v192
  v_mul_f32 v33, v33, v192
  v_mul_f32 v34, v34, v192
  v_mul_f32 v35, v35, v192
  v_mul_f32 v36, v36, v192
  v_mul_f32 v37, v37, v192
  v_mul_f32 v38, v38, v192
  v_mul_f32 v39, v39, v192
  v_cvt_pk_bf16_f32 v32, v32, v33
  v_cvt_pk_bf16_f32 v33, v34, v35
  v_cvt_pk_bf16_f32 v34, v36, v37
  v_cvt_pk_bf16_f32 v35, v38, v39
  buffer_store_dwordx4 v[32:35], v244, s[24:27], s40 offen offset:1024 sc1
  v_accvgpr_read_b32 v40, a36
  v_accvgpr_read_b32 v41, a37
  v_accvgpr_read_b32 v42, a38
  v_accvgpr_read_b32 v43, a39
  v_accvgpr_read_b32 v44, a52
  v_accvgpr_read_b32 v45, a53
  v_accvgpr_read_b32 v46, a54
  v_accvgpr_read_b32 v47, a55
  v_mul_f32 v40, v40, v196
  v_mul_f32 v41, v41, v196
  v_mul_f32 v42, v42, v196
  v_mul_f32 v43, v43, v196
  v_mul_f32 v44, v44, v196
  v_mul_f32 v45, v45, v196
  v_mul_f32 v46, v46, v196
  v_mul_f32 v47, v47, v196
  v_cvt_pk_bf16_f32 v40, v40, v41
  v_cvt_pk_bf16_f32 v41, v42, v43
  v_cvt_pk_bf16_f32 v42, v44, v45
  v_cvt_pk_bf16_f32 v43, v46, v47
  buffer_store_dwordx4 v[40:43], v244, s[24:27], s40 offen offset:3072 sc1
  v_accvgpr_read_b32 v48, a40
  v_accvgpr_read_b32 v49, a41
  v_accvgpr_read_b32 v50, a42
  v_accvgpr_read_b32 v51, a43
  v_accvgpr_read_b32 v52, a56
  v_accvgpr_read_b32 v53, a57
  v_accvgpr_read_b32 v54, a58
  v_accvgpr_read_b32 v55, a59
  v_mul_f32 v48, v48, v200
  v_mul_f32 v49, v49, v200
  v_mul_f32 v50, v50, v200
  v_mul_f32 v51, v51, v200
  v_mul_f32 v52, v52, v200
  v_mul_f32 v53, v53, v200
  v_mul_f32 v54, v54, v200
  v_mul_f32 v55, v55, v200
  v_cvt_pk_bf16_f32 v48, v48, v49
  v_cvt_pk_bf16_f32 v49, v50, v51
  v_cvt_pk_bf16_f32 v50, v52, v53
  v_cvt_pk_bf16_f32 v51, v54, v55
  buffer_store_dwordx4 v[48:51], v244, s[24:27], s41 offen offset:1024 sc1
  v_accvgpr_read_b32 v56, a44
  v_accvgpr_read_b32 v57, a45
  v_accvgpr_read_b32 v58, a46
  v_accvgpr_read_b32 v59, a47
  v_accvgpr_read_b32 v60, a60
  v_accvgpr_read_b32 v61, a61
  v_accvgpr_read_b32 v62, a62
  v_accvgpr_read_b32 v63, a63
  v_mul_f32 v56, v56, v204
  v_mul_f32 v57, v57, v204
  v_mul_f32 v58, v58, v204
  v_mul_f32 v59, v59, v204
  v_mul_f32 v60, v60, v204
  v_mul_f32 v61, v61, v204
  v_mul_f32 v62, v62, v204
  v_mul_f32 v63, v63, v204
  v_cvt_pk_bf16_f32 v56, v56, v57
  v_cvt_pk_bf16_f32 v57, v58, v59
  v_cvt_pk_bf16_f32 v58, v60, v61
  v_cvt_pk_bf16_f32 v59, v62, v63
  buffer_store_dwordx4 v[56:59], v244, s[24:27], s41 offen offset:3072 sc1
  v_accvgpr_read_b32 v0, a64
  v_accvgpr_read_b32 v1, a65
  v_accvgpr_read_b32 v2, a66
  v_accvgpr_read_b32 v3, a67
  v_accvgpr_read_b32 v4, a80
  v_accvgpr_read_b32 v5, a81
  v_accvgpr_read_b32 v6, a82
  v_accvgpr_read_b32 v7, a83
  v_mul_f32 v0, v0, v192
  v_mul_f32 v1, v1, v192
  v_mul_f32 v2, v2, v192
  v_mul_f32 v3, v3, v192
  v_mul_f32 v4, v4, v192
  v_mul_f32 v5, v5, v192
  v_mul_f32 v6, v6, v192
  v_mul_f32 v7, v7, v192
  v_cvt_pk_bf16_f32 v0, v0, v1
  v_cvt_pk_bf16_f32 v1, v2, v3
  v_cvt_pk_bf16_f32 v2, v4, v5
  v_cvt_pk_bf16_f32 v3, v6, v7
  buffer_store_dwordx4 v[0:3], v244, s[24:27], s42 offen offset:0 sc1
  v_accvgpr_read_b32 v8, a68
  v_accvgpr_read_b32 v9, a69
  v_accvgpr_read_b32 v10, a70
  v_accvgpr_read_b32 v11, a71
  v_accvgpr_read_b32 v12, a84
  v_accvgpr_read_b32 v13, a85
  v_accvgpr_read_b32 v14, a86
  v_accvgpr_read_b32 v15, a87
  v_mul_f32 v8, v8, v196
  v_mul_f32 v9, v9, v196
  v_mul_f32 v10, v10, v196
  v_mul_f32 v11, v11, v196
  v_mul_f32 v12, v12, v196
  v_mul_f32 v13, v13, v196
  v_mul_f32 v14, v14, v196
  v_mul_f32 v15, v15, v196
  v_cvt_pk_bf16_f32 v8, v8, v9
  v_cvt_pk_bf16_f32 v9, v10, v11
  v_cvt_pk_bf16_f32 v10, v12, v13
  v_cvt_pk_bf16_f32 v11, v14, v15
  buffer_store_dwordx4 v[8:11], v244, s[24:27], s42 offen offset:2048 sc1
  v_accvgpr_read_b32 v16, a72
  v_accvgpr_read_b32 v17, a73
  v_accvgpr_read_b32 v18, a74
  v_accvgpr_read_b32 v19, a75
  v_accvgpr_read_b32 v20, a88
  v_accvgpr_read_b32 v21, a89
  v_accvgpr_read_b32 v22, a90
  v_accvgpr_read_b32 v23, a91
  v_mul_f32 v16, v16, v200
  v_mul_f32 v17, v17, v200
  v_mul_f32 v18, v18, v200
  v_mul_f32 v19, v19, v200
  v_mul_f32 v20, v20, v200
  v_mul_f32 v21, v21, v200
  v_mul_f32 v22, v22, v200
  v_mul_f32 v23, v23, v200
  v_cvt_pk_bf16_f32 v16, v16, v17
  v_cvt_pk_bf16_f32 v17, v18, v19
  v_cvt_pk_bf16_f32 v18, v20, v21
  v_cvt_pk_bf16_f32 v19, v22, v23
  buffer_store_dwordx4 v[16:19], v244, s[24:27], s43 offen offset:0 sc1
  v_accvgpr_read_b32 v24, a76
  v_accvgpr_read_b32 v25, a77
  v_accvgpr_read_b32 v26, a78
  v_accvgpr_read_b32 v27, a79
  v_accvgpr_read_b32 v28, a92
  v_accvgpr_read_b32 v29, a93
  v_accvgpr_read_b32 v30, a94
  v_accvgpr_read_b32 v31, a95
  v_mul_f32 v24, v24, v204
  v_mul_f32 v25, v25, v204
  v_mul_f32 v26, v26, v204
  v_mul_f32 v27, v27, v204
  v_mul_f32 v28, v28, v204
  v_mul_f32 v29, v29, v204
  v_mul_f32 v30, v30, v204
  v_mul_f32 v31, v31, v204
  v_cvt_pk_bf16_f32 v24, v24, v25
  v_cvt_pk_bf16_f32 v25, v26, v27
  v_cvt_pk_bf16_f32 v26, v28, v29
  v_cvt_pk_bf16_f32 v27, v30, v31
  buffer_store_dwordx4 v[24:27], v244, s[24:27], s43 offen offset:2048 sc1
  v_accvgpr_read_b32 v32, a96
  v_accvgpr_read_b32 v33, a97
  v_accvgpr_read_b32 v34, a98
  v_accvgpr_read_b32 v35, a99
  v_accvgpr_read_b32 v36, a112
  v_accvgpr_read_b32 v37, a113
  v_accvgpr_read_b32 v38, a114
  v_accvgpr_read_b32 v39, a115
  v_mul_f32 v32, v32, v192
  v_mul_f32 v33, v33, v192
  v_mul_f32 v34, v34, v192
  v_mul_f32 v35, v35, v192
  v_mul_f32 v36, v36, v192
  v_mul_f32 v37, v37, v192
  v_mul_f32 v38, v38, v192
  v_mul_f32 v39, v39, v192
  v_cvt_pk_bf16_f32 v32, v32, v33
  v_cvt_pk_bf16_f32 v33, v34, v35
  v_cvt_pk_bf16_f32 v34, v36, v37
  v_cvt_pk_bf16_f32 v35, v38, v39
  buffer_store_dwordx4 v[32:35], v244, s[24:27], s42 offen offset:1024 sc1
  v_accvgpr_read_b32 v40, a100
  v_accvgpr_read_b32 v41, a101
  v_accvgpr_read_b32 v42, a102
  v_accvgpr_read_b32 v43, a103
  v_accvgpr_read_b32 v44, a116
  v_accvgpr_read_b32 v45, a117
  v_accvgpr_read_b32 v46, a118
  v_accvgpr_read_b32 v47, a119
  v_mul_f32 v40, v40, v196
  v_mul_f32 v41, v41, v196
  v_mul_f32 v42, v42, v196
  v_mul_f32 v43, v43, v196
  v_mul_f32 v44, v44, v196
  v_mul_f32 v45, v45, v196
  v_mul_f32 v46, v46, v196
  v_mul_f32 v47, v47, v196
  v_cvt_pk_bf16_f32 v40, v40, v41
  v_cvt_pk_bf16_f32 v41, v42, v43
  v_cvt_pk_bf16_f32 v42, v44, v45
  v_cvt_pk_bf16_f32 v43, v46, v47
  buffer_store_dwordx4 v[40:43], v244, s[24:27], s42 offen offset:3072 sc1
  v_accvgpr_read_b32 v48, a104
  v_accvgpr_read_b32 v49, a105
  v_accvgpr_read_b32 v50, a106
  v_accvgpr_read_b32 v51, a107
  v_accvgpr_read_b32 v52, a120
  v_accvgpr_read_b32 v53, a121
  v_accvgpr_read_b32 v54, a122
  v_accvgpr_read_b32 v55, a123
  v_mul_f32 v48, v48, v200
  v_mul_f32 v49, v49, v200
  v_mul_f32 v50, v50, v200
  v_mul_f32 v51, v51, v200
  v_mul_f32 v52, v52, v200
  v_mul_f32 v53, v53, v200
  v_mul_f32 v54, v54, v200
  v_mul_f32 v55, v55, v200
  v_cvt_pk_bf16_f32 v48, v48, v49
  v_cvt_pk_bf16_f32 v49, v50, v51
  v_cvt_pk_bf16_f32 v50, v52, v53
  v_cvt_pk_bf16_f32 v51, v54, v55
  buffer_store_dwordx4 v[48:51], v244, s[24:27], s43 offen offset:1024 sc1
  v_accvgpr_read_b32 v56, a108
  v_accvgpr_read_b32 v57, a109
  v_accvgpr_read_b32 v58, a110
  v_accvgpr_read_b32 v59, a111
  v_accvgpr_read_b32 v60, a124
  v_accvgpr_read_b32 v61, a125
  v_accvgpr_read_b32 v62, a126
  v_accvgpr_read_b32 v63, a127
  v_mul_f32 v56, v56, v204
  v_mul_f32 v57, v57, v204
  v_mul_f32 v58, v58, v204
  v_mul_f32 v59, v59, v204
  v_mul_f32 v60, v60, v204
  v_mul_f32 v61, v61, v204
  v_mul_f32 v62, v62, v204
  v_mul_f32 v63, v63, v204
  v_cvt_pk_bf16_f32 v56, v56, v57
  v_cvt_pk_bf16_f32 v57, v58, v59
  v_cvt_pk_bf16_f32 v58, v60, v61
  v_cvt_pk_bf16_f32 v59, v62, v63
  buffer_store_dwordx4 v[56:59], v244, s[24:27], s43 offen offset:3072 sc1
  v_add_u32 v252, 4096, v242
  v_add_u32 v253, 8192, v242
  buffer_load_dwordx4 a[128:131], v253, s[24:27], s4 offen offset:3072 sc1
  buffer_load_dwordx4 a[132:135], v242, s[24:27], s5 offen offset:0 sc1
  buffer_load_dwordx4 a[136:139], v242, s[24:27], s5 offen offset:1024 sc1
  buffer_load_dwordx4 a[140:143], v242, s[24:27], s5 offen offset:2048 sc1
  buffer_load_dwordx4 a[144:147], v242, s[24:27], s5 offen offset:3072 sc1
  buffer_load_dwordx4 a[148:151], v252, s[24:27], s5 offen offset:0 sc1
  buffer_load_dwordx4 a[152:155], v252, s[24:27], s5 offen offset:1024 sc1
  buffer_load_dwordx4 a[156:159], v252, s[24:27], s5 offen offset:2048 sc1
  buffer_load_dwordx4 a[0:3], v252, s[24:27], s5 offen offset:3072 sc1
  buffer_load_dwordx4 a[4:7], v253, s[24:27], s5 offen offset:0 sc1
  buffer_load_dwordx4 a[8:11], v253, s[24:27], s5 offen offset:1024 sc1
  buffer_load_dwordx4 a[12:15], v253, s[24:27], s5 offen offset:2048 sc1
  buffer_load_dwordx4 a[16:19], v253, s[24:27], s5 offen offset:3072 sc1
  buffer_load_dwordx4 a[20:23], v242, s[24:27], s6 offen offset:0 sc1
  buffer_load_dwordx4 a[24:27], v242, s[24:27], s6 offen offset:1024 sc1
  buffer_load_dwordx4 a[28:31], v242, s[24:27], s6 offen offset:2048 sc1
  buffer_load_dwordx4 a[32:35], v242, s[24:27], s6 offen offset:3072 sc1
  buffer_load_dwordx4 a[36:39], v252, s[24:27], s6 offen offset:0 sc1
  buffer_load_dwordx4 a[40:43], v252, s[24:27], s6 offen offset:1024 sc1
  buffer_load_dwordx4 a[44:47], v252, s[24:27], s6 offen offset:2048 sc1
  buffer_load_dwordx4 a[48:51], v252, s[24:27], s6 offen offset:3072 sc1
  buffer_load_dwordx4 a[52:55], v253, s[24:27], s6 offen offset:0 sc1
  s_bfe_u32 s39, s2, 0x40002
  s_lshl_b32 s39, s39, 8
  s_add_u32 s39, s39, 2818304
  s_lshl_b32 s38, s3, 26
  v_lshlrev_b32 v64, 22, v242
  v_or_b32 v64, s38, v64
  v_mov_b32 v65, 1
  s_waitcnt vmcnt(0)
  s_barrier
  s_branch tail_go
.section .rodata,"a"
.p2align 6
.amdhsa_kernel recurrent_scan__mha_block_cached__moe_arch_mod__prompt_kernel
  .amdhsa_next_free_vgpr 512
  .amdhsa_next_free_sgpr 102
  .amdhsa_accum_offset 256
  .amdhsa_group_segment_fixed_size 0
  .amdhsa_kernarg_size 104
  .amdhsa_user_sgpr_count 2
  .amdhsa_user_sgpr_kernarg_segment_ptr 1
  .amdhsa_system_sgpr_workgroup_id_x 1
.end_amdhsa_kernel
```

```asm
; @launch grid=(256,1,1) block=(256,1,1) lds=163840
.amdgcn_target "amdgcn-amd-amdhsa--gfx950"
.text
.globl recurrent_scan__mha_block_cached__moe_arch_mod__prompt_kernel
.p2align 8
.type recurrent_scan__mha_block_cached__moe_arch_mod__prompt_kernel,@function
recurrent_scan__mha_block_cached__moe_arch_mod__prompt_kernel:
  s_cmp_ge_u32 s2, 256
  s_cbranch_scc1 attn_end
  s_load_dwordx2 s[60:61], s[0:1], 0
  s_load_dwordx2 s[48:49], s[0:1], 48
  s_load_dwordx4 s[4:7], s[0:1], 8
  s_load_dwordx2 s[8:9], s[0:1], 24
  s_load_dwordx2 s[10:11], s[0:1], 96
  s_load_dwordx2 s[88:89], s[0:1], 32
  s_load_dwordx2 s[90:91], s[0:1], 56
  s_load_dwordx4 s[92:95], s[0:1], 64
  s_load_dwordx2 s[96:97], s[0:1], 88
  s_load_dwordx2 s[62:63], s[0:1], 80
  s_getpc_b64 s[98:99]
attn_hot_pc:
  s_add_u32 s98, s98, attn_hot-attn_hot_pc
  s_addc_u32 s99, s99, 0
  v_lshlrev_b32 v249, 7, v0
  v_min_u32 v249, attn_end-attn_hot-4, v249
  global_load_dword v255, v249, s[98:99]
  v_add_u32 v249, 0x8000, v249
  v_min_u32 v249, attn_end-attn_hot-4, v249
  global_load_dword v255, v249, s[98:99]
attn_hot:
  v_lshrrev_b32 v249, 6, v0
  v_and_b32 v0, 63, v0
  v_mov_b32 v245, v0
  v_readfirstlane_b32 s3, v249
  s_and_b32 s36, s2, 7
  s_lshl_b32 s36, s36, 2
  s_lshr_b32 s37, s2, 6
  s_add_u32 s36, s36, s37
  s_bfe_u32 s37, s2, 0x30003
  s_lshl_b32 s37, s37, 2
  s_add_u32 s37, s37, s3
  s_lshl_b32 s28, s3, 12
  v_lshrrev_b32 v248, 4, v245
  v_and_b32 v247, 15, v245
  s_lshl_b32 s38, s3, 17
  v_lshlrev_b32 v249, 13, v248
  v_add_u32 v249, s38, v249
  v_or_b32 v250, 0, v248
  v_lshlrev_b32 v250, 1, v250
  v_xor_b32 v250, v250, v247
  v_lshl_add_u32 v238, v250, 4, v249
  v_or_b32 v250, 0, v248
  v_lshlrev_b32 v250, 1, v250
  v_xor_b32 v250, v250, v247
  v_lshl_add_u32 v239, v250, 4, v249
  v_add_u32 v239, 31744, v239
  v_or_b32 v250, 4, v248
  v_lshlrev_b32 v250, 1, v250
  v_xor_b32 v250, v250, v247
  v_lshl_add_u32 v240, v250, 4, v249
  v_add_u32 v240, 63488, v240
  v_or_b32 v250, 4, v248
  v_lshlrev_b32 v250, 1, v250
  v_xor_b32 v250, v250, v247
  v_lshl_add_u32 v241, v250, 4, v249
  v_add_u32 v241, 95232, v241
  s_waitcnt lgkmcnt(0)
  s_add_u32 s58, s10, 2830336
  s_addc_u32 s59, s11, 0
  s_load_dword s59, s[58:59], 0
  s_mov_b32 s24, s10
  s_mov_b32 s25, s11
  s_mov_b32 s26, 33554432
  s_mov_b32 s27, 0x20000
  s_lshl_b32 s38, s36, 8
  s_add_u32 s20, s8, s38
  s_addc_u32 s21, s9, 0
  s_mov_b32 s22, 5242880
  s_mov_b32 s23, 0x20000
  s_sub_u32 s22, s22, s38
  s_cmp_ge_u32 s3, 2
  s_cbranch_scc1 front_fetch
  s_mov_b32 s12, s60
  s_mov_b32 s13, s61
  s_mov_b32 s14, 2621440
  s_mov_b32 s15, 0x20000
  s_mov_b32 s16, s48
  s_mov_b32 s17, s49
  s_mov_b32 s18, 1280
  s_mov_b32 s19, 0x20000
  s_lshr_b32 s52, s37, 2
  s_lshl_b32 s52, s52, 5
  s_add_u32 s52, s52, s36
  s_lshl_b32 s52, s52, 1
  s_add_u32 s52, s52, s3
  s_lshl_b32 s52, s52, 2
  s_mul_i32 s53, s52, 1280
  v_lshrrev_b32 v1, 4, v0
  v_and_b32 v2, 15, v0
  v_lshlrev_b32 v3, 4, v2
  v_mul_u32_u24 v4, 0x500, v1
  v_add_u32 v4, v4, v3
  buffer_load_dwordx4 v[8:11], v4, s[12:15], s53 offen offset:0
  buffer_load_dwordx4 v[12:15], v4, s[12:15], s53 offen offset:256
  buffer_load_dwordx4 v[16:19], v4, s[12:15], s53 offen offset:512
  buffer_load_dwordx4 v[20:23], v4, s[12:15], s53 offen offset:768
  buffer_load_dwordx4 v[24:27], v4, s[12:15], s53 offen offset:1024
  buffer_load_dwordx4 v[28:31], v3, s[16:19], 0 offen offset:0
  buffer_load_dwordx4 v[32:35], v3, s[16:19], 0 offen offset:256
  buffer_load_dwordx4 v[36:39], v3, s[16:19], 0 offen offset:512
  buffer_load_dwordx4 v[40:43], v3, s[16:19], 0 offen offset:768
  buffer_load_dwordx4 v[44:47], v3, s[16:19], 0 offen offset:1024
  v_mov_b32 v7, 0
  v_lshlrev_b32 v6, 26, v0
  s_lshl_b32 s53, s2, 7
  s_add_u32 s53, s53, 2834432
  buffer_store_dword v7, v6, s[24:27], s53 offen sc1
  v_lshlrev_b32 v6, 8, v0
  v_lshrrev_b32 v5, 5, v0
  v_lshl_add_u32 v6, v5, 26, v6
  s_cmp_eq_u32 s2, 0
  s_cselect_b32 s53, 0, 1073741824
  v_or_b32 v6, s53, v6
  s_mov_b32 s53, 2818048
  buffer_store_dword v7, v6, s[24:27], s53 offen sc1
  s_lshr_b32 s53, s52, 6
  s_mul_i32 s53, s53, 81920
  s_bfe_u32 s54, s52, 0x20004
  s_lshl_b32 s54, s54, 10
  s_add_u32 s53, s53, s54
  s_and_b32 s54, s52, 15
  s_lshl_b32 s54, s54, 4
  s_add_u32 s53, s53, s54
  v_lshrrev_b32 v5, 2, v2
  v_lshlrev_b32 v5, 12, v5
  v_and_b32 v6, 3, v2
  v_lshl_add_u32 v5, v6, 8, v5
  v_lshl_add_u32 v5, v1, 4, v5
  s_mov_b32 s56, 0xffff0000
  s_waitcnt vmcnt(11)
  v_lshlrev_b32 v48, 16, v8
  v_and_b32 v49, s56, v8
  v_lshlrev_b32 v50, 16, v9
  v_and_b32 v51, s56, v9
  v_lshlrev_b32 v52, 16, v10
  v_and_b32 v53, s56, v10
  v_lshlrev_b32 v54, 16, v11
  v_and_b32 v55, s56, v11
  s_waitcnt vmcnt(10)
  v_lshlrev_b32 v56, 16, v12
  v_and_b32 v57, s56, v12
  v_lshlrev_b32 v58, 16, v13
  v_and_b32 v59, s56, v13
  v_lshlrev_b32 v60, 16, v14
  v_and_b32 v61, s56, v14
  v_lshlrev_b32 v62, 16, v15
  v_and_b32 v63, s56, v15
  s_waitcnt vmcnt(9)
  v_lshlrev_b32 v64, 16, v16
  v_and_b32 v65, s56, v16
  v_lshlrev_b32 v66, 16, v17
  v_and_b32 v67, s56, v17
  v_lshlrev_b32 v68, 16, v18
  v_and_b32 v69, s56, v18
  v_lshlrev_b32 v70, 16, v19
  v_and_b32 v71, s56, v19
  s_waitcnt vmcnt(8)
  v_lshlrev_b32 v72, 16, v20
  v_and_b32 v73, s56, v20
  v_lshlrev_b32 v74, 16, v21
  v_and_b32 v75, s56, v21
  v_lshlrev_b32 v76, 16, v22
  v_and_b32 v77, s56, v22
  v_lshlrev_b32 v78, 16, v23
  v_and_b32 v79, s56, v23
  s_waitcnt vmcnt(7)
  v_lshlrev_b32 v80, 16, v24
  v_and_b32 v81, s56, v24
  v_lshlrev_b32 v82, 16, v25
  v_and_b32 v83, s56, v25
  v_lshlrev_b32 v84, 16, v26
  v_and_b32 v85, s56, v26
  v_lshlrev_b32 v86, 16, v27
  v_and_b32 v87, s56, v27
  v_pk_add_f32 v[88:89], v[48:49], v[50:51]
  v_pk_add_f32 v[90:91], v[52:53], v[54:55]
  v_pk_add_f32 v[88:89], v[88:89], v[56:57]
  v_pk_add_f32 v[90:91], v[90:91], v[58:59]
  v_pk_add_f32 v[88:89], v[88:89], v[60:61]
  v_pk_add_f32 v[90:91], v[90:91], v[62:63]
  v_pk_add_f32 v[88:89], v[88:89], v[64:65]
  v_pk_add_f32 v[90:91], v[90:91], v[66:67]
  v_pk_add_f32 v[88:89], v[88:89], v[68:69]
  v_pk_add_f32 v[90:91], v[90:91], v[70:71]
  v_pk_add_f32 v[88:89], v[88:89], v[72:73]
  v_pk_add_f32 v[90:91], v[90:91], v[74:75]
  v_pk_add_f32 v[88:89], v[88:89], v[76:77]
  v_pk_add_f32 v[90:91], v[90:91], v[78:79]
  v_pk_add_f32 v[88:89], v[88:89], v[80:81]
  v_pk_add_f32 v[90:91], v[90:91], v[82:83]
  v_pk_add_f32 v[88:89], v[88:89], v[84:85]
  v_pk_add_f32 v[90:91], v[90:91], v[86:87]
  v_pk_add_f32 v[88:89], v[88:89], v[90:91]
  v_add_f32 v92, v88, v89
  s_nop 1
  v_add_f32_dpp v92, v92, v92 row_ror:8 row_mask:0xf bank_mask:0xf
  s_nop 1
  v_add_f32_dpp v92, v92, v92 row_ror:4 row_mask:0xf bank_mask:0xf
  s_nop 1
  v_add_f32_dpp v92, v92, v92 row_ror:2 row_mask:0xf bank_mask:0xf
  s_nop 1
  v_add_f32_dpp v92, v92, v92 row_ror:1 row_mask:0xf bank_mask:0xf
  v_mul_f32 v92, 0x3acccccd, v92
  v_pk_add_f32 v[94:95], v[48:49], v[92:93] op_sel_hi:[1,0] neg_lo:[0,1] neg_hi:[0,1]
  v_pk_mul_f32 v[88:89], v[94:95], v[94:95]
  v_pk_add_f32 v[96:97], v[50:51], v[92:93] op_sel_hi:[1,0] neg_lo:[0,1] neg_hi:[0,1]
  v_pk_mul_f32 v[90:91], v[96:97], v[96:97]
  v_pk_add_f32 v[94:95], v[52:53], v[92:93] op_sel_hi:[1,0] neg_lo:[0,1] neg_hi:[0,1]
  v_pk_fma_f32 v[88:89], v[94:95], v[94:95], v[88:89]
  v_pk_add_f32 v[96:97], v[54:55], v[92:93] op_sel_hi:[1,0] neg_lo:[0,1] neg_hi:[0,1]
  v_pk_fma_f32 v[90:91], v[96:97], v[96:97], v[90:91]
  v_pk_add_f32 v[94:95], v[56:57], v[92:93] op_sel_hi:[1,0] neg_lo:[0,1] neg_hi:[0,1]
  v_pk_fma_f32 v[88:89], v[94:95], v[94:95], v[88:89]
  v_pk_add_f32 v[96:97], v[58:59], v[92:93] op_sel_hi:[1,0] neg_lo:[0,1] neg_hi:[0,1]
  v_pk_fma_f32 v[90:91], v[96:97], v[96:97], v[90:91]
  v_pk_add_f32 v[94:95], v[60:61], v[92:93] op_sel_hi:[1,0] neg_lo:[0,1] neg_hi:[0,1]
  v_pk_fma_f32 v[88:89], v[94:95], v[94:95], v[88:89]
  v_pk_add_f32 v[96:97], v[62:63], v[92:93] op_sel_hi:[1,0] neg_lo:[0,1] neg_hi:[0,1]
  v_pk_fma_f32 v[90:91], v[96:97], v[96:97], v[90:91]
  v_pk_add_f32 v[94:95], v[64:65], v[92:93] op_sel_hi:[1,0] neg_lo:[0,1] neg_hi:[0,1]
  v_pk_fma_f32 v[88:89], v[94:95], v[94:95], v[88:89]
  v_pk_add_f32 v[96:97], v[66:67], v[92:93] op_sel_hi:[1,0] neg_lo:[0,1] neg_hi:[0,1]
  v_pk_fma_f32 v[90:91], v[96:97], v[96:97], v[90:91]
  v_pk_add_f32 v[94:95], v[68:69], v[92:93] op_sel_hi:[1,0] neg_lo:[0,1] neg_hi:[0,1]
  v_pk_fma_f32 v[88:89], v[94:95], v[94:95], v[88:89]
  v_pk_add_f32 v[96:97], v[70:71], v[92:93] op_sel_hi:[1,0] neg_lo:[0,1] neg_hi:[0,1]
  v_pk_fma_f32 v[90:91], v[96:97], v[96:97], v[90:91]
  v_pk_add_f32 v[94:95], v[72:73], v[92:93] op_sel_hi:[1,0] neg_lo:[0,1] neg_hi:[0,1]
  v_pk_fma_f32 v[88:89], v[94:95], v[94:95], v[88:89]
  v_pk_add_f32 v[96:97], v[74:75], v[92:93] op_sel_hi:[1,0] neg_lo:[0,1] neg_hi:[0,1]
  v_pk_fma_f32 v[90:91], v[96:97], v[96:97], v[90:91]
  v_pk_add_f32 v[94:95], v[76:77], v[92:93] op_sel_hi:[1,0] neg_lo:[0,1] neg_hi:[0,1]
  v_pk_fma_f32 v[88:89], v[94:95], v[94:95], v[88:89]
  v_pk_add_f32 v[96:97], v[78:79], v[92:93] op_sel_hi:[1,0] neg_lo:[0,1] neg_hi:[0,1]
  v_pk_fma_f32 v[90:91], v[96:97], v[96:97], v[90:91]
  v_pk_add_f32 v[94:95], v[80:81], v[92:93] op_sel_hi:[1,0] neg_lo:[0,1] neg_hi:[0,1]
  v_pk_fma_f32 v[88:89], v[94:95], v[94:95], v[88:89]
  v_pk_add_f32 v[96:97], v[82:83], v[92:93] op_sel_hi:[1,0] neg_lo:[0,1] neg_hi:[0,1]
  v_pk_fma_f32 v[90:91], v[96:97], v[96:97], v[90:91]
  v_pk_add_f32 v[94:95], v[84:85], v[92:93] op_sel_hi:[1,0] neg_lo:[0,1] neg_hi:[0,1]
  v_pk_fma_f32 v[88:89], v[94:95], v[94:95], v[88:89]
  v_pk_add_f32 v[96:97], v[86:87], v[92:93] op_sel_hi:[1,0] neg_lo:[0,1] neg_hi:[0,1]
  v_pk_fma_f32 v[90:91], v[96:97], v[96:97], v[90:91]
  v_pk_add_f32 v[88:89], v[88:89], v[90:91]
  v_add_f32 v98, v88, v89
  s_nop 1
  v_add_f32_dpp v98, v98, v98 row_ror:8 row_mask:0xf bank_mask:0xf
  v_cvt_pk_bf16_f32 v92, v92, v92
  s_nop 0
  v_add_f32_dpp v98, v98, v98 row_ror:4 row_mask:0xf bank_mask:0xf
  v_lshlrev_b32 v92, 16, v92
  s_nop 0
  v_add_f32_dpp v98, v98, v98 row_ror:2 row_mask:0xf bank_mask:0xf
  s_nop 1
  v_add_f32_dpp v98, v98, v98 row_ror:1 row_mask:0xf bank_mask:0xf
  v_mul_f32 v98, 0x3acccccd, v98
  v_cvt_pk_bf16_f32 v98, v98, v98
  v_pk_add_f32 v[48:49], v[48:49], v[92:93] op_sel_hi:[1,0] neg_lo:[0,1] neg_hi:[0,1]
  v_lshlrev_b32 v98, 16, v98
  v_pk_add_f32 v[50:51], v[50:51], v[92:93] op_sel_hi:[1,0] neg_lo:[0,1] neg_hi:[0,1]
  v_add_f32 v98, 0x3727c5ac, v98
  v_pk_add_f32 v[52:53], v[52:53], v[92:93] op_sel_hi:[1,0] neg_lo:[0,1] neg_hi:[0,1]
  v_cvt_pk_bf16_f32 v98, v98, v98
  v_pk_add_f32 v[54:55], v[54:55], v[92:93] op_sel_hi:[1,0] neg_lo:[0,1] neg_hi:[0,1]
  v_lshlrev_b32 v98, 16, v98
  v_pk_add_f32 v[56:57], v[56:57], v[92:93] op_sel_hi:[1,0] neg_lo:[0,1] neg_hi:[0,1]
  v_sqrt_f32 v98, v98
  v_pk_add_f32 v[58:59], v[58:59], v[92:93] op_sel_hi:[1,0] neg_lo:[0,1] neg_hi:[0,1]
  v_cvt_pk_bf16_f32 v98, v98, v98
  v_pk_add_f32 v[60:61], v[60:61], v[92:93] op_sel_hi:[1,0] neg_lo:[0,1] neg_hi:[0,1]
  v_lshlrev_b32 v98, 16, v98
  v_pk_add_f32 v[62:63], v[62:63], v[92:93] op_sel_hi:[1,0] neg_lo:[0,1] neg_hi:[0,1]
  v_rcp_f32 v100, v98
  v_pk_add_f32 v[64:65], v[64:65], v[92:93] op_sel_hi:[1,0] neg_lo:[0,1] neg_hi:[0,1]
  v_pk_add_f32 v[66:67], v[66:67], v[92:93] op_sel_hi:[1,0] neg_lo:[0,1] neg_hi:[0,1]
  v_pk_add_f32 v[68:69], v[68:69], v[92:93] op_sel_hi:[1,0] neg_lo:[0,1] neg_hi:[0,1]
  v_pk_add_f32 v[70:71], v[70:71], v[92:93] op_sel_hi:[1,0] neg_lo:[0,1] neg_hi:[0,1]
  v_pk_add_f32 v[72:73], v[72:73], v[92:93] op_sel_hi:[1,0] neg_lo:[0,1] neg_hi:[0,1]
  v_pk_add_f32 v[74:75], v[74:75], v[92:93] op_sel_hi:[1,0] neg_lo:[0,1] neg_hi:[0,1]
  v_pk_add_f32 v[76:77], v[76:77], v[92:93] op_sel_hi:[1,0] neg_lo:[0,1] neg_hi:[0,1]
  v_pk_add_f32 v[78:79], v[78:79], v[92:93] op_sel_hi:[1,0] neg_lo:[0,1] neg_hi:[0,1]
  v_pk_add_f32 v[80:81], v[80:81], v[92:93] op_sel_hi:[1,0] neg_lo:[0,1] neg_hi:[0,1]
  v_pk_add_f32 v[82:83], v[82:83], v[92:93] op_sel_hi:[1,0] neg_lo:[0,1] neg_hi:[0,1]
  v_pk_add_f32 v[84:85], v[84:85], v[92:93] op_sel_hi:[1,0] neg_lo:[0,1] neg_hi:[0,1]
  v_pk_add_f32 v[86:87], v[86:87], v[92:93] op_sel_hi:[1,0] neg_lo:[0,1] neg_hi:[0,1]
  v_mov_b32 v104, 0
  v_mov_b32 v105, 0
  v_cvt_pk_bf16_f32 v8, v48, v49
  v_cvt_pk_bf16_f32 v9, v50, v51
  v_cvt_pk_bf16_f32 v10, v52, v53
  v_cvt_pk_bf16_f32 v11, v54, v55
  v_cvt_pk_bf16_f32 v12, v56, v57
  v_cvt_pk_bf16_f32 v13, v58, v59
  v_cvt_pk_bf16_f32 v14, v60, v61
  v_cvt_pk_bf16_f32 v15, v62, v63
  v_cvt_pk_bf16_f32 v16, v64, v65
  v_cvt_pk_bf16_f32 v17, v66, v67
  v_cvt_pk_bf16_f32 v18, v68, v69
  v_cvt_pk_bf16_f32 v19, v70, v71
  v_cvt_pk_bf16_f32 v20, v72, v73
  v_cvt_pk_bf16_f32 v21, v74, v75
  v_cvt_pk_bf16_f32 v22, v76, v77
  v_cvt_pk_bf16_f32 v23, v78, v79
  v_cvt_pk_bf16_f32 v24, v80, v81
  v_cvt_pk_bf16_f32 v25, v82, v83
  v_cvt_pk_bf16_f32 v26, v84, v85
  v_cvt_pk_bf16_f32 v27, v86, v87
  v_lshlrev_b32 v48, 16, v8
  v_and_b32 v49, s56, v8
  v_lshlrev_b32 v50, 16, v9
  v_and_b32 v51, s56, v9
  v_lshlrev_b32 v52, 16, v10
  v_and_b32 v53, s56, v10
  v_lshlrev_b32 v54, 16, v11
  v_and_b32 v55, s56, v11
  v_lshlrev_b32 v56, 16, v12
  v_and_b32 v57, s56, v12
  v_lshlrev_b32 v58, 16, v13
  v_and_b32 v59, s56, v13
  v_lshlrev_b32 v60, 16, v14
  v_and_b32 v61, s56, v14
  v_lshlrev_b32 v62, 16, v15
  v_and_b32 v63, s56, v15
  v_lshlrev_b32 v64, 16, v16
  v_and_b32 v65, s56, v16
  v_lshlrev_b32 v66, 16, v17
  v_and_b32 v67, s56, v17
  v_lshlrev_b32 v68, 16, v18
  v_and_b32 v69, s56, v18
  v_lshlrev_b32 v70, 16, v19
  v_and_b32 v71, s56, v19
  v_lshlrev_b32 v72, 16, v20
  v_and_b32 v73, s56, v20
  v_lshlrev_b32 v74, 16, v21
  v_and_b32 v75, s56, v21
  v_lshlrev_b32 v76, 16, v22
  v_and_b32 v77, s56, v22
  v_lshlrev_b32 v78, 16, v23
  v_and_b32 v79, s56, v23
  v_lshlrev_b32 v80, 16, v24
  v_and_b32 v81, s56, v24
  v_lshlrev_b32 v82, 16, v25
  v_and_b32 v83, s56, v25
  v_lshlrev_b32 v84, 16, v26
  v_and_b32 v85, s56, v26
  v_lshlrev_b32 v86, 16, v27
  v_and_b32 v87, s56, v27
  v_pk_mul_f32 v[48:49], v[48:49], v[100:101] op_sel_hi:[1,0]
  v_pk_mul_f32 v[50:51], v[50:51], v[100:101] op_sel_hi:[1,0]
  v_pk_mul_f32 v[52:53], v[52:53], v[100:101] op_sel_hi:[1,0]
  v_pk_mul_f32 v[54:55], v[54:55], v[100:101] op_sel_hi:[1,0]
  v_cvt_pk_bf16_f32 v8, v48, v49
  v_cvt_pk_bf16_f32 v9, v50, v51
  v_cvt_pk_bf16_f32 v10, v52, v53
  v_cvt_pk_bf16_f32 v11, v54, v55
  buffer_store_dwordx4 v[8:11], v5, s[24:27], s53 offen sc1
  s_add_u32 s53, s53, 16384
  v_pk_mul_f32 v[56:57], v[56:57], v[100:101] op_sel_hi:[1,0]
  v_pk_mul_f32 v[58:59], v[58:59], v[100:101] op_sel_hi:[1,0]
  v_pk_mul_f32 v[60:61], v[60:61], v[100:101] op_sel_hi:[1,0]
  v_pk_mul_f32 v[62:63], v[62:63], v[100:101] op_sel_hi:[1,0]
  v_cvt_pk_bf16_f32 v12, v56, v57
  v_cvt_pk_bf16_f32 v13, v58, v59
  v_cvt_pk_bf16_f32 v14, v60, v61
  v_cvt_pk_bf16_f32 v15, v62, v63
  buffer_store_dwordx4 v[12:15], v5, s[24:27], s53 offen sc1
  s_add_u32 s53, s53, 16384
  v_pk_mul_f32 v[64:65], v[64:65], v[100:101] op_sel_hi:[1,0]
  v_pk_mul_f32 v[66:67], v[66:67], v[100:101] op_sel_hi:[1,0]
  v_pk_mul_f32 v[68:69], v[68:69], v[100:101] op_sel_hi:[1,0]
  v_pk_mul_f32 v[70:71], v[70:71], v[100:101] op_sel_hi:[1,0]
  v_cvt_pk_bf16_f32 v16, v64, v65
  v_cvt_pk_bf16_f32 v17, v66, v67
  v_cvt_pk_bf16_f32 v18, v68, v69
  v_cvt_pk_bf16_f32 v19, v70, v71
  buffer_store_dwordx4 v[16:19], v5, s[24:27], s53 offen sc1
  s_add_u32 s53, s53, 16384
  v_pk_mul_f32 v[72:73], v[72:73], v[100:101] op_sel_hi:[1,0]
  v_pk_mul_f32 v[74:75], v[74:75], v[100:101] op_sel_hi:[1,0]
  v_pk_mul_f32 v[76:77], v[76:77], v[100:101] op_sel_hi:[1,0]
  v_pk_mul_f32 v[78:79], v[78:79], v[100:101] op_sel_hi:[1,0]
  v_cvt_pk_bf16_f32 v20, v72, v73
  v_cvt_pk_bf16_f32 v21, v74, v75
  v_cvt_pk_bf16_f32 v22, v76, v77
  v_cvt_pk_bf16_f32 v23, v78, v79
  buffer_store_dwordx4 v[20:23], v5, s[24:27], s53 offen sc1
  s_add_u32 s53, s53, 16384
  v_pk_mul_f32 v[80:81], v[80:81], v[100:101] op_sel_hi:[1,0]
  v_pk_mul_f32 v[82:83], v[82:83], v[100:101] op_sel_hi:[1,0]
  v_pk_mul_f32 v[84:85], v[84:85], v[100:101] op_sel_hi:[1,0]
  v_pk_mul_f32 v[86:87], v[86:87], v[100:101] op_sel_hi:[1,0]
  v_cvt_pk_bf16_f32 v24, v80, v81
  v_cvt_pk_bf16_f32 v25, v82, v83
  v_cvt_pk_bf16_f32 v26, v84, v85
  v_cvt_pk_bf16_f32 v27, v86, v87
  buffer_store_dwordx4 v[24:27], v5, s[24:27], s53 offen sc1
  s_add_u32 s53, s53, 16384
  s_waitcnt vmcnt(11)
  v_dot2_f32_bf16 v104, v8, v28, v104
  v_dot2_f32_bf16 v105, v9, v29, v105
  v_dot2_f32_bf16 v104, v10, v30, v104
  v_dot2_f32_bf16 v105, v11, v31, v105
  s_waitcnt vmcnt(10)
  v_dot2_f32_bf16 v104, v12, v32, v104
  v_dot2_f32_bf16 v105, v13, v33, v105
  v_dot2_f32_bf16 v104, v14, v34, v104
  v_dot2_f32_bf16 v105, v15, v35, v105
  s_waitcnt vmcnt(9)
  v_dot2_f32_bf16 v104, v16, v36, v104
  v_dot2_f32_bf16 v105, v17, v37, v105
  v_dot2_f32_bf16 v104, v18, v38, v104
  v_dot2_f32_bf16 v105, v19, v39, v105
  s_waitcnt vmcnt(8)
  v_dot2_f32_bf16 v104, v20, v40, v104
  v_dot2_f32_bf16 v105, v21, v41, v105
  v_dot2_f32_bf16 v104, v22, v42, v104
  v_dot2_f32_bf16 v105, v23, v43, v105
  s_waitcnt vmcnt(7)
  v_dot2_f32_bf16 v104, v24, v44, v104
  v_dot2_f32_bf16 v105, v25, v45, v105
  v_dot2_f32_bf16 v104, v26, v46, v104
  v_dot2_f32_bf16 v105, v27, v47, v105
  s_nop 2
  v_add_f32 v104, v104, v105
  s_nop 1
  v_add_f32_dpp v104, v104, v104 row_ror:8 row_mask:0xf bank_mask:0xf
  s_nop 1
  v_add_f32_dpp v104, v104, v104 row_ror:4 row_mask:0xf bank_mask:0xf
  s_nop 1
  v_add_f32_dpp v104, v104, v104 row_ror:2 row_mask:0xf bank_mask:0xf
  s_nop 1
  v_add_f32_dpp v104, v104, v104 row_ror:1 row_mask:0xf bank_mask:0xf
  v_cvt_pk_bf16_f32 v104, v104, v104
  v_lshlrev_b32 v104, 16, v104
  v_ashrrev_i32 v105, 31, v104
  v_or_b32 v105, 0x80000000, v105
  v_xor_b32 v104, v104, v105
  v_and_b32 v104, s56, v104
  v_add_u32 v6, s52, v1
  v_sub_u32 v7, 0xffff, v6
  v_or_b32 v104, v104, v7
  v_lshlrev_b32 v6, 2, v6
  v_lshl_add_u32 v6, v2, 26, v6
  s_mov_b32 s53, 2621440
  buffer_store_dword v104, v6, s[24:27], s53 offen sc1
  s_waitcnt vmcnt(0)
  s_branch front_join
front_fetch:
  v_subrev_u32 v16, 0x40000, v238
  v_subrev_u32 v17, 0x40000, v239
  v_subrev_u32 v18, 0x40000, v240
  v_subrev_u32 v19, 0x40000, v241
front_join:
  s_waitcnt lgkmcnt(0)
  s_barrier
  s_mul_i32 s55, s59, 0x9e3779b1
  s_add_u32 s55, s55, 0x7f4a7c15
  s_bfe_u32 s58, s2, 0x30003
  s_lshl_b32 s58, s58, 8
  s_add_u32 s58, s58, 2826240
  s_lshl_b32 s53, s36, 2
  s_lshl_b32 s54, s3, 26
  s_add_u32 s53, s53, s54
  v_min_u32 v1, 1, v0
  v_lshlrev_b32 v1, 28, v1
  v_add_u32 v1, s53, v1
  v_mov_b32 v2, s55
  buffer_store_dword v2, v1, s[24:27], s58 offen sc1
  s_cmp_lt_u32 s3, 2
  s_cbranch_scc1 front_addr
  s_mov_b32 s31, 0
  s_add_u32 m0, s28, 90112
  s_nop 0
  buffer_load_dwordx4 v16, s[20:23], s31 offen offset:0 lds
  buffer_load_dwordx4 v17, s[20:23], s31 offen offset:1024 lds
  buffer_load_dwordx4 v18, s[20:23], s31 offen offset:2048 lds
  buffer_load_dwordx4 v19, s[20:23], s31 offen offset:3072 lds
  s_add_u32 m0, s28, 98304
  s_nop 0
  buffer_load_dwordx4 v238, s[20:23], s31 offen offset:0 lds
  buffer_load_dwordx4 v239, s[20:23], s31 offen offset:1024 lds
  buffer_load_dwordx4 v240, s[20:23], s31 offen offset:2048 lds
  buffer_load_dwordx4 v241, s[20:23], s31 offen offset:3072 lds
  s_mov_b32 s31, 524288
  s_add_u32 m0, s28, 106496
  s_nop 0
  buffer_load_dwordx4 v16, s[20:23], s31 offen offset:0 lds
  buffer_load_dwordx4 v17, s[20:23], s31 offen offset:1024 lds
  buffer_load_dwordx4 v18, s[20:23], s31 offen offset:2048 lds
  buffer_load_dwordx4 v19, s[20:23], s31 offen offset:3072 lds
  s_add_u32 m0, s28, 114688
  s_nop 0
  buffer_load_dwordx4 v238, s[20:23], s31 offen offset:0 lds
  buffer_load_dwordx4 v239, s[20:23], s31 offen offset:1024 lds
  buffer_load_dwordx4 v240, s[20:23], s31 offen offset:2048 lds
  buffer_load_dwordx4 v241, s[20:23], s31 offen offset:3072 lds
  s_mov_b32 s31, 1048576
  s_add_u32 m0, s28, 24576
  s_nop 0
  buffer_load_dwordx4 v16, s[20:23], s31 offen offset:0 lds
  buffer_load_dwordx4 v17, s[20:23], s31 offen offset:1024 lds
  buffer_load_dwordx4 v18, s[20:23], s31 offen offset:2048 lds
  buffer_load_dwordx4 v19, s[20:23], s31 offen offset:3072 lds
  s_add_u32 m0, s28, 32768
  s_nop 0
  buffer_load_dwordx4 v238, s[20:23], s31 offen offset:0 lds
  buffer_load_dwordx4 v239, s[20:23], s31 offen offset:1024 lds
  buffer_load_dwordx4 v240, s[20:23], s31 offen offset:2048 lds
  buffer_load_dwordx4 v241, s[20:23], s31 offen offset:3072 lds
  s_mov_b32 s31, 1572864
  s_add_u32 m0, s28, 40960
  s_nop 0
  buffer_load_dwordx4 v16, s[20:23], s31 offen offset:0 lds
  buffer_load_dwordx4 v17, s[20:23], s31 offen offset:1024 lds
  buffer_load_dwordx4 v18, s[20:23], s31 offen offset:2048 lds
  buffer_load_dwordx4 v19, s[20:23], s31 offen offset:3072 lds
  s_add_u32 m0, s28, 49152
  s_nop 0
  buffer_load_dwordx4 v238, s[20:23], s31 offen offset:0 lds
  buffer_load_dwordx4 v239, s[20:23], s31 offen offset:1024 lds
  buffer_load_dwordx4 v240, s[20:23], s31 offen offset:2048 lds
  buffer_load_dwordx4 v241, s[20:23], s31 offen offset:3072 lds
front_addr:
  s_mov_b32 s31, 2097152
  v_lshlrev_b32 v242, 4, v245
  v_add_u32 v243, 0x1000, v242
  s_mul_i32 s30, s37, 81920
  s_lshl_b32 s38, s36, 19
  s_add_u32 s12, s4, s38
  s_addc_u32 s13, s5, 0
  s_mov_b32 s14, 524288
  s_mov_b32 s15, 0x20000
  s_add_u32 s16, s6, s38
  s_addc_u32 s17, s7, 0
  s_mov_b32 s18, 524288
  s_mov_b32 s19, 0x20000
  v_lshlrev_b32 v249, 8, v248
  v_add_u32 v249, s28, v249
  v_add_u32 v250, 0, v248
  v_xor_b32 v250, v250, v247
  v_lshl_add_u32 v232, v250, 4, v249
  v_add_u32 v250, 4, v248
  v_xor_b32 v250, v250, v247
  v_lshl_add_u32 v233, v250, 4, v249
  v_add_u32 v250, 8, v248
  v_xor_b32 v250, v250, v247
  v_lshl_add_u32 v234, v250, 4, v249
  v_add_u32 v250, 12, v248
  v_xor_b32 v250, v250, v247
  v_lshl_add_u32 v235, v250, 4, v249
  v_add_u32 v250, 0, v248
  v_lshlrev_b32 v250, 1, v250
  v_xor_b32 v250, v250, v247
  v_lshl_add_u32 v236, v250, 4, v249
  v_add_u32 v250, 4, v248
  v_lshlrev_b32 v250, 1, v250
  v_xor_b32 v250, v250, v247
  v_lshl_add_u32 v237, v250, 4, v249
  v_lshrrev_b32 v249, 1, v248
  v_and_b32 v250, 1, v248
  v_lshl_or_b32 v249, v250, 1, v249
  v_xor_b32 v249, v249, v247
  v_lshlrev_b32 v249, 4, v249
  v_lshl_add_u32 v212, v247, 8, v249
  v_xor_b32 v213, 64, v212
  v_xor_b32 v214, 128, v212
  v_xor_b32 v215, 192, v212
  v_bfe_u32 v246, v245, 2, 2
  v_and_b32 v247, 3, v245
  v_lshlrev_b32 v247, 3, v247
  v_add_u32 v247, 65536, v247
  v_lshl_add_u32 v249, v248, 2, v246
  v_and_b32 v250, 7, v249
  v_lshl_add_u32 v250, v250, 5, v247
  v_lshl_add_u32 v216, v249, 8, v250
  v_lshl_add_u32 v249, v248, 3, v246
  v_and_b32 v250, 1, v248
  v_lshl_add_u32 v250, v250, 2, v246
  v_lshl_add_u32 v250, v250, 5, v247
  v_lshl_add_u32 v224, v249, 8, v250
  v_xor_b32 v217, 32, v216
  v_xor_b32 v225, 32, v224
  v_xor_b32 v218, 64, v216
  v_xor_b32 v226, 64, v224
  v_xor_b32 v219, 96, v216
  v_xor_b32 v227, 96, v224
  v_xor_b32 v220, 128, v216
  v_xor_b32 v228, 128, v224
  v_xor_b32 v221, 160, v216
  v_xor_b32 v229, 160, v224
  v_xor_b32 v222, 192, v216
  v_xor_b32 v230, 192, v224
  v_xor_b32 v223, 224, v216
  v_xor_b32 v231, 224, v224
  v_subrev_u32 v144, 65536, v224
  v_subrev_u32 v145, 65536, v225
  v_subrev_u32 v146, 65536, v226
  v_subrev_u32 v147, 65536, v227
  v_subrev_u32 v148, 65536, v228
  v_subrev_u32 v149, 65536, v229
  v_subrev_u32 v150, 65536, v230
  v_subrev_u32 v151, 65536, v231
  s_lshr_b32 s38, s2, 3
  s_min_u32 s38, s38, 26
  s_and_b32 s39, s2, 7
  s_mul_i32 s39, s39, 27
  s_add_u32 s33, s38, s39
  s_mul_i32 s50, s3, 6144
  s_add_u32 s50, s50, 133120
  v_mov_b32 v244, v242
  s_lshl_b32 s40, s37, 19
  s_lshl_b32 s38, s36, 14
  s_add_u32 s40, s40, s38
  s_add_u32 s40, s40, 8388608
  s_add_u32 s41, s40, 4096
  s_add_u32 s42, s40, 8192
  s_add_u32 s43, s40, 12288
  s_mov_b32 s34, 0x3e0293ee
  s_mov_b32 s29, 0
  v_and_b32 v249, 15, v245
  v_cmp_eq_u32 vcc, 0, v249
  v_mov_b32 v249, 0x3f803f80
  s_nop 0
  v_cndmask_b32 v249, 0, v249, vcc
  v_accvgpr_write_b32 a208, v249
  v_accvgpr_write_b32 a209, v249
  v_accvgpr_write_b32 a210, v249
  v_accvgpr_write_b32 a211, v249
  s_cmp_lg_u32 s3, 0
  s_cbranch_scc1 front_go
  v_and_b32 v2, 31, v0
  v_lshlrev_b32 v2, 2, v2
  s_mov_b32 s54, 32768
front_poll:
  buffer_load_dword v1, v2, s[24:27], s58 offen sc1
  s_waitcnt vmcnt(0)
  v_cmp_ne_u32 vcc, s55, v1
  s_nop 0
  s_cbranch_vccz front_go
  s_sleep 2
  s_sub_u32 s54, s54, 1
  s_cmp_lg_u32 s54, 0
  s_cbranch_scc1 front_poll
front_go:
  s_waitcnt vmcnt(24)
  s_barrier
  buffer_load_dwordx4 a[0:3], v242, s[24:27], s30 offen offset:0 sc1
  buffer_load_dwordx4 a[4:7], v242, s[24:27], s30 offen offset:1024 sc1
  buffer_load_dwordx4 a[8:11], v242, s[24:27], s30 offen offset:2048 sc1
  buffer_load_dwordx4 a[12:15], v242, s[24:27], s30 offen offset:3072 sc1
  buffer_load_dwordx4 a[16:19], v243, s[24:27], s30 offen offset:0 sc1
  buffer_load_dwordx4 a[20:23], v243, s[24:27], s30 offen offset:1024 sc1
  buffer_load_dwordx4 a[24:27], v243, s[24:27], s30 offen offset:2048 sc1
  buffer_load_dwordx4 a[28:31], v243, s[24:27], s30 offen offset:3072 sc1
  s_add_u32 s30, s30, 8192
  buffer_load_dwordx4 a[32:35], v242, s[24:27], s30 offen offset:0 sc1
  buffer_load_dwordx4 a[36:39], v242, s[24:27], s30 offen offset:1024 sc1
  buffer_load_dwordx4 a[40:43], v242, s[24:27], s30 offen offset:2048 sc1
  buffer_load_dwordx4 a[44:47], v242, s[24:27], s30 offen offset:3072 sc1
  buffer_load_dwordx4 a[48:51], v243, s[24:27], s30 offen offset:0 sc1
  buffer_load_dwordx4 a[52:55], v243, s[24:27], s30 offen offset:1024 sc1
  buffer_load_dwordx4 a[56:59], v243, s[24:27], s30 offen offset:2048 sc1
  buffer_load_dwordx4 a[60:63], v243, s[24:27], s30 offen offset:3072 sc1
  s_add_u32 s30, s30, 8192
  v_lshrrev_b32 v140, 7, v242
  v_lshlrev_b32 v140, 8, v140
  v_and_b32 v136, 0x70, v242
  v_add_u32 v140, v140, v136
  s_mov_b32 s58, 2826240
  buffer_load_dwordx4 v[136:139], v140, s[24:27], s58 offen sc1
  ds_read_b64_tr_b16 a[160:161], v224 offset:32768
  ds_read_b64_tr_b16 a[162:163], v224 offset:33792
  ds_read_b64_tr_b16 a[164:165], v224 offset:40960
  ds_read_b64_tr_b16 a[166:167], v224 offset:41984
  ds_read_b64_tr_b16 a[168:169], v225 offset:32768
  ds_read_b64_tr_b16 a[170:171], v225 offset:33792
  ds_read_b64_tr_b16 a[172:173], v225 offset:40960
  ds_read_b64_tr_b16 a[174:175], v225 offset:41984
  s_waitcnt vmcnt(9) lgkmcnt(4)
  v_mfma_f32_16x16x32_bf16 v[0:3], a[160:163], a[0:3], 0
  ds_read_b64_tr_b16 a[176:177], v226 offset:32768
  v_mfma_f32_16x16x32_bf16 v[0:3], a[164:167], a[16:19], v[0:3]
  buffer_load_dwordx4 a[64:67], v242, s[24:27], s30 offen offset:0 sc1
  v_mfma_f32_16x16x32_bf16 v[4:7], a[164:167], a[20:23], 0
  ds_read_b64_tr_b16 a[178:179], v226 offset:33792
  v_mfma_f32_16x16x32_bf16 v[4:7], a[160:163], a[4:7], v[4:7]
  buffer_load_dwordx4 a[68:71], v242, s[24:27], s30 offen offset:1024 sc1
  v_mfma_f32_16x16x32_bf16 v[8:11], a[160:163], a[8:11], 0
  ds_read_b64_tr_b16 a[180:181], v226 offset:40960
  v_mfma_f32_16x16x32_bf16 v[8:11], a[164:167], a[24:27], v[8:11]
  v_mfma_f32_16x16x32_bf16 v[12:15], a[164:167], a[28:31], 0
  ds_read_b64_tr_b16 a[182:183], v226 offset:41984
  v_mfma_f32_16x16x32_bf16 v[12:15], a[160:163], a[12:15], v[12:15]
  s_waitcnt lgkmcnt(4)
  buffer_load_dwordx4 a[72:75], v242, s[24:27], s30 offen offset:2048 sc1
  v_mfma_f32_16x16x32_bf16 v[16:19], a[168:171], a[0:3], 0
  ds_read_b64_tr_b16 a[184:185], v227 offset:32768
  v_mfma_f32_16x16x32_bf16 v[16:19], a[172:175], a[16:19], v[16:19]
  v_mfma_f32_16x16x32_bf16 v[20:23], a[172:175], a[20:23], 0
  ds_read_b64_tr_b16 a[186:187], v227 offset:33792
  v_mfma_f32_16x16x32_bf16 v[20:23], a[168:171], a[4:7], v[20:23]
  buffer_load_dwordx4 a[76:79], v242, s[24:27], s30 offen offset:3072 sc1
  v_mfma_f32_16x16x32_bf16 v[24:27], a[168:171], a[8:11], 0
  ds_read_b64_tr_b16 a[188:189], v227 offset:40960
  v_mfma_f32_16x16x32_bf16 v[24:27], a[172:175], a[24:27], v[24:27]
  buffer_load_dwordx4 a[80:83], v243, s[24:27], s30 offen offset:0 sc1
  v_mfma_f32_16x16x32_bf16 v[28:31], a[172:175], a[28:31], 0
  ds_read_b64_tr_b16 a[190:191], v227 offset:41984
  v_mfma_f32_16x16x32_bf16 v[28:31], a[168:171], a[12:15], v[28:31]
  s_waitcnt lgkmcnt(4)
  v_mfma_f32_16x16x32_bf16 v[32:35], a[176:179], a[0:3], 0
  ds_read_b64_tr_b16 a[160:161], v228 offset:32768
  v_mfma_f32_16x16x32_bf16 v[32:35], a[180:183], a[16:19], v[32:35]
  buffer_load_dwordx4 a[84:87], v243, s[24:27], s30 offen offset:1024 sc1
  v_mfma_f32_16x16x32_bf16 v[36:39], a[180:183], a[20:23], 0
  ds_read_b64_tr_b16 a[162:163], v228 offset:33792
  v_mfma_f32_16x16x32_bf16 v[36:39], a[176:179], a[4:7], v[36:39]
  v_mfma_f32_16x16x32_bf16 v[40:43], a[176:179], a[8:11], 0
  ds_read_b64_tr_b16 a[164:165], v228 offset:40960
  v_mfma_f32_16x16x32_bf16 v[40:43], a[180:183], a[24:27], v[40:43]
  buffer_load_dwordx4 a[88:91], v243, s[24:27], s30 offen offset:2048 sc1
  v_mfma_f32_16x16x32_bf16 v[44:47], a[180:183], a[28:31], 0
  ds_read_b64_tr_b16 a[166:167], v228 offset:41984
  v_mfma_f32_16x16x32_bf16 v[44:47], a[176:179], a[12:15], v[44:47]
  s_waitcnt lgkmcnt(4)
  buffer_load_dwordx4 a[92:95], v243, s[24:27], s30 offen offset:3072 sc1
  v_mfma_f32_16x16x32_bf16 v[48:51], a[184:187], a[0:3], 0
  ds_read_b64_tr_b16 a[168:169], v229 offset:32768
  v_mfma_f32_16x16x32_bf16 v[48:51], a[188:191], a[16:19], v[48:51]
  v_mfma_f32_16x16x32_bf16 v[52:55], a[188:191], a[20:23], 0
  ds_read_b64_tr_b16 a[170:171], v229 offset:33792
  v_mfma_f32_16x16x32_bf16 v[52:55], a[184:187], a[4:7], v[52:55]
  s_add_u32 s30, s30, 8192
  v_mfma_f32_16x16x32_bf16 v[56:59], a[184:187], a[8:11], 0
  ds_read_b64_tr_b16 a[172:173], v229 offset:40960
  v_mfma_f32_16x16x32_bf16 v[56:59], a[188:191], a[24:27], v[56:59]
  v_mfma_f32_16x16x32_bf16 v[60:63], a[188:191], a[28:31], 0
  ds_read_b64_tr_b16 a[174:175], v229 offset:41984
  v_mfma_f32_16x16x32_bf16 v[60:63], a[184:187], a[12:15], v[60:63]
  s_waitcnt lgkmcnt(4)
  buffer_load_dwordx4 a[96:99], v242, s[24:27], s30 offen offset:0 sc1
  v_mfma_f32_16x16x32_bf16 v[64:67], a[160:163], a[0:3], 0
  ds_read_b64_tr_b16 a[176:177], v230 offset:32768
  v_mfma_f32_16x16x32_bf16 v[64:67], a[164:167], a[16:19], v[64:67]
  buffer_load_dwordx4 a[100:103], v242, s[24:27], s30 offen offset:1024 sc1
  v_mfma_f32_16x16x32_bf16 v[68:71], a[164:167], a[20:23], 0
  ds_read_b64_tr_b16 a[178:179], v230 offset:33792
  v_mfma_f32_16x16x32_bf16 v[68:71], a[160:163], a[4:7], v[68:71]
  v_mfma_f32_16x16x32_bf16 v[72:75], a[160:163], a[8:11], 0
  ds_read_b64_tr_b16 a[180:181], v230 offset:40960
  v_mfma_f32_16x16x32_bf16 v[72:75], a[164:167], a[24:27], v[72:75]
  buffer_load_dwordx4 a[104:107], v242, s[24:27], s30 offen offset:2048 sc1
  v_mfma_f32_16x16x32_bf16 v[76:79], a[164:167], a[28:31], 0
  ds_read_b64_tr_b16 a[182:183], v230 offset:41984
  v_mfma_f32_16x16x32_bf16 v[76:79], a[160:163], a[12:15], v[76:79]
  s_waitcnt lgkmcnt(4)
  v_mfma_f32_16x16x32_bf16 v[80:83], a[168:171], a[0:3], 0
  ds_read_b64_tr_b16 a[184:185], v231 offset:32768
  v_mfma_f32_16x16x32_bf16 v[80:83], a[172:175], a[16:19], v[80:83]
  buffer_load_dwordx4 a[108:111], v242, s[24:27], s30 offen offset:3072 sc1
  v_mfma_f32_16x16x32_bf16 v[84:87], a[172:175], a[20:23], 0
  ds_read_b64_tr_b16 a[186:187], v231 offset:33792
  v_mfma_f32_16x16x32_bf16 v[84:87], a[168:171], a[4:7], v[84:87]
  buffer_load_dwordx4 a[112:115], v243, s[24:27], s30 offen offset:0 sc1
  v_mfma_f32_16x16x32_bf16 v[88:91], a[168:171], a[8:11], 0
  ds_read_b64_tr_b16 a[188:189], v231 offset:40960
  v_mfma_f32_16x16x32_bf16 v[88:91], a[172:175], a[24:27], v[88:91]
  s_barrier
  v_mfma_f32_16x16x32_bf16 v[92:95], a[172:175], a[28:31], 0
  ds_read_b64_tr_b16 a[190:191], v231 offset:41984
  v_mfma_f32_16x16x32_bf16 v[92:95], a[168:171], a[12:15], v[92:95]
  s_waitcnt lgkmcnt(4)
  buffer_load_dwordx4 a[116:119], v243, s[24:27], s30 offen offset:1024 sc1
  v_mfma_f32_16x16x32_bf16 v[96:99], a[176:179], a[0:3], 0
  ds_read_b64_tr_b16 a[160:161], v224 offset:49152
  v_mfma_f32_16x16x32_bf16 v[96:99], a[180:183], a[16:19], v[96:99]
  v_mfma_f32_16x16x32_bf16 v[100:103], a[180:183], a[20:23], 0
  ds_read_b64_tr_b16 a[162:163], v224 offset:50176
  v_mfma_f32_16x16x32_bf16 v[100:103], a[176:179], a[4:7], v[100:103]
  buffer_load_dwordx4 a[120:123], v243, s[24:27], s30 offen offset:2048 sc1
  v_mfma_f32_16x16x32_bf16 v[104:107], a[176:179], a[8:11], 0
  ds_read_b64_tr_b16 a[164:165], v224 offset:57344
  v_mfma_f32_16x16x32_bf16 v[104:107], a[180:183], a[24:27], v[104:107]
  buffer_load_dwordx4 a[124:127], v243, s[24:27], s30 offen offset:3072 sc1
  v_mfma_f32_16x16x32_bf16 v[108:111], a[180:183], a[28:31], 0
  ds_read_b64_tr_b16 a[166:167], v224 offset:58368
  v_mfma_f32_16x16x32_bf16 v[108:111], a[176:179], a[12:15], v[108:111]
  s_waitcnt lgkmcnt(4)
  v_mfma_f32_16x16x32_bf16 v[112:115], a[184:187], a[0:3], 0
  ds_read_b64_tr_b16 a[168:169], v225 offset:49152
  v_mfma_f32_16x16x32_bf16 v[112:115], a[188:191], a[16:19], v[112:115]
  s_add_u32 s30, s30, 8192
  v_mfma_f32_16x16x32_bf16 v[116:119], a[188:191], a[20:23], 0
  ds_read_b64_tr_b16 a[170:171], v225 offset:50176
  v_mfma_f32_16x16x32_bf16 v[116:119], a[184:187], a[4:7], v[116:119]
  v_mfma_f32_16x16x32_bf16 v[120:123], a[184:187], a[8:11], 0
  ds_read_b64_tr_b16 a[172:173], v225 offset:57344
  v_mfma_f32_16x16x32_bf16 v[120:123], a[188:191], a[24:27], v[120:123]
  v_mfma_f32_16x16x32_bf16 v[124:127], a[188:191], a[28:31], 0
  ds_read_b64_tr_b16 a[174:175], v225 offset:58368
  v_mfma_f32_16x16x32_bf16 v[124:127], a[184:187], a[12:15], v[124:127]
  s_waitcnt vmcnt(17) lgkmcnt(4)
  v_mfma_f32_16x16x32_bf16 v[0:3], a[160:163], a[32:35], v[0:3]
  ds_read_b64_tr_b16 a[176:177], v226 offset:49152
  v_mfma_f32_16x16x32_bf16 v[0:3], a[164:167], a[48:51], v[0:3]
  buffer_load_dwordx4 a[0:3], v242, s[24:27], s30 offen offset:0 sc1
  v_mfma_f32_16x16x32_bf16 v[4:7], a[164:167], a[52:55], v[4:7]
  ds_read_b64_tr_b16 a[178:179], v226 offset:50176
  v_mfma_f32_16x16x32_bf16 v[4:7], a[160:163], a[36:39], v[4:7]
  v_mfma_f32_16x16x32_bf16 v[8:11], a[160:163], a[40:43], v[8:11]
  ds_read_b64_tr_b16 a[180:181], v226 offset:57344
  s_add_u32 m0, s28, 16384
  v_mfma_f32_16x16x32_bf16 v[8:11], a[164:167], a[56:59], v[8:11]
  buffer_load_dwordx4 v238, s[20:23], s31 offen offset:0 lds
  v_mfma_f32_16x16x32_bf16 v[12:15], a[164:167], a[60:63], v[12:15]
  ds_read_b64_tr_b16 a[182:183], v226 offset:58368
  v_mfma_f32_16x16x32_bf16 v[12:15], a[160:163], a[44:47], v[12:15]
  s_waitcnt lgkmcnt(4)
  v_mfma_f32_16x16x32_bf16 v[16:19], a[168:171], a[32:35], v[16:19]
  ds_read_b64_tr_b16 a[184:185], v227 offset:49152
  v_mfma_f32_16x16x32_bf16 v[16:19], a[172:175], a[48:51], v[16:19]
  buffer_load_dwordx4 a[4:7], v242, s[24:27], s30 offen offset:1024 sc1
  v_mfma_f32_16x16x32_bf16 v[20:23], a[172:175], a[52:55], v[20:23]
  ds_read_b64_tr_b16 a[186:187], v227 offset:50176
  v_mfma_f32_16x16x32_bf16 v[20:23], a[168:171], a[36:39], v[20:23]
  v_mfma_f32_16x16x32_bf16 v[24:27], a[168:171], a[40:43], v[24:27]
  ds_read_b64_tr_b16 a[188:189], v227 offset:57344
  v_mfma_f32_16x16x32_bf16 v[24:27], a[172:175], a[56:59], v[24:27]
  v_mfma_f32_16x16x32_bf16 v[28:31], a[172:175], a[60:63], v[28:31]
  ds_read_b64_tr_b16 a[190:191], v227 offset:58368
  v_mfma_f32_16x16x32_bf16 v[28:31], a[168:171], a[44:47], v[28:31]
  s_waitcnt lgkmcnt(4)
  v_mfma_f32_16x16x32_bf16 v[32:35], a[176:179], a[32:35], v[32:35]
  ds_read_b64_tr_b16 a[160:161], v228 offset:49152
  v_mfma_f32_16x16x32_bf16 v[32:35], a[180:183], a[48:51], v[32:35]
  buffer_load_dwordx4 a[8:11], v242, s[24:27], s30 offen offset:2048 sc1
  v_mfma_f32_16x16x32_bf16 v[36:39], a[180:183], a[52:55], v[36:39]
  ds_read_b64_tr_b16 a[162:163], v228 offset:50176
  v_mfma_f32_16x16x32_bf16 v[36:39], a[176:179], a[36:39], v[36:39]
  v_mfma_f32_16x16x32_bf16 v[40:43], a[176:179], a[40:43], v[40:43]
  ds_read_b64_tr_b16 a[164:165], v228 offset:57344
  v_mfma_f32_16x16x32_bf16 v[40:43], a[180:183], a[56:59], v[40:43]
  buffer_load_dwordx4 v239, s[20:23], s31 offen offset:1024 lds
  v_mfma_f32_16x16x32_bf16 v[44:47], a[180:183], a[60:63], v[44:47]
  ds_read_b64_tr_b16 a[166:167], v228 offset:58368
  v_mfma_f32_16x16x32_bf16 v[44:47], a[176:179], a[44:47], v[44:47]
  s_waitcnt lgkmcnt(4)
  v_mfma_f32_16x16x32_bf16 v[48:51], a[184:187], a[32:35], v[48:51]
  ds_read_b64_tr_b16 a[168:169], v229 offset:49152
  v_mfma_f32_16x16x32_bf16 v[48:51], a[188:191], a[48:51], v[48:51]
  buffer_load_dwordx4 a[12:15], v242, s[24:27], s30 offen offset:3072 sc1
  v_mfma_f32_16x16x32_bf16 v[52:55], a[188:191], a[52:55], v[52:55]
  ds_read_b64_tr_b16 a[170:171], v229 offset:50176
  v_mfma_f32_16x16x32_bf16 v[52:55], a[184:187], a[36:39], v[52:55]
  v_mfma_f32_16x16x32_bf16 v[56:59], a[184:187], a[40:43], v[56:59]
  ds_read_b64_tr_b16 a[172:173], v229 offset:57344
  v_mfma_f32_16x16x32_bf16 v[56:59], a[188:191], a[56:59], v[56:59]
  v_mfma_f32_16x16x32_bf16 v[60:63], a[188:191], a[60:63], v[60:63]
  ds_read_b64_tr_b16 a[174:175], v229 offset:58368
  v_mfma_f32_16x16x32_bf16 v[60:63], a[184:187], a[44:47], v[60:63]
  s_waitcnt lgkmcnt(4)
  v_mfma_f32_16x16x32_bf16 v[64:67], a[160:163], a[32:35], v[64:67]
  ds_read_b64_tr_b16 a[176:177], v230 offset:49152
  v_mfma_f32_16x16x32_bf16 v[64:67], a[164:167], a[48:51], v[64:67]
  buffer_load_dwordx4 a[16:19], v243, s[24:27], s30 offen offset:0 sc1
  v_mfma_f32_16x16x32_bf16 v[68:71], a[164:167], a[52:55], v[68:71]
  ds_read_b64_tr_b16 a[178:179], v230 offset:50176
  v_mfma_f32_16x16x32_bf16 v[68:71], a[160:163], a[36:39], v[68:71]
  v_mfma_f32_16x16x32_bf16 v[72:75], a[160:163], a[40:43], v[72:75]
  ds_read_b64_tr_b16 a[180:181], v230 offset:57344
  v_mfma_f32_16x16x32_bf16 v[72:75], a[164:167], a[56:59], v[72:75]
  buffer_load_dwordx4 v240, s[20:23], s31 offen offset:2048 lds
  v_mfma_f32_16x16x32_bf16 v[76:79], a[164:167], a[60:63], v[76:79]
  ds_read_b64_tr_b16 a[182:183], v230 offset:58368
  v_mfma_f32_16x16x32_bf16 v[76:79], a[160:163], a[44:47], v[76:79]
  s_waitcnt lgkmcnt(4)
  v_mfma_f32_16x16x32_bf16 v[80:83], a[168:171], a[32:35], v[80:83]
  ds_read_b64_tr_b16 a[184:185], v231 offset:49152
  v_mfma_f32_16x16x32_bf16 v[80:83], a[172:175], a[48:51], v[80:83]
  buffer_load_dwordx4 a[20:23], v243, s[24:27], s30 offen offset:1024 sc1
  v_mfma_f32_16x16x32_bf16 v[84:87], a[172:175], a[52:55], v[84:87]
  ds_read_b64_tr_b16 a[186:187], v231 offset:50176
  v_mfma_f32_16x16x32_bf16 v[84:87], a[168:171], a[36:39], v[84:87]
  v_mfma_f32_16x16x32_bf16 v[88:91], a[168:171], a[40:43], v[88:91]
  ds_read_b64_tr_b16 a[188:189], v231 offset:57344
  v_mfma_f32_16x16x32_bf16 v[88:91], a[172:175], a[56:59], v[88:91]
  s_barrier
  v_mfma_f32_16x16x32_bf16 v[92:95], a[172:175], a[60:63], v[92:95]
  ds_read_b64_tr_b16 a[190:191], v231 offset:58368
  v_mfma_f32_16x16x32_bf16 v[92:95], a[168:171], a[44:47], v[92:95]
  s_waitcnt lgkmcnt(4)
  v_mfma_f32_16x16x32_bf16 v[96:99], a[176:179], a[32:35], v[96:99]
  ds_read_b64_tr_b16 a[160:161], v144 offset:32768
  v_mfma_f32_16x16x32_bf16 v[96:99], a[180:183], a[48:51], v[96:99]
  buffer_load_dwordx4 a[24:27], v243, s[24:27], s30 offen offset:2048 sc1
  v_mfma_f32_16x16x32_bf16 v[100:103], a[180:183], a[52:55], v[100:103]
  ds_read_b64_tr_b16 a[162:163], v144 offset:33792
  v_mfma_f32_16x16x32_bf16 v[100:103], a[176:179], a[36:39], v[100:103]
  v_mfma_f32_16x16x32_bf16 v[104:107], a[176:179], a[40:43], v[104:107]
  ds_read_b64_tr_b16 a[164:165], v144 offset:40960
  v_mfma_f32_16x16x32_bf16 v[104:107], a[180:183], a[56:59], v[104:107]
  buffer_load_dwordx4 v241, s[20:23], s31 offen offset:3072 lds
  s_add_u32 s31, s31, 0x80000
  v_mfma_f32_16x16x32_bf16 v[108:111], a[180:183], a[60:63], v[108:111]
  ds_read_b64_tr_b16 a[166:167], v144 offset:41984
  v_mfma_f32_16x16x32_bf16 v[108:111], a[176:179], a[44:47], v[108:111]
  s_waitcnt lgkmcnt(4)
  v_mfma_f32_16x16x32_bf16 v[112:115], a[184:187], a[32:35], v[112:115]
  ds_read_b64_tr_b16 a[168:169], v145 offset:32768
  v_mfma_f32_16x16x32_bf16 v[112:115], a[188:191], a[48:51], v[112:115]
  buffer_load_dwordx4 a[28:31], v243, s[24:27], s30 offen offset:3072 sc1
  s_add_u32 s30, s30, 8192
  v_mfma_f32_16x16x32_bf16 v[116:119], a[188:191], a[52:55], v[116:119]
  ds_read_b64_tr_b16 a[170:171], v145 offset:33792
  v_mfma_f32_16x16x32_bf16 v[116:119], a[184:187], a[36:39], v[116:119]
  v_mfma_f32_16x16x32_bf16 v[120:123], a[184:187], a[40:43], v[120:123]
  ds_read_b64_tr_b16 a[172:173], v145 offset:40960
  v_mfma_f32_16x16x32_bf16 v[120:123], a[188:191], a[56:59], v[120:123]
  v_mfma_f32_16x16x32_bf16 v[124:127], a[188:191], a[60:63], v[124:127]
  ds_read_b64_tr_b16 a[174:175], v145 offset:41984
  v_mfma_f32_16x16x32_bf16 v[124:127], a[184:187], a[44:47], v[124:127]
  s_waitcnt vmcnt(20) lgkmcnt(4)
  v_xor_b32 v136, s55, v136
  v_xor_b32 v137, s55, v137
  v_xor_b32 v138, s55, v138
  v_xor_b32 v139, s55, v139
  v_or3_b32 v136, v136, v137, v138
  v_or_b32 v136, v136, v139
  v_cmp_ne_u32 vcc, 0, v136
  s_nop 0
  s_cbranch_vccz front_keys
  s_mov_b32 s54, 32768
front_all:
  s_sleep 2
  buffer_load_dwordx4 v[136:139], v140, s[24:27], s58 offen sc1
  s_waitcnt vmcnt(0)
  v_xor_b32 v136, s55, v136
  v_xor_b32 v137, s55, v137
  v_xor_b32 v138, s55, v138
  v_xor_b32 v139, s55, v139
  v_or3_b32 v136, v136, v137, v138
  v_or_b32 v136, v136, v139
  v_cmp_ne_u32 vcc, 0, v136
  s_nop 0
  s_cbranch_vccz front_keys
  s_sub_u32 s54, s54, 1
  s_cmp_lg_u32 s54, 0
  s_cbranch_scc1 front_all
front_keys:
  s_lshl_b32 s35, s3, 11
  s_add_u32 s35, s35, 2621440
  buffer_load_dwordx4 v[128:131], v242, s[24:27], s35 offen sc1
  buffer_load_dwordx4 v[132:135], v242, s[24:27], s35 offen offset:1024 sc1
  v_mfma_f32_16x16x32_bf16 v[0:3], a[160:163], a[64:67], v[0:3]
  ds_read_b64_tr_b16 a[176:177], v146 offset:32768
  s_add_u32 s59, s59, 1
  s_or_b32 s54, s2, s3
  s_min_u32 s54, s54, 1
  v_mfma_f32_16x16x32_bf16 v[0:3], a[164:167], a[80:83], v[0:3]
  buffer_load_dwordx4 a[32:35], v242, s[24:27], s30 offen offset:0 sc1
  s_lshl_b32 s54, s54, 28
  v_mfma_f32_16x16x32_bf16 v[4:7], a[164:167], a[84:87], v[4:7]
  ds_read_b64_tr_b16 a[178:179], v146 offset:33792
  v_lshlrev_b32 v137, 22, v242
  v_mfma_f32_16x16x32_bf16 v[4:7], a[160:163], a[68:71], v[4:7]
  v_or_b32 v137, s54, v137
  v_mov_b32 v136, s59
  v_mfma_f32_16x16x32_bf16 v[8:11], a[160:163], a[72:75], v[8:11]
  ds_read_b64_tr_b16 a[180:181], v146 offset:40960
  s_add_u32 m0, s28, 0
  s_mov_b32 s58, 2830336
  buffer_store_dword v136, v137, s[24:27], s58 offen sc1
  v_mfma_f32_16x16x32_bf16 v[8:11], a[164:167], a[88:91], v[8:11]
  buffer_load_dwordx4 v238, s[20:23], s31 offen offset:0 lds
  v_mfma_f32_16x16x32_bf16 v[12:15], a[164:167], a[92:95], v[12:15]
  ds_read_b64_tr_b16 a[182:183], v146 offset:41984
  v_mfma_f32_16x16x32_bf16 v[12:15], a[160:163], a[76:79], v[12:15]
  s_waitcnt lgkmcnt(4)
  v_mfma_f32_16x16x32_bf16 v[16:19], a[168:171], a[64:67], v[16:19]
  ds_read_b64_tr_b16 a[184:185], v147 offset:32768
  v_mfma_f32_16x16x32_bf16 v[16:19], a[172:175], a[80:83], v[16:19]
  buffer_load_dwordx4 a[36:39], v242, s[24:27], s30 offen offset:1024 sc1
  v_mfma_f32_16x16x32_bf16 v[20:23], a[172:175], a[84:87], v[20:23]
  ds_read_b64_tr_b16 a[186:187], v147 offset:33792
  v_mfma_f32_16x16x32_bf16 v[20:23], a[168:171], a[68:71], v[20:23]
  v_mfma_f32_16x16x32_bf16 v[24:27], a[168:171], a[72:75], v[24:27]
  ds_read_b64_tr_b16 a[188:189], v147 offset:40960
  v_mfma_f32_16x16x32_bf16 v[24:27], a[172:175], a[88:91], v[24:27]
  v_mfma_f32_16x16x32_bf16 v[28:31], a[172:175], a[92:95], v[28:31]
  ds_read_b64_tr_b16 a[190:191], v147 offset:41984
  v_mfma_f32_16x16x32_bf16 v[28:31], a[168:171], a[76:79], v[28:31]
  s_waitcnt lgkmcnt(4)
  v_mfma_f32_16x16x32_bf16 v[32:35], a[176:179], a[64:67], v[32:35]
  ds_read_b64_tr_b16 a[160:161], v148 offset:32768
  v_mfma_f32_16x16x32_bf16 v[32:35], a[180:183], a[80:83], v[32:35]
  buffer_load_dwordx4 a[40:43], v242, s[24:27], s30 offen offset:2048 sc1
  v_mfma_f32_16x16x32_bf16 v[36:39], a[180:183], a[84:87], v[36:39]
  ds_read_b64_tr_b16 a[162:163], v148 offset:33792
  v_mfma_f32_16x16x32_bf16 v[36:39], a[176:179], a[68:71], v[36:39]
  v_mfma_f32_16x16x32_bf16 v[40:43], a[176:179], a[72:75], v[40:43]
  ds_read_b64_tr_b16 a[164:165], v148 offset:40960
  v_mfma_f32_16x16x32_bf16 v[40:43], a[180:183], a[88:91], v[40:43]
  buffer_load_dwordx4 v239, s[20:23], s31 offen offset:1024 lds
  v_mfma_f32_16x16x32_bf16 v[44:47], a[180:183], a[92:95], v[44:47]
  ds_read_b64_tr_b16 a[166:167], v148 offset:41984
  v_mfma_f32_16x16x32_bf16 v[44:47], a[176:179], a[76:79], v[44:47]
  s_waitcnt lgkmcnt(4)
  v_mfma_f32_16x16x32_bf16 v[48:51], a[184:187], a[64:67], v[48:51]
  ds_read_b64_tr_b16 a[168:169], v149 offset:32768
  v_mfma_f32_16x16x32_bf16 v[48:51], a[188:191], a[80:83], v[48:51]
  buffer_load_dwordx4 a[44:47], v242, s[24:27], s30 offen offset:3072 sc1
  v_mfma_f32_16x16x32_bf16 v[52:55], a[188:191], a[84:87], v[52:55]
  ds_read_b64_tr_b16 a[170:171], v149 offset:33792
  v_mfma_f32_16x16x32_bf16 v[52:55], a[184:187], a[68:71], v[52:55]
  v_mfma_f32_16x16x32_bf16 v[56:59], a[184:187], a[72:75], v[56:59]
  ds_read_b64_tr_b16 a[172:173], v149 offset:40960
  v_mfma_f32_16x16x32_bf16 v[56:59], a[188:191], a[88:91], v[56:59]
  v_mfma_f32_16x16x32_bf16 v[60:63], a[188:191], a[92:95], v[60:63]
  ds_read_b64_tr_b16 a[174:175], v149 offset:41984
  v_mfma_f32_16x16x32_bf16 v[60:63], a[184:187], a[76:79], v[60:63]
  s_waitcnt lgkmcnt(4)
  v_mfma_f32_16x16x32_bf16 v[64:67], a[160:163], a[64:67], v[64:67]
  ds_read_b64_tr_b16 a[176:177], v150 offset:32768
  v_mfma_f32_16x16x32_bf16 v[64:67], a[164:167], a[80:83], v[64:67]
  buffer_load_dwordx4 a[48:51], v243, s[24:27], s30 offen offset:0 sc1
  v_mfma_f32_16x16x32_bf16 v[68:71], a[164:167], a[84:87], v[68:71]
  ds_read_b64_tr_b16 a[178:179], v150 offset:33792
  v_mfma_f32_16x16x32_bf16 v[68:71], a[160:163], a[68:71], v[68:71]
  v_mfma_f32_16x16x32_bf16 v[72:75], a[160:163], a[72:75], v[72:75]
  ds_read_b64_tr_b16 a[180:181], v150 offset:40960
  v_mfma_f32_16x16x32_bf16 v[72:75], a[164:167], a[88:91], v[72:75]
  buffer_load_dwordx4 v240, s[20:23], s31 offen offset:2048 lds
  v_mfma_f32_16x16x32_bf16 v[76:79], a[164:167], a[92:95], v[76:79]
  ds_read_b64_tr_b16 a[182:183], v150 offset:41984
  v_mfma_f32_16x16x32_bf16 v[76:79], a[160:163], a[76:79], v[76:79]
  s_waitcnt lgkmcnt(4)
  v_mfma_f32_16x16x32_bf16 v[80:83], a[168:171], a[64:67], v[80:83]
  ds_read_b64_tr_b16 a[184:185], v151 offset:32768
  v_mfma_f32_16x16x32_bf16 v[80:83], a[172:175], a[80:83], v[80:83]
  buffer_load_dwordx4 a[52:55], v243, s[24:27], s30 offen offset:1024 sc1
  v_mfma_f32_16x16x32_bf16 v[84:87], a[172:175], a[84:87], v[84:87]
  ds_read_b64_tr_b16 a[186:187], v151 offset:33792
  v_mfma_f32_16x16x32_bf16 v[84:87], a[168:171], a[68:71], v[84:87]
  v_mfma_f32_16x16x32_bf16 v[88:91], a[168:171], a[72:75], v[88:91]
  ds_read_b64_tr_b16 a[188:189], v151 offset:40960
  v_mfma_f32_16x16x32_bf16 v[88:91], a[172:175], a[88:91], v[88:91]
  s_barrier
  v_mfma_f32_16x16x32_bf16 v[92:95], a[172:175], a[92:95], v[92:95]
  ds_read_b64_tr_b16 a[190:191], v151 offset:41984
  v_mfma_f32_16x16x32_bf16 v[92:95], a[168:171], a[76:79], v[92:95]
  s_waitcnt lgkmcnt(4)
  v_mfma_f32_16x16x32_bf16 v[96:99], a[176:179], a[64:67], v[96:99]
  ds_read_b64_tr_b16 a[160:161], v144 offset:49152
  v_mfma_f32_16x16x32_bf16 v[96:99], a[180:183], a[80:83], v[96:99]
  buffer_load_dwordx4 a[56:59], v243, s[24:27], s30 offen offset:2048 sc1
  v_mfma_f32_16x16x32_bf16 v[100:103], a[180:183], a[84:87], v[100:103]
  ds_read_b64_tr_b16 a[162:163], v144 offset:50176
  v_mfma_f32_16x16x32_bf16 v[100:103], a[176:179], a[68:71], v[100:103]
  v_mfma_f32_16x16x32_bf16 v[104:107], a[176:179], a[72:75], v[104:107]
  ds_read_b64_tr_b16 a[164:165], v144 offset:57344
  v_mfma_f32_16x16x32_bf16 v[104:107], a[180:183], a[88:91], v[104:107]
  buffer_load_dwordx4 v241, s[20:23], s31 offen offset:3072 lds
  s_add_u32 s31, s31, 0x80000
  v_mfma_f32_16x16x32_bf16 v[108:111], a[180:183], a[92:95], v[108:111]
  ds_read_b64_tr_b16 a[166:167], v144 offset:58368
  v_mfma_f32_16x16x32_bf16 v[108:111], a[176:179], a[76:79], v[108:111]
  s_waitcnt lgkmcnt(4)
  v_mfma_f32_16x16x32_bf16 v[112:115], a[184:187], a[64:67], v[112:115]
  ds_read_b64_tr_b16 a[168:169], v145 offset:49152
  v_mfma_f32_16x16x32_bf16 v[112:115], a[188:191], a[80:83], v[112:115]
  buffer_load_dwordx4 a[60:63], v243, s[24:27], s30 offen offset:3072 sc1
  s_add_u32 s30, s30, 8192
  v_mfma_f32_16x16x32_bf16 v[116:119], a[188:191], a[84:87], v[116:119]
  ds_read_b64_tr_b16 a[170:171], v145 offset:50176
  v_mfma_f32_16x16x32_bf16 v[116:119], a[184:187], a[68:71], v[116:119]
  v_mfma_f32_16x16x32_bf16 v[120:123], a[184:187], a[72:75], v[120:123]
  ds_read_b64_tr_b16 a[172:173], v145 offset:57344
  v_mfma_f32_16x16x32_bf16 v[120:123], a[188:191], a[88:91], v[120:123]
  v_mfma_f32_16x16x32_bf16 v[124:127], a[188:191], a[92:95], v[124:127]
  ds_read_b64_tr_b16 a[174:175], v145 offset:58368
  v_mfma_f32_16x16x32_bf16 v[124:127], a[184:187], a[76:79], v[124:127]
  s_waitcnt vmcnt(27) lgkmcnt(4)
  v_mfma_f32_16x16x32_bf16 v[0:3], a[160:163], a[96:99], v[0:3]
  ds_read_b64_tr_b16 a[176:177], v146 offset:49152
  v_mfma_f32_16x16x32_bf16 v[0:3], a[164:167], a[112:115], v[0:3]
  buffer_load_dwordx4 a[64:67], v242, s[24:27], s30 offen offset:0 sc1
  v_mfma_f32_16x16x32_bf16 v[4:7], a[164:167], a[116:119], v[4:7]
  ds_read_b64_tr_b16 a[178:179], v146 offset:50176
  v_mfma_f32_16x16x32_bf16 v[4:7], a[160:163], a[100:103], v[4:7]
  v_mfma_f32_16x16x32_bf16 v[8:11], a[160:163], a[104:107], v[8:11]
  ds_read_b64_tr_b16 a[180:181], v146 offset:57344
  s_add_u32 m0, s28, 65536
  v_mfma_f32_16x16x32_bf16 v[8:11], a[164:167], a[120:123], v[8:11]
  buffer_load_dwordx4 v238, s[20:23], s31 offen offset:0 lds
  v_mfma_f32_16x16x32_bf16 v[12:15], a[164:167], a[124:127], v[12:15]
  ds_read_b64_tr_b16 a[182:183], v146 offset:58368
  v_mfma_f32_16x16x32_bf16 v[12:15], a[160:163], a[108:111], v[12:15]
  s_waitcnt lgkmcnt(4)
  v_mfma_f32_16x16x32_bf16 v[16:19], a[168:171], a[96:99], v[16:19]
  ds_read_b64_tr_b16 a[184:185], v147 offset:49152
  v_mfma_f32_16x16x32_bf16 v[16:19], a[172:175], a[112:115], v[16:19]
  buffer_load_dwordx4 a[68:71], v242, s[24:27], s30 offen offset:1024 sc1
  v_mfma_f32_16x16x32_bf16 v[20:23], a[172:175], a[116:119], v[20:23]
  ds_read_b64_tr_b16 a[186:187], v147 offset:50176
  v_mfma_f32_16x16x32_bf16 v[20:23], a[168:171], a[100:103], v[20:23]
  v_mfma_f32_16x16x32_bf16 v[24:27], a[168:171], a[104:107], v[24:27]
  ds_read_b64_tr_b16 a[188:189], v147 offset:57344
  v_mfma_f32_16x16x32_bf16 v[24:27], a[172:175], a[120:123], v[24:27]
  v_mfma_f32_16x16x32_bf16 v[28:31], a[172:175], a[124:127], v[28:31]
  ds_read_b64_tr_b16 a[190:191], v147 offset:58368
  v_mfma_f32_16x16x32_bf16 v[28:31], a[168:171], a[108:111], v[28:31]
  s_waitcnt lgkmcnt(4)
  v_mfma_f32_16x16x32_bf16 v[32:35], a[176:179], a[96:99], v[32:35]
  ds_read_b64_tr_b16 a[160:161], v148 offset:49152
  v_mfma_f32_16x16x32_bf16 v[32:35], a[180:183], a[112:115], v[32:35]
  buffer_load_dwordx4 a[72:75], v242, s[24:27], s30 offen offset:2048 sc1
  v_mfma_f32_16x16x32_bf16 v[36:39], a[180:183], a[116:119], v[36:39]
  ds_read_b64_tr_b16 a[162:163], v148 offset:50176
  v_mfma_f32_16x16x32_bf16 v[36:39], a[176:179], a[100:103], v[36:39]
  v_mfma_f32_16x16x32_bf16 v[40:43], a[176:179], a[104:107], v[40:43]
  ds_read_b64_tr_b16 a[164:165], v148 offset:57344
  v_mfma_f32_16x16x32_bf16 v[40:43], a[180:183], a[120:123], v[40:43]
  buffer_load_dwordx4 v239, s[20:23], s31 offen offset:1024 lds
  v_mfma_f32_16x16x32_bf16 v[44:47], a[180:183], a[124:127], v[44:47]
  ds_read_b64_tr_b16 a[166:167], v148 offset:58368
  v_mfma_f32_16x16x32_bf16 v[44:47], a[176:179], a[108:111], v[44:47]
  s_waitcnt lgkmcnt(4)
  v_mfma_f32_16x16x32_bf16 v[48:51], a[184:187], a[96:99], v[48:51]
  ds_read_b64_tr_b16 a[168:169], v149 offset:49152
  v_mfma_f32_16x16x32_bf16 v[48:51], a[188:191], a[112:115], v[48:51]
  buffer_load_dwordx4 a[76:79], v242, s[24:27], s30 offen offset:3072 sc1
  v_mfma_f32_16x16x32_bf16 v[52:55], a[188:191], a[116:119], v[52:55]
  ds_read_b64_tr_b16 a[170:171], v149 offset:50176
  v_mfma_f32_16x16x32_bf16 v[52:55], a[184:187], a[100:103], v[52:55]
  v_mfma_f32_16x16x32_bf16 v[56:59], a[184:187], a[104:107], v[56:59]
  ds_read_b64_tr_b16 a[172:173], v149 offset:57344
  v_mfma_f32_16x16x32_bf16 v[56:59], a[188:191], a[120:123], v[56:59]
  v_mfma_f32_16x16x32_bf16 v[60:63], a[188:191], a[124:127], v[60:63]
  ds_read_b64_tr_b16 a[174:175], v149 offset:58368
  v_mfma_f32_16x16x32_bf16 v[60:63], a[184:187], a[108:111], v[60:63]
  s_waitcnt lgkmcnt(4)
  v_mfma_f32_16x16x32_bf16 v[64:67], a[160:163], a[96:99], v[64:67]
  ds_read_b64_tr_b16 a[176:177], v150 offset:49152
  v_mfma_f32_16x16x32_bf16 v[64:67], a[164:167], a[112:115], v[64:67]
  buffer_load_dwordx4 a[80:83], v243, s[24:27], s30 offen offset:0 sc1
  v_mfma_f32_16x16x32_bf16 v[68:71], a[164:167], a[116:119], v[68:71]
  ds_read_b64_tr_b16 a[178:179], v150 offset:50176
  v_mfma_f32_16x16x32_bf16 v[68:71], a[160:163], a[100:103], v[68:71]
  v_mfma_f32_16x16x32_bf16 v[72:75], a[160:163], a[104:107], v[72:75]
  ds_read_b64_tr_b16 a[180:181], v150 offset:57344
  v_mfma_f32_16x16x32_bf16 v[72:75], a[164:167], a[120:123], v[72:75]
  buffer_load_dwordx4 v240, s[20:23], s31 offen offset:2048 lds
  v_mfma_f32_16x16x32_bf16 v[76:79], a[164:167], a[124:127], v[76:79]
  ds_read_b64_tr_b16 a[182:183], v150 offset:58368
  v_mfma_f32_16x16x32_bf16 v[76:79], a[160:163], a[108:111], v[76:79]
  s_waitcnt lgkmcnt(4)
  v_mfma_f32_16x16x32_bf16 v[80:83], a[168:171], a[96:99], v[80:83]
  ds_read_b64_tr_b16 a[184:185], v151 offset:49152
  v_mfma_f32_16x16x32_bf16 v[80:83], a[172:175], a[112:115], v[80:83]
  buffer_load_dwordx4 a[84:87], v243, s[24:27], s30 offen offset:1024 sc1
  v_mfma_f32_16x16x32_bf16 v[84:87], a[172:175], a[116:119], v[84:87]
  ds_read_b64_tr_b16 a[186:187], v151 offset:50176
  v_mfma_f32_16x16x32_bf16 v[84:87], a[168:171], a[100:103], v[84:87]
  s_waitcnt vmcnt(25)
  v_mfma_f32_16x16x32_bf16 v[88:91], a[168:171], a[104:107], v[88:91]
  ds_read_b64_tr_b16 a[188:189], v151 offset:57344
  v_mfma_f32_16x16x32_bf16 v[88:91], a[172:175], a[120:123], v[88:91]
  s_barrier
  v_mfma_f32_16x16x32_bf16 v[92:95], a[172:175], a[124:127], v[92:95]
  ds_read_b64_tr_b16 a[190:191], v151 offset:58368
  v_mfma_f32_16x16x32_bf16 v[92:95], a[168:171], a[108:111], v[92:95]
  s_waitcnt lgkmcnt(4)
  v_mfma_f32_16x16x32_bf16 v[96:99], a[176:179], a[96:99], v[96:99]
  ds_read_b64_tr_b16 a[160:161], v144 offset:16384
  v_mfma_f32_16x16x32_bf16 v[96:99], a[180:183], a[112:115], v[96:99]
  buffer_load_dwordx4 a[88:91], v243, s[24:27], s30 offen offset:2048 sc1
  v_mfma_f32_16x16x32_bf16 v[100:103], a[180:183], a[116:119], v[100:103]
  ds_read_b64_tr_b16 a[162:163], v144 offset:17408
  v_mfma_f32_16x16x32_bf16 v[100:103], a[176:179], a[100:103], v[100:103]
  v_mfma_f32_16x16x32_bf16 v[104:107], a[176:179], a[104:107], v[104:107]
  ds_read_b64_tr_b16 a[164:165], v144 offset:24576
  v_mfma_f32_16x16x32_bf16 v[104:107], a[180:183], a[120:123], v[104:107]
  buffer_load_dwordx4 v241, s[20:23], s31 offen offset:3072 lds
  s_add_u32 s31, s31, 0x80000
  v_mfma_f32_16x16x32_bf16 v[108:111], a[180:183], a[124:127], v[108:111]
  ds_read_b64_tr_b16 a[166:167], v144 offset:25600
  v_mfma_f32_16x16x32_bf16 v[108:111], a[176:179], a[108:111], v[108:111]
  s_waitcnt lgkmcnt(4)
  v_mfma_f32_16x16x32_bf16 v[112:115], a[184:187], a[96:99], v[112:115]
  ds_read_b64_tr_b16 a[168:169], v145 offset:16384
  v_mfma_f32_16x16x32_bf16 v[112:115], a[188:191], a[112:115], v[112:115]
  buffer_load_dwordx4 a[92:95], v243, s[24:27], s30 offen offset:3072 sc1
  s_add_u32 s30, s30, 8192
  v_mfma_f32_16x16x32_bf16 v[116:119], a[188:191], a[116:119], v[116:119]
  ds_read_b64_tr_b16 a[170:171], v145 offset:17408
  v_mfma_f32_16x16x32_bf16 v[116:119], a[184:187], a[100:103], v[116:119]
  v_mfma_f32_16x16x32_bf16 v[120:123], a[184:187], a[104:107], v[120:123]
  ds_read_b64_tr_b16 a[172:173], v145 offset:24576
  v_mfma_f32_16x16x32_bf16 v[120:123], a[188:191], a[120:123], v[120:123]
  v_mfma_f32_16x16x32_bf16 v[124:127], a[188:191], a[124:127], v[124:127]
  ds_read_b64_tr_b16 a[174:175], v145 offset:25600
  v_mfma_f32_16x16x32_bf16 v[124:127], a[184:187], a[108:111], v[124:127]
  s_waitcnt vmcnt(27) lgkmcnt(4)
  v_mfma_f32_16x16x32_bf16 v[0:3], a[160:163], a[0:3], v[0:3]
  ds_read_b64_tr_b16 a[176:177], v146 offset:16384
  s_waitcnt vmcnt(25)
  s_mov_b32 s51, -1
  v_sub_u32 v137, s51, v128
  v_mfma_f32_16x16x32_bf16 v[0:3], a[164:167], a[16:19], v[0:3]
  buffer_load_dwordx4 a[96:99], v242, s[24:27], s30 offen offset:0 sc1
  v_mfma_f32_16x16x32_bf16 v[4:7], a[164:167], a[20:23], v[4:7]
  ds_read_b64_tr_b16 a[178:179], v146 offset:17408
  v_sub_u32 v138, s51, v129
  v_mfma_f32_16x16x32_bf16 v[4:7], a[160:163], a[4:7], v[4:7]
  v_min_u32 v136, v137, v138
  v_sub_u32 v139, s51, v130
  v_mfma_f32_16x16x32_bf16 v[8:11], a[160:163], a[8:11], v[8:11]
  ds_read_b64_tr_b16 a[180:181], v146 offset:24576
  s_add_u32 m0, s28, 81920
  v_sub_u32 v140, s51, v131
  v_mfma_f32_16x16x32_bf16 v[8:11], a[164:167], a[24:27], v[8:11]
  buffer_load_dwordx4 v238, s[20:23], s31 offen offset:0 lds
  v_mfma_f32_16x16x32_bf16 v[12:15], a[164:167], a[28:31], v[12:15]
  ds_read_b64_tr_b16 a[182:183], v146 offset:25600
  v_min3_u32 v136, v136, v139, v140
  v_mfma_f32_16x16x32_bf16 v[12:15], a[160:163], a[12:15], v[12:15]
  s_waitcnt lgkmcnt(4)
  v_sub_u32 v137, s51, v132
  v_sub_u32 v138, s51, v133
  v_mfma_f32_16x16x32_bf16 v[16:19], a[168:171], a[0:3], v[16:19]
  ds_read_b64_tr_b16 a[184:185], v147 offset:16384
  v_min3_u32 v136, v136, v137, v138
  v_mfma_f32_16x16x32_bf16 v[16:19], a[172:175], a[16:19], v[16:19]
  buffer_load_dwordx4 a[100:103], v242, s[24:27], s30 offen offset:1024 sc1
  v_mfma_f32_16x16x32_bf16 v[20:23], a[172:175], a[20:23], v[20:23]
  ds_read_b64_tr_b16 a[186:187], v147 offset:17408
  v_sub_u32 v139, s51, v134
  v_mfma_f32_16x16x32_bf16 v[20:23], a[168:171], a[4:7], v[20:23]
  v_sub_u32 v140, s51, v135
  v_min3_u32 v136, v136, v139, v140
  v_mfma_f32_16x16x32_bf16 v[24:27], a[168:171], a[8:11], v[24:27]
  ds_read_b64_tr_b16 a[188:189], v147 offset:24576
  v_min_u32_dpp v136, v136, v136 row_ror:8 row_mask:0xf bank_mask:0xf
  v_mfma_f32_16x16x32_bf16 v[24:27], a[172:175], a[24:27], v[24:27]
  v_mfma_f32_16x16x32_bf16 v[28:31], a[172:175], a[28:31], v[28:31]
  ds_read_b64_tr_b16 a[190:191], v147 offset:25600
  v_min_u32_dpp v136, v136, v136 row_ror:4 row_mask:0xf bank_mask:0xf
  v_mfma_f32_16x16x32_bf16 v[28:31], a[168:171], a[12:15], v[28:31]
  s_waitcnt lgkmcnt(4)
  v_min_u32_dpp v136, v136, v136 row_ror:2 row_mask:0xf bank_mask:0xf
  v_mfma_f32_16x16x32_bf16 v[32:35], a[176:179], a[0:3], v[32:35]
  ds_read_b64_tr_b16 a[160:161], v148 offset:16384
  v_min_u32_dpp v136, v136, v136 row_ror:1 row_mask:0xf bank_mask:0xf
  v_mfma_f32_16x16x32_bf16 v[32:35], a[180:183], a[16:19], v[32:35]
  buffer_load_dwordx4 a[104:107], v242, s[24:27], s30 offen offset:2048 sc1
  v_mfma_f32_16x16x32_bf16 v[36:39], a[180:183], a[20:23], v[36:39]
  ds_read_b64_tr_b16 a[162:163], v148 offset:17408
  v_readlane_b32 s98, v136, 0
  v_mfma_f32_16x16x32_bf16 v[36:39], a[176:179], a[4:7], v[36:39]
  v_readlane_b32 s99, v136, 16
  v_readlane_b32 s100, v136, 32
  v_mfma_f32_16x16x32_bf16 v[40:43], a[176:179], a[8:11], v[40:43]
  ds_read_b64_tr_b16 a[164:165], v148 offset:24576
  v_readlane_b32 s101, v136, 48
  v_mfma_f32_16x16x32_bf16 v[40:43], a[180:183], a[24:27], v[40:43]
  buffer_load_dwordx4 v239, s[20:23], s31 offen offset:1024 lds
  s_min_u32 s98, s98, s99
  s_min_u32 s100, s100, s101
  s_min_u32 s98, s98, s100
  v_mfma_f32_16x16x32_bf16 v[44:47], a[180:183], a[28:31], v[44:47]
  ds_read_b64_tr_b16 a[166:167], v148 offset:25600
  s_sub_u32 s52, s51, s98
  s_sub_u32 s51, s52, 1
  v_sub_u32 v137, s51, v128
  v_mfma_f32_16x16x32_bf16 v[44:47], a[176:179], a[12:15], v[44:47]
  s_waitcnt lgkmcnt(4)
  v_sub_u32 v138, s51, v129
  v_min_u32 v136, v137, v138
  v_mfma_f32_16x16x32_bf16 v[48:51], a[184:187], a[0:3], v[48:51]
  ds_read_b64_tr_b16 a[168:169], v149 offset:16384
  v_sub_u32 v139, s51, v130
  v_mfma_f32_16x16x32_bf16 v[48:51], a[188:191], a[16:19], v[48:51]
  buffer_load_dwordx4 a[108:111], v242, s[24:27], s30 offen offset:3072 sc1
  v_mfma_f32_16x16x32_bf16 v[52:55], a[188:191], a[20:23], v[52:55]
  ds_read_b64_tr_b16 a[170:171], v149 offset:17408
  v_sub_u32 v140, s51, v131
  v_mfma_f32_16x16x32_bf16 v[52:55], a[184:187], a[4:7], v[52:55]
  v_min3_u32 v136, v136, v139, v140
  v_sub_u32 v137, s51, v132
  v_mfma_f32_16x16x32_bf16 v[56:59], a[184:187], a[8:11], v[56:59]
  ds_read_b64_tr_b16 a[172:173], v149 offset:24576
  v_sub_u32 v138, s51, v133
  v_mfma_f32_16x16x32_bf16 v[56:59], a[188:191], a[24:27], v[56:59]
  v_min3_u32 v136, v136, v137, v138
  v_sub_u32 v139, s51, v134
  v_mfma_f32_16x16x32_bf16 v[60:63], a[188:191], a[28:31], v[60:63]
  ds_read_b64_tr_b16 a[174:175], v149 offset:25600
  v_sub_u32 v140, s51, v135
  v_mfma_f32_16x16x32_bf16 v[60:63], a[184:187], a[12:15], v[60:63]
  s_waitcnt lgkmcnt(4)
  v_min3_u32 v136, v136, v139, v140
  v_mfma_f32_16x16x32_bf16 v[64:67], a[160:163], a[0:3], v[64:67]
  ds_read_b64_tr_b16 a[176:177], v150 offset:16384
  v_min_u32_dpp v136, v136, v136 row_ror:8 row_mask:0xf bank_mask:0xf
  v_mfma_f32_16x16x32_bf16 v[64:67], a[164:167], a[16:19], v[64:67]
  buffer_load_dwordx4 a[112:115], v243, s[24:27], s30 offen offset:0 sc1
  v_mfma_f32_16x16x32_bf16 v[68:71], a[164:167], a[20:23], v[68:71]
  ds_read_b64_tr_b16 a[178:179], v150 offset:17408
  v_min_u32_dpp v136, v136, v136 row_ror:4 row_mask:0xf bank_mask:0xf
  v_mfma_f32_16x16x32_bf16 v[68:71], a[160:163], a[4:7], v[68:71]
  v_mfma_f32_16x16x32_bf16 v[72:75], a[160:163], a[8:11], v[72:75]
  ds_read_b64_tr_b16 a[180:181], v150 offset:24576
  v_min_u32_dpp v136, v136, v136 row_ror:2 row_mask:0xf bank_mask:0xf
  v_mfma_f32_16x16x32_bf16 v[72:75], a[164:167], a[24:27], v[72:75]
  buffer_load_dwordx4 v240, s[20:23], s31 offen offset:2048 lds
  v_mfma_f32_16x16x32_bf16 v[76:79], a[164:167], a[28:31], v[76:79]
  ds_read_b64_tr_b16 a[182:183], v150 offset:25600
  v_min_u32_dpp v136, v136, v136 row_ror:1 row_mask:0xf bank_mask:0xf
  v_mfma_f32_16x16x32_bf16 v[76:79], a[160:163], a[12:15], v[76:79]
  s_waitcnt lgkmcnt(4)
  v_readlane_b32 s98, v136, 0
  v_readlane_b32 s99, v136, 16
  v_mfma_f32_16x16x32_bf16 v[80:83], a[168:171], a[0:3], v[80:83]
  ds_read_b64_tr_b16 a[184:185], v151 offset:16384
  v_readlane_b32 s100, v136, 32
  v_mfma_f32_16x16x32_bf16 v[80:83], a[172:175], a[16:19], v[80:83]
  buffer_load_dwordx4 a[116:119], v243, s[24:27], s30 offen offset:1024 sc1
  v_mfma_f32_16x16x32_bf16 v[84:87], a[172:175], a[20:23], v[84:87]
  ds_read_b64_tr_b16 a[186:187], v151 offset:17408
  v_readlane_b32 s101, v136, 48
  v_mfma_f32_16x16x32_bf16 v[84:87], a[168:171], a[4:7], v[84:87]
  s_waitcnt vmcnt(22)
  s_min_u32 s98, s98, s99
  s_min_u32 s100, s100, s101
  v_mfma_f32_16x16x32_bf16 v[88:91], a[168:171], a[8:11], v[88:91]
  ds_read_b64_tr_b16 a[188:189], v151 offset:24576
  s_min_u32 s98, s98, s100
  s_sub_u32 s53, s51, s98
  s_sub_u32 s51, s53, 1
  v_sub_u32 v137, s51, v128
  v_mfma_f32_16x16x32_bf16 v[88:91], a[172:175], a[24:27], v[88:91]
  s_barrier
  v_sub_u32 v138, s51, v129
  v_min_u32 v136, v137, v138
  v_mfma_f32_16x16x32_bf16 v[92:95], a[172:175], a[28:31], v[92:95]
  ds_read_b64_tr_b16 a[190:191], v151 offset:25600
  v_sub_u32 v139, s51, v130
  v_mfma_f32_16x16x32_bf16 v[92:95], a[168:171], a[12:15], v[92:95]
  s_waitcnt lgkmcnt(4)
  v_sub_u32 v140, s51, v131
  v_min3_u32 v136, v136, v139, v140
  v_mfma_f32_16x16x32_bf16 v[96:99], a[176:179], a[0:3], v[96:99]
  ds_read_b64_tr_b16 a[160:161], v144 offset:0
  v_sub_u32 v137, s51, v132
  v_mfma_f32_16x16x32_bf16 v[96:99], a[180:183], a[16:19], v[96:99]
  buffer_load_dwordx4 a[120:123], v243, s[24:27], s30 offen offset:2048 sc1
  v_mfma_f32_16x16x32_bf16 v[100:103], a[180:183], a[20:23], v[100:103]
  ds_read_b64_tr_b16 a[162:163], v144 offset:1024
  v_sub_u32 v138, s51, v133
  v_mfma_f32_16x16x32_bf16 v[100:103], a[176:179], a[4:7], v[100:103]
  v_min3_u32 v136, v136, v137, v138
  v_sub_u32 v139, s51, v134
  v_mfma_f32_16x16x32_bf16 v[104:107], a[176:179], a[8:11], v[104:107]
  ds_read_b64_tr_b16 a[164:165], v144 offset:8192
  v_sub_u32 v140, s51, v135
  v_mfma_f32_16x16x32_bf16 v[104:107], a[180:183], a[24:27], v[104:107]
  buffer_load_dwordx4 v241, s[20:23], s31 offen offset:3072 lds
  s_add_u32 s31, s31, 0x80000
  v_mfma_f32_16x16x32_bf16 v[108:111], a[180:183], a[28:31], v[108:111]
  ds_read_b64_tr_b16 a[166:167], v144 offset:9216
  v_min3_u32 v136, v136, v139, v140
  v_mfma_f32_16x16x32_bf16 v[108:111], a[176:179], a[12:15], v[108:111]
  s_waitcnt lgkmcnt(4)
  v_min_u32_dpp v136, v136, v136 row_ror:8 row_mask:0xf bank_mask:0xf
  v_mfma_f32_16x16x32_bf16 v[112:115], a[184:187], a[0:3], v[112:115]
  ds_read_b64_tr_b16 a[168:169], v145 offset:0
  v_min_u32_dpp v136, v136, v136 row_ror:4 row_mask:0xf bank_mask:0xf
  v_mfma_f32_16x16x32_bf16 v[112:115], a[188:191], a[16:19], v[112:115]
  buffer_load_dwordx4 a[124:127], v243, s[24:27], s30 offen offset:3072 sc1
  s_add_u32 s30, s30, 8192
  v_mfma_f32_16x16x32_bf16 v[116:119], a[188:191], a[20:23], v[116:119]
  ds_read_b64_tr_b16 a[170:171], v145 offset:1024
  v_min_u32_dpp v136, v136, v136 row_ror:2 row_mask:0xf bank_mask:0xf
  v_mfma_f32_16x16x32_bf16 v[116:119], a[184:187], a[4:7], v[116:119]
  v_mfma_f32_16x16x32_bf16 v[120:123], a[184:187], a[8:11], v[120:123]
  ds_read_b64_tr_b16 a[172:173], v145 offset:8192
  v_min_u32_dpp v136, v136, v136 row_ror:1 row_mask:0xf bank_mask:0xf
  v_mfma_f32_16x16x32_bf16 v[120:123], a[188:191], a[24:27], v[120:123]
  v_readlane_b32 s98, v136, 0
  v_readlane_b32 s99, v136, 16
  v_mfma_f32_16x16x32_bf16 v[124:127], a[188:191], a[28:31], v[124:127]
  ds_read_b64_tr_b16 a[174:175], v145 offset:9216
  v_readlane_b32 s100, v136, 32
  v_mfma_f32_16x16x32_bf16 v[124:127], a[184:187], a[12:15], v[124:127]
  s_waitcnt vmcnt(24) lgkmcnt(4)
  v_readlane_b32 s101, v136, 48
  v_mfma_f32_16x16x32_bf16 v[0:3], a[160:163], a[32:35], v[0:3]
  ds_read_b64_tr_b16 a[176:177], v146 offset:0
  s_min_u32 s98, s98, s99
  s_min_u32 s100, s100, s101
  s_min_u32 s98, s98, s100
  v_mfma_f32_16x16x32_bf16 v[0:3], a[164:167], a[48:51], v[0:3]
  buffer_load_dwordx4 a[0:3], v242, s[24:27], s30 offen offset:0 sc1
  s_sub_u32 s54, s51, s98
  s_sub_u32 s51, s54, 1
  v_mfma_f32_16x16x32_bf16 v[4:7], a[164:167], a[52:55], v[4:7]
  ds_read_b64_tr_b16 a[178:179], v146 offset:1024
  v_sub_u32 v137, s51, v128
  v_mfma_f32_16x16x32_bf16 v[4:7], a[160:163], a[36:39], v[4:7]
  v_sub_u32 v138, s51, v129
  v_min_u32 v136, v137, v138
  v_mfma_f32_16x16x32_bf16 v[8:11], a[160:163], a[40:43], v[8:11]
  ds_read_b64_tr_b16 a[180:181], v146 offset:8192
  s_add_u32 m0, s28, 98304
  v_sub_u32 v139, s51, v130
  v_mfma_f32_16x16x32_bf16 v[8:11], a[164:167], a[56:59], v[8:11]
  buffer_load_dwordx4 v238, s[20:23], s31 offen offset:0 lds
  v_mfma_f32_16x16x32_bf16 v[12:15], a[164:167], a[60:63], v[12:15]
  ds_read_b64_tr_b16 a[182:183], v146 offset:9216
  v_sub_u32 v140, s51, v131
  v_mfma_f32_16x16x32_bf16 v[12:15], a[160:163], a[44:47], v[12:15]
  s_waitcnt lgkmcnt(4)
  v_min3_u32 v136, v136, v139, v140
  v_sub_u32 v137, s51, v132
  v_mfma_f32_16x16x32_bf16 v[16:19], a[168:171], a[32:35], v[16:19]
  ds_read_b64_tr_b16 a[184:185], v147 offset:0
  v_sub_u32 v138, s51, v133
  v_mfma_f32_16x16x32_bf16 v[16:19], a[172:175], a[48:51], v[16:19]
  buffer_load_dwordx4 a[4:7], v242, s[24:27], s30 offen offset:1024 sc1
  v_mfma_f32_16x16x32_bf16 v[20:23], a[172:175], a[52:55], v[20:23]
  ds_read_b64_tr_b16 a[186:187], v147 offset:1024
  v_min3_u32 v136, v136, v137, v138
  v_mfma_f32_16x16x32_bf16 v[20:23], a[168:171], a[36:39], v[20:23]
  v_sub_u32 v139, s51, v134
  v_sub_u32 v140, s51, v135
  v_mfma_f32_16x16x32_bf16 v[24:27], a[168:171], a[40:43], v[24:27]
  ds_read_b64_tr_b16 a[188:189], v147 offset:8192
  v_min3_u32 v136, v136, v139, v140
  v_mfma_f32_16x16x32_bf16 v[24:27], a[172:175], a[56:59], v[24:27]
  v_mfma_f32_16x16x32_bf16 v[28:31], a[172:175], a[60:63], v[28:31]
  ds_read_b64_tr_b16 a[190:191], v147 offset:9216
  v_min_u32_dpp v136, v136, v136 row_ror:8 row_mask:0xf bank_mask:0xf
  v_mfma_f32_16x16x32_bf16 v[28:31], a[168:171], a[44:47], v[28:31]
  s_waitcnt lgkmcnt(4)
  v_min_u32_dpp v136, v136, v136 row_ror:4 row_mask:0xf bank_mask:0xf
  v_mfma_f32_16x16x32_bf16 v[32:35], a[176:179], a[32:35], v[32:35]
  ds_read_b64_tr_b16 a[160:161], v148 offset:0
  v_min_u32_dpp v136, v136, v136 row_ror:2 row_mask:0xf bank_mask:0xf
  v_mfma_f32_16x16x32_bf16 v[32:35], a[180:183], a[48:51], v[32:35]
  buffer_load_dwordx4 a[8:11], v242, s[24:27], s30 offen offset:2048 sc1
  v_mfma_f32_16x16x32_bf16 v[36:39], a[180:183], a[52:55], v[36:39]
  ds_read_b64_tr_b16 a[162:163], v148 offset:1024
  v_min_u32_dpp v136, v136, v136 row_ror:1 row_mask:0xf bank_mask:0xf
  v_mfma_f32_16x16x32_bf16 v[36:39], a[176:179], a[36:39], v[36:39]
  v_readlane_b32 s98, v136, 0
  v_readlane_b32 s99, v136, 16
  v_mfma_f32_16x16x32_bf16 v[40:43], a[176:179], a[40:43], v[40:43]
  ds_read_b64_tr_b16 a[164:165], v148 offset:8192
  v_readlane_b32 s100, v136, 32
  v_mfma_f32_16x16x32_bf16 v[40:43], a[180:183], a[56:59], v[40:43]
  buffer_load_dwordx4 v239, s[20:23], s31 offen offset:1024 lds
  v_mfma_f32_16x16x32_bf16 v[44:47], a[180:183], a[60:63], v[44:47]
  ds_read_b64_tr_b16 a[166:167], v148 offset:9216
  v_readlane_b32 s101, v136, 48
  v_mfma_f32_16x16x32_bf16 v[44:47], a[176:179], a[44:47], v[44:47]
  s_waitcnt lgkmcnt(4)
  s_min_u32 s98, s98, s99
  s_min_u32 s100, s100, s101
  v_mfma_f32_16x16x32_bf16 v[48:51], a[184:187], a[32:35], v[48:51]
  ds_read_b64_tr_b16 a[168:169], v149 offset:0
  s_min_u32 s98, s98, s100
  s_sub_u32 s55, s51, s98
  s_sub_u32 s51, s55, 1
  v_sub_u32 v137, s51, v128
  v_mfma_f32_16x16x32_bf16 v[48:51], a[188:191], a[48:51], v[48:51]
  buffer_load_dwordx4 a[12:15], v242, s[24:27], s30 offen offset:3072 sc1
  v_mfma_f32_16x16x32_bf16 v[52:55], a[188:191], a[52:55], v[52:55]
  ds_read_b64_tr_b16 a[170:171], v149 offset:1024
  v_sub_u32 v138, s51, v129
  v_mfma_f32_16x16x32_bf16 v[52:55], a[184:187], a[36:39], v[52:55]
  v_min_u32 v136, v137, v138
  v_sub_u32 v139, s51, v130
  v_mfma_f32_16x16x32_bf16 v[56:59], a[184:187], a[40:43], v[56:59]
  ds_read_b64_tr_b16 a[172:173], v149 offset:8192
  v_sub_u32 v140, s51, v131
  v_mfma_f32_16x16x32_bf16 v[56:59], a[188:191], a[56:59], v[56:59]
  v_min3_u32 v136, v136, v139, v140
  v_sub_u32 v137, s51, v132
  v_mfma_f32_16x16x32_bf16 v[60:63], a[188:191], a[60:63], v[60:63]
  ds_read_b64_tr_b16 a[174:175], v149 offset:9216
  v_sub_u32 v138, s51, v133
  v_mfma_f32_16x16x32_bf16 v[60:63], a[184:187], a[44:47], v[60:63]
  s_waitcnt lgkmcnt(4)
  v_min3_u32 v136, v136, v137, v138
  v_sub_u32 v139, s51, v134
  v_mfma_f32_16x16x32_bf16 v[64:67], a[160:163], a[32:35], v[64:67]
  ds_read_b64_tr_b16 a[176:177], v150 offset:0
  v_sub_u32 v140, s51, v135
  v_mfma_f32_16x16x32_bf16 v[64:67], a[164:167], a[48:51], v[64:67]
  buffer_load_dwordx4 a[16:19], v243, s[24:27], s30 offen offset:0 sc1
  v_mfma_f32_16x16x32_bf16 v[68:71], a[164:167], a[52:55], v[68:71]
  ds_read_b64_tr_b16 a[178:179], v150 offset:1024
  v_min3_u32 v136, v136, v139, v140
  v_mfma_f32_16x16x32_bf16 v[68:71], a[160:163], a[36:39], v[68:71]
  v_mfma_f32_16x16x32_bf16 v[72:75], a[160:163], a[40:43], v[72:75]
  ds_read_b64_tr_b16 a[180:181], v150 offset:8192
  v_min_u32_dpp v136, v136, v136 row_ror:8 row_mask:0xf bank_mask:0xf
  v_mfma_f32_16x16x32_bf16 v[72:75], a[164:167], a[56:59], v[72:75]
  buffer_load_dwordx4 v240, s[20:23], s31 offen offset:2048 lds
  v_mfma_f32_16x16x32_bf16 v[76:79], a[164:167], a[60:63], v[76:79]
  ds_read_b64_tr_b16 a[182:183], v150 offset:9216
  v_min_u32_dpp v136, v136, v136 row_ror:4 row_mask:0xf bank_mask:0xf
  v_mfma_f32_16x16x32_bf16 v[76:79], a[160:163], a[44:47], v[76:79]
  s_waitcnt lgkmcnt(4)
  v_min_u32_dpp v136, v136, v136 row_ror:2 row_mask:0xf bank_mask:0xf
  v_mfma_f32_16x16x32_bf16 v[80:83], a[168:171], a[32:35], v[80:83]
  ds_read_b64_tr_b16 a[184:185], v151 offset:0
  v_min_u32_dpp v136, v136, v136 row_ror:1 row_mask:0xf bank_mask:0xf
  v_mfma_f32_16x16x32_bf16 v[80:83], a[172:175], a[48:51], v[80:83]
  buffer_load_dwordx4 a[20:23], v243, s[24:27], s30 offen offset:1024 sc1
  v_mfma_f32_16x16x32_bf16 v[84:87], a[172:175], a[52:55], v[84:87]
  ds_read_b64_tr_b16 a[186:187], v151 offset:1024
  v_readlane_b32 s98, v136, 0
  v_mfma_f32_16x16x32_bf16 v[84:87], a[168:171], a[36:39], v[84:87]
  s_waitcnt vmcnt(22)
  v_readlane_b32 s99, v136, 16
  v_readlane_b32 s100, v136, 32
  v_mfma_f32_16x16x32_bf16 v[88:91], a[168:171], a[40:43], v[88:91]
  ds_read_b64_tr_b16 a[188:189], v151 offset:8192
  v_readlane_b32 s101, v136, 48
  v_mfma_f32_16x16x32_bf16 v[88:91], a[172:175], a[56:59], v[88:91]
  s_barrier
  s_min_u32 s98, s98, s99
  s_min_u32 s100, s100, s101
  v_mfma_f32_16x16x32_bf16 v[92:95], a[172:175], a[60:63], v[92:95]
  ds_read_b64_tr_b16 a[190:191], v151 offset:9216
  s_min_u32 s98, s98, s100
  s_sub_u32 s56, s51, s98
  s_sub_u32 s51, s56, 1
  v_sub_u32 v137, s51, v128
  v_mfma_f32_16x16x32_bf16 v[92:95], a[168:171], a[44:47], v[92:95]
  s_waitcnt lgkmcnt(4)
  v_sub_u32 v138, s51, v129
  v_min_u32 v136, v137, v138
  v_mfma_f32_16x16x32_bf16 v[96:99], a[176:179], a[32:35], v[96:99]
  ds_read_b64_tr_b16 a[160:161], v224 offset:0
  v_sub_u32 v139, s51, v130
  v_mfma_f32_16x16x32_bf16 v[96:99], a[180:183], a[48:51], v[96:99]
  buffer_load_dwordx4 a[24:27], v243, s[24:27], s30 offen offset:2048 sc1
  v_mfma_f32_16x16x32_bf16 v[100:103], a[180:183], a[52:55], v[100:103]
  ds_read_b64_tr_b16 a[162:163], v224 offset:1024
  v_sub_u32 v140, s51, v131
  v_mfma_f32_16x16x32_bf16 v[100:103], a[176:179], a[36:39], v[100:103]
  v_min3_u32 v136, v136, v139, v140
  v_sub_u32 v137, s51, v132
  v_mfma_f32_16x16x32_bf16 v[104:107], a[176:179], a[40:43], v[104:107]
  ds_read_b64_tr_b16 a[164:165], v224 offset:8192
  v_sub_u32 v138, s51, v133
  v_mfma_f32_16x16x32_bf16 v[104:107], a[180:183], a[56:59], v[104:107]
  buffer_load_dwordx4 v241, s[20:23], s31 offen offset:3072 lds
  s_add_u32 s31, s31, 0x80000
  v_mfma_f32_16x16x32_bf16 v[108:111], a[180:183], a[60:63], v[108:111]
  ds_read_b64_tr_b16 a[166:167], v224 offset:9216
  v_min3_u32 v136, v136, v137, v138
  v_mfma_f32_16x16x32_bf16 v[108:111], a[176:179], a[44:47], v[108:111]
  s_waitcnt lgkmcnt(4)
  v_sub_u32 v139, s51, v134
  v_sub_u32 v140, s51, v135
  v_mfma_f32_16x16x32_bf16 v[112:115], a[184:187], a[32:35], v[112:115]
  ds_read_b64_tr_b16 a[168:169], v225 offset:0
  v_min3_u32 v136, v136, v139, v140
  v_mfma_f32_16x16x32_bf16 v[112:115], a[188:191], a[48:51], v[112:115]
  buffer_load_dwordx4 a[28:31], v243, s[24:27], s30 offen offset:3072 sc1
  s_add_u32 s30, s30, 8192
  v_mfma_f32_16x16x32_bf16 v[116:119], a[188:191], a[52:55], v[116:119]
  ds_read_b64_tr_b16 a[170:171], v225 offset:1024
  v_min_u32_dpp v136, v136, v136 row_ror:8 row_mask:0xf bank_mask:0xf
  v_mfma_f32_16x16x32_bf16 v[116:119], a[184:187], a[36:39], v[116:119]
  v_mfma_f32_16x16x32_bf16 v[120:123], a[184:187], a[40:43], v[120:123]
  ds_read_b64_tr_b16 a[172:173], v225 offset:8192
  v_min_u32_dpp v136, v136, v136 row_ror:4 row_mask:0xf bank_mask:0xf
  v_mfma_f32_16x16x32_bf16 v[120:123], a[188:191], a[56:59], v[120:123]
  v_mfma_f32_16x16x32_bf16 v[124:127], a[188:191], a[60:63], v[124:127]
  ds_read_b64_tr_b16 a[174:175], v225 offset:9216
  v_min_u32_dpp v136, v136, v136 row_ror:2 row_mask:0xf bank_mask:0xf
  v_mfma_f32_16x16x32_bf16 v[124:127], a[184:187], a[44:47], v[124:127]
  s_waitcnt vmcnt(24) lgkmcnt(4)
  v_min_u32_dpp v136, v136, v136 row_ror:1 row_mask:0xf bank_mask:0xf
  v_mfma_f32_16x16x32_bf16 v[0:3], a[160:163], a[64:67], v[0:3]
  ds_read_b64_tr_b16 a[176:177], v226 offset:0
  v_readlane_b32 s98, v136, 0
  v_mfma_f32_16x16x32_bf16 v[0:3], a[164:167], a[80:83], v[0:3]
  buffer_load_dwordx4 a[32:35], v242, s[24:27], s30 offen offset:0 sc1
  v_mfma_f32_16x16x32_bf16 v[4:7], a[164:167], a[84:87], v[4:7]
  ds_read_b64_tr_b16 a[178:179], v226 offset:1024
  v_readlane_b32 s99, v136, 16
  v_mfma_f32_16x16x32_bf16 v[4:7], a[160:163], a[68:71], v[4:7]
  v_readlane_b32 s100, v136, 32
  v_readlane_b32 s101, v136, 48
  v_mfma_f32_16x16x32_bf16 v[8:11], a[160:163], a[72:75], v[8:11]
  ds_read_b64_tr_b16 a[180:181], v226 offset:8192
  s_add_u32 m0, s28, 114688
  s_min_u32 s98, s98, s99
  s_min_u32 s100, s100, s101
  v_mfma_f32_16x16x32_bf16 v[8:11], a[164:167], a[88:91], v[8:11]
  buffer_load_dwordx4 v238, s[20:23], s31 offen offset:0 lds
  s_min_u32 s98, s98, s100
  s_sub_u32 s57, s51, s98
  s_sub_u32 s51, s57, 1
  v_mfma_f32_16x16x32_bf16 v[12:15], a[164:167], a[92:95], v[12:15]
  ds_read_b64_tr_b16 a[182:183], v226 offset:9216
  v_sub_u32 v137, s51, v128
  v_mfma_f32_16x16x32_bf16 v[12:15], a[160:163], a[76:79], v[12:15]
  s_waitcnt lgkmcnt(4)
  v_sub_u32 v138, s51, v129
  v_min_u32 v136, v137, v138
  v_mfma_f32_16x16x32_bf16 v[16:19], a[168:171], a[64:67], v[16:19]
  ds_read_b64_tr_b16 a[184:185], v227 offset:0
  v_sub_u32 v139, s51, v130
  v_mfma_f32_16x16x32_bf16 v[16:19], a[172:175], a[80:83], v[16:19]
  buffer_load_dwordx4 a[36:39], v242, s[24:27], s30 offen offset:1024 sc1
  v_mfma_f32_16x16x32_bf16 v[20:23], a[172:175], a[84:87], v[20:23]
  ds_read_b64_tr_b16 a[186:187], v227 offset:1024
  v_sub_u32 v140, s51, v131
  v_mfma_f32_16x16x32_bf16 v[20:23], a[168:171], a[68:71], v[20:23]
  v_min3_u32 v136, v136, v139, v140
  v_sub_u32 v137, s51, v132
  v_mfma_f32_16x16x32_bf16 v[24:27], a[168:171], a[72:75], v[24:27]
  ds_read_b64_tr_b16 a[188:189], v227 offset:8192
  v_sub_u32 v138, s51, v133
  v_mfma_f32_16x16x32_bf16 v[24:27], a[172:175], a[88:91], v[24:27]
  v_min3_u32 v136, v136, v137, v138
  v_sub_u32 v139, s51, v134
  v_mfma_f32_16x16x32_bf16 v[28:31], a[172:175], a[92:95], v[28:31]
  ds_read_b64_tr_b16 a[190:191], v227 offset:9216
  v_sub_u32 v140, s51, v135
  v_mfma_f32_16x16x32_bf16 v[28:31], a[168:171], a[76:79], v[28:31]
  s_waitcnt lgkmcnt(4)
  v_min3_u32 v136, v136, v139, v140
  v_mfma_f32_16x16x32_bf16 v[32:35], a[176:179], a[64:67], v[32:35]
  ds_read_b64_tr_b16 a[160:161], v228 offset:0
  v_min_u32_dpp v136, v136, v136 row_ror:8 row_mask:0xf bank_mask:0xf
  v_mfma_f32_16x16x32_bf16 v[32:35], a[180:183], a[80:83], v[32:35]
  buffer_load_dwordx4 a[40:43], v242, s[24:27], s30 offen offset:2048 sc1
  v_mfma_f32_16x16x32_bf16 v[36:39], a[180:183], a[84:87], v[36:39]
  ds_read_b64_tr_b16 a[162:163], v228 offset:1024
  v_min_u32_dpp v136, v136, v136 row_ror:4 row_mask:0xf bank_mask:0xf
  v_mfma_f32_16x16x32_bf16 v[36:39], a[176:179], a[68:71], v[36:39]
  v_mfma_f32_16x16x32_bf16 v[40:43], a[176:179], a[72:75], v[40:43]
  ds_read_b64_tr_b16 a[164:165], v228 offset:8192
  v_min_u32_dpp v136, v136, v136 row_ror:2 row_mask:0xf bank_mask:0xf
  v_mfma_f32_16x16x32_bf16 v[40:43], a[180:183], a[88:91], v[40:43]
  buffer_load_dwordx4 v239, s[20:23], s31 offen offset:1024 lds
  v_mfma_f32_16x16x32_bf16 v[44:47], a[180:183], a[92:95], v[44:47]
  ds_read_b64_tr_b16 a[166:167], v228 offset:9216
  v_min_u32_dpp v136, v136, v136 row_ror:1 row_mask:0xf bank_mask:0xf
  v_mfma_f32_16x16x32_bf16 v[44:47], a[176:179], a[76:79], v[44:47]
  s_waitcnt lgkmcnt(4)
  v_readlane_b32 s98, v136, 0
  v_readlane_b32 s99, v136, 16
  v_mfma_f32_16x16x32_bf16 v[48:51], a[184:187], a[64:67], v[48:51]
  ds_read_b64_tr_b16 a[168:169], v229 offset:0
  v_readlane_b32 s100, v136, 32
  v_mfma_f32_16x16x32_bf16 v[48:51], a[188:191], a[80:83], v[48:51]
  buffer_load_dwordx4 a[44:47], v242, s[24:27], s30 offen offset:3072 sc1
  v_mfma_f32_16x16x32_bf16 v[52:55], a[188:191], a[84:87], v[52:55]
  ds_read_b64_tr_b16 a[170:171], v229 offset:1024
  v_readlane_b32 s101, v136, 48
  v_mfma_f32_16x16x32_bf16 v[52:55], a[184:187], a[68:71], v[52:55]
  s_min_u32 s98, s98, s99
  s_min_u32 s100, s100, s101
  s_min_u32 s98, s98, s100
  v_mfma_f32_16x16x32_bf16 v[56:59], a[184:187], a[72:75], v[56:59]
  ds_read_b64_tr_b16 a[172:173], v229 offset:8192
  s_sub_u32 s58, s51, s98
  s_sub_u32 s51, s58, 1
  v_sub_u32 v137, s51, v128
  v_mfma_f32_16x16x32_bf16 v[56:59], a[188:191], a[88:91], v[56:59]
  v_sub_u32 v138, s51, v129
  v_min_u32 v136, v137, v138
  v_mfma_f32_16x16x32_bf16 v[60:63], a[188:191], a[92:95], v[60:63]
  ds_read_b64_tr_b16 a[174:175], v229 offset:9216
  v_sub_u32 v139, s51, v130
  v_mfma_f32_16x16x32_bf16 v[60:63], a[184:187], a[76:79], v[60:63]
  s_waitcnt lgkmcnt(4)
  v_sub_u32 v140, s51, v131
  v_min3_u32 v136, v136, v139, v140
  v_mfma_f32_16x16x32_bf16 v[64:67], a[160:163], a[64:67], v[64:67]
  ds_read_b64_tr_b16 a[176:177], v230 offset:0
  v_sub_u32 v137, s51, v132
  v_mfma_f32_16x16x32_bf16 v[64:67], a[164:167], a[80:83], v[64:67]
  buffer_load_dwordx4 a[48:51], v243, s[24:27], s30 offen offset:0 sc1
  v_mfma_f32_16x16x32_bf16 v[68:71], a[164:167], a[84:87], v[68:71]
  ds_read_b64_tr_b16 a[178:179], v230 offset:1024
  v_sub_u32 v138, s51, v133
  v_mfma_f32_16x16x32_bf16 v[68:71], a[160:163], a[68:71], v[68:71]
  v_min3_u32 v136, v136, v137, v138
  v_sub_u32 v139, s51, v134
  v_mfma_f32_16x16x32_bf16 v[72:75], a[160:163], a[72:75], v[72:75]
  ds_read_b64_tr_b16 a[180:181], v230 offset:8192
  v_sub_u32 v140, s51, v135
  v_mfma_f32_16x16x32_bf16 v[72:75], a[164:167], a[88:91], v[72:75]
  buffer_load_dwordx4 v240, s[20:23], s31 offen offset:2048 lds
  v_mfma_f32_16x16x32_bf16 v[76:79], a[164:167], a[92:95], v[76:79]
  ds_read_b64_tr_b16 a[182:183], v230 offset:9216
  v_min3_u32 v136, v136, v139, v140
  v_mfma_f32_16x16x32_bf16 v[76:79], a[160:163], a[76:79], v[76:79]
  s_waitcnt lgkmcnt(4)
  v_min_u32_dpp v136, v136, v136 row_ror:8 row_mask:0xf bank_mask:0xf
  v_mfma_f32_16x16x32_bf16 v[80:83], a[168:171], a[64:67], v[80:83]
  ds_read_b64_tr_b16 a[184:185], v231 offset:0
  v_min_u32_dpp v136, v136, v136 row_ror:4 row_mask:0xf bank_mask:0xf
  v_mfma_f32_16x16x32_bf16 v[80:83], a[172:175], a[80:83], v[80:83]
  buffer_load_dwordx4 a[52:55], v243, s[24:27], s30 offen offset:1024 sc1
  v_mfma_f32_16x16x32_bf16 v[84:87], a[172:175], a[84:87], v[84:87]
  ds_read_b64_tr_b16 a[186:187], v231 offset:1024
  v_min_u32_dpp v136, v136, v136 row_ror:2 row_mask:0xf bank_mask:0xf
  v_mfma_f32_16x16x32_bf16 v[84:87], a[168:171], a[68:71], v[84:87]
  s_waitcnt vmcnt(22)
  v_min_u32_dpp v136, v136, v136 row_ror:1 row_mask:0xf bank_mask:0xf
  v_mfma_f32_16x16x32_bf16 v[88:91], a[168:171], a[72:75], v[88:91]
  ds_read_b64_tr_b16 a[188:189], v231 offset:8192
  v_readlane_b32 s98, v136, 0
  v_readlane_b32 s99, v136, 16
  v_readlane_b32 s100, v136, 32
  v_readlane_b32 s101, v136, 48
  s_min_u32 s98, s98, s99
  s_min_u32 s100, s100, s101
  s_min_u32 s98, s98, s100
  s_sub_u32 s59, s51, s98
  s_sub_u32 s51, s59, 1
  v_writelane_b32 v136, s52, 0
  v_writelane_b32 v136, s53, 1
  v_writelane_b32 v136, s54, 2
  v_writelane_b32 v136, s55, 3
  v_writelane_b32 v136, s56, 4
  v_writelane_b32 v136, s57, 5
  v_writelane_b32 v136, s58, 6
  v_writelane_b32 v136, s59, 7
  s_lshl_b32 s35, s3, 8
  s_add_u32 s35, s35, 158720
  v_lshrrev_b32 v137, 2, v242
  v_add_u32 v137, s35, v137
  ds_write_b32 v137, v136
  s_waitcnt lgkmcnt(0)
  v_mfma_f32_16x16x32_bf16 v[88:91], a[172:175], a[88:91], v[88:91]
  s_barrier
  v_mfma_f32_16x16x32_bf16 v[92:95], a[172:175], a[92:95], v[92:95]
  ds_read_b64_tr_b16 a[190:191], v231 offset:9216
  v_mfma_f32_16x16x32_bf16 v[92:95], a[168:171], a[76:79], v[92:95]
  v_mfma_f32_16x16x32_bf16 v[96:99], a[176:179], a[64:67], v[96:99]
  ds_read_b64_tr_b16 a[160:161], v224 offset:16384
  v_mfma_f32_16x16x32_bf16 v[96:99], a[180:183], a[80:83], v[96:99]
  buffer_load_dwordx4 a[56:59], v243, s[24:27], s30 offen offset:2048 sc1
  v_mfma_f32_16x16x32_bf16 v[100:103], a[180:183], a[84:87], v[100:103]
  ds_read_b64_tr_b16 a[162:163], v224 offset:17408
  v_mfma_f32_16x16x32_bf16 v[100:103], a[176:179], a[68:71], v[100:103]
  v_mfma_f32_16x16x32_bf16 v[104:107], a[176:179], a[72:75], v[104:107]
  ds_read_b64_tr_b16 a[164:165], v224 offset:24576
  v_mfma_f32_16x16x32_bf16 v[104:107], a[180:183], a[88:91], v[104:107]
  buffer_load_dwordx4 v241, s[20:23], s31 offen offset:3072 lds
  s_add_u32 s31, s31, 0x80000
  v_mfma_f32_16x16x32_bf16 v[108:111], a[180:183], a[92:95], v[108:111]
  ds_read_b64_tr_b16 a[166:167], v224 offset:25600
  v_mfma_f32_16x16x32_bf16 v[108:111], a[176:179], a[76:79], v[108:111]
  s_waitcnt lgkmcnt(4)
  v_mfma_f32_16x16x32_bf16 v[112:115], a[184:187], a[64:67], v[112:115]
  ds_read_b64_tr_b16 a[168:169], v225 offset:16384
  v_mfma_f32_16x16x32_bf16 v[112:115], a[188:191], a[80:83], v[112:115]
  buffer_load_dwordx4 a[60:63], v243, s[24:27], s30 offen offset:3072 sc1
  s_add_u32 s30, s30, 8192
  v_mfma_f32_16x16x32_bf16 v[116:119], a[188:191], a[84:87], v[116:119]
  ds_read_b64_tr_b16 a[170:171], v225 offset:17408
  v_mfma_f32_16x16x32_bf16 v[116:119], a[184:187], a[68:71], v[116:119]
  v_mfma_f32_16x16x32_bf16 v[120:123], a[184:187], a[72:75], v[120:123]
  ds_read_b64_tr_b16 a[172:173], v225 offset:24576
  v_mfma_f32_16x16x32_bf16 v[120:123], a[188:191], a[88:91], v[120:123]
  v_mfma_f32_16x16x32_bf16 v[124:127], a[188:191], a[92:95], v[124:127]
  ds_read_b64_tr_b16 a[174:175], v225 offset:25600
  v_mfma_f32_16x16x32_bf16 v[124:127], a[184:187], a[76:79], v[124:127]
  s_waitcnt vmcnt(24) lgkmcnt(4)
  v_mfma_f32_16x16x32_bf16 v[0:3], a[160:163], a[96:99], v[0:3]
  ds_read_b64_tr_b16 a[176:177], v226 offset:16384
  v_lshrrev_b32 v136, 4, v242
  v_mfma_f32_16x16x32_bf16 v[0:3], a[164:167], a[112:115], v[0:3]
  v_bfe_u32 v137, v136, 3, 2
  v_and_b32 v138, 7, v136
  v_mfma_f32_16x16x32_bf16 v[4:7], a[164:167], a[116:119], v[4:7]
  ds_read_b64_tr_b16 a[178:179], v226 offset:17408
  v_lshlrev_b32 v137, 8, v137
  v_mfma_f32_16x16x32_bf16 v[4:7], a[160:163], a[100:103], v[4:7]
  v_lshl_add_u32 v137, v138, 2, v137
  v_add_u32 v137, 158720, v137
  v_mfma_f32_16x16x32_bf16 v[8:11], a[160:163], a[104:107], v[8:11]
  ds_read_b64_tr_b16 a[180:181], v226 offset:24576
  s_add_u32 m0, s28, 0
  ds_read_b32 v128, v137
  v_mfma_f32_16x16x32_bf16 v[8:11], a[164:167], a[120:123], v[8:11]
  buffer_load_dwordx4 v232, s[12:15], s29 offen offset:0 lds
  v_mfma_f32_16x16x32_bf16 v[12:15], a[164:167], a[124:127], v[12:15]
  ds_read_b64_tr_b16 a[182:183], v226 offset:25600
  v_mfma_f32_16x16x32_bf16 v[12:15], a[160:163], a[108:111], v[12:15]
  s_waitcnt lgkmcnt(5)
  v_mfma_f32_16x16x32_bf16 v[16:19], a[168:171], a[96:99], v[16:19]
  ds_read_b64_tr_b16 a[184:185], v227 offset:16384
  v_mfma_f32_16x16x32_bf16 v[16:19], a[172:175], a[112:115], v[16:19]
  v_mfma_f32_16x16x32_bf16 v[20:23], a[172:175], a[116:119], v[20:23]
  ds_read_b64_tr_b16 a[186:187], v227 offset:17408
  v_mfma_f32_16x16x32_bf16 v[20:23], a[168:171], a[100:103], v[20:23]
  v_mfma_f32_16x16x32_bf16 v[24:27], a[168:171], a[104:107], v[24:27]
  ds_read_b64_tr_b16 a[188:189], v227 offset:24576
  s_waitcnt lgkmcnt(4)
  s_mov_b32 s51, -1
  v_sub_u32 v137, s51, v128
  v_mfma_f32_16x16x32_bf16 v[24:27], a[172:175], a[120:123], v[24:27]
  v_mfma_f32_16x16x32_bf16 v[28:31], a[172:175], a[124:127], v[28:31]
  ds_read_b64_tr_b16 a[190:191], v227 offset:25600
  v_min_u32_dpp v137, v137, v137 row_ror:8 row_mask:0xf bank_mask:0xf
  v_mfma_f32_16x16x32_bf16 v[28:31], a[168:171], a[108:111], v[28:31]
  s_waitcnt lgkmcnt(4)
  v_min_u32_dpp v137, v137, v137 row_ror:4 row_mask:0xf bank_mask:0xf
  v_mfma_f32_16x16x32_bf16 v[32:35], a[176:179], a[96:99], v[32:35]
  ds_read_b64_tr_b16 a[160:161], v228 offset:16384
  v_min_u32_dpp v137, v137, v137 row_ror:2 row_mask:0xf bank_mask:0xf
  v_mfma_f32_16x16x32_bf16 v[32:35], a[180:183], a[112:115], v[32:35]
  v_mfma_f32_16x16x32_bf16 v[36:39], a[180:183], a[116:119], v[36:39]
  ds_read_b64_tr_b16 a[162:163], v228 offset:17408
  v_min_u32_dpp v137, v137, v137 row_ror:1 row_mask:0xf bank_mask:0xf
  v_mfma_f32_16x16x32_bf16 v[36:39], a[176:179], a[100:103], v[36:39]
  v_readlane_b32 s98, v137, 0
  v_readlane_b32 s99, v137, 16
  v_mfma_f32_16x16x32_bf16 v[40:43], a[176:179], a[104:107], v[40:43]
  ds_read_b64_tr_b16 a[164:165], v228 offset:24576
  s_min_u32 s98, s98, s99
  s_sub_u32 s52, s51, s98
  s_sub_u32 s51, s52, 1
  v_sub_u32 v137, s51, v128
  v_mfma_f32_16x16x32_bf16 v[40:43], a[180:183], a[120:123], v[40:43]
  buffer_load_dwordx4 v233, s[12:15], s29 offen offset:1024 lds
  v_mfma_f32_16x16x32_bf16 v[44:47], a[180:183], a[124:127], v[44:47]
  ds_read_b64_tr_b16 a[166:167], v228 offset:25600
  v_min_u32_dpp v137, v137, v137 row_ror:8 row_mask:0xf bank_mask:0xf
  v_mfma_f32_16x16x32_bf16 v[44:47], a[176:179], a[108:111], v[44:47]
  s_waitcnt lgkmcnt(4)
  v_min_u32_dpp v137, v137, v137 row_ror:4 row_mask:0xf bank_mask:0xf
  v_mfma_f32_16x16x32_bf16 v[48:51], a[184:187], a[96:99], v[48:51]
  ds_read_b64_tr_b16 a[168:169], v229 offset:16384
  v_min_u32_dpp v137, v137, v137 row_ror:2 row_mask:0xf bank_mask:0xf
  v_mfma_f32_16x16x32_bf16 v[48:51], a[188:191], a[112:115], v[48:51]
  v_mfma_f32_16x16x32_bf16 v[52:55], a[188:191], a[116:119], v[52:55]
  ds_read_b64_tr_b16 a[170:171], v229 offset:17408
  v_min_u32_dpp v137, v137, v137 row_ror:1 row_mask:0xf bank_mask:0xf
  v_mfma_f32_16x16x32_bf16 v[52:55], a[184:187], a[100:103], v[52:55]
  v_readlane_b32 s98, v137, 0
  v_readlane_b32 s99, v137, 16
  v_mfma_f32_16x16x32_bf16 v[56:59], a[184:187], a[104:107], v[56:59]
  ds_read_b64_tr_b16 a[172:173], v229 offset:24576
  s_min_u32 s98, s98, s99
  s_sub_u32 s53, s51, s98
  s_sub_u32 s51, s53, 1
  v_sub_u32 v137, s51, v128
  v_mfma_f32_16x16x32_bf16 v[56:59], a[188:191], a[120:123], v[56:59]
  v_mfma_f32_16x16x32_bf16 v[60:63], a[188:191], a[124:127], v[60:63]
  ds_read_b64_tr_b16 a[174:175], v229 offset:25600
  v_min_u32_dpp v137, v137, v137 row_ror:8 row_mask:0xf bank_mask:0xf
  v_mfma_f32_16x16x32_bf16 v[60:63], a[184:187], a[108:111], v[60:63]
  s_waitcnt lgkmcnt(4)
  v_min_u32_dpp v137, v137, v137 row_ror:4 row_mask:0xf bank_mask:0xf
  v_mfma_f32_16x16x32_bf16 v[64:67], a[160:163], a[96:99], v[64:67]
  ds_read_b64_tr_b16 a[176:177], v230 offset:16384
  v_min_u32_dpp v137, v137, v137 row_ror:2 row_mask:0xf bank_mask:0xf
  v_mfma_f32_16x16x32_bf16 v[64:67], a[164:167], a[112:115], v[64:67]
  v_mfma_f32_16x16x32_bf16 v[68:71], a[164:167], a[116:119], v[68:71]
  ds_read_b64_tr_b16 a[178:179], v230 offset:17408
  v_min_u32_dpp v137, v137, v137 row_ror:1 row_mask:0xf bank_mask:0xf
  v_mfma_f32_16x16x32_bf16 v[68:71], a[160:163], a[100:103], v[68:71]
  v_readlane_b32 s98, v137, 0
  v_readlane_b32 s99, v137, 16
  v_mfma_f32_16x16x32_bf16 v[72:75], a[160:163], a[104:107], v[72:75]
  ds_read_b64_tr_b16 a[180:181], v230 offset:24576
  s_min_u32 s98, s98, s99
  s_sub_u32 s54, s51, s98
  s_sub_u32 s51, s54, 1
  v_sub_u32 v137, s51, v128
  v_mfma_f32_16x16x32_bf16 v[72:75], a[164:167], a[120:123], v[72:75]
  buffer_load_dwordx4 v234, s[12:15], s29 offen offset:2048 lds
  v_mfma_f32_16x16x32_bf16 v[76:79], a[164:167], a[124:127], v[76:79]
  ds_read_b64_tr_b16 a[182:183], v230 offset:25600
  v_min_u32_dpp v137, v137, v137 row_ror:8 row_mask:0xf bank_mask:0xf
  v_mfma_f32_16x16x32_bf16 v[76:79], a[160:163], a[108:111], v[76:79]
  s_waitcnt lgkmcnt(4)
  v_min_u32_dpp v137, v137, v137 row_ror:4 row_mask:0xf bank_mask:0xf
  v_mfma_f32_16x16x32_bf16 v[80:83], a[168:171], a[96:99], v[80:83]
  ds_read_b64_tr_b16 a[184:185], v231 offset:16384
  v_min_u32_dpp v137, v137, v137 row_ror:2 row_mask:0xf bank_mask:0xf
  v_mfma_f32_16x16x32_bf16 v[80:83], a[172:175], a[112:115], v[80:83]
  v_mfma_f32_16x16x32_bf16 v[84:87], a[172:175], a[116:119], v[84:87]
  ds_read_b64_tr_b16 a[186:187], v231 offset:17408
  v_min_u32_dpp v137, v137, v137 row_ror:1 row_mask:0xf bank_mask:0xf
  v_mfma_f32_16x16x32_bf16 v[84:87], a[168:171], a[100:103], v[84:87]
  s_waitcnt vmcnt(16)
  v_readlane_b32 s98, v137, 0
  v_readlane_b32 s99, v137, 16
  v_mfma_f32_16x16x32_bf16 v[88:91], a[168:171], a[104:107], v[88:91]
  ds_read_b64_tr_b16 a[188:189], v231 offset:24576
  s_min_u32 s98, s98, s99
  s_sub_u32 s55, s51, s98
  s_sub_u32 s51, s55, 1
  v_sub_u32 v137, s51, v128
  v_mfma_f32_16x16x32_bf16 v[88:91], a[172:175], a[120:123], v[88:91]
  s_barrier
  v_min_u32_dpp v137, v137, v137 row_ror:8 row_mask:0xf bank_mask:0xf
  v_mfma_f32_16x16x32_bf16 v[92:95], a[172:175], a[124:127], v[92:95]
  ds_read_b64_tr_b16 a[190:191], v231 offset:25600
  v_min_u32_dpp v137, v137, v137 row_ror:4 row_mask:0xf bank_mask:0xf
  v_mfma_f32_16x16x32_bf16 v[92:95], a[168:171], a[108:111], v[92:95]
  s_waitcnt lgkmcnt(4)
  v_min_u32_dpp v137, v137, v137 row_ror:2 row_mask:0xf bank_mask:0xf
  v_mfma_f32_16x16x32_bf16 v[96:99], a[176:179], a[96:99], v[96:99]
  ds_read_b64_tr_b16 a[160:161], v224 offset:32768
  v_min_u32_dpp v137, v137, v137 row_ror:1 row_mask:0xf bank_mask:0xf
  v_mfma_f32_16x16x32_bf16 v[96:99], a[180:183], a[112:115], v[96:99]
  v_readlane_b32 s98, v137, 0
  v_readlane_b32 s99, v137, 16
  v_mfma_f32_16x16x32_bf16 v[100:103], a[180:183], a[116:119], v[100:103]
  ds_read_b64_tr_b16 a[162:163], v224 offset:33792
  s_min_u32 s98, s98, s99
  s_sub_u32 s56, s51, s98
  s_sub_u32 s51, s56, 1
  v_sub_u32 v137, s51, v128
  v_mfma_f32_16x16x32_bf16 v[100:103], a[176:179], a[100:103], v[100:103]
  v_mfma_f32_16x16x32_bf16 v[104:107], a[176:179], a[104:107], v[104:107]
  ds_read_b64_tr_b16 a[164:165], v224 offset:40960
  v_min_u32_dpp v137, v137, v137 row_ror:8 row_mask:0xf bank_mask:0xf
  v_mfma_f32_16x16x32_bf16 v[104:107], a[180:183], a[120:123], v[104:107]
  buffer_load_dwordx4 v235, s[12:15], s29 offen offset:3072 lds
  v_mfma_f32_16x16x32_bf16 v[108:111], a[180:183], a[124:127], v[108:111]
  ds_read_b64_tr_b16 a[166:167], v224 offset:41984
  v_min_u32_dpp v137, v137, v137 row_ror:4 row_mask:0xf bank_mask:0xf
  v_mfma_f32_16x16x32_bf16 v[108:111], a[176:179], a[108:111], v[108:111]
  s_waitcnt lgkmcnt(4)
  v_min_u32_dpp v137, v137, v137 row_ror:2 row_mask:0xf bank_mask:0xf
  v_mfma_f32_16x16x32_bf16 v[112:115], a[184:187], a[96:99], v[112:115]
  ds_read_b64_tr_b16 a[168:169], v225 offset:32768
  v_min_u32_dpp v137, v137, v137 row_ror:1 row_mask:0xf bank_mask:0xf
  v_mfma_f32_16x16x32_bf16 v[112:115], a[188:191], a[112:115], v[112:115]
  v_readlane_b32 s98, v137, 0
  v_readlane_b32 s99, v137, 16
  v_mfma_f32_16x16x32_bf16 v[116:119], a[188:191], a[116:119], v[116:119]
  ds_read_b64_tr_b16 a[170:171], v225 offset:33792
  s_min_u32 s98, s98, s99
  s_sub_u32 s57, s51, s98
  s_sub_u32 s51, s57, 1
  v_sub_u32 v137, s51, v128
  v_mfma_f32_16x16x32_bf16 v[116:119], a[184:187], a[100:103], v[116:119]
  v_mfma_f32_16x16x32_bf16 v[120:123], a[184:187], a[104:107], v[120:123]
  ds_read_b64_tr_b16 a[172:173], v225 offset:40960
  v_min_u32_dpp v137, v137, v137 row_ror:8 row_mask:0xf bank_mask:0xf
  v_mfma_f32_16x16x32_bf16 v[120:123], a[188:191], a[120:123], v[120:123]
  v_mfma_f32_16x16x32_bf16 v[124:127], a[188:191], a[124:127], v[124:127]
  ds_read_b64_tr_b16 a[174:175], v225 offset:41984
  v_min_u32_dpp v137, v137, v137 row_ror:4 row_mask:0xf bank_mask:0xf
  v_mfma_f32_16x16x32_bf16 v[124:127], a[184:187], a[108:111], v[124:127]
  s_waitcnt vmcnt(16) lgkmcnt(4)
  v_min_u32_dpp v137, v137, v137 row_ror:2 row_mask:0xf bank_mask:0xf
  v_mfma_f32_16x16x32_bf16 v[0:3], a[160:163], a[0:3], v[0:3]
  ds_read_b64_tr_b16 a[176:177], v226 offset:32768
  v_min_u32_dpp v137, v137, v137 row_ror:1 row_mask:0xf bank_mask:0xf
  v_mfma_f32_16x16x32_bf16 v[0:3], a[164:167], a[16:19], v[0:3]
  v_readlane_b32 s98, v137, 0
  v_readlane_b32 s99, v137, 16
  v_mfma_f32_16x16x32_bf16 v[4:7], a[164:167], a[20:23], v[4:7]
  ds_read_b64_tr_b16 a[178:179], v226 offset:33792
  s_min_u32 s98, s98, s99
  s_sub_u32 s58, s51, s98
  s_sub_u32 s51, s58, 1
  v_sub_u32 v137, s51, v128
  v_mfma_f32_16x16x32_bf16 v[4:7], a[160:163], a[4:7], v[4:7]
  v_mfma_f32_16x16x32_bf16 v[8:11], a[160:163], a[8:11], v[8:11]
  ds_read_b64_tr_b16 a[180:181], v226 offset:40960
  s_add_u32 m0, s28, 65536
  v_min_u32_dpp v137, v137, v137 row_ror:8 row_mask:0xf bank_mask:0xf
  v_mfma_f32_16x16x32_bf16 v[8:11], a[164:167], a[24:27], v[8:11]
  buffer_load_dwordx4 v236, s[16:19], s29 offen offset:0 lds
  v_mfma_f32_16x16x32_bf16 v[12:15], a[164:167], a[28:31], v[12:15]
  ds_read_b64_tr_b16 a[182:183], v226 offset:41984
  v_min_u32_dpp v137, v137, v137 row_ror:4 row_mask:0xf bank_mask:0xf
  v_mfma_f32_16x16x32_bf16 v[12:15], a[160:163], a[12:15], v[12:15]
  s_waitcnt lgkmcnt(4)
  v_min_u32_dpp v137, v137, v137 row_ror:2 row_mask:0xf bank_mask:0xf
  v_mfma_f32_16x16x32_bf16 v[16:19], a[168:171], a[0:3], v[16:19]
  ds_read_b64_tr_b16 a[184:185], v227 offset:32768
  v_min_u32_dpp v137, v137, v137 row_ror:1 row_mask:0xf bank_mask:0xf
  v_mfma_f32_16x16x32_bf16 v[16:19], a[172:175], a[16:19], v[16:19]
  v_readlane_b32 s98, v137, 0
  v_readlane_b32 s99, v137, 16
  v_mfma_f32_16x16x32_bf16 v[20:23], a[172:175], a[20:23], v[20:23]
  ds_read_b64_tr_b16 a[186:187], v227 offset:33792
  s_min_u32 s98, s98, s99
  s_sub_u32 s59, s51, s98
  s_sub_u32 s51, s59, 1
  v_mov_b32 v128, 0
  v_mfma_f32_16x16x32_bf16 v[20:23], a[168:171], a[4:7], v[20:23]
  v_writelane_b32 v128, s52, 0
  v_writelane_b32 v128, s53, 1
  v_mfma_f32_16x16x32_bf16 v[24:27], a[168:171], a[8:11], v[24:27]
  ds_read_b64_tr_b16 a[188:189], v227 offset:40960
  v_writelane_b32 v128, s54, 2
  v_mfma_f32_16x16x32_bf16 v[24:27], a[172:175], a[24:27], v[24:27]
  v_writelane_b32 v128, s55, 3
  v_writelane_b32 v128, s56, 4
  v_mfma_f32_16x16x32_bf16 v[28:31], a[172:175], a[28:31], v[28:31]
  ds_read_b64_tr_b16 a[190:191], v227 offset:41984
  v_writelane_b32 v128, s57, 5
  v_mfma_f32_16x16x32_bf16 v[28:31], a[168:171], a[12:15], v[28:31]
  s_waitcnt lgkmcnt(4)
  v_writelane_b32 v128, s58, 6
  v_writelane_b32 v128, s59, 7
  v_mfma_f32_16x16x32_bf16 v[32:35], a[176:179], a[0:3], v[32:35]
  ds_read_b64_tr_b16 a[160:161], v228 offset:32768
  v_and_b32 v129, 0xffff, v128
  v_mfma_f32_16x16x32_bf16 v[32:35], a[180:183], a[16:19], v[32:35]
  v_sub_u32 v129, 0xffff, v129
  v_and_b32 v129, 0x7ff, v129
  v_mfma_f32_16x16x32_bf16 v[36:39], a[180:183], a[20:23], v[36:39]
  ds_read_b64_tr_b16 a[162:163], v228 offset:33792
  v_mov_b32 v130, v129
  v_mfma_f32_16x16x32_bf16 v[36:39], a[176:179], a[4:7], v[36:39]
  v_mfma_f32_16x16x32_bf16 v[40:43], a[176:179], a[8:11], v[40:43]
  ds_read_b64_tr_b16 a[164:165], v228 offset:40960
  v_permlane16_swap_b32 v129, v130
  v_mfma_f32_16x16x32_bf16 v[40:43], a[180:183], a[24:27], v[40:43]
  buffer_load_dwordx4 v237, s[16:19], s29 offen offset:1024 lds
  v_mfma_f32_16x16x32_bf16 v[44:47], a[180:183], a[28:31], v[44:47]
  ds_read_b64_tr_b16 a[166:167], v228 offset:41984
  v_mov_b32 v130, v129
  v_mfma_f32_16x16x32_bf16 v[44:47], a[176:179], a[12:15], v[44:47]
  s_waitcnt lgkmcnt(4)
  v_permlane32_swap_b32 v129, v130
  v_lshrrev_b32 v130, 6, v129
  v_mfma_f32_16x16x32_bf16 v[48:51], a[184:187], a[0:3], v[48:51]
  ds_read_b64_tr_b16 a[168:169], v229 offset:32768
  v_mul_u32_u24 v130, 0x14000, v130
  v_mfma_f32_16x16x32_bf16 v[48:51], a[188:191], a[16:19], v[48:51]
  v_bfe_u32 v131, v129, 4, 2
  v_lshl_add_u32 v130, v131, 10, v130
  v_mfma_f32_16x16x32_bf16 v[52:55], a[188:191], a[20:23], v[52:55]
  ds_read_b64_tr_b16 a[170:171], v229 offset:33792
  v_and_b32 v131, 15, v129
  v_mfma_f32_16x16x32_bf16 v[52:55], a[184:187], a[4:7], v[52:55]
  v_lshl_add_u32 v130, v131, 4, v130
  v_lshrrev_b32 v131, 4, v136
  v_mfma_f32_16x16x32_bf16 v[56:59], a[184:187], a[8:11], v[56:59]
  ds_read_b64_tr_b16 a[172:173], v229 offset:40960
  v_lshl_add_u32 v243, v131, 8, v130
  v_mfma_f32_16x16x32_bf16 v[56:59], a[188:191], a[24:27], v[56:59]
  v_mfma_f32_16x16x32_bf16 v[60:63], a[188:191], a[28:31], v[60:63]
  ds_read_b64_tr_b16 a[174:175], v229 offset:41984
  v_mfma_f32_16x16x32_bf16 v[60:63], a[184:187], a[12:15], v[60:63]
  s_waitcnt lgkmcnt(4)
  v_mfma_f32_16x16x32_bf16 v[64:67], a[160:163], a[0:3], v[64:67]
  ds_read_b64_tr_b16 a[176:177], v230 offset:32768
  v_mfma_f32_16x16x32_bf16 v[64:67], a[164:167], a[16:19], v[64:67]
  v_mfma_f32_16x16x32_bf16 v[68:71], a[164:167], a[20:23], v[68:71]
  ds_read_b64_tr_b16 a[178:179], v230 offset:33792
  v_mfma_f32_16x16x32_bf16 v[68:71], a[160:163], a[4:7], v[68:71]
  v_mfma_f32_16x16x32_bf16 v[72:75], a[160:163], a[8:11], v[72:75]
  ds_read_b64_tr_b16 a[180:181], v230 offset:40960
  v_mfma_f32_16x16x32_bf16 v[72:75], a[164:167], a[24:27], v[72:75]
  buffer_load_dwordx4 v236, s[16:19], s29 offen offset:2048 lds
  v_mfma_f32_16x16x32_bf16 v[76:79], a[164:167], a[28:31], v[76:79]
  ds_read_b64_tr_b16 a[182:183], v230 offset:41984
  v_mfma_f32_16x16x32_bf16 v[76:79], a[160:163], a[12:15], v[76:79]
  s_waitcnt lgkmcnt(4)
  v_mfma_f32_16x16x32_bf16 v[80:83], a[168:171], a[0:3], v[80:83]
  ds_read_b64_tr_b16 a[184:185], v231 offset:32768
  v_mfma_f32_16x16x32_bf16 v[80:83], a[172:175], a[16:19], v[80:83]
  v_mfma_f32_16x16x32_bf16 v[84:87], a[172:175], a[20:23], v[84:87]
  ds_read_b64_tr_b16 a[186:187], v231 offset:33792
  v_mfma_f32_16x16x32_bf16 v[84:87], a[168:171], a[4:7], v[84:87]
  s_waitcnt vmcnt(8)
  v_mfma_f32_16x16x32_bf16 v[88:91], a[168:171], a[8:11], v[88:91]
  ds_read_b64_tr_b16 a[188:189], v231 offset:40960
  v_mfma_f32_16x16x32_bf16 v[88:91], a[172:175], a[24:27], v[88:91]
  s_barrier
  v_mfma_f32_16x16x32_bf16 v[92:95], a[172:175], a[28:31], v[92:95]
  ds_read_b64_tr_b16 a[190:191], v231 offset:41984
  v_mfma_f32_16x16x32_bf16 v[92:95], a[168:171], a[12:15], v[92:95]
  s_waitcnt lgkmcnt(4)
  v_mfma_f32_16x16x32_bf16 v[96:99], a[176:179], a[0:3], v[96:99]
  ds_read_b64_tr_b16 a[160:161], v224 offset:49152
  v_mfma_f32_16x16x32_bf16 v[96:99], a[180:183], a[16:19], v[96:99]
  v_mfma_f32_16x16x32_bf16 v[100:103], a[180:183], a[20:23], v[100:103]
  ds_read_b64_tr_b16 a[162:163], v224 offset:50176
  v_mfma_f32_16x16x32_bf16 v[100:103], a[176:179], a[4:7], v[100:103]
  v_mfma_f32_16x16x32_bf16 v[104:107], a[176:179], a[8:11], v[104:107]
  ds_read_b64_tr_b16 a[164:165], v224 offset:57344
  v_mfma_f32_16x16x32_bf16 v[104:107], a[180:183], a[24:27], v[104:107]
  buffer_load_dwordx4 v237, s[16:19], s29 offen offset:3072 lds
  s_add_u32 s29, s29, 16384
  v_mfma_f32_16x16x32_bf16 v[108:111], a[180:183], a[28:31], v[108:111]
  ds_read_b64_tr_b16 a[166:167], v224 offset:58368
  v_mfma_f32_16x16x32_bf16 v[108:111], a[176:179], a[12:15], v[108:111]
  s_waitcnt lgkmcnt(4)
  v_mfma_f32_16x16x32_bf16 v[112:115], a[184:187], a[0:3], v[112:115]
  ds_read_b64_tr_b16 a[168:169], v225 offset:49152
  v_mfma_f32_16x16x32_bf16 v[112:115], a[188:191], a[16:19], v[112:115]
  v_mfma_f32_16x16x32_bf16 v[116:119], a[188:191], a[20:23], v[116:119]
  ds_read_b64_tr_b16 a[170:171], v225 offset:50176
  v_mfma_f32_16x16x32_bf16 v[116:119], a[184:187], a[4:7], v[116:119]
  v_mfma_f32_16x16x32_bf16 v[120:123], a[184:187], a[8:11], v[120:123]
  ds_read_b64_tr_b16 a[172:173], v225 offset:57344
  v_mfma_f32_16x16x32_bf16 v[120:123], a[188:191], a[24:27], v[120:123]
  v_mfma_f32_16x16x32_bf16 v[124:127], a[188:191], a[28:31], v[124:127]
  ds_read_b64_tr_b16 a[174:175], v225 offset:58368
  v_mfma_f32_16x16x32_bf16 v[124:127], a[184:187], a[12:15], v[124:127]
  s_waitcnt vmcnt(8) lgkmcnt(4)
  v_mfma_f32_16x16x32_bf16 v[0:3], a[160:163], a[32:35], v[0:3]
  ds_read_b64_tr_b16 a[176:177], v226 offset:49152
  s_add_u32 m0, s28, 16384
  v_mfma_f32_16x16x32_bf16 v[0:3], a[164:167], a[48:51], v[0:3]
  buffer_load_dwordx4 v232, s[12:15], s29 offen offset:0 lds
  v_mfma_f32_16x16x32_bf16 v[4:7], a[164:167], a[52:55], v[4:7]
  ds_read_b64_tr_b16 a[178:179], v226 offset:50176
  v_mfma_f32_16x16x32_bf16 v[4:7], a[160:163], a[36:39], v[4:7]
  v_mfma_f32_16x16x32_bf16 v[8:11], a[160:163], a[40:43], v[8:11]
  ds_read_b64_tr_b16 a[180:181], v226 offset:57344
  v_mfma_f32_16x16x32_bf16 v[8:11], a[164:167], a[56:59], v[8:11]
  buffer_load_dwordx4 v233, s[12:15], s29 offen offset:1024 lds
  v_mfma_f32_16x16x32_bf16 v[12:15], a[164:167], a[60:63], v[12:15]
  ds_read_b64_tr_b16 a[182:183], v226 offset:58368
  v_mfma_f32_16x16x32_bf16 v[12:15], a[160:163], a[44:47], v[12:15]
  s_waitcnt lgkmcnt(4)
  v_mfma_f32_16x16x32_bf16 v[16:19], a[168:171], a[32:35], v[16:19]
  ds_read_b64_tr_b16 a[184:185], v227 offset:49152
  v_mfma_f32_16x16x32_bf16 v[16:19], a[172:175], a[48:51], v[16:19]
  buffer_load_dwordx4 v234, s[12:15], s29 offen offset:2048 lds
  v_mfma_f32_16x16x32_bf16 v[20:23], a[172:175], a[52:55], v[20:23]
  ds_read_b64_tr_b16 a[186:187], v227 offset:50176
  v_mfma_f32_16x16x32_bf16 v[20:23], a[168:171], a[36:39], v[20:23]
  buffer_load_dwordx4 v235, s[12:15], s29 offen offset:3072 lds
  v_mfma_f32_16x16x32_bf16 v[24:27], a[168:171], a[40:43], v[24:27]
  ds_read_b64_tr_b16 a[188:189], v227 offset:57344
  v_mfma_f32_16x16x32_bf16 v[24:27], a[172:175], a[56:59], v[24:27]
  v_mul_f32 v0, s34, v0
  v_mul_f32 v1, s34, v1
  v_mfma_f32_16x16x32_bf16 v[28:31], a[172:175], a[60:63], v[28:31]
  ds_read_b64_tr_b16 a[190:191], v227 offset:58368
  v_mul_f32 v2, s34, v2
  v_mfma_f32_16x16x32_bf16 v[28:31], a[168:171], a[44:47], v[28:31]
  s_waitcnt lgkmcnt(4)
  v_mul_f32 v3, s34, v3
  v_mul_f32 v16, s34, v16
  v_mfma_f32_16x16x32_bf16 v[32:35], a[176:179], a[32:35], v[32:35]
  ds_read_b64_tr_b16 a[160:161], v228 offset:49152
  v_mul_f32 v17, s34, v17
  v_mfma_f32_16x16x32_bf16 v[32:35], a[180:183], a[48:51], v[32:35]
  v_mul_f32 v18, s34, v18
  v_mul_f32 v19, s34, v19
  v_mfma_f32_16x16x32_bf16 v[36:39], a[180:183], a[52:55], v[36:39]
  ds_read_b64_tr_b16 a[162:163], v228 offset:50176
  v_cvt_pk_bf16_f32 v128, v0, v1
  v_mfma_f32_16x16x32_bf16 v[36:39], a[176:179], a[36:39], v[36:39]
  v_cvt_pk_bf16_f32 v129, v2, v3
  v_cvt_pk_bf16_f32 v130, v16, v17
  v_mfma_f32_16x16x32_bf16 v[40:43], a[176:179], a[40:43], v[40:43]
  ds_read_b64_tr_b16 a[164:165], v228 offset:57344
  v_cvt_pk_bf16_f32 v131, v18, v19
  v_mfma_f32_16x16x32_bf16 v[40:43], a[180:183], a[56:59], v[40:43]
  v_mul_f32 v4, s34, v4
  v_mul_f32 v5, s34, v5
  v_mfma_f32_16x16x32_bf16 v[44:47], a[180:183], a[60:63], v[44:47]
  ds_read_b64_tr_b16 a[166:167], v228 offset:58368
  v_mul_f32 v6, s34, v6
  v_mfma_f32_16x16x32_bf16 v[44:47], a[176:179], a[44:47], v[44:47]
  s_waitcnt lgkmcnt(4)
  v_mul_f32 v7, s34, v7
  v_mul_f32 v20, s34, v20
  v_mfma_f32_16x16x32_bf16 v[48:51], a[184:187], a[32:35], v[48:51]
  ds_read_b64_tr_b16 a[168:169], v229 offset:49152
  v_mul_f32 v21, s34, v21
  v_mfma_f32_16x16x32_bf16 v[48:51], a[188:191], a[48:51], v[48:51]
  v_mul_f32 v22, s34, v22
  v_mul_f32 v23, s34, v23
  v_mfma_f32_16x16x32_bf16 v[52:55], a[188:191], a[52:55], v[52:55]
  ds_read_b64_tr_b16 a[170:171], v229 offset:50176
  v_cvt_pk_bf16_f32 v144, v4, v5
  v_mfma_f32_16x16x32_bf16 v[52:55], a[184:187], a[36:39], v[52:55]
  v_cvt_pk_bf16_f32 v145, v6, v7
  v_cvt_pk_bf16_f32 v146, v20, v21
  v_mfma_f32_16x16x32_bf16 v[56:59], a[184:187], a[40:43], v[56:59]
  ds_read_b64_tr_b16 a[172:173], v229 offset:57344
  v_cvt_pk_bf16_f32 v147, v22, v23
  v_mfma_f32_16x16x32_bf16 v[56:59], a[188:191], a[56:59], v[56:59]
  v_permlane16_swap_b32 v128, v130
  v_permlane16_swap_b32 v129, v131
  v_mfma_f32_16x16x32_bf16 v[60:63], a[188:191], a[60:63], v[60:63]
  ds_read_b64_tr_b16 a[174:175], v229 offset:58368
  v_mul_f32 v8, s34, v8
  v_mfma_f32_16x16x32_bf16 v[60:63], a[184:187], a[44:47], v[60:63]
  s_waitcnt lgkmcnt(4)
  v_mul_f32 v9, s34, v9
  v_mul_f32 v10, s34, v10
  v_mfma_f32_16x16x32_bf16 v[64:67], a[160:163], a[32:35], v[64:67]
  ds_read_b64_tr_b16 a[176:177], v230 offset:49152
  v_mul_f32 v11, s34, v11
  v_mfma_f32_16x16x32_bf16 v[64:67], a[164:167], a[48:51], v[64:67]
  v_mul_f32 v24, s34, v24
  v_mul_f32 v25, s34, v25
  v_mfma_f32_16x16x32_bf16 v[68:71], a[164:167], a[52:55], v[68:71]
  ds_read_b64_tr_b16 a[178:179], v230 offset:50176
  v_mul_f32 v26, s34, v26
  v_mfma_f32_16x16x32_bf16 v[68:71], a[160:163], a[36:39], v[68:71]
  v_mul_f32 v27, s34, v27
  v_cvt_pk_bf16_f32 v160, v8, v9
  v_mfma_f32_16x16x32_bf16 v[72:75], a[160:163], a[40:43], v[72:75]
  ds_read_b64_tr_b16 a[180:181], v230 offset:57344
  v_cvt_pk_bf16_f32 v161, v10, v11
  v_mfma_f32_16x16x32_bf16 v[72:75], a[164:167], a[56:59], v[72:75]
  v_cvt_pk_bf16_f32 v162, v24, v25
  v_cvt_pk_bf16_f32 v163, v26, v27
  v_mfma_f32_16x16x32_bf16 v[76:79], a[164:167], a[60:63], v[76:79]
  ds_read_b64_tr_b16 a[182:183], v230 offset:58368
  v_permlane16_swap_b32 v144, v146
  v_mfma_f32_16x16x32_bf16 v[76:79], a[160:163], a[44:47], v[76:79]
  s_waitcnt lgkmcnt(4)
  v_permlane16_swap_b32 v145, v147
  v_mul_f32 v12, s34, v12
  v_mfma_f32_16x16x32_bf16 v[80:83], a[168:171], a[32:35], v[80:83]
  ds_read_b64_tr_b16 a[184:185], v231 offset:49152
  v_mul_f32 v13, s34, v13
  v_mfma_f32_16x16x32_bf16 v[80:83], a[172:175], a[48:51], v[80:83]
  v_mul_f32 v14, s34, v14
  v_mul_f32 v15, s34, v15
  v_mfma_f32_16x16x32_bf16 v[84:87], a[172:175], a[52:55], v[84:87]
  ds_read_b64_tr_b16 a[186:187], v231 offset:50176
  v_mul_f32 v28, s34, v28
  v_mfma_f32_16x16x32_bf16 v[84:87], a[168:171], a[36:39], v[84:87]
  s_waitcnt vmcnt(8)
  v_mul_f32 v29, s34, v29
  v_mul_f32 v30, s34, v30
  v_mfma_f32_16x16x32_bf16 v[88:91], a[168:171], a[40:43], v[88:91]
  ds_read_b64_tr_b16 a[188:189], v231 offset:57344
  v_mul_f32 v31, s34, v31
  v_mfma_f32_16x16x32_bf16 v[88:91], a[172:175], a[56:59], v[88:91]
  s_barrier
  v_cvt_pk_bf16_f32 v176, v12, v13
  v_cvt_pk_bf16_f32 v177, v14, v15
  v_mfma_f32_16x16x32_bf16 v[92:95], a[172:175], a[60:63], v[92:95]
  ds_read_b64_tr_b16 a[190:191], v231 offset:58368
  v_cvt_pk_bf16_f32 v178, v28, v29
  v_mfma_f32_16x16x32_bf16 v[92:95], a[168:171], a[44:47], v[92:95]
  s_waitcnt lgkmcnt(4)
  v_cvt_pk_bf16_f32 v179, v30, v31
  v_permlane16_swap_b32 v160, v162
  v_mfma_f32_16x16x32_bf16 v[96:99], a[176:179], a[32:35], v[96:99]
  ds_read_b128 a[128:131], v212 offset:0
  v_permlane16_swap_b32 v161, v163
  v_mfma_f32_16x16x32_bf16 v[96:99], a[180:183], a[48:51], v[96:99]
  v_mul_f32 v32, s34, v32
  v_mul_f32 v33, s34, v33
  v_mfma_f32_16x16x32_bf16 v[100:103], a[180:183], a[52:55], v[100:103]
  ds_read_b128 a[132:135], v213 offset:0
  v_mul_f32 v34, s34, v34
  v_mfma_f32_16x16x32_bf16 v[100:103], a[176:179], a[36:39], v[100:103]
  v_mul_f32 v35, s34, v35
  v_mul_f32 v48, s34, v48
  v_mfma_f32_16x16x32_bf16 v[104:107], a[176:179], a[40:43], v[104:107]
  ds_read_b128 a[136:139], v214 offset:0
  v_mul_f32 v49, s34, v49
  v_mfma_f32_16x16x32_bf16 v[104:107], a[180:183], a[56:59], v[104:107]
  v_mul_f32 v50, s34, v50
  v_mul_f32 v51, s34, v51
  v_mfma_f32_16x16x32_bf16 v[108:111], a[180:183], a[60:63], v[108:111]
  ds_read_b128 a[140:143], v215 offset:0
  v_cvt_pk_bf16_f32 v132, v32, v33
  v_mfma_f32_16x16x32_bf16 v[108:111], a[176:179], a[44:47], v[108:111]
  s_waitcnt lgkmcnt(4)
  v_cvt_pk_bf16_f32 v133, v34, v35
  v_cvt_pk_bf16_f32 v134, v48, v49
  v_mfma_f32_16x16x32_bf16 v[112:115], a[184:187], a[32:35], v[112:115]
  v_cvt_pk_bf16_f32 v135, v50, v51
  v_permlane16_swap_b32 v176, v178
  v_mfma_f32_16x16x32_bf16 v[112:115], a[188:191], a[48:51], v[112:115]
  v_permlane16_swap_b32 v177, v179
  v_mul_f32 v36, s34, v36
  v_mfma_f32_16x16x32_bf16 v[116:119], a[188:191], a[52:55], v[116:119]
  v_mul_f32 v37, s34, v37
  v_mul_f32 v38, s34, v38
  v_mfma_f32_16x16x32_bf16 v[116:119], a[184:187], a[36:39], v[116:119]
  v_mul_f32 v39, s34, v39
  v_mul_f32 v52, s34, v52
  v_mfma_f32_16x16x32_bf16 v[120:123], a[184:187], a[40:43], v[120:123]
  v_mul_f32 v53, s34, v53
  v_mul_f32 v54, s34, v54
  v_mfma_f32_16x16x32_bf16 v[120:123], a[188:191], a[56:59], v[120:123]
  v_mul_f32 v55, s34, v55
  v_cvt_pk_bf16_f32 v148, v36, v37
  v_mfma_f32_16x16x32_bf16 v[124:127], a[188:191], a[60:63], v[124:127]
  v_cvt_pk_bf16_f32 v149, v38, v39
  v_cvt_pk_bf16_f32 v150, v52, v53
  v_mfma_f32_16x16x32_bf16 v[124:127], a[184:187], a[44:47], v[124:127]
  s_waitcnt lgkmcnt(0)
  v_cvt_pk_bf16_f32 v151, v54, v55
  v_permlane16_swap_b32 v132, v134
  v_permlane16_swap_b32 v133, v135
  v_pk_mul_f32 v[40:41], v[40:41], s[34:35] op_sel_hi:[1,0]
  v_pk_mul_f32 v[42:43], v[42:43], s[34:35] op_sel_hi:[1,0]
  v_pk_mul_f32 v[56:57], v[56:57], s[34:35] op_sel_hi:[1,0]
  v_pk_mul_f32 v[58:59], v[58:59], s[34:35] op_sel_hi:[1,0]
  v_cvt_pk_bf16_f32 v164, v40, v41
  v_cvt_pk_bf16_f32 v165, v42, v43
  v_cvt_pk_bf16_f32 v166, v56, v57
  v_cvt_pk_bf16_f32 v167, v58, v59
  v_permlane16_swap_b32 v148, v150
  v_permlane16_swap_b32 v149, v151
  v_pk_mul_f32 v[44:45], v[44:45], s[34:35] op_sel_hi:[1,0]
  v_pk_mul_f32 v[46:47], v[46:47], s[34:35] op_sel_hi:[1,0]
  v_pk_mul_f32 v[60:61], v[60:61], s[34:35] op_sel_hi:[1,0]
  v_pk_mul_f32 v[62:63], v[62:63], s[34:35] op_sel_hi:[1,0]
  v_cvt_pk_bf16_f32 v180, v44, v45
  v_cvt_pk_bf16_f32 v181, v46, v47
  v_cvt_pk_bf16_f32 v182, v60, v61
  v_cvt_pk_bf16_f32 v183, v62, v63
  v_permlane16_swap_b32 v164, v166
  v_permlane16_swap_b32 v165, v167
  v_pk_mul_f32 v[64:65], v[64:65], s[34:35] op_sel_hi:[1,0]
  v_pk_mul_f32 v[66:67], v[66:67], s[34:35] op_sel_hi:[1,0]
  v_pk_mul_f32 v[80:81], v[80:81], s[34:35] op_sel_hi:[1,0]
  v_pk_mul_f32 v[82:83], v[82:83], s[34:35] op_sel_hi:[1,0]
  v_cvt_pk_bf16_f32 v136, v64, v65
  v_cvt_pk_bf16_f32 v137, v66, v67
  v_cvt_pk_bf16_f32 v138, v80, v81
  v_cvt_pk_bf16_f32 v139, v82, v83
  v_permlane16_swap_b32 v180, v182
  v_permlane16_swap_b32 v181, v183
  v_pk_mul_f32 v[68:69], v[68:69], s[34:35] op_sel_hi:[1,0]
  v_pk_mul_f32 v[70:71], v[70:71], s[34:35] op_sel_hi:[1,0]
  v_pk_mul_f32 v[84:85], v[84:85], s[34:35] op_sel_hi:[1,0]
  v_pk_mul_f32 v[86:87], v[86:87], s[34:35] op_sel_hi:[1,0]
  v_cvt_pk_bf16_f32 v152, v68, v69
  v_cvt_pk_bf16_f32 v153, v70, v71
  v_cvt_pk_bf16_f32 v154, v84, v85
  v_cvt_pk_bf16_f32 v155, v86, v87
  v_permlane16_swap_b32 v136, v138
  v_permlane16_swap_b32 v137, v139
  v_pk_mul_f32 v[72:73], v[72:73], s[34:35] op_sel_hi:[1,0]
  v_pk_mul_f32 v[74:75], v[74:75], s[34:35] op_sel_hi:[1,0]
  v_pk_mul_f32 v[88:89], v[88:89], s[34:35] op_sel_hi:[1,0]
  v_pk_mul_f32 v[90:91], v[90:91], s[34:35] op_sel_hi:[1,0]
  v_cvt_pk_bf16_f32 v168, v72, v73
  v_cvt_pk_bf16_f32 v169, v74, v75
  v_cvt_pk_bf16_f32 v170, v88, v89
  v_cvt_pk_bf16_f32 v171, v90, v91
  v_permlane16_swap_b32 v152, v154
  v_permlane16_swap_b32 v153, v155
  v_pk_mul_f32 v[76:77], v[76:77], s[34:35] op_sel_hi:[1,0]
  v_pk_mul_f32 v[78:79], v[78:79], s[34:35] op_sel_hi:[1,0]
  v_pk_mul_f32 v[92:93], v[92:93], s[34:35] op_sel_hi:[1,0]
  v_pk_mul_f32 v[94:95], v[94:95], s[34:35] op_sel_hi:[1,0]
  v_cvt_pk_bf16_f32 v184, v76, v77
  v_cvt_pk_bf16_f32 v185, v78, v79
  v_cvt_pk_bf16_f32 v186, v92, v93
  v_cvt_pk_bf16_f32 v187, v94, v95
  v_permlane16_swap_b32 v168, v170
  v_permlane16_swap_b32 v169, v171
  v_pk_mul_f32 v[96:97], v[96:97], s[34:35] op_sel_hi:[1,0]
  v_pk_mul_f32 v[98:99], v[98:99], s[34:35] op_sel_hi:[1,0]
  v_pk_mul_f32 v[112:113], v[112:113], s[34:35] op_sel_hi:[1,0]
  v_pk_mul_f32 v[114:115], v[114:115], s[34:35] op_sel_hi:[1,0]
  v_cvt_pk_bf16_f32 v140, v96, v97
  v_cvt_pk_bf16_f32 v141, v98, v99
  v_cvt_pk_bf16_f32 v142, v112, v113
  v_cvt_pk_bf16_f32 v143, v114, v115
  v_permlane16_swap_b32 v184, v186
  v_permlane16_swap_b32 v185, v187
  v_pk_mul_f32 v[100:101], v[100:101], s[34:35] op_sel_hi:[1,0]
  v_pk_mul_f32 v[102:103], v[102:103], s[34:35] op_sel_hi:[1,0]
  v_pk_mul_f32 v[116:117], v[116:117], s[34:35] op_sel_hi:[1,0]
  v_pk_mul_f32 v[118:119], v[118:119], s[34:35] op_sel_hi:[1,0]
  v_cvt_pk_bf16_f32 v156, v100, v101
  v_cvt_pk_bf16_f32 v157, v102, v103
  v_cvt_pk_bf16_f32 v158, v116, v117
  v_cvt_pk_bf16_f32 v159, v118, v119
  v_permlane16_swap_b32 v140, v142
  v_permlane16_swap_b32 v141, v143
  v_pk_mul_f32 v[104:105], v[104:105], s[34:35] op_sel_hi:[1,0]
  v_pk_mul_f32 v[106:107], v[106:107], s[34:35] op_sel_hi:[1,0]
  v_pk_mul_f32 v[120:121], v[120:121], s[34:35] op_sel_hi:[1,0]
  v_pk_mul_f32 v[122:123], v[122:123], s[34:35] op_sel_hi:[1,0]
  v_cvt_pk_bf16_f32 v172, v104, v105
  v_cvt_pk_bf16_f32 v173, v106, v107
  v_cvt_pk_bf16_f32 v174, v120, v121
  v_cvt_pk_bf16_f32 v175, v122, v123
  v_permlane16_swap_b32 v156, v158
  v_permlane16_swap_b32 v157, v159
  v_pk_mul_f32 v[108:109], v[108:109], s[34:35] op_sel_hi:[1,0]
  v_pk_mul_f32 v[110:111], v[110:111], s[34:35] op_sel_hi:[1,0]
  v_pk_mul_f32 v[124:125], v[124:125], s[34:35] op_sel_hi:[1,0]
  v_pk_mul_f32 v[126:127], v[126:127], s[34:35] op_sel_hi:[1,0]
  v_cvt_pk_bf16_f32 v188, v108, v109
  v_cvt_pk_bf16_f32 v189, v110, v111
  v_cvt_pk_bf16_f32 v190, v124, v125
  v_cvt_pk_bf16_f32 v191, v126, v127
  v_permlane16_swap_b32 v172, v174
  v_permlane16_swap_b32 v173, v175
  v_permlane16_swap_b32 v188, v190
  v_permlane16_swap_b32 v189, v191
  v_mfma_f32_16x16x32_bf16 v[0:3], a[128:131], v[128:131], 0
  s_add_u32 m0, s28, 81920
  ds_read_b128 a[144:147], v212 offset:4096
  s_mov_b32 s20, s90
  s_mov_b32 s21, s91
  v_mfma_f32_16x16x32_bf16 v[0:3], a[132:135], v[132:135], v[0:3]
  buffer_load_dwordx4 v236, s[16:19], s29 offen offset:0 lds
  s_mov_b32 s22, 2211840
  s_mov_b32 s23, 0x20000
  s_mov_b32 s44, s92
  v_mfma_f32_16x16x32_bf16 v[0:3], a[136:139], v[136:139], v[0:3]
  ds_read_b128 a[148:151], v213 offset:4096
  s_mov_b32 s45, s93
  s_mov_b32 s46, 2211840
  s_mov_b32 s47, 0x20000
  v_lshrrev_b32 v253, 4, v242
  v_mfma_f32_16x16x32_bf16 v[0:3], a[140:143], v[140:143], v[0:3]
  buffer_load_dwordx4 v237, s[16:19], s29 offen offset:1024 lds
  v_mfma_f32_16x16x32_bf16 v[8:11], a[140:143], v[156:159], 0
  ds_read_b128 a[152:155], v214 offset:4096
  v_mul_u32_u24 v253, 0xd80, v253
  v_mfma_f32_16x16x32_bf16 v[8:11], a[136:139], v[152:155], v[8:11]
  buffer_load_dwordx4 v236, s[16:19], s29 offen offset:2048 lds
  s_mul_i32 s35, s3, 552960
  s_lshl_b32 s38, s33, 4
  s_add_u32 s35, s35, s38
  v_mfma_f32_16x16x32_bf16 v[8:11], a[132:135], v[148:151], v[8:11]
  ds_read_b128 a[156:159], v215 offset:4096
  v_mfma_f32_16x16x32_bf16 v[8:11], a[128:131], v[144:147], v[8:11]
  buffer_load_dwordx4 v237, s[16:19], s29 offen offset:3072 lds
  v_mfma_f32_16x16x32_bf16 v[16:19], a[128:131], v[160:163], 0
  s_add_u32 s29, s29, 16384
  s_add_u32 m0, s28, 32768
  v_mfma_f32_16x16x32_bf16 v[16:19], a[132:135], v[164:167], v[16:19]
  buffer_load_dwordx4 v232, s[12:15], s29 offen offset:0 lds
  v_mfma_f32_16x16x32_bf16 v[16:19], a[136:139], v[168:171], v[16:19]
  buffer_load_dwordx4 v233, s[12:15], s29 offen offset:1024 lds
  v_mfma_f32_16x16x32_bf16 v[16:19], a[140:143], v[172:175], v[16:19]
  v_max3_f32 v192, v0, v1, v2
  v_max3_f32 v196, v8, v9, v10
  v_mfma_f32_16x16x32_bf16 v[24:27], a[140:143], v[188:191], 0
  v_max_f32 v192, v192, v3
  v_max_f32 v196, v196, v11
  v_mfma_f32_16x16x32_bf16 v[24:27], a[136:139], v[184:187], v[24:27]
  v_mov_b32 v245, v192
  v_mov_b32 v246, v196
  v_mfma_f32_16x16x32_bf16 v[24:27], a[132:135], v[180:183], v[24:27]
  v_permlane16_swap_b32 v192, v245
  v_permlane16_swap_b32 v196, v246
  v_mfma_f32_16x16x32_bf16 v[24:27], a[128:131], v[176:179], v[24:27]
  s_waitcnt lgkmcnt(0)
  v_max_f32 v192, v192, v245
  v_max_f32 v196, v196, v246
  v_mfma_f32_16x16x32_bf16 v[4:7], a[144:147], v[128:131], 0
  ds_read_b128 a[128:131], v212 offset:8192
  v_mov_b32 v245, v192
  v_mfma_f32_16x16x32_bf16 v[4:7], a[148:151], v[132:135], v[4:7]
  v_mov_b32 v246, v196
  v_permlane32_swap_b32 v192, v245
  v_mfma_f32_16x16x32_bf16 v[4:7], a[152:155], v[136:139], v[4:7]
  ds_read_b128 a[132:135], v213 offset:8192
  v_permlane32_swap_b32 v196, v246
  v_mfma_f32_16x16x32_bf16 v[4:7], a[156:159], v[140:143], v[4:7]
  v_max_f32 v192, v192, v245
  v_max_f32 v196, v196, v246
  v_mfma_f32_16x16x32_bf16 v[12:15], a[156:159], v[156:159], 0
  ds_read_b128 a[136:139], v214 offset:8192
  v_sub_f32 v193, 0, v192
  v_mfma_f32_16x16x32_bf16 v[12:15], a[152:155], v[152:155], v[12:15]
  v_sub_f32 v197, 0, v196
  v_sub_f32 v194, 0, v192
  v_mfma_f32_16x16x32_bf16 v[12:15], a[148:151], v[148:151], v[12:15]
  ds_read_b128 a[140:143], v215 offset:8192
  v_sub_f32 v198, 0, v196
  v_mfma_f32_16x16x32_bf16 v[12:15], a[144:147], v[144:147], v[12:15]
  v_sub_f32 v195, 0, v192
  v_sub_f32 v199, 0, v196
  v_mfma_f32_16x16x32_bf16 v[20:23], a[144:147], v[160:163], 0
  buffer_load_dwordx4 v234, s[12:15], s29 offen offset:2048 lds
  v_mfma_f32_16x16x32_bf16 v[20:23], a[148:151], v[164:167], v[20:23]
  v_sub_f32 v192, 0, v192
  v_sub_f32 v196, 0, v196
  v_mfma_f32_16x16x32_bf16 v[20:23], a[152:155], v[168:171], v[20:23]
  buffer_load_dwordx4 v235, s[12:15], s29 offen offset:3072 lds
  v_mfma_f32_16x16x32_bf16 v[20:23], a[156:159], v[172:175], v[20:23]
  v_max3_f32 v200, v16, v17, v18
  v_max3_f32 v204, v24, v25, v26
  v_mfma_f32_16x16x32_bf16 v[28:31], a[156:159], v[188:191], 0
  v_max_f32 v200, v200, v19
  v_max_f32 v204, v204, v27
  v_mfma_f32_16x16x32_bf16 v[28:31], a[152:155], v[184:187], v[28:31]
  v_mov_b32 v247, v200
  v_mov_b32 v248, v204
  v_mfma_f32_16x16x32_bf16 v[28:31], a[148:151], v[180:183], v[28:31]
  v_permlane16_swap_b32 v200, v247
  v_permlane16_swap_b32 v204, v248
  v_max_f32 v200, v200, v247
  v_max_f32 v204, v204, v248
  v_mov_b32 v247, v200
  v_mov_b32 v248, v204
  s_nop 0
  v_permlane32_swap_b32 v200, v247
  v_permlane32_swap_b32 v204, v248
  v_max_f32 v200, v200, v247
  v_max_f32 v204, v204, v248
  v_sub_f32 v201, 0, v200
  v_sub_f32 v205, 0, v204
  v_sub_f32 v202, 0, v200
  v_sub_f32 v206, 0, v204
  v_sub_f32 v203, 0, v200
  v_sub_f32 v207, 0, v204
  v_sub_f32 v200, 0, v200
  v_sub_f32 v204, 0, v204
  v_mfma_f32_16x16x32_bf16 v[28:31], a[144:147], v[176:179], v[28:31]
  s_waitcnt lgkmcnt(0)
  v_add_f32 v0, v192, v0
  v_add_f32 v1, v192, v1
  v_mfma_f32_16x16x32_bf16 v[32:35], a[128:131], v[128:131], v[192:195]
  ds_read_b128 a[144:147], v212 offset:12288
  v_add_f32 v2, v192, v2
  v_mfma_f32_16x16x32_bf16 v[32:35], a[132:135], v[132:135], v[32:35]
  v_add_f32 v3, v192, v3
  v_mfma_f32_16x16x32_bf16 v[32:35], a[136:139], v[136:139], v[32:35]
  ds_read_b128 a[148:151], v213 offset:12288
  v_mfma_f32_16x16x32_bf16 v[32:35], a[140:143], v[140:143], v[32:35]
  v_exp_f32 v0, v0
  v_mfma_f32_16x16x32_bf16 v[40:43], a[140:143], v[156:159], v[196:199]
  ds_read_b128 a[152:155], v214 offset:12288
  v_mfma_f32_16x16x32_bf16 v[40:43], a[136:139], v[152:155], v[40:43]
  v_exp_f32 v1, v1
  v_mfma_f32_16x16x32_bf16 v[40:43], a[132:135], v[148:151], v[40:43]
  ds_read_b128 a[156:159], v215 offset:12288
  v_mfma_f32_16x16x32_bf16 v[40:43], a[128:131], v[144:147], v[40:43]
  v_exp_f32 v2, v2
  v_mfma_f32_16x16x32_bf16 v[48:51], a[128:131], v[160:163], v[200:203]
  s_add_u32 m0, s50, 0
  v_cvt_pk_bf16_f32 v0, v0, v1
  v_mfma_f32_16x16x32_bf16 v[48:51], a[132:135], v[164:167], v[48:51]
  v_exp_f32 v3, v3
  v_mfma_f32_16x16x32_bf16 v[48:51], a[136:139], v[168:171], v[48:51]
  v_add_f32 v8, v196, v8
  v_add_f32 v9, v196, v9
  v_mfma_f32_16x16x32_bf16 v[48:51], a[140:143], v[172:175], v[48:51]
  v_add_f32 v10, v196, v10
  v_add_f32 v11, v196, v11
  v_mfma_f32_16x16x32_bf16 v[56:59], a[140:143], v[188:191], v[204:207]
  v_exp_f32 v8, v8
  v_mfma_f32_16x16x32_bf16 v[56:59], a[136:139], v[184:187], v[56:59]
  v_exp_f32 v9, v9
  buffer_load_dwordx4 v253, s[20:23], s35 offen lds
  v_mfma_f32_16x16x32_bf16 v[56:59], a[132:135], v[180:183], v[56:59]
  v_exp_f32 v10, v10
  v_mfma_f32_16x16x32_bf16 v[56:59], a[128:131], v[176:179], v[56:59]
  s_waitcnt lgkmcnt(0)
  v_cvt_pk_bf16_f32 v8, v8, v9
  v_mfma_f32_16x16x32_bf16 v[36:39], a[144:147], v[128:131], v[192:195]
  s_waitcnt vmcnt(9)
  v_exp_f32 v11, v11
  v_mfma_f32_16x16x32_bf16 v[36:39], a[148:151], v[132:135], v[36:39]
  s_barrier
  v_cvt_pk_bf16_f32 v1, v2, v3
  v_add_f32 v16, v200, v16
  v_mfma_f32_16x16x32_bf16 v[36:39], a[152:155], v[136:139], v[36:39]
  ds_read_b128 a[128:131], v212 offset:16384
  v_add_f32 v17, v200, v17
  v_mfma_f32_16x16x32_bf16 v[36:39], a[156:159], v[140:143], v[36:39]
  v_add_f32 v18, v200, v18
  v_add_f32 v19, v200, v19
  v_mfma_f32_16x16x32_bf16 v[44:47], a[156:159], v[156:159], v[196:199]
  ds_read_b128 a[132:135], v213 offset:16384
  v_mfma_f32_16x16x32_bf16 v[44:47], a[152:155], v[152:155], v[44:47]
  v_exp_f32 v16, v16
  v_mfma_f32_16x16x32_bf16 v[44:47], a[148:151], v[148:151], v[44:47]
  ds_read_b128 a[136:139], v214 offset:16384
  v_mfma_f32_16x16x32_bf16 v[44:47], a[144:147], v[144:147], v[44:47]
  v_exp_f32 v17, v17
  v_mfma_f32_16x16x32_bf16 v[52:55], a[144:147], v[160:163], v[200:203]
  ds_read_b128 a[140:143], v215 offset:16384
  v_mfma_f32_16x16x32_bf16 v[52:55], a[148:151], v[164:167], v[52:55]
  v_exp_f32 v18, v18
  v_mfma_f32_16x16x32_bf16 v[52:55], a[152:155], v[168:171], v[52:55]
  v_cvt_pk_bf16_f32 v16, v16, v17
  v_mfma_f32_16x16x32_bf16 v[52:55], a[156:159], v[172:175], v[52:55]
  v_exp_f32 v19, v19
  v_mfma_f32_16x16x32_bf16 v[60:63], a[156:159], v[188:191], v[204:207]
  v_cvt_pk_bf16_f32 v9, v10, v11
  v_add_f32 v24, v204, v24
  v_mfma_f32_16x16x32_bf16 v[60:63], a[152:155], v[184:187], v[60:63]
  v_add_f32 v25, v204, v25
  v_add_f32 v26, v204, v26
  v_mfma_f32_16x16x32_bf16 v[60:63], a[148:151], v[180:183], v[60:63]
  v_add_f32 v27, v204, v27
  v_mfma_f32_16x16x32_bf16 v[60:63], a[144:147], v[176:179], v[60:63]
  s_waitcnt lgkmcnt(0)
  v_exp_f32 v24, v24
  v_exp_f32 v25, v25
  v_exp_f32 v26, v26
  v_cvt_pk_bf16_f32 v24, v24, v25
  v_exp_f32 v27, v27
  v_cvt_pk_bf16_f32 v17, v18, v19
  v_add_f32 v4, v192, v4
  v_add_f32 v5, v192, v5
  v_add_f32 v6, v192, v6
  v_add_f32 v7, v192, v7
  v_exp_f32 v4, v4
  v_exp_f32 v5, v5
  v_exp_f32 v6, v6
  v_cvt_pk_bf16_f32 v2, v4, v5
  v_exp_f32 v7, v7
  v_cvt_pk_bf16_f32 v25, v26, v27
  v_add_f32 v12, v196, v12
  v_add_f32 v13, v196, v13
  v_add_f32 v14, v196, v14
  v_add_f32 v15, v196, v15
  v_exp_f32 v12, v12
  v_exp_f32 v13, v13
  v_exp_f32 v14, v14
  v_cvt_pk_bf16_f32 v10, v12, v13
  v_exp_f32 v15, v15
  v_cvt_pk_bf16_f32 v3, v6, v7
  v_add_f32 v20, v200, v20
  v_add_f32 v21, v200, v21
  v_add_f32 v22, v200, v22
  v_add_f32 v23, v200, v23
  v_exp_f32 v20, v20
  v_exp_f32 v21, v21
  v_exp_f32 v22, v22
  v_cvt_pk_bf16_f32 v18, v20, v21
  v_exp_f32 v23, v23
  v_cvt_pk_bf16_f32 v11, v14, v15
  v_add_f32 v28, v204, v28
  v_add_f32 v29, v204, v29
  v_add_f32 v30, v204, v30
  v_add_f32 v31, v204, v31
  v_exp_f32 v28, v28
  v_exp_f32 v29, v29
  v_exp_f32 v30, v30
  v_cvt_pk_bf16_f32 v26, v28, v29
  v_exp_f32 v31, v31
  v_cvt_pk_bf16_f32 v19, v22, v23
  v_exp_f32 v32, v32
  v_exp_f32 v33, v33
  v_exp_f32 v34, v34
  v_cvt_pk_bf16_f32 v32, v32, v33
  v_exp_f32 v35, v35
  v_cvt_pk_bf16_f32 v27, v30, v31
  v_exp_f32 v40, v40
  v_exp_f32 v41, v41
  v_exp_f32 v42, v42
  v_cvt_pk_bf16_f32 v40, v40, v41
  v_exp_f32 v43, v43
  v_cvt_pk_bf16_f32 v33, v34, v35
  v_exp_f32 v48, v48
  v_exp_f32 v49, v49
  v_exp_f32 v50, v50
  v_cvt_pk_bf16_f32 v48, v48, v49
  v_exp_f32 v51, v51
  v_cvt_pk_bf16_f32 v41, v42, v43
  v_exp_f32 v56, v56
  v_exp_f32 v57, v57
  v_exp_f32 v58, v58
  v_cvt_pk_bf16_f32 v56, v56, v57
  v_exp_f32 v59, v59
  v_cvt_pk_bf16_f32 v49, v50, v51
  v_exp_f32 v36, v36
  v_exp_f32 v37, v37
  v_exp_f32 v38, v38
  v_cvt_pk_bf16_f32 v34, v36, v37
  v_exp_f32 v39, v39
  v_cvt_pk_bf16_f32 v57, v58, v59
  v_exp_f32 v44, v44
  v_exp_f32 v45, v45
  v_exp_f32 v46, v46
  v_cvt_pk_bf16_f32 v42, v44, v45
  v_exp_f32 v47, v47
  v_cvt_pk_bf16_f32 v35, v38, v39
  v_exp_f32 v52, v52
  v_exp_f32 v53, v53
  v_exp_f32 v54, v54
  v_cvt_pk_bf16_f32 v50, v52, v53
  v_exp_f32 v55, v55
  v_cvt_pk_bf16_f32 v43, v46, v47
  v_exp_f32 v60, v60
  v_exp_f32 v61, v61
  v_exp_f32 v62, v62
  v_cvt_pk_bf16_f32 v58, v60, v61
  v_exp_f32 v63, v63
  v_cvt_pk_bf16_f32 v51, v54, v55
  v_cvt_pk_bf16_f32 v59, v62, v63
  v_mfma_f32_16x16x32_bf16 v[64:67], a[128:131], v[128:131], v[192:195]
  s_add_u32 m0, s28, 98304
  v_mfma_f32_16x16x32_bf16 v[64:67], a[132:135], v[132:135], v[64:67]
  ds_read_b128 a[144:147], v212 offset:20480
  v_mfma_f32_16x16x32_bf16 v[64:67], a[136:139], v[136:139], v[64:67]
  buffer_load_dwordx4 v236, s[16:19], s29 offen offset:0 lds
  v_mfma_f32_16x16x32_bf16 v[64:67], a[140:143], v[140:143], v[64:67]
  ds_read_b128 a[148:151], v213 offset:20480
  v_mfma_f32_16x16x32_bf16 v[72:75], a[140:143], v[156:159], v[196:199]
  v_mfma_f32_16x16x32_bf16 v[72:75], a[136:139], v[152:155], v[72:75]
  ds_read_b128 a[152:155], v214 offset:20480
  v_mfma_f32_16x16x32_bf16 v[72:75], a[132:135], v[148:151], v[72:75]
  buffer_load_dwordx4 v237, s[16:19], s29 offen offset:1024 lds
  v_mfma_f32_16x16x32_bf16 v[72:75], a[128:131], v[144:147], v[72:75]
  ds_read_b128 a[156:159], v215 offset:20480
  v_mfma_f32_16x16x32_bf16 v[80:83], a[128:131], v[160:163], v[200:203]
  v_exp_f32 v64, v64
  v_mfma_f32_16x16x32_bf16 v[80:83], a[132:135], v[164:167], v[80:83]
  v_mfma_f32_16x16x32_bf16 v[80:83], a[136:139], v[168:171], v[80:83]
  v_exp_f32 v65, v65
  v_mfma_f32_16x16x32_bf16 v[80:83], a[140:143], v[172:175], v[80:83]
  v_cvt_pk_bf16_f32 v64, v64, v65
  v_mfma_f32_16x16x32_bf16 v[88:91], a[140:143], v[188:191], v[204:207]
  v_exp_f32 v66, v66
  v_mfma_f32_16x16x32_bf16 v[88:91], a[136:139], v[184:187], v[88:91]
  buffer_load_dwordx4 v236, s[16:19], s29 offen offset:2048 lds
  v_mfma_f32_16x16x32_bf16 v[88:91], a[132:135], v[180:183], v[88:91]
  s_waitcnt lgkmcnt(0)
  v_exp_f32 v67, v67
  v_mfma_f32_16x16x32_bf16 v[88:91], a[128:131], v[176:179], v[88:91]
  v_cvt_pk_bf16_f32 v65, v66, v67
  v_mfma_f32_16x16x32_bf16 v[68:71], a[144:147], v[128:131], v[192:195]
  v_exp_f32 v72, v72
  v_mfma_f32_16x16x32_bf16 v[68:71], a[148:151], v[132:135], v[68:71]
  ds_read_b128 a[128:131], v212 offset:24576
  v_mfma_f32_16x16x32_bf16 v[68:71], a[152:155], v[136:139], v[68:71]
  v_exp_f32 v73, v73
  v_mfma_f32_16x16x32_bf16 v[68:71], a[156:159], v[140:143], v[68:71]
  ds_read_b128 a[132:135], v213 offset:24576
  v_cvt_pk_bf16_f32 v72, v72, v73
  v_mfma_f32_16x16x32_bf16 v[76:79], a[156:159], v[156:159], v[196:199]
  v_exp_f32 v74, v74
  v_mfma_f32_16x16x32_bf16 v[76:79], a[152:155], v[152:155], v[76:79]
  ds_read_b128 a[136:139], v214 offset:24576
  v_mfma_f32_16x16x32_bf16 v[76:79], a[148:151], v[148:151], v[76:79]
  v_exp_f32 v75, v75
  v_mfma_f32_16x16x32_bf16 v[76:79], a[144:147], v[144:147], v[76:79]
  ds_read_b128 a[140:143], v215 offset:24576
  v_cvt_pk_bf16_f32 v73, v74, v75
  v_mfma_f32_16x16x32_bf16 v[84:87], a[144:147], v[160:163], v[200:203]
  v_exp_f32 v80, v80
  v_mfma_f32_16x16x32_bf16 v[84:87], a[148:151], v[164:167], v[84:87]
  buffer_load_dwordx4 v237, s[16:19], s29 offen offset:3072 lds
  v_mfma_f32_16x16x32_bf16 v[84:87], a[152:155], v[168:171], v[84:87]
  s_add_u32 s29, s29, 16384
  v_exp_f32 v81, v81
  v_mfma_f32_16x16x32_bf16 v[84:87], a[156:159], v[172:175], v[84:87]
  v_cvt_pk_bf16_f32 v80, v80, v81
  v_mfma_f32_16x16x32_bf16 v[92:95], a[156:159], v[188:191], v[204:207]
  s_add_u32 m0, s28, 49152
  v_exp_f32 v82, v82
  v_mfma_f32_16x16x32_bf16 v[92:95], a[152:155], v[184:187], v[92:95]
  buffer_load_dwordx4 v232, s[12:15], s29 offen offset:0 lds
  v_mfma_f32_16x16x32_bf16 v[92:95], a[148:151], v[180:183], v[92:95]
  s_waitcnt lgkmcnt(0)
  v_exp_f32 v83, v83
  v_mfma_f32_16x16x32_bf16 v[92:95], a[144:147], v[176:179], v[92:95]
  v_cvt_pk_bf16_f32 v81, v82, v83
  v_mfma_f32_16x16x32_bf16 v[96:99], a[128:131], v[128:131], v[192:195]
  v_exp_f32 v88, v88
  v_mfma_f32_16x16x32_bf16 v[96:99], a[132:135], v[132:135], v[96:99]
  ds_read_b128 a[144:147], v212 offset:28672
  v_mfma_f32_16x16x32_bf16 v[96:99], a[136:139], v[136:139], v[96:99]
  v_exp_f32 v89, v89
  v_mfma_f32_16x16x32_bf16 v[96:99], a[140:143], v[140:143], v[96:99]
  ds_read_b128 a[148:151], v213 offset:28672
  v_cvt_pk_bf16_f32 v88, v88, v89
  v_mfma_f32_16x16x32_bf16 v[104:107], a[140:143], v[156:159], v[196:199]
  v_exp_f32 v90, v90
  v_mfma_f32_16x16x32_bf16 v[104:107], a[136:139], v[152:155], v[104:107]
  ds_read_b128 a[152:155], v214 offset:28672
  v_mfma_f32_16x16x32_bf16 v[104:107], a[132:135], v[148:151], v[104:107]
  v_exp_f32 v91, v91
  v_mfma_f32_16x16x32_bf16 v[104:107], a[128:131], v[144:147], v[104:107]
  ds_read_b128 a[156:159], v215 offset:28672
  v_cvt_pk_bf16_f32 v89, v90, v91
  v_mfma_f32_16x16x32_bf16 v[112:115], a[128:131], v[160:163], v[200:203]
  v_exp_f32 v68, v68
  v_mfma_f32_16x16x32_bf16 v[112:115], a[132:135], v[164:167], v[112:115]
  buffer_load_dwordx4 v233, s[12:15], s29 offen offset:1024 lds
  v_mfma_f32_16x16x32_bf16 v[112:115], a[136:139], v[168:171], v[112:115]
  v_exp_f32 v69, v69
  v_mfma_f32_16x16x32_bf16 v[112:115], a[140:143], v[172:175], v[112:115]
  v_cvt_pk_bf16_f32 v66, v68, v69
  v_mfma_f32_16x16x32_bf16 v[120:123], a[140:143], v[188:191], v[204:207]
  v_exp_f32 v70, v70
  v_mfma_f32_16x16x32_bf16 v[120:123], a[136:139], v[184:187], v[120:123]
  buffer_load_dwordx4 v234, s[12:15], s29 offen offset:2048 lds
  v_mfma_f32_16x16x32_bf16 v[120:123], a[132:135], v[180:183], v[120:123]
  s_waitcnt lgkmcnt(0)
  v_exp_f32 v71, v71
  v_mfma_f32_16x16x32_bf16 v[120:123], a[128:131], v[176:179], v[120:123]
  v_cvt_pk_bf16_f32 v67, v70, v71
  v_mfma_f32_16x16x32_bf16 v[100:103], a[144:147], v[128:131], v[192:195]
  v_exp_f32 v76, v76
  v_mfma_f32_16x16x32_bf16 v[100:103], a[148:151], v[132:135], v[100:103]
  ds_read_b64_tr_b16 a[160:161], v216 offset:0
  v_mfma_f32_16x16x32_bf16 v[100:103], a[152:155], v[136:139], v[100:103]
  v_exp_f32 v77, v77
  v_mfma_f32_16x16x32_bf16 v[100:103], a[156:159], v[140:143], v[100:103]
  ds_read_b64_tr_b16 a[162:163], v216 offset:4096
  v_cvt_pk_bf16_f32 v74, v76, v77
  v_mfma_f32_16x16x32_bf16 v[108:111], a[156:159], v[156:159], v[196:199]
  v_exp_f32 v78, v78
  v_mfma_f32_16x16x32_bf16 v[108:111], a[152:155], v[152:155], v[108:111]
  ds_read_b64_tr_b16 a[164:165], v216 offset:8192
  buffer_load_dwordx4 v235, s[12:15], s29 offen offset:3072 lds
  v_mfma_f32_16x16x32_bf16 v[108:111], a[148:151], v[148:151], v[108:111]
  v_exp_f32 v79, v79
  v_mfma_f32_16x16x32_bf16 v[108:111], a[144:147], v[144:147], v[108:111]
  ds_read_b64_tr_b16 a[166:167], v216 offset:12288
  v_cvt_pk_bf16_f32 v75, v78, v79
  v_mfma_f32_16x16x32_bf16 v[116:119], a[144:147], v[160:163], v[200:203]
  v_exp_f32 v84, v84
  v_mfma_f32_16x16x32_bf16 v[116:119], a[148:151], v[164:167], v[116:119]
  ds_read_b64_tr_b16 a[168:169], v217 offset:0
  s_add_u32 m0, s50, 3072
  v_mfma_f32_16x16x32_bf16 v[116:119], a[152:155], v[168:171], v[116:119]
  v_exp_f32 v85, v85
  v_mfma_f32_16x16x32_bf16 v[116:119], a[156:159], v[172:175], v[116:119]
  ds_read_b64_tr_b16 a[170:171], v217 offset:4096
  v_cvt_pk_bf16_f32 v82, v84, v85
  v_mfma_f32_16x16x32_bf16 v[124:127], a[156:159], v[188:191], v[204:207]
  v_exp_f32 v86, v86
  v_mfma_f32_16x16x32_bf16 v[124:127], a[152:155], v[184:187], v[124:127]
  ds_read_b64_tr_b16 a[172:173], v217 offset:8192
  buffer_load_dwordx4 v253, s[44:47], s35 offen lds
  s_add_u32 s35, s35, 221184
  v_mfma_f32_16x16x32_bf16 v[124:127], a[148:151], v[180:183], v[124:127]
  v_exp_f32 v87, v87
  v_mfma_f32_16x16x32_bf16 v[124:127], a[144:147], v[176:179], v[124:127]
  ds_read_b64_tr_b16 a[174:175], v217 offset:12288
  v_cvt_pk_bf16_f32 v83, v86, v87
  v_mfma_f32_16x16x32_bf16 a[192:195], a[208:211], v[0:3], 0
  v_exp_f32 v92, v92
  v_mfma_f32_16x16x32_bf16 a[192:195], a[208:211], v[32:35], a[192:195]
  ds_read_b64_tr_b16 a[176:177], v218 offset:0
  v_mfma_f32_16x16x32_bf16 a[196:199], a[208:211], v[8:11], 0
  v_exp_f32 v93, v93
  v_mfma_f32_16x16x32_bf16 a[196:199], a[208:211], v[40:43], a[196:199]
  ds_read_b64_tr_b16 a[178:179], v218 offset:4096
  v_cvt_pk_bf16_f32 v90, v92, v93
  v_mfma_f32_16x16x32_bf16 a[200:203], a[208:211], v[16:19], 0
  v_exp_f32 v94, v94
  v_mfma_f32_16x16x32_bf16 a[200:203], a[208:211], v[48:51], a[200:203]
  ds_read_b64_tr_b16 a[180:181], v218 offset:8192
  v_mfma_f32_16x16x32_bf16 a[204:207], a[208:211], v[24:27], 0
  s_waitcnt lgkmcnt(7)
  v_exp_f32 v95, v95
  v_mfma_f32_16x16x32_bf16 a[204:207], a[208:211], v[56:59], a[204:207]
  ds_read_b64_tr_b16 a[182:183], v218 offset:12288
  v_cvt_pk_bf16_f32 v91, v94, v95
  v_mfma_f32_16x16x32_bf16 a[0:3], a[160:163], v[0:3], 0
  v_exp_f32 v96, v96
  v_mfma_f32_16x16x32_bf16 a[0:3], a[164:167], v[32:35], a[0:3]
  ds_read_b64_tr_b16 a[184:185], v219 offset:0
  v_mfma_f32_16x16x32_bf16 a[4:7], a[164:167], v[40:43], 0
  v_exp_f32 v97, v97
  v_mfma_f32_16x16x32_bf16 a[4:7], a[160:163], v[8:11], a[4:7]
  ds_read_b64_tr_b16 a[186:187], v219 offset:4096
  v_cvt_pk_bf16_f32 v96, v96, v97
  v_mfma_f32_16x16x32_bf16 a[8:11], a[160:163], v[16:19], 0
  v_exp_f32 v98, v98
  v_mfma_f32_16x16x32_bf16 a[8:11], a[164:167], v[48:51], a[8:11]
  ds_read_b64_tr_b16 a[188:189], v219 offset:8192
  v_mfma_f32_16x16x32_bf16 a[12:15], a[164:167], v[56:59], 0
  s_waitcnt lgkmcnt(7)
  v_exp_f32 v99, v99
  v_mfma_f32_16x16x32_bf16 a[12:15], a[160:163], v[24:27], a[12:15]
  ds_read_b64_tr_b16 a[190:191], v219 offset:12288
  v_cvt_pk_bf16_f32 v97, v98, v99
  v_mfma_f32_16x16x32_bf16 a[16:19], a[168:171], v[0:3], 0
  v_exp_f32 v104, v104
  v_mfma_f32_16x16x32_bf16 a[16:19], a[172:175], v[32:35], a[16:19]
  ds_read_b64_tr_b16 a[160:161], v220 offset:0
  v_mfma_f32_16x16x32_bf16 a[20:23], a[172:175], v[40:43], 0
  v_exp_f32 v105, v105
  v_mfma_f32_16x16x32_bf16 a[20:23], a[168:171], v[8:11], a[20:23]
  ds_read_b64_tr_b16 a[162:163], v220 offset:4096
  v_cvt_pk_bf16_f32 v104, v104, v105
  v_mfma_f32_16x16x32_bf16 a[24:27], a[168:171], v[16:19], 0
  v_exp_f32 v106, v106
  v_mfma_f32_16x16x32_bf16 a[24:27], a[172:175], v[48:51], a[24:27]
  ds_read_b64_tr_b16 a[164:165], v220 offset:8192
  v_mfma_f32_16x16x32_bf16 a[28:31], a[172:175], v[56:59], 0
  s_waitcnt lgkmcnt(7)
  v_exp_f32 v107, v107
  v_mfma_f32_16x16x32_bf16 a[28:31], a[168:171], v[24:27], a[28:31]
  ds_read_b64_tr_b16 a[166:167], v220 offset:12288
  v_cvt_pk_bf16_f32 v105, v106, v107
  v_mfma_f32_16x16x32_bf16 a[32:35], a[176:179], v[0:3], 0
  v_exp_f32 v112, v112
  v_mfma_f32_16x16x32_bf16 a[32:35], a[180:183], v[32:35], a[32:35]
  ds_read_b64_tr_b16 a[168:169], v221 offset:0
  v_mfma_f32_16x16x32_bf16 a[36:39], a[180:183], v[40:43], 0
  v_exp_f32 v113, v113
  v_mfma_f32_16x16x32_bf16 a[36:39], a[176:179], v[8:11], a[36:39]
  ds_read_b64_tr_b16 a[170:171], v221 offset:4096
  v_cvt_pk_bf16_f32 v112, v112, v113
  v_mfma_f32_16x16x32_bf16 a[40:43], a[176:179], v[16:19], 0
  v_exp_f32 v114, v114
  v_mfma_f32_16x16x32_bf16 a[40:43], a[180:183], v[48:51], a[40:43]
  ds_read_b64_tr_b16 a[172:173], v221 offset:8192
  v_mfma_f32_16x16x32_bf16 a[44:47], a[180:183], v[56:59], 0
  s_waitcnt lgkmcnt(7)
  v_exp_f32 v115, v115
  v_mfma_f32_16x16x32_bf16 a[44:47], a[176:179], v[24:27], a[44:47]
  ds_read_b64_tr_b16 a[174:175], v221 offset:12288
  v_cvt_pk_bf16_f32 v113, v114, v115
  v_mfma_f32_16x16x32_bf16 a[48:51], a[184:187], v[0:3], 0
  v_exp_f32 v120, v120
  v_mfma_f32_16x16x32_bf16 a[48:51], a[188:191], v[32:35], a[48:51]
  ds_read_b64_tr_b16 a[176:177], v222 offset:0
  v_mfma_f32_16x16x32_bf16 a[52:55], a[188:191], v[40:43], 0
  v_exp_f32 v121, v121
  v_mfma_f32_16x16x32_bf16 a[52:55], a[184:187], v[8:11], a[52:55]
  ds_read_b64_tr_b16 a[178:179], v222 offset:4096
  v_cvt_pk_bf16_f32 v120, v120, v121
  v_mfma_f32_16x16x32_bf16 a[56:59], a[184:187], v[16:19], 0
  v_exp_f32 v122, v122
  v_mfma_f32_16x16x32_bf16 a[56:59], a[188:191], v[48:51], a[56:59]
  ds_read_b64_tr_b16 a[180:181], v222 offset:8192
  v_mfma_f32_16x16x32_bf16 a[60:63], a[188:191], v[56:59], 0
  s_waitcnt lgkmcnt(7)
  v_exp_f32 v123, v123
  v_mfma_f32_16x16x32_bf16 a[60:63], a[184:187], v[24:27], a[60:63]
  ds_read_b64_tr_b16 a[182:183], v222 offset:12288
  v_cvt_pk_bf16_f32 v121, v122, v123
  v_mfma_f32_16x16x32_bf16 a[64:67], a[160:163], v[0:3], 0
  v_exp_f32 v100, v100
  v_mfma_f32_16x16x32_bf16 a[64:67], a[164:167], v[32:35], a[64:67]
  ds_read_b64_tr_b16 a[184:185], v223 offset:0
  v_mfma_f32_16x16x32_bf16 a[68:71], a[164:167], v[40:43], 0
  v_exp_f32 v101, v101
  v_mfma_f32_16x16x32_bf16 a[68:71], a[160:163], v[8:11], a[68:71]
  ds_read_b64_tr_b16 a[186:187], v223 offset:4096
  v_cvt_pk_bf16_f32 v98, v100, v101
  v_mfma_f32_16x16x32_bf16 a[72:75], a[160:163], v[16:19], 0
  v_exp_f32 v102, v102
  v_mfma_f32_16x16x32_bf16 a[72:75], a[164:167], v[48:51], a[72:75]
  ds_read_b64_tr_b16 a[188:189], v223 offset:8192
  v_mfma_f32_16x16x32_bf16 a[76:79], a[164:167], v[56:59], 0
  s_waitcnt lgkmcnt(7)
  v_exp_f32 v103, v103
  v_mfma_f32_16x16x32_bf16 a[76:79], a[160:163], v[24:27], a[76:79]
  ds_read_b64_tr_b16 a[190:191], v223 offset:12288
  v_cvt_pk_bf16_f32 v99, v102, v103
  v_mfma_f32_16x16x32_bf16 a[80:83], a[168:171], v[0:3], 0
  s_waitcnt vmcnt(10)
  v_exp_f32 v108, v108
  v_mfma_f32_16x16x32_bf16 a[80:83], a[172:175], v[32:35], a[80:83]
  v_mfma_f32_16x16x32_bf16 a[84:87], a[172:175], v[40:43], 0
  s_barrier
  v_exp_f32 v109, v109
  v_mfma_f32_16x16x32_bf16 a[84:87], a[168:171], v[8:11], a[84:87]
  ds_read_b128 a[128:131], v212 offset:32768
  v_cvt_pk_bf16_f32 v106, v108, v109
  v_mfma_f32_16x16x32_bf16 a[88:91], a[168:171], v[16:19], 0
  v_exp_f32 v110, v110
  v_mfma_f32_16x16x32_bf16 a[88:91], a[172:175], v[48:51], a[88:91]
  ds_read_b128 a[132:135], v213 offset:32768
  v_mfma_f32_16x16x32_bf16 a[92:95], a[172:175], v[56:59], 0
  s_waitcnt lgkmcnt(6)
  v_exp_f32 v111, v111
  v_mfma_f32_16x16x32_bf16 a[92:95], a[168:171], v[24:27], a[92:95]
  ds_read_b128 a[136:139], v214 offset:32768
  v_cvt_pk_bf16_f32 v107, v110, v111
  v_mfma_f32_16x16x32_bf16 a[96:99], a[176:179], v[0:3], 0
  s_mul_i32 s38, s3, 20480
  v_exp_f32 v116, v116
  v_mfma_f32_16x16x32_bf16 a[96:99], a[180:183], v[32:35], a[96:99]
  ds_read_b128 a[140:143], v215 offset:32768
  buffer_load_dwordx4 a[212:215], v243, s[24:27], s38 offen sc1
  s_add_u32 s38, s38, 4096
  v_mfma_f32_16x16x32_bf16 a[100:103], a[180:183], v[40:43], 0
  v_exp_f32 v117, v117
  v_mfma_f32_16x16x32_bf16 a[100:103], a[176:179], v[8:11], a[100:103]
  v_cvt_pk_bf16_f32 v114, v116, v117
  v_mfma_f32_16x16x32_bf16 a[104:107], a[176:179], v[16:19], 0
  v_exp_f32 v118, v118
  v_mfma_f32_16x16x32_bf16 a[104:107], a[180:183], v[48:51], a[104:107]
  v_mfma_f32_16x16x32_bf16 a[108:111], a[180:183], v[56:59], 0
  s_waitcnt lgkmcnt(4)
  v_exp_f32 v119, v119
  v_mfma_f32_16x16x32_bf16 a[108:111], a[176:179], v[24:27], a[108:111]
  v_cvt_pk_bf16_f32 v115, v118, v119
  v_mfma_f32_16x16x32_bf16 a[112:115], a[184:187], v[0:3], 0
  v_exp_f32 v124, v124
  v_mfma_f32_16x16x32_bf16 a[112:115], a[188:191], v[32:35], a[112:115]
  v_mfma_f32_16x16x32_bf16 a[116:119], a[188:191], v[40:43], 0
  v_exp_f32 v125, v125
  v_mfma_f32_16x16x32_bf16 a[116:119], a[184:187], v[8:11], a[116:119]
  v_cvt_pk_bf16_f32 v122, v124, v125
  v_mfma_f32_16x16x32_bf16 a[120:123], a[184:187], v[16:19], 0
  v_exp_f32 v126, v126
  v_mfma_f32_16x16x32_bf16 a[120:123], a[188:191], v[48:51], a[120:123]
  v_mfma_f32_16x16x32_bf16 a[124:127], a[188:191], v[56:59], 0
  s_waitcnt lgkmcnt(0)
  v_exp_f32 v127, v127
  v_mfma_f32_16x16x32_bf16 a[124:127], a[184:187], v[24:27], a[124:127]
  v_cvt_pk_bf16_f32 v123, v126, v127
  v_mfma_f32_16x16x32_bf16 v[0:3], a[128:131], v[128:131], v[192:195]
  s_add_u32 m0, s28, 114688
  v_mfma_f32_16x16x32_bf16 v[0:3], a[132:135], v[132:135], v[0:3]
  ds_read_b128 a[144:147], v212 offset:36864
  v_mfma_f32_16x16x32_bf16 v[0:3], a[136:139], v[136:139], v[0:3]
  buffer_load_dwordx4 v236, s[16:19], s29 offen offset:0 lds
  v_mfma_f32_16x16x32_bf16 v[0:3], a[140:143], v[140:143], v[0:3]
  ds_read_b128 a[148:151], v213 offset:36864
  v_mfma_f32_16x16x32_bf16 v[8:11], a[140:143], v[156:159], v[196:199]
  v_mfma_f32_16x16x32_bf16 v[8:11], a[136:139], v[152:155], v[8:11]
  ds_read_b128 a[152:155], v214 offset:36864
  v_mfma_f32_16x16x32_bf16 v[8:11], a[132:135], v[148:151], v[8:11]
  buffer_load_dwordx4 v237, s[16:19], s29 offen offset:1024 lds
  v_mfma_f32_16x16x32_bf16 v[8:11], a[128:131], v[144:147], v[8:11]
  ds_read_b128 a[156:159], v215 offset:36864
  v_mfma_f32_16x16x32_bf16 v[16:19], a[128:131], v[160:163], v[200:203]
  v_exp_f32 v0, v0
  v_mfma_f32_16x16x32_bf16 v[16:19], a[132:135], v[164:167], v[16:19]
  v_mfma_f32_16x16x32_bf16 v[16:19], a[136:139], v[168:171], v[16:19]
  v_exp_f32 v1, v1
  v_mfma_f32_16x16x32_bf16 v[16:19], a[140:143], v[172:175], v[16:19]
  v_cvt_pk_bf16_f32 v0, v0, v1
  v_mfma_f32_16x16x32_bf16 v[24:27], a[140:143], v[188:191], v[204:207]
  v_exp_f32 v2, v2
  v_mfma_f32_16x16x32_bf16 v[24:27], a[136:139], v[184:187], v[24:27]
  buffer_load_dwordx4 v236, s[16:19], s29 offen offset:2048 lds
  v_mfma_f32_16x16x32_bf16 v[24:27], a[132:135], v[180:183], v[24:27]
  s_waitcnt lgkmcnt(0)
  v_exp_f32 v3, v3
  v_mfma_f32_16x16x32_bf16 v[24:27], a[128:131], v[176:179], v[24:27]
  v_cvt_pk_bf16_f32 v1, v2, v3
  v_mfma_f32_16x16x32_bf16 v[4:7], a[144:147], v[128:131], v[192:195]
  v_exp_f32 v8, v8
  v_mfma_f32_16x16x32_bf16 v[4:7], a[148:151], v[132:135], v[4:7]
  ds_read_b128 a[128:131], v212 offset:40960
  v_mfma_f32_16x16x32_bf16 v[4:7], a[152:155], v[136:139], v[4:7]
  v_exp_f32 v9, v9
  v_mfma_f32_16x16x32_bf16 v[4:7], a[156:159], v[140:143], v[4:7]
  ds_read_b128 a[132:135], v213 offset:40960
  v_cvt_pk_bf16_f32 v8, v8, v9
  v_mfma_f32_16x16x32_bf16 v[12:15], a[156:159], v[156:159], v[196:199]
  v_exp_f32 v10, v10
  v_mfma_f32_16x16x32_bf16 v[12:15], a[152:155], v[152:155], v[12:15]
  ds_read_b128 a[136:139], v214 offset:40960
  v_mfma_f32_16x16x32_bf16 v[12:15], a[148:151], v[148:151], v[12:15]
  v_exp_f32 v11, v11
  v_mfma_f32_16x16x32_bf16 v[12:15], a[144:147], v[144:147], v[12:15]
  ds_read_b128 a[140:143], v215 offset:40960
  v_cvt_pk_bf16_f32 v9, v10, v11
  v_mfma_f32_16x16x32_bf16 v[20:23], a[144:147], v[160:163], v[200:203]
  v_exp_f32 v16, v16
  v_mfma_f32_16x16x32_bf16 v[20:23], a[148:151], v[164:167], v[20:23]
  buffer_load_dwordx4 v237, s[16:19], s29 offen offset:3072 lds
  v_mfma_f32_16x16x32_bf16 v[20:23], a[152:155], v[168:171], v[20:23]
  s_add_u32 s29, s29, 16384
  v_exp_f32 v17, v17
  v_mfma_f32_16x16x32_bf16 v[20:23], a[156:159], v[172:175], v[20:23]
  v_cvt_pk_bf16_f32 v16, v16, v17
  v_mfma_f32_16x16x32_bf16 v[28:31], a[156:159], v[188:191], v[204:207]
  s_add_u32 m0, s28, 0
  v_exp_f32 v18, v18
  v_mfma_f32_16x16x32_bf16 v[28:31], a[152:155], v[184:187], v[28:31]
  buffer_load_dwordx4 v232, s[12:15], s29 offen offset:0 lds
  v_mfma_f32_16x16x32_bf16 v[28:31], a[148:151], v[180:183], v[28:31]
  s_waitcnt lgkmcnt(0)
  v_exp_f32 v19, v19
  v_mfma_f32_16x16x32_bf16 v[28:31], a[144:147], v[176:179], v[28:31]
  v_cvt_pk_bf16_f32 v17, v18, v19
  v_mfma_f32_16x16x32_bf16 v[32:35], a[128:131], v[128:131], v[192:195]
  v_exp_f32 v24, v24
  v_mfma_f32_16x16x32_bf16 v[32:35], a[132:135], v[132:135], v[32:35]
  ds_read_b128 a[144:147], v212 offset:45056
  v_mfma_f32_16x16x32_bf16 v[32:35], a[136:139], v[136:139], v[32:35]
  v_exp_f32 v25, v25
  v_mfma_f32_16x16x32_bf16 v[32:35], a[140:143], v[140:143], v[32:35]
  ds_read_b128 a[148:151], v213 offset:45056
  v_cvt_pk_bf16_f32 v24, v24, v25
  v_mfma_f32_16x16x32_bf16 v[40:43], a[140:143], v[156:159], v[196:199]
  v_exp_f32 v26, v26
  v_mfma_f32_16x16x32_bf16 v[40:43], a[136:139], v[152:155], v[40:43]
  ds_read_b128 a[152:155], v214 offset:45056
  v_mfma_f32_16x16x32_bf16 v[40:43], a[132:135], v[148:151], v[40:43]
  v_exp_f32 v27, v27
  v_mfma_f32_16x16x32_bf16 v[40:43], a[128:131], v[144:147], v[40:43]
  ds_read_b128 a[156:159], v215 offset:45056
  v_cvt_pk_bf16_f32 v25, v26, v27
  v_mfma_f32_16x16x32_bf16 v[48:51], a[128:131], v[160:163], v[200:203]
  v_exp_f32 v4, v4
  v_mfma_f32_16x16x32_bf16 v[48:51], a[132:135], v[164:167], v[48:51]
  buffer_load_dwordx4 v233, s[12:15], s29 offen offset:1024 lds
  v_mfma_f32_16x16x32_bf16 v[48:51], a[136:139], v[168:171], v[48:51]
  v_exp_f32 v5, v5
  v_mfma_f32_16x16x32_bf16 v[48:51], a[140:143], v[172:175], v[48:51]
  v_cvt_pk_bf16_f32 v2, v4, v5
  v_mfma_f32_16x16x32_bf16 v[56:59], a[140:143], v[188:191], v[204:207]
  v_exp_f32 v6, v6
  v_mfma_f32_16x16x32_bf16 v[56:59], a[136:139], v[184:187], v[56:59]
  buffer_load_dwordx4 v234, s[12:15], s29 offen offset:2048 lds
  v_mfma_f32_16x16x32_bf16 v[56:59], a[132:135], v[180:183], v[56:59]
  s_waitcnt lgkmcnt(0)
  v_exp_f32 v7, v7
  v_mfma_f32_16x16x32_bf16 v[56:59], a[128:131], v[176:179], v[56:59]
  v_cvt_pk_bf16_f32 v3, v6, v7
  v_mfma_f32_16x16x32_bf16 v[36:39], a[144:147], v[128:131], v[192:195]
  v_exp_f32 v12, v12
  v_mfma_f32_16x16x32_bf16 v[36:39], a[148:151], v[132:135], v[36:39]
  ds_read_b64_tr_b16 a[160:161], v216 offset:16384
  v_mfma_f32_16x16x32_bf16 v[36:39], a[152:155], v[136:139], v[36:39]
  v_exp_f32 v13, v13
  v_mfma_f32_16x16x32_bf16 v[36:39], a[156:159], v[140:143], v[36:39]
  ds_read_b64_tr_b16 a[162:163], v216 offset:20480
  v_cvt_pk_bf16_f32 v10, v12, v13
  v_mfma_f32_16x16x32_bf16 v[44:47], a[156:159], v[156:159], v[196:199]
  v_exp_f32 v14, v14
  v_mfma_f32_16x16x32_bf16 v[44:47], a[152:155], v[152:155], v[44:47]
  ds_read_b64_tr_b16 a[164:165], v216 offset:24576
  buffer_load_dwordx4 v235, s[12:15], s29 offen offset:3072 lds
  v_mfma_f32_16x16x32_bf16 v[44:47], a[148:151], v[148:151], v[44:47]
  v_exp_f32 v15, v15
  v_mfma_f32_16x16x32_bf16 v[44:47], a[144:147], v[144:147], v[44:47]
  ds_read_b64_tr_b16 a[166:167], v216 offset:28672
  v_cvt_pk_bf16_f32 v11, v14, v15
  v_mfma_f32_16x16x32_bf16 v[52:55], a[144:147], v[160:163], v[200:203]
  v_exp_f32 v20, v20
  v_mfma_f32_16x16x32_bf16 v[52:55], a[148:151], v[164:167], v[52:55]
  ds_read_b64_tr_b16 a[168:169], v217 offset:16384
  s_add_u32 m0, s50, 1024
  v_mfma_f32_16x16x32_bf16 v[52:55], a[152:155], v[168:171], v[52:55]
  v_exp_f32 v21, v21
  v_mfma_f32_16x16x32_bf16 v[52:55], a[156:159], v[172:175], v[52:55]
  ds_read_b64_tr_b16 a[170:171], v217 offset:20480
  v_cvt_pk_bf16_f32 v18, v20, v21
  v_mfma_f32_16x16x32_bf16 v[60:63], a[156:159], v[188:191], v[204:207]
  v_exp_f32 v22, v22
  v_mfma_f32_16x16x32_bf16 v[60:63], a[152:155], v[184:187], v[60:63]
  ds_read_b64_tr_b16 a[172:173], v217 offset:24576
  buffer_load_dwordx4 v253, s[20:23], s35 offen lds
  v_mfma_f32_16x16x32_bf16 v[60:63], a[148:151], v[180:183], v[60:63]
  v_exp_f32 v23, v23
  v_mfma_f32_16x16x32_bf16 v[60:63], a[144:147], v[176:179], v[60:63]
  ds_read_b64_tr_b16 a[174:175], v217 offset:28672
  v_cvt_pk_bf16_f32 v19, v22, v23
  v_mfma_f32_16x16x32_bf16 a[192:195], a[208:211], v[64:67], a[192:195]
  v_exp_f32 v28, v28
  v_mfma_f32_16x16x32_bf16 a[192:195], a[208:211], v[96:99], a[192:195]
  ds_read_b64_tr_b16 a[176:177], v218 offset:16384
  v_mfma_f32_16x16x32_bf16 a[196:199], a[208:211], v[72:75], a[196:199]
  v_exp_f32 v29, v29
  v_mfma_f32_16x16x32_bf16 a[196:199], a[208:211], v[104:107], a[196:199]
  ds_read_b64_tr_b16 a[178:179], v218 offset:20480
  v_cvt_pk_bf16_f32 v26, v28, v29
  v_mfma_f32_16x16x32_bf16 a[200:203], a[208:211], v[80:83], a[200:203]
  v_exp_f32 v30, v30
  v_mfma_f32_16x16x32_bf16 a[200:203], a[208:211], v[112:115], a[200:203]
  ds_read_b64_tr_b16 a[180:181], v218 offset:24576
  v_mfma_f32_16x16x32_bf16 a[204:207], a[208:211], v[88:91], a[204:207]
  s_waitcnt lgkmcnt(7)
  v_exp_f32 v31, v31
  v_mfma_f32_16x16x32_bf16 a[204:207], a[208:211], v[120:123], a[204:207]
  ds_read_b64_tr_b16 a[182:183], v218 offset:28672
  v_cvt_pk_bf16_f32 v27, v30, v31
  v_mfma_f32_16x16x32_bf16 a[0:3], a[160:163], v[64:67], a[0:3]
  v_exp_f32 v32, v32
  v_mfma_f32_16x16x32_bf16 a[0:3], a[164:167], v[96:99], a[0:3]
  ds_read_b64_tr_b16 a[184:185], v219 offset:16384
  v_mfma_f32_16x16x32_bf16 a[4:7], a[164:167], v[104:107], a[4:7]
  v_exp_f32 v33, v33
  v_mfma_f32_16x16x32_bf16 a[4:7], a[160:163], v[72:75], a[4:7]
  ds_read_b64_tr_b16 a[186:187], v219 offset:20480
  v_cvt_pk_bf16_f32 v32, v32, v33
  v_mfma_f32_16x16x32_bf16 a[8:11], a[160:163], v[80:83], a[8:11]
  v_exp_f32 v34, v34
  v_mfma_f32_16x16x32_bf16 a[8:11], a[164:167], v[112:115], a[8:11]
  ds_read_b64_tr_b16 a[188:189], v219 offset:24576
  v_mfma_f32_16x16x32_bf16 a[12:15], a[164:167], v[120:123], a[12:15]
  s_waitcnt lgkmcnt(7)
  v_exp_f32 v35, v35
  v_mfma_f32_16x16x32_bf16 a[12:15], a[160:163], v[88:91], a[12:15]
  ds_read_b64_tr_b16 a[190:191], v219 offset:28672
  v_cvt_pk_bf16_f32 v33, v34, v35
  v_mfma_f32_16x16x32_bf16 a[16:19], a[168:171], v[64:67], a[16:19]
  v_exp_f32 v40, v40
  v_mfma_f32_16x16x32_bf16 a[16:19], a[172:175], v[96:99], a[16:19]
  ds_read_b64_tr_b16 a[160:161], v220 offset:16384
  v_mfma_f32_16x16x32_bf16 a[20:23], a[172:175], v[104:107], a[20:23]
  v_exp_f32 v41, v41
  v_mfma_f32_16x16x32_bf16 a[20:23], a[168:171], v[72:75], a[20:23]
  ds_read_b64_tr_b16 a[162:163], v220 offset:20480
  v_cvt_pk_bf16_f32 v40, v40, v41
  v_mfma_f32_16x16x32_bf16 a[24:27], a[168:171], v[80:83], a[24:27]
  v_exp_f32 v42, v42
  v_mfma_f32_16x16x32_bf16 a[24:27], a[172:175], v[112:115], a[24:27]
  ds_read_b64_tr_b16 a[164:165], v220 offset:24576
  v_mfma_f32_16x16x32_bf16 a[28:31], a[172:175], v[120:123], a[28:31]
  s_waitcnt lgkmcnt(7)
  v_exp_f32 v43, v43
  v_mfma_f32_16x16x32_bf16 a[28:31], a[168:171], v[88:91], a[28:31]
  ds_read_b64_tr_b16 a[166:167], v220 offset:28672
  v_cvt_pk_bf16_f32 v41, v42, v43
  v_mfma_f32_16x16x32_bf16 a[32:35], a[176:179], v[64:67], a[32:35]
  v_exp_f32 v48, v48
  v_mfma_f32_16x16x32_bf16 a[32:35], a[180:183], v[96:99], a[32:35]
  ds_read_b64_tr_b16 a[168:169], v221 offset:16384
  v_mfma_f32_16x16x32_bf16 a[36:39], a[180:183], v[104:107], a[36:39]
  v_exp_f32 v49, v49
  v_mfma_f32_16x16x32_bf16 a[36:39], a[176:179], v[72:75], a[36:39]
  ds_read_b64_tr_b16 a[170:171], v221 offset:20480
  v_cvt_pk_bf16_f32 v48, v48, v49
  v_mfma_f32_16x16x32_bf16 a[40:43], a[176:179], v[80:83], a[40:43]
  v_exp_f32 v50, v50
  v_mfma_f32_16x16x32_bf16 a[40:43], a[180:183], v[112:115], a[40:43]
  ds_read_b64_tr_b16 a[172:173], v221 offset:24576
  v_mfma_f32_16x16x32_bf16 a[44:47], a[180:183], v[120:123], a[44:47]
  s_waitcnt lgkmcnt(7)
  v_exp_f32 v51, v51
  v_mfma_f32_16x16x32_bf16 a[44:47], a[176:179], v[88:91], a[44:47]
  ds_read_b64_tr_b16 a[174:175], v221 offset:28672
  v_cvt_pk_bf16_f32 v49, v50, v51
  v_mfma_f32_16x16x32_bf16 a[48:51], a[184:187], v[64:67], a[48:51]
  v_exp_f32 v56, v56
  v_mfma_f32_16x16x32_bf16 a[48:51], a[188:191], v[96:99], a[48:51]
  ds_read_b64_tr_b16 a[176:177], v222 offset:16384
  v_mfma_f32_16x16x32_bf16 a[52:55], a[188:191], v[104:107], a[52:55]
  v_exp_f32 v57, v57
  v_mfma_f32_16x16x32_bf16 a[52:55], a[184:187], v[72:75], a[52:55]
  ds_read_b64_tr_b16 a[178:179], v222 offset:20480
  v_cvt_pk_bf16_f32 v56, v56, v57
  v_mfma_f32_16x16x32_bf16 a[56:59], a[184:187], v[80:83], a[56:59]
  v_exp_f32 v58, v58
  v_mfma_f32_16x16x32_bf16 a[56:59], a[188:191], v[112:115], a[56:59]
  ds_read_b64_tr_b16 a[180:181], v222 offset:24576
  v_mfma_f32_16x16x32_bf16 a[60:63], a[188:191], v[120:123], a[60:63]
  s_waitcnt lgkmcnt(7)
  v_exp_f32 v59, v59
  v_mfma_f32_16x16x32_bf16 a[60:63], a[184:187], v[88:91], a[60:63]
  ds_read_b64_tr_b16 a[182:183], v222 offset:28672
  v_cvt_pk_bf16_f32 v57, v58, v59
  v_mfma_f32_16x16x32_bf16 a[64:67], a[160:163], v[64:67], a[64:67]
  v_exp_f32 v36, v36
  v_mfma_f32_16x16x32_bf16 a[64:67], a[164:167], v[96:99], a[64:67]
  ds_read_b64_tr_b16 a[184:185], v223 offset:16384
  v_mfma_f32_16x16x32_bf16 a[68:71], a[164:167], v[104:107], a[68:71]
  v_exp_f32 v37, v37
  v_mfma_f32_16x16x32_bf16 a[68:71], a[160:163], v[72:75], a[68:71]
  ds_read_b64_tr_b16 a[186:187], v223 offset:20480
  v_cvt_pk_bf16_f32 v34, v36, v37
  v_mfma_f32_16x16x32_bf16 a[72:75], a[160:163], v[80:83], a[72:75]
  v_exp_f32 v38, v38
  v_mfma_f32_16x16x32_bf16 a[72:75], a[164:167], v[112:115], a[72:75]
  ds_read_b64_tr_b16 a[188:189], v223 offset:24576
  v_mfma_f32_16x16x32_bf16 a[76:79], a[164:167], v[120:123], a[76:79]
  s_waitcnt lgkmcnt(7)
  v_exp_f32 v39, v39
  v_mfma_f32_16x16x32_bf16 a[76:79], a[160:163], v[88:91], a[76:79]
  ds_read_b64_tr_b16 a[190:191], v223 offset:28672
  v_cvt_pk_bf16_f32 v35, v38, v39
  v_mfma_f32_16x16x32_bf16 a[80:83], a[168:171], v[64:67], a[80:83]
  s_waitcnt vmcnt(11)
  v_exp_f32 v44, v44
  v_mfma_f32_16x16x32_bf16 a[80:83], a[172:175], v[96:99], a[80:83]
  v_mfma_f32_16x16x32_bf16 a[84:87], a[172:175], v[104:107], a[84:87]
  s_barrier
  v_exp_f32 v45, v45
  v_mfma_f32_16x16x32_bf16 a[84:87], a[168:171], v[72:75], a[84:87]
  ds_read_b128 a[128:131], v212 offset:49152
  v_cvt_pk_bf16_f32 v42, v44, v45
  v_mfma_f32_16x16x32_bf16 a[88:91], a[168:171], v[80:83], a[88:91]
  v_exp_f32 v46, v46
  v_mfma_f32_16x16x32_bf16 a[88:91], a[172:175], v[112:115], a[88:91]
  ds_read_b128 a[132:135], v213 offset:49152
  v_mfma_f32_16x16x32_bf16 a[92:95], a[172:175], v[120:123], a[92:95]
  s_waitcnt lgkmcnt(6)
  v_exp_f32 v47, v47
  v_mfma_f32_16x16x32_bf16 a[92:95], a[168:171], v[88:91], a[92:95]
  ds_read_b128 a[136:139], v214 offset:49152
  v_cvt_pk_bf16_f32 v43, v46, v47
  v_mfma_f32_16x16x32_bf16 a[96:99], a[176:179], v[64:67], a[96:99]
  v_exp_f32 v52, v52
  v_mfma_f32_16x16x32_bf16 a[96:99], a[180:183], v[96:99], a[96:99]
  ds_read_b128 a[140:143], v215 offset:49152
  buffer_load_dwordx4 a[216:219], v243, s[24:27], s38 offen sc1
  s_add_u32 s38, s38, 4096
  v_mfma_f32_16x16x32_bf16 a[100:103], a[180:183], v[104:107], a[100:103]
  v_exp_f32 v53, v53
  v_mfma_f32_16x16x32_bf16 a[100:103], a[176:179], v[72:75], a[100:103]
  v_cvt_pk_bf16_f32 v50, v52, v53
  v_mfma_f32_16x16x32_bf16 a[104:107], a[176:179], v[80:83], a[104:107]
  v_exp_f32 v54, v54
  v_mfma_f32_16x16x32_bf16 a[104:107], a[180:183], v[112:115], a[104:107]
  v_mfma_f32_16x16x32_bf16 a[108:111], a[180:183], v[120:123], a[108:111]
  s_waitcnt lgkmcnt(4)
  v_exp_f32 v55, v55
  v_mfma_f32_16x16x32_bf16 a[108:111], a[176:179], v[88:91], a[108:111]
  v_cvt_pk_bf16_f32 v51, v54, v55
  v_mfma_f32_16x16x32_bf16 a[112:115], a[184:187], v[64:67], a[112:115]
  v_exp_f32 v60, v60
  v_mfma_f32_16x16x32_bf16 a[112:115], a[188:191], v[96:99], a[112:115]
  v_mfma_f32_16x16x32_bf16 a[116:119], a[188:191], v[104:107], a[116:119]
  v_exp_f32 v61, v61
  v_mfma_f32_16x16x32_bf16 a[116:119], a[184:187], v[72:75], a[116:119]
  v_cvt_pk_bf16_f32 v58, v60, v61
  v_mfma_f32_16x16x32_bf16 a[120:123], a[184:187], v[80:83], a[120:123]
  v_exp_f32 v62, v62
  v_mfma_f32_16x16x32_bf16 a[120:123], a[188:191], v[112:115], a[120:123]
  v_mfma_f32_16x16x32_bf16 a[124:127], a[188:191], v[120:123], a[124:127]
  s_waitcnt lgkmcnt(0)
  v_exp_f32 v63, v63
  v_mfma_f32_16x16x32_bf16 a[124:127], a[184:187], v[88:91], a[124:127]
  v_cvt_pk_bf16_f32 v59, v62, v63
  v_mfma_f32_16x16x32_bf16 v[64:67], a[128:131], v[128:131], v[192:195]
  s_add_u32 m0, s28, 65536
  v_mfma_f32_16x16x32_bf16 v[64:67], a[132:135], v[132:135], v[64:67]
  ds_read_b128 a[144:147], v212 offset:53248
  v_mfma_f32_16x16x32_bf16 v[64:67], a[136:139], v[136:139], v[64:67]
  buffer_load_dwordx4 v236, s[16:19], s29 offen offset:0 lds
  v_mfma_f32_16x16x32_bf16 v[64:67], a[140:143], v[140:143], v[64:67]
  ds_read_b128 a[148:151], v213 offset:53248
  v_mfma_f32_16x16x32_bf16 v[72:75], a[140:143], v[156:159], v[196:199]
  v_mfma_f32_16x16x32_bf16 v[72:75], a[136:139], v[152:155], v[72:75]
  ds_read_b128 a[152:155], v214 offset:53248
  v_mfma_f32_16x16x32_bf16 v[72:75], a[132:135], v[148:151], v[72:75]
  buffer_load_dwordx4 v237, s[16:19], s29 offen offset:1024 lds
  v_mfma_f32_16x16x32_bf16 v[72:75], a[128:131], v[144:147], v[72:75]
  ds_read_b128 a[156:159], v215 offset:53248
  v_mfma_f32_16x16x32_bf16 v[80:83], a[128:131], v[160:163], v[200:203]
  v_exp_f32 v64, v64
  v_mfma_f32_16x16x32_bf16 v[80:83], a[132:135], v[164:167], v[80:83]
  v_mfma_f32_16x16x32_bf16 v[80:83], a[136:139], v[168:171], v[80:83]
  v_exp_f32 v65, v65
  v_mfma_f32_16x16x32_bf16 v[80:83], a[140:143], v[172:175], v[80:83]
  v_cvt_pk_bf16_f32 v64, v64, v65
  v_mfma_f32_16x16x32_bf16 v[88:91], a[140:143], v[188:191], v[204:207]
  v_exp_f32 v66, v66
  v_mfma_f32_16x16x32_bf16 v[88:91], a[136:139], v[184:187], v[88:91]
  buffer_load_dwordx4 v236, s[16:19], s29 offen offset:2048 lds
  v_mfma_f32_16x16x32_bf16 v[88:91], a[132:135], v[180:183], v[88:91]
  s_waitcnt lgkmcnt(0)
  v_exp_f32 v67, v67
  v_mfma_f32_16x16x32_bf16 v[88:91], a[128:131], v[176:179], v[88:91]
  v_cvt_pk_bf16_f32 v65, v66, v67
  v_mfma_f32_16x16x32_bf16 v[68:71], a[144:147], v[128:131], v[192:195]
  v_exp_f32 v72, v72
  v_mfma_f32_16x16x32_bf16 v[68:71], a[148:151], v[132:135], v[68:71]
  ds_read_b128 a[128:131], v212 offset:57344
  v_mfma_f32_16x16x32_bf16 v[68:71], a[152:155], v[136:139], v[68:71]
  v_exp_f32 v73, v73
  v_mfma_f32_16x16x32_bf16 v[68:71], a[156:159], v[140:143], v[68:71]
  ds_read_b128 a[132:135], v213 offset:57344
  v_cvt_pk_bf16_f32 v72, v72, v73
  v_mfma_f32_16x16x32_bf16 v[76:79], a[156:159], v[156:159], v[196:199]
  v_exp_f32 v74, v74
  v_mfma_f32_16x16x32_bf16 v[76:79], a[152:155], v[152:155], v[76:79]
  ds_read_b128 a[136:139], v214 offset:57344
  v_mfma_f32_16x16x32_bf16 v[76:79], a[148:151], v[148:151], v[76:79]
  v_exp_f32 v75, v75
  v_mfma_f32_16x16x32_bf16 v[76:79], a[144:147], v[144:147], v[76:79]
  ds_read_b128 a[140:143], v215 offset:57344
  v_cvt_pk_bf16_f32 v73, v74, v75
  v_mfma_f32_16x16x32_bf16 v[84:87], a[144:147], v[160:163], v[200:203]
  v_exp_f32 v80, v80
  v_mfma_f32_16x16x32_bf16 v[84:87], a[148:151], v[164:167], v[84:87]
  buffer_load_dwordx4 v237, s[16:19], s29 offen offset:3072 lds
  v_mfma_f32_16x16x32_bf16 v[84:87], a[152:155], v[168:171], v[84:87]
  s_add_u32 s29, s29, 16384
  v_exp_f32 v81, v81
  v_mfma_f32_16x16x32_bf16 v[84:87], a[156:159], v[172:175], v[84:87]
  v_cvt_pk_bf16_f32 v80, v80, v81
  v_mfma_f32_16x16x32_bf16 v[92:95], a[156:159], v[188:191], v[204:207]
  s_add_u32 m0, s28, 16384
  v_exp_f32 v82, v82
  v_mfma_f32_16x16x32_bf16 v[92:95], a[152:155], v[184:187], v[92:95]
  buffer_load_dwordx4 v232, s[12:15], s29 offen offset:0 lds
  v_mfma_f32_16x16x32_bf16 v[92:95], a[148:151], v[180:183], v[92:95]
  s_waitcnt lgkmcnt(0)
  v_exp_f32 v83, v83
  v_mfma_f32_16x16x32_bf16 v[92:95], a[144:147], v[176:179], v[92:95]
  v_cvt_pk_bf16_f32 v81, v82, v83
  v_mfma_f32_16x16x32_bf16 v[96:99], a[128:131], v[128:131], v[192:195]
  v_exp_f32 v88, v88
  v_mfma_f32_16x16x32_bf16 v[96:99], a[132:135], v[132:135], v[96:99]
  ds_read_b128 a[144:147], v212 offset:61440
  v_mfma_f32_16x16x32_bf16 v[96:99], a[136:139], v[136:139], v[96:99]
  v_exp_f32 v89, v89
  v_mfma_f32_16x16x32_bf16 v[96:99], a[140:143], v[140:143], v[96:99]
  ds_read_b128 a[148:151], v213 offset:61440
  v_cvt_pk_bf16_f32 v88, v88, v89
  v_mfma_f32_16x16x32_bf16 v[104:107], a[140:143], v[156:159], v[196:199]
  v_exp_f32 v90, v90
  v_mfma_f32_16x16x32_bf16 v[104:107], a[136:139], v[152:155], v[104:107]
  ds_read_b128 a[152:155], v214 offset:61440
  v_mfma_f32_16x16x32_bf16 v[104:107], a[132:135], v[148:151], v[104:107]
  v_exp_f32 v91, v91
  v_mfma_f32_16x16x32_bf16 v[104:107], a[128:131], v[144:147], v[104:107]
  ds_read_b128 a[156:159], v215 offset:61440
  v_cvt_pk_bf16_f32 v89, v90, v91
  v_mfma_f32_16x16x32_bf16 v[112:115], a[128:131], v[160:163], v[200:203]
  v_exp_f32 v68, v68
  v_mfma_f32_16x16x32_bf16 v[112:115], a[132:135], v[164:167], v[112:115]
  buffer_load_dwordx4 v233, s[12:15], s29 offen offset:1024 lds
  v_mfma_f32_16x16x32_bf16 v[112:115], a[136:139], v[168:171], v[112:115]
  v_exp_f32 v69, v69
  v_mfma_f32_16x16x32_bf16 v[112:115], a[140:143], v[172:175], v[112:115]
  v_cvt_pk_bf16_f32 v66, v68, v69
  v_mfma_f32_16x16x32_bf16 v[120:123], a[140:143], v[188:191], v[204:207]
  v_exp_f32 v70, v70
  v_mfma_f32_16x16x32_bf16 v[120:123], a[136:139], v[184:187], v[120:123]
  buffer_load_dwordx4 v234, s[12:15], s29 offen offset:2048 lds
  v_mfma_f32_16x16x32_bf16 v[120:123], a[132:135], v[180:183], v[120:123]
  s_waitcnt lgkmcnt(0)
  v_exp_f32 v71, v71
  v_mfma_f32_16x16x32_bf16 v[120:123], a[128:131], v[176:179], v[120:123]
  v_cvt_pk_bf16_f32 v67, v70, v71
  v_mfma_f32_16x16x32_bf16 v[100:103], a[144:147], v[128:131], v[192:195]
  v_exp_f32 v76, v76
  v_mfma_f32_16x16x32_bf16 v[100:103], a[148:151], v[132:135], v[100:103]
  ds_read_b64_tr_b16 a[160:161], v216 offset:32768
  v_mfma_f32_16x16x32_bf16 v[100:103], a[152:155], v[136:139], v[100:103]
  v_exp_f32 v77, v77
  v_mfma_f32_16x16x32_bf16 v[100:103], a[156:159], v[140:143], v[100:103]
  ds_read_b64_tr_b16 a[162:163], v216 offset:36864
  v_cvt_pk_bf16_f32 v74, v76, v77
  v_mfma_f32_16x16x32_bf16 v[108:111], a[156:159], v[156:159], v[196:199]
  v_exp_f32 v78, v78
  v_mfma_f32_16x16x32_bf16 v[108:111], a[152:155], v[152:155], v[108:111]
  ds_read_b64_tr_b16 a[164:165], v216 offset:40960
  buffer_load_dwordx4 v235, s[12:15], s29 offen offset:3072 lds
  v_mfma_f32_16x16x32_bf16 v[108:111], a[148:151], v[148:151], v[108:111]
  v_exp_f32 v79, v79
  v_mfma_f32_16x16x32_bf16 v[108:111], a[144:147], v[144:147], v[108:111]
  ds_read_b64_tr_b16 a[166:167], v216 offset:45056
  v_cvt_pk_bf16_f32 v75, v78, v79
  v_mfma_f32_16x16x32_bf16 v[116:119], a[144:147], v[160:163], v[200:203]
  v_exp_f32 v84, v84
  v_mfma_f32_16x16x32_bf16 v[116:119], a[148:151], v[164:167], v[116:119]
  ds_read_b64_tr_b16 a[168:169], v217 offset:32768
  s_add_u32 m0, s50, 4096
  v_mfma_f32_16x16x32_bf16 v[116:119], a[152:155], v[168:171], v[116:119]
  v_exp_f32 v85, v85
  v_mfma_f32_16x16x32_bf16 v[116:119], a[156:159], v[172:175], v[116:119]
  ds_read_b64_tr_b16 a[170:171], v217 offset:36864
  v_cvt_pk_bf16_f32 v82, v84, v85
  v_mfma_f32_16x16x32_bf16 v[124:127], a[156:159], v[188:191], v[204:207]
  v_exp_f32 v86, v86
  v_mfma_f32_16x16x32_bf16 v[124:127], a[152:155], v[184:187], v[124:127]
  ds_read_b64_tr_b16 a[172:173], v217 offset:40960
  buffer_load_dwordx4 v253, s[44:47], s35 offen lds
  s_add_u32 s35, s35, 221184
  v_mfma_f32_16x16x32_bf16 v[124:127], a[148:151], v[180:183], v[124:127]
  v_exp_f32 v87, v87
  v_mfma_f32_16x16x32_bf16 v[124:127], a[144:147], v[176:179], v[124:127]
  ds_read_b64_tr_b16 a[174:175], v217 offset:45056
  v_cvt_pk_bf16_f32 v83, v86, v87
  v_mfma_f32_16x16x32_bf16 a[192:195], a[208:211], v[0:3], a[192:195]
  v_exp_f32 v92, v92
  v_mfma_f32_16x16x32_bf16 a[192:195], a[208:211], v[32:35], a[192:195]
  ds_read_b64_tr_b16 a[176:177], v218 offset:32768
  v_lshrrev_b32 v254, 4, v242
  v_mfma_f32_16x16x32_bf16 a[196:199], a[208:211], v[8:11], a[196:199]
  v_exp_f32 v93, v93
  v_mfma_f32_16x16x32_bf16 a[196:199], a[208:211], v[40:43], a[196:199]
  ds_read_b64_tr_b16 a[178:179], v218 offset:36864
  v_cvt_pk_bf16_f32 v90, v92, v93
  v_mfma_f32_16x16x32_bf16 a[200:203], a[208:211], v[16:19], a[200:203]
  v_exp_f32 v94, v94
  v_mfma_f32_16x16x32_bf16 a[200:203], a[208:211], v[48:51], a[200:203]
  ds_read_b64_tr_b16 a[180:181], v218 offset:40960
  v_lshrrev_b32 v254, 5, v254
  v_mfma_f32_16x16x32_bf16 a[204:207], a[208:211], v[24:27], a[204:207]
  s_waitcnt lgkmcnt(7)
  v_exp_f32 v95, v95
  v_mfma_f32_16x16x32_bf16 a[204:207], a[208:211], v[56:59], a[204:207]
  ds_read_b64_tr_b16 a[182:183], v218 offset:45056
  v_cvt_pk_bf16_f32 v91, v94, v95
  v_mfma_f32_16x16x32_bf16 a[0:3], a[160:163], v[0:3], a[0:3]
  v_exp_f32 v96, v96
  v_mfma_f32_16x16x32_bf16 a[0:3], a[164:167], v[32:35], a[0:3]
  ds_read_b64_tr_b16 a[184:185], v219 offset:32768
  v_lshl_add_u32 v253, v254, 30, v253
  v_mfma_f32_16x16x32_bf16 a[4:7], a[164:167], v[40:43], a[4:7]
  v_exp_f32 v97, v97
  v_mfma_f32_16x16x32_bf16 a[4:7], a[160:163], v[8:11], a[4:7]
  ds_read_b64_tr_b16 a[186:187], v219 offset:36864
  v_cvt_pk_bf16_f32 v96, v96, v97
  v_mfma_f32_16x16x32_bf16 a[8:11], a[160:163], v[16:19], a[8:11]
  v_exp_f32 v98, v98
  v_mfma_f32_16x16x32_bf16 a[8:11], a[164:167], v[48:51], a[8:11]
  ds_read_b64_tr_b16 a[188:189], v219 offset:40960
  v_mfma_f32_16x16x32_bf16 a[12:15], a[164:167], v[56:59], a[12:15]
  s_waitcnt lgkmcnt(7)
  v_exp_f32 v99, v99
  v_mfma_f32_16x16x32_bf16 a[12:15], a[160:163], v[24:27], a[12:15]
  ds_read_b64_tr_b16 a[190:191], v219 offset:45056
  v_cvt_pk_bf16_f32 v97, v98, v99
  v_mfma_f32_16x16x32_bf16 a[16:19], a[168:171], v[0:3], a[16:19]
  v_exp_f32 v104, v104
  v_mfma_f32_16x16x32_bf16 a[16:19], a[172:175], v[32:35], a[16:19]
  ds_read_b64_tr_b16 a[160:161], v220 offset:32768
  v_mfma_f32_16x16x32_bf16 a[20:23], a[172:175], v[40:43], a[20:23]
  v_exp_f32 v105, v105
  v_mfma_f32_16x16x32_bf16 a[20:23], a[168:171], v[8:11], a[20:23]
  ds_read_b64_tr_b16 a[162:163], v220 offset:36864
  v_cvt_pk_bf16_f32 v104, v104, v105
  v_mfma_f32_16x16x32_bf16 a[24:27], a[168:171], v[16:19], a[24:27]
  v_exp_f32 v106, v106
  v_mfma_f32_16x16x32_bf16 a[24:27], a[172:175], v[48:51], a[24:27]
  ds_read_b64_tr_b16 a[164:165], v220 offset:40960
  v_mfma_f32_16x16x32_bf16 a[28:31], a[172:175], v[56:59], a[28:31]
  s_waitcnt lgkmcnt(7)
  v_exp_f32 v107, v107
  v_mfma_f32_16x16x32_bf16 a[28:31], a[168:171], v[24:27], a[28:31]
  ds_read_b64_tr_b16 a[166:167], v220 offset:45056
  v_cvt_pk_bf16_f32 v105, v106, v107
  v_mfma_f32_16x16x32_bf16 a[32:35], a[176:179], v[0:3], a[32:35]
  v_exp_f32 v112, v112
  v_mfma_f32_16x16x32_bf16 a[32:35], a[180:183], v[32:35], a[32:35]
  ds_read_b64_tr_b16 a[168:169], v221 offset:32768
  v_mfma_f32_16x16x32_bf16 a[36:39], a[180:183], v[40:43], a[36:39]
  v_exp_f32 v113, v113
  v_mfma_f32_16x16x32_bf16 a[36:39], a[176:179], v[8:11], a[36:39]
  ds_read_b64_tr_b16 a[170:171], v221 offset:36864
  v_cvt_pk_bf16_f32 v112, v112, v113
  v_mfma_f32_16x16x32_bf16 a[40:43], a[176:179], v[16:19], a[40:43]
  v_exp_f32 v114, v114
  v_mfma_f32_16x16x32_bf16 a[40:43], a[180:183], v[48:51], a[40:43]
  ds_read_b64_tr_b16 a[172:173], v221 offset:40960
  v_mfma_f32_16x16x32_bf16 a[44:47], a[180:183], v[56:59], a[44:47]
  s_waitcnt lgkmcnt(7)
  v_exp_f32 v115, v115
  v_mfma_f32_16x16x32_bf16 a[44:47], a[176:179], v[24:27], a[44:47]
  ds_read_b64_tr_b16 a[174:175], v221 offset:45056
  v_cvt_pk_bf16_f32 v113, v114, v115
  v_mfma_f32_16x16x32_bf16 a[48:51], a[184:187], v[0:3], a[48:51]
  v_exp_f32 v120, v120
  v_mfma_f32_16x16x32_bf16 a[48:51], a[188:191], v[32:35], a[48:51]
  ds_read_b64_tr_b16 a[176:177], v222 offset:32768
  v_mfma_f32_16x16x32_bf16 a[52:55], a[188:191], v[40:43], a[52:55]
  v_exp_f32 v121, v121
  v_mfma_f32_16x16x32_bf16 a[52:55], a[184:187], v[8:11], a[52:55]
  ds_read_b64_tr_b16 a[178:179], v222 offset:36864
  v_cvt_pk_bf16_f32 v120, v120, v121
  v_mfma_f32_16x16x32_bf16 a[56:59], a[184:187], v[16:19], a[56:59]
  v_exp_f32 v122, v122
  v_mfma_f32_16x16x32_bf16 a[56:59], a[188:191], v[48:51], a[56:59]
  ds_read_b64_tr_b16 a[180:181], v222 offset:40960
  v_mfma_f32_16x16x32_bf16 a[60:63], a[188:191], v[56:59], a[60:63]
  s_waitcnt lgkmcnt(7)
  v_exp_f32 v123, v123
  v_mfma_f32_16x16x32_bf16 a[60:63], a[184:187], v[24:27], a[60:63]
  ds_read_b64_tr_b16 a[182:183], v222 offset:45056
  v_cvt_pk_bf16_f32 v121, v122, v123
  v_mfma_f32_16x16x32_bf16 a[64:67], a[160:163], v[0:3], a[64:67]
  v_exp_f32 v100, v100
  v_mfma_f32_16x16x32_bf16 a[64:67], a[164:167], v[32:35], a[64:67]
  ds_read_b64_tr_b16 a[184:185], v223 offset:32768
  v_mfma_f32_16x16x32_bf16 a[68:71], a[164:167], v[40:43], a[68:71]
  v_exp_f32 v101, v101
  v_mfma_f32_16x16x32_bf16 a[68:71], a[160:163], v[8:11], a[68:71]
  ds_read_b64_tr_b16 a[186:187], v223 offset:36864
  v_cvt_pk_bf16_f32 v98, v100, v101
  v_mfma_f32_16x16x32_bf16 a[72:75], a[160:163], v[16:19], a[72:75]
  v_exp_f32 v102, v102
  v_mfma_f32_16x16x32_bf16 a[72:75], a[164:167], v[48:51], a[72:75]
  ds_read_b64_tr_b16 a[188:189], v223 offset:40960
  v_mfma_f32_16x16x32_bf16 a[76:79], a[164:167], v[56:59], a[76:79]
  s_waitcnt lgkmcnt(7)
  v_exp_f32 v103, v103
  v_mfma_f32_16x16x32_bf16 a[76:79], a[160:163], v[24:27], a[76:79]
  ds_read_b64_tr_b16 a[190:191], v223 offset:45056
  v_cvt_pk_bf16_f32 v99, v102, v103
  v_mfma_f32_16x16x32_bf16 a[80:83], a[168:171], v[0:3], a[80:83]
  s_waitcnt vmcnt(11)
  v_exp_f32 v108, v108
  v_mfma_f32_16x16x32_bf16 a[80:83], a[172:175], v[32:35], a[80:83]
  v_mfma_f32_16x16x32_bf16 a[84:87], a[172:175], v[40:43], a[84:87]
  s_barrier
  v_exp_f32 v109, v109
  v_mfma_f32_16x16x32_bf16 a[84:87], a[168:171], v[8:11], a[84:87]
  ds_read_b128 a[128:131], v212 offset:0
  v_cvt_pk_bf16_f32 v106, v108, v109
  v_mfma_f32_16x16x32_bf16 a[88:91], a[168:171], v[16:19], a[88:91]
  v_exp_f32 v110, v110
  v_mfma_f32_16x16x32_bf16 a[88:91], a[172:175], v[48:51], a[88:91]
  ds_read_b128 a[132:135], v213 offset:0
  v_mfma_f32_16x16x32_bf16 a[92:95], a[172:175], v[56:59], a[92:95]
  s_waitcnt lgkmcnt(6)
  v_exp_f32 v111, v111
  v_mfma_f32_16x16x32_bf16 a[92:95], a[168:171], v[24:27], a[92:95]
  ds_read_b128 a[136:139], v214 offset:0
  v_cvt_pk_bf16_f32 v107, v110, v111
  v_mfma_f32_16x16x32_bf16 a[96:99], a[176:179], v[0:3], a[96:99]
  v_exp_f32 v116, v116
  v_mfma_f32_16x16x32_bf16 a[96:99], a[180:183], v[32:35], a[96:99]
  ds_read_b128 a[140:143], v215 offset:0
  buffer_load_dwordx4 a[220:223], v243, s[24:27], s38 offen sc1
  s_add_u32 s38, s38, 4096
  v_mfma_f32_16x16x32_bf16 a[100:103], a[180:183], v[40:43], a[100:103]
  v_exp_f32 v117, v117
  v_mfma_f32_16x16x32_bf16 a[100:103], a[176:179], v[8:11], a[100:103]
  v_cvt_pk_bf16_f32 v114, v116, v117
  v_mfma_f32_16x16x32_bf16 a[104:107], a[176:179], v[16:19], a[104:107]
  v_exp_f32 v118, v118
  v_mfma_f32_16x16x32_bf16 a[104:107], a[180:183], v[48:51], a[104:107]
  v_mfma_f32_16x16x32_bf16 a[108:111], a[180:183], v[56:59], a[108:111]
  s_waitcnt lgkmcnt(4)
  v_exp_f32 v119, v119
  v_mfma_f32_16x16x32_bf16 a[108:111], a[176:179], v[24:27], a[108:111]
  v_cvt_pk_bf16_f32 v115, v118, v119
  v_mfma_f32_16x16x32_bf16 a[112:115], a[184:187], v[0:3], a[112:115]
  v_exp_f32 v124, v124
  v_mfma_f32_16x16x32_bf16 a[112:115], a[188:191], v[32:35], a[112:115]
  v_mfma_f32_16x16x32_bf16 a[116:119], a[188:191], v[40:43], a[116:119]
  v_exp_f32 v125, v125
  v_mfma_f32_16x16x32_bf16 a[116:119], a[184:187], v[8:11], a[116:119]
  v_cvt_pk_bf16_f32 v122, v124, v125
  v_mfma_f32_16x16x32_bf16 a[120:123], a[184:187], v[16:19], a[120:123]
  v_exp_f32 v126, v126
  v_mfma_f32_16x16x32_bf16 a[120:123], a[188:191], v[48:51], a[120:123]
  v_mfma_f32_16x16x32_bf16 a[124:127], a[188:191], v[56:59], a[124:127]
  s_waitcnt lgkmcnt(0)
  v_exp_f32 v127, v127
  v_mfma_f32_16x16x32_bf16 a[124:127], a[184:187], v[24:27], a[124:127]
  v_cvt_pk_bf16_f32 v123, v126, v127
  v_mfma_f32_16x16x32_bf16 v[0:3], a[128:131], v[128:131], v[192:195]
  s_add_u32 m0, s28, 81920
  v_mfma_f32_16x16x32_bf16 v[0:3], a[132:135], v[132:135], v[0:3]
  ds_read_b128 a[144:147], v212 offset:4096
  v_mfma_f32_16x16x32_bf16 v[0:3], a[136:139], v[136:139], v[0:3]
  buffer_load_dwordx4 v236, s[16:19], s29 offen offset:0 lds
  v_mfma_f32_16x16x32_bf16 v[0:3], a[140:143], v[140:143], v[0:3]
  ds_read_b128 a[148:151], v213 offset:4096
  v_mfma_f32_16x16x32_bf16 v[8:11], a[140:143], v[156:159], v[196:199]
  v_mfma_f32_16x16x32_bf16 v[8:11], a[136:139], v[152:155], v[8:11]
  ds_read_b128 a[152:155], v214 offset:4096
  v_mfma_f32_16x16x32_bf16 v[8:11], a[132:135], v[148:151], v[8:11]
  buffer_load_dwordx4 v237, s[16:19], s29 offen offset:1024 lds
  v_mfma_f32_16x16x32_bf16 v[8:11], a[128:131], v[144:147], v[8:11]
  ds_read_b128 a[156:159], v215 offset:4096
  v_mfma_f32_16x16x32_bf16 v[16:19], a[128:131], v[160:163], v[200:203]
  v_exp_f32 v0, v0
  v_mfma_f32_16x16x32_bf16 v[16:19], a[132:135], v[164:167], v[16:19]
  v_mfma_f32_16x16x32_bf16 v[16:19], a[136:139], v[168:171], v[16:19]
  v_exp_f32 v1, v1
  v_mfma_f32_16x16x32_bf16 v[16:19], a[140:143], v[172:175], v[16:19]
  v_cvt_pk_bf16_f32 v0, v0, v1
  v_mfma_f32_16x16x32_bf16 v[24:27], a[140:143], v[188:191], v[204:207]
  v_exp_f32 v2, v2
  v_mfma_f32_16x16x32_bf16 v[24:27], a[136:139], v[184:187], v[24:27]
  buffer_load_dwordx4 v236, s[16:19], s29 offen offset:2048 lds
  v_mfma_f32_16x16x32_bf16 v[24:27], a[132:135], v[180:183], v[24:27]
  s_waitcnt lgkmcnt(0)
  v_exp_f32 v3, v3
  v_mfma_f32_16x16x32_bf16 v[24:27], a[128:131], v[176:179], v[24:27]
  v_cvt_pk_bf16_f32 v1, v2, v3
  v_mfma_f32_16x16x32_bf16 v[4:7], a[144:147], v[128:131], v[192:195]
  v_exp_f32 v8, v8
  v_mfma_f32_16x16x32_bf16 v[4:7], a[148:151], v[132:135], v[4:7]
  ds_read_b128 a[128:131], v212 offset:8192
  v_mfma_f32_16x16x32_bf16 v[4:7], a[152:155], v[136:139], v[4:7]
  v_exp_f32 v9, v9
  v_mfma_f32_16x16x32_bf16 v[4:7], a[156:159], v[140:143], v[4:7]
  ds_read_b128 a[132:135], v213 offset:8192
  v_cvt_pk_bf16_f32 v8, v8, v9
  v_mfma_f32_16x16x32_bf16 v[12:15], a[156:159], v[156:159], v[196:199]
  v_exp_f32 v10, v10
  v_mfma_f32_16x16x32_bf16 v[12:15], a[152:155], v[152:155], v[12:15]
  ds_read_b128 a[136:139], v214 offset:8192
  v_mfma_f32_16x16x32_bf16 v[12:15], a[148:151], v[148:151], v[12:15]
  v_exp_f32 v11, v11
  v_mfma_f32_16x16x32_bf16 v[12:15], a[144:147], v[144:147], v[12:15]
  ds_read_b128 a[140:143], v215 offset:8192
  v_cvt_pk_bf16_f32 v9, v10, v11
  v_mfma_f32_16x16x32_bf16 v[20:23], a[144:147], v[160:163], v[200:203]
  v_exp_f32 v16, v16
  v_mfma_f32_16x16x32_bf16 v[20:23], a[148:151], v[164:167], v[20:23]
  buffer_load_dwordx4 v237, s[16:19], s29 offen offset:3072 lds
  v_mfma_f32_16x16x32_bf16 v[20:23], a[152:155], v[168:171], v[20:23]
  s_add_u32 s29, s29, 16384
  v_exp_f32 v17, v17
  v_mfma_f32_16x16x32_bf16 v[20:23], a[156:159], v[172:175], v[20:23]
  v_cvt_pk_bf16_f32 v16, v16, v17
  v_mfma_f32_16x16x32_bf16 v[28:31], a[156:159], v[188:191], v[204:207]
  s_add_u32 m0, s28, 32768
  v_exp_f32 v18, v18
  v_mfma_f32_16x16x32_bf16 v[28:31], a[152:155], v[184:187], v[28:31]
  buffer_load_dwordx4 v232, s[12:15], s29 offen offset:0 lds
  v_mfma_f32_16x16x32_bf16 v[28:31], a[148:151], v[180:183], v[28:31]
  s_waitcnt lgkmcnt(0)
  v_exp_f32 v19, v19
  v_mfma_f32_16x16x32_bf16 v[28:31], a[144:147], v[176:179], v[28:31]
  v_cvt_pk_bf16_f32 v17, v18, v19
  v_mfma_f32_16x16x32_bf16 v[32:35], a[128:131], v[128:131], v[192:195]
  v_exp_f32 v24, v24
  v_mfma_f32_16x16x32_bf16 v[32:35], a[132:135], v[132:135], v[32:35]
  ds_read_b128 a[144:147], v212 offset:12288
  v_mfma_f32_16x16x32_bf16 v[32:35], a[136:139], v[136:139], v[32:35]
  v_exp_f32 v25, v25
  v_mfma_f32_16x16x32_bf16 v[32:35], a[140:143], v[140:143], v[32:35]
  ds_read_b128 a[148:151], v213 offset:12288
  v_cvt_pk_bf16_f32 v24, v24, v25
  v_mfma_f32_16x16x32_bf16 v[40:43], a[140:143], v[156:159], v[196:199]
  v_exp_f32 v26, v26
  v_mfma_f32_16x16x32_bf16 v[40:43], a[136:139], v[152:155], v[40:43]
  ds_read_b128 a[152:155], v214 offset:12288
  v_mfma_f32_16x16x32_bf16 v[40:43], a[132:135], v[148:151], v[40:43]
  v_exp_f32 v27, v27
  v_mfma_f32_16x16x32_bf16 v[40:43], a[128:131], v[144:147], v[40:43]
  ds_read_b128 a[156:159], v215 offset:12288
  v_cvt_pk_bf16_f32 v25, v26, v27
  v_mfma_f32_16x16x32_bf16 v[48:51], a[128:131], v[160:163], v[200:203]
  v_exp_f32 v4, v4
  v_mfma_f32_16x16x32_bf16 v[48:51], a[132:135], v[164:167], v[48:51]
  buffer_load_dwordx4 v233, s[12:15], s29 offen offset:1024 lds
  v_mfma_f32_16x16x32_bf16 v[48:51], a[136:139], v[168:171], v[48:51]
  v_exp_f32 v5, v5
  v_mfma_f32_16x16x32_bf16 v[48:51], a[140:143], v[172:175], v[48:51]
  v_cvt_pk_bf16_f32 v2, v4, v5
  v_mfma_f32_16x16x32_bf16 v[56:59], a[140:143], v[188:191], v[204:207]
  v_exp_f32 v6, v6
  v_mfma_f32_16x16x32_bf16 v[56:59], a[136:139], v[184:187], v[56:59]
  buffer_load_dwordx4 v234, s[12:15], s29 offen offset:2048 lds
  v_mfma_f32_16x16x32_bf16 v[56:59], a[132:135], v[180:183], v[56:59]
  s_waitcnt lgkmcnt(0)
  v_exp_f32 v7, v7
  v_mfma_f32_16x16x32_bf16 v[56:59], a[128:131], v[176:179], v[56:59]
  v_cvt_pk_bf16_f32 v3, v6, v7
  v_mfma_f32_16x16x32_bf16 v[36:39], a[144:147], v[128:131], v[192:195]
  v_exp_f32 v12, v12
  v_mfma_f32_16x16x32_bf16 v[36:39], a[148:151], v[132:135], v[36:39]
  ds_read_b64_tr_b16 a[160:161], v216 offset:49152
  v_mfma_f32_16x16x32_bf16 v[36:39], a[152:155], v[136:139], v[36:39]
  v_exp_f32 v13, v13
  v_mfma_f32_16x16x32_bf16 v[36:39], a[156:159], v[140:143], v[36:39]
  ds_read_b64_tr_b16 a[162:163], v216 offset:53248
  v_cvt_pk_bf16_f32 v10, v12, v13
  v_mfma_f32_16x16x32_bf16 v[44:47], a[156:159], v[156:159], v[196:199]
  v_exp_f32 v14, v14
  v_mfma_f32_16x16x32_bf16 v[44:47], a[152:155], v[152:155], v[44:47]
  ds_read_b64_tr_b16 a[164:165], v216 offset:57344
  buffer_load_dwordx4 v235, s[12:15], s29 offen offset:3072 lds
  v_mfma_f32_16x16x32_bf16 v[44:47], a[148:151], v[148:151], v[44:47]
  v_exp_f32 v15, v15
  v_mfma_f32_16x16x32_bf16 v[44:47], a[144:147], v[144:147], v[44:47]
  ds_read_b64_tr_b16 a[166:167], v216 offset:61440
  v_cvt_pk_bf16_f32 v11, v14, v15
  v_mfma_f32_16x16x32_bf16 v[52:55], a[144:147], v[160:163], v[200:203]
  v_exp_f32 v20, v20
  v_mfma_f32_16x16x32_bf16 v[52:55], a[148:151], v[164:167], v[52:55]
  ds_read_b64_tr_b16 a[168:169], v217 offset:49152
  s_add_u32 m0, s50, 2048
  v_mfma_f32_16x16x32_bf16 v[52:55], a[152:155], v[168:171], v[52:55]
  v_exp_f32 v21, v21
  v_mfma_f32_16x16x32_bf16 v[52:55], a[156:159], v[172:175], v[52:55]
  ds_read_b64_tr_b16 a[170:171], v217 offset:53248
  v_cvt_pk_bf16_f32 v18, v20, v21
  v_mfma_f32_16x16x32_bf16 v[60:63], a[156:159], v[188:191], v[204:207]
  v_exp_f32 v22, v22
  v_mfma_f32_16x16x32_bf16 v[60:63], a[152:155], v[184:187], v[60:63]
  ds_read_b64_tr_b16 a[172:173], v217 offset:57344
  buffer_load_dwordx4 v253, s[20:23], s35 offen lds
  v_mfma_f32_16x16x32_bf16 v[60:63], a[148:151], v[180:183], v[60:63]
  v_exp_f32 v23, v23
  v_mfma_f32_16x16x32_bf16 v[60:63], a[144:147], v[176:179], v[60:63]
  ds_read_b64_tr_b16 a[174:175], v217 offset:61440
  v_cvt_pk_bf16_f32 v19, v22, v23
  v_mfma_f32_16x16x32_bf16 a[192:195], a[208:211], v[64:67], a[192:195]
  v_exp_f32 v28, v28
  v_mfma_f32_16x16x32_bf16 a[192:195], a[208:211], v[96:99], a[192:195]
  ds_read_b64_tr_b16 a[176:177], v218 offset:49152
  v_mfma_f32_16x16x32_bf16 a[196:199], a[208:211], v[72:75], a[196:199]
  v_exp_f32 v29, v29
  v_mfma_f32_16x16x32_bf16 a[196:199], a[208:211], v[104:107], a[196:199]
  ds_read_b64_tr_b16 a[178:179], v218 offset:53248
  v_cvt_pk_bf16_f32 v26, v28, v29
  v_mfma_f32_16x16x32_bf16 a[200:203], a[208:211], v[80:83], a[200:203]
  v_exp_f32 v30, v30
  v_mfma_f32_16x16x32_bf16 a[200:203], a[208:211], v[112:115], a[200:203]
  ds_read_b64_tr_b16 a[180:181], v218 offset:57344
  v_mfma_f32_16x16x32_bf16 a[204:207], a[208:211], v[88:91], a[204:207]
  s_waitcnt lgkmcnt(7)
  v_exp_f32 v31, v31
  v_mfma_f32_16x16x32_bf16 a[204:207], a[208:211], v[120:123], a[204:207]
  ds_read_b64_tr_b16 a[182:183], v218 offset:61440
  v_cvt_pk_bf16_f32 v27, v30, v31
  v_mfma_f32_16x16x32_bf16 a[0:3], a[160:163], v[64:67], a[0:3]
  v_exp_f32 v32, v32
  v_mfma_f32_16x16x32_bf16 a[0:3], a[164:167], v[96:99], a[0:3]
  ds_read_b64_tr_b16 a[184:185], v219 offset:49152
  v_mfma_f32_16x16x32_bf16 a[4:7], a[164:167], v[104:107], a[4:7]
  v_exp_f32 v33, v33
  v_mfma_f32_16x16x32_bf16 a[4:7], a[160:163], v[72:75], a[4:7]
  ds_read_b64_tr_b16 a[186:187], v219 offset:53248
  v_cvt_pk_bf16_f32 v32, v32, v33
  v_mfma_f32_16x16x32_bf16 a[8:11], a[160:163], v[80:83], a[8:11]
  v_exp_f32 v34, v34
  v_mfma_f32_16x16x32_bf16 a[8:11], a[164:167], v[112:115], a[8:11]
  ds_read_b64_tr_b16 a[188:189], v219 offset:57344
  v_mfma_f32_16x16x32_bf16 a[12:15], a[164:167], v[120:123], a[12:15]
  s_waitcnt lgkmcnt(7)
  v_exp_f32 v35, v35
  v_mfma_f32_16x16x32_bf16 a[12:15], a[160:163], v[88:91], a[12:15]
  ds_read_b64_tr_b16 a[190:191], v219 offset:61440
  v_cvt_pk_bf16_f32 v33, v34, v35
  v_mfma_f32_16x16x32_bf16 a[16:19], a[168:171], v[64:67], a[16:19]
  v_exp_f32 v40, v40
  v_mfma_f32_16x16x32_bf16 a[16:19], a[172:175], v[96:99], a[16:19]
  ds_read_b64_tr_b16 a[160:161], v220 offset:49152
  v_mfma_f32_16x16x32_bf16 a[20:23], a[172:175], v[104:107], a[20:23]
  v_exp_f32 v41, v41
  v_mfma_f32_16x16x32_bf16 a[20:23], a[168:171], v[72:75], a[20:23]
  ds_read_b64_tr_b16 a[162:163], v220 offset:53248
  v_cvt_pk_bf16_f32 v40, v40, v41
  v_mfma_f32_16x16x32_bf16 a[24:27], a[168:171], v[80:83], a[24:27]
  v_exp_f32 v42, v42
  v_mfma_f32_16x16x32_bf16 a[24:27], a[172:175], v[112:115], a[24:27]
  ds_read_b64_tr_b16 a[164:165], v220 offset:57344
  v_mfma_f32_16x16x32_bf16 a[28:31], a[172:175], v[120:123], a[28:31]
  s_waitcnt lgkmcnt(7)
  v_exp_f32 v43, v43
  v_mfma_f32_16x16x32_bf16 a[28:31], a[168:171], v[88:91], a[28:31]
  ds_read_b64_tr_b16 a[166:167], v220 offset:61440
  v_cvt_pk_bf16_f32 v41, v42, v43
  v_mfma_f32_16x16x32_bf16 a[32:35], a[176:179], v[64:67], a[32:35]
  v_exp_f32 v48, v48
  v_mfma_f32_16x16x32_bf16 a[32:35], a[180:183], v[96:99], a[32:35]
  ds_read_b64_tr_b16 a[168:169], v221 offset:49152
  v_mfma_f32_16x16x32_bf16 a[36:39], a[180:183], v[104:107], a[36:39]
  v_exp_f32 v49, v49
  v_mfma_f32_16x16x32_bf16 a[36:39], a[176:179], v[72:75], a[36:39]
  ds_read_b64_tr_b16 a[170:171], v221 offset:53248
  v_cvt_pk_bf16_f32 v48, v48, v49
  v_mfma_f32_16x16x32_bf16 a[40:43], a[176:179], v[80:83], a[40:43]
  v_exp_f32 v50, v50
  v_mfma_f32_16x16x32_bf16 a[40:43], a[180:183], v[112:115], a[40:43]
  ds_read_b64_tr_b16 a[172:173], v221 offset:57344
  v_mfma_f32_16x16x32_bf16 a[44:47], a[180:183], v[120:123], a[44:47]
  s_waitcnt lgkmcnt(7)
  v_exp_f32 v51, v51
  v_mfma_f32_16x16x32_bf16 a[44:47], a[176:179], v[88:91], a[44:47]
  ds_read_b64_tr_b16 a[174:175], v221 offset:61440
  v_cvt_pk_bf16_f32 v49, v50, v51
  v_mfma_f32_16x16x32_bf16 a[48:51], a[184:187], v[64:67], a[48:51]
  v_exp_f32 v56, v56
  v_mfma_f32_16x16x32_bf16 a[48:51], a[188:191], v[96:99], a[48:51]
  ds_read_b64_tr_b16 a[176:177], v222 offset:49152
  v_mfma_f32_16x16x32_bf16 a[52:55], a[188:191], v[104:107], a[52:55]
  v_exp_f32 v57, v57
  v_mfma_f32_16x16x32_bf16 a[52:55], a[184:187], v[72:75], a[52:55]
  ds_read_b64_tr_b16 a[178:179], v222 offset:53248
  v_cvt_pk_bf16_f32 v56, v56, v57
  v_mfma_f32_16x16x32_bf16 a[56:59], a[184:187], v[80:83], a[56:59]
  v_exp_f32 v58, v58
  v_mfma_f32_16x16x32_bf16 a[56:59], a[188:191], v[112:115], a[56:59]
  ds_read_b64_tr_b16 a[180:181], v222 offset:57344
  v_mfma_f32_16x16x32_bf16 a[60:63], a[188:191], v[120:123], a[60:63]
  s_waitcnt lgkmcnt(7)
  v_exp_f32 v59, v59
  v_mfma_f32_16x16x32_bf16 a[60:63], a[184:187], v[88:91], a[60:63]
  ds_read_b64_tr_b16 a[182:183], v222 offset:61440
  v_cvt_pk_bf16_f32 v57, v58, v59
  v_mfma_f32_16x16x32_bf16 a[64:67], a[160:163], v[64:67], a[64:67]
  v_exp_f32 v36, v36
  v_mfma_f32_16x16x32_bf16 a[64:67], a[164:167], v[96:99], a[64:67]
  ds_read_b64_tr_b16 a[184:185], v223 offset:49152
  v_mfma_f32_16x16x32_bf16 a[68:71], a[164:167], v[104:107], a[68:71]
  v_exp_f32 v37, v37
  v_mfma_f32_16x16x32_bf16 a[68:71], a[160:163], v[72:75], a[68:71]
  ds_read_b64_tr_b16 a[186:187], v223 offset:53248
  v_cvt_pk_bf16_f32 v34, v36, v37
  v_mfma_f32_16x16x32_bf16 a[72:75], a[160:163], v[80:83], a[72:75]
  v_exp_f32 v38, v38
  v_mfma_f32_16x16x32_bf16 a[72:75], a[164:167], v[112:115], a[72:75]
  ds_read_b64_tr_b16 a[188:189], v223 offset:57344
  v_mfma_f32_16x16x32_bf16 a[76:79], a[164:167], v[120:123], a[76:79]
  s_waitcnt lgkmcnt(7)
  v_exp_f32 v39, v39
  v_mfma_f32_16x16x32_bf16 a[76:79], a[160:163], v[88:91], a[76:79]
  ds_read_b64_tr_b16 a[190:191], v223 offset:61440
  v_cvt_pk_bf16_f32 v35, v38, v39
  v_mfma_f32_16x16x32_bf16 a[80:83], a[168:171], v[64:67], a[80:83]
  s_waitcnt vmcnt(11)
  v_exp_f32 v44, v44
  v_mfma_f32_16x16x32_bf16 a[80:83], a[172:175], v[96:99], a[80:83]
  v_mfma_f32_16x16x32_bf16 a[84:87], a[172:175], v[104:107], a[84:87]
  s_barrier
  v_exp_f32 v45, v45
  v_mfma_f32_16x16x32_bf16 a[84:87], a[168:171], v[72:75], a[84:87]
  ds_read_b128 a[128:131], v212 offset:16384
  v_cvt_pk_bf16_f32 v42, v44, v45
  v_mfma_f32_16x16x32_bf16 a[88:91], a[168:171], v[80:83], a[88:91]
  v_exp_f32 v46, v46
  v_mfma_f32_16x16x32_bf16 a[88:91], a[172:175], v[112:115], a[88:91]
  ds_read_b128 a[132:135], v213 offset:16384
  v_mfma_f32_16x16x32_bf16 a[92:95], a[172:175], v[120:123], a[92:95]
  s_waitcnt lgkmcnt(6)
  v_exp_f32 v47, v47
  v_mfma_f32_16x16x32_bf16 a[92:95], a[168:171], v[88:91], a[92:95]
  ds_read_b128 a[136:139], v214 offset:16384
  v_cvt_pk_bf16_f32 v43, v46, v47
  v_mfma_f32_16x16x32_bf16 a[96:99], a[176:179], v[64:67], a[96:99]
  v_exp_f32 v52, v52
  v_mfma_f32_16x16x32_bf16 a[96:99], a[180:183], v[96:99], a[96:99]
  ds_read_b128 a[140:143], v215 offset:16384
  buffer_load_dwordx4 a[224:227], v243, s[24:27], s38 offen sc1
  s_add_u32 s38, s38, 4096
  v_mfma_f32_16x16x32_bf16 a[100:103], a[180:183], v[104:107], a[100:103]
  v_exp_f32 v53, v53
  v_mfma_f32_16x16x32_bf16 a[100:103], a[176:179], v[72:75], a[100:103]
  v_cvt_pk_bf16_f32 v50, v52, v53
  v_mfma_f32_16x16x32_bf16 a[104:107], a[176:179], v[80:83], a[104:107]
  v_exp_f32 v54, v54
  v_mfma_f32_16x16x32_bf16 a[104:107], a[180:183], v[112:115], a[104:107]
  v_mfma_f32_16x16x32_bf16 a[108:111], a[180:183], v[120:123], a[108:111]
  s_waitcnt lgkmcnt(4)
  v_exp_f32 v55, v55
  v_mfma_f32_16x16x32_bf16 a[108:111], a[176:179], v[88:91], a[108:111]
  v_cvt_pk_bf16_f32 v51, v54, v55
  v_mfma_f32_16x16x32_bf16 a[112:115], a[184:187], v[64:67], a[112:115]
  v_exp_f32 v60, v60
  v_mfma_f32_16x16x32_bf16 a[112:115], a[188:191], v[96:99], a[112:115]
  v_mfma_f32_16x16x32_bf16 a[116:119], a[188:191], v[104:107], a[116:119]
  v_exp_f32 v61, v61
  v_mfma_f32_16x16x32_bf16 a[116:119], a[184:187], v[72:75], a[116:119]
  v_cvt_pk_bf16_f32 v58, v60, v61
  v_mfma_f32_16x16x32_bf16 a[120:123], a[184:187], v[80:83], a[120:123]
  v_exp_f32 v62, v62
  v_mfma_f32_16x16x32_bf16 a[120:123], a[188:191], v[112:115], a[120:123]
  v_mfma_f32_16x16x32_bf16 a[124:127], a[188:191], v[120:123], a[124:127]
  s_waitcnt lgkmcnt(0)
  v_exp_f32 v63, v63
  v_mfma_f32_16x16x32_bf16 a[124:127], a[184:187], v[88:91], a[124:127]
  v_cvt_pk_bf16_f32 v59, v62, v63
  v_mfma_f32_16x16x32_bf16 v[64:67], a[128:131], v[128:131], v[192:195]
  s_add_u32 m0, s28, 98304
  v_mfma_f32_16x16x32_bf16 v[64:67], a[132:135], v[132:135], v[64:67]
  ds_read_b128 a[144:147], v212 offset:20480
  v_mfma_f32_16x16x32_bf16 v[64:67], a[136:139], v[136:139], v[64:67]
  buffer_load_dwordx4 v236, s[16:19], s29 offen offset:0 lds
  v_mfma_f32_16x16x32_bf16 v[64:67], a[140:143], v[140:143], v[64:67]
  ds_read_b128 a[148:151], v213 offset:20480
  v_mfma_f32_16x16x32_bf16 v[72:75], a[140:143], v[156:159], v[196:199]
  v_mfma_f32_16x16x32_bf16 v[72:75], a[136:139], v[152:155], v[72:75]
  ds_read_b128 a[152:155], v214 offset:20480
  v_mfma_f32_16x16x32_bf16 v[72:75], a[132:135], v[148:151], v[72:75]
  buffer_load_dwordx4 v237, s[16:19], s29 offen offset:1024 lds
  v_mfma_f32_16x16x32_bf16 v[72:75], a[128:131], v[144:147], v[72:75]
  ds_read_b128 a[156:159], v215 offset:20480
  v_mfma_f32_16x16x32_bf16 v[80:83], a[128:131], v[160:163], v[200:203]
  v_exp_f32 v64, v64
  v_mfma_f32_16x16x32_bf16 v[80:83], a[132:135], v[164:167], v[80:83]
  v_mfma_f32_16x16x32_bf16 v[80:83], a[136:139], v[168:171], v[80:83]
  v_exp_f32 v65, v65
  v_mfma_f32_16x16x32_bf16 v[80:83], a[140:143], v[172:175], v[80:83]
  v_cvt_pk_bf16_f32 v64, v64, v65
  v_mfma_f32_16x16x32_bf16 v[88:91], a[140:143], v[188:191], v[204:207]
  v_exp_f32 v66, v66
  v_mfma_f32_16x16x32_bf16 v[88:91], a[136:139], v[184:187], v[88:91]
  buffer_load_dwordx4 v236, s[16:19], s29 offen offset:2048 lds
  v_mfma_f32_16x16x32_bf16 v[88:91], a[132:135], v[180:183], v[88:91]
  s_waitcnt lgkmcnt(0)
  v_exp_f32 v67, v67
  v_mfma_f32_16x16x32_bf16 v[88:91], a[128:131], v[176:179], v[88:91]
  v_cvt_pk_bf16_f32 v65, v66, v67
  v_mfma_f32_16x16x32_bf16 v[68:71], a[144:147], v[128:131], v[192:195]
  v_exp_f32 v72, v72
  v_mfma_f32_16x16x32_bf16 v[68:71], a[148:151], v[132:135], v[68:71]
  ds_read_b128 a[128:131], v212 offset:24576
  v_mfma_f32_16x16x32_bf16 v[68:71], a[152:155], v[136:139], v[68:71]
  v_exp_f32 v73, v73
  v_mfma_f32_16x16x32_bf16 v[68:71], a[156:159], v[140:143], v[68:71]
  ds_read_b128 a[132:135], v213 offset:24576
  v_cvt_pk_bf16_f32 v72, v72, v73
  v_mfma_f32_16x16x32_bf16 v[76:79], a[156:159], v[156:159], v[196:199]
  v_exp_f32 v74, v74
  v_mfma_f32_16x16x32_bf16 v[76:79], a[152:155], v[152:155], v[76:79]
  ds_read_b128 a[136:139], v214 offset:24576
  v_mfma_f32_16x16x32_bf16 v[76:79], a[148:151], v[148:151], v[76:79]
  v_exp_f32 v75, v75
  v_mfma_f32_16x16x32_bf16 v[76:79], a[144:147], v[144:147], v[76:79]
  ds_read_b128 a[140:143], v215 offset:24576
  v_cvt_pk_bf16_f32 v73, v74, v75
  v_mfma_f32_16x16x32_bf16 v[84:87], a[144:147], v[160:163], v[200:203]
  v_exp_f32 v80, v80
  v_mfma_f32_16x16x32_bf16 v[84:87], a[148:151], v[164:167], v[84:87]
  buffer_load_dwordx4 v237, s[16:19], s29 offen offset:3072 lds
  v_mfma_f32_16x16x32_bf16 v[84:87], a[152:155], v[168:171], v[84:87]
  s_add_u32 s29, s29, 16384
  v_exp_f32 v81, v81
  v_mfma_f32_16x16x32_bf16 v[84:87], a[156:159], v[172:175], v[84:87]
  v_cvt_pk_bf16_f32 v80, v80, v81
  v_mfma_f32_16x16x32_bf16 v[92:95], a[156:159], v[188:191], v[204:207]
  s_add_u32 m0, s28, 49152
  v_exp_f32 v82, v82
  v_mfma_f32_16x16x32_bf16 v[92:95], a[152:155], v[184:187], v[92:95]
  buffer_load_dwordx4 v232, s[12:15], s29 offen offset:0 lds
  v_mfma_f32_16x16x32_bf16 v[92:95], a[148:151], v[180:183], v[92:95]
  s_waitcnt lgkmcnt(0)
  v_exp_f32 v83, v83
  v_mfma_f32_16x16x32_bf16 v[92:95], a[144:147], v[176:179], v[92:95]
  v_cvt_pk_bf16_f32 v81, v82, v83
  v_mfma_f32_16x16x32_bf16 v[96:99], a[128:131], v[128:131], v[192:195]
  v_exp_f32 v88, v88
  v_mfma_f32_16x16x32_bf16 v[96:99], a[132:135], v[132:135], v[96:99]
  ds_read_b128 a[144:147], v212 offset:28672
  v_mfma_f32_16x16x32_bf16 v[96:99], a[136:139], v[136:139], v[96:99]
  v_exp_f32 v89, v89
  v_mfma_f32_16x16x32_bf16 v[96:99], a[140:143], v[140:143], v[96:99]
  ds_read_b128 a[148:151], v213 offset:28672
  v_cvt_pk_bf16_f32 v88, v88, v89
  v_mfma_f32_16x16x32_bf16 v[104:107], a[140:143], v[156:159], v[196:199]
  v_exp_f32 v90, v90
  v_mfma_f32_16x16x32_bf16 v[104:107], a[136:139], v[152:155], v[104:107]
  ds_read_b128 a[152:155], v214 offset:28672
  v_mfma_f32_16x16x32_bf16 v[104:107], a[132:135], v[148:151], v[104:107]
  v_exp_f32 v91, v91
  v_mfma_f32_16x16x32_bf16 v[104:107], a[128:131], v[144:147], v[104:107]
  ds_read_b128 a[156:159], v215 offset:28672
  v_cvt_pk_bf16_f32 v89, v90, v91
  v_mfma_f32_16x16x32_bf16 v[112:115], a[128:131], v[160:163], v[200:203]
  v_exp_f32 v68, v68
  v_mfma_f32_16x16x32_bf16 v[112:115], a[132:135], v[164:167], v[112:115]
  buffer_load_dwordx4 v233, s[12:15], s29 offen offset:1024 lds
  v_mfma_f32_16x16x32_bf16 v[112:115], a[136:139], v[168:171], v[112:115]
  v_exp_f32 v69, v69
  v_mfma_f32_16x16x32_bf16 v[112:115], a[140:143], v[172:175], v[112:115]
  v_cvt_pk_bf16_f32 v66, v68, v69
  v_mfma_f32_16x16x32_bf16 v[120:123], a[140:143], v[188:191], v[204:207]
  v_exp_f32 v70, v70
  v_mfma_f32_16x16x32_bf16 v[120:123], a[136:139], v[184:187], v[120:123]
  buffer_load_dwordx4 v234, s[12:15], s29 offen offset:2048 lds
  v_mfma_f32_16x16x32_bf16 v[120:123], a[132:135], v[180:183], v[120:123]
  s_waitcnt lgkmcnt(0)
  v_exp_f32 v71, v71
  v_mfma_f32_16x16x32_bf16 v[120:123], a[128:131], v[176:179], v[120:123]
  v_cvt_pk_bf16_f32 v67, v70, v71
  v_mfma_f32_16x16x32_bf16 v[100:103], a[144:147], v[128:131], v[192:195]
  v_exp_f32 v76, v76
  v_mfma_f32_16x16x32_bf16 v[100:103], a[148:151], v[132:135], v[100:103]
  ds_read_b64_tr_b16 a[160:161], v216 offset:0
  v_mfma_f32_16x16x32_bf16 v[100:103], a[152:155], v[136:139], v[100:103]
  v_exp_f32 v77, v77
  v_mfma_f32_16x16x32_bf16 v[100:103], a[156:159], v[140:143], v[100:103]
  ds_read_b64_tr_b16 a[162:163], v216 offset:4096
  v_cvt_pk_bf16_f32 v74, v76, v77
  v_mfma_f32_16x16x32_bf16 v[108:111], a[156:159], v[156:159], v[196:199]
  v_exp_f32 v78, v78
  v_mfma_f32_16x16x32_bf16 v[108:111], a[152:155], v[152:155], v[108:111]
  ds_read_b64_tr_b16 a[164:165], v216 offset:8192
  buffer_load_dwordx4 v235, s[12:15], s29 offen offset:3072 lds
  v_mfma_f32_16x16x32_bf16 v[108:111], a[148:151], v[148:151], v[108:111]
  v_exp_f32 v79, v79
  v_mfma_f32_16x16x32_bf16 v[108:111], a[144:147], v[144:147], v[108:111]
  ds_read_b64_tr_b16 a[166:167], v216 offset:12288
  v_cvt_pk_bf16_f32 v75, v78, v79
  v_mfma_f32_16x16x32_bf16 v[116:119], a[144:147], v[160:163], v[200:203]
  v_exp_f32 v84, v84
  v_mfma_f32_16x16x32_bf16 v[116:119], a[148:151], v[164:167], v[116:119]
  ds_read_b64_tr_b16 a[168:169], v217 offset:0
  s_add_u32 m0, s50, 5120
  v_mfma_f32_16x16x32_bf16 v[116:119], a[152:155], v[168:171], v[116:119]
  v_exp_f32 v85, v85
  v_mfma_f32_16x16x32_bf16 v[116:119], a[156:159], v[172:175], v[116:119]
  ds_read_b64_tr_b16 a[170:171], v217 offset:4096
  v_cvt_pk_bf16_f32 v82, v84, v85
  v_mfma_f32_16x16x32_bf16 v[124:127], a[156:159], v[188:191], v[204:207]
  v_exp_f32 v86, v86
  v_mfma_f32_16x16x32_bf16 v[124:127], a[152:155], v[184:187], v[124:127]
  ds_read_b64_tr_b16 a[172:173], v217 offset:8192
  buffer_load_dwordx4 v253, s[44:47], s35 offen lds
  s_add_u32 s35, s35, 221184
  v_mfma_f32_16x16x32_bf16 v[124:127], a[148:151], v[180:183], v[124:127]
  v_exp_f32 v87, v87
  v_mfma_f32_16x16x32_bf16 v[124:127], a[144:147], v[176:179], v[124:127]
  ds_read_b64_tr_b16 a[174:175], v217 offset:12288
  v_cvt_pk_bf16_f32 v83, v86, v87
  v_mfma_f32_16x16x32_bf16 a[192:195], a[208:211], v[0:3], a[192:195]
  v_exp_f32 v92, v92
  v_mfma_f32_16x16x32_bf16 a[192:195], a[208:211], v[32:35], a[192:195]
  ds_read_b64_tr_b16 a[176:177], v218 offset:0
  v_mfma_f32_16x16x32_bf16 a[196:199], a[208:211], v[8:11], a[196:199]
  v_exp_f32 v93, v93
  v_mfma_f32_16x16x32_bf16 a[196:199], a[208:211], v[40:43], a[196:199]
  ds_read_b64_tr_b16 a[178:179], v218 offset:4096
  v_cvt_pk_bf16_f32 v90, v92, v93
  v_mfma_f32_16x16x32_bf16 a[200:203], a[208:211], v[16:19], a[200:203]
  v_exp_f32 v94, v94
  v_mfma_f32_16x16x32_bf16 a[200:203], a[208:211], v[48:51], a[200:203]
  ds_read_b64_tr_b16 a[180:181], v218 offset:8192
  v_mfma_f32_16x16x32_bf16 a[204:207], a[208:211], v[24:27], a[204:207]
  s_waitcnt lgkmcnt(7)
  v_exp_f32 v95, v95
  v_mfma_f32_16x16x32_bf16 a[204:207], a[208:211], v[56:59], a[204:207]
  ds_read_b64_tr_b16 a[182:183], v218 offset:12288
  v_cvt_pk_bf16_f32 v91, v94, v95
  v_mfma_f32_16x16x32_bf16 a[0:3], a[160:163], v[0:3], a[0:3]
  v_exp_f32 v96, v96
  v_mfma_f32_16x16x32_bf16 a[0:3], a[164:167], v[32:35], a[0:3]
  ds_read_b64_tr_b16 a[184:185], v219 offset:0
  v_mfma_f32_16x16x32_bf16 a[4:7], a[164:167], v[40:43], a[4:7]
  v_exp_f32 v97, v97
  v_mfma_f32_16x16x32_bf16 a[4:7], a[160:163], v[8:11], a[4:7]
  ds_read_b64_tr_b16 a[186:187], v219 offset:4096
  v_cvt_pk_bf16_f32 v96, v96, v97
  v_mfma_f32_16x16x32_bf16 a[8:11], a[160:163], v[16:19], a[8:11]
  v_exp_f32 v98, v98
  v_mfma_f32_16x16x32_bf16 a[8:11], a[164:167], v[48:51], a[8:11]
  ds_read_b64_tr_b16 a[188:189], v219 offset:8192
  v_mfma_f32_16x16x32_bf16 a[12:15], a[164:167], v[56:59], a[12:15]
  s_waitcnt lgkmcnt(7)
  v_exp_f32 v99, v99
  v_mfma_f32_16x16x32_bf16 a[12:15], a[160:163], v[24:27], a[12:15]
  ds_read_b64_tr_b16 a[190:191], v219 offset:12288
  v_cvt_pk_bf16_f32 v97, v98, v99
  v_mfma_f32_16x16x32_bf16 a[16:19], a[168:171], v[0:3], a[16:19]
  v_exp_f32 v104, v104
  v_mfma_f32_16x16x32_bf16 a[16:19], a[172:175], v[32:35], a[16:19]
  ds_read_b64_tr_b16 a[160:161], v220 offset:0
  v_mfma_f32_16x16x32_bf16 a[20:23], a[172:175], v[40:43], a[20:23]
  v_exp_f32 v105, v105
  v_mfma_f32_16x16x32_bf16 a[20:23], a[168:171], v[8:11], a[20:23]
  ds_read_b64_tr_b16 a[162:163], v220 offset:4096
  v_cvt_pk_bf16_f32 v104, v104, v105
  v_mfma_f32_16x16x32_bf16 a[24:27], a[168:171], v[16:19], a[24:27]
  v_exp_f32 v106, v106
  v_mfma_f32_16x16x32_bf16 a[24:27], a[172:175], v[48:51], a[24:27]
  ds_read_b64_tr_b16 a[164:165], v220 offset:8192
  v_mfma_f32_16x16x32_bf16 a[28:31], a[172:175], v[56:59], a[28:31]
  s_waitcnt lgkmcnt(7)
  v_exp_f32 v107, v107
  v_mfma_f32_16x16x32_bf16 a[28:31], a[168:171], v[24:27], a[28:31]
  ds_read_b64_tr_b16 a[166:167], v220 offset:12288
  v_cvt_pk_bf16_f32 v105, v106, v107
  v_mfma_f32_16x16x32_bf16 a[32:35], a[176:179], v[0:3], a[32:35]
  v_exp_f32 v112, v112
  v_mfma_f32_16x16x32_bf16 a[32:35], a[180:183], v[32:35], a[32:35]
  ds_read_b64_tr_b16 a[168:169], v221 offset:0
  v_mfma_f32_16x16x32_bf16 a[36:39], a[180:183], v[40:43], a[36:39]
  v_exp_f32 v113, v113
  v_mfma_f32_16x16x32_bf16 a[36:39], a[176:179], v[8:11], a[36:39]
  ds_read_b64_tr_b16 a[170:171], v221 offset:4096
  v_cvt_pk_bf16_f32 v112, v112, v113
  v_mfma_f32_16x16x32_bf16 a[40:43], a[176:179], v[16:19], a[40:43]
  v_exp_f32 v114, v114
  v_mfma_f32_16x16x32_bf16 a[40:43], a[180:183], v[48:51], a[40:43]
  ds_read_b64_tr_b16 a[172:173], v221 offset:8192
  v_mfma_f32_16x16x32_bf16 a[44:47], a[180:183], v[56:59], a[44:47]
  s_waitcnt lgkmcnt(7)
  v_exp_f32 v115, v115
  v_mfma_f32_16x16x32_bf16 a[44:47], a[176:179], v[24:27], a[44:47]
  ds_read_b64_tr_b16 a[174:175], v221 offset:12288
  v_cvt_pk_bf16_f32 v113, v114, v115
  v_mfma_f32_16x16x32_bf16 a[48:51], a[184:187], v[0:3], a[48:51]
  v_exp_f32 v120, v120
  v_mfma_f32_16x16x32_bf16 a[48:51], a[188:191], v[32:35], a[48:51]
  ds_read_b64_tr_b16 a[176:177], v222 offset:0
  v_mfma_f32_16x16x32_bf16 a[52:55], a[188:191], v[40:43], a[52:55]
  v_exp_f32 v121, v121
  v_mfma_f32_16x16x32_bf16 a[52:55], a[184:187], v[8:11], a[52:55]
  ds_read_b64_tr_b16 a[178:179], v222 offset:4096
  v_cvt_pk_bf16_f32 v120, v120, v121
  v_mfma_f32_16x16x32_bf16 a[56:59], a[184:187], v[16:19], a[56:59]
  v_exp_f32 v122, v122
  v_mfma_f32_16x16x32_bf16 a[56:59], a[188:191], v[48:51], a[56:59]
  ds_read_b64_tr_b16 a[180:181], v222 offset:8192
  v_mfma_f32_16x16x32_bf16 a[60:63], a[188:191], v[56:59], a[60:63]
  s_waitcnt lgkmcnt(7)
  v_exp_f32 v123, v123
  v_mfma_f32_16x16x32_bf16 a[60:63], a[184:187], v[24:27], a[60:63]
  ds_read_b64_tr_b16 a[182:183], v222 offset:12288
  v_cvt_pk_bf16_f32 v121, v122, v123
  v_mfma_f32_16x16x32_bf16 a[64:67], a[160:163], v[0:3], a[64:67]
  v_exp_f32 v100, v100
  v_mfma_f32_16x16x32_bf16 a[64:67], a[164:167], v[32:35], a[64:67]
  ds_read_b64_tr_b16 a[184:185], v223 offset:0
  v_mfma_f32_16x16x32_bf16 a[68:71], a[164:167], v[40:43], a[68:71]
  v_exp_f32 v101, v101
  v_mfma_f32_16x16x32_bf16 a[68:71], a[160:163], v[8:11], a[68:71]
  ds_read_b64_tr_b16 a[186:187], v223 offset:4096
  v_cvt_pk_bf16_f32 v98, v100, v101
  v_mfma_f32_16x16x32_bf16 a[72:75], a[160:163], v[16:19], a[72:75]
  v_exp_f32 v102, v102
  v_mfma_f32_16x16x32_bf16 a[72:75], a[164:167], v[48:51], a[72:75]
  ds_read_b64_tr_b16 a[188:189], v223 offset:8192
  v_mfma_f32_16x16x32_bf16 a[76:79], a[164:167], v[56:59], a[76:79]
  s_waitcnt lgkmcnt(7)
  v_exp_f32 v103, v103
  v_mfma_f32_16x16x32_bf16 a[76:79], a[160:163], v[24:27], a[76:79]
  ds_read_b64_tr_b16 a[190:191], v223 offset:12288
  v_cvt_pk_bf16_f32 v99, v102, v103
  v_mfma_f32_16x16x32_bf16 a[80:83], a[168:171], v[0:3], a[80:83]
  s_waitcnt vmcnt(11)
  v_exp_f32 v108, v108
  v_mfma_f32_16x16x32_bf16 a[80:83], a[172:175], v[32:35], a[80:83]
  v_mfma_f32_16x16x32_bf16 a[84:87], a[172:175], v[40:43], a[84:87]
  s_barrier
  v_exp_f32 v109, v109
  v_mfma_f32_16x16x32_bf16 a[84:87], a[168:171], v[8:11], a[84:87]
  ds_read_b128 a[128:131], v212 offset:32768
  v_cvt_pk_bf16_f32 v106, v108, v109
  v_mfma_f32_16x16x32_bf16 a[88:91], a[168:171], v[16:19], a[88:91]
  v_exp_f32 v110, v110
  v_mfma_f32_16x16x32_bf16 a[88:91], a[172:175], v[48:51], a[88:91]
  ds_read_b128 a[132:135], v213 offset:32768
  v_mfma_f32_16x16x32_bf16 a[92:95], a[172:175], v[56:59], a[92:95]
  s_waitcnt lgkmcnt(6)
  v_exp_f32 v111, v111
  v_mfma_f32_16x16x32_bf16 a[92:95], a[168:171], v[24:27], a[92:95]
  ds_read_b128 a[136:139], v214 offset:32768
  v_cvt_pk_bf16_f32 v107, v110, v111
  v_mfma_f32_16x16x32_bf16 a[96:99], a[176:179], v[0:3], a[96:99]
  v_exp_f32 v116, v116
  v_mfma_f32_16x16x32_bf16 a[96:99], a[180:183], v[32:35], a[96:99]
  ds_read_b128 a[140:143], v215 offset:32768
  buffer_load_dwordx4 a[228:231], v243, s[24:27], s38 offen sc1
  s_add_u32 s38, s38, 4096
  v_mfma_f32_16x16x32_bf16 a[100:103], a[180:183], v[40:43], a[100:103]
  v_exp_f32 v117, v117
  v_mfma_f32_16x16x32_bf16 a[100:103], a[176:179], v[8:11], a[100:103]
  v_cvt_pk_bf16_f32 v114, v116, v117
  v_mfma_f32_16x16x32_bf16 a[104:107], a[176:179], v[16:19], a[104:107]
  v_exp_f32 v118, v118
  v_mfma_f32_16x16x32_bf16 a[104:107], a[180:183], v[48:51], a[104:107]
  v_mfma_f32_16x16x32_bf16 a[108:111], a[180:183], v[56:59], a[108:111]
  s_waitcnt lgkmcnt(4)
  v_exp_f32 v119, v119
  v_mfma_f32_16x16x32_bf16 a[108:111], a[176:179], v[24:27], a[108:111]
  v_cvt_pk_bf16_f32 v115, v118, v119
  v_mfma_f32_16x16x32_bf16 a[112:115], a[184:187], v[0:3], a[112:115]
  v_exp_f32 v124, v124
  v_mfma_f32_16x16x32_bf16 a[112:115], a[188:191], v[32:35], a[112:115]
  v_mfma_f32_16x16x32_bf16 a[116:119], a[188:191], v[40:43], a[116:119]
  v_exp_f32 v125, v125
  v_mfma_f32_16x16x32_bf16 a[116:119], a[184:187], v[8:11], a[116:119]
  v_cvt_pk_bf16_f32 v122, v124, v125
  v_mfma_f32_16x16x32_bf16 a[120:123], a[184:187], v[16:19], a[120:123]
  v_exp_f32 v126, v126
  v_mfma_f32_16x16x32_bf16 a[120:123], a[188:191], v[48:51], a[120:123]
  v_mfma_f32_16x16x32_bf16 a[124:127], a[188:191], v[56:59], a[124:127]
  s_waitcnt lgkmcnt(0)
  v_exp_f32 v127, v127
  v_mfma_f32_16x16x32_bf16 a[124:127], a[184:187], v[24:27], a[124:127]
  v_cvt_pk_bf16_f32 v123, v126, v127
  v_mfma_f32_16x16x32_bf16 v[0:3], a[128:131], v[128:131], v[192:195]
  s_add_u32 m0, s28, 114688
  s_mov_b32 s20, s88
  s_mov_b32 s21, s89
  v_mfma_f32_16x16x32_bf16 v[0:3], a[132:135], v[132:135], v[0:3]
  ds_read_b128 a[144:147], v212 offset:36864
  s_mov_b32 s22, 5242880
  s_mov_b32 s23, 0x20000
  v_lshrrev_b32 v208, 4, v242
  v_mfma_f32_16x16x32_bf16 v[0:3], a[136:139], v[136:139], v[0:3]
  buffer_load_dwordx4 v236, s[16:19], s29 offen offset:0 lds
  v_mfma_f32_16x16x32_bf16 v[0:3], a[140:143], v[140:143], v[0:3]
  ds_read_b128 a[148:151], v213 offset:36864
  v_and_b32 v209, 1, v208
  v_mfma_f32_16x16x32_bf16 v[8:11], a[140:143], v[156:159], v[196:199]
  v_lshrrev_b32 v208, 1, v208
  v_mul_u32_u24 v208, 0x500, v208
  v_mfma_f32_16x16x32_bf16 v[8:11], a[136:139], v[152:155], v[8:11]
  ds_read_b128 a[152:155], v214 offset:36864
  v_lshl_add_u32 v208, v209, 4, v208
  v_mfma_f32_16x16x32_bf16 v[8:11], a[132:135], v[148:151], v[8:11]
  buffer_load_dwordx4 v237, s[16:19], s29 offen offset:1024 lds
  v_mfma_f32_16x16x32_bf16 v[8:11], a[128:131], v[144:147], v[8:11]
  ds_read_b128 a[156:159], v215 offset:36864
  v_lshrrev_b32 v209, 4, v242
  v_mfma_f32_16x16x32_bf16 v[16:19], a[128:131], v[160:163], v[200:203]
  v_exp_f32 v0, v0
  v_mfma_f32_16x16x32_bf16 v[16:19], a[132:135], v[164:167], v[16:19]
  v_lshrrev_b32 v210, 5, v209
  v_lshlrev_b32 v210, 30, v210
  v_mfma_f32_16x16x32_bf16 v[16:19], a[136:139], v[168:171], v[16:19]
  v_exp_f32 v1, v1
  v_mfma_f32_16x16x32_bf16 v[16:19], a[140:143], v[172:175], v[16:19]
  v_cvt_pk_bf16_f32 v0, v0, v1
  v_or_b32 v210, v210, v208
  v_mfma_f32_16x16x32_bf16 v[24:27], a[140:143], v[188:191], v[204:207]
  v_exp_f32 v2, v2
  v_mfma_f32_16x16x32_bf16 v[24:27], a[136:139], v[184:187], v[24:27]
  buffer_load_dwordx4 v236, s[16:19], s29 offen offset:2048 lds
  v_mfma_f32_16x16x32_bf16 v[24:27], a[132:135], v[180:183], v[24:27]
  s_waitcnt lgkmcnt(0)
  v_exp_f32 v3, v3
  v_mfma_f32_16x16x32_bf16 v[24:27], a[128:131], v[176:179], v[24:27]
  v_cvt_pk_bf16_f32 v1, v2, v3
  v_bfe_u32 v211, v209, 2, 4
  v_mfma_f32_16x16x32_bf16 v[4:7], a[144:147], v[128:131], v[192:195]
  v_exp_f32 v8, v8
  v_mfma_f32_16x16x32_bf16 v[4:7], a[148:151], v[132:135], v[4:7]
  ds_read_b128 a[128:131], v212 offset:40960
  v_and_b32 v209, 3, v209
  v_mfma_f32_16x16x32_bf16 v[4:7], a[152:155], v[136:139], v[4:7]
  v_exp_f32 v9, v9
  v_mfma_f32_16x16x32_bf16 v[4:7], a[156:159], v[140:143], v[4:7]
  ds_read_b128 a[132:135], v213 offset:40960
  v_cvt_pk_bf16_f32 v8, v8, v9
  v_mfma_f32_16x16x32_bf16 v[12:15], a[156:159], v[156:159], v[196:199]
  v_exp_f32 v10, v10
  v_mfma_f32_16x16x32_bf16 v[12:15], a[152:155], v[152:155], v[12:15]
  ds_read_b128 a[136:139], v214 offset:40960
  v_lshlrev_b32 v209, 3, v209
  v_mfma_f32_16x16x32_bf16 v[12:15], a[148:151], v[148:151], v[12:15]
  v_exp_f32 v11, v11
  v_mfma_f32_16x16x32_bf16 v[12:15], a[144:147], v[144:147], v[12:15]
  ds_read_b128 a[140:143], v215 offset:40960
  v_cvt_pk_bf16_f32 v9, v10, v11
  v_mfma_f32_16x16x32_bf16 v[20:23], a[144:147], v[160:163], v[200:203]
  v_exp_f32 v16, v16
  v_mfma_f32_16x16x32_bf16 v[20:23], a[148:151], v[164:167], v[20:23]
  buffer_load_dwordx4 v237, s[16:19], s29 offen offset:3072 lds
  v_mfma_f32_16x16x32_bf16 v[20:23], a[152:155], v[168:171], v[20:23]
  s_add_u32 s29, s29, 16384
  v_exp_f32 v17, v17
  v_mfma_f32_16x16x32_bf16 v[20:23], a[156:159], v[172:175], v[20:23]
  v_cvt_pk_bf16_f32 v16, v16, v17
  v_lshl_add_u32 v209, v211, 5, v209
  v_mfma_f32_16x16x32_bf16 v[28:31], a[156:159], v[188:191], v[204:207]
  s_add_u32 m0, s28, 0
  v_exp_f32 v18, v18
  v_mfma_f32_16x16x32_bf16 v[28:31], a[152:155], v[184:187], v[28:31]
  buffer_load_dwordx4 v232, s[12:15], s29 offen offset:0 lds
  v_mfma_f32_16x16x32_bf16 v[28:31], a[148:151], v[180:183], v[28:31]
  s_waitcnt lgkmcnt(0)
  v_exp_f32 v19, v19
  v_mfma_f32_16x16x32_bf16 v[28:31], a[144:147], v[176:179], v[28:31]
  v_cvt_pk_bf16_f32 v17, v18, v19
  v_add_u32 v209, s50, v209
  v_mfma_f32_16x16x32_bf16 v[32:35], a[128:131], v[128:131], v[192:195]
  s_and_b32 s39, s2, 1
  s_lshl_b32 s39, s39, 2
  s_add_u32 s39, s39, s3
  v_exp_f32 v24, v24
  v_mfma_f32_16x16x32_bf16 v[32:35], a[132:135], v[132:135], v[32:35]
  ds_read_b128 a[144:147], v212 offset:45056
  s_lshr_b32 s31, s2, 1
  s_mul_i32 s30, s31, 40960
  s_mul_i32 s48, s39, 160
  v_mfma_f32_16x16x32_bf16 v[32:35], a[136:139], v[136:139], v[32:35]
  s_add_u32 s30, s30, s48
  s_mul_i32 s31, s31, 5120
  s_mul_i32 s39, s39, 655360
  v_exp_f32 v25, v25
  v_mfma_f32_16x16x32_bf16 v[32:35], a[140:143], v[140:143], v[32:35]
  ds_read_b128 a[148:151], v213 offset:45056
  s_add_u32 s31, s31, s39
  s_add_u32 s31, s31, 3145728
  s_lshr_b32 s39, s2, 3
  v_cvt_pk_bf16_f32 v24, v24, v25
  v_mfma_f32_16x16x32_bf16 v[40:43], a[140:143], v[156:159], v[196:199]
  s_min_u32 s39, s39, 29
  s_and_b32 s48, s2, 7
  s_mul_i32 s48, s48, 30
  v_exp_f32 v26, v26
  v_mfma_f32_16x16x32_bf16 v[40:43], a[136:139], v[152:155], v[40:43]
  ds_read_b128 a[152:155], v214 offset:45056
  s_add_u32 s39, s39, s48
  s_mul_i32 s98, s39, 1639
  s_lshr_b32 s98, s98, 16
  v_mfma_f32_16x16x32_bf16 v[40:43], a[132:135], v[148:151], v[40:43]
  s_mul_i32 s99, s98, 40
  s_sub_u32 s99, s39, s99
  s_min_u32 s39, s3, 2
  v_exp_f32 v27, v27
  v_mfma_f32_16x16x32_bf16 v[40:43], a[128:131], v[144:147], v[40:43]
  ds_read_b128 a[156:159], v215 offset:45056
  s_mul_i32 s48, s98, 3
  s_add_u32 s48, s48, s39
  s_mul_i32 s100, s48, 122880
  v_cvt_pk_bf16_f32 v25, v26, v27
  v_mfma_f32_16x16x32_bf16 v[48:51], a[128:131], v[160:163], v[200:203]
  s_lshl_b32 s39, s99, 5
  s_add_u32 s100, s100, s39
  s_mul_i32 s101, s48, 192
  v_exp_f32 v4, v4
  v_mfma_f32_16x16x32_bf16 v[48:51], a[132:135], v[164:167], v[48:51]
  buffer_load_dwordx4 v233, s[12:15], s29 offen offset:1024 lds
  s_add_u32 s101, s101, 2633728
  s_mov_b32 s51, s50
  v_mfma_f32_16x16x32_bf16 v[48:51], a[136:139], v[168:171], v[48:51]
  v_exp_f32 v5, v5
  v_mfma_f32_16x16x32_bf16 v[48:51], a[140:143], v[172:175], v[48:51]
  v_cvt_pk_bf16_f32 v2, v4, v5
  v_mov_b32 v211, v242
  v_mfma_f32_16x16x32_bf16 v[56:59], a[140:143], v[188:191], v[204:207]
  s_mov_b32 s4, s94
  s_mov_b32 s5, s95
  s_mov_b32 s6, 2211840
  v_exp_f32 v6, v6
  v_mfma_f32_16x16x32_bf16 v[56:59], a[136:139], v[184:187], v[56:59]
  buffer_load_dwordx4 v234, s[12:15], s29 offen offset:2048 lds
  s_mov_b32 s7, 0x20000
  v_mfma_f32_16x16x32_bf16 v[56:59], a[132:135], v[180:183], v[56:59]
  s_waitcnt lgkmcnt(0)
  v_exp_f32 v7, v7
  v_mfma_f32_16x16x32_bf16 v[56:59], a[128:131], v[176:179], v[56:59]
  v_cvt_pk_bf16_f32 v3, v6, v7
  v_mfma_f32_16x16x32_bf16 v[36:39], a[144:147], v[128:131], v[192:195]
  v_exp_f32 v12, v12
  v_mfma_f32_16x16x32_bf16 v[36:39], a[148:151], v[132:135], v[36:39]
  ds_read_b64_tr_b16 a[160:161], v216 offset:16384
  v_mfma_f32_16x16x32_bf16 v[36:39], a[152:155], v[136:139], v[36:39]
  v_exp_f32 v13, v13
  v_mfma_f32_16x16x32_bf16 v[36:39], a[156:159], v[140:143], v[36:39]
  ds_read_b64_tr_b16 a[162:163], v216 offset:20480
  v_cvt_pk_bf16_f32 v10, v12, v13
  v_mfma_f32_16x16x32_bf16 v[44:47], a[156:159], v[156:159], v[196:199]
  v_exp_f32 v14, v14
  v_mfma_f32_16x16x32_bf16 v[44:47], a[152:155], v[152:155], v[44:47]
  ds_read_b64_tr_b16 a[164:165], v216 offset:24576
  buffer_load_dwordx4 v235, s[12:15], s29 offen offset:3072 lds
  v_mfma_f32_16x16x32_bf16 v[44:47], a[148:151], v[148:151], v[44:47]
  v_exp_f32 v15, v15
  v_mfma_f32_16x16x32_bf16 v[44:47], a[144:147], v[144:147], v[44:47]
  ds_read_b64_tr_b16 a[166:167], v216 offset:28672
  v_cvt_pk_bf16_f32 v11, v14, v15
  v_mfma_f32_16x16x32_bf16 v[52:55], a[144:147], v[160:163], v[200:203]
  v_exp_f32 v20, v20
  v_mfma_f32_16x16x32_bf16 v[52:55], a[148:151], v[164:167], v[52:55]
  ds_read_b64_tr_b16 a[168:169], v217 offset:16384
  v_mfma_f32_16x16x32_bf16 v[52:55], a[152:155], v[168:171], v[52:55]
  v_exp_f32 v21, v21
  v_mfma_f32_16x16x32_bf16 v[52:55], a[156:159], v[172:175], v[52:55]
  ds_read_b64_tr_b16 a[170:171], v217 offset:20480
  v_cvt_pk_bf16_f32 v18, v20, v21
  v_mfma_f32_16x16x32_bf16 v[60:63], a[156:159], v[188:191], v[204:207]
  v_exp_f32 v22, v22
  v_mfma_f32_16x16x32_bf16 v[60:63], a[152:155], v[184:187], v[60:63]
  ds_read_b64_tr_b16 a[172:173], v217 offset:24576
  v_mfma_f32_16x16x32_bf16 v[60:63], a[148:151], v[180:183], v[60:63]
  v_exp_f32 v23, v23
  v_mfma_f32_16x16x32_bf16 v[60:63], a[144:147], v[176:179], v[60:63]
  ds_read_b64_tr_b16 a[174:175], v217 offset:28672
  v_cvt_pk_bf16_f32 v19, v22, v23
  v_mfma_f32_16x16x32_bf16 a[192:195], a[208:211], v[64:67], a[192:195]
  v_exp_f32 v28, v28
  v_mfma_f32_16x16x32_bf16 a[192:195], a[208:211], v[96:99], a[192:195]
  ds_read_b64_tr_b16 a[176:177], v218 offset:16384
  v_mfma_f32_16x16x32_bf16 a[196:199], a[208:211], v[72:75], a[196:199]
  v_exp_f32 v29, v29
  v_mfma_f32_16x16x32_bf16 a[196:199], a[208:211], v[104:107], a[196:199]
  ds_read_b64_tr_b16 a[178:179], v218 offset:20480
  v_cvt_pk_bf16_f32 v26, v28, v29
  v_mfma_f32_16x16x32_bf16 a[200:203], a[208:211], v[80:83], a[200:203]
  v_exp_f32 v30, v30
  v_mfma_f32_16x16x32_bf16 a[200:203], a[208:211], v[112:115], a[200:203]
  ds_read_b64_tr_b16 a[180:181], v218 offset:24576
  v_mfma_f32_16x16x32_bf16 a[204:207], a[208:211], v[88:91], a[204:207]
  s_waitcnt lgkmcnt(7)
  v_exp_f32 v31, v31
  v_mfma_f32_16x16x32_bf16 a[204:207], a[208:211], v[120:123], a[204:207]
  ds_read_b64_tr_b16 a[182:183], v218 offset:28672
  v_cvt_pk_bf16_f32 v27, v30, v31
  v_mfma_f32_16x16x32_bf16 a[0:3], a[160:163], v[64:67], a[0:3]
  v_exp_f32 v32, v32
  v_mfma_f32_16x16x32_bf16 a[0:3], a[164:167], v[96:99], a[0:3]
  ds_read_b64_tr_b16 a[184:185], v219 offset:16384
  v_mfma_f32_16x16x32_bf16 a[4:7], a[164:167], v[104:107], a[4:7]
  v_exp_f32 v33, v33
  v_mfma_f32_16x16x32_bf16 a[4:7], a[160:163], v[72:75], a[4:7]
  ds_read_b64_tr_b16 a[186:187], v219 offset:20480
  v_cvt_pk_bf16_f32 v32, v32, v33
  v_mfma_f32_16x16x32_bf16 a[8:11], a[160:163], v[80:83], a[8:11]
  v_exp_f32 v34, v34
  v_mfma_f32_16x16x32_bf16 a[8:11], a[164:167], v[112:115], a[8:11]
  ds_read_b64_tr_b16 a[188:189], v219 offset:24576
  v_mfma_f32_16x16x32_bf16 a[12:15], a[164:167], v[120:123], a[12:15]
  s_waitcnt lgkmcnt(7)
  v_exp_f32 v35, v35
  v_mfma_f32_16x16x32_bf16 a[12:15], a[160:163], v[88:91], a[12:15]
  ds_read_b64_tr_b16 a[190:191], v219 offset:28672
  v_cvt_pk_bf16_f32 v33, v34, v35
  v_mfma_f32_16x16x32_bf16 a[16:19], a[168:171], v[64:67], a[16:19]
  v_exp_f32 v40, v40
  v_mfma_f32_16x16x32_bf16 a[16:19], a[172:175], v[96:99], a[16:19]
  ds_read_b64_tr_b16 a[160:161], v220 offset:16384
  v_mfma_f32_16x16x32_bf16 a[20:23], a[172:175], v[104:107], a[20:23]
  v_exp_f32 v41, v41
  v_mfma_f32_16x16x32_bf16 a[20:23], a[168:171], v[72:75], a[20:23]
  ds_read_b64_tr_b16 a[162:163], v220 offset:20480
  v_cvt_pk_bf16_f32 v40, v40, v41
  v_mfma_f32_16x16x32_bf16 a[24:27], a[168:171], v[80:83], a[24:27]
  v_exp_f32 v42, v42
  v_mfma_f32_16x16x32_bf16 a[24:27], a[172:175], v[112:115], a[24:27]
  ds_read_b64_tr_b16 a[164:165], v220 offset:24576
  v_mfma_f32_16x16x32_bf16 a[28:31], a[172:175], v[120:123], a[28:31]
  s_waitcnt lgkmcnt(7)
  v_exp_f32 v43, v43
  v_mfma_f32_16x16x32_bf16 a[28:31], a[168:171], v[88:91], a[28:31]
  ds_read_b64_tr_b16 a[166:167], v220 offset:28672
  v_cvt_pk_bf16_f32 v41, v42, v43
  v_mfma_f32_16x16x32_bf16 a[32:35], a[176:179], v[64:67], a[32:35]
  v_exp_f32 v48, v48
  v_mfma_f32_16x16x32_bf16 a[32:35], a[180:183], v[96:99], a[32:35]
  ds_read_b64_tr_b16 a[168:169], v221 offset:16384
  v_mfma_f32_16x16x32_bf16 a[36:39], a[180:183], v[104:107], a[36:39]
  v_exp_f32 v49, v49
  v_mfma_f32_16x16x32_bf16 a[36:39], a[176:179], v[72:75], a[36:39]
  ds_read_b64_tr_b16 a[170:171], v221 offset:20480
  v_cvt_pk_bf16_f32 v48, v48, v49
  v_mfma_f32_16x16x32_bf16 a[40:43], a[176:179], v[80:83], a[40:43]
  v_exp_f32 v50, v50
  v_mfma_f32_16x16x32_bf16 a[40:43], a[180:183], v[112:115], a[40:43]
  ds_read_b64_tr_b16 a[172:173], v221 offset:24576
  v_mfma_f32_16x16x32_bf16 a[44:47], a[180:183], v[120:123], a[44:47]
  s_waitcnt lgkmcnt(7)
  v_exp_f32 v51, v51
  v_mfma_f32_16x16x32_bf16 a[44:47], a[176:179], v[88:91], a[44:47]
  ds_read_b64_tr_b16 a[174:175], v221 offset:28672
  v_cvt_pk_bf16_f32 v49, v50, v51
  v_mfma_f32_16x16x32_bf16 a[48:51], a[184:187], v[64:67], a[48:51]
  v_exp_f32 v56, v56
  v_mfma_f32_16x16x32_bf16 a[48:51], a[188:191], v[96:99], a[48:51]
  ds_read_b64_tr_b16 a[176:177], v222 offset:16384
  v_mfma_f32_16x16x32_bf16 a[52:55], a[188:191], v[104:107], a[52:55]
  v_exp_f32 v57, v57
  v_mfma_f32_16x16x32_bf16 a[52:55], a[184:187], v[72:75], a[52:55]
  ds_read_b64_tr_b16 a[178:179], v222 offset:20480
  v_cvt_pk_bf16_f32 v56, v56, v57
  v_mfma_f32_16x16x32_bf16 a[56:59], a[184:187], v[80:83], a[56:59]
  v_exp_f32 v58, v58
  v_mfma_f32_16x16x32_bf16 a[56:59], a[188:191], v[112:115], a[56:59]
  ds_read_b64_tr_b16 a[180:181], v222 offset:24576
  v_mfma_f32_16x16x32_bf16 a[60:63], a[188:191], v[120:123], a[60:63]
  s_waitcnt lgkmcnt(7)
  v_exp_f32 v59, v59
  v_mfma_f32_16x16x32_bf16 a[60:63], a[184:187], v[88:91], a[60:63]
  ds_read_b64_tr_b16 a[182:183], v222 offset:28672
  v_cvt_pk_bf16_f32 v57, v58, v59
  v_mfma_f32_16x16x32_bf16 a[64:67], a[160:163], v[64:67], a[64:67]
  v_exp_f32 v36, v36
  v_mfma_f32_16x16x32_bf16 a[64:67], a[164:167], v[96:99], a[64:67]
  ds_read_b64_tr_b16 a[184:185], v223 offset:16384
  v_mfma_f32_16x16x32_bf16 a[68:71], a[164:167], v[104:107], a[68:71]
  v_exp_f32 v37, v37
  v_mfma_f32_16x16x32_bf16 a[68:71], a[160:163], v[72:75], a[68:71]
  ds_read_b64_tr_b16 a[186:187], v223 offset:20480
  v_cvt_pk_bf16_f32 v34, v36, v37
  v_mfma_f32_16x16x32_bf16 a[72:75], a[160:163], v[80:83], a[72:75]
  v_exp_f32 v38, v38
  v_mfma_f32_16x16x32_bf16 a[72:75], a[164:167], v[112:115], a[72:75]
  ds_read_b64_tr_b16 a[188:189], v223 offset:24576
  v_mfma_f32_16x16x32_bf16 a[76:79], a[164:167], v[120:123], a[76:79]
  s_waitcnt lgkmcnt(7)
  v_exp_f32 v39, v39
  v_mfma_f32_16x16x32_bf16 a[76:79], a[160:163], v[88:91], a[76:79]
  ds_read_b64_tr_b16 a[190:191], v223 offset:28672
  v_cvt_pk_bf16_f32 v35, v38, v39
  v_mfma_f32_16x16x32_bf16 a[80:83], a[168:171], v[64:67], a[80:83]
  s_waitcnt vmcnt(10)
  v_exp_f32 v44, v44
  v_mfma_f32_16x16x32_bf16 a[80:83], a[172:175], v[96:99], a[80:83]
  v_mfma_f32_16x16x32_bf16 a[84:87], a[172:175], v[104:107], a[84:87]
  s_barrier
  v_exp_f32 v45, v45
  v_mfma_f32_16x16x32_bf16 a[84:87], a[168:171], v[72:75], a[84:87]
  ds_read_b128 a[128:131], v212 offset:49152
  v_cvt_pk_bf16_f32 v42, v44, v45
  v_mfma_f32_16x16x32_bf16 a[88:91], a[168:171], v[80:83], a[88:91]
  v_exp_f32 v46, v46
  v_mfma_f32_16x16x32_bf16 a[88:91], a[172:175], v[112:115], a[88:91]
  ds_read_b128 a[132:135], v213 offset:49152
  v_mfma_f32_16x16x32_bf16 a[92:95], a[172:175], v[120:123], a[92:95]
  s_waitcnt lgkmcnt(6)
  v_exp_f32 v47, v47
  v_mfma_f32_16x16x32_bf16 a[92:95], a[168:171], v[88:91], a[92:95]
  ds_read_b128 a[136:139], v214 offset:49152
  v_cvt_pk_bf16_f32 v43, v46, v47
  v_mfma_f32_16x16x32_bf16 a[96:99], a[176:179], v[64:67], a[96:99]
  v_exp_f32 v52, v52
  v_mfma_f32_16x16x32_bf16 a[96:99], a[180:183], v[96:99], a[96:99]
  ds_read_b128 a[140:143], v215 offset:49152
  v_mfma_f32_16x16x32_bf16 a[100:103], a[180:183], v[104:107], a[100:103]
  v_exp_f32 v53, v53
  v_mfma_f32_16x16x32_bf16 a[100:103], a[176:179], v[72:75], a[100:103]
  v_cvt_pk_bf16_f32 v50, v52, v53
  v_mfma_f32_16x16x32_bf16 a[104:107], a[176:179], v[80:83], a[104:107]
  v_exp_f32 v54, v54
  v_mfma_f32_16x16x32_bf16 a[104:107], a[180:183], v[112:115], a[104:107]
  v_mfma_f32_16x16x32_bf16 a[108:111], a[180:183], v[120:123], a[108:111]
  s_waitcnt lgkmcnt(4)
  v_exp_f32 v55, v55
  v_mfma_f32_16x16x32_bf16 a[108:111], a[176:179], v[88:91], a[108:111]
  v_cvt_pk_bf16_f32 v51, v54, v55
  v_mfma_f32_16x16x32_bf16 a[112:115], a[184:187], v[64:67], a[112:115]
  v_exp_f32 v60, v60
  v_mfma_f32_16x16x32_bf16 a[112:115], a[188:191], v[96:99], a[112:115]
  v_mfma_f32_16x16x32_bf16 a[116:119], a[188:191], v[104:107], a[116:119]
  v_exp_f32 v61, v61
  v_mfma_f32_16x16x32_bf16 a[116:119], a[184:187], v[72:75], a[116:119]
  v_cvt_pk_bf16_f32 v58, v60, v61
  v_mfma_f32_16x16x32_bf16 a[120:123], a[184:187], v[80:83], a[120:123]
  v_exp_f32 v62, v62
  v_mfma_f32_16x16x32_bf16 a[120:123], a[188:191], v[112:115], a[120:123]
  v_mfma_f32_16x16x32_bf16 a[124:127], a[188:191], v[120:123], a[124:127]
  s_waitcnt lgkmcnt(0)
  v_exp_f32 v63, v63
  v_mfma_f32_16x16x32_bf16 a[124:127], a[184:187], v[88:91], a[124:127]
  v_cvt_pk_bf16_f32 v59, v62, v63
  v_mfma_f32_16x16x32_bf16 v[64:67], a[128:131], v[128:131], v[192:195]
  s_add_u32 m0, s28, 65536
  v_lshrrev_b32 v224, 4, v242
  v_lshrrev_b32 v225, 4, v224
  v_mfma_f32_16x16x32_bf16 v[64:67], a[132:135], v[132:135], v[64:67]
  ds_read_b128 a[144:147], v212 offset:53248
  v_bfe_u32 v226, v224, 2, 2
  v_mfma_f32_16x16x32_bf16 v[64:67], a[136:139], v[136:139], v[64:67]
  buffer_load_dwordx4 v236, s[16:19], s29 offen offset:0 lds
  v_mfma_f32_16x16x32_bf16 v[64:67], a[140:143], v[140:143], v[64:67]
  ds_read_b128 a[148:151], v213 offset:53248
  v_lshl_add_u32 v225, v225, 3, v226
  v_mfma_f32_16x16x32_bf16 v[72:75], a[140:143], v[156:159], v[196:199]
  v_lshlrev_b32 v225, 4, v225
  v_bfe_u32 v226, v224, 1, 1
  v_mfma_f32_16x16x32_bf16 v[72:75], a[136:139], v[152:155], v[72:75]
  ds_read_b128 a[152:155], v214 offset:53248
  v_mul_u32_u24 v226, 0xc00, v226
  v_mfma_f32_16x16x32_bf16 v[72:75], a[132:135], v[148:151], v[72:75]
  buffer_load_dwordx4 v237, s[16:19], s29 offen offset:1024 lds
  v_mfma_f32_16x16x32_bf16 v[72:75], a[128:131], v[144:147], v[72:75]
  ds_read_b128 a[156:159], v215 offset:53248
  v_add3_u32 v225, v225, v226, s50
  v_mfma_f32_16x16x32_bf16 v[80:83], a[128:131], v[160:163], v[200:203]
  v_exp_f32 v64, v64
  v_mfma_f32_16x16x32_bf16 v[80:83], a[132:135], v[164:167], v[80:83]
  v_and_b32 v226, 1, v224
  v_lshl_add_u32 v225, v226, 3, v225
  v_mfma_f32_16x16x32_bf16 v[80:83], a[136:139], v[168:171], v[80:83]
  s_waitcnt vmcnt(10)
  v_exp_f32 v65, v65
  v_mfma_f32_16x16x32_bf16 v[80:83], a[140:143], v[172:175], v[80:83]
  ds_read_b64_tr_b16 a[232:233], v225 offset:0
  v_cvt_pk_bf16_f32 v64, v64, v65
  v_mfma_f32_16x16x32_bf16 v[88:91], a[140:143], v[188:191], v[204:207]
  v_exp_f32 v66, v66
  v_mfma_f32_16x16x32_bf16 v[88:91], a[136:139], v[184:187], v[88:91]
  buffer_load_dwordx4 v236, s[16:19], s29 offen offset:2048 lds
  v_mfma_f32_16x16x32_bf16 v[88:91], a[132:135], v[180:183], v[88:91]
  s_waitcnt lgkmcnt(1)
  v_exp_f32 v67, v67
  v_mfma_f32_16x16x32_bf16 v[88:91], a[128:131], v[176:179], v[88:91]
  ds_read_b64_tr_b16 a[234:235], v225 offset:64
  v_cvt_pk_bf16_f32 v65, v66, v67
  v_mfma_f32_16x16x32_bf16 v[68:71], a[144:147], v[128:131], v[192:195]
  v_exp_f32 v72, v72
  v_mfma_f32_16x16x32_bf16 v[68:71], a[148:151], v[132:135], v[68:71]
  ds_read_b128 a[128:131], v212 offset:57344
  ds_read_b64_tr_b16 a[236:237], v225 offset:512
  v_mfma_f32_16x16x32_bf16 v[68:71], a[152:155], v[136:139], v[68:71]
  v_exp_f32 v73, v73
  v_mfma_f32_16x16x32_bf16 v[68:71], a[156:159], v[140:143], v[68:71]
  ds_read_b128 a[132:135], v213 offset:57344
  v_cvt_pk_bf16_f32 v72, v72, v73
  v_mfma_f32_16x16x32_bf16 v[76:79], a[156:159], v[156:159], v[196:199]
  v_exp_f32 v74, v74
  v_mfma_f32_16x16x32_bf16 v[76:79], a[152:155], v[152:155], v[76:79]
  ds_read_b128 a[136:139], v214 offset:57344
  ds_read_b64_tr_b16 a[238:239], v225 offset:576
  v_mfma_f32_16x16x32_bf16 v[76:79], a[148:151], v[148:151], v[76:79]
  v_exp_f32 v75, v75
  v_mfma_f32_16x16x32_bf16 v[76:79], a[144:147], v[144:147], v[76:79]
  ds_read_b128 a[140:143], v215 offset:57344
  v_cvt_pk_bf16_f32 v73, v74, v75
  v_mfma_f32_16x16x32_bf16 v[84:87], a[144:147], v[160:163], v[200:203]
  v_exp_f32 v80, v80
  v_mfma_f32_16x16x32_bf16 v[84:87], a[148:151], v[164:167], v[84:87]
  buffer_load_dwordx4 v237, s[16:19], s29 offen offset:3072 lds
  v_mfma_f32_16x16x32_bf16 v[84:87], a[152:155], v[168:171], v[84:87]
  s_add_u32 s29, s29, 16384
  v_exp_f32 v81, v81
  v_mfma_f32_16x16x32_bf16 v[84:87], a[156:159], v[172:175], v[84:87]
  ds_read_b64_tr_b16 a[240:241], v225 offset:1024
  v_cvt_pk_bf16_f32 v80, v80, v81
  v_mfma_f32_16x16x32_bf16 v[92:95], a[156:159], v[188:191], v[204:207]
  s_add_u32 m0, s28, 16384
  v_exp_f32 v82, v82
  v_mfma_f32_16x16x32_bf16 v[92:95], a[152:155], v[184:187], v[92:95]
  buffer_load_dwordx4 v232, s[12:15], s29 offen offset:0 lds
  v_mfma_f32_16x16x32_bf16 v[92:95], a[148:151], v[180:183], v[92:95]
  s_waitcnt lgkmcnt(1)
  v_exp_f32 v83, v83
  v_mfma_f32_16x16x32_bf16 v[92:95], a[144:147], v[176:179], v[92:95]
  ds_read_b64_tr_b16 a[242:243], v225 offset:1088
  v_cvt_pk_bf16_f32 v81, v82, v83
  v_mfma_f32_16x16x32_bf16 v[96:99], a[128:131], v[128:131], v[192:195]
  v_exp_f32 v88, v88
  v_mfma_f32_16x16x32_bf16 v[96:99], a[132:135], v[132:135], v[96:99]
  ds_read_b128 a[144:147], v212 offset:61440
  ds_read_b64_tr_b16 a[244:245], v225 offset:1536
  v_mfma_f32_16x16x32_bf16 v[96:99], a[136:139], v[136:139], v[96:99]
  v_exp_f32 v89, v89
  v_mfma_f32_16x16x32_bf16 v[96:99], a[140:143], v[140:143], v[96:99]
  ds_read_b128 a[148:151], v213 offset:61440
  v_cvt_pk_bf16_f32 v88, v88, v89
  v_mfma_f32_16x16x32_bf16 v[104:107], a[140:143], v[156:159], v[196:199]
  v_exp_f32 v90, v90
  v_mfma_f32_16x16x32_bf16 v[104:107], a[136:139], v[152:155], v[104:107]
  ds_read_b128 a[152:155], v214 offset:61440
  ds_read_b64_tr_b16 a[246:247], v225 offset:1600
  v_mfma_f32_16x16x32_bf16 v[104:107], a[132:135], v[148:151], v[104:107]
  v_exp_f32 v91, v91
  v_mfma_f32_16x16x32_bf16 v[104:107], a[128:131], v[144:147], v[104:107]
  ds_read_b128 a[156:159], v215 offset:61440
  v_cvt_pk_bf16_f32 v89, v90, v91
  v_mfma_f32_16x16x32_bf16 v[112:115], a[128:131], v[160:163], v[200:203]
  v_exp_f32 v68, v68
  v_mfma_f32_16x16x32_bf16 v[112:115], a[132:135], v[164:167], v[112:115]
  buffer_load_dwordx4 v233, s[12:15], s29 offen offset:1024 lds
  v_mfma_f32_16x16x32_bf16 v[112:115], a[136:139], v[168:171], v[112:115]
  v_exp_f32 v69, v69
  v_mfma_f32_16x16x32_bf16 v[112:115], a[140:143], v[172:175], v[112:115]
  ds_read_b64_tr_b16 a[248:249], v225 offset:2048
  v_cvt_pk_bf16_f32 v66, v68, v69
  v_mfma_f32_16x16x32_bf16 v[120:123], a[140:143], v[188:191], v[204:207]
  v_exp_f32 v70, v70
  v_mfma_f32_16x16x32_bf16 v[120:123], a[136:139], v[184:187], v[120:123]
  buffer_load_dwordx4 v234, s[12:15], s29 offen offset:2048 lds
  v_mfma_f32_16x16x32_bf16 v[120:123], a[132:135], v[180:183], v[120:123]
  s_waitcnt lgkmcnt(1)
  v_exp_f32 v71, v71
  v_mfma_f32_16x16x32_bf16 v[120:123], a[128:131], v[176:179], v[120:123]
  ds_read_b64_tr_b16 a[250:251], v225 offset:2112
  v_cvt_pk_bf16_f32 v67, v70, v71
  v_mfma_f32_16x16x32_bf16 v[100:103], a[144:147], v[128:131], v[192:195]
  v_exp_f32 v76, v76
  v_mfma_f32_16x16x32_bf16 v[100:103], a[148:151], v[132:135], v[100:103]
  ds_read_b64_tr_b16 a[160:161], v216 offset:32768
  v_mfma_f32_16x16x32_bf16 v[100:103], a[152:155], v[136:139], v[100:103]
  v_exp_f32 v77, v77
  v_mfma_f32_16x16x32_bf16 v[100:103], a[156:159], v[140:143], v[100:103]
  ds_read_b64_tr_b16 a[162:163], v216 offset:36864
  v_cvt_pk_bf16_f32 v74, v76, v77
  v_mfma_f32_16x16x32_bf16 v[108:111], a[156:159], v[156:159], v[196:199]
  v_exp_f32 v78, v78
  v_mfma_f32_16x16x32_bf16 v[108:111], a[152:155], v[152:155], v[108:111]
  ds_read_b64_tr_b16 a[164:165], v216 offset:40960
  buffer_load_dwordx4 v235, s[12:15], s29 offen offset:3072 lds
  v_mfma_f32_16x16x32_bf16 v[108:111], a[148:151], v[148:151], v[108:111]
  v_exp_f32 v79, v79
  v_mfma_f32_16x16x32_bf16 v[108:111], a[144:147], v[144:147], v[108:111]
  ds_read_b64_tr_b16 a[166:167], v216 offset:45056
  s_waitcnt lgkmcnt(4)
  v_cvt_pk_bf16_f32 v75, v78, v79
  v_mfma_f32_16x16x32_bf16 v[116:119], a[144:147], v[160:163], v[200:203]
  v_exp_f32 v84, v84
  v_mfma_f32_16x16x32_bf16 v[116:119], a[148:151], v[164:167], v[116:119]
  ds_read_b64_tr_b16 a[168:169], v217 offset:32768
  v_mfma_f32_16x16x32_bf16 v[228:231], a[232:235], a[212:215], 0
  v_mfma_f32_16x16x32_bf16 v[228:231], a[236:239], a[216:219], v[228:231]
  v_mfma_f32_16x16x32_bf16 v[228:231], a[240:243], a[220:223], v[228:231]
  v_mfma_f32_16x16x32_bf16 v[228:231], a[244:247], a[224:227], v[228:231]
  v_mfma_f32_16x16x32_bf16 v[228:231], a[248:251], a[228:231], v[228:231]
  v_mfma_f32_16x16x32_bf16 v[116:119], a[152:155], v[168:171], v[116:119]
  s_lshl_b32 s35, s3, 10
  s_add_u32 s35, s35, 159744
  v_exp_f32 v85, v85
  v_mfma_f32_16x16x32_bf16 v[116:119], a[156:159], v[172:175], v[116:119]
  ds_read_b64_tr_b16 a[170:171], v217 offset:36864
  v_cvt_pk_bf16_f32 v82, v84, v85
  v_mfma_f32_16x16x32_bf16 v[124:127], a[156:159], v[188:191], v[204:207]
  v_exp_f32 v86, v86
  v_mfma_f32_16x16x32_bf16 v[124:127], a[152:155], v[184:187], v[124:127]
  ds_read_b64_tr_b16 a[172:173], v217 offset:40960
  v_add_u32 v224, s35, v242
  v_mfma_f32_16x16x32_bf16 v[124:127], a[148:151], v[180:183], v[124:127]
  v_exp_f32 v87, v87
  v_mfma_f32_16x16x32_bf16 v[124:127], a[144:147], v[176:179], v[124:127]
  ds_read_b64_tr_b16 a[174:175], v217 offset:45056
  v_cvt_pk_bf16_f32 v83, v86, v87
  v_mfma_f32_16x16x32_bf16 a[192:195], a[208:211], v[0:3], a[192:195]
  v_exp_f32 v92, v92
  v_mfma_f32_16x16x32_bf16 a[192:195], a[208:211], v[32:35], a[192:195]
  ds_read_b64_tr_b16 a[176:177], v218 offset:32768
  ds_write_b128 v224, v[228:231]
  v_mfma_f32_16x16x32_bf16 a[196:199], a[208:211], v[8:11], a[196:199]
  v_exp_f32 v93, v93
  v_mfma_f32_16x16x32_bf16 a[196:199], a[208:211], v[40:43], a[196:199]
  ds_read_b64_tr_b16 a[178:179], v218 offset:36864
  v_cvt_pk_bf16_f32 v90, v92, v93
  v_mfma_f32_16x16x32_bf16 a[200:203], a[208:211], v[16:19], a[200:203]
  v_exp_f32 v94, v94
  v_mfma_f32_16x16x32_bf16 a[200:203], a[208:211], v[48:51], a[200:203]
  ds_read_b64_tr_b16 a[180:181], v218 offset:40960
  v_mfma_f32_16x16x32_bf16 a[204:207], a[208:211], v[24:27], a[204:207]
  s_waitcnt lgkmcnt(8)
  v_exp_f32 v95, v95
  v_mfma_f32_16x16x32_bf16 a[204:207], a[208:211], v[56:59], a[204:207]
  ds_read_b64_tr_b16 a[182:183], v218 offset:45056
  v_cvt_pk_bf16_f32 v91, v94, v95
  v_mfma_f32_16x16x32_bf16 a[0:3], a[160:163], v[0:3], a[0:3]
  v_exp_f32 v96, v96
  v_mfma_f32_16x16x32_bf16 a[0:3], a[164:167], v[32:35], a[0:3]
  ds_read_b64_tr_b16 a[184:185], v219 offset:32768
  s_waitcnt lgkmcnt(4)
  s_mov_b32 m0, s51
  v_mfma_f32_16x16x32_bf16 a[4:7], a[164:167], v[40:43], a[4:7]
  v_exp_f32 v97, v97
  v_mfma_f32_16x16x32_bf16 a[4:7], a[160:163], v[8:11], a[4:7]
  ds_read_b64_tr_b16 a[186:187], v219 offset:36864
  v_cvt_pk_bf16_f32 v96, v96, v97
  v_mfma_f32_16x16x32_bf16 a[8:11], a[160:163], v[16:19], a[8:11]
  v_exp_f32 v98, v98
  v_mfma_f32_16x16x32_bf16 a[8:11], a[164:167], v[48:51], a[8:11]
  ds_read_b64_tr_b16 a[188:189], v219 offset:40960
  buffer_load_dwordx4 v210, s[4:7], s100 offen lds
  s_add_u32 s100, s100, 20480
  s_add_u32 s51, s51, 512
  v_mfma_f32_16x16x32_bf16 a[12:15], a[164:167], v[56:59], a[12:15]
  v_exp_f32 v99, v99
  v_mfma_f32_16x16x32_bf16 a[12:15], a[160:163], v[24:27], a[12:15]
  ds_read_b64_tr_b16 a[190:191], v219 offset:45056
  v_cvt_pk_bf16_f32 v97, v98, v99
  v_mfma_f32_16x16x32_bf16 a[16:19], a[168:171], v[0:3], a[16:19]
  v_exp_f32 v104, v104
  v_mfma_f32_16x16x32_bf16 a[16:19], a[172:175], v[32:35], a[16:19]
  ds_read_b64_tr_b16 a[160:161], v220 offset:32768
  v_lshrrev_b32 v224, 4, v242
  v_mfma_f32_16x16x32_bf16 a[20:23], a[172:175], v[40:43], a[20:23]
  v_exp_f32 v105, v105
  v_mfma_f32_16x16x32_bf16 a[20:23], a[168:171], v[8:11], a[20:23]
  ds_read_b64_tr_b16 a[162:163], v220 offset:36864
  v_cvt_pk_bf16_f32 v104, v104, v105
  v_mfma_f32_16x16x32_bf16 a[24:27], a[168:171], v[16:19], a[24:27]
  v_exp_f32 v106, v106
  v_mfma_f32_16x16x32_bf16 a[24:27], a[172:175], v[48:51], a[24:27]
  ds_read_b64_tr_b16 a[164:165], v220 offset:40960
  v_bfe_u32 v225, v224, 2, 1
  v_mfma_f32_16x16x32_bf16 a[28:31], a[172:175], v[56:59], a[28:31]
  s_waitcnt lgkmcnt(7)
  v_exp_f32 v107, v107
  v_mfma_f32_16x16x32_bf16 a[28:31], a[168:171], v[24:27], a[28:31]
  ds_read_b64_tr_b16 a[166:167], v220 offset:45056
  v_cvt_pk_bf16_f32 v105, v106, v107
  v_mfma_f32_16x16x32_bf16 a[32:35], a[176:179], v[0:3], a[32:35]
  v_exp_f32 v112, v112
  v_mfma_f32_16x16x32_bf16 a[32:35], a[180:183], v[32:35], a[32:35]
  ds_read_b64_tr_b16 a[168:169], v221 offset:32768
  v_lshlrev_b32 v225, 8, v225
  v_mfma_f32_16x16x32_bf16 a[36:39], a[180:183], v[40:43], a[36:39]
  v_exp_f32 v113, v113
  v_mfma_f32_16x16x32_bf16 a[36:39], a[176:179], v[8:11], a[36:39]
  ds_read_b64_tr_b16 a[170:171], v221 offset:36864
  v_cvt_pk_bf16_f32 v112, v112, v113
  v_mfma_f32_16x16x32_bf16 a[40:43], a[176:179], v[16:19], a[40:43]
  v_exp_f32 v114, v114
  v_mfma_f32_16x16x32_bf16 a[40:43], a[180:183], v[48:51], a[40:43]
  ds_read_b64_tr_b16 a[172:173], v221 offset:40960
  v_lshrrev_b32 v226, 3, v224
  v_mfma_f32_16x16x32_bf16 a[44:47], a[180:183], v[56:59], a[44:47]
  s_waitcnt lgkmcnt(7)
  v_exp_f32 v115, v115
  v_mfma_f32_16x16x32_bf16 a[44:47], a[176:179], v[24:27], a[44:47]
  ds_read_b64_tr_b16 a[174:175], v221 offset:45056
  v_cvt_pk_bf16_f32 v113, v114, v115
  v_mfma_f32_16x16x32_bf16 a[48:51], a[184:187], v[0:3], a[48:51]
  v_exp_f32 v120, v120
  v_mfma_f32_16x16x32_bf16 a[48:51], a[188:191], v[32:35], a[48:51]
  ds_read_b64_tr_b16 a[176:177], v222 offset:32768
  v_lshl_add_u32 v225, v226, 4, v225
  v_mfma_f32_16x16x32_bf16 a[52:55], a[188:191], v[40:43], a[52:55]
  v_exp_f32 v121, v121
  v_mfma_f32_16x16x32_bf16 a[52:55], a[184:187], v[8:11], a[52:55]
  ds_read_b64_tr_b16 a[178:179], v222 offset:36864
  v_cvt_pk_bf16_f32 v120, v120, v121
  v_mfma_f32_16x16x32_bf16 a[56:59], a[184:187], v[16:19], a[56:59]
  v_exp_f32 v122, v122
  v_mfma_f32_16x16x32_bf16 a[56:59], a[188:191], v[48:51], a[56:59]
  ds_read_b64_tr_b16 a[180:181], v222 offset:40960
  v_and_b32 v227, 3, v224
  v_mfma_f32_16x16x32_bf16 a[60:63], a[188:191], v[56:59], a[60:63]
  s_waitcnt lgkmcnt(7)
  v_exp_f32 v123, v123
  v_mfma_f32_16x16x32_bf16 a[60:63], a[184:187], v[24:27], a[60:63]
  ds_read_b64_tr_b16 a[182:183], v222 offset:45056
  v_cvt_pk_bf16_f32 v121, v122, v123
  v_mfma_f32_16x16x32_bf16 a[64:67], a[160:163], v[0:3], a[64:67]
  v_exp_f32 v100, v100
  v_mfma_f32_16x16x32_bf16 a[64:67], a[164:167], v[32:35], a[64:67]
  ds_read_b64_tr_b16 a[184:185], v223 offset:32768
  v_lshl_add_u32 v225, v227, 2, v225
  v_mfma_f32_16x16x32_bf16 a[68:71], a[164:167], v[40:43], a[68:71]
  v_exp_f32 v101, v101
  v_mfma_f32_16x16x32_bf16 a[68:71], a[160:163], v[8:11], a[68:71]
  ds_read_b64_tr_b16 a[186:187], v223 offset:36864
  v_cvt_pk_bf16_f32 v98, v100, v101
  v_mfma_f32_16x16x32_bf16 a[72:75], a[160:163], v[16:19], a[72:75]
  v_exp_f32 v102, v102
  v_mfma_f32_16x16x32_bf16 a[72:75], a[164:167], v[48:51], a[72:75]
  ds_read_b64_tr_b16 a[188:189], v223 offset:40960
  v_add_u32 v225, 159744, v225
  v_mfma_f32_16x16x32_bf16 a[76:79], a[164:167], v[56:59], a[76:79]
  s_waitcnt lgkmcnt(7)
  v_exp_f32 v103, v103
  v_mfma_f32_16x16x32_bf16 a[76:79], a[160:163], v[24:27], a[76:79]
  ds_read_b64_tr_b16 a[190:191], v223 offset:45056
  v_cvt_pk_bf16_f32 v99, v102, v103
  v_mfma_f32_16x16x32_bf16 a[80:83], a[168:171], v[0:3], a[80:83]
  s_waitcnt vmcnt(9)
  v_exp_f32 v108, v108
  v_mfma_f32_16x16x32_bf16 a[80:83], a[172:175], v[32:35], a[80:83]
  v_mfma_f32_16x16x32_bf16 a[84:87], a[172:175], v[40:43], a[84:87]
  s_barrier
  v_exp_f32 v109, v109
  v_mfma_f32_16x16x32_bf16 a[84:87], a[168:171], v[8:11], a[84:87]
  ds_read_b128 a[128:131], v212 offset:0
  v_cvt_pk_bf16_f32 v106, v108, v109
  v_mfma_f32_16x16x32_bf16 a[88:91], a[168:171], v[16:19], a[88:91]
  v_exp_f32 v110, v110
  v_mfma_f32_16x16x32_bf16 a[88:91], a[172:175], v[48:51], a[88:91]
  ds_read_b128 a[132:135], v213 offset:0
  ds_read_b32 v228, v225 offset:0
  v_mfma_f32_16x16x32_bf16 a[92:95], a[172:175], v[56:59], a[92:95]
  s_waitcnt lgkmcnt(7)
  v_exp_f32 v111, v111
  v_mfma_f32_16x16x32_bf16 a[92:95], a[168:171], v[24:27], a[92:95]
  ds_read_b128 a[136:139], v214 offset:0
  v_cvt_pk_bf16_f32 v107, v110, v111
  v_mfma_f32_16x16x32_bf16 a[96:99], a[176:179], v[0:3], a[96:99]
  v_exp_f32 v116, v116
  v_mfma_f32_16x16x32_bf16 a[96:99], a[180:183], v[32:35], a[96:99]
  ds_read_b128 a[140:143], v215 offset:0
  ds_read_b32 v229, v225 offset:1024
  v_mfma_f32_16x16x32_bf16 a[100:103], a[180:183], v[40:43], a[100:103]
  v_exp_f32 v117, v117
  v_mfma_f32_16x16x32_bf16 a[100:103], a[176:179], v[8:11], a[100:103]
  ds_read_b32 v230, v225 offset:2048
  v_cvt_pk_bf16_f32 v114, v116, v117
  v_mfma_f32_16x16x32_bf16 a[104:107], a[176:179], v[16:19], a[104:107]
  v_exp_f32 v118, v118
  v_mfma_f32_16x16x32_bf16 a[104:107], a[180:183], v[48:51], a[104:107]
  ds_read_b32 v231, v225 offset:3072
  ds_read_b32 v238, v225 offset:512
  v_mfma_f32_16x16x32_bf16 a[108:111], a[180:183], v[56:59], a[108:111]
  s_waitcnt lgkmcnt(9)
  v_exp_f32 v119, v119
  v_mfma_f32_16x16x32_bf16 a[108:111], a[176:179], v[24:27], a[108:111]
  ds_read_b32 v239, v225 offset:1536
  v_cvt_pk_bf16_f32 v115, v118, v119
  v_mfma_f32_16x16x32_bf16 a[112:115], a[184:187], v[0:3], a[112:115]
  v_exp_f32 v124, v124
  v_mfma_f32_16x16x32_bf16 a[112:115], a[188:191], v[32:35], a[112:115]
  ds_read_b32 v240, v225 offset:2560
  ds_read_b32 v241, v225 offset:3584
  s_cmp_eq_u32 s3, 0
  s_cselect_b32 s35, 0, 1073741824
  v_mfma_f32_16x16x32_bf16 a[116:119], a[188:191], v[40:43], a[116:119]
  v_exp_f32 v125, v125
  v_mfma_f32_16x16x32_bf16 a[116:119], a[184:187], v[8:11], a[116:119]
  v_cvt_pk_bf16_f32 v122, v124, v125
  v_mul_u32_u24 v226, 0xd80, v226
  v_mfma_f32_16x16x32_bf16 a[120:123], a[184:187], v[16:19], a[120:123]
  v_exp_f32 v126, v126
  v_mfma_f32_16x16x32_bf16 a[120:123], a[188:191], v[48:51], a[120:123]
  v_and_b32 v227, 7, v224
  v_lshl_add_u32 v226, v227, 1, v226
  v_mfma_f32_16x16x32_bf16 a[124:127], a[188:191], v[56:59], a[124:127]
  s_waitcnt lgkmcnt(7)
  v_exp_f32 v127, v127
  v_mfma_f32_16x16x32_bf16 a[124:127], a[184:187], v[24:27], a[124:127]
  v_cvt_pk_bf16_f32 v123, v126, v127
  v_and_b32 v227, 1, v224
  v_lshl_add_u32 v226, v227, 30, v226
  v_or_b32 v226, s35, v226
  v_min_u32 v249, 1, v224
  v_lshlrev_b32 v249, 30, v249
  v_or_b32 v249, s35, v249
  v_mov_b32 v251, v249
  v_mov_b32 v250, 1
  s_mov_b32 s47, 2818048
  s_lshl_b32 s35, s33, 4
  s_add_u32 s35, s35, 2633728
  s_waitcnt lgkmcnt(0)
  v_add_f32 v228, v228, v229
  v_add_f32 v238, v238, v239
  v_add_f32 v230, v230, v231
  v_add_f32 v240, v240, v241
  v_add_f32 v228, v228, v230
  v_add_f32 v238, v238, v240
  v_cvt_pk_bf16_f32 v228, v228, v228
  v_cvt_pk_bf16_f32 v238, v238, v238
  v_lshlrev_b32 v228, 16, v228
  v_lshlrev_b32 v238, 16, v238
  v_mul_f32 v229, 0xbfb8aa3b, v228
  v_exp_f32 v229, v229
  s_nop 0
  v_add_f32 v229, 1.0, v229
  v_rcp_f32 v229, v229
  s_nop 0
  v_mul_f32 v228, v228, v229
  v_cvt_pk_bf16_f32 v228, v228, v228
  v_lshlrev_b32 v228, 16, v228
  v_mul_f32 v228, v228, v238
  s_nop 1
  v_mov_b32_dpp v229, v228 quad_perm:[1,0,3,2] row_mask:0xf bank_mask:0xf
  v_cvt_pk_bf16_f32 v228, v228, v229
  buffer_store_dword v228, v226, s[24:27], s35 offen sc1
  s_mov_b32 s32, 5
attn_loop:
  v_mfma_f32_16x16x32_bf16 v[0:3], a[128:131], v[128:131], v[192:195]
  s_add_u32 m0, s28, 81920
  v_mfma_f32_16x16x32_bf16 v[0:3], a[132:135], v[132:135], v[0:3]
  ds_read_b128 a[144:147], v212 offset:4096
  v_mfma_f32_16x16x32_bf16 v[0:3], a[136:139], v[136:139], v[0:3]
  buffer_load_dwordx4 v236, s[16:19], s29 offen offset:0 lds
  v_mfma_f32_16x16x32_bf16 v[0:3], a[140:143], v[140:143], v[0:3]
  ds_read_b128 a[148:151], v213 offset:4096
  v_mfma_f32_16x16x32_bf16 v[8:11], a[140:143], v[156:159], v[196:199]
  v_mfma_f32_16x16x32_bf16 v[8:11], a[136:139], v[152:155], v[8:11]
  ds_read_b128 a[152:155], v214 offset:4096
  v_mfma_f32_16x16x32_bf16 v[8:11], a[132:135], v[148:151], v[8:11]
  buffer_load_dwordx4 v237, s[16:19], s29 offen offset:1024 lds
  v_mfma_f32_16x16x32_bf16 v[8:11], a[128:131], v[144:147], v[8:11]
  ds_read_b128 a[156:159], v215 offset:4096
  v_mfma_f32_16x16x32_bf16 v[16:19], a[128:131], v[160:163], v[200:203]
  v_exp_f32 v0, v0
  v_mfma_f32_16x16x32_bf16 v[16:19], a[132:135], v[164:167], v[16:19]
  v_mfma_f32_16x16x32_bf16 v[16:19], a[136:139], v[168:171], v[16:19]
  v_exp_f32 v1, v1
  v_mfma_f32_16x16x32_bf16 v[16:19], a[140:143], v[172:175], v[16:19]
  v_cvt_pk_bf16_f32 v0, v0, v1
  v_mfma_f32_16x16x32_bf16 v[24:27], a[140:143], v[188:191], v[204:207]
  v_exp_f32 v2, v2
  v_mfma_f32_16x16x32_bf16 v[24:27], a[136:139], v[184:187], v[24:27]
  buffer_load_dwordx4 v236, s[16:19], s29 offen offset:2048 lds
  v_mfma_f32_16x16x32_bf16 v[24:27], a[132:135], v[180:183], v[24:27]
  s_waitcnt lgkmcnt(0)
  v_exp_f32 v3, v3
  v_mfma_f32_16x16x32_bf16 v[24:27], a[128:131], v[176:179], v[24:27]
  v_cvt_pk_bf16_f32 v1, v2, v3
  v_mfma_f32_16x16x32_bf16 v[4:7], a[144:147], v[128:131], v[192:195]
  v_exp_f32 v8, v8
  v_mfma_f32_16x16x32_bf16 v[4:7], a[148:151], v[132:135], v[4:7]
  ds_read_b128 a[128:131], v212 offset:8192
  v_mfma_f32_16x16x32_bf16 v[4:7], a[152:155], v[136:139], v[4:7]
  v_exp_f32 v9, v9
  v_mfma_f32_16x16x32_bf16 v[4:7], a[156:159], v[140:143], v[4:7]
  ds_read_b128 a[132:135], v213 offset:8192
  v_cvt_pk_bf16_f32 v8, v8, v9
  v_mfma_f32_16x16x32_bf16 v[12:15], a[156:159], v[156:159], v[196:199]
  v_exp_f32 v10, v10
  v_mfma_f32_16x16x32_bf16 v[12:15], a[152:155], v[152:155], v[12:15]
  ds_read_b128 a[136:139], v214 offset:8192
  v_mfma_f32_16x16x32_bf16 v[12:15], a[148:151], v[148:151], v[12:15]
  v_exp_f32 v11, v11
  v_mfma_f32_16x16x32_bf16 v[12:15], a[144:147], v[144:147], v[12:15]
  ds_read_b128 a[140:143], v215 offset:8192
  v_cvt_pk_bf16_f32 v9, v10, v11
  v_mfma_f32_16x16x32_bf16 v[20:23], a[144:147], v[160:163], v[200:203]
  v_exp_f32 v16, v16
  v_mfma_f32_16x16x32_bf16 v[20:23], a[148:151], v[164:167], v[20:23]
  buffer_load_dwordx4 v237, s[16:19], s29 offen offset:3072 lds
  v_mfma_f32_16x16x32_bf16 v[20:23], a[152:155], v[168:171], v[20:23]
  s_add_u32 s29, s29, 16384
  v_exp_f32 v17, v17
  v_mfma_f32_16x16x32_bf16 v[20:23], a[156:159], v[172:175], v[20:23]
  v_cvt_pk_bf16_f32 v16, v16, v17
  v_mfma_f32_16x16x32_bf16 v[28:31], a[156:159], v[188:191], v[204:207]
  s_add_u32 m0, s28, 32768
  v_exp_f32 v18, v18
  v_mfma_f32_16x16x32_bf16 v[28:31], a[152:155], v[184:187], v[28:31]
  buffer_load_dwordx4 v232, s[12:15], s29 offen offset:0 lds
  v_mfma_f32_16x16x32_bf16 v[28:31], a[148:151], v[180:183], v[28:31]
  s_waitcnt lgkmcnt(0)
  v_exp_f32 v19, v19
  v_mfma_f32_16x16x32_bf16 v[28:31], a[144:147], v[176:179], v[28:31]
  v_cvt_pk_bf16_f32 v17, v18, v19
  v_mfma_f32_16x16x32_bf16 v[32:35], a[128:131], v[128:131], v[192:195]
  v_exp_f32 v24, v24
  v_mfma_f32_16x16x32_bf16 v[32:35], a[132:135], v[132:135], v[32:35]
  ds_read_b128 a[144:147], v212 offset:12288
  v_mfma_f32_16x16x32_bf16 v[32:35], a[136:139], v[136:139], v[32:35]
  v_exp_f32 v25, v25
  v_mfma_f32_16x16x32_bf16 v[32:35], a[140:143], v[140:143], v[32:35]
  ds_read_b128 a[148:151], v213 offset:12288
  v_cvt_pk_bf16_f32 v24, v24, v25
  v_mfma_f32_16x16x32_bf16 v[40:43], a[140:143], v[156:159], v[196:199]
  v_exp_f32 v26, v26
  v_mfma_f32_16x16x32_bf16 v[40:43], a[136:139], v[152:155], v[40:43]
  ds_read_b128 a[152:155], v214 offset:12288
  v_mfma_f32_16x16x32_bf16 v[40:43], a[132:135], v[148:151], v[40:43]
  v_exp_f32 v27, v27
  v_mfma_f32_16x16x32_bf16 v[40:43], a[128:131], v[144:147], v[40:43]
  ds_read_b128 a[156:159], v215 offset:12288
  v_cvt_pk_bf16_f32 v25, v26, v27
  v_mfma_f32_16x16x32_bf16 v[48:51], a[128:131], v[160:163], v[200:203]
  v_exp_f32 v4, v4
  v_mfma_f32_16x16x32_bf16 v[48:51], a[132:135], v[164:167], v[48:51]
  buffer_load_dwordx4 v233, s[12:15], s29 offen offset:1024 lds
  v_mfma_f32_16x16x32_bf16 v[48:51], a[136:139], v[168:171], v[48:51]
  v_exp_f32 v5, v5
  v_mfma_f32_16x16x32_bf16 v[48:51], a[140:143], v[172:175], v[48:51]
  v_cvt_pk_bf16_f32 v2, v4, v5
  v_mfma_f32_16x16x32_bf16 v[56:59], a[140:143], v[188:191], v[204:207]
  v_exp_f32 v6, v6
  v_mfma_f32_16x16x32_bf16 v[56:59], a[136:139], v[184:187], v[56:59]
  buffer_load_dwordx4 v234, s[12:15], s29 offen offset:2048 lds
  v_mfma_f32_16x16x32_bf16 v[56:59], a[132:135], v[180:183], v[56:59]
  s_waitcnt lgkmcnt(0)
  v_exp_f32 v7, v7
  v_mfma_f32_16x16x32_bf16 v[56:59], a[128:131], v[176:179], v[56:59]
  v_cvt_pk_bf16_f32 v3, v6, v7
  v_mfma_f32_16x16x32_bf16 v[36:39], a[144:147], v[128:131], v[192:195]
  v_exp_f32 v12, v12
  v_mfma_f32_16x16x32_bf16 v[36:39], a[148:151], v[132:135], v[36:39]
  ds_read_b64_tr_b16 a[160:161], v216 offset:49152
  v_mfma_f32_16x16x32_bf16 v[36:39], a[152:155], v[136:139], v[36:39]
  v_exp_f32 v13, v13
  v_mfma_f32_16x16x32_bf16 v[36:39], a[156:159], v[140:143], v[36:39]
  ds_read_b64_tr_b16 a[162:163], v216 offset:53248
  v_cvt_pk_bf16_f32 v10, v12, v13
  v_mfma_f32_16x16x32_bf16 v[44:47], a[156:159], v[156:159], v[196:199]
  v_exp_f32 v14, v14
  v_mfma_f32_16x16x32_bf16 v[44:47], a[152:155], v[152:155], v[44:47]
  ds_read_b64_tr_b16 a[164:165], v216 offset:57344
  buffer_load_dwordx4 v235, s[12:15], s29 offen offset:3072 lds
  v_mfma_f32_16x16x32_bf16 v[44:47], a[148:151], v[148:151], v[44:47]
  v_exp_f32 v15, v15
  v_mfma_f32_16x16x32_bf16 v[44:47], a[144:147], v[144:147], v[44:47]
  ds_read_b64_tr_b16 a[166:167], v216 offset:61440
  v_cvt_pk_bf16_f32 v11, v14, v15
  v_mfma_f32_16x16x32_bf16 v[52:55], a[144:147], v[160:163], v[200:203]
  s_add_u32 m0, s50, 4096
  v_exp_f32 v20, v20
  v_mfma_f32_16x16x32_bf16 v[52:55], a[148:151], v[164:167], v[52:55]
  ds_read_b64_tr_b16 a[168:169], v217 offset:49152
  buffer_load_dwordx4 v208, s[20:23], s30 offen lds
  s_add_u32 s30, s30, 32
  v_mfma_f32_16x16x32_bf16 v[52:55], a[152:155], v[168:171], v[52:55]
  v_exp_f32 v21, v21
  v_mfma_f32_16x16x32_bf16 v[52:55], a[156:159], v[172:175], v[52:55]
  ds_read_b64_tr_b16 a[170:171], v217 offset:53248
  v_cvt_pk_bf16_f32 v18, v20, v21
  v_mfma_f32_16x16x32_bf16 v[60:63], a[156:159], v[188:191], v[204:207]
  v_exp_f32 v22, v22
  v_mfma_f32_16x16x32_bf16 v[60:63], a[152:155], v[184:187], v[60:63]
  ds_read_b64_tr_b16 a[172:173], v217 offset:57344
  v_mfma_f32_16x16x32_bf16 v[60:63], a[148:151], v[180:183], v[60:63]
  v_exp_f32 v23, v23
  v_mfma_f32_16x16x32_bf16 v[60:63], a[144:147], v[176:179], v[60:63]
  ds_read_b64_tr_b16 a[174:175], v217 offset:61440
  v_cvt_pk_bf16_f32 v19, v22, v23
  v_mfma_f32_16x16x32_bf16 a[192:195], a[208:211], v[64:67], a[192:195]
  v_exp_f32 v28, v28
  v_mfma_f32_16x16x32_bf16 a[192:195], a[208:211], v[96:99], a[192:195]
  ds_read_b64_tr_b16 a[176:177], v218 offset:49152
  v_mfma_f32_16x16x32_bf16 a[196:199], a[208:211], v[72:75], a[196:199]
  v_exp_f32 v29, v29
  v_mfma_f32_16x16x32_bf16 a[196:199], a[208:211], v[104:107], a[196:199]
  ds_read_b64_tr_b16 a[178:179], v218 offset:53248
  v_cvt_pk_bf16_f32 v26, v28, v29
  v_mfma_f32_16x16x32_bf16 a[200:203], a[208:211], v[80:83], a[200:203]
  v_exp_f32 v30, v30
  v_mfma_f32_16x16x32_bf16 a[200:203], a[208:211], v[112:115], a[200:203]
  ds_read_b64_tr_b16 a[180:181], v218 offset:57344
  v_mfma_f32_16x16x32_bf16 a[204:207], a[208:211], v[88:91], a[204:207]
  s_waitcnt lgkmcnt(7)
  v_exp_f32 v31, v31
  v_mfma_f32_16x16x32_bf16 a[204:207], a[208:211], v[120:123], a[204:207]
  ds_read_b64_tr_b16 a[182:183], v218 offset:61440
  v_cvt_pk_bf16_f32 v27, v30, v31
  v_mfma_f32_16x16x32_bf16 a[0:3], a[160:163], v[64:67], a[0:3]
  v_exp_f32 v32, v32
  v_mfma_f32_16x16x32_bf16 a[0:3], a[164:167], v[96:99], a[0:3]
  ds_read_b64_tr_b16 a[184:185], v219 offset:49152
  v_mfma_f32_16x16x32_bf16 a[4:7], a[164:167], v[104:107], a[4:7]
  v_exp_f32 v33, v33
  v_mfma_f32_16x16x32_bf16 a[4:7], a[160:163], v[72:75], a[4:7]
  ds_read_b64_tr_b16 a[186:187], v219 offset:53248
  v_cvt_pk_bf16_f32 v32, v32, v33
  v_mfma_f32_16x16x32_bf16 a[8:11], a[160:163], v[80:83], a[8:11]
  v_exp_f32 v34, v34
  v_mfma_f32_16x16x32_bf16 a[8:11], a[164:167], v[112:115], a[8:11]
  ds_read_b64_tr_b16 a[188:189], v219 offset:57344
  v_mfma_f32_16x16x32_bf16 a[12:15], a[164:167], v[120:123], a[12:15]
  s_waitcnt lgkmcnt(7)
  v_exp_f32 v35, v35
  v_mfma_f32_16x16x32_bf16 a[12:15], a[160:163], v[88:91], a[12:15]
  ds_read_b64_tr_b16 a[190:191], v219 offset:61440
  v_cvt_pk_bf16_f32 v33, v34, v35
  v_mfma_f32_16x16x32_bf16 a[16:19], a[168:171], v[64:67], a[16:19]
  v_exp_f32 v40, v40
  v_mfma_f32_16x16x32_bf16 a[16:19], a[172:175], v[96:99], a[16:19]
  ds_read_b64_tr_b16 a[160:161], v220 offset:49152
  v_mfma_f32_16x16x32_bf16 a[20:23], a[172:175], v[104:107], a[20:23]
  v_exp_f32 v41, v41
  v_mfma_f32_16x16x32_bf16 a[20:23], a[168:171], v[72:75], a[20:23]
  ds_read_b64_tr_b16 a[162:163], v220 offset:53248
  v_cvt_pk_bf16_f32 v40, v40, v41
  v_mfma_f32_16x16x32_bf16 a[24:27], a[168:171], v[80:83], a[24:27]
  v_exp_f32 v42, v42
  v_mfma_f32_16x16x32_bf16 a[24:27], a[172:175], v[112:115], a[24:27]
  ds_read_b64_tr_b16 a[164:165], v220 offset:57344
  v_mfma_f32_16x16x32_bf16 a[28:31], a[172:175], v[120:123], a[28:31]
  s_waitcnt lgkmcnt(7)
  v_exp_f32 v43, v43
  v_mfma_f32_16x16x32_bf16 a[28:31], a[168:171], v[88:91], a[28:31]
  ds_read_b64_tr_b16 a[166:167], v220 offset:61440
  v_cvt_pk_bf16_f32 v41, v42, v43
  v_mfma_f32_16x16x32_bf16 a[32:35], a[176:179], v[64:67], a[32:35]
  v_exp_f32 v48, v48
  v_mfma_f32_16x16x32_bf16 a[32:35], a[180:183], v[96:99], a[32:35]
  ds_read_b64_tr_b16 a[168:169], v221 offset:49152
  v_mfma_f32_16x16x32_bf16 a[36:39], a[180:183], v[104:107], a[36:39]
  v_exp_f32 v49, v49
  v_mfma_f32_16x16x32_bf16 a[36:39], a[176:179], v[72:75], a[36:39]
  ds_read_b64_tr_b16 a[170:171], v221 offset:53248
  v_cvt_pk_bf16_f32 v48, v48, v49
  v_mfma_f32_16x16x32_bf16 a[40:43], a[176:179], v[80:83], a[40:43]
  v_exp_f32 v50, v50
  v_mfma_f32_16x16x32_bf16 a[40:43], a[180:183], v[112:115], a[40:43]
  ds_read_b64_tr_b16 a[172:173], v221 offset:57344
  v_mfma_f32_16x16x32_bf16 a[44:47], a[180:183], v[120:123], a[44:47]
  s_waitcnt lgkmcnt(7)
  v_exp_f32 v51, v51
  v_mfma_f32_16x16x32_bf16 a[44:47], a[176:179], v[88:91], a[44:47]
  ds_read_b64_tr_b16 a[174:175], v221 offset:61440
  v_cvt_pk_bf16_f32 v49, v50, v51
  v_mfma_f32_16x16x32_bf16 a[48:51], a[184:187], v[64:67], a[48:51]
  v_exp_f32 v56, v56
  v_mfma_f32_16x16x32_bf16 a[48:51], a[188:191], v[96:99], a[48:51]
  ds_read_b64_tr_b16 a[176:177], v222 offset:49152
  v_mfma_f32_16x16x32_bf16 a[52:55], a[188:191], v[104:107], a[52:55]
  v_exp_f32 v57, v57
  v_mfma_f32_16x16x32_bf16 a[52:55], a[184:187], v[72:75], a[52:55]
  ds_read_b64_tr_b16 a[178:179], v222 offset:53248
  v_cvt_pk_bf16_f32 v56, v56, v57
  v_mfma_f32_16x16x32_bf16 a[56:59], a[184:187], v[80:83], a[56:59]
  v_exp_f32 v58, v58
  v_mfma_f32_16x16x32_bf16 a[56:59], a[188:191], v[112:115], a[56:59]
  ds_read_b64_tr_b16 a[180:181], v222 offset:57344
  v_mfma_f32_16x16x32_bf16 a[60:63], a[188:191], v[120:123], a[60:63]
  s_waitcnt lgkmcnt(7)
  v_exp_f32 v59, v59
  v_mfma_f32_16x16x32_bf16 a[60:63], a[184:187], v[88:91], a[60:63]
  ds_read_b64_tr_b16 a[182:183], v222 offset:61440
  v_cvt_pk_bf16_f32 v57, v58, v59
  v_mfma_f32_16x16x32_bf16 a[64:67], a[160:163], v[64:67], a[64:67]
  v_exp_f32 v36, v36
  v_mfma_f32_16x16x32_bf16 a[64:67], a[164:167], v[96:99], a[64:67]
  ds_read_b64_tr_b16 a[184:185], v223 offset:49152
  v_mfma_f32_16x16x32_bf16 a[68:71], a[164:167], v[104:107], a[68:71]
  v_exp_f32 v37, v37
  v_mfma_f32_16x16x32_bf16 a[68:71], a[160:163], v[72:75], a[68:71]
  ds_read_b64_tr_b16 a[186:187], v223 offset:53248
  v_cvt_pk_bf16_f32 v34, v36, v37
  v_mfma_f32_16x16x32_bf16 a[72:75], a[160:163], v[80:83], a[72:75]
  v_exp_f32 v38, v38
  v_mfma_f32_16x16x32_bf16 a[72:75], a[164:167], v[112:115], a[72:75]
  ds_read_b64_tr_b16 a[188:189], v223 offset:57344
  v_mfma_f32_16x16x32_bf16 a[76:79], a[164:167], v[120:123], a[76:79]
  s_waitcnt lgkmcnt(7)
  v_exp_f32 v39, v39
  v_mfma_f32_16x16x32_bf16 a[76:79], a[160:163], v[88:91], a[76:79]
  ds_read_b64_tr_b16 a[190:191], v223 offset:61440
  v_cvt_pk_bf16_f32 v35, v38, v39
  v_mfma_f32_16x16x32_bf16 a[80:83], a[168:171], v[64:67], a[80:83]
  s_waitcnt vmcnt(11)
  v_exp_f32 v44, v44
  v_mfma_f32_16x16x32_bf16 a[80:83], a[172:175], v[96:99], a[80:83]
  v_mfma_f32_16x16x32_bf16 a[84:87], a[172:175], v[104:107], a[84:87]
  s_barrier
  v_exp_f32 v45, v45
  v_mfma_f32_16x16x32_bf16 a[84:87], a[168:171], v[72:75], a[84:87]
  ds_read_b128 a[128:131], v212 offset:16384
  v_cvt_pk_bf16_f32 v42, v44, v45
  v_mfma_f32_16x16x32_bf16 a[88:91], a[168:171], v[80:83], a[88:91]
  v_exp_f32 v46, v46
  v_mfma_f32_16x16x32_bf16 a[88:91], a[172:175], v[112:115], a[88:91]
  ds_read_b128 a[132:135], v213 offset:16384
  v_mfma_f32_16x16x32_bf16 a[92:95], a[172:175], v[120:123], a[92:95]
  s_waitcnt lgkmcnt(6)
  v_exp_f32 v47, v47
  v_mfma_f32_16x16x32_bf16 a[92:95], a[168:171], v[88:91], a[92:95]
  ds_read_b128 a[136:139], v214 offset:16384
  v_cvt_pk_bf16_f32 v43, v46, v47
  v_mfma_f32_16x16x32_bf16 a[96:99], a[176:179], v[64:67], a[96:99]
  v_exp_f32 v52, v52
  v_mfma_f32_16x16x32_bf16 a[96:99], a[180:183], v[96:99], a[96:99]
  ds_read_b128 a[140:143], v215 offset:16384
  v_mfma_f32_16x16x32_bf16 a[100:103], a[180:183], v[104:107], a[100:103]
  v_exp_f32 v53, v53
  v_mfma_f32_16x16x32_bf16 a[100:103], a[176:179], v[72:75], a[100:103]
  v_cvt_pk_bf16_f32 v50, v52, v53
  v_mfma_f32_16x16x32_bf16 a[104:107], a[176:179], v[80:83], a[104:107]
  v_exp_f32 v54, v54
  v_mfma_f32_16x16x32_bf16 a[104:107], a[180:183], v[112:115], a[104:107]
  v_mfma_f32_16x16x32_bf16 a[108:111], a[180:183], v[120:123], a[108:111]
  s_waitcnt lgkmcnt(4)
  v_exp_f32 v55, v55
  v_mfma_f32_16x16x32_bf16 a[108:111], a[176:179], v[88:91], a[108:111]
  v_cvt_pk_bf16_f32 v51, v54, v55
  v_mfma_f32_16x16x32_bf16 a[112:115], a[184:187], v[64:67], a[112:115]
  v_exp_f32 v60, v60
  v_mfma_f32_16x16x32_bf16 a[112:115], a[188:191], v[96:99], a[112:115]
  v_mfma_f32_16x16x32_bf16 a[116:119], a[188:191], v[104:107], a[116:119]
  v_exp_f32 v61, v61
  v_mfma_f32_16x16x32_bf16 a[116:119], a[184:187], v[72:75], a[116:119]
  v_cvt_pk_bf16_f32 v58, v60, v61
  v_mfma_f32_16x16x32_bf16 a[120:123], a[184:187], v[80:83], a[120:123]
  v_exp_f32 v62, v62
  v_mfma_f32_16x16x32_bf16 a[120:123], a[188:191], v[112:115], a[120:123]
  v_mfma_f32_16x16x32_bf16 a[124:127], a[188:191], v[120:123], a[124:127]
  s_waitcnt lgkmcnt(0)
  v_exp_f32 v63, v63
  v_mfma_f32_16x16x32_bf16 a[124:127], a[184:187], v[88:91], a[124:127]
  v_cvt_pk_bf16_f32 v59, v62, v63
  v_mfma_f32_16x16x32_bf16 v[64:67], a[128:131], v[128:131], v[192:195]
  s_add_u32 m0, s28, 98304
  v_mfma_f32_16x16x32_bf16 v[64:67], a[132:135], v[132:135], v[64:67]
  ds_read_b128 a[144:147], v212 offset:20480
  v_mfma_f32_16x16x32_bf16 v[64:67], a[136:139], v[136:139], v[64:67]
  buffer_load_dwordx4 v236, s[16:19], s29 offen offset:0 lds
  v_mfma_f32_16x16x32_bf16 v[64:67], a[140:143], v[140:143], v[64:67]
  ds_read_b128 a[148:151], v213 offset:20480
  v_mfma_f32_16x16x32_bf16 v[72:75], a[140:143], v[156:159], v[196:199]
  v_mfma_f32_16x16x32_bf16 v[72:75], a[136:139], v[152:155], v[72:75]
  ds_read_b128 a[152:155], v214 offset:20480
  v_mfma_f32_16x16x32_bf16 v[72:75], a[132:135], v[148:151], v[72:75]
  buffer_load_dwordx4 v237, s[16:19], s29 offen offset:1024 lds
  v_mfma_f32_16x16x32_bf16 v[72:75], a[128:131], v[144:147], v[72:75]
  ds_read_b128 a[156:159], v215 offset:20480
  v_mfma_f32_16x16x32_bf16 v[80:83], a[128:131], v[160:163], v[200:203]
  v_exp_f32 v64, v64
  v_mfma_f32_16x16x32_bf16 v[80:83], a[132:135], v[164:167], v[80:83]
  v_mfma_f32_16x16x32_bf16 v[80:83], a[136:139], v[168:171], v[80:83]
  v_exp_f32 v65, v65
  v_mfma_f32_16x16x32_bf16 v[80:83], a[140:143], v[172:175], v[80:83]
  v_cvt_pk_bf16_f32 v64, v64, v65
  v_mfma_f32_16x16x32_bf16 v[88:91], a[140:143], v[188:191], v[204:207]
  v_exp_f32 v66, v66
  v_mfma_f32_16x16x32_bf16 v[88:91], a[136:139], v[184:187], v[88:91]
  buffer_load_dwordx4 v236, s[16:19], s29 offen offset:2048 lds
  v_mfma_f32_16x16x32_bf16 v[88:91], a[132:135], v[180:183], v[88:91]
  s_waitcnt lgkmcnt(0)
  v_exp_f32 v67, v67
  v_mfma_f32_16x16x32_bf16 v[88:91], a[128:131], v[176:179], v[88:91]
  v_cvt_pk_bf16_f32 v65, v66, v67
  v_mfma_f32_16x16x32_bf16 v[68:71], a[144:147], v[128:131], v[192:195]
  v_exp_f32 v72, v72
  v_mfma_f32_16x16x32_bf16 v[68:71], a[148:151], v[132:135], v[68:71]
  ds_read_b128 a[128:131], v212 offset:24576
  v_mfma_f32_16x16x32_bf16 v[68:71], a[152:155], v[136:139], v[68:71]
  v_exp_f32 v73, v73
  v_mfma_f32_16x16x32_bf16 v[68:71], a[156:159], v[140:143], v[68:71]
  ds_read_b128 a[132:135], v213 offset:24576
  v_cvt_pk_bf16_f32 v72, v72, v73
  v_mfma_f32_16x16x32_bf16 v[76:79], a[156:159], v[156:159], v[196:199]
  v_exp_f32 v74, v74
  v_mfma_f32_16x16x32_bf16 v[76:79], a[152:155], v[152:155], v[76:79]
  ds_read_b128 a[136:139], v214 offset:24576
  v_mfma_f32_16x16x32_bf16 v[76:79], a[148:151], v[148:151], v[76:79]
  v_exp_f32 v75, v75
  v_mfma_f32_16x16x32_bf16 v[76:79], a[144:147], v[144:147], v[76:79]
  ds_read_b128 a[140:143], v215 offset:24576
  v_cvt_pk_bf16_f32 v73, v74, v75
  v_mfma_f32_16x16x32_bf16 v[84:87], a[144:147], v[160:163], v[200:203]
  v_exp_f32 v80, v80
  v_mfma_f32_16x16x32_bf16 v[84:87], a[148:151], v[164:167], v[84:87]
  buffer_load_dwordx4 v237, s[16:19], s29 offen offset:3072 lds
  v_mfma_f32_16x16x32_bf16 v[84:87], a[152:155], v[168:171], v[84:87]
  s_add_u32 s29, s29, 16384
  v_exp_f32 v81, v81
  v_mfma_f32_16x16x32_bf16 v[84:87], a[156:159], v[172:175], v[84:87]
  v_cvt_pk_bf16_f32 v80, v80, v81
  v_mfma_f32_16x16x32_bf16 v[92:95], a[156:159], v[188:191], v[204:207]
  s_add_u32 m0, s28, 49152
  v_exp_f32 v82, v82
  v_mfma_f32_16x16x32_bf16 v[92:95], a[152:155], v[184:187], v[92:95]
  buffer_load_dwordx4 v232, s[12:15], s29 offen offset:0 lds
  v_mfma_f32_16x16x32_bf16 v[92:95], a[148:151], v[180:183], v[92:95]
  s_waitcnt lgkmcnt(0)
  v_exp_f32 v83, v83
  v_mfma_f32_16x16x32_bf16 v[92:95], a[144:147], v[176:179], v[92:95]
  v_cvt_pk_bf16_f32 v81, v82, v83
  v_mfma_f32_16x16x32_bf16 v[96:99], a[128:131], v[128:131], v[192:195]
  v_exp_f32 v88, v88
  v_mfma_f32_16x16x32_bf16 v[96:99], a[132:135], v[132:135], v[96:99]
  ds_read_b128 a[144:147], v212 offset:28672
  v_mfma_f32_16x16x32_bf16 v[96:99], a[136:139], v[136:139], v[96:99]
  v_exp_f32 v89, v89
  v_mfma_f32_16x16x32_bf16 v[96:99], a[140:143], v[140:143], v[96:99]
  ds_read_b128 a[148:151], v213 offset:28672
  v_cvt_pk_bf16_f32 v88, v88, v89
  v_mfma_f32_16x16x32_bf16 v[104:107], a[140:143], v[156:159], v[196:199]
  v_exp_f32 v90, v90
  v_mfma_f32_16x16x32_bf16 v[104:107], a[136:139], v[152:155], v[104:107]
  ds_read_b128 a[152:155], v214 offset:28672
  v_mfma_f32_16x16x32_bf16 v[104:107], a[132:135], v[148:151], v[104:107]
  v_exp_f32 v91, v91
  v_mfma_f32_16x16x32_bf16 v[104:107], a[128:131], v[144:147], v[104:107]
  ds_read_b128 a[156:159], v215 offset:28672
  v_cvt_pk_bf16_f32 v89, v90, v91
  v_mfma_f32_16x16x32_bf16 v[112:115], a[128:131], v[160:163], v[200:203]
  v_exp_f32 v68, v68
  v_mfma_f32_16x16x32_bf16 v[112:115], a[132:135], v[164:167], v[112:115]
  buffer_load_dwordx4 v233, s[12:15], s29 offen offset:1024 lds
  v_mfma_f32_16x16x32_bf16 v[112:115], a[136:139], v[168:171], v[112:115]
  v_exp_f32 v69, v69
  v_mfma_f32_16x16x32_bf16 v[112:115], a[140:143], v[172:175], v[112:115]
  v_cvt_pk_bf16_f32 v66, v68, v69
  v_mfma_f32_16x16x32_bf16 v[120:123], a[140:143], v[188:191], v[204:207]
  v_exp_f32 v70, v70
  v_mfma_f32_16x16x32_bf16 v[120:123], a[136:139], v[184:187], v[120:123]
  buffer_load_dwordx4 v234, s[12:15], s29 offen offset:2048 lds
  v_mfma_f32_16x16x32_bf16 v[120:123], a[132:135], v[180:183], v[120:123]
  s_waitcnt lgkmcnt(0)
  v_exp_f32 v71, v71
  v_mfma_f32_16x16x32_bf16 v[120:123], a[128:131], v[176:179], v[120:123]
  v_cvt_pk_bf16_f32 v67, v70, v71
  v_mfma_f32_16x16x32_bf16 v[100:103], a[144:147], v[128:131], v[192:195]
  v_exp_f32 v76, v76
  v_mfma_f32_16x16x32_bf16 v[100:103], a[148:151], v[132:135], v[100:103]
  ds_read_b64_tr_b16 a[160:161], v216 offset:0
  v_mfma_f32_16x16x32_bf16 v[100:103], a[152:155], v[136:139], v[100:103]
  v_exp_f32 v77, v77
  v_mfma_f32_16x16x32_bf16 v[100:103], a[156:159], v[140:143], v[100:103]
  ds_read_b64_tr_b16 a[162:163], v216 offset:4096
  v_cvt_pk_bf16_f32 v74, v76, v77
  v_mfma_f32_16x16x32_bf16 v[108:111], a[156:159], v[156:159], v[196:199]
  v_exp_f32 v78, v78
  v_mfma_f32_16x16x32_bf16 v[108:111], a[152:155], v[152:155], v[108:111]
  ds_read_b64_tr_b16 a[164:165], v216 offset:8192
  buffer_load_dwordx4 v235, s[12:15], s29 offen offset:3072 lds
  v_mfma_f32_16x16x32_bf16 v[108:111], a[148:151], v[148:151], v[108:111]
  v_exp_f32 v79, v79
  v_mfma_f32_16x16x32_bf16 v[108:111], a[144:147], v[144:147], v[108:111]
  ds_read_b64_tr_b16 a[166:167], v216 offset:12288
  v_cvt_pk_bf16_f32 v75, v78, v79
  v_mfma_f32_16x16x32_bf16 v[116:119], a[144:147], v[160:163], v[200:203]
  s_add_u32 m0, s50, 5120
  v_exp_f32 v84, v84
  v_mfma_f32_16x16x32_bf16 v[116:119], a[148:151], v[164:167], v[116:119]
  ds_read_b64_tr_b16 a[168:169], v217 offset:0
  buffer_load_dwordx4 v208, s[20:23], s30 offen lds
  s_add_u32 s30, s30, 32
  v_mfma_f32_16x16x32_bf16 v[116:119], a[152:155], v[168:171], v[116:119]
  v_exp_f32 v85, v85
  v_mfma_f32_16x16x32_bf16 v[116:119], a[156:159], v[172:175], v[116:119]
  ds_read_b64_tr_b16 a[170:171], v217 offset:4096
  v_cvt_pk_bf16_f32 v82, v84, v85
  v_mfma_f32_16x16x32_bf16 v[124:127], a[156:159], v[188:191], v[204:207]
  v_exp_f32 v86, v86
  v_mfma_f32_16x16x32_bf16 v[124:127], a[152:155], v[184:187], v[124:127]
  ds_read_b64_tr_b16 a[172:173], v217 offset:8192
  v_mfma_f32_16x16x32_bf16 v[124:127], a[148:151], v[180:183], v[124:127]
  v_exp_f32 v87, v87
  v_mfma_f32_16x16x32_bf16 v[124:127], a[144:147], v[176:179], v[124:127]
  ds_read_b64_tr_b16 a[174:175], v217 offset:12288
  v_cvt_pk_bf16_f32 v83, v86, v87
  v_mfma_f32_16x16x32_bf16 a[192:195], a[208:211], v[0:3], a[192:195]
  v_exp_f32 v92, v92
  v_mfma_f32_16x16x32_bf16 a[192:195], a[208:211], v[32:35], a[192:195]
  ds_read_b64_tr_b16 a[176:177], v218 offset:0
  v_mfma_f32_16x16x32_bf16 a[196:199], a[208:211], v[8:11], a[196:199]
  v_exp_f32 v93, v93
  v_mfma_f32_16x16x32_bf16 a[196:199], a[208:211], v[40:43], a[196:199]
  ds_read_b64_tr_b16 a[178:179], v218 offset:4096
  v_cvt_pk_bf16_f32 v90, v92, v93
  v_mfma_f32_16x16x32_bf16 a[200:203], a[208:211], v[16:19], a[200:203]
  v_exp_f32 v94, v94
  v_mfma_f32_16x16x32_bf16 a[200:203], a[208:211], v[48:51], a[200:203]
  ds_read_b64_tr_b16 a[180:181], v218 offset:8192
  v_mfma_f32_16x16x32_bf16 a[204:207], a[208:211], v[24:27], a[204:207]
  s_waitcnt lgkmcnt(7)
  v_exp_f32 v95, v95
  v_mfma_f32_16x16x32_bf16 a[204:207], a[208:211], v[56:59], a[204:207]
  ds_read_b64_tr_b16 a[182:183], v218 offset:12288
  v_cvt_pk_bf16_f32 v91, v94, v95
  v_mfma_f32_16x16x32_bf16 a[0:3], a[160:163], v[0:3], a[0:3]
  v_exp_f32 v96, v96
  v_mfma_f32_16x16x32_bf16 a[0:3], a[164:167], v[32:35], a[0:3]
  ds_read_b64_tr_b16 a[184:185], v219 offset:0
  v_mfma_f32_16x16x32_bf16 a[4:7], a[164:167], v[40:43], a[4:7]
  v_exp_f32 v97, v97
  v_mfma_f32_16x16x32_bf16 a[4:7], a[160:163], v[8:11], a[4:7]
  ds_read_b64_tr_b16 a[186:187], v219 offset:4096
  v_cvt_pk_bf16_f32 v96, v96, v97
  v_mfma_f32_16x16x32_bf16 a[8:11], a[160:163], v[16:19], a[8:11]
  v_exp_f32 v98, v98
  v_mfma_f32_16x16x32_bf16 a[8:11], a[164:167], v[48:51], a[8:11]
  ds_read_b64_tr_b16 a[188:189], v219 offset:8192
  v_mfma_f32_16x16x32_bf16 a[12:15], a[164:167], v[56:59], a[12:15]
  s_waitcnt lgkmcnt(7)
  v_exp_f32 v99, v99
  v_mfma_f32_16x16x32_bf16 a[12:15], a[160:163], v[24:27], a[12:15]
  ds_read_b64_tr_b16 a[190:191], v219 offset:12288
  v_cvt_pk_bf16_f32 v97, v98, v99
  v_mfma_f32_16x16x32_bf16 a[16:19], a[168:171], v[0:3], a[16:19]
  v_exp_f32 v104, v104
  v_mfma_f32_16x16x32_bf16 a[16:19], a[172:175], v[32:35], a[16:19]
  ds_read_b64_tr_b16 a[160:161], v220 offset:0
  v_mfma_f32_16x16x32_bf16 a[20:23], a[172:175], v[40:43], a[20:23]
  v_exp_f32 v105, v105
  v_mfma_f32_16x16x32_bf16 a[20:23], a[168:171], v[8:11], a[20:23]
  ds_read_b64_tr_b16 a[162:163], v220 offset:4096
  v_cvt_pk_bf16_f32 v104, v104, v105
  v_mfma_f32_16x16x32_bf16 a[24:27], a[168:171], v[16:19], a[24:27]
  v_exp_f32 v106, v106
  v_mfma_f32_16x16x32_bf16 a[24:27], a[172:175], v[48:51], a[24:27]
  ds_read_b64_tr_b16 a[164:165], v220 offset:8192
  v_mfma_f32_16x16x32_bf16 a[28:31], a[172:175], v[56:59], a[28:31]
  s_waitcnt lgkmcnt(7)
  v_exp_f32 v107, v107
  v_mfma_f32_16x16x32_bf16 a[28:31], a[168:171], v[24:27], a[28:31]
  ds_read_b64_tr_b16 a[166:167], v220 offset:12288
  v_cvt_pk_bf16_f32 v105, v106, v107
  v_mfma_f32_16x16x32_bf16 a[32:35], a[176:179], v[0:3], a[32:35]
  v_exp_f32 v112, v112
  v_mfma_f32_16x16x32_bf16 a[32:35], a[180:183], v[32:35], a[32:35]
  ds_read_b64_tr_b16 a[168:169], v221 offset:0
  v_mfma_f32_16x16x32_bf16 a[36:39], a[180:183], v[40:43], a[36:39]
  v_exp_f32 v113, v113
  v_mfma_f32_16x16x32_bf16 a[36:39], a[176:179], v[8:11], a[36:39]
  ds_read_b64_tr_b16 a[170:171], v221 offset:4096
  v_cvt_pk_bf16_f32 v112, v112, v113
  v_mfma_f32_16x16x32_bf16 a[40:43], a[176:179], v[16:19], a[40:43]
  v_exp_f32 v114, v114
  v_mfma_f32_16x16x32_bf16 a[40:43], a[180:183], v[48:51], a[40:43]
  ds_read_b64_tr_b16 a[172:173], v221 offset:8192
  v_mfma_f32_16x16x32_bf16 a[44:47], a[180:183], v[56:59], a[44:47]
  s_waitcnt lgkmcnt(7)
  v_exp_f32 v115, v115
  v_mfma_f32_16x16x32_bf16 a[44:47], a[176:179], v[24:27], a[44:47]
  ds_read_b64_tr_b16 a[174:175], v221 offset:12288
  v_cvt_pk_bf16_f32 v113, v114, v115
  v_mfma_f32_16x16x32_bf16 a[48:51], a[184:187], v[0:3], a[48:51]
  v_exp_f32 v120, v120
  v_mfma_f32_16x16x32_bf16 a[48:51], a[188:191], v[32:35], a[48:51]
  ds_read_b64_tr_b16 a[176:177], v222 offset:0
  v_mfma_f32_16x16x32_bf16 a[52:55], a[188:191], v[40:43], a[52:55]
  v_exp_f32 v121, v121
  v_mfma_f32_16x16x32_bf16 a[52:55], a[184:187], v[8:11], a[52:55]
  ds_read_b64_tr_b16 a[178:179], v222 offset:4096
  v_cvt_pk_bf16_f32 v120, v120, v121
  v_mfma_f32_16x16x32_bf16 a[56:59], a[184:187], v[16:19], a[56:59]
  v_exp_f32 v122, v122
  v_mfma_f32_16x16x32_bf16 a[56:59], a[188:191], v[48:51], a[56:59]
  ds_read_b64_tr_b16 a[180:181], v222 offset:8192
  v_mfma_f32_16x16x32_bf16 a[60:63], a[188:191], v[56:59], a[60:63]
  s_waitcnt lgkmcnt(7)
  v_exp_f32 v123, v123
  v_mfma_f32_16x16x32_bf16 a[60:63], a[184:187], v[24:27], a[60:63]
  ds_read_b64_tr_b16 a[182:183], v222 offset:12288
  v_cvt_pk_bf16_f32 v121, v122, v123
  v_mfma_f32_16x16x32_bf16 a[64:67], a[160:163], v[0:3], a[64:67]
  v_exp_f32 v100, v100
  v_mfma_f32_16x16x32_bf16 a[64:67], a[164:167], v[32:35], a[64:67]
  ds_read_b64_tr_b16 a[184:185], v223 offset:0
  v_mfma_f32_16x16x32_bf16 a[68:71], a[164:167], v[40:43], a[68:71]
  v_exp_f32 v101, v101
  v_mfma_f32_16x16x32_bf16 a[68:71], a[160:163], v[8:11], a[68:71]
  ds_read_b64_tr_b16 a[186:187], v223 offset:4096
  v_cvt_pk_bf16_f32 v98, v100, v101
  v_mfma_f32_16x16x32_bf16 a[72:75], a[160:163], v[16:19], a[72:75]
  v_exp_f32 v102, v102
  v_mfma_f32_16x16x32_bf16 a[72:75], a[164:167], v[48:51], a[72:75]
  ds_read_b64_tr_b16 a[188:189], v223 offset:8192
  v_mfma_f32_16x16x32_bf16 a[76:79], a[164:167], v[56:59], a[76:79]
  s_waitcnt lgkmcnt(7)
  v_exp_f32 v103, v103
  v_mfma_f32_16x16x32_bf16 a[76:79], a[160:163], v[24:27], a[76:79]
  ds_read_b64_tr_b16 a[190:191], v223 offset:12288
  v_cvt_pk_bf16_f32 v99, v102, v103
  v_mfma_f32_16x16x32_bf16 a[80:83], a[168:171], v[0:3], a[80:83]
  s_waitcnt vmcnt(10)
  v_exp_f32 v108, v108
  v_mfma_f32_16x16x32_bf16 a[80:83], a[172:175], v[32:35], a[80:83]
  v_mfma_f32_16x16x32_bf16 a[84:87], a[172:175], v[40:43], a[84:87]
  s_barrier
  v_exp_f32 v109, v109
  v_mfma_f32_16x16x32_bf16 a[84:87], a[168:171], v[8:11], a[84:87]
  ds_read_b128 a[128:131], v212 offset:32768
  v_cvt_pk_bf16_f32 v106, v108, v109
  v_mfma_f32_16x16x32_bf16 a[88:91], a[168:171], v[16:19], a[88:91]
  v_exp_f32 v110, v110
  v_mfma_f32_16x16x32_bf16 a[88:91], a[172:175], v[48:51], a[88:91]
  ds_read_b128 a[132:135], v213 offset:32768
  buffer_atomic_add v250, v249, s[24:27], s47 offen
  s_cmp_eq_u32 s32, 3
  s_cselect_b32 s39, 0, 1073741824
  v_mfma_f32_16x16x32_bf16 a[92:95], a[172:175], v[56:59], a[92:95]
  s_waitcnt lgkmcnt(6)
  v_exp_f32 v111, v111
  v_mfma_f32_16x16x32_bf16 a[92:95], a[168:171], v[24:27], a[92:95]
  ds_read_b128 a[136:139], v214 offset:32768
  v_cvt_pk_bf16_f32 v107, v110, v111
  v_mfma_f32_16x16x32_bf16 a[96:99], a[176:179], v[0:3], a[96:99]
  v_exp_f32 v116, v116
  v_mfma_f32_16x16x32_bf16 a[96:99], a[180:183], v[32:35], a[96:99]
  ds_read_b128 a[140:143], v215 offset:32768
  v_or_b32 v249, s39, v251
  v_mfma_f32_16x16x32_bf16 a[100:103], a[180:183], v[40:43], a[100:103]
  v_exp_f32 v117, v117
  v_mfma_f32_16x16x32_bf16 a[100:103], a[176:179], v[8:11], a[100:103]
  v_cvt_pk_bf16_f32 v114, v116, v117
  v_mfma_f32_16x16x32_bf16 a[104:107], a[176:179], v[16:19], a[104:107]
  v_exp_f32 v118, v118
  v_mfma_f32_16x16x32_bf16 a[104:107], a[180:183], v[48:51], a[104:107]
  v_mfma_f32_16x16x32_bf16 a[108:111], a[180:183], v[56:59], a[108:111]
  s_waitcnt lgkmcnt(4)
  v_exp_f32 v119, v119
  v_mfma_f32_16x16x32_bf16 a[108:111], a[176:179], v[24:27], a[108:111]
  v_cvt_pk_bf16_f32 v115, v118, v119
  v_mfma_f32_16x16x32_bf16 a[112:115], a[184:187], v[0:3], a[112:115]
  v_exp_f32 v124, v124
  v_mfma_f32_16x16x32_bf16 a[112:115], a[188:191], v[32:35], a[112:115]
  v_mfma_f32_16x16x32_bf16 a[116:119], a[188:191], v[40:43], a[116:119]
  v_exp_f32 v125, v125
  v_mfma_f32_16x16x32_bf16 a[116:119], a[184:187], v[8:11], a[116:119]
  v_cvt_pk_bf16_f32 v122, v124, v125
  v_mfma_f32_16x16x32_bf16 a[120:123], a[184:187], v[16:19], a[120:123]
  v_exp_f32 v126, v126
  v_mfma_f32_16x16x32_bf16 a[120:123], a[188:191], v[48:51], a[120:123]
  v_mfma_f32_16x16x32_bf16 a[124:127], a[188:191], v[56:59], a[124:127]
  s_waitcnt lgkmcnt(0)
  v_exp_f32 v127, v127
  v_mfma_f32_16x16x32_bf16 a[124:127], a[184:187], v[24:27], a[124:127]
  v_cvt_pk_bf16_f32 v123, v126, v127
  v_mfma_f32_16x16x32_bf16 v[0:3], a[128:131], v[128:131], v[192:195]
  s_add_u32 m0, s28, 114688
  v_mfma_f32_16x16x32_bf16 v[0:3], a[132:135], v[132:135], v[0:3]
  ds_read_b128 a[144:147], v212 offset:36864
  v_mfma_f32_16x16x32_bf16 v[0:3], a[136:139], v[136:139], v[0:3]
  buffer_load_dwordx4 v236, s[16:19], s29 offen offset:0 lds
  v_mfma_f32_16x16x32_bf16 v[0:3], a[140:143], v[140:143], v[0:3]
  ds_read_b128 a[148:151], v213 offset:36864
  v_mfma_f32_16x16x32_bf16 v[8:11], a[140:143], v[156:159], v[196:199]
  v_mfma_f32_16x16x32_bf16 v[8:11], a[136:139], v[152:155], v[8:11]
  ds_read_b128 a[152:155], v214 offset:36864
  v_mfma_f32_16x16x32_bf16 v[8:11], a[132:135], v[148:151], v[8:11]
  buffer_load_dwordx4 v237, s[16:19], s29 offen offset:1024 lds
  v_mfma_f32_16x16x32_bf16 v[8:11], a[128:131], v[144:147], v[8:11]
  ds_read_b128 a[156:159], v215 offset:36864
  v_mfma_f32_16x16x32_bf16 v[16:19], a[128:131], v[160:163], v[200:203]
  v_exp_f32 v0, v0
  v_mfma_f32_16x16x32_bf16 v[16:19], a[132:135], v[164:167], v[16:19]
  v_mfma_f32_16x16x32_bf16 v[16:19], a[136:139], v[168:171], v[16:19]
  v_exp_f32 v1, v1
  v_mfma_f32_16x16x32_bf16 v[16:19], a[140:143], v[172:175], v[16:19]
  v_cvt_pk_bf16_f32 v0, v0, v1
  v_mfma_f32_16x16x32_bf16 v[24:27], a[140:143], v[188:191], v[204:207]
  v_exp_f32 v2, v2
  v_mfma_f32_16x16x32_bf16 v[24:27], a[136:139], v[184:187], v[24:27]
  buffer_load_dwordx4 v236, s[16:19], s29 offen offset:2048 lds
  v_mfma_f32_16x16x32_bf16 v[24:27], a[132:135], v[180:183], v[24:27]
  s_waitcnt lgkmcnt(0)
  v_exp_f32 v3, v3
  v_mfma_f32_16x16x32_bf16 v[24:27], a[128:131], v[176:179], v[24:27]
  v_cvt_pk_bf16_f32 v1, v2, v3
  v_mfma_f32_16x16x32_bf16 v[4:7], a[144:147], v[128:131], v[192:195]
  v_exp_f32 v8, v8
  v_mfma_f32_16x16x32_bf16 v[4:7], a[148:151], v[132:135], v[4:7]
  ds_read_b128 a[128:131], v212 offset:40960
  v_mfma_f32_16x16x32_bf16 v[4:7], a[152:155], v[136:139], v[4:7]
  v_exp_f32 v9, v9
  v_mfma_f32_16x16x32_bf16 v[4:7], a[156:159], v[140:143], v[4:7]
  ds_read_b128 a[132:135], v213 offset:40960
  v_cvt_pk_bf16_f32 v8, v8, v9
  v_mfma_f32_16x16x32_bf16 v[12:15], a[156:159], v[156:159], v[196:199]
  v_exp_f32 v10, v10
  v_mfma_f32_16x16x32_bf16 v[12:15], a[152:155], v[152:155], v[12:15]
  ds_read_b128 a[136:139], v214 offset:40960
  v_mfma_f32_16x16x32_bf16 v[12:15], a[148:151], v[148:151], v[12:15]
  v_exp_f32 v11, v11
  v_mfma_f32_16x16x32_bf16 v[12:15], a[144:147], v[144:147], v[12:15]
  ds_read_b128 a[140:143], v215 offset:40960
  v_cvt_pk_bf16_f32 v9, v10, v11
  v_mfma_f32_16x16x32_bf16 v[20:23], a[144:147], v[160:163], v[200:203]
  v_exp_f32 v16, v16
  v_mfma_f32_16x16x32_bf16 v[20:23], a[148:151], v[164:167], v[20:23]
  buffer_load_dwordx4 v237, s[16:19], s29 offen offset:3072 lds
  v_mfma_f32_16x16x32_bf16 v[20:23], a[152:155], v[168:171], v[20:23]
  s_add_u32 s29, s29, 16384
  v_exp_f32 v17, v17
  v_mfma_f32_16x16x32_bf16 v[20:23], a[156:159], v[172:175], v[20:23]
  v_cvt_pk_bf16_f32 v16, v16, v17
  v_mfma_f32_16x16x32_bf16 v[28:31], a[156:159], v[188:191], v[204:207]
  s_add_u32 m0, s28, 0
  v_exp_f32 v18, v18
  v_mfma_f32_16x16x32_bf16 v[28:31], a[152:155], v[184:187], v[28:31]
  buffer_load_dwordx4 v232, s[12:15], s29 offen offset:0 lds
  v_mfma_f32_16x16x32_bf16 v[28:31], a[148:151], v[180:183], v[28:31]
  s_waitcnt lgkmcnt(0)
  v_exp_f32 v19, v19
  v_mfma_f32_16x16x32_bf16 v[28:31], a[144:147], v[176:179], v[28:31]
  v_cvt_pk_bf16_f32 v17, v18, v19
  v_mfma_f32_16x16x32_bf16 v[32:35], a[128:131], v[128:131], v[192:195]
  v_exp_f32 v24, v24
  v_mfma_f32_16x16x32_bf16 v[32:35], a[132:135], v[132:135], v[32:35]
  ds_read_b128 a[144:147], v212 offset:45056
  v_mfma_f32_16x16x32_bf16 v[32:35], a[136:139], v[136:139], v[32:35]
  v_exp_f32 v25, v25
  v_mfma_f32_16x16x32_bf16 v[32:35], a[140:143], v[140:143], v[32:35]
  ds_read_b128 a[148:151], v213 offset:45056
  v_cvt_pk_bf16_f32 v24, v24, v25
  v_mfma_f32_16x16x32_bf16 v[40:43], a[140:143], v[156:159], v[196:199]
  v_exp_f32 v26, v26
  v_mfma_f32_16x16x32_bf16 v[40:43], a[136:139], v[152:155], v[40:43]
  ds_read_b128 a[152:155], v214 offset:45056
  v_mfma_f32_16x16x32_bf16 v[40:43], a[132:135], v[148:151], v[40:43]
  v_exp_f32 v27, v27
  v_mfma_f32_16x16x32_bf16 v[40:43], a[128:131], v[144:147], v[40:43]
  ds_read_b128 a[156:159], v215 offset:45056
  v_cvt_pk_bf16_f32 v25, v26, v27
  v_mfma_f32_16x16x32_bf16 v[48:51], a[128:131], v[160:163], v[200:203]
  v_exp_f32 v4, v4
  v_mfma_f32_16x16x32_bf16 v[48:51], a[132:135], v[164:167], v[48:51]
  buffer_load_dwordx4 v233, s[12:15], s29 offen offset:1024 lds
  v_mfma_f32_16x16x32_bf16 v[48:51], a[136:139], v[168:171], v[48:51]
  v_exp_f32 v5, v5
  v_mfma_f32_16x16x32_bf16 v[48:51], a[140:143], v[172:175], v[48:51]
  v_cvt_pk_bf16_f32 v2, v4, v5
  v_mfma_f32_16x16x32_bf16 v[56:59], a[140:143], v[188:191], v[204:207]
  v_exp_f32 v6, v6
  v_mfma_f32_16x16x32_bf16 v[56:59], a[136:139], v[184:187], v[56:59]
  buffer_load_dwordx4 v234, s[12:15], s29 offen offset:2048 lds
  v_mfma_f32_16x16x32_bf16 v[56:59], a[132:135], v[180:183], v[56:59]
  s_waitcnt lgkmcnt(0)
  v_exp_f32 v7, v7
  v_mfma_f32_16x16x32_bf16 v[56:59], a[128:131], v[176:179], v[56:59]
  v_cvt_pk_bf16_f32 v3, v6, v7
  v_mfma_f32_16x16x32_bf16 v[36:39], a[144:147], v[128:131], v[192:195]
  v_exp_f32 v12, v12
  v_mfma_f32_16x16x32_bf16 v[36:39], a[148:151], v[132:135], v[36:39]
  ds_read_b64_tr_b16 a[160:161], v216 offset:16384
  v_mfma_f32_16x16x32_bf16 v[36:39], a[152:155], v[136:139], v[36:39]
  v_exp_f32 v13, v13
  v_mfma_f32_16x16x32_bf16 v[36:39], a[156:159], v[140:143], v[36:39]
  ds_read_b64_tr_b16 a[162:163], v216 offset:20480
  v_cvt_pk_bf16_f32 v10, v12, v13
  v_mfma_f32_16x16x32_bf16 v[44:47], a[156:159], v[156:159], v[196:199]
  v_exp_f32 v14, v14
  v_mfma_f32_16x16x32_bf16 v[44:47], a[152:155], v[152:155], v[44:47]
  ds_read_b64_tr_b16 a[164:165], v216 offset:24576
  buffer_load_dwordx4 v235, s[12:15], s29 offen offset:3072 lds
  v_mfma_f32_16x16x32_bf16 v[44:47], a[148:151], v[148:151], v[44:47]
  v_exp_f32 v15, v15
  v_mfma_f32_16x16x32_bf16 v[44:47], a[144:147], v[144:147], v[44:47]
  ds_read_b64_tr_b16 a[166:167], v216 offset:28672
  v_cvt_pk_bf16_f32 v11, v14, v15
  v_mfma_f32_16x16x32_bf16 v[52:55], a[144:147], v[160:163], v[200:203]
  s_mov_b32 m0, s51
  v_exp_f32 v20, v20
  v_mfma_f32_16x16x32_bf16 v[52:55], a[148:151], v[164:167], v[52:55]
  ds_read_b64_tr_b16 a[168:169], v217 offset:16384
  buffer_load_dwordx4 v210, s[4:7], s100 offen lds
  s_add_u32 s100, s100, 20480
  s_add_u32 s51, s51, 512
  v_mfma_f32_16x16x32_bf16 v[52:55], a[152:155], v[168:171], v[52:55]
  v_exp_f32 v21, v21
  v_mfma_f32_16x16x32_bf16 v[52:55], a[156:159], v[172:175], v[52:55]
  ds_read_b64_tr_b16 a[170:171], v217 offset:20480
  v_cvt_pk_bf16_f32 v18, v20, v21
  v_mfma_f32_16x16x32_bf16 v[60:63], a[156:159], v[188:191], v[204:207]
  s_waitcnt vmcnt(19)
  v_exp_f32 v22, v22
  v_mfma_f32_16x16x32_bf16 v[60:63], a[152:155], v[184:187], v[60:63]
  ds_read_b64_tr_b16 a[172:173], v217 offset:24576
  ds_read_b64_tr_b16 a[232:233], v209 offset:4096
  v_mfma_f32_16x16x32_bf16 v[60:63], a[148:151], v[180:183], v[60:63]
  v_exp_f32 v23, v23
  v_mfma_f32_16x16x32_bf16 v[60:63], a[144:147], v[176:179], v[60:63]
  ds_read_b64_tr_b16 a[174:175], v217 offset:28672
  v_cvt_pk_bf16_f32 v19, v22, v23
  v_mfma_f32_16x16x32_bf16 a[192:195], a[208:211], v[64:67], a[192:195]
  v_exp_f32 v28, v28
  v_mfma_f32_16x16x32_bf16 a[192:195], a[208:211], v[96:99], a[192:195]
  ds_read_b64_tr_b16 a[176:177], v218 offset:16384
  ds_read_b64_tr_b16 a[234:235], v209 offset:4608
  v_mfma_f32_16x16x32_bf16 a[196:199], a[208:211], v[72:75], a[196:199]
  v_exp_f32 v29, v29
  v_mfma_f32_16x16x32_bf16 a[196:199], a[208:211], v[104:107], a[196:199]
  ds_read_b64_tr_b16 a[178:179], v218 offset:20480
  v_cvt_pk_bf16_f32 v26, v28, v29
  v_mfma_f32_16x16x32_bf16 a[200:203], a[208:211], v[80:83], a[200:203]
  v_exp_f32 v30, v30
  v_mfma_f32_16x16x32_bf16 a[200:203], a[208:211], v[112:115], a[200:203]
  ds_read_b64_tr_b16 a[180:181], v218 offset:24576
  v_mfma_f32_16x16x32_bf16 a[204:207], a[208:211], v[88:91], a[204:207]
  s_waitcnt lgkmcnt(9)
  v_exp_f32 v31, v31
  v_mfma_f32_16x16x32_bf16 a[204:207], a[208:211], v[120:123], a[204:207]
  ds_read_b64_tr_b16 a[182:183], v218 offset:28672
  v_cvt_pk_bf16_f32 v27, v30, v31
  v_mfma_f32_16x16x32_bf16 a[0:3], a[160:163], v[64:67], a[0:3]
  v_exp_f32 v32, v32
  v_mfma_f32_16x16x32_bf16 a[0:3], a[164:167], v[96:99], a[0:3]
  ds_read_b64_tr_b16 a[184:185], v219 offset:16384
  s_waitcnt lgkmcnt(4)
  buffer_store_dwordx4 a[232:235], v211, s[24:27], s31 offen sc1
  s_add_u32 s31, s31, 1024
  s_cmp_gt_u32 s32, 3
  v_mfma_f32_16x16x32_bf16 a[4:7], a[164:167], v[104:107], a[4:7]
  s_cselect_b32 s39, 0, 1073741824
  v_exp_f32 v33, v33
  v_mfma_f32_16x16x32_bf16 a[4:7], a[160:163], v[72:75], a[4:7]
  ds_read_b64_tr_b16 a[186:187], v219 offset:20480
  v_cvt_pk_bf16_f32 v32, v32, v33
  v_mfma_f32_16x16x32_bf16 a[8:11], a[160:163], v[80:83], a[8:11]
  v_exp_f32 v34, v34
  v_mfma_f32_16x16x32_bf16 a[8:11], a[164:167], v[112:115], a[8:11]
  ds_read_b64_tr_b16 a[188:189], v219 offset:24576
  v_or_b32 v211, s39, v211
  v_mfma_f32_16x16x32_bf16 a[12:15], a[164:167], v[120:123], a[12:15]
  v_exp_f32 v35, v35
  v_mfma_f32_16x16x32_bf16 a[12:15], a[160:163], v[88:91], a[12:15]
  ds_read_b64_tr_b16 a[190:191], v219 offset:28672
  v_cvt_pk_bf16_f32 v33, v34, v35
  v_mfma_f32_16x16x32_bf16 a[16:19], a[168:171], v[64:67], a[16:19]
  v_exp_f32 v40, v40
  v_mfma_f32_16x16x32_bf16 a[16:19], a[172:175], v[96:99], a[16:19]
  ds_read_b64_tr_b16 a[160:161], v220 offset:16384
  v_or_b32 v208, s39, v208
  v_mfma_f32_16x16x32_bf16 a[20:23], a[172:175], v[104:107], a[20:23]
  v_exp_f32 v41, v41
  v_mfma_f32_16x16x32_bf16 a[20:23], a[168:171], v[72:75], a[20:23]
  ds_read_b64_tr_b16 a[162:163], v220 offset:20480
  v_cvt_pk_bf16_f32 v40, v40, v41
  v_mfma_f32_16x16x32_bf16 a[24:27], a[168:171], v[80:83], a[24:27]
  v_exp_f32 v42, v42
  v_mfma_f32_16x16x32_bf16 a[24:27], a[172:175], v[112:115], a[24:27]
  ds_read_b64_tr_b16 a[164:165], v220 offset:24576
  v_mfma_f32_16x16x32_bf16 a[28:31], a[172:175], v[120:123], a[28:31]
  s_waitcnt lgkmcnt(7)
  v_exp_f32 v43, v43
  v_mfma_f32_16x16x32_bf16 a[28:31], a[168:171], v[88:91], a[28:31]
  ds_read_b64_tr_b16 a[166:167], v220 offset:28672
  v_cvt_pk_bf16_f32 v41, v42, v43
  v_mfma_f32_16x16x32_bf16 a[32:35], a[176:179], v[64:67], a[32:35]
  v_exp_f32 v48, v48
  v_mfma_f32_16x16x32_bf16 a[32:35], a[180:183], v[96:99], a[32:35]
  ds_read_b64_tr_b16 a[168:169], v221 offset:16384
  v_mfma_f32_16x16x32_bf16 a[36:39], a[180:183], v[104:107], a[36:39]
  v_exp_f32 v49, v49
  v_mfma_f32_16x16x32_bf16 a[36:39], a[176:179], v[72:75], a[36:39]
  ds_read_b64_tr_b16 a[170:171], v221 offset:20480
  v_cvt_pk_bf16_f32 v48, v48, v49
  v_mfma_f32_16x16x32_bf16 a[40:43], a[176:179], v[80:83], a[40:43]
  v_exp_f32 v50, v50
  v_mfma_f32_16x16x32_bf16 a[40:43], a[180:183], v[112:115], a[40:43]
  ds_read_b64_tr_b16 a[172:173], v221 offset:24576
  v_mfma_f32_16x16x32_bf16 a[44:47], a[180:183], v[120:123], a[44:47]
  s_waitcnt lgkmcnt(7)
  v_exp_f32 v51, v51
  v_mfma_f32_16x16x32_bf16 a[44:47], a[176:179], v[88:91], a[44:47]
  ds_read_b64_tr_b16 a[174:175], v221 offset:28672
  v_cvt_pk_bf16_f32 v49, v50, v51
  v_mfma_f32_16x16x32_bf16 a[48:51], a[184:187], v[64:67], a[48:51]
  v_exp_f32 v56, v56
  v_mfma_f32_16x16x32_bf16 a[48:51], a[188:191], v[96:99], a[48:51]
  ds_read_b64_tr_b16 a[176:177], v222 offset:16384
  v_mfma_f32_16x16x32_bf16 a[52:55], a[188:191], v[104:107], a[52:55]
  v_exp_f32 v57, v57
  v_mfma_f32_16x16x32_bf16 a[52:55], a[184:187], v[72:75], a[52:55]
  ds_read_b64_tr_b16 a[178:179], v222 offset:20480
  v_cvt_pk_bf16_f32 v56, v56, v57
  v_mfma_f32_16x16x32_bf16 a[56:59], a[184:187], v[80:83], a[56:59]
  v_exp_f32 v58, v58
  v_mfma_f32_16x16x32_bf16 a[56:59], a[188:191], v[112:115], a[56:59]
  ds_read_b64_tr_b16 a[180:181], v222 offset:24576
  v_mfma_f32_16x16x32_bf16 a[60:63], a[188:191], v[120:123], a[60:63]
  s_waitcnt lgkmcnt(7)
  v_exp_f32 v59, v59
  v_mfma_f32_16x16x32_bf16 a[60:63], a[184:187], v[88:91], a[60:63]
  ds_read_b64_tr_b16 a[182:183], v222 offset:28672
  v_cvt_pk_bf16_f32 v57, v58, v59
  v_mfma_f32_16x16x32_bf16 a[64:67], a[160:163], v[64:67], a[64:67]
  v_exp_f32 v36, v36
  v_mfma_f32_16x16x32_bf16 a[64:67], a[164:167], v[96:99], a[64:67]
  ds_read_b64_tr_b16 a[184:185], v223 offset:16384
  v_mfma_f32_16x16x32_bf16 a[68:71], a[164:167], v[104:107], a[68:71]
  v_exp_f32 v37, v37
  v_mfma_f32_16x16x32_bf16 a[68:71], a[160:163], v[72:75], a[68:71]
  ds_read_b64_tr_b16 a[186:187], v223 offset:20480
  v_cvt_pk_bf16_f32 v34, v36, v37
  v_mfma_f32_16x16x32_bf16 a[72:75], a[160:163], v[80:83], a[72:75]
  v_exp_f32 v38, v38
  v_mfma_f32_16x16x32_bf16 a[72:75], a[164:167], v[112:115], a[72:75]
  ds_read_b64_tr_b16 a[188:189], v223 offset:24576
  v_mfma_f32_16x16x32_bf16 a[76:79], a[164:167], v[120:123], a[76:79]
  s_waitcnt lgkmcnt(7)
  v_exp_f32 v39, v39
  v_mfma_f32_16x16x32_bf16 a[76:79], a[160:163], v[88:91], a[76:79]
  ds_read_b64_tr_b16 a[190:191], v223 offset:28672
  v_cvt_pk_bf16_f32 v35, v38, v39
  v_mfma_f32_16x16x32_bf16 a[80:83], a[168:171], v[64:67], a[80:83]
  s_waitcnt vmcnt(12)
  v_exp_f32 v44, v44
  v_mfma_f32_16x16x32_bf16 a[80:83], a[172:175], v[96:99], a[80:83]
  v_mfma_f32_16x16x32_bf16 a[84:87], a[172:175], v[104:107], a[84:87]
  s_barrier
  v_exp_f32 v45, v45
  v_mfma_f32_16x16x32_bf16 a[84:87], a[168:171], v[72:75], a[84:87]
  ds_read_b128 a[128:131], v212 offset:49152
  v_cvt_pk_bf16_f32 v42, v44, v45
  v_mfma_f32_16x16x32_bf16 a[88:91], a[168:171], v[80:83], a[88:91]
  v_exp_f32 v46, v46
  v_mfma_f32_16x16x32_bf16 a[88:91], a[172:175], v[112:115], a[88:91]
  ds_read_b128 a[132:135], v213 offset:49152
  v_mfma_f32_16x16x32_bf16 a[92:95], a[172:175], v[120:123], a[92:95]
  s_waitcnt lgkmcnt(6)
  v_exp_f32 v47, v47
  v_mfma_f32_16x16x32_bf16 a[92:95], a[168:171], v[88:91], a[92:95]
  ds_read_b128 a[136:139], v214 offset:49152
  v_cvt_pk_bf16_f32 v43, v46, v47
  v_mfma_f32_16x16x32_bf16 a[96:99], a[176:179], v[64:67], a[96:99]
  v_exp_f32 v52, v52
  v_mfma_f32_16x16x32_bf16 a[96:99], a[180:183], v[96:99], a[96:99]
  ds_read_b128 a[140:143], v215 offset:49152
  v_mfma_f32_16x16x32_bf16 a[100:103], a[180:183], v[104:107], a[100:103]
  v_exp_f32 v53, v53
  v_mfma_f32_16x16x32_bf16 a[100:103], a[176:179], v[72:75], a[100:103]
  v_cvt_pk_bf16_f32 v50, v52, v53
  v_mfma_f32_16x16x32_bf16 a[104:107], a[176:179], v[80:83], a[104:107]
  v_exp_f32 v54, v54
  v_mfma_f32_16x16x32_bf16 a[104:107], a[180:183], v[112:115], a[104:107]
  v_mfma_f32_16x16x32_bf16 a[108:111], a[180:183], v[120:123], a[108:111]
  s_waitcnt lgkmcnt(4)
  v_exp_f32 v55, v55
  v_mfma_f32_16x16x32_bf16 a[108:111], a[176:179], v[88:91], a[108:111]
  v_cvt_pk_bf16_f32 v51, v54, v55
  v_mfma_f32_16x16x32_bf16 a[112:115], a[184:187], v[64:67], a[112:115]
  v_exp_f32 v60, v60
  v_mfma_f32_16x16x32_bf16 a[112:115], a[188:191], v[96:99], a[112:115]
  v_mfma_f32_16x16x32_bf16 a[116:119], a[188:191], v[104:107], a[116:119]
  v_exp_f32 v61, v61
  v_mfma_f32_16x16x32_bf16 a[116:119], a[184:187], v[72:75], a[116:119]
  v_cvt_pk_bf16_f32 v58, v60, v61
  v_mfma_f32_16x16x32_bf16 a[120:123], a[184:187], v[80:83], a[120:123]
  v_exp_f32 v62, v62
  v_mfma_f32_16x16x32_bf16 a[120:123], a[188:191], v[112:115], a[120:123]
  v_mfma_f32_16x16x32_bf16 a[124:127], a[188:191], v[120:123], a[124:127]
  s_waitcnt lgkmcnt(0)
  v_exp_f32 v63, v63
  v_mfma_f32_16x16x32_bf16 a[124:127], a[184:187], v[88:91], a[124:127]
  v_cvt_pk_bf16_f32 v59, v62, v63
  v_mfma_f32_16x16x32_bf16 v[64:67], a[128:131], v[128:131], v[192:195]
  s_add_u32 m0, s28, 65536
  v_mfma_f32_16x16x32_bf16 v[64:67], a[132:135], v[132:135], v[64:67]
  ds_read_b128 a[144:147], v212 offset:53248
  v_mfma_f32_16x16x32_bf16 v[64:67], a[136:139], v[136:139], v[64:67]
  buffer_load_dwordx4 v236, s[16:19], s29 offen offset:0 lds
  v_mfma_f32_16x16x32_bf16 v[64:67], a[140:143], v[140:143], v[64:67]
  ds_read_b128 a[148:151], v213 offset:53248
  v_mfma_f32_16x16x32_bf16 v[72:75], a[140:143], v[156:159], v[196:199]
  v_mfma_f32_16x16x32_bf16 v[72:75], a[136:139], v[152:155], v[72:75]
  ds_read_b128 a[152:155], v214 offset:53248
  v_mfma_f32_16x16x32_bf16 v[72:75], a[132:135], v[148:151], v[72:75]
  buffer_load_dwordx4 v237, s[16:19], s29 offen offset:1024 lds
  v_mfma_f32_16x16x32_bf16 v[72:75], a[128:131], v[144:147], v[72:75]
  ds_read_b128 a[156:159], v215 offset:53248
  v_mfma_f32_16x16x32_bf16 v[80:83], a[128:131], v[160:163], v[200:203]
  v_exp_f32 v64, v64
  v_mfma_f32_16x16x32_bf16 v[80:83], a[132:135], v[164:167], v[80:83]
  v_mfma_f32_16x16x32_bf16 v[80:83], a[136:139], v[168:171], v[80:83]
  v_exp_f32 v65, v65
  v_mfma_f32_16x16x32_bf16 v[80:83], a[140:143], v[172:175], v[80:83]
  v_cvt_pk_bf16_f32 v64, v64, v65
  v_mfma_f32_16x16x32_bf16 v[88:91], a[140:143], v[188:191], v[204:207]
  v_exp_f32 v66, v66
  v_mfma_f32_16x16x32_bf16 v[88:91], a[136:139], v[184:187], v[88:91]
  buffer_load_dwordx4 v236, s[16:19], s29 offen offset:2048 lds
  v_mfma_f32_16x16x32_bf16 v[88:91], a[132:135], v[180:183], v[88:91]
  s_waitcnt lgkmcnt(0)
  v_exp_f32 v67, v67
  v_mfma_f32_16x16x32_bf16 v[88:91], a[128:131], v[176:179], v[88:91]
  v_cvt_pk_bf16_f32 v65, v66, v67
  v_mfma_f32_16x16x32_bf16 v[68:71], a[144:147], v[128:131], v[192:195]
  v_exp_f32 v72, v72
  v_mfma_f32_16x16x32_bf16 v[68:71], a[148:151], v[132:135], v[68:71]
  ds_read_b128 a[128:131], v212 offset:57344
  v_mfma_f32_16x16x32_bf16 v[68:71], a[152:155], v[136:139], v[68:71]
  v_exp_f32 v73, v73
  v_mfma_f32_16x16x32_bf16 v[68:71], a[156:159], v[140:143], v[68:71]
  ds_read_b128 a[132:135], v213 offset:57344
  v_cvt_pk_bf16_f32 v72, v72, v73
  v_mfma_f32_16x16x32_bf16 v[76:79], a[156:159], v[156:159], v[196:199]
  v_exp_f32 v74, v74
  v_mfma_f32_16x16x32_bf16 v[76:79], a[152:155], v[152:155], v[76:79]
  ds_read_b128 a[136:139], v214 offset:57344
  v_mfma_f32_16x16x32_bf16 v[76:79], a[148:151], v[148:151], v[76:79]
  v_exp_f32 v75, v75
  v_mfma_f32_16x16x32_bf16 v[76:79], a[144:147], v[144:147], v[76:79]
  ds_read_b128 a[140:143], v215 offset:57344
  v_cvt_pk_bf16_f32 v73, v74, v75
  v_mfma_f32_16x16x32_bf16 v[84:87], a[144:147], v[160:163], v[200:203]
  v_exp_f32 v80, v80
  v_mfma_f32_16x16x32_bf16 v[84:87], a[148:151], v[164:167], v[84:87]
  buffer_load_dwordx4 v237, s[16:19], s29 offen offset:3072 lds
  v_mfma_f32_16x16x32_bf16 v[84:87], a[152:155], v[168:171], v[84:87]
  s_add_u32 s29, s29, 16384
  v_exp_f32 v81, v81
  v_mfma_f32_16x16x32_bf16 v[84:87], a[156:159], v[172:175], v[84:87]
  v_cvt_pk_bf16_f32 v80, v80, v81
  v_mfma_f32_16x16x32_bf16 v[92:95], a[156:159], v[188:191], v[204:207]
  s_add_u32 m0, s28, 16384
  v_exp_f32 v82, v82
  v_mfma_f32_16x16x32_bf16 v[92:95], a[152:155], v[184:187], v[92:95]
  buffer_load_dwordx4 v232, s[12:15], s29 offen offset:0 lds
  v_mfma_f32_16x16x32_bf16 v[92:95], a[148:151], v[180:183], v[92:95]
  s_waitcnt lgkmcnt(0)
  v_exp_f32 v83, v83
  v_mfma_f32_16x16x32_bf16 v[92:95], a[144:147], v[176:179], v[92:95]
  v_cvt_pk_bf16_f32 v81, v82, v83
  v_mfma_f32_16x16x32_bf16 v[96:99], a[128:131], v[128:131], v[192:195]
  v_exp_f32 v88, v88
  v_mfma_f32_16x16x32_bf16 v[96:99], a[132:135], v[132:135], v[96:99]
  ds_read_b128 a[144:147], v212 offset:61440
  v_mfma_f32_16x16x32_bf16 v[96:99], a[136:139], v[136:139], v[96:99]
  v_exp_f32 v89, v89
  v_mfma_f32_16x16x32_bf16 v[96:99], a[140:143], v[140:143], v[96:99]
  ds_read_b128 a[148:151], v213 offset:61440
  v_cvt_pk_bf16_f32 v88, v88, v89
  v_mfma_f32_16x16x32_bf16 v[104:107], a[140:143], v[156:159], v[196:199]
  v_exp_f32 v90, v90
  v_mfma_f32_16x16x32_bf16 v[104:107], a[136:139], v[152:155], v[104:107]
  ds_read_b128 a[152:155], v214 offset:61440
  v_mfma_f32_16x16x32_bf16 v[104:107], a[132:135], v[148:151], v[104:107]
  v_exp_f32 v91, v91
  v_mfma_f32_16x16x32_bf16 v[104:107], a[128:131], v[144:147], v[104:107]
  ds_read_b128 a[156:159], v215 offset:61440
  v_cvt_pk_bf16_f32 v89, v90, v91
  v_mfma_f32_16x16x32_bf16 v[112:115], a[128:131], v[160:163], v[200:203]
  v_exp_f32 v68, v68
  v_mfma_f32_16x16x32_bf16 v[112:115], a[132:135], v[164:167], v[112:115]
  buffer_load_dwordx4 v233, s[12:15], s29 offen offset:1024 lds
  v_mfma_f32_16x16x32_bf16 v[112:115], a[136:139], v[168:171], v[112:115]
  v_exp_f32 v69, v69
  v_mfma_f32_16x16x32_bf16 v[112:115], a[140:143], v[172:175], v[112:115]
  v_cvt_pk_bf16_f32 v66, v68, v69
  v_mfma_f32_16x16x32_bf16 v[120:123], a[140:143], v[188:191], v[204:207]
  v_exp_f32 v70, v70
  v_mfma_f32_16x16x32_bf16 v[120:123], a[136:139], v[184:187], v[120:123]
  buffer_load_dwordx4 v234, s[12:15], s29 offen offset:2048 lds
  v_mfma_f32_16x16x32_bf16 v[120:123], a[132:135], v[180:183], v[120:123]
  s_waitcnt lgkmcnt(0)
  v_exp_f32 v71, v71
  v_mfma_f32_16x16x32_bf16 v[120:123], a[128:131], v[176:179], v[120:123]
  v_cvt_pk_bf16_f32 v67, v70, v71
  v_mfma_f32_16x16x32_bf16 v[100:103], a[144:147], v[128:131], v[192:195]
  v_exp_f32 v76, v76
  v_mfma_f32_16x16x32_bf16 v[100:103], a[148:151], v[132:135], v[100:103]
  ds_read_b64_tr_b16 a[160:161], v216 offset:32768
  v_mfma_f32_16x16x32_bf16 v[100:103], a[152:155], v[136:139], v[100:103]
  v_exp_f32 v77, v77
  v_mfma_f32_16x16x32_bf16 v[100:103], a[156:159], v[140:143], v[100:103]
  ds_read_b64_tr_b16 a[162:163], v216 offset:36864
  v_cvt_pk_bf16_f32 v74, v76, v77
  v_mfma_f32_16x16x32_bf16 v[108:111], a[156:159], v[156:159], v[196:199]
  v_exp_f32 v78, v78
  v_mfma_f32_16x16x32_bf16 v[108:111], a[152:155], v[152:155], v[108:111]
  ds_read_b64_tr_b16 a[164:165], v216 offset:40960
  buffer_load_dwordx4 v235, s[12:15], s29 offen offset:3072 lds
  v_mfma_f32_16x16x32_bf16 v[108:111], a[148:151], v[148:151], v[108:111]
  v_exp_f32 v79, v79
  v_mfma_f32_16x16x32_bf16 v[108:111], a[144:147], v[144:147], v[108:111]
  ds_read_b64_tr_b16 a[166:167], v216 offset:45056
  v_cvt_pk_bf16_f32 v75, v78, v79
  v_mfma_f32_16x16x32_bf16 v[116:119], a[144:147], v[160:163], v[200:203]
  v_exp_f32 v84, v84
  v_mfma_f32_16x16x32_bf16 v[116:119], a[148:151], v[164:167], v[116:119]
  ds_read_b64_tr_b16 a[168:169], v217 offset:32768
  buffer_load_dword v254, off, s[24:27], s47 sc1
  v_mfma_f32_16x16x32_bf16 v[116:119], a[152:155], v[168:171], v[116:119]
  v_exp_f32 v85, v85
  v_mfma_f32_16x16x32_bf16 v[116:119], a[156:159], v[172:175], v[116:119]
  ds_read_b64_tr_b16 a[170:171], v217 offset:36864
  v_cvt_pk_bf16_f32 v82, v84, v85
  v_mfma_f32_16x16x32_bf16 v[124:127], a[156:159], v[188:191], v[204:207]
  s_waitcnt vmcnt(20)
  v_exp_f32 v86, v86
  v_mfma_f32_16x16x32_bf16 v[124:127], a[152:155], v[184:187], v[124:127]
  ds_read_b64_tr_b16 a[172:173], v217 offset:40960
  ds_read_b64_tr_b16 a[232:233], v209 offset:5120
  v_mfma_f32_16x16x32_bf16 v[124:127], a[148:151], v[180:183], v[124:127]
  v_exp_f32 v87, v87
  v_mfma_f32_16x16x32_bf16 v[124:127], a[144:147], v[176:179], v[124:127]
  ds_read_b64_tr_b16 a[174:175], v217 offset:45056
  v_cvt_pk_bf16_f32 v83, v86, v87
  v_mfma_f32_16x16x32_bf16 a[192:195], a[208:211], v[0:3], a[192:195]
  v_exp_f32 v92, v92
  v_mfma_f32_16x16x32_bf16 a[192:195], a[208:211], v[32:35], a[192:195]
  ds_read_b64_tr_b16 a[176:177], v218 offset:32768
  ds_read_b64_tr_b16 a[234:235], v209 offset:5632
  v_mfma_f32_16x16x32_bf16 a[196:199], a[208:211], v[8:11], a[196:199]
  v_exp_f32 v93, v93
  v_mfma_f32_16x16x32_bf16 a[196:199], a[208:211], v[40:43], a[196:199]
  ds_read_b64_tr_b16 a[178:179], v218 offset:36864
  v_cvt_pk_bf16_f32 v90, v92, v93
  v_mfma_f32_16x16x32_bf16 a[200:203], a[208:211], v[16:19], a[200:203]
  v_exp_f32 v94, v94
  v_mfma_f32_16x16x32_bf16 a[200:203], a[208:211], v[48:51], a[200:203]
  ds_read_b64_tr_b16 a[180:181], v218 offset:40960
  v_mfma_f32_16x16x32_bf16 a[204:207], a[208:211], v[24:27], a[204:207]
  s_waitcnt lgkmcnt(9)
  v_exp_f32 v95, v95
  v_mfma_f32_16x16x32_bf16 a[204:207], a[208:211], v[56:59], a[204:207]
  ds_read_b64_tr_b16 a[182:183], v218 offset:45056
  v_cvt_pk_bf16_f32 v91, v94, v95
  v_mfma_f32_16x16x32_bf16 a[0:3], a[160:163], v[0:3], a[0:3]
  v_exp_f32 v96, v96
  v_mfma_f32_16x16x32_bf16 a[0:3], a[164:167], v[32:35], a[0:3]
  ds_read_b64_tr_b16 a[184:185], v219 offset:32768
  s_waitcnt lgkmcnt(4)
  buffer_store_dwordx4 a[232:235], v211, s[24:27], s31 offen sc1
  s_add_u32 s31, s31, 1024
  v_mfma_f32_16x16x32_bf16 a[4:7], a[164:167], v[40:43], a[4:7]
  v_exp_f32 v97, v97
  v_mfma_f32_16x16x32_bf16 a[4:7], a[160:163], v[8:11], a[4:7]
  ds_read_b64_tr_b16 a[186:187], v219 offset:36864
  v_cvt_pk_bf16_f32 v96, v96, v97
  v_mfma_f32_16x16x32_bf16 a[8:11], a[160:163], v[16:19], a[8:11]
  v_exp_f32 v98, v98
  v_mfma_f32_16x16x32_bf16 a[8:11], a[164:167], v[48:51], a[8:11]
  ds_read_b64_tr_b16 a[188:189], v219 offset:40960
  v_mfma_f32_16x16x32_bf16 a[12:15], a[164:167], v[56:59], a[12:15]
  v_exp_f32 v99, v99
  v_mfma_f32_16x16x32_bf16 a[12:15], a[160:163], v[24:27], a[12:15]
  ds_read_b64_tr_b16 a[190:191], v219 offset:45056
  v_cvt_pk_bf16_f32 v97, v98, v99
  v_mfma_f32_16x16x32_bf16 a[16:19], a[168:171], v[0:3], a[16:19]
  v_exp_f32 v104, v104
  v_mfma_f32_16x16x32_bf16 a[16:19], a[172:175], v[32:35], a[16:19]
  ds_read_b64_tr_b16 a[160:161], v220 offset:32768
  v_mfma_f32_16x16x32_bf16 a[20:23], a[172:175], v[40:43], a[20:23]
  v_exp_f32 v105, v105
  v_mfma_f32_16x16x32_bf16 a[20:23], a[168:171], v[8:11], a[20:23]
  ds_read_b64_tr_b16 a[162:163], v220 offset:36864
  v_cvt_pk_bf16_f32 v104, v104, v105
  v_mfma_f32_16x16x32_bf16 a[24:27], a[168:171], v[16:19], a[24:27]
  v_exp_f32 v106, v106
  v_mfma_f32_16x16x32_bf16 a[24:27], a[172:175], v[48:51], a[24:27]
  ds_read_b64_tr_b16 a[164:165], v220 offset:40960
  v_mfma_f32_16x16x32_bf16 a[28:31], a[172:175], v[56:59], a[28:31]
  s_waitcnt lgkmcnt(7)
  v_exp_f32 v107, v107
  v_mfma_f32_16x16x32_bf16 a[28:31], a[168:171], v[24:27], a[28:31]
  ds_read_b64_tr_b16 a[166:167], v220 offset:45056
  v_cvt_pk_bf16_f32 v105, v106, v107
  v_mfma_f32_16x16x32_bf16 a[32:35], a[176:179], v[0:3], a[32:35]
  v_exp_f32 v112, v112
  v_mfma_f32_16x16x32_bf16 a[32:35], a[180:183], v[32:35], a[32:35]
  ds_read_b64_tr_b16 a[168:169], v221 offset:32768
  v_mfma_f32_16x16x32_bf16 a[36:39], a[180:183], v[40:43], a[36:39]
  v_exp_f32 v113, v113
  v_mfma_f32_16x16x32_bf16 a[36:39], a[176:179], v[8:11], a[36:39]
  ds_read_b64_tr_b16 a[170:171], v221 offset:36864
  v_cvt_pk_bf16_f32 v112, v112, v113
  v_mfma_f32_16x16x32_bf16 a[40:43], a[176:179], v[16:19], a[40:43]
  v_exp_f32 v114, v114
  v_mfma_f32_16x16x32_bf16 a[40:43], a[180:183], v[48:51], a[40:43]
  ds_read_b64_tr_b16 a[172:173], v221 offset:40960
  v_mfma_f32_16x16x32_bf16 a[44:47], a[180:183], v[56:59], a[44:47]
  s_waitcnt lgkmcnt(7)
  v_exp_f32 v115, v115
  v_mfma_f32_16x16x32_bf16 a[44:47], a[176:179], v[24:27], a[44:47]
  ds_read_b64_tr_b16 a[174:175], v221 offset:45056
  v_cvt_pk_bf16_f32 v113, v114, v115
  v_mfma_f32_16x16x32_bf16 a[48:51], a[184:187], v[0:3], a[48:51]
  v_exp_f32 v120, v120
  v_mfma_f32_16x16x32_bf16 a[48:51], a[188:191], v[32:35], a[48:51]
  ds_read_b64_tr_b16 a[176:177], v222 offset:32768
  v_mfma_f32_16x16x32_bf16 a[52:55], a[188:191], v[40:43], a[52:55]
  v_exp_f32 v121, v121
  v_mfma_f32_16x16x32_bf16 a[52:55], a[184:187], v[8:11], a[52:55]
  ds_read_b64_tr_b16 a[178:179], v222 offset:36864
  v_cvt_pk_bf16_f32 v120, v120, v121
  v_mfma_f32_16x16x32_bf16 a[56:59], a[184:187], v[16:19], a[56:59]
  v_exp_f32 v122, v122
  v_mfma_f32_16x16x32_bf16 a[56:59], a[188:191], v[48:51], a[56:59]
  ds_read_b64_tr_b16 a[180:181], v222 offset:40960
  v_mfma_f32_16x16x32_bf16 a[60:63], a[188:191], v[56:59], a[60:63]
  s_waitcnt lgkmcnt(7)
  v_exp_f32 v123, v123
  v_mfma_f32_16x16x32_bf16 a[60:63], a[184:187], v[24:27], a[60:63]
  ds_read_b64_tr_b16 a[182:183], v222 offset:45056
  v_cvt_pk_bf16_f32 v121, v122, v123
  v_mfma_f32_16x16x32_bf16 a[64:67], a[160:163], v[0:3], a[64:67]
  v_exp_f32 v100, v100
  v_mfma_f32_16x16x32_bf16 a[64:67], a[164:167], v[32:35], a[64:67]
  ds_read_b64_tr_b16 a[184:185], v223 offset:32768
  v_mfma_f32_16x16x32_bf16 a[68:71], a[164:167], v[40:43], a[68:71]
  v_exp_f32 v101, v101
  v_mfma_f32_16x16x32_bf16 a[68:71], a[160:163], v[8:11], a[68:71]
  ds_read_b64_tr_b16 a[186:187], v223 offset:36864
  v_cvt_pk_bf16_f32 v98, v100, v101
  v_mfma_f32_16x16x32_bf16 a[72:75], a[160:163], v[16:19], a[72:75]
  v_exp_f32 v102, v102
  v_mfma_f32_16x16x32_bf16 a[72:75], a[164:167], v[48:51], a[72:75]
  ds_read_b64_tr_b16 a[188:189], v223 offset:40960
  v_mfma_f32_16x16x32_bf16 a[76:79], a[164:167], v[56:59], a[76:79]
  s_waitcnt lgkmcnt(7)
  v_exp_f32 v103, v103
  v_mfma_f32_16x16x32_bf16 a[76:79], a[160:163], v[24:27], a[76:79]
  ds_read_b64_tr_b16 a[190:191], v223 offset:45056
  v_cvt_pk_bf16_f32 v99, v102, v103
  v_mfma_f32_16x16x32_bf16 a[80:83], a[168:171], v[0:3], a[80:83]
  s_waitcnt vmcnt(12)
  v_exp_f32 v108, v108
  v_mfma_f32_16x16x32_bf16 a[80:83], a[172:175], v[32:35], a[80:83]
  v_mfma_f32_16x16x32_bf16 a[84:87], a[172:175], v[40:43], a[84:87]
  s_barrier
  v_exp_f32 v109, v109
  v_mfma_f32_16x16x32_bf16 a[84:87], a[168:171], v[8:11], a[84:87]
  ds_read_b128 a[128:131], v212 offset:0
  v_cvt_pk_bf16_f32 v106, v108, v109
  v_mfma_f32_16x16x32_bf16 a[88:91], a[168:171], v[16:19], a[88:91]
  v_exp_f32 v110, v110
  v_mfma_f32_16x16x32_bf16 a[88:91], a[172:175], v[48:51], a[88:91]
  ds_read_b128 a[132:135], v213 offset:0
  v_mfma_f32_16x16x32_bf16 a[92:95], a[172:175], v[56:59], a[92:95]
  s_waitcnt lgkmcnt(6)
  v_exp_f32 v111, v111
  v_mfma_f32_16x16x32_bf16 a[92:95], a[168:171], v[24:27], a[92:95]
  ds_read_b128 a[136:139], v214 offset:0
  v_cvt_pk_bf16_f32 v107, v110, v111
  v_mfma_f32_16x16x32_bf16 a[96:99], a[176:179], v[0:3], a[96:99]
  v_exp_f32 v116, v116
  v_mfma_f32_16x16x32_bf16 a[96:99], a[180:183], v[32:35], a[96:99]
  ds_read_b128 a[140:143], v215 offset:0
  v_mfma_f32_16x16x32_bf16 a[100:103], a[180:183], v[40:43], a[100:103]
  v_exp_f32 v117, v117
  v_mfma_f32_16x16x32_bf16 a[100:103], a[176:179], v[8:11], a[100:103]
  v_cvt_pk_bf16_f32 v114, v116, v117
  v_mfma_f32_16x16x32_bf16 a[104:107], a[176:179], v[16:19], a[104:107]
  v_exp_f32 v118, v118
  v_mfma_f32_16x16x32_bf16 a[104:107], a[180:183], v[48:51], a[104:107]
  v_mfma_f32_16x16x32_bf16 a[108:111], a[180:183], v[56:59], a[108:111]
  s_waitcnt lgkmcnt(4)
  v_exp_f32 v119, v119
  v_mfma_f32_16x16x32_bf16 a[108:111], a[176:179], v[24:27], a[108:111]
  v_cvt_pk_bf16_f32 v115, v118, v119
  v_mfma_f32_16x16x32_bf16 a[112:115], a[184:187], v[0:3], a[112:115]
  v_exp_f32 v124, v124
  v_mfma_f32_16x16x32_bf16 a[112:115], a[188:191], v[32:35], a[112:115]
  v_mfma_f32_16x16x32_bf16 a[116:119], a[188:191], v[40:43], a[116:119]
  s_sub_u32 s32, s32, 1
  v_exp_f32 v125, v125
  v_mfma_f32_16x16x32_bf16 a[116:119], a[184:187], v[8:11], a[116:119]
  v_cvt_pk_bf16_f32 v122, v124, v125
  v_mfma_f32_16x16x32_bf16 a[120:123], a[184:187], v[16:19], a[120:123]
  s_cmp_lg_u32 s32, 0
  v_exp_f32 v126, v126
  v_mfma_f32_16x16x32_bf16 a[120:123], a[188:191], v[48:51], a[120:123]
  v_mfma_f32_16x16x32_bf16 a[124:127], a[188:191], v[56:59], a[124:127]
  s_waitcnt lgkmcnt(0)
  v_exp_f32 v127, v127
  v_mfma_f32_16x16x32_bf16 a[124:127], a[184:187], v[24:27], a[124:127]
  v_cvt_pk_bf16_f32 v123, v126, v127
  s_cbranch_scc1 attn_loop
  s_waitcnt vmcnt(1)
  v_readfirstlane_b32 s38, v254
  s_nop 0
  s_cmp_ge_u32 s38, 512
  s_cbranch_scc1 attn_h_ready
  s_mov_b32 s39, 32768
attn_spin:
  s_sleep 4
  buffer_load_dword v254, off, s[24:27], s47 sc1
  s_waitcnt vmcnt(0)
  v_readfirstlane_b32 s38, v254
  s_nop 0
  s_cmp_ge_u32 s38, 512
  s_cbranch_scc1 attn_h_ready
  s_sub_u32 s39, s39, 1
  s_cmp_lg_u32 s39, 0
  s_cbranch_scc1 attn_spin
attn_h_ready:
  v_mfma_f32_16x16x32_bf16 v[0:3], a[128:131], v[128:131], v[192:195]
  s_add_u32 m0, s28, 81920
  s_and_b32 s38, s2, 1
  s_lshl_b32 s38, s38, 2
  v_lshrrev_b32 v224, 4, v242
  v_and_b32 v225, 7, v224
  v_mfma_f32_16x16x32_bf16 v[0:3], a[132:135], v[132:135], v[0:3]
  ds_read_b128 a[144:147], v212 offset:4096
  s_add_u32 s38, s38, s3
  s_mul_i32 s38, s38, 81920
  s_lshr_b32 s39, s2, 5
  v_mul_u32_u24 v225, 0xd80, v225
  v_mfma_f32_16x16x32_bf16 v[0:3], a[136:139], v[136:139], v[0:3]
  buffer_load_dwordx4 v236, s[16:19], s29 offen offset:0 lds
  s_mul_i32 s39, s39, 655360
  s_add_u32 s38, s38, s39
  s_add_u32 s4, s38, 3145728
  v_mfma_f32_16x16x32_bf16 v[0:3], a[140:143], v[140:143], v[0:3]
  ds_read_b128 a[148:151], v213 offset:4096
  s_add_u32 s5, s4, 12288
  s_add_u32 s6, s4, 24576
  s_add_u32 s7, s4, 36864
  v_lshrrev_b32 v224, 4, v224
  v_mfma_f32_16x16x32_bf16 v[8:11], a[140:143], v[156:159], v[196:199]
  s_add_u32 s8, s4, 49152
  s_add_u32 s9, s4, 61440
  s_add_u32 s10, s4, 73728
  v_lshl_add_u32 v225, v224, 4, v225
  v_add_u32 v252, 4096, v242
  v_mfma_f32_16x16x32_bf16 v[8:11], a[136:139], v[152:155], v[8:11]
  ds_read_b128 a[152:155], v214 offset:4096
  buffer_load_dwordx4 a[212:215], v225, s[24:27], s101 offen offset:0 sc1
  v_mfma_f32_16x16x32_bf16 v[8:11], a[132:135], v[148:151], v[8:11]
  buffer_load_dwordx4 v237, s[16:19], s29 offen offset:1024 lds
  v_mfma_f32_16x16x32_bf16 v[8:11], a[128:131], v[144:147], v[8:11]
  ds_read_b128 a[156:159], v215 offset:4096
  buffer_load_dwordx4 a[216:219], v225, s[24:27], s101 offen offset:64 sc1
  v_mfma_f32_16x16x32_bf16 v[16:19], a[128:131], v[160:163], v[200:203]
  v_exp_f32 v0, v0
  v_mfma_f32_16x16x32_bf16 v[16:19], a[132:135], v[164:167], v[16:19]
  buffer_load_dwordx4 a[220:223], v225, s[24:27], s101 offen offset:128 sc1
  v_mfma_f32_16x16x32_bf16 v[16:19], a[136:139], v[168:171], v[16:19]
  v_exp_f32 v1, v1
  v_mfma_f32_16x16x32_bf16 v[16:19], a[140:143], v[172:175], v[16:19]
  v_cvt_pk_bf16_f32 v0, v0, v1
  v_add_u32 v253, 8192, v242
  v_mfma_f32_16x16x32_bf16 v[24:27], a[140:143], v[188:191], v[204:207]
  v_exp_f32 v2, v2
  v_mfma_f32_16x16x32_bf16 v[24:27], a[136:139], v[184:187], v[24:27]
  buffer_load_dwordx4 v236, s[16:19], s29 offen offset:2048 lds
  v_mfma_f32_16x16x32_bf16 v[24:27], a[132:135], v[180:183], v[24:27]
  s_waitcnt lgkmcnt(0)
  v_exp_f32 v3, v3
  v_mfma_f32_16x16x32_bf16 v[24:27], a[128:131], v[176:179], v[24:27]
  v_cvt_pk_bf16_f32 v1, v2, v3
  v_mfma_f32_16x16x32_bf16 v[4:7], a[144:147], v[128:131], v[192:195]
  v_exp_f32 v8, v8
  v_mfma_f32_16x16x32_bf16 v[4:7], a[148:151], v[132:135], v[4:7]
  ds_read_b128 a[128:131], v212 offset:8192
  v_mfma_f32_16x16x32_bf16 v[4:7], a[152:155], v[136:139], v[4:7]
  v_exp_f32 v9, v9
  v_mfma_f32_16x16x32_bf16 v[4:7], a[156:159], v[140:143], v[4:7]
  ds_read_b128 a[132:135], v213 offset:8192
  v_cvt_pk_bf16_f32 v8, v8, v9
  v_mfma_f32_16x16x32_bf16 v[12:15], a[156:159], v[156:159], v[196:199]
  v_exp_f32 v10, v10
  v_mfma_f32_16x16x32_bf16 v[12:15], a[152:155], v[152:155], v[12:15]
  ds_read_b128 a[136:139], v214 offset:8192
  v_mfma_f32_16x16x32_bf16 v[12:15], a[148:151], v[148:151], v[12:15]
  v_exp_f32 v11, v11
  v_mfma_f32_16x16x32_bf16 v[12:15], a[144:147], v[144:147], v[12:15]
  ds_read_b128 a[140:143], v215 offset:8192
  v_cvt_pk_bf16_f32 v9, v10, v11
  v_mfma_f32_16x16x32_bf16 v[20:23], a[144:147], v[160:163], v[200:203]
  v_exp_f32 v16, v16
  v_mfma_f32_16x16x32_bf16 v[20:23], a[148:151], v[164:167], v[20:23]
  buffer_load_dwordx4 v237, s[16:19], s29 offen offset:3072 lds
  v_mfma_f32_16x16x32_bf16 v[20:23], a[152:155], v[168:171], v[20:23]
  s_add_u32 s29, s29, 16384
  v_exp_f32 v17, v17
  v_mfma_f32_16x16x32_bf16 v[20:23], a[156:159], v[172:175], v[20:23]
  v_cvt_pk_bf16_f32 v16, v16, v17
  v_mfma_f32_16x16x32_bf16 v[28:31], a[156:159], v[188:191], v[204:207]
  s_add_u32 m0, s28, 32768
  v_exp_f32 v18, v18
  v_mfma_f32_16x16x32_bf16 v[28:31], a[152:155], v[184:187], v[28:31]
  buffer_load_dwordx4 v232, s[12:15], s29 offen offset:0 lds
  v_mfma_f32_16x16x32_bf16 v[28:31], a[148:151], v[180:183], v[28:31]
  s_waitcnt lgkmcnt(0)
  v_exp_f32 v19, v19
  v_mfma_f32_16x16x32_bf16 v[28:31], a[144:147], v[176:179], v[28:31]
  v_cvt_pk_bf16_f32 v17, v18, v19
  v_mfma_f32_16x16x32_bf16 v[32:35], a[128:131], v[128:131], v[192:195]
  v_exp_f32 v24, v24
  v_mfma_f32_16x16x32_bf16 v[32:35], a[132:135], v[132:135], v[32:35]
  ds_read_b128 a[144:147], v212 offset:12288
  v_mfma_f32_16x16x32_bf16 v[32:35], a[136:139], v[136:139], v[32:35]
  v_exp_f32 v25, v25
  v_mfma_f32_16x16x32_bf16 v[32:35], a[140:143], v[140:143], v[32:35]
  ds_read_b128 a[148:151], v213 offset:12288
  v_cvt_pk_bf16_f32 v24, v24, v25
  v_mfma_f32_16x16x32_bf16 v[40:43], a[140:143], v[156:159], v[196:199]
  v_exp_f32 v26, v26
  v_mfma_f32_16x16x32_bf16 v[40:43], a[136:139], v[152:155], v[40:43]
  ds_read_b128 a[152:155], v214 offset:12288
  v_mfma_f32_16x16x32_bf16 v[40:43], a[132:135], v[148:151], v[40:43]
  v_exp_f32 v27, v27
  v_mfma_f32_16x16x32_bf16 v[40:43], a[128:131], v[144:147], v[40:43]
  ds_read_b128 a[156:159], v215 offset:12288
  v_cvt_pk_bf16_f32 v25, v26, v27
  v_mfma_f32_16x16x32_bf16 v[48:51], a[128:131], v[160:163], v[200:203]
  v_exp_f32 v4, v4
  v_mfma_f32_16x16x32_bf16 v[48:51], a[132:135], v[164:167], v[48:51]
  buffer_load_dwordx4 v233, s[12:15], s29 offen offset:1024 lds
  v_mfma_f32_16x16x32_bf16 v[48:51], a[136:139], v[168:171], v[48:51]
  v_exp_f32 v5, v5
  v_mfma_f32_16x16x32_bf16 v[48:51], a[140:143], v[172:175], v[48:51]
  v_cvt_pk_bf16_f32 v2, v4, v5
  v_mfma_f32_16x16x32_bf16 v[56:59], a[140:143], v[188:191], v[204:207]
  v_exp_f32 v6, v6
  v_mfma_f32_16x16x32_bf16 v[56:59], a[136:139], v[184:187], v[56:59]
  buffer_load_dwordx4 v234, s[12:15], s29 offen offset:2048 lds
  v_mfma_f32_16x16x32_bf16 v[56:59], a[132:135], v[180:183], v[56:59]
  s_waitcnt lgkmcnt(0)
  v_exp_f32 v7, v7
  v_mfma_f32_16x16x32_bf16 v[56:59], a[128:131], v[176:179], v[56:59]
  v_cvt_pk_bf16_f32 v3, v6, v7
  v_mfma_f32_16x16x32_bf16 v[36:39], a[144:147], v[128:131], v[192:195]
  v_exp_f32 v12, v12
  v_mfma_f32_16x16x32_bf16 v[36:39], a[148:151], v[132:135], v[36:39]
  ds_read_b64_tr_b16 a[160:161], v216 offset:49152
  v_mfma_f32_16x16x32_bf16 v[36:39], a[152:155], v[136:139], v[36:39]
  v_exp_f32 v13, v13
  v_mfma_f32_16x16x32_bf16 v[36:39], a[156:159], v[140:143], v[36:39]
  ds_read_b64_tr_b16 a[162:163], v216 offset:53248
  v_cvt_pk_bf16_f32 v10, v12, v13
  v_mfma_f32_16x16x32_bf16 v[44:47], a[156:159], v[156:159], v[196:199]
  v_exp_f32 v14, v14
  v_mfma_f32_16x16x32_bf16 v[44:47], a[152:155], v[152:155], v[44:47]
  ds_read_b64_tr_b16 a[164:165], v216 offset:57344
  buffer_load_dwordx4 v235, s[12:15], s29 offen offset:3072 lds
  v_mfma_f32_16x16x32_bf16 v[44:47], a[148:151], v[148:151], v[44:47]
  v_exp_f32 v15, v15
  v_mfma_f32_16x16x32_bf16 v[44:47], a[144:147], v[144:147], v[44:47]
  ds_read_b64_tr_b16 a[166:167], v216 offset:61440
  v_cvt_pk_bf16_f32 v11, v14, v15
  v_mfma_f32_16x16x32_bf16 v[52:55], a[144:147], v[160:163], v[200:203]
  v_exp_f32 v20, v20
  v_mfma_f32_16x16x32_bf16 v[52:55], a[148:151], v[164:167], v[52:55]
  ds_read_b64_tr_b16 a[168:169], v217 offset:49152
  v_mfma_f32_16x16x32_bf16 v[52:55], a[152:155], v[168:171], v[52:55]
  v_exp_f32 v21, v21
  v_mfma_f32_16x16x32_bf16 v[52:55], a[156:159], v[172:175], v[52:55]
  ds_read_b64_tr_b16 a[170:171], v217 offset:53248
  v_cvt_pk_bf16_f32 v18, v20, v21
  v_mfma_f32_16x16x32_bf16 v[60:63], a[156:159], v[188:191], v[204:207]
  v_exp_f32 v22, v22
  v_mfma_f32_16x16x32_bf16 v[60:63], a[152:155], v[184:187], v[60:63]
  ds_read_b64_tr_b16 a[172:173], v217 offset:57344
  v_mfma_f32_16x16x32_bf16 v[60:63], a[148:151], v[180:183], v[60:63]
  v_exp_f32 v23, v23
  v_mfma_f32_16x16x32_bf16 v[60:63], a[144:147], v[176:179], v[60:63]
  ds_read_b64_tr_b16 a[174:175], v217 offset:61440
  v_cvt_pk_bf16_f32 v19, v22, v23
  v_mfma_f32_16x16x32_bf16 a[192:195], a[208:211], v[64:67], a[192:195]
  v_exp_f32 v28, v28
  v_mfma_f32_16x16x32_bf16 a[192:195], a[208:211], v[96:99], a[192:195]
  ds_read_b64_tr_b16 a[176:177], v218 offset:49152
  v_mfma_f32_16x16x32_bf16 a[196:199], a[208:211], v[72:75], a[196:199]
  v_exp_f32 v29, v29
  v_mfma_f32_16x16x32_bf16 a[196:199], a[208:211], v[104:107], a[196:199]
  ds_read_b64_tr_b16 a[178:179], v218 offset:53248
  v_cvt_pk_bf16_f32 v26, v28, v29
  v_mfma_f32_16x16x32_bf16 a[200:203], a[208:211], v[80:83], a[200:203]
  v_exp_f32 v30, v30
  v_mfma_f32_16x16x32_bf16 a[200:203], a[208:211], v[112:115], a[200:203]
  ds_read_b64_tr_b16 a[180:181], v218 offset:57344
  v_mfma_f32_16x16x32_bf16 a[204:207], a[208:211], v[88:91], a[204:207]
  s_waitcnt lgkmcnt(7)
  v_exp_f32 v31, v31
  v_mfma_f32_16x16x32_bf16 a[204:207], a[208:211], v[120:123], a[204:207]
  ds_read_b64_tr_b16 a[182:183], v218 offset:61440
  v_cvt_pk_bf16_f32 v27, v30, v31
  v_mfma_f32_16x16x32_bf16 a[0:3], a[160:163], v[64:67], a[0:3]
  v_exp_f32 v32, v32
  v_mfma_f32_16x16x32_bf16 a[0:3], a[164:167], v[96:99], a[0:3]
  ds_read_b64_tr_b16 a[184:185], v219 offset:49152
  v_mfma_f32_16x16x32_bf16 a[4:7], a[164:167], v[104:107], a[4:7]
  v_exp_f32 v33, v33
  v_mfma_f32_16x16x32_bf16 a[4:7], a[160:163], v[72:75], a[4:7]
  ds_read_b64_tr_b16 a[186:187], v219 offset:53248
  v_cvt_pk_bf16_f32 v32, v32, v33
  v_mfma_f32_16x16x32_bf16 a[8:11], a[160:163], v[80:83], a[8:11]
  v_exp_f32 v34, v34
  v_mfma_f32_16x16x32_bf16 a[8:11], a[164:167], v[112:115], a[8:11]
  ds_read_b64_tr_b16 a[188:189], v219 offset:57344
  v_mfma_f32_16x16x32_bf16 a[12:15], a[164:167], v[120:123], a[12:15]
  s_waitcnt lgkmcnt(7)
  v_exp_f32 v35, v35
  v_mfma_f32_16x16x32_bf16 a[12:15], a[160:163], v[88:91], a[12:15]
  ds_read_b64_tr_b16 a[190:191], v219 offset:61440
  v_cvt_pk_bf16_f32 v33, v34, v35
  v_mfma_f32_16x16x32_bf16 a[16:19], a[168:171], v[64:67], a[16:19]
  v_exp_f32 v40, v40
  v_mfma_f32_16x16x32_bf16 a[16:19], a[172:175], v[96:99], a[16:19]
  ds_read_b64_tr_b16 a[160:161], v220 offset:49152
  v_mfma_f32_16x16x32_bf16 a[20:23], a[172:175], v[104:107], a[20:23]
  v_exp_f32 v41, v41
  v_mfma_f32_16x16x32_bf16 a[20:23], a[168:171], v[72:75], a[20:23]
  ds_read_b64_tr_b16 a[162:163], v220 offset:53248
  v_cvt_pk_bf16_f32 v40, v40, v41
  v_mfma_f32_16x16x32_bf16 a[24:27], a[168:171], v[80:83], a[24:27]
  v_exp_f32 v42, v42
  v_mfma_f32_16x16x32_bf16 a[24:27], a[172:175], v[112:115], a[24:27]
  ds_read_b64_tr_b16 a[164:165], v220 offset:57344
  v_mfma_f32_16x16x32_bf16 a[28:31], a[172:175], v[120:123], a[28:31]
  s_waitcnt lgkmcnt(7)
  v_exp_f32 v43, v43
  v_mfma_f32_16x16x32_bf16 a[28:31], a[168:171], v[88:91], a[28:31]
  ds_read_b64_tr_b16 a[166:167], v220 offset:61440
  v_cvt_pk_bf16_f32 v41, v42, v43
  v_mfma_f32_16x16x32_bf16 a[32:35], a[176:179], v[64:67], a[32:35]
  v_exp_f32 v48, v48
  v_mfma_f32_16x16x32_bf16 a[32:35], a[180:183], v[96:99], a[32:35]
  ds_read_b64_tr_b16 a[168:169], v221 offset:49152
  v_mfma_f32_16x16x32_bf16 a[36:39], a[180:183], v[104:107], a[36:39]
  v_exp_f32 v49, v49
  v_mfma_f32_16x16x32_bf16 a[36:39], a[176:179], v[72:75], a[36:39]
  ds_read_b64_tr_b16 a[170:171], v221 offset:53248
  v_cvt_pk_bf16_f32 v48, v48, v49
  v_mfma_f32_16x16x32_bf16 a[40:43], a[176:179], v[80:83], a[40:43]
  v_exp_f32 v50, v50
  v_mfma_f32_16x16x32_bf16 a[40:43], a[180:183], v[112:115], a[40:43]
  ds_read_b64_tr_b16 a[172:173], v221 offset:57344
  v_mfma_f32_16x16x32_bf16 a[44:47], a[180:183], v[120:123], a[44:47]
  s_waitcnt lgkmcnt(7)
  v_exp_f32 v51, v51
  v_mfma_f32_16x16x32_bf16 a[44:47], a[176:179], v[88:91], a[44:47]
  ds_read_b64_tr_b16 a[174:175], v221 offset:61440
  v_cvt_pk_bf16_f32 v49, v50, v51
  v_mfma_f32_16x16x32_bf16 a[48:51], a[184:187], v[64:67], a[48:51]
  v_exp_f32 v56, v56
  v_mfma_f32_16x16x32_bf16 a[48:51], a[188:191], v[96:99], a[48:51]
  ds_read_b64_tr_b16 a[176:177], v222 offset:49152
  v_mfma_f32_16x16x32_bf16 a[52:55], a[188:191], v[104:107], a[52:55]
  v_exp_f32 v57, v57
  v_mfma_f32_16x16x32_bf16 a[52:55], a[184:187], v[72:75], a[52:55]
  ds_read_b64_tr_b16 a[178:179], v222 offset:53248
  v_cvt_pk_bf16_f32 v56, v56, v57
  v_mfma_f32_16x16x32_bf16 a[56:59], a[184:187], v[80:83], a[56:59]
  v_exp_f32 v58, v58
  v_mfma_f32_16x16x32_bf16 a[56:59], a[188:191], v[112:115], a[56:59]
  ds_read_b64_tr_b16 a[180:181], v222 offset:57344
  v_mfma_f32_16x16x32_bf16 a[60:63], a[188:191], v[120:123], a[60:63]
  s_waitcnt lgkmcnt(7)
  v_exp_f32 v59, v59
  v_mfma_f32_16x16x32_bf16 a[60:63], a[184:187], v[88:91], a[60:63]
  ds_read_b64_tr_b16 a[182:183], v222 offset:61440
  v_cvt_pk_bf16_f32 v57, v58, v59
  v_mfma_f32_16x16x32_bf16 a[64:67], a[160:163], v[64:67], a[64:67]
  v_exp_f32 v36, v36
  v_mfma_f32_16x16x32_bf16 a[64:67], a[164:167], v[96:99], a[64:67]
  ds_read_b64_tr_b16 a[184:185], v223 offset:49152
  v_mfma_f32_16x16x32_bf16 a[68:71], a[164:167], v[104:107], a[68:71]
  v_exp_f32 v37, v37
  v_mfma_f32_16x16x32_bf16 a[68:71], a[160:163], v[72:75], a[68:71]
  ds_read_b64_tr_b16 a[186:187], v223 offset:53248
  v_cvt_pk_bf16_f32 v34, v36, v37
  v_mfma_f32_16x16x32_bf16 a[72:75], a[160:163], v[80:83], a[72:75]
  v_exp_f32 v38, v38
  v_mfma_f32_16x16x32_bf16 a[72:75], a[164:167], v[112:115], a[72:75]
  ds_read_b64_tr_b16 a[188:189], v223 offset:57344
  v_mfma_f32_16x16x32_bf16 a[76:79], a[164:167], v[120:123], a[76:79]
  s_waitcnt lgkmcnt(7)
  v_exp_f32 v39, v39
  v_mfma_f32_16x16x32_bf16 a[76:79], a[160:163], v[88:91], a[76:79]
  ds_read_b64_tr_b16 a[190:191], v223 offset:61440
  v_cvt_pk_bf16_f32 v35, v38, v39
  v_mfma_f32_16x16x32_bf16 a[80:83], a[168:171], v[64:67], a[80:83]
  v_exp_f32 v44, v44
  v_mfma_f32_16x16x32_bf16 a[80:83], a[172:175], v[96:99], a[80:83]
  v_mfma_f32_16x16x32_bf16 a[84:87], a[172:175], v[104:107], a[84:87]
  s_barrier
  v_exp_f32 v45, v45
  v_mfma_f32_16x16x32_bf16 a[84:87], a[168:171], v[72:75], a[84:87]
  ds_read_b128 a[128:131], v212 offset:16384
  v_cvt_pk_bf16_f32 v42, v44, v45
  v_mfma_f32_16x16x32_bf16 a[88:91], a[168:171], v[80:83], a[88:91]
  v_exp_f32 v46, v46
  v_mfma_f32_16x16x32_bf16 a[88:91], a[172:175], v[112:115], a[88:91]
  ds_read_b128 a[132:135], v213 offset:16384
  v_mfma_f32_16x16x32_bf16 a[92:95], a[172:175], v[120:123], a[92:95]
  s_waitcnt lgkmcnt(6)
  v_exp_f32 v47, v47
  v_mfma_f32_16x16x32_bf16 a[92:95], a[168:171], v[88:91], a[92:95]
  ds_read_b128 a[136:139], v214 offset:16384
  v_cvt_pk_bf16_f32 v43, v46, v47
  v_mfma_f32_16x16x32_bf16 a[96:99], a[176:179], v[64:67], a[96:99]
  v_exp_f32 v52, v52
  v_mfma_f32_16x16x32_bf16 a[96:99], a[180:183], v[96:99], a[96:99]
  ds_read_b128 a[140:143], v215 offset:16384
  v_mfma_f32_16x16x32_bf16 a[100:103], a[180:183], v[104:107], a[100:103]
  v_exp_f32 v53, v53
  v_mfma_f32_16x16x32_bf16 a[100:103], a[176:179], v[72:75], a[100:103]
  v_cvt_pk_bf16_f32 v50, v52, v53
  v_mfma_f32_16x16x32_bf16 a[104:107], a[176:179], v[80:83], a[104:107]
  v_exp_f32 v54, v54
  v_mfma_f32_16x16x32_bf16 a[104:107], a[180:183], v[112:115], a[104:107]
  v_mfma_f32_16x16x32_bf16 a[108:111], a[180:183], v[120:123], a[108:111]
  s_waitcnt lgkmcnt(4)
  v_exp_f32 v55, v55
  v_mfma_f32_16x16x32_bf16 a[108:111], a[176:179], v[88:91], a[108:111]
  v_cvt_pk_bf16_f32 v51, v54, v55
  v_mfma_f32_16x16x32_bf16 a[112:115], a[184:187], v[64:67], a[112:115]
  v_exp_f32 v60, v60
  v_mfma_f32_16x16x32_bf16 a[112:115], a[188:191], v[96:99], a[112:115]
  v_mfma_f32_16x16x32_bf16 a[116:119], a[188:191], v[104:107], a[116:119]
  v_exp_f32 v61, v61
  v_mfma_f32_16x16x32_bf16 a[116:119], a[184:187], v[72:75], a[116:119]
  v_cvt_pk_bf16_f32 v58, v60, v61
  v_mfma_f32_16x16x32_bf16 a[120:123], a[184:187], v[80:83], a[120:123]
  v_exp_f32 v62, v62
  v_mfma_f32_16x16x32_bf16 a[120:123], a[188:191], v[112:115], a[120:123]
  v_mfma_f32_16x16x32_bf16 a[124:127], a[188:191], v[120:123], a[124:127]
  s_waitcnt lgkmcnt(0)
  v_exp_f32 v63, v63
  v_mfma_f32_16x16x32_bf16 a[124:127], a[184:187], v[88:91], a[124:127]
  v_cvt_pk_bf16_f32 v59, v62, v63
  v_mfma_f32_16x16x32_bf16 v[64:67], a[128:131], v[128:131], v[192:195]
  s_add_u32 m0, s28, 98304
  v_mfma_f32_16x16x32_bf16 v[64:67], a[132:135], v[132:135], v[64:67]
  ds_read_b128 a[144:147], v212 offset:20480
  v_mfma_f32_16x16x32_bf16 v[64:67], a[136:139], v[136:139], v[64:67]
  buffer_load_dwordx4 v236, s[16:19], s29 offen offset:0 lds
  v_mfma_f32_16x16x32_bf16 v[64:67], a[140:143], v[140:143], v[64:67]
  ds_read_b128 a[148:151], v213 offset:20480
  v_mfma_f32_16x16x32_bf16 v[72:75], a[140:143], v[156:159], v[196:199]
  v_mfma_f32_16x16x32_bf16 v[72:75], a[136:139], v[152:155], v[72:75]
  ds_read_b128 a[152:155], v214 offset:20480
  v_mfma_f32_16x16x32_bf16 v[72:75], a[132:135], v[148:151], v[72:75]
  buffer_load_dwordx4 v237, s[16:19], s29 offen offset:1024 lds
  v_mfma_f32_16x16x32_bf16 v[72:75], a[128:131], v[144:147], v[72:75]
  ds_read_b128 a[156:159], v215 offset:20480
  v_mfma_f32_16x16x32_bf16 v[80:83], a[128:131], v[160:163], v[200:203]
  v_exp_f32 v64, v64
  v_mfma_f32_16x16x32_bf16 v[80:83], a[132:135], v[164:167], v[80:83]
  v_mfma_f32_16x16x32_bf16 v[80:83], a[136:139], v[168:171], v[80:83]
  v_exp_f32 v65, v65
  v_mfma_f32_16x16x32_bf16 v[80:83], a[140:143], v[172:175], v[80:83]
  v_cvt_pk_bf16_f32 v64, v64, v65
  v_mfma_f32_16x16x32_bf16 v[88:91], a[140:143], v[188:191], v[204:207]
  v_exp_f32 v66, v66
  v_mfma_f32_16x16x32_bf16 v[88:91], a[136:139], v[184:187], v[88:91]
  buffer_load_dwordx4 v236, s[16:19], s29 offen offset:2048 lds
  v_mfma_f32_16x16x32_bf16 v[88:91], a[132:135], v[180:183], v[88:91]
  s_waitcnt lgkmcnt(0)
  v_exp_f32 v67, v67
  v_mfma_f32_16x16x32_bf16 v[88:91], a[128:131], v[176:179], v[88:91]
  v_cvt_pk_bf16_f32 v65, v66, v67
  v_mfma_f32_16x16x32_bf16 v[68:71], a[144:147], v[128:131], v[192:195]
  v_exp_f32 v72, v72
  v_mfma_f32_16x16x32_bf16 v[68:71], a[148:151], v[132:135], v[68:71]
  ds_read_b128 a[128:131], v212 offset:24576
  v_mfma_f32_16x16x32_bf16 v[68:71], a[152:155], v[136:139], v[68:71]
  v_exp_f32 v73, v73
  v_mfma_f32_16x16x32_bf16 v[68:71], a[156:159], v[140:143], v[68:71]
  ds_read_b128 a[132:135], v213 offset:24576
  v_cvt_pk_bf16_f32 v72, v72, v73
  v_mfma_f32_16x16x32_bf16 v[76:79], a[156:159], v[156:159], v[196:199]
  v_exp_f32 v74, v74
  v_mfma_f32_16x16x32_bf16 v[76:79], a[152:155], v[152:155], v[76:79]
  ds_read_b128 a[136:139], v214 offset:24576
  v_lshrrev_b32 v224, 4, v242
  v_mfma_f32_16x16x32_bf16 v[76:79], a[148:151], v[148:151], v[76:79]
  v_exp_f32 v75, v75
  v_mfma_f32_16x16x32_bf16 v[76:79], a[144:147], v[144:147], v[76:79]
  ds_read_b128 a[140:143], v215 offset:24576
  v_cvt_pk_bf16_f32 v73, v74, v75
  v_mfma_f32_16x16x32_bf16 v[84:87], a[144:147], v[160:163], v[200:203]
  v_exp_f32 v80, v80
  v_mfma_f32_16x16x32_bf16 v[84:87], a[148:151], v[164:167], v[84:87]
  buffer_load_dwordx4 v237, s[16:19], s29 offen offset:3072 lds
  v_mfma_f32_16x16x32_bf16 v[84:87], a[152:155], v[168:171], v[84:87]
  s_add_u32 s29, s29, 16384
  v_exp_f32 v81, v81
  v_mfma_f32_16x16x32_bf16 v[84:87], a[156:159], v[172:175], v[84:87]
  v_cvt_pk_bf16_f32 v80, v80, v81
  v_lshrrev_b32 v225, 4, v224
  v_mfma_f32_16x16x32_bf16 v[92:95], a[156:159], v[188:191], v[204:207]
  s_add_u32 m0, s28, 49152
  v_exp_f32 v82, v82
  v_mfma_f32_16x16x32_bf16 v[92:95], a[152:155], v[184:187], v[92:95]
  buffer_load_dwordx4 v232, s[12:15], s29 offen offset:0 lds
  v_mfma_f32_16x16x32_bf16 v[92:95], a[148:151], v[180:183], v[92:95]
  s_waitcnt lgkmcnt(0)
  v_exp_f32 v83, v83
  v_mfma_f32_16x16x32_bf16 v[92:95], a[144:147], v[176:179], v[92:95]
  v_cvt_pk_bf16_f32 v81, v82, v83
  v_bfe_u32 v226, v224, 2, 2
  v_mfma_f32_16x16x32_bf16 v[96:99], a[128:131], v[128:131], v[192:195]
  v_exp_f32 v88, v88
  v_mfma_f32_16x16x32_bf16 v[96:99], a[132:135], v[132:135], v[96:99]
  ds_read_b128 a[144:147], v212 offset:28672
  v_lshl_add_u32 v225, v225, 3, v226
  v_mfma_f32_16x16x32_bf16 v[96:99], a[136:139], v[136:139], v[96:99]
  v_exp_f32 v89, v89
  v_mfma_f32_16x16x32_bf16 v[96:99], a[140:143], v[140:143], v[96:99]
  ds_read_b128 a[148:151], v213 offset:28672
  v_cvt_pk_bf16_f32 v88, v88, v89
  v_mfma_f32_16x16x32_bf16 v[104:107], a[140:143], v[156:159], v[196:199]
  v_exp_f32 v90, v90
  v_mfma_f32_16x16x32_bf16 v[104:107], a[136:139], v[152:155], v[104:107]
  ds_read_b128 a[152:155], v214 offset:28672
  v_lshlrev_b32 v225, 5, v225
  v_mfma_f32_16x16x32_bf16 v[104:107], a[132:135], v[148:151], v[104:107]
  v_exp_f32 v91, v91
  v_mfma_f32_16x16x32_bf16 v[104:107], a[128:131], v[144:147], v[104:107]
  ds_read_b128 a[156:159], v215 offset:28672
  v_cvt_pk_bf16_f32 v89, v90, v91
  v_mfma_f32_16x16x32_bf16 v[112:115], a[128:131], v[160:163], v[200:203]
  v_exp_f32 v68, v68
  v_mfma_f32_16x16x32_bf16 v[112:115], a[132:135], v[164:167], v[112:115]
  buffer_load_dwordx4 v233, s[12:15], s29 offen offset:1024 lds
  v_mfma_f32_16x16x32_bf16 v[112:115], a[136:139], v[168:171], v[112:115]
  v_exp_f32 v69, v69
  v_mfma_f32_16x16x32_bf16 v[112:115], a[140:143], v[172:175], v[112:115]
  v_cvt_pk_bf16_f32 v66, v68, v69
  v_and_b32 v226, 3, v224
  v_mfma_f32_16x16x32_bf16 v[120:123], a[140:143], v[188:191], v[204:207]
  v_exp_f32 v70, v70
  v_mfma_f32_16x16x32_bf16 v[120:123], a[136:139], v[184:187], v[120:123]
  buffer_load_dwordx4 v234, s[12:15], s29 offen offset:2048 lds
  v_mfma_f32_16x16x32_bf16 v[120:123], a[132:135], v[180:183], v[120:123]
  s_waitcnt lgkmcnt(0)
  v_exp_f32 v71, v71
  v_mfma_f32_16x16x32_bf16 v[120:123], a[128:131], v[176:179], v[120:123]
  v_cvt_pk_bf16_f32 v67, v70, v71
  v_lshl_add_u32 v225, v226, 3, v225
  v_mfma_f32_16x16x32_bf16 v[100:103], a[144:147], v[128:131], v[192:195]
  v_exp_f32 v76, v76
  v_mfma_f32_16x16x32_bf16 v[100:103], a[148:151], v[132:135], v[100:103]
  ds_read_b64_tr_b16 a[160:161], v216 offset:0
  v_add_u32 v225, s50, v225
  v_mfma_f32_16x16x32_bf16 v[100:103], a[152:155], v[136:139], v[100:103]
  s_waitcnt vmcnt(13)
  v_exp_f32 v77, v77
  v_mfma_f32_16x16x32_bf16 v[100:103], a[156:159], v[140:143], v[100:103]
  ds_read_b64_tr_b16 a[162:163], v216 offset:4096
  v_cvt_pk_bf16_f32 v74, v76, v77
  v_mfma_f32_16x16x32_bf16 v[108:111], a[156:159], v[156:159], v[196:199]
  v_exp_f32 v78, v78
  v_mfma_f32_16x16x32_bf16 v[108:111], a[152:155], v[152:155], v[108:111]
  ds_read_b64_tr_b16 a[164:165], v216 offset:8192
  buffer_load_dwordx4 v235, s[12:15], s29 offen offset:3072 lds
  v_mfma_f32_16x16x32_bf16 v[108:111], a[148:151], v[148:151], v[108:111]
  v_exp_f32 v79, v79
  v_mfma_f32_16x16x32_bf16 v[108:111], a[144:147], v[144:147], v[108:111]
  ds_read_b64_tr_b16 a[166:167], v216 offset:12288
  v_cvt_pk_bf16_f32 v75, v78, v79
  v_mfma_f32_16x16x32_bf16 v[116:119], a[144:147], v[160:163], v[200:203]
  v_exp_f32 v84, v84
  v_mfma_f32_16x16x32_bf16 v[116:119], a[148:151], v[164:167], v[116:119]
  ds_read_b64_tr_b16 a[168:169], v217 offset:0
  ds_read_b64_tr_b16 a[232:233], v225 offset:0
  s_add_u32 m0, s28, 0
  v_mfma_f32_16x16x32_bf16 v[116:119], a[152:155], v[168:171], v[116:119]
  v_exp_f32 v85, v85
  v_mfma_f32_16x16x32_bf16 v[116:119], a[156:159], v[172:175], v[116:119]
  ds_read_b64_tr_b16 a[170:171], v217 offset:4096
  v_cvt_pk_bf16_f32 v82, v84, v85
  v_mfma_f32_16x16x32_bf16 v[124:127], a[156:159], v[188:191], v[204:207]
  v_exp_f32 v86, v86
  v_mfma_f32_16x16x32_bf16 v[124:127], a[152:155], v[184:187], v[124:127]
  ds_read_b64_tr_b16 a[172:173], v217 offset:8192
  ds_read_b64_tr_b16 a[234:235], v225 offset:128
  v_mfma_f32_16x16x32_bf16 v[124:127], a[148:151], v[180:183], v[124:127]
  v_exp_f32 v87, v87
  v_mfma_f32_16x16x32_bf16 v[124:127], a[144:147], v[176:179], v[124:127]
  ds_read_b64_tr_b16 a[174:175], v217 offset:12288
  v_cvt_pk_bf16_f32 v83, v86, v87
  v_mfma_f32_16x16x32_bf16 a[192:195], a[208:211], v[0:3], a[192:195]
  v_exp_f32 v92, v92
  v_mfma_f32_16x16x32_bf16 a[192:195], a[208:211], v[32:35], a[192:195]
  ds_read_b64_tr_b16 a[176:177], v218 offset:0
  ds_read_b64_tr_b16 a[236:237], v225 offset:1024
  v_mfma_f32_16x16x32_bf16 a[196:199], a[208:211], v[8:11], a[196:199]
  v_exp_f32 v93, v93
  v_mfma_f32_16x16x32_bf16 a[196:199], a[208:211], v[40:43], a[196:199]
  ds_read_b64_tr_b16 a[178:179], v218 offset:4096
  v_cvt_pk_bf16_f32 v90, v92, v93
  v_mfma_f32_16x16x32_bf16 a[200:203], a[208:211], v[16:19], a[200:203]
  v_exp_f32 v94, v94
  v_mfma_f32_16x16x32_bf16 a[200:203], a[208:211], v[48:51], a[200:203]
  ds_read_b64_tr_b16 a[180:181], v218 offset:8192
  ds_read_b64_tr_b16 a[238:239], v225 offset:1152
  v_mfma_f32_16x16x32_bf16 a[204:207], a[208:211], v[24:27], a[204:207]
  s_waitcnt lgkmcnt(11)
  v_exp_f32 v95, v95
  v_mfma_f32_16x16x32_bf16 a[204:207], a[208:211], v[56:59], a[204:207]
  ds_read_b64_tr_b16 a[182:183], v218 offset:12288
  v_cvt_pk_bf16_f32 v91, v94, v95
  v_mfma_f32_16x16x32_bf16 a[0:3], a[160:163], v[0:3], a[0:3]
  v_exp_f32 v96, v96
  v_mfma_f32_16x16x32_bf16 a[0:3], a[164:167], v[32:35], a[0:3]
  ds_read_b64_tr_b16 a[184:185], v219 offset:0
  ds_read_b64_tr_b16 a[240:241], v225 offset:2048
  v_mfma_f32_16x16x32_bf16 a[4:7], a[164:167], v[40:43], a[4:7]
  v_exp_f32 v97, v97
  v_mfma_f32_16x16x32_bf16 a[4:7], a[160:163], v[8:11], a[4:7]
  ds_read_b64_tr_b16 a[186:187], v219 offset:4096
  v_cvt_pk_bf16_f32 v96, v96, v97
  v_mfma_f32_16x16x32_bf16 a[8:11], a[160:163], v[16:19], a[8:11]
  v_exp_f32 v98, v98
  v_mfma_f32_16x16x32_bf16 a[8:11], a[164:167], v[48:51], a[8:11]
  ds_read_b64_tr_b16 a[188:189], v219 offset:8192
  ds_read_b64_tr_b16 a[242:243], v225 offset:2176
  v_mfma_f32_16x16x32_bf16 a[12:15], a[164:167], v[56:59], a[12:15]
  s_waitcnt lgkmcnt(11)
  v_exp_f32 v99, v99
  v_mfma_f32_16x16x32_bf16 a[12:15], a[160:163], v[24:27], a[12:15]
  ds_read_b64_tr_b16 a[190:191], v219 offset:12288
  v_cvt_pk_bf16_f32 v97, v98, v99
  v_mfma_f32_16x16x32_bf16 a[16:19], a[168:171], v[0:3], a[16:19]
  v_exp_f32 v104, v104
  v_mfma_f32_16x16x32_bf16 a[16:19], a[172:175], v[32:35], a[16:19]
  ds_read_b64_tr_b16 a[160:161], v220 offset:0
  buffer_load_dwordx4 v253, s[24:27], s8 offen offset:0 sc1 lds
  v_mfma_f32_16x16x32_bf16 a[20:23], a[172:175], v[40:43], a[20:23]
  v_exp_f32 v105, v105
  v_mfma_f32_16x16x32_bf16 a[20:23], a[168:171], v[8:11], a[20:23]
  ds_read_b64_tr_b16 a[162:163], v220 offset:4096
  v_cvt_pk_bf16_f32 v104, v104, v105
  v_mfma_f32_16x16x32_bf16 a[24:27], a[168:171], v[16:19], a[24:27]
  v_exp_f32 v106, v106
  v_mfma_f32_16x16x32_bf16 a[24:27], a[172:175], v[48:51], a[24:27]
  ds_read_b64_tr_b16 a[164:165], v220 offset:8192
  s_waitcnt lgkmcnt(4)
  buffer_load_dwordx4 v253, s[24:27], s8 offen offset:1024 sc1 lds
  v_mfma_f32_16x16x32_bf16 v[228:231], a[232:235], a[212:215], 0
  v_mfma_f32_16x16x32_bf16 v[228:231], a[236:239], a[216:219], v[228:231]
  v_mfma_f32_16x16x32_bf16 v[228:231], a[240:243], a[220:223], v[228:231]
  v_mfma_f32_16x16x32_bf16 a[28:31], a[172:175], v[56:59], a[28:31]
  s_lshl_b32 s35, s3, 10
  s_add_u32 s35, s35, 159744
  v_exp_f32 v107, v107
  v_mfma_f32_16x16x32_bf16 a[28:31], a[168:171], v[24:27], a[28:31]
  ds_read_b64_tr_b16 a[166:167], v220 offset:12288
  v_cvt_pk_bf16_f32 v105, v106, v107
  v_mfma_f32_16x16x32_bf16 a[32:35], a[176:179], v[0:3], a[32:35]
  v_exp_f32 v112, v112
  v_mfma_f32_16x16x32_bf16 a[32:35], a[180:183], v[32:35], a[32:35]
  ds_read_b64_tr_b16 a[168:169], v221 offset:0
  buffer_load_dwordx4 v253, s[24:27], s8 offen offset:2048 sc1 lds
  v_mfma_f32_16x16x32_bf16 a[36:39], a[180:183], v[40:43], a[36:39]
  v_exp_f32 v113, v113
  v_mfma_f32_16x16x32_bf16 a[36:39], a[176:179], v[8:11], a[36:39]
  ds_read_b64_tr_b16 a[170:171], v221 offset:4096
  v_cvt_pk_bf16_f32 v112, v112, v113
  v_mfma_f32_16x16x32_bf16 a[40:43], a[176:179], v[16:19], a[40:43]
  v_exp_f32 v114, v114
  v_mfma_f32_16x16x32_bf16 a[40:43], a[180:183], v[48:51], a[40:43]
  ds_read_b64_tr_b16 a[172:173], v221 offset:8192
  buffer_load_dwordx4 v253, s[24:27], s8 offen offset:3072 sc1 lds
  v_mfma_f32_16x16x32_bf16 a[44:47], a[180:183], v[56:59], a[44:47]
  s_waitcnt lgkmcnt(7)
  v_exp_f32 v115, v115
  v_mfma_f32_16x16x32_bf16 a[44:47], a[176:179], v[24:27], a[44:47]
  ds_read_b64_tr_b16 a[174:175], v221 offset:12288
  v_cvt_pk_bf16_f32 v113, v114, v115
  v_mfma_f32_16x16x32_bf16 a[48:51], a[184:187], v[0:3], a[48:51]
  v_exp_f32 v120, v120
  v_mfma_f32_16x16x32_bf16 a[48:51], a[188:191], v[32:35], a[48:51]
  ds_read_b64_tr_b16 a[176:177], v222 offset:0
  v_add_u32 v224, s35, v242
  v_mfma_f32_16x16x32_bf16 a[52:55], a[188:191], v[40:43], a[52:55]
  v_exp_f32 v121, v121
  v_mfma_f32_16x16x32_bf16 a[52:55], a[184:187], v[8:11], a[52:55]
  ds_read_b64_tr_b16 a[178:179], v222 offset:4096
  v_cvt_pk_bf16_f32 v120, v120, v121
  v_mfma_f32_16x16x32_bf16 a[56:59], a[184:187], v[16:19], a[56:59]
  v_exp_f32 v122, v122
  v_mfma_f32_16x16x32_bf16 a[56:59], a[188:191], v[48:51], a[56:59]
  ds_read_b64_tr_b16 a[180:181], v222 offset:8192
  ds_write_b128 v224, v[228:231]
  v_mfma_f32_16x16x32_bf16 a[60:63], a[188:191], v[56:59], a[60:63]
  s_waitcnt lgkmcnt(8)
  v_exp_f32 v123, v123
  v_mfma_f32_16x16x32_bf16 a[60:63], a[184:187], v[24:27], a[60:63]
  ds_read_b64_tr_b16 a[182:183], v222 offset:12288
  v_cvt_pk_bf16_f32 v121, v122, v123
  v_mfma_f32_16x16x32_bf16 a[64:67], a[160:163], v[0:3], a[64:67]
  v_exp_f32 v100, v100
  v_mfma_f32_16x16x32_bf16 a[64:67], a[164:167], v[32:35], a[64:67]
  ds_read_b64_tr_b16 a[184:185], v223 offset:0
  v_mfma_f32_16x16x32_bf16 a[68:71], a[164:167], v[40:43], a[68:71]
  v_exp_f32 v101, v101
  v_mfma_f32_16x16x32_bf16 a[68:71], a[160:163], v[8:11], a[68:71]
  ds_read_b64_tr_b16 a[186:187], v223 offset:4096
  v_cvt_pk_bf16_f32 v98, v100, v101
  v_mfma_f32_16x16x32_bf16 a[72:75], a[160:163], v[16:19], a[72:75]
  v_exp_f32 v102, v102
  v_mfma_f32_16x16x32_bf16 a[72:75], a[164:167], v[48:51], a[72:75]
  ds_read_b64_tr_b16 a[188:189], v223 offset:8192
  s_waitcnt lgkmcnt(4)
  v_mfma_f32_16x16x32_bf16 a[76:79], a[164:167], v[56:59], a[76:79]
  v_exp_f32 v103, v103
  v_mfma_f32_16x16x32_bf16 a[76:79], a[160:163], v[24:27], a[76:79]
  ds_read_b64_tr_b16 a[190:191], v223 offset:12288
  v_cvt_pk_bf16_f32 v99, v102, v103
  v_mfma_f32_16x16x32_bf16 a[80:83], a[168:171], v[0:3], a[80:83]
  s_waitcnt vmcnt(12)
  v_exp_f32 v108, v108
  v_mfma_f32_16x16x32_bf16 a[80:83], a[172:175], v[32:35], a[80:83]
  v_mfma_f32_16x16x32_bf16 a[84:87], a[172:175], v[40:43], a[84:87]
  s_barrier
  v_exp_f32 v109, v109
  v_mfma_f32_16x16x32_bf16 a[84:87], a[168:171], v[8:11], a[84:87]
  ds_read_b128 a[128:131], v212 offset:32768
  v_cvt_pk_bf16_f32 v106, v108, v109
  v_mfma_f32_16x16x32_bf16 a[88:91], a[168:171], v[16:19], a[88:91]
  v_exp_f32 v110, v110
  v_mfma_f32_16x16x32_bf16 a[88:91], a[172:175], v[48:51], a[88:91]
  ds_read_b128 a[132:135], v213 offset:32768
  v_mfma_f32_16x16x32_bf16 a[92:95], a[172:175], v[56:59], a[92:95]
  s_waitcnt lgkmcnt(6)
  v_exp_f32 v111, v111
  v_mfma_f32_16x16x32_bf16 a[92:95], a[168:171], v[24:27], a[92:95]
  ds_read_b128 a[136:139], v214 offset:32768
  v_cvt_pk_bf16_f32 v107, v110, v111
  v_mfma_f32_16x16x32_bf16 a[96:99], a[176:179], v[0:3], a[96:99]
  v_exp_f32 v116, v116
  v_mfma_f32_16x16x32_bf16 a[96:99], a[180:183], v[32:35], a[96:99]
  ds_read_b128 a[140:143], v215 offset:32768
  v_mfma_f32_16x16x32_bf16 a[100:103], a[180:183], v[40:43], a[100:103]
  v_exp_f32 v117, v117
  v_mfma_f32_16x16x32_bf16 a[100:103], a[176:179], v[8:11], a[100:103]
  v_cvt_pk_bf16_f32 v114, v116, v117
  v_mfma_f32_16x16x32_bf16 a[104:107], a[176:179], v[16:19], a[104:107]
  v_exp_f32 v118, v118
  v_mfma_f32_16x16x32_bf16 a[104:107], a[180:183], v[48:51], a[104:107]
  v_mfma_f32_16x16x32_bf16 a[108:111], a[180:183], v[56:59], a[108:111]
  s_waitcnt lgkmcnt(4)
  v_exp_f32 v119, v119
  v_mfma_f32_16x16x32_bf16 a[108:111], a[176:179], v[24:27], a[108:111]
  v_cvt_pk_bf16_f32 v115, v118, v119
  v_mfma_f32_16x16x32_bf16 a[112:115], a[184:187], v[0:3], a[112:115]
  v_exp_f32 v124, v124
  v_mfma_f32_16x16x32_bf16 a[112:115], a[188:191], v[32:35], a[112:115]
  v_mfma_f32_16x16x32_bf16 a[116:119], a[188:191], v[40:43], a[116:119]
  v_exp_f32 v125, v125
  v_mfma_f32_16x16x32_bf16 a[116:119], a[184:187], v[8:11], a[116:119]
  v_cvt_pk_bf16_f32 v122, v124, v125
  v_mfma_f32_16x16x32_bf16 a[120:123], a[184:187], v[16:19], a[120:123]
  v_exp_f32 v126, v126
  v_mfma_f32_16x16x32_bf16 a[120:123], a[188:191], v[48:51], a[120:123]
  v_mfma_f32_16x16x32_bf16 a[124:127], a[188:191], v[56:59], a[124:127]
  s_waitcnt lgkmcnt(0)
  v_exp_f32 v127, v127
  v_mfma_f32_16x16x32_bf16 a[124:127], a[184:187], v[24:27], a[124:127]
  v_cvt_pk_bf16_f32 v123, v126, v127
  v_mfma_f32_16x16x32_bf16 v[0:3], a[128:131], v[128:131], v[192:195]
  s_add_u32 m0, s28, 114688
  v_add_u32 v224, 159744, v242
  v_mfma_f32_16x16x32_bf16 v[0:3], a[132:135], v[132:135], v[0:3]
  ds_read_b128 a[144:147], v212 offset:36864
  ds_read_b128 v[228:231], v224 offset:0
  v_mfma_f32_16x16x32_bf16 v[0:3], a[136:139], v[136:139], v[0:3]
  buffer_load_dwordx4 v236, s[16:19], s29 offen offset:0 lds
  v_mfma_f32_16x16x32_bf16 v[0:3], a[140:143], v[140:143], v[0:3]
  ds_read_b128 a[148:151], v213 offset:36864
  ds_read_b128 v[238:241], v224 offset:1024
  v_mfma_f32_16x16x32_bf16 v[8:11], a[140:143], v[156:159], v[196:199]
  ds_read_b128 v[208:211], v224 offset:2048
  v_lshrrev_b32 v224, 4, v242
  v_mfma_f32_16x16x32_bf16 v[8:11], a[136:139], v[152:155], v[8:11]
  ds_read_b128 a[152:155], v214 offset:36864
  s_min_u32 s35, s3, 1
  s_lshl_b32 s35, s35, 30
  v_and_b32 v225, 7, v224
  v_mfma_f32_16x16x32_bf16 v[8:11], a[132:135], v[148:151], v[8:11]
  buffer_load_dwordx4 v237, s[16:19], s29 offen offset:1024 lds
  v_mfma_f32_16x16x32_bf16 v[8:11], a[128:131], v[144:147], v[8:11]
  ds_read_b128 a[156:159], v215 offset:36864
  v_mul_u32_u24 v225, 0xa00, v225
  v_mfma_f32_16x16x32_bf16 v[16:19], a[128:131], v[160:163], v[200:203]
  v_exp_f32 v0, v0
  v_mfma_f32_16x16x32_bf16 v[16:19], a[132:135], v[164:167], v[16:19]
  v_lshrrev_b32 v226, 4, v224
  v_lshl_add_u32 v225, v226, 4, v225
  v_mfma_f32_16x16x32_bf16 v[16:19], a[136:139], v[168:171], v[16:19]
  v_exp_f32 v1, v1
  v_mfma_f32_16x16x32_bf16 v[16:19], a[140:143], v[172:175], v[16:19]
  v_cvt_pk_bf16_f32 v0, v0, v1
  v_bfe_u32 v226, v224, 3, 1
  v_mfma_f32_16x16x32_bf16 v[24:27], a[140:143], v[188:191], v[204:207]
  v_exp_f32 v2, v2
  v_mfma_f32_16x16x32_bf16 v[24:27], a[136:139], v[184:187], v[24:27]
  buffer_load_dwordx4 v236, s[16:19], s29 offen offset:2048 lds
  v_mfma_f32_16x16x32_bf16 v[24:27], a[132:135], v[180:183], v[24:27]
  s_waitcnt lgkmcnt(0)
  v_exp_f32 v3, v3
  v_mfma_f32_16x16x32_bf16 v[24:27], a[128:131], v[176:179], v[24:27]
  v_cvt_pk_bf16_f32 v1, v2, v3
  v_lshl_add_u32 v225, v226, 30, v225
  v_mfma_f32_16x16x32_bf16 v[4:7], a[144:147], v[128:131], v[192:195]
  v_exp_f32 v8, v8
  v_mfma_f32_16x16x32_bf16 v[4:7], a[148:151], v[132:135], v[4:7]
  ds_read_b128 a[128:131], v212 offset:40960
  v_or_b32 v225, s35, v225
  v_mfma_f32_16x16x32_bf16 v[4:7], a[152:155], v[136:139], v[4:7]
  s_mul_i32 s35, s98, 20480
  s_lshl_b32 s38, s99, 6
  s_add_u32 s35, s35, s38
  v_exp_f32 v9, v9
  v_mfma_f32_16x16x32_bf16 v[4:7], a[156:159], v[140:143], v[4:7]
  ds_read_b128 a[132:135], v213 offset:40960
  s_add_u32 s35, s35, 2686976
  v_cvt_pk_bf16_f32 v8, v8, v9
  v_mfma_f32_16x16x32_bf16 v[12:15], a[156:159], v[156:159], v[196:199]
  v_exp_f32 v10, v10
  v_mfma_f32_16x16x32_bf16 v[12:15], a[152:155], v[152:155], v[12:15]
  ds_read_b128 a[136:139], v214 offset:40960
  v_add_f32 v228, v228, v238
  v_mfma_f32_16x16x32_bf16 v[12:15], a[148:151], v[148:151], v[12:15]
  v_exp_f32 v11, v11
  v_mfma_f32_16x16x32_bf16 v[12:15], a[144:147], v[144:147], v[12:15]
  ds_read_b128 a[140:143], v215 offset:40960
  v_cvt_pk_bf16_f32 v9, v10, v11
  v_mfma_f32_16x16x32_bf16 v[20:23], a[144:147], v[160:163], v[200:203]
  v_exp_f32 v16, v16
  v_mfma_f32_16x16x32_bf16 v[20:23], a[148:151], v[164:167], v[20:23]
  buffer_load_dwordx4 v237, s[16:19], s29 offen offset:3072 lds
  v_mfma_f32_16x16x32_bf16 v[20:23], a[152:155], v[168:171], v[20:23]
  s_add_u32 s29, s29, 16384
  v_exp_f32 v17, v17
  v_mfma_f32_16x16x32_bf16 v[20:23], a[156:159], v[172:175], v[20:23]
  v_cvt_pk_bf16_f32 v16, v16, v17
  v_add_f32 v229, v229, v239
  v_mfma_f32_16x16x32_bf16 v[28:31], a[156:159], v[188:191], v[204:207]
  s_add_u32 m0, s28, 16384
  v_exp_f32 v18, v18
  v_mfma_f32_16x16x32_bf16 v[28:31], a[152:155], v[184:187], v[28:31]
  buffer_load_dwordx4 v242, s[24:27], s9 offen offset:0 sc1 lds
  v_mfma_f32_16x16x32_bf16 v[28:31], a[148:151], v[180:183], v[28:31]
  s_waitcnt lgkmcnt(0)
  v_exp_f32 v19, v19
  v_mfma_f32_16x16x32_bf16 v[28:31], a[144:147], v[176:179], v[28:31]
  v_cvt_pk_bf16_f32 v17, v18, v19
  v_add_f32 v230, v230, v240
  v_mfma_f32_16x16x32_bf16 v[32:35], a[128:131], v[128:131], v[192:195]
  v_exp_f32 v24, v24
  v_mfma_f32_16x16x32_bf16 v[32:35], a[132:135], v[132:135], v[32:35]
  ds_read_b128 a[144:147], v212 offset:45056
  v_add_f32 v231, v231, v241
  v_mfma_f32_16x16x32_bf16 v[32:35], a[136:139], v[136:139], v[32:35]
  v_exp_f32 v25, v25
  v_mfma_f32_16x16x32_bf16 v[32:35], a[140:143], v[140:143], v[32:35]
  ds_read_b128 a[148:151], v213 offset:45056
  v_cvt_pk_bf16_f32 v24, v24, v25
  v_mfma_f32_16x16x32_bf16 v[40:43], a[140:143], v[156:159], v[196:199]
  v_exp_f32 v26, v26
  v_mfma_f32_16x16x32_bf16 v[40:43], a[136:139], v[152:155], v[40:43]
  ds_read_b128 a[152:155], v214 offset:45056
  v_add_f32 v228, v228, v208
  v_mfma_f32_16x16x32_bf16 v[40:43], a[132:135], v[148:151], v[40:43]
  v_exp_f32 v27, v27
  v_mfma_f32_16x16x32_bf16 v[40:43], a[128:131], v[144:147], v[40:43]
  ds_read_b128 a[156:159], v215 offset:45056
  v_cvt_pk_bf16_f32 v25, v26, v27
  v_mfma_f32_16x16x32_bf16 v[48:51], a[128:131], v[160:163], v[200:203]
  v_exp_f32 v4, v4
  v_mfma_f32_16x16x32_bf16 v[48:51], a[132:135], v[164:167], v[48:51]
  buffer_load_dwordx4 v242, s[24:27], s9 offen offset:1024 sc1 lds
  v_mfma_f32_16x16x32_bf16 v[48:51], a[136:139], v[168:171], v[48:51]
  v_exp_f32 v5, v5
  v_mfma_f32_16x16x32_bf16 v[48:51], a[140:143], v[172:175], v[48:51]
  v_cvt_pk_bf16_f32 v2, v4, v5
  v_add_f32 v229, v229, v209
  v_mfma_f32_16x16x32_bf16 v[56:59], a[140:143], v[188:191], v[204:207]
  v_exp_f32 v6, v6
  v_mfma_f32_16x16x32_bf16 v[56:59], a[136:139], v[184:187], v[56:59]
  buffer_load_dwordx4 v242, s[24:27], s9 offen offset:2048 sc1 lds
  v_mfma_f32_16x16x32_bf16 v[56:59], a[132:135], v[180:183], v[56:59]
  s_waitcnt lgkmcnt(0)
  v_exp_f32 v7, v7
  v_mfma_f32_16x16x32_bf16 v[56:59], a[128:131], v[176:179], v[56:59]
  v_cvt_pk_bf16_f32 v3, v6, v7
  v_add_f32 v230, v230, v210
  v_mfma_f32_16x16x32_bf16 v[36:39], a[144:147], v[128:131], v[192:195]
  v_exp_f32 v12, v12
  v_mfma_f32_16x16x32_bf16 v[36:39], a[148:151], v[132:135], v[36:39]
  ds_read_b64_tr_b16 a[160:161], v216 offset:16384
  v_add_f32 v231, v231, v211
  v_mfma_f32_16x16x32_bf16 v[36:39], a[152:155], v[136:139], v[36:39]
  v_exp_f32 v13, v13
  v_mfma_f32_16x16x32_bf16 v[36:39], a[156:159], v[140:143], v[36:39]
  ds_read_b64_tr_b16 a[162:163], v216 offset:20480
  v_cvt_pk_bf16_f32 v10, v12, v13
  v_mfma_f32_16x16x32_bf16 v[44:47], a[156:159], v[156:159], v[196:199]
  v_exp_f32 v14, v14
  v_mfma_f32_16x16x32_bf16 v[44:47], a[152:155], v[152:155], v[44:47]
  ds_read_b64_tr_b16 a[164:165], v216 offset:24576
  buffer_load_dwordx4 v242, s[24:27], s9 offen offset:3072 sc1 lds
  v_mfma_f32_16x16x32_bf16 v[44:47], a[148:151], v[148:151], v[44:47]
  v_exp_f32 v15, v15
  v_mfma_f32_16x16x32_bf16 v[44:47], a[144:147], v[144:147], v[44:47]
  ds_read_b64_tr_b16 a[166:167], v216 offset:28672
  v_cvt_pk_bf16_f32 v11, v14, v15
  v_mfma_f32_16x16x32_bf16 v[52:55], a[144:147], v[160:163], v[200:203]
  v_exp_f32 v20, v20
  v_mfma_f32_16x16x32_bf16 v[52:55], a[148:151], v[164:167], v[52:55]
  ds_read_b64_tr_b16 a[168:169], v217 offset:16384
  buffer_store_dwordx4 v[228:231], v225, s[24:27], s35 offen sc1
  v_mfma_f32_16x16x32_bf16 v[52:55], a[152:155], v[168:171], v[52:55]
  v_exp_f32 v21, v21
  v_mfma_f32_16x16x32_bf16 v[52:55], a[156:159], v[172:175], v[52:55]
  ds_read_b64_tr_b16 a[170:171], v217 offset:20480
  v_cvt_pk_bf16_f32 v18, v20, v21
  v_mfma_f32_16x16x32_bf16 v[60:63], a[156:159], v[188:191], v[204:207]
  v_exp_f32 v22, v22
  v_mfma_f32_16x16x32_bf16 v[60:63], a[152:155], v[184:187], v[60:63]
  ds_read_b64_tr_b16 a[172:173], v217 offset:24576
  buffer_load_dwordx4 a[212:215], v242, s[24:27], s4 offen offset:0 sc1
  v_mfma_f32_16x16x32_bf16 v[60:63], a[148:151], v[180:183], v[60:63]
  v_exp_f32 v23, v23
  v_mfma_f32_16x16x32_bf16 v[60:63], a[144:147], v[176:179], v[60:63]
  ds_read_b64_tr_b16 a[174:175], v217 offset:28672
  v_cvt_pk_bf16_f32 v19, v22, v23
  v_mfma_f32_16x16x32_bf16 a[192:195], a[208:211], v[64:67], a[192:195]
  v_exp_f32 v28, v28
  v_mfma_f32_16x16x32_bf16 a[192:195], a[208:211], v[96:99], a[192:195]
  ds_read_b64_tr_b16 a[176:177], v218 offset:16384
  buffer_load_dwordx4 a[216:219], v242, s[24:27], s4 offen offset:1024 sc1
  v_mfma_f32_16x16x32_bf16 a[196:199], a[208:211], v[72:75], a[196:199]
  v_exp_f32 v29, v29
  v_mfma_f32_16x16x32_bf16 a[196:199], a[208:211], v[104:107], a[196:199]
  ds_read_b64_tr_b16 a[178:179], v218 offset:20480
  v_cvt_pk_bf16_f32 v26, v28, v29
  v_mfma_f32_16x16x32_bf16 a[200:203], a[208:211], v[80:83], a[200:203]
  v_exp_f32 v30, v30
  v_mfma_f32_16x16x32_bf16 a[200:203], a[208:211], v[112:115], a[200:203]
  ds_read_b64_tr_b16 a[180:181], v218 offset:24576
  v_mfma_f32_16x16x32_bf16 a[204:207], a[208:211], v[88:91], a[204:207]
  s_waitcnt lgkmcnt(7)
  v_exp_f32 v31, v31
  v_mfma_f32_16x16x32_bf16 a[204:207], a[208:211], v[120:123], a[204:207]
  ds_read_b64_tr_b16 a[182:183], v218 offset:28672
  v_cvt_pk_bf16_f32 v27, v30, v31
  v_mfma_f32_16x16x32_bf16 a[0:3], a[160:163], v[64:67], a[0:3]
  v_exp_f32 v32, v32
  v_mfma_f32_16x16x32_bf16 a[0:3], a[164:167], v[96:99], a[0:3]
  ds_read_b64_tr_b16 a[184:185], v219 offset:16384
  buffer_load_dwordx4 a[220:223], v242, s[24:27], s4 offen offset:2048 sc1
  v_mfma_f32_16x16x32_bf16 a[4:7], a[164:167], v[104:107], a[4:7]
  v_exp_f32 v33, v33
  v_mfma_f32_16x16x32_bf16 a[4:7], a[160:163], v[72:75], a[4:7]
  ds_read_b64_tr_b16 a[186:187], v219 offset:20480
  v_cvt_pk_bf16_f32 v32, v32, v33
  v_mfma_f32_16x16x32_bf16 a[8:11], a[160:163], v[80:83], a[8:11]
  v_exp_f32 v34, v34
  v_mfma_f32_16x16x32_bf16 a[8:11], a[164:167], v[112:115], a[8:11]
  ds_read_b64_tr_b16 a[188:189], v219 offset:24576
  v_mfma_f32_16x16x32_bf16 a[12:15], a[164:167], v[120:123], a[12:15]
  s_waitcnt lgkmcnt(7)
  v_exp_f32 v35, v35
  v_mfma_f32_16x16x32_bf16 a[12:15], a[160:163], v[88:91], a[12:15]
  ds_read_b64_tr_b16 a[190:191], v219 offset:28672
  v_cvt_pk_bf16_f32 v33, v34, v35
  v_mfma_f32_16x16x32_bf16 a[16:19], a[168:171], v[64:67], a[16:19]
  v_exp_f32 v40, v40
  v_mfma_f32_16x16x32_bf16 a[16:19], a[172:175], v[96:99], a[16:19]
  ds_read_b64_tr_b16 a[160:161], v220 offset:16384
  buffer_load_dwordx4 a[224:227], v242, s[24:27], s4 offen offset:3072 sc1
  v_mfma_f32_16x16x32_bf16 a[20:23], a[172:175], v[104:107], a[20:23]
  v_exp_f32 v41, v41
  v_mfma_f32_16x16x32_bf16 a[20:23], a[168:171], v[72:75], a[20:23]
  ds_read_b64_tr_b16 a[162:163], v220 offset:20480
  v_cvt_pk_bf16_f32 v40, v40, v41
  v_mfma_f32_16x16x32_bf16 a[24:27], a[168:171], v[80:83], a[24:27]
  v_exp_f32 v42, v42
  v_mfma_f32_16x16x32_bf16 a[24:27], a[172:175], v[112:115], a[24:27]
  ds_read_b64_tr_b16 a[164:165], v220 offset:24576
  v_mfma_f32_16x16x32_bf16 a[28:31], a[172:175], v[120:123], a[28:31]
  s_waitcnt lgkmcnt(7)
  v_exp_f32 v43, v43
  v_mfma_f32_16x16x32_bf16 a[28:31], a[168:171], v[88:91], a[28:31]
  ds_read_b64_tr_b16 a[166:167], v220 offset:28672
  v_cvt_pk_bf16_f32 v41, v42, v43
  v_mfma_f32_16x16x32_bf16 a[32:35], a[176:179], v[64:67], a[32:35]
  v_exp_f32 v48, v48
  v_mfma_f32_16x16x32_bf16 a[32:35], a[180:183], v[96:99], a[32:35]
  ds_read_b64_tr_b16 a[168:169], v221 offset:16384
  buffer_load_dwordx4 a[228:231], v252, s[24:27], s4 offen offset:0 sc1
  v_mfma_f32_16x16x32_bf16 a[36:39], a[180:183], v[104:107], a[36:39]
  v_exp_f32 v49, v49
  v_mfma_f32_16x16x32_bf16 a[36:39], a[176:179], v[72:75], a[36:39]
  ds_read_b64_tr_b16 a[170:171], v221 offset:20480
  v_cvt_pk_bf16_f32 v48, v48, v49
  v_mfma_f32_16x16x32_bf16 a[40:43], a[176:179], v[80:83], a[40:43]
  v_exp_f32 v50, v50
  v_mfma_f32_16x16x32_bf16 a[40:43], a[180:183], v[112:115], a[40:43]
  ds_read_b64_tr_b16 a[172:173], v221 offset:24576
  v_mfma_f32_16x16x32_bf16 a[44:47], a[180:183], v[120:123], a[44:47]
  s_waitcnt lgkmcnt(7)
  v_exp_f32 v51, v51
  v_mfma_f32_16x16x32_bf16 a[44:47], a[176:179], v[88:91], a[44:47]
  ds_read_b64_tr_b16 a[174:175], v221 offset:28672
  v_cvt_pk_bf16_f32 v49, v50, v51
  v_mfma_f32_16x16x32_bf16 a[48:51], a[184:187], v[64:67], a[48:51]
  v_exp_f32 v56, v56
  v_mfma_f32_16x16x32_bf16 a[48:51], a[188:191], v[96:99], a[48:51]
  ds_read_b64_tr_b16 a[176:177], v222 offset:16384
  buffer_load_dwordx4 a[232:235], v252, s[24:27], s4 offen offset:1024 sc1
  v_mfma_f32_16x16x32_bf16 a[52:55], a[188:191], v[104:107], a[52:55]
  v_exp_f32 v57, v57
  v_mfma_f32_16x16x32_bf16 a[52:55], a[184:187], v[72:75], a[52:55]
  ds_read_b64_tr_b16 a[178:179], v222 offset:20480
  v_cvt_pk_bf16_f32 v56, v56, v57
  v_mfma_f32_16x16x32_bf16 a[56:59], a[184:187], v[80:83], a[56:59]
  v_exp_f32 v58, v58
  v_mfma_f32_16x16x32_bf16 a[56:59], a[188:191], v[112:115], a[56:59]
  ds_read_b64_tr_b16 a[180:181], v222 offset:24576
  v_mfma_f32_16x16x32_bf16 a[60:63], a[188:191], v[120:123], a[60:63]
  s_waitcnt lgkmcnt(7)
  v_exp_f32 v59, v59
  v_mfma_f32_16x16x32_bf16 a[60:63], a[184:187], v[88:91], a[60:63]
  ds_read_b64_tr_b16 a[182:183], v222 offset:28672
  v_cvt_pk_bf16_f32 v57, v58, v59
  v_mfma_f32_16x16x32_bf16 a[64:67], a[160:163], v[64:67], a[64:67]
  v_exp_f32 v36, v36
  v_mfma_f32_16x16x32_bf16 a[64:67], a[164:167], v[96:99], a[64:67]
  ds_read_b64_tr_b16 a[184:185], v223 offset:16384
  v_mfma_f32_16x16x32_bf16 a[68:71], a[164:167], v[104:107], a[68:71]
  v_exp_f32 v37, v37
  v_mfma_f32_16x16x32_bf16 a[68:71], a[160:163], v[72:75], a[68:71]
  ds_read_b64_tr_b16 a[186:187], v223 offset:20480
  v_cvt_pk_bf16_f32 v34, v36, v37
  v_mfma_f32_16x16x32_bf16 a[72:75], a[160:163], v[80:83], a[72:75]
  v_exp_f32 v38, v38
  v_mfma_f32_16x16x32_bf16 a[72:75], a[164:167], v[112:115], a[72:75]
  ds_read_b64_tr_b16 a[188:189], v223 offset:24576
  v_mfma_f32_16x16x32_bf16 a[76:79], a[164:167], v[120:123], a[76:79]
  s_waitcnt lgkmcnt(7)
  v_exp_f32 v39, v39
  v_mfma_f32_16x16x32_bf16 a[76:79], a[160:163], v[88:91], a[76:79]
  ds_read_b64_tr_b16 a[190:191], v223 offset:28672
  v_cvt_pk_bf16_f32 v35, v38, v39
  v_mfma_f32_16x16x32_bf16 a[80:83], a[168:171], v[64:67], a[80:83]
  s_waitcnt vmcnt(19)
  v_exp_f32 v44, v44
  v_mfma_f32_16x16x32_bf16 a[80:83], a[172:175], v[96:99], a[80:83]
  v_mfma_f32_16x16x32_bf16 a[84:87], a[172:175], v[104:107], a[84:87]
  s_barrier
  v_exp_f32 v45, v45
  v_mfma_f32_16x16x32_bf16 a[84:87], a[168:171], v[72:75], a[84:87]
  ds_read_b128 a[128:131], v212 offset:49152
  v_cvt_pk_bf16_f32 v42, v44, v45
  v_mfma_f32_16x16x32_bf16 a[88:91], a[168:171], v[80:83], a[88:91]
  v_exp_f32 v46, v46
  v_mfma_f32_16x16x32_bf16 a[88:91], a[172:175], v[112:115], a[88:91]
  ds_read_b128 a[132:135], v213 offset:49152
  v_mfma_f32_16x16x32_bf16 a[92:95], a[172:175], v[120:123], a[92:95]
  s_waitcnt lgkmcnt(6)
  v_exp_f32 v47, v47
  v_mfma_f32_16x16x32_bf16 a[92:95], a[168:171], v[88:91], a[92:95]
  ds_read_b128 a[136:139], v214 offset:49152
  v_cvt_pk_bf16_f32 v43, v46, v47
  v_mfma_f32_16x16x32_bf16 a[96:99], a[176:179], v[64:67], a[96:99]
  v_exp_f32 v52, v52
  v_mfma_f32_16x16x32_bf16 a[96:99], a[180:183], v[96:99], a[96:99]
  ds_read_b128 a[140:143], v215 offset:49152
  v_mfma_f32_16x16x32_bf16 a[100:103], a[180:183], v[104:107], a[100:103]
  v_exp_f32 v53, v53
  v_mfma_f32_16x16x32_bf16 a[100:103], a[176:179], v[72:75], a[100:103]
  v_cvt_pk_bf16_f32 v50, v52, v53
  v_mfma_f32_16x16x32_bf16 a[104:107], a[176:179], v[80:83], a[104:107]
  v_exp_f32 v54, v54
  v_mfma_f32_16x16x32_bf16 a[104:107], a[180:183], v[112:115], a[104:107]
  v_mfma_f32_16x16x32_bf16 a[108:111], a[180:183], v[120:123], a[108:111]
  s_waitcnt lgkmcnt(4)
  v_exp_f32 v55, v55
  v_mfma_f32_16x16x32_bf16 a[108:111], a[176:179], v[88:91], a[108:111]
  v_cvt_pk_bf16_f32 v51, v54, v55
  v_mfma_f32_16x16x32_bf16 a[112:115], a[184:187], v[64:67], a[112:115]
  v_exp_f32 v60, v60
  v_mfma_f32_16x16x32_bf16 a[112:115], a[188:191], v[96:99], a[112:115]
  v_mfma_f32_16x16x32_bf16 a[116:119], a[188:191], v[104:107], a[116:119]
  v_exp_f32 v61, v61
  v_mfma_f32_16x16x32_bf16 a[116:119], a[184:187], v[72:75], a[116:119]
  v_cvt_pk_bf16_f32 v58, v60, v61
  v_mfma_f32_16x16x32_bf16 a[120:123], a[184:187], v[80:83], a[120:123]
  v_exp_f32 v62, v62
  v_mfma_f32_16x16x32_bf16 a[120:123], a[188:191], v[112:115], a[120:123]
  v_mfma_f32_16x16x32_bf16 a[124:127], a[188:191], v[120:123], a[124:127]
  s_waitcnt lgkmcnt(0)
  v_exp_f32 v63, v63
  v_mfma_f32_16x16x32_bf16 a[124:127], a[184:187], v[88:91], a[124:127]
  v_cvt_pk_bf16_f32 v59, v62, v63
  v_mfma_f32_16x16x32_bf16 v[64:67], a[128:131], v[128:131], v[192:195]
  s_add_u32 m0, s28, 65536
  v_mfma_f32_16x16x32_bf16 v[64:67], a[132:135], v[132:135], v[64:67]
  ds_read_b128 a[144:147], v212 offset:53248
  v_mfma_f32_16x16x32_bf16 v[64:67], a[136:139], v[136:139], v[64:67]
  buffer_load_dwordx4 v253, s[24:27], s9 offen offset:0 sc1 lds
  v_mfma_f32_16x16x32_bf16 v[64:67], a[140:143], v[140:143], v[64:67]
  ds_read_b128 a[148:151], v213 offset:53248
  v_mfma_f32_16x16x32_bf16 v[72:75], a[140:143], v[156:159], v[196:199]
  v_mfma_f32_16x16x32_bf16 v[72:75], a[136:139], v[152:155], v[72:75]
  ds_read_b128 a[152:155], v214 offset:53248
  v_mfma_f32_16x16x32_bf16 v[72:75], a[132:135], v[148:151], v[72:75]
  buffer_load_dwordx4 v253, s[24:27], s9 offen offset:1024 sc1 lds
  v_mfma_f32_16x16x32_bf16 v[72:75], a[128:131], v[144:147], v[72:75]
  ds_read_b128 a[156:159], v215 offset:53248
  v_mfma_f32_16x16x32_bf16 v[80:83], a[128:131], v[160:163], v[200:203]
  v_exp_f32 v64, v64
  v_mfma_f32_16x16x32_bf16 v[80:83], a[132:135], v[164:167], v[80:83]
  v_mfma_f32_16x16x32_bf16 v[80:83], a[136:139], v[168:171], v[80:83]
  v_exp_f32 v65, v65
  v_mfma_f32_16x16x32_bf16 v[80:83], a[140:143], v[172:175], v[80:83]
  v_cvt_pk_bf16_f32 v64, v64, v65
  v_mfma_f32_16x16x32_bf16 v[88:91], a[140:143], v[188:191], v[204:207]
  v_exp_f32 v66, v66
  v_mfma_f32_16x16x32_bf16 v[88:91], a[136:139], v[184:187], v[88:91]
  buffer_load_dwordx4 v253, s[24:27], s9 offen offset:2048 sc1 lds
  v_mfma_f32_16x16x32_bf16 v[88:91], a[132:135], v[180:183], v[88:91]
  s_waitcnt lgkmcnt(0)
  v_exp_f32 v67, v67
  v_mfma_f32_16x16x32_bf16 v[88:91], a[128:131], v[176:179], v[88:91]
  v_cvt_pk_bf16_f32 v65, v66, v67
  v_mfma_f32_16x16x32_bf16 v[68:71], a[144:147], v[128:131], v[192:195]
  v_exp_f32 v72, v72
  v_mfma_f32_16x16x32_bf16 v[68:71], a[148:151], v[132:135], v[68:71]
  ds_read_b128 a[128:131], v212 offset:57344
  v_mfma_f32_16x16x32_bf16 v[68:71], a[152:155], v[136:139], v[68:71]
  v_exp_f32 v73, v73
  v_mfma_f32_16x16x32_bf16 v[68:71], a[156:159], v[140:143], v[68:71]
  ds_read_b128 a[132:135], v213 offset:57344
  v_cvt_pk_bf16_f32 v72, v72, v73
  v_mfma_f32_16x16x32_bf16 v[76:79], a[156:159], v[156:159], v[196:199]
  v_exp_f32 v74, v74
  v_mfma_f32_16x16x32_bf16 v[76:79], a[152:155], v[152:155], v[76:79]
  ds_read_b128 a[136:139], v214 offset:57344
  v_mfma_f32_16x16x32_bf16 v[76:79], a[148:151], v[148:151], v[76:79]
  v_exp_f32 v75, v75
  v_mfma_f32_16x16x32_bf16 v[76:79], a[144:147], v[144:147], v[76:79]
  ds_read_b128 a[140:143], v215 offset:57344
  v_cvt_pk_bf16_f32 v73, v74, v75
  v_mfma_f32_16x16x32_bf16 v[84:87], a[144:147], v[160:163], v[200:203]
  v_exp_f32 v80, v80
  v_mfma_f32_16x16x32_bf16 v[84:87], a[148:151], v[164:167], v[84:87]
  buffer_load_dwordx4 v253, s[24:27], s9 offen offset:3072 sc1 lds
  v_mfma_f32_16x16x32_bf16 v[84:87], a[152:155], v[168:171], v[84:87]
  s_add_u32 s29, s29, 16384
  v_exp_f32 v81, v81
  v_mfma_f32_16x16x32_bf16 v[84:87], a[156:159], v[172:175], v[84:87]
  v_cvt_pk_bf16_f32 v80, v80, v81
  v_mfma_f32_16x16x32_bf16 v[92:95], a[156:159], v[188:191], v[204:207]
  s_add_u32 m0, s28, 32768
  v_exp_f32 v82, v82
  v_mfma_f32_16x16x32_bf16 v[92:95], a[152:155], v[184:187], v[92:95]
  buffer_load_dwordx4 v252, s[24:27], s9 offen offset:0 sc1 lds
  v_mfma_f32_16x16x32_bf16 v[92:95], a[148:151], v[180:183], v[92:95]
  s_waitcnt lgkmcnt(0)
  v_exp_f32 v83, v83
  v_mfma_f32_16x16x32_bf16 v[92:95], a[144:147], v[176:179], v[92:95]
  v_cvt_pk_bf16_f32 v81, v82, v83
  v_mfma_f32_16x16x32_bf16 v[96:99], a[128:131], v[128:131], v[192:195]
  v_exp_f32 v88, v88
  v_mfma_f32_16x16x32_bf16 v[96:99], a[132:135], v[132:135], v[96:99]
  ds_read_b128 a[144:147], v212 offset:61440
  v_mfma_f32_16x16x32_bf16 v[96:99], a[136:139], v[136:139], v[96:99]
  v_exp_f32 v89, v89
  v_mfma_f32_16x16x32_bf16 v[96:99], a[140:143], v[140:143], v[96:99]
  ds_read_b128 a[148:151], v213 offset:61440
  v_cvt_pk_bf16_f32 v88, v88, v89
  v_mfma_f32_16x16x32_bf16 v[104:107], a[140:143], v[156:159], v[196:199]
  v_exp_f32 v90, v90
  v_mfma_f32_16x16x32_bf16 v[104:107], a[136:139], v[152:155], v[104:107]
  ds_read_b128 a[152:155], v214 offset:61440
  v_mfma_f32_16x16x32_bf16 v[104:107], a[132:135], v[148:151], v[104:107]
  v_exp_f32 v91, v91
  v_mfma_f32_16x16x32_bf16 v[104:107], a[128:131], v[144:147], v[104:107]
  ds_read_b128 a[156:159], v215 offset:61440
  v_cvt_pk_bf16_f32 v89, v90, v91
  v_mfma_f32_16x16x32_bf16 v[112:115], a[128:131], v[160:163], v[200:203]
  v_exp_f32 v68, v68
  v_mfma_f32_16x16x32_bf16 v[112:115], a[132:135], v[164:167], v[112:115]
  buffer_load_dwordx4 v252, s[24:27], s9 offen offset:1024 sc1 lds
  v_mfma_f32_16x16x32_bf16 v[112:115], a[136:139], v[168:171], v[112:115]
  v_exp_f32 v69, v69
  v_mfma_f32_16x16x32_bf16 v[112:115], a[140:143], v[172:175], v[112:115]
  v_cvt_pk_bf16_f32 v66, v68, v69
  v_mfma_f32_16x16x32_bf16 v[120:123], a[140:143], v[188:191], v[204:207]
  v_exp_f32 v70, v70
  v_mfma_f32_16x16x32_bf16 v[120:123], a[136:139], v[184:187], v[120:123]
  buffer_load_dwordx4 v252, s[24:27], s9 offen offset:2048 sc1 lds
  v_mfma_f32_16x16x32_bf16 v[120:123], a[132:135], v[180:183], v[120:123]
  s_waitcnt lgkmcnt(0)
  v_exp_f32 v71, v71
  v_mfma_f32_16x16x32_bf16 v[120:123], a[128:131], v[176:179], v[120:123]
  v_cvt_pk_bf16_f32 v67, v70, v71
  v_mfma_f32_16x16x32_bf16 v[100:103], a[144:147], v[128:131], v[192:195]
  v_exp_f32 v76, v76
  v_mfma_f32_16x16x32_bf16 v[100:103], a[148:151], v[132:135], v[100:103]
  ds_read_b64_tr_b16 a[160:161], v216 offset:32768
  v_mfma_f32_16x16x32_bf16 v[100:103], a[152:155], v[136:139], v[100:103]
  v_exp_f32 v77, v77
  v_mfma_f32_16x16x32_bf16 v[100:103], a[156:159], v[140:143], v[100:103]
  ds_read_b64_tr_b16 a[162:163], v216 offset:36864
  v_cvt_pk_bf16_f32 v74, v76, v77
  v_mfma_f32_16x16x32_bf16 v[108:111], a[156:159], v[156:159], v[196:199]
  v_exp_f32 v78, v78
  v_mfma_f32_16x16x32_bf16 v[108:111], a[152:155], v[152:155], v[108:111]
  ds_read_b64_tr_b16 a[164:165], v216 offset:40960
  buffer_load_dwordx4 v252, s[24:27], s9 offen offset:3072 sc1 lds
  v_mfma_f32_16x16x32_bf16 v[108:111], a[148:151], v[148:151], v[108:111]
  v_exp_f32 v79, v79
  v_mfma_f32_16x16x32_bf16 v[108:111], a[144:147], v[144:147], v[108:111]
  ds_read_b64_tr_b16 a[166:167], v216 offset:45056
  v_cvt_pk_bf16_f32 v75, v78, v79
  v_mfma_f32_16x16x32_bf16 v[116:119], a[144:147], v[160:163], v[200:203]
  v_exp_f32 v84, v84
  v_mfma_f32_16x16x32_bf16 v[116:119], a[148:151], v[164:167], v[116:119]
  ds_read_b64_tr_b16 a[168:169], v217 offset:32768
  buffer_load_dwordx4 a[236:239], v252, s[24:27], s4 offen offset:2048 sc1
  v_mfma_f32_16x16x32_bf16 v[116:119], a[152:155], v[168:171], v[116:119]
  v_exp_f32 v85, v85
  v_mfma_f32_16x16x32_bf16 v[116:119], a[156:159], v[172:175], v[116:119]
  ds_read_b64_tr_b16 a[170:171], v217 offset:36864
  v_cvt_pk_bf16_f32 v82, v84, v85
  v_mfma_f32_16x16x32_bf16 v[124:127], a[156:159], v[188:191], v[204:207]
  v_exp_f32 v86, v86
  v_mfma_f32_16x16x32_bf16 v[124:127], a[152:155], v[184:187], v[124:127]
  ds_read_b64_tr_b16 a[172:173], v217 offset:40960
  v_mfma_f32_16x16x32_bf16 v[124:127], a[148:151], v[180:183], v[124:127]
  v_exp_f32 v87, v87
  v_mfma_f32_16x16x32_bf16 v[124:127], a[144:147], v[176:179], v[124:127]
  ds_read_b64_tr_b16 a[174:175], v217 offset:45056
  v_cvt_pk_bf16_f32 v83, v86, v87
  v_mfma_f32_16x16x32_bf16 a[192:195], a[208:211], v[0:3], a[192:195]
  v_exp_f32 v92, v92
  v_mfma_f32_16x16x32_bf16 a[192:195], a[208:211], v[32:35], a[192:195]
  ds_read_b64_tr_b16 a[176:177], v218 offset:32768
  buffer_load_dwordx4 a[240:243], v252, s[24:27], s4 offen offset:3072 sc1
  v_mfma_f32_16x16x32_bf16 a[196:199], a[208:211], v[8:11], a[196:199]
  v_exp_f32 v93, v93
  v_mfma_f32_16x16x32_bf16 a[196:199], a[208:211], v[40:43], a[196:199]
  ds_read_b64_tr_b16 a[178:179], v218 offset:36864
  v_cvt_pk_bf16_f32 v90, v92, v93
  v_mfma_f32_16x16x32_bf16 a[200:203], a[208:211], v[16:19], a[200:203]
  v_exp_f32 v94, v94
  v_mfma_f32_16x16x32_bf16 a[200:203], a[208:211], v[48:51], a[200:203]
  ds_read_b64_tr_b16 a[180:181], v218 offset:40960
  v_mfma_f32_16x16x32_bf16 a[204:207], a[208:211], v[24:27], a[204:207]
  s_waitcnt lgkmcnt(7)
  v_exp_f32 v95, v95
  v_mfma_f32_16x16x32_bf16 a[204:207], a[208:211], v[56:59], a[204:207]
  ds_read_b64_tr_b16 a[182:183], v218 offset:45056
  v_cvt_pk_bf16_f32 v91, v94, v95
  v_mfma_f32_16x16x32_bf16 a[0:3], a[160:163], v[0:3], a[0:3]
  v_exp_f32 v96, v96
  v_mfma_f32_16x16x32_bf16 a[0:3], a[164:167], v[32:35], a[0:3]
  ds_read_b64_tr_b16 a[184:185], v219 offset:32768
  buffer_load_dwordx4 a[244:247], v253, s[24:27], s4 offen offset:0 sc1
  v_mfma_f32_16x16x32_bf16 a[4:7], a[164:167], v[40:43], a[4:7]
  v_exp_f32 v97, v97
  v_mfma_f32_16x16x32_bf16 a[4:7], a[160:163], v[8:11], a[4:7]
  ds_read_b64_tr_b16 a[186:187], v219 offset:36864
  v_cvt_pk_bf16_f32 v96, v96, v97
  v_mfma_f32_16x16x32_bf16 a[8:11], a[160:163], v[16:19], a[8:11]
  v_exp_f32 v98, v98
  v_mfma_f32_16x16x32_bf16 a[8:11], a[164:167], v[48:51], a[8:11]
  ds_read_b64_tr_b16 a[188:189], v219 offset:40960
  v_mfma_f32_16x16x32_bf16 a[12:15], a[164:167], v[56:59], a[12:15]
  s_waitcnt lgkmcnt(7)
  v_exp_f32 v99, v99
  v_mfma_f32_16x16x32_bf16 a[12:15], a[160:163], v[24:27], a[12:15]
  ds_read_b64_tr_b16 a[190:191], v219 offset:45056
  v_cvt_pk_bf16_f32 v97, v98, v99
  v_mfma_f32_16x16x32_bf16 a[16:19], a[168:171], v[0:3], a[16:19]
  v_exp_f32 v104, v104
  v_mfma_f32_16x16x32_bf16 a[16:19], a[172:175], v[32:35], a[16:19]
  ds_read_b64_tr_b16 a[160:161], v220 offset:32768
  buffer_load_dwordx4 a[248:251], v253, s[24:27], s4 offen offset:1024 sc1
  v_mfma_f32_16x16x32_bf16 a[20:23], a[172:175], v[40:43], a[20:23]
  v_exp_f32 v105, v105
  v_mfma_f32_16x16x32_bf16 a[20:23], a[168:171], v[8:11], a[20:23]
  ds_read_b64_tr_b16 a[162:163], v220 offset:36864
  v_cvt_pk_bf16_f32 v104, v104, v105
  v_mfma_f32_16x16x32_bf16 a[24:27], a[168:171], v[16:19], a[24:27]
  v_exp_f32 v106, v106
  v_mfma_f32_16x16x32_bf16 a[24:27], a[172:175], v[48:51], a[24:27]
  ds_read_b64_tr_b16 a[164:165], v220 offset:40960
  v_mfma_f32_16x16x32_bf16 a[28:31], a[172:175], v[56:59], a[28:31]
  s_waitcnt lgkmcnt(7)
  v_exp_f32 v107, v107
  v_mfma_f32_16x16x32_bf16 a[28:31], a[168:171], v[24:27], a[28:31]
  ds_read_b64_tr_b16 a[166:167], v220 offset:45056
  v_cvt_pk_bf16_f32 v105, v106, v107
  v_mfma_f32_16x16x32_bf16 a[32:35], a[176:179], v[0:3], a[32:35]
  v_exp_f32 v112, v112
  v_mfma_f32_16x16x32_bf16 a[32:35], a[180:183], v[32:35], a[32:35]
  ds_read_b64_tr_b16 a[168:169], v221 offset:32768
  buffer_load_dwordx4 a[252:255], v253, s[24:27], s4 offen offset:2048 sc1
  v_mfma_f32_16x16x32_bf16 a[36:39], a[180:183], v[40:43], a[36:39]
  v_exp_f32 v113, v113
  v_mfma_f32_16x16x32_bf16 a[36:39], a[176:179], v[8:11], a[36:39]
  ds_read_b64_tr_b16 a[170:171], v221 offset:36864
  v_cvt_pk_bf16_f32 v112, v112, v113
  v_mfma_f32_16x16x32_bf16 a[40:43], a[176:179], v[16:19], a[40:43]
  v_exp_f32 v114, v114
  v_mfma_f32_16x16x32_bf16 a[40:43], a[180:183], v[48:51], a[40:43]
  ds_read_b64_tr_b16 a[172:173], v221 offset:40960
  v_mfma_f32_16x16x32_bf16 a[44:47], a[180:183], v[56:59], a[44:47]
  s_waitcnt lgkmcnt(7)
  v_exp_f32 v115, v115
  v_mfma_f32_16x16x32_bf16 a[44:47], a[176:179], v[24:27], a[44:47]
  ds_read_b64_tr_b16 a[174:175], v221 offset:45056
  v_cvt_pk_bf16_f32 v113, v114, v115
  v_mfma_f32_16x16x32_bf16 a[48:51], a[184:187], v[0:3], a[48:51]
  v_exp_f32 v120, v120
  v_mfma_f32_16x16x32_bf16 a[48:51], a[188:191], v[32:35], a[48:51]
  ds_read_b64_tr_b16 a[176:177], v222 offset:32768
  v_mfma_f32_16x16x32_bf16 a[52:55], a[188:191], v[40:43], a[52:55]
  v_exp_f32 v121, v121
  v_mfma_f32_16x16x32_bf16 a[52:55], a[184:187], v[8:11], a[52:55]
  ds_read_b64_tr_b16 a[178:179], v222 offset:36864
  v_cvt_pk_bf16_f32 v120, v120, v121
  v_mfma_f32_16x16x32_bf16 a[56:59], a[184:187], v[16:19], a[56:59]
  v_exp_f32 v122, v122
  v_mfma_f32_16x16x32_bf16 a[56:59], a[188:191], v[48:51], a[56:59]
  ds_read_b64_tr_b16 a[180:181], v222 offset:40960
  v_mfma_f32_16x16x32_bf16 a[60:63], a[188:191], v[56:59], a[60:63]
  s_waitcnt lgkmcnt(7)
  v_exp_f32 v123, v123
  v_mfma_f32_16x16x32_bf16 a[60:63], a[184:187], v[24:27], a[60:63]
  ds_read_b64_tr_b16 a[182:183], v222 offset:45056
  v_cvt_pk_bf16_f32 v121, v122, v123
  v_mfma_f32_16x16x32_bf16 a[64:67], a[160:163], v[0:3], a[64:67]
  v_exp_f32 v100, v100
  v_mfma_f32_16x16x32_bf16 a[64:67], a[164:167], v[32:35], a[64:67]
  ds_read_b64_tr_b16 a[184:185], v223 offset:32768
  v_mfma_f32_16x16x32_bf16 a[68:71], a[164:167], v[40:43], a[68:71]
  v_exp_f32 v101, v101
  v_mfma_f32_16x16x32_bf16 a[68:71], a[160:163], v[8:11], a[68:71]
  ds_read_b64_tr_b16 a[186:187], v223 offset:36864
  v_cvt_pk_bf16_f32 v98, v100, v101
  v_mfma_f32_16x16x32_bf16 a[72:75], a[160:163], v[16:19], a[72:75]
  v_exp_f32 v102, v102
  v_mfma_f32_16x16x32_bf16 a[72:75], a[164:167], v[48:51], a[72:75]
  ds_read_b64_tr_b16 a[188:189], v223 offset:40960
  v_mfma_f32_16x16x32_bf16 a[76:79], a[164:167], v[56:59], a[76:79]
  s_waitcnt lgkmcnt(7)
  v_exp_f32 v103, v103
  v_mfma_f32_16x16x32_bf16 a[76:79], a[160:163], v[24:27], a[76:79]
  ds_read_b64_tr_b16 a[190:191], v223 offset:45056
  v_cvt_pk_bf16_f32 v99, v102, v103
  v_mfma_f32_16x16x32_bf16 a[80:83], a[168:171], v[0:3], a[80:83]
  s_waitcnt vmcnt(19)
  v_exp_f32 v108, v108
  v_mfma_f32_16x16x32_bf16 a[80:83], a[172:175], v[32:35], a[80:83]
  v_mfma_f32_16x16x32_bf16 a[84:87], a[172:175], v[40:43], a[84:87]
  s_barrier
  v_exp_f32 v109, v109
  v_mfma_f32_16x16x32_bf16 a[84:87], a[168:171], v[8:11], a[84:87]
  s_mul_i32 s39, s99, 13108
  s_lshr_b32 s39, s39, 16
  s_lshl_b32 s39, s39, 8
  v_cvt_pk_bf16_f32 v106, v108, v109
  v_mfma_f32_16x16x32_bf16 a[88:91], a[168:171], v[16:19], a[88:91]
  s_add_u32 s39, s39, 2822400
  s_cmp_lt_u32 s2, 240
  s_cselect_b32 s48, 0, 1073741824
  v_exp_f32 v110, v110
  v_mfma_f32_16x16x32_bf16 a[88:91], a[172:175], v[48:51], a[88:91]
  v_or_b32 v249, s48, v251
  v_mfma_f32_16x16x32_bf16 a[92:95], a[172:175], v[56:59], a[92:95]
  s_waitcnt lgkmcnt(4)
  v_exp_f32 v111, v111
  v_mfma_f32_16x16x32_bf16 a[92:95], a[168:171], v[24:27], a[92:95]
  buffer_atomic_add v250, v249, s[24:27], s39 offen
  v_cvt_pk_bf16_f32 v107, v110, v111
  v_mfma_f32_16x16x32_bf16 a[96:99], a[176:179], v[0:3], a[96:99]
  v_exp_f32 v116, v116
  v_mfma_f32_16x16x32_bf16 a[96:99], a[180:183], v[32:35], a[96:99]
  v_mfma_f32_16x16x32_bf16 a[100:103], a[180:183], v[40:43], a[100:103]
  v_exp_f32 v117, v117
  v_mfma_f32_16x16x32_bf16 a[100:103], a[176:179], v[8:11], a[100:103]
  v_cvt_pk_bf16_f32 v114, v116, v117
  v_mfma_f32_16x16x32_bf16 a[104:107], a[176:179], v[16:19], a[104:107]
  v_exp_f32 v118, v118
  v_mfma_f32_16x16x32_bf16 a[104:107], a[180:183], v[48:51], a[104:107]
  v_mfma_f32_16x16x32_bf16 a[108:111], a[180:183], v[56:59], a[108:111]
  s_waitcnt lgkmcnt(0)
  v_exp_f32 v119, v119
  v_mfma_f32_16x16x32_bf16 a[108:111], a[176:179], v[24:27], a[108:111]
  v_cvt_pk_bf16_f32 v115, v118, v119
  v_mfma_f32_16x16x32_bf16 a[112:115], a[184:187], v[0:3], a[112:115]
  v_exp_f32 v124, v124
  v_mfma_f32_16x16x32_bf16 a[112:115], a[188:191], v[32:35], a[112:115]
  v_mfma_f32_16x16x32_bf16 a[116:119], a[188:191], v[40:43], a[116:119]
  v_exp_f32 v125, v125
  v_mfma_f32_16x16x32_bf16 a[116:119], a[184:187], v[8:11], a[116:119]
  v_cvt_pk_bf16_f32 v122, v124, v125
  v_mfma_f32_16x16x32_bf16 a[120:123], a[184:187], v[16:19], a[120:123]
  v_exp_f32 v126, v126
  v_mfma_f32_16x16x32_bf16 a[120:123], a[188:191], v[48:51], a[120:123]
  v_mfma_f32_16x16x32_bf16 a[124:127], a[188:191], v[56:59], a[124:127]
  v_exp_f32 v127, v127
  v_mfma_f32_16x16x32_bf16 a[124:127], a[184:187], v[24:27], a[124:127]
  v_cvt_pk_bf16_f32 v123, v126, v127
  ds_read_b64_tr_b16 a[160:161], v216 offset:49152
  ds_read_b64_tr_b16 a[162:163], v216 offset:53248
  ds_read_b64_tr_b16 a[164:165], v216 offset:57344
  ds_read_b64_tr_b16 a[166:167], v216 offset:61440
  ds_read_b64_tr_b16 a[168:169], v217 offset:49152
  ds_read_b64_tr_b16 a[170:171], v217 offset:53248
  ds_read_b64_tr_b16 a[172:173], v217 offset:57344
  ds_read_b64_tr_b16 a[174:175], v217 offset:61440
  s_mov_b32 s48, 0x5d800000
  s_lshl_b32 s39, s3, 8
  v_mfma_f32_16x16x32_bf16 a[192:195], a[208:211], v[64:67], a[192:195]
  s_add_u32 m0, s28, 81920
  v_mfma_f32_16x16x32_bf16 a[192:195], a[208:211], v[96:99], a[192:195]
  v_mfma_f32_16x16x32_bf16 a[196:199], a[208:211], v[72:75], a[196:199]
  buffer_load_dwordx4 v242, s[24:27], s10 offen offset:0 sc1 lds
  v_mfma_f32_16x16x32_bf16 a[196:199], a[208:211], v[104:107], a[196:199]
  v_mfma_f32_16x16x32_bf16 a[200:203], a[208:211], v[80:83], a[200:203]
  buffer_load_dwordx4 v242, s[24:27], s10 offen offset:1024 sc1 lds
  v_mfma_f32_16x16x32_bf16 a[200:203], a[208:211], v[112:115], a[200:203]
  v_mfma_f32_16x16x32_bf16 a[204:207], a[208:211], v[88:91], a[204:207]
  buffer_load_dwordx4 v242, s[24:27], s10 offen offset:2048 sc1 lds
  v_mfma_f32_16x16x32_bf16 a[204:207], a[208:211], v[120:123], a[204:207]
  s_waitcnt lgkmcnt(4)
  v_mfma_f32_16x16x32_bf16 a[0:3], a[160:163], v[64:67], a[0:3]
  buffer_load_dwordx4 v242, s[24:27], s10 offen offset:3072 sc1 lds
  v_mfma_f32_16x16x32_bf16 a[0:3], a[164:167], v[96:99], a[0:3]
  ds_read_b64_tr_b16 a[176:177], v218 offset:49152
  v_mfma_f32_16x16x32_bf16 a[4:7], a[164:167], v[104:107], a[4:7]
  buffer_load_dwordx4 a[128:131], v253, s[24:27], s4 offen offset:3072 sc1
  v_mfma_f32_16x16x32_bf16 a[4:7], a[160:163], v[72:75], a[4:7]
  ds_read_b64_tr_b16 a[178:179], v218 offset:53248
  v_accvgpr_read_b32 v208, a192
  v_mfma_f32_16x16x32_bf16 a[8:11], a[160:163], v[80:83], a[8:11]
  v_accvgpr_read_b32 v209, a196
  v_accvgpr_read_b32 v210, a200
  v_mfma_f32_16x16x32_bf16 a[8:11], a[164:167], v[112:115], a[8:11]
  ds_read_b64_tr_b16 a[180:181], v218 offset:57344
  v_accvgpr_read_b32 v211, a204
  v_mfma_f32_16x16x32_bf16 a[12:15], a[164:167], v[120:123], a[12:15]
  v_mov_b32 v245, v208
  v_mov_b32 v246, v209
  v_mfma_f32_16x16x32_bf16 a[12:15], a[160:163], v[88:91], a[12:15]
  ds_read_b64_tr_b16 a[182:183], v218 offset:61440
  s_waitcnt lgkmcnt(4)
  v_mov_b32 v247, v210
  v_mfma_f32_16x16x32_bf16 a[16:19], a[168:171], v[64:67], a[16:19]
  v_mov_b32 v248, v211
  v_permlane16_swap_b32 v208, v245
  v_mfma_f32_16x16x32_bf16 a[16:19], a[172:175], v[96:99], a[16:19]
  ds_read_b64_tr_b16 a[184:185], v219 offset:49152
  v_permlane16_swap_b32 v209, v246
  v_mfma_f32_16x16x32_bf16 a[20:23], a[172:175], v[104:107], a[20:23]
  v_permlane16_swap_b32 v210, v247
  v_permlane16_swap_b32 v211, v248
  v_mfma_f32_16x16x32_bf16 a[20:23], a[168:171], v[72:75], a[20:23]
  ds_read_b64_tr_b16 a[186:187], v219 offset:53248
  v_add_f32 v208, v208, v245
  v_mfma_f32_16x16x32_bf16 a[24:27], a[168:171], v[80:83], a[24:27]
  v_add_f32 v209, v209, v246
  v_add_f32 v210, v210, v247
  v_mfma_f32_16x16x32_bf16 a[24:27], a[172:175], v[112:115], a[24:27]
  ds_read_b64_tr_b16 a[188:189], v219 offset:57344
  v_add_f32 v211, v211, v248
  v_mfma_f32_16x16x32_bf16 a[28:31], a[172:175], v[120:123], a[28:31]
  v_mov_b32 v245, v208
  v_mov_b32 v246, v209
  v_mfma_f32_16x16x32_bf16 a[28:31], a[168:171], v[88:91], a[28:31]
  ds_read_b64_tr_b16 a[190:191], v219 offset:61440
  s_waitcnt lgkmcnt(4)
  v_mov_b32 v247, v210
  v_mfma_f32_16x16x32_bf16 a[32:35], a[176:179], v[64:67], a[32:35]
  v_mov_b32 v248, v211
  v_permlane32_swap_b32 v208, v245
  v_mfma_f32_16x16x32_bf16 a[32:35], a[180:183], v[96:99], a[32:35]
  ds_read_b64_tr_b16 a[160:161], v220 offset:49152
  v_permlane32_swap_b32 v209, v246
  v_mfma_f32_16x16x32_bf16 a[36:39], a[180:183], v[104:107], a[36:39]
  v_permlane32_swap_b32 v210, v247
  v_permlane32_swap_b32 v211, v248
  v_mfma_f32_16x16x32_bf16 a[36:39], a[176:179], v[72:75], a[36:39]
  ds_read_b64_tr_b16 a[162:163], v220 offset:53248
  v_add_f32 v208, v208, v245
  v_mfma_f32_16x16x32_bf16 a[40:43], a[176:179], v[80:83], a[40:43]
  v_add_f32 v209, v209, v246
  v_add_f32 v210, v210, v247
  v_mfma_f32_16x16x32_bf16 a[40:43], a[180:183], v[112:115], a[40:43]
  ds_read_b64_tr_b16 a[164:165], v220 offset:57344
  v_add_f32 v211, v211, v248
  buffer_load_dwordx4 a[132:135], v242, s[24:27], s5 offen offset:0 sc1
  buffer_load_dwordx4 a[136:139], v242, s[24:27], s5 offen offset:1024 sc1
  buffer_load_dwordx4 a[140:143], v242, s[24:27], s5 offen offset:2048 sc1
  buffer_load_dwordx4 a[144:147], v242, s[24:27], s5 offen offset:3072 sc1
  buffer_load_dwordx4 a[148:151], v252, s[24:27], s5 offen offset:0 sc1
  buffer_load_dwordx4 a[152:155], v252, s[24:27], s5 offen offset:1024 sc1
  buffer_load_dwordx4 a[156:159], v252, s[24:27], s5 offen offset:2048 sc1
  v_mfma_f32_16x16x32_bf16 a[44:47], a[180:183], v[120:123], a[44:47]
  v_rcp_f32 v192, v208
  v_mfma_f32_16x16x32_bf16 a[44:47], a[176:179], v[88:91], a[44:47]
  ds_read_b64_tr_b16 a[166:167], v220 offset:61440
  s_waitcnt lgkmcnt(4)
  v_mfma_f32_16x16x32_bf16 a[48:51], a[184:187], v[64:67], a[48:51]
  v_rcp_f32 v196, v209
  v_mfma_f32_16x16x32_bf16 a[48:51], a[188:191], v[96:99], a[48:51]
  ds_read_b64_tr_b16 a[168:169], v221 offset:49152
  v_mfma_f32_16x16x32_bf16 a[52:55], a[188:191], v[104:107], a[52:55]
  v_rcp_f32 v200, v210
  v_mfma_f32_16x16x32_bf16 a[52:55], a[184:187], v[72:75], a[52:55]
  ds_read_b64_tr_b16 a[170:171], v221 offset:53248
  v_mfma_f32_16x16x32_bf16 a[56:59], a[184:187], v[80:83], a[56:59]
  v_rcp_f32 v204, v211
  v_mfma_f32_16x16x32_bf16 a[56:59], a[188:191], v[112:115], a[56:59]
  ds_read_b64_tr_b16 a[172:173], v221 offset:57344
  v_add_f32 v246, v208, v209
  v_mfma_f32_16x16x32_bf16 a[60:63], a[188:191], v[120:123], a[60:63]
  v_add_f32 v247, v210, v211
  v_add_f32 v246, v246, v247
  v_mfma_f32_16x16x32_bf16 a[60:63], a[184:187], v[88:91], a[60:63]
  ds_read_b64_tr_b16 a[174:175], v221 offset:61440
  s_waitcnt lgkmcnt(4)
  v_lshrrev_b32 v247, 2, v242
  v_mfma_f32_16x16x32_bf16 a[64:67], a[160:163], v[64:67], a[64:67]
  v_cmp_nlt_f32 vcc, v246, s48
  v_add_u32 v247, s39, v247
  v_mfma_f32_16x16x32_bf16 a[64:67], a[164:167], v[96:99], a[64:67]
  ds_read_b64_tr_b16 a[176:177], v222 offset:49152
  v_add_u32 v247, 157696, v247
  v_mfma_f32_16x16x32_bf16 a[68:71], a[164:167], v[104:107], a[68:71]
  v_cndmask_b32_e64 v245, 0, 1, vcc
  v_accvgpr_read_b32 v0, a0
  v_mfma_f32_16x16x32_bf16 a[68:71], a[160:163], v[72:75], a[68:71]
  ds_read_b64_tr_b16 a[178:179], v222 offset:53248
  v_accvgpr_read_b32 v1, a1
  v_mfma_f32_16x16x32_bf16 a[72:75], a[160:163], v[80:83], a[72:75]
  v_accvgpr_read_b32 v2, a2
  v_accvgpr_read_b32 v3, a3
  v_mfma_f32_16x16x32_bf16 a[72:75], a[164:167], v[112:115], a[72:75]
  ds_read_b64_tr_b16 a[180:181], v222 offset:57344
  v_accvgpr_read_b32 v4, a16
  v_mfma_f32_16x16x32_bf16 a[76:79], a[164:167], v[120:123], a[76:79]
  v_accvgpr_read_b32 v5, a17
  v_accvgpr_read_b32 v6, a18
  v_mfma_f32_16x16x32_bf16 a[76:79], a[160:163], v[88:91], a[76:79]
  ds_read_b64_tr_b16 a[182:183], v222 offset:61440
  s_waitcnt lgkmcnt(4)
  v_accvgpr_read_b32 v7, a19
  v_mfma_f32_16x16x32_bf16 a[80:83], a[168:171], v[64:67], a[80:83]
  v_mul_f32 v0, v0, v192
  v_mul_f32 v1, v1, v192
  v_mfma_f32_16x16x32_bf16 a[80:83], a[172:175], v[96:99], a[80:83]
  ds_read_b64_tr_b16 a[184:185], v223 offset:49152
  v_mul_f32 v2, v2, v192
  v_mfma_f32_16x16x32_bf16 a[84:87], a[172:175], v[104:107], a[84:87]
  v_mul_f32 v3, v3, v192
  v_mul_f32 v4, v4, v192
  v_mfma_f32_16x16x32_bf16 a[84:87], a[168:171], v[72:75], a[84:87]
  ds_read_b64_tr_b16 a[186:187], v223 offset:53248
  v_mul_f32 v5, v5, v192
  v_mfma_f32_16x16x32_bf16 a[88:91], a[168:171], v[80:83], a[88:91]
  v_mul_f32 v6, v6, v192
  v_mul_f32 v7, v7, v192
  v_mfma_f32_16x16x32_bf16 a[88:91], a[172:175], v[112:115], a[88:91]
  ds_read_b64_tr_b16 a[188:189], v223 offset:57344
  v_cvt_pk_bf16_f32 v0, v0, v1
  v_mfma_f32_16x16x32_bf16 a[92:95], a[172:175], v[120:123], a[92:95]
  v_cvt_pk_bf16_f32 v1, v2, v3
  v_cvt_pk_bf16_f32 v2, v4, v5
  v_mfma_f32_16x16x32_bf16 a[92:95], a[168:171], v[88:91], a[92:95]
  ds_read_b64_tr_b16 a[190:191], v223 offset:61440
  s_waitcnt lgkmcnt(4)
  v_cvt_pk_bf16_f32 v3, v6, v7
  v_mfma_f32_16x16x32_bf16 a[96:99], a[176:179], v[64:67], a[96:99]
  buffer_store_dwordx4 v[0:3], v244, s[24:27], s40 offen offset:0 sc1
  v_mfma_f32_16x16x32_bf16 a[96:99], a[180:183], v[96:99], a[96:99]
  v_accvgpr_read_b32 v8, a4
  v_accvgpr_read_b32 v9, a5
  v_mfma_f32_16x16x32_bf16 a[100:103], a[180:183], v[104:107], a[100:103]
  v_accvgpr_read_b32 v10, a6
  v_accvgpr_read_b32 v11, a7
  v_mfma_f32_16x16x32_bf16 a[100:103], a[176:179], v[72:75], a[100:103]
  v_accvgpr_read_b32 v12, a20
  v_accvgpr_read_b32 v13, a21
  v_mfma_f32_16x16x32_bf16 a[104:107], a[176:179], v[80:83], a[104:107]
  v_accvgpr_read_b32 v14, a22
  v_accvgpr_read_b32 v15, a23
  v_mfma_f32_16x16x32_bf16 a[104:107], a[180:183], v[112:115], a[104:107]
  v_mul_f32 v8, v8, v196
  v_mul_f32 v9, v9, v196
  v_mfma_f32_16x16x32_bf16 a[108:111], a[180:183], v[120:123], a[108:111]
  v_mul_f32 v10, v10, v196
  v_mul_f32 v11, v11, v196
  v_mfma_f32_16x16x32_bf16 a[108:111], a[176:179], v[88:91], a[108:111]
  s_waitcnt lgkmcnt(0)
  v_mul_f32 v12, v12, v196
  v_mul_f32 v13, v13, v196
  v_mfma_f32_16x16x32_bf16 a[112:115], a[184:187], v[64:67], a[112:115]
  v_mul_f32 v14, v14, v196
  v_mul_f32 v15, v15, v196
  v_mfma_f32_16x16x32_bf16 a[112:115], a[188:191], v[96:99], a[112:115]
  v_cvt_pk_bf16_f32 v8, v8, v9
  v_cvt_pk_bf16_f32 v9, v10, v11
  v_mfma_f32_16x16x32_bf16 a[116:119], a[188:191], v[104:107], a[116:119]
  v_cvt_pk_bf16_f32 v10, v12, v13
  v_cvt_pk_bf16_f32 v11, v14, v15
  v_mfma_f32_16x16x32_bf16 a[116:119], a[184:187], v[72:75], a[116:119]
  buffer_store_dwordx4 v[8:11], v244, s[24:27], s40 offen offset:2048 sc1
  v_mfma_f32_16x16x32_bf16 a[120:123], a[184:187], v[80:83], a[120:123]
  v_accvgpr_read_b32 v16, a8
  v_accvgpr_read_b32 v17, a9
  v_mfma_f32_16x16x32_bf16 a[120:123], a[188:191], v[112:115], a[120:123]
  v_accvgpr_read_b32 v18, a10
  v_accvgpr_read_b32 v19, a11
  v_mfma_f32_16x16x32_bf16 a[124:127], a[188:191], v[120:123], a[124:127]
  v_accvgpr_read_b32 v20, a24
  v_accvgpr_read_b32 v21, a25
  v_mfma_f32_16x16x32_bf16 a[124:127], a[184:187], v[88:91], a[124:127]
  v_accvgpr_read_b32 v22, a26
  v_accvgpr_read_b32 v23, a27
  v_pk_mul_f32 v[16:17], v[16:17], v[200:201] op_sel_hi:[1,0]
  v_pk_mul_f32 v[18:19], v[18:19], v[200:201] op_sel_hi:[1,0]
  v_pk_mul_f32 v[20:21], v[20:21], v[200:201] op_sel_hi:[1,0]
  v_pk_mul_f32 v[22:23], v[22:23], v[200:201] op_sel_hi:[1,0]
  v_cvt_pk_bf16_f32 v16, v16, v17
  v_cvt_pk_bf16_f32 v17, v18, v19
  v_cvt_pk_bf16_f32 v18, v20, v21
  v_cvt_pk_bf16_f32 v19, v22, v23
  buffer_store_dwordx4 v[16:19], v244, s[24:27], s41 offen offset:0 sc1
  v_accvgpr_read_b32 v24, a12
  v_accvgpr_read_b32 v25, a13
  v_accvgpr_read_b32 v26, a14
  v_accvgpr_read_b32 v27, a15
  v_accvgpr_read_b32 v28, a28
  v_accvgpr_read_b32 v29, a29
  v_accvgpr_read_b32 v30, a30
  v_accvgpr_read_b32 v31, a31
  v_pk_mul_f32 v[24:25], v[24:25], v[204:205] op_sel_hi:[1,0]
  v_pk_mul_f32 v[26:27], v[26:27], v[204:205] op_sel_hi:[1,0]
  v_pk_mul_f32 v[28:29], v[28:29], v[204:205] op_sel_hi:[1,0]
  v_pk_mul_f32 v[30:31], v[30:31], v[204:205] op_sel_hi:[1,0]
  v_cvt_pk_bf16_f32 v24, v24, v25
  v_cvt_pk_bf16_f32 v25, v26, v27
  v_cvt_pk_bf16_f32 v26, v28, v29
  v_cvt_pk_bf16_f32 v27, v30, v31
  buffer_store_dwordx4 v[24:27], v244, s[24:27], s41 offen offset:2048 sc1
  v_accvgpr_read_b32 v32, a32
  v_accvgpr_read_b32 v33, a33
  v_accvgpr_read_b32 v34, a34
  v_accvgpr_read_b32 v35, a35
  v_accvgpr_read_b32 v36, a48
  v_accvgpr_read_b32 v37, a49
  v_accvgpr_read_b32 v38, a50
  v_accvgpr_read_b32 v39, a51
  v_pk_mul_f32 v[32:33], v[32:33], v[192:193] op_sel_hi:[1,0]
  v_pk_mul_f32 v[34:35], v[34:35], v[192:193] op_sel_hi:[1,0]
  v_pk_mul_f32 v[36:37], v[36:37], v[192:193] op_sel_hi:[1,0]
  v_pk_mul_f32 v[38:39], v[38:39], v[192:193] op_sel_hi:[1,0]
  v_cvt_pk_bf16_f32 v32, v32, v33
  v_cvt_pk_bf16_f32 v33, v34, v35
  v_cvt_pk_bf16_f32 v34, v36, v37
  v_cvt_pk_bf16_f32 v35, v38, v39
  buffer_store_dwordx4 v[32:35], v244, s[24:27], s40 offen offset:1024 sc1
  v_accvgpr_read_b32 v40, a36
  v_accvgpr_read_b32 v41, a37
  v_accvgpr_read_b32 v42, a38
  v_accvgpr_read_b32 v43, a39
  v_accvgpr_read_b32 v44, a52
  v_accvgpr_read_b32 v45, a53
  v_accvgpr_read_b32 v46, a54
  v_accvgpr_read_b32 v47, a55
  v_pk_mul_f32 v[40:41], v[40:41], v[196:197] op_sel_hi:[1,0]
  v_pk_mul_f32 v[42:43], v[42:43], v[196:197] op_sel_hi:[1,0]
  v_pk_mul_f32 v[44:45], v[44:45], v[196:197] op_sel_hi:[1,0]
  v_pk_mul_f32 v[46:47], v[46:47], v[196:197] op_sel_hi:[1,0]
  v_cvt_pk_bf16_f32 v40, v40, v41
  v_cvt_pk_bf16_f32 v41, v42, v43
  v_cvt_pk_bf16_f32 v42, v44, v45
  v_cvt_pk_bf16_f32 v43, v46, v47
  buffer_store_dwordx4 v[40:43], v244, s[24:27], s40 offen offset:3072 sc1
  v_accvgpr_read_b32 v48, a40
  v_accvgpr_read_b32 v49, a41
  v_accvgpr_read_b32 v50, a42
  v_accvgpr_read_b32 v51, a43
  v_accvgpr_read_b32 v52, a56
  v_accvgpr_read_b32 v53, a57
  v_accvgpr_read_b32 v54, a58
  v_accvgpr_read_b32 v55, a59
  v_pk_mul_f32 v[48:49], v[48:49], v[200:201] op_sel_hi:[1,0]
  v_pk_mul_f32 v[50:51], v[50:51], v[200:201] op_sel_hi:[1,0]
  v_pk_mul_f32 v[52:53], v[52:53], v[200:201] op_sel_hi:[1,0]
  v_pk_mul_f32 v[54:55], v[54:55], v[200:201] op_sel_hi:[1,0]
  v_cvt_pk_bf16_f32 v48, v48, v49
  v_cvt_pk_bf16_f32 v49, v50, v51
  v_cvt_pk_bf16_f32 v50, v52, v53
  v_cvt_pk_bf16_f32 v51, v54, v55
  buffer_store_dwordx4 v[48:51], v244, s[24:27], s41 offen offset:1024 sc1
  v_accvgpr_read_b32 v56, a44
  v_accvgpr_read_b32 v57, a45
  v_accvgpr_read_b32 v58, a46
  v_accvgpr_read_b32 v59, a47
  v_accvgpr_read_b32 v60, a60
  v_accvgpr_read_b32 v61, a61
  v_accvgpr_read_b32 v62, a62
  v_accvgpr_read_b32 v63, a63
  v_pk_mul_f32 v[56:57], v[56:57], v[204:205] op_sel_hi:[1,0]
  v_pk_mul_f32 v[58:59], v[58:59], v[204:205] op_sel_hi:[1,0]
  v_pk_mul_f32 v[60:61], v[60:61], v[204:205] op_sel_hi:[1,0]
  v_pk_mul_f32 v[62:63], v[62:63], v[204:205] op_sel_hi:[1,0]
  v_cvt_pk_bf16_f32 v56, v56, v57
  v_cvt_pk_bf16_f32 v57, v58, v59
  v_cvt_pk_bf16_f32 v58, v60, v61
  v_cvt_pk_bf16_f32 v59, v62, v63
  buffer_store_dwordx4 v[56:59], v244, s[24:27], s41 offen offset:3072 sc1
  v_accvgpr_read_b32 v0, a64
  v_accvgpr_read_b32 v1, a65
  v_accvgpr_read_b32 v2, a66
  v_accvgpr_read_b32 v3, a67
  v_accvgpr_read_b32 v4, a80
  v_accvgpr_read_b32 v5, a81
  v_accvgpr_read_b32 v6, a82
  v_accvgpr_read_b32 v7, a83
  v_pk_mul_f32 v[0:1], v[0:1], v[192:193] op_sel_hi:[1,0]
  v_pk_mul_f32 v[2:3], v[2:3], v[192:193] op_sel_hi:[1,0]
  v_pk_mul_f32 v[4:5], v[4:5], v[192:193] op_sel_hi:[1,0]
  v_pk_mul_f32 v[6:7], v[6:7], v[192:193] op_sel_hi:[1,0]
  v_cvt_pk_bf16_f32 v0, v0, v1
  v_cvt_pk_bf16_f32 v1, v2, v3
  v_cvt_pk_bf16_f32 v2, v4, v5
  v_cvt_pk_bf16_f32 v3, v6, v7
  buffer_store_dwordx4 v[0:3], v244, s[24:27], s42 offen offset:0 sc1
  v_accvgpr_read_b32 v8, a68
  v_accvgpr_read_b32 v9, a69
  v_accvgpr_read_b32 v10, a70
  v_accvgpr_read_b32 v11, a71
  v_accvgpr_read_b32 v12, a84
  v_accvgpr_read_b32 v13, a85
  v_accvgpr_read_b32 v14, a86
  v_accvgpr_read_b32 v15, a87
  v_pk_mul_f32 v[8:9], v[8:9], v[196:197] op_sel_hi:[1,0]
  v_pk_mul_f32 v[10:11], v[10:11], v[196:197] op_sel_hi:[1,0]
  v_pk_mul_f32 v[12:13], v[12:13], v[196:197] op_sel_hi:[1,0]
  v_pk_mul_f32 v[14:15], v[14:15], v[196:197] op_sel_hi:[1,0]
  v_cvt_pk_bf16_f32 v8, v8, v9
  v_cvt_pk_bf16_f32 v9, v10, v11
  v_cvt_pk_bf16_f32 v10, v12, v13
  v_cvt_pk_bf16_f32 v11, v14, v15
  buffer_store_dwordx4 v[8:11], v244, s[24:27], s42 offen offset:2048 sc1
  v_accvgpr_read_b32 v16, a72
  v_accvgpr_read_b32 v17, a73
  v_accvgpr_read_b32 v18, a74
  v_accvgpr_read_b32 v19, a75
  v_accvgpr_read_b32 v20, a88
  v_accvgpr_read_b32 v21, a89
  v_accvgpr_read_b32 v22, a90
  v_accvgpr_read_b32 v23, a91
  v_pk_mul_f32 v[16:17], v[16:17], v[200:201] op_sel_hi:[1,0]
  v_pk_mul_f32 v[18:19], v[18:19], v[200:201] op_sel_hi:[1,0]
  v_pk_mul_f32 v[20:21], v[20:21], v[200:201] op_sel_hi:[1,0]
  v_pk_mul_f32 v[22:23], v[22:23], v[200:201] op_sel_hi:[1,0]
  v_cvt_pk_bf16_f32 v16, v16, v17
  v_cvt_pk_bf16_f32 v17, v18, v19
  v_cvt_pk_bf16_f32 v18, v20, v21
  v_cvt_pk_bf16_f32 v19, v22, v23
  buffer_store_dwordx4 v[16:19], v244, s[24:27], s43 offen offset:0 sc1
  v_accvgpr_read_b32 v24, a76
  v_accvgpr_read_b32 v25, a77
  v_accvgpr_read_b32 v26, a78
  v_accvgpr_read_b32 v27, a79
  v_accvgpr_read_b32 v28, a92
  v_accvgpr_read_b32 v29, a93
  v_accvgpr_read_b32 v30, a94
  v_accvgpr_read_b32 v31, a95
  v_pk_mul_f32 v[24:25], v[24:25], v[204:205] op_sel_hi:[1,0]
  v_pk_mul_f32 v[26:27], v[26:27], v[204:205] op_sel_hi:[1,0]
  v_pk_mul_f32 v[28:29], v[28:29], v[204:205] op_sel_hi:[1,0]
  v_pk_mul_f32 v[30:31], v[30:31], v[204:205] op_sel_hi:[1,0]
  v_cvt_pk_bf16_f32 v24, v24, v25
  v_cvt_pk_bf16_f32 v25, v26, v27
  v_cvt_pk_bf16_f32 v26, v28, v29
  v_cvt_pk_bf16_f32 v27, v30, v31
  buffer_store_dwordx4 v[24:27], v244, s[24:27], s43 offen offset:2048 sc1
  v_accvgpr_read_b32 v32, a96
  v_accvgpr_read_b32 v33, a97
  v_accvgpr_read_b32 v34, a98
  v_accvgpr_read_b32 v35, a99
  v_accvgpr_read_b32 v36, a112
  v_accvgpr_read_b32 v37, a113
  v_accvgpr_read_b32 v38, a114
  v_accvgpr_read_b32 v39, a115
  v_pk_mul_f32 v[32:33], v[32:33], v[192:193] op_sel_hi:[1,0]
  v_pk_mul_f32 v[34:35], v[34:35], v[192:193] op_sel_hi:[1,0]
  v_pk_mul_f32 v[36:37], v[36:37], v[192:193] op_sel_hi:[1,0]
  v_pk_mul_f32 v[38:39], v[38:39], v[192:193] op_sel_hi:[1,0]
  v_cvt_pk_bf16_f32 v32, v32, v33
  v_cvt_pk_bf16_f32 v33, v34, v35
  v_cvt_pk_bf16_f32 v34, v36, v37
  v_cvt_pk_bf16_f32 v35, v38, v39
  buffer_store_dwordx4 v[32:35], v244, s[24:27], s42 offen offset:1024 sc1
  v_accvgpr_read_b32 v40, a100
  v_accvgpr_read_b32 v41, a101
  v_accvgpr_read_b32 v42, a102
  v_accvgpr_read_b32 v43, a103
  v_accvgpr_read_b32 v44, a116
  v_accvgpr_read_b32 v45, a117
  v_accvgpr_read_b32 v46, a118
  v_accvgpr_read_b32 v47, a119
  v_pk_mul_f32 v[40:41], v[40:41], v[196:197] op_sel_hi:[1,0]
  v_pk_mul_f32 v[42:43], v[42:43], v[196:197] op_sel_hi:[1,0]
  v_pk_mul_f32 v[44:45], v[44:45], v[196:197] op_sel_hi:[1,0]
  v_pk_mul_f32 v[46:47], v[46:47], v[196:197] op_sel_hi:[1,0]
  v_cvt_pk_bf16_f32 v40, v40, v41
  v_cvt_pk_bf16_f32 v41, v42, v43
  v_cvt_pk_bf16_f32 v42, v44, v45
  v_cvt_pk_bf16_f32 v43, v46, v47
  buffer_store_dwordx4 v[40:43], v244, s[24:27], s42 offen offset:3072 sc1
  v_accvgpr_read_b32 v48, a104
  v_accvgpr_read_b32 v49, a105
  v_accvgpr_read_b32 v50, a106
  v_accvgpr_read_b32 v51, a107
  v_accvgpr_read_b32 v52, a120
  v_accvgpr_read_b32 v53, a121
  v_accvgpr_read_b32 v54, a122
  v_accvgpr_read_b32 v55, a123
  v_pk_mul_f32 v[48:49], v[48:49], v[200:201] op_sel_hi:[1,0]
  v_pk_mul_f32 v[50:51], v[50:51], v[200:201] op_sel_hi:[1,0]
  v_pk_mul_f32 v[52:53], v[52:53], v[200:201] op_sel_hi:[1,0]
  v_pk_mul_f32 v[54:55], v[54:55], v[200:201] op_sel_hi:[1,0]
  v_cvt_pk_bf16_f32 v48, v48, v49
  v_cvt_pk_bf16_f32 v49, v50, v51
  v_cvt_pk_bf16_f32 v50, v52, v53
  v_cvt_pk_bf16_f32 v51, v54, v55
  buffer_store_dwordx4 v[48:51], v244, s[24:27], s43 offen offset:1024 sc1
  v_accvgpr_read_b32 v56, a108
  v_accvgpr_read_b32 v57, a109
  v_accvgpr_read_b32 v58, a110
  v_accvgpr_read_b32 v59, a111
  v_accvgpr_read_b32 v60, a124
  v_accvgpr_read_b32 v61, a125
  v_accvgpr_read_b32 v62, a126
  v_accvgpr_read_b32 v63, a127
  v_pk_mul_f32 v[56:57], v[56:57], v[204:205] op_sel_hi:[1,0]
  v_pk_mul_f32 v[58:59], v[58:59], v[204:205] op_sel_hi:[1,0]
  v_pk_mul_f32 v[60:61], v[60:61], v[204:205] op_sel_hi:[1,0]
  v_pk_mul_f32 v[62:63], v[62:63], v[204:205] op_sel_hi:[1,0]
  v_cvt_pk_bf16_f32 v56, v56, v57
  v_cvt_pk_bf16_f32 v57, v58, v59
  v_cvt_pk_bf16_f32 v58, v60, v61
  v_cvt_pk_bf16_f32 v59, v62, v63
  buffer_store_dwordx4 v[56:59], v244, s[24:27], s43 offen offset:3072 sc1
  ds_write_b32 v247, v245
  buffer_load_dwordx4 a[0:3], v252, s[24:27], s5 offen offset:3072 sc1
  buffer_load_dwordx4 a[4:7], v253, s[24:27], s5 offen offset:0 sc1
  buffer_load_dwordx4 a[8:11], v253, s[24:27], s5 offen offset:1024 sc1
  buffer_load_dwordx4 a[12:15], v253, s[24:27], s5 offen offset:2048 sc1
  buffer_load_dwordx4 a[16:19], v253, s[24:27], s5 offen offset:3072 sc1
  buffer_load_dwordx4 a[20:23], v242, s[24:27], s6 offen offset:0 sc1
  buffer_load_dwordx4 a[24:27], v242, s[24:27], s6 offen offset:1024 sc1
  buffer_load_dwordx4 a[28:31], v242, s[24:27], s6 offen offset:2048 sc1
  buffer_load_dwordx4 a[32:35], v242, s[24:27], s6 offen offset:3072 sc1
  buffer_load_dwordx4 a[36:39], v252, s[24:27], s6 offen offset:0 sc1
  buffer_load_dwordx4 a[40:43], v252, s[24:27], s6 offen offset:1024 sc1
  buffer_load_dwordx4 a[44:47], v252, s[24:27], s6 offen offset:2048 sc1
  buffer_load_dwordx4 a[48:51], v252, s[24:27], s6 offen offset:3072 sc1
  buffer_load_dwordx4 a[52:55], v253, s[24:27], s6 offen offset:0 sc1
  s_bfe_u32 s39, s2, 0x40002
  s_lshl_b32 s39, s39, 8
  s_add_u32 s39, s39, 2818304
  s_lshl_b32 s38, s3, 26
  v_lshlrev_b32 v64, 22, v242
  v_or_b32 v64, s38, v64
  v_mov_b32 v65, 1
  v_add_u32 v246, 157696, v242
  s_waitcnt vmcnt(14) lgkmcnt(0)
  s_barrier
  ds_read_b128 v[68:71], v246
  s_waitcnt lgkmcnt(0)
  v_or3_b32 v68, v68, v69, v70
  v_or_b32 v68, v68, v71
  v_cmp_ne_u32 vcc, 0, v68
  s_nop 0
  s_cbranch_vccnz attn_redo
tail_go:
  buffer_atomic_add v65, v64, s[24:27], s39 offen
  s_and_b32 s36, s2, 1
  s_bfe_u32 s31, s2, 0x20001
  s_lshl_b32 s31, s31, 2
  s_bfe_u32 s38, s2, 0x20003
  s_add_u32 s31, s31, s38
  s_lshr_b32 s29, s2, 5
  v_mov_b32 v114, v242
  v_add_u32 v115, 0x1000, v114
  v_add_u32 v116, 0x2000, v114
  s_lshl_b32 s38, s36, 2
  s_add_u32 s38, s38, s3
  s_lshl_b32 s30, s38, 16
  buffer_load_dwordx4 a[56:59], v116, s[24:27], s6 offen offset:1024 sc1
  buffer_load_dwordx4 a[60:63], v116, s[24:27], s6 offen offset:2048 sc1
  buffer_load_dwordx4 a[64:67], v116, s[24:27], s6 offen offset:3072 sc1
  buffer_load_dwordx4 a[68:71], v114, s[24:27], s7 offen offset:0 sc1
  buffer_load_dwordx4 a[72:75], v114, s[24:27], s7 offen offset:1024 sc1
  buffer_load_dwordx4 a[76:79], v114, s[24:27], s7 offen offset:2048 sc1
  v_lshrrev_b32 v125, 4, v114
  v_and_b32 v126, 15, v125
  v_lshrrev_b32 v127, 4, v125
  s_add_u32 s38, s3, 0
  s_and_b32 s38, s38, 3
  s_lshl_b32 s38, s38, 11
  v_add_u32 v110, s38, v114
  s_sub_u32 s38, s3, 0
  s_and_b32 s38, s38, 3
  s_mul_i32 s38, s38, 15360
  s_add_u32 s38, s38, 98304
  v_add_u32 v118, s38, v114
  s_add_u32 s38, s3, 1
  s_and_b32 s38, s38, 3
  s_lshl_b32 s38, s38, 11
  v_add_u32 v111, s38, v114
  s_sub_u32 s38, s3, 1
  s_and_b32 s38, s38, 3
  s_mul_i32 s38, s38, 15360
  s_add_u32 s38, s38, 98304
  v_add_u32 v119, s38, v114
  s_add_u32 s38, s3, 2
  s_and_b32 s38, s38, 3
  s_lshl_b32 s38, s38, 11
  v_add_u32 v112, s38, v114
  s_sub_u32 s38, s3, 2
  s_and_b32 s38, s38, 3
  s_mul_i32 s38, s38, 15360
  s_add_u32 s38, s38, 98304
  v_add_u32 v120, s38, v114
  s_add_u32 s38, s3, 3
  s_and_b32 s38, s38, 3
  s_lshl_b32 s38, s38, 11
  v_add_u32 v113, s38, v114
  s_sub_u32 s38, s3, 3
  s_and_b32 s38, s38, 3
  s_mul_i32 s38, s38, 15360
  s_add_u32 s38, s38, 98304
  v_add_u32 v121, s38, v114
  v_add_u32 v122, s28, v114
  v_add_u32 v135, 0x10000, v122
  s_and_b32 s38, s31, 14
  s_add_u32 s38, s38, s36
  s_lshl_b32 s38, s38, 8
  s_add_u32 s38, s38, 2818304
  s_lshl_b32 s39, s29, 8
  s_add_u32 s39, s39, 2822400
  v_mov_b32 v133, s38
  v_writelane_b32 v133, s39, 1
  v_mov_b32 v134, 16
  v_writelane_b32 v134, 30, 1
  s_lshl_b32 s31, s31, 1
  s_add_u32 s31, s31, s36
  s_add_u32 s30, s30, 8388608
  s_lshl_b32 s38, s31, 19
  s_add_u32 s37, s30, s38
  s_xor_b32 s38, s38, 0x80000
  s_add_u32 s30, s30, s38
  s_lshl_b32 s40, s29, 5
  s_add_u32 s40, s40, s31
  s_lshl_b32 s38, s31, 6
  s_lshl_b32 s39, s3, 4
  s_add_u32 s38, s38, s39
  v_add_u32 v128, s38, v126
  v_mul_u32_u24 v117, 0x500, v128
  v_lshl_add_u32 v117, v127, 3, v117
  s_mul_i32 s38, s29, 160
  v_add_u32 v117, s38, v117
  s_mov_b32 s12, s60
  s_mov_b32 s13, s61
  s_mov_b32 s14, 2621440
  s_mov_b32 s15, 0x20000
  s_mov_b32 s16, s62
  s_mov_b32 s17, s63
  s_mov_b32 s18, 2621440
  s_mov_b32 s19, 0x20000
  s_mul_i32 s38, s31, 81920
  s_lshl_b32 s39, s3, 10
  s_add_u32 s38, s38, s39
  s_mul_i32 s39, s29, 10
  v_lshrrev_b32 v129, 1, v127
  v_add_u32 v129, s39, v129
  v_and_b32 v130, 1, v127
  v_lshlrev_b32 v130, 3, v130
  v_lshl_add_u32 v130, v126, 4, v130
  v_lshrrev_b32 v131, 2, v129
  v_lshl_add_u32 v131, v131, 12, v130
  v_and_b32 v132, 3, v129
  v_lshl_add_u32 v131, v132, 8, v131
  buffer_load_dwordx2 v[156:157], v131, s[24:27], s38 offen sc1
  v_add_u32 v129, 2, v129
  buffer_load_dwordx2 v[80:81], v117, s[12:15], 0 offen offset:0
  v_lshrrev_b32 v131, 2, v129
  v_lshl_add_u32 v131, v131, 12, v130
  v_and_b32 v132, 3, v129
  v_lshl_add_u32 v131, v132, 8, v131
  buffer_load_dwordx2 v[158:159], v131, s[24:27], s38 offen sc1
  v_add_u32 v129, 2, v129
  buffer_load_dwordx2 v[82:83], v117, s[12:15], 0 offen offset:32
  v_lshrrev_b32 v131, 2, v129
  v_lshl_add_u32 v131, v131, 12, v130
  v_and_b32 v132, 3, v129
  v_lshl_add_u32 v131, v132, 8, v131
  buffer_load_dwordx2 v[160:161], v131, s[24:27], s38 offen sc1
  v_add_u32 v129, 2, v129
  buffer_load_dwordx2 v[84:85], v117, s[12:15], 0 offen offset:64
  v_lshrrev_b32 v131, 2, v129
  v_lshl_add_u32 v131, v131, 12, v130
  v_and_b32 v132, 3, v129
  v_lshl_add_u32 v131, v132, 8, v131
  buffer_load_dwordx2 v[162:163], v131, s[24:27], s38 offen sc1
  v_add_u32 v129, 2, v129
  buffer_load_dwordx2 v[86:87], v117, s[12:15], 0 offen offset:96
  v_lshrrev_b32 v131, 2, v129
  v_lshl_add_u32 v131, v131, 12, v130
  v_and_b32 v132, 3, v129
  v_lshl_add_u32 v131, v132, 8, v131
  buffer_load_dwordx2 v[164:165], v131, s[24:27], s38 offen sc1
  v_add_u32 v129, 2, v129
  buffer_load_dwordx2 v[88:89], v117, s[12:15], 0 offen offset:128
  v_mov_b32 v123, 1073741824
  v_bfrev_b32 v124, 1
  v_sub_u32 v128, 0xffff, v128
  s_mov_b32 s34, 0xffff0000
  s_and_b32 s38, s52, 0xffff
  v_cmp_eq_u32 vcc, s38, v128
  v_mov_b32 v129, s52
  v_mov_b32 v130, 0
  v_cndmask_b32 v124, v124, v129, vcc
  v_cndmask_b32 v123, v123, v130, vcc
  s_and_b32 s38, s53, 0xffff
  v_cmp_eq_u32 vcc, s38, v128
  v_mov_b32 v129, s53
  v_mov_b32 v130, 2560
  v_cndmask_b32 v124, v124, v129, vcc
  v_cndmask_b32 v123, v123, v130, vcc
  s_and_b32 s38, s54, 0xffff
  v_cmp_eq_u32 vcc, s38, v128
  v_mov_b32 v129, s54
  v_mov_b32 v130, 5120
  v_cndmask_b32 v124, v124, v129, vcc
  v_cndmask_b32 v123, v123, v130, vcc
  s_and_b32 s38, s55, 0xffff
  v_cmp_eq_u32 vcc, s38, v128
  v_mov_b32 v129, s55
  v_mov_b32 v130, 7680
  v_cndmask_b32 v124, v124, v129, vcc
  v_cndmask_b32 v123, v123, v130, vcc
  s_and_b32 s38, s56, 0xffff
  v_cmp_eq_u32 vcc, s38, v128
  v_mov_b32 v129, s56
  v_mov_b32 v130, 10240
  v_cndmask_b32 v124, v124, v129, vcc
  v_cndmask_b32 v123, v123, v130, vcc
  s_and_b32 s38, s57, 0xffff
  v_cmp_eq_u32 vcc, s38, v128
  v_mov_b32 v129, s57
  v_mov_b32 v130, 12800
  v_cndmask_b32 v124, v124, v129, vcc
  v_cndmask_b32 v123, v123, v130, vcc
  s_and_b32 s38, s58, 0xffff
  v_cmp_eq_u32 vcc, s38, v128
  v_mov_b32 v129, s58
  v_mov_b32 v130, 15360
  v_cndmask_b32 v124, v124, v129, vcc
  v_cndmask_b32 v123, v123, v130, vcc
  s_and_b32 s38, s59, 0xffff
  v_cmp_eq_u32 vcc, s38, v128
  v_mov_b32 v129, s59
  v_mov_b32 v130, 17920
  v_cndmask_b32 v124, v124, v129, vcc
  v_cndmask_b32 v123, v123, v130, vcc
  v_lshl_add_u32 v123, v127, 4, v123
  s_mul_i32 s32, s29, 320
  s_add_u32 s32, s32, 2686976
  v_ashrrev_i32 v129, 31, v124
  v_not_b32 v129, v129
  v_or_b32 v129, 0x80000000, v129
  v_xor_b32 v124, v124, v129
  v_and_b32 v124, s34, v124
  v_mul_f32 v124, 0xbfb8aa3b, v124
  v_exp_f32 v124, v124
  s_nop 0
  v_add_f32 v124, 1.0, v124
  v_rcp_f32 v124, v124
  s_nop 0
  v_cvt_pk_bf16_f32 v124, v124, v124
  v_lshlrev_b32 v124, 16, v124
  buffer_load_dword v128, v133, s[24:27], 0 offen sc1
  buffer_load_dwordx4 a[80:83], v114, s[24:27], s7 offen offset:3072 sc1
  buffer_load_dwordx4 a[84:87], v115, s[24:27], s7 offen offset:0 sc1
  buffer_load_dwordx4 a[88:91], v115, s[24:27], s7 offen offset:1024 sc1
  buffer_load_dwordx4 a[92:95], v115, s[24:27], s7 offen offset:2048 sc1
  buffer_load_dwordx4 a[96:99], v115, s[24:27], s7 offen offset:3072 sc1
  buffer_load_dwordx4 a[100:103], v116, s[24:27], s7 offen offset:0 sc1
  s_waitcnt vmcnt(16)
  v_lshlrev_b32 v90, 16, v156
  v_and_b32 v91, s34, v156
  v_lshlrev_b32 v92, 16, v157
  v_and_b32 v93, s34, v157
  s_waitcnt vmcnt(14)
  v_lshlrev_b32 v94, 16, v158
  v_and_b32 v95, s34, v158
  v_lshlrev_b32 v96, 16, v159
  v_and_b32 v97, s34, v159
  s_waitcnt vmcnt(12)
  v_lshlrev_b32 v98, 16, v160
  v_and_b32 v99, s34, v160
  v_lshlrev_b32 v100, 16, v161
  v_and_b32 v101, s34, v161
  s_waitcnt vmcnt(10)
  v_lshlrev_b32 v102, 16, v162
  v_and_b32 v103, s34, v162
  v_lshlrev_b32 v104, 16, v163
  v_and_b32 v105, s34, v163
  s_waitcnt vmcnt(8)
  v_lshlrev_b32 v106, 16, v164
  v_and_b32 v107, s34, v164
  v_lshlrev_b32 v108, 16, v165
  v_and_b32 v109, s34, v165
  v_mov_b32 v156, 0
  v_mov_b32 v157, 0
  v_mov_b32 v158, 0
  v_mov_b32 v159, 0
  v_mov_b32 v160, 0
  v_mov_b32 v161, 0
  v_mov_b32 v162, 0
  v_mov_b32 v163, 0
  v_mov_b32 v164, 0
  v_mov_b32 v165, 0
  v_mov_b32 v166, 0
  v_mov_b32 v167, 0
  v_mov_b32 v168, 0
  v_mov_b32 v169, 0
  v_mov_b32 v170, 0
  v_mov_b32 v171, 0
  v_mov_b32 v172, 0
  v_mov_b32 v173, 0
  v_mov_b32 v174, 0
  v_mov_b32 v175, 0
  s_waitcnt vmcnt(6)
  v_cmp_lt_u32 vcc, v128, v134
  s_nop 0
  s_cbranch_vccz tail_ready
  s_mov_b32 s35, 32768
tail_spin:
  s_sleep 2
  buffer_load_dword v128, v133, s[24:27], 0 offen sc1
  s_waitcnt vmcnt(0)
  v_cmp_lt_u32 vcc, v128, v134
  s_nop 0
  s_cbranch_vccz tail_ready
  s_sub_u32 s35, s35, 1
  s_cmp_lg_u32 s35, 0
  s_cbranch_scc1 tail_spin
tail_ready:
  buffer_load_dwordx4 a[180:183], v110, s[24:27], s30 offen offset:0 sc1
  buffer_load_dwordx4 a[184:187], v110, s[24:27], s30 offen offset:1024 sc1
  buffer_load_dwordx4 a[188:191], v111, s[24:27], s30 offen offset:0 sc1
  buffer_load_dwordx4 a[192:195], v111, s[24:27], s30 offen offset:1024 sc1
  buffer_load_dwordx4 a[196:199], v112, s[24:27], s30 offen offset:0 sc1
  buffer_load_dwordx4 a[200:203], v112, s[24:27], s30 offen offset:1024 sc1
  buffer_load_dwordx4 a[204:207], v113, s[24:27], s30 offen offset:0 sc1
  buffer_load_dwordx4 a[208:211], v113, s[24:27], s30 offen offset:1024 sc1
  v_cmp_gt_u32 vcc, 1073741824, v123
  s_nop 0
  s_and_saveexec_b64 s[42:43], vcc
  s_cbranch_execz tail_plain
  s_waitcnt vmcnt(30)
  buffer_load_dwordx4 v[156:159], v123, s[24:27], s32 offen offset:0 sc1
  buffer_load_dwordx4 v[160:163], v123, s[24:27], s32 offen offset:64 sc1
  buffer_load_dwordx4 v[164:167], v123, s[24:27], s32 offen offset:128 sc1
  buffer_load_dwordx4 v[168:171], v123, s[24:27], s32 offen offset:192 sc1
  buffer_load_dwordx4 v[172:175], v123, s[24:27], s32 offen offset:256 sc1
  s_add_u32 s32, s32, 20480
  buffer_load_dwordx4 v[136:139], v123, s[24:27], s32 offen offset:0 sc1
  buffer_load_dwordx4 v[140:143], v123, s[24:27], s32 offen offset:64 sc1
  buffer_load_dwordx4 v[144:147], v123, s[24:27], s32 offen offset:128 sc1
  buffer_load_dwordx4 v[148:151], v123, s[24:27], s32 offen offset:192 sc1
  buffer_load_dwordx4 v[152:155], v123, s[24:27], s32 offen offset:256 sc1
  s_add_u32 s32, s32, 20480
  buffer_load_dwordx4 v[0:3], v123, s[24:27], s32 offen offset:0 sc1
  buffer_load_dwordx4 v[4:7], v123, s[24:27], s32 offen offset:64 sc1
  buffer_load_dwordx4 v[8:11], v123, s[24:27], s32 offen offset:128 sc1
  buffer_load_dwordx4 v[12:15], v123, s[24:27], s32 offen offset:192 sc1
  buffer_load_dwordx4 v[16:19], v123, s[24:27], s32 offen offset:256 sc1
  s_add_u32 s32, s32, 20480
  buffer_load_dwordx4 v[20:23], v123, s[24:27], s32 offen offset:0 sc1
  buffer_load_dwordx4 v[24:27], v123, s[24:27], s32 offen offset:64 sc1
  buffer_load_dwordx4 v[28:31], v123, s[24:27], s32 offen offset:128 sc1
  buffer_load_dwordx4 v[32:35], v123, s[24:27], s32 offen offset:192 sc1
  buffer_load_dwordx4 v[36:39], v123, s[24:27], s32 offen offset:256 sc1
  s_add_u32 s32, s32, 20480
  buffer_load_dwordx4 v[40:43], v123, s[24:27], s32 offen offset:0 sc1
  buffer_load_dwordx4 v[44:47], v123, s[24:27], s32 offen offset:64 sc1
  buffer_load_dwordx4 v[48:51], v123, s[24:27], s32 offen offset:128 sc1
  buffer_load_dwordx4 v[52:55], v123, s[24:27], s32 offen offset:192 sc1
  buffer_load_dwordx4 v[56:59], v123, s[24:27], s32 offen offset:256 sc1
  s_add_u32 s32, s32, 20480
  buffer_load_dwordx4 v[60:63], v123, s[24:27], s32 offen offset:0 sc1
  buffer_load_dwordx4 v[64:67], v123, s[24:27], s32 offen offset:64 sc1
  buffer_load_dwordx4 v[68:71], v123, s[24:27], s32 offen offset:128 sc1
  buffer_load_dwordx4 v[72:75], v123, s[24:27], s32 offen offset:192 sc1
  buffer_load_dwordx4 v[76:79], v123, s[24:27], s32 offen offset:256 sc1
  s_add_u32 s32, s32, 20480
  s_waitcnt vmcnt(0)
  v_add_f32 v156, v156, v136
  v_add_f32 v157, v157, v137
  v_add_f32 v158, v158, v138
  v_add_f32 v159, v159, v139
  v_add_f32 v160, v160, v140
  v_add_f32 v161, v161, v141
  v_add_f32 v162, v162, v142
  v_add_f32 v163, v163, v143
  v_add_f32 v164, v164, v144
  v_add_f32 v165, v165, v145
  v_add_f32 v166, v166, v146
  v_add_f32 v167, v167, v147
  v_add_f32 v168, v168, v148
  v_add_f32 v169, v169, v149
  v_add_f32 v170, v170, v150
  v_add_f32 v171, v171, v151
  v_add_f32 v172, v172, v152
  v_add_f32 v173, v173, v153
  v_add_f32 v174, v174, v154
  v_add_f32 v175, v175, v155
  v_add_f32 v156, v156, v0
  v_add_f32 v157, v157, v1
  v_add_f32 v158, v158, v2
  v_add_f32 v159, v159, v3
  v_add_f32 v160, v160, v4
  v_add_f32 v161, v161, v5
  v_add_f32 v162, v162, v6
  v_add_f32 v163, v163, v7
  v_add_f32 v164, v164, v8
  v_add_f32 v165, v165, v9
  v_add_f32 v166, v166, v10
  v_add_f32 v167, v167, v11
  v_add_f32 v168, v168, v12
  v_add_f32 v169, v169, v13
  v_add_f32 v170, v170, v14
  v_add_f32 v171, v171, v15
  v_add_f32 v172, v172, v16
  v_add_f32 v173, v173, v17
  v_add_f32 v174, v174, v18
  v_add_f32 v175, v175, v19
  v_add_f32 v156, v156, v20
  v_add_f32 v157, v157, v21
  v_add_f32 v158, v158, v22
  v_add_f32 v159, v159, v23
  v_add_f32 v160, v160, v24
  v_add_f32 v161, v161, v25
  v_add_f32 v162, v162, v26
  v_add_f32 v163, v163, v27
  v_add_f32 v164, v164, v28
  v_add_f32 v165, v165, v29
  v_add_f32 v166, v166, v30
  v_add_f32 v167, v167, v31
  v_add_f32 v168, v168, v32
  v_add_f32 v169, v169, v33
  v_add_f32 v170, v170, v34
  v_add_f32 v171, v171, v35
  v_add_f32 v172, v172, v36
  v_add_f32 v173, v173, v37
  v_add_f32 v174, v174, v38
  v_add_f32 v175, v175, v39
  v_add_f32 v156, v156, v40
  v_add_f32 v157, v157, v41
  v_add_f32 v158, v158, v42
  v_add_f32 v159, v159, v43
  v_add_f32 v160, v160, v44
  v_add_f32 v161, v161, v45
  v_add_f32 v162, v162, v46
  v_add_f32 v163, v163, v47
  v_add_f32 v164, v164, v48
  v_add_f32 v165, v165, v49
  v_add_f32 v166, v166, v50
  v_add_f32 v167, v167, v51
  v_add_f32 v168, v168, v52
  v_add_f32 v169, v169, v53
  v_add_f32 v170, v170, v54
  v_add_f32 v171, v171, v55
  v_add_f32 v172, v172, v56
  v_add_f32 v173, v173, v57
  v_add_f32 v174, v174, v58
  v_add_f32 v175, v175, v59
  v_add_f32 v156, v156, v60
  v_add_f32 v157, v157, v61
  v_add_f32 v158, v158, v62
  v_add_f32 v159, v159, v63
  v_add_f32 v160, v160, v64
  v_add_f32 v161, v161, v65
  v_add_f32 v162, v162, v66
  v_add_f32 v163, v163, v67
  v_add_f32 v164, v164, v68
  v_add_f32 v165, v165, v69
  v_add_f32 v166, v166, v70
  v_add_f32 v167, v167, v71
  v_add_f32 v168, v168, v72
  v_add_f32 v169, v169, v73
  v_add_f32 v170, v170, v74
  v_add_f32 v171, v171, v75
  v_add_f32 v172, v172, v76
  v_add_f32 v173, v173, v77
  v_add_f32 v174, v174, v78
  v_add_f32 v175, v175, v79
tail_plain:
  s_mov_b64 exec, s[42:43]
  s_waitcnt vmcnt(0)
  v_mfma_f32_16x16x32_bf16 v[0:3], a[212:215], a[180:183], 0
  s_add_u32 s30, s30, 8192
  buffer_load_dwordx4 v[176:179], v110, s[24:27], s30 offen offset:0 sc1
  v_mfma_f32_16x16x32_bf16 v[0:3], a[232:235], a[184:187], v[0:3]
  v_cvt_pk_bf16_f32 v156, v156, v156
  v_cvt_pk_bf16_f32 v157, v157, v157
  v_mfma_f32_16x16x32_bf16 v[4:7], a[232:235], a[192:195], 0
  buffer_load_dwordx4 a[104:107], v116, s[24:27], s7 offen offset:1024 sc1
  v_mfma_f32_16x16x32_bf16 v[4:7], a[212:215], a[188:191], v[4:7]
  v_cvt_pk_bf16_f32 v158, v158, v158
  v_cvt_pk_bf16_f32 v159, v159, v159
  v_mfma_f32_16x16x32_bf16 v[8:11], a[212:215], a[196:199], 0
  buffer_load_dwordx4 v[180:183], v110, s[24:27], s30 offen offset:1024 sc1
  v_mfma_f32_16x16x32_bf16 v[8:11], a[232:235], a[200:203], v[8:11]
  v_lshlrev_b32 v156, 16, v156
  v_lshlrev_b32 v157, 16, v157
  v_mfma_f32_16x16x32_bf16 v[12:15], a[232:235], a[208:211], 0
  v_lshlrev_b32 v158, 16, v158
  v_lshlrev_b32 v159, 16, v159
  v_mfma_f32_16x16x32_bf16 v[12:15], a[212:215], a[204:207], v[12:15]
  v_mul_f32 v156, v156, v124
  v_mul_f32 v157, v157, v124
  v_mfma_f32_16x16x32_bf16 v[16:19], a[216:219], a[180:183], 0
  buffer_load_dwordx4 v[184:187], v111, s[24:27], s30 offen offset:0 sc1
  v_mfma_f32_16x16x32_bf16 v[16:19], a[236:239], a[184:187], v[16:19]
  v_mul_f32 v158, v158, v124
  v_mul_f32 v159, v159, v124
  v_mfma_f32_16x16x32_bf16 v[20:23], a[236:239], a[192:195], 0
  buffer_load_dwordx4 a[108:111], v116, s[24:27], s7 offen offset:2048 sc1
  v_mfma_f32_16x16x32_bf16 v[20:23], a[216:219], a[188:191], v[20:23]
  v_cvt_pk_bf16_f32 v156, v156, v156
  v_cvt_pk_bf16_f32 v157, v157, v157
  v_mfma_f32_16x16x32_bf16 v[24:27], a[216:219], a[196:199], 0
  buffer_load_dwordx4 v[188:191], v111, s[24:27], s30 offen offset:1024 sc1
  v_mfma_f32_16x16x32_bf16 v[24:27], a[236:239], a[200:203], v[24:27]
  v_cvt_pk_bf16_f32 v158, v158, v158
  v_cvt_pk_bf16_f32 v159, v159, v159
  v_mfma_f32_16x16x32_bf16 v[28:31], a[236:239], a[208:211], 0
  v_lshlrev_b32 v156, 16, v156
  v_lshlrev_b32 v157, 16, v157
  v_mfma_f32_16x16x32_bf16 v[28:31], a[216:219], a[204:207], v[28:31]
  v_lshlrev_b32 v158, 16, v158
  v_lshlrev_b32 v159, 16, v159
  v_mfma_f32_16x16x32_bf16 v[32:35], a[220:223], a[180:183], 0
  buffer_load_dwordx4 v[192:195], v112, s[24:27], s30 offen offset:0 sc1
  v_mfma_f32_16x16x32_bf16 v[32:35], a[240:243], a[184:187], v[32:35]
  v_add_f32 v90, v90, v156
  v_add_f32 v91, v91, v157
  v_mfma_f32_16x16x32_bf16 v[36:39], a[240:243], a[192:195], 0
  buffer_load_dwordx4 a[112:115], v116, s[24:27], s7 offen offset:3072 sc1
  v_mfma_f32_16x16x32_bf16 v[36:39], a[220:223], a[188:191], v[36:39]
  v_add_f32 v92, v92, v158
  v_add_f32 v93, v93, v159
  v_mfma_f32_16x16x32_bf16 v[40:43], a[220:223], a[196:199], 0
  buffer_load_dwordx4 v[196:199], v112, s[24:27], s30 offen offset:1024 sc1
  v_mfma_f32_16x16x32_bf16 v[40:43], a[240:243], a[200:203], v[40:43]
  v_cvt_pk_bf16_f32 v90, v90, v90
  v_cvt_pk_bf16_f32 v91, v91, v91
  v_mfma_f32_16x16x32_bf16 v[44:47], a[240:243], a[208:211], 0
  v_cvt_pk_bf16_f32 v92, v92, v92
  v_cvt_pk_bf16_f32 v93, v93, v93
  v_mfma_f32_16x16x32_bf16 v[44:47], a[220:223], a[204:207], v[44:47]
  v_lshlrev_b32 v90, 16, v90
  v_lshlrev_b32 v91, 16, v91
  v_mfma_f32_16x16x32_bf16 v[48:51], a[224:227], a[180:183], 0
  buffer_load_dwordx4 v[200:203], v113, s[24:27], s30 offen offset:0 sc1
  v_mfma_f32_16x16x32_bf16 v[48:51], a[244:247], a[184:187], v[48:51]
  v_lshlrev_b32 v92, 16, v92
  v_lshlrev_b32 v93, 16, v93
  v_mfma_f32_16x16x32_bf16 v[52:55], a[244:247], a[192:195], 0
  buffer_load_dwordx4 a[116:119], v114, s[24:27], s8 offen offset:0 sc1
  v_mfma_f32_16x16x32_bf16 v[52:55], a[224:227], a[188:191], v[52:55]
  v_mul_f32 v129, 0xbfb8aa3b, v90
  v_mul_f32 v130, 0xbfb8aa3b, v91
  v_mfma_f32_16x16x32_bf16 v[56:59], a[224:227], a[196:199], 0
  buffer_load_dwordx4 v[204:207], v113, s[24:27], s30 offen offset:1024 sc1
  v_mfma_f32_16x16x32_bf16 v[56:59], a[244:247], a[200:203], v[56:59]
  v_mul_f32 v131, 0xbfb8aa3b, v92
  v_mul_f32 v132, 0xbfb8aa3b, v93
  v_mfma_f32_16x16x32_bf16 v[60:63], a[244:247], a[208:211], 0
  v_exp_f32 v129, v129
  v_mfma_f32_16x16x32_bf16 v[60:63], a[224:227], a[204:207], v[60:63]
  v_exp_f32 v130, v130
  v_mfma_f32_16x16x32_bf16 v[64:67], a[228:231], a[180:183], 0
  s_add_u32 s30, s30, 8192
  buffer_load_dwordx4 v[208:211], v110, s[24:27], s30 offen offset:0 sc1
  v_mfma_f32_16x16x32_bf16 v[64:67], a[248:251], a[184:187], v[64:67]
  v_exp_f32 v131, v131
  v_mfma_f32_16x16x32_bf16 v[68:71], a[248:251], a[192:195], 0
  buffer_load_dwordx4 a[120:123], v114, s[24:27], s8 offen offset:1024 sc1
  v_mfma_f32_16x16x32_bf16 v[68:71], a[228:231], a[188:191], v[68:71]
  v_exp_f32 v132, v132
  v_mfma_f32_16x16x32_bf16 v[72:75], a[228:231], a[196:199], 0
  buffer_load_dwordx4 v[212:215], v110, s[24:27], s30 offen offset:1024 sc1
  v_mfma_f32_16x16x32_bf16 v[72:75], a[248:251], a[200:203], v[72:75]
  v_add_f32 v129, 1.0, v129
  v_add_f32 v130, 1.0, v130
  v_mfma_f32_16x16x32_bf16 v[76:79], a[248:251], a[208:211], 0
  v_add_f32 v131, 1.0, v131
  v_add_f32 v132, 1.0, v132
  v_mfma_f32_16x16x32_bf16 v[76:79], a[228:231], a[204:207], v[76:79]
  v_rcp_f32 v129, v129
  s_waitcnt vmcnt(3)
  v_mfma_f32_16x16x32_bf16 v[0:3], a[252:255], v[176:179], v[0:3]
  buffer_load_dwordx4 v[216:219], v111, s[24:27], s30 offen offset:0 sc1
  v_mfma_f32_16x16x32_bf16 v[0:3], a[144:147], v[180:183], v[0:3]
  v_rcp_f32 v130, v130
  v_mfma_f32_16x16x32_bf16 v[4:7], a[144:147], v[188:191], v[4:7]
  buffer_load_dwordx4 a[124:127], v114, s[24:27], s8 offen offset:2048 sc1
  v_mfma_f32_16x16x32_bf16 v[4:7], a[252:255], v[184:187], v[4:7]
  v_rcp_f32 v131, v131
  v_mfma_f32_16x16x32_bf16 v[8:11], a[252:255], v[192:195], v[8:11]
  buffer_load_dwordx4 v[220:223], v111, s[24:27], s30 offen offset:1024 sc1
  v_mfma_f32_16x16x32_bf16 v[8:11], a[144:147], v[196:199], v[8:11]
  v_rcp_f32 v132, v132
  v_mfma_f32_16x16x32_bf16 v[12:15], a[144:147], v[204:207], v[12:15]
  v_mul_f32 v90, v90, v129
  v_mul_f32 v91, v91, v130
  v_mfma_f32_16x16x32_bf16 v[12:15], a[252:255], v[200:203], v[12:15]
  v_mul_f32 v92, v92, v131
  v_mul_f32 v93, v93, v132
  v_mfma_f32_16x16x32_bf16 v[16:19], a[128:131], v[176:179], v[16:19]
  buffer_load_dwordx4 v[224:227], v112, s[24:27], s30 offen offset:0 sc1
  v_mfma_f32_16x16x32_bf16 v[16:19], a[148:151], v[180:183], v[16:19]
  v_cvt_pk_bf16_f32 v90, v90, v90
  v_cvt_pk_bf16_f32 v91, v91, v91
  v_mfma_f32_16x16x32_bf16 v[20:23], a[148:151], v[188:191], v[20:23]
  buffer_load_dwordx4 a[160:163], v114, s[24:27], s8 offen offset:3072 sc1
  v_mfma_f32_16x16x32_bf16 v[20:23], a[128:131], v[184:187], v[20:23]
  v_cvt_pk_bf16_f32 v92, v92, v92
  v_cvt_pk_bf16_f32 v93, v93, v93
  v_mfma_f32_16x16x32_bf16 v[24:27], a[128:131], v[192:195], v[24:27]
  buffer_load_dwordx4 v[228:231], v112, s[24:27], s30 offen offset:1024 sc1
  v_mfma_f32_16x16x32_bf16 v[24:27], a[148:151], v[196:199], v[24:27]
  v_lshlrev_b32 v90, 16, v90
  v_lshlrev_b32 v91, 16, v91
  v_mfma_f32_16x16x32_bf16 v[28:31], a[148:151], v[204:207], v[28:31]
  v_lshlrev_b32 v92, 16, v92
  v_lshlrev_b32 v93, 16, v93
  v_mfma_f32_16x16x32_bf16 v[28:31], a[128:131], v[200:203], v[28:31]
  v_cvt_pk_bf16_f32 v160, v160, v160
  v_cvt_pk_bf16_f32 v161, v161, v161
  v_mfma_f32_16x16x32_bf16 v[32:35], a[132:135], v[176:179], v[32:35]
  buffer_load_dwordx4 v[232:235], v113, s[24:27], s30 offen offset:0 sc1
  v_mfma_f32_16x16x32_bf16 v[32:35], a[152:155], v[180:183], v[32:35]
  v_cvt_pk_bf16_f32 v162, v162, v162
  v_cvt_pk_bf16_f32 v163, v163, v163
  v_mfma_f32_16x16x32_bf16 v[36:39], a[152:155], v[188:191], v[36:39]
  buffer_load_dwordx4 a[164:167], v115, s[24:27], s8 offen offset:0 sc1
  v_mfma_f32_16x16x32_bf16 v[36:39], a[132:135], v[184:187], v[36:39]
  v_lshlrev_b32 v160, 16, v160
  v_lshlrev_b32 v161, 16, v161
  v_mfma_f32_16x16x32_bf16 v[40:43], a[132:135], v[192:195], v[40:43]
  buffer_load_dwordx4 v[236:239], v113, s[24:27], s30 offen offset:1024 sc1
  v_mfma_f32_16x16x32_bf16 v[40:43], a[152:155], v[196:199], v[40:43]
  v_lshlrev_b32 v162, 16, v162
  v_lshlrev_b32 v163, 16, v163
  v_mfma_f32_16x16x32_bf16 v[44:47], a[152:155], v[204:207], v[44:47]
  v_mul_f32 v160, v160, v124
  v_mul_f32 v161, v161, v124
  v_mfma_f32_16x16x32_bf16 v[44:47], a[132:135], v[200:203], v[44:47]
  v_mul_f32 v162, v162, v124
  v_mul_f32 v163, v163, v124
  v_mfma_f32_16x16x32_bf16 v[48:51], a[136:139], v[176:179], v[48:51]
  s_add_u32 s30, s30, 8192
  buffer_load_dwordx4 v[240:243], v110, s[24:27], s30 offen offset:0 sc1
  v_mfma_f32_16x16x32_bf16 v[48:51], a[156:159], v[180:183], v[48:51]
  v_cvt_pk_bf16_f32 v160, v160, v160
  v_cvt_pk_bf16_f32 v161, v161, v161
  v_mfma_f32_16x16x32_bf16 v[52:55], a[156:159], v[188:191], v[52:55]
  buffer_load_dwordx4 a[168:171], v115, s[24:27], s8 offen offset:1024 sc1
  v_mfma_f32_16x16x32_bf16 v[52:55], a[136:139], v[184:187], v[52:55]
  v_cvt_pk_bf16_f32 v162, v162, v162
  v_cvt_pk_bf16_f32 v163, v163, v163
  v_mfma_f32_16x16x32_bf16 v[56:59], a[136:139], v[192:195], v[56:59]
  buffer_load_dwordx4 v[244:247], v110, s[24:27], s30 offen offset:1024 sc1
  v_mfma_f32_16x16x32_bf16 v[56:59], a[156:159], v[196:199], v[56:59]
  v_lshlrev_b32 v160, 16, v160
  v_lshlrev_b32 v161, 16, v161
  v_mfma_f32_16x16x32_bf16 v[60:63], a[156:159], v[204:207], v[60:63]
  v_lshlrev_b32 v162, 16, v162
  v_lshlrev_b32 v163, 16, v163
  v_mfma_f32_16x16x32_bf16 v[60:63], a[136:139], v[200:203], v[60:63]
  v_add_f32 v94, v94, v160
  v_add_f32 v95, v95, v161
  v_mfma_f32_16x16x32_bf16 v[64:67], a[140:143], v[176:179], v[64:67]
  buffer_load_dwordx4 v[248:251], v111, s[24:27], s30 offen offset:0 sc1
  v_mfma_f32_16x16x32_bf16 v[64:67], a[0:3], v[180:183], v[64:67]
  v_add_f32 v96, v96, v162
  v_add_f32 v97, v97, v163
  v_mfma_f32_16x16x32_bf16 v[68:71], a[0:3], v[188:191], v[68:71]
  buffer_load_dwordx4 a[172:175], v115, s[24:27], s8 offen offset:2048 sc1
  v_mfma_f32_16x16x32_bf16 v[68:71], a[140:143], v[184:187], v[68:71]
  v_cvt_pk_bf16_f32 v94, v94, v94
  v_cvt_pk_bf16_f32 v95, v95, v95
  v_mfma_f32_16x16x32_bf16 v[72:75], a[140:143], v[192:195], v[72:75]
  buffer_load_dwordx4 v[252:255], v111, s[24:27], s30 offen offset:1024 sc1
  v_mfma_f32_16x16x32_bf16 v[72:75], a[0:3], v[196:199], v[72:75]
  v_cvt_pk_bf16_f32 v96, v96, v96
  v_cvt_pk_bf16_f32 v97, v97, v97
  v_mfma_f32_16x16x32_bf16 v[76:79], a[0:3], v[204:207], v[76:79]
  v_lshlrev_b32 v94, 16, v94
  v_lshlrev_b32 v95, 16, v95
  v_mfma_f32_16x16x32_bf16 v[76:79], a[140:143], v[200:203], v[76:79]
  v_lshlrev_b32 v96, 16, v96
  v_lshlrev_b32 v97, 16, v97
  s_waitcnt vmcnt(6)
  v_mfma_f32_16x16x32_bf16 v[0:3], a[4:7], v[208:211], v[0:3]
  buffer_load_dwordx4 v[136:139], v112, s[24:27], s30 offen offset:0 sc1
  v_mfma_f32_16x16x32_bf16 v[0:3], a[24:27], v[212:215], v[0:3]
  v_mul_f32 v129, 0xbfb8aa3b, v94
  v_mul_f32 v130, 0xbfb8aa3b, v95
  v_mfma_f32_16x16x32_bf16 v[4:7], a[24:27], v[220:223], v[4:7]
  buffer_load_dwordx4 a[176:179], v115, s[24:27], s8 offen offset:3072 sc1
  v_mfma_f32_16x16x32_bf16 v[4:7], a[4:7], v[216:219], v[4:7]
  v_mul_f32 v131, 0xbfb8aa3b, v96
  v_mul_f32 v132, 0xbfb8aa3b, v97
  v_mfma_f32_16x16x32_bf16 v[8:11], a[4:7], v[224:227], v[8:11]
  buffer_load_dwordx4 v[140:143], v112, s[24:27], s30 offen offset:1024 sc1
  v_mfma_f32_16x16x32_bf16 v[8:11], a[24:27], v[228:231], v[8:11]
  v_exp_f32 v129, v129
  v_mfma_f32_16x16x32_bf16 v[12:15], a[24:27], v[236:239], v[12:15]
  v_exp_f32 v130, v130
  v_mfma_f32_16x16x32_bf16 v[12:15], a[4:7], v[232:235], v[12:15]
  v_exp_f32 v131, v131
  v_mfma_f32_16x16x32_bf16 v[16:19], a[8:11], v[208:211], v[16:19]
  buffer_load_dwordx4 v[144:147], v113, s[24:27], s30 offen offset:0 sc1
  v_mfma_f32_16x16x32_bf16 v[16:19], a[28:31], v[212:215], v[16:19]
  v_exp_f32 v132, v132
  v_mfma_f32_16x16x32_bf16 v[20:23], a[28:31], v[220:223], v[20:23]
  s_add_u32 m0, s28, 49152
  s_nop 0
  buffer_load_dwordx4 v115, s[24:27], s10 offen offset:0 sc1 lds
  v_mfma_f32_16x16x32_bf16 v[20:23], a[8:11], v[216:219], v[20:23]
  buffer_load_dwordx4 v115, s[24:27], s10 offen offset:1024 sc1 lds
  v_mfma_f32_16x16x32_bf16 v[24:27], a[8:11], v[224:227], v[24:27]
  buffer_load_dwordx4 v115, s[24:27], s10 offen offset:2048 sc1 lds
  v_mfma_f32_16x16x32_bf16 v[24:27], a[28:31], v[228:231], v[24:27]
  buffer_load_dwordx4 v115, s[24:27], s10 offen offset:3072 sc1 lds
  v_mfma_f32_16x16x32_bf16 v[28:31], a[28:31], v[236:239], v[28:31]
  buffer_load_dwordx4 v[148:151], v113, s[24:27], s30 offen offset:1024 sc1
  v_mfma_f32_16x16x32_bf16 v[28:31], a[8:11], v[232:235], v[28:31]
  v_add_f32 v129, 1.0, v129
  v_add_f32 v130, 1.0, v130
  v_mfma_f32_16x16x32_bf16 v[32:35], a[12:15], v[208:211], v[32:35]
  s_add_u32 s30, s30, 8192
  buffer_load_dwordx4 v[152:155], v110, s[24:27], s30 offen offset:0 sc1
  v_mfma_f32_16x16x32_bf16 v[32:35], a[32:35], v[212:215], v[32:35]
  v_add_f32 v131, 1.0, v131
  v_add_f32 v132, 1.0, v132
  v_mfma_f32_16x16x32_bf16 v[36:39], a[32:35], v[220:223], v[36:39]
  v_rcp_f32 v129, v129
  v_mfma_f32_16x16x32_bf16 v[36:39], a[12:15], v[216:219], v[36:39]
  v_rcp_f32 v130, v130
  v_mfma_f32_16x16x32_bf16 v[40:43], a[12:15], v[224:227], v[40:43]
  buffer_load_dwordx4 a[180:183], v110, s[24:27], s30 offen offset:1024 sc1
  v_mfma_f32_16x16x32_bf16 v[40:43], a[32:35], v[228:231], v[40:43]
  v_rcp_f32 v131, v131
  v_mfma_f32_16x16x32_bf16 v[44:47], a[32:35], v[236:239], v[44:47]
  v_rcp_f32 v132, v132
  v_mfma_f32_16x16x32_bf16 v[44:47], a[12:15], v[232:235], v[44:47]
  v_mul_f32 v94, v94, v129
  v_mul_f32 v95, v95, v130
  v_mfma_f32_16x16x32_bf16 v[48:51], a[16:19], v[208:211], v[48:51]
  buffer_load_dwordx4 a[184:187], v111, s[24:27], s30 offen offset:0 sc1
  v_mfma_f32_16x16x32_bf16 v[48:51], a[36:39], v[212:215], v[48:51]
  v_mul_f32 v96, v96, v131
  v_mul_f32 v97, v97, v132
  v_mfma_f32_16x16x32_bf16 v[52:55], a[36:39], v[220:223], v[52:55]
  v_cvt_pk_bf16_f32 v94, v94, v94
  v_cvt_pk_bf16_f32 v95, v95, v95
  v_mfma_f32_16x16x32_bf16 v[52:55], a[16:19], v[216:219], v[52:55]
  v_cvt_pk_bf16_f32 v96, v96, v96
  v_cvt_pk_bf16_f32 v97, v97, v97
  v_mfma_f32_16x16x32_bf16 v[56:59], a[16:19], v[224:227], v[56:59]
  buffer_load_dwordx4 a[188:191], v111, s[24:27], s30 offen offset:1024 sc1
  v_mfma_f32_16x16x32_bf16 v[56:59], a[36:39], v[228:231], v[56:59]
  v_lshlrev_b32 v94, 16, v94
  v_lshlrev_b32 v95, 16, v95
  v_mfma_f32_16x16x32_bf16 v[60:63], a[36:39], v[236:239], v[60:63]
  v_lshlrev_b32 v96, 16, v96
  v_lshlrev_b32 v97, 16, v97
  v_mfma_f32_16x16x32_bf16 v[60:63], a[16:19], v[232:235], v[60:63]
  v_cvt_pk_bf16_f32 v164, v164, v164
  v_cvt_pk_bf16_f32 v165, v165, v165
  v_mfma_f32_16x16x32_bf16 v[64:67], a[20:23], v[208:211], v[64:67]
  buffer_load_dwordx4 a[192:195], v112, s[24:27], s30 offen offset:0 sc1
  v_mfma_f32_16x16x32_bf16 v[64:67], a[40:43], v[212:215], v[64:67]
  v_cvt_pk_bf16_f32 v166, v166, v166
  v_cvt_pk_bf16_f32 v167, v167, v167
  v_mfma_f32_16x16x32_bf16 v[68:71], a[40:43], v[220:223], v[68:71]
  v_lshlrev_b32 v164, 16, v164
  v_lshlrev_b32 v165, 16, v165
  v_mfma_f32_16x16x32_bf16 v[68:71], a[20:23], v[216:219], v[68:71]
  v_lshlrev_b32 v166, 16, v166
  v_lshlrev_b32 v167, 16, v167
  v_mfma_f32_16x16x32_bf16 v[72:75], a[20:23], v[224:227], v[72:75]
  buffer_load_dwordx4 a[196:199], v112, s[24:27], s30 offen offset:1024 sc1
  v_mfma_f32_16x16x32_bf16 v[72:75], a[40:43], v[228:231], v[72:75]
  v_mul_f32 v164, v164, v124
  v_mul_f32 v165, v165, v124
  v_mfma_f32_16x16x32_bf16 v[76:79], a[40:43], v[236:239], v[76:79]
  v_mul_f32 v166, v166, v124
  v_mul_f32 v167, v167, v124
  v_mfma_f32_16x16x32_bf16 v[76:79], a[20:23], v[232:235], v[76:79]
  v_cvt_pk_bf16_f32 v164, v164, v164
  v_cvt_pk_bf16_f32 v165, v165, v165
  s_waitcnt vmcnt(6)
  v_mfma_f32_16x16x32_bf16 v[0:3], a[44:47], v[240:243], v[0:3]
  buffer_load_dwordx4 a[200:203], v113, s[24:27], s30 offen offset:0 sc1
  v_mfma_f32_16x16x32_bf16 v[0:3], a[64:67], v[244:247], v[0:3]
  v_cvt_pk_bf16_f32 v166, v166, v166
  v_cvt_pk_bf16_f32 v167, v167, v167
  v_mfma_f32_16x16x32_bf16 v[4:7], a[64:67], v[252:255], v[4:7]
  v_lshlrev_b32 v164, 16, v164
  v_lshlrev_b32 v165, 16, v165
  v_mfma_f32_16x16x32_bf16 v[4:7], a[44:47], v[248:251], v[4:7]
  v_lshlrev_b32 v166, 16, v166
  v_lshlrev_b32 v167, 16, v167
  v_mfma_f32_16x16x32_bf16 v[8:11], a[44:47], v[136:139], v[8:11]
  buffer_load_dwordx4 a[204:207], v113, s[24:27], s30 offen offset:1024 sc1
  v_mfma_f32_16x16x32_bf16 v[8:11], a[64:67], v[140:143], v[8:11]
  v_add_f32 v98, v98, v164
  v_add_f32 v99, v99, v165
  v_mfma_f32_16x16x32_bf16 v[12:15], a[64:67], v[148:151], v[12:15]
  v_add_f32 v100, v100, v166
  v_add_f32 v101, v101, v167
  v_mfma_f32_16x16x32_bf16 v[12:15], a[44:47], v[144:147], v[12:15]
  v_cvt_pk_bf16_f32 v98, v98, v98
  v_cvt_pk_bf16_f32 v99, v99, v99
  v_mfma_f32_16x16x32_bf16 v[16:19], a[48:51], v[240:243], v[16:19]
  s_add_u32 s30, s30, 8192
  buffer_load_dwordx4 a[208:211], v110, s[24:27], s30 offen offset:0 sc1
  v_mfma_f32_16x16x32_bf16 v[16:19], a[68:71], v[244:247], v[16:19]
  v_cvt_pk_bf16_f32 v100, v100, v100
  v_cvt_pk_bf16_f32 v101, v101, v101
  v_mfma_f32_16x16x32_bf16 v[20:23], a[68:71], v[252:255], v[20:23]
  v_lshlrev_b32 v98, 16, v98
  v_lshlrev_b32 v99, 16, v99
  v_mfma_f32_16x16x32_bf16 v[20:23], a[48:51], v[248:251], v[20:23]
  v_lshlrev_b32 v100, 16, v100
  v_lshlrev_b32 v101, 16, v101
  v_mfma_f32_16x16x32_bf16 v[24:27], a[48:51], v[136:139], v[24:27]
  buffer_load_dwordx4 v[176:179], v110, s[24:27], s30 offen offset:1024 sc1
  v_mfma_f32_16x16x32_bf16 v[24:27], a[68:71], v[140:143], v[24:27]
  v_mul_f32 v129, 0xbfb8aa3b, v98
  v_mul_f32 v130, 0xbfb8aa3b, v99
  v_mfma_f32_16x16x32_bf16 v[28:31], a[68:71], v[148:151], v[28:31]
  v_mul_f32 v131, 0xbfb8aa3b, v100
  v_mul_f32 v132, 0xbfb8aa3b, v101
  v_mfma_f32_16x16x32_bf16 v[28:31], a[48:51], v[144:147], v[28:31]
  v_exp_f32 v129, v129
  v_mfma_f32_16x16x32_bf16 v[32:35], a[52:55], v[240:243], v[32:35]
  buffer_load_dwordx4 v[180:183], v111, s[24:27], s30 offen offset:0 sc1
  v_mfma_f32_16x16x32_bf16 v[32:35], a[72:75], v[244:247], v[32:35]
  v_exp_f32 v130, v130
  v_mfma_f32_16x16x32_bf16 v[36:39], a[72:75], v[252:255], v[36:39]
  v_exp_f32 v131, v131
  v_mfma_f32_16x16x32_bf16 v[36:39], a[52:55], v[248:251], v[36:39]
  v_exp_f32 v132, v132
  v_mfma_f32_16x16x32_bf16 v[40:43], a[52:55], v[136:139], v[40:43]
  buffer_load_dwordx4 v[184:187], v111, s[24:27], s30 offen offset:1024 sc1
  v_mfma_f32_16x16x32_bf16 v[40:43], a[72:75], v[140:143], v[40:43]
  v_add_f32 v129, 1.0, v129
  v_add_f32 v130, 1.0, v130
  v_mfma_f32_16x16x32_bf16 v[44:47], a[72:75], v[148:151], v[44:47]
  v_add_f32 v131, 1.0, v131
  v_add_f32 v132, 1.0, v132
  v_mfma_f32_16x16x32_bf16 v[44:47], a[52:55], v[144:147], v[44:47]
  v_rcp_f32 v129, v129
  v_mfma_f32_16x16x32_bf16 v[48:51], a[56:59], v[240:243], v[48:51]
  buffer_load_dwordx4 v[188:191], v112, s[24:27], s30 offen offset:0 sc1
  v_mfma_f32_16x16x32_bf16 v[48:51], a[76:79], v[244:247], v[48:51]
  v_rcp_f32 v130, v130
  v_mfma_f32_16x16x32_bf16 v[52:55], a[76:79], v[252:255], v[52:55]
  v_rcp_f32 v131, v131
  v_mfma_f32_16x16x32_bf16 v[52:55], a[56:59], v[248:251], v[52:55]
  v_rcp_f32 v132, v132
  v_mfma_f32_16x16x32_bf16 v[56:59], a[56:59], v[136:139], v[56:59]
  buffer_load_dwordx4 v[192:195], v112, s[24:27], s30 offen offset:1024 sc1
  v_mfma_f32_16x16x32_bf16 v[56:59], a[76:79], v[140:143], v[56:59]
  v_mul_f32 v98, v98, v129
  v_mul_f32 v99, v99, v130
  v_mfma_f32_16x16x32_bf16 v[60:63], a[76:79], v[148:151], v[60:63]
  v_mul_f32 v100, v100, v131
  v_mul_f32 v101, v101, v132
  v_mfma_f32_16x16x32_bf16 v[60:63], a[56:59], v[144:147], v[60:63]
  v_cvt_pk_bf16_f32 v98, v98, v98
  v_cvt_pk_bf16_f32 v99, v99, v99
  v_mfma_f32_16x16x32_bf16 v[64:67], a[60:63], v[240:243], v[64:67]
  buffer_load_dwordx4 v[196:199], v113, s[24:27], s30 offen offset:0 sc1
  v_mfma_f32_16x16x32_bf16 v[64:67], a[80:83], v[244:247], v[64:67]
  v_cvt_pk_bf16_f32 v100, v100, v100
  v_cvt_pk_bf16_f32 v101, v101, v101
  v_mfma_f32_16x16x32_bf16 v[68:71], a[80:83], v[252:255], v[68:71]
  v_lshlrev_b32 v98, 16, v98
  v_lshlrev_b32 v99, 16, v99
  v_mfma_f32_16x16x32_bf16 v[68:71], a[60:63], v[248:251], v[68:71]
  v_lshlrev_b32 v100, 16, v100
  v_lshlrev_b32 v101, 16, v101
  v_mfma_f32_16x16x32_bf16 v[72:75], a[60:63], v[136:139], v[72:75]
  buffer_load_dwordx4 v[200:203], v113, s[24:27], s30 offen offset:1024 sc1
  v_mfma_f32_16x16x32_bf16 v[72:75], a[80:83], v[140:143], v[72:75]
  v_cvt_pk_bf16_f32 v168, v168, v168
  v_cvt_pk_bf16_f32 v169, v169, v169
  v_mfma_f32_16x16x32_bf16 v[76:79], a[80:83], v[148:151], v[76:79]
  v_cvt_pk_bf16_f32 v170, v170, v170
  v_cvt_pk_bf16_f32 v171, v171, v171
  v_mfma_f32_16x16x32_bf16 v[76:79], a[60:63], v[144:147], v[76:79]
  v_lshlrev_b32 v168, 16, v168
  v_lshlrev_b32 v169, 16, v169
  s_waitcnt vmcnt(8)
  v_mfma_f32_16x16x32_bf16 v[0:3], a[84:87], v[152:155], v[0:3]
  s_add_u32 s30, s30, 8192
  buffer_load_dwordx4 v[204:207], v110, s[24:27], s30 offen offset:0 sc1
  v_mfma_f32_16x16x32_bf16 v[0:3], a[104:107], a[180:183], v[0:3]
  v_lshlrev_b32 v170, 16, v170
  v_lshlrev_b32 v171, 16, v171
  v_mfma_f32_16x16x32_bf16 v[4:7], a[104:107], a[188:191], v[4:7]
  v_mul_f32 v168, v168, v124
  v_mul_f32 v169, v169, v124
  v_mfma_f32_16x16x32_bf16 v[4:7], a[84:87], a[184:187], v[4:7]
  v_mul_f32 v170, v170, v124
  v_mul_f32 v171, v171, v124
  v_mfma_f32_16x16x32_bf16 v[8:11], a[84:87], a[192:195], v[8:11]
  buffer_load_dwordx4 v[208:211], v110, s[24:27], s30 offen offset:1024 sc1
  v_mfma_f32_16x16x32_bf16 v[8:11], a[104:107], a[196:199], v[8:11]
  v_cvt_pk_bf16_f32 v168, v168, v168
  v_cvt_pk_bf16_f32 v169, v169, v169
  v_mfma_f32_16x16x32_bf16 v[12:15], a[104:107], a[204:207], v[12:15]
  v_cvt_pk_bf16_f32 v170, v170, v170
  v_cvt_pk_bf16_f32 v171, v171, v171
  v_mfma_f32_16x16x32_bf16 v[12:15], a[84:87], a[200:203], v[12:15]
  v_lshlrev_b32 v168, 16, v168
  v_lshlrev_b32 v169, 16, v169
  v_mfma_f32_16x16x32_bf16 v[16:19], a[88:91], v[152:155], v[16:19]
  buffer_load_dwordx4 v[212:215], v111, s[24:27], s30 offen offset:0 sc1
  v_mfma_f32_16x16x32_bf16 v[16:19], a[108:111], a[180:183], v[16:19]
  v_lshlrev_b32 v170, 16, v170
  v_lshlrev_b32 v171, 16, v171
  v_mfma_f32_16x16x32_bf16 v[20:23], a[108:111], a[188:191], v[20:23]
  v_add_f32 v102, v102, v168
  v_add_f32 v103, v103, v169
  v_mfma_f32_16x16x32_bf16 v[20:23], a[88:91], a[184:187], v[20:23]
  v_add_f32 v104, v104, v170
  v_add_f32 v105, v105, v171
  v_mfma_f32_16x16x32_bf16 v[24:27], a[88:91], a[192:195], v[24:27]
  buffer_load_dwordx4 v[216:219], v111, s[24:27], s30 offen offset:1024 sc1
  v_mfma_f32_16x16x32_bf16 v[24:27], a[108:111], a[196:199], v[24:27]
  v_cvt_pk_bf16_f32 v102, v102, v102
  v_cvt_pk_bf16_f32 v103, v103, v103
  v_mfma_f32_16x16x32_bf16 v[28:31], a[108:111], a[204:207], v[28:31]
  v_cvt_pk_bf16_f32 v104, v104, v104
  v_cvt_pk_bf16_f32 v105, v105, v105
  v_mfma_f32_16x16x32_bf16 v[28:31], a[88:91], a[200:203], v[28:31]
  v_lshlrev_b32 v102, 16, v102
  v_lshlrev_b32 v103, 16, v103
  v_mfma_f32_16x16x32_bf16 v[32:35], a[92:95], v[152:155], v[32:35]
  buffer_load_dwordx4 v[220:223], v112, s[24:27], s30 offen offset:0 sc1
  v_mfma_f32_16x16x32_bf16 v[32:35], a[112:115], a[180:183], v[32:35]
  v_lshlrev_b32 v104, 16, v104
  v_lshlrev_b32 v105, 16, v105
  v_mfma_f32_16x16x32_bf16 v[36:39], a[112:115], a[188:191], v[36:39]
  v_mul_f32 v129, 0xbfb8aa3b, v102
  v_mul_f32 v130, 0xbfb8aa3b, v103
  v_mfma_f32_16x16x32_bf16 v[36:39], a[92:95], a[184:187], v[36:39]
  v_mul_f32 v131, 0xbfb8aa3b, v104
  v_mul_f32 v132, 0xbfb8aa3b, v105
  v_mfma_f32_16x16x32_bf16 v[40:43], a[92:95], a[192:195], v[40:43]
  buffer_load_dwordx4 v[224:227], v112, s[24:27], s30 offen offset:1024 sc1
  v_mfma_f32_16x16x32_bf16 v[40:43], a[112:115], a[196:199], v[40:43]
  v_exp_f32 v129, v129
  v_mfma_f32_16x16x32_bf16 v[44:47], a[112:115], a[204:207], v[44:47]
  v_exp_f32 v130, v130
  v_mfma_f32_16x16x32_bf16 v[44:47], a[92:95], a[200:203], v[44:47]
  v_exp_f32 v131, v131
  v_mfma_f32_16x16x32_bf16 v[48:51], a[96:99], v[152:155], v[48:51]
  buffer_load_dwordx4 v[228:231], v113, s[24:27], s30 offen offset:0 sc1
  v_mfma_f32_16x16x32_bf16 v[48:51], a[116:119], a[180:183], v[48:51]
  v_exp_f32 v132, v132
  v_mfma_f32_16x16x32_bf16 v[52:55], a[116:119], a[188:191], v[52:55]
  v_add_f32 v129, 1.0, v129
  v_add_f32 v130, 1.0, v130
  v_mfma_f32_16x16x32_bf16 v[52:55], a[96:99], a[184:187], v[52:55]
  v_add_f32 v131, 1.0, v131
  v_add_f32 v132, 1.0, v132
  v_mfma_f32_16x16x32_bf16 v[56:59], a[96:99], a[192:195], v[56:59]
  buffer_load_dwordx4 v[232:235], v113, s[24:27], s30 offen offset:1024 sc1
  v_mfma_f32_16x16x32_bf16 v[56:59], a[116:119], a[196:199], v[56:59]
  v_rcp_f32 v129, v129
  v_mfma_f32_16x16x32_bf16 v[60:63], a[116:119], a[204:207], v[60:63]
  v_rcp_f32 v130, v130
  v_mfma_f32_16x16x32_bf16 v[60:63], a[96:99], a[200:203], v[60:63]
  v_rcp_f32 v131, v131
  v_mfma_f32_16x16x32_bf16 v[64:67], a[100:103], v[152:155], v[64:67]
  ds_read_b128 v[236:239], v122 offset:0
  s_add_u32 s30, s30, 8192
  v_rcp_f32 v132, v132
  v_mfma_f32_16x16x32_bf16 v[64:67], a[120:123], a[180:183], v[64:67]
  buffer_load_dwordx4 v[240:243], v110, s[24:27], s30 offen offset:0 sc1
  v_mfma_f32_16x16x32_bf16 v[68:71], a[120:123], a[188:191], v[68:71]
  v_mul_f32 v102, v102, v129
  v_mul_f32 v103, v103, v130
  v_mfma_f32_16x16x32_bf16 v[68:71], a[100:103], a[184:187], v[68:71]
  v_mul_f32 v104, v104, v131
  v_mul_f32 v105, v105, v132
  v_mfma_f32_16x16x32_bf16 v[72:75], a[100:103], a[192:195], v[72:75]
  buffer_load_dwordx4 v[244:247], v110, s[24:27], s30 offen offset:1024 sc1
  v_mfma_f32_16x16x32_bf16 v[72:75], a[120:123], a[196:199], v[72:75]
  v_cvt_pk_bf16_f32 v102, v102, v102
  v_cvt_pk_bf16_f32 v103, v103, v103
  v_mfma_f32_16x16x32_bf16 v[76:79], a[120:123], a[204:207], v[76:79]
  v_cvt_pk_bf16_f32 v104, v104, v104
  v_cvt_pk_bf16_f32 v105, v105, v105
  v_mfma_f32_16x16x32_bf16 v[76:79], a[100:103], a[200:203], v[76:79]
  v_lshlrev_b32 v102, 16, v102
  v_lshlrev_b32 v103, 16, v103
  s_waitcnt vmcnt(10)
  v_mfma_f32_16x16x32_bf16 v[0:3], a[124:127], a[208:211], v[0:3]
  ds_read_b128 v[248:251], v122 offset:1024
  v_lshlrev_b32 v104, 16, v104
  v_mfma_f32_16x16x32_bf16 v[0:3], a[176:179], v[176:179], v[0:3]
  buffer_load_dwordx4 v[252:255], v111, s[24:27], s30 offen offset:0 sc1
  v_mfma_f32_16x16x32_bf16 v[4:7], a[176:179], v[184:187], v[4:7]
  v_lshlrev_b32 v105, 16, v105
  v_cvt_pk_bf16_f32 v172, v172, v172
  v_mfma_f32_16x16x32_bf16 v[4:7], a[124:127], v[180:183], v[4:7]
  v_cvt_pk_bf16_f32 v173, v173, v173
  v_cvt_pk_bf16_f32 v174, v174, v174
  v_mfma_f32_16x16x32_bf16 v[8:11], a[124:127], v[188:191], v[8:11]
  buffer_load_dwordx4 v[136:139], v111, s[24:27], s30 offen offset:1024 sc1
  v_mfma_f32_16x16x32_bf16 v[8:11], a[176:179], v[192:195], v[8:11]
  v_cvt_pk_bf16_f32 v175, v175, v175
  v_lshlrev_b32 v172, 16, v172
  v_mfma_f32_16x16x32_bf16 v[12:15], a[176:179], v[200:203], v[12:15]
  v_lshlrev_b32 v173, 16, v173
  v_lshlrev_b32 v174, 16, v174
  v_mfma_f32_16x16x32_bf16 v[12:15], a[124:127], v[196:199], v[12:15]
  v_lshlrev_b32 v175, 16, v175
  v_mul_f32 v172, v172, v124
  s_waitcnt lgkmcnt(1)
  v_mfma_f32_16x16x32_bf16 v[16:19], a[160:163], a[208:211], v[16:19]
  ds_read_b128 v[140:143], v122 offset:2048
  v_mul_f32 v173, v173, v124
  v_mfma_f32_16x16x32_bf16 v[16:19], v[236:239], v[176:179], v[16:19]
  buffer_load_dwordx4 v[144:147], v112, s[24:27], s30 offen offset:0 sc1
  v_mfma_f32_16x16x32_bf16 v[20:23], v[236:239], v[184:187], v[20:23]
  v_mul_f32 v174, v174, v124
  v_mul_f32 v175, v175, v124
  v_mfma_f32_16x16x32_bf16 v[20:23], a[160:163], v[180:183], v[20:23]
  v_cvt_pk_bf16_f32 v172, v172, v172
  v_cvt_pk_bf16_f32 v173, v173, v173
  v_mfma_f32_16x16x32_bf16 v[24:27], a[160:163], v[188:191], v[24:27]
  buffer_load_dwordx4 v[148:151], v112, s[24:27], s30 offen offset:1024 sc1
  v_mfma_f32_16x16x32_bf16 v[24:27], v[236:239], v[192:195], v[24:27]
  v_cvt_pk_bf16_f32 v174, v174, v174
  v_cvt_pk_bf16_f32 v175, v175, v175
  v_mfma_f32_16x16x32_bf16 v[28:31], v[236:239], v[200:203], v[28:31]
  v_lshlrev_b32 v172, 16, v172
  v_lshlrev_b32 v173, 16, v173
  v_mfma_f32_16x16x32_bf16 v[28:31], a[160:163], v[196:199], v[28:31]
  v_lshlrev_b32 v174, 16, v174
  v_lshlrev_b32 v175, 16, v175
  s_waitcnt lgkmcnt(1)
  v_mfma_f32_16x16x32_bf16 v[32:35], a[164:167], a[208:211], v[32:35]
  ds_read_b128 v[152:155], v122 offset:3072
  v_add_f32 v106, v106, v172
  v_mfma_f32_16x16x32_bf16 v[32:35], v[248:251], v[176:179], v[32:35]
  buffer_load_dwordx4 a[180:183], v113, s[24:27], s30 offen offset:0 sc1
  v_mfma_f32_16x16x32_bf16 v[36:39], v[248:251], v[184:187], v[36:39]
  v_add_f32 v107, v107, v173
  v_add_f32 v108, v108, v174
  v_mfma_f32_16x16x32_bf16 v[36:39], a[164:167], v[180:183], v[36:39]
  v_add_f32 v109, v109, v175
  v_cvt_pk_bf16_f32 v106, v106, v106
  v_mfma_f32_16x16x32_bf16 v[40:43], a[164:167], v[188:191], v[40:43]
  buffer_load_dwordx4 a[184:187], v113, s[24:27], s30 offen offset:1024 sc1
  v_mfma_f32_16x16x32_bf16 v[40:43], v[248:251], v[192:195], v[40:43]
  v_cvt_pk_bf16_f32 v107, v107, v107
  v_cvt_pk_bf16_f32 v108, v108, v108
  v_mfma_f32_16x16x32_bf16 v[44:47], v[248:251], v[200:203], v[44:47]
  v_cvt_pk_bf16_f32 v109, v109, v109
  v_lshlrev_b32 v106, 16, v106
  v_mfma_f32_16x16x32_bf16 v[44:47], a[164:167], v[196:199], v[44:47]
  v_lshlrev_b32 v107, 16, v107
  v_lshlrev_b32 v108, 16, v108
  s_waitcnt lgkmcnt(1)
  v_mfma_f32_16x16x32_bf16 v[48:51], a[168:171], a[208:211], v[48:51]
  ds_read_b128 a[188:191], v122 offset:16384
  ds_read_b128 a[192:195], v122 offset:33792
  s_mov_b32 s30, s37
  v_mfma_f32_16x16x32_bf16 v[48:51], v[140:143], v[176:179], v[48:51]
  buffer_load_dwordx4 a[196:199], v110, s[24:27], s30 offen offset:0 sc1
  v_mfma_f32_16x16x32_bf16 v[52:55], v[140:143], v[184:187], v[52:55]
  v_lshlrev_b32 v109, 16, v109
  v_mul_f32 v129, 0xbfb8aa3b, v106
  v_mfma_f32_16x16x32_bf16 v[52:55], a[168:171], v[180:183], v[52:55]
  v_mul_f32 v130, 0xbfb8aa3b, v107
  v_mul_f32 v131, 0xbfb8aa3b, v108
  v_mfma_f32_16x16x32_bf16 v[56:59], a[168:171], v[188:191], v[56:59]
  buffer_load_dwordx4 a[200:203], v110, s[24:27], s30 offen offset:1024 sc1
  v_mfma_f32_16x16x32_bf16 v[56:59], v[140:143], v[192:195], v[56:59]
  v_mul_f32 v132, 0xbfb8aa3b, v109
  v_exp_f32 v129, v129
  v_mfma_f32_16x16x32_bf16 v[60:63], v[140:143], v[200:203], v[60:63]
  v_exp_f32 v130, v130
  v_mfma_f32_16x16x32_bf16 v[60:63], a[168:171], v[196:199], v[60:63]
  v_exp_f32 v131, v131
  s_waitcnt lgkmcnt(2)
  v_mfma_f32_16x16x32_bf16 v[64:67], a[172:175], a[208:211], v[64:67]
  ds_read_b128 a[204:207], v122 offset:17408
  ds_read_b128 v[236:239], v122 offset:34816
  v_mfma_f32_16x16x32_bf16 v[64:67], v[152:155], v[176:179], v[64:67]
  v_exp_f32 v132, v132
  v_mfma_f32_16x16x32_bf16 v[68:71], v[152:155], v[184:187], v[68:71]
  v_add_f32 v129, 1.0, v129
  v_add_f32 v130, 1.0, v130
  v_mfma_f32_16x16x32_bf16 v[68:71], a[172:175], v[180:183], v[68:71]
  v_add_f32 v131, 1.0, v131
  v_add_f32 v132, 1.0, v132
  v_mfma_f32_16x16x32_bf16 v[72:75], a[172:175], v[188:191], v[72:75]
  v_rcp_f32 v129, v129
  v_mfma_f32_16x16x32_bf16 v[72:75], v[152:155], v[192:195], v[72:75]
  v_rcp_f32 v130, v130
  v_mfma_f32_16x16x32_bf16 v[76:79], v[152:155], v[200:203], v[76:79]
  v_rcp_f32 v131, v131
  v_mfma_f32_16x16x32_bf16 v[76:79], a[172:175], v[196:199], v[76:79]
  v_rcp_f32 v132, v132
  s_waitcnt vmcnt(10) lgkmcnt(2)
  v_mfma_f32_16x16x32_bf16 v[0:3], a[188:191], v[204:207], v[0:3]
  ds_read_b128 v[248:251], v122 offset:18432
  ds_read_b128 v[140:143], v122 offset:35840
  v_mfma_f32_16x16x32_bf16 v[0:3], a[192:195], v[208:211], v[0:3]
  buffer_load_dwordx4 v[152:155], v111, s[24:27], s30 offen offset:0 sc1
  v_mfma_f32_16x16x32_bf16 v[4:7], a[192:195], v[216:219], v[4:7]
  v_mul_f32 v106, v106, v129
  v_mul_f32 v107, v107, v130
  v_mfma_f32_16x16x32_bf16 v[4:7], a[188:191], v[212:215], v[4:7]
  v_mul_f32 v108, v108, v131
  v_mul_f32 v109, v109, v132
  v_mfma_f32_16x16x32_bf16 v[8:11], a[188:191], v[220:223], v[8:11]
  buffer_load_dwordx4 a[208:211], v111, s[24:27], s30 offen offset:1024 sc1
  v_mfma_f32_16x16x32_bf16 v[8:11], a[192:195], v[224:227], v[8:11]
  v_cvt_pk_bf16_f32 v106, v106, v106
  v_cvt_pk_bf16_f32 v107, v107, v107
  v_mfma_f32_16x16x32_bf16 v[12:15], a[192:195], v[232:235], v[12:15]
  v_cvt_pk_bf16_f32 v108, v108, v108
  v_cvt_pk_bf16_f32 v109, v109, v109
  v_mfma_f32_16x16x32_bf16 v[12:15], a[188:191], v[228:231], v[12:15]
  v_lshlrev_b32 v106, 16, v106
  v_lshlrev_b32 v107, 16, v107
  s_waitcnt lgkmcnt(2)
  v_mfma_f32_16x16x32_bf16 v[16:19], a[204:207], v[204:207], v[16:19]
  ds_read_b128 v[176:179], v122 offset:19456
  ds_read_b128 v[180:183], v135 offset:0
  v_mfma_f32_16x16x32_bf16 v[16:19], v[236:239], v[208:211], v[16:19]
  buffer_load_dwordx4 v[184:187], v112, s[24:27], s30 offen offset:0 sc1
  v_mfma_f32_16x16x32_bf16 v[20:23], v[236:239], v[216:219], v[20:23]
  v_lshlrev_b32 v108, 16, v108
  v_lshlrev_b32 v109, 16, v109
  v_mfma_f32_16x16x32_bf16 v[20:23], a[204:207], v[212:215], v[20:23]
  v_lshlrev_b32 v156, 16, v80
  v_and_b32 v157, s34, v80
  v_mfma_f32_16x16x32_bf16 v[24:27], a[204:207], v[220:223], v[24:27]
  buffer_load_dwordx4 v[188:191], v112, s[24:27], s30 offen offset:1024 sc1
  v_mfma_f32_16x16x32_bf16 v[24:27], v[236:239], v[224:227], v[24:27]
  v_lshlrev_b32 v158, 16, v81
  v_and_b32 v159, s34, v81
  v_mfma_f32_16x16x32_bf16 v[28:31], v[236:239], v[232:235], v[28:31]
  v_lshlrev_b32 v160, 16, v82
  v_and_b32 v161, s34, v82
  v_mfma_f32_16x16x32_bf16 v[28:31], a[204:207], v[228:231], v[28:31]
  v_lshlrev_b32 v162, 16, v83
  v_and_b32 v163, s34, v83
  s_waitcnt lgkmcnt(2)
  v_mfma_f32_16x16x32_bf16 v[32:35], v[248:251], v[204:207], v[32:35]
  ds_read_b128 v[192:195], v122 offset:32768
  ds_read_b128 v[196:199], v135 offset:1024
  v_mfma_f32_16x16x32_bf16 v[32:35], v[140:143], v[208:211], v[32:35]
  buffer_load_dwordx4 v[200:203], v113, s[24:27], s30 offen offset:0 sc1
  v_mfma_f32_16x16x32_bf16 v[36:39], v[140:143], v[216:219], v[36:39]
  v_lshlrev_b32 v164, 16, v84
  v_and_b32 v165, s34, v84
  v_mfma_f32_16x16x32_bf16 v[36:39], v[248:251], v[212:215], v[36:39]
  v_lshlrev_b32 v166, 16, v85
  v_and_b32 v167, s34, v85
  v_mfma_f32_16x16x32_bf16 v[40:43], v[248:251], v[220:223], v[40:43]
  buffer_load_dwordx4 a[188:191], v113, s[24:27], s30 offen offset:1024 sc1
  v_mfma_f32_16x16x32_bf16 v[40:43], v[140:143], v[224:227], v[40:43]
  v_lshlrev_b32 v168, 16, v86
  v_and_b32 v169, s34, v86
  v_mfma_f32_16x16x32_bf16 v[44:47], v[140:143], v[232:235], v[44:47]
  v_lshlrev_b32 v170, 16, v87
  v_and_b32 v171, s34, v87
  v_mfma_f32_16x16x32_bf16 v[44:47], v[248:251], v[228:231], v[44:47]
  v_lshlrev_b32 v172, 16, v88
  v_and_b32 v173, s34, v88
  s_waitcnt lgkmcnt(2)
  v_mfma_f32_16x16x32_bf16 v[48:51], v[176:179], v[204:207], v[48:51]
  ds_read_b128 a[192:195], v135 offset:2048
  ds_read_b128 a[204:207], v135 offset:19456
  s_add_u32 s30, s30, 8192
  v_mfma_f32_16x16x32_bf16 v[48:51], v[180:183], v[208:211], v[48:51]
  buffer_load_dwordx4 v[236:239], v110, s[24:27], s30 offen offset:0 sc1
  v_mfma_f32_16x16x32_bf16 v[52:55], v[180:183], v[216:219], v[52:55]
  v_lshlrev_b32 v174, 16, v89
  v_and_b32 v175, s34, v89
  v_mfma_f32_16x16x32_bf16 v[52:55], v[176:179], v[212:215], v[52:55]
  s_sub_u32 s41, s3, 1
  s_and_b32 s41, s41, 3
  s_lshl_b32 s41, s41, 12
  v_add_u32 v80, s41, v114
  v_mfma_f32_16x16x32_bf16 v[56:59], v[176:179], v[220:223], v[56:59]
  s_sub_u32 s41, s3, 2
  s_and_b32 s41, s41, 3
  s_lshl_b32 s41, s41, 12
  v_add_u32 v81, s41, v114
  v_mfma_f32_16x16x32_bf16 v[56:59], v[180:183], v[224:227], v[56:59]
  s_sub_u32 s41, s3, 3
  s_and_b32 s41, s41, 3
  s_lshl_b32 s41, s41, 12
  v_add_u32 v82, s41, v114
  v_bfe_u32 v129, v114, 8, 1
  v_mfma_f32_16x16x32_bf16 v[60:63], v[180:183], v[232:235], v[60:63]
  v_mul_u32_u24 v129, 24, v129
  v_add_u32 v83, v117, v129
  v_mfma_f32_16x16x32_bf16 v[60:63], v[176:179], v[228:231], v[60:63]
  s_waitcnt lgkmcnt(2)
  v_mfma_f32_16x16x32_bf16 v[64:67], v[192:195], v[204:207], v[64:67]
  ds_read_b128 v[248:251], v135 offset:3072
  ds_read_b128 v[140:143], v122 offset:49152
  v_mfma_f32_16x16x32_bf16 v[64:67], v[196:199], v[208:211], v[64:67]
  v_mfma_f32_16x16x32_bf16 v[68:71], v[196:199], v[216:219], v[68:71]
  v_mfma_f32_16x16x32_bf16 v[68:71], v[192:195], v[212:215], v[68:71]
  v_mfma_f32_16x16x32_bf16 v[72:75], v[192:195], v[220:223], v[72:75]
  v_mfma_f32_16x16x32_bf16 v[72:75], v[196:199], v[224:227], v[72:75]
  v_mfma_f32_16x16x32_bf16 v[76:79], v[196:199], v[232:235], v[76:79]
  v_mfma_f32_16x16x32_bf16 v[76:79], v[192:195], v[228:231], v[76:79]
  s_waitcnt vmcnt(9) lgkmcnt(2)
  v_mfma_f32_16x16x32_bf16 v[0:3], a[192:195], v[240:243], v[0:3]
  ds_read_b128 v[176:179], v135 offset:16384
  ds_read_b128 v[180:183], v122 offset:50176
  s_xor_b32 s38, s40, 1
  v_mfma_f32_16x16x32_bf16 v[0:3], a[204:207], v[244:247], v[0:3]
  buffer_load_dwordx4 v[192:195], v110, s[24:27], s30 offen offset:1024 sc1
  s_lshl_b32 s38, s38, 2
  s_add_u32 s38, s38, s3
  s_lshl_b32 s38, s38, 13
  v_mfma_f32_16x16x32_bf16 v[4:7], a[204:207], v[136:139], v[4:7]
  s_add_u32 s38, s38, 25165824
  s_add_u32 s39, s38, 4096
  v_mfma_f32_16x16x32_bf16 v[4:7], a[192:195], v[252:255], v[4:7]
  v_mfma_f32_16x16x32_bf16 v[8:11], a[192:195], v[144:147], v[8:11]
  buffer_load_dwordx4 v[196:199], v111, s[24:27], s30 offen offset:0 sc1
  v_mfma_f32_16x16x32_bf16 v[8:11], a[204:207], v[148:151], v[8:11]
  v_mfma_f32_16x16x32_bf16 v[12:15], a[204:207], a[184:187], v[12:15]
  v_mfma_f32_16x16x32_bf16 v[12:15], a[192:195], a[180:183], v[12:15]
  s_waitcnt lgkmcnt(2)
  v_mfma_f32_16x16x32_bf16 v[16:19], v[248:251], v[240:243], v[16:19]
  ds_read_b128 v[204:207], v135 offset:17408
  ds_read_b128 v[208:211], v122 offset:51200
  v_mfma_f32_16x16x32_bf16 v[16:19], v[140:143], v[244:247], v[16:19]
  buffer_load_dwordx4 v[212:215], v111, s[24:27], s30 offen offset:1024 sc1
  v_mfma_f32_16x16x32_bf16 v[20:23], v[140:143], v[136:139], v[20:23]
  ds_write_b128 v118, v[4:7] offset:0
  ds_write_b128 v118, v[8:11] offset:5120
  v_mfma_f32_16x16x32_bf16 v[20:23], v[248:251], v[252:255], v[20:23]
  ds_write_b128 v118, v[12:15] offset:10240
  v_mfma_f32_16x16x32_bf16 v[24:27], v[248:251], v[144:147], v[24:27]
  buffer_load_dwordx4 v[216:219], v112, s[24:27], s30 offen offset:0 sc1
  v_mfma_f32_16x16x32_bf16 v[24:27], v[140:143], v[148:151], v[24:27]
  v_mfma_f32_16x16x32_bf16 v[28:31], v[140:143], a[184:187], v[28:31]
  v_mfma_f32_16x16x32_bf16 v[28:31], v[248:251], a[180:183], v[28:31]
  s_waitcnt lgkmcnt(5)
  v_mfma_f32_16x16x32_bf16 v[32:35], v[176:179], v[240:243], v[32:35]
  ds_read_b128 v[220:223], v135 offset:18432
  ds_read_b128 v[224:227], v122 offset:52224
  v_mfma_f32_16x16x32_bf16 v[32:35], v[180:183], v[244:247], v[32:35]
  buffer_load_dwordx4 v[228:231], v112, s[24:27], s30 offen offset:1024 sc1
  v_mfma_f32_16x16x32_bf16 v[36:39], v[180:183], v[136:139], v[36:39]
  ds_write_b128 v118, v[20:23] offset:1024
  ds_write_b128 v118, v[24:27] offset:6144
  v_mfma_f32_16x16x32_bf16 v[36:39], v[176:179], v[252:255], v[36:39]
  ds_write_b128 v118, v[28:31] offset:11264
  v_mfma_f32_16x16x32_bf16 v[40:43], v[176:179], v[144:147], v[40:43]
  buffer_load_dwordx4 v[232:235], v113, s[24:27], s30 offen offset:0 sc1
  v_mfma_f32_16x16x32_bf16 v[40:43], v[180:183], v[148:151], v[40:43]
  v_mfma_f32_16x16x32_bf16 v[44:47], v[180:183], a[184:187], v[44:47]
  v_mfma_f32_16x16x32_bf16 v[44:47], v[176:179], a[180:183], v[44:47]
  s_waitcnt lgkmcnt(8)
  v_mfma_f32_16x16x32_bf16 v[48:51], v[204:207], v[240:243], v[48:51]
  buffer_load_dwordx4 a[192:195], v113, s[24:27], s30 offen offset:1024 sc1
  v_mfma_f32_16x16x32_bf16 v[48:51], v[208:211], v[244:247], v[48:51]
  ds_write_b128 v118, v[36:39] offset:2048
  v_mfma_f32_16x16x32_bf16 v[52:55], v[208:211], v[136:139], v[52:55]
  ds_write_b128 v118, v[40:43] offset:7168
  v_mfma_f32_16x16x32_bf16 v[52:55], v[204:207], v[252:255], v[52:55]
  ds_write_b128 v118, v[44:47] offset:12288
  v_mfma_f32_16x16x32_bf16 v[56:59], v[204:207], v[144:147], v[56:59]
  s_add_u32 s30, s30, 8192
  buffer_load_dwordx4 a[204:207], v110, s[24:27], s30 offen offset:0 sc1
  v_mfma_f32_16x16x32_bf16 v[56:59], v[208:211], v[148:151], v[56:59]
  v_mfma_f32_16x16x32_bf16 v[60:63], v[208:211], a[184:187], v[60:63]
  v_mfma_f32_16x16x32_bf16 v[60:63], v[204:207], a[180:183], v[60:63]
  s_waitcnt lgkmcnt(6)
  v_mfma_f32_16x16x32_bf16 v[64:67], v[220:223], v[240:243], v[64:67]
  buffer_load_dwordx4 v[248:251], v110, s[24:27], s30 offen offset:1024 sc1
  v_mfma_f32_16x16x32_bf16 v[64:67], v[224:227], v[244:247], v[64:67]
  ds_write_b128 v118, v[52:55] offset:3072
  v_mfma_f32_16x16x32_bf16 v[68:71], v[224:227], v[136:139], v[68:71]
  ds_write_b128 v118, v[56:59] offset:8192
  v_mfma_f32_16x16x32_bf16 v[68:71], v[220:223], v[252:255], v[68:71]
  ds_write_b128 v118, v[60:63] offset:13312
  v_mfma_f32_16x16x32_bf16 v[72:75], v[220:223], v[144:147], v[72:75]
  buffer_load_dwordx4 v[140:143], v111, s[24:27], s30 offen offset:0 sc1
  v_mfma_f32_16x16x32_bf16 v[72:75], v[224:227], v[148:151], v[72:75]
  v_mfma_f32_16x16x32_bf16 v[76:79], v[224:227], a[184:187], v[76:79]
  v_mfma_f32_16x16x32_bf16 v[76:79], v[220:223], a[180:183], v[76:79]
  s_nop 1
  ds_write_b128 v118, v[68:71] offset:4096
  s_nop 2
  ds_write_b128 v118, v[72:75] offset:9216
  s_nop 0
  ds_write_b128 v118, v[76:79] offset:14336
  buffer_load_dwordx4 v[176:179], v111, s[24:27], s30 offen offset:1024 sc1
  buffer_load_dwordx4 v[180:183], v112, s[24:27], s30 offen offset:0 sc1
  buffer_load_dwordx4 v[204:207], v112, s[24:27], s30 offen offset:1024 sc1
  buffer_load_dwordx4 v[208:211], v113, s[24:27], s30 offen offset:0 sc1
  buffer_load_dwordx4 v[220:223], v113, s[24:27], s30 offen offset:1024 sc1
  s_add_u32 s30, s30, 8192
  buffer_load_dwordx4 v[224:227], v110, s[24:27], s30 offen offset:0 sc1
  buffer_load_dwordx4 v[240:243], v110, s[24:27], s30 offen offset:1024 sc1
  buffer_load_dwordx4 v[244:247], v111, s[24:27], s30 offen offset:0 sc1
  buffer_load_dwordx4 v[252:255], v111, s[24:27], s30 offen offset:1024 sc1
  buffer_load_dwordx4 v[136:139], v112, s[24:27], s30 offen offset:0 sc1
  buffer_load_dwordx4 v[144:147], v112, s[24:27], s30 offen offset:1024 sc1
  buffer_load_dwordx4 v[148:151], v113, s[24:27], s30 offen offset:0 sc1
  buffer_load_dwordx4 a[180:183], v113, s[24:27], s30 offen offset:1024 sc1
  s_add_u32 s30, s30, 8192
  buffer_load_dwordx4 a[184:187], v110, s[24:27], s30 offen offset:0 sc1
  s_waitcnt lgkmcnt(0)
  s_barrier
  ds_read_b128 v[4:7], v119 offset:0
  ds_read_b128 v[8:11], v120 offset:5120
  ds_read_b128 v[12:15], v121 offset:10240
  ds_read_b128 v[20:23], v119 offset:1024
  ds_read_b128 v[24:27], v120 offset:6144
  ds_read_b128 v[28:31], v121 offset:11264
  ds_read_b128 v[36:39], v119 offset:2048
  ds_read_b128 v[40:43], v120 offset:7168
  ds_read_b128 v[44:47], v121 offset:12288
  ds_read_b128 v[52:55], v119 offset:3072
  ds_read_b128 v[56:59], v120 offset:8192
  ds_read_b128 v[60:63], v121 offset:13312
  ds_read_b128 v[68:71], v119 offset:4096
  ds_read_b128 v[72:75], v120 offset:9216
  ds_read_b128 v[76:79], v121 offset:14336
  s_waitcnt lgkmcnt(12)
  v_add_f32 v4, v4, v8
  v_add_f32 v5, v5, v9
  v_add_f32 v6, v6, v10
  v_add_f32 v7, v7, v11
  v_add_f32 v0, v0, v12
  v_add_f32 v1, v1, v13
  v_add_f32 v2, v2, v14
  v_add_f32 v3, v3, v15
  v_add_f32 v0, v0, v4
  v_add_f32 v1, v1, v5
  v_add_f32 v2, v2, v6
  v_add_f32 v3, v3, v7
  buffer_store_dwordx4 v[0:3], v114, s[24:27], s38 offen offset:0 sc1
  s_waitcnt vmcnt(26)
  s_nop 0
  v_mfma_f32_16x16x32_bf16 v[0:3], a[212:215], a[196:199], 0
  s_waitcnt lgkmcnt(9)
  v_add_f32 v20, v20, v24
  v_add_f32 v21, v21, v25
  v_mfma_f32_16x16x32_bf16 v[0:3], a[232:235], a[200:203], v[0:3]
  v_add_f32 v22, v22, v26
  v_add_f32 v23, v23, v27
  v_mfma_f32_16x16x32_bf16 v[4:7], a[232:235], a[208:211], 0
  v_add_f32 v16, v16, v28
  v_add_f32 v17, v17, v29
  v_mfma_f32_16x16x32_bf16 v[4:7], a[212:215], v[152:155], v[4:7]
  v_add_f32 v18, v18, v30
  v_add_f32 v19, v19, v31
  v_mfma_f32_16x16x32_bf16 v[8:11], a[212:215], v[184:187], 0
  v_add_f32 v16, v16, v20
  v_add_f32 v17, v17, v21
  v_mfma_f32_16x16x32_bf16 v[8:11], a[232:235], v[188:191], v[8:11]
  v_add_f32 v18, v18, v22
  v_add_f32 v19, v19, v23
  v_mfma_f32_16x16x32_bf16 v[12:15], a[232:235], a[188:191], 0
  buffer_store_dwordx4 v[16:19], v114, s[24:27], s38 offen offset:1024 sc1
  s_waitcnt lgkmcnt(6)
  v_mfma_f32_16x16x32_bf16 v[12:15], a[212:215], v[200:203], v[12:15]
  v_add_f32 v36, v36, v40
  v_add_f32 v37, v37, v41
  v_mfma_f32_16x16x32_bf16 v[16:19], a[216:219], a[196:199], 0
  buffer_load_dwordx4 a[212:215], v110, s[24:27], s30 offen offset:1024 sc1
  v_mfma_f32_16x16x32_bf16 v[16:19], a[236:239], a[200:203], v[16:19]
  v_add_f32 v38, v38, v42
  v_add_f32 v39, v39, v43
  v_mfma_f32_16x16x32_bf16 v[20:23], a[236:239], a[208:211], 0
  v_add_f32 v32, v32, v44
  v_add_f32 v33, v33, v45
  v_mfma_f32_16x16x32_bf16 v[20:23], a[216:219], v[152:155], v[20:23]
  v_add_f32 v34, v34, v46
  v_add_f32 v35, v35, v47
  v_mfma_f32_16x16x32_bf16 v[24:27], a[216:219], v[184:187], 0
  buffer_load_dwordx4 a[232:235], v111, s[24:27], s30 offen offset:0 sc1
  v_mfma_f32_16x16x32_bf16 v[24:27], a[236:239], v[188:191], v[24:27]
  v_add_f32 v32, v32, v36
  v_add_f32 v33, v33, v37
  v_mfma_f32_16x16x32_bf16 v[28:31], a[236:239], a[188:191], 0
  v_add_f32 v34, v34, v38
  v_add_f32 v35, v35, v39
  v_mfma_f32_16x16x32_bf16 v[28:31], a[216:219], v[200:203], v[28:31]
  buffer_store_dwordx4 v[32:35], v114, s[24:27], s38 offen offset:2048 sc1
  s_waitcnt lgkmcnt(3)
  s_nop 0
  v_mfma_f32_16x16x32_bf16 v[32:35], a[220:223], a[196:199], 0
  buffer_load_dwordx4 a[216:219], v111, s[24:27], s30 offen offset:1024 sc1
  v_mfma_f32_16x16x32_bf16 v[32:35], a[240:243], a[200:203], v[32:35]
  v_add_f32 v52, v52, v56
  v_add_f32 v53, v53, v57
  v_mfma_f32_16x16x32_bf16 v[36:39], a[240:243], a[208:211], 0
  v_add_f32 v54, v54, v58
  v_add_f32 v55, v55, v59
  v_mfma_f32_16x16x32_bf16 v[36:39], a[220:223], v[152:155], v[36:39]
  v_add_f32 v48, v48, v60
  v_add_f32 v49, v49, v61
  v_mfma_f32_16x16x32_bf16 v[40:43], a[220:223], v[184:187], 0
  buffer_load_dwordx4 a[236:239], v112, s[24:27], s30 offen offset:0 sc1
  v_mfma_f32_16x16x32_bf16 v[40:43], a[240:243], v[188:191], v[40:43]
  v_add_f32 v50, v50, v62
  v_add_f32 v51, v51, v63
  v_mfma_f32_16x16x32_bf16 v[44:47], a[240:243], a[188:191], 0
  v_add_f32 v48, v48, v52
  v_add_f32 v49, v49, v53
  v_mfma_f32_16x16x32_bf16 v[44:47], a[220:223], v[200:203], v[44:47]
  v_add_f32 v50, v50, v54
  v_add_f32 v51, v51, v55
  buffer_store_dwordx4 v[48:51], v114, s[24:27], s38 offen offset:3072 sc1
  s_nop 1
  v_mfma_f32_16x16x32_bf16 v[48:51], a[224:227], a[196:199], 0
  buffer_load_dwordx4 a[220:223], v112, s[24:27], s30 offen offset:1024 sc1
  s_waitcnt lgkmcnt(0)
  v_mfma_f32_16x16x32_bf16 v[48:51], a[244:247], a[200:203], v[48:51]
  v_add_f32 v68, v68, v72
  v_add_f32 v69, v69, v73
  v_mfma_f32_16x16x32_bf16 v[52:55], a[244:247], a[208:211], 0
  v_add_f32 v70, v70, v74
  v_add_f32 v71, v71, v75
  v_mfma_f32_16x16x32_bf16 v[52:55], a[224:227], v[152:155], v[52:55]
  v_add_f32 v64, v64, v76
  v_add_f32 v65, v65, v77
  v_mfma_f32_16x16x32_bf16 v[56:59], a[224:227], v[184:187], 0
  buffer_load_dwordx4 a[240:243], v113, s[24:27], s30 offen offset:0 sc1
  v_mfma_f32_16x16x32_bf16 v[56:59], a[244:247], v[188:191], v[56:59]
  v_add_f32 v66, v66, v78
  v_add_f32 v67, v67, v79
  v_mfma_f32_16x16x32_bf16 v[60:63], a[244:247], a[188:191], 0
  v_add_f32 v64, v64, v68
  v_add_f32 v65, v65, v69
  v_mfma_f32_16x16x32_bf16 v[60:63], a[224:227], v[200:203], v[60:63]
  v_add_f32 v66, v66, v70
  v_add_f32 v67, v67, v71
  buffer_store_dwordx4 v[64:67], v114, s[24:27], s39 offen offset:0 sc1
  s_nop 1
  v_mfma_f32_16x16x32_bf16 v[64:67], a[228:231], a[196:199], 0
  buffer_load_dwordx4 a[224:227], v113, s[24:27], s30 offen offset:1024 sc1
  s_xor_b32 s38, s40, 1
  s_lshl_b32 s38, s38, 7
  s_add_u32 s38, s38, 2834432
  v_mfma_f32_16x16x32_bf16 v[64:67], a[248:251], a[200:203], v[64:67]
  v_mov_b32 v126, 1073741824
  v_writelane_b32 v126, s38, 0
  v_mfma_f32_16x16x32_bf16 v[68:71], a[248:251], a[208:211], 0
  v_mov_b32 v127, 1
  v_mfma_f32_16x16x32_bf16 v[68:71], a[228:231], v[152:155], v[68:71]
  s_xor_b32 s38, s38, 128
  v_mov_b32 v133, s38
  v_mov_b32 v134, 4
  v_mfma_f32_16x16x32_bf16 v[72:75], a[228:231], v[184:187], 0
  s_add_u32 s30, s30, 8192
  buffer_load_dwordx4 a[244:247], v110, s[24:27], s30 offen offset:0 sc1
  v_mfma_f32_16x16x32_bf16 v[72:75], a[248:251], v[188:191], v[72:75]
  v_mfma_f32_16x16x32_bf16 v[76:79], a[248:251], a[188:191], 0
  v_mfma_f32_16x16x32_bf16 v[76:79], a[228:231], v[200:203], v[76:79]
  s_waitcnt vmcnt(30)
  v_mfma_f32_16x16x32_bf16 v[0:3], a[252:255], v[236:239], v[0:3]
  buffer_load_dwordx4 a[228:231], v110, s[24:27], s30 offen offset:1024 sc1
  v_mfma_f32_16x16x32_bf16 v[0:3], a[144:147], v[192:195], v[0:3]
  v_mfma_f32_16x16x32_bf16 v[4:7], a[144:147], v[212:215], v[4:7]
  v_mfma_f32_16x16x32_bf16 v[4:7], a[252:255], v[196:199], v[4:7]
  v_mfma_f32_16x16x32_bf16 v[8:11], a[252:255], v[216:219], v[8:11]
  buffer_load_dwordx4 a[248:251], v111, s[24:27], s30 offen offset:0 sc1
  v_mfma_f32_16x16x32_bf16 v[8:11], a[144:147], v[228:231], v[8:11]
  v_mfma_f32_16x16x32_bf16 v[12:15], a[144:147], a[192:195], v[12:15]
  v_mfma_f32_16x16x32_bf16 v[12:15], a[252:255], v[232:235], v[12:15]
  v_mfma_f32_16x16x32_bf16 v[16:19], a[128:131], v[236:239], v[16:19]
  buffer_load_dwordx4 a[196:199], v111, s[24:27], s30 offen offset:1024 sc1
  v_mfma_f32_16x16x32_bf16 v[16:19], a[148:151], v[192:195], v[16:19]
  v_mfma_f32_16x16x32_bf16 v[20:23], a[148:151], v[212:215], v[20:23]
  v_mfma_f32_16x16x32_bf16 v[20:23], a[128:131], v[196:199], v[20:23]
  v_mfma_f32_16x16x32_bf16 v[24:27], a[128:131], v[216:219], v[24:27]
  buffer_load_dwordx4 a[200:203], v112, s[24:27], s30 offen offset:0 sc1
  v_mfma_f32_16x16x32_bf16 v[24:27], a[148:151], v[228:231], v[24:27]
  v_mfma_f32_16x16x32_bf16 v[28:31], a[148:151], a[192:195], v[28:31]
  v_mfma_f32_16x16x32_bf16 v[28:31], a[128:131], v[232:235], v[28:31]
  v_mfma_f32_16x16x32_bf16 v[32:35], a[132:135], v[236:239], v[32:35]
  buffer_load_dwordx4 a[208:211], v112, s[24:27], s30 offen offset:1024 sc1
  v_mfma_f32_16x16x32_bf16 v[32:35], a[152:155], v[192:195], v[32:35]
  v_mfma_f32_16x16x32_bf16 v[36:39], a[152:155], v[212:215], v[36:39]
  v_mfma_f32_16x16x32_bf16 v[36:39], a[132:135], v[196:199], v[36:39]
  v_mfma_f32_16x16x32_bf16 v[40:43], a[132:135], v[216:219], v[40:43]
  buffer_load_dwordx4 v[184:187], v113, s[24:27], s30 offen offset:0 sc1
  v_mfma_f32_16x16x32_bf16 v[40:43], a[152:155], v[228:231], v[40:43]
  v_mfma_f32_16x16x32_bf16 v[44:47], a[152:155], a[192:195], v[44:47]
  v_mfma_f32_16x16x32_bf16 v[44:47], a[132:135], v[232:235], v[44:47]
  v_mfma_f32_16x16x32_bf16 v[48:51], a[136:139], v[236:239], v[48:51]
  buffer_load_dwordx4 v[188:191], v113, s[24:27], s30 offen offset:1024 sc1
  v_mfma_f32_16x16x32_bf16 v[48:51], a[156:159], v[192:195], v[48:51]
  v_mfma_f32_16x16x32_bf16 v[52:55], a[156:159], v[212:215], v[52:55]
  v_mfma_f32_16x16x32_bf16 v[52:55], a[136:139], v[196:199], v[52:55]
  v_mfma_f32_16x16x32_bf16 v[56:59], a[136:139], v[216:219], v[56:59]
  s_add_u32 s30, s30, 8192
  buffer_load_dwordx4 v[200:203], v110, s[24:27], s30 offen offset:0 sc1
  v_mfma_f32_16x16x32_bf16 v[56:59], a[156:159], v[228:231], v[56:59]
  v_mfma_f32_16x16x32_bf16 v[60:63], a[156:159], a[192:195], v[60:63]
  v_mfma_f32_16x16x32_bf16 v[60:63], a[136:139], v[232:235], v[60:63]
  v_mfma_f32_16x16x32_bf16 v[64:67], a[140:143], v[236:239], v[64:67]
  buffer_load_dwordx4 a[188:191], v110, s[24:27], s30 offen offset:1024 sc1
  v_mfma_f32_16x16x32_bf16 v[64:67], a[0:3], v[192:195], v[64:67]
  v_mfma_f32_16x16x32_bf16 v[68:71], a[0:3], v[212:215], v[68:71]
  v_mfma_f32_16x16x32_bf16 v[68:71], a[140:143], v[196:199], v[68:71]
  v_mfma_f32_16x16x32_bf16 v[72:75], a[140:143], v[216:219], v[72:75]
  buffer_load_dwordx4 a[252:255], v111, s[24:27], s30 offen offset:0 sc1
  v_mfma_f32_16x16x32_bf16 v[72:75], a[0:3], v[228:231], v[72:75]
  v_mfma_f32_16x16x32_bf16 v[76:79], a[0:3], a[192:195], v[76:79]
  v_mfma_f32_16x16x32_bf16 v[76:79], a[140:143], v[232:235], v[76:79]
  s_waitcnt vmcnt(32)
  v_mfma_f32_16x16x32_bf16 v[0:3], a[4:7], a[204:207], v[0:3]
  buffer_load_dwordx4 a[144:147], v111, s[24:27], s30 offen offset:1024 sc1
  v_mfma_f32_16x16x32_bf16 v[0:3], a[24:27], v[248:251], v[0:3]
  v_mfma_f32_16x16x32_bf16 v[4:7], a[24:27], v[176:179], v[4:7]
  v_mfma_f32_16x16x32_bf16 v[4:7], a[4:7], v[140:143], v[4:7]
  v_mfma_f32_16x16x32_bf16 v[8:11], a[4:7], v[180:183], v[8:11]
  buffer_load_dwordx4 a[128:131], v112, s[24:27], s30 offen offset:0 sc1
  v_mfma_f32_16x16x32_bf16 v[8:11], a[24:27], v[204:207], v[8:11]
  v_mfma_f32_16x16x32_bf16 v[12:15], a[24:27], v[220:223], v[12:15]
  v_mfma_f32_16x16x32_bf16 v[12:15], a[4:7], v[208:211], v[12:15]
  v_mfma_f32_16x16x32_bf16 v[16:19], a[8:11], a[204:207], v[16:19]
  buffer_load_dwordx4 a[148:151], v112, s[24:27], s30 offen offset:1024 sc1
  v_mfma_f32_16x16x32_bf16 v[16:19], a[28:31], v[248:251], v[16:19]
  v_mfma_f32_16x16x32_bf16 v[20:23], a[28:31], v[176:179], v[20:23]
  v_mfma_f32_16x16x32_bf16 v[20:23], a[8:11], v[140:143], v[20:23]
  v_mfma_f32_16x16x32_bf16 v[24:27], a[8:11], v[180:183], v[24:27]
  buffer_load_dwordx4 a[132:135], v113, s[24:27], s30 offen offset:0 sc1
  v_mfma_f32_16x16x32_bf16 v[24:27], a[28:31], v[204:207], v[24:27]
  v_mfma_f32_16x16x32_bf16 v[28:31], a[28:31], v[220:223], v[28:31]
  v_mfma_f32_16x16x32_bf16 v[28:31], a[8:11], v[208:211], v[28:31]
  v_mfma_f32_16x16x32_bf16 v[32:35], a[12:15], a[204:207], v[32:35]
  buffer_load_dwordx4 a[152:155], v113, s[24:27], s30 offen offset:1024 sc1
  v_mfma_f32_16x16x32_bf16 v[32:35], a[32:35], v[248:251], v[32:35]
  v_mfma_f32_16x16x32_bf16 v[36:39], a[32:35], v[176:179], v[36:39]
  v_mfma_f32_16x16x32_bf16 v[36:39], a[12:15], v[140:143], v[36:39]
  v_mfma_f32_16x16x32_bf16 v[40:43], a[12:15], v[180:183], v[40:43]
  s_add_u32 s30, s30, 8192
  buffer_load_dwordx4 a[136:139], v110, s[24:27], s30 offen offset:0 sc1
  v_mfma_f32_16x16x32_bf16 v[40:43], a[32:35], v[204:207], v[40:43]
  v_mfma_f32_16x16x32_bf16 v[44:47], a[32:35], v[220:223], v[44:47]
  v_mfma_f32_16x16x32_bf16 v[44:47], a[12:15], v[208:211], v[44:47]
  v_mfma_f32_16x16x32_bf16 v[48:51], a[16:19], a[204:207], v[48:51]
  buffer_load_dwordx4 a[156:159], v110, s[24:27], s30 offen offset:1024 sc1
  v_mfma_f32_16x16x32_bf16 v[48:51], a[36:39], v[248:251], v[48:51]
  v_mfma_f32_16x16x32_bf16 v[52:55], a[36:39], v[176:179], v[52:55]
  v_mfma_f32_16x16x32_bf16 v[52:55], a[16:19], v[140:143], v[52:55]
  v_mfma_f32_16x16x32_bf16 v[56:59], a[16:19], v[180:183], v[56:59]
  buffer_load_dwordx4 a[140:143], v111, s[24:27], s30 offen offset:0 sc1
  v_mfma_f32_16x16x32_bf16 v[56:59], a[36:39], v[204:207], v[56:59]
  v_mfma_f32_16x16x32_bf16 v[60:63], a[36:39], v[220:223], v[60:63]
  v_mfma_f32_16x16x32_bf16 v[60:63], a[16:19], v[208:211], v[60:63]
  v_mfma_f32_16x16x32_bf16 v[64:67], a[20:23], a[204:207], v[64:67]
  buffer_load_dwordx4 a[0:3], v111, s[24:27], s30 offen offset:1024 sc1
  v_mfma_f32_16x16x32_bf16 v[64:67], a[40:43], v[248:251], v[64:67]
  v_mfma_f32_16x16x32_bf16 v[68:71], a[40:43], v[176:179], v[68:71]
  v_mfma_f32_16x16x32_bf16 v[68:71], a[20:23], v[140:143], v[68:71]
  v_mfma_f32_16x16x32_bf16 v[72:75], a[20:23], v[180:183], v[72:75]
  buffer_load_dwordx4 v[236:239], v112, s[24:27], s30 offen offset:0 sc1
  v_mfma_f32_16x16x32_bf16 v[72:75], a[40:43], v[204:207], v[72:75]
  v_mfma_f32_16x16x32_bf16 v[76:79], a[40:43], v[220:223], v[76:79]
  v_mfma_f32_16x16x32_bf16 v[76:79], a[20:23], v[208:211], v[76:79]
  s_waitcnt vmcnt(34)
  v_mfma_f32_16x16x32_bf16 v[0:3], a[44:47], v[224:227], v[0:3]
  buffer_load_dwordx4 v[192:195], v112, s[24:27], s30 offen offset:1024 sc1
  s_waitcnt vmcnt(23)
  v_mfma_f32_16x16x32_bf16 v[0:3], a[64:67], v[240:243], v[0:3]
  buffer_atomic_add v127, v126, s[24:27], 0 offen
  v_mfma_f32_16x16x32_bf16 v[4:7], a[64:67], v[252:255], v[4:7]
  v_mfma_f32_16x16x32_bf16 v[4:7], a[44:47], v[244:247], v[4:7]
  v_mfma_f32_16x16x32_bf16 v[8:11], a[44:47], v[136:139], v[8:11]
  buffer_load_dwordx4 v[196:199], v113, s[24:27], s30 offen offset:0 sc1
  v_mfma_f32_16x16x32_bf16 v[8:11], a[64:67], v[144:147], v[8:11]
  v_mfma_f32_16x16x32_bf16 v[12:15], a[64:67], a[180:183], v[12:15]
  v_mfma_f32_16x16x32_bf16 v[12:15], a[44:47], v[148:151], v[12:15]
  v_mfma_f32_16x16x32_bf16 v[16:19], a[48:51], v[224:227], v[16:19]
  buffer_load_dwordx4 v[212:215], v113, s[24:27], s30 offen offset:1024 sc1
  v_mfma_f32_16x16x32_bf16 v[16:19], a[68:71], v[240:243], v[16:19]
  v_mfma_f32_16x16x32_bf16 v[20:23], a[68:71], v[252:255], v[20:23]
  v_mfma_f32_16x16x32_bf16 v[20:23], a[48:51], v[244:247], v[20:23]
  v_mfma_f32_16x16x32_bf16 v[24:27], a[48:51], v[136:139], v[24:27]
  s_add_u32 s30, s30, 8192
  v_mfma_f32_16x16x32_bf16 v[24:27], a[68:71], v[144:147], v[24:27]
  v_mfma_f32_16x16x32_bf16 v[28:31], a[68:71], a[180:183], v[28:31]
  v_mfma_f32_16x16x32_bf16 v[28:31], a[48:51], v[148:151], v[28:31]
  v_mfma_f32_16x16x32_bf16 v[32:35], a[52:55], v[224:227], v[32:35]
  v_mfma_f32_16x16x32_bf16 v[32:35], a[72:75], v[240:243], v[32:35]
  v_mfma_f32_16x16x32_bf16 v[36:39], a[72:75], v[252:255], v[36:39]
  v_mfma_f32_16x16x32_bf16 v[36:39], a[52:55], v[244:247], v[36:39]
  v_mfma_f32_16x16x32_bf16 v[40:43], a[52:55], v[136:139], v[40:43]
  v_mfma_f32_16x16x32_bf16 v[40:43], a[72:75], v[144:147], v[40:43]
  v_mfma_f32_16x16x32_bf16 v[44:47], a[72:75], a[180:183], v[44:47]
  v_mfma_f32_16x16x32_bf16 v[44:47], a[52:55], v[148:151], v[44:47]
  v_mfma_f32_16x16x32_bf16 v[48:51], a[56:59], v[224:227], v[48:51]
  v_mfma_f32_16x16x32_bf16 v[48:51], a[76:79], v[240:243], v[48:51]
  v_mfma_f32_16x16x32_bf16 v[52:55], a[76:79], v[252:255], v[52:55]
  v_mfma_f32_16x16x32_bf16 v[52:55], a[56:59], v[244:247], v[52:55]
  v_mfma_f32_16x16x32_bf16 v[56:59], a[56:59], v[136:139], v[56:59]
  v_mfma_f32_16x16x32_bf16 v[56:59], a[76:79], v[144:147], v[56:59]
  v_mfma_f32_16x16x32_bf16 v[60:63], a[76:79], a[180:183], v[60:63]
  v_mfma_f32_16x16x32_bf16 v[60:63], a[56:59], v[148:151], v[60:63]
  v_mfma_f32_16x16x32_bf16 v[64:67], a[60:63], v[224:227], v[64:67]
  v_mfma_f32_16x16x32_bf16 v[64:67], a[80:83], v[240:243], v[64:67]
  v_mfma_f32_16x16x32_bf16 v[68:71], a[80:83], v[252:255], v[68:71]
  v_mfma_f32_16x16x32_bf16 v[68:71], a[60:63], v[244:247], v[68:71]
  v_mfma_f32_16x16x32_bf16 v[72:75], a[60:63], v[136:139], v[72:75]
  v_mfma_f32_16x16x32_bf16 v[72:75], a[80:83], v[144:147], v[72:75]
  v_mfma_f32_16x16x32_bf16 v[76:79], a[80:83], a[180:183], v[76:79]
  v_mfma_f32_16x16x32_bf16 v[76:79], a[60:63], v[148:151], v[76:79]
  s_waitcnt vmcnt(25)
  v_mfma_f32_16x16x32_bf16 v[0:3], a[84:87], a[184:187], v[0:3]
  v_mfma_f32_16x16x32_bf16 v[0:3], a[104:107], a[212:215], v[0:3]
  v_mfma_f32_16x16x32_bf16 v[4:7], a[104:107], a[216:219], v[4:7]
  v_mfma_f32_16x16x32_bf16 v[4:7], a[84:87], a[232:235], v[4:7]
  v_mfma_f32_16x16x32_bf16 v[8:11], a[84:87], a[236:239], v[8:11]
  v_mfma_f32_16x16x32_bf16 v[8:11], a[104:107], a[220:223], v[8:11]
  v_mfma_f32_16x16x32_bf16 v[12:15], a[104:107], a[224:227], v[12:15]
  v_mfma_f32_16x16x32_bf16 v[12:15], a[84:87], a[240:243], v[12:15]
  v_mfma_f32_16x16x32_bf16 v[16:19], a[88:91], a[184:187], v[16:19]
  v_mfma_f32_16x16x32_bf16 v[16:19], a[108:111], a[212:215], v[16:19]
  v_mfma_f32_16x16x32_bf16 v[20:23], a[108:111], a[216:219], v[20:23]
  v_mfma_f32_16x16x32_bf16 v[20:23], a[88:91], a[232:235], v[20:23]
  v_mfma_f32_16x16x32_bf16 v[24:27], a[88:91], a[236:239], v[24:27]
  v_mfma_f32_16x16x32_bf16 v[24:27], a[108:111], a[220:223], v[24:27]
  v_mfma_f32_16x16x32_bf16 v[28:31], a[108:111], a[224:227], v[28:31]
  v_mfma_f32_16x16x32_bf16 v[28:31], a[88:91], a[240:243], v[28:31]
  v_mfma_f32_16x16x32_bf16 v[32:35], a[92:95], a[184:187], v[32:35]
  v_mfma_f32_16x16x32_bf16 v[32:35], a[112:115], a[212:215], v[32:35]
  v_mfma_f32_16x16x32_bf16 v[36:39], a[112:115], a[216:219], v[36:39]
  v_mfma_f32_16x16x32_bf16 v[36:39], a[92:95], a[232:235], v[36:39]
  v_mfma_f32_16x16x32_bf16 v[40:43], a[92:95], a[236:239], v[40:43]
  v_mfma_f32_16x16x32_bf16 v[40:43], a[112:115], a[220:223], v[40:43]
  v_mfma_f32_16x16x32_bf16 v[44:47], a[112:115], a[224:227], v[44:47]
  v_mfma_f32_16x16x32_bf16 v[44:47], a[92:95], a[240:243], v[44:47]
  v_mfma_f32_16x16x32_bf16 v[48:51], a[96:99], a[184:187], v[48:51]
  v_mfma_f32_16x16x32_bf16 v[48:51], a[116:119], a[212:215], v[48:51]
  v_mfma_f32_16x16x32_bf16 v[52:55], a[116:119], a[216:219], v[52:55]
  v_mfma_f32_16x16x32_bf16 v[52:55], a[96:99], a[232:235], v[52:55]
  v_mfma_f32_16x16x32_bf16 v[56:59], a[96:99], a[236:239], v[56:59]
  v_mfma_f32_16x16x32_bf16 v[56:59], a[116:119], a[220:223], v[56:59]
  v_mfma_f32_16x16x32_bf16 v[60:63], a[116:119], a[224:227], v[60:63]
  v_mfma_f32_16x16x32_bf16 v[60:63], a[96:99], a[240:243], v[60:63]
  v_mfma_f32_16x16x32_bf16 v[64:67], a[100:103], a[184:187], v[64:67]
  ds_read_b128 v[216:219], v122 offset:0
  v_mfma_f32_16x16x32_bf16 v[64:67], a[120:123], a[212:215], v[64:67]
  v_mfma_f32_16x16x32_bf16 v[68:71], a[120:123], a[216:219], v[68:71]
  v_mfma_f32_16x16x32_bf16 v[68:71], a[100:103], a[232:235], v[68:71]
  v_mfma_f32_16x16x32_bf16 v[72:75], a[100:103], a[236:239], v[72:75]
  v_mfma_f32_16x16x32_bf16 v[72:75], a[120:123], a[220:223], v[72:75]
  v_mfma_f32_16x16x32_bf16 v[76:79], a[120:123], a[224:227], v[76:79]
  v_mfma_f32_16x16x32_bf16 v[76:79], a[100:103], a[240:243], v[76:79]
  s_waitcnt vmcnt(17)
  v_mfma_f32_16x16x32_bf16 v[0:3], a[124:127], a[244:247], v[0:3]
  ds_read_b128 v[228:231], v122 offset:1024
  buffer_load_dword v128, v133, s[24:27], 0 offen sc1
  s_xor_b32 s38, s40, 0
  s_lshl_b32 s38, s38, 2
  s_add_u32 s38, s38, s3
  v_mfma_f32_16x16x32_bf16 v[0:3], a[176:179], a[228:231], v[0:3]
  s_lshl_b32 s38, s38, 13
  s_add_u32 s38, s38, 25165824
  s_add_u32 s39, s38, 4096
  v_mfma_f32_16x16x32_bf16 v[4:7], a[176:179], a[196:199], v[4:7]
  v_mfma_f32_16x16x32_bf16 v[4:7], a[124:127], a[248:251], v[4:7]
  v_mfma_f32_16x16x32_bf16 v[8:11], a[124:127], a[200:203], v[8:11]
  v_mfma_f32_16x16x32_bf16 v[8:11], a[176:179], a[208:211], v[8:11]
  v_mfma_f32_16x16x32_bf16 v[12:15], a[176:179], v[188:191], v[12:15]
  v_mfma_f32_16x16x32_bf16 v[12:15], a[124:127], v[184:187], v[12:15]
  s_waitcnt lgkmcnt(1)
  v_mfma_f32_16x16x32_bf16 v[16:19], a[160:163], a[244:247], v[16:19]
  ds_read_b128 v[232:235], v122 offset:2048
  v_mfma_f32_16x16x32_bf16 v[16:19], v[216:219], a[228:231], v[16:19]
  v_mfma_f32_16x16x32_bf16 v[20:23], v[216:219], a[196:199], v[20:23]
  v_mfma_f32_16x16x32_bf16 v[20:23], a[160:163], a[248:251], v[20:23]
  v_mfma_f32_16x16x32_bf16 v[24:27], a[160:163], a[200:203], v[24:27]
  v_mfma_f32_16x16x32_bf16 v[24:27], v[216:219], a[208:211], v[24:27]
  v_mfma_f32_16x16x32_bf16 v[28:31], v[216:219], v[188:191], v[28:31]
  v_mfma_f32_16x16x32_bf16 v[28:31], a[160:163], v[184:187], v[28:31]
  s_waitcnt lgkmcnt(1)
  v_mfma_f32_16x16x32_bf16 v[32:35], a[164:167], a[244:247], v[32:35]
  ds_read_b128 a[192:195], v122 offset:3072
  v_mfma_f32_16x16x32_bf16 v[32:35], v[228:231], a[228:231], v[32:35]
  v_mfma_f32_16x16x32_bf16 v[36:39], v[228:231], a[196:199], v[36:39]
  v_mfma_f32_16x16x32_bf16 v[36:39], a[164:167], a[248:251], v[36:39]
  v_mfma_f32_16x16x32_bf16 v[40:43], a[164:167], a[200:203], v[40:43]
  v_mfma_f32_16x16x32_bf16 v[40:43], v[228:231], a[208:211], v[40:43]
  v_mfma_f32_16x16x32_bf16 v[44:47], v[228:231], v[188:191], v[44:47]
  v_mfma_f32_16x16x32_bf16 v[44:47], a[164:167], v[184:187], v[44:47]
  s_waitcnt lgkmcnt(1)
  v_mfma_f32_16x16x32_bf16 v[48:51], a[168:171], a[244:247], v[48:51]
  ds_read_b128 a[4:7], v122 offset:16384
  ds_read_b128 a[24:27], v122 offset:33792
  v_mfma_f32_16x16x32_bf16 v[48:51], v[232:235], a[228:231], v[48:51]
  v_mfma_f32_16x16x32_bf16 v[52:55], v[232:235], a[196:199], v[52:55]
  v_mfma_f32_16x16x32_bf16 v[52:55], a[168:171], a[248:251], v[52:55]
  v_mfma_f32_16x16x32_bf16 v[56:59], a[168:171], a[200:203], v[56:59]
  v_mfma_f32_16x16x32_bf16 v[56:59], v[232:235], a[208:211], v[56:59]
  v_mfma_f32_16x16x32_bf16 v[60:63], v[232:235], v[188:191], v[60:63]
  v_mfma_f32_16x16x32_bf16 v[60:63], a[168:171], v[184:187], v[60:63]
  s_waitcnt lgkmcnt(2)
  v_mfma_f32_16x16x32_bf16 v[64:67], a[172:175], a[244:247], v[64:67]
  ds_read_b128 a[8:11], v122 offset:17408
  ds_read_b128 a[28:31], v122 offset:34816
  v_mfma_f32_16x16x32_bf16 v[64:67], a[192:195], a[228:231], v[64:67]
  v_mfma_f32_16x16x32_bf16 v[68:71], a[192:195], a[196:199], v[68:71]
  v_mfma_f32_16x16x32_bf16 v[68:71], a[172:175], a[248:251], v[68:71]
  v_mfma_f32_16x16x32_bf16 v[72:75], a[172:175], a[200:203], v[72:75]
  v_mfma_f32_16x16x32_bf16 v[72:75], a[192:195], a[208:211], v[72:75]
  v_mfma_f32_16x16x32_bf16 v[76:79], a[192:195], v[188:191], v[76:79]
  v_mfma_f32_16x16x32_bf16 v[76:79], a[172:175], v[184:187], v[76:79]
  s_waitcnt vmcnt(10) lgkmcnt(2)
  v_mfma_f32_16x16x32_bf16 v[0:3], a[4:7], v[200:203], v[0:3]
  ds_read_b128 a[12:15], v122 offset:18432
  ds_read_b128 a[32:35], v122 offset:35840
  v_mfma_f32_16x16x32_bf16 v[0:3], a[24:27], a[188:191], v[0:3]
  v_mfma_f32_16x16x32_bf16 v[4:7], a[24:27], a[144:147], v[4:7]
  v_mfma_f32_16x16x32_bf16 v[4:7], a[4:7], a[252:255], v[4:7]
  v_mfma_f32_16x16x32_bf16 v[8:11], a[4:7], a[128:131], v[8:11]
  v_mfma_f32_16x16x32_bf16 v[8:11], a[24:27], a[148:151], v[8:11]
  v_mfma_f32_16x16x32_bf16 v[12:15], a[24:27], a[152:155], v[12:15]
  v_mfma_f32_16x16x32_bf16 v[12:15], a[4:7], a[132:135], v[12:15]
  s_waitcnt lgkmcnt(2)
  v_mfma_f32_16x16x32_bf16 v[16:19], a[8:11], v[200:203], v[16:19]
  ds_read_b128 a[16:19], v122 offset:19456
  ds_read_b128 a[36:39], v135 offset:0
  v_mfma_f32_16x16x32_bf16 v[16:19], a[28:31], a[188:191], v[16:19]
  v_mfma_f32_16x16x32_bf16 v[20:23], a[28:31], a[144:147], v[20:23]
  v_mfma_f32_16x16x32_bf16 v[20:23], a[8:11], a[252:255], v[20:23]
  v_mfma_f32_16x16x32_bf16 v[24:27], a[8:11], a[128:131], v[24:27]
  v_mfma_f32_16x16x32_bf16 v[24:27], a[28:31], a[148:151], v[24:27]
  v_mfma_f32_16x16x32_bf16 v[28:31], a[28:31], a[152:155], v[28:31]
  v_mfma_f32_16x16x32_bf16 v[28:31], a[8:11], a[132:135], v[28:31]
  s_waitcnt lgkmcnt(2)
  v_mfma_f32_16x16x32_bf16 v[32:35], a[12:15], v[200:203], v[32:35]
  ds_read_b128 a[20:23], v122 offset:32768
  ds_read_b128 a[40:43], v135 offset:1024
  v_mfma_f32_16x16x32_bf16 v[32:35], a[32:35], a[188:191], v[32:35]
  v_mfma_f32_16x16x32_bf16 v[36:39], a[32:35], a[144:147], v[36:39]
  v_mfma_f32_16x16x32_bf16 v[36:39], a[12:15], a[252:255], v[36:39]
  v_mfma_f32_16x16x32_bf16 v[40:43], a[12:15], a[128:131], v[40:43]
  v_mfma_f32_16x16x32_bf16 v[40:43], a[32:35], a[148:151], v[40:43]
  v_mfma_f32_16x16x32_bf16 v[44:47], a[32:35], a[152:155], v[44:47]
  v_mfma_f32_16x16x32_bf16 v[44:47], a[12:15], a[132:135], v[44:47]
  s_waitcnt lgkmcnt(2)
  v_mfma_f32_16x16x32_bf16 v[48:51], a[16:19], v[200:203], v[48:51]
  ds_read_b128 a[204:207], v135 offset:2048
  ds_read_b128 v[248:251], v135 offset:19456
  v_mfma_f32_16x16x32_bf16 v[48:51], a[36:39], a[188:191], v[48:51]
  v_mfma_f32_16x16x32_bf16 v[52:55], a[36:39], a[144:147], v[52:55]
  v_mfma_f32_16x16x32_bf16 v[52:55], a[16:19], a[252:255], v[52:55]
  v_mfma_f32_16x16x32_bf16 v[56:59], a[16:19], a[128:131], v[56:59]
  v_mfma_f32_16x16x32_bf16 v[56:59], a[36:39], a[148:151], v[56:59]
  v_mfma_f32_16x16x32_bf16 v[60:63], a[36:39], a[152:155], v[60:63]
  v_mfma_f32_16x16x32_bf16 v[60:63], a[16:19], a[132:135], v[60:63]
  s_waitcnt lgkmcnt(2)
  v_mfma_f32_16x16x32_bf16 v[64:67], a[20:23], v[200:203], v[64:67]
  ds_read_b128 v[176:179], v135 offset:3072
  ds_read_b128 v[180:183], v122 offset:49152
  v_mfma_f32_16x16x32_bf16 v[64:67], a[40:43], a[188:191], v[64:67]
  v_mfma_f32_16x16x32_bf16 v[68:71], a[40:43], a[144:147], v[68:71]
  v_mfma_f32_16x16x32_bf16 v[68:71], a[20:23], a[252:255], v[68:71]
  v_mfma_f32_16x16x32_bf16 v[72:75], a[20:23], a[128:131], v[72:75]
  v_mfma_f32_16x16x32_bf16 v[72:75], a[40:43], a[148:151], v[72:75]
  v_mfma_f32_16x16x32_bf16 v[76:79], a[40:43], a[152:155], v[76:79]
  v_mfma_f32_16x16x32_bf16 v[76:79], a[20:23], a[132:135], v[76:79]
  s_waitcnt vmcnt(0)
  v_cmp_lt_u32 vcc, v128, v134
  s_nop 0
  s_cbranch_vccz tail_partner
  s_mov_b32 s35, 32768
tail_spin2:
  s_sleep 2
  buffer_load_dword v128, v133, s[24:27], 0 offen sc1
  s_waitcnt vmcnt(0)
  v_cmp_lt_u32 vcc, v128, v134
  s_nop 0
  s_cbranch_vccz tail_partner
  s_sub_u32 s35, s35, 1
  s_cmp_lg_u32 s35, 0
  s_cbranch_scc1 tail_spin2
tail_partner:
  s_waitcnt lgkmcnt(2)
  v_mfma_f32_16x16x32_bf16 v[0:3], a[204:207], a[136:139], v[0:3]
  ds_read_b128 v[204:207], v135 offset:16384
  ds_read_b128 v[208:211], v122 offset:50176
  v_mfma_f32_16x16x32_bf16 v[0:3], v[248:251], a[156:159], v[0:3]
  buffer_load_dwordx4 v[136:139], v114, s[24:27], s38 offen offset:0 sc1
  v_mfma_f32_16x16x32_bf16 v[4:7], v[248:251], a[0:3], v[4:7]
  buffer_load_dwordx4 v[140:143], v114, s[24:27], s38 offen offset:1024 sc1
  v_mfma_f32_16x16x32_bf16 v[4:7], a[204:207], a[140:143], v[4:7]
  buffer_load_dwordx4 v[144:147], v114, s[24:27], s38 offen offset:2048 sc1
  v_mfma_f32_16x16x32_bf16 v[8:11], a[204:207], v[236:239], v[8:11]
  buffer_load_dwordx4 v[148:151], v114, s[24:27], s38 offen offset:3072 sc1
  v_mfma_f32_16x16x32_bf16 v[8:11], v[248:251], v[192:195], v[8:11]
  buffer_load_dwordx4 v[152:155], v114, s[24:27], s39 offen offset:0 sc1
  v_mfma_f32_16x16x32_bf16 v[12:15], v[248:251], v[212:215], v[12:15]
  v_mfma_f32_16x16x32_bf16 v[12:15], a[204:207], v[196:199], v[12:15]
  s_waitcnt lgkmcnt(2)
  v_mfma_f32_16x16x32_bf16 v[16:19], v[176:179], a[136:139], v[16:19]
  ds_read_b128 v[220:223], v135 offset:17408
  ds_read_b128 a[44:47], v122 offset:51200
  v_mfma_f32_16x16x32_bf16 v[16:19], v[180:183], a[156:159], v[16:19]
  ds_write_b128 v122, v[4:7] offset:0
  ds_write_b128 v122, v[8:11] offset:17408
  v_mfma_f32_16x16x32_bf16 v[20:23], v[180:183], a[0:3], v[20:23]
  ds_write_b128 v122, v[12:15] offset:34816
  v_mfma_f32_16x16x32_bf16 v[20:23], v[176:179], a[140:143], v[20:23]
  v_mfma_f32_16x16x32_bf16 v[24:27], v[176:179], v[236:239], v[24:27]
  v_mfma_f32_16x16x32_bf16 v[24:27], v[180:183], v[192:195], v[24:27]
  v_mfma_f32_16x16x32_bf16 v[28:31], v[180:183], v[212:215], v[28:31]
  v_mfma_f32_16x16x32_bf16 v[28:31], v[176:179], v[196:199], v[28:31]
  s_waitcnt lgkmcnt(5)
  v_mfma_f32_16x16x32_bf16 v[32:35], v[204:207], a[136:139], v[32:35]
  ds_read_b128 a[64:67], v135 offset:18432
  ds_read_b128 a[48:51], v122 offset:52224
  v_mfma_f32_16x16x32_bf16 v[32:35], v[208:211], a[156:159], v[32:35]
  ds_write_b128 v122, v[20:23] offset:1024
  ds_write_b128 v122, v[24:27] offset:18432
  v_mfma_f32_16x16x32_bf16 v[36:39], v[208:211], a[0:3], v[36:39]
  ds_write_b128 v122, v[28:31] offset:35840
  v_mfma_f32_16x16x32_bf16 v[36:39], v[204:207], a[140:143], v[36:39]
  v_mfma_f32_16x16x32_bf16 v[40:43], v[204:207], v[236:239], v[40:43]
  v_mfma_f32_16x16x32_bf16 v[40:43], v[208:211], v[192:195], v[40:43]
  v_mfma_f32_16x16x32_bf16 v[44:47], v[208:211], v[212:215], v[44:47]
  v_mfma_f32_16x16x32_bf16 v[44:47], v[204:207], v[196:199], v[44:47]
  s_waitcnt lgkmcnt(8)
  v_mfma_f32_16x16x32_bf16 v[48:51], v[220:223], a[136:139], v[48:51]
  v_mfma_f32_16x16x32_bf16 v[48:51], a[44:47], a[156:159], v[48:51]
  v_mfma_f32_16x16x32_bf16 v[52:55], a[44:47], a[0:3], v[52:55]
  ds_write_b128 v122, v[36:39] offset:2048
  v_mfma_f32_16x16x32_bf16 v[52:55], v[220:223], a[140:143], v[52:55]
  ds_write_b128 v122, v[40:43] offset:19456
  v_mfma_f32_16x16x32_bf16 v[56:59], v[220:223], v[236:239], v[56:59]
  ds_write_b128 v122, v[44:47] offset:49152
  v_mfma_f32_16x16x32_bf16 v[56:59], a[44:47], v[192:195], v[56:59]
  v_mfma_f32_16x16x32_bf16 v[60:63], a[44:47], v[212:215], v[60:63]
  v_mfma_f32_16x16x32_bf16 v[60:63], v[220:223], v[196:199], v[60:63]
  s_waitcnt lgkmcnt(6)
  v_mfma_f32_16x16x32_bf16 v[64:67], a[64:67], a[136:139], v[64:67]
  ds_write_b128 v122, v[52:55] offset:3072
  v_mfma_f32_16x16x32_bf16 v[64:67], a[48:51], a[156:159], v[64:67]
  v_mfma_f32_16x16x32_bf16 v[68:71], a[48:51], a[0:3], v[68:71]
  v_mfma_f32_16x16x32_bf16 v[68:71], a[64:67], a[140:143], v[68:71]
  ds_write_b128 v122, v[56:59] offset:32768
  v_mfma_f32_16x16x32_bf16 v[72:75], a[64:67], v[236:239], v[72:75]
  ds_write_b128 v122, v[60:63] offset:50176
  v_mfma_f32_16x16x32_bf16 v[72:75], a[48:51], v[192:195], v[72:75]
  v_mfma_f32_16x16x32_bf16 v[76:79], a[48:51], v[212:215], v[76:79]
  v_mfma_f32_16x16x32_bf16 v[76:79], a[64:67], v[196:199], v[76:79]
  s_nop 1
  ds_write_b128 v122, v[68:71] offset:16384
  s_nop 2
  ds_write_b128 v122, v[72:75] offset:33792
  s_nop 0
  ds_write_b128 v122, v[76:79] offset:51200
  s_waitcnt lgkmcnt(0)
  s_barrier
  ds_read_b128 v[4:7], v80 offset:0
  ds_read_b128 v[8:11], v81 offset:17408
  ds_read_b128 v[12:15], v82 offset:34816
  ds_read_b128 v[20:23], v80 offset:1024
  ds_read_b128 v[24:27], v81 offset:18432
  ds_read_b128 v[28:31], v82 offset:35840
  ds_read_b128 v[36:39], v80 offset:2048
  ds_read_b128 v[40:43], v81 offset:19456
  ds_read_b128 v[44:47], v82 offset:49152
  ds_read_b128 v[52:55], v80 offset:3072
  ds_read_b128 v[56:59], v81 offset:32768
  ds_read_b128 v[60:63], v82 offset:50176
  ds_read_b128 v[68:71], v80 offset:16384
  ds_read_b128 v[72:75], v81 offset:33792
  ds_read_b128 v[76:79], v82 offset:51200
  s_waitcnt vmcnt(4)
  v_add_f32 v0, v0, v136
  v_add_f32 v1, v1, v137
  v_add_f32 v2, v2, v138
  v_add_f32 v3, v3, v139
  s_waitcnt lgkmcnt(13)
  v_add_f32 v4, v4, v8
  v_add_f32 v5, v5, v9
  v_add_f32 v6, v6, v10
  v_add_f32 v7, v7, v11
  s_waitcnt lgkmcnt(12)
  v_add_f32 v0, v0, v12
  v_add_f32 v1, v1, v13
  v_add_f32 v2, v2, v14
  v_add_f32 v3, v3, v15
  v_add_f32 v0, v0, v4
  v_add_f32 v1, v1, v5
  v_add_f32 v2, v2, v6
  v_add_f32 v3, v3, v7
  v_cvt_pk_bf16_f32 v4, v0, v1
  v_cvt_pk_bf16_f32 v5, v2, v3
  v_lshlrev_b32 v0, 16, v4
  v_and_b32 v1, s34, v4
  v_lshlrev_b32 v2, 16, v5
  v_and_b32 v3, s34, v5
  v_mul_f32 v0, v0, v90
  v_mul_f32 v1, v1, v91
  v_mul_f32 v2, v2, v92
  v_mul_f32 v3, v3, v93
  v_cvt_pk_bf16_f32 v4, v0, v1
  v_cvt_pk_bf16_f32 v5, v2, v3
  v_lshlrev_b32 v0, 16, v4
  v_and_b32 v1, s34, v4
  v_lshlrev_b32 v2, 16, v5
  v_and_b32 v3, s34, v5
  v_add_f32 v0, v0, v156
  v_add_f32 v1, v1, v157
  v_add_f32 v2, v2, v158
  v_add_f32 v3, v3, v159
  v_cvt_pk_bf16_f32 v4, v0, v1
  v_cvt_pk_bf16_f32 v5, v2, v3
  s_waitcnt vmcnt(3)
  v_add_f32 v16, v16, v140
  v_add_f32 v17, v17, v141
  v_add_f32 v18, v18, v142
  v_add_f32 v19, v19, v143
  s_waitcnt lgkmcnt(10)
  v_add_f32 v20, v20, v24
  v_add_f32 v21, v21, v25
  v_add_f32 v22, v22, v26
  v_add_f32 v23, v23, v27
  s_waitcnt lgkmcnt(9)
  v_add_f32 v16, v16, v28
  v_add_f32 v17, v17, v29
  v_add_f32 v18, v18, v30
  v_add_f32 v19, v19, v31
  v_add_f32 v16, v16, v20
  v_add_f32 v17, v17, v21
  v_add_f32 v18, v18, v22
  v_add_f32 v19, v19, v23
  v_cvt_pk_bf16_f32 v20, v16, v17
  v_cvt_pk_bf16_f32 v21, v18, v19
  v_lshlrev_b32 v16, 16, v20
  v_and_b32 v17, s34, v20
  v_lshlrev_b32 v18, 16, v21
  v_and_b32 v19, s34, v21
  v_mul_f32 v16, v16, v94
  v_mul_f32 v17, v17, v95
  v_mul_f32 v18, v18, v96
  v_mul_f32 v19, v19, v97
  v_cvt_pk_bf16_f32 v20, v16, v17
  v_cvt_pk_bf16_f32 v21, v18, v19
  v_lshlrev_b32 v16, 16, v20
  v_and_b32 v17, s34, v20
  v_lshlrev_b32 v18, 16, v21
  v_and_b32 v19, s34, v21
  v_add_f32 v16, v16, v160
  v_add_f32 v17, v17, v161
  v_add_f32 v18, v18, v162
  v_add_f32 v19, v19, v163
  v_cvt_pk_bf16_f32 v6, v16, v17
  v_cvt_pk_bf16_f32 v7, v18, v19
  s_nop 0
  v_permlane16_swap_b32 v4, v6
  v_permlane16_swap_b32 v5, v7
  buffer_store_dwordx4 v[4:7], v83, s[16:19], 0 offen offset:0
  s_waitcnt vmcnt(3)
  v_add_f32 v32, v32, v144
  v_add_f32 v33, v33, v145
  v_add_f32 v34, v34, v146
  v_add_f32 v35, v35, v147
  s_waitcnt lgkmcnt(7)
  v_add_f32 v36, v36, v40
  v_add_f32 v37, v37, v41
  v_add_f32 v38, v38, v42
  v_add_f32 v39, v39, v43
  s_waitcnt lgkmcnt(6)
  v_add_f32 v32, v32, v44
  v_add_f32 v33, v33, v45
  v_add_f32 v34, v34, v46
  v_add_f32 v35, v35, v47
  v_add_f32 v32, v32, v36
  v_add_f32 v33, v33, v37
  v_add_f32 v34, v34, v38
  v_add_f32 v35, v35, v39
  v_cvt_pk_bf16_f32 v36, v32, v33
  v_cvt_pk_bf16_f32 v37, v34, v35
  v_lshlrev_b32 v32, 16, v36
  v_and_b32 v33, s34, v36
  v_lshlrev_b32 v34, 16, v37
  v_and_b32 v35, s34, v37
  v_mul_f32 v32, v32, v98
  v_mul_f32 v33, v33, v99
  v_mul_f32 v34, v34, v100
  v_mul_f32 v35, v35, v101
  v_cvt_pk_bf16_f32 v36, v32, v33
  v_cvt_pk_bf16_f32 v37, v34, v35
  v_lshlrev_b32 v32, 16, v36
  v_and_b32 v33, s34, v36
  v_lshlrev_b32 v34, 16, v37
  v_and_b32 v35, s34, v37
  v_add_f32 v32, v32, v164
  v_add_f32 v33, v33, v165
  v_add_f32 v34, v34, v166
  v_add_f32 v35, v35, v167
  v_cvt_pk_bf16_f32 v36, v32, v33
  v_cvt_pk_bf16_f32 v37, v34, v35
  s_waitcnt vmcnt(2)
  v_add_f32 v48, v48, v148
  v_add_f32 v49, v49, v149
  v_add_f32 v50, v50, v150
  v_add_f32 v51, v51, v151
  s_waitcnt lgkmcnt(4)
  v_add_f32 v52, v52, v56
  v_add_f32 v53, v53, v57
  v_add_f32 v54, v54, v58
  v_add_f32 v55, v55, v59
  s_waitcnt lgkmcnt(3)
  v_add_f32 v48, v48, v60
  v_add_f32 v49, v49, v61
  v_add_f32 v50, v50, v62
  v_add_f32 v51, v51, v63
  v_add_f32 v48, v48, v52
  v_add_f32 v49, v49, v53
  v_add_f32 v50, v50, v54
  v_add_f32 v51, v51, v55
  v_cvt_pk_bf16_f32 v52, v48, v49
  v_cvt_pk_bf16_f32 v53, v50, v51
  v_lshlrev_b32 v48, 16, v52
  v_and_b32 v49, s34, v52
  v_lshlrev_b32 v50, 16, v53
  v_and_b32 v51, s34, v53
  v_mul_f32 v48, v48, v102
  v_mul_f32 v49, v49, v103
  v_mul_f32 v50, v50, v104
  v_mul_f32 v51, v51, v105
  v_cvt_pk_bf16_f32 v52, v48, v49
  v_cvt_pk_bf16_f32 v53, v50, v51
  v_lshlrev_b32 v48, 16, v52
  v_and_b32 v49, s34, v52
  v_lshlrev_b32 v50, 16, v53
  v_and_b32 v51, s34, v53
  v_add_f32 v48, v48, v168
  v_add_f32 v49, v49, v169
  v_add_f32 v50, v50, v170
  v_add_f32 v51, v51, v171
  v_cvt_pk_bf16_f32 v38, v48, v49
  v_cvt_pk_bf16_f32 v39, v50, v51
  s_nop 0
  v_permlane16_swap_b32 v36, v38
  v_permlane16_swap_b32 v37, v39
  buffer_store_dwordx4 v[36:39], v83, s[16:19], 0 offen offset:64
  s_waitcnt vmcnt(2)
  v_add_f32 v64, v64, v152
  v_add_f32 v65, v65, v153
  v_add_f32 v66, v66, v154
  v_add_f32 v67, v67, v155
  s_waitcnt lgkmcnt(1)
  v_add_f32 v68, v68, v72
  v_add_f32 v69, v69, v73
  v_add_f32 v70, v70, v74
  v_add_f32 v71, v71, v75
  s_waitcnt lgkmcnt(0)
  v_add_f32 v64, v64, v76
  v_add_f32 v65, v65, v77
  v_add_f32 v66, v66, v78
  v_add_f32 v67, v67, v79
  v_add_f32 v64, v64, v68
  v_add_f32 v65, v65, v69
  v_add_f32 v66, v66, v70
  v_add_f32 v67, v67, v71
  v_cvt_pk_bf16_f32 v68, v64, v65
  v_cvt_pk_bf16_f32 v69, v66, v67
  v_lshlrev_b32 v64, 16, v68
  v_and_b32 v65, s34, v68
  v_lshlrev_b32 v66, 16, v69
  v_and_b32 v67, s34, v69
  v_mul_f32 v64, v64, v106
  v_mul_f32 v65, v65, v107
  v_mul_f32 v66, v66, v108
  v_mul_f32 v67, v67, v109
  v_cvt_pk_bf16_f32 v68, v64, v65
  v_cvt_pk_bf16_f32 v69, v66, v67
  v_lshlrev_b32 v64, 16, v68
  v_and_b32 v65, s34, v68
  v_lshlrev_b32 v66, 16, v69
  v_and_b32 v67, s34, v69
  v_add_f32 v64, v64, v172
  v_add_f32 v65, v65, v173
  v_add_f32 v66, v66, v174
  v_add_f32 v67, v67, v175
  v_cvt_pk_bf16_f32 v68, v64, v65
  v_cvt_pk_bf16_f32 v69, v66, v67
  buffer_store_dwordx2 v[68:69], v117, s[16:19], 0 offen offset:128
attn_end:
  s_endpgm
attn_redo:
  s_waitcnt vmcnt(0)
  v_accvgpr_write_b32 a0, 0
  v_accvgpr_write_b32 a1, 0
  v_accvgpr_write_b32 a2, 0
  v_accvgpr_write_b32 a3, 0
  v_accvgpr_write_b32 a4, 0
  v_accvgpr_write_b32 a5, 0
  v_accvgpr_write_b32 a6, 0
  v_accvgpr_write_b32 a7, 0
  v_accvgpr_write_b32 a8, 0
  v_accvgpr_write_b32 a9, 0
  v_accvgpr_write_b32 a10, 0
  v_accvgpr_write_b32 a11, 0
  v_accvgpr_write_b32 a12, 0
  v_accvgpr_write_b32 a13, 0
  v_accvgpr_write_b32 a14, 0
  v_accvgpr_write_b32 a15, 0
  v_accvgpr_write_b32 a16, 0
  v_accvgpr_write_b32 a17, 0
  v_accvgpr_write_b32 a18, 0
  v_accvgpr_write_b32 a19, 0
  v_accvgpr_write_b32 a20, 0
  v_accvgpr_write_b32 a21, 0
  v_accvgpr_write_b32 a22, 0
  v_accvgpr_write_b32 a23, 0
  v_accvgpr_write_b32 a24, 0
  v_accvgpr_write_b32 a25, 0
  v_accvgpr_write_b32 a26, 0
  v_accvgpr_write_b32 a27, 0
  v_accvgpr_write_b32 a28, 0
  v_accvgpr_write_b32 a29, 0
  v_accvgpr_write_b32 a30, 0
  v_accvgpr_write_b32 a31, 0
  v_accvgpr_write_b32 a32, 0
  v_accvgpr_write_b32 a33, 0
  v_accvgpr_write_b32 a34, 0
  v_accvgpr_write_b32 a35, 0
  v_accvgpr_write_b32 a36, 0
  v_accvgpr_write_b32 a37, 0
  v_accvgpr_write_b32 a38, 0
  v_accvgpr_write_b32 a39, 0
  v_accvgpr_write_b32 a40, 0
  v_accvgpr_write_b32 a41, 0
  v_accvgpr_write_b32 a42, 0
  v_accvgpr_write_b32 a43, 0
  v_accvgpr_write_b32 a44, 0
  v_accvgpr_write_b32 a45, 0
  v_accvgpr_write_b32 a46, 0
  v_accvgpr_write_b32 a47, 0
  v_accvgpr_write_b32 a48, 0
  v_accvgpr_write_b32 a49, 0
  v_accvgpr_write_b32 a50, 0
  v_accvgpr_write_b32 a51, 0
  v_accvgpr_write_b32 a52, 0
  v_accvgpr_write_b32 a53, 0
  v_accvgpr_write_b32 a54, 0
  v_accvgpr_write_b32 a55, 0
  v_accvgpr_write_b32 a56, 0
  v_accvgpr_write_b32 a57, 0
  v_accvgpr_write_b32 a58, 0
  v_accvgpr_write_b32 a59, 0
  v_accvgpr_write_b32 a60, 0
  v_accvgpr_write_b32 a61, 0
  v_accvgpr_write_b32 a62, 0
  v_accvgpr_write_b32 a63, 0
  v_accvgpr_write_b32 a64, 0
  v_accvgpr_write_b32 a65, 0
  v_accvgpr_write_b32 a66, 0
  v_accvgpr_write_b32 a67, 0
  v_accvgpr_write_b32 a68, 0
  v_accvgpr_write_b32 a69, 0
  v_accvgpr_write_b32 a70, 0
  v_accvgpr_write_b32 a71, 0
  v_accvgpr_write_b32 a72, 0
  v_accvgpr_write_b32 a73, 0
  v_accvgpr_write_b32 a74, 0
  v_accvgpr_write_b32 a75, 0
  v_accvgpr_write_b32 a76, 0
  v_accvgpr_write_b32 a77, 0
  v_accvgpr_write_b32 a78, 0
  v_accvgpr_write_b32 a79, 0
  v_accvgpr_write_b32 a80, 0
  v_accvgpr_write_b32 a81, 0
  v_accvgpr_write_b32 a82, 0
  v_accvgpr_write_b32 a83, 0
  v_accvgpr_write_b32 a84, 0
  v_accvgpr_write_b32 a85, 0
  v_accvgpr_write_b32 a86, 0
  v_accvgpr_write_b32 a87, 0
  v_accvgpr_write_b32 a88, 0
  v_accvgpr_write_b32 a89, 0
  v_accvgpr_write_b32 a90, 0
  v_accvgpr_write_b32 a91, 0
  v_accvgpr_write_b32 a92, 0
  v_accvgpr_write_b32 a93, 0
  v_accvgpr_write_b32 a94, 0
  v_accvgpr_write_b32 a95, 0
  v_accvgpr_write_b32 a96, 0
  v_accvgpr_write_b32 a97, 0
  v_accvgpr_write_b32 a98, 0
  v_accvgpr_write_b32 a99, 0
  v_accvgpr_write_b32 a100, 0
  v_accvgpr_write_b32 a101, 0
  v_accvgpr_write_b32 a102, 0
  v_accvgpr_write_b32 a103, 0
  v_accvgpr_write_b32 a104, 0
  v_accvgpr_write_b32 a105, 0
  v_accvgpr_write_b32 a106, 0
  v_accvgpr_write_b32 a107, 0
  v_accvgpr_write_b32 a108, 0
  v_accvgpr_write_b32 a109, 0
  v_accvgpr_write_b32 a110, 0
  v_accvgpr_write_b32 a111, 0
  v_accvgpr_write_b32 a112, 0
  v_accvgpr_write_b32 a113, 0
  v_accvgpr_write_b32 a114, 0
  v_accvgpr_write_b32 a115, 0
  v_accvgpr_write_b32 a116, 0
  v_accvgpr_write_b32 a117, 0
  v_accvgpr_write_b32 a118, 0
  v_accvgpr_write_b32 a119, 0
  v_accvgpr_write_b32 a120, 0
  v_accvgpr_write_b32 a121, 0
  v_accvgpr_write_b32 a122, 0
  v_accvgpr_write_b32 a123, 0
  v_accvgpr_write_b32 a124, 0
  v_accvgpr_write_b32 a125, 0
  v_accvgpr_write_b32 a126, 0
  v_accvgpr_write_b32 a127, 0
  v_mov_b32 v208, 0
  v_mov_b32 v249, 0xff800000
  v_mov_b32 v209, 0
  v_mov_b32 v250, 0xff800000
  v_mov_b32 v210, 0
  v_mov_b32 v251, 0xff800000
  v_mov_b32 v211, 0
  v_mov_b32 v252, 0xff800000
  s_mov_b32 s29, 0
attn_slow:
  s_barrier
  s_add_u32 m0, s28, 49152
  s_nop 0
  buffer_load_dwordx4 v232, s[12:15], s29 offen offset:0 lds
  buffer_load_dwordx4 v233, s[12:15], s29 offen offset:1024 lds
  buffer_load_dwordx4 v234, s[12:15], s29 offen offset:2048 lds
  buffer_load_dwordx4 v235, s[12:15], s29 offen offset:3072 lds
  s_add_u32 m0, s28, 114688
  s_nop 0
  buffer_load_dwordx4 v236, s[16:19], s29 offen offset:0 lds
  buffer_load_dwordx4 v237, s[16:19], s29 offen offset:1024 lds
  buffer_load_dwordx4 v236, s[16:19], s29 offen offset:2048 lds
  buffer_load_dwordx4 v237, s[16:19], s29 offen offset:3072 lds
  s_waitcnt vmcnt(0)
  s_barrier
  ds_read_b128 a[128:131], v212 offset:49152
  ds_read_b128 a[132:135], v213 offset:49152
  ds_read_b128 a[136:139], v214 offset:49152
  ds_read_b128 a[140:143], v215 offset:49152
  s_waitcnt lgkmcnt(3)
  v_mfma_f32_16x16x32_bf16 v[0:3], a[128:131], v[128:131], 0
  s_waitcnt lgkmcnt(2)
  v_mfma_f32_16x16x32_bf16 v[0:3], a[132:135], v[132:135], v[0:3]
  s_waitcnt lgkmcnt(1)
  v_mfma_f32_16x16x32_bf16 v[0:3], a[136:139], v[136:139], v[0:3]
  s_waitcnt lgkmcnt(0)
  v_mfma_f32_16x16x32_bf16 v[0:3], a[140:143], v[140:143], v[0:3]
  v_mfma_f32_16x16x32_bf16 v[8:11], a[140:143], v[156:159], 0
  v_mfma_f32_16x16x32_bf16 v[8:11], a[136:139], v[152:155], v[8:11]
  v_mfma_f32_16x16x32_bf16 v[8:11], a[132:135], v[148:151], v[8:11]
  v_mfma_f32_16x16x32_bf16 v[8:11], a[128:131], v[144:147], v[8:11]
  v_mfma_f32_16x16x32_bf16 v[16:19], a[128:131], v[160:163], 0
  v_mfma_f32_16x16x32_bf16 v[16:19], a[132:135], v[164:167], v[16:19]
  v_mfma_f32_16x16x32_bf16 v[16:19], a[136:139], v[168:171], v[16:19]
  v_mfma_f32_16x16x32_bf16 v[16:19], a[140:143], v[172:175], v[16:19]
  v_mfma_f32_16x16x32_bf16 v[24:27], a[140:143], v[188:191], 0
  v_mfma_f32_16x16x32_bf16 v[24:27], a[136:139], v[184:187], v[24:27]
  v_mfma_f32_16x16x32_bf16 v[24:27], a[132:135], v[180:183], v[24:27]
  v_mfma_f32_16x16x32_bf16 v[24:27], a[128:131], v[176:179], v[24:27]
  ds_read_b128 a[144:147], v212 offset:53248
  ds_read_b128 a[148:151], v213 offset:53248
  ds_read_b128 a[152:155], v214 offset:53248
  ds_read_b128 a[156:159], v215 offset:53248
  s_waitcnt lgkmcnt(3)
  v_mfma_f32_16x16x32_bf16 v[4:7], a[144:147], v[128:131], 0
  s_waitcnt lgkmcnt(2)
  v_mfma_f32_16x16x32_bf16 v[4:7], a[148:151], v[132:135], v[4:7]
  s_waitcnt lgkmcnt(1)
  v_mfma_f32_16x16x32_bf16 v[4:7], a[152:155], v[136:139], v[4:7]
  s_waitcnt lgkmcnt(0)
  v_mfma_f32_16x16x32_bf16 v[4:7], a[156:159], v[140:143], v[4:7]
  v_mfma_f32_16x16x32_bf16 v[12:15], a[156:159], v[156:159], 0
  v_mfma_f32_16x16x32_bf16 v[12:15], a[152:155], v[152:155], v[12:15]
  v_mfma_f32_16x16x32_bf16 v[12:15], a[148:151], v[148:151], v[12:15]
  v_mfma_f32_16x16x32_bf16 v[12:15], a[144:147], v[144:147], v[12:15]
  v_mfma_f32_16x16x32_bf16 v[20:23], a[144:147], v[160:163], 0
  v_mfma_f32_16x16x32_bf16 v[20:23], a[148:151], v[164:167], v[20:23]
  v_mfma_f32_16x16x32_bf16 v[20:23], a[152:155], v[168:171], v[20:23]
  v_mfma_f32_16x16x32_bf16 v[20:23], a[156:159], v[172:175], v[20:23]
  v_mfma_f32_16x16x32_bf16 v[28:31], a[156:159], v[188:191], 0
  v_mfma_f32_16x16x32_bf16 v[28:31], a[152:155], v[184:187], v[28:31]
  v_mfma_f32_16x16x32_bf16 v[28:31], a[148:151], v[180:183], v[28:31]
  v_mfma_f32_16x16x32_bf16 v[28:31], a[144:147], v[176:179], v[28:31]
  ds_read_b128 a[128:131], v212 offset:57344
  ds_read_b128 a[132:135], v213 offset:57344
  ds_read_b128 a[136:139], v214 offset:57344
  ds_read_b128 a[140:143], v215 offset:57344
  s_waitcnt lgkmcnt(3)
  v_mfma_f32_16x16x32_bf16 v[32:35], a[128:131], v[128:131], 0
  s_waitcnt lgkmcnt(2)
  v_mfma_f32_16x16x32_bf16 v[32:35], a[132:135], v[132:135], v[32:35]
  s_waitcnt lgkmcnt(1)
  v_mfma_f32_16x16x32_bf16 v[32:35], a[136:139], v[136:139], v[32:35]
  s_waitcnt lgkmcnt(0)
  v_mfma_f32_16x16x32_bf16 v[32:35], a[140:143], v[140:143], v[32:35]
  v_mfma_f32_16x16x32_bf16 v[40:43], a[140:143], v[156:159], 0
  v_mfma_f32_16x16x32_bf16 v[40:43], a[136:139], v[152:155], v[40:43]
  v_mfma_f32_16x16x32_bf16 v[40:43], a[132:135], v[148:151], v[40:43]
  v_mfma_f32_16x16x32_bf16 v[40:43], a[128:131], v[144:147], v[40:43]
  v_mfma_f32_16x16x32_bf16 v[48:51], a[128:131], v[160:163], 0
  v_mfma_f32_16x16x32_bf16 v[48:51], a[132:135], v[164:167], v[48:51]
  v_mfma_f32_16x16x32_bf16 v[48:51], a[136:139], v[168:171], v[48:51]
  v_mfma_f32_16x16x32_bf16 v[48:51], a[140:143], v[172:175], v[48:51]
  v_mfma_f32_16x16x32_bf16 v[56:59], a[140:143], v[188:191], 0
  v_mfma_f32_16x16x32_bf16 v[56:59], a[136:139], v[184:187], v[56:59]
  v_mfma_f32_16x16x32_bf16 v[56:59], a[132:135], v[180:183], v[56:59]
  v_mfma_f32_16x16x32_bf16 v[56:59], a[128:131], v[176:179], v[56:59]
  ds_read_b128 a[144:147], v212 offset:61440
  ds_read_b128 a[148:151], v213 offset:61440
  ds_read_b128 a[152:155], v214 offset:61440
  ds_read_b128 a[156:159], v215 offset:61440
  s_waitcnt lgkmcnt(3)
  v_mfma_f32_16x16x32_bf16 v[36:39], a[144:147], v[128:131], 0
  s_waitcnt lgkmcnt(2)
  v_mfma_f32_16x16x32_bf16 v[36:39], a[148:151], v[132:135], v[36:39]
  s_waitcnt lgkmcnt(1)
  v_mfma_f32_16x16x32_bf16 v[36:39], a[152:155], v[136:139], v[36:39]
  s_waitcnt lgkmcnt(0)
  v_mfma_f32_16x16x32_bf16 v[36:39], a[156:159], v[140:143], v[36:39]
  v_mfma_f32_16x16x32_bf16 v[44:47], a[156:159], v[156:159], 0
  v_mfma_f32_16x16x32_bf16 v[44:47], a[152:155], v[152:155], v[44:47]
  v_mfma_f32_16x16x32_bf16 v[44:47], a[148:151], v[148:151], v[44:47]
  v_mfma_f32_16x16x32_bf16 v[44:47], a[144:147], v[144:147], v[44:47]
  v_mfma_f32_16x16x32_bf16 v[52:55], a[144:147], v[160:163], 0
  v_mfma_f32_16x16x32_bf16 v[52:55], a[148:151], v[164:167], v[52:55]
  v_mfma_f32_16x16x32_bf16 v[52:55], a[152:155], v[168:171], v[52:55]
  v_mfma_f32_16x16x32_bf16 v[52:55], a[156:159], v[172:175], v[52:55]
  v_mfma_f32_16x16x32_bf16 v[60:63], a[156:159], v[188:191], 0
  v_mfma_f32_16x16x32_bf16 v[60:63], a[152:155], v[184:187], v[60:63]
  v_mfma_f32_16x16x32_bf16 v[60:63], a[148:151], v[180:183], v[60:63]
  v_mfma_f32_16x16x32_bf16 v[60:63], a[144:147], v[176:179], v[60:63]
  v_mov_b32 v192, v249
  v_max3_f32 v192, v192, v0, v1
  v_max3_f32 v192, v192, v2, v3
  v_max3_f32 v192, v192, v4, v5
  v_max3_f32 v192, v192, v6, v7
  v_max3_f32 v192, v192, v32, v33
  v_max3_f32 v192, v192, v34, v35
  v_max3_f32 v192, v192, v36, v37
  v_max3_f32 v192, v192, v38, v39
  v_mov_b32 v245, v192
  s_nop 1
  v_permlane16_swap_b32 v192, v245
  v_max_f32 v192, v192, v245
  v_mov_b32 v245, v192
  s_nop 1
  v_permlane32_swap_b32 v192, v245
  v_max_f32 v192, v192, v245
  v_sub_f32 v193, v249, v192
  v_exp_f32 v193, v193
  v_mov_b32 v249, v192
  v_mul_f32 v208, v208, v193
  v_sub_f32 v0, v0, v192
  v_sub_f32 v1, v1, v192
  v_sub_f32 v2, v2, v192
  v_sub_f32 v3, v3, v192
  v_sub_f32 v4, v4, v192
  v_sub_f32 v5, v5, v192
  v_sub_f32 v6, v6, v192
  v_sub_f32 v7, v7, v192
  v_sub_f32 v32, v32, v192
  v_sub_f32 v33, v33, v192
  v_sub_f32 v34, v34, v192
  v_sub_f32 v35, v35, v192
  v_sub_f32 v36, v36, v192
  v_sub_f32 v37, v37, v192
  v_sub_f32 v38, v38, v192
  v_sub_f32 v39, v39, v192
  v_exp_f32 v0, v0
  v_exp_f32 v1, v1
  v_add_f32 v208, v208, v0
  v_exp_f32 v2, v2
  v_add_f32 v208, v208, v1
  v_cvt_pk_bf16_f32 v0, v0, v1
  v_exp_f32 v3, v3
  v_add_f32 v208, v208, v2
  v_add_f32 v208, v208, v3
  v_cvt_pk_bf16_f32 v1, v2, v3
  v_exp_f32 v4, v4
  v_exp_f32 v5, v5
  v_add_f32 v208, v208, v4
  v_exp_f32 v6, v6
  v_add_f32 v208, v208, v5
  v_cvt_pk_bf16_f32 v2, v4, v5
  v_exp_f32 v7, v7
  v_add_f32 v208, v208, v6
  v_add_f32 v208, v208, v7
  v_cvt_pk_bf16_f32 v3, v6, v7
  v_exp_f32 v32, v32
  v_exp_f32 v33, v33
  v_add_f32 v208, v208, v32
  v_exp_f32 v34, v34
  v_add_f32 v208, v208, v33
  v_cvt_pk_bf16_f32 v32, v32, v33
  v_exp_f32 v35, v35
  v_add_f32 v208, v208, v34
  v_add_f32 v208, v208, v35
  v_cvt_pk_bf16_f32 v33, v34, v35
  v_exp_f32 v36, v36
  v_exp_f32 v37, v37
  v_add_f32 v208, v208, v36
  v_exp_f32 v38, v38
  v_add_f32 v208, v208, v37
  v_cvt_pk_bf16_f32 v34, v36, v37
  v_exp_f32 v39, v39
  v_add_f32 v208, v208, v38
  v_add_f32 v208, v208, v39
  v_cvt_pk_bf16_f32 v35, v38, v39
  v_accvgpr_read_b32 v64, a0
  v_accvgpr_read_b32 v65, a1
  v_accvgpr_read_b32 v66, a2
  v_accvgpr_read_b32 v67, a3
  v_mul_f32 v64, v64, v193
  v_mul_f32 v65, v65, v193
  v_mul_f32 v66, v66, v193
  v_mul_f32 v67, v67, v193
  v_accvgpr_write_b32 a0, v64
  v_accvgpr_write_b32 a1, v65
  v_accvgpr_write_b32 a2, v66
  v_accvgpr_write_b32 a3, v67
  v_accvgpr_read_b32 v64, a16
  v_accvgpr_read_b32 v65, a17
  v_accvgpr_read_b32 v66, a18
  v_accvgpr_read_b32 v67, a19
  v_mul_f32 v64, v64, v193
  v_mul_f32 v65, v65, v193
  v_mul_f32 v66, v66, v193
  v_mul_f32 v67, v67, v193
  v_accvgpr_write_b32 a16, v64
  v_accvgpr_write_b32 a17, v65
  v_accvgpr_write_b32 a18, v66
  v_accvgpr_write_b32 a19, v67
  v_accvgpr_read_b32 v64, a32
  v_accvgpr_read_b32 v65, a33
  v_accvgpr_read_b32 v66, a34
  v_accvgpr_read_b32 v67, a35
  v_mul_f32 v64, v64, v193
  v_mul_f32 v65, v65, v193
  v_mul_f32 v66, v66, v193
  v_mul_f32 v67, v67, v193
  v_accvgpr_write_b32 a32, v64
  v_accvgpr_write_b32 a33, v65
  v_accvgpr_write_b32 a34, v66
  v_accvgpr_write_b32 a35, v67
  v_accvgpr_read_b32 v64, a48
  v_accvgpr_read_b32 v65, a49
  v_accvgpr_read_b32 v66, a50
  v_accvgpr_read_b32 v67, a51
  v_mul_f32 v64, v64, v193
  v_mul_f32 v65, v65, v193
  v_mul_f32 v66, v66, v193
  v_mul_f32 v67, v67, v193
  v_accvgpr_write_b32 a48, v64
  v_accvgpr_write_b32 a49, v65
  v_accvgpr_write_b32 a50, v66
  v_accvgpr_write_b32 a51, v67
  v_accvgpr_read_b32 v64, a64
  v_accvgpr_read_b32 v65, a65
  v_accvgpr_read_b32 v66, a66
  v_accvgpr_read_b32 v67, a67
  v_mul_f32 v64, v64, v193
  v_mul_f32 v65, v65, v193
  v_mul_f32 v66, v66, v193
  v_mul_f32 v67, v67, v193
  v_accvgpr_write_b32 a64, v64
  v_accvgpr_write_b32 a65, v65
  v_accvgpr_write_b32 a66, v66
  v_accvgpr_write_b32 a67, v67
  v_accvgpr_read_b32 v64, a80
  v_accvgpr_read_b32 v65, a81
  v_accvgpr_read_b32 v66, a82
  v_accvgpr_read_b32 v67, a83
  v_mul_f32 v64, v64, v193
  v_mul_f32 v65, v65, v193
  v_mul_f32 v66, v66, v193
  v_mul_f32 v67, v67, v193
  v_accvgpr_write_b32 a80, v64
  v_accvgpr_write_b32 a81, v65
  v_accvgpr_write_b32 a82, v66
  v_accvgpr_write_b32 a83, v67
  v_accvgpr_read_b32 v64, a96
  v_accvgpr_read_b32 v65, a97
  v_accvgpr_read_b32 v66, a98
  v_accvgpr_read_b32 v67, a99
  v_mul_f32 v64, v64, v193
  v_mul_f32 v65, v65, v193
  v_mul_f32 v66, v66, v193
  v_mul_f32 v67, v67, v193
  v_accvgpr_write_b32 a96, v64
  v_accvgpr_write_b32 a97, v65
  v_accvgpr_write_b32 a98, v66
  v_accvgpr_write_b32 a99, v67
  v_accvgpr_read_b32 v64, a112
  v_accvgpr_read_b32 v65, a113
  v_accvgpr_read_b32 v66, a114
  v_accvgpr_read_b32 v67, a115
  v_mul_f32 v64, v64, v193
  v_mul_f32 v65, v65, v193
  v_mul_f32 v66, v66, v193
  v_mul_f32 v67, v67, v193
  v_accvgpr_write_b32 a112, v64
  v_accvgpr_write_b32 a113, v65
  v_accvgpr_write_b32 a114, v66
  v_accvgpr_write_b32 a115, v67
  v_mov_b32 v196, v250
  v_max3_f32 v196, v196, v8, v9
  v_max3_f32 v196, v196, v10, v11
  v_max3_f32 v196, v196, v12, v13
  v_max3_f32 v196, v196, v14, v15
  v_max3_f32 v196, v196, v40, v41
  v_max3_f32 v196, v196, v42, v43
  v_max3_f32 v196, v196, v44, v45
  v_max3_f32 v196, v196, v46, v47
  v_mov_b32 v245, v196
  s_nop 1
  v_permlane16_swap_b32 v196, v245
  v_max_f32 v196, v196, v245
  v_mov_b32 v245, v196
  s_nop 1
  v_permlane32_swap_b32 v196, v245
  v_max_f32 v196, v196, v245
  v_sub_f32 v197, v250, v196
  v_exp_f32 v197, v197
  v_mov_b32 v250, v196
  v_mul_f32 v209, v209, v197
  v_sub_f32 v8, v8, v196
  v_sub_f32 v9, v9, v196
  v_sub_f32 v10, v10, v196
  v_sub_f32 v11, v11, v196
  v_sub_f32 v12, v12, v196
  v_sub_f32 v13, v13, v196
  v_sub_f32 v14, v14, v196
  v_sub_f32 v15, v15, v196
  v_sub_f32 v40, v40, v196
  v_sub_f32 v41, v41, v196
  v_sub_f32 v42, v42, v196
  v_sub_f32 v43, v43, v196
  v_sub_f32 v44, v44, v196
  v_sub_f32 v45, v45, v196
  v_sub_f32 v46, v46, v196
  v_sub_f32 v47, v47, v196
  v_exp_f32 v8, v8
  v_exp_f32 v9, v9
  v_add_f32 v209, v209, v8
  v_exp_f32 v10, v10
  v_add_f32 v209, v209, v9
  v_cvt_pk_bf16_f32 v8, v8, v9
  v_exp_f32 v11, v11
  v_add_f32 v209, v209, v10
  v_add_f32 v209, v209, v11
  v_cvt_pk_bf16_f32 v9, v10, v11
  v_exp_f32 v12, v12
  v_exp_f32 v13, v13
  v_add_f32 v209, v209, v12
  v_exp_f32 v14, v14
  v_add_f32 v209, v209, v13
  v_cvt_pk_bf16_f32 v10, v12, v13
  v_exp_f32 v15, v15
  v_add_f32 v209, v209, v14
  v_add_f32 v209, v209, v15
  v_cvt_pk_bf16_f32 v11, v14, v15
  v_exp_f32 v40, v40
  v_exp_f32 v41, v41
  v_add_f32 v209, v209, v40
  v_exp_f32 v42, v42
  v_add_f32 v209, v209, v41
  v_cvt_pk_bf16_f32 v40, v40, v41
  v_exp_f32 v43, v43
  v_add_f32 v209, v209, v42
  v_add_f32 v209, v209, v43
  v_cvt_pk_bf16_f32 v41, v42, v43
  v_exp_f32 v44, v44
  v_exp_f32 v45, v45
  v_add_f32 v209, v209, v44
  v_exp_f32 v46, v46
  v_add_f32 v209, v209, v45
  v_cvt_pk_bf16_f32 v42, v44, v45
  v_exp_f32 v47, v47
  v_add_f32 v209, v209, v46
  v_add_f32 v209, v209, v47
  v_cvt_pk_bf16_f32 v43, v46, v47
  v_accvgpr_read_b32 v64, a4
  v_accvgpr_read_b32 v65, a5
  v_accvgpr_read_b32 v66, a6
  v_accvgpr_read_b32 v67, a7
  v_mul_f32 v64, v64, v197
  v_mul_f32 v65, v65, v197
  v_mul_f32 v66, v66, v197
  v_mul_f32 v67, v67, v197
  v_accvgpr_write_b32 a4, v64
  v_accvgpr_write_b32 a5, v65
  v_accvgpr_write_b32 a6, v66
  v_accvgpr_write_b32 a7, v67
  v_accvgpr_read_b32 v64, a20
  v_accvgpr_read_b32 v65, a21
  v_accvgpr_read_b32 v66, a22
  v_accvgpr_read_b32 v67, a23
  v_mul_f32 v64, v64, v197
  v_mul_f32 v65, v65, v197
  v_mul_f32 v66, v66, v197
  v_mul_f32 v67, v67, v197
  v_accvgpr_write_b32 a20, v64
  v_accvgpr_write_b32 a21, v65
  v_accvgpr_write_b32 a22, v66
  v_accvgpr_write_b32 a23, v67
  v_accvgpr_read_b32 v64, a36
  v_accvgpr_read_b32 v65, a37
  v_accvgpr_read_b32 v66, a38
  v_accvgpr_read_b32 v67, a39
  v_mul_f32 v64, v64, v197
  v_mul_f32 v65, v65, v197
  v_mul_f32 v66, v66, v197
  v_mul_f32 v67, v67, v197
  v_accvgpr_write_b32 a36, v64
  v_accvgpr_write_b32 a37, v65
  v_accvgpr_write_b32 a38, v66
  v_accvgpr_write_b32 a39, v67
  v_accvgpr_read_b32 v64, a52
  v_accvgpr_read_b32 v65, a53
  v_accvgpr_read_b32 v66, a54
  v_accvgpr_read_b32 v67, a55
  v_mul_f32 v64, v64, v197
  v_mul_f32 v65, v65, v197
  v_mul_f32 v66, v66, v197
  v_mul_f32 v67, v67, v197
  v_accvgpr_write_b32 a52, v64
  v_accvgpr_write_b32 a53, v65
  v_accvgpr_write_b32 a54, v66
  v_accvgpr_write_b32 a55, v67
  v_accvgpr_read_b32 v64, a68
  v_accvgpr_read_b32 v65, a69
  v_accvgpr_read_b32 v66, a70
  v_accvgpr_read_b32 v67, a71
  v_mul_f32 v64, v64, v197
  v_mul_f32 v65, v65, v197
  v_mul_f32 v66, v66, v197
  v_mul_f32 v67, v67, v197
  v_accvgpr_write_b32 a68, v64
  v_accvgpr_write_b32 a69, v65
  v_accvgpr_write_b32 a70, v66
  v_accvgpr_write_b32 a71, v67
  v_accvgpr_read_b32 v64, a84
  v_accvgpr_read_b32 v65, a85
  v_accvgpr_read_b32 v66, a86
  v_accvgpr_read_b32 v67, a87
  v_mul_f32 v64, v64, v197
  v_mul_f32 v65, v65, v197
  v_mul_f32 v66, v66, v197
  v_mul_f32 v67, v67, v197
  v_accvgpr_write_b32 a84, v64
  v_accvgpr_write_b32 a85, v65
  v_accvgpr_write_b32 a86, v66
  v_accvgpr_write_b32 a87, v67
  v_accvgpr_read_b32 v64, a100
  v_accvgpr_read_b32 v65, a101
  v_accvgpr_read_b32 v66, a102
  v_accvgpr_read_b32 v67, a103
  v_mul_f32 v64, v64, v197
  v_mul_f32 v65, v65, v197
  v_mul_f32 v66, v66, v197
  v_mul_f32 v67, v67, v197
  v_accvgpr_write_b32 a100, v64
  v_accvgpr_write_b32 a101, v65
  v_accvgpr_write_b32 a102, v66
  v_accvgpr_write_b32 a103, v67
  v_accvgpr_read_b32 v64, a116
  v_accvgpr_read_b32 v65, a117
  v_accvgpr_read_b32 v66, a118
  v_accvgpr_read_b32 v67, a119
  v_mul_f32 v64, v64, v197
  v_mul_f32 v65, v65, v197
  v_mul_f32 v66, v66, v197
  v_mul_f32 v67, v67, v197
  v_accvgpr_write_b32 a116, v64
  v_accvgpr_write_b32 a117, v65
  v_accvgpr_write_b32 a118, v66
  v_accvgpr_write_b32 a119, v67
  v_mov_b32 v200, v251
  v_max3_f32 v200, v200, v16, v17
  v_max3_f32 v200, v200, v18, v19
  v_max3_f32 v200, v200, v20, v21
  v_max3_f32 v200, v200, v22, v23
  v_max3_f32 v200, v200, v48, v49
  v_max3_f32 v200, v200, v50, v51
  v_max3_f32 v200, v200, v52, v53
  v_max3_f32 v200, v200, v54, v55
  v_mov_b32 v245, v200
  s_nop 1
  v_permlane16_swap_b32 v200, v245
  v_max_f32 v200, v200, v245
  v_mov_b32 v245, v200
  s_nop 1
  v_permlane32_swap_b32 v200, v245
  v_max_f32 v200, v200, v245
  v_sub_f32 v201, v251, v200
  v_exp_f32 v201, v201
  v_mov_b32 v251, v200
  v_mul_f32 v210, v210, v201
  v_sub_f32 v16, v16, v200
  v_sub_f32 v17, v17, v200
  v_sub_f32 v18, v18, v200
  v_sub_f32 v19, v19, v200
  v_sub_f32 v20, v20, v200
  v_sub_f32 v21, v21, v200
  v_sub_f32 v22, v22, v200
  v_sub_f32 v23, v23, v200
  v_sub_f32 v48, v48, v200
  v_sub_f32 v49, v49, v200
  v_sub_f32 v50, v50, v200
  v_sub_f32 v51, v51, v200
  v_sub_f32 v52, v52, v200
  v_sub_f32 v53, v53, v200
  v_sub_f32 v54, v54, v200
  v_sub_f32 v55, v55, v200
  v_exp_f32 v16, v16
  v_exp_f32 v17, v17
  v_add_f32 v210, v210, v16
  v_exp_f32 v18, v18
  v_add_f32 v210, v210, v17
  v_cvt_pk_bf16_f32 v16, v16, v17
  v_exp_f32 v19, v19
  v_add_f32 v210, v210, v18
  v_add_f32 v210, v210, v19
  v_cvt_pk_bf16_f32 v17, v18, v19
  v_exp_f32 v20, v20
  v_exp_f32 v21, v21
  v_add_f32 v210, v210, v20
  v_exp_f32 v22, v22
  v_add_f32 v210, v210, v21
  v_cvt_pk_bf16_f32 v18, v20, v21
  v_exp_f32 v23, v23
  v_add_f32 v210, v210, v22
  v_add_f32 v210, v210, v23
  v_cvt_pk_bf16_f32 v19, v22, v23
  v_exp_f32 v48, v48
  v_exp_f32 v49, v49
  v_add_f32 v210, v210, v48
  v_exp_f32 v50, v50
  v_add_f32 v210, v210, v49
  v_cvt_pk_bf16_f32 v48, v48, v49
  v_exp_f32 v51, v51
  v_add_f32 v210, v210, v50
  v_add_f32 v210, v210, v51
  v_cvt_pk_bf16_f32 v49, v50, v51
  v_exp_f32 v52, v52
  v_exp_f32 v53, v53
  v_add_f32 v210, v210, v52
  v_exp_f32 v54, v54
  v_add_f32 v210, v210, v53
  v_cvt_pk_bf16_f32 v50, v52, v53
  v_exp_f32 v55, v55
  v_add_f32 v210, v210, v54
  v_add_f32 v210, v210, v55
  v_cvt_pk_bf16_f32 v51, v54, v55
  v_accvgpr_read_b32 v64, a8
  v_accvgpr_read_b32 v65, a9
  v_accvgpr_read_b32 v66, a10
  v_accvgpr_read_b32 v67, a11
  v_mul_f32 v64, v64, v201
  v_mul_f32 v65, v65, v201
  v_mul_f32 v66, v66, v201
  v_mul_f32 v67, v67, v201
  v_accvgpr_write_b32 a8, v64
  v_accvgpr_write_b32 a9, v65
  v_accvgpr_write_b32 a10, v66
  v_accvgpr_write_b32 a11, v67
  v_accvgpr_read_b32 v64, a24
  v_accvgpr_read_b32 v65, a25
  v_accvgpr_read_b32 v66, a26
  v_accvgpr_read_b32 v67, a27
  v_mul_f32 v64, v64, v201
  v_mul_f32 v65, v65, v201
  v_mul_f32 v66, v66, v201
  v_mul_f32 v67, v67, v201
  v_accvgpr_write_b32 a24, v64
  v_accvgpr_write_b32 a25, v65
  v_accvgpr_write_b32 a26, v66
  v_accvgpr_write_b32 a27, v67
  v_accvgpr_read_b32 v64, a40
  v_accvgpr_read_b32 v65, a41
  v_accvgpr_read_b32 v66, a42
  v_accvgpr_read_b32 v67, a43
  v_mul_f32 v64, v64, v201
  v_mul_f32 v65, v65, v201
  v_mul_f32 v66, v66, v201
  v_mul_f32 v67, v67, v201
  v_accvgpr_write_b32 a40, v64
  v_accvgpr_write_b32 a41, v65
  v_accvgpr_write_b32 a42, v66
  v_accvgpr_write_b32 a43, v67
  v_accvgpr_read_b32 v64, a56
  v_accvgpr_read_b32 v65, a57
  v_accvgpr_read_b32 v66, a58
  v_accvgpr_read_b32 v67, a59
  v_mul_f32 v64, v64, v201
  v_mul_f32 v65, v65, v201
  v_mul_f32 v66, v66, v201
  v_mul_f32 v67, v67, v201
  v_accvgpr_write_b32 a56, v64
  v_accvgpr_write_b32 a57, v65
  v_accvgpr_write_b32 a58, v66
  v_accvgpr_write_b32 a59, v67
  v_accvgpr_read_b32 v64, a72
  v_accvgpr_read_b32 v65, a73
  v_accvgpr_read_b32 v66, a74
  v_accvgpr_read_b32 v67, a75
  v_mul_f32 v64, v64, v201
  v_mul_f32 v65, v65, v201
  v_mul_f32 v66, v66, v201
  v_mul_f32 v67, v67, v201
  v_accvgpr_write_b32 a72, v64
  v_accvgpr_write_b32 a73, v65
  v_accvgpr_write_b32 a74, v66
  v_accvgpr_write_b32 a75, v67
  v_accvgpr_read_b32 v64, a88
  v_accvgpr_read_b32 v65, a89
  v_accvgpr_read_b32 v66, a90
  v_accvgpr_read_b32 v67, a91
  v_mul_f32 v64, v64, v201
  v_mul_f32 v65, v65, v201
  v_mul_f32 v66, v66, v201
  v_mul_f32 v67, v67, v201
  v_accvgpr_write_b32 a88, v64
  v_accvgpr_write_b32 a89, v65
  v_accvgpr_write_b32 a90, v66
  v_accvgpr_write_b32 a91, v67
  v_accvgpr_read_b32 v64, a104
  v_accvgpr_read_b32 v65, a105
  v_accvgpr_read_b32 v66, a106
  v_accvgpr_read_b32 v67, a107
  v_mul_f32 v64, v64, v201
  v_mul_f32 v65, v65, v201
  v_mul_f32 v66, v66, v201
  v_mul_f32 v67, v67, v201
  v_accvgpr_write_b32 a104, v64
  v_accvgpr_write_b32 a105, v65
  v_accvgpr_write_b32 a106, v66
  v_accvgpr_write_b32 a107, v67
  v_accvgpr_read_b32 v64, a120
  v_accvgpr_read_b32 v65, a121
  v_accvgpr_read_b32 v66, a122
  v_accvgpr_read_b32 v67, a123
  v_mul_f32 v64, v64, v201
  v_mul_f32 v65, v65, v201
  v_mul_f32 v66, v66, v201
  v_mul_f32 v67, v67, v201
  v_accvgpr_write_b32 a120, v64
  v_accvgpr_write_b32 a121, v65
  v_accvgpr_write_b32 a122, v66
  v_accvgpr_write_b32 a123, v67
  v_mov_b32 v204, v252
  v_max3_f32 v204, v204, v24, v25
  v_max3_f32 v204, v204, v26, v27
  v_max3_f32 v204, v204, v28, v29
  v_max3_f32 v204, v204, v30, v31
  v_max3_f32 v204, v204, v56, v57
  v_max3_f32 v204, v204, v58, v59
  v_max3_f32 v204, v204, v60, v61
  v_max3_f32 v204, v204, v62, v63
  v_mov_b32 v245, v204
  s_nop 1
  v_permlane16_swap_b32 v204, v245
  v_max_f32 v204, v204, v245
  v_mov_b32 v245, v204
  s_nop 1
  v_permlane32_swap_b32 v204, v245
  v_max_f32 v204, v204, v245
  v_sub_f32 v205, v252, v204
  v_exp_f32 v205, v205
  v_mov_b32 v252, v204
  v_mul_f32 v211, v211, v205
  v_sub_f32 v24, v24, v204
  v_sub_f32 v25, v25, v204
  v_sub_f32 v26, v26, v204
  v_sub_f32 v27, v27, v204
  v_sub_f32 v28, v28, v204
  v_sub_f32 v29, v29, v204
  v_sub_f32 v30, v30, v204
  v_sub_f32 v31, v31, v204
  v_sub_f32 v56, v56, v204
  v_sub_f32 v57, v57, v204
  v_sub_f32 v58, v58, v204
  v_sub_f32 v59, v59, v204
  v_sub_f32 v60, v60, v204
  v_sub_f32 v61, v61, v204
  v_sub_f32 v62, v62, v204
  v_sub_f32 v63, v63, v204
  v_exp_f32 v24, v24
  v_exp_f32 v25, v25
  v_add_f32 v211, v211, v24
  v_exp_f32 v26, v26
  v_add_f32 v211, v211, v25
  v_cvt_pk_bf16_f32 v24, v24, v25
  v_exp_f32 v27, v27
  v_add_f32 v211, v211, v26
  v_add_f32 v211, v211, v27
  v_cvt_pk_bf16_f32 v25, v26, v27
  v_exp_f32 v28, v28
  v_exp_f32 v29, v29
  v_add_f32 v211, v211, v28
  v_exp_f32 v30, v30
  v_add_f32 v211, v211, v29
  v_cvt_pk_bf16_f32 v26, v28, v29
  v_exp_f32 v31, v31
  v_add_f32 v211, v211, v30
  v_add_f32 v211, v211, v31
  v_cvt_pk_bf16_f32 v27, v30, v31
  v_exp_f32 v56, v56
  v_exp_f32 v57, v57
  v_add_f32 v211, v211, v56
  v_exp_f32 v58, v58
  v_add_f32 v211, v211, v57
  v_cvt_pk_bf16_f32 v56, v56, v57
  v_exp_f32 v59, v59
  v_add_f32 v211, v211, v58
  v_add_f32 v211, v211, v59
  v_cvt_pk_bf16_f32 v57, v58, v59
  v_exp_f32 v60, v60
  v_exp_f32 v61, v61
  v_add_f32 v211, v211, v60
  v_exp_f32 v62, v62
  v_add_f32 v211, v211, v61
  v_cvt_pk_bf16_f32 v58, v60, v61
  v_exp_f32 v63, v63
  v_add_f32 v211, v211, v62
  v_add_f32 v211, v211, v63
  v_cvt_pk_bf16_f32 v59, v62, v63
  v_accvgpr_read_b32 v64, a12
  v_accvgpr_read_b32 v65, a13
  v_accvgpr_read_b32 v66, a14
  v_accvgpr_read_b32 v67, a15
  v_mul_f32 v64, v64, v205
  v_mul_f32 v65, v65, v205
  v_mul_f32 v66, v66, v205
  v_mul_f32 v67, v67, v205
  v_accvgpr_write_b32 a12, v64
  v_accvgpr_write_b32 a13, v65
  v_accvgpr_write_b32 a14, v66
  v_accvgpr_write_b32 a15, v67
  v_accvgpr_read_b32 v64, a28
  v_accvgpr_read_b32 v65, a29
  v_accvgpr_read_b32 v66, a30
  v_accvgpr_read_b32 v67, a31
  v_mul_f32 v64, v64, v205
  v_mul_f32 v65, v65, v205
  v_mul_f32 v66, v66, v205
  v_mul_f32 v67, v67, v205
  v_accvgpr_write_b32 a28, v64
  v_accvgpr_write_b32 a29, v65
  v_accvgpr_write_b32 a30, v66
  v_accvgpr_write_b32 a31, v67
  v_accvgpr_read_b32 v64, a44
  v_accvgpr_read_b32 v65, a45
  v_accvgpr_read_b32 v66, a46
  v_accvgpr_read_b32 v67, a47
  v_mul_f32 v64, v64, v205
  v_mul_f32 v65, v65, v205
  v_mul_f32 v66, v66, v205
  v_mul_f32 v67, v67, v205
  v_accvgpr_write_b32 a44, v64
  v_accvgpr_write_b32 a45, v65
  v_accvgpr_write_b32 a46, v66
  v_accvgpr_write_b32 a47, v67
  v_accvgpr_read_b32 v64, a60
  v_accvgpr_read_b32 v65, a61
  v_accvgpr_read_b32 v66, a62
  v_accvgpr_read_b32 v67, a63
  v_mul_f32 v64, v64, v205
  v_mul_f32 v65, v65, v205
  v_mul_f32 v66, v66, v205
  v_mul_f32 v67, v67, v205
  v_accvgpr_write_b32 a60, v64
  v_accvgpr_write_b32 a61, v65
  v_accvgpr_write_b32 a62, v66
  v_accvgpr_write_b32 a63, v67
  v_accvgpr_read_b32 v64, a76
  v_accvgpr_read_b32 v65, a77
  v_accvgpr_read_b32 v66, a78
  v_accvgpr_read_b32 v67, a79
  v_mul_f32 v64, v64, v205
  v_mul_f32 v65, v65, v205
  v_mul_f32 v66, v66, v205
  v_mul_f32 v67, v67, v205
  v_accvgpr_write_b32 a76, v64
  v_accvgpr_write_b32 a77, v65
  v_accvgpr_write_b32 a78, v66
  v_accvgpr_write_b32 a79, v67
  v_accvgpr_read_b32 v64, a92
  v_accvgpr_read_b32 v65, a93
  v_accvgpr_read_b32 v66, a94
  v_accvgpr_read_b32 v67, a95
  v_mul_f32 v64, v64, v205
  v_mul_f32 v65, v65, v205
  v_mul_f32 v66, v66, v205
  v_mul_f32 v67, v67, v205
  v_accvgpr_write_b32 a92, v64
  v_accvgpr_write_b32 a93, v65
  v_accvgpr_write_b32 a94, v66
  v_accvgpr_write_b32 a95, v67
  v_accvgpr_read_b32 v64, a108
  v_accvgpr_read_b32 v65, a109
  v_accvgpr_read_b32 v66, a110
  v_accvgpr_read_b32 v67, a111
  v_mul_f32 v64, v64, v205
  v_mul_f32 v65, v65, v205
  v_mul_f32 v66, v66, v205
  v_mul_f32 v67, v67, v205
  v_accvgpr_write_b32 a108, v64
  v_accvgpr_write_b32 a109, v65
  v_accvgpr_write_b32 a110, v66
  v_accvgpr_write_b32 a111, v67
  v_accvgpr_read_b32 v64, a124
  v_accvgpr_read_b32 v65, a125
  v_accvgpr_read_b32 v66, a126
  v_accvgpr_read_b32 v67, a127
  v_mul_f32 v64, v64, v205
  v_mul_f32 v65, v65, v205
  v_mul_f32 v66, v66, v205
  v_mul_f32 v67, v67, v205
  v_accvgpr_write_b32 a124, v64
  v_accvgpr_write_b32 a125, v65
  v_accvgpr_write_b32 a126, v66
  v_accvgpr_write_b32 a127, v67
  ds_read_b64_tr_b16 a[160:161], v216 offset:49152
  ds_read_b64_tr_b16 a[162:163], v216 offset:53248
  ds_read_b64_tr_b16 a[164:165], v216 offset:57344
  ds_read_b64_tr_b16 a[166:167], v216 offset:61440
  s_waitcnt lgkmcnt(2)
  v_mfma_f32_16x16x32_bf16 a[0:3], a[160:163], v[0:3], a[0:3]
  s_waitcnt lgkmcnt(0)
  v_mfma_f32_16x16x32_bf16 a[0:3], a[164:167], v[32:35], a[0:3]
  v_mfma_f32_16x16x32_bf16 a[4:7], a[164:167], v[40:43], a[4:7]
  v_mfma_f32_16x16x32_bf16 a[4:7], a[160:163], v[8:11], a[4:7]
  v_mfma_f32_16x16x32_bf16 a[8:11], a[160:163], v[16:19], a[8:11]
  v_mfma_f32_16x16x32_bf16 a[8:11], a[164:167], v[48:51], a[8:11]
  v_mfma_f32_16x16x32_bf16 a[12:15], a[164:167], v[56:59], a[12:15]
  v_mfma_f32_16x16x32_bf16 a[12:15], a[160:163], v[24:27], a[12:15]
  ds_read_b64_tr_b16 a[168:169], v217 offset:49152
  ds_read_b64_tr_b16 a[170:171], v217 offset:53248
  ds_read_b64_tr_b16 a[172:173], v217 offset:57344
  ds_read_b64_tr_b16 a[174:175], v217 offset:61440
  s_waitcnt lgkmcnt(2)
  v_mfma_f32_16x16x32_bf16 a[16:19], a[168:171], v[0:3], a[16:19]
  s_waitcnt lgkmcnt(0)
  v_mfma_f32_16x16x32_bf16 a[16:19], a[172:175], v[32:35], a[16:19]
  v_mfma_f32_16x16x32_bf16 a[20:23], a[172:175], v[40:43], a[20:23]
  v_mfma_f32_16x16x32_bf16 a[20:23], a[168:171], v[8:11], a[20:23]
  v_mfma_f32_16x16x32_bf16 a[24:27], a[168:171], v[16:19], a[24:27]
  v_mfma_f32_16x16x32_bf16 a[24:27], a[172:175], v[48:51], a[24:27]
  v_mfma_f32_16x16x32_bf16 a[28:31], a[172:175], v[56:59], a[28:31]
  v_mfma_f32_16x16x32_bf16 a[28:31], a[168:171], v[24:27], a[28:31]
  ds_read_b64_tr_b16 a[176:177], v218 offset:49152
  ds_read_b64_tr_b16 a[178:179], v218 offset:53248
  ds_read_b64_tr_b16 a[180:181], v218 offset:57344
  ds_read_b64_tr_b16 a[182:183], v218 offset:61440
  s_waitcnt lgkmcnt(2)
  v_mfma_f32_16x16x32_bf16 a[32:35], a[176:179], v[0:3], a[32:35]
  s_waitcnt lgkmcnt(0)
  v_mfma_f32_16x16x32_bf16 a[32:35], a[180:183], v[32:35], a[32:35]
  v_mfma_f32_16x16x32_bf16 a[36:39], a[180:183], v[40:43], a[36:39]
  v_mfma_f32_16x16x32_bf16 a[36:39], a[176:179], v[8:11], a[36:39]
  v_mfma_f32_16x16x32_bf16 a[40:43], a[176:179], v[16:19], a[40:43]
  v_mfma_f32_16x16x32_bf16 a[40:43], a[180:183], v[48:51], a[40:43]
  v_mfma_f32_16x16x32_bf16 a[44:47], a[180:183], v[56:59], a[44:47]
  v_mfma_f32_16x16x32_bf16 a[44:47], a[176:179], v[24:27], a[44:47]
  ds_read_b64_tr_b16 a[184:185], v219 offset:49152
  ds_read_b64_tr_b16 a[186:187], v219 offset:53248
  ds_read_b64_tr_b16 a[188:189], v219 offset:57344
  ds_read_b64_tr_b16 a[190:191], v219 offset:61440
  s_waitcnt lgkmcnt(2)
  v_mfma_f32_16x16x32_bf16 a[48:51], a[184:187], v[0:3], a[48:51]
  s_waitcnt lgkmcnt(0)
  v_mfma_f32_16x16x32_bf16 a[48:51], a[188:191], v[32:35], a[48:51]
  v_mfma_f32_16x16x32_bf16 a[52:55], a[188:191], v[40:43], a[52:55]
  v_mfma_f32_16x16x32_bf16 a[52:55], a[184:187], v[8:11], a[52:55]
  v_mfma_f32_16x16x32_bf16 a[56:59], a[184:187], v[16:19], a[56:59]
  v_mfma_f32_16x16x32_bf16 a[56:59], a[188:191], v[48:51], a[56:59]
  v_mfma_f32_16x16x32_bf16 a[60:63], a[188:191], v[56:59], a[60:63]
  v_mfma_f32_16x16x32_bf16 a[60:63], a[184:187], v[24:27], a[60:63]
  ds_read_b64_tr_b16 a[160:161], v220 offset:49152
  ds_read_b64_tr_b16 a[162:163], v220 offset:53248
  ds_read_b64_tr_b16 a[164:165], v220 offset:57344
  ds_read_b64_tr_b16 a[166:167], v220 offset:61440
  s_waitcnt lgkmcnt(2)
  v_mfma_f32_16x16x32_bf16 a[64:67], a[160:163], v[0:3], a[64:67]
  s_waitcnt lgkmcnt(0)
  v_mfma_f32_16x16x32_bf16 a[64:67], a[164:167], v[32:35], a[64:67]
  v_mfma_f32_16x16x32_bf16 a[68:71], a[164:167], v[40:43], a[68:71]
  v_mfma_f32_16x16x32_bf16 a[68:71], a[160:163], v[8:11], a[68:71]
  v_mfma_f32_16x16x32_bf16 a[72:75], a[160:163], v[16:19], a[72:75]
  v_mfma_f32_16x16x32_bf16 a[72:75], a[164:167], v[48:51], a[72:75]
  v_mfma_f32_16x16x32_bf16 a[76:79], a[164:167], v[56:59], a[76:79]
  v_mfma_f32_16x16x32_bf16 a[76:79], a[160:163], v[24:27], a[76:79]
  ds_read_b64_tr_b16 a[168:169], v221 offset:49152
  ds_read_b64_tr_b16 a[170:171], v221 offset:53248
  ds_read_b64_tr_b16 a[172:173], v221 offset:57344
  ds_read_b64_tr_b16 a[174:175], v221 offset:61440
  s_waitcnt lgkmcnt(2)
  v_mfma_f32_16x16x32_bf16 a[80:83], a[168:171], v[0:3], a[80:83]
  s_waitcnt lgkmcnt(0)
  v_mfma_f32_16x16x32_bf16 a[80:83], a[172:175], v[32:35], a[80:83]
  v_mfma_f32_16x16x32_bf16 a[84:87], a[172:175], v[40:43], a[84:87]
  v_mfma_f32_16x16x32_bf16 a[84:87], a[168:171], v[8:11], a[84:87]
  v_mfma_f32_16x16x32_bf16 a[88:91], a[168:171], v[16:19], a[88:91]
  v_mfma_f32_16x16x32_bf16 a[88:91], a[172:175], v[48:51], a[88:91]
  v_mfma_f32_16x16x32_bf16 a[92:95], a[172:175], v[56:59], a[92:95]
  v_mfma_f32_16x16x32_bf16 a[92:95], a[168:171], v[24:27], a[92:95]
  ds_read_b64_tr_b16 a[176:177], v222 offset:49152
  ds_read_b64_tr_b16 a[178:179], v222 offset:53248
  ds_read_b64_tr_b16 a[180:181], v222 offset:57344
  ds_read_b64_tr_b16 a[182:183], v222 offset:61440
  s_waitcnt lgkmcnt(2)
  v_mfma_f32_16x16x32_bf16 a[96:99], a[176:179], v[0:3], a[96:99]
  s_waitcnt lgkmcnt(0)
  v_mfma_f32_16x16x32_bf16 a[96:99], a[180:183], v[32:35], a[96:99]
  v_mfma_f32_16x16x32_bf16 a[100:103], a[180:183], v[40:43], a[100:103]
  v_mfma_f32_16x16x32_bf16 a[100:103], a[176:179], v[8:11], a[100:103]
  v_mfma_f32_16x16x32_bf16 a[104:107], a[176:179], v[16:19], a[104:107]
  v_mfma_f32_16x16x32_bf16 a[104:107], a[180:183], v[48:51], a[104:107]
  v_mfma_f32_16x16x32_bf16 a[108:111], a[180:183], v[56:59], a[108:111]
  v_mfma_f32_16x16x32_bf16 a[108:111], a[176:179], v[24:27], a[108:111]
  ds_read_b64_tr_b16 a[184:185], v223 offset:49152
  ds_read_b64_tr_b16 a[186:187], v223 offset:53248
  ds_read_b64_tr_b16 a[188:189], v223 offset:57344
  ds_read_b64_tr_b16 a[190:191], v223 offset:61440
  s_waitcnt lgkmcnt(2)
  v_mfma_f32_16x16x32_bf16 a[112:115], a[184:187], v[0:3], a[112:115]
  s_waitcnt lgkmcnt(0)
  v_mfma_f32_16x16x32_bf16 a[112:115], a[188:191], v[32:35], a[112:115]
  v_mfma_f32_16x16x32_bf16 a[116:119], a[188:191], v[40:43], a[116:119]
  v_mfma_f32_16x16x32_bf16 a[116:119], a[184:187], v[8:11], a[116:119]
  v_mfma_f32_16x16x32_bf16 a[120:123], a[184:187], v[16:19], a[120:123]
  v_mfma_f32_16x16x32_bf16 a[120:123], a[188:191], v[48:51], a[120:123]
  v_mfma_f32_16x16x32_bf16 a[124:127], a[188:191], v[56:59], a[124:127]
  v_mfma_f32_16x16x32_bf16 a[124:127], a[184:187], v[24:27], a[124:127]
  s_add_u32 s29, s29, 16384
  s_cmp_lt_u32 s29, 524288
  s_cbranch_scc1 attn_slow
  v_mov_b32 v245, v208
  v_mov_b32 v246, v209
  v_mov_b32 v247, v210
  v_mov_b32 v248, v211
  v_permlane16_swap_b32 v208, v245
  v_permlane16_swap_b32 v209, v246
  v_permlane16_swap_b32 v210, v247
  v_permlane16_swap_b32 v211, v248
  v_add_f32 v208, v208, v245
  v_add_f32 v209, v209, v246
  v_add_f32 v210, v210, v247
  v_add_f32 v211, v211, v248
  v_mov_b32 v245, v208
  v_mov_b32 v246, v209
  v_mov_b32 v247, v210
  v_mov_b32 v248, v211
  v_permlane32_swap_b32 v208, v245
  v_permlane32_swap_b32 v209, v246
  v_permlane32_swap_b32 v210, v247
  v_permlane32_swap_b32 v211, v248
  v_add_f32 v208, v208, v245
  v_add_f32 v209, v209, v246
  v_add_f32 v210, v210, v247
  v_add_f32 v211, v211, v248
  v_rcp_f32 v192, v208
  v_rcp_f32 v196, v209
  v_rcp_f32 v200, v210
  v_rcp_f32 v204, v211
  v_accvgpr_read_b32 v0, a0
  v_accvgpr_read_b32 v1, a1
  v_accvgpr_read_b32 v2, a2
  v_accvgpr_read_b32 v3, a3
  v_accvgpr_read_b32 v4, a16
  v_accvgpr_read_b32 v5, a17
  v_accvgpr_read_b32 v6, a18
  v_accvgpr_read_b32 v7, a19
  v_mul_f32 v0, v0, v192
  v_mul_f32 v1, v1, v192
  v_mul_f32 v2, v2, v192
  v_mul_f32 v3, v3, v192
  v_mul_f32 v4, v4, v192
  v_mul_f32 v5, v5, v192
  v_mul_f32 v6, v6, v192
  v_mul_f32 v7, v7, v192
  v_cvt_pk_bf16_f32 v0, v0, v1
  v_cvt_pk_bf16_f32 v1, v2, v3
  v_cvt_pk_bf16_f32 v2, v4, v5
  v_cvt_pk_bf16_f32 v3, v6, v7
  buffer_store_dwordx4 v[0:3], v244, s[24:27], s40 offen offset:0 sc1
  v_accvgpr_read_b32 v8, a4
  v_accvgpr_read_b32 v9, a5
  v_accvgpr_read_b32 v10, a6
  v_accvgpr_read_b32 v11, a7
  v_accvgpr_read_b32 v12, a20
  v_accvgpr_read_b32 v13, a21
  v_accvgpr_read_b32 v14, a22
  v_accvgpr_read_b32 v15, a23
  v_mul_f32 v8, v8, v196
  v_mul_f32 v9, v9, v196
  v_mul_f32 v10, v10, v196
  v_mul_f32 v11, v11, v196
  v_mul_f32 v12, v12, v196
  v_mul_f32 v13, v13, v196
  v_mul_f32 v14, v14, v196
  v_mul_f32 v15, v15, v196
  v_cvt_pk_bf16_f32 v8, v8, v9
  v_cvt_pk_bf16_f32 v9, v10, v11
  v_cvt_pk_bf16_f32 v10, v12, v13
  v_cvt_pk_bf16_f32 v11, v14, v15
  buffer_store_dwordx4 v[8:11], v244, s[24:27], s40 offen offset:2048 sc1
  v_accvgpr_read_b32 v16, a8
  v_accvgpr_read_b32 v17, a9
  v_accvgpr_read_b32 v18, a10
  v_accvgpr_read_b32 v19, a11
  v_accvgpr_read_b32 v20, a24
  v_accvgpr_read_b32 v21, a25
  v_accvgpr_read_b32 v22, a26
  v_accvgpr_read_b32 v23, a27
  v_mul_f32 v16, v16, v200
  v_mul_f32 v17, v17, v200
  v_mul_f32 v18, v18, v200
  v_mul_f32 v19, v19, v200
  v_mul_f32 v20, v20, v200
  v_mul_f32 v21, v21, v200
  v_mul_f32 v22, v22, v200
  v_mul_f32 v23, v23, v200
  v_cvt_pk_bf16_f32 v16, v16, v17
  v_cvt_pk_bf16_f32 v17, v18, v19
  v_cvt_pk_bf16_f32 v18, v20, v21
  v_cvt_pk_bf16_f32 v19, v22, v23
  buffer_store_dwordx4 v[16:19], v244, s[24:27], s41 offen offset:0 sc1
  v_accvgpr_read_b32 v24, a12
  v_accvgpr_read_b32 v25, a13
  v_accvgpr_read_b32 v26, a14
  v_accvgpr_read_b32 v27, a15
  v_accvgpr_read_b32 v28, a28
  v_accvgpr_read_b32 v29, a29
  v_accvgpr_read_b32 v30, a30
  v_accvgpr_read_b32 v31, a31
  v_mul_f32 v24, v24, v204
  v_mul_f32 v25, v25, v204
  v_mul_f32 v26, v26, v204
  v_mul_f32 v27, v27, v204
  v_mul_f32 v28, v28, v204
  v_mul_f32 v29, v29, v204
  v_mul_f32 v30, v30, v204
  v_mul_f32 v31, v31, v204
  v_cvt_pk_bf16_f32 v24, v24, v25
  v_cvt_pk_bf16_f32 v25, v26, v27
  v_cvt_pk_bf16_f32 v26, v28, v29
  v_cvt_pk_bf16_f32 v27, v30, v31
  buffer_store_dwordx4 v[24:27], v244, s[24:27], s41 offen offset:2048 sc1
  v_accvgpr_read_b32 v32, a32
  v_accvgpr_read_b32 v33, a33
  v_accvgpr_read_b32 v34, a34
  v_accvgpr_read_b32 v35, a35
  v_accvgpr_read_b32 v36, a48
  v_accvgpr_read_b32 v37, a49
  v_accvgpr_read_b32 v38, a50
  v_accvgpr_read_b32 v39, a51
  v_mul_f32 v32, v32, v192
  v_mul_f32 v33, v33, v192
  v_mul_f32 v34, v34, v192
  v_mul_f32 v35, v35, v192
  v_mul_f32 v36, v36, v192
  v_mul_f32 v37, v37, v192
  v_mul_f32 v38, v38, v192
  v_mul_f32 v39, v39, v192
  v_cvt_pk_bf16_f32 v32, v32, v33
  v_cvt_pk_bf16_f32 v33, v34, v35
  v_cvt_pk_bf16_f32 v34, v36, v37
  v_cvt_pk_bf16_f32 v35, v38, v39
  buffer_store_dwordx4 v[32:35], v244, s[24:27], s40 offen offset:1024 sc1
  v_accvgpr_read_b32 v40, a36
  v_accvgpr_read_b32 v41, a37
  v_accvgpr_read_b32 v42, a38
  v_accvgpr_read_b32 v43, a39
  v_accvgpr_read_b32 v44, a52
  v_accvgpr_read_b32 v45, a53
  v_accvgpr_read_b32 v46, a54
  v_accvgpr_read_b32 v47, a55
  v_mul_f32 v40, v40, v196
  v_mul_f32 v41, v41, v196
  v_mul_f32 v42, v42, v196
  v_mul_f32 v43, v43, v196
  v_mul_f32 v44, v44, v196
  v_mul_f32 v45, v45, v196
  v_mul_f32 v46, v46, v196
  v_mul_f32 v47, v47, v196
  v_cvt_pk_bf16_f32 v40, v40, v41
  v_cvt_pk_bf16_f32 v41, v42, v43
  v_cvt_pk_bf16_f32 v42, v44, v45
  v_cvt_pk_bf16_f32 v43, v46, v47
  buffer_store_dwordx4 v[40:43], v244, s[24:27], s40 offen offset:3072 sc1
  v_accvgpr_read_b32 v48, a40
  v_accvgpr_read_b32 v49, a41
  v_accvgpr_read_b32 v50, a42
  v_accvgpr_read_b32 v51, a43
  v_accvgpr_read_b32 v52, a56
  v_accvgpr_read_b32 v53, a57
  v_accvgpr_read_b32 v54, a58
  v_accvgpr_read_b32 v55, a59
  v_mul_f32 v48, v48, v200
  v_mul_f32 v49, v49, v200
  v_mul_f32 v50, v50, v200
  v_mul_f32 v51, v51, v200
  v_mul_f32 v52, v52, v200
  v_mul_f32 v53, v53, v200
  v_mul_f32 v54, v54, v200
  v_mul_f32 v55, v55, v200
  v_cvt_pk_bf16_f32 v48, v48, v49
  v_cvt_pk_bf16_f32 v49, v50, v51
  v_cvt_pk_bf16_f32 v50, v52, v53
  v_cvt_pk_bf16_f32 v51, v54, v55
  buffer_store_dwordx4 v[48:51], v244, s[24:27], s41 offen offset:1024 sc1
  v_accvgpr_read_b32 v56, a44
  v_accvgpr_read_b32 v57, a45
  v_accvgpr_read_b32 v58, a46
  v_accvgpr_read_b32 v59, a47
  v_accvgpr_read_b32 v60, a60
  v_accvgpr_read_b32 v61, a61
  v_accvgpr_read_b32 v62, a62
  v_accvgpr_read_b32 v63, a63
  v_mul_f32 v56, v56, v204
  v_mul_f32 v57, v57, v204
  v_mul_f32 v58, v58, v204
  v_mul_f32 v59, v59, v204
  v_mul_f32 v60, v60, v204
  v_mul_f32 v61, v61, v204
  v_mul_f32 v62, v62, v204
  v_mul_f32 v63, v63, v204
  v_cvt_pk_bf16_f32 v56, v56, v57
  v_cvt_pk_bf16_f32 v57, v58, v59
  v_cvt_pk_bf16_f32 v58, v60, v61
  v_cvt_pk_bf16_f32 v59, v62, v63
  buffer_store_dwordx4 v[56:59], v244, s[24:27], s41 offen offset:3072 sc1
  v_accvgpr_read_b32 v0, a64
  v_accvgpr_read_b32 v1, a65
  v_accvgpr_read_b32 v2, a66
  v_accvgpr_read_b32 v3, a67
  v_accvgpr_read_b32 v4, a80
  v_accvgpr_read_b32 v5, a81
  v_accvgpr_read_b32 v6, a82
  v_accvgpr_read_b32 v7, a83
  v_mul_f32 v0, v0, v192
  v_mul_f32 v1, v1, v192
  v_mul_f32 v2, v2, v192
  v_mul_f32 v3, v3, v192
  v_mul_f32 v4, v4, v192
  v_mul_f32 v5, v5, v192
  v_mul_f32 v6, v6, v192
  v_mul_f32 v7, v7, v192
  v_cvt_pk_bf16_f32 v0, v0, v1
  v_cvt_pk_bf16_f32 v1, v2, v3
  v_cvt_pk_bf16_f32 v2, v4, v5
  v_cvt_pk_bf16_f32 v3, v6, v7
  buffer_store_dwordx4 v[0:3], v244, s[24:27], s42 offen offset:0 sc1
  v_accvgpr_read_b32 v8, a68
  v_accvgpr_read_b32 v9, a69
  v_accvgpr_read_b32 v10, a70
  v_accvgpr_read_b32 v11, a71
  v_accvgpr_read_b32 v12, a84
  v_accvgpr_read_b32 v13, a85
  v_accvgpr_read_b32 v14, a86
  v_accvgpr_read_b32 v15, a87
  v_mul_f32 v8, v8, v196
  v_mul_f32 v9, v9, v196
  v_mul_f32 v10, v10, v196
  v_mul_f32 v11, v11, v196
  v_mul_f32 v12, v12, v196
  v_mul_f32 v13, v13, v196
  v_mul_f32 v14, v14, v196
  v_mul_f32 v15, v15, v196
  v_cvt_pk_bf16_f32 v8, v8, v9
  v_cvt_pk_bf16_f32 v9, v10, v11
  v_cvt_pk_bf16_f32 v10, v12, v13
  v_cvt_pk_bf16_f32 v11, v14, v15
  buffer_store_dwordx4 v[8:11], v244, s[24:27], s42 offen offset:2048 sc1
  v_accvgpr_read_b32 v16, a72
  v_accvgpr_read_b32 v17, a73
  v_accvgpr_read_b32 v18, a74
  v_accvgpr_read_b32 v19, a75
  v_accvgpr_read_b32 v20, a88
  v_accvgpr_read_b32 v21, a89
  v_accvgpr_read_b32 v22, a90
  v_accvgpr_read_b32 v23, a91
  v_mul_f32 v16, v16, v200
  v_mul_f32 v17, v17, v200
  v_mul_f32 v18, v18, v200
  v_mul_f32 v19, v19, v200
  v_mul_f32 v20, v20, v200
  v_mul_f32 v21, v21, v200
  v_mul_f32 v22, v22, v200
  v_mul_f32 v23, v23, v200
  v_cvt_pk_bf16_f32 v16, v16, v17
  v_cvt_pk_bf16_f32 v17, v18, v19
  v_cvt_pk_bf16_f32 v18, v20, v21
  v_cvt_pk_bf16_f32 v19, v22, v23
  buffer_store_dwordx4 v[16:19], v244, s[24:27], s43 offen offset:0 sc1
  v_accvgpr_read_b32 v24, a76
  v_accvgpr_read_b32 v25, a77
  v_accvgpr_read_b32 v26, a78
  v_accvgpr_read_b32 v27, a79
  v_accvgpr_read_b32 v28, a92
  v_accvgpr_read_b32 v29, a93
  v_accvgpr_read_b32 v30, a94
  v_accvgpr_read_b32 v31, a95
  v_mul_f32 v24, v24, v204
  v_mul_f32 v25, v25, v204
  v_mul_f32 v26, v26, v204
  v_mul_f32 v27, v27, v204
  v_mul_f32 v28, v28, v204
  v_mul_f32 v29, v29, v204
  v_mul_f32 v30, v30, v204
  v_mul_f32 v31, v31, v204
  v_cvt_pk_bf16_f32 v24, v24, v25
  v_cvt_pk_bf16_f32 v25, v26, v27
  v_cvt_pk_bf16_f32 v26, v28, v29
  v_cvt_pk_bf16_f32 v27, v30, v31
  buffer_store_dwordx4 v[24:27], v244, s[24:27], s43 offen offset:2048 sc1
  v_accvgpr_read_b32 v32, a96
  v_accvgpr_read_b32 v33, a97
  v_accvgpr_read_b32 v34, a98
  v_accvgpr_read_b32 v35, a99
  v_accvgpr_read_b32 v36, a112
  v_accvgpr_read_b32 v37, a113
  v_accvgpr_read_b32 v38, a114
  v_accvgpr_read_b32 v39, a115
  v_mul_f32 v32, v32, v192
  v_mul_f32 v33, v33, v192
  v_mul_f32 v34, v34, v192
  v_mul_f32 v35, v35, v192
  v_mul_f32 v36, v36, v192
  v_mul_f32 v37, v37, v192
  v_mul_f32 v38, v38, v192
  v_mul_f32 v39, v39, v192
  v_cvt_pk_bf16_f32 v32, v32, v33
  v_cvt_pk_bf16_f32 v33, v34, v35
  v_cvt_pk_bf16_f32 v34, v36, v37
  v_cvt_pk_bf16_f32 v35, v38, v39
  buffer_store_dwordx4 v[32:35], v244, s[24:27], s42 offen offset:1024 sc1
  v_accvgpr_read_b32 v40, a100
  v_accvgpr_read_b32 v41, a101
  v_accvgpr_read_b32 v42, a102
  v_accvgpr_read_b32 v43, a103
  v_accvgpr_read_b32 v44, a116
  v_accvgpr_read_b32 v45, a117
  v_accvgpr_read_b32 v46, a118
  v_accvgpr_read_b32 v47, a119
  v_mul_f32 v40, v40, v196
  v_mul_f32 v41, v41, v196
  v_mul_f32 v42, v42, v196
  v_mul_f32 v43, v43, v196
  v_mul_f32 v44, v44, v196
  v_mul_f32 v45, v45, v196
  v_mul_f32 v46, v46, v196
  v_mul_f32 v47, v47, v196
  v_cvt_pk_bf16_f32 v40, v40, v41
  v_cvt_pk_bf16_f32 v41, v42, v43
  v_cvt_pk_bf16_f32 v42, v44, v45
  v_cvt_pk_bf16_f32 v43, v46, v47
  buffer_store_dwordx4 v[40:43], v244, s[24:27], s42 offen offset:3072 sc1
  v_accvgpr_read_b32 v48, a104
  v_accvgpr_read_b32 v49, a105
  v_accvgpr_read_b32 v50, a106
  v_accvgpr_read_b32 v51, a107
  v_accvgpr_read_b32 v52, a120
  v_accvgpr_read_b32 v53, a121
  v_accvgpr_read_b32 v54, a122
  v_accvgpr_read_b32 v55, a123
  v_mul_f32 v48, v48, v200
  v_mul_f32 v49, v49, v200
  v_mul_f32 v50, v50, v200
  v_mul_f32 v51, v51, v200
  v_mul_f32 v52, v52, v200
  v_mul_f32 v53, v53, v200
  v_mul_f32 v54, v54, v200
  v_mul_f32 v55, v55, v200
  v_cvt_pk_bf16_f32 v48, v48, v49
  v_cvt_pk_bf16_f32 v49, v50, v51
  v_cvt_pk_bf16_f32 v50, v52, v53
  v_cvt_pk_bf16_f32 v51, v54, v55
  buffer_store_dwordx4 v[48:51], v244, s[24:27], s43 offen offset:1024 sc1
  v_accvgpr_read_b32 v56, a108
  v_accvgpr_read_b32 v57, a109
  v_accvgpr_read_b32 v58, a110
  v_accvgpr_read_b32 v59, a111
  v_accvgpr_read_b32 v60, a124
  v_accvgpr_read_b32 v61, a125
  v_accvgpr_read_b32 v62, a126
  v_accvgpr_read_b32 v63, a127
  v_mul_f32 v56, v56, v204
  v_mul_f32 v57, v57, v204
  v_mul_f32 v58, v58, v204
  v_mul_f32 v59, v59, v204
  v_mul_f32 v60, v60, v204
  v_mul_f32 v61, v61, v204
  v_mul_f32 v62, v62, v204
  v_mul_f32 v63, v63, v204
  v_cvt_pk_bf16_f32 v56, v56, v57
  v_cvt_pk_bf16_f32 v57, v58, v59
  v_cvt_pk_bf16_f32 v58, v60, v61
  v_cvt_pk_bf16_f32 v59, v62, v63
  buffer_store_dwordx4 v[56:59], v244, s[24:27], s43 offen offset:3072 sc1
  v_add_u32 v252, 4096, v242
  v_add_u32 v253, 8192, v242
  buffer_load_dwordx4 a[128:131], v253, s[24:27], s4 offen offset:3072 sc1
  buffer_load_dwordx4 a[132:135], v242, s[24:27], s5 offen offset:0 sc1
  buffer_load_dwordx4 a[136:139], v242, s[24:27], s5 offen offset:1024 sc1
  buffer_load_dwordx4 a[140:143], v242, s[24:27], s5 offen offset:2048 sc1
  buffer_load_dwordx4 a[144:147], v242, s[24:27], s5 offen offset:3072 sc1
  buffer_load_dwordx4 a[148:151], v252, s[24:27], s5 offen offset:0 sc1
  buffer_load_dwordx4 a[152:155], v252, s[24:27], s5 offen offset:1024 sc1
  buffer_load_dwordx4 a[156:159], v252, s[24:27], s5 offen offset:2048 sc1
  buffer_load_dwordx4 a[0:3], v252, s[24:27], s5 offen offset:3072 sc1
  buffer_load_dwordx4 a[4:7], v253, s[24:27], s5 offen offset:0 sc1
  buffer_load_dwordx4 a[8:11], v253, s[24:27], s5 offen offset:1024 sc1
  buffer_load_dwordx4 a[12:15], v253, s[24:27], s5 offen offset:2048 sc1
  buffer_load_dwordx4 a[16:19], v253, s[24:27], s5 offen offset:3072 sc1
  buffer_load_dwordx4 a[20:23], v242, s[24:27], s6 offen offset:0 sc1
  buffer_load_dwordx4 a[24:27], v242, s[24:27], s6 offen offset:1024 sc1
  buffer_load_dwordx4 a[28:31], v242, s[24:27], s6 offen offset:2048 sc1
  buffer_load_dwordx4 a[32:35], v242, s[24:27], s6 offen offset:3072 sc1
  buffer_load_dwordx4 a[36:39], v252, s[24:27], s6 offen offset:0 sc1
  buffer_load_dwordx4 a[40:43], v252, s[24:27], s6 offen offset:1024 sc1
  buffer_load_dwordx4 a[44:47], v252, s[24:27], s6 offen offset:2048 sc1
  buffer_load_dwordx4 a[48:51], v252, s[24:27], s6 offen offset:3072 sc1
  buffer_load_dwordx4 a[52:55], v253, s[24:27], s6 offen offset:0 sc1
  s_bfe_u32 s39, s2, 0x40002
  s_lshl_b32 s39, s39, 8
  s_add_u32 s39, s39, 2818304
  s_lshl_b32 s38, s3, 26
  v_lshlrev_b32 v64, 22, v242
  v_or_b32 v64, s38, v64
  v_mov_b32 v65, 1
  s_waitcnt vmcnt(0)
  s_barrier
  s_branch tail_go
.section .rodata,"a"
.p2align 6
.amdhsa_kernel recurrent_scan__mha_block_cached__moe_arch_mod__prompt_kernel
  .amdhsa_next_free_vgpr 512
  .amdhsa_next_free_sgpr 102
  .amdhsa_accum_offset 256
  .amdhsa_group_segment_fixed_size 0
  .amdhsa_kernarg_size 104
  .amdhsa_user_sgpr_count 2
  .amdhsa_user_sgpr_kernarg_segment_ptr 1
  .amdhsa_system_sgpr_workgroup_id_x 1
.end_amdhsa_kernel
```

```asm
; @launch grid=(256,1,1) block=(256,1,1) lds=163840
.amdgcn_target "amdgcn-amd-amdhsa--gfx950"
.text
.globl recurrent_scan__mha_block_cached__moe_arch_mod__prompt_kernel
.p2align 8
.type recurrent_scan__mha_block_cached__moe_arch_mod__prompt_kernel,@function
recurrent_scan__mha_block_cached__moe_arch_mod__prompt_kernel:
  s_cmp_ge_u32 s2, 256
  s_cbranch_scc1 attn_end
  s_load_dwordx2 s[60:61], s[0:1], 0
  s_load_dwordx2 s[48:49], s[0:1], 48
  s_load_dwordx4 s[4:7], s[0:1], 8
  s_load_dwordx2 s[8:9], s[0:1], 24
  s_load_dwordx2 s[10:11], s[0:1], 96
  s_load_dwordx2 s[88:89], s[0:1], 32
  s_load_dwordx2 s[90:91], s[0:1], 56
  s_load_dwordx4 s[92:95], s[0:1], 64
  s_load_dwordx2 s[96:97], s[0:1], 88
  s_load_dwordx2 s[62:63], s[0:1], 80
  s_getpc_b64 s[98:99]
attn_hot_pc:
  s_add_u32 s98, s98, attn_hot-attn_hot_pc
  s_addc_u32 s99, s99, 0
  v_lshlrev_b32 v249, 7, v0
  v_min_u32 v249, attn_end-attn_hot-4, v249
  global_load_dword v255, v249, s[98:99]
  v_add_u32 v249, 0x8000, v249
  v_min_u32 v249, attn_end-attn_hot-4, v249
  global_load_dword v255, v249, s[98:99]
attn_hot:
  v_lshrrev_b32 v249, 6, v0
  v_and_b32 v0, 63, v0
  v_mov_b32 v245, v0
  v_readfirstlane_b32 s3, v249
  s_and_b32 s36, s2, 7
  s_lshl_b32 s36, s36, 2
  s_lshr_b32 s37, s2, 6
  s_add_u32 s36, s36, s37
  s_bfe_u32 s37, s2, 0x30003
  s_lshl_b32 s37, s37, 2
  s_add_u32 s37, s37, s3
  s_lshl_b32 s28, s3, 12
  v_lshrrev_b32 v248, 4, v245
  v_and_b32 v247, 15, v245
  s_lshl_b32 s38, s3, 17
  v_lshlrev_b32 v249, 13, v248
  v_add_u32 v249, s38, v249
  v_or_b32 v250, 0, v248
  v_lshlrev_b32 v250, 1, v250
  v_xor_b32 v250, v250, v247
  v_lshl_add_u32 v238, v250, 4, v249
  v_or_b32 v250, 0, v248
  v_lshlrev_b32 v250, 1, v250
  v_xor_b32 v250, v250, v247
  v_lshl_add_u32 v239, v250, 4, v249
  v_add_u32 v239, 31744, v239
  v_or_b32 v250, 4, v248
  v_lshlrev_b32 v250, 1, v250
  v_xor_b32 v250, v250, v247
  v_lshl_add_u32 v240, v250, 4, v249
  v_add_u32 v240, 63488, v240
  v_or_b32 v250, 4, v248
  v_lshlrev_b32 v250, 1, v250
  v_xor_b32 v250, v250, v247
  v_lshl_add_u32 v241, v250, 4, v249
  v_add_u32 v241, 95232, v241
  s_waitcnt lgkmcnt(0)
  s_add_u32 s58, s10, 2830336
  s_addc_u32 s59, s11, 0
  s_load_dword s59, s[58:59], 0
  s_mov_b32 s24, s10
  s_mov_b32 s25, s11
  s_mov_b32 s26, 33554432
  s_mov_b32 s27, 0x20000
  s_lshl_b32 s38, s36, 8
  s_add_u32 s20, s8, s38
  s_addc_u32 s21, s9, 0
  s_mov_b32 s22, 5242880
  s_mov_b32 s23, 0x20000
  s_sub_u32 s22, s22, s38
  s_cmp_ge_u32 s3, 2
  s_cbranch_scc1 front_fetch
  s_mov_b32 s12, s60
  s_mov_b32 s13, s61
  s_mov_b32 s14, 2621440
  s_mov_b32 s15, 0x20000
  s_mov_b32 s16, s48
  s_mov_b32 s17, s49
  s_mov_b32 s18, 1280
  s_mov_b32 s19, 0x20000
  s_lshr_b32 s52, s37, 2
  s_lshl_b32 s52, s52, 5
  s_add_u32 s52, s52, s36
  s_lshl_b32 s52, s52, 1
  s_add_u32 s52, s52, s3
  s_lshl_b32 s52, s52, 2
  s_mul_i32 s53, s52, 1280
  v_lshrrev_b32 v1, 4, v0
  v_and_b32 v2, 15, v0
  v_lshlrev_b32 v3, 4, v2
  v_mul_u32_u24 v4, 0x500, v1
  v_add_u32 v4, v4, v3
  buffer_load_dwordx4 v[8:11], v4, s[12:15], s53 offen offset:0
  buffer_load_dwordx4 v[12:15], v4, s[12:15], s53 offen offset:256
  buffer_load_dwordx4 v[16:19], v4, s[12:15], s53 offen offset:512
  buffer_load_dwordx4 v[20:23], v4, s[12:15], s53 offen offset:768
  buffer_load_dwordx4 v[24:27], v4, s[12:15], s53 offen offset:1024
  buffer_load_dwordx4 v[28:31], v3, s[16:19], 0 offen offset:0
  buffer_load_dwordx4 v[32:35], v3, s[16:19], 0 offen offset:256
  buffer_load_dwordx4 v[36:39], v3, s[16:19], 0 offen offset:512
  buffer_load_dwordx4 v[40:43], v3, s[16:19], 0 offen offset:768
  buffer_load_dwordx4 v[44:47], v3, s[16:19], 0 offen offset:1024
  v_mov_b32 v7, 0
  v_lshlrev_b32 v6, 26, v0
  s_lshl_b32 s53, s2, 7
  s_add_u32 s53, s53, 2834432
  buffer_store_dword v7, v6, s[24:27], s53 offen sc1
  v_lshlrev_b32 v6, 8, v0
  v_lshrrev_b32 v5, 5, v0
  v_lshl_add_u32 v6, v5, 26, v6
  s_cmp_eq_u32 s2, 0
  s_cselect_b32 s53, 0, 1073741824
  v_or_b32 v6, s53, v6
  s_mov_b32 s53, 2818048
  buffer_store_dword v7, v6, s[24:27], s53 offen sc1
  s_lshr_b32 s53, s52, 6
  s_mul_i32 s53, s53, 81920
  s_bfe_u32 s54, s52, 0x20004
  s_lshl_b32 s54, s54, 10
  s_add_u32 s53, s53, s54
  s_and_b32 s54, s52, 15
  s_lshl_b32 s54, s54, 4
  s_add_u32 s53, s53, s54
  v_lshrrev_b32 v5, 2, v2
  v_lshlrev_b32 v5, 12, v5
  v_and_b32 v6, 3, v2
  v_lshl_add_u32 v5, v6, 8, v5
  v_lshl_add_u32 v5, v1, 4, v5
  s_mov_b32 s56, 0xffff0000
  s_waitcnt vmcnt(11)
  v_lshlrev_b32 v48, 16, v8
  v_and_b32 v49, s56, v8
  v_lshlrev_b32 v50, 16, v9
  v_and_b32 v51, s56, v9
  v_lshlrev_b32 v52, 16, v10
  v_and_b32 v53, s56, v10
  v_lshlrev_b32 v54, 16, v11
  v_and_b32 v55, s56, v11
  s_waitcnt vmcnt(10)
  v_lshlrev_b32 v56, 16, v12
  v_and_b32 v57, s56, v12
  v_lshlrev_b32 v58, 16, v13
  v_and_b32 v59, s56, v13
  v_lshlrev_b32 v60, 16, v14
  v_and_b32 v61, s56, v14
  v_lshlrev_b32 v62, 16, v15
  v_and_b32 v63, s56, v15
  s_waitcnt vmcnt(9)
  v_lshlrev_b32 v64, 16, v16
  v_and_b32 v65, s56, v16
  v_lshlrev_b32 v66, 16, v17
  v_and_b32 v67, s56, v17
  v_lshlrev_b32 v68, 16, v18
  v_and_b32 v69, s56, v18
  v_lshlrev_b32 v70, 16, v19
  v_and_b32 v71, s56, v19
  s_waitcnt vmcnt(8)
  v_lshlrev_b32 v72, 16, v20
  v_and_b32 v73, s56, v20
  v_lshlrev_b32 v74, 16, v21
  v_and_b32 v75, s56, v21
  v_lshlrev_b32 v76, 16, v22
  v_and_b32 v77, s56, v22
  v_lshlrev_b32 v78, 16, v23
  v_and_b32 v79, s56, v23
  s_waitcnt vmcnt(7)
  v_lshlrev_b32 v80, 16, v24
  v_and_b32 v81, s56, v24
  v_lshlrev_b32 v82, 16, v25
  v_and_b32 v83, s56, v25
  v_lshlrev_b32 v84, 16, v26
  v_and_b32 v85, s56, v26
  v_lshlrev_b32 v86, 16, v27
  v_and_b32 v87, s56, v27
  v_pk_add_f32 v[88:89], v[48:49], v[50:51]
  v_pk_add_f32 v[90:91], v[52:53], v[54:55]
  v_pk_add_f32 v[88:89], v[88:89], v[56:57]
  v_pk_add_f32 v[90:91], v[90:91], v[58:59]
  v_pk_add_f32 v[88:89], v[88:89], v[60:61]
  v_pk_add_f32 v[90:91], v[90:91], v[62:63]
  v_pk_add_f32 v[88:89], v[88:89], v[64:65]
  v_pk_add_f32 v[90:91], v[90:91], v[66:67]
  v_pk_add_f32 v[88:89], v[88:89], v[68:69]
  v_pk_add_f32 v[90:91], v[90:91], v[70:71]
  v_pk_add_f32 v[88:89], v[88:89], v[72:73]
  v_pk_add_f32 v[90:91], v[90:91], v[74:75]
  v_pk_add_f32 v[88:89], v[88:89], v[76:77]
  v_pk_add_f32 v[90:91], v[90:91], v[78:79]
  v_pk_add_f32 v[88:89], v[88:89], v[80:81]
  v_pk_add_f32 v[90:91], v[90:91], v[82:83]
  v_pk_add_f32 v[88:89], v[88:89], v[84:85]
  v_pk_add_f32 v[90:91], v[90:91], v[86:87]
  v_pk_add_f32 v[88:89], v[88:89], v[90:91]
  v_add_f32 v92, v88, v89
  s_nop 1
  v_add_f32_dpp v92, v92, v92 row_ror:8 row_mask:0xf bank_mask:0xf
  s_nop 1
  v_add_f32_dpp v92, v92, v92 row_ror:4 row_mask:0xf bank_mask:0xf
  s_nop 1
  v_add_f32_dpp v92, v92, v92 row_ror:2 row_mask:0xf bank_mask:0xf
  s_nop 1
  v_add_f32_dpp v92, v92, v92 row_ror:1 row_mask:0xf bank_mask:0xf
  v_mul_f32 v92, 0x3acccccd, v92
  v_pk_add_f32 v[94:95], v[48:49], v[92:93] op_sel_hi:[1,0] neg_lo:[0,1] neg_hi:[0,1]
  v_pk_mul_f32 v[88:89], v[94:95], v[94:95]
  v_pk_add_f32 v[96:97], v[50:51], v[92:93] op_sel_hi:[1,0] neg_lo:[0,1] neg_hi:[0,1]
  v_pk_mul_f32 v[90:91], v[96:97], v[96:97]
  v_pk_add_f32 v[94:95], v[52:53], v[92:93] op_sel_hi:[1,0] neg_lo:[0,1] neg_hi:[0,1]
  v_pk_fma_f32 v[88:89], v[94:95], v[94:95], v[88:89]
  v_pk_add_f32 v[96:97], v[54:55], v[92:93] op_sel_hi:[1,0] neg_lo:[0,1] neg_hi:[0,1]
  v_pk_fma_f32 v[90:91], v[96:97], v[96:97], v[90:91]
  v_pk_add_f32 v[94:95], v[56:57], v[92:93] op_sel_hi:[1,0] neg_lo:[0,1] neg_hi:[0,1]
  v_pk_fma_f32 v[88:89], v[94:95], v[94:95], v[88:89]
  v_pk_add_f32 v[96:97], v[58:59], v[92:93] op_sel_hi:[1,0] neg_lo:[0,1] neg_hi:[0,1]
  v_pk_fma_f32 v[90:91], v[96:97], v[96:97], v[90:91]
  v_pk_add_f32 v[94:95], v[60:61], v[92:93] op_sel_hi:[1,0] neg_lo:[0,1] neg_hi:[0,1]
  v_pk_fma_f32 v[88:89], v[94:95], v[94:95], v[88:89]
  v_pk_add_f32 v[96:97], v[62:63], v[92:93] op_sel_hi:[1,0] neg_lo:[0,1] neg_hi:[0,1]
  v_pk_fma_f32 v[90:91], v[96:97], v[96:97], v[90:91]
  v_pk_add_f32 v[94:95], v[64:65], v[92:93] op_sel_hi:[1,0] neg_lo:[0,1] neg_hi:[0,1]
  v_pk_fma_f32 v[88:89], v[94:95], v[94:95], v[88:89]
  v_pk_add_f32 v[96:97], v[66:67], v[92:93] op_sel_hi:[1,0] neg_lo:[0,1] neg_hi:[0,1]
  v_pk_fma_f32 v[90:91], v[96:97], v[96:97], v[90:91]
  v_pk_add_f32 v[94:95], v[68:69], v[92:93] op_sel_hi:[1,0] neg_lo:[0,1] neg_hi:[0,1]
  v_pk_fma_f32 v[88:89], v[94:95], v[94:95], v[88:89]
  v_pk_add_f32 v[96:97], v[70:71], v[92:93] op_sel_hi:[1,0] neg_lo:[0,1] neg_hi:[0,1]
  v_pk_fma_f32 v[90:91], v[96:97], v[96:97], v[90:91]
  v_pk_add_f32 v[94:95], v[72:73], v[92:93] op_sel_hi:[1,0] neg_lo:[0,1] neg_hi:[0,1]
  v_pk_fma_f32 v[88:89], v[94:95], v[94:95], v[88:89]
  v_pk_add_f32 v[96:97], v[74:75], v[92:93] op_sel_hi:[1,0] neg_lo:[0,1] neg_hi:[0,1]
  v_pk_fma_f32 v[90:91], v[96:97], v[96:97], v[90:91]
  v_pk_add_f32 v[94:95], v[76:77], v[92:93] op_sel_hi:[1,0] neg_lo:[0,1] neg_hi:[0,1]
  v_pk_fma_f32 v[88:89], v[94:95], v[94:95], v[88:89]
  v_pk_add_f32 v[96:97], v[78:79], v[92:93] op_sel_hi:[1,0] neg_lo:[0,1] neg_hi:[0,1]
  v_pk_fma_f32 v[90:91], v[96:97], v[96:97], v[90:91]
  v_pk_add_f32 v[94:95], v[80:81], v[92:93] op_sel_hi:[1,0] neg_lo:[0,1] neg_hi:[0,1]
  v_pk_fma_f32 v[88:89], v[94:95], v[94:95], v[88:89]
  v_pk_add_f32 v[96:97], v[82:83], v[92:93] op_sel_hi:[1,0] neg_lo:[0,1] neg_hi:[0,1]
  v_pk_fma_f32 v[90:91], v[96:97], v[96:97], v[90:91]
  v_pk_add_f32 v[94:95], v[84:85], v[92:93] op_sel_hi:[1,0] neg_lo:[0,1] neg_hi:[0,1]
  v_pk_fma_f32 v[88:89], v[94:95], v[94:95], v[88:89]
  v_pk_add_f32 v[96:97], v[86:87], v[92:93] op_sel_hi:[1,0] neg_lo:[0,1] neg_hi:[0,1]
  v_pk_fma_f32 v[90:91], v[96:97], v[96:97], v[90:91]
  v_pk_add_f32 v[88:89], v[88:89], v[90:91]
  v_add_f32 v98, v88, v89
  s_nop 1
  v_add_f32_dpp v98, v98, v98 row_ror:8 row_mask:0xf bank_mask:0xf
  v_cvt_pk_bf16_f32 v92, v92, v92
  s_nop 0
  v_add_f32_dpp v98, v98, v98 row_ror:4 row_mask:0xf bank_mask:0xf
  v_lshlrev_b32 v92, 16, v92
  s_nop 0
  v_add_f32_dpp v98, v98, v98 row_ror:2 row_mask:0xf bank_mask:0xf
  s_nop 1
  v_add_f32_dpp v98, v98, v98 row_ror:1 row_mask:0xf bank_mask:0xf
  v_mul_f32 v98, 0x3acccccd, v98
  v_cvt_pk_bf16_f32 v98, v98, v98
  v_pk_add_f32 v[48:49], v[48:49], v[92:93] op_sel_hi:[1,0] neg_lo:[0,1] neg_hi:[0,1]
  v_lshlrev_b32 v98, 16, v98
  v_pk_add_f32 v[50:51], v[50:51], v[92:93] op_sel_hi:[1,0] neg_lo:[0,1] neg_hi:[0,1]
  v_add_f32 v98, 0x3727c5ac, v98
  v_pk_add_f32 v[52:53], v[52:53], v[92:93] op_sel_hi:[1,0] neg_lo:[0,1] neg_hi:[0,1]
  v_cvt_pk_bf16_f32 v98, v98, v98
  v_pk_add_f32 v[54:55], v[54:55], v[92:93] op_sel_hi:[1,0] neg_lo:[0,1] neg_hi:[0,1]
  v_lshlrev_b32 v98, 16, v98
  v_pk_add_f32 v[56:57], v[56:57], v[92:93] op_sel_hi:[1,0] neg_lo:[0,1] neg_hi:[0,1]
  v_sqrt_f32 v98, v98
  v_pk_add_f32 v[58:59], v[58:59], v[92:93] op_sel_hi:[1,0] neg_lo:[0,1] neg_hi:[0,1]
  v_cvt_pk_bf16_f32 v98, v98, v98
  v_pk_add_f32 v[60:61], v[60:61], v[92:93] op_sel_hi:[1,0] neg_lo:[0,1] neg_hi:[0,1]
  v_lshlrev_b32 v98, 16, v98
  v_pk_add_f32 v[62:63], v[62:63], v[92:93] op_sel_hi:[1,0] neg_lo:[0,1] neg_hi:[0,1]
  v_rcp_f32 v100, v98
  v_pk_add_f32 v[64:65], v[64:65], v[92:93] op_sel_hi:[1,0] neg_lo:[0,1] neg_hi:[0,1]
  v_pk_add_f32 v[66:67], v[66:67], v[92:93] op_sel_hi:[1,0] neg_lo:[0,1] neg_hi:[0,1]
  v_pk_add_f32 v[68:69], v[68:69], v[92:93] op_sel_hi:[1,0] neg_lo:[0,1] neg_hi:[0,1]
  v_pk_add_f32 v[70:71], v[70:71], v[92:93] op_sel_hi:[1,0] neg_lo:[0,1] neg_hi:[0,1]
  v_pk_add_f32 v[72:73], v[72:73], v[92:93] op_sel_hi:[1,0] neg_lo:[0,1] neg_hi:[0,1]
  v_pk_add_f32 v[74:75], v[74:75], v[92:93] op_sel_hi:[1,0] neg_lo:[0,1] neg_hi:[0,1]
  v_pk_add_f32 v[76:77], v[76:77], v[92:93] op_sel_hi:[1,0] neg_lo:[0,1] neg_hi:[0,1]
  v_pk_add_f32 v[78:79], v[78:79], v[92:93] op_sel_hi:[1,0] neg_lo:[0,1] neg_hi:[0,1]
  v_pk_add_f32 v[80:81], v[80:81], v[92:93] op_sel_hi:[1,0] neg_lo:[0,1] neg_hi:[0,1]
  v_pk_add_f32 v[82:83], v[82:83], v[92:93] op_sel_hi:[1,0] neg_lo:[0,1] neg_hi:[0,1]
  v_pk_add_f32 v[84:85], v[84:85], v[92:93] op_sel_hi:[1,0] neg_lo:[0,1] neg_hi:[0,1]
  v_pk_add_f32 v[86:87], v[86:87], v[92:93] op_sel_hi:[1,0] neg_lo:[0,1] neg_hi:[0,1]
  v_mov_b32 v104, 0
  v_mov_b32 v105, 0
  v_cvt_pk_bf16_f32 v8, v48, v49
  v_cvt_pk_bf16_f32 v9, v50, v51
  v_cvt_pk_bf16_f32 v10, v52, v53
  v_cvt_pk_bf16_f32 v11, v54, v55
  v_cvt_pk_bf16_f32 v12, v56, v57
  v_cvt_pk_bf16_f32 v13, v58, v59
  v_cvt_pk_bf16_f32 v14, v60, v61
  v_cvt_pk_bf16_f32 v15, v62, v63
  v_cvt_pk_bf16_f32 v16, v64, v65
  v_cvt_pk_bf16_f32 v17, v66, v67
  v_cvt_pk_bf16_f32 v18, v68, v69
  v_cvt_pk_bf16_f32 v19, v70, v71
  v_cvt_pk_bf16_f32 v20, v72, v73
  v_cvt_pk_bf16_f32 v21, v74, v75
  v_cvt_pk_bf16_f32 v22, v76, v77
  v_cvt_pk_bf16_f32 v23, v78, v79
  v_cvt_pk_bf16_f32 v24, v80, v81
  v_cvt_pk_bf16_f32 v25, v82, v83
  v_cvt_pk_bf16_f32 v26, v84, v85
  v_cvt_pk_bf16_f32 v27, v86, v87
  v_lshlrev_b32 v48, 16, v8
  v_and_b32 v49, s56, v8
  v_lshlrev_b32 v50, 16, v9
  v_and_b32 v51, s56, v9
  v_lshlrev_b32 v52, 16, v10
  v_and_b32 v53, s56, v10
  v_lshlrev_b32 v54, 16, v11
  v_and_b32 v55, s56, v11
  v_lshlrev_b32 v56, 16, v12
  v_and_b32 v57, s56, v12
  v_lshlrev_b32 v58, 16, v13
  v_and_b32 v59, s56, v13
  v_lshlrev_b32 v60, 16, v14
  v_and_b32 v61, s56, v14
  v_lshlrev_b32 v62, 16, v15
  v_and_b32 v63, s56, v15
  v_lshlrev_b32 v64, 16, v16
  v_and_b32 v65, s56, v16
  v_lshlrev_b32 v66, 16, v17
  v_and_b32 v67, s56, v17
  v_lshlrev_b32 v68, 16, v18
  v_and_b32 v69, s56, v18
  v_lshlrev_b32 v70, 16, v19
  v_and_b32 v71, s56, v19
  v_lshlrev_b32 v72, 16, v20
  v_and_b32 v73, s56, v20
  v_lshlrev_b32 v74, 16, v21
  v_and_b32 v75, s56, v21
  v_lshlrev_b32 v76, 16, v22
  v_and_b32 v77, s56, v22
  v_lshlrev_b32 v78, 16, v23
  v_and_b32 v79, s56, v23
  v_lshlrev_b32 v80, 16, v24
  v_and_b32 v81, s56, v24
  v_lshlrev_b32 v82, 16, v25
  v_and_b32 v83, s56, v25
  v_lshlrev_b32 v84, 16, v26
  v_and_b32 v85, s56, v26
  v_lshlrev_b32 v86, 16, v27
  v_and_b32 v87, s56, v27
  v_pk_mul_f32 v[48:49], v[48:49], v[100:101] op_sel_hi:[1,0]
  v_pk_mul_f32 v[50:51], v[50:51], v[100:101] op_sel_hi:[1,0]
  v_pk_mul_f32 v[52:53], v[52:53], v[100:101] op_sel_hi:[1,0]
  v_pk_mul_f32 v[54:55], v[54:55], v[100:101] op_sel_hi:[1,0]
  v_cvt_pk_bf16_f32 v8, v48, v49
  v_cvt_pk_bf16_f32 v9, v50, v51
  v_cvt_pk_bf16_f32 v10, v52, v53
  v_cvt_pk_bf16_f32 v11, v54, v55
  buffer_store_dwordx4 v[8:11], v5, s[24:27], s53 offen sc1
  s_add_u32 s53, s53, 16384
  v_pk_mul_f32 v[56:57], v[56:57], v[100:101] op_sel_hi:[1,0]
  v_pk_mul_f32 v[58:59], v[58:59], v[100:101] op_sel_hi:[1,0]
  v_pk_mul_f32 v[60:61], v[60:61], v[100:101] op_sel_hi:[1,0]
  v_pk_mul_f32 v[62:63], v[62:63], v[100:101] op_sel_hi:[1,0]
  v_cvt_pk_bf16_f32 v12, v56, v57
  v_cvt_pk_bf16_f32 v13, v58, v59
  v_cvt_pk_bf16_f32 v14, v60, v61
  v_cvt_pk_bf16_f32 v15, v62, v63
  buffer_store_dwordx4 v[12:15], v5, s[24:27], s53 offen sc1
  s_add_u32 s53, s53, 16384
  v_pk_mul_f32 v[64:65], v[64:65], v[100:101] op_sel_hi:[1,0]
  v_pk_mul_f32 v[66:67], v[66:67], v[100:101] op_sel_hi:[1,0]
  v_pk_mul_f32 v[68:69], v[68:69], v[100:101] op_sel_hi:[1,0]
  v_pk_mul_f32 v[70:71], v[70:71], v[100:101] op_sel_hi:[1,0]
  v_cvt_pk_bf16_f32 v16, v64, v65
  v_cvt_pk_bf16_f32 v17, v66, v67
  v_cvt_pk_bf16_f32 v18, v68, v69
  v_cvt_pk_bf16_f32 v19, v70, v71
  buffer_store_dwordx4 v[16:19], v5, s[24:27], s53 offen sc1
  s_add_u32 s53, s53, 16384
  v_pk_mul_f32 v[72:73], v[72:73], v[100:101] op_sel_hi:[1,0]
  v_pk_mul_f32 v[74:75], v[74:75], v[100:101] op_sel_hi:[1,0]
  v_pk_mul_f32 v[76:77], v[76:77], v[100:101] op_sel_hi:[1,0]
  v_pk_mul_f32 v[78:79], v[78:79], v[100:101] op_sel_hi:[1,0]
  v_cvt_pk_bf16_f32 v20, v72, v73
  v_cvt_pk_bf16_f32 v21, v74, v75
  v_cvt_pk_bf16_f32 v22, v76, v77
  v_cvt_pk_bf16_f32 v23, v78, v79
  buffer_store_dwordx4 v[20:23], v5, s[24:27], s53 offen sc1
  s_add_u32 s53, s53, 16384
  v_pk_mul_f32 v[80:81], v[80:81], v[100:101] op_sel_hi:[1,0]
  v_pk_mul_f32 v[82:83], v[82:83], v[100:101] op_sel_hi:[1,0]
  v_pk_mul_f32 v[84:85], v[84:85], v[100:101] op_sel_hi:[1,0]
  v_pk_mul_f32 v[86:87], v[86:87], v[100:101] op_sel_hi:[1,0]
  v_cvt_pk_bf16_f32 v24, v80, v81
  v_cvt_pk_bf16_f32 v25, v82, v83
  v_cvt_pk_bf16_f32 v26, v84, v85
  v_cvt_pk_bf16_f32 v27, v86, v87
  buffer_store_dwordx4 v[24:27], v5, s[24:27], s53 offen sc1
  s_add_u32 s53, s53, 16384
  s_waitcnt vmcnt(11)
  v_dot2_f32_bf16 v104, v8, v28, v104
  v_dot2_f32_bf16 v105, v9, v29, v105
  v_dot2_f32_bf16 v104, v10, v30, v104
  v_dot2_f32_bf16 v105, v11, v31, v105
  s_waitcnt vmcnt(10)
  v_dot2_f32_bf16 v104, v12, v32, v104
  v_dot2_f32_bf16 v105, v13, v33, v105
  v_dot2_f32_bf16 v104, v14, v34, v104
  v_dot2_f32_bf16 v105, v15, v35, v105
  s_waitcnt vmcnt(9)
  v_dot2_f32_bf16 v104, v16, v36, v104
  v_dot2_f32_bf16 v105, v17, v37, v105
  v_dot2_f32_bf16 v104, v18, v38, v104
  v_dot2_f32_bf16 v105, v19, v39, v105
  s_waitcnt vmcnt(8)
  v_dot2_f32_bf16 v104, v20, v40, v104
  v_dot2_f32_bf16 v105, v21, v41, v105
  v_dot2_f32_bf16 v104, v22, v42, v104
  v_dot2_f32_bf16 v105, v23, v43, v105
  s_waitcnt vmcnt(7)
  v_dot2_f32_bf16 v104, v24, v44, v104
  v_dot2_f32_bf16 v105, v25, v45, v105
  v_dot2_f32_bf16 v104, v26, v46, v104
  v_dot2_f32_bf16 v105, v27, v47, v105
  s_nop 2
  v_add_f32 v104, v104, v105
  s_nop 1
  v_add_f32_dpp v104, v104, v104 row_ror:8 row_mask:0xf bank_mask:0xf
  s_nop 1
  v_add_f32_dpp v104, v104, v104 row_ror:4 row_mask:0xf bank_mask:0xf
  s_nop 1
  v_add_f32_dpp v104, v104, v104 row_ror:2 row_mask:0xf bank_mask:0xf
  s_nop 1
  v_add_f32_dpp v104, v104, v104 row_ror:1 row_mask:0xf bank_mask:0xf
  v_cvt_pk_bf16_f32 v104, v104, v104
  v_lshlrev_b32 v104, 16, v104
  v_ashrrev_i32 v105, 31, v104
  v_or_b32 v105, 0x80000000, v105
  v_xor_b32 v104, v104, v105
  v_and_b32 v104, s56, v104
  v_add_u32 v6, s52, v1
  v_sub_u32 v7, 0xffff, v6
  v_or_b32 v104, v104, v7
  v_lshlrev_b32 v6, 2, v6
  v_lshl_add_u32 v6, v2, 26, v6
  s_mov_b32 s53, 2621440
  buffer_store_dword v104, v6, s[24:27], s53 offen sc1
  s_waitcnt vmcnt(0)
  s_branch front_join
front_fetch:
  v_subrev_u32 v16, 0x40000, v238
  v_subrev_u32 v17, 0x40000, v239
  v_subrev_u32 v18, 0x40000, v240
  v_subrev_u32 v19, 0x40000, v241
front_join:
  s_waitcnt lgkmcnt(0)
  s_barrier
  s_mul_i32 s55, s59, 0x9e3779b1
  s_add_u32 s55, s55, 0x7f4a7c15
  s_bfe_u32 s58, s2, 0x30003
  s_lshl_b32 s58, s58, 8
  s_add_u32 s58, s58, 2826240
  s_lshl_b32 s53, s36, 2
  s_lshl_b32 s54, s3, 26
  s_add_u32 s53, s53, s54
  v_min_u32 v1, 1, v0
  v_lshlrev_b32 v1, 28, v1
  v_add_u32 v1, s53, v1
  v_mov_b32 v2, s55
  buffer_store_dword v2, v1, s[24:27], s58 offen sc1
  s_cmp_lt_u32 s3, 2
  s_cbranch_scc1 front_addr
  s_mov_b32 s31, 0
  s_add_u32 m0, s28, 90112
  s_nop 0
  buffer_load_dwordx4 v16, s[20:23], s31 offen offset:0 lds
  buffer_load_dwordx4 v17, s[20:23], s31 offen offset:1024 lds
  buffer_load_dwordx4 v18, s[20:23], s31 offen offset:2048 lds
  buffer_load_dwordx4 v19, s[20:23], s31 offen offset:3072 lds
  s_add_u32 m0, s28, 98304
  s_nop 0
  buffer_load_dwordx4 v238, s[20:23], s31 offen offset:0 lds
  buffer_load_dwordx4 v239, s[20:23], s31 offen offset:1024 lds
  buffer_load_dwordx4 v240, s[20:23], s31 offen offset:2048 lds
  buffer_load_dwordx4 v241, s[20:23], s31 offen offset:3072 lds
  s_mov_b32 s31, 524288
  s_add_u32 m0, s28, 106496
  s_nop 0
  buffer_load_dwordx4 v16, s[20:23], s31 offen offset:0 lds
  buffer_load_dwordx4 v17, s[20:23], s31 offen offset:1024 lds
  buffer_load_dwordx4 v18, s[20:23], s31 offen offset:2048 lds
  buffer_load_dwordx4 v19, s[20:23], s31 offen offset:3072 lds
  s_add_u32 m0, s28, 114688
  s_nop 0
  buffer_load_dwordx4 v238, s[20:23], s31 offen offset:0 lds
  buffer_load_dwordx4 v239, s[20:23], s31 offen offset:1024 lds
  buffer_load_dwordx4 v240, s[20:23], s31 offen offset:2048 lds
  buffer_load_dwordx4 v241, s[20:23], s31 offen offset:3072 lds
  s_mov_b32 s31, 1048576
  s_add_u32 m0, s28, 24576
  s_nop 0
  buffer_load_dwordx4 v16, s[20:23], s31 offen offset:0 lds
  buffer_load_dwordx4 v17, s[20:23], s31 offen offset:1024 lds
  buffer_load_dwordx4 v18, s[20:23], s31 offen offset:2048 lds
  buffer_load_dwordx4 v19, s[20:23], s31 offen offset:3072 lds
  s_add_u32 m0, s28, 32768
  s_nop 0
  buffer_load_dwordx4 v238, s[20:23], s31 offen offset:0 lds
  buffer_load_dwordx4 v239, s[20:23], s31 offen offset:1024 lds
  buffer_load_dwordx4 v240, s[20:23], s31 offen offset:2048 lds
  buffer_load_dwordx4 v241, s[20:23], s31 offen offset:3072 lds
  s_mov_b32 s31, 1572864
  s_add_u32 m0, s28, 40960
  s_nop 0
  buffer_load_dwordx4 v16, s[20:23], s31 offen offset:0 lds
  buffer_load_dwordx4 v17, s[20:23], s31 offen offset:1024 lds
  buffer_load_dwordx4 v18, s[20:23], s31 offen offset:2048 lds
  buffer_load_dwordx4 v19, s[20:23], s31 offen offset:3072 lds
  s_add_u32 m0, s28, 49152
  s_nop 0
  buffer_load_dwordx4 v238, s[20:23], s31 offen offset:0 lds
  buffer_load_dwordx4 v239, s[20:23], s31 offen offset:1024 lds
  buffer_load_dwordx4 v240, s[20:23], s31 offen offset:2048 lds
  buffer_load_dwordx4 v241, s[20:23], s31 offen offset:3072 lds
front_addr:
  s_mov_b32 s31, 2097152
  v_lshlrev_b32 v242, 4, v245
  v_add_u32 v243, 0x1000, v242
  s_mul_i32 s30, s37, 81920
  s_lshl_b32 s38, s36, 19
  s_add_u32 s12, s4, s38
  s_addc_u32 s13, s5, 0
  s_mov_b32 s14, 524288
  s_mov_b32 s15, 0x20000
  s_add_u32 s16, s6, s38
  s_addc_u32 s17, s7, 0
  s_mov_b32 s18, 524288
  s_mov_b32 s19, 0x20000
  v_lshlrev_b32 v249, 8, v248
  v_add_u32 v249, s28, v249
  v_add_u32 v250, 0, v248
  v_xor_b32 v250, v250, v247
  v_lshl_add_u32 v232, v250, 4, v249
  v_add_u32 v250, 4, v248
  v_xor_b32 v250, v250, v247
  v_lshl_add_u32 v233, v250, 4, v249
  v_add_u32 v250, 8, v248
  v_xor_b32 v250, v250, v247
  v_lshl_add_u32 v234, v250, 4, v249
  v_add_u32 v250, 12, v248
  v_xor_b32 v250, v250, v247
  v_lshl_add_u32 v235, v250, 4, v249
  v_add_u32 v250, 0, v248
  v_lshlrev_b32 v250, 1, v250
  v_xor_b32 v250, v250, v247
  v_lshl_add_u32 v236, v250, 4, v249
  v_add_u32 v250, 4, v248
  v_lshlrev_b32 v250, 1, v250
  v_xor_b32 v250, v250, v247
  v_lshl_add_u32 v237, v250, 4, v249
  v_lshrrev_b32 v249, 1, v248
  v_and_b32 v250, 1, v248
  v_lshl_or_b32 v249, v250, 1, v249
  v_xor_b32 v249, v249, v247
  v_lshlrev_b32 v249, 4, v249
  v_lshl_add_u32 v212, v247, 8, v249
  v_xor_b32 v213, 64, v212
  v_xor_b32 v214, 128, v212
  v_xor_b32 v215, 192, v212
  v_bfe_u32 v246, v245, 2, 2
  v_and_b32 v247, 3, v245
  v_lshlrev_b32 v247, 3, v247
  v_add_u32 v247, 65536, v247
  v_lshl_add_u32 v249, v248, 2, v246
  v_and_b32 v250, 7, v249
  v_lshl_add_u32 v250, v250, 5, v247
  v_lshl_add_u32 v216, v249, 8, v250
  v_lshl_add_u32 v249, v248, 3, v246
  v_and_b32 v250, 1, v248
  v_lshl_add_u32 v250, v250, 2, v246
  v_lshl_add_u32 v250, v250, 5, v247
  v_lshl_add_u32 v224, v249, 8, v250
  v_xor_b32 v217, 32, v216
  v_xor_b32 v225, 32, v224
  v_xor_b32 v218, 64, v216
  v_xor_b32 v226, 64, v224
  v_xor_b32 v219, 96, v216
  v_xor_b32 v227, 96, v224
  v_xor_b32 v220, 128, v216
  v_xor_b32 v228, 128, v224
  v_xor_b32 v221, 160, v216
  v_xor_b32 v229, 160, v224
  v_xor_b32 v222, 192, v216
  v_xor_b32 v230, 192, v224
  v_xor_b32 v223, 224, v216
  v_xor_b32 v231, 224, v224
  v_subrev_u32 v144, 65536, v224
  v_subrev_u32 v145, 65536, v225
  v_subrev_u32 v146, 65536, v226
  v_subrev_u32 v147, 65536, v227
  v_subrev_u32 v148, 65536, v228
  v_subrev_u32 v149, 65536, v229
  v_subrev_u32 v150, 65536, v230
  v_subrev_u32 v151, 65536, v231
  s_lshr_b32 s38, s2, 3
  s_min_u32 s38, s38, 26
  s_and_b32 s39, s2, 7
  s_mul_i32 s39, s39, 27
  s_add_u32 s33, s38, s39
  s_mul_i32 s50, s3, 6144
  s_add_u32 s50, s50, 133120
  v_mov_b32 v244, v242
  s_lshl_b32 s40, s37, 19
  s_lshl_b32 s38, s36, 14
  s_add_u32 s40, s40, s38
  s_add_u32 s40, s40, 8388608
  s_add_u32 s41, s40, 4096
  s_add_u32 s42, s40, 8192
  s_add_u32 s43, s40, 12288
  s_mov_b32 s34, 0x3e0293ee
  s_mov_b32 s29, 0
  v_and_b32 v249, 15, v245
  v_cmp_eq_u32 vcc, 0, v249
  v_mov_b32 v249, 0x3f803f80
  s_nop 0
  v_cndmask_b32 v249, 0, v249, vcc
  v_accvgpr_write_b32 a208, v249
  v_accvgpr_write_b32 a209, v249
  v_accvgpr_write_b32 a210, v249
  v_accvgpr_write_b32 a211, v249
  s_cmp_lg_u32 s3, 0
  s_cbranch_scc1 front_go
  v_and_b32 v2, 31, v0
  v_lshlrev_b32 v2, 2, v2
  s_mov_b32 s54, 32768
front_poll:
  buffer_load_dword v1, v2, s[24:27], s58 offen sc1
  s_waitcnt vmcnt(0)
  v_cmp_ne_u32 vcc, s55, v1
  s_nop 0
  s_cbranch_vccz front_go
  s_sleep 2
  s_sub_u32 s54, s54, 1
  s_cmp_lg_u32 s54, 0
  s_cbranch_scc1 front_poll
front_go:
  s_waitcnt vmcnt(24)
  s_barrier
  buffer_load_dwordx4 a[0:3], v242, s[24:27], s30 offen offset:0 sc1
  buffer_load_dwordx4 a[4:7], v242, s[24:27], s30 offen offset:1024 sc1
  buffer_load_dwordx4 a[8:11], v242, s[24:27], s30 offen offset:2048 sc1
  buffer_load_dwordx4 a[12:15], v242, s[24:27], s30 offen offset:3072 sc1
  buffer_load_dwordx4 a[16:19], v243, s[24:27], s30 offen offset:0 sc1
  buffer_load_dwordx4 a[20:23], v243, s[24:27], s30 offen offset:1024 sc1
  buffer_load_dwordx4 a[24:27], v243, s[24:27], s30 offen offset:2048 sc1
  buffer_load_dwordx4 a[28:31], v243, s[24:27], s30 offen offset:3072 sc1
  s_add_u32 s30, s30, 8192
  buffer_load_dwordx4 a[32:35], v242, s[24:27], s30 offen offset:0 sc1
  buffer_load_dwordx4 a[36:39], v242, s[24:27], s30 offen offset:1024 sc1
  buffer_load_dwordx4 a[40:43], v242, s[24:27], s30 offen offset:2048 sc1
  buffer_load_dwordx4 a[44:47], v242, s[24:27], s30 offen offset:3072 sc1
  buffer_load_dwordx4 a[48:51], v243, s[24:27], s30 offen offset:0 sc1
  buffer_load_dwordx4 a[52:55], v243, s[24:27], s30 offen offset:1024 sc1
  buffer_load_dwordx4 a[56:59], v243, s[24:27], s30 offen offset:2048 sc1
  buffer_load_dwordx4 a[60:63], v243, s[24:27], s30 offen offset:3072 sc1
  s_add_u32 s30, s30, 8192
  v_lshrrev_b32 v140, 7, v242
  v_lshlrev_b32 v140, 8, v140
  v_and_b32 v136, 0x70, v242
  v_add_u32 v140, v140, v136
  s_mov_b32 s58, 2826240
  buffer_load_dwordx4 v[136:139], v140, s[24:27], s58 offen sc1
  ds_read_b64_tr_b16 a[160:161], v224 offset:32768
  ds_read_b64_tr_b16 a[162:163], v224 offset:33792
  ds_read_b64_tr_b16 a[164:165], v224 offset:40960
  ds_read_b64_tr_b16 a[166:167], v224 offset:41984
  ds_read_b64_tr_b16 a[168:169], v225 offset:32768
  ds_read_b64_tr_b16 a[170:171], v225 offset:33792
  ds_read_b64_tr_b16 a[172:173], v225 offset:40960
  ds_read_b64_tr_b16 a[174:175], v225 offset:41984
  s_waitcnt vmcnt(9) lgkmcnt(4)
  v_mfma_f32_16x16x32_bf16 v[0:3], a[160:163], a[0:3], 0
  ds_read_b64_tr_b16 a[176:177], v226 offset:32768
  v_mfma_f32_16x16x32_bf16 v[0:3], a[164:167], a[16:19], v[0:3]
  buffer_load_dwordx4 a[64:67], v242, s[24:27], s30 offen offset:0 sc1
  v_mfma_f32_16x16x32_bf16 v[4:7], a[164:167], a[20:23], 0
  ds_read_b64_tr_b16 a[178:179], v226 offset:33792
  v_mfma_f32_16x16x32_bf16 v[4:7], a[160:163], a[4:7], v[4:7]
  buffer_load_dwordx4 a[68:71], v242, s[24:27], s30 offen offset:1024 sc1
  v_mfma_f32_16x16x32_bf16 v[8:11], a[160:163], a[8:11], 0
  ds_read_b64_tr_b16 a[180:181], v226 offset:40960
  v_mfma_f32_16x16x32_bf16 v[8:11], a[164:167], a[24:27], v[8:11]
  v_mfma_f32_16x16x32_bf16 v[12:15], a[164:167], a[28:31], 0
  ds_read_b64_tr_b16 a[182:183], v226 offset:41984
  v_mfma_f32_16x16x32_bf16 v[12:15], a[160:163], a[12:15], v[12:15]
  s_waitcnt lgkmcnt(4)
  buffer_load_dwordx4 a[72:75], v242, s[24:27], s30 offen offset:2048 sc1
  v_mfma_f32_16x16x32_bf16 v[16:19], a[168:171], a[0:3], 0
  ds_read_b64_tr_b16 a[184:185], v227 offset:32768
  v_mfma_f32_16x16x32_bf16 v[16:19], a[172:175], a[16:19], v[16:19]
  v_mfma_f32_16x16x32_bf16 v[20:23], a[172:175], a[20:23], 0
  ds_read_b64_tr_b16 a[186:187], v227 offset:33792
  v_mfma_f32_16x16x32_bf16 v[20:23], a[168:171], a[4:7], v[20:23]
  buffer_load_dwordx4 a[76:79], v242, s[24:27], s30 offen offset:3072 sc1
  v_mfma_f32_16x16x32_bf16 v[24:27], a[168:171], a[8:11], 0
  ds_read_b64_tr_b16 a[188:189], v227 offset:40960
  v_mfma_f32_16x16x32_bf16 v[24:27], a[172:175], a[24:27], v[24:27]
  buffer_load_dwordx4 a[80:83], v243, s[24:27], s30 offen offset:0 sc1
  v_mfma_f32_16x16x32_bf16 v[28:31], a[172:175], a[28:31], 0
  ds_read_b64_tr_b16 a[190:191], v227 offset:41984
  v_mfma_f32_16x16x32_bf16 v[28:31], a[168:171], a[12:15], v[28:31]
  s_waitcnt lgkmcnt(4)
  v_mfma_f32_16x16x32_bf16 v[32:35], a[176:179], a[0:3], 0
  ds_read_b64_tr_b16 a[160:161], v228 offset:32768
  v_mfma_f32_16x16x32_bf16 v[32:35], a[180:183], a[16:19], v[32:35]
  buffer_load_dwordx4 a[84:87], v243, s[24:27], s30 offen offset:1024 sc1
  v_mfma_f32_16x16x32_bf16 v[36:39], a[180:183], a[20:23], 0
  ds_read_b64_tr_b16 a[162:163], v228 offset:33792
  v_mfma_f32_16x16x32_bf16 v[36:39], a[176:179], a[4:7], v[36:39]
  v_mfma_f32_16x16x32_bf16 v[40:43], a[176:179], a[8:11], 0
  ds_read_b64_tr_b16 a[164:165], v228 offset:40960
  v_mfma_f32_16x16x32_bf16 v[40:43], a[180:183], a[24:27], v[40:43]
  buffer_load_dwordx4 a[88:91], v243, s[24:27], s30 offen offset:2048 sc1
  v_mfma_f32_16x16x32_bf16 v[44:47], a[180:183], a[28:31], 0
  ds_read_b64_tr_b16 a[166:167], v228 offset:41984
  v_mfma_f32_16x16x32_bf16 v[44:47], a[176:179], a[12:15], v[44:47]
  s_waitcnt lgkmcnt(4)
  buffer_load_dwordx4 a[92:95], v243, s[24:27], s30 offen offset:3072 sc1
  v_mfma_f32_16x16x32_bf16 v[48:51], a[184:187], a[0:3], 0
  ds_read_b64_tr_b16 a[168:169], v229 offset:32768
  v_mfma_f32_16x16x32_bf16 v[48:51], a[188:191], a[16:19], v[48:51]
  v_mfma_f32_16x16x32_bf16 v[52:55], a[188:191], a[20:23], 0
  ds_read_b64_tr_b16 a[170:171], v229 offset:33792
  v_mfma_f32_16x16x32_bf16 v[52:55], a[184:187], a[4:7], v[52:55]
  s_add_u32 s30, s30, 8192
  v_mfma_f32_16x16x32_bf16 v[56:59], a[184:187], a[8:11], 0
  ds_read_b64_tr_b16 a[172:173], v229 offset:40960
  v_mfma_f32_16x16x32_bf16 v[56:59], a[188:191], a[24:27], v[56:59]
  v_mfma_f32_16x16x32_bf16 v[60:63], a[188:191], a[28:31], 0
  ds_read_b64_tr_b16 a[174:175], v229 offset:41984
  v_mfma_f32_16x16x32_bf16 v[60:63], a[184:187], a[12:15], v[60:63]
  s_waitcnt lgkmcnt(4)
  buffer_load_dwordx4 a[96:99], v242, s[24:27], s30 offen offset:0 sc1
  v_mfma_f32_16x16x32_bf16 v[64:67], a[160:163], a[0:3], 0
  ds_read_b64_tr_b16 a[176:177], v230 offset:32768
  v_mfma_f32_16x16x32_bf16 v[64:67], a[164:167], a[16:19], v[64:67]
  buffer_load_dwordx4 a[100:103], v242, s[24:27], s30 offen offset:1024 sc1
  v_mfma_f32_16x16x32_bf16 v[68:71], a[164:167], a[20:23], 0
  ds_read_b64_tr_b16 a[178:179], v230 offset:33792
  v_mfma_f32_16x16x32_bf16 v[68:71], a[160:163], a[4:7], v[68:71]
  v_mfma_f32_16x16x32_bf16 v[72:75], a[160:163], a[8:11], 0
  ds_read_b64_tr_b16 a[180:181], v230 offset:40960
  v_mfma_f32_16x16x32_bf16 v[72:75], a[164:167], a[24:27], v[72:75]
  buffer_load_dwordx4 a[104:107], v242, s[24:27], s30 offen offset:2048 sc1
  v_mfma_f32_16x16x32_bf16 v[76:79], a[164:167], a[28:31], 0
  ds_read_b64_tr_b16 a[182:183], v230 offset:41984
  v_mfma_f32_16x16x32_bf16 v[76:79], a[160:163], a[12:15], v[76:79]
  s_waitcnt lgkmcnt(4)
  v_mfma_f32_16x16x32_bf16 v[80:83], a[168:171], a[0:3], 0
  ds_read_b64_tr_b16 a[184:185], v231 offset:32768
  v_mfma_f32_16x16x32_bf16 v[80:83], a[172:175], a[16:19], v[80:83]
  buffer_load_dwordx4 a[108:111], v242, s[24:27], s30 offen offset:3072 sc1
  v_mfma_f32_16x16x32_bf16 v[84:87], a[172:175], a[20:23], 0
  ds_read_b64_tr_b16 a[186:187], v231 offset:33792
  v_mfma_f32_16x16x32_bf16 v[84:87], a[168:171], a[4:7], v[84:87]
  buffer_load_dwordx4 a[112:115], v243, s[24:27], s30 offen offset:0 sc1
  v_mfma_f32_16x16x32_bf16 v[88:91], a[168:171], a[8:11], 0
  ds_read_b64_tr_b16 a[188:189], v231 offset:40960
  v_mfma_f32_16x16x32_bf16 v[88:91], a[172:175], a[24:27], v[88:91]
  s_barrier
  v_mfma_f32_16x16x32_bf16 v[92:95], a[172:175], a[28:31], 0
  ds_read_b64_tr_b16 a[190:191], v231 offset:41984
  v_mfma_f32_16x16x32_bf16 v[92:95], a[168:171], a[12:15], v[92:95]
  s_waitcnt lgkmcnt(4)
  buffer_load_dwordx4 a[116:119], v243, s[24:27], s30 offen offset:1024 sc1
  v_mfma_f32_16x16x32_bf16 v[96:99], a[176:179], a[0:3], 0
  ds_read_b64_tr_b16 a[160:161], v224 offset:49152
  v_mfma_f32_16x16x32_bf16 v[96:99], a[180:183], a[16:19], v[96:99]
  v_mfma_f32_16x16x32_bf16 v[100:103], a[180:183], a[20:23], 0
  ds_read_b64_tr_b16 a[162:163], v224 offset:50176
  v_mfma_f32_16x16x32_bf16 v[100:103], a[176:179], a[4:7], v[100:103]
  buffer_load_dwordx4 a[120:123], v243, s[24:27], s30 offen offset:2048 sc1
  v_mfma_f32_16x16x32_bf16 v[104:107], a[176:179], a[8:11], 0
  ds_read_b64_tr_b16 a[164:165], v224 offset:57344
  v_mfma_f32_16x16x32_bf16 v[104:107], a[180:183], a[24:27], v[104:107]
  buffer_load_dwordx4 a[124:127], v243, s[24:27], s30 offen offset:3072 sc1
  v_mfma_f32_16x16x32_bf16 v[108:111], a[180:183], a[28:31], 0
  ds_read_b64_tr_b16 a[166:167], v224 offset:58368
  v_mfma_f32_16x16x32_bf16 v[108:111], a[176:179], a[12:15], v[108:111]
  s_waitcnt lgkmcnt(4)
  v_mfma_f32_16x16x32_bf16 v[112:115], a[184:187], a[0:3], 0
  ds_read_b64_tr_b16 a[168:169], v225 offset:49152
  v_mfma_f32_16x16x32_bf16 v[112:115], a[188:191], a[16:19], v[112:115]
  s_add_u32 s30, s30, 8192
  v_mfma_f32_16x16x32_bf16 v[116:119], a[188:191], a[20:23], 0
  ds_read_b64_tr_b16 a[170:171], v225 offset:50176
  v_mfma_f32_16x16x32_bf16 v[116:119], a[184:187], a[4:7], v[116:119]
  v_mfma_f32_16x16x32_bf16 v[120:123], a[184:187], a[8:11], 0
  ds_read_b64_tr_b16 a[172:173], v225 offset:57344
  v_mfma_f32_16x16x32_bf16 v[120:123], a[188:191], a[24:27], v[120:123]
  v_mfma_f32_16x16x32_bf16 v[124:127], a[188:191], a[28:31], 0
  ds_read_b64_tr_b16 a[174:175], v225 offset:58368
  v_mfma_f32_16x16x32_bf16 v[124:127], a[184:187], a[12:15], v[124:127]
  s_waitcnt vmcnt(17) lgkmcnt(4)
  v_mfma_f32_16x16x32_bf16 v[0:3], a[160:163], a[32:35], v[0:3]
  ds_read_b64_tr_b16 a[176:177], v226 offset:49152
  v_mfma_f32_16x16x32_bf16 v[0:3], a[164:167], a[48:51], v[0:3]
  buffer_load_dwordx4 a[0:3], v242, s[24:27], s30 offen offset:0 sc1
  v_mfma_f32_16x16x32_bf16 v[4:7], a[164:167], a[52:55], v[4:7]
  ds_read_b64_tr_b16 a[178:179], v226 offset:50176
  v_mfma_f32_16x16x32_bf16 v[4:7], a[160:163], a[36:39], v[4:7]
  v_mfma_f32_16x16x32_bf16 v[8:11], a[160:163], a[40:43], v[8:11]
  ds_read_b64_tr_b16 a[180:181], v226 offset:57344
  s_add_u32 m0, s28, 16384
  v_mfma_f32_16x16x32_bf16 v[8:11], a[164:167], a[56:59], v[8:11]
  buffer_load_dwordx4 v238, s[20:23], s31 offen offset:0 lds
  v_mfma_f32_16x16x32_bf16 v[12:15], a[164:167], a[60:63], v[12:15]
  ds_read_b64_tr_b16 a[182:183], v226 offset:58368
  v_mfma_f32_16x16x32_bf16 v[12:15], a[160:163], a[44:47], v[12:15]
  s_waitcnt lgkmcnt(4)
  v_mfma_f32_16x16x32_bf16 v[16:19], a[168:171], a[32:35], v[16:19]
  ds_read_b64_tr_b16 a[184:185], v227 offset:49152
  v_mfma_f32_16x16x32_bf16 v[16:19], a[172:175], a[48:51], v[16:19]
  buffer_load_dwordx4 a[4:7], v242, s[24:27], s30 offen offset:1024 sc1
  v_mfma_f32_16x16x32_bf16 v[20:23], a[172:175], a[52:55], v[20:23]
  ds_read_b64_tr_b16 a[186:187], v227 offset:50176
  v_mfma_f32_16x16x32_bf16 v[20:23], a[168:171], a[36:39], v[20:23]
  v_mfma_f32_16x16x32_bf16 v[24:27], a[168:171], a[40:43], v[24:27]
  ds_read_b64_tr_b16 a[188:189], v227 offset:57344
  v_mfma_f32_16x16x32_bf16 v[24:27], a[172:175], a[56:59], v[24:27]
  v_mfma_f32_16x16x32_bf16 v[28:31], a[172:175], a[60:63], v[28:31]
  ds_read_b64_tr_b16 a[190:191], v227 offset:58368
  v_mfma_f32_16x16x32_bf16 v[28:31], a[168:171], a[44:47], v[28:31]
  s_waitcnt lgkmcnt(4)
  v_mfma_f32_16x16x32_bf16 v[32:35], a[176:179], a[32:35], v[32:35]
  ds_read_b64_tr_b16 a[160:161], v228 offset:49152
  v_mfma_f32_16x16x32_bf16 v[32:35], a[180:183], a[48:51], v[32:35]
  buffer_load_dwordx4 a[8:11], v242, s[24:27], s30 offen offset:2048 sc1
  v_mfma_f32_16x16x32_bf16 v[36:39], a[180:183], a[52:55], v[36:39]
  ds_read_b64_tr_b16 a[162:163], v228 offset:50176
  v_mfma_f32_16x16x32_bf16 v[36:39], a[176:179], a[36:39], v[36:39]
  v_mfma_f32_16x16x32_bf16 v[40:43], a[176:179], a[40:43], v[40:43]
  ds_read_b64_tr_b16 a[164:165], v228 offset:57344
  v_mfma_f32_16x16x32_bf16 v[40:43], a[180:183], a[56:59], v[40:43]
  buffer_load_dwordx4 v239, s[20:23], s31 offen offset:1024 lds
  v_mfma_f32_16x16x32_bf16 v[44:47], a[180:183], a[60:63], v[44:47]
  ds_read_b64_tr_b16 a[166:167], v228 offset:58368
  v_mfma_f32_16x16x32_bf16 v[44:47], a[176:179], a[44:47], v[44:47]
  s_waitcnt lgkmcnt(4)
  v_mfma_f32_16x16x32_bf16 v[48:51], a[184:187], a[32:35], v[48:51]
  ds_read_b64_tr_b16 a[168:169], v229 offset:49152
  v_mfma_f32_16x16x32_bf16 v[48:51], a[188:191], a[48:51], v[48:51]
  buffer_load_dwordx4 a[12:15], v242, s[24:27], s30 offen offset:3072 sc1
  v_mfma_f32_16x16x32_bf16 v[52:55], a[188:191], a[52:55], v[52:55]
  ds_read_b64_tr_b16 a[170:171], v229 offset:50176
  v_mfma_f32_16x16x32_bf16 v[52:55], a[184:187], a[36:39], v[52:55]
  v_mfma_f32_16x16x32_bf16 v[56:59], a[184:187], a[40:43], v[56:59]
  ds_read_b64_tr_b16 a[172:173], v229 offset:57344
  v_mfma_f32_16x16x32_bf16 v[56:59], a[188:191], a[56:59], v[56:59]
  v_mfma_f32_16x16x32_bf16 v[60:63], a[188:191], a[60:63], v[60:63]
  ds_read_b64_tr_b16 a[174:175], v229 offset:58368
  v_mfma_f32_16x16x32_bf16 v[60:63], a[184:187], a[44:47], v[60:63]
  s_waitcnt lgkmcnt(4)
  v_mfma_f32_16x16x32_bf16 v[64:67], a[160:163], a[32:35], v[64:67]
  ds_read_b64_tr_b16 a[176:177], v230 offset:49152
  v_mfma_f32_16x16x32_bf16 v[64:67], a[164:167], a[48:51], v[64:67]
  buffer_load_dwordx4 a[16:19], v243, s[24:27], s30 offen offset:0 sc1
  v_mfma_f32_16x16x32_bf16 v[68:71], a[164:167], a[52:55], v[68:71]
  ds_read_b64_tr_b16 a[178:179], v230 offset:50176
  v_mfma_f32_16x16x32_bf16 v[68:71], a[160:163], a[36:39], v[68:71]
  v_mfma_f32_16x16x32_bf16 v[72:75], a[160:163], a[40:43], v[72:75]
  ds_read_b64_tr_b16 a[180:181], v230 offset:57344
  v_mfma_f32_16x16x32_bf16 v[72:75], a[164:167], a[56:59], v[72:75]
  buffer_load_dwordx4 v240, s[20:23], s31 offen offset:2048 lds
  v_mfma_f32_16x16x32_bf16 v[76:79], a[164:167], a[60:63], v[76:79]
  ds_read_b64_tr_b16 a[182:183], v230 offset:58368
  v_mfma_f32_16x16x32_bf16 v[76:79], a[160:163], a[44:47], v[76:79]
  s_waitcnt lgkmcnt(4)
  v_mfma_f32_16x16x32_bf16 v[80:83], a[168:171], a[32:35], v[80:83]
  ds_read_b64_tr_b16 a[184:185], v231 offset:49152
  v_mfma_f32_16x16x32_bf16 v[80:83], a[172:175], a[48:51], v[80:83]
  buffer_load_dwordx4 a[20:23], v243, s[24:27], s30 offen offset:1024 sc1
  v_mfma_f32_16x16x32_bf16 v[84:87], a[172:175], a[52:55], v[84:87]
  ds_read_b64_tr_b16 a[186:187], v231 offset:50176
  v_mfma_f32_16x16x32_bf16 v[84:87], a[168:171], a[36:39], v[84:87]
  v_mfma_f32_16x16x32_bf16 v[88:91], a[168:171], a[40:43], v[88:91]
  ds_read_b64_tr_b16 a[188:189], v231 offset:57344
  v_mfma_f32_16x16x32_bf16 v[88:91], a[172:175], a[56:59], v[88:91]
  s_barrier
  v_mfma_f32_16x16x32_bf16 v[92:95], a[172:175], a[60:63], v[92:95]
  ds_read_b64_tr_b16 a[190:191], v231 offset:58368
  v_mfma_f32_16x16x32_bf16 v[92:95], a[168:171], a[44:47], v[92:95]
  s_waitcnt lgkmcnt(4)
  v_mfma_f32_16x16x32_bf16 v[96:99], a[176:179], a[32:35], v[96:99]
  ds_read_b64_tr_b16 a[160:161], v144 offset:32768
  v_mfma_f32_16x16x32_bf16 v[96:99], a[180:183], a[48:51], v[96:99]
  buffer_load_dwordx4 a[24:27], v243, s[24:27], s30 offen offset:2048 sc1
  v_mfma_f32_16x16x32_bf16 v[100:103], a[180:183], a[52:55], v[100:103]
  ds_read_b64_tr_b16 a[162:163], v144 offset:33792
  v_mfma_f32_16x16x32_bf16 v[100:103], a[176:179], a[36:39], v[100:103]
  v_mfma_f32_16x16x32_bf16 v[104:107], a[176:179], a[40:43], v[104:107]
  ds_read_b64_tr_b16 a[164:165], v144 offset:40960
  v_mfma_f32_16x16x32_bf16 v[104:107], a[180:183], a[56:59], v[104:107]
  buffer_load_dwordx4 v241, s[20:23], s31 offen offset:3072 lds
  s_add_u32 s31, s31, 0x80000
  v_mfma_f32_16x16x32_bf16 v[108:111], a[180:183], a[60:63], v[108:111]
  ds_read_b64_tr_b16 a[166:167], v144 offset:41984
  v_mfma_f32_16x16x32_bf16 v[108:111], a[176:179], a[44:47], v[108:111]
  s_waitcnt lgkmcnt(4)
  v_mfma_f32_16x16x32_bf16 v[112:115], a[184:187], a[32:35], v[112:115]
  ds_read_b64_tr_b16 a[168:169], v145 offset:32768
  v_mfma_f32_16x16x32_bf16 v[112:115], a[188:191], a[48:51], v[112:115]
  buffer_load_dwordx4 a[28:31], v243, s[24:27], s30 offen offset:3072 sc1
  s_add_u32 s30, s30, 8192
  v_mfma_f32_16x16x32_bf16 v[116:119], a[188:191], a[52:55], v[116:119]
  ds_read_b64_tr_b16 a[170:171], v145 offset:33792
  v_mfma_f32_16x16x32_bf16 v[116:119], a[184:187], a[36:39], v[116:119]
  v_mfma_f32_16x16x32_bf16 v[120:123], a[184:187], a[40:43], v[120:123]
  ds_read_b64_tr_b16 a[172:173], v145 offset:40960
  v_mfma_f32_16x16x32_bf16 v[120:123], a[188:191], a[56:59], v[120:123]
  v_mfma_f32_16x16x32_bf16 v[124:127], a[188:191], a[60:63], v[124:127]
  ds_read_b64_tr_b16 a[174:175], v145 offset:41984
  v_mfma_f32_16x16x32_bf16 v[124:127], a[184:187], a[44:47], v[124:127]
  s_waitcnt vmcnt(20) lgkmcnt(4)
  v_xor_b32 v136, s55, v136
  v_xor_b32 v137, s55, v137
  v_xor_b32 v138, s55, v138
  v_xor_b32 v139, s55, v139
  v_or3_b32 v136, v136, v137, v138
  v_or_b32 v136, v136, v139
  v_cmp_ne_u32 vcc, 0, v136
  s_nop 0
  s_cbranch_vccz front_keys
  s_mov_b32 s54, 32768
front_all:
  s_sleep 2
  buffer_load_dwordx4 v[136:139], v140, s[24:27], s58 offen sc1
  s_waitcnt vmcnt(0)
  v_xor_b32 v136, s55, v136
  v_xor_b32 v137, s55, v137
  v_xor_b32 v138, s55, v138
  v_xor_b32 v139, s55, v139
  v_or3_b32 v136, v136, v137, v138
  v_or_b32 v136, v136, v139
  v_cmp_ne_u32 vcc, 0, v136
  s_nop 0
  s_cbranch_vccz front_keys
  s_sub_u32 s54, s54, 1
  s_cmp_lg_u32 s54, 0
  s_cbranch_scc1 front_all
front_keys:
  s_lshl_b32 s35, s3, 11
  s_add_u32 s35, s35, 2621440
  buffer_load_dwordx4 v[128:131], v242, s[24:27], s35 offen sc1
  buffer_load_dwordx4 v[132:135], v242, s[24:27], s35 offen offset:1024 sc1
  v_mfma_f32_16x16x32_bf16 v[0:3], a[160:163], a[64:67], v[0:3]
  ds_read_b64_tr_b16 a[176:177], v146 offset:32768
  s_add_u32 s59, s59, 1
  s_or_b32 s54, s2, s3
  s_min_u32 s54, s54, 1
  v_mfma_f32_16x16x32_bf16 v[0:3], a[164:167], a[80:83], v[0:3]
  buffer_load_dwordx4 a[32:35], v242, s[24:27], s30 offen offset:0 sc1
  s_lshl_b32 s54, s54, 28
  v_mfma_f32_16x16x32_bf16 v[4:7], a[164:167], a[84:87], v[4:7]
  ds_read_b64_tr_b16 a[178:179], v146 offset:33792
  v_lshlrev_b32 v137, 22, v242
  v_mfma_f32_16x16x32_bf16 v[4:7], a[160:163], a[68:71], v[4:7]
  v_or_b32 v137, s54, v137
  v_mov_b32 v136, s59
  v_mfma_f32_16x16x32_bf16 v[8:11], a[160:163], a[72:75], v[8:11]
  ds_read_b64_tr_b16 a[180:181], v146 offset:40960
  s_add_u32 m0, s28, 0
  s_mov_b32 s58, 2830336
  buffer_store_dword v136, v137, s[24:27], s58 offen sc1
  v_mfma_f32_16x16x32_bf16 v[8:11], a[164:167], a[88:91], v[8:11]
  buffer_load_dwordx4 v238, s[20:23], s31 offen offset:0 lds
  v_mfma_f32_16x16x32_bf16 v[12:15], a[164:167], a[92:95], v[12:15]
  ds_read_b64_tr_b16 a[182:183], v146 offset:41984
  v_mfma_f32_16x16x32_bf16 v[12:15], a[160:163], a[76:79], v[12:15]
  s_waitcnt lgkmcnt(4)
  v_mfma_f32_16x16x32_bf16 v[16:19], a[168:171], a[64:67], v[16:19]
  ds_read_b64_tr_b16 a[184:185], v147 offset:32768
  v_mfma_f32_16x16x32_bf16 v[16:19], a[172:175], a[80:83], v[16:19]
  buffer_load_dwordx4 a[36:39], v242, s[24:27], s30 offen offset:1024 sc1
  v_mfma_f32_16x16x32_bf16 v[20:23], a[172:175], a[84:87], v[20:23]
  ds_read_b64_tr_b16 a[186:187], v147 offset:33792
  v_mfma_f32_16x16x32_bf16 v[20:23], a[168:171], a[68:71], v[20:23]
  v_mfma_f32_16x16x32_bf16 v[24:27], a[168:171], a[72:75], v[24:27]
  ds_read_b64_tr_b16 a[188:189], v147 offset:40960
  v_mfma_f32_16x16x32_bf16 v[24:27], a[172:175], a[88:91], v[24:27]
  v_mfma_f32_16x16x32_bf16 v[28:31], a[172:175], a[92:95], v[28:31]
  ds_read_b64_tr_b16 a[190:191], v147 offset:41984
  v_mfma_f32_16x16x32_bf16 v[28:31], a[168:171], a[76:79], v[28:31]
  s_waitcnt lgkmcnt(4)
  v_mfma_f32_16x16x32_bf16 v[32:35], a[176:179], a[64:67], v[32:35]
  ds_read_b64_tr_b16 a[160:161], v148 offset:32768
  v_mfma_f32_16x16x32_bf16 v[32:35], a[180:183], a[80:83], v[32:35]
  buffer_load_dwordx4 a[40:43], v242, s[24:27], s30 offen offset:2048 sc1
  v_mfma_f32_16x16x32_bf16 v[36:39], a[180:183], a[84:87], v[36:39]
  ds_read_b64_tr_b16 a[162:163], v148 offset:33792
  v_mfma_f32_16x16x32_bf16 v[36:39], a[176:179], a[68:71], v[36:39]
  v_mfma_f32_16x16x32_bf16 v[40:43], a[176:179], a[72:75], v[40:43]
  ds_read_b64_tr_b16 a[164:165], v148 offset:40960
  v_mfma_f32_16x16x32_bf16 v[40:43], a[180:183], a[88:91], v[40:43]
  buffer_load_dwordx4 v239, s[20:23], s31 offen offset:1024 lds
  v_mfma_f32_16x16x32_bf16 v[44:47], a[180:183], a[92:95], v[44:47]
  ds_read_b64_tr_b16 a[166:167], v148 offset:41984
  v_mfma_f32_16x16x32_bf16 v[44:47], a[176:179], a[76:79], v[44:47]
  s_waitcnt lgkmcnt(4)
  v_mfma_f32_16x16x32_bf16 v[48:51], a[184:187], a[64:67], v[48:51]
  ds_read_b64_tr_b16 a[168:169], v149 offset:32768
  v_mfma_f32_16x16x32_bf16 v[48:51], a[188:191], a[80:83], v[48:51]
  buffer_load_dwordx4 a[44:47], v242, s[24:27], s30 offen offset:3072 sc1
  v_mfma_f32_16x16x32_bf16 v[52:55], a[188:191], a[84:87], v[52:55]
  ds_read_b64_tr_b16 a[170:171], v149 offset:33792
  v_mfma_f32_16x16x32_bf16 v[52:55], a[184:187], a[68:71], v[52:55]
  v_mfma_f32_16x16x32_bf16 v[56:59], a[184:187], a[72:75], v[56:59]
  ds_read_b64_tr_b16 a[172:173], v149 offset:40960
  v_mfma_f32_16x16x32_bf16 v[56:59], a[188:191], a[88:91], v[56:59]
  v_mfma_f32_16x16x32_bf16 v[60:63], a[188:191], a[92:95], v[60:63]
  ds_read_b64_tr_b16 a[174:175], v149 offset:41984
  v_mfma_f32_16x16x32_bf16 v[60:63], a[184:187], a[76:79], v[60:63]
  s_waitcnt lgkmcnt(4)
  v_mfma_f32_16x16x32_bf16 v[64:67], a[160:163], a[64:67], v[64:67]
  ds_read_b64_tr_b16 a[176:177], v150 offset:32768
  v_mfma_f32_16x16x32_bf16 v[64:67], a[164:167], a[80:83], v[64:67]
  buffer_load_dwordx4 a[48:51], v243, s[24:27], s30 offen offset:0 sc1
  v_mfma_f32_16x16x32_bf16 v[68:71], a[164:167], a[84:87], v[68:71]
  ds_read_b64_tr_b16 a[178:179], v150 offset:33792
  v_mfma_f32_16x16x32_bf16 v[68:71], a[160:163], a[68:71], v[68:71]
  v_mfma_f32_16x16x32_bf16 v[72:75], a[160:163], a[72:75], v[72:75]
  ds_read_b64_tr_b16 a[180:181], v150 offset:40960
  v_mfma_f32_16x16x32_bf16 v[72:75], a[164:167], a[88:91], v[72:75]
  buffer_load_dwordx4 v240, s[20:23], s31 offen offset:2048 lds
  v_mfma_f32_16x16x32_bf16 v[76:79], a[164:167], a[92:95], v[76:79]
  ds_read_b64_tr_b16 a[182:183], v150 offset:41984
  v_mfma_f32_16x16x32_bf16 v[76:79], a[160:163], a[76:79], v[76:79]
  s_waitcnt lgkmcnt(4)
  v_mfma_f32_16x16x32_bf16 v[80:83], a[168:171], a[64:67], v[80:83]
  ds_read_b64_tr_b16 a[184:185], v151 offset:32768
  v_mfma_f32_16x16x32_bf16 v[80:83], a[172:175], a[80:83], v[80:83]
  buffer_load_dwordx4 a[52:55], v243, s[24:27], s30 offen offset:1024 sc1
  v_mfma_f32_16x16x32_bf16 v[84:87], a[172:175], a[84:87], v[84:87]
  ds_read_b64_tr_b16 a[186:187], v151 offset:33792
  v_mfma_f32_16x16x32_bf16 v[84:87], a[168:171], a[68:71], v[84:87]
  v_mfma_f32_16x16x32_bf16 v[88:91], a[168:171], a[72:75], v[88:91]
  ds_read_b64_tr_b16 a[188:189], v151 offset:40960
  v_mfma_f32_16x16x32_bf16 v[88:91], a[172:175], a[88:91], v[88:91]
  s_barrier
  v_mfma_f32_16x16x32_bf16 v[92:95], a[172:175], a[92:95], v[92:95]
  ds_read_b64_tr_b16 a[190:191], v151 offset:41984
  v_mfma_f32_16x16x32_bf16 v[92:95], a[168:171], a[76:79], v[92:95]
  s_waitcnt lgkmcnt(4)
  v_mfma_f32_16x16x32_bf16 v[96:99], a[176:179], a[64:67], v[96:99]
  ds_read_b64_tr_b16 a[160:161], v144 offset:49152
  v_mfma_f32_16x16x32_bf16 v[96:99], a[180:183], a[80:83], v[96:99]
  buffer_load_dwordx4 a[56:59], v243, s[24:27], s30 offen offset:2048 sc1
  v_mfma_f32_16x16x32_bf16 v[100:103], a[180:183], a[84:87], v[100:103]
  ds_read_b64_tr_b16 a[162:163], v144 offset:50176
  v_mfma_f32_16x16x32_bf16 v[100:103], a[176:179], a[68:71], v[100:103]
  v_mfma_f32_16x16x32_bf16 v[104:107], a[176:179], a[72:75], v[104:107]
  ds_read_b64_tr_b16 a[164:165], v144 offset:57344
  v_mfma_f32_16x16x32_bf16 v[104:107], a[180:183], a[88:91], v[104:107]
  buffer_load_dwordx4 v241, s[20:23], s31 offen offset:3072 lds
  s_add_u32 s31, s31, 0x80000
  v_mfma_f32_16x16x32_bf16 v[108:111], a[180:183], a[92:95], v[108:111]
  ds_read_b64_tr_b16 a[166:167], v144 offset:58368
  v_mfma_f32_16x16x32_bf16 v[108:111], a[176:179], a[76:79], v[108:111]
  s_waitcnt lgkmcnt(4)
  v_mfma_f32_16x16x32_bf16 v[112:115], a[184:187], a[64:67], v[112:115]
  ds_read_b64_tr_b16 a[168:169], v145 offset:49152
  v_mfma_f32_16x16x32_bf16 v[112:115], a[188:191], a[80:83], v[112:115]
  buffer_load_dwordx4 a[60:63], v243, s[24:27], s30 offen offset:3072 sc1
  s_add_u32 s30, s30, 8192
  v_mfma_f32_16x16x32_bf16 v[116:119], a[188:191], a[84:87], v[116:119]
  ds_read_b64_tr_b16 a[170:171], v145 offset:50176
  v_mfma_f32_16x16x32_bf16 v[116:119], a[184:187], a[68:71], v[116:119]
  v_mfma_f32_16x16x32_bf16 v[120:123], a[184:187], a[72:75], v[120:123]
  ds_read_b64_tr_b16 a[172:173], v145 offset:57344
  v_mfma_f32_16x16x32_bf16 v[120:123], a[188:191], a[88:91], v[120:123]
  v_mfma_f32_16x16x32_bf16 v[124:127], a[188:191], a[92:95], v[124:127]
  ds_read_b64_tr_b16 a[174:175], v145 offset:58368
  v_mfma_f32_16x16x32_bf16 v[124:127], a[184:187], a[76:79], v[124:127]
  s_waitcnt vmcnt(27) lgkmcnt(4)
  v_mfma_f32_16x16x32_bf16 v[0:3], a[160:163], a[96:99], v[0:3]
  ds_read_b64_tr_b16 a[176:177], v146 offset:49152
  v_mfma_f32_16x16x32_bf16 v[0:3], a[164:167], a[112:115], v[0:3]
  buffer_load_dwordx4 a[64:67], v242, s[24:27], s30 offen offset:0 sc1
  v_mfma_f32_16x16x32_bf16 v[4:7], a[164:167], a[116:119], v[4:7]
  ds_read_b64_tr_b16 a[178:179], v146 offset:50176
  v_mfma_f32_16x16x32_bf16 v[4:7], a[160:163], a[100:103], v[4:7]
  v_mfma_f32_16x16x32_bf16 v[8:11], a[160:163], a[104:107], v[8:11]
  ds_read_b64_tr_b16 a[180:181], v146 offset:57344
  s_add_u32 m0, s28, 65536
  v_mfma_f32_16x16x32_bf16 v[8:11], a[164:167], a[120:123], v[8:11]
  buffer_load_dwordx4 v238, s[20:23], s31 offen offset:0 lds
  v_mfma_f32_16x16x32_bf16 v[12:15], a[164:167], a[124:127], v[12:15]
  ds_read_b64_tr_b16 a[182:183], v146 offset:58368
  v_mfma_f32_16x16x32_bf16 v[12:15], a[160:163], a[108:111], v[12:15]
  s_waitcnt lgkmcnt(4)
  v_mfma_f32_16x16x32_bf16 v[16:19], a[168:171], a[96:99], v[16:19]
  ds_read_b64_tr_b16 a[184:185], v147 offset:49152
  v_mfma_f32_16x16x32_bf16 v[16:19], a[172:175], a[112:115], v[16:19]
  buffer_load_dwordx4 a[68:71], v242, s[24:27], s30 offen offset:1024 sc1
  v_mfma_f32_16x16x32_bf16 v[20:23], a[172:175], a[116:119], v[20:23]
  ds_read_b64_tr_b16 a[186:187], v147 offset:50176
  v_mfma_f32_16x16x32_bf16 v[20:23], a[168:171], a[100:103], v[20:23]
  v_mfma_f32_16x16x32_bf16 v[24:27], a[168:171], a[104:107], v[24:27]
  ds_read_b64_tr_b16 a[188:189], v147 offset:57344
  v_mfma_f32_16x16x32_bf16 v[24:27], a[172:175], a[120:123], v[24:27]
  v_mfma_f32_16x16x32_bf16 v[28:31], a[172:175], a[124:127], v[28:31]
  ds_read_b64_tr_b16 a[190:191], v147 offset:58368
  v_mfma_f32_16x16x32_bf16 v[28:31], a[168:171], a[108:111], v[28:31]
  s_waitcnt lgkmcnt(4)
  v_mfma_f32_16x16x32_bf16 v[32:35], a[176:179], a[96:99], v[32:35]
  ds_read_b64_tr_b16 a[160:161], v148 offset:49152
  v_mfma_f32_16x16x32_bf16 v[32:35], a[180:183], a[112:115], v[32:35]
  buffer_load_dwordx4 a[72:75], v242, s[24:27], s30 offen offset:2048 sc1
  v_mfma_f32_16x16x32_bf16 v[36:39], a[180:183], a[116:119], v[36:39]
  ds_read_b64_tr_b16 a[162:163], v148 offset:50176
  v_mfma_f32_16x16x32_bf16 v[36:39], a[176:179], a[100:103], v[36:39]
  v_mfma_f32_16x16x32_bf16 v[40:43], a[176:179], a[104:107], v[40:43]
  ds_read_b64_tr_b16 a[164:165], v148 offset:57344
  v_mfma_f32_16x16x32_bf16 v[40:43], a[180:183], a[120:123], v[40:43]
  buffer_load_dwordx4 v239, s[20:23], s31 offen offset:1024 lds
  v_mfma_f32_16x16x32_bf16 v[44:47], a[180:183], a[124:127], v[44:47]
  ds_read_b64_tr_b16 a[166:167], v148 offset:58368
  v_mfma_f32_16x16x32_bf16 v[44:47], a[176:179], a[108:111], v[44:47]
  s_waitcnt lgkmcnt(4)
  v_mfma_f32_16x16x32_bf16 v[48:51], a[184:187], a[96:99], v[48:51]
  ds_read_b64_tr_b16 a[168:169], v149 offset:49152
  v_mfma_f32_16x16x32_bf16 v[48:51], a[188:191], a[112:115], v[48:51]
  buffer_load_dwordx4 a[76:79], v242, s[24:27], s30 offen offset:3072 sc1
  v_mfma_f32_16x16x32_bf16 v[52:55], a[188:191], a[116:119], v[52:55]
  ds_read_b64_tr_b16 a[170:171], v149 offset:50176
  v_mfma_f32_16x16x32_bf16 v[52:55], a[184:187], a[100:103], v[52:55]
  v_mfma_f32_16x16x32_bf16 v[56:59], a[184:187], a[104:107], v[56:59]
  ds_read_b64_tr_b16 a[172:173], v149 offset:57344
  v_mfma_f32_16x16x32_bf16 v[56:59], a[188:191], a[120:123], v[56:59]
  v_mfma_f32_16x16x32_bf16 v[60:63], a[188:191], a[124:127], v[60:63]
  ds_read_b64_tr_b16 a[174:175], v149 offset:58368
  v_mfma_f32_16x16x32_bf16 v[60:63], a[184:187], a[108:111], v[60:63]
  s_waitcnt lgkmcnt(4)
  v_mfma_f32_16x16x32_bf16 v[64:67], a[160:163], a[96:99], v[64:67]
  ds_read_b64_tr_b16 a[176:177], v150 offset:49152
  v_mfma_f32_16x16x32_bf16 v[64:67], a[164:167], a[112:115], v[64:67]
  buffer_load_dwordx4 a[80:83], v243, s[24:27], s30 offen offset:0 sc1
  v_mfma_f32_16x16x32_bf16 v[68:71], a[164:167], a[116:119], v[68:71]
  ds_read_b64_tr_b16 a[178:179], v150 offset:50176
  v_mfma_f32_16x16x32_bf16 v[68:71], a[160:163], a[100:103], v[68:71]
  v_mfma_f32_16x16x32_bf16 v[72:75], a[160:163], a[104:107], v[72:75]
  ds_read_b64_tr_b16 a[180:181], v150 offset:57344
  v_mfma_f32_16x16x32_bf16 v[72:75], a[164:167], a[120:123], v[72:75]
  buffer_load_dwordx4 v240, s[20:23], s31 offen offset:2048 lds
  v_mfma_f32_16x16x32_bf16 v[76:79], a[164:167], a[124:127], v[76:79]
  ds_read_b64_tr_b16 a[182:183], v150 offset:58368
  v_mfma_f32_16x16x32_bf16 v[76:79], a[160:163], a[108:111], v[76:79]
  s_waitcnt lgkmcnt(4)
  v_mfma_f32_16x16x32_bf16 v[80:83], a[168:171], a[96:99], v[80:83]
  ds_read_b64_tr_b16 a[184:185], v151 offset:49152
  v_mfma_f32_16x16x32_bf16 v[80:83], a[172:175], a[112:115], v[80:83]
  buffer_load_dwordx4 a[84:87], v243, s[24:27], s30 offen offset:1024 sc1
  v_mfma_f32_16x16x32_bf16 v[84:87], a[172:175], a[116:119], v[84:87]
  ds_read_b64_tr_b16 a[186:187], v151 offset:50176
  v_mfma_f32_16x16x32_bf16 v[84:87], a[168:171], a[100:103], v[84:87]
  s_waitcnt vmcnt(25)
  v_mfma_f32_16x16x32_bf16 v[88:91], a[168:171], a[104:107], v[88:91]
  ds_read_b64_tr_b16 a[188:189], v151 offset:57344
  v_mfma_f32_16x16x32_bf16 v[88:91], a[172:175], a[120:123], v[88:91]
  s_barrier
  v_mfma_f32_16x16x32_bf16 v[92:95], a[172:175], a[124:127], v[92:95]
  ds_read_b64_tr_b16 a[190:191], v151 offset:58368
  v_mfma_f32_16x16x32_bf16 v[92:95], a[168:171], a[108:111], v[92:95]
  s_waitcnt lgkmcnt(4)
  v_mfma_f32_16x16x32_bf16 v[96:99], a[176:179], a[96:99], v[96:99]
  ds_read_b64_tr_b16 a[160:161], v144 offset:16384
  v_mfma_f32_16x16x32_bf16 v[96:99], a[180:183], a[112:115], v[96:99]
  buffer_load_dwordx4 a[88:91], v243, s[24:27], s30 offen offset:2048 sc1
  v_mfma_f32_16x16x32_bf16 v[100:103], a[180:183], a[116:119], v[100:103]
  ds_read_b64_tr_b16 a[162:163], v144 offset:17408
  v_mfma_f32_16x16x32_bf16 v[100:103], a[176:179], a[100:103], v[100:103]
  v_mfma_f32_16x16x32_bf16 v[104:107], a[176:179], a[104:107], v[104:107]
  ds_read_b64_tr_b16 a[164:165], v144 offset:24576
  v_mfma_f32_16x16x32_bf16 v[104:107], a[180:183], a[120:123], v[104:107]
  buffer_load_dwordx4 v241, s[20:23], s31 offen offset:3072 lds
  s_add_u32 s31, s31, 0x80000
  v_mfma_f32_16x16x32_bf16 v[108:111], a[180:183], a[124:127], v[108:111]
  ds_read_b64_tr_b16 a[166:167], v144 offset:25600
  v_mfma_f32_16x16x32_bf16 v[108:111], a[176:179], a[108:111], v[108:111]
  s_waitcnt lgkmcnt(4)
  v_mfma_f32_16x16x32_bf16 v[112:115], a[184:187], a[96:99], v[112:115]
  ds_read_b64_tr_b16 a[168:169], v145 offset:16384
  v_mfma_f32_16x16x32_bf16 v[112:115], a[188:191], a[112:115], v[112:115]
  buffer_load_dwordx4 a[92:95], v243, s[24:27], s30 offen offset:3072 sc1
  s_add_u32 s30, s30, 8192
  v_mfma_f32_16x16x32_bf16 v[116:119], a[188:191], a[116:119], v[116:119]
  ds_read_b64_tr_b16 a[170:171], v145 offset:17408
  v_mfma_f32_16x16x32_bf16 v[116:119], a[184:187], a[100:103], v[116:119]
  v_mfma_f32_16x16x32_bf16 v[120:123], a[184:187], a[104:107], v[120:123]
  ds_read_b64_tr_b16 a[172:173], v145 offset:24576
  v_mfma_f32_16x16x32_bf16 v[120:123], a[188:191], a[120:123], v[120:123]
  v_mfma_f32_16x16x32_bf16 v[124:127], a[188:191], a[124:127], v[124:127]
  ds_read_b64_tr_b16 a[174:175], v145 offset:25600
  v_mfma_f32_16x16x32_bf16 v[124:127], a[184:187], a[108:111], v[124:127]
  s_waitcnt vmcnt(27) lgkmcnt(4)
  v_mfma_f32_16x16x32_bf16 v[0:3], a[160:163], a[0:3], v[0:3]
  ds_read_b64_tr_b16 a[176:177], v146 offset:16384
  s_waitcnt vmcnt(25)
  s_mov_b32 s51, -1
  v_sub_u32 v137, s51, v128
  v_mfma_f32_16x16x32_bf16 v[0:3], a[164:167], a[16:19], v[0:3]
  buffer_load_dwordx4 a[96:99], v242, s[24:27], s30 offen offset:0 sc1
  v_mfma_f32_16x16x32_bf16 v[4:7], a[164:167], a[20:23], v[4:7]
  ds_read_b64_tr_b16 a[178:179], v146 offset:17408
  v_sub_u32 v138, s51, v129
  v_mfma_f32_16x16x32_bf16 v[4:7], a[160:163], a[4:7], v[4:7]
  v_min_u32 v136, v137, v138
  v_sub_u32 v139, s51, v130
  v_mfma_f32_16x16x32_bf16 v[8:11], a[160:163], a[8:11], v[8:11]
  ds_read_b64_tr_b16 a[180:181], v146 offset:24576
  s_add_u32 m0, s28, 81920
  v_sub_u32 v140, s51, v131
  v_mfma_f32_16x16x32_bf16 v[8:11], a[164:167], a[24:27], v[8:11]
  buffer_load_dwordx4 v238, s[20:23], s31 offen offset:0 lds
  v_mfma_f32_16x16x32_bf16 v[12:15], a[164:167], a[28:31], v[12:15]
  ds_read_b64_tr_b16 a[182:183], v146 offset:25600
  v_min3_u32 v136, v136, v139, v140
  v_mfma_f32_16x16x32_bf16 v[12:15], a[160:163], a[12:15], v[12:15]
  s_waitcnt lgkmcnt(4)
  v_sub_u32 v137, s51, v132
  v_sub_u32 v138, s51, v133
  v_mfma_f32_16x16x32_bf16 v[16:19], a[168:171], a[0:3], v[16:19]
  ds_read_b64_tr_b16 a[184:185], v147 offset:16384
  v_min3_u32 v136, v136, v137, v138
  v_mfma_f32_16x16x32_bf16 v[16:19], a[172:175], a[16:19], v[16:19]
  buffer_load_dwordx4 a[100:103], v242, s[24:27], s30 offen offset:1024 sc1
  v_mfma_f32_16x16x32_bf16 v[20:23], a[172:175], a[20:23], v[20:23]
  ds_read_b64_tr_b16 a[186:187], v147 offset:17408
  v_sub_u32 v139, s51, v134
  v_mfma_f32_16x16x32_bf16 v[20:23], a[168:171], a[4:7], v[20:23]
  v_sub_u32 v140, s51, v135
  v_min3_u32 v136, v136, v139, v140
  v_mfma_f32_16x16x32_bf16 v[24:27], a[168:171], a[8:11], v[24:27]
  ds_read_b64_tr_b16 a[188:189], v147 offset:24576
  v_min_u32_dpp v136, v136, v136 row_ror:8 row_mask:0xf bank_mask:0xf
  v_mfma_f32_16x16x32_bf16 v[24:27], a[172:175], a[24:27], v[24:27]
  v_mfma_f32_16x16x32_bf16 v[28:31], a[172:175], a[28:31], v[28:31]
  ds_read_b64_tr_b16 a[190:191], v147 offset:25600
  v_min_u32_dpp v136, v136, v136 row_ror:4 row_mask:0xf bank_mask:0xf
  v_mfma_f32_16x16x32_bf16 v[28:31], a[168:171], a[12:15], v[28:31]
  s_waitcnt lgkmcnt(4)
  v_min_u32_dpp v136, v136, v136 row_ror:2 row_mask:0xf bank_mask:0xf
  v_mfma_f32_16x16x32_bf16 v[32:35], a[176:179], a[0:3], v[32:35]
  ds_read_b64_tr_b16 a[160:161], v148 offset:16384
  v_min_u32_dpp v136, v136, v136 row_ror:1 row_mask:0xf bank_mask:0xf
  v_mfma_f32_16x16x32_bf16 v[32:35], a[180:183], a[16:19], v[32:35]
  buffer_load_dwordx4 a[104:107], v242, s[24:27], s30 offen offset:2048 sc1
  v_mfma_f32_16x16x32_bf16 v[36:39], a[180:183], a[20:23], v[36:39]
  ds_read_b64_tr_b16 a[162:163], v148 offset:17408
  v_readlane_b32 s98, v136, 0
  v_mfma_f32_16x16x32_bf16 v[36:39], a[176:179], a[4:7], v[36:39]
  v_readlane_b32 s99, v136, 16
  v_readlane_b32 s100, v136, 32
  v_mfma_f32_16x16x32_bf16 v[40:43], a[176:179], a[8:11], v[40:43]
  ds_read_b64_tr_b16 a[164:165], v148 offset:24576
  v_readlane_b32 s101, v136, 48
  v_mfma_f32_16x16x32_bf16 v[40:43], a[180:183], a[24:27], v[40:43]
  buffer_load_dwordx4 v239, s[20:23], s31 offen offset:1024 lds
  s_min_u32 s98, s98, s99
  s_min_u32 s100, s100, s101
  s_min_u32 s98, s98, s100
  v_mfma_f32_16x16x32_bf16 v[44:47], a[180:183], a[28:31], v[44:47]
  ds_read_b64_tr_b16 a[166:167], v148 offset:25600
  s_sub_u32 s52, s51, s98
  s_sub_u32 s51, s52, 1
  v_sub_u32 v137, s51, v128
  v_mfma_f32_16x16x32_bf16 v[44:47], a[176:179], a[12:15], v[44:47]
  s_waitcnt lgkmcnt(4)
  v_sub_u32 v138, s51, v129
  v_min_u32 v136, v137, v138
  v_mfma_f32_16x16x32_bf16 v[48:51], a[184:187], a[0:3], v[48:51]
  ds_read_b64_tr_b16 a[168:169], v149 offset:16384
  v_sub_u32 v139, s51, v130
  v_mfma_f32_16x16x32_bf16 v[48:51], a[188:191], a[16:19], v[48:51]
  buffer_load_dwordx4 a[108:111], v242, s[24:27], s30 offen offset:3072 sc1
  v_mfma_f32_16x16x32_bf16 v[52:55], a[188:191], a[20:23], v[52:55]
  ds_read_b64_tr_b16 a[170:171], v149 offset:17408
  v_sub_u32 v140, s51, v131
  v_mfma_f32_16x16x32_bf16 v[52:55], a[184:187], a[4:7], v[52:55]
  v_min3_u32 v136, v136, v139, v140
  v_sub_u32 v137, s51, v132
  v_mfma_f32_16x16x32_bf16 v[56:59], a[184:187], a[8:11], v[56:59]
  ds_read_b64_tr_b16 a[172:173], v149 offset:24576
  v_sub_u32 v138, s51, v133
  v_mfma_f32_16x16x32_bf16 v[56:59], a[188:191], a[24:27], v[56:59]
  v_min3_u32 v136, v136, v137, v138
  v_sub_u32 v139, s51, v134
  v_mfma_f32_16x16x32_bf16 v[60:63], a[188:191], a[28:31], v[60:63]
  ds_read_b64_tr_b16 a[174:175], v149 offset:25600
  v_sub_u32 v140, s51, v135
  v_mfma_f32_16x16x32_bf16 v[60:63], a[184:187], a[12:15], v[60:63]
  s_waitcnt lgkmcnt(4)
  v_min3_u32 v136, v136, v139, v140
  v_mfma_f32_16x16x32_bf16 v[64:67], a[160:163], a[0:3], v[64:67]
  ds_read_b64_tr_b16 a[176:177], v150 offset:16384
  v_min_u32_dpp v136, v136, v136 row_ror:8 row_mask:0xf bank_mask:0xf
  v_mfma_f32_16x16x32_bf16 v[64:67], a[164:167], a[16:19], v[64:67]
  buffer_load_dwordx4 a[112:115], v243, s[24:27], s30 offen offset:0 sc1
  v_mfma_f32_16x16x32_bf16 v[68:71], a[164:167], a[20:23], v[68:71]
  ds_read_b64_tr_b16 a[178:179], v150 offset:17408
  v_min_u32_dpp v136, v136, v136 row_ror:4 row_mask:0xf bank_mask:0xf
  v_mfma_f32_16x16x32_bf16 v[68:71], a[160:163], a[4:7], v[68:71]
  v_mfma_f32_16x16x32_bf16 v[72:75], a[160:163], a[8:11], v[72:75]
  ds_read_b64_tr_b16 a[180:181], v150 offset:24576
  v_min_u32_dpp v136, v136, v136 row_ror:2 row_mask:0xf bank_mask:0xf
  v_mfma_f32_16x16x32_bf16 v[72:75], a[164:167], a[24:27], v[72:75]
  buffer_load_dwordx4 v240, s[20:23], s31 offen offset:2048 lds
  v_mfma_f32_16x16x32_bf16 v[76:79], a[164:167], a[28:31], v[76:79]
  ds_read_b64_tr_b16 a[182:183], v150 offset:25600
  v_min_u32_dpp v136, v136, v136 row_ror:1 row_mask:0xf bank_mask:0xf
  v_mfma_f32_16x16x32_bf16 v[76:79], a[160:163], a[12:15], v[76:79]
  s_waitcnt lgkmcnt(4)
  v_readlane_b32 s98, v136, 0
  v_readlane_b32 s99, v136, 16
  v_mfma_f32_16x16x32_bf16 v[80:83], a[168:171], a[0:3], v[80:83]
  ds_read_b64_tr_b16 a[184:185], v151 offset:16384
  v_readlane_b32 s100, v136, 32
  v_mfma_f32_16x16x32_bf16 v[80:83], a[172:175], a[16:19], v[80:83]
  buffer_load_dwordx4 a[116:119], v243, s[24:27], s30 offen offset:1024 sc1
  v_mfma_f32_16x16x32_bf16 v[84:87], a[172:175], a[20:23], v[84:87]
  ds_read_b64_tr_b16 a[186:187], v151 offset:17408
  v_readlane_b32 s101, v136, 48
  v_mfma_f32_16x16x32_bf16 v[84:87], a[168:171], a[4:7], v[84:87]
  s_waitcnt vmcnt(22)
  s_min_u32 s98, s98, s99
  s_min_u32 s100, s100, s101
  v_mfma_f32_16x16x32_bf16 v[88:91], a[168:171], a[8:11], v[88:91]
  ds_read_b64_tr_b16 a[188:189], v151 offset:24576
  s_min_u32 s98, s98, s100
  s_sub_u32 s53, s51, s98
  s_sub_u32 s51, s53, 1
  v_sub_u32 v137, s51, v128
  v_mfma_f32_16x16x32_bf16 v[88:91], a[172:175], a[24:27], v[88:91]
  s_barrier
  v_sub_u32 v138, s51, v129
  v_min_u32 v136, v137, v138
  v_mfma_f32_16x16x32_bf16 v[92:95], a[172:175], a[28:31], v[92:95]
  ds_read_b64_tr_b16 a[190:191], v151 offset:25600
  v_sub_u32 v139, s51, v130
  v_mfma_f32_16x16x32_bf16 v[92:95], a[168:171], a[12:15], v[92:95]
  s_waitcnt lgkmcnt(4)
  v_sub_u32 v140, s51, v131
  v_min3_u32 v136, v136, v139, v140
  v_mfma_f32_16x16x32_bf16 v[96:99], a[176:179], a[0:3], v[96:99]
  ds_read_b64_tr_b16 a[160:161], v144 offset:0
  v_sub_u32 v137, s51, v132
  v_mfma_f32_16x16x32_bf16 v[96:99], a[180:183], a[16:19], v[96:99]
  buffer_load_dwordx4 a[120:123], v243, s[24:27], s30 offen offset:2048 sc1
  v_mfma_f32_16x16x32_bf16 v[100:103], a[180:183], a[20:23], v[100:103]
  ds_read_b64_tr_b16 a[162:163], v144 offset:1024
  v_sub_u32 v138, s51, v133
  v_mfma_f32_16x16x32_bf16 v[100:103], a[176:179], a[4:7], v[100:103]
  v_min3_u32 v136, v136, v137, v138
  v_sub_u32 v139, s51, v134
  v_mfma_f32_16x16x32_bf16 v[104:107], a[176:179], a[8:11], v[104:107]
  ds_read_b64_tr_b16 a[164:165], v144 offset:8192
  v_sub_u32 v140, s51, v135
  v_mfma_f32_16x16x32_bf16 v[104:107], a[180:183], a[24:27], v[104:107]
  buffer_load_dwordx4 v241, s[20:23], s31 offen offset:3072 lds
  s_add_u32 s31, s31, 0x80000
  v_mfma_f32_16x16x32_bf16 v[108:111], a[180:183], a[28:31], v[108:111]
  ds_read_b64_tr_b16 a[166:167], v144 offset:9216
  v_min3_u32 v136, v136, v139, v140
  v_mfma_f32_16x16x32_bf16 v[108:111], a[176:179], a[12:15], v[108:111]
  s_waitcnt lgkmcnt(4)
  v_min_u32_dpp v136, v136, v136 row_ror:8 row_mask:0xf bank_mask:0xf
  v_mfma_f32_16x16x32_bf16 v[112:115], a[184:187], a[0:3], v[112:115]
  ds_read_b64_tr_b16 a[168:169], v145 offset:0
  v_min_u32_dpp v136, v136, v136 row_ror:4 row_mask:0xf bank_mask:0xf
  v_mfma_f32_16x16x32_bf16 v[112:115], a[188:191], a[16:19], v[112:115]
  buffer_load_dwordx4 a[124:127], v243, s[24:27], s30 offen offset:3072 sc1
  s_add_u32 s30, s30, 8192
  v_mfma_f32_16x16x32_bf16 v[116:119], a[188:191], a[20:23], v[116:119]
  ds_read_b64_tr_b16 a[170:171], v145 offset:1024
  v_min_u32_dpp v136, v136, v136 row_ror:2 row_mask:0xf bank_mask:0xf
  v_mfma_f32_16x16x32_bf16 v[116:119], a[184:187], a[4:7], v[116:119]
  v_mfma_f32_16x16x32_bf16 v[120:123], a[184:187], a[8:11], v[120:123]
  ds_read_b64_tr_b16 a[172:173], v145 offset:8192
  v_min_u32_dpp v136, v136, v136 row_ror:1 row_mask:0xf bank_mask:0xf
  v_mfma_f32_16x16x32_bf16 v[120:123], a[188:191], a[24:27], v[120:123]
  v_readlane_b32 s98, v136, 0
  v_readlane_b32 s99, v136, 16
  v_mfma_f32_16x16x32_bf16 v[124:127], a[188:191], a[28:31], v[124:127]
  ds_read_b64_tr_b16 a[174:175], v145 offset:9216
  v_readlane_b32 s100, v136, 32
  v_mfma_f32_16x16x32_bf16 v[124:127], a[184:187], a[12:15], v[124:127]
  s_waitcnt vmcnt(24) lgkmcnt(4)
  v_readlane_b32 s101, v136, 48
  v_mfma_f32_16x16x32_bf16 v[0:3], a[160:163], a[32:35], v[0:3]
  ds_read_b64_tr_b16 a[176:177], v146 offset:0
  s_min_u32 s98, s98, s99
  s_min_u32 s100, s100, s101
  s_min_u32 s98, s98, s100
  v_mfma_f32_16x16x32_bf16 v[0:3], a[164:167], a[48:51], v[0:3]
  buffer_load_dwordx4 a[0:3], v242, s[24:27], s30 offen offset:0 sc1
  s_sub_u32 s54, s51, s98
  s_sub_u32 s51, s54, 1
  v_mfma_f32_16x16x32_bf16 v[4:7], a[164:167], a[52:55], v[4:7]
  ds_read_b64_tr_b16 a[178:179], v146 offset:1024
  v_sub_u32 v137, s51, v128
  v_mfma_f32_16x16x32_bf16 v[4:7], a[160:163], a[36:39], v[4:7]
  v_sub_u32 v138, s51, v129
  v_min_u32 v136, v137, v138
  v_mfma_f32_16x16x32_bf16 v[8:11], a[160:163], a[40:43], v[8:11]
  ds_read_b64_tr_b16 a[180:181], v146 offset:8192
  s_add_u32 m0, s28, 98304
  v_sub_u32 v139, s51, v130
  v_mfma_f32_16x16x32_bf16 v[8:11], a[164:167], a[56:59], v[8:11]
  buffer_load_dwordx4 v238, s[20:23], s31 offen offset:0 lds
  v_mfma_f32_16x16x32_bf16 v[12:15], a[164:167], a[60:63], v[12:15]
  ds_read_b64_tr_b16 a[182:183], v146 offset:9216
  v_sub_u32 v140, s51, v131
  v_mfma_f32_16x16x32_bf16 v[12:15], a[160:163], a[44:47], v[12:15]
  s_waitcnt lgkmcnt(4)
  v_min3_u32 v136, v136, v139, v140
  v_sub_u32 v137, s51, v132
  v_mfma_f32_16x16x32_bf16 v[16:19], a[168:171], a[32:35], v[16:19]
  ds_read_b64_tr_b16 a[184:185], v147 offset:0
  v_sub_u32 v138, s51, v133
  v_mfma_f32_16x16x32_bf16 v[16:19], a[172:175], a[48:51], v[16:19]
  buffer_load_dwordx4 a[4:7], v242, s[24:27], s30 offen offset:1024 sc1
  v_mfma_f32_16x16x32_bf16 v[20:23], a[172:175], a[52:55], v[20:23]
  ds_read_b64_tr_b16 a[186:187], v147 offset:1024
  v_min3_u32 v136, v136, v137, v138
  v_mfma_f32_16x16x32_bf16 v[20:23], a[168:171], a[36:39], v[20:23]
  v_sub_u32 v139, s51, v134
  v_sub_u32 v140, s51, v135
  v_mfma_f32_16x16x32_bf16 v[24:27], a[168:171], a[40:43], v[24:27]
  ds_read_b64_tr_b16 a[188:189], v147 offset:8192
  v_min3_u32 v136, v136, v139, v140
  v_mfma_f32_16x16x32_bf16 v[24:27], a[172:175], a[56:59], v[24:27]
  v_mfma_f32_16x16x32_bf16 v[28:31], a[172:175], a[60:63], v[28:31]
  ds_read_b64_tr_b16 a[190:191], v147 offset:9216
  v_min_u32_dpp v136, v136, v136 row_ror:8 row_mask:0xf bank_mask:0xf
  v_mfma_f32_16x16x32_bf16 v[28:31], a[168:171], a[44:47], v[28:31]
  s_waitcnt lgkmcnt(4)
  v_min_u32_dpp v136, v136, v136 row_ror:4 row_mask:0xf bank_mask:0xf
  v_mfma_f32_16x16x32_bf16 v[32:35], a[176:179], a[32:35], v[32:35]
  ds_read_b64_tr_b16 a[160:161], v148 offset:0
  v_min_u32_dpp v136, v136, v136 row_ror:2 row_mask:0xf bank_mask:0xf
  v_mfma_f32_16x16x32_bf16 v[32:35], a[180:183], a[48:51], v[32:35]
  buffer_load_dwordx4 a[8:11], v242, s[24:27], s30 offen offset:2048 sc1
  v_mfma_f32_16x16x32_bf16 v[36:39], a[180:183], a[52:55], v[36:39]
  ds_read_b64_tr_b16 a[162:163], v148 offset:1024
  v_min_u32_dpp v136, v136, v136 row_ror:1 row_mask:0xf bank_mask:0xf
  v_mfma_f32_16x16x32_bf16 v[36:39], a[176:179], a[36:39], v[36:39]
  v_readlane_b32 s98, v136, 0
  v_readlane_b32 s99, v136, 16
  v_mfma_f32_16x16x32_bf16 v[40:43], a[176:179], a[40:43], v[40:43]
  ds_read_b64_tr_b16 a[164:165], v148 offset:8192
  v_readlane_b32 s100, v136, 32
  v_mfma_f32_16x16x32_bf16 v[40:43], a[180:183], a[56:59], v[40:43]
  buffer_load_dwordx4 v239, s[20:23], s31 offen offset:1024 lds
  v_mfma_f32_16x16x32_bf16 v[44:47], a[180:183], a[60:63], v[44:47]
  ds_read_b64_tr_b16 a[166:167], v148 offset:9216
  v_readlane_b32 s101, v136, 48
  v_mfma_f32_16x16x32_bf16 v[44:47], a[176:179], a[44:47], v[44:47]
  s_waitcnt lgkmcnt(4)
  s_min_u32 s98, s98, s99
  s_min_u32 s100, s100, s101
  v_mfma_f32_16x16x32_bf16 v[48:51], a[184:187], a[32:35], v[48:51]
  ds_read_b64_tr_b16 a[168:169], v149 offset:0
  s_min_u32 s98, s98, s100
  s_sub_u32 s55, s51, s98
  s_sub_u32 s51, s55, 1
  v_sub_u32 v137, s51, v128
  v_mfma_f32_16x16x32_bf16 v[48:51], a[188:191], a[48:51], v[48:51]
  buffer_load_dwordx4 a[12:15], v242, s[24:27], s30 offen offset:3072 sc1
  v_mfma_f32_16x16x32_bf16 v[52:55], a[188:191], a[52:55], v[52:55]
  ds_read_b64_tr_b16 a[170:171], v149 offset:1024
  v_sub_u32 v138, s51, v129
  v_mfma_f32_16x16x32_bf16 v[52:55], a[184:187], a[36:39], v[52:55]
  v_min_u32 v136, v137, v138
  v_sub_u32 v139, s51, v130
  v_mfma_f32_16x16x32_bf16 v[56:59], a[184:187], a[40:43], v[56:59]
  ds_read_b64_tr_b16 a[172:173], v149 offset:8192
  v_sub_u32 v140, s51, v131
  v_mfma_f32_16x16x32_bf16 v[56:59], a[188:191], a[56:59], v[56:59]
  v_min3_u32 v136, v136, v139, v140
  v_sub_u32 v137, s51, v132
  v_mfma_f32_16x16x32_bf16 v[60:63], a[188:191], a[60:63], v[60:63]
  ds_read_b64_tr_b16 a[174:175], v149 offset:9216
  v_sub_u32 v138, s51, v133
  v_mfma_f32_16x16x32_bf16 v[60:63], a[184:187], a[44:47], v[60:63]
  s_waitcnt lgkmcnt(4)
  v_min3_u32 v136, v136, v137, v138
  v_sub_u32 v139, s51, v134
  v_mfma_f32_16x16x32_bf16 v[64:67], a[160:163], a[32:35], v[64:67]
  ds_read_b64_tr_b16 a[176:177], v150 offset:0
  v_sub_u32 v140, s51, v135
  v_mfma_f32_16x16x32_bf16 v[64:67], a[164:167], a[48:51], v[64:67]
  buffer_load_dwordx4 a[16:19], v243, s[24:27], s30 offen offset:0 sc1
  v_mfma_f32_16x16x32_bf16 v[68:71], a[164:167], a[52:55], v[68:71]
  ds_read_b64_tr_b16 a[178:179], v150 offset:1024
  v_min3_u32 v136, v136, v139, v140
  v_mfma_f32_16x16x32_bf16 v[68:71], a[160:163], a[36:39], v[68:71]
  v_mfma_f32_16x16x32_bf16 v[72:75], a[160:163], a[40:43], v[72:75]
  ds_read_b64_tr_b16 a[180:181], v150 offset:8192
  v_min_u32_dpp v136, v136, v136 row_ror:8 row_mask:0xf bank_mask:0xf
  v_mfma_f32_16x16x32_bf16 v[72:75], a[164:167], a[56:59], v[72:75]
  buffer_load_dwordx4 v240, s[20:23], s31 offen offset:2048 lds
  v_mfma_f32_16x16x32_bf16 v[76:79], a[164:167], a[60:63], v[76:79]
  ds_read_b64_tr_b16 a[182:183], v150 offset:9216
  v_min_u32_dpp v136, v136, v136 row_ror:4 row_mask:0xf bank_mask:0xf
  v_mfma_f32_16x16x32_bf16 v[76:79], a[160:163], a[44:47], v[76:79]
  s_waitcnt lgkmcnt(4)
  v_min_u32_dpp v136, v136, v136 row_ror:2 row_mask:0xf bank_mask:0xf
  v_mfma_f32_16x16x32_bf16 v[80:83], a[168:171], a[32:35], v[80:83]
  ds_read_b64_tr_b16 a[184:185], v151 offset:0
  v_min_u32_dpp v136, v136, v136 row_ror:1 row_mask:0xf bank_mask:0xf
  v_mfma_f32_16x16x32_bf16 v[80:83], a[172:175], a[48:51], v[80:83]
  buffer_load_dwordx4 a[20:23], v243, s[24:27], s30 offen offset:1024 sc1
  v_mfma_f32_16x16x32_bf16 v[84:87], a[172:175], a[52:55], v[84:87]
  ds_read_b64_tr_b16 a[186:187], v151 offset:1024
  v_readlane_b32 s98, v136, 0
  v_mfma_f32_16x16x32_bf16 v[84:87], a[168:171], a[36:39], v[84:87]
  s_waitcnt vmcnt(22)
  v_readlane_b32 s99, v136, 16
  v_readlane_b32 s100, v136, 32
  v_mfma_f32_16x16x32_bf16 v[88:91], a[168:171], a[40:43], v[88:91]
  ds_read_b64_tr_b16 a[188:189], v151 offset:8192
  v_readlane_b32 s101, v136, 48
  v_mfma_f32_16x16x32_bf16 v[88:91], a[172:175], a[56:59], v[88:91]
  s_barrier
  s_min_u32 s98, s98, s99
  s_min_u32 s100, s100, s101
  v_mfma_f32_16x16x32_bf16 v[92:95], a[172:175], a[60:63], v[92:95]
  ds_read_b64_tr_b16 a[190:191], v151 offset:9216
  s_min_u32 s98, s98, s100
  s_sub_u32 s56, s51, s98
  s_sub_u32 s51, s56, 1
  v_sub_u32 v137, s51, v128
  v_mfma_f32_16x16x32_bf16 v[92:95], a[168:171], a[44:47], v[92:95]
  s_waitcnt lgkmcnt(4)
  v_sub_u32 v138, s51, v129
  v_min_u32 v136, v137, v138
  v_mfma_f32_16x16x32_bf16 v[96:99], a[176:179], a[32:35], v[96:99]
  ds_read_b64_tr_b16 a[160:161], v224 offset:0
  v_sub_u32 v139, s51, v130
  v_mfma_f32_16x16x32_bf16 v[96:99], a[180:183], a[48:51], v[96:99]
  buffer_load_dwordx4 a[24:27], v243, s[24:27], s30 offen offset:2048 sc1
  v_mfma_f32_16x16x32_bf16 v[100:103], a[180:183], a[52:55], v[100:103]
  ds_read_b64_tr_b16 a[162:163], v224 offset:1024
  v_sub_u32 v140, s51, v131
  v_mfma_f32_16x16x32_bf16 v[100:103], a[176:179], a[36:39], v[100:103]
  v_min3_u32 v136, v136, v139, v140
  v_sub_u32 v137, s51, v132
  v_mfma_f32_16x16x32_bf16 v[104:107], a[176:179], a[40:43], v[104:107]
  ds_read_b64_tr_b16 a[164:165], v224 offset:8192
  v_sub_u32 v138, s51, v133
  v_mfma_f32_16x16x32_bf16 v[104:107], a[180:183], a[56:59], v[104:107]
  buffer_load_dwordx4 v241, s[20:23], s31 offen offset:3072 lds
  s_add_u32 s31, s31, 0x80000
  v_mfma_f32_16x16x32_bf16 v[108:111], a[180:183], a[60:63], v[108:111]
  ds_read_b64_tr_b16 a[166:167], v224 offset:9216
  v_min3_u32 v136, v136, v137, v138
  v_mfma_f32_16x16x32_bf16 v[108:111], a[176:179], a[44:47], v[108:111]
  s_waitcnt lgkmcnt(4)
  v_sub_u32 v139, s51, v134
  v_sub_u32 v140, s51, v135
  v_mfma_f32_16x16x32_bf16 v[112:115], a[184:187], a[32:35], v[112:115]
  ds_read_b64_tr_b16 a[168:169], v225 offset:0
  v_min3_u32 v136, v136, v139, v140
  v_mfma_f32_16x16x32_bf16 v[112:115], a[188:191], a[48:51], v[112:115]
  buffer_load_dwordx4 a[28:31], v243, s[24:27], s30 offen offset:3072 sc1
  s_add_u32 s30, s30, 8192
  v_mfma_f32_16x16x32_bf16 v[116:119], a[188:191], a[52:55], v[116:119]
  ds_read_b64_tr_b16 a[170:171], v225 offset:1024
  v_min_u32_dpp v136, v136, v136 row_ror:8 row_mask:0xf bank_mask:0xf
  v_mfma_f32_16x16x32_bf16 v[116:119], a[184:187], a[36:39], v[116:119]
  v_mfma_f32_16x16x32_bf16 v[120:123], a[184:187], a[40:43], v[120:123]
  ds_read_b64_tr_b16 a[172:173], v225 offset:8192
  v_min_u32_dpp v136, v136, v136 row_ror:4 row_mask:0xf bank_mask:0xf
  v_mfma_f32_16x16x32_bf16 v[120:123], a[188:191], a[56:59], v[120:123]
  v_mfma_f32_16x16x32_bf16 v[124:127], a[188:191], a[60:63], v[124:127]
  ds_read_b64_tr_b16 a[174:175], v225 offset:9216
  v_min_u32_dpp v136, v136, v136 row_ror:2 row_mask:0xf bank_mask:0xf
  v_mfma_f32_16x16x32_bf16 v[124:127], a[184:187], a[44:47], v[124:127]
  s_waitcnt vmcnt(24) lgkmcnt(4)
  v_min_u32_dpp v136, v136, v136 row_ror:1 row_mask:0xf bank_mask:0xf
  v_mfma_f32_16x16x32_bf16 v[0:3], a[160:163], a[64:67], v[0:3]
  ds_read_b64_tr_b16 a[176:177], v226 offset:0
  v_readlane_b32 s98, v136, 0
  v_mfma_f32_16x16x32_bf16 v[0:3], a[164:167], a[80:83], v[0:3]
  buffer_load_dwordx4 a[32:35], v242, s[24:27], s30 offen offset:0 sc1
  v_mfma_f32_16x16x32_bf16 v[4:7], a[164:167], a[84:87], v[4:7]
  ds_read_b64_tr_b16 a[178:179], v226 offset:1024
  v_readlane_b32 s99, v136, 16
  v_mfma_f32_16x16x32_bf16 v[4:7], a[160:163], a[68:71], v[4:7]
  v_readlane_b32 s100, v136, 32
  v_readlane_b32 s101, v136, 48
  v_mfma_f32_16x16x32_bf16 v[8:11], a[160:163], a[72:75], v[8:11]
  ds_read_b64_tr_b16 a[180:181], v226 offset:8192
  s_add_u32 m0, s28, 114688
  s_min_u32 s98, s98, s99
  s_min_u32 s100, s100, s101
  v_mfma_f32_16x16x32_bf16 v[8:11], a[164:167], a[88:91], v[8:11]
  buffer_load_dwordx4 v238, s[20:23], s31 offen offset:0 lds
  s_min_u32 s98, s98, s100
  s_sub_u32 s57, s51, s98
  s_sub_u32 s51, s57, 1
  v_mfma_f32_16x16x32_bf16 v[12:15], a[164:167], a[92:95], v[12:15]
  ds_read_b64_tr_b16 a[182:183], v226 offset:9216
  v_sub_u32 v137, s51, v128
  v_mfma_f32_16x16x32_bf16 v[12:15], a[160:163], a[76:79], v[12:15]
  s_waitcnt lgkmcnt(4)
  v_sub_u32 v138, s51, v129
  v_min_u32 v136, v137, v138
  v_mfma_f32_16x16x32_bf16 v[16:19], a[168:171], a[64:67], v[16:19]
  ds_read_b64_tr_b16 a[184:185], v227 offset:0
  v_sub_u32 v139, s51, v130
  v_mfma_f32_16x16x32_bf16 v[16:19], a[172:175], a[80:83], v[16:19]
  buffer_load_dwordx4 a[36:39], v242, s[24:27], s30 offen offset:1024 sc1
  v_mfma_f32_16x16x32_bf16 v[20:23], a[172:175], a[84:87], v[20:23]
  ds_read_b64_tr_b16 a[186:187], v227 offset:1024
  v_sub_u32 v140, s51, v131
  v_mfma_f32_16x16x32_bf16 v[20:23], a[168:171], a[68:71], v[20:23]
  v_min3_u32 v136, v136, v139, v140
  v_sub_u32 v137, s51, v132
  v_mfma_f32_16x16x32_bf16 v[24:27], a[168:171], a[72:75], v[24:27]
  ds_read_b64_tr_b16 a[188:189], v227 offset:8192
  v_sub_u32 v138, s51, v133
  v_mfma_f32_16x16x32_bf16 v[24:27], a[172:175], a[88:91], v[24:27]
  v_min3_u32 v136, v136, v137, v138
  v_sub_u32 v139, s51, v134
  v_mfma_f32_16x16x32_bf16 v[28:31], a[172:175], a[92:95], v[28:31]
  ds_read_b64_tr_b16 a[190:191], v227 offset:9216
  v_sub_u32 v140, s51, v135
  v_mfma_f32_16x16x32_bf16 v[28:31], a[168:171], a[76:79], v[28:31]
  s_waitcnt lgkmcnt(4)
  v_min3_u32 v136, v136, v139, v140
  v_mfma_f32_16x16x32_bf16 v[32:35], a[176:179], a[64:67], v[32:35]
  ds_read_b64_tr_b16 a[160:161], v228 offset:0
  v_min_u32_dpp v136, v136, v136 row_ror:8 row_mask:0xf bank_mask:0xf
  v_mfma_f32_16x16x32_bf16 v[32:35], a[180:183], a[80:83], v[32:35]
  buffer_load_dwordx4 a[40:43], v242, s[24:27], s30 offen offset:2048 sc1
  v_mfma_f32_16x16x32_bf16 v[36:39], a[180:183], a[84:87], v[36:39]
  ds_read_b64_tr_b16 a[162:163], v228 offset:1024
  v_min_u32_dpp v136, v136, v136 row_ror:4 row_mask:0xf bank_mask:0xf
  v_mfma_f32_16x16x32_bf16 v[36:39], a[176:179], a[68:71], v[36:39]
  v_mfma_f32_16x16x32_bf16 v[40:43], a[176:179], a[72:75], v[40:43]
  ds_read_b64_tr_b16 a[164:165], v228 offset:8192
  v_min_u32_dpp v136, v136, v136 row_ror:2 row_mask:0xf bank_mask:0xf
  v_mfma_f32_16x16x32_bf16 v[40:43], a[180:183], a[88:91], v[40:43]
  buffer_load_dwordx4 v239, s[20:23], s31 offen offset:1024 lds
  v_mfma_f32_16x16x32_bf16 v[44:47], a[180:183], a[92:95], v[44:47]
  ds_read_b64_tr_b16 a[166:167], v228 offset:9216
  v_min_u32_dpp v136, v136, v136 row_ror:1 row_mask:0xf bank_mask:0xf
  v_mfma_f32_16x16x32_bf16 v[44:47], a[176:179], a[76:79], v[44:47]
  s_waitcnt lgkmcnt(4)
  v_readlane_b32 s98, v136, 0
  v_readlane_b32 s99, v136, 16
  v_mfma_f32_16x16x32_bf16 v[48:51], a[184:187], a[64:67], v[48:51]
  ds_read_b64_tr_b16 a[168:169], v229 offset:0
  v_readlane_b32 s100, v136, 32
  v_mfma_f32_16x16x32_bf16 v[48:51], a[188:191], a[80:83], v[48:51]
  buffer_load_dwordx4 a[44:47], v242, s[24:27], s30 offen offset:3072 sc1
  v_mfma_f32_16x16x32_bf16 v[52:55], a[188:191], a[84:87], v[52:55]
  ds_read_b64_tr_b16 a[170:171], v229 offset:1024
  v_readlane_b32 s101, v136, 48
  v_mfma_f32_16x16x32_bf16 v[52:55], a[184:187], a[68:71], v[52:55]
  s_min_u32 s98, s98, s99
  s_min_u32 s100, s100, s101
  s_min_u32 s98, s98, s100
  v_mfma_f32_16x16x32_bf16 v[56:59], a[184:187], a[72:75], v[56:59]
  ds_read_b64_tr_b16 a[172:173], v229 offset:8192
  s_sub_u32 s58, s51, s98
  s_sub_u32 s51, s58, 1
  v_sub_u32 v137, s51, v128
  v_mfma_f32_16x16x32_bf16 v[56:59], a[188:191], a[88:91], v[56:59]
  v_sub_u32 v138, s51, v129
  v_min_u32 v136, v137, v138
  v_mfma_f32_16x16x32_bf16 v[60:63], a[188:191], a[92:95], v[60:63]
  ds_read_b64_tr_b16 a[174:175], v229 offset:9216
  v_sub_u32 v139, s51, v130
  v_mfma_f32_16x16x32_bf16 v[60:63], a[184:187], a[76:79], v[60:63]
  s_waitcnt lgkmcnt(4)
  v_sub_u32 v140, s51, v131
  v_min3_u32 v136, v136, v139, v140
  v_mfma_f32_16x16x32_bf16 v[64:67], a[160:163], a[64:67], v[64:67]
  ds_read_b64_tr_b16 a[176:177], v230 offset:0
  v_sub_u32 v137, s51, v132
  v_mfma_f32_16x16x32_bf16 v[64:67], a[164:167], a[80:83], v[64:67]
  buffer_load_dwordx4 a[48:51], v243, s[24:27], s30 offen offset:0 sc1
  v_mfma_f32_16x16x32_bf16 v[68:71], a[164:167], a[84:87], v[68:71]
  ds_read_b64_tr_b16 a[178:179], v230 offset:1024
  v_sub_u32 v138, s51, v133
  v_mfma_f32_16x16x32_bf16 v[68:71], a[160:163], a[68:71], v[68:71]
  v_min3_u32 v136, v136, v137, v138
  v_sub_u32 v139, s51, v134
  v_mfma_f32_16x16x32_bf16 v[72:75], a[160:163], a[72:75], v[72:75]
  ds_read_b64_tr_b16 a[180:181], v230 offset:8192
  v_sub_u32 v140, s51, v135
  v_mfma_f32_16x16x32_bf16 v[72:75], a[164:167], a[88:91], v[72:75]
  buffer_load_dwordx4 v240, s[20:23], s31 offen offset:2048 lds
  v_mfma_f32_16x16x32_bf16 v[76:79], a[164:167], a[92:95], v[76:79]
  ds_read_b64_tr_b16 a[182:183], v230 offset:9216
  v_min3_u32 v136, v136, v139, v140
  v_mfma_f32_16x16x32_bf16 v[76:79], a[160:163], a[76:79], v[76:79]
  s_waitcnt lgkmcnt(4)
  v_min_u32_dpp v136, v136, v136 row_ror:8 row_mask:0xf bank_mask:0xf
  v_mfma_f32_16x16x32_bf16 v[80:83], a[168:171], a[64:67], v[80:83]
  ds_read_b64_tr_b16 a[184:185], v231 offset:0
  v_min_u32_dpp v136, v136, v136 row_ror:4 row_mask:0xf bank_mask:0xf
  v_mfma_f32_16x16x32_bf16 v[80:83], a[172:175], a[80:83], v[80:83]
  buffer_load_dwordx4 a[52:55], v243, s[24:27], s30 offen offset:1024 sc1
  v_mfma_f32_16x16x32_bf16 v[84:87], a[172:175], a[84:87], v[84:87]
  ds_read_b64_tr_b16 a[186:187], v231 offset:1024
  v_min_u32_dpp v136, v136, v136 row_ror:2 row_mask:0xf bank_mask:0xf
  v_mfma_f32_16x16x32_bf16 v[84:87], a[168:171], a[68:71], v[84:87]
  s_waitcnt vmcnt(22)
  v_min_u32_dpp v136, v136, v136 row_ror:1 row_mask:0xf bank_mask:0xf
  v_mfma_f32_16x16x32_bf16 v[88:91], a[168:171], a[72:75], v[88:91]
  ds_read_b64_tr_b16 a[188:189], v231 offset:8192
  v_readlane_b32 s98, v136, 0
  v_readlane_b32 s99, v136, 16
  v_readlane_b32 s100, v136, 32
  v_readlane_b32 s101, v136, 48
  s_min_u32 s98, s98, s99
  s_min_u32 s100, s100, s101
  s_min_u32 s98, s98, s100
  s_sub_u32 s59, s51, s98
  s_sub_u32 s51, s59, 1
  v_writelane_b32 v136, s52, 0
  v_writelane_b32 v136, s53, 1
  v_writelane_b32 v136, s54, 2
  v_writelane_b32 v136, s55, 3
  v_writelane_b32 v136, s56, 4
  v_writelane_b32 v136, s57, 5
  v_writelane_b32 v136, s58, 6
  v_writelane_b32 v136, s59, 7
  s_lshl_b32 s35, s3, 8
  s_add_u32 s35, s35, 158720
  v_lshrrev_b32 v137, 2, v242
  v_add_u32 v137, s35, v137
  ds_write_b32 v137, v136
  s_waitcnt lgkmcnt(0)
  v_mfma_f32_16x16x32_bf16 v[88:91], a[172:175], a[88:91], v[88:91]
  s_barrier
  v_mfma_f32_16x16x32_bf16 v[92:95], a[172:175], a[92:95], v[92:95]
  ds_read_b64_tr_b16 a[190:191], v231 offset:9216
  v_mfma_f32_16x16x32_bf16 v[92:95], a[168:171], a[76:79], v[92:95]
  v_mfma_f32_16x16x32_bf16 v[96:99], a[176:179], a[64:67], v[96:99]
  ds_read_b64_tr_b16 a[160:161], v224 offset:16384
  v_mfma_f32_16x16x32_bf16 v[96:99], a[180:183], a[80:83], v[96:99]
  buffer_load_dwordx4 a[56:59], v243, s[24:27], s30 offen offset:2048 sc1
  v_mfma_f32_16x16x32_bf16 v[100:103], a[180:183], a[84:87], v[100:103]
  ds_read_b64_tr_b16 a[162:163], v224 offset:17408
  v_mfma_f32_16x16x32_bf16 v[100:103], a[176:179], a[68:71], v[100:103]
  v_mfma_f32_16x16x32_bf16 v[104:107], a[176:179], a[72:75], v[104:107]
  ds_read_b64_tr_b16 a[164:165], v224 offset:24576
  v_mfma_f32_16x16x32_bf16 v[104:107], a[180:183], a[88:91], v[104:107]
  buffer_load_dwordx4 v241, s[20:23], s31 offen offset:3072 lds
  s_add_u32 s31, s31, 0x80000
  v_mfma_f32_16x16x32_bf16 v[108:111], a[180:183], a[92:95], v[108:111]
  ds_read_b64_tr_b16 a[166:167], v224 offset:25600
  v_mfma_f32_16x16x32_bf16 v[108:111], a[176:179], a[76:79], v[108:111]
  s_waitcnt lgkmcnt(4)
  v_mfma_f32_16x16x32_bf16 v[112:115], a[184:187], a[64:67], v[112:115]
  ds_read_b64_tr_b16 a[168:169], v225 offset:16384
  v_mfma_f32_16x16x32_bf16 v[112:115], a[188:191], a[80:83], v[112:115]
  buffer_load_dwordx4 a[60:63], v243, s[24:27], s30 offen offset:3072 sc1
  s_add_u32 s30, s30, 8192
  v_mfma_f32_16x16x32_bf16 v[116:119], a[188:191], a[84:87], v[116:119]
  ds_read_b64_tr_b16 a[170:171], v225 offset:17408
  v_mfma_f32_16x16x32_bf16 v[116:119], a[184:187], a[68:71], v[116:119]
  v_mfma_f32_16x16x32_bf16 v[120:123], a[184:187], a[72:75], v[120:123]
  ds_read_b64_tr_b16 a[172:173], v225 offset:24576
  v_mfma_f32_16x16x32_bf16 v[120:123], a[188:191], a[88:91], v[120:123]
  v_mfma_f32_16x16x32_bf16 v[124:127], a[188:191], a[92:95], v[124:127]
  ds_read_b64_tr_b16 a[174:175], v225 offset:25600
  v_mfma_f32_16x16x32_bf16 v[124:127], a[184:187], a[76:79], v[124:127]
  s_waitcnt vmcnt(24) lgkmcnt(4)
  v_mfma_f32_16x16x32_bf16 v[0:3], a[160:163], a[96:99], v[0:3]
  ds_read_b64_tr_b16 a[176:177], v226 offset:16384
  v_lshrrev_b32 v136, 4, v242
  v_mfma_f32_16x16x32_bf16 v[0:3], a[164:167], a[112:115], v[0:3]
  v_bfe_u32 v137, v136, 3, 2
  v_and_b32 v138, 7, v136
  v_mfma_f32_16x16x32_bf16 v[4:7], a[164:167], a[116:119], v[4:7]
  ds_read_b64_tr_b16 a[178:179], v226 offset:17408
  v_lshlrev_b32 v137, 8, v137
  v_mfma_f32_16x16x32_bf16 v[4:7], a[160:163], a[100:103], v[4:7]
  v_lshl_add_u32 v137, v138, 2, v137
  v_add_u32 v137, 158720, v137
  v_mfma_f32_16x16x32_bf16 v[8:11], a[160:163], a[104:107], v[8:11]
  ds_read_b64_tr_b16 a[180:181], v226 offset:24576
  s_add_u32 m0, s28, 0
  ds_read_b32 v128, v137
  v_mfma_f32_16x16x32_bf16 v[8:11], a[164:167], a[120:123], v[8:11]
  buffer_load_dwordx4 v232, s[12:15], s29 offen offset:0 lds
  v_mfma_f32_16x16x32_bf16 v[12:15], a[164:167], a[124:127], v[12:15]
  ds_read_b64_tr_b16 a[182:183], v226 offset:25600
  v_mfma_f32_16x16x32_bf16 v[12:15], a[160:163], a[108:111], v[12:15]
  s_waitcnt lgkmcnt(5)
  v_mfma_f32_16x16x32_bf16 v[16:19], a[168:171], a[96:99], v[16:19]
  ds_read_b64_tr_b16 a[184:185], v227 offset:16384
  v_mfma_f32_16x16x32_bf16 v[16:19], a[172:175], a[112:115], v[16:19]
  v_mfma_f32_16x16x32_bf16 v[20:23], a[172:175], a[116:119], v[20:23]
  ds_read_b64_tr_b16 a[186:187], v227 offset:17408
  v_mfma_f32_16x16x32_bf16 v[20:23], a[168:171], a[100:103], v[20:23]
  v_mfma_f32_16x16x32_bf16 v[24:27], a[168:171], a[104:107], v[24:27]
  ds_read_b64_tr_b16 a[188:189], v227 offset:24576
  s_waitcnt lgkmcnt(4)
  s_mov_b32 s51, -1
  v_sub_u32 v137, s51, v128
  v_mfma_f32_16x16x32_bf16 v[24:27], a[172:175], a[120:123], v[24:27]
  v_mfma_f32_16x16x32_bf16 v[28:31], a[172:175], a[124:127], v[28:31]
  ds_read_b64_tr_b16 a[190:191], v227 offset:25600
  v_min_u32_dpp v137, v137, v137 row_ror:8 row_mask:0xf bank_mask:0xf
  v_mfma_f32_16x16x32_bf16 v[28:31], a[168:171], a[108:111], v[28:31]
  s_waitcnt lgkmcnt(4)
  v_min_u32_dpp v137, v137, v137 row_ror:4 row_mask:0xf bank_mask:0xf
  v_mfma_f32_16x16x32_bf16 v[32:35], a[176:179], a[96:99], v[32:35]
  ds_read_b64_tr_b16 a[160:161], v228 offset:16384
  v_min_u32_dpp v137, v137, v137 row_ror:2 row_mask:0xf bank_mask:0xf
  v_mfma_f32_16x16x32_bf16 v[32:35], a[180:183], a[112:115], v[32:35]
  v_mfma_f32_16x16x32_bf16 v[36:39], a[180:183], a[116:119], v[36:39]
  ds_read_b64_tr_b16 a[162:163], v228 offset:17408
  v_min_u32_dpp v137, v137, v137 row_ror:1 row_mask:0xf bank_mask:0xf
  v_mfma_f32_16x16x32_bf16 v[36:39], a[176:179], a[100:103], v[36:39]
  v_readlane_b32 s98, v137, 0
  v_readlane_b32 s99, v137, 16
  v_mfma_f32_16x16x32_bf16 v[40:43], a[176:179], a[104:107], v[40:43]
  ds_read_b64_tr_b16 a[164:165], v228 offset:24576
  s_min_u32 s98, s98, s99
  s_sub_u32 s52, s51, s98
  s_sub_u32 s51, s52, 1
  v_sub_u32 v137, s51, v128
  v_mfma_f32_16x16x32_bf16 v[40:43], a[180:183], a[120:123], v[40:43]
  buffer_load_dwordx4 v233, s[12:15], s29 offen offset:1024 lds
  v_mfma_f32_16x16x32_bf16 v[44:47], a[180:183], a[124:127], v[44:47]
  ds_read_b64_tr_b16 a[166:167], v228 offset:25600
  v_min_u32_dpp v137, v137, v137 row_ror:8 row_mask:0xf bank_mask:0xf
  v_mfma_f32_16x16x32_bf16 v[44:47], a[176:179], a[108:111], v[44:47]
  s_waitcnt lgkmcnt(4)
  v_min_u32_dpp v137, v137, v137 row_ror:4 row_mask:0xf bank_mask:0xf
  v_mfma_f32_16x16x32_bf16 v[48:51], a[184:187], a[96:99], v[48:51]
  ds_read_b64_tr_b16 a[168:169], v229 offset:16384
  v_min_u32_dpp v137, v137, v137 row_ror:2 row_mask:0xf bank_mask:0xf
  v_mfma_f32_16x16x32_bf16 v[48:51], a[188:191], a[112:115], v[48:51]
  v_mfma_f32_16x16x32_bf16 v[52:55], a[188:191], a[116:119], v[52:55]
  ds_read_b64_tr_b16 a[170:171], v229 offset:17408
  v_min_u32_dpp v137, v137, v137 row_ror:1 row_mask:0xf bank_mask:0xf
  v_mfma_f32_16x16x32_bf16 v[52:55], a[184:187], a[100:103], v[52:55]
  v_readlane_b32 s98, v137, 0
  v_readlane_b32 s99, v137, 16
  v_mfma_f32_16x16x32_bf16 v[56:59], a[184:187], a[104:107], v[56:59]
  ds_read_b64_tr_b16 a[172:173], v229 offset:24576
  s_min_u32 s98, s98, s99
  s_sub_u32 s53, s51, s98
  s_sub_u32 s51, s53, 1
  v_sub_u32 v137, s51, v128
  v_mfma_f32_16x16x32_bf16 v[56:59], a[188:191], a[120:123], v[56:59]
  v_mfma_f32_16x16x32_bf16 v[60:63], a[188:191], a[124:127], v[60:63]
  ds_read_b64_tr_b16 a[174:175], v229 offset:25600
  v_min_u32_dpp v137, v137, v137 row_ror:8 row_mask:0xf bank_mask:0xf
  v_mfma_f32_16x16x32_bf16 v[60:63], a[184:187], a[108:111], v[60:63]
  s_waitcnt lgkmcnt(4)
  v_min_u32_dpp v137, v137, v137 row_ror:4 row_mask:0xf bank_mask:0xf
  v_mfma_f32_16x16x32_bf16 v[64:67], a[160:163], a[96:99], v[64:67]
  ds_read_b64_tr_b16 a[176:177], v230 offset:16384
  v_min_u32_dpp v137, v137, v137 row_ror:2 row_mask:0xf bank_mask:0xf
  v_mfma_f32_16x16x32_bf16 v[64:67], a[164:167], a[112:115], v[64:67]
  v_mfma_f32_16x16x32_bf16 v[68:71], a[164:167], a[116:119], v[68:71]
  ds_read_b64_tr_b16 a[178:179], v230 offset:17408
  v_min_u32_dpp v137, v137, v137 row_ror:1 row_mask:0xf bank_mask:0xf
  v_mfma_f32_16x16x32_bf16 v[68:71], a[160:163], a[100:103], v[68:71]
  v_readlane_b32 s98, v137, 0
  v_readlane_b32 s99, v137, 16
  v_mfma_f32_16x16x32_bf16 v[72:75], a[160:163], a[104:107], v[72:75]
  ds_read_b64_tr_b16 a[180:181], v230 offset:24576
  s_min_u32 s98, s98, s99
  s_sub_u32 s54, s51, s98
  s_sub_u32 s51, s54, 1
  v_sub_u32 v137, s51, v128
  v_mfma_f32_16x16x32_bf16 v[72:75], a[164:167], a[120:123], v[72:75]
  buffer_load_dwordx4 v234, s[12:15], s29 offen offset:2048 lds
  v_mfma_f32_16x16x32_bf16 v[76:79], a[164:167], a[124:127], v[76:79]
  ds_read_b64_tr_b16 a[182:183], v230 offset:25600
  v_min_u32_dpp v137, v137, v137 row_ror:8 row_mask:0xf bank_mask:0xf
  v_mfma_f32_16x16x32_bf16 v[76:79], a[160:163], a[108:111], v[76:79]
  s_waitcnt lgkmcnt(4)
  v_min_u32_dpp v137, v137, v137 row_ror:4 row_mask:0xf bank_mask:0xf
  v_mfma_f32_16x16x32_bf16 v[80:83], a[168:171], a[96:99], v[80:83]
  ds_read_b64_tr_b16 a[184:185], v231 offset:16384
  v_min_u32_dpp v137, v137, v137 row_ror:2 row_mask:0xf bank_mask:0xf
  v_mfma_f32_16x16x32_bf16 v[80:83], a[172:175], a[112:115], v[80:83]
  v_mfma_f32_16x16x32_bf16 v[84:87], a[172:175], a[116:119], v[84:87]
  ds_read_b64_tr_b16 a[186:187], v231 offset:17408
  v_min_u32_dpp v137, v137, v137 row_ror:1 row_mask:0xf bank_mask:0xf
  v_mfma_f32_16x16x32_bf16 v[84:87], a[168:171], a[100:103], v[84:87]
  s_waitcnt vmcnt(16)
  v_readlane_b32 s98, v137, 0
  v_readlane_b32 s99, v137, 16
  v_mfma_f32_16x16x32_bf16 v[88:91], a[168:171], a[104:107], v[88:91]
  ds_read_b64_tr_b16 a[188:189], v231 offset:24576
  s_min_u32 s98, s98, s99
  s_sub_u32 s55, s51, s98
  s_sub_u32 s51, s55, 1
  v_sub_u32 v137, s51, v128
  v_mfma_f32_16x16x32_bf16 v[88:91], a[172:175], a[120:123], v[88:91]
  s_barrier
  v_min_u32_dpp v137, v137, v137 row_ror:8 row_mask:0xf bank_mask:0xf
  v_mfma_f32_16x16x32_bf16 v[92:95], a[172:175], a[124:127], v[92:95]
  ds_read_b64_tr_b16 a[190:191], v231 offset:25600
  v_min_u32_dpp v137, v137, v137 row_ror:4 row_mask:0xf bank_mask:0xf
  v_mfma_f32_16x16x32_bf16 v[92:95], a[168:171], a[108:111], v[92:95]
  s_waitcnt lgkmcnt(4)
  v_min_u32_dpp v137, v137, v137 row_ror:2 row_mask:0xf bank_mask:0xf
  v_mfma_f32_16x16x32_bf16 v[96:99], a[176:179], a[96:99], v[96:99]
  ds_read_b64_tr_b16 a[160:161], v224 offset:32768
  v_min_u32_dpp v137, v137, v137 row_ror:1 row_mask:0xf bank_mask:0xf
  v_mfma_f32_16x16x32_bf16 v[96:99], a[180:183], a[112:115], v[96:99]
  v_readlane_b32 s98, v137, 0
  v_readlane_b32 s99, v137, 16
  v_mfma_f32_16x16x32_bf16 v[100:103], a[180:183], a[116:119], v[100:103]
  ds_read_b64_tr_b16 a[162:163], v224 offset:33792
  s_min_u32 s98, s98, s99
  s_sub_u32 s56, s51, s98
  s_sub_u32 s51, s56, 1
  v_sub_u32 v137, s51, v128
  v_mfma_f32_16x16x32_bf16 v[100:103], a[176:179], a[100:103], v[100:103]
  v_mfma_f32_16x16x32_bf16 v[104:107], a[176:179], a[104:107], v[104:107]
  ds_read_b64_tr_b16 a[164:165], v224 offset:40960
  v_min_u32_dpp v137, v137, v137 row_ror:8 row_mask:0xf bank_mask:0xf
  v_mfma_f32_16x16x32_bf16 v[104:107], a[180:183], a[120:123], v[104:107]
  buffer_load_dwordx4 v235, s[12:15], s29 offen offset:3072 lds
  v_mfma_f32_16x16x32_bf16 v[108:111], a[180:183], a[124:127], v[108:111]
  ds_read_b64_tr_b16 a[166:167], v224 offset:41984
  v_min_u32_dpp v137, v137, v137 row_ror:4 row_mask:0xf bank_mask:0xf
  v_mfma_f32_16x16x32_bf16 v[108:111], a[176:179], a[108:111], v[108:111]
  s_waitcnt lgkmcnt(4)
  v_min_u32_dpp v137, v137, v137 row_ror:2 row_mask:0xf bank_mask:0xf
  v_mfma_f32_16x16x32_bf16 v[112:115], a[184:187], a[96:99], v[112:115]
  ds_read_b64_tr_b16 a[168:169], v225 offset:32768
  v_min_u32_dpp v137, v137, v137 row_ror:1 row_mask:0xf bank_mask:0xf
  v_mfma_f32_16x16x32_bf16 v[112:115], a[188:191], a[112:115], v[112:115]
  v_readlane_b32 s98, v137, 0
  v_readlane_b32 s99, v137, 16
  v_mfma_f32_16x16x32_bf16 v[116:119], a[188:191], a[116:119], v[116:119]
  ds_read_b64_tr_b16 a[170:171], v225 offset:33792
  s_min_u32 s98, s98, s99
  s_sub_u32 s57, s51, s98
  s_sub_u32 s51, s57, 1
  v_sub_u32 v137, s51, v128
  v_mfma_f32_16x16x32_bf16 v[116:119], a[184:187], a[100:103], v[116:119]
  v_mfma_f32_16x16x32_bf16 v[120:123], a[184:187], a[104:107], v[120:123]
  ds_read_b64_tr_b16 a[172:173], v225 offset:40960
  v_min_u32_dpp v137, v137, v137 row_ror:8 row_mask:0xf bank_mask:0xf
  v_mfma_f32_16x16x32_bf16 v[120:123], a[188:191], a[120:123], v[120:123]
  v_mfma_f32_16x16x32_bf16 v[124:127], a[188:191], a[124:127], v[124:127]
  ds_read_b64_tr_b16 a[174:175], v225 offset:41984
  v_min_u32_dpp v137, v137, v137 row_ror:4 row_mask:0xf bank_mask:0xf
  v_mfma_f32_16x16x32_bf16 v[124:127], a[184:187], a[108:111], v[124:127]
  s_waitcnt vmcnt(16) lgkmcnt(4)
  v_min_u32_dpp v137, v137, v137 row_ror:2 row_mask:0xf bank_mask:0xf
  v_mfma_f32_16x16x32_bf16 v[0:3], a[160:163], a[0:3], v[0:3]
  ds_read_b64_tr_b16 a[176:177], v226 offset:32768
  v_min_u32_dpp v137, v137, v137 row_ror:1 row_mask:0xf bank_mask:0xf
  v_mfma_f32_16x16x32_bf16 v[0:3], a[164:167], a[16:19], v[0:3]
  v_readlane_b32 s98, v137, 0
  v_readlane_b32 s99, v137, 16
  v_mfma_f32_16x16x32_bf16 v[4:7], a[164:167], a[20:23], v[4:7]
  ds_read_b64_tr_b16 a[178:179], v226 offset:33792
  s_min_u32 s98, s98, s99
  s_sub_u32 s58, s51, s98
  s_sub_u32 s51, s58, 1
  v_sub_u32 v137, s51, v128
  v_mfma_f32_16x16x32_bf16 v[4:7], a[160:163], a[4:7], v[4:7]
  v_mfma_f32_16x16x32_bf16 v[8:11], a[160:163], a[8:11], v[8:11]
  ds_read_b64_tr_b16 a[180:181], v226 offset:40960
  s_add_u32 m0, s28, 65536
  v_min_u32_dpp v137, v137, v137 row_ror:8 row_mask:0xf bank_mask:0xf
  v_mfma_f32_16x16x32_bf16 v[8:11], a[164:167], a[24:27], v[8:11]
  buffer_load_dwordx4 v236, s[16:19], s29 offen offset:0 lds
  v_mfma_f32_16x16x32_bf16 v[12:15], a[164:167], a[28:31], v[12:15]
  ds_read_b64_tr_b16 a[182:183], v226 offset:41984
  v_min_u32_dpp v137, v137, v137 row_ror:4 row_mask:0xf bank_mask:0xf
  v_mfma_f32_16x16x32_bf16 v[12:15], a[160:163], a[12:15], v[12:15]
  s_waitcnt lgkmcnt(4)
  v_min_u32_dpp v137, v137, v137 row_ror:2 row_mask:0xf bank_mask:0xf
  v_mfma_f32_16x16x32_bf16 v[16:19], a[168:171], a[0:3], v[16:19]
  ds_read_b64_tr_b16 a[184:185], v227 offset:32768
  v_min_u32_dpp v137, v137, v137 row_ror:1 row_mask:0xf bank_mask:0xf
  v_mfma_f32_16x16x32_bf16 v[16:19], a[172:175], a[16:19], v[16:19]
  v_readlane_b32 s98, v137, 0
  v_readlane_b32 s99, v137, 16
  v_mfma_f32_16x16x32_bf16 v[20:23], a[172:175], a[20:23], v[20:23]
  ds_read_b64_tr_b16 a[186:187], v227 offset:33792
  s_min_u32 s98, s98, s99
  s_sub_u32 s59, s51, s98
  s_sub_u32 s51, s59, 1
  v_mov_b32 v128, 0
  v_mfma_f32_16x16x32_bf16 v[20:23], a[168:171], a[4:7], v[20:23]
  v_writelane_b32 v128, s52, 0
  v_writelane_b32 v128, s53, 1
  v_mfma_f32_16x16x32_bf16 v[24:27], a[168:171], a[8:11], v[24:27]
  ds_read_b64_tr_b16 a[188:189], v227 offset:40960
  v_writelane_b32 v128, s54, 2
  v_mfma_f32_16x16x32_bf16 v[24:27], a[172:175], a[24:27], v[24:27]
  v_writelane_b32 v128, s55, 3
  v_writelane_b32 v128, s56, 4
  v_mfma_f32_16x16x32_bf16 v[28:31], a[172:175], a[28:31], v[28:31]
  ds_read_b64_tr_b16 a[190:191], v227 offset:41984
  v_writelane_b32 v128, s57, 5
  v_mfma_f32_16x16x32_bf16 v[28:31], a[168:171], a[12:15], v[28:31]
  s_waitcnt lgkmcnt(4)
  v_writelane_b32 v128, s58, 6
  v_writelane_b32 v128, s59, 7
  v_mfma_f32_16x16x32_bf16 v[32:35], a[176:179], a[0:3], v[32:35]
  ds_read_b64_tr_b16 a[160:161], v228 offset:32768
  v_and_b32 v129, 0xffff, v128
  v_mfma_f32_16x16x32_bf16 v[32:35], a[180:183], a[16:19], v[32:35]
  v_sub_u32 v129, 0xffff, v129
  v_and_b32 v129, 0x7ff, v129
  v_mfma_f32_16x16x32_bf16 v[36:39], a[180:183], a[20:23], v[36:39]
  ds_read_b64_tr_b16 a[162:163], v228 offset:33792
  v_mov_b32 v130, v129
  v_mfma_f32_16x16x32_bf16 v[36:39], a[176:179], a[4:7], v[36:39]
  v_mfma_f32_16x16x32_bf16 v[40:43], a[176:179], a[8:11], v[40:43]
  ds_read_b64_tr_b16 a[164:165], v228 offset:40960
  v_permlane16_swap_b32 v129, v130
  v_mfma_f32_16x16x32_bf16 v[40:43], a[180:183], a[24:27], v[40:43]
  buffer_load_dwordx4 v237, s[16:19], s29 offen offset:1024 lds
  v_mfma_f32_16x16x32_bf16 v[44:47], a[180:183], a[28:31], v[44:47]
  ds_read_b64_tr_b16 a[166:167], v228 offset:41984
  v_mov_b32 v130, v129
  v_mfma_f32_16x16x32_bf16 v[44:47], a[176:179], a[12:15], v[44:47]
  s_waitcnt lgkmcnt(4)
  v_permlane32_swap_b32 v129, v130
  v_lshrrev_b32 v130, 6, v129
  v_mfma_f32_16x16x32_bf16 v[48:51], a[184:187], a[0:3], v[48:51]
  ds_read_b64_tr_b16 a[168:169], v229 offset:32768
  v_mul_u32_u24 v130, 0x14000, v130
  v_mfma_f32_16x16x32_bf16 v[48:51], a[188:191], a[16:19], v[48:51]
  v_bfe_u32 v131, v129, 4, 2
  v_lshl_add_u32 v130, v131, 10, v130
  v_mfma_f32_16x16x32_bf16 v[52:55], a[188:191], a[20:23], v[52:55]
  ds_read_b64_tr_b16 a[170:171], v229 offset:33792
  v_and_b32 v131, 15, v129
  v_mfma_f32_16x16x32_bf16 v[52:55], a[184:187], a[4:7], v[52:55]
  v_lshl_add_u32 v130, v131, 4, v130
  v_lshrrev_b32 v131, 4, v136
  v_mfma_f32_16x16x32_bf16 v[56:59], a[184:187], a[8:11], v[56:59]
  ds_read_b64_tr_b16 a[172:173], v229 offset:40960
  v_lshl_add_u32 v243, v131, 8, v130
  v_mfma_f32_16x16x32_bf16 v[56:59], a[188:191], a[24:27], v[56:59]
  v_mfma_f32_16x16x32_bf16 v[60:63], a[188:191], a[28:31], v[60:63]
  ds_read_b64_tr_b16 a[174:175], v229 offset:41984
  v_mfma_f32_16x16x32_bf16 v[60:63], a[184:187], a[12:15], v[60:63]
  s_waitcnt lgkmcnt(4)
  v_mfma_f32_16x16x32_bf16 v[64:67], a[160:163], a[0:3], v[64:67]
  ds_read_b64_tr_b16 a[176:177], v230 offset:32768
  v_mfma_f32_16x16x32_bf16 v[64:67], a[164:167], a[16:19], v[64:67]
  v_mfma_f32_16x16x32_bf16 v[68:71], a[164:167], a[20:23], v[68:71]
  ds_read_b64_tr_b16 a[178:179], v230 offset:33792
  v_mfma_f32_16x16x32_bf16 v[68:71], a[160:163], a[4:7], v[68:71]
  v_mfma_f32_16x16x32_bf16 v[72:75], a[160:163], a[8:11], v[72:75]
  ds_read_b64_tr_b16 a[180:181], v230 offset:40960
  v_mfma_f32_16x16x32_bf16 v[72:75], a[164:167], a[24:27], v[72:75]
  buffer_load_dwordx4 v236, s[16:19], s29 offen offset:2048 lds
  v_mfma_f32_16x16x32_bf16 v[76:79], a[164:167], a[28:31], v[76:79]
  ds_read_b64_tr_b16 a[182:183], v230 offset:41984
  v_mfma_f32_16x16x32_bf16 v[76:79], a[160:163], a[12:15], v[76:79]
  s_waitcnt lgkmcnt(4)
  v_mfma_f32_16x16x32_bf16 v[80:83], a[168:171], a[0:3], v[80:83]
  ds_read_b64_tr_b16 a[184:185], v231 offset:32768
  v_mfma_f32_16x16x32_bf16 v[80:83], a[172:175], a[16:19], v[80:83]
  v_mfma_f32_16x16x32_bf16 v[84:87], a[172:175], a[20:23], v[84:87]
  ds_read_b64_tr_b16 a[186:187], v231 offset:33792
  v_mfma_f32_16x16x32_bf16 v[84:87], a[168:171], a[4:7], v[84:87]
  s_waitcnt vmcnt(8)
  v_mfma_f32_16x16x32_bf16 v[88:91], a[168:171], a[8:11], v[88:91]
  ds_read_b64_tr_b16 a[188:189], v231 offset:40960
  v_mfma_f32_16x16x32_bf16 v[88:91], a[172:175], a[24:27], v[88:91]
  s_barrier
  v_mfma_f32_16x16x32_bf16 v[92:95], a[172:175], a[28:31], v[92:95]
  ds_read_b64_tr_b16 a[190:191], v231 offset:41984
  v_mfma_f32_16x16x32_bf16 v[92:95], a[168:171], a[12:15], v[92:95]
  s_waitcnt lgkmcnt(4)
  v_mfma_f32_16x16x32_bf16 v[96:99], a[176:179], a[0:3], v[96:99]
  ds_read_b64_tr_b16 a[160:161], v224 offset:49152
  v_mfma_f32_16x16x32_bf16 v[96:99], a[180:183], a[16:19], v[96:99]
  v_mfma_f32_16x16x32_bf16 v[100:103], a[180:183], a[20:23], v[100:103]
  ds_read_b64_tr_b16 a[162:163], v224 offset:50176
  v_mfma_f32_16x16x32_bf16 v[100:103], a[176:179], a[4:7], v[100:103]
  v_mfma_f32_16x16x32_bf16 v[104:107], a[176:179], a[8:11], v[104:107]
  ds_read_b64_tr_b16 a[164:165], v224 offset:57344
  v_mfma_f32_16x16x32_bf16 v[104:107], a[180:183], a[24:27], v[104:107]
  buffer_load_dwordx4 v237, s[16:19], s29 offen offset:3072 lds
  s_add_u32 s29, s29, 16384
  v_mfma_f32_16x16x32_bf16 v[108:111], a[180:183], a[28:31], v[108:111]
  ds_read_b64_tr_b16 a[166:167], v224 offset:58368
  v_mfma_f32_16x16x32_bf16 v[108:111], a[176:179], a[12:15], v[108:111]
  s_waitcnt lgkmcnt(4)
  v_mfma_f32_16x16x32_bf16 v[112:115], a[184:187], a[0:3], v[112:115]
  ds_read_b64_tr_b16 a[168:169], v225 offset:49152
  v_mfma_f32_16x16x32_bf16 v[112:115], a[188:191], a[16:19], v[112:115]
  v_mfma_f32_16x16x32_bf16 v[116:119], a[188:191], a[20:23], v[116:119]
  ds_read_b64_tr_b16 a[170:171], v225 offset:50176
  v_mfma_f32_16x16x32_bf16 v[116:119], a[184:187], a[4:7], v[116:119]
  v_mfma_f32_16x16x32_bf16 v[120:123], a[184:187], a[8:11], v[120:123]
  ds_read_b64_tr_b16 a[172:173], v225 offset:57344
  v_mfma_f32_16x16x32_bf16 v[120:123], a[188:191], a[24:27], v[120:123]
  v_mfma_f32_16x16x32_bf16 v[124:127], a[188:191], a[28:31], v[124:127]
  ds_read_b64_tr_b16 a[174:175], v225 offset:58368
  v_mfma_f32_16x16x32_bf16 v[124:127], a[184:187], a[12:15], v[124:127]
  s_waitcnt vmcnt(8) lgkmcnt(4)
  v_mfma_f32_16x16x32_bf16 v[0:3], a[160:163], a[32:35], v[0:3]
  ds_read_b64_tr_b16 a[176:177], v226 offset:49152
  s_add_u32 m0, s28, 16384
  v_mfma_f32_16x16x32_bf16 v[0:3], a[164:167], a[48:51], v[0:3]
  buffer_load_dwordx4 v232, s[12:15], s29 offen offset:0 lds
  v_mfma_f32_16x16x32_bf16 v[4:7], a[164:167], a[52:55], v[4:7]
  ds_read_b64_tr_b16 a[178:179], v226 offset:50176
  v_mfma_f32_16x16x32_bf16 v[4:7], a[160:163], a[36:39], v[4:7]
  v_mfma_f32_16x16x32_bf16 v[8:11], a[160:163], a[40:43], v[8:11]
  ds_read_b64_tr_b16 a[180:181], v226 offset:57344
  v_mfma_f32_16x16x32_bf16 v[8:11], a[164:167], a[56:59], v[8:11]
  buffer_load_dwordx4 v233, s[12:15], s29 offen offset:1024 lds
  v_mfma_f32_16x16x32_bf16 v[12:15], a[164:167], a[60:63], v[12:15]
  ds_read_b64_tr_b16 a[182:183], v226 offset:58368
  v_mfma_f32_16x16x32_bf16 v[12:15], a[160:163], a[44:47], v[12:15]
  s_waitcnt lgkmcnt(4)
  v_mfma_f32_16x16x32_bf16 v[16:19], a[168:171], a[32:35], v[16:19]
  ds_read_b64_tr_b16 a[184:185], v227 offset:49152
  v_mfma_f32_16x16x32_bf16 v[16:19], a[172:175], a[48:51], v[16:19]
  buffer_load_dwordx4 v234, s[12:15], s29 offen offset:2048 lds
  v_mfma_f32_16x16x32_bf16 v[20:23], a[172:175], a[52:55], v[20:23]
  ds_read_b64_tr_b16 a[186:187], v227 offset:50176
  v_mfma_f32_16x16x32_bf16 v[20:23], a[168:171], a[36:39], v[20:23]
  buffer_load_dwordx4 v235, s[12:15], s29 offen offset:3072 lds
  v_mfma_f32_16x16x32_bf16 v[24:27], a[168:171], a[40:43], v[24:27]
  ds_read_b64_tr_b16 a[188:189], v227 offset:57344
  v_mfma_f32_16x16x32_bf16 v[24:27], a[172:175], a[56:59], v[24:27]
  v_mul_f32 v0, s34, v0
  v_mul_f32 v1, s34, v1
  v_mfma_f32_16x16x32_bf16 v[28:31], a[172:175], a[60:63], v[28:31]
  ds_read_b64_tr_b16 a[190:191], v227 offset:58368
  v_mul_f32 v2, s34, v2
  v_mfma_f32_16x16x32_bf16 v[28:31], a[168:171], a[44:47], v[28:31]
  s_waitcnt lgkmcnt(4)
  v_mul_f32 v3, s34, v3
  v_mul_f32 v16, s34, v16
  v_mfma_f32_16x16x32_bf16 v[32:35], a[176:179], a[32:35], v[32:35]
  ds_read_b64_tr_b16 a[160:161], v228 offset:49152
  v_mul_f32 v17, s34, v17
  v_mfma_f32_16x16x32_bf16 v[32:35], a[180:183], a[48:51], v[32:35]
  v_mul_f32 v18, s34, v18
  v_mul_f32 v19, s34, v19
  v_mfma_f32_16x16x32_bf16 v[36:39], a[180:183], a[52:55], v[36:39]
  ds_read_b64_tr_b16 a[162:163], v228 offset:50176
  v_cvt_pk_bf16_f32 v128, v0, v1
  v_mfma_f32_16x16x32_bf16 v[36:39], a[176:179], a[36:39], v[36:39]
  v_cvt_pk_bf16_f32 v129, v2, v3
  v_cvt_pk_bf16_f32 v130, v16, v17
  v_mfma_f32_16x16x32_bf16 v[40:43], a[176:179], a[40:43], v[40:43]
  ds_read_b64_tr_b16 a[164:165], v228 offset:57344
  v_cvt_pk_bf16_f32 v131, v18, v19
  v_mfma_f32_16x16x32_bf16 v[40:43], a[180:183], a[56:59], v[40:43]
  v_mul_f32 v4, s34, v4
  v_mul_f32 v5, s34, v5
  v_mfma_f32_16x16x32_bf16 v[44:47], a[180:183], a[60:63], v[44:47]
  ds_read_b64_tr_b16 a[166:167], v228 offset:58368
  v_mul_f32 v6, s34, v6
  v_mfma_f32_16x16x32_bf16 v[44:47], a[176:179], a[44:47], v[44:47]
  s_waitcnt lgkmcnt(4)
  v_mul_f32 v7, s34, v7
  v_mul_f32 v20, s34, v20
  v_mfma_f32_16x16x32_bf16 v[48:51], a[184:187], a[32:35], v[48:51]
  ds_read_b64_tr_b16 a[168:169], v229 offset:49152
  v_mul_f32 v21, s34, v21
  v_mfma_f32_16x16x32_bf16 v[48:51], a[188:191], a[48:51], v[48:51]
  v_mul_f32 v22, s34, v22
  v_mul_f32 v23, s34, v23
  v_mfma_f32_16x16x32_bf16 v[52:55], a[188:191], a[52:55], v[52:55]
  ds_read_b64_tr_b16 a[170:171], v229 offset:50176
  v_cvt_pk_bf16_f32 v144, v4, v5
  v_mfma_f32_16x16x32_bf16 v[52:55], a[184:187], a[36:39], v[52:55]
  v_cvt_pk_bf16_f32 v145, v6, v7
  v_cvt_pk_bf16_f32 v146, v20, v21
  v_mfma_f32_16x16x32_bf16 v[56:59], a[184:187], a[40:43], v[56:59]
  ds_read_b64_tr_b16 a[172:173], v229 offset:57344
  v_cvt_pk_bf16_f32 v147, v22, v23
  v_mfma_f32_16x16x32_bf16 v[56:59], a[188:191], a[56:59], v[56:59]
  v_permlane16_swap_b32 v128, v130
  v_permlane16_swap_b32 v129, v131
  v_mfma_f32_16x16x32_bf16 v[60:63], a[188:191], a[60:63], v[60:63]
  ds_read_b64_tr_b16 a[174:175], v229 offset:58368
  v_mul_f32 v8, s34, v8
  v_mfma_f32_16x16x32_bf16 v[60:63], a[184:187], a[44:47], v[60:63]
  s_waitcnt lgkmcnt(4)
  v_mul_f32 v9, s34, v9
  v_mul_f32 v10, s34, v10
  v_mfma_f32_16x16x32_bf16 v[64:67], a[160:163], a[32:35], v[64:67]
  ds_read_b64_tr_b16 a[176:177], v230 offset:49152
  v_mul_f32 v11, s34, v11
  v_mfma_f32_16x16x32_bf16 v[64:67], a[164:167], a[48:51], v[64:67]
  v_mul_f32 v24, s34, v24
  v_mul_f32 v25, s34, v25
  v_mfma_f32_16x16x32_bf16 v[68:71], a[164:167], a[52:55], v[68:71]
  ds_read_b64_tr_b16 a[178:179], v230 offset:50176
  v_mul_f32 v26, s34, v26
  v_mfma_f32_16x16x32_bf16 v[68:71], a[160:163], a[36:39], v[68:71]
  v_mul_f32 v27, s34, v27
  v_cvt_pk_bf16_f32 v160, v8, v9
  v_mfma_f32_16x16x32_bf16 v[72:75], a[160:163], a[40:43], v[72:75]
  ds_read_b64_tr_b16 a[180:181], v230 offset:57344
  v_cvt_pk_bf16_f32 v161, v10, v11
  v_mfma_f32_16x16x32_bf16 v[72:75], a[164:167], a[56:59], v[72:75]
  v_cvt_pk_bf16_f32 v162, v24, v25
  v_cvt_pk_bf16_f32 v163, v26, v27
  v_mfma_f32_16x16x32_bf16 v[76:79], a[164:167], a[60:63], v[76:79]
  ds_read_b64_tr_b16 a[182:183], v230 offset:58368
  v_permlane16_swap_b32 v144, v146
  v_mfma_f32_16x16x32_bf16 v[76:79], a[160:163], a[44:47], v[76:79]
  s_waitcnt lgkmcnt(4)
  v_permlane16_swap_b32 v145, v147
  v_mul_f32 v12, s34, v12
  v_mfma_f32_16x16x32_bf16 v[80:83], a[168:171], a[32:35], v[80:83]
  ds_read_b64_tr_b16 a[184:185], v231 offset:49152
  v_mul_f32 v13, s34, v13
  v_mfma_f32_16x16x32_bf16 v[80:83], a[172:175], a[48:51], v[80:83]
  v_mul_f32 v14, s34, v14
  v_mul_f32 v15, s34, v15
  v_mfma_f32_16x16x32_bf16 v[84:87], a[172:175], a[52:55], v[84:87]
  ds_read_b64_tr_b16 a[186:187], v231 offset:50176
  v_mul_f32 v28, s34, v28
  v_mfma_f32_16x16x32_bf16 v[84:87], a[168:171], a[36:39], v[84:87]
  s_waitcnt vmcnt(8)
  v_mul_f32 v29, s34, v29
  v_mul_f32 v30, s34, v30
  v_mfma_f32_16x16x32_bf16 v[88:91], a[168:171], a[40:43], v[88:91]
  ds_read_b64_tr_b16 a[188:189], v231 offset:57344
  v_mul_f32 v31, s34, v31
  v_mfma_f32_16x16x32_bf16 v[88:91], a[172:175], a[56:59], v[88:91]
  s_barrier
  v_cvt_pk_bf16_f32 v176, v12, v13
  v_cvt_pk_bf16_f32 v177, v14, v15
  v_mfma_f32_16x16x32_bf16 v[92:95], a[172:175], a[60:63], v[92:95]
  ds_read_b64_tr_b16 a[190:191], v231 offset:58368
  v_cvt_pk_bf16_f32 v178, v28, v29
  v_mfma_f32_16x16x32_bf16 v[92:95], a[168:171], a[44:47], v[92:95]
  s_waitcnt lgkmcnt(4)
  v_cvt_pk_bf16_f32 v179, v30, v31
  v_permlane16_swap_b32 v160, v162
  v_mfma_f32_16x16x32_bf16 v[96:99], a[176:179], a[32:35], v[96:99]
  ds_read_b128 a[128:131], v212 offset:0
  v_permlane16_swap_b32 v161, v163
  v_mfma_f32_16x16x32_bf16 v[96:99], a[180:183], a[48:51], v[96:99]
  v_mul_f32 v32, s34, v32
  v_mul_f32 v33, s34, v33
  v_mfma_f32_16x16x32_bf16 v[100:103], a[180:183], a[52:55], v[100:103]
  ds_read_b128 a[132:135], v213 offset:0
  v_mul_f32 v34, s34, v34
  v_mfma_f32_16x16x32_bf16 v[100:103], a[176:179], a[36:39], v[100:103]
  v_mul_f32 v35, s34, v35
  v_mul_f32 v48, s34, v48
  v_mfma_f32_16x16x32_bf16 v[104:107], a[176:179], a[40:43], v[104:107]
  ds_read_b128 a[136:139], v214 offset:0
  v_mul_f32 v49, s34, v49
  v_mfma_f32_16x16x32_bf16 v[104:107], a[180:183], a[56:59], v[104:107]
  v_mul_f32 v50, s34, v50
  v_mul_f32 v51, s34, v51
  v_mfma_f32_16x16x32_bf16 v[108:111], a[180:183], a[60:63], v[108:111]
  ds_read_b128 a[140:143], v215 offset:0
  v_cvt_pk_bf16_f32 v132, v32, v33
  v_mfma_f32_16x16x32_bf16 v[108:111], a[176:179], a[44:47], v[108:111]
  s_waitcnt lgkmcnt(4)
  v_cvt_pk_bf16_f32 v133, v34, v35
  v_cvt_pk_bf16_f32 v134, v48, v49
  v_mfma_f32_16x16x32_bf16 v[112:115], a[184:187], a[32:35], v[112:115]
  v_cvt_pk_bf16_f32 v135, v50, v51
  v_permlane16_swap_b32 v176, v178
  v_mfma_f32_16x16x32_bf16 v[112:115], a[188:191], a[48:51], v[112:115]
  v_permlane16_swap_b32 v177, v179
  v_mul_f32 v36, s34, v36
  v_mfma_f32_16x16x32_bf16 v[116:119], a[188:191], a[52:55], v[116:119]
  v_mul_f32 v37, s34, v37
  v_mul_f32 v38, s34, v38
  v_mfma_f32_16x16x32_bf16 v[116:119], a[184:187], a[36:39], v[116:119]
  v_mul_f32 v39, s34, v39
  v_mul_f32 v52, s34, v52
  v_mfma_f32_16x16x32_bf16 v[120:123], a[184:187], a[40:43], v[120:123]
  v_mul_f32 v53, s34, v53
  v_mul_f32 v54, s34, v54
  v_mfma_f32_16x16x32_bf16 v[120:123], a[188:191], a[56:59], v[120:123]
  v_mul_f32 v55, s34, v55
  v_cvt_pk_bf16_f32 v148, v36, v37
  v_mfma_f32_16x16x32_bf16 v[124:127], a[188:191], a[60:63], v[124:127]
  v_cvt_pk_bf16_f32 v149, v38, v39
  v_cvt_pk_bf16_f32 v150, v52, v53
  v_mfma_f32_16x16x32_bf16 v[124:127], a[184:187], a[44:47], v[124:127]
  s_waitcnt lgkmcnt(0)
  v_cvt_pk_bf16_f32 v151, v54, v55
  v_permlane16_swap_b32 v132, v134
  v_permlane16_swap_b32 v133, v135
  v_pk_mul_f32 v[40:41], v[40:41], s[34:35] op_sel_hi:[1,0]
  v_pk_mul_f32 v[42:43], v[42:43], s[34:35] op_sel_hi:[1,0]
  v_pk_mul_f32 v[56:57], v[56:57], s[34:35] op_sel_hi:[1,0]
  v_pk_mul_f32 v[58:59], v[58:59], s[34:35] op_sel_hi:[1,0]
  v_cvt_pk_bf16_f32 v164, v40, v41
  v_cvt_pk_bf16_f32 v165, v42, v43
  v_cvt_pk_bf16_f32 v166, v56, v57
  v_cvt_pk_bf16_f32 v167, v58, v59
  v_permlane16_swap_b32 v148, v150
  v_permlane16_swap_b32 v149, v151
  v_pk_mul_f32 v[44:45], v[44:45], s[34:35] op_sel_hi:[1,0]
  v_pk_mul_f32 v[46:47], v[46:47], s[34:35] op_sel_hi:[1,0]
  v_pk_mul_f32 v[60:61], v[60:61], s[34:35] op_sel_hi:[1,0]
  v_pk_mul_f32 v[62:63], v[62:63], s[34:35] op_sel_hi:[1,0]
  v_cvt_pk_bf16_f32 v180, v44, v45
  v_cvt_pk_bf16_f32 v181, v46, v47
  v_cvt_pk_bf16_f32 v182, v60, v61
  v_cvt_pk_bf16_f32 v183, v62, v63
  v_permlane16_swap_b32 v164, v166
  v_permlane16_swap_b32 v165, v167
  v_pk_mul_f32 v[64:65], v[64:65], s[34:35] op_sel_hi:[1,0]
  v_pk_mul_f32 v[66:67], v[66:67], s[34:35] op_sel_hi:[1,0]
  v_pk_mul_f32 v[80:81], v[80:81], s[34:35] op_sel_hi:[1,0]
  v_pk_mul_f32 v[82:83], v[82:83], s[34:35] op_sel_hi:[1,0]
  v_cvt_pk_bf16_f32 v136, v64, v65
  v_cvt_pk_bf16_f32 v137, v66, v67
  v_cvt_pk_bf16_f32 v138, v80, v81
  v_cvt_pk_bf16_f32 v139, v82, v83
  v_permlane16_swap_b32 v180, v182
  v_permlane16_swap_b32 v181, v183
  v_pk_mul_f32 v[68:69], v[68:69], s[34:35] op_sel_hi:[1,0]
  v_pk_mul_f32 v[70:71], v[70:71], s[34:35] op_sel_hi:[1,0]
  v_pk_mul_f32 v[84:85], v[84:85], s[34:35] op_sel_hi:[1,0]
  v_pk_mul_f32 v[86:87], v[86:87], s[34:35] op_sel_hi:[1,0]
  v_cvt_pk_bf16_f32 v152, v68, v69
  v_cvt_pk_bf16_f32 v153, v70, v71
  v_cvt_pk_bf16_f32 v154, v84, v85
  v_cvt_pk_bf16_f32 v155, v86, v87
  v_permlane16_swap_b32 v136, v138
  v_permlane16_swap_b32 v137, v139
  v_pk_mul_f32 v[72:73], v[72:73], s[34:35] op_sel_hi:[1,0]
  v_pk_mul_f32 v[74:75], v[74:75], s[34:35] op_sel_hi:[1,0]
  v_pk_mul_f32 v[88:89], v[88:89], s[34:35] op_sel_hi:[1,0]
  v_pk_mul_f32 v[90:91], v[90:91], s[34:35] op_sel_hi:[1,0]
  v_cvt_pk_bf16_f32 v168, v72, v73
  v_cvt_pk_bf16_f32 v169, v74, v75
  v_cvt_pk_bf16_f32 v170, v88, v89
  v_cvt_pk_bf16_f32 v171, v90, v91
  v_permlane16_swap_b32 v152, v154
  v_permlane16_swap_b32 v153, v155
  v_pk_mul_f32 v[76:77], v[76:77], s[34:35] op_sel_hi:[1,0]
  v_pk_mul_f32 v[78:79], v[78:79], s[34:35] op_sel_hi:[1,0]
  v_pk_mul_f32 v[92:93], v[92:93], s[34:35] op_sel_hi:[1,0]
  v_pk_mul_f32 v[94:95], v[94:95], s[34:35] op_sel_hi:[1,0]
  v_cvt_pk_bf16_f32 v184, v76, v77
  v_cvt_pk_bf16_f32 v185, v78, v79
  v_cvt_pk_bf16_f32 v186, v92, v93
  v_cvt_pk_bf16_f32 v187, v94, v95
  v_permlane16_swap_b32 v168, v170
  v_permlane16_swap_b32 v169, v171
  v_pk_mul_f32 v[96:97], v[96:97], s[34:35] op_sel_hi:[1,0]
  v_pk_mul_f32 v[98:99], v[98:99], s[34:35] op_sel_hi:[1,0]
  v_pk_mul_f32 v[112:113], v[112:113], s[34:35] op_sel_hi:[1,0]
  v_pk_mul_f32 v[114:115], v[114:115], s[34:35] op_sel_hi:[1,0]
  v_cvt_pk_bf16_f32 v140, v96, v97
  v_cvt_pk_bf16_f32 v141, v98, v99
  v_cvt_pk_bf16_f32 v142, v112, v113
  v_cvt_pk_bf16_f32 v143, v114, v115
  v_permlane16_swap_b32 v184, v186
  v_permlane16_swap_b32 v185, v187
  v_pk_mul_f32 v[100:101], v[100:101], s[34:35] op_sel_hi:[1,0]
  v_pk_mul_f32 v[102:103], v[102:103], s[34:35] op_sel_hi:[1,0]
  v_pk_mul_f32 v[116:117], v[116:117], s[34:35] op_sel_hi:[1,0]
  v_pk_mul_f32 v[118:119], v[118:119], s[34:35] op_sel_hi:[1,0]
  v_cvt_pk_bf16_f32 v156, v100, v101
  v_cvt_pk_bf16_f32 v157, v102, v103
  v_cvt_pk_bf16_f32 v158, v116, v117
  v_cvt_pk_bf16_f32 v159, v118, v119
  v_permlane16_swap_b32 v140, v142
  v_permlane16_swap_b32 v141, v143
  v_pk_mul_f32 v[104:105], v[104:105], s[34:35] op_sel_hi:[1,0]
  v_pk_mul_f32 v[106:107], v[106:107], s[34:35] op_sel_hi:[1,0]
  v_pk_mul_f32 v[120:121], v[120:121], s[34:35] op_sel_hi:[1,0]
  v_pk_mul_f32 v[122:123], v[122:123], s[34:35] op_sel_hi:[1,0]
  v_cvt_pk_bf16_f32 v172, v104, v105
  v_cvt_pk_bf16_f32 v173, v106, v107
  v_cvt_pk_bf16_f32 v174, v120, v121
  v_cvt_pk_bf16_f32 v175, v122, v123
  v_permlane16_swap_b32 v156, v158
  v_permlane16_swap_b32 v157, v159
  v_pk_mul_f32 v[108:109], v[108:109], s[34:35] op_sel_hi:[1,0]
  v_pk_mul_f32 v[110:111], v[110:111], s[34:35] op_sel_hi:[1,0]
  v_pk_mul_f32 v[124:125], v[124:125], s[34:35] op_sel_hi:[1,0]
  v_pk_mul_f32 v[126:127], v[126:127], s[34:35] op_sel_hi:[1,0]
  v_cvt_pk_bf16_f32 v188, v108, v109
  v_cvt_pk_bf16_f32 v189, v110, v111
  v_cvt_pk_bf16_f32 v190, v124, v125
  v_cvt_pk_bf16_f32 v191, v126, v127
  v_permlane16_swap_b32 v172, v174
  v_permlane16_swap_b32 v173, v175
  v_permlane16_swap_b32 v188, v190
  v_permlane16_swap_b32 v189, v191
  v_mfma_f32_16x16x32_bf16 v[0:3], a[128:131], v[128:131], 0
  s_add_u32 m0, s28, 81920
  ds_read_b128 a[144:147], v212 offset:4096
  s_mov_b32 s20, s90
  s_mov_b32 s21, s91
  v_mfma_f32_16x16x32_bf16 v[0:3], a[132:135], v[132:135], v[0:3]
  buffer_load_dwordx4 v236, s[16:19], s29 offen offset:0 lds
  s_mov_b32 s22, 2211840
  s_mov_b32 s23, 0x20000
  s_mov_b32 s44, s92
  v_mfma_f32_16x16x32_bf16 v[0:3], a[136:139], v[136:139], v[0:3]
  ds_read_b128 a[148:151], v213 offset:4096
  s_mov_b32 s45, s93
  s_mov_b32 s46, 2211840
  s_mov_b32 s47, 0x20000
  v_lshrrev_b32 v253, 4, v242
  v_mfma_f32_16x16x32_bf16 v[0:3], a[140:143], v[140:143], v[0:3]
  buffer_load_dwordx4 v237, s[16:19], s29 offen offset:1024 lds
  v_mfma_f32_16x16x32_bf16 v[8:11], a[140:143], v[156:159], 0
  ds_read_b128 a[152:155], v214 offset:4096
  v_mul_u32_u24 v253, 0xd80, v253
  v_mfma_f32_16x16x32_bf16 v[8:11], a[136:139], v[152:155], v[8:11]
  buffer_load_dwordx4 v236, s[16:19], s29 offen offset:2048 lds
  s_mul_i32 s35, s3, 552960
  s_lshl_b32 s38, s33, 4
  s_add_u32 s35, s35, s38
  v_mfma_f32_16x16x32_bf16 v[8:11], a[132:135], v[148:151], v[8:11]
  ds_read_b128 a[156:159], v215 offset:4096
  v_mfma_f32_16x16x32_bf16 v[8:11], a[128:131], v[144:147], v[8:11]
  buffer_load_dwordx4 v237, s[16:19], s29 offen offset:3072 lds
  v_mfma_f32_16x16x32_bf16 v[16:19], a[128:131], v[160:163], 0
  s_add_u32 s29, s29, 16384
  s_add_u32 m0, s28, 32768
  v_mfma_f32_16x16x32_bf16 v[16:19], a[132:135], v[164:167], v[16:19]
  buffer_load_dwordx4 v232, s[12:15], s29 offen offset:0 lds
  v_mfma_f32_16x16x32_bf16 v[16:19], a[136:139], v[168:171], v[16:19]
  buffer_load_dwordx4 v233, s[12:15], s29 offen offset:1024 lds
  v_mfma_f32_16x16x32_bf16 v[16:19], a[140:143], v[172:175], v[16:19]
  v_max3_f32 v192, v0, v1, v2
  v_max3_f32 v196, v8, v9, v10
  v_mfma_f32_16x16x32_bf16 v[24:27], a[140:143], v[188:191], 0
  v_max_f32 v192, v192, v3
  v_max_f32 v196, v196, v11
  v_mfma_f32_16x16x32_bf16 v[24:27], a[136:139], v[184:187], v[24:27]
  v_mov_b32 v245, v192
  v_mov_b32 v246, v196
  v_mfma_f32_16x16x32_bf16 v[24:27], a[132:135], v[180:183], v[24:27]
  v_permlane16_swap_b32 v192, v245
  v_permlane16_swap_b32 v196, v246
  v_mfma_f32_16x16x32_bf16 v[24:27], a[128:131], v[176:179], v[24:27]
  s_waitcnt lgkmcnt(0)
  v_max_f32 v192, v192, v245
  v_max_f32 v196, v196, v246
  v_mfma_f32_16x16x32_bf16 v[4:7], a[144:147], v[128:131], 0
  ds_read_b128 a[128:131], v212 offset:8192
  v_mov_b32 v245, v192
  v_mfma_f32_16x16x32_bf16 v[4:7], a[148:151], v[132:135], v[4:7]
  v_mov_b32 v246, v196
  v_permlane32_swap_b32 v192, v245
  v_mfma_f32_16x16x32_bf16 v[4:7], a[152:155], v[136:139], v[4:7]
  ds_read_b128 a[132:135], v213 offset:8192
  v_permlane32_swap_b32 v196, v246
  v_mfma_f32_16x16x32_bf16 v[4:7], a[156:159], v[140:143], v[4:7]
  v_max_f32 v192, v192, v245
  v_max_f32 v196, v196, v246
  v_mfma_f32_16x16x32_bf16 v[12:15], a[156:159], v[156:159], 0
  ds_read_b128 a[136:139], v214 offset:8192
  v_sub_f32 v193, 0, v192
  v_mfma_f32_16x16x32_bf16 v[12:15], a[152:155], v[152:155], v[12:15]
  v_sub_f32 v197, 0, v196
  v_sub_f32 v194, 0, v192
  v_mfma_f32_16x16x32_bf16 v[12:15], a[148:151], v[148:151], v[12:15]
  ds_read_b128 a[140:143], v215 offset:8192
  v_sub_f32 v198, 0, v196
  v_mfma_f32_16x16x32_bf16 v[12:15], a[144:147], v[144:147], v[12:15]
  v_sub_f32 v195, 0, v192
  v_sub_f32 v199, 0, v196
  v_mfma_f32_16x16x32_bf16 v[20:23], a[144:147], v[160:163], 0
  buffer_load_dwordx4 v234, s[12:15], s29 offen offset:2048 lds
  v_mfma_f32_16x16x32_bf16 v[20:23], a[148:151], v[164:167], v[20:23]
  v_sub_f32 v192, 0, v192
  v_sub_f32 v196, 0, v196
  v_mfma_f32_16x16x32_bf16 v[20:23], a[152:155], v[168:171], v[20:23]
  buffer_load_dwordx4 v235, s[12:15], s29 offen offset:3072 lds
  v_mfma_f32_16x16x32_bf16 v[20:23], a[156:159], v[172:175], v[20:23]
  v_max3_f32 v200, v16, v17, v18
  v_max3_f32 v204, v24, v25, v26
  v_mfma_f32_16x16x32_bf16 v[28:31], a[156:159], v[188:191], 0
  v_max_f32 v200, v200, v19
  v_max_f32 v204, v204, v27
  v_mfma_f32_16x16x32_bf16 v[28:31], a[152:155], v[184:187], v[28:31]
  v_mov_b32 v247, v200
  v_mov_b32 v248, v204
  v_mfma_f32_16x16x32_bf16 v[28:31], a[148:151], v[180:183], v[28:31]
  v_permlane16_swap_b32 v200, v247
  v_permlane16_swap_b32 v204, v248
  v_max_f32 v200, v200, v247
  v_max_f32 v204, v204, v248
  v_mov_b32 v247, v200
  v_mov_b32 v248, v204
  s_nop 0
  v_permlane32_swap_b32 v200, v247
  v_permlane32_swap_b32 v204, v248
  v_max_f32 v200, v200, v247
  v_max_f32 v204, v204, v248
  v_sub_f32 v201, 0, v200
  v_sub_f32 v205, 0, v204
  v_sub_f32 v202, 0, v200
  v_sub_f32 v206, 0, v204
  v_sub_f32 v203, 0, v200
  v_sub_f32 v207, 0, v204
  v_sub_f32 v200, 0, v200
  v_sub_f32 v204, 0, v204
  v_mfma_f32_16x16x32_bf16 v[28:31], a[144:147], v[176:179], v[28:31]
  s_waitcnt lgkmcnt(0)
  v_add_f32 v0, v192, v0
  v_add_f32 v1, v192, v1
  v_mfma_f32_16x16x32_bf16 v[32:35], a[128:131], v[128:131], v[192:195]
  ds_read_b128 a[144:147], v212 offset:12288
  v_add_f32 v2, v192, v2
  v_mfma_f32_16x16x32_bf16 v[32:35], a[132:135], v[132:135], v[32:35]
  v_add_f32 v3, v192, v3
  v_mfma_f32_16x16x32_bf16 v[32:35], a[136:139], v[136:139], v[32:35]
  ds_read_b128 a[148:151], v213 offset:12288
  v_mfma_f32_16x16x32_bf16 v[32:35], a[140:143], v[140:143], v[32:35]
  v_exp_f32 v0, v0
  v_mfma_f32_16x16x32_bf16 v[40:43], a[140:143], v[156:159], v[196:199]
  ds_read_b128 a[152:155], v214 offset:12288
  v_mfma_f32_16x16x32_bf16 v[40:43], a[136:139], v[152:155], v[40:43]
  v_exp_f32 v1, v1
  v_mfma_f32_16x16x32_bf16 v[40:43], a[132:135], v[148:151], v[40:43]
  ds_read_b128 a[156:159], v215 offset:12288
  v_mfma_f32_16x16x32_bf16 v[40:43], a[128:131], v[144:147], v[40:43]
  v_exp_f32 v2, v2
  v_mfma_f32_16x16x32_bf16 v[48:51], a[128:131], v[160:163], v[200:203]
  s_add_u32 m0, s50, 0
  v_cvt_pk_bf16_f32 v0, v0, v1
  v_mfma_f32_16x16x32_bf16 v[48:51], a[132:135], v[164:167], v[48:51]
  v_exp_f32 v3, v3
  v_mfma_f32_16x16x32_bf16 v[48:51], a[136:139], v[168:171], v[48:51]
  v_add_f32 v8, v196, v8
  v_add_f32 v9, v196, v9
  v_mfma_f32_16x16x32_bf16 v[48:51], a[140:143], v[172:175], v[48:51]
  v_add_f32 v10, v196, v10
  v_add_f32 v11, v196, v11
  v_mfma_f32_16x16x32_bf16 v[56:59], a[140:143], v[188:191], v[204:207]
  v_exp_f32 v8, v8
  v_mfma_f32_16x16x32_bf16 v[56:59], a[136:139], v[184:187], v[56:59]
  v_exp_f32 v9, v9
  buffer_load_dwordx4 v253, s[20:23], s35 offen lds
  v_mfma_f32_16x16x32_bf16 v[56:59], a[132:135], v[180:183], v[56:59]
  v_exp_f32 v10, v10
  v_mfma_f32_16x16x32_bf16 v[56:59], a[128:131], v[176:179], v[56:59]
  s_waitcnt lgkmcnt(0)
  v_cvt_pk_bf16_f32 v8, v8, v9
  v_mfma_f32_16x16x32_bf16 v[36:39], a[144:147], v[128:131], v[192:195]
  s_waitcnt vmcnt(9)
  v_exp_f32 v11, v11
  v_mfma_f32_16x16x32_bf16 v[36:39], a[148:151], v[132:135], v[36:39]
  s_barrier
  v_cvt_pk_bf16_f32 v1, v2, v3
  v_add_f32 v16, v200, v16
  v_mfma_f32_16x16x32_bf16 v[36:39], a[152:155], v[136:139], v[36:39]
  ds_read_b128 a[128:131], v212 offset:16384
  v_add_f32 v17, v200, v17
  v_mfma_f32_16x16x32_bf16 v[36:39], a[156:159], v[140:143], v[36:39]
  v_add_f32 v18, v200, v18
  v_add_f32 v19, v200, v19
  v_mfma_f32_16x16x32_bf16 v[44:47], a[156:159], v[156:159], v[196:199]
  ds_read_b128 a[132:135], v213 offset:16384
  v_mfma_f32_16x16x32_bf16 v[44:47], a[152:155], v[152:155], v[44:47]
  v_exp_f32 v16, v16
  v_mfma_f32_16x16x32_bf16 v[44:47], a[148:151], v[148:151], v[44:47]
  ds_read_b128 a[136:139], v214 offset:16384
  v_mfma_f32_16x16x32_bf16 v[44:47], a[144:147], v[144:147], v[44:47]
  v_exp_f32 v17, v17
  v_mfma_f32_16x16x32_bf16 v[52:55], a[144:147], v[160:163], v[200:203]
  ds_read_b128 a[140:143], v215 offset:16384
  v_mfma_f32_16x16x32_bf16 v[52:55], a[148:151], v[164:167], v[52:55]
  v_exp_f32 v18, v18
  v_mfma_f32_16x16x32_bf16 v[52:55], a[152:155], v[168:171], v[52:55]
  v_cvt_pk_bf16_f32 v16, v16, v17
  v_mfma_f32_16x16x32_bf16 v[52:55], a[156:159], v[172:175], v[52:55]
  v_exp_f32 v19, v19
  v_mfma_f32_16x16x32_bf16 v[60:63], a[156:159], v[188:191], v[204:207]
  v_cvt_pk_bf16_f32 v9, v10, v11
  v_add_f32 v24, v204, v24
  v_mfma_f32_16x16x32_bf16 v[60:63], a[152:155], v[184:187], v[60:63]
  v_add_f32 v25, v204, v25
  v_add_f32 v26, v204, v26
  v_mfma_f32_16x16x32_bf16 v[60:63], a[148:151], v[180:183], v[60:63]
  v_add_f32 v27, v204, v27
  v_mfma_f32_16x16x32_bf16 v[60:63], a[144:147], v[176:179], v[60:63]
  s_waitcnt lgkmcnt(0)
  v_exp_f32 v24, v24
  v_exp_f32 v25, v25
  v_exp_f32 v26, v26
  v_cvt_pk_bf16_f32 v24, v24, v25
  v_exp_f32 v27, v27
  v_cvt_pk_bf16_f32 v17, v18, v19
  v_add_f32 v4, v192, v4
  v_add_f32 v5, v192, v5
  v_add_f32 v6, v192, v6
  v_add_f32 v7, v192, v7
  v_exp_f32 v4, v4
  v_exp_f32 v5, v5
  v_exp_f32 v6, v6
  v_cvt_pk_bf16_f32 v2, v4, v5
  v_exp_f32 v7, v7
  v_cvt_pk_bf16_f32 v25, v26, v27
  v_add_f32 v12, v196, v12
  v_add_f32 v13, v196, v13
  v_add_f32 v14, v196, v14
  v_add_f32 v15, v196, v15
  v_exp_f32 v12, v12
  v_exp_f32 v13, v13
  v_exp_f32 v14, v14
  v_cvt_pk_bf16_f32 v10, v12, v13
  v_exp_f32 v15, v15
  v_cvt_pk_bf16_f32 v3, v6, v7
  v_add_f32 v20, v200, v20
  v_add_f32 v21, v200, v21
  v_add_f32 v22, v200, v22
  v_add_f32 v23, v200, v23
  v_exp_f32 v20, v20
  v_exp_f32 v21, v21
  v_exp_f32 v22, v22
  v_cvt_pk_bf16_f32 v18, v20, v21
  v_exp_f32 v23, v23
  v_cvt_pk_bf16_f32 v11, v14, v15
  v_add_f32 v28, v204, v28
  v_add_f32 v29, v204, v29
  v_add_f32 v30, v204, v30
  v_add_f32 v31, v204, v31
  v_exp_f32 v28, v28
  v_exp_f32 v29, v29
  v_exp_f32 v30, v30
  v_cvt_pk_bf16_f32 v26, v28, v29
  v_exp_f32 v31, v31
  v_cvt_pk_bf16_f32 v19, v22, v23
  v_exp_f32 v32, v32
  v_exp_f32 v33, v33
  v_exp_f32 v34, v34
  v_cvt_pk_bf16_f32 v32, v32, v33
  v_exp_f32 v35, v35
  v_cvt_pk_bf16_f32 v27, v30, v31
  v_exp_f32 v40, v40
  v_exp_f32 v41, v41
  v_exp_f32 v42, v42
  v_cvt_pk_bf16_f32 v40, v40, v41
  v_exp_f32 v43, v43
  v_cvt_pk_bf16_f32 v33, v34, v35
  v_exp_f32 v48, v48
  v_exp_f32 v49, v49
  v_exp_f32 v50, v50
  v_cvt_pk_bf16_f32 v48, v48, v49
  v_exp_f32 v51, v51
  v_cvt_pk_bf16_f32 v41, v42, v43
  v_exp_f32 v56, v56
  v_exp_f32 v57, v57
  v_exp_f32 v58, v58
  v_cvt_pk_bf16_f32 v56, v56, v57
  v_exp_f32 v59, v59
  v_cvt_pk_bf16_f32 v49, v50, v51
  v_exp_f32 v36, v36
  v_exp_f32 v37, v37
  v_exp_f32 v38, v38
  v_cvt_pk_bf16_f32 v34, v36, v37
  v_exp_f32 v39, v39
  v_cvt_pk_bf16_f32 v57, v58, v59
  v_exp_f32 v44, v44
  v_exp_f32 v45, v45
  v_exp_f32 v46, v46
  v_cvt_pk_bf16_f32 v42, v44, v45
  v_exp_f32 v47, v47
  v_cvt_pk_bf16_f32 v35, v38, v39
  v_exp_f32 v52, v52
  v_exp_f32 v53, v53
  v_exp_f32 v54, v54
  v_cvt_pk_bf16_f32 v50, v52, v53
  v_exp_f32 v55, v55
  v_cvt_pk_bf16_f32 v43, v46, v47
  v_exp_f32 v60, v60
  v_exp_f32 v61, v61
  v_exp_f32 v62, v62
  v_cvt_pk_bf16_f32 v58, v60, v61
  v_exp_f32 v63, v63
  v_cvt_pk_bf16_f32 v51, v54, v55
  v_cvt_pk_bf16_f32 v59, v62, v63
  v_mfma_f32_16x16x32_bf16 v[64:67], a[128:131], v[128:131], v[192:195]
  s_add_u32 m0, s28, 98304
  v_mfma_f32_16x16x32_bf16 v[64:67], a[132:135], v[132:135], v[64:67]
  ds_read_b128 a[144:147], v212 offset:20480
  v_mfma_f32_16x16x32_bf16 v[64:67], a[136:139], v[136:139], v[64:67]
  buffer_load_dwordx4 v236, s[16:19], s29 offen offset:0 lds
  v_mfma_f32_16x16x32_bf16 v[64:67], a[140:143], v[140:143], v[64:67]
  ds_read_b128 a[148:151], v213 offset:20480
  v_mfma_f32_16x16x32_bf16 v[72:75], a[140:143], v[156:159], v[196:199]
  v_mfma_f32_16x16x32_bf16 v[72:75], a[136:139], v[152:155], v[72:75]
  ds_read_b128 a[152:155], v214 offset:20480
  v_mfma_f32_16x16x32_bf16 v[72:75], a[132:135], v[148:151], v[72:75]
  buffer_load_dwordx4 v237, s[16:19], s29 offen offset:1024 lds
  v_mfma_f32_16x16x32_bf16 v[72:75], a[128:131], v[144:147], v[72:75]
  ds_read_b128 a[156:159], v215 offset:20480
  v_mfma_f32_16x16x32_bf16 v[80:83], a[128:131], v[160:163], v[200:203]
  v_exp_f32 v64, v64
  v_mfma_f32_16x16x32_bf16 v[80:83], a[132:135], v[164:167], v[80:83]
  v_mfma_f32_16x16x32_bf16 v[80:83], a[136:139], v[168:171], v[80:83]
  v_exp_f32 v65, v65
  v_mfma_f32_16x16x32_bf16 v[80:83], a[140:143], v[172:175], v[80:83]
  v_cvt_pk_bf16_f32 v64, v64, v65
  v_mfma_f32_16x16x32_bf16 v[88:91], a[140:143], v[188:191], v[204:207]
  v_exp_f32 v66, v66
  v_mfma_f32_16x16x32_bf16 v[88:91], a[136:139], v[184:187], v[88:91]
  buffer_load_dwordx4 v236, s[16:19], s29 offen offset:2048 lds
  v_mfma_f32_16x16x32_bf16 v[88:91], a[132:135], v[180:183], v[88:91]
  s_waitcnt lgkmcnt(0)
  v_exp_f32 v67, v67
  v_mfma_f32_16x16x32_bf16 v[88:91], a[128:131], v[176:179], v[88:91]
  v_cvt_pk_bf16_f32 v65, v66, v67
  v_mfma_f32_16x16x32_bf16 v[68:71], a[144:147], v[128:131], v[192:195]
  v_exp_f32 v72, v72
  v_mfma_f32_16x16x32_bf16 v[68:71], a[148:151], v[132:135], v[68:71]
  ds_read_b128 a[128:131], v212 offset:24576
  v_mfma_f32_16x16x32_bf16 v[68:71], a[152:155], v[136:139], v[68:71]
  v_exp_f32 v73, v73
  v_mfma_f32_16x16x32_bf16 v[68:71], a[156:159], v[140:143], v[68:71]
  ds_read_b128 a[132:135], v213 offset:24576
  v_cvt_pk_bf16_f32 v72, v72, v73
  v_mfma_f32_16x16x32_bf16 v[76:79], a[156:159], v[156:159], v[196:199]
  v_exp_f32 v74, v74
  v_mfma_f32_16x16x32_bf16 v[76:79], a[152:155], v[152:155], v[76:79]
  ds_read_b128 a[136:139], v214 offset:24576
  v_mfma_f32_16x16x32_bf16 v[76:79], a[148:151], v[148:151], v[76:79]
  v_exp_f32 v75, v75
  v_mfma_f32_16x16x32_bf16 v[76:79], a[144:147], v[144:147], v[76:79]
  ds_read_b128 a[140:143], v215 offset:24576
  v_cvt_pk_bf16_f32 v73, v74, v75
  v_mfma_f32_16x16x32_bf16 v[84:87], a[144:147], v[160:163], v[200:203]
  v_exp_f32 v80, v80
  v_mfma_f32_16x16x32_bf16 v[84:87], a[148:151], v[164:167], v[84:87]
  buffer_load_dwordx4 v237, s[16:19], s29 offen offset:3072 lds
  v_mfma_f32_16x16x32_bf16 v[84:87], a[152:155], v[168:171], v[84:87]
  s_add_u32 s29, s29, 16384
  v_exp_f32 v81, v81
  v_mfma_f32_16x16x32_bf16 v[84:87], a[156:159], v[172:175], v[84:87]
  v_cvt_pk_bf16_f32 v80, v80, v81
  v_mfma_f32_16x16x32_bf16 v[92:95], a[156:159], v[188:191], v[204:207]
  s_add_u32 m0, s28, 49152
  v_exp_f32 v82, v82
  v_mfma_f32_16x16x32_bf16 v[92:95], a[152:155], v[184:187], v[92:95]
  buffer_load_dwordx4 v232, s[12:15], s29 offen offset:0 lds
  v_mfma_f32_16x16x32_bf16 v[92:95], a[148:151], v[180:183], v[92:95]
  s_waitcnt lgkmcnt(0)
  v_exp_f32 v83, v83
  v_mfma_f32_16x16x32_bf16 v[92:95], a[144:147], v[176:179], v[92:95]
  v_cvt_pk_bf16_f32 v81, v82, v83
  v_mfma_f32_16x16x32_bf16 v[96:99], a[128:131], v[128:131], v[192:195]
  v_exp_f32 v88, v88
  v_mfma_f32_16x16x32_bf16 v[96:99], a[132:135], v[132:135], v[96:99]
  ds_read_b128 a[144:147], v212 offset:28672
  v_mfma_f32_16x16x32_bf16 v[96:99], a[136:139], v[136:139], v[96:99]
  v_exp_f32 v89, v89
  v_mfma_f32_16x16x32_bf16 v[96:99], a[140:143], v[140:143], v[96:99]
  ds_read_b128 a[148:151], v213 offset:28672
  v_cvt_pk_bf16_f32 v88, v88, v89
  v_mfma_f32_16x16x32_bf16 v[104:107], a[140:143], v[156:159], v[196:199]
  v_exp_f32 v90, v90
  v_mfma_f32_16x16x32_bf16 v[104:107], a[136:139], v[152:155], v[104:107]
  ds_read_b128 a[152:155], v214 offset:28672
  v_mfma_f32_16x16x32_bf16 v[104:107], a[132:135], v[148:151], v[104:107]
  v_exp_f32 v91, v91
  v_mfma_f32_16x16x32_bf16 v[104:107], a[128:131], v[144:147], v[104:107]
  ds_read_b128 a[156:159], v215 offset:28672
  v_cvt_pk_bf16_f32 v89, v90, v91
  v_mfma_f32_16x16x32_bf16 v[112:115], a[128:131], v[160:163], v[200:203]
  v_exp_f32 v68, v68
  v_mfma_f32_16x16x32_bf16 v[112:115], a[132:135], v[164:167], v[112:115]
  buffer_load_dwordx4 v233, s[12:15], s29 offen offset:1024 lds
  v_mfma_f32_16x16x32_bf16 v[112:115], a[136:139], v[168:171], v[112:115]
  v_exp_f32 v69, v69
  v_mfma_f32_16x16x32_bf16 v[112:115], a[140:143], v[172:175], v[112:115]
  v_cvt_pk_bf16_f32 v66, v68, v69
  v_mfma_f32_16x16x32_bf16 v[120:123], a[140:143], v[188:191], v[204:207]
  v_exp_f32 v70, v70
  v_mfma_f32_16x16x32_bf16 v[120:123], a[136:139], v[184:187], v[120:123]
  buffer_load_dwordx4 v234, s[12:15], s29 offen offset:2048 lds
  v_mfma_f32_16x16x32_bf16 v[120:123], a[132:135], v[180:183], v[120:123]
  s_waitcnt lgkmcnt(0)
  v_exp_f32 v71, v71
  v_mfma_f32_16x16x32_bf16 v[120:123], a[128:131], v[176:179], v[120:123]
  v_cvt_pk_bf16_f32 v67, v70, v71
  v_mfma_f32_16x16x32_bf16 v[100:103], a[144:147], v[128:131], v[192:195]
  v_exp_f32 v76, v76
  v_mfma_f32_16x16x32_bf16 v[100:103], a[148:151], v[132:135], v[100:103]
  ds_read_b64_tr_b16 a[160:161], v216 offset:0
  v_mfma_f32_16x16x32_bf16 v[100:103], a[152:155], v[136:139], v[100:103]
  v_exp_f32 v77, v77
  v_mfma_f32_16x16x32_bf16 v[100:103], a[156:159], v[140:143], v[100:103]
  ds_read_b64_tr_b16 a[162:163], v216 offset:4096
  v_cvt_pk_bf16_f32 v74, v76, v77
  v_mfma_f32_16x16x32_bf16 v[108:111], a[156:159], v[156:159], v[196:199]
  v_exp_f32 v78, v78
  v_mfma_f32_16x16x32_bf16 v[108:111], a[152:155], v[152:155], v[108:111]
  ds_read_b64_tr_b16 a[164:165], v216 offset:8192
  buffer_load_dwordx4 v235, s[12:15], s29 offen offset:3072 lds
  v_mfma_f32_16x16x32_bf16 v[108:111], a[148:151], v[148:151], v[108:111]
  v_exp_f32 v79, v79
  v_mfma_f32_16x16x32_bf16 v[108:111], a[144:147], v[144:147], v[108:111]
  ds_read_b64_tr_b16 a[166:167], v216 offset:12288
  v_cvt_pk_bf16_f32 v75, v78, v79
  v_mfma_f32_16x16x32_bf16 v[116:119], a[144:147], v[160:163], v[200:203]
  v_exp_f32 v84, v84
  v_mfma_f32_16x16x32_bf16 v[116:119], a[148:151], v[164:167], v[116:119]
  ds_read_b64_tr_b16 a[168:169], v217 offset:0
  s_add_u32 m0, s50, 3072
  v_mfma_f32_16x16x32_bf16 v[116:119], a[152:155], v[168:171], v[116:119]
  v_exp_f32 v85, v85
  v_mfma_f32_16x16x32_bf16 v[116:119], a[156:159], v[172:175], v[116:119]
  ds_read_b64_tr_b16 a[170:171], v217 offset:4096
  v_cvt_pk_bf16_f32 v82, v84, v85
  v_mfma_f32_16x16x32_bf16 v[124:127], a[156:159], v[188:191], v[204:207]
  v_exp_f32 v86, v86
  v_mfma_f32_16x16x32_bf16 v[124:127], a[152:155], v[184:187], v[124:127]
  ds_read_b64_tr_b16 a[172:173], v217 offset:8192
  buffer_load_dwordx4 v253, s[44:47], s35 offen lds
  s_add_u32 s35, s35, 221184
  v_mfma_f32_16x16x32_bf16 v[124:127], a[148:151], v[180:183], v[124:127]
  v_exp_f32 v87, v87
  v_mfma_f32_16x16x32_bf16 v[124:127], a[144:147], v[176:179], v[124:127]
  ds_read_b64_tr_b16 a[174:175], v217 offset:12288
  v_cvt_pk_bf16_f32 v83, v86, v87
  v_mfma_f32_16x16x32_bf16 a[192:195], a[208:211], v[0:3], 0
  v_exp_f32 v92, v92
  v_mfma_f32_16x16x32_bf16 a[192:195], a[208:211], v[32:35], a[192:195]
  ds_read_b64_tr_b16 a[176:177], v218 offset:0
  v_mfma_f32_16x16x32_bf16 a[196:199], a[208:211], v[8:11], 0
  v_exp_f32 v93, v93
  v_mfma_f32_16x16x32_bf16 a[196:199], a[208:211], v[40:43], a[196:199]
  ds_read_b64_tr_b16 a[178:179], v218 offset:4096
  v_cvt_pk_bf16_f32 v90, v92, v93
  v_mfma_f32_16x16x32_bf16 a[200:203], a[208:211], v[16:19], 0
  v_exp_f32 v94, v94
  v_mfma_f32_16x16x32_bf16 a[200:203], a[208:211], v[48:51], a[200:203]
  ds_read_b64_tr_b16 a[180:181], v218 offset:8192
  v_mfma_f32_16x16x32_bf16 a[204:207], a[208:211], v[24:27], 0
  s_waitcnt lgkmcnt(7)
  v_exp_f32 v95, v95
  v_mfma_f32_16x16x32_bf16 a[204:207], a[208:211], v[56:59], a[204:207]
  ds_read_b64_tr_b16 a[182:183], v218 offset:12288
  v_cvt_pk_bf16_f32 v91, v94, v95
  v_mfma_f32_16x16x32_bf16 a[0:3], a[160:163], v[0:3], 0
  v_exp_f32 v96, v96
  v_mfma_f32_16x16x32_bf16 a[0:3], a[164:167], v[32:35], a[0:3]
  ds_read_b64_tr_b16 a[184:185], v219 offset:0
  v_mfma_f32_16x16x32_bf16 a[4:7], a[164:167], v[40:43], 0
  v_exp_f32 v97, v97
  v_mfma_f32_16x16x32_bf16 a[4:7], a[160:163], v[8:11], a[4:7]
  ds_read_b64_tr_b16 a[186:187], v219 offset:4096
  v_cvt_pk_bf16_f32 v96, v96, v97
  v_mfma_f32_16x16x32_bf16 a[8:11], a[160:163], v[16:19], 0
  v_exp_f32 v98, v98
  v_mfma_f32_16x16x32_bf16 a[8:11], a[164:167], v[48:51], a[8:11]
  ds_read_b64_tr_b16 a[188:189], v219 offset:8192
  v_mfma_f32_16x16x32_bf16 a[12:15], a[164:167], v[56:59], 0
  s_waitcnt lgkmcnt(7)
  v_exp_f32 v99, v99
  v_mfma_f32_16x16x32_bf16 a[12:15], a[160:163], v[24:27], a[12:15]
  ds_read_b64_tr_b16 a[190:191], v219 offset:12288
  v_cvt_pk_bf16_f32 v97, v98, v99
  v_mfma_f32_16x16x32_bf16 a[16:19], a[168:171], v[0:3], 0
  v_exp_f32 v104, v104
  v_mfma_f32_16x16x32_bf16 a[16:19], a[172:175], v[32:35], a[16:19]
  ds_read_b64_tr_b16 a[160:161], v220 offset:0
  v_mfma_f32_16x16x32_bf16 a[20:23], a[172:175], v[40:43], 0
  v_exp_f32 v105, v105
  v_mfma_f32_16x16x32_bf16 a[20:23], a[168:171], v[8:11], a[20:23]
  ds_read_b64_tr_b16 a[162:163], v220 offset:4096
  v_cvt_pk_bf16_f32 v104, v104, v105
  v_mfma_f32_16x16x32_bf16 a[24:27], a[168:171], v[16:19], 0
  v_exp_f32 v106, v106
  v_mfma_f32_16x16x32_bf16 a[24:27], a[172:175], v[48:51], a[24:27]
  ds_read_b64_tr_b16 a[164:165], v220 offset:8192
  v_mfma_f32_16x16x32_bf16 a[28:31], a[172:175], v[56:59], 0
  s_waitcnt lgkmcnt(7)
  v_exp_f32 v107, v107
  v_mfma_f32_16x16x32_bf16 a[28:31], a[168:171], v[24:27], a[28:31]
  ds_read_b64_tr_b16 a[166:167], v220 offset:12288
  v_cvt_pk_bf16_f32 v105, v106, v107
  v_mfma_f32_16x16x32_bf16 a[32:35], a[176:179], v[0:3], 0
  v_exp_f32 v112, v112
  v_mfma_f32_16x16x32_bf16 a[32:35], a[180:183], v[32:35], a[32:35]
  ds_read_b64_tr_b16 a[168:169], v221 offset:0
  v_mfma_f32_16x16x32_bf16 a[36:39], a[180:183], v[40:43], 0
  v_exp_f32 v113, v113
  v_mfma_f32_16x16x32_bf16 a[36:39], a[176:179], v[8:11], a[36:39]
  ds_read_b64_tr_b16 a[170:171], v221 offset:4096
  v_cvt_pk_bf16_f32 v112, v112, v113
  v_mfma_f32_16x16x32_bf16 a[40:43], a[176:179], v[16:19], 0
  v_exp_f32 v114, v114
  v_mfma_f32_16x16x32_bf16 a[40:43], a[180:183], v[48:51], a[40:43]
  ds_read_b64_tr_b16 a[172:173], v221 offset:8192
  v_mfma_f32_16x16x32_bf16 a[44:47], a[180:183], v[56:59], 0
  s_waitcnt lgkmcnt(7)
  v_exp_f32 v115, v115
  v_mfma_f32_16x16x32_bf16 a[44:47], a[176:179], v[24:27], a[44:47]
  ds_read_b64_tr_b16 a[174:175], v221 offset:12288
  v_cvt_pk_bf16_f32 v113, v114, v115
  v_mfma_f32_16x16x32_bf16 a[48:51], a[184:187], v[0:3], 0
  v_exp_f32 v120, v120
  v_mfma_f32_16x16x32_bf16 a[48:51], a[188:191], v[32:35], a[48:51]
  ds_read_b64_tr_b16 a[176:177], v222 offset:0
  v_mfma_f32_16x16x32_bf16 a[52:55], a[188:191], v[40:43], 0
  v_exp_f32 v121, v121
  v_mfma_f32_16x16x32_bf16 a[52:55], a[184:187], v[8:11], a[52:55]
  ds_read_b64_tr_b16 a[178:179], v222 offset:4096
  v_cvt_pk_bf16_f32 v120, v120, v121
  v_mfma_f32_16x16x32_bf16 a[56:59], a[184:187], v[16:19], 0
  v_exp_f32 v122, v122
  v_mfma_f32_16x16x32_bf16 a[56:59], a[188:191], v[48:51], a[56:59]
  ds_read_b64_tr_b16 a[180:181], v222 offset:8192
  v_mfma_f32_16x16x32_bf16 a[60:63], a[188:191], v[56:59], 0
  s_waitcnt lgkmcnt(7)
  v_exp_f32 v123, v123
  v_mfma_f32_16x16x32_bf16 a[60:63], a[184:187], v[24:27], a[60:63]
  ds_read_b64_tr_b16 a[182:183], v222 offset:12288
  v_cvt_pk_bf16_f32 v121, v122, v123
  v_mfma_f32_16x16x32_bf16 a[64:67], a[160:163], v[0:3], 0
  v_exp_f32 v100, v100
  v_mfma_f32_16x16x32_bf16 a[64:67], a[164:167], v[32:35], a[64:67]
  ds_read_b64_tr_b16 a[184:185], v223 offset:0
  v_mfma_f32_16x16x32_bf16 a[68:71], a[164:167], v[40:43], 0
  v_exp_f32 v101, v101
  v_mfma_f32_16x16x32_bf16 a[68:71], a[160:163], v[8:11], a[68:71]
  ds_read_b64_tr_b16 a[186:187], v223 offset:4096
  v_cvt_pk_bf16_f32 v98, v100, v101
  v_mfma_f32_16x16x32_bf16 a[72:75], a[160:163], v[16:19], 0
  v_exp_f32 v102, v102
  v_mfma_f32_16x16x32_bf16 a[72:75], a[164:167], v[48:51], a[72:75]
  ds_read_b64_tr_b16 a[188:189], v223 offset:8192
  v_mfma_f32_16x16x32_bf16 a[76:79], a[164:167], v[56:59], 0
  s_waitcnt lgkmcnt(7)
  v_exp_f32 v103, v103
  v_mfma_f32_16x16x32_bf16 a[76:79], a[160:163], v[24:27], a[76:79]
  ds_read_b64_tr_b16 a[190:191], v223 offset:12288
  v_cvt_pk_bf16_f32 v99, v102, v103
  v_mfma_f32_16x16x32_bf16 a[80:83], a[168:171], v[0:3], 0
  s_waitcnt vmcnt(10)
  v_exp_f32 v108, v108
  v_mfma_f32_16x16x32_bf16 a[80:83], a[172:175], v[32:35], a[80:83]
  v_mfma_f32_16x16x32_bf16 a[84:87], a[172:175], v[40:43], 0
  s_barrier
  v_exp_f32 v109, v109
  v_mfma_f32_16x16x32_bf16 a[84:87], a[168:171], v[8:11], a[84:87]
  ds_read_b128 a[128:131], v212 offset:32768
  v_cvt_pk_bf16_f32 v106, v108, v109
  v_mfma_f32_16x16x32_bf16 a[88:91], a[168:171], v[16:19], 0
  v_exp_f32 v110, v110
  v_mfma_f32_16x16x32_bf16 a[88:91], a[172:175], v[48:51], a[88:91]
  ds_read_b128 a[132:135], v213 offset:32768
  v_mfma_f32_16x16x32_bf16 a[92:95], a[172:175], v[56:59], 0
  s_waitcnt lgkmcnt(6)
  v_exp_f32 v111, v111
  v_mfma_f32_16x16x32_bf16 a[92:95], a[168:171], v[24:27], a[92:95]
  ds_read_b128 a[136:139], v214 offset:32768
  v_cvt_pk_bf16_f32 v107, v110, v111
  v_mfma_f32_16x16x32_bf16 a[96:99], a[176:179], v[0:3], 0
  s_mul_i32 s38, s3, 20480
  v_exp_f32 v116, v116
  v_mfma_f32_16x16x32_bf16 a[96:99], a[180:183], v[32:35], a[96:99]
  ds_read_b128 a[140:143], v215 offset:32768
  buffer_load_dwordx4 a[212:215], v243, s[24:27], s38 offen sc1
  s_add_u32 s38, s38, 4096
  v_mfma_f32_16x16x32_bf16 a[100:103], a[180:183], v[40:43], 0
  v_exp_f32 v117, v117
  v_mfma_f32_16x16x32_bf16 a[100:103], a[176:179], v[8:11], a[100:103]
  v_cvt_pk_bf16_f32 v114, v116, v117
  v_mfma_f32_16x16x32_bf16 a[104:107], a[176:179], v[16:19], 0
  v_exp_f32 v118, v118
  v_mfma_f32_16x16x32_bf16 a[104:107], a[180:183], v[48:51], a[104:107]
  v_mfma_f32_16x16x32_bf16 a[108:111], a[180:183], v[56:59], 0
  s_waitcnt lgkmcnt(4)
  v_exp_f32 v119, v119
  v_mfma_f32_16x16x32_bf16 a[108:111], a[176:179], v[24:27], a[108:111]
  v_cvt_pk_bf16_f32 v115, v118, v119
  v_mfma_f32_16x16x32_bf16 a[112:115], a[184:187], v[0:3], 0
  v_exp_f32 v124, v124
  v_mfma_f32_16x16x32_bf16 a[112:115], a[188:191], v[32:35], a[112:115]
  v_mfma_f32_16x16x32_bf16 a[116:119], a[188:191], v[40:43], 0
  v_exp_f32 v125, v125
  v_mfma_f32_16x16x32_bf16 a[116:119], a[184:187], v[8:11], a[116:119]
  v_cvt_pk_bf16_f32 v122, v124, v125
  v_mfma_f32_16x16x32_bf16 a[120:123], a[184:187], v[16:19], 0
  v_exp_f32 v126, v126
  v_mfma_f32_16x16x32_bf16 a[120:123], a[188:191], v[48:51], a[120:123]
  v_mfma_f32_16x16x32_bf16 a[124:127], a[188:191], v[56:59], 0
  s_waitcnt lgkmcnt(0)
  v_exp_f32 v127, v127
  v_mfma_f32_16x16x32_bf16 a[124:127], a[184:187], v[24:27], a[124:127]
  v_cvt_pk_bf16_f32 v123, v126, v127
  v_mfma_f32_16x16x32_bf16 v[0:3], a[128:131], v[128:131], v[192:195]
  s_add_u32 m0, s28, 114688
  v_mfma_f32_16x16x32_bf16 v[0:3], a[132:135], v[132:135], v[0:3]
  ds_read_b128 a[144:147], v212 offset:36864
  v_mfma_f32_16x16x32_bf16 v[0:3], a[136:139], v[136:139], v[0:3]
  buffer_load_dwordx4 v236, s[16:19], s29 offen offset:0 lds
  v_mfma_f32_16x16x32_bf16 v[0:3], a[140:143], v[140:143], v[0:3]
  ds_read_b128 a[148:151], v213 offset:36864
  v_mfma_f32_16x16x32_bf16 v[8:11], a[140:143], v[156:159], v[196:199]
  v_mfma_f32_16x16x32_bf16 v[8:11], a[136:139], v[152:155], v[8:11]
  ds_read_b128 a[152:155], v214 offset:36864
  v_mfma_f32_16x16x32_bf16 v[8:11], a[132:135], v[148:151], v[8:11]
  buffer_load_dwordx4 v237, s[16:19], s29 offen offset:1024 lds
  v_mfma_f32_16x16x32_bf16 v[8:11], a[128:131], v[144:147], v[8:11]
  ds_read_b128 a[156:159], v215 offset:36864
  v_mfma_f32_16x16x32_bf16 v[16:19], a[128:131], v[160:163], v[200:203]
  v_exp_f32 v0, v0
  v_mfma_f32_16x16x32_bf16 v[16:19], a[132:135], v[164:167], v[16:19]
  v_mfma_f32_16x16x32_bf16 v[16:19], a[136:139], v[168:171], v[16:19]
  v_exp_f32 v1, v1
  v_mfma_f32_16x16x32_bf16 v[16:19], a[140:143], v[172:175], v[16:19]
  v_cvt_pk_bf16_f32 v0, v0, v1
  v_mfma_f32_16x16x32_bf16 v[24:27], a[140:143], v[188:191], v[204:207]
  v_exp_f32 v2, v2
  v_mfma_f32_16x16x32_bf16 v[24:27], a[136:139], v[184:187], v[24:27]
  buffer_load_dwordx4 v236, s[16:19], s29 offen offset:2048 lds
  v_mfma_f32_16x16x32_bf16 v[24:27], a[132:135], v[180:183], v[24:27]
  s_waitcnt lgkmcnt(0)
  v_exp_f32 v3, v3
  v_mfma_f32_16x16x32_bf16 v[24:27], a[128:131], v[176:179], v[24:27]
  v_cvt_pk_bf16_f32 v1, v2, v3
  v_mfma_f32_16x16x32_bf16 v[4:7], a[144:147], v[128:131], v[192:195]
  v_exp_f32 v8, v8
  v_mfma_f32_16x16x32_bf16 v[4:7], a[148:151], v[132:135], v[4:7]
  ds_read_b128 a[128:131], v212 offset:40960
  v_mfma_f32_16x16x32_bf16 v[4:7], a[152:155], v[136:139], v[4:7]
  v_exp_f32 v9, v9
  v_mfma_f32_16x16x32_bf16 v[4:7], a[156:159], v[140:143], v[4:7]
  ds_read_b128 a[132:135], v213 offset:40960
  v_cvt_pk_bf16_f32 v8, v8, v9
  v_mfma_f32_16x16x32_bf16 v[12:15], a[156:159], v[156:159], v[196:199]
  v_exp_f32 v10, v10
  v_mfma_f32_16x16x32_bf16 v[12:15], a[152:155], v[152:155], v[12:15]
  ds_read_b128 a[136:139], v214 offset:40960
  v_mfma_f32_16x16x32_bf16 v[12:15], a[148:151], v[148:151], v[12:15]
  v_exp_f32 v11, v11
  v_mfma_f32_16x16x32_bf16 v[12:15], a[144:147], v[144:147], v[12:15]
  ds_read_b128 a[140:143], v215 offset:40960
  v_cvt_pk_bf16_f32 v9, v10, v11
  v_mfma_f32_16x16x32_bf16 v[20:23], a[144:147], v[160:163], v[200:203]
  v_exp_f32 v16, v16
  v_mfma_f32_16x16x32_bf16 v[20:23], a[148:151], v[164:167], v[20:23]
  buffer_load_dwordx4 v237, s[16:19], s29 offen offset:3072 lds
  v_mfma_f32_16x16x32_bf16 v[20:23], a[152:155], v[168:171], v[20:23]
  s_add_u32 s29, s29, 16384
  v_exp_f32 v17, v17
  v_mfma_f32_16x16x32_bf16 v[20:23], a[156:159], v[172:175], v[20:23]
  v_cvt_pk_bf16_f32 v16, v16, v17
  v_mfma_f32_16x16x32_bf16 v[28:31], a[156:159], v[188:191], v[204:207]
  s_add_u32 m0, s28, 0
  v_exp_f32 v18, v18
  v_mfma_f32_16x16x32_bf16 v[28:31], a[152:155], v[184:187], v[28:31]
  buffer_load_dwordx4 v232, s[12:15], s29 offen offset:0 lds
  v_mfma_f32_16x16x32_bf16 v[28:31], a[148:151], v[180:183], v[28:31]
  s_waitcnt lgkmcnt(0)
  v_exp_f32 v19, v19
  v_mfma_f32_16x16x32_bf16 v[28:31], a[144:147], v[176:179], v[28:31]
  v_cvt_pk_bf16_f32 v17, v18, v19
  v_mfma_f32_16x16x32_bf16 v[32:35], a[128:131], v[128:131], v[192:195]
  v_exp_f32 v24, v24
  v_mfma_f32_16x16x32_bf16 v[32:35], a[132:135], v[132:135], v[32:35]
  ds_read_b128 a[144:147], v212 offset:45056
  v_mfma_f32_16x16x32_bf16 v[32:35], a[136:139], v[136:139], v[32:35]
  v_exp_f32 v25, v25
  v_mfma_f32_16x16x32_bf16 v[32:35], a[140:143], v[140:143], v[32:35]
  ds_read_b128 a[148:151], v213 offset:45056
  v_cvt_pk_bf16_f32 v24, v24, v25
  v_mfma_f32_16x16x32_bf16 v[40:43], a[140:143], v[156:159], v[196:199]
  v_exp_f32 v26, v26
  v_mfma_f32_16x16x32_bf16 v[40:43], a[136:139], v[152:155], v[40:43]
  ds_read_b128 a[152:155], v214 offset:45056
  v_mfma_f32_16x16x32_bf16 v[40:43], a[132:135], v[148:151], v[40:43]
  v_exp_f32 v27, v27
  v_mfma_f32_16x16x32_bf16 v[40:43], a[128:131], v[144:147], v[40:43]
  ds_read_b128 a[156:159], v215 offset:45056
  v_cvt_pk_bf16_f32 v25, v26, v27
  v_mfma_f32_16x16x32_bf16 v[48:51], a[128:131], v[160:163], v[200:203]
  v_exp_f32 v4, v4
  v_mfma_f32_16x16x32_bf16 v[48:51], a[132:135], v[164:167], v[48:51]
  buffer_load_dwordx4 v233, s[12:15], s29 offen offset:1024 lds
  v_mfma_f32_16x16x32_bf16 v[48:51], a[136:139], v[168:171], v[48:51]
  v_exp_f32 v5, v5
  v_mfma_f32_16x16x32_bf16 v[48:51], a[140:143], v[172:175], v[48:51]
  v_cvt_pk_bf16_f32 v2, v4, v5
  v_mfma_f32_16x16x32_bf16 v[56:59], a[140:143], v[188:191], v[204:207]
  v_exp_f32 v6, v6
  v_mfma_f32_16x16x32_bf16 v[56:59], a[136:139], v[184:187], v[56:59]
  buffer_load_dwordx4 v234, s[12:15], s29 offen offset:2048 lds
  v_mfma_f32_16x16x32_bf16 v[56:59], a[132:135], v[180:183], v[56:59]
  s_waitcnt lgkmcnt(0)
  v_exp_f32 v7, v7
  v_mfma_f32_16x16x32_bf16 v[56:59], a[128:131], v[176:179], v[56:59]
  v_cvt_pk_bf16_f32 v3, v6, v7
  v_mfma_f32_16x16x32_bf16 v[36:39], a[144:147], v[128:131], v[192:195]
  v_exp_f32 v12, v12
  v_mfma_f32_16x16x32_bf16 v[36:39], a[148:151], v[132:135], v[36:39]
  ds_read_b64_tr_b16 a[160:161], v216 offset:16384
  v_mfma_f32_16x16x32_bf16 v[36:39], a[152:155], v[136:139], v[36:39]
  v_exp_f32 v13, v13
  v_mfma_f32_16x16x32_bf16 v[36:39], a[156:159], v[140:143], v[36:39]
  ds_read_b64_tr_b16 a[162:163], v216 offset:20480
  v_cvt_pk_bf16_f32 v10, v12, v13
  v_mfma_f32_16x16x32_bf16 v[44:47], a[156:159], v[156:159], v[196:199]
  v_exp_f32 v14, v14
  v_mfma_f32_16x16x32_bf16 v[44:47], a[152:155], v[152:155], v[44:47]
  ds_read_b64_tr_b16 a[164:165], v216 offset:24576
  buffer_load_dwordx4 v235, s[12:15], s29 offen offset:3072 lds
  v_mfma_f32_16x16x32_bf16 v[44:47], a[148:151], v[148:151], v[44:47]
  v_exp_f32 v15, v15
  v_mfma_f32_16x16x32_bf16 v[44:47], a[144:147], v[144:147], v[44:47]
  ds_read_b64_tr_b16 a[166:167], v216 offset:28672
  v_cvt_pk_bf16_f32 v11, v14, v15
  v_mfma_f32_16x16x32_bf16 v[52:55], a[144:147], v[160:163], v[200:203]
  v_exp_f32 v20, v20
  v_mfma_f32_16x16x32_bf16 v[52:55], a[148:151], v[164:167], v[52:55]
  ds_read_b64_tr_b16 a[168:169], v217 offset:16384
  s_add_u32 m0, s50, 1024
  v_mfma_f32_16x16x32_bf16 v[52:55], a[152:155], v[168:171], v[52:55]
  v_exp_f32 v21, v21
  v_mfma_f32_16x16x32_bf16 v[52:55], a[156:159], v[172:175], v[52:55]
  ds_read_b64_tr_b16 a[170:171], v217 offset:20480
  v_cvt_pk_bf16_f32 v18, v20, v21
  v_mfma_f32_16x16x32_bf16 v[60:63], a[156:159], v[188:191], v[204:207]
  v_exp_f32 v22, v22
  v_mfma_f32_16x16x32_bf16 v[60:63], a[152:155], v[184:187], v[60:63]
  ds_read_b64_tr_b16 a[172:173], v217 offset:24576
  buffer_load_dwordx4 v253, s[20:23], s35 offen lds
  v_mfma_f32_16x16x32_bf16 v[60:63], a[148:151], v[180:183], v[60:63]
  v_exp_f32 v23, v23
  v_mfma_f32_16x16x32_bf16 v[60:63], a[144:147], v[176:179], v[60:63]
  ds_read_b64_tr_b16 a[174:175], v217 offset:28672
  v_cvt_pk_bf16_f32 v19, v22, v23
  v_mfma_f32_16x16x32_bf16 a[192:195], a[208:211], v[64:67], a[192:195]
  v_exp_f32 v28, v28
  v_mfma_f32_16x16x32_bf16 a[192:195], a[208:211], v[96:99], a[192:195]
  ds_read_b64_tr_b16 a[176:177], v218 offset:16384
  v_mfma_f32_16x16x32_bf16 a[196:199], a[208:211], v[72:75], a[196:199]
  v_exp_f32 v29, v29
  v_mfma_f32_16x16x32_bf16 a[196:199], a[208:211], v[104:107], a[196:199]
  ds_read_b64_tr_b16 a[178:179], v218 offset:20480
  v_cvt_pk_bf16_f32 v26, v28, v29
  v_mfma_f32_16x16x32_bf16 a[200:203], a[208:211], v[80:83], a[200:203]
  v_exp_f32 v30, v30
  v_mfma_f32_16x16x32_bf16 a[200:203], a[208:211], v[112:115], a[200:203]
  ds_read_b64_tr_b16 a[180:181], v218 offset:24576
  v_mfma_f32_16x16x32_bf16 a[204:207], a[208:211], v[88:91], a[204:207]
  s_waitcnt lgkmcnt(7)
  v_exp_f32 v31, v31
  v_mfma_f32_16x16x32_bf16 a[204:207], a[208:211], v[120:123], a[204:207]
  ds_read_b64_tr_b16 a[182:183], v218 offset:28672
  v_cvt_pk_bf16_f32 v27, v30, v31
  v_mfma_f32_16x16x32_bf16 a[0:3], a[160:163], v[64:67], a[0:3]
  v_exp_f32 v32, v32
  v_mfma_f32_16x16x32_bf16 a[0:3], a[164:167], v[96:99], a[0:3]
  ds_read_b64_tr_b16 a[184:185], v219 offset:16384
  v_mfma_f32_16x16x32_bf16 a[4:7], a[164:167], v[104:107], a[4:7]
  v_exp_f32 v33, v33
  v_mfma_f32_16x16x32_bf16 a[4:7], a[160:163], v[72:75], a[4:7]
  ds_read_b64_tr_b16 a[186:187], v219 offset:20480
  v_cvt_pk_bf16_f32 v32, v32, v33
  v_mfma_f32_16x16x32_bf16 a[8:11], a[160:163], v[80:83], a[8:11]
  v_exp_f32 v34, v34
  v_mfma_f32_16x16x32_bf16 a[8:11], a[164:167], v[112:115], a[8:11]
  ds_read_b64_tr_b16 a[188:189], v219 offset:24576
  v_mfma_f32_16x16x32_bf16 a[12:15], a[164:167], v[120:123], a[12:15]
  s_waitcnt lgkmcnt(7)
  v_exp_f32 v35, v35
  v_mfma_f32_16x16x32_bf16 a[12:15], a[160:163], v[88:91], a[12:15]
  ds_read_b64_tr_b16 a[190:191], v219 offset:28672
  v_cvt_pk_bf16_f32 v33, v34, v35
  v_mfma_f32_16x16x32_bf16 a[16:19], a[168:171], v[64:67], a[16:19]
  v_exp_f32 v40, v40
  v_mfma_f32_16x16x32_bf16 a[16:19], a[172:175], v[96:99], a[16:19]
  ds_read_b64_tr_b16 a[160:161], v220 offset:16384
  v_mfma_f32_16x16x32_bf16 a[20:23], a[172:175], v[104:107], a[20:23]
  v_exp_f32 v41, v41
  v_mfma_f32_16x16x32_bf16 a[20:23], a[168:171], v[72:75], a[20:23]
  ds_read_b64_tr_b16 a[162:163], v220 offset:20480
  v_cvt_pk_bf16_f32 v40, v40, v41
  v_mfma_f32_16x16x32_bf16 a[24:27], a[168:171], v[80:83], a[24:27]
  v_exp_f32 v42, v42
  v_mfma_f32_16x16x32_bf16 a[24:27], a[172:175], v[112:115], a[24:27]
  ds_read_b64_tr_b16 a[164:165], v220 offset:24576
  v_mfma_f32_16x16x32_bf16 a[28:31], a[172:175], v[120:123], a[28:31]
  s_waitcnt lgkmcnt(7)
  v_exp_f32 v43, v43
  v_mfma_f32_16x16x32_bf16 a[28:31], a[168:171], v[88:91], a[28:31]
  ds_read_b64_tr_b16 a[166:167], v220 offset:28672
  v_cvt_pk_bf16_f32 v41, v42, v43
  v_mfma_f32_16x16x32_bf16 a[32:35], a[176:179], v[64:67], a[32:35]
  v_exp_f32 v48, v48
  v_mfma_f32_16x16x32_bf16 a[32:35], a[180:183], v[96:99], a[32:35]
  ds_read_b64_tr_b16 a[168:169], v221 offset:16384
  v_mfma_f32_16x16x32_bf16 a[36:39], a[180:183], v[104:107], a[36:39]
  v_exp_f32 v49, v49
  v_mfma_f32_16x16x32_bf16 a[36:39], a[176:179], v[72:75], a[36:39]
  ds_read_b64_tr_b16 a[170:171], v221 offset:20480
  v_cvt_pk_bf16_f32 v48, v48, v49
  v_mfma_f32_16x16x32_bf16 a[40:43], a[176:179], v[80:83], a[40:43]
  v_exp_f32 v50, v50
  v_mfma_f32_16x16x32_bf16 a[40:43], a[180:183], v[112:115], a[40:43]
  ds_read_b64_tr_b16 a[172:173], v221 offset:24576
  v_mfma_f32_16x16x32_bf16 a[44:47], a[180:183], v[120:123], a[44:47]
  s_waitcnt lgkmcnt(7)
  v_exp_f32 v51, v51
  v_mfma_f32_16x16x32_bf16 a[44:47], a[176:179], v[88:91], a[44:47]
  ds_read_b64_tr_b16 a[174:175], v221 offset:28672
  v_cvt_pk_bf16_f32 v49, v50, v51
  v_mfma_f32_16x16x32_bf16 a[48:51], a[184:187], v[64:67], a[48:51]
  v_exp_f32 v56, v56
  v_mfma_f32_16x16x32_bf16 a[48:51], a[188:191], v[96:99], a[48:51]
  ds_read_b64_tr_b16 a[176:177], v222 offset:16384
  v_mfma_f32_16x16x32_bf16 a[52:55], a[188:191], v[104:107], a[52:55]
  v_exp_f32 v57, v57
  v_mfma_f32_16x16x32_bf16 a[52:55], a[184:187], v[72:75], a[52:55]
  ds_read_b64_tr_b16 a[178:179], v222 offset:20480
  v_cvt_pk_bf16_f32 v56, v56, v57
  v_mfma_f32_16x16x32_bf16 a[56:59], a[184:187], v[80:83], a[56:59]
  v_exp_f32 v58, v58
  v_mfma_f32_16x16x32_bf16 a[56:59], a[188:191], v[112:115], a[56:59]
  ds_read_b64_tr_b16 a[180:181], v222 offset:24576
  v_mfma_f32_16x16x32_bf16 a[60:63], a[188:191], v[120:123], a[60:63]
  s_waitcnt lgkmcnt(7)
  v_exp_f32 v59, v59
  v_mfma_f32_16x16x32_bf16 a[60:63], a[184:187], v[88:91], a[60:63]
  ds_read_b64_tr_b16 a[182:183], v222 offset:28672
  v_cvt_pk_bf16_f32 v57, v58, v59
  v_mfma_f32_16x16x32_bf16 a[64:67], a[160:163], v[64:67], a[64:67]
  v_exp_f32 v36, v36
  v_mfma_f32_16x16x32_bf16 a[64:67], a[164:167], v[96:99], a[64:67]
  ds_read_b64_tr_b16 a[184:185], v223 offset:16384
  v_mfma_f32_16x16x32_bf16 a[68:71], a[164:167], v[104:107], a[68:71]
  v_exp_f32 v37, v37
  v_mfma_f32_16x16x32_bf16 a[68:71], a[160:163], v[72:75], a[68:71]
  ds_read_b64_tr_b16 a[186:187], v223 offset:20480
  v_cvt_pk_bf16_f32 v34, v36, v37
  v_mfma_f32_16x16x32_bf16 a[72:75], a[160:163], v[80:83], a[72:75]
  v_exp_f32 v38, v38
  v_mfma_f32_16x16x32_bf16 a[72:75], a[164:167], v[112:115], a[72:75]
  ds_read_b64_tr_b16 a[188:189], v223 offset:24576
  v_mfma_f32_16x16x32_bf16 a[76:79], a[164:167], v[120:123], a[76:79]
  s_waitcnt lgkmcnt(7)
  v_exp_f32 v39, v39
  v_mfma_f32_16x16x32_bf16 a[76:79], a[160:163], v[88:91], a[76:79]
  ds_read_b64_tr_b16 a[190:191], v223 offset:28672
  v_cvt_pk_bf16_f32 v35, v38, v39
  v_mfma_f32_16x16x32_bf16 a[80:83], a[168:171], v[64:67], a[80:83]
  s_waitcnt vmcnt(11)
  v_exp_f32 v44, v44
  v_mfma_f32_16x16x32_bf16 a[80:83], a[172:175], v[96:99], a[80:83]
  v_mfma_f32_16x16x32_bf16 a[84:87], a[172:175], v[104:107], a[84:87]
  s_barrier
  v_exp_f32 v45, v45
  v_mfma_f32_16x16x32_bf16 a[84:87], a[168:171], v[72:75], a[84:87]
  ds_read_b128 a[128:131], v212 offset:49152
  v_cvt_pk_bf16_f32 v42, v44, v45
  v_mfma_f32_16x16x32_bf16 a[88:91], a[168:171], v[80:83], a[88:91]
  v_exp_f32 v46, v46
  v_mfma_f32_16x16x32_bf16 a[88:91], a[172:175], v[112:115], a[88:91]
  ds_read_b128 a[132:135], v213 offset:49152
  v_mfma_f32_16x16x32_bf16 a[92:95], a[172:175], v[120:123], a[92:95]
  s_waitcnt lgkmcnt(6)
  v_exp_f32 v47, v47
  v_mfma_f32_16x16x32_bf16 a[92:95], a[168:171], v[88:91], a[92:95]
  ds_read_b128 a[136:139], v214 offset:49152
  v_cvt_pk_bf16_f32 v43, v46, v47
  v_mfma_f32_16x16x32_bf16 a[96:99], a[176:179], v[64:67], a[96:99]
  v_exp_f32 v52, v52
  v_mfma_f32_16x16x32_bf16 a[96:99], a[180:183], v[96:99], a[96:99]
  ds_read_b128 a[140:143], v215 offset:49152
  buffer_load_dwordx4 a[216:219], v243, s[24:27], s38 offen sc1
  s_add_u32 s38, s38, 4096
  v_mfma_f32_16x16x32_bf16 a[100:103], a[180:183], v[104:107], a[100:103]
  v_exp_f32 v53, v53
  v_mfma_f32_16x16x32_bf16 a[100:103], a[176:179], v[72:75], a[100:103]
  v_cvt_pk_bf16_f32 v50, v52, v53
  v_mfma_f32_16x16x32_bf16 a[104:107], a[176:179], v[80:83], a[104:107]
  v_exp_f32 v54, v54
  v_mfma_f32_16x16x32_bf16 a[104:107], a[180:183], v[112:115], a[104:107]
  v_mfma_f32_16x16x32_bf16 a[108:111], a[180:183], v[120:123], a[108:111]
  s_waitcnt lgkmcnt(4)
  v_exp_f32 v55, v55
  v_mfma_f32_16x16x32_bf16 a[108:111], a[176:179], v[88:91], a[108:111]
  v_cvt_pk_bf16_f32 v51, v54, v55
  v_mfma_f32_16x16x32_bf16 a[112:115], a[184:187], v[64:67], a[112:115]
  v_exp_f32 v60, v60
  v_mfma_f32_16x16x32_bf16 a[112:115], a[188:191], v[96:99], a[112:115]
  v_mfma_f32_16x16x32_bf16 a[116:119], a[188:191], v[104:107], a[116:119]
  v_exp_f32 v61, v61
  v_mfma_f32_16x16x32_bf16 a[116:119], a[184:187], v[72:75], a[116:119]
  v_cvt_pk_bf16_f32 v58, v60, v61
  v_mfma_f32_16x16x32_bf16 a[120:123], a[184:187], v[80:83], a[120:123]
  v_exp_f32 v62, v62
  v_mfma_f32_16x16x32_bf16 a[120:123], a[188:191], v[112:115], a[120:123]
  v_mfma_f32_16x16x32_bf16 a[124:127], a[188:191], v[120:123], a[124:127]
  s_waitcnt lgkmcnt(0)
  v_exp_f32 v63, v63
  v_mfma_f32_16x16x32_bf16 a[124:127], a[184:187], v[88:91], a[124:127]
  v_cvt_pk_bf16_f32 v59, v62, v63
  v_mfma_f32_16x16x32_bf16 v[64:67], a[128:131], v[128:131], v[192:195]
  s_add_u32 m0, s28, 65536
  v_mfma_f32_16x16x32_bf16 v[64:67], a[132:135], v[132:135], v[64:67]
  ds_read_b128 a[144:147], v212 offset:53248
  v_mfma_f32_16x16x32_bf16 v[64:67], a[136:139], v[136:139], v[64:67]
  buffer_load_dwordx4 v236, s[16:19], s29 offen offset:0 lds
  v_mfma_f32_16x16x32_bf16 v[64:67], a[140:143], v[140:143], v[64:67]
  ds_read_b128 a[148:151], v213 offset:53248
  v_mfma_f32_16x16x32_bf16 v[72:75], a[140:143], v[156:159], v[196:199]
  v_mfma_f32_16x16x32_bf16 v[72:75], a[136:139], v[152:155], v[72:75]
  ds_read_b128 a[152:155], v214 offset:53248
  v_mfma_f32_16x16x32_bf16 v[72:75], a[132:135], v[148:151], v[72:75]
  buffer_load_dwordx4 v237, s[16:19], s29 offen offset:1024 lds
  v_mfma_f32_16x16x32_bf16 v[72:75], a[128:131], v[144:147], v[72:75]
  ds_read_b128 a[156:159], v215 offset:53248
  v_mfma_f32_16x16x32_bf16 v[80:83], a[128:131], v[160:163], v[200:203]
  v_exp_f32 v64, v64
  v_mfma_f32_16x16x32_bf16 v[80:83], a[132:135], v[164:167], v[80:83]
  v_mfma_f32_16x16x32_bf16 v[80:83], a[136:139], v[168:171], v[80:83]
  v_exp_f32 v65, v65
  v_mfma_f32_16x16x32_bf16 v[80:83], a[140:143], v[172:175], v[80:83]
  v_cvt_pk_bf16_f32 v64, v64, v65
  v_mfma_f32_16x16x32_bf16 v[88:91], a[140:143], v[188:191], v[204:207]
  v_exp_f32 v66, v66
  v_mfma_f32_16x16x32_bf16 v[88:91], a[136:139], v[184:187], v[88:91]
  buffer_load_dwordx4 v236, s[16:19], s29 offen offset:2048 lds
  v_mfma_f32_16x16x32_bf16 v[88:91], a[132:135], v[180:183], v[88:91]
  s_waitcnt lgkmcnt(0)
  v_exp_f32 v67, v67
  v_mfma_f32_16x16x32_bf16 v[88:91], a[128:131], v[176:179], v[88:91]
  v_cvt_pk_bf16_f32 v65, v66, v67
  v_mfma_f32_16x16x32_bf16 v[68:71], a[144:147], v[128:131], v[192:195]
  v_exp_f32 v72, v72
  v_mfma_f32_16x16x32_bf16 v[68:71], a[148:151], v[132:135], v[68:71]
  ds_read_b128 a[128:131], v212 offset:57344
  v_mfma_f32_16x16x32_bf16 v[68:71], a[152:155], v[136:139], v[68:71]
  v_exp_f32 v73, v73
  v_mfma_f32_16x16x32_bf16 v[68:71], a[156:159], v[140:143], v[68:71]
  ds_read_b128 a[132:135], v213 offset:57344
  v_cvt_pk_bf16_f32 v72, v72, v73
  v_mfma_f32_16x16x32_bf16 v[76:79], a[156:159], v[156:159], v[196:199]
  v_exp_f32 v74, v74
  v_mfma_f32_16x16x32_bf16 v[76:79], a[152:155], v[152:155], v[76:79]
  ds_read_b128 a[136:139], v214 offset:57344
  v_mfma_f32_16x16x32_bf16 v[76:79], a[148:151], v[148:151], v[76:79]
  v_exp_f32 v75, v75
  v_mfma_f32_16x16x32_bf16 v[76:79], a[144:147], v[144:147], v[76:79]
  ds_read_b128 a[140:143], v215 offset:57344
  v_cvt_pk_bf16_f32 v73, v74, v75
  v_mfma_f32_16x16x32_bf16 v[84:87], a[144:147], v[160:163], v[200:203]
  v_exp_f32 v80, v80
  v_mfma_f32_16x16x32_bf16 v[84:87], a[148:151], v[164:167], v[84:87]
  buffer_load_dwordx4 v237, s[16:19], s29 offen offset:3072 lds
  v_mfma_f32_16x16x32_bf16 v[84:87], a[152:155], v[168:171], v[84:87]
  s_add_u32 s29, s29, 16384
  v_exp_f32 v81, v81
  v_mfma_f32_16x16x32_bf16 v[84:87], a[156:159], v[172:175], v[84:87]
  v_cvt_pk_bf16_f32 v80, v80, v81
  v_mfma_f32_16x16x32_bf16 v[92:95], a[156:159], v[188:191], v[204:207]
  s_add_u32 m0, s28, 16384
  v_exp_f32 v82, v82
  v_mfma_f32_16x16x32_bf16 v[92:95], a[152:155], v[184:187], v[92:95]
  buffer_load_dwordx4 v232, s[12:15], s29 offen offset:0 lds
  v_mfma_f32_16x16x32_bf16 v[92:95], a[148:151], v[180:183], v[92:95]
  s_waitcnt lgkmcnt(0)
  v_exp_f32 v83, v83
  v_mfma_f32_16x16x32_bf16 v[92:95], a[144:147], v[176:179], v[92:95]
  v_cvt_pk_bf16_f32 v81, v82, v83
  v_mfma_f32_16x16x32_bf16 v[96:99], a[128:131], v[128:131], v[192:195]
  v_exp_f32 v88, v88
  v_mfma_f32_16x16x32_bf16 v[96:99], a[132:135], v[132:135], v[96:99]
  ds_read_b128 a[144:147], v212 offset:61440
  v_mfma_f32_16x16x32_bf16 v[96:99], a[136:139], v[136:139], v[96:99]
  v_exp_f32 v89, v89
  v_mfma_f32_16x16x32_bf16 v[96:99], a[140:143], v[140:143], v[96:99]
  ds_read_b128 a[148:151], v213 offset:61440
  v_cvt_pk_bf16_f32 v88, v88, v89
  v_mfma_f32_16x16x32_bf16 v[104:107], a[140:143], v[156:159], v[196:199]
  v_exp_f32 v90, v90
  v_mfma_f32_16x16x32_bf16 v[104:107], a[136:139], v[152:155], v[104:107]
  ds_read_b128 a[152:155], v214 offset:61440
  v_mfma_f32_16x16x32_bf16 v[104:107], a[132:135], v[148:151], v[104:107]
  v_exp_f32 v91, v91
  v_mfma_f32_16x16x32_bf16 v[104:107], a[128:131], v[144:147], v[104:107]
  ds_read_b128 a[156:159], v215 offset:61440
  v_cvt_pk_bf16_f32 v89, v90, v91
  v_mfma_f32_16x16x32_bf16 v[112:115], a[128:131], v[160:163], v[200:203]
  v_exp_f32 v68, v68
  v_mfma_f32_16x16x32_bf16 v[112:115], a[132:135], v[164:167], v[112:115]
  buffer_load_dwordx4 v233, s[12:15], s29 offen offset:1024 lds
  v_mfma_f32_16x16x32_bf16 v[112:115], a[136:139], v[168:171], v[112:115]
  v_exp_f32 v69, v69
  v_mfma_f32_16x16x32_bf16 v[112:115], a[140:143], v[172:175], v[112:115]
  v_cvt_pk_bf16_f32 v66, v68, v69
  v_mfma_f32_16x16x32_bf16 v[120:123], a[140:143], v[188:191], v[204:207]
  v_exp_f32 v70, v70
  v_mfma_f32_16x16x32_bf16 v[120:123], a[136:139], v[184:187], v[120:123]
  buffer_load_dwordx4 v234, s[12:15], s29 offen offset:2048 lds
  v_mfma_f32_16x16x32_bf16 v[120:123], a[132:135], v[180:183], v[120:123]
  s_waitcnt lgkmcnt(0)
  v_exp_f32 v71, v71
  v_mfma_f32_16x16x32_bf16 v[120:123], a[128:131], v[176:179], v[120:123]
  v_cvt_pk_bf16_f32 v67, v70, v71
  v_mfma_f32_16x16x32_bf16 v[100:103], a[144:147], v[128:131], v[192:195]
  v_exp_f32 v76, v76
  v_mfma_f32_16x16x32_bf16 v[100:103], a[148:151], v[132:135], v[100:103]
  ds_read_b64_tr_b16 a[160:161], v216 offset:32768
  v_mfma_f32_16x16x32_bf16 v[100:103], a[152:155], v[136:139], v[100:103]
  v_exp_f32 v77, v77
  v_mfma_f32_16x16x32_bf16 v[100:103], a[156:159], v[140:143], v[100:103]
  ds_read_b64_tr_b16 a[162:163], v216 offset:36864
  v_cvt_pk_bf16_f32 v74, v76, v77
  v_mfma_f32_16x16x32_bf16 v[108:111], a[156:159], v[156:159], v[196:199]
  v_exp_f32 v78, v78
  v_mfma_f32_16x16x32_bf16 v[108:111], a[152:155], v[152:155], v[108:111]
  ds_read_b64_tr_b16 a[164:165], v216 offset:40960
  buffer_load_dwordx4 v235, s[12:15], s29 offen offset:3072 lds
  v_mfma_f32_16x16x32_bf16 v[108:111], a[148:151], v[148:151], v[108:111]
  v_exp_f32 v79, v79
  v_mfma_f32_16x16x32_bf16 v[108:111], a[144:147], v[144:147], v[108:111]
  ds_read_b64_tr_b16 a[166:167], v216 offset:45056
  v_cvt_pk_bf16_f32 v75, v78, v79
  v_mfma_f32_16x16x32_bf16 v[116:119], a[144:147], v[160:163], v[200:203]
  v_exp_f32 v84, v84
  v_mfma_f32_16x16x32_bf16 v[116:119], a[148:151], v[164:167], v[116:119]
  ds_read_b64_tr_b16 a[168:169], v217 offset:32768
  s_add_u32 m0, s50, 4096
  v_mfma_f32_16x16x32_bf16 v[116:119], a[152:155], v[168:171], v[116:119]
  v_exp_f32 v85, v85
  v_mfma_f32_16x16x32_bf16 v[116:119], a[156:159], v[172:175], v[116:119]
  ds_read_b64_tr_b16 a[170:171], v217 offset:36864
  v_cvt_pk_bf16_f32 v82, v84, v85
  v_mfma_f32_16x16x32_bf16 v[124:127], a[156:159], v[188:191], v[204:207]
  v_exp_f32 v86, v86
  v_mfma_f32_16x16x32_bf16 v[124:127], a[152:155], v[184:187], v[124:127]
  ds_read_b64_tr_b16 a[172:173], v217 offset:40960
  buffer_load_dwordx4 v253, s[44:47], s35 offen lds
  s_add_u32 s35, s35, 221184
  v_mfma_f32_16x16x32_bf16 v[124:127], a[148:151], v[180:183], v[124:127]
  v_exp_f32 v87, v87
  v_mfma_f32_16x16x32_bf16 v[124:127], a[144:147], v[176:179], v[124:127]
  ds_read_b64_tr_b16 a[174:175], v217 offset:45056
  v_cvt_pk_bf16_f32 v83, v86, v87
  v_mfma_f32_16x16x32_bf16 a[192:195], a[208:211], v[0:3], a[192:195]
  v_exp_f32 v92, v92
  v_mfma_f32_16x16x32_bf16 a[192:195], a[208:211], v[32:35], a[192:195]
  ds_read_b64_tr_b16 a[176:177], v218 offset:32768
  v_lshrrev_b32 v254, 4, v242
  v_mfma_f32_16x16x32_bf16 a[196:199], a[208:211], v[8:11], a[196:199]
  v_exp_f32 v93, v93
  v_mfma_f32_16x16x32_bf16 a[196:199], a[208:211], v[40:43], a[196:199]
  ds_read_b64_tr_b16 a[178:179], v218 offset:36864
  v_cvt_pk_bf16_f32 v90, v92, v93
  v_mfma_f32_16x16x32_bf16 a[200:203], a[208:211], v[16:19], a[200:203]
  v_exp_f32 v94, v94
  v_mfma_f32_16x16x32_bf16 a[200:203], a[208:211], v[48:51], a[200:203]
  ds_read_b64_tr_b16 a[180:181], v218 offset:40960
  v_lshrrev_b32 v254, 5, v254
  v_mfma_f32_16x16x32_bf16 a[204:207], a[208:211], v[24:27], a[204:207]
  s_waitcnt lgkmcnt(7)
  v_exp_f32 v95, v95
  v_mfma_f32_16x16x32_bf16 a[204:207], a[208:211], v[56:59], a[204:207]
  ds_read_b64_tr_b16 a[182:183], v218 offset:45056
  v_cvt_pk_bf16_f32 v91, v94, v95
  v_mfma_f32_16x16x32_bf16 a[0:3], a[160:163], v[0:3], a[0:3]
  v_exp_f32 v96, v96
  v_mfma_f32_16x16x32_bf16 a[0:3], a[164:167], v[32:35], a[0:3]
  ds_read_b64_tr_b16 a[184:185], v219 offset:32768
  v_lshl_add_u32 v253, v254, 30, v253
  v_mfma_f32_16x16x32_bf16 a[4:7], a[164:167], v[40:43], a[4:7]
  v_exp_f32 v97, v97
  v_mfma_f32_16x16x32_bf16 a[4:7], a[160:163], v[8:11], a[4:7]
  ds_read_b64_tr_b16 a[186:187], v219 offset:36864
  v_cvt_pk_bf16_f32 v96, v96, v97
  v_mfma_f32_16x16x32_bf16 a[8:11], a[160:163], v[16:19], a[8:11]
  v_exp_f32 v98, v98
  v_mfma_f32_16x16x32_bf16 a[8:11], a[164:167], v[48:51], a[8:11]
  ds_read_b64_tr_b16 a[188:189], v219 offset:40960
  v_mfma_f32_16x16x32_bf16 a[12:15], a[164:167], v[56:59], a[12:15]
  s_waitcnt lgkmcnt(7)
  v_exp_f32 v99, v99
  v_mfma_f32_16x16x32_bf16 a[12:15], a[160:163], v[24:27], a[12:15]
  ds_read_b64_tr_b16 a[190:191], v219 offset:45056
  v_cvt_pk_bf16_f32 v97, v98, v99
  v_mfma_f32_16x16x32_bf16 a[16:19], a[168:171], v[0:3], a[16:19]
  v_exp_f32 v104, v104
  v_mfma_f32_16x16x32_bf16 a[16:19], a[172:175], v[32:35], a[16:19]
  ds_read_b64_tr_b16 a[160:161], v220 offset:32768
  v_mfma_f32_16x16x32_bf16 a[20:23], a[172:175], v[40:43], a[20:23]
  v_exp_f32 v105, v105
  v_mfma_f32_16x16x32_bf16 a[20:23], a[168:171], v[8:11], a[20:23]
  ds_read_b64_tr_b16 a[162:163], v220 offset:36864
  v_cvt_pk_bf16_f32 v104, v104, v105
  v_mfma_f32_16x16x32_bf16 a[24:27], a[168:171], v[16:19], a[24:27]
  v_exp_f32 v106, v106
  v_mfma_f32_16x16x32_bf16 a[24:27], a[172:175], v[48:51], a[24:27]
  ds_read_b64_tr_b16 a[164:165], v220 offset:40960
  v_mfma_f32_16x16x32_bf16 a[28:31], a[172:175], v[56:59], a[28:31]
  s_waitcnt lgkmcnt(7)
  v_exp_f32 v107, v107
  v_mfma_f32_16x16x32_bf16 a[28:31], a[168:171], v[24:27], a[28:31]
  ds_read_b64_tr_b16 a[166:167], v220 offset:45056
  v_cvt_pk_bf16_f32 v105, v106, v107
  v_mfma_f32_16x16x32_bf16 a[32:35], a[176:179], v[0:3], a[32:35]
  v_exp_f32 v112, v112
  v_mfma_f32_16x16x32_bf16 a[32:35], a[180:183], v[32:35], a[32:35]
  ds_read_b64_tr_b16 a[168:169], v221 offset:32768
  v_mfma_f32_16x16x32_bf16 a[36:39], a[180:183], v[40:43], a[36:39]
  v_exp_f32 v113, v113
  v_mfma_f32_16x16x32_bf16 a[36:39], a[176:179], v[8:11], a[36:39]
  ds_read_b64_tr_b16 a[170:171], v221 offset:36864
  v_cvt_pk_bf16_f32 v112, v112, v113
  v_mfma_f32_16x16x32_bf16 a[40:43], a[176:179], v[16:19], a[40:43]
  v_exp_f32 v114, v114
  v_mfma_f32_16x16x32_bf16 a[40:43], a[180:183], v[48:51], a[40:43]
  ds_read_b64_tr_b16 a[172:173], v221 offset:40960
  v_mfma_f32_16x16x32_bf16 a[44:47], a[180:183], v[56:59], a[44:47]
  s_waitcnt lgkmcnt(7)
  v_exp_f32 v115, v115
  v_mfma_f32_16x16x32_bf16 a[44:47], a[176:179], v[24:27], a[44:47]
  ds_read_b64_tr_b16 a[174:175], v221 offset:45056
  v_cvt_pk_bf16_f32 v113, v114, v115
  v_mfma_f32_16x16x32_bf16 a[48:51], a[184:187], v[0:3], a[48:51]
  v_exp_f32 v120, v120
  v_mfma_f32_16x16x32_bf16 a[48:51], a[188:191], v[32:35], a[48:51]
  ds_read_b64_tr_b16 a[176:177], v222 offset:32768
  v_mfma_f32_16x16x32_bf16 a[52:55], a[188:191], v[40:43], a[52:55]
  v_exp_f32 v121, v121
  v_mfma_f32_16x16x32_bf16 a[52:55], a[184:187], v[8:11], a[52:55]
  ds_read_b64_tr_b16 a[178:179], v222 offset:36864
  v_cvt_pk_bf16_f32 v120, v120, v121
  v_mfma_f32_16x16x32_bf16 a[56:59], a[184:187], v[16:19], a[56:59]
  v_exp_f32 v122, v122
  v_mfma_f32_16x16x32_bf16 a[56:59], a[188:191], v[48:51], a[56:59]
  ds_read_b64_tr_b16 a[180:181], v222 offset:40960
  v_mfma_f32_16x16x32_bf16 a[60:63], a[188:191], v[56:59], a[60:63]
  s_waitcnt lgkmcnt(7)
  v_exp_f32 v123, v123
  v_mfma_f32_16x16x32_bf16 a[60:63], a[184:187], v[24:27], a[60:63]
  ds_read_b64_tr_b16 a[182:183], v222 offset:45056
  v_cvt_pk_bf16_f32 v121, v122, v123
  v_mfma_f32_16x16x32_bf16 a[64:67], a[160:163], v[0:3], a[64:67]
  v_exp_f32 v100, v100
  v_mfma_f32_16x16x32_bf16 a[64:67], a[164:167], v[32:35], a[64:67]
  ds_read_b64_tr_b16 a[184:185], v223 offset:32768
  v_mfma_f32_16x16x32_bf16 a[68:71], a[164:167], v[40:43], a[68:71]
  v_exp_f32 v101, v101
  v_mfma_f32_16x16x32_bf16 a[68:71], a[160:163], v[8:11], a[68:71]
  ds_read_b64_tr_b16 a[186:187], v223 offset:36864
  v_cvt_pk_bf16_f32 v98, v100, v101
  v_mfma_f32_16x16x32_bf16 a[72:75], a[160:163], v[16:19], a[72:75]
  v_exp_f32 v102, v102
  v_mfma_f32_16x16x32_bf16 a[72:75], a[164:167], v[48:51], a[72:75]
  ds_read_b64_tr_b16 a[188:189], v223 offset:40960
  v_mfma_f32_16x16x32_bf16 a[76:79], a[164:167], v[56:59], a[76:79]
  s_waitcnt lgkmcnt(7)
  v_exp_f32 v103, v103
  v_mfma_f32_16x16x32_bf16 a[76:79], a[160:163], v[24:27], a[76:79]
  ds_read_b64_tr_b16 a[190:191], v223 offset:45056
  v_cvt_pk_bf16_f32 v99, v102, v103
  v_mfma_f32_16x16x32_bf16 a[80:83], a[168:171], v[0:3], a[80:83]
  s_waitcnt vmcnt(11)
  v_exp_f32 v108, v108
  v_mfma_f32_16x16x32_bf16 a[80:83], a[172:175], v[32:35], a[80:83]
  v_mfma_f32_16x16x32_bf16 a[84:87], a[172:175], v[40:43], a[84:87]
  s_barrier
  v_exp_f32 v109, v109
  v_mfma_f32_16x16x32_bf16 a[84:87], a[168:171], v[8:11], a[84:87]
  ds_read_b128 a[128:131], v212 offset:0
  v_cvt_pk_bf16_f32 v106, v108, v109
  v_mfma_f32_16x16x32_bf16 a[88:91], a[168:171], v[16:19], a[88:91]
  v_exp_f32 v110, v110
  v_mfma_f32_16x16x32_bf16 a[88:91], a[172:175], v[48:51], a[88:91]
  ds_read_b128 a[132:135], v213 offset:0
  v_mfma_f32_16x16x32_bf16 a[92:95], a[172:175], v[56:59], a[92:95]
  s_waitcnt lgkmcnt(6)
  v_exp_f32 v111, v111
  v_mfma_f32_16x16x32_bf16 a[92:95], a[168:171], v[24:27], a[92:95]
  ds_read_b128 a[136:139], v214 offset:0
  v_cvt_pk_bf16_f32 v107, v110, v111
  v_mfma_f32_16x16x32_bf16 a[96:99], a[176:179], v[0:3], a[96:99]
  v_exp_f32 v116, v116
  v_mfma_f32_16x16x32_bf16 a[96:99], a[180:183], v[32:35], a[96:99]
  ds_read_b128 a[140:143], v215 offset:0
  buffer_load_dwordx4 a[220:223], v243, s[24:27], s38 offen sc1
  s_add_u32 s38, s38, 4096
  v_mfma_f32_16x16x32_bf16 a[100:103], a[180:183], v[40:43], a[100:103]
  v_exp_f32 v117, v117
  v_mfma_f32_16x16x32_bf16 a[100:103], a[176:179], v[8:11], a[100:103]
  v_cvt_pk_bf16_f32 v114, v116, v117
  v_mfma_f32_16x16x32_bf16 a[104:107], a[176:179], v[16:19], a[104:107]
  v_exp_f32 v118, v118
  v_mfma_f32_16x16x32_bf16 a[104:107], a[180:183], v[48:51], a[104:107]
  v_mfma_f32_16x16x32_bf16 a[108:111], a[180:183], v[56:59], a[108:111]
  s_waitcnt lgkmcnt(4)
  v_exp_f32 v119, v119
  v_mfma_f32_16x16x32_bf16 a[108:111], a[176:179], v[24:27], a[108:111]
  v_cvt_pk_bf16_f32 v115, v118, v119
  v_mfma_f32_16x16x32_bf16 a[112:115], a[184:187], v[0:3], a[112:115]
  v_exp_f32 v124, v124
  v_mfma_f32_16x16x32_bf16 a[112:115], a[188:191], v[32:35], a[112:115]
  v_mfma_f32_16x16x32_bf16 a[116:119], a[188:191], v[40:43], a[116:119]
  v_exp_f32 v125, v125
  v_mfma_f32_16x16x32_bf16 a[116:119], a[184:187], v[8:11], a[116:119]
  v_cvt_pk_bf16_f32 v122, v124, v125
  v_mfma_f32_16x16x32_bf16 a[120:123], a[184:187], v[16:19], a[120:123]
  v_exp_f32 v126, v126
  v_mfma_f32_16x16x32_bf16 a[120:123], a[188:191], v[48:51], a[120:123]
  v_mfma_f32_16x16x32_bf16 a[124:127], a[188:191], v[56:59], a[124:127]
  s_waitcnt lgkmcnt(0)
  v_exp_f32 v127, v127
  v_mfma_f32_16x16x32_bf16 a[124:127], a[184:187], v[24:27], a[124:127]
  v_cvt_pk_bf16_f32 v123, v126, v127
  v_mfma_f32_16x16x32_bf16 v[0:3], a[128:131], v[128:131], v[192:195]
  s_add_u32 m0, s28, 81920
  v_mfma_f32_16x16x32_bf16 v[0:3], a[132:135], v[132:135], v[0:3]
  ds_read_b128 a[144:147], v212 offset:4096
  v_mfma_f32_16x16x32_bf16 v[0:3], a[136:139], v[136:139], v[0:3]
  buffer_load_dwordx4 v236, s[16:19], s29 offen offset:0 lds
  v_mfma_f32_16x16x32_bf16 v[0:3], a[140:143], v[140:143], v[0:3]
  ds_read_b128 a[148:151], v213 offset:4096
  v_mfma_f32_16x16x32_bf16 v[8:11], a[140:143], v[156:159], v[196:199]
  v_mfma_f32_16x16x32_bf16 v[8:11], a[136:139], v[152:155], v[8:11]
  ds_read_b128 a[152:155], v214 offset:4096
  v_mfma_f32_16x16x32_bf16 v[8:11], a[132:135], v[148:151], v[8:11]
  buffer_load_dwordx4 v237, s[16:19], s29 offen offset:1024 lds
  v_mfma_f32_16x16x32_bf16 v[8:11], a[128:131], v[144:147], v[8:11]
  ds_read_b128 a[156:159], v215 offset:4096
  v_mfma_f32_16x16x32_bf16 v[16:19], a[128:131], v[160:163], v[200:203]
  v_exp_f32 v0, v0
  v_mfma_f32_16x16x32_bf16 v[16:19], a[132:135], v[164:167], v[16:19]
  v_mfma_f32_16x16x32_bf16 v[16:19], a[136:139], v[168:171], v[16:19]
  v_exp_f32 v1, v1
  v_mfma_f32_16x16x32_bf16 v[16:19], a[140:143], v[172:175], v[16:19]
  v_cvt_pk_bf16_f32 v0, v0, v1
  v_mfma_f32_16x16x32_bf16 v[24:27], a[140:143], v[188:191], v[204:207]
  v_exp_f32 v2, v2
  v_mfma_f32_16x16x32_bf16 v[24:27], a[136:139], v[184:187], v[24:27]
  buffer_load_dwordx4 v236, s[16:19], s29 offen offset:2048 lds
  v_mfma_f32_16x16x32_bf16 v[24:27], a[132:135], v[180:183], v[24:27]
  s_waitcnt lgkmcnt(0)
  v_exp_f32 v3, v3
  v_mfma_f32_16x16x32_bf16 v[24:27], a[128:131], v[176:179], v[24:27]
  v_cvt_pk_bf16_f32 v1, v2, v3
  v_mfma_f32_16x16x32_bf16 v[4:7], a[144:147], v[128:131], v[192:195]
  v_exp_f32 v8, v8
  v_mfma_f32_16x16x32_bf16 v[4:7], a[148:151], v[132:135], v[4:7]
  ds_read_b128 a[128:131], v212 offset:8192
  v_mfma_f32_16x16x32_bf16 v[4:7], a[152:155], v[136:139], v[4:7]
  v_exp_f32 v9, v9
  v_mfma_f32_16x16x32_bf16 v[4:7], a[156:159], v[140:143], v[4:7]
  ds_read_b128 a[132:135], v213 offset:8192
  v_cvt_pk_bf16_f32 v8, v8, v9
  v_mfma_f32_16x16x32_bf16 v[12:15], a[156:159], v[156:159], v[196:199]
  v_exp_f32 v10, v10
  v_mfma_f32_16x16x32_bf16 v[12:15], a[152:155], v[152:155], v[12:15]
  ds_read_b128 a[136:139], v214 offset:8192
  v_mfma_f32_16x16x32_bf16 v[12:15], a[148:151], v[148:151], v[12:15]
  v_exp_f32 v11, v11
  v_mfma_f32_16x16x32_bf16 v[12:15], a[144:147], v[144:147], v[12:15]
  ds_read_b128 a[140:143], v215 offset:8192
  v_cvt_pk_bf16_f32 v9, v10, v11
  v_mfma_f32_16x16x32_bf16 v[20:23], a[144:147], v[160:163], v[200:203]
  v_exp_f32 v16, v16
  v_mfma_f32_16x16x32_bf16 v[20:23], a[148:151], v[164:167], v[20:23]
  buffer_load_dwordx4 v237, s[16:19], s29 offen offset:3072 lds
  v_mfma_f32_16x16x32_bf16 v[20:23], a[152:155], v[168:171], v[20:23]
  s_add_u32 s29, s29, 16384
  v_exp_f32 v17, v17
  v_mfma_f32_16x16x32_bf16 v[20:23], a[156:159], v[172:175], v[20:23]
  v_cvt_pk_bf16_f32 v16, v16, v17
  v_mfma_f32_16x16x32_bf16 v[28:31], a[156:159], v[188:191], v[204:207]
  s_add_u32 m0, s28, 32768
  v_exp_f32 v18, v18
  v_mfma_f32_16x16x32_bf16 v[28:31], a[152:155], v[184:187], v[28:31]
  buffer_load_dwordx4 v232, s[12:15], s29 offen offset:0 lds
  v_mfma_f32_16x16x32_bf16 v[28:31], a[148:151], v[180:183], v[28:31]
  s_waitcnt lgkmcnt(0)
  v_exp_f32 v19, v19
  v_mfma_f32_16x16x32_bf16 v[28:31], a[144:147], v[176:179], v[28:31]
  v_cvt_pk_bf16_f32 v17, v18, v19
  v_mfma_f32_16x16x32_bf16 v[32:35], a[128:131], v[128:131], v[192:195]
  v_exp_f32 v24, v24
  v_mfma_f32_16x16x32_bf16 v[32:35], a[132:135], v[132:135], v[32:35]
  ds_read_b128 a[144:147], v212 offset:12288
  v_mfma_f32_16x16x32_bf16 v[32:35], a[136:139], v[136:139], v[32:35]
  v_exp_f32 v25, v25
  v_mfma_f32_16x16x32_bf16 v[32:35], a[140:143], v[140:143], v[32:35]
  ds_read_b128 a[148:151], v213 offset:12288
  v_cvt_pk_bf16_f32 v24, v24, v25
  v_mfma_f32_16x16x32_bf16 v[40:43], a[140:143], v[156:159], v[196:199]
  v_exp_f32 v26, v26
  v_mfma_f32_16x16x32_bf16 v[40:43], a[136:139], v[152:155], v[40:43]
  ds_read_b128 a[152:155], v214 offset:12288
  v_mfma_f32_16x16x32_bf16 v[40:43], a[132:135], v[148:151], v[40:43]
  v_exp_f32 v27, v27
  v_mfma_f32_16x16x32_bf16 v[40:43], a[128:131], v[144:147], v[40:43]
  ds_read_b128 a[156:159], v215 offset:12288
  v_cvt_pk_bf16_f32 v25, v26, v27
  v_mfma_f32_16x16x32_bf16 v[48:51], a[128:131], v[160:163], v[200:203]
  v_exp_f32 v4, v4
  v_mfma_f32_16x16x32_bf16 v[48:51], a[132:135], v[164:167], v[48:51]
  buffer_load_dwordx4 v233, s[12:15], s29 offen offset:1024 lds
  v_mfma_f32_16x16x32_bf16 v[48:51], a[136:139], v[168:171], v[48:51]
  v_exp_f32 v5, v5
  v_mfma_f32_16x16x32_bf16 v[48:51], a[140:143], v[172:175], v[48:51]
  v_cvt_pk_bf16_f32 v2, v4, v5
  v_mfma_f32_16x16x32_bf16 v[56:59], a[140:143], v[188:191], v[204:207]
  v_exp_f32 v6, v6
  v_mfma_f32_16x16x32_bf16 v[56:59], a[136:139], v[184:187], v[56:59]
  buffer_load_dwordx4 v234, s[12:15], s29 offen offset:2048 lds
  v_mfma_f32_16x16x32_bf16 v[56:59], a[132:135], v[180:183], v[56:59]
  s_waitcnt lgkmcnt(0)
  v_exp_f32 v7, v7
  v_mfma_f32_16x16x32_bf16 v[56:59], a[128:131], v[176:179], v[56:59]
  v_cvt_pk_bf16_f32 v3, v6, v7
  v_mfma_f32_16x16x32_bf16 v[36:39], a[144:147], v[128:131], v[192:195]
  v_exp_f32 v12, v12
  v_mfma_f32_16x16x32_bf16 v[36:39], a[148:151], v[132:135], v[36:39]
  ds_read_b64_tr_b16 a[160:161], v216 offset:49152
  v_mfma_f32_16x16x32_bf16 v[36:39], a[152:155], v[136:139], v[36:39]
  v_exp_f32 v13, v13
  v_mfma_f32_16x16x32_bf16 v[36:39], a[156:159], v[140:143], v[36:39]
  ds_read_b64_tr_b16 a[162:163], v216 offset:53248
  v_cvt_pk_bf16_f32 v10, v12, v13
  v_mfma_f32_16x16x32_bf16 v[44:47], a[156:159], v[156:159], v[196:199]
  v_exp_f32 v14, v14
  v_mfma_f32_16x16x32_bf16 v[44:47], a[152:155], v[152:155], v[44:47]
  ds_read_b64_tr_b16 a[164:165], v216 offset:57344
  buffer_load_dwordx4 v235, s[12:15], s29 offen offset:3072 lds
  v_mfma_f32_16x16x32_bf16 v[44:47], a[148:151], v[148:151], v[44:47]
  v_exp_f32 v15, v15
  v_mfma_f32_16x16x32_bf16 v[44:47], a[144:147], v[144:147], v[44:47]
  ds_read_b64_tr_b16 a[166:167], v216 offset:61440
  v_cvt_pk_bf16_f32 v11, v14, v15
  v_mfma_f32_16x16x32_bf16 v[52:55], a[144:147], v[160:163], v[200:203]
  v_exp_f32 v20, v20
  v_mfma_f32_16x16x32_bf16 v[52:55], a[148:151], v[164:167], v[52:55]
  ds_read_b64_tr_b16 a[168:169], v217 offset:49152
  s_add_u32 m0, s50, 2048
  v_mfma_f32_16x16x32_bf16 v[52:55], a[152:155], v[168:171], v[52:55]
  v_exp_f32 v21, v21
  v_mfma_f32_16x16x32_bf16 v[52:55], a[156:159], v[172:175], v[52:55]
  ds_read_b64_tr_b16 a[170:171], v217 offset:53248
  v_cvt_pk_bf16_f32 v18, v20, v21
  v_mfma_f32_16x16x32_bf16 v[60:63], a[156:159], v[188:191], v[204:207]
  v_exp_f32 v22, v22
  v_mfma_f32_16x16x32_bf16 v[60:63], a[152:155], v[184:187], v[60:63]
  ds_read_b64_tr_b16 a[172:173], v217 offset:57344
  buffer_load_dwordx4 v253, s[20:23], s35 offen lds
  v_mfma_f32_16x16x32_bf16 v[60:63], a[148:151], v[180:183], v[60:63]
  v_exp_f32 v23, v23
  v_mfma_f32_16x16x32_bf16 v[60:63], a[144:147], v[176:179], v[60:63]
  ds_read_b64_tr_b16 a[174:175], v217 offset:61440
  v_cvt_pk_bf16_f32 v19, v22, v23
  v_mfma_f32_16x16x32_bf16 a[192:195], a[208:211], v[64:67], a[192:195]
  v_exp_f32 v28, v28
  v_mfma_f32_16x16x32_bf16 a[192:195], a[208:211], v[96:99], a[192:195]
  ds_read_b64_tr_b16 a[176:177], v218 offset:49152
  v_mfma_f32_16x16x32_bf16 a[196:199], a[208:211], v[72:75], a[196:199]
  v_exp_f32 v29, v29
  v_mfma_f32_16x16x32_bf16 a[196:199], a[208:211], v[104:107], a[196:199]
  ds_read_b64_tr_b16 a[178:179], v218 offset:53248
  v_cvt_pk_bf16_f32 v26, v28, v29
  v_mfma_f32_16x16x32_bf16 a[200:203], a[208:211], v[80:83], a[200:203]
  v_exp_f32 v30, v30
  v_mfma_f32_16x16x32_bf16 a[200:203], a[208:211], v[112:115], a[200:203]
  ds_read_b64_tr_b16 a[180:181], v218 offset:57344
  v_mfma_f32_16x16x32_bf16 a[204:207], a[208:211], v[88:91], a[204:207]
  s_waitcnt lgkmcnt(7)
  v_exp_f32 v31, v31
  v_mfma_f32_16x16x32_bf16 a[204:207], a[208:211], v[120:123], a[204:207]
  ds_read_b64_tr_b16 a[182:183], v218 offset:61440
  v_cvt_pk_bf16_f32 v27, v30, v31
  v_mfma_f32_16x16x32_bf16 a[0:3], a[160:163], v[64:67], a[0:3]
  v_exp_f32 v32, v32
  v_mfma_f32_16x16x32_bf16 a[0:3], a[164:167], v[96:99], a[0:3]
  ds_read_b64_tr_b16 a[184:185], v219 offset:49152
  v_mfma_f32_16x16x32_bf16 a[4:7], a[164:167], v[104:107], a[4:7]
  v_exp_f32 v33, v33
  v_mfma_f32_16x16x32_bf16 a[4:7], a[160:163], v[72:75], a[4:7]
  ds_read_b64_tr_b16 a[186:187], v219 offset:53248
  v_cvt_pk_bf16_f32 v32, v32, v33
  v_mfma_f32_16x16x32_bf16 a[8:11], a[160:163], v[80:83], a[8:11]
  v_exp_f32 v34, v34
  v_mfma_f32_16x16x32_bf16 a[8:11], a[164:167], v[112:115], a[8:11]
  ds_read_b64_tr_b16 a[188:189], v219 offset:57344
  v_mfma_f32_16x16x32_bf16 a[12:15], a[164:167], v[120:123], a[12:15]
  s_waitcnt lgkmcnt(7)
  v_exp_f32 v35, v35
  v_mfma_f32_16x16x32_bf16 a[12:15], a[160:163], v[88:91], a[12:15]
  ds_read_b64_tr_b16 a[190:191], v219 offset:61440
  v_cvt_pk_bf16_f32 v33, v34, v35
  v_mfma_f32_16x16x32_bf16 a[16:19], a[168:171], v[64:67], a[16:19]
  v_exp_f32 v40, v40
  v_mfma_f32_16x16x32_bf16 a[16:19], a[172:175], v[96:99], a[16:19]
  ds_read_b64_tr_b16 a[160:161], v220 offset:49152
  v_mfma_f32_16x16x32_bf16 a[20:23], a[172:175], v[104:107], a[20:23]
  v_exp_f32 v41, v41
  v_mfma_f32_16x16x32_bf16 a[20:23], a[168:171], v[72:75], a[20:23]
  ds_read_b64_tr_b16 a[162:163], v220 offset:53248
  v_cvt_pk_bf16_f32 v40, v40, v41
  v_mfma_f32_16x16x32_bf16 a[24:27], a[168:171], v[80:83], a[24:27]
  v_exp_f32 v42, v42
  v_mfma_f32_16x16x32_bf16 a[24:27], a[172:175], v[112:115], a[24:27]
  ds_read_b64_tr_b16 a[164:165], v220 offset:57344
  v_mfma_f32_16x16x32_bf16 a[28:31], a[172:175], v[120:123], a[28:31]
  s_waitcnt lgkmcnt(7)
  v_exp_f32 v43, v43
  v_mfma_f32_16x16x32_bf16 a[28:31], a[168:171], v[88:91], a[28:31]
  ds_read_b64_tr_b16 a[166:167], v220 offset:61440
  v_cvt_pk_bf16_f32 v41, v42, v43
  v_mfma_f32_16x16x32_bf16 a[32:35], a[176:179], v[64:67], a[32:35]
  v_exp_f32 v48, v48
  v_mfma_f32_16x16x32_bf16 a[32:35], a[180:183], v[96:99], a[32:35]
  ds_read_b64_tr_b16 a[168:169], v221 offset:49152
  v_mfma_f32_16x16x32_bf16 a[36:39], a[180:183], v[104:107], a[36:39]
  v_exp_f32 v49, v49
  v_mfma_f32_16x16x32_bf16 a[36:39], a[176:179], v[72:75], a[36:39]
  ds_read_b64_tr_b16 a[170:171], v221 offset:53248
  v_cvt_pk_bf16_f32 v48, v48, v49
  v_mfma_f32_16x16x32_bf16 a[40:43], a[176:179], v[80:83], a[40:43]
  v_exp_f32 v50, v50
  v_mfma_f32_16x16x32_bf16 a[40:43], a[180:183], v[112:115], a[40:43]
  ds_read_b64_tr_b16 a[172:173], v221 offset:57344
  v_mfma_f32_16x16x32_bf16 a[44:47], a[180:183], v[120:123], a[44:47]
  s_waitcnt lgkmcnt(7)
  v_exp_f32 v51, v51
  v_mfma_f32_16x16x32_bf16 a[44:47], a[176:179], v[88:91], a[44:47]
  ds_read_b64_tr_b16 a[174:175], v221 offset:61440
  v_cvt_pk_bf16_f32 v49, v50, v51
  v_mfma_f32_16x16x32_bf16 a[48:51], a[184:187], v[64:67], a[48:51]
  v_exp_f32 v56, v56
  v_mfma_f32_16x16x32_bf16 a[48:51], a[188:191], v[96:99], a[48:51]
  ds_read_b64_tr_b16 a[176:177], v222 offset:49152
  v_mfma_f32_16x16x32_bf16 a[52:55], a[188:191], v[104:107], a[52:55]
  v_exp_f32 v57, v57
  v_mfma_f32_16x16x32_bf16 a[52:55], a[184:187], v[72:75], a[52:55]
  ds_read_b64_tr_b16 a[178:179], v222 offset:53248
  v_cvt_pk_bf16_f32 v56, v56, v57
  v_mfma_f32_16x16x32_bf16 a[56:59], a[184:187], v[80:83], a[56:59]
  v_exp_f32 v58, v58
  v_mfma_f32_16x16x32_bf16 a[56:59], a[188:191], v[112:115], a[56:59]
  ds_read_b64_tr_b16 a[180:181], v222 offset:57344
  v_mfma_f32_16x16x32_bf16 a[60:63], a[188:191], v[120:123], a[60:63]
  s_waitcnt lgkmcnt(7)
  v_exp_f32 v59, v59
  v_mfma_f32_16x16x32_bf16 a[60:63], a[184:187], v[88:91], a[60:63]
  ds_read_b64_tr_b16 a[182:183], v222 offset:61440
  v_cvt_pk_bf16_f32 v57, v58, v59
  v_mfma_f32_16x16x32_bf16 a[64:67], a[160:163], v[64:67], a[64:67]
  v_exp_f32 v36, v36
  v_mfma_f32_16x16x32_bf16 a[64:67], a[164:167], v[96:99], a[64:67]
  ds_read_b64_tr_b16 a[184:185], v223 offset:49152
  v_mfma_f32_16x16x32_bf16 a[68:71], a[164:167], v[104:107], a[68:71]
  v_exp_f32 v37, v37
  v_mfma_f32_16x16x32_bf16 a[68:71], a[160:163], v[72:75], a[68:71]
  ds_read_b64_tr_b16 a[186:187], v223 offset:53248
  v_cvt_pk_bf16_f32 v34, v36, v37
  v_mfma_f32_16x16x32_bf16 a[72:75], a[160:163], v[80:83], a[72:75]
  v_exp_f32 v38, v38
  v_mfma_f32_16x16x32_bf16 a[72:75], a[164:167], v[112:115], a[72:75]
  ds_read_b64_tr_b16 a[188:189], v223 offset:57344
  v_mfma_f32_16x16x32_bf16 a[76:79], a[164:167], v[120:123], a[76:79]
  s_waitcnt lgkmcnt(7)
  v_exp_f32 v39, v39
  v_mfma_f32_16x16x32_bf16 a[76:79], a[160:163], v[88:91], a[76:79]
  ds_read_b64_tr_b16 a[190:191], v223 offset:61440
  v_cvt_pk_bf16_f32 v35, v38, v39
  v_mfma_f32_16x16x32_bf16 a[80:83], a[168:171], v[64:67], a[80:83]
  s_waitcnt vmcnt(11)
  v_exp_f32 v44, v44
  v_mfma_f32_16x16x32_bf16 a[80:83], a[172:175], v[96:99], a[80:83]
  v_mfma_f32_16x16x32_bf16 a[84:87], a[172:175], v[104:107], a[84:87]
  s_barrier
  v_exp_f32 v45, v45
  v_mfma_f32_16x16x32_bf16 a[84:87], a[168:171], v[72:75], a[84:87]
  ds_read_b128 a[128:131], v212 offset:16384
  v_cvt_pk_bf16_f32 v42, v44, v45
  v_mfma_f32_16x16x32_bf16 a[88:91], a[168:171], v[80:83], a[88:91]
  v_exp_f32 v46, v46
  v_mfma_f32_16x16x32_bf16 a[88:91], a[172:175], v[112:115], a[88:91]
  ds_read_b128 a[132:135], v213 offset:16384
  v_mfma_f32_16x16x32_bf16 a[92:95], a[172:175], v[120:123], a[92:95]
  s_waitcnt lgkmcnt(6)
  v_exp_f32 v47, v47
  v_mfma_f32_16x16x32_bf16 a[92:95], a[168:171], v[88:91], a[92:95]
  ds_read_b128 a[136:139], v214 offset:16384
  v_cvt_pk_bf16_f32 v43, v46, v47
  v_mfma_f32_16x16x32_bf16 a[96:99], a[176:179], v[64:67], a[96:99]
  v_exp_f32 v52, v52
  v_mfma_f32_16x16x32_bf16 a[96:99], a[180:183], v[96:99], a[96:99]
  ds_read_b128 a[140:143], v215 offset:16384
  buffer_load_dwordx4 a[224:227], v243, s[24:27], s38 offen sc1
  s_add_u32 s38, s38, 4096
  v_mfma_f32_16x16x32_bf16 a[100:103], a[180:183], v[104:107], a[100:103]
  v_exp_f32 v53, v53
  v_mfma_f32_16x16x32_bf16 a[100:103], a[176:179], v[72:75], a[100:103]
  v_cvt_pk_bf16_f32 v50, v52, v53
  v_mfma_f32_16x16x32_bf16 a[104:107], a[176:179], v[80:83], a[104:107]
  v_exp_f32 v54, v54
  v_mfma_f32_16x16x32_bf16 a[104:107], a[180:183], v[112:115], a[104:107]
  v_mfma_f32_16x16x32_bf16 a[108:111], a[180:183], v[120:123], a[108:111]
  s_waitcnt lgkmcnt(4)
  v_exp_f32 v55, v55
  v_mfma_f32_16x16x32_bf16 a[108:111], a[176:179], v[88:91], a[108:111]
  v_cvt_pk_bf16_f32 v51, v54, v55
  v_mfma_f32_16x16x32_bf16 a[112:115], a[184:187], v[64:67], a[112:115]
  v_exp_f32 v60, v60
  v_mfma_f32_16x16x32_bf16 a[112:115], a[188:191], v[96:99], a[112:115]
  v_mfma_f32_16x16x32_bf16 a[116:119], a[188:191], v[104:107], a[116:119]
  v_exp_f32 v61, v61
  v_mfma_f32_16x16x32_bf16 a[116:119], a[184:187], v[72:75], a[116:119]
  v_cvt_pk_bf16_f32 v58, v60, v61
  v_mfma_f32_16x16x32_bf16 a[120:123], a[184:187], v[80:83], a[120:123]
  v_exp_f32 v62, v62
  v_mfma_f32_16x16x32_bf16 a[120:123], a[188:191], v[112:115], a[120:123]
  v_mfma_f32_16x16x32_bf16 a[124:127], a[188:191], v[120:123], a[124:127]
  s_waitcnt lgkmcnt(0)
  v_exp_f32 v63, v63
  v_mfma_f32_16x16x32_bf16 a[124:127], a[184:187], v[88:91], a[124:127]
  v_cvt_pk_bf16_f32 v59, v62, v63
  v_mfma_f32_16x16x32_bf16 v[64:67], a[128:131], v[128:131], v[192:195]
  s_add_u32 m0, s28, 98304
  v_mfma_f32_16x16x32_bf16 v[64:67], a[132:135], v[132:135], v[64:67]
  ds_read_b128 a[144:147], v212 offset:20480
  v_mfma_f32_16x16x32_bf16 v[64:67], a[136:139], v[136:139], v[64:67]
  buffer_load_dwordx4 v236, s[16:19], s29 offen offset:0 lds
  v_mfma_f32_16x16x32_bf16 v[64:67], a[140:143], v[140:143], v[64:67]
  ds_read_b128 a[148:151], v213 offset:20480
  v_mfma_f32_16x16x32_bf16 v[72:75], a[140:143], v[156:159], v[196:199]
  v_mfma_f32_16x16x32_bf16 v[72:75], a[136:139], v[152:155], v[72:75]
  ds_read_b128 a[152:155], v214 offset:20480
  v_mfma_f32_16x16x32_bf16 v[72:75], a[132:135], v[148:151], v[72:75]
  buffer_load_dwordx4 v237, s[16:19], s29 offen offset:1024 lds
  v_mfma_f32_16x16x32_bf16 v[72:75], a[128:131], v[144:147], v[72:75]
  ds_read_b128 a[156:159], v215 offset:20480
  v_mfma_f32_16x16x32_bf16 v[80:83], a[128:131], v[160:163], v[200:203]
  v_exp_f32 v64, v64
  v_mfma_f32_16x16x32_bf16 v[80:83], a[132:135], v[164:167], v[80:83]
  v_mfma_f32_16x16x32_bf16 v[80:83], a[136:139], v[168:171], v[80:83]
  v_exp_f32 v65, v65
  v_mfma_f32_16x16x32_bf16 v[80:83], a[140:143], v[172:175], v[80:83]
  v_cvt_pk_bf16_f32 v64, v64, v65
  v_mfma_f32_16x16x32_bf16 v[88:91], a[140:143], v[188:191], v[204:207]
  v_exp_f32 v66, v66
  v_mfma_f32_16x16x32_bf16 v[88:91], a[136:139], v[184:187], v[88:91]
  buffer_load_dwordx4 v236, s[16:19], s29 offen offset:2048 lds
  v_mfma_f32_16x16x32_bf16 v[88:91], a[132:135], v[180:183], v[88:91]
  s_waitcnt lgkmcnt(0)
  v_exp_f32 v67, v67
  v_mfma_f32_16x16x32_bf16 v[88:91], a[128:131], v[176:179], v[88:91]
  v_cvt_pk_bf16_f32 v65, v66, v67
  v_mfma_f32_16x16x32_bf16 v[68:71], a[144:147], v[128:131], v[192:195]
  v_exp_f32 v72, v72
  v_mfma_f32_16x16x32_bf16 v[68:71], a[148:151], v[132:135], v[68:71]
  ds_read_b128 a[128:131], v212 offset:24576
  v_mfma_f32_16x16x32_bf16 v[68:71], a[152:155], v[136:139], v[68:71]
  v_exp_f32 v73, v73
  v_mfma_f32_16x16x32_bf16 v[68:71], a[156:159], v[140:143], v[68:71]
  ds_read_b128 a[132:135], v213 offset:24576
  v_cvt_pk_bf16_f32 v72, v72, v73
  v_mfma_f32_16x16x32_bf16 v[76:79], a[156:159], v[156:159], v[196:199]
  v_exp_f32 v74, v74
  v_mfma_f32_16x16x32_bf16 v[76:79], a[152:155], v[152:155], v[76:79]
  ds_read_b128 a[136:139], v214 offset:24576
  v_mfma_f32_16x16x32_bf16 v[76:79], a[148:151], v[148:151], v[76:79]
  v_exp_f32 v75, v75
  v_mfma_f32_16x16x32_bf16 v[76:79], a[144:147], v[144:147], v[76:79]
  ds_read_b128 a[140:143], v215 offset:24576
  v_cvt_pk_bf16_f32 v73, v74, v75
  v_mfma_f32_16x16x32_bf16 v[84:87], a[144:147], v[160:163], v[200:203]
  v_exp_f32 v80, v80
  v_mfma_f32_16x16x32_bf16 v[84:87], a[148:151], v[164:167], v[84:87]
  buffer_load_dwordx4 v237, s[16:19], s29 offen offset:3072 lds
  v_mfma_f32_16x16x32_bf16 v[84:87], a[152:155], v[168:171], v[84:87]
  s_add_u32 s29, s29, 16384
  v_exp_f32 v81, v81
  v_mfma_f32_16x16x32_bf16 v[84:87], a[156:159], v[172:175], v[84:87]
  v_cvt_pk_bf16_f32 v80, v80, v81
  v_mfma_f32_16x16x32_bf16 v[92:95], a[156:159], v[188:191], v[204:207]
  s_add_u32 m0, s28, 49152
  v_exp_f32 v82, v82
  v_mfma_f32_16x16x32_bf16 v[92:95], a[152:155], v[184:187], v[92:95]
  buffer_load_dwordx4 v232, s[12:15], s29 offen offset:0 lds
  v_mfma_f32_16x16x32_bf16 v[92:95], a[148:151], v[180:183], v[92:95]
  s_waitcnt lgkmcnt(0)
  v_exp_f32 v83, v83
  v_mfma_f32_16x16x32_bf16 v[92:95], a[144:147], v[176:179], v[92:95]
  v_cvt_pk_bf16_f32 v81, v82, v83
  v_mfma_f32_16x16x32_bf16 v[96:99], a[128:131], v[128:131], v[192:195]
  v_exp_f32 v88, v88
  v_mfma_f32_16x16x32_bf16 v[96:99], a[132:135], v[132:135], v[96:99]
  ds_read_b128 a[144:147], v212 offset:28672
  v_mfma_f32_16x16x32_bf16 v[96:99], a[136:139], v[136:139], v[96:99]
  v_exp_f32 v89, v89
  v_mfma_f32_16x16x32_bf16 v[96:99], a[140:143], v[140:143], v[96:99]
  ds_read_b128 a[148:151], v213 offset:28672
  v_cvt_pk_bf16_f32 v88, v88, v89
  v_mfma_f32_16x16x32_bf16 v[104:107], a[140:143], v[156:159], v[196:199]
  v_exp_f32 v90, v90
  v_mfma_f32_16x16x32_bf16 v[104:107], a[136:139], v[152:155], v[104:107]
  ds_read_b128 a[152:155], v214 offset:28672
  v_mfma_f32_16x16x32_bf16 v[104:107], a[132:135], v[148:151], v[104:107]
  v_exp_f32 v91, v91
  v_mfma_f32_16x16x32_bf16 v[104:107], a[128:131], v[144:147], v[104:107]
  ds_read_b128 a[156:159], v215 offset:28672
  v_cvt_pk_bf16_f32 v89, v90, v91
  v_mfma_f32_16x16x32_bf16 v[112:115], a[128:131], v[160:163], v[200:203]
  v_exp_f32 v68, v68
  v_mfma_f32_16x16x32_bf16 v[112:115], a[132:135], v[164:167], v[112:115]
  buffer_load_dwordx4 v233, s[12:15], s29 offen offset:1024 lds
  v_mfma_f32_16x16x32_bf16 v[112:115], a[136:139], v[168:171], v[112:115]
  v_exp_f32 v69, v69
  v_mfma_f32_16x16x32_bf16 v[112:115], a[140:143], v[172:175], v[112:115]
  v_cvt_pk_bf16_f32 v66, v68, v69
  v_mfma_f32_16x16x32_bf16 v[120:123], a[140:143], v[188:191], v[204:207]
  v_exp_f32 v70, v70
  v_mfma_f32_16x16x32_bf16 v[120:123], a[136:139], v[184:187], v[120:123]
  buffer_load_dwordx4 v234, s[12:15], s29 offen offset:2048 lds
  v_mfma_f32_16x16x32_bf16 v[120:123], a[132:135], v[180:183], v[120:123]
  s_waitcnt lgkmcnt(0)
  v_exp_f32 v71, v71
  v_mfma_f32_16x16x32_bf16 v[120:123], a[128:131], v[176:179], v[120:123]
  v_cvt_pk_bf16_f32 v67, v70, v71
  v_mfma_f32_16x16x32_bf16 v[100:103], a[144:147], v[128:131], v[192:195]
  v_exp_f32 v76, v76
  v_mfma_f32_16x16x32_bf16 v[100:103], a[148:151], v[132:135], v[100:103]
  ds_read_b64_tr_b16 a[160:161], v216 offset:0
  v_mfma_f32_16x16x32_bf16 v[100:103], a[152:155], v[136:139], v[100:103]
  v_exp_f32 v77, v77
  v_mfma_f32_16x16x32_bf16 v[100:103], a[156:159], v[140:143], v[100:103]
  ds_read_b64_tr_b16 a[162:163], v216 offset:4096
  v_cvt_pk_bf16_f32 v74, v76, v77
  v_mfma_f32_16x16x32_bf16 v[108:111], a[156:159], v[156:159], v[196:199]
  v_exp_f32 v78, v78
  v_mfma_f32_16x16x32_bf16 v[108:111], a[152:155], v[152:155], v[108:111]
  ds_read_b64_tr_b16 a[164:165], v216 offset:8192
  buffer_load_dwordx4 v235, s[12:15], s29 offen offset:3072 lds
  v_mfma_f32_16x16x32_bf16 v[108:111], a[148:151], v[148:151], v[108:111]
  v_exp_f32 v79, v79
  v_mfma_f32_16x16x32_bf16 v[108:111], a[144:147], v[144:147], v[108:111]
  ds_read_b64_tr_b16 a[166:167], v216 offset:12288
  v_cvt_pk_bf16_f32 v75, v78, v79
  v_mfma_f32_16x16x32_bf16 v[116:119], a[144:147], v[160:163], v[200:203]
  v_exp_f32 v84, v84
  v_mfma_f32_16x16x32_bf16 v[116:119], a[148:151], v[164:167], v[116:119]
  ds_read_b64_tr_b16 a[168:169], v217 offset:0
  s_add_u32 m0, s50, 5120
  v_mfma_f32_16x16x32_bf16 v[116:119], a[152:155], v[168:171], v[116:119]
  v_exp_f32 v85, v85
  v_mfma_f32_16x16x32_bf16 v[116:119], a[156:159], v[172:175], v[116:119]
  ds_read_b64_tr_b16 a[170:171], v217 offset:4096
  v_cvt_pk_bf16_f32 v82, v84, v85
  v_mfma_f32_16x16x32_bf16 v[124:127], a[156:159], v[188:191], v[204:207]
  v_exp_f32 v86, v86
  v_mfma_f32_16x16x32_bf16 v[124:127], a[152:155], v[184:187], v[124:127]
  ds_read_b64_tr_b16 a[172:173], v217 offset:8192
  buffer_load_dwordx4 v253, s[44:47], s35 offen lds
  s_add_u32 s35, s35, 221184
  v_mfma_f32_16x16x32_bf16 v[124:127], a[148:151], v[180:183], v[124:127]
  v_exp_f32 v87, v87
  v_mfma_f32_16x16x32_bf16 v[124:127], a[144:147], v[176:179], v[124:127]
  ds_read_b64_tr_b16 a[174:175], v217 offset:12288
  v_cvt_pk_bf16_f32 v83, v86, v87
  v_mfma_f32_16x16x32_bf16 a[192:195], a[208:211], v[0:3], a[192:195]
  v_exp_f32 v92, v92
  v_mfma_f32_16x16x32_bf16 a[192:195], a[208:211], v[32:35], a[192:195]
  ds_read_b64_tr_b16 a[176:177], v218 offset:0
  v_mfma_f32_16x16x32_bf16 a[196:199], a[208:211], v[8:11], a[196:199]
  v_exp_f32 v93, v93
  v_mfma_f32_16x16x32_bf16 a[196:199], a[208:211], v[40:43], a[196:199]
  ds_read_b64_tr_b16 a[178:179], v218 offset:4096
  v_cvt_pk_bf16_f32 v90, v92, v93
  v_mfma_f32_16x16x32_bf16 a[200:203], a[208:211], v[16:19], a[200:203]
  v_exp_f32 v94, v94
  v_mfma_f32_16x16x32_bf16 a[200:203], a[208:211], v[48:51], a[200:203]
  ds_read_b64_tr_b16 a[180:181], v218 offset:8192
  v_mfma_f32_16x16x32_bf16 a[204:207], a[208:211], v[24:27], a[204:207]
  s_waitcnt lgkmcnt(7)
  v_exp_f32 v95, v95
  v_mfma_f32_16x16x32_bf16 a[204:207], a[208:211], v[56:59], a[204:207]
  ds_read_b64_tr_b16 a[182:183], v218 offset:12288
  v_cvt_pk_bf16_f32 v91, v94, v95
  v_mfma_f32_16x16x32_bf16 a[0:3], a[160:163], v[0:3], a[0:3]
  v_exp_f32 v96, v96
  v_mfma_f32_16x16x32_bf16 a[0:3], a[164:167], v[32:35], a[0:3]
  ds_read_b64_tr_b16 a[184:185], v219 offset:0
  v_mfma_f32_16x16x32_bf16 a[4:7], a[164:167], v[40:43], a[4:7]
  v_exp_f32 v97, v97
  v_mfma_f32_16x16x32_bf16 a[4:7], a[160:163], v[8:11], a[4:7]
  ds_read_b64_tr_b16 a[186:187], v219 offset:4096
  v_cvt_pk_bf16_f32 v96, v96, v97
  v_mfma_f32_16x16x32_bf16 a[8:11], a[160:163], v[16:19], a[8:11]
  v_exp_f32 v98, v98
  v_mfma_f32_16x16x32_bf16 a[8:11], a[164:167], v[48:51], a[8:11]
  ds_read_b64_tr_b16 a[188:189], v219 offset:8192
  v_mfma_f32_16x16x32_bf16 a[12:15], a[164:167], v[56:59], a[12:15]
  s_waitcnt lgkmcnt(7)
  v_exp_f32 v99, v99
  v_mfma_f32_16x16x32_bf16 a[12:15], a[160:163], v[24:27], a[12:15]
  ds_read_b64_tr_b16 a[190:191], v219 offset:12288
  v_cvt_pk_bf16_f32 v97, v98, v99
  v_mfma_f32_16x16x32_bf16 a[16:19], a[168:171], v[0:3], a[16:19]
  v_exp_f32 v104, v104
  v_mfma_f32_16x16x32_bf16 a[16:19], a[172:175], v[32:35], a[16:19]
  ds_read_b64_tr_b16 a[160:161], v220 offset:0
  v_mfma_f32_16x16x32_bf16 a[20:23], a[172:175], v[40:43], a[20:23]
  v_exp_f32 v105, v105
  v_mfma_f32_16x16x32_bf16 a[20:23], a[168:171], v[8:11], a[20:23]
  ds_read_b64_tr_b16 a[162:163], v220 offset:4096
  v_cvt_pk_bf16_f32 v104, v104, v105
  v_mfma_f32_16x16x32_bf16 a[24:27], a[168:171], v[16:19], a[24:27]
  v_exp_f32 v106, v106
  v_mfma_f32_16x16x32_bf16 a[24:27], a[172:175], v[48:51], a[24:27]
  ds_read_b64_tr_b16 a[164:165], v220 offset:8192
  v_mfma_f32_16x16x32_bf16 a[28:31], a[172:175], v[56:59], a[28:31]
  s_waitcnt lgkmcnt(7)
  v_exp_f32 v107, v107
  v_mfma_f32_16x16x32_bf16 a[28:31], a[168:171], v[24:27], a[28:31]
  ds_read_b64_tr_b16 a[166:167], v220 offset:12288
  v_cvt_pk_bf16_f32 v105, v106, v107
  v_mfma_f32_16x16x32_bf16 a[32:35], a[176:179], v[0:3], a[32:35]
  v_exp_f32 v112, v112
  v_mfma_f32_16x16x32_bf16 a[32:35], a[180:183], v[32:35], a[32:35]
  ds_read_b64_tr_b16 a[168:169], v221 offset:0
  v_mfma_f32_16x16x32_bf16 a[36:39], a[180:183], v[40:43], a[36:39]
  v_exp_f32 v113, v113
  v_mfma_f32_16x16x32_bf16 a[36:39], a[176:179], v[8:11], a[36:39]
  ds_read_b64_tr_b16 a[170:171], v221 offset:4096
  v_cvt_pk_bf16_f32 v112, v112, v113
  v_mfma_f32_16x16x32_bf16 a[40:43], a[176:179], v[16:19], a[40:43]
  v_exp_f32 v114, v114
  v_mfma_f32_16x16x32_bf16 a[40:43], a[180:183], v[48:51], a[40:43]
  ds_read_b64_tr_b16 a[172:173], v221 offset:8192
  v_mfma_f32_16x16x32_bf16 a[44:47], a[180:183], v[56:59], a[44:47]
  s_waitcnt lgkmcnt(7)
  v_exp_f32 v115, v115
  v_mfma_f32_16x16x32_bf16 a[44:47], a[176:179], v[24:27], a[44:47]
  ds_read_b64_tr_b16 a[174:175], v221 offset:12288
  v_cvt_pk_bf16_f32 v113, v114, v115
  v_mfma_f32_16x16x32_bf16 a[48:51], a[184:187], v[0:3], a[48:51]
  v_exp_f32 v120, v120
  v_mfma_f32_16x16x32_bf16 a[48:51], a[188:191], v[32:35], a[48:51]
  ds_read_b64_tr_b16 a[176:177], v222 offset:0
  v_mfma_f32_16x16x32_bf16 a[52:55], a[188:191], v[40:43], a[52:55]
  v_exp_f32 v121, v121
  v_mfma_f32_16x16x32_bf16 a[52:55], a[184:187], v[8:11], a[52:55]
  ds_read_b64_tr_b16 a[178:179], v222 offset:4096
  v_cvt_pk_bf16_f32 v120, v120, v121
  v_mfma_f32_16x16x32_bf16 a[56:59], a[184:187], v[16:19], a[56:59]
  v_exp_f32 v122, v122
  v_mfma_f32_16x16x32_bf16 a[56:59], a[188:191], v[48:51], a[56:59]
  ds_read_b64_tr_b16 a[180:181], v222 offset:8192
  v_mfma_f32_16x16x32_bf16 a[60:63], a[188:191], v[56:59], a[60:63]
  s_waitcnt lgkmcnt(7)
  v_exp_f32 v123, v123
  v_mfma_f32_16x16x32_bf16 a[60:63], a[184:187], v[24:27], a[60:63]
  ds_read_b64_tr_b16 a[182:183], v222 offset:12288
  v_cvt_pk_bf16_f32 v121, v122, v123
  v_mfma_f32_16x16x32_bf16 a[64:67], a[160:163], v[0:3], a[64:67]
  v_exp_f32 v100, v100
  v_mfma_f32_16x16x32_bf16 a[64:67], a[164:167], v[32:35], a[64:67]
  ds_read_b64_tr_b16 a[184:185], v223 offset:0
  v_mfma_f32_16x16x32_bf16 a[68:71], a[164:167], v[40:43], a[68:71]
  v_exp_f32 v101, v101
  v_mfma_f32_16x16x32_bf16 a[68:71], a[160:163], v[8:11], a[68:71]
  ds_read_b64_tr_b16 a[186:187], v223 offset:4096
  v_cvt_pk_bf16_f32 v98, v100, v101
  v_mfma_f32_16x16x32_bf16 a[72:75], a[160:163], v[16:19], a[72:75]
  v_exp_f32 v102, v102
  v_mfma_f32_16x16x32_bf16 a[72:75], a[164:167], v[48:51], a[72:75]
  ds_read_b64_tr_b16 a[188:189], v223 offset:8192
  v_mfma_f32_16x16x32_bf16 a[76:79], a[164:167], v[56:59], a[76:79]
  s_waitcnt lgkmcnt(7)
  v_exp_f32 v103, v103
  v_mfma_f32_16x16x32_bf16 a[76:79], a[160:163], v[24:27], a[76:79]
  ds_read_b64_tr_b16 a[190:191], v223 offset:12288
  v_cvt_pk_bf16_f32 v99, v102, v103
  v_mfma_f32_16x16x32_bf16 a[80:83], a[168:171], v[0:3], a[80:83]
  s_waitcnt vmcnt(11)
  v_exp_f32 v108, v108
  v_mfma_f32_16x16x32_bf16 a[80:83], a[172:175], v[32:35], a[80:83]
  v_mfma_f32_16x16x32_bf16 a[84:87], a[172:175], v[40:43], a[84:87]
  s_barrier
  v_exp_f32 v109, v109
  v_mfma_f32_16x16x32_bf16 a[84:87], a[168:171], v[8:11], a[84:87]
  ds_read_b128 a[128:131], v212 offset:32768
  v_cvt_pk_bf16_f32 v106, v108, v109
  v_mfma_f32_16x16x32_bf16 a[88:91], a[168:171], v[16:19], a[88:91]
  v_exp_f32 v110, v110
  v_mfma_f32_16x16x32_bf16 a[88:91], a[172:175], v[48:51], a[88:91]
  ds_read_b128 a[132:135], v213 offset:32768
  v_mfma_f32_16x16x32_bf16 a[92:95], a[172:175], v[56:59], a[92:95]
  s_waitcnt lgkmcnt(6)
  v_exp_f32 v111, v111
  v_mfma_f32_16x16x32_bf16 a[92:95], a[168:171], v[24:27], a[92:95]
  ds_read_b128 a[136:139], v214 offset:32768
  v_cvt_pk_bf16_f32 v107, v110, v111
  v_mfma_f32_16x16x32_bf16 a[96:99], a[176:179], v[0:3], a[96:99]
  v_exp_f32 v116, v116
  v_mfma_f32_16x16x32_bf16 a[96:99], a[180:183], v[32:35], a[96:99]
  ds_read_b128 a[140:143], v215 offset:32768
  buffer_load_dwordx4 a[228:231], v243, s[24:27], s38 offen sc1
  s_add_u32 s38, s38, 4096
  v_mfma_f32_16x16x32_bf16 a[100:103], a[180:183], v[40:43], a[100:103]
  v_exp_f32 v117, v117
  v_mfma_f32_16x16x32_bf16 a[100:103], a[176:179], v[8:11], a[100:103]
  v_cvt_pk_bf16_f32 v114, v116, v117
  v_mfma_f32_16x16x32_bf16 a[104:107], a[176:179], v[16:19], a[104:107]
  v_exp_f32 v118, v118
  v_mfma_f32_16x16x32_bf16 a[104:107], a[180:183], v[48:51], a[104:107]
  v_mfma_f32_16x16x32_bf16 a[108:111], a[180:183], v[56:59], a[108:111]
  s_waitcnt lgkmcnt(4)
  v_exp_f32 v119, v119
  v_mfma_f32_16x16x32_bf16 a[108:111], a[176:179], v[24:27], a[108:111]
  v_cvt_pk_bf16_f32 v115, v118, v119
  v_mfma_f32_16x16x32_bf16 a[112:115], a[184:187], v[0:3], a[112:115]
  v_exp_f32 v124, v124
  v_mfma_f32_16x16x32_bf16 a[112:115], a[188:191], v[32:35], a[112:115]
  v_mfma_f32_16x16x32_bf16 a[116:119], a[188:191], v[40:43], a[116:119]
  v_exp_f32 v125, v125
  v_mfma_f32_16x16x32_bf16 a[116:119], a[184:187], v[8:11], a[116:119]
  v_cvt_pk_bf16_f32 v122, v124, v125
  v_mfma_f32_16x16x32_bf16 a[120:123], a[184:187], v[16:19], a[120:123]
  v_exp_f32 v126, v126
  v_mfma_f32_16x16x32_bf16 a[120:123], a[188:191], v[48:51], a[120:123]
  v_mfma_f32_16x16x32_bf16 a[124:127], a[188:191], v[56:59], a[124:127]
  s_waitcnt lgkmcnt(0)
  v_exp_f32 v127, v127
  v_mfma_f32_16x16x32_bf16 a[124:127], a[184:187], v[24:27], a[124:127]
  v_cvt_pk_bf16_f32 v123, v126, v127
  v_mfma_f32_16x16x32_bf16 v[0:3], a[128:131], v[128:131], v[192:195]
  s_add_u32 m0, s28, 114688
  s_mov_b32 s20, s88
  s_mov_b32 s21, s89
  v_mfma_f32_16x16x32_bf16 v[0:3], a[132:135], v[132:135], v[0:3]
  ds_read_b128 a[144:147], v212 offset:36864
  s_mov_b32 s22, 5242880
  s_mov_b32 s23, 0x20000
  v_lshrrev_b32 v208, 4, v242
  v_mfma_f32_16x16x32_bf16 v[0:3], a[136:139], v[136:139], v[0:3]
  buffer_load_dwordx4 v236, s[16:19], s29 offen offset:0 lds
  v_mfma_f32_16x16x32_bf16 v[0:3], a[140:143], v[140:143], v[0:3]
  ds_read_b128 a[148:151], v213 offset:36864
  v_and_b32 v209, 1, v208
  v_mfma_f32_16x16x32_bf16 v[8:11], a[140:143], v[156:159], v[196:199]
  v_lshrrev_b32 v208, 1, v208
  v_mul_u32_u24 v208, 0x500, v208
  v_mfma_f32_16x16x32_bf16 v[8:11], a[136:139], v[152:155], v[8:11]
  ds_read_b128 a[152:155], v214 offset:36864
  v_lshl_add_u32 v208, v209, 4, v208
  v_mfma_f32_16x16x32_bf16 v[8:11], a[132:135], v[148:151], v[8:11]
  buffer_load_dwordx4 v237, s[16:19], s29 offen offset:1024 lds
  v_mfma_f32_16x16x32_bf16 v[8:11], a[128:131], v[144:147], v[8:11]
  ds_read_b128 a[156:159], v215 offset:36864
  v_lshrrev_b32 v209, 4, v242
  v_mfma_f32_16x16x32_bf16 v[16:19], a[128:131], v[160:163], v[200:203]
  v_exp_f32 v0, v0
  v_mfma_f32_16x16x32_bf16 v[16:19], a[132:135], v[164:167], v[16:19]
  v_lshrrev_b32 v210, 5, v209
  v_lshlrev_b32 v210, 30, v210
  v_mfma_f32_16x16x32_bf16 v[16:19], a[136:139], v[168:171], v[16:19]
  v_exp_f32 v1, v1
  v_mfma_f32_16x16x32_bf16 v[16:19], a[140:143], v[172:175], v[16:19]
  v_cvt_pk_bf16_f32 v0, v0, v1
  v_or_b32 v210, v210, v208
  v_mfma_f32_16x16x32_bf16 v[24:27], a[140:143], v[188:191], v[204:207]
  v_exp_f32 v2, v2
  v_mfma_f32_16x16x32_bf16 v[24:27], a[136:139], v[184:187], v[24:27]
  buffer_load_dwordx4 v236, s[16:19], s29 offen offset:2048 lds
  v_mfma_f32_16x16x32_bf16 v[24:27], a[132:135], v[180:183], v[24:27]
  s_waitcnt lgkmcnt(0)
  v_exp_f32 v3, v3
  v_mfma_f32_16x16x32_bf16 v[24:27], a[128:131], v[176:179], v[24:27]
  v_cvt_pk_bf16_f32 v1, v2, v3
  v_bfe_u32 v211, v209, 2, 4
  v_mfma_f32_16x16x32_bf16 v[4:7], a[144:147], v[128:131], v[192:195]
  v_exp_f32 v8, v8
  v_mfma_f32_16x16x32_bf16 v[4:7], a[148:151], v[132:135], v[4:7]
  ds_read_b128 a[128:131], v212 offset:40960
  v_and_b32 v209, 3, v209
  v_mfma_f32_16x16x32_bf16 v[4:7], a[152:155], v[136:139], v[4:7]
  v_exp_f32 v9, v9
  v_mfma_f32_16x16x32_bf16 v[4:7], a[156:159], v[140:143], v[4:7]
  ds_read_b128 a[132:135], v213 offset:40960
  v_cvt_pk_bf16_f32 v8, v8, v9
  v_mfma_f32_16x16x32_bf16 v[12:15], a[156:159], v[156:159], v[196:199]
  v_exp_f32 v10, v10
  v_mfma_f32_16x16x32_bf16 v[12:15], a[152:155], v[152:155], v[12:15]
  ds_read_b128 a[136:139], v214 offset:40960
  v_lshlrev_b32 v209, 3, v209
  v_mfma_f32_16x16x32_bf16 v[12:15], a[148:151], v[148:151], v[12:15]
  v_exp_f32 v11, v11
  v_mfma_f32_16x16x32_bf16 v[12:15], a[144:147], v[144:147], v[12:15]
  ds_read_b128 a[140:143], v215 offset:40960
  v_cvt_pk_bf16_f32 v9, v10, v11
  v_mfma_f32_16x16x32_bf16 v[20:23], a[144:147], v[160:163], v[200:203]
  v_exp_f32 v16, v16
  v_mfma_f32_16x16x32_bf16 v[20:23], a[148:151], v[164:167], v[20:23]
  buffer_load_dwordx4 v237, s[16:19], s29 offen offset:3072 lds
  v_mfma_f32_16x16x32_bf16 v[20:23], a[152:155], v[168:171], v[20:23]
  s_add_u32 s29, s29, 16384
  v_exp_f32 v17, v17
  v_mfma_f32_16x16x32_bf16 v[20:23], a[156:159], v[172:175], v[20:23]
  v_cvt_pk_bf16_f32 v16, v16, v17
  v_lshl_add_u32 v209, v211, 5, v209
  v_mfma_f32_16x16x32_bf16 v[28:31], a[156:159], v[188:191], v[204:207]
  s_add_u32 m0, s28, 0
  v_exp_f32 v18, v18
  v_mfma_f32_16x16x32_bf16 v[28:31], a[152:155], v[184:187], v[28:31]
  buffer_load_dwordx4 v232, s[12:15], s29 offen offset:0 lds
  v_mfma_f32_16x16x32_bf16 v[28:31], a[148:151], v[180:183], v[28:31]
  s_waitcnt lgkmcnt(0)
  v_exp_f32 v19, v19
  v_mfma_f32_16x16x32_bf16 v[28:31], a[144:147], v[176:179], v[28:31]
  v_cvt_pk_bf16_f32 v17, v18, v19
  v_add_u32 v209, s50, v209
  v_mfma_f32_16x16x32_bf16 v[32:35], a[128:131], v[128:131], v[192:195]
  s_and_b32 s39, s2, 1
  s_lshl_b32 s39, s39, 2
  s_add_u32 s39, s39, s3
  v_exp_f32 v24, v24
  v_mfma_f32_16x16x32_bf16 v[32:35], a[132:135], v[132:135], v[32:35]
  ds_read_b128 a[144:147], v212 offset:45056
  s_lshr_b32 s31, s2, 1
  s_mul_i32 s30, s31, 40960
  s_mul_i32 s48, s39, 160
  v_mfma_f32_16x16x32_bf16 v[32:35], a[136:139], v[136:139], v[32:35]
  s_add_u32 s30, s30, s48
  s_mul_i32 s31, s31, 5120
  s_mul_i32 s39, s39, 655360
  v_exp_f32 v25, v25
  v_mfma_f32_16x16x32_bf16 v[32:35], a[140:143], v[140:143], v[32:35]
  ds_read_b128 a[148:151], v213 offset:45056
  s_add_u32 s31, s31, s39
  s_add_u32 s31, s31, 3145728
  s_lshr_b32 s39, s2, 3
  v_cvt_pk_bf16_f32 v24, v24, v25
  v_mfma_f32_16x16x32_bf16 v[40:43], a[140:143], v[156:159], v[196:199]
  s_min_u32 s39, s39, 29
  s_and_b32 s48, s2, 7
  s_mul_i32 s48, s48, 30
  v_exp_f32 v26, v26
  v_mfma_f32_16x16x32_bf16 v[40:43], a[136:139], v[152:155], v[40:43]
  ds_read_b128 a[152:155], v214 offset:45056
  s_add_u32 s39, s39, s48
  s_mul_i32 s98, s39, 1639
  s_lshr_b32 s98, s98, 16
  v_mfma_f32_16x16x32_bf16 v[40:43], a[132:135], v[148:151], v[40:43]
  s_mul_i32 s99, s98, 40
  s_sub_u32 s99, s39, s99
  s_min_u32 s39, s3, 2
  v_exp_f32 v27, v27
  v_mfma_f32_16x16x32_bf16 v[40:43], a[128:131], v[144:147], v[40:43]
  ds_read_b128 a[156:159], v215 offset:45056
  s_mul_i32 s48, s98, 3
  s_add_u32 s48, s48, s39
  s_mul_i32 s100, s48, 122880
  v_cvt_pk_bf16_f32 v25, v26, v27
  v_mfma_f32_16x16x32_bf16 v[48:51], a[128:131], v[160:163], v[200:203]
  s_lshl_b32 s39, s99, 5
  s_add_u32 s100, s100, s39
  s_mul_i32 s101, s48, 192
  v_exp_f32 v4, v4
  v_mfma_f32_16x16x32_bf16 v[48:51], a[132:135], v[164:167], v[48:51]
  buffer_load_dwordx4 v233, s[12:15], s29 offen offset:1024 lds
  s_add_u32 s101, s101, 2633728
  s_mov_b32 s51, s50
  v_mfma_f32_16x16x32_bf16 v[48:51], a[136:139], v[168:171], v[48:51]
  v_exp_f32 v5, v5
  v_mfma_f32_16x16x32_bf16 v[48:51], a[140:143], v[172:175], v[48:51]
  v_cvt_pk_bf16_f32 v2, v4, v5
  v_mov_b32 v211, v242
  v_mfma_f32_16x16x32_bf16 v[56:59], a[140:143], v[188:191], v[204:207]
  s_mov_b32 s4, s94
  s_mov_b32 s5, s95
  s_mov_b32 s6, 2211840
  v_exp_f32 v6, v6
  v_mfma_f32_16x16x32_bf16 v[56:59], a[136:139], v[184:187], v[56:59]
  buffer_load_dwordx4 v234, s[12:15], s29 offen offset:2048 lds
  s_mov_b32 s7, 0x20000
  v_mfma_f32_16x16x32_bf16 v[56:59], a[132:135], v[180:183], v[56:59]
  s_waitcnt lgkmcnt(0)
  v_exp_f32 v7, v7
  v_mfma_f32_16x16x32_bf16 v[56:59], a[128:131], v[176:179], v[56:59]
  v_cvt_pk_bf16_f32 v3, v6, v7
  v_mfma_f32_16x16x32_bf16 v[36:39], a[144:147], v[128:131], v[192:195]
  v_exp_f32 v12, v12
  v_mfma_f32_16x16x32_bf16 v[36:39], a[148:151], v[132:135], v[36:39]
  ds_read_b64_tr_b16 a[160:161], v216 offset:16384
  v_mfma_f32_16x16x32_bf16 v[36:39], a[152:155], v[136:139], v[36:39]
  v_exp_f32 v13, v13
  v_mfma_f32_16x16x32_bf16 v[36:39], a[156:159], v[140:143], v[36:39]
  ds_read_b64_tr_b16 a[162:163], v216 offset:20480
  v_cvt_pk_bf16_f32 v10, v12, v13
  v_mfma_f32_16x16x32_bf16 v[44:47], a[156:159], v[156:159], v[196:199]
  v_exp_f32 v14, v14
  v_mfma_f32_16x16x32_bf16 v[44:47], a[152:155], v[152:155], v[44:47]
  ds_read_b64_tr_b16 a[164:165], v216 offset:24576
  buffer_load_dwordx4 v235, s[12:15], s29 offen offset:3072 lds
  v_mfma_f32_16x16x32_bf16 v[44:47], a[148:151], v[148:151], v[44:47]
  v_exp_f32 v15, v15
  v_mfma_f32_16x16x32_bf16 v[44:47], a[144:147], v[144:147], v[44:47]
  ds_read_b64_tr_b16 a[166:167], v216 offset:28672
  v_cvt_pk_bf16_f32 v11, v14, v15
  v_mfma_f32_16x16x32_bf16 v[52:55], a[144:147], v[160:163], v[200:203]
  v_exp_f32 v20, v20
  v_mfma_f32_16x16x32_bf16 v[52:55], a[148:151], v[164:167], v[52:55]
  ds_read_b64_tr_b16 a[168:169], v217 offset:16384
  v_mfma_f32_16x16x32_bf16 v[52:55], a[152:155], v[168:171], v[52:55]
  v_exp_f32 v21, v21
  v_mfma_f32_16x16x32_bf16 v[52:55], a[156:159], v[172:175], v[52:55]
  ds_read_b64_tr_b16 a[170:171], v217 offset:20480
  v_cvt_pk_bf16_f32 v18, v20, v21
  v_mfma_f32_16x16x32_bf16 v[60:63], a[156:159], v[188:191], v[204:207]
  v_exp_f32 v22, v22
  v_mfma_f32_16x16x32_bf16 v[60:63], a[152:155], v[184:187], v[60:63]
  ds_read_b64_tr_b16 a[172:173], v217 offset:24576
  v_mfma_f32_16x16x32_bf16 v[60:63], a[148:151], v[180:183], v[60:63]
  v_exp_f32 v23, v23
  v_mfma_f32_16x16x32_bf16 v[60:63], a[144:147], v[176:179], v[60:63]
  ds_read_b64_tr_b16 a[174:175], v217 offset:28672
  v_cvt_pk_bf16_f32 v19, v22, v23
  v_mfma_f32_16x16x32_bf16 a[192:195], a[208:211], v[64:67], a[192:195]
  v_exp_f32 v28, v28
  v_mfma_f32_16x16x32_bf16 a[192:195], a[208:211], v[96:99], a[192:195]
  ds_read_b64_tr_b16 a[176:177], v218 offset:16384
  v_mfma_f32_16x16x32_bf16 a[196:199], a[208:211], v[72:75], a[196:199]
  v_exp_f32 v29, v29
  v_mfma_f32_16x16x32_bf16 a[196:199], a[208:211], v[104:107], a[196:199]
  ds_read_b64_tr_b16 a[178:179], v218 offset:20480
  v_cvt_pk_bf16_f32 v26, v28, v29
  v_mfma_f32_16x16x32_bf16 a[200:203], a[208:211], v[80:83], a[200:203]
  v_exp_f32 v30, v30
  v_mfma_f32_16x16x32_bf16 a[200:203], a[208:211], v[112:115], a[200:203]
  ds_read_b64_tr_b16 a[180:181], v218 offset:24576
  v_mfma_f32_16x16x32_bf16 a[204:207], a[208:211], v[88:91], a[204:207]
  s_waitcnt lgkmcnt(7)
  v_exp_f32 v31, v31
  v_mfma_f32_16x16x32_bf16 a[204:207], a[208:211], v[120:123], a[204:207]
  ds_read_b64_tr_b16 a[182:183], v218 offset:28672
  v_cvt_pk_bf16_f32 v27, v30, v31
  v_mfma_f32_16x16x32_bf16 a[0:3], a[160:163], v[64:67], a[0:3]
  v_exp_f32 v32, v32
  v_mfma_f32_16x16x32_bf16 a[0:3], a[164:167], v[96:99], a[0:3]
  ds_read_b64_tr_b16 a[184:185], v219 offset:16384
  v_mfma_f32_16x16x32_bf16 a[4:7], a[164:167], v[104:107], a[4:7]
  v_exp_f32 v33, v33
  v_mfma_f32_16x16x32_bf16 a[4:7], a[160:163], v[72:75], a[4:7]
  ds_read_b64_tr_b16 a[186:187], v219 offset:20480
  v_cvt_pk_bf16_f32 v32, v32, v33
  v_mfma_f32_16x16x32_bf16 a[8:11], a[160:163], v[80:83], a[8:11]
  v_exp_f32 v34, v34
  v_mfma_f32_16x16x32_bf16 a[8:11], a[164:167], v[112:115], a[8:11]
  ds_read_b64_tr_b16 a[188:189], v219 offset:24576
  v_mfma_f32_16x16x32_bf16 a[12:15], a[164:167], v[120:123], a[12:15]
  s_waitcnt lgkmcnt(7)
  v_exp_f32 v35, v35
  v_mfma_f32_16x16x32_bf16 a[12:15], a[160:163], v[88:91], a[12:15]
  ds_read_b64_tr_b16 a[190:191], v219 offset:28672
  v_cvt_pk_bf16_f32 v33, v34, v35
  v_mfma_f32_16x16x32_bf16 a[16:19], a[168:171], v[64:67], a[16:19]
  v_exp_f32 v40, v40
  v_mfma_f32_16x16x32_bf16 a[16:19], a[172:175], v[96:99], a[16:19]
  ds_read_b64_tr_b16 a[160:161], v220 offset:16384
  v_mfma_f32_16x16x32_bf16 a[20:23], a[172:175], v[104:107], a[20:23]
  v_exp_f32 v41, v41
  v_mfma_f32_16x16x32_bf16 a[20:23], a[168:171], v[72:75], a[20:23]
  ds_read_b64_tr_b16 a[162:163], v220 offset:20480
  v_cvt_pk_bf16_f32 v40, v40, v41
  v_mfma_f32_16x16x32_bf16 a[24:27], a[168:171], v[80:83], a[24:27]
  v_exp_f32 v42, v42
  v_mfma_f32_16x16x32_bf16 a[24:27], a[172:175], v[112:115], a[24:27]
  ds_read_b64_tr_b16 a[164:165], v220 offset:24576
  v_mfma_f32_16x16x32_bf16 a[28:31], a[172:175], v[120:123], a[28:31]
  s_waitcnt lgkmcnt(7)
  v_exp_f32 v43, v43
  v_mfma_f32_16x16x32_bf16 a[28:31], a[168:171], v[88:91], a[28:31]
  ds_read_b64_tr_b16 a[166:167], v220 offset:28672
  v_cvt_pk_bf16_f32 v41, v42, v43
  v_mfma_f32_16x16x32_bf16 a[32:35], a[176:179], v[64:67], a[32:35]
  v_exp_f32 v48, v48
  v_mfma_f32_16x16x32_bf16 a[32:35], a[180:183], v[96:99], a[32:35]
  ds_read_b64_tr_b16 a[168:169], v221 offset:16384
  v_mfma_f32_16x16x32_bf16 a[36:39], a[180:183], v[104:107], a[36:39]
  v_exp_f32 v49, v49
  v_mfma_f32_16x16x32_bf16 a[36:39], a[176:179], v[72:75], a[36:39]
  ds_read_b64_tr_b16 a[170:171], v221 offset:20480
  v_cvt_pk_bf16_f32 v48, v48, v49
  v_mfma_f32_16x16x32_bf16 a[40:43], a[176:179], v[80:83], a[40:43]
  v_exp_f32 v50, v50
  v_mfma_f32_16x16x32_bf16 a[40:43], a[180:183], v[112:115], a[40:43]
  ds_read_b64_tr_b16 a[172:173], v221 offset:24576
  v_mfma_f32_16x16x32_bf16 a[44:47], a[180:183], v[120:123], a[44:47]
  s_waitcnt lgkmcnt(7)
  v_exp_f32 v51, v51
  v_mfma_f32_16x16x32_bf16 a[44:47], a[176:179], v[88:91], a[44:47]
  ds_read_b64_tr_b16 a[174:175], v221 offset:28672
  v_cvt_pk_bf16_f32 v49, v50, v51
  v_mfma_f32_16x16x32_bf16 a[48:51], a[184:187], v[64:67], a[48:51]
  v_exp_f32 v56, v56
  v_mfma_f32_16x16x32_bf16 a[48:51], a[188:191], v[96:99], a[48:51]
  ds_read_b64_tr_b16 a[176:177], v222 offset:16384
  v_mfma_f32_16x16x32_bf16 a[52:55], a[188:191], v[104:107], a[52:55]
  v_exp_f32 v57, v57
  v_mfma_f32_16x16x32_bf16 a[52:55], a[184:187], v[72:75], a[52:55]
  ds_read_b64_tr_b16 a[178:179], v222 offset:20480
  v_cvt_pk_bf16_f32 v56, v56, v57
  v_mfma_f32_16x16x32_bf16 a[56:59], a[184:187], v[80:83], a[56:59]
  v_exp_f32 v58, v58
  v_mfma_f32_16x16x32_bf16 a[56:59], a[188:191], v[112:115], a[56:59]
  ds_read_b64_tr_b16 a[180:181], v222 offset:24576
  v_mfma_f32_16x16x32_bf16 a[60:63], a[188:191], v[120:123], a[60:63]
  s_waitcnt lgkmcnt(7)
  v_exp_f32 v59, v59
  v_mfma_f32_16x16x32_bf16 a[60:63], a[184:187], v[88:91], a[60:63]
  ds_read_b64_tr_b16 a[182:183], v222 offset:28672
  v_cvt_pk_bf16_f32 v57, v58, v59
  v_mfma_f32_16x16x32_bf16 a[64:67], a[160:163], v[64:67], a[64:67]
  v_exp_f32 v36, v36
  v_mfma_f32_16x16x32_bf16 a[64:67], a[164:167], v[96:99], a[64:67]
  ds_read_b64_tr_b16 a[184:185], v223 offset:16384
  v_mfma_f32_16x16x32_bf16 a[68:71], a[164:167], v[104:107], a[68:71]
  v_exp_f32 v37, v37
  v_mfma_f32_16x16x32_bf16 a[68:71], a[160:163], v[72:75], a[68:71]
  ds_read_b64_tr_b16 a[186:187], v223 offset:20480
  v_cvt_pk_bf16_f32 v34, v36, v37
  v_mfma_f32_16x16x32_bf16 a[72:75], a[160:163], v[80:83], a[72:75]
  v_exp_f32 v38, v38
  v_mfma_f32_16x16x32_bf16 a[72:75], a[164:167], v[112:115], a[72:75]
  ds_read_b64_tr_b16 a[188:189], v223 offset:24576
  v_mfma_f32_16x16x32_bf16 a[76:79], a[164:167], v[120:123], a[76:79]
  s_waitcnt lgkmcnt(7)
  v_exp_f32 v39, v39
  v_mfma_f32_16x16x32_bf16 a[76:79], a[160:163], v[88:91], a[76:79]
  ds_read_b64_tr_b16 a[190:191], v223 offset:28672
  v_cvt_pk_bf16_f32 v35, v38, v39
  v_mfma_f32_16x16x32_bf16 a[80:83], a[168:171], v[64:67], a[80:83]
  s_waitcnt vmcnt(10)
  v_exp_f32 v44, v44
  v_mfma_f32_16x16x32_bf16 a[80:83], a[172:175], v[96:99], a[80:83]
  v_mfma_f32_16x16x32_bf16 a[84:87], a[172:175], v[104:107], a[84:87]
  s_barrier
  v_exp_f32 v45, v45
  v_mfma_f32_16x16x32_bf16 a[84:87], a[168:171], v[72:75], a[84:87]
  ds_read_b128 a[128:131], v212 offset:49152
  v_cvt_pk_bf16_f32 v42, v44, v45
  v_mfma_f32_16x16x32_bf16 a[88:91], a[168:171], v[80:83], a[88:91]
  v_exp_f32 v46, v46
  v_mfma_f32_16x16x32_bf16 a[88:91], a[172:175], v[112:115], a[88:91]
  ds_read_b128 a[132:135], v213 offset:49152
  v_mfma_f32_16x16x32_bf16 a[92:95], a[172:175], v[120:123], a[92:95]
  s_waitcnt lgkmcnt(6)
  v_exp_f32 v47, v47
  v_mfma_f32_16x16x32_bf16 a[92:95], a[168:171], v[88:91], a[92:95]
  ds_read_b128 a[136:139], v214 offset:49152
  v_cvt_pk_bf16_f32 v43, v46, v47
  v_mfma_f32_16x16x32_bf16 a[96:99], a[176:179], v[64:67], a[96:99]
  v_exp_f32 v52, v52
  v_mfma_f32_16x16x32_bf16 a[96:99], a[180:183], v[96:99], a[96:99]
  ds_read_b128 a[140:143], v215 offset:49152
  v_mfma_f32_16x16x32_bf16 a[100:103], a[180:183], v[104:107], a[100:103]
  v_exp_f32 v53, v53
  v_mfma_f32_16x16x32_bf16 a[100:103], a[176:179], v[72:75], a[100:103]
  v_cvt_pk_bf16_f32 v50, v52, v53
  v_mfma_f32_16x16x32_bf16 a[104:107], a[176:179], v[80:83], a[104:107]
  v_exp_f32 v54, v54
  v_mfma_f32_16x16x32_bf16 a[104:107], a[180:183], v[112:115], a[104:107]
  v_mfma_f32_16x16x32_bf16 a[108:111], a[180:183], v[120:123], a[108:111]
  s_waitcnt lgkmcnt(4)
  v_exp_f32 v55, v55
  v_mfma_f32_16x16x32_bf16 a[108:111], a[176:179], v[88:91], a[108:111]
  v_cvt_pk_bf16_f32 v51, v54, v55
  v_mfma_f32_16x16x32_bf16 a[112:115], a[184:187], v[64:67], a[112:115]
  v_exp_f32 v60, v60
  v_mfma_f32_16x16x32_bf16 a[112:115], a[188:191], v[96:99], a[112:115]
  v_mfma_f32_16x16x32_bf16 a[116:119], a[188:191], v[104:107], a[116:119]
  v_exp_f32 v61, v61
  v_mfma_f32_16x16x32_bf16 a[116:119], a[184:187], v[72:75], a[116:119]
  v_cvt_pk_bf16_f32 v58, v60, v61
  v_mfma_f32_16x16x32_bf16 a[120:123], a[184:187], v[80:83], a[120:123]
  v_exp_f32 v62, v62
  v_mfma_f32_16x16x32_bf16 a[120:123], a[188:191], v[112:115], a[120:123]
  v_mfma_f32_16x16x32_bf16 a[124:127], a[188:191], v[120:123], a[124:127]
  s_waitcnt lgkmcnt(0)
  v_exp_f32 v63, v63
  v_mfma_f32_16x16x32_bf16 a[124:127], a[184:187], v[88:91], a[124:127]
  v_cvt_pk_bf16_f32 v59, v62, v63
  v_mfma_f32_16x16x32_bf16 v[64:67], a[128:131], v[128:131], v[192:195]
  s_add_u32 m0, s28, 65536
  v_lshrrev_b32 v224, 4, v242
  v_lshrrev_b32 v225, 4, v224
  v_mfma_f32_16x16x32_bf16 v[64:67], a[132:135], v[132:135], v[64:67]
  ds_read_b128 a[144:147], v212 offset:53248
  v_bfe_u32 v226, v224, 2, 2
  v_mfma_f32_16x16x32_bf16 v[64:67], a[136:139], v[136:139], v[64:67]
  buffer_load_dwordx4 v236, s[16:19], s29 offen offset:0 lds
  v_mfma_f32_16x16x32_bf16 v[64:67], a[140:143], v[140:143], v[64:67]
  ds_read_b128 a[148:151], v213 offset:53248
  v_lshl_add_u32 v225, v225, 3, v226
  v_mfma_f32_16x16x32_bf16 v[72:75], a[140:143], v[156:159], v[196:199]
  v_lshlrev_b32 v225, 4, v225
  v_bfe_u32 v226, v224, 1, 1
  v_mfma_f32_16x16x32_bf16 v[72:75], a[136:139], v[152:155], v[72:75]
  ds_read_b128 a[152:155], v214 offset:53248
  v_mul_u32_u24 v226, 0xc00, v226
  v_mfma_f32_16x16x32_bf16 v[72:75], a[132:135], v[148:151], v[72:75]
  buffer_load_dwordx4 v237, s[16:19], s29 offen offset:1024 lds
  v_mfma_f32_16x16x32_bf16 v[72:75], a[128:131], v[144:147], v[72:75]
  ds_read_b128 a[156:159], v215 offset:53248
  v_add3_u32 v225, v225, v226, s50
  v_mfma_f32_16x16x32_bf16 v[80:83], a[128:131], v[160:163], v[200:203]
  v_exp_f32 v64, v64
  v_mfma_f32_16x16x32_bf16 v[80:83], a[132:135], v[164:167], v[80:83]
  v_and_b32 v226, 1, v224
  v_lshl_add_u32 v225, v226, 3, v225
  v_mfma_f32_16x16x32_bf16 v[80:83], a[136:139], v[168:171], v[80:83]
  s_waitcnt vmcnt(10)
  v_exp_f32 v65, v65
  v_mfma_f32_16x16x32_bf16 v[80:83], a[140:143], v[172:175], v[80:83]
  ds_read_b64_tr_b16 a[232:233], v225 offset:0
  v_cvt_pk_bf16_f32 v64, v64, v65
  v_mfma_f32_16x16x32_bf16 v[88:91], a[140:143], v[188:191], v[204:207]
  v_exp_f32 v66, v66
  v_mfma_f32_16x16x32_bf16 v[88:91], a[136:139], v[184:187], v[88:91]
  buffer_load_dwordx4 v236, s[16:19], s29 offen offset:2048 lds
  v_mfma_f32_16x16x32_bf16 v[88:91], a[132:135], v[180:183], v[88:91]
  s_waitcnt lgkmcnt(1)
  v_exp_f32 v67, v67
  v_mfma_f32_16x16x32_bf16 v[88:91], a[128:131], v[176:179], v[88:91]
  ds_read_b64_tr_b16 a[234:235], v225 offset:64
  v_cvt_pk_bf16_f32 v65, v66, v67
  v_mfma_f32_16x16x32_bf16 v[68:71], a[144:147], v[128:131], v[192:195]
  v_exp_f32 v72, v72
  v_mfma_f32_16x16x32_bf16 v[68:71], a[148:151], v[132:135], v[68:71]
  ds_read_b128 a[128:131], v212 offset:57344
  ds_read_b64_tr_b16 a[236:237], v225 offset:512
  v_mfma_f32_16x16x32_bf16 v[68:71], a[152:155], v[136:139], v[68:71]
  v_exp_f32 v73, v73
  v_mfma_f32_16x16x32_bf16 v[68:71], a[156:159], v[140:143], v[68:71]
  ds_read_b128 a[132:135], v213 offset:57344
  v_cvt_pk_bf16_f32 v72, v72, v73
  v_mfma_f32_16x16x32_bf16 v[76:79], a[156:159], v[156:159], v[196:199]
  v_exp_f32 v74, v74
  v_mfma_f32_16x16x32_bf16 v[76:79], a[152:155], v[152:155], v[76:79]
  ds_read_b128 a[136:139], v214 offset:57344
  ds_read_b64_tr_b16 a[238:239], v225 offset:576
  v_mfma_f32_16x16x32_bf16 v[76:79], a[148:151], v[148:151], v[76:79]
  v_exp_f32 v75, v75
  v_mfma_f32_16x16x32_bf16 v[76:79], a[144:147], v[144:147], v[76:79]
  ds_read_b128 a[140:143], v215 offset:57344
  v_cvt_pk_bf16_f32 v73, v74, v75
  v_mfma_f32_16x16x32_bf16 v[84:87], a[144:147], v[160:163], v[200:203]
  v_exp_f32 v80, v80
  v_mfma_f32_16x16x32_bf16 v[84:87], a[148:151], v[164:167], v[84:87]
  buffer_load_dwordx4 v237, s[16:19], s29 offen offset:3072 lds
  v_mfma_f32_16x16x32_bf16 v[84:87], a[152:155], v[168:171], v[84:87]
  s_add_u32 s29, s29, 16384
  v_exp_f32 v81, v81
  v_mfma_f32_16x16x32_bf16 v[84:87], a[156:159], v[172:175], v[84:87]
  ds_read_b64_tr_b16 a[240:241], v225 offset:1024
  v_cvt_pk_bf16_f32 v80, v80, v81
  v_mfma_f32_16x16x32_bf16 v[92:95], a[156:159], v[188:191], v[204:207]
  s_add_u32 m0, s28, 16384
  v_exp_f32 v82, v82
  v_mfma_f32_16x16x32_bf16 v[92:95], a[152:155], v[184:187], v[92:95]
  buffer_load_dwordx4 v232, s[12:15], s29 offen offset:0 lds
  v_mfma_f32_16x16x32_bf16 v[92:95], a[148:151], v[180:183], v[92:95]
  s_waitcnt lgkmcnt(1)
  v_exp_f32 v83, v83
  v_mfma_f32_16x16x32_bf16 v[92:95], a[144:147], v[176:179], v[92:95]
  ds_read_b64_tr_b16 a[242:243], v225 offset:1088
  v_cvt_pk_bf16_f32 v81, v82, v83
  v_mfma_f32_16x16x32_bf16 v[96:99], a[128:131], v[128:131], v[192:195]
  v_exp_f32 v88, v88
  v_mfma_f32_16x16x32_bf16 v[96:99], a[132:135], v[132:135], v[96:99]
  ds_read_b128 a[144:147], v212 offset:61440
  ds_read_b64_tr_b16 a[244:245], v225 offset:1536
  v_mfma_f32_16x16x32_bf16 v[96:99], a[136:139], v[136:139], v[96:99]
  v_exp_f32 v89, v89
  v_mfma_f32_16x16x32_bf16 v[96:99], a[140:143], v[140:143], v[96:99]
  ds_read_b128 a[148:151], v213 offset:61440
  v_cvt_pk_bf16_f32 v88, v88, v89
  v_mfma_f32_16x16x32_bf16 v[104:107], a[140:143], v[156:159], v[196:199]
  v_exp_f32 v90, v90
  v_mfma_f32_16x16x32_bf16 v[104:107], a[136:139], v[152:155], v[104:107]
  ds_read_b128 a[152:155], v214 offset:61440
  ds_read_b64_tr_b16 a[246:247], v225 offset:1600
  v_mfma_f32_16x16x32_bf16 v[104:107], a[132:135], v[148:151], v[104:107]
  v_exp_f32 v91, v91
  v_mfma_f32_16x16x32_bf16 v[104:107], a[128:131], v[144:147], v[104:107]
  ds_read_b128 a[156:159], v215 offset:61440
  v_cvt_pk_bf16_f32 v89, v90, v91
  v_mfma_f32_16x16x32_bf16 v[112:115], a[128:131], v[160:163], v[200:203]
  v_exp_f32 v68, v68
  v_mfma_f32_16x16x32_bf16 v[112:115], a[132:135], v[164:167], v[112:115]
  buffer_load_dwordx4 v233, s[12:15], s29 offen offset:1024 lds
  v_mfma_f32_16x16x32_bf16 v[112:115], a[136:139], v[168:171], v[112:115]
  v_exp_f32 v69, v69
  v_mfma_f32_16x16x32_bf16 v[112:115], a[140:143], v[172:175], v[112:115]
  ds_read_b64_tr_b16 a[248:249], v225 offset:2048
  v_cvt_pk_bf16_f32 v66, v68, v69
  v_mfma_f32_16x16x32_bf16 v[120:123], a[140:143], v[188:191], v[204:207]
  v_exp_f32 v70, v70
  v_mfma_f32_16x16x32_bf16 v[120:123], a[136:139], v[184:187], v[120:123]
  buffer_load_dwordx4 v234, s[12:15], s29 offen offset:2048 lds
  v_mfma_f32_16x16x32_bf16 v[120:123], a[132:135], v[180:183], v[120:123]
  s_waitcnt lgkmcnt(1)
  v_exp_f32 v71, v71
  v_mfma_f32_16x16x32_bf16 v[120:123], a[128:131], v[176:179], v[120:123]
  ds_read_b64_tr_b16 a[250:251], v225 offset:2112
  v_cvt_pk_bf16_f32 v67, v70, v71
  v_mfma_f32_16x16x32_bf16 v[100:103], a[144:147], v[128:131], v[192:195]
  v_exp_f32 v76, v76
  v_mfma_f32_16x16x32_bf16 v[100:103], a[148:151], v[132:135], v[100:103]
  ds_read_b64_tr_b16 a[160:161], v216 offset:32768
  v_mfma_f32_16x16x32_bf16 v[100:103], a[152:155], v[136:139], v[100:103]
  v_exp_f32 v77, v77
  v_mfma_f32_16x16x32_bf16 v[100:103], a[156:159], v[140:143], v[100:103]
  ds_read_b64_tr_b16 a[162:163], v216 offset:36864
  v_cvt_pk_bf16_f32 v74, v76, v77
  v_mfma_f32_16x16x32_bf16 v[108:111], a[156:159], v[156:159], v[196:199]
  v_exp_f32 v78, v78
  v_mfma_f32_16x16x32_bf16 v[108:111], a[152:155], v[152:155], v[108:111]
  ds_read_b64_tr_b16 a[164:165], v216 offset:40960
  buffer_load_dwordx4 v235, s[12:15], s29 offen offset:3072 lds
  v_mfma_f32_16x16x32_bf16 v[108:111], a[148:151], v[148:151], v[108:111]
  v_exp_f32 v79, v79
  v_mfma_f32_16x16x32_bf16 v[108:111], a[144:147], v[144:147], v[108:111]
  ds_read_b64_tr_b16 a[166:167], v216 offset:45056
  s_waitcnt lgkmcnt(4)
  v_cvt_pk_bf16_f32 v75, v78, v79
  v_mfma_f32_16x16x32_bf16 v[116:119], a[144:147], v[160:163], v[200:203]
  v_exp_f32 v84, v84
  v_mfma_f32_16x16x32_bf16 v[116:119], a[148:151], v[164:167], v[116:119]
  ds_read_b64_tr_b16 a[168:169], v217 offset:32768
  v_mfma_f32_16x16x32_bf16 v[228:231], a[232:235], a[212:215], 0
  v_mfma_f32_16x16x32_bf16 v[228:231], a[236:239], a[216:219], v[228:231]
  v_mfma_f32_16x16x32_bf16 v[228:231], a[240:243], a[220:223], v[228:231]
  v_mfma_f32_16x16x32_bf16 v[228:231], a[244:247], a[224:227], v[228:231]
  v_mfma_f32_16x16x32_bf16 v[228:231], a[248:251], a[228:231], v[228:231]
  v_mfma_f32_16x16x32_bf16 v[116:119], a[152:155], v[168:171], v[116:119]
  s_lshl_b32 s35, s3, 10
  s_add_u32 s35, s35, 159744
  v_exp_f32 v85, v85
  v_mfma_f32_16x16x32_bf16 v[116:119], a[156:159], v[172:175], v[116:119]
  ds_read_b64_tr_b16 a[170:171], v217 offset:36864
  v_cvt_pk_bf16_f32 v82, v84, v85
  v_mfma_f32_16x16x32_bf16 v[124:127], a[156:159], v[188:191], v[204:207]
  v_exp_f32 v86, v86
  v_mfma_f32_16x16x32_bf16 v[124:127], a[152:155], v[184:187], v[124:127]
  ds_read_b64_tr_b16 a[172:173], v217 offset:40960
  v_add_u32 v224, s35, v242
  v_mfma_f32_16x16x32_bf16 v[124:127], a[148:151], v[180:183], v[124:127]
  v_exp_f32 v87, v87
  v_mfma_f32_16x16x32_bf16 v[124:127], a[144:147], v[176:179], v[124:127]
  ds_read_b64_tr_b16 a[174:175], v217 offset:45056
  v_cvt_pk_bf16_f32 v83, v86, v87
  v_mfma_f32_16x16x32_bf16 a[192:195], a[208:211], v[0:3], a[192:195]
  v_exp_f32 v92, v92
  v_mfma_f32_16x16x32_bf16 a[192:195], a[208:211], v[32:35], a[192:195]
  ds_read_b64_tr_b16 a[176:177], v218 offset:32768
  ds_write_b128 v224, v[228:231]
  v_mfma_f32_16x16x32_bf16 a[196:199], a[208:211], v[8:11], a[196:199]
  v_exp_f32 v93, v93
  v_mfma_f32_16x16x32_bf16 a[196:199], a[208:211], v[40:43], a[196:199]
  ds_read_b64_tr_b16 a[178:179], v218 offset:36864
  v_cvt_pk_bf16_f32 v90, v92, v93
  v_mfma_f32_16x16x32_bf16 a[200:203], a[208:211], v[16:19], a[200:203]
  v_exp_f32 v94, v94
  v_mfma_f32_16x16x32_bf16 a[200:203], a[208:211], v[48:51], a[200:203]
  ds_read_b64_tr_b16 a[180:181], v218 offset:40960
  v_mfma_f32_16x16x32_bf16 a[204:207], a[208:211], v[24:27], a[204:207]
  s_waitcnt lgkmcnt(8)
  v_exp_f32 v95, v95
  v_mfma_f32_16x16x32_bf16 a[204:207], a[208:211], v[56:59], a[204:207]
  ds_read_b64_tr_b16 a[182:183], v218 offset:45056
  v_cvt_pk_bf16_f32 v91, v94, v95
  v_mfma_f32_16x16x32_bf16 a[0:3], a[160:163], v[0:3], a[0:3]
  v_exp_f32 v96, v96
  v_mfma_f32_16x16x32_bf16 a[0:3], a[164:167], v[32:35], a[0:3]
  ds_read_b64_tr_b16 a[184:185], v219 offset:32768
  s_waitcnt lgkmcnt(4)
  s_mov_b32 m0, s51
  v_mfma_f32_16x16x32_bf16 a[4:7], a[164:167], v[40:43], a[4:7]
  v_exp_f32 v97, v97
  v_mfma_f32_16x16x32_bf16 a[4:7], a[160:163], v[8:11], a[4:7]
  ds_read_b64_tr_b16 a[186:187], v219 offset:36864
  v_cvt_pk_bf16_f32 v96, v96, v97
  v_mfma_f32_16x16x32_bf16 a[8:11], a[160:163], v[16:19], a[8:11]
  v_exp_f32 v98, v98
  v_mfma_f32_16x16x32_bf16 a[8:11], a[164:167], v[48:51], a[8:11]
  ds_read_b64_tr_b16 a[188:189], v219 offset:40960
  buffer_load_dwordx4 v210, s[4:7], s100 offen lds
  s_add_u32 s100, s100, 20480
  s_add_u32 s51, s51, 512
  v_mfma_f32_16x16x32_bf16 a[12:15], a[164:167], v[56:59], a[12:15]
  v_exp_f32 v99, v99
  v_mfma_f32_16x16x32_bf16 a[12:15], a[160:163], v[24:27], a[12:15]
  ds_read_b64_tr_b16 a[190:191], v219 offset:45056
  v_cvt_pk_bf16_f32 v97, v98, v99
  v_mfma_f32_16x16x32_bf16 a[16:19], a[168:171], v[0:3], a[16:19]
  v_exp_f32 v104, v104
  v_mfma_f32_16x16x32_bf16 a[16:19], a[172:175], v[32:35], a[16:19]
  ds_read_b64_tr_b16 a[160:161], v220 offset:32768
  v_lshrrev_b32 v224, 4, v242
  v_mfma_f32_16x16x32_bf16 a[20:23], a[172:175], v[40:43], a[20:23]
  v_exp_f32 v105, v105
  v_mfma_f32_16x16x32_bf16 a[20:23], a[168:171], v[8:11], a[20:23]
  ds_read_b64_tr_b16 a[162:163], v220 offset:36864
  v_cvt_pk_bf16_f32 v104, v104, v105
  v_mfma_f32_16x16x32_bf16 a[24:27], a[168:171], v[16:19], a[24:27]
  v_exp_f32 v106, v106
  v_mfma_f32_16x16x32_bf16 a[24:27], a[172:175], v[48:51], a[24:27]
  ds_read_b64_tr_b16 a[164:165], v220 offset:40960
  v_bfe_u32 v225, v224, 2, 1
  v_mfma_f32_16x16x32_bf16 a[28:31], a[172:175], v[56:59], a[28:31]
  s_waitcnt lgkmcnt(7)
  v_exp_f32 v107, v107
  v_mfma_f32_16x16x32_bf16 a[28:31], a[168:171], v[24:27], a[28:31]
  ds_read_b64_tr_b16 a[166:167], v220 offset:45056
  v_cvt_pk_bf16_f32 v105, v106, v107
  v_mfma_f32_16x16x32_bf16 a[32:35], a[176:179], v[0:3], a[32:35]
  v_exp_f32 v112, v112
  v_mfma_f32_16x16x32_bf16 a[32:35], a[180:183], v[32:35], a[32:35]
  ds_read_b64_tr_b16 a[168:169], v221 offset:32768
  v_lshlrev_b32 v225, 8, v225
  v_mfma_f32_16x16x32_bf16 a[36:39], a[180:183], v[40:43], a[36:39]
  v_exp_f32 v113, v113
  v_mfma_f32_16x16x32_bf16 a[36:39], a[176:179], v[8:11], a[36:39]
  ds_read_b64_tr_b16 a[170:171], v221 offset:36864
  v_cvt_pk_bf16_f32 v112, v112, v113
  v_mfma_f32_16x16x32_bf16 a[40:43], a[176:179], v[16:19], a[40:43]
  v_exp_f32 v114, v114
  v_mfma_f32_16x16x32_bf16 a[40:43], a[180:183], v[48:51], a[40:43]
  ds_read_b64_tr_b16 a[172:173], v221 offset:40960
  v_lshrrev_b32 v226, 3, v224
  v_mfma_f32_16x16x32_bf16 a[44:47], a[180:183], v[56:59], a[44:47]
  s_waitcnt lgkmcnt(7)
  v_exp_f32 v115, v115
  v_mfma_f32_16x16x32_bf16 a[44:47], a[176:179], v[24:27], a[44:47]
  ds_read_b64_tr_b16 a[174:175], v221 offset:45056
  v_cvt_pk_bf16_f32 v113, v114, v115
  v_mfma_f32_16x16x32_bf16 a[48:51], a[184:187], v[0:3], a[48:51]
  v_exp_f32 v120, v120
  v_mfma_f32_16x16x32_bf16 a[48:51], a[188:191], v[32:35], a[48:51]
  ds_read_b64_tr_b16 a[176:177], v222 offset:32768
  v_lshl_add_u32 v225, v226, 4, v225
  v_mfma_f32_16x16x32_bf16 a[52:55], a[188:191], v[40:43], a[52:55]
  v_exp_f32 v121, v121
  v_mfma_f32_16x16x32_bf16 a[52:55], a[184:187], v[8:11], a[52:55]
  ds_read_b64_tr_b16 a[178:179], v222 offset:36864
  v_cvt_pk_bf16_f32 v120, v120, v121
  v_mfma_f32_16x16x32_bf16 a[56:59], a[184:187], v[16:19], a[56:59]
  v_exp_f32 v122, v122
  v_mfma_f32_16x16x32_bf16 a[56:59], a[188:191], v[48:51], a[56:59]
  ds_read_b64_tr_b16 a[180:181], v222 offset:40960
  v_and_b32 v227, 3, v224
  v_mfma_f32_16x16x32_bf16 a[60:63], a[188:191], v[56:59], a[60:63]
  s_waitcnt lgkmcnt(7)
  v_exp_f32 v123, v123
  v_mfma_f32_16x16x32_bf16 a[60:63], a[184:187], v[24:27], a[60:63]
  ds_read_b64_tr_b16 a[182:183], v222 offset:45056
  v_cvt_pk_bf16_f32 v121, v122, v123
  v_mfma_f32_16x16x32_bf16 a[64:67], a[160:163], v[0:3], a[64:67]
  v_exp_f32 v100, v100
  v_mfma_f32_16x16x32_bf16 a[64:67], a[164:167], v[32:35], a[64:67]
  ds_read_b64_tr_b16 a[184:185], v223 offset:32768
  v_lshl_add_u32 v225, v227, 2, v225
  v_mfma_f32_16x16x32_bf16 a[68:71], a[164:167], v[40:43], a[68:71]
  v_exp_f32 v101, v101
  v_mfma_f32_16x16x32_bf16 a[68:71], a[160:163], v[8:11], a[68:71]
  ds_read_b64_tr_b16 a[186:187], v223 offset:36864
  v_cvt_pk_bf16_f32 v98, v100, v101
  v_mfma_f32_16x16x32_bf16 a[72:75], a[160:163], v[16:19], a[72:75]
  v_exp_f32 v102, v102
  v_mfma_f32_16x16x32_bf16 a[72:75], a[164:167], v[48:51], a[72:75]
  ds_read_b64_tr_b16 a[188:189], v223 offset:40960
  v_add_u32 v225, 159744, v225
  v_mfma_f32_16x16x32_bf16 a[76:79], a[164:167], v[56:59], a[76:79]
  s_waitcnt lgkmcnt(7)
  v_exp_f32 v103, v103
  v_mfma_f32_16x16x32_bf16 a[76:79], a[160:163], v[24:27], a[76:79]
  ds_read_b64_tr_b16 a[190:191], v223 offset:45056
  v_cvt_pk_bf16_f32 v99, v102, v103
  v_mfma_f32_16x16x32_bf16 a[80:83], a[168:171], v[0:3], a[80:83]
  s_waitcnt vmcnt(9)
  v_exp_f32 v108, v108
  v_mfma_f32_16x16x32_bf16 a[80:83], a[172:175], v[32:35], a[80:83]
  v_mfma_f32_16x16x32_bf16 a[84:87], a[172:175], v[40:43], a[84:87]
  s_barrier
  v_exp_f32 v109, v109
  v_mfma_f32_16x16x32_bf16 a[84:87], a[168:171], v[8:11], a[84:87]
  ds_read_b128 a[128:131], v212 offset:0
  v_cvt_pk_bf16_f32 v106, v108, v109
  v_mfma_f32_16x16x32_bf16 a[88:91], a[168:171], v[16:19], a[88:91]
  v_exp_f32 v110, v110
  v_mfma_f32_16x16x32_bf16 a[88:91], a[172:175], v[48:51], a[88:91]
  ds_read_b128 a[132:135], v213 offset:0
  ds_read_b32 v228, v225 offset:0
  v_mfma_f32_16x16x32_bf16 a[92:95], a[172:175], v[56:59], a[92:95]
  s_waitcnt lgkmcnt(7)
  v_exp_f32 v111, v111
  v_mfma_f32_16x16x32_bf16 a[92:95], a[168:171], v[24:27], a[92:95]
  ds_read_b128 a[136:139], v214 offset:0
  v_cvt_pk_bf16_f32 v107, v110, v111
  v_mfma_f32_16x16x32_bf16 a[96:99], a[176:179], v[0:3], a[96:99]
  v_exp_f32 v116, v116
  v_mfma_f32_16x16x32_bf16 a[96:99], a[180:183], v[32:35], a[96:99]
  ds_read_b128 a[140:143], v215 offset:0
  ds_read_b32 v229, v225 offset:1024
  v_mfma_f32_16x16x32_bf16 a[100:103], a[180:183], v[40:43], a[100:103]
  v_exp_f32 v117, v117
  v_mfma_f32_16x16x32_bf16 a[100:103], a[176:179], v[8:11], a[100:103]
  ds_read_b32 v230, v225 offset:2048
  v_cvt_pk_bf16_f32 v114, v116, v117
  v_mfma_f32_16x16x32_bf16 a[104:107], a[176:179], v[16:19], a[104:107]
  v_exp_f32 v118, v118
  v_mfma_f32_16x16x32_bf16 a[104:107], a[180:183], v[48:51], a[104:107]
  ds_read_b32 v231, v225 offset:3072
  ds_read_b32 v238, v225 offset:512
  v_mfma_f32_16x16x32_bf16 a[108:111], a[180:183], v[56:59], a[108:111]
  s_waitcnt lgkmcnt(9)
  v_exp_f32 v119, v119
  v_mfma_f32_16x16x32_bf16 a[108:111], a[176:179], v[24:27], a[108:111]
  ds_read_b32 v239, v225 offset:1536
  v_cvt_pk_bf16_f32 v115, v118, v119
  v_mfma_f32_16x16x32_bf16 a[112:115], a[184:187], v[0:3], a[112:115]
  v_exp_f32 v124, v124
  v_mfma_f32_16x16x32_bf16 a[112:115], a[188:191], v[32:35], a[112:115]
  ds_read_b32 v240, v225 offset:2560
  ds_read_b32 v241, v225 offset:3584
  s_cmp_eq_u32 s3, 0
  s_cselect_b32 s35, 0, 1073741824
  v_mfma_f32_16x16x32_bf16 a[116:119], a[188:191], v[40:43], a[116:119]
  v_exp_f32 v125, v125
  v_mfma_f32_16x16x32_bf16 a[116:119], a[184:187], v[8:11], a[116:119]
  v_cvt_pk_bf16_f32 v122, v124, v125
  v_mul_u32_u24 v226, 0xd80, v226
  v_mfma_f32_16x16x32_bf16 a[120:123], a[184:187], v[16:19], a[120:123]
  v_exp_f32 v126, v126
  v_mfma_f32_16x16x32_bf16 a[120:123], a[188:191], v[48:51], a[120:123]
  v_and_b32 v227, 7, v224
  v_lshl_add_u32 v226, v227, 1, v226
  v_mfma_f32_16x16x32_bf16 a[124:127], a[188:191], v[56:59], a[124:127]
  s_waitcnt lgkmcnt(7)
  v_exp_f32 v127, v127
  v_mfma_f32_16x16x32_bf16 a[124:127], a[184:187], v[24:27], a[124:127]
  v_cvt_pk_bf16_f32 v123, v126, v127
  v_and_b32 v227, 1, v224
  v_lshl_add_u32 v226, v227, 30, v226
  v_or_b32 v226, s35, v226
  v_min_u32 v249, 1, v224
  v_lshlrev_b32 v249, 30, v249
  v_or_b32 v249, s35, v249
  v_mov_b32 v251, v249
  v_mov_b32 v250, 1
  s_mov_b32 s47, 2818048
  s_lshl_b32 s35, s33, 4
  s_add_u32 s35, s35, 2633728
  s_waitcnt lgkmcnt(0)
  v_add_f32 v228, v228, v229
  v_add_f32 v238, v238, v239
  v_add_f32 v230, v230, v231
  v_add_f32 v240, v240, v241
  v_add_f32 v228, v228, v230
  v_add_f32 v238, v238, v240
  v_cvt_pk_bf16_f32 v228, v228, v228
  v_cvt_pk_bf16_f32 v238, v238, v238
  v_lshlrev_b32 v228, 16, v228
  v_lshlrev_b32 v238, 16, v238
  v_mul_f32 v229, 0xbfb8aa3b, v228
  v_exp_f32 v229, v229
  s_nop 0
  v_add_f32 v229, 1.0, v229
  v_rcp_f32 v229, v229
  s_nop 0
  v_mul_f32 v228, v228, v229
  v_cvt_pk_bf16_f32 v228, v228, v228
  v_lshlrev_b32 v228, 16, v228
  v_mul_f32 v228, v228, v238
  s_nop 1
  v_mov_b32_dpp v229, v228 quad_perm:[1,0,3,2] row_mask:0xf bank_mask:0xf
  v_cvt_pk_bf16_f32 v228, v228, v229
  buffer_store_dword v228, v226, s[24:27], s35 offen sc1
  s_mov_b32 s32, 5
attn_loop:
  v_mfma_f32_16x16x32_bf16 v[0:3], a[128:131], v[128:131], v[192:195]
  s_add_u32 m0, s28, 81920
  v_mfma_f32_16x16x32_bf16 v[0:3], a[132:135], v[132:135], v[0:3]
  ds_read_b128 a[144:147], v212 offset:4096
  v_mfma_f32_16x16x32_bf16 v[0:3], a[136:139], v[136:139], v[0:3]
  buffer_load_dwordx4 v236, s[16:19], s29 offen offset:0 lds
  v_mfma_f32_16x16x32_bf16 v[0:3], a[140:143], v[140:143], v[0:3]
  ds_read_b128 a[148:151], v213 offset:4096
  v_mfma_f32_16x16x32_bf16 v[8:11], a[140:143], v[156:159], v[196:199]
  v_mfma_f32_16x16x32_bf16 v[8:11], a[136:139], v[152:155], v[8:11]
  ds_read_b128 a[152:155], v214 offset:4096
  v_mfma_f32_16x16x32_bf16 v[8:11], a[132:135], v[148:151], v[8:11]
  buffer_load_dwordx4 v237, s[16:19], s29 offen offset:1024 lds
  v_mfma_f32_16x16x32_bf16 v[8:11], a[128:131], v[144:147], v[8:11]
  ds_read_b128 a[156:159], v215 offset:4096
  v_mfma_f32_16x16x32_bf16 v[16:19], a[128:131], v[160:163], v[200:203]
  v_exp_f32 v0, v0
  v_mfma_f32_16x16x32_bf16 v[16:19], a[132:135], v[164:167], v[16:19]
  v_mfma_f32_16x16x32_bf16 v[16:19], a[136:139], v[168:171], v[16:19]
  v_exp_f32 v1, v1
  v_mfma_f32_16x16x32_bf16 v[16:19], a[140:143], v[172:175], v[16:19]
  v_cvt_pk_bf16_f32 v0, v0, v1
  v_mfma_f32_16x16x32_bf16 v[24:27], a[140:143], v[188:191], v[204:207]
  v_exp_f32 v2, v2
  v_mfma_f32_16x16x32_bf16 v[24:27], a[136:139], v[184:187], v[24:27]
  buffer_load_dwordx4 v236, s[16:19], s29 offen offset:2048 lds
  v_mfma_f32_16x16x32_bf16 v[24:27], a[132:135], v[180:183], v[24:27]
  s_waitcnt lgkmcnt(0)
  v_exp_f32 v3, v3
  v_mfma_f32_16x16x32_bf16 v[24:27], a[128:131], v[176:179], v[24:27]
  v_cvt_pk_bf16_f32 v1, v2, v3
  v_mfma_f32_16x16x32_bf16 v[4:7], a[144:147], v[128:131], v[192:195]
  v_exp_f32 v8, v8
  v_mfma_f32_16x16x32_bf16 v[4:7], a[148:151], v[132:135], v[4:7]
  ds_read_b128 a[128:131], v212 offset:8192
  v_mfma_f32_16x16x32_bf16 v[4:7], a[152:155], v[136:139], v[4:7]
  v_exp_f32 v9, v9
  v_mfma_f32_16x16x32_bf16 v[4:7], a[156:159], v[140:143], v[4:7]
  ds_read_b128 a[132:135], v213 offset:8192
  v_cvt_pk_bf16_f32 v8, v8, v9
  v_mfma_f32_16x16x32_bf16 v[12:15], a[156:159], v[156:159], v[196:199]
  v_exp_f32 v10, v10
  v_mfma_f32_16x16x32_bf16 v[12:15], a[152:155], v[152:155], v[12:15]
  ds_read_b128 a[136:139], v214 offset:8192
  v_mfma_f32_16x16x32_bf16 v[12:15], a[148:151], v[148:151], v[12:15]
  v_exp_f32 v11, v11
  v_mfma_f32_16x16x32_bf16 v[12:15], a[144:147], v[144:147], v[12:15]
  ds_read_b128 a[140:143], v215 offset:8192
  v_cvt_pk_bf16_f32 v9, v10, v11
  v_mfma_f32_16x16x32_bf16 v[20:23], a[144:147], v[160:163], v[200:203]
  v_exp_f32 v16, v16
  v_mfma_f32_16x16x32_bf16 v[20:23], a[148:151], v[164:167], v[20:23]
  buffer_load_dwordx4 v237, s[16:19], s29 offen offset:3072 lds
  v_mfma_f32_16x16x32_bf16 v[20:23], a[152:155], v[168:171], v[20:23]
  s_add_u32 s29, s29, 16384
  v_exp_f32 v17, v17
  v_mfma_f32_16x16x32_bf16 v[20:23], a[156:159], v[172:175], v[20:23]
  v_cvt_pk_bf16_f32 v16, v16, v17
  v_mfma_f32_16x16x32_bf16 v[28:31], a[156:159], v[188:191], v[204:207]
  s_add_u32 m0, s28, 32768
  v_exp_f32 v18, v18
  v_mfma_f32_16x16x32_bf16 v[28:31], a[152:155], v[184:187], v[28:31]
  buffer_load_dwordx4 v232, s[12:15], s29 offen offset:0 lds
  v_mfma_f32_16x16x32_bf16 v[28:31], a[148:151], v[180:183], v[28:31]
  s_waitcnt lgkmcnt(0)
  v_exp_f32 v19, v19
  v_mfma_f32_16x16x32_bf16 v[28:31], a[144:147], v[176:179], v[28:31]
  v_cvt_pk_bf16_f32 v17, v18, v19
  v_mfma_f32_16x16x32_bf16 v[32:35], a[128:131], v[128:131], v[192:195]
  v_exp_f32 v24, v24
  v_mfma_f32_16x16x32_bf16 v[32:35], a[132:135], v[132:135], v[32:35]
  ds_read_b128 a[144:147], v212 offset:12288
  v_mfma_f32_16x16x32_bf16 v[32:35], a[136:139], v[136:139], v[32:35]
  v_exp_f32 v25, v25
  v_mfma_f32_16x16x32_bf16 v[32:35], a[140:143], v[140:143], v[32:35]
  ds_read_b128 a[148:151], v213 offset:12288
  v_cvt_pk_bf16_f32 v24, v24, v25
  v_mfma_f32_16x16x32_bf16 v[40:43], a[140:143], v[156:159], v[196:199]
  v_exp_f32 v26, v26
  v_mfma_f32_16x16x32_bf16 v[40:43], a[136:139], v[152:155], v[40:43]
  ds_read_b128 a[152:155], v214 offset:12288
  v_mfma_f32_16x16x32_bf16 v[40:43], a[132:135], v[148:151], v[40:43]
  v_exp_f32 v27, v27
  v_mfma_f32_16x16x32_bf16 v[40:43], a[128:131], v[144:147], v[40:43]
  ds_read_b128 a[156:159], v215 offset:12288
  v_cvt_pk_bf16_f32 v25, v26, v27
  v_mfma_f32_16x16x32_bf16 v[48:51], a[128:131], v[160:163], v[200:203]
  v_exp_f32 v4, v4
  v_mfma_f32_16x16x32_bf16 v[48:51], a[132:135], v[164:167], v[48:51]
  buffer_load_dwordx4 v233, s[12:15], s29 offen offset:1024 lds
  v_mfma_f32_16x16x32_bf16 v[48:51], a[136:139], v[168:171], v[48:51]
  v_exp_f32 v5, v5
  v_mfma_f32_16x16x32_bf16 v[48:51], a[140:143], v[172:175], v[48:51]
  v_cvt_pk_bf16_f32 v2, v4, v5
  v_mfma_f32_16x16x32_bf16 v[56:59], a[140:143], v[188:191], v[204:207]
  v_exp_f32 v6, v6
  v_mfma_f32_16x16x32_bf16 v[56:59], a[136:139], v[184:187], v[56:59]
  buffer_load_dwordx4 v234, s[12:15], s29 offen offset:2048 lds
  v_mfma_f32_16x16x32_bf16 v[56:59], a[132:135], v[180:183], v[56:59]
  s_waitcnt lgkmcnt(0)
  v_exp_f32 v7, v7
  v_mfma_f32_16x16x32_bf16 v[56:59], a[128:131], v[176:179], v[56:59]
  v_cvt_pk_bf16_f32 v3, v6, v7
  v_mfma_f32_16x16x32_bf16 v[36:39], a[144:147], v[128:131], v[192:195]
  v_exp_f32 v12, v12
  v_mfma_f32_16x16x32_bf16 v[36:39], a[148:151], v[132:135], v[36:39]
  ds_read_b64_tr_b16 a[160:161], v216 offset:49152
  v_mfma_f32_16x16x32_bf16 v[36:39], a[152:155], v[136:139], v[36:39]
  v_exp_f32 v13, v13
  v_mfma_f32_16x16x32_bf16 v[36:39], a[156:159], v[140:143], v[36:39]
  ds_read_b64_tr_b16 a[162:163], v216 offset:53248
  v_cvt_pk_bf16_f32 v10, v12, v13
  v_mfma_f32_16x16x32_bf16 v[44:47], a[156:159], v[156:159], v[196:199]
  v_exp_f32 v14, v14
  v_mfma_f32_16x16x32_bf16 v[44:47], a[152:155], v[152:155], v[44:47]
  ds_read_b64_tr_b16 a[164:165], v216 offset:57344
  buffer_load_dwordx4 v235, s[12:15], s29 offen offset:3072 lds
  v_mfma_f32_16x16x32_bf16 v[44:47], a[148:151], v[148:151], v[44:47]
  v_exp_f32 v15, v15
  v_mfma_f32_16x16x32_bf16 v[44:47], a[144:147], v[144:147], v[44:47]
  ds_read_b64_tr_b16 a[166:167], v216 offset:61440
  v_cvt_pk_bf16_f32 v11, v14, v15
  v_mfma_f32_16x16x32_bf16 v[52:55], a[144:147], v[160:163], v[200:203]
  s_add_u32 m0, s50, 4096
  v_exp_f32 v20, v20
  v_mfma_f32_16x16x32_bf16 v[52:55], a[148:151], v[164:167], v[52:55]
  ds_read_b64_tr_b16 a[168:169], v217 offset:49152
  buffer_load_dwordx4 v208, s[20:23], s30 offen lds
  s_add_u32 s30, s30, 32
  v_mfma_f32_16x16x32_bf16 v[52:55], a[152:155], v[168:171], v[52:55]
  v_exp_f32 v21, v21
  v_mfma_f32_16x16x32_bf16 v[52:55], a[156:159], v[172:175], v[52:55]
  ds_read_b64_tr_b16 a[170:171], v217 offset:53248
  v_cvt_pk_bf16_f32 v18, v20, v21
  v_mfma_f32_16x16x32_bf16 v[60:63], a[156:159], v[188:191], v[204:207]
  v_exp_f32 v22, v22
  v_mfma_f32_16x16x32_bf16 v[60:63], a[152:155], v[184:187], v[60:63]
  ds_read_b64_tr_b16 a[172:173], v217 offset:57344
  v_mfma_f32_16x16x32_bf16 v[60:63], a[148:151], v[180:183], v[60:63]
  v_exp_f32 v23, v23
  v_mfma_f32_16x16x32_bf16 v[60:63], a[144:147], v[176:179], v[60:63]
  ds_read_b64_tr_b16 a[174:175], v217 offset:61440
  v_cvt_pk_bf16_f32 v19, v22, v23
  v_mfma_f32_16x16x32_bf16 a[192:195], a[208:211], v[64:67], a[192:195]
  v_exp_f32 v28, v28
  v_mfma_f32_16x16x32_bf16 a[192:195], a[208:211], v[96:99], a[192:195]
  ds_read_b64_tr_b16 a[176:177], v218 offset:49152
  v_mfma_f32_16x16x32_bf16 a[196:199], a[208:211], v[72:75], a[196:199]
  v_exp_f32 v29, v29
  v_mfma_f32_16x16x32_bf16 a[196:199], a[208:211], v[104:107], a[196:199]
  ds_read_b64_tr_b16 a[178:179], v218 offset:53248
  v_cvt_pk_bf16_f32 v26, v28, v29
  v_mfma_f32_16x16x32_bf16 a[200:203], a[208:211], v[80:83], a[200:203]
  v_exp_f32 v30, v30
  v_mfma_f32_16x16x32_bf16 a[200:203], a[208:211], v[112:115], a[200:203]
  ds_read_b64_tr_b16 a[180:181], v218 offset:57344
  v_mfma_f32_16x16x32_bf16 a[204:207], a[208:211], v[88:91], a[204:207]
  s_waitcnt lgkmcnt(7)
  v_exp_f32 v31, v31
  v_mfma_f32_16x16x32_bf16 a[204:207], a[208:211], v[120:123], a[204:207]
  ds_read_b64_tr_b16 a[182:183], v218 offset:61440
  v_cvt_pk_bf16_f32 v27, v30, v31
  v_mfma_f32_16x16x32_bf16 a[0:3], a[160:163], v[64:67], a[0:3]
  v_exp_f32 v32, v32
  v_mfma_f32_16x16x32_bf16 a[0:3], a[164:167], v[96:99], a[0:3]
  ds_read_b64_tr_b16 a[184:185], v219 offset:49152
  v_mfma_f32_16x16x32_bf16 a[4:7], a[164:167], v[104:107], a[4:7]
  v_exp_f32 v33, v33
  v_mfma_f32_16x16x32_bf16 a[4:7], a[160:163], v[72:75], a[4:7]
  ds_read_b64_tr_b16 a[186:187], v219 offset:53248
  v_cvt_pk_bf16_f32 v32, v32, v33
  v_mfma_f32_16x16x32_bf16 a[8:11], a[160:163], v[80:83], a[8:11]
  v_exp_f32 v34, v34
  v_mfma_f32_16x16x32_bf16 a[8:11], a[164:167], v[112:115], a[8:11]
  ds_read_b64_tr_b16 a[188:189], v219 offset:57344
  v_mfma_f32_16x16x32_bf16 a[12:15], a[164:167], v[120:123], a[12:15]
  s_waitcnt lgkmcnt(7)
  v_exp_f32 v35, v35
  v_mfma_f32_16x16x32_bf16 a[12:15], a[160:163], v[88:91], a[12:15]
  ds_read_b64_tr_b16 a[190:191], v219 offset:61440
  v_cvt_pk_bf16_f32 v33, v34, v35
  v_mfma_f32_16x16x32_bf16 a[16:19], a[168:171], v[64:67], a[16:19]
  v_exp_f32 v40, v40
  v_mfma_f32_16x16x32_bf16 a[16:19], a[172:175], v[96:99], a[16:19]
  ds_read_b64_tr_b16 a[160:161], v220 offset:49152
  v_mfma_f32_16x16x32_bf16 a[20:23], a[172:175], v[104:107], a[20:23]
  v_exp_f32 v41, v41
  v_mfma_f32_16x16x32_bf16 a[20:23], a[168:171], v[72:75], a[20:23]
  ds_read_b64_tr_b16 a[162:163], v220 offset:53248
  v_cvt_pk_bf16_f32 v40, v40, v41
  v_mfma_f32_16x16x32_bf16 a[24:27], a[168:171], v[80:83], a[24:27]
  v_exp_f32 v42, v42
  v_mfma_f32_16x16x32_bf16 a[24:27], a[172:175], v[112:115], a[24:27]
  ds_read_b64_tr_b16 a[164:165], v220 offset:57344
  v_mfma_f32_16x16x32_bf16 a[28:31], a[172:175], v[120:123], a[28:31]
  s_waitcnt lgkmcnt(7)
  v_exp_f32 v43, v43
  v_mfma_f32_16x16x32_bf16 a[28:31], a[168:171], v[88:91], a[28:31]
  ds_read_b64_tr_b16 a[166:167], v220 offset:61440
  v_cvt_pk_bf16_f32 v41, v42, v43
  v_mfma_f32_16x16x32_bf16 a[32:35], a[176:179], v[64:67], a[32:35]
  v_exp_f32 v48, v48
  v_mfma_f32_16x16x32_bf16 a[32:35], a[180:183], v[96:99], a[32:35]
  ds_read_b64_tr_b16 a[168:169], v221 offset:49152
  v_mfma_f32_16x16x32_bf16 a[36:39], a[180:183], v[104:107], a[36:39]
  v_exp_f32 v49, v49
  v_mfma_f32_16x16x32_bf16 a[36:39], a[176:179], v[72:75], a[36:39]
  ds_read_b64_tr_b16 a[170:171], v221 offset:53248
  v_cvt_pk_bf16_f32 v48, v48, v49
  v_mfma_f32_16x16x32_bf16 a[40:43], a[176:179], v[80:83], a[40:43]
  v_exp_f32 v50, v50
  v_mfma_f32_16x16x32_bf16 a[40:43], a[180:183], v[112:115], a[40:43]
  ds_read_b64_tr_b16 a[172:173], v221 offset:57344
  v_mfma_f32_16x16x32_bf16 a[44:47], a[180:183], v[120:123], a[44:47]
  s_waitcnt lgkmcnt(7)
  v_exp_f32 v51, v51
  v_mfma_f32_16x16x32_bf16 a[44:47], a[176:179], v[88:91], a[44:47]
  ds_read_b64_tr_b16 a[174:175], v221 offset:61440
  v_cvt_pk_bf16_f32 v49, v50, v51
  v_mfma_f32_16x16x32_bf16 a[48:51], a[184:187], v[64:67], a[48:51]
  v_exp_f32 v56, v56
  v_mfma_f32_16x16x32_bf16 a[48:51], a[188:191], v[96:99], a[48:51]
  ds_read_b64_tr_b16 a[176:177], v222 offset:49152
  v_mfma_f32_16x16x32_bf16 a[52:55], a[188:191], v[104:107], a[52:55]
  v_exp_f32 v57, v57
  v_mfma_f32_16x16x32_bf16 a[52:55], a[184:187], v[72:75], a[52:55]
  ds_read_b64_tr_b16 a[178:179], v222 offset:53248
  v_cvt_pk_bf16_f32 v56, v56, v57
  v_mfma_f32_16x16x32_bf16 a[56:59], a[184:187], v[80:83], a[56:59]
  v_exp_f32 v58, v58
  v_mfma_f32_16x16x32_bf16 a[56:59], a[188:191], v[112:115], a[56:59]
  ds_read_b64_tr_b16 a[180:181], v222 offset:57344
  v_mfma_f32_16x16x32_bf16 a[60:63], a[188:191], v[120:123], a[60:63]
  s_waitcnt lgkmcnt(7)
  v_exp_f32 v59, v59
  v_mfma_f32_16x16x32_bf16 a[60:63], a[184:187], v[88:91], a[60:63]
  ds_read_b64_tr_b16 a[182:183], v222 offset:61440
  v_cvt_pk_bf16_f32 v57, v58, v59
  v_mfma_f32_16x16x32_bf16 a[64:67], a[160:163], v[64:67], a[64:67]
  v_exp_f32 v36, v36
  v_mfma_f32_16x16x32_bf16 a[64:67], a[164:167], v[96:99], a[64:67]
  ds_read_b64_tr_b16 a[184:185], v223 offset:49152
  v_mfma_f32_16x16x32_bf16 a[68:71], a[164:167], v[104:107], a[68:71]
  v_exp_f32 v37, v37
  v_mfma_f32_16x16x32_bf16 a[68:71], a[160:163], v[72:75], a[68:71]
  ds_read_b64_tr_b16 a[186:187], v223 offset:53248
  v_cvt_pk_bf16_f32 v34, v36, v37
  v_mfma_f32_16x16x32_bf16 a[72:75], a[160:163], v[80:83], a[72:75]
  v_exp_f32 v38, v38
  v_mfma_f32_16x16x32_bf16 a[72:75], a[164:167], v[112:115], a[72:75]
  ds_read_b64_tr_b16 a[188:189], v223 offset:57344
  v_mfma_f32_16x16x32_bf16 a[76:79], a[164:167], v[120:123], a[76:79]
  s_waitcnt lgkmcnt(7)
  v_exp_f32 v39, v39
  v_mfma_f32_16x16x32_bf16 a[76:79], a[160:163], v[88:91], a[76:79]
  ds_read_b64_tr_b16 a[190:191], v223 offset:61440
  v_cvt_pk_bf16_f32 v35, v38, v39
  v_mfma_f32_16x16x32_bf16 a[80:83], a[168:171], v[64:67], a[80:83]
  s_waitcnt vmcnt(11)
  v_exp_f32 v44, v44
  v_mfma_f32_16x16x32_bf16 a[80:83], a[172:175], v[96:99], a[80:83]
  v_mfma_f32_16x16x32_bf16 a[84:87], a[172:175], v[104:107], a[84:87]
  s_barrier
  v_exp_f32 v45, v45
  v_mfma_f32_16x16x32_bf16 a[84:87], a[168:171], v[72:75], a[84:87]
  ds_read_b128 a[128:131], v212 offset:16384
  v_cvt_pk_bf16_f32 v42, v44, v45
  v_mfma_f32_16x16x32_bf16 a[88:91], a[168:171], v[80:83], a[88:91]
  v_exp_f32 v46, v46
  v_mfma_f32_16x16x32_bf16 a[88:91], a[172:175], v[112:115], a[88:91]
  ds_read_b128 a[132:135], v213 offset:16384
  v_mfma_f32_16x16x32_bf16 a[92:95], a[172:175], v[120:123], a[92:95]
  s_waitcnt lgkmcnt(6)
  v_exp_f32 v47, v47
  v_mfma_f32_16x16x32_bf16 a[92:95], a[168:171], v[88:91], a[92:95]
  ds_read_b128 a[136:139], v214 offset:16384
  v_cvt_pk_bf16_f32 v43, v46, v47
  v_mfma_f32_16x16x32_bf16 a[96:99], a[176:179], v[64:67], a[96:99]
  v_exp_f32 v52, v52
  v_mfma_f32_16x16x32_bf16 a[96:99], a[180:183], v[96:99], a[96:99]
  ds_read_b128 a[140:143], v215 offset:16384
  v_mfma_f32_16x16x32_bf16 a[100:103], a[180:183], v[104:107], a[100:103]
  v_exp_f32 v53, v53
  v_mfma_f32_16x16x32_bf16 a[100:103], a[176:179], v[72:75], a[100:103]
  v_cvt_pk_bf16_f32 v50, v52, v53
  v_mfma_f32_16x16x32_bf16 a[104:107], a[176:179], v[80:83], a[104:107]
  v_exp_f32 v54, v54
  v_mfma_f32_16x16x32_bf16 a[104:107], a[180:183], v[112:115], a[104:107]
  v_mfma_f32_16x16x32_bf16 a[108:111], a[180:183], v[120:123], a[108:111]
  s_waitcnt lgkmcnt(4)
  v_exp_f32 v55, v55
  v_mfma_f32_16x16x32_bf16 a[108:111], a[176:179], v[88:91], a[108:111]
  v_cvt_pk_bf16_f32 v51, v54, v55
  v_mfma_f32_16x16x32_bf16 a[112:115], a[184:187], v[64:67], a[112:115]
  v_exp_f32 v60, v60
  v_mfma_f32_16x16x32_bf16 a[112:115], a[188:191], v[96:99], a[112:115]
  v_mfma_f32_16x16x32_bf16 a[116:119], a[188:191], v[104:107], a[116:119]
  v_exp_f32 v61, v61
  v_mfma_f32_16x16x32_bf16 a[116:119], a[184:187], v[72:75], a[116:119]
  v_cvt_pk_bf16_f32 v58, v60, v61
  v_mfma_f32_16x16x32_bf16 a[120:123], a[184:187], v[80:83], a[120:123]
  v_exp_f32 v62, v62
  v_mfma_f32_16x16x32_bf16 a[120:123], a[188:191], v[112:115], a[120:123]
  v_mfma_f32_16x16x32_bf16 a[124:127], a[188:191], v[120:123], a[124:127]
  s_waitcnt lgkmcnt(0)
  v_exp_f32 v63, v63
  v_mfma_f32_16x16x32_bf16 a[124:127], a[184:187], v[88:91], a[124:127]
  v_cvt_pk_bf16_f32 v59, v62, v63
  v_mfma_f32_16x16x32_bf16 v[64:67], a[128:131], v[128:131], v[192:195]
  s_add_u32 m0, s28, 98304
  v_mfma_f32_16x16x32_bf16 v[64:67], a[132:135], v[132:135], v[64:67]
  ds_read_b128 a[144:147], v212 offset:20480
  v_mfma_f32_16x16x32_bf16 v[64:67], a[136:139], v[136:139], v[64:67]
  buffer_load_dwordx4 v236, s[16:19], s29 offen offset:0 lds
  v_mfma_f32_16x16x32_bf16 v[64:67], a[140:143], v[140:143], v[64:67]
  ds_read_b128 a[148:151], v213 offset:20480
  v_mfma_f32_16x16x32_bf16 v[72:75], a[140:143], v[156:159], v[196:199]
  v_mfma_f32_16x16x32_bf16 v[72:75], a[136:139], v[152:155], v[72:75]
  ds_read_b128 a[152:155], v214 offset:20480
  v_mfma_f32_16x16x32_bf16 v[72:75], a[132:135], v[148:151], v[72:75]
  buffer_load_dwordx4 v237, s[16:19], s29 offen offset:1024 lds
  v_mfma_f32_16x16x32_bf16 v[72:75], a[128:131], v[144:147], v[72:75]
  ds_read_b128 a[156:159], v215 offset:20480
  v_mfma_f32_16x16x32_bf16 v[80:83], a[128:131], v[160:163], v[200:203]
  v_exp_f32 v64, v64
  v_mfma_f32_16x16x32_bf16 v[80:83], a[132:135], v[164:167], v[80:83]
  v_mfma_f32_16x16x32_bf16 v[80:83], a[136:139], v[168:171], v[80:83]
  v_exp_f32 v65, v65
  v_mfma_f32_16x16x32_bf16 v[80:83], a[140:143], v[172:175], v[80:83]
  v_cvt_pk_bf16_f32 v64, v64, v65
  v_mfma_f32_16x16x32_bf16 v[88:91], a[140:143], v[188:191], v[204:207]
  v_exp_f32 v66, v66
  v_mfma_f32_16x16x32_bf16 v[88:91], a[136:139], v[184:187], v[88:91]
  buffer_load_dwordx4 v236, s[16:19], s29 offen offset:2048 lds
  v_mfma_f32_16x16x32_bf16 v[88:91], a[132:135], v[180:183], v[88:91]
  s_waitcnt lgkmcnt(0)
  v_exp_f32 v67, v67
  v_mfma_f32_16x16x32_bf16 v[88:91], a[128:131], v[176:179], v[88:91]
  v_cvt_pk_bf16_f32 v65, v66, v67
  v_mfma_f32_16x16x32_bf16 v[68:71], a[144:147], v[128:131], v[192:195]
  v_exp_f32 v72, v72
  v_mfma_f32_16x16x32_bf16 v[68:71], a[148:151], v[132:135], v[68:71]
  ds_read_b128 a[128:131], v212 offset:24576
  v_mfma_f32_16x16x32_bf16 v[68:71], a[152:155], v[136:139], v[68:71]
  v_exp_f32 v73, v73
  v_mfma_f32_16x16x32_bf16 v[68:71], a[156:159], v[140:143], v[68:71]
  ds_read_b128 a[132:135], v213 offset:24576
  v_cvt_pk_bf16_f32 v72, v72, v73
  v_mfma_f32_16x16x32_bf16 v[76:79], a[156:159], v[156:159], v[196:199]
  v_exp_f32 v74, v74
  v_mfma_f32_16x16x32_bf16 v[76:79], a[152:155], v[152:155], v[76:79]
  ds_read_b128 a[136:139], v214 offset:24576
  v_mfma_f32_16x16x32_bf16 v[76:79], a[148:151], v[148:151], v[76:79]
  v_exp_f32 v75, v75
  v_mfma_f32_16x16x32_bf16 v[76:79], a[144:147], v[144:147], v[76:79]
  ds_read_b128 a[140:143], v215 offset:24576
  v_cvt_pk_bf16_f32 v73, v74, v75
  v_mfma_f32_16x16x32_bf16 v[84:87], a[144:147], v[160:163], v[200:203]
  v_exp_f32 v80, v80
  v_mfma_f32_16x16x32_bf16 v[84:87], a[148:151], v[164:167], v[84:87]
  buffer_load_dwordx4 v237, s[16:19], s29 offen offset:3072 lds
  v_mfma_f32_16x16x32_bf16 v[84:87], a[152:155], v[168:171], v[84:87]
  s_add_u32 s29, s29, 16384
  v_exp_f32 v81, v81
  v_mfma_f32_16x16x32_bf16 v[84:87], a[156:159], v[172:175], v[84:87]
  v_cvt_pk_bf16_f32 v80, v80, v81
  v_mfma_f32_16x16x32_bf16 v[92:95], a[156:159], v[188:191], v[204:207]
  s_add_u32 m0, s28, 49152
  v_exp_f32 v82, v82
  v_mfma_f32_16x16x32_bf16 v[92:95], a[152:155], v[184:187], v[92:95]
  buffer_load_dwordx4 v232, s[12:15], s29 offen offset:0 lds
  v_mfma_f32_16x16x32_bf16 v[92:95], a[148:151], v[180:183], v[92:95]
  s_waitcnt lgkmcnt(0)
  v_exp_f32 v83, v83
  v_mfma_f32_16x16x32_bf16 v[92:95], a[144:147], v[176:179], v[92:95]
  v_cvt_pk_bf16_f32 v81, v82, v83
  v_mfma_f32_16x16x32_bf16 v[96:99], a[128:131], v[128:131], v[192:195]
  v_exp_f32 v88, v88
  v_mfma_f32_16x16x32_bf16 v[96:99], a[132:135], v[132:135], v[96:99]
  ds_read_b128 a[144:147], v212 offset:28672
  v_mfma_f32_16x16x32_bf16 v[96:99], a[136:139], v[136:139], v[96:99]
  v_exp_f32 v89, v89
  v_mfma_f32_16x16x32_bf16 v[96:99], a[140:143], v[140:143], v[96:99]
  ds_read_b128 a[148:151], v213 offset:28672
  v_cvt_pk_bf16_f32 v88, v88, v89
  v_mfma_f32_16x16x32_bf16 v[104:107], a[140:143], v[156:159], v[196:199]
  v_exp_f32 v90, v90
  v_mfma_f32_16x16x32_bf16 v[104:107], a[136:139], v[152:155], v[104:107]
  ds_read_b128 a[152:155], v214 offset:28672
  v_mfma_f32_16x16x32_bf16 v[104:107], a[132:135], v[148:151], v[104:107]
  v_exp_f32 v91, v91
  v_mfma_f32_16x16x32_bf16 v[104:107], a[128:131], v[144:147], v[104:107]
  ds_read_b128 a[156:159], v215 offset:28672
  v_cvt_pk_bf16_f32 v89, v90, v91
  v_mfma_f32_16x16x32_bf16 v[112:115], a[128:131], v[160:163], v[200:203]
  v_exp_f32 v68, v68
  v_mfma_f32_16x16x32_bf16 v[112:115], a[132:135], v[164:167], v[112:115]
  buffer_load_dwordx4 v233, s[12:15], s29 offen offset:1024 lds
  v_mfma_f32_16x16x32_bf16 v[112:115], a[136:139], v[168:171], v[112:115]
  v_exp_f32 v69, v69
  v_mfma_f32_16x16x32_bf16 v[112:115], a[140:143], v[172:175], v[112:115]
  v_cvt_pk_bf16_f32 v66, v68, v69
  v_mfma_f32_16x16x32_bf16 v[120:123], a[140:143], v[188:191], v[204:207]
  v_exp_f32 v70, v70
  v_mfma_f32_16x16x32_bf16 v[120:123], a[136:139], v[184:187], v[120:123]
  buffer_load_dwordx4 v234, s[12:15], s29 offen offset:2048 lds
  v_mfma_f32_16x16x32_bf16 v[120:123], a[132:135], v[180:183], v[120:123]
  s_waitcnt lgkmcnt(0)
  v_exp_f32 v71, v71
  v_mfma_f32_16x16x32_bf16 v[120:123], a[128:131], v[176:179], v[120:123]
  v_cvt_pk_bf16_f32 v67, v70, v71
  v_mfma_f32_16x16x32_bf16 v[100:103], a[144:147], v[128:131], v[192:195]
  v_exp_f32 v76, v76
  v_mfma_f32_16x16x32_bf16 v[100:103], a[148:151], v[132:135], v[100:103]
  ds_read_b64_tr_b16 a[160:161], v216 offset:0
  v_mfma_f32_16x16x32_bf16 v[100:103], a[152:155], v[136:139], v[100:103]
  v_exp_f32 v77, v77
  v_mfma_f32_16x16x32_bf16 v[100:103], a[156:159], v[140:143], v[100:103]
  ds_read_b64_tr_b16 a[162:163], v216 offset:4096
  v_cvt_pk_bf16_f32 v74, v76, v77
  v_mfma_f32_16x16x32_bf16 v[108:111], a[156:159], v[156:159], v[196:199]
  v_exp_f32 v78, v78
  v_mfma_f32_16x16x32_bf16 v[108:111], a[152:155], v[152:155], v[108:111]
  ds_read_b64_tr_b16 a[164:165], v216 offset:8192
  buffer_load_dwordx4 v235, s[12:15], s29 offen offset:3072 lds
  v_mfma_f32_16x16x32_bf16 v[108:111], a[148:151], v[148:151], v[108:111]
  v_exp_f32 v79, v79
  v_mfma_f32_16x16x32_bf16 v[108:111], a[144:147], v[144:147], v[108:111]
  ds_read_b64_tr_b16 a[166:167], v216 offset:12288
  v_cvt_pk_bf16_f32 v75, v78, v79
  v_mfma_f32_16x16x32_bf16 v[116:119], a[144:147], v[160:163], v[200:203]
  s_add_u32 m0, s50, 5120
  v_exp_f32 v84, v84
  v_mfma_f32_16x16x32_bf16 v[116:119], a[148:151], v[164:167], v[116:119]
  ds_read_b64_tr_b16 a[168:169], v217 offset:0
  buffer_load_dwordx4 v208, s[20:23], s30 offen lds
  s_add_u32 s30, s30, 32
  v_mfma_f32_16x16x32_bf16 v[116:119], a[152:155], v[168:171], v[116:119]
  v_exp_f32 v85, v85
  v_mfma_f32_16x16x32_bf16 v[116:119], a[156:159], v[172:175], v[116:119]
  ds_read_b64_tr_b16 a[170:171], v217 offset:4096
  v_cvt_pk_bf16_f32 v82, v84, v85
  v_mfma_f32_16x16x32_bf16 v[124:127], a[156:159], v[188:191], v[204:207]
  v_exp_f32 v86, v86
  v_mfma_f32_16x16x32_bf16 v[124:127], a[152:155], v[184:187], v[124:127]
  ds_read_b64_tr_b16 a[172:173], v217 offset:8192
  v_mfma_f32_16x16x32_bf16 v[124:127], a[148:151], v[180:183], v[124:127]
  v_exp_f32 v87, v87
  v_mfma_f32_16x16x32_bf16 v[124:127], a[144:147], v[176:179], v[124:127]
  ds_read_b64_tr_b16 a[174:175], v217 offset:12288
  v_cvt_pk_bf16_f32 v83, v86, v87
  v_mfma_f32_16x16x32_bf16 a[192:195], a[208:211], v[0:3], a[192:195]
  v_exp_f32 v92, v92
  v_mfma_f32_16x16x32_bf16 a[192:195], a[208:211], v[32:35], a[192:195]
  ds_read_b64_tr_b16 a[176:177], v218 offset:0
  v_mfma_f32_16x16x32_bf16 a[196:199], a[208:211], v[8:11], a[196:199]
  v_exp_f32 v93, v93
  v_mfma_f32_16x16x32_bf16 a[196:199], a[208:211], v[40:43], a[196:199]
  ds_read_b64_tr_b16 a[178:179], v218 offset:4096
  v_cvt_pk_bf16_f32 v90, v92, v93
  v_mfma_f32_16x16x32_bf16 a[200:203], a[208:211], v[16:19], a[200:203]
  v_exp_f32 v94, v94
  v_mfma_f32_16x16x32_bf16 a[200:203], a[208:211], v[48:51], a[200:203]
  ds_read_b64_tr_b16 a[180:181], v218 offset:8192
  v_mfma_f32_16x16x32_bf16 a[204:207], a[208:211], v[24:27], a[204:207]
  s_waitcnt lgkmcnt(7)
  v_exp_f32 v95, v95
  v_mfma_f32_16x16x32_bf16 a[204:207], a[208:211], v[56:59], a[204:207]
  ds_read_b64_tr_b16 a[182:183], v218 offset:12288
  v_cvt_pk_bf16_f32 v91, v94, v95
  v_mfma_f32_16x16x32_bf16 a[0:3], a[160:163], v[0:3], a[0:3]
  v_exp_f32 v96, v96
  v_mfma_f32_16x16x32_bf16 a[0:3], a[164:167], v[32:35], a[0:3]
  ds_read_b64_tr_b16 a[184:185], v219 offset:0
  v_mfma_f32_16x16x32_bf16 a[4:7], a[164:167], v[40:43], a[4:7]
  v_exp_f32 v97, v97
  v_mfma_f32_16x16x32_bf16 a[4:7], a[160:163], v[8:11], a[4:7]
  ds_read_b64_tr_b16 a[186:187], v219 offset:4096
  v_cvt_pk_bf16_f32 v96, v96, v97
  v_mfma_f32_16x16x32_bf16 a[8:11], a[160:163], v[16:19], a[8:11]
  v_exp_f32 v98, v98
  v_mfma_f32_16x16x32_bf16 a[8:11], a[164:167], v[48:51], a[8:11]
  ds_read_b64_tr_b16 a[188:189], v219 offset:8192
  v_mfma_f32_16x16x32_bf16 a[12:15], a[164:167], v[56:59], a[12:15]
  s_waitcnt lgkmcnt(7)
  v_exp_f32 v99, v99
  v_mfma_f32_16x16x32_bf16 a[12:15], a[160:163], v[24:27], a[12:15]
  ds_read_b64_tr_b16 a[190:191], v219 offset:12288
  v_cvt_pk_bf16_f32 v97, v98, v99
  v_mfma_f32_16x16x32_bf16 a[16:19], a[168:171], v[0:3], a[16:19]
  v_exp_f32 v104, v104
  v_mfma_f32_16x16x32_bf16 a[16:19], a[172:175], v[32:35], a[16:19]
  ds_read_b64_tr_b16 a[160:161], v220 offset:0
  v_mfma_f32_16x16x32_bf16 a[20:23], a[172:175], v[40:43], a[20:23]
  v_exp_f32 v105, v105
  v_mfma_f32_16x16x32_bf16 a[20:23], a[168:171], v[8:11], a[20:23]
  ds_read_b64_tr_b16 a[162:163], v220 offset:4096
  v_cvt_pk_bf16_f32 v104, v104, v105
  v_mfma_f32_16x16x32_bf16 a[24:27], a[168:171], v[16:19], a[24:27]
  v_exp_f32 v106, v106
  v_mfma_f32_16x16x32_bf16 a[24:27], a[172:175], v[48:51], a[24:27]
  ds_read_b64_tr_b16 a[164:165], v220 offset:8192
  v_mfma_f32_16x16x32_bf16 a[28:31], a[172:175], v[56:59], a[28:31]
  s_waitcnt lgkmcnt(7)
  v_exp_f32 v107, v107
  v_mfma_f32_16x16x32_bf16 a[28:31], a[168:171], v[24:27], a[28:31]
  ds_read_b64_tr_b16 a[166:167], v220 offset:12288
  v_cvt_pk_bf16_f32 v105, v106, v107
  v_mfma_f32_16x16x32_bf16 a[32:35], a[176:179], v[0:3], a[32:35]
  v_exp_f32 v112, v112
  v_mfma_f32_16x16x32_bf16 a[32:35], a[180:183], v[32:35], a[32:35]
  ds_read_b64_tr_b16 a[168:169], v221 offset:0
  v_mfma_f32_16x16x32_bf16 a[36:39], a[180:183], v[40:43], a[36:39]
  v_exp_f32 v113, v113
  v_mfma_f32_16x16x32_bf16 a[36:39], a[176:179], v[8:11], a[36:39]
  ds_read_b64_tr_b16 a[170:171], v221 offset:4096
  v_cvt_pk_bf16_f32 v112, v112, v113
  v_mfma_f32_16x16x32_bf16 a[40:43], a[176:179], v[16:19], a[40:43]
  v_exp_f32 v114, v114
  v_mfma_f32_16x16x32_bf16 a[40:43], a[180:183], v[48:51], a[40:43]
  ds_read_b64_tr_b16 a[172:173], v221 offset:8192
  v_mfma_f32_16x16x32_bf16 a[44:47], a[180:183], v[56:59], a[44:47]
  s_waitcnt lgkmcnt(7)
  v_exp_f32 v115, v115
  v_mfma_f32_16x16x32_bf16 a[44:47], a[176:179], v[24:27], a[44:47]
  ds_read_b64_tr_b16 a[174:175], v221 offset:12288
  v_cvt_pk_bf16_f32 v113, v114, v115
  v_mfma_f32_16x16x32_bf16 a[48:51], a[184:187], v[0:3], a[48:51]
  v_exp_f32 v120, v120
  v_mfma_f32_16x16x32_bf16 a[48:51], a[188:191], v[32:35], a[48:51]
  ds_read_b64_tr_b16 a[176:177], v222 offset:0
  v_mfma_f32_16x16x32_bf16 a[52:55], a[188:191], v[40:43], a[52:55]
  v_exp_f32 v121, v121
  v_mfma_f32_16x16x32_bf16 a[52:55], a[184:187], v[8:11], a[52:55]
  ds_read_b64_tr_b16 a[178:179], v222 offset:4096
  v_cvt_pk_bf16_f32 v120, v120, v121
  v_mfma_f32_16x16x32_bf16 a[56:59], a[184:187], v[16:19], a[56:59]
  v_exp_f32 v122, v122
  v_mfma_f32_16x16x32_bf16 a[56:59], a[188:191], v[48:51], a[56:59]
  ds_read_b64_tr_b16 a[180:181], v222 offset:8192
  v_mfma_f32_16x16x32_bf16 a[60:63], a[188:191], v[56:59], a[60:63]
  s_waitcnt lgkmcnt(7)
  v_exp_f32 v123, v123
  v_mfma_f32_16x16x32_bf16 a[60:63], a[184:187], v[24:27], a[60:63]
  ds_read_b64_tr_b16 a[182:183], v222 offset:12288
  v_cvt_pk_bf16_f32 v121, v122, v123
  v_mfma_f32_16x16x32_bf16 a[64:67], a[160:163], v[0:3], a[64:67]
  v_exp_f32 v100, v100
  v_mfma_f32_16x16x32_bf16 a[64:67], a[164:167], v[32:35], a[64:67]
  ds_read_b64_tr_b16 a[184:185], v223 offset:0
  v_mfma_f32_16x16x32_bf16 a[68:71], a[164:167], v[40:43], a[68:71]
  v_exp_f32 v101, v101
  v_mfma_f32_16x16x32_bf16 a[68:71], a[160:163], v[8:11], a[68:71]
  ds_read_b64_tr_b16 a[186:187], v223 offset:4096
  v_cvt_pk_bf16_f32 v98, v100, v101
  v_mfma_f32_16x16x32_bf16 a[72:75], a[160:163], v[16:19], a[72:75]
  v_exp_f32 v102, v102
  v_mfma_f32_16x16x32_bf16 a[72:75], a[164:167], v[48:51], a[72:75]
  ds_read_b64_tr_b16 a[188:189], v223 offset:8192
  v_mfma_f32_16x16x32_bf16 a[76:79], a[164:167], v[56:59], a[76:79]
  s_waitcnt lgkmcnt(7)
  v_exp_f32 v103, v103
  v_mfma_f32_16x16x32_bf16 a[76:79], a[160:163], v[24:27], a[76:79]
  ds_read_b64_tr_b16 a[190:191], v223 offset:12288
  v_cvt_pk_bf16_f32 v99, v102, v103
  v_mfma_f32_16x16x32_bf16 a[80:83], a[168:171], v[0:3], a[80:83]
  s_waitcnt vmcnt(10)
  v_exp_f32 v108, v108
  v_mfma_f32_16x16x32_bf16 a[80:83], a[172:175], v[32:35], a[80:83]
  v_mfma_f32_16x16x32_bf16 a[84:87], a[172:175], v[40:43], a[84:87]
  s_barrier
  v_exp_f32 v109, v109
  v_mfma_f32_16x16x32_bf16 a[84:87], a[168:171], v[8:11], a[84:87]
  ds_read_b128 a[128:131], v212 offset:32768
  v_cvt_pk_bf16_f32 v106, v108, v109
  v_mfma_f32_16x16x32_bf16 a[88:91], a[168:171], v[16:19], a[88:91]
  v_exp_f32 v110, v110
  v_mfma_f32_16x16x32_bf16 a[88:91], a[172:175], v[48:51], a[88:91]
  ds_read_b128 a[132:135], v213 offset:32768
  buffer_atomic_add v250, v249, s[24:27], s47 offen
  s_cmp_eq_u32 s32, 3
  s_cselect_b32 s39, 0, 1073741824
  v_mfma_f32_16x16x32_bf16 a[92:95], a[172:175], v[56:59], a[92:95]
  s_waitcnt lgkmcnt(6)
  v_exp_f32 v111, v111
  v_mfma_f32_16x16x32_bf16 a[92:95], a[168:171], v[24:27], a[92:95]
  ds_read_b128 a[136:139], v214 offset:32768
  v_cvt_pk_bf16_f32 v107, v110, v111
  v_mfma_f32_16x16x32_bf16 a[96:99], a[176:179], v[0:3], a[96:99]
  v_exp_f32 v116, v116
  v_mfma_f32_16x16x32_bf16 a[96:99], a[180:183], v[32:35], a[96:99]
  ds_read_b128 a[140:143], v215 offset:32768
  v_or_b32 v249, s39, v251
  v_mfma_f32_16x16x32_bf16 a[100:103], a[180:183], v[40:43], a[100:103]
  v_exp_f32 v117, v117
  v_mfma_f32_16x16x32_bf16 a[100:103], a[176:179], v[8:11], a[100:103]
  v_cvt_pk_bf16_f32 v114, v116, v117
  v_mfma_f32_16x16x32_bf16 a[104:107], a[176:179], v[16:19], a[104:107]
  v_exp_f32 v118, v118
  v_mfma_f32_16x16x32_bf16 a[104:107], a[180:183], v[48:51], a[104:107]
  v_mfma_f32_16x16x32_bf16 a[108:111], a[180:183], v[56:59], a[108:111]
  s_waitcnt lgkmcnt(4)
  v_exp_f32 v119, v119
  v_mfma_f32_16x16x32_bf16 a[108:111], a[176:179], v[24:27], a[108:111]
  v_cvt_pk_bf16_f32 v115, v118, v119
  v_mfma_f32_16x16x32_bf16 a[112:115], a[184:187], v[0:3], a[112:115]
  v_exp_f32 v124, v124
  v_mfma_f32_16x16x32_bf16 a[112:115], a[188:191], v[32:35], a[112:115]
  v_mfma_f32_16x16x32_bf16 a[116:119], a[188:191], v[40:43], a[116:119]
  v_exp_f32 v125, v125
  v_mfma_f32_16x16x32_bf16 a[116:119], a[184:187], v[8:11], a[116:119]
  v_cvt_pk_bf16_f32 v122, v124, v125
  v_mfma_f32_16x16x32_bf16 a[120:123], a[184:187], v[16:19], a[120:123]
  v_exp_f32 v126, v126
  v_mfma_f32_16x16x32_bf16 a[120:123], a[188:191], v[48:51], a[120:123]
  v_mfma_f32_16x16x32_bf16 a[124:127], a[188:191], v[56:59], a[124:127]
  s_waitcnt lgkmcnt(0)
  v_exp_f32 v127, v127
  v_mfma_f32_16x16x32_bf16 a[124:127], a[184:187], v[24:27], a[124:127]
  v_cvt_pk_bf16_f32 v123, v126, v127
  v_mfma_f32_16x16x32_bf16 v[0:3], a[128:131], v[128:131], v[192:195]
  s_add_u32 m0, s28, 114688
  v_mfma_f32_16x16x32_bf16 v[0:3], a[132:135], v[132:135], v[0:3]
  ds_read_b128 a[144:147], v212 offset:36864
  v_mfma_f32_16x16x32_bf16 v[0:3], a[136:139], v[136:139], v[0:3]
  buffer_load_dwordx4 v236, s[16:19], s29 offen offset:0 lds
  v_mfma_f32_16x16x32_bf16 v[0:3], a[140:143], v[140:143], v[0:3]
  ds_read_b128 a[148:151], v213 offset:36864
  v_mfma_f32_16x16x32_bf16 v[8:11], a[140:143], v[156:159], v[196:199]
  v_mfma_f32_16x16x32_bf16 v[8:11], a[136:139], v[152:155], v[8:11]
  ds_read_b128 a[152:155], v214 offset:36864
  v_mfma_f32_16x16x32_bf16 v[8:11], a[132:135], v[148:151], v[8:11]
  buffer_load_dwordx4 v237, s[16:19], s29 offen offset:1024 lds
  v_mfma_f32_16x16x32_bf16 v[8:11], a[128:131], v[144:147], v[8:11]
  ds_read_b128 a[156:159], v215 offset:36864
  v_mfma_f32_16x16x32_bf16 v[16:19], a[128:131], v[160:163], v[200:203]
  v_exp_f32 v0, v0
  v_mfma_f32_16x16x32_bf16 v[16:19], a[132:135], v[164:167], v[16:19]
  v_mfma_f32_16x16x32_bf16 v[16:19], a[136:139], v[168:171], v[16:19]
  v_exp_f32 v1, v1
  v_mfma_f32_16x16x32_bf16 v[16:19], a[140:143], v[172:175], v[16:19]
  v_cvt_pk_bf16_f32 v0, v0, v1
  v_mfma_f32_16x16x32_bf16 v[24:27], a[140:143], v[188:191], v[204:207]
  v_exp_f32 v2, v2
  v_mfma_f32_16x16x32_bf16 v[24:27], a[136:139], v[184:187], v[24:27]
  buffer_load_dwordx4 v236, s[16:19], s29 offen offset:2048 lds
  v_mfma_f32_16x16x32_bf16 v[24:27], a[132:135], v[180:183], v[24:27]
  s_waitcnt lgkmcnt(0)
  v_exp_f32 v3, v3
  v_mfma_f32_16x16x32_bf16 v[24:27], a[128:131], v[176:179], v[24:27]
  v_cvt_pk_bf16_f32 v1, v2, v3
  v_mfma_f32_16x16x32_bf16 v[4:7], a[144:147], v[128:131], v[192:195]
  v_exp_f32 v8, v8
  v_mfma_f32_16x16x32_bf16 v[4:7], a[148:151], v[132:135], v[4:7]
  ds_read_b128 a[128:131], v212 offset:40960
  v_mfma_f32_16x16x32_bf16 v[4:7], a[152:155], v[136:139], v[4:7]
  v_exp_f32 v9, v9
  v_mfma_f32_16x16x32_bf16 v[4:7], a[156:159], v[140:143], v[4:7]
  ds_read_b128 a[132:135], v213 offset:40960
  v_cvt_pk_bf16_f32 v8, v8, v9
  v_mfma_f32_16x16x32_bf16 v[12:15], a[156:159], v[156:159], v[196:199]
  v_exp_f32 v10, v10
  v_mfma_f32_16x16x32_bf16 v[12:15], a[152:155], v[152:155], v[12:15]
  ds_read_b128 a[136:139], v214 offset:40960
  v_mfma_f32_16x16x32_bf16 v[12:15], a[148:151], v[148:151], v[12:15]
  v_exp_f32 v11, v11
  v_mfma_f32_16x16x32_bf16 v[12:15], a[144:147], v[144:147], v[12:15]
  ds_read_b128 a[140:143], v215 offset:40960
  v_cvt_pk_bf16_f32 v9, v10, v11
  v_mfma_f32_16x16x32_bf16 v[20:23], a[144:147], v[160:163], v[200:203]
  v_exp_f32 v16, v16
  v_mfma_f32_16x16x32_bf16 v[20:23], a[148:151], v[164:167], v[20:23]
  buffer_load_dwordx4 v237, s[16:19], s29 offen offset:3072 lds
  v_mfma_f32_16x16x32_bf16 v[20:23], a[152:155], v[168:171], v[20:23]
  s_add_u32 s29, s29, 16384
  v_exp_f32 v17, v17
  v_mfma_f32_16x16x32_bf16 v[20:23], a[156:159], v[172:175], v[20:23]
  v_cvt_pk_bf16_f32 v16, v16, v17
  v_mfma_f32_16x16x32_bf16 v[28:31], a[156:159], v[188:191], v[204:207]
  s_add_u32 m0, s28, 0
  v_exp_f32 v18, v18
  v_mfma_f32_16x16x32_bf16 v[28:31], a[152:155], v[184:187], v[28:31]
  buffer_load_dwordx4 v232, s[12:15], s29 offen offset:0 lds
  v_mfma_f32_16x16x32_bf16 v[28:31], a[148:151], v[180:183], v[28:31]
  s_waitcnt lgkmcnt(0)
  v_exp_f32 v19, v19
  v_mfma_f32_16x16x32_bf16 v[28:31], a[144:147], v[176:179], v[28:31]
  v_cvt_pk_bf16_f32 v17, v18, v19
  v_mfma_f32_16x16x32_bf16 v[32:35], a[128:131], v[128:131], v[192:195]
  v_exp_f32 v24, v24
  v_mfma_f32_16x16x32_bf16 v[32:35], a[132:135], v[132:135], v[32:35]
  ds_read_b128 a[144:147], v212 offset:45056
  v_mfma_f32_16x16x32_bf16 v[32:35], a[136:139], v[136:139], v[32:35]
  v_exp_f32 v25, v25
  v_mfma_f32_16x16x32_bf16 v[32:35], a[140:143], v[140:143], v[32:35]
  ds_read_b128 a[148:151], v213 offset:45056
  v_cvt_pk_bf16_f32 v24, v24, v25
  v_mfma_f32_16x16x32_bf16 v[40:43], a[140:143], v[156:159], v[196:199]
  v_exp_f32 v26, v26
  v_mfma_f32_16x16x32_bf16 v[40:43], a[136:139], v[152:155], v[40:43]
  ds_read_b128 a[152:155], v214 offset:45056
  v_mfma_f32_16x16x32_bf16 v[40:43], a[132:135], v[148:151], v[40:43]
  v_exp_f32 v27, v27
  v_mfma_f32_16x16x32_bf16 v[40:43], a[128:131], v[144:147], v[40:43]
  ds_read_b128 a[156:159], v215 offset:45056
  v_cvt_pk_bf16_f32 v25, v26, v27
  v_mfma_f32_16x16x32_bf16 v[48:51], a[128:131], v[160:163], v[200:203]
  v_exp_f32 v4, v4
  v_mfma_f32_16x16x32_bf16 v[48:51], a[132:135], v[164:167], v[48:51]
  buffer_load_dwordx4 v233, s[12:15], s29 offen offset:1024 lds
  v_mfma_f32_16x16x32_bf16 v[48:51], a[136:139], v[168:171], v[48:51]
  v_exp_f32 v5, v5
  v_mfma_f32_16x16x32_bf16 v[48:51], a[140:143], v[172:175], v[48:51]
  v_cvt_pk_bf16_f32 v2, v4, v5
  v_mfma_f32_16x16x32_bf16 v[56:59], a[140:143], v[188:191], v[204:207]
  v_exp_f32 v6, v6
  v_mfma_f32_16x16x32_bf16 v[56:59], a[136:139], v[184:187], v[56:59]
  buffer_load_dwordx4 v234, s[12:15], s29 offen offset:2048 lds
  v_mfma_f32_16x16x32_bf16 v[56:59], a[132:135], v[180:183], v[56:59]
  s_waitcnt lgkmcnt(0)
  v_exp_f32 v7, v7
  v_mfma_f32_16x16x32_bf16 v[56:59], a[128:131], v[176:179], v[56:59]
  v_cvt_pk_bf16_f32 v3, v6, v7
  v_mfma_f32_16x16x32_bf16 v[36:39], a[144:147], v[128:131], v[192:195]
  v_exp_f32 v12, v12
  v_mfma_f32_16x16x32_bf16 v[36:39], a[148:151], v[132:135], v[36:39]
  ds_read_b64_tr_b16 a[160:161], v216 offset:16384
  v_mfma_f32_16x16x32_bf16 v[36:39], a[152:155], v[136:139], v[36:39]
  v_exp_f32 v13, v13
  v_mfma_f32_16x16x32_bf16 v[36:39], a[156:159], v[140:143], v[36:39]
  ds_read_b64_tr_b16 a[162:163], v216 offset:20480
  v_cvt_pk_bf16_f32 v10, v12, v13
  v_mfma_f32_16x16x32_bf16 v[44:47], a[156:159], v[156:159], v[196:199]
  v_exp_f32 v14, v14
  v_mfma_f32_16x16x32_bf16 v[44:47], a[152:155], v[152:155], v[44:47]
  ds_read_b64_tr_b16 a[164:165], v216 offset:24576
  buffer_load_dwordx4 v235, s[12:15], s29 offen offset:3072 lds
  v_mfma_f32_16x16x32_bf16 v[44:47], a[148:151], v[148:151], v[44:47]
  v_exp_f32 v15, v15
  v_mfma_f32_16x16x32_bf16 v[44:47], a[144:147], v[144:147], v[44:47]
  ds_read_b64_tr_b16 a[166:167], v216 offset:28672
  v_cvt_pk_bf16_f32 v11, v14, v15
  v_mfma_f32_16x16x32_bf16 v[52:55], a[144:147], v[160:163], v[200:203]
  s_mov_b32 m0, s51
  v_exp_f32 v20, v20
  v_mfma_f32_16x16x32_bf16 v[52:55], a[148:151], v[164:167], v[52:55]
  ds_read_b64_tr_b16 a[168:169], v217 offset:16384
  buffer_load_dwordx4 v210, s[4:7], s100 offen lds
  s_add_u32 s100, s100, 20480
  s_add_u32 s51, s51, 512
  v_mfma_f32_16x16x32_bf16 v[52:55], a[152:155], v[168:171], v[52:55]
  v_exp_f32 v21, v21
  v_mfma_f32_16x16x32_bf16 v[52:55], a[156:159], v[172:175], v[52:55]
  ds_read_b64_tr_b16 a[170:171], v217 offset:20480
  v_cvt_pk_bf16_f32 v18, v20, v21
  v_mfma_f32_16x16x32_bf16 v[60:63], a[156:159], v[188:191], v[204:207]
  s_waitcnt vmcnt(19)
  v_exp_f32 v22, v22
  v_mfma_f32_16x16x32_bf16 v[60:63], a[152:155], v[184:187], v[60:63]
  ds_read_b64_tr_b16 a[172:173], v217 offset:24576
  ds_read_b64_tr_b16 a[232:233], v209 offset:4096
  v_mfma_f32_16x16x32_bf16 v[60:63], a[148:151], v[180:183], v[60:63]
  v_exp_f32 v23, v23
  v_mfma_f32_16x16x32_bf16 v[60:63], a[144:147], v[176:179], v[60:63]
  ds_read_b64_tr_b16 a[174:175], v217 offset:28672
  v_cvt_pk_bf16_f32 v19, v22, v23
  v_mfma_f32_16x16x32_bf16 a[192:195], a[208:211], v[64:67], a[192:195]
  v_exp_f32 v28, v28
  v_mfma_f32_16x16x32_bf16 a[192:195], a[208:211], v[96:99], a[192:195]
  ds_read_b64_tr_b16 a[176:177], v218 offset:16384
  ds_read_b64_tr_b16 a[234:235], v209 offset:4608
  v_mfma_f32_16x16x32_bf16 a[196:199], a[208:211], v[72:75], a[196:199]
  v_exp_f32 v29, v29
  v_mfma_f32_16x16x32_bf16 a[196:199], a[208:211], v[104:107], a[196:199]
  ds_read_b64_tr_b16 a[178:179], v218 offset:20480
  v_cvt_pk_bf16_f32 v26, v28, v29
  v_mfma_f32_16x16x32_bf16 a[200:203], a[208:211], v[80:83], a[200:203]
  v_exp_f32 v30, v30
  v_mfma_f32_16x16x32_bf16 a[200:203], a[208:211], v[112:115], a[200:203]
  ds_read_b64_tr_b16 a[180:181], v218 offset:24576
  v_mfma_f32_16x16x32_bf16 a[204:207], a[208:211], v[88:91], a[204:207]
  s_waitcnt lgkmcnt(9)
  v_exp_f32 v31, v31
  v_mfma_f32_16x16x32_bf16 a[204:207], a[208:211], v[120:123], a[204:207]
  ds_read_b64_tr_b16 a[182:183], v218 offset:28672
  v_cvt_pk_bf16_f32 v27, v30, v31
  v_mfma_f32_16x16x32_bf16 a[0:3], a[160:163], v[64:67], a[0:3]
  v_exp_f32 v32, v32
  v_mfma_f32_16x16x32_bf16 a[0:3], a[164:167], v[96:99], a[0:3]
  ds_read_b64_tr_b16 a[184:185], v219 offset:16384
  s_waitcnt lgkmcnt(4)
  buffer_store_dwordx4 a[232:235], v211, s[24:27], s31 offen sc1
  s_add_u32 s31, s31, 1024
  s_cmp_gt_u32 s32, 3
  v_mfma_f32_16x16x32_bf16 a[4:7], a[164:167], v[104:107], a[4:7]
  s_cselect_b32 s39, 0, 1073741824
  v_exp_f32 v33, v33
  v_mfma_f32_16x16x32_bf16 a[4:7], a[160:163], v[72:75], a[4:7]
  ds_read_b64_tr_b16 a[186:187], v219 offset:20480
  v_cvt_pk_bf16_f32 v32, v32, v33
  v_mfma_f32_16x16x32_bf16 a[8:11], a[160:163], v[80:83], a[8:11]
  v_exp_f32 v34, v34
  v_mfma_f32_16x16x32_bf16 a[8:11], a[164:167], v[112:115], a[8:11]
  ds_read_b64_tr_b16 a[188:189], v219 offset:24576
  v_or_b32 v211, s39, v211
  v_mfma_f32_16x16x32_bf16 a[12:15], a[164:167], v[120:123], a[12:15]
  v_exp_f32 v35, v35
  v_mfma_f32_16x16x32_bf16 a[12:15], a[160:163], v[88:91], a[12:15]
  ds_read_b64_tr_b16 a[190:191], v219 offset:28672
  v_cvt_pk_bf16_f32 v33, v34, v35
  v_mfma_f32_16x16x32_bf16 a[16:19], a[168:171], v[64:67], a[16:19]
  v_exp_f32 v40, v40
  v_mfma_f32_16x16x32_bf16 a[16:19], a[172:175], v[96:99], a[16:19]
  ds_read_b64_tr_b16 a[160:161], v220 offset:16384
  v_or_b32 v208, s39, v208
  v_mfma_f32_16x16x32_bf16 a[20:23], a[172:175], v[104:107], a[20:23]
  v_exp_f32 v41, v41
  v_mfma_f32_16x16x32_bf16 a[20:23], a[168:171], v[72:75], a[20:23]
  ds_read_b64_tr_b16 a[162:163], v220 offset:20480
  v_cvt_pk_bf16_f32 v40, v40, v41
  v_mfma_f32_16x16x32_bf16 a[24:27], a[168:171], v[80:83], a[24:27]
  v_exp_f32 v42, v42
  v_mfma_f32_16x16x32_bf16 a[24:27], a[172:175], v[112:115], a[24:27]
  ds_read_b64_tr_b16 a[164:165], v220 offset:24576
  v_mfma_f32_16x16x32_bf16 a[28:31], a[172:175], v[120:123], a[28:31]
  s_waitcnt lgkmcnt(7)
  v_exp_f32 v43, v43
  v_mfma_f32_16x16x32_bf16 a[28:31], a[168:171], v[88:91], a[28:31]
  ds_read_b64_tr_b16 a[166:167], v220 offset:28672
  v_cvt_pk_bf16_f32 v41, v42, v43
  v_mfma_f32_16x16x32_bf16 a[32:35], a[176:179], v[64:67], a[32:35]
  v_exp_f32 v48, v48
  v_mfma_f32_16x16x32_bf16 a[32:35], a[180:183], v[96:99], a[32:35]
  ds_read_b64_tr_b16 a[168:169], v221 offset:16384
  v_mfma_f32_16x16x32_bf16 a[36:39], a[180:183], v[104:107], a[36:39]
  v_exp_f32 v49, v49
  v_mfma_f32_16x16x32_bf16 a[36:39], a[176:179], v[72:75], a[36:39]
  ds_read_b64_tr_b16 a[170:171], v221 offset:20480
  v_cvt_pk_bf16_f32 v48, v48, v49
  v_mfma_f32_16x16x32_bf16 a[40:43], a[176:179], v[80:83], a[40:43]
  v_exp_f32 v50, v50
  v_mfma_f32_16x16x32_bf16 a[40:43], a[180:183], v[112:115], a[40:43]
  ds_read_b64_tr_b16 a[172:173], v221 offset:24576
  v_mfma_f32_16x16x32_bf16 a[44:47], a[180:183], v[120:123], a[44:47]
  s_waitcnt lgkmcnt(7)
  v_exp_f32 v51, v51
  v_mfma_f32_16x16x32_bf16 a[44:47], a[176:179], v[88:91], a[44:47]
  ds_read_b64_tr_b16 a[174:175], v221 offset:28672
  v_cvt_pk_bf16_f32 v49, v50, v51
  v_mfma_f32_16x16x32_bf16 a[48:51], a[184:187], v[64:67], a[48:51]
  v_exp_f32 v56, v56
  v_mfma_f32_16x16x32_bf16 a[48:51], a[188:191], v[96:99], a[48:51]
  ds_read_b64_tr_b16 a[176:177], v222 offset:16384
  v_mfma_f32_16x16x32_bf16 a[52:55], a[188:191], v[104:107], a[52:55]
  v_exp_f32 v57, v57
  v_mfma_f32_16x16x32_bf16 a[52:55], a[184:187], v[72:75], a[52:55]
  ds_read_b64_tr_b16 a[178:179], v222 offset:20480
  v_cvt_pk_bf16_f32 v56, v56, v57
  v_mfma_f32_16x16x32_bf16 a[56:59], a[184:187], v[80:83], a[56:59]
  v_exp_f32 v58, v58
  v_mfma_f32_16x16x32_bf16 a[56:59], a[188:191], v[112:115], a[56:59]
  ds_read_b64_tr_b16 a[180:181], v222 offset:24576
  v_mfma_f32_16x16x32_bf16 a[60:63], a[188:191], v[120:123], a[60:63]
  s_waitcnt lgkmcnt(7)
  v_exp_f32 v59, v59
  v_mfma_f32_16x16x32_bf16 a[60:63], a[184:187], v[88:91], a[60:63]
  ds_read_b64_tr_b16 a[182:183], v222 offset:28672
  v_cvt_pk_bf16_f32 v57, v58, v59
  v_mfma_f32_16x16x32_bf16 a[64:67], a[160:163], v[64:67], a[64:67]
  v_exp_f32 v36, v36
  v_mfma_f32_16x16x32_bf16 a[64:67], a[164:167], v[96:99], a[64:67]
  ds_read_b64_tr_b16 a[184:185], v223 offset:16384
  v_mfma_f32_16x16x32_bf16 a[68:71], a[164:167], v[104:107], a[68:71]
  v_exp_f32 v37, v37
  v_mfma_f32_16x16x32_bf16 a[68:71], a[160:163], v[72:75], a[68:71]
  ds_read_b64_tr_b16 a[186:187], v223 offset:20480
  v_cvt_pk_bf16_f32 v34, v36, v37
  v_mfma_f32_16x16x32_bf16 a[72:75], a[160:163], v[80:83], a[72:75]
  v_exp_f32 v38, v38
  v_mfma_f32_16x16x32_bf16 a[72:75], a[164:167], v[112:115], a[72:75]
  ds_read_b64_tr_b16 a[188:189], v223 offset:24576
  v_mfma_f32_16x16x32_bf16 a[76:79], a[164:167], v[120:123], a[76:79]
  s_waitcnt lgkmcnt(7)
  v_exp_f32 v39, v39
  v_mfma_f32_16x16x32_bf16 a[76:79], a[160:163], v[88:91], a[76:79]
  ds_read_b64_tr_b16 a[190:191], v223 offset:28672
  v_cvt_pk_bf16_f32 v35, v38, v39
  v_mfma_f32_16x16x32_bf16 a[80:83], a[168:171], v[64:67], a[80:83]
  s_waitcnt vmcnt(12)
  v_exp_f32 v44, v44
  v_mfma_f32_16x16x32_bf16 a[80:83], a[172:175], v[96:99], a[80:83]
  v_mfma_f32_16x16x32_bf16 a[84:87], a[172:175], v[104:107], a[84:87]
  s_barrier
  v_exp_f32 v45, v45
  v_mfma_f32_16x16x32_bf16 a[84:87], a[168:171], v[72:75], a[84:87]
  ds_read_b128 a[128:131], v212 offset:49152
  v_cvt_pk_bf16_f32 v42, v44, v45
  v_mfma_f32_16x16x32_bf16 a[88:91], a[168:171], v[80:83], a[88:91]
  v_exp_f32 v46, v46
  v_mfma_f32_16x16x32_bf16 a[88:91], a[172:175], v[112:115], a[88:91]
  ds_read_b128 a[132:135], v213 offset:49152
  v_mfma_f32_16x16x32_bf16 a[92:95], a[172:175], v[120:123], a[92:95]
  s_waitcnt lgkmcnt(6)
  v_exp_f32 v47, v47
  v_mfma_f32_16x16x32_bf16 a[92:95], a[168:171], v[88:91], a[92:95]
  ds_read_b128 a[136:139], v214 offset:49152
  v_cvt_pk_bf16_f32 v43, v46, v47
  v_mfma_f32_16x16x32_bf16 a[96:99], a[176:179], v[64:67], a[96:99]
  v_exp_f32 v52, v52
  v_mfma_f32_16x16x32_bf16 a[96:99], a[180:183], v[96:99], a[96:99]
  ds_read_b128 a[140:143], v215 offset:49152
  v_mfma_f32_16x16x32_bf16 a[100:103], a[180:183], v[104:107], a[100:103]
  v_exp_f32 v53, v53
  v_mfma_f32_16x16x32_bf16 a[100:103], a[176:179], v[72:75], a[100:103]
  v_cvt_pk_bf16_f32 v50, v52, v53
  v_mfma_f32_16x16x32_bf16 a[104:107], a[176:179], v[80:83], a[104:107]
  v_exp_f32 v54, v54
  v_mfma_f32_16x16x32_bf16 a[104:107], a[180:183], v[112:115], a[104:107]
  v_mfma_f32_16x16x32_bf16 a[108:111], a[180:183], v[120:123], a[108:111]
  s_waitcnt lgkmcnt(4)
  v_exp_f32 v55, v55
  v_mfma_f32_16x16x32_bf16 a[108:111], a[176:179], v[88:91], a[108:111]
  v_cvt_pk_bf16_f32 v51, v54, v55
  v_mfma_f32_16x16x32_bf16 a[112:115], a[184:187], v[64:67], a[112:115]
  v_exp_f32 v60, v60
  v_mfma_f32_16x16x32_bf16 a[112:115], a[188:191], v[96:99], a[112:115]
  v_mfma_f32_16x16x32_bf16 a[116:119], a[188:191], v[104:107], a[116:119]
  v_exp_f32 v61, v61
  v_mfma_f32_16x16x32_bf16 a[116:119], a[184:187], v[72:75], a[116:119]
  v_cvt_pk_bf16_f32 v58, v60, v61
  v_mfma_f32_16x16x32_bf16 a[120:123], a[184:187], v[80:83], a[120:123]
  v_exp_f32 v62, v62
  v_mfma_f32_16x16x32_bf16 a[120:123], a[188:191], v[112:115], a[120:123]
  v_mfma_f32_16x16x32_bf16 a[124:127], a[188:191], v[120:123], a[124:127]
  s_waitcnt lgkmcnt(0)
  v_exp_f32 v63, v63
  v_mfma_f32_16x16x32_bf16 a[124:127], a[184:187], v[88:91], a[124:127]
  v_cvt_pk_bf16_f32 v59, v62, v63
  v_mfma_f32_16x16x32_bf16 v[64:67], a[128:131], v[128:131], v[192:195]
  s_add_u32 m0, s28, 65536
  v_mfma_f32_16x16x32_bf16 v[64:67], a[132:135], v[132:135], v[64:67]
  ds_read_b128 a[144:147], v212 offset:53248
  v_mfma_f32_16x16x32_bf16 v[64:67], a[136:139], v[136:139], v[64:67]
  buffer_load_dwordx4 v236, s[16:19], s29 offen offset:0 lds
  v_mfma_f32_16x16x32_bf16 v[64:67], a[140:143], v[140:143], v[64:67]
  ds_read_b128 a[148:151], v213 offset:53248
  v_mfma_f32_16x16x32_bf16 v[72:75], a[140:143], v[156:159], v[196:199]
  v_mfma_f32_16x16x32_bf16 v[72:75], a[136:139], v[152:155], v[72:75]
  ds_read_b128 a[152:155], v214 offset:53248
  v_mfma_f32_16x16x32_bf16 v[72:75], a[132:135], v[148:151], v[72:75]
  buffer_load_dwordx4 v237, s[16:19], s29 offen offset:1024 lds
  v_mfma_f32_16x16x32_bf16 v[72:75], a[128:131], v[144:147], v[72:75]
  ds_read_b128 a[156:159], v215 offset:53248
  v_mfma_f32_16x16x32_bf16 v[80:83], a[128:131], v[160:163], v[200:203]
  v_exp_f32 v64, v64
  v_mfma_f32_16x16x32_bf16 v[80:83], a[132:135], v[164:167], v[80:83]
  v_mfma_f32_16x16x32_bf16 v[80:83], a[136:139], v[168:171], v[80:83]
  v_exp_f32 v65, v65
  v_mfma_f32_16x16x32_bf16 v[80:83], a[140:143], v[172:175], v[80:83]
  v_cvt_pk_bf16_f32 v64, v64, v65
  v_mfma_f32_16x16x32_bf16 v[88:91], a[140:143], v[188:191], v[204:207]
  v_exp_f32 v66, v66
  v_mfma_f32_16x16x32_bf16 v[88:91], a[136:139], v[184:187], v[88:91]
  buffer_load_dwordx4 v236, s[16:19], s29 offen offset:2048 lds
  v_mfma_f32_16x16x32_bf16 v[88:91], a[132:135], v[180:183], v[88:91]
  s_waitcnt lgkmcnt(0)
  v_exp_f32 v67, v67
  v_mfma_f32_16x16x32_bf16 v[88:91], a[128:131], v[176:179], v[88:91]
  v_cvt_pk_bf16_f32 v65, v66, v67
  v_mfma_f32_16x16x32_bf16 v[68:71], a[144:147], v[128:131], v[192:195]
  v_exp_f32 v72, v72
  v_mfma_f32_16x16x32_bf16 v[68:71], a[148:151], v[132:135], v[68:71]
  ds_read_b128 a[128:131], v212 offset:57344
  v_mfma_f32_16x16x32_bf16 v[68:71], a[152:155], v[136:139], v[68:71]
  v_exp_f32 v73, v73
  v_mfma_f32_16x16x32_bf16 v[68:71], a[156:159], v[140:143], v[68:71]
  ds_read_b128 a[132:135], v213 offset:57344
  v_cvt_pk_bf16_f32 v72, v72, v73
  v_mfma_f32_16x16x32_bf16 v[76:79], a[156:159], v[156:159], v[196:199]
  v_exp_f32 v74, v74
  v_mfma_f32_16x16x32_bf16 v[76:79], a[152:155], v[152:155], v[76:79]
  ds_read_b128 a[136:139], v214 offset:57344
  v_mfma_f32_16x16x32_bf16 v[76:79], a[148:151], v[148:151], v[76:79]
  v_exp_f32 v75, v75
  v_mfma_f32_16x16x32_bf16 v[76:79], a[144:147], v[144:147], v[76:79]
  ds_read_b128 a[140:143], v215 offset:57344
  v_cvt_pk_bf16_f32 v73, v74, v75
  v_mfma_f32_16x16x32_bf16 v[84:87], a[144:147], v[160:163], v[200:203]
  v_exp_f32 v80, v80
  v_mfma_f32_16x16x32_bf16 v[84:87], a[148:151], v[164:167], v[84:87]
  buffer_load_dwordx4 v237, s[16:19], s29 offen offset:3072 lds
  v_mfma_f32_16x16x32_bf16 v[84:87], a[152:155], v[168:171], v[84:87]
  s_add_u32 s29, s29, 16384
  v_exp_f32 v81, v81
  v_mfma_f32_16x16x32_bf16 v[84:87], a[156:159], v[172:175], v[84:87]
  v_cvt_pk_bf16_f32 v80, v80, v81
  v_mfma_f32_16x16x32_bf16 v[92:95], a[156:159], v[188:191], v[204:207]
  s_add_u32 m0, s28, 16384
  v_exp_f32 v82, v82
  v_mfma_f32_16x16x32_bf16 v[92:95], a[152:155], v[184:187], v[92:95]
  buffer_load_dwordx4 v232, s[12:15], s29 offen offset:0 lds
  v_mfma_f32_16x16x32_bf16 v[92:95], a[148:151], v[180:183], v[92:95]
  s_waitcnt lgkmcnt(0)
  v_exp_f32 v83, v83
  v_mfma_f32_16x16x32_bf16 v[92:95], a[144:147], v[176:179], v[92:95]
  v_cvt_pk_bf16_f32 v81, v82, v83
  v_mfma_f32_16x16x32_bf16 v[96:99], a[128:131], v[128:131], v[192:195]
  v_exp_f32 v88, v88
  v_mfma_f32_16x16x32_bf16 v[96:99], a[132:135], v[132:135], v[96:99]
  ds_read_b128 a[144:147], v212 offset:61440
  v_mfma_f32_16x16x32_bf16 v[96:99], a[136:139], v[136:139], v[96:99]
  v_exp_f32 v89, v89
  v_mfma_f32_16x16x32_bf16 v[96:99], a[140:143], v[140:143], v[96:99]
  ds_read_b128 a[148:151], v213 offset:61440
  v_cvt_pk_bf16_f32 v88, v88, v89
  v_mfma_f32_16x16x32_bf16 v[104:107], a[140:143], v[156:159], v[196:199]
  v_exp_f32 v90, v90
  v_mfma_f32_16x16x32_bf16 v[104:107], a[136:139], v[152:155], v[104:107]
  ds_read_b128 a[152:155], v214 offset:61440
  v_mfma_f32_16x16x32_bf16 v[104:107], a[132:135], v[148:151], v[104:107]
  v_exp_f32 v91, v91
  v_mfma_f32_16x16x32_bf16 v[104:107], a[128:131], v[144:147], v[104:107]
  ds_read_b128 a[156:159], v215 offset:61440
  v_cvt_pk_bf16_f32 v89, v90, v91
  v_mfma_f32_16x16x32_bf16 v[112:115], a[128:131], v[160:163], v[200:203]
  v_exp_f32 v68, v68
  v_mfma_f32_16x16x32_bf16 v[112:115], a[132:135], v[164:167], v[112:115]
  buffer_load_dwordx4 v233, s[12:15], s29 offen offset:1024 lds
  v_mfma_f32_16x16x32_bf16 v[112:115], a[136:139], v[168:171], v[112:115]
  v_exp_f32 v69, v69
  v_mfma_f32_16x16x32_bf16 v[112:115], a[140:143], v[172:175], v[112:115]
  v_cvt_pk_bf16_f32 v66, v68, v69
  v_mfma_f32_16x16x32_bf16 v[120:123], a[140:143], v[188:191], v[204:207]
  v_exp_f32 v70, v70
  v_mfma_f32_16x16x32_bf16 v[120:123], a[136:139], v[184:187], v[120:123]
  buffer_load_dwordx4 v234, s[12:15], s29 offen offset:2048 lds
  v_mfma_f32_16x16x32_bf16 v[120:123], a[132:135], v[180:183], v[120:123]
  s_waitcnt lgkmcnt(0)
  v_exp_f32 v71, v71
  v_mfma_f32_16x16x32_bf16 v[120:123], a[128:131], v[176:179], v[120:123]
  v_cvt_pk_bf16_f32 v67, v70, v71
  v_mfma_f32_16x16x32_bf16 v[100:103], a[144:147], v[128:131], v[192:195]
  v_exp_f32 v76, v76
  v_mfma_f32_16x16x32_bf16 v[100:103], a[148:151], v[132:135], v[100:103]
  ds_read_b64_tr_b16 a[160:161], v216 offset:32768
  v_mfma_f32_16x16x32_bf16 v[100:103], a[152:155], v[136:139], v[100:103]
  v_exp_f32 v77, v77
  v_mfma_f32_16x16x32_bf16 v[100:103], a[156:159], v[140:143], v[100:103]
  ds_read_b64_tr_b16 a[162:163], v216 offset:36864
  v_cvt_pk_bf16_f32 v74, v76, v77
  v_mfma_f32_16x16x32_bf16 v[108:111], a[156:159], v[156:159], v[196:199]
  v_exp_f32 v78, v78
  v_mfma_f32_16x16x32_bf16 v[108:111], a[152:155], v[152:155], v[108:111]
  ds_read_b64_tr_b16 a[164:165], v216 offset:40960
  buffer_load_dwordx4 v235, s[12:15], s29 offen offset:3072 lds
  v_mfma_f32_16x16x32_bf16 v[108:111], a[148:151], v[148:151], v[108:111]
  v_exp_f32 v79, v79
  v_mfma_f32_16x16x32_bf16 v[108:111], a[144:147], v[144:147], v[108:111]
  ds_read_b64_tr_b16 a[166:167], v216 offset:45056
  v_cvt_pk_bf16_f32 v75, v78, v79
  v_mfma_f32_16x16x32_bf16 v[116:119], a[144:147], v[160:163], v[200:203]
  v_exp_f32 v84, v84
  v_mfma_f32_16x16x32_bf16 v[116:119], a[148:151], v[164:167], v[116:119]
  ds_read_b64_tr_b16 a[168:169], v217 offset:32768
  buffer_load_dword v254, off, s[24:27], s47 sc1
  v_mfma_f32_16x16x32_bf16 v[116:119], a[152:155], v[168:171], v[116:119]
  v_exp_f32 v85, v85
  v_mfma_f32_16x16x32_bf16 v[116:119], a[156:159], v[172:175], v[116:119]
  ds_read_b64_tr_b16 a[170:171], v217 offset:36864
  v_cvt_pk_bf16_f32 v82, v84, v85
  v_mfma_f32_16x16x32_bf16 v[124:127], a[156:159], v[188:191], v[204:207]
  s_waitcnt vmcnt(20)
  v_exp_f32 v86, v86
  v_mfma_f32_16x16x32_bf16 v[124:127], a[152:155], v[184:187], v[124:127]
  ds_read_b64_tr_b16 a[172:173], v217 offset:40960
  ds_read_b64_tr_b16 a[232:233], v209 offset:5120
  v_mfma_f32_16x16x32_bf16 v[124:127], a[148:151], v[180:183], v[124:127]
  v_exp_f32 v87, v87
  v_mfma_f32_16x16x32_bf16 v[124:127], a[144:147], v[176:179], v[124:127]
  ds_read_b64_tr_b16 a[174:175], v217 offset:45056
  v_cvt_pk_bf16_f32 v83, v86, v87
  v_mfma_f32_16x16x32_bf16 a[192:195], a[208:211], v[0:3], a[192:195]
  v_exp_f32 v92, v92
  v_mfma_f32_16x16x32_bf16 a[192:195], a[208:211], v[32:35], a[192:195]
  ds_read_b64_tr_b16 a[176:177], v218 offset:32768
  ds_read_b64_tr_b16 a[234:235], v209 offset:5632
  v_mfma_f32_16x16x32_bf16 a[196:199], a[208:211], v[8:11], a[196:199]
  v_exp_f32 v93, v93
  v_mfma_f32_16x16x32_bf16 a[196:199], a[208:211], v[40:43], a[196:199]
  ds_read_b64_tr_b16 a[178:179], v218 offset:36864
  v_cvt_pk_bf16_f32 v90, v92, v93
  v_mfma_f32_16x16x32_bf16 a[200:203], a[208:211], v[16:19], a[200:203]
  v_exp_f32 v94, v94
  v_mfma_f32_16x16x32_bf16 a[200:203], a[208:211], v[48:51], a[200:203]
  ds_read_b64_tr_b16 a[180:181], v218 offset:40960
  v_mfma_f32_16x16x32_bf16 a[204:207], a[208:211], v[24:27], a[204:207]
  s_waitcnt lgkmcnt(9)
  v_exp_f32 v95, v95
  v_mfma_f32_16x16x32_bf16 a[204:207], a[208:211], v[56:59], a[204:207]
  ds_read_b64_tr_b16 a[182:183], v218 offset:45056
  v_cvt_pk_bf16_f32 v91, v94, v95
  v_mfma_f32_16x16x32_bf16 a[0:3], a[160:163], v[0:3], a[0:3]
  v_exp_f32 v96, v96
  v_mfma_f32_16x16x32_bf16 a[0:3], a[164:167], v[32:35], a[0:3]
  ds_read_b64_tr_b16 a[184:185], v219 offset:32768
  s_waitcnt lgkmcnt(4)
  buffer_store_dwordx4 a[232:235], v211, s[24:27], s31 offen sc1
  s_add_u32 s31, s31, 1024
  v_mfma_f32_16x16x32_bf16 a[4:7], a[164:167], v[40:43], a[4:7]
  v_exp_f32 v97, v97
  v_mfma_f32_16x16x32_bf16 a[4:7], a[160:163], v[8:11], a[4:7]
  ds_read_b64_tr_b16 a[186:187], v219 offset:36864
  v_cvt_pk_bf16_f32 v96, v96, v97
  v_mfma_f32_16x16x32_bf16 a[8:11], a[160:163], v[16:19], a[8:11]
  v_exp_f32 v98, v98
  v_mfma_f32_16x16x32_bf16 a[8:11], a[164:167], v[48:51], a[8:11]
  ds_read_b64_tr_b16 a[188:189], v219 offset:40960
  v_mfma_f32_16x16x32_bf16 a[12:15], a[164:167], v[56:59], a[12:15]
  v_exp_f32 v99, v99
  v_mfma_f32_16x16x32_bf16 a[12:15], a[160:163], v[24:27], a[12:15]
  ds_read_b64_tr_b16 a[190:191], v219 offset:45056
  v_cvt_pk_bf16_f32 v97, v98, v99
  v_mfma_f32_16x16x32_bf16 a[16:19], a[168:171], v[0:3], a[16:19]
  v_exp_f32 v104, v104
  v_mfma_f32_16x16x32_bf16 a[16:19], a[172:175], v[32:35], a[16:19]
  ds_read_b64_tr_b16 a[160:161], v220 offset:32768
  v_mfma_f32_16x16x32_bf16 a[20:23], a[172:175], v[40:43], a[20:23]
  v_exp_f32 v105, v105
  v_mfma_f32_16x16x32_bf16 a[20:23], a[168:171], v[8:11], a[20:23]
  ds_read_b64_tr_b16 a[162:163], v220 offset:36864
  v_cvt_pk_bf16_f32 v104, v104, v105
  v_mfma_f32_16x16x32_bf16 a[24:27], a[168:171], v[16:19], a[24:27]
  v_exp_f32 v106, v106
  v_mfma_f32_16x16x32_bf16 a[24:27], a[172:175], v[48:51], a[24:27]
  ds_read_b64_tr_b16 a[164:165], v220 offset:40960
  v_mfma_f32_16x16x32_bf16 a[28:31], a[172:175], v[56:59], a[28:31]
  s_waitcnt lgkmcnt(7)
  v_exp_f32 v107, v107
  v_mfma_f32_16x16x32_bf16 a[28:31], a[168:171], v[24:27], a[28:31]
  ds_read_b64_tr_b16 a[166:167], v220 offset:45056
  v_cvt_pk_bf16_f32 v105, v106, v107
  v_mfma_f32_16x16x32_bf16 a[32:35], a[176:179], v[0:3], a[32:35]
  v_exp_f32 v112, v112
  v_mfma_f32_16x16x32_bf16 a[32:35], a[180:183], v[32:35], a[32:35]
  ds_read_b64_tr_b16 a[168:169], v221 offset:32768
  v_mfma_f32_16x16x32_bf16 a[36:39], a[180:183], v[40:43], a[36:39]
  v_exp_f32 v113, v113
  v_mfma_f32_16x16x32_bf16 a[36:39], a[176:179], v[8:11], a[36:39]
  ds_read_b64_tr_b16 a[170:171], v221 offset:36864
  v_cvt_pk_bf16_f32 v112, v112, v113
  v_mfma_f32_16x16x32_bf16 a[40:43], a[176:179], v[16:19], a[40:43]
  v_exp_f32 v114, v114
  v_mfma_f32_16x16x32_bf16 a[40:43], a[180:183], v[48:51], a[40:43]
  ds_read_b64_tr_b16 a[172:173], v221 offset:40960
  v_mfma_f32_16x16x32_bf16 a[44:47], a[180:183], v[56:59], a[44:47]
  s_waitcnt lgkmcnt(7)
  v_exp_f32 v115, v115
  v_mfma_f32_16x16x32_bf16 a[44:47], a[176:179], v[24:27], a[44:47]
  ds_read_b64_tr_b16 a[174:175], v221 offset:45056
  v_cvt_pk_bf16_f32 v113, v114, v115
  v_mfma_f32_16x16x32_bf16 a[48:51], a[184:187], v[0:3], a[48:51]
  v_exp_f32 v120, v120
  v_mfma_f32_16x16x32_bf16 a[48:51], a[188:191], v[32:35], a[48:51]
  ds_read_b64_tr_b16 a[176:177], v222 offset:32768
  v_mfma_f32_16x16x32_bf16 a[52:55], a[188:191], v[40:43], a[52:55]
  v_exp_f32 v121, v121
  v_mfma_f32_16x16x32_bf16 a[52:55], a[184:187], v[8:11], a[52:55]
  ds_read_b64_tr_b16 a[178:179], v222 offset:36864
  v_cvt_pk_bf16_f32 v120, v120, v121
  v_mfma_f32_16x16x32_bf16 a[56:59], a[184:187], v[16:19], a[56:59]
  v_exp_f32 v122, v122
  v_mfma_f32_16x16x32_bf16 a[56:59], a[188:191], v[48:51], a[56:59]
  ds_read_b64_tr_b16 a[180:181], v222 offset:40960
  v_mfma_f32_16x16x32_bf16 a[60:63], a[188:191], v[56:59], a[60:63]
  s_waitcnt lgkmcnt(7)
  v_exp_f32 v123, v123
  v_mfma_f32_16x16x32_bf16 a[60:63], a[184:187], v[24:27], a[60:63]
  ds_read_b64_tr_b16 a[182:183], v222 offset:45056
  v_cvt_pk_bf16_f32 v121, v122, v123
  v_mfma_f32_16x16x32_bf16 a[64:67], a[160:163], v[0:3], a[64:67]
  v_exp_f32 v100, v100
  v_mfma_f32_16x16x32_bf16 a[64:67], a[164:167], v[32:35], a[64:67]
  ds_read_b64_tr_b16 a[184:185], v223 offset:32768
  v_mfma_f32_16x16x32_bf16 a[68:71], a[164:167], v[40:43], a[68:71]
  v_exp_f32 v101, v101
  v_mfma_f32_16x16x32_bf16 a[68:71], a[160:163], v[8:11], a[68:71]
  ds_read_b64_tr_b16 a[186:187], v223 offset:36864
  v_cvt_pk_bf16_f32 v98, v100, v101
  v_mfma_f32_16x16x32_bf16 a[72:75], a[160:163], v[16:19], a[72:75]
  v_exp_f32 v102, v102
  v_mfma_f32_16x16x32_bf16 a[72:75], a[164:167], v[48:51], a[72:75]
  ds_read_b64_tr_b16 a[188:189], v223 offset:40960
  v_mfma_f32_16x16x32_bf16 a[76:79], a[164:167], v[56:59], a[76:79]
  s_waitcnt lgkmcnt(7)
  v_exp_f32 v103, v103
  v_mfma_f32_16x16x32_bf16 a[76:79], a[160:163], v[24:27], a[76:79]
  ds_read_b64_tr_b16 a[190:191], v223 offset:45056
  v_cvt_pk_bf16_f32 v99, v102, v103
  v_mfma_f32_16x16x32_bf16 a[80:83], a[168:171], v[0:3], a[80:83]
  s_waitcnt vmcnt(12)
  v_exp_f32 v108, v108
  v_mfma_f32_16x16x32_bf16 a[80:83], a[172:175], v[32:35], a[80:83]
  v_mfma_f32_16x16x32_bf16 a[84:87], a[172:175], v[40:43], a[84:87]
  s_barrier
  v_exp_f32 v109, v109
  v_mfma_f32_16x16x32_bf16 a[84:87], a[168:171], v[8:11], a[84:87]
  ds_read_b128 a[128:131], v212 offset:0
  v_cvt_pk_bf16_f32 v106, v108, v109
  v_mfma_f32_16x16x32_bf16 a[88:91], a[168:171], v[16:19], a[88:91]
  v_exp_f32 v110, v110
  v_mfma_f32_16x16x32_bf16 a[88:91], a[172:175], v[48:51], a[88:91]
  ds_read_b128 a[132:135], v213 offset:0
  v_mfma_f32_16x16x32_bf16 a[92:95], a[172:175], v[56:59], a[92:95]
  s_waitcnt lgkmcnt(6)
  v_exp_f32 v111, v111
  v_mfma_f32_16x16x32_bf16 a[92:95], a[168:171], v[24:27], a[92:95]
  ds_read_b128 a[136:139], v214 offset:0
  v_cvt_pk_bf16_f32 v107, v110, v111
  v_mfma_f32_16x16x32_bf16 a[96:99], a[176:179], v[0:3], a[96:99]
  v_exp_f32 v116, v116
  v_mfma_f32_16x16x32_bf16 a[96:99], a[180:183], v[32:35], a[96:99]
  ds_read_b128 a[140:143], v215 offset:0
  v_mfma_f32_16x16x32_bf16 a[100:103], a[180:183], v[40:43], a[100:103]
  v_exp_f32 v117, v117
  v_mfma_f32_16x16x32_bf16 a[100:103], a[176:179], v[8:11], a[100:103]
  v_cvt_pk_bf16_f32 v114, v116, v117
  v_mfma_f32_16x16x32_bf16 a[104:107], a[176:179], v[16:19], a[104:107]
  v_exp_f32 v118, v118
  v_mfma_f32_16x16x32_bf16 a[104:107], a[180:183], v[48:51], a[104:107]
  v_mfma_f32_16x16x32_bf16 a[108:111], a[180:183], v[56:59], a[108:111]
  s_waitcnt lgkmcnt(4)
  v_exp_f32 v119, v119
  v_mfma_f32_16x16x32_bf16 a[108:111], a[176:179], v[24:27], a[108:111]
  v_cvt_pk_bf16_f32 v115, v118, v119
  v_mfma_f32_16x16x32_bf16 a[112:115], a[184:187], v[0:3], a[112:115]
  v_exp_f32 v124, v124
  v_mfma_f32_16x16x32_bf16 a[112:115], a[188:191], v[32:35], a[112:115]
  v_mfma_f32_16x16x32_bf16 a[116:119], a[188:191], v[40:43], a[116:119]
  s_sub_u32 s32, s32, 1
  v_exp_f32 v125, v125
  v_mfma_f32_16x16x32_bf16 a[116:119], a[184:187], v[8:11], a[116:119]
  v_cvt_pk_bf16_f32 v122, v124, v125
  v_mfma_f32_16x16x32_bf16 a[120:123], a[184:187], v[16:19], a[120:123]
  s_cmp_lg_u32 s32, 0
  v_exp_f32 v126, v126
  v_mfma_f32_16x16x32_bf16 a[120:123], a[188:191], v[48:51], a[120:123]
  v_mfma_f32_16x16x32_bf16 a[124:127], a[188:191], v[56:59], a[124:127]
  s_waitcnt lgkmcnt(0)
  v_exp_f32 v127, v127
  v_mfma_f32_16x16x32_bf16 a[124:127], a[184:187], v[24:27], a[124:127]
  v_cvt_pk_bf16_f32 v123, v126, v127
  s_cbranch_scc1 attn_loop
  s_waitcnt vmcnt(1)
  v_readfirstlane_b32 s38, v254
  s_nop 0
  s_cmp_ge_u32 s38, 512
  s_cbranch_scc1 attn_h_ready
  s_mov_b32 s39, 32768
attn_spin:
  s_sleep 4
  buffer_load_dword v254, off, s[24:27], s47 sc1
  s_waitcnt vmcnt(0)
  v_readfirstlane_b32 s38, v254
  s_nop 0
  s_cmp_ge_u32 s38, 512
  s_cbranch_scc1 attn_h_ready
  s_sub_u32 s39, s39, 1
  s_cmp_lg_u32 s39, 0
  s_cbranch_scc1 attn_spin
attn_h_ready:
  v_mfma_f32_16x16x32_bf16 v[0:3], a[128:131], v[128:131], v[192:195]
  s_add_u32 m0, s28, 81920
  s_and_b32 s38, s2, 1
  s_lshl_b32 s38, s38, 2
  v_lshrrev_b32 v224, 4, v242
  v_and_b32 v225, 7, v224
  v_mfma_f32_16x16x32_bf16 v[0:3], a[132:135], v[132:135], v[0:3]
  ds_read_b128 a[144:147], v212 offset:4096
  s_add_u32 s38, s38, s3
  s_mul_i32 s38, s38, 81920
  s_lshr_b32 s39, s2, 5
  v_mul_u32_u24 v225, 0xd80, v225
  v_mfma_f32_16x16x32_bf16 v[0:3], a[136:139], v[136:139], v[0:3]
  buffer_load_dwordx4 v236, s[16:19], s29 offen offset:0 lds
  s_mul_i32 s39, s39, 655360
  s_add_u32 s38, s38, s39
  s_add_u32 s4, s38, 3145728
  v_mfma_f32_16x16x32_bf16 v[0:3], a[140:143], v[140:143], v[0:3]
  ds_read_b128 a[148:151], v213 offset:4096
  s_add_u32 s5, s4, 12288
  s_add_u32 s6, s4, 24576
  s_add_u32 s7, s4, 36864
  v_lshrrev_b32 v224, 4, v224
  v_mfma_f32_16x16x32_bf16 v[8:11], a[140:143], v[156:159], v[196:199]
  s_add_u32 s8, s4, 49152
  s_add_u32 s9, s4, 61440
  s_add_u32 s10, s4, 73728
  v_lshl_add_u32 v225, v224, 4, v225
  v_add_u32 v252, 4096, v242
  v_mfma_f32_16x16x32_bf16 v[8:11], a[136:139], v[152:155], v[8:11]
  ds_read_b128 a[152:155], v214 offset:4096
  buffer_load_dwordx4 a[212:215], v225, s[24:27], s101 offen offset:0 sc1
  v_mfma_f32_16x16x32_bf16 v[8:11], a[132:135], v[148:151], v[8:11]
  buffer_load_dwordx4 v237, s[16:19], s29 offen offset:1024 lds
  v_mfma_f32_16x16x32_bf16 v[8:11], a[128:131], v[144:147], v[8:11]
  ds_read_b128 a[156:159], v215 offset:4096
  buffer_load_dwordx4 a[216:219], v225, s[24:27], s101 offen offset:64 sc1
  v_mfma_f32_16x16x32_bf16 v[16:19], a[128:131], v[160:163], v[200:203]
  v_exp_f32 v0, v0
  v_mfma_f32_16x16x32_bf16 v[16:19], a[132:135], v[164:167], v[16:19]
  buffer_load_dwordx4 a[220:223], v225, s[24:27], s101 offen offset:128 sc1
  v_mfma_f32_16x16x32_bf16 v[16:19], a[136:139], v[168:171], v[16:19]
  v_exp_f32 v1, v1
  v_mfma_f32_16x16x32_bf16 v[16:19], a[140:143], v[172:175], v[16:19]
  v_cvt_pk_bf16_f32 v0, v0, v1
  v_add_u32 v253, 8192, v242
  v_mfma_f32_16x16x32_bf16 v[24:27], a[140:143], v[188:191], v[204:207]
  v_exp_f32 v2, v2
  v_mfma_f32_16x16x32_bf16 v[24:27], a[136:139], v[184:187], v[24:27]
  buffer_load_dwordx4 v236, s[16:19], s29 offen offset:2048 lds
  v_mfma_f32_16x16x32_bf16 v[24:27], a[132:135], v[180:183], v[24:27]
  s_waitcnt lgkmcnt(0)
  v_exp_f32 v3, v3
  v_mfma_f32_16x16x32_bf16 v[24:27], a[128:131], v[176:179], v[24:27]
  v_cvt_pk_bf16_f32 v1, v2, v3
  v_mfma_f32_16x16x32_bf16 v[4:7], a[144:147], v[128:131], v[192:195]
  v_exp_f32 v8, v8
  v_mfma_f32_16x16x32_bf16 v[4:7], a[148:151], v[132:135], v[4:7]
  ds_read_b128 a[128:131], v212 offset:8192
  v_mfma_f32_16x16x32_bf16 v[4:7], a[152:155], v[136:139], v[4:7]
  v_exp_f32 v9, v9
  v_mfma_f32_16x16x32_bf16 v[4:7], a[156:159], v[140:143], v[4:7]
  ds_read_b128 a[132:135], v213 offset:8192
  v_cvt_pk_bf16_f32 v8, v8, v9
  v_mfma_f32_16x16x32_bf16 v[12:15], a[156:159], v[156:159], v[196:199]
  v_exp_f32 v10, v10
  v_mfma_f32_16x16x32_bf16 v[12:15], a[152:155], v[152:155], v[12:15]
  ds_read_b128 a[136:139], v214 offset:8192
  v_mfma_f32_16x16x32_bf16 v[12:15], a[148:151], v[148:151], v[12:15]
  v_exp_f32 v11, v11
  v_mfma_f32_16x16x32_bf16 v[12:15], a[144:147], v[144:147], v[12:15]
  ds_read_b128 a[140:143], v215 offset:8192
  v_cvt_pk_bf16_f32 v9, v10, v11
  v_mfma_f32_16x16x32_bf16 v[20:23], a[144:147], v[160:163], v[200:203]
  v_exp_f32 v16, v16
  v_mfma_f32_16x16x32_bf16 v[20:23], a[148:151], v[164:167], v[20:23]
  buffer_load_dwordx4 v237, s[16:19], s29 offen offset:3072 lds
  v_mfma_f32_16x16x32_bf16 v[20:23], a[152:155], v[168:171], v[20:23]
  s_add_u32 s29, s29, 16384
  v_exp_f32 v17, v17
  v_mfma_f32_16x16x32_bf16 v[20:23], a[156:159], v[172:175], v[20:23]
  v_cvt_pk_bf16_f32 v16, v16, v17
  v_mfma_f32_16x16x32_bf16 v[28:31], a[156:159], v[188:191], v[204:207]
  s_add_u32 m0, s28, 32768
  v_exp_f32 v18, v18
  v_mfma_f32_16x16x32_bf16 v[28:31], a[152:155], v[184:187], v[28:31]
  buffer_load_dwordx4 v232, s[12:15], s29 offen offset:0 lds
  v_mfma_f32_16x16x32_bf16 v[28:31], a[148:151], v[180:183], v[28:31]
  s_waitcnt lgkmcnt(0)
  v_exp_f32 v19, v19
  v_mfma_f32_16x16x32_bf16 v[28:31], a[144:147], v[176:179], v[28:31]
  v_cvt_pk_bf16_f32 v17, v18, v19
  v_mfma_f32_16x16x32_bf16 v[32:35], a[128:131], v[128:131], v[192:195]
  v_exp_f32 v24, v24
  v_mfma_f32_16x16x32_bf16 v[32:35], a[132:135], v[132:135], v[32:35]
  ds_read_b128 a[144:147], v212 offset:12288
  v_mfma_f32_16x16x32_bf16 v[32:35], a[136:139], v[136:139], v[32:35]
  v_exp_f32 v25, v25
  v_mfma_f32_16x16x32_bf16 v[32:35], a[140:143], v[140:143], v[32:35]
  ds_read_b128 a[148:151], v213 offset:12288
  v_cvt_pk_bf16_f32 v24, v24, v25
  v_mfma_f32_16x16x32_bf16 v[40:43], a[140:143], v[156:159], v[196:199]
  v_exp_f32 v26, v26
  v_mfma_f32_16x16x32_bf16 v[40:43], a[136:139], v[152:155], v[40:43]
  ds_read_b128 a[152:155], v214 offset:12288
  v_mfma_f32_16x16x32_bf16 v[40:43], a[132:135], v[148:151], v[40:43]
  v_exp_f32 v27, v27
  v_mfma_f32_16x16x32_bf16 v[40:43], a[128:131], v[144:147], v[40:43]
  ds_read_b128 a[156:159], v215 offset:12288
  v_cvt_pk_bf16_f32 v25, v26, v27
  v_mfma_f32_16x16x32_bf16 v[48:51], a[128:131], v[160:163], v[200:203]
  v_exp_f32 v4, v4
  v_mfma_f32_16x16x32_bf16 v[48:51], a[132:135], v[164:167], v[48:51]
  buffer_load_dwordx4 v233, s[12:15], s29 offen offset:1024 lds
  v_mfma_f32_16x16x32_bf16 v[48:51], a[136:139], v[168:171], v[48:51]
  v_exp_f32 v5, v5
  v_mfma_f32_16x16x32_bf16 v[48:51], a[140:143], v[172:175], v[48:51]
  v_cvt_pk_bf16_f32 v2, v4, v5
  v_mfma_f32_16x16x32_bf16 v[56:59], a[140:143], v[188:191], v[204:207]
  v_exp_f32 v6, v6
  v_mfma_f32_16x16x32_bf16 v[56:59], a[136:139], v[184:187], v[56:59]
  buffer_load_dwordx4 v234, s[12:15], s29 offen offset:2048 lds
  v_mfma_f32_16x16x32_bf16 v[56:59], a[132:135], v[180:183], v[56:59]
  s_waitcnt lgkmcnt(0)
  v_exp_f32 v7, v7
  v_mfma_f32_16x16x32_bf16 v[56:59], a[128:131], v[176:179], v[56:59]
  v_cvt_pk_bf16_f32 v3, v6, v7
  v_mfma_f32_16x16x32_bf16 v[36:39], a[144:147], v[128:131], v[192:195]
  v_exp_f32 v12, v12
  v_mfma_f32_16x16x32_bf16 v[36:39], a[148:151], v[132:135], v[36:39]
  ds_read_b64_tr_b16 a[160:161], v216 offset:49152
  v_mfma_f32_16x16x32_bf16 v[36:39], a[152:155], v[136:139], v[36:39]
  v_exp_f32 v13, v13
  v_mfma_f32_16x16x32_bf16 v[36:39], a[156:159], v[140:143], v[36:39]
  ds_read_b64_tr_b16 a[162:163], v216 offset:53248
  v_cvt_pk_bf16_f32 v10, v12, v13
  v_mfma_f32_16x16x32_bf16 v[44:47], a[156:159], v[156:159], v[196:199]
  v_exp_f32 v14, v14
  v_mfma_f32_16x16x32_bf16 v[44:47], a[152:155], v[152:155], v[44:47]
  ds_read_b64_tr_b16 a[164:165], v216 offset:57344
  buffer_load_dwordx4 v235, s[12:15], s29 offen offset:3072 lds
  v_mfma_f32_16x16x32_bf16 v[44:47], a[148:151], v[148:151], v[44:47]
  v_exp_f32 v15, v15
  v_mfma_f32_16x16x32_bf16 v[44:47], a[144:147], v[144:147], v[44:47]
  ds_read_b64_tr_b16 a[166:167], v216 offset:61440
  v_cvt_pk_bf16_f32 v11, v14, v15
  v_mfma_f32_16x16x32_bf16 v[52:55], a[144:147], v[160:163], v[200:203]
  v_exp_f32 v20, v20
  v_mfma_f32_16x16x32_bf16 v[52:55], a[148:151], v[164:167], v[52:55]
  ds_read_b64_tr_b16 a[168:169], v217 offset:49152
  v_mfma_f32_16x16x32_bf16 v[52:55], a[152:155], v[168:171], v[52:55]
  v_exp_f32 v21, v21
  v_mfma_f32_16x16x32_bf16 v[52:55], a[156:159], v[172:175], v[52:55]
  ds_read_b64_tr_b16 a[170:171], v217 offset:53248
  v_cvt_pk_bf16_f32 v18, v20, v21
  v_mfma_f32_16x16x32_bf16 v[60:63], a[156:159], v[188:191], v[204:207]
  v_exp_f32 v22, v22
  v_mfma_f32_16x16x32_bf16 v[60:63], a[152:155], v[184:187], v[60:63]
  ds_read_b64_tr_b16 a[172:173], v217 offset:57344
  v_mfma_f32_16x16x32_bf16 v[60:63], a[148:151], v[180:183], v[60:63]
  v_exp_f32 v23, v23
  v_mfma_f32_16x16x32_bf16 v[60:63], a[144:147], v[176:179], v[60:63]
  ds_read_b64_tr_b16 a[174:175], v217 offset:61440
  v_cvt_pk_bf16_f32 v19, v22, v23
  v_mfma_f32_16x16x32_bf16 a[192:195], a[208:211], v[64:67], a[192:195]
  v_exp_f32 v28, v28
  v_mfma_f32_16x16x32_bf16 a[192:195], a[208:211], v[96:99], a[192:195]
  ds_read_b64_tr_b16 a[176:177], v218 offset:49152
  v_mfma_f32_16x16x32_bf16 a[196:199], a[208:211], v[72:75], a[196:199]
  v_exp_f32 v29, v29
  v_mfma_f32_16x16x32_bf16 a[196:199], a[208:211], v[104:107], a[196:199]
  ds_read_b64_tr_b16 a[178:179], v218 offset:53248
  v_cvt_pk_bf16_f32 v26, v28, v29
  v_mfma_f32_16x16x32_bf16 a[200:203], a[208:211], v[80:83], a[200:203]
  v_exp_f32 v30, v30
  v_mfma_f32_16x16x32_bf16 a[200:203], a[208:211], v[112:115], a[200:203]
  ds_read_b64_tr_b16 a[180:181], v218 offset:57344
  v_mfma_f32_16x16x32_bf16 a[204:207], a[208:211], v[88:91], a[204:207]
  s_waitcnt lgkmcnt(7)
  v_exp_f32 v31, v31
  v_mfma_f32_16x16x32_bf16 a[204:207], a[208:211], v[120:123], a[204:207]
  ds_read_b64_tr_b16 a[182:183], v218 offset:61440
  v_cvt_pk_bf16_f32 v27, v30, v31
  v_mfma_f32_16x16x32_bf16 a[0:3], a[160:163], v[64:67], a[0:3]
  v_exp_f32 v32, v32
  v_mfma_f32_16x16x32_bf16 a[0:3], a[164:167], v[96:99], a[0:3]
  ds_read_b64_tr_b16 a[184:185], v219 offset:49152
  v_mfma_f32_16x16x32_bf16 a[4:7], a[164:167], v[104:107], a[4:7]
  v_exp_f32 v33, v33
  v_mfma_f32_16x16x32_bf16 a[4:7], a[160:163], v[72:75], a[4:7]
  ds_read_b64_tr_b16 a[186:187], v219 offset:53248
  v_cvt_pk_bf16_f32 v32, v32, v33
  v_mfma_f32_16x16x32_bf16 a[8:11], a[160:163], v[80:83], a[8:11]
  v_exp_f32 v34, v34
  v_mfma_f32_16x16x32_bf16 a[8:11], a[164:167], v[112:115], a[8:11]
  ds_read_b64_tr_b16 a[188:189], v219 offset:57344
  v_mfma_f32_16x16x32_bf16 a[12:15], a[164:167], v[120:123], a[12:15]
  s_waitcnt lgkmcnt(7)
  v_exp_f32 v35, v35
  v_mfma_f32_16x16x32_bf16 a[12:15], a[160:163], v[88:91], a[12:15]
  ds_read_b64_tr_b16 a[190:191], v219 offset:61440
  v_cvt_pk_bf16_f32 v33, v34, v35
  v_mfma_f32_16x16x32_bf16 a[16:19], a[168:171], v[64:67], a[16:19]
  v_exp_f32 v40, v40
  v_mfma_f32_16x16x32_bf16 a[16:19], a[172:175], v[96:99], a[16:19]
  ds_read_b64_tr_b16 a[160:161], v220 offset:49152
  v_mfma_f32_16x16x32_bf16 a[20:23], a[172:175], v[104:107], a[20:23]
  v_exp_f32 v41, v41
  v_mfma_f32_16x16x32_bf16 a[20:23], a[168:171], v[72:75], a[20:23]
  ds_read_b64_tr_b16 a[162:163], v220 offset:53248
  v_cvt_pk_bf16_f32 v40, v40, v41
  v_mfma_f32_16x16x32_bf16 a[24:27], a[168:171], v[80:83], a[24:27]
  v_exp_f32 v42, v42
  v_mfma_f32_16x16x32_bf16 a[24:27], a[172:175], v[112:115], a[24:27]
  ds_read_b64_tr_b16 a[164:165], v220 offset:57344
  v_mfma_f32_16x16x32_bf16 a[28:31], a[172:175], v[120:123], a[28:31]
  s_waitcnt lgkmcnt(7)
  v_exp_f32 v43, v43
  v_mfma_f32_16x16x32_bf16 a[28:31], a[168:171], v[88:91], a[28:31]
  ds_read_b64_tr_b16 a[166:167], v220 offset:61440
  v_cvt_pk_bf16_f32 v41, v42, v43
  v_mfma_f32_16x16x32_bf16 a[32:35], a[176:179], v[64:67], a[32:35]
  v_exp_f32 v48, v48
  v_mfma_f32_16x16x32_bf16 a[32:35], a[180:183], v[96:99], a[32:35]
  ds_read_b64_tr_b16 a[168:169], v221 offset:49152
  v_mfma_f32_16x16x32_bf16 a[36:39], a[180:183], v[104:107], a[36:39]
  v_exp_f32 v49, v49
  v_mfma_f32_16x16x32_bf16 a[36:39], a[176:179], v[72:75], a[36:39]
  ds_read_b64_tr_b16 a[170:171], v221 offset:53248
  v_cvt_pk_bf16_f32 v48, v48, v49
  v_mfma_f32_16x16x32_bf16 a[40:43], a[176:179], v[80:83], a[40:43]
  v_exp_f32 v50, v50
  v_mfma_f32_16x16x32_bf16 a[40:43], a[180:183], v[112:115], a[40:43]
  ds_read_b64_tr_b16 a[172:173], v221 offset:57344
  v_mfma_f32_16x16x32_bf16 a[44:47], a[180:183], v[120:123], a[44:47]
  s_waitcnt lgkmcnt(7)
  v_exp_f32 v51, v51
  v_mfma_f32_16x16x32_bf16 a[44:47], a[176:179], v[88:91], a[44:47]
  ds_read_b64_tr_b16 a[174:175], v221 offset:61440
  v_cvt_pk_bf16_f32 v49, v50, v51
  v_mfma_f32_16x16x32_bf16 a[48:51], a[184:187], v[64:67], a[48:51]
  v_exp_f32 v56, v56
  v_mfma_f32_16x16x32_bf16 a[48:51], a[188:191], v[96:99], a[48:51]
  ds_read_b64_tr_b16 a[176:177], v222 offset:49152
  v_mfma_f32_16x16x32_bf16 a[52:55], a[188:191], v[104:107], a[52:55]
  v_exp_f32 v57, v57
  v_mfma_f32_16x16x32_bf16 a[52:55], a[184:187], v[72:75], a[52:55]
  ds_read_b64_tr_b16 a[178:179], v222 offset:53248
  v_cvt_pk_bf16_f32 v56, v56, v57
  v_mfma_f32_16x16x32_bf16 a[56:59], a[184:187], v[80:83], a[56:59]
  v_exp_f32 v58, v58
  v_mfma_f32_16x16x32_bf16 a[56:59], a[188:191], v[112:115], a[56:59]
  ds_read_b64_tr_b16 a[180:181], v222 offset:57344
  v_mfma_f32_16x16x32_bf16 a[60:63], a[188:191], v[120:123], a[60:63]
  s_waitcnt lgkmcnt(7)
  v_exp_f32 v59, v59
  v_mfma_f32_16x16x32_bf16 a[60:63], a[184:187], v[88:91], a[60:63]
  ds_read_b64_tr_b16 a[182:183], v222 offset:61440
  v_cvt_pk_bf16_f32 v57, v58, v59
  v_mfma_f32_16x16x32_bf16 a[64:67], a[160:163], v[64:67], a[64:67]
  v_exp_f32 v36, v36
  v_mfma_f32_16x16x32_bf16 a[64:67], a[164:167], v[96:99], a[64:67]
  ds_read_b64_tr_b16 a[184:185], v223 offset:49152
  v_mfma_f32_16x16x32_bf16 a[68:71], a[164:167], v[104:107], a[68:71]
  v_exp_f32 v37, v37
  v_mfma_f32_16x16x32_bf16 a[68:71], a[160:163], v[72:75], a[68:71]
  ds_read_b64_tr_b16 a[186:187], v223 offset:53248
  v_cvt_pk_bf16_f32 v34, v36, v37
  v_mfma_f32_16x16x32_bf16 a[72:75], a[160:163], v[80:83], a[72:75]
  v_exp_f32 v38, v38
  v_mfma_f32_16x16x32_bf16 a[72:75], a[164:167], v[112:115], a[72:75]
  ds_read_b64_tr_b16 a[188:189], v223 offset:57344
  v_mfma_f32_16x16x32_bf16 a[76:79], a[164:167], v[120:123], a[76:79]
  s_waitcnt lgkmcnt(7)
  v_exp_f32 v39, v39
  v_mfma_f32_16x16x32_bf16 a[76:79], a[160:163], v[88:91], a[76:79]
  ds_read_b64_tr_b16 a[190:191], v223 offset:61440
  v_cvt_pk_bf16_f32 v35, v38, v39
  v_mfma_f32_16x16x32_bf16 a[80:83], a[168:171], v[64:67], a[80:83]
  v_exp_f32 v44, v44
  v_mfma_f32_16x16x32_bf16 a[80:83], a[172:175], v[96:99], a[80:83]
  v_mfma_f32_16x16x32_bf16 a[84:87], a[172:175], v[104:107], a[84:87]
  s_barrier
  v_exp_f32 v45, v45
  v_mfma_f32_16x16x32_bf16 a[84:87], a[168:171], v[72:75], a[84:87]
  ds_read_b128 a[128:131], v212 offset:16384
  v_cvt_pk_bf16_f32 v42, v44, v45
  v_mfma_f32_16x16x32_bf16 a[88:91], a[168:171], v[80:83], a[88:91]
  v_exp_f32 v46, v46
  v_mfma_f32_16x16x32_bf16 a[88:91], a[172:175], v[112:115], a[88:91]
  ds_read_b128 a[132:135], v213 offset:16384
  v_mfma_f32_16x16x32_bf16 a[92:95], a[172:175], v[120:123], a[92:95]
  s_waitcnt lgkmcnt(6)
  v_exp_f32 v47, v47
  v_mfma_f32_16x16x32_bf16 a[92:95], a[168:171], v[88:91], a[92:95]
  ds_read_b128 a[136:139], v214 offset:16384
  v_cvt_pk_bf16_f32 v43, v46, v47
  v_mfma_f32_16x16x32_bf16 a[96:99], a[176:179], v[64:67], a[96:99]
  v_exp_f32 v52, v52
  v_mfma_f32_16x16x32_bf16 a[96:99], a[180:183], v[96:99], a[96:99]
  ds_read_b128 a[140:143], v215 offset:16384
  v_mfma_f32_16x16x32_bf16 a[100:103], a[180:183], v[104:107], a[100:103]
  v_exp_f32 v53, v53
  v_mfma_f32_16x16x32_bf16 a[100:103], a[176:179], v[72:75], a[100:103]
  v_cvt_pk_bf16_f32 v50, v52, v53
  v_mfma_f32_16x16x32_bf16 a[104:107], a[176:179], v[80:83], a[104:107]
  v_exp_f32 v54, v54
  v_mfma_f32_16x16x32_bf16 a[104:107], a[180:183], v[112:115], a[104:107]
  v_mfma_f32_16x16x32_bf16 a[108:111], a[180:183], v[120:123], a[108:111]
  s_waitcnt lgkmcnt(4)
  v_exp_f32 v55, v55
  v_mfma_f32_16x16x32_bf16 a[108:111], a[176:179], v[88:91], a[108:111]
  v_cvt_pk_bf16_f32 v51, v54, v55
  v_mfma_f32_16x16x32_bf16 a[112:115], a[184:187], v[64:67], a[112:115]
  v_exp_f32 v60, v60
  v_mfma_f32_16x16x32_bf16 a[112:115], a[188:191], v[96:99], a[112:115]
  v_mfma_f32_16x16x32_bf16 a[116:119], a[188:191], v[104:107], a[116:119]
  v_exp_f32 v61, v61
  v_mfma_f32_16x16x32_bf16 a[116:119], a[184:187], v[72:75], a[116:119]
  v_cvt_pk_bf16_f32 v58, v60, v61
  v_mfma_f32_16x16x32_bf16 a[120:123], a[184:187], v[80:83], a[120:123]
  v_exp_f32 v62, v62
  v_mfma_f32_16x16x32_bf16 a[120:123], a[188:191], v[112:115], a[120:123]
  v_mfma_f32_16x16x32_bf16 a[124:127], a[188:191], v[120:123], a[124:127]
  s_waitcnt lgkmcnt(0)
  v_exp_f32 v63, v63
  v_mfma_f32_16x16x32_bf16 a[124:127], a[184:187], v[88:91], a[124:127]
  v_cvt_pk_bf16_f32 v59, v62, v63
  v_mfma_f32_16x16x32_bf16 v[64:67], a[128:131], v[128:131], v[192:195]
  s_add_u32 m0, s28, 98304
  v_mfma_f32_16x16x32_bf16 v[64:67], a[132:135], v[132:135], v[64:67]
  ds_read_b128 a[144:147], v212 offset:20480
  v_mfma_f32_16x16x32_bf16 v[64:67], a[136:139], v[136:139], v[64:67]
  buffer_load_dwordx4 v236, s[16:19], s29 offen offset:0 lds
  v_mfma_f32_16x16x32_bf16 v[64:67], a[140:143], v[140:143], v[64:67]
  ds_read_b128 a[148:151], v213 offset:20480
  v_mfma_f32_16x16x32_bf16 v[72:75], a[140:143], v[156:159], v[196:199]
  v_mfma_f32_16x16x32_bf16 v[72:75], a[136:139], v[152:155], v[72:75]
  ds_read_b128 a[152:155], v214 offset:20480
  v_mfma_f32_16x16x32_bf16 v[72:75], a[132:135], v[148:151], v[72:75]
  buffer_load_dwordx4 v237, s[16:19], s29 offen offset:1024 lds
  v_mfma_f32_16x16x32_bf16 v[72:75], a[128:131], v[144:147], v[72:75]
  ds_read_b128 a[156:159], v215 offset:20480
  v_mfma_f32_16x16x32_bf16 v[80:83], a[128:131], v[160:163], v[200:203]
  v_exp_f32 v64, v64
  v_mfma_f32_16x16x32_bf16 v[80:83], a[132:135], v[164:167], v[80:83]
  v_mfma_f32_16x16x32_bf16 v[80:83], a[136:139], v[168:171], v[80:83]
  v_exp_f32 v65, v65
  v_mfma_f32_16x16x32_bf16 v[80:83], a[140:143], v[172:175], v[80:83]
  v_cvt_pk_bf16_f32 v64, v64, v65
  v_mfma_f32_16x16x32_bf16 v[88:91], a[140:143], v[188:191], v[204:207]
  v_exp_f32 v66, v66
  v_mfma_f32_16x16x32_bf16 v[88:91], a[136:139], v[184:187], v[88:91]
  buffer_load_dwordx4 v236, s[16:19], s29 offen offset:2048 lds
  v_mfma_f32_16x16x32_bf16 v[88:91], a[132:135], v[180:183], v[88:91]
  s_waitcnt lgkmcnt(0)
  v_exp_f32 v67, v67
  v_mfma_f32_16x16x32_bf16 v[88:91], a[128:131], v[176:179], v[88:91]
  v_cvt_pk_bf16_f32 v65, v66, v67
  v_mfma_f32_16x16x32_bf16 v[68:71], a[144:147], v[128:131], v[192:195]
  v_exp_f32 v72, v72
  v_mfma_f32_16x16x32_bf16 v[68:71], a[148:151], v[132:135], v[68:71]
  ds_read_b128 a[128:131], v212 offset:24576
  v_mfma_f32_16x16x32_bf16 v[68:71], a[152:155], v[136:139], v[68:71]
  v_exp_f32 v73, v73
  v_mfma_f32_16x16x32_bf16 v[68:71], a[156:159], v[140:143], v[68:71]
  ds_read_b128 a[132:135], v213 offset:24576
  v_cvt_pk_bf16_f32 v72, v72, v73
  v_mfma_f32_16x16x32_bf16 v[76:79], a[156:159], v[156:159], v[196:199]
  v_exp_f32 v74, v74
  v_mfma_f32_16x16x32_bf16 v[76:79], a[152:155], v[152:155], v[76:79]
  ds_read_b128 a[136:139], v214 offset:24576
  v_lshrrev_b32 v224, 4, v242
  v_mfma_f32_16x16x32_bf16 v[76:79], a[148:151], v[148:151], v[76:79]
  v_exp_f32 v75, v75
  v_mfma_f32_16x16x32_bf16 v[76:79], a[144:147], v[144:147], v[76:79]
  ds_read_b128 a[140:143], v215 offset:24576
  v_cvt_pk_bf16_f32 v73, v74, v75
  v_mfma_f32_16x16x32_bf16 v[84:87], a[144:147], v[160:163], v[200:203]
  v_exp_f32 v80, v80
  v_mfma_f32_16x16x32_bf16 v[84:87], a[148:151], v[164:167], v[84:87]
  buffer_load_dwordx4 v237, s[16:19], s29 offen offset:3072 lds
  v_mfma_f32_16x16x32_bf16 v[84:87], a[152:155], v[168:171], v[84:87]
  s_add_u32 s29, s29, 16384
  v_exp_f32 v81, v81
  v_mfma_f32_16x16x32_bf16 v[84:87], a[156:159], v[172:175], v[84:87]
  v_cvt_pk_bf16_f32 v80, v80, v81
  v_lshrrev_b32 v225, 4, v224
  v_mfma_f32_16x16x32_bf16 v[92:95], a[156:159], v[188:191], v[204:207]
  s_add_u32 m0, s28, 49152
  v_exp_f32 v82, v82
  v_mfma_f32_16x16x32_bf16 v[92:95], a[152:155], v[184:187], v[92:95]
  buffer_load_dwordx4 v232, s[12:15], s29 offen offset:0 lds
  v_mfma_f32_16x16x32_bf16 v[92:95], a[148:151], v[180:183], v[92:95]
  s_waitcnt lgkmcnt(0)
  v_exp_f32 v83, v83
  v_mfma_f32_16x16x32_bf16 v[92:95], a[144:147], v[176:179], v[92:95]
  v_cvt_pk_bf16_f32 v81, v82, v83
  v_bfe_u32 v226, v224, 2, 2
  v_mfma_f32_16x16x32_bf16 v[96:99], a[128:131], v[128:131], v[192:195]
  v_exp_f32 v88, v88
  v_mfma_f32_16x16x32_bf16 v[96:99], a[132:135], v[132:135], v[96:99]
  ds_read_b128 a[144:147], v212 offset:28672
  v_lshl_add_u32 v225, v225, 3, v226
  v_mfma_f32_16x16x32_bf16 v[96:99], a[136:139], v[136:139], v[96:99]
  v_exp_f32 v89, v89
  v_mfma_f32_16x16x32_bf16 v[96:99], a[140:143], v[140:143], v[96:99]
  ds_read_b128 a[148:151], v213 offset:28672
  v_cvt_pk_bf16_f32 v88, v88, v89
  v_mfma_f32_16x16x32_bf16 v[104:107], a[140:143], v[156:159], v[196:199]
  v_exp_f32 v90, v90
  v_mfma_f32_16x16x32_bf16 v[104:107], a[136:139], v[152:155], v[104:107]
  ds_read_b128 a[152:155], v214 offset:28672
  v_lshlrev_b32 v225, 5, v225
  v_mfma_f32_16x16x32_bf16 v[104:107], a[132:135], v[148:151], v[104:107]
  v_exp_f32 v91, v91
  v_mfma_f32_16x16x32_bf16 v[104:107], a[128:131], v[144:147], v[104:107]
  ds_read_b128 a[156:159], v215 offset:28672
  v_cvt_pk_bf16_f32 v89, v90, v91
  v_mfma_f32_16x16x32_bf16 v[112:115], a[128:131], v[160:163], v[200:203]
  v_exp_f32 v68, v68
  v_mfma_f32_16x16x32_bf16 v[112:115], a[132:135], v[164:167], v[112:115]
  buffer_load_dwordx4 v233, s[12:15], s29 offen offset:1024 lds
  v_mfma_f32_16x16x32_bf16 v[112:115], a[136:139], v[168:171], v[112:115]
  v_exp_f32 v69, v69
  v_mfma_f32_16x16x32_bf16 v[112:115], a[140:143], v[172:175], v[112:115]
  v_cvt_pk_bf16_f32 v66, v68, v69
  v_and_b32 v226, 3, v224
  v_mfma_f32_16x16x32_bf16 v[120:123], a[140:143], v[188:191], v[204:207]
  v_exp_f32 v70, v70
  v_mfma_f32_16x16x32_bf16 v[120:123], a[136:139], v[184:187], v[120:123]
  buffer_load_dwordx4 v234, s[12:15], s29 offen offset:2048 lds
  v_mfma_f32_16x16x32_bf16 v[120:123], a[132:135], v[180:183], v[120:123]
  s_waitcnt lgkmcnt(0)
  v_exp_f32 v71, v71
  v_mfma_f32_16x16x32_bf16 v[120:123], a[128:131], v[176:179], v[120:123]
  v_cvt_pk_bf16_f32 v67, v70, v71
  v_lshl_add_u32 v225, v226, 3, v225
  v_mfma_f32_16x16x32_bf16 v[100:103], a[144:147], v[128:131], v[192:195]
  v_exp_f32 v76, v76
  v_mfma_f32_16x16x32_bf16 v[100:103], a[148:151], v[132:135], v[100:103]
  ds_read_b64_tr_b16 a[160:161], v216 offset:0
  v_add_u32 v225, s50, v225
  v_mfma_f32_16x16x32_bf16 v[100:103], a[152:155], v[136:139], v[100:103]
  s_waitcnt vmcnt(13)
  v_exp_f32 v77, v77
  v_mfma_f32_16x16x32_bf16 v[100:103], a[156:159], v[140:143], v[100:103]
  ds_read_b64_tr_b16 a[162:163], v216 offset:4096
  v_cvt_pk_bf16_f32 v74, v76, v77
  v_mfma_f32_16x16x32_bf16 v[108:111], a[156:159], v[156:159], v[196:199]
  v_exp_f32 v78, v78
  v_mfma_f32_16x16x32_bf16 v[108:111], a[152:155], v[152:155], v[108:111]
  ds_read_b64_tr_b16 a[164:165], v216 offset:8192
  buffer_load_dwordx4 v235, s[12:15], s29 offen offset:3072 lds
  v_mfma_f32_16x16x32_bf16 v[108:111], a[148:151], v[148:151], v[108:111]
  v_exp_f32 v79, v79
  v_mfma_f32_16x16x32_bf16 v[108:111], a[144:147], v[144:147], v[108:111]
  ds_read_b64_tr_b16 a[166:167], v216 offset:12288
  v_cvt_pk_bf16_f32 v75, v78, v79
  v_mfma_f32_16x16x32_bf16 v[116:119], a[144:147], v[160:163], v[200:203]
  v_exp_f32 v84, v84
  v_mfma_f32_16x16x32_bf16 v[116:119], a[148:151], v[164:167], v[116:119]
  ds_read_b64_tr_b16 a[168:169], v217 offset:0
  ds_read_b64_tr_b16 a[232:233], v225 offset:0
  s_add_u32 m0, s28, 0
  v_mfma_f32_16x16x32_bf16 v[116:119], a[152:155], v[168:171], v[116:119]
  v_exp_f32 v85, v85
  v_mfma_f32_16x16x32_bf16 v[116:119], a[156:159], v[172:175], v[116:119]
  ds_read_b64_tr_b16 a[170:171], v217 offset:4096
  v_cvt_pk_bf16_f32 v82, v84, v85
  v_mfma_f32_16x16x32_bf16 v[124:127], a[156:159], v[188:191], v[204:207]
  v_exp_f32 v86, v86
  v_mfma_f32_16x16x32_bf16 v[124:127], a[152:155], v[184:187], v[124:127]
  ds_read_b64_tr_b16 a[172:173], v217 offset:8192
  ds_read_b64_tr_b16 a[234:235], v225 offset:128
  v_mfma_f32_16x16x32_bf16 v[124:127], a[148:151], v[180:183], v[124:127]
  v_exp_f32 v87, v87
  v_mfma_f32_16x16x32_bf16 v[124:127], a[144:147], v[176:179], v[124:127]
  ds_read_b64_tr_b16 a[174:175], v217 offset:12288
  v_cvt_pk_bf16_f32 v83, v86, v87
  v_mfma_f32_16x16x32_bf16 a[192:195], a[208:211], v[0:3], a[192:195]
  v_exp_f32 v92, v92
  v_mfma_f32_16x16x32_bf16 a[192:195], a[208:211], v[32:35], a[192:195]
  ds_read_b64_tr_b16 a[176:177], v218 offset:0
  ds_read_b64_tr_b16 a[236:237], v225 offset:1024
  v_mfma_f32_16x16x32_bf16 a[196:199], a[208:211], v[8:11], a[196:199]
  v_exp_f32 v93, v93
  v_mfma_f32_16x16x32_bf16 a[196:199], a[208:211], v[40:43], a[196:199]
  ds_read_b64_tr_b16 a[178:179], v218 offset:4096
  v_cvt_pk_bf16_f32 v90, v92, v93
  v_mfma_f32_16x16x32_bf16 a[200:203], a[208:211], v[16:19], a[200:203]
  v_exp_f32 v94, v94
  v_mfma_f32_16x16x32_bf16 a[200:203], a[208:211], v[48:51], a[200:203]
  ds_read_b64_tr_b16 a[180:181], v218 offset:8192
  ds_read_b64_tr_b16 a[238:239], v225 offset:1152
  v_mfma_f32_16x16x32_bf16 a[204:207], a[208:211], v[24:27], a[204:207]
  s_waitcnt lgkmcnt(11)
  v_exp_f32 v95, v95
  v_mfma_f32_16x16x32_bf16 a[204:207], a[208:211], v[56:59], a[204:207]
  ds_read_b64_tr_b16 a[182:183], v218 offset:12288
  v_cvt_pk_bf16_f32 v91, v94, v95
  v_mfma_f32_16x16x32_bf16 a[0:3], a[160:163], v[0:3], a[0:3]
  v_exp_f32 v96, v96
  v_mfma_f32_16x16x32_bf16 a[0:3], a[164:167], v[32:35], a[0:3]
  ds_read_b64_tr_b16 a[184:185], v219 offset:0
  ds_read_b64_tr_b16 a[240:241], v225 offset:2048
  v_mfma_f32_16x16x32_bf16 a[4:7], a[164:167], v[40:43], a[4:7]
  v_exp_f32 v97, v97
  v_mfma_f32_16x16x32_bf16 a[4:7], a[160:163], v[8:11], a[4:7]
  ds_read_b64_tr_b16 a[186:187], v219 offset:4096
  v_cvt_pk_bf16_f32 v96, v96, v97
  v_mfma_f32_16x16x32_bf16 a[8:11], a[160:163], v[16:19], a[8:11]
  v_exp_f32 v98, v98
  v_mfma_f32_16x16x32_bf16 a[8:11], a[164:167], v[48:51], a[8:11]
  ds_read_b64_tr_b16 a[188:189], v219 offset:8192
  ds_read_b64_tr_b16 a[242:243], v225 offset:2176
  v_mfma_f32_16x16x32_bf16 a[12:15], a[164:167], v[56:59], a[12:15]
  s_waitcnt lgkmcnt(11)
  v_exp_f32 v99, v99
  v_mfma_f32_16x16x32_bf16 a[12:15], a[160:163], v[24:27], a[12:15]
  ds_read_b64_tr_b16 a[190:191], v219 offset:12288
  v_cvt_pk_bf16_f32 v97, v98, v99
  v_mfma_f32_16x16x32_bf16 a[16:19], a[168:171], v[0:3], a[16:19]
  v_exp_f32 v104, v104
  v_mfma_f32_16x16x32_bf16 a[16:19], a[172:175], v[32:35], a[16:19]
  ds_read_b64_tr_b16 a[160:161], v220 offset:0
  buffer_load_dwordx4 v253, s[24:27], s8 offen offset:0 sc1 lds
  v_mfma_f32_16x16x32_bf16 a[20:23], a[172:175], v[40:43], a[20:23]
  v_exp_f32 v105, v105
  v_mfma_f32_16x16x32_bf16 a[20:23], a[168:171], v[8:11], a[20:23]
  ds_read_b64_tr_b16 a[162:163], v220 offset:4096
  v_cvt_pk_bf16_f32 v104, v104, v105
  v_mfma_f32_16x16x32_bf16 a[24:27], a[168:171], v[16:19], a[24:27]
  v_exp_f32 v106, v106
  v_mfma_f32_16x16x32_bf16 a[24:27], a[172:175], v[48:51], a[24:27]
  ds_read_b64_tr_b16 a[164:165], v220 offset:8192
  s_waitcnt lgkmcnt(4)
  buffer_load_dwordx4 v253, s[24:27], s8 offen offset:1024 sc1 lds
  v_mfma_f32_16x16x32_bf16 v[228:231], a[232:235], a[212:215], 0
  v_mfma_f32_16x16x32_bf16 v[228:231], a[236:239], a[216:219], v[228:231]
  v_mfma_f32_16x16x32_bf16 v[228:231], a[240:243], a[220:223], v[228:231]
  v_mfma_f32_16x16x32_bf16 a[28:31], a[172:175], v[56:59], a[28:31]
  s_lshl_b32 s35, s3, 10
  s_add_u32 s35, s35, 159744
  v_exp_f32 v107, v107
  v_mfma_f32_16x16x32_bf16 a[28:31], a[168:171], v[24:27], a[28:31]
  ds_read_b64_tr_b16 a[166:167], v220 offset:12288
  v_cvt_pk_bf16_f32 v105, v106, v107
  v_mfma_f32_16x16x32_bf16 a[32:35], a[176:179], v[0:3], a[32:35]
  v_exp_f32 v112, v112
  v_mfma_f32_16x16x32_bf16 a[32:35], a[180:183], v[32:35], a[32:35]
  ds_read_b64_tr_b16 a[168:169], v221 offset:0
  buffer_load_dwordx4 v253, s[24:27], s8 offen offset:2048 sc1 lds
  v_mfma_f32_16x16x32_bf16 a[36:39], a[180:183], v[40:43], a[36:39]
  v_exp_f32 v113, v113
  v_mfma_f32_16x16x32_bf16 a[36:39], a[176:179], v[8:11], a[36:39]
  ds_read_b64_tr_b16 a[170:171], v221 offset:4096
  v_cvt_pk_bf16_f32 v112, v112, v113
  v_mfma_f32_16x16x32_bf16 a[40:43], a[176:179], v[16:19], a[40:43]
  v_exp_f32 v114, v114
  v_mfma_f32_16x16x32_bf16 a[40:43], a[180:183], v[48:51], a[40:43]
  ds_read_b64_tr_b16 a[172:173], v221 offset:8192
  buffer_load_dwordx4 v253, s[24:27], s8 offen offset:3072 sc1 lds
  v_mfma_f32_16x16x32_bf16 a[44:47], a[180:183], v[56:59], a[44:47]
  s_waitcnt lgkmcnt(7)
  v_exp_f32 v115, v115
  v_mfma_f32_16x16x32_bf16 a[44:47], a[176:179], v[24:27], a[44:47]
  ds_read_b64_tr_b16 a[174:175], v221 offset:12288
  v_cvt_pk_bf16_f32 v113, v114, v115
  v_mfma_f32_16x16x32_bf16 a[48:51], a[184:187], v[0:3], a[48:51]
  v_exp_f32 v120, v120
  v_mfma_f32_16x16x32_bf16 a[48:51], a[188:191], v[32:35], a[48:51]
  ds_read_b64_tr_b16 a[176:177], v222 offset:0
  v_add_u32 v224, s35, v242
  v_mfma_f32_16x16x32_bf16 a[52:55], a[188:191], v[40:43], a[52:55]
  v_exp_f32 v121, v121
  v_mfma_f32_16x16x32_bf16 a[52:55], a[184:187], v[8:11], a[52:55]
  ds_read_b64_tr_b16 a[178:179], v222 offset:4096
  v_cvt_pk_bf16_f32 v120, v120, v121
  v_mfma_f32_16x16x32_bf16 a[56:59], a[184:187], v[16:19], a[56:59]
  v_exp_f32 v122, v122
  v_mfma_f32_16x16x32_bf16 a[56:59], a[188:191], v[48:51], a[56:59]
  ds_read_b64_tr_b16 a[180:181], v222 offset:8192
  ds_write_b128 v224, v[228:231]
  v_mfma_f32_16x16x32_bf16 a[60:63], a[188:191], v[56:59], a[60:63]
  s_waitcnt lgkmcnt(8)
  v_exp_f32 v123, v123
  v_mfma_f32_16x16x32_bf16 a[60:63], a[184:187], v[24:27], a[60:63]
  ds_read_b64_tr_b16 a[182:183], v222 offset:12288
  v_cvt_pk_bf16_f32 v121, v122, v123
  v_mfma_f32_16x16x32_bf16 a[64:67], a[160:163], v[0:3], a[64:67]
  v_exp_f32 v100, v100
  v_mfma_f32_16x16x32_bf16 a[64:67], a[164:167], v[32:35], a[64:67]
  ds_read_b64_tr_b16 a[184:185], v223 offset:0
  v_mfma_f32_16x16x32_bf16 a[68:71], a[164:167], v[40:43], a[68:71]
  v_exp_f32 v101, v101
  v_mfma_f32_16x16x32_bf16 a[68:71], a[160:163], v[8:11], a[68:71]
  ds_read_b64_tr_b16 a[186:187], v223 offset:4096
  v_cvt_pk_bf16_f32 v98, v100, v101
  v_mfma_f32_16x16x32_bf16 a[72:75], a[160:163], v[16:19], a[72:75]
  v_exp_f32 v102, v102
  v_mfma_f32_16x16x32_bf16 a[72:75], a[164:167], v[48:51], a[72:75]
  ds_read_b64_tr_b16 a[188:189], v223 offset:8192
  s_waitcnt lgkmcnt(4)
  v_mfma_f32_16x16x32_bf16 a[76:79], a[164:167], v[56:59], a[76:79]
  v_exp_f32 v103, v103
  v_mfma_f32_16x16x32_bf16 a[76:79], a[160:163], v[24:27], a[76:79]
  ds_read_b64_tr_b16 a[190:191], v223 offset:12288
  v_cvt_pk_bf16_f32 v99, v102, v103
  v_mfma_f32_16x16x32_bf16 a[80:83], a[168:171], v[0:3], a[80:83]
  s_waitcnt vmcnt(12)
  v_exp_f32 v108, v108
  v_mfma_f32_16x16x32_bf16 a[80:83], a[172:175], v[32:35], a[80:83]
  v_mfma_f32_16x16x32_bf16 a[84:87], a[172:175], v[40:43], a[84:87]
  s_barrier
  v_exp_f32 v109, v109
  v_mfma_f32_16x16x32_bf16 a[84:87], a[168:171], v[8:11], a[84:87]
  ds_read_b128 a[128:131], v212 offset:32768
  v_cvt_pk_bf16_f32 v106, v108, v109
  v_mfma_f32_16x16x32_bf16 a[88:91], a[168:171], v[16:19], a[88:91]
  v_exp_f32 v110, v110
  v_mfma_f32_16x16x32_bf16 a[88:91], a[172:175], v[48:51], a[88:91]
  ds_read_b128 a[132:135], v213 offset:32768
  v_mfma_f32_16x16x32_bf16 a[92:95], a[172:175], v[56:59], a[92:95]
  s_waitcnt lgkmcnt(6)
  v_exp_f32 v111, v111
  v_mfma_f32_16x16x32_bf16 a[92:95], a[168:171], v[24:27], a[92:95]
  ds_read_b128 a[136:139], v214 offset:32768
  v_cvt_pk_bf16_f32 v107, v110, v111
  v_mfma_f32_16x16x32_bf16 a[96:99], a[176:179], v[0:3], a[96:99]
  v_exp_f32 v116, v116
  v_mfma_f32_16x16x32_bf16 a[96:99], a[180:183], v[32:35], a[96:99]
  ds_read_b128 a[140:143], v215 offset:32768
  v_mfma_f32_16x16x32_bf16 a[100:103], a[180:183], v[40:43], a[100:103]
  v_exp_f32 v117, v117
  v_mfma_f32_16x16x32_bf16 a[100:103], a[176:179], v[8:11], a[100:103]
  v_cvt_pk_bf16_f32 v114, v116, v117
  v_mfma_f32_16x16x32_bf16 a[104:107], a[176:179], v[16:19], a[104:107]
  v_exp_f32 v118, v118
  v_mfma_f32_16x16x32_bf16 a[104:107], a[180:183], v[48:51], a[104:107]
  v_mfma_f32_16x16x32_bf16 a[108:111], a[180:183], v[56:59], a[108:111]
  s_waitcnt lgkmcnt(4)
  v_exp_f32 v119, v119
  v_mfma_f32_16x16x32_bf16 a[108:111], a[176:179], v[24:27], a[108:111]
  v_cvt_pk_bf16_f32 v115, v118, v119
  v_mfma_f32_16x16x32_bf16 a[112:115], a[184:187], v[0:3], a[112:115]
  v_exp_f32 v124, v124
  v_mfma_f32_16x16x32_bf16 a[112:115], a[188:191], v[32:35], a[112:115]
  v_mfma_f32_16x16x32_bf16 a[116:119], a[188:191], v[40:43], a[116:119]
  v_exp_f32 v125, v125
  v_mfma_f32_16x16x32_bf16 a[116:119], a[184:187], v[8:11], a[116:119]
  v_cvt_pk_bf16_f32 v122, v124, v125
  v_mfma_f32_16x16x32_bf16 a[120:123], a[184:187], v[16:19], a[120:123]
  v_exp_f32 v126, v126
  v_mfma_f32_16x16x32_bf16 a[120:123], a[188:191], v[48:51], a[120:123]
  v_mfma_f32_16x16x32_bf16 a[124:127], a[188:191], v[56:59], a[124:127]
  s_waitcnt lgkmcnt(0)
  v_exp_f32 v127, v127
  v_mfma_f32_16x16x32_bf16 a[124:127], a[184:187], v[24:27], a[124:127]
  v_cvt_pk_bf16_f32 v123, v126, v127
  v_mfma_f32_16x16x32_bf16 v[0:3], a[128:131], v[128:131], v[192:195]
  s_add_u32 m0, s28, 114688
  v_add_u32 v224, 159744, v242
  v_mfma_f32_16x16x32_bf16 v[0:3], a[132:135], v[132:135], v[0:3]
  ds_read_b128 a[144:147], v212 offset:36864
  ds_read_b128 v[228:231], v224 offset:0
  v_mfma_f32_16x16x32_bf16 v[0:3], a[136:139], v[136:139], v[0:3]
  buffer_load_dwordx4 v236, s[16:19], s29 offen offset:0 lds
  v_mfma_f32_16x16x32_bf16 v[0:3], a[140:143], v[140:143], v[0:3]
  ds_read_b128 a[148:151], v213 offset:36864
  ds_read_b128 v[238:241], v224 offset:1024
  v_mfma_f32_16x16x32_bf16 v[8:11], a[140:143], v[156:159], v[196:199]
  ds_read_b128 v[208:211], v224 offset:2048
  v_lshrrev_b32 v224, 4, v242
  v_mfma_f32_16x16x32_bf16 v[8:11], a[136:139], v[152:155], v[8:11]
  ds_read_b128 a[152:155], v214 offset:36864
  s_min_u32 s35, s3, 1
  s_lshl_b32 s35, s35, 30
  v_and_b32 v225, 7, v224
  v_mfma_f32_16x16x32_bf16 v[8:11], a[132:135], v[148:151], v[8:11]
  buffer_load_dwordx4 v237, s[16:19], s29 offen offset:1024 lds
  v_mfma_f32_16x16x32_bf16 v[8:11], a[128:131], v[144:147], v[8:11]
  ds_read_b128 a[156:159], v215 offset:36864
  v_mul_u32_u24 v225, 0xa00, v225
  v_mfma_f32_16x16x32_bf16 v[16:19], a[128:131], v[160:163], v[200:203]
  v_exp_f32 v0, v0
  v_mfma_f32_16x16x32_bf16 v[16:19], a[132:135], v[164:167], v[16:19]
  v_lshrrev_b32 v226, 4, v224
  v_lshl_add_u32 v225, v226, 4, v225
  v_mfma_f32_16x16x32_bf16 v[16:19], a[136:139], v[168:171], v[16:19]
  v_exp_f32 v1, v1
  v_mfma_f32_16x16x32_bf16 v[16:19], a[140:143], v[172:175], v[16:19]
  v_cvt_pk_bf16_f32 v0, v0, v1
  v_bfe_u32 v226, v224, 3, 1
  v_mfma_f32_16x16x32_bf16 v[24:27], a[140:143], v[188:191], v[204:207]
  v_exp_f32 v2, v2
  v_mfma_f32_16x16x32_bf16 v[24:27], a[136:139], v[184:187], v[24:27]
  buffer_load_dwordx4 v236, s[16:19], s29 offen offset:2048 lds
  v_mfma_f32_16x16x32_bf16 v[24:27], a[132:135], v[180:183], v[24:27]
  s_waitcnt lgkmcnt(0)
  v_exp_f32 v3, v3
  v_mfma_f32_16x16x32_bf16 v[24:27], a[128:131], v[176:179], v[24:27]
  v_cvt_pk_bf16_f32 v1, v2, v3
  v_lshl_add_u32 v225, v226, 30, v225
  v_mfma_f32_16x16x32_bf16 v[4:7], a[144:147], v[128:131], v[192:195]
  v_exp_f32 v8, v8
  v_mfma_f32_16x16x32_bf16 v[4:7], a[148:151], v[132:135], v[4:7]
  ds_read_b128 a[128:131], v212 offset:40960
  v_or_b32 v225, s35, v225
  v_mfma_f32_16x16x32_bf16 v[4:7], a[152:155], v[136:139], v[4:7]
  s_mul_i32 s35, s98, 20480
  s_lshl_b32 s38, s99, 6
  s_add_u32 s35, s35, s38
  v_exp_f32 v9, v9
  v_mfma_f32_16x16x32_bf16 v[4:7], a[156:159], v[140:143], v[4:7]
  ds_read_b128 a[132:135], v213 offset:40960
  s_add_u32 s35, s35, 2686976
  v_cvt_pk_bf16_f32 v8, v8, v9
  v_mfma_f32_16x16x32_bf16 v[12:15], a[156:159], v[156:159], v[196:199]
  v_exp_f32 v10, v10
  v_mfma_f32_16x16x32_bf16 v[12:15], a[152:155], v[152:155], v[12:15]
  ds_read_b128 a[136:139], v214 offset:40960
  v_add_f32 v228, v228, v238
  v_mfma_f32_16x16x32_bf16 v[12:15], a[148:151], v[148:151], v[12:15]
  v_exp_f32 v11, v11
  v_mfma_f32_16x16x32_bf16 v[12:15], a[144:147], v[144:147], v[12:15]
  ds_read_b128 a[140:143], v215 offset:40960
  v_cvt_pk_bf16_f32 v9, v10, v11
  v_mfma_f32_16x16x32_bf16 v[20:23], a[144:147], v[160:163], v[200:203]
  v_exp_f32 v16, v16
  v_mfma_f32_16x16x32_bf16 v[20:23], a[148:151], v[164:167], v[20:23]
  buffer_load_dwordx4 v237, s[16:19], s29 offen offset:3072 lds
  v_mfma_f32_16x16x32_bf16 v[20:23], a[152:155], v[168:171], v[20:23]
  s_add_u32 s29, s29, 16384
  v_exp_f32 v17, v17
  v_mfma_f32_16x16x32_bf16 v[20:23], a[156:159], v[172:175], v[20:23]
  v_cvt_pk_bf16_f32 v16, v16, v17
  v_add_f32 v229, v229, v239
  v_mfma_f32_16x16x32_bf16 v[28:31], a[156:159], v[188:191], v[204:207]
  s_add_u32 m0, s28, 16384
  v_exp_f32 v18, v18
  v_mfma_f32_16x16x32_bf16 v[28:31], a[152:155], v[184:187], v[28:31]
  buffer_load_dwordx4 v242, s[24:27], s9 offen offset:0 sc1 lds
  v_mfma_f32_16x16x32_bf16 v[28:31], a[148:151], v[180:183], v[28:31]
  s_waitcnt lgkmcnt(0)
  v_exp_f32 v19, v19
  v_mfma_f32_16x16x32_bf16 v[28:31], a[144:147], v[176:179], v[28:31]
  v_cvt_pk_bf16_f32 v17, v18, v19
  v_add_f32 v230, v230, v240
  v_mfma_f32_16x16x32_bf16 v[32:35], a[128:131], v[128:131], v[192:195]
  v_exp_f32 v24, v24
  v_mfma_f32_16x16x32_bf16 v[32:35], a[132:135], v[132:135], v[32:35]
  ds_read_b128 a[144:147], v212 offset:45056
  v_add_f32 v231, v231, v241
  v_mfma_f32_16x16x32_bf16 v[32:35], a[136:139], v[136:139], v[32:35]
  v_exp_f32 v25, v25
  v_mfma_f32_16x16x32_bf16 v[32:35], a[140:143], v[140:143], v[32:35]
  ds_read_b128 a[148:151], v213 offset:45056
  v_cvt_pk_bf16_f32 v24, v24, v25
  v_mfma_f32_16x16x32_bf16 v[40:43], a[140:143], v[156:159], v[196:199]
  v_exp_f32 v26, v26
  v_mfma_f32_16x16x32_bf16 v[40:43], a[136:139], v[152:155], v[40:43]
  ds_read_b128 a[152:155], v214 offset:45056
  v_add_f32 v228, v228, v208
  v_mfma_f32_16x16x32_bf16 v[40:43], a[132:135], v[148:151], v[40:43]
  v_exp_f32 v27, v27
  v_mfma_f32_16x16x32_bf16 v[40:43], a[128:131], v[144:147], v[40:43]
  ds_read_b128 a[156:159], v215 offset:45056
  v_cvt_pk_bf16_f32 v25, v26, v27
  v_mfma_f32_16x16x32_bf16 v[48:51], a[128:131], v[160:163], v[200:203]
  v_exp_f32 v4, v4
  v_mfma_f32_16x16x32_bf16 v[48:51], a[132:135], v[164:167], v[48:51]
  buffer_load_dwordx4 v242, s[24:27], s9 offen offset:1024 sc1 lds
  v_mfma_f32_16x16x32_bf16 v[48:51], a[136:139], v[168:171], v[48:51]
  v_exp_f32 v5, v5
  v_mfma_f32_16x16x32_bf16 v[48:51], a[140:143], v[172:175], v[48:51]
  v_cvt_pk_bf16_f32 v2, v4, v5
  v_add_f32 v229, v229, v209
  v_mfma_f32_16x16x32_bf16 v[56:59], a[140:143], v[188:191], v[204:207]
  v_exp_f32 v6, v6
  v_mfma_f32_16x16x32_bf16 v[56:59], a[136:139], v[184:187], v[56:59]
  buffer_load_dwordx4 v242, s[24:27], s9 offen offset:2048 sc1 lds
  v_mfma_f32_16x16x32_bf16 v[56:59], a[132:135], v[180:183], v[56:59]
  s_waitcnt lgkmcnt(0)
  v_exp_f32 v7, v7
  v_mfma_f32_16x16x32_bf16 v[56:59], a[128:131], v[176:179], v[56:59]
  v_cvt_pk_bf16_f32 v3, v6, v7
  v_add_f32 v230, v230, v210
  v_mfma_f32_16x16x32_bf16 v[36:39], a[144:147], v[128:131], v[192:195]
  v_exp_f32 v12, v12
  v_mfma_f32_16x16x32_bf16 v[36:39], a[148:151], v[132:135], v[36:39]
  ds_read_b64_tr_b16 a[160:161], v216 offset:16384
  v_add_f32 v231, v231, v211
  v_mfma_f32_16x16x32_bf16 v[36:39], a[152:155], v[136:139], v[36:39]
  v_exp_f32 v13, v13
  v_mfma_f32_16x16x32_bf16 v[36:39], a[156:159], v[140:143], v[36:39]
  ds_read_b64_tr_b16 a[162:163], v216 offset:20480
  v_cvt_pk_bf16_f32 v10, v12, v13
  v_mfma_f32_16x16x32_bf16 v[44:47], a[156:159], v[156:159], v[196:199]
  v_exp_f32 v14, v14
  v_mfma_f32_16x16x32_bf16 v[44:47], a[152:155], v[152:155], v[44:47]
  ds_read_b64_tr_b16 a[164:165], v216 offset:24576
  buffer_load_dwordx4 v242, s[24:27], s9 offen offset:3072 sc1 lds
  v_mfma_f32_16x16x32_bf16 v[44:47], a[148:151], v[148:151], v[44:47]
  v_exp_f32 v15, v15
  v_mfma_f32_16x16x32_bf16 v[44:47], a[144:147], v[144:147], v[44:47]
  ds_read_b64_tr_b16 a[166:167], v216 offset:28672
  v_cvt_pk_bf16_f32 v11, v14, v15
  v_mfma_f32_16x16x32_bf16 v[52:55], a[144:147], v[160:163], v[200:203]
  v_exp_f32 v20, v20
  v_mfma_f32_16x16x32_bf16 v[52:55], a[148:151], v[164:167], v[52:55]
  ds_read_b64_tr_b16 a[168:169], v217 offset:16384
  buffer_store_dwordx4 v[228:231], v225, s[24:27], s35 offen sc1
  v_mfma_f32_16x16x32_bf16 v[52:55], a[152:155], v[168:171], v[52:55]
  v_exp_f32 v21, v21
  v_mfma_f32_16x16x32_bf16 v[52:55], a[156:159], v[172:175], v[52:55]
  ds_read_b64_tr_b16 a[170:171], v217 offset:20480
  v_cvt_pk_bf16_f32 v18, v20, v21
  v_mfma_f32_16x16x32_bf16 v[60:63], a[156:159], v[188:191], v[204:207]
  v_exp_f32 v22, v22
  v_mfma_f32_16x16x32_bf16 v[60:63], a[152:155], v[184:187], v[60:63]
  ds_read_b64_tr_b16 a[172:173], v217 offset:24576
  buffer_load_dwordx4 a[212:215], v242, s[24:27], s4 offen offset:0 sc1
  v_mfma_f32_16x16x32_bf16 v[60:63], a[148:151], v[180:183], v[60:63]
  v_exp_f32 v23, v23
  v_mfma_f32_16x16x32_bf16 v[60:63], a[144:147], v[176:179], v[60:63]
  ds_read_b64_tr_b16 a[174:175], v217 offset:28672
  v_cvt_pk_bf16_f32 v19, v22, v23
  v_mfma_f32_16x16x32_bf16 a[192:195], a[208:211], v[64:67], a[192:195]
  v_exp_f32 v28, v28
  v_mfma_f32_16x16x32_bf16 a[192:195], a[208:211], v[96:99], a[192:195]
  ds_read_b64_tr_b16 a[176:177], v218 offset:16384
  buffer_load_dwordx4 a[216:219], v242, s[24:27], s4 offen offset:1024 sc1
  v_mfma_f32_16x16x32_bf16 a[196:199], a[208:211], v[72:75], a[196:199]
  v_exp_f32 v29, v29
  v_mfma_f32_16x16x32_bf16 a[196:199], a[208:211], v[104:107], a[196:199]
  ds_read_b64_tr_b16 a[178:179], v218 offset:20480
  v_cvt_pk_bf16_f32 v26, v28, v29
  v_mfma_f32_16x16x32_bf16 a[200:203], a[208:211], v[80:83], a[200:203]
  v_exp_f32 v30, v30
  v_mfma_f32_16x16x32_bf16 a[200:203], a[208:211], v[112:115], a[200:203]
  ds_read_b64_tr_b16 a[180:181], v218 offset:24576
  v_mfma_f32_16x16x32_bf16 a[204:207], a[208:211], v[88:91], a[204:207]
  s_waitcnt lgkmcnt(7)
  v_exp_f32 v31, v31
  v_mfma_f32_16x16x32_bf16 a[204:207], a[208:211], v[120:123], a[204:207]
  ds_read_b64_tr_b16 a[182:183], v218 offset:28672
  v_cvt_pk_bf16_f32 v27, v30, v31
  v_mfma_f32_16x16x32_bf16 a[0:3], a[160:163], v[64:67], a[0:3]
  v_exp_f32 v32, v32
  v_mfma_f32_16x16x32_bf16 a[0:3], a[164:167], v[96:99], a[0:3]
  ds_read_b64_tr_b16 a[184:185], v219 offset:16384
  buffer_load_dwordx4 a[220:223], v242, s[24:27], s4 offen offset:2048 sc1
  v_mfma_f32_16x16x32_bf16 a[4:7], a[164:167], v[104:107], a[4:7]
  v_exp_f32 v33, v33
  v_mfma_f32_16x16x32_bf16 a[4:7], a[160:163], v[72:75], a[4:7]
  ds_read_b64_tr_b16 a[186:187], v219 offset:20480
  v_cvt_pk_bf16_f32 v32, v32, v33
  v_mfma_f32_16x16x32_bf16 a[8:11], a[160:163], v[80:83], a[8:11]
  v_exp_f32 v34, v34
  v_mfma_f32_16x16x32_bf16 a[8:11], a[164:167], v[112:115], a[8:11]
  ds_read_b64_tr_b16 a[188:189], v219 offset:24576
  v_mfma_f32_16x16x32_bf16 a[12:15], a[164:167], v[120:123], a[12:15]
  s_waitcnt lgkmcnt(7)
  v_exp_f32 v35, v35
  v_mfma_f32_16x16x32_bf16 a[12:15], a[160:163], v[88:91], a[12:15]
  ds_read_b64_tr_b16 a[190:191], v219 offset:28672
  v_cvt_pk_bf16_f32 v33, v34, v35
  v_mfma_f32_16x16x32_bf16 a[16:19], a[168:171], v[64:67], a[16:19]
  v_exp_f32 v40, v40
  v_mfma_f32_16x16x32_bf16 a[16:19], a[172:175], v[96:99], a[16:19]
  ds_read_b64_tr_b16 a[160:161], v220 offset:16384
  buffer_load_dwordx4 a[224:227], v242, s[24:27], s4 offen offset:3072 sc1
  v_mfma_f32_16x16x32_bf16 a[20:23], a[172:175], v[104:107], a[20:23]
  v_exp_f32 v41, v41
  v_mfma_f32_16x16x32_bf16 a[20:23], a[168:171], v[72:75], a[20:23]
  ds_read_b64_tr_b16 a[162:163], v220 offset:20480
  v_cvt_pk_bf16_f32 v40, v40, v41
  v_mfma_f32_16x16x32_bf16 a[24:27], a[168:171], v[80:83], a[24:27]
  v_exp_f32 v42, v42
  v_mfma_f32_16x16x32_bf16 a[24:27], a[172:175], v[112:115], a[24:27]
  ds_read_b64_tr_b16 a[164:165], v220 offset:24576
  v_mfma_f32_16x16x32_bf16 a[28:31], a[172:175], v[120:123], a[28:31]
  s_waitcnt lgkmcnt(7)
  v_exp_f32 v43, v43
  v_mfma_f32_16x16x32_bf16 a[28:31], a[168:171], v[88:91], a[28:31]
  ds_read_b64_tr_b16 a[166:167], v220 offset:28672
  v_cvt_pk_bf16_f32 v41, v42, v43
  v_mfma_f32_16x16x32_bf16 a[32:35], a[176:179], v[64:67], a[32:35]
  v_exp_f32 v48, v48
  v_mfma_f32_16x16x32_bf16 a[32:35], a[180:183], v[96:99], a[32:35]
  ds_read_b64_tr_b16 a[168:169], v221 offset:16384
  buffer_load_dwordx4 a[228:231], v252, s[24:27], s4 offen offset:0 sc1
  v_mfma_f32_16x16x32_bf16 a[36:39], a[180:183], v[104:107], a[36:39]
  v_exp_f32 v49, v49
  v_mfma_f32_16x16x32_bf16 a[36:39], a[176:179], v[72:75], a[36:39]
  ds_read_b64_tr_b16 a[170:171], v221 offset:20480
  v_cvt_pk_bf16_f32 v48, v48, v49
  v_mfma_f32_16x16x32_bf16 a[40:43], a[176:179], v[80:83], a[40:43]
  v_exp_f32 v50, v50
  v_mfma_f32_16x16x32_bf16 a[40:43], a[180:183], v[112:115], a[40:43]
  ds_read_b64_tr_b16 a[172:173], v221 offset:24576
  v_mfma_f32_16x16x32_bf16 a[44:47], a[180:183], v[120:123], a[44:47]
  s_waitcnt lgkmcnt(7)
  v_exp_f32 v51, v51
  v_mfma_f32_16x16x32_bf16 a[44:47], a[176:179], v[88:91], a[44:47]
  ds_read_b64_tr_b16 a[174:175], v221 offset:28672
  v_cvt_pk_bf16_f32 v49, v50, v51
  v_mfma_f32_16x16x32_bf16 a[48:51], a[184:187], v[64:67], a[48:51]
  v_exp_f32 v56, v56
  v_mfma_f32_16x16x32_bf16 a[48:51], a[188:191], v[96:99], a[48:51]
  ds_read_b64_tr_b16 a[176:177], v222 offset:16384
  buffer_load_dwordx4 a[232:235], v252, s[24:27], s4 offen offset:1024 sc1
  v_mfma_f32_16x16x32_bf16 a[52:55], a[188:191], v[104:107], a[52:55]
  v_exp_f32 v57, v57
  v_mfma_f32_16x16x32_bf16 a[52:55], a[184:187], v[72:75], a[52:55]
  ds_read_b64_tr_b16 a[178:179], v222 offset:20480
  v_cvt_pk_bf16_f32 v56, v56, v57
  v_mfma_f32_16x16x32_bf16 a[56:59], a[184:187], v[80:83], a[56:59]
  v_exp_f32 v58, v58
  v_mfma_f32_16x16x32_bf16 a[56:59], a[188:191], v[112:115], a[56:59]
  ds_read_b64_tr_b16 a[180:181], v222 offset:24576
  v_mfma_f32_16x16x32_bf16 a[60:63], a[188:191], v[120:123], a[60:63]
  s_waitcnt lgkmcnt(7)
  v_exp_f32 v59, v59
  v_mfma_f32_16x16x32_bf16 a[60:63], a[184:187], v[88:91], a[60:63]
  ds_read_b64_tr_b16 a[182:183], v222 offset:28672
  v_cvt_pk_bf16_f32 v57, v58, v59
  v_mfma_f32_16x16x32_bf16 a[64:67], a[160:163], v[64:67], a[64:67]
  v_exp_f32 v36, v36
  v_mfma_f32_16x16x32_bf16 a[64:67], a[164:167], v[96:99], a[64:67]
  ds_read_b64_tr_b16 a[184:185], v223 offset:16384
  v_mfma_f32_16x16x32_bf16 a[68:71], a[164:167], v[104:107], a[68:71]
  v_exp_f32 v37, v37
  v_mfma_f32_16x16x32_bf16 a[68:71], a[160:163], v[72:75], a[68:71]
  ds_read_b64_tr_b16 a[186:187], v223 offset:20480
  v_cvt_pk_bf16_f32 v34, v36, v37
  v_mfma_f32_16x16x32_bf16 a[72:75], a[160:163], v[80:83], a[72:75]
  v_exp_f32 v38, v38
  v_mfma_f32_16x16x32_bf16 a[72:75], a[164:167], v[112:115], a[72:75]
  ds_read_b64_tr_b16 a[188:189], v223 offset:24576
  v_mfma_f32_16x16x32_bf16 a[76:79], a[164:167], v[120:123], a[76:79]
  s_waitcnt lgkmcnt(7)
  v_exp_f32 v39, v39
  v_mfma_f32_16x16x32_bf16 a[76:79], a[160:163], v[88:91], a[76:79]
  ds_read_b64_tr_b16 a[190:191], v223 offset:28672
  v_cvt_pk_bf16_f32 v35, v38, v39
  v_mfma_f32_16x16x32_bf16 a[80:83], a[168:171], v[64:67], a[80:83]
  s_waitcnt vmcnt(19)
  v_exp_f32 v44, v44
  v_mfma_f32_16x16x32_bf16 a[80:83], a[172:175], v[96:99], a[80:83]
  v_mfma_f32_16x16x32_bf16 a[84:87], a[172:175], v[104:107], a[84:87]
  s_barrier
  v_exp_f32 v45, v45
  v_mfma_f32_16x16x32_bf16 a[84:87], a[168:171], v[72:75], a[84:87]
  ds_read_b128 a[128:131], v212 offset:49152
  v_cvt_pk_bf16_f32 v42, v44, v45
  v_mfma_f32_16x16x32_bf16 a[88:91], a[168:171], v[80:83], a[88:91]
  v_exp_f32 v46, v46
  v_mfma_f32_16x16x32_bf16 a[88:91], a[172:175], v[112:115], a[88:91]
  ds_read_b128 a[132:135], v213 offset:49152
  v_mfma_f32_16x16x32_bf16 a[92:95], a[172:175], v[120:123], a[92:95]
  s_waitcnt lgkmcnt(6)
  v_exp_f32 v47, v47
  v_mfma_f32_16x16x32_bf16 a[92:95], a[168:171], v[88:91], a[92:95]
  ds_read_b128 a[136:139], v214 offset:49152
  v_cvt_pk_bf16_f32 v43, v46, v47
  v_mfma_f32_16x16x32_bf16 a[96:99], a[176:179], v[64:67], a[96:99]
  v_exp_f32 v52, v52
  v_mfma_f32_16x16x32_bf16 a[96:99], a[180:183], v[96:99], a[96:99]
  ds_read_b128 a[140:143], v215 offset:49152
  v_mfma_f32_16x16x32_bf16 a[100:103], a[180:183], v[104:107], a[100:103]
  v_exp_f32 v53, v53
  v_mfma_f32_16x16x32_bf16 a[100:103], a[176:179], v[72:75], a[100:103]
  v_cvt_pk_bf16_f32 v50, v52, v53
  v_mfma_f32_16x16x32_bf16 a[104:107], a[176:179], v[80:83], a[104:107]
  v_exp_f32 v54, v54
  v_mfma_f32_16x16x32_bf16 a[104:107], a[180:183], v[112:115], a[104:107]
  v_mfma_f32_16x16x32_bf16 a[108:111], a[180:183], v[120:123], a[108:111]
  s_waitcnt lgkmcnt(4)
  v_exp_f32 v55, v55
  v_mfma_f32_16x16x32_bf16 a[108:111], a[176:179], v[88:91], a[108:111]
  v_cvt_pk_bf16_f32 v51, v54, v55
  v_mfma_f32_16x16x32_bf16 a[112:115], a[184:187], v[64:67], a[112:115]
  v_exp_f32 v60, v60
  v_mfma_f32_16x16x32_bf16 a[112:115], a[188:191], v[96:99], a[112:115]
  v_mfma_f32_16x16x32_bf16 a[116:119], a[188:191], v[104:107], a[116:119]
  v_exp_f32 v61, v61
  v_mfma_f32_16x16x32_bf16 a[116:119], a[184:187], v[72:75], a[116:119]
  v_cvt_pk_bf16_f32 v58, v60, v61
  v_mfma_f32_16x16x32_bf16 a[120:123], a[184:187], v[80:83], a[120:123]
  v_exp_f32 v62, v62
  v_mfma_f32_16x16x32_bf16 a[120:123], a[188:191], v[112:115], a[120:123]
  v_mfma_f32_16x16x32_bf16 a[124:127], a[188:191], v[120:123], a[124:127]
  s_waitcnt lgkmcnt(0)
  v_exp_f32 v63, v63
  v_mfma_f32_16x16x32_bf16 a[124:127], a[184:187], v[88:91], a[124:127]
  v_cvt_pk_bf16_f32 v59, v62, v63
  v_mfma_f32_16x16x32_bf16 v[64:67], a[128:131], v[128:131], v[192:195]
  s_add_u32 m0, s28, 65536
  v_mfma_f32_16x16x32_bf16 v[64:67], a[132:135], v[132:135], v[64:67]
  ds_read_b128 a[144:147], v212 offset:53248
  v_mfma_f32_16x16x32_bf16 v[64:67], a[136:139], v[136:139], v[64:67]
  buffer_load_dwordx4 v253, s[24:27], s9 offen offset:0 sc1 lds
  v_mfma_f32_16x16x32_bf16 v[64:67], a[140:143], v[140:143], v[64:67]
  ds_read_b128 a[148:151], v213 offset:53248
  v_mfma_f32_16x16x32_bf16 v[72:75], a[140:143], v[156:159], v[196:199]
  v_mfma_f32_16x16x32_bf16 v[72:75], a[136:139], v[152:155], v[72:75]
  ds_read_b128 a[152:155], v214 offset:53248
  v_mfma_f32_16x16x32_bf16 v[72:75], a[132:135], v[148:151], v[72:75]
  buffer_load_dwordx4 v253, s[24:27], s9 offen offset:1024 sc1 lds
  v_mfma_f32_16x16x32_bf16 v[72:75], a[128:131], v[144:147], v[72:75]
  ds_read_b128 a[156:159], v215 offset:53248
  v_mfma_f32_16x16x32_bf16 v[80:83], a[128:131], v[160:163], v[200:203]
  v_exp_f32 v64, v64
  v_mfma_f32_16x16x32_bf16 v[80:83], a[132:135], v[164:167], v[80:83]
  v_mfma_f32_16x16x32_bf16 v[80:83], a[136:139], v[168:171], v[80:83]
  v_exp_f32 v65, v65
  v_mfma_f32_16x16x32_bf16 v[80:83], a[140:143], v[172:175], v[80:83]
  v_cvt_pk_bf16_f32 v64, v64, v65
  v_mfma_f32_16x16x32_bf16 v[88:91], a[140:143], v[188:191], v[204:207]
  v_exp_f32 v66, v66
  v_mfma_f32_16x16x32_bf16 v[88:91], a[136:139], v[184:187], v[88:91]
  buffer_load_dwordx4 v253, s[24:27], s9 offen offset:2048 sc1 lds
  v_mfma_f32_16x16x32_bf16 v[88:91], a[132:135], v[180:183], v[88:91]
  s_waitcnt lgkmcnt(0)
  v_exp_f32 v67, v67
  v_mfma_f32_16x16x32_bf16 v[88:91], a[128:131], v[176:179], v[88:91]
  v_cvt_pk_bf16_f32 v65, v66, v67
  v_mfma_f32_16x16x32_bf16 v[68:71], a[144:147], v[128:131], v[192:195]
  v_exp_f32 v72, v72
  v_mfma_f32_16x16x32_bf16 v[68:71], a[148:151], v[132:135], v[68:71]
  ds_read_b128 a[128:131], v212 offset:57344
  v_mfma_f32_16x16x32_bf16 v[68:71], a[152:155], v[136:139], v[68:71]
  v_exp_f32 v73, v73
  v_mfma_f32_16x16x32_bf16 v[68:71], a[156:159], v[140:143], v[68:71]
  ds_read_b128 a[132:135], v213 offset:57344
  v_cvt_pk_bf16_f32 v72, v72, v73
  v_mfma_f32_16x16x32_bf16 v[76:79], a[156:159], v[156:159], v[196:199]
  v_exp_f32 v74, v74
  v_mfma_f32_16x16x32_bf16 v[76:79], a[152:155], v[152:155], v[76:79]
  ds_read_b128 a[136:139], v214 offset:57344
  v_mfma_f32_16x16x32_bf16 v[76:79], a[148:151], v[148:151], v[76:79]
  v_exp_f32 v75, v75
  v_mfma_f32_16x16x32_bf16 v[76:79], a[144:147], v[144:147], v[76:79]
  ds_read_b128 a[140:143], v215 offset:57344
  v_cvt_pk_bf16_f32 v73, v74, v75
  v_mfma_f32_16x16x32_bf16 v[84:87], a[144:147], v[160:163], v[200:203]
  v_exp_f32 v80, v80
  v_mfma_f32_16x16x32_bf16 v[84:87], a[148:151], v[164:167], v[84:87]
  buffer_load_dwordx4 v253, s[24:27], s9 offen offset:3072 sc1 lds
  v_mfma_f32_16x16x32_bf16 v[84:87], a[152:155], v[168:171], v[84:87]
  s_add_u32 s29, s29, 16384
  v_exp_f32 v81, v81
  v_mfma_f32_16x16x32_bf16 v[84:87], a[156:159], v[172:175], v[84:87]
  v_cvt_pk_bf16_f32 v80, v80, v81
  v_mfma_f32_16x16x32_bf16 v[92:95], a[156:159], v[188:191], v[204:207]
  s_add_u32 m0, s28, 32768
  v_exp_f32 v82, v82
  v_mfma_f32_16x16x32_bf16 v[92:95], a[152:155], v[184:187], v[92:95]
  buffer_load_dwordx4 v252, s[24:27], s9 offen offset:0 sc1 lds
  v_mfma_f32_16x16x32_bf16 v[92:95], a[148:151], v[180:183], v[92:95]
  s_waitcnt lgkmcnt(0)
  v_exp_f32 v83, v83
  v_mfma_f32_16x16x32_bf16 v[92:95], a[144:147], v[176:179], v[92:95]
  v_cvt_pk_bf16_f32 v81, v82, v83
  v_mfma_f32_16x16x32_bf16 v[96:99], a[128:131], v[128:131], v[192:195]
  v_exp_f32 v88, v88
  v_mfma_f32_16x16x32_bf16 v[96:99], a[132:135], v[132:135], v[96:99]
  ds_read_b128 a[144:147], v212 offset:61440
  v_mfma_f32_16x16x32_bf16 v[96:99], a[136:139], v[136:139], v[96:99]
  v_exp_f32 v89, v89
  v_mfma_f32_16x16x32_bf16 v[96:99], a[140:143], v[140:143], v[96:99]
  ds_read_b128 a[148:151], v213 offset:61440
  v_cvt_pk_bf16_f32 v88, v88, v89
  v_mfma_f32_16x16x32_bf16 v[104:107], a[140:143], v[156:159], v[196:199]
  v_exp_f32 v90, v90
  v_mfma_f32_16x16x32_bf16 v[104:107], a[136:139], v[152:155], v[104:107]
  ds_read_b128 a[152:155], v214 offset:61440
  v_mfma_f32_16x16x32_bf16 v[104:107], a[132:135], v[148:151], v[104:107]
  v_exp_f32 v91, v91
  v_mfma_f32_16x16x32_bf16 v[104:107], a[128:131], v[144:147], v[104:107]
  ds_read_b128 a[156:159], v215 offset:61440
  v_cvt_pk_bf16_f32 v89, v90, v91
  v_mfma_f32_16x16x32_bf16 v[112:115], a[128:131], v[160:163], v[200:203]
  v_exp_f32 v68, v68
  v_mfma_f32_16x16x32_bf16 v[112:115], a[132:135], v[164:167], v[112:115]
  buffer_load_dwordx4 v252, s[24:27], s9 offen offset:1024 sc1 lds
  v_mfma_f32_16x16x32_bf16 v[112:115], a[136:139], v[168:171], v[112:115]
  v_exp_f32 v69, v69
  v_mfma_f32_16x16x32_bf16 v[112:115], a[140:143], v[172:175], v[112:115]
  v_cvt_pk_bf16_f32 v66, v68, v69
  v_mfma_f32_16x16x32_bf16 v[120:123], a[140:143], v[188:191], v[204:207]
  v_exp_f32 v70, v70
  v_mfma_f32_16x16x32_bf16 v[120:123], a[136:139], v[184:187], v[120:123]
  buffer_load_dwordx4 v252, s[24:27], s9 offen offset:2048 sc1 lds
  v_mfma_f32_16x16x32_bf16 v[120:123], a[132:135], v[180:183], v[120:123]
  s_waitcnt lgkmcnt(0)
  v_exp_f32 v71, v71
  v_mfma_f32_16x16x32_bf16 v[120:123], a[128:131], v[176:179], v[120:123]
  v_cvt_pk_bf16_f32 v67, v70, v71
  v_mfma_f32_16x16x32_bf16 v[100:103], a[144:147], v[128:131], v[192:195]
  v_exp_f32 v76, v76
  v_mfma_f32_16x16x32_bf16 v[100:103], a[148:151], v[132:135], v[100:103]
  ds_read_b64_tr_b16 a[160:161], v216 offset:32768
  v_mfma_f32_16x16x32_bf16 v[100:103], a[152:155], v[136:139], v[100:103]
  v_exp_f32 v77, v77
  v_mfma_f32_16x16x32_bf16 v[100:103], a[156:159], v[140:143], v[100:103]
  ds_read_b64_tr_b16 a[162:163], v216 offset:36864
  v_cvt_pk_bf16_f32 v74, v76, v77
  v_mfma_f32_16x16x32_bf16 v[108:111], a[156:159], v[156:159], v[196:199]
  v_exp_f32 v78, v78
  v_mfma_f32_16x16x32_bf16 v[108:111], a[152:155], v[152:155], v[108:111]
  ds_read_b64_tr_b16 a[164:165], v216 offset:40960
  buffer_load_dwordx4 v252, s[24:27], s9 offen offset:3072 sc1 lds
  v_mfma_f32_16x16x32_bf16 v[108:111], a[148:151], v[148:151], v[108:111]
  v_exp_f32 v79, v79
  v_mfma_f32_16x16x32_bf16 v[108:111], a[144:147], v[144:147], v[108:111]
  ds_read_b64_tr_b16 a[166:167], v216 offset:45056
  v_cvt_pk_bf16_f32 v75, v78, v79
  v_mfma_f32_16x16x32_bf16 v[116:119], a[144:147], v[160:163], v[200:203]
  v_exp_f32 v84, v84
  v_mfma_f32_16x16x32_bf16 v[116:119], a[148:151], v[164:167], v[116:119]
  ds_read_b64_tr_b16 a[168:169], v217 offset:32768
  buffer_load_dwordx4 a[236:239], v252, s[24:27], s4 offen offset:2048 sc1
  v_mfma_f32_16x16x32_bf16 v[116:119], a[152:155], v[168:171], v[116:119]
  v_exp_f32 v85, v85
  v_mfma_f32_16x16x32_bf16 v[116:119], a[156:159], v[172:175], v[116:119]
  ds_read_b64_tr_b16 a[170:171], v217 offset:36864
  v_cvt_pk_bf16_f32 v82, v84, v85
  v_mfma_f32_16x16x32_bf16 v[124:127], a[156:159], v[188:191], v[204:207]
  v_exp_f32 v86, v86
  v_mfma_f32_16x16x32_bf16 v[124:127], a[152:155], v[184:187], v[124:127]
  ds_read_b64_tr_b16 a[172:173], v217 offset:40960
  v_mfma_f32_16x16x32_bf16 v[124:127], a[148:151], v[180:183], v[124:127]
  v_exp_f32 v87, v87
  v_mfma_f32_16x16x32_bf16 v[124:127], a[144:147], v[176:179], v[124:127]
  ds_read_b64_tr_b16 a[174:175], v217 offset:45056
  v_cvt_pk_bf16_f32 v83, v86, v87
  v_mfma_f32_16x16x32_bf16 a[192:195], a[208:211], v[0:3], a[192:195]
  v_exp_f32 v92, v92
  v_mfma_f32_16x16x32_bf16 a[192:195], a[208:211], v[32:35], a[192:195]
  ds_read_b64_tr_b16 a[176:177], v218 offset:32768
  buffer_load_dwordx4 a[240:243], v252, s[24:27], s4 offen offset:3072 sc1
  v_mfma_f32_16x16x32_bf16 a[196:199], a[208:211], v[8:11], a[196:199]
  v_exp_f32 v93, v93
  v_mfma_f32_16x16x32_bf16 a[196:199], a[208:211], v[40:43], a[196:199]
  ds_read_b64_tr_b16 a[178:179], v218 offset:36864
  v_cvt_pk_bf16_f32 v90, v92, v93
  v_mfma_f32_16x16x32_bf16 a[200:203], a[208:211], v[16:19], a[200:203]
  v_exp_f32 v94, v94
  v_mfma_f32_16x16x32_bf16 a[200:203], a[208:211], v[48:51], a[200:203]
  ds_read_b64_tr_b16 a[180:181], v218 offset:40960
  v_mfma_f32_16x16x32_bf16 a[204:207], a[208:211], v[24:27], a[204:207]
  s_waitcnt lgkmcnt(7)
  v_exp_f32 v95, v95
  v_mfma_f32_16x16x32_bf16 a[204:207], a[208:211], v[56:59], a[204:207]
  ds_read_b64_tr_b16 a[182:183], v218 offset:45056
  v_cvt_pk_bf16_f32 v91, v94, v95
  v_mfma_f32_16x16x32_bf16 a[0:3], a[160:163], v[0:3], a[0:3]
  v_exp_f32 v96, v96
  v_mfma_f32_16x16x32_bf16 a[0:3], a[164:167], v[32:35], a[0:3]
  ds_read_b64_tr_b16 a[184:185], v219 offset:32768
  buffer_load_dwordx4 a[244:247], v253, s[24:27], s4 offen offset:0 sc1
  v_mfma_f32_16x16x32_bf16 a[4:7], a[164:167], v[40:43], a[4:7]
  v_exp_f32 v97, v97
  v_mfma_f32_16x16x32_bf16 a[4:7], a[160:163], v[8:11], a[4:7]
  ds_read_b64_tr_b16 a[186:187], v219 offset:36864
  v_cvt_pk_bf16_f32 v96, v96, v97
  v_mfma_f32_16x16x32_bf16 a[8:11], a[160:163], v[16:19], a[8:11]
  v_exp_f32 v98, v98
  v_mfma_f32_16x16x32_bf16 a[8:11], a[164:167], v[48:51], a[8:11]
  ds_read_b64_tr_b16 a[188:189], v219 offset:40960
  v_mfma_f32_16x16x32_bf16 a[12:15], a[164:167], v[56:59], a[12:15]
  s_waitcnt lgkmcnt(7)
  v_exp_f32 v99, v99
  v_mfma_f32_16x16x32_bf16 a[12:15], a[160:163], v[24:27], a[12:15]
  ds_read_b64_tr_b16 a[190:191], v219 offset:45056
  v_cvt_pk_bf16_f32 v97, v98, v99
  v_mfma_f32_16x16x32_bf16 a[16:19], a[168:171], v[0:3], a[16:19]
  v_exp_f32 v104, v104
  v_mfma_f32_16x16x32_bf16 a[16:19], a[172:175], v[32:35], a[16:19]
  ds_read_b64_tr_b16 a[160:161], v220 offset:32768
  buffer_load_dwordx4 a[248:251], v253, s[24:27], s4 offen offset:1024 sc1
  v_mfma_f32_16x16x32_bf16 a[20:23], a[172:175], v[40:43], a[20:23]
  v_exp_f32 v105, v105
  v_mfma_f32_16x16x32_bf16 a[20:23], a[168:171], v[8:11], a[20:23]
  ds_read_b64_tr_b16 a[162:163], v220 offset:36864
  v_cvt_pk_bf16_f32 v104, v104, v105
  v_mfma_f32_16x16x32_bf16 a[24:27], a[168:171], v[16:19], a[24:27]
  v_exp_f32 v106, v106
  v_mfma_f32_16x16x32_bf16 a[24:27], a[172:175], v[48:51], a[24:27]
  ds_read_b64_tr_b16 a[164:165], v220 offset:40960
  v_mfma_f32_16x16x32_bf16 a[28:31], a[172:175], v[56:59], a[28:31]
  s_waitcnt lgkmcnt(7)
  v_exp_f32 v107, v107
  v_mfma_f32_16x16x32_bf16 a[28:31], a[168:171], v[24:27], a[28:31]
  ds_read_b64_tr_b16 a[166:167], v220 offset:45056
  v_cvt_pk_bf16_f32 v105, v106, v107
  v_mfma_f32_16x16x32_bf16 a[32:35], a[176:179], v[0:3], a[32:35]
  v_exp_f32 v112, v112
  v_mfma_f32_16x16x32_bf16 a[32:35], a[180:183], v[32:35], a[32:35]
  ds_read_b64_tr_b16 a[168:169], v221 offset:32768
  buffer_load_dwordx4 a[252:255], v253, s[24:27], s4 offen offset:2048 sc1
  v_mfma_f32_16x16x32_bf16 a[36:39], a[180:183], v[40:43], a[36:39]
  v_exp_f32 v113, v113
  v_mfma_f32_16x16x32_bf16 a[36:39], a[176:179], v[8:11], a[36:39]
  ds_read_b64_tr_b16 a[170:171], v221 offset:36864
  v_cvt_pk_bf16_f32 v112, v112, v113
  v_mfma_f32_16x16x32_bf16 a[40:43], a[176:179], v[16:19], a[40:43]
  v_exp_f32 v114, v114
  v_mfma_f32_16x16x32_bf16 a[40:43], a[180:183], v[48:51], a[40:43]
  ds_read_b64_tr_b16 a[172:173], v221 offset:40960
  v_mfma_f32_16x16x32_bf16 a[44:47], a[180:183], v[56:59], a[44:47]
  s_waitcnt lgkmcnt(7)
  v_exp_f32 v115, v115
  v_mfma_f32_16x16x32_bf16 a[44:47], a[176:179], v[24:27], a[44:47]
  ds_read_b64_tr_b16 a[174:175], v221 offset:45056
  v_cvt_pk_bf16_f32 v113, v114, v115
  v_mfma_f32_16x16x32_bf16 a[48:51], a[184:187], v[0:3], a[48:51]
  v_exp_f32 v120, v120
  v_mfma_f32_16x16x32_bf16 a[48:51], a[188:191], v[32:35], a[48:51]
  ds_read_b64_tr_b16 a[176:177], v222 offset:32768
  v_mfma_f32_16x16x32_bf16 a[52:55], a[188:191], v[40:43], a[52:55]
  v_exp_f32 v121, v121
  v_mfma_f32_16x16x32_bf16 a[52:55], a[184:187], v[8:11], a[52:55]
  ds_read_b64_tr_b16 a[178:179], v222 offset:36864
  v_cvt_pk_bf16_f32 v120, v120, v121
  v_mfma_f32_16x16x32_bf16 a[56:59], a[184:187], v[16:19], a[56:59]
  v_exp_f32 v122, v122
  v_mfma_f32_16x16x32_bf16 a[56:59], a[188:191], v[48:51], a[56:59]
  ds_read_b64_tr_b16 a[180:181], v222 offset:40960
  v_mfma_f32_16x16x32_bf16 a[60:63], a[188:191], v[56:59], a[60:63]
  s_waitcnt lgkmcnt(7)
  v_exp_f32 v123, v123
  v_mfma_f32_16x16x32_bf16 a[60:63], a[184:187], v[24:27], a[60:63]
  ds_read_b64_tr_b16 a[182:183], v222 offset:45056
  v_cvt_pk_bf16_f32 v121, v122, v123
  v_mfma_f32_16x16x32_bf16 a[64:67], a[160:163], v[0:3], a[64:67]
  v_exp_f32 v100, v100
  v_mfma_f32_16x16x32_bf16 a[64:67], a[164:167], v[32:35], a[64:67]
  ds_read_b64_tr_b16 a[184:185], v223 offset:32768
  v_mfma_f32_16x16x32_bf16 a[68:71], a[164:167], v[40:43], a[68:71]
  v_exp_f32 v101, v101
  v_mfma_f32_16x16x32_bf16 a[68:71], a[160:163], v[8:11], a[68:71]
  ds_read_b64_tr_b16 a[186:187], v223 offset:36864
  v_cvt_pk_bf16_f32 v98, v100, v101
  v_mfma_f32_16x16x32_bf16 a[72:75], a[160:163], v[16:19], a[72:75]
  v_exp_f32 v102, v102
  v_mfma_f32_16x16x32_bf16 a[72:75], a[164:167], v[48:51], a[72:75]
  ds_read_b64_tr_b16 a[188:189], v223 offset:40960
  v_mfma_f32_16x16x32_bf16 a[76:79], a[164:167], v[56:59], a[76:79]
  s_waitcnt lgkmcnt(7)
  v_exp_f32 v103, v103
  v_mfma_f32_16x16x32_bf16 a[76:79], a[160:163], v[24:27], a[76:79]
  ds_read_b64_tr_b16 a[190:191], v223 offset:45056
  v_cvt_pk_bf16_f32 v99, v102, v103
  v_mfma_f32_16x16x32_bf16 a[80:83], a[168:171], v[0:3], a[80:83]
  s_waitcnt vmcnt(19)
  v_exp_f32 v108, v108
  v_mfma_f32_16x16x32_bf16 a[80:83], a[172:175], v[32:35], a[80:83]
  v_mfma_f32_16x16x32_bf16 a[84:87], a[172:175], v[40:43], a[84:87]
  s_barrier
  v_exp_f32 v109, v109
  v_mfma_f32_16x16x32_bf16 a[84:87], a[168:171], v[8:11], a[84:87]
  s_mul_i32 s39, s99, 13108
  s_lshr_b32 s39, s39, 16
  s_lshl_b32 s39, s39, 8
  v_cvt_pk_bf16_f32 v106, v108, v109
  v_mfma_f32_16x16x32_bf16 a[88:91], a[168:171], v[16:19], a[88:91]
  s_add_u32 s39, s39, 2822400
  s_cmp_lt_u32 s2, 240
  s_cselect_b32 s48, 0, 1073741824
  v_exp_f32 v110, v110
  v_mfma_f32_16x16x32_bf16 a[88:91], a[172:175], v[48:51], a[88:91]
  v_or_b32 v249, s48, v251
  v_mfma_f32_16x16x32_bf16 a[92:95], a[172:175], v[56:59], a[92:95]
  s_waitcnt lgkmcnt(4)
  v_exp_f32 v111, v111
  v_mfma_f32_16x16x32_bf16 a[92:95], a[168:171], v[24:27], a[92:95]
  buffer_atomic_add v250, v249, s[24:27], s39 offen
  v_cvt_pk_bf16_f32 v107, v110, v111
  v_mfma_f32_16x16x32_bf16 a[96:99], a[176:179], v[0:3], a[96:99]
  v_exp_f32 v116, v116
  v_mfma_f32_16x16x32_bf16 a[96:99], a[180:183], v[32:35], a[96:99]
  v_mfma_f32_16x16x32_bf16 a[100:103], a[180:183], v[40:43], a[100:103]
  v_exp_f32 v117, v117
  v_mfma_f32_16x16x32_bf16 a[100:103], a[176:179], v[8:11], a[100:103]
  v_cvt_pk_bf16_f32 v114, v116, v117
  v_mfma_f32_16x16x32_bf16 a[104:107], a[176:179], v[16:19], a[104:107]
  v_exp_f32 v118, v118
  v_mfma_f32_16x16x32_bf16 a[104:107], a[180:183], v[48:51], a[104:107]
  v_mfma_f32_16x16x32_bf16 a[108:111], a[180:183], v[56:59], a[108:111]
  s_waitcnt lgkmcnt(0)
  v_exp_f32 v119, v119
  v_mfma_f32_16x16x32_bf16 a[108:111], a[176:179], v[24:27], a[108:111]
  v_cvt_pk_bf16_f32 v115, v118, v119
  v_mfma_f32_16x16x32_bf16 a[112:115], a[184:187], v[0:3], a[112:115]
  v_exp_f32 v124, v124
  v_mfma_f32_16x16x32_bf16 a[112:115], a[188:191], v[32:35], a[112:115]
  v_mfma_f32_16x16x32_bf16 a[116:119], a[188:191], v[40:43], a[116:119]
  v_exp_f32 v125, v125
  v_mfma_f32_16x16x32_bf16 a[116:119], a[184:187], v[8:11], a[116:119]
  v_cvt_pk_bf16_f32 v122, v124, v125
  v_mfma_f32_16x16x32_bf16 a[120:123], a[184:187], v[16:19], a[120:123]
  v_exp_f32 v126, v126
  v_mfma_f32_16x16x32_bf16 a[120:123], a[188:191], v[48:51], a[120:123]
  v_mfma_f32_16x16x32_bf16 a[124:127], a[188:191], v[56:59], a[124:127]
  v_exp_f32 v127, v127
  v_mfma_f32_16x16x32_bf16 a[124:127], a[184:187], v[24:27], a[124:127]
  v_cvt_pk_bf16_f32 v123, v126, v127
  ds_read_b64_tr_b16 a[160:161], v216 offset:49152
  ds_read_b64_tr_b16 a[162:163], v216 offset:53248
  ds_read_b64_tr_b16 a[164:165], v216 offset:57344
  ds_read_b64_tr_b16 a[166:167], v216 offset:61440
  ds_read_b64_tr_b16 a[168:169], v217 offset:49152
  ds_read_b64_tr_b16 a[170:171], v217 offset:53248
  ds_read_b64_tr_b16 a[172:173], v217 offset:57344
  ds_read_b64_tr_b16 a[174:175], v217 offset:61440
  s_mov_b32 s48, 0x5d800000
  s_lshl_b32 s39, s3, 8
  v_mfma_f32_16x16x32_bf16 a[192:195], a[208:211], v[64:67], a[192:195]
  s_add_u32 m0, s28, 81920
  v_mfma_f32_16x16x32_bf16 a[192:195], a[208:211], v[96:99], a[192:195]
  v_mfma_f32_16x16x32_bf16 a[196:199], a[208:211], v[72:75], a[196:199]
  buffer_load_dwordx4 v242, s[24:27], s10 offen offset:0 sc1 lds
  v_mfma_f32_16x16x32_bf16 a[196:199], a[208:211], v[104:107], a[196:199]
  v_mfma_f32_16x16x32_bf16 a[200:203], a[208:211], v[80:83], a[200:203]
  buffer_load_dwordx4 v242, s[24:27], s10 offen offset:1024 sc1 lds
  v_mfma_f32_16x16x32_bf16 a[200:203], a[208:211], v[112:115], a[200:203]
  v_mfma_f32_16x16x32_bf16 a[204:207], a[208:211], v[88:91], a[204:207]
  buffer_load_dwordx4 v242, s[24:27], s10 offen offset:2048 sc1 lds
  v_mfma_f32_16x16x32_bf16 a[204:207], a[208:211], v[120:123], a[204:207]
  s_waitcnt lgkmcnt(4)
  v_mfma_f32_16x16x32_bf16 a[0:3], a[160:163], v[64:67], a[0:3]
  buffer_load_dwordx4 v242, s[24:27], s10 offen offset:3072 sc1 lds
  v_mfma_f32_16x16x32_bf16 a[0:3], a[164:167], v[96:99], a[0:3]
  ds_read_b64_tr_b16 a[176:177], v218 offset:49152
  v_mfma_f32_16x16x32_bf16 a[4:7], a[164:167], v[104:107], a[4:7]
  buffer_load_dwordx4 a[128:131], v253, s[24:27], s4 offen offset:3072 sc1
  v_mfma_f32_16x16x32_bf16 a[4:7], a[160:163], v[72:75], a[4:7]
  ds_read_b64_tr_b16 a[178:179], v218 offset:53248
  v_accvgpr_read_b32 v208, a192
  v_mfma_f32_16x16x32_bf16 a[8:11], a[160:163], v[80:83], a[8:11]
  v_accvgpr_read_b32 v209, a196
  v_accvgpr_read_b32 v210, a200
  v_mfma_f32_16x16x32_bf16 a[8:11], a[164:167], v[112:115], a[8:11]
  ds_read_b64_tr_b16 a[180:181], v218 offset:57344
  v_accvgpr_read_b32 v211, a204
  v_mfma_f32_16x16x32_bf16 a[12:15], a[164:167], v[120:123], a[12:15]
  v_mov_b32 v245, v208
  v_mov_b32 v246, v209
  v_mfma_f32_16x16x32_bf16 a[12:15], a[160:163], v[88:91], a[12:15]
  ds_read_b64_tr_b16 a[182:183], v218 offset:61440
  s_waitcnt lgkmcnt(4)
  v_mov_b32 v247, v210
  v_mfma_f32_16x16x32_bf16 a[16:19], a[168:171], v[64:67], a[16:19]
  v_mov_b32 v248, v211
  v_permlane16_swap_b32 v208, v245
  v_mfma_f32_16x16x32_bf16 a[16:19], a[172:175], v[96:99], a[16:19]
  ds_read_b64_tr_b16 a[184:185], v219 offset:49152
  v_permlane16_swap_b32 v209, v246
  v_mfma_f32_16x16x32_bf16 a[20:23], a[172:175], v[104:107], a[20:23]
  v_permlane16_swap_b32 v210, v247
  v_permlane16_swap_b32 v211, v248
  v_mfma_f32_16x16x32_bf16 a[20:23], a[168:171], v[72:75], a[20:23]
  ds_read_b64_tr_b16 a[186:187], v219 offset:53248
  v_add_f32 v208, v208, v245
  v_mfma_f32_16x16x32_bf16 a[24:27], a[168:171], v[80:83], a[24:27]
  v_add_f32 v209, v209, v246
  v_add_f32 v210, v210, v247
  v_mfma_f32_16x16x32_bf16 a[24:27], a[172:175], v[112:115], a[24:27]
  ds_read_b64_tr_b16 a[188:189], v219 offset:57344
  v_add_f32 v211, v211, v248
  v_mfma_f32_16x16x32_bf16 a[28:31], a[172:175], v[120:123], a[28:31]
  v_mov_b32 v245, v208
  v_mov_b32 v246, v209
  v_mfma_f32_16x16x32_bf16 a[28:31], a[168:171], v[88:91], a[28:31]
  ds_read_b64_tr_b16 a[190:191], v219 offset:61440
  s_waitcnt lgkmcnt(4)
  v_mov_b32 v247, v210
  v_mfma_f32_16x16x32_bf16 a[32:35], a[176:179], v[64:67], a[32:35]
  v_mov_b32 v248, v211
  v_permlane32_swap_b32 v208, v245
  v_mfma_f32_16x16x32_bf16 a[32:35], a[180:183], v[96:99], a[32:35]
  ds_read_b64_tr_b16 a[160:161], v220 offset:49152
  v_permlane32_swap_b32 v209, v246
  v_mfma_f32_16x16x32_bf16 a[36:39], a[180:183], v[104:107], a[36:39]
  v_permlane32_swap_b32 v210, v247
  v_permlane32_swap_b32 v211, v248
  v_mfma_f32_16x16x32_bf16 a[36:39], a[176:179], v[72:75], a[36:39]
  ds_read_b64_tr_b16 a[162:163], v220 offset:53248
  v_add_f32 v208, v208, v245
  v_mfma_f32_16x16x32_bf16 a[40:43], a[176:179], v[80:83], a[40:43]
  v_add_f32 v209, v209, v246
  v_add_f32 v210, v210, v247
  v_mfma_f32_16x16x32_bf16 a[40:43], a[180:183], v[112:115], a[40:43]
  ds_read_b64_tr_b16 a[164:165], v220 offset:57344
  v_add_f32 v211, v211, v248
  buffer_load_dwordx4 a[132:135], v242, s[24:27], s5 offen offset:0 sc1
  buffer_load_dwordx4 a[136:139], v242, s[24:27], s5 offen offset:1024 sc1
  buffer_load_dwordx4 a[140:143], v242, s[24:27], s5 offen offset:2048 sc1
  buffer_load_dwordx4 a[144:147], v242, s[24:27], s5 offen offset:3072 sc1
  buffer_load_dwordx4 a[148:151], v252, s[24:27], s5 offen offset:0 sc1
  buffer_load_dwordx4 a[152:155], v252, s[24:27], s5 offen offset:1024 sc1
  buffer_load_dwordx4 a[156:159], v252, s[24:27], s5 offen offset:2048 sc1
  v_mfma_f32_16x16x32_bf16 a[44:47], a[180:183], v[120:123], a[44:47]
  v_rcp_f32 v192, v208
  v_mfma_f32_16x16x32_bf16 a[44:47], a[176:179], v[88:91], a[44:47]
  ds_read_b64_tr_b16 a[166:167], v220 offset:61440
  s_waitcnt lgkmcnt(4)
  v_mfma_f32_16x16x32_bf16 a[48:51], a[184:187], v[64:67], a[48:51]
  v_rcp_f32 v196, v209
  v_mfma_f32_16x16x32_bf16 a[48:51], a[188:191], v[96:99], a[48:51]
  ds_read_b64_tr_b16 a[168:169], v221 offset:49152
  v_mfma_f32_16x16x32_bf16 a[52:55], a[188:191], v[104:107], a[52:55]
  v_rcp_f32 v200, v210
  v_mfma_f32_16x16x32_bf16 a[52:55], a[184:187], v[72:75], a[52:55]
  ds_read_b64_tr_b16 a[170:171], v221 offset:53248
  v_mfma_f32_16x16x32_bf16 a[56:59], a[184:187], v[80:83], a[56:59]
  v_rcp_f32 v204, v211
  v_mfma_f32_16x16x32_bf16 a[56:59], a[188:191], v[112:115], a[56:59]
  ds_read_b64_tr_b16 a[172:173], v221 offset:57344
  v_add_f32 v246, v208, v209
  v_mfma_f32_16x16x32_bf16 a[60:63], a[188:191], v[120:123], a[60:63]
  v_add_f32 v247, v210, v211
  v_add_f32 v246, v246, v247
  v_mfma_f32_16x16x32_bf16 a[60:63], a[184:187], v[88:91], a[60:63]
  ds_read_b64_tr_b16 a[174:175], v221 offset:61440
  s_waitcnt lgkmcnt(4)
  v_lshrrev_b32 v247, 2, v242
  v_mfma_f32_16x16x32_bf16 a[64:67], a[160:163], v[64:67], a[64:67]
  v_cmp_nlt_f32 vcc, v246, s48
  v_add_u32 v247, s39, v247
  v_mfma_f32_16x16x32_bf16 a[64:67], a[164:167], v[96:99], a[64:67]
  ds_read_b64_tr_b16 a[176:177], v222 offset:49152
  v_add_u32 v247, 157696, v247
  v_mfma_f32_16x16x32_bf16 a[68:71], a[164:167], v[104:107], a[68:71]
  v_cndmask_b32_e64 v245, 0, 1, vcc
  v_accvgpr_read_b32 v0, a0
  v_mfma_f32_16x16x32_bf16 a[68:71], a[160:163], v[72:75], a[68:71]
  ds_read_b64_tr_b16 a[178:179], v222 offset:53248
  v_accvgpr_read_b32 v1, a1
  v_mfma_f32_16x16x32_bf16 a[72:75], a[160:163], v[80:83], a[72:75]
  v_accvgpr_read_b32 v2, a2
  v_accvgpr_read_b32 v3, a3
  v_mfma_f32_16x16x32_bf16 a[72:75], a[164:167], v[112:115], a[72:75]
  ds_read_b64_tr_b16 a[180:181], v222 offset:57344
  v_accvgpr_read_b32 v4, a16
  v_mfma_f32_16x16x32_bf16 a[76:79], a[164:167], v[120:123], a[76:79]
  v_accvgpr_read_b32 v5, a17
  v_accvgpr_read_b32 v6, a18
  v_mfma_f32_16x16x32_bf16 a[76:79], a[160:163], v[88:91], a[76:79]
  ds_read_b64_tr_b16 a[182:183], v222 offset:61440
  s_waitcnt lgkmcnt(4)
  v_accvgpr_read_b32 v7, a19
  v_mfma_f32_16x16x32_bf16 a[80:83], a[168:171], v[64:67], a[80:83]
  v_mul_f32 v0, v0, v192
  v_mul_f32 v1, v1, v192
  v_mfma_f32_16x16x32_bf16 a[80:83], a[172:175], v[96:99], a[80:83]
  ds_read_b64_tr_b16 a[184:185], v223 offset:49152
  v_mul_f32 v2, v2, v192
  v_mfma_f32_16x16x32_bf16 a[84:87], a[172:175], v[104:107], a[84:87]
  v_mul_f32 v3, v3, v192
  v_mul_f32 v4, v4, v192
  v_mfma_f32_16x16x32_bf16 a[84:87], a[168:171], v[72:75], a[84:87]
  ds_read_b64_tr_b16 a[186:187], v223 offset:53248
  v_mul_f32 v5, v5, v192
  v_mfma_f32_16x16x32_bf16 a[88:91], a[168:171], v[80:83], a[88:91]
  v_mul_f32 v6, v6, v192
  v_mul_f32 v7, v7, v192
  v_mfma_f32_16x16x32_bf16 a[88:91], a[172:175], v[112:115], a[88:91]
  ds_read_b64_tr_b16 a[188:189], v223 offset:57344
  v_cvt_pk_bf16_f32 v0, v0, v1
  v_mfma_f32_16x16x32_bf16 a[92:95], a[172:175], v[120:123], a[92:95]
  v_cvt_pk_bf16_f32 v1, v2, v3
  v_cvt_pk_bf16_f32 v2, v4, v5
  v_mfma_f32_16x16x32_bf16 a[92:95], a[168:171], v[88:91], a[92:95]
  ds_read_b64_tr_b16 a[190:191], v223 offset:61440
  s_waitcnt lgkmcnt(4)
  v_cvt_pk_bf16_f32 v3, v6, v7
  v_mfma_f32_16x16x32_bf16 a[96:99], a[176:179], v[64:67], a[96:99]
  buffer_store_dwordx4 v[0:3], v244, s[24:27], s40 offen offset:0 sc1
  v_mfma_f32_16x16x32_bf16 a[96:99], a[180:183], v[96:99], a[96:99]
  v_accvgpr_read_b32 v8, a4
  v_accvgpr_read_b32 v9, a5
  v_mfma_f32_16x16x32_bf16 a[100:103], a[180:183], v[104:107], a[100:103]
  v_accvgpr_read_b32 v10, a6
  v_accvgpr_read_b32 v11, a7
  v_mfma_f32_16x16x32_bf16 a[100:103], a[176:179], v[72:75], a[100:103]
  v_accvgpr_read_b32 v12, a20
  v_accvgpr_read_b32 v13, a21
  v_mfma_f32_16x16x32_bf16 a[104:107], a[176:179], v[80:83], a[104:107]
  v_accvgpr_read_b32 v14, a22
  v_accvgpr_read_b32 v15, a23
  v_mfma_f32_16x16x32_bf16 a[104:107], a[180:183], v[112:115], a[104:107]
  v_mul_f32 v8, v8, v196
  v_mul_f32 v9, v9, v196
  v_mfma_f32_16x16x32_bf16 a[108:111], a[180:183], v[120:123], a[108:111]
  v_mul_f32 v10, v10, v196
  v_mul_f32 v11, v11, v196
  v_mfma_f32_16x16x32_bf16 a[108:111], a[176:179], v[88:91], a[108:111]
  s_waitcnt lgkmcnt(0)
  v_mul_f32 v12, v12, v196
  v_mul_f32 v13, v13, v196
  v_mfma_f32_16x16x32_bf16 a[112:115], a[184:187], v[64:67], a[112:115]
  v_mul_f32 v14, v14, v196
  v_mul_f32 v15, v15, v196
  v_mfma_f32_16x16x32_bf16 a[112:115], a[188:191], v[96:99], a[112:115]
  v_cvt_pk_bf16_f32 v8, v8, v9
  v_cvt_pk_bf16_f32 v9, v10, v11
  v_mfma_f32_16x16x32_bf16 a[116:119], a[188:191], v[104:107], a[116:119]
  v_cvt_pk_bf16_f32 v10, v12, v13
  v_cvt_pk_bf16_f32 v11, v14, v15
  v_mfma_f32_16x16x32_bf16 a[116:119], a[184:187], v[72:75], a[116:119]
  buffer_store_dwordx4 v[8:11], v244, s[24:27], s40 offen offset:2048 sc1
  v_mfma_f32_16x16x32_bf16 a[120:123], a[184:187], v[80:83], a[120:123]
  v_accvgpr_read_b32 v16, a8
  v_accvgpr_read_b32 v17, a9
  v_mfma_f32_16x16x32_bf16 a[120:123], a[188:191], v[112:115], a[120:123]
  v_accvgpr_read_b32 v18, a10
  v_accvgpr_read_b32 v19, a11
  v_mfma_f32_16x16x32_bf16 a[124:127], a[188:191], v[120:123], a[124:127]
  v_accvgpr_read_b32 v20, a24
  v_accvgpr_read_b32 v21, a25
  v_mfma_f32_16x16x32_bf16 a[124:127], a[184:187], v[88:91], a[124:127]
  v_accvgpr_read_b32 v22, a26
  v_accvgpr_read_b32 v23, a27
  v_pk_mul_f32 v[16:17], v[16:17], v[200:201] op_sel_hi:[1,0]
  v_pk_mul_f32 v[18:19], v[18:19], v[200:201] op_sel_hi:[1,0]
  v_pk_mul_f32 v[20:21], v[20:21], v[200:201] op_sel_hi:[1,0]
  v_pk_mul_f32 v[22:23], v[22:23], v[200:201] op_sel_hi:[1,0]
  v_cvt_pk_bf16_f32 v16, v16, v17
  v_cvt_pk_bf16_f32 v17, v18, v19
  v_cvt_pk_bf16_f32 v18, v20, v21
  v_cvt_pk_bf16_f32 v19, v22, v23
  buffer_store_dwordx4 v[16:19], v244, s[24:27], s41 offen offset:0 sc1
  v_accvgpr_read_b32 v24, a12
  v_accvgpr_read_b32 v25, a13
  v_accvgpr_read_b32 v26, a14
  v_accvgpr_read_b32 v27, a15
  v_accvgpr_read_b32 v28, a28
  v_accvgpr_read_b32 v29, a29
  v_accvgpr_read_b32 v30, a30
  v_accvgpr_read_b32 v31, a31
  v_pk_mul_f32 v[24:25], v[24:25], v[204:205] op_sel_hi:[1,0]
  v_pk_mul_f32 v[26:27], v[26:27], v[204:205] op_sel_hi:[1,0]
  v_pk_mul_f32 v[28:29], v[28:29], v[204:205] op_sel_hi:[1,0]
  v_pk_mul_f32 v[30:31], v[30:31], v[204:205] op_sel_hi:[1,0]
  v_cvt_pk_bf16_f32 v24, v24, v25
  v_cvt_pk_bf16_f32 v25, v26, v27
  v_cvt_pk_bf16_f32 v26, v28, v29
  v_cvt_pk_bf16_f32 v27, v30, v31
  buffer_store_dwordx4 v[24:27], v244, s[24:27], s41 offen offset:2048 sc1
  v_accvgpr_read_b32 v32, a32
  v_accvgpr_read_b32 v33, a33
  v_accvgpr_read_b32 v34, a34
  v_accvgpr_read_b32 v35, a35
  v_accvgpr_read_b32 v36, a48
  v_accvgpr_read_b32 v37, a49
  v_accvgpr_read_b32 v38, a50
  v_accvgpr_read_b32 v39, a51
  v_pk_mul_f32 v[32:33], v[32:33], v[192:193] op_sel_hi:[1,0]
  v_pk_mul_f32 v[34:35], v[34:35], v[192:193] op_sel_hi:[1,0]
  v_pk_mul_f32 v[36:37], v[36:37], v[192:193] op_sel_hi:[1,0]
  v_pk_mul_f32 v[38:39], v[38:39], v[192:193] op_sel_hi:[1,0]
  v_cvt_pk_bf16_f32 v32, v32, v33
  v_cvt_pk_bf16_f32 v33, v34, v35
  v_cvt_pk_bf16_f32 v34, v36, v37
  v_cvt_pk_bf16_f32 v35, v38, v39
  buffer_store_dwordx4 v[32:35], v244, s[24:27], s40 offen offset:1024 sc1
  v_accvgpr_read_b32 v40, a36
  v_accvgpr_read_b32 v41, a37
  v_accvgpr_read_b32 v42, a38
  v_accvgpr_read_b32 v43, a39
  v_accvgpr_read_b32 v44, a52
  v_accvgpr_read_b32 v45, a53
  v_accvgpr_read_b32 v46, a54
  v_accvgpr_read_b32 v47, a55
  v_pk_mul_f32 v[40:41], v[40:41], v[196:197] op_sel_hi:[1,0]
  v_pk_mul_f32 v[42:43], v[42:43], v[196:197] op_sel_hi:[1,0]
  v_pk_mul_f32 v[44:45], v[44:45], v[196:197] op_sel_hi:[1,0]
  v_pk_mul_f32 v[46:47], v[46:47], v[196:197] op_sel_hi:[1,0]
  v_cvt_pk_bf16_f32 v40, v40, v41
  v_cvt_pk_bf16_f32 v41, v42, v43
  v_cvt_pk_bf16_f32 v42, v44, v45
  v_cvt_pk_bf16_f32 v43, v46, v47
  buffer_store_dwordx4 v[40:43], v244, s[24:27], s40 offen offset:3072 sc1
  v_accvgpr_read_b32 v48, a40
  v_accvgpr_read_b32 v49, a41
  v_accvgpr_read_b32 v50, a42
  v_accvgpr_read_b32 v51, a43
  v_accvgpr_read_b32 v52, a56
  v_accvgpr_read_b32 v53, a57
  v_accvgpr_read_b32 v54, a58
  v_accvgpr_read_b32 v55, a59
  v_pk_mul_f32 v[48:49], v[48:49], v[200:201] op_sel_hi:[1,0]
  v_pk_mul_f32 v[50:51], v[50:51], v[200:201] op_sel_hi:[1,0]
  v_pk_mul_f32 v[52:53], v[52:53], v[200:201] op_sel_hi:[1,0]
  v_pk_mul_f32 v[54:55], v[54:55], v[200:201] op_sel_hi:[1,0]
  v_cvt_pk_bf16_f32 v48, v48, v49
  v_cvt_pk_bf16_f32 v49, v50, v51
  v_cvt_pk_bf16_f32 v50, v52, v53
  v_cvt_pk_bf16_f32 v51, v54, v55
  buffer_store_dwordx4 v[48:51], v244, s[24:27], s41 offen offset:1024 sc1
  v_accvgpr_read_b32 v56, a44
  v_accvgpr_read_b32 v57, a45
  v_accvgpr_read_b32 v58, a46
  v_accvgpr_read_b32 v59, a47
  v_accvgpr_read_b32 v60, a60
  v_accvgpr_read_b32 v61, a61
  v_accvgpr_read_b32 v62, a62
  v_accvgpr_read_b32 v63, a63
  v_pk_mul_f32 v[56:57], v[56:57], v[204:205] op_sel_hi:[1,0]
  v_pk_mul_f32 v[58:59], v[58:59], v[204:205] op_sel_hi:[1,0]
  v_pk_mul_f32 v[60:61], v[60:61], v[204:205] op_sel_hi:[1,0]
  v_pk_mul_f32 v[62:63], v[62:63], v[204:205] op_sel_hi:[1,0]
  v_cvt_pk_bf16_f32 v56, v56, v57
  v_cvt_pk_bf16_f32 v57, v58, v59
  v_cvt_pk_bf16_f32 v58, v60, v61
  v_cvt_pk_bf16_f32 v59, v62, v63
  buffer_store_dwordx4 v[56:59], v244, s[24:27], s41 offen offset:3072 sc1
  v_accvgpr_read_b32 v0, a64
  v_accvgpr_read_b32 v1, a65
  v_accvgpr_read_b32 v2, a66
  v_accvgpr_read_b32 v3, a67
  v_accvgpr_read_b32 v4, a80
  v_accvgpr_read_b32 v5, a81
  v_accvgpr_read_b32 v6, a82
  v_accvgpr_read_b32 v7, a83
  v_pk_mul_f32 v[0:1], v[0:1], v[192:193] op_sel_hi:[1,0]
  v_pk_mul_f32 v[2:3], v[2:3], v[192:193] op_sel_hi:[1,0]
  v_pk_mul_f32 v[4:5], v[4:5], v[192:193] op_sel_hi:[1,0]
  v_pk_mul_f32 v[6:7], v[6:7], v[192:193] op_sel_hi:[1,0]
  v_cvt_pk_bf16_f32 v0, v0, v1
  v_cvt_pk_bf16_f32 v1, v2, v3
  v_cvt_pk_bf16_f32 v2, v4, v5
  v_cvt_pk_bf16_f32 v3, v6, v7
  buffer_store_dwordx4 v[0:3], v244, s[24:27], s42 offen offset:0 sc1
  v_accvgpr_read_b32 v8, a68
  v_accvgpr_read_b32 v9, a69
  v_accvgpr_read_b32 v10, a70
  v_accvgpr_read_b32 v11, a71
  v_accvgpr_read_b32 v12, a84
  v_accvgpr_read_b32 v13, a85
  v_accvgpr_read_b32 v14, a86
  v_accvgpr_read_b32 v15, a87
  v_pk_mul_f32 v[8:9], v[8:9], v[196:197] op_sel_hi:[1,0]
  v_pk_mul_f32 v[10:11], v[10:11], v[196:197] op_sel_hi:[1,0]
  v_pk_mul_f32 v[12:13], v[12:13], v[196:197] op_sel_hi:[1,0]
  v_pk_mul_f32 v[14:15], v[14:15], v[196:197] op_sel_hi:[1,0]
  v_cvt_pk_bf16_f32 v8, v8, v9
  v_cvt_pk_bf16_f32 v9, v10, v11
  v_cvt_pk_bf16_f32 v10, v12, v13
  v_cvt_pk_bf16_f32 v11, v14, v15
  buffer_store_dwordx4 v[8:11], v244, s[24:27], s42 offen offset:2048 sc1
  v_accvgpr_read_b32 v16, a72
  v_accvgpr_read_b32 v17, a73
  v_accvgpr_read_b32 v18, a74
  v_accvgpr_read_b32 v19, a75
  v_accvgpr_read_b32 v20, a88
  v_accvgpr_read_b32 v21, a89
  v_accvgpr_read_b32 v22, a90
  v_accvgpr_read_b32 v23, a91
  v_pk_mul_f32 v[16:17], v[16:17], v[200:201] op_sel_hi:[1,0]
  v_pk_mul_f32 v[18:19], v[18:19], v[200:201] op_sel_hi:[1,0]
  v_pk_mul_f32 v[20:21], v[20:21], v[200:201] op_sel_hi:[1,0]
  v_pk_mul_f32 v[22:23], v[22:23], v[200:201] op_sel_hi:[1,0]
  v_cvt_pk_bf16_f32 v16, v16, v17
  v_cvt_pk_bf16_f32 v17, v18, v19
  v_cvt_pk_bf16_f32 v18, v20, v21
  v_cvt_pk_bf16_f32 v19, v22, v23
  buffer_store_dwordx4 v[16:19], v244, s[24:27], s43 offen offset:0 sc1
  v_accvgpr_read_b32 v24, a76
  v_accvgpr_read_b32 v25, a77
  v_accvgpr_read_b32 v26, a78
  v_accvgpr_read_b32 v27, a79
  v_accvgpr_read_b32 v28, a92
  v_accvgpr_read_b32 v29, a93
  v_accvgpr_read_b32 v30, a94
  v_accvgpr_read_b32 v31, a95
  v_pk_mul_f32 v[24:25], v[24:25], v[204:205] op_sel_hi:[1,0]
  v_pk_mul_f32 v[26:27], v[26:27], v[204:205] op_sel_hi:[1,0]
  v_pk_mul_f32 v[28:29], v[28:29], v[204:205] op_sel_hi:[1,0]
  v_pk_mul_f32 v[30:31], v[30:31], v[204:205] op_sel_hi:[1,0]
  v_cvt_pk_bf16_f32 v24, v24, v25
  v_cvt_pk_bf16_f32 v25, v26, v27
  v_cvt_pk_bf16_f32 v26, v28, v29
  v_cvt_pk_bf16_f32 v27, v30, v31
  buffer_store_dwordx4 v[24:27], v244, s[24:27], s43 offen offset:2048 sc1
  v_accvgpr_read_b32 v32, a96
  v_accvgpr_read_b32 v33, a97
  v_accvgpr_read_b32 v34, a98
  v_accvgpr_read_b32 v35, a99
  v_accvgpr_read_b32 v36, a112
  v_accvgpr_read_b32 v37, a113
  v_accvgpr_read_b32 v38, a114
  v_accvgpr_read_b32 v39, a115
  v_pk_mul_f32 v[32:33], v[32:33], v[192:193] op_sel_hi:[1,0]
  v_pk_mul_f32 v[34:35], v[34:35], v[192:193] op_sel_hi:[1,0]
  v_pk_mul_f32 v[36:37], v[36:37], v[192:193] op_sel_hi:[1,0]
  v_pk_mul_f32 v[38:39], v[38:39], v[192:193] op_sel_hi:[1,0]
  v_cvt_pk_bf16_f32 v32, v32, v33
  v_cvt_pk_bf16_f32 v33, v34, v35
  v_cvt_pk_bf16_f32 v34, v36, v37
  v_cvt_pk_bf16_f32 v35, v38, v39
  buffer_store_dwordx4 v[32:35], v244, s[24:27], s42 offen offset:1024 sc1
  v_accvgpr_read_b32 v40, a100
  v_accvgpr_read_b32 v41, a101
  v_accvgpr_read_b32 v42, a102
  v_accvgpr_read_b32 v43, a103
  v_accvgpr_read_b32 v44, a116
  v_accvgpr_read_b32 v45, a117
  v_accvgpr_read_b32 v46, a118
  v_accvgpr_read_b32 v47, a119
  v_pk_mul_f32 v[40:41], v[40:41], v[196:197] op_sel_hi:[1,0]
  v_pk_mul_f32 v[42:43], v[42:43], v[196:197] op_sel_hi:[1,0]
  v_pk_mul_f32 v[44:45], v[44:45], v[196:197] op_sel_hi:[1,0]
  v_pk_mul_f32 v[46:47], v[46:47], v[196:197] op_sel_hi:[1,0]
  v_cvt_pk_bf16_f32 v40, v40, v41
  v_cvt_pk_bf16_f32 v41, v42, v43
  v_cvt_pk_bf16_f32 v42, v44, v45
  v_cvt_pk_bf16_f32 v43, v46, v47
  buffer_store_dwordx4 v[40:43], v244, s[24:27], s42 offen offset:3072 sc1
  v_accvgpr_read_b32 v48, a104
  v_accvgpr_read_b32 v49, a105
  v_accvgpr_read_b32 v50, a106
  v_accvgpr_read_b32 v51, a107
  v_accvgpr_read_b32 v52, a120
  v_accvgpr_read_b32 v53, a121
  v_accvgpr_read_b32 v54, a122
  v_accvgpr_read_b32 v55, a123
  v_pk_mul_f32 v[48:49], v[48:49], v[200:201] op_sel_hi:[1,0]
  v_pk_mul_f32 v[50:51], v[50:51], v[200:201] op_sel_hi:[1,0]
  v_pk_mul_f32 v[52:53], v[52:53], v[200:201] op_sel_hi:[1,0]
  v_pk_mul_f32 v[54:55], v[54:55], v[200:201] op_sel_hi:[1,0]
  v_cvt_pk_bf16_f32 v48, v48, v49
  v_cvt_pk_bf16_f32 v49, v50, v51
  v_cvt_pk_bf16_f32 v50, v52, v53
  v_cvt_pk_bf16_f32 v51, v54, v55
  buffer_store_dwordx4 v[48:51], v244, s[24:27], s43 offen offset:1024 sc1
  v_accvgpr_read_b32 v56, a108
  v_accvgpr_read_b32 v57, a109
  v_accvgpr_read_b32 v58, a110
  v_accvgpr_read_b32 v59, a111
  v_accvgpr_read_b32 v60, a124
  v_accvgpr_read_b32 v61, a125
  v_accvgpr_read_b32 v62, a126
  v_accvgpr_read_b32 v63, a127
  v_pk_mul_f32 v[56:57], v[56:57], v[204:205] op_sel_hi:[1,0]
  v_pk_mul_f32 v[58:59], v[58:59], v[204:205] op_sel_hi:[1,0]
  v_pk_mul_f32 v[60:61], v[60:61], v[204:205] op_sel_hi:[1,0]
  v_pk_mul_f32 v[62:63], v[62:63], v[204:205] op_sel_hi:[1,0]
  v_cvt_pk_bf16_f32 v56, v56, v57
  v_cvt_pk_bf16_f32 v57, v58, v59
  v_cvt_pk_bf16_f32 v58, v60, v61
  v_cvt_pk_bf16_f32 v59, v62, v63
  buffer_store_dwordx4 v[56:59], v244, s[24:27], s43 offen offset:3072 sc1
  ds_write_b32 v247, v245
  buffer_load_dwordx4 a[0:3], v252, s[24:27], s5 offen offset:3072 sc1
  buffer_load_dwordx4 a[4:7], v253, s[24:27], s5 offen offset:0 sc1
  buffer_load_dwordx4 a[8:11], v253, s[24:27], s5 offen offset:1024 sc1
  buffer_load_dwordx4 a[12:15], v253, s[24:27], s5 offen offset:2048 sc1
  buffer_load_dwordx4 a[16:19], v253, s[24:27], s5 offen offset:3072 sc1
  buffer_load_dwordx4 a[20:23], v242, s[24:27], s6 offen offset:0 sc1
  buffer_load_dwordx4 a[24:27], v242, s[24:27], s6 offen offset:1024 sc1
  buffer_load_dwordx4 a[28:31], v242, s[24:27], s6 offen offset:2048 sc1
  buffer_load_dwordx4 a[32:35], v242, s[24:27], s6 offen offset:3072 sc1
  buffer_load_dwordx4 a[36:39], v252, s[24:27], s6 offen offset:0 sc1
  buffer_load_dwordx4 a[40:43], v252, s[24:27], s6 offen offset:1024 sc1
  buffer_load_dwordx4 a[44:47], v252, s[24:27], s6 offen offset:2048 sc1
  buffer_load_dwordx4 a[48:51], v252, s[24:27], s6 offen offset:3072 sc1
  buffer_load_dwordx4 a[52:55], v253, s[24:27], s6 offen offset:0 sc1
  s_bfe_u32 s39, s2, 0x40002
  s_lshl_b32 s39, s39, 8
  s_add_u32 s39, s39, 2818304
  s_lshl_b32 s38, s3, 26
  v_lshlrev_b32 v64, 22, v242
  v_or_b32 v64, s38, v64
  v_mov_b32 v65, 1
  v_add_u32 v246, 157696, v242
  s_waitcnt vmcnt(14) lgkmcnt(0)
  s_barrier
  ds_read_b128 v[68:71], v246
  s_waitcnt lgkmcnt(0)
  v_or3_b32 v68, v68, v69, v70
  v_or_b32 v68, v68, v71
  v_cmp_ne_u32 vcc, 0, v68
  s_nop 0
  s_cbranch_vccnz attn_redo
tail_go:
  buffer_atomic_add v65, v64, s[24:27], s39 offen
  s_and_b32 s36, s2, 1
  s_bfe_u32 s31, s2, 0x20001
  s_lshl_b32 s31, s31, 2
  s_bfe_u32 s38, s2, 0x20003
  s_add_u32 s31, s31, s38
  s_lshr_b32 s29, s2, 5
  v_mov_b32 v114, v242
  v_add_u32 v115, 0x1000, v114
  v_add_u32 v116, 0x2000, v114
  s_lshl_b32 s38, s36, 2
  s_add_u32 s38, s38, s3
  s_lshl_b32 s30, s38, 16
  buffer_load_dwordx4 a[56:59], v116, s[24:27], s6 offen offset:1024 sc1
  buffer_load_dwordx4 a[60:63], v116, s[24:27], s6 offen offset:2048 sc1
  buffer_load_dwordx4 a[64:67], v116, s[24:27], s6 offen offset:3072 sc1
  buffer_load_dwordx4 a[68:71], v114, s[24:27], s7 offen offset:0 sc1
  buffer_load_dwordx4 a[72:75], v114, s[24:27], s7 offen offset:1024 sc1
  buffer_load_dwordx4 a[76:79], v114, s[24:27], s7 offen offset:2048 sc1
  v_lshrrev_b32 v125, 4, v114
  v_and_b32 v126, 15, v125
  v_lshrrev_b32 v127, 4, v125
  s_add_u32 s38, s3, 0
  s_and_b32 s38, s38, 3
  s_lshl_b32 s38, s38, 11
  v_add_u32 v110, s38, v114
  s_sub_u32 s38, s3, 0
  s_and_b32 s38, s38, 3
  s_mul_i32 s38, s38, 15360
  s_add_u32 s38, s38, 98304
  v_add_u32 v118, s38, v114
  s_add_u32 s38, s3, 1
  s_and_b32 s38, s38, 3
  s_lshl_b32 s38, s38, 11
  v_add_u32 v111, s38, v114
  s_sub_u32 s38, s3, 1
  s_and_b32 s38, s38, 3
  s_mul_i32 s38, s38, 15360
  s_add_u32 s38, s38, 98304
  v_add_u32 v119, s38, v114
  s_add_u32 s38, s3, 2
  s_and_b32 s38, s38, 3
  s_lshl_b32 s38, s38, 11
  v_add_u32 v112, s38, v114
  s_sub_u32 s38, s3, 2
  s_and_b32 s38, s38, 3
  s_mul_i32 s38, s38, 15360
  s_add_u32 s38, s38, 98304
  v_add_u32 v120, s38, v114
  s_add_u32 s38, s3, 3
  s_and_b32 s38, s38, 3
  s_lshl_b32 s38, s38, 11
  v_add_u32 v113, s38, v114
  s_sub_u32 s38, s3, 3
  s_and_b32 s38, s38, 3
  s_mul_i32 s38, s38, 15360
  s_add_u32 s38, s38, 98304
  v_add_u32 v121, s38, v114
  v_add_u32 v122, s28, v114
  v_add_u32 v135, 0x10000, v122
  s_and_b32 s38, s31, 14
  s_add_u32 s38, s38, s36
  s_lshl_b32 s38, s38, 8
  s_add_u32 s38, s38, 2818304
  s_lshl_b32 s39, s29, 8
  s_add_u32 s39, s39, 2822400
  v_mov_b32 v133, s38
  v_writelane_b32 v133, s39, 1
  v_mov_b32 v134, 16
  v_writelane_b32 v134, 30, 1
  s_lshl_b32 s31, s31, 1
  s_add_u32 s31, s31, s36
  s_add_u32 s30, s30, 8388608
  s_lshl_b32 s38, s31, 19
  s_add_u32 s37, s30, s38
  s_xor_b32 s38, s38, 0x80000
  s_add_u32 s30, s30, s38
  s_lshl_b32 s40, s29, 5
  s_add_u32 s40, s40, s31
  s_lshl_b32 s38, s31, 6
  s_lshl_b32 s39, s3, 4
  s_add_u32 s38, s38, s39
  v_add_u32 v128, s38, v126
  v_mul_u32_u24 v117, 0x500, v128
  v_lshl_add_u32 v117, v127, 3, v117
  s_mul_i32 s38, s29, 160
  v_add_u32 v117, s38, v117
  s_mov_b32 s12, s60
  s_mov_b32 s13, s61
  s_mov_b32 s14, 2621440
  s_mov_b32 s15, 0x20000
  s_mov_b32 s16, s62
  s_mov_b32 s17, s63
  s_mov_b32 s18, 2621440
  s_mov_b32 s19, 0x20000
  s_mul_i32 s38, s31, 81920
  s_lshl_b32 s39, s3, 10
  s_add_u32 s38, s38, s39
  s_mul_i32 s39, s29, 10
  v_lshrrev_b32 v129, 1, v127
  v_add_u32 v129, s39, v129
  v_and_b32 v130, 1, v127
  v_lshlrev_b32 v130, 3, v130
  v_lshl_add_u32 v130, v126, 4, v130
  v_lshrrev_b32 v131, 2, v129
  v_lshl_add_u32 v131, v131, 12, v130
  v_and_b32 v132, 3, v129
  v_lshl_add_u32 v131, v132, 8, v131
  buffer_load_dwordx2 v[156:157], v131, s[24:27], s38 offen sc1
  v_add_u32 v129, 2, v129
  buffer_load_dwordx2 v[80:81], v117, s[12:15], 0 offen offset:0
  v_lshrrev_b32 v131, 2, v129
  v_lshl_add_u32 v131, v131, 12, v130
  v_and_b32 v132, 3, v129
  v_lshl_add_u32 v131, v132, 8, v131
  buffer_load_dwordx2 v[158:159], v131, s[24:27], s38 offen sc1
  v_add_u32 v129, 2, v129
  buffer_load_dwordx2 v[82:83], v117, s[12:15], 0 offen offset:32
  v_lshrrev_b32 v131, 2, v129
  v_lshl_add_u32 v131, v131, 12, v130
  v_and_b32 v132, 3, v129
  v_lshl_add_u32 v131, v132, 8, v131
  buffer_load_dwordx2 v[160:161], v131, s[24:27], s38 offen sc1
  v_add_u32 v129, 2, v129
  buffer_load_dwordx2 v[84:85], v117, s[12:15], 0 offen offset:64
  v_lshrrev_b32 v131, 2, v129
  v_lshl_add_u32 v131, v131, 12, v130
  v_and_b32 v132, 3, v129
  v_lshl_add_u32 v131, v132, 8, v131
  buffer_load_dwordx2 v[162:163], v131, s[24:27], s38 offen sc1
  v_add_u32 v129, 2, v129
  buffer_load_dwordx2 v[86:87], v117, s[12:15], 0 offen offset:96
  v_lshrrev_b32 v131, 2, v129
  v_lshl_add_u32 v131, v131, 12, v130
  v_and_b32 v132, 3, v129
  v_lshl_add_u32 v131, v132, 8, v131
  buffer_load_dwordx2 v[164:165], v131, s[24:27], s38 offen sc1
  v_add_u32 v129, 2, v129
  buffer_load_dwordx2 v[88:89], v117, s[12:15], 0 offen offset:128
  v_mov_b32 v123, 1073741824
  v_bfrev_b32 v124, 1
  v_sub_u32 v128, 0xffff, v128
  s_mov_b32 s34, 0xffff0000
  s_and_b32 s38, s52, 0xffff
  v_cmp_eq_u32 vcc, s38, v128
  v_mov_b32 v129, s52
  v_mov_b32 v130, 0
  v_cndmask_b32 v124, v124, v129, vcc
  v_cndmask_b32 v123, v123, v130, vcc
  s_and_b32 s38, s53, 0xffff
  v_cmp_eq_u32 vcc, s38, v128
  v_mov_b32 v129, s53
  v_mov_b32 v130, 2560
  v_cndmask_b32 v124, v124, v129, vcc
  v_cndmask_b32 v123, v123, v130, vcc
  s_and_b32 s38, s54, 0xffff
  v_cmp_eq_u32 vcc, s38, v128
  v_mov_b32 v129, s54
  v_mov_b32 v130, 5120
  v_cndmask_b32 v124, v124, v129, vcc
  v_cndmask_b32 v123, v123, v130, vcc
  s_and_b32 s38, s55, 0xffff
  v_cmp_eq_u32 vcc, s38, v128
  v_mov_b32 v129, s55
  v_mov_b32 v130, 7680
  v_cndmask_b32 v124, v124, v129, vcc
  v_cndmask_b32 v123, v123, v130, vcc
  s_and_b32 s38, s56, 0xffff
  v_cmp_eq_u32 vcc, s38, v128
  v_mov_b32 v129, s56
  v_mov_b32 v130, 10240
  v_cndmask_b32 v124, v124, v129, vcc
  v_cndmask_b32 v123, v123, v130, vcc
  s_and_b32 s38, s57, 0xffff
  v_cmp_eq_u32 vcc, s38, v128
  v_mov_b32 v129, s57
  v_mov_b32 v130, 12800
  v_cndmask_b32 v124, v124, v129, vcc
  v_cndmask_b32 v123, v123, v130, vcc
  s_and_b32 s38, s58, 0xffff
  v_cmp_eq_u32 vcc, s38, v128
  v_mov_b32 v129, s58
  v_mov_b32 v130, 15360
  v_cndmask_b32 v124, v124, v129, vcc
  v_cndmask_b32 v123, v123, v130, vcc
  s_and_b32 s38, s59, 0xffff
  v_cmp_eq_u32 vcc, s38, v128
  v_mov_b32 v129, s59
  v_mov_b32 v130, 17920
  v_cndmask_b32 v124, v124, v129, vcc
  v_cndmask_b32 v123, v123, v130, vcc
  v_lshl_add_u32 v123, v127, 4, v123
  s_mul_i32 s32, s29, 320
  s_add_u32 s32, s32, 2686976
  v_ashrrev_i32 v129, 31, v124
  v_not_b32 v129, v129
  v_or_b32 v129, 0x80000000, v129
  v_xor_b32 v124, v124, v129
  v_and_b32 v124, s34, v124
  v_mul_f32 v124, 0xbfb8aa3b, v124
  v_exp_f32 v124, v124
  s_nop 0
  v_add_f32 v124, 1.0, v124
  v_rcp_f32 v124, v124
  s_nop 0
  v_cvt_pk_bf16_f32 v124, v124, v124
  v_lshlrev_b32 v124, 16, v124
  buffer_load_dword v128, v133, s[24:27], 0 offen sc1
  buffer_load_dwordx4 a[80:83], v114, s[24:27], s7 offen offset:3072 sc1
  buffer_load_dwordx4 a[84:87], v115, s[24:27], s7 offen offset:0 sc1
  buffer_load_dwordx4 a[88:91], v115, s[24:27], s7 offen offset:1024 sc1
  buffer_load_dwordx4 a[92:95], v115, s[24:27], s7 offen offset:2048 sc1
  buffer_load_dwordx4 a[96:99], v115, s[24:27], s7 offen offset:3072 sc1
  buffer_load_dwordx4 a[100:103], v116, s[24:27], s7 offen offset:0 sc1
  s_waitcnt vmcnt(16)
  v_lshlrev_b32 v90, 16, v156
  v_and_b32 v91, s34, v156
  v_lshlrev_b32 v92, 16, v157
  v_and_b32 v93, s34, v157
  s_waitcnt vmcnt(14)
  v_lshlrev_b32 v94, 16, v158
  v_and_b32 v95, s34, v158
  v_lshlrev_b32 v96, 16, v159
  v_and_b32 v97, s34, v159
  s_waitcnt vmcnt(12)
  v_lshlrev_b32 v98, 16, v160
  v_and_b32 v99, s34, v160
  v_lshlrev_b32 v100, 16, v161
  v_and_b32 v101, s34, v161
  s_waitcnt vmcnt(10)
  v_lshlrev_b32 v102, 16, v162
  v_and_b32 v103, s34, v162
  v_lshlrev_b32 v104, 16, v163
  v_and_b32 v105, s34, v163
  s_waitcnt vmcnt(8)
  v_lshlrev_b32 v106, 16, v164
  v_and_b32 v107, s34, v164
  v_lshlrev_b32 v108, 16, v165
  v_and_b32 v109, s34, v165
  v_mov_b32 v156, 0
  v_mov_b32 v157, 0
  v_mov_b32 v158, 0
  v_mov_b32 v159, 0
  v_mov_b32 v160, 0
  v_mov_b32 v161, 0
  v_mov_b32 v162, 0
  v_mov_b32 v163, 0
  v_mov_b32 v164, 0
  v_mov_b32 v165, 0
  v_mov_b32 v166, 0
  v_mov_b32 v167, 0
  v_mov_b32 v168, 0
  v_mov_b32 v169, 0
  v_mov_b32 v170, 0
  v_mov_b32 v171, 0
  v_mov_b32 v172, 0
  v_mov_b32 v173, 0
  v_mov_b32 v174, 0
  v_mov_b32 v175, 0
  s_waitcnt vmcnt(6)
  v_cmp_lt_u32 vcc, v128, v134
  s_nop 0
  s_cbranch_vccz tail_ready
  s_mov_b32 s35, 32768
tail_spin:
  s_sleep 2
  buffer_load_dword v128, v133, s[24:27], 0 offen sc1
  s_waitcnt vmcnt(0)
  v_cmp_lt_u32 vcc, v128, v134
  s_nop 0
  s_cbranch_vccz tail_ready
  s_sub_u32 s35, s35, 1
  s_cmp_lg_u32 s35, 0
  s_cbranch_scc1 tail_spin
tail_ready:
  buffer_load_dwordx4 a[180:183], v110, s[24:27], s30 offen offset:0 sc1
  buffer_load_dwordx4 a[184:187], v110, s[24:27], s30 offen offset:1024 sc1
  buffer_load_dwordx4 a[188:191], v111, s[24:27], s30 offen offset:0 sc1
  buffer_load_dwordx4 a[192:195], v111, s[24:27], s30 offen offset:1024 sc1
  buffer_load_dwordx4 a[196:199], v112, s[24:27], s30 offen offset:0 sc1
  buffer_load_dwordx4 a[200:203], v112, s[24:27], s30 offen offset:1024 sc1
  buffer_load_dwordx4 a[204:207], v113, s[24:27], s30 offen offset:0 sc1
  buffer_load_dwordx4 a[208:211], v113, s[24:27], s30 offen offset:1024 sc1
  v_cmp_gt_u32 vcc, 1073741824, v123
  s_nop 0
  s_and_saveexec_b64 s[42:43], vcc
  s_cbranch_execz tail_plain
  s_waitcnt vmcnt(30)
  buffer_load_dwordx4 v[156:159], v123, s[24:27], s32 offen offset:0 sc1
  buffer_load_dwordx4 v[160:163], v123, s[24:27], s32 offen offset:64 sc1
  buffer_load_dwordx4 v[164:167], v123, s[24:27], s32 offen offset:128 sc1
  buffer_load_dwordx4 v[168:171], v123, s[24:27], s32 offen offset:192 sc1
  buffer_load_dwordx4 v[172:175], v123, s[24:27], s32 offen offset:256 sc1
  s_add_u32 s32, s32, 20480
  buffer_load_dwordx4 v[136:139], v123, s[24:27], s32 offen offset:0 sc1
  buffer_load_dwordx4 v[140:143], v123, s[24:27], s32 offen offset:64 sc1
  buffer_load_dwordx4 v[144:147], v123, s[24:27], s32 offen offset:128 sc1
  buffer_load_dwordx4 v[148:151], v123, s[24:27], s32 offen offset:192 sc1
  buffer_load_dwordx4 v[152:155], v123, s[24:27], s32 offen offset:256 sc1
  s_add_u32 s32, s32, 20480
  buffer_load_dwordx4 v[0:3], v123, s[24:27], s32 offen offset:0 sc1
  buffer_load_dwordx4 v[4:7], v123, s[24:27], s32 offen offset:64 sc1
  buffer_load_dwordx4 v[8:11], v123, s[24:27], s32 offen offset:128 sc1
  buffer_load_dwordx4 v[12:15], v123, s[24:27], s32 offen offset:192 sc1
  buffer_load_dwordx4 v[16:19], v123, s[24:27], s32 offen offset:256 sc1
  s_add_u32 s32, s32, 20480
  buffer_load_dwordx4 v[20:23], v123, s[24:27], s32 offen offset:0 sc1
  buffer_load_dwordx4 v[24:27], v123, s[24:27], s32 offen offset:64 sc1
  buffer_load_dwordx4 v[28:31], v123, s[24:27], s32 offen offset:128 sc1
  buffer_load_dwordx4 v[32:35], v123, s[24:27], s32 offen offset:192 sc1
  buffer_load_dwordx4 v[36:39], v123, s[24:27], s32 offen offset:256 sc1
  s_add_u32 s32, s32, 20480
  buffer_load_dwordx4 v[40:43], v123, s[24:27], s32 offen offset:0 sc1
  buffer_load_dwordx4 v[44:47], v123, s[24:27], s32 offen offset:64 sc1
  buffer_load_dwordx4 v[48:51], v123, s[24:27], s32 offen offset:128 sc1
  buffer_load_dwordx4 v[52:55], v123, s[24:27], s32 offen offset:192 sc1
  buffer_load_dwordx4 v[56:59], v123, s[24:27], s32 offen offset:256 sc1
  s_add_u32 s32, s32, 20480
  buffer_load_dwordx4 v[60:63], v123, s[24:27], s32 offen offset:0 sc1
  buffer_load_dwordx4 v[64:67], v123, s[24:27], s32 offen offset:64 sc1
  buffer_load_dwordx4 v[68:71], v123, s[24:27], s32 offen offset:128 sc1
  buffer_load_dwordx4 v[72:75], v123, s[24:27], s32 offen offset:192 sc1
  buffer_load_dwordx4 v[76:79], v123, s[24:27], s32 offen offset:256 sc1
  s_add_u32 s32, s32, 20480
  s_waitcnt vmcnt(0)
  v_add_f32 v156, v156, v136
  v_add_f32 v157, v157, v137
  v_add_f32 v158, v158, v138
  v_add_f32 v159, v159, v139
  v_add_f32 v160, v160, v140
  v_add_f32 v161, v161, v141
  v_add_f32 v162, v162, v142
  v_add_f32 v163, v163, v143
  v_add_f32 v164, v164, v144
  v_add_f32 v165, v165, v145
  v_add_f32 v166, v166, v146
  v_add_f32 v167, v167, v147
  v_add_f32 v168, v168, v148
  v_add_f32 v169, v169, v149
  v_add_f32 v170, v170, v150
  v_add_f32 v171, v171, v151
  v_add_f32 v172, v172, v152
  v_add_f32 v173, v173, v153
  v_add_f32 v174, v174, v154
  v_add_f32 v175, v175, v155
  v_add_f32 v156, v156, v0
  v_add_f32 v157, v157, v1
  v_add_f32 v158, v158, v2
  v_add_f32 v159, v159, v3
  v_add_f32 v160, v160, v4
  v_add_f32 v161, v161, v5
  v_add_f32 v162, v162, v6
  v_add_f32 v163, v163, v7
  v_add_f32 v164, v164, v8
  v_add_f32 v165, v165, v9
  v_add_f32 v166, v166, v10
  v_add_f32 v167, v167, v11
  v_add_f32 v168, v168, v12
  v_add_f32 v169, v169, v13
  v_add_f32 v170, v170, v14
  v_add_f32 v171, v171, v15
  v_add_f32 v172, v172, v16
  v_add_f32 v173, v173, v17
  v_add_f32 v174, v174, v18
  v_add_f32 v175, v175, v19
  v_add_f32 v156, v156, v20
  v_add_f32 v157, v157, v21
  v_add_f32 v158, v158, v22
  v_add_f32 v159, v159, v23
  v_add_f32 v160, v160, v24
  v_add_f32 v161, v161, v25
  v_add_f32 v162, v162, v26
  v_add_f32 v163, v163, v27
  v_add_f32 v164, v164, v28
  v_add_f32 v165, v165, v29
  v_add_f32 v166, v166, v30
  v_add_f32 v167, v167, v31
  v_add_f32 v168, v168, v32
  v_add_f32 v169, v169, v33
  v_add_f32 v170, v170, v34
  v_add_f32 v171, v171, v35
  v_add_f32 v172, v172, v36
  v_add_f32 v173, v173, v37
  v_add_f32 v174, v174, v38
  v_add_f32 v175, v175, v39
  v_add_f32 v156, v156, v40
  v_add_f32 v157, v157, v41
  v_add_f32 v158, v158, v42
  v_add_f32 v159, v159, v43
  v_add_f32 v160, v160, v44
  v_add_f32 v161, v161, v45
  v_add_f32 v162, v162, v46
  v_add_f32 v163, v163, v47
  v_add_f32 v164, v164, v48
  v_add_f32 v165, v165, v49
  v_add_f32 v166, v166, v50
  v_add_f32 v167, v167, v51
  v_add_f32 v168, v168, v52
  v_add_f32 v169, v169, v53
  v_add_f32 v170, v170, v54
  v_add_f32 v171, v171, v55
  v_add_f32 v172, v172, v56
  v_add_f32 v173, v173, v57
  v_add_f32 v174, v174, v58
  v_add_f32 v175, v175, v59
  v_add_f32 v156, v156, v60
  v_add_f32 v157, v157, v61
  v_add_f32 v158, v158, v62
  v_add_f32 v159, v159, v63
  v_add_f32 v160, v160, v64
  v_add_f32 v161, v161, v65
  v_add_f32 v162, v162, v66
  v_add_f32 v163, v163, v67
  v_add_f32 v164, v164, v68
  v_add_f32 v165, v165, v69
  v_add_f32 v166, v166, v70
  v_add_f32 v167, v167, v71
  v_add_f32 v168, v168, v72
  v_add_f32 v169, v169, v73
  v_add_f32 v170, v170, v74
  v_add_f32 v171, v171, v75
  v_add_f32 v172, v172, v76
  v_add_f32 v173, v173, v77
  v_add_f32 v174, v174, v78
  v_add_f32 v175, v175, v79
tail_plain:
  s_mov_b64 exec, s[42:43]
  s_waitcnt vmcnt(0)
  v_mfma_f32_16x16x32_bf16 v[0:3], a[212:215], a[180:183], 0
  s_add_u32 s30, s30, 8192
  buffer_load_dwordx4 v[176:179], v110, s[24:27], s30 offen offset:0 sc1
  v_mfma_f32_16x16x32_bf16 v[0:3], a[232:235], a[184:187], v[0:3]
  v_cvt_pk_bf16_f32 v156, v156, v156
  v_cvt_pk_bf16_f32 v157, v157, v157
  v_mfma_f32_16x16x32_bf16 v[4:7], a[232:235], a[192:195], 0
  buffer_load_dwordx4 a[104:107], v116, s[24:27], s7 offen offset:1024 sc1
  v_mfma_f32_16x16x32_bf16 v[4:7], a[212:215], a[188:191], v[4:7]
  v_cvt_pk_bf16_f32 v158, v158, v158
  v_cvt_pk_bf16_f32 v159, v159, v159
  v_mfma_f32_16x16x32_bf16 v[8:11], a[212:215], a[196:199], 0
  buffer_load_dwordx4 v[180:183], v110, s[24:27], s30 offen offset:1024 sc1
  v_mfma_f32_16x16x32_bf16 v[8:11], a[232:235], a[200:203], v[8:11]
  v_lshlrev_b32 v156, 16, v156
  v_lshlrev_b32 v157, 16, v157
  v_mfma_f32_16x16x32_bf16 v[12:15], a[232:235], a[208:211], 0
  v_lshlrev_b32 v158, 16, v158
  v_lshlrev_b32 v159, 16, v159
  v_mfma_f32_16x16x32_bf16 v[12:15], a[212:215], a[204:207], v[12:15]
  v_mul_f32 v156, v156, v124
  v_mul_f32 v157, v157, v124
  v_mfma_f32_16x16x32_bf16 v[16:19], a[216:219], a[180:183], 0
  buffer_load_dwordx4 v[184:187], v111, s[24:27], s30 offen offset:0 sc1
  v_mfma_f32_16x16x32_bf16 v[16:19], a[236:239], a[184:187], v[16:19]
  v_mul_f32 v158, v158, v124
  v_mul_f32 v159, v159, v124
  v_mfma_f32_16x16x32_bf16 v[20:23], a[236:239], a[192:195], 0
  buffer_load_dwordx4 a[108:111], v116, s[24:27], s7 offen offset:2048 sc1
  v_mfma_f32_16x16x32_bf16 v[20:23], a[216:219], a[188:191], v[20:23]
  v_cvt_pk_bf16_f32 v156, v156, v156
  v_cvt_pk_bf16_f32 v157, v157, v157
  v_mfma_f32_16x16x32_bf16 v[24:27], a[216:219], a[196:199], 0
  buffer_load_dwordx4 v[188:191], v111, s[24:27], s30 offen offset:1024 sc1
  v_mfma_f32_16x16x32_bf16 v[24:27], a[236:239], a[200:203], v[24:27]
  v_cvt_pk_bf16_f32 v158, v158, v158
  v_cvt_pk_bf16_f32 v159, v159, v159
  v_mfma_f32_16x16x32_bf16 v[28:31], a[236:239], a[208:211], 0
  v_lshlrev_b32 v156, 16, v156
  v_lshlrev_b32 v157, 16, v157
  v_mfma_f32_16x16x32_bf16 v[28:31], a[216:219], a[204:207], v[28:31]
  v_lshlrev_b32 v158, 16, v158
  v_lshlrev_b32 v159, 16, v159
  v_mfma_f32_16x16x32_bf16 v[32:35], a[220:223], a[180:183], 0
  buffer_load_dwordx4 v[192:195], v112, s[24:27], s30 offen offset:0 sc1
  v_mfma_f32_16x16x32_bf16 v[32:35], a[240:243], a[184:187], v[32:35]
  v_add_f32 v90, v90, v156
  v_add_f32 v91, v91, v157
  v_mfma_f32_16x16x32_bf16 v[36:39], a[240:243], a[192:195], 0
  buffer_load_dwordx4 a[112:115], v116, s[24:27], s7 offen offset:3072 sc1
  v_mfma_f32_16x16x32_bf16 v[36:39], a[220:223], a[188:191], v[36:39]
  v_add_f32 v92, v92, v158
  v_add_f32 v93, v93, v159
  v_mfma_f32_16x16x32_bf16 v[40:43], a[220:223], a[196:199], 0
  buffer_load_dwordx4 v[196:199], v112, s[24:27], s30 offen offset:1024 sc1
  v_mfma_f32_16x16x32_bf16 v[40:43], a[240:243], a[200:203], v[40:43]
  v_cvt_pk_bf16_f32 v90, v90, v90
  v_cvt_pk_bf16_f32 v91, v91, v91
  v_mfma_f32_16x16x32_bf16 v[44:47], a[240:243], a[208:211], 0
  v_cvt_pk_bf16_f32 v92, v92, v92
  v_cvt_pk_bf16_f32 v93, v93, v93
  v_mfma_f32_16x16x32_bf16 v[44:47], a[220:223], a[204:207], v[44:47]
  v_lshlrev_b32 v90, 16, v90
  v_lshlrev_b32 v91, 16, v91
  v_mfma_f32_16x16x32_bf16 v[48:51], a[224:227], a[180:183], 0
  buffer_load_dwordx4 v[200:203], v113, s[24:27], s30 offen offset:0 sc1
  v_mfma_f32_16x16x32_bf16 v[48:51], a[244:247], a[184:187], v[48:51]
  v_lshlrev_b32 v92, 16, v92
  v_lshlrev_b32 v93, 16, v93
  v_mfma_f32_16x16x32_bf16 v[52:55], a[244:247], a[192:195], 0
  buffer_load_dwordx4 a[116:119], v114, s[24:27], s8 offen offset:0 sc1
  v_mfma_f32_16x16x32_bf16 v[52:55], a[224:227], a[188:191], v[52:55]
  v_mul_f32 v129, 0xbfb8aa3b, v90
  v_mul_f32 v130, 0xbfb8aa3b, v91
  v_mfma_f32_16x16x32_bf16 v[56:59], a[224:227], a[196:199], 0
  buffer_load_dwordx4 v[204:207], v113, s[24:27], s30 offen offset:1024 sc1
  v_mfma_f32_16x16x32_bf16 v[56:59], a[244:247], a[200:203], v[56:59]
  v_mul_f32 v131, 0xbfb8aa3b, v92
  v_mul_f32 v132, 0xbfb8aa3b, v93
  v_mfma_f32_16x16x32_bf16 v[60:63], a[244:247], a[208:211], 0
  v_exp_f32 v129, v129
  v_mfma_f32_16x16x32_bf16 v[60:63], a[224:227], a[204:207], v[60:63]
  v_exp_f32 v130, v130
  v_mfma_f32_16x16x32_bf16 v[64:67], a[228:231], a[180:183], 0
  s_add_u32 s30, s30, 8192
  buffer_load_dwordx4 v[208:211], v110, s[24:27], s30 offen offset:0 sc1
  v_mfma_f32_16x16x32_bf16 v[64:67], a[248:251], a[184:187], v[64:67]
  v_exp_f32 v131, v131
  v_mfma_f32_16x16x32_bf16 v[68:71], a[248:251], a[192:195], 0
  buffer_load_dwordx4 a[120:123], v114, s[24:27], s8 offen offset:1024 sc1
  v_mfma_f32_16x16x32_bf16 v[68:71], a[228:231], a[188:191], v[68:71]
  v_exp_f32 v132, v132
  v_mfma_f32_16x16x32_bf16 v[72:75], a[228:231], a[196:199], 0
  buffer_load_dwordx4 v[212:215], v110, s[24:27], s30 offen offset:1024 sc1
  v_mfma_f32_16x16x32_bf16 v[72:75], a[248:251], a[200:203], v[72:75]
  v_add_f32 v129, 1.0, v129
  v_add_f32 v130, 1.0, v130
  v_mfma_f32_16x16x32_bf16 v[76:79], a[248:251], a[208:211], 0
  v_add_f32 v131, 1.0, v131
  v_add_f32 v132, 1.0, v132
  v_mfma_f32_16x16x32_bf16 v[76:79], a[228:231], a[204:207], v[76:79]
  v_rcp_f32 v129, v129
  s_waitcnt vmcnt(3)
  v_mfma_f32_16x16x32_bf16 v[0:3], a[252:255], v[176:179], v[0:3]
  buffer_load_dwordx4 v[216:219], v111, s[24:27], s30 offen offset:0 sc1
  v_mfma_f32_16x16x32_bf16 v[0:3], a[144:147], v[180:183], v[0:3]
  v_rcp_f32 v130, v130
  v_mfma_f32_16x16x32_bf16 v[4:7], a[144:147], v[188:191], v[4:7]
  buffer_load_dwordx4 a[124:127], v114, s[24:27], s8 offen offset:2048 sc1
  v_mfma_f32_16x16x32_bf16 v[4:7], a[252:255], v[184:187], v[4:7]
  v_rcp_f32 v131, v131
  v_mfma_f32_16x16x32_bf16 v[8:11], a[252:255], v[192:195], v[8:11]
  buffer_load_dwordx4 v[220:223], v111, s[24:27], s30 offen offset:1024 sc1
  v_mfma_f32_16x16x32_bf16 v[8:11], a[144:147], v[196:199], v[8:11]
  v_rcp_f32 v132, v132
  v_mfma_f32_16x16x32_bf16 v[12:15], a[144:147], v[204:207], v[12:15]
  v_mul_f32 v90, v90, v129
  v_mul_f32 v91, v91, v130
  v_mfma_f32_16x16x32_bf16 v[12:15], a[252:255], v[200:203], v[12:15]
  v_mul_f32 v92, v92, v131
  v_mul_f32 v93, v93, v132
  v_mfma_f32_16x16x32_bf16 v[16:19], a[128:131], v[176:179], v[16:19]
  buffer_load_dwordx4 v[224:227], v112, s[24:27], s30 offen offset:0 sc1
  v_mfma_f32_16x16x32_bf16 v[16:19], a[148:151], v[180:183], v[16:19]
  v_cvt_pk_bf16_f32 v90, v90, v90
  v_cvt_pk_bf16_f32 v91, v91, v91
  v_mfma_f32_16x16x32_bf16 v[20:23], a[148:151], v[188:191], v[20:23]
  buffer_load_dwordx4 a[160:163], v114, s[24:27], s8 offen offset:3072 sc1
  v_mfma_f32_16x16x32_bf16 v[20:23], a[128:131], v[184:187], v[20:23]
  v_cvt_pk_bf16_f32 v92, v92, v92
  v_cvt_pk_bf16_f32 v93, v93, v93
  v_mfma_f32_16x16x32_bf16 v[24:27], a[128:131], v[192:195], v[24:27]
  buffer_load_dwordx4 v[228:231], v112, s[24:27], s30 offen offset:1024 sc1
  v_mfma_f32_16x16x32_bf16 v[24:27], a[148:151], v[196:199], v[24:27]
  v_lshlrev_b32 v90, 16, v90
  v_lshlrev_b32 v91, 16, v91
  v_mfma_f32_16x16x32_bf16 v[28:31], a[148:151], v[204:207], v[28:31]
  v_lshlrev_b32 v92, 16, v92
  v_lshlrev_b32 v93, 16, v93
  v_mfma_f32_16x16x32_bf16 v[28:31], a[128:131], v[200:203], v[28:31]
  v_cvt_pk_bf16_f32 v160, v160, v160
  v_cvt_pk_bf16_f32 v161, v161, v161
  v_mfma_f32_16x16x32_bf16 v[32:35], a[132:135], v[176:179], v[32:35]
  buffer_load_dwordx4 v[232:235], v113, s[24:27], s30 offen offset:0 sc1
  v_mfma_f32_16x16x32_bf16 v[32:35], a[152:155], v[180:183], v[32:35]
  v_cvt_pk_bf16_f32 v162, v162, v162
  v_cvt_pk_bf16_f32 v163, v163, v163
  v_mfma_f32_16x16x32_bf16 v[36:39], a[152:155], v[188:191], v[36:39]
  buffer_load_dwordx4 a[164:167], v115, s[24:27], s8 offen offset:0 sc1
  v_mfma_f32_16x16x32_bf16 v[36:39], a[132:135], v[184:187], v[36:39]
  v_lshlrev_b32 v160, 16, v160
  v_lshlrev_b32 v161, 16, v161
  v_mfma_f32_16x16x32_bf16 v[40:43], a[132:135], v[192:195], v[40:43]
  buffer_load_dwordx4 v[236:239], v113, s[24:27], s30 offen offset:1024 sc1
  v_mfma_f32_16x16x32_bf16 v[40:43], a[152:155], v[196:199], v[40:43]
  v_lshlrev_b32 v162, 16, v162
  v_lshlrev_b32 v163, 16, v163
  v_mfma_f32_16x16x32_bf16 v[44:47], a[152:155], v[204:207], v[44:47]
  v_mul_f32 v160, v160, v124
  v_mul_f32 v161, v161, v124
  v_mfma_f32_16x16x32_bf16 v[44:47], a[132:135], v[200:203], v[44:47]
  v_mul_f32 v162, v162, v124
  v_mul_f32 v163, v163, v124
  v_mfma_f32_16x16x32_bf16 v[48:51], a[136:139], v[176:179], v[48:51]
  s_add_u32 s30, s30, 8192
  buffer_load_dwordx4 v[240:243], v110, s[24:27], s30 offen offset:0 sc1
  v_mfma_f32_16x16x32_bf16 v[48:51], a[156:159], v[180:183], v[48:51]
  v_cvt_pk_bf16_f32 v160, v160, v160
  v_cvt_pk_bf16_f32 v161, v161, v161
  v_mfma_f32_16x16x32_bf16 v[52:55], a[156:159], v[188:191], v[52:55]
  buffer_load_dwordx4 a[168:171], v115, s[24:27], s8 offen offset:1024 sc1
  v_mfma_f32_16x16x32_bf16 v[52:55], a[136:139], v[184:187], v[52:55]
  v_cvt_pk_bf16_f32 v162, v162, v162
  v_cvt_pk_bf16_f32 v163, v163, v163
  v_mfma_f32_16x16x32_bf16 v[56:59], a[136:139], v[192:195], v[56:59]
  buffer_load_dwordx4 v[244:247], v110, s[24:27], s30 offen offset:1024 sc1
  v_mfma_f32_16x16x32_bf16 v[56:59], a[156:159], v[196:199], v[56:59]
  v_lshlrev_b32 v160, 16, v160
  v_lshlrev_b32 v161, 16, v161
  v_mfma_f32_16x16x32_bf16 v[60:63], a[156:159], v[204:207], v[60:63]
  v_lshlrev_b32 v162, 16, v162
  v_lshlrev_b32 v163, 16, v163
  v_mfma_f32_16x16x32_bf16 v[60:63], a[136:139], v[200:203], v[60:63]
  v_add_f32 v94, v94, v160
  v_add_f32 v95, v95, v161
  v_mfma_f32_16x16x32_bf16 v[64:67], a[140:143], v[176:179], v[64:67]
  buffer_load_dwordx4 v[248:251], v111, s[24:27], s30 offen offset:0 sc1
  v_mfma_f32_16x16x32_bf16 v[64:67], a[0:3], v[180:183], v[64:67]
  v_add_f32 v96, v96, v162
  v_add_f32 v97, v97, v163
  v_mfma_f32_16x16x32_bf16 v[68:71], a[0:3], v[188:191], v[68:71]
  buffer_load_dwordx4 a[172:175], v115, s[24:27], s8 offen offset:2048 sc1
  v_mfma_f32_16x16x32_bf16 v[68:71], a[140:143], v[184:187], v[68:71]
  v_cvt_pk_bf16_f32 v94, v94, v94
  v_cvt_pk_bf16_f32 v95, v95, v95
  v_mfma_f32_16x16x32_bf16 v[72:75], a[140:143], v[192:195], v[72:75]
  buffer_load_dwordx4 v[252:255], v111, s[24:27], s30 offen offset:1024 sc1
  v_mfma_f32_16x16x32_bf16 v[72:75], a[0:3], v[196:199], v[72:75]
  v_cvt_pk_bf16_f32 v96, v96, v96
  v_cvt_pk_bf16_f32 v97, v97, v97
  v_mfma_f32_16x16x32_bf16 v[76:79], a[0:3], v[204:207], v[76:79]
  v_lshlrev_b32 v94, 16, v94
  v_lshlrev_b32 v95, 16, v95
  v_mfma_f32_16x16x32_bf16 v[76:79], a[140:143], v[200:203], v[76:79]
  v_lshlrev_b32 v96, 16, v96
  v_lshlrev_b32 v97, 16, v97
  s_waitcnt vmcnt(6)
  v_mfma_f32_16x16x32_bf16 v[0:3], a[4:7], v[208:211], v[0:3]
  buffer_load_dwordx4 v[136:139], v112, s[24:27], s30 offen offset:0 sc1
  v_mfma_f32_16x16x32_bf16 v[0:3], a[24:27], v[212:215], v[0:3]
  v_mul_f32 v129, 0xbfb8aa3b, v94
  v_mul_f32 v130, 0xbfb8aa3b, v95
  v_mfma_f32_16x16x32_bf16 v[4:7], a[24:27], v[220:223], v[4:7]
  buffer_load_dwordx4 a[176:179], v115, s[24:27], s8 offen offset:3072 sc1
  v_mfma_f32_16x16x32_bf16 v[4:7], a[4:7], v[216:219], v[4:7]
  v_mul_f32 v131, 0xbfb8aa3b, v96
  v_mul_f32 v132, 0xbfb8aa3b, v97
  v_mfma_f32_16x16x32_bf16 v[8:11], a[4:7], v[224:227], v[8:11]
  buffer_load_dwordx4 v[140:143], v112, s[24:27], s30 offen offset:1024 sc1
  v_mfma_f32_16x16x32_bf16 v[8:11], a[24:27], v[228:231], v[8:11]
  v_exp_f32 v129, v129
  v_mfma_f32_16x16x32_bf16 v[12:15], a[24:27], v[236:239], v[12:15]
  v_exp_f32 v130, v130
  v_mfma_f32_16x16x32_bf16 v[12:15], a[4:7], v[232:235], v[12:15]
  v_exp_f32 v131, v131
  v_mfma_f32_16x16x32_bf16 v[16:19], a[8:11], v[208:211], v[16:19]
  buffer_load_dwordx4 v[144:147], v113, s[24:27], s30 offen offset:0 sc1
  v_mfma_f32_16x16x32_bf16 v[16:19], a[28:31], v[212:215], v[16:19]
  v_exp_f32 v132, v132
  v_mfma_f32_16x16x32_bf16 v[20:23], a[28:31], v[220:223], v[20:23]
  s_add_u32 m0, s28, 49152
  s_nop 0
  buffer_load_dwordx4 v115, s[24:27], s10 offen offset:0 sc1 lds
  v_mfma_f32_16x16x32_bf16 v[20:23], a[8:11], v[216:219], v[20:23]
  buffer_load_dwordx4 v115, s[24:27], s10 offen offset:1024 sc1 lds
  v_mfma_f32_16x16x32_bf16 v[24:27], a[8:11], v[224:227], v[24:27]
  buffer_load_dwordx4 v115, s[24:27], s10 offen offset:2048 sc1 lds
  v_mfma_f32_16x16x32_bf16 v[24:27], a[28:31], v[228:231], v[24:27]
  buffer_load_dwordx4 v115, s[24:27], s10 offen offset:3072 sc1 lds
  v_mfma_f32_16x16x32_bf16 v[28:31], a[28:31], v[236:239], v[28:31]
  buffer_load_dwordx4 v[148:151], v113, s[24:27], s30 offen offset:1024 sc1
  v_mfma_f32_16x16x32_bf16 v[28:31], a[8:11], v[232:235], v[28:31]
  v_add_f32 v129, 1.0, v129
  v_add_f32 v130, 1.0, v130
  v_mfma_f32_16x16x32_bf16 v[32:35], a[12:15], v[208:211], v[32:35]
  s_add_u32 s30, s30, 8192
  buffer_load_dwordx4 v[152:155], v110, s[24:27], s30 offen offset:0 sc1
  v_mfma_f32_16x16x32_bf16 v[32:35], a[32:35], v[212:215], v[32:35]
  v_add_f32 v131, 1.0, v131
  v_add_f32 v132, 1.0, v132
  v_mfma_f32_16x16x32_bf16 v[36:39], a[32:35], v[220:223], v[36:39]
  v_rcp_f32 v129, v129
  v_mfma_f32_16x16x32_bf16 v[36:39], a[12:15], v[216:219], v[36:39]
  v_rcp_f32 v130, v130
  v_mfma_f32_16x16x32_bf16 v[40:43], a[12:15], v[224:227], v[40:43]
  buffer_load_dwordx4 a[180:183], v110, s[24:27], s30 offen offset:1024 sc1
  v_mfma_f32_16x16x32_bf16 v[40:43], a[32:35], v[228:231], v[40:43]
  v_rcp_f32 v131, v131
  v_mfma_f32_16x16x32_bf16 v[44:47], a[32:35], v[236:239], v[44:47]
  v_rcp_f32 v132, v132
  v_mfma_f32_16x16x32_bf16 v[44:47], a[12:15], v[232:235], v[44:47]
  v_mul_f32 v94, v94, v129
  v_mul_f32 v95, v95, v130
  v_mfma_f32_16x16x32_bf16 v[48:51], a[16:19], v[208:211], v[48:51]
  buffer_load_dwordx4 a[184:187], v111, s[24:27], s30 offen offset:0 sc1
  v_mfma_f32_16x16x32_bf16 v[48:51], a[36:39], v[212:215], v[48:51]
  v_mul_f32 v96, v96, v131
  v_mul_f32 v97, v97, v132
  v_mfma_f32_16x16x32_bf16 v[52:55], a[36:39], v[220:223], v[52:55]
  v_cvt_pk_bf16_f32 v94, v94, v94
  v_cvt_pk_bf16_f32 v95, v95, v95
  v_mfma_f32_16x16x32_bf16 v[52:55], a[16:19], v[216:219], v[52:55]
  v_cvt_pk_bf16_f32 v96, v96, v96
  v_cvt_pk_bf16_f32 v97, v97, v97
  v_mfma_f32_16x16x32_bf16 v[56:59], a[16:19], v[224:227], v[56:59]
  buffer_load_dwordx4 a[188:191], v111, s[24:27], s30 offen offset:1024 sc1
  v_mfma_f32_16x16x32_bf16 v[56:59], a[36:39], v[228:231], v[56:59]
  v_lshlrev_b32 v94, 16, v94
  v_lshlrev_b32 v95, 16, v95
  v_mfma_f32_16x16x32_bf16 v[60:63], a[36:39], v[236:239], v[60:63]
  v_lshlrev_b32 v96, 16, v96
  v_lshlrev_b32 v97, 16, v97
  v_mfma_f32_16x16x32_bf16 v[60:63], a[16:19], v[232:235], v[60:63]
  v_cvt_pk_bf16_f32 v164, v164, v164
  v_cvt_pk_bf16_f32 v165, v165, v165
  v_mfma_f32_16x16x32_bf16 v[64:67], a[20:23], v[208:211], v[64:67]
  buffer_load_dwordx4 a[192:195], v112, s[24:27], s30 offen offset:0 sc1
  v_mfma_f32_16x16x32_bf16 v[64:67], a[40:43], v[212:215], v[64:67]
  v_cvt_pk_bf16_f32 v166, v166, v166
  v_cvt_pk_bf16_f32 v167, v167, v167
  v_mfma_f32_16x16x32_bf16 v[68:71], a[40:43], v[220:223], v[68:71]
  v_lshlrev_b32 v164, 16, v164
  v_lshlrev_b32 v165, 16, v165
  v_mfma_f32_16x16x32_bf16 v[68:71], a[20:23], v[216:219], v[68:71]
  v_lshlrev_b32 v166, 16, v166
  v_lshlrev_b32 v167, 16, v167
  v_mfma_f32_16x16x32_bf16 v[72:75], a[20:23], v[224:227], v[72:75]
  buffer_load_dwordx4 a[196:199], v112, s[24:27], s30 offen offset:1024 sc1
  v_mfma_f32_16x16x32_bf16 v[72:75], a[40:43], v[228:231], v[72:75]
  v_mul_f32 v164, v164, v124
  v_mul_f32 v165, v165, v124
  v_mfma_f32_16x16x32_bf16 v[76:79], a[40:43], v[236:239], v[76:79]
  v_mul_f32 v166, v166, v124
  v_mul_f32 v167, v167, v124
  v_mfma_f32_16x16x32_bf16 v[76:79], a[20:23], v[232:235], v[76:79]
  v_cvt_pk_bf16_f32 v164, v164, v164
  v_cvt_pk_bf16_f32 v165, v165, v165
  s_waitcnt vmcnt(6)
  v_mfma_f32_16x16x32_bf16 v[0:3], a[44:47], v[240:243], v[0:3]
  buffer_load_dwordx4 a[200:203], v113, s[24:27], s30 offen offset:0 sc1
  v_mfma_f32_16x16x32_bf16 v[0:3], a[64:67], v[244:247], v[0:3]
  v_cvt_pk_bf16_f32 v166, v166, v166
  v_cvt_pk_bf16_f32 v167, v167, v167
  v_mfma_f32_16x16x32_bf16 v[4:7], a[64:67], v[252:255], v[4:7]
  v_lshlrev_b32 v164, 16, v164
  v_lshlrev_b32 v165, 16, v165
  v_mfma_f32_16x16x32_bf16 v[4:7], a[44:47], v[248:251], v[4:7]
  v_lshlrev_b32 v166, 16, v166
  v_lshlrev_b32 v167, 16, v167
  v_mfma_f32_16x16x32_bf16 v[8:11], a[44:47], v[136:139], v[8:11]
  buffer_load_dwordx4 a[204:207], v113, s[24:27], s30 offen offset:1024 sc1
  v_mfma_f32_16x16x32_bf16 v[8:11], a[64:67], v[140:143], v[8:11]
  v_add_f32 v98, v98, v164
  v_add_f32 v99, v99, v165
  v_mfma_f32_16x16x32_bf16 v[12:15], a[64:67], v[148:151], v[12:15]
  v_add_f32 v100, v100, v166
  v_add_f32 v101, v101, v167
  v_mfma_f32_16x16x32_bf16 v[12:15], a[44:47], v[144:147], v[12:15]
  v_cvt_pk_bf16_f32 v98, v98, v98
  v_cvt_pk_bf16_f32 v99, v99, v99
  v_mfma_f32_16x16x32_bf16 v[16:19], a[48:51], v[240:243], v[16:19]
  s_add_u32 s30, s30, 8192
  buffer_load_dwordx4 a[208:211], v110, s[24:27], s30 offen offset:0 sc1
  v_mfma_f32_16x16x32_bf16 v[16:19], a[68:71], v[244:247], v[16:19]
  v_cvt_pk_bf16_f32 v100, v100, v100
  v_cvt_pk_bf16_f32 v101, v101, v101
  v_mfma_f32_16x16x32_bf16 v[20:23], a[68:71], v[252:255], v[20:23]
  v_lshlrev_b32 v98, 16, v98
  v_lshlrev_b32 v99, 16, v99
  v_mfma_f32_16x16x32_bf16 v[20:23], a[48:51], v[248:251], v[20:23]
  v_lshlrev_b32 v100, 16, v100
  v_lshlrev_b32 v101, 16, v101
  v_mfma_f32_16x16x32_bf16 v[24:27], a[48:51], v[136:139], v[24:27]
  buffer_load_dwordx4 v[176:179], v110, s[24:27], s30 offen offset:1024 sc1
  v_mfma_f32_16x16x32_bf16 v[24:27], a[68:71], v[140:143], v[24:27]
  v_mul_f32 v129, 0xbfb8aa3b, v98
  v_mul_f32 v130, 0xbfb8aa3b, v99
  v_mfma_f32_16x16x32_bf16 v[28:31], a[68:71], v[148:151], v[28:31]
  v_mul_f32 v131, 0xbfb8aa3b, v100
  v_mul_f32 v132, 0xbfb8aa3b, v101
  v_mfma_f32_16x16x32_bf16 v[28:31], a[48:51], v[144:147], v[28:31]
  v_exp_f32 v129, v129
  v_mfma_f32_16x16x32_bf16 v[32:35], a[52:55], v[240:243], v[32:35]
  buffer_load_dwordx4 v[180:183], v111, s[24:27], s30 offen offset:0 sc1
  v_mfma_f32_16x16x32_bf16 v[32:35], a[72:75], v[244:247], v[32:35]
  v_exp_f32 v130, v130
  v_mfma_f32_16x16x32_bf16 v[36:39], a[72:75], v[252:255], v[36:39]
  v_exp_f32 v131, v131
  v_mfma_f32_16x16x32_bf16 v[36:39], a[52:55], v[248:251], v[36:39]
  v_exp_f32 v132, v132
  v_mfma_f32_16x16x32_bf16 v[40:43], a[52:55], v[136:139], v[40:43]
  buffer_load_dwordx4 v[184:187], v111, s[24:27], s30 offen offset:1024 sc1
  v_mfma_f32_16x16x32_bf16 v[40:43], a[72:75], v[140:143], v[40:43]
  v_add_f32 v129, 1.0, v129
  v_add_f32 v130, 1.0, v130
  v_mfma_f32_16x16x32_bf16 v[44:47], a[72:75], v[148:151], v[44:47]
  v_add_f32 v131, 1.0, v131
  v_add_f32 v132, 1.0, v132
  v_mfma_f32_16x16x32_bf16 v[44:47], a[52:55], v[144:147], v[44:47]
  v_rcp_f32 v129, v129
  v_mfma_f32_16x16x32_bf16 v[48:51], a[56:59], v[240:243], v[48:51]
  buffer_load_dwordx4 v[188:191], v112, s[24:27], s30 offen offset:0 sc1
  v_mfma_f32_16x16x32_bf16 v[48:51], a[76:79], v[244:247], v[48:51]
  v_rcp_f32 v130, v130
  v_mfma_f32_16x16x32_bf16 v[52:55], a[76:79], v[252:255], v[52:55]
  v_rcp_f32 v131, v131
  v_mfma_f32_16x16x32_bf16 v[52:55], a[56:59], v[248:251], v[52:55]
  v_rcp_f32 v132, v132
  v_mfma_f32_16x16x32_bf16 v[56:59], a[56:59], v[136:139], v[56:59]
  buffer_load_dwordx4 v[192:195], v112, s[24:27], s30 offen offset:1024 sc1
  v_mfma_f32_16x16x32_bf16 v[56:59], a[76:79], v[140:143], v[56:59]
  v_mul_f32 v98, v98, v129
  v_mul_f32 v99, v99, v130
  v_mfma_f32_16x16x32_bf16 v[60:63], a[76:79], v[148:151], v[60:63]
  v_mul_f32 v100, v100, v131
  v_mul_f32 v101, v101, v132
  v_mfma_f32_16x16x32_bf16 v[60:63], a[56:59], v[144:147], v[60:63]
  v_cvt_pk_bf16_f32 v98, v98, v98
  v_cvt_pk_bf16_f32 v99, v99, v99
  v_mfma_f32_16x16x32_bf16 v[64:67], a[60:63], v[240:243], v[64:67]
  buffer_load_dwordx4 v[196:199], v113, s[24:27], s30 offen offset:0 sc1
  v_mfma_f32_16x16x32_bf16 v[64:67], a[80:83], v[244:247], v[64:67]
  v_cvt_pk_bf16_f32 v100, v100, v100
  v_cvt_pk_bf16_f32 v101, v101, v101
  v_mfma_f32_16x16x32_bf16 v[68:71], a[80:83], v[252:255], v[68:71]
  v_lshlrev_b32 v98, 16, v98
  v_lshlrev_b32 v99, 16, v99
  v_mfma_f32_16x16x32_bf16 v[68:71], a[60:63], v[248:251], v[68:71]
  v_lshlrev_b32 v100, 16, v100
  v_lshlrev_b32 v101, 16, v101
  v_mfma_f32_16x16x32_bf16 v[72:75], a[60:63], v[136:139], v[72:75]
  buffer_load_dwordx4 v[200:203], v113, s[24:27], s30 offen offset:1024 sc1
  v_mfma_f32_16x16x32_bf16 v[72:75], a[80:83], v[140:143], v[72:75]
  v_cvt_pk_bf16_f32 v168, v168, v168
  v_cvt_pk_bf16_f32 v169, v169, v169
  v_mfma_f32_16x16x32_bf16 v[76:79], a[80:83], v[148:151], v[76:79]
  v_cvt_pk_bf16_f32 v170, v170, v170
  v_cvt_pk_bf16_f32 v171, v171, v171
  v_mfma_f32_16x16x32_bf16 v[76:79], a[60:63], v[144:147], v[76:79]
  v_lshlrev_b32 v168, 16, v168
  v_lshlrev_b32 v169, 16, v169
  s_waitcnt vmcnt(8)
  v_mfma_f32_16x16x32_bf16 v[0:3], a[84:87], v[152:155], v[0:3]
  s_add_u32 s30, s30, 8192
  buffer_load_dwordx4 v[204:207], v110, s[24:27], s30 offen offset:0 sc1
  v_mfma_f32_16x16x32_bf16 v[0:3], a[104:107], a[180:183], v[0:3]
  v_lshlrev_b32 v170, 16, v170
  v_lshlrev_b32 v171, 16, v171
  v_mfma_f32_16x16x32_bf16 v[4:7], a[104:107], a[188:191], v[4:7]
  v_mul_f32 v168, v168, v124
  v_mul_f32 v169, v169, v124
  v_mfma_f32_16x16x32_bf16 v[4:7], a[84:87], a[184:187], v[4:7]
  v_mul_f32 v170, v170, v124
  v_mul_f32 v171, v171, v124
  v_mfma_f32_16x16x32_bf16 v[8:11], a[84:87], a[192:195], v[8:11]
  buffer_load_dwordx4 v[208:211], v110, s[24:27], s30 offen offset:1024 sc1
  v_mfma_f32_16x16x32_bf16 v[8:11], a[104:107], a[196:199], v[8:11]
  v_cvt_pk_bf16_f32 v168, v168, v168
  v_cvt_pk_bf16_f32 v169, v169, v169
  v_mfma_f32_16x16x32_bf16 v[12:15], a[104:107], a[204:207], v[12:15]
  v_cvt_pk_bf16_f32 v170, v170, v170
  v_cvt_pk_bf16_f32 v171, v171, v171
  v_mfma_f32_16x16x32_bf16 v[12:15], a[84:87], a[200:203], v[12:15]
  v_lshlrev_b32 v168, 16, v168
  v_lshlrev_b32 v169, 16, v169
  v_mfma_f32_16x16x32_bf16 v[16:19], a[88:91], v[152:155], v[16:19]
  buffer_load_dwordx4 v[212:215], v111, s[24:27], s30 offen offset:0 sc1
  v_mfma_f32_16x16x32_bf16 v[16:19], a[108:111], a[180:183], v[16:19]
  v_lshlrev_b32 v170, 16, v170
  v_lshlrev_b32 v171, 16, v171
  v_mfma_f32_16x16x32_bf16 v[20:23], a[108:111], a[188:191], v[20:23]
  v_add_f32 v102, v102, v168
  v_add_f32 v103, v103, v169
  v_mfma_f32_16x16x32_bf16 v[20:23], a[88:91], a[184:187], v[20:23]
  v_add_f32 v104, v104, v170
  v_add_f32 v105, v105, v171
  v_mfma_f32_16x16x32_bf16 v[24:27], a[88:91], a[192:195], v[24:27]
  buffer_load_dwordx4 v[216:219], v111, s[24:27], s30 offen offset:1024 sc1
  v_mfma_f32_16x16x32_bf16 v[24:27], a[108:111], a[196:199], v[24:27]
  v_cvt_pk_bf16_f32 v102, v102, v102
  v_cvt_pk_bf16_f32 v103, v103, v103
  v_mfma_f32_16x16x32_bf16 v[28:31], a[108:111], a[204:207], v[28:31]
  v_cvt_pk_bf16_f32 v104, v104, v104
  v_cvt_pk_bf16_f32 v105, v105, v105
  v_mfma_f32_16x16x32_bf16 v[28:31], a[88:91], a[200:203], v[28:31]
  v_lshlrev_b32 v102, 16, v102
  v_lshlrev_b32 v103, 16, v103
  v_mfma_f32_16x16x32_bf16 v[32:35], a[92:95], v[152:155], v[32:35]
  buffer_load_dwordx4 v[220:223], v112, s[24:27], s30 offen offset:0 sc1
  v_mfma_f32_16x16x32_bf16 v[32:35], a[112:115], a[180:183], v[32:35]
  v_lshlrev_b32 v104, 16, v104
  v_lshlrev_b32 v105, 16, v105
  v_mfma_f32_16x16x32_bf16 v[36:39], a[112:115], a[188:191], v[36:39]
  v_mul_f32 v129, 0xbfb8aa3b, v102
  v_mul_f32 v130, 0xbfb8aa3b, v103
  v_mfma_f32_16x16x32_bf16 v[36:39], a[92:95], a[184:187], v[36:39]
  v_mul_f32 v131, 0xbfb8aa3b, v104
  v_mul_f32 v132, 0xbfb8aa3b, v105
  v_mfma_f32_16x16x32_bf16 v[40:43], a[92:95], a[192:195], v[40:43]
  buffer_load_dwordx4 v[224:227], v112, s[24:27], s30 offen offset:1024 sc1
  v_mfma_f32_16x16x32_bf16 v[40:43], a[112:115], a[196:199], v[40:43]
  v_exp_f32 v129, v129
  v_mfma_f32_16x16x32_bf16 v[44:47], a[112:115], a[204:207], v[44:47]
  v_exp_f32 v130, v130
  v_mfma_f32_16x16x32_bf16 v[44:47], a[92:95], a[200:203], v[44:47]
  v_exp_f32 v131, v131
  v_mfma_f32_16x16x32_bf16 v[48:51], a[96:99], v[152:155], v[48:51]
  buffer_load_dwordx4 v[228:231], v113, s[24:27], s30 offen offset:0 sc1
  v_mfma_f32_16x16x32_bf16 v[48:51], a[116:119], a[180:183], v[48:51]
  v_exp_f32 v132, v132
  v_mfma_f32_16x16x32_bf16 v[52:55], a[116:119], a[188:191], v[52:55]
  v_add_f32 v129, 1.0, v129
  v_add_f32 v130, 1.0, v130
  v_mfma_f32_16x16x32_bf16 v[52:55], a[96:99], a[184:187], v[52:55]
  v_add_f32 v131, 1.0, v131
  v_add_f32 v132, 1.0, v132
  v_mfma_f32_16x16x32_bf16 v[56:59], a[96:99], a[192:195], v[56:59]
  buffer_load_dwordx4 v[232:235], v113, s[24:27], s30 offen offset:1024 sc1
  v_mfma_f32_16x16x32_bf16 v[56:59], a[116:119], a[196:199], v[56:59]
  v_rcp_f32 v129, v129
  v_mfma_f32_16x16x32_bf16 v[60:63], a[116:119], a[204:207], v[60:63]
  v_rcp_f32 v130, v130
  v_mfma_f32_16x16x32_bf16 v[60:63], a[96:99], a[200:203], v[60:63]
  v_rcp_f32 v131, v131
  v_mfma_f32_16x16x32_bf16 v[64:67], a[100:103], v[152:155], v[64:67]
  ds_read_b128 v[236:239], v122 offset:0
  s_add_u32 s30, s30, 8192
  v_rcp_f32 v132, v132
  v_mfma_f32_16x16x32_bf16 v[64:67], a[120:123], a[180:183], v[64:67]
  buffer_load_dwordx4 v[240:243], v110, s[24:27], s30 offen offset:0 sc1
  v_mfma_f32_16x16x32_bf16 v[68:71], a[120:123], a[188:191], v[68:71]
  v_mul_f32 v102, v102, v129
  v_mul_f32 v103, v103, v130
  v_mfma_f32_16x16x32_bf16 v[68:71], a[100:103], a[184:187], v[68:71]
  v_mul_f32 v104, v104, v131
  v_mul_f32 v105, v105, v132
  v_mfma_f32_16x16x32_bf16 v[72:75], a[100:103], a[192:195], v[72:75]
  buffer_load_dwordx4 v[244:247], v110, s[24:27], s30 offen offset:1024 sc1
  v_mfma_f32_16x16x32_bf16 v[72:75], a[120:123], a[196:199], v[72:75]
  v_cvt_pk_bf16_f32 v102, v102, v102
  v_cvt_pk_bf16_f32 v103, v103, v103
  v_mfma_f32_16x16x32_bf16 v[76:79], a[120:123], a[204:207], v[76:79]
  v_cvt_pk_bf16_f32 v104, v104, v104
  v_cvt_pk_bf16_f32 v105, v105, v105
  v_mfma_f32_16x16x32_bf16 v[76:79], a[100:103], a[200:203], v[76:79]
  v_lshlrev_b32 v102, 16, v102
  v_lshlrev_b32 v103, 16, v103
  s_waitcnt vmcnt(10)
  v_mfma_f32_16x16x32_bf16 v[0:3], a[124:127], a[208:211], v[0:3]
  ds_read_b128 v[248:251], v122 offset:1024
  v_lshlrev_b32 v104, 16, v104
  v_mfma_f32_16x16x32_bf16 v[0:3], a[176:179], v[176:179], v[0:3]
  buffer_load_dwordx4 v[252:255], v111, s[24:27], s30 offen offset:0 sc1
  v_mfma_f32_16x16x32_bf16 v[4:7], a[176:179], v[184:187], v[4:7]
  v_lshlrev_b32 v105, 16, v105
  v_cvt_pk_bf16_f32 v172, v172, v172
  v_mfma_f32_16x16x32_bf16 v[4:7], a[124:127], v[180:183], v[4:7]
  v_cvt_pk_bf16_f32 v173, v173, v173
  v_cvt_pk_bf16_f32 v174, v174, v174
  v_mfma_f32_16x16x32_bf16 v[8:11], a[124:127], v[188:191], v[8:11]
  buffer_load_dwordx4 v[136:139], v111, s[24:27], s30 offen offset:1024 sc1
  v_mfma_f32_16x16x32_bf16 v[8:11], a[176:179], v[192:195], v[8:11]
  v_cvt_pk_bf16_f32 v175, v175, v175
  v_lshlrev_b32 v172, 16, v172
  v_mfma_f32_16x16x32_bf16 v[12:15], a[176:179], v[200:203], v[12:15]
  v_lshlrev_b32 v173, 16, v173
  v_lshlrev_b32 v174, 16, v174
  v_mfma_f32_16x16x32_bf16 v[12:15], a[124:127], v[196:199], v[12:15]
  v_lshlrev_b32 v175, 16, v175
  v_mul_f32 v172, v172, v124
  s_waitcnt lgkmcnt(1)
  v_mfma_f32_16x16x32_bf16 v[16:19], a[160:163], a[208:211], v[16:19]
  ds_read_b128 v[140:143], v122 offset:2048
  v_mul_f32 v173, v173, v124
  v_mfma_f32_16x16x32_bf16 v[16:19], v[236:239], v[176:179], v[16:19]
  buffer_load_dwordx4 v[144:147], v112, s[24:27], s30 offen offset:0 sc1
  v_mfma_f32_16x16x32_bf16 v[20:23], v[236:239], v[184:187], v[20:23]
  v_mul_f32 v174, v174, v124
  v_mul_f32 v175, v175, v124
  v_mfma_f32_16x16x32_bf16 v[20:23], a[160:163], v[180:183], v[20:23]
  v_cvt_pk_bf16_f32 v172, v172, v172
  v_cvt_pk_bf16_f32 v173, v173, v173
  v_mfma_f32_16x16x32_bf16 v[24:27], a[160:163], v[188:191], v[24:27]
  buffer_load_dwordx4 v[148:151], v112, s[24:27], s30 offen offset:1024 sc1
  v_mfma_f32_16x16x32_bf16 v[24:27], v[236:239], v[192:195], v[24:27]
  v_cvt_pk_bf16_f32 v174, v174, v174
  v_cvt_pk_bf16_f32 v175, v175, v175
  v_mfma_f32_16x16x32_bf16 v[28:31], v[236:239], v[200:203], v[28:31]
  v_lshlrev_b32 v172, 16, v172
  v_lshlrev_b32 v173, 16, v173
  v_mfma_f32_16x16x32_bf16 v[28:31], a[160:163], v[196:199], v[28:31]
  v_lshlrev_b32 v174, 16, v174
  v_lshlrev_b32 v175, 16, v175
  s_waitcnt lgkmcnt(1)
  v_mfma_f32_16x16x32_bf16 v[32:35], a[164:167], a[208:211], v[32:35]
  ds_read_b128 v[152:155], v122 offset:3072
  v_add_f32 v106, v106, v172
  v_mfma_f32_16x16x32_bf16 v[32:35], v[248:251], v[176:179], v[32:35]
  buffer_load_dwordx4 a[180:183], v113, s[24:27], s30 offen offset:0 sc1
  v_mfma_f32_16x16x32_bf16 v[36:39], v[248:251], v[184:187], v[36:39]
  v_add_f32 v107, v107, v173
  v_add_f32 v108, v108, v174
  v_mfma_f32_16x16x32_bf16 v[36:39], a[164:167], v[180:183], v[36:39]
  v_add_f32 v109, v109, v175
  v_cvt_pk_bf16_f32 v106, v106, v106
  v_mfma_f32_16x16x32_bf16 v[40:43], a[164:167], v[188:191], v[40:43]
  buffer_load_dwordx4 a[184:187], v113, s[24:27], s30 offen offset:1024 sc1
  v_mfma_f32_16x16x32_bf16 v[40:43], v[248:251], v[192:195], v[40:43]
  v_cvt_pk_bf16_f32 v107, v107, v107
  v_cvt_pk_bf16_f32 v108, v108, v108
  v_mfma_f32_16x16x32_bf16 v[44:47], v[248:251], v[200:203], v[44:47]
  v_cvt_pk_bf16_f32 v109, v109, v109
  v_lshlrev_b32 v106, 16, v106
  v_mfma_f32_16x16x32_bf16 v[44:47], a[164:167], v[196:199], v[44:47]
  v_lshlrev_b32 v107, 16, v107
  v_lshlrev_b32 v108, 16, v108
  s_waitcnt lgkmcnt(1)
  v_mfma_f32_16x16x32_bf16 v[48:51], a[168:171], a[208:211], v[48:51]
  ds_read_b128 a[188:191], v122 offset:16384
  ds_read_b128 a[192:195], v122 offset:33792
  s_mov_b32 s30, s37
  v_mfma_f32_16x16x32_bf16 v[48:51], v[140:143], v[176:179], v[48:51]
  buffer_load_dwordx4 a[196:199], v110, s[24:27], s30 offen offset:0 sc1
  v_mfma_f32_16x16x32_bf16 v[52:55], v[140:143], v[184:187], v[52:55]
  v_lshlrev_b32 v109, 16, v109
  v_mul_f32 v129, 0xbfb8aa3b, v106
  v_mfma_f32_16x16x32_bf16 v[52:55], a[168:171], v[180:183], v[52:55]
  v_mul_f32 v130, 0xbfb8aa3b, v107
  v_mul_f32 v131, 0xbfb8aa3b, v108
  v_mfma_f32_16x16x32_bf16 v[56:59], a[168:171], v[188:191], v[56:59]
  buffer_load_dwordx4 a[200:203], v110, s[24:27], s30 offen offset:1024 sc1
  v_mfma_f32_16x16x32_bf16 v[56:59], v[140:143], v[192:195], v[56:59]
  v_mul_f32 v132, 0xbfb8aa3b, v109
  v_exp_f32 v129, v129
  v_mfma_f32_16x16x32_bf16 v[60:63], v[140:143], v[200:203], v[60:63]
  v_exp_f32 v130, v130
  v_mfma_f32_16x16x32_bf16 v[60:63], a[168:171], v[196:199], v[60:63]
  v_exp_f32 v131, v131
  s_waitcnt lgkmcnt(2)
  v_mfma_f32_16x16x32_bf16 v[64:67], a[172:175], a[208:211], v[64:67]
  ds_read_b128 a[204:207], v122 offset:17408
  ds_read_b128 v[236:239], v122 offset:34816
  v_mfma_f32_16x16x32_bf16 v[64:67], v[152:155], v[176:179], v[64:67]
  v_exp_f32 v132, v132
  v_mfma_f32_16x16x32_bf16 v[68:71], v[152:155], v[184:187], v[68:71]
  v_add_f32 v129, 1.0, v129
  v_add_f32 v130, 1.0, v130
  v_mfma_f32_16x16x32_bf16 v[68:71], a[172:175], v[180:183], v[68:71]
  v_add_f32 v131, 1.0, v131
  v_add_f32 v132, 1.0, v132
  v_mfma_f32_16x16x32_bf16 v[72:75], a[172:175], v[188:191], v[72:75]
  v_rcp_f32 v129, v129
  v_mfma_f32_16x16x32_bf16 v[72:75], v[152:155], v[192:195], v[72:75]
  v_rcp_f32 v130, v130
  v_mfma_f32_16x16x32_bf16 v[76:79], v[152:155], v[200:203], v[76:79]
  v_rcp_f32 v131, v131
  v_mfma_f32_16x16x32_bf16 v[76:79], a[172:175], v[196:199], v[76:79]
  v_rcp_f32 v132, v132
  s_waitcnt vmcnt(10) lgkmcnt(2)
  v_mfma_f32_16x16x32_bf16 v[0:3], a[188:191], v[204:207], v[0:3]
  ds_read_b128 v[248:251], v122 offset:18432
  ds_read_b128 v[140:143], v122 offset:35840
  v_mfma_f32_16x16x32_bf16 v[0:3], a[192:195], v[208:211], v[0:3]
  buffer_load_dwordx4 v[152:155], v111, s[24:27], s30 offen offset:0 sc1
  v_mfma_f32_16x16x32_bf16 v[4:7], a[192:195], v[216:219], v[4:7]
  v_mul_f32 v106, v106, v129
  v_mul_f32 v107, v107, v130
  v_mfma_f32_16x16x32_bf16 v[4:7], a[188:191], v[212:215], v[4:7]
  v_mul_f32 v108, v108, v131
  v_mul_f32 v109, v109, v132
  v_mfma_f32_16x16x32_bf16 v[8:11], a[188:191], v[220:223], v[8:11]
  buffer_load_dwordx4 a[208:211], v111, s[24:27], s30 offen offset:1024 sc1
  v_mfma_f32_16x16x32_bf16 v[8:11], a[192:195], v[224:227], v[8:11]
  v_cvt_pk_bf16_f32 v106, v106, v106
  v_cvt_pk_bf16_f32 v107, v107, v107
  v_mfma_f32_16x16x32_bf16 v[12:15], a[192:195], v[232:235], v[12:15]
  v_cvt_pk_bf16_f32 v108, v108, v108
  v_cvt_pk_bf16_f32 v109, v109, v109
  v_mfma_f32_16x16x32_bf16 v[12:15], a[188:191], v[228:231], v[12:15]
  v_lshlrev_b32 v106, 16, v106
  v_lshlrev_b32 v107, 16, v107
  s_waitcnt lgkmcnt(2)
  v_mfma_f32_16x16x32_bf16 v[16:19], a[204:207], v[204:207], v[16:19]
  ds_read_b128 v[176:179], v122 offset:19456
  ds_read_b128 v[180:183], v135 offset:0
  v_mfma_f32_16x16x32_bf16 v[16:19], v[236:239], v[208:211], v[16:19]
  buffer_load_dwordx4 v[184:187], v112, s[24:27], s30 offen offset:0 sc1
  v_mfma_f32_16x16x32_bf16 v[20:23], v[236:239], v[216:219], v[20:23]
  v_lshlrev_b32 v108, 16, v108
  v_lshlrev_b32 v109, 16, v109
  v_mfma_f32_16x16x32_bf16 v[20:23], a[204:207], v[212:215], v[20:23]
  v_lshlrev_b32 v156, 16, v80
  v_and_b32 v157, s34, v80
  v_mfma_f32_16x16x32_bf16 v[24:27], a[204:207], v[220:223], v[24:27]
  buffer_load_dwordx4 v[188:191], v112, s[24:27], s30 offen offset:1024 sc1
  v_mfma_f32_16x16x32_bf16 v[24:27], v[236:239], v[224:227], v[24:27]
  v_lshlrev_b32 v158, 16, v81
  v_and_b32 v159, s34, v81
  v_mfma_f32_16x16x32_bf16 v[28:31], v[236:239], v[232:235], v[28:31]
  v_lshlrev_b32 v160, 16, v82
  v_and_b32 v161, s34, v82
  v_mfma_f32_16x16x32_bf16 v[28:31], a[204:207], v[228:231], v[28:31]
  v_lshlrev_b32 v162, 16, v83
  v_and_b32 v163, s34, v83
  s_waitcnt lgkmcnt(2)
  v_mfma_f32_16x16x32_bf16 v[32:35], v[248:251], v[204:207], v[32:35]
  ds_read_b128 v[192:195], v122 offset:32768
  ds_read_b128 v[196:199], v135 offset:1024
  v_mfma_f32_16x16x32_bf16 v[32:35], v[140:143], v[208:211], v[32:35]
  buffer_load_dwordx4 v[200:203], v113, s[24:27], s30 offen offset:0 sc1
  v_mfma_f32_16x16x32_bf16 v[36:39], v[140:143], v[216:219], v[36:39]
  v_lshlrev_b32 v164, 16, v84
  v_and_b32 v165, s34, v84
  v_mfma_f32_16x16x32_bf16 v[36:39], v[248:251], v[212:215], v[36:39]
  v_lshlrev_b32 v166, 16, v85
  v_and_b32 v167, s34, v85
  v_mfma_f32_16x16x32_bf16 v[40:43], v[248:251], v[220:223], v[40:43]
  buffer_load_dwordx4 a[188:191], v113, s[24:27], s30 offen offset:1024 sc1
  v_mfma_f32_16x16x32_bf16 v[40:43], v[140:143], v[224:227], v[40:43]
  v_lshlrev_b32 v168, 16, v86
  v_and_b32 v169, s34, v86
  v_mfma_f32_16x16x32_bf16 v[44:47], v[140:143], v[232:235], v[44:47]
  v_lshlrev_b32 v170, 16, v87
  v_and_b32 v171, s34, v87
  v_mfma_f32_16x16x32_bf16 v[44:47], v[248:251], v[228:231], v[44:47]
  v_lshlrev_b32 v172, 16, v88
  v_and_b32 v173, s34, v88
  s_waitcnt lgkmcnt(2)
  v_mfma_f32_16x16x32_bf16 v[48:51], v[176:179], v[204:207], v[48:51]
  ds_read_b128 a[192:195], v135 offset:2048
  ds_read_b128 a[204:207], v135 offset:19456
  s_add_u32 s30, s30, 8192
  v_mfma_f32_16x16x32_bf16 v[48:51], v[180:183], v[208:211], v[48:51]
  buffer_load_dwordx4 v[236:239], v110, s[24:27], s30 offen offset:0 sc1
  v_mfma_f32_16x16x32_bf16 v[52:55], v[180:183], v[216:219], v[52:55]
  v_lshlrev_b32 v174, 16, v89
  v_and_b32 v175, s34, v89
  v_mfma_f32_16x16x32_bf16 v[52:55], v[176:179], v[212:215], v[52:55]
  s_sub_u32 s41, s3, 1
  s_and_b32 s41, s41, 3
  s_lshl_b32 s41, s41, 12
  v_add_u32 v80, s41, v114
  v_mfma_f32_16x16x32_bf16 v[56:59], v[176:179], v[220:223], v[56:59]
  s_sub_u32 s41, s3, 2
  s_and_b32 s41, s41, 3
  s_lshl_b32 s41, s41, 12
  v_add_u32 v81, s41, v114
  v_mfma_f32_16x16x32_bf16 v[56:59], v[180:183], v[224:227], v[56:59]
  s_sub_u32 s41, s3, 3
  s_and_b32 s41, s41, 3
  s_lshl_b32 s41, s41, 12
  v_add_u32 v82, s41, v114
  v_bfe_u32 v129, v114, 8, 1
  v_mfma_f32_16x16x32_bf16 v[60:63], v[180:183], v[232:235], v[60:63]
  v_mul_u32_u24 v129, 24, v129
  v_add_u32 v83, v117, v129
  v_mfma_f32_16x16x32_bf16 v[60:63], v[176:179], v[228:231], v[60:63]
  s_waitcnt lgkmcnt(2)
  v_mfma_f32_16x16x32_bf16 v[64:67], v[192:195], v[204:207], v[64:67]
  ds_read_b128 v[248:251], v135 offset:3072
  ds_read_b128 v[140:143], v122 offset:49152
  v_mfma_f32_16x16x32_bf16 v[64:67], v[196:199], v[208:211], v[64:67]
  v_mfma_f32_16x16x32_bf16 v[68:71], v[196:199], v[216:219], v[68:71]
  v_mfma_f32_16x16x32_bf16 v[68:71], v[192:195], v[212:215], v[68:71]
  v_mfma_f32_16x16x32_bf16 v[72:75], v[192:195], v[220:223], v[72:75]
  v_mfma_f32_16x16x32_bf16 v[72:75], v[196:199], v[224:227], v[72:75]
  v_mfma_f32_16x16x32_bf16 v[76:79], v[196:199], v[232:235], v[76:79]
  v_mfma_f32_16x16x32_bf16 v[76:79], v[192:195], v[228:231], v[76:79]
  s_waitcnt vmcnt(9) lgkmcnt(2)
  v_mfma_f32_16x16x32_bf16 v[0:3], a[192:195], v[240:243], v[0:3]
  ds_read_b128 v[176:179], v135 offset:16384
  ds_read_b128 v[180:183], v122 offset:50176
  s_xor_b32 s38, s40, 1
  v_mfma_f32_16x16x32_bf16 v[0:3], a[204:207], v[244:247], v[0:3]
  buffer_load_dwordx4 v[192:195], v110, s[24:27], s30 offen offset:1024 sc1
  s_lshl_b32 s38, s38, 2
  s_add_u32 s38, s38, s3
  s_lshl_b32 s38, s38, 13
  v_mfma_f32_16x16x32_bf16 v[4:7], a[204:207], v[136:139], v[4:7]
  s_add_u32 s38, s38, 25165824
  s_add_u32 s39, s38, 4096
  v_lshrrev_b32 v125, 1, v114
  v_mfma_f32_16x16x32_bf16 v[4:7], a[192:195], v[252:255], v[4:7]
  v_mfma_f32_16x16x32_bf16 v[8:11], a[192:195], v[144:147], v[8:11]
  buffer_load_dwordx4 v[196:199], v111, s[24:27], s30 offen offset:0 sc1
  v_mfma_f32_16x16x32_bf16 v[8:11], a[204:207], v[148:151], v[8:11]
  v_mfma_f32_16x16x32_bf16 v[12:15], a[204:207], a[184:187], v[12:15]
  v_mfma_f32_16x16x32_bf16 v[12:15], a[192:195], a[180:183], v[12:15]
  s_waitcnt lgkmcnt(2)
  v_mfma_f32_16x16x32_bf16 v[16:19], v[248:251], v[240:243], v[16:19]
  ds_read_b128 v[204:207], v135 offset:17408
  ds_read_b128 v[208:211], v122 offset:51200
  v_mfma_f32_16x16x32_bf16 v[16:19], v[140:143], v[244:247], v[16:19]
  buffer_load_dwordx4 v[212:215], v111, s[24:27], s30 offen offset:1024 sc1
  v_mfma_f32_16x16x32_bf16 v[20:23], v[140:143], v[136:139], v[20:23]
  ds_write_b128 v118, v[4:7] offset:0
  ds_write_b128 v118, v[8:11] offset:5120
  v_mfma_f32_16x16x32_bf16 v[20:23], v[248:251], v[252:255], v[20:23]
  ds_write_b128 v118, v[12:15] offset:10240
  v_mfma_f32_16x16x32_bf16 v[24:27], v[248:251], v[144:147], v[24:27]
  buffer_load_dwordx4 v[216:219], v112, s[24:27], s30 offen offset:0 sc1
  v_mfma_f32_16x16x32_bf16 v[24:27], v[140:143], v[148:151], v[24:27]
  v_mfma_f32_16x16x32_bf16 v[28:31], v[140:143], a[184:187], v[28:31]
  v_mfma_f32_16x16x32_bf16 v[28:31], v[248:251], a[180:183], v[28:31]
  s_waitcnt lgkmcnt(5)
  v_mfma_f32_16x16x32_bf16 v[32:35], v[176:179], v[240:243], v[32:35]
  ds_read_b128 v[220:223], v135 offset:18432
  ds_read_b128 v[224:227], v122 offset:52224
  v_mfma_f32_16x16x32_bf16 v[32:35], v[180:183], v[244:247], v[32:35]
  buffer_load_dwordx4 v[228:231], v112, s[24:27], s30 offen offset:1024 sc1
  v_mfma_f32_16x16x32_bf16 v[36:39], v[180:183], v[136:139], v[36:39]
  ds_write_b128 v118, v[20:23] offset:1024
  ds_write_b128 v118, v[24:27] offset:6144
  v_mfma_f32_16x16x32_bf16 v[36:39], v[176:179], v[252:255], v[36:39]
  ds_write_b128 v118, v[28:31] offset:11264
  v_mfma_f32_16x16x32_bf16 v[40:43], v[176:179], v[144:147], v[40:43]
  buffer_load_dwordx4 v[232:235], v113, s[24:27], s30 offen offset:0 sc1
  v_mfma_f32_16x16x32_bf16 v[40:43], v[180:183], v[148:151], v[40:43]
  v_mfma_f32_16x16x32_bf16 v[44:47], v[180:183], a[184:187], v[44:47]
  v_mfma_f32_16x16x32_bf16 v[44:47], v[176:179], a[180:183], v[44:47]
  s_waitcnt lgkmcnt(8)
  v_mfma_f32_16x16x32_bf16 v[48:51], v[204:207], v[240:243], v[48:51]
  buffer_load_dwordx4 a[192:195], v113, s[24:27], s30 offen offset:1024 sc1
  v_mfma_f32_16x16x32_bf16 v[48:51], v[208:211], v[244:247], v[48:51]
  ds_write_b128 v118, v[36:39] offset:2048
  v_mfma_f32_16x16x32_bf16 v[52:55], v[208:211], v[136:139], v[52:55]
  ds_write_b128 v118, v[40:43] offset:7168
  v_mfma_f32_16x16x32_bf16 v[52:55], v[204:207], v[252:255], v[52:55]
  ds_write_b128 v118, v[44:47] offset:12288
  v_mfma_f32_16x16x32_bf16 v[56:59], v[204:207], v[144:147], v[56:59]
  s_add_u32 s30, s30, 8192
  buffer_load_dwordx4 a[204:207], v110, s[24:27], s30 offen offset:0 sc1
  v_mfma_f32_16x16x32_bf16 v[56:59], v[208:211], v[148:151], v[56:59]
  v_mfma_f32_16x16x32_bf16 v[60:63], v[208:211], a[184:187], v[60:63]
  v_mfma_f32_16x16x32_bf16 v[60:63], v[204:207], a[180:183], v[60:63]
  s_waitcnt lgkmcnt(6)
  v_mfma_f32_16x16x32_bf16 v[64:67], v[220:223], v[240:243], v[64:67]
  buffer_load_dwordx4 v[248:251], v110, s[24:27], s30 offen offset:1024 sc1
  v_mfma_f32_16x16x32_bf16 v[64:67], v[224:227], v[244:247], v[64:67]
  ds_write_b128 v118, v[52:55] offset:3072
  v_mfma_f32_16x16x32_bf16 v[68:71], v[224:227], v[136:139], v[68:71]
  ds_write_b128 v118, v[56:59] offset:8192
  v_mfma_f32_16x16x32_bf16 v[68:71], v[220:223], v[252:255], v[68:71]
  ds_write_b128 v118, v[60:63] offset:13312
  v_mfma_f32_16x16x32_bf16 v[72:75], v[220:223], v[144:147], v[72:75]
  buffer_load_dwordx4 v[140:143], v111, s[24:27], s30 offen offset:0 sc1
  v_mfma_f32_16x16x32_bf16 v[72:75], v[224:227], v[148:151], v[72:75]
  v_mfma_f32_16x16x32_bf16 v[76:79], v[224:227], a[184:187], v[76:79]
  v_mfma_f32_16x16x32_bf16 v[76:79], v[220:223], a[180:183], v[76:79]
  s_nop 1
  ds_write_b128 v118, v[68:71] offset:4096
  s_nop 2
  ds_write_b128 v118, v[72:75] offset:9216
  s_nop 0
  ds_write_b128 v118, v[76:79] offset:14336
  buffer_load_dwordx4 v[176:179], v111, s[24:27], s30 offen offset:1024 sc1
  buffer_load_dwordx4 v[180:183], v112, s[24:27], s30 offen offset:0 sc1
  buffer_load_dwordx4 v[204:207], v112, s[24:27], s30 offen offset:1024 sc1
  buffer_load_dwordx4 v[208:211], v113, s[24:27], s30 offen offset:0 sc1
  buffer_load_dwordx4 v[220:223], v113, s[24:27], s30 offen offset:1024 sc1
  s_add_u32 s30, s30, 8192
  buffer_load_dwordx4 v[224:227], v110, s[24:27], s30 offen offset:0 sc1
  buffer_load_dwordx4 v[240:243], v110, s[24:27], s30 offen offset:1024 sc1
  buffer_load_dwordx4 v[244:247], v111, s[24:27], s30 offen offset:0 sc1
  buffer_load_dwordx4 v[252:255], v111, s[24:27], s30 offen offset:1024 sc1
  buffer_load_dwordx4 v[136:139], v112, s[24:27], s30 offen offset:0 sc1
  buffer_load_dwordx4 v[144:147], v112, s[24:27], s30 offen offset:1024 sc1
  buffer_load_dwordx4 v[148:151], v113, s[24:27], s30 offen offset:0 sc1
  buffer_load_dwordx4 a[180:183], v113, s[24:27], s30 offen offset:1024 sc1
  s_add_u32 s30, s30, 8192
  buffer_load_dwordx4 a[184:187], v110, s[24:27], s30 offen offset:0 sc1
  s_waitcnt lgkmcnt(0)
  s_barrier
  ds_read_b128 v[4:7], v119 offset:0
  ds_read_b128 v[8:11], v120 offset:5120
  ds_read_b128 v[12:15], v121 offset:10240
  ds_read_b128 v[20:23], v119 offset:1024
  ds_read_b128 v[24:27], v120 offset:6144
  ds_read_b128 v[28:31], v121 offset:11264
  ds_read_b128 v[36:39], v119 offset:2048
  ds_read_b128 v[40:43], v120 offset:7168
  ds_read_b128 v[44:47], v121 offset:12288
  ds_read_b128 v[52:55], v119 offset:3072
  ds_read_b128 v[56:59], v120 offset:8192
  ds_read_b128 v[60:63], v121 offset:13312
  ds_read_b128 v[68:71], v119 offset:4096
  ds_read_b128 v[72:75], v120 offset:9216
  ds_read_b128 v[76:79], v121 offset:14336
  s_waitcnt lgkmcnt(12)
  v_add_f32 v4, v4, v8
  v_add_f32 v5, v5, v9
  v_add_f32 v6, v6, v10
  v_add_f32 v7, v7, v11
  v_add_f32 v0, v0, v12
  v_add_f32 v1, v1, v13
  v_add_f32 v2, v2, v14
  v_add_f32 v3, v3, v15
  v_add_f32 v0, v0, v4
  v_add_f32 v1, v1, v5
  v_add_f32 v2, v2, v6
  v_add_f32 v3, v3, v7
  v_cvt_pk_bf16_f32 v4, v0, v1
  v_cvt_pk_bf16_f32 v5, v2, v3
  buffer_store_dwordx2 v[4:5], v125, s[24:27], s38 offen offset:0 sc1
  s_waitcnt vmcnt(26)
  v_mfma_f32_16x16x32_bf16 v[0:3], a[212:215], a[196:199], 0
  s_waitcnt lgkmcnt(9)
  v_add_f32 v20, v20, v24
  v_add_f32 v21, v21, v25
  v_mfma_f32_16x16x32_bf16 v[0:3], a[232:235], a[200:203], v[0:3]
  v_add_f32 v22, v22, v26
  v_add_f32 v23, v23, v27
  v_mfma_f32_16x16x32_bf16 v[4:7], a[232:235], a[208:211], 0
  v_add_f32 v16, v16, v28
  v_add_f32 v17, v17, v29
  v_mfma_f32_16x16x32_bf16 v[4:7], a[212:215], v[152:155], v[4:7]
  v_add_f32 v18, v18, v30
  v_add_f32 v19, v19, v31
  v_mfma_f32_16x16x32_bf16 v[8:11], a[212:215], v[184:187], 0
  v_add_f32 v16, v16, v20
  v_add_f32 v17, v17, v21
  v_mfma_f32_16x16x32_bf16 v[8:11], a[232:235], v[188:191], v[8:11]
  v_add_f32 v18, v18, v22
  v_add_f32 v19, v19, v23
  v_mfma_f32_16x16x32_bf16 v[12:15], a[232:235], a[188:191], 0
  v_cvt_pk_bf16_f32 v20, v16, v17
  v_cvt_pk_bf16_f32 v21, v18, v19
  v_mfma_f32_16x16x32_bf16 v[12:15], a[212:215], v[200:203], v[12:15]
  buffer_store_dwordx2 v[20:21], v125, s[24:27], s38 offen offset:512 sc1
  s_waitcnt lgkmcnt(6)
  v_mfma_f32_16x16x32_bf16 v[16:19], a[216:219], a[196:199], 0
  buffer_load_dwordx4 a[212:215], v110, s[24:27], s30 offen offset:1024 sc1
  v_mfma_f32_16x16x32_bf16 v[16:19], a[236:239], a[200:203], v[16:19]
  v_add_f32 v36, v36, v40
  v_add_f32 v37, v37, v41
  v_mfma_f32_16x16x32_bf16 v[20:23], a[236:239], a[208:211], 0
  v_add_f32 v38, v38, v42
  v_add_f32 v39, v39, v43
  v_mfma_f32_16x16x32_bf16 v[20:23], a[216:219], v[152:155], v[20:23]
  v_add_f32 v32, v32, v44
  v_add_f32 v33, v33, v45
  v_mfma_f32_16x16x32_bf16 v[24:27], a[216:219], v[184:187], 0
  buffer_load_dwordx4 a[232:235], v111, s[24:27], s30 offen offset:0 sc1
  v_mfma_f32_16x16x32_bf16 v[24:27], a[236:239], v[188:191], v[24:27]
  v_add_f32 v34, v34, v46
  v_add_f32 v35, v35, v47
  v_mfma_f32_16x16x32_bf16 v[28:31], a[236:239], a[188:191], 0
  v_add_f32 v32, v32, v36
  v_add_f32 v33, v33, v37
  v_mfma_f32_16x16x32_bf16 v[28:31], a[216:219], v[200:203], v[28:31]
  v_add_f32 v34, v34, v38
  v_add_f32 v35, v35, v39
  v_cvt_pk_bf16_f32 v36, v32, v33
  v_cvt_pk_bf16_f32 v37, v34, v35
  buffer_store_dwordx2 v[36:37], v125, s[24:27], s38 offen offset:1024 sc1
  v_mfma_f32_16x16x32_bf16 v[32:35], a[220:223], a[196:199], 0
  buffer_load_dwordx4 a[216:219], v111, s[24:27], s30 offen offset:1024 sc1
  s_waitcnt lgkmcnt(3)
  v_mfma_f32_16x16x32_bf16 v[32:35], a[240:243], a[200:203], v[32:35]
  v_add_f32 v52, v52, v56
  v_add_f32 v53, v53, v57
  v_mfma_f32_16x16x32_bf16 v[36:39], a[240:243], a[208:211], 0
  v_add_f32 v54, v54, v58
  v_add_f32 v55, v55, v59
  v_mfma_f32_16x16x32_bf16 v[36:39], a[220:223], v[152:155], v[36:39]
  v_add_f32 v48, v48, v60
  v_add_f32 v49, v49, v61
  v_mfma_f32_16x16x32_bf16 v[40:43], a[220:223], v[184:187], 0
  buffer_load_dwordx4 a[236:239], v112, s[24:27], s30 offen offset:0 sc1
  v_mfma_f32_16x16x32_bf16 v[40:43], a[240:243], v[188:191], v[40:43]
  v_add_f32 v50, v50, v62
  v_add_f32 v51, v51, v63
  v_mfma_f32_16x16x32_bf16 v[44:47], a[240:243], a[188:191], 0
  v_add_f32 v48, v48, v52
  v_add_f32 v49, v49, v53
  v_mfma_f32_16x16x32_bf16 v[44:47], a[220:223], v[200:203], v[44:47]
  v_add_f32 v50, v50, v54
  v_add_f32 v51, v51, v55
  v_cvt_pk_bf16_f32 v52, v48, v49
  v_cvt_pk_bf16_f32 v53, v50, v51
  buffer_store_dwordx2 v[52:53], v125, s[24:27], s38 offen offset:1536 sc1
  v_mfma_f32_16x16x32_bf16 v[48:51], a[224:227], a[196:199], 0
  buffer_load_dwordx4 a[220:223], v112, s[24:27], s30 offen offset:1024 sc1
  s_waitcnt lgkmcnt(0)
  v_mfma_f32_16x16x32_bf16 v[48:51], a[244:247], a[200:203], v[48:51]
  v_add_f32 v68, v68, v72
  v_add_f32 v69, v69, v73
  v_mfma_f32_16x16x32_bf16 v[52:55], a[244:247], a[208:211], 0
  v_add_f32 v70, v70, v74
  v_add_f32 v71, v71, v75
  v_mfma_f32_16x16x32_bf16 v[52:55], a[224:227], v[152:155], v[52:55]
  v_add_f32 v64, v64, v76
  v_add_f32 v65, v65, v77
  v_mfma_f32_16x16x32_bf16 v[56:59], a[224:227], v[184:187], 0
  buffer_load_dwordx4 a[240:243], v113, s[24:27], s30 offen offset:0 sc1
  v_mfma_f32_16x16x32_bf16 v[56:59], a[244:247], v[188:191], v[56:59]
  v_add_f32 v66, v66, v78
  v_add_f32 v67, v67, v79
  v_mfma_f32_16x16x32_bf16 v[60:63], a[244:247], a[188:191], 0
  v_add_f32 v64, v64, v68
  v_add_f32 v65, v65, v69
  v_mfma_f32_16x16x32_bf16 v[60:63], a[224:227], v[200:203], v[60:63]
  v_add_f32 v66, v66, v70
  v_add_f32 v67, v67, v71
  v_cvt_pk_bf16_f32 v68, v64, v65
  v_cvt_pk_bf16_f32 v69, v66, v67
  buffer_store_dwordx2 v[68:69], v125, s[24:27], s38 offen offset:2048 sc1
  v_mfma_f32_16x16x32_bf16 v[64:67], a[228:231], a[196:199], 0
  buffer_load_dwordx4 a[224:227], v113, s[24:27], s30 offen offset:1024 sc1
  s_xor_b32 s38, s40, 1
  s_lshl_b32 s38, s38, 7
  s_add_u32 s38, s38, 2834432
  v_mfma_f32_16x16x32_bf16 v[64:67], a[248:251], a[200:203], v[64:67]
  v_mov_b32 v126, 1073741824
  v_writelane_b32 v126, s38, 0
  v_mfma_f32_16x16x32_bf16 v[68:71], a[248:251], a[208:211], 0
  v_mov_b32 v127, 1
  v_mfma_f32_16x16x32_bf16 v[68:71], a[228:231], v[152:155], v[68:71]
  s_xor_b32 s38, s38, 128
  v_mov_b32 v133, s38
  v_mov_b32 v134, 4
  v_mfma_f32_16x16x32_bf16 v[72:75], a[228:231], v[184:187], 0
  s_add_u32 s30, s30, 8192
  buffer_load_dwordx4 a[244:247], v110, s[24:27], s30 offen offset:0 sc1
  v_mfma_f32_16x16x32_bf16 v[72:75], a[248:251], v[188:191], v[72:75]
  v_mfma_f32_16x16x32_bf16 v[76:79], a[248:251], a[188:191], 0
  v_mfma_f32_16x16x32_bf16 v[76:79], a[228:231], v[200:203], v[76:79]
  s_waitcnt vmcnt(30)
  v_mfma_f32_16x16x32_bf16 v[0:3], a[252:255], v[236:239], v[0:3]
  buffer_load_dwordx4 a[228:231], v110, s[24:27], s30 offen offset:1024 sc1
  v_mfma_f32_16x16x32_bf16 v[0:3], a[144:147], v[192:195], v[0:3]
  v_mfma_f32_16x16x32_bf16 v[4:7], a[144:147], v[212:215], v[4:7]
  v_mfma_f32_16x16x32_bf16 v[4:7], a[252:255], v[196:199], v[4:7]
  v_mfma_f32_16x16x32_bf16 v[8:11], a[252:255], v[216:219], v[8:11]
  buffer_load_dwordx4 a[248:251], v111, s[24:27], s30 offen offset:0 sc1
  v_mfma_f32_16x16x32_bf16 v[8:11], a[144:147], v[228:231], v[8:11]
  v_mfma_f32_16x16x32_bf16 v[12:15], a[144:147], a[192:195], v[12:15]
  v_mfma_f32_16x16x32_bf16 v[12:15], a[252:255], v[232:235], v[12:15]
  v_mfma_f32_16x16x32_bf16 v[16:19], a[128:131], v[236:239], v[16:19]
  buffer_load_dwordx4 a[196:199], v111, s[24:27], s30 offen offset:1024 sc1
  v_mfma_f32_16x16x32_bf16 v[16:19], a[148:151], v[192:195], v[16:19]
  v_mfma_f32_16x16x32_bf16 v[20:23], a[148:151], v[212:215], v[20:23]
  v_mfma_f32_16x16x32_bf16 v[20:23], a[128:131], v[196:199], v[20:23]
  v_mfma_f32_16x16x32_bf16 v[24:27], a[128:131], v[216:219], v[24:27]
  buffer_load_dwordx4 a[200:203], v112, s[24:27], s30 offen offset:0 sc1
  v_mfma_f32_16x16x32_bf16 v[24:27], a[148:151], v[228:231], v[24:27]
  v_mfma_f32_16x16x32_bf16 v[28:31], a[148:151], a[192:195], v[28:31]
  v_mfma_f32_16x16x32_bf16 v[28:31], a[128:131], v[232:235], v[28:31]
  v_mfma_f32_16x16x32_bf16 v[32:35], a[132:135], v[236:239], v[32:35]
  buffer_load_dwordx4 a[208:211], v112, s[24:27], s30 offen offset:1024 sc1
  v_mfma_f32_16x16x32_bf16 v[32:35], a[152:155], v[192:195], v[32:35]
  v_mfma_f32_16x16x32_bf16 v[36:39], a[152:155], v[212:215], v[36:39]
  v_mfma_f32_16x16x32_bf16 v[36:39], a[132:135], v[196:199], v[36:39]
  v_mfma_f32_16x16x32_bf16 v[40:43], a[132:135], v[216:219], v[40:43]
  buffer_load_dwordx4 v[184:187], v113, s[24:27], s30 offen offset:0 sc1
  v_mfma_f32_16x16x32_bf16 v[40:43], a[152:155], v[228:231], v[40:43]
  v_mfma_f32_16x16x32_bf16 v[44:47], a[152:155], a[192:195], v[44:47]
  v_mfma_f32_16x16x32_bf16 v[44:47], a[132:135], v[232:235], v[44:47]
  v_mfma_f32_16x16x32_bf16 v[48:51], a[136:139], v[236:239], v[48:51]
  buffer_load_dwordx4 v[188:191], v113, s[24:27], s30 offen offset:1024 sc1
  v_mfma_f32_16x16x32_bf16 v[48:51], a[156:159], v[192:195], v[48:51]
  v_mfma_f32_16x16x32_bf16 v[52:55], a[156:159], v[212:215], v[52:55]
  v_mfma_f32_16x16x32_bf16 v[52:55], a[136:139], v[196:199], v[52:55]
  v_mfma_f32_16x16x32_bf16 v[56:59], a[136:139], v[216:219], v[56:59]
  s_add_u32 s30, s30, 8192
  buffer_load_dwordx4 v[200:203], v110, s[24:27], s30 offen offset:0 sc1
  v_mfma_f32_16x16x32_bf16 v[56:59], a[156:159], v[228:231], v[56:59]
  v_mfma_f32_16x16x32_bf16 v[60:63], a[156:159], a[192:195], v[60:63]
  v_mfma_f32_16x16x32_bf16 v[60:63], a[136:139], v[232:235], v[60:63]
  v_mfma_f32_16x16x32_bf16 v[64:67], a[140:143], v[236:239], v[64:67]
  buffer_load_dwordx4 a[188:191], v110, s[24:27], s30 offen offset:1024 sc1
  v_mfma_f32_16x16x32_bf16 v[64:67], a[0:3], v[192:195], v[64:67]
  v_mfma_f32_16x16x32_bf16 v[68:71], a[0:3], v[212:215], v[68:71]
  v_mfma_f32_16x16x32_bf16 v[68:71], a[140:143], v[196:199], v[68:71]
  v_mfma_f32_16x16x32_bf16 v[72:75], a[140:143], v[216:219], v[72:75]
  buffer_load_dwordx4 a[252:255], v111, s[24:27], s30 offen offset:0 sc1
  v_mfma_f32_16x16x32_bf16 v[72:75], a[0:3], v[228:231], v[72:75]
  v_mfma_f32_16x16x32_bf16 v[76:79], a[0:3], a[192:195], v[76:79]
  v_mfma_f32_16x16x32_bf16 v[76:79], a[140:143], v[232:235], v[76:79]
  s_waitcnt vmcnt(32)
  v_mfma_f32_16x16x32_bf16 v[0:3], a[4:7], a[204:207], v[0:3]
  buffer_load_dwordx4 a[144:147], v111, s[24:27], s30 offen offset:1024 sc1
  v_mfma_f32_16x16x32_bf16 v[0:3], a[24:27], v[248:251], v[0:3]
  v_mfma_f32_16x16x32_bf16 v[4:7], a[24:27], v[176:179], v[4:7]
  v_mfma_f32_16x16x32_bf16 v[4:7], a[4:7], v[140:143], v[4:7]
  v_mfma_f32_16x16x32_bf16 v[8:11], a[4:7], v[180:183], v[8:11]
  buffer_load_dwordx4 a[128:131], v112, s[24:27], s30 offen offset:0 sc1
  v_mfma_f32_16x16x32_bf16 v[8:11], a[24:27], v[204:207], v[8:11]
  v_mfma_f32_16x16x32_bf16 v[12:15], a[24:27], v[220:223], v[12:15]
  v_mfma_f32_16x16x32_bf16 v[12:15], a[4:7], v[208:211], v[12:15]
  v_mfma_f32_16x16x32_bf16 v[16:19], a[8:11], a[204:207], v[16:19]
  buffer_load_dwordx4 a[148:151], v112, s[24:27], s30 offen offset:1024 sc1
  v_mfma_f32_16x16x32_bf16 v[16:19], a[28:31], v[248:251], v[16:19]
  v_mfma_f32_16x16x32_bf16 v[20:23], a[28:31], v[176:179], v[20:23]
  v_mfma_f32_16x16x32_bf16 v[20:23], a[8:11], v[140:143], v[20:23]
  v_mfma_f32_16x16x32_bf16 v[24:27], a[8:11], v[180:183], v[24:27]
  buffer_load_dwordx4 a[132:135], v113, s[24:27], s30 offen offset:0 sc1
  v_mfma_f32_16x16x32_bf16 v[24:27], a[28:31], v[204:207], v[24:27]
  v_mfma_f32_16x16x32_bf16 v[28:31], a[28:31], v[220:223], v[28:31]
  v_mfma_f32_16x16x32_bf16 v[28:31], a[8:11], v[208:211], v[28:31]
  v_mfma_f32_16x16x32_bf16 v[32:35], a[12:15], a[204:207], v[32:35]
  buffer_load_dwordx4 a[152:155], v113, s[24:27], s30 offen offset:1024 sc1
  v_mfma_f32_16x16x32_bf16 v[32:35], a[32:35], v[248:251], v[32:35]
  v_mfma_f32_16x16x32_bf16 v[36:39], a[32:35], v[176:179], v[36:39]
  v_mfma_f32_16x16x32_bf16 v[36:39], a[12:15], v[140:143], v[36:39]
  v_mfma_f32_16x16x32_bf16 v[40:43], a[12:15], v[180:183], v[40:43]
  s_add_u32 s30, s30, 8192
  buffer_load_dwordx4 a[136:139], v110, s[24:27], s30 offen offset:0 sc1
  v_mfma_f32_16x16x32_bf16 v[40:43], a[32:35], v[204:207], v[40:43]
  v_mfma_f32_16x16x32_bf16 v[44:47], a[32:35], v[220:223], v[44:47]
  v_mfma_f32_16x16x32_bf16 v[44:47], a[12:15], v[208:211], v[44:47]
  v_mfma_f32_16x16x32_bf16 v[48:51], a[16:19], a[204:207], v[48:51]
  buffer_load_dwordx4 a[156:159], v110, s[24:27], s30 offen offset:1024 sc1
  v_mfma_f32_16x16x32_bf16 v[48:51], a[36:39], v[248:251], v[48:51]
  v_mfma_f32_16x16x32_bf16 v[52:55], a[36:39], v[176:179], v[52:55]
  v_mfma_f32_16x16x32_bf16 v[52:55], a[16:19], v[140:143], v[52:55]
  v_mfma_f32_16x16x32_bf16 v[56:59], a[16:19], v[180:183], v[56:59]
  buffer_load_dwordx4 a[140:143], v111, s[24:27], s30 offen offset:0 sc1
  v_mfma_f32_16x16x32_bf16 v[56:59], a[36:39], v[204:207], v[56:59]
  v_mfma_f32_16x16x32_bf16 v[60:63], a[36:39], v[220:223], v[60:63]
  v_mfma_f32_16x16x32_bf16 v[60:63], a[16:19], v[208:211], v[60:63]
  v_mfma_f32_16x16x32_bf16 v[64:67], a[20:23], a[204:207], v[64:67]
  buffer_load_dwordx4 a[0:3], v111, s[24:27], s30 offen offset:1024 sc1
  v_mfma_f32_16x16x32_bf16 v[64:67], a[40:43], v[248:251], v[64:67]
  v_mfma_f32_16x16x32_bf16 v[68:71], a[40:43], v[176:179], v[68:71]
  v_mfma_f32_16x16x32_bf16 v[68:71], a[20:23], v[140:143], v[68:71]
  v_mfma_f32_16x16x32_bf16 v[72:75], a[20:23], v[180:183], v[72:75]
  buffer_load_dwordx4 v[236:239], v112, s[24:27], s30 offen offset:0 sc1
  v_mfma_f32_16x16x32_bf16 v[72:75], a[40:43], v[204:207], v[72:75]
  v_mfma_f32_16x16x32_bf16 v[76:79], a[40:43], v[220:223], v[76:79]
  v_mfma_f32_16x16x32_bf16 v[76:79], a[20:23], v[208:211], v[76:79]
  s_waitcnt vmcnt(34)
  v_mfma_f32_16x16x32_bf16 v[0:3], a[44:47], v[224:227], v[0:3]
  buffer_load_dwordx4 v[192:195], v112, s[24:27], s30 offen offset:1024 sc1
  s_waitcnt vmcnt(23)
  v_mfma_f32_16x16x32_bf16 v[0:3], a[64:67], v[240:243], v[0:3]
  buffer_atomic_add v127, v126, s[24:27], 0 offen
  v_mfma_f32_16x16x32_bf16 v[4:7], a[64:67], v[252:255], v[4:7]
  v_mfma_f32_16x16x32_bf16 v[4:7], a[44:47], v[244:247], v[4:7]
  v_mfma_f32_16x16x32_bf16 v[8:11], a[44:47], v[136:139], v[8:11]
  buffer_load_dwordx4 v[196:199], v113, s[24:27], s30 offen offset:0 sc1
  v_mfma_f32_16x16x32_bf16 v[8:11], a[64:67], v[144:147], v[8:11]
  v_mfma_f32_16x16x32_bf16 v[12:15], a[64:67], a[180:183], v[12:15]
  v_mfma_f32_16x16x32_bf16 v[12:15], a[44:47], v[148:151], v[12:15]
  v_mfma_f32_16x16x32_bf16 v[16:19], a[48:51], v[224:227], v[16:19]
  buffer_load_dwordx4 v[212:215], v113, s[24:27], s30 offen offset:1024 sc1
  v_mfma_f32_16x16x32_bf16 v[16:19], a[68:71], v[240:243], v[16:19]
  v_mfma_f32_16x16x32_bf16 v[20:23], a[68:71], v[252:255], v[20:23]
  v_mfma_f32_16x16x32_bf16 v[20:23], a[48:51], v[244:247], v[20:23]
  v_mfma_f32_16x16x32_bf16 v[24:27], a[48:51], v[136:139], v[24:27]
  s_add_u32 s30, s30, 8192
  v_mfma_f32_16x16x32_bf16 v[24:27], a[68:71], v[144:147], v[24:27]
  v_mfma_f32_16x16x32_bf16 v[28:31], a[68:71], a[180:183], v[28:31]
  v_mfma_f32_16x16x32_bf16 v[28:31], a[48:51], v[148:151], v[28:31]
  v_mfma_f32_16x16x32_bf16 v[32:35], a[52:55], v[224:227], v[32:35]
  v_mfma_f32_16x16x32_bf16 v[32:35], a[72:75], v[240:243], v[32:35]
  v_mfma_f32_16x16x32_bf16 v[36:39], a[72:75], v[252:255], v[36:39]
  v_mfma_f32_16x16x32_bf16 v[36:39], a[52:55], v[244:247], v[36:39]
  v_mfma_f32_16x16x32_bf16 v[40:43], a[52:55], v[136:139], v[40:43]
  v_mfma_f32_16x16x32_bf16 v[40:43], a[72:75], v[144:147], v[40:43]
  v_mfma_f32_16x16x32_bf16 v[44:47], a[72:75], a[180:183], v[44:47]
  v_mfma_f32_16x16x32_bf16 v[44:47], a[52:55], v[148:151], v[44:47]
  v_mfma_f32_16x16x32_bf16 v[48:51], a[56:59], v[224:227], v[48:51]
  v_mfma_f32_16x16x32_bf16 v[48:51], a[76:79], v[240:243], v[48:51]
  v_mfma_f32_16x16x32_bf16 v[52:55], a[76:79], v[252:255], v[52:55]
  v_mfma_f32_16x16x32_bf16 v[52:55], a[56:59], v[244:247], v[52:55]
  v_mfma_f32_16x16x32_bf16 v[56:59], a[56:59], v[136:139], v[56:59]
  v_mfma_f32_16x16x32_bf16 v[56:59], a[76:79], v[144:147], v[56:59]
  v_mfma_f32_16x16x32_bf16 v[60:63], a[76:79], a[180:183], v[60:63]
  v_mfma_f32_16x16x32_bf16 v[60:63], a[56:59], v[148:151], v[60:63]
  v_mfma_f32_16x16x32_bf16 v[64:67], a[60:63], v[224:227], v[64:67]
  v_mfma_f32_16x16x32_bf16 v[64:67], a[80:83], v[240:243], v[64:67]
  v_mfma_f32_16x16x32_bf16 v[68:71], a[80:83], v[252:255], v[68:71]
  v_mfma_f32_16x16x32_bf16 v[68:71], a[60:63], v[244:247], v[68:71]
  v_mfma_f32_16x16x32_bf16 v[72:75], a[60:63], v[136:139], v[72:75]
  v_mfma_f32_16x16x32_bf16 v[72:75], a[80:83], v[144:147], v[72:75]
  v_mfma_f32_16x16x32_bf16 v[76:79], a[80:83], a[180:183], v[76:79]
  v_mfma_f32_16x16x32_bf16 v[76:79], a[60:63], v[148:151], v[76:79]
  s_waitcnt vmcnt(25)
  v_mfma_f32_16x16x32_bf16 v[0:3], a[84:87], a[184:187], v[0:3]
  v_mfma_f32_16x16x32_bf16 v[0:3], a[104:107], a[212:215], v[0:3]
  v_mfma_f32_16x16x32_bf16 v[4:7], a[104:107], a[216:219], v[4:7]
  v_mfma_f32_16x16x32_bf16 v[4:7], a[84:87], a[232:235], v[4:7]
  v_mfma_f32_16x16x32_bf16 v[8:11], a[84:87], a[236:239], v[8:11]
  v_mfma_f32_16x16x32_bf16 v[8:11], a[104:107], a[220:223], v[8:11]
  v_mfma_f32_16x16x32_bf16 v[12:15], a[104:107], a[224:227], v[12:15]
  v_mfma_f32_16x16x32_bf16 v[12:15], a[84:87], a[240:243], v[12:15]
  v_mfma_f32_16x16x32_bf16 v[16:19], a[88:91], a[184:187], v[16:19]
  v_mfma_f32_16x16x32_bf16 v[16:19], a[108:111], a[212:215], v[16:19]
  v_mfma_f32_16x16x32_bf16 v[20:23], a[108:111], a[216:219], v[20:23]
  v_mfma_f32_16x16x32_bf16 v[20:23], a[88:91], a[232:235], v[20:23]
  v_mfma_f32_16x16x32_bf16 v[24:27], a[88:91], a[236:239], v[24:27]
  v_mfma_f32_16x16x32_bf16 v[24:27], a[108:111], a[220:223], v[24:27]
  v_mfma_f32_16x16x32_bf16 v[28:31], a[108:111], a[224:227], v[28:31]
  v_mfma_f32_16x16x32_bf16 v[28:31], a[88:91], a[240:243], v[28:31]
  v_mfma_f32_16x16x32_bf16 v[32:35], a[92:95], a[184:187], v[32:35]
  v_mfma_f32_16x16x32_bf16 v[32:35], a[112:115], a[212:215], v[32:35]
  v_mfma_f32_16x16x32_bf16 v[36:39], a[112:115], a[216:219], v[36:39]
  v_mfma_f32_16x16x32_bf16 v[36:39], a[92:95], a[232:235], v[36:39]
  v_mfma_f32_16x16x32_bf16 v[40:43], a[92:95], a[236:239], v[40:43]
  v_mfma_f32_16x16x32_bf16 v[40:43], a[112:115], a[220:223], v[40:43]
  v_mfma_f32_16x16x32_bf16 v[44:47], a[112:115], a[224:227], v[44:47]
  v_mfma_f32_16x16x32_bf16 v[44:47], a[92:95], a[240:243], v[44:47]
  v_mfma_f32_16x16x32_bf16 v[48:51], a[96:99], a[184:187], v[48:51]
  v_mfma_f32_16x16x32_bf16 v[48:51], a[116:119], a[212:215], v[48:51]
  v_mfma_f32_16x16x32_bf16 v[52:55], a[116:119], a[216:219], v[52:55]
  v_mfma_f32_16x16x32_bf16 v[52:55], a[96:99], a[232:235], v[52:55]
  v_mfma_f32_16x16x32_bf16 v[56:59], a[96:99], a[236:239], v[56:59]
  v_mfma_f32_16x16x32_bf16 v[56:59], a[116:119], a[220:223], v[56:59]
  v_mfma_f32_16x16x32_bf16 v[60:63], a[116:119], a[224:227], v[60:63]
  v_mfma_f32_16x16x32_bf16 v[60:63], a[96:99], a[240:243], v[60:63]
  v_mfma_f32_16x16x32_bf16 v[64:67], a[100:103], a[184:187], v[64:67]
  ds_read_b128 v[216:219], v122 offset:0
  v_mfma_f32_16x16x32_bf16 v[64:67], a[120:123], a[212:215], v[64:67]
  v_mfma_f32_16x16x32_bf16 v[68:71], a[120:123], a[216:219], v[68:71]
  v_mfma_f32_16x16x32_bf16 v[68:71], a[100:103], a[232:235], v[68:71]
  v_mfma_f32_16x16x32_bf16 v[72:75], a[100:103], a[236:239], v[72:75]
  v_mfma_f32_16x16x32_bf16 v[72:75], a[120:123], a[220:223], v[72:75]
  v_mfma_f32_16x16x32_bf16 v[76:79], a[120:123], a[224:227], v[76:79]
  v_mfma_f32_16x16x32_bf16 v[76:79], a[100:103], a[240:243], v[76:79]
  s_waitcnt vmcnt(17)
  v_mfma_f32_16x16x32_bf16 v[0:3], a[124:127], a[244:247], v[0:3]
  ds_read_b128 v[228:231], v122 offset:1024
  buffer_load_dword v128, v133, s[24:27], 0 offen sc1
  s_xor_b32 s38, s40, 0
  s_lshl_b32 s38, s38, 2
  s_add_u32 s38, s38, s3
  v_mfma_f32_16x16x32_bf16 v[0:3], a[176:179], a[228:231], v[0:3]
  s_lshl_b32 s38, s38, 13
  s_add_u32 s38, s38, 25165824
  s_add_u32 s39, s38, 4096
  v_mfma_f32_16x16x32_bf16 v[4:7], a[176:179], a[196:199], v[4:7]
  v_mfma_f32_16x16x32_bf16 v[4:7], a[124:127], a[248:251], v[4:7]
  v_mfma_f32_16x16x32_bf16 v[8:11], a[124:127], a[200:203], v[8:11]
  v_mfma_f32_16x16x32_bf16 v[8:11], a[176:179], a[208:211], v[8:11]
  v_mfma_f32_16x16x32_bf16 v[12:15], a[176:179], v[188:191], v[12:15]
  v_mfma_f32_16x16x32_bf16 v[12:15], a[124:127], v[184:187], v[12:15]
  s_waitcnt lgkmcnt(1)
  v_mfma_f32_16x16x32_bf16 v[16:19], a[160:163], a[244:247], v[16:19]
  ds_read_b128 v[232:235], v122 offset:2048
  v_mfma_f32_16x16x32_bf16 v[16:19], v[216:219], a[228:231], v[16:19]
  v_mfma_f32_16x16x32_bf16 v[20:23], v[216:219], a[196:199], v[20:23]
  v_mfma_f32_16x16x32_bf16 v[20:23], a[160:163], a[248:251], v[20:23]
  v_mfma_f32_16x16x32_bf16 v[24:27], a[160:163], a[200:203], v[24:27]
  v_mfma_f32_16x16x32_bf16 v[24:27], v[216:219], a[208:211], v[24:27]
  v_mfma_f32_16x16x32_bf16 v[28:31], v[216:219], v[188:191], v[28:31]
  v_mfma_f32_16x16x32_bf16 v[28:31], a[160:163], v[184:187], v[28:31]
  s_waitcnt lgkmcnt(1)
  v_mfma_f32_16x16x32_bf16 v[32:35], a[164:167], a[244:247], v[32:35]
  ds_read_b128 a[192:195], v122 offset:3072
  v_mfma_f32_16x16x32_bf16 v[32:35], v[228:231], a[228:231], v[32:35]
  v_mfma_f32_16x16x32_bf16 v[36:39], v[228:231], a[196:199], v[36:39]
  v_mfma_f32_16x16x32_bf16 v[36:39], a[164:167], a[248:251], v[36:39]
  v_mfma_f32_16x16x32_bf16 v[40:43], a[164:167], a[200:203], v[40:43]
  v_mfma_f32_16x16x32_bf16 v[40:43], v[228:231], a[208:211], v[40:43]
  v_mfma_f32_16x16x32_bf16 v[44:47], v[228:231], v[188:191], v[44:47]
  v_mfma_f32_16x16x32_bf16 v[44:47], a[164:167], v[184:187], v[44:47]
  s_waitcnt lgkmcnt(1)
  v_mfma_f32_16x16x32_bf16 v[48:51], a[168:171], a[244:247], v[48:51]
  ds_read_b128 a[4:7], v122 offset:16384
  ds_read_b128 a[24:27], v122 offset:33792
  v_mfma_f32_16x16x32_bf16 v[48:51], v[232:235], a[228:231], v[48:51]
  v_mfma_f32_16x16x32_bf16 v[52:55], v[232:235], a[196:199], v[52:55]
  v_mfma_f32_16x16x32_bf16 v[52:55], a[168:171], a[248:251], v[52:55]
  v_mfma_f32_16x16x32_bf16 v[56:59], a[168:171], a[200:203], v[56:59]
  v_mfma_f32_16x16x32_bf16 v[56:59], v[232:235], a[208:211], v[56:59]
  v_mfma_f32_16x16x32_bf16 v[60:63], v[232:235], v[188:191], v[60:63]
  v_mfma_f32_16x16x32_bf16 v[60:63], a[168:171], v[184:187], v[60:63]
  s_waitcnt lgkmcnt(2)
  v_mfma_f32_16x16x32_bf16 v[64:67], a[172:175], a[244:247], v[64:67]
  ds_read_b128 a[8:11], v122 offset:17408
  ds_read_b128 a[28:31], v122 offset:34816
  v_mfma_f32_16x16x32_bf16 v[64:67], a[192:195], a[228:231], v[64:67]
  v_mfma_f32_16x16x32_bf16 v[68:71], a[192:195], a[196:199], v[68:71]
  v_mfma_f32_16x16x32_bf16 v[68:71], a[172:175], a[248:251], v[68:71]
  v_mfma_f32_16x16x32_bf16 v[72:75], a[172:175], a[200:203], v[72:75]
  v_mfma_f32_16x16x32_bf16 v[72:75], a[192:195], a[208:211], v[72:75]
  v_mfma_f32_16x16x32_bf16 v[76:79], a[192:195], v[188:191], v[76:79]
  v_mfma_f32_16x16x32_bf16 v[76:79], a[172:175], v[184:187], v[76:79]
  s_waitcnt vmcnt(10) lgkmcnt(2)
  v_mfma_f32_16x16x32_bf16 v[0:3], a[4:7], v[200:203], v[0:3]
  ds_read_b128 a[12:15], v122 offset:18432
  ds_read_b128 a[32:35], v122 offset:35840
  v_mfma_f32_16x16x32_bf16 v[0:3], a[24:27], a[188:191], v[0:3]
  v_mfma_f32_16x16x32_bf16 v[4:7], a[24:27], a[144:147], v[4:7]
  v_mfma_f32_16x16x32_bf16 v[4:7], a[4:7], a[252:255], v[4:7]
  v_mfma_f32_16x16x32_bf16 v[8:11], a[4:7], a[128:131], v[8:11]
  v_mfma_f32_16x16x32_bf16 v[8:11], a[24:27], a[148:151], v[8:11]
  v_mfma_f32_16x16x32_bf16 v[12:15], a[24:27], a[152:155], v[12:15]
  v_mfma_f32_16x16x32_bf16 v[12:15], a[4:7], a[132:135], v[12:15]
  s_waitcnt lgkmcnt(2)
  v_mfma_f32_16x16x32_bf16 v[16:19], a[8:11], v[200:203], v[16:19]
  ds_read_b128 a[16:19], v122 offset:19456
  ds_read_b128 a[36:39], v135 offset:0
  v_mfma_f32_16x16x32_bf16 v[16:19], a[28:31], a[188:191], v[16:19]
  v_mfma_f32_16x16x32_bf16 v[20:23], a[28:31], a[144:147], v[20:23]
  v_mfma_f32_16x16x32_bf16 v[20:23], a[8:11], a[252:255], v[20:23]
  v_mfma_f32_16x16x32_bf16 v[24:27], a[8:11], a[128:131], v[24:27]
  v_mfma_f32_16x16x32_bf16 v[24:27], a[28:31], a[148:151], v[24:27]
  v_mfma_f32_16x16x32_bf16 v[28:31], a[28:31], a[152:155], v[28:31]
  v_mfma_f32_16x16x32_bf16 v[28:31], a[8:11], a[132:135], v[28:31]
  s_waitcnt lgkmcnt(2)
  v_mfma_f32_16x16x32_bf16 v[32:35], a[12:15], v[200:203], v[32:35]
  ds_read_b128 a[20:23], v122 offset:32768
  ds_read_b128 a[40:43], v135 offset:1024
  v_mfma_f32_16x16x32_bf16 v[32:35], a[32:35], a[188:191], v[32:35]
  v_mfma_f32_16x16x32_bf16 v[36:39], a[32:35], a[144:147], v[36:39]
  v_mfma_f32_16x16x32_bf16 v[36:39], a[12:15], a[252:255], v[36:39]
  v_mfma_f32_16x16x32_bf16 v[40:43], a[12:15], a[128:131], v[40:43]
  v_mfma_f32_16x16x32_bf16 v[40:43], a[32:35], a[148:151], v[40:43]
  v_mfma_f32_16x16x32_bf16 v[44:47], a[32:35], a[152:155], v[44:47]
  v_mfma_f32_16x16x32_bf16 v[44:47], a[12:15], a[132:135], v[44:47]
  s_waitcnt lgkmcnt(2)
  v_mfma_f32_16x16x32_bf16 v[48:51], a[16:19], v[200:203], v[48:51]
  ds_read_b128 a[204:207], v135 offset:2048
  ds_read_b128 v[248:251], v135 offset:19456
  v_mfma_f32_16x16x32_bf16 v[48:51], a[36:39], a[188:191], v[48:51]
  v_mfma_f32_16x16x32_bf16 v[52:55], a[36:39], a[144:147], v[52:55]
  v_mfma_f32_16x16x32_bf16 v[52:55], a[16:19], a[252:255], v[52:55]
  v_mfma_f32_16x16x32_bf16 v[56:59], a[16:19], a[128:131], v[56:59]
  v_mfma_f32_16x16x32_bf16 v[56:59], a[36:39], a[148:151], v[56:59]
  v_mfma_f32_16x16x32_bf16 v[60:63], a[36:39], a[152:155], v[60:63]
  v_mfma_f32_16x16x32_bf16 v[60:63], a[16:19], a[132:135], v[60:63]
  s_waitcnt lgkmcnt(2)
  v_mfma_f32_16x16x32_bf16 v[64:67], a[20:23], v[200:203], v[64:67]
  ds_read_b128 v[176:179], v135 offset:3072
  ds_read_b128 v[180:183], v122 offset:49152
  v_mfma_f32_16x16x32_bf16 v[64:67], a[40:43], a[188:191], v[64:67]
  v_mfma_f32_16x16x32_bf16 v[68:71], a[40:43], a[144:147], v[68:71]
  v_mfma_f32_16x16x32_bf16 v[68:71], a[20:23], a[252:255], v[68:71]
  v_mfma_f32_16x16x32_bf16 v[72:75], a[20:23], a[128:131], v[72:75]
  v_mfma_f32_16x16x32_bf16 v[72:75], a[40:43], a[148:151], v[72:75]
  v_mfma_f32_16x16x32_bf16 v[76:79], a[40:43], a[152:155], v[76:79]
  v_mfma_f32_16x16x32_bf16 v[76:79], a[20:23], a[132:135], v[76:79]
  s_waitcnt vmcnt(0)
  v_cmp_lt_u32 vcc, v128, v134
  s_nop 0
  s_cbranch_vccz tail_partner
  s_mov_b32 s35, 32768
tail_spin2:
  s_sleep 2
  buffer_load_dword v128, v133, s[24:27], 0 offen sc1
  s_waitcnt vmcnt(0)
  v_cmp_lt_u32 vcc, v128, v134
  s_nop 0
  s_cbranch_vccz tail_partner
  s_sub_u32 s35, s35, 1
  s_cmp_lg_u32 s35, 0
  s_cbranch_scc1 tail_spin2
tail_partner:
  s_waitcnt lgkmcnt(2)
  v_mfma_f32_16x16x32_bf16 v[0:3], a[204:207], a[136:139], v[0:3]
  ds_read_b128 v[204:207], v135 offset:16384
  ds_read_b128 v[208:211], v122 offset:50176
  v_mfma_f32_16x16x32_bf16 v[0:3], v[248:251], a[156:159], v[0:3]
  buffer_load_dwordx2 v[138:139], v125, s[24:27], s38 offen offset:0 sc1
  v_mfma_f32_16x16x32_bf16 v[4:7], v[248:251], a[0:3], v[4:7]
  buffer_load_dwordx2 v[142:143], v125, s[24:27], s38 offen offset:512 sc1
  v_mfma_f32_16x16x32_bf16 v[4:7], a[204:207], a[140:143], v[4:7]
  buffer_load_dwordx2 v[146:147], v125, s[24:27], s38 offen offset:1024 sc1
  v_mfma_f32_16x16x32_bf16 v[8:11], a[204:207], v[236:239], v[8:11]
  buffer_load_dwordx2 v[150:151], v125, s[24:27], s38 offen offset:1536 sc1
  v_mfma_f32_16x16x32_bf16 v[8:11], v[248:251], v[192:195], v[8:11]
  buffer_load_dwordx2 v[154:155], v125, s[24:27], s38 offen offset:2048 sc1
  v_mfma_f32_16x16x32_bf16 v[12:15], v[248:251], v[212:215], v[12:15]
  v_mfma_f32_16x16x32_bf16 v[12:15], a[204:207], v[196:199], v[12:15]
  s_waitcnt lgkmcnt(2)
  v_mfma_f32_16x16x32_bf16 v[16:19], v[176:179], a[136:139], v[16:19]
  ds_read_b128 v[220:223], v135 offset:17408
  ds_read_b128 a[44:47], v122 offset:51200
  v_mfma_f32_16x16x32_bf16 v[16:19], v[180:183], a[156:159], v[16:19]
  ds_write_b128 v122, v[4:7] offset:0
  ds_write_b128 v122, v[8:11] offset:17408
  v_mfma_f32_16x16x32_bf16 v[20:23], v[180:183], a[0:3], v[20:23]
  ds_write_b128 v122, v[12:15] offset:34816
  v_mfma_f32_16x16x32_bf16 v[20:23], v[176:179], a[140:143], v[20:23]
  v_mfma_f32_16x16x32_bf16 v[24:27], v[176:179], v[236:239], v[24:27]
  v_mfma_f32_16x16x32_bf16 v[24:27], v[180:183], v[192:195], v[24:27]
  v_mfma_f32_16x16x32_bf16 v[28:31], v[180:183], v[212:215], v[28:31]
  v_mfma_f32_16x16x32_bf16 v[28:31], v[176:179], v[196:199], v[28:31]
  s_waitcnt lgkmcnt(5)
  v_mfma_f32_16x16x32_bf16 v[32:35], v[204:207], a[136:139], v[32:35]
  ds_read_b128 a[64:67], v135 offset:18432
  ds_read_b128 a[48:51], v122 offset:52224
  v_mfma_f32_16x16x32_bf16 v[32:35], v[208:211], a[156:159], v[32:35]
  ds_write_b128 v122, v[20:23] offset:1024
  ds_write_b128 v122, v[24:27] offset:18432
  v_mfma_f32_16x16x32_bf16 v[36:39], v[208:211], a[0:3], v[36:39]
  ds_write_b128 v122, v[28:31] offset:35840
  v_mfma_f32_16x16x32_bf16 v[36:39], v[204:207], a[140:143], v[36:39]
  v_mfma_f32_16x16x32_bf16 v[40:43], v[204:207], v[236:239], v[40:43]
  v_mfma_f32_16x16x32_bf16 v[40:43], v[208:211], v[192:195], v[40:43]
  v_mfma_f32_16x16x32_bf16 v[44:47], v[208:211], v[212:215], v[44:47]
  v_mfma_f32_16x16x32_bf16 v[44:47], v[204:207], v[196:199], v[44:47]
  s_waitcnt lgkmcnt(8)
  v_mfma_f32_16x16x32_bf16 v[48:51], v[220:223], a[136:139], v[48:51]
  v_mfma_f32_16x16x32_bf16 v[48:51], a[44:47], a[156:159], v[48:51]
  v_mfma_f32_16x16x32_bf16 v[52:55], a[44:47], a[0:3], v[52:55]
  ds_write_b128 v122, v[36:39] offset:2048
  v_mfma_f32_16x16x32_bf16 v[52:55], v[220:223], a[140:143], v[52:55]
  ds_write_b128 v122, v[40:43] offset:19456
  v_mfma_f32_16x16x32_bf16 v[56:59], v[220:223], v[236:239], v[56:59]
  ds_write_b128 v122, v[44:47] offset:49152
  v_mfma_f32_16x16x32_bf16 v[56:59], a[44:47], v[192:195], v[56:59]
  v_mfma_f32_16x16x32_bf16 v[60:63], a[44:47], v[212:215], v[60:63]
  v_mfma_f32_16x16x32_bf16 v[60:63], v[220:223], v[196:199], v[60:63]
  s_waitcnt lgkmcnt(6)
  v_mfma_f32_16x16x32_bf16 v[64:67], a[64:67], a[136:139], v[64:67]
  ds_write_b128 v122, v[52:55] offset:3072
  v_mfma_f32_16x16x32_bf16 v[64:67], a[48:51], a[156:159], v[64:67]
  v_mfma_f32_16x16x32_bf16 v[68:71], a[48:51], a[0:3], v[68:71]
  v_mfma_f32_16x16x32_bf16 v[68:71], a[64:67], a[140:143], v[68:71]
  ds_write_b128 v122, v[56:59] offset:32768
  v_mfma_f32_16x16x32_bf16 v[72:75], a[64:67], v[236:239], v[72:75]
  ds_write_b128 v122, v[60:63] offset:50176
  v_mfma_f32_16x16x32_bf16 v[72:75], a[48:51], v[192:195], v[72:75]
  v_mfma_f32_16x16x32_bf16 v[76:79], a[48:51], v[212:215], v[76:79]
  v_mfma_f32_16x16x32_bf16 v[76:79], a[64:67], v[196:199], v[76:79]
  s_nop 1
  ds_write_b128 v122, v[68:71] offset:16384
  s_nop 2
  ds_write_b128 v122, v[72:75] offset:33792
  s_nop 0
  ds_write_b128 v122, v[76:79] offset:51200
  s_waitcnt lgkmcnt(0)
  s_barrier
  ds_read_b128 v[4:7], v80 offset:0
  ds_read_b128 v[8:11], v81 offset:17408
  ds_read_b128 v[12:15], v82 offset:34816
  ds_read_b128 v[20:23], v80 offset:1024
  ds_read_b128 v[24:27], v81 offset:18432
  ds_read_b128 v[28:31], v82 offset:35840
  ds_read_b128 v[36:39], v80 offset:2048
  ds_read_b128 v[40:43], v81 offset:19456
  ds_read_b128 v[44:47], v82 offset:49152
  ds_read_b128 v[52:55], v80 offset:3072
  ds_read_b128 v[56:59], v81 offset:32768
  ds_read_b128 v[60:63], v82 offset:50176
  ds_read_b128 v[68:71], v80 offset:16384
  ds_read_b128 v[72:75], v81 offset:33792
  ds_read_b128 v[76:79], v82 offset:51200
  s_waitcnt vmcnt(4)
  v_lshlrev_b32 v136, 16, v138
  v_and_b32 v137, s34, v138
  v_lshlrev_b32 v138, 16, v139
  v_and_b32 v139, s34, v139
  v_add_f32 v0, v0, v136
  v_add_f32 v1, v1, v137
  v_add_f32 v2, v2, v138
  v_add_f32 v3, v3, v139
  s_waitcnt lgkmcnt(13)
  v_add_f32 v4, v4, v8
  v_add_f32 v5, v5, v9
  v_add_f32 v6, v6, v10
  v_add_f32 v7, v7, v11
  s_waitcnt lgkmcnt(12)
  v_add_f32 v0, v0, v12
  v_add_f32 v1, v1, v13
  v_add_f32 v2, v2, v14
  v_add_f32 v3, v3, v15
  v_add_f32 v0, v0, v4
  v_add_f32 v1, v1, v5
  v_add_f32 v2, v2, v6
  v_add_f32 v3, v3, v7
  v_cvt_pk_bf16_f32 v4, v0, v1
  v_cvt_pk_bf16_f32 v5, v2, v3
  v_lshlrev_b32 v0, 16, v4
  v_and_b32 v1, s34, v4
  v_lshlrev_b32 v2, 16, v5
  v_and_b32 v3, s34, v5
  v_mul_f32 v0, v0, v90
  v_mul_f32 v1, v1, v91
  v_mul_f32 v2, v2, v92
  v_mul_f32 v3, v3, v93
  v_cvt_pk_bf16_f32 v4, v0, v1
  v_cvt_pk_bf16_f32 v5, v2, v3
  v_lshlrev_b32 v0, 16, v4
  v_and_b32 v1, s34, v4
  v_lshlrev_b32 v2, 16, v5
  v_and_b32 v3, s34, v5
  v_add_f32 v0, v0, v156
  v_add_f32 v1, v1, v157
  v_add_f32 v2, v2, v158
  v_add_f32 v3, v3, v159
  v_cvt_pk_bf16_f32 v4, v0, v1
  v_cvt_pk_bf16_f32 v5, v2, v3
  s_waitcnt vmcnt(3)
  v_lshlrev_b32 v140, 16, v142
  v_and_b32 v141, s34, v142
  v_lshlrev_b32 v142, 16, v143
  v_and_b32 v143, s34, v143
  v_add_f32 v16, v16, v140
  v_add_f32 v17, v17, v141
  v_add_f32 v18, v18, v142
  v_add_f32 v19, v19, v143
  s_waitcnt lgkmcnt(10)
  v_add_f32 v20, v20, v24
  v_add_f32 v21, v21, v25
  v_add_f32 v22, v22, v26
  v_add_f32 v23, v23, v27
  s_waitcnt lgkmcnt(9)
  v_add_f32 v16, v16, v28
  v_add_f32 v17, v17, v29
  v_add_f32 v18, v18, v30
  v_add_f32 v19, v19, v31
  v_add_f32 v16, v16, v20
  v_add_f32 v17, v17, v21
  v_add_f32 v18, v18, v22
  v_add_f32 v19, v19, v23
  v_cvt_pk_bf16_f32 v20, v16, v17
  v_cvt_pk_bf16_f32 v21, v18, v19
  v_lshlrev_b32 v16, 16, v20
  v_and_b32 v17, s34, v20
  v_lshlrev_b32 v18, 16, v21
  v_and_b32 v19, s34, v21
  v_mul_f32 v16, v16, v94
  v_mul_f32 v17, v17, v95
  v_mul_f32 v18, v18, v96
  v_mul_f32 v19, v19, v97
  v_cvt_pk_bf16_f32 v20, v16, v17
  v_cvt_pk_bf16_f32 v21, v18, v19
  v_lshlrev_b32 v16, 16, v20
  v_and_b32 v17, s34, v20
  v_lshlrev_b32 v18, 16, v21
  v_and_b32 v19, s34, v21
  v_add_f32 v16, v16, v160
  v_add_f32 v17, v17, v161
  v_add_f32 v18, v18, v162
  v_add_f32 v19, v19, v163
  v_cvt_pk_bf16_f32 v6, v16, v17
  v_cvt_pk_bf16_f32 v7, v18, v19
  s_nop 0
  v_permlane16_swap_b32 v4, v6
  v_permlane16_swap_b32 v5, v7
  buffer_store_dwordx4 v[4:7], v83, s[16:19], 0 offen offset:0
  s_waitcnt vmcnt(3)
  v_lshlrev_b32 v144, 16, v146
  v_and_b32 v145, s34, v146
  v_lshlrev_b32 v146, 16, v147
  v_and_b32 v147, s34, v147
  v_add_f32 v32, v32, v144
  v_add_f32 v33, v33, v145
  v_add_f32 v34, v34, v146
  v_add_f32 v35, v35, v147
  s_waitcnt lgkmcnt(7)
  v_add_f32 v36, v36, v40
  v_add_f32 v37, v37, v41
  v_add_f32 v38, v38, v42
  v_add_f32 v39, v39, v43
  s_waitcnt lgkmcnt(6)
  v_add_f32 v32, v32, v44
  v_add_f32 v33, v33, v45
  v_add_f32 v34, v34, v46
  v_add_f32 v35, v35, v47
  v_add_f32 v32, v32, v36
  v_add_f32 v33, v33, v37
  v_add_f32 v34, v34, v38
  v_add_f32 v35, v35, v39
  v_cvt_pk_bf16_f32 v36, v32, v33
  v_cvt_pk_bf16_f32 v37, v34, v35
  v_lshlrev_b32 v32, 16, v36
  v_and_b32 v33, s34, v36
  v_lshlrev_b32 v34, 16, v37
  v_and_b32 v35, s34, v37
  v_mul_f32 v32, v32, v98
  v_mul_f32 v33, v33, v99
  v_mul_f32 v34, v34, v100
  v_mul_f32 v35, v35, v101
  v_cvt_pk_bf16_f32 v36, v32, v33
  v_cvt_pk_bf16_f32 v37, v34, v35
  v_lshlrev_b32 v32, 16, v36
  v_and_b32 v33, s34, v36
  v_lshlrev_b32 v34, 16, v37
  v_and_b32 v35, s34, v37
  v_add_f32 v32, v32, v164
  v_add_f32 v33, v33, v165
  v_add_f32 v34, v34, v166
  v_add_f32 v35, v35, v167
  v_cvt_pk_bf16_f32 v36, v32, v33
  v_cvt_pk_bf16_f32 v37, v34, v35
  s_waitcnt vmcnt(2)
  v_lshlrev_b32 v148, 16, v150
  v_and_b32 v149, s34, v150
  v_lshlrev_b32 v150, 16, v151
  v_and_b32 v151, s34, v151
  v_add_f32 v48, v48, v148
  v_add_f32 v49, v49, v149
  v_add_f32 v50, v50, v150
  v_add_f32 v51, v51, v151
  s_waitcnt lgkmcnt(4)
  v_add_f32 v52, v52, v56
  v_add_f32 v53, v53, v57
  v_add_f32 v54, v54, v58
  v_add_f32 v55, v55, v59
  s_waitcnt lgkmcnt(3)
  v_add_f32 v48, v48, v60
  v_add_f32 v49, v49, v61
  v_add_f32 v50, v50, v62
  v_add_f32 v51, v51, v63
  v_add_f32 v48, v48, v52
  v_add_f32 v49, v49, v53
  v_add_f32 v50, v50, v54
  v_add_f32 v51, v51, v55
  v_cvt_pk_bf16_f32 v52, v48, v49
  v_cvt_pk_bf16_f32 v53, v50, v51
  v_lshlrev_b32 v48, 16, v52
  v_and_b32 v49, s34, v52
  v_lshlrev_b32 v50, 16, v53
  v_and_b32 v51, s34, v53
  v_mul_f32 v48, v48, v102
  v_mul_f32 v49, v49, v103
  v_mul_f32 v50, v50, v104
  v_mul_f32 v51, v51, v105
  v_cvt_pk_bf16_f32 v52, v48, v49
  v_cvt_pk_bf16_f32 v53, v50, v51
  v_lshlrev_b32 v48, 16, v52
  v_and_b32 v49, s34, v52
  v_lshlrev_b32 v50, 16, v53
  v_and_b32 v51, s34, v53
  v_add_f32 v48, v48, v168
  v_add_f32 v49, v49, v169
  v_add_f32 v50, v50, v170
  v_add_f32 v51, v51, v171
  v_cvt_pk_bf16_f32 v38, v48, v49
  v_cvt_pk_bf16_f32 v39, v50, v51
  s_nop 0
  v_permlane16_swap_b32 v36, v38
  v_permlane16_swap_b32 v37, v39
  buffer_store_dwordx4 v[36:39], v83, s[16:19], 0 offen offset:64
  s_waitcnt vmcnt(2)
  v_lshlrev_b32 v152, 16, v154
  v_and_b32 v153, s34, v154
  v_lshlrev_b32 v154, 16, v155
  v_and_b32 v155, s34, v155
  v_add_f32 v64, v64, v152
  v_add_f32 v65, v65, v153
  v_add_f32 v66, v66, v154
  v_add_f32 v67, v67, v155
  s_waitcnt lgkmcnt(1)
  v_add_f32 v68, v68, v72
  v_add_f32 v69, v69, v73
  v_add_f32 v70, v70, v74
  v_add_f32 v71, v71, v75
  s_waitcnt lgkmcnt(0)
  v_add_f32 v64, v64, v76
  v_add_f32 v65, v65, v77
  v_add_f32 v66, v66, v78
  v_add_f32 v67, v67, v79
  v_add_f32 v64, v64, v68
  v_add_f32 v65, v65, v69
  v_add_f32 v66, v66, v70
  v_add_f32 v67, v67, v71
  v_cvt_pk_bf16_f32 v68, v64, v65
  v_cvt_pk_bf16_f32 v69, v66, v67
  v_lshlrev_b32 v64, 16, v68
  v_and_b32 v65, s34, v68
  v_lshlrev_b32 v66, 16, v69
  v_and_b32 v67, s34, v69
  v_mul_f32 v64, v64, v106
  v_mul_f32 v65, v65, v107
  v_mul_f32 v66, v66, v108
  v_mul_f32 v67, v67, v109
  v_cvt_pk_bf16_f32 v68, v64, v65
  v_cvt_pk_bf16_f32 v69, v66, v67
  v_lshlrev_b32 v64, 16, v68
  v_and_b32 v65, s34, v68
  v_lshlrev_b32 v66, 16, v69
  v_and_b32 v67, s34, v69
  v_add_f32 v64, v64, v172
  v_add_f32 v65, v65, v173
  v_add_f32 v66, v66, v174
  v_add_f32 v67, v67, v175
  v_cvt_pk_bf16_f32 v68, v64, v65
  v_cvt_pk_bf16_f32 v69, v66, v67
  buffer_store_dwordx2 v[68:69], v117, s[16:19], 0 offen offset:128
attn_end:
  s_endpgm
attn_redo:
  s_waitcnt vmcnt(0)
  v_accvgpr_write_b32 a0, 0
  v_accvgpr_write_b32 a1, 0
  v_accvgpr_write_b32 a2, 0
  v_accvgpr_write_b32 a3, 0
  v_accvgpr_write_b32 a4, 0
  v_accvgpr_write_b32 a5, 0
  v_accvgpr_write_b32 a6, 0
  v_accvgpr_write_b32 a7, 0
  v_accvgpr_write_b32 a8, 0
  v_accvgpr_write_b32 a9, 0
  v_accvgpr_write_b32 a10, 0
  v_accvgpr_write_b32 a11, 0
  v_accvgpr_write_b32 a12, 0
  v_accvgpr_write_b32 a13, 0
  v_accvgpr_write_b32 a14, 0
  v_accvgpr_write_b32 a15, 0
  v_accvgpr_write_b32 a16, 0
  v_accvgpr_write_b32 a17, 0
  v_accvgpr_write_b32 a18, 0
  v_accvgpr_write_b32 a19, 0
  v_accvgpr_write_b32 a20, 0
  v_accvgpr_write_b32 a21, 0
  v_accvgpr_write_b32 a22, 0
  v_accvgpr_write_b32 a23, 0
  v_accvgpr_write_b32 a24, 0
  v_accvgpr_write_b32 a25, 0
  v_accvgpr_write_b32 a26, 0
  v_accvgpr_write_b32 a27, 0
  v_accvgpr_write_b32 a28, 0
  v_accvgpr_write_b32 a29, 0
  v_accvgpr_write_b32 a30, 0
  v_accvgpr_write_b32 a31, 0
  v_accvgpr_write_b32 a32, 0
  v_accvgpr_write_b32 a33, 0
  v_accvgpr_write_b32 a34, 0
  v_accvgpr_write_b32 a35, 0
  v_accvgpr_write_b32 a36, 0
  v_accvgpr_write_b32 a37, 0
  v_accvgpr_write_b32 a38, 0
  v_accvgpr_write_b32 a39, 0
  v_accvgpr_write_b32 a40, 0
  v_accvgpr_write_b32 a41, 0
  v_accvgpr_write_b32 a42, 0
  v_accvgpr_write_b32 a43, 0
  v_accvgpr_write_b32 a44, 0
  v_accvgpr_write_b32 a45, 0
  v_accvgpr_write_b32 a46, 0
  v_accvgpr_write_b32 a47, 0
  v_accvgpr_write_b32 a48, 0
  v_accvgpr_write_b32 a49, 0
  v_accvgpr_write_b32 a50, 0
  v_accvgpr_write_b32 a51, 0
  v_accvgpr_write_b32 a52, 0
  v_accvgpr_write_b32 a53, 0
  v_accvgpr_write_b32 a54, 0
  v_accvgpr_write_b32 a55, 0
  v_accvgpr_write_b32 a56, 0
  v_accvgpr_write_b32 a57, 0
  v_accvgpr_write_b32 a58, 0
  v_accvgpr_write_b32 a59, 0
  v_accvgpr_write_b32 a60, 0
  v_accvgpr_write_b32 a61, 0
  v_accvgpr_write_b32 a62, 0
  v_accvgpr_write_b32 a63, 0
  v_accvgpr_write_b32 a64, 0
  v_accvgpr_write_b32 a65, 0
  v_accvgpr_write_b32 a66, 0
  v_accvgpr_write_b32 a67, 0
  v_accvgpr_write_b32 a68, 0
  v_accvgpr_write_b32 a69, 0
  v_accvgpr_write_b32 a70, 0
  v_accvgpr_write_b32 a71, 0
  v_accvgpr_write_b32 a72, 0
  v_accvgpr_write_b32 a73, 0
  v_accvgpr_write_b32 a74, 0
  v_accvgpr_write_b32 a75, 0
  v_accvgpr_write_b32 a76, 0
  v_accvgpr_write_b32 a77, 0
  v_accvgpr_write_b32 a78, 0
  v_accvgpr_write_b32 a79, 0
  v_accvgpr_write_b32 a80, 0
  v_accvgpr_write_b32 a81, 0
  v_accvgpr_write_b32 a82, 0
  v_accvgpr_write_b32 a83, 0
  v_accvgpr_write_b32 a84, 0
  v_accvgpr_write_b32 a85, 0
  v_accvgpr_write_b32 a86, 0
  v_accvgpr_write_b32 a87, 0
  v_accvgpr_write_b32 a88, 0
  v_accvgpr_write_b32 a89, 0
  v_accvgpr_write_b32 a90, 0
  v_accvgpr_write_b32 a91, 0
  v_accvgpr_write_b32 a92, 0
  v_accvgpr_write_b32 a93, 0
  v_accvgpr_write_b32 a94, 0
  v_accvgpr_write_b32 a95, 0
  v_accvgpr_write_b32 a96, 0
  v_accvgpr_write_b32 a97, 0
  v_accvgpr_write_b32 a98, 0
  v_accvgpr_write_b32 a99, 0
  v_accvgpr_write_b32 a100, 0
  v_accvgpr_write_b32 a101, 0
  v_accvgpr_write_b32 a102, 0
  v_accvgpr_write_b32 a103, 0
  v_accvgpr_write_b32 a104, 0
  v_accvgpr_write_b32 a105, 0
  v_accvgpr_write_b32 a106, 0
  v_accvgpr_write_b32 a107, 0
  v_accvgpr_write_b32 a108, 0
  v_accvgpr_write_b32 a109, 0
  v_accvgpr_write_b32 a110, 0
  v_accvgpr_write_b32 a111, 0
  v_accvgpr_write_b32 a112, 0
  v_accvgpr_write_b32 a113, 0
  v_accvgpr_write_b32 a114, 0
  v_accvgpr_write_b32 a115, 0
  v_accvgpr_write_b32 a116, 0
  v_accvgpr_write_b32 a117, 0
  v_accvgpr_write_b32 a118, 0
  v_accvgpr_write_b32 a119, 0
  v_accvgpr_write_b32 a120, 0
  v_accvgpr_write_b32 a121, 0
  v_accvgpr_write_b32 a122, 0
  v_accvgpr_write_b32 a123, 0
  v_accvgpr_write_b32 a124, 0
  v_accvgpr_write_b32 a125, 0
  v_accvgpr_write_b32 a126, 0
  v_accvgpr_write_b32 a127, 0
  v_mov_b32 v208, 0
  v_mov_b32 v249, 0xff800000
  v_mov_b32 v209, 0
  v_mov_b32 v250, 0xff800000
  v_mov_b32 v210, 0
  v_mov_b32 v251, 0xff800000
  v_mov_b32 v211, 0
  v_mov_b32 v252, 0xff800000
  s_mov_b32 s29, 0
attn_slow:
  s_barrier
  s_add_u32 m0, s28, 49152
  s_nop 0
  buffer_load_dwordx4 v232, s[12:15], s29 offen offset:0 lds
  buffer_load_dwordx4 v233, s[12:15], s29 offen offset:1024 lds
  buffer_load_dwordx4 v234, s[12:15], s29 offen offset:2048 lds
  buffer_load_dwordx4 v235, s[12:15], s29 offen offset:3072 lds
  s_add_u32 m0, s28, 114688
  s_nop 0
  buffer_load_dwordx4 v236, s[16:19], s29 offen offset:0 lds
  buffer_load_dwordx4 v237, s[16:19], s29 offen offset:1024 lds
  buffer_load_dwordx4 v236, s[16:19], s29 offen offset:2048 lds
  buffer_load_dwordx4 v237, s[16:19], s29 offen offset:3072 lds
  s_waitcnt vmcnt(0)
  s_barrier
  ds_read_b128 a[128:131], v212 offset:49152
  ds_read_b128 a[132:135], v213 offset:49152
  ds_read_b128 a[136:139], v214 offset:49152
  ds_read_b128 a[140:143], v215 offset:49152
  s_waitcnt lgkmcnt(3)
  v_mfma_f32_16x16x32_bf16 v[0:3], a[128:131], v[128:131], 0
  s_waitcnt lgkmcnt(2)
  v_mfma_f32_16x16x32_bf16 v[0:3], a[132:135], v[132:135], v[0:3]
  s_waitcnt lgkmcnt(1)
  v_mfma_f32_16x16x32_bf16 v[0:3], a[136:139], v[136:139], v[0:3]
  s_waitcnt lgkmcnt(0)
  v_mfma_f32_16x16x32_bf16 v[0:3], a[140:143], v[140:143], v[0:3]
  v_mfma_f32_16x16x32_bf16 v[8:11], a[140:143], v[156:159], 0
  v_mfma_f32_16x16x32_bf16 v[8:11], a[136:139], v[152:155], v[8:11]
  v_mfma_f32_16x16x32_bf16 v[8:11], a[132:135], v[148:151], v[8:11]
  v_mfma_f32_16x16x32_bf16 v[8:11], a[128:131], v[144:147], v[8:11]
  v_mfma_f32_16x16x32_bf16 v[16:19], a[128:131], v[160:163], 0
  v_mfma_f32_16x16x32_bf16 v[16:19], a[132:135], v[164:167], v[16:19]
  v_mfma_f32_16x16x32_bf16 v[16:19], a[136:139], v[168:171], v[16:19]
  v_mfma_f32_16x16x32_bf16 v[16:19], a[140:143], v[172:175], v[16:19]
  v_mfma_f32_16x16x32_bf16 v[24:27], a[140:143], v[188:191], 0
  v_mfma_f32_16x16x32_bf16 v[24:27], a[136:139], v[184:187], v[24:27]
  v_mfma_f32_16x16x32_bf16 v[24:27], a[132:135], v[180:183], v[24:27]
  v_mfma_f32_16x16x32_bf16 v[24:27], a[128:131], v[176:179], v[24:27]
  ds_read_b128 a[144:147], v212 offset:53248
  ds_read_b128 a[148:151], v213 offset:53248
  ds_read_b128 a[152:155], v214 offset:53248
  ds_read_b128 a[156:159], v215 offset:53248
  s_waitcnt lgkmcnt(3)
  v_mfma_f32_16x16x32_bf16 v[4:7], a[144:147], v[128:131], 0
  s_waitcnt lgkmcnt(2)
  v_mfma_f32_16x16x32_bf16 v[4:7], a[148:151], v[132:135], v[4:7]
  s_waitcnt lgkmcnt(1)
  v_mfma_f32_16x16x32_bf16 v[4:7], a[152:155], v[136:139], v[4:7]
  s_waitcnt lgkmcnt(0)
  v_mfma_f32_16x16x32_bf16 v[4:7], a[156:159], v[140:143], v[4:7]
  v_mfma_f32_16x16x32_bf16 v[12:15], a[156:159], v[156:159], 0
  v_mfma_f32_16x16x32_bf16 v[12:15], a[152:155], v[152:155], v[12:15]
  v_mfma_f32_16x16x32_bf16 v[12:15], a[148:151], v[148:151], v[12:15]
  v_mfma_f32_16x16x32_bf16 v[12:15], a[144:147], v[144:147], v[12:15]
  v_mfma_f32_16x16x32_bf16 v[20:23], a[144:147], v[160:163], 0
  v_mfma_f32_16x16x32_bf16 v[20:23], a[148:151], v[164:167], v[20:23]
  v_mfma_f32_16x16x32_bf16 v[20:23], a[152:155], v[168:171], v[20:23]
  v_mfma_f32_16x16x32_bf16 v[20:23], a[156:159], v[172:175], v[20:23]
  v_mfma_f32_16x16x32_bf16 v[28:31], a[156:159], v[188:191], 0
  v_mfma_f32_16x16x32_bf16 v[28:31], a[152:155], v[184:187], v[28:31]
  v_mfma_f32_16x16x32_bf16 v[28:31], a[148:151], v[180:183], v[28:31]
  v_mfma_f32_16x16x32_bf16 v[28:31], a[144:147], v[176:179], v[28:31]
  ds_read_b128 a[128:131], v212 offset:57344
  ds_read_b128 a[132:135], v213 offset:57344
  ds_read_b128 a[136:139], v214 offset:57344
  ds_read_b128 a[140:143], v215 offset:57344
  s_waitcnt lgkmcnt(3)
  v_mfma_f32_16x16x32_bf16 v[32:35], a[128:131], v[128:131], 0
  s_waitcnt lgkmcnt(2)
  v_mfma_f32_16x16x32_bf16 v[32:35], a[132:135], v[132:135], v[32:35]
  s_waitcnt lgkmcnt(1)
  v_mfma_f32_16x16x32_bf16 v[32:35], a[136:139], v[136:139], v[32:35]
  s_waitcnt lgkmcnt(0)
  v_mfma_f32_16x16x32_bf16 v[32:35], a[140:143], v[140:143], v[32:35]
  v_mfma_f32_16x16x32_bf16 v[40:43], a[140:143], v[156:159], 0
  v_mfma_f32_16x16x32_bf16 v[40:43], a[136:139], v[152:155], v[40:43]
  v_mfma_f32_16x16x32_bf16 v[40:43], a[132:135], v[148:151], v[40:43]
  v_mfma_f32_16x16x32_bf16 v[40:43], a[128:131], v[144:147], v[40:43]
  v_mfma_f32_16x16x32_bf16 v[48:51], a[128:131], v[160:163], 0
  v_mfma_f32_16x16x32_bf16 v[48:51], a[132:135], v[164:167], v[48:51]
  v_mfma_f32_16x16x32_bf16 v[48:51], a[136:139], v[168:171], v[48:51]
  v_mfma_f32_16x16x32_bf16 v[48:51], a[140:143], v[172:175], v[48:51]
  v_mfma_f32_16x16x32_bf16 v[56:59], a[140:143], v[188:191], 0
  v_mfma_f32_16x16x32_bf16 v[56:59], a[136:139], v[184:187], v[56:59]
  v_mfma_f32_16x16x32_bf16 v[56:59], a[132:135], v[180:183], v[56:59]
  v_mfma_f32_16x16x32_bf16 v[56:59], a[128:131], v[176:179], v[56:59]
  ds_read_b128 a[144:147], v212 offset:61440
  ds_read_b128 a[148:151], v213 offset:61440
  ds_read_b128 a[152:155], v214 offset:61440
  ds_read_b128 a[156:159], v215 offset:61440
  s_waitcnt lgkmcnt(3)
  v_mfma_f32_16x16x32_bf16 v[36:39], a[144:147], v[128:131], 0
  s_waitcnt lgkmcnt(2)
  v_mfma_f32_16x16x32_bf16 v[36:39], a[148:151], v[132:135], v[36:39]
  s_waitcnt lgkmcnt(1)
  v_mfma_f32_16x16x32_bf16 v[36:39], a[152:155], v[136:139], v[36:39]
  s_waitcnt lgkmcnt(0)
  v_mfma_f32_16x16x32_bf16 v[36:39], a[156:159], v[140:143], v[36:39]
  v_mfma_f32_16x16x32_bf16 v[44:47], a[156:159], v[156:159], 0
  v_mfma_f32_16x16x32_bf16 v[44:47], a[152:155], v[152:155], v[44:47]
  v_mfma_f32_16x16x32_bf16 v[44:47], a[148:151], v[148:151], v[44:47]
  v_mfma_f32_16x16x32_bf16 v[44:47], a[144:147], v[144:147], v[44:47]
  v_mfma_f32_16x16x32_bf16 v[52:55], a[144:147], v[160:163], 0
  v_mfma_f32_16x16x32_bf16 v[52:55], a[148:151], v[164:167], v[52:55]
  v_mfma_f32_16x16x32_bf16 v[52:55], a[152:155], v[168:171], v[52:55]
  v_mfma_f32_16x16x32_bf16 v[52:55], a[156:159], v[172:175], v[52:55]
  v_mfma_f32_16x16x32_bf16 v[60:63], a[156:159], v[188:191], 0
  v_mfma_f32_16x16x32_bf16 v[60:63], a[152:155], v[184:187], v[60:63]
  v_mfma_f32_16x16x32_bf16 v[60:63], a[148:151], v[180:183], v[60:63]
  v_mfma_f32_16x16x32_bf16 v[60:63], a[144:147], v[176:179], v[60:63]
  v_mov_b32 v192, v249
  v_max3_f32 v192, v192, v0, v1
  v_max3_f32 v192, v192, v2, v3
  v_max3_f32 v192, v192, v4, v5
  v_max3_f32 v192, v192, v6, v7
  v_max3_f32 v192, v192, v32, v33
  v_max3_f32 v192, v192, v34, v35
  v_max3_f32 v192, v192, v36, v37
  v_max3_f32 v192, v192, v38, v39
  v_mov_b32 v245, v192
  s_nop 1
  v_permlane16_swap_b32 v192, v245
  v_max_f32 v192, v192, v245
  v_mov_b32 v245, v192
  s_nop 1
  v_permlane32_swap_b32 v192, v245
  v_max_f32 v192, v192, v245
  v_sub_f32 v193, v249, v192
  v_exp_f32 v193, v193
  v_mov_b32 v249, v192
  v_mul_f32 v208, v208, v193
  v_sub_f32 v0, v0, v192
  v_sub_f32 v1, v1, v192
  v_sub_f32 v2, v2, v192
  v_sub_f32 v3, v3, v192
  v_sub_f32 v4, v4, v192
  v_sub_f32 v5, v5, v192
  v_sub_f32 v6, v6, v192
  v_sub_f32 v7, v7, v192
  v_sub_f32 v32, v32, v192
  v_sub_f32 v33, v33, v192
  v_sub_f32 v34, v34, v192
  v_sub_f32 v35, v35, v192
  v_sub_f32 v36, v36, v192
  v_sub_f32 v37, v37, v192
  v_sub_f32 v38, v38, v192
  v_sub_f32 v39, v39, v192
  v_exp_f32 v0, v0
  v_exp_f32 v1, v1
  v_add_f32 v208, v208, v0
  v_exp_f32 v2, v2
  v_add_f32 v208, v208, v1
  v_cvt_pk_bf16_f32 v0, v0, v1
  v_exp_f32 v3, v3
  v_add_f32 v208, v208, v2
  v_add_f32 v208, v208, v3
  v_cvt_pk_bf16_f32 v1, v2, v3
  v_exp_f32 v4, v4
  v_exp_f32 v5, v5
  v_add_f32 v208, v208, v4
  v_exp_f32 v6, v6
  v_add_f32 v208, v208, v5
  v_cvt_pk_bf16_f32 v2, v4, v5
  v_exp_f32 v7, v7
  v_add_f32 v208, v208, v6
  v_add_f32 v208, v208, v7
  v_cvt_pk_bf16_f32 v3, v6, v7
  v_exp_f32 v32, v32
  v_exp_f32 v33, v33
  v_add_f32 v208, v208, v32
  v_exp_f32 v34, v34
  v_add_f32 v208, v208, v33
  v_cvt_pk_bf16_f32 v32, v32, v33
  v_exp_f32 v35, v35
  v_add_f32 v208, v208, v34
  v_add_f32 v208, v208, v35
  v_cvt_pk_bf16_f32 v33, v34, v35
  v_exp_f32 v36, v36
  v_exp_f32 v37, v37
  v_add_f32 v208, v208, v36
  v_exp_f32 v38, v38
  v_add_f32 v208, v208, v37
  v_cvt_pk_bf16_f32 v34, v36, v37
  v_exp_f32 v39, v39
  v_add_f32 v208, v208, v38
  v_add_f32 v208, v208, v39
  v_cvt_pk_bf16_f32 v35, v38, v39
  v_accvgpr_read_b32 v64, a0
  v_accvgpr_read_b32 v65, a1
  v_accvgpr_read_b32 v66, a2
  v_accvgpr_read_b32 v67, a3
  v_mul_f32 v64, v64, v193
  v_mul_f32 v65, v65, v193
  v_mul_f32 v66, v66, v193
  v_mul_f32 v67, v67, v193
  v_accvgpr_write_b32 a0, v64
  v_accvgpr_write_b32 a1, v65
  v_accvgpr_write_b32 a2, v66
  v_accvgpr_write_b32 a3, v67
  v_accvgpr_read_b32 v64, a16
  v_accvgpr_read_b32 v65, a17
  v_accvgpr_read_b32 v66, a18
  v_accvgpr_read_b32 v67, a19
  v_mul_f32 v64, v64, v193
  v_mul_f32 v65, v65, v193
  v_mul_f32 v66, v66, v193
  v_mul_f32 v67, v67, v193
  v_accvgpr_write_b32 a16, v64
  v_accvgpr_write_b32 a17, v65
  v_accvgpr_write_b32 a18, v66
  v_accvgpr_write_b32 a19, v67
  v_accvgpr_read_b32 v64, a32
  v_accvgpr_read_b32 v65, a33
  v_accvgpr_read_b32 v66, a34
  v_accvgpr_read_b32 v67, a35
  v_mul_f32 v64, v64, v193
  v_mul_f32 v65, v65, v193
  v_mul_f32 v66, v66, v193
  v_mul_f32 v67, v67, v193
  v_accvgpr_write_b32 a32, v64
  v_accvgpr_write_b32 a33, v65
  v_accvgpr_write_b32 a34, v66
  v_accvgpr_write_b32 a35, v67
  v_accvgpr_read_b32 v64, a48
  v_accvgpr_read_b32 v65, a49
  v_accvgpr_read_b32 v66, a50
  v_accvgpr_read_b32 v67, a51
  v_mul_f32 v64, v64, v193
  v_mul_f32 v65, v65, v193
  v_mul_f32 v66, v66, v193
  v_mul_f32 v67, v67, v193
  v_accvgpr_write_b32 a48, v64
  v_accvgpr_write_b32 a49, v65
  v_accvgpr_write_b32 a50, v66
  v_accvgpr_write_b32 a51, v67
  v_accvgpr_read_b32 v64, a64
  v_accvgpr_read_b32 v65, a65
  v_accvgpr_read_b32 v66, a66
  v_accvgpr_read_b32 v67, a67
  v_mul_f32 v64, v64, v193
  v_mul_f32 v65, v65, v193
  v_mul_f32 v66, v66, v193
  v_mul_f32 v67, v67, v193
  v_accvgpr_write_b32 a64, v64
  v_accvgpr_write_b32 a65, v65
  v_accvgpr_write_b32 a66, v66
  v_accvgpr_write_b32 a67, v67
  v_accvgpr_read_b32 v64, a80
  v_accvgpr_read_b32 v65, a81
  v_accvgpr_read_b32 v66, a82
  v_accvgpr_read_b32 v67, a83
  v_mul_f32 v64, v64, v193
  v_mul_f32 v65, v65, v193
  v_mul_f32 v66, v66, v193
  v_mul_f32 v67, v67, v193
  v_accvgpr_write_b32 a80, v64
  v_accvgpr_write_b32 a81, v65
  v_accvgpr_write_b32 a82, v66
  v_accvgpr_write_b32 a83, v67
  v_accvgpr_read_b32 v64, a96
  v_accvgpr_read_b32 v65, a97
  v_accvgpr_read_b32 v66, a98
  v_accvgpr_read_b32 v67, a99
  v_mul_f32 v64, v64, v193
  v_mul_f32 v65, v65, v193
  v_mul_f32 v66, v66, v193
  v_mul_f32 v67, v67, v193
  v_accvgpr_write_b32 a96, v64
  v_accvgpr_write_b32 a97, v65
  v_accvgpr_write_b32 a98, v66
  v_accvgpr_write_b32 a99, v67
  v_accvgpr_read_b32 v64, a112
  v_accvgpr_read_b32 v65, a113
  v_accvgpr_read_b32 v66, a114
  v_accvgpr_read_b32 v67, a115
  v_mul_f32 v64, v64, v193
  v_mul_f32 v65, v65, v193
  v_mul_f32 v66, v66, v193
  v_mul_f32 v67, v67, v193
  v_accvgpr_write_b32 a112, v64
  v_accvgpr_write_b32 a113, v65
  v_accvgpr_write_b32 a114, v66
  v_accvgpr_write_b32 a115, v67
  v_mov_b32 v196, v250
  v_max3_f32 v196, v196, v8, v9
  v_max3_f32 v196, v196, v10, v11
  v_max3_f32 v196, v196, v12, v13
  v_max3_f32 v196, v196, v14, v15
  v_max3_f32 v196, v196, v40, v41
  v_max3_f32 v196, v196, v42, v43
  v_max3_f32 v196, v196, v44, v45
  v_max3_f32 v196, v196, v46, v47
  v_mov_b32 v245, v196
  s_nop 1
  v_permlane16_swap_b32 v196, v245
  v_max_f32 v196, v196, v245
  v_mov_b32 v245, v196
  s_nop 1
  v_permlane32_swap_b32 v196, v245
  v_max_f32 v196, v196, v245
  v_sub_f32 v197, v250, v196
  v_exp_f32 v197, v197
  v_mov_b32 v250, v196
  v_mul_f32 v209, v209, v197
  v_sub_f32 v8, v8, v196
  v_sub_f32 v9, v9, v196
  v_sub_f32 v10, v10, v196
  v_sub_f32 v11, v11, v196
  v_sub_f32 v12, v12, v196
  v_sub_f32 v13, v13, v196
  v_sub_f32 v14, v14, v196
  v_sub_f32 v15, v15, v196
  v_sub_f32 v40, v40, v196
  v_sub_f32 v41, v41, v196
  v_sub_f32 v42, v42, v196
  v_sub_f32 v43, v43, v196
  v_sub_f32 v44, v44, v196
  v_sub_f32 v45, v45, v196
  v_sub_f32 v46, v46, v196
  v_sub_f32 v47, v47, v196
  v_exp_f32 v8, v8
  v_exp_f32 v9, v9
  v_add_f32 v209, v209, v8
  v_exp_f32 v10, v10
  v_add_f32 v209, v209, v9
  v_cvt_pk_bf16_f32 v8, v8, v9
  v_exp_f32 v11, v11
  v_add_f32 v209, v209, v10
  v_add_f32 v209, v209, v11
  v_cvt_pk_bf16_f32 v9, v10, v11
  v_exp_f32 v12, v12
  v_exp_f32 v13, v13
  v_add_f32 v209, v209, v12
  v_exp_f32 v14, v14
  v_add_f32 v209, v209, v13
  v_cvt_pk_bf16_f32 v10, v12, v13
  v_exp_f32 v15, v15
  v_add_f32 v209, v209, v14
  v_add_f32 v209, v209, v15
  v_cvt_pk_bf16_f32 v11, v14, v15
  v_exp_f32 v40, v40
  v_exp_f32 v41, v41
  v_add_f32 v209, v209, v40
  v_exp_f32 v42, v42
  v_add_f32 v209, v209, v41
  v_cvt_pk_bf16_f32 v40, v40, v41
  v_exp_f32 v43, v43
  v_add_f32 v209, v209, v42
  v_add_f32 v209, v209, v43
  v_cvt_pk_bf16_f32 v41, v42, v43
  v_exp_f32 v44, v44
  v_exp_f32 v45, v45
  v_add_f32 v209, v209, v44
  v_exp_f32 v46, v46
  v_add_f32 v209, v209, v45
  v_cvt_pk_bf16_f32 v42, v44, v45
  v_exp_f32 v47, v47
  v_add_f32 v209, v209, v46
  v_add_f32 v209, v209, v47
  v_cvt_pk_bf16_f32 v43, v46, v47
  v_accvgpr_read_b32 v64, a4
  v_accvgpr_read_b32 v65, a5
  v_accvgpr_read_b32 v66, a6
  v_accvgpr_read_b32 v67, a7
  v_mul_f32 v64, v64, v197
  v_mul_f32 v65, v65, v197
  v_mul_f32 v66, v66, v197
  v_mul_f32 v67, v67, v197
  v_accvgpr_write_b32 a4, v64
  v_accvgpr_write_b32 a5, v65
  v_accvgpr_write_b32 a6, v66
  v_accvgpr_write_b32 a7, v67
  v_accvgpr_read_b32 v64, a20
  v_accvgpr_read_b32 v65, a21
  v_accvgpr_read_b32 v66, a22
  v_accvgpr_read_b32 v67, a23
  v_mul_f32 v64, v64, v197
  v_mul_f32 v65, v65, v197
  v_mul_f32 v66, v66, v197
  v_mul_f32 v67, v67, v197
  v_accvgpr_write_b32 a20, v64
  v_accvgpr_write_b32 a21, v65
  v_accvgpr_write_b32 a22, v66
  v_accvgpr_write_b32 a23, v67
  v_accvgpr_read_b32 v64, a36
  v_accvgpr_read_b32 v65, a37
  v_accvgpr_read_b32 v66, a38
  v_accvgpr_read_b32 v67, a39
  v_mul_f32 v64, v64, v197
  v_mul_f32 v65, v65, v197
  v_mul_f32 v66, v66, v197
  v_mul_f32 v67, v67, v197
  v_accvgpr_write_b32 a36, v64
  v_accvgpr_write_b32 a37, v65
  v_accvgpr_write_b32 a38, v66
  v_accvgpr_write_b32 a39, v67
  v_accvgpr_read_b32 v64, a52
  v_accvgpr_read_b32 v65, a53
  v_accvgpr_read_b32 v66, a54
  v_accvgpr_read_b32 v67, a55
  v_mul_f32 v64, v64, v197
  v_mul_f32 v65, v65, v197
  v_mul_f32 v66, v66, v197
  v_mul_f32 v67, v67, v197
  v_accvgpr_write_b32 a52, v64
  v_accvgpr_write_b32 a53, v65
  v_accvgpr_write_b32 a54, v66
  v_accvgpr_write_b32 a55, v67
  v_accvgpr_read_b32 v64, a68
  v_accvgpr_read_b32 v65, a69
  v_accvgpr_read_b32 v66, a70
  v_accvgpr_read_b32 v67, a71
  v_mul_f32 v64, v64, v197
  v_mul_f32 v65, v65, v197
  v_mul_f32 v66, v66, v197
  v_mul_f32 v67, v67, v197
  v_accvgpr_write_b32 a68, v64
  v_accvgpr_write_b32 a69, v65
  v_accvgpr_write_b32 a70, v66
  v_accvgpr_write_b32 a71, v67
  v_accvgpr_read_b32 v64, a84
  v_accvgpr_read_b32 v65, a85
  v_accvgpr_read_b32 v66, a86
  v_accvgpr_read_b32 v67, a87
  v_mul_f32 v64, v64, v197
  v_mul_f32 v65, v65, v197
  v_mul_f32 v66, v66, v197
  v_mul_f32 v67, v67, v197
  v_accvgpr_write_b32 a84, v64
  v_accvgpr_write_b32 a85, v65
  v_accvgpr_write_b32 a86, v66
  v_accvgpr_write_b32 a87, v67
  v_accvgpr_read_b32 v64, a100
  v_accvgpr_read_b32 v65, a101
  v_accvgpr_read_b32 v66, a102
  v_accvgpr_read_b32 v67, a103
  v_mul_f32 v64, v64, v197
  v_mul_f32 v65, v65, v197
  v_mul_f32 v66, v66, v197
  v_mul_f32 v67, v67, v197
  v_accvgpr_write_b32 a100, v64
  v_accvgpr_write_b32 a101, v65
  v_accvgpr_write_b32 a102, v66
  v_accvgpr_write_b32 a103, v67
  v_accvgpr_read_b32 v64, a116
  v_accvgpr_read_b32 v65, a117
  v_accvgpr_read_b32 v66, a118
  v_accvgpr_read_b32 v67, a119
  v_mul_f32 v64, v64, v197
  v_mul_f32 v65, v65, v197
  v_mul_f32 v66, v66, v197
  v_mul_f32 v67, v67, v197
  v_accvgpr_write_b32 a116, v64
  v_accvgpr_write_b32 a117, v65
  v_accvgpr_write_b32 a118, v66
  v_accvgpr_write_b32 a119, v67
  v_mov_b32 v200, v251
  v_max3_f32 v200, v200, v16, v17
  v_max3_f32 v200, v200, v18, v19
  v_max3_f32 v200, v200, v20, v21
  v_max3_f32 v200, v200, v22, v23
  v_max3_f32 v200, v200, v48, v49
  v_max3_f32 v200, v200, v50, v51
  v_max3_f32 v200, v200, v52, v53
  v_max3_f32 v200, v200, v54, v55
  v_mov_b32 v245, v200
  s_nop 1
  v_permlane16_swap_b32 v200, v245
  v_max_f32 v200, v200, v245
  v_mov_b32 v245, v200
  s_nop 1
  v_permlane32_swap_b32 v200, v245
  v_max_f32 v200, v200, v245
  v_sub_f32 v201, v251, v200
  v_exp_f32 v201, v201
  v_mov_b32 v251, v200
  v_mul_f32 v210, v210, v201
  v_sub_f32 v16, v16, v200
  v_sub_f32 v17, v17, v200
  v_sub_f32 v18, v18, v200
  v_sub_f32 v19, v19, v200
  v_sub_f32 v20, v20, v200
  v_sub_f32 v21, v21, v200
  v_sub_f32 v22, v22, v200
  v_sub_f32 v23, v23, v200
  v_sub_f32 v48, v48, v200
  v_sub_f32 v49, v49, v200
  v_sub_f32 v50, v50, v200
  v_sub_f32 v51, v51, v200
  v_sub_f32 v52, v52, v200
  v_sub_f32 v53, v53, v200
  v_sub_f32 v54, v54, v200
  v_sub_f32 v55, v55, v200
  v_exp_f32 v16, v16
  v_exp_f32 v17, v17
  v_add_f32 v210, v210, v16
  v_exp_f32 v18, v18
  v_add_f32 v210, v210, v17
  v_cvt_pk_bf16_f32 v16, v16, v17
  v_exp_f32 v19, v19
  v_add_f32 v210, v210, v18
  v_add_f32 v210, v210, v19
  v_cvt_pk_bf16_f32 v17, v18, v19
  v_exp_f32 v20, v20
  v_exp_f32 v21, v21
  v_add_f32 v210, v210, v20
  v_exp_f32 v22, v22
  v_add_f32 v210, v210, v21
  v_cvt_pk_bf16_f32 v18, v20, v21
  v_exp_f32 v23, v23
  v_add_f32 v210, v210, v22
  v_add_f32 v210, v210, v23
  v_cvt_pk_bf16_f32 v19, v22, v23
  v_exp_f32 v48, v48
  v_exp_f32 v49, v49
  v_add_f32 v210, v210, v48
  v_exp_f32 v50, v50
  v_add_f32 v210, v210, v49
  v_cvt_pk_bf16_f32 v48, v48, v49
  v_exp_f32 v51, v51
  v_add_f32 v210, v210, v50
  v_add_f32 v210, v210, v51
  v_cvt_pk_bf16_f32 v49, v50, v51
  v_exp_f32 v52, v52
  v_exp_f32 v53, v53
  v_add_f32 v210, v210, v52
  v_exp_f32 v54, v54
  v_add_f32 v210, v210, v53
  v_cvt_pk_bf16_f32 v50, v52, v53
  v_exp_f32 v55, v55
  v_add_f32 v210, v210, v54
  v_add_f32 v210, v210, v55
  v_cvt_pk_bf16_f32 v51, v54, v55
  v_accvgpr_read_b32 v64, a8
  v_accvgpr_read_b32 v65, a9
  v_accvgpr_read_b32 v66, a10
  v_accvgpr_read_b32 v67, a11
  v_mul_f32 v64, v64, v201
  v_mul_f32 v65, v65, v201
  v_mul_f32 v66, v66, v201
  v_mul_f32 v67, v67, v201
  v_accvgpr_write_b32 a8, v64
  v_accvgpr_write_b32 a9, v65
  v_accvgpr_write_b32 a10, v66
  v_accvgpr_write_b32 a11, v67
  v_accvgpr_read_b32 v64, a24
  v_accvgpr_read_b32 v65, a25
  v_accvgpr_read_b32 v66, a26
  v_accvgpr_read_b32 v67, a27
  v_mul_f32 v64, v64, v201
  v_mul_f32 v65, v65, v201
  v_mul_f32 v66, v66, v201
  v_mul_f32 v67, v67, v201
  v_accvgpr_write_b32 a24, v64
  v_accvgpr_write_b32 a25, v65
  v_accvgpr_write_b32 a26, v66
  v_accvgpr_write_b32 a27, v67
  v_accvgpr_read_b32 v64, a40
  v_accvgpr_read_b32 v65, a41
  v_accvgpr_read_b32 v66, a42
  v_accvgpr_read_b32 v67, a43
  v_mul_f32 v64, v64, v201
  v_mul_f32 v65, v65, v201
  v_mul_f32 v66, v66, v201
  v_mul_f32 v67, v67, v201
  v_accvgpr_write_b32 a40, v64
  v_accvgpr_write_b32 a41, v65
  v_accvgpr_write_b32 a42, v66
  v_accvgpr_write_b32 a43, v67
  v_accvgpr_read_b32 v64, a56
  v_accvgpr_read_b32 v65, a57
  v_accvgpr_read_b32 v66, a58
  v_accvgpr_read_b32 v67, a59
  v_mul_f32 v64, v64, v201
  v_mul_f32 v65, v65, v201
  v_mul_f32 v66, v66, v201
  v_mul_f32 v67, v67, v201
  v_accvgpr_write_b32 a56, v64
  v_accvgpr_write_b32 a57, v65
  v_accvgpr_write_b32 a58, v66
  v_accvgpr_write_b32 a59, v67
  v_accvgpr_read_b32 v64, a72
  v_accvgpr_read_b32 v65, a73
  v_accvgpr_read_b32 v66, a74
  v_accvgpr_read_b32 v67, a75
  v_mul_f32 v64, v64, v201
  v_mul_f32 v65, v65, v201
  v_mul_f32 v66, v66, v201
  v_mul_f32 v67, v67, v201
  v_accvgpr_write_b32 a72, v64
  v_accvgpr_write_b32 a73, v65
  v_accvgpr_write_b32 a74, v66
  v_accvgpr_write_b32 a75, v67
  v_accvgpr_read_b32 v64, a88
  v_accvgpr_read_b32 v65, a89
  v_accvgpr_read_b32 v66, a90
  v_accvgpr_read_b32 v67, a91
  v_mul_f32 v64, v64, v201
  v_mul_f32 v65, v65, v201
  v_mul_f32 v66, v66, v201
  v_mul_f32 v67, v67, v201
  v_accvgpr_write_b32 a88, v64
  v_accvgpr_write_b32 a89, v65
  v_accvgpr_write_b32 a90, v66
  v_accvgpr_write_b32 a91, v67
  v_accvgpr_read_b32 v64, a104
  v_accvgpr_read_b32 v65, a105
  v_accvgpr_read_b32 v66, a106
  v_accvgpr_read_b32 v67, a107
  v_mul_f32 v64, v64, v201
  v_mul_f32 v65, v65, v201
  v_mul_f32 v66, v66, v201
  v_mul_f32 v67, v67, v201
  v_accvgpr_write_b32 a104, v64
  v_accvgpr_write_b32 a105, v65
  v_accvgpr_write_b32 a106, v66
  v_accvgpr_write_b32 a107, v67
  v_accvgpr_read_b32 v64, a120
  v_accvgpr_read_b32 v65, a121
  v_accvgpr_read_b32 v66, a122
  v_accvgpr_read_b32 v67, a123
  v_mul_f32 v64, v64, v201
  v_mul_f32 v65, v65, v201
  v_mul_f32 v66, v66, v201
  v_mul_f32 v67, v67, v201
  v_accvgpr_write_b32 a120, v64
  v_accvgpr_write_b32 a121, v65
  v_accvgpr_write_b32 a122, v66
  v_accvgpr_write_b32 a123, v67
  v_mov_b32 v204, v252
  v_max3_f32 v204, v204, v24, v25
  v_max3_f32 v204, v204, v26, v27
  v_max3_f32 v204, v204, v28, v29
  v_max3_f32 v204, v204, v30, v31
  v_max3_f32 v204, v204, v56, v57
  v_max3_f32 v204, v204, v58, v59
  v_max3_f32 v204, v204, v60, v61
  v_max3_f32 v204, v204, v62, v63
  v_mov_b32 v245, v204
  s_nop 1
  v_permlane16_swap_b32 v204, v245
  v_max_f32 v204, v204, v245
  v_mov_b32 v245, v204
  s_nop 1
  v_permlane32_swap_b32 v204, v245
  v_max_f32 v204, v204, v245
  v_sub_f32 v205, v252, v204
  v_exp_f32 v205, v205
  v_mov_b32 v252, v204
  v_mul_f32 v211, v211, v205
  v_sub_f32 v24, v24, v204
  v_sub_f32 v25, v25, v204
  v_sub_f32 v26, v26, v204
  v_sub_f32 v27, v27, v204
  v_sub_f32 v28, v28, v204
  v_sub_f32 v29, v29, v204
  v_sub_f32 v30, v30, v204
  v_sub_f32 v31, v31, v204
  v_sub_f32 v56, v56, v204
  v_sub_f32 v57, v57, v204
  v_sub_f32 v58, v58, v204
  v_sub_f32 v59, v59, v204
  v_sub_f32 v60, v60, v204
  v_sub_f32 v61, v61, v204
  v_sub_f32 v62, v62, v204
  v_sub_f32 v63, v63, v204
  v_exp_f32 v24, v24
  v_exp_f32 v25, v25
  v_add_f32 v211, v211, v24
  v_exp_f32 v26, v26
  v_add_f32 v211, v211, v25
  v_cvt_pk_bf16_f32 v24, v24, v25
  v_exp_f32 v27, v27
  v_add_f32 v211, v211, v26
  v_add_f32 v211, v211, v27
  v_cvt_pk_bf16_f32 v25, v26, v27
  v_exp_f32 v28, v28
  v_exp_f32 v29, v29
  v_add_f32 v211, v211, v28
  v_exp_f32 v30, v30
  v_add_f32 v211, v211, v29
  v_cvt_pk_bf16_f32 v26, v28, v29
  v_exp_f32 v31, v31
  v_add_f32 v211, v211, v30
  v_add_f32 v211, v211, v31
  v_cvt_pk_bf16_f32 v27, v30, v31
  v_exp_f32 v56, v56
  v_exp_f32 v57, v57
  v_add_f32 v211, v211, v56
  v_exp_f32 v58, v58
  v_add_f32 v211, v211, v57
  v_cvt_pk_bf16_f32 v56, v56, v57
  v_exp_f32 v59, v59
  v_add_f32 v211, v211, v58
  v_add_f32 v211, v211, v59
  v_cvt_pk_bf16_f32 v57, v58, v59
  v_exp_f32 v60, v60
  v_exp_f32 v61, v61
  v_add_f32 v211, v211, v60
  v_exp_f32 v62, v62
  v_add_f32 v211, v211, v61
  v_cvt_pk_bf16_f32 v58, v60, v61
  v_exp_f32 v63, v63
  v_add_f32 v211, v211, v62
  v_add_f32 v211, v211, v63
  v_cvt_pk_bf16_f32 v59, v62, v63
  v_accvgpr_read_b32 v64, a12
  v_accvgpr_read_b32 v65, a13
  v_accvgpr_read_b32 v66, a14
  v_accvgpr_read_b32 v67, a15
  v_mul_f32 v64, v64, v205
  v_mul_f32 v65, v65, v205
  v_mul_f32 v66, v66, v205
  v_mul_f32 v67, v67, v205
  v_accvgpr_write_b32 a12, v64
  v_accvgpr_write_b32 a13, v65
  v_accvgpr_write_b32 a14, v66
  v_accvgpr_write_b32 a15, v67
  v_accvgpr_read_b32 v64, a28
  v_accvgpr_read_b32 v65, a29
  v_accvgpr_read_b32 v66, a30
  v_accvgpr_read_b32 v67, a31
  v_mul_f32 v64, v64, v205
  v_mul_f32 v65, v65, v205
  v_mul_f32 v66, v66, v205
  v_mul_f32 v67, v67, v205
  v_accvgpr_write_b32 a28, v64
  v_accvgpr_write_b32 a29, v65
  v_accvgpr_write_b32 a30, v66
  v_accvgpr_write_b32 a31, v67
  v_accvgpr_read_b32 v64, a44
  v_accvgpr_read_b32 v65, a45
  v_accvgpr_read_b32 v66, a46
  v_accvgpr_read_b32 v67, a47
  v_mul_f32 v64, v64, v205
  v_mul_f32 v65, v65, v205
  v_mul_f32 v66, v66, v205
  v_mul_f32 v67, v67, v205
  v_accvgpr_write_b32 a44, v64
  v_accvgpr_write_b32 a45, v65
  v_accvgpr_write_b32 a46, v66
  v_accvgpr_write_b32 a47, v67
  v_accvgpr_read_b32 v64, a60
  v_accvgpr_read_b32 v65, a61
  v_accvgpr_read_b32 v66, a62
  v_accvgpr_read_b32 v67, a63
  v_mul_f32 v64, v64, v205
  v_mul_f32 v65, v65, v205
  v_mul_f32 v66, v66, v205
  v_mul_f32 v67, v67, v205
  v_accvgpr_write_b32 a60, v64
  v_accvgpr_write_b32 a61, v65
  v_accvgpr_write_b32 a62, v66
  v_accvgpr_write_b32 a63, v67
  v_accvgpr_read_b32 v64, a76
  v_accvgpr_read_b32 v65, a77
  v_accvgpr_read_b32 v66, a78
  v_accvgpr_read_b32 v67, a79
  v_mul_f32 v64, v64, v205
  v_mul_f32 v65, v65, v205
  v_mul_f32 v66, v66, v205
  v_mul_f32 v67, v67, v205
  v_accvgpr_write_b32 a76, v64
  v_accvgpr_write_b32 a77, v65
  v_accvgpr_write_b32 a78, v66
  v_accvgpr_write_b32 a79, v67
  v_accvgpr_read_b32 v64, a92
  v_accvgpr_read_b32 v65, a93
  v_accvgpr_read_b32 v66, a94
  v_accvgpr_read_b32 v67, a95
  v_mul_f32 v64, v64, v205
  v_mul_f32 v65, v65, v205
  v_mul_f32 v66, v66, v205
  v_mul_f32 v67, v67, v205
  v_accvgpr_write_b32 a92, v64
  v_accvgpr_write_b32 a93, v65
  v_accvgpr_write_b32 a94, v66
  v_accvgpr_write_b32 a95, v67
  v_accvgpr_read_b32 v64, a108
  v_accvgpr_read_b32 v65, a109
  v_accvgpr_read_b32 v66, a110
  v_accvgpr_read_b32 v67, a111
  v_mul_f32 v64, v64, v205
  v_mul_f32 v65, v65, v205
  v_mul_f32 v66, v66, v205
  v_mul_f32 v67, v67, v205
  v_accvgpr_write_b32 a108, v64
  v_accvgpr_write_b32 a109, v65
  v_accvgpr_write_b32 a110, v66
  v_accvgpr_write_b32 a111, v67
  v_accvgpr_read_b32 v64, a124
  v_accvgpr_read_b32 v65, a125
  v_accvgpr_read_b32 v66, a126
  v_accvgpr_read_b32 v67, a127
  v_mul_f32 v64, v64, v205
  v_mul_f32 v65, v65, v205
  v_mul_f32 v66, v66, v205
  v_mul_f32 v67, v67, v205
  v_accvgpr_write_b32 a124, v64
  v_accvgpr_write_b32 a125, v65
  v_accvgpr_write_b32 a126, v66
  v_accvgpr_write_b32 a127, v67
  ds_read_b64_tr_b16 a[160:161], v216 offset:49152
  ds_read_b64_tr_b16 a[162:163], v216 offset:53248
  ds_read_b64_tr_b16 a[164:165], v216 offset:57344
  ds_read_b64_tr_b16 a[166:167], v216 offset:61440
  s_waitcnt lgkmcnt(2)
  v_mfma_f32_16x16x32_bf16 a[0:3], a[160:163], v[0:3], a[0:3]
  s_waitcnt lgkmcnt(0)
  v_mfma_f32_16x16x32_bf16 a[0:3], a[164:167], v[32:35], a[0:3]
  v_mfma_f32_16x16x32_bf16 a[4:7], a[164:167], v[40:43], a[4:7]
  v_mfma_f32_16x16x32_bf16 a[4:7], a[160:163], v[8:11], a[4:7]
  v_mfma_f32_16x16x32_bf16 a[8:11], a[160:163], v[16:19], a[8:11]
  v_mfma_f32_16x16x32_bf16 a[8:11], a[164:167], v[48:51], a[8:11]
  v_mfma_f32_16x16x32_bf16 a[12:15], a[164:167], v[56:59], a[12:15]
  v_mfma_f32_16x16x32_bf16 a[12:15], a[160:163], v[24:27], a[12:15]
  ds_read_b64_tr_b16 a[168:169], v217 offset:49152
  ds_read_b64_tr_b16 a[170:171], v217 offset:53248
  ds_read_b64_tr_b16 a[172:173], v217 offset:57344
  ds_read_b64_tr_b16 a[174:175], v217 offset:61440
  s_waitcnt lgkmcnt(2)
  v_mfma_f32_16x16x32_bf16 a[16:19], a[168:171], v[0:3], a[16:19]
  s_waitcnt lgkmcnt(0)
  v_mfma_f32_16x16x32_bf16 a[16:19], a[172:175], v[32:35], a[16:19]
  v_mfma_f32_16x16x32_bf16 a[20:23], a[172:175], v[40:43], a[20:23]
  v_mfma_f32_16x16x32_bf16 a[20:23], a[168:171], v[8:11], a[20:23]
  v_mfma_f32_16x16x32_bf16 a[24:27], a[168:171], v[16:19], a[24:27]
  v_mfma_f32_16x16x32_bf16 a[24:27], a[172:175], v[48:51], a[24:27]
  v_mfma_f32_16x16x32_bf16 a[28:31], a[172:175], v[56:59], a[28:31]
  v_mfma_f32_16x16x32_bf16 a[28:31], a[168:171], v[24:27], a[28:31]
  ds_read_b64_tr_b16 a[176:177], v218 offset:49152
  ds_read_b64_tr_b16 a[178:179], v218 offset:53248
  ds_read_b64_tr_b16 a[180:181], v218 offset:57344
  ds_read_b64_tr_b16 a[182:183], v218 offset:61440
  s_waitcnt lgkmcnt(2)
  v_mfma_f32_16x16x32_bf16 a[32:35], a[176:179], v[0:3], a[32:35]
  s_waitcnt lgkmcnt(0)
  v_mfma_f32_16x16x32_bf16 a[32:35], a[180:183], v[32:35], a[32:35]
  v_mfma_f32_16x16x32_bf16 a[36:39], a[180:183], v[40:43], a[36:39]
  v_mfma_f32_16x16x32_bf16 a[36:39], a[176:179], v[8:11], a[36:39]
  v_mfma_f32_16x16x32_bf16 a[40:43], a[176:179], v[16:19], a[40:43]
  v_mfma_f32_16x16x32_bf16 a[40:43], a[180:183], v[48:51], a[40:43]
  v_mfma_f32_16x16x32_bf16 a[44:47], a[180:183], v[56:59], a[44:47]
  v_mfma_f32_16x16x32_bf16 a[44:47], a[176:179], v[24:27], a[44:47]
  ds_read_b64_tr_b16 a[184:185], v219 offset:49152
  ds_read_b64_tr_b16 a[186:187], v219 offset:53248
  ds_read_b64_tr_b16 a[188:189], v219 offset:57344
  ds_read_b64_tr_b16 a[190:191], v219 offset:61440
  s_waitcnt lgkmcnt(2)
  v_mfma_f32_16x16x32_bf16 a[48:51], a[184:187], v[0:3], a[48:51]
  s_waitcnt lgkmcnt(0)
  v_mfma_f32_16x16x32_bf16 a[48:51], a[188:191], v[32:35], a[48:51]
  v_mfma_f32_16x16x32_bf16 a[52:55], a[188:191], v[40:43], a[52:55]
  v_mfma_f32_16x16x32_bf16 a[52:55], a[184:187], v[8:11], a[52:55]
  v_mfma_f32_16x16x32_bf16 a[56:59], a[184:187], v[16:19], a[56:59]
  v_mfma_f32_16x16x32_bf16 a[56:59], a[188:191], v[48:51], a[56:59]
  v_mfma_f32_16x16x32_bf16 a[60:63], a[188:191], v[56:59], a[60:63]
  v_mfma_f32_16x16x32_bf16 a[60:63], a[184:187], v[24:27], a[60:63]
  ds_read_b64_tr_b16 a[160:161], v220 offset:49152
  ds_read_b64_tr_b16 a[162:163], v220 offset:53248
  ds_read_b64_tr_b16 a[164:165], v220 offset:57344
  ds_read_b64_tr_b16 a[166:167], v220 offset:61440
  s_waitcnt lgkmcnt(2)
  v_mfma_f32_16x16x32_bf16 a[64:67], a[160:163], v[0:3], a[64:67]
  s_waitcnt lgkmcnt(0)
  v_mfma_f32_16x16x32_bf16 a[64:67], a[164:167], v[32:35], a[64:67]
  v_mfma_f32_16x16x32_bf16 a[68:71], a[164:167], v[40:43], a[68:71]
  v_mfma_f32_16x16x32_bf16 a[68:71], a[160:163], v[8:11], a[68:71]
  v_mfma_f32_16x16x32_bf16 a[72:75], a[160:163], v[16:19], a[72:75]
  v_mfma_f32_16x16x32_bf16 a[72:75], a[164:167], v[48:51], a[72:75]
  v_mfma_f32_16x16x32_bf16 a[76:79], a[164:167], v[56:59], a[76:79]
  v_mfma_f32_16x16x32_bf16 a[76:79], a[160:163], v[24:27], a[76:79]
  ds_read_b64_tr_b16 a[168:169], v221 offset:49152
  ds_read_b64_tr_b16 a[170:171], v221 offset:53248
  ds_read_b64_tr_b16 a[172:173], v221 offset:57344
  ds_read_b64_tr_b16 a[174:175], v221 offset:61440
  s_waitcnt lgkmcnt(2)
  v_mfma_f32_16x16x32_bf16 a[80:83], a[168:171], v[0:3], a[80:83]
  s_waitcnt lgkmcnt(0)
  v_mfma_f32_16x16x32_bf16 a[80:83], a[172:175], v[32:35], a[80:83]
  v_mfma_f32_16x16x32_bf16 a[84:87], a[172:175], v[40:43], a[84:87]
  v_mfma_f32_16x16x32_bf16 a[84:87], a[168:171], v[8:11], a[84:87]
  v_mfma_f32_16x16x32_bf16 a[88:91], a[168:171], v[16:19], a[88:91]
  v_mfma_f32_16x16x32_bf16 a[88:91], a[172:175], v[48:51], a[88:91]
  v_mfma_f32_16x16x32_bf16 a[92:95], a[172:175], v[56:59], a[92:95]
  v_mfma_f32_16x16x32_bf16 a[92:95], a[168:171], v[24:27], a[92:95]
  ds_read_b64_tr_b16 a[176:177], v222 offset:49152
  ds_read_b64_tr_b16 a[178:179], v222 offset:53248
  ds_read_b64_tr_b16 a[180:181], v222 offset:57344
  ds_read_b64_tr_b16 a[182:183], v222 offset:61440
  s_waitcnt lgkmcnt(2)
  v_mfma_f32_16x16x32_bf16 a[96:99], a[176:179], v[0:3], a[96:99]
  s_waitcnt lgkmcnt(0)
  v_mfma_f32_16x16x32_bf16 a[96:99], a[180:183], v[32:35], a[96:99]
  v_mfma_f32_16x16x32_bf16 a[100:103], a[180:183], v[40:43], a[100:103]
  v_mfma_f32_16x16x32_bf16 a[100:103], a[176:179], v[8:11], a[100:103]
  v_mfma_f32_16x16x32_bf16 a[104:107], a[176:179], v[16:19], a[104:107]
  v_mfma_f32_16x16x32_bf16 a[104:107], a[180:183], v[48:51], a[104:107]
  v_mfma_f32_16x16x32_bf16 a[108:111], a[180:183], v[56:59], a[108:111]
  v_mfma_f32_16x16x32_bf16 a[108:111], a[176:179], v[24:27], a[108:111]
  ds_read_b64_tr_b16 a[184:185], v223 offset:49152
  ds_read_b64_tr_b16 a[186:187], v223 offset:53248
  ds_read_b64_tr_b16 a[188:189], v223 offset:57344
  ds_read_b64_tr_b16 a[190:191], v223 offset:61440
  s_waitcnt lgkmcnt(2)
  v_mfma_f32_16x16x32_bf16 a[112:115], a[184:187], v[0:3], a[112:115]
  s_waitcnt lgkmcnt(0)
  v_mfma_f32_16x16x32_bf16 a[112:115], a[188:191], v[32:35], a[112:115]
  v_mfma_f32_16x16x32_bf16 a[116:119], a[188:191], v[40:43], a[116:119]
  v_mfma_f32_16x16x32_bf16 a[116:119], a[184:187], v[8:11], a[116:119]
  v_mfma_f32_16x16x32_bf16 a[120:123], a[184:187], v[16:19], a[120:123]
  v_mfma_f32_16x16x32_bf16 a[120:123], a[188:191], v[48:51], a[120:123]
  v_mfma_f32_16x16x32_bf16 a[124:127], a[188:191], v[56:59], a[124:127]
  v_mfma_f32_16x16x32_bf16 a[124:127], a[184:187], v[24:27], a[124:127]
  s_add_u32 s29, s29, 16384
  s_cmp_lt_u32 s29, 524288
  s_cbranch_scc1 attn_slow
  v_mov_b32 v245, v208
  v_mov_b32 v246, v209
  v_mov_b32 v247, v210
  v_mov_b32 v248, v211
  v_permlane16_swap_b32 v208, v245
  v_permlane16_swap_b32 v209, v246
  v_permlane16_swap_b32 v210, v247
  v_permlane16_swap_b32 v211, v248
  v_add_f32 v208, v208, v245
  v_add_f32 v209, v209, v246
  v_add_f32 v210, v210, v247
  v_add_f32 v211, v211, v248
  v_mov_b32 v245, v208
  v_mov_b32 v246, v209
  v_mov_b32 v247, v210
  v_mov_b32 v248, v211
  v_permlane32_swap_b32 v208, v245
  v_permlane32_swap_b32 v209, v246
  v_permlane32_swap_b32 v210, v247
  v_permlane32_swap_b32 v211, v248
  v_add_f32 v208, v208, v245
  v_add_f32 v209, v209, v246
  v_add_f32 v210, v210, v247
  v_add_f32 v211, v211, v248
  v_rcp_f32 v192, v208
  v_rcp_f32 v196, v209
  v_rcp_f32 v200, v210
  v_rcp_f32 v204, v211
  v_accvgpr_read_b32 v0, a0
  v_accvgpr_read_b32 v1, a1
  v_accvgpr_read_b32 v2, a2
  v_accvgpr_read_b32 v3, a3
  v_accvgpr_read_b32 v4, a16
  v_accvgpr_read_b32 v5, a17
  v_accvgpr_read_b32 v6, a18
  v_accvgpr_read_b32 v7, a19
  v_mul_f32 v0, v0, v192
  v_mul_f32 v1, v1, v192
  v_mul_f32 v2, v2, v192
  v_mul_f32 v3, v3, v192
  v_mul_f32 v4, v4, v192
  v_mul_f32 v5, v5, v192
  v_mul_f32 v6, v6, v192
  v_mul_f32 v7, v7, v192
  v_cvt_pk_bf16_f32 v0, v0, v1
  v_cvt_pk_bf16_f32 v1, v2, v3
  v_cvt_pk_bf16_f32 v2, v4, v5
  v_cvt_pk_bf16_f32 v3, v6, v7
  buffer_store_dwordx4 v[0:3], v244, s[24:27], s40 offen offset:0 sc1
  v_accvgpr_read_b32 v8, a4
  v_accvgpr_read_b32 v9, a5
  v_accvgpr_read_b32 v10, a6
  v_accvgpr_read_b32 v11, a7
  v_accvgpr_read_b32 v12, a20
  v_accvgpr_read_b32 v13, a21
  v_accvgpr_read_b32 v14, a22
  v_accvgpr_read_b32 v15, a23
  v_mul_f32 v8, v8, v196
  v_mul_f32 v9, v9, v196
  v_mul_f32 v10, v10, v196
  v_mul_f32 v11, v11, v196
  v_mul_f32 v12, v12, v196
  v_mul_f32 v13, v13, v196
  v_mul_f32 v14, v14, v196
  v_mul_f32 v15, v15, v196
  v_cvt_pk_bf16_f32 v8, v8, v9
  v_cvt_pk_bf16_f32 v9, v10, v11
  v_cvt_pk_bf16_f32 v10, v12, v13
  v_cvt_pk_bf16_f32 v11, v14, v15
  buffer_store_dwordx4 v[8:11], v244, s[24:27], s40 offen offset:2048 sc1
  v_accvgpr_read_b32 v16, a8
  v_accvgpr_read_b32 v17, a9
  v_accvgpr_read_b32 v18, a10
  v_accvgpr_read_b32 v19, a11
  v_accvgpr_read_b32 v20, a24
  v_accvgpr_read_b32 v21, a25
  v_accvgpr_read_b32 v22, a26
  v_accvgpr_read_b32 v23, a27
  v_mul_f32 v16, v16, v200
  v_mul_f32 v17, v17, v200
  v_mul_f32 v18, v18, v200
  v_mul_f32 v19, v19, v200
  v_mul_f32 v20, v20, v200
  v_mul_f32 v21, v21, v200
  v_mul_f32 v22, v22, v200
  v_mul_f32 v23, v23, v200
  v_cvt_pk_bf16_f32 v16, v16, v17
  v_cvt_pk_bf16_f32 v17, v18, v19
  v_cvt_pk_bf16_f32 v18, v20, v21
  v_cvt_pk_bf16_f32 v19, v22, v23
  buffer_store_dwordx4 v[16:19], v244, s[24:27], s41 offen offset:0 sc1
  v_accvgpr_read_b32 v24, a12
  v_accvgpr_read_b32 v25, a13
  v_accvgpr_read_b32 v26, a14
  v_accvgpr_read_b32 v27, a15
  v_accvgpr_read_b32 v28, a28
  v_accvgpr_read_b32 v29, a29
  v_accvgpr_read_b32 v30, a30
  v_accvgpr_read_b32 v31, a31
  v_mul_f32 v24, v24, v204
  v_mul_f32 v25, v25, v204
  v_mul_f32 v26, v26, v204
  v_mul_f32 v27, v27, v204
  v_mul_f32 v28, v28, v204
  v_mul_f32 v29, v29, v204
  v_mul_f32 v30, v30, v204
  v_mul_f32 v31, v31, v204
  v_cvt_pk_bf16_f32 v24, v24, v25
  v_cvt_pk_bf16_f32 v25, v26, v27
  v_cvt_pk_bf16_f32 v26, v28, v29
  v_cvt_pk_bf16_f32 v27, v30, v31
  buffer_store_dwordx4 v[24:27], v244, s[24:27], s41 offen offset:2048 sc1
  v_accvgpr_read_b32 v32, a32
  v_accvgpr_read_b32 v33, a33
  v_accvgpr_read_b32 v34, a34
  v_accvgpr_read_b32 v35, a35
  v_accvgpr_read_b32 v36, a48
  v_accvgpr_read_b32 v37, a49
  v_accvgpr_read_b32 v38, a50
  v_accvgpr_read_b32 v39, a51
  v_mul_f32 v32, v32, v192
  v_mul_f32 v33, v33, v192
  v_mul_f32 v34, v34, v192
  v_mul_f32 v35, v35, v192
  v_mul_f32 v36, v36, v192
  v_mul_f32 v37, v37, v192
  v_mul_f32 v38, v38, v192
  v_mul_f32 v39, v39, v192
  v_cvt_pk_bf16_f32 v32, v32, v33
  v_cvt_pk_bf16_f32 v33, v34, v35
  v_cvt_pk_bf16_f32 v34, v36, v37
  v_cvt_pk_bf16_f32 v35, v38, v39
  buffer_store_dwordx4 v[32:35], v244, s[24:27], s40 offen offset:1024 sc1
  v_accvgpr_read_b32 v40, a36
  v_accvgpr_read_b32 v41, a37
  v_accvgpr_read_b32 v42, a38
  v_accvgpr_read_b32 v43, a39
  v_accvgpr_read_b32 v44, a52
  v_accvgpr_read_b32 v45, a53
  v_accvgpr_read_b32 v46, a54
  v_accvgpr_read_b32 v47, a55
  v_mul_f32 v40, v40, v196
  v_mul_f32 v41, v41, v196
  v_mul_f32 v42, v42, v196
  v_mul_f32 v43, v43, v196
  v_mul_f32 v44, v44, v196
  v_mul_f32 v45, v45, v196
  v_mul_f32 v46, v46, v196
  v_mul_f32 v47, v47, v196
  v_cvt_pk_bf16_f32 v40, v40, v41
  v_cvt_pk_bf16_f32 v41, v42, v43
  v_cvt_pk_bf16_f32 v42, v44, v45
  v_cvt_pk_bf16_f32 v43, v46, v47
  buffer_store_dwordx4 v[40:43], v244, s[24:27], s40 offen offset:3072 sc1
  v_accvgpr_read_b32 v48, a40
  v_accvgpr_read_b32 v49, a41
  v_accvgpr_read_b32 v50, a42
  v_accvgpr_read_b32 v51, a43
  v_accvgpr_read_b32 v52, a56
  v_accvgpr_read_b32 v53, a57
  v_accvgpr_read_b32 v54, a58
  v_accvgpr_read_b32 v55, a59
  v_mul_f32 v48, v48, v200
  v_mul_f32 v49, v49, v200
  v_mul_f32 v50, v50, v200
  v_mul_f32 v51, v51, v200
  v_mul_f32 v52, v52, v200
  v_mul_f32 v53, v53, v200
  v_mul_f32 v54, v54, v200
  v_mul_f32 v55, v55, v200
  v_cvt_pk_bf16_f32 v48, v48, v49
  v_cvt_pk_bf16_f32 v49, v50, v51
  v_cvt_pk_bf16_f32 v50, v52, v53
  v_cvt_pk_bf16_f32 v51, v54, v55
  buffer_store_dwordx4 v[48:51], v244, s[24:27], s41 offen offset:1024 sc1
  v_accvgpr_read_b32 v56, a44
  v_accvgpr_read_b32 v57, a45
  v_accvgpr_read_b32 v58, a46
  v_accvgpr_read_b32 v59, a47
  v_accvgpr_read_b32 v60, a60
  v_accvgpr_read_b32 v61, a61
  v_accvgpr_read_b32 v62, a62
  v_accvgpr_read_b32 v63, a63
  v_mul_f32 v56, v56, v204
  v_mul_f32 v57, v57, v204
  v_mul_f32 v58, v58, v204
  v_mul_f32 v59, v59, v204
  v_mul_f32 v60, v60, v204
  v_mul_f32 v61, v61, v204
  v_mul_f32 v62, v62, v204
  v_mul_f32 v63, v63, v204
  v_cvt_pk_bf16_f32 v56, v56, v57
  v_cvt_pk_bf16_f32 v57, v58, v59
  v_cvt_pk_bf16_f32 v58, v60, v61
  v_cvt_pk_bf16_f32 v59, v62, v63
  buffer_store_dwordx4 v[56:59], v244, s[24:27], s41 offen offset:3072 sc1
  v_accvgpr_read_b32 v0, a64
  v_accvgpr_read_b32 v1, a65
  v_accvgpr_read_b32 v2, a66
  v_accvgpr_read_b32 v3, a67
  v_accvgpr_read_b32 v4, a80
  v_accvgpr_read_b32 v5, a81
  v_accvgpr_read_b32 v6, a82
  v_accvgpr_read_b32 v7, a83
  v_mul_f32 v0, v0, v192
  v_mul_f32 v1, v1, v192
  v_mul_f32 v2, v2, v192
  v_mul_f32 v3, v3, v192
  v_mul_f32 v4, v4, v192
  v_mul_f32 v5, v5, v192
  v_mul_f32 v6, v6, v192
  v_mul_f32 v7, v7, v192
  v_cvt_pk_bf16_f32 v0, v0, v1
  v_cvt_pk_bf16_f32 v1, v2, v3
  v_cvt_pk_bf16_f32 v2, v4, v5
  v_cvt_pk_bf16_f32 v3, v6, v7
  buffer_store_dwordx4 v[0:3], v244, s[24:27], s42 offen offset:0 sc1
  v_accvgpr_read_b32 v8, a68
  v_accvgpr_read_b32 v9, a69
  v_accvgpr_read_b32 v10, a70
  v_accvgpr_read_b32 v11, a71
  v_accvgpr_read_b32 v12, a84
  v_accvgpr_read_b32 v13, a85
  v_accvgpr_read_b32 v14, a86
  v_accvgpr_read_b32 v15, a87
  v_mul_f32 v8, v8, v196
  v_mul_f32 v9, v9, v196
  v_mul_f32 v10, v10, v196
  v_mul_f32 v11, v11, v196
  v_mul_f32 v12, v12, v196
  v_mul_f32 v13, v13, v196
  v_mul_f32 v14, v14, v196
  v_mul_f32 v15, v15, v196
  v_cvt_pk_bf16_f32 v8, v8, v9
  v_cvt_pk_bf16_f32 v9, v10, v11
  v_cvt_pk_bf16_f32 v10, v12, v13
  v_cvt_pk_bf16_f32 v11, v14, v15
  buffer_store_dwordx4 v[8:11], v244, s[24:27], s42 offen offset:2048 sc1
  v_accvgpr_read_b32 v16, a72
  v_accvgpr_read_b32 v17, a73
  v_accvgpr_read_b32 v18, a74
  v_accvgpr_read_b32 v19, a75
  v_accvgpr_read_b32 v20, a88
  v_accvgpr_read_b32 v21, a89
  v_accvgpr_read_b32 v22, a90
  v_accvgpr_read_b32 v23, a91
  v_mul_f32 v16, v16, v200
  v_mul_f32 v17, v17, v200
  v_mul_f32 v18, v18, v200
  v_mul_f32 v19, v19, v200
  v_mul_f32 v20, v20, v200
  v_mul_f32 v21, v21, v200
  v_mul_f32 v22, v22, v200
  v_mul_f32 v23, v23, v200
  v_cvt_pk_bf16_f32 v16, v16, v17
  v_cvt_pk_bf16_f32 v17, v18, v19
  v_cvt_pk_bf16_f32 v18, v20, v21
  v_cvt_pk_bf16_f32 v19, v22, v23
  buffer_store_dwordx4 v[16:19], v244, s[24:27], s43 offen offset:0 sc1
  v_accvgpr_read_b32 v24, a76
  v_accvgpr_read_b32 v25, a77
  v_accvgpr_read_b32 v26, a78
  v_accvgpr_read_b32 v27, a79
  v_accvgpr_read_b32 v28, a92
  v_accvgpr_read_b32 v29, a93
  v_accvgpr_read_b32 v30, a94
  v_accvgpr_read_b32 v31, a95
  v_mul_f32 v24, v24, v204
  v_mul_f32 v25, v25, v204
  v_mul_f32 v26, v26, v204
  v_mul_f32 v27, v27, v204
  v_mul_f32 v28, v28, v204
  v_mul_f32 v29, v29, v204
  v_mul_f32 v30, v30, v204
  v_mul_f32 v31, v31, v204
  v_cvt_pk_bf16_f32 v24, v24, v25
  v_cvt_pk_bf16_f32 v25, v26, v27
  v_cvt_pk_bf16_f32 v26, v28, v29
  v_cvt_pk_bf16_f32 v27, v30, v31
  buffer_store_dwordx4 v[24:27], v244, s[24:27], s43 offen offset:2048 sc1
  v_accvgpr_read_b32 v32, a96
  v_accvgpr_read_b32 v33, a97
  v_accvgpr_read_b32 v34, a98
  v_accvgpr_read_b32 v35, a99
  v_accvgpr_read_b32 v36, a112
  v_accvgpr_read_b32 v37, a113
  v_accvgpr_read_b32 v38, a114
  v_accvgpr_read_b32 v39, a115
  v_mul_f32 v32, v32, v192
  v_mul_f32 v33, v33, v192
  v_mul_f32 v34, v34, v192
  v_mul_f32 v35, v35, v192
  v_mul_f32 v36, v36, v192
  v_mul_f32 v37, v37, v192
  v_mul_f32 v38, v38, v192
  v_mul_f32 v39, v39, v192
  v_cvt_pk_bf16_f32 v32, v32, v33
  v_cvt_pk_bf16_f32 v33, v34, v35
  v_cvt_pk_bf16_f32 v34, v36, v37
  v_cvt_pk_bf16_f32 v35, v38, v39
  buffer_store_dwordx4 v[32:35], v244, s[24:27], s42 offen offset:1024 sc1
  v_accvgpr_read_b32 v40, a100
  v_accvgpr_read_b32 v41, a101
  v_accvgpr_read_b32 v42, a102
  v_accvgpr_read_b32 v43, a103
  v_accvgpr_read_b32 v44, a116
  v_accvgpr_read_b32 v45, a117
  v_accvgpr_read_b32 v46, a118
  v_accvgpr_read_b32 v47, a119
  v_mul_f32 v40, v40, v196
  v_mul_f32 v41, v41, v196
  v_mul_f32 v42, v42, v196
  v_mul_f32 v43, v43, v196
  v_mul_f32 v44, v44, v196
  v_mul_f32 v45, v45, v196
  v_mul_f32 v46, v46, v196
  v_mul_f32 v47, v47, v196
  v_cvt_pk_bf16_f32 v40, v40, v41
  v_cvt_pk_bf16_f32 v41, v42, v43
  v_cvt_pk_bf16_f32 v42, v44, v45
  v_cvt_pk_bf16_f32 v43, v46, v47
  buffer_store_dwordx4 v[40:43], v244, s[24:27], s42 offen offset:3072 sc1
  v_accvgpr_read_b32 v48, a104
  v_accvgpr_read_b32 v49, a105
  v_accvgpr_read_b32 v50, a106
  v_accvgpr_read_b32 v51, a107
  v_accvgpr_read_b32 v52, a120
  v_accvgpr_read_b32 v53, a121
  v_accvgpr_read_b32 v54, a122
  v_accvgpr_read_b32 v55, a123
  v_mul_f32 v48, v48, v200
  v_mul_f32 v49, v49, v200
  v_mul_f32 v50, v50, v200
  v_mul_f32 v51, v51, v200
  v_mul_f32 v52, v52, v200
  v_mul_f32 v53, v53, v200
  v_mul_f32 v54, v54, v200
  v_mul_f32 v55, v55, v200
  v_cvt_pk_bf16_f32 v48, v48, v49
  v_cvt_pk_bf16_f32 v49, v50, v51
  v_cvt_pk_bf16_f32 v50, v52, v53
  v_cvt_pk_bf16_f32 v51, v54, v55
  buffer_store_dwordx4 v[48:51], v244, s[24:27], s43 offen offset:1024 sc1
  v_accvgpr_read_b32 v56, a108
  v_accvgpr_read_b32 v57, a109
  v_accvgpr_read_b32 v58, a110
  v_accvgpr_read_b32 v59, a111
  v_accvgpr_read_b32 v60, a124
  v_accvgpr_read_b32 v61, a125
  v_accvgpr_read_b32 v62, a126
  v_accvgpr_read_b32 v63, a127
  v_mul_f32 v56, v56, v204
  v_mul_f32 v57, v57, v204
  v_mul_f32 v58, v58, v204
  v_mul_f32 v59, v59, v204
  v_mul_f32 v60, v60, v204
  v_mul_f32 v61, v61, v204
  v_mul_f32 v62, v62, v204
  v_mul_f32 v63, v63, v204
  v_cvt_pk_bf16_f32 v56, v56, v57
  v_cvt_pk_bf16_f32 v57, v58, v59
  v_cvt_pk_bf16_f32 v58, v60, v61
  v_cvt_pk_bf16_f32 v59, v62, v63
  buffer_store_dwordx4 v[56:59], v244, s[24:27], s43 offen offset:3072 sc1
  v_add_u32 v252, 4096, v242
  v_add_u32 v253, 8192, v242
  buffer_load_dwordx4 a[128:131], v253, s[24:27], s4 offen offset:3072 sc1
  buffer_load_dwordx4 a[132:135], v242, s[24:27], s5 offen offset:0 sc1
  buffer_load_dwordx4 a[136:139], v242, s[24:27], s5 offen offset:1024 sc1
  buffer_load_dwordx4 a[140:143], v242, s[24:27], s5 offen offset:2048 sc1
  buffer_load_dwordx4 a[144:147], v242, s[24:27], s5 offen offset:3072 sc1
  buffer_load_dwordx4 a[148:151], v252, s[24:27], s5 offen offset:0 sc1
  buffer_load_dwordx4 a[152:155], v252, s[24:27], s5 offen offset:1024 sc1
  buffer_load_dwordx4 a[156:159], v252, s[24:27], s5 offen offset:2048 sc1
  buffer_load_dwordx4 a[0:3], v252, s[24:27], s5 offen offset:3072 sc1
  buffer_load_dwordx4 a[4:7], v253, s[24:27], s5 offen offset:0 sc1
  buffer_load_dwordx4 a[8:11], v253, s[24:27], s5 offen offset:1024 sc1
  buffer_load_dwordx4 a[12:15], v253, s[24:27], s5 offen offset:2048 sc1
  buffer_load_dwordx4 a[16:19], v253, s[24:27], s5 offen offset:3072 sc1
  buffer_load_dwordx4 a[20:23], v242, s[24:27], s6 offen offset:0 sc1
  buffer_load_dwordx4 a[24:27], v242, s[24:27], s6 offen offset:1024 sc1
  buffer_load_dwordx4 a[28:31], v242, s[24:27], s6 offen offset:2048 sc1
  buffer_load_dwordx4 a[32:35], v242, s[24:27], s6 offen offset:3072 sc1
  buffer_load_dwordx4 a[36:39], v252, s[24:27], s6 offen offset:0 sc1
  buffer_load_dwordx4 a[40:43], v252, s[24:27], s6 offen offset:1024 sc1
  buffer_load_dwordx4 a[44:47], v252, s[24:27], s6 offen offset:2048 sc1
  buffer_load_dwordx4 a[48:51], v252, s[24:27], s6 offen offset:3072 sc1
  buffer_load_dwordx4 a[52:55], v253, s[24:27], s6 offen offset:0 sc1
  s_bfe_u32 s39, s2, 0x40002
  s_lshl_b32 s39, s39, 8
  s_add_u32 s39, s39, 2818304
  s_lshl_b32 s38, s3, 26
  v_lshlrev_b32 v64, 22, v242
  v_or_b32 v64, s38, v64
  v_mov_b32 v65, 1
  s_waitcnt vmcnt(0)
  s_barrier
  s_branch tail_go
.section .rodata,"a"
.p2align 6
.amdhsa_kernel recurrent_scan__mha_block_cached__moe_arch_mod__prompt_kernel
  .amdhsa_next_free_vgpr 512
  .amdhsa_next_free_sgpr 102
  .amdhsa_accum_offset 256
  .amdhsa_group_segment_fixed_size 0
  .amdhsa_kernarg_size 104
  .amdhsa_user_sgpr_count 2
  .amdhsa_user_sgpr_kernarg_segment_ptr 1
  .amdhsa_system_sgpr_workgroup_id_x 1
.end_amdhsa_kernel
```

```asm
; @launch grid=(256,1,1) block=(256,1,1) lds=163840
.amdgcn_target "amdgcn-amd-amdhsa--gfx950"
.text
.globl recurrent_scan__mha_block_cached__moe_arch_mod__prompt_kernel
.p2align 8
.type recurrent_scan__mha_block_cached__moe_arch_mod__prompt_kernel,@function
recurrent_scan__mha_block_cached__moe_arch_mod__prompt_kernel:
  s_cmp_ge_u32 s2, 256
  s_cbranch_scc1 attn_end
  s_load_dwordx2 s[60:61], s[0:1], 0
  s_load_dwordx2 s[48:49], s[0:1], 48
  s_load_dwordx4 s[4:7], s[0:1], 8
  s_load_dwordx2 s[8:9], s[0:1], 24
  s_load_dwordx2 s[10:11], s[0:1], 96
  s_load_dwordx2 s[88:89], s[0:1], 32
  s_load_dwordx2 s[90:91], s[0:1], 56
  s_load_dwordx4 s[92:95], s[0:1], 64
  s_load_dwordx2 s[96:97], s[0:1], 88
  s_load_dwordx2 s[62:63], s[0:1], 80
  v_lshrrev_b32 v249, 6, v0
  v_and_b32 v0, 63, v0
  v_mov_b32 v245, v0
  v_readfirstlane_b32 s3, v249
  s_and_b32 s36, s2, 7
  s_lshl_b32 s36, s36, 2
  s_lshr_b32 s37, s2, 6
  s_add_u32 s36, s36, s37
  s_bfe_u32 s37, s2, 0x30003
  s_lshl_b32 s37, s37, 2
  s_add_u32 s37, s37, s3
  s_lshl_b32 s28, s3, 12
  v_lshrrev_b32 v248, 4, v245
  v_and_b32 v247, 15, v245
  s_lshl_b32 s38, s3, 17
  v_lshlrev_b32 v249, 13, v248
  v_add_u32 v249, s38, v249
  v_or_b32 v250, 0, v248
  v_lshlrev_b32 v250, 1, v250
  v_xor_b32 v250, v250, v247
  v_lshl_add_u32 v238, v250, 4, v249
  v_or_b32 v250, 0, v248
  v_lshlrev_b32 v250, 1, v250
  v_xor_b32 v250, v250, v247
  v_lshl_add_u32 v239, v250, 4, v249
  v_add_u32 v239, 31744, v239
  v_or_b32 v250, 4, v248
  v_lshlrev_b32 v250, 1, v250
  v_xor_b32 v250, v250, v247
  v_lshl_add_u32 v240, v250, 4, v249
  v_add_u32 v240, 63488, v240
  v_or_b32 v250, 4, v248
  v_lshlrev_b32 v250, 1, v250
  v_xor_b32 v250, v250, v247
  v_lshl_add_u32 v241, v250, 4, v249
  v_add_u32 v241, 95232, v241
  s_waitcnt lgkmcnt(0)
  s_add_u32 s58, s10, 2830336
  s_addc_u32 s59, s11, 0
  s_load_dword s59, s[58:59], 0
  s_mov_b32 s24, s10
  s_mov_b32 s25, s11
  s_mov_b32 s26, 33554432
  s_mov_b32 s27, 0x20000
  s_lshl_b32 s38, s36, 8
  s_add_u32 s20, s8, s38
  s_addc_u32 s21, s9, 0
  s_mov_b32 s22, 5242880
  s_mov_b32 s23, 0x20000
  s_sub_u32 s22, s22, s38
  s_cmp_ge_u32 s3, 2
  s_cbranch_scc1 front_fetch
  s_mov_b32 s12, s60
  s_mov_b32 s13, s61
  s_mov_b32 s14, 2621440
  s_mov_b32 s15, 0x20000
  s_mov_b32 s16, s48
  s_mov_b32 s17, s49
  s_mov_b32 s18, 1280
  s_mov_b32 s19, 0x20000
  s_lshr_b32 s52, s37, 2
  s_lshl_b32 s52, s52, 5
  s_add_u32 s52, s52, s36
  s_lshl_b32 s52, s52, 1
  s_add_u32 s52, s52, s3
  s_lshl_b32 s52, s52, 2
  s_mul_i32 s53, s52, 1280
  v_lshrrev_b32 v1, 4, v0
  v_and_b32 v2, 15, v0
  v_lshlrev_b32 v3, 4, v2
  v_mul_u32_u24 v4, 0x500, v1
  v_add_u32 v4, v4, v3
  buffer_load_dwordx4 v[8:11], v4, s[12:15], s53 offen offset:0
  buffer_load_dwordx4 v[12:15], v4, s[12:15], s53 offen offset:256
  buffer_load_dwordx4 v[16:19], v4, s[12:15], s53 offen offset:512
  buffer_load_dwordx4 v[20:23], v4, s[12:15], s53 offen offset:768
  buffer_load_dwordx4 v[24:27], v4, s[12:15], s53 offen offset:1024
  buffer_load_dwordx4 v[28:31], v3, s[16:19], 0 offen offset:0
  buffer_load_dwordx4 v[32:35], v3, s[16:19], 0 offen offset:256
  buffer_load_dwordx4 v[36:39], v3, s[16:19], 0 offen offset:512
  buffer_load_dwordx4 v[40:43], v3, s[16:19], 0 offen offset:768
  buffer_load_dwordx4 v[44:47], v3, s[16:19], 0 offen offset:1024
  v_mov_b32 v7, 0
  v_lshlrev_b32 v6, 26, v0
  s_lshl_b32 s53, s2, 7
  s_add_u32 s53, s53, 2834432
  buffer_store_dword v7, v6, s[24:27], s53 offen sc1
  v_lshlrev_b32 v6, 8, v0
  v_lshrrev_b32 v5, 5, v0
  v_lshl_add_u32 v6, v5, 26, v6
  s_cmp_eq_u32 s2, 0
  s_cselect_b32 s53, 0, 1073741824
  v_or_b32 v6, s53, v6
  s_mov_b32 s53, 2818048
  buffer_store_dword v7, v6, s[24:27], s53 offen sc1
  s_lshr_b32 s53, s52, 6
  s_mul_i32 s53, s53, 81920
  s_bfe_u32 s54, s52, 0x20004
  s_lshl_b32 s54, s54, 10
  s_add_u32 s53, s53, s54
  s_and_b32 s54, s52, 15
  s_lshl_b32 s54, s54, 4
  s_add_u32 s53, s53, s54
  v_lshrrev_b32 v5, 2, v2
  v_lshlrev_b32 v5, 12, v5
  v_and_b32 v6, 3, v2
  v_lshl_add_u32 v5, v6, 8, v5
  v_lshl_add_u32 v5, v1, 4, v5
  s_mov_b32 s56, 0xffff0000
  s_waitcnt vmcnt(11)
  v_lshlrev_b32 v48, 16, v8
  v_and_b32 v49, s56, v8
  v_lshlrev_b32 v50, 16, v9
  v_and_b32 v51, s56, v9
  v_lshlrev_b32 v52, 16, v10
  v_and_b32 v53, s56, v10
  v_lshlrev_b32 v54, 16, v11
  v_and_b32 v55, s56, v11
  s_waitcnt vmcnt(10)
  v_lshlrev_b32 v56, 16, v12
  v_and_b32 v57, s56, v12
  v_lshlrev_b32 v58, 16, v13
  v_and_b32 v59, s56, v13
  v_lshlrev_b32 v60, 16, v14
  v_and_b32 v61, s56, v14
  v_lshlrev_b32 v62, 16, v15
  v_and_b32 v63, s56, v15
  s_waitcnt vmcnt(9)
  v_lshlrev_b32 v64, 16, v16
  v_and_b32 v65, s56, v16
  v_lshlrev_b32 v66, 16, v17
  v_and_b32 v67, s56, v17
  v_lshlrev_b32 v68, 16, v18
  v_and_b32 v69, s56, v18
  v_lshlrev_b32 v70, 16, v19
  v_and_b32 v71, s56, v19
  s_waitcnt vmcnt(8)
  v_lshlrev_b32 v72, 16, v20
  v_and_b32 v73, s56, v20
  v_lshlrev_b32 v74, 16, v21
  v_and_b32 v75, s56, v21
  v_lshlrev_b32 v76, 16, v22
  v_and_b32 v77, s56, v22
  v_lshlrev_b32 v78, 16, v23
  v_and_b32 v79, s56, v23
  s_waitcnt vmcnt(7)
  v_lshlrev_b32 v80, 16, v24
  v_and_b32 v81, s56, v24
  v_lshlrev_b32 v82, 16, v25
  v_and_b32 v83, s56, v25
  v_lshlrev_b32 v84, 16, v26
  v_and_b32 v85, s56, v26
  v_lshlrev_b32 v86, 16, v27
  v_and_b32 v87, s56, v27
  v_pk_add_f32 v[88:89], v[48:49], v[50:51]
  v_pk_add_f32 v[90:91], v[52:53], v[54:55]
  v_pk_add_f32 v[88:89], v[88:89], v[56:57]
  v_pk_add_f32 v[90:91], v[90:91], v[58:59]
  v_pk_add_f32 v[88:89], v[88:89], v[60:61]
  v_pk_add_f32 v[90:91], v[90:91], v[62:63]
  v_pk_add_f32 v[88:89], v[88:89], v[64:65]
  v_pk_add_f32 v[90:91], v[90:91], v[66:67]
  v_pk_add_f32 v[88:89], v[88:89], v[68:69]
  v_pk_add_f32 v[90:91], v[90:91], v[70:71]
  v_pk_add_f32 v[88:89], v[88:89], v[72:73]
  v_pk_add_f32 v[90:91], v[90:91], v[74:75]
  v_pk_add_f32 v[88:89], v[88:89], v[76:77]
  v_pk_add_f32 v[90:91], v[90:91], v[78:79]
  v_pk_add_f32 v[88:89], v[88:89], v[80:81]
  v_pk_add_f32 v[90:91], v[90:91], v[82:83]
  v_pk_add_f32 v[88:89], v[88:89], v[84:85]
  v_pk_add_f32 v[90:91], v[90:91], v[86:87]
  v_pk_add_f32 v[88:89], v[88:89], v[90:91]
  v_add_f32 v92, v88, v89
  s_nop 1
  v_add_f32_dpp v92, v92, v92 row_ror:8 row_mask:0xf bank_mask:0xf
  s_nop 1
  v_add_f32_dpp v92, v92, v92 row_ror:4 row_mask:0xf bank_mask:0xf
  s_nop 1
  v_add_f32_dpp v92, v92, v92 row_ror:2 row_mask:0xf bank_mask:0xf
  s_nop 1
  v_add_f32_dpp v92, v92, v92 row_ror:1 row_mask:0xf bank_mask:0xf
  v_mul_f32 v92, 0x3acccccd, v92
  v_pk_add_f32 v[94:95], v[48:49], v[92:93] op_sel_hi:[1,0] neg_lo:[0,1] neg_hi:[0,1]
  v_pk_mul_f32 v[88:89], v[94:95], v[94:95]
  v_pk_add_f32 v[96:97], v[50:51], v[92:93] op_sel_hi:[1,0] neg_lo:[0,1] neg_hi:[0,1]
  v_pk_mul_f32 v[90:91], v[96:97], v[96:97]
  v_pk_add_f32 v[94:95], v[52:53], v[92:93] op_sel_hi:[1,0] neg_lo:[0,1] neg_hi:[0,1]
  v_pk_fma_f32 v[88:89], v[94:95], v[94:95], v[88:89]
  v_pk_add_f32 v[96:97], v[54:55], v[92:93] op_sel_hi:[1,0] neg_lo:[0,1] neg_hi:[0,1]
  v_pk_fma_f32 v[90:91], v[96:97], v[96:97], v[90:91]
  v_pk_add_f32 v[94:95], v[56:57], v[92:93] op_sel_hi:[1,0] neg_lo:[0,1] neg_hi:[0,1]
  v_pk_fma_f32 v[88:89], v[94:95], v[94:95], v[88:89]
  v_pk_add_f32 v[96:97], v[58:59], v[92:93] op_sel_hi:[1,0] neg_lo:[0,1] neg_hi:[0,1]
  v_pk_fma_f32 v[90:91], v[96:97], v[96:97], v[90:91]
  v_pk_add_f32 v[94:95], v[60:61], v[92:93] op_sel_hi:[1,0] neg_lo:[0,1] neg_hi:[0,1]
  v_pk_fma_f32 v[88:89], v[94:95], v[94:95], v[88:89]
  v_pk_add_f32 v[96:97], v[62:63], v[92:93] op_sel_hi:[1,0] neg_lo:[0,1] neg_hi:[0,1]
  v_pk_fma_f32 v[90:91], v[96:97], v[96:97], v[90:91]
  v_pk_add_f32 v[94:95], v[64:65], v[92:93] op_sel_hi:[1,0] neg_lo:[0,1] neg_hi:[0,1]
  v_pk_fma_f32 v[88:89], v[94:95], v[94:95], v[88:89]
  v_pk_add_f32 v[96:97], v[66:67], v[92:93] op_sel_hi:[1,0] neg_lo:[0,1] neg_hi:[0,1]
  v_pk_fma_f32 v[90:91], v[96:97], v[96:97], v[90:91]
  v_pk_add_f32 v[94:95], v[68:69], v[92:93] op_sel_hi:[1,0] neg_lo:[0,1] neg_hi:[0,1]
  v_pk_fma_f32 v[88:89], v[94:95], v[94:95], v[88:89]
  v_pk_add_f32 v[96:97], v[70:71], v[92:93] op_sel_hi:[1,0] neg_lo:[0,1] neg_hi:[0,1]
  v_pk_fma_f32 v[90:91], v[96:97], v[96:97], v[90:91]
  v_pk_add_f32 v[94:95], v[72:73], v[92:93] op_sel_hi:[1,0] neg_lo:[0,1] neg_hi:[0,1]
  v_pk_fma_f32 v[88:89], v[94:95], v[94:95], v[88:89]
  v_pk_add_f32 v[96:97], v[74:75], v[92:93] op_sel_hi:[1,0] neg_lo:[0,1] neg_hi:[0,1]
  v_pk_fma_f32 v[90:91], v[96:97], v[96:97], v[90:91]
  v_pk_add_f32 v[94:95], v[76:77], v[92:93] op_sel_hi:[1,0] neg_lo:[0,1] neg_hi:[0,1]
  v_pk_fma_f32 v[88:89], v[94:95], v[94:95], v[88:89]
  v_pk_add_f32 v[96:97], v[78:79], v[92:93] op_sel_hi:[1,0] neg_lo:[0,1] neg_hi:[0,1]
  v_pk_fma_f32 v[90:91], v[96:97], v[96:97], v[90:91]
  v_pk_add_f32 v[94:95], v[80:81], v[92:93] op_sel_hi:[1,0] neg_lo:[0,1] neg_hi:[0,1]
  v_pk_fma_f32 v[88:89], v[94:95], v[94:95], v[88:89]
  v_pk_add_f32 v[96:97], v[82:83], v[92:93] op_sel_hi:[1,0] neg_lo:[0,1] neg_hi:[0,1]
  v_pk_fma_f32 v[90:91], v[96:97], v[96:97], v[90:91]
  v_pk_add_f32 v[94:95], v[84:85], v[92:93] op_sel_hi:[1,0] neg_lo:[0,1] neg_hi:[0,1]
  v_pk_fma_f32 v[88:89], v[94:95], v[94:95], v[88:89]
  v_pk_add_f32 v[96:97], v[86:87], v[92:93] op_sel_hi:[1,0] neg_lo:[0,1] neg_hi:[0,1]
  v_pk_fma_f32 v[90:91], v[96:97], v[96:97], v[90:91]
  v_pk_add_f32 v[88:89], v[88:89], v[90:91]
  v_add_f32 v98, v88, v89
  s_nop 1
  v_add_f32_dpp v98, v98, v98 row_ror:8 row_mask:0xf bank_mask:0xf
  v_cvt_pk_bf16_f32 v92, v92, v92
  s_nop 0
  v_add_f32_dpp v98, v98, v98 row_ror:4 row_mask:0xf bank_mask:0xf
  v_lshlrev_b32 v92, 16, v92
  s_nop 0
  v_add_f32_dpp v98, v98, v98 row_ror:2 row_mask:0xf bank_mask:0xf
  s_nop 1
  v_add_f32_dpp v98, v98, v98 row_ror:1 row_mask:0xf bank_mask:0xf
  v_mul_f32 v98, 0x3acccccd, v98
  v_cvt_pk_bf16_f32 v98, v98, v98
  v_pk_add_f32 v[48:49], v[48:49], v[92:93] op_sel_hi:[1,0] neg_lo:[0,1] neg_hi:[0,1]
  v_lshlrev_b32 v98, 16, v98
  v_pk_add_f32 v[50:51], v[50:51], v[92:93] op_sel_hi:[1,0] neg_lo:[0,1] neg_hi:[0,1]
  v_add_f32 v98, 0x3727c5ac, v98
  v_pk_add_f32 v[52:53], v[52:53], v[92:93] op_sel_hi:[1,0] neg_lo:[0,1] neg_hi:[0,1]
  v_cvt_pk_bf16_f32 v98, v98, v98
  v_pk_add_f32 v[54:55], v[54:55], v[92:93] op_sel_hi:[1,0] neg_lo:[0,1] neg_hi:[0,1]
  v_lshlrev_b32 v98, 16, v98
  v_pk_add_f32 v[56:57], v[56:57], v[92:93] op_sel_hi:[1,0] neg_lo:[0,1] neg_hi:[0,1]
  v_sqrt_f32 v98, v98
  v_pk_add_f32 v[58:59], v[58:59], v[92:93] op_sel_hi:[1,0] neg_lo:[0,1] neg_hi:[0,1]
  v_cvt_pk_bf16_f32 v98, v98, v98
  v_pk_add_f32 v[60:61], v[60:61], v[92:93] op_sel_hi:[1,0] neg_lo:[0,1] neg_hi:[0,1]
  v_lshlrev_b32 v98, 16, v98
  v_pk_add_f32 v[62:63], v[62:63], v[92:93] op_sel_hi:[1,0] neg_lo:[0,1] neg_hi:[0,1]
  v_rcp_f32 v100, v98
  v_pk_add_f32 v[64:65], v[64:65], v[92:93] op_sel_hi:[1,0] neg_lo:[0,1] neg_hi:[0,1]
  v_pk_add_f32 v[66:67], v[66:67], v[92:93] op_sel_hi:[1,0] neg_lo:[0,1] neg_hi:[0,1]
  v_pk_add_f32 v[68:69], v[68:69], v[92:93] op_sel_hi:[1,0] neg_lo:[0,1] neg_hi:[0,1]
  v_pk_add_f32 v[70:71], v[70:71], v[92:93] op_sel_hi:[1,0] neg_lo:[0,1] neg_hi:[0,1]
  v_pk_add_f32 v[72:73], v[72:73], v[92:93] op_sel_hi:[1,0] neg_lo:[0,1] neg_hi:[0,1]
  v_pk_add_f32 v[74:75], v[74:75], v[92:93] op_sel_hi:[1,0] neg_lo:[0,1] neg_hi:[0,1]
  v_pk_add_f32 v[76:77], v[76:77], v[92:93] op_sel_hi:[1,0] neg_lo:[0,1] neg_hi:[0,1]
  v_pk_add_f32 v[78:79], v[78:79], v[92:93] op_sel_hi:[1,0] neg_lo:[0,1] neg_hi:[0,1]
  v_pk_add_f32 v[80:81], v[80:81], v[92:93] op_sel_hi:[1,0] neg_lo:[0,1] neg_hi:[0,1]
  v_pk_add_f32 v[82:83], v[82:83], v[92:93] op_sel_hi:[1,0] neg_lo:[0,1] neg_hi:[0,1]
  v_pk_add_f32 v[84:85], v[84:85], v[92:93] op_sel_hi:[1,0] neg_lo:[0,1] neg_hi:[0,1]
  v_pk_add_f32 v[86:87], v[86:87], v[92:93] op_sel_hi:[1,0] neg_lo:[0,1] neg_hi:[0,1]
  v_mov_b32 v104, 0
  v_mov_b32 v105, 0
  v_cvt_pk_bf16_f32 v8, v48, v49
  v_cvt_pk_bf16_f32 v9, v50, v51
  v_cvt_pk_bf16_f32 v10, v52, v53
  v_cvt_pk_bf16_f32 v11, v54, v55
  v_cvt_pk_bf16_f32 v12, v56, v57
  v_cvt_pk_bf16_f32 v13, v58, v59
  v_cvt_pk_bf16_f32 v14, v60, v61
  v_cvt_pk_bf16_f32 v15, v62, v63
  v_cvt_pk_bf16_f32 v16, v64, v65
  v_cvt_pk_bf16_f32 v17, v66, v67
  v_cvt_pk_bf16_f32 v18, v68, v69
  v_cvt_pk_bf16_f32 v19, v70, v71
  v_cvt_pk_bf16_f32 v20, v72, v73
  v_cvt_pk_bf16_f32 v21, v74, v75
  v_cvt_pk_bf16_f32 v22, v76, v77
  v_cvt_pk_bf16_f32 v23, v78, v79
  v_cvt_pk_bf16_f32 v24, v80, v81
  v_cvt_pk_bf16_f32 v25, v82, v83
  v_cvt_pk_bf16_f32 v26, v84, v85
  v_cvt_pk_bf16_f32 v27, v86, v87
  v_lshlrev_b32 v48, 16, v8
  v_and_b32 v49, s56, v8
  v_lshlrev_b32 v50, 16, v9
  v_and_b32 v51, s56, v9
  v_lshlrev_b32 v52, 16, v10
  v_and_b32 v53, s56, v10
  v_lshlrev_b32 v54, 16, v11
  v_and_b32 v55, s56, v11
  v_lshlrev_b32 v56, 16, v12
  v_and_b32 v57, s56, v12
  v_lshlrev_b32 v58, 16, v13
  v_and_b32 v59, s56, v13
  v_lshlrev_b32 v60, 16, v14
  v_and_b32 v61, s56, v14
  v_lshlrev_b32 v62, 16, v15
  v_and_b32 v63, s56, v15
  v_lshlrev_b32 v64, 16, v16
  v_and_b32 v65, s56, v16
  v_lshlrev_b32 v66, 16, v17
  v_and_b32 v67, s56, v17
  v_lshlrev_b32 v68, 16, v18
  v_and_b32 v69, s56, v18
  v_lshlrev_b32 v70, 16, v19
  v_and_b32 v71, s56, v19
  v_lshlrev_b32 v72, 16, v20
  v_and_b32 v73, s56, v20
  v_lshlrev_b32 v74, 16, v21
  v_and_b32 v75, s56, v21
  v_lshlrev_b32 v76, 16, v22
  v_and_b32 v77, s56, v22
  v_lshlrev_b32 v78, 16, v23
  v_and_b32 v79, s56, v23
  v_lshlrev_b32 v80, 16, v24
  v_and_b32 v81, s56, v24
  v_lshlrev_b32 v82, 16, v25
  v_and_b32 v83, s56, v25
  v_lshlrev_b32 v84, 16, v26
  v_and_b32 v85, s56, v26
  v_lshlrev_b32 v86, 16, v27
  v_and_b32 v87, s56, v27
  v_pk_mul_f32 v[48:49], v[48:49], v[100:101] op_sel_hi:[1,0]
  v_pk_mul_f32 v[50:51], v[50:51], v[100:101] op_sel_hi:[1,0]
  v_pk_mul_f32 v[52:53], v[52:53], v[100:101] op_sel_hi:[1,0]
  v_pk_mul_f32 v[54:55], v[54:55], v[100:101] op_sel_hi:[1,0]
  v_cvt_pk_bf16_f32 v8, v48, v49
  v_cvt_pk_bf16_f32 v9, v50, v51
  v_cvt_pk_bf16_f32 v10, v52, v53
  v_cvt_pk_bf16_f32 v11, v54, v55
  buffer_store_dwordx4 v[8:11], v5, s[24:27], s53 offen sc1
  s_add_u32 s53, s53, 16384
  v_pk_mul_f32 v[56:57], v[56:57], v[100:101] op_sel_hi:[1,0]
  v_pk_mul_f32 v[58:59], v[58:59], v[100:101] op_sel_hi:[1,0]
  v_pk_mul_f32 v[60:61], v[60:61], v[100:101] op_sel_hi:[1,0]
  v_pk_mul_f32 v[62:63], v[62:63], v[100:101] op_sel_hi:[1,0]
  v_cvt_pk_bf16_f32 v12, v56, v57
  v_cvt_pk_bf16_f32 v13, v58, v59
  v_cvt_pk_bf16_f32 v14, v60, v61
  v_cvt_pk_bf16_f32 v15, v62, v63
  buffer_store_dwordx4 v[12:15], v5, s[24:27], s53 offen sc1
  s_add_u32 s53, s53, 16384
  v_pk_mul_f32 v[64:65], v[64:65], v[100:101] op_sel_hi:[1,0]
  v_pk_mul_f32 v[66:67], v[66:67], v[100:101] op_sel_hi:[1,0]
  v_pk_mul_f32 v[68:69], v[68:69], v[100:101] op_sel_hi:[1,0]
  v_pk_mul_f32 v[70:71], v[70:71], v[100:101] op_sel_hi:[1,0]
  v_cvt_pk_bf16_f32 v16, v64, v65
  v_cvt_pk_bf16_f32 v17, v66, v67
  v_cvt_pk_bf16_f32 v18, v68, v69
  v_cvt_pk_bf16_f32 v19, v70, v71
  buffer_store_dwordx4 v[16:19], v5, s[24:27], s53 offen sc1
  s_add_u32 s53, s53, 16384
  v_pk_mul_f32 v[72:73], v[72:73], v[100:101] op_sel_hi:[1,0]
  v_pk_mul_f32 v[74:75], v[74:75], v[100:101] op_sel_hi:[1,0]
  v_pk_mul_f32 v[76:77], v[76:77], v[100:101] op_sel_hi:[1,0]
  v_pk_mul_f32 v[78:79], v[78:79], v[100:101] op_sel_hi:[1,0]
  v_cvt_pk_bf16_f32 v20, v72, v73
  v_cvt_pk_bf16_f32 v21, v74, v75
  v_cvt_pk_bf16_f32 v22, v76, v77
  v_cvt_pk_bf16_f32 v23, v78, v79
  buffer_store_dwordx4 v[20:23], v5, s[24:27], s53 offen sc1
  s_add_u32 s53, s53, 16384
  v_pk_mul_f32 v[80:81], v[80:81], v[100:101] op_sel_hi:[1,0]
  v_pk_mul_f32 v[82:83], v[82:83], v[100:101] op_sel_hi:[1,0]
  v_pk_mul_f32 v[84:85], v[84:85], v[100:101] op_sel_hi:[1,0]
  v_pk_mul_f32 v[86:87], v[86:87], v[100:101] op_sel_hi:[1,0]
  v_cvt_pk_bf16_f32 v24, v80, v81
  v_cvt_pk_bf16_f32 v25, v82, v83
  v_cvt_pk_bf16_f32 v26, v84, v85
  v_cvt_pk_bf16_f32 v27, v86, v87
  buffer_store_dwordx4 v[24:27], v5, s[24:27], s53 offen sc1
  s_add_u32 s53, s53, 16384
  s_waitcnt vmcnt(11)
  v_dot2_f32_bf16 v104, v8, v28, v104
  v_dot2_f32_bf16 v105, v9, v29, v105
  v_dot2_f32_bf16 v104, v10, v30, v104
  v_dot2_f32_bf16 v105, v11, v31, v105
  s_waitcnt vmcnt(10)
  v_dot2_f32_bf16 v104, v12, v32, v104
  v_dot2_f32_bf16 v105, v13, v33, v105
  v_dot2_f32_bf16 v104, v14, v34, v104
  v_dot2_f32_bf16 v105, v15, v35, v105
  s_waitcnt vmcnt(9)
  v_dot2_f32_bf16 v104, v16, v36, v104
  v_dot2_f32_bf16 v105, v17, v37, v105
  v_dot2_f32_bf16 v104, v18, v38, v104
  v_dot2_f32_bf16 v105, v19, v39, v105
  s_waitcnt vmcnt(8)
  v_dot2_f32_bf16 v104, v20, v40, v104
  v_dot2_f32_bf16 v105, v21, v41, v105
  v_dot2_f32_bf16 v104, v22, v42, v104
  v_dot2_f32_bf16 v105, v23, v43, v105
  s_waitcnt vmcnt(7)
  v_dot2_f32_bf16 v104, v24, v44, v104
  v_dot2_f32_bf16 v105, v25, v45, v105
  v_dot2_f32_bf16 v104, v26, v46, v104
  v_dot2_f32_bf16 v105, v27, v47, v105
  s_nop 2
  v_add_f32 v104, v104, v105
  s_nop 1
  v_add_f32_dpp v104, v104, v104 row_ror:8 row_mask:0xf bank_mask:0xf
  s_nop 1
  v_add_f32_dpp v104, v104, v104 row_ror:4 row_mask:0xf bank_mask:0xf
  s_nop 1
  v_add_f32_dpp v104, v104, v104 row_ror:2 row_mask:0xf bank_mask:0xf
  s_nop 1
  v_add_f32_dpp v104, v104, v104 row_ror:1 row_mask:0xf bank_mask:0xf
  v_cvt_pk_bf16_f32 v104, v104, v104
  v_lshlrev_b32 v104, 16, v104
  v_ashrrev_i32 v105, 31, v104
  v_or_b32 v105, 0x80000000, v105
  v_xor_b32 v104, v104, v105
  v_and_b32 v104, s56, v104
  v_add_u32 v6, s52, v1
  v_sub_u32 v7, 0xffff, v6
  v_or_b32 v104, v104, v7
  v_lshlrev_b32 v6, 2, v6
  v_lshl_add_u32 v6, v2, 26, v6
  s_mov_b32 s53, 2621440
  buffer_store_dword v104, v6, s[24:27], s53 offen sc1
  s_waitcnt vmcnt(0)
  s_branch front_join
front_fetch:
  s_getpc_b64 s[98:99]
attn_hot_pc:
  s_add_u32 s98, s98, attn_hot-attn_hot_pc
  s_addc_u32 s99, s99, 0
  s_lshr_b32 s100, s2, 3
  v_min_u32 v249, 17, v0
  v_lshlrev_b32 v249, 5, v249
  v_add_u32 v249, s100, v249
  v_lshlrev_b32 v249, 7, v249
  v_min_u32 v249, attn_end-attn_hot-4, v249
  global_load_dword v255, v249, s[98:99]
attn_hot:
  v_subrev_u32 v16, 0x40000, v238
  v_subrev_u32 v17, 0x40000, v239
  v_subrev_u32 v18, 0x40000, v240
  v_subrev_u32 v19, 0x40000, v241
  s_mov_b32 s31, 0
  s_add_u32 m0, s28, 90112
  s_nop 0
  buffer_load_dwordx4 v16, s[20:23], s31 offen offset:0 lds
  buffer_load_dwordx4 v17, s[20:23], s31 offen offset:1024 lds
  buffer_load_dwordx4 v18, s[20:23], s31 offen offset:2048 lds
  buffer_load_dwordx4 v19, s[20:23], s31 offen offset:3072 lds
  s_add_u32 m0, s28, 98304
  s_nop 0
  buffer_load_dwordx4 v238, s[20:23], s31 offen offset:0 lds
  buffer_load_dwordx4 v239, s[20:23], s31 offen offset:1024 lds
  buffer_load_dwordx4 v240, s[20:23], s31 offen offset:2048 lds
  buffer_load_dwordx4 v241, s[20:23], s31 offen offset:3072 lds
front_join:
  s_waitcnt lgkmcnt(0)
  s_barrier
  s_mul_i32 s55, s59, 0x9e3779b1
  s_add_u32 s55, s55, 0x7f4a7c15
  s_bfe_u32 s58, s2, 0x30003
  s_lshl_b32 s58, s58, 8
  s_add_u32 s58, s58, 2826240
  s_lshl_b32 s53, s36, 2
  s_lshl_b32 s54, s3, 26
  s_add_u32 s53, s53, s54
  v_min_u32 v1, 1, v0
  v_lshlrev_b32 v1, 28, v1
  v_add_u32 v1, s53, v1
  v_mov_b32 v2, s55
  buffer_store_dword v2, v1, s[24:27], s58 offen sc1
  s_cmp_lt_u32 s3, 2
  s_cbranch_scc1 front_addr
  s_mov_b32 s31, 524288
  s_add_u32 m0, s28, 106496
  s_nop 0
  buffer_load_dwordx4 v16, s[20:23], s31 offen offset:0 lds
  buffer_load_dwordx4 v17, s[20:23], s31 offen offset:1024 lds
  buffer_load_dwordx4 v18, s[20:23], s31 offen offset:2048 lds
  buffer_load_dwordx4 v19, s[20:23], s31 offen offset:3072 lds
  s_add_u32 m0, s28, 114688
  s_nop 0
  buffer_load_dwordx4 v238, s[20:23], s31 offen offset:0 lds
  buffer_load_dwordx4 v239, s[20:23], s31 offen offset:1024 lds
  buffer_load_dwordx4 v240, s[20:23], s31 offen offset:2048 lds
  buffer_load_dwordx4 v241, s[20:23], s31 offen offset:3072 lds
  s_mov_b32 s31, 1048576
  s_add_u32 m0, s28, 24576
  s_nop 0
  buffer_load_dwordx4 v16, s[20:23], s31 offen offset:0 lds
  buffer_load_dwordx4 v17, s[20:23], s31 offen offset:1024 lds
  buffer_load_dwordx4 v18, s[20:23], s31 offen offset:2048 lds
  buffer_load_dwordx4 v19, s[20:23], s31 offen offset:3072 lds
  s_add_u32 m0, s28, 32768
  s_nop 0
  buffer_load_dwordx4 v238, s[20:23], s31 offen offset:0 lds
  buffer_load_dwordx4 v239, s[20:23], s31 offen offset:1024 lds
  buffer_load_dwordx4 v240, s[20:23], s31 offen offset:2048 lds
  buffer_load_dwordx4 v241, s[20:23], s31 offen offset:3072 lds
  s_mov_b32 s31, 1572864
  s_add_u32 m0, s28, 40960
  s_nop 0
  buffer_load_dwordx4 v16, s[20:23], s31 offen offset:0 lds
  buffer_load_dwordx4 v17, s[20:23], s31 offen offset:1024 lds
  buffer_load_dwordx4 v18, s[20:23], s31 offen offset:2048 lds
  buffer_load_dwordx4 v19, s[20:23], s31 offen offset:3072 lds
  s_add_u32 m0, s28, 49152
  s_nop 0
  buffer_load_dwordx4 v238, s[20:23], s31 offen offset:0 lds
  buffer_load_dwordx4 v239, s[20:23], s31 offen offset:1024 lds
  buffer_load_dwordx4 v240, s[20:23], s31 offen offset:2048 lds
  buffer_load_dwordx4 v241, s[20:23], s31 offen offset:3072 lds
front_addr:
  s_mov_b32 s31, 2097152
  v_lshlrev_b32 v242, 4, v245
  v_add_u32 v243, 0x1000, v242
  s_mul_i32 s30, s37, 81920
  s_lshl_b32 s38, s36, 19
  s_add_u32 s12, s4, s38
  s_addc_u32 s13, s5, 0
  s_mov_b32 s14, 524288
  s_mov_b32 s15, 0x20000
  s_add_u32 s16, s6, s38
  s_addc_u32 s17, s7, 0
  s_mov_b32 s18, 524288
  s_mov_b32 s19, 0x20000
  v_lshlrev_b32 v249, 8, v248
  v_add_u32 v249, s28, v249
  v_add_u32 v250, 0, v248
  v_xor_b32 v250, v250, v247
  v_lshl_add_u32 v232, v250, 4, v249
  v_add_u32 v250, 4, v248
  v_xor_b32 v250, v250, v247
  v_lshl_add_u32 v233, v250, 4, v249
  v_add_u32 v250, 8, v248
  v_xor_b32 v250, v250, v247
  v_lshl_add_u32 v234, v250, 4, v249
  v_add_u32 v250, 12, v248
  v_xor_b32 v250, v250, v247
  v_lshl_add_u32 v235, v250, 4, v249
  v_add_u32 v250, 0, v248
  v_lshlrev_b32 v250, 1, v250
  v_xor_b32 v250, v250, v247
  v_lshl_add_u32 v236, v250, 4, v249
  v_add_u32 v250, 4, v248
  v_lshlrev_b32 v250, 1, v250
  v_xor_b32 v250, v250, v247
  v_lshl_add_u32 v237, v250, 4, v249
  v_lshrrev_b32 v249, 1, v248
  v_and_b32 v250, 1, v248
  v_lshl_or_b32 v249, v250, 1, v249
  v_xor_b32 v249, v249, v247
  v_lshlrev_b32 v249, 4, v249
  v_lshl_add_u32 v212, v247, 8, v249
  v_xor_b32 v213, 64, v212
  v_xor_b32 v214, 128, v212
  v_xor_b32 v215, 192, v212
  v_bfe_u32 v246, v245, 2, 2
  v_and_b32 v247, 3, v245
  v_lshlrev_b32 v247, 3, v247
  v_add_u32 v247, 65536, v247
  v_lshl_add_u32 v249, v248, 2, v246
  v_and_b32 v250, 7, v249
  v_lshl_add_u32 v250, v250, 5, v247
  v_lshl_add_u32 v216, v249, 8, v250
  v_lshl_add_u32 v249, v248, 3, v246
  v_and_b32 v250, 1, v248
  v_lshl_add_u32 v250, v250, 2, v246
  v_lshl_add_u32 v250, v250, 5, v247
  v_lshl_add_u32 v224, v249, 8, v250
  v_xor_b32 v217, 32, v216
  v_xor_b32 v225, 32, v224
  v_xor_b32 v218, 64, v216
  v_xor_b32 v226, 64, v224
  v_xor_b32 v219, 96, v216
  v_xor_b32 v227, 96, v224
  v_xor_b32 v220, 128, v216
  v_xor_b32 v228, 128, v224
  v_xor_b32 v221, 160, v216
  v_xor_b32 v229, 160, v224
  v_xor_b32 v222, 192, v216
  v_xor_b32 v230, 192, v224
  v_xor_b32 v223, 224, v216
  v_xor_b32 v231, 224, v224
  v_subrev_u32 v144, 65536, v224
  v_subrev_u32 v145, 65536, v225
  v_subrev_u32 v146, 65536, v226
  v_subrev_u32 v147, 65536, v227
  v_subrev_u32 v148, 65536, v228
  v_subrev_u32 v149, 65536, v229
  v_subrev_u32 v150, 65536, v230
  v_subrev_u32 v151, 65536, v231
  s_lshr_b32 s38, s2, 3
  s_min_u32 s38, s38, 26
  s_and_b32 s39, s2, 7
  s_mul_i32 s39, s39, 27
  s_add_u32 s33, s38, s39
  s_mul_i32 s50, s3, 6144
  s_add_u32 s50, s50, 133120
  v_mov_b32 v244, v242
  s_lshl_b32 s40, s37, 19
  s_lshl_b32 s38, s36, 14
  s_add_u32 s40, s40, s38
  s_add_u32 s40, s40, 8388608
  s_add_u32 s41, s40, 4096
  s_add_u32 s42, s40, 8192
  s_add_u32 s43, s40, 12288
  s_mov_b32 s34, 0x3e0293ee
  s_mov_b32 s29, 0
  v_and_b32 v249, 15, v245
  v_cmp_eq_u32 vcc, 0, v249
  v_mov_b32 v249, 0x3f803f80
  s_nop 0
  v_cndmask_b32 v249, 0, v249, vcc
  v_accvgpr_write_b32 a208, v249
  v_accvgpr_write_b32 a209, v249
  v_accvgpr_write_b32 a210, v249
  v_accvgpr_write_b32 a211, v249
  s_cmp_lg_u32 s3, 0
  s_cbranch_scc1 front_go
  v_and_b32 v2, 31, v0
  v_lshlrev_b32 v2, 2, v2
  s_mov_b32 s54, 32768
front_poll:
  buffer_load_dword v1, v2, s[24:27], s58 offen sc1
  s_waitcnt vmcnt(0)
  v_cmp_ne_u32 vcc, s55, v1
  s_nop 0
  s_cbranch_vccz front_go
  s_sleep 2
  s_sub_u32 s54, s54, 1
  s_cmp_lg_u32 s54, 0
  s_cbranch_scc1 front_poll
front_go:
  s_waitcnt vmcnt(25)
  s_barrier
  buffer_load_dwordx4 a[0:3], v242, s[24:27], s30 offen offset:0 sc1
  buffer_load_dwordx4 a[4:7], v242, s[24:27], s30 offen offset:1024 sc1
  buffer_load_dwordx4 a[8:11], v242, s[24:27], s30 offen offset:2048 sc1
  buffer_load_dwordx4 a[12:15], v242, s[24:27], s30 offen offset:3072 sc1
  buffer_load_dwordx4 a[16:19], v243, s[24:27], s30 offen offset:0 sc1
  buffer_load_dwordx4 a[20:23], v243, s[24:27], s30 offen offset:1024 sc1
  buffer_load_dwordx4 a[24:27], v243, s[24:27], s30 offen offset:2048 sc1
  buffer_load_dwordx4 a[28:31], v243, s[24:27], s30 offen offset:3072 sc1
  s_add_u32 s30, s30, 8192
  buffer_load_dwordx4 a[32:35], v242, s[24:27], s30 offen offset:0 sc1
  buffer_load_dwordx4 a[36:39], v242, s[24:27], s30 offen offset:1024 sc1
  buffer_load_dwordx4 a[40:43], v242, s[24:27], s30 offen offset:2048 sc1
  buffer_load_dwordx4 a[44:47], v242, s[24:27], s30 offen offset:3072 sc1
  buffer_load_dwordx4 a[48:51], v243, s[24:27], s30 offen offset:0 sc1
  buffer_load_dwordx4 a[52:55], v243, s[24:27], s30 offen offset:1024 sc1
  buffer_load_dwordx4 a[56:59], v243, s[24:27], s30 offen offset:2048 sc1
  buffer_load_dwordx4 a[60:63], v243, s[24:27], s30 offen offset:3072 sc1
  s_add_u32 s30, s30, 8192
  v_lshrrev_b32 v140, 7, v242
  v_lshlrev_b32 v140, 8, v140
  v_and_b32 v136, 0x70, v242
  v_add_u32 v140, v140, v136
  s_mov_b32 s58, 2826240
  buffer_load_dwordx4 v[136:139], v140, s[24:27], s58 offen sc1
  ds_read_b64_tr_b16 a[160:161], v224 offset:32768
  ds_read_b64_tr_b16 a[162:163], v224 offset:33792
  ds_read_b64_tr_b16 a[164:165], v224 offset:40960
  ds_read_b64_tr_b16 a[166:167], v224 offset:41984
  ds_read_b64_tr_b16 a[168:169], v225 offset:32768
  ds_read_b64_tr_b16 a[170:171], v225 offset:33792
  ds_read_b64_tr_b16 a[172:173], v225 offset:40960
  ds_read_b64_tr_b16 a[174:175], v225 offset:41984
  s_waitcnt vmcnt(9) lgkmcnt(4)
  v_mfma_f32_16x16x32_bf16 v[0:3], a[160:163], a[0:3], 0
  ds_read_b64_tr_b16 a[176:177], v226 offset:32768
  v_mfma_f32_16x16x32_bf16 v[0:3], a[164:167], a[16:19], v[0:3]
  buffer_load_dwordx4 a[64:67], v242, s[24:27], s30 offen offset:0 sc1
  v_mfma_f32_16x16x32_bf16 v[4:7], a[164:167], a[20:23], 0
  ds_read_b64_tr_b16 a[178:179], v226 offset:33792
  v_mfma_f32_16x16x32_bf16 v[4:7], a[160:163], a[4:7], v[4:7]
  buffer_load_dwordx4 a[68:71], v242, s[24:27], s30 offen offset:1024 sc1
  v_mfma_f32_16x16x32_bf16 v[8:11], a[160:163], a[8:11], 0
  ds_read_b64_tr_b16 a[180:181], v226 offset:40960
  v_mfma_f32_16x16x32_bf16 v[8:11], a[164:167], a[24:27], v[8:11]
  v_mfma_f32_16x16x32_bf16 v[12:15], a[164:167], a[28:31], 0
  ds_read_b64_tr_b16 a[182:183], v226 offset:41984
  v_mfma_f32_16x16x32_bf16 v[12:15], a[160:163], a[12:15], v[12:15]
  s_waitcnt lgkmcnt(4)
  buffer_load_dwordx4 a[72:75], v242, s[24:27], s30 offen offset:2048 sc1
  v_mfma_f32_16x16x32_bf16 v[16:19], a[168:171], a[0:3], 0
  ds_read_b64_tr_b16 a[184:185], v227 offset:32768
  v_mfma_f32_16x16x32_bf16 v[16:19], a[172:175], a[16:19], v[16:19]
  v_mfma_f32_16x16x32_bf16 v[20:23], a[172:175], a[20:23], 0
  ds_read_b64_tr_b16 a[186:187], v227 offset:33792
  v_mfma_f32_16x16x32_bf16 v[20:23], a[168:171], a[4:7], v[20:23]
  buffer_load_dwordx4 a[76:79], v242, s[24:27], s30 offen offset:3072 sc1
  v_mfma_f32_16x16x32_bf16 v[24:27], a[168:171], a[8:11], 0
  ds_read_b64_tr_b16 a[188:189], v227 offset:40960
  v_mfma_f32_16x16x32_bf16 v[24:27], a[172:175], a[24:27], v[24:27]
  buffer_load_dwordx4 a[80:83], v243, s[24:27], s30 offen offset:0 sc1
  v_mfma_f32_16x16x32_bf16 v[28:31], a[172:175], a[28:31], 0
  ds_read_b64_tr_b16 a[190:191], v227 offset:41984
  v_mfma_f32_16x16x32_bf16 v[28:31], a[168:171], a[12:15], v[28:31]
  s_waitcnt lgkmcnt(4)
  v_mfma_f32_16x16x32_bf16 v[32:35], a[176:179], a[0:3], 0
  ds_read_b64_tr_b16 a[160:161], v228 offset:32768
  v_mfma_f32_16x16x32_bf16 v[32:35], a[180:183], a[16:19], v[32:35]
  buffer_load_dwordx4 a[84:87], v243, s[24:27], s30 offen offset:1024 sc1
  v_mfma_f32_16x16x32_bf16 v[36:39], a[180:183], a[20:23], 0
  ds_read_b64_tr_b16 a[162:163], v228 offset:33792
  v_mfma_f32_16x16x32_bf16 v[36:39], a[176:179], a[4:7], v[36:39]
  v_mfma_f32_16x16x32_bf16 v[40:43], a[176:179], a[8:11], 0
  ds_read_b64_tr_b16 a[164:165], v228 offset:40960
  v_mfma_f32_16x16x32_bf16 v[40:43], a[180:183], a[24:27], v[40:43]
  buffer_load_dwordx4 a[88:91], v243, s[24:27], s30 offen offset:2048 sc1
  v_mfma_f32_16x16x32_bf16 v[44:47], a[180:183], a[28:31], 0
  ds_read_b64_tr_b16 a[166:167], v228 offset:41984
  v_mfma_f32_16x16x32_bf16 v[44:47], a[176:179], a[12:15], v[44:47]
  s_waitcnt lgkmcnt(4)
  buffer_load_dwordx4 a[92:95], v243, s[24:27], s30 offen offset:3072 sc1
  v_mfma_f32_16x16x32_bf16 v[48:51], a[184:187], a[0:3], 0
  ds_read_b64_tr_b16 a[168:169], v229 offset:32768
  v_mfma_f32_16x16x32_bf16 v[48:51], a[188:191], a[16:19], v[48:51]
  v_mfma_f32_16x16x32_bf16 v[52:55], a[188:191], a[20:23], 0
  ds_read_b64_tr_b16 a[170:171], v229 offset:33792
  v_mfma_f32_16x16x32_bf16 v[52:55], a[184:187], a[4:7], v[52:55]
  s_add_u32 s30, s30, 8192
  v_mfma_f32_16x16x32_bf16 v[56:59], a[184:187], a[8:11], 0
  ds_read_b64_tr_b16 a[172:173], v229 offset:40960
  v_mfma_f32_16x16x32_bf16 v[56:59], a[188:191], a[24:27], v[56:59]
  v_mfma_f32_16x16x32_bf16 v[60:63], a[188:191], a[28:31], 0
  ds_read_b64_tr_b16 a[174:175], v229 offset:41984
  v_mfma_f32_16x16x32_bf16 v[60:63], a[184:187], a[12:15], v[60:63]
  s_waitcnt lgkmcnt(4)
  buffer_load_dwordx4 a[96:99], v242, s[24:27], s30 offen offset:0 sc1
  v_mfma_f32_16x16x32_bf16 v[64:67], a[160:163], a[0:3], 0
  ds_read_b64_tr_b16 a[176:177], v230 offset:32768
  v_mfma_f32_16x16x32_bf16 v[64:67], a[164:167], a[16:19], v[64:67]
  buffer_load_dwordx4 a[100:103], v242, s[24:27], s30 offen offset:1024 sc1
  v_mfma_f32_16x16x32_bf16 v[68:71], a[164:167], a[20:23], 0
  ds_read_b64_tr_b16 a[178:179], v230 offset:33792
  v_mfma_f32_16x16x32_bf16 v[68:71], a[160:163], a[4:7], v[68:71]
  v_mfma_f32_16x16x32_bf16 v[72:75], a[160:163], a[8:11], 0
  ds_read_b64_tr_b16 a[180:181], v230 offset:40960
  v_mfma_f32_16x16x32_bf16 v[72:75], a[164:167], a[24:27], v[72:75]
  buffer_load_dwordx4 a[104:107], v242, s[24:27], s30 offen offset:2048 sc1
  v_mfma_f32_16x16x32_bf16 v[76:79], a[164:167], a[28:31], 0
  ds_read_b64_tr_b16 a[182:183], v230 offset:41984
  v_mfma_f32_16x16x32_bf16 v[76:79], a[160:163], a[12:15], v[76:79]
  s_waitcnt lgkmcnt(4)
  v_mfma_f32_16x16x32_bf16 v[80:83], a[168:171], a[0:3], 0
  ds_read_b64_tr_b16 a[184:185], v231 offset:32768
  v_mfma_f32_16x16x32_bf16 v[80:83], a[172:175], a[16:19], v[80:83]
  buffer_load_dwordx4 a[108:111], v242, s[24:27], s30 offen offset:3072 sc1
  v_mfma_f32_16x16x32_bf16 v[84:87], a[172:175], a[20:23], 0
  ds_read_b64_tr_b16 a[186:187], v231 offset:33792
  v_mfma_f32_16x16x32_bf16 v[84:87], a[168:171], a[4:7], v[84:87]
  buffer_load_dwordx4 a[112:115], v243, s[24:27], s30 offen offset:0 sc1
  v_mfma_f32_16x16x32_bf16 v[88:91], a[168:171], a[8:11], 0
  ds_read_b64_tr_b16 a[188:189], v231 offset:40960
  v_mfma_f32_16x16x32_bf16 v[88:91], a[172:175], a[24:27], v[88:91]
  s_barrier
  v_mfma_f32_16x16x32_bf16 v[92:95], a[172:175], a[28:31], 0
  ds_read_b64_tr_b16 a[190:191], v231 offset:41984
  v_mfma_f32_16x16x32_bf16 v[92:95], a[168:171], a[12:15], v[92:95]
  s_waitcnt lgkmcnt(4)
  buffer_load_dwordx4 a[116:119], v243, s[24:27], s30 offen offset:1024 sc1
  v_mfma_f32_16x16x32_bf16 v[96:99], a[176:179], a[0:3], 0
  ds_read_b64_tr_b16 a[160:161], v224 offset:49152
  v_mfma_f32_16x16x32_bf16 v[96:99], a[180:183], a[16:19], v[96:99]
  v_mfma_f32_16x16x32_bf16 v[100:103], a[180:183], a[20:23], 0
  ds_read_b64_tr_b16 a[162:163], v224 offset:50176
  v_mfma_f32_16x16x32_bf16 v[100:103], a[176:179], a[4:7], v[100:103]
  buffer_load_dwordx4 a[120:123], v243, s[24:27], s30 offen offset:2048 sc1
  v_mfma_f32_16x16x32_bf16 v[104:107], a[176:179], a[8:11], 0
  ds_read_b64_tr_b16 a[164:165], v224 offset:57344
  v_mfma_f32_16x16x32_bf16 v[104:107], a[180:183], a[24:27], v[104:107]
  buffer_load_dwordx4 a[124:127], v243, s[24:27], s30 offen offset:3072 sc1
  v_mfma_f32_16x16x32_bf16 v[108:111], a[180:183], a[28:31], 0
  ds_read_b64_tr_b16 a[166:167], v224 offset:58368
  v_mfma_f32_16x16x32_bf16 v[108:111], a[176:179], a[12:15], v[108:111]
  s_waitcnt lgkmcnt(4)
  v_mfma_f32_16x16x32_bf16 v[112:115], a[184:187], a[0:3], 0
  ds_read_b64_tr_b16 a[168:169], v225 offset:49152
  v_mfma_f32_16x16x32_bf16 v[112:115], a[188:191], a[16:19], v[112:115]
  s_add_u32 s30, s30, 8192
  v_mfma_f32_16x16x32_bf16 v[116:119], a[188:191], a[20:23], 0
  ds_read_b64_tr_b16 a[170:171], v225 offset:50176
  v_mfma_f32_16x16x32_bf16 v[116:119], a[184:187], a[4:7], v[116:119]
  v_mfma_f32_16x16x32_bf16 v[120:123], a[184:187], a[8:11], 0
  ds_read_b64_tr_b16 a[172:173], v225 offset:57344
  v_mfma_f32_16x16x32_bf16 v[120:123], a[188:191], a[24:27], v[120:123]
  v_mfma_f32_16x16x32_bf16 v[124:127], a[188:191], a[28:31], 0
  ds_read_b64_tr_b16 a[174:175], v225 offset:58368
  v_mfma_f32_16x16x32_bf16 v[124:127], a[184:187], a[12:15], v[124:127]
  s_waitcnt vmcnt(17) lgkmcnt(4)
  v_mfma_f32_16x16x32_bf16 v[0:3], a[160:163], a[32:35], v[0:3]
  ds_read_b64_tr_b16 a[176:177], v226 offset:49152
  v_mfma_f32_16x16x32_bf16 v[0:3], a[164:167], a[48:51], v[0:3]
  buffer_load_dwordx4 a[0:3], v242, s[24:27], s30 offen offset:0 sc1
  v_mfma_f32_16x16x32_bf16 v[4:7], a[164:167], a[52:55], v[4:7]
  ds_read_b64_tr_b16 a[178:179], v226 offset:50176
  v_mfma_f32_16x16x32_bf16 v[4:7], a[160:163], a[36:39], v[4:7]
  v_mfma_f32_16x16x32_bf16 v[8:11], a[160:163], a[40:43], v[8:11]
  ds_read_b64_tr_b16 a[180:181], v226 offset:57344
  s_add_u32 m0, s28, 16384
  v_mfma_f32_16x16x32_bf16 v[8:11], a[164:167], a[56:59], v[8:11]
  buffer_load_dwordx4 v238, s[20:23], s31 offen offset:0 lds
  v_mfma_f32_16x16x32_bf16 v[12:15], a[164:167], a[60:63], v[12:15]
  ds_read_b64_tr_b16 a[182:183], v226 offset:58368
  v_mfma_f32_16x16x32_bf16 v[12:15], a[160:163], a[44:47], v[12:15]
  s_waitcnt lgkmcnt(4)
  v_mfma_f32_16x16x32_bf16 v[16:19], a[168:171], a[32:35], v[16:19]
  ds_read_b64_tr_b16 a[184:185], v227 offset:49152
  v_mfma_f32_16x16x32_bf16 v[16:19], a[172:175], a[48:51], v[16:19]
  buffer_load_dwordx4 a[4:7], v242, s[24:27], s30 offen offset:1024 sc1
  v_mfma_f32_16x16x32_bf16 v[20:23], a[172:175], a[52:55], v[20:23]
  ds_read_b64_tr_b16 a[186:187], v227 offset:50176
  v_mfma_f32_16x16x32_bf16 v[20:23], a[168:171], a[36:39], v[20:23]
  v_mfma_f32_16x16x32_bf16 v[24:27], a[168:171], a[40:43], v[24:27]
  ds_read_b64_tr_b16 a[188:189], v227 offset:57344
  v_mfma_f32_16x16x32_bf16 v[24:27], a[172:175], a[56:59], v[24:27]
  v_mfma_f32_16x16x32_bf16 v[28:31], a[172:175], a[60:63], v[28:31]
  ds_read_b64_tr_b16 a[190:191], v227 offset:58368
  v_mfma_f32_16x16x32_bf16 v[28:31], a[168:171], a[44:47], v[28:31]
  s_waitcnt lgkmcnt(4)
  v_mfma_f32_16x16x32_bf16 v[32:35], a[176:179], a[32:35], v[32:35]
  ds_read_b64_tr_b16 a[160:161], v228 offset:49152
  v_mfma_f32_16x16x32_bf16 v[32:35], a[180:183], a[48:51], v[32:35]
  buffer_load_dwordx4 a[8:11], v242, s[24:27], s30 offen offset:2048 sc1
  v_mfma_f32_16x16x32_bf16 v[36:39], a[180:183], a[52:55], v[36:39]
  ds_read_b64_tr_b16 a[162:163], v228 offset:50176
  v_mfma_f32_16x16x32_bf16 v[36:39], a[176:179], a[36:39], v[36:39]
  v_mfma_f32_16x16x32_bf16 v[40:43], a[176:179], a[40:43], v[40:43]
  ds_read_b64_tr_b16 a[164:165], v228 offset:57344
  v_mfma_f32_16x16x32_bf16 v[40:43], a[180:183], a[56:59], v[40:43]
  buffer_load_dwordx4 v239, s[20:23], s31 offen offset:1024 lds
  v_mfma_f32_16x16x32_bf16 v[44:47], a[180:183], a[60:63], v[44:47]
  ds_read_b64_tr_b16 a[166:167], v228 offset:58368
  v_mfma_f32_16x16x32_bf16 v[44:47], a[176:179], a[44:47], v[44:47]
  s_waitcnt lgkmcnt(4)
  v_mfma_f32_16x16x32_bf16 v[48:51], a[184:187], a[32:35], v[48:51]
  ds_read_b64_tr_b16 a[168:169], v229 offset:49152
  v_mfma_f32_16x16x32_bf16 v[48:51], a[188:191], a[48:51], v[48:51]
  buffer_load_dwordx4 a[12:15], v242, s[24:27], s30 offen offset:3072 sc1
  v_mfma_f32_16x16x32_bf16 v[52:55], a[188:191], a[52:55], v[52:55]
  ds_read_b64_tr_b16 a[170:171], v229 offset:50176
  v_mfma_f32_16x16x32_bf16 v[52:55], a[184:187], a[36:39], v[52:55]
  v_mfma_f32_16x16x32_bf16 v[56:59], a[184:187], a[40:43], v[56:59]
  ds_read_b64_tr_b16 a[172:173], v229 offset:57344
  v_mfma_f32_16x16x32_bf16 v[56:59], a[188:191], a[56:59], v[56:59]
  v_mfma_f32_16x16x32_bf16 v[60:63], a[188:191], a[60:63], v[60:63]
  ds_read_b64_tr_b16 a[174:175], v229 offset:58368
  v_mfma_f32_16x16x32_bf16 v[60:63], a[184:187], a[44:47], v[60:63]
  s_waitcnt lgkmcnt(4)
  v_mfma_f32_16x16x32_bf16 v[64:67], a[160:163], a[32:35], v[64:67]
  ds_read_b64_tr_b16 a[176:177], v230 offset:49152
  v_mfma_f32_16x16x32_bf16 v[64:67], a[164:167], a[48:51], v[64:67]
  buffer_load_dwordx4 a[16:19], v243, s[24:27], s30 offen offset:0 sc1
  v_mfma_f32_16x16x32_bf16 v[68:71], a[164:167], a[52:55], v[68:71]
  ds_read_b64_tr_b16 a[178:179], v230 offset:50176
  v_mfma_f32_16x16x32_bf16 v[68:71], a[160:163], a[36:39], v[68:71]
  v_mfma_f32_16x16x32_bf16 v[72:75], a[160:163], a[40:43], v[72:75]
  ds_read_b64_tr_b16 a[180:181], v230 offset:57344
  v_mfma_f32_16x16x32_bf16 v[72:75], a[164:167], a[56:59], v[72:75]
  buffer_load_dwordx4 v240, s[20:23], s31 offen offset:2048 lds
  v_mfma_f32_16x16x32_bf16 v[76:79], a[164:167], a[60:63], v[76:79]
  ds_read_b64_tr_b16 a[182:183], v230 offset:58368
  v_mfma_f32_16x16x32_bf16 v[76:79], a[160:163], a[44:47], v[76:79]
  s_waitcnt lgkmcnt(4)
  v_mfma_f32_16x16x32_bf16 v[80:83], a[168:171], a[32:35], v[80:83]
  ds_read_b64_tr_b16 a[184:185], v231 offset:49152
  v_mfma_f32_16x16x32_bf16 v[80:83], a[172:175], a[48:51], v[80:83]
  buffer_load_dwordx4 a[20:23], v243, s[24:27], s30 offen offset:1024 sc1
  v_mfma_f32_16x16x32_bf16 v[84:87], a[172:175], a[52:55], v[84:87]
  ds_read_b64_tr_b16 a[186:187], v231 offset:50176
  v_mfma_f32_16x16x32_bf16 v[84:87], a[168:171], a[36:39], v[84:87]
  v_mfma_f32_16x16x32_bf16 v[88:91], a[168:171], a[40:43], v[88:91]
  ds_read_b64_tr_b16 a[188:189], v231 offset:57344
  v_mfma_f32_16x16x32_bf16 v[88:91], a[172:175], a[56:59], v[88:91]
  s_barrier
  v_mfma_f32_16x16x32_bf16 v[92:95], a[172:175], a[60:63], v[92:95]
  ds_read_b64_tr_b16 a[190:191], v231 offset:58368
  v_mfma_f32_16x16x32_bf16 v[92:95], a[168:171], a[44:47], v[92:95]
  s_waitcnt lgkmcnt(4)
  v_mfma_f32_16x16x32_bf16 v[96:99], a[176:179], a[32:35], v[96:99]
  ds_read_b64_tr_b16 a[160:161], v144 offset:32768
  v_mfma_f32_16x16x32_bf16 v[96:99], a[180:183], a[48:51], v[96:99]
  buffer_load_dwordx4 a[24:27], v243, s[24:27], s30 offen offset:2048 sc1
  v_mfma_f32_16x16x32_bf16 v[100:103], a[180:183], a[52:55], v[100:103]
  ds_read_b64_tr_b16 a[162:163], v144 offset:33792
  v_mfma_f32_16x16x32_bf16 v[100:103], a[176:179], a[36:39], v[100:103]
  v_mfma_f32_16x16x32_bf16 v[104:107], a[176:179], a[40:43], v[104:107]
  ds_read_b64_tr_b16 a[164:165], v144 offset:40960
  v_mfma_f32_16x16x32_bf16 v[104:107], a[180:183], a[56:59], v[104:107]
  buffer_load_dwordx4 v241, s[20:23], s31 offen offset:3072 lds
  s_add_u32 s31, s31, 0x80000
  v_mfma_f32_16x16x32_bf16 v[108:111], a[180:183], a[60:63], v[108:111]
  ds_read_b64_tr_b16 a[166:167], v144 offset:41984
  v_mfma_f32_16x16x32_bf16 v[108:111], a[176:179], a[44:47], v[108:111]
  s_waitcnt lgkmcnt(4)
  v_mfma_f32_16x16x32_bf16 v[112:115], a[184:187], a[32:35], v[112:115]
  ds_read_b64_tr_b16 a[168:169], v145 offset:32768
  v_mfma_f32_16x16x32_bf16 v[112:115], a[188:191], a[48:51], v[112:115]
  buffer_load_dwordx4 a[28:31], v243, s[24:27], s30 offen offset:3072 sc1
  s_add_u32 s30, s30, 8192
  v_mfma_f32_16x16x32_bf16 v[116:119], a[188:191], a[52:55], v[116:119]
  ds_read_b64_tr_b16 a[170:171], v145 offset:33792
  v_mfma_f32_16x16x32_bf16 v[116:119], a[184:187], a[36:39], v[116:119]
  v_mfma_f32_16x16x32_bf16 v[120:123], a[184:187], a[40:43], v[120:123]
  ds_read_b64_tr_b16 a[172:173], v145 offset:40960
  v_mfma_f32_16x16x32_bf16 v[120:123], a[188:191], a[56:59], v[120:123]
  v_mfma_f32_16x16x32_bf16 v[124:127], a[188:191], a[60:63], v[124:127]
  ds_read_b64_tr_b16 a[174:175], v145 offset:41984
  v_mfma_f32_16x16x32_bf16 v[124:127], a[184:187], a[44:47], v[124:127]
  s_waitcnt vmcnt(20) lgkmcnt(4)
  v_xor_b32 v136, s55, v136
  v_xor_b32 v137, s55, v137
  v_xor_b32 v138, s55, v138
  v_xor_b32 v139, s55, v139
  v_or3_b32 v136, v136, v137, v138
  v_or_b32 v136, v136, v139
  v_cmp_ne_u32 vcc, 0, v136
  s_nop 0
  s_cbranch_vccz front_keys
  s_mov_b32 s54, 32768
front_all:
  s_sleep 2
  buffer_load_dwordx4 v[136:139], v140, s[24:27], s58 offen sc1
  s_waitcnt vmcnt(0)
  v_xor_b32 v136, s55, v136
  v_xor_b32 v137, s55, v137
  v_xor_b32 v138, s55, v138
  v_xor_b32 v139, s55, v139
  v_or3_b32 v136, v136, v137, v138
  v_or_b32 v136, v136, v139
  v_cmp_ne_u32 vcc, 0, v136
  s_nop 0
  s_cbranch_vccz front_keys
  s_sub_u32 s54, s54, 1
  s_cmp_lg_u32 s54, 0
  s_cbranch_scc1 front_all
front_keys:
  s_lshl_b32 s35, s3, 11
  s_add_u32 s35, s35, 2621440
  buffer_load_dwordx4 v[128:131], v242, s[24:27], s35 offen sc1
  buffer_load_dwordx4 v[132:135], v242, s[24:27], s35 offen offset:1024 sc1
  v_mfma_f32_16x16x32_bf16 v[0:3], a[160:163], a[64:67], v[0:3]
  ds_read_b64_tr_b16 a[176:177], v146 offset:32768
  s_add_u32 s59, s59, 1
  s_or_b32 s54, s2, s3
  s_min_u32 s54, s54, 1
  v_mfma_f32_16x16x32_bf16 v[0:3], a[164:167], a[80:83], v[0:3]
  buffer_load_dwordx4 a[32:35], v242, s[24:27], s30 offen offset:0 sc1
  s_lshl_b32 s54, s54, 28
  v_mfma_f32_16x16x32_bf16 v[4:7], a[164:167], a[84:87], v[4:7]
  ds_read_b64_tr_b16 a[178:179], v146 offset:33792
  v_lshlrev_b32 v137, 22, v242
  v_mfma_f32_16x16x32_bf16 v[4:7], a[160:163], a[68:71], v[4:7]
  v_or_b32 v137, s54, v137
  v_mov_b32 v136, s59
  v_mfma_f32_16x16x32_bf16 v[8:11], a[160:163], a[72:75], v[8:11]
  ds_read_b64_tr_b16 a[180:181], v146 offset:40960
  s_add_u32 m0, s28, 0
  s_mov_b32 s58, 2830336
  buffer_store_dword v136, v137, s[24:27], s58 offen sc1
  v_mfma_f32_16x16x32_bf16 v[8:11], a[164:167], a[88:91], v[8:11]
  buffer_load_dwordx4 v238, s[20:23], s31 offen offset:0 lds
  v_mfma_f32_16x16x32_bf16 v[12:15], a[164:167], a[92:95], v[12:15]
  ds_read_b64_tr_b16 a[182:183], v146 offset:41984
  v_mfma_f32_16x16x32_bf16 v[12:15], a[160:163], a[76:79], v[12:15]
  s_waitcnt lgkmcnt(4)
  v_mfma_f32_16x16x32_bf16 v[16:19], a[168:171], a[64:67], v[16:19]
  ds_read_b64_tr_b16 a[184:185], v147 offset:32768
  v_mfma_f32_16x16x32_bf16 v[16:19], a[172:175], a[80:83], v[16:19]
  buffer_load_dwordx4 a[36:39], v242, s[24:27], s30 offen offset:1024 sc1
  v_mfma_f32_16x16x32_bf16 v[20:23], a[172:175], a[84:87], v[20:23]
  ds_read_b64_tr_b16 a[186:187], v147 offset:33792
  v_mfma_f32_16x16x32_bf16 v[20:23], a[168:171], a[68:71], v[20:23]
  v_mfma_f32_16x16x32_bf16 v[24:27], a[168:171], a[72:75], v[24:27]
  ds_read_b64_tr_b16 a[188:189], v147 offset:40960
  v_mfma_f32_16x16x32_bf16 v[24:27], a[172:175], a[88:91], v[24:27]
  v_mfma_f32_16x16x32_bf16 v[28:31], a[172:175], a[92:95], v[28:31]
  ds_read_b64_tr_b16 a[190:191], v147 offset:41984
  v_mfma_f32_16x16x32_bf16 v[28:31], a[168:171], a[76:79], v[28:31]
  s_waitcnt lgkmcnt(4)
  v_mfma_f32_16x16x32_bf16 v[32:35], a[176:179], a[64:67], v[32:35]
  ds_read_b64_tr_b16 a[160:161], v148 offset:32768
  v_mfma_f32_16x16x32_bf16 v[32:35], a[180:183], a[80:83], v[32:35]
  buffer_load_dwordx4 a[40:43], v242, s[24:27], s30 offen offset:2048 sc1
  v_mfma_f32_16x16x32_bf16 v[36:39], a[180:183], a[84:87], v[36:39]
  ds_read_b64_tr_b16 a[162:163], v148 offset:33792
  v_mfma_f32_16x16x32_bf16 v[36:39], a[176:179], a[68:71], v[36:39]
  v_mfma_f32_16x16x32_bf16 v[40:43], a[176:179], a[72:75], v[40:43]
  ds_read_b64_tr_b16 a[164:165], v148 offset:40960
  v_mfma_f32_16x16x32_bf16 v[40:43], a[180:183], a[88:91], v[40:43]
  buffer_load_dwordx4 v239, s[20:23], s31 offen offset:1024 lds
  v_mfma_f32_16x16x32_bf16 v[44:47], a[180:183], a[92:95], v[44:47]
  ds_read_b64_tr_b16 a[166:167], v148 offset:41984
  v_mfma_f32_16x16x32_bf16 v[44:47], a[176:179], a[76:79], v[44:47]
  s_waitcnt lgkmcnt(4)
  v_mfma_f32_16x16x32_bf16 v[48:51], a[184:187], a[64:67], v[48:51]
  ds_read_b64_tr_b16 a[168:169], v149 offset:32768
  v_mfma_f32_16x16x32_bf16 v[48:51], a[188:191], a[80:83], v[48:51]
  buffer_load_dwordx4 a[44:47], v242, s[24:27], s30 offen offset:3072 sc1
  v_mfma_f32_16x16x32_bf16 v[52:55], a[188:191], a[84:87], v[52:55]
  ds_read_b64_tr_b16 a[170:171], v149 offset:33792
  v_mfma_f32_16x16x32_bf16 v[52:55], a[184:187], a[68:71], v[52:55]
  v_mfma_f32_16x16x32_bf16 v[56:59], a[184:187], a[72:75], v[56:59]
  ds_read_b64_tr_b16 a[172:173], v149 offset:40960
  v_mfma_f32_16x16x32_bf16 v[56:59], a[188:191], a[88:91], v[56:59]
  v_mfma_f32_16x16x32_bf16 v[60:63], a[188:191], a[92:95], v[60:63]
  ds_read_b64_tr_b16 a[174:175], v149 offset:41984
  v_mfma_f32_16x16x32_bf16 v[60:63], a[184:187], a[76:79], v[60:63]
  s_waitcnt lgkmcnt(4)
  v_mfma_f32_16x16x32_bf16 v[64:67], a[160:163], a[64:67], v[64:67]
  ds_read_b64_tr_b16 a[176:177], v150 offset:32768
  v_mfma_f32_16x16x32_bf16 v[64:67], a[164:167], a[80:83], v[64:67]
  buffer_load_dwordx4 a[48:51], v243, s[24:27], s30 offen offset:0 sc1
  v_mfma_f32_16x16x32_bf16 v[68:71], a[164:167], a[84:87], v[68:71]
  ds_read_b64_tr_b16 a[178:179], v150 offset:33792
  v_mfma_f32_16x16x32_bf16 v[68:71], a[160:163], a[68:71], v[68:71]
  v_mfma_f32_16x16x32_bf16 v[72:75], a[160:163], a[72:75], v[72:75]
  ds_read_b64_tr_b16 a[180:181], v150 offset:40960
  v_mfma_f32_16x16x32_bf16 v[72:75], a[164:167], a[88:91], v[72:75]
  buffer_load_dwordx4 v240, s[20:23], s31 offen offset:2048 lds
  v_mfma_f32_16x16x32_bf16 v[76:79], a[164:167], a[92:95], v[76:79]
  ds_read_b64_tr_b16 a[182:183], v150 offset:41984
  v_mfma_f32_16x16x32_bf16 v[76:79], a[160:163], a[76:79], v[76:79]
  s_waitcnt lgkmcnt(4)
  v_mfma_f32_16x16x32_bf16 v[80:83], a[168:171], a[64:67], v[80:83]
  ds_read_b64_tr_b16 a[184:185], v151 offset:32768
  v_mfma_f32_16x16x32_bf16 v[80:83], a[172:175], a[80:83], v[80:83]
  buffer_load_dwordx4 a[52:55], v243, s[24:27], s30 offen offset:1024 sc1
  v_mfma_f32_16x16x32_bf16 v[84:87], a[172:175], a[84:87], v[84:87]
  ds_read_b64_tr_b16 a[186:187], v151 offset:33792
  v_mfma_f32_16x16x32_bf16 v[84:87], a[168:171], a[68:71], v[84:87]
  v_mfma_f32_16x16x32_bf16 v[88:91], a[168:171], a[72:75], v[88:91]
  ds_read_b64_tr_b16 a[188:189], v151 offset:40960
  v_mfma_f32_16x16x32_bf16 v[88:91], a[172:175], a[88:91], v[88:91]
  s_barrier
  v_mfma_f32_16x16x32_bf16 v[92:95], a[172:175], a[92:95], v[92:95]
  ds_read_b64_tr_b16 a[190:191], v151 offset:41984
  v_mfma_f32_16x16x32_bf16 v[92:95], a[168:171], a[76:79], v[92:95]
  s_waitcnt lgkmcnt(4)
  v_mfma_f32_16x16x32_bf16 v[96:99], a[176:179], a[64:67], v[96:99]
  ds_read_b64_tr_b16 a[160:161], v144 offset:49152
  v_mfma_f32_16x16x32_bf16 v[96:99], a[180:183], a[80:83], v[96:99]
  buffer_load_dwordx4 a[56:59], v243, s[24:27], s30 offen offset:2048 sc1
  v_mfma_f32_16x16x32_bf16 v[100:103], a[180:183], a[84:87], v[100:103]
  ds_read_b64_tr_b16 a[162:163], v144 offset:50176
  v_mfma_f32_16x16x32_bf16 v[100:103], a[176:179], a[68:71], v[100:103]
  v_mfma_f32_16x16x32_bf16 v[104:107], a[176:179], a[72:75], v[104:107]
  ds_read_b64_tr_b16 a[164:165], v144 offset:57344
  v_mfma_f32_16x16x32_bf16 v[104:107], a[180:183], a[88:91], v[104:107]
  buffer_load_dwordx4 v241, s[20:23], s31 offen offset:3072 lds
  s_add_u32 s31, s31, 0x80000
  v_mfma_f32_16x16x32_bf16 v[108:111], a[180:183], a[92:95], v[108:111]
  ds_read_b64_tr_b16 a[166:167], v144 offset:58368
  v_mfma_f32_16x16x32_bf16 v[108:111], a[176:179], a[76:79], v[108:111]
  s_waitcnt lgkmcnt(4)
  v_mfma_f32_16x16x32_bf16 v[112:115], a[184:187], a[64:67], v[112:115]
  ds_read_b64_tr_b16 a[168:169], v145 offset:49152
  v_mfma_f32_16x16x32_bf16 v[112:115], a[188:191], a[80:83], v[112:115]
  buffer_load_dwordx4 a[60:63], v243, s[24:27], s30 offen offset:3072 sc1
  s_add_u32 s30, s30, 8192
  v_mfma_f32_16x16x32_bf16 v[116:119], a[188:191], a[84:87], v[116:119]
  ds_read_b64_tr_b16 a[170:171], v145 offset:50176
  v_mfma_f32_16x16x32_bf16 v[116:119], a[184:187], a[68:71], v[116:119]
  v_mfma_f32_16x16x32_bf16 v[120:123], a[184:187], a[72:75], v[120:123]
  ds_read_b64_tr_b16 a[172:173], v145 offset:57344
  v_mfma_f32_16x16x32_bf16 v[120:123], a[188:191], a[88:91], v[120:123]
  v_mfma_f32_16x16x32_bf16 v[124:127], a[188:191], a[92:95], v[124:127]
  ds_read_b64_tr_b16 a[174:175], v145 offset:58368
  v_mfma_f32_16x16x32_bf16 v[124:127], a[184:187], a[76:79], v[124:127]
  s_waitcnt vmcnt(27) lgkmcnt(4)
  v_mfma_f32_16x16x32_bf16 v[0:3], a[160:163], a[96:99], v[0:3]
  ds_read_b64_tr_b16 a[176:177], v146 offset:49152
  v_mfma_f32_16x16x32_bf16 v[0:3], a[164:167], a[112:115], v[0:3]
  buffer_load_dwordx4 a[64:67], v242, s[24:27], s30 offen offset:0 sc1
  v_mfma_f32_16x16x32_bf16 v[4:7], a[164:167], a[116:119], v[4:7]
  ds_read_b64_tr_b16 a[178:179], v146 offset:50176
  v_mfma_f32_16x16x32_bf16 v[4:7], a[160:163], a[100:103], v[4:7]
  v_mfma_f32_16x16x32_bf16 v[8:11], a[160:163], a[104:107], v[8:11]
  ds_read_b64_tr_b16 a[180:181], v146 offset:57344
  s_add_u32 m0, s28, 65536
  v_mfma_f32_16x16x32_bf16 v[8:11], a[164:167], a[120:123], v[8:11]
  buffer_load_dwordx4 v238, s[20:23], s31 offen offset:0 lds
  v_mfma_f32_16x16x32_bf16 v[12:15], a[164:167], a[124:127], v[12:15]
  ds_read_b64_tr_b16 a[182:183], v146 offset:58368
  v_mfma_f32_16x16x32_bf16 v[12:15], a[160:163], a[108:111], v[12:15]
  s_waitcnt lgkmcnt(4)
  v_mfma_f32_16x16x32_bf16 v[16:19], a[168:171], a[96:99], v[16:19]
  ds_read_b64_tr_b16 a[184:185], v147 offset:49152
  v_mfma_f32_16x16x32_bf16 v[16:19], a[172:175], a[112:115], v[16:19]
  buffer_load_dwordx4 a[68:71], v242, s[24:27], s30 offen offset:1024 sc1
  v_mfma_f32_16x16x32_bf16 v[20:23], a[172:175], a[116:119], v[20:23]
  ds_read_b64_tr_b16 a[186:187], v147 offset:50176
  v_mfma_f32_16x16x32_bf16 v[20:23], a[168:171], a[100:103], v[20:23]
  v_mfma_f32_16x16x32_bf16 v[24:27], a[168:171], a[104:107], v[24:27]
  ds_read_b64_tr_b16 a[188:189], v147 offset:57344
  v_mfma_f32_16x16x32_bf16 v[24:27], a[172:175], a[120:123], v[24:27]
  v_mfma_f32_16x16x32_bf16 v[28:31], a[172:175], a[124:127], v[28:31]
  ds_read_b64_tr_b16 a[190:191], v147 offset:58368
  v_mfma_f32_16x16x32_bf16 v[28:31], a[168:171], a[108:111], v[28:31]
  s_waitcnt lgkmcnt(4)
  v_mfma_f32_16x16x32_bf16 v[32:35], a[176:179], a[96:99], v[32:35]
  ds_read_b64_tr_b16 a[160:161], v148 offset:49152
  v_mfma_f32_16x16x32_bf16 v[32:35], a[180:183], a[112:115], v[32:35]
  buffer_load_dwordx4 a[72:75], v242, s[24:27], s30 offen offset:2048 sc1
  v_mfma_f32_16x16x32_bf16 v[36:39], a[180:183], a[116:119], v[36:39]
  ds_read_b64_tr_b16 a[162:163], v148 offset:50176
  v_mfma_f32_16x16x32_bf16 v[36:39], a[176:179], a[100:103], v[36:39]
  v_mfma_f32_16x16x32_bf16 v[40:43], a[176:179], a[104:107], v[40:43]
  ds_read_b64_tr_b16 a[164:165], v148 offset:57344
  v_mfma_f32_16x16x32_bf16 v[40:43], a[180:183], a[120:123], v[40:43]
  buffer_load_dwordx4 v239, s[20:23], s31 offen offset:1024 lds
  v_mfma_f32_16x16x32_bf16 v[44:47], a[180:183], a[124:127], v[44:47]
  ds_read_b64_tr_b16 a[166:167], v148 offset:58368
  v_mfma_f32_16x16x32_bf16 v[44:47], a[176:179], a[108:111], v[44:47]
  s_waitcnt lgkmcnt(4)
  v_mfma_f32_16x16x32_bf16 v[48:51], a[184:187], a[96:99], v[48:51]
  ds_read_b64_tr_b16 a[168:169], v149 offset:49152
  v_mfma_f32_16x16x32_bf16 v[48:51], a[188:191], a[112:115], v[48:51]
  buffer_load_dwordx4 a[76:79], v242, s[24:27], s30 offen offset:3072 sc1
  v_mfma_f32_16x16x32_bf16 v[52:55], a[188:191], a[116:119], v[52:55]
  ds_read_b64_tr_b16 a[170:171], v149 offset:50176
  v_mfma_f32_16x16x32_bf16 v[52:55], a[184:187], a[100:103], v[52:55]
  v_mfma_f32_16x16x32_bf16 v[56:59], a[184:187], a[104:107], v[56:59]
  ds_read_b64_tr_b16 a[172:173], v149 offset:57344
  v_mfma_f32_16x16x32_bf16 v[56:59], a[188:191], a[120:123], v[56:59]
  v_mfma_f32_16x16x32_bf16 v[60:63], a[188:191], a[124:127], v[60:63]
  ds_read_b64_tr_b16 a[174:175], v149 offset:58368
  v_mfma_f32_16x16x32_bf16 v[60:63], a[184:187], a[108:111], v[60:63]
  s_waitcnt lgkmcnt(4)
  v_mfma_f32_16x16x32_bf16 v[64:67], a[160:163], a[96:99], v[64:67]
  ds_read_b64_tr_b16 a[176:177], v150 offset:49152
  v_mfma_f32_16x16x32_bf16 v[64:67], a[164:167], a[112:115], v[64:67]
  buffer_load_dwordx4 a[80:83], v243, s[24:27], s30 offen offset:0 sc1
  v_mfma_f32_16x16x32_bf16 v[68:71], a[164:167], a[116:119], v[68:71]
  ds_read_b64_tr_b16 a[178:179], v150 offset:50176
  v_mfma_f32_16x16x32_bf16 v[68:71], a[160:163], a[100:103], v[68:71]
  v_mfma_f32_16x16x32_bf16 v[72:75], a[160:163], a[104:107], v[72:75]
  ds_read_b64_tr_b16 a[180:181], v150 offset:57344
  v_mfma_f32_16x16x32_bf16 v[72:75], a[164:167], a[120:123], v[72:75]
  buffer_load_dwordx4 v240, s[20:23], s31 offen offset:2048 lds
  v_mfma_f32_16x16x32_bf16 v[76:79], a[164:167], a[124:127], v[76:79]
  ds_read_b64_tr_b16 a[182:183], v150 offset:58368
  v_mfma_f32_16x16x32_bf16 v[76:79], a[160:163], a[108:111], v[76:79]
  s_waitcnt lgkmcnt(4)
  v_mfma_f32_16x16x32_bf16 v[80:83], a[168:171], a[96:99], v[80:83]
  ds_read_b64_tr_b16 a[184:185], v151 offset:49152
  v_mfma_f32_16x16x32_bf16 v[80:83], a[172:175], a[112:115], v[80:83]
  buffer_load_dwordx4 a[84:87], v243, s[24:27], s30 offen offset:1024 sc1
  v_mfma_f32_16x16x32_bf16 v[84:87], a[172:175], a[116:119], v[84:87]
  ds_read_b64_tr_b16 a[186:187], v151 offset:50176
  v_mfma_f32_16x16x32_bf16 v[84:87], a[168:171], a[100:103], v[84:87]
  s_waitcnt vmcnt(25)
  v_mfma_f32_16x16x32_bf16 v[88:91], a[168:171], a[104:107], v[88:91]
  ds_read_b64_tr_b16 a[188:189], v151 offset:57344
  v_mfma_f32_16x16x32_bf16 v[88:91], a[172:175], a[120:123], v[88:91]
  s_barrier
  v_mfma_f32_16x16x32_bf16 v[92:95], a[172:175], a[124:127], v[92:95]
  ds_read_b64_tr_b16 a[190:191], v151 offset:58368
  v_mfma_f32_16x16x32_bf16 v[92:95], a[168:171], a[108:111], v[92:95]
  s_waitcnt lgkmcnt(4)
  v_mfma_f32_16x16x32_bf16 v[96:99], a[176:179], a[96:99], v[96:99]
  ds_read_b64_tr_b16 a[160:161], v144 offset:16384
  v_mfma_f32_16x16x32_bf16 v[96:99], a[180:183], a[112:115], v[96:99]
  buffer_load_dwordx4 a[88:91], v243, s[24:27], s30 offen offset:2048 sc1
  v_mfma_f32_16x16x32_bf16 v[100:103], a[180:183], a[116:119], v[100:103]
  ds_read_b64_tr_b16 a[162:163], v144 offset:17408
  v_mfma_f32_16x16x32_bf16 v[100:103], a[176:179], a[100:103], v[100:103]
  v_mfma_f32_16x16x32_bf16 v[104:107], a[176:179], a[104:107], v[104:107]
  ds_read_b64_tr_b16 a[164:165], v144 offset:24576
  v_mfma_f32_16x16x32_bf16 v[104:107], a[180:183], a[120:123], v[104:107]
  buffer_load_dwordx4 v241, s[20:23], s31 offen offset:3072 lds
  s_add_u32 s31, s31, 0x80000
  v_mfma_f32_16x16x32_bf16 v[108:111], a[180:183], a[124:127], v[108:111]
  ds_read_b64_tr_b16 a[166:167], v144 offset:25600
  v_mfma_f32_16x16x32_bf16 v[108:111], a[176:179], a[108:111], v[108:111]
  s_waitcnt lgkmcnt(4)
  v_mfma_f32_16x16x32_bf16 v[112:115], a[184:187], a[96:99], v[112:115]
  ds_read_b64_tr_b16 a[168:169], v145 offset:16384
  v_mfma_f32_16x16x32_bf16 v[112:115], a[188:191], a[112:115], v[112:115]
  buffer_load_dwordx4 a[92:95], v243, s[24:27], s30 offen offset:3072 sc1
  s_add_u32 s30, s30, 8192
  v_mfma_f32_16x16x32_bf16 v[116:119], a[188:191], a[116:119], v[116:119]
  ds_read_b64_tr_b16 a[170:171], v145 offset:17408
  v_mfma_f32_16x16x32_bf16 v[116:119], a[184:187], a[100:103], v[116:119]
  v_mfma_f32_16x16x32_bf16 v[120:123], a[184:187], a[104:107], v[120:123]
  ds_read_b64_tr_b16 a[172:173], v145 offset:24576
  v_mfma_f32_16x16x32_bf16 v[120:123], a[188:191], a[120:123], v[120:123]
  v_mfma_f32_16x16x32_bf16 v[124:127], a[188:191], a[124:127], v[124:127]
  ds_read_b64_tr_b16 a[174:175], v145 offset:25600
  v_mfma_f32_16x16x32_bf16 v[124:127], a[184:187], a[108:111], v[124:127]
  s_waitcnt vmcnt(27) lgkmcnt(4)
  v_mfma_f32_16x16x32_bf16 v[0:3], a[160:163], a[0:3], v[0:3]
  ds_read_b64_tr_b16 a[176:177], v146 offset:16384
  s_waitcnt vmcnt(25)
  s_mov_b32 s51, -1
  v_sub_u32 v137, s51, v128
  v_mfma_f32_16x16x32_bf16 v[0:3], a[164:167], a[16:19], v[0:3]
  buffer_load_dwordx4 a[96:99], v242, s[24:27], s30 offen offset:0 sc1
  v_mfma_f32_16x16x32_bf16 v[4:7], a[164:167], a[20:23], v[4:7]
  ds_read_b64_tr_b16 a[178:179], v146 offset:17408
  v_sub_u32 v138, s51, v129
  v_mfma_f32_16x16x32_bf16 v[4:7], a[160:163], a[4:7], v[4:7]
  v_min_u32 v136, v137, v138
  v_sub_u32 v139, s51, v130
  v_mfma_f32_16x16x32_bf16 v[8:11], a[160:163], a[8:11], v[8:11]
  ds_read_b64_tr_b16 a[180:181], v146 offset:24576
  s_add_u32 m0, s28, 81920
  v_sub_u32 v140, s51, v131
  v_mfma_f32_16x16x32_bf16 v[8:11], a[164:167], a[24:27], v[8:11]
  buffer_load_dwordx4 v238, s[20:23], s31 offen offset:0 lds
  v_mfma_f32_16x16x32_bf16 v[12:15], a[164:167], a[28:31], v[12:15]
  ds_read_b64_tr_b16 a[182:183], v146 offset:25600
  v_min3_u32 v136, v136, v139, v140
  v_mfma_f32_16x16x32_bf16 v[12:15], a[160:163], a[12:15], v[12:15]
  s_waitcnt lgkmcnt(4)
  v_sub_u32 v137, s51, v132
  v_sub_u32 v138, s51, v133
  v_mfma_f32_16x16x32_bf16 v[16:19], a[168:171], a[0:3], v[16:19]
  ds_read_b64_tr_b16 a[184:185], v147 offset:16384
  v_min3_u32 v136, v136, v137, v138
  v_mfma_f32_16x16x32_bf16 v[16:19], a[172:175], a[16:19], v[16:19]
  buffer_load_dwordx4 a[100:103], v242, s[24:27], s30 offen offset:1024 sc1
  v_mfma_f32_16x16x32_bf16 v[20:23], a[172:175], a[20:23], v[20:23]
  ds_read_b64_tr_b16 a[186:187], v147 offset:17408
  v_sub_u32 v139, s51, v134
  v_mfma_f32_16x16x32_bf16 v[20:23], a[168:171], a[4:7], v[20:23]
  v_sub_u32 v140, s51, v135
  v_min3_u32 v136, v136, v139, v140
  v_mfma_f32_16x16x32_bf16 v[24:27], a[168:171], a[8:11], v[24:27]
  ds_read_b64_tr_b16 a[188:189], v147 offset:24576
  v_min_u32_dpp v136, v136, v136 row_ror:8 row_mask:0xf bank_mask:0xf
  v_mfma_f32_16x16x32_bf16 v[24:27], a[172:175], a[24:27], v[24:27]
  v_mfma_f32_16x16x32_bf16 v[28:31], a[172:175], a[28:31], v[28:31]
  ds_read_b64_tr_b16 a[190:191], v147 offset:25600
  v_min_u32_dpp v136, v136, v136 row_ror:4 row_mask:0xf bank_mask:0xf
  v_mfma_f32_16x16x32_bf16 v[28:31], a[168:171], a[12:15], v[28:31]
  s_waitcnt lgkmcnt(4)
  v_min_u32_dpp v136, v136, v136 row_ror:2 row_mask:0xf bank_mask:0xf
  v_mfma_f32_16x16x32_bf16 v[32:35], a[176:179], a[0:3], v[32:35]
  ds_read_b64_tr_b16 a[160:161], v148 offset:16384
  v_min_u32_dpp v136, v136, v136 row_ror:1 row_mask:0xf bank_mask:0xf
  v_mfma_f32_16x16x32_bf16 v[32:35], a[180:183], a[16:19], v[32:35]
  buffer_load_dwordx4 a[104:107], v242, s[24:27], s30 offen offset:2048 sc1
  v_mfma_f32_16x16x32_bf16 v[36:39], a[180:183], a[20:23], v[36:39]
  ds_read_b64_tr_b16 a[162:163], v148 offset:17408
  v_readlane_b32 s98, v136, 0
  v_mfma_f32_16x16x32_bf16 v[36:39], a[176:179], a[4:7], v[36:39]
  v_readlane_b32 s99, v136, 16
  v_readlane_b32 s100, v136, 32
  v_mfma_f32_16x16x32_bf16 v[40:43], a[176:179], a[8:11], v[40:43]
  ds_read_b64_tr_b16 a[164:165], v148 offset:24576
  v_readlane_b32 s101, v136, 48
  v_mfma_f32_16x16x32_bf16 v[40:43], a[180:183], a[24:27], v[40:43]
  buffer_load_dwordx4 v239, s[20:23], s31 offen offset:1024 lds
  s_min_u32 s98, s98, s99
  s_min_u32 s100, s100, s101
  s_min_u32 s98, s98, s100
  v_mfma_f32_16x16x32_bf16 v[44:47], a[180:183], a[28:31], v[44:47]
  ds_read_b64_tr_b16 a[166:167], v148 offset:25600
  s_sub_u32 s52, s51, s98
  s_sub_u32 s51, s52, 1
  v_sub_u32 v137, s51, v128
  v_mfma_f32_16x16x32_bf16 v[44:47], a[176:179], a[12:15], v[44:47]
  s_waitcnt lgkmcnt(4)
  v_sub_u32 v138, s51, v129
  v_min_u32 v136, v137, v138
  v_mfma_f32_16x16x32_bf16 v[48:51], a[184:187], a[0:3], v[48:51]
  ds_read_b64_tr_b16 a[168:169], v149 offset:16384
  v_sub_u32 v139, s51, v130
  v_mfma_f32_16x16x32_bf16 v[48:51], a[188:191], a[16:19], v[48:51]
  buffer_load_dwordx4 a[108:111], v242, s[24:27], s30 offen offset:3072 sc1
  v_mfma_f32_16x16x32_bf16 v[52:55], a[188:191], a[20:23], v[52:55]
  ds_read_b64_tr_b16 a[170:171], v149 offset:17408
  v_sub_u32 v140, s51, v131
  v_mfma_f32_16x16x32_bf16 v[52:55], a[184:187], a[4:7], v[52:55]
  v_min3_u32 v136, v136, v139, v140
  v_sub_u32 v137, s51, v132
  v_mfma_f32_16x16x32_bf16 v[56:59], a[184:187], a[8:11], v[56:59]
  ds_read_b64_tr_b16 a[172:173], v149 offset:24576
  v_sub_u32 v138, s51, v133
  v_mfma_f32_16x16x32_bf16 v[56:59], a[188:191], a[24:27], v[56:59]
  v_min3_u32 v136, v136, v137, v138
  v_sub_u32 v139, s51, v134
  v_mfma_f32_16x16x32_bf16 v[60:63], a[188:191], a[28:31], v[60:63]
  ds_read_b64_tr_b16 a[174:175], v149 offset:25600
  v_sub_u32 v140, s51, v135
  v_mfma_f32_16x16x32_bf16 v[60:63], a[184:187], a[12:15], v[60:63]
  s_waitcnt lgkmcnt(4)
  v_min3_u32 v136, v136, v139, v140
  v_mfma_f32_16x16x32_bf16 v[64:67], a[160:163], a[0:3], v[64:67]
  ds_read_b64_tr_b16 a[176:177], v150 offset:16384
  v_min_u32_dpp v136, v136, v136 row_ror:8 row_mask:0xf bank_mask:0xf
  v_mfma_f32_16x16x32_bf16 v[64:67], a[164:167], a[16:19], v[64:67]
  buffer_load_dwordx4 a[112:115], v243, s[24:27], s30 offen offset:0 sc1
  v_mfma_f32_16x16x32_bf16 v[68:71], a[164:167], a[20:23], v[68:71]
  ds_read_b64_tr_b16 a[178:179], v150 offset:17408
  v_min_u32_dpp v136, v136, v136 row_ror:4 row_mask:0xf bank_mask:0xf
  v_mfma_f32_16x16x32_bf16 v[68:71], a[160:163], a[4:7], v[68:71]
  v_mfma_f32_16x16x32_bf16 v[72:75], a[160:163], a[8:11], v[72:75]
  ds_read_b64_tr_b16 a[180:181], v150 offset:24576
  v_min_u32_dpp v136, v136, v136 row_ror:2 row_mask:0xf bank_mask:0xf
  v_mfma_f32_16x16x32_bf16 v[72:75], a[164:167], a[24:27], v[72:75]
  buffer_load_dwordx4 v240, s[20:23], s31 offen offset:2048 lds
  v_mfma_f32_16x16x32_bf16 v[76:79], a[164:167], a[28:31], v[76:79]
  ds_read_b64_tr_b16 a[182:183], v150 offset:25600
  v_min_u32_dpp v136, v136, v136 row_ror:1 row_mask:0xf bank_mask:0xf
  v_mfma_f32_16x16x32_bf16 v[76:79], a[160:163], a[12:15], v[76:79]
  s_waitcnt lgkmcnt(4)
  v_readlane_b32 s98, v136, 0
  v_readlane_b32 s99, v136, 16
  v_mfma_f32_16x16x32_bf16 v[80:83], a[168:171], a[0:3], v[80:83]
  ds_read_b64_tr_b16 a[184:185], v151 offset:16384
  v_readlane_b32 s100, v136, 32
  v_mfma_f32_16x16x32_bf16 v[80:83], a[172:175], a[16:19], v[80:83]
  buffer_load_dwordx4 a[116:119], v243, s[24:27], s30 offen offset:1024 sc1
  v_mfma_f32_16x16x32_bf16 v[84:87], a[172:175], a[20:23], v[84:87]
  ds_read_b64_tr_b16 a[186:187], v151 offset:17408
  v_readlane_b32 s101, v136, 48
  v_mfma_f32_16x16x32_bf16 v[84:87], a[168:171], a[4:7], v[84:87]
  s_waitcnt vmcnt(22)
  s_min_u32 s98, s98, s99
  s_min_u32 s100, s100, s101
  v_mfma_f32_16x16x32_bf16 v[88:91], a[168:171], a[8:11], v[88:91]
  ds_read_b64_tr_b16 a[188:189], v151 offset:24576
  s_min_u32 s98, s98, s100
  s_sub_u32 s53, s51, s98
  s_sub_u32 s51, s53, 1
  v_sub_u32 v137, s51, v128
  v_mfma_f32_16x16x32_bf16 v[88:91], a[172:175], a[24:27], v[88:91]
  s_barrier
  v_sub_u32 v138, s51, v129
  v_min_u32 v136, v137, v138
  v_mfma_f32_16x16x32_bf16 v[92:95], a[172:175], a[28:31], v[92:95]
  ds_read_b64_tr_b16 a[190:191], v151 offset:25600
  v_sub_u32 v139, s51, v130
  v_mfma_f32_16x16x32_bf16 v[92:95], a[168:171], a[12:15], v[92:95]
  s_waitcnt lgkmcnt(4)
  v_sub_u32 v140, s51, v131
  v_min3_u32 v136, v136, v139, v140
  v_mfma_f32_16x16x32_bf16 v[96:99], a[176:179], a[0:3], v[96:99]
  ds_read_b64_tr_b16 a[160:161], v144 offset:0
  v_sub_u32 v137, s51, v132
  v_mfma_f32_16x16x32_bf16 v[96:99], a[180:183], a[16:19], v[96:99]
  buffer_load_dwordx4 a[120:123], v243, s[24:27], s30 offen offset:2048 sc1
  v_mfma_f32_16x16x32_bf16 v[100:103], a[180:183], a[20:23], v[100:103]
  ds_read_b64_tr_b16 a[162:163], v144 offset:1024
  v_sub_u32 v138, s51, v133
  v_mfma_f32_16x16x32_bf16 v[100:103], a[176:179], a[4:7], v[100:103]
  v_min3_u32 v136, v136, v137, v138
  v_sub_u32 v139, s51, v134
  v_mfma_f32_16x16x32_bf16 v[104:107], a[176:179], a[8:11], v[104:107]
  ds_read_b64_tr_b16 a[164:165], v144 offset:8192
  v_sub_u32 v140, s51, v135
  v_mfma_f32_16x16x32_bf16 v[104:107], a[180:183], a[24:27], v[104:107]
  buffer_load_dwordx4 v241, s[20:23], s31 offen offset:3072 lds
  s_add_u32 s31, s31, 0x80000
  v_mfma_f32_16x16x32_bf16 v[108:111], a[180:183], a[28:31], v[108:111]
  ds_read_b64_tr_b16 a[166:167], v144 offset:9216
  v_min3_u32 v136, v136, v139, v140
  v_mfma_f32_16x16x32_bf16 v[108:111], a[176:179], a[12:15], v[108:111]
  s_waitcnt lgkmcnt(4)
  v_min_u32_dpp v136, v136, v136 row_ror:8 row_mask:0xf bank_mask:0xf
  v_mfma_f32_16x16x32_bf16 v[112:115], a[184:187], a[0:3], v[112:115]
  ds_read_b64_tr_b16 a[168:169], v145 offset:0
  v_min_u32_dpp v136, v136, v136 row_ror:4 row_mask:0xf bank_mask:0xf
  v_mfma_f32_16x16x32_bf16 v[112:115], a[188:191], a[16:19], v[112:115]
  buffer_load_dwordx4 a[124:127], v243, s[24:27], s30 offen offset:3072 sc1
  s_add_u32 s30, s30, 8192
  v_mfma_f32_16x16x32_bf16 v[116:119], a[188:191], a[20:23], v[116:119]
  ds_read_b64_tr_b16 a[170:171], v145 offset:1024
  v_min_u32_dpp v136, v136, v136 row_ror:2 row_mask:0xf bank_mask:0xf
  v_mfma_f32_16x16x32_bf16 v[116:119], a[184:187], a[4:7], v[116:119]
  v_mfma_f32_16x16x32_bf16 v[120:123], a[184:187], a[8:11], v[120:123]
  ds_read_b64_tr_b16 a[172:173], v145 offset:8192
  v_min_u32_dpp v136, v136, v136 row_ror:1 row_mask:0xf bank_mask:0xf
  v_mfma_f32_16x16x32_bf16 v[120:123], a[188:191], a[24:27], v[120:123]
  v_readlane_b32 s98, v136, 0
  v_readlane_b32 s99, v136, 16
  v_mfma_f32_16x16x32_bf16 v[124:127], a[188:191], a[28:31], v[124:127]
  ds_read_b64_tr_b16 a[174:175], v145 offset:9216
  v_readlane_b32 s100, v136, 32
  v_mfma_f32_16x16x32_bf16 v[124:127], a[184:187], a[12:15], v[124:127]
  s_waitcnt vmcnt(24) lgkmcnt(4)
  v_readlane_b32 s101, v136, 48
  v_mfma_f32_16x16x32_bf16 v[0:3], a[160:163], a[32:35], v[0:3]
  ds_read_b64_tr_b16 a[176:177], v146 offset:0
  s_min_u32 s98, s98, s99
  s_min_u32 s100, s100, s101
  s_min_u32 s98, s98, s100
  v_mfma_f32_16x16x32_bf16 v[0:3], a[164:167], a[48:51], v[0:3]
  buffer_load_dwordx4 a[0:3], v242, s[24:27], s30 offen offset:0 sc1
  s_sub_u32 s54, s51, s98
  s_sub_u32 s51, s54, 1
  v_mfma_f32_16x16x32_bf16 v[4:7], a[164:167], a[52:55], v[4:7]
  ds_read_b64_tr_b16 a[178:179], v146 offset:1024
  v_sub_u32 v137, s51, v128
  v_mfma_f32_16x16x32_bf16 v[4:7], a[160:163], a[36:39], v[4:7]
  v_sub_u32 v138, s51, v129
  v_min_u32 v136, v137, v138
  v_mfma_f32_16x16x32_bf16 v[8:11], a[160:163], a[40:43], v[8:11]
  ds_read_b64_tr_b16 a[180:181], v146 offset:8192
  s_add_u32 m0, s28, 98304
  v_sub_u32 v139, s51, v130
  v_mfma_f32_16x16x32_bf16 v[8:11], a[164:167], a[56:59], v[8:11]
  buffer_load_dwordx4 v238, s[20:23], s31 offen offset:0 lds
  v_mfma_f32_16x16x32_bf16 v[12:15], a[164:167], a[60:63], v[12:15]
  ds_read_b64_tr_b16 a[182:183], v146 offset:9216
  v_sub_u32 v140, s51, v131
  v_mfma_f32_16x16x32_bf16 v[12:15], a[160:163], a[44:47], v[12:15]
  s_waitcnt lgkmcnt(4)
  v_min3_u32 v136, v136, v139, v140
  v_sub_u32 v137, s51, v132
  v_mfma_f32_16x16x32_bf16 v[16:19], a[168:171], a[32:35], v[16:19]
  ds_read_b64_tr_b16 a[184:185], v147 offset:0
  v_sub_u32 v138, s51, v133
  v_mfma_f32_16x16x32_bf16 v[16:19], a[172:175], a[48:51], v[16:19]
  buffer_load_dwordx4 a[4:7], v242, s[24:27], s30 offen offset:1024 sc1
  v_mfma_f32_16x16x32_bf16 v[20:23], a[172:175], a[52:55], v[20:23]
  ds_read_b64_tr_b16 a[186:187], v147 offset:1024
  v_min3_u32 v136, v136, v137, v138
  v_mfma_f32_16x16x32_bf16 v[20:23], a[168:171], a[36:39], v[20:23]
  v_sub_u32 v139, s51, v134
  v_sub_u32 v140, s51, v135
  v_mfma_f32_16x16x32_bf16 v[24:27], a[168:171], a[40:43], v[24:27]
  ds_read_b64_tr_b16 a[188:189], v147 offset:8192
  v_min3_u32 v136, v136, v139, v140
  v_mfma_f32_16x16x32_bf16 v[24:27], a[172:175], a[56:59], v[24:27]
  v_mfma_f32_16x16x32_bf16 v[28:31], a[172:175], a[60:63], v[28:31]
  ds_read_b64_tr_b16 a[190:191], v147 offset:9216
  v_min_u32_dpp v136, v136, v136 row_ror:8 row_mask:0xf bank_mask:0xf
  v_mfma_f32_16x16x32_bf16 v[28:31], a[168:171], a[44:47], v[28:31]
  s_waitcnt lgkmcnt(4)
  v_min_u32_dpp v136, v136, v136 row_ror:4 row_mask:0xf bank_mask:0xf
  v_mfma_f32_16x16x32_bf16 v[32:35], a[176:179], a[32:35], v[32:35]
  ds_read_b64_tr_b16 a[160:161], v148 offset:0
  v_min_u32_dpp v136, v136, v136 row_ror:2 row_mask:0xf bank_mask:0xf
  v_mfma_f32_16x16x32_bf16 v[32:35], a[180:183], a[48:51], v[32:35]
  buffer_load_dwordx4 a[8:11], v242, s[24:27], s30 offen offset:2048 sc1
  v_mfma_f32_16x16x32_bf16 v[36:39], a[180:183], a[52:55], v[36:39]
  ds_read_b64_tr_b16 a[162:163], v148 offset:1024
  v_min_u32_dpp v136, v136, v136 row_ror:1 row_mask:0xf bank_mask:0xf
  v_mfma_f32_16x16x32_bf16 v[36:39], a[176:179], a[36:39], v[36:39]
  v_readlane_b32 s98, v136, 0
  v_readlane_b32 s99, v136, 16
  v_mfma_f32_16x16x32_bf16 v[40:43], a[176:179], a[40:43], v[40:43]
  ds_read_b64_tr_b16 a[164:165], v148 offset:8192
  v_readlane_b32 s100, v136, 32
  v_mfma_f32_16x16x32_bf16 v[40:43], a[180:183], a[56:59], v[40:43]
  buffer_load_dwordx4 v239, s[20:23], s31 offen offset:1024 lds
  v_mfma_f32_16x16x32_bf16 v[44:47], a[180:183], a[60:63], v[44:47]
  ds_read_b64_tr_b16 a[166:167], v148 offset:9216
  v_readlane_b32 s101, v136, 48
  v_mfma_f32_16x16x32_bf16 v[44:47], a[176:179], a[44:47], v[44:47]
  s_waitcnt lgkmcnt(4)
  s_min_u32 s98, s98, s99
  s_min_u32 s100, s100, s101
  v_mfma_f32_16x16x32_bf16 v[48:51], a[184:187], a[32:35], v[48:51]
  ds_read_b64_tr_b16 a[168:169], v149 offset:0
  s_min_u32 s98, s98, s100
  s_sub_u32 s55, s51, s98
  s_sub_u32 s51, s55, 1
  v_sub_u32 v137, s51, v128
  v_mfma_f32_16x16x32_bf16 v[48:51], a[188:191], a[48:51], v[48:51]
  buffer_load_dwordx4 a[12:15], v242, s[24:27], s30 offen offset:3072 sc1
  v_mfma_f32_16x16x32_bf16 v[52:55], a[188:191], a[52:55], v[52:55]
  ds_read_b64_tr_b16 a[170:171], v149 offset:1024
  v_sub_u32 v138, s51, v129
  v_mfma_f32_16x16x32_bf16 v[52:55], a[184:187], a[36:39], v[52:55]
  v_min_u32 v136, v137, v138
  v_sub_u32 v139, s51, v130
  v_mfma_f32_16x16x32_bf16 v[56:59], a[184:187], a[40:43], v[56:59]
  ds_read_b64_tr_b16 a[172:173], v149 offset:8192
  v_sub_u32 v140, s51, v131
  v_mfma_f32_16x16x32_bf16 v[56:59], a[188:191], a[56:59], v[56:59]
  v_min3_u32 v136, v136, v139, v140
  v_sub_u32 v137, s51, v132
  v_mfma_f32_16x16x32_bf16 v[60:63], a[188:191], a[60:63], v[60:63]
  ds_read_b64_tr_b16 a[174:175], v149 offset:9216
  v_sub_u32 v138, s51, v133
  v_mfma_f32_16x16x32_bf16 v[60:63], a[184:187], a[44:47], v[60:63]
  s_waitcnt lgkmcnt(4)
  v_min3_u32 v136, v136, v137, v138
  v_sub_u32 v139, s51, v134
  v_mfma_f32_16x16x32_bf16 v[64:67], a[160:163], a[32:35], v[64:67]
  ds_read_b64_tr_b16 a[176:177], v150 offset:0
  v_sub_u32 v140, s51, v135
  v_mfma_f32_16x16x32_bf16 v[64:67], a[164:167], a[48:51], v[64:67]
  buffer_load_dwordx4 a[16:19], v243, s[24:27], s30 offen offset:0 sc1
  v_mfma_f32_16x16x32_bf16 v[68:71], a[164:167], a[52:55], v[68:71]
  ds_read_b64_tr_b16 a[178:179], v150 offset:1024
  v_min3_u32 v136, v136, v139, v140
  v_mfma_f32_16x16x32_bf16 v[68:71], a[160:163], a[36:39], v[68:71]
  v_mfma_f32_16x16x32_bf16 v[72:75], a[160:163], a[40:43], v[72:75]
  ds_read_b64_tr_b16 a[180:181], v150 offset:8192
  v_min_u32_dpp v136, v136, v136 row_ror:8 row_mask:0xf bank_mask:0xf
  v_mfma_f32_16x16x32_bf16 v[72:75], a[164:167], a[56:59], v[72:75]
  buffer_load_dwordx4 v240, s[20:23], s31 offen offset:2048 lds
  v_mfma_f32_16x16x32_bf16 v[76:79], a[164:167], a[60:63], v[76:79]
  ds_read_b64_tr_b16 a[182:183], v150 offset:9216
  v_min_u32_dpp v136, v136, v136 row_ror:4 row_mask:0xf bank_mask:0xf
  v_mfma_f32_16x16x32_bf16 v[76:79], a[160:163], a[44:47], v[76:79]
  s_waitcnt lgkmcnt(4)
  v_min_u32_dpp v136, v136, v136 row_ror:2 row_mask:0xf bank_mask:0xf
  v_mfma_f32_16x16x32_bf16 v[80:83], a[168:171], a[32:35], v[80:83]
  ds_read_b64_tr_b16 a[184:185], v151 offset:0
  v_min_u32_dpp v136, v136, v136 row_ror:1 row_mask:0xf bank_mask:0xf
  v_mfma_f32_16x16x32_bf16 v[80:83], a[172:175], a[48:51], v[80:83]
  buffer_load_dwordx4 a[20:23], v243, s[24:27], s30 offen offset:1024 sc1
  v_mfma_f32_16x16x32_bf16 v[84:87], a[172:175], a[52:55], v[84:87]
  ds_read_b64_tr_b16 a[186:187], v151 offset:1024
  v_readlane_b32 s98, v136, 0
  v_mfma_f32_16x16x32_bf16 v[84:87], a[168:171], a[36:39], v[84:87]
  s_waitcnt vmcnt(22)
  v_readlane_b32 s99, v136, 16
  v_readlane_b32 s100, v136, 32
  v_mfma_f32_16x16x32_bf16 v[88:91], a[168:171], a[40:43], v[88:91]
  ds_read_b64_tr_b16 a[188:189], v151 offset:8192
  v_readlane_b32 s101, v136, 48
  v_mfma_f32_16x16x32_bf16 v[88:91], a[172:175], a[56:59], v[88:91]
  s_barrier
  s_min_u32 s98, s98, s99
  s_min_u32 s100, s100, s101
  v_mfma_f32_16x16x32_bf16 v[92:95], a[172:175], a[60:63], v[92:95]
  ds_read_b64_tr_b16 a[190:191], v151 offset:9216
  s_min_u32 s98, s98, s100
  s_sub_u32 s56, s51, s98
  s_sub_u32 s51, s56, 1
  v_sub_u32 v137, s51, v128
  v_mfma_f32_16x16x32_bf16 v[92:95], a[168:171], a[44:47], v[92:95]
  s_waitcnt lgkmcnt(4)
  v_sub_u32 v138, s51, v129
  v_min_u32 v136, v137, v138
  v_mfma_f32_16x16x32_bf16 v[96:99], a[176:179], a[32:35], v[96:99]
  ds_read_b64_tr_b16 a[160:161], v224 offset:0
  v_sub_u32 v139, s51, v130
  v_mfma_f32_16x16x32_bf16 v[96:99], a[180:183], a[48:51], v[96:99]
  buffer_load_dwordx4 a[24:27], v243, s[24:27], s30 offen offset:2048 sc1
  v_mfma_f32_16x16x32_bf16 v[100:103], a[180:183], a[52:55], v[100:103]
  ds_read_b64_tr_b16 a[162:163], v224 offset:1024
  v_sub_u32 v140, s51, v131
  v_mfma_f32_16x16x32_bf16 v[100:103], a[176:179], a[36:39], v[100:103]
  v_min3_u32 v136, v136, v139, v140
  v_sub_u32 v137, s51, v132
  v_mfma_f32_16x16x32_bf16 v[104:107], a[176:179], a[40:43], v[104:107]
  ds_read_b64_tr_b16 a[164:165], v224 offset:8192
  v_sub_u32 v138, s51, v133
  v_mfma_f32_16x16x32_bf16 v[104:107], a[180:183], a[56:59], v[104:107]
  buffer_load_dwordx4 v241, s[20:23], s31 offen offset:3072 lds
  s_add_u32 s31, s31, 0x80000
  v_mfma_f32_16x16x32_bf16 v[108:111], a[180:183], a[60:63], v[108:111]
  ds_read_b64_tr_b16 a[166:167], v224 offset:9216
  v_min3_u32 v136, v136, v137, v138
  v_mfma_f32_16x16x32_bf16 v[108:111], a[176:179], a[44:47], v[108:111]
  s_waitcnt lgkmcnt(4)
  v_sub_u32 v139, s51, v134
  v_sub_u32 v140, s51, v135
  v_mfma_f32_16x16x32_bf16 v[112:115], a[184:187], a[32:35], v[112:115]
  ds_read_b64_tr_b16 a[168:169], v225 offset:0
  v_min3_u32 v136, v136, v139, v140
  v_mfma_f32_16x16x32_bf16 v[112:115], a[188:191], a[48:51], v[112:115]
  buffer_load_dwordx4 a[28:31], v243, s[24:27], s30 offen offset:3072 sc1
  s_add_u32 s30, s30, 8192
  v_mfma_f32_16x16x32_bf16 v[116:119], a[188:191], a[52:55], v[116:119]
  ds_read_b64_tr_b16 a[170:171], v225 offset:1024
  v_min_u32_dpp v136, v136, v136 row_ror:8 row_mask:0xf bank_mask:0xf
  v_mfma_f32_16x16x32_bf16 v[116:119], a[184:187], a[36:39], v[116:119]
  v_mfma_f32_16x16x32_bf16 v[120:123], a[184:187], a[40:43], v[120:123]
  ds_read_b64_tr_b16 a[172:173], v225 offset:8192
  v_min_u32_dpp v136, v136, v136 row_ror:4 row_mask:0xf bank_mask:0xf
  v_mfma_f32_16x16x32_bf16 v[120:123], a[188:191], a[56:59], v[120:123]
  v_mfma_f32_16x16x32_bf16 v[124:127], a[188:191], a[60:63], v[124:127]
  ds_read_b64_tr_b16 a[174:175], v225 offset:9216
  v_min_u32_dpp v136, v136, v136 row_ror:2 row_mask:0xf bank_mask:0xf
  v_mfma_f32_16x16x32_bf16 v[124:127], a[184:187], a[44:47], v[124:127]
  s_waitcnt vmcnt(24) lgkmcnt(4)
  v_min_u32_dpp v136, v136, v136 row_ror:1 row_mask:0xf bank_mask:0xf
  v_mfma_f32_16x16x32_bf16 v[0:3], a[160:163], a[64:67], v[0:3]
  ds_read_b64_tr_b16 a[176:177], v226 offset:0
  v_readlane_b32 s98, v136, 0
  v_mfma_f32_16x16x32_bf16 v[0:3], a[164:167], a[80:83], v[0:3]
  buffer_load_dwordx4 a[32:35], v242, s[24:27], s30 offen offset:0 sc1
  v_mfma_f32_16x16x32_bf16 v[4:7], a[164:167], a[84:87], v[4:7]
  ds_read_b64_tr_b16 a[178:179], v226 offset:1024
  v_readlane_b32 s99, v136, 16
  v_mfma_f32_16x16x32_bf16 v[4:7], a[160:163], a[68:71], v[4:7]
  v_readlane_b32 s100, v136, 32
  v_readlane_b32 s101, v136, 48
  v_mfma_f32_16x16x32_bf16 v[8:11], a[160:163], a[72:75], v[8:11]
  ds_read_b64_tr_b16 a[180:181], v226 offset:8192
  s_add_u32 m0, s28, 114688
  s_min_u32 s98, s98, s99
  s_min_u32 s100, s100, s101
  v_mfma_f32_16x16x32_bf16 v[8:11], a[164:167], a[88:91], v[8:11]
  buffer_load_dwordx4 v238, s[20:23], s31 offen offset:0 lds
  s_min_u32 s98, s98, s100
  s_sub_u32 s57, s51, s98
  s_sub_u32 s51, s57, 1
  v_mfma_f32_16x16x32_bf16 v[12:15], a[164:167], a[92:95], v[12:15]
  ds_read_b64_tr_b16 a[182:183], v226 offset:9216
  v_sub_u32 v137, s51, v128
  v_mfma_f32_16x16x32_bf16 v[12:15], a[160:163], a[76:79], v[12:15]
  s_waitcnt lgkmcnt(4)
  v_sub_u32 v138, s51, v129
  v_min_u32 v136, v137, v138
  v_mfma_f32_16x16x32_bf16 v[16:19], a[168:171], a[64:67], v[16:19]
  ds_read_b64_tr_b16 a[184:185], v227 offset:0
  v_sub_u32 v139, s51, v130
  v_mfma_f32_16x16x32_bf16 v[16:19], a[172:175], a[80:83], v[16:19]
  buffer_load_dwordx4 a[36:39], v242, s[24:27], s30 offen offset:1024 sc1
  v_mfma_f32_16x16x32_bf16 v[20:23], a[172:175], a[84:87], v[20:23]
  ds_read_b64_tr_b16 a[186:187], v227 offset:1024
  v_sub_u32 v140, s51, v131
  v_mfma_f32_16x16x32_bf16 v[20:23], a[168:171], a[68:71], v[20:23]
  v_min3_u32 v136, v136, v139, v140
  v_sub_u32 v137, s51, v132
  v_mfma_f32_16x16x32_bf16 v[24:27], a[168:171], a[72:75], v[24:27]
  ds_read_b64_tr_b16 a[188:189], v227 offset:8192
  v_sub_u32 v138, s51, v133
  v_mfma_f32_16x16x32_bf16 v[24:27], a[172:175], a[88:91], v[24:27]
  v_min3_u32 v136, v136, v137, v138
  v_sub_u32 v139, s51, v134
  v_mfma_f32_16x16x32_bf16 v[28:31], a[172:175], a[92:95], v[28:31]
  ds_read_b64_tr_b16 a[190:191], v227 offset:9216
  v_sub_u32 v140, s51, v135
  v_mfma_f32_16x16x32_bf16 v[28:31], a[168:171], a[76:79], v[28:31]
  s_waitcnt lgkmcnt(4)
  v_min3_u32 v136, v136, v139, v140
  v_mfma_f32_16x16x32_bf16 v[32:35], a[176:179], a[64:67], v[32:35]
  ds_read_b64_tr_b16 a[160:161], v228 offset:0
  v_min_u32_dpp v136, v136, v136 row_ror:8 row_mask:0xf bank_mask:0xf
  v_mfma_f32_16x16x32_bf16 v[32:35], a[180:183], a[80:83], v[32:35]
  buffer_load_dwordx4 a[40:43], v242, s[24:27], s30 offen offset:2048 sc1
  v_mfma_f32_16x16x32_bf16 v[36:39], a[180:183], a[84:87], v[36:39]
  ds_read_b64_tr_b16 a[162:163], v228 offset:1024
  v_min_u32_dpp v136, v136, v136 row_ror:4 row_mask:0xf bank_mask:0xf
  v_mfma_f32_16x16x32_bf16 v[36:39], a[176:179], a[68:71], v[36:39]
  v_mfma_f32_16x16x32_bf16 v[40:43], a[176:179], a[72:75], v[40:43]
  ds_read_b64_tr_b16 a[164:165], v228 offset:8192
  v_min_u32_dpp v136, v136, v136 row_ror:2 row_mask:0xf bank_mask:0xf
  v_mfma_f32_16x16x32_bf16 v[40:43], a[180:183], a[88:91], v[40:43]
  buffer_load_dwordx4 v239, s[20:23], s31 offen offset:1024 lds
  v_mfma_f32_16x16x32_bf16 v[44:47], a[180:183], a[92:95], v[44:47]
  ds_read_b64_tr_b16 a[166:167], v228 offset:9216
  v_min_u32_dpp v136, v136, v136 row_ror:1 row_mask:0xf bank_mask:0xf
  v_mfma_f32_16x16x32_bf16 v[44:47], a[176:179], a[76:79], v[44:47]
  s_waitcnt lgkmcnt(4)
  v_readlane_b32 s98, v136, 0
  v_readlane_b32 s99, v136, 16
  v_mfma_f32_16x16x32_bf16 v[48:51], a[184:187], a[64:67], v[48:51]
  ds_read_b64_tr_b16 a[168:169], v229 offset:0
  v_readlane_b32 s100, v136, 32
  v_mfma_f32_16x16x32_bf16 v[48:51], a[188:191], a[80:83], v[48:51]
  buffer_load_dwordx4 a[44:47], v242, s[24:27], s30 offen offset:3072 sc1
  v_mfma_f32_16x16x32_bf16 v[52:55], a[188:191], a[84:87], v[52:55]
  ds_read_b64_tr_b16 a[170:171], v229 offset:1024
  v_readlane_b32 s101, v136, 48
  v_mfma_f32_16x16x32_bf16 v[52:55], a[184:187], a[68:71], v[52:55]
  s_min_u32 s98, s98, s99
  s_min_u32 s100, s100, s101
  s_min_u32 s98, s98, s100
  v_mfma_f32_16x16x32_bf16 v[56:59], a[184:187], a[72:75], v[56:59]
  ds_read_b64_tr_b16 a[172:173], v229 offset:8192
  s_sub_u32 s58, s51, s98
  s_sub_u32 s51, s58, 1
  v_sub_u32 v137, s51, v128
  v_mfma_f32_16x16x32_bf16 v[56:59], a[188:191], a[88:91], v[56:59]
  v_sub_u32 v138, s51, v129
  v_min_u32 v136, v137, v138
  v_mfma_f32_16x16x32_bf16 v[60:63], a[188:191], a[92:95], v[60:63]
  ds_read_b64_tr_b16 a[174:175], v229 offset:9216
  v_sub_u32 v139, s51, v130
  v_mfma_f32_16x16x32_bf16 v[60:63], a[184:187], a[76:79], v[60:63]
  s_waitcnt lgkmcnt(4)
  v_sub_u32 v140, s51, v131
  v_min3_u32 v136, v136, v139, v140
  v_mfma_f32_16x16x32_bf16 v[64:67], a[160:163], a[64:67], v[64:67]
  ds_read_b64_tr_b16 a[176:177], v230 offset:0
  v_sub_u32 v137, s51, v132
  v_mfma_f32_16x16x32_bf16 v[64:67], a[164:167], a[80:83], v[64:67]
  buffer_load_dwordx4 a[48:51], v243, s[24:27], s30 offen offset:0 sc1
  v_mfma_f32_16x16x32_bf16 v[68:71], a[164:167], a[84:87], v[68:71]
  ds_read_b64_tr_b16 a[178:179], v230 offset:1024
  v_sub_u32 v138, s51, v133
  v_mfma_f32_16x16x32_bf16 v[68:71], a[160:163], a[68:71], v[68:71]
  v_min3_u32 v136, v136, v137, v138
  v_sub_u32 v139, s51, v134
  v_mfma_f32_16x16x32_bf16 v[72:75], a[160:163], a[72:75], v[72:75]
  ds_read_b64_tr_b16 a[180:181], v230 offset:8192
  v_sub_u32 v140, s51, v135
  v_mfma_f32_16x16x32_bf16 v[72:75], a[164:167], a[88:91], v[72:75]
  buffer_load_dwordx4 v240, s[20:23], s31 offen offset:2048 lds
  v_mfma_f32_16x16x32_bf16 v[76:79], a[164:167], a[92:95], v[76:79]
  ds_read_b64_tr_b16 a[182:183], v230 offset:9216
  v_min3_u32 v136, v136, v139, v140
  v_mfma_f32_16x16x32_bf16 v[76:79], a[160:163], a[76:79], v[76:79]
  s_waitcnt lgkmcnt(4)
  v_min_u32_dpp v136, v136, v136 row_ror:8 row_mask:0xf bank_mask:0xf
  v_mfma_f32_16x16x32_bf16 v[80:83], a[168:171], a[64:67], v[80:83]
  ds_read_b64_tr_b16 a[184:185], v231 offset:0
  v_min_u32_dpp v136, v136, v136 row_ror:4 row_mask:0xf bank_mask:0xf
  v_mfma_f32_16x16x32_bf16 v[80:83], a[172:175], a[80:83], v[80:83]
  buffer_load_dwordx4 a[52:55], v243, s[24:27], s30 offen offset:1024 sc1
  v_mfma_f32_16x16x32_bf16 v[84:87], a[172:175], a[84:87], v[84:87]
  ds_read_b64_tr_b16 a[186:187], v231 offset:1024
  v_min_u32_dpp v136, v136, v136 row_ror:2 row_mask:0xf bank_mask:0xf
  v_mfma_f32_16x16x32_bf16 v[84:87], a[168:171], a[68:71], v[84:87]
  s_waitcnt vmcnt(22)
  v_min_u32_dpp v136, v136, v136 row_ror:1 row_mask:0xf bank_mask:0xf
  v_mfma_f32_16x16x32_bf16 v[88:91], a[168:171], a[72:75], v[88:91]
  ds_read_b64_tr_b16 a[188:189], v231 offset:8192
  v_readlane_b32 s98, v136, 0
  v_readlane_b32 s99, v136, 16
  v_readlane_b32 s100, v136, 32
  v_readlane_b32 s101, v136, 48
  s_min_u32 s98, s98, s99
  s_min_u32 s100, s100, s101
  s_min_u32 s98, s98, s100
  s_sub_u32 s59, s51, s98
  s_sub_u32 s51, s59, 1
  v_writelane_b32 v136, s52, 0
  v_writelane_b32 v136, s53, 1
  v_writelane_b32 v136, s54, 2
  v_writelane_b32 v136, s55, 3
  v_writelane_b32 v136, s56, 4
  v_writelane_b32 v136, s57, 5
  v_writelane_b32 v136, s58, 6
  v_writelane_b32 v136, s59, 7
  s_lshl_b32 s35, s3, 8
  s_add_u32 s35, s35, 158720
  v_lshrrev_b32 v137, 2, v242
  v_add_u32 v137, s35, v137
  ds_write_b32 v137, v136
  s_waitcnt lgkmcnt(0)
  v_mfma_f32_16x16x32_bf16 v[88:91], a[172:175], a[88:91], v[88:91]
  s_barrier
  v_mfma_f32_16x16x32_bf16 v[92:95], a[172:175], a[92:95], v[92:95]
  ds_read_b64_tr_b16 a[190:191], v231 offset:9216
  v_mfma_f32_16x16x32_bf16 v[92:95], a[168:171], a[76:79], v[92:95]
  v_mfma_f32_16x16x32_bf16 v[96:99], a[176:179], a[64:67], v[96:99]
  ds_read_b64_tr_b16 a[160:161], v224 offset:16384
  v_mfma_f32_16x16x32_bf16 v[96:99], a[180:183], a[80:83], v[96:99]
  buffer_load_dwordx4 a[56:59], v243, s[24:27], s30 offen offset:2048 sc1
  v_mfma_f32_16x16x32_bf16 v[100:103], a[180:183], a[84:87], v[100:103]
  ds_read_b64_tr_b16 a[162:163], v224 offset:17408
  v_mfma_f32_16x16x32_bf16 v[100:103], a[176:179], a[68:71], v[100:103]
  v_mfma_f32_16x16x32_bf16 v[104:107], a[176:179], a[72:75], v[104:107]
  ds_read_b64_tr_b16 a[164:165], v224 offset:24576
  v_mfma_f32_16x16x32_bf16 v[104:107], a[180:183], a[88:91], v[104:107]
  buffer_load_dwordx4 v241, s[20:23], s31 offen offset:3072 lds
  s_add_u32 s31, s31, 0x80000
  v_mfma_f32_16x16x32_bf16 v[108:111], a[180:183], a[92:95], v[108:111]
  ds_read_b64_tr_b16 a[166:167], v224 offset:25600
  v_mfma_f32_16x16x32_bf16 v[108:111], a[176:179], a[76:79], v[108:111]
  s_waitcnt lgkmcnt(4)
  v_mfma_f32_16x16x32_bf16 v[112:115], a[184:187], a[64:67], v[112:115]
  ds_read_b64_tr_b16 a[168:169], v225 offset:16384
  v_mfma_f32_16x16x32_bf16 v[112:115], a[188:191], a[80:83], v[112:115]
  buffer_load_dwordx4 a[60:63], v243, s[24:27], s30 offen offset:3072 sc1
  s_add_u32 s30, s30, 8192
  v_mfma_f32_16x16x32_bf16 v[116:119], a[188:191], a[84:87], v[116:119]
  ds_read_b64_tr_b16 a[170:171], v225 offset:17408
  v_mfma_f32_16x16x32_bf16 v[116:119], a[184:187], a[68:71], v[116:119]
  v_mfma_f32_16x16x32_bf16 v[120:123], a[184:187], a[72:75], v[120:123]
  ds_read_b64_tr_b16 a[172:173], v225 offset:24576
  v_mfma_f32_16x16x32_bf16 v[120:123], a[188:191], a[88:91], v[120:123]
  v_mfma_f32_16x16x32_bf16 v[124:127], a[188:191], a[92:95], v[124:127]
  ds_read_b64_tr_b16 a[174:175], v225 offset:25600
  v_mfma_f32_16x16x32_bf16 v[124:127], a[184:187], a[76:79], v[124:127]
  s_waitcnt vmcnt(24) lgkmcnt(4)
  v_mfma_f32_16x16x32_bf16 v[0:3], a[160:163], a[96:99], v[0:3]
  ds_read_b64_tr_b16 a[176:177], v226 offset:16384
  v_lshrrev_b32 v136, 4, v242
  v_mfma_f32_16x16x32_bf16 v[0:3], a[164:167], a[112:115], v[0:3]
  v_bfe_u32 v137, v136, 3, 2
  v_and_b32 v138, 7, v136
  v_mfma_f32_16x16x32_bf16 v[4:7], a[164:167], a[116:119], v[4:7]
  ds_read_b64_tr_b16 a[178:179], v226 offset:17408
  v_lshlrev_b32 v137, 8, v137
  v_mfma_f32_16x16x32_bf16 v[4:7], a[160:163], a[100:103], v[4:7]
  v_lshl_add_u32 v137, v138, 2, v137
  v_add_u32 v137, 158720, v137
  v_mfma_f32_16x16x32_bf16 v[8:11], a[160:163], a[104:107], v[8:11]
  ds_read_b64_tr_b16 a[180:181], v226 offset:24576
  s_add_u32 m0, s28, 0
  ds_read_b32 v128, v137
  v_mfma_f32_16x16x32_bf16 v[8:11], a[164:167], a[120:123], v[8:11]
  buffer_load_dwordx4 v232, s[12:15], s29 offen offset:0 lds
  v_mfma_f32_16x16x32_bf16 v[12:15], a[164:167], a[124:127], v[12:15]
  ds_read_b64_tr_b16 a[182:183], v226 offset:25600
  v_mfma_f32_16x16x32_bf16 v[12:15], a[160:163], a[108:111], v[12:15]
  s_waitcnt lgkmcnt(5)
  v_mfma_f32_16x16x32_bf16 v[16:19], a[168:171], a[96:99], v[16:19]
  ds_read_b64_tr_b16 a[184:185], v227 offset:16384
  v_mfma_f32_16x16x32_bf16 v[16:19], a[172:175], a[112:115], v[16:19]
  v_mfma_f32_16x16x32_bf16 v[20:23], a[172:175], a[116:119], v[20:23]
  ds_read_b64_tr_b16 a[186:187], v227 offset:17408
  v_mfma_f32_16x16x32_bf16 v[20:23], a[168:171], a[100:103], v[20:23]
  v_mfma_f32_16x16x32_bf16 v[24:27], a[168:171], a[104:107], v[24:27]
  ds_read_b64_tr_b16 a[188:189], v227 offset:24576
  s_waitcnt lgkmcnt(4)
  s_mov_b32 s51, -1
  v_sub_u32 v137, s51, v128
  v_mfma_f32_16x16x32_bf16 v[24:27], a[172:175], a[120:123], v[24:27]
  v_mfma_f32_16x16x32_bf16 v[28:31], a[172:175], a[124:127], v[28:31]
  ds_read_b64_tr_b16 a[190:191], v227 offset:25600
  v_min_u32_dpp v137, v137, v137 row_ror:8 row_mask:0xf bank_mask:0xf
  v_mfma_f32_16x16x32_bf16 v[28:31], a[168:171], a[108:111], v[28:31]
  s_waitcnt lgkmcnt(4)
  v_min_u32_dpp v137, v137, v137 row_ror:4 row_mask:0xf bank_mask:0xf
  v_mfma_f32_16x16x32_bf16 v[32:35], a[176:179], a[96:99], v[32:35]
  ds_read_b64_tr_b16 a[160:161], v228 offset:16384
  v_min_u32_dpp v137, v137, v137 row_ror:2 row_mask:0xf bank_mask:0xf
  v_mfma_f32_16x16x32_bf16 v[32:35], a[180:183], a[112:115], v[32:35]
  v_mfma_f32_16x16x32_bf16 v[36:39], a[180:183], a[116:119], v[36:39]
  ds_read_b64_tr_b16 a[162:163], v228 offset:17408
  v_min_u32_dpp v137, v137, v137 row_ror:1 row_mask:0xf bank_mask:0xf
  v_mfma_f32_16x16x32_bf16 v[36:39], a[176:179], a[100:103], v[36:39]
  v_readlane_b32 s98, v137, 0
  v_readlane_b32 s99, v137, 16
  v_mfma_f32_16x16x32_bf16 v[40:43], a[176:179], a[104:107], v[40:43]
  ds_read_b64_tr_b16 a[164:165], v228 offset:24576
  s_min_u32 s98, s98, s99
  s_sub_u32 s52, s51, s98
  s_sub_u32 s51, s52, 1
  v_sub_u32 v137, s51, v128
  v_mfma_f32_16x16x32_bf16 v[40:43], a[180:183], a[120:123], v[40:43]
  buffer_load_dwordx4 v233, s[12:15], s29 offen offset:1024 lds
  v_mfma_f32_16x16x32_bf16 v[44:47], a[180:183], a[124:127], v[44:47]
  ds_read_b64_tr_b16 a[166:167], v228 offset:25600
  v_min_u32_dpp v137, v137, v137 row_ror:8 row_mask:0xf bank_mask:0xf
  v_mfma_f32_16x16x32_bf16 v[44:47], a[176:179], a[108:111], v[44:47]
  s_waitcnt lgkmcnt(4)
  v_min_u32_dpp v137, v137, v137 row_ror:4 row_mask:0xf bank_mask:0xf
  v_mfma_f32_16x16x32_bf16 v[48:51], a[184:187], a[96:99], v[48:51]
  ds_read_b64_tr_b16 a[168:169], v229 offset:16384
  v_min_u32_dpp v137, v137, v137 row_ror:2 row_mask:0xf bank_mask:0xf
  v_mfma_f32_16x16x32_bf16 v[48:51], a[188:191], a[112:115], v[48:51]
  v_mfma_f32_16x16x32_bf16 v[52:55], a[188:191], a[116:119], v[52:55]
  ds_read_b64_tr_b16 a[170:171], v229 offset:17408
  v_min_u32_dpp v137, v137, v137 row_ror:1 row_mask:0xf bank_mask:0xf
  v_mfma_f32_16x16x32_bf16 v[52:55], a[184:187], a[100:103], v[52:55]
  v_readlane_b32 s98, v137, 0
  v_readlane_b32 s99, v137, 16
  v_mfma_f32_16x16x32_bf16 v[56:59], a[184:187], a[104:107], v[56:59]
  ds_read_b64_tr_b16 a[172:173], v229 offset:24576
  s_min_u32 s98, s98, s99
  s_sub_u32 s53, s51, s98
  s_sub_u32 s51, s53, 1
  v_sub_u32 v137, s51, v128
  v_mfma_f32_16x16x32_bf16 v[56:59], a[188:191], a[120:123], v[56:59]
  v_mfma_f32_16x16x32_bf16 v[60:63], a[188:191], a[124:127], v[60:63]
  ds_read_b64_tr_b16 a[174:175], v229 offset:25600
  v_min_u32_dpp v137, v137, v137 row_ror:8 row_mask:0xf bank_mask:0xf
  v_mfma_f32_16x16x32_bf16 v[60:63], a[184:187], a[108:111], v[60:63]
  s_waitcnt lgkmcnt(4)
  v_min_u32_dpp v137, v137, v137 row_ror:4 row_mask:0xf bank_mask:0xf
  v_mfma_f32_16x16x32_bf16 v[64:67], a[160:163], a[96:99], v[64:67]
  ds_read_b64_tr_b16 a[176:177], v230 offset:16384
  v_min_u32_dpp v137, v137, v137 row_ror:2 row_mask:0xf bank_mask:0xf
  v_mfma_f32_16x16x32_bf16 v[64:67], a[164:167], a[112:115], v[64:67]
  v_mfma_f32_16x16x32_bf16 v[68:71], a[164:167], a[116:119], v[68:71]
  ds_read_b64_tr_b16 a[178:179], v230 offset:17408
  v_min_u32_dpp v137, v137, v137 row_ror:1 row_mask:0xf bank_mask:0xf
  v_mfma_f32_16x16x32_bf16 v[68:71], a[160:163], a[100:103], v[68:71]
  v_readlane_b32 s98, v137, 0
  v_readlane_b32 s99, v137, 16
  v_mfma_f32_16x16x32_bf16 v[72:75], a[160:163], a[104:107], v[72:75]
  ds_read_b64_tr_b16 a[180:181], v230 offset:24576
  s_min_u32 s98, s98, s99
  s_sub_u32 s54, s51, s98
  s_sub_u32 s51, s54, 1
  v_sub_u32 v137, s51, v128
  v_mfma_f32_16x16x32_bf16 v[72:75], a[164:167], a[120:123], v[72:75]
  buffer_load_dwordx4 v234, s[12:15], s29 offen offset:2048 lds
  v_mfma_f32_16x16x32_bf16 v[76:79], a[164:167], a[124:127], v[76:79]
  ds_read_b64_tr_b16 a[182:183], v230 offset:25600
  v_min_u32_dpp v137, v137, v137 row_ror:8 row_mask:0xf bank_mask:0xf
  v_mfma_f32_16x16x32_bf16 v[76:79], a[160:163], a[108:111], v[76:79]
  s_waitcnt lgkmcnt(4)
  v_min_u32_dpp v137, v137, v137 row_ror:4 row_mask:0xf bank_mask:0xf
  v_mfma_f32_16x16x32_bf16 v[80:83], a[168:171], a[96:99], v[80:83]
  ds_read_b64_tr_b16 a[184:185], v231 offset:16384
  v_min_u32_dpp v137, v137, v137 row_ror:2 row_mask:0xf bank_mask:0xf
  v_mfma_f32_16x16x32_bf16 v[80:83], a[172:175], a[112:115], v[80:83]
  v_mfma_f32_16x16x32_bf16 v[84:87], a[172:175], a[116:119], v[84:87]
  ds_read_b64_tr_b16 a[186:187], v231 offset:17408
  v_min_u32_dpp v137, v137, v137 row_ror:1 row_mask:0xf bank_mask:0xf
  v_mfma_f32_16x16x32_bf16 v[84:87], a[168:171], a[100:103], v[84:87]
  s_waitcnt vmcnt(16)
  v_readlane_b32 s98, v137, 0
  v_readlane_b32 s99, v137, 16
  v_mfma_f32_16x16x32_bf16 v[88:91], a[168:171], a[104:107], v[88:91]
  ds_read_b64_tr_b16 a[188:189], v231 offset:24576
  s_min_u32 s98, s98, s99
  s_sub_u32 s55, s51, s98
  s_sub_u32 s51, s55, 1
  v_sub_u32 v137, s51, v128
  v_mfma_f32_16x16x32_bf16 v[88:91], a[172:175], a[120:123], v[88:91]
  s_barrier
  v_min_u32_dpp v137, v137, v137 row_ror:8 row_mask:0xf bank_mask:0xf
  v_mfma_f32_16x16x32_bf16 v[92:95], a[172:175], a[124:127], v[92:95]
  ds_read_b64_tr_b16 a[190:191], v231 offset:25600
  v_min_u32_dpp v137, v137, v137 row_ror:4 row_mask:0xf bank_mask:0xf
  v_mfma_f32_16x16x32_bf16 v[92:95], a[168:171], a[108:111], v[92:95]
  s_waitcnt lgkmcnt(4)
  v_min_u32_dpp v137, v137, v137 row_ror:2 row_mask:0xf bank_mask:0xf
  v_mfma_f32_16x16x32_bf16 v[96:99], a[176:179], a[96:99], v[96:99]
  ds_read_b64_tr_b16 a[160:161], v224 offset:32768
  v_min_u32_dpp v137, v137, v137 row_ror:1 row_mask:0xf bank_mask:0xf
  v_mfma_f32_16x16x32_bf16 v[96:99], a[180:183], a[112:115], v[96:99]
  v_readlane_b32 s98, v137, 0
  v_readlane_b32 s99, v137, 16
  v_mfma_f32_16x16x32_bf16 v[100:103], a[180:183], a[116:119], v[100:103]
  ds_read_b64_tr_b16 a[162:163], v224 offset:33792
  s_min_u32 s98, s98, s99
  s_sub_u32 s56, s51, s98
  s_sub_u32 s51, s56, 1
  v_sub_u32 v137, s51, v128
  v_mfma_f32_16x16x32_bf16 v[100:103], a[176:179], a[100:103], v[100:103]
  v_mfma_f32_16x16x32_bf16 v[104:107], a[176:179], a[104:107], v[104:107]
  ds_read_b64_tr_b16 a[164:165], v224 offset:40960
  v_min_u32_dpp v137, v137, v137 row_ror:8 row_mask:0xf bank_mask:0xf
  v_mfma_f32_16x16x32_bf16 v[104:107], a[180:183], a[120:123], v[104:107]
  buffer_load_dwordx4 v235, s[12:15], s29 offen offset:3072 lds
  v_mfma_f32_16x16x32_bf16 v[108:111], a[180:183], a[124:127], v[108:111]
  ds_read_b64_tr_b16 a[166:167], v224 offset:41984
  v_min_u32_dpp v137, v137, v137 row_ror:4 row_mask:0xf bank_mask:0xf
  v_mfma_f32_16x16x32_bf16 v[108:111], a[176:179], a[108:111], v[108:111]
  s_waitcnt lgkmcnt(4)
  v_min_u32_dpp v137, v137, v137 row_ror:2 row_mask:0xf bank_mask:0xf
  v_mfma_f32_16x16x32_bf16 v[112:115], a[184:187], a[96:99], v[112:115]
  ds_read_b64_tr_b16 a[168:169], v225 offset:32768
  v_min_u32_dpp v137, v137, v137 row_ror:1 row_mask:0xf bank_mask:0xf
  v_mfma_f32_16x16x32_bf16 v[112:115], a[188:191], a[112:115], v[112:115]
  v_readlane_b32 s98, v137, 0
  v_readlane_b32 s99, v137, 16
  v_mfma_f32_16x16x32_bf16 v[116:119], a[188:191], a[116:119], v[116:119]
  ds_read_b64_tr_b16 a[170:171], v225 offset:33792
  s_min_u32 s98, s98, s99
  s_sub_u32 s57, s51, s98
  s_sub_u32 s51, s57, 1
  v_sub_u32 v137, s51, v128
  v_mfma_f32_16x16x32_bf16 v[116:119], a[184:187], a[100:103], v[116:119]
  v_mfma_f32_16x16x32_bf16 v[120:123], a[184:187], a[104:107], v[120:123]
  ds_read_b64_tr_b16 a[172:173], v225 offset:40960
  v_min_u32_dpp v137, v137, v137 row_ror:8 row_mask:0xf bank_mask:0xf
  v_mfma_f32_16x16x32_bf16 v[120:123], a[188:191], a[120:123], v[120:123]
  v_mfma_f32_16x16x32_bf16 v[124:127], a[188:191], a[124:127], v[124:127]
  ds_read_b64_tr_b16 a[174:175], v225 offset:41984
  v_min_u32_dpp v137, v137, v137 row_ror:4 row_mask:0xf bank_mask:0xf
  v_mfma_f32_16x16x32_bf16 v[124:127], a[184:187], a[108:111], v[124:127]
  s_waitcnt vmcnt(16) lgkmcnt(4)
  v_min_u32_dpp v137, v137, v137 row_ror:2 row_mask:0xf bank_mask:0xf
  v_mfma_f32_16x16x32_bf16 v[0:3], a[160:163], a[0:3], v[0:3]
  ds_read_b64_tr_b16 a[176:177], v226 offset:32768
  v_min_u32_dpp v137, v137, v137 row_ror:1 row_mask:0xf bank_mask:0xf
  v_mfma_f32_16x16x32_bf16 v[0:3], a[164:167], a[16:19], v[0:3]
  v_readlane_b32 s98, v137, 0
  v_readlane_b32 s99, v137, 16
  v_mfma_f32_16x16x32_bf16 v[4:7], a[164:167], a[20:23], v[4:7]
  ds_read_b64_tr_b16 a[178:179], v226 offset:33792
  s_min_u32 s98, s98, s99
  s_sub_u32 s58, s51, s98
  s_sub_u32 s51, s58, 1
  v_sub_u32 v137, s51, v128
  v_mfma_f32_16x16x32_bf16 v[4:7], a[160:163], a[4:7], v[4:7]
  v_mfma_f32_16x16x32_bf16 v[8:11], a[160:163], a[8:11], v[8:11]
  ds_read_b64_tr_b16 a[180:181], v226 offset:40960
  s_add_u32 m0, s28, 65536
  v_min_u32_dpp v137, v137, v137 row_ror:8 row_mask:0xf bank_mask:0xf
  v_mfma_f32_16x16x32_bf16 v[8:11], a[164:167], a[24:27], v[8:11]
  buffer_load_dwordx4 v236, s[16:19], s29 offen offset:0 lds
  v_mfma_f32_16x16x32_bf16 v[12:15], a[164:167], a[28:31], v[12:15]
  ds_read_b64_tr_b16 a[182:183], v226 offset:41984
  v_min_u32_dpp v137, v137, v137 row_ror:4 row_mask:0xf bank_mask:0xf
  v_mfma_f32_16x16x32_bf16 v[12:15], a[160:163], a[12:15], v[12:15]
  s_waitcnt lgkmcnt(4)
  v_min_u32_dpp v137, v137, v137 row_ror:2 row_mask:0xf bank_mask:0xf
  v_mfma_f32_16x16x32_bf16 v[16:19], a[168:171], a[0:3], v[16:19]
  ds_read_b64_tr_b16 a[184:185], v227 offset:32768
  v_min_u32_dpp v137, v137, v137 row_ror:1 row_mask:0xf bank_mask:0xf
  v_mfma_f32_16x16x32_bf16 v[16:19], a[172:175], a[16:19], v[16:19]
  v_readlane_b32 s98, v137, 0
  v_readlane_b32 s99, v137, 16
  v_mfma_f32_16x16x32_bf16 v[20:23], a[172:175], a[20:23], v[20:23]
  ds_read_b64_tr_b16 a[186:187], v227 offset:33792
  s_min_u32 s98, s98, s99
  s_sub_u32 s59, s51, s98
  s_sub_u32 s51, s59, 1
  v_mov_b32 v128, 0
  v_mfma_f32_16x16x32_bf16 v[20:23], a[168:171], a[4:7], v[20:23]
  v_writelane_b32 v128, s52, 0
  v_writelane_b32 v128, s53, 1
  v_mfma_f32_16x16x32_bf16 v[24:27], a[168:171], a[8:11], v[24:27]
  ds_read_b64_tr_b16 a[188:189], v227 offset:40960
  v_writelane_b32 v128, s54, 2
  v_mfma_f32_16x16x32_bf16 v[24:27], a[172:175], a[24:27], v[24:27]
  v_writelane_b32 v128, s55, 3
  v_writelane_b32 v128, s56, 4
  v_mfma_f32_16x16x32_bf16 v[28:31], a[172:175], a[28:31], v[28:31]
  ds_read_b64_tr_b16 a[190:191], v227 offset:41984
  v_writelane_b32 v128, s57, 5
  v_mfma_f32_16x16x32_bf16 v[28:31], a[168:171], a[12:15], v[28:31]
  s_waitcnt lgkmcnt(4)
  v_writelane_b32 v128, s58, 6
  v_writelane_b32 v128, s59, 7
  v_mfma_f32_16x16x32_bf16 v[32:35], a[176:179], a[0:3], v[32:35]
  ds_read_b64_tr_b16 a[160:161], v228 offset:32768
  v_and_b32 v129, 0xffff, v128
  v_mfma_f32_16x16x32_bf16 v[32:35], a[180:183], a[16:19], v[32:35]
  v_sub_u32 v129, 0xffff, v129
  v_and_b32 v129, 0x7ff, v129
  v_mfma_f32_16x16x32_bf16 v[36:39], a[180:183], a[20:23], v[36:39]
  ds_read_b64_tr_b16 a[162:163], v228 offset:33792
  v_mov_b32 v130, v129
  v_mfma_f32_16x16x32_bf16 v[36:39], a[176:179], a[4:7], v[36:39]
  v_mfma_f32_16x16x32_bf16 v[40:43], a[176:179], a[8:11], v[40:43]
  ds_read_b64_tr_b16 a[164:165], v228 offset:40960
  v_permlane16_swap_b32 v129, v130
  v_mfma_f32_16x16x32_bf16 v[40:43], a[180:183], a[24:27], v[40:43]
  buffer_load_dwordx4 v237, s[16:19], s29 offen offset:1024 lds
  v_mfma_f32_16x16x32_bf16 v[44:47], a[180:183], a[28:31], v[44:47]
  ds_read_b64_tr_b16 a[166:167], v228 offset:41984
  v_mov_b32 v130, v129
  v_mfma_f32_16x16x32_bf16 v[44:47], a[176:179], a[12:15], v[44:47]
  s_waitcnt lgkmcnt(4)
  v_permlane32_swap_b32 v129, v130
  v_lshrrev_b32 v130, 6, v129
  v_mfma_f32_16x16x32_bf16 v[48:51], a[184:187], a[0:3], v[48:51]
  ds_read_b64_tr_b16 a[168:169], v229 offset:32768
  v_mul_u32_u24 v130, 0x14000, v130
  v_mfma_f32_16x16x32_bf16 v[48:51], a[188:191], a[16:19], v[48:51]
  v_bfe_u32 v131, v129, 4, 2
  v_lshl_add_u32 v130, v131, 10, v130
  v_mfma_f32_16x16x32_bf16 v[52:55], a[188:191], a[20:23], v[52:55]
  ds_read_b64_tr_b16 a[170:171], v229 offset:33792
  v_and_b32 v131, 15, v129
  v_mfma_f32_16x16x32_bf16 v[52:55], a[184:187], a[4:7], v[52:55]
  v_lshl_add_u32 v130, v131, 4, v130
  v_lshrrev_b32 v131, 4, v136
  v_mfma_f32_16x16x32_bf16 v[56:59], a[184:187], a[8:11], v[56:59]
  ds_read_b64_tr_b16 a[172:173], v229 offset:40960
  v_lshl_add_u32 v243, v131, 8, v130
  v_mfma_f32_16x16x32_bf16 v[56:59], a[188:191], a[24:27], v[56:59]
  v_mfma_f32_16x16x32_bf16 v[60:63], a[188:191], a[28:31], v[60:63]
  ds_read_b64_tr_b16 a[174:175], v229 offset:41984
  v_mfma_f32_16x16x32_bf16 v[60:63], a[184:187], a[12:15], v[60:63]
  s_waitcnt lgkmcnt(4)
  v_mfma_f32_16x16x32_bf16 v[64:67], a[160:163], a[0:3], v[64:67]
  ds_read_b64_tr_b16 a[176:177], v230 offset:32768
  v_mfma_f32_16x16x32_bf16 v[64:67], a[164:167], a[16:19], v[64:67]
  v_mfma_f32_16x16x32_bf16 v[68:71], a[164:167], a[20:23], v[68:71]
  ds_read_b64_tr_b16 a[178:179], v230 offset:33792
  v_mfma_f32_16x16x32_bf16 v[68:71], a[160:163], a[4:7], v[68:71]
  v_mfma_f32_16x16x32_bf16 v[72:75], a[160:163], a[8:11], v[72:75]
  ds_read_b64_tr_b16 a[180:181], v230 offset:40960
  v_mfma_f32_16x16x32_bf16 v[72:75], a[164:167], a[24:27], v[72:75]
  buffer_load_dwordx4 v236, s[16:19], s29 offen offset:2048 lds
  v_mfma_f32_16x16x32_bf16 v[76:79], a[164:167], a[28:31], v[76:79]
  ds_read_b64_tr_b16 a[182:183], v230 offset:41984
  v_mfma_f32_16x16x32_bf16 v[76:79], a[160:163], a[12:15], v[76:79]
  s_waitcnt lgkmcnt(4)
  v_mfma_f32_16x16x32_bf16 v[80:83], a[168:171], a[0:3], v[80:83]
  ds_read_b64_tr_b16 a[184:185], v231 offset:32768
  v_mfma_f32_16x16x32_bf16 v[80:83], a[172:175], a[16:19], v[80:83]
  v_mfma_f32_16x16x32_bf16 v[84:87], a[172:175], a[20:23], v[84:87]
  ds_read_b64_tr_b16 a[186:187], v231 offset:33792
  v_mfma_f32_16x16x32_bf16 v[84:87], a[168:171], a[4:7], v[84:87]
  s_waitcnt vmcnt(8)
  v_mfma_f32_16x16x32_bf16 v[88:91], a[168:171], a[8:11], v[88:91]
  ds_read_b64_tr_b16 a[188:189], v231 offset:40960
  v_mfma_f32_16x16x32_bf16 v[88:91], a[172:175], a[24:27], v[88:91]
  s_barrier
  v_mfma_f32_16x16x32_bf16 v[92:95], a[172:175], a[28:31], v[92:95]
  ds_read_b64_tr_b16 a[190:191], v231 offset:41984
  v_mfma_f32_16x16x32_bf16 v[92:95], a[168:171], a[12:15], v[92:95]
  s_waitcnt lgkmcnt(4)
  v_mfma_f32_16x16x32_bf16 v[96:99], a[176:179], a[0:3], v[96:99]
  ds_read_b64_tr_b16 a[160:161], v224 offset:49152
  v_mfma_f32_16x16x32_bf16 v[96:99], a[180:183], a[16:19], v[96:99]
  v_mfma_f32_16x16x32_bf16 v[100:103], a[180:183], a[20:23], v[100:103]
  ds_read_b64_tr_b16 a[162:163], v224 offset:50176
  v_mfma_f32_16x16x32_bf16 v[100:103], a[176:179], a[4:7], v[100:103]
  v_mfma_f32_16x16x32_bf16 v[104:107], a[176:179], a[8:11], v[104:107]
  ds_read_b64_tr_b16 a[164:165], v224 offset:57344
  v_mfma_f32_16x16x32_bf16 v[104:107], a[180:183], a[24:27], v[104:107]
  buffer_load_dwordx4 v237, s[16:19], s29 offen offset:3072 lds
  s_add_u32 s29, s29, 16384
  v_mfma_f32_16x16x32_bf16 v[108:111], a[180:183], a[28:31], v[108:111]
  ds_read_b64_tr_b16 a[166:167], v224 offset:58368
  v_mfma_f32_16x16x32_bf16 v[108:111], a[176:179], a[12:15], v[108:111]
  s_waitcnt lgkmcnt(4)
  v_mfma_f32_16x16x32_bf16 v[112:115], a[184:187], a[0:3], v[112:115]
  ds_read_b64_tr_b16 a[168:169], v225 offset:49152
  v_mfma_f32_16x16x32_bf16 v[112:115], a[188:191], a[16:19], v[112:115]
  v_mfma_f32_16x16x32_bf16 v[116:119], a[188:191], a[20:23], v[116:119]
  ds_read_b64_tr_b16 a[170:171], v225 offset:50176
  v_mfma_f32_16x16x32_bf16 v[116:119], a[184:187], a[4:7], v[116:119]
  v_mfma_f32_16x16x32_bf16 v[120:123], a[184:187], a[8:11], v[120:123]
  ds_read_b64_tr_b16 a[172:173], v225 offset:57344
  v_mfma_f32_16x16x32_bf16 v[120:123], a[188:191], a[24:27], v[120:123]
  v_mfma_f32_16x16x32_bf16 v[124:127], a[188:191], a[28:31], v[124:127]
  ds_read_b64_tr_b16 a[174:175], v225 offset:58368
  v_mfma_f32_16x16x32_bf16 v[124:127], a[184:187], a[12:15], v[124:127]
  s_waitcnt vmcnt(8) lgkmcnt(4)
  v_mfma_f32_16x16x32_bf16 v[0:3], a[160:163], a[32:35], v[0:3]
  ds_read_b64_tr_b16 a[176:177], v226 offset:49152
  s_add_u32 m0, s28, 16384
  v_mfma_f32_16x16x32_bf16 v[0:3], a[164:167], a[48:51], v[0:3]
  buffer_load_dwordx4 v232, s[12:15], s29 offen offset:0 lds
  v_mfma_f32_16x16x32_bf16 v[4:7], a[164:167], a[52:55], v[4:7]
  ds_read_b64_tr_b16 a[178:179], v226 offset:50176
  v_mfma_f32_16x16x32_bf16 v[4:7], a[160:163], a[36:39], v[4:7]
  v_mfma_f32_16x16x32_bf16 v[8:11], a[160:163], a[40:43], v[8:11]
  ds_read_b64_tr_b16 a[180:181], v226 offset:57344
  v_mfma_f32_16x16x32_bf16 v[8:11], a[164:167], a[56:59], v[8:11]
  buffer_load_dwordx4 v233, s[12:15], s29 offen offset:1024 lds
  v_mfma_f32_16x16x32_bf16 v[12:15], a[164:167], a[60:63], v[12:15]
  ds_read_b64_tr_b16 a[182:183], v226 offset:58368
  v_mfma_f32_16x16x32_bf16 v[12:15], a[160:163], a[44:47], v[12:15]
  s_waitcnt lgkmcnt(4)
  v_mfma_f32_16x16x32_bf16 v[16:19], a[168:171], a[32:35], v[16:19]
  ds_read_b64_tr_b16 a[184:185], v227 offset:49152
  v_mfma_f32_16x16x32_bf16 v[16:19], a[172:175], a[48:51], v[16:19]
  buffer_load_dwordx4 v234, s[12:15], s29 offen offset:2048 lds
  v_mfma_f32_16x16x32_bf16 v[20:23], a[172:175], a[52:55], v[20:23]
  ds_read_b64_tr_b16 a[186:187], v227 offset:50176
  v_mfma_f32_16x16x32_bf16 v[20:23], a[168:171], a[36:39], v[20:23]
  buffer_load_dwordx4 v235, s[12:15], s29 offen offset:3072 lds
  v_mfma_f32_16x16x32_bf16 v[24:27], a[168:171], a[40:43], v[24:27]
  ds_read_b64_tr_b16 a[188:189], v227 offset:57344
  v_mfma_f32_16x16x32_bf16 v[24:27], a[172:175], a[56:59], v[24:27]
  v_mul_f32 v0, s34, v0
  v_mul_f32 v1, s34, v1
  v_mfma_f32_16x16x32_bf16 v[28:31], a[172:175], a[60:63], v[28:31]
  ds_read_b64_tr_b16 a[190:191], v227 offset:58368
  v_mul_f32 v2, s34, v2
  v_mfma_f32_16x16x32_bf16 v[28:31], a[168:171], a[44:47], v[28:31]
  s_waitcnt lgkmcnt(4)
  v_mul_f32 v3, s34, v3
  v_mul_f32 v16, s34, v16
  v_mfma_f32_16x16x32_bf16 v[32:35], a[176:179], a[32:35], v[32:35]
  ds_read_b64_tr_b16 a[160:161], v228 offset:49152
  v_mul_f32 v17, s34, v17
  v_mfma_f32_16x16x32_bf16 v[32:35], a[180:183], a[48:51], v[32:35]
  v_mul_f32 v18, s34, v18
  v_mul_f32 v19, s34, v19
  v_mfma_f32_16x16x32_bf16 v[36:39], a[180:183], a[52:55], v[36:39]
  ds_read_b64_tr_b16 a[162:163], v228 offset:50176
  v_cvt_pk_bf16_f32 v128, v0, v1
  v_mfma_f32_16x16x32_bf16 v[36:39], a[176:179], a[36:39], v[36:39]
  v_cvt_pk_bf16_f32 v129, v2, v3
  v_cvt_pk_bf16_f32 v130, v16, v17
  v_mfma_f32_16x16x32_bf16 v[40:43], a[176:179], a[40:43], v[40:43]
  ds_read_b64_tr_b16 a[164:165], v228 offset:57344
  v_cvt_pk_bf16_f32 v131, v18, v19
  v_mfma_f32_16x16x32_bf16 v[40:43], a[180:183], a[56:59], v[40:43]
  v_mul_f32 v4, s34, v4
  v_mul_f32 v5, s34, v5
  v_mfma_f32_16x16x32_bf16 v[44:47], a[180:183], a[60:63], v[44:47]
  ds_read_b64_tr_b16 a[166:167], v228 offset:58368
  v_mul_f32 v6, s34, v6
  v_mfma_f32_16x16x32_bf16 v[44:47], a[176:179], a[44:47], v[44:47]
  s_waitcnt lgkmcnt(4)
  v_mul_f32 v7, s34, v7
  v_mul_f32 v20, s34, v20
  v_mfma_f32_16x16x32_bf16 v[48:51], a[184:187], a[32:35], v[48:51]
  ds_read_b64_tr_b16 a[168:169], v229 offset:49152
  v_mul_f32 v21, s34, v21
  v_mfma_f32_16x16x32_bf16 v[48:51], a[188:191], a[48:51], v[48:51]
  v_mul_f32 v22, s34, v22
  v_mul_f32 v23, s34, v23
  v_mfma_f32_16x16x32_bf16 v[52:55], a[188:191], a[52:55], v[52:55]
  ds_read_b64_tr_b16 a[170:171], v229 offset:50176
  v_cvt_pk_bf16_f32 v144, v4, v5
  v_mfma_f32_16x16x32_bf16 v[52:55], a[184:187], a[36:39], v[52:55]
  v_cvt_pk_bf16_f32 v145, v6, v7
  v_cvt_pk_bf16_f32 v146, v20, v21
  v_mfma_f32_16x16x32_bf16 v[56:59], a[184:187], a[40:43], v[56:59]
  ds_read_b64_tr_b16 a[172:173], v229 offset:57344
  v_cvt_pk_bf16_f32 v147, v22, v23
  v_mfma_f32_16x16x32_bf16 v[56:59], a[188:191], a[56:59], v[56:59]
  v_permlane16_swap_b32 v128, v130
  v_permlane16_swap_b32 v129, v131
  v_mfma_f32_16x16x32_bf16 v[60:63], a[188:191], a[60:63], v[60:63]
  ds_read_b64_tr_b16 a[174:175], v229 offset:58368
  v_mul_f32 v8, s34, v8
  v_mfma_f32_16x16x32_bf16 v[60:63], a[184:187], a[44:47], v[60:63]
  s_waitcnt lgkmcnt(4)
  v_mul_f32 v9, s34, v9
  v_mul_f32 v10, s34, v10
  v_mfma_f32_16x16x32_bf16 v[64:67], a[160:163], a[32:35], v[64:67]
  ds_read_b64_tr_b16 a[176:177], v230 offset:49152
  v_mul_f32 v11, s34, v11
  v_mfma_f32_16x16x32_bf16 v[64:67], a[164:167], a[48:51], v[64:67]
  v_mul_f32 v24, s34, v24
  v_mul_f32 v25, s34, v25
  v_mfma_f32_16x16x32_bf16 v[68:71], a[164:167], a[52:55], v[68:71]
  ds_read_b64_tr_b16 a[178:179], v230 offset:50176
  v_mul_f32 v26, s34, v26
  v_mfma_f32_16x16x32_bf16 v[68:71], a[160:163], a[36:39], v[68:71]
  v_mul_f32 v27, s34, v27
  v_cvt_pk_bf16_f32 v160, v8, v9
  v_mfma_f32_16x16x32_bf16 v[72:75], a[160:163], a[40:43], v[72:75]
  ds_read_b64_tr_b16 a[180:181], v230 offset:57344
  v_cvt_pk_bf16_f32 v161, v10, v11
  v_mfma_f32_16x16x32_bf16 v[72:75], a[164:167], a[56:59], v[72:75]
  v_cvt_pk_bf16_f32 v162, v24, v25
  v_cvt_pk_bf16_f32 v163, v26, v27
  v_mfma_f32_16x16x32_bf16 v[76:79], a[164:167], a[60:63], v[76:79]
  ds_read_b64_tr_b16 a[182:183], v230 offset:58368
  v_permlane16_swap_b32 v144, v146
  v_mfma_f32_16x16x32_bf16 v[76:79], a[160:163], a[44:47], v[76:79]
  s_waitcnt lgkmcnt(4)
  v_permlane16_swap_b32 v145, v147
  v_mul_f32 v12, s34, v12
  v_mfma_f32_16x16x32_bf16 v[80:83], a[168:171], a[32:35], v[80:83]
  ds_read_b64_tr_b16 a[184:185], v231 offset:49152
  v_mul_f32 v13, s34, v13
  v_mfma_f32_16x16x32_bf16 v[80:83], a[172:175], a[48:51], v[80:83]
  v_mul_f32 v14, s34, v14
  v_mul_f32 v15, s34, v15
  v_mfma_f32_16x16x32_bf16 v[84:87], a[172:175], a[52:55], v[84:87]
  ds_read_b64_tr_b16 a[186:187], v231 offset:50176
  v_mul_f32 v28, s34, v28
  v_mfma_f32_16x16x32_bf16 v[84:87], a[168:171], a[36:39], v[84:87]
  s_waitcnt vmcnt(8)
  v_mul_f32 v29, s34, v29
  v_mul_f32 v30, s34, v30
  v_mfma_f32_16x16x32_bf16 v[88:91], a[168:171], a[40:43], v[88:91]
  ds_read_b64_tr_b16 a[188:189], v231 offset:57344
  v_mul_f32 v31, s34, v31
  v_mfma_f32_16x16x32_bf16 v[88:91], a[172:175], a[56:59], v[88:91]
  s_barrier
  v_cvt_pk_bf16_f32 v176, v12, v13
  v_cvt_pk_bf16_f32 v177, v14, v15
  v_mfma_f32_16x16x32_bf16 v[92:95], a[172:175], a[60:63], v[92:95]
  ds_read_b64_tr_b16 a[190:191], v231 offset:58368
  v_cvt_pk_bf16_f32 v178, v28, v29
  v_mfma_f32_16x16x32_bf16 v[92:95], a[168:171], a[44:47], v[92:95]
  s_waitcnt lgkmcnt(4)
  v_cvt_pk_bf16_f32 v179, v30, v31
  v_permlane16_swap_b32 v160, v162
  v_mfma_f32_16x16x32_bf16 v[96:99], a[176:179], a[32:35], v[96:99]
  ds_read_b128 a[128:131], v212 offset:0
  v_permlane16_swap_b32 v161, v163
  v_mfma_f32_16x16x32_bf16 v[96:99], a[180:183], a[48:51], v[96:99]
  v_mul_f32 v32, s34, v32
  v_mul_f32 v33, s34, v33
  v_mfma_f32_16x16x32_bf16 v[100:103], a[180:183], a[52:55], v[100:103]
  ds_read_b128 a[132:135], v213 offset:0
  v_mul_f32 v34, s34, v34
  v_mfma_f32_16x16x32_bf16 v[100:103], a[176:179], a[36:39], v[100:103]
  v_mul_f32 v35, s34, v35
  v_mul_f32 v48, s34, v48
  v_mfma_f32_16x16x32_bf16 v[104:107], a[176:179], a[40:43], v[104:107]
  ds_read_b128 a[136:139], v214 offset:0
  v_mul_f32 v49, s34, v49
  v_mfma_f32_16x16x32_bf16 v[104:107], a[180:183], a[56:59], v[104:107]
  v_mul_f32 v50, s34, v50
  v_mul_f32 v51, s34, v51
  v_mfma_f32_16x16x32_bf16 v[108:111], a[180:183], a[60:63], v[108:111]
  ds_read_b128 a[140:143], v215 offset:0
  v_cvt_pk_bf16_f32 v132, v32, v33
  v_mfma_f32_16x16x32_bf16 v[108:111], a[176:179], a[44:47], v[108:111]
  s_waitcnt lgkmcnt(4)
  v_cvt_pk_bf16_f32 v133, v34, v35
  v_cvt_pk_bf16_f32 v134, v48, v49
  v_mfma_f32_16x16x32_bf16 v[112:115], a[184:187], a[32:35], v[112:115]
  v_cvt_pk_bf16_f32 v135, v50, v51
  v_permlane16_swap_b32 v176, v178
  v_mfma_f32_16x16x32_bf16 v[112:115], a[188:191], a[48:51], v[112:115]
  v_permlane16_swap_b32 v177, v179
  v_mul_f32 v36, s34, v36
  v_mfma_f32_16x16x32_bf16 v[116:119], a[188:191], a[52:55], v[116:119]
  v_mul_f32 v37, s34, v37
  v_mul_f32 v38, s34, v38
  v_mfma_f32_16x16x32_bf16 v[116:119], a[184:187], a[36:39], v[116:119]
  v_mul_f32 v39, s34, v39
  v_mul_f32 v52, s34, v52
  v_mfma_f32_16x16x32_bf16 v[120:123], a[184:187], a[40:43], v[120:123]
  v_mul_f32 v53, s34, v53
  v_mul_f32 v54, s34, v54
  v_mfma_f32_16x16x32_bf16 v[120:123], a[188:191], a[56:59], v[120:123]
  v_mul_f32 v55, s34, v55
  v_cvt_pk_bf16_f32 v148, v36, v37
  v_mfma_f32_16x16x32_bf16 v[124:127], a[188:191], a[60:63], v[124:127]
  v_cvt_pk_bf16_f32 v149, v38, v39
  v_cvt_pk_bf16_f32 v150, v52, v53
  v_mfma_f32_16x16x32_bf16 v[124:127], a[184:187], a[44:47], v[124:127]
  s_waitcnt lgkmcnt(0)
  v_cvt_pk_bf16_f32 v151, v54, v55
  v_permlane16_swap_b32 v132, v134
  v_permlane16_swap_b32 v133, v135
  v_pk_mul_f32 v[40:41], v[40:41], s[34:35] op_sel_hi:[1,0]
  v_pk_mul_f32 v[42:43], v[42:43], s[34:35] op_sel_hi:[1,0]
  v_pk_mul_f32 v[56:57], v[56:57], s[34:35] op_sel_hi:[1,0]
  v_pk_mul_f32 v[58:59], v[58:59], s[34:35] op_sel_hi:[1,0]
  v_cvt_pk_bf16_f32 v164, v40, v41
  v_cvt_pk_bf16_f32 v165, v42, v43
  v_cvt_pk_bf16_f32 v166, v56, v57
  v_cvt_pk_bf16_f32 v167, v58, v59
  v_permlane16_swap_b32 v148, v150
  v_permlane16_swap_b32 v149, v151
  v_pk_mul_f32 v[44:45], v[44:45], s[34:35] op_sel_hi:[1,0]
  v_pk_mul_f32 v[46:47], v[46:47], s[34:35] op_sel_hi:[1,0]
  v_pk_mul_f32 v[60:61], v[60:61], s[34:35] op_sel_hi:[1,0]
  v_pk_mul_f32 v[62:63], v[62:63], s[34:35] op_sel_hi:[1,0]
  v_cvt_pk_bf16_f32 v180, v44, v45
  v_cvt_pk_bf16_f32 v181, v46, v47
  v_cvt_pk_bf16_f32 v182, v60, v61
  v_cvt_pk_bf16_f32 v183, v62, v63
  v_permlane16_swap_b32 v164, v166
  v_permlane16_swap_b32 v165, v167
  v_pk_mul_f32 v[64:65], v[64:65], s[34:35] op_sel_hi:[1,0]
  v_pk_mul_f32 v[66:67], v[66:67], s[34:35] op_sel_hi:[1,0]
  v_pk_mul_f32 v[80:81], v[80:81], s[34:35] op_sel_hi:[1,0]
  v_pk_mul_f32 v[82:83], v[82:83], s[34:35] op_sel_hi:[1,0]
  v_cvt_pk_bf16_f32 v136, v64, v65
  v_cvt_pk_bf16_f32 v137, v66, v67
  v_cvt_pk_bf16_f32 v138, v80, v81
  v_cvt_pk_bf16_f32 v139, v82, v83
  v_permlane16_swap_b32 v180, v182
  v_permlane16_swap_b32 v181, v183
  v_pk_mul_f32 v[68:69], v[68:69], s[34:35] op_sel_hi:[1,0]
  v_pk_mul_f32 v[70:71], v[70:71], s[34:35] op_sel_hi:[1,0]
  v_pk_mul_f32 v[84:85], v[84:85], s[34:35] op_sel_hi:[1,0]
  v_pk_mul_f32 v[86:87], v[86:87], s[34:35] op_sel_hi:[1,0]
  v_cvt_pk_bf16_f32 v152, v68, v69
  v_cvt_pk_bf16_f32 v153, v70, v71
  v_cvt_pk_bf16_f32 v154, v84, v85
  v_cvt_pk_bf16_f32 v155, v86, v87
  v_permlane16_swap_b32 v136, v138
  v_permlane16_swap_b32 v137, v139
  v_pk_mul_f32 v[72:73], v[72:73], s[34:35] op_sel_hi:[1,0]
  v_pk_mul_f32 v[74:75], v[74:75], s[34:35] op_sel_hi:[1,0]
  v_pk_mul_f32 v[88:89], v[88:89], s[34:35] op_sel_hi:[1,0]
  v_pk_mul_f32 v[90:91], v[90:91], s[34:35] op_sel_hi:[1,0]
  v_cvt_pk_bf16_f32 v168, v72, v73
  v_cvt_pk_bf16_f32 v169, v74, v75
  v_cvt_pk_bf16_f32 v170, v88, v89
  v_cvt_pk_bf16_f32 v171, v90, v91
  v_permlane16_swap_b32 v152, v154
  v_permlane16_swap_b32 v153, v155
  v_pk_mul_f32 v[76:77], v[76:77], s[34:35] op_sel_hi:[1,0]
  v_pk_mul_f32 v[78:79], v[78:79], s[34:35] op_sel_hi:[1,0]
  v_pk_mul_f32 v[92:93], v[92:93], s[34:35] op_sel_hi:[1,0]
  v_pk_mul_f32 v[94:95], v[94:95], s[34:35] op_sel_hi:[1,0]
  v_cvt_pk_bf16_f32 v184, v76, v77
  v_cvt_pk_bf16_f32 v185, v78, v79
  v_cvt_pk_bf16_f32 v186, v92, v93
  v_cvt_pk_bf16_f32 v187, v94, v95
  v_permlane16_swap_b32 v168, v170
  v_permlane16_swap_b32 v169, v171
  v_pk_mul_f32 v[96:97], v[96:97], s[34:35] op_sel_hi:[1,0]
  v_pk_mul_f32 v[98:99], v[98:99], s[34:35] op_sel_hi:[1,0]
  v_pk_mul_f32 v[112:113], v[112:113], s[34:35] op_sel_hi:[1,0]
  v_pk_mul_f32 v[114:115], v[114:115], s[34:35] op_sel_hi:[1,0]
  v_cvt_pk_bf16_f32 v140, v96, v97
  v_cvt_pk_bf16_f32 v141, v98, v99
  v_cvt_pk_bf16_f32 v142, v112, v113
  v_cvt_pk_bf16_f32 v143, v114, v115
  v_permlane16_swap_b32 v184, v186
  v_permlane16_swap_b32 v185, v187
  v_pk_mul_f32 v[100:101], v[100:101], s[34:35] op_sel_hi:[1,0]
  v_pk_mul_f32 v[102:103], v[102:103], s[34:35] op_sel_hi:[1,0]
  v_pk_mul_f32 v[116:117], v[116:117], s[34:35] op_sel_hi:[1,0]
  v_pk_mul_f32 v[118:119], v[118:119], s[34:35] op_sel_hi:[1,0]
  v_cvt_pk_bf16_f32 v156, v100, v101
  v_cvt_pk_bf16_f32 v157, v102, v103
  v_cvt_pk_bf16_f32 v158, v116, v117
  v_cvt_pk_bf16_f32 v159, v118, v119
  v_permlane16_swap_b32 v140, v142
  v_permlane16_swap_b32 v141, v143
  v_pk_mul_f32 v[104:105], v[104:105], s[34:35] op_sel_hi:[1,0]
  v_pk_mul_f32 v[106:107], v[106:107], s[34:35] op_sel_hi:[1,0]
  v_pk_mul_f32 v[120:121], v[120:121], s[34:35] op_sel_hi:[1,0]
  v_pk_mul_f32 v[122:123], v[122:123], s[34:35] op_sel_hi:[1,0]
  v_cvt_pk_bf16_f32 v172, v104, v105
  v_cvt_pk_bf16_f32 v173, v106, v107
  v_cvt_pk_bf16_f32 v174, v120, v121
  v_cvt_pk_bf16_f32 v175, v122, v123
  v_permlane16_swap_b32 v156, v158
  v_permlane16_swap_b32 v157, v159
  v_pk_mul_f32 v[108:109], v[108:109], s[34:35] op_sel_hi:[1,0]
  v_pk_mul_f32 v[110:111], v[110:111], s[34:35] op_sel_hi:[1,0]
  v_pk_mul_f32 v[124:125], v[124:125], s[34:35] op_sel_hi:[1,0]
  v_pk_mul_f32 v[126:127], v[126:127], s[34:35] op_sel_hi:[1,0]
  v_cvt_pk_bf16_f32 v188, v108, v109
  v_cvt_pk_bf16_f32 v189, v110, v111
  v_cvt_pk_bf16_f32 v190, v124, v125
  v_cvt_pk_bf16_f32 v191, v126, v127
  v_permlane16_swap_b32 v172, v174
  v_permlane16_swap_b32 v173, v175
  v_permlane16_swap_b32 v188, v190
  v_permlane16_swap_b32 v189, v191
  v_mfma_f32_16x16x32_bf16 v[0:3], a[128:131], v[128:131], 0
  s_add_u32 m0, s28, 81920
  ds_read_b128 a[144:147], v212 offset:4096
  s_mov_b32 s20, s90
  s_mov_b32 s21, s91
  v_mfma_f32_16x16x32_bf16 v[0:3], a[132:135], v[132:135], v[0:3]
  buffer_load_dwordx4 v236, s[16:19], s29 offen offset:0 lds
  s_mov_b32 s22, 2211840
  s_mov_b32 s23, 0x20000
  s_mov_b32 s44, s92
  v_mfma_f32_16x16x32_bf16 v[0:3], a[136:139], v[136:139], v[0:3]
  ds_read_b128 a[148:151], v213 offset:4096
  s_mov_b32 s45, s93
  s_mov_b32 s46, 2211840
  s_mov_b32 s47, 0x20000
  v_lshrrev_b32 v253, 4, v242
  v_mfma_f32_16x16x32_bf16 v[0:3], a[140:143], v[140:143], v[0:3]
  buffer_load_dwordx4 v237, s[16:19], s29 offen offset:1024 lds
  v_mfma_f32_16x16x32_bf16 v[8:11], a[140:143], v[156:159], 0
  ds_read_b128 a[152:155], v214 offset:4096
  v_mul_u32_u24 v253, 0xd80, v253
  v_mfma_f32_16x16x32_bf16 v[8:11], a[136:139], v[152:155], v[8:11]
  buffer_load_dwordx4 v236, s[16:19], s29 offen offset:2048 lds
  s_mul_i32 s35, s3, 552960
  s_lshl_b32 s38, s33, 4
  s_add_u32 s35, s35, s38
  v_mfma_f32_16x16x32_bf16 v[8:11], a[132:135], v[148:151], v[8:11]
  ds_read_b128 a[156:159], v215 offset:4096
  v_mfma_f32_16x16x32_bf16 v[8:11], a[128:131], v[144:147], v[8:11]
  buffer_load_dwordx4 v237, s[16:19], s29 offen offset:3072 lds
  v_mfma_f32_16x16x32_bf16 v[16:19], a[128:131], v[160:163], 0
  s_add_u32 s29, s29, 16384
  s_add_u32 m0, s28, 32768
  v_mfma_f32_16x16x32_bf16 v[16:19], a[132:135], v[164:167], v[16:19]
  buffer_load_dwordx4 v232, s[12:15], s29 offen offset:0 lds
  v_mfma_f32_16x16x32_bf16 v[16:19], a[136:139], v[168:171], v[16:19]
  buffer_load_dwordx4 v233, s[12:15], s29 offen offset:1024 lds
  v_mfma_f32_16x16x32_bf16 v[16:19], a[140:143], v[172:175], v[16:19]
  v_max3_f32 v192, v0, v1, v2
  v_max3_f32 v196, v8, v9, v10
  v_mfma_f32_16x16x32_bf16 v[24:27], a[140:143], v[188:191], 0
  v_max_f32 v192, v192, v3
  v_max_f32 v196, v196, v11
  v_mfma_f32_16x16x32_bf16 v[24:27], a[136:139], v[184:187], v[24:27]
  v_mov_b32 v245, v192
  v_mov_b32 v246, v196
  v_mfma_f32_16x16x32_bf16 v[24:27], a[132:135], v[180:183], v[24:27]
  v_permlane16_swap_b32 v192, v245
  v_permlane16_swap_b32 v196, v246
  v_mfma_f32_16x16x32_bf16 v[24:27], a[128:131], v[176:179], v[24:27]
  s_waitcnt lgkmcnt(0)
  v_max_f32 v192, v192, v245
  v_max_f32 v196, v196, v246
  v_mfma_f32_16x16x32_bf16 v[4:7], a[144:147], v[128:131], 0
  ds_read_b128 a[128:131], v212 offset:8192
  v_mov_b32 v245, v192
  v_mfma_f32_16x16x32_bf16 v[4:7], a[148:151], v[132:135], v[4:7]
  v_mov_b32 v246, v196
  v_permlane32_swap_b32 v192, v245
  v_mfma_f32_16x16x32_bf16 v[4:7], a[152:155], v[136:139], v[4:7]
  ds_read_b128 a[132:135], v213 offset:8192
  v_permlane32_swap_b32 v196, v246
  v_mfma_f32_16x16x32_bf16 v[4:7], a[156:159], v[140:143], v[4:7]
  v_max_f32 v192, v192, v245
  v_max_f32 v196, v196, v246
  v_mfma_f32_16x16x32_bf16 v[12:15], a[156:159], v[156:159], 0
  ds_read_b128 a[136:139], v214 offset:8192
  v_sub_f32 v193, 0, v192
  v_mfma_f32_16x16x32_bf16 v[12:15], a[152:155], v[152:155], v[12:15]
  v_sub_f32 v197, 0, v196
  v_sub_f32 v194, 0, v192
  v_mfma_f32_16x16x32_bf16 v[12:15], a[148:151], v[148:151], v[12:15]
  ds_read_b128 a[140:143], v215 offset:8192
  v_sub_f32 v198, 0, v196
  v_mfma_f32_16x16x32_bf16 v[12:15], a[144:147], v[144:147], v[12:15]
  v_sub_f32 v195, 0, v192
  v_sub_f32 v199, 0, v196
  v_mfma_f32_16x16x32_bf16 v[20:23], a[144:147], v[160:163], 0
  buffer_load_dwordx4 v234, s[12:15], s29 offen offset:2048 lds
  v_mfma_f32_16x16x32_bf16 v[20:23], a[148:151], v[164:167], v[20:23]
  v_sub_f32 v192, 0, v192
  v_sub_f32 v196, 0, v196
  v_mfma_f32_16x16x32_bf16 v[20:23], a[152:155], v[168:171], v[20:23]
  buffer_load_dwordx4 v235, s[12:15], s29 offen offset:3072 lds
  v_mfma_f32_16x16x32_bf16 v[20:23], a[156:159], v[172:175], v[20:23]
  v_max3_f32 v200, v16, v17, v18
  v_max3_f32 v204, v24, v25, v26
  v_mfma_f32_16x16x32_bf16 v[28:31], a[156:159], v[188:191], 0
  v_max_f32 v200, v200, v19
  v_max_f32 v204, v204, v27
  v_mfma_f32_16x16x32_bf16 v[28:31], a[152:155], v[184:187], v[28:31]
  v_mov_b32 v247, v200
  v_mov_b32 v248, v204
  v_mfma_f32_16x16x32_bf16 v[28:31], a[148:151], v[180:183], v[28:31]
  v_permlane16_swap_b32 v200, v247
  v_permlane16_swap_b32 v204, v248
  v_max_f32 v200, v200, v247
  v_max_f32 v204, v204, v248
  v_mov_b32 v247, v200
  v_mov_b32 v248, v204
  s_nop 0
  v_permlane32_swap_b32 v200, v247
  v_permlane32_swap_b32 v204, v248
  v_max_f32 v200, v200, v247
  v_max_f32 v204, v204, v248
  v_sub_f32 v201, 0, v200
  v_sub_f32 v205, 0, v204
  v_sub_f32 v202, 0, v200
  v_sub_f32 v206, 0, v204
  v_sub_f32 v203, 0, v200
  v_sub_f32 v207, 0, v204
  v_sub_f32 v200, 0, v200
  v_sub_f32 v204, 0, v204
  v_mfma_f32_16x16x32_bf16 v[28:31], a[144:147], v[176:179], v[28:31]
  s_waitcnt lgkmcnt(0)
  v_add_f32 v0, v192, v0
  v_add_f32 v1, v192, v1
  v_mfma_f32_16x16x32_bf16 v[32:35], a[128:131], v[128:131], v[192:195]
  ds_read_b128 a[144:147], v212 offset:12288
  v_add_f32 v2, v192, v2
  v_mfma_f32_16x16x32_bf16 v[32:35], a[132:135], v[132:135], v[32:35]
  v_add_f32 v3, v192, v3
  v_mfma_f32_16x16x32_bf16 v[32:35], a[136:139], v[136:139], v[32:35]
  ds_read_b128 a[148:151], v213 offset:12288
  v_mfma_f32_16x16x32_bf16 v[32:35], a[140:143], v[140:143], v[32:35]
  v_exp_f32 v0, v0
  v_mfma_f32_16x16x32_bf16 v[40:43], a[140:143], v[156:159], v[196:199]
  ds_read_b128 a[152:155], v214 offset:12288
  v_mfma_f32_16x16x32_bf16 v[40:43], a[136:139], v[152:155], v[40:43]
  v_exp_f32 v1, v1
  v_mfma_f32_16x16x32_bf16 v[40:43], a[132:135], v[148:151], v[40:43]
  ds_read_b128 a[156:159], v215 offset:12288
  v_mfma_f32_16x16x32_bf16 v[40:43], a[128:131], v[144:147], v[40:43]
  v_exp_f32 v2, v2
  v_mfma_f32_16x16x32_bf16 v[48:51], a[128:131], v[160:163], v[200:203]
  s_add_u32 m0, s50, 0
  v_cvt_pk_bf16_f32 v0, v0, v1
  v_mfma_f32_16x16x32_bf16 v[48:51], a[132:135], v[164:167], v[48:51]
  v_exp_f32 v3, v3
  v_mfma_f32_16x16x32_bf16 v[48:51], a[136:139], v[168:171], v[48:51]
  v_add_f32 v8, v196, v8
  v_add_f32 v9, v196, v9
  v_mfma_f32_16x16x32_bf16 v[48:51], a[140:143], v[172:175], v[48:51]
  v_add_f32 v10, v196, v10
  v_add_f32 v11, v196, v11
  v_mfma_f32_16x16x32_bf16 v[56:59], a[140:143], v[188:191], v[204:207]
  v_exp_f32 v8, v8
  v_mfma_f32_16x16x32_bf16 v[56:59], a[136:139], v[184:187], v[56:59]
  v_exp_f32 v9, v9
  buffer_load_dwordx4 v253, s[20:23], s35 offen lds
  v_mfma_f32_16x16x32_bf16 v[56:59], a[132:135], v[180:183], v[56:59]
  v_exp_f32 v10, v10
  v_mfma_f32_16x16x32_bf16 v[56:59], a[128:131], v[176:179], v[56:59]
  s_waitcnt lgkmcnt(0)
  v_cvt_pk_bf16_f32 v8, v8, v9
  v_mfma_f32_16x16x32_bf16 v[36:39], a[144:147], v[128:131], v[192:195]
  s_waitcnt vmcnt(9)
  v_exp_f32 v11, v11
  v_mfma_f32_16x16x32_bf16 v[36:39], a[148:151], v[132:135], v[36:39]
  s_barrier
  v_cvt_pk_bf16_f32 v1, v2, v3
  v_add_f32 v16, v200, v16
  v_mfma_f32_16x16x32_bf16 v[36:39], a[152:155], v[136:139], v[36:39]
  ds_read_b128 a[128:131], v212 offset:16384
  v_add_f32 v17, v200, v17
  v_mfma_f32_16x16x32_bf16 v[36:39], a[156:159], v[140:143], v[36:39]
  v_add_f32 v18, v200, v18
  v_add_f32 v19, v200, v19
  v_mfma_f32_16x16x32_bf16 v[44:47], a[156:159], v[156:159], v[196:199]
  ds_read_b128 a[132:135], v213 offset:16384
  v_mfma_f32_16x16x32_bf16 v[44:47], a[152:155], v[152:155], v[44:47]
  v_exp_f32 v16, v16
  v_mfma_f32_16x16x32_bf16 v[44:47], a[148:151], v[148:151], v[44:47]
  ds_read_b128 a[136:139], v214 offset:16384
  v_mfma_f32_16x16x32_bf16 v[44:47], a[144:147], v[144:147], v[44:47]
  v_exp_f32 v17, v17
  v_mfma_f32_16x16x32_bf16 v[52:55], a[144:147], v[160:163], v[200:203]
  ds_read_b128 a[140:143], v215 offset:16384
  v_mfma_f32_16x16x32_bf16 v[52:55], a[148:151], v[164:167], v[52:55]
  v_exp_f32 v18, v18
  v_mfma_f32_16x16x32_bf16 v[52:55], a[152:155], v[168:171], v[52:55]
  v_cvt_pk_bf16_f32 v16, v16, v17
  v_mfma_f32_16x16x32_bf16 v[52:55], a[156:159], v[172:175], v[52:55]
  v_exp_f32 v19, v19
  v_mfma_f32_16x16x32_bf16 v[60:63], a[156:159], v[188:191], v[204:207]
  v_cvt_pk_bf16_f32 v9, v10, v11
  v_add_f32 v24, v204, v24
  v_mfma_f32_16x16x32_bf16 v[60:63], a[152:155], v[184:187], v[60:63]
  v_add_f32 v25, v204, v25
  v_add_f32 v26, v204, v26
  v_mfma_f32_16x16x32_bf16 v[60:63], a[148:151], v[180:183], v[60:63]
  v_add_f32 v27, v204, v27
  v_mfma_f32_16x16x32_bf16 v[60:63], a[144:147], v[176:179], v[60:63]
  s_waitcnt lgkmcnt(0)
  v_exp_f32 v24, v24
  v_exp_f32 v25, v25
  v_exp_f32 v26, v26
  v_cvt_pk_bf16_f32 v24, v24, v25
  v_exp_f32 v27, v27
  v_cvt_pk_bf16_f32 v17, v18, v19
  v_add_f32 v4, v192, v4
  v_add_f32 v5, v192, v5
  v_add_f32 v6, v192, v6
  v_add_f32 v7, v192, v7
  v_exp_f32 v4, v4
  v_exp_f32 v5, v5
  v_exp_f32 v6, v6
  v_cvt_pk_bf16_f32 v2, v4, v5
  v_exp_f32 v7, v7
  v_cvt_pk_bf16_f32 v25, v26, v27
  v_add_f32 v12, v196, v12
  v_add_f32 v13, v196, v13
  v_add_f32 v14, v196, v14
  v_add_f32 v15, v196, v15
  v_exp_f32 v12, v12
  v_exp_f32 v13, v13
  v_exp_f32 v14, v14
  v_cvt_pk_bf16_f32 v10, v12, v13
  v_exp_f32 v15, v15
  v_cvt_pk_bf16_f32 v3, v6, v7
  v_add_f32 v20, v200, v20
  v_add_f32 v21, v200, v21
  v_add_f32 v22, v200, v22
  v_add_f32 v23, v200, v23
  v_exp_f32 v20, v20
  v_exp_f32 v21, v21
  v_exp_f32 v22, v22
  v_cvt_pk_bf16_f32 v18, v20, v21
  v_exp_f32 v23, v23
  v_cvt_pk_bf16_f32 v11, v14, v15
  v_add_f32 v28, v204, v28
  v_add_f32 v29, v204, v29
  v_add_f32 v30, v204, v30
  v_add_f32 v31, v204, v31
  v_exp_f32 v28, v28
  v_exp_f32 v29, v29
  v_exp_f32 v30, v30
  v_cvt_pk_bf16_f32 v26, v28, v29
  v_exp_f32 v31, v31
  v_cvt_pk_bf16_f32 v19, v22, v23
  v_exp_f32 v32, v32
  v_exp_f32 v33, v33
  v_exp_f32 v34, v34
  v_cvt_pk_bf16_f32 v32, v32, v33
  v_exp_f32 v35, v35
  v_cvt_pk_bf16_f32 v27, v30, v31
  v_exp_f32 v40, v40
  v_exp_f32 v41, v41
  v_exp_f32 v42, v42
  v_cvt_pk_bf16_f32 v40, v40, v41
  v_exp_f32 v43, v43
  v_cvt_pk_bf16_f32 v33, v34, v35
  v_exp_f32 v48, v48
  v_exp_f32 v49, v49
  v_exp_f32 v50, v50
  v_cvt_pk_bf16_f32 v48, v48, v49
  v_exp_f32 v51, v51
  v_cvt_pk_bf16_f32 v41, v42, v43
  v_exp_f32 v56, v56
  v_exp_f32 v57, v57
  v_exp_f32 v58, v58
  v_cvt_pk_bf16_f32 v56, v56, v57
  v_exp_f32 v59, v59
  v_cvt_pk_bf16_f32 v49, v50, v51
  v_exp_f32 v36, v36
  v_exp_f32 v37, v37
  v_exp_f32 v38, v38
  v_cvt_pk_bf16_f32 v34, v36, v37
  v_exp_f32 v39, v39
  v_cvt_pk_bf16_f32 v57, v58, v59
  v_exp_f32 v44, v44
  v_exp_f32 v45, v45
  v_exp_f32 v46, v46
  v_cvt_pk_bf16_f32 v42, v44, v45
  v_exp_f32 v47, v47
  v_cvt_pk_bf16_f32 v35, v38, v39
  v_exp_f32 v52, v52
  v_exp_f32 v53, v53
  v_exp_f32 v54, v54
  v_cvt_pk_bf16_f32 v50, v52, v53
  v_exp_f32 v55, v55
  v_cvt_pk_bf16_f32 v43, v46, v47
  v_exp_f32 v60, v60
  v_exp_f32 v61, v61
  v_exp_f32 v62, v62
  v_cvt_pk_bf16_f32 v58, v60, v61
  v_exp_f32 v63, v63
  v_cvt_pk_bf16_f32 v51, v54, v55
  v_cvt_pk_bf16_f32 v59, v62, v63
  v_mfma_f32_16x16x32_bf16 v[64:67], a[128:131], v[128:131], v[192:195]
  s_add_u32 m0, s28, 98304
  v_mfma_f32_16x16x32_bf16 v[64:67], a[132:135], v[132:135], v[64:67]
  ds_read_b128 a[144:147], v212 offset:20480
  v_mfma_f32_16x16x32_bf16 v[64:67], a[136:139], v[136:139], v[64:67]
  buffer_load_dwordx4 v236, s[16:19], s29 offen offset:0 lds
  v_mfma_f32_16x16x32_bf16 v[64:67], a[140:143], v[140:143], v[64:67]
  ds_read_b128 a[148:151], v213 offset:20480
  v_mfma_f32_16x16x32_bf16 v[72:75], a[140:143], v[156:159], v[196:199]
  v_mfma_f32_16x16x32_bf16 v[72:75], a[136:139], v[152:155], v[72:75]
  ds_read_b128 a[152:155], v214 offset:20480
  v_mfma_f32_16x16x32_bf16 v[72:75], a[132:135], v[148:151], v[72:75]
  buffer_load_dwordx4 v237, s[16:19], s29 offen offset:1024 lds
  v_mfma_f32_16x16x32_bf16 v[72:75], a[128:131], v[144:147], v[72:75]
  ds_read_b128 a[156:159], v215 offset:20480
  v_mfma_f32_16x16x32_bf16 v[80:83], a[128:131], v[160:163], v[200:203]
  v_exp_f32 v64, v64
  v_mfma_f32_16x16x32_bf16 v[80:83], a[132:135], v[164:167], v[80:83]
  v_mfma_f32_16x16x32_bf16 v[80:83], a[136:139], v[168:171], v[80:83]
  v_exp_f32 v65, v65
  v_mfma_f32_16x16x32_bf16 v[80:83], a[140:143], v[172:175], v[80:83]
  v_cvt_pk_bf16_f32 v64, v64, v65
  v_mfma_f32_16x16x32_bf16 v[88:91], a[140:143], v[188:191], v[204:207]
  v_exp_f32 v66, v66
  v_mfma_f32_16x16x32_bf16 v[88:91], a[136:139], v[184:187], v[88:91]
  buffer_load_dwordx4 v236, s[16:19], s29 offen offset:2048 lds
  v_mfma_f32_16x16x32_bf16 v[88:91], a[132:135], v[180:183], v[88:91]
  s_waitcnt lgkmcnt(0)
  v_exp_f32 v67, v67
  v_mfma_f32_16x16x32_bf16 v[88:91], a[128:131], v[176:179], v[88:91]
  v_cvt_pk_bf16_f32 v65, v66, v67
  v_mfma_f32_16x16x32_bf16 v[68:71], a[144:147], v[128:131], v[192:195]
  v_exp_f32 v72, v72
  v_mfma_f32_16x16x32_bf16 v[68:71], a[148:151], v[132:135], v[68:71]
  ds_read_b128 a[128:131], v212 offset:24576
  v_mfma_f32_16x16x32_bf16 v[68:71], a[152:155], v[136:139], v[68:71]
  v_exp_f32 v73, v73
  v_mfma_f32_16x16x32_bf16 v[68:71], a[156:159], v[140:143], v[68:71]
  ds_read_b128 a[132:135], v213 offset:24576
  v_cvt_pk_bf16_f32 v72, v72, v73
  v_mfma_f32_16x16x32_bf16 v[76:79], a[156:159], v[156:159], v[196:199]
  v_exp_f32 v74, v74
  v_mfma_f32_16x16x32_bf16 v[76:79], a[152:155], v[152:155], v[76:79]
  ds_read_b128 a[136:139], v214 offset:24576
  v_mfma_f32_16x16x32_bf16 v[76:79], a[148:151], v[148:151], v[76:79]
  v_exp_f32 v75, v75
  v_mfma_f32_16x16x32_bf16 v[76:79], a[144:147], v[144:147], v[76:79]
  ds_read_b128 a[140:143], v215 offset:24576
  v_cvt_pk_bf16_f32 v73, v74, v75
  v_mfma_f32_16x16x32_bf16 v[84:87], a[144:147], v[160:163], v[200:203]
  v_exp_f32 v80, v80
  v_mfma_f32_16x16x32_bf16 v[84:87], a[148:151], v[164:167], v[84:87]
  buffer_load_dwordx4 v237, s[16:19], s29 offen offset:3072 lds
  v_mfma_f32_16x16x32_bf16 v[84:87], a[152:155], v[168:171], v[84:87]
  s_add_u32 s29, s29, 16384
  v_exp_f32 v81, v81
  v_mfma_f32_16x16x32_bf16 v[84:87], a[156:159], v[172:175], v[84:87]
  v_cvt_pk_bf16_f32 v80, v80, v81
  v_mfma_f32_16x16x32_bf16 v[92:95], a[156:159], v[188:191], v[204:207]
  s_add_u32 m0, s28, 49152
  v_exp_f32 v82, v82
  v_mfma_f32_16x16x32_bf16 v[92:95], a[152:155], v[184:187], v[92:95]
  buffer_load_dwordx4 v232, s[12:15], s29 offen offset:0 lds
  v_mfma_f32_16x16x32_bf16 v[92:95], a[148:151], v[180:183], v[92:95]
  s_waitcnt lgkmcnt(0)
  v_exp_f32 v83, v83
  v_mfma_f32_16x16x32_bf16 v[92:95], a[144:147], v[176:179], v[92:95]
  v_cvt_pk_bf16_f32 v81, v82, v83
  v_mfma_f32_16x16x32_bf16 v[96:99], a[128:131], v[128:131], v[192:195]
  v_exp_f32 v88, v88
  v_mfma_f32_16x16x32_bf16 v[96:99], a[132:135], v[132:135], v[96:99]
  ds_read_b128 a[144:147], v212 offset:28672
  v_mfma_f32_16x16x32_bf16 v[96:99], a[136:139], v[136:139], v[96:99]
  v_exp_f32 v89, v89
  v_mfma_f32_16x16x32_bf16 v[96:99], a[140:143], v[140:143], v[96:99]
  ds_read_b128 a[148:151], v213 offset:28672
  v_cvt_pk_bf16_f32 v88, v88, v89
  v_mfma_f32_16x16x32_bf16 v[104:107], a[140:143], v[156:159], v[196:199]
  v_exp_f32 v90, v90
  v_mfma_f32_16x16x32_bf16 v[104:107], a[136:139], v[152:155], v[104:107]
  ds_read_b128 a[152:155], v214 offset:28672
  v_mfma_f32_16x16x32_bf16 v[104:107], a[132:135], v[148:151], v[104:107]
  v_exp_f32 v91, v91
  v_mfma_f32_16x16x32_bf16 v[104:107], a[128:131], v[144:147], v[104:107]
  ds_read_b128 a[156:159], v215 offset:28672
  v_cvt_pk_bf16_f32 v89, v90, v91
  v_mfma_f32_16x16x32_bf16 v[112:115], a[128:131], v[160:163], v[200:203]
  v_exp_f32 v68, v68
  v_mfma_f32_16x16x32_bf16 v[112:115], a[132:135], v[164:167], v[112:115]
  buffer_load_dwordx4 v233, s[12:15], s29 offen offset:1024 lds
  v_mfma_f32_16x16x32_bf16 v[112:115], a[136:139], v[168:171], v[112:115]
  v_exp_f32 v69, v69
  v_mfma_f32_16x16x32_bf16 v[112:115], a[140:143], v[172:175], v[112:115]
  v_cvt_pk_bf16_f32 v66, v68, v69
  v_mfma_f32_16x16x32_bf16 v[120:123], a[140:143], v[188:191], v[204:207]
  v_exp_f32 v70, v70
  v_mfma_f32_16x16x32_bf16 v[120:123], a[136:139], v[184:187], v[120:123]
  buffer_load_dwordx4 v234, s[12:15], s29 offen offset:2048 lds
  v_mfma_f32_16x16x32_bf16 v[120:123], a[132:135], v[180:183], v[120:123]
  s_waitcnt lgkmcnt(0)
  v_exp_f32 v71, v71
  v_mfma_f32_16x16x32_bf16 v[120:123], a[128:131], v[176:179], v[120:123]
  v_cvt_pk_bf16_f32 v67, v70, v71
  v_mfma_f32_16x16x32_bf16 v[100:103], a[144:147], v[128:131], v[192:195]
  v_exp_f32 v76, v76
  v_mfma_f32_16x16x32_bf16 v[100:103], a[148:151], v[132:135], v[100:103]
  ds_read_b64_tr_b16 a[160:161], v216 offset:0
  v_mfma_f32_16x16x32_bf16 v[100:103], a[152:155], v[136:139], v[100:103]
  v_exp_f32 v77, v77
  v_mfma_f32_16x16x32_bf16 v[100:103], a[156:159], v[140:143], v[100:103]
  ds_read_b64_tr_b16 a[162:163], v216 offset:4096
  v_cvt_pk_bf16_f32 v74, v76, v77
  v_mfma_f32_16x16x32_bf16 v[108:111], a[156:159], v[156:159], v[196:199]
  v_exp_f32 v78, v78
  v_mfma_f32_16x16x32_bf16 v[108:111], a[152:155], v[152:155], v[108:111]
  ds_read_b64_tr_b16 a[164:165], v216 offset:8192
  buffer_load_dwordx4 v235, s[12:15], s29 offen offset:3072 lds
  v_mfma_f32_16x16x32_bf16 v[108:111], a[148:151], v[148:151], v[108:111]
  v_exp_f32 v79, v79
  v_mfma_f32_16x16x32_bf16 v[108:111], a[144:147], v[144:147], v[108:111]
  ds_read_b64_tr_b16 a[166:167], v216 offset:12288
  v_cvt_pk_bf16_f32 v75, v78, v79
  v_mfma_f32_16x16x32_bf16 v[116:119], a[144:147], v[160:163], v[200:203]
  v_exp_f32 v84, v84
  v_mfma_f32_16x16x32_bf16 v[116:119], a[148:151], v[164:167], v[116:119]
  ds_read_b64_tr_b16 a[168:169], v217 offset:0
  s_add_u32 m0, s50, 3072
  v_mfma_f32_16x16x32_bf16 v[116:119], a[152:155], v[168:171], v[116:119]
  v_exp_f32 v85, v85
  v_mfma_f32_16x16x32_bf16 v[116:119], a[156:159], v[172:175], v[116:119]
  ds_read_b64_tr_b16 a[170:171], v217 offset:4096
  v_cvt_pk_bf16_f32 v82, v84, v85
  v_mfma_f32_16x16x32_bf16 v[124:127], a[156:159], v[188:191], v[204:207]
  v_exp_f32 v86, v86
  v_mfma_f32_16x16x32_bf16 v[124:127], a[152:155], v[184:187], v[124:127]
  ds_read_b64_tr_b16 a[172:173], v217 offset:8192
  buffer_load_dwordx4 v253, s[44:47], s35 offen lds
  s_add_u32 s35, s35, 221184
  v_mfma_f32_16x16x32_bf16 v[124:127], a[148:151], v[180:183], v[124:127]
  v_exp_f32 v87, v87
  v_mfma_f32_16x16x32_bf16 v[124:127], a[144:147], v[176:179], v[124:127]
  ds_read_b64_tr_b16 a[174:175], v217 offset:12288
  v_cvt_pk_bf16_f32 v83, v86, v87
  v_mfma_f32_16x16x32_bf16 a[192:195], a[208:211], v[0:3], 0
  v_exp_f32 v92, v92
  v_mfma_f32_16x16x32_bf16 a[192:195], a[208:211], v[32:35], a[192:195]
  ds_read_b64_tr_b16 a[176:177], v218 offset:0
  v_mfma_f32_16x16x32_bf16 a[196:199], a[208:211], v[8:11], 0
  v_exp_f32 v93, v93
  v_mfma_f32_16x16x32_bf16 a[196:199], a[208:211], v[40:43], a[196:199]
  ds_read_b64_tr_b16 a[178:179], v218 offset:4096
  v_cvt_pk_bf16_f32 v90, v92, v93
  v_mfma_f32_16x16x32_bf16 a[200:203], a[208:211], v[16:19], 0
  v_exp_f32 v94, v94
  v_mfma_f32_16x16x32_bf16 a[200:203], a[208:211], v[48:51], a[200:203]
  ds_read_b64_tr_b16 a[180:181], v218 offset:8192
  v_mfma_f32_16x16x32_bf16 a[204:207], a[208:211], v[24:27], 0
  s_waitcnt lgkmcnt(7)
  v_exp_f32 v95, v95
  v_mfma_f32_16x16x32_bf16 a[204:207], a[208:211], v[56:59], a[204:207]
  ds_read_b64_tr_b16 a[182:183], v218 offset:12288
  v_cvt_pk_bf16_f32 v91, v94, v95
  v_mfma_f32_16x16x32_bf16 a[0:3], a[160:163], v[0:3], 0
  v_exp_f32 v96, v96
  v_mfma_f32_16x16x32_bf16 a[0:3], a[164:167], v[32:35], a[0:3]
  ds_read_b64_tr_b16 a[184:185], v219 offset:0
  v_mfma_f32_16x16x32_bf16 a[4:7], a[164:167], v[40:43], 0
  v_exp_f32 v97, v97
  v_mfma_f32_16x16x32_bf16 a[4:7], a[160:163], v[8:11], a[4:7]
  ds_read_b64_tr_b16 a[186:187], v219 offset:4096
  v_cvt_pk_bf16_f32 v96, v96, v97
  v_mfma_f32_16x16x32_bf16 a[8:11], a[160:163], v[16:19], 0
  v_exp_f32 v98, v98
  v_mfma_f32_16x16x32_bf16 a[8:11], a[164:167], v[48:51], a[8:11]
  ds_read_b64_tr_b16 a[188:189], v219 offset:8192
  v_mfma_f32_16x16x32_bf16 a[12:15], a[164:167], v[56:59], 0
  s_waitcnt lgkmcnt(7)
  v_exp_f32 v99, v99
  v_mfma_f32_16x16x32_bf16 a[12:15], a[160:163], v[24:27], a[12:15]
  ds_read_b64_tr_b16 a[190:191], v219 offset:12288
  v_cvt_pk_bf16_f32 v97, v98, v99
  v_mfma_f32_16x16x32_bf16 a[16:19], a[168:171], v[0:3], 0
  v_exp_f32 v104, v104
  v_mfma_f32_16x16x32_bf16 a[16:19], a[172:175], v[32:35], a[16:19]
  ds_read_b64_tr_b16 a[160:161], v220 offset:0
  v_mfma_f32_16x16x32_bf16 a[20:23], a[172:175], v[40:43], 0
  v_exp_f32 v105, v105
  v_mfma_f32_16x16x32_bf16 a[20:23], a[168:171], v[8:11], a[20:23]
  ds_read_b64_tr_b16 a[162:163], v220 offset:4096
  v_cvt_pk_bf16_f32 v104, v104, v105
  v_mfma_f32_16x16x32_bf16 a[24:27], a[168:171], v[16:19], 0
  v_exp_f32 v106, v106
  v_mfma_f32_16x16x32_bf16 a[24:27], a[172:175], v[48:51], a[24:27]
  ds_read_b64_tr_b16 a[164:165], v220 offset:8192
  v_mfma_f32_16x16x32_bf16 a[28:31], a[172:175], v[56:59], 0
  s_waitcnt lgkmcnt(7)
  v_exp_f32 v107, v107
  v_mfma_f32_16x16x32_bf16 a[28:31], a[168:171], v[24:27], a[28:31]
  ds_read_b64_tr_b16 a[166:167], v220 offset:12288
  v_cvt_pk_bf16_f32 v105, v106, v107
  v_mfma_f32_16x16x32_bf16 a[32:35], a[176:179], v[0:3], 0
  v_exp_f32 v112, v112
  v_mfma_f32_16x16x32_bf16 a[32:35], a[180:183], v[32:35], a[32:35]
  ds_read_b64_tr_b16 a[168:169], v221 offset:0
  v_mfma_f32_16x16x32_bf16 a[36:39], a[180:183], v[40:43], 0
  v_exp_f32 v113, v113
  v_mfma_f32_16x16x32_bf16 a[36:39], a[176:179], v[8:11], a[36:39]
  ds_read_b64_tr_b16 a[170:171], v221 offset:4096
  v_cvt_pk_bf16_f32 v112, v112, v113
  v_mfma_f32_16x16x32_bf16 a[40:43], a[176:179], v[16:19], 0
  v_exp_f32 v114, v114
  v_mfma_f32_16x16x32_bf16 a[40:43], a[180:183], v[48:51], a[40:43]
  ds_read_b64_tr_b16 a[172:173], v221 offset:8192
  v_mfma_f32_16x16x32_bf16 a[44:47], a[180:183], v[56:59], 0
  s_waitcnt lgkmcnt(7)
  v_exp_f32 v115, v115
  v_mfma_f32_16x16x32_bf16 a[44:47], a[176:179], v[24:27], a[44:47]
  ds_read_b64_tr_b16 a[174:175], v221 offset:12288
  v_cvt_pk_bf16_f32 v113, v114, v115
  v_mfma_f32_16x16x32_bf16 a[48:51], a[184:187], v[0:3], 0
  v_exp_f32 v120, v120
  v_mfma_f32_16x16x32_bf16 a[48:51], a[188:191], v[32:35], a[48:51]
  ds_read_b64_tr_b16 a[176:177], v222 offset:0
  v_mfma_f32_16x16x32_bf16 a[52:55], a[188:191], v[40:43], 0
  v_exp_f32 v121, v121
  v_mfma_f32_16x16x32_bf16 a[52:55], a[184:187], v[8:11], a[52:55]
  ds_read_b64_tr_b16 a[178:179], v222 offset:4096
  v_cvt_pk_bf16_f32 v120, v120, v121
  v_mfma_f32_16x16x32_bf16 a[56:59], a[184:187], v[16:19], 0
  v_exp_f32 v122, v122
  v_mfma_f32_16x16x32_bf16 a[56:59], a[188:191], v[48:51], a[56:59]
  ds_read_b64_tr_b16 a[180:181], v222 offset:8192
  v_mfma_f32_16x16x32_bf16 a[60:63], a[188:191], v[56:59], 0
  s_waitcnt lgkmcnt(7)
  v_exp_f32 v123, v123
  v_mfma_f32_16x16x32_bf16 a[60:63], a[184:187], v[24:27], a[60:63]
  ds_read_b64_tr_b16 a[182:183], v222 offset:12288
  v_cvt_pk_bf16_f32 v121, v122, v123
  v_mfma_f32_16x16x32_bf16 a[64:67], a[160:163], v[0:3], 0
  v_exp_f32 v100, v100
  v_mfma_f32_16x16x32_bf16 a[64:67], a[164:167], v[32:35], a[64:67]
  ds_read_b64_tr_b16 a[184:185], v223 offset:0
  v_mfma_f32_16x16x32_bf16 a[68:71], a[164:167], v[40:43], 0
  v_exp_f32 v101, v101
  v_mfma_f32_16x16x32_bf16 a[68:71], a[160:163], v[8:11], a[68:71]
  ds_read_b64_tr_b16 a[186:187], v223 offset:4096
  v_cvt_pk_bf16_f32 v98, v100, v101
  v_mfma_f32_16x16x32_bf16 a[72:75], a[160:163], v[16:19], 0
  v_exp_f32 v102, v102
  v_mfma_f32_16x16x32_bf16 a[72:75], a[164:167], v[48:51], a[72:75]
  ds_read_b64_tr_b16 a[188:189], v223 offset:8192
  v_mfma_f32_16x16x32_bf16 a[76:79], a[164:167], v[56:59], 0
  s_waitcnt lgkmcnt(7)
  v_exp_f32 v103, v103
  v_mfma_f32_16x16x32_bf16 a[76:79], a[160:163], v[24:27], a[76:79]
  ds_read_b64_tr_b16 a[190:191], v223 offset:12288
  v_cvt_pk_bf16_f32 v99, v102, v103
  v_mfma_f32_16x16x32_bf16 a[80:83], a[168:171], v[0:3], 0
  s_waitcnt vmcnt(10)
  v_exp_f32 v108, v108
  v_mfma_f32_16x16x32_bf16 a[80:83], a[172:175], v[32:35], a[80:83]
  v_mfma_f32_16x16x32_bf16 a[84:87], a[172:175], v[40:43], 0
  s_barrier
  v_exp_f32 v109, v109
  v_mfma_f32_16x16x32_bf16 a[84:87], a[168:171], v[8:11], a[84:87]
  ds_read_b128 a[128:131], v212 offset:32768
  v_cvt_pk_bf16_f32 v106, v108, v109
  v_mfma_f32_16x16x32_bf16 a[88:91], a[168:171], v[16:19], 0
  v_exp_f32 v110, v110
  v_mfma_f32_16x16x32_bf16 a[88:91], a[172:175], v[48:51], a[88:91]
  ds_read_b128 a[132:135], v213 offset:32768
  v_mfma_f32_16x16x32_bf16 a[92:95], a[172:175], v[56:59], 0
  s_waitcnt lgkmcnt(6)
  v_exp_f32 v111, v111
  v_mfma_f32_16x16x32_bf16 a[92:95], a[168:171], v[24:27], a[92:95]
  ds_read_b128 a[136:139], v214 offset:32768
  v_cvt_pk_bf16_f32 v107, v110, v111
  v_mfma_f32_16x16x32_bf16 a[96:99], a[176:179], v[0:3], 0
  s_mul_i32 s38, s3, 20480
  v_exp_f32 v116, v116
  v_mfma_f32_16x16x32_bf16 a[96:99], a[180:183], v[32:35], a[96:99]
  ds_read_b128 a[140:143], v215 offset:32768
  buffer_load_dwordx4 a[212:215], v243, s[24:27], s38 offen sc1
  s_add_u32 s38, s38, 4096
  v_mfma_f32_16x16x32_bf16 a[100:103], a[180:183], v[40:43], 0
  v_exp_f32 v117, v117
  v_mfma_f32_16x16x32_bf16 a[100:103], a[176:179], v[8:11], a[100:103]
  v_cvt_pk_bf16_f32 v114, v116, v117
  v_mfma_f32_16x16x32_bf16 a[104:107], a[176:179], v[16:19], 0
  v_exp_f32 v118, v118
  v_mfma_f32_16x16x32_bf16 a[104:107], a[180:183], v[48:51], a[104:107]
  v_mfma_f32_16x16x32_bf16 a[108:111], a[180:183], v[56:59], 0
  s_waitcnt lgkmcnt(4)
  v_exp_f32 v119, v119
  v_mfma_f32_16x16x32_bf16 a[108:111], a[176:179], v[24:27], a[108:111]
  v_cvt_pk_bf16_f32 v115, v118, v119
  v_mfma_f32_16x16x32_bf16 a[112:115], a[184:187], v[0:3], 0
  v_exp_f32 v124, v124
  v_mfma_f32_16x16x32_bf16 a[112:115], a[188:191], v[32:35], a[112:115]
  v_mfma_f32_16x16x32_bf16 a[116:119], a[188:191], v[40:43], 0
  v_exp_f32 v125, v125
  v_mfma_f32_16x16x32_bf16 a[116:119], a[184:187], v[8:11], a[116:119]
  v_cvt_pk_bf16_f32 v122, v124, v125
  v_mfma_f32_16x16x32_bf16 a[120:123], a[184:187], v[16:19], 0
  v_exp_f32 v126, v126
  v_mfma_f32_16x16x32_bf16 a[120:123], a[188:191], v[48:51], a[120:123]
  v_mfma_f32_16x16x32_bf16 a[124:127], a[188:191], v[56:59], 0
  s_waitcnt lgkmcnt(0)
  v_exp_f32 v127, v127
  v_mfma_f32_16x16x32_bf16 a[124:127], a[184:187], v[24:27], a[124:127]
  v_cvt_pk_bf16_f32 v123, v126, v127
  v_mfma_f32_16x16x32_bf16 v[0:3], a[128:131], v[128:131], v[192:195]
  s_add_u32 m0, s28, 114688
  v_mfma_f32_16x16x32_bf16 v[0:3], a[132:135], v[132:135], v[0:3]
  ds_read_b128 a[144:147], v212 offset:36864
  v_mfma_f32_16x16x32_bf16 v[0:3], a[136:139], v[136:139], v[0:3]
  buffer_load_dwordx4 v236, s[16:19], s29 offen offset:0 lds
  v_mfma_f32_16x16x32_bf16 v[0:3], a[140:143], v[140:143], v[0:3]
  ds_read_b128 a[148:151], v213 offset:36864
  v_mfma_f32_16x16x32_bf16 v[8:11], a[140:143], v[156:159], v[196:199]
  v_mfma_f32_16x16x32_bf16 v[8:11], a[136:139], v[152:155], v[8:11]
  ds_read_b128 a[152:155], v214 offset:36864
  v_mfma_f32_16x16x32_bf16 v[8:11], a[132:135], v[148:151], v[8:11]
  buffer_load_dwordx4 v237, s[16:19], s29 offen offset:1024 lds
  v_mfma_f32_16x16x32_bf16 v[8:11], a[128:131], v[144:147], v[8:11]
  ds_read_b128 a[156:159], v215 offset:36864
  v_mfma_f32_16x16x32_bf16 v[16:19], a[128:131], v[160:163], v[200:203]
  v_exp_f32 v0, v0
  v_mfma_f32_16x16x32_bf16 v[16:19], a[132:135], v[164:167], v[16:19]
  v_mfma_f32_16x16x32_bf16 v[16:19], a[136:139], v[168:171], v[16:19]
  v_exp_f32 v1, v1
  v_mfma_f32_16x16x32_bf16 v[16:19], a[140:143], v[172:175], v[16:19]
  v_cvt_pk_bf16_f32 v0, v0, v1
  v_mfma_f32_16x16x32_bf16 v[24:27], a[140:143], v[188:191], v[204:207]
  v_exp_f32 v2, v2
  v_mfma_f32_16x16x32_bf16 v[24:27], a[136:139], v[184:187], v[24:27]
  buffer_load_dwordx4 v236, s[16:19], s29 offen offset:2048 lds
  v_mfma_f32_16x16x32_bf16 v[24:27], a[132:135], v[180:183], v[24:27]
  s_waitcnt lgkmcnt(0)
  v_exp_f32 v3, v3
  v_mfma_f32_16x16x32_bf16 v[24:27], a[128:131], v[176:179], v[24:27]
  v_cvt_pk_bf16_f32 v1, v2, v3
  v_mfma_f32_16x16x32_bf16 v[4:7], a[144:147], v[128:131], v[192:195]
  v_exp_f32 v8, v8
  v_mfma_f32_16x16x32_bf16 v[4:7], a[148:151], v[132:135], v[4:7]
  ds_read_b128 a[128:131], v212 offset:40960
  v_mfma_f32_16x16x32_bf16 v[4:7], a[152:155], v[136:139], v[4:7]
  v_exp_f32 v9, v9
  v_mfma_f32_16x16x32_bf16 v[4:7], a[156:159], v[140:143], v[4:7]
  ds_read_b128 a[132:135], v213 offset:40960
  v_cvt_pk_bf16_f32 v8, v8, v9
  v_mfma_f32_16x16x32_bf16 v[12:15], a[156:159], v[156:159], v[196:199]
  v_exp_f32 v10, v10
  v_mfma_f32_16x16x32_bf16 v[12:15], a[152:155], v[152:155], v[12:15]
  ds_read_b128 a[136:139], v214 offset:40960
  v_mfma_f32_16x16x32_bf16 v[12:15], a[148:151], v[148:151], v[12:15]
  v_exp_f32 v11, v11
  v_mfma_f32_16x16x32_bf16 v[12:15], a[144:147], v[144:147], v[12:15]
  ds_read_b128 a[140:143], v215 offset:40960
  v_cvt_pk_bf16_f32 v9, v10, v11
  v_mfma_f32_16x16x32_bf16 v[20:23], a[144:147], v[160:163], v[200:203]
  v_exp_f32 v16, v16
  v_mfma_f32_16x16x32_bf16 v[20:23], a[148:151], v[164:167], v[20:23]
  buffer_load_dwordx4 v237, s[16:19], s29 offen offset:3072 lds
  v_mfma_f32_16x16x32_bf16 v[20:23], a[152:155], v[168:171], v[20:23]
  s_add_u32 s29, s29, 16384
  v_exp_f32 v17, v17
  v_mfma_f32_16x16x32_bf16 v[20:23], a[156:159], v[172:175], v[20:23]
  v_cvt_pk_bf16_f32 v16, v16, v17
  v_mfma_f32_16x16x32_bf16 v[28:31], a[156:159], v[188:191], v[204:207]
  s_add_u32 m0, s28, 0
  v_exp_f32 v18, v18
  v_mfma_f32_16x16x32_bf16 v[28:31], a[152:155], v[184:187], v[28:31]
  buffer_load_dwordx4 v232, s[12:15], s29 offen offset:0 lds
  v_mfma_f32_16x16x32_bf16 v[28:31], a[148:151], v[180:183], v[28:31]
  s_waitcnt lgkmcnt(0)
  v_exp_f32 v19, v19
  v_mfma_f32_16x16x32_bf16 v[28:31], a[144:147], v[176:179], v[28:31]
  v_cvt_pk_bf16_f32 v17, v18, v19
  v_mfma_f32_16x16x32_bf16 v[32:35], a[128:131], v[128:131], v[192:195]
  v_exp_f32 v24, v24
  v_mfma_f32_16x16x32_bf16 v[32:35], a[132:135], v[132:135], v[32:35]
  ds_read_b128 a[144:147], v212 offset:45056
  v_mfma_f32_16x16x32_bf16 v[32:35], a[136:139], v[136:139], v[32:35]
  v_exp_f32 v25, v25
  v_mfma_f32_16x16x32_bf16 v[32:35], a[140:143], v[140:143], v[32:35]
  ds_read_b128 a[148:151], v213 offset:45056
  v_cvt_pk_bf16_f32 v24, v24, v25
  v_mfma_f32_16x16x32_bf16 v[40:43], a[140:143], v[156:159], v[196:199]
  v_exp_f32 v26, v26
  v_mfma_f32_16x16x32_bf16 v[40:43], a[136:139], v[152:155], v[40:43]
  ds_read_b128 a[152:155], v214 offset:45056
  v_mfma_f32_16x16x32_bf16 v[40:43], a[132:135], v[148:151], v[40:43]
  v_exp_f32 v27, v27
  v_mfma_f32_16x16x32_bf16 v[40:43], a[128:131], v[144:147], v[40:43]
  ds_read_b128 a[156:159], v215 offset:45056
  v_cvt_pk_bf16_f32 v25, v26, v27
  v_mfma_f32_16x16x32_bf16 v[48:51], a[128:131], v[160:163], v[200:203]
  v_exp_f32 v4, v4
  v_mfma_f32_16x16x32_bf16 v[48:51], a[132:135], v[164:167], v[48:51]
  buffer_load_dwordx4 v233, s[12:15], s29 offen offset:1024 lds
  v_mfma_f32_16x16x32_bf16 v[48:51], a[136:139], v[168:171], v[48:51]
  v_exp_f32 v5, v5
  v_mfma_f32_16x16x32_bf16 v[48:51], a[140:143], v[172:175], v[48:51]
  v_cvt_pk_bf16_f32 v2, v4, v5
  v_mfma_f32_16x16x32_bf16 v[56:59], a[140:143], v[188:191], v[204:207]
  v_exp_f32 v6, v6
  v_mfma_f32_16x16x32_bf16 v[56:59], a[136:139], v[184:187], v[56:59]
  buffer_load_dwordx4 v234, s[12:15], s29 offen offset:2048 lds
  v_mfma_f32_16x16x32_bf16 v[56:59], a[132:135], v[180:183], v[56:59]
  s_waitcnt lgkmcnt(0)
  v_exp_f32 v7, v7
  v_mfma_f32_16x16x32_bf16 v[56:59], a[128:131], v[176:179], v[56:59]
  v_cvt_pk_bf16_f32 v3, v6, v7
  v_mfma_f32_16x16x32_bf16 v[36:39], a[144:147], v[128:131], v[192:195]
  v_exp_f32 v12, v12
  v_mfma_f32_16x16x32_bf16 v[36:39], a[148:151], v[132:135], v[36:39]
  ds_read_b64_tr_b16 a[160:161], v216 offset:16384
  v_mfma_f32_16x16x32_bf16 v[36:39], a[152:155], v[136:139], v[36:39]
  v_exp_f32 v13, v13
  v_mfma_f32_16x16x32_bf16 v[36:39], a[156:159], v[140:143], v[36:39]
  ds_read_b64_tr_b16 a[162:163], v216 offset:20480
  v_cvt_pk_bf16_f32 v10, v12, v13
  v_mfma_f32_16x16x32_bf16 v[44:47], a[156:159], v[156:159], v[196:199]
  v_exp_f32 v14, v14
  v_mfma_f32_16x16x32_bf16 v[44:47], a[152:155], v[152:155], v[44:47]
  ds_read_b64_tr_b16 a[164:165], v216 offset:24576
  buffer_load_dwordx4 v235, s[12:15], s29 offen offset:3072 lds
  v_mfma_f32_16x16x32_bf16 v[44:47], a[148:151], v[148:151], v[44:47]
  v_exp_f32 v15, v15
  v_mfma_f32_16x16x32_bf16 v[44:47], a[144:147], v[144:147], v[44:47]
  ds_read_b64_tr_b16 a[166:167], v216 offset:28672
  v_cvt_pk_bf16_f32 v11, v14, v15
  v_mfma_f32_16x16x32_bf16 v[52:55], a[144:147], v[160:163], v[200:203]
  v_exp_f32 v20, v20
  v_mfma_f32_16x16x32_bf16 v[52:55], a[148:151], v[164:167], v[52:55]
  ds_read_b64_tr_b16 a[168:169], v217 offset:16384
  s_add_u32 m0, s50, 1024
  v_mfma_f32_16x16x32_bf16 v[52:55], a[152:155], v[168:171], v[52:55]
  v_exp_f32 v21, v21
  v_mfma_f32_16x16x32_bf16 v[52:55], a[156:159], v[172:175], v[52:55]
  ds_read_b64_tr_b16 a[170:171], v217 offset:20480
  v_cvt_pk_bf16_f32 v18, v20, v21
  v_mfma_f32_16x16x32_bf16 v[60:63], a[156:159], v[188:191], v[204:207]
  v_exp_f32 v22, v22
  v_mfma_f32_16x16x32_bf16 v[60:63], a[152:155], v[184:187], v[60:63]
  ds_read_b64_tr_b16 a[172:173], v217 offset:24576
  buffer_load_dwordx4 v253, s[20:23], s35 offen lds
  v_mfma_f32_16x16x32_bf16 v[60:63], a[148:151], v[180:183], v[60:63]
  v_exp_f32 v23, v23
  v_mfma_f32_16x16x32_bf16 v[60:63], a[144:147], v[176:179], v[60:63]
  ds_read_b64_tr_b16 a[174:175], v217 offset:28672
  v_cvt_pk_bf16_f32 v19, v22, v23
  v_mfma_f32_16x16x32_bf16 a[192:195], a[208:211], v[64:67], a[192:195]
  v_exp_f32 v28, v28
  v_mfma_f32_16x16x32_bf16 a[192:195], a[208:211], v[96:99], a[192:195]
  ds_read_b64_tr_b16 a[176:177], v218 offset:16384
  v_mfma_f32_16x16x32_bf16 a[196:199], a[208:211], v[72:75], a[196:199]
  v_exp_f32 v29, v29
  v_mfma_f32_16x16x32_bf16 a[196:199], a[208:211], v[104:107], a[196:199]
  ds_read_b64_tr_b16 a[178:179], v218 offset:20480
  v_cvt_pk_bf16_f32 v26, v28, v29
  v_mfma_f32_16x16x32_bf16 a[200:203], a[208:211], v[80:83], a[200:203]
  v_exp_f32 v30, v30
  v_mfma_f32_16x16x32_bf16 a[200:203], a[208:211], v[112:115], a[200:203]
  ds_read_b64_tr_b16 a[180:181], v218 offset:24576
  v_mfma_f32_16x16x32_bf16 a[204:207], a[208:211], v[88:91], a[204:207]
  s_waitcnt lgkmcnt(7)
  v_exp_f32 v31, v31
  v_mfma_f32_16x16x32_bf16 a[204:207], a[208:211], v[120:123], a[204:207]
  ds_read_b64_tr_b16 a[182:183], v218 offset:28672
  v_cvt_pk_bf16_f32 v27, v30, v31
  v_mfma_f32_16x16x32_bf16 a[0:3], a[160:163], v[64:67], a[0:3]
  v_exp_f32 v32, v32
  v_mfma_f32_16x16x32_bf16 a[0:3], a[164:167], v[96:99], a[0:3]
  ds_read_b64_tr_b16 a[184:185], v219 offset:16384
  v_mfma_f32_16x16x32_bf16 a[4:7], a[164:167], v[104:107], a[4:7]
  v_exp_f32 v33, v33
  v_mfma_f32_16x16x32_bf16 a[4:7], a[160:163], v[72:75], a[4:7]
  ds_read_b64_tr_b16 a[186:187], v219 offset:20480
  v_cvt_pk_bf16_f32 v32, v32, v33
  v_mfma_f32_16x16x32_bf16 a[8:11], a[160:163], v[80:83], a[8:11]
  v_exp_f32 v34, v34
  v_mfma_f32_16x16x32_bf16 a[8:11], a[164:167], v[112:115], a[8:11]
  ds_read_b64_tr_b16 a[188:189], v219 offset:24576
  v_mfma_f32_16x16x32_bf16 a[12:15], a[164:167], v[120:123], a[12:15]
  s_waitcnt lgkmcnt(7)
  v_exp_f32 v35, v35
  v_mfma_f32_16x16x32_bf16 a[12:15], a[160:163], v[88:91], a[12:15]
  ds_read_b64_tr_b16 a[190:191], v219 offset:28672
  v_cvt_pk_bf16_f32 v33, v34, v35
  v_mfma_f32_16x16x32_bf16 a[16:19], a[168:171], v[64:67], a[16:19]
  v_exp_f32 v40, v40
  v_mfma_f32_16x16x32_bf16 a[16:19], a[172:175], v[96:99], a[16:19]
  ds_read_b64_tr_b16 a[160:161], v220 offset:16384
  v_mfma_f32_16x16x32_bf16 a[20:23], a[172:175], v[104:107], a[20:23]
  v_exp_f32 v41, v41
  v_mfma_f32_16x16x32_bf16 a[20:23], a[168:171], v[72:75], a[20:23]
  ds_read_b64_tr_b16 a[162:163], v220 offset:20480
  v_cvt_pk_bf16_f32 v40, v40, v41
  v_mfma_f32_16x16x32_bf16 a[24:27], a[168:171], v[80:83], a[24:27]
  v_exp_f32 v42, v42
  v_mfma_f32_16x16x32_bf16 a[24:27], a[172:175], v[112:115], a[24:27]
  ds_read_b64_tr_b16 a[164:165], v220 offset:24576
  v_mfma_f32_16x16x32_bf16 a[28:31], a[172:175], v[120:123], a[28:31]
  s_waitcnt lgkmcnt(7)
  v_exp_f32 v43, v43
  v_mfma_f32_16x16x32_bf16 a[28:31], a[168:171], v[88:91], a[28:31]
  ds_read_b64_tr_b16 a[166:167], v220 offset:28672
  v_cvt_pk_bf16_f32 v41, v42, v43
  v_mfma_f32_16x16x32_bf16 a[32:35], a[176:179], v[64:67], a[32:35]
  v_exp_f32 v48, v48
  v_mfma_f32_16x16x32_bf16 a[32:35], a[180:183], v[96:99], a[32:35]
  ds_read_b64_tr_b16 a[168:169], v221 offset:16384
  v_mfma_f32_16x16x32_bf16 a[36:39], a[180:183], v[104:107], a[36:39]
  v_exp_f32 v49, v49
  v_mfma_f32_16x16x32_bf16 a[36:39], a[176:179], v[72:75], a[36:39]
  ds_read_b64_tr_b16 a[170:171], v221 offset:20480
  v_cvt_pk_bf16_f32 v48, v48, v49
  v_mfma_f32_16x16x32_bf16 a[40:43], a[176:179], v[80:83], a[40:43]
  v_exp_f32 v50, v50
  v_mfma_f32_16x16x32_bf16 a[40:43], a[180:183], v[112:115], a[40:43]
  ds_read_b64_tr_b16 a[172:173], v221 offset:24576
  v_mfma_f32_16x16x32_bf16 a[44:47], a[180:183], v[120:123], a[44:47]
  s_waitcnt lgkmcnt(7)
  v_exp_f32 v51, v51
  v_mfma_f32_16x16x32_bf16 a[44:47], a[176:179], v[88:91], a[44:47]
  ds_read_b64_tr_b16 a[174:175], v221 offset:28672
  v_cvt_pk_bf16_f32 v49, v50, v51
  v_mfma_f32_16x16x32_bf16 a[48:51], a[184:187], v[64:67], a[48:51]
  v_exp_f32 v56, v56
  v_mfma_f32_16x16x32_bf16 a[48:51], a[188:191], v[96:99], a[48:51]
  ds_read_b64_tr_b16 a[176:177], v222 offset:16384
  v_mfma_f32_16x16x32_bf16 a[52:55], a[188:191], v[104:107], a[52:55]
  v_exp_f32 v57, v57
  v_mfma_f32_16x16x32_bf16 a[52:55], a[184:187], v[72:75], a[52:55]
  ds_read_b64_tr_b16 a[178:179], v222 offset:20480
  v_cvt_pk_bf16_f32 v56, v56, v57
  v_mfma_f32_16x16x32_bf16 a[56:59], a[184:187], v[80:83], a[56:59]
  v_exp_f32 v58, v58
  v_mfma_f32_16x16x32_bf16 a[56:59], a[188:191], v[112:115], a[56:59]
  ds_read_b64_tr_b16 a[180:181], v222 offset:24576
  v_mfma_f32_16x16x32_bf16 a[60:63], a[188:191], v[120:123], a[60:63]
  s_waitcnt lgkmcnt(7)
  v_exp_f32 v59, v59
  v_mfma_f32_16x16x32_bf16 a[60:63], a[184:187], v[88:91], a[60:63]
  ds_read_b64_tr_b16 a[182:183], v222 offset:28672
  v_cvt_pk_bf16_f32 v57, v58, v59
  v_mfma_f32_16x16x32_bf16 a[64:67], a[160:163], v[64:67], a[64:67]
  v_exp_f32 v36, v36
  v_mfma_f32_16x16x32_bf16 a[64:67], a[164:167], v[96:99], a[64:67]
  ds_read_b64_tr_b16 a[184:185], v223 offset:16384
  v_mfma_f32_16x16x32_bf16 a[68:71], a[164:167], v[104:107], a[68:71]
  v_exp_f32 v37, v37
  v_mfma_f32_16x16x32_bf16 a[68:71], a[160:163], v[72:75], a[68:71]
  ds_read_b64_tr_b16 a[186:187], v223 offset:20480
  v_cvt_pk_bf16_f32 v34, v36, v37
  v_mfma_f32_16x16x32_bf16 a[72:75], a[160:163], v[80:83], a[72:75]
  v_exp_f32 v38, v38
  v_mfma_f32_16x16x32_bf16 a[72:75], a[164:167], v[112:115], a[72:75]
  ds_read_b64_tr_b16 a[188:189], v223 offset:24576
  v_mfma_f32_16x16x32_bf16 a[76:79], a[164:167], v[120:123], a[76:79]
  s_waitcnt lgkmcnt(7)
  v_exp_f32 v39, v39
  v_mfma_f32_16x16x32_bf16 a[76:79], a[160:163], v[88:91], a[76:79]
  ds_read_b64_tr_b16 a[190:191], v223 offset:28672
  v_cvt_pk_bf16_f32 v35, v38, v39
  v_mfma_f32_16x16x32_bf16 a[80:83], a[168:171], v[64:67], a[80:83]
  s_waitcnt vmcnt(11)
  v_exp_f32 v44, v44
  v_mfma_f32_16x16x32_bf16 a[80:83], a[172:175], v[96:99], a[80:83]
  v_mfma_f32_16x16x32_bf16 a[84:87], a[172:175], v[104:107], a[84:87]
  s_barrier
  v_exp_f32 v45, v45
  v_mfma_f32_16x16x32_bf16 a[84:87], a[168:171], v[72:75], a[84:87]
  ds_read_b128 a[128:131], v212 offset:49152
  v_cvt_pk_bf16_f32 v42, v44, v45
  v_mfma_f32_16x16x32_bf16 a[88:91], a[168:171], v[80:83], a[88:91]
  v_exp_f32 v46, v46
  v_mfma_f32_16x16x32_bf16 a[88:91], a[172:175], v[112:115], a[88:91]
  ds_read_b128 a[132:135], v213 offset:49152
  v_mfma_f32_16x16x32_bf16 a[92:95], a[172:175], v[120:123], a[92:95]
  s_waitcnt lgkmcnt(6)
  v_exp_f32 v47, v47
  v_mfma_f32_16x16x32_bf16 a[92:95], a[168:171], v[88:91], a[92:95]
  ds_read_b128 a[136:139], v214 offset:49152
  v_cvt_pk_bf16_f32 v43, v46, v47
  v_mfma_f32_16x16x32_bf16 a[96:99], a[176:179], v[64:67], a[96:99]
  v_exp_f32 v52, v52
  v_mfma_f32_16x16x32_bf16 a[96:99], a[180:183], v[96:99], a[96:99]
  ds_read_b128 a[140:143], v215 offset:49152
  buffer_load_dwordx4 a[216:219], v243, s[24:27], s38 offen sc1
  s_add_u32 s38, s38, 4096
  v_mfma_f32_16x16x32_bf16 a[100:103], a[180:183], v[104:107], a[100:103]
  v_exp_f32 v53, v53
  v_mfma_f32_16x16x32_bf16 a[100:103], a[176:179], v[72:75], a[100:103]
  v_cvt_pk_bf16_f32 v50, v52, v53
  v_mfma_f32_16x16x32_bf16 a[104:107], a[176:179], v[80:83], a[104:107]
  v_exp_f32 v54, v54
  v_mfma_f32_16x16x32_bf16 a[104:107], a[180:183], v[112:115], a[104:107]
  v_mfma_f32_16x16x32_bf16 a[108:111], a[180:183], v[120:123], a[108:111]
  s_waitcnt lgkmcnt(4)
  v_exp_f32 v55, v55
  v_mfma_f32_16x16x32_bf16 a[108:111], a[176:179], v[88:91], a[108:111]
  v_cvt_pk_bf16_f32 v51, v54, v55
  v_mfma_f32_16x16x32_bf16 a[112:115], a[184:187], v[64:67], a[112:115]
  v_exp_f32 v60, v60
  v_mfma_f32_16x16x32_bf16 a[112:115], a[188:191], v[96:99], a[112:115]
  v_mfma_f32_16x16x32_bf16 a[116:119], a[188:191], v[104:107], a[116:119]
  v_exp_f32 v61, v61
  v_mfma_f32_16x16x32_bf16 a[116:119], a[184:187], v[72:75], a[116:119]
  v_cvt_pk_bf16_f32 v58, v60, v61
  v_mfma_f32_16x16x32_bf16 a[120:123], a[184:187], v[80:83], a[120:123]
  v_exp_f32 v62, v62
  v_mfma_f32_16x16x32_bf16 a[120:123], a[188:191], v[112:115], a[120:123]
  v_mfma_f32_16x16x32_bf16 a[124:127], a[188:191], v[120:123], a[124:127]
  s_waitcnt lgkmcnt(0)
  v_exp_f32 v63, v63
  v_mfma_f32_16x16x32_bf16 a[124:127], a[184:187], v[88:91], a[124:127]
  v_cvt_pk_bf16_f32 v59, v62, v63
  v_mfma_f32_16x16x32_bf16 v[64:67], a[128:131], v[128:131], v[192:195]
  s_add_u32 m0, s28, 65536
  v_mfma_f32_16x16x32_bf16 v[64:67], a[132:135], v[132:135], v[64:67]
  ds_read_b128 a[144:147], v212 offset:53248
  v_mfma_f32_16x16x32_bf16 v[64:67], a[136:139], v[136:139], v[64:67]
  buffer_load_dwordx4 v236, s[16:19], s29 offen offset:0 lds
  v_mfma_f32_16x16x32_bf16 v[64:67], a[140:143], v[140:143], v[64:67]
  ds_read_b128 a[148:151], v213 offset:53248
  v_mfma_f32_16x16x32_bf16 v[72:75], a[140:143], v[156:159], v[196:199]
  v_mfma_f32_16x16x32_bf16 v[72:75], a[136:139], v[152:155], v[72:75]
  ds_read_b128 a[152:155], v214 offset:53248
  v_mfma_f32_16x16x32_bf16 v[72:75], a[132:135], v[148:151], v[72:75]
  buffer_load_dwordx4 v237, s[16:19], s29 offen offset:1024 lds
  v_mfma_f32_16x16x32_bf16 v[72:75], a[128:131], v[144:147], v[72:75]
  ds_read_b128 a[156:159], v215 offset:53248
  v_mfma_f32_16x16x32_bf16 v[80:83], a[128:131], v[160:163], v[200:203]
  v_exp_f32 v64, v64
  v_mfma_f32_16x16x32_bf16 v[80:83], a[132:135], v[164:167], v[80:83]
  v_mfma_f32_16x16x32_bf16 v[80:83], a[136:139], v[168:171], v[80:83]
  v_exp_f32 v65, v65
  v_mfma_f32_16x16x32_bf16 v[80:83], a[140:143], v[172:175], v[80:83]
  v_cvt_pk_bf16_f32 v64, v64, v65
  v_mfma_f32_16x16x32_bf16 v[88:91], a[140:143], v[188:191], v[204:207]
  v_exp_f32 v66, v66
  v_mfma_f32_16x16x32_bf16 v[88:91], a[136:139], v[184:187], v[88:91]
  buffer_load_dwordx4 v236, s[16:19], s29 offen offset:2048 lds
  v_mfma_f32_16x16x32_bf16 v[88:91], a[132:135], v[180:183], v[88:91]
  s_waitcnt lgkmcnt(0)
  v_exp_f32 v67, v67
  v_mfma_f32_16x16x32_bf16 v[88:91], a[128:131], v[176:179], v[88:91]
  v_cvt_pk_bf16_f32 v65, v66, v67
  v_mfma_f32_16x16x32_bf16 v[68:71], a[144:147], v[128:131], v[192:195]
  v_exp_f32 v72, v72
  v_mfma_f32_16x16x32_bf16 v[68:71], a[148:151], v[132:135], v[68:71]
  ds_read_b128 a[128:131], v212 offset:57344
  v_mfma_f32_16x16x32_bf16 v[68:71], a[152:155], v[136:139], v[68:71]
  v_exp_f32 v73, v73
  v_mfma_f32_16x16x32_bf16 v[68:71], a[156:159], v[140:143], v[68:71]
  ds_read_b128 a[132:135], v213 offset:57344
  v_cvt_pk_bf16_f32 v72, v72, v73
  v_mfma_f32_16x16x32_bf16 v[76:79], a[156:159], v[156:159], v[196:199]
  v_exp_f32 v74, v74
  v_mfma_f32_16x16x32_bf16 v[76:79], a[152:155], v[152:155], v[76:79]
  ds_read_b128 a[136:139], v214 offset:57344
  v_mfma_f32_16x16x32_bf16 v[76:79], a[148:151], v[148:151], v[76:79]
  v_exp_f32 v75, v75
  v_mfma_f32_16x16x32_bf16 v[76:79], a[144:147], v[144:147], v[76:79]
  ds_read_b128 a[140:143], v215 offset:57344
  v_cvt_pk_bf16_f32 v73, v74, v75
  v_mfma_f32_16x16x32_bf16 v[84:87], a[144:147], v[160:163], v[200:203]
  v_exp_f32 v80, v80
  v_mfma_f32_16x16x32_bf16 v[84:87], a[148:151], v[164:167], v[84:87]
  buffer_load_dwordx4 v237, s[16:19], s29 offen offset:3072 lds
  v_mfma_f32_16x16x32_bf16 v[84:87], a[152:155], v[168:171], v[84:87]
  s_add_u32 s29, s29, 16384
  v_exp_f32 v81, v81
  v_mfma_f32_16x16x32_bf16 v[84:87], a[156:159], v[172:175], v[84:87]
  v_cvt_pk_bf16_f32 v80, v80, v81
  v_mfma_f32_16x16x32_bf16 v[92:95], a[156:159], v[188:191], v[204:207]
  s_add_u32 m0, s28, 16384
  v_exp_f32 v82, v82
  v_mfma_f32_16x16x32_bf16 v[92:95], a[152:155], v[184:187], v[92:95]
  buffer_load_dwordx4 v232, s[12:15], s29 offen offset:0 lds
  v_mfma_f32_16x16x32_bf16 v[92:95], a[148:151], v[180:183], v[92:95]
  s_waitcnt lgkmcnt(0)
  v_exp_f32 v83, v83
  v_mfma_f32_16x16x32_bf16 v[92:95], a[144:147], v[176:179], v[92:95]
  v_cvt_pk_bf16_f32 v81, v82, v83
  v_mfma_f32_16x16x32_bf16 v[96:99], a[128:131], v[128:131], v[192:195]
  v_exp_f32 v88, v88
  v_mfma_f32_16x16x32_bf16 v[96:99], a[132:135], v[132:135], v[96:99]
  ds_read_b128 a[144:147], v212 offset:61440
  v_mfma_f32_16x16x32_bf16 v[96:99], a[136:139], v[136:139], v[96:99]
  v_exp_f32 v89, v89
  v_mfma_f32_16x16x32_bf16 v[96:99], a[140:143], v[140:143], v[96:99]
  ds_read_b128 a[148:151], v213 offset:61440
  v_cvt_pk_bf16_f32 v88, v88, v89
  v_mfma_f32_16x16x32_bf16 v[104:107], a[140:143], v[156:159], v[196:199]
  v_exp_f32 v90, v90
  v_mfma_f32_16x16x32_bf16 v[104:107], a[136:139], v[152:155], v[104:107]
  ds_read_b128 a[152:155], v214 offset:61440
  v_mfma_f32_16x16x32_bf16 v[104:107], a[132:135], v[148:151], v[104:107]
  v_exp_f32 v91, v91
  v_mfma_f32_16x16x32_bf16 v[104:107], a[128:131], v[144:147], v[104:107]
  ds_read_b128 a[156:159], v215 offset:61440
  v_cvt_pk_bf16_f32 v89, v90, v91
  v_mfma_f32_16x16x32_bf16 v[112:115], a[128:131], v[160:163], v[200:203]
  v_exp_f32 v68, v68
  v_mfma_f32_16x16x32_bf16 v[112:115], a[132:135], v[164:167], v[112:115]
  buffer_load_dwordx4 v233, s[12:15], s29 offen offset:1024 lds
  v_mfma_f32_16x16x32_bf16 v[112:115], a[136:139], v[168:171], v[112:115]
  v_exp_f32 v69, v69
  v_mfma_f32_16x16x32_bf16 v[112:115], a[140:143], v[172:175], v[112:115]
  v_cvt_pk_bf16_f32 v66, v68, v69
  v_mfma_f32_16x16x32_bf16 v[120:123], a[140:143], v[188:191], v[204:207]
  v_exp_f32 v70, v70
  v_mfma_f32_16x16x32_bf16 v[120:123], a[136:139], v[184:187], v[120:123]
  buffer_load_dwordx4 v234, s[12:15], s29 offen offset:2048 lds
  v_mfma_f32_16x16x32_bf16 v[120:123], a[132:135], v[180:183], v[120:123]
  s_waitcnt lgkmcnt(0)
  v_exp_f32 v71, v71
  v_mfma_f32_16x16x32_bf16 v[120:123], a[128:131], v[176:179], v[120:123]
  v_cvt_pk_bf16_f32 v67, v70, v71
  v_mfma_f32_16x16x32_bf16 v[100:103], a[144:147], v[128:131], v[192:195]
  v_exp_f32 v76, v76
  v_mfma_f32_16x16x32_bf16 v[100:103], a[148:151], v[132:135], v[100:103]
  ds_read_b64_tr_b16 a[160:161], v216 offset:32768
  v_mfma_f32_16x16x32_bf16 v[100:103], a[152:155], v[136:139], v[100:103]
  v_exp_f32 v77, v77
  v_mfma_f32_16x16x32_bf16 v[100:103], a[156:159], v[140:143], v[100:103]
  ds_read_b64_tr_b16 a[162:163], v216 offset:36864
  v_cvt_pk_bf16_f32 v74, v76, v77
  v_mfma_f32_16x16x32_bf16 v[108:111], a[156:159], v[156:159], v[196:199]
  v_exp_f32 v78, v78
  v_mfma_f32_16x16x32_bf16 v[108:111], a[152:155], v[152:155], v[108:111]
  ds_read_b64_tr_b16 a[164:165], v216 offset:40960
  buffer_load_dwordx4 v235, s[12:15], s29 offen offset:3072 lds
  v_mfma_f32_16x16x32_bf16 v[108:111], a[148:151], v[148:151], v[108:111]
  v_exp_f32 v79, v79
  v_mfma_f32_16x16x32_bf16 v[108:111], a[144:147], v[144:147], v[108:111]
  ds_read_b64_tr_b16 a[166:167], v216 offset:45056
  v_cvt_pk_bf16_f32 v75, v78, v79
  v_mfma_f32_16x16x32_bf16 v[116:119], a[144:147], v[160:163], v[200:203]
  v_exp_f32 v84, v84
  v_mfma_f32_16x16x32_bf16 v[116:119], a[148:151], v[164:167], v[116:119]
  ds_read_b64_tr_b16 a[168:169], v217 offset:32768
  s_add_u32 m0, s50, 4096
  v_mfma_f32_16x16x32_bf16 v[116:119], a[152:155], v[168:171], v[116:119]
  v_exp_f32 v85, v85
  v_mfma_f32_16x16x32_bf16 v[116:119], a[156:159], v[172:175], v[116:119]
  ds_read_b64_tr_b16 a[170:171], v217 offset:36864
  v_cvt_pk_bf16_f32 v82, v84, v85
  v_mfma_f32_16x16x32_bf16 v[124:127], a[156:159], v[188:191], v[204:207]
  v_exp_f32 v86, v86
  v_mfma_f32_16x16x32_bf16 v[124:127], a[152:155], v[184:187], v[124:127]
  ds_read_b64_tr_b16 a[172:173], v217 offset:40960
  buffer_load_dwordx4 v253, s[44:47], s35 offen lds
  s_add_u32 s35, s35, 221184
  v_mfma_f32_16x16x32_bf16 v[124:127], a[148:151], v[180:183], v[124:127]
  v_exp_f32 v87, v87
  v_mfma_f32_16x16x32_bf16 v[124:127], a[144:147], v[176:179], v[124:127]
  ds_read_b64_tr_b16 a[174:175], v217 offset:45056
  v_cvt_pk_bf16_f32 v83, v86, v87
  v_mfma_f32_16x16x32_bf16 a[192:195], a[208:211], v[0:3], a[192:195]
  v_exp_f32 v92, v92
  v_mfma_f32_16x16x32_bf16 a[192:195], a[208:211], v[32:35], a[192:195]
  ds_read_b64_tr_b16 a[176:177], v218 offset:32768
  v_lshrrev_b32 v254, 4, v242
  v_mfma_f32_16x16x32_bf16 a[196:199], a[208:211], v[8:11], a[196:199]
  v_exp_f32 v93, v93
  v_mfma_f32_16x16x32_bf16 a[196:199], a[208:211], v[40:43], a[196:199]
  ds_read_b64_tr_b16 a[178:179], v218 offset:36864
  v_cvt_pk_bf16_f32 v90, v92, v93
  v_mfma_f32_16x16x32_bf16 a[200:203], a[208:211], v[16:19], a[200:203]
  v_exp_f32 v94, v94
  v_mfma_f32_16x16x32_bf16 a[200:203], a[208:211], v[48:51], a[200:203]
  ds_read_b64_tr_b16 a[180:181], v218 offset:40960
  v_lshrrev_b32 v254, 5, v254
  v_mfma_f32_16x16x32_bf16 a[204:207], a[208:211], v[24:27], a[204:207]
  s_waitcnt lgkmcnt(7)
  v_exp_f32 v95, v95
  v_mfma_f32_16x16x32_bf16 a[204:207], a[208:211], v[56:59], a[204:207]
  ds_read_b64_tr_b16 a[182:183], v218 offset:45056
  v_cvt_pk_bf16_f32 v91, v94, v95
  v_mfma_f32_16x16x32_bf16 a[0:3], a[160:163], v[0:3], a[0:3]
  v_exp_f32 v96, v96
  v_mfma_f32_16x16x32_bf16 a[0:3], a[164:167], v[32:35], a[0:3]
  ds_read_b64_tr_b16 a[184:185], v219 offset:32768
  v_lshl_add_u32 v253, v254, 30, v253
  v_mfma_f32_16x16x32_bf16 a[4:7], a[164:167], v[40:43], a[4:7]
  v_exp_f32 v97, v97
  v_mfma_f32_16x16x32_bf16 a[4:7], a[160:163], v[8:11], a[4:7]
  ds_read_b64_tr_b16 a[186:187], v219 offset:36864
  v_cvt_pk_bf16_f32 v96, v96, v97
  v_mfma_f32_16x16x32_bf16 a[8:11], a[160:163], v[16:19], a[8:11]
  v_exp_f32 v98, v98
  v_mfma_f32_16x16x32_bf16 a[8:11], a[164:167], v[48:51], a[8:11]
  ds_read_b64_tr_b16 a[188:189], v219 offset:40960
  v_mfma_f32_16x16x32_bf16 a[12:15], a[164:167], v[56:59], a[12:15]
  s_waitcnt lgkmcnt(7)
  v_exp_f32 v99, v99
  v_mfma_f32_16x16x32_bf16 a[12:15], a[160:163], v[24:27], a[12:15]
  ds_read_b64_tr_b16 a[190:191], v219 offset:45056
  v_cvt_pk_bf16_f32 v97, v98, v99
  v_mfma_f32_16x16x32_bf16 a[16:19], a[168:171], v[0:3], a[16:19]
  v_exp_f32 v104, v104
  v_mfma_f32_16x16x32_bf16 a[16:19], a[172:175], v[32:35], a[16:19]
  ds_read_b64_tr_b16 a[160:161], v220 offset:32768
  v_mfma_f32_16x16x32_bf16 a[20:23], a[172:175], v[40:43], a[20:23]
  v_exp_f32 v105, v105
  v_mfma_f32_16x16x32_bf16 a[20:23], a[168:171], v[8:11], a[20:23]
  ds_read_b64_tr_b16 a[162:163], v220 offset:36864
  v_cvt_pk_bf16_f32 v104, v104, v105
  v_mfma_f32_16x16x32_bf16 a[24:27], a[168:171], v[16:19], a[24:27]
  v_exp_f32 v106, v106
  v_mfma_f32_16x16x32_bf16 a[24:27], a[172:175], v[48:51], a[24:27]
  ds_read_b64_tr_b16 a[164:165], v220 offset:40960
  v_mfma_f32_16x16x32_bf16 a[28:31], a[172:175], v[56:59], a[28:31]
  s_waitcnt lgkmcnt(7)
  v_exp_f32 v107, v107
  v_mfma_f32_16x16x32_bf16 a[28:31], a[168:171], v[24:27], a[28:31]
  ds_read_b64_tr_b16 a[166:167], v220 offset:45056
  v_cvt_pk_bf16_f32 v105, v106, v107
  v_mfma_f32_16x16x32_bf16 a[32:35], a[176:179], v[0:3], a[32:35]
  v_exp_f32 v112, v112
  v_mfma_f32_16x16x32_bf16 a[32:35], a[180:183], v[32:35], a[32:35]
  ds_read_b64_tr_b16 a[168:169], v221 offset:32768
  v_mfma_f32_16x16x32_bf16 a[36:39], a[180:183], v[40:43], a[36:39]
  v_exp_f32 v113, v113
  v_mfma_f32_16x16x32_bf16 a[36:39], a[176:179], v[8:11], a[36:39]
  ds_read_b64_tr_b16 a[170:171], v221 offset:36864
  v_cvt_pk_bf16_f32 v112, v112, v113
  v_mfma_f32_16x16x32_bf16 a[40:43], a[176:179], v[16:19], a[40:43]
  v_exp_f32 v114, v114
  v_mfma_f32_16x16x32_bf16 a[40:43], a[180:183], v[48:51], a[40:43]
  ds_read_b64_tr_b16 a[172:173], v221 offset:40960
  v_mfma_f32_16x16x32_bf16 a[44:47], a[180:183], v[56:59], a[44:47]
  s_waitcnt lgkmcnt(7)
  v_exp_f32 v115, v115
  v_mfma_f32_16x16x32_bf16 a[44:47], a[176:179], v[24:27], a[44:47]
  ds_read_b64_tr_b16 a[174:175], v221 offset:45056
  v_cvt_pk_bf16_f32 v113, v114, v115
  v_mfma_f32_16x16x32_bf16 a[48:51], a[184:187], v[0:3], a[48:51]
  v_exp_f32 v120, v120
  v_mfma_f32_16x16x32_bf16 a[48:51], a[188:191], v[32:35], a[48:51]
  ds_read_b64_tr_b16 a[176:177], v222 offset:32768
  v_mfma_f32_16x16x32_bf16 a[52:55], a[188:191], v[40:43], a[52:55]
  v_exp_f32 v121, v121
  v_mfma_f32_16x16x32_bf16 a[52:55], a[184:187], v[8:11], a[52:55]
  ds_read_b64_tr_b16 a[178:179], v222 offset:36864
  v_cvt_pk_bf16_f32 v120, v120, v121
  v_mfma_f32_16x16x32_bf16 a[56:59], a[184:187], v[16:19], a[56:59]
  v_exp_f32 v122, v122
  v_mfma_f32_16x16x32_bf16 a[56:59], a[188:191], v[48:51], a[56:59]
  ds_read_b64_tr_b16 a[180:181], v222 offset:40960
  v_mfma_f32_16x16x32_bf16 a[60:63], a[188:191], v[56:59], a[60:63]
  s_waitcnt lgkmcnt(7)
  v_exp_f32 v123, v123
  v_mfma_f32_16x16x32_bf16 a[60:63], a[184:187], v[24:27], a[60:63]
  ds_read_b64_tr_b16 a[182:183], v222 offset:45056
  v_cvt_pk_bf16_f32 v121, v122, v123
  v_mfma_f32_16x16x32_bf16 a[64:67], a[160:163], v[0:3], a[64:67]
  v_exp_f32 v100, v100
  v_mfma_f32_16x16x32_bf16 a[64:67], a[164:167], v[32:35], a[64:67]
  ds_read_b64_tr_b16 a[184:185], v223 offset:32768
  v_mfma_f32_16x16x32_bf16 a[68:71], a[164:167], v[40:43], a[68:71]
  v_exp_f32 v101, v101
  v_mfma_f32_16x16x32_bf16 a[68:71], a[160:163], v[8:11], a[68:71]
  ds_read_b64_tr_b16 a[186:187], v223 offset:36864
  v_cvt_pk_bf16_f32 v98, v100, v101
  v_mfma_f32_16x16x32_bf16 a[72:75], a[160:163], v[16:19], a[72:75]
  v_exp_f32 v102, v102
  v_mfma_f32_16x16x32_bf16 a[72:75], a[164:167], v[48:51], a[72:75]
  ds_read_b64_tr_b16 a[188:189], v223 offset:40960
  v_mfma_f32_16x16x32_bf16 a[76:79], a[164:167], v[56:59], a[76:79]
  s_waitcnt lgkmcnt(7)
  v_exp_f32 v103, v103
  v_mfma_f32_16x16x32_bf16 a[76:79], a[160:163], v[24:27], a[76:79]
  ds_read_b64_tr_b16 a[190:191], v223 offset:45056
  v_cvt_pk_bf16_f32 v99, v102, v103
  v_mfma_f32_16x16x32_bf16 a[80:83], a[168:171], v[0:3], a[80:83]
  s_waitcnt vmcnt(11)
  v_exp_f32 v108, v108
  v_mfma_f32_16x16x32_bf16 a[80:83], a[172:175], v[32:35], a[80:83]
  v_mfma_f32_16x16x32_bf16 a[84:87], a[172:175], v[40:43], a[84:87]
  s_barrier
  v_exp_f32 v109, v109
  v_mfma_f32_16x16x32_bf16 a[84:87], a[168:171], v[8:11], a[84:87]
  ds_read_b128 a[128:131], v212 offset:0
  v_cvt_pk_bf16_f32 v106, v108, v109
  v_mfma_f32_16x16x32_bf16 a[88:91], a[168:171], v[16:19], a[88:91]
  v_exp_f32 v110, v110
  v_mfma_f32_16x16x32_bf16 a[88:91], a[172:175], v[48:51], a[88:91]
  ds_read_b128 a[132:135], v213 offset:0
  v_mfma_f32_16x16x32_bf16 a[92:95], a[172:175], v[56:59], a[92:95]
  s_waitcnt lgkmcnt(6)
  v_exp_f32 v111, v111
  v_mfma_f32_16x16x32_bf16 a[92:95], a[168:171], v[24:27], a[92:95]
  ds_read_b128 a[136:139], v214 offset:0
  v_cvt_pk_bf16_f32 v107, v110, v111
  v_mfma_f32_16x16x32_bf16 a[96:99], a[176:179], v[0:3], a[96:99]
  v_exp_f32 v116, v116
  v_mfma_f32_16x16x32_bf16 a[96:99], a[180:183], v[32:35], a[96:99]
  ds_read_b128 a[140:143], v215 offset:0
  buffer_load_dwordx4 a[220:223], v243, s[24:27], s38 offen sc1
  s_add_u32 s38, s38, 4096
  v_mfma_f32_16x16x32_bf16 a[100:103], a[180:183], v[40:43], a[100:103]
  v_exp_f32 v117, v117
  v_mfma_f32_16x16x32_bf16 a[100:103], a[176:179], v[8:11], a[100:103]
  v_cvt_pk_bf16_f32 v114, v116, v117
  v_mfma_f32_16x16x32_bf16 a[104:107], a[176:179], v[16:19], a[104:107]
  v_exp_f32 v118, v118
  v_mfma_f32_16x16x32_bf16 a[104:107], a[180:183], v[48:51], a[104:107]
  v_mfma_f32_16x16x32_bf16 a[108:111], a[180:183], v[56:59], a[108:111]
  s_waitcnt lgkmcnt(4)
  v_exp_f32 v119, v119
  v_mfma_f32_16x16x32_bf16 a[108:111], a[176:179], v[24:27], a[108:111]
  v_cvt_pk_bf16_f32 v115, v118, v119
  v_mfma_f32_16x16x32_bf16 a[112:115], a[184:187], v[0:3], a[112:115]
  v_exp_f32 v124, v124
  v_mfma_f32_16x16x32_bf16 a[112:115], a[188:191], v[32:35], a[112:115]
  v_mfma_f32_16x16x32_bf16 a[116:119], a[188:191], v[40:43], a[116:119]
  v_exp_f32 v125, v125
  v_mfma_f32_16x16x32_bf16 a[116:119], a[184:187], v[8:11], a[116:119]
  v_cvt_pk_bf16_f32 v122, v124, v125
  v_mfma_f32_16x16x32_bf16 a[120:123], a[184:187], v[16:19], a[120:123]
  v_exp_f32 v126, v126
  v_mfma_f32_16x16x32_bf16 a[120:123], a[188:191], v[48:51], a[120:123]
  v_mfma_f32_16x16x32_bf16 a[124:127], a[188:191], v[56:59], a[124:127]
  s_waitcnt lgkmcnt(0)
  v_exp_f32 v127, v127
  v_mfma_f32_16x16x32_bf16 a[124:127], a[184:187], v[24:27], a[124:127]
  v_cvt_pk_bf16_f32 v123, v126, v127
  v_mfma_f32_16x16x32_bf16 v[0:3], a[128:131], v[128:131], v[192:195]
  s_add_u32 m0, s28, 81920
  v_mfma_f32_16x16x32_bf16 v[0:3], a[132:135], v[132:135], v[0:3]
  ds_read_b128 a[144:147], v212 offset:4096
  v_mfma_f32_16x16x32_bf16 v[0:3], a[136:139], v[136:139], v[0:3]
  buffer_load_dwordx4 v236, s[16:19], s29 offen offset:0 lds
  v_mfma_f32_16x16x32_bf16 v[0:3], a[140:143], v[140:143], v[0:3]
  ds_read_b128 a[148:151], v213 offset:4096
  v_mfma_f32_16x16x32_bf16 v[8:11], a[140:143], v[156:159], v[196:199]
  v_mfma_f32_16x16x32_bf16 v[8:11], a[136:139], v[152:155], v[8:11]
  ds_read_b128 a[152:155], v214 offset:4096
  v_mfma_f32_16x16x32_bf16 v[8:11], a[132:135], v[148:151], v[8:11]
  buffer_load_dwordx4 v237, s[16:19], s29 offen offset:1024 lds
  v_mfma_f32_16x16x32_bf16 v[8:11], a[128:131], v[144:147], v[8:11]
  ds_read_b128 a[156:159], v215 offset:4096
  v_mfma_f32_16x16x32_bf16 v[16:19], a[128:131], v[160:163], v[200:203]
  v_exp_f32 v0, v0
  v_mfma_f32_16x16x32_bf16 v[16:19], a[132:135], v[164:167], v[16:19]
  v_mfma_f32_16x16x32_bf16 v[16:19], a[136:139], v[168:171], v[16:19]
  v_exp_f32 v1, v1
  v_mfma_f32_16x16x32_bf16 v[16:19], a[140:143], v[172:175], v[16:19]
  v_cvt_pk_bf16_f32 v0, v0, v1
  v_mfma_f32_16x16x32_bf16 v[24:27], a[140:143], v[188:191], v[204:207]
  v_exp_f32 v2, v2
  v_mfma_f32_16x16x32_bf16 v[24:27], a[136:139], v[184:187], v[24:27]
  buffer_load_dwordx4 v236, s[16:19], s29 offen offset:2048 lds
  v_mfma_f32_16x16x32_bf16 v[24:27], a[132:135], v[180:183], v[24:27]
  s_waitcnt lgkmcnt(0)
  v_exp_f32 v3, v3
  v_mfma_f32_16x16x32_bf16 v[24:27], a[128:131], v[176:179], v[24:27]
  v_cvt_pk_bf16_f32 v1, v2, v3
  v_mfma_f32_16x16x32_bf16 v[4:7], a[144:147], v[128:131], v[192:195]
  v_exp_f32 v8, v8
  v_mfma_f32_16x16x32_bf16 v[4:7], a[148:151], v[132:135], v[4:7]
  ds_read_b128 a[128:131], v212 offset:8192
  v_mfma_f32_16x16x32_bf16 v[4:7], a[152:155], v[136:139], v[4:7]
  v_exp_f32 v9, v9
  v_mfma_f32_16x16x32_bf16 v[4:7], a[156:159], v[140:143], v[4:7]
  ds_read_b128 a[132:135], v213 offset:8192
  v_cvt_pk_bf16_f32 v8, v8, v9
  v_mfma_f32_16x16x32_bf16 v[12:15], a[156:159], v[156:159], v[196:199]
  v_exp_f32 v10, v10
  v_mfma_f32_16x16x32_bf16 v[12:15], a[152:155], v[152:155], v[12:15]
  ds_read_b128 a[136:139], v214 offset:8192
  v_mfma_f32_16x16x32_bf16 v[12:15], a[148:151], v[148:151], v[12:15]
  v_exp_f32 v11, v11
  v_mfma_f32_16x16x32_bf16 v[12:15], a[144:147], v[144:147], v[12:15]
  ds_read_b128 a[140:143], v215 offset:8192
  v_cvt_pk_bf16_f32 v9, v10, v11
  v_mfma_f32_16x16x32_bf16 v[20:23], a[144:147], v[160:163], v[200:203]
  v_exp_f32 v16, v16
  v_mfma_f32_16x16x32_bf16 v[20:23], a[148:151], v[164:167], v[20:23]
  buffer_load_dwordx4 v237, s[16:19], s29 offen offset:3072 lds
  v_mfma_f32_16x16x32_bf16 v[20:23], a[152:155], v[168:171], v[20:23]
  s_add_u32 s29, s29, 16384
  v_exp_f32 v17, v17
  v_mfma_f32_16x16x32_bf16 v[20:23], a[156:159], v[172:175], v[20:23]
  v_cvt_pk_bf16_f32 v16, v16, v17
  v_mfma_f32_16x16x32_bf16 v[28:31], a[156:159], v[188:191], v[204:207]
  s_add_u32 m0, s28, 32768
  v_exp_f32 v18, v18
  v_mfma_f32_16x16x32_bf16 v[28:31], a[152:155], v[184:187], v[28:31]
  buffer_load_dwordx4 v232, s[12:15], s29 offen offset:0 lds
  v_mfma_f32_16x16x32_bf16 v[28:31], a[148:151], v[180:183], v[28:31]
  s_waitcnt lgkmcnt(0)
  v_exp_f32 v19, v19
  v_mfma_f32_16x16x32_bf16 v[28:31], a[144:147], v[176:179], v[28:31]
  v_cvt_pk_bf16_f32 v17, v18, v19
  v_mfma_f32_16x16x32_bf16 v[32:35], a[128:131], v[128:131], v[192:195]
  v_exp_f32 v24, v24
  v_mfma_f32_16x16x32_bf16 v[32:35], a[132:135], v[132:135], v[32:35]
  ds_read_b128 a[144:147], v212 offset:12288
  v_mfma_f32_16x16x32_bf16 v[32:35], a[136:139], v[136:139], v[32:35]
  v_exp_f32 v25, v25
  v_mfma_f32_16x16x32_bf16 v[32:35], a[140:143], v[140:143], v[32:35]
  ds_read_b128 a[148:151], v213 offset:12288
  v_cvt_pk_bf16_f32 v24, v24, v25
  v_mfma_f32_16x16x32_bf16 v[40:43], a[140:143], v[156:159], v[196:199]
  v_exp_f32 v26, v26
  v_mfma_f32_16x16x32_bf16 v[40:43], a[136:139], v[152:155], v[40:43]
  ds_read_b128 a[152:155], v214 offset:12288
  v_mfma_f32_16x16x32_bf16 v[40:43], a[132:135], v[148:151], v[40:43]
  v_exp_f32 v27, v27
  v_mfma_f32_16x16x32_bf16 v[40:43], a[128:131], v[144:147], v[40:43]
  ds_read_b128 a[156:159], v215 offset:12288
  v_cvt_pk_bf16_f32 v25, v26, v27
  v_mfma_f32_16x16x32_bf16 v[48:51], a[128:131], v[160:163], v[200:203]
  v_exp_f32 v4, v4
  v_mfma_f32_16x16x32_bf16 v[48:51], a[132:135], v[164:167], v[48:51]
  buffer_load_dwordx4 v233, s[12:15], s29 offen offset:1024 lds
  v_mfma_f32_16x16x32_bf16 v[48:51], a[136:139], v[168:171], v[48:51]
  v_exp_f32 v5, v5
  v_mfma_f32_16x16x32_bf16 v[48:51], a[140:143], v[172:175], v[48:51]
  v_cvt_pk_bf16_f32 v2, v4, v5
  v_mfma_f32_16x16x32_bf16 v[56:59], a[140:143], v[188:191], v[204:207]
  v_exp_f32 v6, v6
  v_mfma_f32_16x16x32_bf16 v[56:59], a[136:139], v[184:187], v[56:59]
  buffer_load_dwordx4 v234, s[12:15], s29 offen offset:2048 lds
  v_mfma_f32_16x16x32_bf16 v[56:59], a[132:135], v[180:183], v[56:59]
  s_waitcnt lgkmcnt(0)
  v_exp_f32 v7, v7
  v_mfma_f32_16x16x32_bf16 v[56:59], a[128:131], v[176:179], v[56:59]
  v_cvt_pk_bf16_f32 v3, v6, v7
  v_mfma_f32_16x16x32_bf16 v[36:39], a[144:147], v[128:131], v[192:195]
  v_exp_f32 v12, v12
  v_mfma_f32_16x16x32_bf16 v[36:39], a[148:151], v[132:135], v[36:39]
  ds_read_b64_tr_b16 a[160:161], v216 offset:49152
  v_mfma_f32_16x16x32_bf16 v[36:39], a[152:155], v[136:139], v[36:39]
  v_exp_f32 v13, v13
  v_mfma_f32_16x16x32_bf16 v[36:39], a[156:159], v[140:143], v[36:39]
  ds_read_b64_tr_b16 a[162:163], v216 offset:53248
  v_cvt_pk_bf16_f32 v10, v12, v13
  v_mfma_f32_16x16x32_bf16 v[44:47], a[156:159], v[156:159], v[196:199]
  v_exp_f32 v14, v14
  v_mfma_f32_16x16x32_bf16 v[44:47], a[152:155], v[152:155], v[44:47]
  ds_read_b64_tr_b16 a[164:165], v216 offset:57344
  buffer_load_dwordx4 v235, s[12:15], s29 offen offset:3072 lds
  v_mfma_f32_16x16x32_bf16 v[44:47], a[148:151], v[148:151], v[44:47]
  v_exp_f32 v15, v15
  v_mfma_f32_16x16x32_bf16 v[44:47], a[144:147], v[144:147], v[44:47]
  ds_read_b64_tr_b16 a[166:167], v216 offset:61440
  v_cvt_pk_bf16_f32 v11, v14, v15
  v_mfma_f32_16x16x32_bf16 v[52:55], a[144:147], v[160:163], v[200:203]
  v_exp_f32 v20, v20
  v_mfma_f32_16x16x32_bf16 v[52:55], a[148:151], v[164:167], v[52:55]
  ds_read_b64_tr_b16 a[168:169], v217 offset:49152
  s_add_u32 m0, s50, 2048
  v_mfma_f32_16x16x32_bf16 v[52:55], a[152:155], v[168:171], v[52:55]
  v_exp_f32 v21, v21
  v_mfma_f32_16x16x32_bf16 v[52:55], a[156:159], v[172:175], v[52:55]
  ds_read_b64_tr_b16 a[170:171], v217 offset:53248
  v_cvt_pk_bf16_f32 v18, v20, v21
  v_mfma_f32_16x16x32_bf16 v[60:63], a[156:159], v[188:191], v[204:207]
  v_exp_f32 v22, v22
  v_mfma_f32_16x16x32_bf16 v[60:63], a[152:155], v[184:187], v[60:63]
  ds_read_b64_tr_b16 a[172:173], v217 offset:57344
  buffer_load_dwordx4 v253, s[20:23], s35 offen lds
  v_mfma_f32_16x16x32_bf16 v[60:63], a[148:151], v[180:183], v[60:63]
  v_exp_f32 v23, v23
  v_mfma_f32_16x16x32_bf16 v[60:63], a[144:147], v[176:179], v[60:63]
  ds_read_b64_tr_b16 a[174:175], v217 offset:61440
  v_cvt_pk_bf16_f32 v19, v22, v23
  v_mfma_f32_16x16x32_bf16 a[192:195], a[208:211], v[64:67], a[192:195]
  v_exp_f32 v28, v28
  v_mfma_f32_16x16x32_bf16 a[192:195], a[208:211], v[96:99], a[192:195]
  ds_read_b64_tr_b16 a[176:177], v218 offset:49152
  v_mfma_f32_16x16x32_bf16 a[196:199], a[208:211], v[72:75], a[196:199]
  v_exp_f32 v29, v29
  v_mfma_f32_16x16x32_bf16 a[196:199], a[208:211], v[104:107], a[196:199]
  ds_read_b64_tr_b16 a[178:179], v218 offset:53248
  v_cvt_pk_bf16_f32 v26, v28, v29
  v_mfma_f32_16x16x32_bf16 a[200:203], a[208:211], v[80:83], a[200:203]
  v_exp_f32 v30, v30
  v_mfma_f32_16x16x32_bf16 a[200:203], a[208:211], v[112:115], a[200:203]
  ds_read_b64_tr_b16 a[180:181], v218 offset:57344
  v_mfma_f32_16x16x32_bf16 a[204:207], a[208:211], v[88:91], a[204:207]
  s_waitcnt lgkmcnt(7)
  v_exp_f32 v31, v31
  v_mfma_f32_16x16x32_bf16 a[204:207], a[208:211], v[120:123], a[204:207]
  ds_read_b64_tr_b16 a[182:183], v218 offset:61440
  v_cvt_pk_bf16_f32 v27, v30, v31
  v_mfma_f32_16x16x32_bf16 a[0:3], a[160:163], v[64:67], a[0:3]
  v_exp_f32 v32, v32
  v_mfma_f32_16x16x32_bf16 a[0:3], a[164:167], v[96:99], a[0:3]
  ds_read_b64_tr_b16 a[184:185], v219 offset:49152
  v_mfma_f32_16x16x32_bf16 a[4:7], a[164:167], v[104:107], a[4:7]
  v_exp_f32 v33, v33
  v_mfma_f32_16x16x32_bf16 a[4:7], a[160:163], v[72:75], a[4:7]
  ds_read_b64_tr_b16 a[186:187], v219 offset:53248
  v_cvt_pk_bf16_f32 v32, v32, v33
  v_mfma_f32_16x16x32_bf16 a[8:11], a[160:163], v[80:83], a[8:11]
  v_exp_f32 v34, v34
  v_mfma_f32_16x16x32_bf16 a[8:11], a[164:167], v[112:115], a[8:11]
  ds_read_b64_tr_b16 a[188:189], v219 offset:57344
  v_mfma_f32_16x16x32_bf16 a[12:15], a[164:167], v[120:123], a[12:15]
  s_waitcnt lgkmcnt(7)
  v_exp_f32 v35, v35
  v_mfma_f32_16x16x32_bf16 a[12:15], a[160:163], v[88:91], a[12:15]
  ds_read_b64_tr_b16 a[190:191], v219 offset:61440
  v_cvt_pk_bf16_f32 v33, v34, v35
  v_mfma_f32_16x16x32_bf16 a[16:19], a[168:171], v[64:67], a[16:19]
  v_exp_f32 v40, v40
  v_mfma_f32_16x16x32_bf16 a[16:19], a[172:175], v[96:99], a[16:19]
  ds_read_b64_tr_b16 a[160:161], v220 offset:49152
  v_mfma_f32_16x16x32_bf16 a[20:23], a[172:175], v[104:107], a[20:23]
  v_exp_f32 v41, v41
  v_mfma_f32_16x16x32_bf16 a[20:23], a[168:171], v[72:75], a[20:23]
  ds_read_b64_tr_b16 a[162:163], v220 offset:53248
  v_cvt_pk_bf16_f32 v40, v40, v41
  v_mfma_f32_16x16x32_bf16 a[24:27], a[168:171], v[80:83], a[24:27]
  v_exp_f32 v42, v42
  v_mfma_f32_16x16x32_bf16 a[24:27], a[172:175], v[112:115], a[24:27]
  ds_read_b64_tr_b16 a[164:165], v220 offset:57344
  v_mfma_f32_16x16x32_bf16 a[28:31], a[172:175], v[120:123], a[28:31]
  s_waitcnt lgkmcnt(7)
  v_exp_f32 v43, v43
  v_mfma_f32_16x16x32_bf16 a[28:31], a[168:171], v[88:91], a[28:31]
  ds_read_b64_tr_b16 a[166:167], v220 offset:61440
  v_cvt_pk_bf16_f32 v41, v42, v43
  v_mfma_f32_16x16x32_bf16 a[32:35], a[176:179], v[64:67], a[32:35]
  v_exp_f32 v48, v48
  v_mfma_f32_16x16x32_bf16 a[32:35], a[180:183], v[96:99], a[32:35]
  ds_read_b64_tr_b16 a[168:169], v221 offset:49152
  v_mfma_f32_16x16x32_bf16 a[36:39], a[180:183], v[104:107], a[36:39]
  v_exp_f32 v49, v49
  v_mfma_f32_16x16x32_bf16 a[36:39], a[176:179], v[72:75], a[36:39]
  ds_read_b64_tr_b16 a[170:171], v221 offset:53248
  v_cvt_pk_bf16_f32 v48, v48, v49
  v_mfma_f32_16x16x32_bf16 a[40:43], a[176:179], v[80:83], a[40:43]
  v_exp_f32 v50, v50
  v_mfma_f32_16x16x32_bf16 a[40:43], a[180:183], v[112:115], a[40:43]
  ds_read_b64_tr_b16 a[172:173], v221 offset:57344
  v_mfma_f32_16x16x32_bf16 a[44:47], a[180:183], v[120:123], a[44:47]
  s_waitcnt lgkmcnt(7)
  v_exp_f32 v51, v51
  v_mfma_f32_16x16x32_bf16 a[44:47], a[176:179], v[88:91], a[44:47]
  ds_read_b64_tr_b16 a[174:175], v221 offset:61440
  v_cvt_pk_bf16_f32 v49, v50, v51
  v_mfma_f32_16x16x32_bf16 a[48:51], a[184:187], v[64:67], a[48:51]
  v_exp_f32 v56, v56
  v_mfma_f32_16x16x32_bf16 a[48:51], a[188:191], v[96:99], a[48:51]
  ds_read_b64_tr_b16 a[176:177], v222 offset:49152
  v_mfma_f32_16x16x32_bf16 a[52:55], a[188:191], v[104:107], a[52:55]
  v_exp_f32 v57, v57
  v_mfma_f32_16x16x32_bf16 a[52:55], a[184:187], v[72:75], a[52:55]
  ds_read_b64_tr_b16 a[178:179], v222 offset:53248
  v_cvt_pk_bf16_f32 v56, v56, v57
  v_mfma_f32_16x16x32_bf16 a[56:59], a[184:187], v[80:83], a[56:59]
  v_exp_f32 v58, v58
  v_mfma_f32_16x16x32_bf16 a[56:59], a[188:191], v[112:115], a[56:59]
  ds_read_b64_tr_b16 a[180:181], v222 offset:57344
  v_mfma_f32_16x16x32_bf16 a[60:63], a[188:191], v[120:123], a[60:63]
  s_waitcnt lgkmcnt(7)
  v_exp_f32 v59, v59
  v_mfma_f32_16x16x32_bf16 a[60:63], a[184:187], v[88:91], a[60:63]
  ds_read_b64_tr_b16 a[182:183], v222 offset:61440
  v_cvt_pk_bf16_f32 v57, v58, v59
  v_mfma_f32_16x16x32_bf16 a[64:67], a[160:163], v[64:67], a[64:67]
  v_exp_f32 v36, v36
  v_mfma_f32_16x16x32_bf16 a[64:67], a[164:167], v[96:99], a[64:67]
  ds_read_b64_tr_b16 a[184:185], v223 offset:49152
  v_mfma_f32_16x16x32_bf16 a[68:71], a[164:167], v[104:107], a[68:71]
  v_exp_f32 v37, v37
  v_mfma_f32_16x16x32_bf16 a[68:71], a[160:163], v[72:75], a[68:71]
  ds_read_b64_tr_b16 a[186:187], v223 offset:53248
  v_cvt_pk_bf16_f32 v34, v36, v37
  v_mfma_f32_16x16x32_bf16 a[72:75], a[160:163], v[80:83], a[72:75]
  v_exp_f32 v38, v38
  v_mfma_f32_16x16x32_bf16 a[72:75], a[164:167], v[112:115], a[72:75]
  ds_read_b64_tr_b16 a[188:189], v223 offset:57344
  v_mfma_f32_16x16x32_bf16 a[76:79], a[164:167], v[120:123], a[76:79]
  s_waitcnt lgkmcnt(7)
  v_exp_f32 v39, v39
  v_mfma_f32_16x16x32_bf16 a[76:79], a[160:163], v[88:91], a[76:79]
  ds_read_b64_tr_b16 a[190:191], v223 offset:61440
  v_cvt_pk_bf16_f32 v35, v38, v39
  v_mfma_f32_16x16x32_bf16 a[80:83], a[168:171], v[64:67], a[80:83]
  s_waitcnt vmcnt(11)
  v_exp_f32 v44, v44
  v_mfma_f32_16x16x32_bf16 a[80:83], a[172:175], v[96:99], a[80:83]
  v_mfma_f32_16x16x32_bf16 a[84:87], a[172:175], v[104:107], a[84:87]
  s_barrier
  v_exp_f32 v45, v45
  v_mfma_f32_16x16x32_bf16 a[84:87], a[168:171], v[72:75], a[84:87]
  ds_read_b128 a[128:131], v212 offset:16384
  v_cvt_pk_bf16_f32 v42, v44, v45
  v_mfma_f32_16x16x32_bf16 a[88:91], a[168:171], v[80:83], a[88:91]
  v_exp_f32 v46, v46
  v_mfma_f32_16x16x32_bf16 a[88:91], a[172:175], v[112:115], a[88:91]
  ds_read_b128 a[132:135], v213 offset:16384
  v_mfma_f32_16x16x32_bf16 a[92:95], a[172:175], v[120:123], a[92:95]
  s_waitcnt lgkmcnt(6)
  v_exp_f32 v47, v47
  v_mfma_f32_16x16x32_bf16 a[92:95], a[168:171], v[88:91], a[92:95]
  ds_read_b128 a[136:139], v214 offset:16384
  v_cvt_pk_bf16_f32 v43, v46, v47
  v_mfma_f32_16x16x32_bf16 a[96:99], a[176:179], v[64:67], a[96:99]
  v_exp_f32 v52, v52
  v_mfma_f32_16x16x32_bf16 a[96:99], a[180:183], v[96:99], a[96:99]
  ds_read_b128 a[140:143], v215 offset:16384
  buffer_load_dwordx4 a[224:227], v243, s[24:27], s38 offen sc1
  s_add_u32 s38, s38, 4096
  v_mfma_f32_16x16x32_bf16 a[100:103], a[180:183], v[104:107], a[100:103]
  v_exp_f32 v53, v53
  v_mfma_f32_16x16x32_bf16 a[100:103], a[176:179], v[72:75], a[100:103]
  v_cvt_pk_bf16_f32 v50, v52, v53
  v_mfma_f32_16x16x32_bf16 a[104:107], a[176:179], v[80:83], a[104:107]
  v_exp_f32 v54, v54
  v_mfma_f32_16x16x32_bf16 a[104:107], a[180:183], v[112:115], a[104:107]
  v_mfma_f32_16x16x32_bf16 a[108:111], a[180:183], v[120:123], a[108:111]
  s_waitcnt lgkmcnt(4)
  v_exp_f32 v55, v55
  v_mfma_f32_16x16x32_bf16 a[108:111], a[176:179], v[88:91], a[108:111]
  v_cvt_pk_bf16_f32 v51, v54, v55
  v_mfma_f32_16x16x32_bf16 a[112:115], a[184:187], v[64:67], a[112:115]
  v_exp_f32 v60, v60
  v_mfma_f32_16x16x32_bf16 a[112:115], a[188:191], v[96:99], a[112:115]
  v_mfma_f32_16x16x32_bf16 a[116:119], a[188:191], v[104:107], a[116:119]
  v_exp_f32 v61, v61
  v_mfma_f32_16x16x32_bf16 a[116:119], a[184:187], v[72:75], a[116:119]
  v_cvt_pk_bf16_f32 v58, v60, v61
  v_mfma_f32_16x16x32_bf16 a[120:123], a[184:187], v[80:83], a[120:123]
  v_exp_f32 v62, v62
  v_mfma_f32_16x16x32_bf16 a[120:123], a[188:191], v[112:115], a[120:123]
  v_mfma_f32_16x16x32_bf16 a[124:127], a[188:191], v[120:123], a[124:127]
  s_waitcnt lgkmcnt(0)
  v_exp_f32 v63, v63
  v_mfma_f32_16x16x32_bf16 a[124:127], a[184:187], v[88:91], a[124:127]
  v_cvt_pk_bf16_f32 v59, v62, v63
  v_mfma_f32_16x16x32_bf16 v[64:67], a[128:131], v[128:131], v[192:195]
  s_add_u32 m0, s28, 98304
  v_mfma_f32_16x16x32_bf16 v[64:67], a[132:135], v[132:135], v[64:67]
  ds_read_b128 a[144:147], v212 offset:20480
  v_mfma_f32_16x16x32_bf16 v[64:67], a[136:139], v[136:139], v[64:67]
  buffer_load_dwordx4 v236, s[16:19], s29 offen offset:0 lds
  v_mfma_f32_16x16x32_bf16 v[64:67], a[140:143], v[140:143], v[64:67]
  ds_read_b128 a[148:151], v213 offset:20480
  v_mfma_f32_16x16x32_bf16 v[72:75], a[140:143], v[156:159], v[196:199]
  v_mfma_f32_16x16x32_bf16 v[72:75], a[136:139], v[152:155], v[72:75]
  ds_read_b128 a[152:155], v214 offset:20480
  v_mfma_f32_16x16x32_bf16 v[72:75], a[132:135], v[148:151], v[72:75]
  buffer_load_dwordx4 v237, s[16:19], s29 offen offset:1024 lds
  v_mfma_f32_16x16x32_bf16 v[72:75], a[128:131], v[144:147], v[72:75]
  ds_read_b128 a[156:159], v215 offset:20480
  v_mfma_f32_16x16x32_bf16 v[80:83], a[128:131], v[160:163], v[200:203]
  v_exp_f32 v64, v64
  v_mfma_f32_16x16x32_bf16 v[80:83], a[132:135], v[164:167], v[80:83]
  v_mfma_f32_16x16x32_bf16 v[80:83], a[136:139], v[168:171], v[80:83]
  v_exp_f32 v65, v65
  v_mfma_f32_16x16x32_bf16 v[80:83], a[140:143], v[172:175], v[80:83]
  v_cvt_pk_bf16_f32 v64, v64, v65
  v_mfma_f32_16x16x32_bf16 v[88:91], a[140:143], v[188:191], v[204:207]
  v_exp_f32 v66, v66
  v_mfma_f32_16x16x32_bf16 v[88:91], a[136:139], v[184:187], v[88:91]
  buffer_load_dwordx4 v236, s[16:19], s29 offen offset:2048 lds
  v_mfma_f32_16x16x32_bf16 v[88:91], a[132:135], v[180:183], v[88:91]
  s_waitcnt lgkmcnt(0)
  v_exp_f32 v67, v67
  v_mfma_f32_16x16x32_bf16 v[88:91], a[128:131], v[176:179], v[88:91]
  v_cvt_pk_bf16_f32 v65, v66, v67
  v_mfma_f32_16x16x32_bf16 v[68:71], a[144:147], v[128:131], v[192:195]
  v_exp_f32 v72, v72
  v_mfma_f32_16x16x32_bf16 v[68:71], a[148:151], v[132:135], v[68:71]
  ds_read_b128 a[128:131], v212 offset:24576
  v_mfma_f32_16x16x32_bf16 v[68:71], a[152:155], v[136:139], v[68:71]
  v_exp_f32 v73, v73
  v_mfma_f32_16x16x32_bf16 v[68:71], a[156:159], v[140:143], v[68:71]
  ds_read_b128 a[132:135], v213 offset:24576
  v_cvt_pk_bf16_f32 v72, v72, v73
  v_mfma_f32_16x16x32_bf16 v[76:79], a[156:159], v[156:159], v[196:199]
  v_exp_f32 v74, v74
  v_mfma_f32_16x16x32_bf16 v[76:79], a[152:155], v[152:155], v[76:79]
  ds_read_b128 a[136:139], v214 offset:24576
  v_mfma_f32_16x16x32_bf16 v[76:79], a[148:151], v[148:151], v[76:79]
  v_exp_f32 v75, v75
  v_mfma_f32_16x16x32_bf16 v[76:79], a[144:147], v[144:147], v[76:79]
  ds_read_b128 a[140:143], v215 offset:24576
  v_cvt_pk_bf16_f32 v73, v74, v75
  v_mfma_f32_16x16x32_bf16 v[84:87], a[144:147], v[160:163], v[200:203]
  v_exp_f32 v80, v80
  v_mfma_f32_16x16x32_bf16 v[84:87], a[148:151], v[164:167], v[84:87]
  buffer_load_dwordx4 v237, s[16:19], s29 offen offset:3072 lds
  v_mfma_f32_16x16x32_bf16 v[84:87], a[152:155], v[168:171], v[84:87]
  s_add_u32 s29, s29, 16384
  v_exp_f32 v81, v81
  v_mfma_f32_16x16x32_bf16 v[84:87], a[156:159], v[172:175], v[84:87]
  v_cvt_pk_bf16_f32 v80, v80, v81
  v_mfma_f32_16x16x32_bf16 v[92:95], a[156:159], v[188:191], v[204:207]
  s_add_u32 m0, s28, 49152
  v_exp_f32 v82, v82
  v_mfma_f32_16x16x32_bf16 v[92:95], a[152:155], v[184:187], v[92:95]
  buffer_load_dwordx4 v232, s[12:15], s29 offen offset:0 lds
  v_mfma_f32_16x16x32_bf16 v[92:95], a[148:151], v[180:183], v[92:95]
  s_waitcnt lgkmcnt(0)
  v_exp_f32 v83, v83
  v_mfma_f32_16x16x32_bf16 v[92:95], a[144:147], v[176:179], v[92:95]
  v_cvt_pk_bf16_f32 v81, v82, v83
  v_mfma_f32_16x16x32_bf16 v[96:99], a[128:131], v[128:131], v[192:195]
  v_exp_f32 v88, v88
  v_mfma_f32_16x16x32_bf16 v[96:99], a[132:135], v[132:135], v[96:99]
  ds_read_b128 a[144:147], v212 offset:28672
  v_mfma_f32_16x16x32_bf16 v[96:99], a[136:139], v[136:139], v[96:99]
  v_exp_f32 v89, v89
  v_mfma_f32_16x16x32_bf16 v[96:99], a[140:143], v[140:143], v[96:99]
  ds_read_b128 a[148:151], v213 offset:28672
  v_cvt_pk_bf16_f32 v88, v88, v89
  v_mfma_f32_16x16x32_bf16 v[104:107], a[140:143], v[156:159], v[196:199]
  v_exp_f32 v90, v90
  v_mfma_f32_16x16x32_bf16 v[104:107], a[136:139], v[152:155], v[104:107]
  ds_read_b128 a[152:155], v214 offset:28672
  v_mfma_f32_16x16x32_bf16 v[104:107], a[132:135], v[148:151], v[104:107]
  v_exp_f32 v91, v91
  v_mfma_f32_16x16x32_bf16 v[104:107], a[128:131], v[144:147], v[104:107]
  ds_read_b128 a[156:159], v215 offset:28672
  v_cvt_pk_bf16_f32 v89, v90, v91
  v_mfma_f32_16x16x32_bf16 v[112:115], a[128:131], v[160:163], v[200:203]
  v_exp_f32 v68, v68
  v_mfma_f32_16x16x32_bf16 v[112:115], a[132:135], v[164:167], v[112:115]
  buffer_load_dwordx4 v233, s[12:15], s29 offen offset:1024 lds
  v_mfma_f32_16x16x32_bf16 v[112:115], a[136:139], v[168:171], v[112:115]
  v_exp_f32 v69, v69
  v_mfma_f32_16x16x32_bf16 v[112:115], a[140:143], v[172:175], v[112:115]
  v_cvt_pk_bf16_f32 v66, v68, v69
  v_mfma_f32_16x16x32_bf16 v[120:123], a[140:143], v[188:191], v[204:207]
  v_exp_f32 v70, v70
  v_mfma_f32_16x16x32_bf16 v[120:123], a[136:139], v[184:187], v[120:123]
  buffer_load_dwordx4 v234, s[12:15], s29 offen offset:2048 lds
  v_mfma_f32_16x16x32_bf16 v[120:123], a[132:135], v[180:183], v[120:123]
  s_waitcnt lgkmcnt(0)
  v_exp_f32 v71, v71
  v_mfma_f32_16x16x32_bf16 v[120:123], a[128:131], v[176:179], v[120:123]
  v_cvt_pk_bf16_f32 v67, v70, v71
  v_mfma_f32_16x16x32_bf16 v[100:103], a[144:147], v[128:131], v[192:195]
  v_exp_f32 v76, v76
  v_mfma_f32_16x16x32_bf16 v[100:103], a[148:151], v[132:135], v[100:103]
  ds_read_b64_tr_b16 a[160:161], v216 offset:0
  v_mfma_f32_16x16x32_bf16 v[100:103], a[152:155], v[136:139], v[100:103]
  v_exp_f32 v77, v77
  v_mfma_f32_16x16x32_bf16 v[100:103], a[156:159], v[140:143], v[100:103]
  ds_read_b64_tr_b16 a[162:163], v216 offset:4096
  v_cvt_pk_bf16_f32 v74, v76, v77
  v_mfma_f32_16x16x32_bf16 v[108:111], a[156:159], v[156:159], v[196:199]
  v_exp_f32 v78, v78
  v_mfma_f32_16x16x32_bf16 v[108:111], a[152:155], v[152:155], v[108:111]
  ds_read_b64_tr_b16 a[164:165], v216 offset:8192
  buffer_load_dwordx4 v235, s[12:15], s29 offen offset:3072 lds
  v_mfma_f32_16x16x32_bf16 v[108:111], a[148:151], v[148:151], v[108:111]
  v_exp_f32 v79, v79
  v_mfma_f32_16x16x32_bf16 v[108:111], a[144:147], v[144:147], v[108:111]
  ds_read_b64_tr_b16 a[166:167], v216 offset:12288
  v_cvt_pk_bf16_f32 v75, v78, v79
  v_mfma_f32_16x16x32_bf16 v[116:119], a[144:147], v[160:163], v[200:203]
  v_exp_f32 v84, v84
  v_mfma_f32_16x16x32_bf16 v[116:119], a[148:151], v[164:167], v[116:119]
  ds_read_b64_tr_b16 a[168:169], v217 offset:0
  s_add_u32 m0, s50, 5120
  v_mfma_f32_16x16x32_bf16 v[116:119], a[152:155], v[168:171], v[116:119]
  v_exp_f32 v85, v85
  v_mfma_f32_16x16x32_bf16 v[116:119], a[156:159], v[172:175], v[116:119]
  ds_read_b64_tr_b16 a[170:171], v217 offset:4096
  v_cvt_pk_bf16_f32 v82, v84, v85
  v_mfma_f32_16x16x32_bf16 v[124:127], a[156:159], v[188:191], v[204:207]
  v_exp_f32 v86, v86
  v_mfma_f32_16x16x32_bf16 v[124:127], a[152:155], v[184:187], v[124:127]
  ds_read_b64_tr_b16 a[172:173], v217 offset:8192
  buffer_load_dwordx4 v253, s[44:47], s35 offen lds
  s_add_u32 s35, s35, 221184
  v_mfma_f32_16x16x32_bf16 v[124:127], a[148:151], v[180:183], v[124:127]
  v_exp_f32 v87, v87
  v_mfma_f32_16x16x32_bf16 v[124:127], a[144:147], v[176:179], v[124:127]
  ds_read_b64_tr_b16 a[174:175], v217 offset:12288
  v_cvt_pk_bf16_f32 v83, v86, v87
  v_mfma_f32_16x16x32_bf16 a[192:195], a[208:211], v[0:3], a[192:195]
  v_exp_f32 v92, v92
  v_mfma_f32_16x16x32_bf16 a[192:195], a[208:211], v[32:35], a[192:195]
  ds_read_b64_tr_b16 a[176:177], v218 offset:0
  v_mfma_f32_16x16x32_bf16 a[196:199], a[208:211], v[8:11], a[196:199]
  v_exp_f32 v93, v93
  v_mfma_f32_16x16x32_bf16 a[196:199], a[208:211], v[40:43], a[196:199]
  ds_read_b64_tr_b16 a[178:179], v218 offset:4096
  v_cvt_pk_bf16_f32 v90, v92, v93
  v_mfma_f32_16x16x32_bf16 a[200:203], a[208:211], v[16:19], a[200:203]
  v_exp_f32 v94, v94
  v_mfma_f32_16x16x32_bf16 a[200:203], a[208:211], v[48:51], a[200:203]
  ds_read_b64_tr_b16 a[180:181], v218 offset:8192
  v_mfma_f32_16x16x32_bf16 a[204:207], a[208:211], v[24:27], a[204:207]
  s_waitcnt lgkmcnt(7)
  v_exp_f32 v95, v95
  v_mfma_f32_16x16x32_bf16 a[204:207], a[208:211], v[56:59], a[204:207]
  ds_read_b64_tr_b16 a[182:183], v218 offset:12288
  v_cvt_pk_bf16_f32 v91, v94, v95
  v_mfma_f32_16x16x32_bf16 a[0:3], a[160:163], v[0:3], a[0:3]
  v_exp_f32 v96, v96
  v_mfma_f32_16x16x32_bf16 a[0:3], a[164:167], v[32:35], a[0:3]
  ds_read_b64_tr_b16 a[184:185], v219 offset:0
  v_mfma_f32_16x16x32_bf16 a[4:7], a[164:167], v[40:43], a[4:7]
  v_exp_f32 v97, v97
  v_mfma_f32_16x16x32_bf16 a[4:7], a[160:163], v[8:11], a[4:7]
  ds_read_b64_tr_b16 a[186:187], v219 offset:4096
  v_cvt_pk_bf16_f32 v96, v96, v97
  v_mfma_f32_16x16x32_bf16 a[8:11], a[160:163], v[16:19], a[8:11]
  v_exp_f32 v98, v98
  v_mfma_f32_16x16x32_bf16 a[8:11], a[164:167], v[48:51], a[8:11]
  ds_read_b64_tr_b16 a[188:189], v219 offset:8192
  v_mfma_f32_16x16x32_bf16 a[12:15], a[164:167], v[56:59], a[12:15]
  s_waitcnt lgkmcnt(7)
  v_exp_f32 v99, v99
  v_mfma_f32_16x16x32_bf16 a[12:15], a[160:163], v[24:27], a[12:15]
  ds_read_b64_tr_b16 a[190:191], v219 offset:12288
  v_cvt_pk_bf16_f32 v97, v98, v99
  v_mfma_f32_16x16x32_bf16 a[16:19], a[168:171], v[0:3], a[16:19]
  v_exp_f32 v104, v104
  v_mfma_f32_16x16x32_bf16 a[16:19], a[172:175], v[32:35], a[16:19]
  ds_read_b64_tr_b16 a[160:161], v220 offset:0
  v_mfma_f32_16x16x32_bf16 a[20:23], a[172:175], v[40:43], a[20:23]
  v_exp_f32 v105, v105
  v_mfma_f32_16x16x32_bf16 a[20:23], a[168:171], v[8:11], a[20:23]
  ds_read_b64_tr_b16 a[162:163], v220 offset:4096
  v_cvt_pk_bf16_f32 v104, v104, v105
  v_mfma_f32_16x16x32_bf16 a[24:27], a[168:171], v[16:19], a[24:27]
  v_exp_f32 v106, v106
  v_mfma_f32_16x16x32_bf16 a[24:27], a[172:175], v[48:51], a[24:27]
  ds_read_b64_tr_b16 a[164:165], v220 offset:8192
  v_mfma_f32_16x16x32_bf16 a[28:31], a[172:175], v[56:59], a[28:31]
  s_waitcnt lgkmcnt(7)
  v_exp_f32 v107, v107
  v_mfma_f32_16x16x32_bf16 a[28:31], a[168:171], v[24:27], a[28:31]
  ds_read_b64_tr_b16 a[166:167], v220 offset:12288
  v_cvt_pk_bf16_f32 v105, v106, v107
  v_mfma_f32_16x16x32_bf16 a[32:35], a[176:179], v[0:3], a[32:35]
  v_exp_f32 v112, v112
  v_mfma_f32_16x16x32_bf16 a[32:35], a[180:183], v[32:35], a[32:35]
  ds_read_b64_tr_b16 a[168:169], v221 offset:0
  v_mfma_f32_16x16x32_bf16 a[36:39], a[180:183], v[40:43], a[36:39]
  v_exp_f32 v113, v113
  v_mfma_f32_16x16x32_bf16 a[36:39], a[176:179], v[8:11], a[36:39]
  ds_read_b64_tr_b16 a[170:171], v221 offset:4096
  v_cvt_pk_bf16_f32 v112, v112, v113
  v_mfma_f32_16x16x32_bf16 a[40:43], a[176:179], v[16:19], a[40:43]
  v_exp_f32 v114, v114
  v_mfma_f32_16x16x32_bf16 a[40:43], a[180:183], v[48:51], a[40:43]
  ds_read_b64_tr_b16 a[172:173], v221 offset:8192
  v_mfma_f32_16x16x32_bf16 a[44:47], a[180:183], v[56:59], a[44:47]
  s_waitcnt lgkmcnt(7)
  v_exp_f32 v115, v115
  v_mfma_f32_16x16x32_bf16 a[44:47], a[176:179], v[24:27], a[44:47]
  ds_read_b64_tr_b16 a[174:175], v221 offset:12288
  v_cvt_pk_bf16_f32 v113, v114, v115
  v_mfma_f32_16x16x32_bf16 a[48:51], a[184:187], v[0:3], a[48:51]
  v_exp_f32 v120, v120
  v_mfma_f32_16x16x32_bf16 a[48:51], a[188:191], v[32:35], a[48:51]
  ds_read_b64_tr_b16 a[176:177], v222 offset:0
  v_mfma_f32_16x16x32_bf16 a[52:55], a[188:191], v[40:43], a[52:55]
  v_exp_f32 v121, v121
  v_mfma_f32_16x16x32_bf16 a[52:55], a[184:187], v[8:11], a[52:55]
  ds_read_b64_tr_b16 a[178:179], v222 offset:4096
  v_cvt_pk_bf16_f32 v120, v120, v121
  v_mfma_f32_16x16x32_bf16 a[56:59], a[184:187], v[16:19], a[56:59]
  v_exp_f32 v122, v122
  v_mfma_f32_16x16x32_bf16 a[56:59], a[188:191], v[48:51], a[56:59]
  ds_read_b64_tr_b16 a[180:181], v222 offset:8192
  v_mfma_f32_16x16x32_bf16 a[60:63], a[188:191], v[56:59], a[60:63]
  s_waitcnt lgkmcnt(7)
  v_exp_f32 v123, v123
  v_mfma_f32_16x16x32_bf16 a[60:63], a[184:187], v[24:27], a[60:63]
  ds_read_b64_tr_b16 a[182:183], v222 offset:12288
  v_cvt_pk_bf16_f32 v121, v122, v123
  v_mfma_f32_16x16x32_bf16 a[64:67], a[160:163], v[0:3], a[64:67]
  v_exp_f32 v100, v100
  v_mfma_f32_16x16x32_bf16 a[64:67], a[164:167], v[32:35], a[64:67]
  ds_read_b64_tr_b16 a[184:185], v223 offset:0
  v_mfma_f32_16x16x32_bf16 a[68:71], a[164:167], v[40:43], a[68:71]
  v_exp_f32 v101, v101
  v_mfma_f32_16x16x32_bf16 a[68:71], a[160:163], v[8:11], a[68:71]
  ds_read_b64_tr_b16 a[186:187], v223 offset:4096
  v_cvt_pk_bf16_f32 v98, v100, v101
  v_mfma_f32_16x16x32_bf16 a[72:75], a[160:163], v[16:19], a[72:75]
  v_exp_f32 v102, v102
  v_mfma_f32_16x16x32_bf16 a[72:75], a[164:167], v[48:51], a[72:75]
  ds_read_b64_tr_b16 a[188:189], v223 offset:8192
  v_mfma_f32_16x16x32_bf16 a[76:79], a[164:167], v[56:59], a[76:79]
  s_waitcnt lgkmcnt(7)
  v_exp_f32 v103, v103
  v_mfma_f32_16x16x32_bf16 a[76:79], a[160:163], v[24:27], a[76:79]
  ds_read_b64_tr_b16 a[190:191], v223 offset:12288
  v_cvt_pk_bf16_f32 v99, v102, v103
  v_mfma_f32_16x16x32_bf16 a[80:83], a[168:171], v[0:3], a[80:83]
  s_waitcnt vmcnt(11)
  v_exp_f32 v108, v108
  v_mfma_f32_16x16x32_bf16 a[80:83], a[172:175], v[32:35], a[80:83]
  v_mfma_f32_16x16x32_bf16 a[84:87], a[172:175], v[40:43], a[84:87]
  s_barrier
  v_exp_f32 v109, v109
  v_mfma_f32_16x16x32_bf16 a[84:87], a[168:171], v[8:11], a[84:87]
  ds_read_b128 a[128:131], v212 offset:32768
  v_cvt_pk_bf16_f32 v106, v108, v109
  v_mfma_f32_16x16x32_bf16 a[88:91], a[168:171], v[16:19], a[88:91]
  v_exp_f32 v110, v110
  v_mfma_f32_16x16x32_bf16 a[88:91], a[172:175], v[48:51], a[88:91]
  ds_read_b128 a[132:135], v213 offset:32768
  v_mfma_f32_16x16x32_bf16 a[92:95], a[172:175], v[56:59], a[92:95]
  s_waitcnt lgkmcnt(6)
  v_exp_f32 v111, v111
  v_mfma_f32_16x16x32_bf16 a[92:95], a[168:171], v[24:27], a[92:95]
  ds_read_b128 a[136:139], v214 offset:32768
  v_cvt_pk_bf16_f32 v107, v110, v111
  v_mfma_f32_16x16x32_bf16 a[96:99], a[176:179], v[0:3], a[96:99]
  v_exp_f32 v116, v116
  v_mfma_f32_16x16x32_bf16 a[96:99], a[180:183], v[32:35], a[96:99]
  ds_read_b128 a[140:143], v215 offset:32768
  buffer_load_dwordx4 a[228:231], v243, s[24:27], s38 offen sc1
  s_add_u32 s38, s38, 4096
  v_mfma_f32_16x16x32_bf16 a[100:103], a[180:183], v[40:43], a[100:103]
  v_exp_f32 v117, v117
  v_mfma_f32_16x16x32_bf16 a[100:103], a[176:179], v[8:11], a[100:103]
  v_cvt_pk_bf16_f32 v114, v116, v117
  v_mfma_f32_16x16x32_bf16 a[104:107], a[176:179], v[16:19], a[104:107]
  v_exp_f32 v118, v118
  v_mfma_f32_16x16x32_bf16 a[104:107], a[180:183], v[48:51], a[104:107]
  v_mfma_f32_16x16x32_bf16 a[108:111], a[180:183], v[56:59], a[108:111]
  s_waitcnt lgkmcnt(4)
  v_exp_f32 v119, v119
  v_mfma_f32_16x16x32_bf16 a[108:111], a[176:179], v[24:27], a[108:111]
  v_cvt_pk_bf16_f32 v115, v118, v119
  v_mfma_f32_16x16x32_bf16 a[112:115], a[184:187], v[0:3], a[112:115]
  v_exp_f32 v124, v124
  v_mfma_f32_16x16x32_bf16 a[112:115], a[188:191], v[32:35], a[112:115]
  v_mfma_f32_16x16x32_bf16 a[116:119], a[188:191], v[40:43], a[116:119]
  v_exp_f32 v125, v125
  v_mfma_f32_16x16x32_bf16 a[116:119], a[184:187], v[8:11], a[116:119]
  v_cvt_pk_bf16_f32 v122, v124, v125
  v_mfma_f32_16x16x32_bf16 a[120:123], a[184:187], v[16:19], a[120:123]
  v_exp_f32 v126, v126
  v_mfma_f32_16x16x32_bf16 a[120:123], a[188:191], v[48:51], a[120:123]
  v_mfma_f32_16x16x32_bf16 a[124:127], a[188:191], v[56:59], a[124:127]
  s_waitcnt lgkmcnt(0)
  v_exp_f32 v127, v127
  v_mfma_f32_16x16x32_bf16 a[124:127], a[184:187], v[24:27], a[124:127]
  v_cvt_pk_bf16_f32 v123, v126, v127
  v_mfma_f32_16x16x32_bf16 v[0:3], a[128:131], v[128:131], v[192:195]
  s_add_u32 m0, s28, 114688
  s_mov_b32 s20, s88
  s_mov_b32 s21, s89
  v_mfma_f32_16x16x32_bf16 v[0:3], a[132:135], v[132:135], v[0:3]
  ds_read_b128 a[144:147], v212 offset:36864
  s_mov_b32 s22, 5242880
  s_mov_b32 s23, 0x20000
  v_lshrrev_b32 v208, 4, v242
  v_mfma_f32_16x16x32_bf16 v[0:3], a[136:139], v[136:139], v[0:3]
  buffer_load_dwordx4 v236, s[16:19], s29 offen offset:0 lds
  v_mfma_f32_16x16x32_bf16 v[0:3], a[140:143], v[140:143], v[0:3]
  ds_read_b128 a[148:151], v213 offset:36864
  v_and_b32 v209, 1, v208
  v_mfma_f32_16x16x32_bf16 v[8:11], a[140:143], v[156:159], v[196:199]
  v_lshrrev_b32 v208, 1, v208
  v_mul_u32_u24 v208, 0x500, v208
  v_mfma_f32_16x16x32_bf16 v[8:11], a[136:139], v[152:155], v[8:11]
  ds_read_b128 a[152:155], v214 offset:36864
  v_lshl_add_u32 v208, v209, 4, v208
  v_mfma_f32_16x16x32_bf16 v[8:11], a[132:135], v[148:151], v[8:11]
  buffer_load_dwordx4 v237, s[16:19], s29 offen offset:1024 lds
  v_mfma_f32_16x16x32_bf16 v[8:11], a[128:131], v[144:147], v[8:11]
  ds_read_b128 a[156:159], v215 offset:36864
  v_lshrrev_b32 v209, 4, v242
  v_mfma_f32_16x16x32_bf16 v[16:19], a[128:131], v[160:163], v[200:203]
  v_exp_f32 v0, v0
  v_mfma_f32_16x16x32_bf16 v[16:19], a[132:135], v[164:167], v[16:19]
  v_lshrrev_b32 v210, 5, v209
  v_lshlrev_b32 v210, 30, v210
  v_mfma_f32_16x16x32_bf16 v[16:19], a[136:139], v[168:171], v[16:19]
  v_exp_f32 v1, v1
  v_mfma_f32_16x16x32_bf16 v[16:19], a[140:143], v[172:175], v[16:19]
  v_cvt_pk_bf16_f32 v0, v0, v1
  v_or_b32 v210, v210, v208
  v_mfma_f32_16x16x32_bf16 v[24:27], a[140:143], v[188:191], v[204:207]
  v_exp_f32 v2, v2
  v_mfma_f32_16x16x32_bf16 v[24:27], a[136:139], v[184:187], v[24:27]
  buffer_load_dwordx4 v236, s[16:19], s29 offen offset:2048 lds
  v_mfma_f32_16x16x32_bf16 v[24:27], a[132:135], v[180:183], v[24:27]
  s_waitcnt lgkmcnt(0)
  v_exp_f32 v3, v3
  v_mfma_f32_16x16x32_bf16 v[24:27], a[128:131], v[176:179], v[24:27]
  v_cvt_pk_bf16_f32 v1, v2, v3
  v_bfe_u32 v211, v209, 2, 4
  v_mfma_f32_16x16x32_bf16 v[4:7], a[144:147], v[128:131], v[192:195]
  v_exp_f32 v8, v8
  v_mfma_f32_16x16x32_bf16 v[4:7], a[148:151], v[132:135], v[4:7]
  ds_read_b128 a[128:131], v212 offset:40960
  v_and_b32 v209, 3, v209
  v_mfma_f32_16x16x32_bf16 v[4:7], a[152:155], v[136:139], v[4:7]
  v_exp_f32 v9, v9
  v_mfma_f32_16x16x32_bf16 v[4:7], a[156:159], v[140:143], v[4:7]
  ds_read_b128 a[132:135], v213 offset:40960
  v_cvt_pk_bf16_f32 v8, v8, v9
  v_mfma_f32_16x16x32_bf16 v[12:15], a[156:159], v[156:159], v[196:199]
  v_exp_f32 v10, v10
  v_mfma_f32_16x16x32_bf16 v[12:15], a[152:155], v[152:155], v[12:15]
  ds_read_b128 a[136:139], v214 offset:40960
  v_lshlrev_b32 v209, 3, v209
  v_mfma_f32_16x16x32_bf16 v[12:15], a[148:151], v[148:151], v[12:15]
  v_exp_f32 v11, v11
  v_mfma_f32_16x16x32_bf16 v[12:15], a[144:147], v[144:147], v[12:15]
  ds_read_b128 a[140:143], v215 offset:40960
  v_cvt_pk_bf16_f32 v9, v10, v11
  v_mfma_f32_16x16x32_bf16 v[20:23], a[144:147], v[160:163], v[200:203]
  v_exp_f32 v16, v16
  v_mfma_f32_16x16x32_bf16 v[20:23], a[148:151], v[164:167], v[20:23]
  buffer_load_dwordx4 v237, s[16:19], s29 offen offset:3072 lds
  v_mfma_f32_16x16x32_bf16 v[20:23], a[152:155], v[168:171], v[20:23]
  s_add_u32 s29, s29, 16384
  v_exp_f32 v17, v17
  v_mfma_f32_16x16x32_bf16 v[20:23], a[156:159], v[172:175], v[20:23]
  v_cvt_pk_bf16_f32 v16, v16, v17
  v_lshl_add_u32 v209, v211, 5, v209
  v_mfma_f32_16x16x32_bf16 v[28:31], a[156:159], v[188:191], v[204:207]
  s_add_u32 m0, s28, 0
  v_exp_f32 v18, v18
  v_mfma_f32_16x16x32_bf16 v[28:31], a[152:155], v[184:187], v[28:31]
  buffer_load_dwordx4 v232, s[12:15], s29 offen offset:0 lds
  v_mfma_f32_16x16x32_bf16 v[28:31], a[148:151], v[180:183], v[28:31]
  s_waitcnt lgkmcnt(0)
  v_exp_f32 v19, v19
  v_mfma_f32_16x16x32_bf16 v[28:31], a[144:147], v[176:179], v[28:31]
  v_cvt_pk_bf16_f32 v17, v18, v19
  v_add_u32 v209, s50, v209
  v_mfma_f32_16x16x32_bf16 v[32:35], a[128:131], v[128:131], v[192:195]
  s_and_b32 s39, s2, 1
  s_lshl_b32 s39, s39, 2
  s_add_u32 s39, s39, s3
  v_exp_f32 v24, v24
  v_mfma_f32_16x16x32_bf16 v[32:35], a[132:135], v[132:135], v[32:35]
  ds_read_b128 a[144:147], v212 offset:45056
  s_lshr_b32 s31, s2, 1
  s_mul_i32 s30, s31, 40960
  s_mul_i32 s48, s39, 160
  v_mfma_f32_16x16x32_bf16 v[32:35], a[136:139], v[136:139], v[32:35]
  s_add_u32 s30, s30, s48
  s_mul_i32 s31, s31, 5120
  s_mul_i32 s39, s39, 655360
  v_exp_f32 v25, v25
  v_mfma_f32_16x16x32_bf16 v[32:35], a[140:143], v[140:143], v[32:35]
  ds_read_b128 a[148:151], v213 offset:45056
  s_add_u32 s31, s31, s39
  s_add_u32 s31, s31, 3145728
  s_lshr_b32 s39, s2, 3
  v_cvt_pk_bf16_f32 v24, v24, v25
  v_mfma_f32_16x16x32_bf16 v[40:43], a[140:143], v[156:159], v[196:199]
  s_min_u32 s39, s39, 29
  s_and_b32 s48, s2, 7
  s_mul_i32 s48, s48, 30
  v_exp_f32 v26, v26
  v_mfma_f32_16x16x32_bf16 v[40:43], a[136:139], v[152:155], v[40:43]
  ds_read_b128 a[152:155], v214 offset:45056
  s_add_u32 s39, s39, s48
  s_mul_i32 s98, s39, 1639
  s_lshr_b32 s98, s98, 16
  v_mfma_f32_16x16x32_bf16 v[40:43], a[132:135], v[148:151], v[40:43]
  s_mul_i32 s99, s98, 40
  s_sub_u32 s99, s39, s99
  s_min_u32 s39, s3, 2
  v_exp_f32 v27, v27
  v_mfma_f32_16x16x32_bf16 v[40:43], a[128:131], v[144:147], v[40:43]
  ds_read_b128 a[156:159], v215 offset:45056
  s_mul_i32 s48, s98, 3
  s_add_u32 s48, s48, s39
  s_mul_i32 s100, s48, 122880
  v_cvt_pk_bf16_f32 v25, v26, v27
  v_mfma_f32_16x16x32_bf16 v[48:51], a[128:131], v[160:163], v[200:203]
  s_lshl_b32 s39, s99, 5
  s_add_u32 s100, s100, s39
  s_mul_i32 s101, s48, 192
  v_exp_f32 v4, v4
  v_mfma_f32_16x16x32_bf16 v[48:51], a[132:135], v[164:167], v[48:51]
  buffer_load_dwordx4 v233, s[12:15], s29 offen offset:1024 lds
  s_add_u32 s101, s101, 2633728
  s_mov_b32 s51, s50
  v_mfma_f32_16x16x32_bf16 v[48:51], a[136:139], v[168:171], v[48:51]
  v_exp_f32 v5, v5
  v_mfma_f32_16x16x32_bf16 v[48:51], a[140:143], v[172:175], v[48:51]
  v_cvt_pk_bf16_f32 v2, v4, v5
  v_mov_b32 v211, v242
  v_mfma_f32_16x16x32_bf16 v[56:59], a[140:143], v[188:191], v[204:207]
  s_mov_b32 s4, s94
  s_mov_b32 s5, s95
  s_mov_b32 s6, 2211840
  v_exp_f32 v6, v6
  v_mfma_f32_16x16x32_bf16 v[56:59], a[136:139], v[184:187], v[56:59]
  buffer_load_dwordx4 v234, s[12:15], s29 offen offset:2048 lds
  s_mov_b32 s7, 0x20000
  s_getpc_b64 s[8:9]
attn_late_pc:
  s_add_u32 s8, s8, attn_h_ready-attn_late_pc
  s_addc_u32 s9, s9, 0
  v_mfma_f32_16x16x32_bf16 v[56:59], a[132:135], v[180:183], v[56:59]
  s_waitcnt lgkmcnt(0)
  s_lshr_b32 s39, s2, 3
  v_exp_f32 v7, v7
  v_mfma_f32_16x16x32_bf16 v[56:59], a[128:131], v[176:179], v[56:59]
  v_cvt_pk_bf16_f32 v3, v6, v7
  v_lshrrev_b32 v252, 4, v242
  v_mfma_f32_16x16x32_bf16 v[36:39], a[144:147], v[128:131], v[192:195]
  v_exp_f32 v12, v12
  v_mfma_f32_16x16x32_bf16 v[36:39], a[148:151], v[132:135], v[36:39]
  ds_read_b64_tr_b16 a[160:161], v216 offset:16384
  v_min_u32 v252, 11, v252
  v_mfma_f32_16x16x32_bf16 v[36:39], a[152:155], v[136:139], v[36:39]
  v_exp_f32 v13, v13
  v_mfma_f32_16x16x32_bf16 v[36:39], a[156:159], v[140:143], v[36:39]
  ds_read_b64_tr_b16 a[162:163], v216 offset:20480
  v_cvt_pk_bf16_f32 v10, v12, v13
  v_mfma_f32_16x16x32_bf16 v[44:47], a[156:159], v[156:159], v[196:199]
  v_exp_f32 v14, v14
  v_mfma_f32_16x16x32_bf16 v[44:47], a[152:155], v[152:155], v[44:47]
  ds_read_b64_tr_b16 a[164:165], v216 offset:24576
  buffer_load_dwordx4 v235, s[12:15], s29 offen offset:3072 lds
  v_mfma_f32_16x16x32_bf16 v[44:47], a[148:151], v[148:151], v[44:47]
  v_exp_f32 v15, v15
  v_mfma_f32_16x16x32_bf16 v[44:47], a[144:147], v[144:147], v[44:47]
  ds_read_b64_tr_b16 a[166:167], v216 offset:28672
  v_cvt_pk_bf16_f32 v11, v14, v15
  v_mfma_f32_16x16x32_bf16 v[52:55], a[144:147], v[160:163], v[200:203]
  v_exp_f32 v20, v20
  v_mfma_f32_16x16x32_bf16 v[52:55], a[148:151], v[164:167], v[52:55]
  ds_read_b64_tr_b16 a[168:169], v217 offset:16384
  v_lshlrev_b32 v252, 5, v252
  v_mfma_f32_16x16x32_bf16 v[52:55], a[152:155], v[168:171], v[52:55]
  v_exp_f32 v21, v21
  v_mfma_f32_16x16x32_bf16 v[52:55], a[156:159], v[172:175], v[52:55]
  ds_read_b64_tr_b16 a[170:171], v217 offset:20480
  v_cvt_pk_bf16_f32 v18, v20, v21
  v_mfma_f32_16x16x32_bf16 v[60:63], a[156:159], v[188:191], v[204:207]
  v_exp_f32 v22, v22
  v_mfma_f32_16x16x32_bf16 v[60:63], a[152:155], v[184:187], v[60:63]
  ds_read_b64_tr_b16 a[172:173], v217 offset:24576
  v_add_u32 v252, s39, v252
  v_mfma_f32_16x16x32_bf16 v[60:63], a[148:151], v[180:183], v[60:63]
  v_exp_f32 v23, v23
  v_mfma_f32_16x16x32_bf16 v[60:63], a[144:147], v[176:179], v[60:63]
  ds_read_b64_tr_b16 a[174:175], v217 offset:28672
  v_cvt_pk_bf16_f32 v19, v22, v23
  v_mfma_f32_16x16x32_bf16 a[192:195], a[208:211], v[64:67], a[192:195]
  v_exp_f32 v28, v28
  v_mfma_f32_16x16x32_bf16 a[192:195], a[208:211], v[96:99], a[192:195]
  ds_read_b64_tr_b16 a[176:177], v218 offset:16384
  v_lshlrev_b32 v252, 7, v252
  v_mfma_f32_16x16x32_bf16 a[196:199], a[208:211], v[72:75], a[196:199]
  v_exp_f32 v29, v29
  v_mfma_f32_16x16x32_bf16 a[196:199], a[208:211], v[104:107], a[196:199]
  ds_read_b64_tr_b16 a[178:179], v218 offset:20480
  v_cvt_pk_bf16_f32 v26, v28, v29
  v_mfma_f32_16x16x32_bf16 a[200:203], a[208:211], v[80:83], a[200:203]
  v_exp_f32 v30, v30
  v_mfma_f32_16x16x32_bf16 a[200:203], a[208:211], v[112:115], a[200:203]
  ds_read_b64_tr_b16 a[180:181], v218 offset:24576
  v_min_u32 v252, attn_end-attn_h_ready-4, v252
  v_mfma_f32_16x16x32_bf16 a[204:207], a[208:211], v[88:91], a[204:207]
  s_waitcnt lgkmcnt(7)
  v_exp_f32 v31, v31
  v_mfma_f32_16x16x32_bf16 a[204:207], a[208:211], v[120:123], a[204:207]
  ds_read_b64_tr_b16 a[182:183], v218 offset:28672
  v_cvt_pk_bf16_f32 v27, v30, v31
  v_mfma_f32_16x16x32_bf16 a[0:3], a[160:163], v[64:67], a[0:3]
  v_exp_f32 v32, v32
  v_mfma_f32_16x16x32_bf16 a[0:3], a[164:167], v[96:99], a[0:3]
  ds_read_b64_tr_b16 a[184:185], v219 offset:16384
  v_mfma_f32_16x16x32_bf16 a[4:7], a[164:167], v[104:107], a[4:7]
  v_exp_f32 v33, v33
  v_mfma_f32_16x16x32_bf16 a[4:7], a[160:163], v[72:75], a[4:7]
  ds_read_b64_tr_b16 a[186:187], v219 offset:20480
  v_cvt_pk_bf16_f32 v32, v32, v33
  v_mfma_f32_16x16x32_bf16 a[8:11], a[160:163], v[80:83], a[8:11]
  v_exp_f32 v34, v34
  v_mfma_f32_16x16x32_bf16 a[8:11], a[164:167], v[112:115], a[8:11]
  ds_read_b64_tr_b16 a[188:189], v219 offset:24576
  v_mfma_f32_16x16x32_bf16 a[12:15], a[164:167], v[120:123], a[12:15]
  s_waitcnt lgkmcnt(7)
  v_exp_f32 v35, v35
  v_mfma_f32_16x16x32_bf16 a[12:15], a[160:163], v[88:91], a[12:15]
  ds_read_b64_tr_b16 a[190:191], v219 offset:28672
  v_cvt_pk_bf16_f32 v33, v34, v35
  v_mfma_f32_16x16x32_bf16 a[16:19], a[168:171], v[64:67], a[16:19]
  v_exp_f32 v40, v40
  v_mfma_f32_16x16x32_bf16 a[16:19], a[172:175], v[96:99], a[16:19]
  ds_read_b64_tr_b16 a[160:161], v220 offset:16384
  v_mfma_f32_16x16x32_bf16 a[20:23], a[172:175], v[104:107], a[20:23]
  v_exp_f32 v41, v41
  v_mfma_f32_16x16x32_bf16 a[20:23], a[168:171], v[72:75], a[20:23]
  ds_read_b64_tr_b16 a[162:163], v220 offset:20480
  v_cvt_pk_bf16_f32 v40, v40, v41
  v_mfma_f32_16x16x32_bf16 a[24:27], a[168:171], v[80:83], a[24:27]
  v_exp_f32 v42, v42
  v_mfma_f32_16x16x32_bf16 a[24:27], a[172:175], v[112:115], a[24:27]
  ds_read_b64_tr_b16 a[164:165], v220 offset:24576
  v_mfma_f32_16x16x32_bf16 a[28:31], a[172:175], v[120:123], a[28:31]
  s_waitcnt lgkmcnt(7)
  v_exp_f32 v43, v43
  v_mfma_f32_16x16x32_bf16 a[28:31], a[168:171], v[88:91], a[28:31]
  ds_read_b64_tr_b16 a[166:167], v220 offset:28672
  v_cvt_pk_bf16_f32 v41, v42, v43
  v_mfma_f32_16x16x32_bf16 a[32:35], a[176:179], v[64:67], a[32:35]
  v_exp_f32 v48, v48
  v_mfma_f32_16x16x32_bf16 a[32:35], a[180:183], v[96:99], a[32:35]
  ds_read_b64_tr_b16 a[168:169], v221 offset:16384
  v_mfma_f32_16x16x32_bf16 a[36:39], a[180:183], v[104:107], a[36:39]
  v_exp_f32 v49, v49
  v_mfma_f32_16x16x32_bf16 a[36:39], a[176:179], v[72:75], a[36:39]
  ds_read_b64_tr_b16 a[170:171], v221 offset:20480
  v_cvt_pk_bf16_f32 v48, v48, v49
  v_mfma_f32_16x16x32_bf16 a[40:43], a[176:179], v[80:83], a[40:43]
  v_exp_f32 v50, v50
  v_mfma_f32_16x16x32_bf16 a[40:43], a[180:183], v[112:115], a[40:43]
  ds_read_b64_tr_b16 a[172:173], v221 offset:24576
  v_mfma_f32_16x16x32_bf16 a[44:47], a[180:183], v[120:123], a[44:47]
  s_waitcnt lgkmcnt(7)
  v_exp_f32 v51, v51
  v_mfma_f32_16x16x32_bf16 a[44:47], a[176:179], v[88:91], a[44:47]
  ds_read_b64_tr_b16 a[174:175], v221 offset:28672
  v_cvt_pk_bf16_f32 v49, v50, v51
  v_mfma_f32_16x16x32_bf16 a[48:51], a[184:187], v[64:67], a[48:51]
  v_exp_f32 v56, v56
  v_mfma_f32_16x16x32_bf16 a[48:51], a[188:191], v[96:99], a[48:51]
  ds_read_b64_tr_b16 a[176:177], v222 offset:16384
  v_mfma_f32_16x16x32_bf16 a[52:55], a[188:191], v[104:107], a[52:55]
  v_exp_f32 v57, v57
  v_mfma_f32_16x16x32_bf16 a[52:55], a[184:187], v[72:75], a[52:55]
  ds_read_b64_tr_b16 a[178:179], v222 offset:20480
  v_cvt_pk_bf16_f32 v56, v56, v57
  v_mfma_f32_16x16x32_bf16 a[56:59], a[184:187], v[80:83], a[56:59]
  v_exp_f32 v58, v58
  v_mfma_f32_16x16x32_bf16 a[56:59], a[188:191], v[112:115], a[56:59]
  ds_read_b64_tr_b16 a[180:181], v222 offset:24576
  v_mfma_f32_16x16x32_bf16 a[60:63], a[188:191], v[120:123], a[60:63]
  s_waitcnt lgkmcnt(7)
  v_exp_f32 v59, v59
  v_mfma_f32_16x16x32_bf16 a[60:63], a[184:187], v[88:91], a[60:63]
  ds_read_b64_tr_b16 a[182:183], v222 offset:28672
  v_cvt_pk_bf16_f32 v57, v58, v59
  v_mfma_f32_16x16x32_bf16 a[64:67], a[160:163], v[64:67], a[64:67]
  v_exp_f32 v36, v36
  v_mfma_f32_16x16x32_bf16 a[64:67], a[164:167], v[96:99], a[64:67]
  ds_read_b64_tr_b16 a[184:185], v223 offset:16384
  v_mfma_f32_16x16x32_bf16 a[68:71], a[164:167], v[104:107], a[68:71]
  v_exp_f32 v37, v37
  v_mfma_f32_16x16x32_bf16 a[68:71], a[160:163], v[72:75], a[68:71]
  ds_read_b64_tr_b16 a[186:187], v223 offset:20480
  v_cvt_pk_bf16_f32 v34, v36, v37
  v_mfma_f32_16x16x32_bf16 a[72:75], a[160:163], v[80:83], a[72:75]
  v_exp_f32 v38, v38
  v_mfma_f32_16x16x32_bf16 a[72:75], a[164:167], v[112:115], a[72:75]
  ds_read_b64_tr_b16 a[188:189], v223 offset:24576
  v_mfma_f32_16x16x32_bf16 a[76:79], a[164:167], v[120:123], a[76:79]
  s_waitcnt lgkmcnt(7)
  v_exp_f32 v39, v39
  v_mfma_f32_16x16x32_bf16 a[76:79], a[160:163], v[88:91], a[76:79]
  ds_read_b64_tr_b16 a[190:191], v223 offset:28672
  v_cvt_pk_bf16_f32 v35, v38, v39
  v_mfma_f32_16x16x32_bf16 a[80:83], a[168:171], v[64:67], a[80:83]
  s_waitcnt vmcnt(10)
  v_exp_f32 v44, v44
  v_mfma_f32_16x16x32_bf16 a[80:83], a[172:175], v[96:99], a[80:83]
  v_mfma_f32_16x16x32_bf16 a[84:87], a[172:175], v[104:107], a[84:87]
  s_barrier
  v_exp_f32 v45, v45
  v_mfma_f32_16x16x32_bf16 a[84:87], a[168:171], v[72:75], a[84:87]
  ds_read_b128 a[128:131], v212 offset:49152
  v_cvt_pk_bf16_f32 v42, v44, v45
  v_mfma_f32_16x16x32_bf16 a[88:91], a[168:171], v[80:83], a[88:91]
  v_exp_f32 v46, v46
  v_mfma_f32_16x16x32_bf16 a[88:91], a[172:175], v[112:115], a[88:91]
  ds_read_b128 a[132:135], v213 offset:49152
  v_mfma_f32_16x16x32_bf16 a[92:95], a[172:175], v[120:123], a[92:95]
  s_waitcnt lgkmcnt(6)
  v_exp_f32 v47, v47
  v_mfma_f32_16x16x32_bf16 a[92:95], a[168:171], v[88:91], a[92:95]
  ds_read_b128 a[136:139], v214 offset:49152
  v_cvt_pk_bf16_f32 v43, v46, v47
  v_mfma_f32_16x16x32_bf16 a[96:99], a[176:179], v[64:67], a[96:99]
  v_exp_f32 v52, v52
  v_mfma_f32_16x16x32_bf16 a[96:99], a[180:183], v[96:99], a[96:99]
  ds_read_b128 a[140:143], v215 offset:49152
  v_mfma_f32_16x16x32_bf16 a[100:103], a[180:183], v[104:107], a[100:103]
  v_exp_f32 v53, v53
  v_mfma_f32_16x16x32_bf16 a[100:103], a[176:179], v[72:75], a[100:103]
  v_cvt_pk_bf16_f32 v50, v52, v53
  v_mfma_f32_16x16x32_bf16 a[104:107], a[176:179], v[80:83], a[104:107]
  v_exp_f32 v54, v54
  v_mfma_f32_16x16x32_bf16 a[104:107], a[180:183], v[112:115], a[104:107]
  v_mfma_f32_16x16x32_bf16 a[108:111], a[180:183], v[120:123], a[108:111]
  s_waitcnt lgkmcnt(4)
  v_exp_f32 v55, v55
  v_mfma_f32_16x16x32_bf16 a[108:111], a[176:179], v[88:91], a[108:111]
  v_cvt_pk_bf16_f32 v51, v54, v55
  v_mfma_f32_16x16x32_bf16 a[112:115], a[184:187], v[64:67], a[112:115]
  v_exp_f32 v60, v60
  v_mfma_f32_16x16x32_bf16 a[112:115], a[188:191], v[96:99], a[112:115]
  v_mfma_f32_16x16x32_bf16 a[116:119], a[188:191], v[104:107], a[116:119]
  v_exp_f32 v61, v61
  v_mfma_f32_16x16x32_bf16 a[116:119], a[184:187], v[72:75], a[116:119]
  v_cvt_pk_bf16_f32 v58, v60, v61
  v_mfma_f32_16x16x32_bf16 a[120:123], a[184:187], v[80:83], a[120:123]
  v_exp_f32 v62, v62
  v_mfma_f32_16x16x32_bf16 a[120:123], a[188:191], v[112:115], a[120:123]
  v_mfma_f32_16x16x32_bf16 a[124:127], a[188:191], v[120:123], a[124:127]
  s_waitcnt lgkmcnt(0)
  v_exp_f32 v63, v63
  v_mfma_f32_16x16x32_bf16 a[124:127], a[184:187], v[88:91], a[124:127]
  v_cvt_pk_bf16_f32 v59, v62, v63
  v_mfma_f32_16x16x32_bf16 v[64:67], a[128:131], v[128:131], v[192:195]
  s_add_u32 m0, s28, 65536
  v_lshrrev_b32 v224, 4, v242
  v_lshrrev_b32 v225, 4, v224
  v_mfma_f32_16x16x32_bf16 v[64:67], a[132:135], v[132:135], v[64:67]
  ds_read_b128 a[144:147], v212 offset:53248
  v_bfe_u32 v226, v224, 2, 2
  v_mfma_f32_16x16x32_bf16 v[64:67], a[136:139], v[136:139], v[64:67]
  buffer_load_dwordx4 v236, s[16:19], s29 offen offset:0 lds
  v_mfma_f32_16x16x32_bf16 v[64:67], a[140:143], v[140:143], v[64:67]
  ds_read_b128 a[148:151], v213 offset:53248
  v_lshl_add_u32 v225, v225, 3, v226
  v_mfma_f32_16x16x32_bf16 v[72:75], a[140:143], v[156:159], v[196:199]
  v_lshlrev_b32 v225, 4, v225
  v_bfe_u32 v226, v224, 1, 1
  v_mfma_f32_16x16x32_bf16 v[72:75], a[136:139], v[152:155], v[72:75]
  ds_read_b128 a[152:155], v214 offset:53248
  v_mul_u32_u24 v226, 0xc00, v226
  v_mfma_f32_16x16x32_bf16 v[72:75], a[132:135], v[148:151], v[72:75]
  buffer_load_dwordx4 v237, s[16:19], s29 offen offset:1024 lds
  v_mfma_f32_16x16x32_bf16 v[72:75], a[128:131], v[144:147], v[72:75]
  ds_read_b128 a[156:159], v215 offset:53248
  v_add3_u32 v225, v225, v226, s50
  v_mfma_f32_16x16x32_bf16 v[80:83], a[128:131], v[160:163], v[200:203]
  v_exp_f32 v64, v64
  v_mfma_f32_16x16x32_bf16 v[80:83], a[132:135], v[164:167], v[80:83]
  v_and_b32 v226, 1, v224
  v_lshl_add_u32 v225, v226, 3, v225
  v_mfma_f32_16x16x32_bf16 v[80:83], a[136:139], v[168:171], v[80:83]
  s_waitcnt vmcnt(10)
  v_exp_f32 v65, v65
  v_mfma_f32_16x16x32_bf16 v[80:83], a[140:143], v[172:175], v[80:83]
  ds_read_b64_tr_b16 a[232:233], v225 offset:0
  v_cvt_pk_bf16_f32 v64, v64, v65
  v_mfma_f32_16x16x32_bf16 v[88:91], a[140:143], v[188:191], v[204:207]
  v_exp_f32 v66, v66
  v_mfma_f32_16x16x32_bf16 v[88:91], a[136:139], v[184:187], v[88:91]
  buffer_load_dwordx4 v236, s[16:19], s29 offen offset:2048 lds
  v_mfma_f32_16x16x32_bf16 v[88:91], a[132:135], v[180:183], v[88:91]
  s_waitcnt lgkmcnt(1)
  v_exp_f32 v67, v67
  v_mfma_f32_16x16x32_bf16 v[88:91], a[128:131], v[176:179], v[88:91]
  ds_read_b64_tr_b16 a[234:235], v225 offset:64
  v_cvt_pk_bf16_f32 v65, v66, v67
  v_mfma_f32_16x16x32_bf16 v[68:71], a[144:147], v[128:131], v[192:195]
  v_exp_f32 v72, v72
  v_mfma_f32_16x16x32_bf16 v[68:71], a[148:151], v[132:135], v[68:71]
  ds_read_b128 a[128:131], v212 offset:57344
  ds_read_b64_tr_b16 a[236:237], v225 offset:512
  v_mfma_f32_16x16x32_bf16 v[68:71], a[152:155], v[136:139], v[68:71]
  v_exp_f32 v73, v73
  v_mfma_f32_16x16x32_bf16 v[68:71], a[156:159], v[140:143], v[68:71]
  ds_read_b128 a[132:135], v213 offset:57344
  v_cvt_pk_bf16_f32 v72, v72, v73
  v_mfma_f32_16x16x32_bf16 v[76:79], a[156:159], v[156:159], v[196:199]
  v_exp_f32 v74, v74
  v_mfma_f32_16x16x32_bf16 v[76:79], a[152:155], v[152:155], v[76:79]
  ds_read_b128 a[136:139], v214 offset:57344
  ds_read_b64_tr_b16 a[238:239], v225 offset:576
  v_mfma_f32_16x16x32_bf16 v[76:79], a[148:151], v[148:151], v[76:79]
  v_exp_f32 v75, v75
  v_mfma_f32_16x16x32_bf16 v[76:79], a[144:147], v[144:147], v[76:79]
  ds_read_b128 a[140:143], v215 offset:57344
  v_cvt_pk_bf16_f32 v73, v74, v75
  v_mfma_f32_16x16x32_bf16 v[84:87], a[144:147], v[160:163], v[200:203]
  v_exp_f32 v80, v80
  v_mfma_f32_16x16x32_bf16 v[84:87], a[148:151], v[164:167], v[84:87]
  buffer_load_dwordx4 v237, s[16:19], s29 offen offset:3072 lds
  v_mfma_f32_16x16x32_bf16 v[84:87], a[152:155], v[168:171], v[84:87]
  s_add_u32 s29, s29, 16384
  v_exp_f32 v81, v81
  v_mfma_f32_16x16x32_bf16 v[84:87], a[156:159], v[172:175], v[84:87]
  ds_read_b64_tr_b16 a[240:241], v225 offset:1024
  v_cvt_pk_bf16_f32 v80, v80, v81
  v_mfma_f32_16x16x32_bf16 v[92:95], a[156:159], v[188:191], v[204:207]
  s_add_u32 m0, s28, 16384
  v_exp_f32 v82, v82
  v_mfma_f32_16x16x32_bf16 v[92:95], a[152:155], v[184:187], v[92:95]
  buffer_load_dwordx4 v232, s[12:15], s29 offen offset:0 lds
  v_mfma_f32_16x16x32_bf16 v[92:95], a[148:151], v[180:183], v[92:95]
  s_waitcnt lgkmcnt(1)
  v_exp_f32 v83, v83
  v_mfma_f32_16x16x32_bf16 v[92:95], a[144:147], v[176:179], v[92:95]
  ds_read_b64_tr_b16 a[242:243], v225 offset:1088
  v_cvt_pk_bf16_f32 v81, v82, v83
  v_mfma_f32_16x16x32_bf16 v[96:99], a[128:131], v[128:131], v[192:195]
  v_exp_f32 v88, v88
  v_mfma_f32_16x16x32_bf16 v[96:99], a[132:135], v[132:135], v[96:99]
  ds_read_b128 a[144:147], v212 offset:61440
  ds_read_b64_tr_b16 a[244:245], v225 offset:1536
  v_mfma_f32_16x16x32_bf16 v[96:99], a[136:139], v[136:139], v[96:99]
  v_exp_f32 v89, v89
  v_mfma_f32_16x16x32_bf16 v[96:99], a[140:143], v[140:143], v[96:99]
  ds_read_b128 a[148:151], v213 offset:61440
  v_cvt_pk_bf16_f32 v88, v88, v89
  v_mfma_f32_16x16x32_bf16 v[104:107], a[140:143], v[156:159], v[196:199]
  v_exp_f32 v90, v90
  v_mfma_f32_16x16x32_bf16 v[104:107], a[136:139], v[152:155], v[104:107]
  ds_read_b128 a[152:155], v214 offset:61440
  ds_read_b64_tr_b16 a[246:247], v225 offset:1600
  v_mfma_f32_16x16x32_bf16 v[104:107], a[132:135], v[148:151], v[104:107]
  v_exp_f32 v91, v91
  v_mfma_f32_16x16x32_bf16 v[104:107], a[128:131], v[144:147], v[104:107]
  ds_read_b128 a[156:159], v215 offset:61440
  v_cvt_pk_bf16_f32 v89, v90, v91
  v_mfma_f32_16x16x32_bf16 v[112:115], a[128:131], v[160:163], v[200:203]
  v_exp_f32 v68, v68
  v_mfma_f32_16x16x32_bf16 v[112:115], a[132:135], v[164:167], v[112:115]
  buffer_load_dwordx4 v233, s[12:15], s29 offen offset:1024 lds
  v_mfma_f32_16x16x32_bf16 v[112:115], a[136:139], v[168:171], v[112:115]
  v_exp_f32 v69, v69
  v_mfma_f32_16x16x32_bf16 v[112:115], a[140:143], v[172:175], v[112:115]
  ds_read_b64_tr_b16 a[248:249], v225 offset:2048
  v_cvt_pk_bf16_f32 v66, v68, v69
  v_mfma_f32_16x16x32_bf16 v[120:123], a[140:143], v[188:191], v[204:207]
  v_exp_f32 v70, v70
  v_mfma_f32_16x16x32_bf16 v[120:123], a[136:139], v[184:187], v[120:123]
  buffer_load_dwordx4 v234, s[12:15], s29 offen offset:2048 lds
  v_mfma_f32_16x16x32_bf16 v[120:123], a[132:135], v[180:183], v[120:123]
  s_waitcnt lgkmcnt(1)
  v_exp_f32 v71, v71
  v_mfma_f32_16x16x32_bf16 v[120:123], a[128:131], v[176:179], v[120:123]
  ds_read_b64_tr_b16 a[250:251], v225 offset:2112
  v_cvt_pk_bf16_f32 v67, v70, v71
  v_mfma_f32_16x16x32_bf16 v[100:103], a[144:147], v[128:131], v[192:195]
  v_exp_f32 v76, v76
  v_mfma_f32_16x16x32_bf16 v[100:103], a[148:151], v[132:135], v[100:103]
  ds_read_b64_tr_b16 a[160:161], v216 offset:32768
  v_mfma_f32_16x16x32_bf16 v[100:103], a[152:155], v[136:139], v[100:103]
  v_exp_f32 v77, v77
  v_mfma_f32_16x16x32_bf16 v[100:103], a[156:159], v[140:143], v[100:103]
  ds_read_b64_tr_b16 a[162:163], v216 offset:36864
  v_cvt_pk_bf16_f32 v74, v76, v77
  v_mfma_f32_16x16x32_bf16 v[108:111], a[156:159], v[156:159], v[196:199]
  v_exp_f32 v78, v78
  v_mfma_f32_16x16x32_bf16 v[108:111], a[152:155], v[152:155], v[108:111]
  ds_read_b64_tr_b16 a[164:165], v216 offset:40960
  buffer_load_dwordx4 v235, s[12:15], s29 offen offset:3072 lds
  v_mfma_f32_16x16x32_bf16 v[108:111], a[148:151], v[148:151], v[108:111]
  v_exp_f32 v79, v79
  v_mfma_f32_16x16x32_bf16 v[108:111], a[144:147], v[144:147], v[108:111]
  ds_read_b64_tr_b16 a[166:167], v216 offset:45056
  s_waitcnt lgkmcnt(4)
  v_cvt_pk_bf16_f32 v75, v78, v79
  v_mfma_f32_16x16x32_bf16 v[116:119], a[144:147], v[160:163], v[200:203]
  v_exp_f32 v84, v84
  v_mfma_f32_16x16x32_bf16 v[116:119], a[148:151], v[164:167], v[116:119]
  ds_read_b64_tr_b16 a[168:169], v217 offset:32768
  v_mfma_f32_16x16x32_bf16 v[228:231], a[232:235], a[212:215], 0
  v_mfma_f32_16x16x32_bf16 v[228:231], a[236:239], a[216:219], v[228:231]
  v_mfma_f32_16x16x32_bf16 v[228:231], a[240:243], a[220:223], v[228:231]
  v_mfma_f32_16x16x32_bf16 v[228:231], a[244:247], a[224:227], v[228:231]
  v_mfma_f32_16x16x32_bf16 v[228:231], a[248:251], a[228:231], v[228:231]
  v_mfma_f32_16x16x32_bf16 v[116:119], a[152:155], v[168:171], v[116:119]
  s_lshl_b32 s35, s3, 10
  s_add_u32 s35, s35, 159744
  v_exp_f32 v85, v85
  v_mfma_f32_16x16x32_bf16 v[116:119], a[156:159], v[172:175], v[116:119]
  ds_read_b64_tr_b16 a[170:171], v217 offset:36864
  v_cvt_pk_bf16_f32 v82, v84, v85
  v_mfma_f32_16x16x32_bf16 v[124:127], a[156:159], v[188:191], v[204:207]
  v_exp_f32 v86, v86
  v_mfma_f32_16x16x32_bf16 v[124:127], a[152:155], v[184:187], v[124:127]
  ds_read_b64_tr_b16 a[172:173], v217 offset:40960
  v_add_u32 v224, s35, v242
  v_mfma_f32_16x16x32_bf16 v[124:127], a[148:151], v[180:183], v[124:127]
  v_exp_f32 v87, v87
  v_mfma_f32_16x16x32_bf16 v[124:127], a[144:147], v[176:179], v[124:127]
  ds_read_b64_tr_b16 a[174:175], v217 offset:45056
  v_cvt_pk_bf16_f32 v83, v86, v87
  v_mfma_f32_16x16x32_bf16 a[192:195], a[208:211], v[0:3], a[192:195]
  v_exp_f32 v92, v92
  v_mfma_f32_16x16x32_bf16 a[192:195], a[208:211], v[32:35], a[192:195]
  ds_read_b64_tr_b16 a[176:177], v218 offset:32768
  ds_write_b128 v224, v[228:231]
  v_mfma_f32_16x16x32_bf16 a[196:199], a[208:211], v[8:11], a[196:199]
  v_exp_f32 v93, v93
  v_mfma_f32_16x16x32_bf16 a[196:199], a[208:211], v[40:43], a[196:199]
  ds_read_b64_tr_b16 a[178:179], v218 offset:36864
  v_cvt_pk_bf16_f32 v90, v92, v93
  v_mfma_f32_16x16x32_bf16 a[200:203], a[208:211], v[16:19], a[200:203]
  v_exp_f32 v94, v94
  v_mfma_f32_16x16x32_bf16 a[200:203], a[208:211], v[48:51], a[200:203]
  ds_read_b64_tr_b16 a[180:181], v218 offset:40960
  v_mfma_f32_16x16x32_bf16 a[204:207], a[208:211], v[24:27], a[204:207]
  s_waitcnt lgkmcnt(8)
  v_exp_f32 v95, v95
  v_mfma_f32_16x16x32_bf16 a[204:207], a[208:211], v[56:59], a[204:207]
  ds_read_b64_tr_b16 a[182:183], v218 offset:45056
  v_cvt_pk_bf16_f32 v91, v94, v95
  v_mfma_f32_16x16x32_bf16 a[0:3], a[160:163], v[0:3], a[0:3]
  v_exp_f32 v96, v96
  v_mfma_f32_16x16x32_bf16 a[0:3], a[164:167], v[32:35], a[0:3]
  ds_read_b64_tr_b16 a[184:185], v219 offset:32768
  s_waitcnt lgkmcnt(4)
  s_mov_b32 m0, s51
  v_mfma_f32_16x16x32_bf16 a[4:7], a[164:167], v[40:43], a[4:7]
  v_exp_f32 v97, v97
  v_mfma_f32_16x16x32_bf16 a[4:7], a[160:163], v[8:11], a[4:7]
  ds_read_b64_tr_b16 a[186:187], v219 offset:36864
  v_cvt_pk_bf16_f32 v96, v96, v97
  v_mfma_f32_16x16x32_bf16 a[8:11], a[160:163], v[16:19], a[8:11]
  v_exp_f32 v98, v98
  v_mfma_f32_16x16x32_bf16 a[8:11], a[164:167], v[48:51], a[8:11]
  ds_read_b64_tr_b16 a[188:189], v219 offset:40960
  buffer_load_dwordx4 v210, s[4:7], s100 offen lds
  s_add_u32 s100, s100, 20480
  s_add_u32 s51, s51, 512
  v_mfma_f32_16x16x32_bf16 a[12:15], a[164:167], v[56:59], a[12:15]
  v_exp_f32 v99, v99
  v_mfma_f32_16x16x32_bf16 a[12:15], a[160:163], v[24:27], a[12:15]
  ds_read_b64_tr_b16 a[190:191], v219 offset:45056
  v_cvt_pk_bf16_f32 v97, v98, v99
  v_mfma_f32_16x16x32_bf16 a[16:19], a[168:171], v[0:3], a[16:19]
  v_exp_f32 v104, v104
  v_mfma_f32_16x16x32_bf16 a[16:19], a[172:175], v[32:35], a[16:19]
  ds_read_b64_tr_b16 a[160:161], v220 offset:32768
  v_lshrrev_b32 v224, 4, v242
  v_mfma_f32_16x16x32_bf16 a[20:23], a[172:175], v[40:43], a[20:23]
  v_exp_f32 v105, v105
  v_mfma_f32_16x16x32_bf16 a[20:23], a[168:171], v[8:11], a[20:23]
  ds_read_b64_tr_b16 a[162:163], v220 offset:36864
  v_cvt_pk_bf16_f32 v104, v104, v105
  v_mfma_f32_16x16x32_bf16 a[24:27], a[168:171], v[16:19], a[24:27]
  v_exp_f32 v106, v106
  v_mfma_f32_16x16x32_bf16 a[24:27], a[172:175], v[48:51], a[24:27]
  ds_read_b64_tr_b16 a[164:165], v220 offset:40960
  v_bfe_u32 v225, v224, 2, 1
  v_mfma_f32_16x16x32_bf16 a[28:31], a[172:175], v[56:59], a[28:31]
  s_waitcnt lgkmcnt(7)
  v_exp_f32 v107, v107
  v_mfma_f32_16x16x32_bf16 a[28:31], a[168:171], v[24:27], a[28:31]
  ds_read_b64_tr_b16 a[166:167], v220 offset:45056
  v_cvt_pk_bf16_f32 v105, v106, v107
  v_mfma_f32_16x16x32_bf16 a[32:35], a[176:179], v[0:3], a[32:35]
  v_exp_f32 v112, v112
  v_mfma_f32_16x16x32_bf16 a[32:35], a[180:183], v[32:35], a[32:35]
  ds_read_b64_tr_b16 a[168:169], v221 offset:32768
  v_lshlrev_b32 v225, 8, v225
  v_mfma_f32_16x16x32_bf16 a[36:39], a[180:183], v[40:43], a[36:39]
  v_exp_f32 v113, v113
  v_mfma_f32_16x16x32_bf16 a[36:39], a[176:179], v[8:11], a[36:39]
  ds_read_b64_tr_b16 a[170:171], v221 offset:36864
  v_cvt_pk_bf16_f32 v112, v112, v113
  v_mfma_f32_16x16x32_bf16 a[40:43], a[176:179], v[16:19], a[40:43]
  v_exp_f32 v114, v114
  v_mfma_f32_16x16x32_bf16 a[40:43], a[180:183], v[48:51], a[40:43]
  ds_read_b64_tr_b16 a[172:173], v221 offset:40960
  v_lshrrev_b32 v226, 3, v224
  v_mfma_f32_16x16x32_bf16 a[44:47], a[180:183], v[56:59], a[44:47]
  s_waitcnt lgkmcnt(7)
  v_exp_f32 v115, v115
  v_mfma_f32_16x16x32_bf16 a[44:47], a[176:179], v[24:27], a[44:47]
  ds_read_b64_tr_b16 a[174:175], v221 offset:45056
  v_cvt_pk_bf16_f32 v113, v114, v115
  v_mfma_f32_16x16x32_bf16 a[48:51], a[184:187], v[0:3], a[48:51]
  v_exp_f32 v120, v120
  v_mfma_f32_16x16x32_bf16 a[48:51], a[188:191], v[32:35], a[48:51]
  ds_read_b64_tr_b16 a[176:177], v222 offset:32768
  v_lshl_add_u32 v225, v226, 4, v225
  v_mfma_f32_16x16x32_bf16 a[52:55], a[188:191], v[40:43], a[52:55]
  v_exp_f32 v121, v121
  v_mfma_f32_16x16x32_bf16 a[52:55], a[184:187], v[8:11], a[52:55]
  ds_read_b64_tr_b16 a[178:179], v222 offset:36864
  v_cvt_pk_bf16_f32 v120, v120, v121
  v_mfma_f32_16x16x32_bf16 a[56:59], a[184:187], v[16:19], a[56:59]
  v_exp_f32 v122, v122
  v_mfma_f32_16x16x32_bf16 a[56:59], a[188:191], v[48:51], a[56:59]
  ds_read_b64_tr_b16 a[180:181], v222 offset:40960
  v_and_b32 v227, 3, v224
  v_mfma_f32_16x16x32_bf16 a[60:63], a[188:191], v[56:59], a[60:63]
  s_waitcnt lgkmcnt(7)
  v_exp_f32 v123, v123
  v_mfma_f32_16x16x32_bf16 a[60:63], a[184:187], v[24:27], a[60:63]
  ds_read_b64_tr_b16 a[182:183], v222 offset:45056
  v_cvt_pk_bf16_f32 v121, v122, v123
  v_mfma_f32_16x16x32_bf16 a[64:67], a[160:163], v[0:3], a[64:67]
  v_exp_f32 v100, v100
  v_mfma_f32_16x16x32_bf16 a[64:67], a[164:167], v[32:35], a[64:67]
  ds_read_b64_tr_b16 a[184:185], v223 offset:32768
  v_lshl_add_u32 v225, v227, 2, v225
  v_mfma_f32_16x16x32_bf16 a[68:71], a[164:167], v[40:43], a[68:71]
  v_exp_f32 v101, v101
  v_mfma_f32_16x16x32_bf16 a[68:71], a[160:163], v[8:11], a[68:71]
  ds_read_b64_tr_b16 a[186:187], v223 offset:36864
  v_cvt_pk_bf16_f32 v98, v100, v101
  v_mfma_f32_16x16x32_bf16 a[72:75], a[160:163], v[16:19], a[72:75]
  v_exp_f32 v102, v102
  v_mfma_f32_16x16x32_bf16 a[72:75], a[164:167], v[48:51], a[72:75]
  ds_read_b64_tr_b16 a[188:189], v223 offset:40960
  v_add_u32 v225, 159744, v225
  v_mfma_f32_16x16x32_bf16 a[76:79], a[164:167], v[56:59], a[76:79]
  s_waitcnt lgkmcnt(7)
  v_exp_f32 v103, v103
  v_mfma_f32_16x16x32_bf16 a[76:79], a[160:163], v[24:27], a[76:79]
  ds_read_b64_tr_b16 a[190:191], v223 offset:45056
  v_cvt_pk_bf16_f32 v99, v102, v103
  v_mfma_f32_16x16x32_bf16 a[80:83], a[168:171], v[0:3], a[80:83]
  s_waitcnt vmcnt(9)
  v_exp_f32 v108, v108
  v_mfma_f32_16x16x32_bf16 a[80:83], a[172:175], v[32:35], a[80:83]
  v_mfma_f32_16x16x32_bf16 a[84:87], a[172:175], v[40:43], a[84:87]
  s_barrier
  v_exp_f32 v109, v109
  v_mfma_f32_16x16x32_bf16 a[84:87], a[168:171], v[8:11], a[84:87]
  ds_read_b128 a[128:131], v212 offset:0
  v_cvt_pk_bf16_f32 v106, v108, v109
  v_mfma_f32_16x16x32_bf16 a[88:91], a[168:171], v[16:19], a[88:91]
  v_exp_f32 v110, v110
  v_mfma_f32_16x16x32_bf16 a[88:91], a[172:175], v[48:51], a[88:91]
  ds_read_b128 a[132:135], v213 offset:0
  ds_read_b32 v228, v225 offset:0
  v_mfma_f32_16x16x32_bf16 a[92:95], a[172:175], v[56:59], a[92:95]
  s_waitcnt lgkmcnt(7)
  v_exp_f32 v111, v111
  v_mfma_f32_16x16x32_bf16 a[92:95], a[168:171], v[24:27], a[92:95]
  ds_read_b128 a[136:139], v214 offset:0
  v_cvt_pk_bf16_f32 v107, v110, v111
  v_mfma_f32_16x16x32_bf16 a[96:99], a[176:179], v[0:3], a[96:99]
  v_exp_f32 v116, v116
  v_mfma_f32_16x16x32_bf16 a[96:99], a[180:183], v[32:35], a[96:99]
  ds_read_b128 a[140:143], v215 offset:0
  ds_read_b32 v229, v225 offset:1024
  v_mfma_f32_16x16x32_bf16 a[100:103], a[180:183], v[40:43], a[100:103]
  v_exp_f32 v117, v117
  v_mfma_f32_16x16x32_bf16 a[100:103], a[176:179], v[8:11], a[100:103]
  ds_read_b32 v230, v225 offset:2048
  v_cvt_pk_bf16_f32 v114, v116, v117
  v_mfma_f32_16x16x32_bf16 a[104:107], a[176:179], v[16:19], a[104:107]
  v_exp_f32 v118, v118
  v_mfma_f32_16x16x32_bf16 a[104:107], a[180:183], v[48:51], a[104:107]
  ds_read_b32 v231, v225 offset:3072
  ds_read_b32 v238, v225 offset:512
  v_mfma_f32_16x16x32_bf16 a[108:111], a[180:183], v[56:59], a[108:111]
  s_waitcnt lgkmcnt(9)
  v_exp_f32 v119, v119
  v_mfma_f32_16x16x32_bf16 a[108:111], a[176:179], v[24:27], a[108:111]
  ds_read_b32 v239, v225 offset:1536
  v_cvt_pk_bf16_f32 v115, v118, v119
  v_mfma_f32_16x16x32_bf16 a[112:115], a[184:187], v[0:3], a[112:115]
  v_exp_f32 v124, v124
  v_mfma_f32_16x16x32_bf16 a[112:115], a[188:191], v[32:35], a[112:115]
  ds_read_b32 v240, v225 offset:2560
  ds_read_b32 v241, v225 offset:3584
  s_cmp_eq_u32 s3, 0
  s_cselect_b32 s35, 0, 1073741824
  v_mfma_f32_16x16x32_bf16 a[116:119], a[188:191], v[40:43], a[116:119]
  v_exp_f32 v125, v125
  v_mfma_f32_16x16x32_bf16 a[116:119], a[184:187], v[8:11], a[116:119]
  v_cvt_pk_bf16_f32 v122, v124, v125
  v_mul_u32_u24 v226, 0xd80, v226
  v_mfma_f32_16x16x32_bf16 a[120:123], a[184:187], v[16:19], a[120:123]
  v_exp_f32 v126, v126
  v_mfma_f32_16x16x32_bf16 a[120:123], a[188:191], v[48:51], a[120:123]
  v_and_b32 v227, 7, v224
  v_lshl_add_u32 v226, v227, 1, v226
  v_mfma_f32_16x16x32_bf16 a[124:127], a[188:191], v[56:59], a[124:127]
  s_waitcnt lgkmcnt(7)
  v_exp_f32 v127, v127
  v_mfma_f32_16x16x32_bf16 a[124:127], a[184:187], v[24:27], a[124:127]
  v_cvt_pk_bf16_f32 v123, v126, v127
  v_and_b32 v227, 1, v224
  v_lshl_add_u32 v226, v227, 30, v226
  v_or_b32 v226, s35, v226
  v_min_u32 v249, 1, v224
  v_lshlrev_b32 v249, 30, v249
  v_or_b32 v249, s35, v249
  v_mov_b32 v251, v249
  v_mov_b32 v250, 1
  s_mov_b32 s47, 2818048
  s_lshl_b32 s35, s33, 4
  s_add_u32 s35, s35, 2633728
  s_waitcnt lgkmcnt(0)
  v_add_f32 v228, v228, v229
  v_add_f32 v238, v238, v239
  v_add_f32 v230, v230, v231
  v_add_f32 v240, v240, v241
  v_add_f32 v228, v228, v230
  v_add_f32 v238, v238, v240
  v_cvt_pk_bf16_f32 v228, v228, v228
  v_cvt_pk_bf16_f32 v238, v238, v238
  v_lshlrev_b32 v228, 16, v228
  v_lshlrev_b32 v238, 16, v238
  v_mul_f32 v229, 0xbfb8aa3b, v228
  v_exp_f32 v229, v229
  s_nop 0
  v_add_f32 v229, 1.0, v229
  v_rcp_f32 v229, v229
  s_nop 0
  v_mul_f32 v228, v228, v229
  v_cvt_pk_bf16_f32 v228, v228, v228
  v_lshlrev_b32 v228, 16, v228
  v_mul_f32 v228, v228, v238
  s_nop 1
  v_mov_b32_dpp v229, v228 quad_perm:[1,0,3,2] row_mask:0xf bank_mask:0xf
  v_cvt_pk_bf16_f32 v228, v228, v229
  buffer_store_dword v228, v226, s[24:27], s35 offen sc1
  s_mov_b32 s32, 5
attn_loop:
  v_mfma_f32_16x16x32_bf16 v[0:3], a[128:131], v[128:131], v[192:195]
  s_add_u32 m0, s28, 81920
  v_mfma_f32_16x16x32_bf16 v[0:3], a[132:135], v[132:135], v[0:3]
  ds_read_b128 a[144:147], v212 offset:4096
  v_mfma_f32_16x16x32_bf16 v[0:3], a[136:139], v[136:139], v[0:3]
  buffer_load_dwordx4 v236, s[16:19], s29 offen offset:0 lds
  v_mfma_f32_16x16x32_bf16 v[0:3], a[140:143], v[140:143], v[0:3]
  ds_read_b128 a[148:151], v213 offset:4096
  v_mfma_f32_16x16x32_bf16 v[8:11], a[140:143], v[156:159], v[196:199]
  v_mfma_f32_16x16x32_bf16 v[8:11], a[136:139], v[152:155], v[8:11]
  ds_read_b128 a[152:155], v214 offset:4096
  v_mfma_f32_16x16x32_bf16 v[8:11], a[132:135], v[148:151], v[8:11]
  buffer_load_dwordx4 v237, s[16:19], s29 offen offset:1024 lds
  v_mfma_f32_16x16x32_bf16 v[8:11], a[128:131], v[144:147], v[8:11]
  ds_read_b128 a[156:159], v215 offset:4096
  v_mfma_f32_16x16x32_bf16 v[16:19], a[128:131], v[160:163], v[200:203]
  v_exp_f32 v0, v0
  v_mfma_f32_16x16x32_bf16 v[16:19], a[132:135], v[164:167], v[16:19]
  v_mfma_f32_16x16x32_bf16 v[16:19], a[136:139], v[168:171], v[16:19]
  v_exp_f32 v1, v1
  v_mfma_f32_16x16x32_bf16 v[16:19], a[140:143], v[172:175], v[16:19]
  v_cvt_pk_bf16_f32 v0, v0, v1
  v_mfma_f32_16x16x32_bf16 v[24:27], a[140:143], v[188:191], v[204:207]
  v_exp_f32 v2, v2
  v_mfma_f32_16x16x32_bf16 v[24:27], a[136:139], v[184:187], v[24:27]
  buffer_load_dwordx4 v236, s[16:19], s29 offen offset:2048 lds
  v_mfma_f32_16x16x32_bf16 v[24:27], a[132:135], v[180:183], v[24:27]
  s_waitcnt lgkmcnt(0)
  v_exp_f32 v3, v3
  v_mfma_f32_16x16x32_bf16 v[24:27], a[128:131], v[176:179], v[24:27]
  v_cvt_pk_bf16_f32 v1, v2, v3
  v_mfma_f32_16x16x32_bf16 v[4:7], a[144:147], v[128:131], v[192:195]
  v_exp_f32 v8, v8
  v_mfma_f32_16x16x32_bf16 v[4:7], a[148:151], v[132:135], v[4:7]
  ds_read_b128 a[128:131], v212 offset:8192
  v_mfma_f32_16x16x32_bf16 v[4:7], a[152:155], v[136:139], v[4:7]
  v_exp_f32 v9, v9
  v_mfma_f32_16x16x32_bf16 v[4:7], a[156:159], v[140:143], v[4:7]
  ds_read_b128 a[132:135], v213 offset:8192
  v_cvt_pk_bf16_f32 v8, v8, v9
  v_mfma_f32_16x16x32_bf16 v[12:15], a[156:159], v[156:159], v[196:199]
  v_exp_f32 v10, v10
  v_mfma_f32_16x16x32_bf16 v[12:15], a[152:155], v[152:155], v[12:15]
  ds_read_b128 a[136:139], v214 offset:8192
  v_mfma_f32_16x16x32_bf16 v[12:15], a[148:151], v[148:151], v[12:15]
  v_exp_f32 v11, v11
  v_mfma_f32_16x16x32_bf16 v[12:15], a[144:147], v[144:147], v[12:15]
  ds_read_b128 a[140:143], v215 offset:8192
  v_cvt_pk_bf16_f32 v9, v10, v11
  v_mfma_f32_16x16x32_bf16 v[20:23], a[144:147], v[160:163], v[200:203]
  v_exp_f32 v16, v16
  v_mfma_f32_16x16x32_bf16 v[20:23], a[148:151], v[164:167], v[20:23]
  buffer_load_dwordx4 v237, s[16:19], s29 offen offset:3072 lds
  v_mfma_f32_16x16x32_bf16 v[20:23], a[152:155], v[168:171], v[20:23]
  s_add_u32 s29, s29, 16384
  v_exp_f32 v17, v17
  v_mfma_f32_16x16x32_bf16 v[20:23], a[156:159], v[172:175], v[20:23]
  v_cvt_pk_bf16_f32 v16, v16, v17
  v_mfma_f32_16x16x32_bf16 v[28:31], a[156:159], v[188:191], v[204:207]
  s_add_u32 m0, s28, 32768
  v_exp_f32 v18, v18
  v_mfma_f32_16x16x32_bf16 v[28:31], a[152:155], v[184:187], v[28:31]
  buffer_load_dwordx4 v232, s[12:15], s29 offen offset:0 lds
  v_mfma_f32_16x16x32_bf16 v[28:31], a[148:151], v[180:183], v[28:31]
  s_waitcnt lgkmcnt(0)
  v_exp_f32 v19, v19
  v_mfma_f32_16x16x32_bf16 v[28:31], a[144:147], v[176:179], v[28:31]
  v_cvt_pk_bf16_f32 v17, v18, v19
  v_mfma_f32_16x16x32_bf16 v[32:35], a[128:131], v[128:131], v[192:195]
  v_exp_f32 v24, v24
  v_mfma_f32_16x16x32_bf16 v[32:35], a[132:135], v[132:135], v[32:35]
  ds_read_b128 a[144:147], v212 offset:12288
  v_mfma_f32_16x16x32_bf16 v[32:35], a[136:139], v[136:139], v[32:35]
  v_exp_f32 v25, v25
  v_mfma_f32_16x16x32_bf16 v[32:35], a[140:143], v[140:143], v[32:35]
  ds_read_b128 a[148:151], v213 offset:12288
  v_cvt_pk_bf16_f32 v24, v24, v25
  v_mfma_f32_16x16x32_bf16 v[40:43], a[140:143], v[156:159], v[196:199]
  v_exp_f32 v26, v26
  v_mfma_f32_16x16x32_bf16 v[40:43], a[136:139], v[152:155], v[40:43]
  ds_read_b128 a[152:155], v214 offset:12288
  v_mfma_f32_16x16x32_bf16 v[40:43], a[132:135], v[148:151], v[40:43]
  v_exp_f32 v27, v27
  v_mfma_f32_16x16x32_bf16 v[40:43], a[128:131], v[144:147], v[40:43]
  ds_read_b128 a[156:159], v215 offset:12288
  v_cvt_pk_bf16_f32 v25, v26, v27
  v_mfma_f32_16x16x32_bf16 v[48:51], a[128:131], v[160:163], v[200:203]
  v_exp_f32 v4, v4
  v_mfma_f32_16x16x32_bf16 v[48:51], a[132:135], v[164:167], v[48:51]
  buffer_load_dwordx4 v233, s[12:15], s29 offen offset:1024 lds
  v_mfma_f32_16x16x32_bf16 v[48:51], a[136:139], v[168:171], v[48:51]
  v_exp_f32 v5, v5
  v_mfma_f32_16x16x32_bf16 v[48:51], a[140:143], v[172:175], v[48:51]
  v_cvt_pk_bf16_f32 v2, v4, v5
  v_mfma_f32_16x16x32_bf16 v[56:59], a[140:143], v[188:191], v[204:207]
  v_exp_f32 v6, v6
  v_mfma_f32_16x16x32_bf16 v[56:59], a[136:139], v[184:187], v[56:59]
  buffer_load_dwordx4 v234, s[12:15], s29 offen offset:2048 lds
  v_mfma_f32_16x16x32_bf16 v[56:59], a[132:135], v[180:183], v[56:59]
  s_waitcnt lgkmcnt(0)
  v_exp_f32 v7, v7
  v_mfma_f32_16x16x32_bf16 v[56:59], a[128:131], v[176:179], v[56:59]
  v_cvt_pk_bf16_f32 v3, v6, v7
  v_mfma_f32_16x16x32_bf16 v[36:39], a[144:147], v[128:131], v[192:195]
  v_exp_f32 v12, v12
  v_mfma_f32_16x16x32_bf16 v[36:39], a[148:151], v[132:135], v[36:39]
  ds_read_b64_tr_b16 a[160:161], v216 offset:49152
  v_mfma_f32_16x16x32_bf16 v[36:39], a[152:155], v[136:139], v[36:39]
  v_exp_f32 v13, v13
  v_mfma_f32_16x16x32_bf16 v[36:39], a[156:159], v[140:143], v[36:39]
  ds_read_b64_tr_b16 a[162:163], v216 offset:53248
  v_cvt_pk_bf16_f32 v10, v12, v13
  v_mfma_f32_16x16x32_bf16 v[44:47], a[156:159], v[156:159], v[196:199]
  v_exp_f32 v14, v14
  v_mfma_f32_16x16x32_bf16 v[44:47], a[152:155], v[152:155], v[44:47]
  ds_read_b64_tr_b16 a[164:165], v216 offset:57344
  buffer_load_dwordx4 v235, s[12:15], s29 offen offset:3072 lds
  v_mfma_f32_16x16x32_bf16 v[44:47], a[148:151], v[148:151], v[44:47]
  v_exp_f32 v15, v15
  v_mfma_f32_16x16x32_bf16 v[44:47], a[144:147], v[144:147], v[44:47]
  ds_read_b64_tr_b16 a[166:167], v216 offset:61440
  v_cvt_pk_bf16_f32 v11, v14, v15
  v_mfma_f32_16x16x32_bf16 v[52:55], a[144:147], v[160:163], v[200:203]
  s_add_u32 m0, s50, 4096
  v_exp_f32 v20, v20
  v_mfma_f32_16x16x32_bf16 v[52:55], a[148:151], v[164:167], v[52:55]
  ds_read_b64_tr_b16 a[168:169], v217 offset:49152
  buffer_load_dwordx4 v208, s[20:23], s30 offen lds
  s_add_u32 s30, s30, 32
  v_mfma_f32_16x16x32_bf16 v[52:55], a[152:155], v[168:171], v[52:55]
  v_exp_f32 v21, v21
  v_mfma_f32_16x16x32_bf16 v[52:55], a[156:159], v[172:175], v[52:55]
  ds_read_b64_tr_b16 a[170:171], v217 offset:53248
  v_cvt_pk_bf16_f32 v18, v20, v21
  v_mfma_f32_16x16x32_bf16 v[60:63], a[156:159], v[188:191], v[204:207]
  v_exp_f32 v22, v22
  v_mfma_f32_16x16x32_bf16 v[60:63], a[152:155], v[184:187], v[60:63]
  ds_read_b64_tr_b16 a[172:173], v217 offset:57344
  v_mfma_f32_16x16x32_bf16 v[60:63], a[148:151], v[180:183], v[60:63]
  v_exp_f32 v23, v23
  v_mfma_f32_16x16x32_bf16 v[60:63], a[144:147], v[176:179], v[60:63]
  ds_read_b64_tr_b16 a[174:175], v217 offset:61440
  v_cvt_pk_bf16_f32 v19, v22, v23
  v_mfma_f32_16x16x32_bf16 a[192:195], a[208:211], v[64:67], a[192:195]
  v_exp_f32 v28, v28
  v_mfma_f32_16x16x32_bf16 a[192:195], a[208:211], v[96:99], a[192:195]
  ds_read_b64_tr_b16 a[176:177], v218 offset:49152
  v_mfma_f32_16x16x32_bf16 a[196:199], a[208:211], v[72:75], a[196:199]
  v_exp_f32 v29, v29
  v_mfma_f32_16x16x32_bf16 a[196:199], a[208:211], v[104:107], a[196:199]
  ds_read_b64_tr_b16 a[178:179], v218 offset:53248
  v_cvt_pk_bf16_f32 v26, v28, v29
  v_mfma_f32_16x16x32_bf16 a[200:203], a[208:211], v[80:83], a[200:203]
  v_exp_f32 v30, v30
  v_mfma_f32_16x16x32_bf16 a[200:203], a[208:211], v[112:115], a[200:203]
  ds_read_b64_tr_b16 a[180:181], v218 offset:57344
  v_mfma_f32_16x16x32_bf16 a[204:207], a[208:211], v[88:91], a[204:207]
  s_waitcnt lgkmcnt(7)
  v_exp_f32 v31, v31
  v_mfma_f32_16x16x32_bf16 a[204:207], a[208:211], v[120:123], a[204:207]
  ds_read_b64_tr_b16 a[182:183], v218 offset:61440
  v_cvt_pk_bf16_f32 v27, v30, v31
  v_mfma_f32_16x16x32_bf16 a[0:3], a[160:163], v[64:67], a[0:3]
  v_exp_f32 v32, v32
  v_mfma_f32_16x16x32_bf16 a[0:3], a[164:167], v[96:99], a[0:3]
  ds_read_b64_tr_b16 a[184:185], v219 offset:49152
  v_mfma_f32_16x16x32_bf16 a[4:7], a[164:167], v[104:107], a[4:7]
  v_exp_f32 v33, v33
  v_mfma_f32_16x16x32_bf16 a[4:7], a[160:163], v[72:75], a[4:7]
  ds_read_b64_tr_b16 a[186:187], v219 offset:53248
  v_cvt_pk_bf16_f32 v32, v32, v33
  v_mfma_f32_16x16x32_bf16 a[8:11], a[160:163], v[80:83], a[8:11]
  v_exp_f32 v34, v34
  v_mfma_f32_16x16x32_bf16 a[8:11], a[164:167], v[112:115], a[8:11]
  ds_read_b64_tr_b16 a[188:189], v219 offset:57344
  v_mfma_f32_16x16x32_bf16 a[12:15], a[164:167], v[120:123], a[12:15]
  s_waitcnt lgkmcnt(7)
  v_exp_f32 v35, v35
  v_mfma_f32_16x16x32_bf16 a[12:15], a[160:163], v[88:91], a[12:15]
  ds_read_b64_tr_b16 a[190:191], v219 offset:61440
  v_cvt_pk_bf16_f32 v33, v34, v35
  v_mfma_f32_16x16x32_bf16 a[16:19], a[168:171], v[64:67], a[16:19]
  v_exp_f32 v40, v40
  v_mfma_f32_16x16x32_bf16 a[16:19], a[172:175], v[96:99], a[16:19]
  ds_read_b64_tr_b16 a[160:161], v220 offset:49152
  v_mfma_f32_16x16x32_bf16 a[20:23], a[172:175], v[104:107], a[20:23]
  v_exp_f32 v41, v41
  v_mfma_f32_16x16x32_bf16 a[20:23], a[168:171], v[72:75], a[20:23]
  ds_read_b64_tr_b16 a[162:163], v220 offset:53248
  v_cvt_pk_bf16_f32 v40, v40, v41
  v_mfma_f32_16x16x32_bf16 a[24:27], a[168:171], v[80:83], a[24:27]
  v_exp_f32 v42, v42
  v_mfma_f32_16x16x32_bf16 a[24:27], a[172:175], v[112:115], a[24:27]
  ds_read_b64_tr_b16 a[164:165], v220 offset:57344
  v_mfma_f32_16x16x32_bf16 a[28:31], a[172:175], v[120:123], a[28:31]
  s_waitcnt lgkmcnt(7)
  v_exp_f32 v43, v43
  v_mfma_f32_16x16x32_bf16 a[28:31], a[168:171], v[88:91], a[28:31]
  ds_read_b64_tr_b16 a[166:167], v220 offset:61440
  v_cvt_pk_bf16_f32 v41, v42, v43
  v_mfma_f32_16x16x32_bf16 a[32:35], a[176:179], v[64:67], a[32:35]
  v_exp_f32 v48, v48
  v_mfma_f32_16x16x32_bf16 a[32:35], a[180:183], v[96:99], a[32:35]
  ds_read_b64_tr_b16 a[168:169], v221 offset:49152
  v_mfma_f32_16x16x32_bf16 a[36:39], a[180:183], v[104:107], a[36:39]
  v_exp_f32 v49, v49
  v_mfma_f32_16x16x32_bf16 a[36:39], a[176:179], v[72:75], a[36:39]
  ds_read_b64_tr_b16 a[170:171], v221 offset:53248
  v_cvt_pk_bf16_f32 v48, v48, v49
  v_mfma_f32_16x16x32_bf16 a[40:43], a[176:179], v[80:83], a[40:43]
  v_exp_f32 v50, v50
  v_mfma_f32_16x16x32_bf16 a[40:43], a[180:183], v[112:115], a[40:43]
  ds_read_b64_tr_b16 a[172:173], v221 offset:57344
  v_mfma_f32_16x16x32_bf16 a[44:47], a[180:183], v[120:123], a[44:47]
  s_waitcnt lgkmcnt(7)
  v_exp_f32 v51, v51
  v_mfma_f32_16x16x32_bf16 a[44:47], a[176:179], v[88:91], a[44:47]
  ds_read_b64_tr_b16 a[174:175], v221 offset:61440
  v_cvt_pk_bf16_f32 v49, v50, v51
  v_mfma_f32_16x16x32_bf16 a[48:51], a[184:187], v[64:67], a[48:51]
  v_exp_f32 v56, v56
  v_mfma_f32_16x16x32_bf16 a[48:51], a[188:191], v[96:99], a[48:51]
  ds_read_b64_tr_b16 a[176:177], v222 offset:49152
  v_mfma_f32_16x16x32_bf16 a[52:55], a[188:191], v[104:107], a[52:55]
  v_exp_f32 v57, v57
  v_mfma_f32_16x16x32_bf16 a[52:55], a[184:187], v[72:75], a[52:55]
  ds_read_b64_tr_b16 a[178:179], v222 offset:53248
  v_cvt_pk_bf16_f32 v56, v56, v57
  v_mfma_f32_16x16x32_bf16 a[56:59], a[184:187], v[80:83], a[56:59]
  v_exp_f32 v58, v58
  v_mfma_f32_16x16x32_bf16 a[56:59], a[188:191], v[112:115], a[56:59]
  ds_read_b64_tr_b16 a[180:181], v222 offset:57344
  global_load_dword v255, v252, s[8:9]
  v_mfma_f32_16x16x32_bf16 a[60:63], a[188:191], v[120:123], a[60:63]
  s_waitcnt lgkmcnt(7)
  v_exp_f32 v59, v59
  v_mfma_f32_16x16x32_bf16 a[60:63], a[184:187], v[88:91], a[60:63]
  ds_read_b64_tr_b16 a[182:183], v222 offset:61440
  v_cvt_pk_bf16_f32 v57, v58, v59
  v_mfma_f32_16x16x32_bf16 a[64:67], a[160:163], v[64:67], a[64:67]
  v_exp_f32 v36, v36
  v_mfma_f32_16x16x32_bf16 a[64:67], a[164:167], v[96:99], a[64:67]
  ds_read_b64_tr_b16 a[184:185], v223 offset:49152
  v_mfma_f32_16x16x32_bf16 a[68:71], a[164:167], v[104:107], a[68:71]
  v_exp_f32 v37, v37
  v_mfma_f32_16x16x32_bf16 a[68:71], a[160:163], v[72:75], a[68:71]
  ds_read_b64_tr_b16 a[186:187], v223 offset:53248
  v_cvt_pk_bf16_f32 v34, v36, v37
  v_mfma_f32_16x16x32_bf16 a[72:75], a[160:163], v[80:83], a[72:75]
  v_exp_f32 v38, v38
  v_mfma_f32_16x16x32_bf16 a[72:75], a[164:167], v[112:115], a[72:75]
  ds_read_b64_tr_b16 a[188:189], v223 offset:57344
  v_mfma_f32_16x16x32_bf16 a[76:79], a[164:167], v[120:123], a[76:79]
  s_waitcnt lgkmcnt(7)
  v_exp_f32 v39, v39
  v_mfma_f32_16x16x32_bf16 a[76:79], a[160:163], v[88:91], a[76:79]
  ds_read_b64_tr_b16 a[190:191], v223 offset:61440
  v_cvt_pk_bf16_f32 v35, v38, v39
  v_mfma_f32_16x16x32_bf16 a[80:83], a[168:171], v[64:67], a[80:83]
  s_waitcnt vmcnt(12)
  v_exp_f32 v44, v44
  v_mfma_f32_16x16x32_bf16 a[80:83], a[172:175], v[96:99], a[80:83]
  v_mfma_f32_16x16x32_bf16 a[84:87], a[172:175], v[104:107], a[84:87]
  s_barrier
  v_exp_f32 v45, v45
  v_mfma_f32_16x16x32_bf16 a[84:87], a[168:171], v[72:75], a[84:87]
  ds_read_b128 a[128:131], v212 offset:16384
  v_cvt_pk_bf16_f32 v42, v44, v45
  v_mfma_f32_16x16x32_bf16 a[88:91], a[168:171], v[80:83], a[88:91]
  v_exp_f32 v46, v46
  v_mfma_f32_16x16x32_bf16 a[88:91], a[172:175], v[112:115], a[88:91]
  ds_read_b128 a[132:135], v213 offset:16384
  v_mfma_f32_16x16x32_bf16 a[92:95], a[172:175], v[120:123], a[92:95]
  s_waitcnt lgkmcnt(6)
  v_exp_f32 v47, v47
  v_mfma_f32_16x16x32_bf16 a[92:95], a[168:171], v[88:91], a[92:95]
  ds_read_b128 a[136:139], v214 offset:16384
  v_cvt_pk_bf16_f32 v43, v46, v47
  v_mfma_f32_16x16x32_bf16 a[96:99], a[176:179], v[64:67], a[96:99]
  v_exp_f32 v52, v52
  v_mfma_f32_16x16x32_bf16 a[96:99], a[180:183], v[96:99], a[96:99]
  ds_read_b128 a[140:143], v215 offset:16384
  v_mfma_f32_16x16x32_bf16 a[100:103], a[180:183], v[104:107], a[100:103]
  v_exp_f32 v53, v53
  v_mfma_f32_16x16x32_bf16 a[100:103], a[176:179], v[72:75], a[100:103]
  v_cvt_pk_bf16_f32 v50, v52, v53
  v_mfma_f32_16x16x32_bf16 a[104:107], a[176:179], v[80:83], a[104:107]
  v_exp_f32 v54, v54
  v_mfma_f32_16x16x32_bf16 a[104:107], a[180:183], v[112:115], a[104:107]
  v_mfma_f32_16x16x32_bf16 a[108:111], a[180:183], v[120:123], a[108:111]
  s_waitcnt lgkmcnt(4)
  v_exp_f32 v55, v55
  v_mfma_f32_16x16x32_bf16 a[108:111], a[176:179], v[88:91], a[108:111]
  v_cvt_pk_bf16_f32 v51, v54, v55
  v_mfma_f32_16x16x32_bf16 a[112:115], a[184:187], v[64:67], a[112:115]
  v_exp_f32 v60, v60
  v_mfma_f32_16x16x32_bf16 a[112:115], a[188:191], v[96:99], a[112:115]
  v_mfma_f32_16x16x32_bf16 a[116:119], a[188:191], v[104:107], a[116:119]
  v_exp_f32 v61, v61
  v_mfma_f32_16x16x32_bf16 a[116:119], a[184:187], v[72:75], a[116:119]
  v_cvt_pk_bf16_f32 v58, v60, v61
  v_mfma_f32_16x16x32_bf16 a[120:123], a[184:187], v[80:83], a[120:123]
  v_exp_f32 v62, v62
  v_mfma_f32_16x16x32_bf16 a[120:123], a[188:191], v[112:115], a[120:123]
  v_mfma_f32_16x16x32_bf16 a[124:127], a[188:191], v[120:123], a[124:127]
  s_waitcnt lgkmcnt(0)
  v_exp_f32 v63, v63
  v_mfma_f32_16x16x32_bf16 a[124:127], a[184:187], v[88:91], a[124:127]
  v_cvt_pk_bf16_f32 v59, v62, v63
  v_mfma_f32_16x16x32_bf16 v[64:67], a[128:131], v[128:131], v[192:195]
  s_add_u32 m0, s28, 98304
  v_mfma_f32_16x16x32_bf16 v[64:67], a[132:135], v[132:135], v[64:67]
  ds_read_b128 a[144:147], v212 offset:20480
  v_mfma_f32_16x16x32_bf16 v[64:67], a[136:139], v[136:139], v[64:67]
  buffer_load_dwordx4 v236, s[16:19], s29 offen offset:0 lds
  v_mfma_f32_16x16x32_bf16 v[64:67], a[140:143], v[140:143], v[64:67]
  ds_read_b128 a[148:151], v213 offset:20480
  v_mfma_f32_16x16x32_bf16 v[72:75], a[140:143], v[156:159], v[196:199]
  v_mfma_f32_16x16x32_bf16 v[72:75], a[136:139], v[152:155], v[72:75]
  ds_read_b128 a[152:155], v214 offset:20480
  v_mfma_f32_16x16x32_bf16 v[72:75], a[132:135], v[148:151], v[72:75]
  buffer_load_dwordx4 v237, s[16:19], s29 offen offset:1024 lds
  v_mfma_f32_16x16x32_bf16 v[72:75], a[128:131], v[144:147], v[72:75]
  ds_read_b128 a[156:159], v215 offset:20480
  v_mfma_f32_16x16x32_bf16 v[80:83], a[128:131], v[160:163], v[200:203]
  v_exp_f32 v64, v64
  v_mfma_f32_16x16x32_bf16 v[80:83], a[132:135], v[164:167], v[80:83]
  v_mfma_f32_16x16x32_bf16 v[80:83], a[136:139], v[168:171], v[80:83]
  v_exp_f32 v65, v65
  v_mfma_f32_16x16x32_bf16 v[80:83], a[140:143], v[172:175], v[80:83]
  v_cvt_pk_bf16_f32 v64, v64, v65
  v_mfma_f32_16x16x32_bf16 v[88:91], a[140:143], v[188:191], v[204:207]
  v_exp_f32 v66, v66
  v_mfma_f32_16x16x32_bf16 v[88:91], a[136:139], v[184:187], v[88:91]
  buffer_load_dwordx4 v236, s[16:19], s29 offen offset:2048 lds
  v_mfma_f32_16x16x32_bf16 v[88:91], a[132:135], v[180:183], v[88:91]
  s_waitcnt lgkmcnt(0)
  v_exp_f32 v67, v67
  v_mfma_f32_16x16x32_bf16 v[88:91], a[128:131], v[176:179], v[88:91]
  v_cvt_pk_bf16_f32 v65, v66, v67
  v_mfma_f32_16x16x32_bf16 v[68:71], a[144:147], v[128:131], v[192:195]
  v_exp_f32 v72, v72
  v_mfma_f32_16x16x32_bf16 v[68:71], a[148:151], v[132:135], v[68:71]
  ds_read_b128 a[128:131], v212 offset:24576
  v_mfma_f32_16x16x32_bf16 v[68:71], a[152:155], v[136:139], v[68:71]
  v_exp_f32 v73, v73
  v_mfma_f32_16x16x32_bf16 v[68:71], a[156:159], v[140:143], v[68:71]
  ds_read_b128 a[132:135], v213 offset:24576
  v_cvt_pk_bf16_f32 v72, v72, v73
  v_mfma_f32_16x16x32_bf16 v[76:79], a[156:159], v[156:159], v[196:199]
  v_exp_f32 v74, v74
  v_mfma_f32_16x16x32_bf16 v[76:79], a[152:155], v[152:155], v[76:79]
  ds_read_b128 a[136:139], v214 offset:24576
  v_mfma_f32_16x16x32_bf16 v[76:79], a[148:151], v[148:151], v[76:79]
  v_exp_f32 v75, v75
  v_mfma_f32_16x16x32_bf16 v[76:79], a[144:147], v[144:147], v[76:79]
  ds_read_b128 a[140:143], v215 offset:24576
  v_cvt_pk_bf16_f32 v73, v74, v75
  v_mfma_f32_16x16x32_bf16 v[84:87], a[144:147], v[160:163], v[200:203]
  v_exp_f32 v80, v80
  v_mfma_f32_16x16x32_bf16 v[84:87], a[148:151], v[164:167], v[84:87]
  buffer_load_dwordx4 v237, s[16:19], s29 offen offset:3072 lds
  v_mfma_f32_16x16x32_bf16 v[84:87], a[152:155], v[168:171], v[84:87]
  s_add_u32 s29, s29, 16384
  v_exp_f32 v81, v81
  v_mfma_f32_16x16x32_bf16 v[84:87], a[156:159], v[172:175], v[84:87]
  v_cvt_pk_bf16_f32 v80, v80, v81
  v_mfma_f32_16x16x32_bf16 v[92:95], a[156:159], v[188:191], v[204:207]
  s_add_u32 m0, s28, 49152
  v_exp_f32 v82, v82
  v_mfma_f32_16x16x32_bf16 v[92:95], a[152:155], v[184:187], v[92:95]
  buffer_load_dwordx4 v232, s[12:15], s29 offen offset:0 lds
  v_mfma_f32_16x16x32_bf16 v[92:95], a[148:151], v[180:183], v[92:95]
  s_waitcnt lgkmcnt(0)
  v_exp_f32 v83, v83
  v_mfma_f32_16x16x32_bf16 v[92:95], a[144:147], v[176:179], v[92:95]
  v_cvt_pk_bf16_f32 v81, v82, v83
  v_mfma_f32_16x16x32_bf16 v[96:99], a[128:131], v[128:131], v[192:195]
  v_exp_f32 v88, v88
  v_mfma_f32_16x16x32_bf16 v[96:99], a[132:135], v[132:135], v[96:99]
  ds_read_b128 a[144:147], v212 offset:28672
  v_mfma_f32_16x16x32_bf16 v[96:99], a[136:139], v[136:139], v[96:99]
  v_exp_f32 v89, v89
  v_mfma_f32_16x16x32_bf16 v[96:99], a[140:143], v[140:143], v[96:99]
  ds_read_b128 a[148:151], v213 offset:28672
  v_cvt_pk_bf16_f32 v88, v88, v89
  v_mfma_f32_16x16x32_bf16 v[104:107], a[140:143], v[156:159], v[196:199]
  v_exp_f32 v90, v90
  v_mfma_f32_16x16x32_bf16 v[104:107], a[136:139], v[152:155], v[104:107]
  ds_read_b128 a[152:155], v214 offset:28672
  v_mfma_f32_16x16x32_bf16 v[104:107], a[132:135], v[148:151], v[104:107]
  v_exp_f32 v91, v91
  v_mfma_f32_16x16x32_bf16 v[104:107], a[128:131], v[144:147], v[104:107]
  ds_read_b128 a[156:159], v215 offset:28672
  v_cvt_pk_bf16_f32 v89, v90, v91
  v_mfma_f32_16x16x32_bf16 v[112:115], a[128:131], v[160:163], v[200:203]
  v_exp_f32 v68, v68
  v_mfma_f32_16x16x32_bf16 v[112:115], a[132:135], v[164:167], v[112:115]
  buffer_load_dwordx4 v233, s[12:15], s29 offen offset:1024 lds
  v_mfma_f32_16x16x32_bf16 v[112:115], a[136:139], v[168:171], v[112:115]
  v_exp_f32 v69, v69
  v_mfma_f32_16x16x32_bf16 v[112:115], a[140:143], v[172:175], v[112:115]
  v_cvt_pk_bf16_f32 v66, v68, v69
  v_mfma_f32_16x16x32_bf16 v[120:123], a[140:143], v[188:191], v[204:207]
  v_exp_f32 v70, v70
  v_mfma_f32_16x16x32_bf16 v[120:123], a[136:139], v[184:187], v[120:123]
  buffer_load_dwordx4 v234, s[12:15], s29 offen offset:2048 lds
  v_mfma_f32_16x16x32_bf16 v[120:123], a[132:135], v[180:183], v[120:123]
  s_waitcnt lgkmcnt(0)
  v_exp_f32 v71, v71
  v_mfma_f32_16x16x32_bf16 v[120:123], a[128:131], v[176:179], v[120:123]
  v_cvt_pk_bf16_f32 v67, v70, v71
  v_mfma_f32_16x16x32_bf16 v[100:103], a[144:147], v[128:131], v[192:195]
  v_exp_f32 v76, v76
  v_mfma_f32_16x16x32_bf16 v[100:103], a[148:151], v[132:135], v[100:103]
  ds_read_b64_tr_b16 a[160:161], v216 offset:0
  v_mfma_f32_16x16x32_bf16 v[100:103], a[152:155], v[136:139], v[100:103]
  v_exp_f32 v77, v77
  v_mfma_f32_16x16x32_bf16 v[100:103], a[156:159], v[140:143], v[100:103]
  ds_read_b64_tr_b16 a[162:163], v216 offset:4096
  v_cvt_pk_bf16_f32 v74, v76, v77
  v_mfma_f32_16x16x32_bf16 v[108:111], a[156:159], v[156:159], v[196:199]
  v_exp_f32 v78, v78
  v_mfma_f32_16x16x32_bf16 v[108:111], a[152:155], v[152:155], v[108:111]
  ds_read_b64_tr_b16 a[164:165], v216 offset:8192
  buffer_load_dwordx4 v235, s[12:15], s29 offen offset:3072 lds
  v_mfma_f32_16x16x32_bf16 v[108:111], a[148:151], v[148:151], v[108:111]
  v_exp_f32 v79, v79
  v_mfma_f32_16x16x32_bf16 v[108:111], a[144:147], v[144:147], v[108:111]
  ds_read_b64_tr_b16 a[166:167], v216 offset:12288
  v_cvt_pk_bf16_f32 v75, v78, v79
  v_mfma_f32_16x16x32_bf16 v[116:119], a[144:147], v[160:163], v[200:203]
  s_add_u32 m0, s50, 5120
  v_exp_f32 v84, v84
  v_mfma_f32_16x16x32_bf16 v[116:119], a[148:151], v[164:167], v[116:119]
  ds_read_b64_tr_b16 a[168:169], v217 offset:0
  buffer_load_dwordx4 v208, s[20:23], s30 offen lds
  s_add_u32 s30, s30, 32
  v_mfma_f32_16x16x32_bf16 v[116:119], a[152:155], v[168:171], v[116:119]
  v_exp_f32 v85, v85
  v_mfma_f32_16x16x32_bf16 v[116:119], a[156:159], v[172:175], v[116:119]
  ds_read_b64_tr_b16 a[170:171], v217 offset:4096
  v_cvt_pk_bf16_f32 v82, v84, v85
  v_mfma_f32_16x16x32_bf16 v[124:127], a[156:159], v[188:191], v[204:207]
  v_exp_f32 v86, v86
  v_mfma_f32_16x16x32_bf16 v[124:127], a[152:155], v[184:187], v[124:127]
  ds_read_b64_tr_b16 a[172:173], v217 offset:8192
  v_mfma_f32_16x16x32_bf16 v[124:127], a[148:151], v[180:183], v[124:127]
  v_exp_f32 v87, v87
  v_mfma_f32_16x16x32_bf16 v[124:127], a[144:147], v[176:179], v[124:127]
  ds_read_b64_tr_b16 a[174:175], v217 offset:12288
  v_cvt_pk_bf16_f32 v83, v86, v87
  v_mfma_f32_16x16x32_bf16 a[192:195], a[208:211], v[0:3], a[192:195]
  v_exp_f32 v92, v92
  v_mfma_f32_16x16x32_bf16 a[192:195], a[208:211], v[32:35], a[192:195]
  ds_read_b64_tr_b16 a[176:177], v218 offset:0
  v_mfma_f32_16x16x32_bf16 a[196:199], a[208:211], v[8:11], a[196:199]
  v_exp_f32 v93, v93
  v_mfma_f32_16x16x32_bf16 a[196:199], a[208:211], v[40:43], a[196:199]
  ds_read_b64_tr_b16 a[178:179], v218 offset:4096
  v_cvt_pk_bf16_f32 v90, v92, v93
  v_mfma_f32_16x16x32_bf16 a[200:203], a[208:211], v[16:19], a[200:203]
  v_exp_f32 v94, v94
  v_mfma_f32_16x16x32_bf16 a[200:203], a[208:211], v[48:51], a[200:203]
  ds_read_b64_tr_b16 a[180:181], v218 offset:8192
  v_mfma_f32_16x16x32_bf16 a[204:207], a[208:211], v[24:27], a[204:207]
  s_waitcnt lgkmcnt(7)
  v_exp_f32 v95, v95
  v_mfma_f32_16x16x32_bf16 a[204:207], a[208:211], v[56:59], a[204:207]
  ds_read_b64_tr_b16 a[182:183], v218 offset:12288
  v_cvt_pk_bf16_f32 v91, v94, v95
  v_mfma_f32_16x16x32_bf16 a[0:3], a[160:163], v[0:3], a[0:3]
  v_exp_f32 v96, v96
  v_mfma_f32_16x16x32_bf16 a[0:3], a[164:167], v[32:35], a[0:3]
  ds_read_b64_tr_b16 a[184:185], v219 offset:0
  v_mfma_f32_16x16x32_bf16 a[4:7], a[164:167], v[40:43], a[4:7]
  v_exp_f32 v97, v97
  v_mfma_f32_16x16x32_bf16 a[4:7], a[160:163], v[8:11], a[4:7]
  ds_read_b64_tr_b16 a[186:187], v219 offset:4096
  v_cvt_pk_bf16_f32 v96, v96, v97
  v_mfma_f32_16x16x32_bf16 a[8:11], a[160:163], v[16:19], a[8:11]
  v_exp_f32 v98, v98
  v_mfma_f32_16x16x32_bf16 a[8:11], a[164:167], v[48:51], a[8:11]
  ds_read_b64_tr_b16 a[188:189], v219 offset:8192
  v_mfma_f32_16x16x32_bf16 a[12:15], a[164:167], v[56:59], a[12:15]
  s_waitcnt lgkmcnt(7)
  v_exp_f32 v99, v99
  v_mfma_f32_16x16x32_bf16 a[12:15], a[160:163], v[24:27], a[12:15]
  ds_read_b64_tr_b16 a[190:191], v219 offset:12288
  v_cvt_pk_bf16_f32 v97, v98, v99
  v_mfma_f32_16x16x32_bf16 a[16:19], a[168:171], v[0:3], a[16:19]
  v_exp_f32 v104, v104
  v_mfma_f32_16x16x32_bf16 a[16:19], a[172:175], v[32:35], a[16:19]
  ds_read_b64_tr_b16 a[160:161], v220 offset:0
  v_mfma_f32_16x16x32_bf16 a[20:23], a[172:175], v[40:43], a[20:23]
  v_exp_f32 v105, v105
  v_mfma_f32_16x16x32_bf16 a[20:23], a[168:171], v[8:11], a[20:23]
  ds_read_b64_tr_b16 a[162:163], v220 offset:4096
  v_cvt_pk_bf16_f32 v104, v104, v105
  v_mfma_f32_16x16x32_bf16 a[24:27], a[168:171], v[16:19], a[24:27]
  v_exp_f32 v106, v106
  v_mfma_f32_16x16x32_bf16 a[24:27], a[172:175], v[48:51], a[24:27]
  ds_read_b64_tr_b16 a[164:165], v220 offset:8192
  v_mfma_f32_16x16x32_bf16 a[28:31], a[172:175], v[56:59], a[28:31]
  s_waitcnt lgkmcnt(7)
  v_exp_f32 v107, v107
  v_mfma_f32_16x16x32_bf16 a[28:31], a[168:171], v[24:27], a[28:31]
  ds_read_b64_tr_b16 a[166:167], v220 offset:12288
  v_cvt_pk_bf16_f32 v105, v106, v107
  v_mfma_f32_16x16x32_bf16 a[32:35], a[176:179], v[0:3], a[32:35]
  v_exp_f32 v112, v112
  v_mfma_f32_16x16x32_bf16 a[32:35], a[180:183], v[32:35], a[32:35]
  ds_read_b64_tr_b16 a[168:169], v221 offset:0
  v_mfma_f32_16x16x32_bf16 a[36:39], a[180:183], v[40:43], a[36:39]
  v_exp_f32 v113, v113
  v_mfma_f32_16x16x32_bf16 a[36:39], a[176:179], v[8:11], a[36:39]
  ds_read_b64_tr_b16 a[170:171], v221 offset:4096
  v_cvt_pk_bf16_f32 v112, v112, v113
  v_mfma_f32_16x16x32_bf16 a[40:43], a[176:179], v[16:19], a[40:43]
  v_exp_f32 v114, v114
  v_mfma_f32_16x16x32_bf16 a[40:43], a[180:183], v[48:51], a[40:43]
  ds_read_b64_tr_b16 a[172:173], v221 offset:8192
  v_mfma_f32_16x16x32_bf16 a[44:47], a[180:183], v[56:59], a[44:47]
  s_waitcnt lgkmcnt(7)
  v_exp_f32 v115, v115
  v_mfma_f32_16x16x32_bf16 a[44:47], a[176:179], v[24:27], a[44:47]
  ds_read_b64_tr_b16 a[174:175], v221 offset:12288
  v_cvt_pk_bf16_f32 v113, v114, v115
  v_mfma_f32_16x16x32_bf16 a[48:51], a[184:187], v[0:3], a[48:51]
  v_exp_f32 v120, v120
  v_mfma_f32_16x16x32_bf16 a[48:51], a[188:191], v[32:35], a[48:51]
  ds_read_b64_tr_b16 a[176:177], v222 offset:0
  v_mfma_f32_16x16x32_bf16 a[52:55], a[188:191], v[40:43], a[52:55]
  v_exp_f32 v121, v121
  v_mfma_f32_16x16x32_bf16 a[52:55], a[184:187], v[8:11], a[52:55]
  ds_read_b64_tr_b16 a[178:179], v222 offset:4096
  v_cvt_pk_bf16_f32 v120, v120, v121
  v_mfma_f32_16x16x32_bf16 a[56:59], a[184:187], v[16:19], a[56:59]
  v_exp_f32 v122, v122
  v_mfma_f32_16x16x32_bf16 a[56:59], a[188:191], v[48:51], a[56:59]
  ds_read_b64_tr_b16 a[180:181], v222 offset:8192
  v_mfma_f32_16x16x32_bf16 a[60:63], a[188:191], v[56:59], a[60:63]
  s_waitcnt lgkmcnt(7)
  v_exp_f32 v123, v123
  v_mfma_f32_16x16x32_bf16 a[60:63], a[184:187], v[24:27], a[60:63]
  ds_read_b64_tr_b16 a[182:183], v222 offset:12288
  v_cvt_pk_bf16_f32 v121, v122, v123
  v_mfma_f32_16x16x32_bf16 a[64:67], a[160:163], v[0:3], a[64:67]
  v_exp_f32 v100, v100
  v_mfma_f32_16x16x32_bf16 a[64:67], a[164:167], v[32:35], a[64:67]
  ds_read_b64_tr_b16 a[184:185], v223 offset:0
  v_mfma_f32_16x16x32_bf16 a[68:71], a[164:167], v[40:43], a[68:71]
  v_exp_f32 v101, v101
  v_mfma_f32_16x16x32_bf16 a[68:71], a[160:163], v[8:11], a[68:71]
  ds_read_b64_tr_b16 a[186:187], v223 offset:4096
  v_cvt_pk_bf16_f32 v98, v100, v101
  v_mfma_f32_16x16x32_bf16 a[72:75], a[160:163], v[16:19], a[72:75]
  v_exp_f32 v102, v102
  v_mfma_f32_16x16x32_bf16 a[72:75], a[164:167], v[48:51], a[72:75]
  ds_read_b64_tr_b16 a[188:189], v223 offset:8192
  v_mfma_f32_16x16x32_bf16 a[76:79], a[164:167], v[56:59], a[76:79]
  s_waitcnt lgkmcnt(7)
  v_exp_f32 v103, v103
  v_mfma_f32_16x16x32_bf16 a[76:79], a[160:163], v[24:27], a[76:79]
  ds_read_b64_tr_b16 a[190:191], v223 offset:12288
  v_cvt_pk_bf16_f32 v99, v102, v103
  v_mfma_f32_16x16x32_bf16 a[80:83], a[168:171], v[0:3], a[80:83]
  s_waitcnt vmcnt(11)
  v_exp_f32 v108, v108
  v_mfma_f32_16x16x32_bf16 a[80:83], a[172:175], v[32:35], a[80:83]
  v_mfma_f32_16x16x32_bf16 a[84:87], a[172:175], v[40:43], a[84:87]
  s_barrier
  v_exp_f32 v109, v109
  v_mfma_f32_16x16x32_bf16 a[84:87], a[168:171], v[8:11], a[84:87]
  ds_read_b128 a[128:131], v212 offset:32768
  v_cvt_pk_bf16_f32 v106, v108, v109
  v_mfma_f32_16x16x32_bf16 a[88:91], a[168:171], v[16:19], a[88:91]
  v_exp_f32 v110, v110
  v_mfma_f32_16x16x32_bf16 a[88:91], a[172:175], v[48:51], a[88:91]
  ds_read_b128 a[132:135], v213 offset:32768
  buffer_atomic_add v250, v249, s[24:27], s47 offen
  s_cmp_eq_u32 s32, 3
  s_cselect_b32 s39, 0, 1073741824
  v_mfma_f32_16x16x32_bf16 a[92:95], a[172:175], v[56:59], a[92:95]
  s_waitcnt lgkmcnt(6)
  v_exp_f32 v111, v111
  v_mfma_f32_16x16x32_bf16 a[92:95], a[168:171], v[24:27], a[92:95]
  ds_read_b128 a[136:139], v214 offset:32768
  v_cvt_pk_bf16_f32 v107, v110, v111
  v_mfma_f32_16x16x32_bf16 a[96:99], a[176:179], v[0:3], a[96:99]
  v_exp_f32 v116, v116
  v_mfma_f32_16x16x32_bf16 a[96:99], a[180:183], v[32:35], a[96:99]
  ds_read_b128 a[140:143], v215 offset:32768
  v_or_b32 v249, s39, v251
  v_mfma_f32_16x16x32_bf16 a[100:103], a[180:183], v[40:43], a[100:103]
  v_exp_f32 v117, v117
  v_mfma_f32_16x16x32_bf16 a[100:103], a[176:179], v[8:11], a[100:103]
  v_cvt_pk_bf16_f32 v114, v116, v117
  v_mfma_f32_16x16x32_bf16 a[104:107], a[176:179], v[16:19], a[104:107]
  v_exp_f32 v118, v118
  v_mfma_f32_16x16x32_bf16 a[104:107], a[180:183], v[48:51], a[104:107]
  v_mfma_f32_16x16x32_bf16 a[108:111], a[180:183], v[56:59], a[108:111]
  s_waitcnt lgkmcnt(4)
  v_exp_f32 v119, v119
  v_mfma_f32_16x16x32_bf16 a[108:111], a[176:179], v[24:27], a[108:111]
  v_cvt_pk_bf16_f32 v115, v118, v119
  v_mfma_f32_16x16x32_bf16 a[112:115], a[184:187], v[0:3], a[112:115]
  v_exp_f32 v124, v124
  v_mfma_f32_16x16x32_bf16 a[112:115], a[188:191], v[32:35], a[112:115]
  v_mfma_f32_16x16x32_bf16 a[116:119], a[188:191], v[40:43], a[116:119]
  v_exp_f32 v125, v125
  v_mfma_f32_16x16x32_bf16 a[116:119], a[184:187], v[8:11], a[116:119]
  v_cvt_pk_bf16_f32 v122, v124, v125
  v_mfma_f32_16x16x32_bf16 a[120:123], a[184:187], v[16:19], a[120:123]
  v_exp_f32 v126, v126
  v_mfma_f32_16x16x32_bf16 a[120:123], a[188:191], v[48:51], a[120:123]
  v_mfma_f32_16x16x32_bf16 a[124:127], a[188:191], v[56:59], a[124:127]
  s_waitcnt lgkmcnt(0)
  v_exp_f32 v127, v127
  v_mfma_f32_16x16x32_bf16 a[124:127], a[184:187], v[24:27], a[124:127]
  v_cvt_pk_bf16_f32 v123, v126, v127
  v_mfma_f32_16x16x32_bf16 v[0:3], a[128:131], v[128:131], v[192:195]
  s_add_u32 m0, s28, 114688
  v_mfma_f32_16x16x32_bf16 v[0:3], a[132:135], v[132:135], v[0:3]
  ds_read_b128 a[144:147], v212 offset:36864
  v_mfma_f32_16x16x32_bf16 v[0:3], a[136:139], v[136:139], v[0:3]
  buffer_load_dwordx4 v236, s[16:19], s29 offen offset:0 lds
  v_mfma_f32_16x16x32_bf16 v[0:3], a[140:143], v[140:143], v[0:3]
  ds_read_b128 a[148:151], v213 offset:36864
  v_mfma_f32_16x16x32_bf16 v[8:11], a[140:143], v[156:159], v[196:199]
  v_mfma_f32_16x16x32_bf16 v[8:11], a[136:139], v[152:155], v[8:11]
  ds_read_b128 a[152:155], v214 offset:36864
  v_mfma_f32_16x16x32_bf16 v[8:11], a[132:135], v[148:151], v[8:11]
  buffer_load_dwordx4 v237, s[16:19], s29 offen offset:1024 lds
  v_mfma_f32_16x16x32_bf16 v[8:11], a[128:131], v[144:147], v[8:11]
  ds_read_b128 a[156:159], v215 offset:36864
  v_mfma_f32_16x16x32_bf16 v[16:19], a[128:131], v[160:163], v[200:203]
  v_exp_f32 v0, v0
  v_mfma_f32_16x16x32_bf16 v[16:19], a[132:135], v[164:167], v[16:19]
  v_mfma_f32_16x16x32_bf16 v[16:19], a[136:139], v[168:171], v[16:19]
  v_exp_f32 v1, v1
  v_mfma_f32_16x16x32_bf16 v[16:19], a[140:143], v[172:175], v[16:19]
  v_cvt_pk_bf16_f32 v0, v0, v1
  v_mfma_f32_16x16x32_bf16 v[24:27], a[140:143], v[188:191], v[204:207]
  v_exp_f32 v2, v2
  v_mfma_f32_16x16x32_bf16 v[24:27], a[136:139], v[184:187], v[24:27]
  buffer_load_dwordx4 v236, s[16:19], s29 offen offset:2048 lds
  v_mfma_f32_16x16x32_bf16 v[24:27], a[132:135], v[180:183], v[24:27]
  s_waitcnt lgkmcnt(0)
  v_exp_f32 v3, v3
  v_mfma_f32_16x16x32_bf16 v[24:27], a[128:131], v[176:179], v[24:27]
  v_cvt_pk_bf16_f32 v1, v2, v3
  v_mfma_f32_16x16x32_bf16 v[4:7], a[144:147], v[128:131], v[192:195]
  v_exp_f32 v8, v8
  v_mfma_f32_16x16x32_bf16 v[4:7], a[148:151], v[132:135], v[4:7]
  ds_read_b128 a[128:131], v212 offset:40960
  v_mfma_f32_16x16x32_bf16 v[4:7], a[152:155], v[136:139], v[4:7]
  v_exp_f32 v9, v9
  v_mfma_f32_16x16x32_bf16 v[4:7], a[156:159], v[140:143], v[4:7]
  ds_read_b128 a[132:135], v213 offset:40960
  v_cvt_pk_bf16_f32 v8, v8, v9
  v_mfma_f32_16x16x32_bf16 v[12:15], a[156:159], v[156:159], v[196:199]
  v_exp_f32 v10, v10
  v_mfma_f32_16x16x32_bf16 v[12:15], a[152:155], v[152:155], v[12:15]
  ds_read_b128 a[136:139], v214 offset:40960
  v_mfma_f32_16x16x32_bf16 v[12:15], a[148:151], v[148:151], v[12:15]
  v_exp_f32 v11, v11
  v_mfma_f32_16x16x32_bf16 v[12:15], a[144:147], v[144:147], v[12:15]
  ds_read_b128 a[140:143], v215 offset:40960
  v_cvt_pk_bf16_f32 v9, v10, v11
  v_mfma_f32_16x16x32_bf16 v[20:23], a[144:147], v[160:163], v[200:203]
  v_exp_f32 v16, v16
  v_mfma_f32_16x16x32_bf16 v[20:23], a[148:151], v[164:167], v[20:23]
  buffer_load_dwordx4 v237, s[16:19], s29 offen offset:3072 lds
  v_mfma_f32_16x16x32_bf16 v[20:23], a[152:155], v[168:171], v[20:23]
  s_add_u32 s29, s29, 16384
  v_exp_f32 v17, v17
  v_mfma_f32_16x16x32_bf16 v[20:23], a[156:159], v[172:175], v[20:23]
  v_cvt_pk_bf16_f32 v16, v16, v17
  v_mfma_f32_16x16x32_bf16 v[28:31], a[156:159], v[188:191], v[204:207]
  s_add_u32 m0, s28, 0
  v_exp_f32 v18, v18
  v_mfma_f32_16x16x32_bf16 v[28:31], a[152:155], v[184:187], v[28:31]
  buffer_load_dwordx4 v232, s[12:15], s29 offen offset:0 lds
  v_mfma_f32_16x16x32_bf16 v[28:31], a[148:151], v[180:183], v[28:31]
  s_waitcnt lgkmcnt(0)
  v_exp_f32 v19, v19
  v_mfma_f32_16x16x32_bf16 v[28:31], a[144:147], v[176:179], v[28:31]
  v_cvt_pk_bf16_f32 v17, v18, v19
  v_mfma_f32_16x16x32_bf16 v[32:35], a[128:131], v[128:131], v[192:195]
  v_exp_f32 v24, v24
  v_mfma_f32_16x16x32_bf16 v[32:35], a[132:135], v[132:135], v[32:35]
  ds_read_b128 a[144:147], v212 offset:45056
  v_mfma_f32_16x16x32_bf16 v[32:35], a[136:139], v[136:139], v[32:35]
  v_exp_f32 v25, v25
  v_mfma_f32_16x16x32_bf16 v[32:35], a[140:143], v[140:143], v[32:35]
  ds_read_b128 a[148:151], v213 offset:45056
  v_cvt_pk_bf16_f32 v24, v24, v25
  v_mfma_f32_16x16x32_bf16 v[40:43], a[140:143], v[156:159], v[196:199]
  v_exp_f32 v26, v26
  v_mfma_f32_16x16x32_bf16 v[40:43], a[136:139], v[152:155], v[40:43]
  ds_read_b128 a[152:155], v214 offset:45056
  v_mfma_f32_16x16x32_bf16 v[40:43], a[132:135], v[148:151], v[40:43]
  v_exp_f32 v27, v27
  v_mfma_f32_16x16x32_bf16 v[40:43], a[128:131], v[144:147], v[40:43]
  ds_read_b128 a[156:159], v215 offset:45056
  v_cvt_pk_bf16_f32 v25, v26, v27
  v_mfma_f32_16x16x32_bf16 v[48:51], a[128:131], v[160:163], v[200:203]
  v_exp_f32 v4, v4
  v_mfma_f32_16x16x32_bf16 v[48:51], a[132:135], v[164:167], v[48:51]
  buffer_load_dwordx4 v233, s[12:15], s29 offen offset:1024 lds
  v_mfma_f32_16x16x32_bf16 v[48:51], a[136:139], v[168:171], v[48:51]
  v_exp_f32 v5, v5
  v_mfma_f32_16x16x32_bf16 v[48:51], a[140:143], v[172:175], v[48:51]
  v_cvt_pk_bf16_f32 v2, v4, v5
  v_mfma_f32_16x16x32_bf16 v[56:59], a[140:143], v[188:191], v[204:207]
  v_exp_f32 v6, v6
  v_mfma_f32_16x16x32_bf16 v[56:59], a[136:139], v[184:187], v[56:59]
  buffer_load_dwordx4 v234, s[12:15], s29 offen offset:2048 lds
  v_mfma_f32_16x16x32_bf16 v[56:59], a[132:135], v[180:183], v[56:59]
  s_waitcnt lgkmcnt(0)
  v_exp_f32 v7, v7
  v_mfma_f32_16x16x32_bf16 v[56:59], a[128:131], v[176:179], v[56:59]
  v_cvt_pk_bf16_f32 v3, v6, v7
  v_mfma_f32_16x16x32_bf16 v[36:39], a[144:147], v[128:131], v[192:195]
  v_exp_f32 v12, v12
  v_mfma_f32_16x16x32_bf16 v[36:39], a[148:151], v[132:135], v[36:39]
  ds_read_b64_tr_b16 a[160:161], v216 offset:16384
  v_mfma_f32_16x16x32_bf16 v[36:39], a[152:155], v[136:139], v[36:39]
  v_exp_f32 v13, v13
  v_mfma_f32_16x16x32_bf16 v[36:39], a[156:159], v[140:143], v[36:39]
  ds_read_b64_tr_b16 a[162:163], v216 offset:20480
  v_cvt_pk_bf16_f32 v10, v12, v13
  v_mfma_f32_16x16x32_bf16 v[44:47], a[156:159], v[156:159], v[196:199]
  v_exp_f32 v14, v14
  v_mfma_f32_16x16x32_bf16 v[44:47], a[152:155], v[152:155], v[44:47]
  ds_read_b64_tr_b16 a[164:165], v216 offset:24576
  buffer_load_dwordx4 v235, s[12:15], s29 offen offset:3072 lds
  v_mfma_f32_16x16x32_bf16 v[44:47], a[148:151], v[148:151], v[44:47]
  v_exp_f32 v15, v15
  v_mfma_f32_16x16x32_bf16 v[44:47], a[144:147], v[144:147], v[44:47]
  ds_read_b64_tr_b16 a[166:167], v216 offset:28672
  v_cvt_pk_bf16_f32 v11, v14, v15
  v_mfma_f32_16x16x32_bf16 v[52:55], a[144:147], v[160:163], v[200:203]
  s_mov_b32 m0, s51
  v_exp_f32 v20, v20
  v_mfma_f32_16x16x32_bf16 v[52:55], a[148:151], v[164:167], v[52:55]
  ds_read_b64_tr_b16 a[168:169], v217 offset:16384
  buffer_load_dwordx4 v210, s[4:7], s100 offen lds
  s_add_u32 s100, s100, 20480
  s_add_u32 s51, s51, 512
  v_mfma_f32_16x16x32_bf16 v[52:55], a[152:155], v[168:171], v[52:55]
  v_exp_f32 v21, v21
  v_mfma_f32_16x16x32_bf16 v[52:55], a[156:159], v[172:175], v[52:55]
  ds_read_b64_tr_b16 a[170:171], v217 offset:20480
  v_cvt_pk_bf16_f32 v18, v20, v21
  v_mfma_f32_16x16x32_bf16 v[60:63], a[156:159], v[188:191], v[204:207]
  s_waitcnt vmcnt(20)
  v_exp_f32 v22, v22
  v_mfma_f32_16x16x32_bf16 v[60:63], a[152:155], v[184:187], v[60:63]
  ds_read_b64_tr_b16 a[172:173], v217 offset:24576
  ds_read_b64_tr_b16 a[232:233], v209 offset:4096
  v_mfma_f32_16x16x32_bf16 v[60:63], a[148:151], v[180:183], v[60:63]
  v_exp_f32 v23, v23
  v_mfma_f32_16x16x32_bf16 v[60:63], a[144:147], v[176:179], v[60:63]
  ds_read_b64_tr_b16 a[174:175], v217 offset:28672
  v_cvt_pk_bf16_f32 v19, v22, v23
  v_mfma_f32_16x16x32_bf16 a[192:195], a[208:211], v[64:67], a[192:195]
  v_exp_f32 v28, v28
  v_mfma_f32_16x16x32_bf16 a[192:195], a[208:211], v[96:99], a[192:195]
  ds_read_b64_tr_b16 a[176:177], v218 offset:16384
  ds_read_b64_tr_b16 a[234:235], v209 offset:4608
  v_mfma_f32_16x16x32_bf16 a[196:199], a[208:211], v[72:75], a[196:199]
  v_exp_f32 v29, v29
  v_mfma_f32_16x16x32_bf16 a[196:199], a[208:211], v[104:107], a[196:199]
  ds_read_b64_tr_b16 a[178:179], v218 offset:20480
  v_cvt_pk_bf16_f32 v26, v28, v29
  v_mfma_f32_16x16x32_bf16 a[200:203], a[208:211], v[80:83], a[200:203]
  v_exp_f32 v30, v30
  v_mfma_f32_16x16x32_bf16 a[200:203], a[208:211], v[112:115], a[200:203]
  ds_read_b64_tr_b16 a[180:181], v218 offset:24576
  v_mfma_f32_16x16x32_bf16 a[204:207], a[208:211], v[88:91], a[204:207]
  s_waitcnt lgkmcnt(9)
  v_exp_f32 v31, v31
  v_mfma_f32_16x16x32_bf16 a[204:207], a[208:211], v[120:123], a[204:207]
  ds_read_b64_tr_b16 a[182:183], v218 offset:28672
  v_cvt_pk_bf16_f32 v27, v30, v31
  v_mfma_f32_16x16x32_bf16 a[0:3], a[160:163], v[64:67], a[0:3]
  v_exp_f32 v32, v32
  v_mfma_f32_16x16x32_bf16 a[0:3], a[164:167], v[96:99], a[0:3]
  ds_read_b64_tr_b16 a[184:185], v219 offset:16384
  s_waitcnt lgkmcnt(4)
  buffer_store_dwordx4 a[232:235], v211, s[24:27], s31 offen sc1
  s_add_u32 s31, s31, 1024
  s_cmp_gt_u32 s32, 3
  v_mfma_f32_16x16x32_bf16 a[4:7], a[164:167], v[104:107], a[4:7]
  s_cselect_b32 s39, 0, 1073741824
  v_exp_f32 v33, v33
  v_mfma_f32_16x16x32_bf16 a[4:7], a[160:163], v[72:75], a[4:7]
  ds_read_b64_tr_b16 a[186:187], v219 offset:20480
  v_cvt_pk_bf16_f32 v32, v32, v33
  v_mfma_f32_16x16x32_bf16 a[8:11], a[160:163], v[80:83], a[8:11]
  v_exp_f32 v34, v34
  v_mfma_f32_16x16x32_bf16 a[8:11], a[164:167], v[112:115], a[8:11]
  ds_read_b64_tr_b16 a[188:189], v219 offset:24576
  v_or_b32 v211, s39, v211
  v_mfma_f32_16x16x32_bf16 a[12:15], a[164:167], v[120:123], a[12:15]
  v_exp_f32 v35, v35
  v_mfma_f32_16x16x32_bf16 a[12:15], a[160:163], v[88:91], a[12:15]
  ds_read_b64_tr_b16 a[190:191], v219 offset:28672
  v_cvt_pk_bf16_f32 v33, v34, v35
  v_mfma_f32_16x16x32_bf16 a[16:19], a[168:171], v[64:67], a[16:19]
  v_exp_f32 v40, v40
  v_mfma_f32_16x16x32_bf16 a[16:19], a[172:175], v[96:99], a[16:19]
  ds_read_b64_tr_b16 a[160:161], v220 offset:16384
  v_or_b32 v208, s39, v208
  v_mfma_f32_16x16x32_bf16 a[20:23], a[172:175], v[104:107], a[20:23]
  v_exp_f32 v41, v41
  v_mfma_f32_16x16x32_bf16 a[20:23], a[168:171], v[72:75], a[20:23]
  ds_read_b64_tr_b16 a[162:163], v220 offset:20480
  v_cvt_pk_bf16_f32 v40, v40, v41
  v_mfma_f32_16x16x32_bf16 a[24:27], a[168:171], v[80:83], a[24:27]
  v_exp_f32 v42, v42
  v_mfma_f32_16x16x32_bf16 a[24:27], a[172:175], v[112:115], a[24:27]
  ds_read_b64_tr_b16 a[164:165], v220 offset:24576
  v_mfma_f32_16x16x32_bf16 a[28:31], a[172:175], v[120:123], a[28:31]
  s_waitcnt lgkmcnt(7)
  v_exp_f32 v43, v43
  v_mfma_f32_16x16x32_bf16 a[28:31], a[168:171], v[88:91], a[28:31]
  ds_read_b64_tr_b16 a[166:167], v220 offset:28672
  v_cvt_pk_bf16_f32 v41, v42, v43
  v_mfma_f32_16x16x32_bf16 a[32:35], a[176:179], v[64:67], a[32:35]
  v_exp_f32 v48, v48
  v_mfma_f32_16x16x32_bf16 a[32:35], a[180:183], v[96:99], a[32:35]
  ds_read_b64_tr_b16 a[168:169], v221 offset:16384
  v_mfma_f32_16x16x32_bf16 a[36:39], a[180:183], v[104:107], a[36:39]
  v_exp_f32 v49, v49
  v_mfma_f32_16x16x32_bf16 a[36:39], a[176:179], v[72:75], a[36:39]
  ds_read_b64_tr_b16 a[170:171], v221 offset:20480
  v_cvt_pk_bf16_f32 v48, v48, v49
  v_mfma_f32_16x16x32_bf16 a[40:43], a[176:179], v[80:83], a[40:43]
  v_exp_f32 v50, v50
  v_mfma_f32_16x16x32_bf16 a[40:43], a[180:183], v[112:115], a[40:43]
  ds_read_b64_tr_b16 a[172:173], v221 offset:24576
  v_mfma_f32_16x16x32_bf16 a[44:47], a[180:183], v[120:123], a[44:47]
  s_waitcnt lgkmcnt(7)
  v_exp_f32 v51, v51
  v_mfma_f32_16x16x32_bf16 a[44:47], a[176:179], v[88:91], a[44:47]
  ds_read_b64_tr_b16 a[174:175], v221 offset:28672
  v_cvt_pk_bf16_f32 v49, v50, v51
  v_mfma_f32_16x16x32_bf16 a[48:51], a[184:187], v[64:67], a[48:51]
  v_exp_f32 v56, v56
  v_mfma_f32_16x16x32_bf16 a[48:51], a[188:191], v[96:99], a[48:51]
  ds_read_b64_tr_b16 a[176:177], v222 offset:16384
  v_mfma_f32_16x16x32_bf16 a[52:55], a[188:191], v[104:107], a[52:55]
  v_exp_f32 v57, v57
  v_mfma_f32_16x16x32_bf16 a[52:55], a[184:187], v[72:75], a[52:55]
  ds_read_b64_tr_b16 a[178:179], v222 offset:20480
  v_cvt_pk_bf16_f32 v56, v56, v57
  v_mfma_f32_16x16x32_bf16 a[56:59], a[184:187], v[80:83], a[56:59]
  v_exp_f32 v58, v58
  v_mfma_f32_16x16x32_bf16 a[56:59], a[188:191], v[112:115], a[56:59]
  ds_read_b64_tr_b16 a[180:181], v222 offset:24576
  v_mfma_f32_16x16x32_bf16 a[60:63], a[188:191], v[120:123], a[60:63]
  s_waitcnt lgkmcnt(7)
  v_exp_f32 v59, v59
  v_mfma_f32_16x16x32_bf16 a[60:63], a[184:187], v[88:91], a[60:63]
  ds_read_b64_tr_b16 a[182:183], v222 offset:28672
  v_cvt_pk_bf16_f32 v57, v58, v59
  v_mfma_f32_16x16x32_bf16 a[64:67], a[160:163], v[64:67], a[64:67]
  v_exp_f32 v36, v36
  v_mfma_f32_16x16x32_bf16 a[64:67], a[164:167], v[96:99], a[64:67]
  ds_read_b64_tr_b16 a[184:185], v223 offset:16384
  v_mfma_f32_16x16x32_bf16 a[68:71], a[164:167], v[104:107], a[68:71]
  v_exp_f32 v37, v37
  v_mfma_f32_16x16x32_bf16 a[68:71], a[160:163], v[72:75], a[68:71]
  ds_read_b64_tr_b16 a[186:187], v223 offset:20480
  v_cvt_pk_bf16_f32 v34, v36, v37
  v_mfma_f32_16x16x32_bf16 a[72:75], a[160:163], v[80:83], a[72:75]
  v_exp_f32 v38, v38
  v_mfma_f32_16x16x32_bf16 a[72:75], a[164:167], v[112:115], a[72:75]
  ds_read_b64_tr_b16 a[188:189], v223 offset:24576
  v_mfma_f32_16x16x32_bf16 a[76:79], a[164:167], v[120:123], a[76:79]
  s_waitcnt lgkmcnt(7)
  v_exp_f32 v39, v39
  v_mfma_f32_16x16x32_bf16 a[76:79], a[160:163], v[88:91], a[76:79]
  ds_read_b64_tr_b16 a[190:191], v223 offset:28672
  v_cvt_pk_bf16_f32 v35, v38, v39
  v_mfma_f32_16x16x32_bf16 a[80:83], a[168:171], v[64:67], a[80:83]
  s_waitcnt vmcnt(12)
  v_exp_f32 v44, v44
  v_mfma_f32_16x16x32_bf16 a[80:83], a[172:175], v[96:99], a[80:83]
  v_mfma_f32_16x16x32_bf16 a[84:87], a[172:175], v[104:107], a[84:87]
  s_barrier
  v_exp_f32 v45, v45
  v_mfma_f32_16x16x32_bf16 a[84:87], a[168:171], v[72:75], a[84:87]
  ds_read_b128 a[128:131], v212 offset:49152
  v_cvt_pk_bf16_f32 v42, v44, v45
  v_mfma_f32_16x16x32_bf16 a[88:91], a[168:171], v[80:83], a[88:91]
  v_exp_f32 v46, v46
  v_mfma_f32_16x16x32_bf16 a[88:91], a[172:175], v[112:115], a[88:91]
  ds_read_b128 a[132:135], v213 offset:49152
  v_mfma_f32_16x16x32_bf16 a[92:95], a[172:175], v[120:123], a[92:95]
  s_waitcnt lgkmcnt(6)
  v_exp_f32 v47, v47
  v_mfma_f32_16x16x32_bf16 a[92:95], a[168:171], v[88:91], a[92:95]
  ds_read_b128 a[136:139], v214 offset:49152
  v_cvt_pk_bf16_f32 v43, v46, v47
  v_mfma_f32_16x16x32_bf16 a[96:99], a[176:179], v[64:67], a[96:99]
  v_exp_f32 v52, v52
  v_mfma_f32_16x16x32_bf16 a[96:99], a[180:183], v[96:99], a[96:99]
  ds_read_b128 a[140:143], v215 offset:49152
  v_mfma_f32_16x16x32_bf16 a[100:103], a[180:183], v[104:107], a[100:103]
  v_exp_f32 v53, v53
  v_mfma_f32_16x16x32_bf16 a[100:103], a[176:179], v[72:75], a[100:103]
  v_cvt_pk_bf16_f32 v50, v52, v53
  v_mfma_f32_16x16x32_bf16 a[104:107], a[176:179], v[80:83], a[104:107]
  v_exp_f32 v54, v54
  v_mfma_f32_16x16x32_bf16 a[104:107], a[180:183], v[112:115], a[104:107]
  v_mfma_f32_16x16x32_bf16 a[108:111], a[180:183], v[120:123], a[108:111]
  s_waitcnt lgkmcnt(4)
  v_exp_f32 v55, v55
  v_mfma_f32_16x16x32_bf16 a[108:111], a[176:179], v[88:91], a[108:111]
  v_cvt_pk_bf16_f32 v51, v54, v55
  v_mfma_f32_16x16x32_bf16 a[112:115], a[184:187], v[64:67], a[112:115]
  v_exp_f32 v60, v60
  v_mfma_f32_16x16x32_bf16 a[112:115], a[188:191], v[96:99], a[112:115]
  v_mfma_f32_16x16x32_bf16 a[116:119], a[188:191], v[104:107], a[116:119]
  v_exp_f32 v61, v61
  v_mfma_f32_16x16x32_bf16 a[116:119], a[184:187], v[72:75], a[116:119]
  v_cvt_pk_bf16_f32 v58, v60, v61
  v_mfma_f32_16x16x32_bf16 a[120:123], a[184:187], v[80:83], a[120:123]
  v_exp_f32 v62, v62
  v_mfma_f32_16x16x32_bf16 a[120:123], a[188:191], v[112:115], a[120:123]
  v_mfma_f32_16x16x32_bf16 a[124:127], a[188:191], v[120:123], a[124:127]
  s_waitcnt lgkmcnt(0)
  v_exp_f32 v63, v63
  v_mfma_f32_16x16x32_bf16 a[124:127], a[184:187], v[88:91], a[124:127]
  v_cvt_pk_bf16_f32 v59, v62, v63
  v_mfma_f32_16x16x32_bf16 v[64:67], a[128:131], v[128:131], v[192:195]
  s_add_u32 m0, s28, 65536
  v_mfma_f32_16x16x32_bf16 v[64:67], a[132:135], v[132:135], v[64:67]
  ds_read_b128 a[144:147], v212 offset:53248
  v_mfma_f32_16x16x32_bf16 v[64:67], a[136:139], v[136:139], v[64:67]
  buffer_load_dwordx4 v236, s[16:19], s29 offen offset:0 lds
  v_mfma_f32_16x16x32_bf16 v[64:67], a[140:143], v[140:143], v[64:67]
  ds_read_b128 a[148:151], v213 offset:53248
  v_mfma_f32_16x16x32_bf16 v[72:75], a[140:143], v[156:159], v[196:199]
  v_mfma_f32_16x16x32_bf16 v[72:75], a[136:139], v[152:155], v[72:75]
  ds_read_b128 a[152:155], v214 offset:53248
  v_mfma_f32_16x16x32_bf16 v[72:75], a[132:135], v[148:151], v[72:75]
  buffer_load_dwordx4 v237, s[16:19], s29 offen offset:1024 lds
  v_mfma_f32_16x16x32_bf16 v[72:75], a[128:131], v[144:147], v[72:75]
  ds_read_b128 a[156:159], v215 offset:53248
  v_mfma_f32_16x16x32_bf16 v[80:83], a[128:131], v[160:163], v[200:203]
  v_exp_f32 v64, v64
  v_mfma_f32_16x16x32_bf16 v[80:83], a[132:135], v[164:167], v[80:83]
  v_mfma_f32_16x16x32_bf16 v[80:83], a[136:139], v[168:171], v[80:83]
  v_exp_f32 v65, v65
  v_mfma_f32_16x16x32_bf16 v[80:83], a[140:143], v[172:175], v[80:83]
  v_cvt_pk_bf16_f32 v64, v64, v65
  v_mfma_f32_16x16x32_bf16 v[88:91], a[140:143], v[188:191], v[204:207]
  v_exp_f32 v66, v66
  v_mfma_f32_16x16x32_bf16 v[88:91], a[136:139], v[184:187], v[88:91]
  buffer_load_dwordx4 v236, s[16:19], s29 offen offset:2048 lds
  v_mfma_f32_16x16x32_bf16 v[88:91], a[132:135], v[180:183], v[88:91]
  s_waitcnt lgkmcnt(0)
  v_exp_f32 v67, v67
  v_mfma_f32_16x16x32_bf16 v[88:91], a[128:131], v[176:179], v[88:91]
  v_cvt_pk_bf16_f32 v65, v66, v67
  v_mfma_f32_16x16x32_bf16 v[68:71], a[144:147], v[128:131], v[192:195]
  v_exp_f32 v72, v72
  v_mfma_f32_16x16x32_bf16 v[68:71], a[148:151], v[132:135], v[68:71]
  ds_read_b128 a[128:131], v212 offset:57344
  v_mfma_f32_16x16x32_bf16 v[68:71], a[152:155], v[136:139], v[68:71]
  v_exp_f32 v73, v73
  v_mfma_f32_16x16x32_bf16 v[68:71], a[156:159], v[140:143], v[68:71]
  ds_read_b128 a[132:135], v213 offset:57344
  v_cvt_pk_bf16_f32 v72, v72, v73
  v_mfma_f32_16x16x32_bf16 v[76:79], a[156:159], v[156:159], v[196:199]
  v_exp_f32 v74, v74
  v_mfma_f32_16x16x32_bf16 v[76:79], a[152:155], v[152:155], v[76:79]
  ds_read_b128 a[136:139], v214 offset:57344
  v_mfma_f32_16x16x32_bf16 v[76:79], a[148:151], v[148:151], v[76:79]
  v_exp_f32 v75, v75
  v_mfma_f32_16x16x32_bf16 v[76:79], a[144:147], v[144:147], v[76:79]
  ds_read_b128 a[140:143], v215 offset:57344
  v_cvt_pk_bf16_f32 v73, v74, v75
  v_mfma_f32_16x16x32_bf16 v[84:87], a[144:147], v[160:163], v[200:203]
  v_exp_f32 v80, v80
  v_mfma_f32_16x16x32_bf16 v[84:87], a[148:151], v[164:167], v[84:87]
  buffer_load_dwordx4 v237, s[16:19], s29 offen offset:3072 lds
  v_mfma_f32_16x16x32_bf16 v[84:87], a[152:155], v[168:171], v[84:87]
  s_add_u32 s29, s29, 16384
  v_exp_f32 v81, v81
  v_mfma_f32_16x16x32_bf16 v[84:87], a[156:159], v[172:175], v[84:87]
  v_cvt_pk_bf16_f32 v80, v80, v81
  v_mfma_f32_16x16x32_bf16 v[92:95], a[156:159], v[188:191], v[204:207]
  s_add_u32 m0, s28, 16384
  v_exp_f32 v82, v82
  v_mfma_f32_16x16x32_bf16 v[92:95], a[152:155], v[184:187], v[92:95]
  buffer_load_dwordx4 v232, s[12:15], s29 offen offset:0 lds
  v_mfma_f32_16x16x32_bf16 v[92:95], a[148:151], v[180:183], v[92:95]
  s_waitcnt lgkmcnt(0)
  v_exp_f32 v83, v83
  v_mfma_f32_16x16x32_bf16 v[92:95], a[144:147], v[176:179], v[92:95]
  v_cvt_pk_bf16_f32 v81, v82, v83
  v_mfma_f32_16x16x32_bf16 v[96:99], a[128:131], v[128:131], v[192:195]
  v_exp_f32 v88, v88
  v_mfma_f32_16x16x32_bf16 v[96:99], a[132:135], v[132:135], v[96:99]
  ds_read_b128 a[144:147], v212 offset:61440
  v_mfma_f32_16x16x32_bf16 v[96:99], a[136:139], v[136:139], v[96:99]
  v_exp_f32 v89, v89
  v_mfma_f32_16x16x32_bf16 v[96:99], a[140:143], v[140:143], v[96:99]
  ds_read_b128 a[148:151], v213 offset:61440
  v_cvt_pk_bf16_f32 v88, v88, v89
  v_mfma_f32_16x16x32_bf16 v[104:107], a[140:143], v[156:159], v[196:199]
  v_exp_f32 v90, v90
  v_mfma_f32_16x16x32_bf16 v[104:107], a[136:139], v[152:155], v[104:107]
  ds_read_b128 a[152:155], v214 offset:61440
  v_mfma_f32_16x16x32_bf16 v[104:107], a[132:135], v[148:151], v[104:107]
  v_exp_f32 v91, v91
  v_mfma_f32_16x16x32_bf16 v[104:107], a[128:131], v[144:147], v[104:107]
  ds_read_b128 a[156:159], v215 offset:61440
  v_cvt_pk_bf16_f32 v89, v90, v91
  v_mfma_f32_16x16x32_bf16 v[112:115], a[128:131], v[160:163], v[200:203]
  v_exp_f32 v68, v68
  v_mfma_f32_16x16x32_bf16 v[112:115], a[132:135], v[164:167], v[112:115]
  buffer_load_dwordx4 v233, s[12:15], s29 offen offset:1024 lds
  v_mfma_f32_16x16x32_bf16 v[112:115], a[136:139], v[168:171], v[112:115]
  v_exp_f32 v69, v69
  v_mfma_f32_16x16x32_bf16 v[112:115], a[140:143], v[172:175], v[112:115]
  v_cvt_pk_bf16_f32 v66, v68, v69
  v_mfma_f32_16x16x32_bf16 v[120:123], a[140:143], v[188:191], v[204:207]
  v_exp_f32 v70, v70
  v_mfma_f32_16x16x32_bf16 v[120:123], a[136:139], v[184:187], v[120:123]
  buffer_load_dwordx4 v234, s[12:15], s29 offen offset:2048 lds
  v_mfma_f32_16x16x32_bf16 v[120:123], a[132:135], v[180:183], v[120:123]
  s_waitcnt lgkmcnt(0)
  v_exp_f32 v71, v71
  v_mfma_f32_16x16x32_bf16 v[120:123], a[128:131], v[176:179], v[120:123]
  v_cvt_pk_bf16_f32 v67, v70, v71
  v_mfma_f32_16x16x32_bf16 v[100:103], a[144:147], v[128:131], v[192:195]
  v_exp_f32 v76, v76
  v_mfma_f32_16x16x32_bf16 v[100:103], a[148:151], v[132:135], v[100:103]
  ds_read_b64_tr_b16 a[160:161], v216 offset:32768
  v_mfma_f32_16x16x32_bf16 v[100:103], a[152:155], v[136:139], v[100:103]
  v_exp_f32 v77, v77
  v_mfma_f32_16x16x32_bf16 v[100:103], a[156:159], v[140:143], v[100:103]
  ds_read_b64_tr_b16 a[162:163], v216 offset:36864
  v_cvt_pk_bf16_f32 v74, v76, v77
  v_mfma_f32_16x16x32_bf16 v[108:111], a[156:159], v[156:159], v[196:199]
  v_exp_f32 v78, v78
  v_mfma_f32_16x16x32_bf16 v[108:111], a[152:155], v[152:155], v[108:111]
  ds_read_b64_tr_b16 a[164:165], v216 offset:40960
  buffer_load_dwordx4 v235, s[12:15], s29 offen offset:3072 lds
  v_mfma_f32_16x16x32_bf16 v[108:111], a[148:151], v[148:151], v[108:111]
  v_exp_f32 v79, v79
  v_mfma_f32_16x16x32_bf16 v[108:111], a[144:147], v[144:147], v[108:111]
  ds_read_b64_tr_b16 a[166:167], v216 offset:45056
  v_cvt_pk_bf16_f32 v75, v78, v79
  v_mfma_f32_16x16x32_bf16 v[116:119], a[144:147], v[160:163], v[200:203]
  v_exp_f32 v84, v84
  v_mfma_f32_16x16x32_bf16 v[116:119], a[148:151], v[164:167], v[116:119]
  ds_read_b64_tr_b16 a[168:169], v217 offset:32768
  buffer_load_dword v254, off, s[24:27], s47 sc1
  v_mfma_f32_16x16x32_bf16 v[116:119], a[152:155], v[168:171], v[116:119]
  v_exp_f32 v85, v85
  v_mfma_f32_16x16x32_bf16 v[116:119], a[156:159], v[172:175], v[116:119]
  ds_read_b64_tr_b16 a[170:171], v217 offset:36864
  v_cvt_pk_bf16_f32 v82, v84, v85
  v_mfma_f32_16x16x32_bf16 v[124:127], a[156:159], v[188:191], v[204:207]
  s_waitcnt vmcnt(20)
  v_exp_f32 v86, v86
  v_mfma_f32_16x16x32_bf16 v[124:127], a[152:155], v[184:187], v[124:127]
  ds_read_b64_tr_b16 a[172:173], v217 offset:40960
  ds_read_b64_tr_b16 a[232:233], v209 offset:5120
  v_mfma_f32_16x16x32_bf16 v[124:127], a[148:151], v[180:183], v[124:127]
  v_exp_f32 v87, v87
  v_mfma_f32_16x16x32_bf16 v[124:127], a[144:147], v[176:179], v[124:127]
  ds_read_b64_tr_b16 a[174:175], v217 offset:45056
  v_cvt_pk_bf16_f32 v83, v86, v87
  v_mfma_f32_16x16x32_bf16 a[192:195], a[208:211], v[0:3], a[192:195]
  v_exp_f32 v92, v92
  v_mfma_f32_16x16x32_bf16 a[192:195], a[208:211], v[32:35], a[192:195]
  ds_read_b64_tr_b16 a[176:177], v218 offset:32768
  ds_read_b64_tr_b16 a[234:235], v209 offset:5632
  v_mfma_f32_16x16x32_bf16 a[196:199], a[208:211], v[8:11], a[196:199]
  v_exp_f32 v93, v93
  v_mfma_f32_16x16x32_bf16 a[196:199], a[208:211], v[40:43], a[196:199]
  ds_read_b64_tr_b16 a[178:179], v218 offset:36864
  v_cvt_pk_bf16_f32 v90, v92, v93
  v_mfma_f32_16x16x32_bf16 a[200:203], a[208:211], v[16:19], a[200:203]
  v_exp_f32 v94, v94
  v_mfma_f32_16x16x32_bf16 a[200:203], a[208:211], v[48:51], a[200:203]
  ds_read_b64_tr_b16 a[180:181], v218 offset:40960
  v_mfma_f32_16x16x32_bf16 a[204:207], a[208:211], v[24:27], a[204:207]
  s_waitcnt lgkmcnt(9)
  v_exp_f32 v95, v95
  v_mfma_f32_16x16x32_bf16 a[204:207], a[208:211], v[56:59], a[204:207]
  ds_read_b64_tr_b16 a[182:183], v218 offset:45056
  v_cvt_pk_bf16_f32 v91, v94, v95
  v_mfma_f32_16x16x32_bf16 a[0:3], a[160:163], v[0:3], a[0:3]
  v_exp_f32 v96, v96
  v_mfma_f32_16x16x32_bf16 a[0:3], a[164:167], v[32:35], a[0:3]
  ds_read_b64_tr_b16 a[184:185], v219 offset:32768
  s_waitcnt lgkmcnt(4)
  buffer_store_dwordx4 a[232:235], v211, s[24:27], s31 offen sc1
  s_add_u32 s31, s31, 1024
  v_mfma_f32_16x16x32_bf16 a[4:7], a[164:167], v[40:43], a[4:7]
  v_exp_f32 v97, v97
  v_mfma_f32_16x16x32_bf16 a[4:7], a[160:163], v[8:11], a[4:7]
  ds_read_b64_tr_b16 a[186:187], v219 offset:36864
  v_cvt_pk_bf16_f32 v96, v96, v97
  v_mfma_f32_16x16x32_bf16 a[8:11], a[160:163], v[16:19], a[8:11]
  v_exp_f32 v98, v98
  v_mfma_f32_16x16x32_bf16 a[8:11], a[164:167], v[48:51], a[8:11]
  ds_read_b64_tr_b16 a[188:189], v219 offset:40960
  v_mfma_f32_16x16x32_bf16 a[12:15], a[164:167], v[56:59], a[12:15]
  v_exp_f32 v99, v99
  v_mfma_f32_16x16x32_bf16 a[12:15], a[160:163], v[24:27], a[12:15]
  ds_read_b64_tr_b16 a[190:191], v219 offset:45056
  v_cvt_pk_bf16_f32 v97, v98, v99
  v_mfma_f32_16x16x32_bf16 a[16:19], a[168:171], v[0:3], a[16:19]
  v_exp_f32 v104, v104
  v_mfma_f32_16x16x32_bf16 a[16:19], a[172:175], v[32:35], a[16:19]
  ds_read_b64_tr_b16 a[160:161], v220 offset:32768
  v_mfma_f32_16x16x32_bf16 a[20:23], a[172:175], v[40:43], a[20:23]
  v_exp_f32 v105, v105
  v_mfma_f32_16x16x32_bf16 a[20:23], a[168:171], v[8:11], a[20:23]
  ds_read_b64_tr_b16 a[162:163], v220 offset:36864
  v_cvt_pk_bf16_f32 v104, v104, v105
  v_mfma_f32_16x16x32_bf16 a[24:27], a[168:171], v[16:19], a[24:27]
  v_exp_f32 v106, v106
  v_mfma_f32_16x16x32_bf16 a[24:27], a[172:175], v[48:51], a[24:27]
  ds_read_b64_tr_b16 a[164:165], v220 offset:40960
  v_mfma_f32_16x16x32_bf16 a[28:31], a[172:175], v[56:59], a[28:31]
  s_waitcnt lgkmcnt(7)
  v_exp_f32 v107, v107
  v_mfma_f32_16x16x32_bf16 a[28:31], a[168:171], v[24:27], a[28:31]
  ds_read_b64_tr_b16 a[166:167], v220 offset:45056
  v_cvt_pk_bf16_f32 v105, v106, v107
  v_mfma_f32_16x16x32_bf16 a[32:35], a[176:179], v[0:3], a[32:35]
  v_exp_f32 v112, v112
  v_mfma_f32_16x16x32_bf16 a[32:35], a[180:183], v[32:35], a[32:35]
  ds_read_b64_tr_b16 a[168:169], v221 offset:32768
  v_mfma_f32_16x16x32_bf16 a[36:39], a[180:183], v[40:43], a[36:39]
  v_exp_f32 v113, v113
  v_mfma_f32_16x16x32_bf16 a[36:39], a[176:179], v[8:11], a[36:39]
  ds_read_b64_tr_b16 a[170:171], v221 offset:36864
  v_cvt_pk_bf16_f32 v112, v112, v113
  v_mfma_f32_16x16x32_bf16 a[40:43], a[176:179], v[16:19], a[40:43]
  v_exp_f32 v114, v114
  v_mfma_f32_16x16x32_bf16 a[40:43], a[180:183], v[48:51], a[40:43]
  ds_read_b64_tr_b16 a[172:173], v221 offset:40960
  v_mfma_f32_16x16x32_bf16 a[44:47], a[180:183], v[56:59], a[44:47]
  s_waitcnt lgkmcnt(7)
  v_exp_f32 v115, v115
  v_mfma_f32_16x16x32_bf16 a[44:47], a[176:179], v[24:27], a[44:47]
  ds_read_b64_tr_b16 a[174:175], v221 offset:45056
  v_cvt_pk_bf16_f32 v113, v114, v115
  v_mfma_f32_16x16x32_bf16 a[48:51], a[184:187], v[0:3], a[48:51]
  v_exp_f32 v120, v120
  v_mfma_f32_16x16x32_bf16 a[48:51], a[188:191], v[32:35], a[48:51]
  ds_read_b64_tr_b16 a[176:177], v222 offset:32768
  v_mfma_f32_16x16x32_bf16 a[52:55], a[188:191], v[40:43], a[52:55]
  v_exp_f32 v121, v121
  v_mfma_f32_16x16x32_bf16 a[52:55], a[184:187], v[8:11], a[52:55]
  ds_read_b64_tr_b16 a[178:179], v222 offset:36864
  v_cvt_pk_bf16_f32 v120, v120, v121
  v_mfma_f32_16x16x32_bf16 a[56:59], a[184:187], v[16:19], a[56:59]
  v_exp_f32 v122, v122
  v_mfma_f32_16x16x32_bf16 a[56:59], a[188:191], v[48:51], a[56:59]
  ds_read_b64_tr_b16 a[180:181], v222 offset:40960
  v_mfma_f32_16x16x32_bf16 a[60:63], a[188:191], v[56:59], a[60:63]
  s_waitcnt lgkmcnt(7)
  v_exp_f32 v123, v123
  v_mfma_f32_16x16x32_bf16 a[60:63], a[184:187], v[24:27], a[60:63]
  ds_read_b64_tr_b16 a[182:183], v222 offset:45056
  v_cvt_pk_bf16_f32 v121, v122, v123
  v_mfma_f32_16x16x32_bf16 a[64:67], a[160:163], v[0:3], a[64:67]
  v_exp_f32 v100, v100
  v_mfma_f32_16x16x32_bf16 a[64:67], a[164:167], v[32:35], a[64:67]
  ds_read_b64_tr_b16 a[184:185], v223 offset:32768
  v_mfma_f32_16x16x32_bf16 a[68:71], a[164:167], v[40:43], a[68:71]
  v_exp_f32 v101, v101
  v_mfma_f32_16x16x32_bf16 a[68:71], a[160:163], v[8:11], a[68:71]
  ds_read_b64_tr_b16 a[186:187], v223 offset:36864
  v_cvt_pk_bf16_f32 v98, v100, v101
  v_mfma_f32_16x16x32_bf16 a[72:75], a[160:163], v[16:19], a[72:75]
  v_exp_f32 v102, v102
  v_mfma_f32_16x16x32_bf16 a[72:75], a[164:167], v[48:51], a[72:75]
  ds_read_b64_tr_b16 a[188:189], v223 offset:40960
  v_mfma_f32_16x16x32_bf16 a[76:79], a[164:167], v[56:59], a[76:79]
  s_waitcnt lgkmcnt(7)
  v_exp_f32 v103, v103
  v_mfma_f32_16x16x32_bf16 a[76:79], a[160:163], v[24:27], a[76:79]
  ds_read_b64_tr_b16 a[190:191], v223 offset:45056
  v_cvt_pk_bf16_f32 v99, v102, v103
  v_mfma_f32_16x16x32_bf16 a[80:83], a[168:171], v[0:3], a[80:83]
  s_waitcnt vmcnt(12)
  v_exp_f32 v108, v108
  v_mfma_f32_16x16x32_bf16 a[80:83], a[172:175], v[32:35], a[80:83]
  v_mfma_f32_16x16x32_bf16 a[84:87], a[172:175], v[40:43], a[84:87]
  s_barrier
  v_exp_f32 v109, v109
  v_mfma_f32_16x16x32_bf16 a[84:87], a[168:171], v[8:11], a[84:87]
  ds_read_b128 a[128:131], v212 offset:0
  v_cvt_pk_bf16_f32 v106, v108, v109
  v_mfma_f32_16x16x32_bf16 a[88:91], a[168:171], v[16:19], a[88:91]
  v_exp_f32 v110, v110
  v_mfma_f32_16x16x32_bf16 a[88:91], a[172:175], v[48:51], a[88:91]
  ds_read_b128 a[132:135], v213 offset:0
  v_mfma_f32_16x16x32_bf16 a[92:95], a[172:175], v[56:59], a[92:95]
  s_waitcnt lgkmcnt(6)
  v_exp_f32 v111, v111
  v_mfma_f32_16x16x32_bf16 a[92:95], a[168:171], v[24:27], a[92:95]
  ds_read_b128 a[136:139], v214 offset:0
  v_cvt_pk_bf16_f32 v107, v110, v111
  v_mfma_f32_16x16x32_bf16 a[96:99], a[176:179], v[0:3], a[96:99]
  v_exp_f32 v116, v116
  v_mfma_f32_16x16x32_bf16 a[96:99], a[180:183], v[32:35], a[96:99]
  ds_read_b128 a[140:143], v215 offset:0
  v_mfma_f32_16x16x32_bf16 a[100:103], a[180:183], v[40:43], a[100:103]
  v_exp_f32 v117, v117
  v_mfma_f32_16x16x32_bf16 a[100:103], a[176:179], v[8:11], a[100:103]
  v_cvt_pk_bf16_f32 v114, v116, v117
  v_mfma_f32_16x16x32_bf16 a[104:107], a[176:179], v[16:19], a[104:107]
  v_exp_f32 v118, v118
  v_mfma_f32_16x16x32_bf16 a[104:107], a[180:183], v[48:51], a[104:107]
  v_mfma_f32_16x16x32_bf16 a[108:111], a[180:183], v[56:59], a[108:111]
  s_waitcnt lgkmcnt(4)
  v_exp_f32 v119, v119
  v_mfma_f32_16x16x32_bf16 a[108:111], a[176:179], v[24:27], a[108:111]
  v_cvt_pk_bf16_f32 v115, v118, v119
  v_mfma_f32_16x16x32_bf16 a[112:115], a[184:187], v[0:3], a[112:115]
  v_exp_f32 v124, v124
  v_mfma_f32_16x16x32_bf16 a[112:115], a[188:191], v[32:35], a[112:115]
  v_mfma_f32_16x16x32_bf16 a[116:119], a[188:191], v[40:43], a[116:119]
  s_sub_u32 s32, s32, 1
  v_exp_f32 v125, v125
  v_mfma_f32_16x16x32_bf16 a[116:119], a[184:187], v[8:11], a[116:119]
  v_cvt_pk_bf16_f32 v122, v124, v125
  v_mfma_f32_16x16x32_bf16 a[120:123], a[184:187], v[16:19], a[120:123]
  s_cmp_lg_u32 s32, 0
  v_exp_f32 v126, v126
  v_mfma_f32_16x16x32_bf16 a[120:123], a[188:191], v[48:51], a[120:123]
  v_mfma_f32_16x16x32_bf16 a[124:127], a[188:191], v[56:59], a[124:127]
  s_waitcnt lgkmcnt(0)
  v_exp_f32 v127, v127
  v_mfma_f32_16x16x32_bf16 a[124:127], a[184:187], v[24:27], a[124:127]
  v_cvt_pk_bf16_f32 v123, v126, v127
  s_cbranch_scc1 attn_loop
  s_waitcnt vmcnt(1)
  v_readfirstlane_b32 s38, v254
  s_nop 0
  s_cmp_ge_u32 s38, 512
  s_cbranch_scc1 attn_h_ready
  s_mov_b32 s39, 32768
attn_spin:
  s_sleep 4
  buffer_load_dword v254, off, s[24:27], s47 sc1
  s_waitcnt vmcnt(0)
  v_readfirstlane_b32 s38, v254
  s_nop 0
  s_cmp_ge_u32 s38, 512
  s_cbranch_scc1 attn_h_ready
  s_sub_u32 s39, s39, 1
  s_cmp_lg_u32 s39, 0
  s_cbranch_scc1 attn_spin
attn_h_ready:
  v_mfma_f32_16x16x32_bf16 v[0:3], a[128:131], v[128:131], v[192:195]
  s_add_u32 m0, s28, 81920
  s_and_b32 s38, s2, 1
  s_lshl_b32 s38, s38, 2
  v_lshrrev_b32 v224, 4, v242
  v_and_b32 v225, 7, v224
  v_mfma_f32_16x16x32_bf16 v[0:3], a[132:135], v[132:135], v[0:3]
  ds_read_b128 a[144:147], v212 offset:4096
  s_add_u32 s38, s38, s3
  s_mul_i32 s38, s38, 81920
  s_lshr_b32 s39, s2, 5
  v_mul_u32_u24 v225, 0xd80, v225
  v_mfma_f32_16x16x32_bf16 v[0:3], a[136:139], v[136:139], v[0:3]
  buffer_load_dwordx4 v236, s[16:19], s29 offen offset:0 lds
  s_mul_i32 s39, s39, 655360
  s_add_u32 s38, s38, s39
  s_add_u32 s4, s38, 3145728
  v_mfma_f32_16x16x32_bf16 v[0:3], a[140:143], v[140:143], v[0:3]
  ds_read_b128 a[148:151], v213 offset:4096
  s_add_u32 s5, s4, 12288
  s_add_u32 s6, s4, 24576
  s_add_u32 s7, s4, 36864
  v_lshrrev_b32 v224, 4, v224
  v_mfma_f32_16x16x32_bf16 v[8:11], a[140:143], v[156:159], v[196:199]
  s_add_u32 s8, s4, 49152
  s_add_u32 s9, s4, 61440
  s_add_u32 s10, s4, 73728
  v_lshl_add_u32 v225, v224, 4, v225
  v_add_u32 v252, 4096, v242
  v_mfma_f32_16x16x32_bf16 v[8:11], a[136:139], v[152:155], v[8:11]
  ds_read_b128 a[152:155], v214 offset:4096
  buffer_load_dwordx4 a[212:215], v225, s[24:27], s101 offen offset:0 sc1
  v_mfma_f32_16x16x32_bf16 v[8:11], a[132:135], v[148:151], v[8:11]
  buffer_load_dwordx4 v237, s[16:19], s29 offen offset:1024 lds
  v_mfma_f32_16x16x32_bf16 v[8:11], a[128:131], v[144:147], v[8:11]
  ds_read_b128 a[156:159], v215 offset:4096
  buffer_load_dwordx4 a[216:219], v225, s[24:27], s101 offen offset:64 sc1
  v_mfma_f32_16x16x32_bf16 v[16:19], a[128:131], v[160:163], v[200:203]
  v_exp_f32 v0, v0
  v_mfma_f32_16x16x32_bf16 v[16:19], a[132:135], v[164:167], v[16:19]
  buffer_load_dwordx4 a[220:223], v225, s[24:27], s101 offen offset:128 sc1
  v_mfma_f32_16x16x32_bf16 v[16:19], a[136:139], v[168:171], v[16:19]
  v_exp_f32 v1, v1
  v_mfma_f32_16x16x32_bf16 v[16:19], a[140:143], v[172:175], v[16:19]
  v_cvt_pk_bf16_f32 v0, v0, v1
  v_add_u32 v253, 8192, v242
  v_mfma_f32_16x16x32_bf16 v[24:27], a[140:143], v[188:191], v[204:207]
  v_exp_f32 v2, v2
  v_mfma_f32_16x16x32_bf16 v[24:27], a[136:139], v[184:187], v[24:27]
  buffer_load_dwordx4 v236, s[16:19], s29 offen offset:2048 lds
  v_mfma_f32_16x16x32_bf16 v[24:27], a[132:135], v[180:183], v[24:27]
  s_waitcnt lgkmcnt(0)
  v_exp_f32 v3, v3
  v_mfma_f32_16x16x32_bf16 v[24:27], a[128:131], v[176:179], v[24:27]
  v_cvt_pk_bf16_f32 v1, v2, v3
  v_mfma_f32_16x16x32_bf16 v[4:7], a[144:147], v[128:131], v[192:195]
  v_exp_f32 v8, v8
  v_mfma_f32_16x16x32_bf16 v[4:7], a[148:151], v[132:135], v[4:7]
  ds_read_b128 a[128:131], v212 offset:8192
  v_mfma_f32_16x16x32_bf16 v[4:7], a[152:155], v[136:139], v[4:7]
  v_exp_f32 v9, v9
  v_mfma_f32_16x16x32_bf16 v[4:7], a[156:159], v[140:143], v[4:7]
  ds_read_b128 a[132:135], v213 offset:8192
  v_cvt_pk_bf16_f32 v8, v8, v9
  v_mfma_f32_16x16x32_bf16 v[12:15], a[156:159], v[156:159], v[196:199]
  v_exp_f32 v10, v10
  v_mfma_f32_16x16x32_bf16 v[12:15], a[152:155], v[152:155], v[12:15]
  ds_read_b128 a[136:139], v214 offset:8192
  v_mfma_f32_16x16x32_bf16 v[12:15], a[148:151], v[148:151], v[12:15]
  v_exp_f32 v11, v11
  v_mfma_f32_16x16x32_bf16 v[12:15], a[144:147], v[144:147], v[12:15]
  ds_read_b128 a[140:143], v215 offset:8192
  v_cvt_pk_bf16_f32 v9, v10, v11
  v_mfma_f32_16x16x32_bf16 v[20:23], a[144:147], v[160:163], v[200:203]
  v_exp_f32 v16, v16
  v_mfma_f32_16x16x32_bf16 v[20:23], a[148:151], v[164:167], v[20:23]
  buffer_load_dwordx4 v237, s[16:19], s29 offen offset:3072 lds
  v_mfma_f32_16x16x32_bf16 v[20:23], a[152:155], v[168:171], v[20:23]
  s_add_u32 s29, s29, 16384
  v_exp_f32 v17, v17
  v_mfma_f32_16x16x32_bf16 v[20:23], a[156:159], v[172:175], v[20:23]
  v_cvt_pk_bf16_f32 v16, v16, v17
  v_mfma_f32_16x16x32_bf16 v[28:31], a[156:159], v[188:191], v[204:207]
  s_add_u32 m0, s28, 32768
  v_exp_f32 v18, v18
  v_mfma_f32_16x16x32_bf16 v[28:31], a[152:155], v[184:187], v[28:31]
  buffer_load_dwordx4 v232, s[12:15], s29 offen offset:0 lds
  v_mfma_f32_16x16x32_bf16 v[28:31], a[148:151], v[180:183], v[28:31]
  s_waitcnt lgkmcnt(0)
  v_exp_f32 v19, v19
  v_mfma_f32_16x16x32_bf16 v[28:31], a[144:147], v[176:179], v[28:31]
  v_cvt_pk_bf16_f32 v17, v18, v19
  v_mfma_f32_16x16x32_bf16 v[32:35], a[128:131], v[128:131], v[192:195]
  v_exp_f32 v24, v24
  v_mfma_f32_16x16x32_bf16 v[32:35], a[132:135], v[132:135], v[32:35]
  ds_read_b128 a[144:147], v212 offset:12288
  v_mfma_f32_16x16x32_bf16 v[32:35], a[136:139], v[136:139], v[32:35]
  v_exp_f32 v25, v25
  v_mfma_f32_16x16x32_bf16 v[32:35], a[140:143], v[140:143], v[32:35]
  ds_read_b128 a[148:151], v213 offset:12288
  v_cvt_pk_bf16_f32 v24, v24, v25
  v_mfma_f32_16x16x32_bf16 v[40:43], a[140:143], v[156:159], v[196:199]
  v_exp_f32 v26, v26
  v_mfma_f32_16x16x32_bf16 v[40:43], a[136:139], v[152:155], v[40:43]
  ds_read_b128 a[152:155], v214 offset:12288
  v_mfma_f32_16x16x32_bf16 v[40:43], a[132:135], v[148:151], v[40:43]
  v_exp_f32 v27, v27
  v_mfma_f32_16x16x32_bf16 v[40:43], a[128:131], v[144:147], v[40:43]
  ds_read_b128 a[156:159], v215 offset:12288
  v_cvt_pk_bf16_f32 v25, v26, v27
  v_mfma_f32_16x16x32_bf16 v[48:51], a[128:131], v[160:163], v[200:203]
  v_exp_f32 v4, v4
  v_mfma_f32_16x16x32_bf16 v[48:51], a[132:135], v[164:167], v[48:51]
  buffer_load_dwordx4 v233, s[12:15], s29 offen offset:1024 lds
  v_mfma_f32_16x16x32_bf16 v[48:51], a[136:139], v[168:171], v[48:51]
  v_exp_f32 v5, v5
  v_mfma_f32_16x16x32_bf16 v[48:51], a[140:143], v[172:175], v[48:51]
  v_cvt_pk_bf16_f32 v2, v4, v5
  v_mfma_f32_16x16x32_bf16 v[56:59], a[140:143], v[188:191], v[204:207]
  v_exp_f32 v6, v6
  v_mfma_f32_16x16x32_bf16 v[56:59], a[136:139], v[184:187], v[56:59]
  buffer_load_dwordx4 v234, s[12:15], s29 offen offset:2048 lds
  v_mfma_f32_16x16x32_bf16 v[56:59], a[132:135], v[180:183], v[56:59]
  s_waitcnt lgkmcnt(0)
  v_exp_f32 v7, v7
  v_mfma_f32_16x16x32_bf16 v[56:59], a[128:131], v[176:179], v[56:59]
  v_cvt_pk_bf16_f32 v3, v6, v7
  v_mfma_f32_16x16x32_bf16 v[36:39], a[144:147], v[128:131], v[192:195]
  v_exp_f32 v12, v12
  v_mfma_f32_16x16x32_bf16 v[36:39], a[148:151], v[132:135], v[36:39]
  ds_read_b64_tr_b16 a[160:161], v216 offset:49152
  v_mfma_f32_16x16x32_bf16 v[36:39], a[152:155], v[136:139], v[36:39]
  v_exp_f32 v13, v13
  v_mfma_f32_16x16x32_bf16 v[36:39], a[156:159], v[140:143], v[36:39]
  ds_read_b64_tr_b16 a[162:163], v216 offset:53248
  v_cvt_pk_bf16_f32 v10, v12, v13
  v_mfma_f32_16x16x32_bf16 v[44:47], a[156:159], v[156:159], v[196:199]
  v_exp_f32 v14, v14
  v_mfma_f32_16x16x32_bf16 v[44:47], a[152:155], v[152:155], v[44:47]
  ds_read_b64_tr_b16 a[164:165], v216 offset:57344
  buffer_load_dwordx4 v235, s[12:15], s29 offen offset:3072 lds
  v_mfma_f32_16x16x32_bf16 v[44:47], a[148:151], v[148:151], v[44:47]
  v_exp_f32 v15, v15
  v_mfma_f32_16x16x32_bf16 v[44:47], a[144:147], v[144:147], v[44:47]
  ds_read_b64_tr_b16 a[166:167], v216 offset:61440
  v_cvt_pk_bf16_f32 v11, v14, v15
  v_mfma_f32_16x16x32_bf16 v[52:55], a[144:147], v[160:163], v[200:203]
  v_exp_f32 v20, v20
  v_mfma_f32_16x16x32_bf16 v[52:55], a[148:151], v[164:167], v[52:55]
  ds_read_b64_tr_b16 a[168:169], v217 offset:49152
  v_mfma_f32_16x16x32_bf16 v[52:55], a[152:155], v[168:171], v[52:55]
  v_exp_f32 v21, v21
  v_mfma_f32_16x16x32_bf16 v[52:55], a[156:159], v[172:175], v[52:55]
  ds_read_b64_tr_b16 a[170:171], v217 offset:53248
  v_cvt_pk_bf16_f32 v18, v20, v21
  v_mfma_f32_16x16x32_bf16 v[60:63], a[156:159], v[188:191], v[204:207]
  v_exp_f32 v22, v22
  v_mfma_f32_16x16x32_bf16 v[60:63], a[152:155], v[184:187], v[60:63]
  ds_read_b64_tr_b16 a[172:173], v217 offset:57344
  v_mfma_f32_16x16x32_bf16 v[60:63], a[148:151], v[180:183], v[60:63]
  v_exp_f32 v23, v23
  v_mfma_f32_16x16x32_bf16 v[60:63], a[144:147], v[176:179], v[60:63]
  ds_read_b64_tr_b16 a[174:175], v217 offset:61440
  v_cvt_pk_bf16_f32 v19, v22, v23
  v_mfma_f32_16x16x32_bf16 a[192:195], a[208:211], v[64:67], a[192:195]
  v_exp_f32 v28, v28
  v_mfma_f32_16x16x32_bf16 a[192:195], a[208:211], v[96:99], a[192:195]
  ds_read_b64_tr_b16 a[176:177], v218 offset:49152
  v_mfma_f32_16x16x32_bf16 a[196:199], a[208:211], v[72:75], a[196:199]
  v_exp_f32 v29, v29
  v_mfma_f32_16x16x32_bf16 a[196:199], a[208:211], v[104:107], a[196:199]
  ds_read_b64_tr_b16 a[178:179], v218 offset:53248
  v_cvt_pk_bf16_f32 v26, v28, v29
  v_mfma_f32_16x16x32_bf16 a[200:203], a[208:211], v[80:83], a[200:203]
  v_exp_f32 v30, v30
  v_mfma_f32_16x16x32_bf16 a[200:203], a[208:211], v[112:115], a[200:203]
  ds_read_b64_tr_b16 a[180:181], v218 offset:57344
  v_mfma_f32_16x16x32_bf16 a[204:207], a[208:211], v[88:91], a[204:207]
  s_waitcnt lgkmcnt(7)
  v_exp_f32 v31, v31
  v_mfma_f32_16x16x32_bf16 a[204:207], a[208:211], v[120:123], a[204:207]
  ds_read_b64_tr_b16 a[182:183], v218 offset:61440
  v_cvt_pk_bf16_f32 v27, v30, v31
  v_mfma_f32_16x16x32_bf16 a[0:3], a[160:163], v[64:67], a[0:3]
  v_exp_f32 v32, v32
  v_mfma_f32_16x16x32_bf16 a[0:3], a[164:167], v[96:99], a[0:3]
  ds_read_b64_tr_b16 a[184:185], v219 offset:49152
  v_mfma_f32_16x16x32_bf16 a[4:7], a[164:167], v[104:107], a[4:7]
  v_exp_f32 v33, v33
  v_mfma_f32_16x16x32_bf16 a[4:7], a[160:163], v[72:75], a[4:7]
  ds_read_b64_tr_b16 a[186:187], v219 offset:53248
  v_cvt_pk_bf16_f32 v32, v32, v33
  v_mfma_f32_16x16x32_bf16 a[8:11], a[160:163], v[80:83], a[8:11]
  v_exp_f32 v34, v34
  v_mfma_f32_16x16x32_bf16 a[8:11], a[164:167], v[112:115], a[8:11]
  ds_read_b64_tr_b16 a[188:189], v219 offset:57344
  v_mfma_f32_16x16x32_bf16 a[12:15], a[164:167], v[120:123], a[12:15]
  s_waitcnt lgkmcnt(7)
  v_exp_f32 v35, v35
  v_mfma_f32_16x16x32_bf16 a[12:15], a[160:163], v[88:91], a[12:15]
  ds_read_b64_tr_b16 a[190:191], v219 offset:61440
  v_cvt_pk_bf16_f32 v33, v34, v35
  v_mfma_f32_16x16x32_bf16 a[16:19], a[168:171], v[64:67], a[16:19]
  v_exp_f32 v40, v40
  v_mfma_f32_16x16x32_bf16 a[16:19], a[172:175], v[96:99], a[16:19]
  ds_read_b64_tr_b16 a[160:161], v220 offset:49152
  v_mfma_f32_16x16x32_bf16 a[20:23], a[172:175], v[104:107], a[20:23]
  v_exp_f32 v41, v41
  v_mfma_f32_16x16x32_bf16 a[20:23], a[168:171], v[72:75], a[20:23]
  ds_read_b64_tr_b16 a[162:163], v220 offset:53248
  v_cvt_pk_bf16_f32 v40, v40, v41
  v_mfma_f32_16x16x32_bf16 a[24:27], a[168:171], v[80:83], a[24:27]
  v_exp_f32 v42, v42
  v_mfma_f32_16x16x32_bf16 a[24:27], a[172:175], v[112:115], a[24:27]
  ds_read_b64_tr_b16 a[164:165], v220 offset:57344
  v_mfma_f32_16x16x32_bf16 a[28:31], a[172:175], v[120:123], a[28:31]
  s_waitcnt lgkmcnt(7)
  v_exp_f32 v43, v43
  v_mfma_f32_16x16x32_bf16 a[28:31], a[168:171], v[88:91], a[28:31]
  ds_read_b64_tr_b16 a[166:167], v220 offset:61440
  v_cvt_pk_bf16_f32 v41, v42, v43
  v_mfma_f32_16x16x32_bf16 a[32:35], a[176:179], v[64:67], a[32:35]
  v_exp_f32 v48, v48
  v_mfma_f32_16x16x32_bf16 a[32:35], a[180:183], v[96:99], a[32:35]
  ds_read_b64_tr_b16 a[168:169], v221 offset:49152
  v_mfma_f32_16x16x32_bf16 a[36:39], a[180:183], v[104:107], a[36:39]
  v_exp_f32 v49, v49
  v_mfma_f32_16x16x32_bf16 a[36:39], a[176:179], v[72:75], a[36:39]
  ds_read_b64_tr_b16 a[170:171], v221 offset:53248
  v_cvt_pk_bf16_f32 v48, v48, v49
  v_mfma_f32_16x16x32_bf16 a[40:43], a[176:179], v[80:83], a[40:43]
  v_exp_f32 v50, v50
  v_mfma_f32_16x16x32_bf16 a[40:43], a[180:183], v[112:115], a[40:43]
  ds_read_b64_tr_b16 a[172:173], v221 offset:57344
  v_mfma_f32_16x16x32_bf16 a[44:47], a[180:183], v[120:123], a[44:47]
  s_waitcnt lgkmcnt(7)
  v_exp_f32 v51, v51
  v_mfma_f32_16x16x32_bf16 a[44:47], a[176:179], v[88:91], a[44:47]
  ds_read_b64_tr_b16 a[174:175], v221 offset:61440
  v_cvt_pk_bf16_f32 v49, v50, v51
  v_mfma_f32_16x16x32_bf16 a[48:51], a[184:187], v[64:67], a[48:51]
  v_exp_f32 v56, v56
  v_mfma_f32_16x16x32_bf16 a[48:51], a[188:191], v[96:99], a[48:51]
  ds_read_b64_tr_b16 a[176:177], v222 offset:49152
  v_mfma_f32_16x16x32_bf16 a[52:55], a[188:191], v[104:107], a[52:55]
  v_exp_f32 v57, v57
  v_mfma_f32_16x16x32_bf16 a[52:55], a[184:187], v[72:75], a[52:55]
  ds_read_b64_tr_b16 a[178:179], v222 offset:53248
  v_cvt_pk_bf16_f32 v56, v56, v57
  v_mfma_f32_16x16x32_bf16 a[56:59], a[184:187], v[80:83], a[56:59]
  v_exp_f32 v58, v58
  v_mfma_f32_16x16x32_bf16 a[56:59], a[188:191], v[112:115], a[56:59]
  ds_read_b64_tr_b16 a[180:181], v222 offset:57344
  v_mfma_f32_16x16x32_bf16 a[60:63], a[188:191], v[120:123], a[60:63]
  s_waitcnt lgkmcnt(7)
  v_exp_f32 v59, v59
  v_mfma_f32_16x16x32_bf16 a[60:63], a[184:187], v[88:91], a[60:63]
  ds_read_b64_tr_b16 a[182:183], v222 offset:61440
  v_cvt_pk_bf16_f32 v57, v58, v59
  v_mfma_f32_16x16x32_bf16 a[64:67], a[160:163], v[64:67], a[64:67]
  v_exp_f32 v36, v36
  v_mfma_f32_16x16x32_bf16 a[64:67], a[164:167], v[96:99], a[64:67]
  ds_read_b64_tr_b16 a[184:185], v223 offset:49152
  v_mfma_f32_16x16x32_bf16 a[68:71], a[164:167], v[104:107], a[68:71]
  v_exp_f32 v37, v37
  v_mfma_f32_16x16x32_bf16 a[68:71], a[160:163], v[72:75], a[68:71]
  ds_read_b64_tr_b16 a[186:187], v223 offset:53248
  v_cvt_pk_bf16_f32 v34, v36, v37
  v_mfma_f32_16x16x32_bf16 a[72:75], a[160:163], v[80:83], a[72:75]
  v_exp_f32 v38, v38
  v_mfma_f32_16x16x32_bf16 a[72:75], a[164:167], v[112:115], a[72:75]
  ds_read_b64_tr_b16 a[188:189], v223 offset:57344
  v_mfma_f32_16x16x32_bf16 a[76:79], a[164:167], v[120:123], a[76:79]
  s_waitcnt lgkmcnt(7)
  v_exp_f32 v39, v39
  v_mfma_f32_16x16x32_bf16 a[76:79], a[160:163], v[88:91], a[76:79]
  ds_read_b64_tr_b16 a[190:191], v223 offset:61440
  v_cvt_pk_bf16_f32 v35, v38, v39
  v_mfma_f32_16x16x32_bf16 a[80:83], a[168:171], v[64:67], a[80:83]
  v_exp_f32 v44, v44
  v_mfma_f32_16x16x32_bf16 a[80:83], a[172:175], v[96:99], a[80:83]
  v_mfma_f32_16x16x32_bf16 a[84:87], a[172:175], v[104:107], a[84:87]
  s_barrier
  v_exp_f32 v45, v45
  v_mfma_f32_16x16x32_bf16 a[84:87], a[168:171], v[72:75], a[84:87]
  ds_read_b128 a[128:131], v212 offset:16384
  v_cvt_pk_bf16_f32 v42, v44, v45
  v_mfma_f32_16x16x32_bf16 a[88:91], a[168:171], v[80:83], a[88:91]
  v_exp_f32 v46, v46
  v_mfma_f32_16x16x32_bf16 a[88:91], a[172:175], v[112:115], a[88:91]
  ds_read_b128 a[132:135], v213 offset:16384
  v_mfma_f32_16x16x32_bf16 a[92:95], a[172:175], v[120:123], a[92:95]
  s_waitcnt lgkmcnt(6)
  v_exp_f32 v47, v47
  v_mfma_f32_16x16x32_bf16 a[92:95], a[168:171], v[88:91], a[92:95]
  ds_read_b128 a[136:139], v214 offset:16384
  v_cvt_pk_bf16_f32 v43, v46, v47
  v_mfma_f32_16x16x32_bf16 a[96:99], a[176:179], v[64:67], a[96:99]
  v_exp_f32 v52, v52
  v_mfma_f32_16x16x32_bf16 a[96:99], a[180:183], v[96:99], a[96:99]
  ds_read_b128 a[140:143], v215 offset:16384
  v_mfma_f32_16x16x32_bf16 a[100:103], a[180:183], v[104:107], a[100:103]
  v_exp_f32 v53, v53
  v_mfma_f32_16x16x32_bf16 a[100:103], a[176:179], v[72:75], a[100:103]
  v_cvt_pk_bf16_f32 v50, v52, v53
  v_mfma_f32_16x16x32_bf16 a[104:107], a[176:179], v[80:83], a[104:107]
  v_exp_f32 v54, v54
  v_mfma_f32_16x16x32_bf16 a[104:107], a[180:183], v[112:115], a[104:107]
  v_mfma_f32_16x16x32_bf16 a[108:111], a[180:183], v[120:123], a[108:111]
  s_waitcnt lgkmcnt(4)
  v_exp_f32 v55, v55
  v_mfma_f32_16x16x32_bf16 a[108:111], a[176:179], v[88:91], a[108:111]
  v_cvt_pk_bf16_f32 v51, v54, v55
  v_mfma_f32_16x16x32_bf16 a[112:115], a[184:187], v[64:67], a[112:115]
  v_exp_f32 v60, v60
  v_mfma_f32_16x16x32_bf16 a[112:115], a[188:191], v[96:99], a[112:115]
  v_mfma_f32_16x16x32_bf16 a[116:119], a[188:191], v[104:107], a[116:119]
  v_exp_f32 v61, v61
  v_mfma_f32_16x16x32_bf16 a[116:119], a[184:187], v[72:75], a[116:119]
  v_cvt_pk_bf16_f32 v58, v60, v61
  v_mfma_f32_16x16x32_bf16 a[120:123], a[184:187], v[80:83], a[120:123]
  v_exp_f32 v62, v62
  v_mfma_f32_16x16x32_bf16 a[120:123], a[188:191], v[112:115], a[120:123]
  v_mfma_f32_16x16x32_bf16 a[124:127], a[188:191], v[120:123], a[124:127]
  s_waitcnt lgkmcnt(0)
  v_exp_f32 v63, v63
  v_mfma_f32_16x16x32_bf16 a[124:127], a[184:187], v[88:91], a[124:127]
  v_cvt_pk_bf16_f32 v59, v62, v63
  v_mfma_f32_16x16x32_bf16 v[64:67], a[128:131], v[128:131], v[192:195]
  s_add_u32 m0, s28, 98304
  v_mfma_f32_16x16x32_bf16 v[64:67], a[132:135], v[132:135], v[64:67]
  ds_read_b128 a[144:147], v212 offset:20480
  v_mfma_f32_16x16x32_bf16 v[64:67], a[136:139], v[136:139], v[64:67]
  buffer_load_dwordx4 v236, s[16:19], s29 offen offset:0 lds
  v_mfma_f32_16x16x32_bf16 v[64:67], a[140:143], v[140:143], v[64:67]
  ds_read_b128 a[148:151], v213 offset:20480
  v_mfma_f32_16x16x32_bf16 v[72:75], a[140:143], v[156:159], v[196:199]
  v_mfma_f32_16x16x32_bf16 v[72:75], a[136:139], v[152:155], v[72:75]
  ds_read_b128 a[152:155], v214 offset:20480
  v_mfma_f32_16x16x32_bf16 v[72:75], a[132:135], v[148:151], v[72:75]
  buffer_load_dwordx4 v237, s[16:19], s29 offen offset:1024 lds
  v_mfma_f32_16x16x32_bf16 v[72:75], a[128:131], v[144:147], v[72:75]
  ds_read_b128 a[156:159], v215 offset:20480
  v_mfma_f32_16x16x32_bf16 v[80:83], a[128:131], v[160:163], v[200:203]
  v_exp_f32 v64, v64
  v_mfma_f32_16x16x32_bf16 v[80:83], a[132:135], v[164:167], v[80:83]
  v_mfma_f32_16x16x32_bf16 v[80:83], a[136:139], v[168:171], v[80:83]
  v_exp_f32 v65, v65
  v_mfma_f32_16x16x32_bf16 v[80:83], a[140:143], v[172:175], v[80:83]
  v_cvt_pk_bf16_f32 v64, v64, v65
  v_mfma_f32_16x16x32_bf16 v[88:91], a[140:143], v[188:191], v[204:207]
  v_exp_f32 v66, v66
  v_mfma_f32_16x16x32_bf16 v[88:91], a[136:139], v[184:187], v[88:91]
  buffer_load_dwordx4 v236, s[16:19], s29 offen offset:2048 lds
  v_mfma_f32_16x16x32_bf16 v[88:91], a[132:135], v[180:183], v[88:91]
  s_waitcnt lgkmcnt(0)
  v_exp_f32 v67, v67
  v_mfma_f32_16x16x32_bf16 v[88:91], a[128:131], v[176:179], v[88:91]
  v_cvt_pk_bf16_f32 v65, v66, v67
  v_mfma_f32_16x16x32_bf16 v[68:71], a[144:147], v[128:131], v[192:195]
  v_exp_f32 v72, v72
  v_mfma_f32_16x16x32_bf16 v[68:71], a[148:151], v[132:135], v[68:71]
  ds_read_b128 a[128:131], v212 offset:24576
  v_mfma_f32_16x16x32_bf16 v[68:71], a[152:155], v[136:139], v[68:71]
  v_exp_f32 v73, v73
  v_mfma_f32_16x16x32_bf16 v[68:71], a[156:159], v[140:143], v[68:71]
  ds_read_b128 a[132:135], v213 offset:24576
  v_cvt_pk_bf16_f32 v72, v72, v73
  v_mfma_f32_16x16x32_bf16 v[76:79], a[156:159], v[156:159], v[196:199]
  v_exp_f32 v74, v74
  v_mfma_f32_16x16x32_bf16 v[76:79], a[152:155], v[152:155], v[76:79]
  ds_read_b128 a[136:139], v214 offset:24576
  v_lshrrev_b32 v224, 4, v242
  v_mfma_f32_16x16x32_bf16 v[76:79], a[148:151], v[148:151], v[76:79]
  v_exp_f32 v75, v75
  v_mfma_f32_16x16x32_bf16 v[76:79], a[144:147], v[144:147], v[76:79]
  ds_read_b128 a[140:143], v215 offset:24576
  v_cvt_pk_bf16_f32 v73, v74, v75
  v_mfma_f32_16x16x32_bf16 v[84:87], a[144:147], v[160:163], v[200:203]
  v_exp_f32 v80, v80
  v_mfma_f32_16x16x32_bf16 v[84:87], a[148:151], v[164:167], v[84:87]
  buffer_load_dwordx4 v237, s[16:19], s29 offen offset:3072 lds
  v_mfma_f32_16x16x32_bf16 v[84:87], a[152:155], v[168:171], v[84:87]
  s_add_u32 s29, s29, 16384
  v_exp_f32 v81, v81
  v_mfma_f32_16x16x32_bf16 v[84:87], a[156:159], v[172:175], v[84:87]
  v_cvt_pk_bf16_f32 v80, v80, v81
  v_lshrrev_b32 v225, 4, v224
  v_mfma_f32_16x16x32_bf16 v[92:95], a[156:159], v[188:191], v[204:207]
  s_add_u32 m0, s28, 49152
  v_exp_f32 v82, v82
  v_mfma_f32_16x16x32_bf16 v[92:95], a[152:155], v[184:187], v[92:95]
  buffer_load_dwordx4 v232, s[12:15], s29 offen offset:0 lds
  v_mfma_f32_16x16x32_bf16 v[92:95], a[148:151], v[180:183], v[92:95]
  s_waitcnt lgkmcnt(0)
  v_exp_f32 v83, v83
  v_mfma_f32_16x16x32_bf16 v[92:95], a[144:147], v[176:179], v[92:95]
  v_cvt_pk_bf16_f32 v81, v82, v83
  v_bfe_u32 v226, v224, 2, 2
  v_mfma_f32_16x16x32_bf16 v[96:99], a[128:131], v[128:131], v[192:195]
  v_exp_f32 v88, v88
  v_mfma_f32_16x16x32_bf16 v[96:99], a[132:135], v[132:135], v[96:99]
  ds_read_b128 a[144:147], v212 offset:28672
  v_lshl_add_u32 v225, v225, 3, v226
  v_mfma_f32_16x16x32_bf16 v[96:99], a[136:139], v[136:139], v[96:99]
  v_exp_f32 v89, v89
  v_mfma_f32_16x16x32_bf16 v[96:99], a[140:143], v[140:143], v[96:99]
  ds_read_b128 a[148:151], v213 offset:28672
  v_cvt_pk_bf16_f32 v88, v88, v89
  v_mfma_f32_16x16x32_bf16 v[104:107], a[140:143], v[156:159], v[196:199]
  v_exp_f32 v90, v90
  v_mfma_f32_16x16x32_bf16 v[104:107], a[136:139], v[152:155], v[104:107]
  ds_read_b128 a[152:155], v214 offset:28672
  v_lshlrev_b32 v225, 5, v225
  v_mfma_f32_16x16x32_bf16 v[104:107], a[132:135], v[148:151], v[104:107]
  v_exp_f32 v91, v91
  v_mfma_f32_16x16x32_bf16 v[104:107], a[128:131], v[144:147], v[104:107]
  ds_read_b128 a[156:159], v215 offset:28672
  v_cvt_pk_bf16_f32 v89, v90, v91
  v_mfma_f32_16x16x32_bf16 v[112:115], a[128:131], v[160:163], v[200:203]
  v_exp_f32 v68, v68
  v_mfma_f32_16x16x32_bf16 v[112:115], a[132:135], v[164:167], v[112:115]
  buffer_load_dwordx4 v233, s[12:15], s29 offen offset:1024 lds
  v_mfma_f32_16x16x32_bf16 v[112:115], a[136:139], v[168:171], v[112:115]
  v_exp_f32 v69, v69
  v_mfma_f32_16x16x32_bf16 v[112:115], a[140:143], v[172:175], v[112:115]
  v_cvt_pk_bf16_f32 v66, v68, v69
  v_and_b32 v226, 3, v224
  v_mfma_f32_16x16x32_bf16 v[120:123], a[140:143], v[188:191], v[204:207]
  v_exp_f32 v70, v70
  v_mfma_f32_16x16x32_bf16 v[120:123], a[136:139], v[184:187], v[120:123]
  buffer_load_dwordx4 v234, s[12:15], s29 offen offset:2048 lds
  v_mfma_f32_16x16x32_bf16 v[120:123], a[132:135], v[180:183], v[120:123]
  s_waitcnt lgkmcnt(0)
  v_exp_f32 v71, v71
  v_mfma_f32_16x16x32_bf16 v[120:123], a[128:131], v[176:179], v[120:123]
  v_cvt_pk_bf16_f32 v67, v70, v71
  v_lshl_add_u32 v225, v226, 3, v225
  v_mfma_f32_16x16x32_bf16 v[100:103], a[144:147], v[128:131], v[192:195]
  v_exp_f32 v76, v76
  v_mfma_f32_16x16x32_bf16 v[100:103], a[148:151], v[132:135], v[100:103]
  ds_read_b64_tr_b16 a[160:161], v216 offset:0
  v_add_u32 v225, s50, v225
  v_mfma_f32_16x16x32_bf16 v[100:103], a[152:155], v[136:139], v[100:103]
  s_waitcnt vmcnt(13)
  v_exp_f32 v77, v77
  v_mfma_f32_16x16x32_bf16 v[100:103], a[156:159], v[140:143], v[100:103]
  ds_read_b64_tr_b16 a[162:163], v216 offset:4096
  v_cvt_pk_bf16_f32 v74, v76, v77
  v_mfma_f32_16x16x32_bf16 v[108:111], a[156:159], v[156:159], v[196:199]
  v_exp_f32 v78, v78
  v_mfma_f32_16x16x32_bf16 v[108:111], a[152:155], v[152:155], v[108:111]
  ds_read_b64_tr_b16 a[164:165], v216 offset:8192
  buffer_load_dwordx4 v235, s[12:15], s29 offen offset:3072 lds
  v_mfma_f32_16x16x32_bf16 v[108:111], a[148:151], v[148:151], v[108:111]
  v_exp_f32 v79, v79
  v_mfma_f32_16x16x32_bf16 v[108:111], a[144:147], v[144:147], v[108:111]
  ds_read_b64_tr_b16 a[166:167], v216 offset:12288
  v_cvt_pk_bf16_f32 v75, v78, v79
  v_mfma_f32_16x16x32_bf16 v[116:119], a[144:147], v[160:163], v[200:203]
  v_exp_f32 v84, v84
  v_mfma_f32_16x16x32_bf16 v[116:119], a[148:151], v[164:167], v[116:119]
  ds_read_b64_tr_b16 a[168:169], v217 offset:0
  ds_read_b64_tr_b16 a[232:233], v225 offset:0
  s_add_u32 m0, s28, 0
  v_mfma_f32_16x16x32_bf16 v[116:119], a[152:155], v[168:171], v[116:119]
  v_exp_f32 v85, v85
  v_mfma_f32_16x16x32_bf16 v[116:119], a[156:159], v[172:175], v[116:119]
  ds_read_b64_tr_b16 a[170:171], v217 offset:4096
  v_cvt_pk_bf16_f32 v82, v84, v85
  v_mfma_f32_16x16x32_bf16 v[124:127], a[156:159], v[188:191], v[204:207]
  v_exp_f32 v86, v86
  v_mfma_f32_16x16x32_bf16 v[124:127], a[152:155], v[184:187], v[124:127]
  ds_read_b64_tr_b16 a[172:173], v217 offset:8192
  ds_read_b64_tr_b16 a[234:235], v225 offset:128
  v_mfma_f32_16x16x32_bf16 v[124:127], a[148:151], v[180:183], v[124:127]
  v_exp_f32 v87, v87
  v_mfma_f32_16x16x32_bf16 v[124:127], a[144:147], v[176:179], v[124:127]
  ds_read_b64_tr_b16 a[174:175], v217 offset:12288
  v_cvt_pk_bf16_f32 v83, v86, v87
  v_mfma_f32_16x16x32_bf16 a[192:195], a[208:211], v[0:3], a[192:195]
  v_exp_f32 v92, v92
  v_mfma_f32_16x16x32_bf16 a[192:195], a[208:211], v[32:35], a[192:195]
  ds_read_b64_tr_b16 a[176:177], v218 offset:0
  ds_read_b64_tr_b16 a[236:237], v225 offset:1024
  v_mfma_f32_16x16x32_bf16 a[196:199], a[208:211], v[8:11], a[196:199]
  v_exp_f32 v93, v93
  v_mfma_f32_16x16x32_bf16 a[196:199], a[208:211], v[40:43], a[196:199]
  ds_read_b64_tr_b16 a[178:179], v218 offset:4096
  v_cvt_pk_bf16_f32 v90, v92, v93
  v_mfma_f32_16x16x32_bf16 a[200:203], a[208:211], v[16:19], a[200:203]
  v_exp_f32 v94, v94
  v_mfma_f32_16x16x32_bf16 a[200:203], a[208:211], v[48:51], a[200:203]
  ds_read_b64_tr_b16 a[180:181], v218 offset:8192
  ds_read_b64_tr_b16 a[238:239], v225 offset:1152
  v_mfma_f32_16x16x32_bf16 a[204:207], a[208:211], v[24:27], a[204:207]
  s_waitcnt lgkmcnt(11)
  v_exp_f32 v95, v95
  v_mfma_f32_16x16x32_bf16 a[204:207], a[208:211], v[56:59], a[204:207]
  ds_read_b64_tr_b16 a[182:183], v218 offset:12288
  v_cvt_pk_bf16_f32 v91, v94, v95
  v_mfma_f32_16x16x32_bf16 a[0:3], a[160:163], v[0:3], a[0:3]
  v_exp_f32 v96, v96
  v_mfma_f32_16x16x32_bf16 a[0:3], a[164:167], v[32:35], a[0:3]
  ds_read_b64_tr_b16 a[184:185], v219 offset:0
  ds_read_b64_tr_b16 a[240:241], v225 offset:2048
  v_mfma_f32_16x16x32_bf16 a[4:7], a[164:167], v[40:43], a[4:7]
  v_exp_f32 v97, v97
  v_mfma_f32_16x16x32_bf16 a[4:7], a[160:163], v[8:11], a[4:7]
  ds_read_b64_tr_b16 a[186:187], v219 offset:4096
  v_cvt_pk_bf16_f32 v96, v96, v97
  v_mfma_f32_16x16x32_bf16 a[8:11], a[160:163], v[16:19], a[8:11]
  v_exp_f32 v98, v98
  v_mfma_f32_16x16x32_bf16 a[8:11], a[164:167], v[48:51], a[8:11]
  ds_read_b64_tr_b16 a[188:189], v219 offset:8192
  ds_read_b64_tr_b16 a[242:243], v225 offset:2176
  v_mfma_f32_16x16x32_bf16 a[12:15], a[164:167], v[56:59], a[12:15]
  s_waitcnt lgkmcnt(11)
  v_exp_f32 v99, v99
  v_mfma_f32_16x16x32_bf16 a[12:15], a[160:163], v[24:27], a[12:15]
  ds_read_b64_tr_b16 a[190:191], v219 offset:12288
  v_cvt_pk_bf16_f32 v97, v98, v99
  v_mfma_f32_16x16x32_bf16 a[16:19], a[168:171], v[0:3], a[16:19]
  v_exp_f32 v104, v104
  v_mfma_f32_16x16x32_bf16 a[16:19], a[172:175], v[32:35], a[16:19]
  ds_read_b64_tr_b16 a[160:161], v220 offset:0
  buffer_load_dwordx4 v253, s[24:27], s8 offen offset:0 sc1 lds
  v_mfma_f32_16x16x32_bf16 a[20:23], a[172:175], v[40:43], a[20:23]
  v_exp_f32 v105, v105
  v_mfma_f32_16x16x32_bf16 a[20:23], a[168:171], v[8:11], a[20:23]
  ds_read_b64_tr_b16 a[162:163], v220 offset:4096
  v_cvt_pk_bf16_f32 v104, v104, v105
  v_mfma_f32_16x16x32_bf16 a[24:27], a[168:171], v[16:19], a[24:27]
  v_exp_f32 v106, v106
  v_mfma_f32_16x16x32_bf16 a[24:27], a[172:175], v[48:51], a[24:27]
  ds_read_b64_tr_b16 a[164:165], v220 offset:8192
  s_waitcnt lgkmcnt(4)
  buffer_load_dwordx4 v253, s[24:27], s8 offen offset:1024 sc1 lds
  v_mfma_f32_16x16x32_bf16 v[228:231], a[232:235], a[212:215], 0
  v_mfma_f32_16x16x32_bf16 v[228:231], a[236:239], a[216:219], v[228:231]
  v_mfma_f32_16x16x32_bf16 v[228:231], a[240:243], a[220:223], v[228:231]
  v_mfma_f32_16x16x32_bf16 a[28:31], a[172:175], v[56:59], a[28:31]
  s_lshl_b32 s35, s3, 10
  s_add_u32 s35, s35, 159744
  v_exp_f32 v107, v107
  v_mfma_f32_16x16x32_bf16 a[28:31], a[168:171], v[24:27], a[28:31]
  ds_read_b64_tr_b16 a[166:167], v220 offset:12288
  v_cvt_pk_bf16_f32 v105, v106, v107
  v_mfma_f32_16x16x32_bf16 a[32:35], a[176:179], v[0:3], a[32:35]
  v_exp_f32 v112, v112
  v_mfma_f32_16x16x32_bf16 a[32:35], a[180:183], v[32:35], a[32:35]
  ds_read_b64_tr_b16 a[168:169], v221 offset:0
  buffer_load_dwordx4 v253, s[24:27], s8 offen offset:2048 sc1 lds
  v_mfma_f32_16x16x32_bf16 a[36:39], a[180:183], v[40:43], a[36:39]
  v_exp_f32 v113, v113
  v_mfma_f32_16x16x32_bf16 a[36:39], a[176:179], v[8:11], a[36:39]
  ds_read_b64_tr_b16 a[170:171], v221 offset:4096
  v_cvt_pk_bf16_f32 v112, v112, v113
  v_mfma_f32_16x16x32_bf16 a[40:43], a[176:179], v[16:19], a[40:43]
  v_exp_f32 v114, v114
  v_mfma_f32_16x16x32_bf16 a[40:43], a[180:183], v[48:51], a[40:43]
  ds_read_b64_tr_b16 a[172:173], v221 offset:8192
  buffer_load_dwordx4 v253, s[24:27], s8 offen offset:3072 sc1 lds
  v_mfma_f32_16x16x32_bf16 a[44:47], a[180:183], v[56:59], a[44:47]
  s_waitcnt lgkmcnt(7)
  v_exp_f32 v115, v115
  v_mfma_f32_16x16x32_bf16 a[44:47], a[176:179], v[24:27], a[44:47]
  ds_read_b64_tr_b16 a[174:175], v221 offset:12288
  v_cvt_pk_bf16_f32 v113, v114, v115
  v_mfma_f32_16x16x32_bf16 a[48:51], a[184:187], v[0:3], a[48:51]
  v_exp_f32 v120, v120
  v_mfma_f32_16x16x32_bf16 a[48:51], a[188:191], v[32:35], a[48:51]
  ds_read_b64_tr_b16 a[176:177], v222 offset:0
  v_add_u32 v224, s35, v242
  v_mfma_f32_16x16x32_bf16 a[52:55], a[188:191], v[40:43], a[52:55]
  v_exp_f32 v121, v121
  v_mfma_f32_16x16x32_bf16 a[52:55], a[184:187], v[8:11], a[52:55]
  ds_read_b64_tr_b16 a[178:179], v222 offset:4096
  v_cvt_pk_bf16_f32 v120, v120, v121
  v_mfma_f32_16x16x32_bf16 a[56:59], a[184:187], v[16:19], a[56:59]
  v_exp_f32 v122, v122
  v_mfma_f32_16x16x32_bf16 a[56:59], a[188:191], v[48:51], a[56:59]
  ds_read_b64_tr_b16 a[180:181], v222 offset:8192
  ds_write_b128 v224, v[228:231]
  v_mfma_f32_16x16x32_bf16 a[60:63], a[188:191], v[56:59], a[60:63]
  s_waitcnt lgkmcnt(8)
  v_exp_f32 v123, v123
  v_mfma_f32_16x16x32_bf16 a[60:63], a[184:187], v[24:27], a[60:63]
  ds_read_b64_tr_b16 a[182:183], v222 offset:12288
  v_cvt_pk_bf16_f32 v121, v122, v123
  v_mfma_f32_16x16x32_bf16 a[64:67], a[160:163], v[0:3], a[64:67]
  v_exp_f32 v100, v100
  v_mfma_f32_16x16x32_bf16 a[64:67], a[164:167], v[32:35], a[64:67]
  ds_read_b64_tr_b16 a[184:185], v223 offset:0
  v_mfma_f32_16x16x32_bf16 a[68:71], a[164:167], v[40:43], a[68:71]
  v_exp_f32 v101, v101
  v_mfma_f32_16x16x32_bf16 a[68:71], a[160:163], v[8:11], a[68:71]
  ds_read_b64_tr_b16 a[186:187], v223 offset:4096
  v_cvt_pk_bf16_f32 v98, v100, v101
  v_mfma_f32_16x16x32_bf16 a[72:75], a[160:163], v[16:19], a[72:75]
  v_exp_f32 v102, v102
  v_mfma_f32_16x16x32_bf16 a[72:75], a[164:167], v[48:51], a[72:75]
  ds_read_b64_tr_b16 a[188:189], v223 offset:8192
  s_waitcnt lgkmcnt(4)
  v_mfma_f32_16x16x32_bf16 a[76:79], a[164:167], v[56:59], a[76:79]
  v_exp_f32 v103, v103
  v_mfma_f32_16x16x32_bf16 a[76:79], a[160:163], v[24:27], a[76:79]
  ds_read_b64_tr_b16 a[190:191], v223 offset:12288
  v_cvt_pk_bf16_f32 v99, v102, v103
  v_mfma_f32_16x16x32_bf16 a[80:83], a[168:171], v[0:3], a[80:83]
  s_waitcnt vmcnt(12)
  v_exp_f32 v108, v108
  v_mfma_f32_16x16x32_bf16 a[80:83], a[172:175], v[32:35], a[80:83]
  v_mfma_f32_16x16x32_bf16 a[84:87], a[172:175], v[40:43], a[84:87]
  s_barrier
  v_exp_f32 v109, v109
  v_mfma_f32_16x16x32_bf16 a[84:87], a[168:171], v[8:11], a[84:87]
  ds_read_b128 a[128:131], v212 offset:32768
  v_cvt_pk_bf16_f32 v106, v108, v109
  v_mfma_f32_16x16x32_bf16 a[88:91], a[168:171], v[16:19], a[88:91]
  v_exp_f32 v110, v110
  v_mfma_f32_16x16x32_bf16 a[88:91], a[172:175], v[48:51], a[88:91]
  ds_read_b128 a[132:135], v213 offset:32768
  v_mfma_f32_16x16x32_bf16 a[92:95], a[172:175], v[56:59], a[92:95]
  s_waitcnt lgkmcnt(6)
  v_exp_f32 v111, v111
  v_mfma_f32_16x16x32_bf16 a[92:95], a[168:171], v[24:27], a[92:95]
  ds_read_b128 a[136:139], v214 offset:32768
  v_cvt_pk_bf16_f32 v107, v110, v111
  v_mfma_f32_16x16x32_bf16 a[96:99], a[176:179], v[0:3], a[96:99]
  v_exp_f32 v116, v116
  v_mfma_f32_16x16x32_bf16 a[96:99], a[180:183], v[32:35], a[96:99]
  ds_read_b128 a[140:143], v215 offset:32768
  v_mfma_f32_16x16x32_bf16 a[100:103], a[180:183], v[40:43], a[100:103]
  v_exp_f32 v117, v117
  v_mfma_f32_16x16x32_bf16 a[100:103], a[176:179], v[8:11], a[100:103]
  v_cvt_pk_bf16_f32 v114, v116, v117
  v_mfma_f32_16x16x32_bf16 a[104:107], a[176:179], v[16:19], a[104:107]
  v_exp_f32 v118, v118
  v_mfma_f32_16x16x32_bf16 a[104:107], a[180:183], v[48:51], a[104:107]
  v_mfma_f32_16x16x32_bf16 a[108:111], a[180:183], v[56:59], a[108:111]
  s_waitcnt lgkmcnt(4)
  v_exp_f32 v119, v119
  v_mfma_f32_16x16x32_bf16 a[108:111], a[176:179], v[24:27], a[108:111]
  v_cvt_pk_bf16_f32 v115, v118, v119
  v_mfma_f32_16x16x32_bf16 a[112:115], a[184:187], v[0:3], a[112:115]
  v_exp_f32 v124, v124
  v_mfma_f32_16x16x32_bf16 a[112:115], a[188:191], v[32:35], a[112:115]
  v_mfma_f32_16x16x32_bf16 a[116:119], a[188:191], v[40:43], a[116:119]
  v_exp_f32 v125, v125
  v_mfma_f32_16x16x32_bf16 a[116:119], a[184:187], v[8:11], a[116:119]
  v_cvt_pk_bf16_f32 v122, v124, v125
  v_mfma_f32_16x16x32_bf16 a[120:123], a[184:187], v[16:19], a[120:123]
  v_exp_f32 v126, v126
  v_mfma_f32_16x16x32_bf16 a[120:123], a[188:191], v[48:51], a[120:123]
  v_mfma_f32_16x16x32_bf16 a[124:127], a[188:191], v[56:59], a[124:127]
  s_waitcnt lgkmcnt(0)
  v_exp_f32 v127, v127
  v_mfma_f32_16x16x32_bf16 a[124:127], a[184:187], v[24:27], a[124:127]
  v_cvt_pk_bf16_f32 v123, v126, v127
  v_mfma_f32_16x16x32_bf16 v[0:3], a[128:131], v[128:131], v[192:195]
  s_add_u32 m0, s28, 114688
  v_add_u32 v224, 159744, v242
  v_mfma_f32_16x16x32_bf16 v[0:3], a[132:135], v[132:135], v[0:3]
  ds_read_b128 a[144:147], v212 offset:36864
  ds_read_b128 v[228:231], v224 offset:0
  v_mfma_f32_16x16x32_bf16 v[0:3], a[136:139], v[136:139], v[0:3]
  buffer_load_dwordx4 v236, s[16:19], s29 offen offset:0 lds
  v_mfma_f32_16x16x32_bf16 v[0:3], a[140:143], v[140:143], v[0:3]
  ds_read_b128 a[148:151], v213 offset:36864
  ds_read_b128 v[238:241], v224 offset:1024
  v_mfma_f32_16x16x32_bf16 v[8:11], a[140:143], v[156:159], v[196:199]
  ds_read_b128 v[208:211], v224 offset:2048
  v_lshrrev_b32 v224, 4, v242
  v_mfma_f32_16x16x32_bf16 v[8:11], a[136:139], v[152:155], v[8:11]
  ds_read_b128 a[152:155], v214 offset:36864
  s_min_u32 s35, s3, 1
  s_lshl_b32 s35, s35, 30
  v_and_b32 v225, 7, v224
  v_mfma_f32_16x16x32_bf16 v[8:11], a[132:135], v[148:151], v[8:11]
  buffer_load_dwordx4 v237, s[16:19], s29 offen offset:1024 lds
  v_mfma_f32_16x16x32_bf16 v[8:11], a[128:131], v[144:147], v[8:11]
  ds_read_b128 a[156:159], v215 offset:36864
  v_mul_u32_u24 v225, 0xa00, v225
  v_mfma_f32_16x16x32_bf16 v[16:19], a[128:131], v[160:163], v[200:203]
  v_exp_f32 v0, v0
  v_mfma_f32_16x16x32_bf16 v[16:19], a[132:135], v[164:167], v[16:19]
  v_lshrrev_b32 v226, 4, v224
  v_lshl_add_u32 v225, v226, 4, v225
  v_mfma_f32_16x16x32_bf16 v[16:19], a[136:139], v[168:171], v[16:19]
  v_exp_f32 v1, v1
  v_mfma_f32_16x16x32_bf16 v[16:19], a[140:143], v[172:175], v[16:19]
  v_cvt_pk_bf16_f32 v0, v0, v1
  v_bfe_u32 v226, v224, 3, 1
  v_mfma_f32_16x16x32_bf16 v[24:27], a[140:143], v[188:191], v[204:207]
  v_exp_f32 v2, v2
  v_mfma_f32_16x16x32_bf16 v[24:27], a[136:139], v[184:187], v[24:27]
  buffer_load_dwordx4 v236, s[16:19], s29 offen offset:2048 lds
  v_mfma_f32_16x16x32_bf16 v[24:27], a[132:135], v[180:183], v[24:27]
  s_waitcnt lgkmcnt(0)
  v_exp_f32 v3, v3
  v_mfma_f32_16x16x32_bf16 v[24:27], a[128:131], v[176:179], v[24:27]
  v_cvt_pk_bf16_f32 v1, v2, v3
  v_lshl_add_u32 v225, v226, 30, v225
  v_mfma_f32_16x16x32_bf16 v[4:7], a[144:147], v[128:131], v[192:195]
  v_exp_f32 v8, v8
  v_mfma_f32_16x16x32_bf16 v[4:7], a[148:151], v[132:135], v[4:7]
  ds_read_b128 a[128:131], v212 offset:40960
  v_or_b32 v225, s35, v225
  v_mfma_f32_16x16x32_bf16 v[4:7], a[152:155], v[136:139], v[4:7]
  s_mul_i32 s35, s98, 20480
  s_lshl_b32 s38, s99, 6
  s_add_u32 s35, s35, s38
  v_exp_f32 v9, v9
  v_mfma_f32_16x16x32_bf16 v[4:7], a[156:159], v[140:143], v[4:7]
  ds_read_b128 a[132:135], v213 offset:40960
  s_add_u32 s35, s35, 2686976
  v_cvt_pk_bf16_f32 v8, v8, v9
  v_mfma_f32_16x16x32_bf16 v[12:15], a[156:159], v[156:159], v[196:199]
  v_exp_f32 v10, v10
  v_mfma_f32_16x16x32_bf16 v[12:15], a[152:155], v[152:155], v[12:15]
  ds_read_b128 a[136:139], v214 offset:40960
  v_add_f32 v228, v228, v238
  v_mfma_f32_16x16x32_bf16 v[12:15], a[148:151], v[148:151], v[12:15]
  v_exp_f32 v11, v11
  v_mfma_f32_16x16x32_bf16 v[12:15], a[144:147], v[144:147], v[12:15]
  ds_read_b128 a[140:143], v215 offset:40960
  v_cvt_pk_bf16_f32 v9, v10, v11
  v_mfma_f32_16x16x32_bf16 v[20:23], a[144:147], v[160:163], v[200:203]
  v_exp_f32 v16, v16
  v_mfma_f32_16x16x32_bf16 v[20:23], a[148:151], v[164:167], v[20:23]
  buffer_load_dwordx4 v237, s[16:19], s29 offen offset:3072 lds
  v_mfma_f32_16x16x32_bf16 v[20:23], a[152:155], v[168:171], v[20:23]
  s_add_u32 s29, s29, 16384
  v_exp_f32 v17, v17
  v_mfma_f32_16x16x32_bf16 v[20:23], a[156:159], v[172:175], v[20:23]
  v_cvt_pk_bf16_f32 v16, v16, v17
  v_add_f32 v229, v229, v239
  v_mfma_f32_16x16x32_bf16 v[28:31], a[156:159], v[188:191], v[204:207]
  s_add_u32 m0, s28, 16384
  v_exp_f32 v18, v18
  v_mfma_f32_16x16x32_bf16 v[28:31], a[152:155], v[184:187], v[28:31]
  buffer_load_dwordx4 v242, s[24:27], s9 offen offset:0 sc1 lds
  v_mfma_f32_16x16x32_bf16 v[28:31], a[148:151], v[180:183], v[28:31]
  s_waitcnt lgkmcnt(0)
  v_exp_f32 v19, v19
  v_mfma_f32_16x16x32_bf16 v[28:31], a[144:147], v[176:179], v[28:31]
  v_cvt_pk_bf16_f32 v17, v18, v19
  v_add_f32 v230, v230, v240
  v_mfma_f32_16x16x32_bf16 v[32:35], a[128:131], v[128:131], v[192:195]
  v_exp_f32 v24, v24
  v_mfma_f32_16x16x32_bf16 v[32:35], a[132:135], v[132:135], v[32:35]
  ds_read_b128 a[144:147], v212 offset:45056
  v_add_f32 v231, v231, v241
  v_mfma_f32_16x16x32_bf16 v[32:35], a[136:139], v[136:139], v[32:35]
  v_exp_f32 v25, v25
  v_mfma_f32_16x16x32_bf16 v[32:35], a[140:143], v[140:143], v[32:35]
  ds_read_b128 a[148:151], v213 offset:45056
  v_cvt_pk_bf16_f32 v24, v24, v25
  v_mfma_f32_16x16x32_bf16 v[40:43], a[140:143], v[156:159], v[196:199]
  v_exp_f32 v26, v26
  v_mfma_f32_16x16x32_bf16 v[40:43], a[136:139], v[152:155], v[40:43]
  ds_read_b128 a[152:155], v214 offset:45056
  v_add_f32 v228, v228, v208
  v_mfma_f32_16x16x32_bf16 v[40:43], a[132:135], v[148:151], v[40:43]
  v_exp_f32 v27, v27
  v_mfma_f32_16x16x32_bf16 v[40:43], a[128:131], v[144:147], v[40:43]
  ds_read_b128 a[156:159], v215 offset:45056
  v_cvt_pk_bf16_f32 v25, v26, v27
  v_mfma_f32_16x16x32_bf16 v[48:51], a[128:131], v[160:163], v[200:203]
  v_exp_f32 v4, v4
  v_mfma_f32_16x16x32_bf16 v[48:51], a[132:135], v[164:167], v[48:51]
  buffer_load_dwordx4 v242, s[24:27], s9 offen offset:1024 sc1 lds
  v_mfma_f32_16x16x32_bf16 v[48:51], a[136:139], v[168:171], v[48:51]
  v_exp_f32 v5, v5
  v_mfma_f32_16x16x32_bf16 v[48:51], a[140:143], v[172:175], v[48:51]
  v_cvt_pk_bf16_f32 v2, v4, v5
  v_add_f32 v229, v229, v209
  v_mfma_f32_16x16x32_bf16 v[56:59], a[140:143], v[188:191], v[204:207]
  v_exp_f32 v6, v6
  v_mfma_f32_16x16x32_bf16 v[56:59], a[136:139], v[184:187], v[56:59]
  buffer_load_dwordx4 v242, s[24:27], s9 offen offset:2048 sc1 lds
  v_mfma_f32_16x16x32_bf16 v[56:59], a[132:135], v[180:183], v[56:59]
  s_waitcnt lgkmcnt(0)
  v_exp_f32 v7, v7
  v_mfma_f32_16x16x32_bf16 v[56:59], a[128:131], v[176:179], v[56:59]
  v_cvt_pk_bf16_f32 v3, v6, v7
  v_add_f32 v230, v230, v210
  v_mfma_f32_16x16x32_bf16 v[36:39], a[144:147], v[128:131], v[192:195]
  v_exp_f32 v12, v12
  v_mfma_f32_16x16x32_bf16 v[36:39], a[148:151], v[132:135], v[36:39]
  ds_read_b64_tr_b16 a[160:161], v216 offset:16384
  v_add_f32 v231, v231, v211
  v_mfma_f32_16x16x32_bf16 v[36:39], a[152:155], v[136:139], v[36:39]
  v_exp_f32 v13, v13
  v_mfma_f32_16x16x32_bf16 v[36:39], a[156:159], v[140:143], v[36:39]
  ds_read_b64_tr_b16 a[162:163], v216 offset:20480
  v_cvt_pk_bf16_f32 v10, v12, v13
  v_mfma_f32_16x16x32_bf16 v[44:47], a[156:159], v[156:159], v[196:199]
  v_exp_f32 v14, v14
  v_mfma_f32_16x16x32_bf16 v[44:47], a[152:155], v[152:155], v[44:47]
  ds_read_b64_tr_b16 a[164:165], v216 offset:24576
  buffer_load_dwordx4 v242, s[24:27], s9 offen offset:3072 sc1 lds
  v_mfma_f32_16x16x32_bf16 v[44:47], a[148:151], v[148:151], v[44:47]
  v_exp_f32 v15, v15
  v_mfma_f32_16x16x32_bf16 v[44:47], a[144:147], v[144:147], v[44:47]
  ds_read_b64_tr_b16 a[166:167], v216 offset:28672
  v_cvt_pk_bf16_f32 v11, v14, v15
  v_mfma_f32_16x16x32_bf16 v[52:55], a[144:147], v[160:163], v[200:203]
  v_exp_f32 v20, v20
  v_mfma_f32_16x16x32_bf16 v[52:55], a[148:151], v[164:167], v[52:55]
  ds_read_b64_tr_b16 a[168:169], v217 offset:16384
  buffer_store_dwordx4 v[228:231], v225, s[24:27], s35 offen sc1
  v_mfma_f32_16x16x32_bf16 v[52:55], a[152:155], v[168:171], v[52:55]
  v_exp_f32 v21, v21
  v_mfma_f32_16x16x32_bf16 v[52:55], a[156:159], v[172:175], v[52:55]
  ds_read_b64_tr_b16 a[170:171], v217 offset:20480
  v_cvt_pk_bf16_f32 v18, v20, v21
  v_mfma_f32_16x16x32_bf16 v[60:63], a[156:159], v[188:191], v[204:207]
  v_exp_f32 v22, v22
  v_mfma_f32_16x16x32_bf16 v[60:63], a[152:155], v[184:187], v[60:63]
  ds_read_b64_tr_b16 a[172:173], v217 offset:24576
  buffer_load_dwordx4 a[212:215], v242, s[24:27], s4 offen offset:0 sc1
  v_mfma_f32_16x16x32_bf16 v[60:63], a[148:151], v[180:183], v[60:63]
  v_exp_f32 v23, v23
  v_mfma_f32_16x16x32_bf16 v[60:63], a[144:147], v[176:179], v[60:63]
  ds_read_b64_tr_b16 a[174:175], v217 offset:28672
  v_cvt_pk_bf16_f32 v19, v22, v23
  v_mfma_f32_16x16x32_bf16 a[192:195], a[208:211], v[64:67], a[192:195]
  v_exp_f32 v28, v28
  v_mfma_f32_16x16x32_bf16 a[192:195], a[208:211], v[96:99], a[192:195]
  ds_read_b64_tr_b16 a[176:177], v218 offset:16384
  buffer_load_dwordx4 a[216:219], v242, s[24:27], s4 offen offset:1024 sc1
  v_mfma_f32_16x16x32_bf16 a[196:199], a[208:211], v[72:75], a[196:199]
  v_exp_f32 v29, v29
  v_mfma_f32_16x16x32_bf16 a[196:199], a[208:211], v[104:107], a[196:199]
  ds_read_b64_tr_b16 a[178:179], v218 offset:20480
  v_cvt_pk_bf16_f32 v26, v28, v29
  v_mfma_f32_16x16x32_bf16 a[200:203], a[208:211], v[80:83], a[200:203]
  v_exp_f32 v30, v30
  v_mfma_f32_16x16x32_bf16 a[200:203], a[208:211], v[112:115], a[200:203]
  ds_read_b64_tr_b16 a[180:181], v218 offset:24576
  v_mfma_f32_16x16x32_bf16 a[204:207], a[208:211], v[88:91], a[204:207]
  s_waitcnt lgkmcnt(7)
  v_exp_f32 v31, v31
  v_mfma_f32_16x16x32_bf16 a[204:207], a[208:211], v[120:123], a[204:207]
  ds_read_b64_tr_b16 a[182:183], v218 offset:28672
  v_cvt_pk_bf16_f32 v27, v30, v31
  v_mfma_f32_16x16x32_bf16 a[0:3], a[160:163], v[64:67], a[0:3]
  v_exp_f32 v32, v32
  v_mfma_f32_16x16x32_bf16 a[0:3], a[164:167], v[96:99], a[0:3]
  ds_read_b64_tr_b16 a[184:185], v219 offset:16384
  buffer_load_dwordx4 a[220:223], v242, s[24:27], s4 offen offset:2048 sc1
  v_mfma_f32_16x16x32_bf16 a[4:7], a[164:167], v[104:107], a[4:7]
  v_exp_f32 v33, v33
  v_mfma_f32_16x16x32_bf16 a[4:7], a[160:163], v[72:75], a[4:7]
  ds_read_b64_tr_b16 a[186:187], v219 offset:20480
  v_cvt_pk_bf16_f32 v32, v32, v33
  v_mfma_f32_16x16x32_bf16 a[8:11], a[160:163], v[80:83], a[8:11]
  v_exp_f32 v34, v34
  v_mfma_f32_16x16x32_bf16 a[8:11], a[164:167], v[112:115], a[8:11]
  ds_read_b64_tr_b16 a[188:189], v219 offset:24576
  v_mfma_f32_16x16x32_bf16 a[12:15], a[164:167], v[120:123], a[12:15]
  s_waitcnt lgkmcnt(7)
  v_exp_f32 v35, v35
  v_mfma_f32_16x16x32_bf16 a[12:15], a[160:163], v[88:91], a[12:15]
  ds_read_b64_tr_b16 a[190:191], v219 offset:28672
  v_cvt_pk_bf16_f32 v33, v34, v35
  v_mfma_f32_16x16x32_bf16 a[16:19], a[168:171], v[64:67], a[16:19]
  v_exp_f32 v40, v40
  v_mfma_f32_16x16x32_bf16 a[16:19], a[172:175], v[96:99], a[16:19]
  ds_read_b64_tr_b16 a[160:161], v220 offset:16384
  buffer_load_dwordx4 a[224:227], v242, s[24:27], s4 offen offset:3072 sc1
  v_mfma_f32_16x16x32_bf16 a[20:23], a[172:175], v[104:107], a[20:23]
  v_exp_f32 v41, v41
  v_mfma_f32_16x16x32_bf16 a[20:23], a[168:171], v[72:75], a[20:23]
  ds_read_b64_tr_b16 a[162:163], v220 offset:20480
  v_cvt_pk_bf16_f32 v40, v40, v41
  v_mfma_f32_16x16x32_bf16 a[24:27], a[168:171], v[80:83], a[24:27]
  v_exp_f32 v42, v42
  v_mfma_f32_16x16x32_bf16 a[24:27], a[172:175], v[112:115], a[24:27]
  ds_read_b64_tr_b16 a[164:165], v220 offset:24576
  v_mfma_f32_16x16x32_bf16 a[28:31], a[172:175], v[120:123], a[28:31]
  s_waitcnt lgkmcnt(7)
  v_exp_f32 v43, v43
  v_mfma_f32_16x16x32_bf16 a[28:31], a[168:171], v[88:91], a[28:31]
  ds_read_b64_tr_b16 a[166:167], v220 offset:28672
  v_cvt_pk_bf16_f32 v41, v42, v43
  v_mfma_f32_16x16x32_bf16 a[32:35], a[176:179], v[64:67], a[32:35]
  v_exp_f32 v48, v48
  v_mfma_f32_16x16x32_bf16 a[32:35], a[180:183], v[96:99], a[32:35]
  ds_read_b64_tr_b16 a[168:169], v221 offset:16384
  buffer_load_dwordx4 a[228:231], v252, s[24:27], s4 offen offset:0 sc1
  v_mfma_f32_16x16x32_bf16 a[36:39], a[180:183], v[104:107], a[36:39]
  v_exp_f32 v49, v49
  v_mfma_f32_16x16x32_bf16 a[36:39], a[176:179], v[72:75], a[36:39]
  ds_read_b64_tr_b16 a[170:171], v221 offset:20480
  v_cvt_pk_bf16_f32 v48, v48, v49
  v_mfma_f32_16x16x32_bf16 a[40:43], a[176:179], v[80:83], a[40:43]
  v_exp_f32 v50, v50
  v_mfma_f32_16x16x32_bf16 a[40:43], a[180:183], v[112:115], a[40:43]
  ds_read_b64_tr_b16 a[172:173], v221 offset:24576
  v_mfma_f32_16x16x32_bf16 a[44:47], a[180:183], v[120:123], a[44:47]
  s_waitcnt lgkmcnt(7)
  v_exp_f32 v51, v51
  v_mfma_f32_16x16x32_bf16 a[44:47], a[176:179], v[88:91], a[44:47]
  ds_read_b64_tr_b16 a[174:175], v221 offset:28672
  v_cvt_pk_bf16_f32 v49, v50, v51
  v_mfma_f32_16x16x32_bf16 a[48:51], a[184:187], v[64:67], a[48:51]
  v_exp_f32 v56, v56
  v_mfma_f32_16x16x32_bf16 a[48:51], a[188:191], v[96:99], a[48:51]
  ds_read_b64_tr_b16 a[176:177], v222 offset:16384
  buffer_load_dwordx4 a[232:235], v252, s[24:27], s4 offen offset:1024 sc1
  v_mfma_f32_16x16x32_bf16 a[52:55], a[188:191], v[104:107], a[52:55]
  v_exp_f32 v57, v57
  v_mfma_f32_16x16x32_bf16 a[52:55], a[184:187], v[72:75], a[52:55]
  ds_read_b64_tr_b16 a[178:179], v222 offset:20480
  v_cvt_pk_bf16_f32 v56, v56, v57
  v_mfma_f32_16x16x32_bf16 a[56:59], a[184:187], v[80:83], a[56:59]
  v_exp_f32 v58, v58
  v_mfma_f32_16x16x32_bf16 a[56:59], a[188:191], v[112:115], a[56:59]
  ds_read_b64_tr_b16 a[180:181], v222 offset:24576
  v_mfma_f32_16x16x32_bf16 a[60:63], a[188:191], v[120:123], a[60:63]
  s_waitcnt lgkmcnt(7)
  v_exp_f32 v59, v59
  v_mfma_f32_16x16x32_bf16 a[60:63], a[184:187], v[88:91], a[60:63]
  ds_read_b64_tr_b16 a[182:183], v222 offset:28672
  v_cvt_pk_bf16_f32 v57, v58, v59
  v_mfma_f32_16x16x32_bf16 a[64:67], a[160:163], v[64:67], a[64:67]
  v_exp_f32 v36, v36
  v_mfma_f32_16x16x32_bf16 a[64:67], a[164:167], v[96:99], a[64:67]
  ds_read_b64_tr_b16 a[184:185], v223 offset:16384
  v_mfma_f32_16x16x32_bf16 a[68:71], a[164:167], v[104:107], a[68:71]
  v_exp_f32 v37, v37
  v_mfma_f32_16x16x32_bf16 a[68:71], a[160:163], v[72:75], a[68:71]
  ds_read_b64_tr_b16 a[186:187], v223 offset:20480
  v_cvt_pk_bf16_f32 v34, v36, v37
  v_mfma_f32_16x16x32_bf16 a[72:75], a[160:163], v[80:83], a[72:75]
  v_exp_f32 v38, v38
  v_mfma_f32_16x16x32_bf16 a[72:75], a[164:167], v[112:115], a[72:75]
  ds_read_b64_tr_b16 a[188:189], v223 offset:24576
  v_mfma_f32_16x16x32_bf16 a[76:79], a[164:167], v[120:123], a[76:79]
  s_waitcnt lgkmcnt(7)
  v_exp_f32 v39, v39
  v_mfma_f32_16x16x32_bf16 a[76:79], a[160:163], v[88:91], a[76:79]
  ds_read_b64_tr_b16 a[190:191], v223 offset:28672
  v_cvt_pk_bf16_f32 v35, v38, v39
  v_mfma_f32_16x16x32_bf16 a[80:83], a[168:171], v[64:67], a[80:83]
  s_waitcnt vmcnt(19)
  v_exp_f32 v44, v44
  v_mfma_f32_16x16x32_bf16 a[80:83], a[172:175], v[96:99], a[80:83]
  v_mfma_f32_16x16x32_bf16 a[84:87], a[172:175], v[104:107], a[84:87]
  s_barrier
  v_exp_f32 v45, v45
  v_mfma_f32_16x16x32_bf16 a[84:87], a[168:171], v[72:75], a[84:87]
  ds_read_b128 a[128:131], v212 offset:49152
  v_cvt_pk_bf16_f32 v42, v44, v45
  v_mfma_f32_16x16x32_bf16 a[88:91], a[168:171], v[80:83], a[88:91]
  v_exp_f32 v46, v46
  v_mfma_f32_16x16x32_bf16 a[88:91], a[172:175], v[112:115], a[88:91]
  ds_read_b128 a[132:135], v213 offset:49152
  v_mfma_f32_16x16x32_bf16 a[92:95], a[172:175], v[120:123], a[92:95]
  s_waitcnt lgkmcnt(6)
  v_exp_f32 v47, v47
  v_mfma_f32_16x16x32_bf16 a[92:95], a[168:171], v[88:91], a[92:95]
  ds_read_b128 a[136:139], v214 offset:49152
  v_cvt_pk_bf16_f32 v43, v46, v47
  v_mfma_f32_16x16x32_bf16 a[96:99], a[176:179], v[64:67], a[96:99]
  v_exp_f32 v52, v52
  v_mfma_f32_16x16x32_bf16 a[96:99], a[180:183], v[96:99], a[96:99]
  ds_read_b128 a[140:143], v215 offset:49152
  v_mfma_f32_16x16x32_bf16 a[100:103], a[180:183], v[104:107], a[100:103]
  v_exp_f32 v53, v53
  v_mfma_f32_16x16x32_bf16 a[100:103], a[176:179], v[72:75], a[100:103]
  v_cvt_pk_bf16_f32 v50, v52, v53
  v_mfma_f32_16x16x32_bf16 a[104:107], a[176:179], v[80:83], a[104:107]
  v_exp_f32 v54, v54
  v_mfma_f32_16x16x32_bf16 a[104:107], a[180:183], v[112:115], a[104:107]
  v_mfma_f32_16x16x32_bf16 a[108:111], a[180:183], v[120:123], a[108:111]
  s_waitcnt lgkmcnt(4)
  v_exp_f32 v55, v55
  v_mfma_f32_16x16x32_bf16 a[108:111], a[176:179], v[88:91], a[108:111]
  v_cvt_pk_bf16_f32 v51, v54, v55
  v_mfma_f32_16x16x32_bf16 a[112:115], a[184:187], v[64:67], a[112:115]
  v_exp_f32 v60, v60
  v_mfma_f32_16x16x32_bf16 a[112:115], a[188:191], v[96:99], a[112:115]
  v_mfma_f32_16x16x32_bf16 a[116:119], a[188:191], v[104:107], a[116:119]
  v_exp_f32 v61, v61
  v_mfma_f32_16x16x32_bf16 a[116:119], a[184:187], v[72:75], a[116:119]
  v_cvt_pk_bf16_f32 v58, v60, v61
  v_mfma_f32_16x16x32_bf16 a[120:123], a[184:187], v[80:83], a[120:123]
  v_exp_f32 v62, v62
  v_mfma_f32_16x16x32_bf16 a[120:123], a[188:191], v[112:115], a[120:123]
  v_mfma_f32_16x16x32_bf16 a[124:127], a[188:191], v[120:123], a[124:127]
  s_waitcnt lgkmcnt(0)
  v_exp_f32 v63, v63
  v_mfma_f32_16x16x32_bf16 a[124:127], a[184:187], v[88:91], a[124:127]
  v_cvt_pk_bf16_f32 v59, v62, v63
  v_mfma_f32_16x16x32_bf16 v[64:67], a[128:131], v[128:131], v[192:195]
  s_add_u32 m0, s28, 65536
  v_mfma_f32_16x16x32_bf16 v[64:67], a[132:135], v[132:135], v[64:67]
  ds_read_b128 a[144:147], v212 offset:53248
  v_mfma_f32_16x16x32_bf16 v[64:67], a[136:139], v[136:139], v[64:67]
  buffer_load_dwordx4 v253, s[24:27], s9 offen offset:0 sc1 lds
  v_mfma_f32_16x16x32_bf16 v[64:67], a[140:143], v[140:143], v[64:67]
  ds_read_b128 a[148:151], v213 offset:53248
  v_mfma_f32_16x16x32_bf16 v[72:75], a[140:143], v[156:159], v[196:199]
  v_mfma_f32_16x16x32_bf16 v[72:75], a[136:139], v[152:155], v[72:75]
  ds_read_b128 a[152:155], v214 offset:53248
  v_mfma_f32_16x16x32_bf16 v[72:75], a[132:135], v[148:151], v[72:75]
  buffer_load_dwordx4 v253, s[24:27], s9 offen offset:1024 sc1 lds
  v_mfma_f32_16x16x32_bf16 v[72:75], a[128:131], v[144:147], v[72:75]
  ds_read_b128 a[156:159], v215 offset:53248
  v_mfma_f32_16x16x32_bf16 v[80:83], a[128:131], v[160:163], v[200:203]
  v_exp_f32 v64, v64
  v_mfma_f32_16x16x32_bf16 v[80:83], a[132:135], v[164:167], v[80:83]
  v_mfma_f32_16x16x32_bf16 v[80:83], a[136:139], v[168:171], v[80:83]
  v_exp_f32 v65, v65
  v_mfma_f32_16x16x32_bf16 v[80:83], a[140:143], v[172:175], v[80:83]
  v_cvt_pk_bf16_f32 v64, v64, v65
  v_mfma_f32_16x16x32_bf16 v[88:91], a[140:143], v[188:191], v[204:207]
  v_exp_f32 v66, v66
  v_mfma_f32_16x16x32_bf16 v[88:91], a[136:139], v[184:187], v[88:91]
  buffer_load_dwordx4 v253, s[24:27], s9 offen offset:2048 sc1 lds
  v_mfma_f32_16x16x32_bf16 v[88:91], a[132:135], v[180:183], v[88:91]
  s_waitcnt lgkmcnt(0)
  v_exp_f32 v67, v67
  v_mfma_f32_16x16x32_bf16 v[88:91], a[128:131], v[176:179], v[88:91]
  v_cvt_pk_bf16_f32 v65, v66, v67
  v_mfma_f32_16x16x32_bf16 v[68:71], a[144:147], v[128:131], v[192:195]
  v_exp_f32 v72, v72
  v_mfma_f32_16x16x32_bf16 v[68:71], a[148:151], v[132:135], v[68:71]
  ds_read_b128 a[128:131], v212 offset:57344
  v_mfma_f32_16x16x32_bf16 v[68:71], a[152:155], v[136:139], v[68:71]
  v_exp_f32 v73, v73
  v_mfma_f32_16x16x32_bf16 v[68:71], a[156:159], v[140:143], v[68:71]
  ds_read_b128 a[132:135], v213 offset:57344
  v_cvt_pk_bf16_f32 v72, v72, v73
  v_mfma_f32_16x16x32_bf16 v[76:79], a[156:159], v[156:159], v[196:199]
  v_exp_f32 v74, v74
  v_mfma_f32_16x16x32_bf16 v[76:79], a[152:155], v[152:155], v[76:79]
  ds_read_b128 a[136:139], v214 offset:57344
  v_mfma_f32_16x16x32_bf16 v[76:79], a[148:151], v[148:151], v[76:79]
  v_exp_f32 v75, v75
  v_mfma_f32_16x16x32_bf16 v[76:79], a[144:147], v[144:147], v[76:79]
  ds_read_b128 a[140:143], v215 offset:57344
  v_cvt_pk_bf16_f32 v73, v74, v75
  v_mfma_f32_16x16x32_bf16 v[84:87], a[144:147], v[160:163], v[200:203]
  v_exp_f32 v80, v80
  v_mfma_f32_16x16x32_bf16 v[84:87], a[148:151], v[164:167], v[84:87]
  buffer_load_dwordx4 v253, s[24:27], s9 offen offset:3072 sc1 lds
  v_mfma_f32_16x16x32_bf16 v[84:87], a[152:155], v[168:171], v[84:87]
  s_add_u32 s29, s29, 16384
  v_exp_f32 v81, v81
  v_mfma_f32_16x16x32_bf16 v[84:87], a[156:159], v[172:175], v[84:87]
  v_cvt_pk_bf16_f32 v80, v80, v81
  v_mfma_f32_16x16x32_bf16 v[92:95], a[156:159], v[188:191], v[204:207]
  s_add_u32 m0, s28, 32768
  v_exp_f32 v82, v82
  v_mfma_f32_16x16x32_bf16 v[92:95], a[152:155], v[184:187], v[92:95]
  buffer_load_dwordx4 v252, s[24:27], s9 offen offset:0 sc1 lds
  v_mfma_f32_16x16x32_bf16 v[92:95], a[148:151], v[180:183], v[92:95]
  s_waitcnt lgkmcnt(0)
  v_exp_f32 v83, v83
  v_mfma_f32_16x16x32_bf16 v[92:95], a[144:147], v[176:179], v[92:95]
  v_cvt_pk_bf16_f32 v81, v82, v83
  v_mfma_f32_16x16x32_bf16 v[96:99], a[128:131], v[128:131], v[192:195]
  v_exp_f32 v88, v88
  v_mfma_f32_16x16x32_bf16 v[96:99], a[132:135], v[132:135], v[96:99]
  ds_read_b128 a[144:147], v212 offset:61440
  v_mfma_f32_16x16x32_bf16 v[96:99], a[136:139], v[136:139], v[96:99]
  v_exp_f32 v89, v89
  v_mfma_f32_16x16x32_bf16 v[96:99], a[140:143], v[140:143], v[96:99]
  ds_read_b128 a[148:151], v213 offset:61440
  v_cvt_pk_bf16_f32 v88, v88, v89
  v_mfma_f32_16x16x32_bf16 v[104:107], a[140:143], v[156:159], v[196:199]
  v_exp_f32 v90, v90
  v_mfma_f32_16x16x32_bf16 v[104:107], a[136:139], v[152:155], v[104:107]
  ds_read_b128 a[152:155], v214 offset:61440
  v_mfma_f32_16x16x32_bf16 v[104:107], a[132:135], v[148:151], v[104:107]
  v_exp_f32 v91, v91
  v_mfma_f32_16x16x32_bf16 v[104:107], a[128:131], v[144:147], v[104:107]
  ds_read_b128 a[156:159], v215 offset:61440
  v_cvt_pk_bf16_f32 v89, v90, v91
  v_mfma_f32_16x16x32_bf16 v[112:115], a[128:131], v[160:163], v[200:203]
  v_exp_f32 v68, v68
  v_mfma_f32_16x16x32_bf16 v[112:115], a[132:135], v[164:167], v[112:115]
  buffer_load_dwordx4 v252, s[24:27], s9 offen offset:1024 sc1 lds
  v_mfma_f32_16x16x32_bf16 v[112:115], a[136:139], v[168:171], v[112:115]
  v_exp_f32 v69, v69
  v_mfma_f32_16x16x32_bf16 v[112:115], a[140:143], v[172:175], v[112:115]
  v_cvt_pk_bf16_f32 v66, v68, v69
  v_mfma_f32_16x16x32_bf16 v[120:123], a[140:143], v[188:191], v[204:207]
  v_exp_f32 v70, v70
  v_mfma_f32_16x16x32_bf16 v[120:123], a[136:139], v[184:187], v[120:123]
  buffer_load_dwordx4 v252, s[24:27], s9 offen offset:2048 sc1 lds
  v_mfma_f32_16x16x32_bf16 v[120:123], a[132:135], v[180:183], v[120:123]
  s_waitcnt lgkmcnt(0)
  v_exp_f32 v71, v71
  v_mfma_f32_16x16x32_bf16 v[120:123], a[128:131], v[176:179], v[120:123]
  v_cvt_pk_bf16_f32 v67, v70, v71
  v_mfma_f32_16x16x32_bf16 v[100:103], a[144:147], v[128:131], v[192:195]
  v_exp_f32 v76, v76
  v_mfma_f32_16x16x32_bf16 v[100:103], a[148:151], v[132:135], v[100:103]
  ds_read_b64_tr_b16 a[160:161], v216 offset:32768
  v_mfma_f32_16x16x32_bf16 v[100:103], a[152:155], v[136:139], v[100:103]
  v_exp_f32 v77, v77
  v_mfma_f32_16x16x32_bf16 v[100:103], a[156:159], v[140:143], v[100:103]
  ds_read_b64_tr_b16 a[162:163], v216 offset:36864
  v_cvt_pk_bf16_f32 v74, v76, v77
  v_mfma_f32_16x16x32_bf16 v[108:111], a[156:159], v[156:159], v[196:199]
  v_exp_f32 v78, v78
  v_mfma_f32_16x16x32_bf16 v[108:111], a[152:155], v[152:155], v[108:111]
  ds_read_b64_tr_b16 a[164:165], v216 offset:40960
  buffer_load_dwordx4 v252, s[24:27], s9 offen offset:3072 sc1 lds
  v_mfma_f32_16x16x32_bf16 v[108:111], a[148:151], v[148:151], v[108:111]
  v_exp_f32 v79, v79
  v_mfma_f32_16x16x32_bf16 v[108:111], a[144:147], v[144:147], v[108:111]
  ds_read_b64_tr_b16 a[166:167], v216 offset:45056
  v_cvt_pk_bf16_f32 v75, v78, v79
  v_mfma_f32_16x16x32_bf16 v[116:119], a[144:147], v[160:163], v[200:203]
  v_exp_f32 v84, v84
  v_mfma_f32_16x16x32_bf16 v[116:119], a[148:151], v[164:167], v[116:119]
  ds_read_b64_tr_b16 a[168:169], v217 offset:32768
  buffer_load_dwordx4 a[236:239], v252, s[24:27], s4 offen offset:2048 sc1
  v_mfma_f32_16x16x32_bf16 v[116:119], a[152:155], v[168:171], v[116:119]
  v_exp_f32 v85, v85
  v_mfma_f32_16x16x32_bf16 v[116:119], a[156:159], v[172:175], v[116:119]
  ds_read_b64_tr_b16 a[170:171], v217 offset:36864
  v_cvt_pk_bf16_f32 v82, v84, v85
  v_mfma_f32_16x16x32_bf16 v[124:127], a[156:159], v[188:191], v[204:207]
  v_exp_f32 v86, v86
  v_mfma_f32_16x16x32_bf16 v[124:127], a[152:155], v[184:187], v[124:127]
  ds_read_b64_tr_b16 a[172:173], v217 offset:40960
  v_mfma_f32_16x16x32_bf16 v[124:127], a[148:151], v[180:183], v[124:127]
  v_exp_f32 v87, v87
  v_mfma_f32_16x16x32_bf16 v[124:127], a[144:147], v[176:179], v[124:127]
  ds_read_b64_tr_b16 a[174:175], v217 offset:45056
  v_cvt_pk_bf16_f32 v83, v86, v87
  v_mfma_f32_16x16x32_bf16 a[192:195], a[208:211], v[0:3], a[192:195]
  v_exp_f32 v92, v92
  v_mfma_f32_16x16x32_bf16 a[192:195], a[208:211], v[32:35], a[192:195]
  ds_read_b64_tr_b16 a[176:177], v218 offset:32768
  buffer_load_dwordx4 a[240:243], v252, s[24:27], s4 offen offset:3072 sc1
  v_mfma_f32_16x16x32_bf16 a[196:199], a[208:211], v[8:11], a[196:199]
  v_exp_f32 v93, v93
  v_mfma_f32_16x16x32_bf16 a[196:199], a[208:211], v[40:43], a[196:199]
  ds_read_b64_tr_b16 a[178:179], v218 offset:36864
  v_cvt_pk_bf16_f32 v90, v92, v93
  v_mfma_f32_16x16x32_bf16 a[200:203], a[208:211], v[16:19], a[200:203]
  v_exp_f32 v94, v94
  v_mfma_f32_16x16x32_bf16 a[200:203], a[208:211], v[48:51], a[200:203]
  ds_read_b64_tr_b16 a[180:181], v218 offset:40960
  v_mfma_f32_16x16x32_bf16 a[204:207], a[208:211], v[24:27], a[204:207]
  s_waitcnt lgkmcnt(7)
  v_exp_f32 v95, v95
  v_mfma_f32_16x16x32_bf16 a[204:207], a[208:211], v[56:59], a[204:207]
  ds_read_b64_tr_b16 a[182:183], v218 offset:45056
  v_cvt_pk_bf16_f32 v91, v94, v95
  v_mfma_f32_16x16x32_bf16 a[0:3], a[160:163], v[0:3], a[0:3]
  v_exp_f32 v96, v96
  v_mfma_f32_16x16x32_bf16 a[0:3], a[164:167], v[32:35], a[0:3]
  ds_read_b64_tr_b16 a[184:185], v219 offset:32768
  buffer_load_dwordx4 a[244:247], v253, s[24:27], s4 offen offset:0 sc1
  v_mfma_f32_16x16x32_bf16 a[4:7], a[164:167], v[40:43], a[4:7]
  v_exp_f32 v97, v97
  v_mfma_f32_16x16x32_bf16 a[4:7], a[160:163], v[8:11], a[4:7]
  ds_read_b64_tr_b16 a[186:187], v219 offset:36864
  v_cvt_pk_bf16_f32 v96, v96, v97
  v_mfma_f32_16x16x32_bf16 a[8:11], a[160:163], v[16:19], a[8:11]
  v_exp_f32 v98, v98
  v_mfma_f32_16x16x32_bf16 a[8:11], a[164:167], v[48:51], a[8:11]
  ds_read_b64_tr_b16 a[188:189], v219 offset:40960
  v_mfma_f32_16x16x32_bf16 a[12:15], a[164:167], v[56:59], a[12:15]
  s_waitcnt lgkmcnt(7)
  v_exp_f32 v99, v99
  v_mfma_f32_16x16x32_bf16 a[12:15], a[160:163], v[24:27], a[12:15]
  ds_read_b64_tr_b16 a[190:191], v219 offset:45056
  v_cvt_pk_bf16_f32 v97, v98, v99
  v_mfma_f32_16x16x32_bf16 a[16:19], a[168:171], v[0:3], a[16:19]
  v_exp_f32 v104, v104
  v_mfma_f32_16x16x32_bf16 a[16:19], a[172:175], v[32:35], a[16:19]
  ds_read_b64_tr_b16 a[160:161], v220 offset:32768
  buffer_load_dwordx4 a[248:251], v253, s[24:27], s4 offen offset:1024 sc1
  v_mfma_f32_16x16x32_bf16 a[20:23], a[172:175], v[40:43], a[20:23]
  v_exp_f32 v105, v105
  v_mfma_f32_16x16x32_bf16 a[20:23], a[168:171], v[8:11], a[20:23]
  ds_read_b64_tr_b16 a[162:163], v220 offset:36864
  v_cvt_pk_bf16_f32 v104, v104, v105
  v_mfma_f32_16x16x32_bf16 a[24:27], a[168:171], v[16:19], a[24:27]
  v_exp_f32 v106, v106
  v_mfma_f32_16x16x32_bf16 a[24:27], a[172:175], v[48:51], a[24:27]
  ds_read_b64_tr_b16 a[164:165], v220 offset:40960
  v_mfma_f32_16x16x32_bf16 a[28:31], a[172:175], v[56:59], a[28:31]
  s_waitcnt lgkmcnt(7)
  v_exp_f32 v107, v107
  v_mfma_f32_16x16x32_bf16 a[28:31], a[168:171], v[24:27], a[28:31]
  ds_read_b64_tr_b16 a[166:167], v220 offset:45056
  v_cvt_pk_bf16_f32 v105, v106, v107
  v_mfma_f32_16x16x32_bf16 a[32:35], a[176:179], v[0:3], a[32:35]
  v_exp_f32 v112, v112
  v_mfma_f32_16x16x32_bf16 a[32:35], a[180:183], v[32:35], a[32:35]
  ds_read_b64_tr_b16 a[168:169], v221 offset:32768
  buffer_load_dwordx4 a[252:255], v253, s[24:27], s4 offen offset:2048 sc1
  v_mfma_f32_16x16x32_bf16 a[36:39], a[180:183], v[40:43], a[36:39]
  v_exp_f32 v113, v113
  v_mfma_f32_16x16x32_bf16 a[36:39], a[176:179], v[8:11], a[36:39]
  ds_read_b64_tr_b16 a[170:171], v221 offset:36864
  v_cvt_pk_bf16_f32 v112, v112, v113
  v_mfma_f32_16x16x32_bf16 a[40:43], a[176:179], v[16:19], a[40:43]
  v_exp_f32 v114, v114
  v_mfma_f32_16x16x32_bf16 a[40:43], a[180:183], v[48:51], a[40:43]
  ds_read_b64_tr_b16 a[172:173], v221 offset:40960
  v_mfma_f32_16x16x32_bf16 a[44:47], a[180:183], v[56:59], a[44:47]
  s_waitcnt lgkmcnt(7)
  v_exp_f32 v115, v115
  v_mfma_f32_16x16x32_bf16 a[44:47], a[176:179], v[24:27], a[44:47]
  ds_read_b64_tr_b16 a[174:175], v221 offset:45056
  v_cvt_pk_bf16_f32 v113, v114, v115
  v_mfma_f32_16x16x32_bf16 a[48:51], a[184:187], v[0:3], a[48:51]
  v_exp_f32 v120, v120
  v_mfma_f32_16x16x32_bf16 a[48:51], a[188:191], v[32:35], a[48:51]
  ds_read_b64_tr_b16 a[176:177], v222 offset:32768
  v_mfma_f32_16x16x32_bf16 a[52:55], a[188:191], v[40:43], a[52:55]
  v_exp_f32 v121, v121
  v_mfma_f32_16x16x32_bf16 a[52:55], a[184:187], v[8:11], a[52:55]
  ds_read_b64_tr_b16 a[178:179], v222 offset:36864
  v_cvt_pk_bf16_f32 v120, v120, v121
  v_mfma_f32_16x16x32_bf16 a[56:59], a[184:187], v[16:19], a[56:59]
  v_exp_f32 v122, v122
  v_mfma_f32_16x16x32_bf16 a[56:59], a[188:191], v[48:51], a[56:59]
  ds_read_b64_tr_b16 a[180:181], v222 offset:40960
  v_mfma_f32_16x16x32_bf16 a[60:63], a[188:191], v[56:59], a[60:63]
  s_waitcnt lgkmcnt(7)
  v_exp_f32 v123, v123
  v_mfma_f32_16x16x32_bf16 a[60:63], a[184:187], v[24:27], a[60:63]
  ds_read_b64_tr_b16 a[182:183], v222 offset:45056
  v_cvt_pk_bf16_f32 v121, v122, v123
  v_mfma_f32_16x16x32_bf16 a[64:67], a[160:163], v[0:3], a[64:67]
  v_exp_f32 v100, v100
  v_mfma_f32_16x16x32_bf16 a[64:67], a[164:167], v[32:35], a[64:67]
  ds_read_b64_tr_b16 a[184:185], v223 offset:32768
  v_mfma_f32_16x16x32_bf16 a[68:71], a[164:167], v[40:43], a[68:71]
  v_exp_f32 v101, v101
  v_mfma_f32_16x16x32_bf16 a[68:71], a[160:163], v[8:11], a[68:71]
  ds_read_b64_tr_b16 a[186:187], v223 offset:36864
  v_cvt_pk_bf16_f32 v98, v100, v101
  v_mfma_f32_16x16x32_bf16 a[72:75], a[160:163], v[16:19], a[72:75]
  v_exp_f32 v102, v102
  v_mfma_f32_16x16x32_bf16 a[72:75], a[164:167], v[48:51], a[72:75]
  ds_read_b64_tr_b16 a[188:189], v223 offset:40960
  v_mfma_f32_16x16x32_bf16 a[76:79], a[164:167], v[56:59], a[76:79]
  s_waitcnt lgkmcnt(7)
  v_exp_f32 v103, v103
  v_mfma_f32_16x16x32_bf16 a[76:79], a[160:163], v[24:27], a[76:79]
  ds_read_b64_tr_b16 a[190:191], v223 offset:45056
  v_cvt_pk_bf16_f32 v99, v102, v103
  v_mfma_f32_16x16x32_bf16 a[80:83], a[168:171], v[0:3], a[80:83]
  s_waitcnt vmcnt(19)
  v_exp_f32 v108, v108
  v_mfma_f32_16x16x32_bf16 a[80:83], a[172:175], v[32:35], a[80:83]
  v_mfma_f32_16x16x32_bf16 a[84:87], a[172:175], v[40:43], a[84:87]
  s_barrier
  v_exp_f32 v109, v109
  v_mfma_f32_16x16x32_bf16 a[84:87], a[168:171], v[8:11], a[84:87]
  s_mul_i32 s39, s99, 13108
  s_lshr_b32 s39, s39, 16
  s_lshl_b32 s39, s39, 8
  v_cvt_pk_bf16_f32 v106, v108, v109
  v_mfma_f32_16x16x32_bf16 a[88:91], a[168:171], v[16:19], a[88:91]
  s_add_u32 s39, s39, 2822400
  s_cmp_lt_u32 s2, 240
  s_cselect_b32 s48, 0, 1073741824
  v_exp_f32 v110, v110
  v_mfma_f32_16x16x32_bf16 a[88:91], a[172:175], v[48:51], a[88:91]
  v_or_b32 v249, s48, v251
  v_mfma_f32_16x16x32_bf16 a[92:95], a[172:175], v[56:59], a[92:95]
  s_waitcnt lgkmcnt(4)
  v_exp_f32 v111, v111
  v_mfma_f32_16x16x32_bf16 a[92:95], a[168:171], v[24:27], a[92:95]
  buffer_atomic_add v250, v249, s[24:27], s39 offen
  v_cvt_pk_bf16_f32 v107, v110, v111
  v_mfma_f32_16x16x32_bf16 a[96:99], a[176:179], v[0:3], a[96:99]
  v_exp_f32 v116, v116
  v_mfma_f32_16x16x32_bf16 a[96:99], a[180:183], v[32:35], a[96:99]
  v_mfma_f32_16x16x32_bf16 a[100:103], a[180:183], v[40:43], a[100:103]
  v_exp_f32 v117, v117
  v_mfma_f32_16x16x32_bf16 a[100:103], a[176:179], v[8:11], a[100:103]
  v_cvt_pk_bf16_f32 v114, v116, v117
  v_mfma_f32_16x16x32_bf16 a[104:107], a[176:179], v[16:19], a[104:107]
  v_exp_f32 v118, v118
  v_mfma_f32_16x16x32_bf16 a[104:107], a[180:183], v[48:51], a[104:107]
  v_mfma_f32_16x16x32_bf16 a[108:111], a[180:183], v[56:59], a[108:111]
  s_waitcnt lgkmcnt(0)
  v_exp_f32 v119, v119
  v_mfma_f32_16x16x32_bf16 a[108:111], a[176:179], v[24:27], a[108:111]
  v_cvt_pk_bf16_f32 v115, v118, v119
  v_mfma_f32_16x16x32_bf16 a[112:115], a[184:187], v[0:3], a[112:115]
  v_exp_f32 v124, v124
  v_mfma_f32_16x16x32_bf16 a[112:115], a[188:191], v[32:35], a[112:115]
  v_mfma_f32_16x16x32_bf16 a[116:119], a[188:191], v[40:43], a[116:119]
  v_exp_f32 v125, v125
  v_mfma_f32_16x16x32_bf16 a[116:119], a[184:187], v[8:11], a[116:119]
  v_cvt_pk_bf16_f32 v122, v124, v125
  v_mfma_f32_16x16x32_bf16 a[120:123], a[184:187], v[16:19], a[120:123]
  v_exp_f32 v126, v126
  v_mfma_f32_16x16x32_bf16 a[120:123], a[188:191], v[48:51], a[120:123]
  v_mfma_f32_16x16x32_bf16 a[124:127], a[188:191], v[56:59], a[124:127]
  v_exp_f32 v127, v127
  v_mfma_f32_16x16x32_bf16 a[124:127], a[184:187], v[24:27], a[124:127]
  v_cvt_pk_bf16_f32 v123, v126, v127
  ds_read_b64_tr_b16 a[160:161], v216 offset:49152
  ds_read_b64_tr_b16 a[162:163], v216 offset:53248
  ds_read_b64_tr_b16 a[164:165], v216 offset:57344
  ds_read_b64_tr_b16 a[166:167], v216 offset:61440
  ds_read_b64_tr_b16 a[168:169], v217 offset:49152
  ds_read_b64_tr_b16 a[170:171], v217 offset:53248
  ds_read_b64_tr_b16 a[172:173], v217 offset:57344
  ds_read_b64_tr_b16 a[174:175], v217 offset:61440
  s_mov_b32 s48, 0x5d800000
  s_lshl_b32 s39, s3, 8
  v_mfma_f32_16x16x32_bf16 a[192:195], a[208:211], v[64:67], a[192:195]
  s_add_u32 m0, s28, 81920
  v_mfma_f32_16x16x32_bf16 a[192:195], a[208:211], v[96:99], a[192:195]
  v_mfma_f32_16x16x32_bf16 a[196:199], a[208:211], v[72:75], a[196:199]
  buffer_load_dwordx4 v242, s[24:27], s10 offen offset:0 sc1 lds
  v_mfma_f32_16x16x32_bf16 a[196:199], a[208:211], v[104:107], a[196:199]
  v_mfma_f32_16x16x32_bf16 a[200:203], a[208:211], v[80:83], a[200:203]
  buffer_load_dwordx4 v242, s[24:27], s10 offen offset:1024 sc1 lds
  v_mfma_f32_16x16x32_bf16 a[200:203], a[208:211], v[112:115], a[200:203]
  v_mfma_f32_16x16x32_bf16 a[204:207], a[208:211], v[88:91], a[204:207]
  buffer_load_dwordx4 v242, s[24:27], s10 offen offset:2048 sc1 lds
  v_mfma_f32_16x16x32_bf16 a[204:207], a[208:211], v[120:123], a[204:207]
  s_waitcnt lgkmcnt(4)
  v_mfma_f32_16x16x32_bf16 a[0:3], a[160:163], v[64:67], a[0:3]
  buffer_load_dwordx4 v242, s[24:27], s10 offen offset:3072 sc1 lds
  v_mfma_f32_16x16x32_bf16 a[0:3], a[164:167], v[96:99], a[0:3]
  ds_read_b64_tr_b16 a[176:177], v218 offset:49152
  v_mfma_f32_16x16x32_bf16 a[4:7], a[164:167], v[104:107], a[4:7]
  buffer_load_dwordx4 a[128:131], v253, s[24:27], s4 offen offset:3072 sc1
  v_mfma_f32_16x16x32_bf16 a[4:7], a[160:163], v[72:75], a[4:7]
  ds_read_b64_tr_b16 a[178:179], v218 offset:53248
  v_accvgpr_read_b32 v208, a192
  v_mfma_f32_16x16x32_bf16 a[8:11], a[160:163], v[80:83], a[8:11]
  v_accvgpr_read_b32 v209, a196
  v_accvgpr_read_b32 v210, a200
  v_mfma_f32_16x16x32_bf16 a[8:11], a[164:167], v[112:115], a[8:11]
  ds_read_b64_tr_b16 a[180:181], v218 offset:57344
  v_accvgpr_read_b32 v211, a204
  v_mfma_f32_16x16x32_bf16 a[12:15], a[164:167], v[120:123], a[12:15]
  v_mov_b32 v245, v208
  v_mov_b32 v246, v209
  v_mfma_f32_16x16x32_bf16 a[12:15], a[160:163], v[88:91], a[12:15]
  ds_read_b64_tr_b16 a[182:183], v218 offset:61440
  s_waitcnt lgkmcnt(4)
  v_mov_b32 v247, v210
  v_mfma_f32_16x16x32_bf16 a[16:19], a[168:171], v[64:67], a[16:19]
  v_mov_b32 v248, v211
  v_permlane16_swap_b32 v208, v245
  v_mfma_f32_16x16x32_bf16 a[16:19], a[172:175], v[96:99], a[16:19]
  ds_read_b64_tr_b16 a[184:185], v219 offset:49152
  v_permlane16_swap_b32 v209, v246
  v_mfma_f32_16x16x32_bf16 a[20:23], a[172:175], v[104:107], a[20:23]
  v_permlane16_swap_b32 v210, v247
  v_permlane16_swap_b32 v211, v248
  v_mfma_f32_16x16x32_bf16 a[20:23], a[168:171], v[72:75], a[20:23]
  ds_read_b64_tr_b16 a[186:187], v219 offset:53248
  v_add_f32 v208, v208, v245
  v_mfma_f32_16x16x32_bf16 a[24:27], a[168:171], v[80:83], a[24:27]
  v_add_f32 v209, v209, v246
  v_add_f32 v210, v210, v247
  v_mfma_f32_16x16x32_bf16 a[24:27], a[172:175], v[112:115], a[24:27]
  ds_read_b64_tr_b16 a[188:189], v219 offset:57344
  v_add_f32 v211, v211, v248
  v_mfma_f32_16x16x32_bf16 a[28:31], a[172:175], v[120:123], a[28:31]
  v_mov_b32 v245, v208
  v_mov_b32 v246, v209
  v_mfma_f32_16x16x32_bf16 a[28:31], a[168:171], v[88:91], a[28:31]
  ds_read_b64_tr_b16 a[190:191], v219 offset:61440
  s_waitcnt lgkmcnt(4)
  v_mov_b32 v247, v210
  v_mfma_f32_16x16x32_bf16 a[32:35], a[176:179], v[64:67], a[32:35]
  v_mov_b32 v248, v211
  v_permlane32_swap_b32 v208, v245
  v_mfma_f32_16x16x32_bf16 a[32:35], a[180:183], v[96:99], a[32:35]
  ds_read_b64_tr_b16 a[160:161], v220 offset:49152
  v_permlane32_swap_b32 v209, v246
  v_mfma_f32_16x16x32_bf16 a[36:39], a[180:183], v[104:107], a[36:39]
  v_permlane32_swap_b32 v210, v247
  v_permlane32_swap_b32 v211, v248
  v_mfma_f32_16x16x32_bf16 a[36:39], a[176:179], v[72:75], a[36:39]
  ds_read_b64_tr_b16 a[162:163], v220 offset:53248
  v_add_f32 v208, v208, v245
  v_mfma_f32_16x16x32_bf16 a[40:43], a[176:179], v[80:83], a[40:43]
  v_add_f32 v209, v209, v246
  v_add_f32 v210, v210, v247
  v_mfma_f32_16x16x32_bf16 a[40:43], a[180:183], v[112:115], a[40:43]
  ds_read_b64_tr_b16 a[164:165], v220 offset:57344
  v_add_f32 v211, v211, v248
  buffer_load_dwordx4 a[132:135], v242, s[24:27], s5 offen offset:0 sc1
  buffer_load_dwordx4 a[136:139], v242, s[24:27], s5 offen offset:1024 sc1
  buffer_load_dwordx4 a[140:143], v242, s[24:27], s5 offen offset:2048 sc1
  buffer_load_dwordx4 a[144:147], v242, s[24:27], s5 offen offset:3072 sc1
  buffer_load_dwordx4 a[148:151], v252, s[24:27], s5 offen offset:0 sc1
  buffer_load_dwordx4 a[152:155], v252, s[24:27], s5 offen offset:1024 sc1
  buffer_load_dwordx4 a[156:159], v252, s[24:27], s5 offen offset:2048 sc1
  v_mfma_f32_16x16x32_bf16 a[44:47], a[180:183], v[120:123], a[44:47]
  v_rcp_f32 v192, v208
  v_mfma_f32_16x16x32_bf16 a[44:47], a[176:179], v[88:91], a[44:47]
  ds_read_b64_tr_b16 a[166:167], v220 offset:61440
  s_waitcnt lgkmcnt(4)
  v_mfma_f32_16x16x32_bf16 a[48:51], a[184:187], v[64:67], a[48:51]
  v_rcp_f32 v196, v209
  v_mfma_f32_16x16x32_bf16 a[48:51], a[188:191], v[96:99], a[48:51]
  ds_read_b64_tr_b16 a[168:169], v221 offset:49152
  v_mfma_f32_16x16x32_bf16 a[52:55], a[188:191], v[104:107], a[52:55]
  v_rcp_f32 v200, v210
  v_mfma_f32_16x16x32_bf16 a[52:55], a[184:187], v[72:75], a[52:55]
  ds_read_b64_tr_b16 a[170:171], v221 offset:53248
  v_mfma_f32_16x16x32_bf16 a[56:59], a[184:187], v[80:83], a[56:59]
  v_rcp_f32 v204, v211
  v_mfma_f32_16x16x32_bf16 a[56:59], a[188:191], v[112:115], a[56:59]
  ds_read_b64_tr_b16 a[172:173], v221 offset:57344
  v_add_f32 v246, v208, v209
  v_mfma_f32_16x16x32_bf16 a[60:63], a[188:191], v[120:123], a[60:63]
  v_add_f32 v247, v210, v211
  v_add_f32 v246, v246, v247
  v_mfma_f32_16x16x32_bf16 a[60:63], a[184:187], v[88:91], a[60:63]
  ds_read_b64_tr_b16 a[174:175], v221 offset:61440
  s_waitcnt lgkmcnt(4)
  v_lshrrev_b32 v247, 2, v242
  v_mfma_f32_16x16x32_bf16 a[64:67], a[160:163], v[64:67], a[64:67]
  v_cmp_nlt_f32 vcc, v246, s48
  v_add_u32 v247, s39, v247
  v_mfma_f32_16x16x32_bf16 a[64:67], a[164:167], v[96:99], a[64:67]
  ds_read_b64_tr_b16 a[176:177], v222 offset:49152
  v_add_u32 v247, 157696, v247
  v_mfma_f32_16x16x32_bf16 a[68:71], a[164:167], v[104:107], a[68:71]
  v_cndmask_b32_e64 v245, 0, 1, vcc
  v_accvgpr_read_b32 v0, a0
  v_mfma_f32_16x16x32_bf16 a[68:71], a[160:163], v[72:75], a[68:71]
  ds_read_b64_tr_b16 a[178:179], v222 offset:53248
  v_accvgpr_read_b32 v1, a1
  v_mfma_f32_16x16x32_bf16 a[72:75], a[160:163], v[80:83], a[72:75]
  v_accvgpr_read_b32 v2, a2
  v_accvgpr_read_b32 v3, a3
  v_mfma_f32_16x16x32_bf16 a[72:75], a[164:167], v[112:115], a[72:75]
  ds_read_b64_tr_b16 a[180:181], v222 offset:57344
  v_accvgpr_read_b32 v4, a16
  v_mfma_f32_16x16x32_bf16 a[76:79], a[164:167], v[120:123], a[76:79]
  v_accvgpr_read_b32 v5, a17
  v_accvgpr_read_b32 v6, a18
  v_mfma_f32_16x16x32_bf16 a[76:79], a[160:163], v[88:91], a[76:79]
  ds_read_b64_tr_b16 a[182:183], v222 offset:61440
  s_waitcnt lgkmcnt(4)
  v_accvgpr_read_b32 v7, a19
  v_mfma_f32_16x16x32_bf16 a[80:83], a[168:171], v[64:67], a[80:83]
  v_mul_f32 v0, v0, v192
  v_mul_f32 v1, v1, v192
  v_mfma_f32_16x16x32_bf16 a[80:83], a[172:175], v[96:99], a[80:83]
  ds_read_b64_tr_b16 a[184:185], v223 offset:49152
  v_mul_f32 v2, v2, v192
  v_mfma_f32_16x16x32_bf16 a[84:87], a[172:175], v[104:107], a[84:87]
  v_mul_f32 v3, v3, v192
  v_mul_f32 v4, v4, v192
  v_mfma_f32_16x16x32_bf16 a[84:87], a[168:171], v[72:75], a[84:87]
  ds_read_b64_tr_b16 a[186:187], v223 offset:53248
  v_mul_f32 v5, v5, v192
  v_mfma_f32_16x16x32_bf16 a[88:91], a[168:171], v[80:83], a[88:91]
  v_mul_f32 v6, v6, v192
  v_mul_f32 v7, v7, v192
  v_mfma_f32_16x16x32_bf16 a[88:91], a[172:175], v[112:115], a[88:91]
  ds_read_b64_tr_b16 a[188:189], v223 offset:57344
  v_cvt_pk_bf16_f32 v0, v0, v1
  v_mfma_f32_16x16x32_bf16 a[92:95], a[172:175], v[120:123], a[92:95]
  v_cvt_pk_bf16_f32 v1, v2, v3
  v_cvt_pk_bf16_f32 v2, v4, v5
  v_mfma_f32_16x16x32_bf16 a[92:95], a[168:171], v[88:91], a[92:95]
  ds_read_b64_tr_b16 a[190:191], v223 offset:61440
  s_waitcnt lgkmcnt(4)
  v_cvt_pk_bf16_f32 v3, v6, v7
  v_mfma_f32_16x16x32_bf16 a[96:99], a[176:179], v[64:67], a[96:99]
  buffer_store_dwordx4 v[0:3], v244, s[24:27], s40 offen offset:0 sc1
  v_mfma_f32_16x16x32_bf16 a[96:99], a[180:183], v[96:99], a[96:99]
  v_accvgpr_read_b32 v8, a4
  v_accvgpr_read_b32 v9, a5
  v_mfma_f32_16x16x32_bf16 a[100:103], a[180:183], v[104:107], a[100:103]
  v_accvgpr_read_b32 v10, a6
  v_accvgpr_read_b32 v11, a7
  v_mfma_f32_16x16x32_bf16 a[100:103], a[176:179], v[72:75], a[100:103]
  v_accvgpr_read_b32 v12, a20
  v_accvgpr_read_b32 v13, a21
  v_mfma_f32_16x16x32_bf16 a[104:107], a[176:179], v[80:83], a[104:107]
  v_accvgpr_read_b32 v14, a22
  v_accvgpr_read_b32 v15, a23
  v_mfma_f32_16x16x32_bf16 a[104:107], a[180:183], v[112:115], a[104:107]
  v_mul_f32 v8, v8, v196
  v_mul_f32 v9, v9, v196
  v_mfma_f32_16x16x32_bf16 a[108:111], a[180:183], v[120:123], a[108:111]
  v_mul_f32 v10, v10, v196
  v_mul_f32 v11, v11, v196
  v_mfma_f32_16x16x32_bf16 a[108:111], a[176:179], v[88:91], a[108:111]
  s_waitcnt lgkmcnt(0)
  v_mul_f32 v12, v12, v196
  v_mul_f32 v13, v13, v196
  v_mfma_f32_16x16x32_bf16 a[112:115], a[184:187], v[64:67], a[112:115]
  v_mul_f32 v14, v14, v196
  v_mul_f32 v15, v15, v196
  v_mfma_f32_16x16x32_bf16 a[112:115], a[188:191], v[96:99], a[112:115]
  v_cvt_pk_bf16_f32 v8, v8, v9
  v_cvt_pk_bf16_f32 v9, v10, v11
  v_mfma_f32_16x16x32_bf16 a[116:119], a[188:191], v[104:107], a[116:119]
  v_cvt_pk_bf16_f32 v10, v12, v13
  v_cvt_pk_bf16_f32 v11, v14, v15
  v_mfma_f32_16x16x32_bf16 a[116:119], a[184:187], v[72:75], a[116:119]
  buffer_store_dwordx4 v[8:11], v244, s[24:27], s40 offen offset:2048 sc1
  v_mfma_f32_16x16x32_bf16 a[120:123], a[184:187], v[80:83], a[120:123]
  v_accvgpr_read_b32 v16, a8
  v_accvgpr_read_b32 v17, a9
  v_mfma_f32_16x16x32_bf16 a[120:123], a[188:191], v[112:115], a[120:123]
  v_accvgpr_read_b32 v18, a10
  v_accvgpr_read_b32 v19, a11
  v_mfma_f32_16x16x32_bf16 a[124:127], a[188:191], v[120:123], a[124:127]
  v_accvgpr_read_b32 v20, a24
  v_accvgpr_read_b32 v21, a25
  v_mfma_f32_16x16x32_bf16 a[124:127], a[184:187], v[88:91], a[124:127]
  v_accvgpr_read_b32 v22, a26
  v_accvgpr_read_b32 v23, a27
  v_pk_mul_f32 v[16:17], v[16:17], v[200:201] op_sel_hi:[1,0]
  v_pk_mul_f32 v[18:19], v[18:19], v[200:201] op_sel_hi:[1,0]
  v_pk_mul_f32 v[20:21], v[20:21], v[200:201] op_sel_hi:[1,0]
  v_pk_mul_f32 v[22:23], v[22:23], v[200:201] op_sel_hi:[1,0]
  v_cvt_pk_bf16_f32 v16, v16, v17
  v_cvt_pk_bf16_f32 v17, v18, v19
  v_cvt_pk_bf16_f32 v18, v20, v21
  v_cvt_pk_bf16_f32 v19, v22, v23
  buffer_store_dwordx4 v[16:19], v244, s[24:27], s41 offen offset:0 sc1
  v_accvgpr_read_b32 v24, a12
  v_accvgpr_read_b32 v25, a13
  v_accvgpr_read_b32 v26, a14
  v_accvgpr_read_b32 v27, a15
  v_accvgpr_read_b32 v28, a28
  v_accvgpr_read_b32 v29, a29
  v_accvgpr_read_b32 v30, a30
  v_accvgpr_read_b32 v31, a31
  v_pk_mul_f32 v[24:25], v[24:25], v[204:205] op_sel_hi:[1,0]
  v_pk_mul_f32 v[26:27], v[26:27], v[204:205] op_sel_hi:[1,0]
  v_pk_mul_f32 v[28:29], v[28:29], v[204:205] op_sel_hi:[1,0]
  v_pk_mul_f32 v[30:31], v[30:31], v[204:205] op_sel_hi:[1,0]
  v_cvt_pk_bf16_f32 v24, v24, v25
  v_cvt_pk_bf16_f32 v25, v26, v27
  v_cvt_pk_bf16_f32 v26, v28, v29
  v_cvt_pk_bf16_f32 v27, v30, v31
  buffer_store_dwordx4 v[24:27], v244, s[24:27], s41 offen offset:2048 sc1
  v_accvgpr_read_b32 v32, a32
  v_accvgpr_read_b32 v33, a33
  v_accvgpr_read_b32 v34, a34
  v_accvgpr_read_b32 v35, a35
  v_accvgpr_read_b32 v36, a48
  v_accvgpr_read_b32 v37, a49
  v_accvgpr_read_b32 v38, a50
  v_accvgpr_read_b32 v39, a51
  v_pk_mul_f32 v[32:33], v[32:33], v[192:193] op_sel_hi:[1,0]
  v_pk_mul_f32 v[34:35], v[34:35], v[192:193] op_sel_hi:[1,0]
  v_pk_mul_f32 v[36:37], v[36:37], v[192:193] op_sel_hi:[1,0]
  v_pk_mul_f32 v[38:39], v[38:39], v[192:193] op_sel_hi:[1,0]
  v_cvt_pk_bf16_f32 v32, v32, v33
  v_cvt_pk_bf16_f32 v33, v34, v35
  v_cvt_pk_bf16_f32 v34, v36, v37
  v_cvt_pk_bf16_f32 v35, v38, v39
  buffer_store_dwordx4 v[32:35], v244, s[24:27], s40 offen offset:1024 sc1
  v_accvgpr_read_b32 v40, a36
  v_accvgpr_read_b32 v41, a37
  v_accvgpr_read_b32 v42, a38
  v_accvgpr_read_b32 v43, a39
  v_accvgpr_read_b32 v44, a52
  v_accvgpr_read_b32 v45, a53
  v_accvgpr_read_b32 v46, a54
  v_accvgpr_read_b32 v47, a55
  v_pk_mul_f32 v[40:41], v[40:41], v[196:197] op_sel_hi:[1,0]
  v_pk_mul_f32 v[42:43], v[42:43], v[196:197] op_sel_hi:[1,0]
  v_pk_mul_f32 v[44:45], v[44:45], v[196:197] op_sel_hi:[1,0]
  v_pk_mul_f32 v[46:47], v[46:47], v[196:197] op_sel_hi:[1,0]
  v_cvt_pk_bf16_f32 v40, v40, v41
  v_cvt_pk_bf16_f32 v41, v42, v43
  v_cvt_pk_bf16_f32 v42, v44, v45
  v_cvt_pk_bf16_f32 v43, v46, v47
  buffer_store_dwordx4 v[40:43], v244, s[24:27], s40 offen offset:3072 sc1
  v_accvgpr_read_b32 v48, a40
  v_accvgpr_read_b32 v49, a41
  v_accvgpr_read_b32 v50, a42
  v_accvgpr_read_b32 v51, a43
  v_accvgpr_read_b32 v52, a56
  v_accvgpr_read_b32 v53, a57
  v_accvgpr_read_b32 v54, a58
  v_accvgpr_read_b32 v55, a59
  v_pk_mul_f32 v[48:49], v[48:49], v[200:201] op_sel_hi:[1,0]
  v_pk_mul_f32 v[50:51], v[50:51], v[200:201] op_sel_hi:[1,0]
  v_pk_mul_f32 v[52:53], v[52:53], v[200:201] op_sel_hi:[1,0]
  v_pk_mul_f32 v[54:55], v[54:55], v[200:201] op_sel_hi:[1,0]
  v_cvt_pk_bf16_f32 v48, v48, v49
  v_cvt_pk_bf16_f32 v49, v50, v51
  v_cvt_pk_bf16_f32 v50, v52, v53
  v_cvt_pk_bf16_f32 v51, v54, v55
  buffer_store_dwordx4 v[48:51], v244, s[24:27], s41 offen offset:1024 sc1
  v_accvgpr_read_b32 v56, a44
  v_accvgpr_read_b32 v57, a45
  v_accvgpr_read_b32 v58, a46
  v_accvgpr_read_b32 v59, a47
  v_accvgpr_read_b32 v60, a60
  v_accvgpr_read_b32 v61, a61
  v_accvgpr_read_b32 v62, a62
  v_accvgpr_read_b32 v63, a63
  v_pk_mul_f32 v[56:57], v[56:57], v[204:205] op_sel_hi:[1,0]
  v_pk_mul_f32 v[58:59], v[58:59], v[204:205] op_sel_hi:[1,0]
  v_pk_mul_f32 v[60:61], v[60:61], v[204:205] op_sel_hi:[1,0]
  v_pk_mul_f32 v[62:63], v[62:63], v[204:205] op_sel_hi:[1,0]
  v_cvt_pk_bf16_f32 v56, v56, v57
  v_cvt_pk_bf16_f32 v57, v58, v59
  v_cvt_pk_bf16_f32 v58, v60, v61
  v_cvt_pk_bf16_f32 v59, v62, v63
  buffer_store_dwordx4 v[56:59], v244, s[24:27], s41 offen offset:3072 sc1
  v_accvgpr_read_b32 v0, a64
  v_accvgpr_read_b32 v1, a65
  v_accvgpr_read_b32 v2, a66
  v_accvgpr_read_b32 v3, a67
  v_accvgpr_read_b32 v4, a80
  v_accvgpr_read_b32 v5, a81
  v_accvgpr_read_b32 v6, a82
  v_accvgpr_read_b32 v7, a83
  v_pk_mul_f32 v[0:1], v[0:1], v[192:193] op_sel_hi:[1,0]
  v_pk_mul_f32 v[2:3], v[2:3], v[192:193] op_sel_hi:[1,0]
  v_pk_mul_f32 v[4:5], v[4:5], v[192:193] op_sel_hi:[1,0]
  v_pk_mul_f32 v[6:7], v[6:7], v[192:193] op_sel_hi:[1,0]
  v_cvt_pk_bf16_f32 v0, v0, v1
  v_cvt_pk_bf16_f32 v1, v2, v3
  v_cvt_pk_bf16_f32 v2, v4, v5
  v_cvt_pk_bf16_f32 v3, v6, v7
  buffer_store_dwordx4 v[0:3], v244, s[24:27], s42 offen offset:0 sc1
  v_accvgpr_read_b32 v8, a68
  v_accvgpr_read_b32 v9, a69
  v_accvgpr_read_b32 v10, a70
  v_accvgpr_read_b32 v11, a71
  v_accvgpr_read_b32 v12, a84
  v_accvgpr_read_b32 v13, a85
  v_accvgpr_read_b32 v14, a86
  v_accvgpr_read_b32 v15, a87
  v_pk_mul_f32 v[8:9], v[8:9], v[196:197] op_sel_hi:[1,0]
  v_pk_mul_f32 v[10:11], v[10:11], v[196:197] op_sel_hi:[1,0]
  v_pk_mul_f32 v[12:13], v[12:13], v[196:197] op_sel_hi:[1,0]
  v_pk_mul_f32 v[14:15], v[14:15], v[196:197] op_sel_hi:[1,0]
  v_cvt_pk_bf16_f32 v8, v8, v9
  v_cvt_pk_bf16_f32 v9, v10, v11
  v_cvt_pk_bf16_f32 v10, v12, v13
  v_cvt_pk_bf16_f32 v11, v14, v15
  buffer_store_dwordx4 v[8:11], v244, s[24:27], s42 offen offset:2048 sc1
  v_accvgpr_read_b32 v16, a72
  v_accvgpr_read_b32 v17, a73
  v_accvgpr_read_b32 v18, a74
  v_accvgpr_read_b32 v19, a75
  v_accvgpr_read_b32 v20, a88
  v_accvgpr_read_b32 v21, a89
  v_accvgpr_read_b32 v22, a90
  v_accvgpr_read_b32 v23, a91
  v_pk_mul_f32 v[16:17], v[16:17], v[200:201] op_sel_hi:[1,0]
  v_pk_mul_f32 v[18:19], v[18:19], v[200:201] op_sel_hi:[1,0]
  v_pk_mul_f32 v[20:21], v[20:21], v[200:201] op_sel_hi:[1,0]
  v_pk_mul_f32 v[22:23], v[22:23], v[200:201] op_sel_hi:[1,0]
  v_cvt_pk_bf16_f32 v16, v16, v17
  v_cvt_pk_bf16_f32 v17, v18, v19
  v_cvt_pk_bf16_f32 v18, v20, v21
  v_cvt_pk_bf16_f32 v19, v22, v23
  buffer_store_dwordx4 v[16:19], v244, s[24:27], s43 offen offset:0 sc1
  v_accvgpr_read_b32 v24, a76
  v_accvgpr_read_b32 v25, a77
  v_accvgpr_read_b32 v26, a78
  v_accvgpr_read_b32 v27, a79
  v_accvgpr_read_b32 v28, a92
  v_accvgpr_read_b32 v29, a93
  v_accvgpr_read_b32 v30, a94
  v_accvgpr_read_b32 v31, a95
  v_pk_mul_f32 v[24:25], v[24:25], v[204:205] op_sel_hi:[1,0]
  v_pk_mul_f32 v[26:27], v[26:27], v[204:205] op_sel_hi:[1,0]
  v_pk_mul_f32 v[28:29], v[28:29], v[204:205] op_sel_hi:[1,0]
  v_pk_mul_f32 v[30:31], v[30:31], v[204:205] op_sel_hi:[1,0]
  v_cvt_pk_bf16_f32 v24, v24, v25
  v_cvt_pk_bf16_f32 v25, v26, v27
  v_cvt_pk_bf16_f32 v26, v28, v29
  v_cvt_pk_bf16_f32 v27, v30, v31
  buffer_store_dwordx4 v[24:27], v244, s[24:27], s43 offen offset:2048 sc1
  v_accvgpr_read_b32 v32, a96
  v_accvgpr_read_b32 v33, a97
  v_accvgpr_read_b32 v34, a98
  v_accvgpr_read_b32 v35, a99
  v_accvgpr_read_b32 v36, a112
  v_accvgpr_read_b32 v37, a113
  v_accvgpr_read_b32 v38, a114
  v_accvgpr_read_b32 v39, a115
  v_pk_mul_f32 v[32:33], v[32:33], v[192:193] op_sel_hi:[1,0]
  v_pk_mul_f32 v[34:35], v[34:35], v[192:193] op_sel_hi:[1,0]
  v_pk_mul_f32 v[36:37], v[36:37], v[192:193] op_sel_hi:[1,0]
  v_pk_mul_f32 v[38:39], v[38:39], v[192:193] op_sel_hi:[1,0]
  v_cvt_pk_bf16_f32 v32, v32, v33
  v_cvt_pk_bf16_f32 v33, v34, v35
  v_cvt_pk_bf16_f32 v34, v36, v37
  v_cvt_pk_bf16_f32 v35, v38, v39
  buffer_store_dwordx4 v[32:35], v244, s[24:27], s42 offen offset:1024 sc1
  v_accvgpr_read_b32 v40, a100
  v_accvgpr_read_b32 v41, a101
  v_accvgpr_read_b32 v42, a102
  v_accvgpr_read_b32 v43, a103
  v_accvgpr_read_b32 v44, a116
  v_accvgpr_read_b32 v45, a117
  v_accvgpr_read_b32 v46, a118
  v_accvgpr_read_b32 v47, a119
  v_pk_mul_f32 v[40:41], v[40:41], v[196:197] op_sel_hi:[1,0]
  v_pk_mul_f32 v[42:43], v[42:43], v[196:197] op_sel_hi:[1,0]
  v_pk_mul_f32 v[44:45], v[44:45], v[196:197] op_sel_hi:[1,0]
  v_pk_mul_f32 v[46:47], v[46:47], v[196:197] op_sel_hi:[1,0]
  v_cvt_pk_bf16_f32 v40, v40, v41
  v_cvt_pk_bf16_f32 v41, v42, v43
  v_cvt_pk_bf16_f32 v42, v44, v45
  v_cvt_pk_bf16_f32 v43, v46, v47
  buffer_store_dwordx4 v[40:43], v244, s[24:27], s42 offen offset:3072 sc1
  v_accvgpr_read_b32 v48, a104
  v_accvgpr_read_b32 v49, a105
  v_accvgpr_read_b32 v50, a106
  v_accvgpr_read_b32 v51, a107
  v_accvgpr_read_b32 v52, a120
  v_accvgpr_read_b32 v53, a121
  v_accvgpr_read_b32 v54, a122
  v_accvgpr_read_b32 v55, a123
  v_pk_mul_f32 v[48:49], v[48:49], v[200:201] op_sel_hi:[1,0]
  v_pk_mul_f32 v[50:51], v[50:51], v[200:201] op_sel_hi:[1,0]
  v_pk_mul_f32 v[52:53], v[52:53], v[200:201] op_sel_hi:[1,0]
  v_pk_mul_f32 v[54:55], v[54:55], v[200:201] op_sel_hi:[1,0]
  v_cvt_pk_bf16_f32 v48, v48, v49
  v_cvt_pk_bf16_f32 v49, v50, v51
  v_cvt_pk_bf16_f32 v50, v52, v53
  v_cvt_pk_bf16_f32 v51, v54, v55
  buffer_store_dwordx4 v[48:51], v244, s[24:27], s43 offen offset:1024 sc1
  v_accvgpr_read_b32 v56, a108
  v_accvgpr_read_b32 v57, a109
  v_accvgpr_read_b32 v58, a110
  v_accvgpr_read_b32 v59, a111
  v_accvgpr_read_b32 v60, a124
  v_accvgpr_read_b32 v61, a125
  v_accvgpr_read_b32 v62, a126
  v_accvgpr_read_b32 v63, a127
  v_pk_mul_f32 v[56:57], v[56:57], v[204:205] op_sel_hi:[1,0]
  v_pk_mul_f32 v[58:59], v[58:59], v[204:205] op_sel_hi:[1,0]
  v_pk_mul_f32 v[60:61], v[60:61], v[204:205] op_sel_hi:[1,0]
  v_pk_mul_f32 v[62:63], v[62:63], v[204:205] op_sel_hi:[1,0]
  v_cvt_pk_bf16_f32 v56, v56, v57
  v_cvt_pk_bf16_f32 v57, v58, v59
  v_cvt_pk_bf16_f32 v58, v60, v61
  v_cvt_pk_bf16_f32 v59, v62, v63
  buffer_store_dwordx4 v[56:59], v244, s[24:27], s43 offen offset:3072 sc1
  ds_write_b32 v247, v245
  buffer_load_dwordx4 a[0:3], v252, s[24:27], s5 offen offset:3072 sc1
  buffer_load_dwordx4 a[4:7], v253, s[24:27], s5 offen offset:0 sc1
  buffer_load_dwordx4 a[8:11], v253, s[24:27], s5 offen offset:1024 sc1
  buffer_load_dwordx4 a[12:15], v253, s[24:27], s5 offen offset:2048 sc1
  buffer_load_dwordx4 a[16:19], v253, s[24:27], s5 offen offset:3072 sc1
  buffer_load_dwordx4 a[20:23], v242, s[24:27], s6 offen offset:0 sc1
  buffer_load_dwordx4 a[24:27], v242, s[24:27], s6 offen offset:1024 sc1
  buffer_load_dwordx4 a[28:31], v242, s[24:27], s6 offen offset:2048 sc1
  buffer_load_dwordx4 a[32:35], v242, s[24:27], s6 offen offset:3072 sc1
  buffer_load_dwordx4 a[36:39], v252, s[24:27], s6 offen offset:0 sc1
  buffer_load_dwordx4 a[40:43], v252, s[24:27], s6 offen offset:1024 sc1
  buffer_load_dwordx4 a[44:47], v252, s[24:27], s6 offen offset:2048 sc1
  buffer_load_dwordx4 a[48:51], v252, s[24:27], s6 offen offset:3072 sc1
  buffer_load_dwordx4 a[52:55], v253, s[24:27], s6 offen offset:0 sc1
  s_bfe_u32 s39, s2, 0x40002
  s_lshl_b32 s39, s39, 8
  s_add_u32 s39, s39, 2818304
  s_lshl_b32 s38, s3, 26
  v_lshlrev_b32 v64, 22, v242
  v_or_b32 v64, s38, v64
  v_mov_b32 v65, 1
  v_add_u32 v246, 157696, v242
  s_waitcnt vmcnt(14) lgkmcnt(0)
  s_barrier
  ds_read_b128 v[68:71], v246
  s_waitcnt lgkmcnt(0)
  v_or3_b32 v68, v68, v69, v70
  v_or_b32 v68, v68, v71
  v_cmp_ne_u32 vcc, 0, v68
  s_nop 0
  s_cbranch_vccnz attn_redo
tail_go:
  buffer_atomic_add v65, v64, s[24:27], s39 offen
  s_and_b32 s36, s2, 1
  s_bfe_u32 s31, s2, 0x20001
  s_lshl_b32 s31, s31, 2
  s_bfe_u32 s38, s2, 0x20003
  s_add_u32 s31, s31, s38
  s_lshr_b32 s29, s2, 5
  v_mov_b32 v114, v242
  v_add_u32 v115, 0x1000, v114
  v_add_u32 v116, 0x2000, v114
  s_lshl_b32 s38, s36, 2
  s_add_u32 s38, s38, s3
  s_lshl_b32 s30, s38, 16
  buffer_load_dwordx4 a[56:59], v116, s[24:27], s6 offen offset:1024 sc1
  buffer_load_dwordx4 a[60:63], v116, s[24:27], s6 offen offset:2048 sc1
  buffer_load_dwordx4 a[64:67], v116, s[24:27], s6 offen offset:3072 sc1
  buffer_load_dwordx4 a[68:71], v114, s[24:27], s7 offen offset:0 sc1
  buffer_load_dwordx4 a[72:75], v114, s[24:27], s7 offen offset:1024 sc1
  buffer_load_dwordx4 a[76:79], v114, s[24:27], s7 offen offset:2048 sc1
  v_lshrrev_b32 v125, 4, v114
  v_and_b32 v126, 15, v125
  v_lshrrev_b32 v127, 4, v125
  s_add_u32 s38, s3, 0
  s_and_b32 s38, s38, 3
  s_lshl_b32 s38, s38, 11
  v_add_u32 v110, s38, v114
  s_sub_u32 s38, s3, 0
  s_and_b32 s38, s38, 3
  s_mul_i32 s38, s38, 15360
  s_add_u32 s38, s38, 98304
  v_add_u32 v118, s38, v114
  s_add_u32 s38, s3, 1
  s_and_b32 s38, s38, 3
  s_lshl_b32 s38, s38, 11
  v_add_u32 v111, s38, v114
  s_sub_u32 s38, s3, 1
  s_and_b32 s38, s38, 3
  s_mul_i32 s38, s38, 15360
  s_add_u32 s38, s38, 98304
  v_add_u32 v119, s38, v114
  s_add_u32 s38, s3, 2
  s_and_b32 s38, s38, 3
  s_lshl_b32 s38, s38, 11
  v_add_u32 v112, s38, v114
  s_sub_u32 s38, s3, 2
  s_and_b32 s38, s38, 3
  s_mul_i32 s38, s38, 15360
  s_add_u32 s38, s38, 98304
  v_add_u32 v120, s38, v114
  s_add_u32 s38, s3, 3
  s_and_b32 s38, s38, 3
  s_lshl_b32 s38, s38, 11
  v_add_u32 v113, s38, v114
  s_sub_u32 s38, s3, 3
  s_and_b32 s38, s38, 3
  s_mul_i32 s38, s38, 15360
  s_add_u32 s38, s38, 98304
  v_add_u32 v121, s38, v114
  v_add_u32 v122, s28, v114
  v_add_u32 v135, 0x10000, v122
  s_and_b32 s38, s31, 14
  s_add_u32 s38, s38, s36
  s_lshl_b32 s38, s38, 8
  s_add_u32 s38, s38, 2818304
  s_lshl_b32 s39, s29, 8
  s_add_u32 s39, s39, 2822400
  v_mov_b32 v133, s38
  v_writelane_b32 v133, s39, 1
  v_mov_b32 v134, 16
  v_writelane_b32 v134, 30, 1
  s_lshl_b32 s31, s31, 1
  s_add_u32 s31, s31, s36
  s_add_u32 s30, s30, 8388608
  s_lshl_b32 s38, s31, 19
  s_add_u32 s37, s30, s38
  s_xor_b32 s38, s38, 0x80000
  s_add_u32 s30, s30, s38
  s_lshl_b32 s40, s29, 5
  s_add_u32 s40, s40, s31
  s_lshl_b32 s38, s31, 6
  s_lshl_b32 s39, s3, 4
  s_add_u32 s38, s38, s39
  v_add_u32 v128, s38, v126
  v_mul_u32_u24 v117, 0x500, v128
  v_lshl_add_u32 v117, v127, 3, v117
  s_mul_i32 s38, s29, 160
  v_add_u32 v117, s38, v117
  s_mov_b32 s12, s60
  s_mov_b32 s13, s61
  s_mov_b32 s14, 2621440
  s_mov_b32 s15, 0x20000
  s_mov_b32 s16, s62
  s_mov_b32 s17, s63
  s_mov_b32 s18, 2621440
  s_mov_b32 s19, 0x20000
  s_mul_i32 s38, s31, 81920
  s_lshl_b32 s39, s3, 10
  s_add_u32 s38, s38, s39
  s_mul_i32 s39, s29, 10
  v_lshrrev_b32 v129, 1, v127
  v_add_u32 v129, s39, v129
  v_and_b32 v130, 1, v127
  v_lshlrev_b32 v130, 3, v130
  v_lshl_add_u32 v130, v126, 4, v130
  v_lshrrev_b32 v131, 2, v129
  v_lshl_add_u32 v131, v131, 12, v130
  v_and_b32 v132, 3, v129
  v_lshl_add_u32 v131, v132, 8, v131
  buffer_load_dwordx2 v[156:157], v131, s[24:27], s38 offen sc1
  v_add_u32 v129, 2, v129
  buffer_load_dwordx2 v[80:81], v117, s[12:15], 0 offen offset:0
  v_lshrrev_b32 v131, 2, v129
  v_lshl_add_u32 v131, v131, 12, v130
  v_and_b32 v132, 3, v129
  v_lshl_add_u32 v131, v132, 8, v131
  buffer_load_dwordx2 v[158:159], v131, s[24:27], s38 offen sc1
  v_add_u32 v129, 2, v129
  buffer_load_dwordx2 v[82:83], v117, s[12:15], 0 offen offset:32
  v_lshrrev_b32 v131, 2, v129
  v_lshl_add_u32 v131, v131, 12, v130
  v_and_b32 v132, 3, v129
  v_lshl_add_u32 v131, v132, 8, v131
  buffer_load_dwordx2 v[160:161], v131, s[24:27], s38 offen sc1
  v_add_u32 v129, 2, v129
  buffer_load_dwordx2 v[84:85], v117, s[12:15], 0 offen offset:64
  v_lshrrev_b32 v131, 2, v129
  v_lshl_add_u32 v131, v131, 12, v130
  v_and_b32 v132, 3, v129
  v_lshl_add_u32 v131, v132, 8, v131
  buffer_load_dwordx2 v[162:163], v131, s[24:27], s38 offen sc1
  v_add_u32 v129, 2, v129
  buffer_load_dwordx2 v[86:87], v117, s[12:15], 0 offen offset:96
  v_lshrrev_b32 v131, 2, v129
  v_lshl_add_u32 v131, v131, 12, v130
  v_and_b32 v132, 3, v129
  v_lshl_add_u32 v131, v132, 8, v131
  buffer_load_dwordx2 v[164:165], v131, s[24:27], s38 offen sc1
  v_add_u32 v129, 2, v129
  buffer_load_dwordx2 v[88:89], v117, s[12:15], 0 offen offset:128
  v_mov_b32 v123, 1073741824
  v_bfrev_b32 v124, 1
  v_sub_u32 v128, 0xffff, v128
  s_mov_b32 s34, 0xffff0000
  s_and_b32 s38, s52, 0xffff
  v_cmp_eq_u32 vcc, s38, v128
  v_mov_b32 v129, s52
  v_mov_b32 v130, 0
  v_cndmask_b32 v124, v124, v129, vcc
  v_cndmask_b32 v123, v123, v130, vcc
  s_and_b32 s38, s53, 0xffff
  v_cmp_eq_u32 vcc, s38, v128
  v_mov_b32 v129, s53
  v_mov_b32 v130, 2560
  v_cndmask_b32 v124, v124, v129, vcc
  v_cndmask_b32 v123, v123, v130, vcc
  s_and_b32 s38, s54, 0xffff
  v_cmp_eq_u32 vcc, s38, v128
  v_mov_b32 v129, s54
  v_mov_b32 v130, 5120
  v_cndmask_b32 v124, v124, v129, vcc
  v_cndmask_b32 v123, v123, v130, vcc
  s_and_b32 s38, s55, 0xffff
  v_cmp_eq_u32 vcc, s38, v128
  v_mov_b32 v129, s55
  v_mov_b32 v130, 7680
  v_cndmask_b32 v124, v124, v129, vcc
  v_cndmask_b32 v123, v123, v130, vcc
  s_and_b32 s38, s56, 0xffff
  v_cmp_eq_u32 vcc, s38, v128
  v_mov_b32 v129, s56
  v_mov_b32 v130, 10240
  v_cndmask_b32 v124, v124, v129, vcc
  v_cndmask_b32 v123, v123, v130, vcc
  s_and_b32 s38, s57, 0xffff
  v_cmp_eq_u32 vcc, s38, v128
  v_mov_b32 v129, s57
  v_mov_b32 v130, 12800
  v_cndmask_b32 v124, v124, v129, vcc
  v_cndmask_b32 v123, v123, v130, vcc
  s_and_b32 s38, s58, 0xffff
  v_cmp_eq_u32 vcc, s38, v128
  v_mov_b32 v129, s58
  v_mov_b32 v130, 15360
  v_cndmask_b32 v124, v124, v129, vcc
  v_cndmask_b32 v123, v123, v130, vcc
  s_and_b32 s38, s59, 0xffff
  v_cmp_eq_u32 vcc, s38, v128
  v_mov_b32 v129, s59
  v_mov_b32 v130, 17920
  v_cndmask_b32 v124, v124, v129, vcc
  v_cndmask_b32 v123, v123, v130, vcc
  v_lshl_add_u32 v123, v127, 4, v123
  s_mul_i32 s32, s29, 320
  s_add_u32 s32, s32, 2686976
  v_ashrrev_i32 v129, 31, v124
  v_not_b32 v129, v129
  v_or_b32 v129, 0x80000000, v129
  v_xor_b32 v124, v124, v129
  v_and_b32 v124, s34, v124
  v_mul_f32 v124, 0xbfb8aa3b, v124
  v_exp_f32 v124, v124
  s_nop 0
  v_add_f32 v124, 1.0, v124
  v_rcp_f32 v124, v124
  s_nop 0
  v_cvt_pk_bf16_f32 v124, v124, v124
  v_lshlrev_b32 v124, 16, v124
  buffer_load_dword v128, v133, s[24:27], 0 offen sc1
  buffer_load_dwordx4 a[80:83], v114, s[24:27], s7 offen offset:3072 sc1
  buffer_load_dwordx4 a[84:87], v115, s[24:27], s7 offen offset:0 sc1
  buffer_load_dwordx4 a[88:91], v115, s[24:27], s7 offen offset:1024 sc1
  buffer_load_dwordx4 a[92:95], v115, s[24:27], s7 offen offset:2048 sc1
  buffer_load_dwordx4 a[96:99], v115, s[24:27], s7 offen offset:3072 sc1
  buffer_load_dwordx4 a[100:103], v116, s[24:27], s7 offen offset:0 sc1
  s_waitcnt vmcnt(16)
  v_lshlrev_b32 v90, 16, v156
  v_and_b32 v91, s34, v156
  v_lshlrev_b32 v92, 16, v157
  v_and_b32 v93, s34, v157
  s_waitcnt vmcnt(14)
  v_lshlrev_b32 v94, 16, v158
  v_and_b32 v95, s34, v158
  v_lshlrev_b32 v96, 16, v159
  v_and_b32 v97, s34, v159
  s_waitcnt vmcnt(12)
  v_lshlrev_b32 v98, 16, v160
  v_and_b32 v99, s34, v160
  v_lshlrev_b32 v100, 16, v161
  v_and_b32 v101, s34, v161
  s_waitcnt vmcnt(10)
  v_lshlrev_b32 v102, 16, v162
  v_and_b32 v103, s34, v162
  v_lshlrev_b32 v104, 16, v163
  v_and_b32 v105, s34, v163
  s_waitcnt vmcnt(8)
  v_lshlrev_b32 v106, 16, v164
  v_and_b32 v107, s34, v164
  v_lshlrev_b32 v108, 16, v165
  v_and_b32 v109, s34, v165
  v_mov_b32 v156, 0
  v_mov_b32 v157, 0
  v_mov_b32 v158, 0
  v_mov_b32 v159, 0
  v_mov_b32 v160, 0
  v_mov_b32 v161, 0
  v_mov_b32 v162, 0
  v_mov_b32 v163, 0
  v_mov_b32 v164, 0
  v_mov_b32 v165, 0
  v_mov_b32 v166, 0
  v_mov_b32 v167, 0
  v_mov_b32 v168, 0
  v_mov_b32 v169, 0
  v_mov_b32 v170, 0
  v_mov_b32 v171, 0
  v_mov_b32 v172, 0
  v_mov_b32 v173, 0
  v_mov_b32 v174, 0
  v_mov_b32 v175, 0
  s_waitcnt vmcnt(6)
  v_cmp_lt_u32 vcc, v128, v134
  s_nop 0
  s_cbranch_vccz tail_ready
  s_mov_b32 s35, 32768
tail_spin:
  s_sleep 2
  buffer_load_dword v128, v133, s[24:27], 0 offen sc1
  s_waitcnt vmcnt(0)
  v_cmp_lt_u32 vcc, v128, v134
  s_nop 0
  s_cbranch_vccz tail_ready
  s_sub_u32 s35, s35, 1
  s_cmp_lg_u32 s35, 0
  s_cbranch_scc1 tail_spin
tail_ready:
  buffer_load_dwordx4 a[180:183], v110, s[24:27], s30 offen offset:0 sc1
  buffer_load_dwordx4 a[184:187], v110, s[24:27], s30 offen offset:1024 sc1
  buffer_load_dwordx4 a[188:191], v111, s[24:27], s30 offen offset:0 sc1
  buffer_load_dwordx4 a[192:195], v111, s[24:27], s30 offen offset:1024 sc1
  buffer_load_dwordx4 a[196:199], v112, s[24:27], s30 offen offset:0 sc1
  buffer_load_dwordx4 a[200:203], v112, s[24:27], s30 offen offset:1024 sc1
  buffer_load_dwordx4 a[204:207], v113, s[24:27], s30 offen offset:0 sc1
  buffer_load_dwordx4 a[208:211], v113, s[24:27], s30 offen offset:1024 sc1
  v_cmp_gt_u32 vcc, 1073741824, v123
  s_nop 0
  s_and_saveexec_b64 s[42:43], vcc
  s_cbranch_execz tail_plain
  s_waitcnt vmcnt(30)
  buffer_load_dwordx4 v[156:159], v123, s[24:27], s32 offen offset:0 sc1
  buffer_load_dwordx4 v[160:163], v123, s[24:27], s32 offen offset:64 sc1
  buffer_load_dwordx4 v[164:167], v123, s[24:27], s32 offen offset:128 sc1
  buffer_load_dwordx4 v[168:171], v123, s[24:27], s32 offen offset:192 sc1
  buffer_load_dwordx4 v[172:175], v123, s[24:27], s32 offen offset:256 sc1
  s_add_u32 s32, s32, 20480
  buffer_load_dwordx4 v[136:139], v123, s[24:27], s32 offen offset:0 sc1
  buffer_load_dwordx4 v[140:143], v123, s[24:27], s32 offen offset:64 sc1
  buffer_load_dwordx4 v[144:147], v123, s[24:27], s32 offen offset:128 sc1
  buffer_load_dwordx4 v[148:151], v123, s[24:27], s32 offen offset:192 sc1
  buffer_load_dwordx4 v[152:155], v123, s[24:27], s32 offen offset:256 sc1
  s_add_u32 s32, s32, 20480
  buffer_load_dwordx4 v[0:3], v123, s[24:27], s32 offen offset:0 sc1
  buffer_load_dwordx4 v[4:7], v123, s[24:27], s32 offen offset:64 sc1
  buffer_load_dwordx4 v[8:11], v123, s[24:27], s32 offen offset:128 sc1
  buffer_load_dwordx4 v[12:15], v123, s[24:27], s32 offen offset:192 sc1
  buffer_load_dwordx4 v[16:19], v123, s[24:27], s32 offen offset:256 sc1
  s_add_u32 s32, s32, 20480
  buffer_load_dwordx4 v[20:23], v123, s[24:27], s32 offen offset:0 sc1
  buffer_load_dwordx4 v[24:27], v123, s[24:27], s32 offen offset:64 sc1
  buffer_load_dwordx4 v[28:31], v123, s[24:27], s32 offen offset:128 sc1
  buffer_load_dwordx4 v[32:35], v123, s[24:27], s32 offen offset:192 sc1
  buffer_load_dwordx4 v[36:39], v123, s[24:27], s32 offen offset:256 sc1
  s_add_u32 s32, s32, 20480
  buffer_load_dwordx4 v[40:43], v123, s[24:27], s32 offen offset:0 sc1
  buffer_load_dwordx4 v[44:47], v123, s[24:27], s32 offen offset:64 sc1
  buffer_load_dwordx4 v[48:51], v123, s[24:27], s32 offen offset:128 sc1
  buffer_load_dwordx4 v[52:55], v123, s[24:27], s32 offen offset:192 sc1
  buffer_load_dwordx4 v[56:59], v123, s[24:27], s32 offen offset:256 sc1
  s_add_u32 s32, s32, 20480
  buffer_load_dwordx4 v[60:63], v123, s[24:27], s32 offen offset:0 sc1
  buffer_load_dwordx4 v[64:67], v123, s[24:27], s32 offen offset:64 sc1
  buffer_load_dwordx4 v[68:71], v123, s[24:27], s32 offen offset:128 sc1
  buffer_load_dwordx4 v[72:75], v123, s[24:27], s32 offen offset:192 sc1
  buffer_load_dwordx4 v[76:79], v123, s[24:27], s32 offen offset:256 sc1
  s_add_u32 s32, s32, 20480
  s_waitcnt vmcnt(0)
  v_add_f32 v156, v156, v136
  v_add_f32 v157, v157, v137
  v_add_f32 v158, v158, v138
  v_add_f32 v159, v159, v139
  v_add_f32 v160, v160, v140
  v_add_f32 v161, v161, v141
  v_add_f32 v162, v162, v142
  v_add_f32 v163, v163, v143
  v_add_f32 v164, v164, v144
  v_add_f32 v165, v165, v145
  v_add_f32 v166, v166, v146
  v_add_f32 v167, v167, v147
  v_add_f32 v168, v168, v148
  v_add_f32 v169, v169, v149
  v_add_f32 v170, v170, v150
  v_add_f32 v171, v171, v151
  v_add_f32 v172, v172, v152
  v_add_f32 v173, v173, v153
  v_add_f32 v174, v174, v154
  v_add_f32 v175, v175, v155
  v_add_f32 v156, v156, v0
  v_add_f32 v157, v157, v1
  v_add_f32 v158, v158, v2
  v_add_f32 v159, v159, v3
  v_add_f32 v160, v160, v4
  v_add_f32 v161, v161, v5
  v_add_f32 v162, v162, v6
  v_add_f32 v163, v163, v7
  v_add_f32 v164, v164, v8
  v_add_f32 v165, v165, v9
  v_add_f32 v166, v166, v10
  v_add_f32 v167, v167, v11
  v_add_f32 v168, v168, v12
  v_add_f32 v169, v169, v13
  v_add_f32 v170, v170, v14
  v_add_f32 v171, v171, v15
  v_add_f32 v172, v172, v16
  v_add_f32 v173, v173, v17
  v_add_f32 v174, v174, v18
  v_add_f32 v175, v175, v19
  v_add_f32 v156, v156, v20
  v_add_f32 v157, v157, v21
  v_add_f32 v158, v158, v22
  v_add_f32 v159, v159, v23
  v_add_f32 v160, v160, v24
  v_add_f32 v161, v161, v25
  v_add_f32 v162, v162, v26
  v_add_f32 v163, v163, v27
  v_add_f32 v164, v164, v28
  v_add_f32 v165, v165, v29
  v_add_f32 v166, v166, v30
  v_add_f32 v167, v167, v31
  v_add_f32 v168, v168, v32
  v_add_f32 v169, v169, v33
  v_add_f32 v170, v170, v34
  v_add_f32 v171, v171, v35
  v_add_f32 v172, v172, v36
  v_add_f32 v173, v173, v37
  v_add_f32 v174, v174, v38
  v_add_f32 v175, v175, v39
  v_add_f32 v156, v156, v40
  v_add_f32 v157, v157, v41
  v_add_f32 v158, v158, v42
  v_add_f32 v159, v159, v43
  v_add_f32 v160, v160, v44
  v_add_f32 v161, v161, v45
  v_add_f32 v162, v162, v46
  v_add_f32 v163, v163, v47
  v_add_f32 v164, v164, v48
  v_add_f32 v165, v165, v49
  v_add_f32 v166, v166, v50
  v_add_f32 v167, v167, v51
  v_add_f32 v168, v168, v52
  v_add_f32 v169, v169, v53
  v_add_f32 v170, v170, v54
  v_add_f32 v171, v171, v55
  v_add_f32 v172, v172, v56
  v_add_f32 v173, v173, v57
  v_add_f32 v174, v174, v58
  v_add_f32 v175, v175, v59
  v_add_f32 v156, v156, v60
  v_add_f32 v157, v157, v61
  v_add_f32 v158, v158, v62
  v_add_f32 v159, v159, v63
  v_add_f32 v160, v160, v64
  v_add_f32 v161, v161, v65
  v_add_f32 v162, v162, v66
  v_add_f32 v163, v163, v67
  v_add_f32 v164, v164, v68
  v_add_f32 v165, v165, v69
  v_add_f32 v166, v166, v70
  v_add_f32 v167, v167, v71
  v_add_f32 v168, v168, v72
  v_add_f32 v169, v169, v73
  v_add_f32 v170, v170, v74
  v_add_f32 v171, v171, v75
  v_add_f32 v172, v172, v76
  v_add_f32 v173, v173, v77
  v_add_f32 v174, v174, v78
  v_add_f32 v175, v175, v79
tail_plain:
  s_mov_b64 exec, s[42:43]
  s_waitcnt vmcnt(0)
  v_mfma_f32_16x16x32_bf16 v[0:3], a[212:215], a[180:183], 0
  s_add_u32 s30, s30, 8192
  buffer_load_dwordx4 v[176:179], v110, s[24:27], s30 offen offset:0 sc1
  v_mfma_f32_16x16x32_bf16 v[0:3], a[232:235], a[184:187], v[0:3]
  v_cvt_pk_bf16_f32 v156, v156, v156
  v_cvt_pk_bf16_f32 v157, v157, v157
  v_mfma_f32_16x16x32_bf16 v[4:7], a[232:235], a[192:195], 0
  buffer_load_dwordx4 a[104:107], v116, s[24:27], s7 offen offset:1024 sc1
  v_mfma_f32_16x16x32_bf16 v[4:7], a[212:215], a[188:191], v[4:7]
  v_cvt_pk_bf16_f32 v158, v158, v158
  v_cvt_pk_bf16_f32 v159, v159, v159
  v_mfma_f32_16x16x32_bf16 v[8:11], a[212:215], a[196:199], 0
  buffer_load_dwordx4 v[180:183], v110, s[24:27], s30 offen offset:1024 sc1
  v_mfma_f32_16x16x32_bf16 v[8:11], a[232:235], a[200:203], v[8:11]
  v_lshlrev_b32 v156, 16, v156
  v_lshlrev_b32 v157, 16, v157
  v_mfma_f32_16x16x32_bf16 v[12:15], a[232:235], a[208:211], 0
  v_lshlrev_b32 v158, 16, v158
  v_lshlrev_b32 v159, 16, v159
  v_mfma_f32_16x16x32_bf16 v[12:15], a[212:215], a[204:207], v[12:15]
  v_mul_f32 v156, v156, v124
  v_mul_f32 v157, v157, v124
  v_mfma_f32_16x16x32_bf16 v[16:19], a[216:219], a[180:183], 0
  buffer_load_dwordx4 v[184:187], v111, s[24:27], s30 offen offset:0 sc1
  v_mfma_f32_16x16x32_bf16 v[16:19], a[236:239], a[184:187], v[16:19]
  v_mul_f32 v158, v158, v124
  v_mul_f32 v159, v159, v124
  v_mfma_f32_16x16x32_bf16 v[20:23], a[236:239], a[192:195], 0
  buffer_load_dwordx4 a[108:111], v116, s[24:27], s7 offen offset:2048 sc1
  v_mfma_f32_16x16x32_bf16 v[20:23], a[216:219], a[188:191], v[20:23]
  v_cvt_pk_bf16_f32 v156, v156, v156
  v_cvt_pk_bf16_f32 v157, v157, v157
  v_mfma_f32_16x16x32_bf16 v[24:27], a[216:219], a[196:199], 0
  buffer_load_dwordx4 v[188:191], v111, s[24:27], s30 offen offset:1024 sc1
  v_mfma_f32_16x16x32_bf16 v[24:27], a[236:239], a[200:203], v[24:27]
  v_cvt_pk_bf16_f32 v158, v158, v158
  v_cvt_pk_bf16_f32 v159, v159, v159
  v_mfma_f32_16x16x32_bf16 v[28:31], a[236:239], a[208:211], 0
  v_lshlrev_b32 v156, 16, v156
  v_lshlrev_b32 v157, 16, v157
  v_mfma_f32_16x16x32_bf16 v[28:31], a[216:219], a[204:207], v[28:31]
  v_lshlrev_b32 v158, 16, v158
  v_lshlrev_b32 v159, 16, v159
  v_mfma_f32_16x16x32_bf16 v[32:35], a[220:223], a[180:183], 0
  buffer_load_dwordx4 v[192:195], v112, s[24:27], s30 offen offset:0 sc1
  v_mfma_f32_16x16x32_bf16 v[32:35], a[240:243], a[184:187], v[32:35]
  v_add_f32 v90, v90, v156
  v_add_f32 v91, v91, v157
  v_mfma_f32_16x16x32_bf16 v[36:39], a[240:243], a[192:195], 0
  buffer_load_dwordx4 a[112:115], v116, s[24:27], s7 offen offset:3072 sc1
  v_mfma_f32_16x16x32_bf16 v[36:39], a[220:223], a[188:191], v[36:39]
  v_add_f32 v92, v92, v158
  v_add_f32 v93, v93, v159
  v_mfma_f32_16x16x32_bf16 v[40:43], a[220:223], a[196:199], 0
  buffer_load_dwordx4 v[196:199], v112, s[24:27], s30 offen offset:1024 sc1
  v_mfma_f32_16x16x32_bf16 v[40:43], a[240:243], a[200:203], v[40:43]
  v_cvt_pk_bf16_f32 v90, v90, v90
  v_cvt_pk_bf16_f32 v91, v91, v91
  v_mfma_f32_16x16x32_bf16 v[44:47], a[240:243], a[208:211], 0
  v_cvt_pk_bf16_f32 v92, v92, v92
  v_cvt_pk_bf16_f32 v93, v93, v93
  v_mfma_f32_16x16x32_bf16 v[44:47], a[220:223], a[204:207], v[44:47]
  v_lshlrev_b32 v90, 16, v90
  v_lshlrev_b32 v91, 16, v91
  v_mfma_f32_16x16x32_bf16 v[48:51], a[224:227], a[180:183], 0
  buffer_load_dwordx4 v[200:203], v113, s[24:27], s30 offen offset:0 sc1
  v_mfma_f32_16x16x32_bf16 v[48:51], a[244:247], a[184:187], v[48:51]
  v_lshlrev_b32 v92, 16, v92
  v_lshlrev_b32 v93, 16, v93
  v_mfma_f32_16x16x32_bf16 v[52:55], a[244:247], a[192:195], 0
  buffer_load_dwordx4 a[116:119], v114, s[24:27], s8 offen offset:0 sc1
  v_mfma_f32_16x16x32_bf16 v[52:55], a[224:227], a[188:191], v[52:55]
  v_mul_f32 v129, 0xbfb8aa3b, v90
  v_mul_f32 v130, 0xbfb8aa3b, v91
  v_mfma_f32_16x16x32_bf16 v[56:59], a[224:227], a[196:199], 0
  buffer_load_dwordx4 v[204:207], v113, s[24:27], s30 offen offset:1024 sc1
  v_mfma_f32_16x16x32_bf16 v[56:59], a[244:247], a[200:203], v[56:59]
  v_mul_f32 v131, 0xbfb8aa3b, v92
  v_mul_f32 v132, 0xbfb8aa3b, v93
  v_mfma_f32_16x16x32_bf16 v[60:63], a[244:247], a[208:211], 0
  v_exp_f32 v129, v129
  v_mfma_f32_16x16x32_bf16 v[60:63], a[224:227], a[204:207], v[60:63]
  v_exp_f32 v130, v130
  v_mfma_f32_16x16x32_bf16 v[64:67], a[228:231], a[180:183], 0
  s_add_u32 s30, s30, 8192
  buffer_load_dwordx4 v[208:211], v110, s[24:27], s30 offen offset:0 sc1
  v_mfma_f32_16x16x32_bf16 v[64:67], a[248:251], a[184:187], v[64:67]
  v_exp_f32 v131, v131
  v_mfma_f32_16x16x32_bf16 v[68:71], a[248:251], a[192:195], 0
  buffer_load_dwordx4 a[120:123], v114, s[24:27], s8 offen offset:1024 sc1
  v_mfma_f32_16x16x32_bf16 v[68:71], a[228:231], a[188:191], v[68:71]
  v_exp_f32 v132, v132
  v_mfma_f32_16x16x32_bf16 v[72:75], a[228:231], a[196:199], 0
  buffer_load_dwordx4 v[212:215], v110, s[24:27], s30 offen offset:1024 sc1
  v_mfma_f32_16x16x32_bf16 v[72:75], a[248:251], a[200:203], v[72:75]
  v_add_f32 v129, 1.0, v129
  v_add_f32 v130, 1.0, v130
  v_mfma_f32_16x16x32_bf16 v[76:79], a[248:251], a[208:211], 0
  v_add_f32 v131, 1.0, v131
  v_add_f32 v132, 1.0, v132
  v_mfma_f32_16x16x32_bf16 v[76:79], a[228:231], a[204:207], v[76:79]
  v_rcp_f32 v129, v129
  s_waitcnt vmcnt(3)
  v_mfma_f32_16x16x32_bf16 v[0:3], a[252:255], v[176:179], v[0:3]
  buffer_load_dwordx4 v[216:219], v111, s[24:27], s30 offen offset:0 sc1
  v_mfma_f32_16x16x32_bf16 v[0:3], a[144:147], v[180:183], v[0:3]
  v_rcp_f32 v130, v130
  v_mfma_f32_16x16x32_bf16 v[4:7], a[144:147], v[188:191], v[4:7]
  buffer_load_dwordx4 a[124:127], v114, s[24:27], s8 offen offset:2048 sc1
  v_mfma_f32_16x16x32_bf16 v[4:7], a[252:255], v[184:187], v[4:7]
  v_rcp_f32 v131, v131
  v_mfma_f32_16x16x32_bf16 v[8:11], a[252:255], v[192:195], v[8:11]
  buffer_load_dwordx4 v[220:223], v111, s[24:27], s30 offen offset:1024 sc1
  v_mfma_f32_16x16x32_bf16 v[8:11], a[144:147], v[196:199], v[8:11]
  v_rcp_f32 v132, v132
  v_mfma_f32_16x16x32_bf16 v[12:15], a[144:147], v[204:207], v[12:15]
  v_mul_f32 v90, v90, v129
  v_mul_f32 v91, v91, v130
  v_mfma_f32_16x16x32_bf16 v[12:15], a[252:255], v[200:203], v[12:15]
  v_mul_f32 v92, v92, v131
  v_mul_f32 v93, v93, v132
  v_mfma_f32_16x16x32_bf16 v[16:19], a[128:131], v[176:179], v[16:19]
  buffer_load_dwordx4 v[224:227], v112, s[24:27], s30 offen offset:0 sc1
  v_mfma_f32_16x16x32_bf16 v[16:19], a[148:151], v[180:183], v[16:19]
  v_cvt_pk_bf16_f32 v90, v90, v90
  v_cvt_pk_bf16_f32 v91, v91, v91
  v_mfma_f32_16x16x32_bf16 v[20:23], a[148:151], v[188:191], v[20:23]
  buffer_load_dwordx4 a[160:163], v114, s[24:27], s8 offen offset:3072 sc1
  v_mfma_f32_16x16x32_bf16 v[20:23], a[128:131], v[184:187], v[20:23]
  v_cvt_pk_bf16_f32 v92, v92, v92
  v_cvt_pk_bf16_f32 v93, v93, v93
  v_mfma_f32_16x16x32_bf16 v[24:27], a[128:131], v[192:195], v[24:27]
  buffer_load_dwordx4 v[228:231], v112, s[24:27], s30 offen offset:1024 sc1
  v_mfma_f32_16x16x32_bf16 v[24:27], a[148:151], v[196:199], v[24:27]
  v_lshlrev_b32 v90, 16, v90
  v_lshlrev_b32 v91, 16, v91
  v_mfma_f32_16x16x32_bf16 v[28:31], a[148:151], v[204:207], v[28:31]
  v_lshlrev_b32 v92, 16, v92
  v_lshlrev_b32 v93, 16, v93
  v_mfma_f32_16x16x32_bf16 v[28:31], a[128:131], v[200:203], v[28:31]
  v_cvt_pk_bf16_f32 v160, v160, v160
  v_cvt_pk_bf16_f32 v161, v161, v161
  v_mfma_f32_16x16x32_bf16 v[32:35], a[132:135], v[176:179], v[32:35]
  buffer_load_dwordx4 v[232:235], v113, s[24:27], s30 offen offset:0 sc1
  v_mfma_f32_16x16x32_bf16 v[32:35], a[152:155], v[180:183], v[32:35]
  v_cvt_pk_bf16_f32 v162, v162, v162
  v_cvt_pk_bf16_f32 v163, v163, v163
  v_mfma_f32_16x16x32_bf16 v[36:39], a[152:155], v[188:191], v[36:39]
  buffer_load_dwordx4 a[164:167], v115, s[24:27], s8 offen offset:0 sc1
  v_mfma_f32_16x16x32_bf16 v[36:39], a[132:135], v[184:187], v[36:39]
  v_lshlrev_b32 v160, 16, v160
  v_lshlrev_b32 v161, 16, v161
  v_mfma_f32_16x16x32_bf16 v[40:43], a[132:135], v[192:195], v[40:43]
  buffer_load_dwordx4 v[236:239], v113, s[24:27], s30 offen offset:1024 sc1
  v_mfma_f32_16x16x32_bf16 v[40:43], a[152:155], v[196:199], v[40:43]
  v_lshlrev_b32 v162, 16, v162
  v_lshlrev_b32 v163, 16, v163
  v_mfma_f32_16x16x32_bf16 v[44:47], a[152:155], v[204:207], v[44:47]
  v_mul_f32 v160, v160, v124
  v_mul_f32 v161, v161, v124
  v_mfma_f32_16x16x32_bf16 v[44:47], a[132:135], v[200:203], v[44:47]
  v_mul_f32 v162, v162, v124
  v_mul_f32 v163, v163, v124
  v_mfma_f32_16x16x32_bf16 v[48:51], a[136:139], v[176:179], v[48:51]
  s_add_u32 s30, s30, 8192
  buffer_load_dwordx4 v[240:243], v110, s[24:27], s30 offen offset:0 sc1
  v_mfma_f32_16x16x32_bf16 v[48:51], a[156:159], v[180:183], v[48:51]
  v_cvt_pk_bf16_f32 v160, v160, v160
  v_cvt_pk_bf16_f32 v161, v161, v161
  v_mfma_f32_16x16x32_bf16 v[52:55], a[156:159], v[188:191], v[52:55]
  buffer_load_dwordx4 a[168:171], v115, s[24:27], s8 offen offset:1024 sc1
  v_mfma_f32_16x16x32_bf16 v[52:55], a[136:139], v[184:187], v[52:55]
  v_cvt_pk_bf16_f32 v162, v162, v162
  v_cvt_pk_bf16_f32 v163, v163, v163
  v_mfma_f32_16x16x32_bf16 v[56:59], a[136:139], v[192:195], v[56:59]
  buffer_load_dwordx4 v[244:247], v110, s[24:27], s30 offen offset:1024 sc1
  v_mfma_f32_16x16x32_bf16 v[56:59], a[156:159], v[196:199], v[56:59]
  v_lshlrev_b32 v160, 16, v160
  v_lshlrev_b32 v161, 16, v161
  v_mfma_f32_16x16x32_bf16 v[60:63], a[156:159], v[204:207], v[60:63]
  v_lshlrev_b32 v162, 16, v162
  v_lshlrev_b32 v163, 16, v163
  v_mfma_f32_16x16x32_bf16 v[60:63], a[136:139], v[200:203], v[60:63]
  v_add_f32 v94, v94, v160
  v_add_f32 v95, v95, v161
  v_mfma_f32_16x16x32_bf16 v[64:67], a[140:143], v[176:179], v[64:67]
  buffer_load_dwordx4 v[248:251], v111, s[24:27], s30 offen offset:0 sc1
  v_mfma_f32_16x16x32_bf16 v[64:67], a[0:3], v[180:183], v[64:67]
  v_add_f32 v96, v96, v162
  v_add_f32 v97, v97, v163
  v_mfma_f32_16x16x32_bf16 v[68:71], a[0:3], v[188:191], v[68:71]
  buffer_load_dwordx4 a[172:175], v115, s[24:27], s8 offen offset:2048 sc1
  v_mfma_f32_16x16x32_bf16 v[68:71], a[140:143], v[184:187], v[68:71]
  v_cvt_pk_bf16_f32 v94, v94, v94
  v_cvt_pk_bf16_f32 v95, v95, v95
  v_mfma_f32_16x16x32_bf16 v[72:75], a[140:143], v[192:195], v[72:75]
  buffer_load_dwordx4 v[252:255], v111, s[24:27], s30 offen offset:1024 sc1
  v_mfma_f32_16x16x32_bf16 v[72:75], a[0:3], v[196:199], v[72:75]
  v_cvt_pk_bf16_f32 v96, v96, v96
  v_cvt_pk_bf16_f32 v97, v97, v97
  v_mfma_f32_16x16x32_bf16 v[76:79], a[0:3], v[204:207], v[76:79]
  v_lshlrev_b32 v94, 16, v94
  v_lshlrev_b32 v95, 16, v95
  v_mfma_f32_16x16x32_bf16 v[76:79], a[140:143], v[200:203], v[76:79]
  v_lshlrev_b32 v96, 16, v96
  v_lshlrev_b32 v97, 16, v97
  s_waitcnt vmcnt(6)
  v_mfma_f32_16x16x32_bf16 v[0:3], a[4:7], v[208:211], v[0:3]
  buffer_load_dwordx4 v[136:139], v112, s[24:27], s30 offen offset:0 sc1
  v_mfma_f32_16x16x32_bf16 v[0:3], a[24:27], v[212:215], v[0:3]
  v_mul_f32 v129, 0xbfb8aa3b, v94
  v_mul_f32 v130, 0xbfb8aa3b, v95
  v_mfma_f32_16x16x32_bf16 v[4:7], a[24:27], v[220:223], v[4:7]
  buffer_load_dwordx4 a[176:179], v115, s[24:27], s8 offen offset:3072 sc1
  v_mfma_f32_16x16x32_bf16 v[4:7], a[4:7], v[216:219], v[4:7]
  v_mul_f32 v131, 0xbfb8aa3b, v96
  v_mul_f32 v132, 0xbfb8aa3b, v97
  v_mfma_f32_16x16x32_bf16 v[8:11], a[4:7], v[224:227], v[8:11]
  buffer_load_dwordx4 v[140:143], v112, s[24:27], s30 offen offset:1024 sc1
  v_mfma_f32_16x16x32_bf16 v[8:11], a[24:27], v[228:231], v[8:11]
  v_exp_f32 v129, v129
  v_mfma_f32_16x16x32_bf16 v[12:15], a[24:27], v[236:239], v[12:15]
  v_exp_f32 v130, v130
  v_mfma_f32_16x16x32_bf16 v[12:15], a[4:7], v[232:235], v[12:15]
  v_exp_f32 v131, v131
  v_mfma_f32_16x16x32_bf16 v[16:19], a[8:11], v[208:211], v[16:19]
  buffer_load_dwordx4 v[144:147], v113, s[24:27], s30 offen offset:0 sc1
  v_mfma_f32_16x16x32_bf16 v[16:19], a[28:31], v[212:215], v[16:19]
  v_exp_f32 v132, v132
  v_mfma_f32_16x16x32_bf16 v[20:23], a[28:31], v[220:223], v[20:23]
  s_add_u32 m0, s28, 49152
  s_nop 0
  buffer_load_dwordx4 v115, s[24:27], s10 offen offset:0 sc1 lds
  v_mfma_f32_16x16x32_bf16 v[20:23], a[8:11], v[216:219], v[20:23]
  buffer_load_dwordx4 v115, s[24:27], s10 offen offset:1024 sc1 lds
  v_mfma_f32_16x16x32_bf16 v[24:27], a[8:11], v[224:227], v[24:27]
  buffer_load_dwordx4 v115, s[24:27], s10 offen offset:2048 sc1 lds
  v_mfma_f32_16x16x32_bf16 v[24:27], a[28:31], v[228:231], v[24:27]
  buffer_load_dwordx4 v115, s[24:27], s10 offen offset:3072 sc1 lds
  v_mfma_f32_16x16x32_bf16 v[28:31], a[28:31], v[236:239], v[28:31]
  buffer_load_dwordx4 v[148:151], v113, s[24:27], s30 offen offset:1024 sc1
  v_mfma_f32_16x16x32_bf16 v[28:31], a[8:11], v[232:235], v[28:31]
  v_add_f32 v129, 1.0, v129
  v_add_f32 v130, 1.0, v130
  v_mfma_f32_16x16x32_bf16 v[32:35], a[12:15], v[208:211], v[32:35]
  s_add_u32 s30, s30, 8192
  buffer_load_dwordx4 v[152:155], v110, s[24:27], s30 offen offset:0 sc1
  v_mfma_f32_16x16x32_bf16 v[32:35], a[32:35], v[212:215], v[32:35]
  v_add_f32 v131, 1.0, v131
  v_add_f32 v132, 1.0, v132
  v_mfma_f32_16x16x32_bf16 v[36:39], a[32:35], v[220:223], v[36:39]
  v_rcp_f32 v129, v129
  v_mfma_f32_16x16x32_bf16 v[36:39], a[12:15], v[216:219], v[36:39]
  v_rcp_f32 v130, v130
  v_mfma_f32_16x16x32_bf16 v[40:43], a[12:15], v[224:227], v[40:43]
  buffer_load_dwordx4 a[180:183], v110, s[24:27], s30 offen offset:1024 sc1
  v_mfma_f32_16x16x32_bf16 v[40:43], a[32:35], v[228:231], v[40:43]
  v_rcp_f32 v131, v131
  v_mfma_f32_16x16x32_bf16 v[44:47], a[32:35], v[236:239], v[44:47]
  v_rcp_f32 v132, v132
  v_mfma_f32_16x16x32_bf16 v[44:47], a[12:15], v[232:235], v[44:47]
  v_mul_f32 v94, v94, v129
  v_mul_f32 v95, v95, v130
  v_mfma_f32_16x16x32_bf16 v[48:51], a[16:19], v[208:211], v[48:51]
  buffer_load_dwordx4 a[184:187], v111, s[24:27], s30 offen offset:0 sc1
  v_mfma_f32_16x16x32_bf16 v[48:51], a[36:39], v[212:215], v[48:51]
  v_mul_f32 v96, v96, v131
  v_mul_f32 v97, v97, v132
  v_mfma_f32_16x16x32_bf16 v[52:55], a[36:39], v[220:223], v[52:55]
  v_cvt_pk_bf16_f32 v94, v94, v94
  v_cvt_pk_bf16_f32 v95, v95, v95
  v_mfma_f32_16x16x32_bf16 v[52:55], a[16:19], v[216:219], v[52:55]
  v_cvt_pk_bf16_f32 v96, v96, v96
  v_cvt_pk_bf16_f32 v97, v97, v97
  v_mfma_f32_16x16x32_bf16 v[56:59], a[16:19], v[224:227], v[56:59]
  buffer_load_dwordx4 a[188:191], v111, s[24:27], s30 offen offset:1024 sc1
  v_mfma_f32_16x16x32_bf16 v[56:59], a[36:39], v[228:231], v[56:59]
  v_lshlrev_b32 v94, 16, v94
  v_lshlrev_b32 v95, 16, v95
  v_mfma_f32_16x16x32_bf16 v[60:63], a[36:39], v[236:239], v[60:63]
  v_lshlrev_b32 v96, 16, v96
  v_lshlrev_b32 v97, 16, v97
  v_mfma_f32_16x16x32_bf16 v[60:63], a[16:19], v[232:235], v[60:63]
  v_cvt_pk_bf16_f32 v164, v164, v164
  v_cvt_pk_bf16_f32 v165, v165, v165
  v_mfma_f32_16x16x32_bf16 v[64:67], a[20:23], v[208:211], v[64:67]
  buffer_load_dwordx4 a[192:195], v112, s[24:27], s30 offen offset:0 sc1
  v_mfma_f32_16x16x32_bf16 v[64:67], a[40:43], v[212:215], v[64:67]
  v_cvt_pk_bf16_f32 v166, v166, v166
  v_cvt_pk_bf16_f32 v167, v167, v167
  v_mfma_f32_16x16x32_bf16 v[68:71], a[40:43], v[220:223], v[68:71]
  v_lshlrev_b32 v164, 16, v164
  v_lshlrev_b32 v165, 16, v165
  v_mfma_f32_16x16x32_bf16 v[68:71], a[20:23], v[216:219], v[68:71]
  v_lshlrev_b32 v166, 16, v166
  v_lshlrev_b32 v167, 16, v167
  v_mfma_f32_16x16x32_bf16 v[72:75], a[20:23], v[224:227], v[72:75]
  buffer_load_dwordx4 a[196:199], v112, s[24:27], s30 offen offset:1024 sc1
  v_mfma_f32_16x16x32_bf16 v[72:75], a[40:43], v[228:231], v[72:75]
  v_mul_f32 v164, v164, v124
  v_mul_f32 v165, v165, v124
  v_mfma_f32_16x16x32_bf16 v[76:79], a[40:43], v[236:239], v[76:79]
  v_mul_f32 v166, v166, v124
  v_mul_f32 v167, v167, v124
  v_mfma_f32_16x16x32_bf16 v[76:79], a[20:23], v[232:235], v[76:79]
  v_cvt_pk_bf16_f32 v164, v164, v164
  v_cvt_pk_bf16_f32 v165, v165, v165
  s_waitcnt vmcnt(6)
  v_mfma_f32_16x16x32_bf16 v[0:3], a[44:47], v[240:243], v[0:3]
  buffer_load_dwordx4 a[200:203], v113, s[24:27], s30 offen offset:0 sc1
  v_mfma_f32_16x16x32_bf16 v[0:3], a[64:67], v[244:247], v[0:3]
  v_cvt_pk_bf16_f32 v166, v166, v166
  v_cvt_pk_bf16_f32 v167, v167, v167
  v_mfma_f32_16x16x32_bf16 v[4:7], a[64:67], v[252:255], v[4:7]
  v_lshlrev_b32 v164, 16, v164
  v_lshlrev_b32 v165, 16, v165
  v_mfma_f32_16x16x32_bf16 v[4:7], a[44:47], v[248:251], v[4:7]
  v_lshlrev_b32 v166, 16, v166
  v_lshlrev_b32 v167, 16, v167
  v_mfma_f32_16x16x32_bf16 v[8:11], a[44:47], v[136:139], v[8:11]
  buffer_load_dwordx4 a[204:207], v113, s[24:27], s30 offen offset:1024 sc1
  v_mfma_f32_16x16x32_bf16 v[8:11], a[64:67], v[140:143], v[8:11]
  v_add_f32 v98, v98, v164
  v_add_f32 v99, v99, v165
  v_mfma_f32_16x16x32_bf16 v[12:15], a[64:67], v[148:151], v[12:15]
  v_add_f32 v100, v100, v166
  v_add_f32 v101, v101, v167
  v_mfma_f32_16x16x32_bf16 v[12:15], a[44:47], v[144:147], v[12:15]
  v_cvt_pk_bf16_f32 v98, v98, v98
  v_cvt_pk_bf16_f32 v99, v99, v99
  v_mfma_f32_16x16x32_bf16 v[16:19], a[48:51], v[240:243], v[16:19]
  s_add_u32 s30, s30, 8192
  buffer_load_dwordx4 a[208:211], v110, s[24:27], s30 offen offset:0 sc1
  v_mfma_f32_16x16x32_bf16 v[16:19], a[68:71], v[244:247], v[16:19]
  v_cvt_pk_bf16_f32 v100, v100, v100
  v_cvt_pk_bf16_f32 v101, v101, v101
  v_mfma_f32_16x16x32_bf16 v[20:23], a[68:71], v[252:255], v[20:23]
  v_lshlrev_b32 v98, 16, v98
  v_lshlrev_b32 v99, 16, v99
  v_mfma_f32_16x16x32_bf16 v[20:23], a[48:51], v[248:251], v[20:23]
  v_lshlrev_b32 v100, 16, v100
  v_lshlrev_b32 v101, 16, v101
  v_mfma_f32_16x16x32_bf16 v[24:27], a[48:51], v[136:139], v[24:27]
  buffer_load_dwordx4 v[176:179], v110, s[24:27], s30 offen offset:1024 sc1
  v_mfma_f32_16x16x32_bf16 v[24:27], a[68:71], v[140:143], v[24:27]
  v_mul_f32 v129, 0xbfb8aa3b, v98
  v_mul_f32 v130, 0xbfb8aa3b, v99
  v_mfma_f32_16x16x32_bf16 v[28:31], a[68:71], v[148:151], v[28:31]
  v_mul_f32 v131, 0xbfb8aa3b, v100
  v_mul_f32 v132, 0xbfb8aa3b, v101
  v_mfma_f32_16x16x32_bf16 v[28:31], a[48:51], v[144:147], v[28:31]
  v_exp_f32 v129, v129
  v_mfma_f32_16x16x32_bf16 v[32:35], a[52:55], v[240:243], v[32:35]
  buffer_load_dwordx4 v[180:183], v111, s[24:27], s30 offen offset:0 sc1
  v_mfma_f32_16x16x32_bf16 v[32:35], a[72:75], v[244:247], v[32:35]
  v_exp_f32 v130, v130
  v_mfma_f32_16x16x32_bf16 v[36:39], a[72:75], v[252:255], v[36:39]
  v_exp_f32 v131, v131
  v_mfma_f32_16x16x32_bf16 v[36:39], a[52:55], v[248:251], v[36:39]
  v_exp_f32 v132, v132
  v_mfma_f32_16x16x32_bf16 v[40:43], a[52:55], v[136:139], v[40:43]
  buffer_load_dwordx4 v[184:187], v111, s[24:27], s30 offen offset:1024 sc1
  v_mfma_f32_16x16x32_bf16 v[40:43], a[72:75], v[140:143], v[40:43]
  v_add_f32 v129, 1.0, v129
  v_add_f32 v130, 1.0, v130
  v_mfma_f32_16x16x32_bf16 v[44:47], a[72:75], v[148:151], v[44:47]
  v_add_f32 v131, 1.0, v131
  v_add_f32 v132, 1.0, v132
  v_mfma_f32_16x16x32_bf16 v[44:47], a[52:55], v[144:147], v[44:47]
  v_rcp_f32 v129, v129
  v_mfma_f32_16x16x32_bf16 v[48:51], a[56:59], v[240:243], v[48:51]
  buffer_load_dwordx4 v[188:191], v112, s[24:27], s30 offen offset:0 sc1
  v_mfma_f32_16x16x32_bf16 v[48:51], a[76:79], v[244:247], v[48:51]
  v_rcp_f32 v130, v130
  v_mfma_f32_16x16x32_bf16 v[52:55], a[76:79], v[252:255], v[52:55]
  v_rcp_f32 v131, v131
  v_mfma_f32_16x16x32_bf16 v[52:55], a[56:59], v[248:251], v[52:55]
  v_rcp_f32 v132, v132
  v_mfma_f32_16x16x32_bf16 v[56:59], a[56:59], v[136:139], v[56:59]
  buffer_load_dwordx4 v[192:195], v112, s[24:27], s30 offen offset:1024 sc1
  v_mfma_f32_16x16x32_bf16 v[56:59], a[76:79], v[140:143], v[56:59]
  v_mul_f32 v98, v98, v129
  v_mul_f32 v99, v99, v130
  v_mfma_f32_16x16x32_bf16 v[60:63], a[76:79], v[148:151], v[60:63]
  v_mul_f32 v100, v100, v131
  v_mul_f32 v101, v101, v132
  v_mfma_f32_16x16x32_bf16 v[60:63], a[56:59], v[144:147], v[60:63]
  v_cvt_pk_bf16_f32 v98, v98, v98
  v_cvt_pk_bf16_f32 v99, v99, v99
  v_mfma_f32_16x16x32_bf16 v[64:67], a[60:63], v[240:243], v[64:67]
  buffer_load_dwordx4 v[196:199], v113, s[24:27], s30 offen offset:0 sc1
  v_mfma_f32_16x16x32_bf16 v[64:67], a[80:83], v[244:247], v[64:67]
  v_cvt_pk_bf16_f32 v100, v100, v100
  v_cvt_pk_bf16_f32 v101, v101, v101
  v_mfma_f32_16x16x32_bf16 v[68:71], a[80:83], v[252:255], v[68:71]
  v_lshlrev_b32 v98, 16, v98
  v_lshlrev_b32 v99, 16, v99
  v_mfma_f32_16x16x32_bf16 v[68:71], a[60:63], v[248:251], v[68:71]
  v_lshlrev_b32 v100, 16, v100
  v_lshlrev_b32 v101, 16, v101
  v_mfma_f32_16x16x32_bf16 v[72:75], a[60:63], v[136:139], v[72:75]
  buffer_load_dwordx4 v[200:203], v113, s[24:27], s30 offen offset:1024 sc1
  v_mfma_f32_16x16x32_bf16 v[72:75], a[80:83], v[140:143], v[72:75]
  v_cvt_pk_bf16_f32 v168, v168, v168
  v_cvt_pk_bf16_f32 v169, v169, v169
  v_mfma_f32_16x16x32_bf16 v[76:79], a[80:83], v[148:151], v[76:79]
  v_cvt_pk_bf16_f32 v170, v170, v170
  v_cvt_pk_bf16_f32 v171, v171, v171
  v_mfma_f32_16x16x32_bf16 v[76:79], a[60:63], v[144:147], v[76:79]
  v_lshlrev_b32 v168, 16, v168
  v_lshlrev_b32 v169, 16, v169
  s_waitcnt vmcnt(8)
  v_mfma_f32_16x16x32_bf16 v[0:3], a[84:87], v[152:155], v[0:3]
  s_add_u32 s30, s30, 8192
  buffer_load_dwordx4 v[204:207], v110, s[24:27], s30 offen offset:0 sc1
  v_mfma_f32_16x16x32_bf16 v[0:3], a[104:107], a[180:183], v[0:3]
  v_lshlrev_b32 v170, 16, v170
  v_lshlrev_b32 v171, 16, v171
  v_mfma_f32_16x16x32_bf16 v[4:7], a[104:107], a[188:191], v[4:7]
  v_mul_f32 v168, v168, v124
  v_mul_f32 v169, v169, v124
  v_mfma_f32_16x16x32_bf16 v[4:7], a[84:87], a[184:187], v[4:7]
  v_mul_f32 v170, v170, v124
  v_mul_f32 v171, v171, v124
  v_mfma_f32_16x16x32_bf16 v[8:11], a[84:87], a[192:195], v[8:11]
  buffer_load_dwordx4 v[208:211], v110, s[24:27], s30 offen offset:1024 sc1
  v_mfma_f32_16x16x32_bf16 v[8:11], a[104:107], a[196:199], v[8:11]
  v_cvt_pk_bf16_f32 v168, v168, v168
  v_cvt_pk_bf16_f32 v169, v169, v169
  v_mfma_f32_16x16x32_bf16 v[12:15], a[104:107], a[204:207], v[12:15]
  v_cvt_pk_bf16_f32 v170, v170, v170
  v_cvt_pk_bf16_f32 v171, v171, v171
  v_mfma_f32_16x16x32_bf16 v[12:15], a[84:87], a[200:203], v[12:15]
  v_lshlrev_b32 v168, 16, v168
  v_lshlrev_b32 v169, 16, v169
  v_mfma_f32_16x16x32_bf16 v[16:19], a[88:91], v[152:155], v[16:19]
  buffer_load_dwordx4 v[212:215], v111, s[24:27], s30 offen offset:0 sc1
  v_mfma_f32_16x16x32_bf16 v[16:19], a[108:111], a[180:183], v[16:19]
  v_lshlrev_b32 v170, 16, v170
  v_lshlrev_b32 v171, 16, v171
  v_mfma_f32_16x16x32_bf16 v[20:23], a[108:111], a[188:191], v[20:23]
  v_add_f32 v102, v102, v168
  v_add_f32 v103, v103, v169
  v_mfma_f32_16x16x32_bf16 v[20:23], a[88:91], a[184:187], v[20:23]
  v_add_f32 v104, v104, v170
  v_add_f32 v105, v105, v171
  v_mfma_f32_16x16x32_bf16 v[24:27], a[88:91], a[192:195], v[24:27]
  buffer_load_dwordx4 v[216:219], v111, s[24:27], s30 offen offset:1024 sc1
  v_mfma_f32_16x16x32_bf16 v[24:27], a[108:111], a[196:199], v[24:27]
  v_cvt_pk_bf16_f32 v102, v102, v102
  v_cvt_pk_bf16_f32 v103, v103, v103
  v_mfma_f32_16x16x32_bf16 v[28:31], a[108:111], a[204:207], v[28:31]
  v_cvt_pk_bf16_f32 v104, v104, v104
  v_cvt_pk_bf16_f32 v105, v105, v105
  v_mfma_f32_16x16x32_bf16 v[28:31], a[88:91], a[200:203], v[28:31]
  v_lshlrev_b32 v102, 16, v102
  v_lshlrev_b32 v103, 16, v103
  v_mfma_f32_16x16x32_bf16 v[32:35], a[92:95], v[152:155], v[32:35]
  buffer_load_dwordx4 v[220:223], v112, s[24:27], s30 offen offset:0 sc1
  v_mfma_f32_16x16x32_bf16 v[32:35], a[112:115], a[180:183], v[32:35]
  v_lshlrev_b32 v104, 16, v104
  v_lshlrev_b32 v105, 16, v105
  v_mfma_f32_16x16x32_bf16 v[36:39], a[112:115], a[188:191], v[36:39]
  v_mul_f32 v129, 0xbfb8aa3b, v102
  v_mul_f32 v130, 0xbfb8aa3b, v103
  v_mfma_f32_16x16x32_bf16 v[36:39], a[92:95], a[184:187], v[36:39]
  v_mul_f32 v131, 0xbfb8aa3b, v104
  v_mul_f32 v132, 0xbfb8aa3b, v105
  v_mfma_f32_16x16x32_bf16 v[40:43], a[92:95], a[192:195], v[40:43]
  buffer_load_dwordx4 v[224:227], v112, s[24:27], s30 offen offset:1024 sc1
  v_mfma_f32_16x16x32_bf16 v[40:43], a[112:115], a[196:199], v[40:43]
  v_exp_f32 v129, v129
  v_mfma_f32_16x16x32_bf16 v[44:47], a[112:115], a[204:207], v[44:47]
  v_exp_f32 v130, v130
  v_mfma_f32_16x16x32_bf16 v[44:47], a[92:95], a[200:203], v[44:47]
  v_exp_f32 v131, v131
  v_mfma_f32_16x16x32_bf16 v[48:51], a[96:99], v[152:155], v[48:51]
  buffer_load_dwordx4 v[228:231], v113, s[24:27], s30 offen offset:0 sc1
  v_mfma_f32_16x16x32_bf16 v[48:51], a[116:119], a[180:183], v[48:51]
  v_exp_f32 v132, v132
  v_mfma_f32_16x16x32_bf16 v[52:55], a[116:119], a[188:191], v[52:55]
  v_add_f32 v129, 1.0, v129
  v_add_f32 v130, 1.0, v130
  v_mfma_f32_16x16x32_bf16 v[52:55], a[96:99], a[184:187], v[52:55]
  v_add_f32 v131, 1.0, v131
  v_add_f32 v132, 1.0, v132
  v_mfma_f32_16x16x32_bf16 v[56:59], a[96:99], a[192:195], v[56:59]
  buffer_load_dwordx4 v[232:235], v113, s[24:27], s30 offen offset:1024 sc1
  v_mfma_f32_16x16x32_bf16 v[56:59], a[116:119], a[196:199], v[56:59]
  v_rcp_f32 v129, v129
  v_mfma_f32_16x16x32_bf16 v[60:63], a[116:119], a[204:207], v[60:63]
  v_rcp_f32 v130, v130
  v_mfma_f32_16x16x32_bf16 v[60:63], a[96:99], a[200:203], v[60:63]
  v_rcp_f32 v131, v131
  v_mfma_f32_16x16x32_bf16 v[64:67], a[100:103], v[152:155], v[64:67]
  ds_read_b128 v[236:239], v122 offset:0
  s_add_u32 s30, s30, 8192
  v_rcp_f32 v132, v132
  v_mfma_f32_16x16x32_bf16 v[64:67], a[120:123], a[180:183], v[64:67]
  buffer_load_dwordx4 v[240:243], v110, s[24:27], s30 offen offset:0 sc1
  v_mfma_f32_16x16x32_bf16 v[68:71], a[120:123], a[188:191], v[68:71]
  v_mul_f32 v102, v102, v129
  v_mul_f32 v103, v103, v130
  v_mfma_f32_16x16x32_bf16 v[68:71], a[100:103], a[184:187], v[68:71]
  v_mul_f32 v104, v104, v131
  v_mul_f32 v105, v105, v132
  v_mfma_f32_16x16x32_bf16 v[72:75], a[100:103], a[192:195], v[72:75]
  buffer_load_dwordx4 v[244:247], v110, s[24:27], s30 offen offset:1024 sc1
  v_mfma_f32_16x16x32_bf16 v[72:75], a[120:123], a[196:199], v[72:75]
  v_cvt_pk_bf16_f32 v102, v102, v102
  v_cvt_pk_bf16_f32 v103, v103, v103
  v_mfma_f32_16x16x32_bf16 v[76:79], a[120:123], a[204:207], v[76:79]
  v_cvt_pk_bf16_f32 v104, v104, v104
  v_cvt_pk_bf16_f32 v105, v105, v105
  v_mfma_f32_16x16x32_bf16 v[76:79], a[100:103], a[200:203], v[76:79]
  v_lshlrev_b32 v102, 16, v102
  v_lshlrev_b32 v103, 16, v103
  s_waitcnt vmcnt(10)
  v_mfma_f32_16x16x32_bf16 v[0:3], a[124:127], a[208:211], v[0:3]
  ds_read_b128 v[248:251], v122 offset:1024
  v_lshlrev_b32 v104, 16, v104
  v_mfma_f32_16x16x32_bf16 v[0:3], a[176:179], v[176:179], v[0:3]
  buffer_load_dwordx4 v[252:255], v111, s[24:27], s30 offen offset:0 sc1
  v_mfma_f32_16x16x32_bf16 v[4:7], a[176:179], v[184:187], v[4:7]
  v_lshlrev_b32 v105, 16, v105
  v_cvt_pk_bf16_f32 v172, v172, v172
  v_mfma_f32_16x16x32_bf16 v[4:7], a[124:127], v[180:183], v[4:7]
  v_cvt_pk_bf16_f32 v173, v173, v173
  v_cvt_pk_bf16_f32 v174, v174, v174
  v_mfma_f32_16x16x32_bf16 v[8:11], a[124:127], v[188:191], v[8:11]
  buffer_load_dwordx4 v[136:139], v111, s[24:27], s30 offen offset:1024 sc1
  v_mfma_f32_16x16x32_bf16 v[8:11], a[176:179], v[192:195], v[8:11]
  v_cvt_pk_bf16_f32 v175, v175, v175
  v_lshlrev_b32 v172, 16, v172
  v_mfma_f32_16x16x32_bf16 v[12:15], a[176:179], v[200:203], v[12:15]
  v_lshlrev_b32 v173, 16, v173
  v_lshlrev_b32 v174, 16, v174
  v_mfma_f32_16x16x32_bf16 v[12:15], a[124:127], v[196:199], v[12:15]
  v_lshlrev_b32 v175, 16, v175
  v_mul_f32 v172, v172, v124
  s_waitcnt lgkmcnt(1)
  v_mfma_f32_16x16x32_bf16 v[16:19], a[160:163], a[208:211], v[16:19]
  ds_read_b128 v[140:143], v122 offset:2048
  v_mul_f32 v173, v173, v124
  v_mfma_f32_16x16x32_bf16 v[16:19], v[236:239], v[176:179], v[16:19]
  buffer_load_dwordx4 v[144:147], v112, s[24:27], s30 offen offset:0 sc1
  v_mfma_f32_16x16x32_bf16 v[20:23], v[236:239], v[184:187], v[20:23]
  v_mul_f32 v174, v174, v124
  v_mul_f32 v175, v175, v124
  v_mfma_f32_16x16x32_bf16 v[20:23], a[160:163], v[180:183], v[20:23]
  v_cvt_pk_bf16_f32 v172, v172, v172
  v_cvt_pk_bf16_f32 v173, v173, v173
  v_mfma_f32_16x16x32_bf16 v[24:27], a[160:163], v[188:191], v[24:27]
  buffer_load_dwordx4 v[148:151], v112, s[24:27], s30 offen offset:1024 sc1
  v_mfma_f32_16x16x32_bf16 v[24:27], v[236:239], v[192:195], v[24:27]
  v_cvt_pk_bf16_f32 v174, v174, v174
  v_cvt_pk_bf16_f32 v175, v175, v175
  v_mfma_f32_16x16x32_bf16 v[28:31], v[236:239], v[200:203], v[28:31]
  v_lshlrev_b32 v172, 16, v172
  v_lshlrev_b32 v173, 16, v173
  v_mfma_f32_16x16x32_bf16 v[28:31], a[160:163], v[196:199], v[28:31]
  v_lshlrev_b32 v174, 16, v174
  v_lshlrev_b32 v175, 16, v175
  s_waitcnt lgkmcnt(1)
  v_mfma_f32_16x16x32_bf16 v[32:35], a[164:167], a[208:211], v[32:35]
  ds_read_b128 v[152:155], v122 offset:3072
  v_add_f32 v106, v106, v172
  v_mfma_f32_16x16x32_bf16 v[32:35], v[248:251], v[176:179], v[32:35]
  buffer_load_dwordx4 a[180:183], v113, s[24:27], s30 offen offset:0 sc1
  v_mfma_f32_16x16x32_bf16 v[36:39], v[248:251], v[184:187], v[36:39]
  v_add_f32 v107, v107, v173
  v_add_f32 v108, v108, v174
  v_mfma_f32_16x16x32_bf16 v[36:39], a[164:167], v[180:183], v[36:39]
  v_add_f32 v109, v109, v175
  v_cvt_pk_bf16_f32 v106, v106, v106
  v_mfma_f32_16x16x32_bf16 v[40:43], a[164:167], v[188:191], v[40:43]
  buffer_load_dwordx4 a[184:187], v113, s[24:27], s30 offen offset:1024 sc1
  v_mfma_f32_16x16x32_bf16 v[40:43], v[248:251], v[192:195], v[40:43]
  v_cvt_pk_bf16_f32 v107, v107, v107
  v_cvt_pk_bf16_f32 v108, v108, v108
  v_mfma_f32_16x16x32_bf16 v[44:47], v[248:251], v[200:203], v[44:47]
  v_cvt_pk_bf16_f32 v109, v109, v109
  v_lshlrev_b32 v106, 16, v106
  v_mfma_f32_16x16x32_bf16 v[44:47], a[164:167], v[196:199], v[44:47]
  v_lshlrev_b32 v107, 16, v107
  v_lshlrev_b32 v108, 16, v108
  s_waitcnt lgkmcnt(1)
  v_mfma_f32_16x16x32_bf16 v[48:51], a[168:171], a[208:211], v[48:51]
  ds_read_b128 a[188:191], v122 offset:16384
  ds_read_b128 a[192:195], v122 offset:33792
  s_mov_b32 s30, s37
  v_mfma_f32_16x16x32_bf16 v[48:51], v[140:143], v[176:179], v[48:51]
  buffer_load_dwordx4 a[196:199], v110, s[24:27], s30 offen offset:0 sc1
  v_mfma_f32_16x16x32_bf16 v[52:55], v[140:143], v[184:187], v[52:55]
  v_lshlrev_b32 v109, 16, v109
  v_mul_f32 v129, 0xbfb8aa3b, v106
  v_mfma_f32_16x16x32_bf16 v[52:55], a[168:171], v[180:183], v[52:55]
  v_mul_f32 v130, 0xbfb8aa3b, v107
  v_mul_f32 v131, 0xbfb8aa3b, v108
  v_mfma_f32_16x16x32_bf16 v[56:59], a[168:171], v[188:191], v[56:59]
  buffer_load_dwordx4 a[200:203], v110, s[24:27], s30 offen offset:1024 sc1
  v_mfma_f32_16x16x32_bf16 v[56:59], v[140:143], v[192:195], v[56:59]
  v_mul_f32 v132, 0xbfb8aa3b, v109
  v_exp_f32 v129, v129
  v_mfma_f32_16x16x32_bf16 v[60:63], v[140:143], v[200:203], v[60:63]
  v_exp_f32 v130, v130
  v_mfma_f32_16x16x32_bf16 v[60:63], a[168:171], v[196:199], v[60:63]
  v_exp_f32 v131, v131
  s_waitcnt lgkmcnt(2)
  v_mfma_f32_16x16x32_bf16 v[64:67], a[172:175], a[208:211], v[64:67]
  ds_read_b128 a[204:207], v122 offset:17408
  ds_read_b128 v[236:239], v122 offset:34816
  v_mfma_f32_16x16x32_bf16 v[64:67], v[152:155], v[176:179], v[64:67]
  v_exp_f32 v132, v132
  v_mfma_f32_16x16x32_bf16 v[68:71], v[152:155], v[184:187], v[68:71]
  v_add_f32 v129, 1.0, v129
  v_add_f32 v130, 1.0, v130
  v_mfma_f32_16x16x32_bf16 v[68:71], a[172:175], v[180:183], v[68:71]
  v_add_f32 v131, 1.0, v131
  v_add_f32 v132, 1.0, v132
  v_mfma_f32_16x16x32_bf16 v[72:75], a[172:175], v[188:191], v[72:75]
  v_rcp_f32 v129, v129
  v_mfma_f32_16x16x32_bf16 v[72:75], v[152:155], v[192:195], v[72:75]
  v_rcp_f32 v130, v130
  v_mfma_f32_16x16x32_bf16 v[76:79], v[152:155], v[200:203], v[76:79]
  v_rcp_f32 v131, v131
  v_mfma_f32_16x16x32_bf16 v[76:79], a[172:175], v[196:199], v[76:79]
  v_rcp_f32 v132, v132
  s_waitcnt vmcnt(10) lgkmcnt(2)
  v_mfma_f32_16x16x32_bf16 v[0:3], a[188:191], v[204:207], v[0:3]
  ds_read_b128 v[248:251], v122 offset:18432
  ds_read_b128 v[140:143], v122 offset:35840
  v_mfma_f32_16x16x32_bf16 v[0:3], a[192:195], v[208:211], v[0:3]
  buffer_load_dwordx4 v[152:155], v111, s[24:27], s30 offen offset:0 sc1
  v_mfma_f32_16x16x32_bf16 v[4:7], a[192:195], v[216:219], v[4:7]
  v_mul_f32 v106, v106, v129
  v_mul_f32 v107, v107, v130
  v_mfma_f32_16x16x32_bf16 v[4:7], a[188:191], v[212:215], v[4:7]
  v_mul_f32 v108, v108, v131
  v_mul_f32 v109, v109, v132
  v_mfma_f32_16x16x32_bf16 v[8:11], a[188:191], v[220:223], v[8:11]
  buffer_load_dwordx4 a[208:211], v111, s[24:27], s30 offen offset:1024 sc1
  v_mfma_f32_16x16x32_bf16 v[8:11], a[192:195], v[224:227], v[8:11]
  v_cvt_pk_bf16_f32 v106, v106, v106
  v_cvt_pk_bf16_f32 v107, v107, v107
  v_mfma_f32_16x16x32_bf16 v[12:15], a[192:195], v[232:235], v[12:15]
  v_cvt_pk_bf16_f32 v108, v108, v108
  v_cvt_pk_bf16_f32 v109, v109, v109
  v_mfma_f32_16x16x32_bf16 v[12:15], a[188:191], v[228:231], v[12:15]
  v_lshlrev_b32 v106, 16, v106
  v_lshlrev_b32 v107, 16, v107
  s_waitcnt lgkmcnt(2)
  v_mfma_f32_16x16x32_bf16 v[16:19], a[204:207], v[204:207], v[16:19]
  ds_read_b128 v[176:179], v122 offset:19456
  ds_read_b128 v[180:183], v135 offset:0
  v_mfma_f32_16x16x32_bf16 v[16:19], v[236:239], v[208:211], v[16:19]
  buffer_load_dwordx4 v[184:187], v112, s[24:27], s30 offen offset:0 sc1
  v_mfma_f32_16x16x32_bf16 v[20:23], v[236:239], v[216:219], v[20:23]
  v_lshlrev_b32 v108, 16, v108
  v_lshlrev_b32 v109, 16, v109
  v_mfma_f32_16x16x32_bf16 v[20:23], a[204:207], v[212:215], v[20:23]
  v_lshlrev_b32 v156, 16, v80
  v_and_b32 v157, s34, v80
  v_mfma_f32_16x16x32_bf16 v[24:27], a[204:207], v[220:223], v[24:27]
  buffer_load_dwordx4 v[188:191], v112, s[24:27], s30 offen offset:1024 sc1
  v_mfma_f32_16x16x32_bf16 v[24:27], v[236:239], v[224:227], v[24:27]
  v_lshlrev_b32 v158, 16, v81
  v_and_b32 v159, s34, v81
  v_mfma_f32_16x16x32_bf16 v[28:31], v[236:239], v[232:235], v[28:31]
  v_lshlrev_b32 v160, 16, v82
  v_and_b32 v161, s34, v82
  v_mfma_f32_16x16x32_bf16 v[28:31], a[204:207], v[228:231], v[28:31]
  v_lshlrev_b32 v162, 16, v83
  v_and_b32 v163, s34, v83
  s_waitcnt lgkmcnt(2)
  v_mfma_f32_16x16x32_bf16 v[32:35], v[248:251], v[204:207], v[32:35]
  ds_read_b128 v[192:195], v122 offset:32768
  ds_read_b128 v[196:199], v135 offset:1024
  v_mfma_f32_16x16x32_bf16 v[32:35], v[140:143], v[208:211], v[32:35]
  buffer_load_dwordx4 v[200:203], v113, s[24:27], s30 offen offset:0 sc1
  v_mfma_f32_16x16x32_bf16 v[36:39], v[140:143], v[216:219], v[36:39]
  v_lshlrev_b32 v164, 16, v84
  v_and_b32 v165, s34, v84
  v_mfma_f32_16x16x32_bf16 v[36:39], v[248:251], v[212:215], v[36:39]
  v_lshlrev_b32 v166, 16, v85
  v_and_b32 v167, s34, v85
  v_mfma_f32_16x16x32_bf16 v[40:43], v[248:251], v[220:223], v[40:43]
  buffer_load_dwordx4 a[188:191], v113, s[24:27], s30 offen offset:1024 sc1
  v_mfma_f32_16x16x32_bf16 v[40:43], v[140:143], v[224:227], v[40:43]
  v_lshlrev_b32 v168, 16, v86
  v_and_b32 v169, s34, v86
  v_mfma_f32_16x16x32_bf16 v[44:47], v[140:143], v[232:235], v[44:47]
  v_lshlrev_b32 v170, 16, v87
  v_and_b32 v171, s34, v87
  v_mfma_f32_16x16x32_bf16 v[44:47], v[248:251], v[228:231], v[44:47]
  v_lshlrev_b32 v172, 16, v88
  v_and_b32 v173, s34, v88
  s_waitcnt lgkmcnt(2)
  v_mfma_f32_16x16x32_bf16 v[48:51], v[176:179], v[204:207], v[48:51]
  ds_read_b128 a[192:195], v135 offset:2048
  ds_read_b128 a[204:207], v135 offset:19456
  s_add_u32 s30, s30, 8192
  v_mfma_f32_16x16x32_bf16 v[48:51], v[180:183], v[208:211], v[48:51]
  buffer_load_dwordx4 v[236:239], v110, s[24:27], s30 offen offset:0 sc1
  v_mfma_f32_16x16x32_bf16 v[52:55], v[180:183], v[216:219], v[52:55]
  v_lshlrev_b32 v174, 16, v89
  v_and_b32 v175, s34, v89
  v_mfma_f32_16x16x32_bf16 v[52:55], v[176:179], v[212:215], v[52:55]
  s_sub_u32 s41, s3, 1
  s_and_b32 s41, s41, 3
  s_lshl_b32 s41, s41, 12
  v_add_u32 v80, s41, v114
  v_mfma_f32_16x16x32_bf16 v[56:59], v[176:179], v[220:223], v[56:59]
  s_sub_u32 s41, s3, 2
  s_and_b32 s41, s41, 3
  s_lshl_b32 s41, s41, 12
  v_add_u32 v81, s41, v114
  v_mfma_f32_16x16x32_bf16 v[56:59], v[180:183], v[224:227], v[56:59]
  s_sub_u32 s41, s3, 3
  s_and_b32 s41, s41, 3
  s_lshl_b32 s41, s41, 12
  v_add_u32 v82, s41, v114
  v_bfe_u32 v129, v114, 8, 1
  v_mfma_f32_16x16x32_bf16 v[60:63], v[180:183], v[232:235], v[60:63]
  v_mul_u32_u24 v129, 24, v129
  v_add_u32 v83, v117, v129
  v_mfma_f32_16x16x32_bf16 v[60:63], v[176:179], v[228:231], v[60:63]
  s_waitcnt lgkmcnt(2)
  v_mfma_f32_16x16x32_bf16 v[64:67], v[192:195], v[204:207], v[64:67]
  ds_read_b128 v[248:251], v135 offset:3072
  ds_read_b128 v[140:143], v122 offset:49152
  v_mfma_f32_16x16x32_bf16 v[64:67], v[196:199], v[208:211], v[64:67]
  v_mfma_f32_16x16x32_bf16 v[68:71], v[196:199], v[216:219], v[68:71]
  v_mfma_f32_16x16x32_bf16 v[68:71], v[192:195], v[212:215], v[68:71]
  v_mfma_f32_16x16x32_bf16 v[72:75], v[192:195], v[220:223], v[72:75]
  v_mfma_f32_16x16x32_bf16 v[72:75], v[196:199], v[224:227], v[72:75]
  v_mfma_f32_16x16x32_bf16 v[76:79], v[196:199], v[232:235], v[76:79]
  v_mfma_f32_16x16x32_bf16 v[76:79], v[192:195], v[228:231], v[76:79]
  s_waitcnt vmcnt(9) lgkmcnt(2)
  v_mfma_f32_16x16x32_bf16 v[0:3], a[192:195], v[240:243], v[0:3]
  ds_read_b128 v[176:179], v135 offset:16384
  ds_read_b128 v[180:183], v122 offset:50176
  s_xor_b32 s38, s40, 1
  v_mfma_f32_16x16x32_bf16 v[0:3], a[204:207], v[244:247], v[0:3]
  buffer_load_dwordx4 v[192:195], v110, s[24:27], s30 offen offset:1024 sc1
  s_lshl_b32 s38, s38, 2
  s_add_u32 s38, s38, s3
  s_lshl_b32 s38, s38, 13
  v_mfma_f32_16x16x32_bf16 v[4:7], a[204:207], v[136:139], v[4:7]
  s_add_u32 s38, s38, 25165824
  s_add_u32 s39, s38, 4096
  v_lshrrev_b32 v125, 1, v114
  v_mfma_f32_16x16x32_bf16 v[4:7], a[192:195], v[252:255], v[4:7]
  v_mfma_f32_16x16x32_bf16 v[8:11], a[192:195], v[144:147], v[8:11]
  buffer_load_dwordx4 v[196:199], v111, s[24:27], s30 offen offset:0 sc1
  v_mfma_f32_16x16x32_bf16 v[8:11], a[204:207], v[148:151], v[8:11]
  v_mfma_f32_16x16x32_bf16 v[12:15], a[204:207], a[184:187], v[12:15]
  v_mfma_f32_16x16x32_bf16 v[12:15], a[192:195], a[180:183], v[12:15]
  s_waitcnt lgkmcnt(2)
  v_mfma_f32_16x16x32_bf16 v[16:19], v[248:251], v[240:243], v[16:19]
  ds_read_b128 v[204:207], v135 offset:17408
  ds_read_b128 v[208:211], v122 offset:51200
  v_mfma_f32_16x16x32_bf16 v[16:19], v[140:143], v[244:247], v[16:19]
  buffer_load_dwordx4 v[212:215], v111, s[24:27], s30 offen offset:1024 sc1
  v_mfma_f32_16x16x32_bf16 v[20:23], v[140:143], v[136:139], v[20:23]
  ds_write_b128 v118, v[4:7] offset:0
  ds_write_b128 v118, v[8:11] offset:5120
  v_mfma_f32_16x16x32_bf16 v[20:23], v[248:251], v[252:255], v[20:23]
  ds_write_b128 v118, v[12:15] offset:10240
  v_mfma_f32_16x16x32_bf16 v[24:27], v[248:251], v[144:147], v[24:27]
  buffer_load_dwordx4 v[216:219], v112, s[24:27], s30 offen offset:0 sc1
  v_mfma_f32_16x16x32_bf16 v[24:27], v[140:143], v[148:151], v[24:27]
  v_mfma_f32_16x16x32_bf16 v[28:31], v[140:143], a[184:187], v[28:31]
  v_mfma_f32_16x16x32_bf16 v[28:31], v[248:251], a[180:183], v[28:31]
  s_waitcnt lgkmcnt(5)
  v_mfma_f32_16x16x32_bf16 v[32:35], v[176:179], v[240:243], v[32:35]
  ds_read_b128 v[220:223], v135 offset:18432
  ds_read_b128 v[224:227], v122 offset:52224
  v_mfma_f32_16x16x32_bf16 v[32:35], v[180:183], v[244:247], v[32:35]
  buffer_load_dwordx4 v[228:231], v112, s[24:27], s30 offen offset:1024 sc1
  v_mfma_f32_16x16x32_bf16 v[36:39], v[180:183], v[136:139], v[36:39]
  ds_write_b128 v118, v[20:23] offset:1024
  ds_write_b128 v118, v[24:27] offset:6144
  v_mfma_f32_16x16x32_bf16 v[36:39], v[176:179], v[252:255], v[36:39]
  ds_write_b128 v118, v[28:31] offset:11264
  v_mfma_f32_16x16x32_bf16 v[40:43], v[176:179], v[144:147], v[40:43]
  buffer_load_dwordx4 v[232:235], v113, s[24:27], s30 offen offset:0 sc1
  v_mfma_f32_16x16x32_bf16 v[40:43], v[180:183], v[148:151], v[40:43]
  v_mfma_f32_16x16x32_bf16 v[44:47], v[180:183], a[184:187], v[44:47]
  v_mfma_f32_16x16x32_bf16 v[44:47], v[176:179], a[180:183], v[44:47]
  s_waitcnt lgkmcnt(8)
  v_mfma_f32_16x16x32_bf16 v[48:51], v[204:207], v[240:243], v[48:51]
  buffer_load_dwordx4 a[192:195], v113, s[24:27], s30 offen offset:1024 sc1
  v_mfma_f32_16x16x32_bf16 v[48:51], v[208:211], v[244:247], v[48:51]
  ds_write_b128 v118, v[36:39] offset:2048
  v_mfma_f32_16x16x32_bf16 v[52:55], v[208:211], v[136:139], v[52:55]
  ds_write_b128 v118, v[40:43] offset:7168
  v_mfma_f32_16x16x32_bf16 v[52:55], v[204:207], v[252:255], v[52:55]
  ds_write_b128 v118, v[44:47] offset:12288
  v_mfma_f32_16x16x32_bf16 v[56:59], v[204:207], v[144:147], v[56:59]
  s_add_u32 s30, s30, 8192
  buffer_load_dwordx4 a[204:207], v110, s[24:27], s30 offen offset:0 sc1
  v_mfma_f32_16x16x32_bf16 v[56:59], v[208:211], v[148:151], v[56:59]
  v_mfma_f32_16x16x32_bf16 v[60:63], v[208:211], a[184:187], v[60:63]
  v_mfma_f32_16x16x32_bf16 v[60:63], v[204:207], a[180:183], v[60:63]
  s_waitcnt lgkmcnt(6)
  v_mfma_f32_16x16x32_bf16 v[64:67], v[220:223], v[240:243], v[64:67]
  buffer_load_dwordx4 v[248:251], v110, s[24:27], s30 offen offset:1024 sc1
  v_mfma_f32_16x16x32_bf16 v[64:67], v[224:227], v[244:247], v[64:67]
  ds_write_b128 v118, v[52:55] offset:3072
  v_mfma_f32_16x16x32_bf16 v[68:71], v[224:227], v[136:139], v[68:71]
  ds_write_b128 v118, v[56:59] offset:8192
  v_mfma_f32_16x16x32_bf16 v[68:71], v[220:223], v[252:255], v[68:71]
  ds_write_b128 v118, v[60:63] offset:13312
  v_mfma_f32_16x16x32_bf16 v[72:75], v[220:223], v[144:147], v[72:75]
  buffer_load_dwordx4 v[140:143], v111, s[24:27], s30 offen offset:0 sc1
  v_mfma_f32_16x16x32_bf16 v[72:75], v[224:227], v[148:151], v[72:75]
  v_mfma_f32_16x16x32_bf16 v[76:79], v[224:227], a[184:187], v[76:79]
  v_mfma_f32_16x16x32_bf16 v[76:79], v[220:223], a[180:183], v[76:79]
  s_nop 1
  ds_write_b128 v118, v[68:71] offset:4096
  s_nop 2
  ds_write_b128 v118, v[72:75] offset:9216
  s_nop 0
  ds_write_b128 v118, v[76:79] offset:14336
  buffer_load_dwordx4 v[176:179], v111, s[24:27], s30 offen offset:1024 sc1
  buffer_load_dwordx4 v[180:183], v112, s[24:27], s30 offen offset:0 sc1
  buffer_load_dwordx4 v[204:207], v112, s[24:27], s30 offen offset:1024 sc1
  buffer_load_dwordx4 v[208:211], v113, s[24:27], s30 offen offset:0 sc1
  buffer_load_dwordx4 v[220:223], v113, s[24:27], s30 offen offset:1024 sc1
  s_add_u32 s30, s30, 8192
  buffer_load_dwordx4 v[224:227], v110, s[24:27], s30 offen offset:0 sc1
  buffer_load_dwordx4 v[240:243], v110, s[24:27], s30 offen offset:1024 sc1
  buffer_load_dwordx4 v[244:247], v111, s[24:27], s30 offen offset:0 sc1
  buffer_load_dwordx4 v[252:255], v111, s[24:27], s30 offen offset:1024 sc1
  buffer_load_dwordx4 v[136:139], v112, s[24:27], s30 offen offset:0 sc1
  buffer_load_dwordx4 v[144:147], v112, s[24:27], s30 offen offset:1024 sc1
  buffer_load_dwordx4 v[148:151], v113, s[24:27], s30 offen offset:0 sc1
  buffer_load_dwordx4 a[180:183], v113, s[24:27], s30 offen offset:1024 sc1
  s_add_u32 s30, s30, 8192
  buffer_load_dwordx4 a[184:187], v110, s[24:27], s30 offen offset:0 sc1
  s_waitcnt lgkmcnt(0)
  s_barrier
  ds_read_b128 v[4:7], v119 offset:0
  ds_read_b128 v[8:11], v120 offset:5120
  ds_read_b128 v[12:15], v121 offset:10240
  ds_read_b128 v[20:23], v119 offset:1024
  ds_read_b128 v[24:27], v120 offset:6144
  ds_read_b128 v[28:31], v121 offset:11264
  ds_read_b128 v[36:39], v119 offset:2048
  ds_read_b128 v[40:43], v120 offset:7168
  ds_read_b128 v[44:47], v121 offset:12288
  ds_read_b128 v[52:55], v119 offset:3072
  ds_read_b128 v[56:59], v120 offset:8192
  ds_read_b128 v[60:63], v121 offset:13312
  ds_read_b128 v[68:71], v119 offset:4096
  ds_read_b128 v[72:75], v120 offset:9216
  ds_read_b128 v[76:79], v121 offset:14336
  s_waitcnt lgkmcnt(12)
  v_add_f32 v4, v4, v8
  v_add_f32 v5, v5, v9
  v_add_f32 v6, v6, v10
  v_add_f32 v7, v7, v11
  v_add_f32 v0, v0, v12
  v_add_f32 v1, v1, v13
  v_add_f32 v2, v2, v14
  v_add_f32 v3, v3, v15
  v_add_f32 v0, v0, v4
  v_add_f32 v1, v1, v5
  v_add_f32 v2, v2, v6
  v_add_f32 v3, v3, v7
  v_cvt_pk_bf16_f32 v4, v0, v1
  v_cvt_pk_bf16_f32 v5, v2, v3
  buffer_store_dwordx2 v[4:5], v125, s[24:27], s38 offen offset:0 sc1
  s_waitcnt vmcnt(26)
  v_mfma_f32_16x16x32_bf16 v[0:3], a[212:215], a[196:199], 0
  s_waitcnt lgkmcnt(9)
  v_add_f32 v20, v20, v24
  v_add_f32 v21, v21, v25
  v_mfma_f32_16x16x32_bf16 v[0:3], a[232:235], a[200:203], v[0:3]
  v_add_f32 v22, v22, v26
  v_add_f32 v23, v23, v27
  v_mfma_f32_16x16x32_bf16 v[4:7], a[232:235], a[208:211], 0
  v_add_f32 v16, v16, v28
  v_add_f32 v17, v17, v29
  v_mfma_f32_16x16x32_bf16 v[4:7], a[212:215], v[152:155], v[4:7]
  v_add_f32 v18, v18, v30
  v_add_f32 v19, v19, v31
  v_mfma_f32_16x16x32_bf16 v[8:11], a[212:215], v[184:187], 0
  v_add_f32 v16, v16, v20
  v_add_f32 v17, v17, v21
  v_mfma_f32_16x16x32_bf16 v[8:11], a[232:235], v[188:191], v[8:11]
  v_add_f32 v18, v18, v22
  v_add_f32 v19, v19, v23
  v_mfma_f32_16x16x32_bf16 v[12:15], a[232:235], a[188:191], 0
  v_cvt_pk_bf16_f32 v20, v16, v17
  v_cvt_pk_bf16_f32 v21, v18, v19
  v_mfma_f32_16x16x32_bf16 v[12:15], a[212:215], v[200:203], v[12:15]
  buffer_store_dwordx2 v[20:21], v125, s[24:27], s38 offen offset:512 sc1
  s_waitcnt lgkmcnt(6)
  v_mfma_f32_16x16x32_bf16 v[16:19], a[216:219], a[196:199], 0
  buffer_load_dwordx4 a[212:215], v110, s[24:27], s30 offen offset:1024 sc1
  v_mfma_f32_16x16x32_bf16 v[16:19], a[236:239], a[200:203], v[16:19]
  v_add_f32 v36, v36, v40
  v_add_f32 v37, v37, v41
  v_mfma_f32_16x16x32_bf16 v[20:23], a[236:239], a[208:211], 0
  v_add_f32 v38, v38, v42
  v_add_f32 v39, v39, v43
  v_mfma_f32_16x16x32_bf16 v[20:23], a[216:219], v[152:155], v[20:23]
  v_add_f32 v32, v32, v44
  v_add_f32 v33, v33, v45
  v_mfma_f32_16x16x32_bf16 v[24:27], a[216:219], v[184:187], 0
  buffer_load_dwordx4 a[232:235], v111, s[24:27], s30 offen offset:0 sc1
  v_mfma_f32_16x16x32_bf16 v[24:27], a[236:239], v[188:191], v[24:27]
  v_add_f32 v34, v34, v46
  v_add_f32 v35, v35, v47
  v_mfma_f32_16x16x32_bf16 v[28:31], a[236:239], a[188:191], 0
  v_add_f32 v32, v32, v36
  v_add_f32 v33, v33, v37
  v_mfma_f32_16x16x32_bf16 v[28:31], a[216:219], v[200:203], v[28:31]
  v_add_f32 v34, v34, v38
  v_add_f32 v35, v35, v39
  v_cvt_pk_bf16_f32 v36, v32, v33
  v_cvt_pk_bf16_f32 v37, v34, v35
  buffer_store_dwordx2 v[36:37], v125, s[24:27], s38 offen offset:1024 sc1
  v_mfma_f32_16x16x32_bf16 v[32:35], a[220:223], a[196:199], 0
  buffer_load_dwordx4 a[216:219], v111, s[24:27], s30 offen offset:1024 sc1
  s_waitcnt lgkmcnt(3)
  v_mfma_f32_16x16x32_bf16 v[32:35], a[240:243], a[200:203], v[32:35]
  v_add_f32 v52, v52, v56
  v_add_f32 v53, v53, v57
  v_mfma_f32_16x16x32_bf16 v[36:39], a[240:243], a[208:211], 0
  v_add_f32 v54, v54, v58
  v_add_f32 v55, v55, v59
  v_mfma_f32_16x16x32_bf16 v[36:39], a[220:223], v[152:155], v[36:39]
  v_add_f32 v48, v48, v60
  v_add_f32 v49, v49, v61
  v_mfma_f32_16x16x32_bf16 v[40:43], a[220:223], v[184:187], 0
  buffer_load_dwordx4 a[236:239], v112, s[24:27], s30 offen offset:0 sc1
  v_mfma_f32_16x16x32_bf16 v[40:43], a[240:243], v[188:191], v[40:43]
  v_add_f32 v50, v50, v62
  v_add_f32 v51, v51, v63
  v_mfma_f32_16x16x32_bf16 v[44:47], a[240:243], a[188:191], 0
  v_add_f32 v48, v48, v52
  v_add_f32 v49, v49, v53
  v_mfma_f32_16x16x32_bf16 v[44:47], a[220:223], v[200:203], v[44:47]
  v_add_f32 v50, v50, v54
  v_add_f32 v51, v51, v55
  v_cvt_pk_bf16_f32 v52, v48, v49
  v_cvt_pk_bf16_f32 v53, v50, v51
  buffer_store_dwordx2 v[52:53], v125, s[24:27], s38 offen offset:1536 sc1
  v_mfma_f32_16x16x32_bf16 v[48:51], a[224:227], a[196:199], 0
  buffer_load_dwordx4 a[220:223], v112, s[24:27], s30 offen offset:1024 sc1
  s_waitcnt lgkmcnt(0)
  v_mfma_f32_16x16x32_bf16 v[48:51], a[244:247], a[200:203], v[48:51]
  v_add_f32 v68, v68, v72
  v_add_f32 v69, v69, v73
  v_mfma_f32_16x16x32_bf16 v[52:55], a[244:247], a[208:211], 0
  v_add_f32 v70, v70, v74
  v_add_f32 v71, v71, v75
  v_mfma_f32_16x16x32_bf16 v[52:55], a[224:227], v[152:155], v[52:55]
  v_add_f32 v64, v64, v76
  v_add_f32 v65, v65, v77
  v_mfma_f32_16x16x32_bf16 v[56:59], a[224:227], v[184:187], 0
  buffer_load_dwordx4 a[240:243], v113, s[24:27], s30 offen offset:0 sc1
  v_mfma_f32_16x16x32_bf16 v[56:59], a[244:247], v[188:191], v[56:59]
  v_add_f32 v66, v66, v78
  v_add_f32 v67, v67, v79
  v_mfma_f32_16x16x32_bf16 v[60:63], a[244:247], a[188:191], 0
  v_add_f32 v64, v64, v68
  v_add_f32 v65, v65, v69
  v_mfma_f32_16x16x32_bf16 v[60:63], a[224:227], v[200:203], v[60:63]
  v_add_f32 v66, v66, v70
  v_add_f32 v67, v67, v71
  v_cvt_pk_bf16_f32 v68, v64, v65
  v_cvt_pk_bf16_f32 v69, v66, v67
  buffer_store_dwordx2 v[68:69], v125, s[24:27], s38 offen offset:2048 sc1
  v_mfma_f32_16x16x32_bf16 v[64:67], a[228:231], a[196:199], 0
  buffer_load_dwordx4 a[224:227], v113, s[24:27], s30 offen offset:1024 sc1
  s_xor_b32 s38, s40, 1
  s_lshl_b32 s38, s38, 7
  s_add_u32 s38, s38, 2834432
  v_mfma_f32_16x16x32_bf16 v[64:67], a[248:251], a[200:203], v[64:67]
  v_mov_b32 v126, 1073741824
  v_writelane_b32 v126, s38, 0
  v_mfma_f32_16x16x32_bf16 v[68:71], a[248:251], a[208:211], 0
  v_mov_b32 v127, 1
  v_mfma_f32_16x16x32_bf16 v[68:71], a[228:231], v[152:155], v[68:71]
  s_xor_b32 s38, s38, 128
  v_mov_b32 v133, s38
  v_mov_b32 v134, 4
  v_mfma_f32_16x16x32_bf16 v[72:75], a[228:231], v[184:187], 0
  s_add_u32 s30, s30, 8192
  buffer_load_dwordx4 a[244:247], v110, s[24:27], s30 offen offset:0 sc1
  v_mfma_f32_16x16x32_bf16 v[72:75], a[248:251], v[188:191], v[72:75]
  v_mfma_f32_16x16x32_bf16 v[76:79], a[248:251], a[188:191], 0
  v_mfma_f32_16x16x32_bf16 v[76:79], a[228:231], v[200:203], v[76:79]
  s_waitcnt vmcnt(30)
  v_mfma_f32_16x16x32_bf16 v[0:3], a[252:255], v[236:239], v[0:3]
  buffer_load_dwordx4 a[228:231], v110, s[24:27], s30 offen offset:1024 sc1
  v_mfma_f32_16x16x32_bf16 v[0:3], a[144:147], v[192:195], v[0:3]
  v_mfma_f32_16x16x32_bf16 v[4:7], a[144:147], v[212:215], v[4:7]
  v_mfma_f32_16x16x32_bf16 v[4:7], a[252:255], v[196:199], v[4:7]
  v_mfma_f32_16x16x32_bf16 v[8:11], a[252:255], v[216:219], v[8:11]
  buffer_load_dwordx4 a[248:251], v111, s[24:27], s30 offen offset:0 sc1
  v_mfma_f32_16x16x32_bf16 v[8:11], a[144:147], v[228:231], v[8:11]
  v_mfma_f32_16x16x32_bf16 v[12:15], a[144:147], a[192:195], v[12:15]
  v_mfma_f32_16x16x32_bf16 v[12:15], a[252:255], v[232:235], v[12:15]
  v_mfma_f32_16x16x32_bf16 v[16:19], a[128:131], v[236:239], v[16:19]
  buffer_load_dwordx4 a[196:199], v111, s[24:27], s30 offen offset:1024 sc1
  v_mfma_f32_16x16x32_bf16 v[16:19], a[148:151], v[192:195], v[16:19]
  v_mfma_f32_16x16x32_bf16 v[20:23], a[148:151], v[212:215], v[20:23]
  v_mfma_f32_16x16x32_bf16 v[20:23], a[128:131], v[196:199], v[20:23]
  v_mfma_f32_16x16x32_bf16 v[24:27], a[128:131], v[216:219], v[24:27]
  buffer_load_dwordx4 a[200:203], v112, s[24:27], s30 offen offset:0 sc1
  v_mfma_f32_16x16x32_bf16 v[24:27], a[148:151], v[228:231], v[24:27]
  v_mfma_f32_16x16x32_bf16 v[28:31], a[148:151], a[192:195], v[28:31]
  v_mfma_f32_16x16x32_bf16 v[28:31], a[128:131], v[232:235], v[28:31]
  v_mfma_f32_16x16x32_bf16 v[32:35], a[132:135], v[236:239], v[32:35]
  buffer_load_dwordx4 a[208:211], v112, s[24:27], s30 offen offset:1024 sc1
  v_mfma_f32_16x16x32_bf16 v[32:35], a[152:155], v[192:195], v[32:35]
  v_mfma_f32_16x16x32_bf16 v[36:39], a[152:155], v[212:215], v[36:39]
  v_mfma_f32_16x16x32_bf16 v[36:39], a[132:135], v[196:199], v[36:39]
  v_mfma_f32_16x16x32_bf16 v[40:43], a[132:135], v[216:219], v[40:43]
  buffer_load_dwordx4 v[184:187], v113, s[24:27], s30 offen offset:0 sc1
  v_mfma_f32_16x16x32_bf16 v[40:43], a[152:155], v[228:231], v[40:43]
  v_mfma_f32_16x16x32_bf16 v[44:47], a[152:155], a[192:195], v[44:47]
  v_mfma_f32_16x16x32_bf16 v[44:47], a[132:135], v[232:235], v[44:47]
  v_mfma_f32_16x16x32_bf16 v[48:51], a[136:139], v[236:239], v[48:51]
  buffer_load_dwordx4 v[188:191], v113, s[24:27], s30 offen offset:1024 sc1
  v_mfma_f32_16x16x32_bf16 v[48:51], a[156:159], v[192:195], v[48:51]
  v_mfma_f32_16x16x32_bf16 v[52:55], a[156:159], v[212:215], v[52:55]
  v_mfma_f32_16x16x32_bf16 v[52:55], a[136:139], v[196:199], v[52:55]
  v_mfma_f32_16x16x32_bf16 v[56:59], a[136:139], v[216:219], v[56:59]
  s_add_u32 s30, s30, 8192
  buffer_load_dwordx4 v[200:203], v110, s[24:27], s30 offen offset:0 sc1
  v_mfma_f32_16x16x32_bf16 v[56:59], a[156:159], v[228:231], v[56:59]
  v_mfma_f32_16x16x32_bf16 v[60:63], a[156:159], a[192:195], v[60:63]
  v_mfma_f32_16x16x32_bf16 v[60:63], a[136:139], v[232:235], v[60:63]
  v_mfma_f32_16x16x32_bf16 v[64:67], a[140:143], v[236:239], v[64:67]
  buffer_load_dwordx4 a[188:191], v110, s[24:27], s30 offen offset:1024 sc1
  v_mfma_f32_16x16x32_bf16 v[64:67], a[0:3], v[192:195], v[64:67]
  v_mfma_f32_16x16x32_bf16 v[68:71], a[0:3], v[212:215], v[68:71]
  v_mfma_f32_16x16x32_bf16 v[68:71], a[140:143], v[196:199], v[68:71]
  v_mfma_f32_16x16x32_bf16 v[72:75], a[140:143], v[216:219], v[72:75]
  buffer_load_dwordx4 a[252:255], v111, s[24:27], s30 offen offset:0 sc1
  v_mfma_f32_16x16x32_bf16 v[72:75], a[0:3], v[228:231], v[72:75]
  v_mfma_f32_16x16x32_bf16 v[76:79], a[0:3], a[192:195], v[76:79]
  v_mfma_f32_16x16x32_bf16 v[76:79], a[140:143], v[232:235], v[76:79]
  s_waitcnt vmcnt(32)
  v_mfma_f32_16x16x32_bf16 v[0:3], a[4:7], a[204:207], v[0:3]
  buffer_load_dwordx4 a[144:147], v111, s[24:27], s30 offen offset:1024 sc1
  v_mfma_f32_16x16x32_bf16 v[0:3], a[24:27], v[248:251], v[0:3]
  v_mfma_f32_16x16x32_bf16 v[4:7], a[24:27], v[176:179], v[4:7]
  v_mfma_f32_16x16x32_bf16 v[4:7], a[4:7], v[140:143], v[4:7]
  v_mfma_f32_16x16x32_bf16 v[8:11], a[4:7], v[180:183], v[8:11]
  buffer_load_dwordx4 a[128:131], v112, s[24:27], s30 offen offset:0 sc1
  v_mfma_f32_16x16x32_bf16 v[8:11], a[24:27], v[204:207], v[8:11]
  v_mfma_f32_16x16x32_bf16 v[12:15], a[24:27], v[220:223], v[12:15]
  v_mfma_f32_16x16x32_bf16 v[12:15], a[4:7], v[208:211], v[12:15]
  v_mfma_f32_16x16x32_bf16 v[16:19], a[8:11], a[204:207], v[16:19]
  buffer_load_dwordx4 a[148:151], v112, s[24:27], s30 offen offset:1024 sc1
  v_mfma_f32_16x16x32_bf16 v[16:19], a[28:31], v[248:251], v[16:19]
  v_mfma_f32_16x16x32_bf16 v[20:23], a[28:31], v[176:179], v[20:23]
  v_mfma_f32_16x16x32_bf16 v[20:23], a[8:11], v[140:143], v[20:23]
  v_mfma_f32_16x16x32_bf16 v[24:27], a[8:11], v[180:183], v[24:27]
  buffer_load_dwordx4 a[132:135], v113, s[24:27], s30 offen offset:0 sc1
  v_mfma_f32_16x16x32_bf16 v[24:27], a[28:31], v[204:207], v[24:27]
  v_mfma_f32_16x16x32_bf16 v[28:31], a[28:31], v[220:223], v[28:31]
  v_mfma_f32_16x16x32_bf16 v[28:31], a[8:11], v[208:211], v[28:31]
  v_mfma_f32_16x16x32_bf16 v[32:35], a[12:15], a[204:207], v[32:35]
  buffer_load_dwordx4 a[152:155], v113, s[24:27], s30 offen offset:1024 sc1
  v_mfma_f32_16x16x32_bf16 v[32:35], a[32:35], v[248:251], v[32:35]
  v_mfma_f32_16x16x32_bf16 v[36:39], a[32:35], v[176:179], v[36:39]
  v_mfma_f32_16x16x32_bf16 v[36:39], a[12:15], v[140:143], v[36:39]
  v_mfma_f32_16x16x32_bf16 v[40:43], a[12:15], v[180:183], v[40:43]
  s_add_u32 s30, s30, 8192
  buffer_load_dwordx4 a[136:139], v110, s[24:27], s30 offen offset:0 sc1
  v_mfma_f32_16x16x32_bf16 v[40:43], a[32:35], v[204:207], v[40:43]
  v_mfma_f32_16x16x32_bf16 v[44:47], a[32:35], v[220:223], v[44:47]
  v_mfma_f32_16x16x32_bf16 v[44:47], a[12:15], v[208:211], v[44:47]
  v_mfma_f32_16x16x32_bf16 v[48:51], a[16:19], a[204:207], v[48:51]
  buffer_load_dwordx4 a[156:159], v110, s[24:27], s30 offen offset:1024 sc1
  v_mfma_f32_16x16x32_bf16 v[48:51], a[36:39], v[248:251], v[48:51]
  v_mfma_f32_16x16x32_bf16 v[52:55], a[36:39], v[176:179], v[52:55]
  v_mfma_f32_16x16x32_bf16 v[52:55], a[16:19], v[140:143], v[52:55]
  v_mfma_f32_16x16x32_bf16 v[56:59], a[16:19], v[180:183], v[56:59]
  buffer_load_dwordx4 a[140:143], v111, s[24:27], s30 offen offset:0 sc1
  v_mfma_f32_16x16x32_bf16 v[56:59], a[36:39], v[204:207], v[56:59]
  v_mfma_f32_16x16x32_bf16 v[60:63], a[36:39], v[220:223], v[60:63]
  v_mfma_f32_16x16x32_bf16 v[60:63], a[16:19], v[208:211], v[60:63]
  v_mfma_f32_16x16x32_bf16 v[64:67], a[20:23], a[204:207], v[64:67]
  buffer_load_dwordx4 a[0:3], v111, s[24:27], s30 offen offset:1024 sc1
  v_mfma_f32_16x16x32_bf16 v[64:67], a[40:43], v[248:251], v[64:67]
  v_mfma_f32_16x16x32_bf16 v[68:71], a[40:43], v[176:179], v[68:71]
  v_mfma_f32_16x16x32_bf16 v[68:71], a[20:23], v[140:143], v[68:71]
  v_mfma_f32_16x16x32_bf16 v[72:75], a[20:23], v[180:183], v[72:75]
  buffer_load_dwordx4 v[236:239], v112, s[24:27], s30 offen offset:0 sc1
  v_mfma_f32_16x16x32_bf16 v[72:75], a[40:43], v[204:207], v[72:75]
  v_mfma_f32_16x16x32_bf16 v[76:79], a[40:43], v[220:223], v[76:79]
  v_mfma_f32_16x16x32_bf16 v[76:79], a[20:23], v[208:211], v[76:79]
  s_waitcnt vmcnt(34)
  v_mfma_f32_16x16x32_bf16 v[0:3], a[44:47], v[224:227], v[0:3]
  buffer_load_dwordx4 v[192:195], v112, s[24:27], s30 offen offset:1024 sc1
  s_waitcnt vmcnt(23)
  v_mfma_f32_16x16x32_bf16 v[0:3], a[64:67], v[240:243], v[0:3]
  buffer_atomic_add v127, v126, s[24:27], 0 offen
  v_mfma_f32_16x16x32_bf16 v[4:7], a[64:67], v[252:255], v[4:7]
  v_mfma_f32_16x16x32_bf16 v[4:7], a[44:47], v[244:247], v[4:7]
  v_mfma_f32_16x16x32_bf16 v[8:11], a[44:47], v[136:139], v[8:11]
  buffer_load_dwordx4 v[196:199], v113, s[24:27], s30 offen offset:0 sc1
  v_mfma_f32_16x16x32_bf16 v[8:11], a[64:67], v[144:147], v[8:11]
  v_mfma_f32_16x16x32_bf16 v[12:15], a[64:67], a[180:183], v[12:15]
  v_mfma_f32_16x16x32_bf16 v[12:15], a[44:47], v[148:151], v[12:15]
  v_mfma_f32_16x16x32_bf16 v[16:19], a[48:51], v[224:227], v[16:19]
  buffer_load_dwordx4 v[212:215], v113, s[24:27], s30 offen offset:1024 sc1
  v_mfma_f32_16x16x32_bf16 v[16:19], a[68:71], v[240:243], v[16:19]
  v_mfma_f32_16x16x32_bf16 v[20:23], a[68:71], v[252:255], v[20:23]
  v_mfma_f32_16x16x32_bf16 v[20:23], a[48:51], v[244:247], v[20:23]
  v_mfma_f32_16x16x32_bf16 v[24:27], a[48:51], v[136:139], v[24:27]
  s_add_u32 s30, s30, 8192
  v_mfma_f32_16x16x32_bf16 v[24:27], a[68:71], v[144:147], v[24:27]
  v_mfma_f32_16x16x32_bf16 v[28:31], a[68:71], a[180:183], v[28:31]
  v_mfma_f32_16x16x32_bf16 v[28:31], a[48:51], v[148:151], v[28:31]
  v_mfma_f32_16x16x32_bf16 v[32:35], a[52:55], v[224:227], v[32:35]
  v_mfma_f32_16x16x32_bf16 v[32:35], a[72:75], v[240:243], v[32:35]
  v_mfma_f32_16x16x32_bf16 v[36:39], a[72:75], v[252:255], v[36:39]
  v_mfma_f32_16x16x32_bf16 v[36:39], a[52:55], v[244:247], v[36:39]
  v_mfma_f32_16x16x32_bf16 v[40:43], a[52:55], v[136:139], v[40:43]
  v_mfma_f32_16x16x32_bf16 v[40:43], a[72:75], v[144:147], v[40:43]
  v_mfma_f32_16x16x32_bf16 v[44:47], a[72:75], a[180:183], v[44:47]
  v_mfma_f32_16x16x32_bf16 v[44:47], a[52:55], v[148:151], v[44:47]
  v_mfma_f32_16x16x32_bf16 v[48:51], a[56:59], v[224:227], v[48:51]
  v_mfma_f32_16x16x32_bf16 v[48:51], a[76:79], v[240:243], v[48:51]
  v_mfma_f32_16x16x32_bf16 v[52:55], a[76:79], v[252:255], v[52:55]
  v_mfma_f32_16x16x32_bf16 v[52:55], a[56:59], v[244:247], v[52:55]
  v_mfma_f32_16x16x32_bf16 v[56:59], a[56:59], v[136:139], v[56:59]
  v_mfma_f32_16x16x32_bf16 v[56:59], a[76:79], v[144:147], v[56:59]
  v_mfma_f32_16x16x32_bf16 v[60:63], a[76:79], a[180:183], v[60:63]
  v_mfma_f32_16x16x32_bf16 v[60:63], a[56:59], v[148:151], v[60:63]
  v_mfma_f32_16x16x32_bf16 v[64:67], a[60:63], v[224:227], v[64:67]
  v_mfma_f32_16x16x32_bf16 v[64:67], a[80:83], v[240:243], v[64:67]
  v_mfma_f32_16x16x32_bf16 v[68:71], a[80:83], v[252:255], v[68:71]
  v_mfma_f32_16x16x32_bf16 v[68:71], a[60:63], v[244:247], v[68:71]
  v_mfma_f32_16x16x32_bf16 v[72:75], a[60:63], v[136:139], v[72:75]
  v_mfma_f32_16x16x32_bf16 v[72:75], a[80:83], v[144:147], v[72:75]
  v_mfma_f32_16x16x32_bf16 v[76:79], a[80:83], a[180:183], v[76:79]
  v_mfma_f32_16x16x32_bf16 v[76:79], a[60:63], v[148:151], v[76:79]
  s_waitcnt vmcnt(25)
  v_mfma_f32_16x16x32_bf16 v[0:3], a[84:87], a[184:187], v[0:3]
  v_mfma_f32_16x16x32_bf16 v[0:3], a[104:107], a[212:215], v[0:3]
  v_mfma_f32_16x16x32_bf16 v[4:7], a[104:107], a[216:219], v[4:7]
  v_mfma_f32_16x16x32_bf16 v[4:7], a[84:87], a[232:235], v[4:7]
  v_mfma_f32_16x16x32_bf16 v[8:11], a[84:87], a[236:239], v[8:11]
  v_mfma_f32_16x16x32_bf16 v[8:11], a[104:107], a[220:223], v[8:11]
  v_mfma_f32_16x16x32_bf16 v[12:15], a[104:107], a[224:227], v[12:15]
  v_mfma_f32_16x16x32_bf16 v[12:15], a[84:87], a[240:243], v[12:15]
  v_mfma_f32_16x16x32_bf16 v[16:19], a[88:91], a[184:187], v[16:19]
  v_mfma_f32_16x16x32_bf16 v[16:19], a[108:111], a[212:215], v[16:19]
  v_mfma_f32_16x16x32_bf16 v[20:23], a[108:111], a[216:219], v[20:23]
  v_mfma_f32_16x16x32_bf16 v[20:23], a[88:91], a[232:235], v[20:23]
  v_mfma_f32_16x16x32_bf16 v[24:27], a[88:91], a[236:239], v[24:27]
  v_mfma_f32_16x16x32_bf16 v[24:27], a[108:111], a[220:223], v[24:27]
  v_mfma_f32_16x16x32_bf16 v[28:31], a[108:111], a[224:227], v[28:31]
  v_mfma_f32_16x16x32_bf16 v[28:31], a[88:91], a[240:243], v[28:31]
  v_mfma_f32_16x16x32_bf16 v[32:35], a[92:95], a[184:187], v[32:35]
  v_mfma_f32_16x16x32_bf16 v[32:35], a[112:115], a[212:215], v[32:35]
  v_mfma_f32_16x16x32_bf16 v[36:39], a[112:115], a[216:219], v[36:39]
  v_mfma_f32_16x16x32_bf16 v[36:39], a[92:95], a[232:235], v[36:39]
  v_mfma_f32_16x16x32_bf16 v[40:43], a[92:95], a[236:239], v[40:43]
  v_mfma_f32_16x16x32_bf16 v[40:43], a[112:115], a[220:223], v[40:43]
  v_mfma_f32_16x16x32_bf16 v[44:47], a[112:115], a[224:227], v[44:47]
  v_mfma_f32_16x16x32_bf16 v[44:47], a[92:95], a[240:243], v[44:47]
  v_mfma_f32_16x16x32_bf16 v[48:51], a[96:99], a[184:187], v[48:51]
  v_mfma_f32_16x16x32_bf16 v[48:51], a[116:119], a[212:215], v[48:51]
  v_mfma_f32_16x16x32_bf16 v[52:55], a[116:119], a[216:219], v[52:55]
  v_mfma_f32_16x16x32_bf16 v[52:55], a[96:99], a[232:235], v[52:55]
  v_mfma_f32_16x16x32_bf16 v[56:59], a[96:99], a[236:239], v[56:59]
  v_mfma_f32_16x16x32_bf16 v[56:59], a[116:119], a[220:223], v[56:59]
  v_mfma_f32_16x16x32_bf16 v[60:63], a[116:119], a[224:227], v[60:63]
  v_mfma_f32_16x16x32_bf16 v[60:63], a[96:99], a[240:243], v[60:63]
  v_mfma_f32_16x16x32_bf16 v[64:67], a[100:103], a[184:187], v[64:67]
  ds_read_b128 v[216:219], v122 offset:0
  v_mfma_f32_16x16x32_bf16 v[64:67], a[120:123], a[212:215], v[64:67]
  v_mfma_f32_16x16x32_bf16 v[68:71], a[120:123], a[216:219], v[68:71]
  v_mfma_f32_16x16x32_bf16 v[68:71], a[100:103], a[232:235], v[68:71]
  v_mfma_f32_16x16x32_bf16 v[72:75], a[100:103], a[236:239], v[72:75]
  v_mfma_f32_16x16x32_bf16 v[72:75], a[120:123], a[220:223], v[72:75]
  v_mfma_f32_16x16x32_bf16 v[76:79], a[120:123], a[224:227], v[76:79]
  v_mfma_f32_16x16x32_bf16 v[76:79], a[100:103], a[240:243], v[76:79]
  s_waitcnt vmcnt(17)
  v_mfma_f32_16x16x32_bf16 v[0:3], a[124:127], a[244:247], v[0:3]
  ds_read_b128 v[228:231], v122 offset:1024
  buffer_load_dword v128, v133, s[24:27], 0 offen sc1
  s_xor_b32 s38, s40, 0
  s_lshl_b32 s38, s38, 2
  s_add_u32 s38, s38, s3
  v_mfma_f32_16x16x32_bf16 v[0:3], a[176:179], a[228:231], v[0:3]
  s_lshl_b32 s38, s38, 13
  s_add_u32 s38, s38, 25165824
  s_add_u32 s39, s38, 4096
  v_mfma_f32_16x16x32_bf16 v[4:7], a[176:179], a[196:199], v[4:7]
  v_mfma_f32_16x16x32_bf16 v[4:7], a[124:127], a[248:251], v[4:7]
  v_mfma_f32_16x16x32_bf16 v[8:11], a[124:127], a[200:203], v[8:11]
  v_mfma_f32_16x16x32_bf16 v[8:11], a[176:179], a[208:211], v[8:11]
  v_mfma_f32_16x16x32_bf16 v[12:15], a[176:179], v[188:191], v[12:15]
  v_mfma_f32_16x16x32_bf16 v[12:15], a[124:127], v[184:187], v[12:15]
  s_waitcnt lgkmcnt(1)
  v_mfma_f32_16x16x32_bf16 v[16:19], a[160:163], a[244:247], v[16:19]
  ds_read_b128 v[232:235], v122 offset:2048
  v_mfma_f32_16x16x32_bf16 v[16:19], v[216:219], a[228:231], v[16:19]
  v_mfma_f32_16x16x32_bf16 v[20:23], v[216:219], a[196:199], v[20:23]
  v_mfma_f32_16x16x32_bf16 v[20:23], a[160:163], a[248:251], v[20:23]
  v_mfma_f32_16x16x32_bf16 v[24:27], a[160:163], a[200:203], v[24:27]
  v_mfma_f32_16x16x32_bf16 v[24:27], v[216:219], a[208:211], v[24:27]
  v_mfma_f32_16x16x32_bf16 v[28:31], v[216:219], v[188:191], v[28:31]
  v_mfma_f32_16x16x32_bf16 v[28:31], a[160:163], v[184:187], v[28:31]
  s_waitcnt lgkmcnt(1)
  v_mfma_f32_16x16x32_bf16 v[32:35], a[164:167], a[244:247], v[32:35]
  ds_read_b128 a[192:195], v122 offset:3072
  v_mfma_f32_16x16x32_bf16 v[32:35], v[228:231], a[228:231], v[32:35]
  v_mfma_f32_16x16x32_bf16 v[36:39], v[228:231], a[196:199], v[36:39]
  v_mfma_f32_16x16x32_bf16 v[36:39], a[164:167], a[248:251], v[36:39]
  v_mfma_f32_16x16x32_bf16 v[40:43], a[164:167], a[200:203], v[40:43]
  v_mfma_f32_16x16x32_bf16 v[40:43], v[228:231], a[208:211], v[40:43]
  v_mfma_f32_16x16x32_bf16 v[44:47], v[228:231], v[188:191], v[44:47]
  v_mfma_f32_16x16x32_bf16 v[44:47], a[164:167], v[184:187], v[44:47]
  s_waitcnt lgkmcnt(1)
  v_mfma_f32_16x16x32_bf16 v[48:51], a[168:171], a[244:247], v[48:51]
  ds_read_b128 a[4:7], v122 offset:16384
  ds_read_b128 a[24:27], v122 offset:33792
  v_mfma_f32_16x16x32_bf16 v[48:51], v[232:235], a[228:231], v[48:51]
  v_mfma_f32_16x16x32_bf16 v[52:55], v[232:235], a[196:199], v[52:55]
  v_mfma_f32_16x16x32_bf16 v[52:55], a[168:171], a[248:251], v[52:55]
  v_mfma_f32_16x16x32_bf16 v[56:59], a[168:171], a[200:203], v[56:59]
  v_mfma_f32_16x16x32_bf16 v[56:59], v[232:235], a[208:211], v[56:59]
  v_mfma_f32_16x16x32_bf16 v[60:63], v[232:235], v[188:191], v[60:63]
  v_mfma_f32_16x16x32_bf16 v[60:63], a[168:171], v[184:187], v[60:63]
  s_waitcnt lgkmcnt(2)
  v_mfma_f32_16x16x32_bf16 v[64:67], a[172:175], a[244:247], v[64:67]
  ds_read_b128 a[8:11], v122 offset:17408
  ds_read_b128 a[28:31], v122 offset:34816
  v_mfma_f32_16x16x32_bf16 v[64:67], a[192:195], a[228:231], v[64:67]
  v_mfma_f32_16x16x32_bf16 v[68:71], a[192:195], a[196:199], v[68:71]
  v_mfma_f32_16x16x32_bf16 v[68:71], a[172:175], a[248:251], v[68:71]
  v_mfma_f32_16x16x32_bf16 v[72:75], a[172:175], a[200:203], v[72:75]
  v_mfma_f32_16x16x32_bf16 v[72:75], a[192:195], a[208:211], v[72:75]
  v_mfma_f32_16x16x32_bf16 v[76:79], a[192:195], v[188:191], v[76:79]
  v_mfma_f32_16x16x32_bf16 v[76:79], a[172:175], v[184:187], v[76:79]
  s_waitcnt vmcnt(10) lgkmcnt(2)
  v_mfma_f32_16x16x32_bf16 v[0:3], a[4:7], v[200:203], v[0:3]
  ds_read_b128 a[12:15], v122 offset:18432
  ds_read_b128 a[32:35], v122 offset:35840
  v_mfma_f32_16x16x32_bf16 v[0:3], a[24:27], a[188:191], v[0:3]
  v_mfma_f32_16x16x32_bf16 v[4:7], a[24:27], a[144:147], v[4:7]
  v_mfma_f32_16x16x32_bf16 v[4:7], a[4:7], a[252:255], v[4:7]
  v_mfma_f32_16x16x32_bf16 v[8:11], a[4:7], a[128:131], v[8:11]
  v_mfma_f32_16x16x32_bf16 v[8:11], a[24:27], a[148:151], v[8:11]
  v_mfma_f32_16x16x32_bf16 v[12:15], a[24:27], a[152:155], v[12:15]
  v_mfma_f32_16x16x32_bf16 v[12:15], a[4:7], a[132:135], v[12:15]
  s_waitcnt lgkmcnt(2)
  v_mfma_f32_16x16x32_bf16 v[16:19], a[8:11], v[200:203], v[16:19]
  ds_read_b128 a[16:19], v122 offset:19456
  ds_read_b128 a[36:39], v135 offset:0
  v_mfma_f32_16x16x32_bf16 v[16:19], a[28:31], a[188:191], v[16:19]
  v_mfma_f32_16x16x32_bf16 v[20:23], a[28:31], a[144:147], v[20:23]
  v_mfma_f32_16x16x32_bf16 v[20:23], a[8:11], a[252:255], v[20:23]
  v_mfma_f32_16x16x32_bf16 v[24:27], a[8:11], a[128:131], v[24:27]
  v_mfma_f32_16x16x32_bf16 v[24:27], a[28:31], a[148:151], v[24:27]
  v_mfma_f32_16x16x32_bf16 v[28:31], a[28:31], a[152:155], v[28:31]
  v_mfma_f32_16x16x32_bf16 v[28:31], a[8:11], a[132:135], v[28:31]
  s_waitcnt lgkmcnt(2)
  v_mfma_f32_16x16x32_bf16 v[32:35], a[12:15], v[200:203], v[32:35]
  ds_read_b128 a[20:23], v122 offset:32768
  ds_read_b128 a[40:43], v135 offset:1024
  v_mfma_f32_16x16x32_bf16 v[32:35], a[32:35], a[188:191], v[32:35]
  v_mfma_f32_16x16x32_bf16 v[36:39], a[32:35], a[144:147], v[36:39]
  v_mfma_f32_16x16x32_bf16 v[36:39], a[12:15], a[252:255], v[36:39]
  v_mfma_f32_16x16x32_bf16 v[40:43], a[12:15], a[128:131], v[40:43]
  v_mfma_f32_16x16x32_bf16 v[40:43], a[32:35], a[148:151], v[40:43]
  v_mfma_f32_16x16x32_bf16 v[44:47], a[32:35], a[152:155], v[44:47]
  v_mfma_f32_16x16x32_bf16 v[44:47], a[12:15], a[132:135], v[44:47]
  s_waitcnt lgkmcnt(2)
  v_mfma_f32_16x16x32_bf16 v[48:51], a[16:19], v[200:203], v[48:51]
  ds_read_b128 a[204:207], v135 offset:2048
  ds_read_b128 v[248:251], v135 offset:19456
  v_mfma_f32_16x16x32_bf16 v[48:51], a[36:39], a[188:191], v[48:51]
  v_mfma_f32_16x16x32_bf16 v[52:55], a[36:39], a[144:147], v[52:55]
  v_mfma_f32_16x16x32_bf16 v[52:55], a[16:19], a[252:255], v[52:55]
  v_mfma_f32_16x16x32_bf16 v[56:59], a[16:19], a[128:131], v[56:59]
  v_mfma_f32_16x16x32_bf16 v[56:59], a[36:39], a[148:151], v[56:59]
  v_mfma_f32_16x16x32_bf16 v[60:63], a[36:39], a[152:155], v[60:63]
  v_mfma_f32_16x16x32_bf16 v[60:63], a[16:19], a[132:135], v[60:63]
  s_waitcnt lgkmcnt(2)
  v_mfma_f32_16x16x32_bf16 v[64:67], a[20:23], v[200:203], v[64:67]
  ds_read_b128 v[176:179], v135 offset:3072
  ds_read_b128 v[180:183], v122 offset:49152
  v_mfma_f32_16x16x32_bf16 v[64:67], a[40:43], a[188:191], v[64:67]
  v_mfma_f32_16x16x32_bf16 v[68:71], a[40:43], a[144:147], v[68:71]
  v_mfma_f32_16x16x32_bf16 v[68:71], a[20:23], a[252:255], v[68:71]
  v_mfma_f32_16x16x32_bf16 v[72:75], a[20:23], a[128:131], v[72:75]
  v_mfma_f32_16x16x32_bf16 v[72:75], a[40:43], a[148:151], v[72:75]
  v_mfma_f32_16x16x32_bf16 v[76:79], a[40:43], a[152:155], v[76:79]
  v_mfma_f32_16x16x32_bf16 v[76:79], a[20:23], a[132:135], v[76:79]
  s_waitcnt vmcnt(0)
  v_cmp_lt_u32 vcc, v128, v134
  s_nop 0
  s_cbranch_vccz tail_partner
  s_mov_b32 s35, 32768
tail_spin2:
  s_sleep 2
  buffer_load_dword v128, v133, s[24:27], 0 offen sc1
  s_waitcnt vmcnt(0)
  v_cmp_lt_u32 vcc, v128, v134
  s_nop 0
  s_cbranch_vccz tail_partner
  s_sub_u32 s35, s35, 1
  s_cmp_lg_u32 s35, 0
  s_cbranch_scc1 tail_spin2
tail_partner:
  s_waitcnt lgkmcnt(2)
  v_mfma_f32_16x16x32_bf16 v[0:3], a[204:207], a[136:139], v[0:3]
  ds_read_b128 v[204:207], v135 offset:16384
  ds_read_b128 v[208:211], v122 offset:50176
  v_mfma_f32_16x16x32_bf16 v[0:3], v[248:251], a[156:159], v[0:3]
  buffer_load_dwordx2 v[138:139], v125, s[24:27], s38 offen offset:0 sc1
  v_mfma_f32_16x16x32_bf16 v[4:7], v[248:251], a[0:3], v[4:7]
  buffer_load_dwordx2 v[142:143], v125, s[24:27], s38 offen offset:512 sc1
  v_mfma_f32_16x16x32_bf16 v[4:7], a[204:207], a[140:143], v[4:7]
  buffer_load_dwordx2 v[146:147], v125, s[24:27], s38 offen offset:1024 sc1
  v_mfma_f32_16x16x32_bf16 v[8:11], a[204:207], v[236:239], v[8:11]
  buffer_load_dwordx2 v[150:151], v125, s[24:27], s38 offen offset:1536 sc1
  v_mfma_f32_16x16x32_bf16 v[8:11], v[248:251], v[192:195], v[8:11]
  buffer_load_dwordx2 v[154:155], v125, s[24:27], s38 offen offset:2048 sc1
  v_mfma_f32_16x16x32_bf16 v[12:15], v[248:251], v[212:215], v[12:15]
  v_mfma_f32_16x16x32_bf16 v[12:15], a[204:207], v[196:199], v[12:15]
  s_waitcnt lgkmcnt(2)
  v_mfma_f32_16x16x32_bf16 v[16:19], v[176:179], a[136:139], v[16:19]
  ds_read_b128 v[220:223], v135 offset:17408
  ds_read_b128 a[44:47], v122 offset:51200
  v_mfma_f32_16x16x32_bf16 v[16:19], v[180:183], a[156:159], v[16:19]
  ds_write_b128 v122, v[4:7] offset:0
  ds_write_b128 v122, v[8:11] offset:17408
  v_mfma_f32_16x16x32_bf16 v[20:23], v[180:183], a[0:3], v[20:23]
  ds_write_b128 v122, v[12:15] offset:34816
  v_mfma_f32_16x16x32_bf16 v[20:23], v[176:179], a[140:143], v[20:23]
  v_mfma_f32_16x16x32_bf16 v[24:27], v[176:179], v[236:239], v[24:27]
  v_mfma_f32_16x16x32_bf16 v[24:27], v[180:183], v[192:195], v[24:27]
  v_mfma_f32_16x16x32_bf16 v[28:31], v[180:183], v[212:215], v[28:31]
  v_mfma_f32_16x16x32_bf16 v[28:31], v[176:179], v[196:199], v[28:31]
  s_waitcnt lgkmcnt(5)
  v_mfma_f32_16x16x32_bf16 v[32:35], v[204:207], a[136:139], v[32:35]
  ds_read_b128 a[64:67], v135 offset:18432
  ds_read_b128 a[48:51], v122 offset:52224
  v_mfma_f32_16x16x32_bf16 v[32:35], v[208:211], a[156:159], v[32:35]
  ds_write_b128 v122, v[20:23] offset:1024
  ds_write_b128 v122, v[24:27] offset:18432
  v_mfma_f32_16x16x32_bf16 v[36:39], v[208:211], a[0:3], v[36:39]
  ds_write_b128 v122, v[28:31] offset:35840
  v_mfma_f32_16x16x32_bf16 v[36:39], v[204:207], a[140:143], v[36:39]
  v_mfma_f32_16x16x32_bf16 v[40:43], v[204:207], v[236:239], v[40:43]
  v_mfma_f32_16x16x32_bf16 v[40:43], v[208:211], v[192:195], v[40:43]
  v_mfma_f32_16x16x32_bf16 v[44:47], v[208:211], v[212:215], v[44:47]
  v_mfma_f32_16x16x32_bf16 v[44:47], v[204:207], v[196:199], v[44:47]
  s_waitcnt lgkmcnt(8)
  v_mfma_f32_16x16x32_bf16 v[48:51], v[220:223], a[136:139], v[48:51]
  v_mfma_f32_16x16x32_bf16 v[48:51], a[44:47], a[156:159], v[48:51]
  v_mfma_f32_16x16x32_bf16 v[52:55], a[44:47], a[0:3], v[52:55]
  ds_write_b128 v122, v[36:39] offset:2048
  v_mfma_f32_16x16x32_bf16 v[52:55], v[220:223], a[140:143], v[52:55]
  ds_write_b128 v122, v[40:43] offset:19456
  v_mfma_f32_16x16x32_bf16 v[56:59], v[220:223], v[236:239], v[56:59]
  ds_write_b128 v122, v[44:47] offset:49152
  v_mfma_f32_16x16x32_bf16 v[56:59], a[44:47], v[192:195], v[56:59]
  v_mfma_f32_16x16x32_bf16 v[60:63], a[44:47], v[212:215], v[60:63]
  v_mfma_f32_16x16x32_bf16 v[60:63], v[220:223], v[196:199], v[60:63]
  s_waitcnt lgkmcnt(6)
  v_mfma_f32_16x16x32_bf16 v[64:67], a[64:67], a[136:139], v[64:67]
  ds_write_b128 v122, v[52:55] offset:3072
  v_mfma_f32_16x16x32_bf16 v[64:67], a[48:51], a[156:159], v[64:67]
  v_mfma_f32_16x16x32_bf16 v[68:71], a[48:51], a[0:3], v[68:71]
  v_mfma_f32_16x16x32_bf16 v[68:71], a[64:67], a[140:143], v[68:71]
  ds_write_b128 v122, v[56:59] offset:32768
  v_mfma_f32_16x16x32_bf16 v[72:75], a[64:67], v[236:239], v[72:75]
  ds_write_b128 v122, v[60:63] offset:50176
  v_mfma_f32_16x16x32_bf16 v[72:75], a[48:51], v[192:195], v[72:75]
  v_mfma_f32_16x16x32_bf16 v[76:79], a[48:51], v[212:215], v[76:79]
  v_mfma_f32_16x16x32_bf16 v[76:79], a[64:67], v[196:199], v[76:79]
  s_nop 1
  ds_write_b128 v122, v[68:71] offset:16384
  s_nop 2
  ds_write_b128 v122, v[72:75] offset:33792
  s_nop 0
  ds_write_b128 v122, v[76:79] offset:51200
  s_waitcnt lgkmcnt(0)
  s_barrier
  ds_read_b128 v[4:7], v80 offset:0
  ds_read_b128 v[8:11], v81 offset:17408
  ds_read_b128 v[12:15], v82 offset:34816
  ds_read_b128 v[20:23], v80 offset:1024
  ds_read_b128 v[24:27], v81 offset:18432
  ds_read_b128 v[28:31], v82 offset:35840
  ds_read_b128 v[36:39], v80 offset:2048
  ds_read_b128 v[40:43], v81 offset:19456
  ds_read_b128 v[44:47], v82 offset:49152
  ds_read_b128 v[52:55], v80 offset:3072
  ds_read_b128 v[56:59], v81 offset:32768
  ds_read_b128 v[60:63], v82 offset:50176
  ds_read_b128 v[68:71], v80 offset:16384
  ds_read_b128 v[72:75], v81 offset:33792
  ds_read_b128 v[76:79], v82 offset:51200
  s_waitcnt vmcnt(4)
  v_lshlrev_b32 v136, 16, v138
  v_and_b32 v137, s34, v138
  v_lshlrev_b32 v138, 16, v139
  v_and_b32 v139, s34, v139
  v_add_f32 v0, v0, v136
  v_add_f32 v1, v1, v137
  v_add_f32 v2, v2, v138
  v_add_f32 v3, v3, v139
  s_waitcnt lgkmcnt(13)
  v_add_f32 v4, v4, v8
  v_add_f32 v5, v5, v9
  v_add_f32 v6, v6, v10
  v_add_f32 v7, v7, v11
  s_waitcnt lgkmcnt(12)
  v_add_f32 v0, v0, v12
  v_add_f32 v1, v1, v13
  v_add_f32 v2, v2, v14
  v_add_f32 v3, v3, v15
  v_add_f32 v0, v0, v4
  v_add_f32 v1, v1, v5
  v_add_f32 v2, v2, v6
  v_add_f32 v3, v3, v7
  v_cvt_pk_bf16_f32 v4, v0, v1
  v_cvt_pk_bf16_f32 v5, v2, v3
  v_lshlrev_b32 v0, 16, v4
  v_and_b32 v1, s34, v4
  v_lshlrev_b32 v2, 16, v5
  v_and_b32 v3, s34, v5
  v_mul_f32 v0, v0, v90
  v_mul_f32 v1, v1, v91
  v_mul_f32 v2, v2, v92
  v_mul_f32 v3, v3, v93
  v_cvt_pk_bf16_f32 v4, v0, v1
  v_cvt_pk_bf16_f32 v5, v2, v3
  v_lshlrev_b32 v0, 16, v4
  v_and_b32 v1, s34, v4
  v_lshlrev_b32 v2, 16, v5
  v_and_b32 v3, s34, v5
  v_add_f32 v0, v0, v156
  v_add_f32 v1, v1, v157
  v_add_f32 v2, v2, v158
  v_add_f32 v3, v3, v159
  v_cvt_pk_bf16_f32 v4, v0, v1
  v_cvt_pk_bf16_f32 v5, v2, v3
  s_waitcnt vmcnt(3)
  v_lshlrev_b32 v140, 16, v142
  v_and_b32 v141, s34, v142
  v_lshlrev_b32 v142, 16, v143
  v_and_b32 v143, s34, v143
  v_add_f32 v16, v16, v140
  v_add_f32 v17, v17, v141
  v_add_f32 v18, v18, v142
  v_add_f32 v19, v19, v143
  s_waitcnt lgkmcnt(10)
  v_add_f32 v20, v20, v24
  v_add_f32 v21, v21, v25
  v_add_f32 v22, v22, v26
  v_add_f32 v23, v23, v27
  s_waitcnt lgkmcnt(9)
  v_add_f32 v16, v16, v28
  v_add_f32 v17, v17, v29
  v_add_f32 v18, v18, v30
  v_add_f32 v19, v19, v31
  v_add_f32 v16, v16, v20
  v_add_f32 v17, v17, v21
  v_add_f32 v18, v18, v22
  v_add_f32 v19, v19, v23
  v_cvt_pk_bf16_f32 v20, v16, v17
  v_cvt_pk_bf16_f32 v21, v18, v19
  v_lshlrev_b32 v16, 16, v20
  v_and_b32 v17, s34, v20
  v_lshlrev_b32 v18, 16, v21
  v_and_b32 v19, s34, v21
  v_mul_f32 v16, v16, v94
  v_mul_f32 v17, v17, v95
  v_mul_f32 v18, v18, v96
  v_mul_f32 v19, v19, v97
  v_cvt_pk_bf16_f32 v20, v16, v17
  v_cvt_pk_bf16_f32 v21, v18, v19
  v_lshlrev_b32 v16, 16, v20
  v_and_b32 v17, s34, v20
  v_lshlrev_b32 v18, 16, v21
  v_and_b32 v19, s34, v21
  v_add_f32 v16, v16, v160
  v_add_f32 v17, v17, v161
  v_add_f32 v18, v18, v162
  v_add_f32 v19, v19, v163
  v_cvt_pk_bf16_f32 v6, v16, v17
  v_cvt_pk_bf16_f32 v7, v18, v19
  s_nop 0
  v_permlane16_swap_b32 v4, v6
  v_permlane16_swap_b32 v5, v7
  buffer_store_dwordx4 v[4:7], v83, s[16:19], 0 offen offset:0
  s_waitcnt vmcnt(3)
  v_lshlrev_b32 v144, 16, v146
  v_and_b32 v145, s34, v146
  v_lshlrev_b32 v146, 16, v147
  v_and_b32 v147, s34, v147
  v_add_f32 v32, v32, v144
  v_add_f32 v33, v33, v145
  v_add_f32 v34, v34, v146
  v_add_f32 v35, v35, v147
  s_waitcnt lgkmcnt(7)
  v_add_f32 v36, v36, v40
  v_add_f32 v37, v37, v41
  v_add_f32 v38, v38, v42
  v_add_f32 v39, v39, v43
  s_waitcnt lgkmcnt(6)
  v_add_f32 v32, v32, v44
  v_add_f32 v33, v33, v45
  v_add_f32 v34, v34, v46
  v_add_f32 v35, v35, v47
  v_add_f32 v32, v32, v36
  v_add_f32 v33, v33, v37
  v_add_f32 v34, v34, v38
  v_add_f32 v35, v35, v39
  v_cvt_pk_bf16_f32 v36, v32, v33
  v_cvt_pk_bf16_f32 v37, v34, v35
  v_lshlrev_b32 v32, 16, v36
  v_and_b32 v33, s34, v36
  v_lshlrev_b32 v34, 16, v37
  v_and_b32 v35, s34, v37
  v_mul_f32 v32, v32, v98
  v_mul_f32 v33, v33, v99
  v_mul_f32 v34, v34, v100
  v_mul_f32 v35, v35, v101
  v_cvt_pk_bf16_f32 v36, v32, v33
  v_cvt_pk_bf16_f32 v37, v34, v35
  v_lshlrev_b32 v32, 16, v36
  v_and_b32 v33, s34, v36
  v_lshlrev_b32 v34, 16, v37
  v_and_b32 v35, s34, v37
  v_add_f32 v32, v32, v164
  v_add_f32 v33, v33, v165
  v_add_f32 v34, v34, v166
  v_add_f32 v35, v35, v167
  v_cvt_pk_bf16_f32 v36, v32, v33
  v_cvt_pk_bf16_f32 v37, v34, v35
  s_waitcnt vmcnt(2)
  v_lshlrev_b32 v148, 16, v150
  v_and_b32 v149, s34, v150
  v_lshlrev_b32 v150, 16, v151
  v_and_b32 v151, s34, v151
  v_add_f32 v48, v48, v148
  v_add_f32 v49, v49, v149
  v_add_f32 v50, v50, v150
  v_add_f32 v51, v51, v151
  s_waitcnt lgkmcnt(4)
  v_add_f32 v52, v52, v56
  v_add_f32 v53, v53, v57
  v_add_f32 v54, v54, v58
  v_add_f32 v55, v55, v59
  s_waitcnt lgkmcnt(3)
  v_add_f32 v48, v48, v60
  v_add_f32 v49, v49, v61
  v_add_f32 v50, v50, v62
  v_add_f32 v51, v51, v63
  v_add_f32 v48, v48, v52
  v_add_f32 v49, v49, v53
  v_add_f32 v50, v50, v54
  v_add_f32 v51, v51, v55
  v_cvt_pk_bf16_f32 v52, v48, v49
  v_cvt_pk_bf16_f32 v53, v50, v51
  v_lshlrev_b32 v48, 16, v52
  v_and_b32 v49, s34, v52
  v_lshlrev_b32 v50, 16, v53
  v_and_b32 v51, s34, v53
  v_mul_f32 v48, v48, v102
  v_mul_f32 v49, v49, v103
  v_mul_f32 v50, v50, v104
  v_mul_f32 v51, v51, v105
  v_cvt_pk_bf16_f32 v52, v48, v49
  v_cvt_pk_bf16_f32 v53, v50, v51
  v_lshlrev_b32 v48, 16, v52
  v_and_b32 v49, s34, v52
  v_lshlrev_b32 v50, 16, v53
  v_and_b32 v51, s34, v53
  v_add_f32 v48, v48, v168
  v_add_f32 v49, v49, v169
  v_add_f32 v50, v50, v170
  v_add_f32 v51, v51, v171
  v_cvt_pk_bf16_f32 v38, v48, v49
  v_cvt_pk_bf16_f32 v39, v50, v51
  s_nop 0
  v_permlane16_swap_b32 v36, v38
  v_permlane16_swap_b32 v37, v39
  buffer_store_dwordx4 v[36:39], v83, s[16:19], 0 offen offset:64
  s_waitcnt vmcnt(2)
  v_lshlrev_b32 v152, 16, v154
  v_and_b32 v153, s34, v154
  v_lshlrev_b32 v154, 16, v155
  v_and_b32 v155, s34, v155
  v_add_f32 v64, v64, v152
  v_add_f32 v65, v65, v153
  v_add_f32 v66, v66, v154
  v_add_f32 v67, v67, v155
  s_waitcnt lgkmcnt(1)
  v_add_f32 v68, v68, v72
  v_add_f32 v69, v69, v73
  v_add_f32 v70, v70, v74
  v_add_f32 v71, v71, v75
  s_waitcnt lgkmcnt(0)
  v_add_f32 v64, v64, v76
  v_add_f32 v65, v65, v77
  v_add_f32 v66, v66, v78
  v_add_f32 v67, v67, v79
  v_add_f32 v64, v64, v68
  v_add_f32 v65, v65, v69
  v_add_f32 v66, v66, v70
  v_add_f32 v67, v67, v71
  v_cvt_pk_bf16_f32 v68, v64, v65
  v_cvt_pk_bf16_f32 v69, v66, v67
  v_lshlrev_b32 v64, 16, v68
  v_and_b32 v65, s34, v68
  v_lshlrev_b32 v66, 16, v69
  v_and_b32 v67, s34, v69
  v_mul_f32 v64, v64, v106
  v_mul_f32 v65, v65, v107
  v_mul_f32 v66, v66, v108
  v_mul_f32 v67, v67, v109
  v_cvt_pk_bf16_f32 v68, v64, v65
  v_cvt_pk_bf16_f32 v69, v66, v67
  v_lshlrev_b32 v64, 16, v68
  v_and_b32 v65, s34, v68
  v_lshlrev_b32 v66, 16, v69
  v_and_b32 v67, s34, v69
  v_add_f32 v64, v64, v172
  v_add_f32 v65, v65, v173
  v_add_f32 v66, v66, v174
  v_add_f32 v67, v67, v175
  v_cvt_pk_bf16_f32 v68, v64, v65
  v_cvt_pk_bf16_f32 v69, v66, v67
  buffer_store_dwordx2 v[68:69], v117, s[16:19], 0 offen offset:128
attn_end:
  s_endpgm
attn_redo:
  s_waitcnt vmcnt(0)
  v_accvgpr_write_b32 a0, 0
  v_accvgpr_write_b32 a1, 0
  v_accvgpr_write_b32 a2, 0
  v_accvgpr_write_b32 a3, 0
  v_accvgpr_write_b32 a4, 0
  v_accvgpr_write_b32 a5, 0
  v_accvgpr_write_b32 a6, 0
  v_accvgpr_write_b32 a7, 0
  v_accvgpr_write_b32 a8, 0
  v_accvgpr_write_b32 a9, 0
  v_accvgpr_write_b32 a10, 0
  v_accvgpr_write_b32 a11, 0
  v_accvgpr_write_b32 a12, 0
  v_accvgpr_write_b32 a13, 0
  v_accvgpr_write_b32 a14, 0
  v_accvgpr_write_b32 a15, 0
  v_accvgpr_write_b32 a16, 0
  v_accvgpr_write_b32 a17, 0
  v_accvgpr_write_b32 a18, 0
  v_accvgpr_write_b32 a19, 0
  v_accvgpr_write_b32 a20, 0
  v_accvgpr_write_b32 a21, 0
  v_accvgpr_write_b32 a22, 0
  v_accvgpr_write_b32 a23, 0
  v_accvgpr_write_b32 a24, 0
  v_accvgpr_write_b32 a25, 0
  v_accvgpr_write_b32 a26, 0
  v_accvgpr_write_b32 a27, 0
  v_accvgpr_write_b32 a28, 0
  v_accvgpr_write_b32 a29, 0
  v_accvgpr_write_b32 a30, 0
  v_accvgpr_write_b32 a31, 0
  v_accvgpr_write_b32 a32, 0
  v_accvgpr_write_b32 a33, 0
  v_accvgpr_write_b32 a34, 0
  v_accvgpr_write_b32 a35, 0
  v_accvgpr_write_b32 a36, 0
  v_accvgpr_write_b32 a37, 0
  v_accvgpr_write_b32 a38, 0
  v_accvgpr_write_b32 a39, 0
  v_accvgpr_write_b32 a40, 0
  v_accvgpr_write_b32 a41, 0
  v_accvgpr_write_b32 a42, 0
  v_accvgpr_write_b32 a43, 0
  v_accvgpr_write_b32 a44, 0
  v_accvgpr_write_b32 a45, 0
  v_accvgpr_write_b32 a46, 0
  v_accvgpr_write_b32 a47, 0
  v_accvgpr_write_b32 a48, 0
  v_accvgpr_write_b32 a49, 0
  v_accvgpr_write_b32 a50, 0
  v_accvgpr_write_b32 a51, 0
  v_accvgpr_write_b32 a52, 0
  v_accvgpr_write_b32 a53, 0
  v_accvgpr_write_b32 a54, 0
  v_accvgpr_write_b32 a55, 0
  v_accvgpr_write_b32 a56, 0
  v_accvgpr_write_b32 a57, 0
  v_accvgpr_write_b32 a58, 0
  v_accvgpr_write_b32 a59, 0
  v_accvgpr_write_b32 a60, 0
  v_accvgpr_write_b32 a61, 0
  v_accvgpr_write_b32 a62, 0
  v_accvgpr_write_b32 a63, 0
  v_accvgpr_write_b32 a64, 0
  v_accvgpr_write_b32 a65, 0
  v_accvgpr_write_b32 a66, 0
  v_accvgpr_write_b32 a67, 0
  v_accvgpr_write_b32 a68, 0
  v_accvgpr_write_b32 a69, 0
  v_accvgpr_write_b32 a70, 0
  v_accvgpr_write_b32 a71, 0
  v_accvgpr_write_b32 a72, 0
  v_accvgpr_write_b32 a73, 0
  v_accvgpr_write_b32 a74, 0
  v_accvgpr_write_b32 a75, 0
  v_accvgpr_write_b32 a76, 0
  v_accvgpr_write_b32 a77, 0
  v_accvgpr_write_b32 a78, 0
  v_accvgpr_write_b32 a79, 0
  v_accvgpr_write_b32 a80, 0
  v_accvgpr_write_b32 a81, 0
  v_accvgpr_write_b32 a82, 0
  v_accvgpr_write_b32 a83, 0
  v_accvgpr_write_b32 a84, 0
  v_accvgpr_write_b32 a85, 0
  v_accvgpr_write_b32 a86, 0
  v_accvgpr_write_b32 a87, 0
  v_accvgpr_write_b32 a88, 0
  v_accvgpr_write_b32 a89, 0
  v_accvgpr_write_b32 a90, 0
  v_accvgpr_write_b32 a91, 0
  v_accvgpr_write_b32 a92, 0
  v_accvgpr_write_b32 a93, 0
  v_accvgpr_write_b32 a94, 0
  v_accvgpr_write_b32 a95, 0
  v_accvgpr_write_b32 a96, 0
  v_accvgpr_write_b32 a97, 0
  v_accvgpr_write_b32 a98, 0
  v_accvgpr_write_b32 a99, 0
  v_accvgpr_write_b32 a100, 0
  v_accvgpr_write_b32 a101, 0
  v_accvgpr_write_b32 a102, 0
  v_accvgpr_write_b32 a103, 0
  v_accvgpr_write_b32 a104, 0
  v_accvgpr_write_b32 a105, 0
  v_accvgpr_write_b32 a106, 0
  v_accvgpr_write_b32 a107, 0
  v_accvgpr_write_b32 a108, 0
  v_accvgpr_write_b32 a109, 0
  v_accvgpr_write_b32 a110, 0
  v_accvgpr_write_b32 a111, 0
  v_accvgpr_write_b32 a112, 0
  v_accvgpr_write_b32 a113, 0
  v_accvgpr_write_b32 a114, 0
  v_accvgpr_write_b32 a115, 0
  v_accvgpr_write_b32 a116, 0
  v_accvgpr_write_b32 a117, 0
  v_accvgpr_write_b32 a118, 0
  v_accvgpr_write_b32 a119, 0
  v_accvgpr_write_b32 a120, 0
  v_accvgpr_write_b32 a121, 0
  v_accvgpr_write_b32 a122, 0
  v_accvgpr_write_b32 a123, 0
  v_accvgpr_write_b32 a124, 0
  v_accvgpr_write_b32 a125, 0
  v_accvgpr_write_b32 a126, 0
  v_accvgpr_write_b32 a127, 0
  v_mov_b32 v208, 0
  v_mov_b32 v249, 0xff800000
  v_mov_b32 v209, 0
  v_mov_b32 v250, 0xff800000
  v_mov_b32 v210, 0
  v_mov_b32 v251, 0xff800000
  v_mov_b32 v211, 0
  v_mov_b32 v252, 0xff800000
  s_mov_b32 s29, 0
attn_slow:
  s_barrier
  s_add_u32 m0, s28, 49152
  s_nop 0
  buffer_load_dwordx4 v232, s[12:15], s29 offen offset:0 lds
  buffer_load_dwordx4 v233, s[12:15], s29 offen offset:1024 lds
  buffer_load_dwordx4 v234, s[12:15], s29 offen offset:2048 lds
  buffer_load_dwordx4 v235, s[12:15], s29 offen offset:3072 lds
  s_add_u32 m0, s28, 114688
  s_nop 0
  buffer_load_dwordx4 v236, s[16:19], s29 offen offset:0 lds
  buffer_load_dwordx4 v237, s[16:19], s29 offen offset:1024 lds
  buffer_load_dwordx4 v236, s[16:19], s29 offen offset:2048 lds
  buffer_load_dwordx4 v237, s[16:19], s29 offen offset:3072 lds
  s_waitcnt vmcnt(0)
  s_barrier
  ds_read_b128 a[128:131], v212 offset:49152
  ds_read_b128 a[132:135], v213 offset:49152
  ds_read_b128 a[136:139], v214 offset:49152
  ds_read_b128 a[140:143], v215 offset:49152
  s_waitcnt lgkmcnt(3)
  v_mfma_f32_16x16x32_bf16 v[0:3], a[128:131], v[128:131], 0
  s_waitcnt lgkmcnt(2)
  v_mfma_f32_16x16x32_bf16 v[0:3], a[132:135], v[132:135], v[0:3]
  s_waitcnt lgkmcnt(1)
  v_mfma_f32_16x16x32_bf16 v[0:3], a[136:139], v[136:139], v[0:3]
  s_waitcnt lgkmcnt(0)
  v_mfma_f32_16x16x32_bf16 v[0:3], a[140:143], v[140:143], v[0:3]
  v_mfma_f32_16x16x32_bf16 v[8:11], a[140:143], v[156:159], 0
  v_mfma_f32_16x16x32_bf16 v[8:11], a[136:139], v[152:155], v[8:11]
  v_mfma_f32_16x16x32_bf16 v[8:11], a[132:135], v[148:151], v[8:11]
  v_mfma_f32_16x16x32_bf16 v[8:11], a[128:131], v[144:147], v[8:11]
  v_mfma_f32_16x16x32_bf16 v[16:19], a[128:131], v[160:163], 0
  v_mfma_f32_16x16x32_bf16 v[16:19], a[132:135], v[164:167], v[16:19]
  v_mfma_f32_16x16x32_bf16 v[16:19], a[136:139], v[168:171], v[16:19]
  v_mfma_f32_16x16x32_bf16 v[16:19], a[140:143], v[172:175], v[16:19]
  v_mfma_f32_16x16x32_bf16 v[24:27], a[140:143], v[188:191], 0
  v_mfma_f32_16x16x32_bf16 v[24:27], a[136:139], v[184:187], v[24:27]
  v_mfma_f32_16x16x32_bf16 v[24:27], a[132:135], v[180:183], v[24:27]
  v_mfma_f32_16x16x32_bf16 v[24:27], a[128:131], v[176:179], v[24:27]
  ds_read_b128 a[144:147], v212 offset:53248
  ds_read_b128 a[148:151], v213 offset:53248
  ds_read_b128 a[152:155], v214 offset:53248
  ds_read_b128 a[156:159], v215 offset:53248
  s_waitcnt lgkmcnt(3)
  v_mfma_f32_16x16x32_bf16 v[4:7], a[144:147], v[128:131], 0
  s_waitcnt lgkmcnt(2)
  v_mfma_f32_16x16x32_bf16 v[4:7], a[148:151], v[132:135], v[4:7]
  s_waitcnt lgkmcnt(1)
  v_mfma_f32_16x16x32_bf16 v[4:7], a[152:155], v[136:139], v[4:7]
  s_waitcnt lgkmcnt(0)
  v_mfma_f32_16x16x32_bf16 v[4:7], a[156:159], v[140:143], v[4:7]
  v_mfma_f32_16x16x32_bf16 v[12:15], a[156:159], v[156:159], 0
  v_mfma_f32_16x16x32_bf16 v[12:15], a[152:155], v[152:155], v[12:15]
  v_mfma_f32_16x16x32_bf16 v[12:15], a[148:151], v[148:151], v[12:15]
  v_mfma_f32_16x16x32_bf16 v[12:15], a[144:147], v[144:147], v[12:15]
  v_mfma_f32_16x16x32_bf16 v[20:23], a[144:147], v[160:163], 0
  v_mfma_f32_16x16x32_bf16 v[20:23], a[148:151], v[164:167], v[20:23]
  v_mfma_f32_16x16x32_bf16 v[20:23], a[152:155], v[168:171], v[20:23]
  v_mfma_f32_16x16x32_bf16 v[20:23], a[156:159], v[172:175], v[20:23]
  v_mfma_f32_16x16x32_bf16 v[28:31], a[156:159], v[188:191], 0
  v_mfma_f32_16x16x32_bf16 v[28:31], a[152:155], v[184:187], v[28:31]
  v_mfma_f32_16x16x32_bf16 v[28:31], a[148:151], v[180:183], v[28:31]
  v_mfma_f32_16x16x32_bf16 v[28:31], a[144:147], v[176:179], v[28:31]
  ds_read_b128 a[128:131], v212 offset:57344
  ds_read_b128 a[132:135], v213 offset:57344
  ds_read_b128 a[136:139], v214 offset:57344
  ds_read_b128 a[140:143], v215 offset:57344
  s_waitcnt lgkmcnt(3)
  v_mfma_f32_16x16x32_bf16 v[32:35], a[128:131], v[128:131], 0
  s_waitcnt lgkmcnt(2)
  v_mfma_f32_16x16x32_bf16 v[32:35], a[132:135], v[132:135], v[32:35]
  s_waitcnt lgkmcnt(1)
  v_mfma_f32_16x16x32_bf16 v[32:35], a[136:139], v[136:139], v[32:35]
  s_waitcnt lgkmcnt(0)
  v_mfma_f32_16x16x32_bf16 v[32:35], a[140:143], v[140:143], v[32:35]
  v_mfma_f32_16x16x32_bf16 v[40:43], a[140:143], v[156:159], 0
  v_mfma_f32_16x16x32_bf16 v[40:43], a[136:139], v[152:155], v[40:43]
  v_mfma_f32_16x16x32_bf16 v[40:43], a[132:135], v[148:151], v[40:43]
  v_mfma_f32_16x16x32_bf16 v[40:43], a[128:131], v[144:147], v[40:43]
  v_mfma_f32_16x16x32_bf16 v[48:51], a[128:131], v[160:163], 0
  v_mfma_f32_16x16x32_bf16 v[48:51], a[132:135], v[164:167], v[48:51]
  v_mfma_f32_16x16x32_bf16 v[48:51], a[136:139], v[168:171], v[48:51]
  v_mfma_f32_16x16x32_bf16 v[48:51], a[140:143], v[172:175], v[48:51]
  v_mfma_f32_16x16x32_bf16 v[56:59], a[140:143], v[188:191], 0
  v_mfma_f32_16x16x32_bf16 v[56:59], a[136:139], v[184:187], v[56:59]
  v_mfma_f32_16x16x32_bf16 v[56:59], a[132:135], v[180:183], v[56:59]
  v_mfma_f32_16x16x32_bf16 v[56:59], a[128:131], v[176:179], v[56:59]
  ds_read_b128 a[144:147], v212 offset:61440
  ds_read_b128 a[148:151], v213 offset:61440
  ds_read_b128 a[152:155], v214 offset:61440
  ds_read_b128 a[156:159], v215 offset:61440
  s_waitcnt lgkmcnt(3)
  v_mfma_f32_16x16x32_bf16 v[36:39], a[144:147], v[128:131], 0
  s_waitcnt lgkmcnt(2)
  v_mfma_f32_16x16x32_bf16 v[36:39], a[148:151], v[132:135], v[36:39]
  s_waitcnt lgkmcnt(1)
  v_mfma_f32_16x16x32_bf16 v[36:39], a[152:155], v[136:139], v[36:39]
  s_waitcnt lgkmcnt(0)
  v_mfma_f32_16x16x32_bf16 v[36:39], a[156:159], v[140:143], v[36:39]
  v_mfma_f32_16x16x32_bf16 v[44:47], a[156:159], v[156:159], 0
  v_mfma_f32_16x16x32_bf16 v[44:47], a[152:155], v[152:155], v[44:47]
  v_mfma_f32_16x16x32_bf16 v[44:47], a[148:151], v[148:151], v[44:47]
  v_mfma_f32_16x16x32_bf16 v[44:47], a[144:147], v[144:147], v[44:47]
  v_mfma_f32_16x16x32_bf16 v[52:55], a[144:147], v[160:163], 0
  v_mfma_f32_16x16x32_bf16 v[52:55], a[148:151], v[164:167], v[52:55]
  v_mfma_f32_16x16x32_bf16 v[52:55], a[152:155], v[168:171], v[52:55]
  v_mfma_f32_16x16x32_bf16 v[52:55], a[156:159], v[172:175], v[52:55]
  v_mfma_f32_16x16x32_bf16 v[60:63], a[156:159], v[188:191], 0
  v_mfma_f32_16x16x32_bf16 v[60:63], a[152:155], v[184:187], v[60:63]
  v_mfma_f32_16x16x32_bf16 v[60:63], a[148:151], v[180:183], v[60:63]
  v_mfma_f32_16x16x32_bf16 v[60:63], a[144:147], v[176:179], v[60:63]
  v_mov_b32 v192, v249
  v_max3_f32 v192, v192, v0, v1
  v_max3_f32 v192, v192, v2, v3
  v_max3_f32 v192, v192, v4, v5
  v_max3_f32 v192, v192, v6, v7
  v_max3_f32 v192, v192, v32, v33
  v_max3_f32 v192, v192, v34, v35
  v_max3_f32 v192, v192, v36, v37
  v_max3_f32 v192, v192, v38, v39
  v_mov_b32 v245, v192
  s_nop 1
  v_permlane16_swap_b32 v192, v245
  v_max_f32 v192, v192, v245
  v_mov_b32 v245, v192
  s_nop 1
  v_permlane32_swap_b32 v192, v245
  v_max_f32 v192, v192, v245
  v_sub_f32 v193, v249, v192
  v_exp_f32 v193, v193
  v_mov_b32 v249, v192
  v_mul_f32 v208, v208, v193
  v_sub_f32 v0, v0, v192
  v_sub_f32 v1, v1, v192
  v_sub_f32 v2, v2, v192
  v_sub_f32 v3, v3, v192
  v_sub_f32 v4, v4, v192
  v_sub_f32 v5, v5, v192
  v_sub_f32 v6, v6, v192
  v_sub_f32 v7, v7, v192
  v_sub_f32 v32, v32, v192
  v_sub_f32 v33, v33, v192
  v_sub_f32 v34, v34, v192
  v_sub_f32 v35, v35, v192
  v_sub_f32 v36, v36, v192
  v_sub_f32 v37, v37, v192
  v_sub_f32 v38, v38, v192
  v_sub_f32 v39, v39, v192
  v_exp_f32 v0, v0
  v_exp_f32 v1, v1
  v_add_f32 v208, v208, v0
  v_exp_f32 v2, v2
  v_add_f32 v208, v208, v1
  v_cvt_pk_bf16_f32 v0, v0, v1
  v_exp_f32 v3, v3
  v_add_f32 v208, v208, v2
  v_add_f32 v208, v208, v3
  v_cvt_pk_bf16_f32 v1, v2, v3
  v_exp_f32 v4, v4
  v_exp_f32 v5, v5
  v_add_f32 v208, v208, v4
  v_exp_f32 v6, v6
  v_add_f32 v208, v208, v5
  v_cvt_pk_bf16_f32 v2, v4, v5
  v_exp_f32 v7, v7
  v_add_f32 v208, v208, v6
  v_add_f32 v208, v208, v7
  v_cvt_pk_bf16_f32 v3, v6, v7
  v_exp_f32 v32, v32
  v_exp_f32 v33, v33
  v_add_f32 v208, v208, v32
  v_exp_f32 v34, v34
  v_add_f32 v208, v208, v33
  v_cvt_pk_bf16_f32 v32, v32, v33
  v_exp_f32 v35, v35
  v_add_f32 v208, v208, v34
  v_add_f32 v208, v208, v35
  v_cvt_pk_bf16_f32 v33, v34, v35
  v_exp_f32 v36, v36
  v_exp_f32 v37, v37
  v_add_f32 v208, v208, v36
  v_exp_f32 v38, v38
  v_add_f32 v208, v208, v37
  v_cvt_pk_bf16_f32 v34, v36, v37
  v_exp_f32 v39, v39
  v_add_f32 v208, v208, v38
  v_add_f32 v208, v208, v39
  v_cvt_pk_bf16_f32 v35, v38, v39
  v_accvgpr_read_b32 v64, a0
  v_accvgpr_read_b32 v65, a1
  v_accvgpr_read_b32 v66, a2
  v_accvgpr_read_b32 v67, a3
  v_mul_f32 v64, v64, v193
  v_mul_f32 v65, v65, v193
  v_mul_f32 v66, v66, v193
  v_mul_f32 v67, v67, v193
  v_accvgpr_write_b32 a0, v64
  v_accvgpr_write_b32 a1, v65
  v_accvgpr_write_b32 a2, v66
  v_accvgpr_write_b32 a3, v67
  v_accvgpr_read_b32 v64, a16
  v_accvgpr_read_b32 v65, a17
  v_accvgpr_read_b32 v66, a18
  v_accvgpr_read_b32 v67, a19
  v_mul_f32 v64, v64, v193
  v_mul_f32 v65, v65, v193
  v_mul_f32 v66, v66, v193
  v_mul_f32 v67, v67, v193
  v_accvgpr_write_b32 a16, v64
  v_accvgpr_write_b32 a17, v65
  v_accvgpr_write_b32 a18, v66
  v_accvgpr_write_b32 a19, v67
  v_accvgpr_read_b32 v64, a32
  v_accvgpr_read_b32 v65, a33
  v_accvgpr_read_b32 v66, a34
  v_accvgpr_read_b32 v67, a35
  v_mul_f32 v64, v64, v193
  v_mul_f32 v65, v65, v193
  v_mul_f32 v66, v66, v193
  v_mul_f32 v67, v67, v193
  v_accvgpr_write_b32 a32, v64
  v_accvgpr_write_b32 a33, v65
  v_accvgpr_write_b32 a34, v66
  v_accvgpr_write_b32 a35, v67
  v_accvgpr_read_b32 v64, a48
  v_accvgpr_read_b32 v65, a49
  v_accvgpr_read_b32 v66, a50
  v_accvgpr_read_b32 v67, a51
  v_mul_f32 v64, v64, v193
  v_mul_f32 v65, v65, v193
  v_mul_f32 v66, v66, v193
  v_mul_f32 v67, v67, v193
  v_accvgpr_write_b32 a48, v64
  v_accvgpr_write_b32 a49, v65
  v_accvgpr_write_b32 a50, v66
  v_accvgpr_write_b32 a51, v67
  v_accvgpr_read_b32 v64, a64
  v_accvgpr_read_b32 v65, a65
  v_accvgpr_read_b32 v66, a66
  v_accvgpr_read_b32 v67, a67
  v_mul_f32 v64, v64, v193
  v_mul_f32 v65, v65, v193
  v_mul_f32 v66, v66, v193
  v_mul_f32 v67, v67, v193
  v_accvgpr_write_b32 a64, v64
  v_accvgpr_write_b32 a65, v65
  v_accvgpr_write_b32 a66, v66
  v_accvgpr_write_b32 a67, v67
  v_accvgpr_read_b32 v64, a80
  v_accvgpr_read_b32 v65, a81
  v_accvgpr_read_b32 v66, a82
  v_accvgpr_read_b32 v67, a83
  v_mul_f32 v64, v64, v193
  v_mul_f32 v65, v65, v193
  v_mul_f32 v66, v66, v193
  v_mul_f32 v67, v67, v193
  v_accvgpr_write_b32 a80, v64
  v_accvgpr_write_b32 a81, v65
  v_accvgpr_write_b32 a82, v66
  v_accvgpr_write_b32 a83, v67
  v_accvgpr_read_b32 v64, a96
  v_accvgpr_read_b32 v65, a97
  v_accvgpr_read_b32 v66, a98
  v_accvgpr_read_b32 v67, a99
  v_mul_f32 v64, v64, v193
  v_mul_f32 v65, v65, v193
  v_mul_f32 v66, v66, v193
  v_mul_f32 v67, v67, v193
  v_accvgpr_write_b32 a96, v64
  v_accvgpr_write_b32 a97, v65
  v_accvgpr_write_b32 a98, v66
  v_accvgpr_write_b32 a99, v67
  v_accvgpr_read_b32 v64, a112
  v_accvgpr_read_b32 v65, a113
  v_accvgpr_read_b32 v66, a114
  v_accvgpr_read_b32 v67, a115
  v_mul_f32 v64, v64, v193
  v_mul_f32 v65, v65, v193
  v_mul_f32 v66, v66, v193
  v_mul_f32 v67, v67, v193
  v_accvgpr_write_b32 a112, v64
  v_accvgpr_write_b32 a113, v65
  v_accvgpr_write_b32 a114, v66
  v_accvgpr_write_b32 a115, v67
  v_mov_b32 v196, v250
  v_max3_f32 v196, v196, v8, v9
  v_max3_f32 v196, v196, v10, v11
  v_max3_f32 v196, v196, v12, v13
  v_max3_f32 v196, v196, v14, v15
  v_max3_f32 v196, v196, v40, v41
  v_max3_f32 v196, v196, v42, v43
  v_max3_f32 v196, v196, v44, v45
  v_max3_f32 v196, v196, v46, v47
  v_mov_b32 v245, v196
  s_nop 1
  v_permlane16_swap_b32 v196, v245
  v_max_f32 v196, v196, v245
  v_mov_b32 v245, v196
  s_nop 1
  v_permlane32_swap_b32 v196, v245
  v_max_f32 v196, v196, v245
  v_sub_f32 v197, v250, v196
  v_exp_f32 v197, v197
  v_mov_b32 v250, v196
  v_mul_f32 v209, v209, v197
  v_sub_f32 v8, v8, v196
  v_sub_f32 v9, v9, v196
  v_sub_f32 v10, v10, v196
  v_sub_f32 v11, v11, v196
  v_sub_f32 v12, v12, v196
  v_sub_f32 v13, v13, v196
  v_sub_f32 v14, v14, v196
  v_sub_f32 v15, v15, v196
  v_sub_f32 v40, v40, v196
  v_sub_f32 v41, v41, v196
  v_sub_f32 v42, v42, v196
  v_sub_f32 v43, v43, v196
  v_sub_f32 v44, v44, v196
  v_sub_f32 v45, v45, v196
  v_sub_f32 v46, v46, v196
  v_sub_f32 v47, v47, v196
  v_exp_f32 v8, v8
  v_exp_f32 v9, v9
  v_add_f32 v209, v209, v8
  v_exp_f32 v10, v10
  v_add_f32 v209, v209, v9
  v_cvt_pk_bf16_f32 v8, v8, v9
  v_exp_f32 v11, v11
  v_add_f32 v209, v209, v10
  v_add_f32 v209, v209, v11
  v_cvt_pk_bf16_f32 v9, v10, v11
  v_exp_f32 v12, v12
  v_exp_f32 v13, v13
  v_add_f32 v209, v209, v12
  v_exp_f32 v14, v14
  v_add_f32 v209, v209, v13
  v_cvt_pk_bf16_f32 v10, v12, v13
  v_exp_f32 v15, v15
  v_add_f32 v209, v209, v14
  v_add_f32 v209, v209, v15
  v_cvt_pk_bf16_f32 v11, v14, v15
  v_exp_f32 v40, v40
  v_exp_f32 v41, v41
  v_add_f32 v209, v209, v40
  v_exp_f32 v42, v42
  v_add_f32 v209, v209, v41
  v_cvt_pk_bf16_f32 v40, v40, v41
  v_exp_f32 v43, v43
  v_add_f32 v209, v209, v42
  v_add_f32 v209, v209, v43
  v_cvt_pk_bf16_f32 v41, v42, v43
  v_exp_f32 v44, v44
  v_exp_f32 v45, v45
  v_add_f32 v209, v209, v44
  v_exp_f32 v46, v46
  v_add_f32 v209, v209, v45
  v_cvt_pk_bf16_f32 v42, v44, v45
  v_exp_f32 v47, v47
  v_add_f32 v209, v209, v46
  v_add_f32 v209, v209, v47
  v_cvt_pk_bf16_f32 v43, v46, v47
  v_accvgpr_read_b32 v64, a4
  v_accvgpr_read_b32 v65, a5
  v_accvgpr_read_b32 v66, a6
  v_accvgpr_read_b32 v67, a7
  v_mul_f32 v64, v64, v197
  v_mul_f32 v65, v65, v197
  v_mul_f32 v66, v66, v197
  v_mul_f32 v67, v67, v197
  v_accvgpr_write_b32 a4, v64
  v_accvgpr_write_b32 a5, v65
  v_accvgpr_write_b32 a6, v66
  v_accvgpr_write_b32 a7, v67
  v_accvgpr_read_b32 v64, a20
  v_accvgpr_read_b32 v65, a21
  v_accvgpr_read_b32 v66, a22
  v_accvgpr_read_b32 v67, a23
  v_mul_f32 v64, v64, v197
  v_mul_f32 v65, v65, v197
  v_mul_f32 v66, v66, v197
  v_mul_f32 v67, v67, v197
  v_accvgpr_write_b32 a20, v64
  v_accvgpr_write_b32 a21, v65
  v_accvgpr_write_b32 a22, v66
  v_accvgpr_write_b32 a23, v67
  v_accvgpr_read_b32 v64, a36
  v_accvgpr_read_b32 v65, a37
  v_accvgpr_read_b32 v66, a38
  v_accvgpr_read_b32 v67, a39
  v_mul_f32 v64, v64, v197
  v_mul_f32 v65, v65, v197
  v_mul_f32 v66, v66, v197
  v_mul_f32 v67, v67, v197
  v_accvgpr_write_b32 a36, v64
  v_accvgpr_write_b32 a37, v65
  v_accvgpr_write_b32 a38, v66
  v_accvgpr_write_b32 a39, v67
  v_accvgpr_read_b32 v64, a52
  v_accvgpr_read_b32 v65, a53
  v_accvgpr_read_b32 v66, a54
  v_accvgpr_read_b32 v67, a55
  v_mul_f32 v64, v64, v197
  v_mul_f32 v65, v65, v197
  v_mul_f32 v66, v66, v197
  v_mul_f32 v67, v67, v197
  v_accvgpr_write_b32 a52, v64
  v_accvgpr_write_b32 a53, v65
  v_accvgpr_write_b32 a54, v66
  v_accvgpr_write_b32 a55, v67
  v_accvgpr_read_b32 v64, a68
  v_accvgpr_read_b32 v65, a69
  v_accvgpr_read_b32 v66, a70
  v_accvgpr_read_b32 v67, a71
  v_mul_f32 v64, v64, v197
  v_mul_f32 v65, v65, v197
  v_mul_f32 v66, v66, v197
  v_mul_f32 v67, v67, v197
  v_accvgpr_write_b32 a68, v64
  v_accvgpr_write_b32 a69, v65
  v_accvgpr_write_b32 a70, v66
  v_accvgpr_write_b32 a71, v67
  v_accvgpr_read_b32 v64, a84
  v_accvgpr_read_b32 v65, a85
  v_accvgpr_read_b32 v66, a86
  v_accvgpr_read_b32 v67, a87
  v_mul_f32 v64, v64, v197
  v_mul_f32 v65, v65, v197
  v_mul_f32 v66, v66, v197
  v_mul_f32 v67, v67, v197
  v_accvgpr_write_b32 a84, v64
  v_accvgpr_write_b32 a85, v65
  v_accvgpr_write_b32 a86, v66
  v_accvgpr_write_b32 a87, v67
  v_accvgpr_read_b32 v64, a100
  v_accvgpr_read_b32 v65, a101
  v_accvgpr_read_b32 v66, a102
  v_accvgpr_read_b32 v67, a103
  v_mul_f32 v64, v64, v197
  v_mul_f32 v65, v65, v197
  v_mul_f32 v66, v66, v197
  v_mul_f32 v67, v67, v197
  v_accvgpr_write_b32 a100, v64
  v_accvgpr_write_b32 a101, v65
  v_accvgpr_write_b32 a102, v66
  v_accvgpr_write_b32 a103, v67
  v_accvgpr_read_b32 v64, a116
  v_accvgpr_read_b32 v65, a117
  v_accvgpr_read_b32 v66, a118
  v_accvgpr_read_b32 v67, a119
  v_mul_f32 v64, v64, v197
  v_mul_f32 v65, v65, v197
  v_mul_f32 v66, v66, v197
  v_mul_f32 v67, v67, v197
  v_accvgpr_write_b32 a116, v64
  v_accvgpr_write_b32 a117, v65
  v_accvgpr_write_b32 a118, v66
  v_accvgpr_write_b32 a119, v67
  v_mov_b32 v200, v251
  v_max3_f32 v200, v200, v16, v17
  v_max3_f32 v200, v200, v18, v19
  v_max3_f32 v200, v200, v20, v21
  v_max3_f32 v200, v200, v22, v23
  v_max3_f32 v200, v200, v48, v49
  v_max3_f32 v200, v200, v50, v51
  v_max3_f32 v200, v200, v52, v53
  v_max3_f32 v200, v200, v54, v55
  v_mov_b32 v245, v200
  s_nop 1
  v_permlane16_swap_b32 v200, v245
  v_max_f32 v200, v200, v245
  v_mov_b32 v245, v200
  s_nop 1
  v_permlane32_swap_b32 v200, v245
  v_max_f32 v200, v200, v245
  v_sub_f32 v201, v251, v200
  v_exp_f32 v201, v201
  v_mov_b32 v251, v200
  v_mul_f32 v210, v210, v201
  v_sub_f32 v16, v16, v200
  v_sub_f32 v17, v17, v200
  v_sub_f32 v18, v18, v200
  v_sub_f32 v19, v19, v200
  v_sub_f32 v20, v20, v200
  v_sub_f32 v21, v21, v200
  v_sub_f32 v22, v22, v200
  v_sub_f32 v23, v23, v200
  v_sub_f32 v48, v48, v200
  v_sub_f32 v49, v49, v200
  v_sub_f32 v50, v50, v200
  v_sub_f32 v51, v51, v200
  v_sub_f32 v52, v52, v200
  v_sub_f32 v53, v53, v200
  v_sub_f32 v54, v54, v200
  v_sub_f32 v55, v55, v200
  v_exp_f32 v16, v16
  v_exp_f32 v17, v17
  v_add_f32 v210, v210, v16
  v_exp_f32 v18, v18
  v_add_f32 v210, v210, v17
  v_cvt_pk_bf16_f32 v16, v16, v17
  v_exp_f32 v19, v19
  v_add_f32 v210, v210, v18
  v_add_f32 v210, v210, v19
  v_cvt_pk_bf16_f32 v17, v18, v19
  v_exp_f32 v20, v20
  v_exp_f32 v21, v21
  v_add_f32 v210, v210, v20
  v_exp_f32 v22, v22
  v_add_f32 v210, v210, v21
  v_cvt_pk_bf16_f32 v18, v20, v21
  v_exp_f32 v23, v23
  v_add_f32 v210, v210, v22
  v_add_f32 v210, v210, v23
  v_cvt_pk_bf16_f32 v19, v22, v23
  v_exp_f32 v48, v48
  v_exp_f32 v49, v49
  v_add_f32 v210, v210, v48
  v_exp_f32 v50, v50
  v_add_f32 v210, v210, v49
  v_cvt_pk_bf16_f32 v48, v48, v49
  v_exp_f32 v51, v51
  v_add_f32 v210, v210, v50
  v_add_f32 v210, v210, v51
  v_cvt_pk_bf16_f32 v49, v50, v51
  v_exp_f32 v52, v52
  v_exp_f32 v53, v53
  v_add_f32 v210, v210, v52
  v_exp_f32 v54, v54
  v_add_f32 v210, v210, v53
  v_cvt_pk_bf16_f32 v50, v52, v53
  v_exp_f32 v55, v55
  v_add_f32 v210, v210, v54
  v_add_f32 v210, v210, v55
  v_cvt_pk_bf16_f32 v51, v54, v55
  v_accvgpr_read_b32 v64, a8
  v_accvgpr_read_b32 v65, a9
  v_accvgpr_read_b32 v66, a10
  v_accvgpr_read_b32 v67, a11
  v_mul_f32 v64, v64, v201
  v_mul_f32 v65, v65, v201
  v_mul_f32 v66, v66, v201
  v_mul_f32 v67, v67, v201
  v_accvgpr_write_b32 a8, v64
  v_accvgpr_write_b32 a9, v65
  v_accvgpr_write_b32 a10, v66
  v_accvgpr_write_b32 a11, v67
  v_accvgpr_read_b32 v64, a24
  v_accvgpr_read_b32 v65, a25
  v_accvgpr_read_b32 v66, a26
  v_accvgpr_read_b32 v67, a27
  v_mul_f32 v64, v64, v201
  v_mul_f32 v65, v65, v201
  v_mul_f32 v66, v66, v201
  v_mul_f32 v67, v67, v201
  v_accvgpr_write_b32 a24, v64
  v_accvgpr_write_b32 a25, v65
  v_accvgpr_write_b32 a26, v66
  v_accvgpr_write_b32 a27, v67
  v_accvgpr_read_b32 v64, a40
  v_accvgpr_read_b32 v65, a41
  v_accvgpr_read_b32 v66, a42
  v_accvgpr_read_b32 v67, a43
  v_mul_f32 v64, v64, v201
  v_mul_f32 v65, v65, v201
  v_mul_f32 v66, v66, v201
  v_mul_f32 v67, v67, v201
  v_accvgpr_write_b32 a40, v64
  v_accvgpr_write_b32 a41, v65
  v_accvgpr_write_b32 a42, v66
  v_accvgpr_write_b32 a43, v67
  v_accvgpr_read_b32 v64, a56
  v_accvgpr_read_b32 v65, a57
  v_accvgpr_read_b32 v66, a58
  v_accvgpr_read_b32 v67, a59
  v_mul_f32 v64, v64, v201
  v_mul_f32 v65, v65, v201
  v_mul_f32 v66, v66, v201
  v_mul_f32 v67, v67, v201
  v_accvgpr_write_b32 a56, v64
  v_accvgpr_write_b32 a57, v65
  v_accvgpr_write_b32 a58, v66
  v_accvgpr_write_b32 a59, v67
  v_accvgpr_read_b32 v64, a72
  v_accvgpr_read_b32 v65, a73
  v_accvgpr_read_b32 v66, a74
  v_accvgpr_read_b32 v67, a75
  v_mul_f32 v64, v64, v201
  v_mul_f32 v65, v65, v201
  v_mul_f32 v66, v66, v201
  v_mul_f32 v67, v67, v201
  v_accvgpr_write_b32 a72, v64
  v_accvgpr_write_b32 a73, v65
  v_accvgpr_write_b32 a74, v66
  v_accvgpr_write_b32 a75, v67
  v_accvgpr_read_b32 v64, a88
  v_accvgpr_read_b32 v65, a89
  v_accvgpr_read_b32 v66, a90
  v_accvgpr_read_b32 v67, a91
  v_mul_f32 v64, v64, v201
  v_mul_f32 v65, v65, v201
  v_mul_f32 v66, v66, v201
  v_mul_f32 v67, v67, v201
  v_accvgpr_write_b32 a88, v64
  v_accvgpr_write_b32 a89, v65
  v_accvgpr_write_b32 a90, v66
  v_accvgpr_write_b32 a91, v67
  v_accvgpr_read_b32 v64, a104
  v_accvgpr_read_b32 v65, a105
  v_accvgpr_read_b32 v66, a106
  v_accvgpr_read_b32 v67, a107
  v_mul_f32 v64, v64, v201
  v_mul_f32 v65, v65, v201
  v_mul_f32 v66, v66, v201
  v_mul_f32 v67, v67, v201
  v_accvgpr_write_b32 a104, v64
  v_accvgpr_write_b32 a105, v65
  v_accvgpr_write_b32 a106, v66
  v_accvgpr_write_b32 a107, v67
  v_accvgpr_read_b32 v64, a120
  v_accvgpr_read_b32 v65, a121
  v_accvgpr_read_b32 v66, a122
  v_accvgpr_read_b32 v67, a123
  v_mul_f32 v64, v64, v201
  v_mul_f32 v65, v65, v201
  v_mul_f32 v66, v66, v201
  v_mul_f32 v67, v67, v201
  v_accvgpr_write_b32 a120, v64
  v_accvgpr_write_b32 a121, v65
  v_accvgpr_write_b32 a122, v66
  v_accvgpr_write_b32 a123, v67
  v_mov_b32 v204, v252
  v_max3_f32 v204, v204, v24, v25
  v_max3_f32 v204, v204, v26, v27
  v_max3_f32 v204, v204, v28, v29
  v_max3_f32 v204, v204, v30, v31
  v_max3_f32 v204, v204, v56, v57
  v_max3_f32 v204, v204, v58, v59
  v_max3_f32 v204, v204, v60, v61
  v_max3_f32 v204, v204, v62, v63
  v_mov_b32 v245, v204
  s_nop 1
  v_permlane16_swap_b32 v204, v245
  v_max_f32 v204, v204, v245
  v_mov_b32 v245, v204
  s_nop 1
  v_permlane32_swap_b32 v204, v245
  v_max_f32 v204, v204, v245
  v_sub_f32 v205, v252, v204
  v_exp_f32 v205, v205
  v_mov_b32 v252, v204
  v_mul_f32 v211, v211, v205
  v_sub_f32 v24, v24, v204
  v_sub_f32 v25, v25, v204
  v_sub_f32 v26, v26, v204
  v_sub_f32 v27, v27, v204
  v_sub_f32 v28, v28, v204
  v_sub_f32 v29, v29, v204
  v_sub_f32 v30, v30, v204
  v_sub_f32 v31, v31, v204
  v_sub_f32 v56, v56, v204
  v_sub_f32 v57, v57, v204
  v_sub_f32 v58, v58, v204
  v_sub_f32 v59, v59, v204
  v_sub_f32 v60, v60, v204
  v_sub_f32 v61, v61, v204
  v_sub_f32 v62, v62, v204
  v_sub_f32 v63, v63, v204
  v_exp_f32 v24, v24
  v_exp_f32 v25, v25
  v_add_f32 v211, v211, v24
  v_exp_f32 v26, v26
  v_add_f32 v211, v211, v25
  v_cvt_pk_bf16_f32 v24, v24, v25
  v_exp_f32 v27, v27
  v_add_f32 v211, v211, v26
  v_add_f32 v211, v211, v27
  v_cvt_pk_bf16_f32 v25, v26, v27
  v_exp_f32 v28, v28
  v_exp_f32 v29, v29
  v_add_f32 v211, v211, v28
  v_exp_f32 v30, v30
  v_add_f32 v211, v211, v29
  v_cvt_pk_bf16_f32 v26, v28, v29
  v_exp_f32 v31, v31
  v_add_f32 v211, v211, v30
  v_add_f32 v211, v211, v31
  v_cvt_pk_bf16_f32 v27, v30, v31
  v_exp_f32 v56, v56
  v_exp_f32 v57, v57
  v_add_f32 v211, v211, v56
  v_exp_f32 v58, v58
  v_add_f32 v211, v211, v57
  v_cvt_pk_bf16_f32 v56, v56, v57
  v_exp_f32 v59, v59
  v_add_f32 v211, v211, v58
  v_add_f32 v211, v211, v59
  v_cvt_pk_bf16_f32 v57, v58, v59
  v_exp_f32 v60, v60
  v_exp_f32 v61, v61
  v_add_f32 v211, v211, v60
  v_exp_f32 v62, v62
  v_add_f32 v211, v211, v61
  v_cvt_pk_bf16_f32 v58, v60, v61
  v_exp_f32 v63, v63
  v_add_f32 v211, v211, v62
  v_add_f32 v211, v211, v63
  v_cvt_pk_bf16_f32 v59, v62, v63
  v_accvgpr_read_b32 v64, a12
  v_accvgpr_read_b32 v65, a13
  v_accvgpr_read_b32 v66, a14
  v_accvgpr_read_b32 v67, a15
  v_mul_f32 v64, v64, v205
  v_mul_f32 v65, v65, v205
  v_mul_f32 v66, v66, v205
  v_mul_f32 v67, v67, v205
  v_accvgpr_write_b32 a12, v64
  v_accvgpr_write_b32 a13, v65
  v_accvgpr_write_b32 a14, v66
  v_accvgpr_write_b32 a15, v67
  v_accvgpr_read_b32 v64, a28
  v_accvgpr_read_b32 v65, a29
  v_accvgpr_read_b32 v66, a30
  v_accvgpr_read_b32 v67, a31
  v_mul_f32 v64, v64, v205
  v_mul_f32 v65, v65, v205
  v_mul_f32 v66, v66, v205
  v_mul_f32 v67, v67, v205
  v_accvgpr_write_b32 a28, v64
  v_accvgpr_write_b32 a29, v65
  v_accvgpr_write_b32 a30, v66
  v_accvgpr_write_b32 a31, v67
  v_accvgpr_read_b32 v64, a44
  v_accvgpr_read_b32 v65, a45
  v_accvgpr_read_b32 v66, a46
  v_accvgpr_read_b32 v67, a47
  v_mul_f32 v64, v64, v205
  v_mul_f32 v65, v65, v205
  v_mul_f32 v66, v66, v205
  v_mul_f32 v67, v67, v205
  v_accvgpr_write_b32 a44, v64
  v_accvgpr_write_b32 a45, v65
  v_accvgpr_write_b32 a46, v66
  v_accvgpr_write_b32 a47, v67
  v_accvgpr_read_b32 v64, a60
  v_accvgpr_read_b32 v65, a61
  v_accvgpr_read_b32 v66, a62
  v_accvgpr_read_b32 v67, a63
  v_mul_f32 v64, v64, v205
  v_mul_f32 v65, v65, v205
  v_mul_f32 v66, v66, v205
  v_mul_f32 v67, v67, v205
  v_accvgpr_write_b32 a60, v64
  v_accvgpr_write_b32 a61, v65
  v_accvgpr_write_b32 a62, v66
  v_accvgpr_write_b32 a63, v67
  v_accvgpr_read_b32 v64, a76
  v_accvgpr_read_b32 v65, a77
  v_accvgpr_read_b32 v66, a78
  v_accvgpr_read_b32 v67, a79
  v_mul_f32 v64, v64, v205
  v_mul_f32 v65, v65, v205
  v_mul_f32 v66, v66, v205
  v_mul_f32 v67, v67, v205
  v_accvgpr_write_b32 a76, v64
  v_accvgpr_write_b32 a77, v65
  v_accvgpr_write_b32 a78, v66
  v_accvgpr_write_b32 a79, v67
  v_accvgpr_read_b32 v64, a92
  v_accvgpr_read_b32 v65, a93
  v_accvgpr_read_b32 v66, a94
  v_accvgpr_read_b32 v67, a95
  v_mul_f32 v64, v64, v205
  v_mul_f32 v65, v65, v205
  v_mul_f32 v66, v66, v205
  v_mul_f32 v67, v67, v205
  v_accvgpr_write_b32 a92, v64
  v_accvgpr_write_b32 a93, v65
  v_accvgpr_write_b32 a94, v66
  v_accvgpr_write_b32 a95, v67
  v_accvgpr_read_b32 v64, a108
  v_accvgpr_read_b32 v65, a109
  v_accvgpr_read_b32 v66, a110
  v_accvgpr_read_b32 v67, a111
  v_mul_f32 v64, v64, v205
  v_mul_f32 v65, v65, v205
  v_mul_f32 v66, v66, v205
  v_mul_f32 v67, v67, v205
  v_accvgpr_write_b32 a108, v64
  v_accvgpr_write_b32 a109, v65
  v_accvgpr_write_b32 a110, v66
  v_accvgpr_write_b32 a111, v67
  v_accvgpr_read_b32 v64, a124
  v_accvgpr_read_b32 v65, a125
  v_accvgpr_read_b32 v66, a126
  v_accvgpr_read_b32 v67, a127
  v_mul_f32 v64, v64, v205
  v_mul_f32 v65, v65, v205
  v_mul_f32 v66, v66, v205
  v_mul_f32 v67, v67, v205
  v_accvgpr_write_b32 a124, v64
  v_accvgpr_write_b32 a125, v65
  v_accvgpr_write_b32 a126, v66
  v_accvgpr_write_b32 a127, v67
  ds_read_b64_tr_b16 a[160:161], v216 offset:49152
  ds_read_b64_tr_b16 a[162:163], v216 offset:53248
  ds_read_b64_tr_b16 a[164:165], v216 offset:57344
  ds_read_b64_tr_b16 a[166:167], v216 offset:61440
  s_waitcnt lgkmcnt(2)
  v_mfma_f32_16x16x32_bf16 a[0:3], a[160:163], v[0:3], a[0:3]
  s_waitcnt lgkmcnt(0)
  v_mfma_f32_16x16x32_bf16 a[0:3], a[164:167], v[32:35], a[0:3]
  v_mfma_f32_16x16x32_bf16 a[4:7], a[164:167], v[40:43], a[4:7]
  v_mfma_f32_16x16x32_bf16 a[4:7], a[160:163], v[8:11], a[4:7]
  v_mfma_f32_16x16x32_bf16 a[8:11], a[160:163], v[16:19], a[8:11]
  v_mfma_f32_16x16x32_bf16 a[8:11], a[164:167], v[48:51], a[8:11]
  v_mfma_f32_16x16x32_bf16 a[12:15], a[164:167], v[56:59], a[12:15]
  v_mfma_f32_16x16x32_bf16 a[12:15], a[160:163], v[24:27], a[12:15]
  ds_read_b64_tr_b16 a[168:169], v217 offset:49152
  ds_read_b64_tr_b16 a[170:171], v217 offset:53248
  ds_read_b64_tr_b16 a[172:173], v217 offset:57344
  ds_read_b64_tr_b16 a[174:175], v217 offset:61440
  s_waitcnt lgkmcnt(2)
  v_mfma_f32_16x16x32_bf16 a[16:19], a[168:171], v[0:3], a[16:19]
  s_waitcnt lgkmcnt(0)
  v_mfma_f32_16x16x32_bf16 a[16:19], a[172:175], v[32:35], a[16:19]
  v_mfma_f32_16x16x32_bf16 a[20:23], a[172:175], v[40:43], a[20:23]
  v_mfma_f32_16x16x32_bf16 a[20:23], a[168:171], v[8:11], a[20:23]
  v_mfma_f32_16x16x32_bf16 a[24:27], a[168:171], v[16:19], a[24:27]
  v_mfma_f32_16x16x32_bf16 a[24:27], a[172:175], v[48:51], a[24:27]
  v_mfma_f32_16x16x32_bf16 a[28:31], a[172:175], v[56:59], a[28:31]
  v_mfma_f32_16x16x32_bf16 a[28:31], a[168:171], v[24:27], a[28:31]
  ds_read_b64_tr_b16 a[176:177], v218 offset:49152
  ds_read_b64_tr_b16 a[178:179], v218 offset:53248
  ds_read_b64_tr_b16 a[180:181], v218 offset:57344
  ds_read_b64_tr_b16 a[182:183], v218 offset:61440
  s_waitcnt lgkmcnt(2)
  v_mfma_f32_16x16x32_bf16 a[32:35], a[176:179], v[0:3], a[32:35]
  s_waitcnt lgkmcnt(0)
  v_mfma_f32_16x16x32_bf16 a[32:35], a[180:183], v[32:35], a[32:35]
  v_mfma_f32_16x16x32_bf16 a[36:39], a[180:183], v[40:43], a[36:39]
  v_mfma_f32_16x16x32_bf16 a[36:39], a[176:179], v[8:11], a[36:39]
  v_mfma_f32_16x16x32_bf16 a[40:43], a[176:179], v[16:19], a[40:43]
  v_mfma_f32_16x16x32_bf16 a[40:43], a[180:183], v[48:51], a[40:43]
  v_mfma_f32_16x16x32_bf16 a[44:47], a[180:183], v[56:59], a[44:47]
  v_mfma_f32_16x16x32_bf16 a[44:47], a[176:179], v[24:27], a[44:47]
  ds_read_b64_tr_b16 a[184:185], v219 offset:49152
  ds_read_b64_tr_b16 a[186:187], v219 offset:53248
  ds_read_b64_tr_b16 a[188:189], v219 offset:57344
  ds_read_b64_tr_b16 a[190:191], v219 offset:61440
  s_waitcnt lgkmcnt(2)
  v_mfma_f32_16x16x32_bf16 a[48:51], a[184:187], v[0:3], a[48:51]
  s_waitcnt lgkmcnt(0)
  v_mfma_f32_16x16x32_bf16 a[48:51], a[188:191], v[32:35], a[48:51]
  v_mfma_f32_16x16x32_bf16 a[52:55], a[188:191], v[40:43], a[52:55]
  v_mfma_f32_16x16x32_bf16 a[52:55], a[184:187], v[8:11], a[52:55]
  v_mfma_f32_16x16x32_bf16 a[56:59], a[184:187], v[16:19], a[56:59]
  v_mfma_f32_16x16x32_bf16 a[56:59], a[188:191], v[48:51], a[56:59]
  v_mfma_f32_16x16x32_bf16 a[60:63], a[188:191], v[56:59], a[60:63]
  v_mfma_f32_16x16x32_bf16 a[60:63], a[184:187], v[24:27], a[60:63]
  ds_read_b64_tr_b16 a[160:161], v220 offset:49152
  ds_read_b64_tr_b16 a[162:163], v220 offset:53248
  ds_read_b64_tr_b16 a[164:165], v220 offset:57344
  ds_read_b64_tr_b16 a[166:167], v220 offset:61440
  s_waitcnt lgkmcnt(2)
  v_mfma_f32_16x16x32_bf16 a[64:67], a[160:163], v[0:3], a[64:67]
  s_waitcnt lgkmcnt(0)
  v_mfma_f32_16x16x32_bf16 a[64:67], a[164:167], v[32:35], a[64:67]
  v_mfma_f32_16x16x32_bf16 a[68:71], a[164:167], v[40:43], a[68:71]
  v_mfma_f32_16x16x32_bf16 a[68:71], a[160:163], v[8:11], a[68:71]
  v_mfma_f32_16x16x32_bf16 a[72:75], a[160:163], v[16:19], a[72:75]
  v_mfma_f32_16x16x32_bf16 a[72:75], a[164:167], v[48:51], a[72:75]
  v_mfma_f32_16x16x32_bf16 a[76:79], a[164:167], v[56:59], a[76:79]
  v_mfma_f32_16x16x32_bf16 a[76:79], a[160:163], v[24:27], a[76:79]
  ds_read_b64_tr_b16 a[168:169], v221 offset:49152
  ds_read_b64_tr_b16 a[170:171], v221 offset:53248
  ds_read_b64_tr_b16 a[172:173], v221 offset:57344
  ds_read_b64_tr_b16 a[174:175], v221 offset:61440
  s_waitcnt lgkmcnt(2)
  v_mfma_f32_16x16x32_bf16 a[80:83], a[168:171], v[0:3], a[80:83]
  s_waitcnt lgkmcnt(0)
  v_mfma_f32_16x16x32_bf16 a[80:83], a[172:175], v[32:35], a[80:83]
  v_mfma_f32_16x16x32_bf16 a[84:87], a[172:175], v[40:43], a[84:87]
  v_mfma_f32_16x16x32_bf16 a[84:87], a[168:171], v[8:11], a[84:87]
  v_mfma_f32_16x16x32_bf16 a[88:91], a[168:171], v[16:19], a[88:91]
  v_mfma_f32_16x16x32_bf16 a[88:91], a[172:175], v[48:51], a[88:91]
  v_mfma_f32_16x16x32_bf16 a[92:95], a[172:175], v[56:59], a[92:95]
  v_mfma_f32_16x16x32_bf16 a[92:95], a[168:171], v[24:27], a[92:95]
  ds_read_b64_tr_b16 a[176:177], v222 offset:49152
  ds_read_b64_tr_b16 a[178:179], v222 offset:53248
  ds_read_b64_tr_b16 a[180:181], v222 offset:57344
  ds_read_b64_tr_b16 a[182:183], v222 offset:61440
  s_waitcnt lgkmcnt(2)
  v_mfma_f32_16x16x32_bf16 a[96:99], a[176:179], v[0:3], a[96:99]
  s_waitcnt lgkmcnt(0)
  v_mfma_f32_16x16x32_bf16 a[96:99], a[180:183], v[32:35], a[96:99]
  v_mfma_f32_16x16x32_bf16 a[100:103], a[180:183], v[40:43], a[100:103]
  v_mfma_f32_16x16x32_bf16 a[100:103], a[176:179], v[8:11], a[100:103]
  v_mfma_f32_16x16x32_bf16 a[104:107], a[176:179], v[16:19], a[104:107]
  v_mfma_f32_16x16x32_bf16 a[104:107], a[180:183], v[48:51], a[104:107]
  v_mfma_f32_16x16x32_bf16 a[108:111], a[180:183], v[56:59], a[108:111]
  v_mfma_f32_16x16x32_bf16 a[108:111], a[176:179], v[24:27], a[108:111]
  ds_read_b64_tr_b16 a[184:185], v223 offset:49152
  ds_read_b64_tr_b16 a[186:187], v223 offset:53248
  ds_read_b64_tr_b16 a[188:189], v223 offset:57344
  ds_read_b64_tr_b16 a[190:191], v223 offset:61440
  s_waitcnt lgkmcnt(2)
  v_mfma_f32_16x16x32_bf16 a[112:115], a[184:187], v[0:3], a[112:115]
  s_waitcnt lgkmcnt(0)
  v_mfma_f32_16x16x32_bf16 a[112:115], a[188:191], v[32:35], a[112:115]
  v_mfma_f32_16x16x32_bf16 a[116:119], a[188:191], v[40:43], a[116:119]
  v_mfma_f32_16x16x32_bf16 a[116:119], a[184:187], v[8:11], a[116:119]
  v_mfma_f32_16x16x32_bf16 a[120:123], a[184:187], v[16:19], a[120:123]
  v_mfma_f32_16x16x32_bf16 a[120:123], a[188:191], v[48:51], a[120:123]
  v_mfma_f32_16x16x32_bf16 a[124:127], a[188:191], v[56:59], a[124:127]
  v_mfma_f32_16x16x32_bf16 a[124:127], a[184:187], v[24:27], a[124:127]
  s_add_u32 s29, s29, 16384
  s_cmp_lt_u32 s29, 524288
  s_cbranch_scc1 attn_slow
  v_mov_b32 v245, v208
  v_mov_b32 v246, v209
  v_mov_b32 v247, v210
  v_mov_b32 v248, v211
  v_permlane16_swap_b32 v208, v245
  v_permlane16_swap_b32 v209, v246
  v_permlane16_swap_b32 v210, v247
  v_permlane16_swap_b32 v211, v248
  v_add_f32 v208, v208, v245
  v_add_f32 v209, v209, v246
  v_add_f32 v210, v210, v247
  v_add_f32 v211, v211, v248
  v_mov_b32 v245, v208
  v_mov_b32 v246, v209
  v_mov_b32 v247, v210
  v_mov_b32 v248, v211
  v_permlane32_swap_b32 v208, v245
  v_permlane32_swap_b32 v209, v246
  v_permlane32_swap_b32 v210, v247
  v_permlane32_swap_b32 v211, v248
  v_add_f32 v208, v208, v245
  v_add_f32 v209, v209, v246
  v_add_f32 v210, v210, v247
  v_add_f32 v211, v211, v248
  v_rcp_f32 v192, v208
  v_rcp_f32 v196, v209
  v_rcp_f32 v200, v210
  v_rcp_f32 v204, v211
  v_accvgpr_read_b32 v0, a0
  v_accvgpr_read_b32 v1, a1
  v_accvgpr_read_b32 v2, a2
  v_accvgpr_read_b32 v3, a3
  v_accvgpr_read_b32 v4, a16
  v_accvgpr_read_b32 v5, a17
  v_accvgpr_read_b32 v6, a18
  v_accvgpr_read_b32 v7, a19
  v_mul_f32 v0, v0, v192
  v_mul_f32 v1, v1, v192
  v_mul_f32 v2, v2, v192
  v_mul_f32 v3, v3, v192
  v_mul_f32 v4, v4, v192
  v_mul_f32 v5, v5, v192
  v_mul_f32 v6, v6, v192
  v_mul_f32 v7, v7, v192
  v_cvt_pk_bf16_f32 v0, v0, v1
  v_cvt_pk_bf16_f32 v1, v2, v3
  v_cvt_pk_bf16_f32 v2, v4, v5
  v_cvt_pk_bf16_f32 v3, v6, v7
  buffer_store_dwordx4 v[0:3], v244, s[24:27], s40 offen offset:0 sc1
  v_accvgpr_read_b32 v8, a4
  v_accvgpr_read_b32 v9, a5
  v_accvgpr_read_b32 v10, a6
  v_accvgpr_read_b32 v11, a7
  v_accvgpr_read_b32 v12, a20
  v_accvgpr_read_b32 v13, a21
  v_accvgpr_read_b32 v14, a22
  v_accvgpr_read_b32 v15, a23
  v_mul_f32 v8, v8, v196
  v_mul_f32 v9, v9, v196
  v_mul_f32 v10, v10, v196
  v_mul_f32 v11, v11, v196
  v_mul_f32 v12, v12, v196
  v_mul_f32 v13, v13, v196
  v_mul_f32 v14, v14, v196
  v_mul_f32 v15, v15, v196
  v_cvt_pk_bf16_f32 v8, v8, v9
  v_cvt_pk_bf16_f32 v9, v10, v11
  v_cvt_pk_bf16_f32 v10, v12, v13
  v_cvt_pk_bf16_f32 v11, v14, v15
  buffer_store_dwordx4 v[8:11], v244, s[24:27], s40 offen offset:2048 sc1
  v_accvgpr_read_b32 v16, a8
  v_accvgpr_read_b32 v17, a9
  v_accvgpr_read_b32 v18, a10
  v_accvgpr_read_b32 v19, a11
  v_accvgpr_read_b32 v20, a24
  v_accvgpr_read_b32 v21, a25
  v_accvgpr_read_b32 v22, a26
  v_accvgpr_read_b32 v23, a27
  v_mul_f32 v16, v16, v200
  v_mul_f32 v17, v17, v200
  v_mul_f32 v18, v18, v200
  v_mul_f32 v19, v19, v200
  v_mul_f32 v20, v20, v200
  v_mul_f32 v21, v21, v200
  v_mul_f32 v22, v22, v200
  v_mul_f32 v23, v23, v200
  v_cvt_pk_bf16_f32 v16, v16, v17
  v_cvt_pk_bf16_f32 v17, v18, v19
  v_cvt_pk_bf16_f32 v18, v20, v21
  v_cvt_pk_bf16_f32 v19, v22, v23
  buffer_store_dwordx4 v[16:19], v244, s[24:27], s41 offen offset:0 sc1
  v_accvgpr_read_b32 v24, a12
  v_accvgpr_read_b32 v25, a13
  v_accvgpr_read_b32 v26, a14
  v_accvgpr_read_b32 v27, a15
  v_accvgpr_read_b32 v28, a28
  v_accvgpr_read_b32 v29, a29
  v_accvgpr_read_b32 v30, a30
  v_accvgpr_read_b32 v31, a31
  v_mul_f32 v24, v24, v204
  v_mul_f32 v25, v25, v204
  v_mul_f32 v26, v26, v204
  v_mul_f32 v27, v27, v204
  v_mul_f32 v28, v28, v204
  v_mul_f32 v29, v29, v204
  v_mul_f32 v30, v30, v204
  v_mul_f32 v31, v31, v204
  v_cvt_pk_bf16_f32 v24, v24, v25
  v_cvt_pk_bf16_f32 v25, v26, v27
  v_cvt_pk_bf16_f32 v26, v28, v29
  v_cvt_pk_bf16_f32 v27, v30, v31
  buffer_store_dwordx4 v[24:27], v244, s[24:27], s41 offen offset:2048 sc1
  v_accvgpr_read_b32 v32, a32
  v_accvgpr_read_b32 v33, a33
  v_accvgpr_read_b32 v34, a34
  v_accvgpr_read_b32 v35, a35
  v_accvgpr_read_b32 v36, a48
  v_accvgpr_read_b32 v37, a49
  v_accvgpr_read_b32 v38, a50
  v_accvgpr_read_b32 v39, a51
  v_mul_f32 v32, v32, v192
  v_mul_f32 v33, v33, v192
  v_mul_f32 v34, v34, v192
  v_mul_f32 v35, v35, v192
  v_mul_f32 v36, v36, v192
  v_mul_f32 v37, v37, v192
  v_mul_f32 v38, v38, v192
  v_mul_f32 v39, v39, v192
  v_cvt_pk_bf16_f32 v32, v32, v33
  v_cvt_pk_bf16_f32 v33, v34, v35
  v_cvt_pk_bf16_f32 v34, v36, v37
  v_cvt_pk_bf16_f32 v35, v38, v39
  buffer_store_dwordx4 v[32:35], v244, s[24:27], s40 offen offset:1024 sc1
  v_accvgpr_read_b32 v40, a36
  v_accvgpr_read_b32 v41, a37
  v_accvgpr_read_b32 v42, a38
  v_accvgpr_read_b32 v43, a39
  v_accvgpr_read_b32 v44, a52
  v_accvgpr_read_b32 v45, a53
  v_accvgpr_read_b32 v46, a54
  v_accvgpr_read_b32 v47, a55
  v_mul_f32 v40, v40, v196
  v_mul_f32 v41, v41, v196
  v_mul_f32 v42, v42, v196
  v_mul_f32 v43, v43, v196
  v_mul_f32 v44, v44, v196
  v_mul_f32 v45, v45, v196
  v_mul_f32 v46, v46, v196
  v_mul_f32 v47, v47, v196
  v_cvt_pk_bf16_f32 v40, v40, v41
  v_cvt_pk_bf16_f32 v41, v42, v43
  v_cvt_pk_bf16_f32 v42, v44, v45
  v_cvt_pk_bf16_f32 v43, v46, v47
  buffer_store_dwordx4 v[40:43], v244, s[24:27], s40 offen offset:3072 sc1
  v_accvgpr_read_b32 v48, a40
  v_accvgpr_read_b32 v49, a41
  v_accvgpr_read_b32 v50, a42
  v_accvgpr_read_b32 v51, a43
  v_accvgpr_read_b32 v52, a56
  v_accvgpr_read_b32 v53, a57
  v_accvgpr_read_b32 v54, a58
  v_accvgpr_read_b32 v55, a59
  v_mul_f32 v48, v48, v200
  v_mul_f32 v49, v49, v200
  v_mul_f32 v50, v50, v200
  v_mul_f32 v51, v51, v200
  v_mul_f32 v52, v52, v200
  v_mul_f32 v53, v53, v200
  v_mul_f32 v54, v54, v200
  v_mul_f32 v55, v55, v200
  v_cvt_pk_bf16_f32 v48, v48, v49
  v_cvt_pk_bf16_f32 v49, v50, v51
  v_cvt_pk_bf16_f32 v50, v52, v53
  v_cvt_pk_bf16_f32 v51, v54, v55
  buffer_store_dwordx4 v[48:51], v244, s[24:27], s41 offen offset:1024 sc1
  v_accvgpr_read_b32 v56, a44
  v_accvgpr_read_b32 v57, a45
  v_accvgpr_read_b32 v58, a46
  v_accvgpr_read_b32 v59, a47
  v_accvgpr_read_b32 v60, a60
  v_accvgpr_read_b32 v61, a61
  v_accvgpr_read_b32 v62, a62
  v_accvgpr_read_b32 v63, a63
  v_mul_f32 v56, v56, v204
  v_mul_f32 v57, v57, v204
  v_mul_f32 v58, v58, v204
  v_mul_f32 v59, v59, v204
  v_mul_f32 v60, v60, v204
  v_mul_f32 v61, v61, v204
  v_mul_f32 v62, v62, v204
  v_mul_f32 v63, v63, v204
  v_cvt_pk_bf16_f32 v56, v56, v57
  v_cvt_pk_bf16_f32 v57, v58, v59
  v_cvt_pk_bf16_f32 v58, v60, v61
  v_cvt_pk_bf16_f32 v59, v62, v63
  buffer_store_dwordx4 v[56:59], v244, s[24:27], s41 offen offset:3072 sc1
  v_accvgpr_read_b32 v0, a64
  v_accvgpr_read_b32 v1, a65
  v_accvgpr_read_b32 v2, a66
  v_accvgpr_read_b32 v3, a67
  v_accvgpr_read_b32 v4, a80
  v_accvgpr_read_b32 v5, a81
  v_accvgpr_read_b32 v6, a82
  v_accvgpr_read_b32 v7, a83
  v_mul_f32 v0, v0, v192
  v_mul_f32 v1, v1, v192
  v_mul_f32 v2, v2, v192
  v_mul_f32 v3, v3, v192
  v_mul_f32 v4, v4, v192
  v_mul_f32 v5, v5, v192
  v_mul_f32 v6, v6, v192
  v_mul_f32 v7, v7, v192
  v_cvt_pk_bf16_f32 v0, v0, v1
  v_cvt_pk_bf16_f32 v1, v2, v3
  v_cvt_pk_bf16_f32 v2, v4, v5
  v_cvt_pk_bf16_f32 v3, v6, v7
  buffer_store_dwordx4 v[0:3], v244, s[24:27], s42 offen offset:0 sc1
  v_accvgpr_read_b32 v8, a68
  v_accvgpr_read_b32 v9, a69
  v_accvgpr_read_b32 v10, a70
  v_accvgpr_read_b32 v11, a71
  v_accvgpr_read_b32 v12, a84
  v_accvgpr_read_b32 v13, a85
  v_accvgpr_read_b32 v14, a86
  v_accvgpr_read_b32 v15, a87
  v_mul_f32 v8, v8, v196
  v_mul_f32 v9, v9, v196
  v_mul_f32 v10, v10, v196
  v_mul_f32 v11, v11, v196
  v_mul_f32 v12, v12, v196
  v_mul_f32 v13, v13, v196
  v_mul_f32 v14, v14, v196
  v_mul_f32 v15, v15, v196
  v_cvt_pk_bf16_f32 v8, v8, v9
  v_cvt_pk_bf16_f32 v9, v10, v11
  v_cvt_pk_bf16_f32 v10, v12, v13
  v_cvt_pk_bf16_f32 v11, v14, v15
  buffer_store_dwordx4 v[8:11], v244, s[24:27], s42 offen offset:2048 sc1
  v_accvgpr_read_b32 v16, a72
  v_accvgpr_read_b32 v17, a73
  v_accvgpr_read_b32 v18, a74
  v_accvgpr_read_b32 v19, a75
  v_accvgpr_read_b32 v20, a88
  v_accvgpr_read_b32 v21, a89
  v_accvgpr_read_b32 v22, a90
  v_accvgpr_read_b32 v23, a91
  v_mul_f32 v16, v16, v200
  v_mul_f32 v17, v17, v200
  v_mul_f32 v18, v18, v200
  v_mul_f32 v19, v19, v200
  v_mul_f32 v20, v20, v200
  v_mul_f32 v21, v21, v200
  v_mul_f32 v22, v22, v200
  v_mul_f32 v23, v23, v200
  v_cvt_pk_bf16_f32 v16, v16, v17
  v_cvt_pk_bf16_f32 v17, v18, v19
  v_cvt_pk_bf16_f32 v18, v20, v21
  v_cvt_pk_bf16_f32 v19, v22, v23
  buffer_store_dwordx4 v[16:19], v244, s[24:27], s43 offen offset:0 sc1
  v_accvgpr_read_b32 v24, a76
  v_accvgpr_read_b32 v25, a77
  v_accvgpr_read_b32 v26, a78
  v_accvgpr_read_b32 v27, a79
  v_accvgpr_read_b32 v28, a92
  v_accvgpr_read_b32 v29, a93
  v_accvgpr_read_b32 v30, a94
  v_accvgpr_read_b32 v31, a95
  v_mul_f32 v24, v24, v204
  v_mul_f32 v25, v25, v204
  v_mul_f32 v26, v26, v204
  v_mul_f32 v27, v27, v204
  v_mul_f32 v28, v28, v204
  v_mul_f32 v29, v29, v204
  v_mul_f32 v30, v30, v204
  v_mul_f32 v31, v31, v204
  v_cvt_pk_bf16_f32 v24, v24, v25
  v_cvt_pk_bf16_f32 v25, v26, v27
  v_cvt_pk_bf16_f32 v26, v28, v29
  v_cvt_pk_bf16_f32 v27, v30, v31
  buffer_store_dwordx4 v[24:27], v244, s[24:27], s43 offen offset:2048 sc1
  v_accvgpr_read_b32 v32, a96
  v_accvgpr_read_b32 v33, a97
  v_accvgpr_read_b32 v34, a98
  v_accvgpr_read_b32 v35, a99
  v_accvgpr_read_b32 v36, a112
  v_accvgpr_read_b32 v37, a113
  v_accvgpr_read_b32 v38, a114
  v_accvgpr_read_b32 v39, a115
  v_mul_f32 v32, v32, v192
  v_mul_f32 v33, v33, v192
  v_mul_f32 v34, v34, v192
  v_mul_f32 v35, v35, v192
  v_mul_f32 v36, v36, v192
  v_mul_f32 v37, v37, v192
  v_mul_f32 v38, v38, v192
  v_mul_f32 v39, v39, v192
  v_cvt_pk_bf16_f32 v32, v32, v33
  v_cvt_pk_bf16_f32 v33, v34, v35
  v_cvt_pk_bf16_f32 v34, v36, v37
  v_cvt_pk_bf16_f32 v35, v38, v39
  buffer_store_dwordx4 v[32:35], v244, s[24:27], s42 offen offset:1024 sc1
  v_accvgpr_read_b32 v40, a100
  v_accvgpr_read_b32 v41, a101
  v_accvgpr_read_b32 v42, a102
  v_accvgpr_read_b32 v43, a103
  v_accvgpr_read_b32 v44, a116
  v_accvgpr_read_b32 v45, a117
  v_accvgpr_read_b32 v46, a118
  v_accvgpr_read_b32 v47, a119
  v_mul_f32 v40, v40, v196
  v_mul_f32 v41, v41, v196
  v_mul_f32 v42, v42, v196
  v_mul_f32 v43, v43, v196
  v_mul_f32 v44, v44, v196
  v_mul_f32 v45, v45, v196
  v_mul_f32 v46, v46, v196
  v_mul_f32 v47, v47, v196
  v_cvt_pk_bf16_f32 v40, v40, v41
  v_cvt_pk_bf16_f32 v41, v42, v43
  v_cvt_pk_bf16_f32 v42, v44, v45
  v_cvt_pk_bf16_f32 v43, v46, v47
  buffer_store_dwordx4 v[40:43], v244, s[24:27], s42 offen offset:3072 sc1
  v_accvgpr_read_b32 v48, a104
  v_accvgpr_read_b32 v49, a105
  v_accvgpr_read_b32 v50, a106
  v_accvgpr_read_b32 v51, a107
  v_accvgpr_read_b32 v52, a120
  v_accvgpr_read_b32 v53, a121
  v_accvgpr_read_b32 v54, a122
  v_accvgpr_read_b32 v55, a123
  v_mul_f32 v48, v48, v200
  v_mul_f32 v49, v49, v200
  v_mul_f32 v50, v50, v200
  v_mul_f32 v51, v51, v200
  v_mul_f32 v52, v52, v200
  v_mul_f32 v53, v53, v200
  v_mul_f32 v54, v54, v200
  v_mul_f32 v55, v55, v200
  v_cvt_pk_bf16_f32 v48, v48, v49
  v_cvt_pk_bf16_f32 v49, v50, v51
  v_cvt_pk_bf16_f32 v50, v52, v53
  v_cvt_pk_bf16_f32 v51, v54, v55
  buffer_store_dwordx4 v[48:51], v244, s[24:27], s43 offen offset:1024 sc1
  v_accvgpr_read_b32 v56, a108
  v_accvgpr_read_b32 v57, a109
  v_accvgpr_read_b32 v58, a110
  v_accvgpr_read_b32 v59, a111
  v_accvgpr_read_b32 v60, a124
  v_accvgpr_read_b32 v61, a125
  v_accvgpr_read_b32 v62, a126
  v_accvgpr_read_b32 v63, a127
  v_mul_f32 v56, v56, v204
  v_mul_f32 v57, v57, v204
  v_mul_f32 v58, v58, v204
  v_mul_f32 v59, v59, v204
  v_mul_f32 v60, v60, v204
  v_mul_f32 v61, v61, v204
  v_mul_f32 v62, v62, v204
  v_mul_f32 v63, v63, v204
  v_cvt_pk_bf16_f32 v56, v56, v57
  v_cvt_pk_bf16_f32 v57, v58, v59
  v_cvt_pk_bf16_f32 v58, v60, v61
  v_cvt_pk_bf16_f32 v59, v62, v63
  buffer_store_dwordx4 v[56:59], v244, s[24:27], s43 offen offset:3072 sc1
  v_add_u32 v252, 4096, v242
  v_add_u32 v253, 8192, v242
  buffer_load_dwordx4 a[128:131], v253, s[24:27], s4 offen offset:3072 sc1
  buffer_load_dwordx4 a[132:135], v242, s[24:27], s5 offen offset:0 sc1
  buffer_load_dwordx4 a[136:139], v242, s[24:27], s5 offen offset:1024 sc1
  buffer_load_dwordx4 a[140:143], v242, s[24:27], s5 offen offset:2048 sc1
  buffer_load_dwordx4 a[144:147], v242, s[24:27], s5 offen offset:3072 sc1
  buffer_load_dwordx4 a[148:151], v252, s[24:27], s5 offen offset:0 sc1
  buffer_load_dwordx4 a[152:155], v252, s[24:27], s5 offen offset:1024 sc1
  buffer_load_dwordx4 a[156:159], v252, s[24:27], s5 offen offset:2048 sc1
  buffer_load_dwordx4 a[0:3], v252, s[24:27], s5 offen offset:3072 sc1
  buffer_load_dwordx4 a[4:7], v253, s[24:27], s5 offen offset:0 sc1
  buffer_load_dwordx4 a[8:11], v253, s[24:27], s5 offen offset:1024 sc1
  buffer_load_dwordx4 a[12:15], v253, s[24:27], s5 offen offset:2048 sc1
  buffer_load_dwordx4 a[16:19], v253, s[24:27], s5 offen offset:3072 sc1
  buffer_load_dwordx4 a[20:23], v242, s[24:27], s6 offen offset:0 sc1
  buffer_load_dwordx4 a[24:27], v242, s[24:27], s6 offen offset:1024 sc1
  buffer_load_dwordx4 a[28:31], v242, s[24:27], s6 offen offset:2048 sc1
  buffer_load_dwordx4 a[32:35], v242, s[24:27], s6 offen offset:3072 sc1
  buffer_load_dwordx4 a[36:39], v252, s[24:27], s6 offen offset:0 sc1
  buffer_load_dwordx4 a[40:43], v252, s[24:27], s6 offen offset:1024 sc1
  buffer_load_dwordx4 a[44:47], v252, s[24:27], s6 offen offset:2048 sc1
  buffer_load_dwordx4 a[48:51], v252, s[24:27], s6 offen offset:3072 sc1
  buffer_load_dwordx4 a[52:55], v253, s[24:27], s6 offen offset:0 sc1
  s_bfe_u32 s39, s2, 0x40002
  s_lshl_b32 s39, s39, 8
  s_add_u32 s39, s39, 2818304
  s_lshl_b32 s38, s3, 26
  v_lshlrev_b32 v64, 22, v242
  v_or_b32 v64, s38, v64
  v_mov_b32 v65, 1
  s_waitcnt vmcnt(0)
  s_barrier
  s_branch tail_go
.section .rodata,"a"
.p2align 6
.amdhsa_kernel recurrent_scan__mha_block_cached__moe_arch_mod__prompt_kernel
  .amdhsa_next_free_vgpr 512
  .amdhsa_next_free_sgpr 102
  .amdhsa_accum_offset 256
  .amdhsa_group_segment_fixed_size 0
  .amdhsa_kernarg_size 104
  .amdhsa_user_sgpr_count 2
  .amdhsa_user_sgpr_kernarg_segment_ptr 1
  .amdhsa_system_sgpr_workgroup_id_x 1
.end_amdhsa_kernel
```

```asm
; @launch grid=(256,1,1) block=(256,1,1) lds=163840
.amdgcn_target "amdgcn-amd-amdhsa--gfx950"
.text
.globl recurrent_scan__mha_block_cached__moe_arch_mod__prompt_kernel
.p2align 8
.type recurrent_scan__mha_block_cached__moe_arch_mod__prompt_kernel,@function
recurrent_scan__mha_block_cached__moe_arch_mod__prompt_kernel:
  s_cmp_ge_u32 s2, 256
  s_cbranch_scc1 attn_end
  s_load_dwordx2 s[60:61], s[0:1], 0
  s_load_dwordx2 s[48:49], s[0:1], 48
  s_load_dwordx4 s[4:7], s[0:1], 8
  s_load_dwordx2 s[8:9], s[0:1], 24
  s_load_dwordx2 s[10:11], s[0:1], 96
  s_load_dwordx2 s[88:89], s[0:1], 32
  s_load_dwordx2 s[90:91], s[0:1], 56
  s_load_dwordx4 s[92:95], s[0:1], 64
  s_load_dwordx2 s[96:97], s[0:1], 88
  s_load_dwordx2 s[62:63], s[0:1], 80
  v_lshrrev_b32 v249, 6, v0
  v_and_b32 v0, 63, v0
  v_mov_b32 v245, v0
  v_readfirstlane_b32 s3, v249
  s_and_b32 s36, s2, 7
  s_lshl_b32 s36, s36, 2
  s_lshr_b32 s37, s2, 6
  s_add_u32 s36, s36, s37
  s_bfe_u32 s37, s2, 0x30003
  s_lshl_b32 s37, s37, 2
  s_add_u32 s37, s37, s3
  s_lshl_b32 s28, s3, 12
  v_lshrrev_b32 v248, 4, v245
  v_and_b32 v247, 15, v245
  s_lshl_b32 s38, s3, 17
  v_lshlrev_b32 v249, 13, v248
  v_add_u32 v249, s38, v249
  v_or_b32 v250, 0, v248
  v_lshlrev_b32 v250, 1, v250
  v_xor_b32 v250, v250, v247
  v_lshl_add_u32 v238, v250, 4, v249
  v_or_b32 v250, 0, v248
  v_lshlrev_b32 v250, 1, v250
  v_xor_b32 v250, v250, v247
  v_lshl_add_u32 v239, v250, 4, v249
  v_add_u32 v239, 31744, v239
  v_or_b32 v250, 4, v248
  v_lshlrev_b32 v250, 1, v250
  v_xor_b32 v250, v250, v247
  v_lshl_add_u32 v240, v250, 4, v249
  v_add_u32 v240, 63488, v240
  v_or_b32 v250, 4, v248
  v_lshlrev_b32 v250, 1, v250
  v_xor_b32 v250, v250, v247
  v_lshl_add_u32 v241, v250, 4, v249
  v_add_u32 v241, 95232, v241
  s_waitcnt lgkmcnt(0)
  s_add_u32 s58, s10, 2830336
  s_addc_u32 s59, s11, 0
  s_load_dword s59, s[58:59], 0
  s_mov_b32 s24, s10
  s_mov_b32 s25, s11
  s_mov_b32 s26, 33554432
  s_mov_b32 s27, 0x20000
  s_lshl_b32 s38, s36, 8
  s_add_u32 s20, s8, s38
  s_addc_u32 s21, s9, 0
  s_mov_b32 s22, 5242880
  s_mov_b32 s23, 0x20000
  s_sub_u32 s22, s22, s38
  s_cmp_ge_u32 s3, 2
  s_cbranch_scc1 front_fetch
  s_mov_b32 s12, s60
  s_mov_b32 s13, s61
  s_mov_b32 s14, 2621440
  s_mov_b32 s15, 0x20000
  s_mov_b32 s16, s48
  s_mov_b32 s17, s49
  s_mov_b32 s18, 1280
  s_mov_b32 s19, 0x20000
  s_lshr_b32 s52, s37, 2
  s_lshl_b32 s52, s52, 5
  s_add_u32 s52, s52, s36
  s_lshl_b32 s52, s52, 1
  s_add_u32 s52, s52, s3
  s_lshl_b32 s52, s52, 2
  s_mul_i32 s53, s52, 1280
  v_lshrrev_b32 v1, 4, v0
  v_and_b32 v2, 15, v0
  v_lshlrev_b32 v3, 4, v2
  v_mul_u32_u24 v4, 0x500, v1
  v_add_u32 v4, v4, v3
  buffer_load_dwordx4 v[8:11], v4, s[12:15], s53 offen offset:0
  buffer_load_dwordx4 v[12:15], v4, s[12:15], s53 offen offset:256
  buffer_load_dwordx4 v[16:19], v4, s[12:15], s53 offen offset:512
  buffer_load_dwordx4 v[20:23], v4, s[12:15], s53 offen offset:768
  buffer_load_dwordx4 v[24:27], v4, s[12:15], s53 offen offset:1024
  buffer_load_dwordx4 v[28:31], v3, s[16:19], 0 offen offset:0
  buffer_load_dwordx4 v[32:35], v3, s[16:19], 0 offen offset:256
  buffer_load_dwordx4 v[36:39], v3, s[16:19], 0 offen offset:512
  buffer_load_dwordx4 v[40:43], v3, s[16:19], 0 offen offset:768
  buffer_load_dwordx4 v[44:47], v3, s[16:19], 0 offen offset:1024
  v_mov_b32 v7, 0
  v_lshlrev_b32 v6, 26, v0
  s_lshl_b32 s53, s2, 7
  s_add_u32 s53, s53, 2834432
  buffer_store_dword v7, v6, s[24:27], s53 offen sc1
  v_lshlrev_b32 v6, 8, v0
  v_lshrrev_b32 v5, 5, v0
  v_lshl_add_u32 v6, v5, 26, v6
  s_cmp_eq_u32 s2, 0
  s_cselect_b32 s53, 0, 1073741824
  v_or_b32 v6, s53, v6
  s_mov_b32 s53, 2818048
  buffer_store_dword v7, v6, s[24:27], s53 offen sc1
  v_lshlrev_b32 v6, 7, v0
  s_cmp_eq_u32 s2, 1
  s_cselect_b32 s53, 0, 1073741824
  v_or_b32 v6, s53, v6
  s_mov_b32 s53, 2867200
  buffer_store_dword v7, v6, s[24:27], s53 offen sc1
  s_lshr_b32 s53, s52, 6
  s_mul_i32 s53, s53, 81920
  s_bfe_u32 s54, s52, 0x20004
  s_lshl_b32 s54, s54, 10
  s_add_u32 s53, s53, s54
  s_and_b32 s54, s52, 15
  s_lshl_b32 s54, s54, 4
  s_add_u32 s53, s53, s54
  v_lshrrev_b32 v5, 2, v2
  v_lshlrev_b32 v5, 12, v5
  v_and_b32 v6, 3, v2
  v_lshl_add_u32 v5, v6, 8, v5
  v_lshl_add_u32 v5, v1, 4, v5
  s_mov_b32 s56, 0xffff0000
  s_waitcnt vmcnt(12)
  v_lshlrev_b32 v48, 16, v8
  v_and_b32 v49, s56, v8
  v_lshlrev_b32 v50, 16, v9
  v_and_b32 v51, s56, v9
  v_lshlrev_b32 v52, 16, v10
  v_and_b32 v53, s56, v10
  v_lshlrev_b32 v54, 16, v11
  v_and_b32 v55, s56, v11
  s_waitcnt vmcnt(11)
  v_lshlrev_b32 v56, 16, v12
  v_and_b32 v57, s56, v12
  v_lshlrev_b32 v58, 16, v13
  v_and_b32 v59, s56, v13
  v_lshlrev_b32 v60, 16, v14
  v_and_b32 v61, s56, v14
  v_lshlrev_b32 v62, 16, v15
  v_and_b32 v63, s56, v15
  s_waitcnt vmcnt(10)
  v_lshlrev_b32 v64, 16, v16
  v_and_b32 v65, s56, v16
  v_lshlrev_b32 v66, 16, v17
  v_and_b32 v67, s56, v17
  v_lshlrev_b32 v68, 16, v18
  v_and_b32 v69, s56, v18
  v_lshlrev_b32 v70, 16, v19
  v_and_b32 v71, s56, v19
  s_waitcnt vmcnt(9)
  v_lshlrev_b32 v72, 16, v20
  v_and_b32 v73, s56, v20
  v_lshlrev_b32 v74, 16, v21
  v_and_b32 v75, s56, v21
  v_lshlrev_b32 v76, 16, v22
  v_and_b32 v77, s56, v22
  v_lshlrev_b32 v78, 16, v23
  v_and_b32 v79, s56, v23
  s_waitcnt vmcnt(8)
  v_lshlrev_b32 v80, 16, v24
  v_and_b32 v81, s56, v24
  v_lshlrev_b32 v82, 16, v25
  v_and_b32 v83, s56, v25
  v_lshlrev_b32 v84, 16, v26
  v_and_b32 v85, s56, v26
  v_lshlrev_b32 v86, 16, v27
  v_and_b32 v87, s56, v27
  v_pk_add_f32 v[88:89], v[48:49], v[50:51]
  v_pk_add_f32 v[90:91], v[52:53], v[54:55]
  v_pk_add_f32 v[88:89], v[88:89], v[56:57]
  v_pk_add_f32 v[90:91], v[90:91], v[58:59]
  v_pk_add_f32 v[88:89], v[88:89], v[60:61]
  v_pk_add_f32 v[90:91], v[90:91], v[62:63]
  v_pk_add_f32 v[88:89], v[88:89], v[64:65]
  v_pk_add_f32 v[90:91], v[90:91], v[66:67]
  v_pk_add_f32 v[88:89], v[88:89], v[68:69]
  v_pk_add_f32 v[90:91], v[90:91], v[70:71]
  v_pk_add_f32 v[88:89], v[88:89], v[72:73]
  v_pk_add_f32 v[90:91], v[90:91], v[74:75]
  v_pk_add_f32 v[88:89], v[88:89], v[76:77]
  v_pk_add_f32 v[90:91], v[90:91], v[78:79]
  v_pk_add_f32 v[88:89], v[88:89], v[80:81]
  v_pk_add_f32 v[90:91], v[90:91], v[82:83]
  v_pk_add_f32 v[88:89], v[88:89], v[84:85]
  v_pk_add_f32 v[90:91], v[90:91], v[86:87]
  v_pk_add_f32 v[88:89], v[88:89], v[90:91]
  v_add_f32 v92, v88, v89
  s_nop 1
  v_add_f32_dpp v92, v92, v92 row_ror:8 row_mask:0xf bank_mask:0xf
  s_nop 1
  v_add_f32_dpp v92, v92, v92 row_ror:4 row_mask:0xf bank_mask:0xf
  s_nop 1
  v_add_f32_dpp v92, v92, v92 row_ror:2 row_mask:0xf bank_mask:0xf
  s_nop 1
  v_add_f32_dpp v92, v92, v92 row_ror:1 row_mask:0xf bank_mask:0xf
  v_mul_f32 v92, 0x3acccccd, v92
  v_pk_add_f32 v[94:95], v[48:49], v[92:93] op_sel_hi:[1,0] neg_lo:[0,1] neg_hi:[0,1]
  v_pk_mul_f32 v[88:89], v[94:95], v[94:95]
  v_pk_add_f32 v[96:97], v[50:51], v[92:93] op_sel_hi:[1,0] neg_lo:[0,1] neg_hi:[0,1]
  v_pk_mul_f32 v[90:91], v[96:97], v[96:97]
  v_pk_add_f32 v[94:95], v[52:53], v[92:93] op_sel_hi:[1,0] neg_lo:[0,1] neg_hi:[0,1]
  v_pk_fma_f32 v[88:89], v[94:95], v[94:95], v[88:89]
  v_pk_add_f32 v[96:97], v[54:55], v[92:93] op_sel_hi:[1,0] neg_lo:[0,1] neg_hi:[0,1]
  v_pk_fma_f32 v[90:91], v[96:97], v[96:97], v[90:91]
  v_pk_add_f32 v[94:95], v[56:57], v[92:93] op_sel_hi:[1,0] neg_lo:[0,1] neg_hi:[0,1]
  v_pk_fma_f32 v[88:89], v[94:95], v[94:95], v[88:89]
  v_pk_add_f32 v[96:97], v[58:59], v[92:93] op_sel_hi:[1,0] neg_lo:[0,1] neg_hi:[0,1]
  v_pk_fma_f32 v[90:91], v[96:97], v[96:97], v[90:91]
  v_pk_add_f32 v[94:95], v[60:61], v[92:93] op_sel_hi:[1,0] neg_lo:[0,1] neg_hi:[0,1]
  v_pk_fma_f32 v[88:89], v[94:95], v[94:95], v[88:89]
  v_pk_add_f32 v[96:97], v[62:63], v[92:93] op_sel_hi:[1,0] neg_lo:[0,1] neg_hi:[0,1]
  v_pk_fma_f32 v[90:91], v[96:97], v[96:97], v[90:91]
  v_pk_add_f32 v[94:95], v[64:65], v[92:93] op_sel_hi:[1,0] neg_lo:[0,1] neg_hi:[0,1]
  v_pk_fma_f32 v[88:89], v[94:95], v[94:95], v[88:89]
  v_pk_add_f32 v[96:97], v[66:67], v[92:93] op_sel_hi:[1,0] neg_lo:[0,1] neg_hi:[0,1]
  v_pk_fma_f32 v[90:91], v[96:97], v[96:97], v[90:91]
  v_pk_add_f32 v[94:95], v[68:69], v[92:93] op_sel_hi:[1,0] neg_lo:[0,1] neg_hi:[0,1]
  v_pk_fma_f32 v[88:89], v[94:95], v[94:95], v[88:89]
  v_pk_add_f32 v[96:97], v[70:71], v[92:93] op_sel_hi:[1,0] neg_lo:[0,1] neg_hi:[0,1]
  v_pk_fma_f32 v[90:91], v[96:97], v[96:97], v[90:91]
  v_pk_add_f32 v[94:95], v[72:73], v[92:93] op_sel_hi:[1,0] neg_lo:[0,1] neg_hi:[0,1]
  v_pk_fma_f32 v[88:89], v[94:95], v[94:95], v[88:89]
  v_pk_add_f32 v[96:97], v[74:75], v[92:93] op_sel_hi:[1,0] neg_lo:[0,1] neg_hi:[0,1]
  v_pk_fma_f32 v[90:91], v[96:97], v[96:97], v[90:91]
  v_pk_add_f32 v[94:95], v[76:77], v[92:93] op_sel_hi:[1,0] neg_lo:[0,1] neg_hi:[0,1]
  v_pk_fma_f32 v[88:89], v[94:95], v[94:95], v[88:89]
  v_pk_add_f32 v[96:97], v[78:79], v[92:93] op_sel_hi:[1,0] neg_lo:[0,1] neg_hi:[0,1]
  v_pk_fma_f32 v[90:91], v[96:97], v[96:97], v[90:91]
  v_pk_add_f32 v[94:95], v[80:81], v[92:93] op_sel_hi:[1,0] neg_lo:[0,1] neg_hi:[0,1]
  v_pk_fma_f32 v[88:89], v[94:95], v[94:95], v[88:89]
  v_pk_add_f32 v[96:97], v[82:83], v[92:93] op_sel_hi:[1,0] neg_lo:[0,1] neg_hi:[0,1]
  v_pk_fma_f32 v[90:91], v[96:97], v[96:97], v[90:91]
  v_pk_add_f32 v[94:95], v[84:85], v[92:93] op_sel_hi:[1,0] neg_lo:[0,1] neg_hi:[0,1]
  v_pk_fma_f32 v[88:89], v[94:95], v[94:95], v[88:89]
  v_pk_add_f32 v[96:97], v[86:87], v[92:93] op_sel_hi:[1,0] neg_lo:[0,1] neg_hi:[0,1]
  v_pk_fma_f32 v[90:91], v[96:97], v[96:97], v[90:91]
  v_pk_add_f32 v[88:89], v[88:89], v[90:91]
  v_add_f32 v98, v88, v89
  s_nop 1
  v_add_f32_dpp v98, v98, v98 row_ror:8 row_mask:0xf bank_mask:0xf
  v_cvt_pk_bf16_f32 v92, v92, v92
  s_nop 0
  v_add_f32_dpp v98, v98, v98 row_ror:4 row_mask:0xf bank_mask:0xf
  v_lshlrev_b32 v92, 16, v92
  s_nop 0
  v_add_f32_dpp v98, v98, v98 row_ror:2 row_mask:0xf bank_mask:0xf
  s_nop 1
  v_add_f32_dpp v98, v98, v98 row_ror:1 row_mask:0xf bank_mask:0xf
  v_mul_f32 v98, 0x3acccccd, v98
  v_cvt_pk_bf16_f32 v98, v98, v98
  v_pk_add_f32 v[48:49], v[48:49], v[92:93] op_sel_hi:[1,0] neg_lo:[0,1] neg_hi:[0,1]
  v_lshlrev_b32 v98, 16, v98
  v_pk_add_f32 v[50:51], v[50:51], v[92:93] op_sel_hi:[1,0] neg_lo:[0,1] neg_hi:[0,1]
  v_add_f32 v98, 0x3727c5ac, v98
  v_pk_add_f32 v[52:53], v[52:53], v[92:93] op_sel_hi:[1,0] neg_lo:[0,1] neg_hi:[0,1]
  v_cvt_pk_bf16_f32 v98, v98, v98
  v_pk_add_f32 v[54:55], v[54:55], v[92:93] op_sel_hi:[1,0] neg_lo:[0,1] neg_hi:[0,1]
  v_lshlrev_b32 v98, 16, v98
  v_pk_add_f32 v[56:57], v[56:57], v[92:93] op_sel_hi:[1,0] neg_lo:[0,1] neg_hi:[0,1]
  v_sqrt_f32 v98, v98
  v_pk_add_f32 v[58:59], v[58:59], v[92:93] op_sel_hi:[1,0] neg_lo:[0,1] neg_hi:[0,1]
  v_cvt_pk_bf16_f32 v98, v98, v98
  v_pk_add_f32 v[60:61], v[60:61], v[92:93] op_sel_hi:[1,0] neg_lo:[0,1] neg_hi:[0,1]
  v_lshlrev_b32 v98, 16, v98
  v_pk_add_f32 v[62:63], v[62:63], v[92:93] op_sel_hi:[1,0] neg_lo:[0,1] neg_hi:[0,1]
  v_rcp_f32 v100, v98
  v_pk_add_f32 v[64:65], v[64:65], v[92:93] op_sel_hi:[1,0] neg_lo:[0,1] neg_hi:[0,1]
  v_pk_add_f32 v[66:67], v[66:67], v[92:93] op_sel_hi:[1,0] neg_lo:[0,1] neg_hi:[0,1]
  v_pk_add_f32 v[68:69], v[68:69], v[92:93] op_sel_hi:[1,0] neg_lo:[0,1] neg_hi:[0,1]
  v_pk_add_f32 v[70:71], v[70:71], v[92:93] op_sel_hi:[1,0] neg_lo:[0,1] neg_hi:[0,1]
  v_pk_add_f32 v[72:73], v[72:73], v[92:93] op_sel_hi:[1,0] neg_lo:[0,1] neg_hi:[0,1]
  v_pk_add_f32 v[74:75], v[74:75], v[92:93] op_sel_hi:[1,0] neg_lo:[0,1] neg_hi:[0,1]
  v_pk_add_f32 v[76:77], v[76:77], v[92:93] op_sel_hi:[1,0] neg_lo:[0,1] neg_hi:[0,1]
  v_pk_add_f32 v[78:79], v[78:79], v[92:93] op_sel_hi:[1,0] neg_lo:[0,1] neg_hi:[0,1]
  v_pk_add_f32 v[80:81], v[80:81], v[92:93] op_sel_hi:[1,0] neg_lo:[0,1] neg_hi:[0,1]
  v_pk_add_f32 v[82:83], v[82:83], v[92:93] op_sel_hi:[1,0] neg_lo:[0,1] neg_hi:[0,1]
  v_pk_add_f32 v[84:85], v[84:85], v[92:93] op_sel_hi:[1,0] neg_lo:[0,1] neg_hi:[0,1]
  v_pk_add_f32 v[86:87], v[86:87], v[92:93] op_sel_hi:[1,0] neg_lo:[0,1] neg_hi:[0,1]
  v_mov_b32 v104, 0
  v_mov_b32 v105, 0
  v_cvt_pk_bf16_f32 v8, v48, v49
  v_cvt_pk_bf16_f32 v9, v50, v51
  v_cvt_pk_bf16_f32 v10, v52, v53
  v_cvt_pk_bf16_f32 v11, v54, v55
  v_cvt_pk_bf16_f32 v12, v56, v57
  v_cvt_pk_bf16_f32 v13, v58, v59
  v_cvt_pk_bf16_f32 v14, v60, v61
  v_cvt_pk_bf16_f32 v15, v62, v63
  v_cvt_pk_bf16_f32 v16, v64, v65
  v_cvt_pk_bf16_f32 v17, v66, v67
  v_cvt_pk_bf16_f32 v18, v68, v69
  v_cvt_pk_bf16_f32 v19, v70, v71
  v_cvt_pk_bf16_f32 v20, v72, v73
  v_cvt_pk_bf16_f32 v21, v74, v75
  v_cvt_pk_bf16_f32 v22, v76, v77
  v_cvt_pk_bf16_f32 v23, v78, v79
  v_cvt_pk_bf16_f32 v24, v80, v81
  v_cvt_pk_bf16_f32 v25, v82, v83
  v_cvt_pk_bf16_f32 v26, v84, v85
  v_cvt_pk_bf16_f32 v27, v86, v87
  v_lshlrev_b32 v48, 16, v8
  v_and_b32 v49, s56, v8
  v_lshlrev_b32 v50, 16, v9
  v_and_b32 v51, s56, v9
  v_lshlrev_b32 v52, 16, v10
  v_and_b32 v53, s56, v10
  v_lshlrev_b32 v54, 16, v11
  v_and_b32 v55, s56, v11
  v_lshlrev_b32 v56, 16, v12
  v_and_b32 v57, s56, v12
  v_lshlrev_b32 v58, 16, v13
  v_and_b32 v59, s56, v13
  v_lshlrev_b32 v60, 16, v14
  v_and_b32 v61, s56, v14
  v_lshlrev_b32 v62, 16, v15
  v_and_b32 v63, s56, v15
  v_lshlrev_b32 v64, 16, v16
  v_and_b32 v65, s56, v16
  v_lshlrev_b32 v66, 16, v17
  v_and_b32 v67, s56, v17
  v_lshlrev_b32 v68, 16, v18
  v_and_b32 v69, s56, v18
  v_lshlrev_b32 v70, 16, v19
  v_and_b32 v71, s56, v19
  v_lshlrev_b32 v72, 16, v20
  v_and_b32 v73, s56, v20
  v_lshlrev_b32 v74, 16, v21
  v_and_b32 v75, s56, v21
  v_lshlrev_b32 v76, 16, v22
  v_and_b32 v77, s56, v22
  v_lshlrev_b32 v78, 16, v23
  v_and_b32 v79, s56, v23
  v_lshlrev_b32 v80, 16, v24
  v_and_b32 v81, s56, v24
  v_lshlrev_b32 v82, 16, v25
  v_and_b32 v83, s56, v25
  v_lshlrev_b32 v84, 16, v26
  v_and_b32 v85, s56, v26
  v_lshlrev_b32 v86, 16, v27
  v_and_b32 v87, s56, v27
  v_pk_mul_f32 v[48:49], v[48:49], v[100:101] op_sel_hi:[1,0]
  v_pk_mul_f32 v[50:51], v[50:51], v[100:101] op_sel_hi:[1,0]
  v_pk_mul_f32 v[52:53], v[52:53], v[100:101] op_sel_hi:[1,0]
  v_pk_mul_f32 v[54:55], v[54:55], v[100:101] op_sel_hi:[1,0]
  v_cvt_pk_bf16_f32 v8, v48, v49
  v_cvt_pk_bf16_f32 v9, v50, v51
  v_cvt_pk_bf16_f32 v10, v52, v53
  v_cvt_pk_bf16_f32 v11, v54, v55
  buffer_store_dwordx4 v[8:11], v5, s[24:27], s53 offen sc1
  s_add_u32 s53, s53, 16384
  v_pk_mul_f32 v[56:57], v[56:57], v[100:101] op_sel_hi:[1,0]
  v_pk_mul_f32 v[58:59], v[58:59], v[100:101] op_sel_hi:[1,0]
  v_pk_mul_f32 v[60:61], v[60:61], v[100:101] op_sel_hi:[1,0]
  v_pk_mul_f32 v[62:63], v[62:63], v[100:101] op_sel_hi:[1,0]
  v_cvt_pk_bf16_f32 v12, v56, v57
  v_cvt_pk_bf16_f32 v13, v58, v59
  v_cvt_pk_bf16_f32 v14, v60, v61
  v_cvt_pk_bf16_f32 v15, v62, v63
  buffer_store_dwordx4 v[12:15], v5, s[24:27], s53 offen sc1
  s_add_u32 s53, s53, 16384
  v_pk_mul_f32 v[64:65], v[64:65], v[100:101] op_sel_hi:[1,0]
  v_pk_mul_f32 v[66:67], v[66:67], v[100:101] op_sel_hi:[1,0]
  v_pk_mul_f32 v[68:69], v[68:69], v[100:101] op_sel_hi:[1,0]
  v_pk_mul_f32 v[70:71], v[70:71], v[100:101] op_sel_hi:[1,0]
  v_cvt_pk_bf16_f32 v16, v64, v65
  v_cvt_pk_bf16_f32 v17, v66, v67
  v_cvt_pk_bf16_f32 v18, v68, v69
  v_cvt_pk_bf16_f32 v19, v70, v71
  buffer_store_dwordx4 v[16:19], v5, s[24:27], s53 offen sc1
  s_add_u32 s53, s53, 16384
  v_pk_mul_f32 v[72:73], v[72:73], v[100:101] op_sel_hi:[1,0]
  v_pk_mul_f32 v[74:75], v[74:75], v[100:101] op_sel_hi:[1,0]
  v_pk_mul_f32 v[76:77], v[76:77], v[100:101] op_sel_hi:[1,0]
  v_pk_mul_f32 v[78:79], v[78:79], v[100:101] op_sel_hi:[1,0]
  v_cvt_pk_bf16_f32 v20, v72, v73
  v_cvt_pk_bf16_f32 v21, v74, v75
  v_cvt_pk_bf16_f32 v22, v76, v77
  v_cvt_pk_bf16_f32 v23, v78, v79
  buffer_store_dwordx4 v[20:23], v5, s[24:27], s53 offen sc1
  s_add_u32 s53, s53, 16384
  v_pk_mul_f32 v[80:81], v[80:81], v[100:101] op_sel_hi:[1,0]
  v_pk_mul_f32 v[82:83], v[82:83], v[100:101] op_sel_hi:[1,0]
  v_pk_mul_f32 v[84:85], v[84:85], v[100:101] op_sel_hi:[1,0]
  v_pk_mul_f32 v[86:87], v[86:87], v[100:101] op_sel_hi:[1,0]
  v_cvt_pk_bf16_f32 v24, v80, v81
  v_cvt_pk_bf16_f32 v25, v82, v83
  v_cvt_pk_bf16_f32 v26, v84, v85
  v_cvt_pk_bf16_f32 v27, v86, v87
  buffer_store_dwordx4 v[24:27], v5, s[24:27], s53 offen sc1
  s_add_u32 s53, s53, 16384
  s_waitcnt vmcnt(12)
  v_dot2_f32_bf16 v104, v8, v28, v104
  v_dot2_f32_bf16 v105, v9, v29, v105
  v_dot2_f32_bf16 v104, v10, v30, v104
  v_dot2_f32_bf16 v105, v11, v31, v105
  s_waitcnt vmcnt(11)
  v_dot2_f32_bf16 v104, v12, v32, v104
  v_dot2_f32_bf16 v105, v13, v33, v105
  v_dot2_f32_bf16 v104, v14, v34, v104
  v_dot2_f32_bf16 v105, v15, v35, v105
  s_waitcnt vmcnt(10)
  v_dot2_f32_bf16 v104, v16, v36, v104
  v_dot2_f32_bf16 v105, v17, v37, v105
  v_dot2_f32_bf16 v104, v18, v38, v104
  v_dot2_f32_bf16 v105, v19, v39, v105
  s_waitcnt vmcnt(9)
  v_dot2_f32_bf16 v104, v20, v40, v104
  v_dot2_f32_bf16 v105, v21, v41, v105
  v_dot2_f32_bf16 v104, v22, v42, v104
  v_dot2_f32_bf16 v105, v23, v43, v105
  s_waitcnt vmcnt(8)
  v_dot2_f32_bf16 v104, v24, v44, v104
  v_dot2_f32_bf16 v105, v25, v45, v105
  v_dot2_f32_bf16 v104, v26, v46, v104
  v_dot2_f32_bf16 v105, v27, v47, v105
  s_nop 2
  v_add_f32 v104, v104, v105
  s_nop 1
  v_add_f32_dpp v104, v104, v104 row_ror:8 row_mask:0xf bank_mask:0xf
  s_nop 1
  v_add_f32_dpp v104, v104, v104 row_ror:4 row_mask:0xf bank_mask:0xf
  s_nop 1
  v_add_f32_dpp v104, v104, v104 row_ror:2 row_mask:0xf bank_mask:0xf
  s_nop 1
  v_add_f32_dpp v104, v104, v104 row_ror:1 row_mask:0xf bank_mask:0xf
  v_cvt_pk_bf16_f32 v104, v104, v104
  v_lshlrev_b32 v104, 16, v104
  v_ashrrev_i32 v105, 31, v104
  v_or_b32 v105, 0x80000000, v105
  v_xor_b32 v104, v104, v105
  v_and_b32 v104, s56, v104
  v_add_u32 v6, s52, v1
  v_sub_u32 v7, 0xffff, v6
  v_or_b32 v104, v104, v7
  v_lshlrev_b32 v6, 2, v6
  v_lshl_add_u32 v6, v2, 26, v6
  s_mov_b32 s53, 2621440
  buffer_store_dword v104, v6, s[24:27], s53 offen sc1
  s_waitcnt vmcnt(0)
  s_branch front_join
front_fetch:
  s_getpc_b64 s[98:99]
attn_hot_pc:
  s_add_u32 s98, s98, attn_hot-attn_hot_pc
  s_addc_u32 s99, s99, 0
  s_lshr_b32 s100, s2, 3
  v_min_u32 v249, 17, v0
  v_lshlrev_b32 v249, 5, v249
  v_add_u32 v249, s100, v249
  v_lshlrev_b32 v249, 7, v249
  v_min_u32 v249, attn_end-attn_hot-4, v249
  global_load_dword v255, v249, s[98:99]
attn_hot:
  v_subrev_u32 v16, 0x40000, v238
  v_subrev_u32 v17, 0x40000, v239
  v_subrev_u32 v18, 0x40000, v240
  v_subrev_u32 v19, 0x40000, v241
  s_mov_b32 s31, 0
  s_add_u32 m0, s28, 90112
  s_nop 0
  buffer_load_dwordx4 v16, s[20:23], s31 offen offset:0 lds
  buffer_load_dwordx4 v17, s[20:23], s31 offen offset:1024 lds
  buffer_load_dwordx4 v18, s[20:23], s31 offen offset:2048 lds
  buffer_load_dwordx4 v19, s[20:23], s31 offen offset:3072 lds
  s_add_u32 m0, s28, 98304
  s_nop 0
  buffer_load_dwordx4 v238, s[20:23], s31 offen offset:0 lds
  buffer_load_dwordx4 v239, s[20:23], s31 offen offset:1024 lds
  buffer_load_dwordx4 v240, s[20:23], s31 offen offset:2048 lds
  buffer_load_dwordx4 v241, s[20:23], s31 offen offset:3072 lds
front_join:
  s_waitcnt lgkmcnt(0)
  s_barrier
  s_mul_i32 s55, s59, 0x9e3779b1
  s_add_u32 s55, s55, 0x7f4a7c15
  s_bfe_u32 s58, s2, 0x30003
  s_lshl_b32 s58, s58, 8
  s_add_u32 s58, s58, 2826240
  s_lshl_b32 s53, s36, 2
  s_lshl_b32 s54, s3, 26
  s_add_u32 s53, s53, s54
  v_min_u32 v1, 1, v0
  v_lshlrev_b32 v1, 28, v1
  v_add_u32 v1, s53, v1
  v_mov_b32 v2, s55
  buffer_store_dword v2, v1, s[24:27], s58 offen sc1
  s_cmp_lt_u32 s3, 2
  s_cbranch_scc1 front_addr
  s_mov_b32 s31, 524288
  s_add_u32 m0, s28, 106496
  s_nop 0
  buffer_load_dwordx4 v16, s[20:23], s31 offen offset:0 lds
  buffer_load_dwordx4 v17, s[20:23], s31 offen offset:1024 lds
  buffer_load_dwordx4 v18, s[20:23], s31 offen offset:2048 lds
  buffer_load_dwordx4 v19, s[20:23], s31 offen offset:3072 lds
  s_add_u32 m0, s28, 114688
  s_nop 0
  buffer_load_dwordx4 v238, s[20:23], s31 offen offset:0 lds
  buffer_load_dwordx4 v239, s[20:23], s31 offen offset:1024 lds
  buffer_load_dwordx4 v240, s[20:23], s31 offen offset:2048 lds
  buffer_load_dwordx4 v241, s[20:23], s31 offen offset:3072 lds
  s_mov_b32 s31, 1048576
  s_add_u32 m0, s28, 24576
  s_nop 0
  buffer_load_dwordx4 v16, s[20:23], s31 offen offset:0 lds
  buffer_load_dwordx4 v17, s[20:23], s31 offen offset:1024 lds
  buffer_load_dwordx4 v18, s[20:23], s31 offen offset:2048 lds
  buffer_load_dwordx4 v19, s[20:23], s31 offen offset:3072 lds
  s_add_u32 m0, s28, 32768
  s_nop 0
  buffer_load_dwordx4 v238, s[20:23], s31 offen offset:0 lds
  buffer_load_dwordx4 v239, s[20:23], s31 offen offset:1024 lds
  buffer_load_dwordx4 v240, s[20:23], s31 offen offset:2048 lds
  buffer_load_dwordx4 v241, s[20:23], s31 offen offset:3072 lds
  s_mov_b32 s31, 1572864
  s_add_u32 m0, s28, 40960
  s_nop 0
  buffer_load_dwordx4 v16, s[20:23], s31 offen offset:0 lds
  buffer_load_dwordx4 v17, s[20:23], s31 offen offset:1024 lds
  buffer_load_dwordx4 v18, s[20:23], s31 offen offset:2048 lds
  buffer_load_dwordx4 v19, s[20:23], s31 offen offset:3072 lds
  s_add_u32 m0, s28, 49152
  s_nop 0
  buffer_load_dwordx4 v238, s[20:23], s31 offen offset:0 lds
  buffer_load_dwordx4 v239, s[20:23], s31 offen offset:1024 lds
  buffer_load_dwordx4 v240, s[20:23], s31 offen offset:2048 lds
  buffer_load_dwordx4 v241, s[20:23], s31 offen offset:3072 lds
front_addr:
  s_mov_b32 s31, 2097152
  v_lshlrev_b32 v242, 4, v245
  v_add_u32 v243, 0x1000, v242
  s_mul_i32 s30, s37, 81920
  s_lshl_b32 s38, s36, 19
  s_add_u32 s12, s4, s38
  s_addc_u32 s13, s5, 0
  s_mov_b32 s14, 524288
  s_mov_b32 s15, 0x20000
  s_add_u32 s16, s6, s38
  s_addc_u32 s17, s7, 0
  s_mov_b32 s18, 524288
  s_mov_b32 s19, 0x20000
  v_lshlrev_b32 v249, 8, v248
  v_add_u32 v249, s28, v249
  v_add_u32 v250, 0, v248
  v_xor_b32 v250, v250, v247
  v_lshl_add_u32 v232, v250, 4, v249
  v_add_u32 v250, 4, v248
  v_xor_b32 v250, v250, v247
  v_lshl_add_u32 v233, v250, 4, v249
  v_add_u32 v250, 8, v248
  v_xor_b32 v250, v250, v247
  v_lshl_add_u32 v234, v250, 4, v249
  v_add_u32 v250, 12, v248
  v_xor_b32 v250, v250, v247
  v_lshl_add_u32 v235, v250, 4, v249
  v_add_u32 v250, 0, v248
  v_lshlrev_b32 v250, 1, v250
  v_xor_b32 v250, v250, v247
  v_lshl_add_u32 v236, v250, 4, v249
  v_add_u32 v250, 4, v248
  v_lshlrev_b32 v250, 1, v250
  v_xor_b32 v250, v250, v247
  v_lshl_add_u32 v237, v250, 4, v249
  v_lshrrev_b32 v249, 1, v248
  v_and_b32 v250, 1, v248
  v_lshl_or_b32 v249, v250, 1, v249
  v_xor_b32 v249, v249, v247
  v_lshlrev_b32 v249, 4, v249
  v_lshl_add_u32 v212, v247, 8, v249
  v_xor_b32 v213, 64, v212
  v_xor_b32 v214, 128, v212
  v_xor_b32 v215, 192, v212
  v_bfe_u32 v246, v245, 2, 2
  v_and_b32 v247, 3, v245
  v_lshlrev_b32 v247, 3, v247
  v_add_u32 v247, 65536, v247
  v_lshl_add_u32 v249, v248, 2, v246
  v_and_b32 v250, 7, v249
  v_lshl_add_u32 v250, v250, 5, v247
  v_lshl_add_u32 v216, v249, 8, v250
  v_lshl_add_u32 v249, v248, 3, v246
  v_and_b32 v250, 1, v248
  v_lshl_add_u32 v250, v250, 2, v246
  v_lshl_add_u32 v250, v250, 5, v247
  v_lshl_add_u32 v224, v249, 8, v250
  v_xor_b32 v217, 32, v216
  v_xor_b32 v225, 32, v224
  v_xor_b32 v218, 64, v216
  v_xor_b32 v226, 64, v224
  v_xor_b32 v219, 96, v216
  v_xor_b32 v227, 96, v224
  v_xor_b32 v220, 128, v216
  v_xor_b32 v228, 128, v224
  v_xor_b32 v221, 160, v216
  v_xor_b32 v229, 160, v224
  v_xor_b32 v222, 192, v216
  v_xor_b32 v230, 192, v224
  v_xor_b32 v223, 224, v216
  v_xor_b32 v231, 224, v224
  v_subrev_u32 v144, 65536, v224
  v_subrev_u32 v145, 65536, v225
  v_subrev_u32 v146, 65536, v226
  v_subrev_u32 v147, 65536, v227
  v_subrev_u32 v148, 65536, v228
  v_subrev_u32 v149, 65536, v229
  v_subrev_u32 v150, 65536, v230
  v_subrev_u32 v151, 65536, v231
  s_lshr_b32 s38, s2, 3
  s_min_u32 s38, s38, 26
  s_and_b32 s39, s2, 7
  s_mul_i32 s39, s39, 27
  s_add_u32 s33, s38, s39
  s_mul_i32 s50, s3, 6144
  s_add_u32 s50, s50, 133120
  v_mov_b32 v244, v242
  s_lshl_b32 s40, s37, 19
  s_lshl_b32 s38, s36, 14
  s_add_u32 s40, s40, s38
  s_add_u32 s40, s40, 8388608
  s_add_u32 s41, s40, 4096
  s_add_u32 s42, s40, 8192
  s_add_u32 s43, s40, 12288
  s_mov_b32 s34, 0x3e0293ee
  s_mov_b32 s29, 0
  v_and_b32 v249, 15, v245
  v_cmp_eq_u32 vcc, 0, v249
  v_mov_b32 v249, 0x3f803f80
  s_nop 0
  v_cndmask_b32 v249, 0, v249, vcc
  v_accvgpr_write_b32 a208, v249
  v_accvgpr_write_b32 a209, v249
  v_accvgpr_write_b32 a210, v249
  v_accvgpr_write_b32 a211, v249
  s_cmp_lg_u32 s3, 0
  s_cbranch_scc1 front_go
  v_and_b32 v2, 31, v0
  v_lshlrev_b32 v2, 2, v2
  s_mov_b32 s54, 32768
front_poll:
  buffer_load_dword v1, v2, s[24:27], s58 offen sc1
  s_waitcnt vmcnt(0)
  v_cmp_ne_u32 vcc, s55, v1
  s_nop 0
  s_cbranch_vccz front_go
  s_sleep 2
  s_sub_u32 s54, s54, 1
  s_cmp_lg_u32 s54, 0
  s_cbranch_scc1 front_poll
front_go:
  s_waitcnt vmcnt(25)
  s_barrier
  buffer_load_dwordx4 a[0:3], v242, s[24:27], s30 offen offset:0 sc1
  buffer_load_dwordx4 a[4:7], v242, s[24:27], s30 offen offset:1024 sc1
  buffer_load_dwordx4 a[8:11], v242, s[24:27], s30 offen offset:2048 sc1
  buffer_load_dwordx4 a[12:15], v242, s[24:27], s30 offen offset:3072 sc1
  buffer_load_dwordx4 a[16:19], v243, s[24:27], s30 offen offset:0 sc1
  buffer_load_dwordx4 a[20:23], v243, s[24:27], s30 offen offset:1024 sc1
  buffer_load_dwordx4 a[24:27], v243, s[24:27], s30 offen offset:2048 sc1
  buffer_load_dwordx4 a[28:31], v243, s[24:27], s30 offen offset:3072 sc1
  s_add_u32 s30, s30, 8192
  buffer_load_dwordx4 a[32:35], v242, s[24:27], s30 offen offset:0 sc1
  buffer_load_dwordx4 a[36:39], v242, s[24:27], s30 offen offset:1024 sc1
  buffer_load_dwordx4 a[40:43], v242, s[24:27], s30 offen offset:2048 sc1
  buffer_load_dwordx4 a[44:47], v242, s[24:27], s30 offen offset:3072 sc1
  buffer_load_dwordx4 a[48:51], v243, s[24:27], s30 offen offset:0 sc1
  buffer_load_dwordx4 a[52:55], v243, s[24:27], s30 offen offset:1024 sc1
  buffer_load_dwordx4 a[56:59], v243, s[24:27], s30 offen offset:2048 sc1
  buffer_load_dwordx4 a[60:63], v243, s[24:27], s30 offen offset:3072 sc1
  s_add_u32 s30, s30, 8192
  v_lshrrev_b32 v140, 7, v242
  v_lshlrev_b32 v140, 8, v140
  v_and_b32 v136, 0x70, v242
  v_add_u32 v140, v140, v136
  s_mov_b32 s58, 2826240
  buffer_load_dwordx4 v[136:139], v140, s[24:27], s58 offen sc1
  ds_read_b64_tr_b16 a[160:161], v224 offset:32768
  ds_read_b64_tr_b16 a[162:163], v224 offset:33792
  ds_read_b64_tr_b16 a[164:165], v224 offset:40960
  ds_read_b64_tr_b16 a[166:167], v224 offset:41984
  ds_read_b64_tr_b16 a[168:169], v225 offset:32768
  ds_read_b64_tr_b16 a[170:171], v225 offset:33792
  ds_read_b64_tr_b16 a[172:173], v225 offset:40960
  ds_read_b64_tr_b16 a[174:175], v225 offset:41984
  s_waitcnt vmcnt(9) lgkmcnt(4)
  v_mfma_f32_16x16x32_bf16 v[0:3], a[160:163], a[0:3], 0
  ds_read_b64_tr_b16 a[176:177], v226 offset:32768
  v_mfma_f32_16x16x32_bf16 v[0:3], a[164:167], a[16:19], v[0:3]
  buffer_load_dwordx4 a[64:67], v242, s[24:27], s30 offen offset:0 sc1
  v_mfma_f32_16x16x32_bf16 v[4:7], a[164:167], a[20:23], 0
  ds_read_b64_tr_b16 a[178:179], v226 offset:33792
  v_mfma_f32_16x16x32_bf16 v[4:7], a[160:163], a[4:7], v[4:7]
  buffer_load_dwordx4 a[68:71], v242, s[24:27], s30 offen offset:1024 sc1
  v_mfma_f32_16x16x32_bf16 v[8:11], a[160:163], a[8:11], 0
  ds_read_b64_tr_b16 a[180:181], v226 offset:40960
  v_mfma_f32_16x16x32_bf16 v[8:11], a[164:167], a[24:27], v[8:11]
  v_mfma_f32_16x16x32_bf16 v[12:15], a[164:167], a[28:31], 0
  ds_read_b64_tr_b16 a[182:183], v226 offset:41984
  v_mfma_f32_16x16x32_bf16 v[12:15], a[160:163], a[12:15], v[12:15]
  s_waitcnt lgkmcnt(4)
  buffer_load_dwordx4 a[72:75], v242, s[24:27], s30 offen offset:2048 sc1
  v_mfma_f32_16x16x32_bf16 v[16:19], a[168:171], a[0:3], 0
  ds_read_b64_tr_b16 a[184:185], v227 offset:32768
  v_mfma_f32_16x16x32_bf16 v[16:19], a[172:175], a[16:19], v[16:19]
  v_mfma_f32_16x16x32_bf16 v[20:23], a[172:175], a[20:23], 0
  ds_read_b64_tr_b16 a[186:187], v227 offset:33792
  v_mfma_f32_16x16x32_bf16 v[20:23], a[168:171], a[4:7], v[20:23]
  buffer_load_dwordx4 a[76:79], v242, s[24:27], s30 offen offset:3072 sc1
  v_mfma_f32_16x16x32_bf16 v[24:27], a[168:171], a[8:11], 0
  ds_read_b64_tr_b16 a[188:189], v227 offset:40960
  v_mfma_f32_16x16x32_bf16 v[24:27], a[172:175], a[24:27], v[24:27]
  buffer_load_dwordx4 a[80:83], v243, s[24:27], s30 offen offset:0 sc1
  v_mfma_f32_16x16x32_bf16 v[28:31], a[172:175], a[28:31], 0
  ds_read_b64_tr_b16 a[190:191], v227 offset:41984
  v_mfma_f32_16x16x32_bf16 v[28:31], a[168:171], a[12:15], v[28:31]
  s_waitcnt lgkmcnt(4)
  v_mfma_f32_16x16x32_bf16 v[32:35], a[176:179], a[0:3], 0
  ds_read_b64_tr_b16 a[160:161], v228 offset:32768
  v_mfma_f32_16x16x32_bf16 v[32:35], a[180:183], a[16:19], v[32:35]
  buffer_load_dwordx4 a[84:87], v243, s[24:27], s30 offen offset:1024 sc1
  v_mfma_f32_16x16x32_bf16 v[36:39], a[180:183], a[20:23], 0
  ds_read_b64_tr_b16 a[162:163], v228 offset:33792
  v_mfma_f32_16x16x32_bf16 v[36:39], a[176:179], a[4:7], v[36:39]
  v_mfma_f32_16x16x32_bf16 v[40:43], a[176:179], a[8:11], 0
  ds_read_b64_tr_b16 a[164:165], v228 offset:40960
  v_mfma_f32_16x16x32_bf16 v[40:43], a[180:183], a[24:27], v[40:43]
  buffer_load_dwordx4 a[88:91], v243, s[24:27], s30 offen offset:2048 sc1
  v_mfma_f32_16x16x32_bf16 v[44:47], a[180:183], a[28:31], 0
  ds_read_b64_tr_b16 a[166:167], v228 offset:41984
  v_mfma_f32_16x16x32_bf16 v[44:47], a[176:179], a[12:15], v[44:47]
  s_waitcnt lgkmcnt(4)
  buffer_load_dwordx4 a[92:95], v243, s[24:27], s30 offen offset:3072 sc1
  v_mfma_f32_16x16x32_bf16 v[48:51], a[184:187], a[0:3], 0
  ds_read_b64_tr_b16 a[168:169], v229 offset:32768
  v_mfma_f32_16x16x32_bf16 v[48:51], a[188:191], a[16:19], v[48:51]
  v_mfma_f32_16x16x32_bf16 v[52:55], a[188:191], a[20:23], 0
  ds_read_b64_tr_b16 a[170:171], v229 offset:33792
  v_mfma_f32_16x16x32_bf16 v[52:55], a[184:187], a[4:7], v[52:55]
  s_add_u32 s30, s30, 8192
  v_mfma_f32_16x16x32_bf16 v[56:59], a[184:187], a[8:11], 0
  ds_read_b64_tr_b16 a[172:173], v229 offset:40960
  v_mfma_f32_16x16x32_bf16 v[56:59], a[188:191], a[24:27], v[56:59]
  v_mfma_f32_16x16x32_bf16 v[60:63], a[188:191], a[28:31], 0
  ds_read_b64_tr_b16 a[174:175], v229 offset:41984
  v_mfma_f32_16x16x32_bf16 v[60:63], a[184:187], a[12:15], v[60:63]
  s_waitcnt lgkmcnt(4)
  buffer_load_dwordx4 a[96:99], v242, s[24:27], s30 offen offset:0 sc1
  v_mfma_f32_16x16x32_bf16 v[64:67], a[160:163], a[0:3], 0
  ds_read_b64_tr_b16 a[176:177], v230 offset:32768
  v_mfma_f32_16x16x32_bf16 v[64:67], a[164:167], a[16:19], v[64:67]
  buffer_load_dwordx4 a[100:103], v242, s[24:27], s30 offen offset:1024 sc1
  v_mfma_f32_16x16x32_bf16 v[68:71], a[164:167], a[20:23], 0
  ds_read_b64_tr_b16 a[178:179], v230 offset:33792
  v_mfma_f32_16x16x32_bf16 v[68:71], a[160:163], a[4:7], v[68:71]
  v_mfma_f32_16x16x32_bf16 v[72:75], a[160:163], a[8:11], 0
  ds_read_b64_tr_b16 a[180:181], v230 offset:40960
  v_mfma_f32_16x16x32_bf16 v[72:75], a[164:167], a[24:27], v[72:75]
  buffer_load_dwordx4 a[104:107], v242, s[24:27], s30 offen offset:2048 sc1
  v_mfma_f32_16x16x32_bf16 v[76:79], a[164:167], a[28:31], 0
  ds_read_b64_tr_b16 a[182:183], v230 offset:41984
  v_mfma_f32_16x16x32_bf16 v[76:79], a[160:163], a[12:15], v[76:79]
  s_waitcnt lgkmcnt(4)
  v_mfma_f32_16x16x32_bf16 v[80:83], a[168:171], a[0:3], 0
  ds_read_b64_tr_b16 a[184:185], v231 offset:32768
  v_mfma_f32_16x16x32_bf16 v[80:83], a[172:175], a[16:19], v[80:83]
  buffer_load_dwordx4 a[108:111], v242, s[24:27], s30 offen offset:3072 sc1
  v_mfma_f32_16x16x32_bf16 v[84:87], a[172:175], a[20:23], 0
  ds_read_b64_tr_b16 a[186:187], v231 offset:33792
  v_mfma_f32_16x16x32_bf16 v[84:87], a[168:171], a[4:7], v[84:87]
  buffer_load_dwordx4 a[112:115], v243, s[24:27], s30 offen offset:0 sc1
  v_mfma_f32_16x16x32_bf16 v[88:91], a[168:171], a[8:11], 0
  ds_read_b64_tr_b16 a[188:189], v231 offset:40960
  v_mfma_f32_16x16x32_bf16 v[88:91], a[172:175], a[24:27], v[88:91]
  s_barrier
  v_mfma_f32_16x16x32_bf16 v[92:95], a[172:175], a[28:31], 0
  ds_read_b64_tr_b16 a[190:191], v231 offset:41984
  v_mfma_f32_16x16x32_bf16 v[92:95], a[168:171], a[12:15], v[92:95]
  s_waitcnt lgkmcnt(4)
  buffer_load_dwordx4 a[116:119], v243, s[24:27], s30 offen offset:1024 sc1
  v_mfma_f32_16x16x32_bf16 v[96:99], a[176:179], a[0:3], 0
  ds_read_b64_tr_b16 a[160:161], v224 offset:49152
  v_mfma_f32_16x16x32_bf16 v[96:99], a[180:183], a[16:19], v[96:99]
  v_mfma_f32_16x16x32_bf16 v[100:103], a[180:183], a[20:23], 0
  ds_read_b64_tr_b16 a[162:163], v224 offset:50176
  v_mfma_f32_16x16x32_bf16 v[100:103], a[176:179], a[4:7], v[100:103]
  buffer_load_dwordx4 a[120:123], v243, s[24:27], s30 offen offset:2048 sc1
  v_mfma_f32_16x16x32_bf16 v[104:107], a[176:179], a[8:11], 0
  ds_read_b64_tr_b16 a[164:165], v224 offset:57344
  v_mfma_f32_16x16x32_bf16 v[104:107], a[180:183], a[24:27], v[104:107]
  buffer_load_dwordx4 a[124:127], v243, s[24:27], s30 offen offset:3072 sc1
  v_mfma_f32_16x16x32_bf16 v[108:111], a[180:183], a[28:31], 0
  ds_read_b64_tr_b16 a[166:167], v224 offset:58368
  v_mfma_f32_16x16x32_bf16 v[108:111], a[176:179], a[12:15], v[108:111]
  s_waitcnt lgkmcnt(4)
  v_mfma_f32_16x16x32_bf16 v[112:115], a[184:187], a[0:3], 0
  ds_read_b64_tr_b16 a[168:169], v225 offset:49152
  v_mfma_f32_16x16x32_bf16 v[112:115], a[188:191], a[16:19], v[112:115]
  s_add_u32 s30, s30, 8192
  v_mfma_f32_16x16x32_bf16 v[116:119], a[188:191], a[20:23], 0
  ds_read_b64_tr_b16 a[170:171], v225 offset:50176
  v_mfma_f32_16x16x32_bf16 v[116:119], a[184:187], a[4:7], v[116:119]
  v_mfma_f32_16x16x32_bf16 v[120:123], a[184:187], a[8:11], 0
  ds_read_b64_tr_b16 a[172:173], v225 offset:57344
  v_mfma_f32_16x16x32_bf16 v[120:123], a[188:191], a[24:27], v[120:123]
  v_mfma_f32_16x16x32_bf16 v[124:127], a[188:191], a[28:31], 0
  ds_read_b64_tr_b16 a[174:175], v225 offset:58368
  v_mfma_f32_16x16x32_bf16 v[124:127], a[184:187], a[12:15], v[124:127]
  s_waitcnt vmcnt(17) lgkmcnt(4)
  v_mfma_f32_16x16x32_bf16 v[0:3], a[160:163], a[32:35], v[0:3]
  ds_read_b64_tr_b16 a[176:177], v226 offset:49152
  v_mfma_f32_16x16x32_bf16 v[0:3], a[164:167], a[48:51], v[0:3]
  buffer_load_dwordx4 a[0:3], v242, s[24:27], s30 offen offset:0 sc1
  v_mfma_f32_16x16x32_bf16 v[4:7], a[164:167], a[52:55], v[4:7]
  ds_read_b64_tr_b16 a[178:179], v226 offset:50176
  v_mfma_f32_16x16x32_bf16 v[4:7], a[160:163], a[36:39], v[4:7]
  v_mfma_f32_16x16x32_bf16 v[8:11], a[160:163], a[40:43], v[8:11]
  ds_read_b64_tr_b16 a[180:181], v226 offset:57344
  s_add_u32 m0, s28, 16384
  v_mfma_f32_16x16x32_bf16 v[8:11], a[164:167], a[56:59], v[8:11]
  buffer_load_dwordx4 v238, s[20:23], s31 offen offset:0 lds
  v_mfma_f32_16x16x32_bf16 v[12:15], a[164:167], a[60:63], v[12:15]
  ds_read_b64_tr_b16 a[182:183], v226 offset:58368
  v_mfma_f32_16x16x32_bf16 v[12:15], a[160:163], a[44:47], v[12:15]
  s_waitcnt lgkmcnt(4)
  v_mfma_f32_16x16x32_bf16 v[16:19], a[168:171], a[32:35], v[16:19]
  ds_read_b64_tr_b16 a[184:185], v227 offset:49152
  v_mfma_f32_16x16x32_bf16 v[16:19], a[172:175], a[48:51], v[16:19]
  buffer_load_dwordx4 a[4:7], v242, s[24:27], s30 offen offset:1024 sc1
  v_mfma_f32_16x16x32_bf16 v[20:23], a[172:175], a[52:55], v[20:23]
  ds_read_b64_tr_b16 a[186:187], v227 offset:50176
  v_mfma_f32_16x16x32_bf16 v[20:23], a[168:171], a[36:39], v[20:23]
  v_mfma_f32_16x16x32_bf16 v[24:27], a[168:171], a[40:43], v[24:27]
  ds_read_b64_tr_b16 a[188:189], v227 offset:57344
  v_mfma_f32_16x16x32_bf16 v[24:27], a[172:175], a[56:59], v[24:27]
  v_mfma_f32_16x16x32_bf16 v[28:31], a[172:175], a[60:63], v[28:31]
  ds_read_b64_tr_b16 a[190:191], v227 offset:58368
  v_mfma_f32_16x16x32_bf16 v[28:31], a[168:171], a[44:47], v[28:31]
  s_waitcnt lgkmcnt(4)
  v_mfma_f32_16x16x32_bf16 v[32:35], a[176:179], a[32:35], v[32:35]
  ds_read_b64_tr_b16 a[160:161], v228 offset:49152
  v_mfma_f32_16x16x32_bf16 v[32:35], a[180:183], a[48:51], v[32:35]
  buffer_load_dwordx4 a[8:11], v242, s[24:27], s30 offen offset:2048 sc1
  v_mfma_f32_16x16x32_bf16 v[36:39], a[180:183], a[52:55], v[36:39]
  ds_read_b64_tr_b16 a[162:163], v228 offset:50176
  v_mfma_f32_16x16x32_bf16 v[36:39], a[176:179], a[36:39], v[36:39]
  v_mfma_f32_16x16x32_bf16 v[40:43], a[176:179], a[40:43], v[40:43]
  ds_read_b64_tr_b16 a[164:165], v228 offset:57344
  v_mfma_f32_16x16x32_bf16 v[40:43], a[180:183], a[56:59], v[40:43]
  buffer_load_dwordx4 v239, s[20:23], s31 offen offset:1024 lds
  v_mfma_f32_16x16x32_bf16 v[44:47], a[180:183], a[60:63], v[44:47]
  ds_read_b64_tr_b16 a[166:167], v228 offset:58368
  v_mfma_f32_16x16x32_bf16 v[44:47], a[176:179], a[44:47], v[44:47]
  s_waitcnt lgkmcnt(4)
  v_mfma_f32_16x16x32_bf16 v[48:51], a[184:187], a[32:35], v[48:51]
  ds_read_b64_tr_b16 a[168:169], v229 offset:49152
  v_mfma_f32_16x16x32_bf16 v[48:51], a[188:191], a[48:51], v[48:51]
  buffer_load_dwordx4 a[12:15], v242, s[24:27], s30 offen offset:3072 sc1
  v_mfma_f32_16x16x32_bf16 v[52:55], a[188:191], a[52:55], v[52:55]
  ds_read_b64_tr_b16 a[170:171], v229 offset:50176
  v_mfma_f32_16x16x32_bf16 v[52:55], a[184:187], a[36:39], v[52:55]
  v_mfma_f32_16x16x32_bf16 v[56:59], a[184:187], a[40:43], v[56:59]
  ds_read_b64_tr_b16 a[172:173], v229 offset:57344
  v_mfma_f32_16x16x32_bf16 v[56:59], a[188:191], a[56:59], v[56:59]
  v_mfma_f32_16x16x32_bf16 v[60:63], a[188:191], a[60:63], v[60:63]
  ds_read_b64_tr_b16 a[174:175], v229 offset:58368
  v_mfma_f32_16x16x32_bf16 v[60:63], a[184:187], a[44:47], v[60:63]
  s_waitcnt lgkmcnt(4)
  v_mfma_f32_16x16x32_bf16 v[64:67], a[160:163], a[32:35], v[64:67]
  ds_read_b64_tr_b16 a[176:177], v230 offset:49152
  v_mfma_f32_16x16x32_bf16 v[64:67], a[164:167], a[48:51], v[64:67]
  buffer_load_dwordx4 a[16:19], v243, s[24:27], s30 offen offset:0 sc1
  v_mfma_f32_16x16x32_bf16 v[68:71], a[164:167], a[52:55], v[68:71]
  ds_read_b64_tr_b16 a[178:179], v230 offset:50176
  v_mfma_f32_16x16x32_bf16 v[68:71], a[160:163], a[36:39], v[68:71]
  v_mfma_f32_16x16x32_bf16 v[72:75], a[160:163], a[40:43], v[72:75]
  ds_read_b64_tr_b16 a[180:181], v230 offset:57344
  v_mfma_f32_16x16x32_bf16 v[72:75], a[164:167], a[56:59], v[72:75]
  buffer_load_dwordx4 v240, s[20:23], s31 offen offset:2048 lds
  v_mfma_f32_16x16x32_bf16 v[76:79], a[164:167], a[60:63], v[76:79]
  ds_read_b64_tr_b16 a[182:183], v230 offset:58368
  v_mfma_f32_16x16x32_bf16 v[76:79], a[160:163], a[44:47], v[76:79]
  s_waitcnt lgkmcnt(4)
  v_mfma_f32_16x16x32_bf16 v[80:83], a[168:171], a[32:35], v[80:83]
  ds_read_b64_tr_b16 a[184:185], v231 offset:49152
  v_mfma_f32_16x16x32_bf16 v[80:83], a[172:175], a[48:51], v[80:83]
  buffer_load_dwordx4 a[20:23], v243, s[24:27], s30 offen offset:1024 sc1
  v_mfma_f32_16x16x32_bf16 v[84:87], a[172:175], a[52:55], v[84:87]
  ds_read_b64_tr_b16 a[186:187], v231 offset:50176
  v_mfma_f32_16x16x32_bf16 v[84:87], a[168:171], a[36:39], v[84:87]
  v_mfma_f32_16x16x32_bf16 v[88:91], a[168:171], a[40:43], v[88:91]
  ds_read_b64_tr_b16 a[188:189], v231 offset:57344
  v_mfma_f32_16x16x32_bf16 v[88:91], a[172:175], a[56:59], v[88:91]
  s_barrier
  v_mfma_f32_16x16x32_bf16 v[92:95], a[172:175], a[60:63], v[92:95]
  ds_read_b64_tr_b16 a[190:191], v231 offset:58368
  v_mfma_f32_16x16x32_bf16 v[92:95], a[168:171], a[44:47], v[92:95]
  s_waitcnt lgkmcnt(4)
  v_mfma_f32_16x16x32_bf16 v[96:99], a[176:179], a[32:35], v[96:99]
  ds_read_b64_tr_b16 a[160:161], v144 offset:32768
  v_mfma_f32_16x16x32_bf16 v[96:99], a[180:183], a[48:51], v[96:99]
  buffer_load_dwordx4 a[24:27], v243, s[24:27], s30 offen offset:2048 sc1
  v_mfma_f32_16x16x32_bf16 v[100:103], a[180:183], a[52:55], v[100:103]
  ds_read_b64_tr_b16 a[162:163], v144 offset:33792
  v_mfma_f32_16x16x32_bf16 v[100:103], a[176:179], a[36:39], v[100:103]
  v_mfma_f32_16x16x32_bf16 v[104:107], a[176:179], a[40:43], v[104:107]
  ds_read_b64_tr_b16 a[164:165], v144 offset:40960
  v_mfma_f32_16x16x32_bf16 v[104:107], a[180:183], a[56:59], v[104:107]
  buffer_load_dwordx4 v241, s[20:23], s31 offen offset:3072 lds
  s_add_u32 s31, s31, 0x80000
  v_mfma_f32_16x16x32_bf16 v[108:111], a[180:183], a[60:63], v[108:111]
  ds_read_b64_tr_b16 a[166:167], v144 offset:41984
  v_mfma_f32_16x16x32_bf16 v[108:111], a[176:179], a[44:47], v[108:111]
  s_waitcnt lgkmcnt(4)
  v_mfma_f32_16x16x32_bf16 v[112:115], a[184:187], a[32:35], v[112:115]
  ds_read_b64_tr_b16 a[168:169], v145 offset:32768
  v_mfma_f32_16x16x32_bf16 v[112:115], a[188:191], a[48:51], v[112:115]
  buffer_load_dwordx4 a[28:31], v243, s[24:27], s30 offen offset:3072 sc1
  s_add_u32 s30, s30, 8192
  v_mfma_f32_16x16x32_bf16 v[116:119], a[188:191], a[52:55], v[116:119]
  ds_read_b64_tr_b16 a[170:171], v145 offset:33792
  v_mfma_f32_16x16x32_bf16 v[116:119], a[184:187], a[36:39], v[116:119]
  v_mfma_f32_16x16x32_bf16 v[120:123], a[184:187], a[40:43], v[120:123]
  ds_read_b64_tr_b16 a[172:173], v145 offset:40960
  v_mfma_f32_16x16x32_bf16 v[120:123], a[188:191], a[56:59], v[120:123]
  v_mfma_f32_16x16x32_bf16 v[124:127], a[188:191], a[60:63], v[124:127]
  ds_read_b64_tr_b16 a[174:175], v145 offset:41984
  v_mfma_f32_16x16x32_bf16 v[124:127], a[184:187], a[44:47], v[124:127]
  s_waitcnt vmcnt(20) lgkmcnt(4)
  v_xor_b32 v136, s55, v136
  v_xor_b32 v137, s55, v137
  v_xor_b32 v138, s55, v138
  v_xor_b32 v139, s55, v139
  v_or3_b32 v136, v136, v137, v138
  v_or_b32 v136, v136, v139
  v_cmp_ne_u32 vcc, 0, v136
  s_nop 0
  s_cbranch_vccz front_keys
  s_mov_b32 s54, 32768
front_all:
  s_sleep 2
  buffer_load_dwordx4 v[136:139], v140, s[24:27], s58 offen sc1
  s_waitcnt vmcnt(0)
  v_xor_b32 v136, s55, v136
  v_xor_b32 v137, s55, v137
  v_xor_b32 v138, s55, v138
  v_xor_b32 v139, s55, v139
  v_or3_b32 v136, v136, v137, v138
  v_or_b32 v136, v136, v139
  v_cmp_ne_u32 vcc, 0, v136
  s_nop 0
  s_cbranch_vccz front_keys
  s_sub_u32 s54, s54, 1
  s_cmp_lg_u32 s54, 0
  s_cbranch_scc1 front_all
front_keys:
  s_lshl_b32 s35, s3, 11
  s_add_u32 s35, s35, 2621440
  buffer_load_dwordx4 v[128:131], v242, s[24:27], s35 offen sc1
  buffer_load_dwordx4 v[132:135], v242, s[24:27], s35 offen offset:1024 sc1
  v_mfma_f32_16x16x32_bf16 v[0:3], a[160:163], a[64:67], v[0:3]
  ds_read_b64_tr_b16 a[176:177], v146 offset:32768
  s_add_u32 s59, s59, 1
  s_or_b32 s54, s2, s3
  s_min_u32 s54, s54, 1
  v_mfma_f32_16x16x32_bf16 v[0:3], a[164:167], a[80:83], v[0:3]
  buffer_load_dwordx4 a[32:35], v242, s[24:27], s30 offen offset:0 sc1
  s_lshl_b32 s54, s54, 28
  v_mfma_f32_16x16x32_bf16 v[4:7], a[164:167], a[84:87], v[4:7]
  ds_read_b64_tr_b16 a[178:179], v146 offset:33792
  v_lshlrev_b32 v137, 22, v242
  v_mfma_f32_16x16x32_bf16 v[4:7], a[160:163], a[68:71], v[4:7]
  v_or_b32 v137, s54, v137
  v_mov_b32 v136, s59
  v_mfma_f32_16x16x32_bf16 v[8:11], a[160:163], a[72:75], v[8:11]
  ds_read_b64_tr_b16 a[180:181], v146 offset:40960
  s_add_u32 m0, s28, 0
  s_mov_b32 s58, 2830336
  buffer_store_dword v136, v137, s[24:27], s58 offen sc1
  v_mfma_f32_16x16x32_bf16 v[8:11], a[164:167], a[88:91], v[8:11]
  buffer_load_dwordx4 v238, s[20:23], s31 offen offset:0 lds
  v_mfma_f32_16x16x32_bf16 v[12:15], a[164:167], a[92:95], v[12:15]
  ds_read_b64_tr_b16 a[182:183], v146 offset:41984
  v_mfma_f32_16x16x32_bf16 v[12:15], a[160:163], a[76:79], v[12:15]
  s_waitcnt lgkmcnt(4)
  v_mfma_f32_16x16x32_bf16 v[16:19], a[168:171], a[64:67], v[16:19]
  ds_read_b64_tr_b16 a[184:185], v147 offset:32768
  v_mfma_f32_16x16x32_bf16 v[16:19], a[172:175], a[80:83], v[16:19]
  buffer_load_dwordx4 a[36:39], v242, s[24:27], s30 offen offset:1024 sc1
  v_mfma_f32_16x16x32_bf16 v[20:23], a[172:175], a[84:87], v[20:23]
  ds_read_b64_tr_b16 a[186:187], v147 offset:33792
  v_mfma_f32_16x16x32_bf16 v[20:23], a[168:171], a[68:71], v[20:23]
  v_mfma_f32_16x16x32_bf16 v[24:27], a[168:171], a[72:75], v[24:27]
  ds_read_b64_tr_b16 a[188:189], v147 offset:40960
  v_mfma_f32_16x16x32_bf16 v[24:27], a[172:175], a[88:91], v[24:27]
  v_mfma_f32_16x16x32_bf16 v[28:31], a[172:175], a[92:95], v[28:31]
  ds_read_b64_tr_b16 a[190:191], v147 offset:41984
  v_mfma_f32_16x16x32_bf16 v[28:31], a[168:171], a[76:79], v[28:31]
  s_waitcnt lgkmcnt(4)
  v_mfma_f32_16x16x32_bf16 v[32:35], a[176:179], a[64:67], v[32:35]
  ds_read_b64_tr_b16 a[160:161], v148 offset:32768
  v_mfma_f32_16x16x32_bf16 v[32:35], a[180:183], a[80:83], v[32:35]
  buffer_load_dwordx4 a[40:43], v242, s[24:27], s30 offen offset:2048 sc1
  v_mfma_f32_16x16x32_bf16 v[36:39], a[180:183], a[84:87], v[36:39]
  ds_read_b64_tr_b16 a[162:163], v148 offset:33792
  v_mfma_f32_16x16x32_bf16 v[36:39], a[176:179], a[68:71], v[36:39]
  v_mfma_f32_16x16x32_bf16 v[40:43], a[176:179], a[72:75], v[40:43]
  ds_read_b64_tr_b16 a[164:165], v148 offset:40960
  v_mfma_f32_16x16x32_bf16 v[40:43], a[180:183], a[88:91], v[40:43]
  buffer_load_dwordx4 v239, s[20:23], s31 offen offset:1024 lds
  v_mfma_f32_16x16x32_bf16 v[44:47], a[180:183], a[92:95], v[44:47]
  ds_read_b64_tr_b16 a[166:167], v148 offset:41984
  v_mfma_f32_16x16x32_bf16 v[44:47], a[176:179], a[76:79], v[44:47]
  s_waitcnt lgkmcnt(4)
  v_mfma_f32_16x16x32_bf16 v[48:51], a[184:187], a[64:67], v[48:51]
  ds_read_b64_tr_b16 a[168:169], v149 offset:32768
  v_mfma_f32_16x16x32_bf16 v[48:51], a[188:191], a[80:83], v[48:51]
  buffer_load_dwordx4 a[44:47], v242, s[24:27], s30 offen offset:3072 sc1
  v_mfma_f32_16x16x32_bf16 v[52:55], a[188:191], a[84:87], v[52:55]
  ds_read_b64_tr_b16 a[170:171], v149 offset:33792
  v_mfma_f32_16x16x32_bf16 v[52:55], a[184:187], a[68:71], v[52:55]
  v_mfma_f32_16x16x32_bf16 v[56:59], a[184:187], a[72:75], v[56:59]
  ds_read_b64_tr_b16 a[172:173], v149 offset:40960
  v_mfma_f32_16x16x32_bf16 v[56:59], a[188:191], a[88:91], v[56:59]
  v_mfma_f32_16x16x32_bf16 v[60:63], a[188:191], a[92:95], v[60:63]
  ds_read_b64_tr_b16 a[174:175], v149 offset:41984
  v_mfma_f32_16x16x32_bf16 v[60:63], a[184:187], a[76:79], v[60:63]
  s_waitcnt lgkmcnt(4)
  v_mfma_f32_16x16x32_bf16 v[64:67], a[160:163], a[64:67], v[64:67]
  ds_read_b64_tr_b16 a[176:177], v150 offset:32768
  v_mfma_f32_16x16x32_bf16 v[64:67], a[164:167], a[80:83], v[64:67]
  buffer_load_dwordx4 a[48:51], v243, s[24:27], s30 offen offset:0 sc1
  v_mfma_f32_16x16x32_bf16 v[68:71], a[164:167], a[84:87], v[68:71]
  ds_read_b64_tr_b16 a[178:179], v150 offset:33792
  v_mfma_f32_16x16x32_bf16 v[68:71], a[160:163], a[68:71], v[68:71]
  v_mfma_f32_16x16x32_bf16 v[72:75], a[160:163], a[72:75], v[72:75]
  ds_read_b64_tr_b16 a[180:181], v150 offset:40960
  v_mfma_f32_16x16x32_bf16 v[72:75], a[164:167], a[88:91], v[72:75]
  buffer_load_dwordx4 v240, s[20:23], s31 offen offset:2048 lds
  v_mfma_f32_16x16x32_bf16 v[76:79], a[164:167], a[92:95], v[76:79]
  ds_read_b64_tr_b16 a[182:183], v150 offset:41984
  v_mfma_f32_16x16x32_bf16 v[76:79], a[160:163], a[76:79], v[76:79]
  s_waitcnt lgkmcnt(4)
  v_mfma_f32_16x16x32_bf16 v[80:83], a[168:171], a[64:67], v[80:83]
  ds_read_b64_tr_b16 a[184:185], v151 offset:32768
  v_mfma_f32_16x16x32_bf16 v[80:83], a[172:175], a[80:83], v[80:83]
  buffer_load_dwordx4 a[52:55], v243, s[24:27], s30 offen offset:1024 sc1
  v_mfma_f32_16x16x32_bf16 v[84:87], a[172:175], a[84:87], v[84:87]
  ds_read_b64_tr_b16 a[186:187], v151 offset:33792
  v_mfma_f32_16x16x32_bf16 v[84:87], a[168:171], a[68:71], v[84:87]
  v_mfma_f32_16x16x32_bf16 v[88:91], a[168:171], a[72:75], v[88:91]
  ds_read_b64_tr_b16 a[188:189], v151 offset:40960
  v_mfma_f32_16x16x32_bf16 v[88:91], a[172:175], a[88:91], v[88:91]
  s_barrier
  v_mfma_f32_16x16x32_bf16 v[92:95], a[172:175], a[92:95], v[92:95]
  ds_read_b64_tr_b16 a[190:191], v151 offset:41984
  v_mfma_f32_16x16x32_bf16 v[92:95], a[168:171], a[76:79], v[92:95]
  s_waitcnt lgkmcnt(4)
  v_mfma_f32_16x16x32_bf16 v[96:99], a[176:179], a[64:67], v[96:99]
  ds_read_b64_tr_b16 a[160:161], v144 offset:49152
  v_mfma_f32_16x16x32_bf16 v[96:99], a[180:183], a[80:83], v[96:99]
  buffer_load_dwordx4 a[56:59], v243, s[24:27], s30 offen offset:2048 sc1
  v_mfma_f32_16x16x32_bf16 v[100:103], a[180:183], a[84:87], v[100:103]
  ds_read_b64_tr_b16 a[162:163], v144 offset:50176
  v_mfma_f32_16x16x32_bf16 v[100:103], a[176:179], a[68:71], v[100:103]
  v_mfma_f32_16x16x32_bf16 v[104:107], a[176:179], a[72:75], v[104:107]
  ds_read_b64_tr_b16 a[164:165], v144 offset:57344
  v_mfma_f32_16x16x32_bf16 v[104:107], a[180:183], a[88:91], v[104:107]
  buffer_load_dwordx4 v241, s[20:23], s31 offen offset:3072 lds
  s_add_u32 s31, s31, 0x80000
  v_mfma_f32_16x16x32_bf16 v[108:111], a[180:183], a[92:95], v[108:111]
  ds_read_b64_tr_b16 a[166:167], v144 offset:58368
  v_mfma_f32_16x16x32_bf16 v[108:111], a[176:179], a[76:79], v[108:111]
  s_waitcnt lgkmcnt(4)
  v_mfma_f32_16x16x32_bf16 v[112:115], a[184:187], a[64:67], v[112:115]
  ds_read_b64_tr_b16 a[168:169], v145 offset:49152
  v_mfma_f32_16x16x32_bf16 v[112:115], a[188:191], a[80:83], v[112:115]
  buffer_load_dwordx4 a[60:63], v243, s[24:27], s30 offen offset:3072 sc1
  s_add_u32 s30, s30, 8192
  v_mfma_f32_16x16x32_bf16 v[116:119], a[188:191], a[84:87], v[116:119]
  ds_read_b64_tr_b16 a[170:171], v145 offset:50176
  v_mfma_f32_16x16x32_bf16 v[116:119], a[184:187], a[68:71], v[116:119]
  v_mfma_f32_16x16x32_bf16 v[120:123], a[184:187], a[72:75], v[120:123]
  ds_read_b64_tr_b16 a[172:173], v145 offset:57344
  v_mfma_f32_16x16x32_bf16 v[120:123], a[188:191], a[88:91], v[120:123]
  v_mfma_f32_16x16x32_bf16 v[124:127], a[188:191], a[92:95], v[124:127]
  ds_read_b64_tr_b16 a[174:175], v145 offset:58368
  v_mfma_f32_16x16x32_bf16 v[124:127], a[184:187], a[76:79], v[124:127]
  s_waitcnt vmcnt(27) lgkmcnt(4)
  v_mfma_f32_16x16x32_bf16 v[0:3], a[160:163], a[96:99], v[0:3]
  ds_read_b64_tr_b16 a[176:177], v146 offset:49152
  v_mfma_f32_16x16x32_bf16 v[0:3], a[164:167], a[112:115], v[0:3]
  buffer_load_dwordx4 a[64:67], v242, s[24:27], s30 offen offset:0 sc1
  v_mfma_f32_16x16x32_bf16 v[4:7], a[164:167], a[116:119], v[4:7]
  ds_read_b64_tr_b16 a[178:179], v146 offset:50176
  v_mfma_f32_16x16x32_bf16 v[4:7], a[160:163], a[100:103], v[4:7]
  v_mfma_f32_16x16x32_bf16 v[8:11], a[160:163], a[104:107], v[8:11]
  ds_read_b64_tr_b16 a[180:181], v146 offset:57344
  s_add_u32 m0, s28, 65536
  v_mfma_f32_16x16x32_bf16 v[8:11], a[164:167], a[120:123], v[8:11]
  buffer_load_dwordx4 v238, s[20:23], s31 offen offset:0 lds
  v_mfma_f32_16x16x32_bf16 v[12:15], a[164:167], a[124:127], v[12:15]
  ds_read_b64_tr_b16 a[182:183], v146 offset:58368
  v_mfma_f32_16x16x32_bf16 v[12:15], a[160:163], a[108:111], v[12:15]
  s_waitcnt lgkmcnt(4)
  v_mfma_f32_16x16x32_bf16 v[16:19], a[168:171], a[96:99], v[16:19]
  ds_read_b64_tr_b16 a[184:185], v147 offset:49152
  v_mfma_f32_16x16x32_bf16 v[16:19], a[172:175], a[112:115], v[16:19]
  buffer_load_dwordx4 a[68:71], v242, s[24:27], s30 offen offset:1024 sc1
  v_mfma_f32_16x16x32_bf16 v[20:23], a[172:175], a[116:119], v[20:23]
  ds_read_b64_tr_b16 a[186:187], v147 offset:50176
  v_mfma_f32_16x16x32_bf16 v[20:23], a[168:171], a[100:103], v[20:23]
  v_mfma_f32_16x16x32_bf16 v[24:27], a[168:171], a[104:107], v[24:27]
  ds_read_b64_tr_b16 a[188:189], v147 offset:57344
  v_mfma_f32_16x16x32_bf16 v[24:27], a[172:175], a[120:123], v[24:27]
  v_mfma_f32_16x16x32_bf16 v[28:31], a[172:175], a[124:127], v[28:31]
  ds_read_b64_tr_b16 a[190:191], v147 offset:58368
  v_mfma_f32_16x16x32_bf16 v[28:31], a[168:171], a[108:111], v[28:31]
  s_waitcnt lgkmcnt(4)
  v_mfma_f32_16x16x32_bf16 v[32:35], a[176:179], a[96:99], v[32:35]
  ds_read_b64_tr_b16 a[160:161], v148 offset:49152
  v_mfma_f32_16x16x32_bf16 v[32:35], a[180:183], a[112:115], v[32:35]
  buffer_load_dwordx4 a[72:75], v242, s[24:27], s30 offen offset:2048 sc1
  v_mfma_f32_16x16x32_bf16 v[36:39], a[180:183], a[116:119], v[36:39]
  ds_read_b64_tr_b16 a[162:163], v148 offset:50176
  v_mfma_f32_16x16x32_bf16 v[36:39], a[176:179], a[100:103], v[36:39]
  v_mfma_f32_16x16x32_bf16 v[40:43], a[176:179], a[104:107], v[40:43]
  ds_read_b64_tr_b16 a[164:165], v148 offset:57344
  v_mfma_f32_16x16x32_bf16 v[40:43], a[180:183], a[120:123], v[40:43]
  buffer_load_dwordx4 v239, s[20:23], s31 offen offset:1024 lds
  v_mfma_f32_16x16x32_bf16 v[44:47], a[180:183], a[124:127], v[44:47]
  ds_read_b64_tr_b16 a[166:167], v148 offset:58368
  v_mfma_f32_16x16x32_bf16 v[44:47], a[176:179], a[108:111], v[44:47]
  s_waitcnt lgkmcnt(4)
  v_mfma_f32_16x16x32_bf16 v[48:51], a[184:187], a[96:99], v[48:51]
  ds_read_b64_tr_b16 a[168:169], v149 offset:49152
  v_mfma_f32_16x16x32_bf16 v[48:51], a[188:191], a[112:115], v[48:51]
  buffer_load_dwordx4 a[76:79], v242, s[24:27], s30 offen offset:3072 sc1
  v_mfma_f32_16x16x32_bf16 v[52:55], a[188:191], a[116:119], v[52:55]
  ds_read_b64_tr_b16 a[170:171], v149 offset:50176
  v_mfma_f32_16x16x32_bf16 v[52:55], a[184:187], a[100:103], v[52:55]
  v_mfma_f32_16x16x32_bf16 v[56:59], a[184:187], a[104:107], v[56:59]
  ds_read_b64_tr_b16 a[172:173], v149 offset:57344
  v_mfma_f32_16x16x32_bf16 v[56:59], a[188:191], a[120:123], v[56:59]
  v_mfma_f32_16x16x32_bf16 v[60:63], a[188:191], a[124:127], v[60:63]
  ds_read_b64_tr_b16 a[174:175], v149 offset:58368
  v_mfma_f32_16x16x32_bf16 v[60:63], a[184:187], a[108:111], v[60:63]
  s_waitcnt lgkmcnt(4)
  v_mfma_f32_16x16x32_bf16 v[64:67], a[160:163], a[96:99], v[64:67]
  ds_read_b64_tr_b16 a[176:177], v150 offset:49152
  v_mfma_f32_16x16x32_bf16 v[64:67], a[164:167], a[112:115], v[64:67]
  buffer_load_dwordx4 a[80:83], v243, s[24:27], s30 offen offset:0 sc1
  v_mfma_f32_16x16x32_bf16 v[68:71], a[164:167], a[116:119], v[68:71]
  ds_read_b64_tr_b16 a[178:179], v150 offset:50176
  v_mfma_f32_16x16x32_bf16 v[68:71], a[160:163], a[100:103], v[68:71]
  v_mfma_f32_16x16x32_bf16 v[72:75], a[160:163], a[104:107], v[72:75]
  ds_read_b64_tr_b16 a[180:181], v150 offset:57344
  v_mfma_f32_16x16x32_bf16 v[72:75], a[164:167], a[120:123], v[72:75]
  buffer_load_dwordx4 v240, s[20:23], s31 offen offset:2048 lds
  v_mfma_f32_16x16x32_bf16 v[76:79], a[164:167], a[124:127], v[76:79]
  ds_read_b64_tr_b16 a[182:183], v150 offset:58368
  v_mfma_f32_16x16x32_bf16 v[76:79], a[160:163], a[108:111], v[76:79]
  s_waitcnt lgkmcnt(4)
  v_mfma_f32_16x16x32_bf16 v[80:83], a[168:171], a[96:99], v[80:83]
  ds_read_b64_tr_b16 a[184:185], v151 offset:49152
  v_mfma_f32_16x16x32_bf16 v[80:83], a[172:175], a[112:115], v[80:83]
  buffer_load_dwordx4 a[84:87], v243, s[24:27], s30 offen offset:1024 sc1
  v_mfma_f32_16x16x32_bf16 v[84:87], a[172:175], a[116:119], v[84:87]
  ds_read_b64_tr_b16 a[186:187], v151 offset:50176
  v_mfma_f32_16x16x32_bf16 v[84:87], a[168:171], a[100:103], v[84:87]
  s_waitcnt vmcnt(25)
  v_mfma_f32_16x16x32_bf16 v[88:91], a[168:171], a[104:107], v[88:91]
  ds_read_b64_tr_b16 a[188:189], v151 offset:57344
  v_mfma_f32_16x16x32_bf16 v[88:91], a[172:175], a[120:123], v[88:91]
  s_barrier
  v_mfma_f32_16x16x32_bf16 v[92:95], a[172:175], a[124:127], v[92:95]
  ds_read_b64_tr_b16 a[190:191], v151 offset:58368
  v_mfma_f32_16x16x32_bf16 v[92:95], a[168:171], a[108:111], v[92:95]
  s_waitcnt lgkmcnt(4)
  v_mfma_f32_16x16x32_bf16 v[96:99], a[176:179], a[96:99], v[96:99]
  ds_read_b64_tr_b16 a[160:161], v144 offset:16384
  v_mfma_f32_16x16x32_bf16 v[96:99], a[180:183], a[112:115], v[96:99]
  buffer_load_dwordx4 a[88:91], v243, s[24:27], s30 offen offset:2048 sc1
  v_mfma_f32_16x16x32_bf16 v[100:103], a[180:183], a[116:119], v[100:103]
  ds_read_b64_tr_b16 a[162:163], v144 offset:17408
  v_mfma_f32_16x16x32_bf16 v[100:103], a[176:179], a[100:103], v[100:103]
  v_mfma_f32_16x16x32_bf16 v[104:107], a[176:179], a[104:107], v[104:107]
  ds_read_b64_tr_b16 a[164:165], v144 offset:24576
  v_mfma_f32_16x16x32_bf16 v[104:107], a[180:183], a[120:123], v[104:107]
  buffer_load_dwordx4 v241, s[20:23], s31 offen offset:3072 lds
  s_add_u32 s31, s31, 0x80000
  v_mfma_f32_16x16x32_bf16 v[108:111], a[180:183], a[124:127], v[108:111]
  ds_read_b64_tr_b16 a[166:167], v144 offset:25600
  v_mfma_f32_16x16x32_bf16 v[108:111], a[176:179], a[108:111], v[108:111]
  s_waitcnt lgkmcnt(4)
  v_mfma_f32_16x16x32_bf16 v[112:115], a[184:187], a[96:99], v[112:115]
  ds_read_b64_tr_b16 a[168:169], v145 offset:16384
  v_mfma_f32_16x16x32_bf16 v[112:115], a[188:191], a[112:115], v[112:115]
  buffer_load_dwordx4 a[92:95], v243, s[24:27], s30 offen offset:3072 sc1
  s_add_u32 s30, s30, 8192
  v_mfma_f32_16x16x32_bf16 v[116:119], a[188:191], a[116:119], v[116:119]
  ds_read_b64_tr_b16 a[170:171], v145 offset:17408
  v_mfma_f32_16x16x32_bf16 v[116:119], a[184:187], a[100:103], v[116:119]
  v_mfma_f32_16x16x32_bf16 v[120:123], a[184:187], a[104:107], v[120:123]
  ds_read_b64_tr_b16 a[172:173], v145 offset:24576
  v_mfma_f32_16x16x32_bf16 v[120:123], a[188:191], a[120:123], v[120:123]
  v_mfma_f32_16x16x32_bf16 v[124:127], a[188:191], a[124:127], v[124:127]
  ds_read_b64_tr_b16 a[174:175], v145 offset:25600
  v_mfma_f32_16x16x32_bf16 v[124:127], a[184:187], a[108:111], v[124:127]
  s_waitcnt vmcnt(27) lgkmcnt(4)
  v_mfma_f32_16x16x32_bf16 v[0:3], a[160:163], a[0:3], v[0:3]
  ds_read_b64_tr_b16 a[176:177], v146 offset:16384
  s_waitcnt vmcnt(25)
  s_mov_b32 s51, -1
  v_sub_u32 v137, s51, v128
  v_mfma_f32_16x16x32_bf16 v[0:3], a[164:167], a[16:19], v[0:3]
  buffer_load_dwordx4 a[96:99], v242, s[24:27], s30 offen offset:0 sc1
  v_mfma_f32_16x16x32_bf16 v[4:7], a[164:167], a[20:23], v[4:7]
  ds_read_b64_tr_b16 a[178:179], v146 offset:17408
  v_sub_u32 v138, s51, v129
  v_mfma_f32_16x16x32_bf16 v[4:7], a[160:163], a[4:7], v[4:7]
  v_min_u32 v136, v137, v138
  v_sub_u32 v139, s51, v130
  v_mfma_f32_16x16x32_bf16 v[8:11], a[160:163], a[8:11], v[8:11]
  ds_read_b64_tr_b16 a[180:181], v146 offset:24576
  s_add_u32 m0, s28, 81920
  v_sub_u32 v140, s51, v131
  v_mfma_f32_16x16x32_bf16 v[8:11], a[164:167], a[24:27], v[8:11]
  buffer_load_dwordx4 v238, s[20:23], s31 offen offset:0 lds
  v_mfma_f32_16x16x32_bf16 v[12:15], a[164:167], a[28:31], v[12:15]
  ds_read_b64_tr_b16 a[182:183], v146 offset:25600
  v_min3_u32 v136, v136, v139, v140
  v_mfma_f32_16x16x32_bf16 v[12:15], a[160:163], a[12:15], v[12:15]
  s_waitcnt lgkmcnt(4)
  v_sub_u32 v137, s51, v132
  v_sub_u32 v138, s51, v133
  v_mfma_f32_16x16x32_bf16 v[16:19], a[168:171], a[0:3], v[16:19]
  ds_read_b64_tr_b16 a[184:185], v147 offset:16384
  v_min3_u32 v136, v136, v137, v138
  v_mfma_f32_16x16x32_bf16 v[16:19], a[172:175], a[16:19], v[16:19]
  buffer_load_dwordx4 a[100:103], v242, s[24:27], s30 offen offset:1024 sc1
  v_mfma_f32_16x16x32_bf16 v[20:23], a[172:175], a[20:23], v[20:23]
  ds_read_b64_tr_b16 a[186:187], v147 offset:17408
  v_sub_u32 v139, s51, v134
  v_mfma_f32_16x16x32_bf16 v[20:23], a[168:171], a[4:7], v[20:23]
  v_sub_u32 v140, s51, v135
  v_min3_u32 v136, v136, v139, v140
  v_mfma_f32_16x16x32_bf16 v[24:27], a[168:171], a[8:11], v[24:27]
  ds_read_b64_tr_b16 a[188:189], v147 offset:24576
  v_min_u32_dpp v136, v136, v136 row_ror:8 row_mask:0xf bank_mask:0xf
  v_mfma_f32_16x16x32_bf16 v[24:27], a[172:175], a[24:27], v[24:27]
  v_mfma_f32_16x16x32_bf16 v[28:31], a[172:175], a[28:31], v[28:31]
  ds_read_b64_tr_b16 a[190:191], v147 offset:25600
  v_min_u32_dpp v136, v136, v136 row_ror:4 row_mask:0xf bank_mask:0xf
  v_mfma_f32_16x16x32_bf16 v[28:31], a[168:171], a[12:15], v[28:31]
  s_waitcnt lgkmcnt(4)
  v_min_u32_dpp v136, v136, v136 row_ror:2 row_mask:0xf bank_mask:0xf
  v_mfma_f32_16x16x32_bf16 v[32:35], a[176:179], a[0:3], v[32:35]
  ds_read_b64_tr_b16 a[160:161], v148 offset:16384
  v_min_u32_dpp v136, v136, v136 row_ror:1 row_mask:0xf bank_mask:0xf
  v_mfma_f32_16x16x32_bf16 v[32:35], a[180:183], a[16:19], v[32:35]
  buffer_load_dwordx4 a[104:107], v242, s[24:27], s30 offen offset:2048 sc1
  v_mfma_f32_16x16x32_bf16 v[36:39], a[180:183], a[20:23], v[36:39]
  ds_read_b64_tr_b16 a[162:163], v148 offset:17408
  v_readlane_b32 s98, v136, 0
  v_mfma_f32_16x16x32_bf16 v[36:39], a[176:179], a[4:7], v[36:39]
  v_readlane_b32 s99, v136, 16
  v_readlane_b32 s100, v136, 32
  v_mfma_f32_16x16x32_bf16 v[40:43], a[176:179], a[8:11], v[40:43]
  ds_read_b64_tr_b16 a[164:165], v148 offset:24576
  v_readlane_b32 s101, v136, 48
  v_mfma_f32_16x16x32_bf16 v[40:43], a[180:183], a[24:27], v[40:43]
  buffer_load_dwordx4 v239, s[20:23], s31 offen offset:1024 lds
  s_min_u32 s98, s98, s99
  s_min_u32 s100, s100, s101
  s_min_u32 s98, s98, s100
  v_mfma_f32_16x16x32_bf16 v[44:47], a[180:183], a[28:31], v[44:47]
  ds_read_b64_tr_b16 a[166:167], v148 offset:25600
  s_sub_u32 s52, s51, s98
  s_sub_u32 s51, s52, 1
  v_sub_u32 v137, s51, v128
  v_mfma_f32_16x16x32_bf16 v[44:47], a[176:179], a[12:15], v[44:47]
  s_waitcnt lgkmcnt(4)
  v_sub_u32 v138, s51, v129
  v_min_u32 v136, v137, v138
  v_mfma_f32_16x16x32_bf16 v[48:51], a[184:187], a[0:3], v[48:51]
  ds_read_b64_tr_b16 a[168:169], v149 offset:16384
  v_sub_u32 v139, s51, v130
  v_mfma_f32_16x16x32_bf16 v[48:51], a[188:191], a[16:19], v[48:51]
  buffer_load_dwordx4 a[108:111], v242, s[24:27], s30 offen offset:3072 sc1
  v_mfma_f32_16x16x32_bf16 v[52:55], a[188:191], a[20:23], v[52:55]
  ds_read_b64_tr_b16 a[170:171], v149 offset:17408
  v_sub_u32 v140, s51, v131
  v_mfma_f32_16x16x32_bf16 v[52:55], a[184:187], a[4:7], v[52:55]
  v_min3_u32 v136, v136, v139, v140
  v_sub_u32 v137, s51, v132
  v_mfma_f32_16x16x32_bf16 v[56:59], a[184:187], a[8:11], v[56:59]
  ds_read_b64_tr_b16 a[172:173], v149 offset:24576
  v_sub_u32 v138, s51, v133
  v_mfma_f32_16x16x32_bf16 v[56:59], a[188:191], a[24:27], v[56:59]
  v_min3_u32 v136, v136, v137, v138
  v_sub_u32 v139, s51, v134
  v_mfma_f32_16x16x32_bf16 v[60:63], a[188:191], a[28:31], v[60:63]
  ds_read_b64_tr_b16 a[174:175], v149 offset:25600
  v_sub_u32 v140, s51, v135
  v_mfma_f32_16x16x32_bf16 v[60:63], a[184:187], a[12:15], v[60:63]
  s_waitcnt lgkmcnt(4)
  v_min3_u32 v136, v136, v139, v140
  v_mfma_f32_16x16x32_bf16 v[64:67], a[160:163], a[0:3], v[64:67]
  ds_read_b64_tr_b16 a[176:177], v150 offset:16384
  v_min_u32_dpp v136, v136, v136 row_ror:8 row_mask:0xf bank_mask:0xf
  v_mfma_f32_16x16x32_bf16 v[64:67], a[164:167], a[16:19], v[64:67]
  buffer_load_dwordx4 a[112:115], v243, s[24:27], s30 offen offset:0 sc1
  v_mfma_f32_16x16x32_bf16 v[68:71], a[164:167], a[20:23], v[68:71]
  ds_read_b64_tr_b16 a[178:179], v150 offset:17408
  v_min_u32_dpp v136, v136, v136 row_ror:4 row_mask:0xf bank_mask:0xf
  v_mfma_f32_16x16x32_bf16 v[68:71], a[160:163], a[4:7], v[68:71]
  v_mfma_f32_16x16x32_bf16 v[72:75], a[160:163], a[8:11], v[72:75]
  ds_read_b64_tr_b16 a[180:181], v150 offset:24576
  v_min_u32_dpp v136, v136, v136 row_ror:2 row_mask:0xf bank_mask:0xf
  v_mfma_f32_16x16x32_bf16 v[72:75], a[164:167], a[24:27], v[72:75]
  buffer_load_dwordx4 v240, s[20:23], s31 offen offset:2048 lds
  v_mfma_f32_16x16x32_bf16 v[76:79], a[164:167], a[28:31], v[76:79]
  ds_read_b64_tr_b16 a[182:183], v150 offset:25600
  v_min_u32_dpp v136, v136, v136 row_ror:1 row_mask:0xf bank_mask:0xf
  v_mfma_f32_16x16x32_bf16 v[76:79], a[160:163], a[12:15], v[76:79]
  s_waitcnt lgkmcnt(4)
  v_readlane_b32 s98, v136, 0
  v_readlane_b32 s99, v136, 16
  v_mfma_f32_16x16x32_bf16 v[80:83], a[168:171], a[0:3], v[80:83]
  ds_read_b64_tr_b16 a[184:185], v151 offset:16384
  v_readlane_b32 s100, v136, 32
  v_mfma_f32_16x16x32_bf16 v[80:83], a[172:175], a[16:19], v[80:83]
  buffer_load_dwordx4 a[116:119], v243, s[24:27], s30 offen offset:1024 sc1
  v_mfma_f32_16x16x32_bf16 v[84:87], a[172:175], a[20:23], v[84:87]
  ds_read_b64_tr_b16 a[186:187], v151 offset:17408
  v_readlane_b32 s101, v136, 48
  v_mfma_f32_16x16x32_bf16 v[84:87], a[168:171], a[4:7], v[84:87]
  s_waitcnt vmcnt(22)
  s_min_u32 s98, s98, s99
  s_min_u32 s100, s100, s101
  v_mfma_f32_16x16x32_bf16 v[88:91], a[168:171], a[8:11], v[88:91]
  ds_read_b64_tr_b16 a[188:189], v151 offset:24576
  s_min_u32 s98, s98, s100
  s_sub_u32 s53, s51, s98
  s_sub_u32 s51, s53, 1
  v_sub_u32 v137, s51, v128
  v_mfma_f32_16x16x32_bf16 v[88:91], a[172:175], a[24:27], v[88:91]
  s_barrier
  v_sub_u32 v138, s51, v129
  v_min_u32 v136, v137, v138
  v_mfma_f32_16x16x32_bf16 v[92:95], a[172:175], a[28:31], v[92:95]
  ds_read_b64_tr_b16 a[190:191], v151 offset:25600
  v_sub_u32 v139, s51, v130
  v_mfma_f32_16x16x32_bf16 v[92:95], a[168:171], a[12:15], v[92:95]
  s_waitcnt lgkmcnt(4)
  v_sub_u32 v140, s51, v131
  v_min3_u32 v136, v136, v139, v140
  v_mfma_f32_16x16x32_bf16 v[96:99], a[176:179], a[0:3], v[96:99]
  ds_read_b64_tr_b16 a[160:161], v144 offset:0
  v_sub_u32 v137, s51, v132
  v_mfma_f32_16x16x32_bf16 v[96:99], a[180:183], a[16:19], v[96:99]
  buffer_load_dwordx4 a[120:123], v243, s[24:27], s30 offen offset:2048 sc1
  v_mfma_f32_16x16x32_bf16 v[100:103], a[180:183], a[20:23], v[100:103]
  ds_read_b64_tr_b16 a[162:163], v144 offset:1024
  v_sub_u32 v138, s51, v133
  v_mfma_f32_16x16x32_bf16 v[100:103], a[176:179], a[4:7], v[100:103]
  v_min3_u32 v136, v136, v137, v138
  v_sub_u32 v139, s51, v134
  v_mfma_f32_16x16x32_bf16 v[104:107], a[176:179], a[8:11], v[104:107]
  ds_read_b64_tr_b16 a[164:165], v144 offset:8192
  v_sub_u32 v140, s51, v135
  v_mfma_f32_16x16x32_bf16 v[104:107], a[180:183], a[24:27], v[104:107]
  buffer_load_dwordx4 v241, s[20:23], s31 offen offset:3072 lds
  s_add_u32 s31, s31, 0x80000
  v_mfma_f32_16x16x32_bf16 v[108:111], a[180:183], a[28:31], v[108:111]
  ds_read_b64_tr_b16 a[166:167], v144 offset:9216
  v_min3_u32 v136, v136, v139, v140
  v_mfma_f32_16x16x32_bf16 v[108:111], a[176:179], a[12:15], v[108:111]
  s_waitcnt lgkmcnt(4)
  v_min_u32_dpp v136, v136, v136 row_ror:8 row_mask:0xf bank_mask:0xf
  v_mfma_f32_16x16x32_bf16 v[112:115], a[184:187], a[0:3], v[112:115]
  ds_read_b64_tr_b16 a[168:169], v145 offset:0
  v_min_u32_dpp v136, v136, v136 row_ror:4 row_mask:0xf bank_mask:0xf
  v_mfma_f32_16x16x32_bf16 v[112:115], a[188:191], a[16:19], v[112:115]
  buffer_load_dwordx4 a[124:127], v243, s[24:27], s30 offen offset:3072 sc1
  s_add_u32 s30, s30, 8192
  v_mfma_f32_16x16x32_bf16 v[116:119], a[188:191], a[20:23], v[116:119]
  ds_read_b64_tr_b16 a[170:171], v145 offset:1024
  v_min_u32_dpp v136, v136, v136 row_ror:2 row_mask:0xf bank_mask:0xf
  v_mfma_f32_16x16x32_bf16 v[116:119], a[184:187], a[4:7], v[116:119]
  v_mfma_f32_16x16x32_bf16 v[120:123], a[184:187], a[8:11], v[120:123]
  ds_read_b64_tr_b16 a[172:173], v145 offset:8192
  v_min_u32_dpp v136, v136, v136 row_ror:1 row_mask:0xf bank_mask:0xf
  v_mfma_f32_16x16x32_bf16 v[120:123], a[188:191], a[24:27], v[120:123]
  v_readlane_b32 s98, v136, 0
  v_readlane_b32 s99, v136, 16
  v_mfma_f32_16x16x32_bf16 v[124:127], a[188:191], a[28:31], v[124:127]
  ds_read_b64_tr_b16 a[174:175], v145 offset:9216
  v_readlane_b32 s100, v136, 32
  v_mfma_f32_16x16x32_bf16 v[124:127], a[184:187], a[12:15], v[124:127]
  s_waitcnt vmcnt(24) lgkmcnt(4)
  v_readlane_b32 s101, v136, 48
  v_mfma_f32_16x16x32_bf16 v[0:3], a[160:163], a[32:35], v[0:3]
  ds_read_b64_tr_b16 a[176:177], v146 offset:0
  s_min_u32 s98, s98, s99
  s_min_u32 s100, s100, s101
  s_min_u32 s98, s98, s100
  v_mfma_f32_16x16x32_bf16 v[0:3], a[164:167], a[48:51], v[0:3]
  buffer_load_dwordx4 a[0:3], v242, s[24:27], s30 offen offset:0 sc1
  s_sub_u32 s54, s51, s98
  s_sub_u32 s51, s54, 1
  v_mfma_f32_16x16x32_bf16 v[4:7], a[164:167], a[52:55], v[4:7]
  ds_read_b64_tr_b16 a[178:179], v146 offset:1024
  v_sub_u32 v137, s51, v128
  v_mfma_f32_16x16x32_bf16 v[4:7], a[160:163], a[36:39], v[4:7]
  v_sub_u32 v138, s51, v129
  v_min_u32 v136, v137, v138
  v_mfma_f32_16x16x32_bf16 v[8:11], a[160:163], a[40:43], v[8:11]
  ds_read_b64_tr_b16 a[180:181], v146 offset:8192
  s_add_u32 m0, s28, 98304
  v_sub_u32 v139, s51, v130
  v_mfma_f32_16x16x32_bf16 v[8:11], a[164:167], a[56:59], v[8:11]
  buffer_load_dwordx4 v238, s[20:23], s31 offen offset:0 lds
  v_mfma_f32_16x16x32_bf16 v[12:15], a[164:167], a[60:63], v[12:15]
  ds_read_b64_tr_b16 a[182:183], v146 offset:9216
  v_sub_u32 v140, s51, v131
  v_mfma_f32_16x16x32_bf16 v[12:15], a[160:163], a[44:47], v[12:15]
  s_waitcnt lgkmcnt(4)
  v_min3_u32 v136, v136, v139, v140
  v_sub_u32 v137, s51, v132
  v_mfma_f32_16x16x32_bf16 v[16:19], a[168:171], a[32:35], v[16:19]
  ds_read_b64_tr_b16 a[184:185], v147 offset:0
  v_sub_u32 v138, s51, v133
  v_mfma_f32_16x16x32_bf16 v[16:19], a[172:175], a[48:51], v[16:19]
  buffer_load_dwordx4 a[4:7], v242, s[24:27], s30 offen offset:1024 sc1
  v_mfma_f32_16x16x32_bf16 v[20:23], a[172:175], a[52:55], v[20:23]
  ds_read_b64_tr_b16 a[186:187], v147 offset:1024
  v_min3_u32 v136, v136, v137, v138
  v_mfma_f32_16x16x32_bf16 v[20:23], a[168:171], a[36:39], v[20:23]
  v_sub_u32 v139, s51, v134
  v_sub_u32 v140, s51, v135
  v_mfma_f32_16x16x32_bf16 v[24:27], a[168:171], a[40:43], v[24:27]
  ds_read_b64_tr_b16 a[188:189], v147 offset:8192
  v_min3_u32 v136, v136, v139, v140
  v_mfma_f32_16x16x32_bf16 v[24:27], a[172:175], a[56:59], v[24:27]
  v_mfma_f32_16x16x32_bf16 v[28:31], a[172:175], a[60:63], v[28:31]
  ds_read_b64_tr_b16 a[190:191], v147 offset:9216
  v_min_u32_dpp v136, v136, v136 row_ror:8 row_mask:0xf bank_mask:0xf
  v_mfma_f32_16x16x32_bf16 v[28:31], a[168:171], a[44:47], v[28:31]
  s_waitcnt lgkmcnt(4)
  v_min_u32_dpp v136, v136, v136 row_ror:4 row_mask:0xf bank_mask:0xf
  v_mfma_f32_16x16x32_bf16 v[32:35], a[176:179], a[32:35], v[32:35]
  ds_read_b64_tr_b16 a[160:161], v148 offset:0
  v_min_u32_dpp v136, v136, v136 row_ror:2 row_mask:0xf bank_mask:0xf
  v_mfma_f32_16x16x32_bf16 v[32:35], a[180:183], a[48:51], v[32:35]
  buffer_load_dwordx4 a[8:11], v242, s[24:27], s30 offen offset:2048 sc1
  v_mfma_f32_16x16x32_bf16 v[36:39], a[180:183], a[52:55], v[36:39]
  ds_read_b64_tr_b16 a[162:163], v148 offset:1024
  v_min_u32_dpp v136, v136, v136 row_ror:1 row_mask:0xf bank_mask:0xf
  v_mfma_f32_16x16x32_bf16 v[36:39], a[176:179], a[36:39], v[36:39]
  v_readlane_b32 s98, v136, 0
  v_readlane_b32 s99, v136, 16
  v_mfma_f32_16x16x32_bf16 v[40:43], a[176:179], a[40:43], v[40:43]
  ds_read_b64_tr_b16 a[164:165], v148 offset:8192
  v_readlane_b32 s100, v136, 32
  v_mfma_f32_16x16x32_bf16 v[40:43], a[180:183], a[56:59], v[40:43]
  buffer_load_dwordx4 v239, s[20:23], s31 offen offset:1024 lds
  v_mfma_f32_16x16x32_bf16 v[44:47], a[180:183], a[60:63], v[44:47]
  ds_read_b64_tr_b16 a[166:167], v148 offset:9216
  v_readlane_b32 s101, v136, 48
  v_mfma_f32_16x16x32_bf16 v[44:47], a[176:179], a[44:47], v[44:47]
  s_waitcnt lgkmcnt(4)
  s_min_u32 s98, s98, s99
  s_min_u32 s100, s100, s101
  v_mfma_f32_16x16x32_bf16 v[48:51], a[184:187], a[32:35], v[48:51]
  ds_read_b64_tr_b16 a[168:169], v149 offset:0
  s_min_u32 s98, s98, s100
  s_sub_u32 s55, s51, s98
  s_sub_u32 s51, s55, 1
  v_sub_u32 v137, s51, v128
  v_mfma_f32_16x16x32_bf16 v[48:51], a[188:191], a[48:51], v[48:51]
  buffer_load_dwordx4 a[12:15], v242, s[24:27], s30 offen offset:3072 sc1
  v_mfma_f32_16x16x32_bf16 v[52:55], a[188:191], a[52:55], v[52:55]
  ds_read_b64_tr_b16 a[170:171], v149 offset:1024
  v_sub_u32 v138, s51, v129
  v_mfma_f32_16x16x32_bf16 v[52:55], a[184:187], a[36:39], v[52:55]
  v_min_u32 v136, v137, v138
  v_sub_u32 v139, s51, v130
  v_mfma_f32_16x16x32_bf16 v[56:59], a[184:187], a[40:43], v[56:59]
  ds_read_b64_tr_b16 a[172:173], v149 offset:8192
  v_sub_u32 v140, s51, v131
  v_mfma_f32_16x16x32_bf16 v[56:59], a[188:191], a[56:59], v[56:59]
  v_min3_u32 v136, v136, v139, v140
  v_sub_u32 v137, s51, v132
  v_mfma_f32_16x16x32_bf16 v[60:63], a[188:191], a[60:63], v[60:63]
  ds_read_b64_tr_b16 a[174:175], v149 offset:9216
  v_sub_u32 v138, s51, v133
  v_mfma_f32_16x16x32_bf16 v[60:63], a[184:187], a[44:47], v[60:63]
  s_waitcnt lgkmcnt(4)
  v_min3_u32 v136, v136, v137, v138
  v_sub_u32 v139, s51, v134
  v_mfma_f32_16x16x32_bf16 v[64:67], a[160:163], a[32:35], v[64:67]
  ds_read_b64_tr_b16 a[176:177], v150 offset:0
  v_sub_u32 v140, s51, v135
  v_mfma_f32_16x16x32_bf16 v[64:67], a[164:167], a[48:51], v[64:67]
  buffer_load_dwordx4 a[16:19], v243, s[24:27], s30 offen offset:0 sc1
  v_mfma_f32_16x16x32_bf16 v[68:71], a[164:167], a[52:55], v[68:71]
  ds_read_b64_tr_b16 a[178:179], v150 offset:1024
  v_min3_u32 v136, v136, v139, v140
  v_mfma_f32_16x16x32_bf16 v[68:71], a[160:163], a[36:39], v[68:71]
  v_mfma_f32_16x16x32_bf16 v[72:75], a[160:163], a[40:43], v[72:75]
  ds_read_b64_tr_b16 a[180:181], v150 offset:8192
  v_min_u32_dpp v136, v136, v136 row_ror:8 row_mask:0xf bank_mask:0xf
  v_mfma_f32_16x16x32_bf16 v[72:75], a[164:167], a[56:59], v[72:75]
  buffer_load_dwordx4 v240, s[20:23], s31 offen offset:2048 lds
  v_mfma_f32_16x16x32_bf16 v[76:79], a[164:167], a[60:63], v[76:79]
  ds_read_b64_tr_b16 a[182:183], v150 offset:9216
  v_min_u32_dpp v136, v136, v136 row_ror:4 row_mask:0xf bank_mask:0xf
  v_mfma_f32_16x16x32_bf16 v[76:79], a[160:163], a[44:47], v[76:79]
  s_waitcnt lgkmcnt(4)
  v_min_u32_dpp v136, v136, v136 row_ror:2 row_mask:0xf bank_mask:0xf
  v_mfma_f32_16x16x32_bf16 v[80:83], a[168:171], a[32:35], v[80:83]
  ds_read_b64_tr_b16 a[184:185], v151 offset:0
  v_min_u32_dpp v136, v136, v136 row_ror:1 row_mask:0xf bank_mask:0xf
  v_mfma_f32_16x16x32_bf16 v[80:83], a[172:175], a[48:51], v[80:83]
  buffer_load_dwordx4 a[20:23], v243, s[24:27], s30 offen offset:1024 sc1
  v_mfma_f32_16x16x32_bf16 v[84:87], a[172:175], a[52:55], v[84:87]
  ds_read_b64_tr_b16 a[186:187], v151 offset:1024
  v_readlane_b32 s98, v136, 0
  v_mfma_f32_16x16x32_bf16 v[84:87], a[168:171], a[36:39], v[84:87]
  s_waitcnt vmcnt(22)
  v_readlane_b32 s99, v136, 16
  v_readlane_b32 s100, v136, 32
  v_mfma_f32_16x16x32_bf16 v[88:91], a[168:171], a[40:43], v[88:91]
  ds_read_b64_tr_b16 a[188:189], v151 offset:8192
  v_readlane_b32 s101, v136, 48
  v_mfma_f32_16x16x32_bf16 v[88:91], a[172:175], a[56:59], v[88:91]
  s_barrier
  s_min_u32 s98, s98, s99
  s_min_u32 s100, s100, s101
  v_mfma_f32_16x16x32_bf16 v[92:95], a[172:175], a[60:63], v[92:95]
  ds_read_b64_tr_b16 a[190:191], v151 offset:9216
  s_min_u32 s98, s98, s100
  s_sub_u32 s56, s51, s98
  s_sub_u32 s51, s56, 1
  v_sub_u32 v137, s51, v128
  v_mfma_f32_16x16x32_bf16 v[92:95], a[168:171], a[44:47], v[92:95]
  s_waitcnt lgkmcnt(4)
  v_sub_u32 v138, s51, v129
  v_min_u32 v136, v137, v138
  v_mfma_f32_16x16x32_bf16 v[96:99], a[176:179], a[32:35], v[96:99]
  ds_read_b64_tr_b16 a[160:161], v224 offset:0
  v_sub_u32 v139, s51, v130
  v_mfma_f32_16x16x32_bf16 v[96:99], a[180:183], a[48:51], v[96:99]
  buffer_load_dwordx4 a[24:27], v243, s[24:27], s30 offen offset:2048 sc1
  v_mfma_f32_16x16x32_bf16 v[100:103], a[180:183], a[52:55], v[100:103]
  ds_read_b64_tr_b16 a[162:163], v224 offset:1024
  v_sub_u32 v140, s51, v131
  v_mfma_f32_16x16x32_bf16 v[100:103], a[176:179], a[36:39], v[100:103]
  v_min3_u32 v136, v136, v139, v140
  v_sub_u32 v137, s51, v132
  v_mfma_f32_16x16x32_bf16 v[104:107], a[176:179], a[40:43], v[104:107]
  ds_read_b64_tr_b16 a[164:165], v224 offset:8192
  v_sub_u32 v138, s51, v133
  v_mfma_f32_16x16x32_bf16 v[104:107], a[180:183], a[56:59], v[104:107]
  buffer_load_dwordx4 v241, s[20:23], s31 offen offset:3072 lds
  s_add_u32 s31, s31, 0x80000
  v_mfma_f32_16x16x32_bf16 v[108:111], a[180:183], a[60:63], v[108:111]
  ds_read_b64_tr_b16 a[166:167], v224 offset:9216
  v_min3_u32 v136, v136, v137, v138
  v_mfma_f32_16x16x32_bf16 v[108:111], a[176:179], a[44:47], v[108:111]
  s_waitcnt lgkmcnt(4)
  v_sub_u32 v139, s51, v134
  v_sub_u32 v140, s51, v135
  v_mfma_f32_16x16x32_bf16 v[112:115], a[184:187], a[32:35], v[112:115]
  ds_read_b64_tr_b16 a[168:169], v225 offset:0
  v_min3_u32 v136, v136, v139, v140
  v_mfma_f32_16x16x32_bf16 v[112:115], a[188:191], a[48:51], v[112:115]
  buffer_load_dwordx4 a[28:31], v243, s[24:27], s30 offen offset:3072 sc1
  s_add_u32 s30, s30, 8192
  v_mfma_f32_16x16x32_bf16 v[116:119], a[188:191], a[52:55], v[116:119]
  ds_read_b64_tr_b16 a[170:171], v225 offset:1024
  v_min_u32_dpp v136, v136, v136 row_ror:8 row_mask:0xf bank_mask:0xf
  v_mfma_f32_16x16x32_bf16 v[116:119], a[184:187], a[36:39], v[116:119]
  v_mfma_f32_16x16x32_bf16 v[120:123], a[184:187], a[40:43], v[120:123]
  ds_read_b64_tr_b16 a[172:173], v225 offset:8192
  v_min_u32_dpp v136, v136, v136 row_ror:4 row_mask:0xf bank_mask:0xf
  v_mfma_f32_16x16x32_bf16 v[120:123], a[188:191], a[56:59], v[120:123]
  v_mfma_f32_16x16x32_bf16 v[124:127], a[188:191], a[60:63], v[124:127]
  ds_read_b64_tr_b16 a[174:175], v225 offset:9216
  v_min_u32_dpp v136, v136, v136 row_ror:2 row_mask:0xf bank_mask:0xf
  v_mfma_f32_16x16x32_bf16 v[124:127], a[184:187], a[44:47], v[124:127]
  s_waitcnt vmcnt(24) lgkmcnt(4)
  v_min_u32_dpp v136, v136, v136 row_ror:1 row_mask:0xf bank_mask:0xf
  v_mfma_f32_16x16x32_bf16 v[0:3], a[160:163], a[64:67], v[0:3]
  ds_read_b64_tr_b16 a[176:177], v226 offset:0
  v_readlane_b32 s98, v136, 0
  v_mfma_f32_16x16x32_bf16 v[0:3], a[164:167], a[80:83], v[0:3]
  buffer_load_dwordx4 a[32:35], v242, s[24:27], s30 offen offset:0 sc1
  v_mfma_f32_16x16x32_bf16 v[4:7], a[164:167], a[84:87], v[4:7]
  ds_read_b64_tr_b16 a[178:179], v226 offset:1024
  v_readlane_b32 s99, v136, 16
  v_mfma_f32_16x16x32_bf16 v[4:7], a[160:163], a[68:71], v[4:7]
  v_readlane_b32 s100, v136, 32
  v_readlane_b32 s101, v136, 48
  v_mfma_f32_16x16x32_bf16 v[8:11], a[160:163], a[72:75], v[8:11]
  ds_read_b64_tr_b16 a[180:181], v226 offset:8192
  s_add_u32 m0, s28, 114688
  s_min_u32 s98, s98, s99
  s_min_u32 s100, s100, s101
  v_mfma_f32_16x16x32_bf16 v[8:11], a[164:167], a[88:91], v[8:11]
  buffer_load_dwordx4 v238, s[20:23], s31 offen offset:0 lds
  s_min_u32 s98, s98, s100
  s_sub_u32 s57, s51, s98
  s_sub_u32 s51, s57, 1
  v_mfma_f32_16x16x32_bf16 v[12:15], a[164:167], a[92:95], v[12:15]
  ds_read_b64_tr_b16 a[182:183], v226 offset:9216
  v_sub_u32 v137, s51, v128
  v_mfma_f32_16x16x32_bf16 v[12:15], a[160:163], a[76:79], v[12:15]
  s_waitcnt lgkmcnt(4)
  v_sub_u32 v138, s51, v129
  v_min_u32 v136, v137, v138
  v_mfma_f32_16x16x32_bf16 v[16:19], a[168:171], a[64:67], v[16:19]
  ds_read_b64_tr_b16 a[184:185], v227 offset:0
  v_sub_u32 v139, s51, v130
  v_mfma_f32_16x16x32_bf16 v[16:19], a[172:175], a[80:83], v[16:19]
  buffer_load_dwordx4 a[36:39], v242, s[24:27], s30 offen offset:1024 sc1
  v_mfma_f32_16x16x32_bf16 v[20:23], a[172:175], a[84:87], v[20:23]
  ds_read_b64_tr_b16 a[186:187], v227 offset:1024
  v_sub_u32 v140, s51, v131
  v_mfma_f32_16x16x32_bf16 v[20:23], a[168:171], a[68:71], v[20:23]
  v_min3_u32 v136, v136, v139, v140
  v_sub_u32 v137, s51, v132
  v_mfma_f32_16x16x32_bf16 v[24:27], a[168:171], a[72:75], v[24:27]
  ds_read_b64_tr_b16 a[188:189], v227 offset:8192
  v_sub_u32 v138, s51, v133
  v_mfma_f32_16x16x32_bf16 v[24:27], a[172:175], a[88:91], v[24:27]
  v_min3_u32 v136, v136, v137, v138
  v_sub_u32 v139, s51, v134
  v_mfma_f32_16x16x32_bf16 v[28:31], a[172:175], a[92:95], v[28:31]
  ds_read_b64_tr_b16 a[190:191], v227 offset:9216
  v_sub_u32 v140, s51, v135
  v_mfma_f32_16x16x32_bf16 v[28:31], a[168:171], a[76:79], v[28:31]
  s_waitcnt lgkmcnt(4)
  v_min3_u32 v136, v136, v139, v140
  v_mfma_f32_16x16x32_bf16 v[32:35], a[176:179], a[64:67], v[32:35]
  ds_read_b64_tr_b16 a[160:161], v228 offset:0
  v_min_u32_dpp v136, v136, v136 row_ror:8 row_mask:0xf bank_mask:0xf
  v_mfma_f32_16x16x32_bf16 v[32:35], a[180:183], a[80:83], v[32:35]
  buffer_load_dwordx4 a[40:43], v242, s[24:27], s30 offen offset:2048 sc1
  v_mfma_f32_16x16x32_bf16 v[36:39], a[180:183], a[84:87], v[36:39]
  ds_read_b64_tr_b16 a[162:163], v228 offset:1024
  v_min_u32_dpp v136, v136, v136 row_ror:4 row_mask:0xf bank_mask:0xf
  v_mfma_f32_16x16x32_bf16 v[36:39], a[176:179], a[68:71], v[36:39]
  v_mfma_f32_16x16x32_bf16 v[40:43], a[176:179], a[72:75], v[40:43]
  ds_read_b64_tr_b16 a[164:165], v228 offset:8192
  v_min_u32_dpp v136, v136, v136 row_ror:2 row_mask:0xf bank_mask:0xf
  v_mfma_f32_16x16x32_bf16 v[40:43], a[180:183], a[88:91], v[40:43]
  buffer_load_dwordx4 v239, s[20:23], s31 offen offset:1024 lds
  v_mfma_f32_16x16x32_bf16 v[44:47], a[180:183], a[92:95], v[44:47]
  ds_read_b64_tr_b16 a[166:167], v228 offset:9216
  v_min_u32_dpp v136, v136, v136 row_ror:1 row_mask:0xf bank_mask:0xf
  v_mfma_f32_16x16x32_bf16 v[44:47], a[176:179], a[76:79], v[44:47]
  s_waitcnt lgkmcnt(4)
  v_readlane_b32 s98, v136, 0
  v_readlane_b32 s99, v136, 16
  v_mfma_f32_16x16x32_bf16 v[48:51], a[184:187], a[64:67], v[48:51]
  ds_read_b64_tr_b16 a[168:169], v229 offset:0
  v_readlane_b32 s100, v136, 32
  v_mfma_f32_16x16x32_bf16 v[48:51], a[188:191], a[80:83], v[48:51]
  buffer_load_dwordx4 a[44:47], v242, s[24:27], s30 offen offset:3072 sc1
  v_mfma_f32_16x16x32_bf16 v[52:55], a[188:191], a[84:87], v[52:55]
  ds_read_b64_tr_b16 a[170:171], v229 offset:1024
  v_readlane_b32 s101, v136, 48
  v_mfma_f32_16x16x32_bf16 v[52:55], a[184:187], a[68:71], v[52:55]
  s_min_u32 s98, s98, s99
  s_min_u32 s100, s100, s101
  s_min_u32 s98, s98, s100
  v_mfma_f32_16x16x32_bf16 v[56:59], a[184:187], a[72:75], v[56:59]
  ds_read_b64_tr_b16 a[172:173], v229 offset:8192
  s_sub_u32 s58, s51, s98
  s_sub_u32 s51, s58, 1
  v_sub_u32 v137, s51, v128
  v_mfma_f32_16x16x32_bf16 v[56:59], a[188:191], a[88:91], v[56:59]
  v_sub_u32 v138, s51, v129
  v_min_u32 v136, v137, v138
  v_mfma_f32_16x16x32_bf16 v[60:63], a[188:191], a[92:95], v[60:63]
  ds_read_b64_tr_b16 a[174:175], v229 offset:9216
  v_sub_u32 v139, s51, v130
  v_mfma_f32_16x16x32_bf16 v[60:63], a[184:187], a[76:79], v[60:63]
  s_waitcnt lgkmcnt(4)
  v_sub_u32 v140, s51, v131
  v_min3_u32 v136, v136, v139, v140
  v_mfma_f32_16x16x32_bf16 v[64:67], a[160:163], a[64:67], v[64:67]
  ds_read_b64_tr_b16 a[176:177], v230 offset:0
  v_sub_u32 v137, s51, v132
  v_mfma_f32_16x16x32_bf16 v[64:67], a[164:167], a[80:83], v[64:67]
  buffer_load_dwordx4 a[48:51], v243, s[24:27], s30 offen offset:0 sc1
  v_mfma_f32_16x16x32_bf16 v[68:71], a[164:167], a[84:87], v[68:71]
  ds_read_b64_tr_b16 a[178:179], v230 offset:1024
  v_sub_u32 v138, s51, v133
  v_mfma_f32_16x16x32_bf16 v[68:71], a[160:163], a[68:71], v[68:71]
  v_min3_u32 v136, v136, v137, v138
  v_sub_u32 v139, s51, v134
  v_mfma_f32_16x16x32_bf16 v[72:75], a[160:163], a[72:75], v[72:75]
  ds_read_b64_tr_b16 a[180:181], v230 offset:8192
  v_sub_u32 v140, s51, v135
  v_mfma_f32_16x16x32_bf16 v[72:75], a[164:167], a[88:91], v[72:75]
  buffer_load_dwordx4 v240, s[20:23], s31 offen offset:2048 lds
  v_mfma_f32_16x16x32_bf16 v[76:79], a[164:167], a[92:95], v[76:79]
  ds_read_b64_tr_b16 a[182:183], v230 offset:9216
  v_min3_u32 v136, v136, v139, v140
  v_mfma_f32_16x16x32_bf16 v[76:79], a[160:163], a[76:79], v[76:79]
  s_waitcnt lgkmcnt(4)
  v_min_u32_dpp v136, v136, v136 row_ror:8 row_mask:0xf bank_mask:0xf
  v_mfma_f32_16x16x32_bf16 v[80:83], a[168:171], a[64:67], v[80:83]
  ds_read_b64_tr_b16 a[184:185], v231 offset:0
  v_min_u32_dpp v136, v136, v136 row_ror:4 row_mask:0xf bank_mask:0xf
  v_mfma_f32_16x16x32_bf16 v[80:83], a[172:175], a[80:83], v[80:83]
  buffer_load_dwordx4 a[52:55], v243, s[24:27], s30 offen offset:1024 sc1
  v_mfma_f32_16x16x32_bf16 v[84:87], a[172:175], a[84:87], v[84:87]
  ds_read_b64_tr_b16 a[186:187], v231 offset:1024
  v_min_u32_dpp v136, v136, v136 row_ror:2 row_mask:0xf bank_mask:0xf
  v_mfma_f32_16x16x32_bf16 v[84:87], a[168:171], a[68:71], v[84:87]
  s_waitcnt vmcnt(22)
  v_min_u32_dpp v136, v136, v136 row_ror:1 row_mask:0xf bank_mask:0xf
  v_mfma_f32_16x16x32_bf16 v[88:91], a[168:171], a[72:75], v[88:91]
  ds_read_b64_tr_b16 a[188:189], v231 offset:8192
  v_readlane_b32 s98, v136, 0
  v_readlane_b32 s99, v136, 16
  v_readlane_b32 s100, v136, 32
  v_readlane_b32 s101, v136, 48
  s_min_u32 s98, s98, s99
  s_min_u32 s100, s100, s101
  s_min_u32 s98, s98, s100
  s_sub_u32 s59, s51, s98
  s_sub_u32 s51, s59, 1
  v_writelane_b32 v136, s52, 0
  v_writelane_b32 v136, s53, 1
  v_writelane_b32 v136, s54, 2
  v_writelane_b32 v136, s55, 3
  v_writelane_b32 v136, s56, 4
  v_writelane_b32 v136, s57, 5
  v_writelane_b32 v136, s58, 6
  v_writelane_b32 v136, s59, 7
  s_lshl_b32 s35, s3, 8
  s_add_u32 s35, s35, 158720
  v_lshrrev_b32 v137, 2, v242
  v_add_u32 v137, s35, v137
  ds_write_b32 v137, v136
  s_waitcnt lgkmcnt(0)
  v_mfma_f32_16x16x32_bf16 v[88:91], a[172:175], a[88:91], v[88:91]
  s_barrier
  v_mfma_f32_16x16x32_bf16 v[92:95], a[172:175], a[92:95], v[92:95]
  ds_read_b64_tr_b16 a[190:191], v231 offset:9216
  v_mfma_f32_16x16x32_bf16 v[92:95], a[168:171], a[76:79], v[92:95]
  v_mfma_f32_16x16x32_bf16 v[96:99], a[176:179], a[64:67], v[96:99]
  ds_read_b64_tr_b16 a[160:161], v224 offset:16384
  v_mfma_f32_16x16x32_bf16 v[96:99], a[180:183], a[80:83], v[96:99]
  buffer_load_dwordx4 a[56:59], v243, s[24:27], s30 offen offset:2048 sc1
  v_mfma_f32_16x16x32_bf16 v[100:103], a[180:183], a[84:87], v[100:103]
  ds_read_b64_tr_b16 a[162:163], v224 offset:17408
  v_mfma_f32_16x16x32_bf16 v[100:103], a[176:179], a[68:71], v[100:103]
  v_mfma_f32_16x16x32_bf16 v[104:107], a[176:179], a[72:75], v[104:107]
  ds_read_b64_tr_b16 a[164:165], v224 offset:24576
  v_mfma_f32_16x16x32_bf16 v[104:107], a[180:183], a[88:91], v[104:107]
  buffer_load_dwordx4 v241, s[20:23], s31 offen offset:3072 lds
  s_add_u32 s31, s31, 0x80000
  v_mfma_f32_16x16x32_bf16 v[108:111], a[180:183], a[92:95], v[108:111]
  ds_read_b64_tr_b16 a[166:167], v224 offset:25600
  v_mfma_f32_16x16x32_bf16 v[108:111], a[176:179], a[76:79], v[108:111]
  s_waitcnt lgkmcnt(4)
  v_mfma_f32_16x16x32_bf16 v[112:115], a[184:187], a[64:67], v[112:115]
  ds_read_b64_tr_b16 a[168:169], v225 offset:16384
  v_mfma_f32_16x16x32_bf16 v[112:115], a[188:191], a[80:83], v[112:115]
  buffer_load_dwordx4 a[60:63], v243, s[24:27], s30 offen offset:3072 sc1
  s_add_u32 s30, s30, 8192
  v_mfma_f32_16x16x32_bf16 v[116:119], a[188:191], a[84:87], v[116:119]
  ds_read_b64_tr_b16 a[170:171], v225 offset:17408
  v_mfma_f32_16x16x32_bf16 v[116:119], a[184:187], a[68:71], v[116:119]
  v_mfma_f32_16x16x32_bf16 v[120:123], a[184:187], a[72:75], v[120:123]
  ds_read_b64_tr_b16 a[172:173], v225 offset:24576
  v_mfma_f32_16x16x32_bf16 v[120:123], a[188:191], a[88:91], v[120:123]
  v_mfma_f32_16x16x32_bf16 v[124:127], a[188:191], a[92:95], v[124:127]
  ds_read_b64_tr_b16 a[174:175], v225 offset:25600
  v_mfma_f32_16x16x32_bf16 v[124:127], a[184:187], a[76:79], v[124:127]
  s_waitcnt vmcnt(24) lgkmcnt(4)
  v_mfma_f32_16x16x32_bf16 v[0:3], a[160:163], a[96:99], v[0:3]
  ds_read_b64_tr_b16 a[176:177], v226 offset:16384
  v_lshrrev_b32 v136, 4, v242
  v_mfma_f32_16x16x32_bf16 v[0:3], a[164:167], a[112:115], v[0:3]
  v_bfe_u32 v137, v136, 3, 2
  v_and_b32 v138, 7, v136
  v_mfma_f32_16x16x32_bf16 v[4:7], a[164:167], a[116:119], v[4:7]
  ds_read_b64_tr_b16 a[178:179], v226 offset:17408
  v_lshlrev_b32 v137, 8, v137
  v_mfma_f32_16x16x32_bf16 v[4:7], a[160:163], a[100:103], v[4:7]
  v_lshl_add_u32 v137, v138, 2, v137
  v_add_u32 v137, 158720, v137
  v_mfma_f32_16x16x32_bf16 v[8:11], a[160:163], a[104:107], v[8:11]
  ds_read_b64_tr_b16 a[180:181], v226 offset:24576
  s_add_u32 m0, s28, 0
  ds_read_b32 v128, v137
  v_mfma_f32_16x16x32_bf16 v[8:11], a[164:167], a[120:123], v[8:11]
  buffer_load_dwordx4 v232, s[12:15], s29 offen offset:0 lds
  v_mfma_f32_16x16x32_bf16 v[12:15], a[164:167], a[124:127], v[12:15]
  ds_read_b64_tr_b16 a[182:183], v226 offset:25600
  v_mfma_f32_16x16x32_bf16 v[12:15], a[160:163], a[108:111], v[12:15]
  s_waitcnt lgkmcnt(5)
  v_mfma_f32_16x16x32_bf16 v[16:19], a[168:171], a[96:99], v[16:19]
  ds_read_b64_tr_b16 a[184:185], v227 offset:16384
  v_mfma_f32_16x16x32_bf16 v[16:19], a[172:175], a[112:115], v[16:19]
  v_mfma_f32_16x16x32_bf16 v[20:23], a[172:175], a[116:119], v[20:23]
  ds_read_b64_tr_b16 a[186:187], v227 offset:17408
  v_mfma_f32_16x16x32_bf16 v[20:23], a[168:171], a[100:103], v[20:23]
  v_mfma_f32_16x16x32_bf16 v[24:27], a[168:171], a[104:107], v[24:27]
  ds_read_b64_tr_b16 a[188:189], v227 offset:24576
  s_waitcnt lgkmcnt(4)
  s_mov_b32 s51, -1
  v_sub_u32 v137, s51, v128
  v_mfma_f32_16x16x32_bf16 v[24:27], a[172:175], a[120:123], v[24:27]
  v_mfma_f32_16x16x32_bf16 v[28:31], a[172:175], a[124:127], v[28:31]
  ds_read_b64_tr_b16 a[190:191], v227 offset:25600
  v_min_u32_dpp v137, v137, v137 row_ror:8 row_mask:0xf bank_mask:0xf
  v_mfma_f32_16x16x32_bf16 v[28:31], a[168:171], a[108:111], v[28:31]
  s_waitcnt lgkmcnt(4)
  v_min_u32_dpp v137, v137, v137 row_ror:4 row_mask:0xf bank_mask:0xf
  v_mfma_f32_16x16x32_bf16 v[32:35], a[176:179], a[96:99], v[32:35]
  ds_read_b64_tr_b16 a[160:161], v228 offset:16384
  v_min_u32_dpp v137, v137, v137 row_ror:2 row_mask:0xf bank_mask:0xf
  v_mfma_f32_16x16x32_bf16 v[32:35], a[180:183], a[112:115], v[32:35]
  v_mfma_f32_16x16x32_bf16 v[36:39], a[180:183], a[116:119], v[36:39]
  ds_read_b64_tr_b16 a[162:163], v228 offset:17408
  v_min_u32_dpp v137, v137, v137 row_ror:1 row_mask:0xf bank_mask:0xf
  v_mfma_f32_16x16x32_bf16 v[36:39], a[176:179], a[100:103], v[36:39]
  v_readlane_b32 s98, v137, 0
  v_readlane_b32 s99, v137, 16
  v_mfma_f32_16x16x32_bf16 v[40:43], a[176:179], a[104:107], v[40:43]
  ds_read_b64_tr_b16 a[164:165], v228 offset:24576
  s_min_u32 s98, s98, s99
  s_sub_u32 s52, s51, s98
  s_sub_u32 s51, s52, 1
  v_sub_u32 v137, s51, v128
  v_mfma_f32_16x16x32_bf16 v[40:43], a[180:183], a[120:123], v[40:43]
  buffer_load_dwordx4 v233, s[12:15], s29 offen offset:1024 lds
  v_mfma_f32_16x16x32_bf16 v[44:47], a[180:183], a[124:127], v[44:47]
  ds_read_b64_tr_b16 a[166:167], v228 offset:25600
  v_min_u32_dpp v137, v137, v137 row_ror:8 row_mask:0xf bank_mask:0xf
  v_mfma_f32_16x16x32_bf16 v[44:47], a[176:179], a[108:111], v[44:47]
  s_waitcnt lgkmcnt(4)
  v_min_u32_dpp v137, v137, v137 row_ror:4 row_mask:0xf bank_mask:0xf
  v_mfma_f32_16x16x32_bf16 v[48:51], a[184:187], a[96:99], v[48:51]
  ds_read_b64_tr_b16 a[168:169], v229 offset:16384
  v_min_u32_dpp v137, v137, v137 row_ror:2 row_mask:0xf bank_mask:0xf
  v_mfma_f32_16x16x32_bf16 v[48:51], a[188:191], a[112:115], v[48:51]
  v_mfma_f32_16x16x32_bf16 v[52:55], a[188:191], a[116:119], v[52:55]
  ds_read_b64_tr_b16 a[170:171], v229 offset:17408
  v_min_u32_dpp v137, v137, v137 row_ror:1 row_mask:0xf bank_mask:0xf
  v_mfma_f32_16x16x32_bf16 v[52:55], a[184:187], a[100:103], v[52:55]
  v_readlane_b32 s98, v137, 0
  v_readlane_b32 s99, v137, 16
  v_mfma_f32_16x16x32_bf16 v[56:59], a[184:187], a[104:107], v[56:59]
  ds_read_b64_tr_b16 a[172:173], v229 offset:24576
  s_min_u32 s98, s98, s99
  s_sub_u32 s53, s51, s98
  s_sub_u32 s51, s53, 1
  v_sub_u32 v137, s51, v128
  v_mfma_f32_16x16x32_bf16 v[56:59], a[188:191], a[120:123], v[56:59]
  v_mfma_f32_16x16x32_bf16 v[60:63], a[188:191], a[124:127], v[60:63]
  ds_read_b64_tr_b16 a[174:175], v229 offset:25600
  v_min_u32_dpp v137, v137, v137 row_ror:8 row_mask:0xf bank_mask:0xf
  v_mfma_f32_16x16x32_bf16 v[60:63], a[184:187], a[108:111], v[60:63]
  s_waitcnt lgkmcnt(4)
  v_min_u32_dpp v137, v137, v137 row_ror:4 row_mask:0xf bank_mask:0xf
  v_mfma_f32_16x16x32_bf16 v[64:67], a[160:163], a[96:99], v[64:67]
  ds_read_b64_tr_b16 a[176:177], v230 offset:16384
  v_min_u32_dpp v137, v137, v137 row_ror:2 row_mask:0xf bank_mask:0xf
  v_mfma_f32_16x16x32_bf16 v[64:67], a[164:167], a[112:115], v[64:67]
  v_mfma_f32_16x16x32_bf16 v[68:71], a[164:167], a[116:119], v[68:71]
  ds_read_b64_tr_b16 a[178:179], v230 offset:17408
  v_min_u32_dpp v137, v137, v137 row_ror:1 row_mask:0xf bank_mask:0xf
  v_mfma_f32_16x16x32_bf16 v[68:71], a[160:163], a[100:103], v[68:71]
  v_readlane_b32 s98, v137, 0
  v_readlane_b32 s99, v137, 16
  v_mfma_f32_16x16x32_bf16 v[72:75], a[160:163], a[104:107], v[72:75]
  ds_read_b64_tr_b16 a[180:181], v230 offset:24576
  s_min_u32 s98, s98, s99
  s_sub_u32 s54, s51, s98
  s_sub_u32 s51, s54, 1
  v_sub_u32 v137, s51, v128
  v_mfma_f32_16x16x32_bf16 v[72:75], a[164:167], a[120:123], v[72:75]
  buffer_load_dwordx4 v234, s[12:15], s29 offen offset:2048 lds
  v_mfma_f32_16x16x32_bf16 v[76:79], a[164:167], a[124:127], v[76:79]
  ds_read_b64_tr_b16 a[182:183], v230 offset:25600
  v_min_u32_dpp v137, v137, v137 row_ror:8 row_mask:0xf bank_mask:0xf
  v_mfma_f32_16x16x32_bf16 v[76:79], a[160:163], a[108:111], v[76:79]
  s_waitcnt lgkmcnt(4)
  v_min_u32_dpp v137, v137, v137 row_ror:4 row_mask:0xf bank_mask:0xf
  v_mfma_f32_16x16x32_bf16 v[80:83], a[168:171], a[96:99], v[80:83]
  ds_read_b64_tr_b16 a[184:185], v231 offset:16384
  v_min_u32_dpp v137, v137, v137 row_ror:2 row_mask:0xf bank_mask:0xf
  v_mfma_f32_16x16x32_bf16 v[80:83], a[172:175], a[112:115], v[80:83]
  v_mfma_f32_16x16x32_bf16 v[84:87], a[172:175], a[116:119], v[84:87]
  ds_read_b64_tr_b16 a[186:187], v231 offset:17408
  v_min_u32_dpp v137, v137, v137 row_ror:1 row_mask:0xf bank_mask:0xf
  v_mfma_f32_16x16x32_bf16 v[84:87], a[168:171], a[100:103], v[84:87]
  s_waitcnt vmcnt(16)
  v_readlane_b32 s98, v137, 0
  v_readlane_b32 s99, v137, 16
  v_mfma_f32_16x16x32_bf16 v[88:91], a[168:171], a[104:107], v[88:91]
  ds_read_b64_tr_b16 a[188:189], v231 offset:24576
  s_min_u32 s98, s98, s99
  s_sub_u32 s55, s51, s98
  s_sub_u32 s51, s55, 1
  v_sub_u32 v137, s51, v128
  v_mfma_f32_16x16x32_bf16 v[88:91], a[172:175], a[120:123], v[88:91]
  s_barrier
  v_min_u32_dpp v137, v137, v137 row_ror:8 row_mask:0xf bank_mask:0xf
  v_mfma_f32_16x16x32_bf16 v[92:95], a[172:175], a[124:127], v[92:95]
  ds_read_b64_tr_b16 a[190:191], v231 offset:25600
  v_min_u32_dpp v137, v137, v137 row_ror:4 row_mask:0xf bank_mask:0xf
  v_mfma_f32_16x16x32_bf16 v[92:95], a[168:171], a[108:111], v[92:95]
  s_waitcnt lgkmcnt(4)
  v_min_u32_dpp v137, v137, v137 row_ror:2 row_mask:0xf bank_mask:0xf
  v_mfma_f32_16x16x32_bf16 v[96:99], a[176:179], a[96:99], v[96:99]
  ds_read_b64_tr_b16 a[160:161], v224 offset:32768
  v_min_u32_dpp v137, v137, v137 row_ror:1 row_mask:0xf bank_mask:0xf
  v_mfma_f32_16x16x32_bf16 v[96:99], a[180:183], a[112:115], v[96:99]
  v_readlane_b32 s98, v137, 0
  v_readlane_b32 s99, v137, 16
  v_mfma_f32_16x16x32_bf16 v[100:103], a[180:183], a[116:119], v[100:103]
  ds_read_b64_tr_b16 a[162:163], v224 offset:33792
  s_min_u32 s98, s98, s99
  s_sub_u32 s56, s51, s98
  s_sub_u32 s51, s56, 1
  v_sub_u32 v137, s51, v128
  v_mfma_f32_16x16x32_bf16 v[100:103], a[176:179], a[100:103], v[100:103]
  v_mfma_f32_16x16x32_bf16 v[104:107], a[176:179], a[104:107], v[104:107]
  ds_read_b64_tr_b16 a[164:165], v224 offset:40960
  v_min_u32_dpp v137, v137, v137 row_ror:8 row_mask:0xf bank_mask:0xf
  v_mfma_f32_16x16x32_bf16 v[104:107], a[180:183], a[120:123], v[104:107]
  buffer_load_dwordx4 v235, s[12:15], s29 offen offset:3072 lds
  v_mfma_f32_16x16x32_bf16 v[108:111], a[180:183], a[124:127], v[108:111]
  ds_read_b64_tr_b16 a[166:167], v224 offset:41984
  v_min_u32_dpp v137, v137, v137 row_ror:4 row_mask:0xf bank_mask:0xf
  v_mfma_f32_16x16x32_bf16 v[108:111], a[176:179], a[108:111], v[108:111]
  s_waitcnt lgkmcnt(4)
  v_min_u32_dpp v137, v137, v137 row_ror:2 row_mask:0xf bank_mask:0xf
  v_mfma_f32_16x16x32_bf16 v[112:115], a[184:187], a[96:99], v[112:115]
  ds_read_b64_tr_b16 a[168:169], v225 offset:32768
  v_min_u32_dpp v137, v137, v137 row_ror:1 row_mask:0xf bank_mask:0xf
  v_mfma_f32_16x16x32_bf16 v[112:115], a[188:191], a[112:115], v[112:115]
  v_readlane_b32 s98, v137, 0
  v_readlane_b32 s99, v137, 16
  v_mfma_f32_16x16x32_bf16 v[116:119], a[188:191], a[116:119], v[116:119]
  ds_read_b64_tr_b16 a[170:171], v225 offset:33792
  s_min_u32 s98, s98, s99
  s_sub_u32 s57, s51, s98
  s_sub_u32 s51, s57, 1
  v_sub_u32 v137, s51, v128
  v_mfma_f32_16x16x32_bf16 v[116:119], a[184:187], a[100:103], v[116:119]
  v_mfma_f32_16x16x32_bf16 v[120:123], a[184:187], a[104:107], v[120:123]
  ds_read_b64_tr_b16 a[172:173], v225 offset:40960
  v_min_u32_dpp v137, v137, v137 row_ror:8 row_mask:0xf bank_mask:0xf
  v_mfma_f32_16x16x32_bf16 v[120:123], a[188:191], a[120:123], v[120:123]
  v_mfma_f32_16x16x32_bf16 v[124:127], a[188:191], a[124:127], v[124:127]
  ds_read_b64_tr_b16 a[174:175], v225 offset:41984
  v_min_u32_dpp v137, v137, v137 row_ror:4 row_mask:0xf bank_mask:0xf
  v_mfma_f32_16x16x32_bf16 v[124:127], a[184:187], a[108:111], v[124:127]
  s_waitcnt vmcnt(16) lgkmcnt(4)
  v_min_u32_dpp v137, v137, v137 row_ror:2 row_mask:0xf bank_mask:0xf
  v_mfma_f32_16x16x32_bf16 v[0:3], a[160:163], a[0:3], v[0:3]
  ds_read_b64_tr_b16 a[176:177], v226 offset:32768
  v_min_u32_dpp v137, v137, v137 row_ror:1 row_mask:0xf bank_mask:0xf
  v_mfma_f32_16x16x32_bf16 v[0:3], a[164:167], a[16:19], v[0:3]
  v_readlane_b32 s98, v137, 0
  v_readlane_b32 s99, v137, 16
  v_mfma_f32_16x16x32_bf16 v[4:7], a[164:167], a[20:23], v[4:7]
  ds_read_b64_tr_b16 a[178:179], v226 offset:33792
  s_min_u32 s98, s98, s99
  s_sub_u32 s58, s51, s98
  s_sub_u32 s51, s58, 1
  v_sub_u32 v137, s51, v128
  v_mfma_f32_16x16x32_bf16 v[4:7], a[160:163], a[4:7], v[4:7]
  v_mfma_f32_16x16x32_bf16 v[8:11], a[160:163], a[8:11], v[8:11]
  ds_read_b64_tr_b16 a[180:181], v226 offset:40960
  s_add_u32 m0, s28, 65536
  v_min_u32_dpp v137, v137, v137 row_ror:8 row_mask:0xf bank_mask:0xf
  v_mfma_f32_16x16x32_bf16 v[8:11], a[164:167], a[24:27], v[8:11]
  buffer_load_dwordx4 v236, s[16:19], s29 offen offset:0 lds
  v_mfma_f32_16x16x32_bf16 v[12:15], a[164:167], a[28:31], v[12:15]
  ds_read_b64_tr_b16 a[182:183], v226 offset:41984
  v_min_u32_dpp v137, v137, v137 row_ror:4 row_mask:0xf bank_mask:0xf
  v_mfma_f32_16x16x32_bf16 v[12:15], a[160:163], a[12:15], v[12:15]
  s_waitcnt lgkmcnt(4)
  v_min_u32_dpp v137, v137, v137 row_ror:2 row_mask:0xf bank_mask:0xf
  v_mfma_f32_16x16x32_bf16 v[16:19], a[168:171], a[0:3], v[16:19]
  ds_read_b64_tr_b16 a[184:185], v227 offset:32768
  v_min_u32_dpp v137, v137, v137 row_ror:1 row_mask:0xf bank_mask:0xf
  v_mfma_f32_16x16x32_bf16 v[16:19], a[172:175], a[16:19], v[16:19]
  v_readlane_b32 s98, v137, 0
  v_readlane_b32 s99, v137, 16
  v_mfma_f32_16x16x32_bf16 v[20:23], a[172:175], a[20:23], v[20:23]
  ds_read_b64_tr_b16 a[186:187], v227 offset:33792
  s_min_u32 s98, s98, s99
  s_sub_u32 s59, s51, s98
  s_sub_u32 s51, s59, 1
  v_mov_b32 v128, 0
  v_mfma_f32_16x16x32_bf16 v[20:23], a[168:171], a[4:7], v[20:23]
  v_writelane_b32 v128, s52, 0
  v_writelane_b32 v128, s53, 1
  v_mfma_f32_16x16x32_bf16 v[24:27], a[168:171], a[8:11], v[24:27]
  ds_read_b64_tr_b16 a[188:189], v227 offset:40960
  v_writelane_b32 v128, s54, 2
  v_mfma_f32_16x16x32_bf16 v[24:27], a[172:175], a[24:27], v[24:27]
  v_writelane_b32 v128, s55, 3
  v_writelane_b32 v128, s56, 4
  v_mfma_f32_16x16x32_bf16 v[28:31], a[172:175], a[28:31], v[28:31]
  ds_read_b64_tr_b16 a[190:191], v227 offset:41984
  v_writelane_b32 v128, s57, 5
  v_mfma_f32_16x16x32_bf16 v[28:31], a[168:171], a[12:15], v[28:31]
  s_waitcnt lgkmcnt(4)
  v_writelane_b32 v128, s58, 6
  v_writelane_b32 v128, s59, 7
  v_mfma_f32_16x16x32_bf16 v[32:35], a[176:179], a[0:3], v[32:35]
  ds_read_b64_tr_b16 a[160:161], v228 offset:32768
  v_and_b32 v129, 0xffff, v128
  v_mfma_f32_16x16x32_bf16 v[32:35], a[180:183], a[16:19], v[32:35]
  v_sub_u32 v129, 0xffff, v129
  v_and_b32 v129, 0x7ff, v129
  v_mfma_f32_16x16x32_bf16 v[36:39], a[180:183], a[20:23], v[36:39]
  ds_read_b64_tr_b16 a[162:163], v228 offset:33792
  v_mov_b32 v130, v129
  v_mfma_f32_16x16x32_bf16 v[36:39], a[176:179], a[4:7], v[36:39]
  v_mfma_f32_16x16x32_bf16 v[40:43], a[176:179], a[8:11], v[40:43]
  ds_read_b64_tr_b16 a[164:165], v228 offset:40960
  v_permlane16_swap_b32 v129, v130
  v_mfma_f32_16x16x32_bf16 v[40:43], a[180:183], a[24:27], v[40:43]
  buffer_load_dwordx4 v237, s[16:19], s29 offen offset:1024 lds
  v_mfma_f32_16x16x32_bf16 v[44:47], a[180:183], a[28:31], v[44:47]
  ds_read_b64_tr_b16 a[166:167], v228 offset:41984
  v_mov_b32 v130, v129
  v_mfma_f32_16x16x32_bf16 v[44:47], a[176:179], a[12:15], v[44:47]
  s_waitcnt lgkmcnt(4)
  v_permlane32_swap_b32 v129, v130
  v_lshrrev_b32 v130, 6, v129
  v_mfma_f32_16x16x32_bf16 v[48:51], a[184:187], a[0:3], v[48:51]
  ds_read_b64_tr_b16 a[168:169], v229 offset:32768
  v_mul_u32_u24 v130, 0x14000, v130
  v_mfma_f32_16x16x32_bf16 v[48:51], a[188:191], a[16:19], v[48:51]
  v_bfe_u32 v131, v129, 4, 2
  v_lshl_add_u32 v130, v131, 10, v130
  v_mfma_f32_16x16x32_bf16 v[52:55], a[188:191], a[20:23], v[52:55]
  ds_read_b64_tr_b16 a[170:171], v229 offset:33792
  v_and_b32 v131, 15, v129
  v_mfma_f32_16x16x32_bf16 v[52:55], a[184:187], a[4:7], v[52:55]
  v_lshl_add_u32 v130, v131, 4, v130
  v_lshrrev_b32 v131, 4, v136
  v_mfma_f32_16x16x32_bf16 v[56:59], a[184:187], a[8:11], v[56:59]
  ds_read_b64_tr_b16 a[172:173], v229 offset:40960
  v_lshl_add_u32 v243, v131, 8, v130
  v_mfma_f32_16x16x32_bf16 v[56:59], a[188:191], a[24:27], v[56:59]
  v_mfma_f32_16x16x32_bf16 v[60:63], a[188:191], a[28:31], v[60:63]
  ds_read_b64_tr_b16 a[174:175], v229 offset:41984
  v_mfma_f32_16x16x32_bf16 v[60:63], a[184:187], a[12:15], v[60:63]
  s_waitcnt lgkmcnt(4)
  v_mfma_f32_16x16x32_bf16 v[64:67], a[160:163], a[0:3], v[64:67]
  ds_read_b64_tr_b16 a[176:177], v230 offset:32768
  v_mfma_f32_16x16x32_bf16 v[64:67], a[164:167], a[16:19], v[64:67]
  v_mfma_f32_16x16x32_bf16 v[68:71], a[164:167], a[20:23], v[68:71]
  ds_read_b64_tr_b16 a[178:179], v230 offset:33792
  v_mfma_f32_16x16x32_bf16 v[68:71], a[160:163], a[4:7], v[68:71]
  v_mfma_f32_16x16x32_bf16 v[72:75], a[160:163], a[8:11], v[72:75]
  ds_read_b64_tr_b16 a[180:181], v230 offset:40960
  v_mfma_f32_16x16x32_bf16 v[72:75], a[164:167], a[24:27], v[72:75]
  buffer_load_dwordx4 v236, s[16:19], s29 offen offset:2048 lds
  v_mfma_f32_16x16x32_bf16 v[76:79], a[164:167], a[28:31], v[76:79]
  ds_read_b64_tr_b16 a[182:183], v230 offset:41984
  v_mfma_f32_16x16x32_bf16 v[76:79], a[160:163], a[12:15], v[76:79]
  s_waitcnt lgkmcnt(4)
  v_mfma_f32_16x16x32_bf16 v[80:83], a[168:171], a[0:3], v[80:83]
  ds_read_b64_tr_b16 a[184:185], v231 offset:32768
  v_mfma_f32_16x16x32_bf16 v[80:83], a[172:175], a[16:19], v[80:83]
  v_mfma_f32_16x16x32_bf16 v[84:87], a[172:175], a[20:23], v[84:87]
  ds_read_b64_tr_b16 a[186:187], v231 offset:33792
  v_mfma_f32_16x16x32_bf16 v[84:87], a[168:171], a[4:7], v[84:87]
  s_waitcnt vmcnt(8)
  v_mfma_f32_16x16x32_bf16 v[88:91], a[168:171], a[8:11], v[88:91]
  ds_read_b64_tr_b16 a[188:189], v231 offset:40960
  v_mfma_f32_16x16x32_bf16 v[88:91], a[172:175], a[24:27], v[88:91]
  s_barrier
  v_mfma_f32_16x16x32_bf16 v[92:95], a[172:175], a[28:31], v[92:95]
  ds_read_b64_tr_b16 a[190:191], v231 offset:41984
  v_mfma_f32_16x16x32_bf16 v[92:95], a[168:171], a[12:15], v[92:95]
  s_waitcnt lgkmcnt(4)
  v_mfma_f32_16x16x32_bf16 v[96:99], a[176:179], a[0:3], v[96:99]
  ds_read_b64_tr_b16 a[160:161], v224 offset:49152
  v_mfma_f32_16x16x32_bf16 v[96:99], a[180:183], a[16:19], v[96:99]
  v_mfma_f32_16x16x32_bf16 v[100:103], a[180:183], a[20:23], v[100:103]
  ds_read_b64_tr_b16 a[162:163], v224 offset:50176
  v_mfma_f32_16x16x32_bf16 v[100:103], a[176:179], a[4:7], v[100:103]
  v_mfma_f32_16x16x32_bf16 v[104:107], a[176:179], a[8:11], v[104:107]
  ds_read_b64_tr_b16 a[164:165], v224 offset:57344
  v_mfma_f32_16x16x32_bf16 v[104:107], a[180:183], a[24:27], v[104:107]
  buffer_load_dwordx4 v237, s[16:19], s29 offen offset:3072 lds
  s_add_u32 s29, s29, 16384
  v_mfma_f32_16x16x32_bf16 v[108:111], a[180:183], a[28:31], v[108:111]
  ds_read_b64_tr_b16 a[166:167], v224 offset:58368
  v_mfma_f32_16x16x32_bf16 v[108:111], a[176:179], a[12:15], v[108:111]
  s_waitcnt lgkmcnt(4)
  v_mfma_f32_16x16x32_bf16 v[112:115], a[184:187], a[0:3], v[112:115]
  ds_read_b64_tr_b16 a[168:169], v225 offset:49152
  v_mfma_f32_16x16x32_bf16 v[112:115], a[188:191], a[16:19], v[112:115]
  v_mfma_f32_16x16x32_bf16 v[116:119], a[188:191], a[20:23], v[116:119]
  ds_read_b64_tr_b16 a[170:171], v225 offset:50176
  v_mfma_f32_16x16x32_bf16 v[116:119], a[184:187], a[4:7], v[116:119]
  v_mfma_f32_16x16x32_bf16 v[120:123], a[184:187], a[8:11], v[120:123]
  ds_read_b64_tr_b16 a[172:173], v225 offset:57344
  v_mfma_f32_16x16x32_bf16 v[120:123], a[188:191], a[24:27], v[120:123]
  v_mfma_f32_16x16x32_bf16 v[124:127], a[188:191], a[28:31], v[124:127]
  ds_read_b64_tr_b16 a[174:175], v225 offset:58368
  v_mfma_f32_16x16x32_bf16 v[124:127], a[184:187], a[12:15], v[124:127]
  s_waitcnt vmcnt(8) lgkmcnt(4)
  v_mfma_f32_16x16x32_bf16 v[0:3], a[160:163], a[32:35], v[0:3]
  ds_read_b64_tr_b16 a[176:177], v226 offset:49152
  s_add_u32 m0, s28, 16384
  v_mfma_f32_16x16x32_bf16 v[0:3], a[164:167], a[48:51], v[0:3]
  buffer_load_dwordx4 v232, s[12:15], s29 offen offset:0 lds
  v_mfma_f32_16x16x32_bf16 v[4:7], a[164:167], a[52:55], v[4:7]
  ds_read_b64_tr_b16 a[178:179], v226 offset:50176
  v_mfma_f32_16x16x32_bf16 v[4:7], a[160:163], a[36:39], v[4:7]
  v_mfma_f32_16x16x32_bf16 v[8:11], a[160:163], a[40:43], v[8:11]
  ds_read_b64_tr_b16 a[180:181], v226 offset:57344
  v_mfma_f32_16x16x32_bf16 v[8:11], a[164:167], a[56:59], v[8:11]
  buffer_load_dwordx4 v233, s[12:15], s29 offen offset:1024 lds
  v_mfma_f32_16x16x32_bf16 v[12:15], a[164:167], a[60:63], v[12:15]
  ds_read_b64_tr_b16 a[182:183], v226 offset:58368
  v_mfma_f32_16x16x32_bf16 v[12:15], a[160:163], a[44:47], v[12:15]
  s_waitcnt lgkmcnt(4)
  v_mfma_f32_16x16x32_bf16 v[16:19], a[168:171], a[32:35], v[16:19]
  ds_read_b64_tr_b16 a[184:185], v227 offset:49152
  v_mfma_f32_16x16x32_bf16 v[16:19], a[172:175], a[48:51], v[16:19]
  buffer_load_dwordx4 v234, s[12:15], s29 offen offset:2048 lds
  v_mfma_f32_16x16x32_bf16 v[20:23], a[172:175], a[52:55], v[20:23]
  ds_read_b64_tr_b16 a[186:187], v227 offset:50176
  v_mfma_f32_16x16x32_bf16 v[20:23], a[168:171], a[36:39], v[20:23]
  buffer_load_dwordx4 v235, s[12:15], s29 offen offset:3072 lds
  v_mfma_f32_16x16x32_bf16 v[24:27], a[168:171], a[40:43], v[24:27]
  ds_read_b64_tr_b16 a[188:189], v227 offset:57344
  v_mfma_f32_16x16x32_bf16 v[24:27], a[172:175], a[56:59], v[24:27]
  v_mul_f32 v0, s34, v0
  v_mul_f32 v1, s34, v1
  v_mfma_f32_16x16x32_bf16 v[28:31], a[172:175], a[60:63], v[28:31]
  ds_read_b64_tr_b16 a[190:191], v227 offset:58368
  v_mul_f32 v2, s34, v2
  v_mfma_f32_16x16x32_bf16 v[28:31], a[168:171], a[44:47], v[28:31]
  s_waitcnt lgkmcnt(4)
  v_mul_f32 v3, s34, v3
  v_mul_f32 v16, s34, v16
  v_mfma_f32_16x16x32_bf16 v[32:35], a[176:179], a[32:35], v[32:35]
  ds_read_b64_tr_b16 a[160:161], v228 offset:49152
  v_mul_f32 v17, s34, v17
  v_mfma_f32_16x16x32_bf16 v[32:35], a[180:183], a[48:51], v[32:35]
  v_mul_f32 v18, s34, v18
  v_mul_f32 v19, s34, v19
  v_mfma_f32_16x16x32_bf16 v[36:39], a[180:183], a[52:55], v[36:39]
  ds_read_b64_tr_b16 a[162:163], v228 offset:50176
  v_cvt_pk_bf16_f32 v128, v0, v1
  v_mfma_f32_16x16x32_bf16 v[36:39], a[176:179], a[36:39], v[36:39]
  v_cvt_pk_bf16_f32 v129, v2, v3
  v_cvt_pk_bf16_f32 v130, v16, v17
  v_mfma_f32_16x16x32_bf16 v[40:43], a[176:179], a[40:43], v[40:43]
  ds_read_b64_tr_b16 a[164:165], v228 offset:57344
  v_cvt_pk_bf16_f32 v131, v18, v19
  v_mfma_f32_16x16x32_bf16 v[40:43], a[180:183], a[56:59], v[40:43]
  v_mul_f32 v4, s34, v4
  v_mul_f32 v5, s34, v5
  v_mfma_f32_16x16x32_bf16 v[44:47], a[180:183], a[60:63], v[44:47]
  ds_read_b64_tr_b16 a[166:167], v228 offset:58368
  v_mul_f32 v6, s34, v6
  v_mfma_f32_16x16x32_bf16 v[44:47], a[176:179], a[44:47], v[44:47]
  s_waitcnt lgkmcnt(4)
  v_mul_f32 v7, s34, v7
  v_mul_f32 v20, s34, v20
  v_mfma_f32_16x16x32_bf16 v[48:51], a[184:187], a[32:35], v[48:51]
  ds_read_b64_tr_b16 a[168:169], v229 offset:49152
  v_mul_f32 v21, s34, v21
  v_mfma_f32_16x16x32_bf16 v[48:51], a[188:191], a[48:51], v[48:51]
  v_mul_f32 v22, s34, v22
  v_mul_f32 v23, s34, v23
  v_mfma_f32_16x16x32_bf16 v[52:55], a[188:191], a[52:55], v[52:55]
  ds_read_b64_tr_b16 a[170:171], v229 offset:50176
  v_cvt_pk_bf16_f32 v144, v4, v5
  v_mfma_f32_16x16x32_bf16 v[52:55], a[184:187], a[36:39], v[52:55]
  v_cvt_pk_bf16_f32 v145, v6, v7
  v_cvt_pk_bf16_f32 v146, v20, v21
  v_mfma_f32_16x16x32_bf16 v[56:59], a[184:187], a[40:43], v[56:59]
  ds_read_b64_tr_b16 a[172:173], v229 offset:57344
  v_cvt_pk_bf16_f32 v147, v22, v23
  v_mfma_f32_16x16x32_bf16 v[56:59], a[188:191], a[56:59], v[56:59]
  v_permlane16_swap_b32 v128, v130
  v_permlane16_swap_b32 v129, v131
  v_mfma_f32_16x16x32_bf16 v[60:63], a[188:191], a[60:63], v[60:63]
  ds_read_b64_tr_b16 a[174:175], v229 offset:58368
  v_mul_f32 v8, s34, v8
  v_mfma_f32_16x16x32_bf16 v[60:63], a[184:187], a[44:47], v[60:63]
  s_waitcnt lgkmcnt(4)
  v_mul_f32 v9, s34, v9
  v_mul_f32 v10, s34, v10
  v_mfma_f32_16x16x32_bf16 v[64:67], a[160:163], a[32:35], v[64:67]
  ds_read_b64_tr_b16 a[176:177], v230 offset:49152
  v_mul_f32 v11, s34, v11
  v_mfma_f32_16x16x32_bf16 v[64:67], a[164:167], a[48:51], v[64:67]
  v_mul_f32 v24, s34, v24
  v_mul_f32 v25, s34, v25
  v_mfma_f32_16x16x32_bf16 v[68:71], a[164:167], a[52:55], v[68:71]
  ds_read_b64_tr_b16 a[178:179], v230 offset:50176
  v_mul_f32 v26, s34, v26
  v_mfma_f32_16x16x32_bf16 v[68:71], a[160:163], a[36:39], v[68:71]
  v_mul_f32 v27, s34, v27
  v_cvt_pk_bf16_f32 v160, v8, v9
  v_mfma_f32_16x16x32_bf16 v[72:75], a[160:163], a[40:43], v[72:75]
  ds_read_b64_tr_b16 a[180:181], v230 offset:57344
  v_cvt_pk_bf16_f32 v161, v10, v11
  v_mfma_f32_16x16x32_bf16 v[72:75], a[164:167], a[56:59], v[72:75]
  v_cvt_pk_bf16_f32 v162, v24, v25
  v_cvt_pk_bf16_f32 v163, v26, v27
  v_mfma_f32_16x16x32_bf16 v[76:79], a[164:167], a[60:63], v[76:79]
  ds_read_b64_tr_b16 a[182:183], v230 offset:58368
  v_permlane16_swap_b32 v144, v146
  v_mfma_f32_16x16x32_bf16 v[76:79], a[160:163], a[44:47], v[76:79]
  s_waitcnt lgkmcnt(4)
  v_permlane16_swap_b32 v145, v147
  v_mul_f32 v12, s34, v12
  v_mfma_f32_16x16x32_bf16 v[80:83], a[168:171], a[32:35], v[80:83]
  ds_read_b64_tr_b16 a[184:185], v231 offset:49152
  v_mul_f32 v13, s34, v13
  v_mfma_f32_16x16x32_bf16 v[80:83], a[172:175], a[48:51], v[80:83]
  v_mul_f32 v14, s34, v14
  v_mul_f32 v15, s34, v15
  v_mfma_f32_16x16x32_bf16 v[84:87], a[172:175], a[52:55], v[84:87]
  ds_read_b64_tr_b16 a[186:187], v231 offset:50176
  v_mul_f32 v28, s34, v28
  v_mfma_f32_16x16x32_bf16 v[84:87], a[168:171], a[36:39], v[84:87]
  s_waitcnt vmcnt(8)
  v_mul_f32 v29, s34, v29
  v_mul_f32 v30, s34, v30
  v_mfma_f32_16x16x32_bf16 v[88:91], a[168:171], a[40:43], v[88:91]
  ds_read_b64_tr_b16 a[188:189], v231 offset:57344
  v_mul_f32 v31, s34, v31
  v_mfma_f32_16x16x32_bf16 v[88:91], a[172:175], a[56:59], v[88:91]
  s_barrier
  v_cvt_pk_bf16_f32 v176, v12, v13
  v_cvt_pk_bf16_f32 v177, v14, v15
  v_mfma_f32_16x16x32_bf16 v[92:95], a[172:175], a[60:63], v[92:95]
  ds_read_b64_tr_b16 a[190:191], v231 offset:58368
  v_cvt_pk_bf16_f32 v178, v28, v29
  v_mfma_f32_16x16x32_bf16 v[92:95], a[168:171], a[44:47], v[92:95]
  s_waitcnt lgkmcnt(4)
  v_cvt_pk_bf16_f32 v179, v30, v31
  v_permlane16_swap_b32 v160, v162
  v_mfma_f32_16x16x32_bf16 v[96:99], a[176:179], a[32:35], v[96:99]
  ds_read_b128 a[128:131], v212 offset:0
  v_permlane16_swap_b32 v161, v163
  v_mfma_f32_16x16x32_bf16 v[96:99], a[180:183], a[48:51], v[96:99]
  v_mul_f32 v32, s34, v32
  v_mul_f32 v33, s34, v33
  v_mfma_f32_16x16x32_bf16 v[100:103], a[180:183], a[52:55], v[100:103]
  ds_read_b128 a[132:135], v213 offset:0
  v_mul_f32 v34, s34, v34
  v_mfma_f32_16x16x32_bf16 v[100:103], a[176:179], a[36:39], v[100:103]
  v_mul_f32 v35, s34, v35
  v_mul_f32 v48, s34, v48
  v_mfma_f32_16x16x32_bf16 v[104:107], a[176:179], a[40:43], v[104:107]
  ds_read_b128 a[136:139], v214 offset:0
  v_mul_f32 v49, s34, v49
  v_mfma_f32_16x16x32_bf16 v[104:107], a[180:183], a[56:59], v[104:107]
  v_mul_f32 v50, s34, v50
  v_mul_f32 v51, s34, v51
  v_mfma_f32_16x16x32_bf16 v[108:111], a[180:183], a[60:63], v[108:111]
  ds_read_b128 a[140:143], v215 offset:0
  v_cvt_pk_bf16_f32 v132, v32, v33
  v_mfma_f32_16x16x32_bf16 v[108:111], a[176:179], a[44:47], v[108:111]
  s_waitcnt lgkmcnt(4)
  v_cvt_pk_bf16_f32 v133, v34, v35
  v_cvt_pk_bf16_f32 v134, v48, v49
  v_mfma_f32_16x16x32_bf16 v[112:115], a[184:187], a[32:35], v[112:115]
  v_cvt_pk_bf16_f32 v135, v50, v51
  v_permlane16_swap_b32 v176, v178
  v_mfma_f32_16x16x32_bf16 v[112:115], a[188:191], a[48:51], v[112:115]
  v_permlane16_swap_b32 v177, v179
  v_mul_f32 v36, s34, v36
  v_mfma_f32_16x16x32_bf16 v[116:119], a[188:191], a[52:55], v[116:119]
  v_mul_f32 v37, s34, v37
  v_mul_f32 v38, s34, v38
  v_mfma_f32_16x16x32_bf16 v[116:119], a[184:187], a[36:39], v[116:119]
  v_mul_f32 v39, s34, v39
  v_mul_f32 v52, s34, v52
  v_mfma_f32_16x16x32_bf16 v[120:123], a[184:187], a[40:43], v[120:123]
  v_mul_f32 v53, s34, v53
  v_mul_f32 v54, s34, v54
  v_mfma_f32_16x16x32_bf16 v[120:123], a[188:191], a[56:59], v[120:123]
  v_mul_f32 v55, s34, v55
  v_cvt_pk_bf16_f32 v148, v36, v37
  v_mfma_f32_16x16x32_bf16 v[124:127], a[188:191], a[60:63], v[124:127]
  v_cvt_pk_bf16_f32 v149, v38, v39
  v_cvt_pk_bf16_f32 v150, v52, v53
  v_mfma_f32_16x16x32_bf16 v[124:127], a[184:187], a[44:47], v[124:127]
  s_waitcnt lgkmcnt(0)
  v_cvt_pk_bf16_f32 v151, v54, v55
  v_permlane16_swap_b32 v132, v134
  v_permlane16_swap_b32 v133, v135
  v_pk_mul_f32 v[40:41], v[40:41], s[34:35] op_sel_hi:[1,0]
  v_pk_mul_f32 v[42:43], v[42:43], s[34:35] op_sel_hi:[1,0]
  v_pk_mul_f32 v[56:57], v[56:57], s[34:35] op_sel_hi:[1,0]
  v_pk_mul_f32 v[58:59], v[58:59], s[34:35] op_sel_hi:[1,0]
  v_cvt_pk_bf16_f32 v164, v40, v41
  v_cvt_pk_bf16_f32 v165, v42, v43
  v_cvt_pk_bf16_f32 v166, v56, v57
  v_cvt_pk_bf16_f32 v167, v58, v59
  v_permlane16_swap_b32 v148, v150
  v_permlane16_swap_b32 v149, v151
  v_pk_mul_f32 v[44:45], v[44:45], s[34:35] op_sel_hi:[1,0]
  v_pk_mul_f32 v[46:47], v[46:47], s[34:35] op_sel_hi:[1,0]
  v_pk_mul_f32 v[60:61], v[60:61], s[34:35] op_sel_hi:[1,0]
  v_pk_mul_f32 v[62:63], v[62:63], s[34:35] op_sel_hi:[1,0]
  v_cvt_pk_bf16_f32 v180, v44, v45
  v_cvt_pk_bf16_f32 v181, v46, v47
  v_cvt_pk_bf16_f32 v182, v60, v61
  v_cvt_pk_bf16_f32 v183, v62, v63
  v_permlane16_swap_b32 v164, v166
  v_permlane16_swap_b32 v165, v167
  v_pk_mul_f32 v[64:65], v[64:65], s[34:35] op_sel_hi:[1,0]
  v_pk_mul_f32 v[66:67], v[66:67], s[34:35] op_sel_hi:[1,0]
  v_pk_mul_f32 v[80:81], v[80:81], s[34:35] op_sel_hi:[1,0]
  v_pk_mul_f32 v[82:83], v[82:83], s[34:35] op_sel_hi:[1,0]
  v_cvt_pk_bf16_f32 v136, v64, v65
  v_cvt_pk_bf16_f32 v137, v66, v67
  v_cvt_pk_bf16_f32 v138, v80, v81
  v_cvt_pk_bf16_f32 v139, v82, v83
  v_permlane16_swap_b32 v180, v182
  v_permlane16_swap_b32 v181, v183
  v_pk_mul_f32 v[68:69], v[68:69], s[34:35] op_sel_hi:[1,0]
  v_pk_mul_f32 v[70:71], v[70:71], s[34:35] op_sel_hi:[1,0]
  v_pk_mul_f32 v[84:85], v[84:85], s[34:35] op_sel_hi:[1,0]
  v_pk_mul_f32 v[86:87], v[86:87], s[34:35] op_sel_hi:[1,0]
  v_cvt_pk_bf16_f32 v152, v68, v69
  v_cvt_pk_bf16_f32 v153, v70, v71
  v_cvt_pk_bf16_f32 v154, v84, v85
  v_cvt_pk_bf16_f32 v155, v86, v87
  v_permlane16_swap_b32 v136, v138
  v_permlane16_swap_b32 v137, v139
  v_pk_mul_f32 v[72:73], v[72:73], s[34:35] op_sel_hi:[1,0]
  v_pk_mul_f32 v[74:75], v[74:75], s[34:35] op_sel_hi:[1,0]
  v_pk_mul_f32 v[88:89], v[88:89], s[34:35] op_sel_hi:[1,0]
  v_pk_mul_f32 v[90:91], v[90:91], s[34:35] op_sel_hi:[1,0]
  v_cvt_pk_bf16_f32 v168, v72, v73
  v_cvt_pk_bf16_f32 v169, v74, v75
  v_cvt_pk_bf16_f32 v170, v88, v89
  v_cvt_pk_bf16_f32 v171, v90, v91
  v_permlane16_swap_b32 v152, v154
  v_permlane16_swap_b32 v153, v155
  v_pk_mul_f32 v[76:77], v[76:77], s[34:35] op_sel_hi:[1,0]
  v_pk_mul_f32 v[78:79], v[78:79], s[34:35] op_sel_hi:[1,0]
  v_pk_mul_f32 v[92:93], v[92:93], s[34:35] op_sel_hi:[1,0]
  v_pk_mul_f32 v[94:95], v[94:95], s[34:35] op_sel_hi:[1,0]
  v_cvt_pk_bf16_f32 v184, v76, v77
  v_cvt_pk_bf16_f32 v185, v78, v79
  v_cvt_pk_bf16_f32 v186, v92, v93
  v_cvt_pk_bf16_f32 v187, v94, v95
  v_permlane16_swap_b32 v168, v170
  v_permlane16_swap_b32 v169, v171
  v_pk_mul_f32 v[96:97], v[96:97], s[34:35] op_sel_hi:[1,0]
  v_pk_mul_f32 v[98:99], v[98:99], s[34:35] op_sel_hi:[1,0]
  v_pk_mul_f32 v[112:113], v[112:113], s[34:35] op_sel_hi:[1,0]
  v_pk_mul_f32 v[114:115], v[114:115], s[34:35] op_sel_hi:[1,0]
  v_cvt_pk_bf16_f32 v140, v96, v97
  v_cvt_pk_bf16_f32 v141, v98, v99
  v_cvt_pk_bf16_f32 v142, v112, v113
  v_cvt_pk_bf16_f32 v143, v114, v115
  v_permlane16_swap_b32 v184, v186
  v_permlane16_swap_b32 v185, v187
  v_pk_mul_f32 v[100:101], v[100:101], s[34:35] op_sel_hi:[1,0]
  v_pk_mul_f32 v[102:103], v[102:103], s[34:35] op_sel_hi:[1,0]
  v_pk_mul_f32 v[116:117], v[116:117], s[34:35] op_sel_hi:[1,0]
  v_pk_mul_f32 v[118:119], v[118:119], s[34:35] op_sel_hi:[1,0]
  v_cvt_pk_bf16_f32 v156, v100, v101
  v_cvt_pk_bf16_f32 v157, v102, v103
  v_cvt_pk_bf16_f32 v158, v116, v117
  v_cvt_pk_bf16_f32 v159, v118, v119
  v_permlane16_swap_b32 v140, v142
  v_permlane16_swap_b32 v141, v143
  v_pk_mul_f32 v[104:105], v[104:105], s[34:35] op_sel_hi:[1,0]
  v_pk_mul_f32 v[106:107], v[106:107], s[34:35] op_sel_hi:[1,0]
  v_pk_mul_f32 v[120:121], v[120:121], s[34:35] op_sel_hi:[1,0]
  v_pk_mul_f32 v[122:123], v[122:123], s[34:35] op_sel_hi:[1,0]
  v_cvt_pk_bf16_f32 v172, v104, v105
  v_cvt_pk_bf16_f32 v173, v106, v107
  v_cvt_pk_bf16_f32 v174, v120, v121
  v_cvt_pk_bf16_f32 v175, v122, v123
  v_permlane16_swap_b32 v156, v158
  v_permlane16_swap_b32 v157, v159
  v_pk_mul_f32 v[108:109], v[108:109], s[34:35] op_sel_hi:[1,0]
  v_pk_mul_f32 v[110:111], v[110:111], s[34:35] op_sel_hi:[1,0]
  v_pk_mul_f32 v[124:125], v[124:125], s[34:35] op_sel_hi:[1,0]
  v_pk_mul_f32 v[126:127], v[126:127], s[34:35] op_sel_hi:[1,0]
  v_cvt_pk_bf16_f32 v188, v108, v109
  v_cvt_pk_bf16_f32 v189, v110, v111
  v_cvt_pk_bf16_f32 v190, v124, v125
  v_cvt_pk_bf16_f32 v191, v126, v127
  v_permlane16_swap_b32 v172, v174
  v_permlane16_swap_b32 v173, v175
  v_permlane16_swap_b32 v188, v190
  v_permlane16_swap_b32 v189, v191
  v_mfma_f32_16x16x32_bf16 v[0:3], a[128:131], v[128:131], 0
  s_add_u32 m0, s28, 81920
  ds_read_b128 a[144:147], v212 offset:4096
  s_mov_b32 s20, s90
  s_mov_b32 s21, s91
  v_mfma_f32_16x16x32_bf16 v[0:3], a[132:135], v[132:135], v[0:3]
  buffer_load_dwordx4 v236, s[16:19], s29 offen offset:0 lds
  s_mov_b32 s22, 2211840
  s_mov_b32 s23, 0x20000
  s_mov_b32 s44, s92
  v_mfma_f32_16x16x32_bf16 v[0:3], a[136:139], v[136:139], v[0:3]
  ds_read_b128 a[148:151], v213 offset:4096
  s_mov_b32 s45, s93
  s_mov_b32 s46, 2211840
  s_mov_b32 s47, 0x20000
  v_lshrrev_b32 v253, 4, v242
  v_mfma_f32_16x16x32_bf16 v[0:3], a[140:143], v[140:143], v[0:3]
  buffer_load_dwordx4 v237, s[16:19], s29 offen offset:1024 lds
  v_mfma_f32_16x16x32_bf16 v[8:11], a[140:143], v[156:159], 0
  ds_read_b128 a[152:155], v214 offset:4096
  v_mul_u32_u24 v253, 0xd80, v253
  v_mfma_f32_16x16x32_bf16 v[8:11], a[136:139], v[152:155], v[8:11]
  buffer_load_dwordx4 v236, s[16:19], s29 offen offset:2048 lds
  s_mul_i32 s35, s3, 552960
  s_lshl_b32 s38, s33, 4
  s_add_u32 s35, s35, s38
  v_mfma_f32_16x16x32_bf16 v[8:11], a[132:135], v[148:151], v[8:11]
  ds_read_b128 a[156:159], v215 offset:4096
  v_mfma_f32_16x16x32_bf16 v[8:11], a[128:131], v[144:147], v[8:11]
  buffer_load_dwordx4 v237, s[16:19], s29 offen offset:3072 lds
  v_mfma_f32_16x16x32_bf16 v[16:19], a[128:131], v[160:163], 0
  s_add_u32 s29, s29, 16384
  s_add_u32 m0, s28, 32768
  v_mfma_f32_16x16x32_bf16 v[16:19], a[132:135], v[164:167], v[16:19]
  buffer_load_dwordx4 v232, s[12:15], s29 offen offset:0 lds
  v_mfma_f32_16x16x32_bf16 v[16:19], a[136:139], v[168:171], v[16:19]
  buffer_load_dwordx4 v233, s[12:15], s29 offen offset:1024 lds
  v_mfma_f32_16x16x32_bf16 v[16:19], a[140:143], v[172:175], v[16:19]
  v_max3_f32 v192, v0, v1, v2
  v_max3_f32 v196, v8, v9, v10
  v_mfma_f32_16x16x32_bf16 v[24:27], a[140:143], v[188:191], 0
  v_max_f32 v192, v192, v3
  v_max_f32 v196, v196, v11
  v_mfma_f32_16x16x32_bf16 v[24:27], a[136:139], v[184:187], v[24:27]
  v_mov_b32 v245, v192
  v_mov_b32 v246, v196
  v_mfma_f32_16x16x32_bf16 v[24:27], a[132:135], v[180:183], v[24:27]
  v_permlane16_swap_b32 v192, v245
  v_permlane16_swap_b32 v196, v246
  v_mfma_f32_16x16x32_bf16 v[24:27], a[128:131], v[176:179], v[24:27]
  s_waitcnt lgkmcnt(0)
  v_max_f32 v192, v192, v245
  v_max_f32 v196, v196, v246
  v_mfma_f32_16x16x32_bf16 v[4:7], a[144:147], v[128:131], 0
  ds_read_b128 a[128:131], v212 offset:8192
  v_mov_b32 v245, v192
  v_mfma_f32_16x16x32_bf16 v[4:7], a[148:151], v[132:135], v[4:7]
  v_mov_b32 v246, v196
  v_permlane32_swap_b32 v192, v245
  v_mfma_f32_16x16x32_bf16 v[4:7], a[152:155], v[136:139], v[4:7]
  ds_read_b128 a[132:135], v213 offset:8192
  v_permlane32_swap_b32 v196, v246
  v_mfma_f32_16x16x32_bf16 v[4:7], a[156:159], v[140:143], v[4:7]
  v_max_f32 v192, v192, v245
  v_max_f32 v196, v196, v246
  v_mfma_f32_16x16x32_bf16 v[12:15], a[156:159], v[156:159], 0
  ds_read_b128 a[136:139], v214 offset:8192
  v_sub_f32 v193, 0, v192
  v_mfma_f32_16x16x32_bf16 v[12:15], a[152:155], v[152:155], v[12:15]
  v_sub_f32 v197, 0, v196
  v_sub_f32 v194, 0, v192
  v_mfma_f32_16x16x32_bf16 v[12:15], a[148:151], v[148:151], v[12:15]
  ds_read_b128 a[140:143], v215 offset:8192
  v_sub_f32 v198, 0, v196
  v_mfma_f32_16x16x32_bf16 v[12:15], a[144:147], v[144:147], v[12:15]
  v_sub_f32 v195, 0, v192
  v_sub_f32 v199, 0, v196
  v_mfma_f32_16x16x32_bf16 v[20:23], a[144:147], v[160:163], 0
  buffer_load_dwordx4 v234, s[12:15], s29 offen offset:2048 lds
  v_mfma_f32_16x16x32_bf16 v[20:23], a[148:151], v[164:167], v[20:23]
  v_sub_f32 v192, 0, v192
  v_sub_f32 v196, 0, v196
  v_mfma_f32_16x16x32_bf16 v[20:23], a[152:155], v[168:171], v[20:23]
  buffer_load_dwordx4 v235, s[12:15], s29 offen offset:3072 lds
  v_mfma_f32_16x16x32_bf16 v[20:23], a[156:159], v[172:175], v[20:23]
  v_max3_f32 v200, v16, v17, v18
  v_max3_f32 v204, v24, v25, v26
  v_mfma_f32_16x16x32_bf16 v[28:31], a[156:159], v[188:191], 0
  v_max_f32 v200, v200, v19
  v_max_f32 v204, v204, v27
  v_mfma_f32_16x16x32_bf16 v[28:31], a[152:155], v[184:187], v[28:31]
  v_mov_b32 v247, v200
  v_mov_b32 v248, v204
  v_mfma_f32_16x16x32_bf16 v[28:31], a[148:151], v[180:183], v[28:31]
  v_permlane16_swap_b32 v200, v247
  v_permlane16_swap_b32 v204, v248
  v_max_f32 v200, v200, v247
  v_max_f32 v204, v204, v248
  v_mov_b32 v247, v200
  v_mov_b32 v248, v204
  s_nop 0
  v_permlane32_swap_b32 v200, v247
  v_permlane32_swap_b32 v204, v248
  v_max_f32 v200, v200, v247
  v_max_f32 v204, v204, v248
  v_sub_f32 v201, 0, v200
  v_sub_f32 v205, 0, v204
  v_sub_f32 v202, 0, v200
  v_sub_f32 v206, 0, v204
  v_sub_f32 v203, 0, v200
  v_sub_f32 v207, 0, v204
  v_sub_f32 v200, 0, v200
  v_sub_f32 v204, 0, v204
  v_mfma_f32_16x16x32_bf16 v[28:31], a[144:147], v[176:179], v[28:31]
  s_waitcnt lgkmcnt(0)
  v_add_f32 v0, v192, v0
  v_add_f32 v1, v192, v1
  v_mfma_f32_16x16x32_bf16 v[32:35], a[128:131], v[128:131], v[192:195]
  ds_read_b128 a[144:147], v212 offset:12288
  v_add_f32 v2, v192, v2
  v_mfma_f32_16x16x32_bf16 v[32:35], a[132:135], v[132:135], v[32:35]
  v_add_f32 v3, v192, v3
  v_mfma_f32_16x16x32_bf16 v[32:35], a[136:139], v[136:139], v[32:35]
  ds_read_b128 a[148:151], v213 offset:12288
  v_mfma_f32_16x16x32_bf16 v[32:35], a[140:143], v[140:143], v[32:35]
  v_exp_f32 v0, v0
  v_mfma_f32_16x16x32_bf16 v[40:43], a[140:143], v[156:159], v[196:199]
  ds_read_b128 a[152:155], v214 offset:12288
  v_mfma_f32_16x16x32_bf16 v[40:43], a[136:139], v[152:155], v[40:43]
  v_exp_f32 v1, v1
  v_mfma_f32_16x16x32_bf16 v[40:43], a[132:135], v[148:151], v[40:43]
  ds_read_b128 a[156:159], v215 offset:12288
  v_mfma_f32_16x16x32_bf16 v[40:43], a[128:131], v[144:147], v[40:43]
  v_exp_f32 v2, v2
  v_mfma_f32_16x16x32_bf16 v[48:51], a[128:131], v[160:163], v[200:203]
  s_add_u32 m0, s50, 0
  v_cvt_pk_bf16_f32 v0, v0, v1
  v_mfma_f32_16x16x32_bf16 v[48:51], a[132:135], v[164:167], v[48:51]
  v_exp_f32 v3, v3
  v_mfma_f32_16x16x32_bf16 v[48:51], a[136:139], v[168:171], v[48:51]
  v_add_f32 v8, v196, v8
  v_add_f32 v9, v196, v9
  v_mfma_f32_16x16x32_bf16 v[48:51], a[140:143], v[172:175], v[48:51]
  v_add_f32 v10, v196, v10
  v_add_f32 v11, v196, v11
  v_mfma_f32_16x16x32_bf16 v[56:59], a[140:143], v[188:191], v[204:207]
  v_exp_f32 v8, v8
  v_mfma_f32_16x16x32_bf16 v[56:59], a[136:139], v[184:187], v[56:59]
  v_exp_f32 v9, v9
  buffer_load_dwordx4 v253, s[20:23], s35 offen lds
  v_mfma_f32_16x16x32_bf16 v[56:59], a[132:135], v[180:183], v[56:59]
  v_exp_f32 v10, v10
  v_mfma_f32_16x16x32_bf16 v[56:59], a[128:131], v[176:179], v[56:59]
  s_waitcnt lgkmcnt(0)
  v_cvt_pk_bf16_f32 v8, v8, v9
  v_mfma_f32_16x16x32_bf16 v[36:39], a[144:147], v[128:131], v[192:195]
  s_waitcnt vmcnt(9)
  v_exp_f32 v11, v11
  v_mfma_f32_16x16x32_bf16 v[36:39], a[148:151], v[132:135], v[36:39]
  s_barrier
  v_cvt_pk_bf16_f32 v1, v2, v3
  v_add_f32 v16, v200, v16
  v_mfma_f32_16x16x32_bf16 v[36:39], a[152:155], v[136:139], v[36:39]
  ds_read_b128 a[128:131], v212 offset:16384
  v_add_f32 v17, v200, v17
  v_mfma_f32_16x16x32_bf16 v[36:39], a[156:159], v[140:143], v[36:39]
  v_add_f32 v18, v200, v18
  v_add_f32 v19, v200, v19
  v_mfma_f32_16x16x32_bf16 v[44:47], a[156:159], v[156:159], v[196:199]
  ds_read_b128 a[132:135], v213 offset:16384
  v_mfma_f32_16x16x32_bf16 v[44:47], a[152:155], v[152:155], v[44:47]
  v_exp_f32 v16, v16
  v_mfma_f32_16x16x32_bf16 v[44:47], a[148:151], v[148:151], v[44:47]
  ds_read_b128 a[136:139], v214 offset:16384
  v_mfma_f32_16x16x32_bf16 v[44:47], a[144:147], v[144:147], v[44:47]
  v_exp_f32 v17, v17
  v_mfma_f32_16x16x32_bf16 v[52:55], a[144:147], v[160:163], v[200:203]
  ds_read_b128 a[140:143], v215 offset:16384
  v_mfma_f32_16x16x32_bf16 v[52:55], a[148:151], v[164:167], v[52:55]
  v_exp_f32 v18, v18
  v_mfma_f32_16x16x32_bf16 v[52:55], a[152:155], v[168:171], v[52:55]
  v_cvt_pk_bf16_f32 v16, v16, v17
  v_mfma_f32_16x16x32_bf16 v[52:55], a[156:159], v[172:175], v[52:55]
  v_exp_f32 v19, v19
  v_mfma_f32_16x16x32_bf16 v[60:63], a[156:159], v[188:191], v[204:207]
  v_cvt_pk_bf16_f32 v9, v10, v11
  v_add_f32 v24, v204, v24
  v_mfma_f32_16x16x32_bf16 v[60:63], a[152:155], v[184:187], v[60:63]
  v_add_f32 v25, v204, v25
  v_add_f32 v26, v204, v26
  v_mfma_f32_16x16x32_bf16 v[60:63], a[148:151], v[180:183], v[60:63]
  v_add_f32 v27, v204, v27
  v_mfma_f32_16x16x32_bf16 v[60:63], a[144:147], v[176:179], v[60:63]
  s_waitcnt lgkmcnt(0)
  v_exp_f32 v24, v24
  v_exp_f32 v25, v25
  v_exp_f32 v26, v26
  v_cvt_pk_bf16_f32 v24, v24, v25
  v_exp_f32 v27, v27
  v_cvt_pk_bf16_f32 v17, v18, v19
  v_add_f32 v4, v192, v4
  v_add_f32 v5, v192, v5
  v_add_f32 v6, v192, v6
  v_add_f32 v7, v192, v7
  v_exp_f32 v4, v4
  v_exp_f32 v5, v5
  v_exp_f32 v6, v6
  v_cvt_pk_bf16_f32 v2, v4, v5
  v_exp_f32 v7, v7
  v_cvt_pk_bf16_f32 v25, v26, v27
  v_add_f32 v12, v196, v12
  v_add_f32 v13, v196, v13
  v_add_f32 v14, v196, v14
  v_add_f32 v15, v196, v15
  v_exp_f32 v12, v12
  v_exp_f32 v13, v13
  v_exp_f32 v14, v14
  v_cvt_pk_bf16_f32 v10, v12, v13
  v_exp_f32 v15, v15
  v_cvt_pk_bf16_f32 v3, v6, v7
  v_add_f32 v20, v200, v20
  v_add_f32 v21, v200, v21
  v_add_f32 v22, v200, v22
  v_add_f32 v23, v200, v23
  v_exp_f32 v20, v20
  v_exp_f32 v21, v21
  v_exp_f32 v22, v22
  v_cvt_pk_bf16_f32 v18, v20, v21
  v_exp_f32 v23, v23
  v_cvt_pk_bf16_f32 v11, v14, v15
  v_add_f32 v28, v204, v28
  v_add_f32 v29, v204, v29
  v_add_f32 v30, v204, v30
  v_add_f32 v31, v204, v31
  v_exp_f32 v28, v28
  v_exp_f32 v29, v29
  v_exp_f32 v30, v30
  v_cvt_pk_bf16_f32 v26, v28, v29
  v_exp_f32 v31, v31
  v_cvt_pk_bf16_f32 v19, v22, v23
  v_exp_f32 v32, v32
  v_exp_f32 v33, v33
  v_exp_f32 v34, v34
  v_cvt_pk_bf16_f32 v32, v32, v33
  v_exp_f32 v35, v35
  v_cvt_pk_bf16_f32 v27, v30, v31
  v_exp_f32 v40, v40
  v_exp_f32 v41, v41
  v_exp_f32 v42, v42
  v_cvt_pk_bf16_f32 v40, v40, v41
  v_exp_f32 v43, v43
  v_cvt_pk_bf16_f32 v33, v34, v35
  v_exp_f32 v48, v48
  v_exp_f32 v49, v49
  v_exp_f32 v50, v50
  v_cvt_pk_bf16_f32 v48, v48, v49
  v_exp_f32 v51, v51
  v_cvt_pk_bf16_f32 v41, v42, v43
  v_exp_f32 v56, v56
  v_exp_f32 v57, v57
  v_exp_f32 v58, v58
  v_cvt_pk_bf16_f32 v56, v56, v57
  v_exp_f32 v59, v59
  v_cvt_pk_bf16_f32 v49, v50, v51
  v_exp_f32 v36, v36
  v_exp_f32 v37, v37
  v_exp_f32 v38, v38
  v_cvt_pk_bf16_f32 v34, v36, v37
  v_exp_f32 v39, v39
  v_cvt_pk_bf16_f32 v57, v58, v59
  v_exp_f32 v44, v44
  v_exp_f32 v45, v45
  v_exp_f32 v46, v46
  v_cvt_pk_bf16_f32 v42, v44, v45
  v_exp_f32 v47, v47
  v_cvt_pk_bf16_f32 v35, v38, v39
  v_exp_f32 v52, v52
  v_exp_f32 v53, v53
  v_exp_f32 v54, v54
  v_cvt_pk_bf16_f32 v50, v52, v53
  v_exp_f32 v55, v55
  v_cvt_pk_bf16_f32 v43, v46, v47
  v_exp_f32 v60, v60
  v_exp_f32 v61, v61
  v_exp_f32 v62, v62
  v_cvt_pk_bf16_f32 v58, v60, v61
  v_exp_f32 v63, v63
  v_cvt_pk_bf16_f32 v51, v54, v55
  v_cvt_pk_bf16_f32 v59, v62, v63
  v_mfma_f32_16x16x32_bf16 v[64:67], a[128:131], v[128:131], v[192:195]
  s_add_u32 m0, s28, 98304
  v_mfma_f32_16x16x32_bf16 v[64:67], a[132:135], v[132:135], v[64:67]
  ds_read_b128 a[144:147], v212 offset:20480
  v_mfma_f32_16x16x32_bf16 v[64:67], a[136:139], v[136:139], v[64:67]
  buffer_load_dwordx4 v236, s[16:19], s29 offen offset:0 lds
  v_mfma_f32_16x16x32_bf16 v[64:67], a[140:143], v[140:143], v[64:67]
  ds_read_b128 a[148:151], v213 offset:20480
  v_mfma_f32_16x16x32_bf16 v[72:75], a[140:143], v[156:159], v[196:199]
  v_mfma_f32_16x16x32_bf16 v[72:75], a[136:139], v[152:155], v[72:75]
  ds_read_b128 a[152:155], v214 offset:20480
  v_mfma_f32_16x16x32_bf16 v[72:75], a[132:135], v[148:151], v[72:75]
  buffer_load_dwordx4 v237, s[16:19], s29 offen offset:1024 lds
  v_mfma_f32_16x16x32_bf16 v[72:75], a[128:131], v[144:147], v[72:75]
  ds_read_b128 a[156:159], v215 offset:20480
  v_mfma_f32_16x16x32_bf16 v[80:83], a[128:131], v[160:163], v[200:203]
  v_exp_f32 v64, v64
  v_mfma_f32_16x16x32_bf16 v[80:83], a[132:135], v[164:167], v[80:83]
  v_mfma_f32_16x16x32_bf16 v[80:83], a[136:139], v[168:171], v[80:83]
  v_exp_f32 v65, v65
  v_mfma_f32_16x16x32_bf16 v[80:83], a[140:143], v[172:175], v[80:83]
  v_cvt_pk_bf16_f32 v64, v64, v65
  v_mfma_f32_16x16x32_bf16 v[88:91], a[140:143], v[188:191], v[204:207]
  v_exp_f32 v66, v66
  v_mfma_f32_16x16x32_bf16 v[88:91], a[136:139], v[184:187], v[88:91]
  buffer_load_dwordx4 v236, s[16:19], s29 offen offset:2048 lds
  v_mfma_f32_16x16x32_bf16 v[88:91], a[132:135], v[180:183], v[88:91]
  s_waitcnt lgkmcnt(0)
  v_exp_f32 v67, v67
  v_mfma_f32_16x16x32_bf16 v[88:91], a[128:131], v[176:179], v[88:91]
  v_cvt_pk_bf16_f32 v65, v66, v67
  v_mfma_f32_16x16x32_bf16 v[68:71], a[144:147], v[128:131], v[192:195]
  v_exp_f32 v72, v72
  v_mfma_f32_16x16x32_bf16 v[68:71], a[148:151], v[132:135], v[68:71]
  ds_read_b128 a[128:131], v212 offset:24576
  v_mfma_f32_16x16x32_bf16 v[68:71], a[152:155], v[136:139], v[68:71]
  v_exp_f32 v73, v73
  v_mfma_f32_16x16x32_bf16 v[68:71], a[156:159], v[140:143], v[68:71]
  ds_read_b128 a[132:135], v213 offset:24576
  v_cvt_pk_bf16_f32 v72, v72, v73
  v_mfma_f32_16x16x32_bf16 v[76:79], a[156:159], v[156:159], v[196:199]
  v_exp_f32 v74, v74
  v_mfma_f32_16x16x32_bf16 v[76:79], a[152:155], v[152:155], v[76:79]
  ds_read_b128 a[136:139], v214 offset:24576
  v_mfma_f32_16x16x32_bf16 v[76:79], a[148:151], v[148:151], v[76:79]
  v_exp_f32 v75, v75
  v_mfma_f32_16x16x32_bf16 v[76:79], a[144:147], v[144:147], v[76:79]
  ds_read_b128 a[140:143], v215 offset:24576
  v_cvt_pk_bf16_f32 v73, v74, v75
  v_mfma_f32_16x16x32_bf16 v[84:87], a[144:147], v[160:163], v[200:203]
  v_exp_f32 v80, v80
  v_mfma_f32_16x16x32_bf16 v[84:87], a[148:151], v[164:167], v[84:87]
  buffer_load_dwordx4 v237, s[16:19], s29 offen offset:3072 lds
  v_mfma_f32_16x16x32_bf16 v[84:87], a[152:155], v[168:171], v[84:87]
  s_add_u32 s29, s29, 16384
  v_exp_f32 v81, v81
  v_mfma_f32_16x16x32_bf16 v[84:87], a[156:159], v[172:175], v[84:87]
  v_cvt_pk_bf16_f32 v80, v80, v81
  v_mfma_f32_16x16x32_bf16 v[92:95], a[156:159], v[188:191], v[204:207]
  s_add_u32 m0, s28, 49152
  v_exp_f32 v82, v82
  v_mfma_f32_16x16x32_bf16 v[92:95], a[152:155], v[184:187], v[92:95]
  buffer_load_dwordx4 v232, s[12:15], s29 offen offset:0 lds
  v_mfma_f32_16x16x32_bf16 v[92:95], a[148:151], v[180:183], v[92:95]
  s_waitcnt lgkmcnt(0)
  v_exp_f32 v83, v83
  v_mfma_f32_16x16x32_bf16 v[92:95], a[144:147], v[176:179], v[92:95]
  v_cvt_pk_bf16_f32 v81, v82, v83
  v_mfma_f32_16x16x32_bf16 v[96:99], a[128:131], v[128:131], v[192:195]
  v_exp_f32 v88, v88
  v_mfma_f32_16x16x32_bf16 v[96:99], a[132:135], v[132:135], v[96:99]
  ds_read_b128 a[144:147], v212 offset:28672
  v_mfma_f32_16x16x32_bf16 v[96:99], a[136:139], v[136:139], v[96:99]
  v_exp_f32 v89, v89
  v_mfma_f32_16x16x32_bf16 v[96:99], a[140:143], v[140:143], v[96:99]
  ds_read_b128 a[148:151], v213 offset:28672
  v_cvt_pk_bf16_f32 v88, v88, v89
  v_mfma_f32_16x16x32_bf16 v[104:107], a[140:143], v[156:159], v[196:199]
  v_exp_f32 v90, v90
  v_mfma_f32_16x16x32_bf16 v[104:107], a[136:139], v[152:155], v[104:107]
  ds_read_b128 a[152:155], v214 offset:28672
  v_mfma_f32_16x16x32_bf16 v[104:107], a[132:135], v[148:151], v[104:107]
  v_exp_f32 v91, v91
  v_mfma_f32_16x16x32_bf16 v[104:107], a[128:131], v[144:147], v[104:107]
  ds_read_b128 a[156:159], v215 offset:28672
  v_cvt_pk_bf16_f32 v89, v90, v91
  v_mfma_f32_16x16x32_bf16 v[112:115], a[128:131], v[160:163], v[200:203]
  v_exp_f32 v68, v68
  v_mfma_f32_16x16x32_bf16 v[112:115], a[132:135], v[164:167], v[112:115]
  buffer_load_dwordx4 v233, s[12:15], s29 offen offset:1024 lds
  v_mfma_f32_16x16x32_bf16 v[112:115], a[136:139], v[168:171], v[112:115]
  v_exp_f32 v69, v69
  v_mfma_f32_16x16x32_bf16 v[112:115], a[140:143], v[172:175], v[112:115]
  v_cvt_pk_bf16_f32 v66, v68, v69
  v_mfma_f32_16x16x32_bf16 v[120:123], a[140:143], v[188:191], v[204:207]
  v_exp_f32 v70, v70
  v_mfma_f32_16x16x32_bf16 v[120:123], a[136:139], v[184:187], v[120:123]
  buffer_load_dwordx4 v234, s[12:15], s29 offen offset:2048 lds
  v_mfma_f32_16x16x32_bf16 v[120:123], a[132:135], v[180:183], v[120:123]
  s_waitcnt lgkmcnt(0)
  v_exp_f32 v71, v71
  v_mfma_f32_16x16x32_bf16 v[120:123], a[128:131], v[176:179], v[120:123]
  v_cvt_pk_bf16_f32 v67, v70, v71
  v_mfma_f32_16x16x32_bf16 v[100:103], a[144:147], v[128:131], v[192:195]
  v_exp_f32 v76, v76
  v_mfma_f32_16x16x32_bf16 v[100:103], a[148:151], v[132:135], v[100:103]
  ds_read_b64_tr_b16 a[160:161], v216 offset:0
  v_mfma_f32_16x16x32_bf16 v[100:103], a[152:155], v[136:139], v[100:103]
  v_exp_f32 v77, v77
  v_mfma_f32_16x16x32_bf16 v[100:103], a[156:159], v[140:143], v[100:103]
  ds_read_b64_tr_b16 a[162:163], v216 offset:4096
  v_cvt_pk_bf16_f32 v74, v76, v77
  v_mfma_f32_16x16x32_bf16 v[108:111], a[156:159], v[156:159], v[196:199]
  v_exp_f32 v78, v78
  v_mfma_f32_16x16x32_bf16 v[108:111], a[152:155], v[152:155], v[108:111]
  ds_read_b64_tr_b16 a[164:165], v216 offset:8192
  buffer_load_dwordx4 v235, s[12:15], s29 offen offset:3072 lds
  v_mfma_f32_16x16x32_bf16 v[108:111], a[148:151], v[148:151], v[108:111]
  v_exp_f32 v79, v79
  v_mfma_f32_16x16x32_bf16 v[108:111], a[144:147], v[144:147], v[108:111]
  ds_read_b64_tr_b16 a[166:167], v216 offset:12288
  v_cvt_pk_bf16_f32 v75, v78, v79
  v_mfma_f32_16x16x32_bf16 v[116:119], a[144:147], v[160:163], v[200:203]
  v_exp_f32 v84, v84
  v_mfma_f32_16x16x32_bf16 v[116:119], a[148:151], v[164:167], v[116:119]
  ds_read_b64_tr_b16 a[168:169], v217 offset:0
  s_add_u32 m0, s50, 3072
  v_mfma_f32_16x16x32_bf16 v[116:119], a[152:155], v[168:171], v[116:119]
  v_exp_f32 v85, v85
  v_mfma_f32_16x16x32_bf16 v[116:119], a[156:159], v[172:175], v[116:119]
  ds_read_b64_tr_b16 a[170:171], v217 offset:4096
  v_cvt_pk_bf16_f32 v82, v84, v85
  v_mfma_f32_16x16x32_bf16 v[124:127], a[156:159], v[188:191], v[204:207]
  v_exp_f32 v86, v86
  v_mfma_f32_16x16x32_bf16 v[124:127], a[152:155], v[184:187], v[124:127]
  ds_read_b64_tr_b16 a[172:173], v217 offset:8192
  buffer_load_dwordx4 v253, s[44:47], s35 offen lds
  s_add_u32 s35, s35, 221184
  v_mfma_f32_16x16x32_bf16 v[124:127], a[148:151], v[180:183], v[124:127]
  v_exp_f32 v87, v87
  v_mfma_f32_16x16x32_bf16 v[124:127], a[144:147], v[176:179], v[124:127]
  ds_read_b64_tr_b16 a[174:175], v217 offset:12288
  v_cvt_pk_bf16_f32 v83, v86, v87
  v_mfma_f32_16x16x32_bf16 a[192:195], a[208:211], v[0:3], 0
  v_exp_f32 v92, v92
  v_mfma_f32_16x16x32_bf16 a[192:195], a[208:211], v[32:35], a[192:195]
  ds_read_b64_tr_b16 a[176:177], v218 offset:0
  v_mfma_f32_16x16x32_bf16 a[196:199], a[208:211], v[8:11], 0
  v_exp_f32 v93, v93
  v_mfma_f32_16x16x32_bf16 a[196:199], a[208:211], v[40:43], a[196:199]
  ds_read_b64_tr_b16 a[178:179], v218 offset:4096
  v_cvt_pk_bf16_f32 v90, v92, v93
  v_mfma_f32_16x16x32_bf16 a[200:203], a[208:211], v[16:19], 0
  v_exp_f32 v94, v94
  v_mfma_f32_16x16x32_bf16 a[200:203], a[208:211], v[48:51], a[200:203]
  ds_read_b64_tr_b16 a[180:181], v218 offset:8192
  v_mfma_f32_16x16x32_bf16 a[204:207], a[208:211], v[24:27], 0
  s_waitcnt lgkmcnt(7)
  v_exp_f32 v95, v95
  v_mfma_f32_16x16x32_bf16 a[204:207], a[208:211], v[56:59], a[204:207]
  ds_read_b64_tr_b16 a[182:183], v218 offset:12288
  v_cvt_pk_bf16_f32 v91, v94, v95
  v_mfma_f32_16x16x32_bf16 a[0:3], a[160:163], v[0:3], 0
  v_exp_f32 v96, v96
  v_mfma_f32_16x16x32_bf16 a[0:3], a[164:167], v[32:35], a[0:3]
  ds_read_b64_tr_b16 a[184:185], v219 offset:0
  v_mfma_f32_16x16x32_bf16 a[4:7], a[164:167], v[40:43], 0
  v_exp_f32 v97, v97
  v_mfma_f32_16x16x32_bf16 a[4:7], a[160:163], v[8:11], a[4:7]
  ds_read_b64_tr_b16 a[186:187], v219 offset:4096
  v_cvt_pk_bf16_f32 v96, v96, v97
  v_mfma_f32_16x16x32_bf16 a[8:11], a[160:163], v[16:19], 0
  v_exp_f32 v98, v98
  v_mfma_f32_16x16x32_bf16 a[8:11], a[164:167], v[48:51], a[8:11]
  ds_read_b64_tr_b16 a[188:189], v219 offset:8192
  v_mfma_f32_16x16x32_bf16 a[12:15], a[164:167], v[56:59], 0
  s_waitcnt lgkmcnt(7)
  v_exp_f32 v99, v99
  v_mfma_f32_16x16x32_bf16 a[12:15], a[160:163], v[24:27], a[12:15]
  ds_read_b64_tr_b16 a[190:191], v219 offset:12288
  v_cvt_pk_bf16_f32 v97, v98, v99
  v_mfma_f32_16x16x32_bf16 a[16:19], a[168:171], v[0:3], 0
  v_exp_f32 v104, v104
  v_mfma_f32_16x16x32_bf16 a[16:19], a[172:175], v[32:35], a[16:19]
  ds_read_b64_tr_b16 a[160:161], v220 offset:0
  v_mfma_f32_16x16x32_bf16 a[20:23], a[172:175], v[40:43], 0
  v_exp_f32 v105, v105
  v_mfma_f32_16x16x32_bf16 a[20:23], a[168:171], v[8:11], a[20:23]
  ds_read_b64_tr_b16 a[162:163], v220 offset:4096
  v_cvt_pk_bf16_f32 v104, v104, v105
  v_mfma_f32_16x16x32_bf16 a[24:27], a[168:171], v[16:19], 0
  v_exp_f32 v106, v106
  v_mfma_f32_16x16x32_bf16 a[24:27], a[172:175], v[48:51], a[24:27]
  ds_read_b64_tr_b16 a[164:165], v220 offset:8192
  v_mfma_f32_16x16x32_bf16 a[28:31], a[172:175], v[56:59], 0
  s_waitcnt lgkmcnt(7)
  v_exp_f32 v107, v107
  v_mfma_f32_16x16x32_bf16 a[28:31], a[168:171], v[24:27], a[28:31]
  ds_read_b64_tr_b16 a[166:167], v220 offset:12288
  v_cvt_pk_bf16_f32 v105, v106, v107
  v_mfma_f32_16x16x32_bf16 a[32:35], a[176:179], v[0:3], 0
  v_exp_f32 v112, v112
  v_mfma_f32_16x16x32_bf16 a[32:35], a[180:183], v[32:35], a[32:35]
  ds_read_b64_tr_b16 a[168:169], v221 offset:0
  v_mfma_f32_16x16x32_bf16 a[36:39], a[180:183], v[40:43], 0
  v_exp_f32 v113, v113
  v_mfma_f32_16x16x32_bf16 a[36:39], a[176:179], v[8:11], a[36:39]
  ds_read_b64_tr_b16 a[170:171], v221 offset:4096
  v_cvt_pk_bf16_f32 v112, v112, v113
  v_mfma_f32_16x16x32_bf16 a[40:43], a[176:179], v[16:19], 0
  v_exp_f32 v114, v114
  v_mfma_f32_16x16x32_bf16 a[40:43], a[180:183], v[48:51], a[40:43]
  ds_read_b64_tr_b16 a[172:173], v221 offset:8192
  v_mfma_f32_16x16x32_bf16 a[44:47], a[180:183], v[56:59], 0
  s_waitcnt lgkmcnt(7)
  v_exp_f32 v115, v115
  v_mfma_f32_16x16x32_bf16 a[44:47], a[176:179], v[24:27], a[44:47]
  ds_read_b64_tr_b16 a[174:175], v221 offset:12288
  v_cvt_pk_bf16_f32 v113, v114, v115
  v_mfma_f32_16x16x32_bf16 a[48:51], a[184:187], v[0:3], 0
  v_exp_f32 v120, v120
  v_mfma_f32_16x16x32_bf16 a[48:51], a[188:191], v[32:35], a[48:51]
  ds_read_b64_tr_b16 a[176:177], v222 offset:0
  v_mfma_f32_16x16x32_bf16 a[52:55], a[188:191], v[40:43], 0
  v_exp_f32 v121, v121
  v_mfma_f32_16x16x32_bf16 a[52:55], a[184:187], v[8:11], a[52:55]
  ds_read_b64_tr_b16 a[178:179], v222 offset:4096
  v_cvt_pk_bf16_f32 v120, v120, v121
  v_mfma_f32_16x16x32_bf16 a[56:59], a[184:187], v[16:19], 0
  v_exp_f32 v122, v122
  v_mfma_f32_16x16x32_bf16 a[56:59], a[188:191], v[48:51], a[56:59]
  ds_read_b64_tr_b16 a[180:181], v222 offset:8192
  v_mfma_f32_16x16x32_bf16 a[60:63], a[188:191], v[56:59], 0
  s_waitcnt lgkmcnt(7)
  v_exp_f32 v123, v123
  v_mfma_f32_16x16x32_bf16 a[60:63], a[184:187], v[24:27], a[60:63]
  ds_read_b64_tr_b16 a[182:183], v222 offset:12288
  v_cvt_pk_bf16_f32 v121, v122, v123
  v_mfma_f32_16x16x32_bf16 a[64:67], a[160:163], v[0:3], 0
  v_exp_f32 v100, v100
  v_mfma_f32_16x16x32_bf16 a[64:67], a[164:167], v[32:35], a[64:67]
  ds_read_b64_tr_b16 a[184:185], v223 offset:0
  v_mfma_f32_16x16x32_bf16 a[68:71], a[164:167], v[40:43], 0
  v_exp_f32 v101, v101
  v_mfma_f32_16x16x32_bf16 a[68:71], a[160:163], v[8:11], a[68:71]
  ds_read_b64_tr_b16 a[186:187], v223 offset:4096
  v_cvt_pk_bf16_f32 v98, v100, v101
  v_mfma_f32_16x16x32_bf16 a[72:75], a[160:163], v[16:19], 0
  v_exp_f32 v102, v102
  v_mfma_f32_16x16x32_bf16 a[72:75], a[164:167], v[48:51], a[72:75]
  ds_read_b64_tr_b16 a[188:189], v223 offset:8192
  v_mfma_f32_16x16x32_bf16 a[76:79], a[164:167], v[56:59], 0
  s_waitcnt lgkmcnt(7)
  v_exp_f32 v103, v103
  v_mfma_f32_16x16x32_bf16 a[76:79], a[160:163], v[24:27], a[76:79]
  ds_read_b64_tr_b16 a[190:191], v223 offset:12288
  v_cvt_pk_bf16_f32 v99, v102, v103
  v_mfma_f32_16x16x32_bf16 a[80:83], a[168:171], v[0:3], 0
  s_waitcnt vmcnt(10)
  v_exp_f32 v108, v108
  v_mfma_f32_16x16x32_bf16 a[80:83], a[172:175], v[32:35], a[80:83]
  v_mfma_f32_16x16x32_bf16 a[84:87], a[172:175], v[40:43], 0
  s_barrier
  v_exp_f32 v109, v109
  v_mfma_f32_16x16x32_bf16 a[84:87], a[168:171], v[8:11], a[84:87]
  ds_read_b128 a[128:131], v212 offset:32768
  v_cvt_pk_bf16_f32 v106, v108, v109
  v_mfma_f32_16x16x32_bf16 a[88:91], a[168:171], v[16:19], 0
  v_exp_f32 v110, v110
  v_mfma_f32_16x16x32_bf16 a[88:91], a[172:175], v[48:51], a[88:91]
  ds_read_b128 a[132:135], v213 offset:32768
  v_mfma_f32_16x16x32_bf16 a[92:95], a[172:175], v[56:59], 0
  s_waitcnt lgkmcnt(6)
  v_exp_f32 v111, v111
  v_mfma_f32_16x16x32_bf16 a[92:95], a[168:171], v[24:27], a[92:95]
  ds_read_b128 a[136:139], v214 offset:32768
  v_cvt_pk_bf16_f32 v107, v110, v111
  v_mfma_f32_16x16x32_bf16 a[96:99], a[176:179], v[0:3], 0
  s_mul_i32 s38, s3, 20480
  v_exp_f32 v116, v116
  v_mfma_f32_16x16x32_bf16 a[96:99], a[180:183], v[32:35], a[96:99]
  ds_read_b128 a[140:143], v215 offset:32768
  buffer_load_dwordx4 a[212:215], v243, s[24:27], s38 offen sc1
  s_add_u32 s38, s38, 4096
  v_mfma_f32_16x16x32_bf16 a[100:103], a[180:183], v[40:43], 0
  v_exp_f32 v117, v117
  v_mfma_f32_16x16x32_bf16 a[100:103], a[176:179], v[8:11], a[100:103]
  v_cvt_pk_bf16_f32 v114, v116, v117
  v_mfma_f32_16x16x32_bf16 a[104:107], a[176:179], v[16:19], 0
  v_exp_f32 v118, v118
  v_mfma_f32_16x16x32_bf16 a[104:107], a[180:183], v[48:51], a[104:107]
  v_mfma_f32_16x16x32_bf16 a[108:111], a[180:183], v[56:59], 0
  s_waitcnt lgkmcnt(4)
  v_exp_f32 v119, v119
  v_mfma_f32_16x16x32_bf16 a[108:111], a[176:179], v[24:27], a[108:111]
  v_cvt_pk_bf16_f32 v115, v118, v119
  v_mfma_f32_16x16x32_bf16 a[112:115], a[184:187], v[0:3], 0
  v_exp_f32 v124, v124
  v_mfma_f32_16x16x32_bf16 a[112:115], a[188:191], v[32:35], a[112:115]
  v_mfma_f32_16x16x32_bf16 a[116:119], a[188:191], v[40:43], 0
  v_exp_f32 v125, v125
  v_mfma_f32_16x16x32_bf16 a[116:119], a[184:187], v[8:11], a[116:119]
  v_cvt_pk_bf16_f32 v122, v124, v125
  v_mfma_f32_16x16x32_bf16 a[120:123], a[184:187], v[16:19], 0
  v_exp_f32 v126, v126
  v_mfma_f32_16x16x32_bf16 a[120:123], a[188:191], v[48:51], a[120:123]
  v_mfma_f32_16x16x32_bf16 a[124:127], a[188:191], v[56:59], 0
  s_waitcnt lgkmcnt(0)
  v_exp_f32 v127, v127
  v_mfma_f32_16x16x32_bf16 a[124:127], a[184:187], v[24:27], a[124:127]
  v_cvt_pk_bf16_f32 v123, v126, v127
  v_mfma_f32_16x16x32_bf16 v[0:3], a[128:131], v[128:131], v[192:195]
  s_add_u32 m0, s28, 114688
  v_mfma_f32_16x16x32_bf16 v[0:3], a[132:135], v[132:135], v[0:3]
  ds_read_b128 a[144:147], v212 offset:36864
  v_mfma_f32_16x16x32_bf16 v[0:3], a[136:139], v[136:139], v[0:3]
  buffer_load_dwordx4 v236, s[16:19], s29 offen offset:0 lds
  v_mfma_f32_16x16x32_bf16 v[0:3], a[140:143], v[140:143], v[0:3]
  ds_read_b128 a[148:151], v213 offset:36864
  v_mfma_f32_16x16x32_bf16 v[8:11], a[140:143], v[156:159], v[196:199]
  v_mfma_f32_16x16x32_bf16 v[8:11], a[136:139], v[152:155], v[8:11]
  ds_read_b128 a[152:155], v214 offset:36864
  v_mfma_f32_16x16x32_bf16 v[8:11], a[132:135], v[148:151], v[8:11]
  buffer_load_dwordx4 v237, s[16:19], s29 offen offset:1024 lds
  v_mfma_f32_16x16x32_bf16 v[8:11], a[128:131], v[144:147], v[8:11]
  ds_read_b128 a[156:159], v215 offset:36864
  v_mfma_f32_16x16x32_bf16 v[16:19], a[128:131], v[160:163], v[200:203]
  v_exp_f32 v0, v0
  v_mfma_f32_16x16x32_bf16 v[16:19], a[132:135], v[164:167], v[16:19]
  v_mfma_f32_16x16x32_bf16 v[16:19], a[136:139], v[168:171], v[16:19]
  v_exp_f32 v1, v1
  v_mfma_f32_16x16x32_bf16 v[16:19], a[140:143], v[172:175], v[16:19]
  v_cvt_pk_bf16_f32 v0, v0, v1
  v_mfma_f32_16x16x32_bf16 v[24:27], a[140:143], v[188:191], v[204:207]
  v_exp_f32 v2, v2
  v_mfma_f32_16x16x32_bf16 v[24:27], a[136:139], v[184:187], v[24:27]
  buffer_load_dwordx4 v236, s[16:19], s29 offen offset:2048 lds
  v_mfma_f32_16x16x32_bf16 v[24:27], a[132:135], v[180:183], v[24:27]
  s_waitcnt lgkmcnt(0)
  v_exp_f32 v3, v3
  v_mfma_f32_16x16x32_bf16 v[24:27], a[128:131], v[176:179], v[24:27]
  v_cvt_pk_bf16_f32 v1, v2, v3
  v_mfma_f32_16x16x32_bf16 v[4:7], a[144:147], v[128:131], v[192:195]
  v_exp_f32 v8, v8
  v_mfma_f32_16x16x32_bf16 v[4:7], a[148:151], v[132:135], v[4:7]
  ds_read_b128 a[128:131], v212 offset:40960
  v_mfma_f32_16x16x32_bf16 v[4:7], a[152:155], v[136:139], v[4:7]
  v_exp_f32 v9, v9
  v_mfma_f32_16x16x32_bf16 v[4:7], a[156:159], v[140:143], v[4:7]
  ds_read_b128 a[132:135], v213 offset:40960
  v_cvt_pk_bf16_f32 v8, v8, v9
  v_mfma_f32_16x16x32_bf16 v[12:15], a[156:159], v[156:159], v[196:199]
  v_exp_f32 v10, v10
  v_mfma_f32_16x16x32_bf16 v[12:15], a[152:155], v[152:155], v[12:15]
  ds_read_b128 a[136:139], v214 offset:40960
  v_mfma_f32_16x16x32_bf16 v[12:15], a[148:151], v[148:151], v[12:15]
  v_exp_f32 v11, v11
  v_mfma_f32_16x16x32_bf16 v[12:15], a[144:147], v[144:147], v[12:15]
  ds_read_b128 a[140:143], v215 offset:40960
  v_cvt_pk_bf16_f32 v9, v10, v11
  v_mfma_f32_16x16x32_bf16 v[20:23], a[144:147], v[160:163], v[200:203]
  v_exp_f32 v16, v16
  v_mfma_f32_16x16x32_bf16 v[20:23], a[148:151], v[164:167], v[20:23]
  buffer_load_dwordx4 v237, s[16:19], s29 offen offset:3072 lds
  v_mfma_f32_16x16x32_bf16 v[20:23], a[152:155], v[168:171], v[20:23]
  s_add_u32 s29, s29, 16384
  v_exp_f32 v17, v17
  v_mfma_f32_16x16x32_bf16 v[20:23], a[156:159], v[172:175], v[20:23]
  v_cvt_pk_bf16_f32 v16, v16, v17
  v_mfma_f32_16x16x32_bf16 v[28:31], a[156:159], v[188:191], v[204:207]
  s_add_u32 m0, s28, 0
  v_exp_f32 v18, v18
  v_mfma_f32_16x16x32_bf16 v[28:31], a[152:155], v[184:187], v[28:31]
  buffer_load_dwordx4 v232, s[12:15], s29 offen offset:0 lds
  v_mfma_f32_16x16x32_bf16 v[28:31], a[148:151], v[180:183], v[28:31]
  s_waitcnt lgkmcnt(0)
  v_exp_f32 v19, v19
  v_mfma_f32_16x16x32_bf16 v[28:31], a[144:147], v[176:179], v[28:31]
  v_cvt_pk_bf16_f32 v17, v18, v19
  v_mfma_f32_16x16x32_bf16 v[32:35], a[128:131], v[128:131], v[192:195]
  v_exp_f32 v24, v24
  v_mfma_f32_16x16x32_bf16 v[32:35], a[132:135], v[132:135], v[32:35]
  ds_read_b128 a[144:147], v212 offset:45056
  v_mfma_f32_16x16x32_bf16 v[32:35], a[136:139], v[136:139], v[32:35]
  v_exp_f32 v25, v25
  v_mfma_f32_16x16x32_bf16 v[32:35], a[140:143], v[140:143], v[32:35]
  ds_read_b128 a[148:151], v213 offset:45056
  v_cvt_pk_bf16_f32 v24, v24, v25
  v_mfma_f32_16x16x32_bf16 v[40:43], a[140:143], v[156:159], v[196:199]
  v_exp_f32 v26, v26
  v_mfma_f32_16x16x32_bf16 v[40:43], a[136:139], v[152:155], v[40:43]
  ds_read_b128 a[152:155], v214 offset:45056
  v_mfma_f32_16x16x32_bf16 v[40:43], a[132:135], v[148:151], v[40:43]
  v_exp_f32 v27, v27
  v_mfma_f32_16x16x32_bf16 v[40:43], a[128:131], v[144:147], v[40:43]
  ds_read_b128 a[156:159], v215 offset:45056
  v_cvt_pk_bf16_f32 v25, v26, v27
  v_mfma_f32_16x16x32_bf16 v[48:51], a[128:131], v[160:163], v[200:203]
  v_exp_f32 v4, v4
  v_mfma_f32_16x16x32_bf16 v[48:51], a[132:135], v[164:167], v[48:51]
  buffer_load_dwordx4 v233, s[12:15], s29 offen offset:1024 lds
  v_mfma_f32_16x16x32_bf16 v[48:51], a[136:139], v[168:171], v[48:51]
  v_exp_f32 v5, v5
  v_mfma_f32_16x16x32_bf16 v[48:51], a[140:143], v[172:175], v[48:51]
  v_cvt_pk_bf16_f32 v2, v4, v5
  v_mfma_f32_16x16x32_bf16 v[56:59], a[140:143], v[188:191], v[204:207]
  v_exp_f32 v6, v6
  v_mfma_f32_16x16x32_bf16 v[56:59], a[136:139], v[184:187], v[56:59]
  buffer_load_dwordx4 v234, s[12:15], s29 offen offset:2048 lds
  v_mfma_f32_16x16x32_bf16 v[56:59], a[132:135], v[180:183], v[56:59]
  s_waitcnt lgkmcnt(0)
  v_exp_f32 v7, v7
  v_mfma_f32_16x16x32_bf16 v[56:59], a[128:131], v[176:179], v[56:59]
  v_cvt_pk_bf16_f32 v3, v6, v7
  v_mfma_f32_16x16x32_bf16 v[36:39], a[144:147], v[128:131], v[192:195]
  v_exp_f32 v12, v12
  v_mfma_f32_16x16x32_bf16 v[36:39], a[148:151], v[132:135], v[36:39]
  ds_read_b64_tr_b16 a[160:161], v216 offset:16384
  v_mfma_f32_16x16x32_bf16 v[36:39], a[152:155], v[136:139], v[36:39]
  v_exp_f32 v13, v13
  v_mfma_f32_16x16x32_bf16 v[36:39], a[156:159], v[140:143], v[36:39]
  ds_read_b64_tr_b16 a[162:163], v216 offset:20480
  v_cvt_pk_bf16_f32 v10, v12, v13
  v_mfma_f32_16x16x32_bf16 v[44:47], a[156:159], v[156:159], v[196:199]
  v_exp_f32 v14, v14
  v_mfma_f32_16x16x32_bf16 v[44:47], a[152:155], v[152:155], v[44:47]
  ds_read_b64_tr_b16 a[164:165], v216 offset:24576
  buffer_load_dwordx4 v235, s[12:15], s29 offen offset:3072 lds
  v_mfma_f32_16x16x32_bf16 v[44:47], a[148:151], v[148:151], v[44:47]
  v_exp_f32 v15, v15
  v_mfma_f32_16x16x32_bf16 v[44:47], a[144:147], v[144:147], v[44:47]
  ds_read_b64_tr_b16 a[166:167], v216 offset:28672
  v_cvt_pk_bf16_f32 v11, v14, v15
  v_mfma_f32_16x16x32_bf16 v[52:55], a[144:147], v[160:163], v[200:203]
  v_exp_f32 v20, v20
  v_mfma_f32_16x16x32_bf16 v[52:55], a[148:151], v[164:167], v[52:55]
  ds_read_b64_tr_b16 a[168:169], v217 offset:16384
  s_add_u32 m0, s50, 1024
  v_mfma_f32_16x16x32_bf16 v[52:55], a[152:155], v[168:171], v[52:55]
  v_exp_f32 v21, v21
  v_mfma_f32_16x16x32_bf16 v[52:55], a[156:159], v[172:175], v[52:55]
  ds_read_b64_tr_b16 a[170:171], v217 offset:20480
  v_cvt_pk_bf16_f32 v18, v20, v21
  v_mfma_f32_16x16x32_bf16 v[60:63], a[156:159], v[188:191], v[204:207]
  v_exp_f32 v22, v22
  v_mfma_f32_16x16x32_bf16 v[60:63], a[152:155], v[184:187], v[60:63]
  ds_read_b64_tr_b16 a[172:173], v217 offset:24576
  buffer_load_dwordx4 v253, s[20:23], s35 offen lds
  v_mfma_f32_16x16x32_bf16 v[60:63], a[148:151], v[180:183], v[60:63]
  v_exp_f32 v23, v23
  v_mfma_f32_16x16x32_bf16 v[60:63], a[144:147], v[176:179], v[60:63]
  ds_read_b64_tr_b16 a[174:175], v217 offset:28672
  v_cvt_pk_bf16_f32 v19, v22, v23
  v_mfma_f32_16x16x32_bf16 a[192:195], a[208:211], v[64:67], a[192:195]
  v_exp_f32 v28, v28
  v_mfma_f32_16x16x32_bf16 a[192:195], a[208:211], v[96:99], a[192:195]
  ds_read_b64_tr_b16 a[176:177], v218 offset:16384
  v_mfma_f32_16x16x32_bf16 a[196:199], a[208:211], v[72:75], a[196:199]
  v_exp_f32 v29, v29
  v_mfma_f32_16x16x32_bf16 a[196:199], a[208:211], v[104:107], a[196:199]
  ds_read_b64_tr_b16 a[178:179], v218 offset:20480
  v_cvt_pk_bf16_f32 v26, v28, v29
  v_mfma_f32_16x16x32_bf16 a[200:203], a[208:211], v[80:83], a[200:203]
  v_exp_f32 v30, v30
  v_mfma_f32_16x16x32_bf16 a[200:203], a[208:211], v[112:115], a[200:203]
  ds_read_b64_tr_b16 a[180:181], v218 offset:24576
  v_mfma_f32_16x16x32_bf16 a[204:207], a[208:211], v[88:91], a[204:207]
  s_waitcnt lgkmcnt(7)
  v_exp_f32 v31, v31
  v_mfma_f32_16x16x32_bf16 a[204:207], a[208:211], v[120:123], a[204:207]
  ds_read_b64_tr_b16 a[182:183], v218 offset:28672
  v_cvt_pk_bf16_f32 v27, v30, v31
  v_mfma_f32_16x16x32_bf16 a[0:3], a[160:163], v[64:67], a[0:3]
  v_exp_f32 v32, v32
  v_mfma_f32_16x16x32_bf16 a[0:3], a[164:167], v[96:99], a[0:3]
  ds_read_b64_tr_b16 a[184:185], v219 offset:16384
  v_mfma_f32_16x16x32_bf16 a[4:7], a[164:167], v[104:107], a[4:7]
  v_exp_f32 v33, v33
  v_mfma_f32_16x16x32_bf16 a[4:7], a[160:163], v[72:75], a[4:7]
  ds_read_b64_tr_b16 a[186:187], v219 offset:20480
  v_cvt_pk_bf16_f32 v32, v32, v33
  v_mfma_f32_16x16x32_bf16 a[8:11], a[160:163], v[80:83], a[8:11]
  v_exp_f32 v34, v34
  v_mfma_f32_16x16x32_bf16 a[8:11], a[164:167], v[112:115], a[8:11]
  ds_read_b64_tr_b16 a[188:189], v219 offset:24576
  v_mfma_f32_16x16x32_bf16 a[12:15], a[164:167], v[120:123], a[12:15]
  s_waitcnt lgkmcnt(7)
  v_exp_f32 v35, v35
  v_mfma_f32_16x16x32_bf16 a[12:15], a[160:163], v[88:91], a[12:15]
  ds_read_b64_tr_b16 a[190:191], v219 offset:28672
  v_cvt_pk_bf16_f32 v33, v34, v35
  v_mfma_f32_16x16x32_bf16 a[16:19], a[168:171], v[64:67], a[16:19]
  v_exp_f32 v40, v40
  v_mfma_f32_16x16x32_bf16 a[16:19], a[172:175], v[96:99], a[16:19]
  ds_read_b64_tr_b16 a[160:161], v220 offset:16384
  v_mfma_f32_16x16x32_bf16 a[20:23], a[172:175], v[104:107], a[20:23]
  v_exp_f32 v41, v41
  v_mfma_f32_16x16x32_bf16 a[20:23], a[168:171], v[72:75], a[20:23]
  ds_read_b64_tr_b16 a[162:163], v220 offset:20480
  v_cvt_pk_bf16_f32 v40, v40, v41
  v_mfma_f32_16x16x32_bf16 a[24:27], a[168:171], v[80:83], a[24:27]
  v_exp_f32 v42, v42
  v_mfma_f32_16x16x32_bf16 a[24:27], a[172:175], v[112:115], a[24:27]
  ds_read_b64_tr_b16 a[164:165], v220 offset:24576
  v_mfma_f32_16x16x32_bf16 a[28:31], a[172:175], v[120:123], a[28:31]
  s_waitcnt lgkmcnt(7)
  v_exp_f32 v43, v43
  v_mfma_f32_16x16x32_bf16 a[28:31], a[168:171], v[88:91], a[28:31]
  ds_read_b64_tr_b16 a[166:167], v220 offset:28672
  v_cvt_pk_bf16_f32 v41, v42, v43
  v_mfma_f32_16x16x32_bf16 a[32:35], a[176:179], v[64:67], a[32:35]
  v_exp_f32 v48, v48
  v_mfma_f32_16x16x32_bf16 a[32:35], a[180:183], v[96:99], a[32:35]
  ds_read_b64_tr_b16 a[168:169], v221 offset:16384
  v_mfma_f32_16x16x32_bf16 a[36:39], a[180:183], v[104:107], a[36:39]
  v_exp_f32 v49, v49
  v_mfma_f32_16x16x32_bf16 a[36:39], a[176:179], v[72:75], a[36:39]
  ds_read_b64_tr_b16 a[170:171], v221 offset:20480
  v_cvt_pk_bf16_f32 v48, v48, v49
  v_mfma_f32_16x16x32_bf16 a[40:43], a[176:179], v[80:83], a[40:43]
  v_exp_f32 v50, v50
  v_mfma_f32_16x16x32_bf16 a[40:43], a[180:183], v[112:115], a[40:43]
  ds_read_b64_tr_b16 a[172:173], v221 offset:24576
  v_mfma_f32_16x16x32_bf16 a[44:47], a[180:183], v[120:123], a[44:47]
  s_waitcnt lgkmcnt(7)
  v_exp_f32 v51, v51
  v_mfma_f32_16x16x32_bf16 a[44:47], a[176:179], v[88:91], a[44:47]
  ds_read_b64_tr_b16 a[174:175], v221 offset:28672
  v_cvt_pk_bf16_f32 v49, v50, v51
  v_mfma_f32_16x16x32_bf16 a[48:51], a[184:187], v[64:67], a[48:51]
  v_exp_f32 v56, v56
  v_mfma_f32_16x16x32_bf16 a[48:51], a[188:191], v[96:99], a[48:51]
  ds_read_b64_tr_b16 a[176:177], v222 offset:16384
  v_mfma_f32_16x16x32_bf16 a[52:55], a[188:191], v[104:107], a[52:55]
  v_exp_f32 v57, v57
  v_mfma_f32_16x16x32_bf16 a[52:55], a[184:187], v[72:75], a[52:55]
  ds_read_b64_tr_b16 a[178:179], v222 offset:20480
  v_cvt_pk_bf16_f32 v56, v56, v57
  v_mfma_f32_16x16x32_bf16 a[56:59], a[184:187], v[80:83], a[56:59]
  v_exp_f32 v58, v58
  v_mfma_f32_16x16x32_bf16 a[56:59], a[188:191], v[112:115], a[56:59]
  ds_read_b64_tr_b16 a[180:181], v222 offset:24576
  v_mfma_f32_16x16x32_bf16 a[60:63], a[188:191], v[120:123], a[60:63]
  s_waitcnt lgkmcnt(7)
  v_exp_f32 v59, v59
  v_mfma_f32_16x16x32_bf16 a[60:63], a[184:187], v[88:91], a[60:63]
  ds_read_b64_tr_b16 a[182:183], v222 offset:28672
  v_cvt_pk_bf16_f32 v57, v58, v59
  v_mfma_f32_16x16x32_bf16 a[64:67], a[160:163], v[64:67], a[64:67]
  v_exp_f32 v36, v36
  v_mfma_f32_16x16x32_bf16 a[64:67], a[164:167], v[96:99], a[64:67]
  ds_read_b64_tr_b16 a[184:185], v223 offset:16384
  v_mfma_f32_16x16x32_bf16 a[68:71], a[164:167], v[104:107], a[68:71]
  v_exp_f32 v37, v37
  v_mfma_f32_16x16x32_bf16 a[68:71], a[160:163], v[72:75], a[68:71]
  ds_read_b64_tr_b16 a[186:187], v223 offset:20480
  v_cvt_pk_bf16_f32 v34, v36, v37
  v_mfma_f32_16x16x32_bf16 a[72:75], a[160:163], v[80:83], a[72:75]
  v_exp_f32 v38, v38
  v_mfma_f32_16x16x32_bf16 a[72:75], a[164:167], v[112:115], a[72:75]
  ds_read_b64_tr_b16 a[188:189], v223 offset:24576
  v_mfma_f32_16x16x32_bf16 a[76:79], a[164:167], v[120:123], a[76:79]
  s_waitcnt lgkmcnt(7)
  v_exp_f32 v39, v39
  v_mfma_f32_16x16x32_bf16 a[76:79], a[160:163], v[88:91], a[76:79]
  ds_read_b64_tr_b16 a[190:191], v223 offset:28672
  v_cvt_pk_bf16_f32 v35, v38, v39
  v_mfma_f32_16x16x32_bf16 a[80:83], a[168:171], v[64:67], a[80:83]
  s_waitcnt vmcnt(11)
  v_exp_f32 v44, v44
  v_mfma_f32_16x16x32_bf16 a[80:83], a[172:175], v[96:99], a[80:83]
  v_mfma_f32_16x16x32_bf16 a[84:87], a[172:175], v[104:107], a[84:87]
  s_barrier
  v_exp_f32 v45, v45
  v_mfma_f32_16x16x32_bf16 a[84:87], a[168:171], v[72:75], a[84:87]
  ds_read_b128 a[128:131], v212 offset:49152
  v_cvt_pk_bf16_f32 v42, v44, v45
  v_mfma_f32_16x16x32_bf16 a[88:91], a[168:171], v[80:83], a[88:91]
  v_exp_f32 v46, v46
  v_mfma_f32_16x16x32_bf16 a[88:91], a[172:175], v[112:115], a[88:91]
  ds_read_b128 a[132:135], v213 offset:49152
  v_mfma_f32_16x16x32_bf16 a[92:95], a[172:175], v[120:123], a[92:95]
  s_waitcnt lgkmcnt(6)
  v_exp_f32 v47, v47
  v_mfma_f32_16x16x32_bf16 a[92:95], a[168:171], v[88:91], a[92:95]
  ds_read_b128 a[136:139], v214 offset:49152
  v_cvt_pk_bf16_f32 v43, v46, v47
  v_mfma_f32_16x16x32_bf16 a[96:99], a[176:179], v[64:67], a[96:99]
  v_exp_f32 v52, v52
  v_mfma_f32_16x16x32_bf16 a[96:99], a[180:183], v[96:99], a[96:99]
  ds_read_b128 a[140:143], v215 offset:49152
  buffer_load_dwordx4 a[216:219], v243, s[24:27], s38 offen sc1
  s_add_u32 s38, s38, 4096
  v_mfma_f32_16x16x32_bf16 a[100:103], a[180:183], v[104:107], a[100:103]
  v_exp_f32 v53, v53
  v_mfma_f32_16x16x32_bf16 a[100:103], a[176:179], v[72:75], a[100:103]
  v_cvt_pk_bf16_f32 v50, v52, v53
  v_mfma_f32_16x16x32_bf16 a[104:107], a[176:179], v[80:83], a[104:107]
  v_exp_f32 v54, v54
  v_mfma_f32_16x16x32_bf16 a[104:107], a[180:183], v[112:115], a[104:107]
  v_mfma_f32_16x16x32_bf16 a[108:111], a[180:183], v[120:123], a[108:111]
  s_waitcnt lgkmcnt(4)
  v_exp_f32 v55, v55
  v_mfma_f32_16x16x32_bf16 a[108:111], a[176:179], v[88:91], a[108:111]
  v_cvt_pk_bf16_f32 v51, v54, v55
  v_mfma_f32_16x16x32_bf16 a[112:115], a[184:187], v[64:67], a[112:115]
  v_exp_f32 v60, v60
  v_mfma_f32_16x16x32_bf16 a[112:115], a[188:191], v[96:99], a[112:115]
  v_mfma_f32_16x16x32_bf16 a[116:119], a[188:191], v[104:107], a[116:119]
  v_exp_f32 v61, v61
  v_mfma_f32_16x16x32_bf16 a[116:119], a[184:187], v[72:75], a[116:119]
  v_cvt_pk_bf16_f32 v58, v60, v61
  v_mfma_f32_16x16x32_bf16 a[120:123], a[184:187], v[80:83], a[120:123]
  v_exp_f32 v62, v62
  v_mfma_f32_16x16x32_bf16 a[120:123], a[188:191], v[112:115], a[120:123]
  v_mfma_f32_16x16x32_bf16 a[124:127], a[188:191], v[120:123], a[124:127]
  s_waitcnt lgkmcnt(0)
  v_exp_f32 v63, v63
  v_mfma_f32_16x16x32_bf16 a[124:127], a[184:187], v[88:91], a[124:127]
  v_cvt_pk_bf16_f32 v59, v62, v63
  v_mfma_f32_16x16x32_bf16 v[64:67], a[128:131], v[128:131], v[192:195]
  s_add_u32 m0, s28, 65536
  v_mfma_f32_16x16x32_bf16 v[64:67], a[132:135], v[132:135], v[64:67]
  ds_read_b128 a[144:147], v212 offset:53248
  v_mfma_f32_16x16x32_bf16 v[64:67], a[136:139], v[136:139], v[64:67]
  buffer_load_dwordx4 v236, s[16:19], s29 offen offset:0 lds
  v_mfma_f32_16x16x32_bf16 v[64:67], a[140:143], v[140:143], v[64:67]
  ds_read_b128 a[148:151], v213 offset:53248
  v_mfma_f32_16x16x32_bf16 v[72:75], a[140:143], v[156:159], v[196:199]
  v_mfma_f32_16x16x32_bf16 v[72:75], a[136:139], v[152:155], v[72:75]
  ds_read_b128 a[152:155], v214 offset:53248
  v_mfma_f32_16x16x32_bf16 v[72:75], a[132:135], v[148:151], v[72:75]
  buffer_load_dwordx4 v237, s[16:19], s29 offen offset:1024 lds
  v_mfma_f32_16x16x32_bf16 v[72:75], a[128:131], v[144:147], v[72:75]
  ds_read_b128 a[156:159], v215 offset:53248
  v_mfma_f32_16x16x32_bf16 v[80:83], a[128:131], v[160:163], v[200:203]
  v_exp_f32 v64, v64
  v_mfma_f32_16x16x32_bf16 v[80:83], a[132:135], v[164:167], v[80:83]
  v_mfma_f32_16x16x32_bf16 v[80:83], a[136:139], v[168:171], v[80:83]
  v_exp_f32 v65, v65
  v_mfma_f32_16x16x32_bf16 v[80:83], a[140:143], v[172:175], v[80:83]
  v_cvt_pk_bf16_f32 v64, v64, v65
  v_mfma_f32_16x16x32_bf16 v[88:91], a[140:143], v[188:191], v[204:207]
  v_exp_f32 v66, v66
  v_mfma_f32_16x16x32_bf16 v[88:91], a[136:139], v[184:187], v[88:91]
  buffer_load_dwordx4 v236, s[16:19], s29 offen offset:2048 lds
  v_mfma_f32_16x16x32_bf16 v[88:91], a[132:135], v[180:183], v[88:91]
  s_waitcnt lgkmcnt(0)
  v_exp_f32 v67, v67
  v_mfma_f32_16x16x32_bf16 v[88:91], a[128:131], v[176:179], v[88:91]
  v_cvt_pk_bf16_f32 v65, v66, v67
  v_mfma_f32_16x16x32_bf16 v[68:71], a[144:147], v[128:131], v[192:195]
  v_exp_f32 v72, v72
  v_mfma_f32_16x16x32_bf16 v[68:71], a[148:151], v[132:135], v[68:71]
  ds_read_b128 a[128:131], v212 offset:57344
  v_mfma_f32_16x16x32_bf16 v[68:71], a[152:155], v[136:139], v[68:71]
  v_exp_f32 v73, v73
  v_mfma_f32_16x16x32_bf16 v[68:71], a[156:159], v[140:143], v[68:71]
  ds_read_b128 a[132:135], v213 offset:57344
  v_cvt_pk_bf16_f32 v72, v72, v73
  v_mfma_f32_16x16x32_bf16 v[76:79], a[156:159], v[156:159], v[196:199]
  v_exp_f32 v74, v74
  v_mfma_f32_16x16x32_bf16 v[76:79], a[152:155], v[152:155], v[76:79]
  ds_read_b128 a[136:139], v214 offset:57344
  v_mfma_f32_16x16x32_bf16 v[76:79], a[148:151], v[148:151], v[76:79]
  v_exp_f32 v75, v75
  v_mfma_f32_16x16x32_bf16 v[76:79], a[144:147], v[144:147], v[76:79]
  ds_read_b128 a[140:143], v215 offset:57344
  v_cvt_pk_bf16_f32 v73, v74, v75
  v_mfma_f32_16x16x32_bf16 v[84:87], a[144:147], v[160:163], v[200:203]
  v_exp_f32 v80, v80
  v_mfma_f32_16x16x32_bf16 v[84:87], a[148:151], v[164:167], v[84:87]
  buffer_load_dwordx4 v237, s[16:19], s29 offen offset:3072 lds
  v_mfma_f32_16x16x32_bf16 v[84:87], a[152:155], v[168:171], v[84:87]
  s_add_u32 s29, s29, 16384
  v_exp_f32 v81, v81
  v_mfma_f32_16x16x32_bf16 v[84:87], a[156:159], v[172:175], v[84:87]
  v_cvt_pk_bf16_f32 v80, v80, v81
  v_mfma_f32_16x16x32_bf16 v[92:95], a[156:159], v[188:191], v[204:207]
  s_add_u32 m0, s28, 16384
  v_exp_f32 v82, v82
  v_mfma_f32_16x16x32_bf16 v[92:95], a[152:155], v[184:187], v[92:95]
  buffer_load_dwordx4 v232, s[12:15], s29 offen offset:0 lds
  v_mfma_f32_16x16x32_bf16 v[92:95], a[148:151], v[180:183], v[92:95]
  s_waitcnt lgkmcnt(0)
  v_exp_f32 v83, v83
  v_mfma_f32_16x16x32_bf16 v[92:95], a[144:147], v[176:179], v[92:95]
  v_cvt_pk_bf16_f32 v81, v82, v83
  v_mfma_f32_16x16x32_bf16 v[96:99], a[128:131], v[128:131], v[192:195]
  v_exp_f32 v88, v88
  v_mfma_f32_16x16x32_bf16 v[96:99], a[132:135], v[132:135], v[96:99]
  ds_read_b128 a[144:147], v212 offset:61440
  v_mfma_f32_16x16x32_bf16 v[96:99], a[136:139], v[136:139], v[96:99]
  v_exp_f32 v89, v89
  v_mfma_f32_16x16x32_bf16 v[96:99], a[140:143], v[140:143], v[96:99]
  ds_read_b128 a[148:151], v213 offset:61440
  v_cvt_pk_bf16_f32 v88, v88, v89
  v_mfma_f32_16x16x32_bf16 v[104:107], a[140:143], v[156:159], v[196:199]
  v_exp_f32 v90, v90
  v_mfma_f32_16x16x32_bf16 v[104:107], a[136:139], v[152:155], v[104:107]
  ds_read_b128 a[152:155], v214 offset:61440
  v_mfma_f32_16x16x32_bf16 v[104:107], a[132:135], v[148:151], v[104:107]
  v_exp_f32 v91, v91
  v_mfma_f32_16x16x32_bf16 v[104:107], a[128:131], v[144:147], v[104:107]
  ds_read_b128 a[156:159], v215 offset:61440
  v_cvt_pk_bf16_f32 v89, v90, v91
  v_mfma_f32_16x16x32_bf16 v[112:115], a[128:131], v[160:163], v[200:203]
  v_exp_f32 v68, v68
  v_mfma_f32_16x16x32_bf16 v[112:115], a[132:135], v[164:167], v[112:115]
  buffer_load_dwordx4 v233, s[12:15], s29 offen offset:1024 lds
  v_mfma_f32_16x16x32_bf16 v[112:115], a[136:139], v[168:171], v[112:115]
  v_exp_f32 v69, v69
  v_mfma_f32_16x16x32_bf16 v[112:115], a[140:143], v[172:175], v[112:115]
  v_cvt_pk_bf16_f32 v66, v68, v69
  v_mfma_f32_16x16x32_bf16 v[120:123], a[140:143], v[188:191], v[204:207]
  v_exp_f32 v70, v70
  v_mfma_f32_16x16x32_bf16 v[120:123], a[136:139], v[184:187], v[120:123]
  buffer_load_dwordx4 v234, s[12:15], s29 offen offset:2048 lds
  v_mfma_f32_16x16x32_bf16 v[120:123], a[132:135], v[180:183], v[120:123]
  s_waitcnt lgkmcnt(0)
  v_exp_f32 v71, v71
  v_mfma_f32_16x16x32_bf16 v[120:123], a[128:131], v[176:179], v[120:123]
  v_cvt_pk_bf16_f32 v67, v70, v71
  v_mfma_f32_16x16x32_bf16 v[100:103], a[144:147], v[128:131], v[192:195]
  v_exp_f32 v76, v76
  v_mfma_f32_16x16x32_bf16 v[100:103], a[148:151], v[132:135], v[100:103]
  ds_read_b64_tr_b16 a[160:161], v216 offset:32768
  v_mfma_f32_16x16x32_bf16 v[100:103], a[152:155], v[136:139], v[100:103]
  v_exp_f32 v77, v77
  v_mfma_f32_16x16x32_bf16 v[100:103], a[156:159], v[140:143], v[100:103]
  ds_read_b64_tr_b16 a[162:163], v216 offset:36864
  v_cvt_pk_bf16_f32 v74, v76, v77
  v_mfma_f32_16x16x32_bf16 v[108:111], a[156:159], v[156:159], v[196:199]
  v_exp_f32 v78, v78
  v_mfma_f32_16x16x32_bf16 v[108:111], a[152:155], v[152:155], v[108:111]
  ds_read_b64_tr_b16 a[164:165], v216 offset:40960
  buffer_load_dwordx4 v235, s[12:15], s29 offen offset:3072 lds
  v_mfma_f32_16x16x32_bf16 v[108:111], a[148:151], v[148:151], v[108:111]
  v_exp_f32 v79, v79
  v_mfma_f32_16x16x32_bf16 v[108:111], a[144:147], v[144:147], v[108:111]
  ds_read_b64_tr_b16 a[166:167], v216 offset:45056
  v_cvt_pk_bf16_f32 v75, v78, v79
  v_mfma_f32_16x16x32_bf16 v[116:119], a[144:147], v[160:163], v[200:203]
  v_exp_f32 v84, v84
  v_mfma_f32_16x16x32_bf16 v[116:119], a[148:151], v[164:167], v[116:119]
  ds_read_b64_tr_b16 a[168:169], v217 offset:32768
  s_add_u32 m0, s50, 4096
  v_mfma_f32_16x16x32_bf16 v[116:119], a[152:155], v[168:171], v[116:119]
  v_exp_f32 v85, v85
  v_mfma_f32_16x16x32_bf16 v[116:119], a[156:159], v[172:175], v[116:119]
  ds_read_b64_tr_b16 a[170:171], v217 offset:36864
  v_cvt_pk_bf16_f32 v82, v84, v85
  v_mfma_f32_16x16x32_bf16 v[124:127], a[156:159], v[188:191], v[204:207]
  v_exp_f32 v86, v86
  v_mfma_f32_16x16x32_bf16 v[124:127], a[152:155], v[184:187], v[124:127]
  ds_read_b64_tr_b16 a[172:173], v217 offset:40960
  buffer_load_dwordx4 v253, s[44:47], s35 offen lds
  s_add_u32 s35, s35, 221184
  v_mfma_f32_16x16x32_bf16 v[124:127], a[148:151], v[180:183], v[124:127]
  v_exp_f32 v87, v87
  v_mfma_f32_16x16x32_bf16 v[124:127], a[144:147], v[176:179], v[124:127]
  ds_read_b64_tr_b16 a[174:175], v217 offset:45056
  v_cvt_pk_bf16_f32 v83, v86, v87
  v_mfma_f32_16x16x32_bf16 a[192:195], a[208:211], v[0:3], a[192:195]
  v_exp_f32 v92, v92
  v_mfma_f32_16x16x32_bf16 a[192:195], a[208:211], v[32:35], a[192:195]
  ds_read_b64_tr_b16 a[176:177], v218 offset:32768
  v_lshrrev_b32 v254, 4, v242
  v_mfma_f32_16x16x32_bf16 a[196:199], a[208:211], v[8:11], a[196:199]
  v_exp_f32 v93, v93
  v_mfma_f32_16x16x32_bf16 a[196:199], a[208:211], v[40:43], a[196:199]
  ds_read_b64_tr_b16 a[178:179], v218 offset:36864
  v_cvt_pk_bf16_f32 v90, v92, v93
  v_mfma_f32_16x16x32_bf16 a[200:203], a[208:211], v[16:19], a[200:203]
  v_exp_f32 v94, v94
  v_mfma_f32_16x16x32_bf16 a[200:203], a[208:211], v[48:51], a[200:203]
  ds_read_b64_tr_b16 a[180:181], v218 offset:40960
  v_lshrrev_b32 v254, 5, v254
  v_mfma_f32_16x16x32_bf16 a[204:207], a[208:211], v[24:27], a[204:207]
  s_waitcnt lgkmcnt(7)
  v_exp_f32 v95, v95
  v_mfma_f32_16x16x32_bf16 a[204:207], a[208:211], v[56:59], a[204:207]
  ds_read_b64_tr_b16 a[182:183], v218 offset:45056
  v_cvt_pk_bf16_f32 v91, v94, v95
  v_mfma_f32_16x16x32_bf16 a[0:3], a[160:163], v[0:3], a[0:3]
  v_exp_f32 v96, v96
  v_mfma_f32_16x16x32_bf16 a[0:3], a[164:167], v[32:35], a[0:3]
  ds_read_b64_tr_b16 a[184:185], v219 offset:32768
  v_lshl_add_u32 v253, v254, 30, v253
  v_mfma_f32_16x16x32_bf16 a[4:7], a[164:167], v[40:43], a[4:7]
  v_exp_f32 v97, v97
  v_mfma_f32_16x16x32_bf16 a[4:7], a[160:163], v[8:11], a[4:7]
  ds_read_b64_tr_b16 a[186:187], v219 offset:36864
  v_cvt_pk_bf16_f32 v96, v96, v97
  v_mfma_f32_16x16x32_bf16 a[8:11], a[160:163], v[16:19], a[8:11]
  v_exp_f32 v98, v98
  v_mfma_f32_16x16x32_bf16 a[8:11], a[164:167], v[48:51], a[8:11]
  ds_read_b64_tr_b16 a[188:189], v219 offset:40960
  v_mfma_f32_16x16x32_bf16 a[12:15], a[164:167], v[56:59], a[12:15]
  s_waitcnt lgkmcnt(7)
  v_exp_f32 v99, v99
  v_mfma_f32_16x16x32_bf16 a[12:15], a[160:163], v[24:27], a[12:15]
  ds_read_b64_tr_b16 a[190:191], v219 offset:45056
  v_cvt_pk_bf16_f32 v97, v98, v99
  v_mfma_f32_16x16x32_bf16 a[16:19], a[168:171], v[0:3], a[16:19]
  v_exp_f32 v104, v104
  v_mfma_f32_16x16x32_bf16 a[16:19], a[172:175], v[32:35], a[16:19]
  ds_read_b64_tr_b16 a[160:161], v220 offset:32768
  v_mfma_f32_16x16x32_bf16 a[20:23], a[172:175], v[40:43], a[20:23]
  v_exp_f32 v105, v105
  v_mfma_f32_16x16x32_bf16 a[20:23], a[168:171], v[8:11], a[20:23]
  ds_read_b64_tr_b16 a[162:163], v220 offset:36864
  v_cvt_pk_bf16_f32 v104, v104, v105
  v_mfma_f32_16x16x32_bf16 a[24:27], a[168:171], v[16:19], a[24:27]
  v_exp_f32 v106, v106
  v_mfma_f32_16x16x32_bf16 a[24:27], a[172:175], v[48:51], a[24:27]
  ds_read_b64_tr_b16 a[164:165], v220 offset:40960
  v_mfma_f32_16x16x32_bf16 a[28:31], a[172:175], v[56:59], a[28:31]
  s_waitcnt lgkmcnt(7)
  v_exp_f32 v107, v107
  v_mfma_f32_16x16x32_bf16 a[28:31], a[168:171], v[24:27], a[28:31]
  ds_read_b64_tr_b16 a[166:167], v220 offset:45056
  v_cvt_pk_bf16_f32 v105, v106, v107
  v_mfma_f32_16x16x32_bf16 a[32:35], a[176:179], v[0:3], a[32:35]
  v_exp_f32 v112, v112
  v_mfma_f32_16x16x32_bf16 a[32:35], a[180:183], v[32:35], a[32:35]
  ds_read_b64_tr_b16 a[168:169], v221 offset:32768
  v_mfma_f32_16x16x32_bf16 a[36:39], a[180:183], v[40:43], a[36:39]
  v_exp_f32 v113, v113
  v_mfma_f32_16x16x32_bf16 a[36:39], a[176:179], v[8:11], a[36:39]
  ds_read_b64_tr_b16 a[170:171], v221 offset:36864
  v_cvt_pk_bf16_f32 v112, v112, v113
  v_mfma_f32_16x16x32_bf16 a[40:43], a[176:179], v[16:19], a[40:43]
  v_exp_f32 v114, v114
  v_mfma_f32_16x16x32_bf16 a[40:43], a[180:183], v[48:51], a[40:43]
  ds_read_b64_tr_b16 a[172:173], v221 offset:40960
  v_mfma_f32_16x16x32_bf16 a[44:47], a[180:183], v[56:59], a[44:47]
  s_waitcnt lgkmcnt(7)
  v_exp_f32 v115, v115
  v_mfma_f32_16x16x32_bf16 a[44:47], a[176:179], v[24:27], a[44:47]
  ds_read_b64_tr_b16 a[174:175], v221 offset:45056
  v_cvt_pk_bf16_f32 v113, v114, v115
  v_mfma_f32_16x16x32_bf16 a[48:51], a[184:187], v[0:3], a[48:51]
  v_exp_f32 v120, v120
  v_mfma_f32_16x16x32_bf16 a[48:51], a[188:191], v[32:35], a[48:51]
  ds_read_b64_tr_b16 a[176:177], v222 offset:32768
  v_mfma_f32_16x16x32_bf16 a[52:55], a[188:191], v[40:43], a[52:55]
  v_exp_f32 v121, v121
  v_mfma_f32_16x16x32_bf16 a[52:55], a[184:187], v[8:11], a[52:55]
  ds_read_b64_tr_b16 a[178:179], v222 offset:36864
  v_cvt_pk_bf16_f32 v120, v120, v121
  v_mfma_f32_16x16x32_bf16 a[56:59], a[184:187], v[16:19], a[56:59]
  v_exp_f32 v122, v122
  v_mfma_f32_16x16x32_bf16 a[56:59], a[188:191], v[48:51], a[56:59]
  ds_read_b64_tr_b16 a[180:181], v222 offset:40960
  v_mfma_f32_16x16x32_bf16 a[60:63], a[188:191], v[56:59], a[60:63]
  s_waitcnt lgkmcnt(7)
  v_exp_f32 v123, v123
  v_mfma_f32_16x16x32_bf16 a[60:63], a[184:187], v[24:27], a[60:63]
  ds_read_b64_tr_b16 a[182:183], v222 offset:45056
  v_cvt_pk_bf16_f32 v121, v122, v123
  v_mfma_f32_16x16x32_bf16 a[64:67], a[160:163], v[0:3], a[64:67]
  v_exp_f32 v100, v100
  v_mfma_f32_16x16x32_bf16 a[64:67], a[164:167], v[32:35], a[64:67]
  ds_read_b64_tr_b16 a[184:185], v223 offset:32768
  v_mfma_f32_16x16x32_bf16 a[68:71], a[164:167], v[40:43], a[68:71]
  v_exp_f32 v101, v101
  v_mfma_f32_16x16x32_bf16 a[68:71], a[160:163], v[8:11], a[68:71]
  ds_read_b64_tr_b16 a[186:187], v223 offset:36864
  v_cvt_pk_bf16_f32 v98, v100, v101
  v_mfma_f32_16x16x32_bf16 a[72:75], a[160:163], v[16:19], a[72:75]
  v_exp_f32 v102, v102
  v_mfma_f32_16x16x32_bf16 a[72:75], a[164:167], v[48:51], a[72:75]
  ds_read_b64_tr_b16 a[188:189], v223 offset:40960
  v_mfma_f32_16x16x32_bf16 a[76:79], a[164:167], v[56:59], a[76:79]
  s_waitcnt lgkmcnt(7)
  v_exp_f32 v103, v103
  v_mfma_f32_16x16x32_bf16 a[76:79], a[160:163], v[24:27], a[76:79]
  ds_read_b64_tr_b16 a[190:191], v223 offset:45056
  v_cvt_pk_bf16_f32 v99, v102, v103
  v_mfma_f32_16x16x32_bf16 a[80:83], a[168:171], v[0:3], a[80:83]
  s_waitcnt vmcnt(11)
  v_exp_f32 v108, v108
  v_mfma_f32_16x16x32_bf16 a[80:83], a[172:175], v[32:35], a[80:83]
  v_mfma_f32_16x16x32_bf16 a[84:87], a[172:175], v[40:43], a[84:87]
  s_barrier
  v_exp_f32 v109, v109
  v_mfma_f32_16x16x32_bf16 a[84:87], a[168:171], v[8:11], a[84:87]
  ds_read_b128 a[128:131], v212 offset:0
  v_cvt_pk_bf16_f32 v106, v108, v109
  v_mfma_f32_16x16x32_bf16 a[88:91], a[168:171], v[16:19], a[88:91]
  v_exp_f32 v110, v110
  v_mfma_f32_16x16x32_bf16 a[88:91], a[172:175], v[48:51], a[88:91]
  ds_read_b128 a[132:135], v213 offset:0
  v_mfma_f32_16x16x32_bf16 a[92:95], a[172:175], v[56:59], a[92:95]
  s_waitcnt lgkmcnt(6)
  v_exp_f32 v111, v111
  v_mfma_f32_16x16x32_bf16 a[92:95], a[168:171], v[24:27], a[92:95]
  ds_read_b128 a[136:139], v214 offset:0
  v_cvt_pk_bf16_f32 v107, v110, v111
  v_mfma_f32_16x16x32_bf16 a[96:99], a[176:179], v[0:3], a[96:99]
  v_exp_f32 v116, v116
  v_mfma_f32_16x16x32_bf16 a[96:99], a[180:183], v[32:35], a[96:99]
  ds_read_b128 a[140:143], v215 offset:0
  buffer_load_dwordx4 a[220:223], v243, s[24:27], s38 offen sc1
  s_add_u32 s38, s38, 4096
  v_mfma_f32_16x16x32_bf16 a[100:103], a[180:183], v[40:43], a[100:103]
  v_exp_f32 v117, v117
  v_mfma_f32_16x16x32_bf16 a[100:103], a[176:179], v[8:11], a[100:103]
  v_cvt_pk_bf16_f32 v114, v116, v117
  v_mfma_f32_16x16x32_bf16 a[104:107], a[176:179], v[16:19], a[104:107]
  v_exp_f32 v118, v118
  v_mfma_f32_16x16x32_bf16 a[104:107], a[180:183], v[48:51], a[104:107]
  v_mfma_f32_16x16x32_bf16 a[108:111], a[180:183], v[56:59], a[108:111]
  s_waitcnt lgkmcnt(4)
  v_exp_f32 v119, v119
  v_mfma_f32_16x16x32_bf16 a[108:111], a[176:179], v[24:27], a[108:111]
  v_cvt_pk_bf16_f32 v115, v118, v119
  v_mfma_f32_16x16x32_bf16 a[112:115], a[184:187], v[0:3], a[112:115]
  v_exp_f32 v124, v124
  v_mfma_f32_16x16x32_bf16 a[112:115], a[188:191], v[32:35], a[112:115]
  v_mfma_f32_16x16x32_bf16 a[116:119], a[188:191], v[40:43], a[116:119]
  v_exp_f32 v125, v125
  v_mfma_f32_16x16x32_bf16 a[116:119], a[184:187], v[8:11], a[116:119]
  v_cvt_pk_bf16_f32 v122, v124, v125
  v_mfma_f32_16x16x32_bf16 a[120:123], a[184:187], v[16:19], a[120:123]
  v_exp_f32 v126, v126
  v_mfma_f32_16x16x32_bf16 a[120:123], a[188:191], v[48:51], a[120:123]
  v_mfma_f32_16x16x32_bf16 a[124:127], a[188:191], v[56:59], a[124:127]
  s_waitcnt lgkmcnt(0)
  v_exp_f32 v127, v127
  v_mfma_f32_16x16x32_bf16 a[124:127], a[184:187], v[24:27], a[124:127]
  v_cvt_pk_bf16_f32 v123, v126, v127
  v_mfma_f32_16x16x32_bf16 v[0:3], a[128:131], v[128:131], v[192:195]
  s_add_u32 m0, s28, 81920
  v_mfma_f32_16x16x32_bf16 v[0:3], a[132:135], v[132:135], v[0:3]
  ds_read_b128 a[144:147], v212 offset:4096
  v_mfma_f32_16x16x32_bf16 v[0:3], a[136:139], v[136:139], v[0:3]
  buffer_load_dwordx4 v236, s[16:19], s29 offen offset:0 lds
  v_mfma_f32_16x16x32_bf16 v[0:3], a[140:143], v[140:143], v[0:3]
  ds_read_b128 a[148:151], v213 offset:4096
  v_mfma_f32_16x16x32_bf16 v[8:11], a[140:143], v[156:159], v[196:199]
  v_mfma_f32_16x16x32_bf16 v[8:11], a[136:139], v[152:155], v[8:11]
  ds_read_b128 a[152:155], v214 offset:4096
  v_mfma_f32_16x16x32_bf16 v[8:11], a[132:135], v[148:151], v[8:11]
  buffer_load_dwordx4 v237, s[16:19], s29 offen offset:1024 lds
  v_mfma_f32_16x16x32_bf16 v[8:11], a[128:131], v[144:147], v[8:11]
  ds_read_b128 a[156:159], v215 offset:4096
  v_mfma_f32_16x16x32_bf16 v[16:19], a[128:131], v[160:163], v[200:203]
  v_exp_f32 v0, v0
  v_mfma_f32_16x16x32_bf16 v[16:19], a[132:135], v[164:167], v[16:19]
  v_mfma_f32_16x16x32_bf16 v[16:19], a[136:139], v[168:171], v[16:19]
  v_exp_f32 v1, v1
  v_mfma_f32_16x16x32_bf16 v[16:19], a[140:143], v[172:175], v[16:19]
  v_cvt_pk_bf16_f32 v0, v0, v1
  v_mfma_f32_16x16x32_bf16 v[24:27], a[140:143], v[188:191], v[204:207]
  v_exp_f32 v2, v2
  v_mfma_f32_16x16x32_bf16 v[24:27], a[136:139], v[184:187], v[24:27]
  buffer_load_dwordx4 v236, s[16:19], s29 offen offset:2048 lds
  v_mfma_f32_16x16x32_bf16 v[24:27], a[132:135], v[180:183], v[24:27]
  s_waitcnt lgkmcnt(0)
  v_exp_f32 v3, v3
  v_mfma_f32_16x16x32_bf16 v[24:27], a[128:131], v[176:179], v[24:27]
  v_cvt_pk_bf16_f32 v1, v2, v3
  v_mfma_f32_16x16x32_bf16 v[4:7], a[144:147], v[128:131], v[192:195]
  v_exp_f32 v8, v8
  v_mfma_f32_16x16x32_bf16 v[4:7], a[148:151], v[132:135], v[4:7]
  ds_read_b128 a[128:131], v212 offset:8192
  v_mfma_f32_16x16x32_bf16 v[4:7], a[152:155], v[136:139], v[4:7]
  v_exp_f32 v9, v9
  v_mfma_f32_16x16x32_bf16 v[4:7], a[156:159], v[140:143], v[4:7]
  ds_read_b128 a[132:135], v213 offset:8192
  v_cvt_pk_bf16_f32 v8, v8, v9
  v_mfma_f32_16x16x32_bf16 v[12:15], a[156:159], v[156:159], v[196:199]
  v_exp_f32 v10, v10
  v_mfma_f32_16x16x32_bf16 v[12:15], a[152:155], v[152:155], v[12:15]
  ds_read_b128 a[136:139], v214 offset:8192
  v_mfma_f32_16x16x32_bf16 v[12:15], a[148:151], v[148:151], v[12:15]
  v_exp_f32 v11, v11
  v_mfma_f32_16x16x32_bf16 v[12:15], a[144:147], v[144:147], v[12:15]
  ds_read_b128 a[140:143], v215 offset:8192
  v_cvt_pk_bf16_f32 v9, v10, v11
  v_mfma_f32_16x16x32_bf16 v[20:23], a[144:147], v[160:163], v[200:203]
  v_exp_f32 v16, v16
  v_mfma_f32_16x16x32_bf16 v[20:23], a[148:151], v[164:167], v[20:23]
  buffer_load_dwordx4 v237, s[16:19], s29 offen offset:3072 lds
  v_mfma_f32_16x16x32_bf16 v[20:23], a[152:155], v[168:171], v[20:23]
  s_add_u32 s29, s29, 16384
  v_exp_f32 v17, v17
  v_mfma_f32_16x16x32_bf16 v[20:23], a[156:159], v[172:175], v[20:23]
  v_cvt_pk_bf16_f32 v16, v16, v17
  v_mfma_f32_16x16x32_bf16 v[28:31], a[156:159], v[188:191], v[204:207]
  s_add_u32 m0, s28, 32768
  v_exp_f32 v18, v18
  v_mfma_f32_16x16x32_bf16 v[28:31], a[152:155], v[184:187], v[28:31]
  buffer_load_dwordx4 v232, s[12:15], s29 offen offset:0 lds
  v_mfma_f32_16x16x32_bf16 v[28:31], a[148:151], v[180:183], v[28:31]
  s_waitcnt lgkmcnt(0)
  v_exp_f32 v19, v19
  v_mfma_f32_16x16x32_bf16 v[28:31], a[144:147], v[176:179], v[28:31]
  v_cvt_pk_bf16_f32 v17, v18, v19
  v_mfma_f32_16x16x32_bf16 v[32:35], a[128:131], v[128:131], v[192:195]
  v_exp_f32 v24, v24
  v_mfma_f32_16x16x32_bf16 v[32:35], a[132:135], v[132:135], v[32:35]
  ds_read_b128 a[144:147], v212 offset:12288
  v_mfma_f32_16x16x32_bf16 v[32:35], a[136:139], v[136:139], v[32:35]
  v_exp_f32 v25, v25
  v_mfma_f32_16x16x32_bf16 v[32:35], a[140:143], v[140:143], v[32:35]
  ds_read_b128 a[148:151], v213 offset:12288
  v_cvt_pk_bf16_f32 v24, v24, v25
  v_mfma_f32_16x16x32_bf16 v[40:43], a[140:143], v[156:159], v[196:199]
  v_exp_f32 v26, v26
  v_mfma_f32_16x16x32_bf16 v[40:43], a[136:139], v[152:155], v[40:43]
  ds_read_b128 a[152:155], v214 offset:12288
  v_mfma_f32_16x16x32_bf16 v[40:43], a[132:135], v[148:151], v[40:43]
  v_exp_f32 v27, v27
  v_mfma_f32_16x16x32_bf16 v[40:43], a[128:131], v[144:147], v[40:43]
  ds_read_b128 a[156:159], v215 offset:12288
  v_cvt_pk_bf16_f32 v25, v26, v27
  v_mfma_f32_16x16x32_bf16 v[48:51], a[128:131], v[160:163], v[200:203]
  v_exp_f32 v4, v4
  v_mfma_f32_16x16x32_bf16 v[48:51], a[132:135], v[164:167], v[48:51]
  buffer_load_dwordx4 v233, s[12:15], s29 offen offset:1024 lds
  v_mfma_f32_16x16x32_bf16 v[48:51], a[136:139], v[168:171], v[48:51]
  v_exp_f32 v5, v5
  v_mfma_f32_16x16x32_bf16 v[48:51], a[140:143], v[172:175], v[48:51]
  v_cvt_pk_bf16_f32 v2, v4, v5
  v_mfma_f32_16x16x32_bf16 v[56:59], a[140:143], v[188:191], v[204:207]
  v_exp_f32 v6, v6
  v_mfma_f32_16x16x32_bf16 v[56:59], a[136:139], v[184:187], v[56:59]
  buffer_load_dwordx4 v234, s[12:15], s29 offen offset:2048 lds
  v_mfma_f32_16x16x32_bf16 v[56:59], a[132:135], v[180:183], v[56:59]
  s_waitcnt lgkmcnt(0)
  v_exp_f32 v7, v7
  v_mfma_f32_16x16x32_bf16 v[56:59], a[128:131], v[176:179], v[56:59]
  v_cvt_pk_bf16_f32 v3, v6, v7
  v_mfma_f32_16x16x32_bf16 v[36:39], a[144:147], v[128:131], v[192:195]
  v_exp_f32 v12, v12
  v_mfma_f32_16x16x32_bf16 v[36:39], a[148:151], v[132:135], v[36:39]
  ds_read_b64_tr_b16 a[160:161], v216 offset:49152
  v_mfma_f32_16x16x32_bf16 v[36:39], a[152:155], v[136:139], v[36:39]
  v_exp_f32 v13, v13
  v_mfma_f32_16x16x32_bf16 v[36:39], a[156:159], v[140:143], v[36:39]
  ds_read_b64_tr_b16 a[162:163], v216 offset:53248
  v_cvt_pk_bf16_f32 v10, v12, v13
  v_mfma_f32_16x16x32_bf16 v[44:47], a[156:159], v[156:159], v[196:199]
  v_exp_f32 v14, v14
  v_mfma_f32_16x16x32_bf16 v[44:47], a[152:155], v[152:155], v[44:47]
  ds_read_b64_tr_b16 a[164:165], v216 offset:57344
  buffer_load_dwordx4 v235, s[12:15], s29 offen offset:3072 lds
  v_mfma_f32_16x16x32_bf16 v[44:47], a[148:151], v[148:151], v[44:47]
  v_exp_f32 v15, v15
  v_mfma_f32_16x16x32_bf16 v[44:47], a[144:147], v[144:147], v[44:47]
  ds_read_b64_tr_b16 a[166:167], v216 offset:61440
  v_cvt_pk_bf16_f32 v11, v14, v15
  v_mfma_f32_16x16x32_bf16 v[52:55], a[144:147], v[160:163], v[200:203]
  v_exp_f32 v20, v20
  v_mfma_f32_16x16x32_bf16 v[52:55], a[148:151], v[164:167], v[52:55]
  ds_read_b64_tr_b16 a[168:169], v217 offset:49152
  s_add_u32 m0, s50, 2048
  v_mfma_f32_16x16x32_bf16 v[52:55], a[152:155], v[168:171], v[52:55]
  v_exp_f32 v21, v21
  v_mfma_f32_16x16x32_bf16 v[52:55], a[156:159], v[172:175], v[52:55]
  ds_read_b64_tr_b16 a[170:171], v217 offset:53248
  v_cvt_pk_bf16_f32 v18, v20, v21
  v_mfma_f32_16x16x32_bf16 v[60:63], a[156:159], v[188:191], v[204:207]
  v_exp_f32 v22, v22
  v_mfma_f32_16x16x32_bf16 v[60:63], a[152:155], v[184:187], v[60:63]
  ds_read_b64_tr_b16 a[172:173], v217 offset:57344
  buffer_load_dwordx4 v253, s[20:23], s35 offen lds
  v_mfma_f32_16x16x32_bf16 v[60:63], a[148:151], v[180:183], v[60:63]
  v_exp_f32 v23, v23
  v_mfma_f32_16x16x32_bf16 v[60:63], a[144:147], v[176:179], v[60:63]
  ds_read_b64_tr_b16 a[174:175], v217 offset:61440
  v_cvt_pk_bf16_f32 v19, v22, v23
  v_mfma_f32_16x16x32_bf16 a[192:195], a[208:211], v[64:67], a[192:195]
  v_exp_f32 v28, v28
  v_mfma_f32_16x16x32_bf16 a[192:195], a[208:211], v[96:99], a[192:195]
  ds_read_b64_tr_b16 a[176:177], v218 offset:49152
  v_mfma_f32_16x16x32_bf16 a[196:199], a[208:211], v[72:75], a[196:199]
  v_exp_f32 v29, v29
  v_mfma_f32_16x16x32_bf16 a[196:199], a[208:211], v[104:107], a[196:199]
  ds_read_b64_tr_b16 a[178:179], v218 offset:53248
  v_cvt_pk_bf16_f32 v26, v28, v29
  v_mfma_f32_16x16x32_bf16 a[200:203], a[208:211], v[80:83], a[200:203]
  v_exp_f32 v30, v30
  v_mfma_f32_16x16x32_bf16 a[200:203], a[208:211], v[112:115], a[200:203]
  ds_read_b64_tr_b16 a[180:181], v218 offset:57344
  v_mfma_f32_16x16x32_bf16 a[204:207], a[208:211], v[88:91], a[204:207]
  s_waitcnt lgkmcnt(7)
  v_exp_f32 v31, v31
  v_mfma_f32_16x16x32_bf16 a[204:207], a[208:211], v[120:123], a[204:207]
  ds_read_b64_tr_b16 a[182:183], v218 offset:61440
  v_cvt_pk_bf16_f32 v27, v30, v31
  v_mfma_f32_16x16x32_bf16 a[0:3], a[160:163], v[64:67], a[0:3]
  v_exp_f32 v32, v32
  v_mfma_f32_16x16x32_bf16 a[0:3], a[164:167], v[96:99], a[0:3]
  ds_read_b64_tr_b16 a[184:185], v219 offset:49152
  v_mfma_f32_16x16x32_bf16 a[4:7], a[164:167], v[104:107], a[4:7]
  v_exp_f32 v33, v33
  v_mfma_f32_16x16x32_bf16 a[4:7], a[160:163], v[72:75], a[4:7]
  ds_read_b64_tr_b16 a[186:187], v219 offset:53248
  v_cvt_pk_bf16_f32 v32, v32, v33
  v_mfma_f32_16x16x32_bf16 a[8:11], a[160:163], v[80:83], a[8:11]
  v_exp_f32 v34, v34
  v_mfma_f32_16x16x32_bf16 a[8:11], a[164:167], v[112:115], a[8:11]
  ds_read_b64_tr_b16 a[188:189], v219 offset:57344
  v_mfma_f32_16x16x32_bf16 a[12:15], a[164:167], v[120:123], a[12:15]
  s_waitcnt lgkmcnt(7)
  v_exp_f32 v35, v35
  v_mfma_f32_16x16x32_bf16 a[12:15], a[160:163], v[88:91], a[12:15]
  ds_read_b64_tr_b16 a[190:191], v219 offset:61440
  v_cvt_pk_bf16_f32 v33, v34, v35
  v_mfma_f32_16x16x32_bf16 a[16:19], a[168:171], v[64:67], a[16:19]
  v_exp_f32 v40, v40
  v_mfma_f32_16x16x32_bf16 a[16:19], a[172:175], v[96:99], a[16:19]
  ds_read_b64_tr_b16 a[160:161], v220 offset:49152
  v_mfma_f32_16x16x32_bf16 a[20:23], a[172:175], v[104:107], a[20:23]
  v_exp_f32 v41, v41
  v_mfma_f32_16x16x32_bf16 a[20:23], a[168:171], v[72:75], a[20:23]
  ds_read_b64_tr_b16 a[162:163], v220 offset:53248
  v_cvt_pk_bf16_f32 v40, v40, v41
  v_mfma_f32_16x16x32_bf16 a[24:27], a[168:171], v[80:83], a[24:27]
  v_exp_f32 v42, v42
  v_mfma_f32_16x16x32_bf16 a[24:27], a[172:175], v[112:115], a[24:27]
  ds_read_b64_tr_b16 a[164:165], v220 offset:57344
  v_mfma_f32_16x16x32_bf16 a[28:31], a[172:175], v[120:123], a[28:31]
  s_waitcnt lgkmcnt(7)
  v_exp_f32 v43, v43
  v_mfma_f32_16x16x32_bf16 a[28:31], a[168:171], v[88:91], a[28:31]
  ds_read_b64_tr_b16 a[166:167], v220 offset:61440
  v_cvt_pk_bf16_f32 v41, v42, v43
  v_mfma_f32_16x16x32_bf16 a[32:35], a[176:179], v[64:67], a[32:35]
  v_exp_f32 v48, v48
  v_mfma_f32_16x16x32_bf16 a[32:35], a[180:183], v[96:99], a[32:35]
  ds_read_b64_tr_b16 a[168:169], v221 offset:49152
  v_mfma_f32_16x16x32_bf16 a[36:39], a[180:183], v[104:107], a[36:39]
  v_exp_f32 v49, v49
  v_mfma_f32_16x16x32_bf16 a[36:39], a[176:179], v[72:75], a[36:39]
  ds_read_b64_tr_b16 a[170:171], v221 offset:53248
  v_cvt_pk_bf16_f32 v48, v48, v49
  v_mfma_f32_16x16x32_bf16 a[40:43], a[176:179], v[80:83], a[40:43]
  v_exp_f32 v50, v50
  v_mfma_f32_16x16x32_bf16 a[40:43], a[180:183], v[112:115], a[40:43]
  ds_read_b64_tr_b16 a[172:173], v221 offset:57344
  v_mfma_f32_16x16x32_bf16 a[44:47], a[180:183], v[120:123], a[44:47]
  s_waitcnt lgkmcnt(7)
  v_exp_f32 v51, v51
  v_mfma_f32_16x16x32_bf16 a[44:47], a[176:179], v[88:91], a[44:47]
  ds_read_b64_tr_b16 a[174:175], v221 offset:61440
  v_cvt_pk_bf16_f32 v49, v50, v51
  v_mfma_f32_16x16x32_bf16 a[48:51], a[184:187], v[64:67], a[48:51]
  v_exp_f32 v56, v56
  v_mfma_f32_16x16x32_bf16 a[48:51], a[188:191], v[96:99], a[48:51]
  ds_read_b64_tr_b16 a[176:177], v222 offset:49152
  v_mfma_f32_16x16x32_bf16 a[52:55], a[188:191], v[104:107], a[52:55]
  v_exp_f32 v57, v57
  v_mfma_f32_16x16x32_bf16 a[52:55], a[184:187], v[72:75], a[52:55]
  ds_read_b64_tr_b16 a[178:179], v222 offset:53248
  v_cvt_pk_bf16_f32 v56, v56, v57
  v_mfma_f32_16x16x32_bf16 a[56:59], a[184:187], v[80:83], a[56:59]
  v_exp_f32 v58, v58
  v_mfma_f32_16x16x32_bf16 a[56:59], a[188:191], v[112:115], a[56:59]
  ds_read_b64_tr_b16 a[180:181], v222 offset:57344
  v_mfma_f32_16x16x32_bf16 a[60:63], a[188:191], v[120:123], a[60:63]
  s_waitcnt lgkmcnt(7)
  v_exp_f32 v59, v59
  v_mfma_f32_16x16x32_bf16 a[60:63], a[184:187], v[88:91], a[60:63]
  ds_read_b64_tr_b16 a[182:183], v222 offset:61440
  v_cvt_pk_bf16_f32 v57, v58, v59
  v_mfma_f32_16x16x32_bf16 a[64:67], a[160:163], v[64:67], a[64:67]
  v_exp_f32 v36, v36
  v_mfma_f32_16x16x32_bf16 a[64:67], a[164:167], v[96:99], a[64:67]
  ds_read_b64_tr_b16 a[184:185], v223 offset:49152
  v_mfma_f32_16x16x32_bf16 a[68:71], a[164:167], v[104:107], a[68:71]
  v_exp_f32 v37, v37
  v_mfma_f32_16x16x32_bf16 a[68:71], a[160:163], v[72:75], a[68:71]
  ds_read_b64_tr_b16 a[186:187], v223 offset:53248
  v_cvt_pk_bf16_f32 v34, v36, v37
  v_mfma_f32_16x16x32_bf16 a[72:75], a[160:163], v[80:83], a[72:75]
  v_exp_f32 v38, v38
  v_mfma_f32_16x16x32_bf16 a[72:75], a[164:167], v[112:115], a[72:75]
  ds_read_b64_tr_b16 a[188:189], v223 offset:57344
  v_mfma_f32_16x16x32_bf16 a[76:79], a[164:167], v[120:123], a[76:79]
  s_waitcnt lgkmcnt(7)
  v_exp_f32 v39, v39
  v_mfma_f32_16x16x32_bf16 a[76:79], a[160:163], v[88:91], a[76:79]
  ds_read_b64_tr_b16 a[190:191], v223 offset:61440
  v_cvt_pk_bf16_f32 v35, v38, v39
  v_mfma_f32_16x16x32_bf16 a[80:83], a[168:171], v[64:67], a[80:83]
  s_waitcnt vmcnt(11)
  v_exp_f32 v44, v44
  v_mfma_f32_16x16x32_bf16 a[80:83], a[172:175], v[96:99], a[80:83]
  v_mfma_f32_16x16x32_bf16 a[84:87], a[172:175], v[104:107], a[84:87]
  s_barrier
  v_exp_f32 v45, v45
  v_mfma_f32_16x16x32_bf16 a[84:87], a[168:171], v[72:75], a[84:87]
  ds_read_b128 a[128:131], v212 offset:16384
  v_cvt_pk_bf16_f32 v42, v44, v45
  v_mfma_f32_16x16x32_bf16 a[88:91], a[168:171], v[80:83], a[88:91]
  v_exp_f32 v46, v46
  v_mfma_f32_16x16x32_bf16 a[88:91], a[172:175], v[112:115], a[88:91]
  ds_read_b128 a[132:135], v213 offset:16384
  v_mfma_f32_16x16x32_bf16 a[92:95], a[172:175], v[120:123], a[92:95]
  s_waitcnt lgkmcnt(6)
  v_exp_f32 v47, v47
  v_mfma_f32_16x16x32_bf16 a[92:95], a[168:171], v[88:91], a[92:95]
  ds_read_b128 a[136:139], v214 offset:16384
  v_cvt_pk_bf16_f32 v43, v46, v47
  v_mfma_f32_16x16x32_bf16 a[96:99], a[176:179], v[64:67], a[96:99]
  v_exp_f32 v52, v52
  v_mfma_f32_16x16x32_bf16 a[96:99], a[180:183], v[96:99], a[96:99]
  ds_read_b128 a[140:143], v215 offset:16384
  buffer_load_dwordx4 a[224:227], v243, s[24:27], s38 offen sc1
  s_add_u32 s38, s38, 4096
  v_mfma_f32_16x16x32_bf16 a[100:103], a[180:183], v[104:107], a[100:103]
  v_exp_f32 v53, v53
  v_mfma_f32_16x16x32_bf16 a[100:103], a[176:179], v[72:75], a[100:103]
  v_cvt_pk_bf16_f32 v50, v52, v53
  v_mfma_f32_16x16x32_bf16 a[104:107], a[176:179], v[80:83], a[104:107]
  v_exp_f32 v54, v54
  v_mfma_f32_16x16x32_bf16 a[104:107], a[180:183], v[112:115], a[104:107]
  v_mfma_f32_16x16x32_bf16 a[108:111], a[180:183], v[120:123], a[108:111]
  s_waitcnt lgkmcnt(4)
  v_exp_f32 v55, v55
  v_mfma_f32_16x16x32_bf16 a[108:111], a[176:179], v[88:91], a[108:111]
  v_cvt_pk_bf16_f32 v51, v54, v55
  v_mfma_f32_16x16x32_bf16 a[112:115], a[184:187], v[64:67], a[112:115]
  v_exp_f32 v60, v60
  v_mfma_f32_16x16x32_bf16 a[112:115], a[188:191], v[96:99], a[112:115]
  v_mfma_f32_16x16x32_bf16 a[116:119], a[188:191], v[104:107], a[116:119]
  v_exp_f32 v61, v61
  v_mfma_f32_16x16x32_bf16 a[116:119], a[184:187], v[72:75], a[116:119]
  v_cvt_pk_bf16_f32 v58, v60, v61
  v_mfma_f32_16x16x32_bf16 a[120:123], a[184:187], v[80:83], a[120:123]
  v_exp_f32 v62, v62
  v_mfma_f32_16x16x32_bf16 a[120:123], a[188:191], v[112:115], a[120:123]
  v_mfma_f32_16x16x32_bf16 a[124:127], a[188:191], v[120:123], a[124:127]
  s_waitcnt lgkmcnt(0)
  v_exp_f32 v63, v63
  v_mfma_f32_16x16x32_bf16 a[124:127], a[184:187], v[88:91], a[124:127]
  v_cvt_pk_bf16_f32 v59, v62, v63
  v_mfma_f32_16x16x32_bf16 v[64:67], a[128:131], v[128:131], v[192:195]
  s_add_u32 m0, s28, 98304
  v_mfma_f32_16x16x32_bf16 v[64:67], a[132:135], v[132:135], v[64:67]
  ds_read_b128 a[144:147], v212 offset:20480
  v_mfma_f32_16x16x32_bf16 v[64:67], a[136:139], v[136:139], v[64:67]
  buffer_load_dwordx4 v236, s[16:19], s29 offen offset:0 lds
  v_mfma_f32_16x16x32_bf16 v[64:67], a[140:143], v[140:143], v[64:67]
  ds_read_b128 a[148:151], v213 offset:20480
  v_mfma_f32_16x16x32_bf16 v[72:75], a[140:143], v[156:159], v[196:199]
  v_mfma_f32_16x16x32_bf16 v[72:75], a[136:139], v[152:155], v[72:75]
  ds_read_b128 a[152:155], v214 offset:20480
  v_mfma_f32_16x16x32_bf16 v[72:75], a[132:135], v[148:151], v[72:75]
  buffer_load_dwordx4 v237, s[16:19], s29 offen offset:1024 lds
  v_mfma_f32_16x16x32_bf16 v[72:75], a[128:131], v[144:147], v[72:75]
  ds_read_b128 a[156:159], v215 offset:20480
  v_mfma_f32_16x16x32_bf16 v[80:83], a[128:131], v[160:163], v[200:203]
  v_exp_f32 v64, v64
  v_mfma_f32_16x16x32_bf16 v[80:83], a[132:135], v[164:167], v[80:83]
  v_mfma_f32_16x16x32_bf16 v[80:83], a[136:139], v[168:171], v[80:83]
  v_exp_f32 v65, v65
  v_mfma_f32_16x16x32_bf16 v[80:83], a[140:143], v[172:175], v[80:83]
  v_cvt_pk_bf16_f32 v64, v64, v65
  v_mfma_f32_16x16x32_bf16 v[88:91], a[140:143], v[188:191], v[204:207]
  v_exp_f32 v66, v66
  v_mfma_f32_16x16x32_bf16 v[88:91], a[136:139], v[184:187], v[88:91]
  buffer_load_dwordx4 v236, s[16:19], s29 offen offset:2048 lds
  v_mfma_f32_16x16x32_bf16 v[88:91], a[132:135], v[180:183], v[88:91]
  s_waitcnt lgkmcnt(0)
  v_exp_f32 v67, v67
  v_mfma_f32_16x16x32_bf16 v[88:91], a[128:131], v[176:179], v[88:91]
  v_cvt_pk_bf16_f32 v65, v66, v67
  v_mfma_f32_16x16x32_bf16 v[68:71], a[144:147], v[128:131], v[192:195]
  v_exp_f32 v72, v72
  v_mfma_f32_16x16x32_bf16 v[68:71], a[148:151], v[132:135], v[68:71]
  ds_read_b128 a[128:131], v212 offset:24576
  v_mfma_f32_16x16x32_bf16 v[68:71], a[152:155], v[136:139], v[68:71]
  v_exp_f32 v73, v73
  v_mfma_f32_16x16x32_bf16 v[68:71], a[156:159], v[140:143], v[68:71]
  ds_read_b128 a[132:135], v213 offset:24576
  v_cvt_pk_bf16_f32 v72, v72, v73
  v_mfma_f32_16x16x32_bf16 v[76:79], a[156:159], v[156:159], v[196:199]
  v_exp_f32 v74, v74
  v_mfma_f32_16x16x32_bf16 v[76:79], a[152:155], v[152:155], v[76:79]
  ds_read_b128 a[136:139], v214 offset:24576
  v_mfma_f32_16x16x32_bf16 v[76:79], a[148:151], v[148:151], v[76:79]
  v_exp_f32 v75, v75
  v_mfma_f32_16x16x32_bf16 v[76:79], a[144:147], v[144:147], v[76:79]
  ds_read_b128 a[140:143], v215 offset:24576
  v_cvt_pk_bf16_f32 v73, v74, v75
  v_mfma_f32_16x16x32_bf16 v[84:87], a[144:147], v[160:163], v[200:203]
  v_exp_f32 v80, v80
  v_mfma_f32_16x16x32_bf16 v[84:87], a[148:151], v[164:167], v[84:87]
  buffer_load_dwordx4 v237, s[16:19], s29 offen offset:3072 lds
  v_mfma_f32_16x16x32_bf16 v[84:87], a[152:155], v[168:171], v[84:87]
  s_add_u32 s29, s29, 16384
  v_exp_f32 v81, v81
  v_mfma_f32_16x16x32_bf16 v[84:87], a[156:159], v[172:175], v[84:87]
  v_cvt_pk_bf16_f32 v80, v80, v81
  v_mfma_f32_16x16x32_bf16 v[92:95], a[156:159], v[188:191], v[204:207]
  s_add_u32 m0, s28, 49152
  v_exp_f32 v82, v82
  v_mfma_f32_16x16x32_bf16 v[92:95], a[152:155], v[184:187], v[92:95]
  buffer_load_dwordx4 v232, s[12:15], s29 offen offset:0 lds
  v_mfma_f32_16x16x32_bf16 v[92:95], a[148:151], v[180:183], v[92:95]
  s_waitcnt lgkmcnt(0)
  v_exp_f32 v83, v83
  v_mfma_f32_16x16x32_bf16 v[92:95], a[144:147], v[176:179], v[92:95]
  v_cvt_pk_bf16_f32 v81, v82, v83
  v_mfma_f32_16x16x32_bf16 v[96:99], a[128:131], v[128:131], v[192:195]
  v_exp_f32 v88, v88
  v_mfma_f32_16x16x32_bf16 v[96:99], a[132:135], v[132:135], v[96:99]
  ds_read_b128 a[144:147], v212 offset:28672
  v_mfma_f32_16x16x32_bf16 v[96:99], a[136:139], v[136:139], v[96:99]
  v_exp_f32 v89, v89
  v_mfma_f32_16x16x32_bf16 v[96:99], a[140:143], v[140:143], v[96:99]
  ds_read_b128 a[148:151], v213 offset:28672
  v_cvt_pk_bf16_f32 v88, v88, v89
  v_mfma_f32_16x16x32_bf16 v[104:107], a[140:143], v[156:159], v[196:199]
  v_exp_f32 v90, v90
  v_mfma_f32_16x16x32_bf16 v[104:107], a[136:139], v[152:155], v[104:107]
  ds_read_b128 a[152:155], v214 offset:28672
  v_mfma_f32_16x16x32_bf16 v[104:107], a[132:135], v[148:151], v[104:107]
  v_exp_f32 v91, v91
  v_mfma_f32_16x16x32_bf16 v[104:107], a[128:131], v[144:147], v[104:107]
  ds_read_b128 a[156:159], v215 offset:28672
  v_cvt_pk_bf16_f32 v89, v90, v91
  v_mfma_f32_16x16x32_bf16 v[112:115], a[128:131], v[160:163], v[200:203]
  v_exp_f32 v68, v68
  v_mfma_f32_16x16x32_bf16 v[112:115], a[132:135], v[164:167], v[112:115]
  buffer_load_dwordx4 v233, s[12:15], s29 offen offset:1024 lds
  v_mfma_f32_16x16x32_bf16 v[112:115], a[136:139], v[168:171], v[112:115]
  v_exp_f32 v69, v69
  v_mfma_f32_16x16x32_bf16 v[112:115], a[140:143], v[172:175], v[112:115]
  v_cvt_pk_bf16_f32 v66, v68, v69
  v_mfma_f32_16x16x32_bf16 v[120:123], a[140:143], v[188:191], v[204:207]
  v_exp_f32 v70, v70
  v_mfma_f32_16x16x32_bf16 v[120:123], a[136:139], v[184:187], v[120:123]
  buffer_load_dwordx4 v234, s[12:15], s29 offen offset:2048 lds
  v_mfma_f32_16x16x32_bf16 v[120:123], a[132:135], v[180:183], v[120:123]
  s_waitcnt lgkmcnt(0)
  v_exp_f32 v71, v71
  v_mfma_f32_16x16x32_bf16 v[120:123], a[128:131], v[176:179], v[120:123]
  v_cvt_pk_bf16_f32 v67, v70, v71
  v_mfma_f32_16x16x32_bf16 v[100:103], a[144:147], v[128:131], v[192:195]
  v_exp_f32 v76, v76
  v_mfma_f32_16x16x32_bf16 v[100:103], a[148:151], v[132:135], v[100:103]
  ds_read_b64_tr_b16 a[160:161], v216 offset:0
  v_mfma_f32_16x16x32_bf16 v[100:103], a[152:155], v[136:139], v[100:103]
  v_exp_f32 v77, v77
  v_mfma_f32_16x16x32_bf16 v[100:103], a[156:159], v[140:143], v[100:103]
  ds_read_b64_tr_b16 a[162:163], v216 offset:4096
  v_cvt_pk_bf16_f32 v74, v76, v77
  v_mfma_f32_16x16x32_bf16 v[108:111], a[156:159], v[156:159], v[196:199]
  v_exp_f32 v78, v78
  v_mfma_f32_16x16x32_bf16 v[108:111], a[152:155], v[152:155], v[108:111]
  ds_read_b64_tr_b16 a[164:165], v216 offset:8192
  buffer_load_dwordx4 v235, s[12:15], s29 offen offset:3072 lds
  v_mfma_f32_16x16x32_bf16 v[108:111], a[148:151], v[148:151], v[108:111]
  v_exp_f32 v79, v79
  v_mfma_f32_16x16x32_bf16 v[108:111], a[144:147], v[144:147], v[108:111]
  ds_read_b64_tr_b16 a[166:167], v216 offset:12288
  v_cvt_pk_bf16_f32 v75, v78, v79
  v_mfma_f32_16x16x32_bf16 v[116:119], a[144:147], v[160:163], v[200:203]
  v_exp_f32 v84, v84
  v_mfma_f32_16x16x32_bf16 v[116:119], a[148:151], v[164:167], v[116:119]
  ds_read_b64_tr_b16 a[168:169], v217 offset:0
  s_add_u32 m0, s50, 5120
  v_mfma_f32_16x16x32_bf16 v[116:119], a[152:155], v[168:171], v[116:119]
  v_exp_f32 v85, v85
  v_mfma_f32_16x16x32_bf16 v[116:119], a[156:159], v[172:175], v[116:119]
  ds_read_b64_tr_b16 a[170:171], v217 offset:4096
  v_cvt_pk_bf16_f32 v82, v84, v85
  v_mfma_f32_16x16x32_bf16 v[124:127], a[156:159], v[188:191], v[204:207]
  v_exp_f32 v86, v86
  v_mfma_f32_16x16x32_bf16 v[124:127], a[152:155], v[184:187], v[124:127]
  ds_read_b64_tr_b16 a[172:173], v217 offset:8192
  buffer_load_dwordx4 v253, s[44:47], s35 offen lds
  s_add_u32 s35, s35, 221184
  v_mfma_f32_16x16x32_bf16 v[124:127], a[148:151], v[180:183], v[124:127]
  v_exp_f32 v87, v87
  v_mfma_f32_16x16x32_bf16 v[124:127], a[144:147], v[176:179], v[124:127]
  ds_read_b64_tr_b16 a[174:175], v217 offset:12288
  v_cvt_pk_bf16_f32 v83, v86, v87
  v_mfma_f32_16x16x32_bf16 a[192:195], a[208:211], v[0:3], a[192:195]
  v_exp_f32 v92, v92
  v_mfma_f32_16x16x32_bf16 a[192:195], a[208:211], v[32:35], a[192:195]
  ds_read_b64_tr_b16 a[176:177], v218 offset:0
  v_mfma_f32_16x16x32_bf16 a[196:199], a[208:211], v[8:11], a[196:199]
  v_exp_f32 v93, v93
  v_mfma_f32_16x16x32_bf16 a[196:199], a[208:211], v[40:43], a[196:199]
  ds_read_b64_tr_b16 a[178:179], v218 offset:4096
  v_cvt_pk_bf16_f32 v90, v92, v93
  v_mfma_f32_16x16x32_bf16 a[200:203], a[208:211], v[16:19], a[200:203]
  v_exp_f32 v94, v94
  v_mfma_f32_16x16x32_bf16 a[200:203], a[208:211], v[48:51], a[200:203]
  ds_read_b64_tr_b16 a[180:181], v218 offset:8192
  v_mfma_f32_16x16x32_bf16 a[204:207], a[208:211], v[24:27], a[204:207]
  s_waitcnt lgkmcnt(7)
  v_exp_f32 v95, v95
  v_mfma_f32_16x16x32_bf16 a[204:207], a[208:211], v[56:59], a[204:207]
  ds_read_b64_tr_b16 a[182:183], v218 offset:12288
  v_cvt_pk_bf16_f32 v91, v94, v95
  v_mfma_f32_16x16x32_bf16 a[0:3], a[160:163], v[0:3], a[0:3]
  v_exp_f32 v96, v96
  v_mfma_f32_16x16x32_bf16 a[0:3], a[164:167], v[32:35], a[0:3]
  ds_read_b64_tr_b16 a[184:185], v219 offset:0
  v_mfma_f32_16x16x32_bf16 a[4:7], a[164:167], v[40:43], a[4:7]
  v_exp_f32 v97, v97
  v_mfma_f32_16x16x32_bf16 a[4:7], a[160:163], v[8:11], a[4:7]
  ds_read_b64_tr_b16 a[186:187], v219 offset:4096
  v_cvt_pk_bf16_f32 v96, v96, v97
  v_mfma_f32_16x16x32_bf16 a[8:11], a[160:163], v[16:19], a[8:11]
  v_exp_f32 v98, v98
  v_mfma_f32_16x16x32_bf16 a[8:11], a[164:167], v[48:51], a[8:11]
  ds_read_b64_tr_b16 a[188:189], v219 offset:8192
  v_mfma_f32_16x16x32_bf16 a[12:15], a[164:167], v[56:59], a[12:15]
  s_waitcnt lgkmcnt(7)
  v_exp_f32 v99, v99
  v_mfma_f32_16x16x32_bf16 a[12:15], a[160:163], v[24:27], a[12:15]
  ds_read_b64_tr_b16 a[190:191], v219 offset:12288
  v_cvt_pk_bf16_f32 v97, v98, v99
  v_mfma_f32_16x16x32_bf16 a[16:19], a[168:171], v[0:3], a[16:19]
  v_exp_f32 v104, v104
  v_mfma_f32_16x16x32_bf16 a[16:19], a[172:175], v[32:35], a[16:19]
  ds_read_b64_tr_b16 a[160:161], v220 offset:0
  v_mfma_f32_16x16x32_bf16 a[20:23], a[172:175], v[40:43], a[20:23]
  v_exp_f32 v105, v105
  v_mfma_f32_16x16x32_bf16 a[20:23], a[168:171], v[8:11], a[20:23]
  ds_read_b64_tr_b16 a[162:163], v220 offset:4096
  v_cvt_pk_bf16_f32 v104, v104, v105
  v_mfma_f32_16x16x32_bf16 a[24:27], a[168:171], v[16:19], a[24:27]
  v_exp_f32 v106, v106
  v_mfma_f32_16x16x32_bf16 a[24:27], a[172:175], v[48:51], a[24:27]
  ds_read_b64_tr_b16 a[164:165], v220 offset:8192
  v_mfma_f32_16x16x32_bf16 a[28:31], a[172:175], v[56:59], a[28:31]
  s_waitcnt lgkmcnt(7)
  v_exp_f32 v107, v107
  v_mfma_f32_16x16x32_bf16 a[28:31], a[168:171], v[24:27], a[28:31]
  ds_read_b64_tr_b16 a[166:167], v220 offset:12288
  v_cvt_pk_bf16_f32 v105, v106, v107
  v_mfma_f32_16x16x32_bf16 a[32:35], a[176:179], v[0:3], a[32:35]
  v_exp_f32 v112, v112
  v_mfma_f32_16x16x32_bf16 a[32:35], a[180:183], v[32:35], a[32:35]
  ds_read_b64_tr_b16 a[168:169], v221 offset:0
  v_mfma_f32_16x16x32_bf16 a[36:39], a[180:183], v[40:43], a[36:39]
  v_exp_f32 v113, v113
  v_mfma_f32_16x16x32_bf16 a[36:39], a[176:179], v[8:11], a[36:39]
  ds_read_b64_tr_b16 a[170:171], v221 offset:4096
  v_cvt_pk_bf16_f32 v112, v112, v113
  v_mfma_f32_16x16x32_bf16 a[40:43], a[176:179], v[16:19], a[40:43]
  v_exp_f32 v114, v114
  v_mfma_f32_16x16x32_bf16 a[40:43], a[180:183], v[48:51], a[40:43]
  ds_read_b64_tr_b16 a[172:173], v221 offset:8192
  v_mfma_f32_16x16x32_bf16 a[44:47], a[180:183], v[56:59], a[44:47]
  s_waitcnt lgkmcnt(7)
  v_exp_f32 v115, v115
  v_mfma_f32_16x16x32_bf16 a[44:47], a[176:179], v[24:27], a[44:47]
  ds_read_b64_tr_b16 a[174:175], v221 offset:12288
  v_cvt_pk_bf16_f32 v113, v114, v115
  v_mfma_f32_16x16x32_bf16 a[48:51], a[184:187], v[0:3], a[48:51]
  v_exp_f32 v120, v120
  v_mfma_f32_16x16x32_bf16 a[48:51], a[188:191], v[32:35], a[48:51]
  ds_read_b64_tr_b16 a[176:177], v222 offset:0
  v_mfma_f32_16x16x32_bf16 a[52:55], a[188:191], v[40:43], a[52:55]
  v_exp_f32 v121, v121
  v_mfma_f32_16x16x32_bf16 a[52:55], a[184:187], v[8:11], a[52:55]
  ds_read_b64_tr_b16 a[178:179], v222 offset:4096
  v_cvt_pk_bf16_f32 v120, v120, v121
  v_mfma_f32_16x16x32_bf16 a[56:59], a[184:187], v[16:19], a[56:59]
  v_exp_f32 v122, v122
  v_mfma_f32_16x16x32_bf16 a[56:59], a[188:191], v[48:51], a[56:59]
  ds_read_b64_tr_b16 a[180:181], v222 offset:8192
  v_mfma_f32_16x16x32_bf16 a[60:63], a[188:191], v[56:59], a[60:63]
  s_waitcnt lgkmcnt(7)
  v_exp_f32 v123, v123
  v_mfma_f32_16x16x32_bf16 a[60:63], a[184:187], v[24:27], a[60:63]
  ds_read_b64_tr_b16 a[182:183], v222 offset:12288
  v_cvt_pk_bf16_f32 v121, v122, v123
  v_mfma_f32_16x16x32_bf16 a[64:67], a[160:163], v[0:3], a[64:67]
  v_exp_f32 v100, v100
  v_mfma_f32_16x16x32_bf16 a[64:67], a[164:167], v[32:35], a[64:67]
  ds_read_b64_tr_b16 a[184:185], v223 offset:0
  v_mfma_f32_16x16x32_bf16 a[68:71], a[164:167], v[40:43], a[68:71]
  v_exp_f32 v101, v101
  v_mfma_f32_16x16x32_bf16 a[68:71], a[160:163], v[8:11], a[68:71]
  ds_read_b64_tr_b16 a[186:187], v223 offset:4096
  v_cvt_pk_bf16_f32 v98, v100, v101
  v_mfma_f32_16x16x32_bf16 a[72:75], a[160:163], v[16:19], a[72:75]
  v_exp_f32 v102, v102
  v_mfma_f32_16x16x32_bf16 a[72:75], a[164:167], v[48:51], a[72:75]
  ds_read_b64_tr_b16 a[188:189], v223 offset:8192
  v_mfma_f32_16x16x32_bf16 a[76:79], a[164:167], v[56:59], a[76:79]
  s_waitcnt lgkmcnt(7)
  v_exp_f32 v103, v103
  v_mfma_f32_16x16x32_bf16 a[76:79], a[160:163], v[24:27], a[76:79]
  ds_read_b64_tr_b16 a[190:191], v223 offset:12288
  v_cvt_pk_bf16_f32 v99, v102, v103
  v_mfma_f32_16x16x32_bf16 a[80:83], a[168:171], v[0:3], a[80:83]
  s_waitcnt vmcnt(11)
  v_exp_f32 v108, v108
  v_mfma_f32_16x16x32_bf16 a[80:83], a[172:175], v[32:35], a[80:83]
  v_mfma_f32_16x16x32_bf16 a[84:87], a[172:175], v[40:43], a[84:87]
  s_barrier
  v_exp_f32 v109, v109
  v_mfma_f32_16x16x32_bf16 a[84:87], a[168:171], v[8:11], a[84:87]
  ds_read_b128 a[128:131], v212 offset:32768
  v_cvt_pk_bf16_f32 v106, v108, v109
  v_mfma_f32_16x16x32_bf16 a[88:91], a[168:171], v[16:19], a[88:91]
  v_exp_f32 v110, v110
  v_mfma_f32_16x16x32_bf16 a[88:91], a[172:175], v[48:51], a[88:91]
  ds_read_b128 a[132:135], v213 offset:32768
  v_mfma_f32_16x16x32_bf16 a[92:95], a[172:175], v[56:59], a[92:95]
  s_waitcnt lgkmcnt(6)
  v_exp_f32 v111, v111
  v_mfma_f32_16x16x32_bf16 a[92:95], a[168:171], v[24:27], a[92:95]
  ds_read_b128 a[136:139], v214 offset:32768
  v_cvt_pk_bf16_f32 v107, v110, v111
  v_mfma_f32_16x16x32_bf16 a[96:99], a[176:179], v[0:3], a[96:99]
  v_exp_f32 v116, v116
  v_mfma_f32_16x16x32_bf16 a[96:99], a[180:183], v[32:35], a[96:99]
  ds_read_b128 a[140:143], v215 offset:32768
  buffer_load_dwordx4 a[228:231], v243, s[24:27], s38 offen sc1
  s_add_u32 s38, s38, 4096
  v_mfma_f32_16x16x32_bf16 a[100:103], a[180:183], v[40:43], a[100:103]
  v_exp_f32 v117, v117
  v_mfma_f32_16x16x32_bf16 a[100:103], a[176:179], v[8:11], a[100:103]
  v_cvt_pk_bf16_f32 v114, v116, v117
  v_mfma_f32_16x16x32_bf16 a[104:107], a[176:179], v[16:19], a[104:107]
  v_exp_f32 v118, v118
  v_mfma_f32_16x16x32_bf16 a[104:107], a[180:183], v[48:51], a[104:107]
  v_mfma_f32_16x16x32_bf16 a[108:111], a[180:183], v[56:59], a[108:111]
  s_waitcnt lgkmcnt(4)
  v_exp_f32 v119, v119
  v_mfma_f32_16x16x32_bf16 a[108:111], a[176:179], v[24:27], a[108:111]
  v_cvt_pk_bf16_f32 v115, v118, v119
  v_mfma_f32_16x16x32_bf16 a[112:115], a[184:187], v[0:3], a[112:115]
  v_exp_f32 v124, v124
  v_mfma_f32_16x16x32_bf16 a[112:115], a[188:191], v[32:35], a[112:115]
  v_mfma_f32_16x16x32_bf16 a[116:119], a[188:191], v[40:43], a[116:119]
  v_exp_f32 v125, v125
  v_mfma_f32_16x16x32_bf16 a[116:119], a[184:187], v[8:11], a[116:119]
  v_cvt_pk_bf16_f32 v122, v124, v125
  v_mfma_f32_16x16x32_bf16 a[120:123], a[184:187], v[16:19], a[120:123]
  v_exp_f32 v126, v126
  v_mfma_f32_16x16x32_bf16 a[120:123], a[188:191], v[48:51], a[120:123]
  v_mfma_f32_16x16x32_bf16 a[124:127], a[188:191], v[56:59], a[124:127]
  s_waitcnt lgkmcnt(0)
  v_exp_f32 v127, v127
  v_mfma_f32_16x16x32_bf16 a[124:127], a[184:187], v[24:27], a[124:127]
  v_cvt_pk_bf16_f32 v123, v126, v127
  v_mfma_f32_16x16x32_bf16 v[0:3], a[128:131], v[128:131], v[192:195]
  s_add_u32 m0, s28, 114688
  s_mov_b32 s20, s88
  s_mov_b32 s21, s89
  v_mfma_f32_16x16x32_bf16 v[0:3], a[132:135], v[132:135], v[0:3]
  ds_read_b128 a[144:147], v212 offset:36864
  s_mov_b32 s22, 5242880
  s_mov_b32 s23, 0x20000
  v_lshrrev_b32 v208, 4, v242
  v_mfma_f32_16x16x32_bf16 v[0:3], a[136:139], v[136:139], v[0:3]
  buffer_load_dwordx4 v236, s[16:19], s29 offen offset:0 lds
  v_mfma_f32_16x16x32_bf16 v[0:3], a[140:143], v[140:143], v[0:3]
  ds_read_b128 a[148:151], v213 offset:36864
  v_and_b32 v209, 1, v208
  v_mfma_f32_16x16x32_bf16 v[8:11], a[140:143], v[156:159], v[196:199]
  v_lshrrev_b32 v208, 1, v208
  v_mul_u32_u24 v208, 0x500, v208
  v_mfma_f32_16x16x32_bf16 v[8:11], a[136:139], v[152:155], v[8:11]
  ds_read_b128 a[152:155], v214 offset:36864
  v_lshl_add_u32 v208, v209, 4, v208
  v_mfma_f32_16x16x32_bf16 v[8:11], a[132:135], v[148:151], v[8:11]
  buffer_load_dwordx4 v237, s[16:19], s29 offen offset:1024 lds
  v_mfma_f32_16x16x32_bf16 v[8:11], a[128:131], v[144:147], v[8:11]
  ds_read_b128 a[156:159], v215 offset:36864
  v_lshrrev_b32 v209, 4, v242
  v_mfma_f32_16x16x32_bf16 v[16:19], a[128:131], v[160:163], v[200:203]
  v_exp_f32 v0, v0
  v_mfma_f32_16x16x32_bf16 v[16:19], a[132:135], v[164:167], v[16:19]
  v_lshrrev_b32 v210, 5, v209
  v_lshlrev_b32 v210, 30, v210
  v_mfma_f32_16x16x32_bf16 v[16:19], a[136:139], v[168:171], v[16:19]
  v_exp_f32 v1, v1
  v_mfma_f32_16x16x32_bf16 v[16:19], a[140:143], v[172:175], v[16:19]
  v_cvt_pk_bf16_f32 v0, v0, v1
  v_or_b32 v210, v210, v208
  v_mfma_f32_16x16x32_bf16 v[24:27], a[140:143], v[188:191], v[204:207]
  v_exp_f32 v2, v2
  v_mfma_f32_16x16x32_bf16 v[24:27], a[136:139], v[184:187], v[24:27]
  buffer_load_dwordx4 v236, s[16:19], s29 offen offset:2048 lds
  v_mfma_f32_16x16x32_bf16 v[24:27], a[132:135], v[180:183], v[24:27]
  s_waitcnt lgkmcnt(0)
  v_exp_f32 v3, v3
  v_mfma_f32_16x16x32_bf16 v[24:27], a[128:131], v[176:179], v[24:27]
  v_cvt_pk_bf16_f32 v1, v2, v3
  v_bfe_u32 v211, v209, 2, 4
  v_mfma_f32_16x16x32_bf16 v[4:7], a[144:147], v[128:131], v[192:195]
  v_exp_f32 v8, v8
  v_mfma_f32_16x16x32_bf16 v[4:7], a[148:151], v[132:135], v[4:7]
  ds_read_b128 a[128:131], v212 offset:40960
  v_and_b32 v209, 3, v209
  v_mfma_f32_16x16x32_bf16 v[4:7], a[152:155], v[136:139], v[4:7]
  v_exp_f32 v9, v9
  v_mfma_f32_16x16x32_bf16 v[4:7], a[156:159], v[140:143], v[4:7]
  ds_read_b128 a[132:135], v213 offset:40960
  v_cvt_pk_bf16_f32 v8, v8, v9
  v_mfma_f32_16x16x32_bf16 v[12:15], a[156:159], v[156:159], v[196:199]
  v_exp_f32 v10, v10
  v_mfma_f32_16x16x32_bf16 v[12:15], a[152:155], v[152:155], v[12:15]
  ds_read_b128 a[136:139], v214 offset:40960
  v_lshlrev_b32 v209, 3, v209
  v_mfma_f32_16x16x32_bf16 v[12:15], a[148:151], v[148:151], v[12:15]
  v_exp_f32 v11, v11
  v_mfma_f32_16x16x32_bf16 v[12:15], a[144:147], v[144:147], v[12:15]
  ds_read_b128 a[140:143], v215 offset:40960
  v_cvt_pk_bf16_f32 v9, v10, v11
  v_mfma_f32_16x16x32_bf16 v[20:23], a[144:147], v[160:163], v[200:203]
  v_exp_f32 v16, v16
  v_mfma_f32_16x16x32_bf16 v[20:23], a[148:151], v[164:167], v[20:23]
  buffer_load_dwordx4 v237, s[16:19], s29 offen offset:3072 lds
  v_mfma_f32_16x16x32_bf16 v[20:23], a[152:155], v[168:171], v[20:23]
  s_add_u32 s29, s29, 16384
  v_exp_f32 v17, v17
  v_mfma_f32_16x16x32_bf16 v[20:23], a[156:159], v[172:175], v[20:23]
  v_cvt_pk_bf16_f32 v16, v16, v17
  v_lshl_add_u32 v209, v211, 5, v209
  v_mfma_f32_16x16x32_bf16 v[28:31], a[156:159], v[188:191], v[204:207]
  s_add_u32 m0, s28, 0
  v_exp_f32 v18, v18
  v_mfma_f32_16x16x32_bf16 v[28:31], a[152:155], v[184:187], v[28:31]
  buffer_load_dwordx4 v232, s[12:15], s29 offen offset:0 lds
  v_mfma_f32_16x16x32_bf16 v[28:31], a[148:151], v[180:183], v[28:31]
  s_waitcnt lgkmcnt(0)
  v_exp_f32 v19, v19
  v_mfma_f32_16x16x32_bf16 v[28:31], a[144:147], v[176:179], v[28:31]
  v_cvt_pk_bf16_f32 v17, v18, v19
  v_add_u32 v209, s50, v209
  v_mfma_f32_16x16x32_bf16 v[32:35], a[128:131], v[128:131], v[192:195]
  s_and_b32 s39, s2, 1
  s_lshl_b32 s39, s39, 2
  s_add_u32 s39, s39, s3
  v_exp_f32 v24, v24
  v_mfma_f32_16x16x32_bf16 v[32:35], a[132:135], v[132:135], v[32:35]
  ds_read_b128 a[144:147], v212 offset:45056
  s_lshr_b32 s31, s2, 1
  s_mul_i32 s30, s31, 40960
  s_mul_i32 s48, s39, 160
  v_mfma_f32_16x16x32_bf16 v[32:35], a[136:139], v[136:139], v[32:35]
  s_add_u32 s30, s30, s48
  s_mul_i32 s31, s31, 5120
  s_mul_i32 s39, s39, 655360
  v_exp_f32 v25, v25
  v_mfma_f32_16x16x32_bf16 v[32:35], a[140:143], v[140:143], v[32:35]
  ds_read_b128 a[148:151], v213 offset:45056
  s_add_u32 s31, s31, s39
  s_add_u32 s31, s31, 3145728
  s_lshr_b32 s39, s2, 3
  v_cvt_pk_bf16_f32 v24, v24, v25
  v_mfma_f32_16x16x32_bf16 v[40:43], a[140:143], v[156:159], v[196:199]
  s_min_u32 s39, s39, 29
  s_and_b32 s48, s2, 7
  s_mul_i32 s48, s48, 30
  v_exp_f32 v26, v26
  v_mfma_f32_16x16x32_bf16 v[40:43], a[136:139], v[152:155], v[40:43]
  ds_read_b128 a[152:155], v214 offset:45056
  s_add_u32 s39, s39, s48
  s_mul_i32 s98, s39, 1639
  s_lshr_b32 s98, s98, 16
  v_mfma_f32_16x16x32_bf16 v[40:43], a[132:135], v[148:151], v[40:43]
  s_mul_i32 s99, s98, 40
  s_sub_u32 s99, s39, s99
  s_min_u32 s39, s3, 2
  v_exp_f32 v27, v27
  v_mfma_f32_16x16x32_bf16 v[40:43], a[128:131], v[144:147], v[40:43]
  ds_read_b128 a[156:159], v215 offset:45056
  s_mul_i32 s48, s98, 3
  s_add_u32 s48, s48, s39
  s_mul_i32 s100, s48, 122880
  v_cvt_pk_bf16_f32 v25, v26, v27
  v_mfma_f32_16x16x32_bf16 v[48:51], a[128:131], v[160:163], v[200:203]
  s_lshl_b32 s39, s99, 5
  s_add_u32 s100, s100, s39
  s_mul_i32 s101, s48, 192
  v_exp_f32 v4, v4
  v_mfma_f32_16x16x32_bf16 v[48:51], a[132:135], v[164:167], v[48:51]
  buffer_load_dwordx4 v233, s[12:15], s29 offen offset:1024 lds
  s_add_u32 s101, s101, 2633728
  s_mov_b32 s51, s50
  v_mfma_f32_16x16x32_bf16 v[48:51], a[136:139], v[168:171], v[48:51]
  v_exp_f32 v5, v5
  v_mfma_f32_16x16x32_bf16 v[48:51], a[140:143], v[172:175], v[48:51]
  v_cvt_pk_bf16_f32 v2, v4, v5
  v_mov_b32 v211, v242
  v_mfma_f32_16x16x32_bf16 v[56:59], a[140:143], v[188:191], v[204:207]
  s_mov_b32 s4, s94
  s_mov_b32 s5, s95
  s_mov_b32 s6, 2211840
  v_exp_f32 v6, v6
  v_mfma_f32_16x16x32_bf16 v[56:59], a[136:139], v[184:187], v[56:59]
  buffer_load_dwordx4 v234, s[12:15], s29 offen offset:2048 lds
  s_mov_b32 s7, 0x20000
  s_getpc_b64 s[8:9]
attn_late_pc:
  s_add_u32 s8, s8, attn_h_ready-attn_late_pc
  s_addc_u32 s9, s9, 0
  v_mfma_f32_16x16x32_bf16 v[56:59], a[132:135], v[180:183], v[56:59]
  s_waitcnt lgkmcnt(0)
  s_lshr_b32 s39, s2, 3
  v_exp_f32 v7, v7
  v_mfma_f32_16x16x32_bf16 v[56:59], a[128:131], v[176:179], v[56:59]
  v_cvt_pk_bf16_f32 v3, v6, v7
  v_lshrrev_b32 v252, 4, v242
  v_mfma_f32_16x16x32_bf16 v[36:39], a[144:147], v[128:131], v[192:195]
  v_exp_f32 v12, v12
  v_mfma_f32_16x16x32_bf16 v[36:39], a[148:151], v[132:135], v[36:39]
  ds_read_b64_tr_b16 a[160:161], v216 offset:16384
  v_min_u32 v252, 11, v252
  v_mfma_f32_16x16x32_bf16 v[36:39], a[152:155], v[136:139], v[36:39]
  v_exp_f32 v13, v13
  v_mfma_f32_16x16x32_bf16 v[36:39], a[156:159], v[140:143], v[36:39]
  ds_read_b64_tr_b16 a[162:163], v216 offset:20480
  v_cvt_pk_bf16_f32 v10, v12, v13
  v_mfma_f32_16x16x32_bf16 v[44:47], a[156:159], v[156:159], v[196:199]
  v_exp_f32 v14, v14
  v_mfma_f32_16x16x32_bf16 v[44:47], a[152:155], v[152:155], v[44:47]
  ds_read_b64_tr_b16 a[164:165], v216 offset:24576
  buffer_load_dwordx4 v235, s[12:15], s29 offen offset:3072 lds
  v_mfma_f32_16x16x32_bf16 v[44:47], a[148:151], v[148:151], v[44:47]
  v_exp_f32 v15, v15
  v_mfma_f32_16x16x32_bf16 v[44:47], a[144:147], v[144:147], v[44:47]
  ds_read_b64_tr_b16 a[166:167], v216 offset:28672
  v_cvt_pk_bf16_f32 v11, v14, v15
  v_mfma_f32_16x16x32_bf16 v[52:55], a[144:147], v[160:163], v[200:203]
  v_exp_f32 v20, v20
  v_mfma_f32_16x16x32_bf16 v[52:55], a[148:151], v[164:167], v[52:55]
  ds_read_b64_tr_b16 a[168:169], v217 offset:16384
  v_lshlrev_b32 v252, 5, v252
  v_mfma_f32_16x16x32_bf16 v[52:55], a[152:155], v[168:171], v[52:55]
  v_exp_f32 v21, v21
  v_mfma_f32_16x16x32_bf16 v[52:55], a[156:159], v[172:175], v[52:55]
  ds_read_b64_tr_b16 a[170:171], v217 offset:20480
  v_cvt_pk_bf16_f32 v18, v20, v21
  v_mfma_f32_16x16x32_bf16 v[60:63], a[156:159], v[188:191], v[204:207]
  v_exp_f32 v22, v22
  v_mfma_f32_16x16x32_bf16 v[60:63], a[152:155], v[184:187], v[60:63]
  ds_read_b64_tr_b16 a[172:173], v217 offset:24576
  v_add_u32 v252, s39, v252
  v_mfma_f32_16x16x32_bf16 v[60:63], a[148:151], v[180:183], v[60:63]
  v_exp_f32 v23, v23
  v_mfma_f32_16x16x32_bf16 v[60:63], a[144:147], v[176:179], v[60:63]
  ds_read_b64_tr_b16 a[174:175], v217 offset:28672
  v_cvt_pk_bf16_f32 v19, v22, v23
  v_mfma_f32_16x16x32_bf16 a[192:195], a[208:211], v[64:67], a[192:195]
  v_exp_f32 v28, v28
  v_mfma_f32_16x16x32_bf16 a[192:195], a[208:211], v[96:99], a[192:195]
  ds_read_b64_tr_b16 a[176:177], v218 offset:16384
  v_lshlrev_b32 v252, 7, v252
  v_mfma_f32_16x16x32_bf16 a[196:199], a[208:211], v[72:75], a[196:199]
  v_exp_f32 v29, v29
  v_mfma_f32_16x16x32_bf16 a[196:199], a[208:211], v[104:107], a[196:199]
  ds_read_b64_tr_b16 a[178:179], v218 offset:20480
  v_cvt_pk_bf16_f32 v26, v28, v29
  v_mfma_f32_16x16x32_bf16 a[200:203], a[208:211], v[80:83], a[200:203]
  v_exp_f32 v30, v30
  v_mfma_f32_16x16x32_bf16 a[200:203], a[208:211], v[112:115], a[200:203]
  ds_read_b64_tr_b16 a[180:181], v218 offset:24576
  v_min_u32 v252, attn_end-attn_h_ready-4, v252
  v_mfma_f32_16x16x32_bf16 a[204:207], a[208:211], v[88:91], a[204:207]
  s_waitcnt lgkmcnt(7)
  v_exp_f32 v31, v31
  v_mfma_f32_16x16x32_bf16 a[204:207], a[208:211], v[120:123], a[204:207]
  ds_read_b64_tr_b16 a[182:183], v218 offset:28672
  v_cvt_pk_bf16_f32 v27, v30, v31
  v_mfma_f32_16x16x32_bf16 a[0:3], a[160:163], v[64:67], a[0:3]
  v_exp_f32 v32, v32
  v_mfma_f32_16x16x32_bf16 a[0:3], a[164:167], v[96:99], a[0:3]
  ds_read_b64_tr_b16 a[184:185], v219 offset:16384
  v_mfma_f32_16x16x32_bf16 a[4:7], a[164:167], v[104:107], a[4:7]
  v_exp_f32 v33, v33
  v_mfma_f32_16x16x32_bf16 a[4:7], a[160:163], v[72:75], a[4:7]
  ds_read_b64_tr_b16 a[186:187], v219 offset:20480
  v_cvt_pk_bf16_f32 v32, v32, v33
  v_mfma_f32_16x16x32_bf16 a[8:11], a[160:163], v[80:83], a[8:11]
  v_exp_f32 v34, v34
  v_mfma_f32_16x16x32_bf16 a[8:11], a[164:167], v[112:115], a[8:11]
  ds_read_b64_tr_b16 a[188:189], v219 offset:24576
  v_mfma_f32_16x16x32_bf16 a[12:15], a[164:167], v[120:123], a[12:15]
  s_waitcnt lgkmcnt(7)
  v_exp_f32 v35, v35
  v_mfma_f32_16x16x32_bf16 a[12:15], a[160:163], v[88:91], a[12:15]
  ds_read_b64_tr_b16 a[190:191], v219 offset:28672
  v_cvt_pk_bf16_f32 v33, v34, v35
  v_mfma_f32_16x16x32_bf16 a[16:19], a[168:171], v[64:67], a[16:19]
  v_exp_f32 v40, v40
  v_mfma_f32_16x16x32_bf16 a[16:19], a[172:175], v[96:99], a[16:19]
  ds_read_b64_tr_b16 a[160:161], v220 offset:16384
  v_mfma_f32_16x16x32_bf16 a[20:23], a[172:175], v[104:107], a[20:23]
  v_exp_f32 v41, v41
  v_mfma_f32_16x16x32_bf16 a[20:23], a[168:171], v[72:75], a[20:23]
  ds_read_b64_tr_b16 a[162:163], v220 offset:20480
  v_cvt_pk_bf16_f32 v40, v40, v41
  v_mfma_f32_16x16x32_bf16 a[24:27], a[168:171], v[80:83], a[24:27]
  v_exp_f32 v42, v42
  v_mfma_f32_16x16x32_bf16 a[24:27], a[172:175], v[112:115], a[24:27]
  ds_read_b64_tr_b16 a[164:165], v220 offset:24576
  v_mfma_f32_16x16x32_bf16 a[28:31], a[172:175], v[120:123], a[28:31]
  s_waitcnt lgkmcnt(7)
  v_exp_f32 v43, v43
  v_mfma_f32_16x16x32_bf16 a[28:31], a[168:171], v[88:91], a[28:31]
  ds_read_b64_tr_b16 a[166:167], v220 offset:28672
  v_cvt_pk_bf16_f32 v41, v42, v43
  v_mfma_f32_16x16x32_bf16 a[32:35], a[176:179], v[64:67], a[32:35]
  v_exp_f32 v48, v48
  v_mfma_f32_16x16x32_bf16 a[32:35], a[180:183], v[96:99], a[32:35]
  ds_read_b64_tr_b16 a[168:169], v221 offset:16384
  v_mfma_f32_16x16x32_bf16 a[36:39], a[180:183], v[104:107], a[36:39]
  v_exp_f32 v49, v49
  v_mfma_f32_16x16x32_bf16 a[36:39], a[176:179], v[72:75], a[36:39]
  ds_read_b64_tr_b16 a[170:171], v221 offset:20480
  v_cvt_pk_bf16_f32 v48, v48, v49
  v_mfma_f32_16x16x32_bf16 a[40:43], a[176:179], v[80:83], a[40:43]
  v_exp_f32 v50, v50
  v_mfma_f32_16x16x32_bf16 a[40:43], a[180:183], v[112:115], a[40:43]
  ds_read_b64_tr_b16 a[172:173], v221 offset:24576
  v_mfma_f32_16x16x32_bf16 a[44:47], a[180:183], v[120:123], a[44:47]
  s_waitcnt lgkmcnt(7)
  v_exp_f32 v51, v51
  v_mfma_f32_16x16x32_bf16 a[44:47], a[176:179], v[88:91], a[44:47]
  ds_read_b64_tr_b16 a[174:175], v221 offset:28672
  v_cvt_pk_bf16_f32 v49, v50, v51
  v_mfma_f32_16x16x32_bf16 a[48:51], a[184:187], v[64:67], a[48:51]
  v_exp_f32 v56, v56
  v_mfma_f32_16x16x32_bf16 a[48:51], a[188:191], v[96:99], a[48:51]
  ds_read_b64_tr_b16 a[176:177], v222 offset:16384
  v_mfma_f32_16x16x32_bf16 a[52:55], a[188:191], v[104:107], a[52:55]
  v_exp_f32 v57, v57
  v_mfma_f32_16x16x32_bf16 a[52:55], a[184:187], v[72:75], a[52:55]
  ds_read_b64_tr_b16 a[178:179], v222 offset:20480
  v_cvt_pk_bf16_f32 v56, v56, v57
  v_mfma_f32_16x16x32_bf16 a[56:59], a[184:187], v[80:83], a[56:59]
  v_exp_f32 v58, v58
  v_mfma_f32_16x16x32_bf16 a[56:59], a[188:191], v[112:115], a[56:59]
  ds_read_b64_tr_b16 a[180:181], v222 offset:24576
  v_mfma_f32_16x16x32_bf16 a[60:63], a[188:191], v[120:123], a[60:63]
  s_waitcnt lgkmcnt(7)
  v_exp_f32 v59, v59
  v_mfma_f32_16x16x32_bf16 a[60:63], a[184:187], v[88:91], a[60:63]
  ds_read_b64_tr_b16 a[182:183], v222 offset:28672
  v_cvt_pk_bf16_f32 v57, v58, v59
  v_mfma_f32_16x16x32_bf16 a[64:67], a[160:163], v[64:67], a[64:67]
  v_exp_f32 v36, v36
  v_mfma_f32_16x16x32_bf16 a[64:67], a[164:167], v[96:99], a[64:67]
  ds_read_b64_tr_b16 a[184:185], v223 offset:16384
  v_mfma_f32_16x16x32_bf16 a[68:71], a[164:167], v[104:107], a[68:71]
  v_exp_f32 v37, v37
  v_mfma_f32_16x16x32_bf16 a[68:71], a[160:163], v[72:75], a[68:71]
  ds_read_b64_tr_b16 a[186:187], v223 offset:20480
  v_cvt_pk_bf16_f32 v34, v36, v37
  v_mfma_f32_16x16x32_bf16 a[72:75], a[160:163], v[80:83], a[72:75]
  v_exp_f32 v38, v38
  v_mfma_f32_16x16x32_bf16 a[72:75], a[164:167], v[112:115], a[72:75]
  ds_read_b64_tr_b16 a[188:189], v223 offset:24576
  v_mfma_f32_16x16x32_bf16 a[76:79], a[164:167], v[120:123], a[76:79]
  s_waitcnt lgkmcnt(7)
  v_exp_f32 v39, v39
  v_mfma_f32_16x16x32_bf16 a[76:79], a[160:163], v[88:91], a[76:79]
  ds_read_b64_tr_b16 a[190:191], v223 offset:28672
  v_cvt_pk_bf16_f32 v35, v38, v39
  v_mfma_f32_16x16x32_bf16 a[80:83], a[168:171], v[64:67], a[80:83]
  s_waitcnt vmcnt(10)
  v_exp_f32 v44, v44
  v_mfma_f32_16x16x32_bf16 a[80:83], a[172:175], v[96:99], a[80:83]
  v_mfma_f32_16x16x32_bf16 a[84:87], a[172:175], v[104:107], a[84:87]
  s_barrier
  v_exp_f32 v45, v45
  v_mfma_f32_16x16x32_bf16 a[84:87], a[168:171], v[72:75], a[84:87]
  ds_read_b128 a[128:131], v212 offset:49152
  v_cvt_pk_bf16_f32 v42, v44, v45
  v_mfma_f32_16x16x32_bf16 a[88:91], a[168:171], v[80:83], a[88:91]
  v_exp_f32 v46, v46
  v_mfma_f32_16x16x32_bf16 a[88:91], a[172:175], v[112:115], a[88:91]
  ds_read_b128 a[132:135], v213 offset:49152
  v_mfma_f32_16x16x32_bf16 a[92:95], a[172:175], v[120:123], a[92:95]
  s_waitcnt lgkmcnt(6)
  v_exp_f32 v47, v47
  v_mfma_f32_16x16x32_bf16 a[92:95], a[168:171], v[88:91], a[92:95]
  ds_read_b128 a[136:139], v214 offset:49152
  v_cvt_pk_bf16_f32 v43, v46, v47
  v_mfma_f32_16x16x32_bf16 a[96:99], a[176:179], v[64:67], a[96:99]
  v_exp_f32 v52, v52
  v_mfma_f32_16x16x32_bf16 a[96:99], a[180:183], v[96:99], a[96:99]
  ds_read_b128 a[140:143], v215 offset:49152
  v_mfma_f32_16x16x32_bf16 a[100:103], a[180:183], v[104:107], a[100:103]
  v_exp_f32 v53, v53
  v_mfma_f32_16x16x32_bf16 a[100:103], a[176:179], v[72:75], a[100:103]
  v_cvt_pk_bf16_f32 v50, v52, v53
  v_mfma_f32_16x16x32_bf16 a[104:107], a[176:179], v[80:83], a[104:107]
  v_exp_f32 v54, v54
  v_mfma_f32_16x16x32_bf16 a[104:107], a[180:183], v[112:115], a[104:107]
  v_mfma_f32_16x16x32_bf16 a[108:111], a[180:183], v[120:123], a[108:111]
  s_waitcnt lgkmcnt(4)
  v_exp_f32 v55, v55
  v_mfma_f32_16x16x32_bf16 a[108:111], a[176:179], v[88:91], a[108:111]
  v_cvt_pk_bf16_f32 v51, v54, v55
  v_mfma_f32_16x16x32_bf16 a[112:115], a[184:187], v[64:67], a[112:115]
  v_exp_f32 v60, v60
  v_mfma_f32_16x16x32_bf16 a[112:115], a[188:191], v[96:99], a[112:115]
  v_mfma_f32_16x16x32_bf16 a[116:119], a[188:191], v[104:107], a[116:119]
  v_exp_f32 v61, v61
  v_mfma_f32_16x16x32_bf16 a[116:119], a[184:187], v[72:75], a[116:119]
  v_cvt_pk_bf16_f32 v58, v60, v61
  v_mfma_f32_16x16x32_bf16 a[120:123], a[184:187], v[80:83], a[120:123]
  v_exp_f32 v62, v62
  v_mfma_f32_16x16x32_bf16 a[120:123], a[188:191], v[112:115], a[120:123]
  v_mfma_f32_16x16x32_bf16 a[124:127], a[188:191], v[120:123], a[124:127]
  s_waitcnt lgkmcnt(0)
  v_exp_f32 v63, v63
  v_mfma_f32_16x16x32_bf16 a[124:127], a[184:187], v[88:91], a[124:127]
  v_cvt_pk_bf16_f32 v59, v62, v63
  v_mfma_f32_16x16x32_bf16 v[64:67], a[128:131], v[128:131], v[192:195]
  s_add_u32 m0, s28, 65536
  v_lshrrev_b32 v224, 4, v242
  v_lshrrev_b32 v225, 4, v224
  v_mfma_f32_16x16x32_bf16 v[64:67], a[132:135], v[132:135], v[64:67]
  ds_read_b128 a[144:147], v212 offset:53248
  v_bfe_u32 v226, v224, 2, 2
  v_mfma_f32_16x16x32_bf16 v[64:67], a[136:139], v[136:139], v[64:67]
  buffer_load_dwordx4 v236, s[16:19], s29 offen offset:0 lds
  v_mfma_f32_16x16x32_bf16 v[64:67], a[140:143], v[140:143], v[64:67]
  ds_read_b128 a[148:151], v213 offset:53248
  v_lshl_add_u32 v225, v225, 3, v226
  v_mfma_f32_16x16x32_bf16 v[72:75], a[140:143], v[156:159], v[196:199]
  v_lshlrev_b32 v225, 4, v225
  v_bfe_u32 v226, v224, 1, 1
  v_mfma_f32_16x16x32_bf16 v[72:75], a[136:139], v[152:155], v[72:75]
  ds_read_b128 a[152:155], v214 offset:53248
  v_mul_u32_u24 v226, 0xc00, v226
  v_mfma_f32_16x16x32_bf16 v[72:75], a[132:135], v[148:151], v[72:75]
  buffer_load_dwordx4 v237, s[16:19], s29 offen offset:1024 lds
  v_mfma_f32_16x16x32_bf16 v[72:75], a[128:131], v[144:147], v[72:75]
  ds_read_b128 a[156:159], v215 offset:53248
  v_add3_u32 v225, v225, v226, s50
  v_mfma_f32_16x16x32_bf16 v[80:83], a[128:131], v[160:163], v[200:203]
  v_exp_f32 v64, v64
  v_mfma_f32_16x16x32_bf16 v[80:83], a[132:135], v[164:167], v[80:83]
  v_and_b32 v226, 1, v224
  v_lshl_add_u32 v225, v226, 3, v225
  v_mfma_f32_16x16x32_bf16 v[80:83], a[136:139], v[168:171], v[80:83]
  s_waitcnt vmcnt(10)
  v_exp_f32 v65, v65
  v_mfma_f32_16x16x32_bf16 v[80:83], a[140:143], v[172:175], v[80:83]
  ds_read_b64_tr_b16 a[232:233], v225 offset:0
  v_cvt_pk_bf16_f32 v64, v64, v65
  v_mfma_f32_16x16x32_bf16 v[88:91], a[140:143], v[188:191], v[204:207]
  v_exp_f32 v66, v66
  v_mfma_f32_16x16x32_bf16 v[88:91], a[136:139], v[184:187], v[88:91]
  buffer_load_dwordx4 v236, s[16:19], s29 offen offset:2048 lds
  v_mfma_f32_16x16x32_bf16 v[88:91], a[132:135], v[180:183], v[88:91]
  s_waitcnt lgkmcnt(1)
  v_exp_f32 v67, v67
  v_mfma_f32_16x16x32_bf16 v[88:91], a[128:131], v[176:179], v[88:91]
  ds_read_b64_tr_b16 a[234:235], v225 offset:64
  v_cvt_pk_bf16_f32 v65, v66, v67
  v_mfma_f32_16x16x32_bf16 v[68:71], a[144:147], v[128:131], v[192:195]
  v_exp_f32 v72, v72
  v_mfma_f32_16x16x32_bf16 v[68:71], a[148:151], v[132:135], v[68:71]
  ds_read_b128 a[128:131], v212 offset:57344
  ds_read_b64_tr_b16 a[236:237], v225 offset:512
  v_mfma_f32_16x16x32_bf16 v[68:71], a[152:155], v[136:139], v[68:71]
  v_exp_f32 v73, v73
  v_mfma_f32_16x16x32_bf16 v[68:71], a[156:159], v[140:143], v[68:71]
  ds_read_b128 a[132:135], v213 offset:57344
  v_cvt_pk_bf16_f32 v72, v72, v73
  v_mfma_f32_16x16x32_bf16 v[76:79], a[156:159], v[156:159], v[196:199]
  v_exp_f32 v74, v74
  v_mfma_f32_16x16x32_bf16 v[76:79], a[152:155], v[152:155], v[76:79]
  ds_read_b128 a[136:139], v214 offset:57344
  ds_read_b64_tr_b16 a[238:239], v225 offset:576
  v_mfma_f32_16x16x32_bf16 v[76:79], a[148:151], v[148:151], v[76:79]
  v_exp_f32 v75, v75
  v_mfma_f32_16x16x32_bf16 v[76:79], a[144:147], v[144:147], v[76:79]
  ds_read_b128 a[140:143], v215 offset:57344
  v_cvt_pk_bf16_f32 v73, v74, v75
  v_mfma_f32_16x16x32_bf16 v[84:87], a[144:147], v[160:163], v[200:203]
  v_exp_f32 v80, v80
  v_mfma_f32_16x16x32_bf16 v[84:87], a[148:151], v[164:167], v[84:87]
  buffer_load_dwordx4 v237, s[16:19], s29 offen offset:3072 lds
  v_mfma_f32_16x16x32_bf16 v[84:87], a[152:155], v[168:171], v[84:87]
  s_add_u32 s29, s29, 16384
  v_exp_f32 v81, v81
  v_mfma_f32_16x16x32_bf16 v[84:87], a[156:159], v[172:175], v[84:87]
  ds_read_b64_tr_b16 a[240:241], v225 offset:1024
  v_cvt_pk_bf16_f32 v80, v80, v81
  v_mfma_f32_16x16x32_bf16 v[92:95], a[156:159], v[188:191], v[204:207]
  s_add_u32 m0, s28, 16384
  v_exp_f32 v82, v82
  v_mfma_f32_16x16x32_bf16 v[92:95], a[152:155], v[184:187], v[92:95]
  buffer_load_dwordx4 v232, s[12:15], s29 offen offset:0 lds
  v_mfma_f32_16x16x32_bf16 v[92:95], a[148:151], v[180:183], v[92:95]
  s_waitcnt lgkmcnt(1)
  v_exp_f32 v83, v83
  v_mfma_f32_16x16x32_bf16 v[92:95], a[144:147], v[176:179], v[92:95]
  ds_read_b64_tr_b16 a[242:243], v225 offset:1088
  v_cvt_pk_bf16_f32 v81, v82, v83
  v_mfma_f32_16x16x32_bf16 v[96:99], a[128:131], v[128:131], v[192:195]
  v_exp_f32 v88, v88
  v_mfma_f32_16x16x32_bf16 v[96:99], a[132:135], v[132:135], v[96:99]
  ds_read_b128 a[144:147], v212 offset:61440
  ds_read_b64_tr_b16 a[244:245], v225 offset:1536
  v_mfma_f32_16x16x32_bf16 v[96:99], a[136:139], v[136:139], v[96:99]
  v_exp_f32 v89, v89
  v_mfma_f32_16x16x32_bf16 v[96:99], a[140:143], v[140:143], v[96:99]
  ds_read_b128 a[148:151], v213 offset:61440
  v_cvt_pk_bf16_f32 v88, v88, v89
  v_mfma_f32_16x16x32_bf16 v[104:107], a[140:143], v[156:159], v[196:199]
  v_exp_f32 v90, v90
  v_mfma_f32_16x16x32_bf16 v[104:107], a[136:139], v[152:155], v[104:107]
  ds_read_b128 a[152:155], v214 offset:61440
  ds_read_b64_tr_b16 a[246:247], v225 offset:1600
  v_mfma_f32_16x16x32_bf16 v[104:107], a[132:135], v[148:151], v[104:107]
  v_exp_f32 v91, v91
  v_mfma_f32_16x16x32_bf16 v[104:107], a[128:131], v[144:147], v[104:107]
  ds_read_b128 a[156:159], v215 offset:61440
  v_cvt_pk_bf16_f32 v89, v90, v91
  v_mfma_f32_16x16x32_bf16 v[112:115], a[128:131], v[160:163], v[200:203]
  v_exp_f32 v68, v68
  v_mfma_f32_16x16x32_bf16 v[112:115], a[132:135], v[164:167], v[112:115]
  buffer_load_dwordx4 v233, s[12:15], s29 offen offset:1024 lds
  v_mfma_f32_16x16x32_bf16 v[112:115], a[136:139], v[168:171], v[112:115]
  v_exp_f32 v69, v69
  v_mfma_f32_16x16x32_bf16 v[112:115], a[140:143], v[172:175], v[112:115]
  ds_read_b64_tr_b16 a[248:249], v225 offset:2048
  v_cvt_pk_bf16_f32 v66, v68, v69
  v_mfma_f32_16x16x32_bf16 v[120:123], a[140:143], v[188:191], v[204:207]
  v_exp_f32 v70, v70
  v_mfma_f32_16x16x32_bf16 v[120:123], a[136:139], v[184:187], v[120:123]
  buffer_load_dwordx4 v234, s[12:15], s29 offen offset:2048 lds
  v_mfma_f32_16x16x32_bf16 v[120:123], a[132:135], v[180:183], v[120:123]
  s_waitcnt lgkmcnt(1)
  v_exp_f32 v71, v71
  v_mfma_f32_16x16x32_bf16 v[120:123], a[128:131], v[176:179], v[120:123]
  ds_read_b64_tr_b16 a[250:251], v225 offset:2112
  v_cvt_pk_bf16_f32 v67, v70, v71
  v_mfma_f32_16x16x32_bf16 v[100:103], a[144:147], v[128:131], v[192:195]
  v_exp_f32 v76, v76
  v_mfma_f32_16x16x32_bf16 v[100:103], a[148:151], v[132:135], v[100:103]
  ds_read_b64_tr_b16 a[160:161], v216 offset:32768
  v_mfma_f32_16x16x32_bf16 v[100:103], a[152:155], v[136:139], v[100:103]
  v_exp_f32 v77, v77
  v_mfma_f32_16x16x32_bf16 v[100:103], a[156:159], v[140:143], v[100:103]
  ds_read_b64_tr_b16 a[162:163], v216 offset:36864
  v_cvt_pk_bf16_f32 v74, v76, v77
  v_mfma_f32_16x16x32_bf16 v[108:111], a[156:159], v[156:159], v[196:199]
  v_exp_f32 v78, v78
  v_mfma_f32_16x16x32_bf16 v[108:111], a[152:155], v[152:155], v[108:111]
  ds_read_b64_tr_b16 a[164:165], v216 offset:40960
  buffer_load_dwordx4 v235, s[12:15], s29 offen offset:3072 lds
  v_mfma_f32_16x16x32_bf16 v[108:111], a[148:151], v[148:151], v[108:111]
  v_exp_f32 v79, v79
  v_mfma_f32_16x16x32_bf16 v[108:111], a[144:147], v[144:147], v[108:111]
  ds_read_b64_tr_b16 a[166:167], v216 offset:45056
  s_waitcnt lgkmcnt(4)
  v_cvt_pk_bf16_f32 v75, v78, v79
  v_mfma_f32_16x16x32_bf16 v[116:119], a[144:147], v[160:163], v[200:203]
  v_exp_f32 v84, v84
  v_mfma_f32_16x16x32_bf16 v[116:119], a[148:151], v[164:167], v[116:119]
  ds_read_b64_tr_b16 a[168:169], v217 offset:32768
  v_mfma_f32_16x16x32_bf16 v[228:231], a[232:235], a[212:215], 0
  v_mfma_f32_16x16x32_bf16 v[228:231], a[236:239], a[216:219], v[228:231]
  v_mfma_f32_16x16x32_bf16 v[228:231], a[240:243], a[220:223], v[228:231]
  v_mfma_f32_16x16x32_bf16 v[228:231], a[244:247], a[224:227], v[228:231]
  v_mfma_f32_16x16x32_bf16 v[228:231], a[248:251], a[228:231], v[228:231]
  v_mfma_f32_16x16x32_bf16 v[116:119], a[152:155], v[168:171], v[116:119]
  s_lshl_b32 s35, s3, 10
  s_add_u32 s35, s35, 159744
  v_exp_f32 v85, v85
  v_mfma_f32_16x16x32_bf16 v[116:119], a[156:159], v[172:175], v[116:119]
  ds_read_b64_tr_b16 a[170:171], v217 offset:36864
  v_cvt_pk_bf16_f32 v82, v84, v85
  v_mfma_f32_16x16x32_bf16 v[124:127], a[156:159], v[188:191], v[204:207]
  v_exp_f32 v86, v86
  v_mfma_f32_16x16x32_bf16 v[124:127], a[152:155], v[184:187], v[124:127]
  ds_read_b64_tr_b16 a[172:173], v217 offset:40960
  v_add_u32 v224, s35, v242
  v_mfma_f32_16x16x32_bf16 v[124:127], a[148:151], v[180:183], v[124:127]
  v_exp_f32 v87, v87
  v_mfma_f32_16x16x32_bf16 v[124:127], a[144:147], v[176:179], v[124:127]
  ds_read_b64_tr_b16 a[174:175], v217 offset:45056
  v_cvt_pk_bf16_f32 v83, v86, v87
  v_mfma_f32_16x16x32_bf16 a[192:195], a[208:211], v[0:3], a[192:195]
  v_exp_f32 v92, v92
  v_mfma_f32_16x16x32_bf16 a[192:195], a[208:211], v[32:35], a[192:195]
  ds_read_b64_tr_b16 a[176:177], v218 offset:32768
  ds_write_b128 v224, v[228:231]
  v_mfma_f32_16x16x32_bf16 a[196:199], a[208:211], v[8:11], a[196:199]
  v_exp_f32 v93, v93
  v_mfma_f32_16x16x32_bf16 a[196:199], a[208:211], v[40:43], a[196:199]
  ds_read_b64_tr_b16 a[178:179], v218 offset:36864
  v_cvt_pk_bf16_f32 v90, v92, v93
  v_mfma_f32_16x16x32_bf16 a[200:203], a[208:211], v[16:19], a[200:203]
  v_exp_f32 v94, v94
  v_mfma_f32_16x16x32_bf16 a[200:203], a[208:211], v[48:51], a[200:203]
  ds_read_b64_tr_b16 a[180:181], v218 offset:40960
  v_mfma_f32_16x16x32_bf16 a[204:207], a[208:211], v[24:27], a[204:207]
  s_waitcnt lgkmcnt(8)
  v_exp_f32 v95, v95
  v_mfma_f32_16x16x32_bf16 a[204:207], a[208:211], v[56:59], a[204:207]
  ds_read_b64_tr_b16 a[182:183], v218 offset:45056
  v_cvt_pk_bf16_f32 v91, v94, v95
  v_mfma_f32_16x16x32_bf16 a[0:3], a[160:163], v[0:3], a[0:3]
  v_exp_f32 v96, v96
  v_mfma_f32_16x16x32_bf16 a[0:3], a[164:167], v[32:35], a[0:3]
  ds_read_b64_tr_b16 a[184:185], v219 offset:32768
  s_waitcnt lgkmcnt(4)
  s_mov_b32 m0, s51
  v_mfma_f32_16x16x32_bf16 a[4:7], a[164:167], v[40:43], a[4:7]
  v_exp_f32 v97, v97
  v_mfma_f32_16x16x32_bf16 a[4:7], a[160:163], v[8:11], a[4:7]
  ds_read_b64_tr_b16 a[186:187], v219 offset:36864
  v_cvt_pk_bf16_f32 v96, v96, v97
  v_mfma_f32_16x16x32_bf16 a[8:11], a[160:163], v[16:19], a[8:11]
  v_exp_f32 v98, v98
  v_mfma_f32_16x16x32_bf16 a[8:11], a[164:167], v[48:51], a[8:11]
  ds_read_b64_tr_b16 a[188:189], v219 offset:40960
  buffer_load_dwordx4 v210, s[4:7], s100 offen lds
  s_add_u32 s100, s100, 20480
  s_add_u32 s51, s51, 512
  v_mfma_f32_16x16x32_bf16 a[12:15], a[164:167], v[56:59], a[12:15]
  v_exp_f32 v99, v99
  v_mfma_f32_16x16x32_bf16 a[12:15], a[160:163], v[24:27], a[12:15]
  ds_read_b64_tr_b16 a[190:191], v219 offset:45056
  v_cvt_pk_bf16_f32 v97, v98, v99
  v_mfma_f32_16x16x32_bf16 a[16:19], a[168:171], v[0:3], a[16:19]
  v_exp_f32 v104, v104
  v_mfma_f32_16x16x32_bf16 a[16:19], a[172:175], v[32:35], a[16:19]
  ds_read_b64_tr_b16 a[160:161], v220 offset:32768
  v_lshrrev_b32 v224, 4, v242
  v_mfma_f32_16x16x32_bf16 a[20:23], a[172:175], v[40:43], a[20:23]
  v_exp_f32 v105, v105
  v_mfma_f32_16x16x32_bf16 a[20:23], a[168:171], v[8:11], a[20:23]
  ds_read_b64_tr_b16 a[162:163], v220 offset:36864
  v_cvt_pk_bf16_f32 v104, v104, v105
  v_mfma_f32_16x16x32_bf16 a[24:27], a[168:171], v[16:19], a[24:27]
  v_exp_f32 v106, v106
  v_mfma_f32_16x16x32_bf16 a[24:27], a[172:175], v[48:51], a[24:27]
  ds_read_b64_tr_b16 a[164:165], v220 offset:40960
  v_bfe_u32 v225, v224, 2, 1
  v_mfma_f32_16x16x32_bf16 a[28:31], a[172:175], v[56:59], a[28:31]
  s_waitcnt lgkmcnt(7)
  v_exp_f32 v107, v107
  v_mfma_f32_16x16x32_bf16 a[28:31], a[168:171], v[24:27], a[28:31]
  ds_read_b64_tr_b16 a[166:167], v220 offset:45056
  v_cvt_pk_bf16_f32 v105, v106, v107
  v_mfma_f32_16x16x32_bf16 a[32:35], a[176:179], v[0:3], a[32:35]
  v_exp_f32 v112, v112
  v_mfma_f32_16x16x32_bf16 a[32:35], a[180:183], v[32:35], a[32:35]
  ds_read_b64_tr_b16 a[168:169], v221 offset:32768
  v_lshlrev_b32 v225, 8, v225
  v_mfma_f32_16x16x32_bf16 a[36:39], a[180:183], v[40:43], a[36:39]
  v_exp_f32 v113, v113
  v_mfma_f32_16x16x32_bf16 a[36:39], a[176:179], v[8:11], a[36:39]
  ds_read_b64_tr_b16 a[170:171], v221 offset:36864
  v_cvt_pk_bf16_f32 v112, v112, v113
  v_mfma_f32_16x16x32_bf16 a[40:43], a[176:179], v[16:19], a[40:43]
  v_exp_f32 v114, v114
  v_mfma_f32_16x16x32_bf16 a[40:43], a[180:183], v[48:51], a[40:43]
  ds_read_b64_tr_b16 a[172:173], v221 offset:40960
  v_lshrrev_b32 v226, 3, v224
  v_mfma_f32_16x16x32_bf16 a[44:47], a[180:183], v[56:59], a[44:47]
  s_waitcnt lgkmcnt(7)
  v_exp_f32 v115, v115
  v_mfma_f32_16x16x32_bf16 a[44:47], a[176:179], v[24:27], a[44:47]
  ds_read_b64_tr_b16 a[174:175], v221 offset:45056
  v_cvt_pk_bf16_f32 v113, v114, v115
  v_mfma_f32_16x16x32_bf16 a[48:51], a[184:187], v[0:3], a[48:51]
  v_exp_f32 v120, v120
  v_mfma_f32_16x16x32_bf16 a[48:51], a[188:191], v[32:35], a[48:51]
  ds_read_b64_tr_b16 a[176:177], v222 offset:32768
  v_lshl_add_u32 v225, v226, 4, v225
  v_mfma_f32_16x16x32_bf16 a[52:55], a[188:191], v[40:43], a[52:55]
  v_exp_f32 v121, v121
  v_mfma_f32_16x16x32_bf16 a[52:55], a[184:187], v[8:11], a[52:55]
  ds_read_b64_tr_b16 a[178:179], v222 offset:36864
  v_cvt_pk_bf16_f32 v120, v120, v121
  v_mfma_f32_16x16x32_bf16 a[56:59], a[184:187], v[16:19], a[56:59]
  v_exp_f32 v122, v122
  v_mfma_f32_16x16x32_bf16 a[56:59], a[188:191], v[48:51], a[56:59]
  ds_read_b64_tr_b16 a[180:181], v222 offset:40960
  v_and_b32 v227, 3, v224
  v_mfma_f32_16x16x32_bf16 a[60:63], a[188:191], v[56:59], a[60:63]
  s_waitcnt lgkmcnt(7)
  v_exp_f32 v123, v123
  v_mfma_f32_16x16x32_bf16 a[60:63], a[184:187], v[24:27], a[60:63]
  ds_read_b64_tr_b16 a[182:183], v222 offset:45056
  v_cvt_pk_bf16_f32 v121, v122, v123
  v_mfma_f32_16x16x32_bf16 a[64:67], a[160:163], v[0:3], a[64:67]
  v_exp_f32 v100, v100
  v_mfma_f32_16x16x32_bf16 a[64:67], a[164:167], v[32:35], a[64:67]
  ds_read_b64_tr_b16 a[184:185], v223 offset:32768
  v_lshl_add_u32 v225, v227, 2, v225
  v_mfma_f32_16x16x32_bf16 a[68:71], a[164:167], v[40:43], a[68:71]
  v_exp_f32 v101, v101
  v_mfma_f32_16x16x32_bf16 a[68:71], a[160:163], v[8:11], a[68:71]
  ds_read_b64_tr_b16 a[186:187], v223 offset:36864
  v_cvt_pk_bf16_f32 v98, v100, v101
  v_mfma_f32_16x16x32_bf16 a[72:75], a[160:163], v[16:19], a[72:75]
  v_exp_f32 v102, v102
  v_mfma_f32_16x16x32_bf16 a[72:75], a[164:167], v[48:51], a[72:75]
  ds_read_b64_tr_b16 a[188:189], v223 offset:40960
  v_add_u32 v225, 159744, v225
  v_mfma_f32_16x16x32_bf16 a[76:79], a[164:167], v[56:59], a[76:79]
  s_waitcnt lgkmcnt(7)
  v_exp_f32 v103, v103
  v_mfma_f32_16x16x32_bf16 a[76:79], a[160:163], v[24:27], a[76:79]
  ds_read_b64_tr_b16 a[190:191], v223 offset:45056
  v_cvt_pk_bf16_f32 v99, v102, v103
  v_mfma_f32_16x16x32_bf16 a[80:83], a[168:171], v[0:3], a[80:83]
  s_waitcnt vmcnt(9)
  v_exp_f32 v108, v108
  v_mfma_f32_16x16x32_bf16 a[80:83], a[172:175], v[32:35], a[80:83]
  v_mfma_f32_16x16x32_bf16 a[84:87], a[172:175], v[40:43], a[84:87]
  s_barrier
  v_exp_f32 v109, v109
  v_mfma_f32_16x16x32_bf16 a[84:87], a[168:171], v[8:11], a[84:87]
  ds_read_b128 a[128:131], v212 offset:0
  v_cvt_pk_bf16_f32 v106, v108, v109
  v_mfma_f32_16x16x32_bf16 a[88:91], a[168:171], v[16:19], a[88:91]
  v_exp_f32 v110, v110
  v_mfma_f32_16x16x32_bf16 a[88:91], a[172:175], v[48:51], a[88:91]
  ds_read_b128 a[132:135], v213 offset:0
  ds_read_b32 v228, v225 offset:0
  v_mfma_f32_16x16x32_bf16 a[92:95], a[172:175], v[56:59], a[92:95]
  s_waitcnt lgkmcnt(7)
  v_exp_f32 v111, v111
  v_mfma_f32_16x16x32_bf16 a[92:95], a[168:171], v[24:27], a[92:95]
  ds_read_b128 a[136:139], v214 offset:0
  v_cvt_pk_bf16_f32 v107, v110, v111
  v_mfma_f32_16x16x32_bf16 a[96:99], a[176:179], v[0:3], a[96:99]
  v_exp_f32 v116, v116
  v_mfma_f32_16x16x32_bf16 a[96:99], a[180:183], v[32:35], a[96:99]
  ds_read_b128 a[140:143], v215 offset:0
  ds_read_b32 v229, v225 offset:1024
  v_mfma_f32_16x16x32_bf16 a[100:103], a[180:183], v[40:43], a[100:103]
  v_exp_f32 v117, v117
  v_mfma_f32_16x16x32_bf16 a[100:103], a[176:179], v[8:11], a[100:103]
  ds_read_b32 v230, v225 offset:2048
  v_cvt_pk_bf16_f32 v114, v116, v117
  v_mfma_f32_16x16x32_bf16 a[104:107], a[176:179], v[16:19], a[104:107]
  v_exp_f32 v118, v118
  v_mfma_f32_16x16x32_bf16 a[104:107], a[180:183], v[48:51], a[104:107]
  ds_read_b32 v231, v225 offset:3072
  ds_read_b32 v238, v225 offset:512
  v_mfma_f32_16x16x32_bf16 a[108:111], a[180:183], v[56:59], a[108:111]
  s_waitcnt lgkmcnt(9)
  v_exp_f32 v119, v119
  v_mfma_f32_16x16x32_bf16 a[108:111], a[176:179], v[24:27], a[108:111]
  ds_read_b32 v239, v225 offset:1536
  v_cvt_pk_bf16_f32 v115, v118, v119
  v_mfma_f32_16x16x32_bf16 a[112:115], a[184:187], v[0:3], a[112:115]
  v_exp_f32 v124, v124
  v_mfma_f32_16x16x32_bf16 a[112:115], a[188:191], v[32:35], a[112:115]
  ds_read_b32 v240, v225 offset:2560
  ds_read_b32 v241, v225 offset:3584
  s_cmp_eq_u32 s3, 0
  s_cselect_b32 s35, 0, 1073741824
  v_mfma_f32_16x16x32_bf16 a[116:119], a[188:191], v[40:43], a[116:119]
  v_exp_f32 v125, v125
  v_mfma_f32_16x16x32_bf16 a[116:119], a[184:187], v[8:11], a[116:119]
  v_cvt_pk_bf16_f32 v122, v124, v125
  v_mul_u32_u24 v226, 0xd80, v226
  v_mfma_f32_16x16x32_bf16 a[120:123], a[184:187], v[16:19], a[120:123]
  v_exp_f32 v126, v126
  v_mfma_f32_16x16x32_bf16 a[120:123], a[188:191], v[48:51], a[120:123]
  v_and_b32 v227, 7, v224
  v_lshl_add_u32 v226, v227, 1, v226
  v_mfma_f32_16x16x32_bf16 a[124:127], a[188:191], v[56:59], a[124:127]
  s_waitcnt lgkmcnt(7)
  v_exp_f32 v127, v127
  v_mfma_f32_16x16x32_bf16 a[124:127], a[184:187], v[24:27], a[124:127]
  v_cvt_pk_bf16_f32 v123, v126, v127
  v_and_b32 v227, 1, v224
  v_lshl_add_u32 v226, v227, 30, v226
  v_or_b32 v226, s35, v226
  v_min_u32 v249, 1, v224
  v_lshlrev_b32 v249, 30, v249
  v_or_b32 v249, s35, v249
  v_mov_b32 v251, v249
  v_mov_b32 v250, 1
  s_mov_b32 s47, 2818048
  s_lshl_b32 s35, s33, 4
  s_add_u32 s35, s35, 2633728
  s_waitcnt lgkmcnt(0)
  v_add_f32 v228, v228, v229
  v_add_f32 v238, v238, v239
  v_add_f32 v230, v230, v231
  v_add_f32 v240, v240, v241
  v_add_f32 v228, v228, v230
  v_add_f32 v238, v238, v240
  v_cvt_pk_bf16_f32 v228, v228, v228
  v_cvt_pk_bf16_f32 v238, v238, v238
  v_lshlrev_b32 v228, 16, v228
  v_lshlrev_b32 v238, 16, v238
  v_mul_f32 v229, 0xbfb8aa3b, v228
  v_exp_f32 v229, v229
  s_nop 0
  v_add_f32 v229, 1.0, v229
  v_rcp_f32 v229, v229
  s_nop 0
  v_mul_f32 v228, v228, v229
  v_cvt_pk_bf16_f32 v228, v228, v228
  v_lshlrev_b32 v228, 16, v228
  v_mul_f32 v228, v228, v238
  s_nop 1
  v_mov_b32_dpp v229, v228 quad_perm:[1,0,3,2] row_mask:0xf bank_mask:0xf
  v_cvt_pk_bf16_f32 v228, v228, v229
  buffer_store_dword v228, v226, s[24:27], s35 offen sc1
  s_mov_b32 s32, 5
attn_loop:
  v_mfma_f32_16x16x32_bf16 v[0:3], a[128:131], v[128:131], v[192:195]
  s_add_u32 m0, s28, 81920
  v_mfma_f32_16x16x32_bf16 v[0:3], a[132:135], v[132:135], v[0:3]
  ds_read_b128 a[144:147], v212 offset:4096
  v_mfma_f32_16x16x32_bf16 v[0:3], a[136:139], v[136:139], v[0:3]
  buffer_load_dwordx4 v236, s[16:19], s29 offen offset:0 lds
  v_mfma_f32_16x16x32_bf16 v[0:3], a[140:143], v[140:143], v[0:3]
  ds_read_b128 a[148:151], v213 offset:4096
  v_mfma_f32_16x16x32_bf16 v[8:11], a[140:143], v[156:159], v[196:199]
  v_mfma_f32_16x16x32_bf16 v[8:11], a[136:139], v[152:155], v[8:11]
  ds_read_b128 a[152:155], v214 offset:4096
  v_mfma_f32_16x16x32_bf16 v[8:11], a[132:135], v[148:151], v[8:11]
  buffer_load_dwordx4 v237, s[16:19], s29 offen offset:1024 lds
  v_mfma_f32_16x16x32_bf16 v[8:11], a[128:131], v[144:147], v[8:11]
  ds_read_b128 a[156:159], v215 offset:4096
  v_mfma_f32_16x16x32_bf16 v[16:19], a[128:131], v[160:163], v[200:203]
  v_exp_f32 v0, v0
  v_mfma_f32_16x16x32_bf16 v[16:19], a[132:135], v[164:167], v[16:19]
  v_mfma_f32_16x16x32_bf16 v[16:19], a[136:139], v[168:171], v[16:19]
  v_exp_f32 v1, v1
  v_mfma_f32_16x16x32_bf16 v[16:19], a[140:143], v[172:175], v[16:19]
  v_cvt_pk_bf16_f32 v0, v0, v1
  v_mfma_f32_16x16x32_bf16 v[24:27], a[140:143], v[188:191], v[204:207]
  v_exp_f32 v2, v2
  v_mfma_f32_16x16x32_bf16 v[24:27], a[136:139], v[184:187], v[24:27]
  buffer_load_dwordx4 v236, s[16:19], s29 offen offset:2048 lds
  v_mfma_f32_16x16x32_bf16 v[24:27], a[132:135], v[180:183], v[24:27]
  s_waitcnt lgkmcnt(0)
  v_exp_f32 v3, v3
  v_mfma_f32_16x16x32_bf16 v[24:27], a[128:131], v[176:179], v[24:27]
  v_cvt_pk_bf16_f32 v1, v2, v3
  v_mfma_f32_16x16x32_bf16 v[4:7], a[144:147], v[128:131], v[192:195]
  v_exp_f32 v8, v8
  v_mfma_f32_16x16x32_bf16 v[4:7], a[148:151], v[132:135], v[4:7]
  ds_read_b128 a[128:131], v212 offset:8192
  v_mfma_f32_16x16x32_bf16 v[4:7], a[152:155], v[136:139], v[4:7]
  v_exp_f32 v9, v9
  v_mfma_f32_16x16x32_bf16 v[4:7], a[156:159], v[140:143], v[4:7]
  ds_read_b128 a[132:135], v213 offset:8192
  v_cvt_pk_bf16_f32 v8, v8, v9
  v_mfma_f32_16x16x32_bf16 v[12:15], a[156:159], v[156:159], v[196:199]
  v_exp_f32 v10, v10
  v_mfma_f32_16x16x32_bf16 v[12:15], a[152:155], v[152:155], v[12:15]
  ds_read_b128 a[136:139], v214 offset:8192
  v_mfma_f32_16x16x32_bf16 v[12:15], a[148:151], v[148:151], v[12:15]
  v_exp_f32 v11, v11
  v_mfma_f32_16x16x32_bf16 v[12:15], a[144:147], v[144:147], v[12:15]
  ds_read_b128 a[140:143], v215 offset:8192
  v_cvt_pk_bf16_f32 v9, v10, v11
  v_mfma_f32_16x16x32_bf16 v[20:23], a[144:147], v[160:163], v[200:203]
  v_exp_f32 v16, v16
  v_mfma_f32_16x16x32_bf16 v[20:23], a[148:151], v[164:167], v[20:23]
  buffer_load_dwordx4 v237, s[16:19], s29 offen offset:3072 lds
  v_mfma_f32_16x16x32_bf16 v[20:23], a[152:155], v[168:171], v[20:23]
  s_add_u32 s29, s29, 16384
  v_exp_f32 v17, v17
  v_mfma_f32_16x16x32_bf16 v[20:23], a[156:159], v[172:175], v[20:23]
  v_cvt_pk_bf16_f32 v16, v16, v17
  v_mfma_f32_16x16x32_bf16 v[28:31], a[156:159], v[188:191], v[204:207]
  s_add_u32 m0, s28, 32768
  v_exp_f32 v18, v18
  v_mfma_f32_16x16x32_bf16 v[28:31], a[152:155], v[184:187], v[28:31]
  buffer_load_dwordx4 v232, s[12:15], s29 offen offset:0 lds
  v_mfma_f32_16x16x32_bf16 v[28:31], a[148:151], v[180:183], v[28:31]
  s_waitcnt lgkmcnt(0)
  v_exp_f32 v19, v19
  v_mfma_f32_16x16x32_bf16 v[28:31], a[144:147], v[176:179], v[28:31]
  v_cvt_pk_bf16_f32 v17, v18, v19
  v_mfma_f32_16x16x32_bf16 v[32:35], a[128:131], v[128:131], v[192:195]
  v_exp_f32 v24, v24
  v_mfma_f32_16x16x32_bf16 v[32:35], a[132:135], v[132:135], v[32:35]
  ds_read_b128 a[144:147], v212 offset:12288
  v_mfma_f32_16x16x32_bf16 v[32:35], a[136:139], v[136:139], v[32:35]
  v_exp_f32 v25, v25
  v_mfma_f32_16x16x32_bf16 v[32:35], a[140:143], v[140:143], v[32:35]
  ds_read_b128 a[148:151], v213 offset:12288
  v_cvt_pk_bf16_f32 v24, v24, v25
  v_mfma_f32_16x16x32_bf16 v[40:43], a[140:143], v[156:159], v[196:199]
  v_exp_f32 v26, v26
  v_mfma_f32_16x16x32_bf16 v[40:43], a[136:139], v[152:155], v[40:43]
  ds_read_b128 a[152:155], v214 offset:12288
  v_mfma_f32_16x16x32_bf16 v[40:43], a[132:135], v[148:151], v[40:43]
  v_exp_f32 v27, v27
  v_mfma_f32_16x16x32_bf16 v[40:43], a[128:131], v[144:147], v[40:43]
  ds_read_b128 a[156:159], v215 offset:12288
  v_cvt_pk_bf16_f32 v25, v26, v27
  v_mfma_f32_16x16x32_bf16 v[48:51], a[128:131], v[160:163], v[200:203]
  v_exp_f32 v4, v4
  v_mfma_f32_16x16x32_bf16 v[48:51], a[132:135], v[164:167], v[48:51]
  buffer_load_dwordx4 v233, s[12:15], s29 offen offset:1024 lds
  v_mfma_f32_16x16x32_bf16 v[48:51], a[136:139], v[168:171], v[48:51]
  v_exp_f32 v5, v5
  v_mfma_f32_16x16x32_bf16 v[48:51], a[140:143], v[172:175], v[48:51]
  v_cvt_pk_bf16_f32 v2, v4, v5
  v_mfma_f32_16x16x32_bf16 v[56:59], a[140:143], v[188:191], v[204:207]
  v_exp_f32 v6, v6
  v_mfma_f32_16x16x32_bf16 v[56:59], a[136:139], v[184:187], v[56:59]
  buffer_load_dwordx4 v234, s[12:15], s29 offen offset:2048 lds
  v_mfma_f32_16x16x32_bf16 v[56:59], a[132:135], v[180:183], v[56:59]
  s_waitcnt lgkmcnt(0)
  v_exp_f32 v7, v7
  v_mfma_f32_16x16x32_bf16 v[56:59], a[128:131], v[176:179], v[56:59]
  v_cvt_pk_bf16_f32 v3, v6, v7
  v_mfma_f32_16x16x32_bf16 v[36:39], a[144:147], v[128:131], v[192:195]
  v_exp_f32 v12, v12
  v_mfma_f32_16x16x32_bf16 v[36:39], a[148:151], v[132:135], v[36:39]
  ds_read_b64_tr_b16 a[160:161], v216 offset:49152
  v_mfma_f32_16x16x32_bf16 v[36:39], a[152:155], v[136:139], v[36:39]
  v_exp_f32 v13, v13
  v_mfma_f32_16x16x32_bf16 v[36:39], a[156:159], v[140:143], v[36:39]
  ds_read_b64_tr_b16 a[162:163], v216 offset:53248
  v_cvt_pk_bf16_f32 v10, v12, v13
  v_mfma_f32_16x16x32_bf16 v[44:47], a[156:159], v[156:159], v[196:199]
  v_exp_f32 v14, v14
  v_mfma_f32_16x16x32_bf16 v[44:47], a[152:155], v[152:155], v[44:47]
  ds_read_b64_tr_b16 a[164:165], v216 offset:57344
  buffer_load_dwordx4 v235, s[12:15], s29 offen offset:3072 lds
  v_mfma_f32_16x16x32_bf16 v[44:47], a[148:151], v[148:151], v[44:47]
  v_exp_f32 v15, v15
  v_mfma_f32_16x16x32_bf16 v[44:47], a[144:147], v[144:147], v[44:47]
  ds_read_b64_tr_b16 a[166:167], v216 offset:61440
  v_cvt_pk_bf16_f32 v11, v14, v15
  v_mfma_f32_16x16x32_bf16 v[52:55], a[144:147], v[160:163], v[200:203]
  s_add_u32 m0, s50, 4096
  v_exp_f32 v20, v20
  v_mfma_f32_16x16x32_bf16 v[52:55], a[148:151], v[164:167], v[52:55]
  ds_read_b64_tr_b16 a[168:169], v217 offset:49152
  buffer_load_dwordx4 v208, s[20:23], s30 offen lds
  s_add_u32 s30, s30, 32
  v_mfma_f32_16x16x32_bf16 v[52:55], a[152:155], v[168:171], v[52:55]
  v_exp_f32 v21, v21
  v_mfma_f32_16x16x32_bf16 v[52:55], a[156:159], v[172:175], v[52:55]
  ds_read_b64_tr_b16 a[170:171], v217 offset:53248
  v_cvt_pk_bf16_f32 v18, v20, v21
  v_mfma_f32_16x16x32_bf16 v[60:63], a[156:159], v[188:191], v[204:207]
  v_exp_f32 v22, v22
  v_mfma_f32_16x16x32_bf16 v[60:63], a[152:155], v[184:187], v[60:63]
  ds_read_b64_tr_b16 a[172:173], v217 offset:57344
  v_mfma_f32_16x16x32_bf16 v[60:63], a[148:151], v[180:183], v[60:63]
  v_exp_f32 v23, v23
  v_mfma_f32_16x16x32_bf16 v[60:63], a[144:147], v[176:179], v[60:63]
  ds_read_b64_tr_b16 a[174:175], v217 offset:61440
  v_cvt_pk_bf16_f32 v19, v22, v23
  v_mfma_f32_16x16x32_bf16 a[192:195], a[208:211], v[64:67], a[192:195]
  v_exp_f32 v28, v28
  v_mfma_f32_16x16x32_bf16 a[192:195], a[208:211], v[96:99], a[192:195]
  ds_read_b64_tr_b16 a[176:177], v218 offset:49152
  v_mfma_f32_16x16x32_bf16 a[196:199], a[208:211], v[72:75], a[196:199]
  v_exp_f32 v29, v29
  v_mfma_f32_16x16x32_bf16 a[196:199], a[208:211], v[104:107], a[196:199]
  ds_read_b64_tr_b16 a[178:179], v218 offset:53248
  v_cvt_pk_bf16_f32 v26, v28, v29
  v_mfma_f32_16x16x32_bf16 a[200:203], a[208:211], v[80:83], a[200:203]
  v_exp_f32 v30, v30
  v_mfma_f32_16x16x32_bf16 a[200:203], a[208:211], v[112:115], a[200:203]
  ds_read_b64_tr_b16 a[180:181], v218 offset:57344
  v_mfma_f32_16x16x32_bf16 a[204:207], a[208:211], v[88:91], a[204:207]
  s_waitcnt lgkmcnt(7)
  v_exp_f32 v31, v31
  v_mfma_f32_16x16x32_bf16 a[204:207], a[208:211], v[120:123], a[204:207]
  ds_read_b64_tr_b16 a[182:183], v218 offset:61440
  v_cvt_pk_bf16_f32 v27, v30, v31
  v_mfma_f32_16x16x32_bf16 a[0:3], a[160:163], v[64:67], a[0:3]
  v_exp_f32 v32, v32
  v_mfma_f32_16x16x32_bf16 a[0:3], a[164:167], v[96:99], a[0:3]
  ds_read_b64_tr_b16 a[184:185], v219 offset:49152
  v_mfma_f32_16x16x32_bf16 a[4:7], a[164:167], v[104:107], a[4:7]
  v_exp_f32 v33, v33
  v_mfma_f32_16x16x32_bf16 a[4:7], a[160:163], v[72:75], a[4:7]
  ds_read_b64_tr_b16 a[186:187], v219 offset:53248
  v_cvt_pk_bf16_f32 v32, v32, v33
  v_mfma_f32_16x16x32_bf16 a[8:11], a[160:163], v[80:83], a[8:11]
  v_exp_f32 v34, v34
  v_mfma_f32_16x16x32_bf16 a[8:11], a[164:167], v[112:115], a[8:11]
  ds_read_b64_tr_b16 a[188:189], v219 offset:57344
  v_mfma_f32_16x16x32_bf16 a[12:15], a[164:167], v[120:123], a[12:15]
  s_waitcnt lgkmcnt(7)
  v_exp_f32 v35, v35
  v_mfma_f32_16x16x32_bf16 a[12:15], a[160:163], v[88:91], a[12:15]
  ds_read_b64_tr_b16 a[190:191], v219 offset:61440
  v_cvt_pk_bf16_f32 v33, v34, v35
  v_mfma_f32_16x16x32_bf16 a[16:19], a[168:171], v[64:67], a[16:19]
  v_exp_f32 v40, v40
  v_mfma_f32_16x16x32_bf16 a[16:19], a[172:175], v[96:99], a[16:19]
  ds_read_b64_tr_b16 a[160:161], v220 offset:49152
  v_mfma_f32_16x16x32_bf16 a[20:23], a[172:175], v[104:107], a[20:23]
  v_exp_f32 v41, v41
  v_mfma_f32_16x16x32_bf16 a[20:23], a[168:171], v[72:75], a[20:23]
  ds_read_b64_tr_b16 a[162:163], v220 offset:53248
  v_cvt_pk_bf16_f32 v40, v40, v41
  v_mfma_f32_16x16x32_bf16 a[24:27], a[168:171], v[80:83], a[24:27]
  v_exp_f32 v42, v42
  v_mfma_f32_16x16x32_bf16 a[24:27], a[172:175], v[112:115], a[24:27]
  ds_read_b64_tr_b16 a[164:165], v220 offset:57344
  v_mfma_f32_16x16x32_bf16 a[28:31], a[172:175], v[120:123], a[28:31]
  s_waitcnt lgkmcnt(7)
  v_exp_f32 v43, v43
  v_mfma_f32_16x16x32_bf16 a[28:31], a[168:171], v[88:91], a[28:31]
  ds_read_b64_tr_b16 a[166:167], v220 offset:61440
  v_cvt_pk_bf16_f32 v41, v42, v43
  v_mfma_f32_16x16x32_bf16 a[32:35], a[176:179], v[64:67], a[32:35]
  v_exp_f32 v48, v48
  v_mfma_f32_16x16x32_bf16 a[32:35], a[180:183], v[96:99], a[32:35]
  ds_read_b64_tr_b16 a[168:169], v221 offset:49152
  v_mfma_f32_16x16x32_bf16 a[36:39], a[180:183], v[104:107], a[36:39]
  v_exp_f32 v49, v49
  v_mfma_f32_16x16x32_bf16 a[36:39], a[176:179], v[72:75], a[36:39]
  ds_read_b64_tr_b16 a[170:171], v221 offset:53248
  v_cvt_pk_bf16_f32 v48, v48, v49
  v_mfma_f32_16x16x32_bf16 a[40:43], a[176:179], v[80:83], a[40:43]
  v_exp_f32 v50, v50
  v_mfma_f32_16x16x32_bf16 a[40:43], a[180:183], v[112:115], a[40:43]
  ds_read_b64_tr_b16 a[172:173], v221 offset:57344
  v_mfma_f32_16x16x32_bf16 a[44:47], a[180:183], v[120:123], a[44:47]
  s_waitcnt lgkmcnt(7)
  v_exp_f32 v51, v51
  v_mfma_f32_16x16x32_bf16 a[44:47], a[176:179], v[88:91], a[44:47]
  ds_read_b64_tr_b16 a[174:175], v221 offset:61440
  v_cvt_pk_bf16_f32 v49, v50, v51
  v_mfma_f32_16x16x32_bf16 a[48:51], a[184:187], v[64:67], a[48:51]
  v_exp_f32 v56, v56
  v_mfma_f32_16x16x32_bf16 a[48:51], a[188:191], v[96:99], a[48:51]
  ds_read_b64_tr_b16 a[176:177], v222 offset:49152
  v_mfma_f32_16x16x32_bf16 a[52:55], a[188:191], v[104:107], a[52:55]
  v_exp_f32 v57, v57
  v_mfma_f32_16x16x32_bf16 a[52:55], a[184:187], v[72:75], a[52:55]
  ds_read_b64_tr_b16 a[178:179], v222 offset:53248
  v_cvt_pk_bf16_f32 v56, v56, v57
  v_mfma_f32_16x16x32_bf16 a[56:59], a[184:187], v[80:83], a[56:59]
  v_exp_f32 v58, v58
  v_mfma_f32_16x16x32_bf16 a[56:59], a[188:191], v[112:115], a[56:59]
  ds_read_b64_tr_b16 a[180:181], v222 offset:57344
  global_load_dword v255, v252, s[8:9]
  v_mfma_f32_16x16x32_bf16 a[60:63], a[188:191], v[120:123], a[60:63]
  s_waitcnt lgkmcnt(7)
  v_exp_f32 v59, v59
  v_mfma_f32_16x16x32_bf16 a[60:63], a[184:187], v[88:91], a[60:63]
  ds_read_b64_tr_b16 a[182:183], v222 offset:61440
  v_cvt_pk_bf16_f32 v57, v58, v59
  v_mfma_f32_16x16x32_bf16 a[64:67], a[160:163], v[64:67], a[64:67]
  v_exp_f32 v36, v36
  v_mfma_f32_16x16x32_bf16 a[64:67], a[164:167], v[96:99], a[64:67]
  ds_read_b64_tr_b16 a[184:185], v223 offset:49152
  v_mfma_f32_16x16x32_bf16 a[68:71], a[164:167], v[104:107], a[68:71]
  v_exp_f32 v37, v37
  v_mfma_f32_16x16x32_bf16 a[68:71], a[160:163], v[72:75], a[68:71]
  ds_read_b64_tr_b16 a[186:187], v223 offset:53248
  v_cvt_pk_bf16_f32 v34, v36, v37
  v_mfma_f32_16x16x32_bf16 a[72:75], a[160:163], v[80:83], a[72:75]
  v_exp_f32 v38, v38
  v_mfma_f32_16x16x32_bf16 a[72:75], a[164:167], v[112:115], a[72:75]
  ds_read_b64_tr_b16 a[188:189], v223 offset:57344
  v_mfma_f32_16x16x32_bf16 a[76:79], a[164:167], v[120:123], a[76:79]
  s_waitcnt lgkmcnt(7)
  v_exp_f32 v39, v39
  v_mfma_f32_16x16x32_bf16 a[76:79], a[160:163], v[88:91], a[76:79]
  ds_read_b64_tr_b16 a[190:191], v223 offset:61440
  v_cvt_pk_bf16_f32 v35, v38, v39
  v_mfma_f32_16x16x32_bf16 a[80:83], a[168:171], v[64:67], a[80:83]
  s_waitcnt vmcnt(12)
  v_exp_f32 v44, v44
  v_mfma_f32_16x16x32_bf16 a[80:83], a[172:175], v[96:99], a[80:83]
  v_mfma_f32_16x16x32_bf16 a[84:87], a[172:175], v[104:107], a[84:87]
  s_barrier
  v_exp_f32 v45, v45
  v_mfma_f32_16x16x32_bf16 a[84:87], a[168:171], v[72:75], a[84:87]
  ds_read_b128 a[128:131], v212 offset:16384
  v_cvt_pk_bf16_f32 v42, v44, v45
  v_mfma_f32_16x16x32_bf16 a[88:91], a[168:171], v[80:83], a[88:91]
  v_exp_f32 v46, v46
  v_mfma_f32_16x16x32_bf16 a[88:91], a[172:175], v[112:115], a[88:91]
  ds_read_b128 a[132:135], v213 offset:16384
  v_mfma_f32_16x16x32_bf16 a[92:95], a[172:175], v[120:123], a[92:95]
  s_waitcnt lgkmcnt(6)
  v_exp_f32 v47, v47
  v_mfma_f32_16x16x32_bf16 a[92:95], a[168:171], v[88:91], a[92:95]
  ds_read_b128 a[136:139], v214 offset:16384
  v_cvt_pk_bf16_f32 v43, v46, v47
  v_mfma_f32_16x16x32_bf16 a[96:99], a[176:179], v[64:67], a[96:99]
  v_exp_f32 v52, v52
  v_mfma_f32_16x16x32_bf16 a[96:99], a[180:183], v[96:99], a[96:99]
  ds_read_b128 a[140:143], v215 offset:16384
  v_mfma_f32_16x16x32_bf16 a[100:103], a[180:183], v[104:107], a[100:103]
  v_exp_f32 v53, v53
  v_mfma_f32_16x16x32_bf16 a[100:103], a[176:179], v[72:75], a[100:103]
  v_cvt_pk_bf16_f32 v50, v52, v53
  v_mfma_f32_16x16x32_bf16 a[104:107], a[176:179], v[80:83], a[104:107]
  v_exp_f32 v54, v54
  v_mfma_f32_16x16x32_bf16 a[104:107], a[180:183], v[112:115], a[104:107]
  v_mfma_f32_16x16x32_bf16 a[108:111], a[180:183], v[120:123], a[108:111]
  s_waitcnt lgkmcnt(4)
  v_exp_f32 v55, v55
  v_mfma_f32_16x16x32_bf16 a[108:111], a[176:179], v[88:91], a[108:111]
  v_cvt_pk_bf16_f32 v51, v54, v55
  v_mfma_f32_16x16x32_bf16 a[112:115], a[184:187], v[64:67], a[112:115]
  v_exp_f32 v60, v60
  v_mfma_f32_16x16x32_bf16 a[112:115], a[188:191], v[96:99], a[112:115]
  v_mfma_f32_16x16x32_bf16 a[116:119], a[188:191], v[104:107], a[116:119]
  v_exp_f32 v61, v61
  v_mfma_f32_16x16x32_bf16 a[116:119], a[184:187], v[72:75], a[116:119]
  v_cvt_pk_bf16_f32 v58, v60, v61
  v_mfma_f32_16x16x32_bf16 a[120:123], a[184:187], v[80:83], a[120:123]
  v_exp_f32 v62, v62
  v_mfma_f32_16x16x32_bf16 a[120:123], a[188:191], v[112:115], a[120:123]
  v_mfma_f32_16x16x32_bf16 a[124:127], a[188:191], v[120:123], a[124:127]
  s_waitcnt lgkmcnt(0)
  v_exp_f32 v63, v63
  v_mfma_f32_16x16x32_bf16 a[124:127], a[184:187], v[88:91], a[124:127]
  v_cvt_pk_bf16_f32 v59, v62, v63
  v_mfma_f32_16x16x32_bf16 v[64:67], a[128:131], v[128:131], v[192:195]
  s_add_u32 m0, s28, 98304
  v_mfma_f32_16x16x32_bf16 v[64:67], a[132:135], v[132:135], v[64:67]
  ds_read_b128 a[144:147], v212 offset:20480
  v_mfma_f32_16x16x32_bf16 v[64:67], a[136:139], v[136:139], v[64:67]
  buffer_load_dwordx4 v236, s[16:19], s29 offen offset:0 lds
  v_mfma_f32_16x16x32_bf16 v[64:67], a[140:143], v[140:143], v[64:67]
  ds_read_b128 a[148:151], v213 offset:20480
  v_mfma_f32_16x16x32_bf16 v[72:75], a[140:143], v[156:159], v[196:199]
  v_mfma_f32_16x16x32_bf16 v[72:75], a[136:139], v[152:155], v[72:75]
  ds_read_b128 a[152:155], v214 offset:20480
  v_mfma_f32_16x16x32_bf16 v[72:75], a[132:135], v[148:151], v[72:75]
  buffer_load_dwordx4 v237, s[16:19], s29 offen offset:1024 lds
  v_mfma_f32_16x16x32_bf16 v[72:75], a[128:131], v[144:147], v[72:75]
  ds_read_b128 a[156:159], v215 offset:20480
  v_mfma_f32_16x16x32_bf16 v[80:83], a[128:131], v[160:163], v[200:203]
  v_exp_f32 v64, v64
  v_mfma_f32_16x16x32_bf16 v[80:83], a[132:135], v[164:167], v[80:83]
  v_mfma_f32_16x16x32_bf16 v[80:83], a[136:139], v[168:171], v[80:83]
  v_exp_f32 v65, v65
  v_mfma_f32_16x16x32_bf16 v[80:83], a[140:143], v[172:175], v[80:83]
  v_cvt_pk_bf16_f32 v64, v64, v65
  v_mfma_f32_16x16x32_bf16 v[88:91], a[140:143], v[188:191], v[204:207]
  v_exp_f32 v66, v66
  v_mfma_f32_16x16x32_bf16 v[88:91], a[136:139], v[184:187], v[88:91]
  buffer_load_dwordx4 v236, s[16:19], s29 offen offset:2048 lds
  v_mfma_f32_16x16x32_bf16 v[88:91], a[132:135], v[180:183], v[88:91]
  s_waitcnt lgkmcnt(0)
  v_exp_f32 v67, v67
  v_mfma_f32_16x16x32_bf16 v[88:91], a[128:131], v[176:179], v[88:91]
  v_cvt_pk_bf16_f32 v65, v66, v67
  v_mfma_f32_16x16x32_bf16 v[68:71], a[144:147], v[128:131], v[192:195]
  v_exp_f32 v72, v72
  v_mfma_f32_16x16x32_bf16 v[68:71], a[148:151], v[132:135], v[68:71]
  ds_read_b128 a[128:131], v212 offset:24576
  v_mfma_f32_16x16x32_bf16 v[68:71], a[152:155], v[136:139], v[68:71]
  v_exp_f32 v73, v73
  v_mfma_f32_16x16x32_bf16 v[68:71], a[156:159], v[140:143], v[68:71]
  ds_read_b128 a[132:135], v213 offset:24576
  v_cvt_pk_bf16_f32 v72, v72, v73
  v_mfma_f32_16x16x32_bf16 v[76:79], a[156:159], v[156:159], v[196:199]
  v_exp_f32 v74, v74
  v_mfma_f32_16x16x32_bf16 v[76:79], a[152:155], v[152:155], v[76:79]
  ds_read_b128 a[136:139], v214 offset:24576
  v_mfma_f32_16x16x32_bf16 v[76:79], a[148:151], v[148:151], v[76:79]
  v_exp_f32 v75, v75
  v_mfma_f32_16x16x32_bf16 v[76:79], a[144:147], v[144:147], v[76:79]
  ds_read_b128 a[140:143], v215 offset:24576
  v_cvt_pk_bf16_f32 v73, v74, v75
  v_mfma_f32_16x16x32_bf16 v[84:87], a[144:147], v[160:163], v[200:203]
  v_exp_f32 v80, v80
  v_mfma_f32_16x16x32_bf16 v[84:87], a[148:151], v[164:167], v[84:87]
  buffer_load_dwordx4 v237, s[16:19], s29 offen offset:3072 lds
  v_mfma_f32_16x16x32_bf16 v[84:87], a[152:155], v[168:171], v[84:87]
  s_add_u32 s29, s29, 16384
  v_exp_f32 v81, v81
  v_mfma_f32_16x16x32_bf16 v[84:87], a[156:159], v[172:175], v[84:87]
  v_cvt_pk_bf16_f32 v80, v80, v81
  v_mfma_f32_16x16x32_bf16 v[92:95], a[156:159], v[188:191], v[204:207]
  s_add_u32 m0, s28, 49152
  v_exp_f32 v82, v82
  v_mfma_f32_16x16x32_bf16 v[92:95], a[152:155], v[184:187], v[92:95]
  buffer_load_dwordx4 v232, s[12:15], s29 offen offset:0 lds
  v_mfma_f32_16x16x32_bf16 v[92:95], a[148:151], v[180:183], v[92:95]
  s_waitcnt lgkmcnt(0)
  v_exp_f32 v83, v83
  v_mfma_f32_16x16x32_bf16 v[92:95], a[144:147], v[176:179], v[92:95]
  v_cvt_pk_bf16_f32 v81, v82, v83
  v_mfma_f32_16x16x32_bf16 v[96:99], a[128:131], v[128:131], v[192:195]
  v_exp_f32 v88, v88
  v_mfma_f32_16x16x32_bf16 v[96:99], a[132:135], v[132:135], v[96:99]
  ds_read_b128 a[144:147], v212 offset:28672
  v_mfma_f32_16x16x32_bf16 v[96:99], a[136:139], v[136:139], v[96:99]
  v_exp_f32 v89, v89
  v_mfma_f32_16x16x32_bf16 v[96:99], a[140:143], v[140:143], v[96:99]
  ds_read_b128 a[148:151], v213 offset:28672
  v_cvt_pk_bf16_f32 v88, v88, v89
  v_mfma_f32_16x16x32_bf16 v[104:107], a[140:143], v[156:159], v[196:199]
  v_exp_f32 v90, v90
  v_mfma_f32_16x16x32_bf16 v[104:107], a[136:139], v[152:155], v[104:107]
  ds_read_b128 a[152:155], v214 offset:28672
  v_mfma_f32_16x16x32_bf16 v[104:107], a[132:135], v[148:151], v[104:107]
  v_exp_f32 v91, v91
  v_mfma_f32_16x16x32_bf16 v[104:107], a[128:131], v[144:147], v[104:107]
  ds_read_b128 a[156:159], v215 offset:28672
  v_cvt_pk_bf16_f32 v89, v90, v91
  v_mfma_f32_16x16x32_bf16 v[112:115], a[128:131], v[160:163], v[200:203]
  v_exp_f32 v68, v68
  v_mfma_f32_16x16x32_bf16 v[112:115], a[132:135], v[164:167], v[112:115]
  buffer_load_dwordx4 v233, s[12:15], s29 offen offset:1024 lds
  v_mfma_f32_16x16x32_bf16 v[112:115], a[136:139], v[168:171], v[112:115]
  v_exp_f32 v69, v69
  v_mfma_f32_16x16x32_bf16 v[112:115], a[140:143], v[172:175], v[112:115]
  v_cvt_pk_bf16_f32 v66, v68, v69
  v_mfma_f32_16x16x32_bf16 v[120:123], a[140:143], v[188:191], v[204:207]
  v_exp_f32 v70, v70
  v_mfma_f32_16x16x32_bf16 v[120:123], a[136:139], v[184:187], v[120:123]
  buffer_load_dwordx4 v234, s[12:15], s29 offen offset:2048 lds
  v_mfma_f32_16x16x32_bf16 v[120:123], a[132:135], v[180:183], v[120:123]
  s_waitcnt lgkmcnt(0)
  v_exp_f32 v71, v71
  v_mfma_f32_16x16x32_bf16 v[120:123], a[128:131], v[176:179], v[120:123]
  v_cvt_pk_bf16_f32 v67, v70, v71
  v_mfma_f32_16x16x32_bf16 v[100:103], a[144:147], v[128:131], v[192:195]
  v_exp_f32 v76, v76
  v_mfma_f32_16x16x32_bf16 v[100:103], a[148:151], v[132:135], v[100:103]
  ds_read_b64_tr_b16 a[160:161], v216 offset:0
  v_mfma_f32_16x16x32_bf16 v[100:103], a[152:155], v[136:139], v[100:103]
  v_exp_f32 v77, v77
  v_mfma_f32_16x16x32_bf16 v[100:103], a[156:159], v[140:143], v[100:103]
  ds_read_b64_tr_b16 a[162:163], v216 offset:4096
  v_cvt_pk_bf16_f32 v74, v76, v77
  v_mfma_f32_16x16x32_bf16 v[108:111], a[156:159], v[156:159], v[196:199]
  v_exp_f32 v78, v78
  v_mfma_f32_16x16x32_bf16 v[108:111], a[152:155], v[152:155], v[108:111]
  ds_read_b64_tr_b16 a[164:165], v216 offset:8192
  buffer_load_dwordx4 v235, s[12:15], s29 offen offset:3072 lds
  v_mfma_f32_16x16x32_bf16 v[108:111], a[148:151], v[148:151], v[108:111]
  v_exp_f32 v79, v79
  v_mfma_f32_16x16x32_bf16 v[108:111], a[144:147], v[144:147], v[108:111]
  ds_read_b64_tr_b16 a[166:167], v216 offset:12288
  v_cvt_pk_bf16_f32 v75, v78, v79
  v_mfma_f32_16x16x32_bf16 v[116:119], a[144:147], v[160:163], v[200:203]
  s_add_u32 m0, s50, 5120
  v_exp_f32 v84, v84
  v_mfma_f32_16x16x32_bf16 v[116:119], a[148:151], v[164:167], v[116:119]
  ds_read_b64_tr_b16 a[168:169], v217 offset:0
  buffer_load_dwordx4 v208, s[20:23], s30 offen lds
  s_add_u32 s30, s30, 32
  v_mfma_f32_16x16x32_bf16 v[116:119], a[152:155], v[168:171], v[116:119]
  v_exp_f32 v85, v85
  v_mfma_f32_16x16x32_bf16 v[116:119], a[156:159], v[172:175], v[116:119]
  ds_read_b64_tr_b16 a[170:171], v217 offset:4096
  v_cvt_pk_bf16_f32 v82, v84, v85
  v_mfma_f32_16x16x32_bf16 v[124:127], a[156:159], v[188:191], v[204:207]
  v_exp_f32 v86, v86
  v_mfma_f32_16x16x32_bf16 v[124:127], a[152:155], v[184:187], v[124:127]
  ds_read_b64_tr_b16 a[172:173], v217 offset:8192
  v_mfma_f32_16x16x32_bf16 v[124:127], a[148:151], v[180:183], v[124:127]
  v_exp_f32 v87, v87
  v_mfma_f32_16x16x32_bf16 v[124:127], a[144:147], v[176:179], v[124:127]
  ds_read_b64_tr_b16 a[174:175], v217 offset:12288
  v_cvt_pk_bf16_f32 v83, v86, v87
  v_mfma_f32_16x16x32_bf16 a[192:195], a[208:211], v[0:3], a[192:195]
  v_exp_f32 v92, v92
  v_mfma_f32_16x16x32_bf16 a[192:195], a[208:211], v[32:35], a[192:195]
  ds_read_b64_tr_b16 a[176:177], v218 offset:0
  v_mfma_f32_16x16x32_bf16 a[196:199], a[208:211], v[8:11], a[196:199]
  v_exp_f32 v93, v93
  v_mfma_f32_16x16x32_bf16 a[196:199], a[208:211], v[40:43], a[196:199]
  ds_read_b64_tr_b16 a[178:179], v218 offset:4096
  v_cvt_pk_bf16_f32 v90, v92, v93
  v_mfma_f32_16x16x32_bf16 a[200:203], a[208:211], v[16:19], a[200:203]
  v_exp_f32 v94, v94
  v_mfma_f32_16x16x32_bf16 a[200:203], a[208:211], v[48:51], a[200:203]
  ds_read_b64_tr_b16 a[180:181], v218 offset:8192
  v_mfma_f32_16x16x32_bf16 a[204:207], a[208:211], v[24:27], a[204:207]
  s_waitcnt lgkmcnt(7)
  v_exp_f32 v95, v95
  v_mfma_f32_16x16x32_bf16 a[204:207], a[208:211], v[56:59], a[204:207]
  ds_read_b64_tr_b16 a[182:183], v218 offset:12288
  v_cvt_pk_bf16_f32 v91, v94, v95
  v_mfma_f32_16x16x32_bf16 a[0:3], a[160:163], v[0:3], a[0:3]
  v_exp_f32 v96, v96
  v_mfma_f32_16x16x32_bf16 a[0:3], a[164:167], v[32:35], a[0:3]
  ds_read_b64_tr_b16 a[184:185], v219 offset:0
  v_mfma_f32_16x16x32_bf16 a[4:7], a[164:167], v[40:43], a[4:7]
  v_exp_f32 v97, v97
  v_mfma_f32_16x16x32_bf16 a[4:7], a[160:163], v[8:11], a[4:7]
  ds_read_b64_tr_b16 a[186:187], v219 offset:4096
  v_cvt_pk_bf16_f32 v96, v96, v97
  v_mfma_f32_16x16x32_bf16 a[8:11], a[160:163], v[16:19], a[8:11]
  v_exp_f32 v98, v98
  v_mfma_f32_16x16x32_bf16 a[8:11], a[164:167], v[48:51], a[8:11]
  ds_read_b64_tr_b16 a[188:189], v219 offset:8192
  v_mfma_f32_16x16x32_bf16 a[12:15], a[164:167], v[56:59], a[12:15]
  s_waitcnt lgkmcnt(7)
  v_exp_f32 v99, v99
  v_mfma_f32_16x16x32_bf16 a[12:15], a[160:163], v[24:27], a[12:15]
  ds_read_b64_tr_b16 a[190:191], v219 offset:12288
  v_cvt_pk_bf16_f32 v97, v98, v99
  v_mfma_f32_16x16x32_bf16 a[16:19], a[168:171], v[0:3], a[16:19]
  v_exp_f32 v104, v104
  v_mfma_f32_16x16x32_bf16 a[16:19], a[172:175], v[32:35], a[16:19]
  ds_read_b64_tr_b16 a[160:161], v220 offset:0
  v_mfma_f32_16x16x32_bf16 a[20:23], a[172:175], v[40:43], a[20:23]
  v_exp_f32 v105, v105
  v_mfma_f32_16x16x32_bf16 a[20:23], a[168:171], v[8:11], a[20:23]
  ds_read_b64_tr_b16 a[162:163], v220 offset:4096
  v_cvt_pk_bf16_f32 v104, v104, v105
  v_mfma_f32_16x16x32_bf16 a[24:27], a[168:171], v[16:19], a[24:27]
  v_exp_f32 v106, v106
  v_mfma_f32_16x16x32_bf16 a[24:27], a[172:175], v[48:51], a[24:27]
  ds_read_b64_tr_b16 a[164:165], v220 offset:8192
  v_mfma_f32_16x16x32_bf16 a[28:31], a[172:175], v[56:59], a[28:31]
  s_waitcnt lgkmcnt(7)
  v_exp_f32 v107, v107
  v_mfma_f32_16x16x32_bf16 a[28:31], a[168:171], v[24:27], a[28:31]
  ds_read_b64_tr_b16 a[166:167], v220 offset:12288
  v_cvt_pk_bf16_f32 v105, v106, v107
  v_mfma_f32_16x16x32_bf16 a[32:35], a[176:179], v[0:3], a[32:35]
  v_exp_f32 v112, v112
  v_mfma_f32_16x16x32_bf16 a[32:35], a[180:183], v[32:35], a[32:35]
  ds_read_b64_tr_b16 a[168:169], v221 offset:0
  v_mfma_f32_16x16x32_bf16 a[36:39], a[180:183], v[40:43], a[36:39]
  v_exp_f32 v113, v113
  v_mfma_f32_16x16x32_bf16 a[36:39], a[176:179], v[8:11], a[36:39]
  ds_read_b64_tr_b16 a[170:171], v221 offset:4096
  v_cvt_pk_bf16_f32 v112, v112, v113
  v_mfma_f32_16x16x32_bf16 a[40:43], a[176:179], v[16:19], a[40:43]
  v_exp_f32 v114, v114
  v_mfma_f32_16x16x32_bf16 a[40:43], a[180:183], v[48:51], a[40:43]
  ds_read_b64_tr_b16 a[172:173], v221 offset:8192
  v_mfma_f32_16x16x32_bf16 a[44:47], a[180:183], v[56:59], a[44:47]
  s_waitcnt lgkmcnt(7)
  v_exp_f32 v115, v115
  v_mfma_f32_16x16x32_bf16 a[44:47], a[176:179], v[24:27], a[44:47]
  ds_read_b64_tr_b16 a[174:175], v221 offset:12288
  v_cvt_pk_bf16_f32 v113, v114, v115
  v_mfma_f32_16x16x32_bf16 a[48:51], a[184:187], v[0:3], a[48:51]
  v_exp_f32 v120, v120
  v_mfma_f32_16x16x32_bf16 a[48:51], a[188:191], v[32:35], a[48:51]
  ds_read_b64_tr_b16 a[176:177], v222 offset:0
  v_mfma_f32_16x16x32_bf16 a[52:55], a[188:191], v[40:43], a[52:55]
  v_exp_f32 v121, v121
  v_mfma_f32_16x16x32_bf16 a[52:55], a[184:187], v[8:11], a[52:55]
  ds_read_b64_tr_b16 a[178:179], v222 offset:4096
  v_cvt_pk_bf16_f32 v120, v120, v121
  v_mfma_f32_16x16x32_bf16 a[56:59], a[184:187], v[16:19], a[56:59]
  v_exp_f32 v122, v122
  v_mfma_f32_16x16x32_bf16 a[56:59], a[188:191], v[48:51], a[56:59]
  ds_read_b64_tr_b16 a[180:181], v222 offset:8192
  v_mfma_f32_16x16x32_bf16 a[60:63], a[188:191], v[56:59], a[60:63]
  s_waitcnt lgkmcnt(7)
  v_exp_f32 v123, v123
  v_mfma_f32_16x16x32_bf16 a[60:63], a[184:187], v[24:27], a[60:63]
  ds_read_b64_tr_b16 a[182:183], v222 offset:12288
  v_cvt_pk_bf16_f32 v121, v122, v123
  v_mfma_f32_16x16x32_bf16 a[64:67], a[160:163], v[0:3], a[64:67]
  v_exp_f32 v100, v100
  v_mfma_f32_16x16x32_bf16 a[64:67], a[164:167], v[32:35], a[64:67]
  ds_read_b64_tr_b16 a[184:185], v223 offset:0
  v_mfma_f32_16x16x32_bf16 a[68:71], a[164:167], v[40:43], a[68:71]
  v_exp_f32 v101, v101
  v_mfma_f32_16x16x32_bf16 a[68:71], a[160:163], v[8:11], a[68:71]
  ds_read_b64_tr_b16 a[186:187], v223 offset:4096
  v_cvt_pk_bf16_f32 v98, v100, v101
  v_mfma_f32_16x16x32_bf16 a[72:75], a[160:163], v[16:19], a[72:75]
  v_exp_f32 v102, v102
  v_mfma_f32_16x16x32_bf16 a[72:75], a[164:167], v[48:51], a[72:75]
  ds_read_b64_tr_b16 a[188:189], v223 offset:8192
  v_mfma_f32_16x16x32_bf16 a[76:79], a[164:167], v[56:59], a[76:79]
  s_waitcnt lgkmcnt(7)
  v_exp_f32 v103, v103
  v_mfma_f32_16x16x32_bf16 a[76:79], a[160:163], v[24:27], a[76:79]
  ds_read_b64_tr_b16 a[190:191], v223 offset:12288
  v_cvt_pk_bf16_f32 v99, v102, v103
  v_mfma_f32_16x16x32_bf16 a[80:83], a[168:171], v[0:3], a[80:83]
  s_waitcnt vmcnt(11)
  v_exp_f32 v108, v108
  v_mfma_f32_16x16x32_bf16 a[80:83], a[172:175], v[32:35], a[80:83]
  v_mfma_f32_16x16x32_bf16 a[84:87], a[172:175], v[40:43], a[84:87]
  s_barrier
  v_exp_f32 v109, v109
  v_mfma_f32_16x16x32_bf16 a[84:87], a[168:171], v[8:11], a[84:87]
  ds_read_b128 a[128:131], v212 offset:32768
  v_cvt_pk_bf16_f32 v106, v108, v109
  v_mfma_f32_16x16x32_bf16 a[88:91], a[168:171], v[16:19], a[88:91]
  v_exp_f32 v110, v110
  v_mfma_f32_16x16x32_bf16 a[88:91], a[172:175], v[48:51], a[88:91]
  ds_read_b128 a[132:135], v213 offset:32768
  buffer_atomic_add v250, v249, s[24:27], s47 offen
  s_cmp_eq_u32 s32, 3
  s_cselect_b32 s39, 0, 1073741824
  v_mfma_f32_16x16x32_bf16 a[92:95], a[172:175], v[56:59], a[92:95]
  s_waitcnt lgkmcnt(6)
  v_exp_f32 v111, v111
  v_mfma_f32_16x16x32_bf16 a[92:95], a[168:171], v[24:27], a[92:95]
  ds_read_b128 a[136:139], v214 offset:32768
  v_cvt_pk_bf16_f32 v107, v110, v111
  v_mfma_f32_16x16x32_bf16 a[96:99], a[176:179], v[0:3], a[96:99]
  v_exp_f32 v116, v116
  v_mfma_f32_16x16x32_bf16 a[96:99], a[180:183], v[32:35], a[96:99]
  ds_read_b128 a[140:143], v215 offset:32768
  v_or_b32 v249, s39, v251
  v_mfma_f32_16x16x32_bf16 a[100:103], a[180:183], v[40:43], a[100:103]
  v_exp_f32 v117, v117
  v_mfma_f32_16x16x32_bf16 a[100:103], a[176:179], v[8:11], a[100:103]
  v_cvt_pk_bf16_f32 v114, v116, v117
  v_mfma_f32_16x16x32_bf16 a[104:107], a[176:179], v[16:19], a[104:107]
  v_exp_f32 v118, v118
  v_mfma_f32_16x16x32_bf16 a[104:107], a[180:183], v[48:51], a[104:107]
  v_mfma_f32_16x16x32_bf16 a[108:111], a[180:183], v[56:59], a[108:111]
  s_waitcnt lgkmcnt(4)
  v_exp_f32 v119, v119
  v_mfma_f32_16x16x32_bf16 a[108:111], a[176:179], v[24:27], a[108:111]
  v_cvt_pk_bf16_f32 v115, v118, v119
  v_mfma_f32_16x16x32_bf16 a[112:115], a[184:187], v[0:3], a[112:115]
  v_exp_f32 v124, v124
  v_mfma_f32_16x16x32_bf16 a[112:115], a[188:191], v[32:35], a[112:115]
  v_mfma_f32_16x16x32_bf16 a[116:119], a[188:191], v[40:43], a[116:119]
  v_exp_f32 v125, v125
  v_mfma_f32_16x16x32_bf16 a[116:119], a[184:187], v[8:11], a[116:119]
  v_cvt_pk_bf16_f32 v122, v124, v125
  v_mfma_f32_16x16x32_bf16 a[120:123], a[184:187], v[16:19], a[120:123]
  v_exp_f32 v126, v126
  v_mfma_f32_16x16x32_bf16 a[120:123], a[188:191], v[48:51], a[120:123]
  v_mfma_f32_16x16x32_bf16 a[124:127], a[188:191], v[56:59], a[124:127]
  s_waitcnt lgkmcnt(0)
  v_exp_f32 v127, v127
  v_mfma_f32_16x16x32_bf16 a[124:127], a[184:187], v[24:27], a[124:127]
  v_cvt_pk_bf16_f32 v123, v126, v127
  v_mfma_f32_16x16x32_bf16 v[0:3], a[128:131], v[128:131], v[192:195]
  s_add_u32 m0, s28, 114688
  v_mfma_f32_16x16x32_bf16 v[0:3], a[132:135], v[132:135], v[0:3]
  ds_read_b128 a[144:147], v212 offset:36864
  v_mfma_f32_16x16x32_bf16 v[0:3], a[136:139], v[136:139], v[0:3]
  buffer_load_dwordx4 v236, s[16:19], s29 offen offset:0 lds
  v_mfma_f32_16x16x32_bf16 v[0:3], a[140:143], v[140:143], v[0:3]
  ds_read_b128 a[148:151], v213 offset:36864
  v_mfma_f32_16x16x32_bf16 v[8:11], a[140:143], v[156:159], v[196:199]
  v_mfma_f32_16x16x32_bf16 v[8:11], a[136:139], v[152:155], v[8:11]
  ds_read_b128 a[152:155], v214 offset:36864
  v_mfma_f32_16x16x32_bf16 v[8:11], a[132:135], v[148:151], v[8:11]
  buffer_load_dwordx4 v237, s[16:19], s29 offen offset:1024 lds
  v_mfma_f32_16x16x32_bf16 v[8:11], a[128:131], v[144:147], v[8:11]
  ds_read_b128 a[156:159], v215 offset:36864
  v_mfma_f32_16x16x32_bf16 v[16:19], a[128:131], v[160:163], v[200:203]
  v_exp_f32 v0, v0
  v_mfma_f32_16x16x32_bf16 v[16:19], a[132:135], v[164:167], v[16:19]
  v_mfma_f32_16x16x32_bf16 v[16:19], a[136:139], v[168:171], v[16:19]
  v_exp_f32 v1, v1
  v_mfma_f32_16x16x32_bf16 v[16:19], a[140:143], v[172:175], v[16:19]
  v_cvt_pk_bf16_f32 v0, v0, v1
  v_mfma_f32_16x16x32_bf16 v[24:27], a[140:143], v[188:191], v[204:207]
  v_exp_f32 v2, v2
  v_mfma_f32_16x16x32_bf16 v[24:27], a[136:139], v[184:187], v[24:27]
  buffer_load_dwordx4 v236, s[16:19], s29 offen offset:2048 lds
  v_mfma_f32_16x16x32_bf16 v[24:27], a[132:135], v[180:183], v[24:27]
  s_waitcnt lgkmcnt(0)
  v_exp_f32 v3, v3
  v_mfma_f32_16x16x32_bf16 v[24:27], a[128:131], v[176:179], v[24:27]
  v_cvt_pk_bf16_f32 v1, v2, v3
  v_mfma_f32_16x16x32_bf16 v[4:7], a[144:147], v[128:131], v[192:195]
  v_exp_f32 v8, v8
  v_mfma_f32_16x16x32_bf16 v[4:7], a[148:151], v[132:135], v[4:7]
  ds_read_b128 a[128:131], v212 offset:40960
  v_mfma_f32_16x16x32_bf16 v[4:7], a[152:155], v[136:139], v[4:7]
  v_exp_f32 v9, v9
  v_mfma_f32_16x16x32_bf16 v[4:7], a[156:159], v[140:143], v[4:7]
  ds_read_b128 a[132:135], v213 offset:40960
  v_cvt_pk_bf16_f32 v8, v8, v9
  v_mfma_f32_16x16x32_bf16 v[12:15], a[156:159], v[156:159], v[196:199]
  v_exp_f32 v10, v10
  v_mfma_f32_16x16x32_bf16 v[12:15], a[152:155], v[152:155], v[12:15]
  ds_read_b128 a[136:139], v214 offset:40960
  v_mfma_f32_16x16x32_bf16 v[12:15], a[148:151], v[148:151], v[12:15]
  v_exp_f32 v11, v11
  v_mfma_f32_16x16x32_bf16 v[12:15], a[144:147], v[144:147], v[12:15]
  ds_read_b128 a[140:143], v215 offset:40960
  v_cvt_pk_bf16_f32 v9, v10, v11
  v_mfma_f32_16x16x32_bf16 v[20:23], a[144:147], v[160:163], v[200:203]
  v_exp_f32 v16, v16
  v_mfma_f32_16x16x32_bf16 v[20:23], a[148:151], v[164:167], v[20:23]
  buffer_load_dwordx4 v237, s[16:19], s29 offen offset:3072 lds
  v_mfma_f32_16x16x32_bf16 v[20:23], a[152:155], v[168:171], v[20:23]
  s_add_u32 s29, s29, 16384
  v_exp_f32 v17, v17
  v_mfma_f32_16x16x32_bf16 v[20:23], a[156:159], v[172:175], v[20:23]
  v_cvt_pk_bf16_f32 v16, v16, v17
  v_mfma_f32_16x16x32_bf16 v[28:31], a[156:159], v[188:191], v[204:207]
  s_add_u32 m0, s28, 0
  v_exp_f32 v18, v18
  v_mfma_f32_16x16x32_bf16 v[28:31], a[152:155], v[184:187], v[28:31]
  buffer_load_dwordx4 v232, s[12:15], s29 offen offset:0 lds
  v_mfma_f32_16x16x32_bf16 v[28:31], a[148:151], v[180:183], v[28:31]
  s_waitcnt lgkmcnt(0)
  v_exp_f32 v19, v19
  v_mfma_f32_16x16x32_bf16 v[28:31], a[144:147], v[176:179], v[28:31]
  v_cvt_pk_bf16_f32 v17, v18, v19
  v_mfma_f32_16x16x32_bf16 v[32:35], a[128:131], v[128:131], v[192:195]
  v_exp_f32 v24, v24
  v_mfma_f32_16x16x32_bf16 v[32:35], a[132:135], v[132:135], v[32:35]
  ds_read_b128 a[144:147], v212 offset:45056
  v_mfma_f32_16x16x32_bf16 v[32:35], a[136:139], v[136:139], v[32:35]
  v_exp_f32 v25, v25
  v_mfma_f32_16x16x32_bf16 v[32:35], a[140:143], v[140:143], v[32:35]
  ds_read_b128 a[148:151], v213 offset:45056
  v_cvt_pk_bf16_f32 v24, v24, v25
  v_mfma_f32_16x16x32_bf16 v[40:43], a[140:143], v[156:159], v[196:199]
  v_exp_f32 v26, v26
  v_mfma_f32_16x16x32_bf16 v[40:43], a[136:139], v[152:155], v[40:43]
  ds_read_b128 a[152:155], v214 offset:45056
  v_mfma_f32_16x16x32_bf16 v[40:43], a[132:135], v[148:151], v[40:43]
  v_exp_f32 v27, v27
  v_mfma_f32_16x16x32_bf16 v[40:43], a[128:131], v[144:147], v[40:43]
  ds_read_b128 a[156:159], v215 offset:45056
  v_cvt_pk_bf16_f32 v25, v26, v27
  v_mfma_f32_16x16x32_bf16 v[48:51], a[128:131], v[160:163], v[200:203]
  v_exp_f32 v4, v4
  v_mfma_f32_16x16x32_bf16 v[48:51], a[132:135], v[164:167], v[48:51]
  buffer_load_dwordx4 v233, s[12:15], s29 offen offset:1024 lds
  v_mfma_f32_16x16x32_bf16 v[48:51], a[136:139], v[168:171], v[48:51]
  v_exp_f32 v5, v5
  v_mfma_f32_16x16x32_bf16 v[48:51], a[140:143], v[172:175], v[48:51]
  v_cvt_pk_bf16_f32 v2, v4, v5
  v_mfma_f32_16x16x32_bf16 v[56:59], a[140:143], v[188:191], v[204:207]
  v_exp_f32 v6, v6
  v_mfma_f32_16x16x32_bf16 v[56:59], a[136:139], v[184:187], v[56:59]
  buffer_load_dwordx4 v234, s[12:15], s29 offen offset:2048 lds
  v_mfma_f32_16x16x32_bf16 v[56:59], a[132:135], v[180:183], v[56:59]
  s_waitcnt lgkmcnt(0)
  v_exp_f32 v7, v7
  v_mfma_f32_16x16x32_bf16 v[56:59], a[128:131], v[176:179], v[56:59]
  v_cvt_pk_bf16_f32 v3, v6, v7
  v_mfma_f32_16x16x32_bf16 v[36:39], a[144:147], v[128:131], v[192:195]
  v_exp_f32 v12, v12
  v_mfma_f32_16x16x32_bf16 v[36:39], a[148:151], v[132:135], v[36:39]
  ds_read_b64_tr_b16 a[160:161], v216 offset:16384
  v_mfma_f32_16x16x32_bf16 v[36:39], a[152:155], v[136:139], v[36:39]
  v_exp_f32 v13, v13
  v_mfma_f32_16x16x32_bf16 v[36:39], a[156:159], v[140:143], v[36:39]
  ds_read_b64_tr_b16 a[162:163], v216 offset:20480
  v_cvt_pk_bf16_f32 v10, v12, v13
  v_mfma_f32_16x16x32_bf16 v[44:47], a[156:159], v[156:159], v[196:199]
  v_exp_f32 v14, v14
  v_mfma_f32_16x16x32_bf16 v[44:47], a[152:155], v[152:155], v[44:47]
  ds_read_b64_tr_b16 a[164:165], v216 offset:24576
  buffer_load_dwordx4 v235, s[12:15], s29 offen offset:3072 lds
  v_mfma_f32_16x16x32_bf16 v[44:47], a[148:151], v[148:151], v[44:47]
  v_exp_f32 v15, v15
  v_mfma_f32_16x16x32_bf16 v[44:47], a[144:147], v[144:147], v[44:47]
  ds_read_b64_tr_b16 a[166:167], v216 offset:28672
  v_cvt_pk_bf16_f32 v11, v14, v15
  v_mfma_f32_16x16x32_bf16 v[52:55], a[144:147], v[160:163], v[200:203]
  s_mov_b32 m0, s51
  v_exp_f32 v20, v20
  v_mfma_f32_16x16x32_bf16 v[52:55], a[148:151], v[164:167], v[52:55]
  ds_read_b64_tr_b16 a[168:169], v217 offset:16384
  buffer_load_dwordx4 v210, s[4:7], s100 offen lds
  s_add_u32 s100, s100, 20480
  s_add_u32 s51, s51, 512
  v_mfma_f32_16x16x32_bf16 v[52:55], a[152:155], v[168:171], v[52:55]
  v_exp_f32 v21, v21
  v_mfma_f32_16x16x32_bf16 v[52:55], a[156:159], v[172:175], v[52:55]
  ds_read_b64_tr_b16 a[170:171], v217 offset:20480
  v_cvt_pk_bf16_f32 v18, v20, v21
  v_mfma_f32_16x16x32_bf16 v[60:63], a[156:159], v[188:191], v[204:207]
  s_waitcnt vmcnt(20)
  v_exp_f32 v22, v22
  v_mfma_f32_16x16x32_bf16 v[60:63], a[152:155], v[184:187], v[60:63]
  ds_read_b64_tr_b16 a[172:173], v217 offset:24576
  ds_read_b64_tr_b16 a[232:233], v209 offset:4096
  v_mfma_f32_16x16x32_bf16 v[60:63], a[148:151], v[180:183], v[60:63]
  v_exp_f32 v23, v23
  v_mfma_f32_16x16x32_bf16 v[60:63], a[144:147], v[176:179], v[60:63]
  ds_read_b64_tr_b16 a[174:175], v217 offset:28672
  v_cvt_pk_bf16_f32 v19, v22, v23
  v_mfma_f32_16x16x32_bf16 a[192:195], a[208:211], v[64:67], a[192:195]
  v_exp_f32 v28, v28
  v_mfma_f32_16x16x32_bf16 a[192:195], a[208:211], v[96:99], a[192:195]
  ds_read_b64_tr_b16 a[176:177], v218 offset:16384
  ds_read_b64_tr_b16 a[234:235], v209 offset:4608
  v_mfma_f32_16x16x32_bf16 a[196:199], a[208:211], v[72:75], a[196:199]
  v_exp_f32 v29, v29
  v_mfma_f32_16x16x32_bf16 a[196:199], a[208:211], v[104:107], a[196:199]
  ds_read_b64_tr_b16 a[178:179], v218 offset:20480
  v_cvt_pk_bf16_f32 v26, v28, v29
  v_mfma_f32_16x16x32_bf16 a[200:203], a[208:211], v[80:83], a[200:203]
  v_exp_f32 v30, v30
  v_mfma_f32_16x16x32_bf16 a[200:203], a[208:211], v[112:115], a[200:203]
  ds_read_b64_tr_b16 a[180:181], v218 offset:24576
  v_mfma_f32_16x16x32_bf16 a[204:207], a[208:211], v[88:91], a[204:207]
  s_waitcnt lgkmcnt(9)
  v_exp_f32 v31, v31
  v_mfma_f32_16x16x32_bf16 a[204:207], a[208:211], v[120:123], a[204:207]
  ds_read_b64_tr_b16 a[182:183], v218 offset:28672
  v_cvt_pk_bf16_f32 v27, v30, v31
  v_mfma_f32_16x16x32_bf16 a[0:3], a[160:163], v[64:67], a[0:3]
  v_exp_f32 v32, v32
  v_mfma_f32_16x16x32_bf16 a[0:3], a[164:167], v[96:99], a[0:3]
  ds_read_b64_tr_b16 a[184:185], v219 offset:16384
  s_waitcnt lgkmcnt(4)
  buffer_store_dwordx4 a[232:235], v211, s[24:27], s31 offen sc1
  s_add_u32 s31, s31, 1024
  s_cmp_gt_u32 s32, 3
  v_mfma_f32_16x16x32_bf16 a[4:7], a[164:167], v[104:107], a[4:7]
  s_cselect_b32 s39, 0, 1073741824
  v_exp_f32 v33, v33
  v_mfma_f32_16x16x32_bf16 a[4:7], a[160:163], v[72:75], a[4:7]
  ds_read_b64_tr_b16 a[186:187], v219 offset:20480
  v_cvt_pk_bf16_f32 v32, v32, v33
  v_mfma_f32_16x16x32_bf16 a[8:11], a[160:163], v[80:83], a[8:11]
  v_exp_f32 v34, v34
  v_mfma_f32_16x16x32_bf16 a[8:11], a[164:167], v[112:115], a[8:11]
  ds_read_b64_tr_b16 a[188:189], v219 offset:24576
  v_or_b32 v211, s39, v211
  v_mfma_f32_16x16x32_bf16 a[12:15], a[164:167], v[120:123], a[12:15]
  v_exp_f32 v35, v35
  v_mfma_f32_16x16x32_bf16 a[12:15], a[160:163], v[88:91], a[12:15]
  ds_read_b64_tr_b16 a[190:191], v219 offset:28672
  v_cvt_pk_bf16_f32 v33, v34, v35
  v_mfma_f32_16x16x32_bf16 a[16:19], a[168:171], v[64:67], a[16:19]
  v_exp_f32 v40, v40
  v_mfma_f32_16x16x32_bf16 a[16:19], a[172:175], v[96:99], a[16:19]
  ds_read_b64_tr_b16 a[160:161], v220 offset:16384
  v_or_b32 v208, s39, v208
  v_mfma_f32_16x16x32_bf16 a[20:23], a[172:175], v[104:107], a[20:23]
  v_exp_f32 v41, v41
  v_mfma_f32_16x16x32_bf16 a[20:23], a[168:171], v[72:75], a[20:23]
  ds_read_b64_tr_b16 a[162:163], v220 offset:20480
  v_cvt_pk_bf16_f32 v40, v40, v41
  v_mfma_f32_16x16x32_bf16 a[24:27], a[168:171], v[80:83], a[24:27]
  v_exp_f32 v42, v42
  v_mfma_f32_16x16x32_bf16 a[24:27], a[172:175], v[112:115], a[24:27]
  ds_read_b64_tr_b16 a[164:165], v220 offset:24576
  v_mfma_f32_16x16x32_bf16 a[28:31], a[172:175], v[120:123], a[28:31]
  s_waitcnt lgkmcnt(7)
  v_exp_f32 v43, v43
  v_mfma_f32_16x16x32_bf16 a[28:31], a[168:171], v[88:91], a[28:31]
  ds_read_b64_tr_b16 a[166:167], v220 offset:28672
  v_cvt_pk_bf16_f32 v41, v42, v43
  v_mfma_f32_16x16x32_bf16 a[32:35], a[176:179], v[64:67], a[32:35]
  v_exp_f32 v48, v48
  v_mfma_f32_16x16x32_bf16 a[32:35], a[180:183], v[96:99], a[32:35]
  ds_read_b64_tr_b16 a[168:169], v221 offset:16384
  v_mfma_f32_16x16x32_bf16 a[36:39], a[180:183], v[104:107], a[36:39]
  v_exp_f32 v49, v49
  v_mfma_f32_16x16x32_bf16 a[36:39], a[176:179], v[72:75], a[36:39]
  ds_read_b64_tr_b16 a[170:171], v221 offset:20480
  v_cvt_pk_bf16_f32 v48, v48, v49
  v_mfma_f32_16x16x32_bf16 a[40:43], a[176:179], v[80:83], a[40:43]
  v_exp_f32 v50, v50
  v_mfma_f32_16x16x32_bf16 a[40:43], a[180:183], v[112:115], a[40:43]
  ds_read_b64_tr_b16 a[172:173], v221 offset:24576
  v_mfma_f32_16x16x32_bf16 a[44:47], a[180:183], v[120:123], a[44:47]
  s_waitcnt lgkmcnt(7)
  v_exp_f32 v51, v51
  v_mfma_f32_16x16x32_bf16 a[44:47], a[176:179], v[88:91], a[44:47]
  ds_read_b64_tr_b16 a[174:175], v221 offset:28672
  v_cvt_pk_bf16_f32 v49, v50, v51
  v_mfma_f32_16x16x32_bf16 a[48:51], a[184:187], v[64:67], a[48:51]
  v_exp_f32 v56, v56
  v_mfma_f32_16x16x32_bf16 a[48:51], a[188:191], v[96:99], a[48:51]
  ds_read_b64_tr_b16 a[176:177], v222 offset:16384
  v_mfma_f32_16x16x32_bf16 a[52:55], a[188:191], v[104:107], a[52:55]
  v_exp_f32 v57, v57
  v_mfma_f32_16x16x32_bf16 a[52:55], a[184:187], v[72:75], a[52:55]
  ds_read_b64_tr_b16 a[178:179], v222 offset:20480
  v_cvt_pk_bf16_f32 v56, v56, v57
  v_mfma_f32_16x16x32_bf16 a[56:59], a[184:187], v[80:83], a[56:59]
  v_exp_f32 v58, v58
  v_mfma_f32_16x16x32_bf16 a[56:59], a[188:191], v[112:115], a[56:59]
  ds_read_b64_tr_b16 a[180:181], v222 offset:24576
  v_mfma_f32_16x16x32_bf16 a[60:63], a[188:191], v[120:123], a[60:63]
  s_waitcnt lgkmcnt(7)
  v_exp_f32 v59, v59
  v_mfma_f32_16x16x32_bf16 a[60:63], a[184:187], v[88:91], a[60:63]
  ds_read_b64_tr_b16 a[182:183], v222 offset:28672
  v_cvt_pk_bf16_f32 v57, v58, v59
  v_mfma_f32_16x16x32_bf16 a[64:67], a[160:163], v[64:67], a[64:67]
  v_exp_f32 v36, v36
  v_mfma_f32_16x16x32_bf16 a[64:67], a[164:167], v[96:99], a[64:67]
  ds_read_b64_tr_b16 a[184:185], v223 offset:16384
  v_mfma_f32_16x16x32_bf16 a[68:71], a[164:167], v[104:107], a[68:71]
  v_exp_f32 v37, v37
  v_mfma_f32_16x16x32_bf16 a[68:71], a[160:163], v[72:75], a[68:71]
  ds_read_b64_tr_b16 a[186:187], v223 offset:20480
  v_cvt_pk_bf16_f32 v34, v36, v37
  v_mfma_f32_16x16x32_bf16 a[72:75], a[160:163], v[80:83], a[72:75]
  v_exp_f32 v38, v38
  v_mfma_f32_16x16x32_bf16 a[72:75], a[164:167], v[112:115], a[72:75]
  ds_read_b64_tr_b16 a[188:189], v223 offset:24576
  v_mfma_f32_16x16x32_bf16 a[76:79], a[164:167], v[120:123], a[76:79]
  s_waitcnt lgkmcnt(7)
  v_exp_f32 v39, v39
  v_mfma_f32_16x16x32_bf16 a[76:79], a[160:163], v[88:91], a[76:79]
  ds_read_b64_tr_b16 a[190:191], v223 offset:28672
  v_cvt_pk_bf16_f32 v35, v38, v39
  v_mfma_f32_16x16x32_bf16 a[80:83], a[168:171], v[64:67], a[80:83]
  s_waitcnt vmcnt(12)
  v_exp_f32 v44, v44
  v_mfma_f32_16x16x32_bf16 a[80:83], a[172:175], v[96:99], a[80:83]
  v_mfma_f32_16x16x32_bf16 a[84:87], a[172:175], v[104:107], a[84:87]
  s_barrier
  v_exp_f32 v45, v45
  v_mfma_f32_16x16x32_bf16 a[84:87], a[168:171], v[72:75], a[84:87]
  ds_read_b128 a[128:131], v212 offset:49152
  v_cvt_pk_bf16_f32 v42, v44, v45
  v_mfma_f32_16x16x32_bf16 a[88:91], a[168:171], v[80:83], a[88:91]
  v_exp_f32 v46, v46
  v_mfma_f32_16x16x32_bf16 a[88:91], a[172:175], v[112:115], a[88:91]
  ds_read_b128 a[132:135], v213 offset:49152
  v_mfma_f32_16x16x32_bf16 a[92:95], a[172:175], v[120:123], a[92:95]
  s_waitcnt lgkmcnt(6)
  v_exp_f32 v47, v47
  v_mfma_f32_16x16x32_bf16 a[92:95], a[168:171], v[88:91], a[92:95]
  ds_read_b128 a[136:139], v214 offset:49152
  v_cvt_pk_bf16_f32 v43, v46, v47
  v_mfma_f32_16x16x32_bf16 a[96:99], a[176:179], v[64:67], a[96:99]
  v_exp_f32 v52, v52
  v_mfma_f32_16x16x32_bf16 a[96:99], a[180:183], v[96:99], a[96:99]
  ds_read_b128 a[140:143], v215 offset:49152
  v_mfma_f32_16x16x32_bf16 a[100:103], a[180:183], v[104:107], a[100:103]
  v_exp_f32 v53, v53
  v_mfma_f32_16x16x32_bf16 a[100:103], a[176:179], v[72:75], a[100:103]
  v_cvt_pk_bf16_f32 v50, v52, v53
  v_mfma_f32_16x16x32_bf16 a[104:107], a[176:179], v[80:83], a[104:107]
  v_exp_f32 v54, v54
  v_mfma_f32_16x16x32_bf16 a[104:107], a[180:183], v[112:115], a[104:107]
  v_mfma_f32_16x16x32_bf16 a[108:111], a[180:183], v[120:123], a[108:111]
  s_waitcnt lgkmcnt(4)
  v_exp_f32 v55, v55
  v_mfma_f32_16x16x32_bf16 a[108:111], a[176:179], v[88:91], a[108:111]
  v_cvt_pk_bf16_f32 v51, v54, v55
  v_mfma_f32_16x16x32_bf16 a[112:115], a[184:187], v[64:67], a[112:115]
  v_exp_f32 v60, v60
  v_mfma_f32_16x16x32_bf16 a[112:115], a[188:191], v[96:99], a[112:115]
  v_mfma_f32_16x16x32_bf16 a[116:119], a[188:191], v[104:107], a[116:119]
  v_exp_f32 v61, v61
  v_mfma_f32_16x16x32_bf16 a[116:119], a[184:187], v[72:75], a[116:119]
  v_cvt_pk_bf16_f32 v58, v60, v61
  v_mfma_f32_16x16x32_bf16 a[120:123], a[184:187], v[80:83], a[120:123]
  v_exp_f32 v62, v62
  v_mfma_f32_16x16x32_bf16 a[120:123], a[188:191], v[112:115], a[120:123]
  v_mfma_f32_16x16x32_bf16 a[124:127], a[188:191], v[120:123], a[124:127]
  s_waitcnt lgkmcnt(0)
  v_exp_f32 v63, v63
  v_mfma_f32_16x16x32_bf16 a[124:127], a[184:187], v[88:91], a[124:127]
  v_cvt_pk_bf16_f32 v59, v62, v63
  v_mfma_f32_16x16x32_bf16 v[64:67], a[128:131], v[128:131], v[192:195]
  s_add_u32 m0, s28, 65536
  v_mfma_f32_16x16x32_bf16 v[64:67], a[132:135], v[132:135], v[64:67]
  ds_read_b128 a[144:147], v212 offset:53248
  v_mfma_f32_16x16x32_bf16 v[64:67], a[136:139], v[136:139], v[64:67]
  buffer_load_dwordx4 v236, s[16:19], s29 offen offset:0 lds
  v_mfma_f32_16x16x32_bf16 v[64:67], a[140:143], v[140:143], v[64:67]
  ds_read_b128 a[148:151], v213 offset:53248
  v_mfma_f32_16x16x32_bf16 v[72:75], a[140:143], v[156:159], v[196:199]
  v_mfma_f32_16x16x32_bf16 v[72:75], a[136:139], v[152:155], v[72:75]
  ds_read_b128 a[152:155], v214 offset:53248
  v_mfma_f32_16x16x32_bf16 v[72:75], a[132:135], v[148:151], v[72:75]
  buffer_load_dwordx4 v237, s[16:19], s29 offen offset:1024 lds
  v_mfma_f32_16x16x32_bf16 v[72:75], a[128:131], v[144:147], v[72:75]
  ds_read_b128 a[156:159], v215 offset:53248
  v_mfma_f32_16x16x32_bf16 v[80:83], a[128:131], v[160:163], v[200:203]
  v_exp_f32 v64, v64
  v_mfma_f32_16x16x32_bf16 v[80:83], a[132:135], v[164:167], v[80:83]
  v_mfma_f32_16x16x32_bf16 v[80:83], a[136:139], v[168:171], v[80:83]
  v_exp_f32 v65, v65
  v_mfma_f32_16x16x32_bf16 v[80:83], a[140:143], v[172:175], v[80:83]
  v_cvt_pk_bf16_f32 v64, v64, v65
  v_mfma_f32_16x16x32_bf16 v[88:91], a[140:143], v[188:191], v[204:207]
  v_exp_f32 v66, v66
  v_mfma_f32_16x16x32_bf16 v[88:91], a[136:139], v[184:187], v[88:91]
  buffer_load_dwordx4 v236, s[16:19], s29 offen offset:2048 lds
  v_mfma_f32_16x16x32_bf16 v[88:91], a[132:135], v[180:183], v[88:91]
  s_waitcnt lgkmcnt(0)
  v_exp_f32 v67, v67
  v_mfma_f32_16x16x32_bf16 v[88:91], a[128:131], v[176:179], v[88:91]
  v_cvt_pk_bf16_f32 v65, v66, v67
  v_mfma_f32_16x16x32_bf16 v[68:71], a[144:147], v[128:131], v[192:195]
  v_exp_f32 v72, v72
  v_mfma_f32_16x16x32_bf16 v[68:71], a[148:151], v[132:135], v[68:71]
  ds_read_b128 a[128:131], v212 offset:57344
  v_mfma_f32_16x16x32_bf16 v[68:71], a[152:155], v[136:139], v[68:71]
  v_exp_f32 v73, v73
  v_mfma_f32_16x16x32_bf16 v[68:71], a[156:159], v[140:143], v[68:71]
  ds_read_b128 a[132:135], v213 offset:57344
  v_cvt_pk_bf16_f32 v72, v72, v73
  v_mfma_f32_16x16x32_bf16 v[76:79], a[156:159], v[156:159], v[196:199]
  v_exp_f32 v74, v74
  v_mfma_f32_16x16x32_bf16 v[76:79], a[152:155], v[152:155], v[76:79]
  ds_read_b128 a[136:139], v214 offset:57344
  v_mfma_f32_16x16x32_bf16 v[76:79], a[148:151], v[148:151], v[76:79]
  v_exp_f32 v75, v75
  v_mfma_f32_16x16x32_bf16 v[76:79], a[144:147], v[144:147], v[76:79]
  ds_read_b128 a[140:143], v215 offset:57344
  v_cvt_pk_bf16_f32 v73, v74, v75
  v_mfma_f32_16x16x32_bf16 v[84:87], a[144:147], v[160:163], v[200:203]
  v_exp_f32 v80, v80
  v_mfma_f32_16x16x32_bf16 v[84:87], a[148:151], v[164:167], v[84:87]
  buffer_load_dwordx4 v237, s[16:19], s29 offen offset:3072 lds
  v_mfma_f32_16x16x32_bf16 v[84:87], a[152:155], v[168:171], v[84:87]
  s_add_u32 s29, s29, 16384
  v_exp_f32 v81, v81
  v_mfma_f32_16x16x32_bf16 v[84:87], a[156:159], v[172:175], v[84:87]
  v_cvt_pk_bf16_f32 v80, v80, v81
  v_mfma_f32_16x16x32_bf16 v[92:95], a[156:159], v[188:191], v[204:207]
  s_add_u32 m0, s28, 16384
  v_exp_f32 v82, v82
  v_mfma_f32_16x16x32_bf16 v[92:95], a[152:155], v[184:187], v[92:95]
  buffer_load_dwordx4 v232, s[12:15], s29 offen offset:0 lds
  v_mfma_f32_16x16x32_bf16 v[92:95], a[148:151], v[180:183], v[92:95]
  s_waitcnt lgkmcnt(0)
  v_exp_f32 v83, v83
  v_mfma_f32_16x16x32_bf16 v[92:95], a[144:147], v[176:179], v[92:95]
  v_cvt_pk_bf16_f32 v81, v82, v83
  v_mfma_f32_16x16x32_bf16 v[96:99], a[128:131], v[128:131], v[192:195]
  v_exp_f32 v88, v88
  v_mfma_f32_16x16x32_bf16 v[96:99], a[132:135], v[132:135], v[96:99]
  ds_read_b128 a[144:147], v212 offset:61440
  v_mfma_f32_16x16x32_bf16 v[96:99], a[136:139], v[136:139], v[96:99]
  v_exp_f32 v89, v89
  v_mfma_f32_16x16x32_bf16 v[96:99], a[140:143], v[140:143], v[96:99]
  ds_read_b128 a[148:151], v213 offset:61440
  v_cvt_pk_bf16_f32 v88, v88, v89
  v_mfma_f32_16x16x32_bf16 v[104:107], a[140:143], v[156:159], v[196:199]
  v_exp_f32 v90, v90
  v_mfma_f32_16x16x32_bf16 v[104:107], a[136:139], v[152:155], v[104:107]
  ds_read_b128 a[152:155], v214 offset:61440
  v_mfma_f32_16x16x32_bf16 v[104:107], a[132:135], v[148:151], v[104:107]
  v_exp_f32 v91, v91
  v_mfma_f32_16x16x32_bf16 v[104:107], a[128:131], v[144:147], v[104:107]
  ds_read_b128 a[156:159], v215 offset:61440
  v_cvt_pk_bf16_f32 v89, v90, v91
  v_mfma_f32_16x16x32_bf16 v[112:115], a[128:131], v[160:163], v[200:203]
  v_exp_f32 v68, v68
  v_mfma_f32_16x16x32_bf16 v[112:115], a[132:135], v[164:167], v[112:115]
  buffer_load_dwordx4 v233, s[12:15], s29 offen offset:1024 lds
  v_mfma_f32_16x16x32_bf16 v[112:115], a[136:139], v[168:171], v[112:115]
  v_exp_f32 v69, v69
  v_mfma_f32_16x16x32_bf16 v[112:115], a[140:143], v[172:175], v[112:115]
  v_cvt_pk_bf16_f32 v66, v68, v69
  v_mfma_f32_16x16x32_bf16 v[120:123], a[140:143], v[188:191], v[204:207]
  v_exp_f32 v70, v70
  v_mfma_f32_16x16x32_bf16 v[120:123], a[136:139], v[184:187], v[120:123]
  buffer_load_dwordx4 v234, s[12:15], s29 offen offset:2048 lds
  v_mfma_f32_16x16x32_bf16 v[120:123], a[132:135], v[180:183], v[120:123]
  s_waitcnt lgkmcnt(0)
  v_exp_f32 v71, v71
  v_mfma_f32_16x16x32_bf16 v[120:123], a[128:131], v[176:179], v[120:123]
  v_cvt_pk_bf16_f32 v67, v70, v71
  v_mfma_f32_16x16x32_bf16 v[100:103], a[144:147], v[128:131], v[192:195]
  v_exp_f32 v76, v76
  v_mfma_f32_16x16x32_bf16 v[100:103], a[148:151], v[132:135], v[100:103]
  ds_read_b64_tr_b16 a[160:161], v216 offset:32768
  v_mfma_f32_16x16x32_bf16 v[100:103], a[152:155], v[136:139], v[100:103]
  v_exp_f32 v77, v77
  v_mfma_f32_16x16x32_bf16 v[100:103], a[156:159], v[140:143], v[100:103]
  ds_read_b64_tr_b16 a[162:163], v216 offset:36864
  v_cvt_pk_bf16_f32 v74, v76, v77
  v_mfma_f32_16x16x32_bf16 v[108:111], a[156:159], v[156:159], v[196:199]
  v_exp_f32 v78, v78
  v_mfma_f32_16x16x32_bf16 v[108:111], a[152:155], v[152:155], v[108:111]
  ds_read_b64_tr_b16 a[164:165], v216 offset:40960
  buffer_load_dwordx4 v235, s[12:15], s29 offen offset:3072 lds
  v_mfma_f32_16x16x32_bf16 v[108:111], a[148:151], v[148:151], v[108:111]
  v_exp_f32 v79, v79
  v_mfma_f32_16x16x32_bf16 v[108:111], a[144:147], v[144:147], v[108:111]
  ds_read_b64_tr_b16 a[166:167], v216 offset:45056
  v_cvt_pk_bf16_f32 v75, v78, v79
  v_mfma_f32_16x16x32_bf16 v[116:119], a[144:147], v[160:163], v[200:203]
  v_exp_f32 v84, v84
  v_mfma_f32_16x16x32_bf16 v[116:119], a[148:151], v[164:167], v[116:119]
  ds_read_b64_tr_b16 a[168:169], v217 offset:32768
  buffer_load_dword v254, off, s[24:27], s47 sc1
  v_mfma_f32_16x16x32_bf16 v[116:119], a[152:155], v[168:171], v[116:119]
  v_exp_f32 v85, v85
  v_mfma_f32_16x16x32_bf16 v[116:119], a[156:159], v[172:175], v[116:119]
  ds_read_b64_tr_b16 a[170:171], v217 offset:36864
  v_cvt_pk_bf16_f32 v82, v84, v85
  v_mfma_f32_16x16x32_bf16 v[124:127], a[156:159], v[188:191], v[204:207]
  s_waitcnt vmcnt(20)
  v_exp_f32 v86, v86
  v_mfma_f32_16x16x32_bf16 v[124:127], a[152:155], v[184:187], v[124:127]
  ds_read_b64_tr_b16 a[172:173], v217 offset:40960
  ds_read_b64_tr_b16 a[232:233], v209 offset:5120
  v_mfma_f32_16x16x32_bf16 v[124:127], a[148:151], v[180:183], v[124:127]
  v_exp_f32 v87, v87
  v_mfma_f32_16x16x32_bf16 v[124:127], a[144:147], v[176:179], v[124:127]
  ds_read_b64_tr_b16 a[174:175], v217 offset:45056
  v_cvt_pk_bf16_f32 v83, v86, v87
  v_mfma_f32_16x16x32_bf16 a[192:195], a[208:211], v[0:3], a[192:195]
  v_exp_f32 v92, v92
  v_mfma_f32_16x16x32_bf16 a[192:195], a[208:211], v[32:35], a[192:195]
  ds_read_b64_tr_b16 a[176:177], v218 offset:32768
  ds_read_b64_tr_b16 a[234:235], v209 offset:5632
  v_mfma_f32_16x16x32_bf16 a[196:199], a[208:211], v[8:11], a[196:199]
  v_exp_f32 v93, v93
  v_mfma_f32_16x16x32_bf16 a[196:199], a[208:211], v[40:43], a[196:199]
  ds_read_b64_tr_b16 a[178:179], v218 offset:36864
  v_cvt_pk_bf16_f32 v90, v92, v93
  v_mfma_f32_16x16x32_bf16 a[200:203], a[208:211], v[16:19], a[200:203]
  v_exp_f32 v94, v94
  v_mfma_f32_16x16x32_bf16 a[200:203], a[208:211], v[48:51], a[200:203]
  ds_read_b64_tr_b16 a[180:181], v218 offset:40960
  v_mfma_f32_16x16x32_bf16 a[204:207], a[208:211], v[24:27], a[204:207]
  s_waitcnt lgkmcnt(9)
  v_exp_f32 v95, v95
  v_mfma_f32_16x16x32_bf16 a[204:207], a[208:211], v[56:59], a[204:207]
  ds_read_b64_tr_b16 a[182:183], v218 offset:45056
  v_cvt_pk_bf16_f32 v91, v94, v95
  v_mfma_f32_16x16x32_bf16 a[0:3], a[160:163], v[0:3], a[0:3]
  v_exp_f32 v96, v96
  v_mfma_f32_16x16x32_bf16 a[0:3], a[164:167], v[32:35], a[0:3]
  ds_read_b64_tr_b16 a[184:185], v219 offset:32768
  s_waitcnt lgkmcnt(4)
  buffer_store_dwordx4 a[232:235], v211, s[24:27], s31 offen sc1
  s_add_u32 s31, s31, 1024
  v_mfma_f32_16x16x32_bf16 a[4:7], a[164:167], v[40:43], a[4:7]
  v_exp_f32 v97, v97
  v_mfma_f32_16x16x32_bf16 a[4:7], a[160:163], v[8:11], a[4:7]
  ds_read_b64_tr_b16 a[186:187], v219 offset:36864
  v_cvt_pk_bf16_f32 v96, v96, v97
  v_mfma_f32_16x16x32_bf16 a[8:11], a[160:163], v[16:19], a[8:11]
  v_exp_f32 v98, v98
  v_mfma_f32_16x16x32_bf16 a[8:11], a[164:167], v[48:51], a[8:11]
  ds_read_b64_tr_b16 a[188:189], v219 offset:40960
  v_mfma_f32_16x16x32_bf16 a[12:15], a[164:167], v[56:59], a[12:15]
  v_exp_f32 v99, v99
  v_mfma_f32_16x16x32_bf16 a[12:15], a[160:163], v[24:27], a[12:15]
  ds_read_b64_tr_b16 a[190:191], v219 offset:45056
  v_cvt_pk_bf16_f32 v97, v98, v99
  v_mfma_f32_16x16x32_bf16 a[16:19], a[168:171], v[0:3], a[16:19]
  v_exp_f32 v104, v104
  v_mfma_f32_16x16x32_bf16 a[16:19], a[172:175], v[32:35], a[16:19]
  ds_read_b64_tr_b16 a[160:161], v220 offset:32768
  v_mfma_f32_16x16x32_bf16 a[20:23], a[172:175], v[40:43], a[20:23]
  v_exp_f32 v105, v105
  v_mfma_f32_16x16x32_bf16 a[20:23], a[168:171], v[8:11], a[20:23]
  ds_read_b64_tr_b16 a[162:163], v220 offset:36864
  v_cvt_pk_bf16_f32 v104, v104, v105
  v_mfma_f32_16x16x32_bf16 a[24:27], a[168:171], v[16:19], a[24:27]
  v_exp_f32 v106, v106
  v_mfma_f32_16x16x32_bf16 a[24:27], a[172:175], v[48:51], a[24:27]
  ds_read_b64_tr_b16 a[164:165], v220 offset:40960
  v_mfma_f32_16x16x32_bf16 a[28:31], a[172:175], v[56:59], a[28:31]
  s_waitcnt lgkmcnt(7)
  v_exp_f32 v107, v107
  v_mfma_f32_16x16x32_bf16 a[28:31], a[168:171], v[24:27], a[28:31]
  ds_read_b64_tr_b16 a[166:167], v220 offset:45056
  v_cvt_pk_bf16_f32 v105, v106, v107
  v_mfma_f32_16x16x32_bf16 a[32:35], a[176:179], v[0:3], a[32:35]
  v_exp_f32 v112, v112
  v_mfma_f32_16x16x32_bf16 a[32:35], a[180:183], v[32:35], a[32:35]
  ds_read_b64_tr_b16 a[168:169], v221 offset:32768
  v_mfma_f32_16x16x32_bf16 a[36:39], a[180:183], v[40:43], a[36:39]
  v_exp_f32 v113, v113
  v_mfma_f32_16x16x32_bf16 a[36:39], a[176:179], v[8:11], a[36:39]
  ds_read_b64_tr_b16 a[170:171], v221 offset:36864
  v_cvt_pk_bf16_f32 v112, v112, v113
  v_mfma_f32_16x16x32_bf16 a[40:43], a[176:179], v[16:19], a[40:43]
  v_exp_f32 v114, v114
  v_mfma_f32_16x16x32_bf16 a[40:43], a[180:183], v[48:51], a[40:43]
  ds_read_b64_tr_b16 a[172:173], v221 offset:40960
  v_mfma_f32_16x16x32_bf16 a[44:47], a[180:183], v[56:59], a[44:47]
  s_waitcnt lgkmcnt(7)
  v_exp_f32 v115, v115
  v_mfma_f32_16x16x32_bf16 a[44:47], a[176:179], v[24:27], a[44:47]
  ds_read_b64_tr_b16 a[174:175], v221 offset:45056
  v_cvt_pk_bf16_f32 v113, v114, v115
  v_mfma_f32_16x16x32_bf16 a[48:51], a[184:187], v[0:3], a[48:51]
  v_exp_f32 v120, v120
  v_mfma_f32_16x16x32_bf16 a[48:51], a[188:191], v[32:35], a[48:51]
  ds_read_b64_tr_b16 a[176:177], v222 offset:32768
  v_mfma_f32_16x16x32_bf16 a[52:55], a[188:191], v[40:43], a[52:55]
  v_exp_f32 v121, v121
  v_mfma_f32_16x16x32_bf16 a[52:55], a[184:187], v[8:11], a[52:55]
  ds_read_b64_tr_b16 a[178:179], v222 offset:36864
  v_cvt_pk_bf16_f32 v120, v120, v121
  v_mfma_f32_16x16x32_bf16 a[56:59], a[184:187], v[16:19], a[56:59]
  v_exp_f32 v122, v122
  v_mfma_f32_16x16x32_bf16 a[56:59], a[188:191], v[48:51], a[56:59]
  ds_read_b64_tr_b16 a[180:181], v222 offset:40960
  v_mfma_f32_16x16x32_bf16 a[60:63], a[188:191], v[56:59], a[60:63]
  s_waitcnt lgkmcnt(7)
  v_exp_f32 v123, v123
  v_mfma_f32_16x16x32_bf16 a[60:63], a[184:187], v[24:27], a[60:63]
  ds_read_b64_tr_b16 a[182:183], v222 offset:45056
  v_cvt_pk_bf16_f32 v121, v122, v123
  v_mfma_f32_16x16x32_bf16 a[64:67], a[160:163], v[0:3], a[64:67]
  v_exp_f32 v100, v100
  v_mfma_f32_16x16x32_bf16 a[64:67], a[164:167], v[32:35], a[64:67]
  ds_read_b64_tr_b16 a[184:185], v223 offset:32768
  v_mfma_f32_16x16x32_bf16 a[68:71], a[164:167], v[40:43], a[68:71]
  v_exp_f32 v101, v101
  v_mfma_f32_16x16x32_bf16 a[68:71], a[160:163], v[8:11], a[68:71]
  ds_read_b64_tr_b16 a[186:187], v223 offset:36864
  v_cvt_pk_bf16_f32 v98, v100, v101
  v_mfma_f32_16x16x32_bf16 a[72:75], a[160:163], v[16:19], a[72:75]
  v_exp_f32 v102, v102
  v_mfma_f32_16x16x32_bf16 a[72:75], a[164:167], v[48:51], a[72:75]
  ds_read_b64_tr_b16 a[188:189], v223 offset:40960
  v_mfma_f32_16x16x32_bf16 a[76:79], a[164:167], v[56:59], a[76:79]
  s_waitcnt lgkmcnt(7)
  v_exp_f32 v103, v103
  v_mfma_f32_16x16x32_bf16 a[76:79], a[160:163], v[24:27], a[76:79]
  ds_read_b64_tr_b16 a[190:191], v223 offset:45056
  v_cvt_pk_bf16_f32 v99, v102, v103
  v_mfma_f32_16x16x32_bf16 a[80:83], a[168:171], v[0:3], a[80:83]
  s_waitcnt vmcnt(12)
  v_exp_f32 v108, v108
  v_mfma_f32_16x16x32_bf16 a[80:83], a[172:175], v[32:35], a[80:83]
  v_mfma_f32_16x16x32_bf16 a[84:87], a[172:175], v[40:43], a[84:87]
  s_barrier
  v_exp_f32 v109, v109
  v_mfma_f32_16x16x32_bf16 a[84:87], a[168:171], v[8:11], a[84:87]
  ds_read_b128 a[128:131], v212 offset:0
  v_cvt_pk_bf16_f32 v106, v108, v109
  v_mfma_f32_16x16x32_bf16 a[88:91], a[168:171], v[16:19], a[88:91]
  v_exp_f32 v110, v110
  v_mfma_f32_16x16x32_bf16 a[88:91], a[172:175], v[48:51], a[88:91]
  ds_read_b128 a[132:135], v213 offset:0
  v_mfma_f32_16x16x32_bf16 a[92:95], a[172:175], v[56:59], a[92:95]
  s_waitcnt lgkmcnt(6)
  v_exp_f32 v111, v111
  v_mfma_f32_16x16x32_bf16 a[92:95], a[168:171], v[24:27], a[92:95]
  ds_read_b128 a[136:139], v214 offset:0
  v_cvt_pk_bf16_f32 v107, v110, v111
  v_mfma_f32_16x16x32_bf16 a[96:99], a[176:179], v[0:3], a[96:99]
  v_exp_f32 v116, v116
  v_mfma_f32_16x16x32_bf16 a[96:99], a[180:183], v[32:35], a[96:99]
  ds_read_b128 a[140:143], v215 offset:0
  v_mfma_f32_16x16x32_bf16 a[100:103], a[180:183], v[40:43], a[100:103]
  v_exp_f32 v117, v117
  v_mfma_f32_16x16x32_bf16 a[100:103], a[176:179], v[8:11], a[100:103]
  v_cvt_pk_bf16_f32 v114, v116, v117
  v_mfma_f32_16x16x32_bf16 a[104:107], a[176:179], v[16:19], a[104:107]
  v_exp_f32 v118, v118
  v_mfma_f32_16x16x32_bf16 a[104:107], a[180:183], v[48:51], a[104:107]
  v_mfma_f32_16x16x32_bf16 a[108:111], a[180:183], v[56:59], a[108:111]
  s_waitcnt lgkmcnt(4)
  v_exp_f32 v119, v119
  v_mfma_f32_16x16x32_bf16 a[108:111], a[176:179], v[24:27], a[108:111]
  v_cvt_pk_bf16_f32 v115, v118, v119
  v_mfma_f32_16x16x32_bf16 a[112:115], a[184:187], v[0:3], a[112:115]
  v_exp_f32 v124, v124
  v_mfma_f32_16x16x32_bf16 a[112:115], a[188:191], v[32:35], a[112:115]
  v_mfma_f32_16x16x32_bf16 a[116:119], a[188:191], v[40:43], a[116:119]
  s_sub_u32 s32, s32, 1
  v_exp_f32 v125, v125
  v_mfma_f32_16x16x32_bf16 a[116:119], a[184:187], v[8:11], a[116:119]
  v_cvt_pk_bf16_f32 v122, v124, v125
  v_mfma_f32_16x16x32_bf16 a[120:123], a[184:187], v[16:19], a[120:123]
  s_cmp_lg_u32 s32, 0
  v_exp_f32 v126, v126
  v_mfma_f32_16x16x32_bf16 a[120:123], a[188:191], v[48:51], a[120:123]
  v_mfma_f32_16x16x32_bf16 a[124:127], a[188:191], v[56:59], a[124:127]
  s_waitcnt lgkmcnt(0)
  v_exp_f32 v127, v127
  v_mfma_f32_16x16x32_bf16 a[124:127], a[184:187], v[24:27], a[124:127]
  v_cvt_pk_bf16_f32 v123, v126, v127
  s_cbranch_scc1 attn_loop
  s_waitcnt vmcnt(1)
  v_readfirstlane_b32 s38, v254
  s_nop 0
  s_cmp_ge_u32 s38, 512
  s_cbranch_scc1 attn_h_ready
  s_mov_b32 s39, 32768
attn_spin:
  s_sleep 4
  buffer_load_dword v254, off, s[24:27], s47 sc1
  s_waitcnt vmcnt(0)
  v_readfirstlane_b32 s38, v254
  s_nop 0
  s_cmp_ge_u32 s38, 512
  s_cbranch_scc1 attn_h_ready
  s_sub_u32 s39, s39, 1
  s_cmp_lg_u32 s39, 0
  s_cbranch_scc1 attn_spin
attn_h_ready:
  v_mfma_f32_16x16x32_bf16 v[0:3], a[128:131], v[128:131], v[192:195]
  s_add_u32 m0, s28, 81920
  s_and_b32 s38, s2, 1
  s_lshl_b32 s38, s38, 2
  v_lshrrev_b32 v224, 4, v242
  v_and_b32 v225, 7, v224
  v_mfma_f32_16x16x32_bf16 v[0:3], a[132:135], v[132:135], v[0:3]
  ds_read_b128 a[144:147], v212 offset:4096
  s_add_u32 s38, s38, s3
  s_mul_i32 s38, s38, 81920
  s_lshr_b32 s39, s2, 5
  v_mul_u32_u24 v225, 0xd80, v225
  v_mfma_f32_16x16x32_bf16 v[0:3], a[136:139], v[136:139], v[0:3]
  buffer_load_dwordx4 v236, s[16:19], s29 offen offset:0 lds
  s_mul_i32 s39, s39, 655360
  s_add_u32 s38, s38, s39
  s_add_u32 s4, s38, 3145728
  v_mfma_f32_16x16x32_bf16 v[0:3], a[140:143], v[140:143], v[0:3]
  ds_read_b128 a[148:151], v213 offset:4096
  s_add_u32 s5, s4, 12288
  s_add_u32 s6, s4, 24576
  s_add_u32 s7, s4, 36864
  v_lshrrev_b32 v224, 4, v224
  v_mfma_f32_16x16x32_bf16 v[8:11], a[140:143], v[156:159], v[196:199]
  s_add_u32 s8, s4, 49152
  s_add_u32 s9, s4, 61440
  s_add_u32 s10, s4, 73728
  v_lshl_add_u32 v225, v224, 4, v225
  v_add_u32 v252, 4096, v242
  v_mfma_f32_16x16x32_bf16 v[8:11], a[136:139], v[152:155], v[8:11]
  ds_read_b128 a[152:155], v214 offset:4096
  buffer_load_dwordx4 a[212:215], v225, s[24:27], s101 offen offset:0 sc1
  v_mfma_f32_16x16x32_bf16 v[8:11], a[132:135], v[148:151], v[8:11]
  buffer_load_dwordx4 v237, s[16:19], s29 offen offset:1024 lds
  v_mfma_f32_16x16x32_bf16 v[8:11], a[128:131], v[144:147], v[8:11]
  ds_read_b128 a[156:159], v215 offset:4096
  buffer_load_dwordx4 a[216:219], v225, s[24:27], s101 offen offset:64 sc1
  v_mfma_f32_16x16x32_bf16 v[16:19], a[128:131], v[160:163], v[200:203]
  v_exp_f32 v0, v0
  v_mfma_f32_16x16x32_bf16 v[16:19], a[132:135], v[164:167], v[16:19]
  buffer_load_dwordx4 a[220:223], v225, s[24:27], s101 offen offset:128 sc1
  v_mfma_f32_16x16x32_bf16 v[16:19], a[136:139], v[168:171], v[16:19]
  v_exp_f32 v1, v1
  v_mfma_f32_16x16x32_bf16 v[16:19], a[140:143], v[172:175], v[16:19]
  v_cvt_pk_bf16_f32 v0, v0, v1
  v_add_u32 v253, 8192, v242
  v_mfma_f32_16x16x32_bf16 v[24:27], a[140:143], v[188:191], v[204:207]
  v_exp_f32 v2, v2
  v_mfma_f32_16x16x32_bf16 v[24:27], a[136:139], v[184:187], v[24:27]
  buffer_load_dwordx4 v236, s[16:19], s29 offen offset:2048 lds
  v_mfma_f32_16x16x32_bf16 v[24:27], a[132:135], v[180:183], v[24:27]
  s_waitcnt lgkmcnt(0)
  v_exp_f32 v3, v3
  v_mfma_f32_16x16x32_bf16 v[24:27], a[128:131], v[176:179], v[24:27]
  v_cvt_pk_bf16_f32 v1, v2, v3
  v_mfma_f32_16x16x32_bf16 v[4:7], a[144:147], v[128:131], v[192:195]
  v_exp_f32 v8, v8
  v_mfma_f32_16x16x32_bf16 v[4:7], a[148:151], v[132:135], v[4:7]
  ds_read_b128 a[128:131], v212 offset:8192
  v_mfma_f32_16x16x32_bf16 v[4:7], a[152:155], v[136:139], v[4:7]
  v_exp_f32 v9, v9
  v_mfma_f32_16x16x32_bf16 v[4:7], a[156:159], v[140:143], v[4:7]
  ds_read_b128 a[132:135], v213 offset:8192
  v_cvt_pk_bf16_f32 v8, v8, v9
  v_mfma_f32_16x16x32_bf16 v[12:15], a[156:159], v[156:159], v[196:199]
  v_exp_f32 v10, v10
  v_mfma_f32_16x16x32_bf16 v[12:15], a[152:155], v[152:155], v[12:15]
  ds_read_b128 a[136:139], v214 offset:8192
  v_mfma_f32_16x16x32_bf16 v[12:15], a[148:151], v[148:151], v[12:15]
  v_exp_f32 v11, v11
  v_mfma_f32_16x16x32_bf16 v[12:15], a[144:147], v[144:147], v[12:15]
  ds_read_b128 a[140:143], v215 offset:8192
  v_cvt_pk_bf16_f32 v9, v10, v11
  v_mfma_f32_16x16x32_bf16 v[20:23], a[144:147], v[160:163], v[200:203]
  v_exp_f32 v16, v16
  v_mfma_f32_16x16x32_bf16 v[20:23], a[148:151], v[164:167], v[20:23]
  buffer_load_dwordx4 v237, s[16:19], s29 offen offset:3072 lds
  v_mfma_f32_16x16x32_bf16 v[20:23], a[152:155], v[168:171], v[20:23]
  s_add_u32 s29, s29, 16384
  v_exp_f32 v17, v17
  v_mfma_f32_16x16x32_bf16 v[20:23], a[156:159], v[172:175], v[20:23]
  v_cvt_pk_bf16_f32 v16, v16, v17
  v_mfma_f32_16x16x32_bf16 v[28:31], a[156:159], v[188:191], v[204:207]
  s_add_u32 m0, s28, 32768
  v_exp_f32 v18, v18
  v_mfma_f32_16x16x32_bf16 v[28:31], a[152:155], v[184:187], v[28:31]
  buffer_load_dwordx4 v232, s[12:15], s29 offen offset:0 lds
  v_mfma_f32_16x16x32_bf16 v[28:31], a[148:151], v[180:183], v[28:31]
  s_waitcnt lgkmcnt(0)
  v_exp_f32 v19, v19
  v_mfma_f32_16x16x32_bf16 v[28:31], a[144:147], v[176:179], v[28:31]
  v_cvt_pk_bf16_f32 v17, v18, v19
  v_mfma_f32_16x16x32_bf16 v[32:35], a[128:131], v[128:131], v[192:195]
  v_exp_f32 v24, v24
  v_mfma_f32_16x16x32_bf16 v[32:35], a[132:135], v[132:135], v[32:35]
  ds_read_b128 a[144:147], v212 offset:12288
  v_mfma_f32_16x16x32_bf16 v[32:35], a[136:139], v[136:139], v[32:35]
  v_exp_f32 v25, v25
  v_mfma_f32_16x16x32_bf16 v[32:35], a[140:143], v[140:143], v[32:35]
  ds_read_b128 a[148:151], v213 offset:12288
  v_cvt_pk_bf16_f32 v24, v24, v25
  v_mfma_f32_16x16x32_bf16 v[40:43], a[140:143], v[156:159], v[196:199]
  v_exp_f32 v26, v26
  v_mfma_f32_16x16x32_bf16 v[40:43], a[136:139], v[152:155], v[40:43]
  ds_read_b128 a[152:155], v214 offset:12288
  v_mfma_f32_16x16x32_bf16 v[40:43], a[132:135], v[148:151], v[40:43]
  v_exp_f32 v27, v27
  v_mfma_f32_16x16x32_bf16 v[40:43], a[128:131], v[144:147], v[40:43]
  ds_read_b128 a[156:159], v215 offset:12288
  v_cvt_pk_bf16_f32 v25, v26, v27
  v_mfma_f32_16x16x32_bf16 v[48:51], a[128:131], v[160:163], v[200:203]
  v_exp_f32 v4, v4
  v_mfma_f32_16x16x32_bf16 v[48:51], a[132:135], v[164:167], v[48:51]
  buffer_load_dwordx4 v233, s[12:15], s29 offen offset:1024 lds
  v_mfma_f32_16x16x32_bf16 v[48:51], a[136:139], v[168:171], v[48:51]
  v_exp_f32 v5, v5
  v_mfma_f32_16x16x32_bf16 v[48:51], a[140:143], v[172:175], v[48:51]
  v_cvt_pk_bf16_f32 v2, v4, v5
  v_mfma_f32_16x16x32_bf16 v[56:59], a[140:143], v[188:191], v[204:207]
  v_exp_f32 v6, v6
  v_mfma_f32_16x16x32_bf16 v[56:59], a[136:139], v[184:187], v[56:59]
  buffer_load_dwordx4 v234, s[12:15], s29 offen offset:2048 lds
  v_mfma_f32_16x16x32_bf16 v[56:59], a[132:135], v[180:183], v[56:59]
  s_waitcnt lgkmcnt(0)
  v_exp_f32 v7, v7
  v_mfma_f32_16x16x32_bf16 v[56:59], a[128:131], v[176:179], v[56:59]
  v_cvt_pk_bf16_f32 v3, v6, v7
  v_mfma_f32_16x16x32_bf16 v[36:39], a[144:147], v[128:131], v[192:195]
  v_exp_f32 v12, v12
  v_mfma_f32_16x16x32_bf16 v[36:39], a[148:151], v[132:135], v[36:39]
  ds_read_b64_tr_b16 a[160:161], v216 offset:49152
  v_mfma_f32_16x16x32_bf16 v[36:39], a[152:155], v[136:139], v[36:39]
  v_exp_f32 v13, v13
  v_mfma_f32_16x16x32_bf16 v[36:39], a[156:159], v[140:143], v[36:39]
  ds_read_b64_tr_b16 a[162:163], v216 offset:53248
  v_cvt_pk_bf16_f32 v10, v12, v13
  v_mfma_f32_16x16x32_bf16 v[44:47], a[156:159], v[156:159], v[196:199]
  v_exp_f32 v14, v14
  v_mfma_f32_16x16x32_bf16 v[44:47], a[152:155], v[152:155], v[44:47]
  ds_read_b64_tr_b16 a[164:165], v216 offset:57344
  buffer_load_dwordx4 v235, s[12:15], s29 offen offset:3072 lds
  v_mfma_f32_16x16x32_bf16 v[44:47], a[148:151], v[148:151], v[44:47]
  v_exp_f32 v15, v15
  v_mfma_f32_16x16x32_bf16 v[44:47], a[144:147], v[144:147], v[44:47]
  ds_read_b64_tr_b16 a[166:167], v216 offset:61440
  v_cvt_pk_bf16_f32 v11, v14, v15
  v_mfma_f32_16x16x32_bf16 v[52:55], a[144:147], v[160:163], v[200:203]
  v_exp_f32 v20, v20
  v_mfma_f32_16x16x32_bf16 v[52:55], a[148:151], v[164:167], v[52:55]
  ds_read_b64_tr_b16 a[168:169], v217 offset:49152
  v_mfma_f32_16x16x32_bf16 v[52:55], a[152:155], v[168:171], v[52:55]
  v_exp_f32 v21, v21
  v_mfma_f32_16x16x32_bf16 v[52:55], a[156:159], v[172:175], v[52:55]
  ds_read_b64_tr_b16 a[170:171], v217 offset:53248
  v_cvt_pk_bf16_f32 v18, v20, v21
  v_mfma_f32_16x16x32_bf16 v[60:63], a[156:159], v[188:191], v[204:207]
  v_exp_f32 v22, v22
  v_mfma_f32_16x16x32_bf16 v[60:63], a[152:155], v[184:187], v[60:63]
  ds_read_b64_tr_b16 a[172:173], v217 offset:57344
  v_mfma_f32_16x16x32_bf16 v[60:63], a[148:151], v[180:183], v[60:63]
  v_exp_f32 v23, v23
  v_mfma_f32_16x16x32_bf16 v[60:63], a[144:147], v[176:179], v[60:63]
  ds_read_b64_tr_b16 a[174:175], v217 offset:61440
  v_cvt_pk_bf16_f32 v19, v22, v23
  v_mfma_f32_16x16x32_bf16 a[192:195], a[208:211], v[64:67], a[192:195]
  v_exp_f32 v28, v28
  v_mfma_f32_16x16x32_bf16 a[192:195], a[208:211], v[96:99], a[192:195]
  ds_read_b64_tr_b16 a[176:177], v218 offset:49152
  v_mfma_f32_16x16x32_bf16 a[196:199], a[208:211], v[72:75], a[196:199]
  v_exp_f32 v29, v29
  v_mfma_f32_16x16x32_bf16 a[196:199], a[208:211], v[104:107], a[196:199]
  ds_read_b64_tr_b16 a[178:179], v218 offset:53248
  v_cvt_pk_bf16_f32 v26, v28, v29
  v_mfma_f32_16x16x32_bf16 a[200:203], a[208:211], v[80:83], a[200:203]
  v_exp_f32 v30, v30
  v_mfma_f32_16x16x32_bf16 a[200:203], a[208:211], v[112:115], a[200:203]
  ds_read_b64_tr_b16 a[180:181], v218 offset:57344
  v_mfma_f32_16x16x32_bf16 a[204:207], a[208:211], v[88:91], a[204:207]
  s_waitcnt lgkmcnt(7)
  v_exp_f32 v31, v31
  v_mfma_f32_16x16x32_bf16 a[204:207], a[208:211], v[120:123], a[204:207]
  ds_read_b64_tr_b16 a[182:183], v218 offset:61440
  v_cvt_pk_bf16_f32 v27, v30, v31
  v_mfma_f32_16x16x32_bf16 a[0:3], a[160:163], v[64:67], a[0:3]
  v_exp_f32 v32, v32
  v_mfma_f32_16x16x32_bf16 a[0:3], a[164:167], v[96:99], a[0:3]
  ds_read_b64_tr_b16 a[184:185], v219 offset:49152
  v_mfma_f32_16x16x32_bf16 a[4:7], a[164:167], v[104:107], a[4:7]
  v_exp_f32 v33, v33
  v_mfma_f32_16x16x32_bf16 a[4:7], a[160:163], v[72:75], a[4:7]
  ds_read_b64_tr_b16 a[186:187], v219 offset:53248
  v_cvt_pk_bf16_f32 v32, v32, v33
  v_mfma_f32_16x16x32_bf16 a[8:11], a[160:163], v[80:83], a[8:11]
  v_exp_f32 v34, v34
  v_mfma_f32_16x16x32_bf16 a[8:11], a[164:167], v[112:115], a[8:11]
  ds_read_b64_tr_b16 a[188:189], v219 offset:57344
  v_mfma_f32_16x16x32_bf16 a[12:15], a[164:167], v[120:123], a[12:15]
  s_waitcnt lgkmcnt(7)
  v_exp_f32 v35, v35
  v_mfma_f32_16x16x32_bf16 a[12:15], a[160:163], v[88:91], a[12:15]
  ds_read_b64_tr_b16 a[190:191], v219 offset:61440
  v_cvt_pk_bf16_f32 v33, v34, v35
  v_mfma_f32_16x16x32_bf16 a[16:19], a[168:171], v[64:67], a[16:19]
  v_exp_f32 v40, v40
  v_mfma_f32_16x16x32_bf16 a[16:19], a[172:175], v[96:99], a[16:19]
  ds_read_b64_tr_b16 a[160:161], v220 offset:49152
  v_mfma_f32_16x16x32_bf16 a[20:23], a[172:175], v[104:107], a[20:23]
  v_exp_f32 v41, v41
  v_mfma_f32_16x16x32_bf16 a[20:23], a[168:171], v[72:75], a[20:23]
  ds_read_b64_tr_b16 a[162:163], v220 offset:53248
  v_cvt_pk_bf16_f32 v40, v40, v41
  v_mfma_f32_16x16x32_bf16 a[24:27], a[168:171], v[80:83], a[24:27]
  v_exp_f32 v42, v42
  v_mfma_f32_16x16x32_bf16 a[24:27], a[172:175], v[112:115], a[24:27]
  ds_read_b64_tr_b16 a[164:165], v220 offset:57344
  v_mfma_f32_16x16x32_bf16 a[28:31], a[172:175], v[120:123], a[28:31]
  s_waitcnt lgkmcnt(7)
  v_exp_f32 v43, v43
  v_mfma_f32_16x16x32_bf16 a[28:31], a[168:171], v[88:91], a[28:31]
  ds_read_b64_tr_b16 a[166:167], v220 offset:61440
  v_cvt_pk_bf16_f32 v41, v42, v43
  v_mfma_f32_16x16x32_bf16 a[32:35], a[176:179], v[64:67], a[32:35]
  v_exp_f32 v48, v48
  v_mfma_f32_16x16x32_bf16 a[32:35], a[180:183], v[96:99], a[32:35]
  ds_read_b64_tr_b16 a[168:169], v221 offset:49152
  v_mfma_f32_16x16x32_bf16 a[36:39], a[180:183], v[104:107], a[36:39]
  v_exp_f32 v49, v49
  v_mfma_f32_16x16x32_bf16 a[36:39], a[176:179], v[72:75], a[36:39]
  ds_read_b64_tr_b16 a[170:171], v221 offset:53248
  v_cvt_pk_bf16_f32 v48, v48, v49
  v_mfma_f32_16x16x32_bf16 a[40:43], a[176:179], v[80:83], a[40:43]
  v_exp_f32 v50, v50
  v_mfma_f32_16x16x32_bf16 a[40:43], a[180:183], v[112:115], a[40:43]
  ds_read_b64_tr_b16 a[172:173], v221 offset:57344
  v_mfma_f32_16x16x32_bf16 a[44:47], a[180:183], v[120:123], a[44:47]
  s_waitcnt lgkmcnt(7)
  v_exp_f32 v51, v51
  v_mfma_f32_16x16x32_bf16 a[44:47], a[176:179], v[88:91], a[44:47]
  ds_read_b64_tr_b16 a[174:175], v221 offset:61440
  v_cvt_pk_bf16_f32 v49, v50, v51
  v_mfma_f32_16x16x32_bf16 a[48:51], a[184:187], v[64:67], a[48:51]
  v_exp_f32 v56, v56
  v_mfma_f32_16x16x32_bf16 a[48:51], a[188:191], v[96:99], a[48:51]
  ds_read_b64_tr_b16 a[176:177], v222 offset:49152
  v_mfma_f32_16x16x32_bf16 a[52:55], a[188:191], v[104:107], a[52:55]
  v_exp_f32 v57, v57
  v_mfma_f32_16x16x32_bf16 a[52:55], a[184:187], v[72:75], a[52:55]
  ds_read_b64_tr_b16 a[178:179], v222 offset:53248
  v_cvt_pk_bf16_f32 v56, v56, v57
  v_mfma_f32_16x16x32_bf16 a[56:59], a[184:187], v[80:83], a[56:59]
  v_exp_f32 v58, v58
  v_mfma_f32_16x16x32_bf16 a[56:59], a[188:191], v[112:115], a[56:59]
  ds_read_b64_tr_b16 a[180:181], v222 offset:57344
  v_mfma_f32_16x16x32_bf16 a[60:63], a[188:191], v[120:123], a[60:63]
  s_waitcnt lgkmcnt(7)
  v_exp_f32 v59, v59
  v_mfma_f32_16x16x32_bf16 a[60:63], a[184:187], v[88:91], a[60:63]
  ds_read_b64_tr_b16 a[182:183], v222 offset:61440
  v_cvt_pk_bf16_f32 v57, v58, v59
  v_mfma_f32_16x16x32_bf16 a[64:67], a[160:163], v[64:67], a[64:67]
  v_exp_f32 v36, v36
  v_mfma_f32_16x16x32_bf16 a[64:67], a[164:167], v[96:99], a[64:67]
  ds_read_b64_tr_b16 a[184:185], v223 offset:49152
  v_mfma_f32_16x16x32_bf16 a[68:71], a[164:167], v[104:107], a[68:71]
  v_exp_f32 v37, v37
  v_mfma_f32_16x16x32_bf16 a[68:71], a[160:163], v[72:75], a[68:71]
  ds_read_b64_tr_b16 a[186:187], v223 offset:53248
  v_cvt_pk_bf16_f32 v34, v36, v37
  v_mfma_f32_16x16x32_bf16 a[72:75], a[160:163], v[80:83], a[72:75]
  v_exp_f32 v38, v38
  v_mfma_f32_16x16x32_bf16 a[72:75], a[164:167], v[112:115], a[72:75]
  ds_read_b64_tr_b16 a[188:189], v223 offset:57344
  v_mfma_f32_16x16x32_bf16 a[76:79], a[164:167], v[120:123], a[76:79]
  s_waitcnt lgkmcnt(7)
  v_exp_f32 v39, v39
  v_mfma_f32_16x16x32_bf16 a[76:79], a[160:163], v[88:91], a[76:79]
  ds_read_b64_tr_b16 a[190:191], v223 offset:61440
  v_cvt_pk_bf16_f32 v35, v38, v39
  v_mfma_f32_16x16x32_bf16 a[80:83], a[168:171], v[64:67], a[80:83]
  v_exp_f32 v44, v44
  v_mfma_f32_16x16x32_bf16 a[80:83], a[172:175], v[96:99], a[80:83]
  v_mfma_f32_16x16x32_bf16 a[84:87], a[172:175], v[104:107], a[84:87]
  s_barrier
  v_exp_f32 v45, v45
  v_mfma_f32_16x16x32_bf16 a[84:87], a[168:171], v[72:75], a[84:87]
  ds_read_b128 a[128:131], v212 offset:16384
  v_cvt_pk_bf16_f32 v42, v44, v45
  v_mfma_f32_16x16x32_bf16 a[88:91], a[168:171], v[80:83], a[88:91]
  v_exp_f32 v46, v46
  v_mfma_f32_16x16x32_bf16 a[88:91], a[172:175], v[112:115], a[88:91]
  ds_read_b128 a[132:135], v213 offset:16384
  v_mfma_f32_16x16x32_bf16 a[92:95], a[172:175], v[120:123], a[92:95]
  s_waitcnt lgkmcnt(6)
  v_exp_f32 v47, v47
  v_mfma_f32_16x16x32_bf16 a[92:95], a[168:171], v[88:91], a[92:95]
  ds_read_b128 a[136:139], v214 offset:16384
  v_cvt_pk_bf16_f32 v43, v46, v47
  v_mfma_f32_16x16x32_bf16 a[96:99], a[176:179], v[64:67], a[96:99]
  v_exp_f32 v52, v52
  v_mfma_f32_16x16x32_bf16 a[96:99], a[180:183], v[96:99], a[96:99]
  ds_read_b128 a[140:143], v215 offset:16384
  v_mfma_f32_16x16x32_bf16 a[100:103], a[180:183], v[104:107], a[100:103]
  v_exp_f32 v53, v53
  v_mfma_f32_16x16x32_bf16 a[100:103], a[176:179], v[72:75], a[100:103]
  v_cvt_pk_bf16_f32 v50, v52, v53
  v_mfma_f32_16x16x32_bf16 a[104:107], a[176:179], v[80:83], a[104:107]
  v_exp_f32 v54, v54
  v_mfma_f32_16x16x32_bf16 a[104:107], a[180:183], v[112:115], a[104:107]
  v_mfma_f32_16x16x32_bf16 a[108:111], a[180:183], v[120:123], a[108:111]
  s_waitcnt lgkmcnt(4)
  v_exp_f32 v55, v55
  v_mfma_f32_16x16x32_bf16 a[108:111], a[176:179], v[88:91], a[108:111]
  v_cvt_pk_bf16_f32 v51, v54, v55
  v_mfma_f32_16x16x32_bf16 a[112:115], a[184:187], v[64:67], a[112:115]
  v_exp_f32 v60, v60
  v_mfma_f32_16x16x32_bf16 a[112:115], a[188:191], v[96:99], a[112:115]
  v_mfma_f32_16x16x32_bf16 a[116:119], a[188:191], v[104:107], a[116:119]
  v_exp_f32 v61, v61
  v_mfma_f32_16x16x32_bf16 a[116:119], a[184:187], v[72:75], a[116:119]
  v_cvt_pk_bf16_f32 v58, v60, v61
  v_mfma_f32_16x16x32_bf16 a[120:123], a[184:187], v[80:83], a[120:123]
  v_exp_f32 v62, v62
  v_mfma_f32_16x16x32_bf16 a[120:123], a[188:191], v[112:115], a[120:123]
  v_mfma_f32_16x16x32_bf16 a[124:127], a[188:191], v[120:123], a[124:127]
  s_waitcnt lgkmcnt(0)
  v_exp_f32 v63, v63
  v_mfma_f32_16x16x32_bf16 a[124:127], a[184:187], v[88:91], a[124:127]
  v_cvt_pk_bf16_f32 v59, v62, v63
  v_mfma_f32_16x16x32_bf16 v[64:67], a[128:131], v[128:131], v[192:195]
  s_add_u32 m0, s28, 98304
  v_mfma_f32_16x16x32_bf16 v[64:67], a[132:135], v[132:135], v[64:67]
  ds_read_b128 a[144:147], v212 offset:20480
  v_mfma_f32_16x16x32_bf16 v[64:67], a[136:139], v[136:139], v[64:67]
  buffer_load_dwordx4 v236, s[16:19], s29 offen offset:0 lds
  v_mfma_f32_16x16x32_bf16 v[64:67], a[140:143], v[140:143], v[64:67]
  ds_read_b128 a[148:151], v213 offset:20480
  v_mfma_f32_16x16x32_bf16 v[72:75], a[140:143], v[156:159], v[196:199]
  v_mfma_f32_16x16x32_bf16 v[72:75], a[136:139], v[152:155], v[72:75]
  ds_read_b128 a[152:155], v214 offset:20480
  v_mfma_f32_16x16x32_bf16 v[72:75], a[132:135], v[148:151], v[72:75]
  buffer_load_dwordx4 v237, s[16:19], s29 offen offset:1024 lds
  v_mfma_f32_16x16x32_bf16 v[72:75], a[128:131], v[144:147], v[72:75]
  ds_read_b128 a[156:159], v215 offset:20480
  v_mfma_f32_16x16x32_bf16 v[80:83], a[128:131], v[160:163], v[200:203]
  v_exp_f32 v64, v64
  v_mfma_f32_16x16x32_bf16 v[80:83], a[132:135], v[164:167], v[80:83]
  v_mfma_f32_16x16x32_bf16 v[80:83], a[136:139], v[168:171], v[80:83]
  v_exp_f32 v65, v65
  v_mfma_f32_16x16x32_bf16 v[80:83], a[140:143], v[172:175], v[80:83]
  v_cvt_pk_bf16_f32 v64, v64, v65
  v_mfma_f32_16x16x32_bf16 v[88:91], a[140:143], v[188:191], v[204:207]
  v_exp_f32 v66, v66
  v_mfma_f32_16x16x32_bf16 v[88:91], a[136:139], v[184:187], v[88:91]
  buffer_load_dwordx4 v236, s[16:19], s29 offen offset:2048 lds
  v_mfma_f32_16x16x32_bf16 v[88:91], a[132:135], v[180:183], v[88:91]
  s_waitcnt lgkmcnt(0)
  v_exp_f32 v67, v67
  v_mfma_f32_16x16x32_bf16 v[88:91], a[128:131], v[176:179], v[88:91]
  v_cvt_pk_bf16_f32 v65, v66, v67
  v_mfma_f32_16x16x32_bf16 v[68:71], a[144:147], v[128:131], v[192:195]
  v_exp_f32 v72, v72
  v_mfma_f32_16x16x32_bf16 v[68:71], a[148:151], v[132:135], v[68:71]
  ds_read_b128 a[128:131], v212 offset:24576
  v_mfma_f32_16x16x32_bf16 v[68:71], a[152:155], v[136:139], v[68:71]
  v_exp_f32 v73, v73
  v_mfma_f32_16x16x32_bf16 v[68:71], a[156:159], v[140:143], v[68:71]
  ds_read_b128 a[132:135], v213 offset:24576
  v_cvt_pk_bf16_f32 v72, v72, v73
  v_mfma_f32_16x16x32_bf16 v[76:79], a[156:159], v[156:159], v[196:199]
  v_exp_f32 v74, v74
  v_mfma_f32_16x16x32_bf16 v[76:79], a[152:155], v[152:155], v[76:79]
  ds_read_b128 a[136:139], v214 offset:24576
  v_lshrrev_b32 v224, 4, v242
  v_mfma_f32_16x16x32_bf16 v[76:79], a[148:151], v[148:151], v[76:79]
  v_exp_f32 v75, v75
  v_mfma_f32_16x16x32_bf16 v[76:79], a[144:147], v[144:147], v[76:79]
  ds_read_b128 a[140:143], v215 offset:24576
  v_cvt_pk_bf16_f32 v73, v74, v75
  v_mfma_f32_16x16x32_bf16 v[84:87], a[144:147], v[160:163], v[200:203]
  v_exp_f32 v80, v80
  v_mfma_f32_16x16x32_bf16 v[84:87], a[148:151], v[164:167], v[84:87]
  buffer_load_dwordx4 v237, s[16:19], s29 offen offset:3072 lds
  v_mfma_f32_16x16x32_bf16 v[84:87], a[152:155], v[168:171], v[84:87]
  s_add_u32 s29, s29, 16384
  v_exp_f32 v81, v81
  v_mfma_f32_16x16x32_bf16 v[84:87], a[156:159], v[172:175], v[84:87]
  v_cvt_pk_bf16_f32 v80, v80, v81
  v_lshrrev_b32 v225, 4, v224
  v_mfma_f32_16x16x32_bf16 v[92:95], a[156:159], v[188:191], v[204:207]
  s_add_u32 m0, s28, 49152
  v_exp_f32 v82, v82
  v_mfma_f32_16x16x32_bf16 v[92:95], a[152:155], v[184:187], v[92:95]
  buffer_load_dwordx4 v232, s[12:15], s29 offen offset:0 lds
  v_mfma_f32_16x16x32_bf16 v[92:95], a[148:151], v[180:183], v[92:95]
  s_waitcnt lgkmcnt(0)
  v_exp_f32 v83, v83
  v_mfma_f32_16x16x32_bf16 v[92:95], a[144:147], v[176:179], v[92:95]
  v_cvt_pk_bf16_f32 v81, v82, v83
  v_bfe_u32 v226, v224, 2, 2
  v_mfma_f32_16x16x32_bf16 v[96:99], a[128:131], v[128:131], v[192:195]
  v_exp_f32 v88, v88
  v_mfma_f32_16x16x32_bf16 v[96:99], a[132:135], v[132:135], v[96:99]
  ds_read_b128 a[144:147], v212 offset:28672
  v_lshl_add_u32 v225, v225, 3, v226
  v_mfma_f32_16x16x32_bf16 v[96:99], a[136:139], v[136:139], v[96:99]
  v_exp_f32 v89, v89
  v_mfma_f32_16x16x32_bf16 v[96:99], a[140:143], v[140:143], v[96:99]
  ds_read_b128 a[148:151], v213 offset:28672
  v_cvt_pk_bf16_f32 v88, v88, v89
  v_mfma_f32_16x16x32_bf16 v[104:107], a[140:143], v[156:159], v[196:199]
  v_exp_f32 v90, v90
  v_mfma_f32_16x16x32_bf16 v[104:107], a[136:139], v[152:155], v[104:107]
  ds_read_b128 a[152:155], v214 offset:28672
  v_lshlrev_b32 v225, 5, v225
  v_mfma_f32_16x16x32_bf16 v[104:107], a[132:135], v[148:151], v[104:107]
  v_exp_f32 v91, v91
  v_mfma_f32_16x16x32_bf16 v[104:107], a[128:131], v[144:147], v[104:107]
  ds_read_b128 a[156:159], v215 offset:28672
  v_cvt_pk_bf16_f32 v89, v90, v91
  v_mfma_f32_16x16x32_bf16 v[112:115], a[128:131], v[160:163], v[200:203]
  v_exp_f32 v68, v68
  v_mfma_f32_16x16x32_bf16 v[112:115], a[132:135], v[164:167], v[112:115]
  buffer_load_dwordx4 v233, s[12:15], s29 offen offset:1024 lds
  v_mfma_f32_16x16x32_bf16 v[112:115], a[136:139], v[168:171], v[112:115]
  v_exp_f32 v69, v69
  v_mfma_f32_16x16x32_bf16 v[112:115], a[140:143], v[172:175], v[112:115]
  v_cvt_pk_bf16_f32 v66, v68, v69
  v_and_b32 v226, 3, v224
  v_mfma_f32_16x16x32_bf16 v[120:123], a[140:143], v[188:191], v[204:207]
  v_exp_f32 v70, v70
  v_mfma_f32_16x16x32_bf16 v[120:123], a[136:139], v[184:187], v[120:123]
  buffer_load_dwordx4 v234, s[12:15], s29 offen offset:2048 lds
  v_mfma_f32_16x16x32_bf16 v[120:123], a[132:135], v[180:183], v[120:123]
  s_waitcnt lgkmcnt(0)
  v_exp_f32 v71, v71
  v_mfma_f32_16x16x32_bf16 v[120:123], a[128:131], v[176:179], v[120:123]
  v_cvt_pk_bf16_f32 v67, v70, v71
  v_lshl_add_u32 v225, v226, 3, v225
  v_mfma_f32_16x16x32_bf16 v[100:103], a[144:147], v[128:131], v[192:195]
  v_exp_f32 v76, v76
  v_mfma_f32_16x16x32_bf16 v[100:103], a[148:151], v[132:135], v[100:103]
  ds_read_b64_tr_b16 a[160:161], v216 offset:0
  v_add_u32 v225, s50, v225
  v_mfma_f32_16x16x32_bf16 v[100:103], a[152:155], v[136:139], v[100:103]
  s_waitcnt vmcnt(13)
  v_exp_f32 v77, v77
  v_mfma_f32_16x16x32_bf16 v[100:103], a[156:159], v[140:143], v[100:103]
  ds_read_b64_tr_b16 a[162:163], v216 offset:4096
  v_cvt_pk_bf16_f32 v74, v76, v77
  v_mfma_f32_16x16x32_bf16 v[108:111], a[156:159], v[156:159], v[196:199]
  v_exp_f32 v78, v78
  v_mfma_f32_16x16x32_bf16 v[108:111], a[152:155], v[152:155], v[108:111]
  ds_read_b64_tr_b16 a[164:165], v216 offset:8192
  buffer_load_dwordx4 v235, s[12:15], s29 offen offset:3072 lds
  v_mfma_f32_16x16x32_bf16 v[108:111], a[148:151], v[148:151], v[108:111]
  v_exp_f32 v79, v79
  v_mfma_f32_16x16x32_bf16 v[108:111], a[144:147], v[144:147], v[108:111]
  ds_read_b64_tr_b16 a[166:167], v216 offset:12288
  v_cvt_pk_bf16_f32 v75, v78, v79
  v_mfma_f32_16x16x32_bf16 v[116:119], a[144:147], v[160:163], v[200:203]
  v_exp_f32 v84, v84
  v_mfma_f32_16x16x32_bf16 v[116:119], a[148:151], v[164:167], v[116:119]
  ds_read_b64_tr_b16 a[168:169], v217 offset:0
  ds_read_b64_tr_b16 a[232:233], v225 offset:0
  s_add_u32 m0, s28, 0
  v_mfma_f32_16x16x32_bf16 v[116:119], a[152:155], v[168:171], v[116:119]
  v_exp_f32 v85, v85
  v_mfma_f32_16x16x32_bf16 v[116:119], a[156:159], v[172:175], v[116:119]
  ds_read_b64_tr_b16 a[170:171], v217 offset:4096
  v_cvt_pk_bf16_f32 v82, v84, v85
  v_mfma_f32_16x16x32_bf16 v[124:127], a[156:159], v[188:191], v[204:207]
  v_exp_f32 v86, v86
  v_mfma_f32_16x16x32_bf16 v[124:127], a[152:155], v[184:187], v[124:127]
  ds_read_b64_tr_b16 a[172:173], v217 offset:8192
  ds_read_b64_tr_b16 a[234:235], v225 offset:128
  v_mfma_f32_16x16x32_bf16 v[124:127], a[148:151], v[180:183], v[124:127]
  v_exp_f32 v87, v87
  v_mfma_f32_16x16x32_bf16 v[124:127], a[144:147], v[176:179], v[124:127]
  ds_read_b64_tr_b16 a[174:175], v217 offset:12288
  v_cvt_pk_bf16_f32 v83, v86, v87
  v_mfma_f32_16x16x32_bf16 a[192:195], a[208:211], v[0:3], a[192:195]
  v_exp_f32 v92, v92
  v_mfma_f32_16x16x32_bf16 a[192:195], a[208:211], v[32:35], a[192:195]
  ds_read_b64_tr_b16 a[176:177], v218 offset:0
  ds_read_b64_tr_b16 a[236:237], v225 offset:1024
  v_mfma_f32_16x16x32_bf16 a[196:199], a[208:211], v[8:11], a[196:199]
  v_exp_f32 v93, v93
  v_mfma_f32_16x16x32_bf16 a[196:199], a[208:211], v[40:43], a[196:199]
  ds_read_b64_tr_b16 a[178:179], v218 offset:4096
  v_cvt_pk_bf16_f32 v90, v92, v93
  v_mfma_f32_16x16x32_bf16 a[200:203], a[208:211], v[16:19], a[200:203]
  v_exp_f32 v94, v94
  v_mfma_f32_16x16x32_bf16 a[200:203], a[208:211], v[48:51], a[200:203]
  ds_read_b64_tr_b16 a[180:181], v218 offset:8192
  ds_read_b64_tr_b16 a[238:239], v225 offset:1152
  v_mfma_f32_16x16x32_bf16 a[204:207], a[208:211], v[24:27], a[204:207]
  s_waitcnt lgkmcnt(11)
  v_exp_f32 v95, v95
  v_mfma_f32_16x16x32_bf16 a[204:207], a[208:211], v[56:59], a[204:207]
  ds_read_b64_tr_b16 a[182:183], v218 offset:12288
  v_cvt_pk_bf16_f32 v91, v94, v95
  v_mfma_f32_16x16x32_bf16 a[0:3], a[160:163], v[0:3], a[0:3]
  v_exp_f32 v96, v96
  v_mfma_f32_16x16x32_bf16 a[0:3], a[164:167], v[32:35], a[0:3]
  ds_read_b64_tr_b16 a[184:185], v219 offset:0
  ds_read_b64_tr_b16 a[240:241], v225 offset:2048
  v_mfma_f32_16x16x32_bf16 a[4:7], a[164:167], v[40:43], a[4:7]
  v_exp_f32 v97, v97
  v_mfma_f32_16x16x32_bf16 a[4:7], a[160:163], v[8:11], a[4:7]
  ds_read_b64_tr_b16 a[186:187], v219 offset:4096
  v_cvt_pk_bf16_f32 v96, v96, v97
  v_mfma_f32_16x16x32_bf16 a[8:11], a[160:163], v[16:19], a[8:11]
  v_exp_f32 v98, v98
  v_mfma_f32_16x16x32_bf16 a[8:11], a[164:167], v[48:51], a[8:11]
  ds_read_b64_tr_b16 a[188:189], v219 offset:8192
  ds_read_b64_tr_b16 a[242:243], v225 offset:2176
  v_mfma_f32_16x16x32_bf16 a[12:15], a[164:167], v[56:59], a[12:15]
  s_waitcnt lgkmcnt(11)
  v_exp_f32 v99, v99
  v_mfma_f32_16x16x32_bf16 a[12:15], a[160:163], v[24:27], a[12:15]
  ds_read_b64_tr_b16 a[190:191], v219 offset:12288
  v_cvt_pk_bf16_f32 v97, v98, v99
  v_mfma_f32_16x16x32_bf16 a[16:19], a[168:171], v[0:3], a[16:19]
  v_exp_f32 v104, v104
  v_mfma_f32_16x16x32_bf16 a[16:19], a[172:175], v[32:35], a[16:19]
  ds_read_b64_tr_b16 a[160:161], v220 offset:0
  buffer_load_dwordx4 v253, s[24:27], s8 offen offset:0 sc1 lds
  v_mfma_f32_16x16x32_bf16 a[20:23], a[172:175], v[40:43], a[20:23]
  v_exp_f32 v105, v105
  v_mfma_f32_16x16x32_bf16 a[20:23], a[168:171], v[8:11], a[20:23]
  ds_read_b64_tr_b16 a[162:163], v220 offset:4096
  v_cvt_pk_bf16_f32 v104, v104, v105
  v_mfma_f32_16x16x32_bf16 a[24:27], a[168:171], v[16:19], a[24:27]
  v_exp_f32 v106, v106
  v_mfma_f32_16x16x32_bf16 a[24:27], a[172:175], v[48:51], a[24:27]
  ds_read_b64_tr_b16 a[164:165], v220 offset:8192
  s_waitcnt lgkmcnt(4)
  buffer_load_dwordx4 v253, s[24:27], s8 offen offset:1024 sc1 lds
  v_mfma_f32_16x16x32_bf16 v[228:231], a[232:235], a[212:215], 0
  v_mfma_f32_16x16x32_bf16 v[228:231], a[236:239], a[216:219], v[228:231]
  v_mfma_f32_16x16x32_bf16 v[228:231], a[240:243], a[220:223], v[228:231]
  v_mfma_f32_16x16x32_bf16 a[28:31], a[172:175], v[56:59], a[28:31]
  s_lshl_b32 s35, s3, 10
  s_add_u32 s35, s35, 159744
  v_exp_f32 v107, v107
  v_mfma_f32_16x16x32_bf16 a[28:31], a[168:171], v[24:27], a[28:31]
  ds_read_b64_tr_b16 a[166:167], v220 offset:12288
  v_cvt_pk_bf16_f32 v105, v106, v107
  v_mfma_f32_16x16x32_bf16 a[32:35], a[176:179], v[0:3], a[32:35]
  v_exp_f32 v112, v112
  v_mfma_f32_16x16x32_bf16 a[32:35], a[180:183], v[32:35], a[32:35]
  ds_read_b64_tr_b16 a[168:169], v221 offset:0
  buffer_load_dwordx4 v253, s[24:27], s8 offen offset:2048 sc1 lds
  v_mfma_f32_16x16x32_bf16 a[36:39], a[180:183], v[40:43], a[36:39]
  v_exp_f32 v113, v113
  v_mfma_f32_16x16x32_bf16 a[36:39], a[176:179], v[8:11], a[36:39]
  ds_read_b64_tr_b16 a[170:171], v221 offset:4096
  v_cvt_pk_bf16_f32 v112, v112, v113
  v_mfma_f32_16x16x32_bf16 a[40:43], a[176:179], v[16:19], a[40:43]
  v_exp_f32 v114, v114
  v_mfma_f32_16x16x32_bf16 a[40:43], a[180:183], v[48:51], a[40:43]
  ds_read_b64_tr_b16 a[172:173], v221 offset:8192
  buffer_load_dwordx4 v253, s[24:27], s8 offen offset:3072 sc1 lds
  v_mfma_f32_16x16x32_bf16 a[44:47], a[180:183], v[56:59], a[44:47]
  s_waitcnt lgkmcnt(7)
  v_exp_f32 v115, v115
  v_mfma_f32_16x16x32_bf16 a[44:47], a[176:179], v[24:27], a[44:47]
  ds_read_b64_tr_b16 a[174:175], v221 offset:12288
  v_cvt_pk_bf16_f32 v113, v114, v115
  v_mfma_f32_16x16x32_bf16 a[48:51], a[184:187], v[0:3], a[48:51]
  v_exp_f32 v120, v120
  v_mfma_f32_16x16x32_bf16 a[48:51], a[188:191], v[32:35], a[48:51]
  ds_read_b64_tr_b16 a[176:177], v222 offset:0
  v_add_u32 v224, s35, v242
  v_mfma_f32_16x16x32_bf16 a[52:55], a[188:191], v[40:43], a[52:55]
  v_exp_f32 v121, v121
  v_mfma_f32_16x16x32_bf16 a[52:55], a[184:187], v[8:11], a[52:55]
  ds_read_b64_tr_b16 a[178:179], v222 offset:4096
  v_cvt_pk_bf16_f32 v120, v120, v121
  v_mfma_f32_16x16x32_bf16 a[56:59], a[184:187], v[16:19], a[56:59]
  v_exp_f32 v122, v122
  v_mfma_f32_16x16x32_bf16 a[56:59], a[188:191], v[48:51], a[56:59]
  ds_read_b64_tr_b16 a[180:181], v222 offset:8192
  ds_write_b128 v224, v[228:231]
  v_mfma_f32_16x16x32_bf16 a[60:63], a[188:191], v[56:59], a[60:63]
  s_waitcnt lgkmcnt(8)
  v_exp_f32 v123, v123
  v_mfma_f32_16x16x32_bf16 a[60:63], a[184:187], v[24:27], a[60:63]
  ds_read_b64_tr_b16 a[182:183], v222 offset:12288
  v_cvt_pk_bf16_f32 v121, v122, v123
  v_mfma_f32_16x16x32_bf16 a[64:67], a[160:163], v[0:3], a[64:67]
  v_exp_f32 v100, v100
  v_mfma_f32_16x16x32_bf16 a[64:67], a[164:167], v[32:35], a[64:67]
  ds_read_b64_tr_b16 a[184:185], v223 offset:0
  v_mfma_f32_16x16x32_bf16 a[68:71], a[164:167], v[40:43], a[68:71]
  v_exp_f32 v101, v101
  v_mfma_f32_16x16x32_bf16 a[68:71], a[160:163], v[8:11], a[68:71]
  ds_read_b64_tr_b16 a[186:187], v223 offset:4096
  v_cvt_pk_bf16_f32 v98, v100, v101
  v_mfma_f32_16x16x32_bf16 a[72:75], a[160:163], v[16:19], a[72:75]
  v_exp_f32 v102, v102
  v_mfma_f32_16x16x32_bf16 a[72:75], a[164:167], v[48:51], a[72:75]
  ds_read_b64_tr_b16 a[188:189], v223 offset:8192
  s_waitcnt lgkmcnt(4)
  v_mfma_f32_16x16x32_bf16 a[76:79], a[164:167], v[56:59], a[76:79]
  v_exp_f32 v103, v103
  v_mfma_f32_16x16x32_bf16 a[76:79], a[160:163], v[24:27], a[76:79]
  ds_read_b64_tr_b16 a[190:191], v223 offset:12288
  v_cvt_pk_bf16_f32 v99, v102, v103
  v_mfma_f32_16x16x32_bf16 a[80:83], a[168:171], v[0:3], a[80:83]
  s_waitcnt vmcnt(12)
  v_exp_f32 v108, v108
  v_mfma_f32_16x16x32_bf16 a[80:83], a[172:175], v[32:35], a[80:83]
  v_mfma_f32_16x16x32_bf16 a[84:87], a[172:175], v[40:43], a[84:87]
  s_barrier
  v_exp_f32 v109, v109
  v_mfma_f32_16x16x32_bf16 a[84:87], a[168:171], v[8:11], a[84:87]
  ds_read_b128 a[128:131], v212 offset:32768
  v_cvt_pk_bf16_f32 v106, v108, v109
  v_mfma_f32_16x16x32_bf16 a[88:91], a[168:171], v[16:19], a[88:91]
  v_exp_f32 v110, v110
  v_mfma_f32_16x16x32_bf16 a[88:91], a[172:175], v[48:51], a[88:91]
  ds_read_b128 a[132:135], v213 offset:32768
  v_mfma_f32_16x16x32_bf16 a[92:95], a[172:175], v[56:59], a[92:95]
  s_waitcnt lgkmcnt(6)
  v_exp_f32 v111, v111
  v_mfma_f32_16x16x32_bf16 a[92:95], a[168:171], v[24:27], a[92:95]
  ds_read_b128 a[136:139], v214 offset:32768
  v_cvt_pk_bf16_f32 v107, v110, v111
  v_mfma_f32_16x16x32_bf16 a[96:99], a[176:179], v[0:3], a[96:99]
  v_exp_f32 v116, v116
  v_mfma_f32_16x16x32_bf16 a[96:99], a[180:183], v[32:35], a[96:99]
  ds_read_b128 a[140:143], v215 offset:32768
  v_mfma_f32_16x16x32_bf16 a[100:103], a[180:183], v[40:43], a[100:103]
  v_exp_f32 v117, v117
  v_mfma_f32_16x16x32_bf16 a[100:103], a[176:179], v[8:11], a[100:103]
  v_cvt_pk_bf16_f32 v114, v116, v117
  v_mfma_f32_16x16x32_bf16 a[104:107], a[176:179], v[16:19], a[104:107]
  v_exp_f32 v118, v118
  v_mfma_f32_16x16x32_bf16 a[104:107], a[180:183], v[48:51], a[104:107]
  v_mfma_f32_16x16x32_bf16 a[108:111], a[180:183], v[56:59], a[108:111]
  s_waitcnt lgkmcnt(4)
  v_exp_f32 v119, v119
  v_mfma_f32_16x16x32_bf16 a[108:111], a[176:179], v[24:27], a[108:111]
  v_cvt_pk_bf16_f32 v115, v118, v119
  v_mfma_f32_16x16x32_bf16 a[112:115], a[184:187], v[0:3], a[112:115]
  v_exp_f32 v124, v124
  v_mfma_f32_16x16x32_bf16 a[112:115], a[188:191], v[32:35], a[112:115]
  v_mfma_f32_16x16x32_bf16 a[116:119], a[188:191], v[40:43], a[116:119]
  v_exp_f32 v125, v125
  v_mfma_f32_16x16x32_bf16 a[116:119], a[184:187], v[8:11], a[116:119]
  v_cvt_pk_bf16_f32 v122, v124, v125
  v_mfma_f32_16x16x32_bf16 a[120:123], a[184:187], v[16:19], a[120:123]
  v_exp_f32 v126, v126
  v_mfma_f32_16x16x32_bf16 a[120:123], a[188:191], v[48:51], a[120:123]
  v_mfma_f32_16x16x32_bf16 a[124:127], a[188:191], v[56:59], a[124:127]
  s_waitcnt lgkmcnt(0)
  v_exp_f32 v127, v127
  v_mfma_f32_16x16x32_bf16 a[124:127], a[184:187], v[24:27], a[124:127]
  v_cvt_pk_bf16_f32 v123, v126, v127
  v_mfma_f32_16x16x32_bf16 v[0:3], a[128:131], v[128:131], v[192:195]
  s_add_u32 m0, s28, 114688
  v_add_u32 v224, 159744, v242
  v_mfma_f32_16x16x32_bf16 v[0:3], a[132:135], v[132:135], v[0:3]
  ds_read_b128 a[144:147], v212 offset:36864
  ds_read_b128 v[228:231], v224 offset:0
  v_mfma_f32_16x16x32_bf16 v[0:3], a[136:139], v[136:139], v[0:3]
  buffer_load_dwordx4 v236, s[16:19], s29 offen offset:0 lds
  v_mfma_f32_16x16x32_bf16 v[0:3], a[140:143], v[140:143], v[0:3]
  ds_read_b128 a[148:151], v213 offset:36864
  ds_read_b128 v[238:241], v224 offset:1024
  v_mfma_f32_16x16x32_bf16 v[8:11], a[140:143], v[156:159], v[196:199]
  ds_read_b128 v[208:211], v224 offset:2048
  v_lshrrev_b32 v224, 4, v242
  v_mfma_f32_16x16x32_bf16 v[8:11], a[136:139], v[152:155], v[8:11]
  ds_read_b128 a[152:155], v214 offset:36864
  s_min_u32 s35, s3, 1
  s_lshl_b32 s35, s35, 30
  v_and_b32 v225, 7, v224
  v_mfma_f32_16x16x32_bf16 v[8:11], a[132:135], v[148:151], v[8:11]
  buffer_load_dwordx4 v237, s[16:19], s29 offen offset:1024 lds
  v_mfma_f32_16x16x32_bf16 v[8:11], a[128:131], v[144:147], v[8:11]
  ds_read_b128 a[156:159], v215 offset:36864
  v_mul_u32_u24 v225, 0xa00, v225
  v_mfma_f32_16x16x32_bf16 v[16:19], a[128:131], v[160:163], v[200:203]
  v_exp_f32 v0, v0
  v_mfma_f32_16x16x32_bf16 v[16:19], a[132:135], v[164:167], v[16:19]
  v_lshrrev_b32 v226, 4, v224
  v_lshl_add_u32 v225, v226, 4, v225
  v_mfma_f32_16x16x32_bf16 v[16:19], a[136:139], v[168:171], v[16:19]
  v_exp_f32 v1, v1
  v_mfma_f32_16x16x32_bf16 v[16:19], a[140:143], v[172:175], v[16:19]
  v_cvt_pk_bf16_f32 v0, v0, v1
  v_bfe_u32 v226, v224, 3, 1
  v_mfma_f32_16x16x32_bf16 v[24:27], a[140:143], v[188:191], v[204:207]
  v_exp_f32 v2, v2
  v_mfma_f32_16x16x32_bf16 v[24:27], a[136:139], v[184:187], v[24:27]
  buffer_load_dwordx4 v236, s[16:19], s29 offen offset:2048 lds
  v_mfma_f32_16x16x32_bf16 v[24:27], a[132:135], v[180:183], v[24:27]
  s_waitcnt lgkmcnt(0)
  v_exp_f32 v3, v3
  v_mfma_f32_16x16x32_bf16 v[24:27], a[128:131], v[176:179], v[24:27]
  v_cvt_pk_bf16_f32 v1, v2, v3
  v_lshl_add_u32 v225, v226, 30, v225
  v_mfma_f32_16x16x32_bf16 v[4:7], a[144:147], v[128:131], v[192:195]
  v_exp_f32 v8, v8
  v_mfma_f32_16x16x32_bf16 v[4:7], a[148:151], v[132:135], v[4:7]
  ds_read_b128 a[128:131], v212 offset:40960
  v_or_b32 v225, s35, v225
  v_mfma_f32_16x16x32_bf16 v[4:7], a[152:155], v[136:139], v[4:7]
  s_mul_i32 s35, s98, 20480
  s_lshl_b32 s38, s99, 6
  s_add_u32 s35, s35, s38
  v_exp_f32 v9, v9
  v_mfma_f32_16x16x32_bf16 v[4:7], a[156:159], v[140:143], v[4:7]
  ds_read_b128 a[132:135], v213 offset:40960
  s_add_u32 s35, s35, 2686976
  v_cvt_pk_bf16_f32 v8, v8, v9
  v_mfma_f32_16x16x32_bf16 v[12:15], a[156:159], v[156:159], v[196:199]
  v_exp_f32 v10, v10
  v_mfma_f32_16x16x32_bf16 v[12:15], a[152:155], v[152:155], v[12:15]
  ds_read_b128 a[136:139], v214 offset:40960
  v_add_f32 v228, v228, v238
  v_mfma_f32_16x16x32_bf16 v[12:15], a[148:151], v[148:151], v[12:15]
  v_exp_f32 v11, v11
  v_mfma_f32_16x16x32_bf16 v[12:15], a[144:147], v[144:147], v[12:15]
  ds_read_b128 a[140:143], v215 offset:40960
  v_cvt_pk_bf16_f32 v9, v10, v11
  v_mfma_f32_16x16x32_bf16 v[20:23], a[144:147], v[160:163], v[200:203]
  v_exp_f32 v16, v16
  v_mfma_f32_16x16x32_bf16 v[20:23], a[148:151], v[164:167], v[20:23]
  buffer_load_dwordx4 v237, s[16:19], s29 offen offset:3072 lds
  v_mfma_f32_16x16x32_bf16 v[20:23], a[152:155], v[168:171], v[20:23]
  s_add_u32 s29, s29, 16384
  v_exp_f32 v17, v17
  v_mfma_f32_16x16x32_bf16 v[20:23], a[156:159], v[172:175], v[20:23]
  v_cvt_pk_bf16_f32 v16, v16, v17
  v_add_f32 v229, v229, v239
  v_mfma_f32_16x16x32_bf16 v[28:31], a[156:159], v[188:191], v[204:207]
  s_add_u32 m0, s28, 16384
  v_exp_f32 v18, v18
  v_mfma_f32_16x16x32_bf16 v[28:31], a[152:155], v[184:187], v[28:31]
  buffer_load_dwordx4 v242, s[24:27], s9 offen offset:0 sc1 lds
  v_mfma_f32_16x16x32_bf16 v[28:31], a[148:151], v[180:183], v[28:31]
  s_waitcnt lgkmcnt(0)
  v_exp_f32 v19, v19
  v_mfma_f32_16x16x32_bf16 v[28:31], a[144:147], v[176:179], v[28:31]
  v_cvt_pk_bf16_f32 v17, v18, v19
  v_add_f32 v230, v230, v240
  v_mfma_f32_16x16x32_bf16 v[32:35], a[128:131], v[128:131], v[192:195]
  v_exp_f32 v24, v24
  v_mfma_f32_16x16x32_bf16 v[32:35], a[132:135], v[132:135], v[32:35]
  ds_read_b128 a[144:147], v212 offset:45056
  v_add_f32 v231, v231, v241
  v_mfma_f32_16x16x32_bf16 v[32:35], a[136:139], v[136:139], v[32:35]
  v_exp_f32 v25, v25
  v_mfma_f32_16x16x32_bf16 v[32:35], a[140:143], v[140:143], v[32:35]
  ds_read_b128 a[148:151], v213 offset:45056
  v_cvt_pk_bf16_f32 v24, v24, v25
  v_mfma_f32_16x16x32_bf16 v[40:43], a[140:143], v[156:159], v[196:199]
  v_exp_f32 v26, v26
  v_mfma_f32_16x16x32_bf16 v[40:43], a[136:139], v[152:155], v[40:43]
  ds_read_b128 a[152:155], v214 offset:45056
  v_add_f32 v228, v228, v208
  v_mfma_f32_16x16x32_bf16 v[40:43], a[132:135], v[148:151], v[40:43]
  v_exp_f32 v27, v27
  v_mfma_f32_16x16x32_bf16 v[40:43], a[128:131], v[144:147], v[40:43]
  ds_read_b128 a[156:159], v215 offset:45056
  v_cvt_pk_bf16_f32 v25, v26, v27
  v_mfma_f32_16x16x32_bf16 v[48:51], a[128:131], v[160:163], v[200:203]
  v_exp_f32 v4, v4
  v_mfma_f32_16x16x32_bf16 v[48:51], a[132:135], v[164:167], v[48:51]
  buffer_load_dwordx4 v242, s[24:27], s9 offen offset:1024 sc1 lds
  v_mfma_f32_16x16x32_bf16 v[48:51], a[136:139], v[168:171], v[48:51]
  v_exp_f32 v5, v5
  v_mfma_f32_16x16x32_bf16 v[48:51], a[140:143], v[172:175], v[48:51]
  v_cvt_pk_bf16_f32 v2, v4, v5
  v_add_f32 v229, v229, v209
  v_mfma_f32_16x16x32_bf16 v[56:59], a[140:143], v[188:191], v[204:207]
  v_exp_f32 v6, v6
  v_mfma_f32_16x16x32_bf16 v[56:59], a[136:139], v[184:187], v[56:59]
  buffer_load_dwordx4 v242, s[24:27], s9 offen offset:2048 sc1 lds
  v_mfma_f32_16x16x32_bf16 v[56:59], a[132:135], v[180:183], v[56:59]
  s_waitcnt lgkmcnt(0)
  v_exp_f32 v7, v7
  v_mfma_f32_16x16x32_bf16 v[56:59], a[128:131], v[176:179], v[56:59]
  v_cvt_pk_bf16_f32 v3, v6, v7
  v_add_f32 v230, v230, v210
  v_mfma_f32_16x16x32_bf16 v[36:39], a[144:147], v[128:131], v[192:195]
  v_exp_f32 v12, v12
  v_mfma_f32_16x16x32_bf16 v[36:39], a[148:151], v[132:135], v[36:39]
  ds_read_b64_tr_b16 a[160:161], v216 offset:16384
  v_add_f32 v231, v231, v211
  v_mfma_f32_16x16x32_bf16 v[36:39], a[152:155], v[136:139], v[36:39]
  v_exp_f32 v13, v13
  v_mfma_f32_16x16x32_bf16 v[36:39], a[156:159], v[140:143], v[36:39]
  ds_read_b64_tr_b16 a[162:163], v216 offset:20480
  v_cvt_pk_bf16_f32 v10, v12, v13
  v_mfma_f32_16x16x32_bf16 v[44:47], a[156:159], v[156:159], v[196:199]
  v_exp_f32 v14, v14
  v_mfma_f32_16x16x32_bf16 v[44:47], a[152:155], v[152:155], v[44:47]
  ds_read_b64_tr_b16 a[164:165], v216 offset:24576
  buffer_load_dwordx4 v242, s[24:27], s9 offen offset:3072 sc1 lds
  v_mfma_f32_16x16x32_bf16 v[44:47], a[148:151], v[148:151], v[44:47]
  v_exp_f32 v15, v15
  v_mfma_f32_16x16x32_bf16 v[44:47], a[144:147], v[144:147], v[44:47]
  ds_read_b64_tr_b16 a[166:167], v216 offset:28672
  v_cvt_pk_bf16_f32 v11, v14, v15
  v_mfma_f32_16x16x32_bf16 v[52:55], a[144:147], v[160:163], v[200:203]
  v_exp_f32 v20, v20
  v_mfma_f32_16x16x32_bf16 v[52:55], a[148:151], v[164:167], v[52:55]
  ds_read_b64_tr_b16 a[168:169], v217 offset:16384
  buffer_store_dwordx4 v[228:231], v225, s[24:27], s35 offen sc1
  v_mfma_f32_16x16x32_bf16 v[52:55], a[152:155], v[168:171], v[52:55]
  v_exp_f32 v21, v21
  v_mfma_f32_16x16x32_bf16 v[52:55], a[156:159], v[172:175], v[52:55]
  ds_read_b64_tr_b16 a[170:171], v217 offset:20480
  v_cvt_pk_bf16_f32 v18, v20, v21
  v_mfma_f32_16x16x32_bf16 v[60:63], a[156:159], v[188:191], v[204:207]
  v_exp_f32 v22, v22
  v_mfma_f32_16x16x32_bf16 v[60:63], a[152:155], v[184:187], v[60:63]
  ds_read_b64_tr_b16 a[172:173], v217 offset:24576
  buffer_load_dwordx4 a[212:215], v242, s[24:27], s4 offen offset:0 sc1
  v_mfma_f32_16x16x32_bf16 v[60:63], a[148:151], v[180:183], v[60:63]
  v_exp_f32 v23, v23
  v_mfma_f32_16x16x32_bf16 v[60:63], a[144:147], v[176:179], v[60:63]
  ds_read_b64_tr_b16 a[174:175], v217 offset:28672
  v_cvt_pk_bf16_f32 v19, v22, v23
  v_mfma_f32_16x16x32_bf16 a[192:195], a[208:211], v[64:67], a[192:195]
  v_exp_f32 v28, v28
  v_mfma_f32_16x16x32_bf16 a[192:195], a[208:211], v[96:99], a[192:195]
  ds_read_b64_tr_b16 a[176:177], v218 offset:16384
  buffer_load_dwordx4 a[216:219], v242, s[24:27], s4 offen offset:1024 sc1
  v_mfma_f32_16x16x32_bf16 a[196:199], a[208:211], v[72:75], a[196:199]
  v_exp_f32 v29, v29
  v_mfma_f32_16x16x32_bf16 a[196:199], a[208:211], v[104:107], a[196:199]
  ds_read_b64_tr_b16 a[178:179], v218 offset:20480
  v_cvt_pk_bf16_f32 v26, v28, v29
  v_mfma_f32_16x16x32_bf16 a[200:203], a[208:211], v[80:83], a[200:203]
  v_exp_f32 v30, v30
  v_mfma_f32_16x16x32_bf16 a[200:203], a[208:211], v[112:115], a[200:203]
  ds_read_b64_tr_b16 a[180:181], v218 offset:24576
  v_mfma_f32_16x16x32_bf16 a[204:207], a[208:211], v[88:91], a[204:207]
  s_waitcnt lgkmcnt(7)
  v_exp_f32 v31, v31
  v_mfma_f32_16x16x32_bf16 a[204:207], a[208:211], v[120:123], a[204:207]
  ds_read_b64_tr_b16 a[182:183], v218 offset:28672
  v_cvt_pk_bf16_f32 v27, v30, v31
  v_mfma_f32_16x16x32_bf16 a[0:3], a[160:163], v[64:67], a[0:3]
  v_exp_f32 v32, v32
  v_mfma_f32_16x16x32_bf16 a[0:3], a[164:167], v[96:99], a[0:3]
  ds_read_b64_tr_b16 a[184:185], v219 offset:16384
  buffer_load_dwordx4 a[220:223], v242, s[24:27], s4 offen offset:2048 sc1
  v_mfma_f32_16x16x32_bf16 a[4:7], a[164:167], v[104:107], a[4:7]
  v_exp_f32 v33, v33
  v_mfma_f32_16x16x32_bf16 a[4:7], a[160:163], v[72:75], a[4:7]
  ds_read_b64_tr_b16 a[186:187], v219 offset:20480
  v_cvt_pk_bf16_f32 v32, v32, v33
  v_mfma_f32_16x16x32_bf16 a[8:11], a[160:163], v[80:83], a[8:11]
  v_exp_f32 v34, v34
  v_mfma_f32_16x16x32_bf16 a[8:11], a[164:167], v[112:115], a[8:11]
  ds_read_b64_tr_b16 a[188:189], v219 offset:24576
  v_mfma_f32_16x16x32_bf16 a[12:15], a[164:167], v[120:123], a[12:15]
  s_waitcnt lgkmcnt(7)
  v_exp_f32 v35, v35
  v_mfma_f32_16x16x32_bf16 a[12:15], a[160:163], v[88:91], a[12:15]
  ds_read_b64_tr_b16 a[190:191], v219 offset:28672
  v_cvt_pk_bf16_f32 v33, v34, v35
  v_mfma_f32_16x16x32_bf16 a[16:19], a[168:171], v[64:67], a[16:19]
  v_exp_f32 v40, v40
  v_mfma_f32_16x16x32_bf16 a[16:19], a[172:175], v[96:99], a[16:19]
  ds_read_b64_tr_b16 a[160:161], v220 offset:16384
  buffer_load_dwordx4 a[224:227], v242, s[24:27], s4 offen offset:3072 sc1
  v_mfma_f32_16x16x32_bf16 a[20:23], a[172:175], v[104:107], a[20:23]
  v_exp_f32 v41, v41
  v_mfma_f32_16x16x32_bf16 a[20:23], a[168:171], v[72:75], a[20:23]
  ds_read_b64_tr_b16 a[162:163], v220 offset:20480
  v_cvt_pk_bf16_f32 v40, v40, v41
  v_mfma_f32_16x16x32_bf16 a[24:27], a[168:171], v[80:83], a[24:27]
  v_exp_f32 v42, v42
  v_mfma_f32_16x16x32_bf16 a[24:27], a[172:175], v[112:115], a[24:27]
  ds_read_b64_tr_b16 a[164:165], v220 offset:24576
  v_mfma_f32_16x16x32_bf16 a[28:31], a[172:175], v[120:123], a[28:31]
  s_waitcnt lgkmcnt(7)
  v_exp_f32 v43, v43
  v_mfma_f32_16x16x32_bf16 a[28:31], a[168:171], v[88:91], a[28:31]
  ds_read_b64_tr_b16 a[166:167], v220 offset:28672
  v_cvt_pk_bf16_f32 v41, v42, v43
  v_mfma_f32_16x16x32_bf16 a[32:35], a[176:179], v[64:67], a[32:35]
  v_exp_f32 v48, v48
  v_mfma_f32_16x16x32_bf16 a[32:35], a[180:183], v[96:99], a[32:35]
  ds_read_b64_tr_b16 a[168:169], v221 offset:16384
  buffer_load_dwordx4 a[228:231], v252, s[24:27], s4 offen offset:0 sc1
  v_mfma_f32_16x16x32_bf16 a[36:39], a[180:183], v[104:107], a[36:39]
  v_exp_f32 v49, v49
  v_mfma_f32_16x16x32_bf16 a[36:39], a[176:179], v[72:75], a[36:39]
  ds_read_b64_tr_b16 a[170:171], v221 offset:20480
  v_cvt_pk_bf16_f32 v48, v48, v49
  v_mfma_f32_16x16x32_bf16 a[40:43], a[176:179], v[80:83], a[40:43]
  v_exp_f32 v50, v50
  v_mfma_f32_16x16x32_bf16 a[40:43], a[180:183], v[112:115], a[40:43]
  ds_read_b64_tr_b16 a[172:173], v221 offset:24576
  v_mfma_f32_16x16x32_bf16 a[44:47], a[180:183], v[120:123], a[44:47]
  s_waitcnt lgkmcnt(7)
  v_exp_f32 v51, v51
  v_mfma_f32_16x16x32_bf16 a[44:47], a[176:179], v[88:91], a[44:47]
  ds_read_b64_tr_b16 a[174:175], v221 offset:28672
  v_cvt_pk_bf16_f32 v49, v50, v51
  v_mfma_f32_16x16x32_bf16 a[48:51], a[184:187], v[64:67], a[48:51]
  v_exp_f32 v56, v56
  v_mfma_f32_16x16x32_bf16 a[48:51], a[188:191], v[96:99], a[48:51]
  ds_read_b64_tr_b16 a[176:177], v222 offset:16384
  buffer_load_dwordx4 a[232:235], v252, s[24:27], s4 offen offset:1024 sc1
  v_mfma_f32_16x16x32_bf16 a[52:55], a[188:191], v[104:107], a[52:55]
  v_exp_f32 v57, v57
  v_mfma_f32_16x16x32_bf16 a[52:55], a[184:187], v[72:75], a[52:55]
  ds_read_b64_tr_b16 a[178:179], v222 offset:20480
  v_cvt_pk_bf16_f32 v56, v56, v57
  v_mfma_f32_16x16x32_bf16 a[56:59], a[184:187], v[80:83], a[56:59]
  v_exp_f32 v58, v58
  v_mfma_f32_16x16x32_bf16 a[56:59], a[188:191], v[112:115], a[56:59]
  ds_read_b64_tr_b16 a[180:181], v222 offset:24576
  v_mfma_f32_16x16x32_bf16 a[60:63], a[188:191], v[120:123], a[60:63]
  s_waitcnt lgkmcnt(7)
  v_exp_f32 v59, v59
  v_mfma_f32_16x16x32_bf16 a[60:63], a[184:187], v[88:91], a[60:63]
  ds_read_b64_tr_b16 a[182:183], v222 offset:28672
  v_cvt_pk_bf16_f32 v57, v58, v59
  v_mfma_f32_16x16x32_bf16 a[64:67], a[160:163], v[64:67], a[64:67]
  v_exp_f32 v36, v36
  v_mfma_f32_16x16x32_bf16 a[64:67], a[164:167], v[96:99], a[64:67]
  ds_read_b64_tr_b16 a[184:185], v223 offset:16384
  v_mfma_f32_16x16x32_bf16 a[68:71], a[164:167], v[104:107], a[68:71]
  v_exp_f32 v37, v37
  v_mfma_f32_16x16x32_bf16 a[68:71], a[160:163], v[72:75], a[68:71]
  ds_read_b64_tr_b16 a[186:187], v223 offset:20480
  v_cvt_pk_bf16_f32 v34, v36, v37
  v_mfma_f32_16x16x32_bf16 a[72:75], a[160:163], v[80:83], a[72:75]
  v_exp_f32 v38, v38
  v_mfma_f32_16x16x32_bf16 a[72:75], a[164:167], v[112:115], a[72:75]
  ds_read_b64_tr_b16 a[188:189], v223 offset:24576
  v_mfma_f32_16x16x32_bf16 a[76:79], a[164:167], v[120:123], a[76:79]
  s_waitcnt lgkmcnt(7)
  v_exp_f32 v39, v39
  v_mfma_f32_16x16x32_bf16 a[76:79], a[160:163], v[88:91], a[76:79]
  ds_read_b64_tr_b16 a[190:191], v223 offset:28672
  v_cvt_pk_bf16_f32 v35, v38, v39
  v_mfma_f32_16x16x32_bf16 a[80:83], a[168:171], v[64:67], a[80:83]
  s_waitcnt vmcnt(19)
  v_exp_f32 v44, v44
  v_mfma_f32_16x16x32_bf16 a[80:83], a[172:175], v[96:99], a[80:83]
  v_mfma_f32_16x16x32_bf16 a[84:87], a[172:175], v[104:107], a[84:87]
  s_barrier
  v_exp_f32 v45, v45
  v_mfma_f32_16x16x32_bf16 a[84:87], a[168:171], v[72:75], a[84:87]
  ds_read_b128 a[128:131], v212 offset:49152
  v_cvt_pk_bf16_f32 v42, v44, v45
  v_mfma_f32_16x16x32_bf16 a[88:91], a[168:171], v[80:83], a[88:91]
  v_exp_f32 v46, v46
  v_mfma_f32_16x16x32_bf16 a[88:91], a[172:175], v[112:115], a[88:91]
  ds_read_b128 a[132:135], v213 offset:49152
  v_mfma_f32_16x16x32_bf16 a[92:95], a[172:175], v[120:123], a[92:95]
  s_waitcnt lgkmcnt(6)
  v_exp_f32 v47, v47
  v_mfma_f32_16x16x32_bf16 a[92:95], a[168:171], v[88:91], a[92:95]
  ds_read_b128 a[136:139], v214 offset:49152
  v_cvt_pk_bf16_f32 v43, v46, v47
  v_mfma_f32_16x16x32_bf16 a[96:99], a[176:179], v[64:67], a[96:99]
  v_exp_f32 v52, v52
  v_mfma_f32_16x16x32_bf16 a[96:99], a[180:183], v[96:99], a[96:99]
  ds_read_b128 a[140:143], v215 offset:49152
  v_mfma_f32_16x16x32_bf16 a[100:103], a[180:183], v[104:107], a[100:103]
  v_exp_f32 v53, v53
  v_mfma_f32_16x16x32_bf16 a[100:103], a[176:179], v[72:75], a[100:103]
  v_cvt_pk_bf16_f32 v50, v52, v53
  v_mfma_f32_16x16x32_bf16 a[104:107], a[176:179], v[80:83], a[104:107]
  v_exp_f32 v54, v54
  v_mfma_f32_16x16x32_bf16 a[104:107], a[180:183], v[112:115], a[104:107]
  v_mfma_f32_16x16x32_bf16 a[108:111], a[180:183], v[120:123], a[108:111]
  s_waitcnt lgkmcnt(4)
  v_exp_f32 v55, v55
  v_mfma_f32_16x16x32_bf16 a[108:111], a[176:179], v[88:91], a[108:111]
  v_cvt_pk_bf16_f32 v51, v54, v55
  v_mfma_f32_16x16x32_bf16 a[112:115], a[184:187], v[64:67], a[112:115]
  v_exp_f32 v60, v60
  v_mfma_f32_16x16x32_bf16 a[112:115], a[188:191], v[96:99], a[112:115]
  v_mfma_f32_16x16x32_bf16 a[116:119], a[188:191], v[104:107], a[116:119]
  v_exp_f32 v61, v61
  v_mfma_f32_16x16x32_bf16 a[116:119], a[184:187], v[72:75], a[116:119]
  v_cvt_pk_bf16_f32 v58, v60, v61
  v_mfma_f32_16x16x32_bf16 a[120:123], a[184:187], v[80:83], a[120:123]
  v_exp_f32 v62, v62
  v_mfma_f32_16x16x32_bf16 a[120:123], a[188:191], v[112:115], a[120:123]
  v_mfma_f32_16x16x32_bf16 a[124:127], a[188:191], v[120:123], a[124:127]
  s_waitcnt lgkmcnt(0)
  v_exp_f32 v63, v63
  v_mfma_f32_16x16x32_bf16 a[124:127], a[184:187], v[88:91], a[124:127]
  v_cvt_pk_bf16_f32 v59, v62, v63
  v_mfma_f32_16x16x32_bf16 v[64:67], a[128:131], v[128:131], v[192:195]
  s_add_u32 m0, s28, 65536
  v_mfma_f32_16x16x32_bf16 v[64:67], a[132:135], v[132:135], v[64:67]
  ds_read_b128 a[144:147], v212 offset:53248
  v_mfma_f32_16x16x32_bf16 v[64:67], a[136:139], v[136:139], v[64:67]
  buffer_load_dwordx4 v253, s[24:27], s9 offen offset:0 sc1 lds
  v_mfma_f32_16x16x32_bf16 v[64:67], a[140:143], v[140:143], v[64:67]
  ds_read_b128 a[148:151], v213 offset:53248
  v_mfma_f32_16x16x32_bf16 v[72:75], a[140:143], v[156:159], v[196:199]
  v_mfma_f32_16x16x32_bf16 v[72:75], a[136:139], v[152:155], v[72:75]
  ds_read_b128 a[152:155], v214 offset:53248
  v_mfma_f32_16x16x32_bf16 v[72:75], a[132:135], v[148:151], v[72:75]
  buffer_load_dwordx4 v253, s[24:27], s9 offen offset:1024 sc1 lds
  v_mfma_f32_16x16x32_bf16 v[72:75], a[128:131], v[144:147], v[72:75]
  ds_read_b128 a[156:159], v215 offset:53248
  v_mfma_f32_16x16x32_bf16 v[80:83], a[128:131], v[160:163], v[200:203]
  v_exp_f32 v64, v64
  v_mfma_f32_16x16x32_bf16 v[80:83], a[132:135], v[164:167], v[80:83]
  v_mfma_f32_16x16x32_bf16 v[80:83], a[136:139], v[168:171], v[80:83]
  v_exp_f32 v65, v65
  v_mfma_f32_16x16x32_bf16 v[80:83], a[140:143], v[172:175], v[80:83]
  v_cvt_pk_bf16_f32 v64, v64, v65
  v_mfma_f32_16x16x32_bf16 v[88:91], a[140:143], v[188:191], v[204:207]
  v_exp_f32 v66, v66
  v_mfma_f32_16x16x32_bf16 v[88:91], a[136:139], v[184:187], v[88:91]
  buffer_load_dwordx4 v253, s[24:27], s9 offen offset:2048 sc1 lds
  v_mfma_f32_16x16x32_bf16 v[88:91], a[132:135], v[180:183], v[88:91]
  s_waitcnt lgkmcnt(0)
  v_exp_f32 v67, v67
  v_mfma_f32_16x16x32_bf16 v[88:91], a[128:131], v[176:179], v[88:91]
  v_cvt_pk_bf16_f32 v65, v66, v67
  v_mfma_f32_16x16x32_bf16 v[68:71], a[144:147], v[128:131], v[192:195]
  v_exp_f32 v72, v72
  v_mfma_f32_16x16x32_bf16 v[68:71], a[148:151], v[132:135], v[68:71]
  ds_read_b128 a[128:131], v212 offset:57344
  v_mfma_f32_16x16x32_bf16 v[68:71], a[152:155], v[136:139], v[68:71]
  v_exp_f32 v73, v73
  v_mfma_f32_16x16x32_bf16 v[68:71], a[156:159], v[140:143], v[68:71]
  ds_read_b128 a[132:135], v213 offset:57344
  v_cvt_pk_bf16_f32 v72, v72, v73
  v_mfma_f32_16x16x32_bf16 v[76:79], a[156:159], v[156:159], v[196:199]
  v_exp_f32 v74, v74
  v_mfma_f32_16x16x32_bf16 v[76:79], a[152:155], v[152:155], v[76:79]
  ds_read_b128 a[136:139], v214 offset:57344
  v_mfma_f32_16x16x32_bf16 v[76:79], a[148:151], v[148:151], v[76:79]
  v_exp_f32 v75, v75
  v_mfma_f32_16x16x32_bf16 v[76:79], a[144:147], v[144:147], v[76:79]
  ds_read_b128 a[140:143], v215 offset:57344
  v_cvt_pk_bf16_f32 v73, v74, v75
  v_mfma_f32_16x16x32_bf16 v[84:87], a[144:147], v[160:163], v[200:203]
  v_exp_f32 v80, v80
  v_mfma_f32_16x16x32_bf16 v[84:87], a[148:151], v[164:167], v[84:87]
  buffer_load_dwordx4 v253, s[24:27], s9 offen offset:3072 sc1 lds
  v_mfma_f32_16x16x32_bf16 v[84:87], a[152:155], v[168:171], v[84:87]
  s_add_u32 s29, s29, 16384
  v_exp_f32 v81, v81
  v_mfma_f32_16x16x32_bf16 v[84:87], a[156:159], v[172:175], v[84:87]
  v_cvt_pk_bf16_f32 v80, v80, v81
  v_mfma_f32_16x16x32_bf16 v[92:95], a[156:159], v[188:191], v[204:207]
  s_add_u32 m0, s28, 32768
  v_exp_f32 v82, v82
  v_mfma_f32_16x16x32_bf16 v[92:95], a[152:155], v[184:187], v[92:95]
  buffer_load_dwordx4 v252, s[24:27], s9 offen offset:0 sc1 lds
  v_mfma_f32_16x16x32_bf16 v[92:95], a[148:151], v[180:183], v[92:95]
  s_waitcnt lgkmcnt(0)
  v_exp_f32 v83, v83
  v_mfma_f32_16x16x32_bf16 v[92:95], a[144:147], v[176:179], v[92:95]
  v_cvt_pk_bf16_f32 v81, v82, v83
  v_mfma_f32_16x16x32_bf16 v[96:99], a[128:131], v[128:131], v[192:195]
  v_exp_f32 v88, v88
  v_mfma_f32_16x16x32_bf16 v[96:99], a[132:135], v[132:135], v[96:99]
  ds_read_b128 a[144:147], v212 offset:61440
  v_mfma_f32_16x16x32_bf16 v[96:99], a[136:139], v[136:139], v[96:99]
  v_exp_f32 v89, v89
  v_mfma_f32_16x16x32_bf16 v[96:99], a[140:143], v[140:143], v[96:99]
  ds_read_b128 a[148:151], v213 offset:61440
  v_cvt_pk_bf16_f32 v88, v88, v89
  v_mfma_f32_16x16x32_bf16 v[104:107], a[140:143], v[156:159], v[196:199]
  v_exp_f32 v90, v90
  v_mfma_f32_16x16x32_bf16 v[104:107], a[136:139], v[152:155], v[104:107]
  ds_read_b128 a[152:155], v214 offset:61440
  v_mfma_f32_16x16x32_bf16 v[104:107], a[132:135], v[148:151], v[104:107]
  v_exp_f32 v91, v91
  v_mfma_f32_16x16x32_bf16 v[104:107], a[128:131], v[144:147], v[104:107]
  ds_read_b128 a[156:159], v215 offset:61440
  v_cvt_pk_bf16_f32 v89, v90, v91
  v_mfma_f32_16x16x32_bf16 v[112:115], a[128:131], v[160:163], v[200:203]
  v_exp_f32 v68, v68
  v_mfma_f32_16x16x32_bf16 v[112:115], a[132:135], v[164:167], v[112:115]
  buffer_load_dwordx4 v252, s[24:27], s9 offen offset:1024 sc1 lds
  v_mfma_f32_16x16x32_bf16 v[112:115], a[136:139], v[168:171], v[112:115]
  v_exp_f32 v69, v69
  v_mfma_f32_16x16x32_bf16 v[112:115], a[140:143], v[172:175], v[112:115]
  v_cvt_pk_bf16_f32 v66, v68, v69
  v_mfma_f32_16x16x32_bf16 v[120:123], a[140:143], v[188:191], v[204:207]
  v_exp_f32 v70, v70
  v_mfma_f32_16x16x32_bf16 v[120:123], a[136:139], v[184:187], v[120:123]
  buffer_load_dwordx4 v252, s[24:27], s9 offen offset:2048 sc1 lds
  v_mfma_f32_16x16x32_bf16 v[120:123], a[132:135], v[180:183], v[120:123]
  s_waitcnt lgkmcnt(0)
  v_exp_f32 v71, v71
  v_mfma_f32_16x16x32_bf16 v[120:123], a[128:131], v[176:179], v[120:123]
  v_cvt_pk_bf16_f32 v67, v70, v71
  v_mfma_f32_16x16x32_bf16 v[100:103], a[144:147], v[128:131], v[192:195]
  v_exp_f32 v76, v76
  v_mfma_f32_16x16x32_bf16 v[100:103], a[148:151], v[132:135], v[100:103]
  ds_read_b64_tr_b16 a[160:161], v216 offset:32768
  v_mfma_f32_16x16x32_bf16 v[100:103], a[152:155], v[136:139], v[100:103]
  v_exp_f32 v77, v77
  v_mfma_f32_16x16x32_bf16 v[100:103], a[156:159], v[140:143], v[100:103]
  ds_read_b64_tr_b16 a[162:163], v216 offset:36864
  v_cvt_pk_bf16_f32 v74, v76, v77
  v_mfma_f32_16x16x32_bf16 v[108:111], a[156:159], v[156:159], v[196:199]
  v_exp_f32 v78, v78
  v_mfma_f32_16x16x32_bf16 v[108:111], a[152:155], v[152:155], v[108:111]
  ds_read_b64_tr_b16 a[164:165], v216 offset:40960
  buffer_load_dwordx4 v252, s[24:27], s9 offen offset:3072 sc1 lds
  v_mfma_f32_16x16x32_bf16 v[108:111], a[148:151], v[148:151], v[108:111]
  v_exp_f32 v79, v79
  v_mfma_f32_16x16x32_bf16 v[108:111], a[144:147], v[144:147], v[108:111]
  ds_read_b64_tr_b16 a[166:167], v216 offset:45056
  v_cvt_pk_bf16_f32 v75, v78, v79
  v_mfma_f32_16x16x32_bf16 v[116:119], a[144:147], v[160:163], v[200:203]
  v_exp_f32 v84, v84
  v_mfma_f32_16x16x32_bf16 v[116:119], a[148:151], v[164:167], v[116:119]
  ds_read_b64_tr_b16 a[168:169], v217 offset:32768
  buffer_load_dwordx4 a[236:239], v252, s[24:27], s4 offen offset:2048 sc1
  v_mfma_f32_16x16x32_bf16 v[116:119], a[152:155], v[168:171], v[116:119]
  v_exp_f32 v85, v85
  v_mfma_f32_16x16x32_bf16 v[116:119], a[156:159], v[172:175], v[116:119]
  ds_read_b64_tr_b16 a[170:171], v217 offset:36864
  v_cvt_pk_bf16_f32 v82, v84, v85
  v_mfma_f32_16x16x32_bf16 v[124:127], a[156:159], v[188:191], v[204:207]
  v_exp_f32 v86, v86
  v_mfma_f32_16x16x32_bf16 v[124:127], a[152:155], v[184:187], v[124:127]
  ds_read_b64_tr_b16 a[172:173], v217 offset:40960
  v_mfma_f32_16x16x32_bf16 v[124:127], a[148:151], v[180:183], v[124:127]
  v_exp_f32 v87, v87
  v_mfma_f32_16x16x32_bf16 v[124:127], a[144:147], v[176:179], v[124:127]
  ds_read_b64_tr_b16 a[174:175], v217 offset:45056
  v_cvt_pk_bf16_f32 v83, v86, v87
  v_mfma_f32_16x16x32_bf16 a[192:195], a[208:211], v[0:3], a[192:195]
  v_exp_f32 v92, v92
  v_mfma_f32_16x16x32_bf16 a[192:195], a[208:211], v[32:35], a[192:195]
  ds_read_b64_tr_b16 a[176:177], v218 offset:32768
  buffer_load_dwordx4 a[240:243], v252, s[24:27], s4 offen offset:3072 sc1
  v_mfma_f32_16x16x32_bf16 a[196:199], a[208:211], v[8:11], a[196:199]
  v_exp_f32 v93, v93
  v_mfma_f32_16x16x32_bf16 a[196:199], a[208:211], v[40:43], a[196:199]
  ds_read_b64_tr_b16 a[178:179], v218 offset:36864
  v_cvt_pk_bf16_f32 v90, v92, v93
  v_mfma_f32_16x16x32_bf16 a[200:203], a[208:211], v[16:19], a[200:203]
  v_exp_f32 v94, v94
  v_mfma_f32_16x16x32_bf16 a[200:203], a[208:211], v[48:51], a[200:203]
  ds_read_b64_tr_b16 a[180:181], v218 offset:40960
  v_mfma_f32_16x16x32_bf16 a[204:207], a[208:211], v[24:27], a[204:207]
  s_waitcnt lgkmcnt(7)
  v_exp_f32 v95, v95
  v_mfma_f32_16x16x32_bf16 a[204:207], a[208:211], v[56:59], a[204:207]
  ds_read_b64_tr_b16 a[182:183], v218 offset:45056
  v_cvt_pk_bf16_f32 v91, v94, v95
  v_mfma_f32_16x16x32_bf16 a[0:3], a[160:163], v[0:3], a[0:3]
  v_exp_f32 v96, v96
  v_mfma_f32_16x16x32_bf16 a[0:3], a[164:167], v[32:35], a[0:3]
  ds_read_b64_tr_b16 a[184:185], v219 offset:32768
  buffer_load_dwordx4 a[244:247], v253, s[24:27], s4 offen offset:0 sc1
  v_mfma_f32_16x16x32_bf16 a[4:7], a[164:167], v[40:43], a[4:7]
  v_exp_f32 v97, v97
  v_mfma_f32_16x16x32_bf16 a[4:7], a[160:163], v[8:11], a[4:7]
  ds_read_b64_tr_b16 a[186:187], v219 offset:36864
  v_cvt_pk_bf16_f32 v96, v96, v97
  v_mfma_f32_16x16x32_bf16 a[8:11], a[160:163], v[16:19], a[8:11]
  v_exp_f32 v98, v98
  v_mfma_f32_16x16x32_bf16 a[8:11], a[164:167], v[48:51], a[8:11]
  ds_read_b64_tr_b16 a[188:189], v219 offset:40960
  v_mfma_f32_16x16x32_bf16 a[12:15], a[164:167], v[56:59], a[12:15]
  s_waitcnt lgkmcnt(7)
  v_exp_f32 v99, v99
  v_mfma_f32_16x16x32_bf16 a[12:15], a[160:163], v[24:27], a[12:15]
  ds_read_b64_tr_b16 a[190:191], v219 offset:45056
  v_cvt_pk_bf16_f32 v97, v98, v99
  v_mfma_f32_16x16x32_bf16 a[16:19], a[168:171], v[0:3], a[16:19]
  v_exp_f32 v104, v104
  v_mfma_f32_16x16x32_bf16 a[16:19], a[172:175], v[32:35], a[16:19]
  ds_read_b64_tr_b16 a[160:161], v220 offset:32768
  buffer_load_dwordx4 a[248:251], v253, s[24:27], s4 offen offset:1024 sc1
  v_mfma_f32_16x16x32_bf16 a[20:23], a[172:175], v[40:43], a[20:23]
  v_exp_f32 v105, v105
  v_mfma_f32_16x16x32_bf16 a[20:23], a[168:171], v[8:11], a[20:23]
  ds_read_b64_tr_b16 a[162:163], v220 offset:36864
  v_cvt_pk_bf16_f32 v104, v104, v105
  v_mfma_f32_16x16x32_bf16 a[24:27], a[168:171], v[16:19], a[24:27]
  v_exp_f32 v106, v106
  v_mfma_f32_16x16x32_bf16 a[24:27], a[172:175], v[48:51], a[24:27]
  ds_read_b64_tr_b16 a[164:165], v220 offset:40960
  v_mfma_f32_16x16x32_bf16 a[28:31], a[172:175], v[56:59], a[28:31]
  s_waitcnt lgkmcnt(7)
  v_exp_f32 v107, v107
  v_mfma_f32_16x16x32_bf16 a[28:31], a[168:171], v[24:27], a[28:31]
  ds_read_b64_tr_b16 a[166:167], v220 offset:45056
  v_cvt_pk_bf16_f32 v105, v106, v107
  v_mfma_f32_16x16x32_bf16 a[32:35], a[176:179], v[0:3], a[32:35]
  v_exp_f32 v112, v112
  v_mfma_f32_16x16x32_bf16 a[32:35], a[180:183], v[32:35], a[32:35]
  ds_read_b64_tr_b16 a[168:169], v221 offset:32768
  buffer_load_dwordx4 a[252:255], v253, s[24:27], s4 offen offset:2048 sc1
  v_mfma_f32_16x16x32_bf16 a[36:39], a[180:183], v[40:43], a[36:39]
  v_exp_f32 v113, v113
  v_mfma_f32_16x16x32_bf16 a[36:39], a[176:179], v[8:11], a[36:39]
  ds_read_b64_tr_b16 a[170:171], v221 offset:36864
  v_cvt_pk_bf16_f32 v112, v112, v113
  v_mfma_f32_16x16x32_bf16 a[40:43], a[176:179], v[16:19], a[40:43]
  v_exp_f32 v114, v114
  v_mfma_f32_16x16x32_bf16 a[40:43], a[180:183], v[48:51], a[40:43]
  ds_read_b64_tr_b16 a[172:173], v221 offset:40960
  v_mfma_f32_16x16x32_bf16 a[44:47], a[180:183], v[56:59], a[44:47]
  s_waitcnt lgkmcnt(7)
  v_exp_f32 v115, v115
  v_mfma_f32_16x16x32_bf16 a[44:47], a[176:179], v[24:27], a[44:47]
  ds_read_b64_tr_b16 a[174:175], v221 offset:45056
  v_cvt_pk_bf16_f32 v113, v114, v115
  v_mfma_f32_16x16x32_bf16 a[48:51], a[184:187], v[0:3], a[48:51]
  v_exp_f32 v120, v120
  v_mfma_f32_16x16x32_bf16 a[48:51], a[188:191], v[32:35], a[48:51]
  ds_read_b64_tr_b16 a[176:177], v222 offset:32768
  v_mfma_f32_16x16x32_bf16 a[52:55], a[188:191], v[40:43], a[52:55]
  v_exp_f32 v121, v121
  v_mfma_f32_16x16x32_bf16 a[52:55], a[184:187], v[8:11], a[52:55]
  ds_read_b64_tr_b16 a[178:179], v222 offset:36864
  v_cvt_pk_bf16_f32 v120, v120, v121
  v_mfma_f32_16x16x32_bf16 a[56:59], a[184:187], v[16:19], a[56:59]
  v_exp_f32 v122, v122
  v_mfma_f32_16x16x32_bf16 a[56:59], a[188:191], v[48:51], a[56:59]
  ds_read_b64_tr_b16 a[180:181], v222 offset:40960
  v_mfma_f32_16x16x32_bf16 a[60:63], a[188:191], v[56:59], a[60:63]
  s_waitcnt lgkmcnt(7)
  v_exp_f32 v123, v123
  v_mfma_f32_16x16x32_bf16 a[60:63], a[184:187], v[24:27], a[60:63]
  ds_read_b64_tr_b16 a[182:183], v222 offset:45056
  v_cvt_pk_bf16_f32 v121, v122, v123
  v_mfma_f32_16x16x32_bf16 a[64:67], a[160:163], v[0:3], a[64:67]
  v_exp_f32 v100, v100
  v_mfma_f32_16x16x32_bf16 a[64:67], a[164:167], v[32:35], a[64:67]
  ds_read_b64_tr_b16 a[184:185], v223 offset:32768
  v_mfma_f32_16x16x32_bf16 a[68:71], a[164:167], v[40:43], a[68:71]
  v_exp_f32 v101, v101
  v_mfma_f32_16x16x32_bf16 a[68:71], a[160:163], v[8:11], a[68:71]
  ds_read_b64_tr_b16 a[186:187], v223 offset:36864
  v_cvt_pk_bf16_f32 v98, v100, v101
  v_mfma_f32_16x16x32_bf16 a[72:75], a[160:163], v[16:19], a[72:75]
  v_exp_f32 v102, v102
  v_mfma_f32_16x16x32_bf16 a[72:75], a[164:167], v[48:51], a[72:75]
  ds_read_b64_tr_b16 a[188:189], v223 offset:40960
  v_mfma_f32_16x16x32_bf16 a[76:79], a[164:167], v[56:59], a[76:79]
  s_waitcnt lgkmcnt(7)
  v_exp_f32 v103, v103
  v_mfma_f32_16x16x32_bf16 a[76:79], a[160:163], v[24:27], a[76:79]
  ds_read_b64_tr_b16 a[190:191], v223 offset:45056
  v_cvt_pk_bf16_f32 v99, v102, v103
  v_mfma_f32_16x16x32_bf16 a[80:83], a[168:171], v[0:3], a[80:83]
  s_waitcnt vmcnt(19)
  v_exp_f32 v108, v108
  v_mfma_f32_16x16x32_bf16 a[80:83], a[172:175], v[32:35], a[80:83]
  v_mfma_f32_16x16x32_bf16 a[84:87], a[172:175], v[40:43], a[84:87]
  s_barrier
  v_exp_f32 v109, v109
  v_mfma_f32_16x16x32_bf16 a[84:87], a[168:171], v[8:11], a[84:87]
  s_mul_i32 s39, s99, 13108
  s_lshr_b32 s39, s39, 16
  s_lshl_b32 s39, s39, 8
  v_cvt_pk_bf16_f32 v106, v108, v109
  v_mfma_f32_16x16x32_bf16 a[88:91], a[168:171], v[16:19], a[88:91]
  s_add_u32 s39, s39, 2818304
  s_cmp_lt_u32 s2, 240
  s_cselect_b32 s48, 0, 1073741824
  v_exp_f32 v110, v110
  v_mfma_f32_16x16x32_bf16 a[88:91], a[172:175], v[48:51], a[88:91]
  v_or_b32 v249, s48, v251
  v_mfma_f32_16x16x32_bf16 a[92:95], a[172:175], v[56:59], a[92:95]
  s_waitcnt lgkmcnt(4)
  v_exp_f32 v111, v111
  v_mfma_f32_16x16x32_bf16 a[92:95], a[168:171], v[24:27], a[92:95]
  buffer_atomic_add v250, v249, s[24:27], s39 offen
  v_cvt_pk_bf16_f32 v107, v110, v111
  v_mfma_f32_16x16x32_bf16 a[96:99], a[176:179], v[0:3], a[96:99]
  v_exp_f32 v116, v116
  v_mfma_f32_16x16x32_bf16 a[96:99], a[180:183], v[32:35], a[96:99]
  v_mfma_f32_16x16x32_bf16 a[100:103], a[180:183], v[40:43], a[100:103]
  v_exp_f32 v117, v117
  v_mfma_f32_16x16x32_bf16 a[100:103], a[176:179], v[8:11], a[100:103]
  v_cvt_pk_bf16_f32 v114, v116, v117
  v_mfma_f32_16x16x32_bf16 a[104:107], a[176:179], v[16:19], a[104:107]
  v_exp_f32 v118, v118
  v_mfma_f32_16x16x32_bf16 a[104:107], a[180:183], v[48:51], a[104:107]
  v_mfma_f32_16x16x32_bf16 a[108:111], a[180:183], v[56:59], a[108:111]
  s_waitcnt lgkmcnt(0)
  v_exp_f32 v119, v119
  v_mfma_f32_16x16x32_bf16 a[108:111], a[176:179], v[24:27], a[108:111]
  v_cvt_pk_bf16_f32 v115, v118, v119
  v_mfma_f32_16x16x32_bf16 a[112:115], a[184:187], v[0:3], a[112:115]
  v_exp_f32 v124, v124
  v_mfma_f32_16x16x32_bf16 a[112:115], a[188:191], v[32:35], a[112:115]
  v_mfma_f32_16x16x32_bf16 a[116:119], a[188:191], v[40:43], a[116:119]
  v_exp_f32 v125, v125
  v_mfma_f32_16x16x32_bf16 a[116:119], a[184:187], v[8:11], a[116:119]
  v_cvt_pk_bf16_f32 v122, v124, v125
  v_mfma_f32_16x16x32_bf16 a[120:123], a[184:187], v[16:19], a[120:123]
  v_exp_f32 v126, v126
  v_mfma_f32_16x16x32_bf16 a[120:123], a[188:191], v[48:51], a[120:123]
  v_mfma_f32_16x16x32_bf16 a[124:127], a[188:191], v[56:59], a[124:127]
  v_exp_f32 v127, v127
  v_mfma_f32_16x16x32_bf16 a[124:127], a[184:187], v[24:27], a[124:127]
  v_cvt_pk_bf16_f32 v123, v126, v127
  ds_read_b64_tr_b16 a[160:161], v216 offset:49152
  ds_read_b64_tr_b16 a[162:163], v216 offset:53248
  ds_read_b64_tr_b16 a[164:165], v216 offset:57344
  ds_read_b64_tr_b16 a[166:167], v216 offset:61440
  ds_read_b64_tr_b16 a[168:169], v217 offset:49152
  ds_read_b64_tr_b16 a[170:171], v217 offset:53248
  ds_read_b64_tr_b16 a[172:173], v217 offset:57344
  ds_read_b64_tr_b16 a[174:175], v217 offset:61440
  s_mov_b32 s48, 0x53800000
  s_lshl_b32 s39, s3, 8
  v_mfma_f32_16x16x32_bf16 a[192:195], a[208:211], v[64:67], a[192:195]
  s_add_u32 m0, s28, 81920
  v_mfma_f32_16x16x32_bf16 a[192:195], a[208:211], v[96:99], a[192:195]
  v_mfma_f32_16x16x32_bf16 a[196:199], a[208:211], v[72:75], a[196:199]
  buffer_load_dwordx4 v242, s[24:27], s10 offen offset:0 sc1 lds
  v_mfma_f32_16x16x32_bf16 a[196:199], a[208:211], v[104:107], a[196:199]
  v_mfma_f32_16x16x32_bf16 a[200:203], a[208:211], v[80:83], a[200:203]
  buffer_load_dwordx4 v242, s[24:27], s10 offen offset:1024 sc1 lds
  v_mfma_f32_16x16x32_bf16 a[200:203], a[208:211], v[112:115], a[200:203]
  v_mfma_f32_16x16x32_bf16 a[204:207], a[208:211], v[88:91], a[204:207]
  buffer_load_dwordx4 v242, s[24:27], s10 offen offset:2048 sc1 lds
  v_mfma_f32_16x16x32_bf16 a[204:207], a[208:211], v[120:123], a[204:207]
  s_waitcnt lgkmcnt(4)
  v_mfma_f32_16x16x32_bf16 a[0:3], a[160:163], v[64:67], a[0:3]
  buffer_load_dwordx4 v242, s[24:27], s10 offen offset:3072 sc1 lds
  v_mfma_f32_16x16x32_bf16 a[0:3], a[164:167], v[96:99], a[0:3]
  ds_read_b64_tr_b16 a[176:177], v218 offset:49152
  v_mfma_f32_16x16x32_bf16 a[4:7], a[164:167], v[104:107], a[4:7]
  buffer_load_dwordx4 a[128:131], v253, s[24:27], s4 offen offset:3072 sc1
  v_mfma_f32_16x16x32_bf16 a[4:7], a[160:163], v[72:75], a[4:7]
  ds_read_b64_tr_b16 a[178:179], v218 offset:53248
  v_accvgpr_read_b32 v208, a192
  v_mfma_f32_16x16x32_bf16 a[8:11], a[160:163], v[80:83], a[8:11]
  v_accvgpr_read_b32 v209, a196
  v_accvgpr_read_b32 v210, a200
  v_mfma_f32_16x16x32_bf16 a[8:11], a[164:167], v[112:115], a[8:11]
  ds_read_b64_tr_b16 a[180:181], v218 offset:57344
  v_accvgpr_read_b32 v211, a204
  v_mfma_f32_16x16x32_bf16 a[12:15], a[164:167], v[120:123], a[12:15]
  v_mov_b32 v245, v208
  v_mov_b32 v246, v209
  v_mfma_f32_16x16x32_bf16 a[12:15], a[160:163], v[88:91], a[12:15]
  ds_read_b64_tr_b16 a[182:183], v218 offset:61440
  s_waitcnt lgkmcnt(4)
  v_mov_b32 v247, v210
  v_mfma_f32_16x16x32_bf16 a[16:19], a[168:171], v[64:67], a[16:19]
  v_mov_b32 v248, v211
  v_permlane16_swap_b32 v208, v245
  v_mfma_f32_16x16x32_bf16 a[16:19], a[172:175], v[96:99], a[16:19]
  ds_read_b64_tr_b16 a[184:185], v219 offset:49152
  v_permlane16_swap_b32 v209, v246
  v_mfma_f32_16x16x32_bf16 a[20:23], a[172:175], v[104:107], a[20:23]
  v_permlane16_swap_b32 v210, v247
  v_permlane16_swap_b32 v211, v248
  v_mfma_f32_16x16x32_bf16 a[20:23], a[168:171], v[72:75], a[20:23]
  ds_read_b64_tr_b16 a[186:187], v219 offset:53248
  v_add_f32 v208, v208, v245
  v_mfma_f32_16x16x32_bf16 a[24:27], a[168:171], v[80:83], a[24:27]
  v_add_f32 v209, v209, v246
  v_add_f32 v210, v210, v247
  v_mfma_f32_16x16x32_bf16 a[24:27], a[172:175], v[112:115], a[24:27]
  ds_read_b64_tr_b16 a[188:189], v219 offset:57344
  v_add_f32 v211, v211, v248
  v_mfma_f32_16x16x32_bf16 a[28:31], a[172:175], v[120:123], a[28:31]
  v_mov_b32 v245, v208
  v_mov_b32 v246, v209
  v_mfma_f32_16x16x32_bf16 a[28:31], a[168:171], v[88:91], a[28:31]
  ds_read_b64_tr_b16 a[190:191], v219 offset:61440
  s_waitcnt lgkmcnt(4)
  v_mov_b32 v247, v210
  v_mfma_f32_16x16x32_bf16 a[32:35], a[176:179], v[64:67], a[32:35]
  v_mov_b32 v248, v211
  v_permlane32_swap_b32 v208, v245
  v_mfma_f32_16x16x32_bf16 a[32:35], a[180:183], v[96:99], a[32:35]
  ds_read_b64_tr_b16 a[160:161], v220 offset:49152
  v_permlane32_swap_b32 v209, v246
  v_mfma_f32_16x16x32_bf16 a[36:39], a[180:183], v[104:107], a[36:39]
  v_permlane32_swap_b32 v210, v247
  v_permlane32_swap_b32 v211, v248
  v_mfma_f32_16x16x32_bf16 a[36:39], a[176:179], v[72:75], a[36:39]
  ds_read_b64_tr_b16 a[162:163], v220 offset:53248
  v_add_f32 v208, v208, v245
  v_mfma_f32_16x16x32_bf16 a[40:43], a[176:179], v[80:83], a[40:43]
  v_add_f32 v209, v209, v246
  v_add_f32 v210, v210, v247
  v_mfma_f32_16x16x32_bf16 a[40:43], a[180:183], v[112:115], a[40:43]
  ds_read_b64_tr_b16 a[164:165], v220 offset:57344
  v_add_f32 v211, v211, v248
  buffer_load_dwordx4 a[132:135], v242, s[24:27], s5 offen offset:0 sc1
  buffer_load_dwordx4 a[136:139], v242, s[24:27], s5 offen offset:1024 sc1
  buffer_load_dwordx4 a[140:143], v242, s[24:27], s5 offen offset:2048 sc1
  buffer_load_dwordx4 a[144:147], v242, s[24:27], s5 offen offset:3072 sc1
  buffer_load_dwordx4 a[148:151], v252, s[24:27], s5 offen offset:0 sc1
  buffer_load_dwordx4 a[152:155], v252, s[24:27], s5 offen offset:1024 sc1
  buffer_load_dwordx4 a[156:159], v252, s[24:27], s5 offen offset:2048 sc1
  v_mfma_f32_16x16x32_bf16 a[44:47], a[180:183], v[120:123], a[44:47]
  v_rcp_f32 v192, v208
  v_mfma_f32_16x16x32_bf16 a[44:47], a[176:179], v[88:91], a[44:47]
  ds_read_b64_tr_b16 a[166:167], v220 offset:61440
  s_waitcnt lgkmcnt(4)
  v_mfma_f32_16x16x32_bf16 a[48:51], a[184:187], v[64:67], a[48:51]
  v_rcp_f32 v196, v209
  v_mfma_f32_16x16x32_bf16 a[48:51], a[188:191], v[96:99], a[48:51]
  ds_read_b64_tr_b16 a[168:169], v221 offset:49152
  v_mfma_f32_16x16x32_bf16 a[52:55], a[188:191], v[104:107], a[52:55]
  v_rcp_f32 v200, v210
  v_mfma_f32_16x16x32_bf16 a[52:55], a[184:187], v[72:75], a[52:55]
  ds_read_b64_tr_b16 a[170:171], v221 offset:53248
  v_mfma_f32_16x16x32_bf16 a[56:59], a[184:187], v[80:83], a[56:59]
  v_rcp_f32 v204, v211
  v_mfma_f32_16x16x32_bf16 a[56:59], a[188:191], v[112:115], a[56:59]
  ds_read_b64_tr_b16 a[172:173], v221 offset:57344
  v_add_f32 v246, v208, v209
  v_mfma_f32_16x16x32_bf16 a[60:63], a[188:191], v[120:123], a[60:63]
  v_add_f32 v247, v210, v211
  v_add_f32 v246, v246, v247
  v_mfma_f32_16x16x32_bf16 a[60:63], a[184:187], v[88:91], a[60:63]
  ds_read_b64_tr_b16 a[174:175], v221 offset:61440
  s_waitcnt lgkmcnt(4)
  v_lshrrev_b32 v247, 2, v242
  v_mfma_f32_16x16x32_bf16 a[64:67], a[160:163], v[64:67], a[64:67]
  v_cmp_nlt_f32 vcc, v246, s48
  v_add_u32 v247, s39, v247
  v_mfma_f32_16x16x32_bf16 a[64:67], a[164:167], v[96:99], a[64:67]
  ds_read_b64_tr_b16 a[176:177], v222 offset:49152
  v_add_u32 v247, 157696, v247
  v_mfma_f32_16x16x32_bf16 a[68:71], a[164:167], v[104:107], a[68:71]
  v_cndmask_b32_e64 v245, 0, 1, vcc
  v_accvgpr_read_b32 v0, a0
  v_mfma_f32_16x16x32_bf16 a[68:71], a[160:163], v[72:75], a[68:71]
  ds_read_b64_tr_b16 a[178:179], v222 offset:53248
  v_accvgpr_read_b32 v1, a1
  v_mfma_f32_16x16x32_bf16 a[72:75], a[160:163], v[80:83], a[72:75]
  v_accvgpr_read_b32 v2, a2
  v_accvgpr_read_b32 v3, a3
  v_mfma_f32_16x16x32_bf16 a[72:75], a[164:167], v[112:115], a[72:75]
  ds_read_b64_tr_b16 a[180:181], v222 offset:57344
  v_accvgpr_read_b32 v4, a16
  v_mfma_f32_16x16x32_bf16 a[76:79], a[164:167], v[120:123], a[76:79]
  v_accvgpr_read_b32 v5, a17
  v_accvgpr_read_b32 v6, a18
  v_mfma_f32_16x16x32_bf16 a[76:79], a[160:163], v[88:91], a[76:79]
  ds_read_b64_tr_b16 a[182:183], v222 offset:61440
  s_waitcnt lgkmcnt(4)
  v_accvgpr_read_b32 v7, a19
  v_mfma_f32_16x16x32_bf16 a[80:83], a[168:171], v[64:67], a[80:83]
  v_mul_f32 v0, v0, v192
  v_mul_f32 v1, v1, v192
  v_mfma_f32_16x16x32_bf16 a[80:83], a[172:175], v[96:99], a[80:83]
  ds_read_b64_tr_b16 a[184:185], v223 offset:49152
  v_mul_f32 v2, v2, v192
  v_mfma_f32_16x16x32_bf16 a[84:87], a[172:175], v[104:107], a[84:87]
  v_mul_f32 v3, v3, v192
  v_mul_f32 v4, v4, v192
  v_mfma_f32_16x16x32_bf16 a[84:87], a[168:171], v[72:75], a[84:87]
  ds_read_b64_tr_b16 a[186:187], v223 offset:53248
  v_mul_f32 v5, v5, v192
  v_mfma_f32_16x16x32_bf16 a[88:91], a[168:171], v[80:83], a[88:91]
  v_mul_f32 v6, v6, v192
  v_mul_f32 v7, v7, v192
  v_mfma_f32_16x16x32_bf16 a[88:91], a[172:175], v[112:115], a[88:91]
  ds_read_b64_tr_b16 a[188:189], v223 offset:57344
  v_cvt_pk_bf16_f32 v0, v0, v1
  v_mfma_f32_16x16x32_bf16 a[92:95], a[172:175], v[120:123], a[92:95]
  v_cvt_pk_bf16_f32 v1, v2, v3
  v_cvt_pk_bf16_f32 v2, v4, v5
  v_mfma_f32_16x16x32_bf16 a[92:95], a[168:171], v[88:91], a[92:95]
  ds_read_b64_tr_b16 a[190:191], v223 offset:61440
  s_waitcnt lgkmcnt(4)
  v_cvt_pk_bf16_f32 v3, v6, v7
  v_mfma_f32_16x16x32_bf16 a[96:99], a[176:179], v[64:67], a[96:99]
  buffer_store_dwordx4 v[0:3], v244, s[24:27], s40 offen offset:0 sc1
  v_mfma_f32_16x16x32_bf16 a[96:99], a[180:183], v[96:99], a[96:99]
  v_accvgpr_read_b32 v8, a4
  v_accvgpr_read_b32 v9, a5
  v_mfma_f32_16x16x32_bf16 a[100:103], a[180:183], v[104:107], a[100:103]
  v_accvgpr_read_b32 v10, a6
  v_accvgpr_read_b32 v11, a7
  v_mfma_f32_16x16x32_bf16 a[100:103], a[176:179], v[72:75], a[100:103]
  v_accvgpr_read_b32 v12, a20
  v_accvgpr_read_b32 v13, a21
  v_mfma_f32_16x16x32_bf16 a[104:107], a[176:179], v[80:83], a[104:107]
  v_accvgpr_read_b32 v14, a22
  v_accvgpr_read_b32 v15, a23
  v_mfma_f32_16x16x32_bf16 a[104:107], a[180:183], v[112:115], a[104:107]
  v_mul_f32 v8, v8, v196
  v_mul_f32 v9, v9, v196
  v_mfma_f32_16x16x32_bf16 a[108:111], a[180:183], v[120:123], a[108:111]
  v_mul_f32 v10, v10, v196
  v_mul_f32 v11, v11, v196
  v_mfma_f32_16x16x32_bf16 a[108:111], a[176:179], v[88:91], a[108:111]
  s_waitcnt lgkmcnt(0)
  v_mul_f32 v12, v12, v196
  v_mul_f32 v13, v13, v196
  v_mfma_f32_16x16x32_bf16 a[112:115], a[184:187], v[64:67], a[112:115]
  v_mul_f32 v14, v14, v196
  v_mul_f32 v15, v15, v196
  v_mfma_f32_16x16x32_bf16 a[112:115], a[188:191], v[96:99], a[112:115]
  v_cvt_pk_bf16_f32 v8, v8, v9
  v_cvt_pk_bf16_f32 v9, v10, v11
  v_mfma_f32_16x16x32_bf16 a[116:119], a[188:191], v[104:107], a[116:119]
  v_cvt_pk_bf16_f32 v10, v12, v13
  v_cvt_pk_bf16_f32 v11, v14, v15
  v_mfma_f32_16x16x32_bf16 a[116:119], a[184:187], v[72:75], a[116:119]
  buffer_store_dwordx4 v[8:11], v244, s[24:27], s40 offen offset:2048 sc1
  v_mfma_f32_16x16x32_bf16 a[120:123], a[184:187], v[80:83], a[120:123]
  v_accvgpr_read_b32 v16, a8
  v_accvgpr_read_b32 v17, a9
  v_mfma_f32_16x16x32_bf16 a[120:123], a[188:191], v[112:115], a[120:123]
  v_accvgpr_read_b32 v18, a10
  v_accvgpr_read_b32 v19, a11
  v_mfma_f32_16x16x32_bf16 a[124:127], a[188:191], v[120:123], a[124:127]
  v_accvgpr_read_b32 v20, a24
  v_accvgpr_read_b32 v21, a25
  v_mfma_f32_16x16x32_bf16 a[124:127], a[184:187], v[88:91], a[124:127]
  v_accvgpr_read_b32 v22, a26
  v_accvgpr_read_b32 v23, a27
  v_pk_mul_f32 v[16:17], v[16:17], v[200:201] op_sel_hi:[1,0]
  v_pk_mul_f32 v[18:19], v[18:19], v[200:201] op_sel_hi:[1,0]
  v_pk_mul_f32 v[20:21], v[20:21], v[200:201] op_sel_hi:[1,0]
  v_pk_mul_f32 v[22:23], v[22:23], v[200:201] op_sel_hi:[1,0]
  v_cvt_pk_bf16_f32 v16, v16, v17
  v_cvt_pk_bf16_f32 v17, v18, v19
  v_cvt_pk_bf16_f32 v18, v20, v21
  v_cvt_pk_bf16_f32 v19, v22, v23
  buffer_store_dwordx4 v[16:19], v244, s[24:27], s41 offen offset:0 sc1
  v_accvgpr_read_b32 v24, a12
  v_accvgpr_read_b32 v25, a13
  v_accvgpr_read_b32 v26, a14
  v_accvgpr_read_b32 v27, a15
  v_accvgpr_read_b32 v28, a28
  v_accvgpr_read_b32 v29, a29
  v_accvgpr_read_b32 v30, a30
  v_accvgpr_read_b32 v31, a31
  v_pk_mul_f32 v[24:25], v[24:25], v[204:205] op_sel_hi:[1,0]
  v_pk_mul_f32 v[26:27], v[26:27], v[204:205] op_sel_hi:[1,0]
  v_pk_mul_f32 v[28:29], v[28:29], v[204:205] op_sel_hi:[1,0]
  v_pk_mul_f32 v[30:31], v[30:31], v[204:205] op_sel_hi:[1,0]
  v_cvt_pk_bf16_f32 v24, v24, v25
  v_cvt_pk_bf16_f32 v25, v26, v27
  v_cvt_pk_bf16_f32 v26, v28, v29
  v_cvt_pk_bf16_f32 v27, v30, v31
  buffer_store_dwordx4 v[24:27], v244, s[24:27], s41 offen offset:2048 sc1
  v_accvgpr_read_b32 v32, a32
  v_accvgpr_read_b32 v33, a33
  v_accvgpr_read_b32 v34, a34
  v_accvgpr_read_b32 v35, a35
  v_accvgpr_read_b32 v36, a48
  v_accvgpr_read_b32 v37, a49
  v_accvgpr_read_b32 v38, a50
  v_accvgpr_read_b32 v39, a51
  v_pk_mul_f32 v[32:33], v[32:33], v[192:193] op_sel_hi:[1,0]
  v_pk_mul_f32 v[34:35], v[34:35], v[192:193] op_sel_hi:[1,0]
  v_pk_mul_f32 v[36:37], v[36:37], v[192:193] op_sel_hi:[1,0]
  v_pk_mul_f32 v[38:39], v[38:39], v[192:193] op_sel_hi:[1,0]
  v_cvt_pk_bf16_f32 v32, v32, v33
  v_cvt_pk_bf16_f32 v33, v34, v35
  v_cvt_pk_bf16_f32 v34, v36, v37
  v_cvt_pk_bf16_f32 v35, v38, v39
  buffer_store_dwordx4 v[32:35], v244, s[24:27], s40 offen offset:1024 sc1
  v_accvgpr_read_b32 v40, a36
  v_accvgpr_read_b32 v41, a37
  v_accvgpr_read_b32 v42, a38
  v_accvgpr_read_b32 v43, a39
  v_accvgpr_read_b32 v44, a52
  v_accvgpr_read_b32 v45, a53
  v_accvgpr_read_b32 v46, a54
  v_accvgpr_read_b32 v47, a55
  v_pk_mul_f32 v[40:41], v[40:41], v[196:197] op_sel_hi:[1,0]
  v_pk_mul_f32 v[42:43], v[42:43], v[196:197] op_sel_hi:[1,0]
  v_pk_mul_f32 v[44:45], v[44:45], v[196:197] op_sel_hi:[1,0]
  v_pk_mul_f32 v[46:47], v[46:47], v[196:197] op_sel_hi:[1,0]
  v_cvt_pk_bf16_f32 v40, v40, v41
  v_cvt_pk_bf16_f32 v41, v42, v43
  v_cvt_pk_bf16_f32 v42, v44, v45
  v_cvt_pk_bf16_f32 v43, v46, v47
  buffer_store_dwordx4 v[40:43], v244, s[24:27], s40 offen offset:3072 sc1
  v_accvgpr_read_b32 v48, a40
  v_accvgpr_read_b32 v49, a41
  v_accvgpr_read_b32 v50, a42
  v_accvgpr_read_b32 v51, a43
  v_accvgpr_read_b32 v52, a56
  v_accvgpr_read_b32 v53, a57
  v_accvgpr_read_b32 v54, a58
  v_accvgpr_read_b32 v55, a59
  v_pk_mul_f32 v[48:49], v[48:49], v[200:201] op_sel_hi:[1,0]
  v_pk_mul_f32 v[50:51], v[50:51], v[200:201] op_sel_hi:[1,0]
  v_pk_mul_f32 v[52:53], v[52:53], v[200:201] op_sel_hi:[1,0]
  v_pk_mul_f32 v[54:55], v[54:55], v[200:201] op_sel_hi:[1,0]
  v_cvt_pk_bf16_f32 v48, v48, v49
  v_cvt_pk_bf16_f32 v49, v50, v51
  v_cvt_pk_bf16_f32 v50, v52, v53
  v_cvt_pk_bf16_f32 v51, v54, v55
  buffer_store_dwordx4 v[48:51], v244, s[24:27], s41 offen offset:1024 sc1
  v_accvgpr_read_b32 v56, a44
  v_accvgpr_read_b32 v57, a45
  v_accvgpr_read_b32 v58, a46
  v_accvgpr_read_b32 v59, a47
  v_accvgpr_read_b32 v60, a60
  v_accvgpr_read_b32 v61, a61
  v_accvgpr_read_b32 v62, a62
  v_accvgpr_read_b32 v63, a63
  v_pk_mul_f32 v[56:57], v[56:57], v[204:205] op_sel_hi:[1,0]
  v_pk_mul_f32 v[58:59], v[58:59], v[204:205] op_sel_hi:[1,0]
  v_pk_mul_f32 v[60:61], v[60:61], v[204:205] op_sel_hi:[1,0]
  v_pk_mul_f32 v[62:63], v[62:63], v[204:205] op_sel_hi:[1,0]
  v_cvt_pk_bf16_f32 v56, v56, v57
  v_cvt_pk_bf16_f32 v57, v58, v59
  v_cvt_pk_bf16_f32 v58, v60, v61
  v_cvt_pk_bf16_f32 v59, v62, v63
  buffer_store_dwordx4 v[56:59], v244, s[24:27], s41 offen offset:3072 sc1
  v_accvgpr_read_b32 v0, a64
  v_accvgpr_read_b32 v1, a65
  v_accvgpr_read_b32 v2, a66
  v_accvgpr_read_b32 v3, a67
  v_accvgpr_read_b32 v4, a80
  v_accvgpr_read_b32 v5, a81
  v_accvgpr_read_b32 v6, a82
  v_accvgpr_read_b32 v7, a83
  v_pk_mul_f32 v[0:1], v[0:1], v[192:193] op_sel_hi:[1,0]
  v_pk_mul_f32 v[2:3], v[2:3], v[192:193] op_sel_hi:[1,0]
  v_pk_mul_f32 v[4:5], v[4:5], v[192:193] op_sel_hi:[1,0]
  v_pk_mul_f32 v[6:7], v[6:7], v[192:193] op_sel_hi:[1,0]
  v_cvt_pk_bf16_f32 v0, v0, v1
  v_cvt_pk_bf16_f32 v1, v2, v3
  v_cvt_pk_bf16_f32 v2, v4, v5
  v_cvt_pk_bf16_f32 v3, v6, v7
  buffer_store_dwordx4 v[0:3], v244, s[24:27], s42 offen offset:0 sc1
  v_accvgpr_read_b32 v8, a68
  v_accvgpr_read_b32 v9, a69
  v_accvgpr_read_b32 v10, a70
  v_accvgpr_read_b32 v11, a71
  v_accvgpr_read_b32 v12, a84
  v_accvgpr_read_b32 v13, a85
  v_accvgpr_read_b32 v14, a86
  v_accvgpr_read_b32 v15, a87
  v_pk_mul_f32 v[8:9], v[8:9], v[196:197] op_sel_hi:[1,0]
  v_pk_mul_f32 v[10:11], v[10:11], v[196:197] op_sel_hi:[1,0]
  v_pk_mul_f32 v[12:13], v[12:13], v[196:197] op_sel_hi:[1,0]
  v_pk_mul_f32 v[14:15], v[14:15], v[196:197] op_sel_hi:[1,0]
  v_cvt_pk_bf16_f32 v8, v8, v9
  v_cvt_pk_bf16_f32 v9, v10, v11
  v_cvt_pk_bf16_f32 v10, v12, v13
  v_cvt_pk_bf16_f32 v11, v14, v15
  buffer_store_dwordx4 v[8:11], v244, s[24:27], s42 offen offset:2048 sc1
  v_accvgpr_read_b32 v16, a72
  v_accvgpr_read_b32 v17, a73
  v_accvgpr_read_b32 v18, a74
  v_accvgpr_read_b32 v19, a75
  v_accvgpr_read_b32 v20, a88
  v_accvgpr_read_b32 v21, a89
  v_accvgpr_read_b32 v22, a90
  v_accvgpr_read_b32 v23, a91
  v_pk_mul_f32 v[16:17], v[16:17], v[200:201] op_sel_hi:[1,0]
  v_pk_mul_f32 v[18:19], v[18:19], v[200:201] op_sel_hi:[1,0]
  v_pk_mul_f32 v[20:21], v[20:21], v[200:201] op_sel_hi:[1,0]
  v_pk_mul_f32 v[22:23], v[22:23], v[200:201] op_sel_hi:[1,0]
  v_cvt_pk_bf16_f32 v16, v16, v17
  v_cvt_pk_bf16_f32 v17, v18, v19
  v_cvt_pk_bf16_f32 v18, v20, v21
  v_cvt_pk_bf16_f32 v19, v22, v23
  buffer_store_dwordx4 v[16:19], v244, s[24:27], s43 offen offset:0 sc1
  v_accvgpr_read_b32 v24, a76
  v_accvgpr_read_b32 v25, a77
  v_accvgpr_read_b32 v26, a78
  v_accvgpr_read_b32 v27, a79
  v_accvgpr_read_b32 v28, a92
  v_accvgpr_read_b32 v29, a93
  v_accvgpr_read_b32 v30, a94
  v_accvgpr_read_b32 v31, a95
  v_pk_mul_f32 v[24:25], v[24:25], v[204:205] op_sel_hi:[1,0]
  v_pk_mul_f32 v[26:27], v[26:27], v[204:205] op_sel_hi:[1,0]
  v_pk_mul_f32 v[28:29], v[28:29], v[204:205] op_sel_hi:[1,0]
  v_pk_mul_f32 v[30:31], v[30:31], v[204:205] op_sel_hi:[1,0]
  v_cvt_pk_bf16_f32 v24, v24, v25
  v_cvt_pk_bf16_f32 v25, v26, v27
  v_cvt_pk_bf16_f32 v26, v28, v29
  v_cvt_pk_bf16_f32 v27, v30, v31
  buffer_store_dwordx4 v[24:27], v244, s[24:27], s43 offen offset:2048 sc1
  v_accvgpr_read_b32 v32, a96
  v_accvgpr_read_b32 v33, a97
  v_accvgpr_read_b32 v34, a98
  v_accvgpr_read_b32 v35, a99
  v_accvgpr_read_b32 v36, a112
  v_accvgpr_read_b32 v37, a113
  v_accvgpr_read_b32 v38, a114
  v_accvgpr_read_b32 v39, a115
  v_pk_mul_f32 v[32:33], v[32:33], v[192:193] op_sel_hi:[1,0]
  v_pk_mul_f32 v[34:35], v[34:35], v[192:193] op_sel_hi:[1,0]
  v_pk_mul_f32 v[36:37], v[36:37], v[192:193] op_sel_hi:[1,0]
  v_pk_mul_f32 v[38:39], v[38:39], v[192:193] op_sel_hi:[1,0]
  v_cvt_pk_bf16_f32 v32, v32, v33
  v_cvt_pk_bf16_f32 v33, v34, v35
  v_cvt_pk_bf16_f32 v34, v36, v37
  v_cvt_pk_bf16_f32 v35, v38, v39
  buffer_store_dwordx4 v[32:35], v244, s[24:27], s42 offen offset:1024 sc1
  v_accvgpr_read_b32 v40, a100
  v_accvgpr_read_b32 v41, a101
  v_accvgpr_read_b32 v42, a102
  v_accvgpr_read_b32 v43, a103
  v_accvgpr_read_b32 v44, a116
  v_accvgpr_read_b32 v45, a117
  v_accvgpr_read_b32 v46, a118
  v_accvgpr_read_b32 v47, a119
  v_pk_mul_f32 v[40:41], v[40:41], v[196:197] op_sel_hi:[1,0]
  v_pk_mul_f32 v[42:43], v[42:43], v[196:197] op_sel_hi:[1,0]
  v_pk_mul_f32 v[44:45], v[44:45], v[196:197] op_sel_hi:[1,0]
  v_pk_mul_f32 v[46:47], v[46:47], v[196:197] op_sel_hi:[1,0]
  v_cvt_pk_bf16_f32 v40, v40, v41
  v_cvt_pk_bf16_f32 v41, v42, v43
  v_cvt_pk_bf16_f32 v42, v44, v45
  v_cvt_pk_bf16_f32 v43, v46, v47
  buffer_store_dwordx4 v[40:43], v244, s[24:27], s42 offen offset:3072 sc1
  v_accvgpr_read_b32 v48, a104
  v_accvgpr_read_b32 v49, a105
  v_accvgpr_read_b32 v50, a106
  v_accvgpr_read_b32 v51, a107
  v_accvgpr_read_b32 v52, a120
  v_accvgpr_read_b32 v53, a121
  v_accvgpr_read_b32 v54, a122
  v_accvgpr_read_b32 v55, a123
  v_pk_mul_f32 v[48:49], v[48:49], v[200:201] op_sel_hi:[1,0]
  v_pk_mul_f32 v[50:51], v[50:51], v[200:201] op_sel_hi:[1,0]
  v_pk_mul_f32 v[52:53], v[52:53], v[200:201] op_sel_hi:[1,0]
  v_pk_mul_f32 v[54:55], v[54:55], v[200:201] op_sel_hi:[1,0]
  v_cvt_pk_bf16_f32 v48, v48, v49
  v_cvt_pk_bf16_f32 v49, v50, v51
  v_cvt_pk_bf16_f32 v50, v52, v53
  v_cvt_pk_bf16_f32 v51, v54, v55
  buffer_store_dwordx4 v[48:51], v244, s[24:27], s43 offen offset:1024 sc1
  v_accvgpr_read_b32 v56, a108
  v_accvgpr_read_b32 v57, a109
  v_accvgpr_read_b32 v58, a110
  v_accvgpr_read_b32 v59, a111
  v_accvgpr_read_b32 v60, a124
  v_accvgpr_read_b32 v61, a125
  v_accvgpr_read_b32 v62, a126
  v_accvgpr_read_b32 v63, a127
  v_pk_mul_f32 v[56:57], v[56:57], v[204:205] op_sel_hi:[1,0]
  v_pk_mul_f32 v[58:59], v[58:59], v[204:205] op_sel_hi:[1,0]
  v_pk_mul_f32 v[60:61], v[60:61], v[204:205] op_sel_hi:[1,0]
  v_pk_mul_f32 v[62:63], v[62:63], v[204:205] op_sel_hi:[1,0]
  v_cvt_pk_bf16_f32 v56, v56, v57
  v_cvt_pk_bf16_f32 v57, v58, v59
  v_cvt_pk_bf16_f32 v58, v60, v61
  v_cvt_pk_bf16_f32 v59, v62, v63
  buffer_store_dwordx4 v[56:59], v244, s[24:27], s43 offen offset:3072 sc1
  ds_write_b32 v247, v245
  buffer_load_dwordx4 a[0:3], v252, s[24:27], s5 offen offset:3072 sc1
  buffer_load_dwordx4 a[4:7], v253, s[24:27], s5 offen offset:0 sc1
  buffer_load_dwordx4 a[8:11], v253, s[24:27], s5 offen offset:1024 sc1
  buffer_load_dwordx4 a[12:15], v253, s[24:27], s5 offen offset:2048 sc1
  buffer_load_dwordx4 a[16:19], v253, s[24:27], s5 offen offset:3072 sc1
  buffer_load_dwordx4 a[20:23], v242, s[24:27], s6 offen offset:0 sc1
  buffer_load_dwordx4 a[24:27], v242, s[24:27], s6 offen offset:1024 sc1
  buffer_load_dwordx4 a[28:31], v242, s[24:27], s6 offen offset:2048 sc1
  buffer_load_dwordx4 a[32:35], v242, s[24:27], s6 offen offset:3072 sc1
  buffer_load_dwordx4 a[36:39], v252, s[24:27], s6 offen offset:0 sc1
  s_and_b32 s39, s2, 63
  s_lshl_b32 s39, s39, 7
  s_add_u32 s39, s39, 2867200
  s_lshl_b32 s38, s3, 26
  v_lshlrev_b32 v64, 22, v242
  v_or_b32 v64, s38, v64
  v_mov_b32 v65, 1
  v_add_u32 v246, 157696, v242
  s_waitcnt vmcnt(10) lgkmcnt(0)
  s_barrier
  ds_read_b128 v[68:71], v246
  s_waitcnt lgkmcnt(0)
  v_or3_b32 v68, v68, v69, v70
  v_or_b32 v68, v68, v71
  v_cmp_ne_u32 vcc, 0, v68
  s_nop 0
  s_cbranch_vccnz attn_redo
tail_go:
  buffer_atomic_add v65, v64, s[24:27], s39 offen
  s_and_b32 s36, s2, 1
  s_bfe_u32 s31, s2, 0x20001
  s_lshl_b32 s31, s31, 2
  s_bfe_u32 s38, s2, 0x20003
  s_add_u32 s31, s31, s38
  s_lshr_b32 s29, s2, 5
  v_mov_b32 v114, v242
  v_add_u32 v115, 0x1000, v114
  v_add_u32 v116, 0x2000, v114
  s_lshl_b32 s38, s36, 2
  s_add_u32 s38, s38, s3
  s_lshl_b32 s30, s38, 16
  buffer_load_dwordx4 a[40:43], v115, s[24:27], s6 offen offset:1024 sc1
  buffer_load_dwordx4 a[44:47], v115, s[24:27], s6 offen offset:2048 sc1
  buffer_load_dwordx4 a[48:51], v115, s[24:27], s6 offen offset:3072 sc1
  buffer_load_dwordx4 a[52:55], v116, s[24:27], s6 offen offset:0 sc1
  v_lshrrev_b32 v125, 4, v114
  v_and_b32 v126, 15, v125
  v_lshrrev_b32 v127, 4, v125
  s_add_u32 s38, s3, 0
  s_and_b32 s38, s38, 3
  s_lshl_b32 s38, s38, 11
  v_add_u32 v110, s38, v114
  s_sub_u32 s38, s3, 0
  s_and_b32 s38, s38, 3
  s_mul_i32 s38, s38, 15360
  s_add_u32 s38, s38, 98304
  v_add_u32 v118, s38, v114
  s_add_u32 s38, s3, 1
  s_and_b32 s38, s38, 3
  s_lshl_b32 s38, s38, 11
  v_add_u32 v111, s38, v114
  s_sub_u32 s38, s3, 1
  s_and_b32 s38, s38, 3
  s_mul_i32 s38, s38, 15360
  s_add_u32 s38, s38, 98304
  v_add_u32 v119, s38, v114
  s_add_u32 s38, s3, 2
  s_and_b32 s38, s38, 3
  s_lshl_b32 s38, s38, 11
  v_add_u32 v112, s38, v114
  s_sub_u32 s38, s3, 2
  s_and_b32 s38, s38, 3
  s_mul_i32 s38, s38, 15360
  s_add_u32 s38, s38, 98304
  v_add_u32 v120, s38, v114
  s_add_u32 s38, s3, 3
  s_and_b32 s38, s38, 3
  s_lshl_b32 s38, s38, 11
  v_add_u32 v113, s38, v114
  s_sub_u32 s38, s3, 3
  s_and_b32 s38, s38, 3
  s_mul_i32 s38, s38, 15360
  s_add_u32 s38, s38, 98304
  v_add_u32 v121, s38, v114
  v_add_u32 v122, s28, v114
  v_add_u32 v135, 0x10000, v122
  s_and_b32 s38, s31, 14
  s_add_u32 s38, s38, s36
  s_lshl_b32 s38, s38, 2
  s_add_u32 s38, s38, s3
  s_lshl_b32 s38, s38, 7
  s_add_u32 s38, s38, 2867200
  s_lshl_b32 s39, s29, 8
  s_add_u32 s39, s39, 2818304
  v_mov_b32 v133, s38
  v_writelane_b32 v133, s39, 1
  v_mov_b32 v134, 4
  v_writelane_b32 v134, 30, 1
  s_lshl_b32 s31, s31, 1
  s_add_u32 s31, s31, s36
  s_add_u32 s30, s30, 8388608
  s_lshl_b32 s38, s31, 19
  s_add_u32 s37, s30, s38
  s_xor_b32 s38, s38, 0x80000
  s_add_u32 s30, s30, s38
  s_lshl_b32 s40, s29, 5
  s_add_u32 s40, s40, s31
  s_lshl_b32 s38, s31, 6
  s_lshl_b32 s39, s3, 4
  s_add_u32 s38, s38, s39
  v_add_u32 v128, s38, v126
  v_mul_u32_u24 v117, 0x500, v128
  v_lshl_add_u32 v117, v127, 3, v117
  s_mul_i32 s38, s29, 160
  v_add_u32 v117, s38, v117
  s_mov_b32 s12, s60
  s_mov_b32 s13, s61
  s_mov_b32 s14, 2621440
  s_mov_b32 s15, 0x20000
  s_mov_b32 s16, s62
  s_mov_b32 s17, s63
  s_mov_b32 s18, 2621440
  s_mov_b32 s19, 0x20000
  s_mul_i32 s38, s31, 81920
  s_lshl_b32 s39, s3, 10
  s_add_u32 s38, s38, s39
  s_mul_i32 s39, s29, 10
  v_lshrrev_b32 v129, 1, v127
  v_add_u32 v129, s39, v129
  v_and_b32 v130, 1, v127
  v_lshlrev_b32 v130, 3, v130
  v_lshl_add_u32 v130, v126, 4, v130
  v_lshrrev_b32 v131, 2, v129
  v_lshl_add_u32 v131, v131, 12, v130
  v_and_b32 v132, 3, v129
  v_lshl_add_u32 v131, v132, 8, v131
  buffer_load_dwordx2 v[156:157], v131, s[24:27], s38 offen sc1
  v_add_u32 v129, 2, v129
  buffer_load_dwordx2 v[80:81], v117, s[12:15], 0 offen offset:0
  v_lshrrev_b32 v131, 2, v129
  v_lshl_add_u32 v131, v131, 12, v130
  v_and_b32 v132, 3, v129
  v_lshl_add_u32 v131, v132, 8, v131
  buffer_load_dwordx2 v[158:159], v131, s[24:27], s38 offen sc1
  v_add_u32 v129, 2, v129
  buffer_load_dwordx2 v[82:83], v117, s[12:15], 0 offen offset:32
  v_lshrrev_b32 v131, 2, v129
  v_lshl_add_u32 v131, v131, 12, v130
  v_and_b32 v132, 3, v129
  v_lshl_add_u32 v131, v132, 8, v131
  buffer_load_dwordx2 v[160:161], v131, s[24:27], s38 offen sc1
  v_add_u32 v129, 2, v129
  buffer_load_dwordx2 v[84:85], v117, s[12:15], 0 offen offset:64
  v_lshrrev_b32 v131, 2, v129
  v_lshl_add_u32 v131, v131, 12, v130
  v_and_b32 v132, 3, v129
  v_lshl_add_u32 v131, v132, 8, v131
  buffer_load_dwordx2 v[162:163], v131, s[24:27], s38 offen sc1
  v_add_u32 v129, 2, v129
  buffer_load_dwordx2 v[86:87], v117, s[12:15], 0 offen offset:96
  v_lshrrev_b32 v131, 2, v129
  v_lshl_add_u32 v131, v131, 12, v130
  v_and_b32 v132, 3, v129
  v_lshl_add_u32 v131, v132, 8, v131
  buffer_load_dwordx2 v[164:165], v131, s[24:27], s38 offen sc1
  v_add_u32 v129, 2, v129
  buffer_load_dwordx2 v[88:89], v117, s[12:15], 0 offen offset:128
  v_mov_b32 v123, 1073741824
  v_bfrev_b32 v124, 1
  v_sub_u32 v128, 0xffff, v128
  s_mov_b32 s34, 0xffff0000
  s_and_b32 s38, s52, 0xffff
  v_cmp_eq_u32 vcc, s38, v128
  v_mov_b32 v129, s52
  v_mov_b32 v130, 0
  v_cndmask_b32 v124, v124, v129, vcc
  v_cndmask_b32 v123, v123, v130, vcc
  s_and_b32 s38, s53, 0xffff
  v_cmp_eq_u32 vcc, s38, v128
  v_mov_b32 v129, s53
  v_mov_b32 v130, 2560
  v_cndmask_b32 v124, v124, v129, vcc
  v_cndmask_b32 v123, v123, v130, vcc
  s_and_b32 s38, s54, 0xffff
  v_cmp_eq_u32 vcc, s38, v128
  v_mov_b32 v129, s54
  v_mov_b32 v130, 5120
  v_cndmask_b32 v124, v124, v129, vcc
  v_cndmask_b32 v123, v123, v130, vcc
  s_and_b32 s38, s55, 0xffff
  v_cmp_eq_u32 vcc, s38, v128
  v_mov_b32 v129, s55
  v_mov_b32 v130, 7680
  v_cndmask_b32 v124, v124, v129, vcc
  v_cndmask_b32 v123, v123, v130, vcc
  s_and_b32 s38, s56, 0xffff
  v_cmp_eq_u32 vcc, s38, v128
  v_mov_b32 v129, s56
  v_mov_b32 v130, 10240
  v_cndmask_b32 v124, v124, v129, vcc
  v_cndmask_b32 v123, v123, v130, vcc
  s_and_b32 s38, s57, 0xffff
  v_cmp_eq_u32 vcc, s38, v128
  v_mov_b32 v129, s57
  v_mov_b32 v130, 12800
  v_cndmask_b32 v124, v124, v129, vcc
  v_cndmask_b32 v123, v123, v130, vcc
  s_and_b32 s38, s58, 0xffff
  v_cmp_eq_u32 vcc, s38, v128
  v_mov_b32 v129, s58
  v_mov_b32 v130, 15360
  v_cndmask_b32 v124, v124, v129, vcc
  v_cndmask_b32 v123, v123, v130, vcc
  s_and_b32 s38, s59, 0xffff
  v_cmp_eq_u32 vcc, s38, v128
  v_mov_b32 v129, s59
  v_mov_b32 v130, 17920
  v_cndmask_b32 v124, v124, v129, vcc
  v_cndmask_b32 v123, v123, v130, vcc
  v_lshl_add_u32 v123, v127, 4, v123
  s_mul_i32 s32, s29, 320
  s_add_u32 s32, s32, 2686976
  v_ashrrev_i32 v129, 31, v124
  v_not_b32 v129, v129
  v_or_b32 v129, 0x80000000, v129
  v_xor_b32 v124, v124, v129
  v_and_b32 v124, s34, v124
  v_mul_f32 v124, 0xbfb8aa3b, v124
  v_exp_f32 v124, v124
  s_nop 0
  v_add_f32 v124, 1.0, v124
  v_rcp_f32 v124, v124
  s_nop 0
  v_cvt_pk_bf16_f32 v124, v124, v124
  v_lshlrev_b32 v124, 16, v124
  buffer_load_dword v128, v133, s[24:27], 0 offen sc1
  buffer_load_dwordx4 a[56:59], v116, s[24:27], s6 offen offset:1024 sc1
  buffer_load_dwordx4 a[60:63], v116, s[24:27], s6 offen offset:2048 sc1
  buffer_load_dwordx4 a[64:67], v116, s[24:27], s6 offen offset:3072 sc1
  buffer_load_dwordx4 a[68:71], v114, s[24:27], s7 offen offset:0 sc1
  buffer_load_dwordx4 a[72:75], v114, s[24:27], s7 offen offset:1024 sc1
  buffer_load_dwordx4 a[76:79], v114, s[24:27], s7 offen offset:2048 sc1
  buffer_load_dwordx4 a[80:83], v114, s[24:27], s7 offen offset:3072 sc1
  buffer_load_dwordx4 a[84:87], v115, s[24:27], s7 offen offset:0 sc1
  buffer_load_dwordx4 a[88:91], v115, s[24:27], s7 offen offset:1024 sc1
  buffer_load_dwordx4 a[92:95], v115, s[24:27], s7 offen offset:2048 sc1
  s_waitcnt vmcnt(20)
  v_lshlrev_b32 v90, 16, v156
  v_and_b32 v91, s34, v156
  v_lshlrev_b32 v92, 16, v157
  v_and_b32 v93, s34, v157
  s_waitcnt vmcnt(18)
  v_lshlrev_b32 v94, 16, v158
  v_and_b32 v95, s34, v158
  v_lshlrev_b32 v96, 16, v159
  v_and_b32 v97, s34, v159
  s_waitcnt vmcnt(16)
  v_lshlrev_b32 v98, 16, v160
  v_and_b32 v99, s34, v160
  v_lshlrev_b32 v100, 16, v161
  v_and_b32 v101, s34, v161
  s_waitcnt vmcnt(14)
  v_lshlrev_b32 v102, 16, v162
  v_and_b32 v103, s34, v162
  v_lshlrev_b32 v104, 16, v163
  v_and_b32 v105, s34, v163
  s_waitcnt vmcnt(12)
  v_lshlrev_b32 v106, 16, v164
  v_and_b32 v107, s34, v164
  v_lshlrev_b32 v108, 16, v165
  v_and_b32 v109, s34, v165
  v_mov_b32 v156, 0
  v_mov_b32 v157, 0
  v_mov_b32 v158, 0
  v_mov_b32 v159, 0
  v_mov_b32 v160, 0
  v_mov_b32 v161, 0
  v_mov_b32 v162, 0
  v_mov_b32 v163, 0
  v_mov_b32 v164, 0
  v_mov_b32 v165, 0
  v_mov_b32 v166, 0
  v_mov_b32 v167, 0
  v_mov_b32 v168, 0
  v_mov_b32 v169, 0
  v_mov_b32 v170, 0
  v_mov_b32 v171, 0
  v_mov_b32 v172, 0
  v_mov_b32 v173, 0
  v_mov_b32 v174, 0
  v_mov_b32 v175, 0
  s_waitcnt vmcnt(10)
  v_cmp_lt_u32 vcc, v128, v134
  s_nop 0
  s_cbranch_vccz tail_ready
  s_mov_b32 s35, 32768
tail_spin:
  s_sleep 2
  buffer_load_dword v128, v133, s[24:27], 0 offen sc1
  s_waitcnt vmcnt(0)
  v_cmp_lt_u32 vcc, v128, v134
  s_nop 0
  s_cbranch_vccz tail_ready
  s_sub_u32 s35, s35, 1
  s_cmp_lg_u32 s35, 0
  s_cbranch_scc1 tail_spin
tail_ready:
  buffer_load_dwordx4 a[180:183], v110, s[24:27], s30 offen offset:0 sc1
  buffer_load_dwordx4 a[184:187], v110, s[24:27], s30 offen offset:1024 sc1
  buffer_load_dwordx4 a[188:191], v111, s[24:27], s30 offen offset:0 sc1
  buffer_load_dwordx4 a[192:195], v111, s[24:27], s30 offen offset:1024 sc1
  buffer_load_dwordx4 a[196:199], v112, s[24:27], s30 offen offset:0 sc1
  buffer_load_dwordx4 a[200:203], v112, s[24:27], s30 offen offset:1024 sc1
  buffer_load_dwordx4 a[204:207], v113, s[24:27], s30 offen offset:0 sc1
  buffer_load_dwordx4 a[208:211], v113, s[24:27], s30 offen offset:1024 sc1
  v_cmp_gt_u32 vcc, 1073741824, v123
  s_nop 0
  s_and_saveexec_b64 s[42:43], vcc
  s_cbranch_execz tail_plain
  s_waitcnt vmcnt(30)
  buffer_load_dwordx4 v[156:159], v123, s[24:27], s32 offen offset:0 sc1
  buffer_load_dwordx4 v[160:163], v123, s[24:27], s32 offen offset:64 sc1
  buffer_load_dwordx4 v[164:167], v123, s[24:27], s32 offen offset:128 sc1
  buffer_load_dwordx4 v[168:171], v123, s[24:27], s32 offen offset:192 sc1
  buffer_load_dwordx4 v[172:175], v123, s[24:27], s32 offen offset:256 sc1
  s_add_u32 s32, s32, 20480
  buffer_load_dwordx4 v[136:139], v123, s[24:27], s32 offen offset:0 sc1
  buffer_load_dwordx4 v[140:143], v123, s[24:27], s32 offen offset:64 sc1
  buffer_load_dwordx4 v[144:147], v123, s[24:27], s32 offen offset:128 sc1
  buffer_load_dwordx4 v[148:151], v123, s[24:27], s32 offen offset:192 sc1
  buffer_load_dwordx4 v[152:155], v123, s[24:27], s32 offen offset:256 sc1
  s_add_u32 s32, s32, 20480
  buffer_load_dwordx4 v[0:3], v123, s[24:27], s32 offen offset:0 sc1
  buffer_load_dwordx4 v[4:7], v123, s[24:27], s32 offen offset:64 sc1
  buffer_load_dwordx4 v[8:11], v123, s[24:27], s32 offen offset:128 sc1
  buffer_load_dwordx4 v[12:15], v123, s[24:27], s32 offen offset:192 sc1
  buffer_load_dwordx4 v[16:19], v123, s[24:27], s32 offen offset:256 sc1
  s_add_u32 s32, s32, 20480
  buffer_load_dwordx4 v[20:23], v123, s[24:27], s32 offen offset:0 sc1
  buffer_load_dwordx4 v[24:27], v123, s[24:27], s32 offen offset:64 sc1
  buffer_load_dwordx4 v[28:31], v123, s[24:27], s32 offen offset:128 sc1
  buffer_load_dwordx4 v[32:35], v123, s[24:27], s32 offen offset:192 sc1
  buffer_load_dwordx4 v[36:39], v123, s[24:27], s32 offen offset:256 sc1
  s_add_u32 s32, s32, 20480
  buffer_load_dwordx4 v[40:43], v123, s[24:27], s32 offen offset:0 sc1
  buffer_load_dwordx4 v[44:47], v123, s[24:27], s32 offen offset:64 sc1
  buffer_load_dwordx4 v[48:51], v123, s[24:27], s32 offen offset:128 sc1
  buffer_load_dwordx4 v[52:55], v123, s[24:27], s32 offen offset:192 sc1
  buffer_load_dwordx4 v[56:59], v123, s[24:27], s32 offen offset:256 sc1
  s_add_u32 s32, s32, 20480
  buffer_load_dwordx4 v[60:63], v123, s[24:27], s32 offen offset:0 sc1
  buffer_load_dwordx4 v[64:67], v123, s[24:27], s32 offen offset:64 sc1
  buffer_load_dwordx4 v[68:71], v123, s[24:27], s32 offen offset:128 sc1
  buffer_load_dwordx4 v[72:75], v123, s[24:27], s32 offen offset:192 sc1
  buffer_load_dwordx4 v[76:79], v123, s[24:27], s32 offen offset:256 sc1
  s_add_u32 s32, s32, 20480
  s_waitcnt vmcnt(0)
  v_add_f32 v156, v156, v136
  v_add_f32 v157, v157, v137
  v_add_f32 v158, v158, v138
  v_add_f32 v159, v159, v139
  v_add_f32 v160, v160, v140
  v_add_f32 v161, v161, v141
  v_add_f32 v162, v162, v142
  v_add_f32 v163, v163, v143
  v_add_f32 v164, v164, v144
  v_add_f32 v165, v165, v145
  v_add_f32 v166, v166, v146
  v_add_f32 v167, v167, v147
  v_add_f32 v168, v168, v148
  v_add_f32 v169, v169, v149
  v_add_f32 v170, v170, v150
  v_add_f32 v171, v171, v151
  v_add_f32 v172, v172, v152
  v_add_f32 v173, v173, v153
  v_add_f32 v174, v174, v154
  v_add_f32 v175, v175, v155
  v_add_f32 v156, v156, v0
  v_add_f32 v157, v157, v1
  v_add_f32 v158, v158, v2
  v_add_f32 v159, v159, v3
  v_add_f32 v160, v160, v4
  v_add_f32 v161, v161, v5
  v_add_f32 v162, v162, v6
  v_add_f32 v163, v163, v7
  v_add_f32 v164, v164, v8
  v_add_f32 v165, v165, v9
  v_add_f32 v166, v166, v10
  v_add_f32 v167, v167, v11
  v_add_f32 v168, v168, v12
  v_add_f32 v169, v169, v13
  v_add_f32 v170, v170, v14
  v_add_f32 v171, v171, v15
  v_add_f32 v172, v172, v16
  v_add_f32 v173, v173, v17
  v_add_f32 v174, v174, v18
  v_add_f32 v175, v175, v19
  v_add_f32 v156, v156, v20
  v_add_f32 v157, v157, v21
  v_add_f32 v158, v158, v22
  v_add_f32 v159, v159, v23
  v_add_f32 v160, v160, v24
  v_add_f32 v161, v161, v25
  v_add_f32 v162, v162, v26
  v_add_f32 v163, v163, v27
  v_add_f32 v164, v164, v28
  v_add_f32 v165, v165, v29
  v_add_f32 v166, v166, v30
  v_add_f32 v167, v167, v31
  v_add_f32 v168, v168, v32
  v_add_f32 v169, v169, v33
  v_add_f32 v170, v170, v34
  v_add_f32 v171, v171, v35
  v_add_f32 v172, v172, v36
  v_add_f32 v173, v173, v37
  v_add_f32 v174, v174, v38
  v_add_f32 v175, v175, v39
  v_add_f32 v156, v156, v40
  v_add_f32 v157, v157, v41
  v_add_f32 v158, v158, v42
  v_add_f32 v159, v159, v43
  v_add_f32 v160, v160, v44
  v_add_f32 v161, v161, v45
  v_add_f32 v162, v162, v46
  v_add_f32 v163, v163, v47
  v_add_f32 v164, v164, v48
  v_add_f32 v165, v165, v49
  v_add_f32 v166, v166, v50
  v_add_f32 v167, v167, v51
  v_add_f32 v168, v168, v52
  v_add_f32 v169, v169, v53
  v_add_f32 v170, v170, v54
  v_add_f32 v171, v171, v55
  v_add_f32 v172, v172, v56
  v_add_f32 v173, v173, v57
  v_add_f32 v174, v174, v58
  v_add_f32 v175, v175, v59
  v_add_f32 v156, v156, v60
  v_add_f32 v157, v157, v61
  v_add_f32 v158, v158, v62
  v_add_f32 v159, v159, v63
  v_add_f32 v160, v160, v64
  v_add_f32 v161, v161, v65
  v_add_f32 v162, v162, v66
  v_add_f32 v163, v163, v67
  v_add_f32 v164, v164, v68
  v_add_f32 v165, v165, v69
  v_add_f32 v166, v166, v70
  v_add_f32 v167, v167, v71
  v_add_f32 v168, v168, v72
  v_add_f32 v169, v169, v73
  v_add_f32 v170, v170, v74
  v_add_f32 v171, v171, v75
  v_add_f32 v172, v172, v76
  v_add_f32 v173, v173, v77
  v_add_f32 v174, v174, v78
  v_add_f32 v175, v175, v79
tail_plain:
  s_mov_b64 exec, s[42:43]
  s_waitcnt vmcnt(0)
  v_mfma_f32_16x16x32_bf16 v[0:3], a[212:215], a[180:183], 0
  s_add_u32 s30, s30, 8192
  buffer_load_dwordx4 v[176:179], v110, s[24:27], s30 offen offset:0 sc1
  v_mfma_f32_16x16x32_bf16 v[0:3], a[232:235], a[184:187], v[0:3]
  v_cvt_pk_bf16_f32 v156, v156, v156
  v_cvt_pk_bf16_f32 v157, v157, v157
  v_mfma_f32_16x16x32_bf16 v[4:7], a[232:235], a[192:195], 0
  buffer_load_dwordx4 a[96:99], v115, s[24:27], s7 offen offset:3072 sc1
  v_mfma_f32_16x16x32_bf16 v[4:7], a[212:215], a[188:191], v[4:7]
  v_cvt_pk_bf16_f32 v158, v158, v158
  v_cvt_pk_bf16_f32 v159, v159, v159
  v_mfma_f32_16x16x32_bf16 v[8:11], a[212:215], a[196:199], 0
  buffer_load_dwordx4 v[180:183], v110, s[24:27], s30 offen offset:1024 sc1
  v_mfma_f32_16x16x32_bf16 v[8:11], a[232:235], a[200:203], v[8:11]
  v_lshlrev_b32 v156, 16, v156
  v_lshlrev_b32 v157, 16, v157
  v_mfma_f32_16x16x32_bf16 v[12:15], a[232:235], a[208:211], 0
  v_lshlrev_b32 v158, 16, v158
  v_lshlrev_b32 v159, 16, v159
  v_mfma_f32_16x16x32_bf16 v[12:15], a[212:215], a[204:207], v[12:15]
  v_mul_f32 v156, v156, v124
  v_mul_f32 v157, v157, v124
  v_mfma_f32_16x16x32_bf16 v[16:19], a[216:219], a[180:183], 0
  buffer_load_dwordx4 v[184:187], v111, s[24:27], s30 offen offset:0 sc1
  v_mfma_f32_16x16x32_bf16 v[16:19], a[236:239], a[184:187], v[16:19]
  v_mul_f32 v158, v158, v124
  v_mul_f32 v159, v159, v124
  v_mfma_f32_16x16x32_bf16 v[20:23], a[236:239], a[192:195], 0
  buffer_load_dwordx4 a[100:103], v116, s[24:27], s7 offen offset:0 sc1
  v_mfma_f32_16x16x32_bf16 v[20:23], a[216:219], a[188:191], v[20:23]
  v_cvt_pk_bf16_f32 v156, v156, v156
  v_cvt_pk_bf16_f32 v157, v157, v157
  v_mfma_f32_16x16x32_bf16 v[24:27], a[216:219], a[196:199], 0
  buffer_load_dwordx4 v[188:191], v111, s[24:27], s30 offen offset:1024 sc1
  v_mfma_f32_16x16x32_bf16 v[24:27], a[236:239], a[200:203], v[24:27]
  v_cvt_pk_bf16_f32 v158, v158, v158
  v_cvt_pk_bf16_f32 v159, v159, v159
  v_mfma_f32_16x16x32_bf16 v[28:31], a[236:239], a[208:211], 0
  v_lshlrev_b32 v156, 16, v156
  v_lshlrev_b32 v157, 16, v157
  v_mfma_f32_16x16x32_bf16 v[28:31], a[216:219], a[204:207], v[28:31]
  v_lshlrev_b32 v158, 16, v158
  v_lshlrev_b32 v159, 16, v159
  v_mfma_f32_16x16x32_bf16 v[32:35], a[220:223], a[180:183], 0
  buffer_load_dwordx4 v[192:195], v112, s[24:27], s30 offen offset:0 sc1
  v_mfma_f32_16x16x32_bf16 v[32:35], a[240:243], a[184:187], v[32:35]
  v_add_f32 v90, v90, v156
  v_add_f32 v91, v91, v157
  v_mfma_f32_16x16x32_bf16 v[36:39], a[240:243], a[192:195], 0
  buffer_load_dwordx4 a[104:107], v116, s[24:27], s7 offen offset:1024 sc1
  v_mfma_f32_16x16x32_bf16 v[36:39], a[220:223], a[188:191], v[36:39]
  v_add_f32 v92, v92, v158
  v_add_f32 v93, v93, v159
  v_mfma_f32_16x16x32_bf16 v[40:43], a[220:223], a[196:199], 0
  buffer_load_dwordx4 v[196:199], v112, s[24:27], s30 offen offset:1024 sc1
  v_mfma_f32_16x16x32_bf16 v[40:43], a[240:243], a[200:203], v[40:43]
  v_cvt_pk_bf16_f32 v90, v90, v90
  v_cvt_pk_bf16_f32 v91, v91, v91
  v_mfma_f32_16x16x32_bf16 v[44:47], a[240:243], a[208:211], 0
  v_cvt_pk_bf16_f32 v92, v92, v92
  v_cvt_pk_bf16_f32 v93, v93, v93
  v_mfma_f32_16x16x32_bf16 v[44:47], a[220:223], a[204:207], v[44:47]
  v_lshlrev_b32 v90, 16, v90
  v_lshlrev_b32 v91, 16, v91
  v_mfma_f32_16x16x32_bf16 v[48:51], a[224:227], a[180:183], 0
  buffer_load_dwordx4 v[200:203], v113, s[24:27], s30 offen offset:0 sc1
  v_mfma_f32_16x16x32_bf16 v[48:51], a[244:247], a[184:187], v[48:51]
  v_lshlrev_b32 v92, 16, v92
  v_lshlrev_b32 v93, 16, v93
  v_mfma_f32_16x16x32_bf16 v[52:55], a[244:247], a[192:195], 0
  buffer_load_dwordx4 a[108:111], v116, s[24:27], s7 offen offset:2048 sc1
  v_mfma_f32_16x16x32_bf16 v[52:55], a[224:227], a[188:191], v[52:55]
  v_mul_f32 v129, 0xbfb8aa3b, v90
  v_mul_f32 v130, 0xbfb8aa3b, v91
  v_mfma_f32_16x16x32_bf16 v[56:59], a[224:227], a[196:199], 0
  buffer_load_dwordx4 v[204:207], v113, s[24:27], s30 offen offset:1024 sc1
  v_mfma_f32_16x16x32_bf16 v[56:59], a[244:247], a[200:203], v[56:59]
  v_mul_f32 v131, 0xbfb8aa3b, v92
  v_mul_f32 v132, 0xbfb8aa3b, v93
  v_mfma_f32_16x16x32_bf16 v[60:63], a[244:247], a[208:211], 0
  v_exp_f32 v129, v129
  v_mfma_f32_16x16x32_bf16 v[60:63], a[224:227], a[204:207], v[60:63]
  v_exp_f32 v130, v130
  v_mfma_f32_16x16x32_bf16 v[64:67], a[228:231], a[180:183], 0
  s_add_u32 s30, s30, 8192
  buffer_load_dwordx4 v[208:211], v110, s[24:27], s30 offen offset:0 sc1
  v_mfma_f32_16x16x32_bf16 v[64:67], a[248:251], a[184:187], v[64:67]
  v_exp_f32 v131, v131
  v_mfma_f32_16x16x32_bf16 v[68:71], a[248:251], a[192:195], 0
  buffer_load_dwordx4 a[112:115], v116, s[24:27], s7 offen offset:3072 sc1
  v_mfma_f32_16x16x32_bf16 v[68:71], a[228:231], a[188:191], v[68:71]
  v_exp_f32 v132, v132
  v_mfma_f32_16x16x32_bf16 v[72:75], a[228:231], a[196:199], 0
  buffer_load_dwordx4 v[212:215], v110, s[24:27], s30 offen offset:1024 sc1
  v_mfma_f32_16x16x32_bf16 v[72:75], a[248:251], a[200:203], v[72:75]
  v_add_f32 v129, 1.0, v129
  v_add_f32 v130, 1.0, v130
  v_mfma_f32_16x16x32_bf16 v[76:79], a[248:251], a[208:211], 0
  v_add_f32 v131, 1.0, v131
  v_add_f32 v132, 1.0, v132
  v_mfma_f32_16x16x32_bf16 v[76:79], a[228:231], a[204:207], v[76:79]
  v_rcp_f32 v129, v129
  s_waitcnt vmcnt(3)
  v_mfma_f32_16x16x32_bf16 v[0:3], a[252:255], v[176:179], v[0:3]
  buffer_load_dwordx4 v[216:219], v111, s[24:27], s30 offen offset:0 sc1
  v_mfma_f32_16x16x32_bf16 v[0:3], a[144:147], v[180:183], v[0:3]
  v_rcp_f32 v130, v130
  v_mfma_f32_16x16x32_bf16 v[4:7], a[144:147], v[188:191], v[4:7]
  buffer_load_dwordx4 a[116:119], v114, s[24:27], s8 offen offset:0 sc1
  v_mfma_f32_16x16x32_bf16 v[4:7], a[252:255], v[184:187], v[4:7]
  v_rcp_f32 v131, v131
  v_mfma_f32_16x16x32_bf16 v[8:11], a[252:255], v[192:195], v[8:11]
  buffer_load_dwordx4 v[220:223], v111, s[24:27], s30 offen offset:1024 sc1
  v_mfma_f32_16x16x32_bf16 v[8:11], a[144:147], v[196:199], v[8:11]
  v_rcp_f32 v132, v132
  v_mfma_f32_16x16x32_bf16 v[12:15], a[144:147], v[204:207], v[12:15]
  v_mul_f32 v90, v90, v129
  v_mul_f32 v91, v91, v130
  v_mfma_f32_16x16x32_bf16 v[12:15], a[252:255], v[200:203], v[12:15]
  v_mul_f32 v92, v92, v131
  v_mul_f32 v93, v93, v132
  v_mfma_f32_16x16x32_bf16 v[16:19], a[128:131], v[176:179], v[16:19]
  buffer_load_dwordx4 v[224:227], v112, s[24:27], s30 offen offset:0 sc1
  v_mfma_f32_16x16x32_bf16 v[16:19], a[148:151], v[180:183], v[16:19]
  v_cvt_pk_bf16_f32 v90, v90, v90
  v_cvt_pk_bf16_f32 v91, v91, v91
  v_mfma_f32_16x16x32_bf16 v[20:23], a[148:151], v[188:191], v[20:23]
  buffer_load_dwordx4 a[120:123], v114, s[24:27], s8 offen offset:1024 sc1
  v_mfma_f32_16x16x32_bf16 v[20:23], a[128:131], v[184:187], v[20:23]
  v_cvt_pk_bf16_f32 v92, v92, v92
  v_cvt_pk_bf16_f32 v93, v93, v93
  v_mfma_f32_16x16x32_bf16 v[24:27], a[128:131], v[192:195], v[24:27]
  buffer_load_dwordx4 v[228:231], v112, s[24:27], s30 offen offset:1024 sc1
  v_mfma_f32_16x16x32_bf16 v[24:27], a[148:151], v[196:199], v[24:27]
  v_lshlrev_b32 v90, 16, v90
  v_lshlrev_b32 v91, 16, v91
  v_mfma_f32_16x16x32_bf16 v[28:31], a[148:151], v[204:207], v[28:31]
  v_lshlrev_b32 v92, 16, v92
  v_lshlrev_b32 v93, 16, v93
  v_mfma_f32_16x16x32_bf16 v[28:31], a[128:131], v[200:203], v[28:31]
  v_cvt_pk_bf16_f32 v160, v160, v160
  v_cvt_pk_bf16_f32 v161, v161, v161
  v_mfma_f32_16x16x32_bf16 v[32:35], a[132:135], v[176:179], v[32:35]
  buffer_load_dwordx4 v[232:235], v113, s[24:27], s30 offen offset:0 sc1
  v_mfma_f32_16x16x32_bf16 v[32:35], a[152:155], v[180:183], v[32:35]
  v_cvt_pk_bf16_f32 v162, v162, v162
  v_cvt_pk_bf16_f32 v163, v163, v163
  v_mfma_f32_16x16x32_bf16 v[36:39], a[152:155], v[188:191], v[36:39]
  buffer_load_dwordx4 a[124:127], v114, s[24:27], s8 offen offset:2048 sc1
  v_mfma_f32_16x16x32_bf16 v[36:39], a[132:135], v[184:187], v[36:39]
  v_lshlrev_b32 v160, 16, v160
  v_lshlrev_b32 v161, 16, v161
  v_mfma_f32_16x16x32_bf16 v[40:43], a[132:135], v[192:195], v[40:43]
  buffer_load_dwordx4 v[236:239], v113, s[24:27], s30 offen offset:1024 sc1
  v_mfma_f32_16x16x32_bf16 v[40:43], a[152:155], v[196:199], v[40:43]
  v_lshlrev_b32 v162, 16, v162
  v_lshlrev_b32 v163, 16, v163
  v_mfma_f32_16x16x32_bf16 v[44:47], a[152:155], v[204:207], v[44:47]
  v_mul_f32 v160, v160, v124
  v_mul_f32 v161, v161, v124
  v_mfma_f32_16x16x32_bf16 v[44:47], a[132:135], v[200:203], v[44:47]
  v_mul_f32 v162, v162, v124
  v_mul_f32 v163, v163, v124
  v_mfma_f32_16x16x32_bf16 v[48:51], a[136:139], v[176:179], v[48:51]
  s_add_u32 s30, s30, 8192
  buffer_load_dwordx4 v[240:243], v110, s[24:27], s30 offen offset:0 sc1
  v_mfma_f32_16x16x32_bf16 v[48:51], a[156:159], v[180:183], v[48:51]
  v_cvt_pk_bf16_f32 v160, v160, v160
  v_cvt_pk_bf16_f32 v161, v161, v161
  v_mfma_f32_16x16x32_bf16 v[52:55], a[156:159], v[188:191], v[52:55]
  buffer_load_dwordx4 a[160:163], v114, s[24:27], s8 offen offset:3072 sc1
  v_mfma_f32_16x16x32_bf16 v[52:55], a[136:139], v[184:187], v[52:55]
  v_cvt_pk_bf16_f32 v162, v162, v162
  v_cvt_pk_bf16_f32 v163, v163, v163
  v_mfma_f32_16x16x32_bf16 v[56:59], a[136:139], v[192:195], v[56:59]
  buffer_load_dwordx4 v[244:247], v110, s[24:27], s30 offen offset:1024 sc1
  v_mfma_f32_16x16x32_bf16 v[56:59], a[156:159], v[196:199], v[56:59]
  v_lshlrev_b32 v160, 16, v160
  v_lshlrev_b32 v161, 16, v161
  v_mfma_f32_16x16x32_bf16 v[60:63], a[156:159], v[204:207], v[60:63]
  v_lshlrev_b32 v162, 16, v162
  v_lshlrev_b32 v163, 16, v163
  v_mfma_f32_16x16x32_bf16 v[60:63], a[136:139], v[200:203], v[60:63]
  v_add_f32 v94, v94, v160
  v_add_f32 v95, v95, v161
  v_mfma_f32_16x16x32_bf16 v[64:67], a[140:143], v[176:179], v[64:67]
  buffer_load_dwordx4 v[248:251], v111, s[24:27], s30 offen offset:0 sc1
  v_mfma_f32_16x16x32_bf16 v[64:67], a[0:3], v[180:183], v[64:67]
  v_add_f32 v96, v96, v162
  v_add_f32 v97, v97, v163
  v_mfma_f32_16x16x32_bf16 v[68:71], a[0:3], v[188:191], v[68:71]
  buffer_load_dwordx4 a[164:167], v115, s[24:27], s8 offen offset:0 sc1
  v_mfma_f32_16x16x32_bf16 v[68:71], a[140:143], v[184:187], v[68:71]
  v_cvt_pk_bf16_f32 v94, v94, v94
  v_cvt_pk_bf16_f32 v95, v95, v95
  v_mfma_f32_16x16x32_bf16 v[72:75], a[140:143], v[192:195], v[72:75]
  buffer_load_dwordx4 v[252:255], v111, s[24:27], s30 offen offset:1024 sc1
  v_mfma_f32_16x16x32_bf16 v[72:75], a[0:3], v[196:199], v[72:75]
  v_cvt_pk_bf16_f32 v96, v96, v96
  v_cvt_pk_bf16_f32 v97, v97, v97
  v_mfma_f32_16x16x32_bf16 v[76:79], a[0:3], v[204:207], v[76:79]
  v_lshlrev_b32 v94, 16, v94
  v_lshlrev_b32 v95, 16, v95
  v_mfma_f32_16x16x32_bf16 v[76:79], a[140:143], v[200:203], v[76:79]
  v_lshlrev_b32 v96, 16, v96
  v_lshlrev_b32 v97, 16, v97
  s_waitcnt vmcnt(6)
  v_mfma_f32_16x16x32_bf16 v[0:3], a[4:7], v[208:211], v[0:3]
  buffer_load_dwordx4 v[136:139], v112, s[24:27], s30 offen offset:0 sc1
  v_mfma_f32_16x16x32_bf16 v[0:3], a[24:27], v[212:215], v[0:3]
  v_mul_f32 v129, 0xbfb8aa3b, v94
  v_mul_f32 v130, 0xbfb8aa3b, v95
  v_mfma_f32_16x16x32_bf16 v[4:7], a[24:27], v[220:223], v[4:7]
  buffer_load_dwordx4 a[168:171], v115, s[24:27], s8 offen offset:1024 sc1
  v_mfma_f32_16x16x32_bf16 v[4:7], a[4:7], v[216:219], v[4:7]
  v_mul_f32 v131, 0xbfb8aa3b, v96
  v_mul_f32 v132, 0xbfb8aa3b, v97
  v_mfma_f32_16x16x32_bf16 v[8:11], a[4:7], v[224:227], v[8:11]
  buffer_load_dwordx4 v[140:143], v112, s[24:27], s30 offen offset:1024 sc1
  v_mfma_f32_16x16x32_bf16 v[8:11], a[24:27], v[228:231], v[8:11]
  v_exp_f32 v129, v129
  v_mfma_f32_16x16x32_bf16 v[12:15], a[24:27], v[236:239], v[12:15]
  v_exp_f32 v130, v130
  v_mfma_f32_16x16x32_bf16 v[12:15], a[4:7], v[232:235], v[12:15]
  v_exp_f32 v131, v131
  v_mfma_f32_16x16x32_bf16 v[16:19], a[8:11], v[208:211], v[16:19]
  buffer_load_dwordx4 v[144:147], v113, s[24:27], s30 offen offset:0 sc1
  v_mfma_f32_16x16x32_bf16 v[16:19], a[28:31], v[212:215], v[16:19]
  v_exp_f32 v132, v132
  v_mfma_f32_16x16x32_bf16 v[20:23], a[28:31], v[220:223], v[20:23]
  buffer_load_dwordx4 a[172:175], v115, s[24:27], s8 offen offset:2048 sc1
  v_mfma_f32_16x16x32_bf16 v[20:23], a[8:11], v[216:219], v[20:23]
  v_add_f32 v129, 1.0, v129
  v_add_f32 v130, 1.0, v130
  v_mfma_f32_16x16x32_bf16 v[24:27], a[8:11], v[224:227], v[24:27]
  buffer_load_dwordx4 v[148:151], v113, s[24:27], s30 offen offset:1024 sc1
  v_mfma_f32_16x16x32_bf16 v[24:27], a[28:31], v[228:231], v[24:27]
  v_add_f32 v131, 1.0, v131
  v_add_f32 v132, 1.0, v132
  v_mfma_f32_16x16x32_bf16 v[28:31], a[28:31], v[236:239], v[28:31]
  v_rcp_f32 v129, v129
  v_mfma_f32_16x16x32_bf16 v[28:31], a[8:11], v[232:235], v[28:31]
  v_rcp_f32 v130, v130
  v_mfma_f32_16x16x32_bf16 v[32:35], a[12:15], v[208:211], v[32:35]
  s_add_u32 s30, s30, 8192
  buffer_load_dwordx4 v[152:155], v110, s[24:27], s30 offen offset:0 sc1
  v_mfma_f32_16x16x32_bf16 v[32:35], a[32:35], v[212:215], v[32:35]
  v_rcp_f32 v131, v131
  v_mfma_f32_16x16x32_bf16 v[36:39], a[32:35], v[220:223], v[36:39]
  buffer_load_dwordx4 a[176:179], v115, s[24:27], s8 offen offset:3072 sc1
  v_mfma_f32_16x16x32_bf16 v[36:39], a[12:15], v[216:219], v[36:39]
  v_rcp_f32 v132, v132
  v_mfma_f32_16x16x32_bf16 v[40:43], a[12:15], v[224:227], v[40:43]
  buffer_load_dwordx4 a[180:183], v110, s[24:27], s30 offen offset:1024 sc1
  v_mfma_f32_16x16x32_bf16 v[40:43], a[32:35], v[228:231], v[40:43]
  v_mul_f32 v94, v94, v129
  v_mul_f32 v95, v95, v130
  v_mfma_f32_16x16x32_bf16 v[44:47], a[32:35], v[236:239], v[44:47]
  v_mul_f32 v96, v96, v131
  v_mul_f32 v97, v97, v132
  v_mfma_f32_16x16x32_bf16 v[44:47], a[12:15], v[232:235], v[44:47]
  v_cvt_pk_bf16_f32 v94, v94, v94
  v_cvt_pk_bf16_f32 v95, v95, v95
  v_mfma_f32_16x16x32_bf16 v[48:51], a[16:19], v[208:211], v[48:51]
  buffer_load_dwordx4 a[184:187], v111, s[24:27], s30 offen offset:0 sc1
  v_mfma_f32_16x16x32_bf16 v[48:51], a[36:39], v[212:215], v[48:51]
  v_cvt_pk_bf16_f32 v96, v96, v96
  v_cvt_pk_bf16_f32 v97, v97, v97
  v_mfma_f32_16x16x32_bf16 v[52:55], a[36:39], v[220:223], v[52:55]
  s_add_u32 m0, s28, 49152
  s_nop 0
  buffer_load_dwordx4 v115, s[24:27], s10 offen offset:0 sc1 lds
  v_mfma_f32_16x16x32_bf16 v[52:55], a[16:19], v[216:219], v[52:55]
  buffer_load_dwordx4 v115, s[24:27], s10 offen offset:1024 sc1 lds
  v_mfma_f32_16x16x32_bf16 v[56:59], a[16:19], v[224:227], v[56:59]
  buffer_load_dwordx4 v115, s[24:27], s10 offen offset:2048 sc1 lds
  v_mfma_f32_16x16x32_bf16 v[56:59], a[36:39], v[228:231], v[56:59]
  buffer_load_dwordx4 v115, s[24:27], s10 offen offset:3072 sc1 lds
  v_mfma_f32_16x16x32_bf16 v[60:63], a[36:39], v[236:239], v[60:63]
  buffer_load_dwordx4 a[188:191], v111, s[24:27], s30 offen offset:1024 sc1
  v_mfma_f32_16x16x32_bf16 v[60:63], a[16:19], v[232:235], v[60:63]
  v_lshlrev_b32 v94, 16, v94
  v_lshlrev_b32 v95, 16, v95
  v_mfma_f32_16x16x32_bf16 v[64:67], a[20:23], v[208:211], v[64:67]
  buffer_load_dwordx4 a[192:195], v112, s[24:27], s30 offen offset:0 sc1
  v_mfma_f32_16x16x32_bf16 v[64:67], a[40:43], v[212:215], v[64:67]
  v_lshlrev_b32 v96, 16, v96
  v_lshlrev_b32 v97, 16, v97
  v_mfma_f32_16x16x32_bf16 v[68:71], a[40:43], v[220:223], v[68:71]
  v_cvt_pk_bf16_f32 v164, v164, v164
  v_cvt_pk_bf16_f32 v165, v165, v165
  v_mfma_f32_16x16x32_bf16 v[68:71], a[20:23], v[216:219], v[68:71]
  v_cvt_pk_bf16_f32 v166, v166, v166
  v_cvt_pk_bf16_f32 v167, v167, v167
  v_mfma_f32_16x16x32_bf16 v[72:75], a[20:23], v[224:227], v[72:75]
  buffer_load_dwordx4 a[196:199], v112, s[24:27], s30 offen offset:1024 sc1
  v_mfma_f32_16x16x32_bf16 v[72:75], a[40:43], v[228:231], v[72:75]
  v_lshlrev_b32 v164, 16, v164
  v_lshlrev_b32 v165, 16, v165
  v_mfma_f32_16x16x32_bf16 v[76:79], a[40:43], v[236:239], v[76:79]
  v_lshlrev_b32 v166, 16, v166
  v_lshlrev_b32 v167, 16, v167
  v_mfma_f32_16x16x32_bf16 v[76:79], a[20:23], v[232:235], v[76:79]
  v_mul_f32 v164, v164, v124
  v_mul_f32 v165, v165, v124
  s_waitcnt vmcnt(11)
  v_mfma_f32_16x16x32_bf16 v[0:3], a[44:47], v[240:243], v[0:3]
  buffer_load_dwordx4 a[200:203], v113, s[24:27], s30 offen offset:0 sc1
  v_mfma_f32_16x16x32_bf16 v[0:3], a[64:67], v[244:247], v[0:3]
  v_mul_f32 v166, v166, v124
  v_mul_f32 v167, v167, v124
  v_mfma_f32_16x16x32_bf16 v[4:7], a[64:67], v[252:255], v[4:7]
  v_cvt_pk_bf16_f32 v164, v164, v164
  v_cvt_pk_bf16_f32 v165, v165, v165
  v_mfma_f32_16x16x32_bf16 v[4:7], a[44:47], v[248:251], v[4:7]
  v_cvt_pk_bf16_f32 v166, v166, v166
  v_cvt_pk_bf16_f32 v167, v167, v167
  v_mfma_f32_16x16x32_bf16 v[8:11], a[44:47], v[136:139], v[8:11]
  buffer_load_dwordx4 a[204:207], v113, s[24:27], s30 offen offset:1024 sc1
  v_mfma_f32_16x16x32_bf16 v[8:11], a[64:67], v[140:143], v[8:11]
  v_lshlrev_b32 v164, 16, v164
  v_lshlrev_b32 v165, 16, v165
  v_mfma_f32_16x16x32_bf16 v[12:15], a[64:67], v[148:151], v[12:15]
  v_lshlrev_b32 v166, 16, v166
  v_lshlrev_b32 v167, 16, v167
  v_mfma_f32_16x16x32_bf16 v[12:15], a[44:47], v[144:147], v[12:15]
  v_add_f32 v98, v98, v164
  v_add_f32 v99, v99, v165
  v_mfma_f32_16x16x32_bf16 v[16:19], a[48:51], v[240:243], v[16:19]
  s_add_u32 s30, s30, 8192
  buffer_load_dwordx4 a[208:211], v110, s[24:27], s30 offen offset:0 sc1
  v_mfma_f32_16x16x32_bf16 v[16:19], a[68:71], v[244:247], v[16:19]
  v_add_f32 v100, v100, v166
  v_add_f32 v101, v101, v167
  v_mfma_f32_16x16x32_bf16 v[20:23], a[68:71], v[252:255], v[20:23]
  v_cvt_pk_bf16_f32 v98, v98, v98
  v_cvt_pk_bf16_f32 v99, v99, v99
  v_mfma_f32_16x16x32_bf16 v[20:23], a[48:51], v[248:251], v[20:23]
  v_cvt_pk_bf16_f32 v100, v100, v100
  v_cvt_pk_bf16_f32 v101, v101, v101
  v_mfma_f32_16x16x32_bf16 v[24:27], a[48:51], v[136:139], v[24:27]
  buffer_load_dwordx4 v[176:179], v110, s[24:27], s30 offen offset:1024 sc1
  v_mfma_f32_16x16x32_bf16 v[24:27], a[68:71], v[140:143], v[24:27]
  v_lshlrev_b32 v98, 16, v98
  v_lshlrev_b32 v99, 16, v99
  v_mfma_f32_16x16x32_bf16 v[28:31], a[68:71], v[148:151], v[28:31]
  v_lshlrev_b32 v100, 16, v100
  v_lshlrev_b32 v101, 16, v101
  v_mfma_f32_16x16x32_bf16 v[28:31], a[48:51], v[144:147], v[28:31]
  v_mul_f32 v129, 0xbfb8aa3b, v98
  v_mul_f32 v130, 0xbfb8aa3b, v99
  v_mfma_f32_16x16x32_bf16 v[32:35], a[52:55], v[240:243], v[32:35]
  buffer_load_dwordx4 v[180:183], v111, s[24:27], s30 offen offset:0 sc1
  v_mfma_f32_16x16x32_bf16 v[32:35], a[72:75], v[244:247], v[32:35]
  v_mul_f32 v131, 0xbfb8aa3b, v100
  v_mul_f32 v132, 0xbfb8aa3b, v101
  v_mfma_f32_16x16x32_bf16 v[36:39], a[72:75], v[252:255], v[36:39]
  v_exp_f32 v129, v129
  v_mfma_f32_16x16x32_bf16 v[36:39], a[52:55], v[248:251], v[36:39]
  v_exp_f32 v130, v130
  v_mfma_f32_16x16x32_bf16 v[40:43], a[52:55], v[136:139], v[40:43]
  buffer_load_dwordx4 v[184:187], v111, s[24:27], s30 offen offset:1024 sc1
  v_mfma_f32_16x16x32_bf16 v[40:43], a[72:75], v[140:143], v[40:43]
  v_exp_f32 v131, v131
  v_mfma_f32_16x16x32_bf16 v[44:47], a[72:75], v[148:151], v[44:47]
  v_exp_f32 v132, v132
  v_mfma_f32_16x16x32_bf16 v[44:47], a[52:55], v[144:147], v[44:47]
  v_add_f32 v129, 1.0, v129
  v_add_f32 v130, 1.0, v130
  v_mfma_f32_16x16x32_bf16 v[48:51], a[56:59], v[240:243], v[48:51]
  buffer_load_dwordx4 v[188:191], v112, s[24:27], s30 offen offset:0 sc1
  v_mfma_f32_16x16x32_bf16 v[48:51], a[76:79], v[244:247], v[48:51]
  v_add_f32 v131, 1.0, v131
  v_add_f32 v132, 1.0, v132
  v_mfma_f32_16x16x32_bf16 v[52:55], a[76:79], v[252:255], v[52:55]
  v_rcp_f32 v129, v129
  v_mfma_f32_16x16x32_bf16 v[52:55], a[56:59], v[248:251], v[52:55]
  v_rcp_f32 v130, v130
  v_mfma_f32_16x16x32_bf16 v[56:59], a[56:59], v[136:139], v[56:59]
  buffer_load_dwordx4 v[192:195], v112, s[24:27], s30 offen offset:1024 sc1
  v_mfma_f32_16x16x32_bf16 v[56:59], a[76:79], v[140:143], v[56:59]
  v_rcp_f32 v131, v131
  v_mfma_f32_16x16x32_bf16 v[60:63], a[76:79], v[148:151], v[60:63]
  v_rcp_f32 v132, v132
  v_mfma_f32_16x16x32_bf16 v[60:63], a[56:59], v[144:147], v[60:63]
  v_mul_f32 v98, v98, v129
  v_mul_f32 v99, v99, v130
  v_mfma_f32_16x16x32_bf16 v[64:67], a[60:63], v[240:243], v[64:67]
  buffer_load_dwordx4 v[196:199], v113, s[24:27], s30 offen offset:0 sc1
  v_mfma_f32_16x16x32_bf16 v[64:67], a[80:83], v[244:247], v[64:67]
  v_mul_f32 v100, v100, v131
  v_mul_f32 v101, v101, v132
  v_mfma_f32_16x16x32_bf16 v[68:71], a[80:83], v[252:255], v[68:71]
  v_cvt_pk_bf16_f32 v98, v98, v98
  v_cvt_pk_bf16_f32 v99, v99, v99
  v_mfma_f32_16x16x32_bf16 v[68:71], a[60:63], v[248:251], v[68:71]
  v_cvt_pk_bf16_f32 v100, v100, v100
  v_cvt_pk_bf16_f32 v101, v101, v101
  v_mfma_f32_16x16x32_bf16 v[72:75], a[60:63], v[136:139], v[72:75]
  buffer_load_dwordx4 v[200:203], v113, s[24:27], s30 offen offset:1024 sc1
  v_mfma_f32_16x16x32_bf16 v[72:75], a[80:83], v[140:143], v[72:75]
  v_lshlrev_b32 v98, 16, v98
  v_lshlrev_b32 v99, 16, v99
  v_mfma_f32_16x16x32_bf16 v[76:79], a[80:83], v[148:151], v[76:79]
  v_lshlrev_b32 v100, 16, v100
  v_lshlrev_b32 v101, 16, v101
  v_mfma_f32_16x16x32_bf16 v[76:79], a[60:63], v[144:147], v[76:79]
  v_cvt_pk_bf16_f32 v168, v168, v168
  v_cvt_pk_bf16_f32 v169, v169, v169
  s_waitcnt vmcnt(8)
  v_mfma_f32_16x16x32_bf16 v[0:3], a[84:87], v[152:155], v[0:3]
  s_add_u32 s30, s30, 8192
  buffer_load_dwordx4 v[204:207], v110, s[24:27], s30 offen offset:0 sc1
  v_mfma_f32_16x16x32_bf16 v[0:3], a[104:107], a[180:183], v[0:3]
  v_cvt_pk_bf16_f32 v170, v170, v170
  v_cvt_pk_bf16_f32 v171, v171, v171
  v_mfma_f32_16x16x32_bf16 v[4:7], a[104:107], a[188:191], v[4:7]
  v_lshlrev_b32 v168, 16, v168
  v_lshlrev_b32 v169, 16, v169
  v_mfma_f32_16x16x32_bf16 v[4:7], a[84:87], a[184:187], v[4:7]
  v_lshlrev_b32 v170, 16, v170
  v_lshlrev_b32 v171, 16, v171
  v_mfma_f32_16x16x32_bf16 v[8:11], a[84:87], a[192:195], v[8:11]
  buffer_load_dwordx4 v[208:211], v110, s[24:27], s30 offen offset:1024 sc1
  v_mfma_f32_16x16x32_bf16 v[8:11], a[104:107], a[196:199], v[8:11]
  v_mul_f32 v168, v168, v124
  v_mul_f32 v169, v169, v124
  v_mfma_f32_16x16x32_bf16 v[12:15], a[104:107], a[204:207], v[12:15]
  v_mul_f32 v170, v170, v124
  v_mul_f32 v171, v171, v124
  v_mfma_f32_16x16x32_bf16 v[12:15], a[84:87], a[200:203], v[12:15]
  v_cvt_pk_bf16_f32 v168, v168, v168
  v_cvt_pk_bf16_f32 v169, v169, v169
  v_mfma_f32_16x16x32_bf16 v[16:19], a[88:91], v[152:155], v[16:19]
  buffer_load_dwordx4 v[212:215], v111, s[24:27], s30 offen offset:0 sc1
  v_mfma_f32_16x16x32_bf16 v[16:19], a[108:111], a[180:183], v[16:19]
  v_cvt_pk_bf16_f32 v170, v170, v170
  v_cvt_pk_bf16_f32 v171, v171, v171
  v_mfma_f32_16x16x32_bf16 v[20:23], a[108:111], a[188:191], v[20:23]
  v_lshlrev_b32 v168, 16, v168
  v_lshlrev_b32 v169, 16, v169
  v_mfma_f32_16x16x32_bf16 v[20:23], a[88:91], a[184:187], v[20:23]
  v_lshlrev_b32 v170, 16, v170
  v_lshlrev_b32 v171, 16, v171
  v_mfma_f32_16x16x32_bf16 v[24:27], a[88:91], a[192:195], v[24:27]
  buffer_load_dwordx4 v[216:219], v111, s[24:27], s30 offen offset:1024 sc1
  v_mfma_f32_16x16x32_bf16 v[24:27], a[108:111], a[196:199], v[24:27]
  v_add_f32 v102, v102, v168
  v_add_f32 v103, v103, v169
  v_mfma_f32_16x16x32_bf16 v[28:31], a[108:111], a[204:207], v[28:31]
  v_add_f32 v104, v104, v170
  v_add_f32 v105, v105, v171
  v_mfma_f32_16x16x32_bf16 v[28:31], a[88:91], a[200:203], v[28:31]
  v_cvt_pk_bf16_f32 v102, v102, v102
  v_cvt_pk_bf16_f32 v103, v103, v103
  v_mfma_f32_16x16x32_bf16 v[32:35], a[92:95], v[152:155], v[32:35]
  buffer_load_dwordx4 v[220:223], v112, s[24:27], s30 offen offset:0 sc1
  v_mfma_f32_16x16x32_bf16 v[32:35], a[112:115], a[180:183], v[32:35]
  v_cvt_pk_bf16_f32 v104, v104, v104
  v_cvt_pk_bf16_f32 v105, v105, v105
  v_mfma_f32_16x16x32_bf16 v[36:39], a[112:115], a[188:191], v[36:39]
  v_lshlrev_b32 v102, 16, v102
  v_lshlrev_b32 v103, 16, v103
  v_mfma_f32_16x16x32_bf16 v[36:39], a[92:95], a[184:187], v[36:39]
  v_lshlrev_b32 v104, 16, v104
  v_lshlrev_b32 v105, 16, v105
  v_mfma_f32_16x16x32_bf16 v[40:43], a[92:95], a[192:195], v[40:43]
  buffer_load_dwordx4 v[224:227], v112, s[24:27], s30 offen offset:1024 sc1
  v_mfma_f32_16x16x32_bf16 v[40:43], a[112:115], a[196:199], v[40:43]
  v_mul_f32 v129, 0xbfb8aa3b, v102
  v_mul_f32 v130, 0xbfb8aa3b, v103
  v_mfma_f32_16x16x32_bf16 v[44:47], a[112:115], a[204:207], v[44:47]
  v_mul_f32 v131, 0xbfb8aa3b, v104
  v_mul_f32 v132, 0xbfb8aa3b, v105
  v_mfma_f32_16x16x32_bf16 v[44:47], a[92:95], a[200:203], v[44:47]
  v_exp_f32 v129, v129
  v_mfma_f32_16x16x32_bf16 v[48:51], a[96:99], v[152:155], v[48:51]
  buffer_load_dwordx4 v[228:231], v113, s[24:27], s30 offen offset:0 sc1
  v_mfma_f32_16x16x32_bf16 v[48:51], a[116:119], a[180:183], v[48:51]
  v_exp_f32 v130, v130
  v_mfma_f32_16x16x32_bf16 v[52:55], a[116:119], a[188:191], v[52:55]
  v_exp_f32 v131, v131
  v_mfma_f32_16x16x32_bf16 v[52:55], a[96:99], a[184:187], v[52:55]
  v_exp_f32 v132, v132
  v_mfma_f32_16x16x32_bf16 v[56:59], a[96:99], a[192:195], v[56:59]
  buffer_load_dwordx4 v[232:235], v113, s[24:27], s30 offen offset:1024 sc1
  v_mfma_f32_16x16x32_bf16 v[56:59], a[116:119], a[196:199], v[56:59]
  v_add_f32 v129, 1.0, v129
  v_add_f32 v130, 1.0, v130
  v_mfma_f32_16x16x32_bf16 v[60:63], a[116:119], a[204:207], v[60:63]
  v_add_f32 v131, 1.0, v131
  v_add_f32 v132, 1.0, v132
  v_mfma_f32_16x16x32_bf16 v[60:63], a[96:99], a[200:203], v[60:63]
  v_rcp_f32 v129, v129
  v_mfma_f32_16x16x32_bf16 v[64:67], a[100:103], v[152:155], v[64:67]
  ds_read_b128 v[236:239], v122 offset:0
  s_add_u32 s30, s30, 8192
  v_rcp_f32 v130, v130
  v_mfma_f32_16x16x32_bf16 v[64:67], a[120:123], a[180:183], v[64:67]
  buffer_load_dwordx4 v[240:243], v110, s[24:27], s30 offen offset:0 sc1
  v_mfma_f32_16x16x32_bf16 v[68:71], a[120:123], a[188:191], v[68:71]
  v_rcp_f32 v131, v131
  v_mfma_f32_16x16x32_bf16 v[68:71], a[100:103], a[184:187], v[68:71]
  v_rcp_f32 v132, v132
  v_mfma_f32_16x16x32_bf16 v[72:75], a[100:103], a[192:195], v[72:75]
  buffer_load_dwordx4 v[244:247], v110, s[24:27], s30 offen offset:1024 sc1
  v_mfma_f32_16x16x32_bf16 v[72:75], a[120:123], a[196:199], v[72:75]
  v_mul_f32 v102, v102, v129
  v_mul_f32 v103, v103, v130
  v_mfma_f32_16x16x32_bf16 v[76:79], a[120:123], a[204:207], v[76:79]
  v_mul_f32 v104, v104, v131
  v_mul_f32 v105, v105, v132
  v_mfma_f32_16x16x32_bf16 v[76:79], a[100:103], a[200:203], v[76:79]
  v_cvt_pk_bf16_f32 v102, v102, v102
  v_cvt_pk_bf16_f32 v103, v103, v103
  s_waitcnt vmcnt(10)
  v_mfma_f32_16x16x32_bf16 v[0:3], a[124:127], a[208:211], v[0:3]
  ds_read_b128 v[248:251], v122 offset:1024
  v_cvt_pk_bf16_f32 v104, v104, v104
  v_mfma_f32_16x16x32_bf16 v[0:3], a[176:179], v[176:179], v[0:3]
  buffer_load_dwordx4 v[252:255], v111, s[24:27], s30 offen offset:0 sc1
  v_mfma_f32_16x16x32_bf16 v[4:7], a[176:179], v[184:187], v[4:7]
  v_cvt_pk_bf16_f32 v105, v105, v105
  v_lshlrev_b32 v102, 16, v102
  v_mfma_f32_16x16x32_bf16 v[4:7], a[124:127], v[180:183], v[4:7]
  v_lshlrev_b32 v103, 16, v103
  v_lshlrev_b32 v104, 16, v104
  v_mfma_f32_16x16x32_bf16 v[8:11], a[124:127], v[188:191], v[8:11]
  buffer_load_dwordx4 v[136:139], v111, s[24:27], s30 offen offset:1024 sc1
  v_mfma_f32_16x16x32_bf16 v[8:11], a[176:179], v[192:195], v[8:11]
  v_lshlrev_b32 v105, 16, v105
  v_cvt_pk_bf16_f32 v172, v172, v172
  v_mfma_f32_16x16x32_bf16 v[12:15], a[176:179], v[200:203], v[12:15]
  v_cvt_pk_bf16_f32 v173, v173, v173
  v_cvt_pk_bf16_f32 v174, v174, v174
  v_mfma_f32_16x16x32_bf16 v[12:15], a[124:127], v[196:199], v[12:15]
  v_cvt_pk_bf16_f32 v175, v175, v175
  v_lshlrev_b32 v172, 16, v172
  s_waitcnt lgkmcnt(1)
  v_mfma_f32_16x16x32_bf16 v[16:19], a[160:163], a[208:211], v[16:19]
  ds_read_b128 v[140:143], v122 offset:2048
  v_lshlrev_b32 v173, 16, v173
  v_mfma_f32_16x16x32_bf16 v[16:19], v[236:239], v[176:179], v[16:19]
  buffer_load_dwordx4 v[144:147], v112, s[24:27], s30 offen offset:0 sc1
  v_mfma_f32_16x16x32_bf16 v[20:23], v[236:239], v[184:187], v[20:23]
  v_lshlrev_b32 v174, 16, v174
  v_lshlrev_b32 v175, 16, v175
  v_mfma_f32_16x16x32_bf16 v[20:23], a[160:163], v[180:183], v[20:23]
  v_mul_f32 v172, v172, v124
  v_mul_f32 v173, v173, v124
  v_mfma_f32_16x16x32_bf16 v[24:27], a[160:163], v[188:191], v[24:27]
  buffer_load_dwordx4 v[148:151], v112, s[24:27], s30 offen offset:1024 sc1
  v_mfma_f32_16x16x32_bf16 v[24:27], v[236:239], v[192:195], v[24:27]
  v_mul_f32 v174, v174, v124
  v_mul_f32 v175, v175, v124
  v_mfma_f32_16x16x32_bf16 v[28:31], v[236:239], v[200:203], v[28:31]
  v_cvt_pk_bf16_f32 v172, v172, v172
  v_cvt_pk_bf16_f32 v173, v173, v173
  v_mfma_f32_16x16x32_bf16 v[28:31], a[160:163], v[196:199], v[28:31]
  v_cvt_pk_bf16_f32 v174, v174, v174
  v_cvt_pk_bf16_f32 v175, v175, v175
  s_waitcnt lgkmcnt(1)
  v_mfma_f32_16x16x32_bf16 v[32:35], a[164:167], a[208:211], v[32:35]
  ds_read_b128 v[152:155], v122 offset:3072
  v_lshlrev_b32 v172, 16, v172
  v_mfma_f32_16x16x32_bf16 v[32:35], v[248:251], v[176:179], v[32:35]
  buffer_load_dwordx4 a[180:183], v113, s[24:27], s30 offen offset:0 sc1
  v_mfma_f32_16x16x32_bf16 v[36:39], v[248:251], v[184:187], v[36:39]
  v_lshlrev_b32 v173, 16, v173
  v_lshlrev_b32 v174, 16, v174
  v_mfma_f32_16x16x32_bf16 v[36:39], a[164:167], v[180:183], v[36:39]
  v_lshlrev_b32 v175, 16, v175
  v_add_f32 v106, v106, v172
  v_mfma_f32_16x16x32_bf16 v[40:43], a[164:167], v[188:191], v[40:43]
  buffer_load_dwordx4 a[184:187], v113, s[24:27], s30 offen offset:1024 sc1
  v_mfma_f32_16x16x32_bf16 v[40:43], v[248:251], v[192:195], v[40:43]
  v_add_f32 v107, v107, v173
  v_add_f32 v108, v108, v174
  v_mfma_f32_16x16x32_bf16 v[44:47], v[248:251], v[200:203], v[44:47]
  v_add_f32 v109, v109, v175
  v_cvt_pk_bf16_f32 v106, v106, v106
  v_mfma_f32_16x16x32_bf16 v[44:47], a[164:167], v[196:199], v[44:47]
  v_cvt_pk_bf16_f32 v107, v107, v107
  v_cvt_pk_bf16_f32 v108, v108, v108
  s_waitcnt lgkmcnt(1)
  v_mfma_f32_16x16x32_bf16 v[48:51], a[168:171], a[208:211], v[48:51]
  ds_read_b128 a[188:191], v122 offset:16384
  ds_read_b128 a[192:195], v122 offset:33792
  s_mov_b32 s30, s37
  v_mfma_f32_16x16x32_bf16 v[48:51], v[140:143], v[176:179], v[48:51]
  buffer_load_dwordx4 a[196:199], v110, s[24:27], s30 offen offset:0 sc1
  v_mfma_f32_16x16x32_bf16 v[52:55], v[140:143], v[184:187], v[52:55]
  v_cvt_pk_bf16_f32 v109, v109, v109
  v_lshlrev_b32 v106, 16, v106
  v_mfma_f32_16x16x32_bf16 v[52:55], a[168:171], v[180:183], v[52:55]
  v_lshlrev_b32 v107, 16, v107
  v_lshlrev_b32 v108, 16, v108
  v_mfma_f32_16x16x32_bf16 v[56:59], a[168:171], v[188:191], v[56:59]
  buffer_load_dwordx4 a[200:203], v110, s[24:27], s30 offen offset:1024 sc1
  v_mfma_f32_16x16x32_bf16 v[56:59], v[140:143], v[192:195], v[56:59]
  v_lshlrev_b32 v109, 16, v109
  v_mul_f32 v129, 0xbfb8aa3b, v106
  v_mfma_f32_16x16x32_bf16 v[60:63], v[140:143], v[200:203], v[60:63]
  v_mul_f32 v130, 0xbfb8aa3b, v107
  v_mul_f32 v131, 0xbfb8aa3b, v108
  v_mfma_f32_16x16x32_bf16 v[60:63], a[168:171], v[196:199], v[60:63]
  v_mul_f32 v132, 0xbfb8aa3b, v109
  v_exp_f32 v129, v129
  s_waitcnt lgkmcnt(2)
  v_mfma_f32_16x16x32_bf16 v[64:67], a[172:175], a[208:211], v[64:67]
  ds_read_b128 a[204:207], v122 offset:17408
  ds_read_b128 v[236:239], v122 offset:34816
  v_mfma_f32_16x16x32_bf16 v[64:67], v[152:155], v[176:179], v[64:67]
  v_exp_f32 v130, v130
  v_mfma_f32_16x16x32_bf16 v[68:71], v[152:155], v[184:187], v[68:71]
  v_exp_f32 v131, v131
  v_mfma_f32_16x16x32_bf16 v[68:71], a[172:175], v[180:183], v[68:71]
  v_exp_f32 v132, v132
  v_mfma_f32_16x16x32_bf16 v[72:75], a[172:175], v[188:191], v[72:75]
  v_add_f32 v129, 1.0, v129
  v_add_f32 v130, 1.0, v130
  v_mfma_f32_16x16x32_bf16 v[72:75], v[152:155], v[192:195], v[72:75]
  v_add_f32 v131, 1.0, v131
  v_add_f32 v132, 1.0, v132
  v_mfma_f32_16x16x32_bf16 v[76:79], v[152:155], v[200:203], v[76:79]
  v_rcp_f32 v129, v129
  v_mfma_f32_16x16x32_bf16 v[76:79], a[172:175], v[196:199], v[76:79]
  v_rcp_f32 v130, v130
  s_waitcnt vmcnt(10) lgkmcnt(2)
  v_mfma_f32_16x16x32_bf16 v[0:3], a[188:191], v[204:207], v[0:3]
  ds_read_b128 v[248:251], v122 offset:18432
  ds_read_b128 v[140:143], v122 offset:35840
  v_mfma_f32_16x16x32_bf16 v[0:3], a[192:195], v[208:211], v[0:3]
  buffer_load_dwordx4 v[152:155], v111, s[24:27], s30 offen offset:0 sc1
  v_mfma_f32_16x16x32_bf16 v[4:7], a[192:195], v[216:219], v[4:7]
  v_rcp_f32 v131, v131
  v_mfma_f32_16x16x32_bf16 v[4:7], a[188:191], v[212:215], v[4:7]
  v_rcp_f32 v132, v132
  v_mfma_f32_16x16x32_bf16 v[8:11], a[188:191], v[220:223], v[8:11]
  buffer_load_dwordx4 a[208:211], v111, s[24:27], s30 offen offset:1024 sc1
  v_mfma_f32_16x16x32_bf16 v[8:11], a[192:195], v[224:227], v[8:11]
  v_mul_f32 v106, v106, v129
  v_mul_f32 v107, v107, v130
  v_mfma_f32_16x16x32_bf16 v[12:15], a[192:195], v[232:235], v[12:15]
  v_mul_f32 v108, v108, v131
  v_mul_f32 v109, v109, v132
  v_mfma_f32_16x16x32_bf16 v[12:15], a[188:191], v[228:231], v[12:15]
  v_cvt_pk_bf16_f32 v106, v106, v106
  v_cvt_pk_bf16_f32 v107, v107, v107
  s_waitcnt lgkmcnt(2)
  v_mfma_f32_16x16x32_bf16 v[16:19], a[204:207], v[204:207], v[16:19]
  ds_read_b128 v[176:179], v122 offset:19456
  ds_read_b128 v[180:183], v135 offset:0
  v_mfma_f32_16x16x32_bf16 v[16:19], v[236:239], v[208:211], v[16:19]
  buffer_load_dwordx4 v[184:187], v112, s[24:27], s30 offen offset:0 sc1
  v_mfma_f32_16x16x32_bf16 v[20:23], v[236:239], v[216:219], v[20:23]
  v_cvt_pk_bf16_f32 v108, v108, v108
  v_cvt_pk_bf16_f32 v109, v109, v109
  v_mfma_f32_16x16x32_bf16 v[20:23], a[204:207], v[212:215], v[20:23]
  v_lshlrev_b32 v106, 16, v106
  v_lshlrev_b32 v107, 16, v107
  v_mfma_f32_16x16x32_bf16 v[24:27], a[204:207], v[220:223], v[24:27]
  buffer_load_dwordx4 v[188:191], v112, s[24:27], s30 offen offset:1024 sc1
  v_mfma_f32_16x16x32_bf16 v[24:27], v[236:239], v[224:227], v[24:27]
  v_lshlrev_b32 v108, 16, v108
  v_lshlrev_b32 v109, 16, v109
  v_mfma_f32_16x16x32_bf16 v[28:31], v[236:239], v[232:235], v[28:31]
  v_lshlrev_b32 v156, 16, v80
  v_and_b32 v157, s34, v80
  v_mfma_f32_16x16x32_bf16 v[28:31], a[204:207], v[228:231], v[28:31]
  v_lshlrev_b32 v158, 16, v81
  v_and_b32 v159, s34, v81
  s_waitcnt lgkmcnt(2)
  v_mfma_f32_16x16x32_bf16 v[32:35], v[248:251], v[204:207], v[32:35]
  ds_read_b128 v[192:195], v122 offset:32768
  ds_read_b128 v[196:199], v135 offset:1024
  v_mfma_f32_16x16x32_bf16 v[32:35], v[140:143], v[208:211], v[32:35]
  buffer_load_dwordx4 v[200:203], v113, s[24:27], s30 offen offset:0 sc1
  v_mfma_f32_16x16x32_bf16 v[36:39], v[140:143], v[216:219], v[36:39]
  v_lshlrev_b32 v160, 16, v82
  v_and_b32 v161, s34, v82
  v_mfma_f32_16x16x32_bf16 v[36:39], v[248:251], v[212:215], v[36:39]
  v_lshlrev_b32 v162, 16, v83
  v_and_b32 v163, s34, v83
  v_mfma_f32_16x16x32_bf16 v[40:43], v[248:251], v[220:223], v[40:43]
  buffer_load_dwordx4 a[188:191], v113, s[24:27], s30 offen offset:1024 sc1
  v_mfma_f32_16x16x32_bf16 v[40:43], v[140:143], v[224:227], v[40:43]
  v_lshlrev_b32 v164, 16, v84
  v_and_b32 v165, s34, v84
  v_mfma_f32_16x16x32_bf16 v[44:47], v[140:143], v[232:235], v[44:47]
  v_lshlrev_b32 v166, 16, v85
  v_and_b32 v167, s34, v85
  v_mfma_f32_16x16x32_bf16 v[44:47], v[248:251], v[228:231], v[44:47]
  v_lshlrev_b32 v168, 16, v86
  v_and_b32 v169, s34, v86
  s_waitcnt lgkmcnt(2)
  v_mfma_f32_16x16x32_bf16 v[48:51], v[176:179], v[204:207], v[48:51]
  ds_read_b128 a[192:195], v135 offset:2048
  ds_read_b128 a[204:207], v135 offset:19456
  s_add_u32 s30, s30, 8192
  v_mfma_f32_16x16x32_bf16 v[48:51], v[180:183], v[208:211], v[48:51]
  buffer_load_dwordx4 v[236:239], v110, s[24:27], s30 offen offset:0 sc1
  v_mfma_f32_16x16x32_bf16 v[52:55], v[180:183], v[216:219], v[52:55]
  v_lshlrev_b32 v170, 16, v87
  v_and_b32 v171, s34, v87
  v_mfma_f32_16x16x32_bf16 v[52:55], v[176:179], v[212:215], v[52:55]
  v_lshlrev_b32 v172, 16, v88
  v_and_b32 v173, s34, v88
  v_mfma_f32_16x16x32_bf16 v[56:59], v[176:179], v[220:223], v[56:59]
  v_lshlrev_b32 v174, 16, v89
  v_and_b32 v175, s34, v89
  v_mfma_f32_16x16x32_bf16 v[56:59], v[180:183], v[224:227], v[56:59]
  s_sub_u32 s41, s3, 1
  s_and_b32 s41, s41, 3
  s_lshl_b32 s41, s41, 12
  v_add_u32 v80, s41, v114
  v_mfma_f32_16x16x32_bf16 v[60:63], v[180:183], v[232:235], v[60:63]
  s_sub_u32 s41, s3, 2
  s_and_b32 s41, s41, 3
  s_lshl_b32 s41, s41, 12
  v_add_u32 v81, s41, v114
  v_mfma_f32_16x16x32_bf16 v[60:63], v[176:179], v[228:231], v[60:63]
  s_sub_u32 s41, s3, 3
  s_and_b32 s41, s41, 3
  s_lshl_b32 s41, s41, 12
  v_add_u32 v82, s41, v114
  v_bfe_u32 v129, v114, 8, 1
  s_waitcnt lgkmcnt(2)
  v_mfma_f32_16x16x32_bf16 v[64:67], v[192:195], v[204:207], v[64:67]
  ds_read_b128 v[248:251], v135 offset:3072
  ds_read_b128 v[140:143], v122 offset:49152
  v_mfma_f32_16x16x32_bf16 v[64:67], v[196:199], v[208:211], v[64:67]
  v_mul_u32_u24 v129, 24, v129
  v_add_u32 v83, v117, v129
  v_mfma_f32_16x16x32_bf16 v[68:71], v[196:199], v[216:219], v[68:71]
  v_mfma_f32_16x16x32_bf16 v[68:71], v[192:195], v[212:215], v[68:71]
  v_mfma_f32_16x16x32_bf16 v[72:75], v[192:195], v[220:223], v[72:75]
  v_mfma_f32_16x16x32_bf16 v[72:75], v[196:199], v[224:227], v[72:75]
  v_mfma_f32_16x16x32_bf16 v[76:79], v[196:199], v[232:235], v[76:79]
  v_mfma_f32_16x16x32_bf16 v[76:79], v[192:195], v[228:231], v[76:79]
  s_waitcnt vmcnt(9) lgkmcnt(2)
  v_mfma_f32_16x16x32_bf16 v[0:3], a[192:195], v[240:243], v[0:3]
  ds_read_b128 v[176:179], v135 offset:16384
  ds_read_b128 v[180:183], v122 offset:50176
  s_xor_b32 s38, s40, 1
  v_mfma_f32_16x16x32_bf16 v[0:3], a[204:207], v[244:247], v[0:3]
  buffer_load_dwordx4 v[192:195], v110, s[24:27], s30 offen offset:1024 sc1
  s_lshl_b32 s38, s38, 2
  s_add_u32 s38, s38, s3
  s_lshl_b32 s38, s38, 13
  v_mfma_f32_16x16x32_bf16 v[4:7], a[204:207], v[136:139], v[4:7]
  s_add_u32 s38, s38, 25165824
  s_add_u32 s39, s38, 4096
  v_lshrrev_b32 v125, 1, v114
  v_mfma_f32_16x16x32_bf16 v[4:7], a[192:195], v[252:255], v[4:7]
  v_mfma_f32_16x16x32_bf16 v[8:11], a[192:195], v[144:147], v[8:11]
  buffer_load_dwordx4 v[196:199], v111, s[24:27], s30 offen offset:0 sc1
  v_mfma_f32_16x16x32_bf16 v[8:11], a[204:207], v[148:151], v[8:11]
  v_mfma_f32_16x16x32_bf16 v[12:15], a[204:207], a[184:187], v[12:15]
  v_mfma_f32_16x16x32_bf16 v[12:15], a[192:195], a[180:183], v[12:15]
  s_waitcnt lgkmcnt(2)
  v_mfma_f32_16x16x32_bf16 v[16:19], v[248:251], v[240:243], v[16:19]
  ds_read_b128 v[204:207], v135 offset:17408
  ds_read_b128 v[208:211], v122 offset:51200
  v_mfma_f32_16x16x32_bf16 v[16:19], v[140:143], v[244:247], v[16:19]
  buffer_load_dwordx4 v[212:215], v111, s[24:27], s30 offen offset:1024 sc1
  v_mfma_f32_16x16x32_bf16 v[20:23], v[140:143], v[136:139], v[20:23]
  ds_write_b128 v118, v[4:7] offset:0
  ds_write_b128 v118, v[8:11] offset:5120
  v_mfma_f32_16x16x32_bf16 v[20:23], v[248:251], v[252:255], v[20:23]
  ds_write_b128 v118, v[12:15] offset:10240
  v_mfma_f32_16x16x32_bf16 v[24:27], v[248:251], v[144:147], v[24:27]
  buffer_load_dwordx4 v[216:219], v112, s[24:27], s30 offen offset:0 sc1
  v_mfma_f32_16x16x32_bf16 v[24:27], v[140:143], v[148:151], v[24:27]
  v_mfma_f32_16x16x32_bf16 v[28:31], v[140:143], a[184:187], v[28:31]
  v_mfma_f32_16x16x32_bf16 v[28:31], v[248:251], a[180:183], v[28:31]
  s_waitcnt lgkmcnt(5)
  v_mfma_f32_16x16x32_bf16 v[32:35], v[176:179], v[240:243], v[32:35]
  ds_read_b128 v[220:223], v135 offset:18432
  ds_read_b128 v[224:227], v122 offset:52224
  v_mfma_f32_16x16x32_bf16 v[32:35], v[180:183], v[244:247], v[32:35]
  buffer_load_dwordx4 v[228:231], v112, s[24:27], s30 offen offset:1024 sc1
  v_mfma_f32_16x16x32_bf16 v[36:39], v[180:183], v[136:139], v[36:39]
  ds_write_b128 v118, v[20:23] offset:1024
  ds_write_b128 v118, v[24:27] offset:6144
  v_mfma_f32_16x16x32_bf16 v[36:39], v[176:179], v[252:255], v[36:39]
  ds_write_b128 v118, v[28:31] offset:11264
  v_mfma_f32_16x16x32_bf16 v[40:43], v[176:179], v[144:147], v[40:43]
  buffer_load_dwordx4 v[232:235], v113, s[24:27], s30 offen offset:0 sc1
  v_mfma_f32_16x16x32_bf16 v[40:43], v[180:183], v[148:151], v[40:43]
  v_mfma_f32_16x16x32_bf16 v[44:47], v[180:183], a[184:187], v[44:47]
  v_mfma_f32_16x16x32_bf16 v[44:47], v[176:179], a[180:183], v[44:47]
  s_waitcnt lgkmcnt(8)
  v_mfma_f32_16x16x32_bf16 v[48:51], v[204:207], v[240:243], v[48:51]
  buffer_load_dwordx4 a[192:195], v113, s[24:27], s30 offen offset:1024 sc1
  v_mfma_f32_16x16x32_bf16 v[48:51], v[208:211], v[244:247], v[48:51]
  ds_write_b128 v118, v[36:39] offset:2048
  v_mfma_f32_16x16x32_bf16 v[52:55], v[208:211], v[136:139], v[52:55]
  ds_write_b128 v118, v[40:43] offset:7168
  v_mfma_f32_16x16x32_bf16 v[52:55], v[204:207], v[252:255], v[52:55]
  ds_write_b128 v118, v[44:47] offset:12288
  v_mfma_f32_16x16x32_bf16 v[56:59], v[204:207], v[144:147], v[56:59]
  s_add_u32 s30, s30, 8192
  buffer_load_dwordx4 a[204:207], v110, s[24:27], s30 offen offset:0 sc1
  v_mfma_f32_16x16x32_bf16 v[56:59], v[208:211], v[148:151], v[56:59]
  v_mfma_f32_16x16x32_bf16 v[60:63], v[208:211], a[184:187], v[60:63]
  v_mfma_f32_16x16x32_bf16 v[60:63], v[204:207], a[180:183], v[60:63]
  s_waitcnt lgkmcnt(6)
  v_mfma_f32_16x16x32_bf16 v[64:67], v[220:223], v[240:243], v[64:67]
  buffer_load_dwordx4 v[248:251], v110, s[24:27], s30 offen offset:1024 sc1
  v_mfma_f32_16x16x32_bf16 v[64:67], v[224:227], v[244:247], v[64:67]
  ds_write_b128 v118, v[52:55] offset:3072
  v_mfma_f32_16x16x32_bf16 v[68:71], v[224:227], v[136:139], v[68:71]
  ds_write_b128 v118, v[56:59] offset:8192
  v_mfma_f32_16x16x32_bf16 v[68:71], v[220:223], v[252:255], v[68:71]
  ds_write_b128 v118, v[60:63] offset:13312
  v_mfma_f32_16x16x32_bf16 v[72:75], v[220:223], v[144:147], v[72:75]
  buffer_load_dwordx4 v[140:143], v111, s[24:27], s30 offen offset:0 sc1
  v_mfma_f32_16x16x32_bf16 v[72:75], v[224:227], v[148:151], v[72:75]
  v_mfma_f32_16x16x32_bf16 v[76:79], v[224:227], a[184:187], v[76:79]
  v_mfma_f32_16x16x32_bf16 v[76:79], v[220:223], a[180:183], v[76:79]
  s_nop 1
  ds_write_b128 v118, v[68:71] offset:4096
  s_nop 2
  ds_write_b128 v118, v[72:75] offset:9216
  s_nop 0
  ds_write_b128 v118, v[76:79] offset:14336
  buffer_load_dwordx4 v[176:179], v111, s[24:27], s30 offen offset:1024 sc1
  buffer_load_dwordx4 v[180:183], v112, s[24:27], s30 offen offset:0 sc1
  buffer_load_dwordx4 v[204:207], v112, s[24:27], s30 offen offset:1024 sc1
  buffer_load_dwordx4 v[208:211], v113, s[24:27], s30 offen offset:0 sc1
  buffer_load_dwordx4 v[220:223], v113, s[24:27], s30 offen offset:1024 sc1
  s_add_u32 s30, s30, 8192
  buffer_load_dwordx4 v[224:227], v110, s[24:27], s30 offen offset:0 sc1
  buffer_load_dwordx4 v[240:243], v110, s[24:27], s30 offen offset:1024 sc1
  buffer_load_dwordx4 v[244:247], v111, s[24:27], s30 offen offset:0 sc1
  buffer_load_dwordx4 v[252:255], v111, s[24:27], s30 offen offset:1024 sc1
  buffer_load_dwordx4 v[136:139], v112, s[24:27], s30 offen offset:0 sc1
  buffer_load_dwordx4 v[144:147], v112, s[24:27], s30 offen offset:1024 sc1
  buffer_load_dwordx4 v[148:151], v113, s[24:27], s30 offen offset:0 sc1
  buffer_load_dwordx4 a[180:183], v113, s[24:27], s30 offen offset:1024 sc1
  s_add_u32 s30, s30, 8192
  buffer_load_dwordx4 a[184:187], v110, s[24:27], s30 offen offset:0 sc1
  s_waitcnt lgkmcnt(0)
  s_barrier
  ds_read_b128 v[4:7], v119 offset:0
  ds_read_b128 v[8:11], v120 offset:5120
  ds_read_b128 v[12:15], v121 offset:10240
  ds_read_b128 v[20:23], v119 offset:1024
  ds_read_b128 v[24:27], v120 offset:6144
  ds_read_b128 v[28:31], v121 offset:11264
  ds_read_b128 v[36:39], v119 offset:2048
  ds_read_b128 v[40:43], v120 offset:7168
  ds_read_b128 v[44:47], v121 offset:12288
  ds_read_b128 v[52:55], v119 offset:3072
  ds_read_b128 v[56:59], v120 offset:8192
  ds_read_b128 v[60:63], v121 offset:13312
  ds_read_b128 v[68:71], v119 offset:4096
  ds_read_b128 v[72:75], v120 offset:9216
  ds_read_b128 v[76:79], v121 offset:14336
  s_waitcnt lgkmcnt(12)
  v_add_f32 v4, v4, v8
  v_add_f32 v5, v5, v9
  v_add_f32 v6, v6, v10
  v_add_f32 v7, v7, v11
  v_add_f32 v0, v0, v12
  v_add_f32 v1, v1, v13
  v_add_f32 v2, v2, v14
  v_add_f32 v3, v3, v15
  v_add_f32 v0, v0, v4
  v_add_f32 v1, v1, v5
  v_add_f32 v2, v2, v6
  v_add_f32 v3, v3, v7
  v_cvt_pk_bf16_f32 v4, v0, v1
  v_cvt_pk_bf16_f32 v5, v2, v3
  buffer_store_dwordx2 v[4:5], v125, s[24:27], s38 offen offset:0 sc1
  s_waitcnt vmcnt(26)
  v_mfma_f32_16x16x32_bf16 v[0:3], a[212:215], a[196:199], 0
  s_waitcnt lgkmcnt(9)
  v_add_f32 v20, v20, v24
  v_add_f32 v21, v21, v25
  v_mfma_f32_16x16x32_bf16 v[0:3], a[232:235], a[200:203], v[0:3]
  v_add_f32 v22, v22, v26
  v_add_f32 v23, v23, v27
  v_mfma_f32_16x16x32_bf16 v[4:7], a[232:235], a[208:211], 0
  v_add_f32 v16, v16, v28
  v_add_f32 v17, v17, v29
  v_mfma_f32_16x16x32_bf16 v[4:7], a[212:215], v[152:155], v[4:7]
  v_add_f32 v18, v18, v30
  v_add_f32 v19, v19, v31
  v_mfma_f32_16x16x32_bf16 v[8:11], a[212:215], v[184:187], 0
  v_add_f32 v16, v16, v20
  v_add_f32 v17, v17, v21
  v_mfma_f32_16x16x32_bf16 v[8:11], a[232:235], v[188:191], v[8:11]
  v_add_f32 v18, v18, v22
  v_add_f32 v19, v19, v23
  v_mfma_f32_16x16x32_bf16 v[12:15], a[232:235], a[188:191], 0
  v_cvt_pk_bf16_f32 v20, v16, v17
  v_cvt_pk_bf16_f32 v21, v18, v19
  v_mfma_f32_16x16x32_bf16 v[12:15], a[212:215], v[200:203], v[12:15]
  buffer_store_dwordx2 v[20:21], v125, s[24:27], s38 offen offset:512 sc1
  s_waitcnt lgkmcnt(6)
  v_mfma_f32_16x16x32_bf16 v[16:19], a[216:219], a[196:199], 0
  buffer_load_dwordx4 a[212:215], v110, s[24:27], s30 offen offset:1024 sc1
  v_mfma_f32_16x16x32_bf16 v[16:19], a[236:239], a[200:203], v[16:19]
  v_add_f32 v36, v36, v40
  v_add_f32 v37, v37, v41
  v_mfma_f32_16x16x32_bf16 v[20:23], a[236:239], a[208:211], 0
  v_add_f32 v38, v38, v42
  v_add_f32 v39, v39, v43
  v_mfma_f32_16x16x32_bf16 v[20:23], a[216:219], v[152:155], v[20:23]
  v_add_f32 v32, v32, v44
  v_add_f32 v33, v33, v45
  v_mfma_f32_16x16x32_bf16 v[24:27], a[216:219], v[184:187], 0
  buffer_load_dwordx4 a[232:235], v111, s[24:27], s30 offen offset:0 sc1
  v_mfma_f32_16x16x32_bf16 v[24:27], a[236:239], v[188:191], v[24:27]
  v_add_f32 v34, v34, v46
  v_add_f32 v35, v35, v47
  v_mfma_f32_16x16x32_bf16 v[28:31], a[236:239], a[188:191], 0
  v_add_f32 v32, v32, v36
  v_add_f32 v33, v33, v37
  v_mfma_f32_16x16x32_bf16 v[28:31], a[216:219], v[200:203], v[28:31]
  v_add_f32 v34, v34, v38
  v_add_f32 v35, v35, v39
  v_cvt_pk_bf16_f32 v36, v32, v33
  v_cvt_pk_bf16_f32 v37, v34, v35
  buffer_store_dwordx2 v[36:37], v125, s[24:27], s38 offen offset:1024 sc1
  v_mfma_f32_16x16x32_bf16 v[32:35], a[220:223], a[196:199], 0
  buffer_load_dwordx4 a[216:219], v111, s[24:27], s30 offen offset:1024 sc1
  s_waitcnt lgkmcnt(3)
  v_mfma_f32_16x16x32_bf16 v[32:35], a[240:243], a[200:203], v[32:35]
  v_add_f32 v52, v52, v56
  v_add_f32 v53, v53, v57
  v_mfma_f32_16x16x32_bf16 v[36:39], a[240:243], a[208:211], 0
  v_add_f32 v54, v54, v58
  v_add_f32 v55, v55, v59
  v_mfma_f32_16x16x32_bf16 v[36:39], a[220:223], v[152:155], v[36:39]
  v_add_f32 v48, v48, v60
  v_add_f32 v49, v49, v61
  v_mfma_f32_16x16x32_bf16 v[40:43], a[220:223], v[184:187], 0
  buffer_load_dwordx4 a[236:239], v112, s[24:27], s30 offen offset:0 sc1
  v_mfma_f32_16x16x32_bf16 v[40:43], a[240:243], v[188:191], v[40:43]
  v_add_f32 v50, v50, v62
  v_add_f32 v51, v51, v63
  v_mfma_f32_16x16x32_bf16 v[44:47], a[240:243], a[188:191], 0
  v_add_f32 v48, v48, v52
  v_add_f32 v49, v49, v53
  v_mfma_f32_16x16x32_bf16 v[44:47], a[220:223], v[200:203], v[44:47]
  v_add_f32 v50, v50, v54
  v_add_f32 v51, v51, v55
  v_cvt_pk_bf16_f32 v52, v48, v49
  v_cvt_pk_bf16_f32 v53, v50, v51
  buffer_store_dwordx2 v[52:53], v125, s[24:27], s38 offen offset:1536 sc1
  v_mfma_f32_16x16x32_bf16 v[48:51], a[224:227], a[196:199], 0
  buffer_load_dwordx4 a[220:223], v112, s[24:27], s30 offen offset:1024 sc1
  s_waitcnt lgkmcnt(0)
  v_mfma_f32_16x16x32_bf16 v[48:51], a[244:247], a[200:203], v[48:51]
  v_add_f32 v68, v68, v72
  v_add_f32 v69, v69, v73
  v_mfma_f32_16x16x32_bf16 v[52:55], a[244:247], a[208:211], 0
  v_add_f32 v70, v70, v74
  v_add_f32 v71, v71, v75
  v_mfma_f32_16x16x32_bf16 v[52:55], a[224:227], v[152:155], v[52:55]
  v_add_f32 v64, v64, v76
  v_add_f32 v65, v65, v77
  v_mfma_f32_16x16x32_bf16 v[56:59], a[224:227], v[184:187], 0
  buffer_load_dwordx4 a[240:243], v113, s[24:27], s30 offen offset:0 sc1
  v_mfma_f32_16x16x32_bf16 v[56:59], a[244:247], v[188:191], v[56:59]
  v_add_f32 v66, v66, v78
  v_add_f32 v67, v67, v79
  v_mfma_f32_16x16x32_bf16 v[60:63], a[244:247], a[188:191], 0
  v_add_f32 v64, v64, v68
  v_add_f32 v65, v65, v69
  v_mfma_f32_16x16x32_bf16 v[60:63], a[224:227], v[200:203], v[60:63]
  v_add_f32 v66, v66, v70
  v_add_f32 v67, v67, v71
  v_cvt_pk_bf16_f32 v68, v64, v65
  v_cvt_pk_bf16_f32 v69, v66, v67
  buffer_store_dwordx2 v[68:69], v125, s[24:27], s38 offen offset:2048 sc1
  v_mfma_f32_16x16x32_bf16 v[64:67], a[228:231], a[196:199], 0
  buffer_load_dwordx4 a[224:227], v113, s[24:27], s30 offen offset:1024 sc1
  s_xor_b32 s38, s40, 1
  s_lshl_b32 s38, s38, 7
  s_add_u32 s38, s38, 2834432
  v_mfma_f32_16x16x32_bf16 v[64:67], a[248:251], a[200:203], v[64:67]
  v_mov_b32 v126, 1073741824
  v_writelane_b32 v126, s38, 0
  v_mfma_f32_16x16x32_bf16 v[68:71], a[248:251], a[208:211], 0
  v_mov_b32 v127, 1
  v_mfma_f32_16x16x32_bf16 v[68:71], a[228:231], v[152:155], v[68:71]
  s_xor_b32 s38, s38, 128
  v_mov_b32 v133, s38
  v_mov_b32 v134, 4
  v_mfma_f32_16x16x32_bf16 v[72:75], a[228:231], v[184:187], 0
  s_add_u32 s30, s30, 8192
  buffer_load_dwordx4 a[244:247], v110, s[24:27], s30 offen offset:0 sc1
  v_mfma_f32_16x16x32_bf16 v[72:75], a[248:251], v[188:191], v[72:75]
  v_mfma_f32_16x16x32_bf16 v[76:79], a[248:251], a[188:191], 0
  v_mfma_f32_16x16x32_bf16 v[76:79], a[228:231], v[200:203], v[76:79]
  s_waitcnt vmcnt(30)
  v_mfma_f32_16x16x32_bf16 v[0:3], a[252:255], v[236:239], v[0:3]
  buffer_load_dwordx4 a[228:231], v110, s[24:27], s30 offen offset:1024 sc1
  v_mfma_f32_16x16x32_bf16 v[0:3], a[144:147], v[192:195], v[0:3]
  v_mfma_f32_16x16x32_bf16 v[4:7], a[144:147], v[212:215], v[4:7]
  v_mfma_f32_16x16x32_bf16 v[4:7], a[252:255], v[196:199], v[4:7]
  v_mfma_f32_16x16x32_bf16 v[8:11], a[252:255], v[216:219], v[8:11]
  buffer_load_dwordx4 a[248:251], v111, s[24:27], s30 offen offset:0 sc1
  v_mfma_f32_16x16x32_bf16 v[8:11], a[144:147], v[228:231], v[8:11]
  v_mfma_f32_16x16x32_bf16 v[12:15], a[144:147], a[192:195], v[12:15]
  v_mfma_f32_16x16x32_bf16 v[12:15], a[252:255], v[232:235], v[12:15]
  v_mfma_f32_16x16x32_bf16 v[16:19], a[128:131], v[236:239], v[16:19]
  buffer_load_dwordx4 a[196:199], v111, s[24:27], s30 offen offset:1024 sc1
  v_mfma_f32_16x16x32_bf16 v[16:19], a[148:151], v[192:195], v[16:19]
  v_mfma_f32_16x16x32_bf16 v[20:23], a[148:151], v[212:215], v[20:23]
  v_mfma_f32_16x16x32_bf16 v[20:23], a[128:131], v[196:199], v[20:23]
  v_mfma_f32_16x16x32_bf16 v[24:27], a[128:131], v[216:219], v[24:27]
  buffer_load_dwordx4 a[200:203], v112, s[24:27], s30 offen offset:0 sc1
  v_mfma_f32_16x16x32_bf16 v[24:27], a[148:151], v[228:231], v[24:27]
  v_mfma_f32_16x16x32_bf16 v[28:31], a[148:151], a[192:195], v[28:31]
  v_mfma_f32_16x16x32_bf16 v[28:31], a[128:131], v[232:235], v[28:31]
  v_mfma_f32_16x16x32_bf16 v[32:35], a[132:135], v[236:239], v[32:35]
  buffer_load_dwordx4 a[208:211], v112, s[24:27], s30 offen offset:1024 sc1
  v_mfma_f32_16x16x32_bf16 v[32:35], a[152:155], v[192:195], v[32:35]
  v_mfma_f32_16x16x32_bf16 v[36:39], a[152:155], v[212:215], v[36:39]
  v_mfma_f32_16x16x32_bf16 v[36:39], a[132:135], v[196:199], v[36:39]
  v_mfma_f32_16x16x32_bf16 v[40:43], a[132:135], v[216:219], v[40:43]
  buffer_load_dwordx4 v[184:187], v113, s[24:27], s30 offen offset:0 sc1
  v_mfma_f32_16x16x32_bf16 v[40:43], a[152:155], v[228:231], v[40:43]
  v_mfma_f32_16x16x32_bf16 v[44:47], a[152:155], a[192:195], v[44:47]
  v_mfma_f32_16x16x32_bf16 v[44:47], a[132:135], v[232:235], v[44:47]
  v_mfma_f32_16x16x32_bf16 v[48:51], a[136:139], v[236:239], v[48:51]
  buffer_load_dwordx4 v[188:191], v113, s[24:27], s30 offen offset:1024 sc1
  v_mfma_f32_16x16x32_bf16 v[48:51], a[156:159], v[192:195], v[48:51]
  v_mfma_f32_16x16x32_bf16 v[52:55], a[156:159], v[212:215], v[52:55]
  v_mfma_f32_16x16x32_bf16 v[52:55], a[136:139], v[196:199], v[52:55]
  v_mfma_f32_16x16x32_bf16 v[56:59], a[136:139], v[216:219], v[56:59]
  s_add_u32 s30, s30, 8192
  buffer_load_dwordx4 v[200:203], v110, s[24:27], s30 offen offset:0 sc1
  v_mfma_f32_16x16x32_bf16 v[56:59], a[156:159], v[228:231], v[56:59]
  v_mfma_f32_16x16x32_bf16 v[60:63], a[156:159], a[192:195], v[60:63]
  v_mfma_f32_16x16x32_bf16 v[60:63], a[136:139], v[232:235], v[60:63]
  v_mfma_f32_16x16x32_bf16 v[64:67], a[140:143], v[236:239], v[64:67]
  buffer_load_dwordx4 a[188:191], v110, s[24:27], s30 offen offset:1024 sc1
  v_mfma_f32_16x16x32_bf16 v[64:67], a[0:3], v[192:195], v[64:67]
  v_mfma_f32_16x16x32_bf16 v[68:71], a[0:3], v[212:215], v[68:71]
  v_mfma_f32_16x16x32_bf16 v[68:71], a[140:143], v[196:199], v[68:71]
  v_mfma_f32_16x16x32_bf16 v[72:75], a[140:143], v[216:219], v[72:75]
  buffer_load_dwordx4 a[252:255], v111, s[24:27], s30 offen offset:0 sc1
  v_mfma_f32_16x16x32_bf16 v[72:75], a[0:3], v[228:231], v[72:75]
  v_mfma_f32_16x16x32_bf16 v[76:79], a[0:3], a[192:195], v[76:79]
  v_mfma_f32_16x16x32_bf16 v[76:79], a[140:143], v[232:235], v[76:79]
  s_waitcnt vmcnt(32)
  v_mfma_f32_16x16x32_bf16 v[0:3], a[4:7], a[204:207], v[0:3]
  buffer_load_dwordx4 a[144:147], v111, s[24:27], s30 offen offset:1024 sc1
  v_mfma_f32_16x16x32_bf16 v[0:3], a[24:27], v[248:251], v[0:3]
  v_mfma_f32_16x16x32_bf16 v[4:7], a[24:27], v[176:179], v[4:7]
  v_mfma_f32_16x16x32_bf16 v[4:7], a[4:7], v[140:143], v[4:7]
  v_mfma_f32_16x16x32_bf16 v[8:11], a[4:7], v[180:183], v[8:11]
  buffer_load_dwordx4 a[128:131], v112, s[24:27], s30 offen offset:0 sc1
  v_mfma_f32_16x16x32_bf16 v[8:11], a[24:27], v[204:207], v[8:11]
  v_mfma_f32_16x16x32_bf16 v[12:15], a[24:27], v[220:223], v[12:15]
  v_mfma_f32_16x16x32_bf16 v[12:15], a[4:7], v[208:211], v[12:15]
  v_mfma_f32_16x16x32_bf16 v[16:19], a[8:11], a[204:207], v[16:19]
  buffer_load_dwordx4 a[148:151], v112, s[24:27], s30 offen offset:1024 sc1
  v_mfma_f32_16x16x32_bf16 v[16:19], a[28:31], v[248:251], v[16:19]
  v_mfma_f32_16x16x32_bf16 v[20:23], a[28:31], v[176:179], v[20:23]
  v_mfma_f32_16x16x32_bf16 v[20:23], a[8:11], v[140:143], v[20:23]
  v_mfma_f32_16x16x32_bf16 v[24:27], a[8:11], v[180:183], v[24:27]
  buffer_load_dwordx4 a[132:135], v113, s[24:27], s30 offen offset:0 sc1
  v_mfma_f32_16x16x32_bf16 v[24:27], a[28:31], v[204:207], v[24:27]
  v_mfma_f32_16x16x32_bf16 v[28:31], a[28:31], v[220:223], v[28:31]
  v_mfma_f32_16x16x32_bf16 v[28:31], a[8:11], v[208:211], v[28:31]
  v_mfma_f32_16x16x32_bf16 v[32:35], a[12:15], a[204:207], v[32:35]
  buffer_load_dwordx4 a[152:155], v113, s[24:27], s30 offen offset:1024 sc1
  v_mfma_f32_16x16x32_bf16 v[32:35], a[32:35], v[248:251], v[32:35]
  v_mfma_f32_16x16x32_bf16 v[36:39], a[32:35], v[176:179], v[36:39]
  v_mfma_f32_16x16x32_bf16 v[36:39], a[12:15], v[140:143], v[36:39]
  v_mfma_f32_16x16x32_bf16 v[40:43], a[12:15], v[180:183], v[40:43]
  s_add_u32 s30, s30, 8192
  buffer_load_dwordx4 a[136:139], v110, s[24:27], s30 offen offset:0 sc1
  v_mfma_f32_16x16x32_bf16 v[40:43], a[32:35], v[204:207], v[40:43]
  v_mfma_f32_16x16x32_bf16 v[44:47], a[32:35], v[220:223], v[44:47]
  v_mfma_f32_16x16x32_bf16 v[44:47], a[12:15], v[208:211], v[44:47]
  v_mfma_f32_16x16x32_bf16 v[48:51], a[16:19], a[204:207], v[48:51]
  buffer_load_dwordx4 a[156:159], v110, s[24:27], s30 offen offset:1024 sc1
  v_mfma_f32_16x16x32_bf16 v[48:51], a[36:39], v[248:251], v[48:51]
  v_mfma_f32_16x16x32_bf16 v[52:55], a[36:39], v[176:179], v[52:55]
  v_mfma_f32_16x16x32_bf16 v[52:55], a[16:19], v[140:143], v[52:55]
  v_mfma_f32_16x16x32_bf16 v[56:59], a[16:19], v[180:183], v[56:59]
  buffer_load_dwordx4 a[140:143], v111, s[24:27], s30 offen offset:0 sc1
  v_mfma_f32_16x16x32_bf16 v[56:59], a[36:39], v[204:207], v[56:59]
  v_mfma_f32_16x16x32_bf16 v[60:63], a[36:39], v[220:223], v[60:63]
  v_mfma_f32_16x16x32_bf16 v[60:63], a[16:19], v[208:211], v[60:63]
  v_mfma_f32_16x16x32_bf16 v[64:67], a[20:23], a[204:207], v[64:67]
  buffer_load_dwordx4 a[0:3], v111, s[24:27], s30 offen offset:1024 sc1
  v_mfma_f32_16x16x32_bf16 v[64:67], a[40:43], v[248:251], v[64:67]
  v_mfma_f32_16x16x32_bf16 v[68:71], a[40:43], v[176:179], v[68:71]
  v_mfma_f32_16x16x32_bf16 v[68:71], a[20:23], v[140:143], v[68:71]
  v_mfma_f32_16x16x32_bf16 v[72:75], a[20:23], v[180:183], v[72:75]
  buffer_load_dwordx4 v[236:239], v112, s[24:27], s30 offen offset:0 sc1
  v_mfma_f32_16x16x32_bf16 v[72:75], a[40:43], v[204:207], v[72:75]
  v_mfma_f32_16x16x32_bf16 v[76:79], a[40:43], v[220:223], v[76:79]
  v_mfma_f32_16x16x32_bf16 v[76:79], a[20:23], v[208:211], v[76:79]
  s_waitcnt vmcnt(34)
  v_mfma_f32_16x16x32_bf16 v[0:3], a[44:47], v[224:227], v[0:3]
  buffer_load_dwordx4 v[192:195], v112, s[24:27], s30 offen offset:1024 sc1
  s_waitcnt vmcnt(23)
  v_mfma_f32_16x16x32_bf16 v[0:3], a[64:67], v[240:243], v[0:3]
  buffer_atomic_add v127, v126, s[24:27], 0 offen
  v_mfma_f32_16x16x32_bf16 v[4:7], a[64:67], v[252:255], v[4:7]
  v_mfma_f32_16x16x32_bf16 v[4:7], a[44:47], v[244:247], v[4:7]
  v_mfma_f32_16x16x32_bf16 v[8:11], a[44:47], v[136:139], v[8:11]
  buffer_load_dwordx4 v[196:199], v113, s[24:27], s30 offen offset:0 sc1
  v_mfma_f32_16x16x32_bf16 v[8:11], a[64:67], v[144:147], v[8:11]
  v_mfma_f32_16x16x32_bf16 v[12:15], a[64:67], a[180:183], v[12:15]
  v_mfma_f32_16x16x32_bf16 v[12:15], a[44:47], v[148:151], v[12:15]
  v_mfma_f32_16x16x32_bf16 v[16:19], a[48:51], v[224:227], v[16:19]
  buffer_load_dwordx4 v[212:215], v113, s[24:27], s30 offen offset:1024 sc1
  v_mfma_f32_16x16x32_bf16 v[16:19], a[68:71], v[240:243], v[16:19]
  v_mfma_f32_16x16x32_bf16 v[20:23], a[68:71], v[252:255], v[20:23]
  v_mfma_f32_16x16x32_bf16 v[20:23], a[48:51], v[244:247], v[20:23]
  v_mfma_f32_16x16x32_bf16 v[24:27], a[48:51], v[136:139], v[24:27]
  s_add_u32 s30, s30, 8192
  v_mfma_f32_16x16x32_bf16 v[24:27], a[68:71], v[144:147], v[24:27]
  v_mfma_f32_16x16x32_bf16 v[28:31], a[68:71], a[180:183], v[28:31]
  v_mfma_f32_16x16x32_bf16 v[28:31], a[48:51], v[148:151], v[28:31]
  v_mfma_f32_16x16x32_bf16 v[32:35], a[52:55], v[224:227], v[32:35]
  v_mfma_f32_16x16x32_bf16 v[32:35], a[72:75], v[240:243], v[32:35]
  v_mfma_f32_16x16x32_bf16 v[36:39], a[72:75], v[252:255], v[36:39]
  v_mfma_f32_16x16x32_bf16 v[36:39], a[52:55], v[244:247], v[36:39]
  v_mfma_f32_16x16x32_bf16 v[40:43], a[52:55], v[136:139], v[40:43]
  v_mfma_f32_16x16x32_bf16 v[40:43], a[72:75], v[144:147], v[40:43]
  v_mfma_f32_16x16x32_bf16 v[44:47], a[72:75], a[180:183], v[44:47]
  v_mfma_f32_16x16x32_bf16 v[44:47], a[52:55], v[148:151], v[44:47]
  v_mfma_f32_16x16x32_bf16 v[48:51], a[56:59], v[224:227], v[48:51]
  v_mfma_f32_16x16x32_bf16 v[48:51], a[76:79], v[240:243], v[48:51]
  v_mfma_f32_16x16x32_bf16 v[52:55], a[76:79], v[252:255], v[52:55]
  v_mfma_f32_16x16x32_bf16 v[52:55], a[56:59], v[244:247], v[52:55]
  v_mfma_f32_16x16x32_bf16 v[56:59], a[56:59], v[136:139], v[56:59]
  v_mfma_f32_16x16x32_bf16 v[56:59], a[76:79], v[144:147], v[56:59]
  v_mfma_f32_16x16x32_bf16 v[60:63], a[76:79], a[180:183], v[60:63]
  v_mfma_f32_16x16x32_bf16 v[60:63], a[56:59], v[148:151], v[60:63]
  v_mfma_f32_16x16x32_bf16 v[64:67], a[60:63], v[224:227], v[64:67]
  v_mfma_f32_16x16x32_bf16 v[64:67], a[80:83], v[240:243], v[64:67]
  v_mfma_f32_16x16x32_bf16 v[68:71], a[80:83], v[252:255], v[68:71]
  v_mfma_f32_16x16x32_bf16 v[68:71], a[60:63], v[244:247], v[68:71]
  v_mfma_f32_16x16x32_bf16 v[72:75], a[60:63], v[136:139], v[72:75]
  v_mfma_f32_16x16x32_bf16 v[72:75], a[80:83], v[144:147], v[72:75]
  v_mfma_f32_16x16x32_bf16 v[76:79], a[80:83], a[180:183], v[76:79]
  v_mfma_f32_16x16x32_bf16 v[76:79], a[60:63], v[148:151], v[76:79]
  s_waitcnt vmcnt(25)
  v_mfma_f32_16x16x32_bf16 v[0:3], a[84:87], a[184:187], v[0:3]
  v_mfma_f32_16x16x32_bf16 v[0:3], a[104:107], a[212:215], v[0:3]
  v_mfma_f32_16x16x32_bf16 v[4:7], a[104:107], a[216:219], v[4:7]
  v_mfma_f32_16x16x32_bf16 v[4:7], a[84:87], a[232:235], v[4:7]
  v_mfma_f32_16x16x32_bf16 v[8:11], a[84:87], a[236:239], v[8:11]
  v_mfma_f32_16x16x32_bf16 v[8:11], a[104:107], a[220:223], v[8:11]
  v_mfma_f32_16x16x32_bf16 v[12:15], a[104:107], a[224:227], v[12:15]
  v_mfma_f32_16x16x32_bf16 v[12:15], a[84:87], a[240:243], v[12:15]
  v_mfma_f32_16x16x32_bf16 v[16:19], a[88:91], a[184:187], v[16:19]
  v_mfma_f32_16x16x32_bf16 v[16:19], a[108:111], a[212:215], v[16:19]
  v_mfma_f32_16x16x32_bf16 v[20:23], a[108:111], a[216:219], v[20:23]
  v_mfma_f32_16x16x32_bf16 v[20:23], a[88:91], a[232:235], v[20:23]
  v_mfma_f32_16x16x32_bf16 v[24:27], a[88:91], a[236:239], v[24:27]
  v_mfma_f32_16x16x32_bf16 v[24:27], a[108:111], a[220:223], v[24:27]
  v_mfma_f32_16x16x32_bf16 v[28:31], a[108:111], a[224:227], v[28:31]
  v_mfma_f32_16x16x32_bf16 v[28:31], a[88:91], a[240:243], v[28:31]
  v_mfma_f32_16x16x32_bf16 v[32:35], a[92:95], a[184:187], v[32:35]
  v_mfma_f32_16x16x32_bf16 v[32:35], a[112:115], a[212:215], v[32:35]
  v_mfma_f32_16x16x32_bf16 v[36:39], a[112:115], a[216:219], v[36:39]
  v_mfma_f32_16x16x32_bf16 v[36:39], a[92:95], a[232:235], v[36:39]
  v_mfma_f32_16x16x32_bf16 v[40:43], a[92:95], a[236:239], v[40:43]
  v_mfma_f32_16x16x32_bf16 v[40:43], a[112:115], a[220:223], v[40:43]
  v_mfma_f32_16x16x32_bf16 v[44:47], a[112:115], a[224:227], v[44:47]
  v_mfma_f32_16x16x32_bf16 v[44:47], a[92:95], a[240:243], v[44:47]
  v_mfma_f32_16x16x32_bf16 v[48:51], a[96:99], a[184:187], v[48:51]
  v_mfma_f32_16x16x32_bf16 v[48:51], a[116:119], a[212:215], v[48:51]
  v_mfma_f32_16x16x32_bf16 v[52:55], a[116:119], a[216:219], v[52:55]
  v_mfma_f32_16x16x32_bf16 v[52:55], a[96:99], a[232:235], v[52:55]
  v_mfma_f32_16x16x32_bf16 v[56:59], a[96:99], a[236:239], v[56:59]
  v_mfma_f32_16x16x32_bf16 v[56:59], a[116:119], a[220:223], v[56:59]
  v_mfma_f32_16x16x32_bf16 v[60:63], a[116:119], a[224:227], v[60:63]
  v_mfma_f32_16x16x32_bf16 v[60:63], a[96:99], a[240:243], v[60:63]
  v_mfma_f32_16x16x32_bf16 v[64:67], a[100:103], a[184:187], v[64:67]
  ds_read_b128 v[216:219], v122 offset:0
  v_mfma_f32_16x16x32_bf16 v[64:67], a[120:123], a[212:215], v[64:67]
  v_mfma_f32_16x16x32_bf16 v[68:71], a[120:123], a[216:219], v[68:71]
  v_mfma_f32_16x16x32_bf16 v[68:71], a[100:103], a[232:235], v[68:71]
  v_mfma_f32_16x16x32_bf16 v[72:75], a[100:103], a[236:239], v[72:75]
  v_mfma_f32_16x16x32_bf16 v[72:75], a[120:123], a[220:223], v[72:75]
  v_mfma_f32_16x16x32_bf16 v[76:79], a[120:123], a[224:227], v[76:79]
  v_mfma_f32_16x16x32_bf16 v[76:79], a[100:103], a[240:243], v[76:79]
  s_waitcnt vmcnt(17)
  v_mfma_f32_16x16x32_bf16 v[0:3], a[124:127], a[244:247], v[0:3]
  ds_read_b128 v[228:231], v122 offset:1024
  buffer_load_dword v128, v133, s[24:27], 0 offen sc1
  s_xor_b32 s38, s40, 0
  s_lshl_b32 s38, s38, 2
  s_add_u32 s38, s38, s3
  v_mfma_f32_16x16x32_bf16 v[0:3], a[176:179], a[228:231], v[0:3]
  s_lshl_b32 s38, s38, 13
  s_add_u32 s38, s38, 25165824
  s_add_u32 s39, s38, 4096
  v_mfma_f32_16x16x32_bf16 v[4:7], a[176:179], a[196:199], v[4:7]
  v_mfma_f32_16x16x32_bf16 v[4:7], a[124:127], a[248:251], v[4:7]
  v_mfma_f32_16x16x32_bf16 v[8:11], a[124:127], a[200:203], v[8:11]
  v_mfma_f32_16x16x32_bf16 v[8:11], a[176:179], a[208:211], v[8:11]
  v_mfma_f32_16x16x32_bf16 v[12:15], a[176:179], v[188:191], v[12:15]
  v_mfma_f32_16x16x32_bf16 v[12:15], a[124:127], v[184:187], v[12:15]
  s_waitcnt lgkmcnt(1)
  v_mfma_f32_16x16x32_bf16 v[16:19], a[160:163], a[244:247], v[16:19]
  ds_read_b128 v[232:235], v122 offset:2048
  v_mfma_f32_16x16x32_bf16 v[16:19], v[216:219], a[228:231], v[16:19]
  v_mfma_f32_16x16x32_bf16 v[20:23], v[216:219], a[196:199], v[20:23]
  v_mfma_f32_16x16x32_bf16 v[20:23], a[160:163], a[248:251], v[20:23]
  v_mfma_f32_16x16x32_bf16 v[24:27], a[160:163], a[200:203], v[24:27]
  v_mfma_f32_16x16x32_bf16 v[24:27], v[216:219], a[208:211], v[24:27]
  v_mfma_f32_16x16x32_bf16 v[28:31], v[216:219], v[188:191], v[28:31]
  v_mfma_f32_16x16x32_bf16 v[28:31], a[160:163], v[184:187], v[28:31]
  s_waitcnt lgkmcnt(1)
  v_mfma_f32_16x16x32_bf16 v[32:35], a[164:167], a[244:247], v[32:35]
  ds_read_b128 a[192:195], v122 offset:3072
  v_mfma_f32_16x16x32_bf16 v[32:35], v[228:231], a[228:231], v[32:35]
  v_mfma_f32_16x16x32_bf16 v[36:39], v[228:231], a[196:199], v[36:39]
  v_mfma_f32_16x16x32_bf16 v[36:39], a[164:167], a[248:251], v[36:39]
  v_mfma_f32_16x16x32_bf16 v[40:43], a[164:167], a[200:203], v[40:43]
  v_mfma_f32_16x16x32_bf16 v[40:43], v[228:231], a[208:211], v[40:43]
  v_mfma_f32_16x16x32_bf16 v[44:47], v[228:231], v[188:191], v[44:47]
  v_mfma_f32_16x16x32_bf16 v[44:47], a[164:167], v[184:187], v[44:47]
  s_waitcnt lgkmcnt(1)
  v_mfma_f32_16x16x32_bf16 v[48:51], a[168:171], a[244:247], v[48:51]
  ds_read_b128 a[4:7], v122 offset:16384
  ds_read_b128 a[24:27], v122 offset:33792
  v_mfma_f32_16x16x32_bf16 v[48:51], v[232:235], a[228:231], v[48:51]
  v_mfma_f32_16x16x32_bf16 v[52:55], v[232:235], a[196:199], v[52:55]
  v_mfma_f32_16x16x32_bf16 v[52:55], a[168:171], a[248:251], v[52:55]
  v_mfma_f32_16x16x32_bf16 v[56:59], a[168:171], a[200:203], v[56:59]
  v_mfma_f32_16x16x32_bf16 v[56:59], v[232:235], a[208:211], v[56:59]
  v_mfma_f32_16x16x32_bf16 v[60:63], v[232:235], v[188:191], v[60:63]
  v_mfma_f32_16x16x32_bf16 v[60:63], a[168:171], v[184:187], v[60:63]
  s_waitcnt lgkmcnt(2)
  v_mfma_f32_16x16x32_bf16 v[64:67], a[172:175], a[244:247], v[64:67]
  ds_read_b128 a[8:11], v122 offset:17408
  ds_read_b128 a[28:31], v122 offset:34816
  v_mfma_f32_16x16x32_bf16 v[64:67], a[192:195], a[228:231], v[64:67]
  v_mfma_f32_16x16x32_bf16 v[68:71], a[192:195], a[196:199], v[68:71]
  v_mfma_f32_16x16x32_bf16 v[68:71], a[172:175], a[248:251], v[68:71]
  v_mfma_f32_16x16x32_bf16 v[72:75], a[172:175], a[200:203], v[72:75]
  v_mfma_f32_16x16x32_bf16 v[72:75], a[192:195], a[208:211], v[72:75]
  v_mfma_f32_16x16x32_bf16 v[76:79], a[192:195], v[188:191], v[76:79]
  v_mfma_f32_16x16x32_bf16 v[76:79], a[172:175], v[184:187], v[76:79]
  s_waitcnt vmcnt(10) lgkmcnt(2)
  v_mfma_f32_16x16x32_bf16 v[0:3], a[4:7], v[200:203], v[0:3]
  ds_read_b128 a[12:15], v122 offset:18432
  ds_read_b128 a[32:35], v122 offset:35840
  v_mfma_f32_16x16x32_bf16 v[0:3], a[24:27], a[188:191], v[0:3]
  v_mfma_f32_16x16x32_bf16 v[4:7], a[24:27], a[144:147], v[4:7]
  v_mfma_f32_16x16x32_bf16 v[4:7], a[4:7], a[252:255], v[4:7]
  v_mfma_f32_16x16x32_bf16 v[8:11], a[4:7], a[128:131], v[8:11]
  v_mfma_f32_16x16x32_bf16 v[8:11], a[24:27], a[148:151], v[8:11]
  v_mfma_f32_16x16x32_bf16 v[12:15], a[24:27], a[152:155], v[12:15]
  v_mfma_f32_16x16x32_bf16 v[12:15], a[4:7], a[132:135], v[12:15]
  s_waitcnt lgkmcnt(2)
  v_mfma_f32_16x16x32_bf16 v[16:19], a[8:11], v[200:203], v[16:19]
  ds_read_b128 a[16:19], v122 offset:19456
  ds_read_b128 a[36:39], v135 offset:0
  v_mfma_f32_16x16x32_bf16 v[16:19], a[28:31], a[188:191], v[16:19]
  v_mfma_f32_16x16x32_bf16 v[20:23], a[28:31], a[144:147], v[20:23]
  v_mfma_f32_16x16x32_bf16 v[20:23], a[8:11], a[252:255], v[20:23]
  v_mfma_f32_16x16x32_bf16 v[24:27], a[8:11], a[128:131], v[24:27]
  v_mfma_f32_16x16x32_bf16 v[24:27], a[28:31], a[148:151], v[24:27]
  v_mfma_f32_16x16x32_bf16 v[28:31], a[28:31], a[152:155], v[28:31]
  v_mfma_f32_16x16x32_bf16 v[28:31], a[8:11], a[132:135], v[28:31]
  s_waitcnt lgkmcnt(2)
  v_mfma_f32_16x16x32_bf16 v[32:35], a[12:15], v[200:203], v[32:35]
  ds_read_b128 a[20:23], v122 offset:32768
  ds_read_b128 a[40:43], v135 offset:1024
  v_mfma_f32_16x16x32_bf16 v[32:35], a[32:35], a[188:191], v[32:35]
  v_mfma_f32_16x16x32_bf16 v[36:39], a[32:35], a[144:147], v[36:39]
  v_mfma_f32_16x16x32_bf16 v[36:39], a[12:15], a[252:255], v[36:39]
  v_mfma_f32_16x16x32_bf16 v[40:43], a[12:15], a[128:131], v[40:43]
  v_mfma_f32_16x16x32_bf16 v[40:43], a[32:35], a[148:151], v[40:43]
  v_mfma_f32_16x16x32_bf16 v[44:47], a[32:35], a[152:155], v[44:47]
  v_mfma_f32_16x16x32_bf16 v[44:47], a[12:15], a[132:135], v[44:47]
  s_waitcnt lgkmcnt(2)
  v_mfma_f32_16x16x32_bf16 v[48:51], a[16:19], v[200:203], v[48:51]
  ds_read_b128 a[204:207], v135 offset:2048
  ds_read_b128 v[248:251], v135 offset:19456
  v_mfma_f32_16x16x32_bf16 v[48:51], a[36:39], a[188:191], v[48:51]
  v_mfma_f32_16x16x32_bf16 v[52:55], a[36:39], a[144:147], v[52:55]
  v_mfma_f32_16x16x32_bf16 v[52:55], a[16:19], a[252:255], v[52:55]
  v_mfma_f32_16x16x32_bf16 v[56:59], a[16:19], a[128:131], v[56:59]
  v_mfma_f32_16x16x32_bf16 v[56:59], a[36:39], a[148:151], v[56:59]
  v_mfma_f32_16x16x32_bf16 v[60:63], a[36:39], a[152:155], v[60:63]
  v_mfma_f32_16x16x32_bf16 v[60:63], a[16:19], a[132:135], v[60:63]
  s_waitcnt lgkmcnt(2)
  v_mfma_f32_16x16x32_bf16 v[64:67], a[20:23], v[200:203], v[64:67]
  ds_read_b128 v[176:179], v135 offset:3072
  ds_read_b128 v[180:183], v122 offset:49152
  v_mfma_f32_16x16x32_bf16 v[64:67], a[40:43], a[188:191], v[64:67]
  v_mfma_f32_16x16x32_bf16 v[68:71], a[40:43], a[144:147], v[68:71]
  v_mfma_f32_16x16x32_bf16 v[68:71], a[20:23], a[252:255], v[68:71]
  v_mfma_f32_16x16x32_bf16 v[72:75], a[20:23], a[128:131], v[72:75]
  v_mfma_f32_16x16x32_bf16 v[72:75], a[40:43], a[148:151], v[72:75]
  v_mfma_f32_16x16x32_bf16 v[76:79], a[40:43], a[152:155], v[76:79]
  v_mfma_f32_16x16x32_bf16 v[76:79], a[20:23], a[132:135], v[76:79]
  s_waitcnt vmcnt(0)
  v_cmp_lt_u32 vcc, v128, v134
  s_nop 0
  s_cbranch_vccz tail_partner
  s_mov_b32 s35, 32768
tail_spin2:
  s_sleep 2
  buffer_load_dword v128, v133, s[24:27], 0 offen sc1
  s_waitcnt vmcnt(0)
  v_cmp_lt_u32 vcc, v128, v134
  s_nop 0
  s_cbranch_vccz tail_partner
  s_sub_u32 s35, s35, 1
  s_cmp_lg_u32 s35, 0
  s_cbranch_scc1 tail_spin2
tail_partner:
  s_waitcnt lgkmcnt(2)
  v_mfma_f32_16x16x32_bf16 v[0:3], a[204:207], a[136:139], v[0:3]
  ds_read_b128 v[204:207], v135 offset:16384
  ds_read_b128 v[208:211], v122 offset:50176
  v_mfma_f32_16x16x32_bf16 v[0:3], v[248:251], a[156:159], v[0:3]
  buffer_load_dwordx2 v[138:139], v125, s[24:27], s38 offen offset:0 sc1
  v_mfma_f32_16x16x32_bf16 v[4:7], v[248:251], a[0:3], v[4:7]
  buffer_load_dwordx2 v[142:143], v125, s[24:27], s38 offen offset:512 sc1
  v_mfma_f32_16x16x32_bf16 v[4:7], a[204:207], a[140:143], v[4:7]
  buffer_load_dwordx2 v[146:147], v125, s[24:27], s38 offen offset:1024 sc1
  v_mfma_f32_16x16x32_bf16 v[8:11], a[204:207], v[236:239], v[8:11]
  buffer_load_dwordx2 v[150:151], v125, s[24:27], s38 offen offset:1536 sc1
  v_mfma_f32_16x16x32_bf16 v[8:11], v[248:251], v[192:195], v[8:11]
  buffer_load_dwordx2 v[154:155], v125, s[24:27], s38 offen offset:2048 sc1
  v_mfma_f32_16x16x32_bf16 v[12:15], v[248:251], v[212:215], v[12:15]
  v_mfma_f32_16x16x32_bf16 v[12:15], a[204:207], v[196:199], v[12:15]
  s_waitcnt lgkmcnt(2)
  v_mfma_f32_16x16x32_bf16 v[16:19], v[176:179], a[136:139], v[16:19]
  ds_read_b128 v[220:223], v135 offset:17408
  ds_read_b128 a[44:47], v122 offset:51200
  v_mfma_f32_16x16x32_bf16 v[16:19], v[180:183], a[156:159], v[16:19]
  ds_write_b128 v122, v[4:7] offset:0
  ds_write_b128 v122, v[8:11] offset:17408
  v_mfma_f32_16x16x32_bf16 v[20:23], v[180:183], a[0:3], v[20:23]
  ds_write_b128 v122, v[12:15] offset:34816
  v_mfma_f32_16x16x32_bf16 v[20:23], v[176:179], a[140:143], v[20:23]
  v_mfma_f32_16x16x32_bf16 v[24:27], v[176:179], v[236:239], v[24:27]
  v_mfma_f32_16x16x32_bf16 v[24:27], v[180:183], v[192:195], v[24:27]
  v_mfma_f32_16x16x32_bf16 v[28:31], v[180:183], v[212:215], v[28:31]
  v_mfma_f32_16x16x32_bf16 v[28:31], v[176:179], v[196:199], v[28:31]
  s_waitcnt lgkmcnt(5)
  v_mfma_f32_16x16x32_bf16 v[32:35], v[204:207], a[136:139], v[32:35]
  ds_read_b128 a[64:67], v135 offset:18432
  ds_read_b128 a[48:51], v122 offset:52224
  v_mfma_f32_16x16x32_bf16 v[32:35], v[208:211], a[156:159], v[32:35]
  ds_write_b128 v122, v[20:23] offset:1024
  ds_write_b128 v122, v[24:27] offset:18432
  v_mfma_f32_16x16x32_bf16 v[36:39], v[208:211], a[0:3], v[36:39]
  ds_write_b128 v122, v[28:31] offset:35840
  v_mfma_f32_16x16x32_bf16 v[36:39], v[204:207], a[140:143], v[36:39]
  v_mfma_f32_16x16x32_bf16 v[40:43], v[204:207], v[236:239], v[40:43]
  v_mfma_f32_16x16x32_bf16 v[40:43], v[208:211], v[192:195], v[40:43]
  v_mfma_f32_16x16x32_bf16 v[44:47], v[208:211], v[212:215], v[44:47]
  v_mfma_f32_16x16x32_bf16 v[44:47], v[204:207], v[196:199], v[44:47]
  s_waitcnt lgkmcnt(8)
  v_mfma_f32_16x16x32_bf16 v[48:51], v[220:223], a[136:139], v[48:51]
  v_mfma_f32_16x16x32_bf16 v[48:51], a[44:47], a[156:159], v[48:51]
  v_mfma_f32_16x16x32_bf16 v[52:55], a[44:47], a[0:3], v[52:55]
  ds_write_b128 v122, v[36:39] offset:2048
  v_mfma_f32_16x16x32_bf16 v[52:55], v[220:223], a[140:143], v[52:55]
  ds_write_b128 v122, v[40:43] offset:19456
  v_mfma_f32_16x16x32_bf16 v[56:59], v[220:223], v[236:239], v[56:59]
  ds_write_b128 v122, v[44:47] offset:49152
  v_mfma_f32_16x16x32_bf16 v[56:59], a[44:47], v[192:195], v[56:59]
  v_mfma_f32_16x16x32_bf16 v[60:63], a[44:47], v[212:215], v[60:63]
  v_mfma_f32_16x16x32_bf16 v[60:63], v[220:223], v[196:199], v[60:63]
  s_waitcnt lgkmcnt(6)
  v_mfma_f32_16x16x32_bf16 v[64:67], a[64:67], a[136:139], v[64:67]
  ds_write_b128 v122, v[52:55] offset:3072
  v_mfma_f32_16x16x32_bf16 v[64:67], a[48:51], a[156:159], v[64:67]
  v_mfma_f32_16x16x32_bf16 v[68:71], a[48:51], a[0:3], v[68:71]
  v_mfma_f32_16x16x32_bf16 v[68:71], a[64:67], a[140:143], v[68:71]
  ds_write_b128 v122, v[56:59] offset:32768
  v_mfma_f32_16x16x32_bf16 v[72:75], a[64:67], v[236:239], v[72:75]
  ds_write_b128 v122, v[60:63] offset:50176
  v_mfma_f32_16x16x32_bf16 v[72:75], a[48:51], v[192:195], v[72:75]
  v_mfma_f32_16x16x32_bf16 v[76:79], a[48:51], v[212:215], v[76:79]
  v_mfma_f32_16x16x32_bf16 v[76:79], a[64:67], v[196:199], v[76:79]
  s_nop 1
  ds_write_b128 v122, v[68:71] offset:16384
  s_nop 2
  ds_write_b128 v122, v[72:75] offset:33792
  s_nop 0
  ds_write_b128 v122, v[76:79] offset:51200
  s_waitcnt lgkmcnt(0)
  s_barrier
  ds_read_b128 v[4:7], v80 offset:0
  ds_read_b128 v[8:11], v81 offset:17408
  ds_read_b128 v[12:15], v82 offset:34816
  ds_read_b128 v[20:23], v80 offset:1024
  ds_read_b128 v[24:27], v81 offset:18432
  ds_read_b128 v[28:31], v82 offset:35840
  ds_read_b128 v[36:39], v80 offset:2048
  ds_read_b128 v[40:43], v81 offset:19456
  ds_read_b128 v[44:47], v82 offset:49152
  ds_read_b128 v[52:55], v80 offset:3072
  ds_read_b128 v[56:59], v81 offset:32768
  ds_read_b128 v[60:63], v82 offset:50176
  ds_read_b128 v[68:71], v80 offset:16384
  ds_read_b128 v[72:75], v81 offset:33792
  ds_read_b128 v[76:79], v82 offset:51200
  s_waitcnt vmcnt(4)
  v_lshlrev_b32 v136, 16, v138
  v_and_b32 v137, s34, v138
  v_lshlrev_b32 v138, 16, v139
  v_and_b32 v139, s34, v139
  v_add_f32 v0, v0, v136
  v_add_f32 v1, v1, v137
  v_add_f32 v2, v2, v138
  v_add_f32 v3, v3, v139
  s_waitcnt lgkmcnt(13)
  v_add_f32 v4, v4, v8
  v_add_f32 v5, v5, v9
  v_add_f32 v6, v6, v10
  v_add_f32 v7, v7, v11
  s_waitcnt lgkmcnt(12)
  v_add_f32 v0, v0, v12
  v_add_f32 v1, v1, v13
  v_add_f32 v2, v2, v14
  v_add_f32 v3, v3, v15
  v_add_f32 v0, v0, v4
  v_add_f32 v1, v1, v5
  v_add_f32 v2, v2, v6
  v_add_f32 v3, v3, v7
  v_cvt_pk_bf16_f32 v4, v0, v1
  v_cvt_pk_bf16_f32 v5, v2, v3
  v_lshlrev_b32 v0, 16, v4
  v_and_b32 v1, s34, v4
  v_lshlrev_b32 v2, 16, v5
  v_and_b32 v3, s34, v5
  v_mul_f32 v0, v0, v90
  v_mul_f32 v1, v1, v91
  v_mul_f32 v2, v2, v92
  v_mul_f32 v3, v3, v93
  v_cvt_pk_bf16_f32 v4, v0, v1
  v_cvt_pk_bf16_f32 v5, v2, v3
  v_lshlrev_b32 v0, 16, v4
  v_and_b32 v1, s34, v4
  v_lshlrev_b32 v2, 16, v5
  v_and_b32 v3, s34, v5
  v_add_f32 v0, v0, v156
  v_add_f32 v1, v1, v157
  v_add_f32 v2, v2, v158
  v_add_f32 v3, v3, v159
  v_cvt_pk_bf16_f32 v4, v0, v1
  v_cvt_pk_bf16_f32 v5, v2, v3
  s_waitcnt vmcnt(3)
  v_lshlrev_b32 v140, 16, v142
  v_and_b32 v141, s34, v142
  v_lshlrev_b32 v142, 16, v143
  v_and_b32 v143, s34, v143
  v_add_f32 v16, v16, v140
  v_add_f32 v17, v17, v141
  v_add_f32 v18, v18, v142
  v_add_f32 v19, v19, v143
  s_waitcnt lgkmcnt(10)
  v_add_f32 v20, v20, v24
  v_add_f32 v21, v21, v25
  v_add_f32 v22, v22, v26
  v_add_f32 v23, v23, v27
  s_waitcnt lgkmcnt(9)
  v_add_f32 v16, v16, v28
  v_add_f32 v17, v17, v29
  v_add_f32 v18, v18, v30
  v_add_f32 v19, v19, v31
  v_add_f32 v16, v16, v20
  v_add_f32 v17, v17, v21
  v_add_f32 v18, v18, v22
  v_add_f32 v19, v19, v23
  v_cvt_pk_bf16_f32 v20, v16, v17
  v_cvt_pk_bf16_f32 v21, v18, v19
  v_lshlrev_b32 v16, 16, v20
  v_and_b32 v17, s34, v20
  v_lshlrev_b32 v18, 16, v21
  v_and_b32 v19, s34, v21
  v_mul_f32 v16, v16, v94
  v_mul_f32 v17, v17, v95
  v_mul_f32 v18, v18, v96
  v_mul_f32 v19, v19, v97
  v_cvt_pk_bf16_f32 v20, v16, v17
  v_cvt_pk_bf16_f32 v21, v18, v19
  v_lshlrev_b32 v16, 16, v20
  v_and_b32 v17, s34, v20
  v_lshlrev_b32 v18, 16, v21
  v_and_b32 v19, s34, v21
  v_add_f32 v16, v16, v160
  v_add_f32 v17, v17, v161
  v_add_f32 v18, v18, v162
  v_add_f32 v19, v19, v163
  v_cvt_pk_bf16_f32 v6, v16, v17
  v_cvt_pk_bf16_f32 v7, v18, v19
  s_nop 0
  v_permlane16_swap_b32 v4, v6
  v_permlane16_swap_b32 v5, v7
  buffer_store_dwordx4 v[4:7], v83, s[16:19], 0 offen offset:0
  s_waitcnt vmcnt(3)
  v_lshlrev_b32 v144, 16, v146
  v_and_b32 v145, s34, v146
  v_lshlrev_b32 v146, 16, v147
  v_and_b32 v147, s34, v147
  v_add_f32 v32, v32, v144
  v_add_f32 v33, v33, v145
  v_add_f32 v34, v34, v146
  v_add_f32 v35, v35, v147
  s_waitcnt lgkmcnt(7)
  v_add_f32 v36, v36, v40
  v_add_f32 v37, v37, v41
  v_add_f32 v38, v38, v42
  v_add_f32 v39, v39, v43
  s_waitcnt lgkmcnt(6)
  v_add_f32 v32, v32, v44
  v_add_f32 v33, v33, v45
  v_add_f32 v34, v34, v46
  v_add_f32 v35, v35, v47
  v_add_f32 v32, v32, v36
  v_add_f32 v33, v33, v37
  v_add_f32 v34, v34, v38
  v_add_f32 v35, v35, v39
  v_cvt_pk_bf16_f32 v36, v32, v33
  v_cvt_pk_bf16_f32 v37, v34, v35
  v_lshlrev_b32 v32, 16, v36
  v_and_b32 v33, s34, v36
  v_lshlrev_b32 v34, 16, v37
  v_and_b32 v35, s34, v37
  v_mul_f32 v32, v32, v98
  v_mul_f32 v33, v33, v99
  v_mul_f32 v34, v34, v100
  v_mul_f32 v35, v35, v101
  v_cvt_pk_bf16_f32 v36, v32, v33
  v_cvt_pk_bf16_f32 v37, v34, v35
  v_lshlrev_b32 v32, 16, v36
  v_and_b32 v33, s34, v36
  v_lshlrev_b32 v34, 16, v37
  v_and_b32 v35, s34, v37
  v_add_f32 v32, v32, v164
  v_add_f32 v33, v33, v165
  v_add_f32 v34, v34, v166
  v_add_f32 v35, v35, v167
  v_cvt_pk_bf16_f32 v36, v32, v33
  v_cvt_pk_bf16_f32 v37, v34, v35
  s_waitcnt vmcnt(2)
  v_lshlrev_b32 v148, 16, v150
  v_and_b32 v149, s34, v150
  v_lshlrev_b32 v150, 16, v151
  v_and_b32 v151, s34, v151
  v_add_f32 v48, v48, v148
  v_add_f32 v49, v49, v149
  v_add_f32 v50, v50, v150
  v_add_f32 v51, v51, v151
  s_waitcnt lgkmcnt(4)
  v_add_f32 v52, v52, v56
  v_add_f32 v53, v53, v57
  v_add_f32 v54, v54, v58
  v_add_f32 v55, v55, v59
  s_waitcnt lgkmcnt(3)
  v_add_f32 v48, v48, v60
  v_add_f32 v49, v49, v61
  v_add_f32 v50, v50, v62
  v_add_f32 v51, v51, v63
  v_add_f32 v48, v48, v52
  v_add_f32 v49, v49, v53
  v_add_f32 v50, v50, v54
  v_add_f32 v51, v51, v55
  v_cvt_pk_bf16_f32 v52, v48, v49
  v_cvt_pk_bf16_f32 v53, v50, v51
  v_lshlrev_b32 v48, 16, v52
  v_and_b32 v49, s34, v52
  v_lshlrev_b32 v50, 16, v53
  v_and_b32 v51, s34, v53
  v_mul_f32 v48, v48, v102
  v_mul_f32 v49, v49, v103
  v_mul_f32 v50, v50, v104
  v_mul_f32 v51, v51, v105
  v_cvt_pk_bf16_f32 v52, v48, v49
  v_cvt_pk_bf16_f32 v53, v50, v51
  v_lshlrev_b32 v48, 16, v52
  v_and_b32 v49, s34, v52
  v_lshlrev_b32 v50, 16, v53
  v_and_b32 v51, s34, v53
  v_add_f32 v48, v48, v168
  v_add_f32 v49, v49, v169
  v_add_f32 v50, v50, v170
  v_add_f32 v51, v51, v171
  v_cvt_pk_bf16_f32 v38, v48, v49
  v_cvt_pk_bf16_f32 v39, v50, v51
  s_nop 0
  v_permlane16_swap_b32 v36, v38
  v_permlane16_swap_b32 v37, v39
  buffer_store_dwordx4 v[36:39], v83, s[16:19], 0 offen offset:64
  s_waitcnt vmcnt(2)
  v_lshlrev_b32 v152, 16, v154
  v_and_b32 v153, s34, v154
  v_lshlrev_b32 v154, 16, v155
  v_and_b32 v155, s34, v155
  v_add_f32 v64, v64, v152
  v_add_f32 v65, v65, v153
  v_add_f32 v66, v66, v154
  v_add_f32 v67, v67, v155
  s_waitcnt lgkmcnt(1)
  v_add_f32 v68, v68, v72
  v_add_f32 v69, v69, v73
  v_add_f32 v70, v70, v74
  v_add_f32 v71, v71, v75
  s_waitcnt lgkmcnt(0)
  v_add_f32 v64, v64, v76
  v_add_f32 v65, v65, v77
  v_add_f32 v66, v66, v78
  v_add_f32 v67, v67, v79
  v_add_f32 v64, v64, v68
  v_add_f32 v65, v65, v69
  v_add_f32 v66, v66, v70
  v_add_f32 v67, v67, v71
  v_cvt_pk_bf16_f32 v68, v64, v65
  v_cvt_pk_bf16_f32 v69, v66, v67
  v_lshlrev_b32 v64, 16, v68
  v_and_b32 v65, s34, v68
  v_lshlrev_b32 v66, 16, v69
  v_and_b32 v67, s34, v69
  v_mul_f32 v64, v64, v106
  v_mul_f32 v65, v65, v107
  v_mul_f32 v66, v66, v108
  v_mul_f32 v67, v67, v109
  v_cvt_pk_bf16_f32 v68, v64, v65
  v_cvt_pk_bf16_f32 v69, v66, v67
  v_lshlrev_b32 v64, 16, v68
  v_and_b32 v65, s34, v68
  v_lshlrev_b32 v66, 16, v69
  v_and_b32 v67, s34, v69
  v_add_f32 v64, v64, v172
  v_add_f32 v65, v65, v173
  v_add_f32 v66, v66, v174
  v_add_f32 v67, v67, v175
  v_cvt_pk_bf16_f32 v68, v64, v65
  v_cvt_pk_bf16_f32 v69, v66, v67
  buffer_store_dwordx2 v[68:69], v117, s[16:19], 0 offen offset:128
attn_end:
  s_endpgm
attn_redo:
  s_waitcnt vmcnt(0)
  v_accvgpr_write_b32 a0, 0
  v_accvgpr_write_b32 a1, 0
  v_accvgpr_write_b32 a2, 0
  v_accvgpr_write_b32 a3, 0
  v_accvgpr_write_b32 a4, 0
  v_accvgpr_write_b32 a5, 0
  v_accvgpr_write_b32 a6, 0
  v_accvgpr_write_b32 a7, 0
  v_accvgpr_write_b32 a8, 0
  v_accvgpr_write_b32 a9, 0
  v_accvgpr_write_b32 a10, 0
  v_accvgpr_write_b32 a11, 0
  v_accvgpr_write_b32 a12, 0
  v_accvgpr_write_b32 a13, 0
  v_accvgpr_write_b32 a14, 0
  v_accvgpr_write_b32 a15, 0
  v_accvgpr_write_b32 a16, 0
  v_accvgpr_write_b32 a17, 0
  v_accvgpr_write_b32 a18, 0
  v_accvgpr_write_b32 a19, 0
  v_accvgpr_write_b32 a20, 0
  v_accvgpr_write_b32 a21, 0
  v_accvgpr_write_b32 a22, 0
  v_accvgpr_write_b32 a23, 0
  v_accvgpr_write_b32 a24, 0
  v_accvgpr_write_b32 a25, 0
  v_accvgpr_write_b32 a26, 0
  v_accvgpr_write_b32 a27, 0
  v_accvgpr_write_b32 a28, 0
  v_accvgpr_write_b32 a29, 0
  v_accvgpr_write_b32 a30, 0
  v_accvgpr_write_b32 a31, 0
  v_accvgpr_write_b32 a32, 0
  v_accvgpr_write_b32 a33, 0
  v_accvgpr_write_b32 a34, 0
  v_accvgpr_write_b32 a35, 0
  v_accvgpr_write_b32 a36, 0
  v_accvgpr_write_b32 a37, 0
  v_accvgpr_write_b32 a38, 0
  v_accvgpr_write_b32 a39, 0
  v_accvgpr_write_b32 a40, 0
  v_accvgpr_write_b32 a41, 0
  v_accvgpr_write_b32 a42, 0
  v_accvgpr_write_b32 a43, 0
  v_accvgpr_write_b32 a44, 0
  v_accvgpr_write_b32 a45, 0
  v_accvgpr_write_b32 a46, 0
  v_accvgpr_write_b32 a47, 0
  v_accvgpr_write_b32 a48, 0
  v_accvgpr_write_b32 a49, 0
  v_accvgpr_write_b32 a50, 0
  v_accvgpr_write_b32 a51, 0
  v_accvgpr_write_b32 a52, 0
  v_accvgpr_write_b32 a53, 0
  v_accvgpr_write_b32 a54, 0
  v_accvgpr_write_b32 a55, 0
  v_accvgpr_write_b32 a56, 0
  v_accvgpr_write_b32 a57, 0
  v_accvgpr_write_b32 a58, 0
  v_accvgpr_write_b32 a59, 0
  v_accvgpr_write_b32 a60, 0
  v_accvgpr_write_b32 a61, 0
  v_accvgpr_write_b32 a62, 0
  v_accvgpr_write_b32 a63, 0
  v_accvgpr_write_b32 a64, 0
  v_accvgpr_write_b32 a65, 0
  v_accvgpr_write_b32 a66, 0
  v_accvgpr_write_b32 a67, 0
  v_accvgpr_write_b32 a68, 0
  v_accvgpr_write_b32 a69, 0
  v_accvgpr_write_b32 a70, 0
  v_accvgpr_write_b32 a71, 0
  v_accvgpr_write_b32 a72, 0
  v_accvgpr_write_b32 a73, 0
  v_accvgpr_write_b32 a74, 0
  v_accvgpr_write_b32 a75, 0
  v_accvgpr_write_b32 a76, 0
  v_accvgpr_write_b32 a77, 0
  v_accvgpr_write_b32 a78, 0
  v_accvgpr_write_b32 a79, 0
  v_accvgpr_write_b32 a80, 0
  v_accvgpr_write_b32 a81, 0
  v_accvgpr_write_b32 a82, 0
  v_accvgpr_write_b32 a83, 0
  v_accvgpr_write_b32 a84, 0
  v_accvgpr_write_b32 a85, 0
  v_accvgpr_write_b32 a86, 0
  v_accvgpr_write_b32 a87, 0
  v_accvgpr_write_b32 a88, 0
  v_accvgpr_write_b32 a89, 0
  v_accvgpr_write_b32 a90, 0
  v_accvgpr_write_b32 a91, 0
  v_accvgpr_write_b32 a92, 0
  v_accvgpr_write_b32 a93, 0
  v_accvgpr_write_b32 a94, 0
  v_accvgpr_write_b32 a95, 0
  v_accvgpr_write_b32 a96, 0
  v_accvgpr_write_b32 a97, 0
  v_accvgpr_write_b32 a98, 0
  v_accvgpr_write_b32 a99, 0
  v_accvgpr_write_b32 a100, 0
  v_accvgpr_write_b32 a101, 0
  v_accvgpr_write_b32 a102, 0
  v_accvgpr_write_b32 a103, 0
  v_accvgpr_write_b32 a104, 0
  v_accvgpr_write_b32 a105, 0
  v_accvgpr_write_b32 a106, 0
  v_accvgpr_write_b32 a107, 0
  v_accvgpr_write_b32 a108, 0
  v_accvgpr_write_b32 a109, 0
  v_accvgpr_write_b32 a110, 0
  v_accvgpr_write_b32 a111, 0
  v_accvgpr_write_b32 a112, 0
  v_accvgpr_write_b32 a113, 0
  v_accvgpr_write_b32 a114, 0
  v_accvgpr_write_b32 a115, 0
  v_accvgpr_write_b32 a116, 0
  v_accvgpr_write_b32 a117, 0
  v_accvgpr_write_b32 a118, 0
  v_accvgpr_write_b32 a119, 0
  v_accvgpr_write_b32 a120, 0
  v_accvgpr_write_b32 a121, 0
  v_accvgpr_write_b32 a122, 0
  v_accvgpr_write_b32 a123, 0
  v_accvgpr_write_b32 a124, 0
  v_accvgpr_write_b32 a125, 0
  v_accvgpr_write_b32 a126, 0
  v_accvgpr_write_b32 a127, 0
  v_mov_b32 v208, 0
  v_mov_b32 v249, 0xff800000
  v_mov_b32 v209, 0
  v_mov_b32 v250, 0xff800000
  v_mov_b32 v210, 0
  v_mov_b32 v251, 0xff800000
  v_mov_b32 v211, 0
  v_mov_b32 v252, 0xff800000
  s_mov_b32 s29, 0
attn_slow:
  s_barrier
  s_add_u32 m0, s28, 49152
  s_nop 0
  buffer_load_dwordx4 v232, s[12:15], s29 offen offset:0 lds
  buffer_load_dwordx4 v233, s[12:15], s29 offen offset:1024 lds
  buffer_load_dwordx4 v234, s[12:15], s29 offen offset:2048 lds
  buffer_load_dwordx4 v235, s[12:15], s29 offen offset:3072 lds
  s_add_u32 m0, s28, 114688
  s_nop 0
  buffer_load_dwordx4 v236, s[16:19], s29 offen offset:0 lds
  buffer_load_dwordx4 v237, s[16:19], s29 offen offset:1024 lds
  buffer_load_dwordx4 v236, s[16:19], s29 offen offset:2048 lds
  buffer_load_dwordx4 v237, s[16:19], s29 offen offset:3072 lds
  s_waitcnt vmcnt(0)
  s_barrier
  ds_read_b128 a[128:131], v212 offset:49152
  ds_read_b128 a[132:135], v213 offset:49152
  ds_read_b128 a[136:139], v214 offset:49152
  ds_read_b128 a[140:143], v215 offset:49152
  s_waitcnt lgkmcnt(3)
  v_mfma_f32_16x16x32_bf16 v[0:3], a[128:131], v[128:131], 0
  s_waitcnt lgkmcnt(2)
  v_mfma_f32_16x16x32_bf16 v[0:3], a[132:135], v[132:135], v[0:3]
  s_waitcnt lgkmcnt(1)
  v_mfma_f32_16x16x32_bf16 v[0:3], a[136:139], v[136:139], v[0:3]
  s_waitcnt lgkmcnt(0)
  v_mfma_f32_16x16x32_bf16 v[0:3], a[140:143], v[140:143], v[0:3]
  v_mfma_f32_16x16x32_bf16 v[8:11], a[140:143], v[156:159], 0
  v_mfma_f32_16x16x32_bf16 v[8:11], a[136:139], v[152:155], v[8:11]
  v_mfma_f32_16x16x32_bf16 v[8:11], a[132:135], v[148:151], v[8:11]
  v_mfma_f32_16x16x32_bf16 v[8:11], a[128:131], v[144:147], v[8:11]
  v_mfma_f32_16x16x32_bf16 v[16:19], a[128:131], v[160:163], 0
  v_mfma_f32_16x16x32_bf16 v[16:19], a[132:135], v[164:167], v[16:19]
  v_mfma_f32_16x16x32_bf16 v[16:19], a[136:139], v[168:171], v[16:19]
  v_mfma_f32_16x16x32_bf16 v[16:19], a[140:143], v[172:175], v[16:19]
  v_mfma_f32_16x16x32_bf16 v[24:27], a[140:143], v[188:191], 0
  v_mfma_f32_16x16x32_bf16 v[24:27], a[136:139], v[184:187], v[24:27]
  v_mfma_f32_16x16x32_bf16 v[24:27], a[132:135], v[180:183], v[24:27]
  v_mfma_f32_16x16x32_bf16 v[24:27], a[128:131], v[176:179], v[24:27]
  ds_read_b128 a[144:147], v212 offset:53248
  ds_read_b128 a[148:151], v213 offset:53248
  ds_read_b128 a[152:155], v214 offset:53248
  ds_read_b128 a[156:159], v215 offset:53248
  s_waitcnt lgkmcnt(3)
  v_mfma_f32_16x16x32_bf16 v[4:7], a[144:147], v[128:131], 0
  s_waitcnt lgkmcnt(2)
  v_mfma_f32_16x16x32_bf16 v[4:7], a[148:151], v[132:135], v[4:7]
  s_waitcnt lgkmcnt(1)
  v_mfma_f32_16x16x32_bf16 v[4:7], a[152:155], v[136:139], v[4:7]
  s_waitcnt lgkmcnt(0)
  v_mfma_f32_16x16x32_bf16 v[4:7], a[156:159], v[140:143], v[4:7]
  v_mfma_f32_16x16x32_bf16 v[12:15], a[156:159], v[156:159], 0
  v_mfma_f32_16x16x32_bf16 v[12:15], a[152:155], v[152:155], v[12:15]
  v_mfma_f32_16x16x32_bf16 v[12:15], a[148:151], v[148:151], v[12:15]
  v_mfma_f32_16x16x32_bf16 v[12:15], a[144:147], v[144:147], v[12:15]
  v_mfma_f32_16x16x32_bf16 v[20:23], a[144:147], v[160:163], 0
  v_mfma_f32_16x16x32_bf16 v[20:23], a[148:151], v[164:167], v[20:23]
  v_mfma_f32_16x16x32_bf16 v[20:23], a[152:155], v[168:171], v[20:23]
  v_mfma_f32_16x16x32_bf16 v[20:23], a[156:159], v[172:175], v[20:23]
  v_mfma_f32_16x16x32_bf16 v[28:31], a[156:159], v[188:191], 0
  v_mfma_f32_16x16x32_bf16 v[28:31], a[152:155], v[184:187], v[28:31]
  v_mfma_f32_16x16x32_bf16 v[28:31], a[148:151], v[180:183], v[28:31]
  v_mfma_f32_16x16x32_bf16 v[28:31], a[144:147], v[176:179], v[28:31]
  ds_read_b128 a[128:131], v212 offset:57344
  ds_read_b128 a[132:135], v213 offset:57344
  ds_read_b128 a[136:139], v214 offset:57344
  ds_read_b128 a[140:143], v215 offset:57344
  s_waitcnt lgkmcnt(3)
  v_mfma_f32_16x16x32_bf16 v[32:35], a[128:131], v[128:131], 0
  s_waitcnt lgkmcnt(2)
  v_mfma_f32_16x16x32_bf16 v[32:35], a[132:135], v[132:135], v[32:35]
  s_waitcnt lgkmcnt(1)
  v_mfma_f32_16x16x32_bf16 v[32:35], a[136:139], v[136:139], v[32:35]
  s_waitcnt lgkmcnt(0)
  v_mfma_f32_16x16x32_bf16 v[32:35], a[140:143], v[140:143], v[32:35]
  v_mfma_f32_16x16x32_bf16 v[40:43], a[140:143], v[156:159], 0
  v_mfma_f32_16x16x32_bf16 v[40:43], a[136:139], v[152:155], v[40:43]
  v_mfma_f32_16x16x32_bf16 v[40:43], a[132:135], v[148:151], v[40:43]
  v_mfma_f32_16x16x32_bf16 v[40:43], a[128:131], v[144:147], v[40:43]
  v_mfma_f32_16x16x32_bf16 v[48:51], a[128:131], v[160:163], 0
  v_mfma_f32_16x16x32_bf16 v[48:51], a[132:135], v[164:167], v[48:51]
  v_mfma_f32_16x16x32_bf16 v[48:51], a[136:139], v[168:171], v[48:51]
  v_mfma_f32_16x16x32_bf16 v[48:51], a[140:143], v[172:175], v[48:51]
  v_mfma_f32_16x16x32_bf16 v[56:59], a[140:143], v[188:191], 0
  v_mfma_f32_16x16x32_bf16 v[56:59], a[136:139], v[184:187], v[56:59]
  v_mfma_f32_16x16x32_bf16 v[56:59], a[132:135], v[180:183], v[56:59]
  v_mfma_f32_16x16x32_bf16 v[56:59], a[128:131], v[176:179], v[56:59]
  ds_read_b128 a[144:147], v212 offset:61440
  ds_read_b128 a[148:151], v213 offset:61440
  ds_read_b128 a[152:155], v214 offset:61440
  ds_read_b128 a[156:159], v215 offset:61440
  s_waitcnt lgkmcnt(3)
  v_mfma_f32_16x16x32_bf16 v[36:39], a[144:147], v[128:131], 0
  s_waitcnt lgkmcnt(2)
  v_mfma_f32_16x16x32_bf16 v[36:39], a[148:151], v[132:135], v[36:39]
  s_waitcnt lgkmcnt(1)
  v_mfma_f32_16x16x32_bf16 v[36:39], a[152:155], v[136:139], v[36:39]
  s_waitcnt lgkmcnt(0)
  v_mfma_f32_16x16x32_bf16 v[36:39], a[156:159], v[140:143], v[36:39]
  v_mfma_f32_16x16x32_bf16 v[44:47], a[156:159], v[156:159], 0
  v_mfma_f32_16x16x32_bf16 v[44:47], a[152:155], v[152:155], v[44:47]
  v_mfma_f32_16x16x32_bf16 v[44:47], a[148:151], v[148:151], v[44:47]
  v_mfma_f32_16x16x32_bf16 v[44:47], a[144:147], v[144:147], v[44:47]
  v_mfma_f32_16x16x32_bf16 v[52:55], a[144:147], v[160:163], 0
  v_mfma_f32_16x16x32_bf16 v[52:55], a[148:151], v[164:167], v[52:55]
  v_mfma_f32_16x16x32_bf16 v[52:55], a[152:155], v[168:171], v[52:55]
  v_mfma_f32_16x16x32_bf16 v[52:55], a[156:159], v[172:175], v[52:55]
  v_mfma_f32_16x16x32_bf16 v[60:63], a[156:159], v[188:191], 0
  v_mfma_f32_16x16x32_bf16 v[60:63], a[152:155], v[184:187], v[60:63]
  v_mfma_f32_16x16x32_bf16 v[60:63], a[148:151], v[180:183], v[60:63]
  v_mfma_f32_16x16x32_bf16 v[60:63], a[144:147], v[176:179], v[60:63]
  v_mov_b32 v192, v249
  v_max3_f32 v192, v192, v0, v1
  v_max3_f32 v192, v192, v2, v3
  v_max3_f32 v192, v192, v4, v5
  v_max3_f32 v192, v192, v6, v7
  v_max3_f32 v192, v192, v32, v33
  v_max3_f32 v192, v192, v34, v35
  v_max3_f32 v192, v192, v36, v37
  v_max3_f32 v192, v192, v38, v39
  v_mov_b32 v245, v192
  s_nop 1
  v_permlane16_swap_b32 v192, v245
  v_max_f32 v192, v192, v245
  v_mov_b32 v245, v192
  s_nop 1
  v_permlane32_swap_b32 v192, v245
  v_max_f32 v192, v192, v245
  v_sub_f32 v193, v249, v192
  v_exp_f32 v193, v193
  v_mov_b32 v249, v192
  v_mul_f32 v208, v208, v193
  v_sub_f32 v0, v0, v192
  v_sub_f32 v1, v1, v192
  v_sub_f32 v2, v2, v192
  v_sub_f32 v3, v3, v192
  v_sub_f32 v4, v4, v192
  v_sub_f32 v5, v5, v192
  v_sub_f32 v6, v6, v192
  v_sub_f32 v7, v7, v192
  v_sub_f32 v32, v32, v192
  v_sub_f32 v33, v33, v192
  v_sub_f32 v34, v34, v192
  v_sub_f32 v35, v35, v192
  v_sub_f32 v36, v36, v192
  v_sub_f32 v37, v37, v192
  v_sub_f32 v38, v38, v192
  v_sub_f32 v39, v39, v192
  v_exp_f32 v0, v0
  v_exp_f32 v1, v1
  v_add_f32 v208, v208, v0
  v_exp_f32 v2, v2
  v_add_f32 v208, v208, v1
  v_cvt_pk_bf16_f32 v0, v0, v1
  v_exp_f32 v3, v3
  v_add_f32 v208, v208, v2
  v_add_f32 v208, v208, v3
  v_cvt_pk_bf16_f32 v1, v2, v3
  v_exp_f32 v4, v4
  v_exp_f32 v5, v5
  v_add_f32 v208, v208, v4
  v_exp_f32 v6, v6
  v_add_f32 v208, v208, v5
  v_cvt_pk_bf16_f32 v2, v4, v5
  v_exp_f32 v7, v7
  v_add_f32 v208, v208, v6
  v_add_f32 v208, v208, v7
  v_cvt_pk_bf16_f32 v3, v6, v7
  v_exp_f32 v32, v32
  v_exp_f32 v33, v33
  v_add_f32 v208, v208, v32
  v_exp_f32 v34, v34
  v_add_f32 v208, v208, v33
  v_cvt_pk_bf16_f32 v32, v32, v33
  v_exp_f32 v35, v35
  v_add_f32 v208, v208, v34
  v_add_f32 v208, v208, v35
  v_cvt_pk_bf16_f32 v33, v34, v35
  v_exp_f32 v36, v36
  v_exp_f32 v37, v37
  v_add_f32 v208, v208, v36
  v_exp_f32 v38, v38
  v_add_f32 v208, v208, v37
  v_cvt_pk_bf16_f32 v34, v36, v37
  v_exp_f32 v39, v39
  v_add_f32 v208, v208, v38
  v_add_f32 v208, v208, v39
  v_cvt_pk_bf16_f32 v35, v38, v39
  v_accvgpr_read_b32 v64, a0
  v_accvgpr_read_b32 v65, a1
  v_accvgpr_read_b32 v66, a2
  v_accvgpr_read_b32 v67, a3
  v_mul_f32 v64, v64, v193
  v_mul_f32 v65, v65, v193
  v_mul_f32 v66, v66, v193
  v_mul_f32 v67, v67, v193
  v_accvgpr_write_b32 a0, v64
  v_accvgpr_write_b32 a1, v65
  v_accvgpr_write_b32 a2, v66
  v_accvgpr_write_b32 a3, v67
  v_accvgpr_read_b32 v64, a16
  v_accvgpr_read_b32 v65, a17
  v_accvgpr_read_b32 v66, a18
  v_accvgpr_read_b32 v67, a19
  v_mul_f32 v64, v64, v193
  v_mul_f32 v65, v65, v193
  v_mul_f32 v66, v66, v193
  v_mul_f32 v67, v67, v193
  v_accvgpr_write_b32 a16, v64
  v_accvgpr_write_b32 a17, v65
  v_accvgpr_write_b32 a18, v66
  v_accvgpr_write_b32 a19, v67
  v_accvgpr_read_b32 v64, a32
  v_accvgpr_read_b32 v65, a33
  v_accvgpr_read_b32 v66, a34
  v_accvgpr_read_b32 v67, a35
  v_mul_f32 v64, v64, v193
  v_mul_f32 v65, v65, v193
  v_mul_f32 v66, v66, v193
  v_mul_f32 v67, v67, v193
  v_accvgpr_write_b32 a32, v64
  v_accvgpr_write_b32 a33, v65
  v_accvgpr_write_b32 a34, v66
  v_accvgpr_write_b32 a35, v67
  v_accvgpr_read_b32 v64, a48
  v_accvgpr_read_b32 v65, a49
  v_accvgpr_read_b32 v66, a50
  v_accvgpr_read_b32 v67, a51
  v_mul_f32 v64, v64, v193
  v_mul_f32 v65, v65, v193
  v_mul_f32 v66, v66, v193
  v_mul_f32 v67, v67, v193
  v_accvgpr_write_b32 a48, v64
  v_accvgpr_write_b32 a49, v65
  v_accvgpr_write_b32 a50, v66
  v_accvgpr_write_b32 a51, v67
  v_accvgpr_read_b32 v64, a64
  v_accvgpr_read_b32 v65, a65
  v_accvgpr_read_b32 v66, a66
  v_accvgpr_read_b32 v67, a67
  v_mul_f32 v64, v64, v193
  v_mul_f32 v65, v65, v193
  v_mul_f32 v66, v66, v193
  v_mul_f32 v67, v67, v193
  v_accvgpr_write_b32 a64, v64
  v_accvgpr_write_b32 a65, v65
  v_accvgpr_write_b32 a66, v66
  v_accvgpr_write_b32 a67, v67
  v_accvgpr_read_b32 v64, a80
  v_accvgpr_read_b32 v65, a81
  v_accvgpr_read_b32 v66, a82
  v_accvgpr_read_b32 v67, a83
  v_mul_f32 v64, v64, v193
  v_mul_f32 v65, v65, v193
  v_mul_f32 v66, v66, v193
  v_mul_f32 v67, v67, v193
  v_accvgpr_write_b32 a80, v64
  v_accvgpr_write_b32 a81, v65
  v_accvgpr_write_b32 a82, v66
  v_accvgpr_write_b32 a83, v67
  v_accvgpr_read_b32 v64, a96
  v_accvgpr_read_b32 v65, a97
  v_accvgpr_read_b32 v66, a98
  v_accvgpr_read_b32 v67, a99
  v_mul_f32 v64, v64, v193
  v_mul_f32 v65, v65, v193
  v_mul_f32 v66, v66, v193
  v_mul_f32 v67, v67, v193
  v_accvgpr_write_b32 a96, v64
  v_accvgpr_write_b32 a97, v65
  v_accvgpr_write_b32 a98, v66
  v_accvgpr_write_b32 a99, v67
  v_accvgpr_read_b32 v64, a112
  v_accvgpr_read_b32 v65, a113
  v_accvgpr_read_b32 v66, a114
  v_accvgpr_read_b32 v67, a115
  v_mul_f32 v64, v64, v193
  v_mul_f32 v65, v65, v193
  v_mul_f32 v66, v66, v193
  v_mul_f32 v67, v67, v193
  v_accvgpr_write_b32 a112, v64
  v_accvgpr_write_b32 a113, v65
  v_accvgpr_write_b32 a114, v66
  v_accvgpr_write_b32 a115, v67
  v_mov_b32 v196, v250
  v_max3_f32 v196, v196, v8, v9
  v_max3_f32 v196, v196, v10, v11
  v_max3_f32 v196, v196, v12, v13
  v_max3_f32 v196, v196, v14, v15
  v_max3_f32 v196, v196, v40, v41
  v_max3_f32 v196, v196, v42, v43
  v_max3_f32 v196, v196, v44, v45
  v_max3_f32 v196, v196, v46, v47
  v_mov_b32 v245, v196
  s_nop 1
  v_permlane16_swap_b32 v196, v245
  v_max_f32 v196, v196, v245
  v_mov_b32 v245, v196
  s_nop 1
  v_permlane32_swap_b32 v196, v245
  v_max_f32 v196, v196, v245
  v_sub_f32 v197, v250, v196
  v_exp_f32 v197, v197
  v_mov_b32 v250, v196
  v_mul_f32 v209, v209, v197
  v_sub_f32 v8, v8, v196
  v_sub_f32 v9, v9, v196
  v_sub_f32 v10, v10, v196
  v_sub_f32 v11, v11, v196
  v_sub_f32 v12, v12, v196
  v_sub_f32 v13, v13, v196
  v_sub_f32 v14, v14, v196
  v_sub_f32 v15, v15, v196
  v_sub_f32 v40, v40, v196
  v_sub_f32 v41, v41, v196
  v_sub_f32 v42, v42, v196
  v_sub_f32 v43, v43, v196
  v_sub_f32 v44, v44, v196
  v_sub_f32 v45, v45, v196
  v_sub_f32 v46, v46, v196
  v_sub_f32 v47, v47, v196
  v_exp_f32 v8, v8
  v_exp_f32 v9, v9
  v_add_f32 v209, v209, v8
  v_exp_f32 v10, v10
  v_add_f32 v209, v209, v9
  v_cvt_pk_bf16_f32 v8, v8, v9
  v_exp_f32 v11, v11
  v_add_f32 v209, v209, v10
  v_add_f32 v209, v209, v11
  v_cvt_pk_bf16_f32 v9, v10, v11
  v_exp_f32 v12, v12
  v_exp_f32 v13, v13
  v_add_f32 v209, v209, v12
  v_exp_f32 v14, v14
  v_add_f32 v209, v209, v13
  v_cvt_pk_bf16_f32 v10, v12, v13
  v_exp_f32 v15, v15
  v_add_f32 v209, v209, v14
  v_add_f32 v209, v209, v15
  v_cvt_pk_bf16_f32 v11, v14, v15
  v_exp_f32 v40, v40
  v_exp_f32 v41, v41
  v_add_f32 v209, v209, v40
  v_exp_f32 v42, v42
  v_add_f32 v209, v209, v41
  v_cvt_pk_bf16_f32 v40, v40, v41
  v_exp_f32 v43, v43
  v_add_f32 v209, v209, v42
  v_add_f32 v209, v209, v43
  v_cvt_pk_bf16_f32 v41, v42, v43
  v_exp_f32 v44, v44
  v_exp_f32 v45, v45
  v_add_f32 v209, v209, v44
  v_exp_f32 v46, v46
  v_add_f32 v209, v209, v45
  v_cvt_pk_bf16_f32 v42, v44, v45
  v_exp_f32 v47, v47
  v_add_f32 v209, v209, v46
  v_add_f32 v209, v209, v47
  v_cvt_pk_bf16_f32 v43, v46, v47
  v_accvgpr_read_b32 v64, a4
  v_accvgpr_read_b32 v65, a5
  v_accvgpr_read_b32 v66, a6
  v_accvgpr_read_b32 v67, a7
  v_mul_f32 v64, v64, v197
  v_mul_f32 v65, v65, v197
  v_mul_f32 v66, v66, v197
  v_mul_f32 v67, v67, v197
  v_accvgpr_write_b32 a4, v64
  v_accvgpr_write_b32 a5, v65
  v_accvgpr_write_b32 a6, v66
  v_accvgpr_write_b32 a7, v67
  v_accvgpr_read_b32 v64, a20
  v_accvgpr_read_b32 v65, a21
  v_accvgpr_read_b32 v66, a22
  v_accvgpr_read_b32 v67, a23
  v_mul_f32 v64, v64, v197
  v_mul_f32 v65, v65, v197
  v_mul_f32 v66, v66, v197
  v_mul_f32 v67, v67, v197
  v_accvgpr_write_b32 a20, v64
  v_accvgpr_write_b32 a21, v65
  v_accvgpr_write_b32 a22, v66
  v_accvgpr_write_b32 a23, v67
  v_accvgpr_read_b32 v64, a36
  v_accvgpr_read_b32 v65, a37
  v_accvgpr_read_b32 v66, a38
  v_accvgpr_read_b32 v67, a39
  v_mul_f32 v64, v64, v197
  v_mul_f32 v65, v65, v197
  v_mul_f32 v66, v66, v197
  v_mul_f32 v67, v67, v197
  v_accvgpr_write_b32 a36, v64
  v_accvgpr_write_b32 a37, v65
  v_accvgpr_write_b32 a38, v66
  v_accvgpr_write_b32 a39, v67
  v_accvgpr_read_b32 v64, a52
  v_accvgpr_read_b32 v65, a53
  v_accvgpr_read_b32 v66, a54
  v_accvgpr_read_b32 v67, a55
  v_mul_f32 v64, v64, v197
  v_mul_f32 v65, v65, v197
  v_mul_f32 v66, v66, v197
  v_mul_f32 v67, v67, v197
  v_accvgpr_write_b32 a52, v64
  v_accvgpr_write_b32 a53, v65
  v_accvgpr_write_b32 a54, v66
  v_accvgpr_write_b32 a55, v67
  v_accvgpr_read_b32 v64, a68
  v_accvgpr_read_b32 v65, a69
  v_accvgpr_read_b32 v66, a70
  v_accvgpr_read_b32 v67, a71
  v_mul_f32 v64, v64, v197
  v_mul_f32 v65, v65, v197
  v_mul_f32 v66, v66, v197
  v_mul_f32 v67, v67, v197
  v_accvgpr_write_b32 a68, v64
  v_accvgpr_write_b32 a69, v65
  v_accvgpr_write_b32 a70, v66
  v_accvgpr_write_b32 a71, v67
  v_accvgpr_read_b32 v64, a84
  v_accvgpr_read_b32 v65, a85
  v_accvgpr_read_b32 v66, a86
  v_accvgpr_read_b32 v67, a87
  v_mul_f32 v64, v64, v197
  v_mul_f32 v65, v65, v197
  v_mul_f32 v66, v66, v197
  v_mul_f32 v67, v67, v197
  v_accvgpr_write_b32 a84, v64
  v_accvgpr_write_b32 a85, v65
  v_accvgpr_write_b32 a86, v66
  v_accvgpr_write_b32 a87, v67
  v_accvgpr_read_b32 v64, a100
  v_accvgpr_read_b32 v65, a101
  v_accvgpr_read_b32 v66, a102
  v_accvgpr_read_b32 v67, a103
  v_mul_f32 v64, v64, v197
  v_mul_f32 v65, v65, v197
  v_mul_f32 v66, v66, v197
  v_mul_f32 v67, v67, v197
  v_accvgpr_write_b32 a100, v64
  v_accvgpr_write_b32 a101, v65
  v_accvgpr_write_b32 a102, v66
  v_accvgpr_write_b32 a103, v67
  v_accvgpr_read_b32 v64, a116
  v_accvgpr_read_b32 v65, a117
  v_accvgpr_read_b32 v66, a118
  v_accvgpr_read_b32 v67, a119
  v_mul_f32 v64, v64, v197
  v_mul_f32 v65, v65, v197
  v_mul_f32 v66, v66, v197
  v_mul_f32 v67, v67, v197
  v_accvgpr_write_b32 a116, v64
  v_accvgpr_write_b32 a117, v65
  v_accvgpr_write_b32 a118, v66
  v_accvgpr_write_b32 a119, v67
  v_mov_b32 v200, v251
  v_max3_f32 v200, v200, v16, v17
  v_max3_f32 v200, v200, v18, v19
  v_max3_f32 v200, v200, v20, v21
  v_max3_f32 v200, v200, v22, v23
  v_max3_f32 v200, v200, v48, v49
  v_max3_f32 v200, v200, v50, v51
  v_max3_f32 v200, v200, v52, v53
  v_max3_f32 v200, v200, v54, v55
  v_mov_b32 v245, v200
  s_nop 1
  v_permlane16_swap_b32 v200, v245
  v_max_f32 v200, v200, v245
  v_mov_b32 v245, v200
  s_nop 1
  v_permlane32_swap_b32 v200, v245
  v_max_f32 v200, v200, v245
  v_sub_f32 v201, v251, v200
  v_exp_f32 v201, v201
  v_mov_b32 v251, v200
  v_mul_f32 v210, v210, v201
  v_sub_f32 v16, v16, v200
  v_sub_f32 v17, v17, v200
  v_sub_f32 v18, v18, v200
  v_sub_f32 v19, v19, v200
  v_sub_f32 v20, v20, v200
  v_sub_f32 v21, v21, v200
  v_sub_f32 v22, v22, v200
  v_sub_f32 v23, v23, v200
  v_sub_f32 v48, v48, v200
  v_sub_f32 v49, v49, v200
  v_sub_f32 v50, v50, v200
  v_sub_f32 v51, v51, v200
  v_sub_f32 v52, v52, v200
  v_sub_f32 v53, v53, v200
  v_sub_f32 v54, v54, v200
  v_sub_f32 v55, v55, v200
  v_exp_f32 v16, v16
  v_exp_f32 v17, v17
  v_add_f32 v210, v210, v16
  v_exp_f32 v18, v18
  v_add_f32 v210, v210, v17
  v_cvt_pk_bf16_f32 v16, v16, v17
  v_exp_f32 v19, v19
  v_add_f32 v210, v210, v18
  v_add_f32 v210, v210, v19
  v_cvt_pk_bf16_f32 v17, v18, v19
  v_exp_f32 v20, v20
  v_exp_f32 v21, v21
  v_add_f32 v210, v210, v20
  v_exp_f32 v22, v22
  v_add_f32 v210, v210, v21
  v_cvt_pk_bf16_f32 v18, v20, v21
  v_exp_f32 v23, v23
  v_add_f32 v210, v210, v22
  v_add_f32 v210, v210, v23
  v_cvt_pk_bf16_f32 v19, v22, v23
  v_exp_f32 v48, v48
  v_exp_f32 v49, v49
  v_add_f32 v210, v210, v48
  v_exp_f32 v50, v50
  v_add_f32 v210, v210, v49
  v_cvt_pk_bf16_f32 v48, v48, v49
  v_exp_f32 v51, v51
  v_add_f32 v210, v210, v50
  v_add_f32 v210, v210, v51
  v_cvt_pk_bf16_f32 v49, v50, v51
  v_exp_f32 v52, v52
  v_exp_f32 v53, v53
  v_add_f32 v210, v210, v52
  v_exp_f32 v54, v54
  v_add_f32 v210, v210, v53
  v_cvt_pk_bf16_f32 v50, v52, v53
  v_exp_f32 v55, v55
  v_add_f32 v210, v210, v54
  v_add_f32 v210, v210, v55
  v_cvt_pk_bf16_f32 v51, v54, v55
  v_accvgpr_read_b32 v64, a8
  v_accvgpr_read_b32 v65, a9
  v_accvgpr_read_b32 v66, a10
  v_accvgpr_read_b32 v67, a11
  v_mul_f32 v64, v64, v201
  v_mul_f32 v65, v65, v201
  v_mul_f32 v66, v66, v201
  v_mul_f32 v67, v67, v201
  v_accvgpr_write_b32 a8, v64
  v_accvgpr_write_b32 a9, v65
  v_accvgpr_write_b32 a10, v66
  v_accvgpr_write_b32 a11, v67
  v_accvgpr_read_b32 v64, a24
  v_accvgpr_read_b32 v65, a25
  v_accvgpr_read_b32 v66, a26
  v_accvgpr_read_b32 v67, a27
  v_mul_f32 v64, v64, v201
  v_mul_f32 v65, v65, v201
  v_mul_f32 v66, v66, v201
  v_mul_f32 v67, v67, v201
  v_accvgpr_write_b32 a24, v64
  v_accvgpr_write_b32 a25, v65
  v_accvgpr_write_b32 a26, v66
  v_accvgpr_write_b32 a27, v67
  v_accvgpr_read_b32 v64, a40
  v_accvgpr_read_b32 v65, a41
  v_accvgpr_read_b32 v66, a42
  v_accvgpr_read_b32 v67, a43
  v_mul_f32 v64, v64, v201
  v_mul_f32 v65, v65, v201
  v_mul_f32 v66, v66, v201
  v_mul_f32 v67, v67, v201
  v_accvgpr_write_b32 a40, v64
  v_accvgpr_write_b32 a41, v65
  v_accvgpr_write_b32 a42, v66
  v_accvgpr_write_b32 a43, v67
  v_accvgpr_read_b32 v64, a56
  v_accvgpr_read_b32 v65, a57
  v_accvgpr_read_b32 v66, a58
  v_accvgpr_read_b32 v67, a59
  v_mul_f32 v64, v64, v201
  v_mul_f32 v65, v65, v201
  v_mul_f32 v66, v66, v201
  v_mul_f32 v67, v67, v201
  v_accvgpr_write_b32 a56, v64
  v_accvgpr_write_b32 a57, v65
  v_accvgpr_write_b32 a58, v66
  v_accvgpr_write_b32 a59, v67
  v_accvgpr_read_b32 v64, a72
  v_accvgpr_read_b32 v65, a73
  v_accvgpr_read_b32 v66, a74
  v_accvgpr_read_b32 v67, a75
  v_mul_f32 v64, v64, v201
  v_mul_f32 v65, v65, v201
  v_mul_f32 v66, v66, v201
  v_mul_f32 v67, v67, v201
  v_accvgpr_write_b32 a72, v64
  v_accvgpr_write_b32 a73, v65
  v_accvgpr_write_b32 a74, v66
  v_accvgpr_write_b32 a75, v67
  v_accvgpr_read_b32 v64, a88
  v_accvgpr_read_b32 v65, a89
  v_accvgpr_read_b32 v66, a90
  v_accvgpr_read_b32 v67, a91
  v_mul_f32 v64, v64, v201
  v_mul_f32 v65, v65, v201
  v_mul_f32 v66, v66, v201
  v_mul_f32 v67, v67, v201
  v_accvgpr_write_b32 a88, v64
  v_accvgpr_write_b32 a89, v65
  v_accvgpr_write_b32 a90, v66
  v_accvgpr_write_b32 a91, v67
  v_accvgpr_read_b32 v64, a104
  v_accvgpr_read_b32 v65, a105
  v_accvgpr_read_b32 v66, a106
  v_accvgpr_read_b32 v67, a107
  v_mul_f32 v64, v64, v201
  v_mul_f32 v65, v65, v201
  v_mul_f32 v66, v66, v201
  v_mul_f32 v67, v67, v201
  v_accvgpr_write_b32 a104, v64
  v_accvgpr_write_b32 a105, v65
  v_accvgpr_write_b32 a106, v66
  v_accvgpr_write_b32 a107, v67
  v_accvgpr_read_b32 v64, a120
  v_accvgpr_read_b32 v65, a121
  v_accvgpr_read_b32 v66, a122
  v_accvgpr_read_b32 v67, a123
  v_mul_f32 v64, v64, v201
  v_mul_f32 v65, v65, v201
  v_mul_f32 v66, v66, v201
  v_mul_f32 v67, v67, v201
  v_accvgpr_write_b32 a120, v64
  v_accvgpr_write_b32 a121, v65
  v_accvgpr_write_b32 a122, v66
  v_accvgpr_write_b32 a123, v67
  v_mov_b32 v204, v252
  v_max3_f32 v204, v204, v24, v25
  v_max3_f32 v204, v204, v26, v27
  v_max3_f32 v204, v204, v28, v29
  v_max3_f32 v204, v204, v30, v31
  v_max3_f32 v204, v204, v56, v57
  v_max3_f32 v204, v204, v58, v59
  v_max3_f32 v204, v204, v60, v61
  v_max3_f32 v204, v204, v62, v63
  v_mov_b32 v245, v204
  s_nop 1
  v_permlane16_swap_b32 v204, v245
  v_max_f32 v204, v204, v245
  v_mov_b32 v245, v204
  s_nop 1
  v_permlane32_swap_b32 v204, v245
  v_max_f32 v204, v204, v245
  v_sub_f32 v205, v252, v204
  v_exp_f32 v205, v205
  v_mov_b32 v252, v204
  v_mul_f32 v211, v211, v205
  v_sub_f32 v24, v24, v204
  v_sub_f32 v25, v25, v204
  v_sub_f32 v26, v26, v204
  v_sub_f32 v27, v27, v204
  v_sub_f32 v28, v28, v204
  v_sub_f32 v29, v29, v204
  v_sub_f32 v30, v30, v204
  v_sub_f32 v31, v31, v204
  v_sub_f32 v56, v56, v204
  v_sub_f32 v57, v57, v204
  v_sub_f32 v58, v58, v204
  v_sub_f32 v59, v59, v204
  v_sub_f32 v60, v60, v204
  v_sub_f32 v61, v61, v204
  v_sub_f32 v62, v62, v204
  v_sub_f32 v63, v63, v204
  v_exp_f32 v24, v24
  v_exp_f32 v25, v25
  v_add_f32 v211, v211, v24
  v_exp_f32 v26, v26
  v_add_f32 v211, v211, v25
  v_cvt_pk_bf16_f32 v24, v24, v25
  v_exp_f32 v27, v27
  v_add_f32 v211, v211, v26
  v_add_f32 v211, v211, v27
  v_cvt_pk_bf16_f32 v25, v26, v27
  v_exp_f32 v28, v28
  v_exp_f32 v29, v29
  v_add_f32 v211, v211, v28
  v_exp_f32 v30, v30
  v_add_f32 v211, v211, v29
  v_cvt_pk_bf16_f32 v26, v28, v29
  v_exp_f32 v31, v31
  v_add_f32 v211, v211, v30
  v_add_f32 v211, v211, v31
  v_cvt_pk_bf16_f32 v27, v30, v31
  v_exp_f32 v56, v56
  v_exp_f32 v57, v57
  v_add_f32 v211, v211, v56
  v_exp_f32 v58, v58
  v_add_f32 v211, v211, v57
  v_cvt_pk_bf16_f32 v56, v56, v57
  v_exp_f32 v59, v59
  v_add_f32 v211, v211, v58
  v_add_f32 v211, v211, v59
  v_cvt_pk_bf16_f32 v57, v58, v59
  v_exp_f32 v60, v60
  v_exp_f32 v61, v61
  v_add_f32 v211, v211, v60
  v_exp_f32 v62, v62
  v_add_f32 v211, v211, v61
  v_cvt_pk_bf16_f32 v58, v60, v61
  v_exp_f32 v63, v63
  v_add_f32 v211, v211, v62
  v_add_f32 v211, v211, v63
  v_cvt_pk_bf16_f32 v59, v62, v63
  v_accvgpr_read_b32 v64, a12
  v_accvgpr_read_b32 v65, a13
  v_accvgpr_read_b32 v66, a14
  v_accvgpr_read_b32 v67, a15
  v_mul_f32 v64, v64, v205
  v_mul_f32 v65, v65, v205
  v_mul_f32 v66, v66, v205
  v_mul_f32 v67, v67, v205
  v_accvgpr_write_b32 a12, v64
  v_accvgpr_write_b32 a13, v65
  v_accvgpr_write_b32 a14, v66
  v_accvgpr_write_b32 a15, v67
  v_accvgpr_read_b32 v64, a28
  v_accvgpr_read_b32 v65, a29
  v_accvgpr_read_b32 v66, a30
  v_accvgpr_read_b32 v67, a31
  v_mul_f32 v64, v64, v205
  v_mul_f32 v65, v65, v205
  v_mul_f32 v66, v66, v205
  v_mul_f32 v67, v67, v205
  v_accvgpr_write_b32 a28, v64
  v_accvgpr_write_b32 a29, v65
  v_accvgpr_write_b32 a30, v66
  v_accvgpr_write_b32 a31, v67
  v_accvgpr_read_b32 v64, a44
  v_accvgpr_read_b32 v65, a45
  v_accvgpr_read_b32 v66, a46
  v_accvgpr_read_b32 v67, a47
  v_mul_f32 v64, v64, v205
  v_mul_f32 v65, v65, v205
  v_mul_f32 v66, v66, v205
  v_mul_f32 v67, v67, v205
  v_accvgpr_write_b32 a44, v64
  v_accvgpr_write_b32 a45, v65
  v_accvgpr_write_b32 a46, v66
  v_accvgpr_write_b32 a47, v67
  v_accvgpr_read_b32 v64, a60
  v_accvgpr_read_b32 v65, a61
  v_accvgpr_read_b32 v66, a62
  v_accvgpr_read_b32 v67, a63
  v_mul_f32 v64, v64, v205
  v_mul_f32 v65, v65, v205
  v_mul_f32 v66, v66, v205
  v_mul_f32 v67, v67, v205
  v_accvgpr_write_b32 a60, v64
  v_accvgpr_write_b32 a61, v65
  v_accvgpr_write_b32 a62, v66
  v_accvgpr_write_b32 a63, v67
  v_accvgpr_read_b32 v64, a76
  v_accvgpr_read_b32 v65, a77
  v_accvgpr_read_b32 v66, a78
  v_accvgpr_read_b32 v67, a79
  v_mul_f32 v64, v64, v205
  v_mul_f32 v65, v65, v205
  v_mul_f32 v66, v66, v205
  v_mul_f32 v67, v67, v205
  v_accvgpr_write_b32 a76, v64
  v_accvgpr_write_b32 a77, v65
  v_accvgpr_write_b32 a78, v66
  v_accvgpr_write_b32 a79, v67
  v_accvgpr_read_b32 v64, a92
  v_accvgpr_read_b32 v65, a93
  v_accvgpr_read_b32 v66, a94
  v_accvgpr_read_b32 v67, a95
  v_mul_f32 v64, v64, v205
  v_mul_f32 v65, v65, v205
  v_mul_f32 v66, v66, v205
  v_mul_f32 v67, v67, v205
  v_accvgpr_write_b32 a92, v64
  v_accvgpr_write_b32 a93, v65
  v_accvgpr_write_b32 a94, v66
  v_accvgpr_write_b32 a95, v67
  v_accvgpr_read_b32 v64, a108
  v_accvgpr_read_b32 v65, a109
  v_accvgpr_read_b32 v66, a110
  v_accvgpr_read_b32 v67, a111
  v_mul_f32 v64, v64, v205
  v_mul_f32 v65, v65, v205
  v_mul_f32 v66, v66, v205
  v_mul_f32 v67, v67, v205
  v_accvgpr_write_b32 a108, v64
  v_accvgpr_write_b32 a109, v65
  v_accvgpr_write_b32 a110, v66
  v_accvgpr_write_b32 a111, v67
  v_accvgpr_read_b32 v64, a124
  v_accvgpr_read_b32 v65, a125
  v_accvgpr_read_b32 v66, a126
  v_accvgpr_read_b32 v67, a127
  v_mul_f32 v64, v64, v205
  v_mul_f32 v65, v65, v205
  v_mul_f32 v66, v66, v205
  v_mul_f32 v67, v67, v205
  v_accvgpr_write_b32 a124, v64
  v_accvgpr_write_b32 a125, v65
  v_accvgpr_write_b32 a126, v66
  v_accvgpr_write_b32 a127, v67
  ds_read_b64_tr_b16 a[160:161], v216 offset:49152
  ds_read_b64_tr_b16 a[162:163], v216 offset:53248
  ds_read_b64_tr_b16 a[164:165], v216 offset:57344
  ds_read_b64_tr_b16 a[166:167], v216 offset:61440
  s_waitcnt lgkmcnt(2)
  v_mfma_f32_16x16x32_bf16 a[0:3], a[160:163], v[0:3], a[0:3]
  s_waitcnt lgkmcnt(0)
  v_mfma_f32_16x16x32_bf16 a[0:3], a[164:167], v[32:35], a[0:3]
  v_mfma_f32_16x16x32_bf16 a[4:7], a[164:167], v[40:43], a[4:7]
  v_mfma_f32_16x16x32_bf16 a[4:7], a[160:163], v[8:11], a[4:7]
  v_mfma_f32_16x16x32_bf16 a[8:11], a[160:163], v[16:19], a[8:11]
  v_mfma_f32_16x16x32_bf16 a[8:11], a[164:167], v[48:51], a[8:11]
  v_mfma_f32_16x16x32_bf16 a[12:15], a[164:167], v[56:59], a[12:15]
  v_mfma_f32_16x16x32_bf16 a[12:15], a[160:163], v[24:27], a[12:15]
  ds_read_b64_tr_b16 a[168:169], v217 offset:49152
  ds_read_b64_tr_b16 a[170:171], v217 offset:53248
  ds_read_b64_tr_b16 a[172:173], v217 offset:57344
  ds_read_b64_tr_b16 a[174:175], v217 offset:61440
  s_waitcnt lgkmcnt(2)
  v_mfma_f32_16x16x32_bf16 a[16:19], a[168:171], v[0:3], a[16:19]
  s_waitcnt lgkmcnt(0)
  v_mfma_f32_16x16x32_bf16 a[16:19], a[172:175], v[32:35], a[16:19]
  v_mfma_f32_16x16x32_bf16 a[20:23], a[172:175], v[40:43], a[20:23]
  v_mfma_f32_16x16x32_bf16 a[20:23], a[168:171], v[8:11], a[20:23]
  v_mfma_f32_16x16x32_bf16 a[24:27], a[168:171], v[16:19], a[24:27]
  v_mfma_f32_16x16x32_bf16 a[24:27], a[172:175], v[48:51], a[24:27]
  v_mfma_f32_16x16x32_bf16 a[28:31], a[172:175], v[56:59], a[28:31]
  v_mfma_f32_16x16x32_bf16 a[28:31], a[168:171], v[24:27], a[28:31]
  ds_read_b64_tr_b16 a[176:177], v218 offset:49152
  ds_read_b64_tr_b16 a[178:179], v218 offset:53248
  ds_read_b64_tr_b16 a[180:181], v218 offset:57344
  ds_read_b64_tr_b16 a[182:183], v218 offset:61440
  s_waitcnt lgkmcnt(2)
  v_mfma_f32_16x16x32_bf16 a[32:35], a[176:179], v[0:3], a[32:35]
  s_waitcnt lgkmcnt(0)
  v_mfma_f32_16x16x32_bf16 a[32:35], a[180:183], v[32:35], a[32:35]
  v_mfma_f32_16x16x32_bf16 a[36:39], a[180:183], v[40:43], a[36:39]
  v_mfma_f32_16x16x32_bf16 a[36:39], a[176:179], v[8:11], a[36:39]
  v_mfma_f32_16x16x32_bf16 a[40:43], a[176:179], v[16:19], a[40:43]
  v_mfma_f32_16x16x32_bf16 a[40:43], a[180:183], v[48:51], a[40:43]
  v_mfma_f32_16x16x32_bf16 a[44:47], a[180:183], v[56:59], a[44:47]
  v_mfma_f32_16x16x32_bf16 a[44:47], a[176:179], v[24:27], a[44:47]
  ds_read_b64_tr_b16 a[184:185], v219 offset:49152
  ds_read_b64_tr_b16 a[186:187], v219 offset:53248
  ds_read_b64_tr_b16 a[188:189], v219 offset:57344
  ds_read_b64_tr_b16 a[190:191], v219 offset:61440
  s_waitcnt lgkmcnt(2)
  v_mfma_f32_16x16x32_bf16 a[48:51], a[184:187], v[0:3], a[48:51]
  s_waitcnt lgkmcnt(0)
  v_mfma_f32_16x16x32_bf16 a[48:51], a[188:191], v[32:35], a[48:51]
  v_mfma_f32_16x16x32_bf16 a[52:55], a[188:191], v[40:43], a[52:55]
  v_mfma_f32_16x16x32_bf16 a[52:55], a[184:187], v[8:11], a[52:55]
  v_mfma_f32_16x16x32_bf16 a[56:59], a[184:187], v[16:19], a[56:59]
  v_mfma_f32_16x16x32_bf16 a[56:59], a[188:191], v[48:51], a[56:59]
  v_mfma_f32_16x16x32_bf16 a[60:63], a[188:191], v[56:59], a[60:63]
  v_mfma_f32_16x16x32_bf16 a[60:63], a[184:187], v[24:27], a[60:63]
  ds_read_b64_tr_b16 a[160:161], v220 offset:49152
  ds_read_b64_tr_b16 a[162:163], v220 offset:53248
  ds_read_b64_tr_b16 a[164:165], v220 offset:57344
  ds_read_b64_tr_b16 a[166:167], v220 offset:61440
  s_waitcnt lgkmcnt(2)
  v_mfma_f32_16x16x32_bf16 a[64:67], a[160:163], v[0:3], a[64:67]
  s_waitcnt lgkmcnt(0)
  v_mfma_f32_16x16x32_bf16 a[64:67], a[164:167], v[32:35], a[64:67]
  v_mfma_f32_16x16x32_bf16 a[68:71], a[164:167], v[40:43], a[68:71]
  v_mfma_f32_16x16x32_bf16 a[68:71], a[160:163], v[8:11], a[68:71]
  v_mfma_f32_16x16x32_bf16 a[72:75], a[160:163], v[16:19], a[72:75]
  v_mfma_f32_16x16x32_bf16 a[72:75], a[164:167], v[48:51], a[72:75]
  v_mfma_f32_16x16x32_bf16 a[76:79], a[164:167], v[56:59], a[76:79]
  v_mfma_f32_16x16x32_bf16 a[76:79], a[160:163], v[24:27], a[76:79]
  ds_read_b64_tr_b16 a[168:169], v221 offset:49152
  ds_read_b64_tr_b16 a[170:171], v221 offset:53248
  ds_read_b64_tr_b16 a[172:173], v221 offset:57344
  ds_read_b64_tr_b16 a[174:175], v221 offset:61440
  s_waitcnt lgkmcnt(2)
  v_mfma_f32_16x16x32_bf16 a[80:83], a[168:171], v[0:3], a[80:83]
  s_waitcnt lgkmcnt(0)
  v_mfma_f32_16x16x32_bf16 a[80:83], a[172:175], v[32:35], a[80:83]
  v_mfma_f32_16x16x32_bf16 a[84:87], a[172:175], v[40:43], a[84:87]
  v_mfma_f32_16x16x32_bf16 a[84:87], a[168:171], v[8:11], a[84:87]
  v_mfma_f32_16x16x32_bf16 a[88:91], a[168:171], v[16:19], a[88:91]
  v_mfma_f32_16x16x32_bf16 a[88:91], a[172:175], v[48:51], a[88:91]
  v_mfma_f32_16x16x32_bf16 a[92:95], a[172:175], v[56:59], a[92:95]
  v_mfma_f32_16x16x32_bf16 a[92:95], a[168:171], v[24:27], a[92:95]
  ds_read_b64_tr_b16 a[176:177], v222 offset:49152
  ds_read_b64_tr_b16 a[178:179], v222 offset:53248
  ds_read_b64_tr_b16 a[180:181], v222 offset:57344
  ds_read_b64_tr_b16 a[182:183], v222 offset:61440
  s_waitcnt lgkmcnt(2)
  v_mfma_f32_16x16x32_bf16 a[96:99], a[176:179], v[0:3], a[96:99]
  s_waitcnt lgkmcnt(0)
  v_mfma_f32_16x16x32_bf16 a[96:99], a[180:183], v[32:35], a[96:99]
  v_mfma_f32_16x16x32_bf16 a[100:103], a[180:183], v[40:43], a[100:103]
  v_mfma_f32_16x16x32_bf16 a[100:103], a[176:179], v[8:11], a[100:103]
  v_mfma_f32_16x16x32_bf16 a[104:107], a[176:179], v[16:19], a[104:107]
  v_mfma_f32_16x16x32_bf16 a[104:107], a[180:183], v[48:51], a[104:107]
  v_mfma_f32_16x16x32_bf16 a[108:111], a[180:183], v[56:59], a[108:111]
  v_mfma_f32_16x16x32_bf16 a[108:111], a[176:179], v[24:27], a[108:111]
  ds_read_b64_tr_b16 a[184:185], v223 offset:49152
  ds_read_b64_tr_b16 a[186:187], v223 offset:53248
  ds_read_b64_tr_b16 a[188:189], v223 offset:57344
  ds_read_b64_tr_b16 a[190:191], v223 offset:61440
  s_waitcnt lgkmcnt(2)
  v_mfma_f32_16x16x32_bf16 a[112:115], a[184:187], v[0:3], a[112:115]
  s_waitcnt lgkmcnt(0)
  v_mfma_f32_16x16x32_bf16 a[112:115], a[188:191], v[32:35], a[112:115]
  v_mfma_f32_16x16x32_bf16 a[116:119], a[188:191], v[40:43], a[116:119]
  v_mfma_f32_16x16x32_bf16 a[116:119], a[184:187], v[8:11], a[116:119]
  v_mfma_f32_16x16x32_bf16 a[120:123], a[184:187], v[16:19], a[120:123]
  v_mfma_f32_16x16x32_bf16 a[120:123], a[188:191], v[48:51], a[120:123]
  v_mfma_f32_16x16x32_bf16 a[124:127], a[188:191], v[56:59], a[124:127]
  v_mfma_f32_16x16x32_bf16 a[124:127], a[184:187], v[24:27], a[124:127]
  s_add_u32 s29, s29, 16384
  s_cmp_lt_u32 s29, 524288
  s_cbranch_scc1 attn_slow
  v_mov_b32 v245, v208
  v_mov_b32 v246, v209
  v_mov_b32 v247, v210
  v_mov_b32 v248, v211
  v_permlane16_swap_b32 v208, v245
  v_permlane16_swap_b32 v209, v246
  v_permlane16_swap_b32 v210, v247
  v_permlane16_swap_b32 v211, v248
  v_add_f32 v208, v208, v245
  v_add_f32 v209, v209, v246
  v_add_f32 v210, v210, v247
  v_add_f32 v211, v211, v248
  v_mov_b32 v245, v208
  v_mov_b32 v246, v209
  v_mov_b32 v247, v210
  v_mov_b32 v248, v211
  v_permlane32_swap_b32 v208, v245
  v_permlane32_swap_b32 v209, v246
  v_permlane32_swap_b32 v210, v247
  v_permlane32_swap_b32 v211, v248
  v_add_f32 v208, v208, v245
  v_add_f32 v209, v209, v246
  v_add_f32 v210, v210, v247
  v_add_f32 v211, v211, v248
  v_rcp_f32 v192, v208
  v_rcp_f32 v196, v209
  v_rcp_f32 v200, v210
  v_rcp_f32 v204, v211
  v_accvgpr_read_b32 v0, a0
  v_accvgpr_read_b32 v1, a1
  v_accvgpr_read_b32 v2, a2
  v_accvgpr_read_b32 v3, a3
  v_accvgpr_read_b32 v4, a16
  v_accvgpr_read_b32 v5, a17
  v_accvgpr_read_b32 v6, a18
  v_accvgpr_read_b32 v7, a19
  v_mul_f32 v0, v0, v192
  v_mul_f32 v1, v1, v192
  v_mul_f32 v2, v2, v192
  v_mul_f32 v3, v3, v192
  v_mul_f32 v4, v4, v192
  v_mul_f32 v5, v5, v192
  v_mul_f32 v6, v6, v192
  v_mul_f32 v7, v7, v192
  v_cvt_pk_bf16_f32 v0, v0, v1
  v_cvt_pk_bf16_f32 v1, v2, v3
  v_cvt_pk_bf16_f32 v2, v4, v5
  v_cvt_pk_bf16_f32 v3, v6, v7
  buffer_store_dwordx4 v[0:3], v244, s[24:27], s40 offen offset:0 sc1
  v_accvgpr_read_b32 v8, a4
  v_accvgpr_read_b32 v9, a5
  v_accvgpr_read_b32 v10, a6
  v_accvgpr_read_b32 v11, a7
  v_accvgpr_read_b32 v12, a20
  v_accvgpr_read_b32 v13, a21
  v_accvgpr_read_b32 v14, a22
  v_accvgpr_read_b32 v15, a23
  v_mul_f32 v8, v8, v196
  v_mul_f32 v9, v9, v196
  v_mul_f32 v10, v10, v196
  v_mul_f32 v11, v11, v196
  v_mul_f32 v12, v12, v196
  v_mul_f32 v13, v13, v196
  v_mul_f32 v14, v14, v196
  v_mul_f32 v15, v15, v196
  v_cvt_pk_bf16_f32 v8, v8, v9
  v_cvt_pk_bf16_f32 v9, v10, v11
  v_cvt_pk_bf16_f32 v10, v12, v13
  v_cvt_pk_bf16_f32 v11, v14, v15
  buffer_store_dwordx4 v[8:11], v244, s[24:27], s40 offen offset:2048 sc1
  v_accvgpr_read_b32 v16, a8
  v_accvgpr_read_b32 v17, a9
  v_accvgpr_read_b32 v18, a10
  v_accvgpr_read_b32 v19, a11
  v_accvgpr_read_b32 v20, a24
  v_accvgpr_read_b32 v21, a25
  v_accvgpr_read_b32 v22, a26
  v_accvgpr_read_b32 v23, a27
  v_mul_f32 v16, v16, v200
  v_mul_f32 v17, v17, v200
  v_mul_f32 v18, v18, v200
  v_mul_f32 v19, v19, v200
  v_mul_f32 v20, v20, v200
  v_mul_f32 v21, v21, v200
  v_mul_f32 v22, v22, v200
  v_mul_f32 v23, v23, v200
  v_cvt_pk_bf16_f32 v16, v16, v17
  v_cvt_pk_bf16_f32 v17, v18, v19
  v_cvt_pk_bf16_f32 v18, v20, v21
  v_cvt_pk_bf16_f32 v19, v22, v23
  buffer_store_dwordx4 v[16:19], v244, s[24:27], s41 offen offset:0 sc1
  v_accvgpr_read_b32 v24, a12
  v_accvgpr_read_b32 v25, a13
  v_accvgpr_read_b32 v26, a14
  v_accvgpr_read_b32 v27, a15
  v_accvgpr_read_b32 v28, a28
  v_accvgpr_read_b32 v29, a29
  v_accvgpr_read_b32 v30, a30
  v_accvgpr_read_b32 v31, a31
  v_mul_f32 v24, v24, v204
  v_mul_f32 v25, v25, v204
  v_mul_f32 v26, v26, v204
  v_mul_f32 v27, v27, v204
  v_mul_f32 v28, v28, v204
  v_mul_f32 v29, v29, v204
  v_mul_f32 v30, v30, v204
  v_mul_f32 v31, v31, v204
  v_cvt_pk_bf16_f32 v24, v24, v25
  v_cvt_pk_bf16_f32 v25, v26, v27
  v_cvt_pk_bf16_f32 v26, v28, v29
  v_cvt_pk_bf16_f32 v27, v30, v31
  buffer_store_dwordx4 v[24:27], v244, s[24:27], s41 offen offset:2048 sc1
  v_accvgpr_read_b32 v32, a32
  v_accvgpr_read_b32 v33, a33
  v_accvgpr_read_b32 v34, a34
  v_accvgpr_read_b32 v35, a35
  v_accvgpr_read_b32 v36, a48
  v_accvgpr_read_b32 v37, a49
  v_accvgpr_read_b32 v38, a50
  v_accvgpr_read_b32 v39, a51
  v_mul_f32 v32, v32, v192
  v_mul_f32 v33, v33, v192
  v_mul_f32 v34, v34, v192
  v_mul_f32 v35, v35, v192
  v_mul_f32 v36, v36, v192
  v_mul_f32 v37, v37, v192
  v_mul_f32 v38, v38, v192
  v_mul_f32 v39, v39, v192
  v_cvt_pk_bf16_f32 v32, v32, v33
  v_cvt_pk_bf16_f32 v33, v34, v35
  v_cvt_pk_bf16_f32 v34, v36, v37
  v_cvt_pk_bf16_f32 v35, v38, v39
  buffer_store_dwordx4 v[32:35], v244, s[24:27], s40 offen offset:1024 sc1
  v_accvgpr_read_b32 v40, a36
  v_accvgpr_read_b32 v41, a37
  v_accvgpr_read_b32 v42, a38
  v_accvgpr_read_b32 v43, a39
  v_accvgpr_read_b32 v44, a52
  v_accvgpr_read_b32 v45, a53
  v_accvgpr_read_b32 v46, a54
  v_accvgpr_read_b32 v47, a55
  v_mul_f32 v40, v40, v196
  v_mul_f32 v41, v41, v196
  v_mul_f32 v42, v42, v196
  v_mul_f32 v43, v43, v196
  v_mul_f32 v44, v44, v196
  v_mul_f32 v45, v45, v196
  v_mul_f32 v46, v46, v196
  v_mul_f32 v47, v47, v196
  v_cvt_pk_bf16_f32 v40, v40, v41
  v_cvt_pk_bf16_f32 v41, v42, v43
  v_cvt_pk_bf16_f32 v42, v44, v45
  v_cvt_pk_bf16_f32 v43, v46, v47
  buffer_store_dwordx4 v[40:43], v244, s[24:27], s40 offen offset:3072 sc1
  v_accvgpr_read_b32 v48, a40
  v_accvgpr_read_b32 v49, a41
  v_accvgpr_read_b32 v50, a42
  v_accvgpr_read_b32 v51, a43
  v_accvgpr_read_b32 v52, a56
  v_accvgpr_read_b32 v53, a57
  v_accvgpr_read_b32 v54, a58
  v_accvgpr_read_b32 v55, a59
  v_mul_f32 v48, v48, v200
  v_mul_f32 v49, v49, v200
  v_mul_f32 v50, v50, v200
  v_mul_f32 v51, v51, v200
  v_mul_f32 v52, v52, v200
  v_mul_f32 v53, v53, v200
  v_mul_f32 v54, v54, v200
  v_mul_f32 v55, v55, v200
  v_cvt_pk_bf16_f32 v48, v48, v49
  v_cvt_pk_bf16_f32 v49, v50, v51
  v_cvt_pk_bf16_f32 v50, v52, v53
  v_cvt_pk_bf16_f32 v51, v54, v55
  buffer_store_dwordx4 v[48:51], v244, s[24:27], s41 offen offset:1024 sc1
  v_accvgpr_read_b32 v56, a44
  v_accvgpr_read_b32 v57, a45
  v_accvgpr_read_b32 v58, a46
  v_accvgpr_read_b32 v59, a47
  v_accvgpr_read_b32 v60, a60
  v_accvgpr_read_b32 v61, a61
  v_accvgpr_read_b32 v62, a62
  v_accvgpr_read_b32 v63, a63
  v_mul_f32 v56, v56, v204
  v_mul_f32 v57, v57, v204
  v_mul_f32 v58, v58, v204
  v_mul_f32 v59, v59, v204
  v_mul_f32 v60, v60, v204
  v_mul_f32 v61, v61, v204
  v_mul_f32 v62, v62, v204
  v_mul_f32 v63, v63, v204
  v_cvt_pk_bf16_f32 v56, v56, v57
  v_cvt_pk_bf16_f32 v57, v58, v59
  v_cvt_pk_bf16_f32 v58, v60, v61
  v_cvt_pk_bf16_f32 v59, v62, v63
  buffer_store_dwordx4 v[56:59], v244, s[24:27], s41 offen offset:3072 sc1
  v_accvgpr_read_b32 v0, a64
  v_accvgpr_read_b32 v1, a65
  v_accvgpr_read_b32 v2, a66
  v_accvgpr_read_b32 v3, a67
  v_accvgpr_read_b32 v4, a80
  v_accvgpr_read_b32 v5, a81
  v_accvgpr_read_b32 v6, a82
  v_accvgpr_read_b32 v7, a83
  v_mul_f32 v0, v0, v192
  v_mul_f32 v1, v1, v192
  v_mul_f32 v2, v2, v192
  v_mul_f32 v3, v3, v192
  v_mul_f32 v4, v4, v192
  v_mul_f32 v5, v5, v192
  v_mul_f32 v6, v6, v192
  v_mul_f32 v7, v7, v192
  v_cvt_pk_bf16_f32 v0, v0, v1
  v_cvt_pk_bf16_f32 v1, v2, v3
  v_cvt_pk_bf16_f32 v2, v4, v5
  v_cvt_pk_bf16_f32 v3, v6, v7
  buffer_store_dwordx4 v[0:3], v244, s[24:27], s42 offen offset:0 sc1
  v_accvgpr_read_b32 v8, a68
  v_accvgpr_read_b32 v9, a69
  v_accvgpr_read_b32 v10, a70
  v_accvgpr_read_b32 v11, a71
  v_accvgpr_read_b32 v12, a84
  v_accvgpr_read_b32 v13, a85
  v_accvgpr_read_b32 v14, a86
  v_accvgpr_read_b32 v15, a87
  v_mul_f32 v8, v8, v196
  v_mul_f32 v9, v9, v196
  v_mul_f32 v10, v10, v196
  v_mul_f32 v11, v11, v196
  v_mul_f32 v12, v12, v196
  v_mul_f32 v13, v13, v196
  v_mul_f32 v14, v14, v196
  v_mul_f32 v15, v15, v196
  v_cvt_pk_bf16_f32 v8, v8, v9
  v_cvt_pk_bf16_f32 v9, v10, v11
  v_cvt_pk_bf16_f32 v10, v12, v13
  v_cvt_pk_bf16_f32 v11, v14, v15
  buffer_store_dwordx4 v[8:11], v244, s[24:27], s42 offen offset:2048 sc1
  v_accvgpr_read_b32 v16, a72
  v_accvgpr_read_b32 v17, a73
  v_accvgpr_read_b32 v18, a74
  v_accvgpr_read_b32 v19, a75
  v_accvgpr_read_b32 v20, a88
  v_accvgpr_read_b32 v21, a89
  v_accvgpr_read_b32 v22, a90
  v_accvgpr_read_b32 v23, a91
  v_mul_f32 v16, v16, v200
  v_mul_f32 v17, v17, v200
  v_mul_f32 v18, v18, v200
  v_mul_f32 v19, v19, v200
  v_mul_f32 v20, v20, v200
  v_mul_f32 v21, v21, v200
  v_mul_f32 v22, v22, v200
  v_mul_f32 v23, v23, v200
  v_cvt_pk_bf16_f32 v16, v16, v17
  v_cvt_pk_bf16_f32 v17, v18, v19
  v_cvt_pk_bf16_f32 v18, v20, v21
  v_cvt_pk_bf16_f32 v19, v22, v23
  buffer_store_dwordx4 v[16:19], v244, s[24:27], s43 offen offset:0 sc1
  v_accvgpr_read_b32 v24, a76
  v_accvgpr_read_b32 v25, a77
  v_accvgpr_read_b32 v26, a78
  v_accvgpr_read_b32 v27, a79
  v_accvgpr_read_b32 v28, a92
  v_accvgpr_read_b32 v29, a93
  v_accvgpr_read_b32 v30, a94
  v_accvgpr_read_b32 v31, a95
  v_mul_f32 v24, v24, v204
  v_mul_f32 v25, v25, v204
  v_mul_f32 v26, v26, v204
  v_mul_f32 v27, v27, v204
  v_mul_f32 v28, v28, v204
  v_mul_f32 v29, v29, v204
  v_mul_f32 v30, v30, v204
  v_mul_f32 v31, v31, v204
  v_cvt_pk_bf16_f32 v24, v24, v25
  v_cvt_pk_bf16_f32 v25, v26, v27
  v_cvt_pk_bf16_f32 v26, v28, v29
  v_cvt_pk_bf16_f32 v27, v30, v31
  buffer_store_dwordx4 v[24:27], v244, s[24:27], s43 offen offset:2048 sc1
  v_accvgpr_read_b32 v32, a96
  v_accvgpr_read_b32 v33, a97
  v_accvgpr_read_b32 v34, a98
  v_accvgpr_read_b32 v35, a99
  v_accvgpr_read_b32 v36, a112
  v_accvgpr_read_b32 v37, a113
  v_accvgpr_read_b32 v38, a114
  v_accvgpr_read_b32 v39, a115
  v_mul_f32 v32, v32, v192
  v_mul_f32 v33, v33, v192
  v_mul_f32 v34, v34, v192
  v_mul_f32 v35, v35, v192
  v_mul_f32 v36, v36, v192
  v_mul_f32 v37, v37, v192
  v_mul_f32 v38, v38, v192
  v_mul_f32 v39, v39, v192
  v_cvt_pk_bf16_f32 v32, v32, v33
  v_cvt_pk_bf16_f32 v33, v34, v35
  v_cvt_pk_bf16_f32 v34, v36, v37
  v_cvt_pk_bf16_f32 v35, v38, v39
  buffer_store_dwordx4 v[32:35], v244, s[24:27], s42 offen offset:1024 sc1
  v_accvgpr_read_b32 v40, a100
  v_accvgpr_read_b32 v41, a101
  v_accvgpr_read_b32 v42, a102
  v_accvgpr_read_b32 v43, a103
  v_accvgpr_read_b32 v44, a116
  v_accvgpr_read_b32 v45, a117
  v_accvgpr_read_b32 v46, a118
  v_accvgpr_read_b32 v47, a119
  v_mul_f32 v40, v40, v196
  v_mul_f32 v41, v41, v196
  v_mul_f32 v42, v42, v196
  v_mul_f32 v43, v43, v196
  v_mul_f32 v44, v44, v196
  v_mul_f32 v45, v45, v196
  v_mul_f32 v46, v46, v196
  v_mul_f32 v47, v47, v196
  v_cvt_pk_bf16_f32 v40, v40, v41
  v_cvt_pk_bf16_f32 v41, v42, v43
  v_cvt_pk_bf16_f32 v42, v44, v45
  v_cvt_pk_bf16_f32 v43, v46, v47
  buffer_store_dwordx4 v[40:43], v244, s[24:27], s42 offen offset:3072 sc1
  v_accvgpr_read_b32 v48, a104
  v_accvgpr_read_b32 v49, a105
  v_accvgpr_read_b32 v50, a106
  v_accvgpr_read_b32 v51, a107
  v_accvgpr_read_b32 v52, a120
  v_accvgpr_read_b32 v53, a121
  v_accvgpr_read_b32 v54, a122
  v_accvgpr_read_b32 v55, a123
  v_mul_f32 v48, v48, v200
  v_mul_f32 v49, v49, v200
  v_mul_f32 v50, v50, v200
  v_mul_f32 v51, v51, v200
  v_mul_f32 v52, v52, v200
  v_mul_f32 v53, v53, v200
  v_mul_f32 v54, v54, v200
  v_mul_f32 v55, v55, v200
  v_cvt_pk_bf16_f32 v48, v48, v49
  v_cvt_pk_bf16_f32 v49, v50, v51
  v_cvt_pk_bf16_f32 v50, v52, v53
  v_cvt_pk_bf16_f32 v51, v54, v55
  buffer_store_dwordx4 v[48:51], v244, s[24:27], s43 offen offset:1024 sc1
  v_accvgpr_read_b32 v56, a108
  v_accvgpr_read_b32 v57, a109
  v_accvgpr_read_b32 v58, a110
  v_accvgpr_read_b32 v59, a111
  v_accvgpr_read_b32 v60, a124
  v_accvgpr_read_b32 v61, a125
  v_accvgpr_read_b32 v62, a126
  v_accvgpr_read_b32 v63, a127
  v_mul_f32 v56, v56, v204
  v_mul_f32 v57, v57, v204
  v_mul_f32 v58, v58, v204
  v_mul_f32 v59, v59, v204
  v_mul_f32 v60, v60, v204
  v_mul_f32 v61, v61, v204
  v_mul_f32 v62, v62, v204
  v_mul_f32 v63, v63, v204
  v_cvt_pk_bf16_f32 v56, v56, v57
  v_cvt_pk_bf16_f32 v57, v58, v59
  v_cvt_pk_bf16_f32 v58, v60, v61
  v_cvt_pk_bf16_f32 v59, v62, v63
  buffer_store_dwordx4 v[56:59], v244, s[24:27], s43 offen offset:3072 sc1
  v_add_u32 v252, 4096, v242
  v_add_u32 v253, 8192, v242
  buffer_load_dwordx4 a[128:131], v253, s[24:27], s4 offen offset:3072 sc1
  buffer_load_dwordx4 a[132:135], v242, s[24:27], s5 offen offset:0 sc1
  buffer_load_dwordx4 a[136:139], v242, s[24:27], s5 offen offset:1024 sc1
  buffer_load_dwordx4 a[140:143], v242, s[24:27], s5 offen offset:2048 sc1
  buffer_load_dwordx4 a[144:147], v242, s[24:27], s5 offen offset:3072 sc1
  buffer_load_dwordx4 a[148:151], v252, s[24:27], s5 offen offset:0 sc1
  buffer_load_dwordx4 a[152:155], v252, s[24:27], s5 offen offset:1024 sc1
  buffer_load_dwordx4 a[156:159], v252, s[24:27], s5 offen offset:2048 sc1
  buffer_load_dwordx4 a[0:3], v252, s[24:27], s5 offen offset:3072 sc1
  buffer_load_dwordx4 a[4:7], v253, s[24:27], s5 offen offset:0 sc1
  buffer_load_dwordx4 a[8:11], v253, s[24:27], s5 offen offset:1024 sc1
  buffer_load_dwordx4 a[12:15], v253, s[24:27], s5 offen offset:2048 sc1
  buffer_load_dwordx4 a[16:19], v253, s[24:27], s5 offen offset:3072 sc1
  buffer_load_dwordx4 a[20:23], v242, s[24:27], s6 offen offset:0 sc1
  buffer_load_dwordx4 a[24:27], v242, s[24:27], s6 offen offset:1024 sc1
  buffer_load_dwordx4 a[28:31], v242, s[24:27], s6 offen offset:2048 sc1
  buffer_load_dwordx4 a[32:35], v242, s[24:27], s6 offen offset:3072 sc1
  buffer_load_dwordx4 a[36:39], v252, s[24:27], s6 offen offset:0 sc1
  s_and_b32 s39, s2, 63
  s_lshl_b32 s39, s39, 7
  s_add_u32 s39, s39, 2867200
  s_lshl_b32 s38, s3, 26
  v_lshlrev_b32 v64, 22, v242
  v_or_b32 v64, s38, v64
  v_mov_b32 v65, 1
  s_waitcnt vmcnt(0)
  s_barrier
  s_branch tail_go
.section .rodata,"a"
.p2align 6
.amdhsa_kernel recurrent_scan__mha_block_cached__moe_arch_mod__prompt_kernel
  .amdhsa_next_free_vgpr 512
  .amdhsa_next_free_sgpr 102
  .amdhsa_accum_offset 256
  .amdhsa_group_segment_fixed_size 0
  .amdhsa_kernarg_size 104
  .amdhsa_user_sgpr_count 2
  .amdhsa_user_sgpr_kernarg_segment_ptr 1
  .amdhsa_system_sgpr_workgroup_id_x 1
.end_amdhsa_kernel
```

```asm
; @launch grid=(256,1,1) block=(256,1,1) lds=163840
.amdgcn_target "amdgcn-amd-amdhsa--gfx950"
.text
.globl recurrent_scan__mha_block_cached__moe_arch_mod__prompt_kernel
.p2align 8
.type recurrent_scan__mha_block_cached__moe_arch_mod__prompt_kernel,@function
recurrent_scan__mha_block_cached__moe_arch_mod__prompt_kernel:
  s_cmp_ge_u32 s2, 256
  s_cbranch_scc1 attn_end
  s_load_dwordx2 s[60:61], s[0:1], 0
  s_load_dwordx2 s[48:49], s[0:1], 48
  s_load_dwordx4 s[4:7], s[0:1], 8
  s_load_dwordx2 s[8:9], s[0:1], 24
  s_load_dwordx2 s[10:11], s[0:1], 96
  s_load_dwordx2 s[88:89], s[0:1], 32
  s_load_dwordx2 s[90:91], s[0:1], 56
  s_load_dwordx4 s[92:95], s[0:1], 64
  s_load_dwordx2 s[62:63], s[0:1], 80
  v_lshrrev_b32 v249, 6, v0
  v_and_b32 v0, 63, v0
  v_mov_b32 v245, v0
  v_readfirstlane_b32 s3, v249
  s_and_b32 s36, s2, 7
  s_lshl_b32 s36, s36, 2
  s_lshr_b32 s37, s2, 6
  s_add_u32 s36, s36, s37
  s_bfe_u32 s37, s2, 0x30003
  s_lshl_b32 s37, s37, 2
  s_add_u32 s37, s37, s3
  s_lshl_b32 s28, s3, 12
  v_lshrrev_b32 v248, 4, v245
  v_and_b32 v247, 15, v245
  s_lshl_b32 s38, s3, 17
  v_lshlrev_b32 v249, 13, v248
  v_add_u32 v249, s38, v249
  v_or_b32 v250, 0, v248
  v_lshlrev_b32 v250, 1, v250
  v_xor_b32 v250, v250, v247
  v_lshl_add_u32 v238, v250, 4, v249
  v_or_b32 v250, 0, v248
  v_lshlrev_b32 v250, 1, v250
  v_xor_b32 v250, v250, v247
  v_lshl_add_u32 v239, v250, 4, v249
  v_add_u32 v239, 31744, v239
  v_or_b32 v250, 4, v248
  v_lshlrev_b32 v250, 1, v250
  v_xor_b32 v250, v250, v247
  v_lshl_add_u32 v240, v250, 4, v249
  v_add_u32 v240, 63488, v240
  v_or_b32 v250, 4, v248
  v_lshlrev_b32 v250, 1, v250
  v_xor_b32 v250, v250, v247
  v_lshl_add_u32 v241, v250, 4, v249
  v_add_u32 v241, 95232, v241
  s_waitcnt lgkmcnt(0)
  s_add_u32 s58, s10, 2830336
  s_addc_u32 s59, s11, 0
  s_load_dword s59, s[58:59], 0
  s_mov_b32 s24, s10
  s_mov_b32 s25, s11
  s_mov_b32 s26, 33554432
  s_mov_b32 s27, 0x20000
  s_lshl_b32 s38, s36, 8
  s_add_u32 s20, s8, s38
  s_addc_u32 s21, s9, 0
  s_mov_b32 s22, 5242880
  s_mov_b32 s23, 0x20000
  s_sub_u32 s22, s22, s38
  s_cmp_ge_u32 s3, 2
  s_cbranch_scc1 front_fetch
  s_mov_b32 s12, s60
  s_mov_b32 s13, s61
  s_mov_b32 s14, 2621440
  s_mov_b32 s15, 0x20000
  s_mov_b32 s16, s48
  s_mov_b32 s17, s49
  s_mov_b32 s18, 1280
  s_mov_b32 s19, 0x20000
  s_lshr_b32 s52, s37, 2
  s_lshl_b32 s52, s52, 5
  s_add_u32 s52, s52, s36
  s_lshl_b32 s52, s52, 1
  s_add_u32 s52, s52, s3
  s_lshl_b32 s52, s52, 2
  s_mul_i32 s53, s52, 1280
  v_lshrrev_b32 v1, 4, v0
  v_and_b32 v2, 15, v0
  v_lshlrev_b32 v3, 4, v2
  v_mul_u32_u24 v4, 0x500, v1
  v_add_u32 v4, v4, v3
  buffer_load_dwordx4 v[8:11], v4, s[12:15], s53 offen offset:0
  buffer_load_dwordx4 v[12:15], v4, s[12:15], s53 offen offset:256
  buffer_load_dwordx4 v[16:19], v4, s[12:15], s53 offen offset:512
  buffer_load_dwordx4 v[20:23], v4, s[12:15], s53 offen offset:768
  buffer_load_dwordx4 v[24:27], v4, s[12:15], s53 offen offset:1024
  buffer_load_dwordx4 v[28:31], v3, s[16:19], 0 offen offset:0
  buffer_load_dwordx4 v[32:35], v3, s[16:19], 0 offen offset:256
  buffer_load_dwordx4 v[36:39], v3, s[16:19], 0 offen offset:512
  buffer_load_dwordx4 v[40:43], v3, s[16:19], 0 offen offset:768
  buffer_load_dwordx4 v[44:47], v3, s[16:19], 0 offen offset:1024
  v_mov_b32 v7, 0
  v_lshlrev_b32 v6, 26, v0
  s_lshl_b32 s53, s2, 7
  s_add_u32 s53, s53, 2834432
  buffer_store_dword v7, v6, s[24:27], s53 offen sc1
  v_lshlrev_b32 v6, 8, v0
  v_lshrrev_b32 v5, 5, v0
  v_lshl_add_u32 v6, v5, 26, v6
  s_cmp_eq_u32 s2, 0
  s_cselect_b32 s53, 0, 1073741824
  v_or_b32 v6, s53, v6
  s_mov_b32 s53, 2818048
  buffer_store_dword v7, v6, s[24:27], s53 offen sc1
  v_lshlrev_b32 v6, 7, v0
  s_cmp_eq_u32 s2, 1
  s_cselect_b32 s53, 0, 1073741824
  v_or_b32 v6, s53, v6
  s_mov_b32 s53, 2867200
  buffer_store_dword v7, v6, s[24:27], s53 offen sc1
  s_lshr_b32 s53, s52, 6
  s_mul_i32 s53, s53, 81920
  s_bfe_u32 s54, s52, 0x20004
  s_lshl_b32 s54, s54, 10
  s_add_u32 s53, s53, s54
  s_and_b32 s54, s52, 15
  s_lshl_b32 s54, s54, 4
  s_add_u32 s53, s53, s54
  v_lshrrev_b32 v5, 2, v2
  v_lshlrev_b32 v5, 12, v5
  v_and_b32 v6, 3, v2
  v_lshl_add_u32 v5, v6, 8, v5
  v_lshl_add_u32 v5, v1, 4, v5
  s_mov_b32 s56, 0xffff0000
  s_waitcnt vmcnt(12)
  v_lshlrev_b32 v48, 16, v8
  v_and_b32 v49, s56, v8
  v_lshlrev_b32 v50, 16, v9
  v_and_b32 v51, s56, v9
  v_lshlrev_b32 v52, 16, v10
  v_and_b32 v53, s56, v10
  v_lshlrev_b32 v54, 16, v11
  v_and_b32 v55, s56, v11
  s_waitcnt vmcnt(11)
  v_lshlrev_b32 v56, 16, v12
  v_and_b32 v57, s56, v12
  v_lshlrev_b32 v58, 16, v13
  v_and_b32 v59, s56, v13
  v_lshlrev_b32 v60, 16, v14
  v_and_b32 v61, s56, v14
  v_lshlrev_b32 v62, 16, v15
  v_and_b32 v63, s56, v15
  s_waitcnt vmcnt(10)
  v_lshlrev_b32 v64, 16, v16
  v_and_b32 v65, s56, v16
  v_lshlrev_b32 v66, 16, v17
  v_and_b32 v67, s56, v17
  v_lshlrev_b32 v68, 16, v18
  v_and_b32 v69, s56, v18
  v_lshlrev_b32 v70, 16, v19
  v_and_b32 v71, s56, v19
  s_waitcnt vmcnt(9)
  v_lshlrev_b32 v72, 16, v20
  v_and_b32 v73, s56, v20
  v_lshlrev_b32 v74, 16, v21
  v_and_b32 v75, s56, v21
  v_lshlrev_b32 v76, 16, v22
  v_and_b32 v77, s56, v22
  v_lshlrev_b32 v78, 16, v23
  v_and_b32 v79, s56, v23
  s_waitcnt vmcnt(8)
  v_lshlrev_b32 v80, 16, v24
  v_and_b32 v81, s56, v24
  v_lshlrev_b32 v82, 16, v25
  v_and_b32 v83, s56, v25
  v_lshlrev_b32 v84, 16, v26
  v_and_b32 v85, s56, v26
  v_lshlrev_b32 v86, 16, v27
  v_and_b32 v87, s56, v27
  v_pk_add_f32 v[88:89], v[48:49], v[50:51]
  v_pk_add_f32 v[90:91], v[52:53], v[54:55]
  v_pk_add_f32 v[88:89], v[88:89], v[56:57]
  v_pk_add_f32 v[90:91], v[90:91], v[58:59]
  v_pk_add_f32 v[88:89], v[88:89], v[60:61]
  v_pk_add_f32 v[90:91], v[90:91], v[62:63]
  v_pk_add_f32 v[88:89], v[88:89], v[64:65]
  v_pk_add_f32 v[90:91], v[90:91], v[66:67]
  v_pk_add_f32 v[88:89], v[88:89], v[68:69]
  v_pk_add_f32 v[90:91], v[90:91], v[70:71]
  v_pk_add_f32 v[88:89], v[88:89], v[72:73]
  v_pk_add_f32 v[90:91], v[90:91], v[74:75]
  v_pk_add_f32 v[88:89], v[88:89], v[76:77]
  v_pk_add_f32 v[90:91], v[90:91], v[78:79]
  v_pk_add_f32 v[88:89], v[88:89], v[80:81]
  v_pk_add_f32 v[90:91], v[90:91], v[82:83]
  v_pk_add_f32 v[88:89], v[88:89], v[84:85]
  v_pk_add_f32 v[90:91], v[90:91], v[86:87]
  v_pk_add_f32 v[88:89], v[88:89], v[90:91]
  v_add_f32 v92, v88, v89
  s_nop 1
  v_add_f32_dpp v92, v92, v92 row_ror:8 row_mask:0xf bank_mask:0xf
  s_nop 1
  v_add_f32_dpp v92, v92, v92 row_ror:4 row_mask:0xf bank_mask:0xf
  s_nop 1
  v_add_f32_dpp v92, v92, v92 row_ror:2 row_mask:0xf bank_mask:0xf
  s_nop 1
  v_add_f32_dpp v92, v92, v92 row_ror:1 row_mask:0xf bank_mask:0xf
  v_mul_f32 v92, 0x3acccccd, v92
  v_pk_add_f32 v[94:95], v[48:49], v[92:93] op_sel_hi:[1,0] neg_lo:[0,1] neg_hi:[0,1]
  v_pk_mul_f32 v[88:89], v[94:95], v[94:95]
  v_pk_add_f32 v[96:97], v[50:51], v[92:93] op_sel_hi:[1,0] neg_lo:[0,1] neg_hi:[0,1]
  v_pk_mul_f32 v[90:91], v[96:97], v[96:97]
  v_pk_add_f32 v[94:95], v[52:53], v[92:93] op_sel_hi:[1,0] neg_lo:[0,1] neg_hi:[0,1]
  v_pk_fma_f32 v[88:89], v[94:95], v[94:95], v[88:89]
  v_pk_add_f32 v[96:97], v[54:55], v[92:93] op_sel_hi:[1,0] neg_lo:[0,1] neg_hi:[0,1]
  v_pk_fma_f32 v[90:91], v[96:97], v[96:97], v[90:91]
  v_pk_add_f32 v[94:95], v[56:57], v[92:93] op_sel_hi:[1,0] neg_lo:[0,1] neg_hi:[0,1]
  v_pk_fma_f32 v[88:89], v[94:95], v[94:95], v[88:89]
  v_pk_add_f32 v[96:97], v[58:59], v[92:93] op_sel_hi:[1,0] neg_lo:[0,1] neg_hi:[0,1]
  v_pk_fma_f32 v[90:91], v[96:97], v[96:97], v[90:91]
  v_pk_add_f32 v[94:95], v[60:61], v[92:93] op_sel_hi:[1,0] neg_lo:[0,1] neg_hi:[0,1]
  v_pk_fma_f32 v[88:89], v[94:95], v[94:95], v[88:89]
  v_pk_add_f32 v[96:97], v[62:63], v[92:93] op_sel_hi:[1,0] neg_lo:[0,1] neg_hi:[0,1]
  v_pk_fma_f32 v[90:91], v[96:97], v[96:97], v[90:91]
  v_pk_add_f32 v[94:95], v[64:65], v[92:93] op_sel_hi:[1,0] neg_lo:[0,1] neg_hi:[0,1]
  v_pk_fma_f32 v[88:89], v[94:95], v[94:95], v[88:89]
  v_pk_add_f32 v[96:97], v[66:67], v[92:93] op_sel_hi:[1,0] neg_lo:[0,1] neg_hi:[0,1]
  v_pk_fma_f32 v[90:91], v[96:97], v[96:97], v[90:91]
  v_pk_add_f32 v[94:95], v[68:69], v[92:93] op_sel_hi:[1,0] neg_lo:[0,1] neg_hi:[0,1]
  v_pk_fma_f32 v[88:89], v[94:95], v[94:95], v[88:89]
  v_pk_add_f32 v[96:97], v[70:71], v[92:93] op_sel_hi:[1,0] neg_lo:[0,1] neg_hi:[0,1]
  v_pk_fma_f32 v[90:91], v[96:97], v[96:97], v[90:91]
  v_pk_add_f32 v[94:95], v[72:73], v[92:93] op_sel_hi:[1,0] neg_lo:[0,1] neg_hi:[0,1]
  v_pk_fma_f32 v[88:89], v[94:95], v[94:95], v[88:89]
  v_pk_add_f32 v[96:97], v[74:75], v[92:93] op_sel_hi:[1,0] neg_lo:[0,1] neg_hi:[0,1]
  v_pk_fma_f32 v[90:91], v[96:97], v[96:97], v[90:91]
  v_pk_add_f32 v[94:95], v[76:77], v[92:93] op_sel_hi:[1,0] neg_lo:[0,1] neg_hi:[0,1]
  v_pk_fma_f32 v[88:89], v[94:95], v[94:95], v[88:89]
  v_pk_add_f32 v[96:97], v[78:79], v[92:93] op_sel_hi:[1,0] neg_lo:[0,1] neg_hi:[0,1]
  v_pk_fma_f32 v[90:91], v[96:97], v[96:97], v[90:91]
  v_pk_add_f32 v[94:95], v[80:81], v[92:93] op_sel_hi:[1,0] neg_lo:[0,1] neg_hi:[0,1]
  v_pk_fma_f32 v[88:89], v[94:95], v[94:95], v[88:89]
  v_pk_add_f32 v[96:97], v[82:83], v[92:93] op_sel_hi:[1,0] neg_lo:[0,1] neg_hi:[0,1]
  v_pk_fma_f32 v[90:91], v[96:97], v[96:97], v[90:91]
  v_pk_add_f32 v[94:95], v[84:85], v[92:93] op_sel_hi:[1,0] neg_lo:[0,1] neg_hi:[0,1]
  v_pk_fma_f32 v[88:89], v[94:95], v[94:95], v[88:89]
  v_pk_add_f32 v[96:97], v[86:87], v[92:93] op_sel_hi:[1,0] neg_lo:[0,1] neg_hi:[0,1]
  v_pk_fma_f32 v[90:91], v[96:97], v[96:97], v[90:91]
  v_pk_add_f32 v[88:89], v[88:89], v[90:91]
  v_add_f32 v98, v88, v89
  s_nop 1
  v_add_f32_dpp v98, v98, v98 row_ror:8 row_mask:0xf bank_mask:0xf
  v_cvt_pk_bf16_f32 v92, v92, v92
  s_nop 0
  v_add_f32_dpp v98, v98, v98 row_ror:4 row_mask:0xf bank_mask:0xf
  v_lshlrev_b32 v92, 16, v92
  s_nop 0
  v_add_f32_dpp v98, v98, v98 row_ror:2 row_mask:0xf bank_mask:0xf
  s_nop 1
  v_add_f32_dpp v98, v98, v98 row_ror:1 row_mask:0xf bank_mask:0xf
  v_mul_f32 v98, 0x3acccccd, v98
  v_cvt_pk_bf16_f32 v98, v98, v98
  v_pk_add_f32 v[48:49], v[48:49], v[92:93] op_sel_hi:[1,0] neg_lo:[0,1] neg_hi:[0,1]
  v_lshlrev_b32 v98, 16, v98
  v_pk_add_f32 v[50:51], v[50:51], v[92:93] op_sel_hi:[1,0] neg_lo:[0,1] neg_hi:[0,1]
  v_add_f32 v98, 0x3727c5ac, v98
  v_pk_add_f32 v[52:53], v[52:53], v[92:93] op_sel_hi:[1,0] neg_lo:[0,1] neg_hi:[0,1]
  v_cvt_pk_bf16_f32 v98, v98, v98
  v_pk_add_f32 v[54:55], v[54:55], v[92:93] op_sel_hi:[1,0] neg_lo:[0,1] neg_hi:[0,1]
  v_lshlrev_b32 v98, 16, v98
  v_pk_add_f32 v[56:57], v[56:57], v[92:93] op_sel_hi:[1,0] neg_lo:[0,1] neg_hi:[0,1]
  v_sqrt_f32 v98, v98
  v_pk_add_f32 v[58:59], v[58:59], v[92:93] op_sel_hi:[1,0] neg_lo:[0,1] neg_hi:[0,1]
  v_cvt_pk_bf16_f32 v98, v98, v98
  v_pk_add_f32 v[60:61], v[60:61], v[92:93] op_sel_hi:[1,0] neg_lo:[0,1] neg_hi:[0,1]
  v_lshlrev_b32 v98, 16, v98
  v_pk_add_f32 v[62:63], v[62:63], v[92:93] op_sel_hi:[1,0] neg_lo:[0,1] neg_hi:[0,1]
  v_rcp_f32 v100, v98
  v_pk_add_f32 v[64:65], v[64:65], v[92:93] op_sel_hi:[1,0] neg_lo:[0,1] neg_hi:[0,1]
  v_pk_add_f32 v[66:67], v[66:67], v[92:93] op_sel_hi:[1,0] neg_lo:[0,1] neg_hi:[0,1]
  v_pk_add_f32 v[68:69], v[68:69], v[92:93] op_sel_hi:[1,0] neg_lo:[0,1] neg_hi:[0,1]
  v_pk_add_f32 v[70:71], v[70:71], v[92:93] op_sel_hi:[1,0] neg_lo:[0,1] neg_hi:[0,1]
  v_pk_add_f32 v[72:73], v[72:73], v[92:93] op_sel_hi:[1,0] neg_lo:[0,1] neg_hi:[0,1]
  v_pk_add_f32 v[74:75], v[74:75], v[92:93] op_sel_hi:[1,0] neg_lo:[0,1] neg_hi:[0,1]
  v_pk_add_f32 v[76:77], v[76:77], v[92:93] op_sel_hi:[1,0] neg_lo:[0,1] neg_hi:[0,1]
  v_pk_add_f32 v[78:79], v[78:79], v[92:93] op_sel_hi:[1,0] neg_lo:[0,1] neg_hi:[0,1]
  v_pk_add_f32 v[80:81], v[80:81], v[92:93] op_sel_hi:[1,0] neg_lo:[0,1] neg_hi:[0,1]
  v_pk_add_f32 v[82:83], v[82:83], v[92:93] op_sel_hi:[1,0] neg_lo:[0,1] neg_hi:[0,1]
  v_pk_add_f32 v[84:85], v[84:85], v[92:93] op_sel_hi:[1,0] neg_lo:[0,1] neg_hi:[0,1]
  v_pk_add_f32 v[86:87], v[86:87], v[92:93] op_sel_hi:[1,0] neg_lo:[0,1] neg_hi:[0,1]
  v_mov_b32 v104, 0
  v_mov_b32 v105, 0
  v_cvt_pk_bf16_f32 v8, v48, v49
  v_cvt_pk_bf16_f32 v9, v50, v51
  v_cvt_pk_bf16_f32 v10, v52, v53
  v_cvt_pk_bf16_f32 v11, v54, v55
  v_cvt_pk_bf16_f32 v12, v56, v57
  v_cvt_pk_bf16_f32 v13, v58, v59
  v_cvt_pk_bf16_f32 v14, v60, v61
  v_cvt_pk_bf16_f32 v15, v62, v63
  v_cvt_pk_bf16_f32 v16, v64, v65
  v_cvt_pk_bf16_f32 v17, v66, v67
  v_cvt_pk_bf16_f32 v18, v68, v69
  v_cvt_pk_bf16_f32 v19, v70, v71
  v_cvt_pk_bf16_f32 v20, v72, v73
  v_cvt_pk_bf16_f32 v21, v74, v75
  v_cvt_pk_bf16_f32 v22, v76, v77
  v_cvt_pk_bf16_f32 v23, v78, v79
  v_cvt_pk_bf16_f32 v24, v80, v81
  v_cvt_pk_bf16_f32 v25, v82, v83
  v_cvt_pk_bf16_f32 v26, v84, v85
  v_cvt_pk_bf16_f32 v27, v86, v87
  v_lshlrev_b32 v48, 16, v8
  v_and_b32 v49, s56, v8
  v_lshlrev_b32 v50, 16, v9
  v_and_b32 v51, s56, v9
  v_lshlrev_b32 v52, 16, v10
  v_and_b32 v53, s56, v10
  v_lshlrev_b32 v54, 16, v11
  v_and_b32 v55, s56, v11
  v_lshlrev_b32 v56, 16, v12
  v_and_b32 v57, s56, v12
  v_lshlrev_b32 v58, 16, v13
  v_and_b32 v59, s56, v13
  v_lshlrev_b32 v60, 16, v14
  v_and_b32 v61, s56, v14
  v_lshlrev_b32 v62, 16, v15
  v_and_b32 v63, s56, v15
  v_lshlrev_b32 v64, 16, v16
  v_and_b32 v65, s56, v16
  v_lshlrev_b32 v66, 16, v17
  v_and_b32 v67, s56, v17
  v_lshlrev_b32 v68, 16, v18
  v_and_b32 v69, s56, v18
  v_lshlrev_b32 v70, 16, v19
  v_and_b32 v71, s56, v19
  v_lshlrev_b32 v72, 16, v20
  v_and_b32 v73, s56, v20
  v_lshlrev_b32 v74, 16, v21
  v_and_b32 v75, s56, v21
  v_lshlrev_b32 v76, 16, v22
  v_and_b32 v77, s56, v22
  v_lshlrev_b32 v78, 16, v23
  v_and_b32 v79, s56, v23
  v_lshlrev_b32 v80, 16, v24
  v_and_b32 v81, s56, v24
  v_lshlrev_b32 v82, 16, v25
  v_and_b32 v83, s56, v25
  v_lshlrev_b32 v84, 16, v26
  v_and_b32 v85, s56, v26
  v_lshlrev_b32 v86, 16, v27
  v_and_b32 v87, s56, v27
  v_pk_mul_f32 v[48:49], v[48:49], v[100:101] op_sel_hi:[1,0]
  v_pk_mul_f32 v[50:51], v[50:51], v[100:101] op_sel_hi:[1,0]
  v_pk_mul_f32 v[52:53], v[52:53], v[100:101] op_sel_hi:[1,0]
  v_pk_mul_f32 v[54:55], v[54:55], v[100:101] op_sel_hi:[1,0]
  v_cvt_pk_bf16_f32 v8, v48, v49
  v_cvt_pk_bf16_f32 v9, v50, v51
  v_cvt_pk_bf16_f32 v10, v52, v53
  v_cvt_pk_bf16_f32 v11, v54, v55
  buffer_store_dwordx4 v[8:11], v5, s[24:27], s53 offen sc1
  s_add_u32 s53, s53, 16384
  v_pk_mul_f32 v[56:57], v[56:57], v[100:101] op_sel_hi:[1,0]
  v_pk_mul_f32 v[58:59], v[58:59], v[100:101] op_sel_hi:[1,0]
  v_pk_mul_f32 v[60:61], v[60:61], v[100:101] op_sel_hi:[1,0]
  v_pk_mul_f32 v[62:63], v[62:63], v[100:101] op_sel_hi:[1,0]
  v_cvt_pk_bf16_f32 v12, v56, v57
  v_cvt_pk_bf16_f32 v13, v58, v59
  v_cvt_pk_bf16_f32 v14, v60, v61
  v_cvt_pk_bf16_f32 v15, v62, v63
  buffer_store_dwordx4 v[12:15], v5, s[24:27], s53 offen sc1
  s_add_u32 s53, s53, 16384
  v_pk_mul_f32 v[64:65], v[64:65], v[100:101] op_sel_hi:[1,0]
  v_pk_mul_f32 v[66:67], v[66:67], v[100:101] op_sel_hi:[1,0]
  v_pk_mul_f32 v[68:69], v[68:69], v[100:101] op_sel_hi:[1,0]
  v_pk_mul_f32 v[70:71], v[70:71], v[100:101] op_sel_hi:[1,0]
  v_cvt_pk_bf16_f32 v16, v64, v65
  v_cvt_pk_bf16_f32 v17, v66, v67
  v_cvt_pk_bf16_f32 v18, v68, v69
  v_cvt_pk_bf16_f32 v19, v70, v71
  buffer_store_dwordx4 v[16:19], v5, s[24:27], s53 offen sc1
  s_add_u32 s53, s53, 16384
  v_pk_mul_f32 v[72:73], v[72:73], v[100:101] op_sel_hi:[1,0]
  v_pk_mul_f32 v[74:75], v[74:75], v[100:101] op_sel_hi:[1,0]
  v_pk_mul_f32 v[76:77], v[76:77], v[100:101] op_sel_hi:[1,0]
  v_pk_mul_f32 v[78:79], v[78:79], v[100:101] op_sel_hi:[1,0]
  v_cvt_pk_bf16_f32 v20, v72, v73
  v_cvt_pk_bf16_f32 v21, v74, v75
  v_cvt_pk_bf16_f32 v22, v76, v77
  v_cvt_pk_bf16_f32 v23, v78, v79
  buffer_store_dwordx4 v[20:23], v5, s[24:27], s53 offen sc1
  s_add_u32 s53, s53, 16384
  v_pk_mul_f32 v[80:81], v[80:81], v[100:101] op_sel_hi:[1,0]
  v_pk_mul_f32 v[82:83], v[82:83], v[100:101] op_sel_hi:[1,0]
  v_pk_mul_f32 v[84:85], v[84:85], v[100:101] op_sel_hi:[1,0]
  v_pk_mul_f32 v[86:87], v[86:87], v[100:101] op_sel_hi:[1,0]
  v_cvt_pk_bf16_f32 v24, v80, v81
  v_cvt_pk_bf16_f32 v25, v82, v83
  v_cvt_pk_bf16_f32 v26, v84, v85
  v_cvt_pk_bf16_f32 v27, v86, v87
  buffer_store_dwordx4 v[24:27], v5, s[24:27], s53 offen sc1
  s_add_u32 s53, s53, 16384
  s_waitcnt vmcnt(12)
  v_dot2_f32_bf16 v104, v8, v28, v104
  v_dot2_f32_bf16 v105, v9, v29, v105
  v_dot2_f32_bf16 v104, v10, v30, v104
  v_dot2_f32_bf16 v105, v11, v31, v105
  s_waitcnt vmcnt(11)
  v_dot2_f32_bf16 v104, v12, v32, v104
  v_dot2_f32_bf16 v105, v13, v33, v105
  v_dot2_f32_bf16 v104, v14, v34, v104
  v_dot2_f32_bf16 v105, v15, v35, v105
  s_waitcnt vmcnt(10)
  v_dot2_f32_bf16 v104, v16, v36, v104
  v_dot2_f32_bf16 v105, v17, v37, v105
  v_dot2_f32_bf16 v104, v18, v38, v104
  v_dot2_f32_bf16 v105, v19, v39, v105
  s_waitcnt vmcnt(9)
  v_dot2_f32_bf16 v104, v20, v40, v104
  v_dot2_f32_bf16 v105, v21, v41, v105
  v_dot2_f32_bf16 v104, v22, v42, v104
  v_dot2_f32_bf16 v105, v23, v43, v105
  s_waitcnt vmcnt(8)
  v_dot2_f32_bf16 v104, v24, v44, v104
  v_dot2_f32_bf16 v105, v25, v45, v105
  v_dot2_f32_bf16 v104, v26, v46, v104
  v_dot2_f32_bf16 v105, v27, v47, v105
  s_nop 2
  v_add_f32 v104, v104, v105
  s_nop 1
  v_add_f32_dpp v104, v104, v104 row_ror:8 row_mask:0xf bank_mask:0xf
  s_nop 1
  v_add_f32_dpp v104, v104, v104 row_ror:4 row_mask:0xf bank_mask:0xf
  s_nop 1
  v_add_f32_dpp v104, v104, v104 row_ror:2 row_mask:0xf bank_mask:0xf
  s_nop 1
  v_add_f32_dpp v104, v104, v104 row_ror:1 row_mask:0xf bank_mask:0xf
  v_cvt_pk_bf16_f32 v104, v104, v104
  v_lshlrev_b32 v104, 16, v104
  v_ashrrev_i32 v105, 31, v104
  v_or_b32 v105, 0x80000000, v105
  v_xor_b32 v104, v104, v105
  v_and_b32 v104, s56, v104
  v_add_u32 v6, s52, v1
  v_sub_u32 v7, 0xffff, v6
  v_or_b32 v104, v104, v7
  v_lshlrev_b32 v6, 2, v6
  v_lshl_add_u32 v6, v2, 26, v6
  s_mov_b32 s53, 2621440
  buffer_store_dword v104, v6, s[24:27], s53 offen sc1
  s_waitcnt vmcnt(0)
  s_branch front_join
front_fetch:
  s_getpc_b64 s[98:99]
attn_hot_pc:
  s_add_u32 s98, s98, attn_hot-attn_hot_pc
  s_addc_u32 s99, s99, 0
  s_lshr_b32 s100, s2, 3
  v_min_u32 v249, 17, v0
  v_lshlrev_b32 v249, 5, v249
  v_add_u32 v249, s100, v249
  v_lshlrev_b32 v249, 7, v249
  v_min_u32 v249, attn_end-attn_hot-4, v249
  global_load_dword v255, v249, s[98:99]
attn_hot:
  v_subrev_u32 v16, 0x40000, v238
  v_subrev_u32 v17, 0x40000, v239
  v_subrev_u32 v18, 0x40000, v240
  v_subrev_u32 v19, 0x40000, v241
  s_mov_b32 s31, 0
  s_add_u32 m0, s28, 90112
  s_nop 0
  buffer_load_dwordx4 v16, s[20:23], s31 offen offset:0 lds
  buffer_load_dwordx4 v17, s[20:23], s31 offen offset:1024 lds
  buffer_load_dwordx4 v18, s[20:23], s31 offen offset:2048 lds
  buffer_load_dwordx4 v19, s[20:23], s31 offen offset:3072 lds
  s_add_u32 m0, s28, 98304
  s_nop 0
  buffer_load_dwordx4 v238, s[20:23], s31 offen offset:0 lds
  buffer_load_dwordx4 v239, s[20:23], s31 offen offset:1024 lds
  buffer_load_dwordx4 v240, s[20:23], s31 offen offset:2048 lds
  buffer_load_dwordx4 v241, s[20:23], s31 offen offset:3072 lds
front_join:
  s_waitcnt lgkmcnt(0)
  s_barrier
  s_mul_i32 s55, s59, 0x9e3779b1
  s_add_u32 s55, s55, 0x7f4a7c15
  s_bfe_u32 s58, s2, 0x30003
  s_lshl_b32 s58, s58, 8
  s_add_u32 s58, s58, 2826240
  s_lshl_b32 s53, s36, 2
  s_lshl_b32 s54, s3, 26
  s_add_u32 s53, s53, s54
  v_min_u32 v1, 1, v0
  v_lshlrev_b32 v1, 28, v1
  v_add_u32 v1, s53, v1
  v_mov_b32 v2, s55
  buffer_store_dword v2, v1, s[24:27], s58 offen sc1
  s_cmp_lt_u32 s3, 2
  s_cbranch_scc1 front_addr
  s_mov_b32 s31, 524288
  s_add_u32 m0, s28, 106496
  s_nop 0
  buffer_load_dwordx4 v16, s[20:23], s31 offen offset:0 lds
  buffer_load_dwordx4 v17, s[20:23], s31 offen offset:1024 lds
  buffer_load_dwordx4 v18, s[20:23], s31 offen offset:2048 lds
  buffer_load_dwordx4 v19, s[20:23], s31 offen offset:3072 lds
  s_add_u32 m0, s28, 114688
  s_nop 0
  buffer_load_dwordx4 v238, s[20:23], s31 offen offset:0 lds
  buffer_load_dwordx4 v239, s[20:23], s31 offen offset:1024 lds
  buffer_load_dwordx4 v240, s[20:23], s31 offen offset:2048 lds
  buffer_load_dwordx4 v241, s[20:23], s31 offen offset:3072 lds
  s_mov_b32 s31, 1048576
  s_add_u32 m0, s28, 24576
  s_nop 0
  buffer_load_dwordx4 v16, s[20:23], s31 offen offset:0 lds
  buffer_load_dwordx4 v17, s[20:23], s31 offen offset:1024 lds
  buffer_load_dwordx4 v18, s[20:23], s31 offen offset:2048 lds
  buffer_load_dwordx4 v19, s[20:23], s31 offen offset:3072 lds
  s_add_u32 m0, s28, 32768
  s_nop 0
  buffer_load_dwordx4 v238, s[20:23], s31 offen offset:0 lds
  buffer_load_dwordx4 v239, s[20:23], s31 offen offset:1024 lds
  buffer_load_dwordx4 v240, s[20:23], s31 offen offset:2048 lds
  buffer_load_dwordx4 v241, s[20:23], s31 offen offset:3072 lds
  s_mov_b32 s31, 1572864
  s_add_u32 m0, s28, 40960
  s_nop 0
  buffer_load_dwordx4 v16, s[20:23], s31 offen offset:0 lds
  buffer_load_dwordx4 v17, s[20:23], s31 offen offset:1024 lds
  buffer_load_dwordx4 v18, s[20:23], s31 offen offset:2048 lds
  buffer_load_dwordx4 v19, s[20:23], s31 offen offset:3072 lds
  s_add_u32 m0, s28, 49152
  s_nop 0
  buffer_load_dwordx4 v238, s[20:23], s31 offen offset:0 lds
  buffer_load_dwordx4 v239, s[20:23], s31 offen offset:1024 lds
  buffer_load_dwordx4 v240, s[20:23], s31 offen offset:2048 lds
  buffer_load_dwordx4 v241, s[20:23], s31 offen offset:3072 lds
front_addr:
  s_mov_b32 s31, 2097152
  v_lshlrev_b32 v242, 4, v245
  v_add_u32 v243, 0x1000, v242
  s_mul_i32 s30, s37, 81920
  s_lshl_b32 s38, s36, 19
  s_add_u32 s12, s4, s38
  s_addc_u32 s13, s5, 0
  s_mov_b32 s14, 524288
  s_mov_b32 s15, 0x20000
  s_add_u32 s16, s6, s38
  s_addc_u32 s17, s7, 0
  s_mov_b32 s18, 524288
  s_mov_b32 s19, 0x20000
  v_lshlrev_b32 v249, 8, v248
  v_add_u32 v249, s28, v249
  v_add_u32 v250, 0, v248
  v_xor_b32 v250, v250, v247
  v_lshl_add_u32 v232, v250, 4, v249
  v_add_u32 v250, 4, v248
  v_xor_b32 v250, v250, v247
  v_lshl_add_u32 v233, v250, 4, v249
  v_add_u32 v250, 8, v248
  v_xor_b32 v250, v250, v247
  v_lshl_add_u32 v234, v250, 4, v249
  v_add_u32 v250, 12, v248
  v_xor_b32 v250, v250, v247
  v_lshl_add_u32 v235, v250, 4, v249
  v_add_u32 v250, 0, v248
  v_lshlrev_b32 v250, 1, v250
  v_xor_b32 v250, v250, v247
  v_lshl_add_u32 v236, v250, 4, v249
  v_add_u32 v250, 4, v248
  v_lshlrev_b32 v250, 1, v250
  v_xor_b32 v250, v250, v247
  v_lshl_add_u32 v237, v250, 4, v249
  v_lshrrev_b32 v249, 1, v248
  v_and_b32 v250, 1, v248
  v_lshl_or_b32 v249, v250, 1, v249
  v_xor_b32 v249, v249, v247
  v_lshlrev_b32 v249, 4, v249
  v_lshl_add_u32 v212, v247, 8, v249
  v_xor_b32 v213, 64, v212
  v_xor_b32 v214, 128, v212
  v_xor_b32 v215, 192, v212
  v_bfe_u32 v246, v245, 2, 2
  v_and_b32 v247, 3, v245
  v_lshlrev_b32 v247, 3, v247
  v_add_u32 v247, 65536, v247
  v_lshl_add_u32 v249, v248, 2, v246
  v_and_b32 v250, 7, v249
  v_lshl_add_u32 v250, v250, 5, v247
  v_lshl_add_u32 v216, v249, 8, v250
  v_lshl_add_u32 v249, v248, 3, v246
  v_and_b32 v250, 1, v248
  v_lshl_add_u32 v250, v250, 2, v246
  v_lshl_add_u32 v250, v250, 5, v247
  v_lshl_add_u32 v224, v249, 8, v250
  v_xor_b32 v217, 32, v216
  v_xor_b32 v225, 32, v224
  v_xor_b32 v218, 64, v216
  v_xor_b32 v226, 64, v224
  v_xor_b32 v219, 96, v216
  v_xor_b32 v227, 96, v224
  v_xor_b32 v220, 128, v216
  v_xor_b32 v228, 128, v224
  v_xor_b32 v221, 160, v216
  v_xor_b32 v229, 160, v224
  v_xor_b32 v222, 192, v216
  v_xor_b32 v230, 192, v224
  v_xor_b32 v223, 224, v216
  v_xor_b32 v231, 224, v224
  v_subrev_u32 v144, 65536, v224
  v_subrev_u32 v145, 65536, v225
  v_subrev_u32 v146, 65536, v226
  v_subrev_u32 v147, 65536, v227
  v_subrev_u32 v148, 65536, v228
  v_subrev_u32 v149, 65536, v229
  v_subrev_u32 v150, 65536, v230
  v_subrev_u32 v151, 65536, v231
  s_lshr_b32 s38, s2, 3
  s_min_u32 s38, s38, 26
  s_and_b32 s39, s2, 7
  s_mul_i32 s39, s39, 27
  s_add_u32 s33, s38, s39
  s_mul_i32 s50, s3, 6144
  s_add_u32 s50, s50, 133120
  v_mov_b32 v244, v242
  s_lshl_b32 s40, s37, 19
  s_lshl_b32 s38, s36, 14
  s_add_u32 s40, s40, s38
  s_add_u32 s40, s40, 8388608
  s_add_u32 s41, s40, 4096
  s_add_u32 s42, s40, 8192
  s_add_u32 s43, s40, 12288
  s_mov_b32 s34, 0x3e0293ee
  s_mov_b32 s29, 0
  v_and_b32 v249, 15, v245
  v_cmp_eq_u32 vcc, 0, v249
  v_mov_b32 v249, 0x3f803f80
  s_nop 0
  v_cndmask_b32 v249, 0, v249, vcc
  v_accvgpr_write_b32 a208, v249
  v_accvgpr_write_b32 a209, v249
  v_accvgpr_write_b32 a210, v249
  v_accvgpr_write_b32 a211, v249
  v_and_b32 v2, 7, v0
  v_lshlrev_b32 v2, 2, v2
  s_lshl_b32 s54, s3, 5
  v_add_u32 v2, s54, v2
  s_mov_b32 s54, 32768
  buffer_load_dword v3, v2, s[24:27], s58 offen sc1
  s_sleep 2
  buffer_load_dword v4, v2, s[24:27], s58 offen sc1
  s_sleep 2
  buffer_load_dword v5, v2, s[24:27], s58 offen sc1
  s_sleep 2
front_poll:
  buffer_load_dword v6, v2, s[24:27], s58 offen sc1
  s_waitcnt vmcnt(3)
  v_cmp_ne_u32 vcc, s55, v3
  s_nop 0
  s_cbranch_vccz front_go
  s_sleep 2
  buffer_load_dword v3, v2, s[24:27], s58 offen sc1
  s_waitcnt vmcnt(3)
  v_cmp_ne_u32 vcc, s55, v4
  s_nop 0
  s_cbranch_vccz front_go
  s_sleep 2
  buffer_load_dword v4, v2, s[24:27], s58 offen sc1
  s_waitcnt vmcnt(3)
  v_cmp_ne_u32 vcc, s55, v5
  s_nop 0
  s_cbranch_vccz front_go
  s_sleep 2
  buffer_load_dword v5, v2, s[24:27], s58 offen sc1
  s_waitcnt vmcnt(3)
  v_cmp_ne_u32 vcc, s55, v6
  s_nop 0
  s_cbranch_vccz front_go
  s_sleep 2
  s_sub_u32 s54, s54, 1
  s_cmp_lg_u32 s54, 0
  s_cbranch_scc1 front_poll
front_go:
  buffer_load_dwordx4 a[0:3], v242, s[24:27], s30 offen offset:0 sc1
  buffer_load_dwordx4 a[4:7], v242, s[24:27], s30 offen offset:1024 sc1
  buffer_load_dwordx4 a[8:11], v242, s[24:27], s30 offen offset:2048 sc1
  buffer_load_dwordx4 a[12:15], v242, s[24:27], s30 offen offset:3072 sc1
  buffer_load_dwordx4 a[16:19], v243, s[24:27], s30 offen offset:0 sc1
  buffer_load_dwordx4 a[20:23], v243, s[24:27], s30 offen offset:1024 sc1
  buffer_load_dwordx4 a[24:27], v243, s[24:27], s30 offen offset:2048 sc1
  buffer_load_dwordx4 a[28:31], v243, s[24:27], s30 offen offset:3072 sc1
  s_add_u32 s30, s30, 8192
  buffer_load_dwordx4 a[32:35], v242, s[24:27], s30 offen offset:0 sc1
  buffer_load_dwordx4 a[36:39], v242, s[24:27], s30 offen offset:1024 sc1
  buffer_load_dwordx4 a[40:43], v242, s[24:27], s30 offen offset:2048 sc1
  buffer_load_dwordx4 a[44:47], v242, s[24:27], s30 offen offset:3072 sc1
  buffer_load_dwordx4 a[48:51], v243, s[24:27], s30 offen offset:0 sc1
  buffer_load_dwordx4 a[52:55], v243, s[24:27], s30 offen offset:1024 sc1
  buffer_load_dwordx4 a[56:59], v243, s[24:27], s30 offen offset:2048 sc1
  buffer_load_dwordx4 a[60:63], v243, s[24:27], s30 offen offset:3072 sc1
  s_add_u32 s30, s30, 8192
  v_lshrrev_b32 v140, 7, v242
  v_lshlrev_b32 v140, 8, v140
  v_and_b32 v136, 0x70, v242
  v_add_u32 v140, v140, v136
  s_mov_b32 s58, 2826240
  buffer_load_dwordx4 v[136:139], v140, s[24:27], s58 offen sc1
  s_barrier
  ds_read_b64_tr_b16 a[160:161], v224 offset:32768
  ds_read_b64_tr_b16 a[162:163], v224 offset:33792
  ds_read_b64_tr_b16 a[164:165], v224 offset:40960
  ds_read_b64_tr_b16 a[166:167], v224 offset:41984
  ds_read_b64_tr_b16 a[168:169], v225 offset:32768
  ds_read_b64_tr_b16 a[170:171], v225 offset:33792
  ds_read_b64_tr_b16 a[172:173], v225 offset:40960
  ds_read_b64_tr_b16 a[174:175], v225 offset:41984
  s_waitcnt vmcnt(9) lgkmcnt(4)
  v_mfma_f32_16x16x32_bf16 v[0:3], a[160:163], a[0:3], 0
  ds_read_b64_tr_b16 a[176:177], v226 offset:32768
  v_mfma_f32_16x16x32_bf16 v[0:3], a[164:167], a[16:19], v[0:3]
  buffer_load_dwordx4 a[64:67], v242, s[24:27], s30 offen offset:0 sc1
  v_mfma_f32_16x16x32_bf16 v[4:7], a[164:167], a[20:23], 0
  ds_read_b64_tr_b16 a[178:179], v226 offset:33792
  v_mfma_f32_16x16x32_bf16 v[4:7], a[160:163], a[4:7], v[4:7]
  buffer_load_dwordx4 a[68:71], v242, s[24:27], s30 offen offset:1024 sc1
  v_mfma_f32_16x16x32_bf16 v[8:11], a[160:163], a[8:11], 0
  ds_read_b64_tr_b16 a[180:181], v226 offset:40960
  v_mfma_f32_16x16x32_bf16 v[8:11], a[164:167], a[24:27], v[8:11]
  v_mfma_f32_16x16x32_bf16 v[12:15], a[164:167], a[28:31], 0
  ds_read_b64_tr_b16 a[182:183], v226 offset:41984
  v_mfma_f32_16x16x32_bf16 v[12:15], a[160:163], a[12:15], v[12:15]
  s_waitcnt lgkmcnt(4)
  buffer_load_dwordx4 a[72:75], v242, s[24:27], s30 offen offset:2048 sc1
  v_mfma_f32_16x16x32_bf16 v[16:19], a[168:171], a[0:3], 0
  ds_read_b64_tr_b16 a[184:185], v227 offset:32768
  v_mfma_f32_16x16x32_bf16 v[16:19], a[172:175], a[16:19], v[16:19]
  v_mfma_f32_16x16x32_bf16 v[20:23], a[172:175], a[20:23], 0
  ds_read_b64_tr_b16 a[186:187], v227 offset:33792
  v_mfma_f32_16x16x32_bf16 v[20:23], a[168:171], a[4:7], v[20:23]
  buffer_load_dwordx4 a[76:79], v242, s[24:27], s30 offen offset:3072 sc1
  v_mfma_f32_16x16x32_bf16 v[24:27], a[168:171], a[8:11], 0
  ds_read_b64_tr_b16 a[188:189], v227 offset:40960
  v_mfma_f32_16x16x32_bf16 v[24:27], a[172:175], a[24:27], v[24:27]
  buffer_load_dwordx4 a[80:83], v243, s[24:27], s30 offen offset:0 sc1
  v_mfma_f32_16x16x32_bf16 v[28:31], a[172:175], a[28:31], 0
  ds_read_b64_tr_b16 a[190:191], v227 offset:41984
  v_mfma_f32_16x16x32_bf16 v[28:31], a[168:171], a[12:15], v[28:31]
  s_waitcnt lgkmcnt(4)
  v_mfma_f32_16x16x32_bf16 v[32:35], a[176:179], a[0:3], 0
  ds_read_b64_tr_b16 a[160:161], v228 offset:32768
  v_mfma_f32_16x16x32_bf16 v[32:35], a[180:183], a[16:19], v[32:35]
  buffer_load_dwordx4 a[84:87], v243, s[24:27], s30 offen offset:1024 sc1
  v_mfma_f32_16x16x32_bf16 v[36:39], a[180:183], a[20:23], 0
  ds_read_b64_tr_b16 a[162:163], v228 offset:33792
  v_mfma_f32_16x16x32_bf16 v[36:39], a[176:179], a[4:7], v[36:39]
  v_mfma_f32_16x16x32_bf16 v[40:43], a[176:179], a[8:11], 0
  ds_read_b64_tr_b16 a[164:165], v228 offset:40960
  v_mfma_f32_16x16x32_bf16 v[40:43], a[180:183], a[24:27], v[40:43]
  buffer_load_dwordx4 a[88:91], v243, s[24:27], s30 offen offset:2048 sc1
  v_mfma_f32_16x16x32_bf16 v[44:47], a[180:183], a[28:31], 0
  ds_read_b64_tr_b16 a[166:167], v228 offset:41984
  v_mfma_f32_16x16x32_bf16 v[44:47], a[176:179], a[12:15], v[44:47]
  s_waitcnt lgkmcnt(4)
  buffer_load_dwordx4 a[92:95], v243, s[24:27], s30 offen offset:3072 sc1
  v_mfma_f32_16x16x32_bf16 v[48:51], a[184:187], a[0:3], 0
  ds_read_b64_tr_b16 a[168:169], v229 offset:32768
  v_mfma_f32_16x16x32_bf16 v[48:51], a[188:191], a[16:19], v[48:51]
  v_mfma_f32_16x16x32_bf16 v[52:55], a[188:191], a[20:23], 0
  ds_read_b64_tr_b16 a[170:171], v229 offset:33792
  v_mfma_f32_16x16x32_bf16 v[52:55], a[184:187], a[4:7], v[52:55]
  s_add_u32 s30, s30, 8192
  v_mfma_f32_16x16x32_bf16 v[56:59], a[184:187], a[8:11], 0
  ds_read_b64_tr_b16 a[172:173], v229 offset:40960
  v_mfma_f32_16x16x32_bf16 v[56:59], a[188:191], a[24:27], v[56:59]
  v_mfma_f32_16x16x32_bf16 v[60:63], a[188:191], a[28:31], 0
  ds_read_b64_tr_b16 a[174:175], v229 offset:41984
  v_mfma_f32_16x16x32_bf16 v[60:63], a[184:187], a[12:15], v[60:63]
  s_waitcnt lgkmcnt(4)
  buffer_load_dwordx4 a[96:99], v242, s[24:27], s30 offen offset:0 sc1
  v_mfma_f32_16x16x32_bf16 v[64:67], a[160:163], a[0:3], 0
  ds_read_b64_tr_b16 a[176:177], v230 offset:32768
  v_mfma_f32_16x16x32_bf16 v[64:67], a[164:167], a[16:19], v[64:67]
  buffer_load_dwordx4 a[100:103], v242, s[24:27], s30 offen offset:1024 sc1
  v_mfma_f32_16x16x32_bf16 v[68:71], a[164:167], a[20:23], 0
  ds_read_b64_tr_b16 a[178:179], v230 offset:33792
  v_mfma_f32_16x16x32_bf16 v[68:71], a[160:163], a[4:7], v[68:71]
  v_mfma_f32_16x16x32_bf16 v[72:75], a[160:163], a[8:11], 0
  ds_read_b64_tr_b16 a[180:181], v230 offset:40960
  v_mfma_f32_16x16x32_bf16 v[72:75], a[164:167], a[24:27], v[72:75]
  buffer_load_dwordx4 a[104:107], v242, s[24:27], s30 offen offset:2048 sc1
  v_mfma_f32_16x16x32_bf16 v[76:79], a[164:167], a[28:31], 0
  ds_read_b64_tr_b16 a[182:183], v230 offset:41984
  v_mfma_f32_16x16x32_bf16 v[76:79], a[160:163], a[12:15], v[76:79]
  s_waitcnt lgkmcnt(4)
  v_mfma_f32_16x16x32_bf16 v[80:83], a[168:171], a[0:3], 0
  ds_read_b64_tr_b16 a[184:185], v231 offset:32768
  v_mfma_f32_16x16x32_bf16 v[80:83], a[172:175], a[16:19], v[80:83]
  buffer_load_dwordx4 a[108:111], v242, s[24:27], s30 offen offset:3072 sc1
  v_mfma_f32_16x16x32_bf16 v[84:87], a[172:175], a[20:23], 0
  ds_read_b64_tr_b16 a[186:187], v231 offset:33792
  v_mfma_f32_16x16x32_bf16 v[84:87], a[168:171], a[4:7], v[84:87]
  buffer_load_dwordx4 a[112:115], v243, s[24:27], s30 offen offset:0 sc1
  v_mfma_f32_16x16x32_bf16 v[88:91], a[168:171], a[8:11], 0
  ds_read_b64_tr_b16 a[188:189], v231 offset:40960
  v_mfma_f32_16x16x32_bf16 v[88:91], a[172:175], a[24:27], v[88:91]
  s_barrier
  v_mfma_f32_16x16x32_bf16 v[92:95], a[172:175], a[28:31], 0
  ds_read_b64_tr_b16 a[190:191], v231 offset:41984
  v_mfma_f32_16x16x32_bf16 v[92:95], a[168:171], a[12:15], v[92:95]
  s_waitcnt lgkmcnt(4)
  buffer_load_dwordx4 a[116:119], v243, s[24:27], s30 offen offset:1024 sc1
  v_mfma_f32_16x16x32_bf16 v[96:99], a[176:179], a[0:3], 0
  ds_read_b64_tr_b16 a[160:161], v224 offset:49152
  v_mfma_f32_16x16x32_bf16 v[96:99], a[180:183], a[16:19], v[96:99]
  v_mfma_f32_16x16x32_bf16 v[100:103], a[180:183], a[20:23], 0
  ds_read_b64_tr_b16 a[162:163], v224 offset:50176
  v_mfma_f32_16x16x32_bf16 v[100:103], a[176:179], a[4:7], v[100:103]
  buffer_load_dwordx4 a[120:123], v243, s[24:27], s30 offen offset:2048 sc1
  v_mfma_f32_16x16x32_bf16 v[104:107], a[176:179], a[8:11], 0
  ds_read_b64_tr_b16 a[164:165], v224 offset:57344
  v_mfma_f32_16x16x32_bf16 v[104:107], a[180:183], a[24:27], v[104:107]
  buffer_load_dwordx4 a[124:127], v243, s[24:27], s30 offen offset:3072 sc1
  v_mfma_f32_16x16x32_bf16 v[108:111], a[180:183], a[28:31], 0
  ds_read_b64_tr_b16 a[166:167], v224 offset:58368
  v_mfma_f32_16x16x32_bf16 v[108:111], a[176:179], a[12:15], v[108:111]
  s_waitcnt lgkmcnt(4)
  v_mfma_f32_16x16x32_bf16 v[112:115], a[184:187], a[0:3], 0
  ds_read_b64_tr_b16 a[168:169], v225 offset:49152
  v_mfma_f32_16x16x32_bf16 v[112:115], a[188:191], a[16:19], v[112:115]
  s_add_u32 s30, s30, 8192
  v_mfma_f32_16x16x32_bf16 v[116:119], a[188:191], a[20:23], 0
  ds_read_b64_tr_b16 a[170:171], v225 offset:50176
  v_mfma_f32_16x16x32_bf16 v[116:119], a[184:187], a[4:7], v[116:119]
  v_mfma_f32_16x16x32_bf16 v[120:123], a[184:187], a[8:11], 0
  ds_read_b64_tr_b16 a[172:173], v225 offset:57344
  v_mfma_f32_16x16x32_bf16 v[120:123], a[188:191], a[24:27], v[120:123]
  v_mfma_f32_16x16x32_bf16 v[124:127], a[188:191], a[28:31], 0
  ds_read_b64_tr_b16 a[174:175], v225 offset:58368
  v_mfma_f32_16x16x32_bf16 v[124:127], a[184:187], a[12:15], v[124:127]
  s_waitcnt vmcnt(17) lgkmcnt(4)
  v_mfma_f32_16x16x32_bf16 v[0:3], a[160:163], a[32:35], v[0:3]
  ds_read_b64_tr_b16 a[176:177], v226 offset:49152
  v_mfma_f32_16x16x32_bf16 v[0:3], a[164:167], a[48:51], v[0:3]
  buffer_load_dwordx4 a[0:3], v242, s[24:27], s30 offen offset:0 sc1
  v_mfma_f32_16x16x32_bf16 v[4:7], a[164:167], a[52:55], v[4:7]
  ds_read_b64_tr_b16 a[178:179], v226 offset:50176
  v_mfma_f32_16x16x32_bf16 v[4:7], a[160:163], a[36:39], v[4:7]
  v_mfma_f32_16x16x32_bf16 v[8:11], a[160:163], a[40:43], v[8:11]
  ds_read_b64_tr_b16 a[180:181], v226 offset:57344
  s_add_u32 m0, s28, 16384
  v_mfma_f32_16x16x32_bf16 v[8:11], a[164:167], a[56:59], v[8:11]
  buffer_load_dwordx4 v238, s[20:23], s31 offen offset:0 lds
  v_mfma_f32_16x16x32_bf16 v[12:15], a[164:167], a[60:63], v[12:15]
  ds_read_b64_tr_b16 a[182:183], v226 offset:58368
  v_mfma_f32_16x16x32_bf16 v[12:15], a[160:163], a[44:47], v[12:15]
  s_waitcnt lgkmcnt(4)
  v_mfma_f32_16x16x32_bf16 v[16:19], a[168:171], a[32:35], v[16:19]
  ds_read_b64_tr_b16 a[184:185], v227 offset:49152
  v_mfma_f32_16x16x32_bf16 v[16:19], a[172:175], a[48:51], v[16:19]
  buffer_load_dwordx4 a[4:7], v242, s[24:27], s30 offen offset:1024 sc1
  v_mfma_f32_16x16x32_bf16 v[20:23], a[172:175], a[52:55], v[20:23]
  ds_read_b64_tr_b16 a[186:187], v227 offset:50176
  v_mfma_f32_16x16x32_bf16 v[20:23], a[168:171], a[36:39], v[20:23]
  v_mfma_f32_16x16x32_bf16 v[24:27], a[168:171], a[40:43], v[24:27]
  ds_read_b64_tr_b16 a[188:189], v227 offset:57344
  v_mfma_f32_16x16x32_bf16 v[24:27], a[172:175], a[56:59], v[24:27]
  v_mfma_f32_16x16x32_bf16 v[28:31], a[172:175], a[60:63], v[28:31]
  ds_read_b64_tr_b16 a[190:191], v227 offset:58368
  v_mfma_f32_16x16x32_bf16 v[28:31], a[168:171], a[44:47], v[28:31]
  s_waitcnt lgkmcnt(4)
  v_mfma_f32_16x16x32_bf16 v[32:35], a[176:179], a[32:35], v[32:35]
  ds_read_b64_tr_b16 a[160:161], v228 offset:49152
  v_mfma_f32_16x16x32_bf16 v[32:35], a[180:183], a[48:51], v[32:35]
  buffer_load_dwordx4 a[8:11], v242, s[24:27], s30 offen offset:2048 sc1
  v_mfma_f32_16x16x32_bf16 v[36:39], a[180:183], a[52:55], v[36:39]
  ds_read_b64_tr_b16 a[162:163], v228 offset:50176
  v_mfma_f32_16x16x32_bf16 v[36:39], a[176:179], a[36:39], v[36:39]
  v_mfma_f32_16x16x32_bf16 v[40:43], a[176:179], a[40:43], v[40:43]
  ds_read_b64_tr_b16 a[164:165], v228 offset:57344
  v_mfma_f32_16x16x32_bf16 v[40:43], a[180:183], a[56:59], v[40:43]
  buffer_load_dwordx4 v239, s[20:23], s31 offen offset:1024 lds
  v_mfma_f32_16x16x32_bf16 v[44:47], a[180:183], a[60:63], v[44:47]
  ds_read_b64_tr_b16 a[166:167], v228 offset:58368
  v_mfma_f32_16x16x32_bf16 v[44:47], a[176:179], a[44:47], v[44:47]
  s_waitcnt lgkmcnt(4)
  v_mfma_f32_16x16x32_bf16 v[48:51], a[184:187], a[32:35], v[48:51]
  ds_read_b64_tr_b16 a[168:169], v229 offset:49152
  v_mfma_f32_16x16x32_bf16 v[48:51], a[188:191], a[48:51], v[48:51]
  buffer_load_dwordx4 a[12:15], v242, s[24:27], s30 offen offset:3072 sc1
  v_mfma_f32_16x16x32_bf16 v[52:55], a[188:191], a[52:55], v[52:55]
  ds_read_b64_tr_b16 a[170:171], v229 offset:50176
  v_mfma_f32_16x16x32_bf16 v[52:55], a[184:187], a[36:39], v[52:55]
  v_mfma_f32_16x16x32_bf16 v[56:59], a[184:187], a[40:43], v[56:59]
  ds_read_b64_tr_b16 a[172:173], v229 offset:57344
  v_mfma_f32_16x16x32_bf16 v[56:59], a[188:191], a[56:59], v[56:59]
  v_mfma_f32_16x16x32_bf16 v[60:63], a[188:191], a[60:63], v[60:63]
  ds_read_b64_tr_b16 a[174:175], v229 offset:58368
  v_mfma_f32_16x16x32_bf16 v[60:63], a[184:187], a[44:47], v[60:63]
  s_waitcnt lgkmcnt(4)
  v_mfma_f32_16x16x32_bf16 v[64:67], a[160:163], a[32:35], v[64:67]
  ds_read_b64_tr_b16 a[176:177], v230 offset:49152
  v_mfma_f32_16x16x32_bf16 v[64:67], a[164:167], a[48:51], v[64:67]
  buffer_load_dwordx4 a[16:19], v243, s[24:27], s30 offen offset:0 sc1
  v_mfma_f32_16x16x32_bf16 v[68:71], a[164:167], a[52:55], v[68:71]
  ds_read_b64_tr_b16 a[178:179], v230 offset:50176
  v_mfma_f32_16x16x32_bf16 v[68:71], a[160:163], a[36:39], v[68:71]
  v_mfma_f32_16x16x32_bf16 v[72:75], a[160:163], a[40:43], v[72:75]
  ds_read_b64_tr_b16 a[180:181], v230 offset:57344
  v_mfma_f32_16x16x32_bf16 v[72:75], a[164:167], a[56:59], v[72:75]
  buffer_load_dwordx4 v240, s[20:23], s31 offen offset:2048 lds
  v_mfma_f32_16x16x32_bf16 v[76:79], a[164:167], a[60:63], v[76:79]
  ds_read_b64_tr_b16 a[182:183], v230 offset:58368
  v_mfma_f32_16x16x32_bf16 v[76:79], a[160:163], a[44:47], v[76:79]
  s_waitcnt lgkmcnt(4)
  v_mfma_f32_16x16x32_bf16 v[80:83], a[168:171], a[32:35], v[80:83]
  ds_read_b64_tr_b16 a[184:185], v231 offset:49152
  v_mfma_f32_16x16x32_bf16 v[80:83], a[172:175], a[48:51], v[80:83]
  buffer_load_dwordx4 a[20:23], v243, s[24:27], s30 offen offset:1024 sc1
  v_mfma_f32_16x16x32_bf16 v[84:87], a[172:175], a[52:55], v[84:87]
  ds_read_b64_tr_b16 a[186:187], v231 offset:50176
  v_mfma_f32_16x16x32_bf16 v[84:87], a[168:171], a[36:39], v[84:87]
  v_mfma_f32_16x16x32_bf16 v[88:91], a[168:171], a[40:43], v[88:91]
  ds_read_b64_tr_b16 a[188:189], v231 offset:57344
  v_mfma_f32_16x16x32_bf16 v[88:91], a[172:175], a[56:59], v[88:91]
  s_barrier
  v_mfma_f32_16x16x32_bf16 v[92:95], a[172:175], a[60:63], v[92:95]
  ds_read_b64_tr_b16 a[190:191], v231 offset:58368
  v_mfma_f32_16x16x32_bf16 v[92:95], a[168:171], a[44:47], v[92:95]
  s_waitcnt lgkmcnt(4)
  v_mfma_f32_16x16x32_bf16 v[96:99], a[176:179], a[32:35], v[96:99]
  ds_read_b64_tr_b16 a[160:161], v144 offset:32768
  v_mfma_f32_16x16x32_bf16 v[96:99], a[180:183], a[48:51], v[96:99]
  buffer_load_dwordx4 a[24:27], v243, s[24:27], s30 offen offset:2048 sc1
  v_mfma_f32_16x16x32_bf16 v[100:103], a[180:183], a[52:55], v[100:103]
  ds_read_b64_tr_b16 a[162:163], v144 offset:33792
  v_mfma_f32_16x16x32_bf16 v[100:103], a[176:179], a[36:39], v[100:103]
  v_mfma_f32_16x16x32_bf16 v[104:107], a[176:179], a[40:43], v[104:107]
  ds_read_b64_tr_b16 a[164:165], v144 offset:40960
  v_mfma_f32_16x16x32_bf16 v[104:107], a[180:183], a[56:59], v[104:107]
  buffer_load_dwordx4 v241, s[20:23], s31 offen offset:3072 lds
  s_add_u32 s31, s31, 0x80000
  v_mfma_f32_16x16x32_bf16 v[108:111], a[180:183], a[60:63], v[108:111]
  ds_read_b64_tr_b16 a[166:167], v144 offset:41984
  v_mfma_f32_16x16x32_bf16 v[108:111], a[176:179], a[44:47], v[108:111]
  s_waitcnt lgkmcnt(4)
  v_mfma_f32_16x16x32_bf16 v[112:115], a[184:187], a[32:35], v[112:115]
  ds_read_b64_tr_b16 a[168:169], v145 offset:32768
  v_mfma_f32_16x16x32_bf16 v[112:115], a[188:191], a[48:51], v[112:115]
  buffer_load_dwordx4 a[28:31], v243, s[24:27], s30 offen offset:3072 sc1
  s_add_u32 s30, s30, 8192
  v_mfma_f32_16x16x32_bf16 v[116:119], a[188:191], a[52:55], v[116:119]
  ds_read_b64_tr_b16 a[170:171], v145 offset:33792
  v_mfma_f32_16x16x32_bf16 v[116:119], a[184:187], a[36:39], v[116:119]
  v_mfma_f32_16x16x32_bf16 v[120:123], a[184:187], a[40:43], v[120:123]
  ds_read_b64_tr_b16 a[172:173], v145 offset:40960
  v_mfma_f32_16x16x32_bf16 v[120:123], a[188:191], a[56:59], v[120:123]
  v_mfma_f32_16x16x32_bf16 v[124:127], a[188:191], a[60:63], v[124:127]
  ds_read_b64_tr_b16 a[174:175], v145 offset:41984
  v_mfma_f32_16x16x32_bf16 v[124:127], a[184:187], a[44:47], v[124:127]
  s_waitcnt vmcnt(20) lgkmcnt(4)
  v_xor_b32 v136, s55, v136
  v_xor_b32 v137, s55, v137
  v_xor_b32 v138, s55, v138
  v_xor_b32 v139, s55, v139
  v_or3_b32 v136, v136, v137, v138
  v_or_b32 v136, v136, v139
  v_cmp_ne_u32 vcc, 0, v136
  s_nop 0
  s_cbranch_vccz front_keys
  s_mov_b32 s54, 32768
front_all:
  s_sleep 2
  buffer_load_dwordx4 v[136:139], v140, s[24:27], s58 offen sc1
  s_waitcnt vmcnt(0)
  v_xor_b32 v136, s55, v136
  v_xor_b32 v137, s55, v137
  v_xor_b32 v138, s55, v138
  v_xor_b32 v139, s55, v139
  v_or3_b32 v136, v136, v137, v138
  v_or_b32 v136, v136, v139
  v_cmp_ne_u32 vcc, 0, v136
  s_nop 0
  s_cbranch_vccz front_keys
  s_sub_u32 s54, s54, 1
  s_cmp_lg_u32 s54, 0
  s_cbranch_scc1 front_all
front_keys:
  s_lshl_b32 s35, s3, 11
  s_add_u32 s35, s35, 2621440
  buffer_load_dwordx4 v[128:131], v242, s[24:27], s35 offen sc1
  buffer_load_dwordx4 v[132:135], v242, s[24:27], s35 offen offset:1024 sc1
  v_mfma_f32_16x16x32_bf16 v[0:3], a[160:163], a[64:67], v[0:3]
  ds_read_b64_tr_b16 a[176:177], v146 offset:32768
  s_add_u32 s59, s59, 1
  s_or_b32 s54, s2, s3
  s_min_u32 s54, s54, 1
  v_mfma_f32_16x16x32_bf16 v[0:3], a[164:167], a[80:83], v[0:3]
  buffer_load_dwordx4 a[32:35], v242, s[24:27], s30 offen offset:0 sc1
  s_lshl_b32 s54, s54, 28
  v_mfma_f32_16x16x32_bf16 v[4:7], a[164:167], a[84:87], v[4:7]
  ds_read_b64_tr_b16 a[178:179], v146 offset:33792
  v_lshlrev_b32 v137, 22, v242
  v_mfma_f32_16x16x32_bf16 v[4:7], a[160:163], a[68:71], v[4:7]
  v_or_b32 v137, s54, v137
  v_mov_b32 v136, s59
  v_mfma_f32_16x16x32_bf16 v[8:11], a[160:163], a[72:75], v[8:11]
  ds_read_b64_tr_b16 a[180:181], v146 offset:40960
  s_add_u32 m0, s28, 0
  s_mov_b32 s58, 2830336
  buffer_store_dword v136, v137, s[24:27], s58 offen sc1
  v_mfma_f32_16x16x32_bf16 v[8:11], a[164:167], a[88:91], v[8:11]
  buffer_load_dwordx4 v238, s[20:23], s31 offen offset:0 lds
  v_mfma_f32_16x16x32_bf16 v[12:15], a[164:167], a[92:95], v[12:15]
  ds_read_b64_tr_b16 a[182:183], v146 offset:41984
  v_mfma_f32_16x16x32_bf16 v[12:15], a[160:163], a[76:79], v[12:15]
  s_waitcnt lgkmcnt(4)
  v_mfma_f32_16x16x32_bf16 v[16:19], a[168:171], a[64:67], v[16:19]
  ds_read_b64_tr_b16 a[184:185], v147 offset:32768
  v_mfma_f32_16x16x32_bf16 v[16:19], a[172:175], a[80:83], v[16:19]
  buffer_load_dwordx4 a[36:39], v242, s[24:27], s30 offen offset:1024 sc1
  v_mfma_f32_16x16x32_bf16 v[20:23], a[172:175], a[84:87], v[20:23]
  ds_read_b64_tr_b16 a[186:187], v147 offset:33792
  v_mfma_f32_16x16x32_bf16 v[20:23], a[168:171], a[68:71], v[20:23]
  v_mfma_f32_16x16x32_bf16 v[24:27], a[168:171], a[72:75], v[24:27]
  ds_read_b64_tr_b16 a[188:189], v147 offset:40960
  v_mfma_f32_16x16x32_bf16 v[24:27], a[172:175], a[88:91], v[24:27]
  v_mfma_f32_16x16x32_bf16 v[28:31], a[172:175], a[92:95], v[28:31]
  ds_read_b64_tr_b16 a[190:191], v147 offset:41984
  v_mfma_f32_16x16x32_bf16 v[28:31], a[168:171], a[76:79], v[28:31]
  s_waitcnt lgkmcnt(4)
  v_mfma_f32_16x16x32_bf16 v[32:35], a[176:179], a[64:67], v[32:35]
  ds_read_b64_tr_b16 a[160:161], v148 offset:32768
  v_mfma_f32_16x16x32_bf16 v[32:35], a[180:183], a[80:83], v[32:35]
  buffer_load_dwordx4 a[40:43], v242, s[24:27], s30 offen offset:2048 sc1
  v_mfma_f32_16x16x32_bf16 v[36:39], a[180:183], a[84:87], v[36:39]
  ds_read_b64_tr_b16 a[162:163], v148 offset:33792
  v_mfma_f32_16x16x32_bf16 v[36:39], a[176:179], a[68:71], v[36:39]
  v_mfma_f32_16x16x32_bf16 v[40:43], a[176:179], a[72:75], v[40:43]
  ds_read_b64_tr_b16 a[164:165], v148 offset:40960
  v_mfma_f32_16x16x32_bf16 v[40:43], a[180:183], a[88:91], v[40:43]
  buffer_load_dwordx4 v239, s[20:23], s31 offen offset:1024 lds
  v_mfma_f32_16x16x32_bf16 v[44:47], a[180:183], a[92:95], v[44:47]
  ds_read_b64_tr_b16 a[166:167], v148 offset:41984
  v_mfma_f32_16x16x32_bf16 v[44:47], a[176:179], a[76:79], v[44:47]
  s_waitcnt lgkmcnt(4)
  v_mfma_f32_16x16x32_bf16 v[48:51], a[184:187], a[64:67], v[48:51]
  ds_read_b64_tr_b16 a[168:169], v149 offset:32768
  v_mfma_f32_16x16x32_bf16 v[48:51], a[188:191], a[80:83], v[48:51]
  buffer_load_dwordx4 a[44:47], v242, s[24:27], s30 offen offset:3072 sc1
  v_mfma_f32_16x16x32_bf16 v[52:55], a[188:191], a[84:87], v[52:55]
  ds_read_b64_tr_b16 a[170:171], v149 offset:33792
  v_mfma_f32_16x16x32_bf16 v[52:55], a[184:187], a[68:71], v[52:55]
  v_mfma_f32_16x16x32_bf16 v[56:59], a[184:187], a[72:75], v[56:59]
  ds_read_b64_tr_b16 a[172:173], v149 offset:40960
  v_mfma_f32_16x16x32_bf16 v[56:59], a[188:191], a[88:91], v[56:59]
  v_mfma_f32_16x16x32_bf16 v[60:63], a[188:191], a[92:95], v[60:63]
  ds_read_b64_tr_b16 a[174:175], v149 offset:41984
  v_mfma_f32_16x16x32_bf16 v[60:63], a[184:187], a[76:79], v[60:63]
  s_waitcnt lgkmcnt(4)
  v_mfma_f32_16x16x32_bf16 v[64:67], a[160:163], a[64:67], v[64:67]
  ds_read_b64_tr_b16 a[176:177], v150 offset:32768
  v_mfma_f32_16x16x32_bf16 v[64:67], a[164:167], a[80:83], v[64:67]
  buffer_load_dwordx4 a[48:51], v243, s[24:27], s30 offen offset:0 sc1
  v_mfma_f32_16x16x32_bf16 v[68:71], a[164:167], a[84:87], v[68:71]
  ds_read_b64_tr_b16 a[178:179], v150 offset:33792
  v_mfma_f32_16x16x32_bf16 v[68:71], a[160:163], a[68:71], v[68:71]
  v_mfma_f32_16x16x32_bf16 v[72:75], a[160:163], a[72:75], v[72:75]
  ds_read_b64_tr_b16 a[180:181], v150 offset:40960
  v_mfma_f32_16x16x32_bf16 v[72:75], a[164:167], a[88:91], v[72:75]
  buffer_load_dwordx4 v240, s[20:23], s31 offen offset:2048 lds
  v_mfma_f32_16x16x32_bf16 v[76:79], a[164:167], a[92:95], v[76:79]
  ds_read_b64_tr_b16 a[182:183], v150 offset:41984
  v_mfma_f32_16x16x32_bf16 v[76:79], a[160:163], a[76:79], v[76:79]
  s_waitcnt lgkmcnt(4)
  v_mfma_f32_16x16x32_bf16 v[80:83], a[168:171], a[64:67], v[80:83]
  ds_read_b64_tr_b16 a[184:185], v151 offset:32768
  v_mfma_f32_16x16x32_bf16 v[80:83], a[172:175], a[80:83], v[80:83]
  buffer_load_dwordx4 a[52:55], v243, s[24:27], s30 offen offset:1024 sc1
  v_mfma_f32_16x16x32_bf16 v[84:87], a[172:175], a[84:87], v[84:87]
  ds_read_b64_tr_b16 a[186:187], v151 offset:33792
  v_mfma_f32_16x16x32_bf16 v[84:87], a[168:171], a[68:71], v[84:87]
  v_mfma_f32_16x16x32_bf16 v[88:91], a[168:171], a[72:75], v[88:91]
  ds_read_b64_tr_b16 a[188:189], v151 offset:40960
  v_mfma_f32_16x16x32_bf16 v[88:91], a[172:175], a[88:91], v[88:91]
  s_barrier
  v_mfma_f32_16x16x32_bf16 v[92:95], a[172:175], a[92:95], v[92:95]
  ds_read_b64_tr_b16 a[190:191], v151 offset:41984
  v_mfma_f32_16x16x32_bf16 v[92:95], a[168:171], a[76:79], v[92:95]
  s_waitcnt lgkmcnt(4)
  v_mfma_f32_16x16x32_bf16 v[96:99], a[176:179], a[64:67], v[96:99]
  ds_read_b64_tr_b16 a[160:161], v144 offset:49152
  v_mfma_f32_16x16x32_bf16 v[96:99], a[180:183], a[80:83], v[96:99]
  buffer_load_dwordx4 a[56:59], v243, s[24:27], s30 offen offset:2048 sc1
  v_mfma_f32_16x16x32_bf16 v[100:103], a[180:183], a[84:87], v[100:103]
  ds_read_b64_tr_b16 a[162:163], v144 offset:50176
  v_mfma_f32_16x16x32_bf16 v[100:103], a[176:179], a[68:71], v[100:103]
  v_mfma_f32_16x16x32_bf16 v[104:107], a[176:179], a[72:75], v[104:107]
  ds_read_b64_tr_b16 a[164:165], v144 offset:57344
  v_mfma_f32_16x16x32_bf16 v[104:107], a[180:183], a[88:91], v[104:107]
  buffer_load_dwordx4 v241, s[20:23], s31 offen offset:3072 lds
  s_add_u32 s31, s31, 0x80000
  v_mfma_f32_16x16x32_bf16 v[108:111], a[180:183], a[92:95], v[108:111]
  ds_read_b64_tr_b16 a[166:167], v144 offset:58368
  v_mfma_f32_16x16x32_bf16 v[108:111], a[176:179], a[76:79], v[108:111]
  s_waitcnt lgkmcnt(4)
  v_mfma_f32_16x16x32_bf16 v[112:115], a[184:187], a[64:67], v[112:115]
  ds_read_b64_tr_b16 a[168:169], v145 offset:49152
  v_mfma_f32_16x16x32_bf16 v[112:115], a[188:191], a[80:83], v[112:115]
  buffer_load_dwordx4 a[60:63], v243, s[24:27], s30 offen offset:3072 sc1
  s_add_u32 s30, s30, 8192
  v_mfma_f32_16x16x32_bf16 v[116:119], a[188:191], a[84:87], v[116:119]
  ds_read_b64_tr_b16 a[170:171], v145 offset:50176
  v_mfma_f32_16x16x32_bf16 v[116:119], a[184:187], a[68:71], v[116:119]
  v_mfma_f32_16x16x32_bf16 v[120:123], a[184:187], a[72:75], v[120:123]
  ds_read_b64_tr_b16 a[172:173], v145 offset:57344
  v_mfma_f32_16x16x32_bf16 v[120:123], a[188:191], a[88:91], v[120:123]
  v_mfma_f32_16x16x32_bf16 v[124:127], a[188:191], a[92:95], v[124:127]
  ds_read_b64_tr_b16 a[174:175], v145 offset:58368
  v_mfma_f32_16x16x32_bf16 v[124:127], a[184:187], a[76:79], v[124:127]
  s_waitcnt vmcnt(27) lgkmcnt(4)
  v_mfma_f32_16x16x32_bf16 v[0:3], a[160:163], a[96:99], v[0:3]
  ds_read_b64_tr_b16 a[176:177], v146 offset:49152
  v_mfma_f32_16x16x32_bf16 v[0:3], a[164:167], a[112:115], v[0:3]
  buffer_load_dwordx4 a[64:67], v242, s[24:27], s30 offen offset:0 sc1
  v_mfma_f32_16x16x32_bf16 v[4:7], a[164:167], a[116:119], v[4:7]
  ds_read_b64_tr_b16 a[178:179], v146 offset:50176
  v_mfma_f32_16x16x32_bf16 v[4:7], a[160:163], a[100:103], v[4:7]
  v_mfma_f32_16x16x32_bf16 v[8:11], a[160:163], a[104:107], v[8:11]
  ds_read_b64_tr_b16 a[180:181], v146 offset:57344
  s_add_u32 m0, s28, 65536
  v_mfma_f32_16x16x32_bf16 v[8:11], a[164:167], a[120:123], v[8:11]
  buffer_load_dwordx4 v238, s[20:23], s31 offen offset:0 lds
  v_mfma_f32_16x16x32_bf16 v[12:15], a[164:167], a[124:127], v[12:15]
  ds_read_b64_tr_b16 a[182:183], v146 offset:58368
  v_mfma_f32_16x16x32_bf16 v[12:15], a[160:163], a[108:111], v[12:15]
  s_waitcnt lgkmcnt(4)
  v_mfma_f32_16x16x32_bf16 v[16:19], a[168:171], a[96:99], v[16:19]
  ds_read_b64_tr_b16 a[184:185], v147 offset:49152
  v_mfma_f32_16x16x32_bf16 v[16:19], a[172:175], a[112:115], v[16:19]
  buffer_load_dwordx4 a[68:71], v242, s[24:27], s30 offen offset:1024 sc1
  v_mfma_f32_16x16x32_bf16 v[20:23], a[172:175], a[116:119], v[20:23]
  ds_read_b64_tr_b16 a[186:187], v147 offset:50176
  v_mfma_f32_16x16x32_bf16 v[20:23], a[168:171], a[100:103], v[20:23]
  v_mfma_f32_16x16x32_bf16 v[24:27], a[168:171], a[104:107], v[24:27]
  ds_read_b64_tr_b16 a[188:189], v147 offset:57344
  v_mfma_f32_16x16x32_bf16 v[24:27], a[172:175], a[120:123], v[24:27]
  v_mfma_f32_16x16x32_bf16 v[28:31], a[172:175], a[124:127], v[28:31]
  ds_read_b64_tr_b16 a[190:191], v147 offset:58368
  v_mfma_f32_16x16x32_bf16 v[28:31], a[168:171], a[108:111], v[28:31]
  s_waitcnt lgkmcnt(4)
  v_mfma_f32_16x16x32_bf16 v[32:35], a[176:179], a[96:99], v[32:35]
  ds_read_b64_tr_b16 a[160:161], v148 offset:49152
  v_mfma_f32_16x16x32_bf16 v[32:35], a[180:183], a[112:115], v[32:35]
  buffer_load_dwordx4 a[72:75], v242, s[24:27], s30 offen offset:2048 sc1
  v_mfma_f32_16x16x32_bf16 v[36:39], a[180:183], a[116:119], v[36:39]
  ds_read_b64_tr_b16 a[162:163], v148 offset:50176
  v_mfma_f32_16x16x32_bf16 v[36:39], a[176:179], a[100:103], v[36:39]
  v_mfma_f32_16x16x32_bf16 v[40:43], a[176:179], a[104:107], v[40:43]
  ds_read_b64_tr_b16 a[164:165], v148 offset:57344
  v_mfma_f32_16x16x32_bf16 v[40:43], a[180:183], a[120:123], v[40:43]
  buffer_load_dwordx4 v239, s[20:23], s31 offen offset:1024 lds
  v_mfma_f32_16x16x32_bf16 v[44:47], a[180:183], a[124:127], v[44:47]
  ds_read_b64_tr_b16 a[166:167], v148 offset:58368
  v_mfma_f32_16x16x32_bf16 v[44:47], a[176:179], a[108:111], v[44:47]
  s_waitcnt lgkmcnt(4)
  v_mfma_f32_16x16x32_bf16 v[48:51], a[184:187], a[96:99], v[48:51]
  ds_read_b64_tr_b16 a[168:169], v149 offset:49152
  v_mfma_f32_16x16x32_bf16 v[48:51], a[188:191], a[112:115], v[48:51]
  buffer_load_dwordx4 a[76:79], v242, s[24:27], s30 offen offset:3072 sc1
  v_mfma_f32_16x16x32_bf16 v[52:55], a[188:191], a[116:119], v[52:55]
  ds_read_b64_tr_b16 a[170:171], v149 offset:50176
  v_mfma_f32_16x16x32_bf16 v[52:55], a[184:187], a[100:103], v[52:55]
  v_mfma_f32_16x16x32_bf16 v[56:59], a[184:187], a[104:107], v[56:59]
  ds_read_b64_tr_b16 a[172:173], v149 offset:57344
  v_mfma_f32_16x16x32_bf16 v[56:59], a[188:191], a[120:123], v[56:59]
  v_mfma_f32_16x16x32_bf16 v[60:63], a[188:191], a[124:127], v[60:63]
  ds_read_b64_tr_b16 a[174:175], v149 offset:58368
  v_mfma_f32_16x16x32_bf16 v[60:63], a[184:187], a[108:111], v[60:63]
  s_waitcnt lgkmcnt(4)
  v_mfma_f32_16x16x32_bf16 v[64:67], a[160:163], a[96:99], v[64:67]
  ds_read_b64_tr_b16 a[176:177], v150 offset:49152
  v_mfma_f32_16x16x32_bf16 v[64:67], a[164:167], a[112:115], v[64:67]
  buffer_load_dwordx4 a[80:83], v243, s[24:27], s30 offen offset:0 sc1
  v_mfma_f32_16x16x32_bf16 v[68:71], a[164:167], a[116:119], v[68:71]
  ds_read_b64_tr_b16 a[178:179], v150 offset:50176
  v_mfma_f32_16x16x32_bf16 v[68:71], a[160:163], a[100:103], v[68:71]
  v_mfma_f32_16x16x32_bf16 v[72:75], a[160:163], a[104:107], v[72:75]
  ds_read_b64_tr_b16 a[180:181], v150 offset:57344
  v_mfma_f32_16x16x32_bf16 v[72:75], a[164:167], a[120:123], v[72:75]
  buffer_load_dwordx4 v240, s[20:23], s31 offen offset:2048 lds
  v_mfma_f32_16x16x32_bf16 v[76:79], a[164:167], a[124:127], v[76:79]
  ds_read_b64_tr_b16 a[182:183], v150 offset:58368
  v_mfma_f32_16x16x32_bf16 v[76:79], a[160:163], a[108:111], v[76:79]
  s_waitcnt lgkmcnt(4)
  v_mfma_f32_16x16x32_bf16 v[80:83], a[168:171], a[96:99], v[80:83]
  ds_read_b64_tr_b16 a[184:185], v151 offset:49152
  v_mfma_f32_16x16x32_bf16 v[80:83], a[172:175], a[112:115], v[80:83]
  buffer_load_dwordx4 a[84:87], v243, s[24:27], s30 offen offset:1024 sc1
  v_mfma_f32_16x16x32_bf16 v[84:87], a[172:175], a[116:119], v[84:87]
  ds_read_b64_tr_b16 a[186:187], v151 offset:50176
  v_mfma_f32_16x16x32_bf16 v[84:87], a[168:171], a[100:103], v[84:87]
  s_waitcnt vmcnt(25)
  v_mfma_f32_16x16x32_bf16 v[88:91], a[168:171], a[104:107], v[88:91]
  ds_read_b64_tr_b16 a[188:189], v151 offset:57344
  v_mfma_f32_16x16x32_bf16 v[88:91], a[172:175], a[120:123], v[88:91]
  s_barrier
  v_mfma_f32_16x16x32_bf16 v[92:95], a[172:175], a[124:127], v[92:95]
  ds_read_b64_tr_b16 a[190:191], v151 offset:58368
  v_mfma_f32_16x16x32_bf16 v[92:95], a[168:171], a[108:111], v[92:95]
  s_waitcnt lgkmcnt(4)
  v_mfma_f32_16x16x32_bf16 v[96:99], a[176:179], a[96:99], v[96:99]
  ds_read_b64_tr_b16 a[160:161], v144 offset:16384
  v_mfma_f32_16x16x32_bf16 v[96:99], a[180:183], a[112:115], v[96:99]
  buffer_load_dwordx4 a[88:91], v243, s[24:27], s30 offen offset:2048 sc1
  v_mfma_f32_16x16x32_bf16 v[100:103], a[180:183], a[116:119], v[100:103]
  ds_read_b64_tr_b16 a[162:163], v144 offset:17408
  v_mfma_f32_16x16x32_bf16 v[100:103], a[176:179], a[100:103], v[100:103]
  v_mfma_f32_16x16x32_bf16 v[104:107], a[176:179], a[104:107], v[104:107]
  ds_read_b64_tr_b16 a[164:165], v144 offset:24576
  v_mfma_f32_16x16x32_bf16 v[104:107], a[180:183], a[120:123], v[104:107]
  buffer_load_dwordx4 v241, s[20:23], s31 offen offset:3072 lds
  s_add_u32 s31, s31, 0x80000
  v_mfma_f32_16x16x32_bf16 v[108:111], a[180:183], a[124:127], v[108:111]
  ds_read_b64_tr_b16 a[166:167], v144 offset:25600
  v_mfma_f32_16x16x32_bf16 v[108:111], a[176:179], a[108:111], v[108:111]
  s_waitcnt lgkmcnt(4)
  v_mfma_f32_16x16x32_bf16 v[112:115], a[184:187], a[96:99], v[112:115]
  ds_read_b64_tr_b16 a[168:169], v145 offset:16384
  v_mfma_f32_16x16x32_bf16 v[112:115], a[188:191], a[112:115], v[112:115]
  buffer_load_dwordx4 a[92:95], v243, s[24:27], s30 offen offset:3072 sc1
  s_add_u32 s30, s30, 8192
  v_mfma_f32_16x16x32_bf16 v[116:119], a[188:191], a[116:119], v[116:119]
  ds_read_b64_tr_b16 a[170:171], v145 offset:17408
  v_mfma_f32_16x16x32_bf16 v[116:119], a[184:187], a[100:103], v[116:119]
  v_mfma_f32_16x16x32_bf16 v[120:123], a[184:187], a[104:107], v[120:123]
  ds_read_b64_tr_b16 a[172:173], v145 offset:24576
  v_mfma_f32_16x16x32_bf16 v[120:123], a[188:191], a[120:123], v[120:123]
  v_mfma_f32_16x16x32_bf16 v[124:127], a[188:191], a[124:127], v[124:127]
  ds_read_b64_tr_b16 a[174:175], v145 offset:25600
  v_mfma_f32_16x16x32_bf16 v[124:127], a[184:187], a[108:111], v[124:127]
  s_waitcnt vmcnt(27) lgkmcnt(4)
  v_mfma_f32_16x16x32_bf16 v[0:3], a[160:163], a[0:3], v[0:3]
  ds_read_b64_tr_b16 a[176:177], v146 offset:16384
  s_waitcnt vmcnt(25)
  s_mov_b32 s51, -1
  v_sub_u32 v137, s51, v128
  v_mfma_f32_16x16x32_bf16 v[0:3], a[164:167], a[16:19], v[0:3]
  buffer_load_dwordx4 a[96:99], v242, s[24:27], s30 offen offset:0 sc1
  v_mfma_f32_16x16x32_bf16 v[4:7], a[164:167], a[20:23], v[4:7]
  ds_read_b64_tr_b16 a[178:179], v146 offset:17408
  v_sub_u32 v138, s51, v129
  v_mfma_f32_16x16x32_bf16 v[4:7], a[160:163], a[4:7], v[4:7]
  v_min_u32 v136, v137, v138
  v_sub_u32 v139, s51, v130
  v_mfma_f32_16x16x32_bf16 v[8:11], a[160:163], a[8:11], v[8:11]
  ds_read_b64_tr_b16 a[180:181], v146 offset:24576
  s_add_u32 m0, s28, 81920
  v_sub_u32 v140, s51, v131
  v_mfma_f32_16x16x32_bf16 v[8:11], a[164:167], a[24:27], v[8:11]
  buffer_load_dwordx4 v238, s[20:23], s31 offen offset:0 lds
  v_mfma_f32_16x16x32_bf16 v[12:15], a[164:167], a[28:31], v[12:15]
  ds_read_b64_tr_b16 a[182:183], v146 offset:25600
  v_min3_u32 v136, v136, v139, v140
  v_mfma_f32_16x16x32_bf16 v[12:15], a[160:163], a[12:15], v[12:15]
  s_waitcnt lgkmcnt(4)
  v_sub_u32 v137, s51, v132
  v_sub_u32 v138, s51, v133
  v_mfma_f32_16x16x32_bf16 v[16:19], a[168:171], a[0:3], v[16:19]
  ds_read_b64_tr_b16 a[184:185], v147 offset:16384
  v_min3_u32 v136, v136, v137, v138
  v_mfma_f32_16x16x32_bf16 v[16:19], a[172:175], a[16:19], v[16:19]
  buffer_load_dwordx4 a[100:103], v242, s[24:27], s30 offen offset:1024 sc1
  v_mfma_f32_16x16x32_bf16 v[20:23], a[172:175], a[20:23], v[20:23]
  ds_read_b64_tr_b16 a[186:187], v147 offset:17408
  v_sub_u32 v139, s51, v134
  v_mfma_f32_16x16x32_bf16 v[20:23], a[168:171], a[4:7], v[20:23]
  v_sub_u32 v140, s51, v135
  v_min3_u32 v136, v136, v139, v140
  v_mfma_f32_16x16x32_bf16 v[24:27], a[168:171], a[8:11], v[24:27]
  ds_read_b64_tr_b16 a[188:189], v147 offset:24576
  v_min_u32_dpp v136, v136, v136 row_ror:8 row_mask:0xf bank_mask:0xf
  v_mfma_f32_16x16x32_bf16 v[24:27], a[172:175], a[24:27], v[24:27]
  v_mfma_f32_16x16x32_bf16 v[28:31], a[172:175], a[28:31], v[28:31]
  ds_read_b64_tr_b16 a[190:191], v147 offset:25600
  v_min_u32_dpp v136, v136, v136 row_ror:4 row_mask:0xf bank_mask:0xf
  v_mfma_f32_16x16x32_bf16 v[28:31], a[168:171], a[12:15], v[28:31]
  s_waitcnt lgkmcnt(4)
  v_min_u32_dpp v136, v136, v136 row_ror:2 row_mask:0xf bank_mask:0xf
  v_mfma_f32_16x16x32_bf16 v[32:35], a[176:179], a[0:3], v[32:35]
  ds_read_b64_tr_b16 a[160:161], v148 offset:16384
  v_min_u32_dpp v136, v136, v136 row_ror:1 row_mask:0xf bank_mask:0xf
  v_mfma_f32_16x16x32_bf16 v[32:35], a[180:183], a[16:19], v[32:35]
  buffer_load_dwordx4 a[104:107], v242, s[24:27], s30 offen offset:2048 sc1
  v_mfma_f32_16x16x32_bf16 v[36:39], a[180:183], a[20:23], v[36:39]
  ds_read_b64_tr_b16 a[162:163], v148 offset:17408
  v_readlane_b32 s98, v136, 0
  v_mfma_f32_16x16x32_bf16 v[36:39], a[176:179], a[4:7], v[36:39]
  v_readlane_b32 s99, v136, 16
  v_readlane_b32 s100, v136, 32
  v_mfma_f32_16x16x32_bf16 v[40:43], a[176:179], a[8:11], v[40:43]
  ds_read_b64_tr_b16 a[164:165], v148 offset:24576
  v_readlane_b32 s101, v136, 48
  v_mfma_f32_16x16x32_bf16 v[40:43], a[180:183], a[24:27], v[40:43]
  buffer_load_dwordx4 v239, s[20:23], s31 offen offset:1024 lds
  s_min_u32 s98, s98, s99
  s_min_u32 s100, s100, s101
  s_min_u32 s98, s98, s100
  v_mfma_f32_16x16x32_bf16 v[44:47], a[180:183], a[28:31], v[44:47]
  ds_read_b64_tr_b16 a[166:167], v148 offset:25600
  s_sub_u32 s52, s51, s98
  s_sub_u32 s51, s52, 1
  v_sub_u32 v137, s51, v128
  v_mfma_f32_16x16x32_bf16 v[44:47], a[176:179], a[12:15], v[44:47]
  s_waitcnt lgkmcnt(4)
  v_sub_u32 v138, s51, v129
  v_min_u32 v136, v137, v138
  v_mfma_f32_16x16x32_bf16 v[48:51], a[184:187], a[0:3], v[48:51]
  ds_read_b64_tr_b16 a[168:169], v149 offset:16384
  v_sub_u32 v139, s51, v130
  v_mfma_f32_16x16x32_bf16 v[48:51], a[188:191], a[16:19], v[48:51]
  buffer_load_dwordx4 a[108:111], v242, s[24:27], s30 offen offset:3072 sc1
  v_mfma_f32_16x16x32_bf16 v[52:55], a[188:191], a[20:23], v[52:55]
  ds_read_b64_tr_b16 a[170:171], v149 offset:17408
  v_sub_u32 v140, s51, v131
  v_mfma_f32_16x16x32_bf16 v[52:55], a[184:187], a[4:7], v[52:55]
  v_min3_u32 v136, v136, v139, v140
  v_sub_u32 v137, s51, v132
  v_mfma_f32_16x16x32_bf16 v[56:59], a[184:187], a[8:11], v[56:59]
  ds_read_b64_tr_b16 a[172:173], v149 offset:24576
  v_sub_u32 v138, s51, v133
  v_mfma_f32_16x16x32_bf16 v[56:59], a[188:191], a[24:27], v[56:59]
  v_min3_u32 v136, v136, v137, v138
  v_sub_u32 v139, s51, v134
  v_mfma_f32_16x16x32_bf16 v[60:63], a[188:191], a[28:31], v[60:63]
  ds_read_b64_tr_b16 a[174:175], v149 offset:25600
  v_sub_u32 v140, s51, v135
  v_mfma_f32_16x16x32_bf16 v[60:63], a[184:187], a[12:15], v[60:63]
  s_waitcnt lgkmcnt(4)
  v_min3_u32 v136, v136, v139, v140
  v_mfma_f32_16x16x32_bf16 v[64:67], a[160:163], a[0:3], v[64:67]
  ds_read_b64_tr_b16 a[176:177], v150 offset:16384
  v_min_u32_dpp v136, v136, v136 row_ror:8 row_mask:0xf bank_mask:0xf
  v_mfma_f32_16x16x32_bf16 v[64:67], a[164:167], a[16:19], v[64:67]
  buffer_load_dwordx4 a[112:115], v243, s[24:27], s30 offen offset:0 sc1
  v_mfma_f32_16x16x32_bf16 v[68:71], a[164:167], a[20:23], v[68:71]
  ds_read_b64_tr_b16 a[178:179], v150 offset:17408
  v_min_u32_dpp v136, v136, v136 row_ror:4 row_mask:0xf bank_mask:0xf
  v_mfma_f32_16x16x32_bf16 v[68:71], a[160:163], a[4:7], v[68:71]
  v_mfma_f32_16x16x32_bf16 v[72:75], a[160:163], a[8:11], v[72:75]
  ds_read_b64_tr_b16 a[180:181], v150 offset:24576
  v_min_u32_dpp v136, v136, v136 row_ror:2 row_mask:0xf bank_mask:0xf
  v_mfma_f32_16x16x32_bf16 v[72:75], a[164:167], a[24:27], v[72:75]
  buffer_load_dwordx4 v240, s[20:23], s31 offen offset:2048 lds
  v_mfma_f32_16x16x32_bf16 v[76:79], a[164:167], a[28:31], v[76:79]
  ds_read_b64_tr_b16 a[182:183], v150 offset:25600
  v_min_u32_dpp v136, v136, v136 row_ror:1 row_mask:0xf bank_mask:0xf
  v_mfma_f32_16x16x32_bf16 v[76:79], a[160:163], a[12:15], v[76:79]
  s_waitcnt lgkmcnt(4)
  v_readlane_b32 s98, v136, 0
  v_readlane_b32 s99, v136, 16
  v_mfma_f32_16x16x32_bf16 v[80:83], a[168:171], a[0:3], v[80:83]
  ds_read_b64_tr_b16 a[184:185], v151 offset:16384
  v_readlane_b32 s100, v136, 32
  v_mfma_f32_16x16x32_bf16 v[80:83], a[172:175], a[16:19], v[80:83]
  buffer_load_dwordx4 a[116:119], v243, s[24:27], s30 offen offset:1024 sc1
  v_mfma_f32_16x16x32_bf16 v[84:87], a[172:175], a[20:23], v[84:87]
  ds_read_b64_tr_b16 a[186:187], v151 offset:17408
  v_readlane_b32 s101, v136, 48
  v_mfma_f32_16x16x32_bf16 v[84:87], a[168:171], a[4:7], v[84:87]
  s_waitcnt vmcnt(22)
  s_min_u32 s98, s98, s99
  s_min_u32 s100, s100, s101
  v_mfma_f32_16x16x32_bf16 v[88:91], a[168:171], a[8:11], v[88:91]
  ds_read_b64_tr_b16 a[188:189], v151 offset:24576
  s_min_u32 s98, s98, s100
  s_sub_u32 s53, s51, s98
  s_sub_u32 s51, s53, 1
  v_sub_u32 v137, s51, v128
  v_mfma_f32_16x16x32_bf16 v[88:91], a[172:175], a[24:27], v[88:91]
  s_barrier
  v_sub_u32 v138, s51, v129
  v_min_u32 v136, v137, v138
  v_mfma_f32_16x16x32_bf16 v[92:95], a[172:175], a[28:31], v[92:95]
  ds_read_b64_tr_b16 a[190:191], v151 offset:25600
  v_sub_u32 v139, s51, v130
  v_mfma_f32_16x16x32_bf16 v[92:95], a[168:171], a[12:15], v[92:95]
  s_waitcnt lgkmcnt(4)
  v_sub_u32 v140, s51, v131
  v_min3_u32 v136, v136, v139, v140
  v_mfma_f32_16x16x32_bf16 v[96:99], a[176:179], a[0:3], v[96:99]
  ds_read_b64_tr_b16 a[160:161], v144 offset:0
  v_sub_u32 v137, s51, v132
  v_mfma_f32_16x16x32_bf16 v[96:99], a[180:183], a[16:19], v[96:99]
  buffer_load_dwordx4 a[120:123], v243, s[24:27], s30 offen offset:2048 sc1
  v_mfma_f32_16x16x32_bf16 v[100:103], a[180:183], a[20:23], v[100:103]
  ds_read_b64_tr_b16 a[162:163], v144 offset:1024
  v_sub_u32 v138, s51, v133
  v_mfma_f32_16x16x32_bf16 v[100:103], a[176:179], a[4:7], v[100:103]
  v_min3_u32 v136, v136, v137, v138
  v_sub_u32 v139, s51, v134
  v_mfma_f32_16x16x32_bf16 v[104:107], a[176:179], a[8:11], v[104:107]
  ds_read_b64_tr_b16 a[164:165], v144 offset:8192
  v_sub_u32 v140, s51, v135
  v_mfma_f32_16x16x32_bf16 v[104:107], a[180:183], a[24:27], v[104:107]
  buffer_load_dwordx4 v241, s[20:23], s31 offen offset:3072 lds
  s_add_u32 s31, s31, 0x80000
  v_mfma_f32_16x16x32_bf16 v[108:111], a[180:183], a[28:31], v[108:111]
  ds_read_b64_tr_b16 a[166:167], v144 offset:9216
  v_min3_u32 v136, v136, v139, v140
  v_mfma_f32_16x16x32_bf16 v[108:111], a[176:179], a[12:15], v[108:111]
  s_waitcnt lgkmcnt(4)
  v_min_u32_dpp v136, v136, v136 row_ror:8 row_mask:0xf bank_mask:0xf
  v_mfma_f32_16x16x32_bf16 v[112:115], a[184:187], a[0:3], v[112:115]
  ds_read_b64_tr_b16 a[168:169], v145 offset:0
  v_min_u32_dpp v136, v136, v136 row_ror:4 row_mask:0xf bank_mask:0xf
  v_mfma_f32_16x16x32_bf16 v[112:115], a[188:191], a[16:19], v[112:115]
  buffer_load_dwordx4 a[124:127], v243, s[24:27], s30 offen offset:3072 sc1
  s_add_u32 s30, s30, 8192
  v_mfma_f32_16x16x32_bf16 v[116:119], a[188:191], a[20:23], v[116:119]
  ds_read_b64_tr_b16 a[170:171], v145 offset:1024
  v_min_u32_dpp v136, v136, v136 row_ror:2 row_mask:0xf bank_mask:0xf
  v_mfma_f32_16x16x32_bf16 v[116:119], a[184:187], a[4:7], v[116:119]
  v_mfma_f32_16x16x32_bf16 v[120:123], a[184:187], a[8:11], v[120:123]
  ds_read_b64_tr_b16 a[172:173], v145 offset:8192
  v_min_u32_dpp v136, v136, v136 row_ror:1 row_mask:0xf bank_mask:0xf
  v_mfma_f32_16x16x32_bf16 v[120:123], a[188:191], a[24:27], v[120:123]
  v_readlane_b32 s98, v136, 0
  v_readlane_b32 s99, v136, 16
  v_mfma_f32_16x16x32_bf16 v[124:127], a[188:191], a[28:31], v[124:127]
  ds_read_b64_tr_b16 a[174:175], v145 offset:9216
  v_readlane_b32 s100, v136, 32
  v_mfma_f32_16x16x32_bf16 v[124:127], a[184:187], a[12:15], v[124:127]
  s_waitcnt vmcnt(24) lgkmcnt(4)
  v_readlane_b32 s101, v136, 48
  v_mfma_f32_16x16x32_bf16 v[0:3], a[160:163], a[32:35], v[0:3]
  ds_read_b64_tr_b16 a[176:177], v146 offset:0
  s_min_u32 s98, s98, s99
  s_min_u32 s100, s100, s101
  s_min_u32 s98, s98, s100
  v_mfma_f32_16x16x32_bf16 v[0:3], a[164:167], a[48:51], v[0:3]
  buffer_load_dwordx4 a[0:3], v242, s[24:27], s30 offen offset:0 sc1
  s_sub_u32 s54, s51, s98
  s_sub_u32 s51, s54, 1
  v_mfma_f32_16x16x32_bf16 v[4:7], a[164:167], a[52:55], v[4:7]
  ds_read_b64_tr_b16 a[178:179], v146 offset:1024
  v_sub_u32 v137, s51, v128
  v_mfma_f32_16x16x32_bf16 v[4:7], a[160:163], a[36:39], v[4:7]
  v_sub_u32 v138, s51, v129
  v_min_u32 v136, v137, v138
  v_mfma_f32_16x16x32_bf16 v[8:11], a[160:163], a[40:43], v[8:11]
  ds_read_b64_tr_b16 a[180:181], v146 offset:8192
  s_add_u32 m0, s28, 98304
  v_sub_u32 v139, s51, v130
  v_mfma_f32_16x16x32_bf16 v[8:11], a[164:167], a[56:59], v[8:11]
  buffer_load_dwordx4 v238, s[20:23], s31 offen offset:0 lds
  v_mfma_f32_16x16x32_bf16 v[12:15], a[164:167], a[60:63], v[12:15]
  ds_read_b64_tr_b16 a[182:183], v146 offset:9216
  v_sub_u32 v140, s51, v131
  v_mfma_f32_16x16x32_bf16 v[12:15], a[160:163], a[44:47], v[12:15]
  s_waitcnt lgkmcnt(4)
  v_min3_u32 v136, v136, v139, v140
  v_sub_u32 v137, s51, v132
  v_mfma_f32_16x16x32_bf16 v[16:19], a[168:171], a[32:35], v[16:19]
  ds_read_b64_tr_b16 a[184:185], v147 offset:0
  v_sub_u32 v138, s51, v133
  v_mfma_f32_16x16x32_bf16 v[16:19], a[172:175], a[48:51], v[16:19]
  buffer_load_dwordx4 a[4:7], v242, s[24:27], s30 offen offset:1024 sc1
  v_mfma_f32_16x16x32_bf16 v[20:23], a[172:175], a[52:55], v[20:23]
  ds_read_b64_tr_b16 a[186:187], v147 offset:1024
  v_min3_u32 v136, v136, v137, v138
  v_mfma_f32_16x16x32_bf16 v[20:23], a[168:171], a[36:39], v[20:23]
  v_sub_u32 v139, s51, v134
  v_sub_u32 v140, s51, v135
  v_mfma_f32_16x16x32_bf16 v[24:27], a[168:171], a[40:43], v[24:27]
  ds_read_b64_tr_b16 a[188:189], v147 offset:8192
  v_min3_u32 v136, v136, v139, v140
  v_mfma_f32_16x16x32_bf16 v[24:27], a[172:175], a[56:59], v[24:27]
  v_mfma_f32_16x16x32_bf16 v[28:31], a[172:175], a[60:63], v[28:31]
  ds_read_b64_tr_b16 a[190:191], v147 offset:9216
  v_min_u32_dpp v136, v136, v136 row_ror:8 row_mask:0xf bank_mask:0xf
  v_mfma_f32_16x16x32_bf16 v[28:31], a[168:171], a[44:47], v[28:31]
  s_waitcnt lgkmcnt(4)
  v_min_u32_dpp v136, v136, v136 row_ror:4 row_mask:0xf bank_mask:0xf
  v_mfma_f32_16x16x32_bf16 v[32:35], a[176:179], a[32:35], v[32:35]
  ds_read_b64_tr_b16 a[160:161], v148 offset:0
  v_min_u32_dpp v136, v136, v136 row_ror:2 row_mask:0xf bank_mask:0xf
  v_mfma_f32_16x16x32_bf16 v[32:35], a[180:183], a[48:51], v[32:35]
  buffer_load_dwordx4 a[8:11], v242, s[24:27], s30 offen offset:2048 sc1
  v_mfma_f32_16x16x32_bf16 v[36:39], a[180:183], a[52:55], v[36:39]
  ds_read_b64_tr_b16 a[162:163], v148 offset:1024
  v_min_u32_dpp v136, v136, v136 row_ror:1 row_mask:0xf bank_mask:0xf
  v_mfma_f32_16x16x32_bf16 v[36:39], a[176:179], a[36:39], v[36:39]
  v_readlane_b32 s98, v136, 0
  v_readlane_b32 s99, v136, 16
  v_mfma_f32_16x16x32_bf16 v[40:43], a[176:179], a[40:43], v[40:43]
  ds_read_b64_tr_b16 a[164:165], v148 offset:8192
  v_readlane_b32 s100, v136, 32
  v_mfma_f32_16x16x32_bf16 v[40:43], a[180:183], a[56:59], v[40:43]
  buffer_load_dwordx4 v239, s[20:23], s31 offen offset:1024 lds
  v_mfma_f32_16x16x32_bf16 v[44:47], a[180:183], a[60:63], v[44:47]
  ds_read_b64_tr_b16 a[166:167], v148 offset:9216
  v_readlane_b32 s101, v136, 48
  v_mfma_f32_16x16x32_bf16 v[44:47], a[176:179], a[44:47], v[44:47]
  s_waitcnt lgkmcnt(4)
  s_min_u32 s98, s98, s99
  s_min_u32 s100, s100, s101
  v_mfma_f32_16x16x32_bf16 v[48:51], a[184:187], a[32:35], v[48:51]
  ds_read_b64_tr_b16 a[168:169], v149 offset:0
  s_min_u32 s98, s98, s100
  s_sub_u32 s55, s51, s98
  s_sub_u32 s51, s55, 1
  v_sub_u32 v137, s51, v128
  v_mfma_f32_16x16x32_bf16 v[48:51], a[188:191], a[48:51], v[48:51]
  buffer_load_dwordx4 a[12:15], v242, s[24:27], s30 offen offset:3072 sc1
  v_mfma_f32_16x16x32_bf16 v[52:55], a[188:191], a[52:55], v[52:55]
  ds_read_b64_tr_b16 a[170:171], v149 offset:1024
  v_sub_u32 v138, s51, v129
  v_mfma_f32_16x16x32_bf16 v[52:55], a[184:187], a[36:39], v[52:55]
  v_min_u32 v136, v137, v138
  v_sub_u32 v139, s51, v130
  v_mfma_f32_16x16x32_bf16 v[56:59], a[184:187], a[40:43], v[56:59]
  ds_read_b64_tr_b16 a[172:173], v149 offset:8192
  v_sub_u32 v140, s51, v131
  v_mfma_f32_16x16x32_bf16 v[56:59], a[188:191], a[56:59], v[56:59]
  v_min3_u32 v136, v136, v139, v140
  v_sub_u32 v137, s51, v132
  v_mfma_f32_16x16x32_bf16 v[60:63], a[188:191], a[60:63], v[60:63]
  ds_read_b64_tr_b16 a[174:175], v149 offset:9216
  v_sub_u32 v138, s51, v133
  v_mfma_f32_16x16x32_bf16 v[60:63], a[184:187], a[44:47], v[60:63]
  s_waitcnt lgkmcnt(4)
  v_min3_u32 v136, v136, v137, v138
  v_sub_u32 v139, s51, v134
  v_mfma_f32_16x16x32_bf16 v[64:67], a[160:163], a[32:35], v[64:67]
  ds_read_b64_tr_b16 a[176:177], v150 offset:0
  v_sub_u32 v140, s51, v135
  v_mfma_f32_16x16x32_bf16 v[64:67], a[164:167], a[48:51], v[64:67]
  buffer_load_dwordx4 a[16:19], v243, s[24:27], s30 offen offset:0 sc1
  v_mfma_f32_16x16x32_bf16 v[68:71], a[164:167], a[52:55], v[68:71]
  ds_read_b64_tr_b16 a[178:179], v150 offset:1024
  v_min3_u32 v136, v136, v139, v140
  v_mfma_f32_16x16x32_bf16 v[68:71], a[160:163], a[36:39], v[68:71]
  v_mfma_f32_16x16x32_bf16 v[72:75], a[160:163], a[40:43], v[72:75]
  ds_read_b64_tr_b16 a[180:181], v150 offset:8192
  v_min_u32_dpp v136, v136, v136 row_ror:8 row_mask:0xf bank_mask:0xf
  v_mfma_f32_16x16x32_bf16 v[72:75], a[164:167], a[56:59], v[72:75]
  buffer_load_dwordx4 v240, s[20:23], s31 offen offset:2048 lds
  v_mfma_f32_16x16x32_bf16 v[76:79], a[164:167], a[60:63], v[76:79]
  ds_read_b64_tr_b16 a[182:183], v150 offset:9216
  v_min_u32_dpp v136, v136, v136 row_ror:4 row_mask:0xf bank_mask:0xf
  v_mfma_f32_16x16x32_bf16 v[76:79], a[160:163], a[44:47], v[76:79]
  s_waitcnt lgkmcnt(4)
  v_min_u32_dpp v136, v136, v136 row_ror:2 row_mask:0xf bank_mask:0xf
  v_mfma_f32_16x16x32_bf16 v[80:83], a[168:171], a[32:35], v[80:83]
  ds_read_b64_tr_b16 a[184:185], v151 offset:0
  v_min_u32_dpp v136, v136, v136 row_ror:1 row_mask:0xf bank_mask:0xf
  v_mfma_f32_16x16x32_bf16 v[80:83], a[172:175], a[48:51], v[80:83]
  buffer_load_dwordx4 a[20:23], v243, s[24:27], s30 offen offset:1024 sc1
  v_mfma_f32_16x16x32_bf16 v[84:87], a[172:175], a[52:55], v[84:87]
  ds_read_b64_tr_b16 a[186:187], v151 offset:1024
  v_readlane_b32 s98, v136, 0
  v_mfma_f32_16x16x32_bf16 v[84:87], a[168:171], a[36:39], v[84:87]
  s_waitcnt vmcnt(22)
  v_readlane_b32 s99, v136, 16
  v_readlane_b32 s100, v136, 32
  v_mfma_f32_16x16x32_bf16 v[88:91], a[168:171], a[40:43], v[88:91]
  ds_read_b64_tr_b16 a[188:189], v151 offset:8192
  v_readlane_b32 s101, v136, 48
  v_mfma_f32_16x16x32_bf16 v[88:91], a[172:175], a[56:59], v[88:91]
  s_barrier
  s_min_u32 s98, s98, s99
  s_min_u32 s100, s100, s101
  v_mfma_f32_16x16x32_bf16 v[92:95], a[172:175], a[60:63], v[92:95]
  ds_read_b64_tr_b16 a[190:191], v151 offset:9216
  s_min_u32 s98, s98, s100
  s_sub_u32 s56, s51, s98
  s_sub_u32 s51, s56, 1
  v_sub_u32 v137, s51, v128
  v_mfma_f32_16x16x32_bf16 v[92:95], a[168:171], a[44:47], v[92:95]
  s_waitcnt lgkmcnt(4)
  v_sub_u32 v138, s51, v129
  v_min_u32 v136, v137, v138
  v_mfma_f32_16x16x32_bf16 v[96:99], a[176:179], a[32:35], v[96:99]
  ds_read_b64_tr_b16 a[160:161], v224 offset:0
  v_sub_u32 v139, s51, v130
  v_mfma_f32_16x16x32_bf16 v[96:99], a[180:183], a[48:51], v[96:99]
  buffer_load_dwordx4 a[24:27], v243, s[24:27], s30 offen offset:2048 sc1
  v_mfma_f32_16x16x32_bf16 v[100:103], a[180:183], a[52:55], v[100:103]
  ds_read_b64_tr_b16 a[162:163], v224 offset:1024
  v_sub_u32 v140, s51, v131
  v_mfma_f32_16x16x32_bf16 v[100:103], a[176:179], a[36:39], v[100:103]
  v_min3_u32 v136, v136, v139, v140
  v_sub_u32 v137, s51, v132
  v_mfma_f32_16x16x32_bf16 v[104:107], a[176:179], a[40:43], v[104:107]
  ds_read_b64_tr_b16 a[164:165], v224 offset:8192
  v_sub_u32 v138, s51, v133
  v_mfma_f32_16x16x32_bf16 v[104:107], a[180:183], a[56:59], v[104:107]
  buffer_load_dwordx4 v241, s[20:23], s31 offen offset:3072 lds
  s_add_u32 s31, s31, 0x80000
  v_mfma_f32_16x16x32_bf16 v[108:111], a[180:183], a[60:63], v[108:111]
  ds_read_b64_tr_b16 a[166:167], v224 offset:9216
  v_min3_u32 v136, v136, v137, v138
  v_mfma_f32_16x16x32_bf16 v[108:111], a[176:179], a[44:47], v[108:111]
  s_waitcnt lgkmcnt(4)
  v_sub_u32 v139, s51, v134
  v_sub_u32 v140, s51, v135
  v_mfma_f32_16x16x32_bf16 v[112:115], a[184:187], a[32:35], v[112:115]
  ds_read_b64_tr_b16 a[168:169], v225 offset:0
  v_min3_u32 v136, v136, v139, v140
  v_mfma_f32_16x16x32_bf16 v[112:115], a[188:191], a[48:51], v[112:115]
  buffer_load_dwordx4 a[28:31], v243, s[24:27], s30 offen offset:3072 sc1
  s_add_u32 s30, s30, 8192
  v_mfma_f32_16x16x32_bf16 v[116:119], a[188:191], a[52:55], v[116:119]
  ds_read_b64_tr_b16 a[170:171], v225 offset:1024
  v_min_u32_dpp v136, v136, v136 row_ror:8 row_mask:0xf bank_mask:0xf
  v_mfma_f32_16x16x32_bf16 v[116:119], a[184:187], a[36:39], v[116:119]
  v_mfma_f32_16x16x32_bf16 v[120:123], a[184:187], a[40:43], v[120:123]
  ds_read_b64_tr_b16 a[172:173], v225 offset:8192
  v_min_u32_dpp v136, v136, v136 row_ror:4 row_mask:0xf bank_mask:0xf
  v_mfma_f32_16x16x32_bf16 v[120:123], a[188:191], a[56:59], v[120:123]
  v_mfma_f32_16x16x32_bf16 v[124:127], a[188:191], a[60:63], v[124:127]
  ds_read_b64_tr_b16 a[174:175], v225 offset:9216
  v_min_u32_dpp v136, v136, v136 row_ror:2 row_mask:0xf bank_mask:0xf
  v_mfma_f32_16x16x32_bf16 v[124:127], a[184:187], a[44:47], v[124:127]
  s_waitcnt vmcnt(24) lgkmcnt(4)
  v_min_u32_dpp v136, v136, v136 row_ror:1 row_mask:0xf bank_mask:0xf
  v_mfma_f32_16x16x32_bf16 v[0:3], a[160:163], a[64:67], v[0:3]
  ds_read_b64_tr_b16 a[176:177], v226 offset:0
  v_readlane_b32 s98, v136, 0
  v_mfma_f32_16x16x32_bf16 v[0:3], a[164:167], a[80:83], v[0:3]
  buffer_load_dwordx4 a[32:35], v242, s[24:27], s30 offen offset:0 sc1
  v_mfma_f32_16x16x32_bf16 v[4:7], a[164:167], a[84:87], v[4:7]
  ds_read_b64_tr_b16 a[178:179], v226 offset:1024
  v_readlane_b32 s99, v136, 16
  v_mfma_f32_16x16x32_bf16 v[4:7], a[160:163], a[68:71], v[4:7]
  v_readlane_b32 s100, v136, 32
  v_readlane_b32 s101, v136, 48
  v_mfma_f32_16x16x32_bf16 v[8:11], a[160:163], a[72:75], v[8:11]
  ds_read_b64_tr_b16 a[180:181], v226 offset:8192
  s_add_u32 m0, s28, 114688
  s_min_u32 s98, s98, s99
  s_min_u32 s100, s100, s101
  v_mfma_f32_16x16x32_bf16 v[8:11], a[164:167], a[88:91], v[8:11]
  buffer_load_dwordx4 v238, s[20:23], s31 offen offset:0 lds
  s_min_u32 s98, s98, s100
  s_sub_u32 s57, s51, s98
  s_sub_u32 s51, s57, 1
  v_mfma_f32_16x16x32_bf16 v[12:15], a[164:167], a[92:95], v[12:15]
  ds_read_b64_tr_b16 a[182:183], v226 offset:9216
  v_sub_u32 v137, s51, v128
  v_mfma_f32_16x16x32_bf16 v[12:15], a[160:163], a[76:79], v[12:15]
  s_waitcnt lgkmcnt(4)
  v_sub_u32 v138, s51, v129
  v_min_u32 v136, v137, v138
  v_mfma_f32_16x16x32_bf16 v[16:19], a[168:171], a[64:67], v[16:19]
  ds_read_b64_tr_b16 a[184:185], v227 offset:0
  v_sub_u32 v139, s51, v130
  v_mfma_f32_16x16x32_bf16 v[16:19], a[172:175], a[80:83], v[16:19]
  buffer_load_dwordx4 a[36:39], v242, s[24:27], s30 offen offset:1024 sc1
  v_mfma_f32_16x16x32_bf16 v[20:23], a[172:175], a[84:87], v[20:23]
  ds_read_b64_tr_b16 a[186:187], v227 offset:1024
  v_sub_u32 v140, s51, v131
  v_mfma_f32_16x16x32_bf16 v[20:23], a[168:171], a[68:71], v[20:23]
  v_min3_u32 v136, v136, v139, v140
  v_sub_u32 v137, s51, v132
  v_mfma_f32_16x16x32_bf16 v[24:27], a[168:171], a[72:75], v[24:27]
  ds_read_b64_tr_b16 a[188:189], v227 offset:8192
  v_sub_u32 v138, s51, v133
  v_mfma_f32_16x16x32_bf16 v[24:27], a[172:175], a[88:91], v[24:27]
  v_min3_u32 v136, v136, v137, v138
  v_sub_u32 v139, s51, v134
  v_mfma_f32_16x16x32_bf16 v[28:31], a[172:175], a[92:95], v[28:31]
  ds_read_b64_tr_b16 a[190:191], v227 offset:9216
  v_sub_u32 v140, s51, v135
  v_mfma_f32_16x16x32_bf16 v[28:31], a[168:171], a[76:79], v[28:31]
  s_waitcnt lgkmcnt(4)
  v_min3_u32 v136, v136, v139, v140
  v_mfma_f32_16x16x32_bf16 v[32:35], a[176:179], a[64:67], v[32:35]
  ds_read_b64_tr_b16 a[160:161], v228 offset:0
  v_min_u32_dpp v136, v136, v136 row_ror:8 row_mask:0xf bank_mask:0xf
  v_mfma_f32_16x16x32_bf16 v[32:35], a[180:183], a[80:83], v[32:35]
  buffer_load_dwordx4 a[40:43], v242, s[24:27], s30 offen offset:2048 sc1
  v_mfma_f32_16x16x32_bf16 v[36:39], a[180:183], a[84:87], v[36:39]
  ds_read_b64_tr_b16 a[162:163], v228 offset:1024
  v_min_u32_dpp v136, v136, v136 row_ror:4 row_mask:0xf bank_mask:0xf
  v_mfma_f32_16x16x32_bf16 v[36:39], a[176:179], a[68:71], v[36:39]
  v_mfma_f32_16x16x32_bf16 v[40:43], a[176:179], a[72:75], v[40:43]
  ds_read_b64_tr_b16 a[164:165], v228 offset:8192
  v_min_u32_dpp v136, v136, v136 row_ror:2 row_mask:0xf bank_mask:0xf
  v_mfma_f32_16x16x32_bf16 v[40:43], a[180:183], a[88:91], v[40:43]
  buffer_load_dwordx4 v239, s[20:23], s31 offen offset:1024 lds
  v_mfma_f32_16x16x32_bf16 v[44:47], a[180:183], a[92:95], v[44:47]
  ds_read_b64_tr_b16 a[166:167], v228 offset:9216
  v_min_u32_dpp v136, v136, v136 row_ror:1 row_mask:0xf bank_mask:0xf
  v_mfma_f32_16x16x32_bf16 v[44:47], a[176:179], a[76:79], v[44:47]
  s_waitcnt lgkmcnt(4)
  v_readlane_b32 s98, v136, 0
  v_readlane_b32 s99, v136, 16
  v_mfma_f32_16x16x32_bf16 v[48:51], a[184:187], a[64:67], v[48:51]
  ds_read_b64_tr_b16 a[168:169], v229 offset:0
  v_readlane_b32 s100, v136, 32
  v_mfma_f32_16x16x32_bf16 v[48:51], a[188:191], a[80:83], v[48:51]
  buffer_load_dwordx4 a[44:47], v242, s[24:27], s30 offen offset:3072 sc1
  v_mfma_f32_16x16x32_bf16 v[52:55], a[188:191], a[84:87], v[52:55]
  ds_read_b64_tr_b16 a[170:171], v229 offset:1024
  v_readlane_b32 s101, v136, 48
  v_mfma_f32_16x16x32_bf16 v[52:55], a[184:187], a[68:71], v[52:55]
  s_min_u32 s98, s98, s99
  s_min_u32 s100, s100, s101
  s_min_u32 s98, s98, s100
  v_mfma_f32_16x16x32_bf16 v[56:59], a[184:187], a[72:75], v[56:59]
  ds_read_b64_tr_b16 a[172:173], v229 offset:8192
  s_sub_u32 s58, s51, s98
  s_sub_u32 s51, s58, 1
  v_sub_u32 v137, s51, v128
  v_mfma_f32_16x16x32_bf16 v[56:59], a[188:191], a[88:91], v[56:59]
  v_sub_u32 v138, s51, v129
  v_min_u32 v136, v137, v138
  v_mfma_f32_16x16x32_bf16 v[60:63], a[188:191], a[92:95], v[60:63]
  ds_read_b64_tr_b16 a[174:175], v229 offset:9216
  v_sub_u32 v139, s51, v130
  v_mfma_f32_16x16x32_bf16 v[60:63], a[184:187], a[76:79], v[60:63]
  s_waitcnt lgkmcnt(4)
  v_sub_u32 v140, s51, v131
  v_min3_u32 v136, v136, v139, v140
  v_mfma_f32_16x16x32_bf16 v[64:67], a[160:163], a[64:67], v[64:67]
  ds_read_b64_tr_b16 a[176:177], v230 offset:0
  v_sub_u32 v137, s51, v132
  v_mfma_f32_16x16x32_bf16 v[64:67], a[164:167], a[80:83], v[64:67]
  buffer_load_dwordx4 a[48:51], v243, s[24:27], s30 offen offset:0 sc1
  v_mfma_f32_16x16x32_bf16 v[68:71], a[164:167], a[84:87], v[68:71]
  ds_read_b64_tr_b16 a[178:179], v230 offset:1024
  v_sub_u32 v138, s51, v133
  v_mfma_f32_16x16x32_bf16 v[68:71], a[160:163], a[68:71], v[68:71]
  v_min3_u32 v136, v136, v137, v138
  v_sub_u32 v139, s51, v134
  v_mfma_f32_16x16x32_bf16 v[72:75], a[160:163], a[72:75], v[72:75]
  ds_read_b64_tr_b16 a[180:181], v230 offset:8192
  v_sub_u32 v140, s51, v135
  v_mfma_f32_16x16x32_bf16 v[72:75], a[164:167], a[88:91], v[72:75]
  buffer_load_dwordx4 v240, s[20:23], s31 offen offset:2048 lds
  v_mfma_f32_16x16x32_bf16 v[76:79], a[164:167], a[92:95], v[76:79]
  ds_read_b64_tr_b16 a[182:183], v230 offset:9216
  v_min3_u32 v136, v136, v139, v140
  v_mfma_f32_16x16x32_bf16 v[76:79], a[160:163], a[76:79], v[76:79]
  s_waitcnt lgkmcnt(4)
  v_min_u32_dpp v136, v136, v136 row_ror:8 row_mask:0xf bank_mask:0xf
  v_mfma_f32_16x16x32_bf16 v[80:83], a[168:171], a[64:67], v[80:83]
  ds_read_b64_tr_b16 a[184:185], v231 offset:0
  v_min_u32_dpp v136, v136, v136 row_ror:4 row_mask:0xf bank_mask:0xf
  v_mfma_f32_16x16x32_bf16 v[80:83], a[172:175], a[80:83], v[80:83]
  buffer_load_dwordx4 a[52:55], v243, s[24:27], s30 offen offset:1024 sc1
  v_mfma_f32_16x16x32_bf16 v[84:87], a[172:175], a[84:87], v[84:87]
  ds_read_b64_tr_b16 a[186:187], v231 offset:1024
  v_min_u32_dpp v136, v136, v136 row_ror:2 row_mask:0xf bank_mask:0xf
  v_mfma_f32_16x16x32_bf16 v[84:87], a[168:171], a[68:71], v[84:87]
  s_waitcnt vmcnt(22)
  v_min_u32_dpp v136, v136, v136 row_ror:1 row_mask:0xf bank_mask:0xf
  v_mfma_f32_16x16x32_bf16 v[88:91], a[168:171], a[72:75], v[88:91]
  ds_read_b64_tr_b16 a[188:189], v231 offset:8192
  v_readlane_b32 s98, v136, 0
  v_readlane_b32 s99, v136, 16
  v_readlane_b32 s100, v136, 32
  v_readlane_b32 s101, v136, 48
  s_min_u32 s98, s98, s99
  s_min_u32 s100, s100, s101
  s_min_u32 s98, s98, s100
  s_sub_u32 s59, s51, s98
  s_sub_u32 s51, s59, 1
  v_writelane_b32 v136, s52, 0
  v_writelane_b32 v136, s53, 1
  v_writelane_b32 v136, s54, 2
  v_writelane_b32 v136, s55, 3
  v_writelane_b32 v136, s56, 4
  v_writelane_b32 v136, s57, 5
  v_writelane_b32 v136, s58, 6
  v_writelane_b32 v136, s59, 7
  s_lshl_b32 s35, s3, 8
  s_add_u32 s35, s35, 158720
  v_lshrrev_b32 v137, 2, v242
  v_add_u32 v137, s35, v137
  ds_write_b32 v137, v136
  s_waitcnt lgkmcnt(0)
  v_mfma_f32_16x16x32_bf16 v[88:91], a[172:175], a[88:91], v[88:91]
  s_barrier
  v_mfma_f32_16x16x32_bf16 v[92:95], a[172:175], a[92:95], v[92:95]
  ds_read_b64_tr_b16 a[190:191], v231 offset:9216
  v_mfma_f32_16x16x32_bf16 v[92:95], a[168:171], a[76:79], v[92:95]
  v_mfma_f32_16x16x32_bf16 v[96:99], a[176:179], a[64:67], v[96:99]
  ds_read_b64_tr_b16 a[160:161], v224 offset:16384
  v_mfma_f32_16x16x32_bf16 v[96:99], a[180:183], a[80:83], v[96:99]
  buffer_load_dwordx4 a[56:59], v243, s[24:27], s30 offen offset:2048 sc1
  v_mfma_f32_16x16x32_bf16 v[100:103], a[180:183], a[84:87], v[100:103]
  ds_read_b64_tr_b16 a[162:163], v224 offset:17408
  v_mfma_f32_16x16x32_bf16 v[100:103], a[176:179], a[68:71], v[100:103]
  v_mfma_f32_16x16x32_bf16 v[104:107], a[176:179], a[72:75], v[104:107]
  ds_read_b64_tr_b16 a[164:165], v224 offset:24576
  v_mfma_f32_16x16x32_bf16 v[104:107], a[180:183], a[88:91], v[104:107]
  buffer_load_dwordx4 v241, s[20:23], s31 offen offset:3072 lds
  s_add_u32 s31, s31, 0x80000
  v_mfma_f32_16x16x32_bf16 v[108:111], a[180:183], a[92:95], v[108:111]
  ds_read_b64_tr_b16 a[166:167], v224 offset:25600
  v_mfma_f32_16x16x32_bf16 v[108:111], a[176:179], a[76:79], v[108:111]
  s_waitcnt lgkmcnt(4)
  v_mfma_f32_16x16x32_bf16 v[112:115], a[184:187], a[64:67], v[112:115]
  ds_read_b64_tr_b16 a[168:169], v225 offset:16384
  v_mfma_f32_16x16x32_bf16 v[112:115], a[188:191], a[80:83], v[112:115]
  buffer_load_dwordx4 a[60:63], v243, s[24:27], s30 offen offset:3072 sc1
  s_add_u32 s30, s30, 8192
  v_mfma_f32_16x16x32_bf16 v[116:119], a[188:191], a[84:87], v[116:119]
  ds_read_b64_tr_b16 a[170:171], v225 offset:17408
  v_mfma_f32_16x16x32_bf16 v[116:119], a[184:187], a[68:71], v[116:119]
  v_mfma_f32_16x16x32_bf16 v[120:123], a[184:187], a[72:75], v[120:123]
  ds_read_b64_tr_b16 a[172:173], v225 offset:24576
  v_mfma_f32_16x16x32_bf16 v[120:123], a[188:191], a[88:91], v[120:123]
  v_mfma_f32_16x16x32_bf16 v[124:127], a[188:191], a[92:95], v[124:127]
  ds_read_b64_tr_b16 a[174:175], v225 offset:25600
  v_mfma_f32_16x16x32_bf16 v[124:127], a[184:187], a[76:79], v[124:127]
  s_waitcnt vmcnt(24) lgkmcnt(4)
  v_mfma_f32_16x16x32_bf16 v[0:3], a[160:163], a[96:99], v[0:3]
  ds_read_b64_tr_b16 a[176:177], v226 offset:16384
  v_lshrrev_b32 v136, 4, v242
  v_mfma_f32_16x16x32_bf16 v[0:3], a[164:167], a[112:115], v[0:3]
  v_bfe_u32 v137, v136, 3, 2
  v_and_b32 v138, 7, v136
  v_mfma_f32_16x16x32_bf16 v[4:7], a[164:167], a[116:119], v[4:7]
  ds_read_b64_tr_b16 a[178:179], v226 offset:17408
  v_lshlrev_b32 v137, 8, v137
  v_mfma_f32_16x16x32_bf16 v[4:7], a[160:163], a[100:103], v[4:7]
  v_lshl_add_u32 v137, v138, 2, v137
  v_add_u32 v137, 158720, v137
  v_mfma_f32_16x16x32_bf16 v[8:11], a[160:163], a[104:107], v[8:11]
  ds_read_b64_tr_b16 a[180:181], v226 offset:24576
  s_add_u32 m0, s28, 0
  ds_read_b32 v128, v137
  v_mfma_f32_16x16x32_bf16 v[8:11], a[164:167], a[120:123], v[8:11]
  buffer_load_dwordx4 v232, s[12:15], s29 offen offset:0 lds
  v_mfma_f32_16x16x32_bf16 v[12:15], a[164:167], a[124:127], v[12:15]
  ds_read_b64_tr_b16 a[182:183], v226 offset:25600
  v_mfma_f32_16x16x32_bf16 v[12:15], a[160:163], a[108:111], v[12:15]
  s_waitcnt lgkmcnt(5)
  v_mfma_f32_16x16x32_bf16 v[16:19], a[168:171], a[96:99], v[16:19]
  ds_read_b64_tr_b16 a[184:185], v227 offset:16384
  v_mfma_f32_16x16x32_bf16 v[16:19], a[172:175], a[112:115], v[16:19]
  v_mfma_f32_16x16x32_bf16 v[20:23], a[172:175], a[116:119], v[20:23]
  ds_read_b64_tr_b16 a[186:187], v227 offset:17408
  v_mfma_f32_16x16x32_bf16 v[20:23], a[168:171], a[100:103], v[20:23]
  v_mfma_f32_16x16x32_bf16 v[24:27], a[168:171], a[104:107], v[24:27]
  ds_read_b64_tr_b16 a[188:189], v227 offset:24576
  s_waitcnt lgkmcnt(4)
  s_mov_b32 s51, -1
  v_sub_u32 v137, s51, v128
  v_mfma_f32_16x16x32_bf16 v[24:27], a[172:175], a[120:123], v[24:27]
  v_mfma_f32_16x16x32_bf16 v[28:31], a[172:175], a[124:127], v[28:31]
  ds_read_b64_tr_b16 a[190:191], v227 offset:25600
  v_min_u32_dpp v137, v137, v137 row_ror:8 row_mask:0xf bank_mask:0xf
  v_mfma_f32_16x16x32_bf16 v[28:31], a[168:171], a[108:111], v[28:31]
  s_waitcnt lgkmcnt(4)
  v_min_u32_dpp v137, v137, v137 row_ror:4 row_mask:0xf bank_mask:0xf
  v_mfma_f32_16x16x32_bf16 v[32:35], a[176:179], a[96:99], v[32:35]
  ds_read_b64_tr_b16 a[160:161], v228 offset:16384
  v_min_u32_dpp v137, v137, v137 row_ror:2 row_mask:0xf bank_mask:0xf
  v_mfma_f32_16x16x32_bf16 v[32:35], a[180:183], a[112:115], v[32:35]
  v_mfma_f32_16x16x32_bf16 v[36:39], a[180:183], a[116:119], v[36:39]
  ds_read_b64_tr_b16 a[162:163], v228 offset:17408
  v_min_u32_dpp v137, v137, v137 row_ror:1 row_mask:0xf bank_mask:0xf
  v_mfma_f32_16x16x32_bf16 v[36:39], a[176:179], a[100:103], v[36:39]
  v_readlane_b32 s98, v137, 0
  v_readlane_b32 s99, v137, 16
  v_mfma_f32_16x16x32_bf16 v[40:43], a[176:179], a[104:107], v[40:43]
  ds_read_b64_tr_b16 a[164:165], v228 offset:24576
  s_min_u32 s98, s98, s99
  s_sub_u32 s52, s51, s98
  s_sub_u32 s51, s52, 1
  v_sub_u32 v137, s51, v128
  v_mfma_f32_16x16x32_bf16 v[40:43], a[180:183], a[120:123], v[40:43]
  buffer_load_dwordx4 v233, s[12:15], s29 offen offset:1024 lds
  v_mfma_f32_16x16x32_bf16 v[44:47], a[180:183], a[124:127], v[44:47]
  ds_read_b64_tr_b16 a[166:167], v228 offset:25600
  v_min_u32_dpp v137, v137, v137 row_ror:8 row_mask:0xf bank_mask:0xf
  v_mfma_f32_16x16x32_bf16 v[44:47], a[176:179], a[108:111], v[44:47]
  s_waitcnt lgkmcnt(4)
  v_min_u32_dpp v137, v137, v137 row_ror:4 row_mask:0xf bank_mask:0xf
  v_mfma_f32_16x16x32_bf16 v[48:51], a[184:187], a[96:99], v[48:51]
  ds_read_b64_tr_b16 a[168:169], v229 offset:16384
  v_min_u32_dpp v137, v137, v137 row_ror:2 row_mask:0xf bank_mask:0xf
  v_mfma_f32_16x16x32_bf16 v[48:51], a[188:191], a[112:115], v[48:51]
  v_mfma_f32_16x16x32_bf16 v[52:55], a[188:191], a[116:119], v[52:55]
  ds_read_b64_tr_b16 a[170:171], v229 offset:17408
  v_min_u32_dpp v137, v137, v137 row_ror:1 row_mask:0xf bank_mask:0xf
  v_mfma_f32_16x16x32_bf16 v[52:55], a[184:187], a[100:103], v[52:55]
  v_readlane_b32 s98, v137, 0
  v_readlane_b32 s99, v137, 16
  v_mfma_f32_16x16x32_bf16 v[56:59], a[184:187], a[104:107], v[56:59]
  ds_read_b64_tr_b16 a[172:173], v229 offset:24576
  s_min_u32 s98, s98, s99
  s_sub_u32 s53, s51, s98
  s_sub_u32 s51, s53, 1
  v_sub_u32 v137, s51, v128
  v_mfma_f32_16x16x32_bf16 v[56:59], a[188:191], a[120:123], v[56:59]
  v_mfma_f32_16x16x32_bf16 v[60:63], a[188:191], a[124:127], v[60:63]
  ds_read_b64_tr_b16 a[174:175], v229 offset:25600
  v_min_u32_dpp v137, v137, v137 row_ror:8 row_mask:0xf bank_mask:0xf
  v_mfma_f32_16x16x32_bf16 v[60:63], a[184:187], a[108:111], v[60:63]
  s_waitcnt lgkmcnt(4)
  v_min_u32_dpp v137, v137, v137 row_ror:4 row_mask:0xf bank_mask:0xf
  v_mfma_f32_16x16x32_bf16 v[64:67], a[160:163], a[96:99], v[64:67]
  ds_read_b64_tr_b16 a[176:177], v230 offset:16384
  v_min_u32_dpp v137, v137, v137 row_ror:2 row_mask:0xf bank_mask:0xf
  v_mfma_f32_16x16x32_bf16 v[64:67], a[164:167], a[112:115], v[64:67]
  v_mfma_f32_16x16x32_bf16 v[68:71], a[164:167], a[116:119], v[68:71]
  ds_read_b64_tr_b16 a[178:179], v230 offset:17408
  v_min_u32_dpp v137, v137, v137 row_ror:1 row_mask:0xf bank_mask:0xf
  v_mfma_f32_16x16x32_bf16 v[68:71], a[160:163], a[100:103], v[68:71]
  v_readlane_b32 s98, v137, 0
  v_readlane_b32 s99, v137, 16
  v_mfma_f32_16x16x32_bf16 v[72:75], a[160:163], a[104:107], v[72:75]
  ds_read_b64_tr_b16 a[180:181], v230 offset:24576
  s_min_u32 s98, s98, s99
  s_sub_u32 s54, s51, s98
  s_sub_u32 s51, s54, 1
  v_sub_u32 v137, s51, v128
  v_mfma_f32_16x16x32_bf16 v[72:75], a[164:167], a[120:123], v[72:75]
  buffer_load_dwordx4 v234, s[12:15], s29 offen offset:2048 lds
  v_mfma_f32_16x16x32_bf16 v[76:79], a[164:167], a[124:127], v[76:79]
  ds_read_b64_tr_b16 a[182:183], v230 offset:25600
  v_min_u32_dpp v137, v137, v137 row_ror:8 row_mask:0xf bank_mask:0xf
  v_mfma_f32_16x16x32_bf16 v[76:79], a[160:163], a[108:111], v[76:79]
  s_waitcnt lgkmcnt(4)
  v_min_u32_dpp v137, v137, v137 row_ror:4 row_mask:0xf bank_mask:0xf
  v_mfma_f32_16x16x32_bf16 v[80:83], a[168:171], a[96:99], v[80:83]
  ds_read_b64_tr_b16 a[184:185], v231 offset:16384
  v_min_u32_dpp v137, v137, v137 row_ror:2 row_mask:0xf bank_mask:0xf
  v_mfma_f32_16x16x32_bf16 v[80:83], a[172:175], a[112:115], v[80:83]
  v_mfma_f32_16x16x32_bf16 v[84:87], a[172:175], a[116:119], v[84:87]
  ds_read_b64_tr_b16 a[186:187], v231 offset:17408
  v_min_u32_dpp v137, v137, v137 row_ror:1 row_mask:0xf bank_mask:0xf
  v_mfma_f32_16x16x32_bf16 v[84:87], a[168:171], a[100:103], v[84:87]
  s_waitcnt vmcnt(16)
  v_readlane_b32 s98, v137, 0
  v_readlane_b32 s99, v137, 16
  v_mfma_f32_16x16x32_bf16 v[88:91], a[168:171], a[104:107], v[88:91]
  ds_read_b64_tr_b16 a[188:189], v231 offset:24576
  s_min_u32 s98, s98, s99
  s_sub_u32 s55, s51, s98
  s_sub_u32 s51, s55, 1
  v_sub_u32 v137, s51, v128
  v_mfma_f32_16x16x32_bf16 v[88:91], a[172:175], a[120:123], v[88:91]
  s_barrier
  v_min_u32_dpp v137, v137, v137 row_ror:8 row_mask:0xf bank_mask:0xf
  v_mfma_f32_16x16x32_bf16 v[92:95], a[172:175], a[124:127], v[92:95]
  ds_read_b64_tr_b16 a[190:191], v231 offset:25600
  v_min_u32_dpp v137, v137, v137 row_ror:4 row_mask:0xf bank_mask:0xf
  v_mfma_f32_16x16x32_bf16 v[92:95], a[168:171], a[108:111], v[92:95]
  s_waitcnt lgkmcnt(4)
  v_min_u32_dpp v137, v137, v137 row_ror:2 row_mask:0xf bank_mask:0xf
  v_mfma_f32_16x16x32_bf16 v[96:99], a[176:179], a[96:99], v[96:99]
  ds_read_b64_tr_b16 a[160:161], v224 offset:32768
  v_min_u32_dpp v137, v137, v137 row_ror:1 row_mask:0xf bank_mask:0xf
  v_mfma_f32_16x16x32_bf16 v[96:99], a[180:183], a[112:115], v[96:99]
  v_readlane_b32 s98, v137, 0
  v_readlane_b32 s99, v137, 16
  v_mfma_f32_16x16x32_bf16 v[100:103], a[180:183], a[116:119], v[100:103]
  ds_read_b64_tr_b16 a[162:163], v224 offset:33792
  s_min_u32 s98, s98, s99
  s_sub_u32 s56, s51, s98
  s_sub_u32 s51, s56, 1
  v_sub_u32 v137, s51, v128
  v_mfma_f32_16x16x32_bf16 v[100:103], a[176:179], a[100:103], v[100:103]
  v_mfma_f32_16x16x32_bf16 v[104:107], a[176:179], a[104:107], v[104:107]
  ds_read_b64_tr_b16 a[164:165], v224 offset:40960
  v_min_u32_dpp v137, v137, v137 row_ror:8 row_mask:0xf bank_mask:0xf
  v_mfma_f32_16x16x32_bf16 v[104:107], a[180:183], a[120:123], v[104:107]
  buffer_load_dwordx4 v235, s[12:15], s29 offen offset:3072 lds
  v_mfma_f32_16x16x32_bf16 v[108:111], a[180:183], a[124:127], v[108:111]
  ds_read_b64_tr_b16 a[166:167], v224 offset:41984
  v_min_u32_dpp v137, v137, v137 row_ror:4 row_mask:0xf bank_mask:0xf
  v_mfma_f32_16x16x32_bf16 v[108:111], a[176:179], a[108:111], v[108:111]
  s_waitcnt lgkmcnt(4)
  v_min_u32_dpp v137, v137, v137 row_ror:2 row_mask:0xf bank_mask:0xf
  v_mfma_f32_16x16x32_bf16 v[112:115], a[184:187], a[96:99], v[112:115]
  ds_read_b64_tr_b16 a[168:169], v225 offset:32768
  v_min_u32_dpp v137, v137, v137 row_ror:1 row_mask:0xf bank_mask:0xf
  v_mfma_f32_16x16x32_bf16 v[112:115], a[188:191], a[112:115], v[112:115]
  v_readlane_b32 s98, v137, 0
  v_readlane_b32 s99, v137, 16
  v_mfma_f32_16x16x32_bf16 v[116:119], a[188:191], a[116:119], v[116:119]
  ds_read_b64_tr_b16 a[170:171], v225 offset:33792
  s_min_u32 s98, s98, s99
  s_sub_u32 s57, s51, s98
  s_sub_u32 s51, s57, 1
  v_sub_u32 v137, s51, v128
  v_mfma_f32_16x16x32_bf16 v[116:119], a[184:187], a[100:103], v[116:119]
  v_mfma_f32_16x16x32_bf16 v[120:123], a[184:187], a[104:107], v[120:123]
  ds_read_b64_tr_b16 a[172:173], v225 offset:40960
  v_min_u32_dpp v137, v137, v137 row_ror:8 row_mask:0xf bank_mask:0xf
  v_mfma_f32_16x16x32_bf16 v[120:123], a[188:191], a[120:123], v[120:123]
  v_mfma_f32_16x16x32_bf16 v[124:127], a[188:191], a[124:127], v[124:127]
  ds_read_b64_tr_b16 a[174:175], v225 offset:41984
  v_min_u32_dpp v137, v137, v137 row_ror:4 row_mask:0xf bank_mask:0xf
  v_mfma_f32_16x16x32_bf16 v[124:127], a[184:187], a[108:111], v[124:127]
  s_waitcnt vmcnt(16) lgkmcnt(4)
  v_min_u32_dpp v137, v137, v137 row_ror:2 row_mask:0xf bank_mask:0xf
  v_mfma_f32_16x16x32_bf16 v[0:3], a[160:163], a[0:3], v[0:3]
  ds_read_b64_tr_b16 a[176:177], v226 offset:32768
  v_min_u32_dpp v137, v137, v137 row_ror:1 row_mask:0xf bank_mask:0xf
  v_mfma_f32_16x16x32_bf16 v[0:3], a[164:167], a[16:19], v[0:3]
  v_readlane_b32 s98, v137, 0
  v_readlane_b32 s99, v137, 16
  v_mfma_f32_16x16x32_bf16 v[4:7], a[164:167], a[20:23], v[4:7]
  ds_read_b64_tr_b16 a[178:179], v226 offset:33792
  s_min_u32 s98, s98, s99
  s_sub_u32 s58, s51, s98
  s_sub_u32 s51, s58, 1
  v_sub_u32 v137, s51, v128
  v_mfma_f32_16x16x32_bf16 v[4:7], a[160:163], a[4:7], v[4:7]
  v_mfma_f32_16x16x32_bf16 v[8:11], a[160:163], a[8:11], v[8:11]
  ds_read_b64_tr_b16 a[180:181], v226 offset:40960
  s_add_u32 m0, s28, 65536
  v_min_u32_dpp v137, v137, v137 row_ror:8 row_mask:0xf bank_mask:0xf
  v_mfma_f32_16x16x32_bf16 v[8:11], a[164:167], a[24:27], v[8:11]
  buffer_load_dwordx4 v236, s[16:19], s29 offen offset:0 lds
  v_mfma_f32_16x16x32_bf16 v[12:15], a[164:167], a[28:31], v[12:15]
  ds_read_b64_tr_b16 a[182:183], v226 offset:41984
  v_min_u32_dpp v137, v137, v137 row_ror:4 row_mask:0xf bank_mask:0xf
  v_mfma_f32_16x16x32_bf16 v[12:15], a[160:163], a[12:15], v[12:15]
  s_waitcnt lgkmcnt(4)
  v_min_u32_dpp v137, v137, v137 row_ror:2 row_mask:0xf bank_mask:0xf
  v_mfma_f32_16x16x32_bf16 v[16:19], a[168:171], a[0:3], v[16:19]
  ds_read_b64_tr_b16 a[184:185], v227 offset:32768
  v_min_u32_dpp v137, v137, v137 row_ror:1 row_mask:0xf bank_mask:0xf
  v_mfma_f32_16x16x32_bf16 v[16:19], a[172:175], a[16:19], v[16:19]
  v_readlane_b32 s98, v137, 0
  v_readlane_b32 s99, v137, 16
  v_mfma_f32_16x16x32_bf16 v[20:23], a[172:175], a[20:23], v[20:23]
  ds_read_b64_tr_b16 a[186:187], v227 offset:33792
  s_min_u32 s98, s98, s99
  s_sub_u32 s59, s51, s98
  s_sub_u32 s51, s59, 1
  v_mov_b32 v128, 0
  v_mfma_f32_16x16x32_bf16 v[20:23], a[168:171], a[4:7], v[20:23]
  v_writelane_b32 v128, s52, 0
  v_writelane_b32 v128, s53, 1
  v_mfma_f32_16x16x32_bf16 v[24:27], a[168:171], a[8:11], v[24:27]
  ds_read_b64_tr_b16 a[188:189], v227 offset:40960
  v_writelane_b32 v128, s54, 2
  v_mfma_f32_16x16x32_bf16 v[24:27], a[172:175], a[24:27], v[24:27]
  v_writelane_b32 v128, s55, 3
  v_writelane_b32 v128, s56, 4
  v_mfma_f32_16x16x32_bf16 v[28:31], a[172:175], a[28:31], v[28:31]
  ds_read_b64_tr_b16 a[190:191], v227 offset:41984
  v_writelane_b32 v128, s57, 5
  v_mfma_f32_16x16x32_bf16 v[28:31], a[168:171], a[12:15], v[28:31]
  s_waitcnt lgkmcnt(4)
  v_writelane_b32 v128, s58, 6
  v_writelane_b32 v128, s59, 7
  v_mfma_f32_16x16x32_bf16 v[32:35], a[176:179], a[0:3], v[32:35]
  ds_read_b64_tr_b16 a[160:161], v228 offset:32768
  v_and_b32 v129, 0xffff, v128
  v_mfma_f32_16x16x32_bf16 v[32:35], a[180:183], a[16:19], v[32:35]
  v_sub_u32 v129, 0xffff, v129
  v_and_b32 v129, 0x7ff, v129
  v_mfma_f32_16x16x32_bf16 v[36:39], a[180:183], a[20:23], v[36:39]
  ds_read_b64_tr_b16 a[162:163], v228 offset:33792
  v_mov_b32 v130, v129
  v_mfma_f32_16x16x32_bf16 v[36:39], a[176:179], a[4:7], v[36:39]
  v_mfma_f32_16x16x32_bf16 v[40:43], a[176:179], a[8:11], v[40:43]
  ds_read_b64_tr_b16 a[164:165], v228 offset:40960
  v_permlane16_swap_b32 v129, v130
  v_mfma_f32_16x16x32_bf16 v[40:43], a[180:183], a[24:27], v[40:43]
  buffer_load_dwordx4 v237, s[16:19], s29 offen offset:1024 lds
  v_mfma_f32_16x16x32_bf16 v[44:47], a[180:183], a[28:31], v[44:47]
  ds_read_b64_tr_b16 a[166:167], v228 offset:41984
  v_mov_b32 v130, v129
  v_mfma_f32_16x16x32_bf16 v[44:47], a[176:179], a[12:15], v[44:47]
  s_waitcnt lgkmcnt(4)
  v_permlane32_swap_b32 v129, v130
  v_lshrrev_b32 v130, 6, v129
  v_mfma_f32_16x16x32_bf16 v[48:51], a[184:187], a[0:3], v[48:51]
  ds_read_b64_tr_b16 a[168:169], v229 offset:32768
  v_mul_u32_u24 v130, 0x14000, v130
  v_mfma_f32_16x16x32_bf16 v[48:51], a[188:191], a[16:19], v[48:51]
  v_bfe_u32 v131, v129, 4, 2
  v_lshl_add_u32 v130, v131, 10, v130
  v_mfma_f32_16x16x32_bf16 v[52:55], a[188:191], a[20:23], v[52:55]
  ds_read_b64_tr_b16 a[170:171], v229 offset:33792
  v_and_b32 v131, 15, v129
  v_mfma_f32_16x16x32_bf16 v[52:55], a[184:187], a[4:7], v[52:55]
  v_lshl_add_u32 v130, v131, 4, v130
  v_lshrrev_b32 v131, 4, v136
  v_mfma_f32_16x16x32_bf16 v[56:59], a[184:187], a[8:11], v[56:59]
  ds_read_b64_tr_b16 a[172:173], v229 offset:40960
  v_lshl_add_u32 v243, v131, 8, v130
  v_mfma_f32_16x16x32_bf16 v[56:59], a[188:191], a[24:27], v[56:59]
  v_mfma_f32_16x16x32_bf16 v[60:63], a[188:191], a[28:31], v[60:63]
  ds_read_b64_tr_b16 a[174:175], v229 offset:41984
  v_mfma_f32_16x16x32_bf16 v[60:63], a[184:187], a[12:15], v[60:63]
  s_waitcnt lgkmcnt(4)
  v_mfma_f32_16x16x32_bf16 v[64:67], a[160:163], a[0:3], v[64:67]
  ds_read_b64_tr_b16 a[176:177], v230 offset:32768
  v_mfma_f32_16x16x32_bf16 v[64:67], a[164:167], a[16:19], v[64:67]
  v_mfma_f32_16x16x32_bf16 v[68:71], a[164:167], a[20:23], v[68:71]
  ds_read_b64_tr_b16 a[178:179], v230 offset:33792
  v_mfma_f32_16x16x32_bf16 v[68:71], a[160:163], a[4:7], v[68:71]
  v_mfma_f32_16x16x32_bf16 v[72:75], a[160:163], a[8:11], v[72:75]
  ds_read_b64_tr_b16 a[180:181], v230 offset:40960
  v_mfma_f32_16x16x32_bf16 v[72:75], a[164:167], a[24:27], v[72:75]
  buffer_load_dwordx4 v236, s[16:19], s29 offen offset:2048 lds
  v_mfma_f32_16x16x32_bf16 v[76:79], a[164:167], a[28:31], v[76:79]
  ds_read_b64_tr_b16 a[182:183], v230 offset:41984
  v_mfma_f32_16x16x32_bf16 v[76:79], a[160:163], a[12:15], v[76:79]
  s_waitcnt lgkmcnt(4)
  v_mfma_f32_16x16x32_bf16 v[80:83], a[168:171], a[0:3], v[80:83]
  ds_read_b64_tr_b16 a[184:185], v231 offset:32768
  v_mfma_f32_16x16x32_bf16 v[80:83], a[172:175], a[16:19], v[80:83]
  v_mfma_f32_16x16x32_bf16 v[84:87], a[172:175], a[20:23], v[84:87]
  ds_read_b64_tr_b16 a[186:187], v231 offset:33792
  v_mfma_f32_16x16x32_bf16 v[84:87], a[168:171], a[4:7], v[84:87]
  s_waitcnt vmcnt(8)
  v_mfma_f32_16x16x32_bf16 v[88:91], a[168:171], a[8:11], v[88:91]
  ds_read_b64_tr_b16 a[188:189], v231 offset:40960
  v_mfma_f32_16x16x32_bf16 v[88:91], a[172:175], a[24:27], v[88:91]
  s_barrier
  v_mfma_f32_16x16x32_bf16 v[92:95], a[172:175], a[28:31], v[92:95]
  ds_read_b64_tr_b16 a[190:191], v231 offset:41984
  v_mfma_f32_16x16x32_bf16 v[92:95], a[168:171], a[12:15], v[92:95]
  s_waitcnt lgkmcnt(4)
  v_mfma_f32_16x16x32_bf16 v[96:99], a[176:179], a[0:3], v[96:99]
  ds_read_b64_tr_b16 a[160:161], v224 offset:49152
  v_mfma_f32_16x16x32_bf16 v[96:99], a[180:183], a[16:19], v[96:99]
  v_mfma_f32_16x16x32_bf16 v[100:103], a[180:183], a[20:23], v[100:103]
  ds_read_b64_tr_b16 a[162:163], v224 offset:50176
  v_mfma_f32_16x16x32_bf16 v[100:103], a[176:179], a[4:7], v[100:103]
  v_mfma_f32_16x16x32_bf16 v[104:107], a[176:179], a[8:11], v[104:107]
  ds_read_b64_tr_b16 a[164:165], v224 offset:57344
  v_mfma_f32_16x16x32_bf16 v[104:107], a[180:183], a[24:27], v[104:107]
  buffer_load_dwordx4 v237, s[16:19], s29 offen offset:3072 lds
  s_add_u32 s29, s29, 16384
  v_mfma_f32_16x16x32_bf16 v[108:111], a[180:183], a[28:31], v[108:111]
  ds_read_b64_tr_b16 a[166:167], v224 offset:58368
  v_mfma_f32_16x16x32_bf16 v[108:111], a[176:179], a[12:15], v[108:111]
  s_waitcnt lgkmcnt(4)
  v_mfma_f32_16x16x32_bf16 v[112:115], a[184:187], a[0:3], v[112:115]
  ds_read_b64_tr_b16 a[168:169], v225 offset:49152
  v_mfma_f32_16x16x32_bf16 v[112:115], a[188:191], a[16:19], v[112:115]
  v_mfma_f32_16x16x32_bf16 v[116:119], a[188:191], a[20:23], v[116:119]
  ds_read_b64_tr_b16 a[170:171], v225 offset:50176
  v_mfma_f32_16x16x32_bf16 v[116:119], a[184:187], a[4:7], v[116:119]
  v_mfma_f32_16x16x32_bf16 v[120:123], a[184:187], a[8:11], v[120:123]
  ds_read_b64_tr_b16 a[172:173], v225 offset:57344
  v_mfma_f32_16x16x32_bf16 v[120:123], a[188:191], a[24:27], v[120:123]
  v_mfma_f32_16x16x32_bf16 v[124:127], a[188:191], a[28:31], v[124:127]
  ds_read_b64_tr_b16 a[174:175], v225 offset:58368
  v_mfma_f32_16x16x32_bf16 v[124:127], a[184:187], a[12:15], v[124:127]
  s_waitcnt vmcnt(8) lgkmcnt(4)
  v_mfma_f32_16x16x32_bf16 v[0:3], a[160:163], a[32:35], v[0:3]
  ds_read_b64_tr_b16 a[176:177], v226 offset:49152
  s_add_u32 m0, s28, 16384
  v_mfma_f32_16x16x32_bf16 v[0:3], a[164:167], a[48:51], v[0:3]
  buffer_load_dwordx4 v232, s[12:15], s29 offen offset:0 lds
  v_mfma_f32_16x16x32_bf16 v[4:7], a[164:167], a[52:55], v[4:7]
  ds_read_b64_tr_b16 a[178:179], v226 offset:50176
  v_mfma_f32_16x16x32_bf16 v[4:7], a[160:163], a[36:39], v[4:7]
  v_mfma_f32_16x16x32_bf16 v[8:11], a[160:163], a[40:43], v[8:11]
  ds_read_b64_tr_b16 a[180:181], v226 offset:57344
  v_mfma_f32_16x16x32_bf16 v[8:11], a[164:167], a[56:59], v[8:11]
  buffer_load_dwordx4 v233, s[12:15], s29 offen offset:1024 lds
  v_mfma_f32_16x16x32_bf16 v[12:15], a[164:167], a[60:63], v[12:15]
  ds_read_b64_tr_b16 a[182:183], v226 offset:58368
  v_mfma_f32_16x16x32_bf16 v[12:15], a[160:163], a[44:47], v[12:15]
  s_waitcnt lgkmcnt(4)
  v_mfma_f32_16x16x32_bf16 v[16:19], a[168:171], a[32:35], v[16:19]
  ds_read_b64_tr_b16 a[184:185], v227 offset:49152
  v_mfma_f32_16x16x32_bf16 v[16:19], a[172:175], a[48:51], v[16:19]
  buffer_load_dwordx4 v234, s[12:15], s29 offen offset:2048 lds
  v_mfma_f32_16x16x32_bf16 v[20:23], a[172:175], a[52:55], v[20:23]
  ds_read_b64_tr_b16 a[186:187], v227 offset:50176
  v_mfma_f32_16x16x32_bf16 v[20:23], a[168:171], a[36:39], v[20:23]
  buffer_load_dwordx4 v235, s[12:15], s29 offen offset:3072 lds
  v_mfma_f32_16x16x32_bf16 v[24:27], a[168:171], a[40:43], v[24:27]
  ds_read_b64_tr_b16 a[188:189], v227 offset:57344
  v_mfma_f32_16x16x32_bf16 v[24:27], a[172:175], a[56:59], v[24:27]
  v_mul_f32 v0, s34, v0
  v_mul_f32 v1, s34, v1
  v_mfma_f32_16x16x32_bf16 v[28:31], a[172:175], a[60:63], v[28:31]
  ds_read_b64_tr_b16 a[190:191], v227 offset:58368
  v_mul_f32 v2, s34, v2
  v_mfma_f32_16x16x32_bf16 v[28:31], a[168:171], a[44:47], v[28:31]
  s_waitcnt lgkmcnt(4)
  v_mul_f32 v3, s34, v3
  v_mul_f32 v16, s34, v16
  v_mfma_f32_16x16x32_bf16 v[32:35], a[176:179], a[32:35], v[32:35]
  ds_read_b64_tr_b16 a[160:161], v228 offset:49152
  v_mul_f32 v17, s34, v17
  v_mfma_f32_16x16x32_bf16 v[32:35], a[180:183], a[48:51], v[32:35]
  v_mul_f32 v18, s34, v18
  v_mul_f32 v19, s34, v19
  v_mfma_f32_16x16x32_bf16 v[36:39], a[180:183], a[52:55], v[36:39]
  ds_read_b64_tr_b16 a[162:163], v228 offset:50176
  v_cvt_pk_bf16_f32 v128, v0, v1
  v_mfma_f32_16x16x32_bf16 v[36:39], a[176:179], a[36:39], v[36:39]
  v_cvt_pk_bf16_f32 v129, v2, v3
  v_cvt_pk_bf16_f32 v130, v16, v17
  v_mfma_f32_16x16x32_bf16 v[40:43], a[176:179], a[40:43], v[40:43]
  ds_read_b64_tr_b16 a[164:165], v228 offset:57344
  v_cvt_pk_bf16_f32 v131, v18, v19
  v_mfma_f32_16x16x32_bf16 v[40:43], a[180:183], a[56:59], v[40:43]
  v_mul_f32 v4, s34, v4
  v_mul_f32 v5, s34, v5
  v_mfma_f32_16x16x32_bf16 v[44:47], a[180:183], a[60:63], v[44:47]
  ds_read_b64_tr_b16 a[166:167], v228 offset:58368
  v_mul_f32 v6, s34, v6
  v_mfma_f32_16x16x32_bf16 v[44:47], a[176:179], a[44:47], v[44:47]
  s_waitcnt lgkmcnt(4)
  v_mul_f32 v7, s34, v7
  v_mul_f32 v20, s34, v20
  v_mfma_f32_16x16x32_bf16 v[48:51], a[184:187], a[32:35], v[48:51]
  ds_read_b64_tr_b16 a[168:169], v229 offset:49152
  v_mul_f32 v21, s34, v21
  v_mfma_f32_16x16x32_bf16 v[48:51], a[188:191], a[48:51], v[48:51]
  v_mul_f32 v22, s34, v22
  v_mul_f32 v23, s34, v23
  v_mfma_f32_16x16x32_bf16 v[52:55], a[188:191], a[52:55], v[52:55]
  ds_read_b64_tr_b16 a[170:171], v229 offset:50176
  v_cvt_pk_bf16_f32 v144, v4, v5
  v_mfma_f32_16x16x32_bf16 v[52:55], a[184:187], a[36:39], v[52:55]
  v_cvt_pk_bf16_f32 v145, v6, v7
  v_cvt_pk_bf16_f32 v146, v20, v21
  v_mfma_f32_16x16x32_bf16 v[56:59], a[184:187], a[40:43], v[56:59]
  ds_read_b64_tr_b16 a[172:173], v229 offset:57344
  v_cvt_pk_bf16_f32 v147, v22, v23
  v_mfma_f32_16x16x32_bf16 v[56:59], a[188:191], a[56:59], v[56:59]
  v_permlane16_swap_b32 v128, v130
  v_permlane16_swap_b32 v129, v131
  v_mfma_f32_16x16x32_bf16 v[60:63], a[188:191], a[60:63], v[60:63]
  ds_read_b64_tr_b16 a[174:175], v229 offset:58368
  v_mul_f32 v8, s34, v8
  v_mfma_f32_16x16x32_bf16 v[60:63], a[184:187], a[44:47], v[60:63]
  s_waitcnt lgkmcnt(4)
  v_mul_f32 v9, s34, v9
  v_mul_f32 v10, s34, v10
  v_mfma_f32_16x16x32_bf16 v[64:67], a[160:163], a[32:35], v[64:67]
  ds_read_b64_tr_b16 a[176:177], v230 offset:49152
  v_mul_f32 v11, s34, v11
  v_mfma_f32_16x16x32_bf16 v[64:67], a[164:167], a[48:51], v[64:67]
  v_mul_f32 v24, s34, v24
  v_mul_f32 v25, s34, v25
  v_mfma_f32_16x16x32_bf16 v[68:71], a[164:167], a[52:55], v[68:71]
  ds_read_b64_tr_b16 a[178:179], v230 offset:50176
  v_mul_f32 v26, s34, v26
  v_mfma_f32_16x16x32_bf16 v[68:71], a[160:163], a[36:39], v[68:71]
  v_mul_f32 v27, s34, v27
  v_cvt_pk_bf16_f32 v160, v8, v9
  v_mfma_f32_16x16x32_bf16 v[72:75], a[160:163], a[40:43], v[72:75]
  ds_read_b64_tr_b16 a[180:181], v230 offset:57344
  v_cvt_pk_bf16_f32 v161, v10, v11
  v_mfma_f32_16x16x32_bf16 v[72:75], a[164:167], a[56:59], v[72:75]
  v_cvt_pk_bf16_f32 v162, v24, v25
  v_cvt_pk_bf16_f32 v163, v26, v27
  v_mfma_f32_16x16x32_bf16 v[76:79], a[164:167], a[60:63], v[76:79]
  ds_read_b64_tr_b16 a[182:183], v230 offset:58368
  v_permlane16_swap_b32 v144, v146
  v_mfma_f32_16x16x32_bf16 v[76:79], a[160:163], a[44:47], v[76:79]
  s_waitcnt lgkmcnt(4)
  v_permlane16_swap_b32 v145, v147
  v_mul_f32 v12, s34, v12
  v_mfma_f32_16x16x32_bf16 v[80:83], a[168:171], a[32:35], v[80:83]
  ds_read_b64_tr_b16 a[184:185], v231 offset:49152
  v_mul_f32 v13, s34, v13
  v_mfma_f32_16x16x32_bf16 v[80:83], a[172:175], a[48:51], v[80:83]
  v_mul_f32 v14, s34, v14
  v_mul_f32 v15, s34, v15
  v_mfma_f32_16x16x32_bf16 v[84:87], a[172:175], a[52:55], v[84:87]
  ds_read_b64_tr_b16 a[186:187], v231 offset:50176
  v_mul_f32 v28, s34, v28
  v_mfma_f32_16x16x32_bf16 v[84:87], a[168:171], a[36:39], v[84:87]
  s_waitcnt vmcnt(8)
  v_mul_f32 v29, s34, v29
  v_mul_f32 v30, s34, v30
  v_mfma_f32_16x16x32_bf16 v[88:91], a[168:171], a[40:43], v[88:91]
  ds_read_b64_tr_b16 a[188:189], v231 offset:57344
  v_mul_f32 v31, s34, v31
  v_mfma_f32_16x16x32_bf16 v[88:91], a[172:175], a[56:59], v[88:91]
  s_barrier
  v_cvt_pk_bf16_f32 v176, v12, v13
  v_cvt_pk_bf16_f32 v177, v14, v15
  v_mfma_f32_16x16x32_bf16 v[92:95], a[172:175], a[60:63], v[92:95]
  ds_read_b64_tr_b16 a[190:191], v231 offset:58368
  v_cvt_pk_bf16_f32 v178, v28, v29
  v_mfma_f32_16x16x32_bf16 v[92:95], a[168:171], a[44:47], v[92:95]
  s_waitcnt lgkmcnt(4)
  v_cvt_pk_bf16_f32 v179, v30, v31
  v_permlane16_swap_b32 v160, v162
  v_mfma_f32_16x16x32_bf16 v[96:99], a[176:179], a[32:35], v[96:99]
  ds_read_b128 a[128:131], v212 offset:0
  v_permlane16_swap_b32 v161, v163
  v_mfma_f32_16x16x32_bf16 v[96:99], a[180:183], a[48:51], v[96:99]
  v_mul_f32 v32, s34, v32
  v_mul_f32 v33, s34, v33
  v_mfma_f32_16x16x32_bf16 v[100:103], a[180:183], a[52:55], v[100:103]
  ds_read_b128 a[132:135], v213 offset:0
  v_mul_f32 v34, s34, v34
  v_mfma_f32_16x16x32_bf16 v[100:103], a[176:179], a[36:39], v[100:103]
  v_mul_f32 v35, s34, v35
  v_mul_f32 v48, s34, v48
  v_mfma_f32_16x16x32_bf16 v[104:107], a[176:179], a[40:43], v[104:107]
  ds_read_b128 a[136:139], v214 offset:0
  v_mul_f32 v49, s34, v49
  v_mfma_f32_16x16x32_bf16 v[104:107], a[180:183], a[56:59], v[104:107]
  v_mul_f32 v50, s34, v50
  v_mul_f32 v51, s34, v51
  v_mfma_f32_16x16x32_bf16 v[108:111], a[180:183], a[60:63], v[108:111]
  ds_read_b128 a[140:143], v215 offset:0
  v_cvt_pk_bf16_f32 v132, v32, v33
  v_mfma_f32_16x16x32_bf16 v[108:111], a[176:179], a[44:47], v[108:111]
  s_waitcnt lgkmcnt(4)
  v_cvt_pk_bf16_f32 v133, v34, v35
  v_cvt_pk_bf16_f32 v134, v48, v49
  v_mfma_f32_16x16x32_bf16 v[112:115], a[184:187], a[32:35], v[112:115]
  v_cvt_pk_bf16_f32 v135, v50, v51
  v_permlane16_swap_b32 v176, v178
  v_mfma_f32_16x16x32_bf16 v[112:115], a[188:191], a[48:51], v[112:115]
  v_permlane16_swap_b32 v177, v179
  v_mul_f32 v36, s34, v36
  v_mfma_f32_16x16x32_bf16 v[116:119], a[188:191], a[52:55], v[116:119]
  v_mul_f32 v37, s34, v37
  v_mul_f32 v38, s34, v38
  v_mfma_f32_16x16x32_bf16 v[116:119], a[184:187], a[36:39], v[116:119]
  v_mul_f32 v39, s34, v39
  v_mul_f32 v52, s34, v52
  v_mfma_f32_16x16x32_bf16 v[120:123], a[184:187], a[40:43], v[120:123]
  v_mul_f32 v53, s34, v53
  v_mul_f32 v54, s34, v54
  v_mfma_f32_16x16x32_bf16 v[120:123], a[188:191], a[56:59], v[120:123]
  v_mul_f32 v55, s34, v55
  v_cvt_pk_bf16_f32 v148, v36, v37
  v_mfma_f32_16x16x32_bf16 v[124:127], a[188:191], a[60:63], v[124:127]
  v_cvt_pk_bf16_f32 v149, v38, v39
  v_cvt_pk_bf16_f32 v150, v52, v53
  v_mfma_f32_16x16x32_bf16 v[124:127], a[184:187], a[44:47], v[124:127]
  s_waitcnt lgkmcnt(0)
  v_cvt_pk_bf16_f32 v151, v54, v55
  v_permlane16_swap_b32 v132, v134
  v_permlane16_swap_b32 v133, v135
  v_pk_mul_f32 v[40:41], v[40:41], s[34:35] op_sel_hi:[1,0]
  v_pk_mul_f32 v[42:43], v[42:43], s[34:35] op_sel_hi:[1,0]
  v_pk_mul_f32 v[56:57], v[56:57], s[34:35] op_sel_hi:[1,0]
  v_pk_mul_f32 v[58:59], v[58:59], s[34:35] op_sel_hi:[1,0]
  v_cvt_pk_bf16_f32 v164, v40, v41
  v_cvt_pk_bf16_f32 v165, v42, v43
  v_cvt_pk_bf16_f32 v166, v56, v57
  v_cvt_pk_bf16_f32 v167, v58, v59
  v_permlane16_swap_b32 v148, v150
  v_permlane16_swap_b32 v149, v151
  v_pk_mul_f32 v[44:45], v[44:45], s[34:35] op_sel_hi:[1,0]
  v_pk_mul_f32 v[46:47], v[46:47], s[34:35] op_sel_hi:[1,0]
  v_pk_mul_f32 v[60:61], v[60:61], s[34:35] op_sel_hi:[1,0]
  v_pk_mul_f32 v[62:63], v[62:63], s[34:35] op_sel_hi:[1,0]
  v_cvt_pk_bf16_f32 v180, v44, v45
  v_cvt_pk_bf16_f32 v181, v46, v47
  v_cvt_pk_bf16_f32 v182, v60, v61
  v_cvt_pk_bf16_f32 v183, v62, v63
  v_permlane16_swap_b32 v164, v166
  v_permlane16_swap_b32 v165, v167
  v_pk_mul_f32 v[64:65], v[64:65], s[34:35] op_sel_hi:[1,0]
  v_pk_mul_f32 v[66:67], v[66:67], s[34:35] op_sel_hi:[1,0]
  v_pk_mul_f32 v[80:81], v[80:81], s[34:35] op_sel_hi:[1,0]
  v_pk_mul_f32 v[82:83], v[82:83], s[34:35] op_sel_hi:[1,0]
  v_cvt_pk_bf16_f32 v136, v64, v65
  v_cvt_pk_bf16_f32 v137, v66, v67
  v_cvt_pk_bf16_f32 v138, v80, v81
  v_cvt_pk_bf16_f32 v139, v82, v83
  v_permlane16_swap_b32 v180, v182
  v_permlane16_swap_b32 v181, v183
  v_pk_mul_f32 v[68:69], v[68:69], s[34:35] op_sel_hi:[1,0]
  v_pk_mul_f32 v[70:71], v[70:71], s[34:35] op_sel_hi:[1,0]
  v_pk_mul_f32 v[84:85], v[84:85], s[34:35] op_sel_hi:[1,0]
  v_pk_mul_f32 v[86:87], v[86:87], s[34:35] op_sel_hi:[1,0]
  v_cvt_pk_bf16_f32 v152, v68, v69
  v_cvt_pk_bf16_f32 v153, v70, v71
  v_cvt_pk_bf16_f32 v154, v84, v85
  v_cvt_pk_bf16_f32 v155, v86, v87
  v_permlane16_swap_b32 v136, v138
  v_permlane16_swap_b32 v137, v139
  v_pk_mul_f32 v[72:73], v[72:73], s[34:35] op_sel_hi:[1,0]
  v_pk_mul_f32 v[74:75], v[74:75], s[34:35] op_sel_hi:[1,0]
  v_pk_mul_f32 v[88:89], v[88:89], s[34:35] op_sel_hi:[1,0]
  v_pk_mul_f32 v[90:91], v[90:91], s[34:35] op_sel_hi:[1,0]
  v_cvt_pk_bf16_f32 v168, v72, v73
  v_cvt_pk_bf16_f32 v169, v74, v75
  v_cvt_pk_bf16_f32 v170, v88, v89
  v_cvt_pk_bf16_f32 v171, v90, v91
  v_permlane16_swap_b32 v152, v154
  v_permlane16_swap_b32 v153, v155
  v_pk_mul_f32 v[76:77], v[76:77], s[34:35] op_sel_hi:[1,0]
  v_pk_mul_f32 v[78:79], v[78:79], s[34:35] op_sel_hi:[1,0]
  v_pk_mul_f32 v[92:93], v[92:93], s[34:35] op_sel_hi:[1,0]
  v_pk_mul_f32 v[94:95], v[94:95], s[34:35] op_sel_hi:[1,0]
  v_cvt_pk_bf16_f32 v184, v76, v77
  v_cvt_pk_bf16_f32 v185, v78, v79
  v_cvt_pk_bf16_f32 v186, v92, v93
  v_cvt_pk_bf16_f32 v187, v94, v95
  v_permlane16_swap_b32 v168, v170
  v_permlane16_swap_b32 v169, v171
  v_pk_mul_f32 v[96:97], v[96:97], s[34:35] op_sel_hi:[1,0]
  v_pk_mul_f32 v[98:99], v[98:99], s[34:35] op_sel_hi:[1,0]
  v_pk_mul_f32 v[112:113], v[112:113], s[34:35] op_sel_hi:[1,0]
  v_pk_mul_f32 v[114:115], v[114:115], s[34:35] op_sel_hi:[1,0]
  v_cvt_pk_bf16_f32 v140, v96, v97
  v_cvt_pk_bf16_f32 v141, v98, v99
  v_cvt_pk_bf16_f32 v142, v112, v113
  v_cvt_pk_bf16_f32 v143, v114, v115
  v_permlane16_swap_b32 v184, v186
  v_permlane16_swap_b32 v185, v187
  v_pk_mul_f32 v[100:101], v[100:101], s[34:35] op_sel_hi:[1,0]
  v_pk_mul_f32 v[102:103], v[102:103], s[34:35] op_sel_hi:[1,0]
  v_pk_mul_f32 v[116:117], v[116:117], s[34:35] op_sel_hi:[1,0]
  v_pk_mul_f32 v[118:119], v[118:119], s[34:35] op_sel_hi:[1,0]
  v_cvt_pk_bf16_f32 v156, v100, v101
  v_cvt_pk_bf16_f32 v157, v102, v103
  v_cvt_pk_bf16_f32 v158, v116, v117
  v_cvt_pk_bf16_f32 v159, v118, v119
  v_permlane16_swap_b32 v140, v142
  v_permlane16_swap_b32 v141, v143
  v_pk_mul_f32 v[104:105], v[104:105], s[34:35] op_sel_hi:[1,0]
  v_pk_mul_f32 v[106:107], v[106:107], s[34:35] op_sel_hi:[1,0]
  v_pk_mul_f32 v[120:121], v[120:121], s[34:35] op_sel_hi:[1,0]
  v_pk_mul_f32 v[122:123], v[122:123], s[34:35] op_sel_hi:[1,0]
  v_cvt_pk_bf16_f32 v172, v104, v105
  v_cvt_pk_bf16_f32 v173, v106, v107
  v_cvt_pk_bf16_f32 v174, v120, v121
  v_cvt_pk_bf16_f32 v175, v122, v123
  v_permlane16_swap_b32 v156, v158
  v_permlane16_swap_b32 v157, v159
  v_pk_mul_f32 v[108:109], v[108:109], s[34:35] op_sel_hi:[1,0]
  v_pk_mul_f32 v[110:111], v[110:111], s[34:35] op_sel_hi:[1,0]
  v_pk_mul_f32 v[124:125], v[124:125], s[34:35] op_sel_hi:[1,0]
  v_pk_mul_f32 v[126:127], v[126:127], s[34:35] op_sel_hi:[1,0]
  v_cvt_pk_bf16_f32 v188, v108, v109
  v_cvt_pk_bf16_f32 v189, v110, v111
  v_cvt_pk_bf16_f32 v190, v124, v125
  v_cvt_pk_bf16_f32 v191, v126, v127
  v_permlane16_swap_b32 v172, v174
  v_permlane16_swap_b32 v173, v175
  v_permlane16_swap_b32 v188, v190
  v_permlane16_swap_b32 v189, v191
  v_mfma_f32_16x16x32_bf16 v[0:3], a[128:131], v[128:131], 0
  s_add_u32 m0, s28, 81920
  ds_read_b128 a[144:147], v212 offset:4096
  s_mov_b32 s20, s90
  s_mov_b32 s21, s91
  v_mfma_f32_16x16x32_bf16 v[0:3], a[132:135], v[132:135], v[0:3]
  buffer_load_dwordx4 v236, s[16:19], s29 offen offset:0 lds
  s_mov_b32 s22, 2211840
  s_mov_b32 s23, 0x20000
  s_mov_b32 s44, s92
  v_mfma_f32_16x16x32_bf16 v[0:3], a[136:139], v[136:139], v[0:3]
  ds_read_b128 a[148:151], v213 offset:4096
  s_mov_b32 s45, s93
  s_mov_b32 s46, 2211840
  s_mov_b32 s47, 0x20000
  v_lshrrev_b32 v253, 4, v242
  v_mfma_f32_16x16x32_bf16 v[0:3], a[140:143], v[140:143], v[0:3]
  buffer_load_dwordx4 v237, s[16:19], s29 offen offset:1024 lds
  v_mfma_f32_16x16x32_bf16 v[8:11], a[140:143], v[156:159], 0
  ds_read_b128 a[152:155], v214 offset:4096
  v_mul_u32_u24 v253, 0xd80, v253
  v_mfma_f32_16x16x32_bf16 v[8:11], a[136:139], v[152:155], v[8:11]
  buffer_load_dwordx4 v236, s[16:19], s29 offen offset:2048 lds
  s_mul_i32 s35, s3, 552960
  s_lshl_b32 s38, s33, 4
  s_add_u32 s35, s35, s38
  v_mfma_f32_16x16x32_bf16 v[8:11], a[132:135], v[148:151], v[8:11]
  ds_read_b128 a[156:159], v215 offset:4096
  v_mfma_f32_16x16x32_bf16 v[8:11], a[128:131], v[144:147], v[8:11]
  buffer_load_dwordx4 v237, s[16:19], s29 offen offset:3072 lds
  v_mfma_f32_16x16x32_bf16 v[16:19], a[128:131], v[160:163], 0
  s_add_u32 s29, s29, 16384
  s_add_u32 m0, s28, 32768
  v_mfma_f32_16x16x32_bf16 v[16:19], a[132:135], v[164:167], v[16:19]
  buffer_load_dwordx4 v232, s[12:15], s29 offen offset:0 lds
  v_mfma_f32_16x16x32_bf16 v[16:19], a[136:139], v[168:171], v[16:19]
  buffer_load_dwordx4 v233, s[12:15], s29 offen offset:1024 lds
  v_mfma_f32_16x16x32_bf16 v[16:19], a[140:143], v[172:175], v[16:19]
  v_max3_f32 v192, v0, v1, v2
  v_max3_f32 v196, v8, v9, v10
  v_mfma_f32_16x16x32_bf16 v[24:27], a[140:143], v[188:191], 0
  v_max_f32 v192, v192, v3
  v_max_f32 v196, v196, v11
  v_mfma_f32_16x16x32_bf16 v[24:27], a[136:139], v[184:187], v[24:27]
  v_mov_b32 v245, v192
  v_mov_b32 v246, v196
  v_mfma_f32_16x16x32_bf16 v[24:27], a[132:135], v[180:183], v[24:27]
  v_permlane16_swap_b32 v192, v245
  v_permlane16_swap_b32 v196, v246
  v_mfma_f32_16x16x32_bf16 v[24:27], a[128:131], v[176:179], v[24:27]
  s_waitcnt lgkmcnt(0)
  v_max_f32 v192, v192, v245
  v_max_f32 v196, v196, v246
  v_mfma_f32_16x16x32_bf16 v[4:7], a[144:147], v[128:131], 0
  ds_read_b128 a[128:131], v212 offset:8192
  v_mov_b32 v245, v192
  v_mfma_f32_16x16x32_bf16 v[4:7], a[148:151], v[132:135], v[4:7]
  v_mov_b32 v246, v196
  v_permlane32_swap_b32 v192, v245
  v_mfma_f32_16x16x32_bf16 v[4:7], a[152:155], v[136:139], v[4:7]
  ds_read_b128 a[132:135], v213 offset:8192
  v_permlane32_swap_b32 v196, v246
  v_mfma_f32_16x16x32_bf16 v[4:7], a[156:159], v[140:143], v[4:7]
  v_max_f32 v192, v192, v245
  v_max_f32 v196, v196, v246
  v_mfma_f32_16x16x32_bf16 v[12:15], a[156:159], v[156:159], 0
  ds_read_b128 a[136:139], v214 offset:8192
  v_sub_f32 v193, 0, v192
  v_mfma_f32_16x16x32_bf16 v[12:15], a[152:155], v[152:155], v[12:15]
  v_sub_f32 v197, 0, v196
  v_sub_f32 v194, 0, v192
  v_mfma_f32_16x16x32_bf16 v[12:15], a[148:151], v[148:151], v[12:15]
  ds_read_b128 a[140:143], v215 offset:8192
  v_sub_f32 v198, 0, v196
  v_mfma_f32_16x16x32_bf16 v[12:15], a[144:147], v[144:147], v[12:15]
  v_sub_f32 v195, 0, v192
  v_sub_f32 v199, 0, v196
  v_mfma_f32_16x16x32_bf16 v[20:23], a[144:147], v[160:163], 0
  buffer_load_dwordx4 v234, s[12:15], s29 offen offset:2048 lds
  v_mfma_f32_16x16x32_bf16 v[20:23], a[148:151], v[164:167], v[20:23]
  v_sub_f32 v192, 0, v192
  v_sub_f32 v196, 0, v196
  v_mfma_f32_16x16x32_bf16 v[20:23], a[152:155], v[168:171], v[20:23]
  buffer_load_dwordx4 v235, s[12:15], s29 offen offset:3072 lds
  v_mfma_f32_16x16x32_bf16 v[20:23], a[156:159], v[172:175], v[20:23]
  v_max3_f32 v200, v16, v17, v18
  v_max3_f32 v204, v24, v25, v26
  v_mfma_f32_16x16x32_bf16 v[28:31], a[156:159], v[188:191], 0
  v_max_f32 v200, v200, v19
  v_max_f32 v204, v204, v27
  v_mfma_f32_16x16x32_bf16 v[28:31], a[152:155], v[184:187], v[28:31]
  v_mov_b32 v247, v200
  v_mov_b32 v248, v204
  v_mfma_f32_16x16x32_bf16 v[28:31], a[148:151], v[180:183], v[28:31]
  v_permlane16_swap_b32 v200, v247
  v_permlane16_swap_b32 v204, v248
  v_max_f32 v200, v200, v247
  v_max_f32 v204, v204, v248
  v_mov_b32 v247, v200
  v_mov_b32 v248, v204
  s_nop 0
  v_permlane32_swap_b32 v200, v247
  v_permlane32_swap_b32 v204, v248
  v_max_f32 v200, v200, v247
  v_max_f32 v204, v204, v248
  v_sub_f32 v201, 0, v200
  v_sub_f32 v205, 0, v204
  v_sub_f32 v202, 0, v200
  v_sub_f32 v206, 0, v204
  v_sub_f32 v203, 0, v200
  v_sub_f32 v207, 0, v204
  v_sub_f32 v200, 0, v200
  v_sub_f32 v204, 0, v204
  v_mfma_f32_16x16x32_bf16 v[28:31], a[144:147], v[176:179], v[28:31]
  s_waitcnt lgkmcnt(0)
  v_add_f32 v0, v192, v0
  v_add_f32 v1, v192, v1
  v_mfma_f32_16x16x32_bf16 v[32:35], a[128:131], v[128:131], v[192:195]
  ds_read_b128 a[144:147], v212 offset:12288
  v_add_f32 v2, v192, v2
  v_mfma_f32_16x16x32_bf16 v[32:35], a[132:135], v[132:135], v[32:35]
  v_add_f32 v3, v192, v3
  v_mfma_f32_16x16x32_bf16 v[32:35], a[136:139], v[136:139], v[32:35]
  ds_read_b128 a[148:151], v213 offset:12288
  v_mfma_f32_16x16x32_bf16 v[32:35], a[140:143], v[140:143], v[32:35]
  v_exp_f32 v0, v0
  v_mfma_f32_16x16x32_bf16 v[40:43], a[140:143], v[156:159], v[196:199]
  ds_read_b128 a[152:155], v214 offset:12288
  v_mfma_f32_16x16x32_bf16 v[40:43], a[136:139], v[152:155], v[40:43]
  v_exp_f32 v1, v1
  v_mfma_f32_16x16x32_bf16 v[40:43], a[132:135], v[148:151], v[40:43]
  ds_read_b128 a[156:159], v215 offset:12288
  v_mfma_f32_16x16x32_bf16 v[40:43], a[128:131], v[144:147], v[40:43]
  v_exp_f32 v2, v2
  v_mfma_f32_16x16x32_bf16 v[48:51], a[128:131], v[160:163], v[200:203]
  s_add_u32 m0, s50, 0
  v_cvt_pk_bf16_f32 v0, v0, v1
  v_mfma_f32_16x16x32_bf16 v[48:51], a[132:135], v[164:167], v[48:51]
  v_exp_f32 v3, v3
  v_mfma_f32_16x16x32_bf16 v[48:51], a[136:139], v[168:171], v[48:51]
  v_add_f32 v8, v196, v8
  v_add_f32 v9, v196, v9
  v_mfma_f32_16x16x32_bf16 v[48:51], a[140:143], v[172:175], v[48:51]
  v_add_f32 v10, v196, v10
  v_add_f32 v11, v196, v11
  v_mfma_f32_16x16x32_bf16 v[56:59], a[140:143], v[188:191], v[204:207]
  v_exp_f32 v8, v8
  v_mfma_f32_16x16x32_bf16 v[56:59], a[136:139], v[184:187], v[56:59]
  v_exp_f32 v9, v9
  buffer_load_dwordx4 v253, s[20:23], s35 offen lds
  v_mfma_f32_16x16x32_bf16 v[56:59], a[132:135], v[180:183], v[56:59]
  v_exp_f32 v10, v10
  v_mfma_f32_16x16x32_bf16 v[56:59], a[128:131], v[176:179], v[56:59]
  s_waitcnt lgkmcnt(0)
  v_cvt_pk_bf16_f32 v8, v8, v9
  v_mfma_f32_16x16x32_bf16 v[36:39], a[144:147], v[128:131], v[192:195]
  s_waitcnt vmcnt(9)
  v_exp_f32 v11, v11
  v_mfma_f32_16x16x32_bf16 v[36:39], a[148:151], v[132:135], v[36:39]
  s_barrier
  v_cvt_pk_bf16_f32 v1, v2, v3
  v_add_f32 v16, v200, v16
  v_mfma_f32_16x16x32_bf16 v[36:39], a[152:155], v[136:139], v[36:39]
  ds_read_b128 a[128:131], v212 offset:16384
  v_add_f32 v17, v200, v17
  v_mfma_f32_16x16x32_bf16 v[36:39], a[156:159], v[140:143], v[36:39]
  v_add_f32 v18, v200, v18
  v_add_f32 v19, v200, v19
  v_mfma_f32_16x16x32_bf16 v[44:47], a[156:159], v[156:159], v[196:199]
  ds_read_b128 a[132:135], v213 offset:16384
  v_mfma_f32_16x16x32_bf16 v[44:47], a[152:155], v[152:155], v[44:47]
  v_exp_f32 v16, v16
  v_mfma_f32_16x16x32_bf16 v[44:47], a[148:151], v[148:151], v[44:47]
  ds_read_b128 a[136:139], v214 offset:16384
  v_mfma_f32_16x16x32_bf16 v[44:47], a[144:147], v[144:147], v[44:47]
  v_exp_f32 v17, v17
  v_mfma_f32_16x16x32_bf16 v[52:55], a[144:147], v[160:163], v[200:203]
  ds_read_b128 a[140:143], v215 offset:16384
  v_mfma_f32_16x16x32_bf16 v[52:55], a[148:151], v[164:167], v[52:55]
  v_exp_f32 v18, v18
  v_mfma_f32_16x16x32_bf16 v[52:55], a[152:155], v[168:171], v[52:55]
  v_cvt_pk_bf16_f32 v16, v16, v17
  v_mfma_f32_16x16x32_bf16 v[52:55], a[156:159], v[172:175], v[52:55]
  v_exp_f32 v19, v19
  v_mfma_f32_16x16x32_bf16 v[60:63], a[156:159], v[188:191], v[204:207]
  v_cvt_pk_bf16_f32 v9, v10, v11
  v_add_f32 v24, v204, v24
  v_mfma_f32_16x16x32_bf16 v[60:63], a[152:155], v[184:187], v[60:63]
  v_add_f32 v25, v204, v25
  v_add_f32 v26, v204, v26
  v_mfma_f32_16x16x32_bf16 v[60:63], a[148:151], v[180:183], v[60:63]
  v_add_f32 v27, v204, v27
  v_mfma_f32_16x16x32_bf16 v[60:63], a[144:147], v[176:179], v[60:63]
  s_waitcnt lgkmcnt(0)
  v_exp_f32 v24, v24
  v_exp_f32 v25, v25
  v_exp_f32 v26, v26
  v_cvt_pk_bf16_f32 v24, v24, v25
  v_exp_f32 v27, v27
  v_cvt_pk_bf16_f32 v17, v18, v19
  v_add_f32 v4, v192, v4
  v_add_f32 v5, v192, v5
  v_add_f32 v6, v192, v6
  v_add_f32 v7, v192, v7
  v_exp_f32 v4, v4
  v_exp_f32 v5, v5
  v_exp_f32 v6, v6
  v_cvt_pk_bf16_f32 v2, v4, v5
  v_exp_f32 v7, v7
  v_cvt_pk_bf16_f32 v25, v26, v27
  v_add_f32 v12, v196, v12
  v_add_f32 v13, v196, v13
  v_add_f32 v14, v196, v14
  v_add_f32 v15, v196, v15
  v_exp_f32 v12, v12
  v_exp_f32 v13, v13
  v_exp_f32 v14, v14
  v_cvt_pk_bf16_f32 v10, v12, v13
  v_exp_f32 v15, v15
  v_cvt_pk_bf16_f32 v3, v6, v7
  v_add_f32 v20, v200, v20
  v_add_f32 v21, v200, v21
  v_add_f32 v22, v200, v22
  v_add_f32 v23, v200, v23
  v_exp_f32 v20, v20
  v_exp_f32 v21, v21
  v_exp_f32 v22, v22
  v_cvt_pk_bf16_f32 v18, v20, v21
  v_exp_f32 v23, v23
  v_cvt_pk_bf16_f32 v11, v14, v15
  v_add_f32 v28, v204, v28
  v_add_f32 v29, v204, v29
  v_add_f32 v30, v204, v30
  v_add_f32 v31, v204, v31
  v_exp_f32 v28, v28
  v_exp_f32 v29, v29
  v_exp_f32 v30, v30
  v_cvt_pk_bf16_f32 v26, v28, v29
  v_exp_f32 v31, v31
  v_cvt_pk_bf16_f32 v19, v22, v23
  v_exp_f32 v32, v32
  v_exp_f32 v33, v33
  v_exp_f32 v34, v34
  v_cvt_pk_bf16_f32 v32, v32, v33
  v_exp_f32 v35, v35
  v_cvt_pk_bf16_f32 v27, v30, v31
  v_exp_f32 v40, v40
  v_exp_f32 v41, v41
  v_exp_f32 v42, v42
  v_cvt_pk_bf16_f32 v40, v40, v41
  v_exp_f32 v43, v43
  v_cvt_pk_bf16_f32 v33, v34, v35
  v_exp_f32 v48, v48
  v_exp_f32 v49, v49
  v_exp_f32 v50, v50
  v_cvt_pk_bf16_f32 v48, v48, v49
  v_exp_f32 v51, v51
  v_cvt_pk_bf16_f32 v41, v42, v43
  v_exp_f32 v56, v56
  v_exp_f32 v57, v57
  v_exp_f32 v58, v58
  v_cvt_pk_bf16_f32 v56, v56, v57
  v_exp_f32 v59, v59
  v_cvt_pk_bf16_f32 v49, v50, v51
  v_exp_f32 v36, v36
  v_exp_f32 v37, v37
  v_exp_f32 v38, v38
  v_cvt_pk_bf16_f32 v34, v36, v37
  v_exp_f32 v39, v39
  v_cvt_pk_bf16_f32 v57, v58, v59
  v_exp_f32 v44, v44
  v_exp_f32 v45, v45
  v_exp_f32 v46, v46
  v_cvt_pk_bf16_f32 v42, v44, v45
  v_exp_f32 v47, v47
  v_cvt_pk_bf16_f32 v35, v38, v39
  v_exp_f32 v52, v52
  v_exp_f32 v53, v53
  v_exp_f32 v54, v54
  v_cvt_pk_bf16_f32 v50, v52, v53
  v_exp_f32 v55, v55
  v_cvt_pk_bf16_f32 v43, v46, v47
  v_exp_f32 v60, v60
  v_exp_f32 v61, v61
  v_exp_f32 v62, v62
  v_cvt_pk_bf16_f32 v58, v60, v61
  v_exp_f32 v63, v63
  v_cvt_pk_bf16_f32 v51, v54, v55
  v_cvt_pk_bf16_f32 v59, v62, v63
  v_mfma_f32_16x16x32_bf16 v[64:67], a[128:131], v[128:131], v[192:195]
  s_add_u32 m0, s28, 98304
  v_mfma_f32_16x16x32_bf16 v[64:67], a[132:135], v[132:135], v[64:67]
  ds_read_b128 a[144:147], v212 offset:20480
  v_mfma_f32_16x16x32_bf16 v[64:67], a[136:139], v[136:139], v[64:67]
  buffer_load_dwordx4 v236, s[16:19], s29 offen offset:0 lds
  v_mfma_f32_16x16x32_bf16 v[64:67], a[140:143], v[140:143], v[64:67]
  ds_read_b128 a[148:151], v213 offset:20480
  v_mfma_f32_16x16x32_bf16 v[72:75], a[140:143], v[156:159], v[196:199]
  v_mfma_f32_16x16x32_bf16 v[72:75], a[136:139], v[152:155], v[72:75]
  ds_read_b128 a[152:155], v214 offset:20480
  v_mfma_f32_16x16x32_bf16 v[72:75], a[132:135], v[148:151], v[72:75]
  buffer_load_dwordx4 v237, s[16:19], s29 offen offset:1024 lds
  v_mfma_f32_16x16x32_bf16 v[72:75], a[128:131], v[144:147], v[72:75]
  ds_read_b128 a[156:159], v215 offset:20480
  v_mfma_f32_16x16x32_bf16 v[80:83], a[128:131], v[160:163], v[200:203]
  v_exp_f32 v64, v64
  v_mfma_f32_16x16x32_bf16 v[80:83], a[132:135], v[164:167], v[80:83]
  v_mfma_f32_16x16x32_bf16 v[80:83], a[136:139], v[168:171], v[80:83]
  v_exp_f32 v65, v65
  v_mfma_f32_16x16x32_bf16 v[80:83], a[140:143], v[172:175], v[80:83]
  v_cvt_pk_bf16_f32 v64, v64, v65
  v_mfma_f32_16x16x32_bf16 v[88:91], a[140:143], v[188:191], v[204:207]
  v_exp_f32 v66, v66
  v_mfma_f32_16x16x32_bf16 v[88:91], a[136:139], v[184:187], v[88:91]
  buffer_load_dwordx4 v236, s[16:19], s29 offen offset:2048 lds
  v_mfma_f32_16x16x32_bf16 v[88:91], a[132:135], v[180:183], v[88:91]
  s_waitcnt lgkmcnt(0)
  v_exp_f32 v67, v67
  v_mfma_f32_16x16x32_bf16 v[88:91], a[128:131], v[176:179], v[88:91]
  v_cvt_pk_bf16_f32 v65, v66, v67
  v_mfma_f32_16x16x32_bf16 v[68:71], a[144:147], v[128:131], v[192:195]
  v_exp_f32 v72, v72
  v_mfma_f32_16x16x32_bf16 v[68:71], a[148:151], v[132:135], v[68:71]
  ds_read_b128 a[128:131], v212 offset:24576
  v_mfma_f32_16x16x32_bf16 v[68:71], a[152:155], v[136:139], v[68:71]
  v_exp_f32 v73, v73
  v_mfma_f32_16x16x32_bf16 v[68:71], a[156:159], v[140:143], v[68:71]
  ds_read_b128 a[132:135], v213 offset:24576
  v_cvt_pk_bf16_f32 v72, v72, v73
  v_mfma_f32_16x16x32_bf16 v[76:79], a[156:159], v[156:159], v[196:199]
  v_exp_f32 v74, v74
  v_mfma_f32_16x16x32_bf16 v[76:79], a[152:155], v[152:155], v[76:79]
  ds_read_b128 a[136:139], v214 offset:24576
  v_mfma_f32_16x16x32_bf16 v[76:79], a[148:151], v[148:151], v[76:79]
  v_exp_f32 v75, v75
  v_mfma_f32_16x16x32_bf16 v[76:79], a[144:147], v[144:147], v[76:79]
  ds_read_b128 a[140:143], v215 offset:24576
  v_cvt_pk_bf16_f32 v73, v74, v75
  v_mfma_f32_16x16x32_bf16 v[84:87], a[144:147], v[160:163], v[200:203]
  v_exp_f32 v80, v80
  v_mfma_f32_16x16x32_bf16 v[84:87], a[148:151], v[164:167], v[84:87]
  buffer_load_dwordx4 v237, s[16:19], s29 offen offset:3072 lds
  v_mfma_f32_16x16x32_bf16 v[84:87], a[152:155], v[168:171], v[84:87]
  s_add_u32 s29, s29, 16384
  v_exp_f32 v81, v81
  v_mfma_f32_16x16x32_bf16 v[84:87], a[156:159], v[172:175], v[84:87]
  v_cvt_pk_bf16_f32 v80, v80, v81
  v_mfma_f32_16x16x32_bf16 v[92:95], a[156:159], v[188:191], v[204:207]
  s_add_u32 m0, s28, 49152
  v_exp_f32 v82, v82
  v_mfma_f32_16x16x32_bf16 v[92:95], a[152:155], v[184:187], v[92:95]
  buffer_load_dwordx4 v232, s[12:15], s29 offen offset:0 lds
  v_mfma_f32_16x16x32_bf16 v[92:95], a[148:151], v[180:183], v[92:95]
  s_waitcnt lgkmcnt(0)
  v_exp_f32 v83, v83
  v_mfma_f32_16x16x32_bf16 v[92:95], a[144:147], v[176:179], v[92:95]
  v_cvt_pk_bf16_f32 v81, v82, v83
  v_mfma_f32_16x16x32_bf16 v[96:99], a[128:131], v[128:131], v[192:195]
  v_exp_f32 v88, v88
  v_mfma_f32_16x16x32_bf16 v[96:99], a[132:135], v[132:135], v[96:99]
  ds_read_b128 a[144:147], v212 offset:28672
  v_mfma_f32_16x16x32_bf16 v[96:99], a[136:139], v[136:139], v[96:99]
  v_exp_f32 v89, v89
  v_mfma_f32_16x16x32_bf16 v[96:99], a[140:143], v[140:143], v[96:99]
  ds_read_b128 a[148:151], v213 offset:28672
  v_cvt_pk_bf16_f32 v88, v88, v89
  v_mfma_f32_16x16x32_bf16 v[104:107], a[140:143], v[156:159], v[196:199]
  v_exp_f32 v90, v90
  v_mfma_f32_16x16x32_bf16 v[104:107], a[136:139], v[152:155], v[104:107]
  ds_read_b128 a[152:155], v214 offset:28672
  v_mfma_f32_16x16x32_bf16 v[104:107], a[132:135], v[148:151], v[104:107]
  v_exp_f32 v91, v91
  v_mfma_f32_16x16x32_bf16 v[104:107], a[128:131], v[144:147], v[104:107]
  ds_read_b128 a[156:159], v215 offset:28672
  v_cvt_pk_bf16_f32 v89, v90, v91
  v_mfma_f32_16x16x32_bf16 v[112:115], a[128:131], v[160:163], v[200:203]
  v_exp_f32 v68, v68
  v_mfma_f32_16x16x32_bf16 v[112:115], a[132:135], v[164:167], v[112:115]
  buffer_load_dwordx4 v233, s[12:15], s29 offen offset:1024 lds
  v_mfma_f32_16x16x32_bf16 v[112:115], a[136:139], v[168:171], v[112:115]
  v_exp_f32 v69, v69
  v_mfma_f32_16x16x32_bf16 v[112:115], a[140:143], v[172:175], v[112:115]
  v_cvt_pk_bf16_f32 v66, v68, v69
  v_mfma_f32_16x16x32_bf16 v[120:123], a[140:143], v[188:191], v[204:207]
  v_exp_f32 v70, v70
  v_mfma_f32_16x16x32_bf16 v[120:123], a[136:139], v[184:187], v[120:123]
  buffer_load_dwordx4 v234, s[12:15], s29 offen offset:2048 lds
  v_mfma_f32_16x16x32_bf16 v[120:123], a[132:135], v[180:183], v[120:123]
  s_waitcnt lgkmcnt(0)
  v_exp_f32 v71, v71
  v_mfma_f32_16x16x32_bf16 v[120:123], a[128:131], v[176:179], v[120:123]
  v_cvt_pk_bf16_f32 v67, v70, v71
  v_mfma_f32_16x16x32_bf16 v[100:103], a[144:147], v[128:131], v[192:195]
  v_exp_f32 v76, v76
  v_mfma_f32_16x16x32_bf16 v[100:103], a[148:151], v[132:135], v[100:103]
  ds_read_b64_tr_b16 a[160:161], v216 offset:0
  v_mfma_f32_16x16x32_bf16 v[100:103], a[152:155], v[136:139], v[100:103]
  v_exp_f32 v77, v77
  v_mfma_f32_16x16x32_bf16 v[100:103], a[156:159], v[140:143], v[100:103]
  ds_read_b64_tr_b16 a[162:163], v216 offset:4096
  v_cvt_pk_bf16_f32 v74, v76, v77
  v_mfma_f32_16x16x32_bf16 v[108:111], a[156:159], v[156:159], v[196:199]
  v_exp_f32 v78, v78
  v_mfma_f32_16x16x32_bf16 v[108:111], a[152:155], v[152:155], v[108:111]
  ds_read_b64_tr_b16 a[164:165], v216 offset:8192
  buffer_load_dwordx4 v235, s[12:15], s29 offen offset:3072 lds
  v_mfma_f32_16x16x32_bf16 v[108:111], a[148:151], v[148:151], v[108:111]
  v_exp_f32 v79, v79
  v_mfma_f32_16x16x32_bf16 v[108:111], a[144:147], v[144:147], v[108:111]
  ds_read_b64_tr_b16 a[166:167], v216 offset:12288
  v_cvt_pk_bf16_f32 v75, v78, v79
  v_mfma_f32_16x16x32_bf16 v[116:119], a[144:147], v[160:163], v[200:203]
  v_exp_f32 v84, v84
  v_mfma_f32_16x16x32_bf16 v[116:119], a[148:151], v[164:167], v[116:119]
  ds_read_b64_tr_b16 a[168:169], v217 offset:0
  s_add_u32 m0, s50, 3072
  v_mfma_f32_16x16x32_bf16 v[116:119], a[152:155], v[168:171], v[116:119]
  v_exp_f32 v85, v85
  v_mfma_f32_16x16x32_bf16 v[116:119], a[156:159], v[172:175], v[116:119]
  ds_read_b64_tr_b16 a[170:171], v217 offset:4096
  v_cvt_pk_bf16_f32 v82, v84, v85
  v_mfma_f32_16x16x32_bf16 v[124:127], a[156:159], v[188:191], v[204:207]
  v_exp_f32 v86, v86
  v_mfma_f32_16x16x32_bf16 v[124:127], a[152:155], v[184:187], v[124:127]
  ds_read_b64_tr_b16 a[172:173], v217 offset:8192
  buffer_load_dwordx4 v253, s[44:47], s35 offen lds
  s_add_u32 s35, s35, 221184
  v_mfma_f32_16x16x32_bf16 v[124:127], a[148:151], v[180:183], v[124:127]
  v_exp_f32 v87, v87
  v_mfma_f32_16x16x32_bf16 v[124:127], a[144:147], v[176:179], v[124:127]
  ds_read_b64_tr_b16 a[174:175], v217 offset:12288
  v_cvt_pk_bf16_f32 v83, v86, v87
  v_mfma_f32_16x16x32_bf16 a[192:195], a[208:211], v[0:3], 0
  v_exp_f32 v92, v92
  v_mfma_f32_16x16x32_bf16 a[192:195], a[208:211], v[32:35], a[192:195]
  ds_read_b64_tr_b16 a[176:177], v218 offset:0
  v_mfma_f32_16x16x32_bf16 a[196:199], a[208:211], v[8:11], 0
  v_exp_f32 v93, v93
  v_mfma_f32_16x16x32_bf16 a[196:199], a[208:211], v[40:43], a[196:199]
  ds_read_b64_tr_b16 a[178:179], v218 offset:4096
  v_cvt_pk_bf16_f32 v90, v92, v93
  v_mfma_f32_16x16x32_bf16 a[200:203], a[208:211], v[16:19], 0
  v_exp_f32 v94, v94
  v_mfma_f32_16x16x32_bf16 a[200:203], a[208:211], v[48:51], a[200:203]
  ds_read_b64_tr_b16 a[180:181], v218 offset:8192
  v_mfma_f32_16x16x32_bf16 a[204:207], a[208:211], v[24:27], 0
  s_waitcnt lgkmcnt(7)
  v_exp_f32 v95, v95
  v_mfma_f32_16x16x32_bf16 a[204:207], a[208:211], v[56:59], a[204:207]
  ds_read_b64_tr_b16 a[182:183], v218 offset:12288
  v_cvt_pk_bf16_f32 v91, v94, v95
  v_mfma_f32_16x16x32_bf16 a[0:3], a[160:163], v[0:3], 0
  v_exp_f32 v96, v96
  v_mfma_f32_16x16x32_bf16 a[0:3], a[164:167], v[32:35], a[0:3]
  ds_read_b64_tr_b16 a[184:185], v219 offset:0
  v_mfma_f32_16x16x32_bf16 a[4:7], a[164:167], v[40:43], 0
  v_exp_f32 v97, v97
  v_mfma_f32_16x16x32_bf16 a[4:7], a[160:163], v[8:11], a[4:7]
  ds_read_b64_tr_b16 a[186:187], v219 offset:4096
  v_cvt_pk_bf16_f32 v96, v96, v97
  v_mfma_f32_16x16x32_bf16 a[8:11], a[160:163], v[16:19], 0
  v_exp_f32 v98, v98
  v_mfma_f32_16x16x32_bf16 a[8:11], a[164:167], v[48:51], a[8:11]
  ds_read_b64_tr_b16 a[188:189], v219 offset:8192
  v_mfma_f32_16x16x32_bf16 a[12:15], a[164:167], v[56:59], 0
  s_waitcnt lgkmcnt(7)
  v_exp_f32 v99, v99
  v_mfma_f32_16x16x32_bf16 a[12:15], a[160:163], v[24:27], a[12:15]
  ds_read_b64_tr_b16 a[190:191], v219 offset:12288
  v_cvt_pk_bf16_f32 v97, v98, v99
  v_mfma_f32_16x16x32_bf16 a[16:19], a[168:171], v[0:3], 0
  v_exp_f32 v104, v104
  v_mfma_f32_16x16x32_bf16 a[16:19], a[172:175], v[32:35], a[16:19]
  ds_read_b64_tr_b16 a[160:161], v220 offset:0
  v_mfma_f32_16x16x32_bf16 a[20:23], a[172:175], v[40:43], 0
  v_exp_f32 v105, v105
  v_mfma_f32_16x16x32_bf16 a[20:23], a[168:171], v[8:11], a[20:23]
  ds_read_b64_tr_b16 a[162:163], v220 offset:4096
  v_cvt_pk_bf16_f32 v104, v104, v105
  v_mfma_f32_16x16x32_bf16 a[24:27], a[168:171], v[16:19], 0
  v_exp_f32 v106, v106
  v_mfma_f32_16x16x32_bf16 a[24:27], a[172:175], v[48:51], a[24:27]
  ds_read_b64_tr_b16 a[164:165], v220 offset:8192
  v_mfma_f32_16x16x32_bf16 a[28:31], a[172:175], v[56:59], 0
  s_waitcnt lgkmcnt(7)
  v_exp_f32 v107, v107
  v_mfma_f32_16x16x32_bf16 a[28:31], a[168:171], v[24:27], a[28:31]
  ds_read_b64_tr_b16 a[166:167], v220 offset:12288
  v_cvt_pk_bf16_f32 v105, v106, v107
  v_mfma_f32_16x16x32_bf16 a[32:35], a[176:179], v[0:3], 0
  v_exp_f32 v112, v112
  v_mfma_f32_16x16x32_bf16 a[32:35], a[180:183], v[32:35], a[32:35]
  ds_read_b64_tr_b16 a[168:169], v221 offset:0
  v_mfma_f32_16x16x32_bf16 a[36:39], a[180:183], v[40:43], 0
  v_exp_f32 v113, v113
  v_mfma_f32_16x16x32_bf16 a[36:39], a[176:179], v[8:11], a[36:39]
  ds_read_b64_tr_b16 a[170:171], v221 offset:4096
  v_cvt_pk_bf16_f32 v112, v112, v113
  v_mfma_f32_16x16x32_bf16 a[40:43], a[176:179], v[16:19], 0
  v_exp_f32 v114, v114
  v_mfma_f32_16x16x32_bf16 a[40:43], a[180:183], v[48:51], a[40:43]
  ds_read_b64_tr_b16 a[172:173], v221 offset:8192
  v_mfma_f32_16x16x32_bf16 a[44:47], a[180:183], v[56:59], 0
  s_waitcnt lgkmcnt(7)
  v_exp_f32 v115, v115
  v_mfma_f32_16x16x32_bf16 a[44:47], a[176:179], v[24:27], a[44:47]
  ds_read_b64_tr_b16 a[174:175], v221 offset:12288
  v_cvt_pk_bf16_f32 v113, v114, v115
  v_mfma_f32_16x16x32_bf16 a[48:51], a[184:187], v[0:3], 0
  v_exp_f32 v120, v120
  v_mfma_f32_16x16x32_bf16 a[48:51], a[188:191], v[32:35], a[48:51]
  ds_read_b64_tr_b16 a[176:177], v222 offset:0
  v_mfma_f32_16x16x32_bf16 a[52:55], a[188:191], v[40:43], 0
  v_exp_f32 v121, v121
  v_mfma_f32_16x16x32_bf16 a[52:55], a[184:187], v[8:11], a[52:55]
  ds_read_b64_tr_b16 a[178:179], v222 offset:4096
  v_cvt_pk_bf16_f32 v120, v120, v121
  v_mfma_f32_16x16x32_bf16 a[56:59], a[184:187], v[16:19], 0
  v_exp_f32 v122, v122
  v_mfma_f32_16x16x32_bf16 a[56:59], a[188:191], v[48:51], a[56:59]
  ds_read_b64_tr_b16 a[180:181], v222 offset:8192
  v_mfma_f32_16x16x32_bf16 a[60:63], a[188:191], v[56:59], 0
  s_waitcnt lgkmcnt(7)
  v_exp_f32 v123, v123
  v_mfma_f32_16x16x32_bf16 a[60:63], a[184:187], v[24:27], a[60:63]
  ds_read_b64_tr_b16 a[182:183], v222 offset:12288
  v_cvt_pk_bf16_f32 v121, v122, v123
  v_mfma_f32_16x16x32_bf16 a[64:67], a[160:163], v[0:3], 0
  v_exp_f32 v100, v100
  v_mfma_f32_16x16x32_bf16 a[64:67], a[164:167], v[32:35], a[64:67]
  ds_read_b64_tr_b16 a[184:185], v223 offset:0
  v_mfma_f32_16x16x32_bf16 a[68:71], a[164:167], v[40:43], 0
  v_exp_f32 v101, v101
  v_mfma_f32_16x16x32_bf16 a[68:71], a[160:163], v[8:11], a[68:71]
  ds_read_b64_tr_b16 a[186:187], v223 offset:4096
  v_cvt_pk_bf16_f32 v98, v100, v101
  v_mfma_f32_16x16x32_bf16 a[72:75], a[160:163], v[16:19], 0
  v_exp_f32 v102, v102
  v_mfma_f32_16x16x32_bf16 a[72:75], a[164:167], v[48:51], a[72:75]
  ds_read_b64_tr_b16 a[188:189], v223 offset:8192
  v_mfma_f32_16x16x32_bf16 a[76:79], a[164:167], v[56:59], 0
  s_waitcnt lgkmcnt(7)
  v_exp_f32 v103, v103
  v_mfma_f32_16x16x32_bf16 a[76:79], a[160:163], v[24:27], a[76:79]
  ds_read_b64_tr_b16 a[190:191], v223 offset:12288
  v_cvt_pk_bf16_f32 v99, v102, v103
  v_mfma_f32_16x16x32_bf16 a[80:83], a[168:171], v[0:3], 0
  s_waitcnt vmcnt(10)
  v_exp_f32 v108, v108
  v_mfma_f32_16x16x32_bf16 a[80:83], a[172:175], v[32:35], a[80:83]
  v_mfma_f32_16x16x32_bf16 a[84:87], a[172:175], v[40:43], 0
  s_barrier
  v_exp_f32 v109, v109
  v_mfma_f32_16x16x32_bf16 a[84:87], a[168:171], v[8:11], a[84:87]
  ds_read_b128 a[128:131], v212 offset:32768
  v_cvt_pk_bf16_f32 v106, v108, v109
  v_mfma_f32_16x16x32_bf16 a[88:91], a[168:171], v[16:19], 0
  v_exp_f32 v110, v110
  v_mfma_f32_16x16x32_bf16 a[88:91], a[172:175], v[48:51], a[88:91]
  ds_read_b128 a[132:135], v213 offset:32768
  v_mfma_f32_16x16x32_bf16 a[92:95], a[172:175], v[56:59], 0
  s_waitcnt lgkmcnt(6)
  v_exp_f32 v111, v111
  v_mfma_f32_16x16x32_bf16 a[92:95], a[168:171], v[24:27], a[92:95]
  ds_read_b128 a[136:139], v214 offset:32768
  v_cvt_pk_bf16_f32 v107, v110, v111
  v_mfma_f32_16x16x32_bf16 a[96:99], a[176:179], v[0:3], 0
  s_mul_i32 s38, s3, 20480
  v_exp_f32 v116, v116
  v_mfma_f32_16x16x32_bf16 a[96:99], a[180:183], v[32:35], a[96:99]
  ds_read_b128 a[140:143], v215 offset:32768
  buffer_load_dwordx4 a[212:215], v243, s[24:27], s38 offen sc1
  s_add_u32 s38, s38, 4096
  v_mfma_f32_16x16x32_bf16 a[100:103], a[180:183], v[40:43], 0
  v_exp_f32 v117, v117
  v_mfma_f32_16x16x32_bf16 a[100:103], a[176:179], v[8:11], a[100:103]
  v_cvt_pk_bf16_f32 v114, v116, v117
  v_mfma_f32_16x16x32_bf16 a[104:107], a[176:179], v[16:19], 0
  v_exp_f32 v118, v118
  v_mfma_f32_16x16x32_bf16 a[104:107], a[180:183], v[48:51], a[104:107]
  v_mfma_f32_16x16x32_bf16 a[108:111], a[180:183], v[56:59], 0
  s_waitcnt lgkmcnt(4)
  v_exp_f32 v119, v119
  v_mfma_f32_16x16x32_bf16 a[108:111], a[176:179], v[24:27], a[108:111]
  v_cvt_pk_bf16_f32 v115, v118, v119
  v_mfma_f32_16x16x32_bf16 a[112:115], a[184:187], v[0:3], 0
  v_exp_f32 v124, v124
  v_mfma_f32_16x16x32_bf16 a[112:115], a[188:191], v[32:35], a[112:115]
  v_mfma_f32_16x16x32_bf16 a[116:119], a[188:191], v[40:43], 0
  v_exp_f32 v125, v125
  v_mfma_f32_16x16x32_bf16 a[116:119], a[184:187], v[8:11], a[116:119]
  v_cvt_pk_bf16_f32 v122, v124, v125
  v_mfma_f32_16x16x32_bf16 a[120:123], a[184:187], v[16:19], 0
  v_exp_f32 v126, v126
  v_mfma_f32_16x16x32_bf16 a[120:123], a[188:191], v[48:51], a[120:123]
  v_mfma_f32_16x16x32_bf16 a[124:127], a[188:191], v[56:59], 0
  s_waitcnt lgkmcnt(0)
  v_exp_f32 v127, v127
  v_mfma_f32_16x16x32_bf16 a[124:127], a[184:187], v[24:27], a[124:127]
  v_cvt_pk_bf16_f32 v123, v126, v127
  v_mfma_f32_16x16x32_bf16 v[0:3], a[128:131], v[128:131], v[192:195]
  s_add_u32 m0, s28, 114688
  v_mfma_f32_16x16x32_bf16 v[0:3], a[132:135], v[132:135], v[0:3]
  ds_read_b128 a[144:147], v212 offset:36864
  v_mfma_f32_16x16x32_bf16 v[0:3], a[136:139], v[136:139], v[0:3]
  buffer_load_dwordx4 v236, s[16:19], s29 offen offset:0 lds
  v_mfma_f32_16x16x32_bf16 v[0:3], a[140:143], v[140:143], v[0:3]
  ds_read_b128 a[148:151], v213 offset:36864
  v_mfma_f32_16x16x32_bf16 v[8:11], a[140:143], v[156:159], v[196:199]
  v_mfma_f32_16x16x32_bf16 v[8:11], a[136:139], v[152:155], v[8:11]
  ds_read_b128 a[152:155], v214 offset:36864
  v_mfma_f32_16x16x32_bf16 v[8:11], a[132:135], v[148:151], v[8:11]
  buffer_load_dwordx4 v237, s[16:19], s29 offen offset:1024 lds
  v_mfma_f32_16x16x32_bf16 v[8:11], a[128:131], v[144:147], v[8:11]
  ds_read_b128 a[156:159], v215 offset:36864
  v_mfma_f32_16x16x32_bf16 v[16:19], a[128:131], v[160:163], v[200:203]
  v_exp_f32 v0, v0
  v_mfma_f32_16x16x32_bf16 v[16:19], a[132:135], v[164:167], v[16:19]
  v_mfma_f32_16x16x32_bf16 v[16:19], a[136:139], v[168:171], v[16:19]
  v_exp_f32 v1, v1
  v_mfma_f32_16x16x32_bf16 v[16:19], a[140:143], v[172:175], v[16:19]
  v_cvt_pk_bf16_f32 v0, v0, v1
  v_mfma_f32_16x16x32_bf16 v[24:27], a[140:143], v[188:191], v[204:207]
  v_exp_f32 v2, v2
  v_mfma_f32_16x16x32_bf16 v[24:27], a[136:139], v[184:187], v[24:27]
  buffer_load_dwordx4 v236, s[16:19], s29 offen offset:2048 lds
  v_mfma_f32_16x16x32_bf16 v[24:27], a[132:135], v[180:183], v[24:27]
  s_waitcnt lgkmcnt(0)
  v_exp_f32 v3, v3
  v_mfma_f32_16x16x32_bf16 v[24:27], a[128:131], v[176:179], v[24:27]
  v_cvt_pk_bf16_f32 v1, v2, v3
  v_mfma_f32_16x16x32_bf16 v[4:7], a[144:147], v[128:131], v[192:195]
  v_exp_f32 v8, v8
  v_mfma_f32_16x16x32_bf16 v[4:7], a[148:151], v[132:135], v[4:7]
  ds_read_b128 a[128:131], v212 offset:40960
  v_mfma_f32_16x16x32_bf16 v[4:7], a[152:155], v[136:139], v[4:7]
  v_exp_f32 v9, v9
  v_mfma_f32_16x16x32_bf16 v[4:7], a[156:159], v[140:143], v[4:7]
  ds_read_b128 a[132:135], v213 offset:40960
  v_cvt_pk_bf16_f32 v8, v8, v9
  v_mfma_f32_16x16x32_bf16 v[12:15], a[156:159], v[156:159], v[196:199]
  v_exp_f32 v10, v10
  v_mfma_f32_16x16x32_bf16 v[12:15], a[152:155], v[152:155], v[12:15]
  ds_read_b128 a[136:139], v214 offset:40960
  v_mfma_f32_16x16x32_bf16 v[12:15], a[148:151], v[148:151], v[12:15]
  v_exp_f32 v11, v11
  v_mfma_f32_16x16x32_bf16 v[12:15], a[144:147], v[144:147], v[12:15]
  ds_read_b128 a[140:143], v215 offset:40960
  v_cvt_pk_bf16_f32 v9, v10, v11
  v_mfma_f32_16x16x32_bf16 v[20:23], a[144:147], v[160:163], v[200:203]
  v_exp_f32 v16, v16
  v_mfma_f32_16x16x32_bf16 v[20:23], a[148:151], v[164:167], v[20:23]
  buffer_load_dwordx4 v237, s[16:19], s29 offen offset:3072 lds
  v_mfma_f32_16x16x32_bf16 v[20:23], a[152:155], v[168:171], v[20:23]
  s_add_u32 s29, s29, 16384
  v_exp_f32 v17, v17
  v_mfma_f32_16x16x32_bf16 v[20:23], a[156:159], v[172:175], v[20:23]
  v_cvt_pk_bf16_f32 v16, v16, v17
  v_mfma_f32_16x16x32_bf16 v[28:31], a[156:159], v[188:191], v[204:207]
  s_add_u32 m0, s28, 0
  v_exp_f32 v18, v18
  v_mfma_f32_16x16x32_bf16 v[28:31], a[152:155], v[184:187], v[28:31]
  buffer_load_dwordx4 v232, s[12:15], s29 offen offset:0 lds
  v_mfma_f32_16x16x32_bf16 v[28:31], a[148:151], v[180:183], v[28:31]
  s_waitcnt lgkmcnt(0)
  v_exp_f32 v19, v19
  v_mfma_f32_16x16x32_bf16 v[28:31], a[144:147], v[176:179], v[28:31]
  v_cvt_pk_bf16_f32 v17, v18, v19
  v_mfma_f32_16x16x32_bf16 v[32:35], a[128:131], v[128:131], v[192:195]
  v_exp_f32 v24, v24
  v_mfma_f32_16x16x32_bf16 v[32:35], a[132:135], v[132:135], v[32:35]
  ds_read_b128 a[144:147], v212 offset:45056
  v_mfma_f32_16x16x32_bf16 v[32:35], a[136:139], v[136:139], v[32:35]
  v_exp_f32 v25, v25
  v_mfma_f32_16x16x32_bf16 v[32:35], a[140:143], v[140:143], v[32:35]
  ds_read_b128 a[148:151], v213 offset:45056
  v_cvt_pk_bf16_f32 v24, v24, v25
  v_mfma_f32_16x16x32_bf16 v[40:43], a[140:143], v[156:159], v[196:199]
  v_exp_f32 v26, v26
  v_mfma_f32_16x16x32_bf16 v[40:43], a[136:139], v[152:155], v[40:43]
  ds_read_b128 a[152:155], v214 offset:45056
  v_mfma_f32_16x16x32_bf16 v[40:43], a[132:135], v[148:151], v[40:43]
  v_exp_f32 v27, v27
  v_mfma_f32_16x16x32_bf16 v[40:43], a[128:131], v[144:147], v[40:43]
  ds_read_b128 a[156:159], v215 offset:45056
  v_cvt_pk_bf16_f32 v25, v26, v27
  v_mfma_f32_16x16x32_bf16 v[48:51], a[128:131], v[160:163], v[200:203]
  v_exp_f32 v4, v4
  v_mfma_f32_16x16x32_bf16 v[48:51], a[132:135], v[164:167], v[48:51]
  buffer_load_dwordx4 v233, s[12:15], s29 offen offset:1024 lds
  v_mfma_f32_16x16x32_bf16 v[48:51], a[136:139], v[168:171], v[48:51]
  v_exp_f32 v5, v5
  v_mfma_f32_16x16x32_bf16 v[48:51], a[140:143], v[172:175], v[48:51]
  v_cvt_pk_bf16_f32 v2, v4, v5
  v_mfma_f32_16x16x32_bf16 v[56:59], a[140:143], v[188:191], v[204:207]
  v_exp_f32 v6, v6
  v_mfma_f32_16x16x32_bf16 v[56:59], a[136:139], v[184:187], v[56:59]
  buffer_load_dwordx4 v234, s[12:15], s29 offen offset:2048 lds
  v_mfma_f32_16x16x32_bf16 v[56:59], a[132:135], v[180:183], v[56:59]
  s_waitcnt lgkmcnt(0)
  v_exp_f32 v7, v7
  v_mfma_f32_16x16x32_bf16 v[56:59], a[128:131], v[176:179], v[56:59]
  v_cvt_pk_bf16_f32 v3, v6, v7
  v_mfma_f32_16x16x32_bf16 v[36:39], a[144:147], v[128:131], v[192:195]
  v_exp_f32 v12, v12
  v_mfma_f32_16x16x32_bf16 v[36:39], a[148:151], v[132:135], v[36:39]
  ds_read_b64_tr_b16 a[160:161], v216 offset:16384
  v_mfma_f32_16x16x32_bf16 v[36:39], a[152:155], v[136:139], v[36:39]
  v_exp_f32 v13, v13
  v_mfma_f32_16x16x32_bf16 v[36:39], a[156:159], v[140:143], v[36:39]
  ds_read_b64_tr_b16 a[162:163], v216 offset:20480
  v_cvt_pk_bf16_f32 v10, v12, v13
  v_mfma_f32_16x16x32_bf16 v[44:47], a[156:159], v[156:159], v[196:199]
  v_exp_f32 v14, v14
  v_mfma_f32_16x16x32_bf16 v[44:47], a[152:155], v[152:155], v[44:47]
  ds_read_b64_tr_b16 a[164:165], v216 offset:24576
  buffer_load_dwordx4 v235, s[12:15], s29 offen offset:3072 lds
  v_mfma_f32_16x16x32_bf16 v[44:47], a[148:151], v[148:151], v[44:47]
  v_exp_f32 v15, v15
  v_mfma_f32_16x16x32_bf16 v[44:47], a[144:147], v[144:147], v[44:47]
  ds_read_b64_tr_b16 a[166:167], v216 offset:28672
  v_cvt_pk_bf16_f32 v11, v14, v15
  v_mfma_f32_16x16x32_bf16 v[52:55], a[144:147], v[160:163], v[200:203]
  v_exp_f32 v20, v20
  v_mfma_f32_16x16x32_bf16 v[52:55], a[148:151], v[164:167], v[52:55]
  ds_read_b64_tr_b16 a[168:169], v217 offset:16384
  s_add_u32 m0, s50, 1024
  v_mfma_f32_16x16x32_bf16 v[52:55], a[152:155], v[168:171], v[52:55]
  v_exp_f32 v21, v21
  v_mfma_f32_16x16x32_bf16 v[52:55], a[156:159], v[172:175], v[52:55]
  ds_read_b64_tr_b16 a[170:171], v217 offset:20480
  v_cvt_pk_bf16_f32 v18, v20, v21
  v_mfma_f32_16x16x32_bf16 v[60:63], a[156:159], v[188:191], v[204:207]
  v_exp_f32 v22, v22
  v_mfma_f32_16x16x32_bf16 v[60:63], a[152:155], v[184:187], v[60:63]
  ds_read_b64_tr_b16 a[172:173], v217 offset:24576
  buffer_load_dwordx4 v253, s[20:23], s35 offen lds
  v_mfma_f32_16x16x32_bf16 v[60:63], a[148:151], v[180:183], v[60:63]
  v_exp_f32 v23, v23
  v_mfma_f32_16x16x32_bf16 v[60:63], a[144:147], v[176:179], v[60:63]
  ds_read_b64_tr_b16 a[174:175], v217 offset:28672
  v_cvt_pk_bf16_f32 v19, v22, v23
  v_mfma_f32_16x16x32_bf16 a[192:195], a[208:211], v[64:67], a[192:195]
  v_exp_f32 v28, v28
  v_mfma_f32_16x16x32_bf16 a[192:195], a[208:211], v[96:99], a[192:195]
  ds_read_b64_tr_b16 a[176:177], v218 offset:16384
  v_mfma_f32_16x16x32_bf16 a[196:199], a[208:211], v[72:75], a[196:199]
  v_exp_f32 v29, v29
  v_mfma_f32_16x16x32_bf16 a[196:199], a[208:211], v[104:107], a[196:199]
  ds_read_b64_tr_b16 a[178:179], v218 offset:20480
  v_cvt_pk_bf16_f32 v26, v28, v29
  v_mfma_f32_16x16x32_bf16 a[200:203], a[208:211], v[80:83], a[200:203]
  v_exp_f32 v30, v30
  v_mfma_f32_16x16x32_bf16 a[200:203], a[208:211], v[112:115], a[200:203]
  ds_read_b64_tr_b16 a[180:181], v218 offset:24576
  v_mfma_f32_16x16x32_bf16 a[204:207], a[208:211], v[88:91], a[204:207]
  s_waitcnt lgkmcnt(7)
  v_exp_f32 v31, v31
  v_mfma_f32_16x16x32_bf16 a[204:207], a[208:211], v[120:123], a[204:207]
  ds_read_b64_tr_b16 a[182:183], v218 offset:28672
  v_cvt_pk_bf16_f32 v27, v30, v31
  v_mfma_f32_16x16x32_bf16 a[0:3], a[160:163], v[64:67], a[0:3]
  v_exp_f32 v32, v32
  v_mfma_f32_16x16x32_bf16 a[0:3], a[164:167], v[96:99], a[0:3]
  ds_read_b64_tr_b16 a[184:185], v219 offset:16384
  v_mfma_f32_16x16x32_bf16 a[4:7], a[164:167], v[104:107], a[4:7]
  v_exp_f32 v33, v33
  v_mfma_f32_16x16x32_bf16 a[4:7], a[160:163], v[72:75], a[4:7]
  ds_read_b64_tr_b16 a[186:187], v219 offset:20480
  v_cvt_pk_bf16_f32 v32, v32, v33
  v_mfma_f32_16x16x32_bf16 a[8:11], a[160:163], v[80:83], a[8:11]
  v_exp_f32 v34, v34
  v_mfma_f32_16x16x32_bf16 a[8:11], a[164:167], v[112:115], a[8:11]
  ds_read_b64_tr_b16 a[188:189], v219 offset:24576
  v_mfma_f32_16x16x32_bf16 a[12:15], a[164:167], v[120:123], a[12:15]
  s_waitcnt lgkmcnt(7)
  v_exp_f32 v35, v35
  v_mfma_f32_16x16x32_bf16 a[12:15], a[160:163], v[88:91], a[12:15]
  ds_read_b64_tr_b16 a[190:191], v219 offset:28672
  v_cvt_pk_bf16_f32 v33, v34, v35
  v_mfma_f32_16x16x32_bf16 a[16:19], a[168:171], v[64:67], a[16:19]
  v_exp_f32 v40, v40
  v_mfma_f32_16x16x32_bf16 a[16:19], a[172:175], v[96:99], a[16:19]
  ds_read_b64_tr_b16 a[160:161], v220 offset:16384
  v_mfma_f32_16x16x32_bf16 a[20:23], a[172:175], v[104:107], a[20:23]
  v_exp_f32 v41, v41
  v_mfma_f32_16x16x32_bf16 a[20:23], a[168:171], v[72:75], a[20:23]
  ds_read_b64_tr_b16 a[162:163], v220 offset:20480
  v_cvt_pk_bf16_f32 v40, v40, v41
  v_mfma_f32_16x16x32_bf16 a[24:27], a[168:171], v[80:83], a[24:27]
  v_exp_f32 v42, v42
  v_mfma_f32_16x16x32_bf16 a[24:27], a[172:175], v[112:115], a[24:27]
  ds_read_b64_tr_b16 a[164:165], v220 offset:24576
  v_mfma_f32_16x16x32_bf16 a[28:31], a[172:175], v[120:123], a[28:31]
  s_waitcnt lgkmcnt(7)
  v_exp_f32 v43, v43
  v_mfma_f32_16x16x32_bf16 a[28:31], a[168:171], v[88:91], a[28:31]
  ds_read_b64_tr_b16 a[166:167], v220 offset:28672
  v_cvt_pk_bf16_f32 v41, v42, v43
  v_mfma_f32_16x16x32_bf16 a[32:35], a[176:179], v[64:67], a[32:35]
  v_exp_f32 v48, v48
  v_mfma_f32_16x16x32_bf16 a[32:35], a[180:183], v[96:99], a[32:35]
  ds_read_b64_tr_b16 a[168:169], v221 offset:16384
  v_mfma_f32_16x16x32_bf16 a[36:39], a[180:183], v[104:107], a[36:39]
  v_exp_f32 v49, v49
  v_mfma_f32_16x16x32_bf16 a[36:39], a[176:179], v[72:75], a[36:39]
  ds_read_b64_tr_b16 a[170:171], v221 offset:20480
  v_cvt_pk_bf16_f32 v48, v48, v49
  v_mfma_f32_16x16x32_bf16 a[40:43], a[176:179], v[80:83], a[40:43]
  v_exp_f32 v50, v50
  v_mfma_f32_16x16x32_bf16 a[40:43], a[180:183], v[112:115], a[40:43]
  ds_read_b64_tr_b16 a[172:173], v221 offset:24576
  v_mfma_f32_16x16x32_bf16 a[44:47], a[180:183], v[120:123], a[44:47]
  s_waitcnt lgkmcnt(7)
  v_exp_f32 v51, v51
  v_mfma_f32_16x16x32_bf16 a[44:47], a[176:179], v[88:91], a[44:47]
  ds_read_b64_tr_b16 a[174:175], v221 offset:28672
  v_cvt_pk_bf16_f32 v49, v50, v51
  v_mfma_f32_16x16x32_bf16 a[48:51], a[184:187], v[64:67], a[48:51]
  v_exp_f32 v56, v56
  v_mfma_f32_16x16x32_bf16 a[48:51], a[188:191], v[96:99], a[48:51]
  ds_read_b64_tr_b16 a[176:177], v222 offset:16384
  v_mfma_f32_16x16x32_bf16 a[52:55], a[188:191], v[104:107], a[52:55]
  v_exp_f32 v57, v57
  v_mfma_f32_16x16x32_bf16 a[52:55], a[184:187], v[72:75], a[52:55]
  ds_read_b64_tr_b16 a[178:179], v222 offset:20480
  v_cvt_pk_bf16_f32 v56, v56, v57
  v_mfma_f32_16x16x32_bf16 a[56:59], a[184:187], v[80:83], a[56:59]
  v_exp_f32 v58, v58
  v_mfma_f32_16x16x32_bf16 a[56:59], a[188:191], v[112:115], a[56:59]
  ds_read_b64_tr_b16 a[180:181], v222 offset:24576
  v_mfma_f32_16x16x32_bf16 a[60:63], a[188:191], v[120:123], a[60:63]
  s_waitcnt lgkmcnt(7)
  v_exp_f32 v59, v59
  v_mfma_f32_16x16x32_bf16 a[60:63], a[184:187], v[88:91], a[60:63]
  ds_read_b64_tr_b16 a[182:183], v222 offset:28672
  v_cvt_pk_bf16_f32 v57, v58, v59
  v_mfma_f32_16x16x32_bf16 a[64:67], a[160:163], v[64:67], a[64:67]
  v_exp_f32 v36, v36
  v_mfma_f32_16x16x32_bf16 a[64:67], a[164:167], v[96:99], a[64:67]
  ds_read_b64_tr_b16 a[184:185], v223 offset:16384
  v_mfma_f32_16x16x32_bf16 a[68:71], a[164:167], v[104:107], a[68:71]
  v_exp_f32 v37, v37
  v_mfma_f32_16x16x32_bf16 a[68:71], a[160:163], v[72:75], a[68:71]
  ds_read_b64_tr_b16 a[186:187], v223 offset:20480
  v_cvt_pk_bf16_f32 v34, v36, v37
  v_mfma_f32_16x16x32_bf16 a[72:75], a[160:163], v[80:83], a[72:75]
  v_exp_f32 v38, v38
  v_mfma_f32_16x16x32_bf16 a[72:75], a[164:167], v[112:115], a[72:75]
  ds_read_b64_tr_b16 a[188:189], v223 offset:24576
  v_mfma_f32_16x16x32_bf16 a[76:79], a[164:167], v[120:123], a[76:79]
  s_waitcnt lgkmcnt(7)
  v_exp_f32 v39, v39
  v_mfma_f32_16x16x32_bf16 a[76:79], a[160:163], v[88:91], a[76:79]
  ds_read_b64_tr_b16 a[190:191], v223 offset:28672
  v_cvt_pk_bf16_f32 v35, v38, v39
  v_mfma_f32_16x16x32_bf16 a[80:83], a[168:171], v[64:67], a[80:83]
  s_waitcnt vmcnt(11)
  v_exp_f32 v44, v44
  v_mfma_f32_16x16x32_bf16 a[80:83], a[172:175], v[96:99], a[80:83]
  v_mfma_f32_16x16x32_bf16 a[84:87], a[172:175], v[104:107], a[84:87]
  s_barrier
  v_exp_f32 v45, v45
  v_mfma_f32_16x16x32_bf16 a[84:87], a[168:171], v[72:75], a[84:87]
  ds_read_b128 a[128:131], v212 offset:49152
  v_cvt_pk_bf16_f32 v42, v44, v45
  v_mfma_f32_16x16x32_bf16 a[88:91], a[168:171], v[80:83], a[88:91]
  v_exp_f32 v46, v46
  v_mfma_f32_16x16x32_bf16 a[88:91], a[172:175], v[112:115], a[88:91]
  ds_read_b128 a[132:135], v213 offset:49152
  v_mfma_f32_16x16x32_bf16 a[92:95], a[172:175], v[120:123], a[92:95]
  s_waitcnt lgkmcnt(6)
  v_exp_f32 v47, v47
  v_mfma_f32_16x16x32_bf16 a[92:95], a[168:171], v[88:91], a[92:95]
  ds_read_b128 a[136:139], v214 offset:49152
  v_cvt_pk_bf16_f32 v43, v46, v47
  v_mfma_f32_16x16x32_bf16 a[96:99], a[176:179], v[64:67], a[96:99]
  v_exp_f32 v52, v52
  v_mfma_f32_16x16x32_bf16 a[96:99], a[180:183], v[96:99], a[96:99]
  ds_read_b128 a[140:143], v215 offset:49152
  buffer_load_dwordx4 a[216:219], v243, s[24:27], s38 offen sc1
  s_add_u32 s38, s38, 4096
  v_mfma_f32_16x16x32_bf16 a[100:103], a[180:183], v[104:107], a[100:103]
  v_exp_f32 v53, v53
  v_mfma_f32_16x16x32_bf16 a[100:103], a[176:179], v[72:75], a[100:103]
  v_cvt_pk_bf16_f32 v50, v52, v53
  v_mfma_f32_16x16x32_bf16 a[104:107], a[176:179], v[80:83], a[104:107]
  v_exp_f32 v54, v54
  v_mfma_f32_16x16x32_bf16 a[104:107], a[180:183], v[112:115], a[104:107]
  v_mfma_f32_16x16x32_bf16 a[108:111], a[180:183], v[120:123], a[108:111]
  s_waitcnt lgkmcnt(4)
  v_exp_f32 v55, v55
  v_mfma_f32_16x16x32_bf16 a[108:111], a[176:179], v[88:91], a[108:111]
  v_cvt_pk_bf16_f32 v51, v54, v55
  v_mfma_f32_16x16x32_bf16 a[112:115], a[184:187], v[64:67], a[112:115]
  v_exp_f32 v60, v60
  v_mfma_f32_16x16x32_bf16 a[112:115], a[188:191], v[96:99], a[112:115]
  v_mfma_f32_16x16x32_bf16 a[116:119], a[188:191], v[104:107], a[116:119]
  v_exp_f32 v61, v61
  v_mfma_f32_16x16x32_bf16 a[116:119], a[184:187], v[72:75], a[116:119]
  v_cvt_pk_bf16_f32 v58, v60, v61
  v_mfma_f32_16x16x32_bf16 a[120:123], a[184:187], v[80:83], a[120:123]
  v_exp_f32 v62, v62
  v_mfma_f32_16x16x32_bf16 a[120:123], a[188:191], v[112:115], a[120:123]
  v_mfma_f32_16x16x32_bf16 a[124:127], a[188:191], v[120:123], a[124:127]
  s_waitcnt lgkmcnt(0)
  v_exp_f32 v63, v63
  v_mfma_f32_16x16x32_bf16 a[124:127], a[184:187], v[88:91], a[124:127]
  v_cvt_pk_bf16_f32 v59, v62, v63
  v_mfma_f32_16x16x32_bf16 v[64:67], a[128:131], v[128:131], v[192:195]
  s_add_u32 m0, s28, 65536
  v_mfma_f32_16x16x32_bf16 v[64:67], a[132:135], v[132:135], v[64:67]
  ds_read_b128 a[144:147], v212 offset:53248
  v_mfma_f32_16x16x32_bf16 v[64:67], a[136:139], v[136:139], v[64:67]
  buffer_load_dwordx4 v236, s[16:19], s29 offen offset:0 lds
  v_mfma_f32_16x16x32_bf16 v[64:67], a[140:143], v[140:143], v[64:67]
  ds_read_b128 a[148:151], v213 offset:53248
  v_mfma_f32_16x16x32_bf16 v[72:75], a[140:143], v[156:159], v[196:199]
  v_mfma_f32_16x16x32_bf16 v[72:75], a[136:139], v[152:155], v[72:75]
  ds_read_b128 a[152:155], v214 offset:53248
  v_mfma_f32_16x16x32_bf16 v[72:75], a[132:135], v[148:151], v[72:75]
  buffer_load_dwordx4 v237, s[16:19], s29 offen offset:1024 lds
  v_mfma_f32_16x16x32_bf16 v[72:75], a[128:131], v[144:147], v[72:75]
  ds_read_b128 a[156:159], v215 offset:53248
  v_mfma_f32_16x16x32_bf16 v[80:83], a[128:131], v[160:163], v[200:203]
  v_exp_f32 v64, v64
  v_mfma_f32_16x16x32_bf16 v[80:83], a[132:135], v[164:167], v[80:83]
  v_mfma_f32_16x16x32_bf16 v[80:83], a[136:139], v[168:171], v[80:83]
  v_exp_f32 v65, v65
  v_mfma_f32_16x16x32_bf16 v[80:83], a[140:143], v[172:175], v[80:83]
  v_cvt_pk_bf16_f32 v64, v64, v65
  v_mfma_f32_16x16x32_bf16 v[88:91], a[140:143], v[188:191], v[204:207]
  v_exp_f32 v66, v66
  v_mfma_f32_16x16x32_bf16 v[88:91], a[136:139], v[184:187], v[88:91]
  buffer_load_dwordx4 v236, s[16:19], s29 offen offset:2048 lds
  v_mfma_f32_16x16x32_bf16 v[88:91], a[132:135], v[180:183], v[88:91]
  s_waitcnt lgkmcnt(0)
  v_exp_f32 v67, v67
  v_mfma_f32_16x16x32_bf16 v[88:91], a[128:131], v[176:179], v[88:91]
  v_cvt_pk_bf16_f32 v65, v66, v67
  v_mfma_f32_16x16x32_bf16 v[68:71], a[144:147], v[128:131], v[192:195]
  v_exp_f32 v72, v72
  v_mfma_f32_16x16x32_bf16 v[68:71], a[148:151], v[132:135], v[68:71]
  ds_read_b128 a[128:131], v212 offset:57344
  v_mfma_f32_16x16x32_bf16 v[68:71], a[152:155], v[136:139], v[68:71]
  v_exp_f32 v73, v73
  v_mfma_f32_16x16x32_bf16 v[68:71], a[156:159], v[140:143], v[68:71]
  ds_read_b128 a[132:135], v213 offset:57344
  v_cvt_pk_bf16_f32 v72, v72, v73
  v_mfma_f32_16x16x32_bf16 v[76:79], a[156:159], v[156:159], v[196:199]
  v_exp_f32 v74, v74
  v_mfma_f32_16x16x32_bf16 v[76:79], a[152:155], v[152:155], v[76:79]
  ds_read_b128 a[136:139], v214 offset:57344
  v_mfma_f32_16x16x32_bf16 v[76:79], a[148:151], v[148:151], v[76:79]
  v_exp_f32 v75, v75
  v_mfma_f32_16x16x32_bf16 v[76:79], a[144:147], v[144:147], v[76:79]
  ds_read_b128 a[140:143], v215 offset:57344
  v_cvt_pk_bf16_f32 v73, v74, v75
  v_mfma_f32_16x16x32_bf16 v[84:87], a[144:147], v[160:163], v[200:203]
  v_exp_f32 v80, v80
  v_mfma_f32_16x16x32_bf16 v[84:87], a[148:151], v[164:167], v[84:87]
  buffer_load_dwordx4 v237, s[16:19], s29 offen offset:3072 lds
  v_mfma_f32_16x16x32_bf16 v[84:87], a[152:155], v[168:171], v[84:87]
  s_add_u32 s29, s29, 16384
  v_exp_f32 v81, v81
  v_mfma_f32_16x16x32_bf16 v[84:87], a[156:159], v[172:175], v[84:87]
  v_cvt_pk_bf16_f32 v80, v80, v81
  v_mfma_f32_16x16x32_bf16 v[92:95], a[156:159], v[188:191], v[204:207]
  s_add_u32 m0, s28, 16384
  v_exp_f32 v82, v82
  v_mfma_f32_16x16x32_bf16 v[92:95], a[152:155], v[184:187], v[92:95]
  buffer_load_dwordx4 v232, s[12:15], s29 offen offset:0 lds
  v_mfma_f32_16x16x32_bf16 v[92:95], a[148:151], v[180:183], v[92:95]
  s_waitcnt lgkmcnt(0)
  v_exp_f32 v83, v83
  v_mfma_f32_16x16x32_bf16 v[92:95], a[144:147], v[176:179], v[92:95]
  v_cvt_pk_bf16_f32 v81, v82, v83
  v_mfma_f32_16x16x32_bf16 v[96:99], a[128:131], v[128:131], v[192:195]
  v_exp_f32 v88, v88
  v_mfma_f32_16x16x32_bf16 v[96:99], a[132:135], v[132:135], v[96:99]
  ds_read_b128 a[144:147], v212 offset:61440
  v_mfma_f32_16x16x32_bf16 v[96:99], a[136:139], v[136:139], v[96:99]
  v_exp_f32 v89, v89
  v_mfma_f32_16x16x32_bf16 v[96:99], a[140:143], v[140:143], v[96:99]
  ds_read_b128 a[148:151], v213 offset:61440
  v_cvt_pk_bf16_f32 v88, v88, v89
  v_mfma_f32_16x16x32_bf16 v[104:107], a[140:143], v[156:159], v[196:199]
  v_exp_f32 v90, v90
  v_mfma_f32_16x16x32_bf16 v[104:107], a[136:139], v[152:155], v[104:107]
  ds_read_b128 a[152:155], v214 offset:61440
  v_mfma_f32_16x16x32_bf16 v[104:107], a[132:135], v[148:151], v[104:107]
  v_exp_f32 v91, v91
  v_mfma_f32_16x16x32_bf16 v[104:107], a[128:131], v[144:147], v[104:107]
  ds_read_b128 a[156:159], v215 offset:61440
  v_cvt_pk_bf16_f32 v89, v90, v91
  v_mfma_f32_16x16x32_bf16 v[112:115], a[128:131], v[160:163], v[200:203]
  v_exp_f32 v68, v68
  v_mfma_f32_16x16x32_bf16 v[112:115], a[132:135], v[164:167], v[112:115]
  buffer_load_dwordx4 v233, s[12:15], s29 offen offset:1024 lds
  v_mfma_f32_16x16x32_bf16 v[112:115], a[136:139], v[168:171], v[112:115]
  v_exp_f32 v69, v69
  v_mfma_f32_16x16x32_bf16 v[112:115], a[140:143], v[172:175], v[112:115]
  v_cvt_pk_bf16_f32 v66, v68, v69
  v_mfma_f32_16x16x32_bf16 v[120:123], a[140:143], v[188:191], v[204:207]
  v_exp_f32 v70, v70
  v_mfma_f32_16x16x32_bf16 v[120:123], a[136:139], v[184:187], v[120:123]
  buffer_load_dwordx4 v234, s[12:15], s29 offen offset:2048 lds
  v_mfma_f32_16x16x32_bf16 v[120:123], a[132:135], v[180:183], v[120:123]
  s_waitcnt lgkmcnt(0)
  v_exp_f32 v71, v71
  v_mfma_f32_16x16x32_bf16 v[120:123], a[128:131], v[176:179], v[120:123]
  v_cvt_pk_bf16_f32 v67, v70, v71
  v_mfma_f32_16x16x32_bf16 v[100:103], a[144:147], v[128:131], v[192:195]
  v_exp_f32 v76, v76
  v_mfma_f32_16x16x32_bf16 v[100:103], a[148:151], v[132:135], v[100:103]
  ds_read_b64_tr_b16 a[160:161], v216 offset:32768
  v_mfma_f32_16x16x32_bf16 v[100:103], a[152:155], v[136:139], v[100:103]
  v_exp_f32 v77, v77
  v_mfma_f32_16x16x32_bf16 v[100:103], a[156:159], v[140:143], v[100:103]
  ds_read_b64_tr_b16 a[162:163], v216 offset:36864
  v_cvt_pk_bf16_f32 v74, v76, v77
  v_mfma_f32_16x16x32_bf16 v[108:111], a[156:159], v[156:159], v[196:199]
  v_exp_f32 v78, v78
  v_mfma_f32_16x16x32_bf16 v[108:111], a[152:155], v[152:155], v[108:111]
  ds_read_b64_tr_b16 a[164:165], v216 offset:40960
  buffer_load_dwordx4 v235, s[12:15], s29 offen offset:3072 lds
  v_mfma_f32_16x16x32_bf16 v[108:111], a[148:151], v[148:151], v[108:111]
  v_exp_f32 v79, v79
  v_mfma_f32_16x16x32_bf16 v[108:111], a[144:147], v[144:147], v[108:111]
  ds_read_b64_tr_b16 a[166:167], v216 offset:45056
  v_cvt_pk_bf16_f32 v75, v78, v79
  v_mfma_f32_16x16x32_bf16 v[116:119], a[144:147], v[160:163], v[200:203]
  v_exp_f32 v84, v84
  v_mfma_f32_16x16x32_bf16 v[116:119], a[148:151], v[164:167], v[116:119]
  ds_read_b64_tr_b16 a[168:169], v217 offset:32768
  s_add_u32 m0, s50, 4096
  v_mfma_f32_16x16x32_bf16 v[116:119], a[152:155], v[168:171], v[116:119]
  v_exp_f32 v85, v85
  v_mfma_f32_16x16x32_bf16 v[116:119], a[156:159], v[172:175], v[116:119]
  ds_read_b64_tr_b16 a[170:171], v217 offset:36864
  v_cvt_pk_bf16_f32 v82, v84, v85
  v_mfma_f32_16x16x32_bf16 v[124:127], a[156:159], v[188:191], v[204:207]
  v_exp_f32 v86, v86
  v_mfma_f32_16x16x32_bf16 v[124:127], a[152:155], v[184:187], v[124:127]
  ds_read_b64_tr_b16 a[172:173], v217 offset:40960
  buffer_load_dwordx4 v253, s[44:47], s35 offen lds
  s_add_u32 s35, s35, 221184
  v_mfma_f32_16x16x32_bf16 v[124:127], a[148:151], v[180:183], v[124:127]
  v_exp_f32 v87, v87
  v_mfma_f32_16x16x32_bf16 v[124:127], a[144:147], v[176:179], v[124:127]
  ds_read_b64_tr_b16 a[174:175], v217 offset:45056
  v_cvt_pk_bf16_f32 v83, v86, v87
  v_mfma_f32_16x16x32_bf16 a[192:195], a[208:211], v[0:3], a[192:195]
  v_exp_f32 v92, v92
  v_mfma_f32_16x16x32_bf16 a[192:195], a[208:211], v[32:35], a[192:195]
  ds_read_b64_tr_b16 a[176:177], v218 offset:32768
  v_lshrrev_b32 v254, 4, v242
  v_mfma_f32_16x16x32_bf16 a[196:199], a[208:211], v[8:11], a[196:199]
  v_exp_f32 v93, v93
  v_mfma_f32_16x16x32_bf16 a[196:199], a[208:211], v[40:43], a[196:199]
  ds_read_b64_tr_b16 a[178:179], v218 offset:36864
  v_cvt_pk_bf16_f32 v90, v92, v93
  v_mfma_f32_16x16x32_bf16 a[200:203], a[208:211], v[16:19], a[200:203]
  v_exp_f32 v94, v94
  v_mfma_f32_16x16x32_bf16 a[200:203], a[208:211], v[48:51], a[200:203]
  ds_read_b64_tr_b16 a[180:181], v218 offset:40960
  v_lshrrev_b32 v254, 5, v254
  v_mfma_f32_16x16x32_bf16 a[204:207], a[208:211], v[24:27], a[204:207]
  s_waitcnt lgkmcnt(7)
  v_exp_f32 v95, v95
  v_mfma_f32_16x16x32_bf16 a[204:207], a[208:211], v[56:59], a[204:207]
  ds_read_b64_tr_b16 a[182:183], v218 offset:45056
  v_cvt_pk_bf16_f32 v91, v94, v95
  v_mfma_f32_16x16x32_bf16 a[0:3], a[160:163], v[0:3], a[0:3]
  v_exp_f32 v96, v96
  v_mfma_f32_16x16x32_bf16 a[0:3], a[164:167], v[32:35], a[0:3]
  ds_read_b64_tr_b16 a[184:185], v219 offset:32768
  v_lshl_add_u32 v253, v254, 30, v253
  v_mfma_f32_16x16x32_bf16 a[4:7], a[164:167], v[40:43], a[4:7]
  v_exp_f32 v97, v97
  v_mfma_f32_16x16x32_bf16 a[4:7], a[160:163], v[8:11], a[4:7]
  ds_read_b64_tr_b16 a[186:187], v219 offset:36864
  v_cvt_pk_bf16_f32 v96, v96, v97
  v_mfma_f32_16x16x32_bf16 a[8:11], a[160:163], v[16:19], a[8:11]
  v_exp_f32 v98, v98
  v_mfma_f32_16x16x32_bf16 a[8:11], a[164:167], v[48:51], a[8:11]
  ds_read_b64_tr_b16 a[188:189], v219 offset:40960
  v_mfma_f32_16x16x32_bf16 a[12:15], a[164:167], v[56:59], a[12:15]
  s_waitcnt lgkmcnt(7)
  v_exp_f32 v99, v99
  v_mfma_f32_16x16x32_bf16 a[12:15], a[160:163], v[24:27], a[12:15]
  ds_read_b64_tr_b16 a[190:191], v219 offset:45056
  v_cvt_pk_bf16_f32 v97, v98, v99
  v_mfma_f32_16x16x32_bf16 a[16:19], a[168:171], v[0:3], a[16:19]
  v_exp_f32 v104, v104
  v_mfma_f32_16x16x32_bf16 a[16:19], a[172:175], v[32:35], a[16:19]
  ds_read_b64_tr_b16 a[160:161], v220 offset:32768
  v_mfma_f32_16x16x32_bf16 a[20:23], a[172:175], v[40:43], a[20:23]
  v_exp_f32 v105, v105
  v_mfma_f32_16x16x32_bf16 a[20:23], a[168:171], v[8:11], a[20:23]
  ds_read_b64_tr_b16 a[162:163], v220 offset:36864
  v_cvt_pk_bf16_f32 v104, v104, v105
  v_mfma_f32_16x16x32_bf16 a[24:27], a[168:171], v[16:19], a[24:27]
  v_exp_f32 v106, v106
  v_mfma_f32_16x16x32_bf16 a[24:27], a[172:175], v[48:51], a[24:27]
  ds_read_b64_tr_b16 a[164:165], v220 offset:40960
  v_mfma_f32_16x16x32_bf16 a[28:31], a[172:175], v[56:59], a[28:31]
  s_waitcnt lgkmcnt(7)
  v_exp_f32 v107, v107
  v_mfma_f32_16x16x32_bf16 a[28:31], a[168:171], v[24:27], a[28:31]
  ds_read_b64_tr_b16 a[166:167], v220 offset:45056
  v_cvt_pk_bf16_f32 v105, v106, v107
  v_mfma_f32_16x16x32_bf16 a[32:35], a[176:179], v[0:3], a[32:35]
  v_exp_f32 v112, v112
  v_mfma_f32_16x16x32_bf16 a[32:35], a[180:183], v[32:35], a[32:35]
  ds_read_b64_tr_b16 a[168:169], v221 offset:32768
  v_mfma_f32_16x16x32_bf16 a[36:39], a[180:183], v[40:43], a[36:39]
  v_exp_f32 v113, v113
  v_mfma_f32_16x16x32_bf16 a[36:39], a[176:179], v[8:11], a[36:39]
  ds_read_b64_tr_b16 a[170:171], v221 offset:36864
  v_cvt_pk_bf16_f32 v112, v112, v113
  v_mfma_f32_16x16x32_bf16 a[40:43], a[176:179], v[16:19], a[40:43]
  v_exp_f32 v114, v114
  v_mfma_f32_16x16x32_bf16 a[40:43], a[180:183], v[48:51], a[40:43]
  ds_read_b64_tr_b16 a[172:173], v221 offset:40960
  v_mfma_f32_16x16x32_bf16 a[44:47], a[180:183], v[56:59], a[44:47]
  s_waitcnt lgkmcnt(7)
  v_exp_f32 v115, v115
  v_mfma_f32_16x16x32_bf16 a[44:47], a[176:179], v[24:27], a[44:47]
  ds_read_b64_tr_b16 a[174:175], v221 offset:45056
  v_cvt_pk_bf16_f32 v113, v114, v115
  v_mfma_f32_16x16x32_bf16 a[48:51], a[184:187], v[0:3], a[48:51]
  v_exp_f32 v120, v120
  v_mfma_f32_16x16x32_bf16 a[48:51], a[188:191], v[32:35], a[48:51]
  ds_read_b64_tr_b16 a[176:177], v222 offset:32768
  v_mfma_f32_16x16x32_bf16 a[52:55], a[188:191], v[40:43], a[52:55]
  v_exp_f32 v121, v121
  v_mfma_f32_16x16x32_bf16 a[52:55], a[184:187], v[8:11], a[52:55]
  ds_read_b64_tr_b16 a[178:179], v222 offset:36864
  v_cvt_pk_bf16_f32 v120, v120, v121
  v_mfma_f32_16x16x32_bf16 a[56:59], a[184:187], v[16:19], a[56:59]
  v_exp_f32 v122, v122
  v_mfma_f32_16x16x32_bf16 a[56:59], a[188:191], v[48:51], a[56:59]
  ds_read_b64_tr_b16 a[180:181], v222 offset:40960
  v_mfma_f32_16x16x32_bf16 a[60:63], a[188:191], v[56:59], a[60:63]
  s_waitcnt lgkmcnt(7)
  v_exp_f32 v123, v123
  v_mfma_f32_16x16x32_bf16 a[60:63], a[184:187], v[24:27], a[60:63]
  ds_read_b64_tr_b16 a[182:183], v222 offset:45056
  v_cvt_pk_bf16_f32 v121, v122, v123
  v_mfma_f32_16x16x32_bf16 a[64:67], a[160:163], v[0:3], a[64:67]
  v_exp_f32 v100, v100
  v_mfma_f32_16x16x32_bf16 a[64:67], a[164:167], v[32:35], a[64:67]
  ds_read_b64_tr_b16 a[184:185], v223 offset:32768
  v_mfma_f32_16x16x32_bf16 a[68:71], a[164:167], v[40:43], a[68:71]
  v_exp_f32 v101, v101
  v_mfma_f32_16x16x32_bf16 a[68:71], a[160:163], v[8:11], a[68:71]
  ds_read_b64_tr_b16 a[186:187], v223 offset:36864
  v_cvt_pk_bf16_f32 v98, v100, v101
  v_mfma_f32_16x16x32_bf16 a[72:75], a[160:163], v[16:19], a[72:75]
  v_exp_f32 v102, v102
  v_mfma_f32_16x16x32_bf16 a[72:75], a[164:167], v[48:51], a[72:75]
  ds_read_b64_tr_b16 a[188:189], v223 offset:40960
  v_mfma_f32_16x16x32_bf16 a[76:79], a[164:167], v[56:59], a[76:79]
  s_waitcnt lgkmcnt(7)
  v_exp_f32 v103, v103
  v_mfma_f32_16x16x32_bf16 a[76:79], a[160:163], v[24:27], a[76:79]
  ds_read_b64_tr_b16 a[190:191], v223 offset:45056
  v_cvt_pk_bf16_f32 v99, v102, v103
  v_mfma_f32_16x16x32_bf16 a[80:83], a[168:171], v[0:3], a[80:83]
  s_waitcnt vmcnt(11)
  v_exp_f32 v108, v108
  v_mfma_f32_16x16x32_bf16 a[80:83], a[172:175], v[32:35], a[80:83]
  v_mfma_f32_16x16x32_bf16 a[84:87], a[172:175], v[40:43], a[84:87]
  s_barrier
  v_exp_f32 v109, v109
  v_mfma_f32_16x16x32_bf16 a[84:87], a[168:171], v[8:11], a[84:87]
  ds_read_b128 a[128:131], v212 offset:0
  v_cvt_pk_bf16_f32 v106, v108, v109
  v_mfma_f32_16x16x32_bf16 a[88:91], a[168:171], v[16:19], a[88:91]
  v_exp_f32 v110, v110
  v_mfma_f32_16x16x32_bf16 a[88:91], a[172:175], v[48:51], a[88:91]
  ds_read_b128 a[132:135], v213 offset:0
  v_mfma_f32_16x16x32_bf16 a[92:95], a[172:175], v[56:59], a[92:95]
  s_waitcnt lgkmcnt(6)
  v_exp_f32 v111, v111
  v_mfma_f32_16x16x32_bf16 a[92:95], a[168:171], v[24:27], a[92:95]
  ds_read_b128 a[136:139], v214 offset:0
  v_cvt_pk_bf16_f32 v107, v110, v111
  v_mfma_f32_16x16x32_bf16 a[96:99], a[176:179], v[0:3], a[96:99]
  v_exp_f32 v116, v116
  v_mfma_f32_16x16x32_bf16 a[96:99], a[180:183], v[32:35], a[96:99]
  ds_read_b128 a[140:143], v215 offset:0
  buffer_load_dwordx4 a[220:223], v243, s[24:27], s38 offen sc1
  s_add_u32 s38, s38, 4096
  v_mfma_f32_16x16x32_bf16 a[100:103], a[180:183], v[40:43], a[100:103]
  v_exp_f32 v117, v117
  v_mfma_f32_16x16x32_bf16 a[100:103], a[176:179], v[8:11], a[100:103]
  v_cvt_pk_bf16_f32 v114, v116, v117
  v_mfma_f32_16x16x32_bf16 a[104:107], a[176:179], v[16:19], a[104:107]
  v_exp_f32 v118, v118
  v_mfma_f32_16x16x32_bf16 a[104:107], a[180:183], v[48:51], a[104:107]
  v_mfma_f32_16x16x32_bf16 a[108:111], a[180:183], v[56:59], a[108:111]
  s_waitcnt lgkmcnt(4)
  v_exp_f32 v119, v119
  v_mfma_f32_16x16x32_bf16 a[108:111], a[176:179], v[24:27], a[108:111]
  v_cvt_pk_bf16_f32 v115, v118, v119
  v_mfma_f32_16x16x32_bf16 a[112:115], a[184:187], v[0:3], a[112:115]
  v_exp_f32 v124, v124
  v_mfma_f32_16x16x32_bf16 a[112:115], a[188:191], v[32:35], a[112:115]
  v_mfma_f32_16x16x32_bf16 a[116:119], a[188:191], v[40:43], a[116:119]
  v_exp_f32 v125, v125
  v_mfma_f32_16x16x32_bf16 a[116:119], a[184:187], v[8:11], a[116:119]
  v_cvt_pk_bf16_f32 v122, v124, v125
  v_mfma_f32_16x16x32_bf16 a[120:123], a[184:187], v[16:19], a[120:123]
  v_exp_f32 v126, v126
  v_mfma_f32_16x16x32_bf16 a[120:123], a[188:191], v[48:51], a[120:123]
  v_mfma_f32_16x16x32_bf16 a[124:127], a[188:191], v[56:59], a[124:127]
  s_waitcnt lgkmcnt(0)
  v_exp_f32 v127, v127
  v_mfma_f32_16x16x32_bf16 a[124:127], a[184:187], v[24:27], a[124:127]
  v_cvt_pk_bf16_f32 v123, v126, v127
  v_mfma_f32_16x16x32_bf16 v[0:3], a[128:131], v[128:131], v[192:195]
  s_add_u32 m0, s28, 81920
  v_mfma_f32_16x16x32_bf16 v[0:3], a[132:135], v[132:135], v[0:3]
  ds_read_b128 a[144:147], v212 offset:4096
  v_mfma_f32_16x16x32_bf16 v[0:3], a[136:139], v[136:139], v[0:3]
  buffer_load_dwordx4 v236, s[16:19], s29 offen offset:0 lds
  v_mfma_f32_16x16x32_bf16 v[0:3], a[140:143], v[140:143], v[0:3]
  ds_read_b128 a[148:151], v213 offset:4096
  v_mfma_f32_16x16x32_bf16 v[8:11], a[140:143], v[156:159], v[196:199]
  v_mfma_f32_16x16x32_bf16 v[8:11], a[136:139], v[152:155], v[8:11]
  ds_read_b128 a[152:155], v214 offset:4096
  v_mfma_f32_16x16x32_bf16 v[8:11], a[132:135], v[148:151], v[8:11]
  buffer_load_dwordx4 v237, s[16:19], s29 offen offset:1024 lds
  v_mfma_f32_16x16x32_bf16 v[8:11], a[128:131], v[144:147], v[8:11]
  ds_read_b128 a[156:159], v215 offset:4096
  v_mfma_f32_16x16x32_bf16 v[16:19], a[128:131], v[160:163], v[200:203]
  v_exp_f32 v0, v0
  v_mfma_f32_16x16x32_bf16 v[16:19], a[132:135], v[164:167], v[16:19]
  v_mfma_f32_16x16x32_bf16 v[16:19], a[136:139], v[168:171], v[16:19]
  v_exp_f32 v1, v1
  v_mfma_f32_16x16x32_bf16 v[16:19], a[140:143], v[172:175], v[16:19]
  v_cvt_pk_bf16_f32 v0, v0, v1
  v_mfma_f32_16x16x32_bf16 v[24:27], a[140:143], v[188:191], v[204:207]
  v_exp_f32 v2, v2
  v_mfma_f32_16x16x32_bf16 v[24:27], a[136:139], v[184:187], v[24:27]
  buffer_load_dwordx4 v236, s[16:19], s29 offen offset:2048 lds
  v_mfma_f32_16x16x32_bf16 v[24:27], a[132:135], v[180:183], v[24:27]
  s_waitcnt lgkmcnt(0)
  v_exp_f32 v3, v3
  v_mfma_f32_16x16x32_bf16 v[24:27], a[128:131], v[176:179], v[24:27]
  v_cvt_pk_bf16_f32 v1, v2, v3
  v_mfma_f32_16x16x32_bf16 v[4:7], a[144:147], v[128:131], v[192:195]
  v_exp_f32 v8, v8
  v_mfma_f32_16x16x32_bf16 v[4:7], a[148:151], v[132:135], v[4:7]
  ds_read_b128 a[128:131], v212 offset:8192
  v_mfma_f32_16x16x32_bf16 v[4:7], a[152:155], v[136:139], v[4:7]
  v_exp_f32 v9, v9
  v_mfma_f32_16x16x32_bf16 v[4:7], a[156:159], v[140:143], v[4:7]
  ds_read_b128 a[132:135], v213 offset:8192
  v_cvt_pk_bf16_f32 v8, v8, v9
  v_mfma_f32_16x16x32_bf16 v[12:15], a[156:159], v[156:159], v[196:199]
  v_exp_f32 v10, v10
  v_mfma_f32_16x16x32_bf16 v[12:15], a[152:155], v[152:155], v[12:15]
  ds_read_b128 a[136:139], v214 offset:8192
  v_mfma_f32_16x16x32_bf16 v[12:15], a[148:151], v[148:151], v[12:15]
  v_exp_f32 v11, v11
  v_mfma_f32_16x16x32_bf16 v[12:15], a[144:147], v[144:147], v[12:15]
  ds_read_b128 a[140:143], v215 offset:8192
  v_cvt_pk_bf16_f32 v9, v10, v11
  v_mfma_f32_16x16x32_bf16 v[20:23], a[144:147], v[160:163], v[200:203]
  v_exp_f32 v16, v16
  v_mfma_f32_16x16x32_bf16 v[20:23], a[148:151], v[164:167], v[20:23]
  buffer_load_dwordx4 v237, s[16:19], s29 offen offset:3072 lds
  v_mfma_f32_16x16x32_bf16 v[20:23], a[152:155], v[168:171], v[20:23]
  s_add_u32 s29, s29, 16384
  v_exp_f32 v17, v17
  v_mfma_f32_16x16x32_bf16 v[20:23], a[156:159], v[172:175], v[20:23]
  v_cvt_pk_bf16_f32 v16, v16, v17
  v_mfma_f32_16x16x32_bf16 v[28:31], a[156:159], v[188:191], v[204:207]
  s_add_u32 m0, s28, 32768
  v_exp_f32 v18, v18
  v_mfma_f32_16x16x32_bf16 v[28:31], a[152:155], v[184:187], v[28:31]
  buffer_load_dwordx4 v232, s[12:15], s29 offen offset:0 lds
  v_mfma_f32_16x16x32_bf16 v[28:31], a[148:151], v[180:183], v[28:31]
  s_waitcnt lgkmcnt(0)
  v_exp_f32 v19, v19
  v_mfma_f32_16x16x32_bf16 v[28:31], a[144:147], v[176:179], v[28:31]
  v_cvt_pk_bf16_f32 v17, v18, v19
  v_mfma_f32_16x16x32_bf16 v[32:35], a[128:131], v[128:131], v[192:195]
  v_exp_f32 v24, v24
  v_mfma_f32_16x16x32_bf16 v[32:35], a[132:135], v[132:135], v[32:35]
  ds_read_b128 a[144:147], v212 offset:12288
  v_mfma_f32_16x16x32_bf16 v[32:35], a[136:139], v[136:139], v[32:35]
  v_exp_f32 v25, v25
  v_mfma_f32_16x16x32_bf16 v[32:35], a[140:143], v[140:143], v[32:35]
  ds_read_b128 a[148:151], v213 offset:12288
  v_cvt_pk_bf16_f32 v24, v24, v25
  v_mfma_f32_16x16x32_bf16 v[40:43], a[140:143], v[156:159], v[196:199]
  v_exp_f32 v26, v26
  v_mfma_f32_16x16x32_bf16 v[40:43], a[136:139], v[152:155], v[40:43]
  ds_read_b128 a[152:155], v214 offset:12288
  v_mfma_f32_16x16x32_bf16 v[40:43], a[132:135], v[148:151], v[40:43]
  v_exp_f32 v27, v27
  v_mfma_f32_16x16x32_bf16 v[40:43], a[128:131], v[144:147], v[40:43]
  ds_read_b128 a[156:159], v215 offset:12288
  v_cvt_pk_bf16_f32 v25, v26, v27
  v_mfma_f32_16x16x32_bf16 v[48:51], a[128:131], v[160:163], v[200:203]
  v_exp_f32 v4, v4
  v_mfma_f32_16x16x32_bf16 v[48:51], a[132:135], v[164:167], v[48:51]
  buffer_load_dwordx4 v233, s[12:15], s29 offen offset:1024 lds
  v_mfma_f32_16x16x32_bf16 v[48:51], a[136:139], v[168:171], v[48:51]
  v_exp_f32 v5, v5
  v_mfma_f32_16x16x32_bf16 v[48:51], a[140:143], v[172:175], v[48:51]
  v_cvt_pk_bf16_f32 v2, v4, v5
  v_mfma_f32_16x16x32_bf16 v[56:59], a[140:143], v[188:191], v[204:207]
  v_exp_f32 v6, v6
  v_mfma_f32_16x16x32_bf16 v[56:59], a[136:139], v[184:187], v[56:59]
  buffer_load_dwordx4 v234, s[12:15], s29 offen offset:2048 lds
  v_mfma_f32_16x16x32_bf16 v[56:59], a[132:135], v[180:183], v[56:59]
  s_waitcnt lgkmcnt(0)
  v_exp_f32 v7, v7
  v_mfma_f32_16x16x32_bf16 v[56:59], a[128:131], v[176:179], v[56:59]
  v_cvt_pk_bf16_f32 v3, v6, v7
  v_mfma_f32_16x16x32_bf16 v[36:39], a[144:147], v[128:131], v[192:195]
  v_exp_f32 v12, v12
  v_mfma_f32_16x16x32_bf16 v[36:39], a[148:151], v[132:135], v[36:39]
  ds_read_b64_tr_b16 a[160:161], v216 offset:49152
  v_mfma_f32_16x16x32_bf16 v[36:39], a[152:155], v[136:139], v[36:39]
  v_exp_f32 v13, v13
  v_mfma_f32_16x16x32_bf16 v[36:39], a[156:159], v[140:143], v[36:39]
  ds_read_b64_tr_b16 a[162:163], v216 offset:53248
  v_cvt_pk_bf16_f32 v10, v12, v13
  v_mfma_f32_16x16x32_bf16 v[44:47], a[156:159], v[156:159], v[196:199]
  v_exp_f32 v14, v14
  v_mfma_f32_16x16x32_bf16 v[44:47], a[152:155], v[152:155], v[44:47]
  ds_read_b64_tr_b16 a[164:165], v216 offset:57344
  buffer_load_dwordx4 v235, s[12:15], s29 offen offset:3072 lds
  v_mfma_f32_16x16x32_bf16 v[44:47], a[148:151], v[148:151], v[44:47]
  v_exp_f32 v15, v15
  v_mfma_f32_16x16x32_bf16 v[44:47], a[144:147], v[144:147], v[44:47]
  ds_read_b64_tr_b16 a[166:167], v216 offset:61440
  v_cvt_pk_bf16_f32 v11, v14, v15
  v_mfma_f32_16x16x32_bf16 v[52:55], a[144:147], v[160:163], v[200:203]
  v_exp_f32 v20, v20
  v_mfma_f32_16x16x32_bf16 v[52:55], a[148:151], v[164:167], v[52:55]
  ds_read_b64_tr_b16 a[168:169], v217 offset:49152
  s_add_u32 m0, s50, 2048
  v_mfma_f32_16x16x32_bf16 v[52:55], a[152:155], v[168:171], v[52:55]
  v_exp_f32 v21, v21
  v_mfma_f32_16x16x32_bf16 v[52:55], a[156:159], v[172:175], v[52:55]
  ds_read_b64_tr_b16 a[170:171], v217 offset:53248
  v_cvt_pk_bf16_f32 v18, v20, v21
  v_mfma_f32_16x16x32_bf16 v[60:63], a[156:159], v[188:191], v[204:207]
  v_exp_f32 v22, v22
  v_mfma_f32_16x16x32_bf16 v[60:63], a[152:155], v[184:187], v[60:63]
  ds_read_b64_tr_b16 a[172:173], v217 offset:57344
  buffer_load_dwordx4 v253, s[20:23], s35 offen lds
  v_mfma_f32_16x16x32_bf16 v[60:63], a[148:151], v[180:183], v[60:63]
  v_exp_f32 v23, v23
  v_mfma_f32_16x16x32_bf16 v[60:63], a[144:147], v[176:179], v[60:63]
  ds_read_b64_tr_b16 a[174:175], v217 offset:61440
  v_cvt_pk_bf16_f32 v19, v22, v23
  v_mfma_f32_16x16x32_bf16 a[192:195], a[208:211], v[64:67], a[192:195]
  v_exp_f32 v28, v28
  v_mfma_f32_16x16x32_bf16 a[192:195], a[208:211], v[96:99], a[192:195]
  ds_read_b64_tr_b16 a[176:177], v218 offset:49152
  v_mfma_f32_16x16x32_bf16 a[196:199], a[208:211], v[72:75], a[196:199]
  v_exp_f32 v29, v29
  v_mfma_f32_16x16x32_bf16 a[196:199], a[208:211], v[104:107], a[196:199]
  ds_read_b64_tr_b16 a[178:179], v218 offset:53248
  v_cvt_pk_bf16_f32 v26, v28, v29
  v_mfma_f32_16x16x32_bf16 a[200:203], a[208:211], v[80:83], a[200:203]
  v_exp_f32 v30, v30
  v_mfma_f32_16x16x32_bf16 a[200:203], a[208:211], v[112:115], a[200:203]
  ds_read_b64_tr_b16 a[180:181], v218 offset:57344
  v_mfma_f32_16x16x32_bf16 a[204:207], a[208:211], v[88:91], a[204:207]
  s_waitcnt lgkmcnt(7)
  v_exp_f32 v31, v31
  v_mfma_f32_16x16x32_bf16 a[204:207], a[208:211], v[120:123], a[204:207]
  ds_read_b64_tr_b16 a[182:183], v218 offset:61440
  v_cvt_pk_bf16_f32 v27, v30, v31
  v_mfma_f32_16x16x32_bf16 a[0:3], a[160:163], v[64:67], a[0:3]
  v_exp_f32 v32, v32
  v_mfma_f32_16x16x32_bf16 a[0:3], a[164:167], v[96:99], a[0:3]
  ds_read_b64_tr_b16 a[184:185], v219 offset:49152
  v_mfma_f32_16x16x32_bf16 a[4:7], a[164:167], v[104:107], a[4:7]
  v_exp_f32 v33, v33
  v_mfma_f32_16x16x32_bf16 a[4:7], a[160:163], v[72:75], a[4:7]
  ds_read_b64_tr_b16 a[186:187], v219 offset:53248
  v_cvt_pk_bf16_f32 v32, v32, v33
  v_mfma_f32_16x16x32_bf16 a[8:11], a[160:163], v[80:83], a[8:11]
  v_exp_f32 v34, v34
  v_mfma_f32_16x16x32_bf16 a[8:11], a[164:167], v[112:115], a[8:11]
  ds_read_b64_tr_b16 a[188:189], v219 offset:57344
  v_mfma_f32_16x16x32_bf16 a[12:15], a[164:167], v[120:123], a[12:15]
  s_waitcnt lgkmcnt(7)
  v_exp_f32 v35, v35
  v_mfma_f32_16x16x32_bf16 a[12:15], a[160:163], v[88:91], a[12:15]
  ds_read_b64_tr_b16 a[190:191], v219 offset:61440
  v_cvt_pk_bf16_f32 v33, v34, v35
  v_mfma_f32_16x16x32_bf16 a[16:19], a[168:171], v[64:67], a[16:19]
  v_exp_f32 v40, v40
  v_mfma_f32_16x16x32_bf16 a[16:19], a[172:175], v[96:99], a[16:19]
  ds_read_b64_tr_b16 a[160:161], v220 offset:49152
  v_mfma_f32_16x16x32_bf16 a[20:23], a[172:175], v[104:107], a[20:23]
  v_exp_f32 v41, v41
  v_mfma_f32_16x16x32_bf16 a[20:23], a[168:171], v[72:75], a[20:23]
  ds_read_b64_tr_b16 a[162:163], v220 offset:53248
  v_cvt_pk_bf16_f32 v40, v40, v41
  v_mfma_f32_16x16x32_bf16 a[24:27], a[168:171], v[80:83], a[24:27]
  v_exp_f32 v42, v42
  v_mfma_f32_16x16x32_bf16 a[24:27], a[172:175], v[112:115], a[24:27]
  ds_read_b64_tr_b16 a[164:165], v220 offset:57344
  v_mfma_f32_16x16x32_bf16 a[28:31], a[172:175], v[120:123], a[28:31]
  s_waitcnt lgkmcnt(7)
  v_exp_f32 v43, v43
  v_mfma_f32_16x16x32_bf16 a[28:31], a[168:171], v[88:91], a[28:31]
  ds_read_b64_tr_b16 a[166:167], v220 offset:61440
  v_cvt_pk_bf16_f32 v41, v42, v43
  v_mfma_f32_16x16x32_bf16 a[32:35], a[176:179], v[64:67], a[32:35]
  v_exp_f32 v48, v48
  v_mfma_f32_16x16x32_bf16 a[32:35], a[180:183], v[96:99], a[32:35]
  ds_read_b64_tr_b16 a[168:169], v221 offset:49152
  v_mfma_f32_16x16x32_bf16 a[36:39], a[180:183], v[104:107], a[36:39]
  v_exp_f32 v49, v49
  v_mfma_f32_16x16x32_bf16 a[36:39], a[176:179], v[72:75], a[36:39]
  ds_read_b64_tr_b16 a[170:171], v221 offset:53248
  v_cvt_pk_bf16_f32 v48, v48, v49
  v_mfma_f32_16x16x32_bf16 a[40:43], a[176:179], v[80:83], a[40:43]
  v_exp_f32 v50, v50
  v_mfma_f32_16x16x32_bf16 a[40:43], a[180:183], v[112:115], a[40:43]
  ds_read_b64_tr_b16 a[172:173], v221 offset:57344
  v_mfma_f32_16x16x32_bf16 a[44:47], a[180:183], v[120:123], a[44:47]
  s_waitcnt lgkmcnt(7)
  v_exp_f32 v51, v51
  v_mfma_f32_16x16x32_bf16 a[44:47], a[176:179], v[88:91], a[44:47]
  ds_read_b64_tr_b16 a[174:175], v221 offset:61440
  v_cvt_pk_bf16_f32 v49, v50, v51
  v_mfma_f32_16x16x32_bf16 a[48:51], a[184:187], v[64:67], a[48:51]
  v_exp_f32 v56, v56
  v_mfma_f32_16x16x32_bf16 a[48:51], a[188:191], v[96:99], a[48:51]
  ds_read_b64_tr_b16 a[176:177], v222 offset:49152
  v_mfma_f32_16x16x32_bf16 a[52:55], a[188:191], v[104:107], a[52:55]
  v_exp_f32 v57, v57
  v_mfma_f32_16x16x32_bf16 a[52:55], a[184:187], v[72:75], a[52:55]
  ds_read_b64_tr_b16 a[178:179], v222 offset:53248
  v_cvt_pk_bf16_f32 v56, v56, v57
  v_mfma_f32_16x16x32_bf16 a[56:59], a[184:187], v[80:83], a[56:59]
  v_exp_f32 v58, v58
  v_mfma_f32_16x16x32_bf16 a[56:59], a[188:191], v[112:115], a[56:59]
  ds_read_b64_tr_b16 a[180:181], v222 offset:57344
  v_mfma_f32_16x16x32_bf16 a[60:63], a[188:191], v[120:123], a[60:63]
  s_waitcnt lgkmcnt(7)
  v_exp_f32 v59, v59
  v_mfma_f32_16x16x32_bf16 a[60:63], a[184:187], v[88:91], a[60:63]
  ds_read_b64_tr_b16 a[182:183], v222 offset:61440
  v_cvt_pk_bf16_f32 v57, v58, v59
  v_mfma_f32_16x16x32_bf16 a[64:67], a[160:163], v[64:67], a[64:67]
  v_exp_f32 v36, v36
  v_mfma_f32_16x16x32_bf16 a[64:67], a[164:167], v[96:99], a[64:67]
  ds_read_b64_tr_b16 a[184:185], v223 offset:49152
  v_mfma_f32_16x16x32_bf16 a[68:71], a[164:167], v[104:107], a[68:71]
  v_exp_f32 v37, v37
  v_mfma_f32_16x16x32_bf16 a[68:71], a[160:163], v[72:75], a[68:71]
  ds_read_b64_tr_b16 a[186:187], v223 offset:53248
  v_cvt_pk_bf16_f32 v34, v36, v37
  v_mfma_f32_16x16x32_bf16 a[72:75], a[160:163], v[80:83], a[72:75]
  v_exp_f32 v38, v38
  v_mfma_f32_16x16x32_bf16 a[72:75], a[164:167], v[112:115], a[72:75]
  ds_read_b64_tr_b16 a[188:189], v223 offset:57344
  v_mfma_f32_16x16x32_bf16 a[76:79], a[164:167], v[120:123], a[76:79]
  s_waitcnt lgkmcnt(7)
  v_exp_f32 v39, v39
  v_mfma_f32_16x16x32_bf16 a[76:79], a[160:163], v[88:91], a[76:79]
  ds_read_b64_tr_b16 a[190:191], v223 offset:61440
  v_cvt_pk_bf16_f32 v35, v38, v39
  v_mfma_f32_16x16x32_bf16 a[80:83], a[168:171], v[64:67], a[80:83]
  s_waitcnt vmcnt(11)
  v_exp_f32 v44, v44
  v_mfma_f32_16x16x32_bf16 a[80:83], a[172:175], v[96:99], a[80:83]
  v_mfma_f32_16x16x32_bf16 a[84:87], a[172:175], v[104:107], a[84:87]
  s_barrier
  v_exp_f32 v45, v45
  v_mfma_f32_16x16x32_bf16 a[84:87], a[168:171], v[72:75], a[84:87]
  ds_read_b128 a[128:131], v212 offset:16384
  v_cvt_pk_bf16_f32 v42, v44, v45
  v_mfma_f32_16x16x32_bf16 a[88:91], a[168:171], v[80:83], a[88:91]
  v_exp_f32 v46, v46
  v_mfma_f32_16x16x32_bf16 a[88:91], a[172:175], v[112:115], a[88:91]
  ds_read_b128 a[132:135], v213 offset:16384
  v_mfma_f32_16x16x32_bf16 a[92:95], a[172:175], v[120:123], a[92:95]
  s_waitcnt lgkmcnt(6)
  v_exp_f32 v47, v47
  v_mfma_f32_16x16x32_bf16 a[92:95], a[168:171], v[88:91], a[92:95]
  ds_read_b128 a[136:139], v214 offset:16384
  v_cvt_pk_bf16_f32 v43, v46, v47
  v_mfma_f32_16x16x32_bf16 a[96:99], a[176:179], v[64:67], a[96:99]
  v_exp_f32 v52, v52
  v_mfma_f32_16x16x32_bf16 a[96:99], a[180:183], v[96:99], a[96:99]
  ds_read_b128 a[140:143], v215 offset:16384
  buffer_load_dwordx4 a[224:227], v243, s[24:27], s38 offen sc1
  s_add_u32 s38, s38, 4096
  v_mfma_f32_16x16x32_bf16 a[100:103], a[180:183], v[104:107], a[100:103]
  v_exp_f32 v53, v53
  v_mfma_f32_16x16x32_bf16 a[100:103], a[176:179], v[72:75], a[100:103]
  v_cvt_pk_bf16_f32 v50, v52, v53
  v_mfma_f32_16x16x32_bf16 a[104:107], a[176:179], v[80:83], a[104:107]
  v_exp_f32 v54, v54
  v_mfma_f32_16x16x32_bf16 a[104:107], a[180:183], v[112:115], a[104:107]
  v_mfma_f32_16x16x32_bf16 a[108:111], a[180:183], v[120:123], a[108:111]
  s_waitcnt lgkmcnt(4)
  v_exp_f32 v55, v55
  v_mfma_f32_16x16x32_bf16 a[108:111], a[176:179], v[88:91], a[108:111]
  v_cvt_pk_bf16_f32 v51, v54, v55
  v_mfma_f32_16x16x32_bf16 a[112:115], a[184:187], v[64:67], a[112:115]
  v_exp_f32 v60, v60
  v_mfma_f32_16x16x32_bf16 a[112:115], a[188:191], v[96:99], a[112:115]
  v_mfma_f32_16x16x32_bf16 a[116:119], a[188:191], v[104:107], a[116:119]
  v_exp_f32 v61, v61
  v_mfma_f32_16x16x32_bf16 a[116:119], a[184:187], v[72:75], a[116:119]
  v_cvt_pk_bf16_f32 v58, v60, v61
  v_mfma_f32_16x16x32_bf16 a[120:123], a[184:187], v[80:83], a[120:123]
  v_exp_f32 v62, v62
  v_mfma_f32_16x16x32_bf16 a[120:123], a[188:191], v[112:115], a[120:123]
  v_mfma_f32_16x16x32_bf16 a[124:127], a[188:191], v[120:123], a[124:127]
  s_waitcnt lgkmcnt(0)
  v_exp_f32 v63, v63
  v_mfma_f32_16x16x32_bf16 a[124:127], a[184:187], v[88:91], a[124:127]
  v_cvt_pk_bf16_f32 v59, v62, v63
  v_mfma_f32_16x16x32_bf16 v[64:67], a[128:131], v[128:131], v[192:195]
  s_add_u32 m0, s28, 98304
  v_mfma_f32_16x16x32_bf16 v[64:67], a[132:135], v[132:135], v[64:67]
  ds_read_b128 a[144:147], v212 offset:20480
  v_mfma_f32_16x16x32_bf16 v[64:67], a[136:139], v[136:139], v[64:67]
  buffer_load_dwordx4 v236, s[16:19], s29 offen offset:0 lds
  v_mfma_f32_16x16x32_bf16 v[64:67], a[140:143], v[140:143], v[64:67]
  ds_read_b128 a[148:151], v213 offset:20480
  v_mfma_f32_16x16x32_bf16 v[72:75], a[140:143], v[156:159], v[196:199]
  v_mfma_f32_16x16x32_bf16 v[72:75], a[136:139], v[152:155], v[72:75]
  ds_read_b128 a[152:155], v214 offset:20480
  v_mfma_f32_16x16x32_bf16 v[72:75], a[132:135], v[148:151], v[72:75]
  buffer_load_dwordx4 v237, s[16:19], s29 offen offset:1024 lds
  v_mfma_f32_16x16x32_bf16 v[72:75], a[128:131], v[144:147], v[72:75]
  ds_read_b128 a[156:159], v215 offset:20480
  v_mfma_f32_16x16x32_bf16 v[80:83], a[128:131], v[160:163], v[200:203]
  v_exp_f32 v64, v64
  v_mfma_f32_16x16x32_bf16 v[80:83], a[132:135], v[164:167], v[80:83]
  v_mfma_f32_16x16x32_bf16 v[80:83], a[136:139], v[168:171], v[80:83]
  v_exp_f32 v65, v65
  v_mfma_f32_16x16x32_bf16 v[80:83], a[140:143], v[172:175], v[80:83]
  v_cvt_pk_bf16_f32 v64, v64, v65
  v_mfma_f32_16x16x32_bf16 v[88:91], a[140:143], v[188:191], v[204:207]
  v_exp_f32 v66, v66
  v_mfma_f32_16x16x32_bf16 v[88:91], a[136:139], v[184:187], v[88:91]
  buffer_load_dwordx4 v236, s[16:19], s29 offen offset:2048 lds
  v_mfma_f32_16x16x32_bf16 v[88:91], a[132:135], v[180:183], v[88:91]
  s_waitcnt lgkmcnt(0)
  v_exp_f32 v67, v67
  v_mfma_f32_16x16x32_bf16 v[88:91], a[128:131], v[176:179], v[88:91]
  v_cvt_pk_bf16_f32 v65, v66, v67
  v_mfma_f32_16x16x32_bf16 v[68:71], a[144:147], v[128:131], v[192:195]
  v_exp_f32 v72, v72
  v_mfma_f32_16x16x32_bf16 v[68:71], a[148:151], v[132:135], v[68:71]
  ds_read_b128 a[128:131], v212 offset:24576
  v_mfma_f32_16x16x32_bf16 v[68:71], a[152:155], v[136:139], v[68:71]
  v_exp_f32 v73, v73
  v_mfma_f32_16x16x32_bf16 v[68:71], a[156:159], v[140:143], v[68:71]
  ds_read_b128 a[132:135], v213 offset:24576
  v_cvt_pk_bf16_f32 v72, v72, v73
  v_mfma_f32_16x16x32_bf16 v[76:79], a[156:159], v[156:159], v[196:199]
  v_exp_f32 v74, v74
  v_mfma_f32_16x16x32_bf16 v[76:79], a[152:155], v[152:155], v[76:79]
  ds_read_b128 a[136:139], v214 offset:24576
  v_mfma_f32_16x16x32_bf16 v[76:79], a[148:151], v[148:151], v[76:79]
  v_exp_f32 v75, v75
  v_mfma_f32_16x16x32_bf16 v[76:79], a[144:147], v[144:147], v[76:79]
  ds_read_b128 a[140:143], v215 offset:24576
  v_cvt_pk_bf16_f32 v73, v74, v75
  v_mfma_f32_16x16x32_bf16 v[84:87], a[144:147], v[160:163], v[200:203]
  v_exp_f32 v80, v80
  v_mfma_f32_16x16x32_bf16 v[84:87], a[148:151], v[164:167], v[84:87]
  buffer_load_dwordx4 v237, s[16:19], s29 offen offset:3072 lds
  v_mfma_f32_16x16x32_bf16 v[84:87], a[152:155], v[168:171], v[84:87]
  s_add_u32 s29, s29, 16384
  v_exp_f32 v81, v81
  v_mfma_f32_16x16x32_bf16 v[84:87], a[156:159], v[172:175], v[84:87]
  v_cvt_pk_bf16_f32 v80, v80, v81
  v_mfma_f32_16x16x32_bf16 v[92:95], a[156:159], v[188:191], v[204:207]
  s_add_u32 m0, s28, 49152
  v_exp_f32 v82, v82
  v_mfma_f32_16x16x32_bf16 v[92:95], a[152:155], v[184:187], v[92:95]
  buffer_load_dwordx4 v232, s[12:15], s29 offen offset:0 lds
  v_mfma_f32_16x16x32_bf16 v[92:95], a[148:151], v[180:183], v[92:95]
  s_waitcnt lgkmcnt(0)
  v_exp_f32 v83, v83
  v_mfma_f32_16x16x32_bf16 v[92:95], a[144:147], v[176:179], v[92:95]
  v_cvt_pk_bf16_f32 v81, v82, v83
  v_mfma_f32_16x16x32_bf16 v[96:99], a[128:131], v[128:131], v[192:195]
  v_exp_f32 v88, v88
  v_mfma_f32_16x16x32_bf16 v[96:99], a[132:135], v[132:135], v[96:99]
  ds_read_b128 a[144:147], v212 offset:28672
  v_mfma_f32_16x16x32_bf16 v[96:99], a[136:139], v[136:139], v[96:99]
  v_exp_f32 v89, v89
  v_mfma_f32_16x16x32_bf16 v[96:99], a[140:143], v[140:143], v[96:99]
  ds_read_b128 a[148:151], v213 offset:28672
  v_cvt_pk_bf16_f32 v88, v88, v89
  v_mfma_f32_16x16x32_bf16 v[104:107], a[140:143], v[156:159], v[196:199]
  v_exp_f32 v90, v90
  v_mfma_f32_16x16x32_bf16 v[104:107], a[136:139], v[152:155], v[104:107]
  ds_read_b128 a[152:155], v214 offset:28672
  v_mfma_f32_16x16x32_bf16 v[104:107], a[132:135], v[148:151], v[104:107]
  v_exp_f32 v91, v91
  v_mfma_f32_16x16x32_bf16 v[104:107], a[128:131], v[144:147], v[104:107]
  ds_read_b128 a[156:159], v215 offset:28672
  v_cvt_pk_bf16_f32 v89, v90, v91
  v_mfma_f32_16x16x32_bf16 v[112:115], a[128:131], v[160:163], v[200:203]
  v_exp_f32 v68, v68
  v_mfma_f32_16x16x32_bf16 v[112:115], a[132:135], v[164:167], v[112:115]
  buffer_load_dwordx4 v233, s[12:15], s29 offen offset:1024 lds
  v_mfma_f32_16x16x32_bf16 v[112:115], a[136:139], v[168:171], v[112:115]
  v_exp_f32 v69, v69
  v_mfma_f32_16x16x32_bf16 v[112:115], a[140:143], v[172:175], v[112:115]
  v_cvt_pk_bf16_f32 v66, v68, v69
  v_mfma_f32_16x16x32_bf16 v[120:123], a[140:143], v[188:191], v[204:207]
  v_exp_f32 v70, v70
  v_mfma_f32_16x16x32_bf16 v[120:123], a[136:139], v[184:187], v[120:123]
  buffer_load_dwordx4 v234, s[12:15], s29 offen offset:2048 lds
  v_mfma_f32_16x16x32_bf16 v[120:123], a[132:135], v[180:183], v[120:123]
  s_waitcnt lgkmcnt(0)
  v_exp_f32 v71, v71
  v_mfma_f32_16x16x32_bf16 v[120:123], a[128:131], v[176:179], v[120:123]
  v_cvt_pk_bf16_f32 v67, v70, v71
  v_mfma_f32_16x16x32_bf16 v[100:103], a[144:147], v[128:131], v[192:195]
  v_exp_f32 v76, v76
  v_mfma_f32_16x16x32_bf16 v[100:103], a[148:151], v[132:135], v[100:103]
  ds_read_b64_tr_b16 a[160:161], v216 offset:0
  v_mfma_f32_16x16x32_bf16 v[100:103], a[152:155], v[136:139], v[100:103]
  v_exp_f32 v77, v77
  v_mfma_f32_16x16x32_bf16 v[100:103], a[156:159], v[140:143], v[100:103]
  ds_read_b64_tr_b16 a[162:163], v216 offset:4096
  v_cvt_pk_bf16_f32 v74, v76, v77
  v_mfma_f32_16x16x32_bf16 v[108:111], a[156:159], v[156:159], v[196:199]
  v_exp_f32 v78, v78
  v_mfma_f32_16x16x32_bf16 v[108:111], a[152:155], v[152:155], v[108:111]
  ds_read_b64_tr_b16 a[164:165], v216 offset:8192
  buffer_load_dwordx4 v235, s[12:15], s29 offen offset:3072 lds
  v_mfma_f32_16x16x32_bf16 v[108:111], a[148:151], v[148:151], v[108:111]
  v_exp_f32 v79, v79
  v_mfma_f32_16x16x32_bf16 v[108:111], a[144:147], v[144:147], v[108:111]
  ds_read_b64_tr_b16 a[166:167], v216 offset:12288
  v_cvt_pk_bf16_f32 v75, v78, v79
  v_mfma_f32_16x16x32_bf16 v[116:119], a[144:147], v[160:163], v[200:203]
  v_exp_f32 v84, v84
  v_mfma_f32_16x16x32_bf16 v[116:119], a[148:151], v[164:167], v[116:119]
  ds_read_b64_tr_b16 a[168:169], v217 offset:0
  s_add_u32 m0, s50, 5120
  v_mfma_f32_16x16x32_bf16 v[116:119], a[152:155], v[168:171], v[116:119]
  v_exp_f32 v85, v85
  v_mfma_f32_16x16x32_bf16 v[116:119], a[156:159], v[172:175], v[116:119]
  ds_read_b64_tr_b16 a[170:171], v217 offset:4096
  v_cvt_pk_bf16_f32 v82, v84, v85
  v_mfma_f32_16x16x32_bf16 v[124:127], a[156:159], v[188:191], v[204:207]
  v_exp_f32 v86, v86
  v_mfma_f32_16x16x32_bf16 v[124:127], a[152:155], v[184:187], v[124:127]
  ds_read_b64_tr_b16 a[172:173], v217 offset:8192
  buffer_load_dwordx4 v253, s[44:47], s35 offen lds
  s_add_u32 s35, s35, 221184
  v_mfma_f32_16x16x32_bf16 v[124:127], a[148:151], v[180:183], v[124:127]
  v_exp_f32 v87, v87
  v_mfma_f32_16x16x32_bf16 v[124:127], a[144:147], v[176:179], v[124:127]
  ds_read_b64_tr_b16 a[174:175], v217 offset:12288
  v_cvt_pk_bf16_f32 v83, v86, v87
  v_mfma_f32_16x16x32_bf16 a[192:195], a[208:211], v[0:3], a[192:195]
  v_exp_f32 v92, v92
  v_mfma_f32_16x16x32_bf16 a[192:195], a[208:211], v[32:35], a[192:195]
  ds_read_b64_tr_b16 a[176:177], v218 offset:0
  v_mfma_f32_16x16x32_bf16 a[196:199], a[208:211], v[8:11], a[196:199]
  v_exp_f32 v93, v93
  v_mfma_f32_16x16x32_bf16 a[196:199], a[208:211], v[40:43], a[196:199]
  ds_read_b64_tr_b16 a[178:179], v218 offset:4096
  v_cvt_pk_bf16_f32 v90, v92, v93
  v_mfma_f32_16x16x32_bf16 a[200:203], a[208:211], v[16:19], a[200:203]
  v_exp_f32 v94, v94
  v_mfma_f32_16x16x32_bf16 a[200:203], a[208:211], v[48:51], a[200:203]
  ds_read_b64_tr_b16 a[180:181], v218 offset:8192
  v_mfma_f32_16x16x32_bf16 a[204:207], a[208:211], v[24:27], a[204:207]
  s_waitcnt lgkmcnt(7)
  v_exp_f32 v95, v95
  v_mfma_f32_16x16x32_bf16 a[204:207], a[208:211], v[56:59], a[204:207]
  ds_read_b64_tr_b16 a[182:183], v218 offset:12288
  v_cvt_pk_bf16_f32 v91, v94, v95
  v_mfma_f32_16x16x32_bf16 a[0:3], a[160:163], v[0:3], a[0:3]
  v_exp_f32 v96, v96
  v_mfma_f32_16x16x32_bf16 a[0:3], a[164:167], v[32:35], a[0:3]
  ds_read_b64_tr_b16 a[184:185], v219 offset:0
  v_mfma_f32_16x16x32_bf16 a[4:7], a[164:167], v[40:43], a[4:7]
  v_exp_f32 v97, v97
  v_mfma_f32_16x16x32_bf16 a[4:7], a[160:163], v[8:11], a[4:7]
  ds_read_b64_tr_b16 a[186:187], v219 offset:4096
  v_cvt_pk_bf16_f32 v96, v96, v97
  v_mfma_f32_16x16x32_bf16 a[8:11], a[160:163], v[16:19], a[8:11]
  v_exp_f32 v98, v98
  v_mfma_f32_16x16x32_bf16 a[8:11], a[164:167], v[48:51], a[8:11]
  ds_read_b64_tr_b16 a[188:189], v219 offset:8192
  v_mfma_f32_16x16x32_bf16 a[12:15], a[164:167], v[56:59], a[12:15]
  s_waitcnt lgkmcnt(7)
  v_exp_f32 v99, v99
  v_mfma_f32_16x16x32_bf16 a[12:15], a[160:163], v[24:27], a[12:15]
  ds_read_b64_tr_b16 a[190:191], v219 offset:12288
  v_cvt_pk_bf16_f32 v97, v98, v99
  v_mfma_f32_16x16x32_bf16 a[16:19], a[168:171], v[0:3], a[16:19]
  v_exp_f32 v104, v104
  v_mfma_f32_16x16x32_bf16 a[16:19], a[172:175], v[32:35], a[16:19]
  ds_read_b64_tr_b16 a[160:161], v220 offset:0
  v_mfma_f32_16x16x32_bf16 a[20:23], a[172:175], v[40:43], a[20:23]
  v_exp_f32 v105, v105
  v_mfma_f32_16x16x32_bf16 a[20:23], a[168:171], v[8:11], a[20:23]
  ds_read_b64_tr_b16 a[162:163], v220 offset:4096
  v_cvt_pk_bf16_f32 v104, v104, v105
  v_mfma_f32_16x16x32_bf16 a[24:27], a[168:171], v[16:19], a[24:27]
  v_exp_f32 v106, v106
  v_mfma_f32_16x16x32_bf16 a[24:27], a[172:175], v[48:51], a[24:27]
  ds_read_b64_tr_b16 a[164:165], v220 offset:8192
  v_mfma_f32_16x16x32_bf16 a[28:31], a[172:175], v[56:59], a[28:31]
  s_waitcnt lgkmcnt(7)
  v_exp_f32 v107, v107
  v_mfma_f32_16x16x32_bf16 a[28:31], a[168:171], v[24:27], a[28:31]
  ds_read_b64_tr_b16 a[166:167], v220 offset:12288
  v_cvt_pk_bf16_f32 v105, v106, v107
  v_mfma_f32_16x16x32_bf16 a[32:35], a[176:179], v[0:3], a[32:35]
  v_exp_f32 v112, v112
  v_mfma_f32_16x16x32_bf16 a[32:35], a[180:183], v[32:35], a[32:35]
  ds_read_b64_tr_b16 a[168:169], v221 offset:0
  v_mfma_f32_16x16x32_bf16 a[36:39], a[180:183], v[40:43], a[36:39]
  v_exp_f32 v113, v113
  v_mfma_f32_16x16x32_bf16 a[36:39], a[176:179], v[8:11], a[36:39]
  ds_read_b64_tr_b16 a[170:171], v221 offset:4096
  v_cvt_pk_bf16_f32 v112, v112, v113
  v_mfma_f32_16x16x32_bf16 a[40:43], a[176:179], v[16:19], a[40:43]
  v_exp_f32 v114, v114
  v_mfma_f32_16x16x32_bf16 a[40:43], a[180:183], v[48:51], a[40:43]
  ds_read_b64_tr_b16 a[172:173], v221 offset:8192
  v_mfma_f32_16x16x32_bf16 a[44:47], a[180:183], v[56:59], a[44:47]
  s_waitcnt lgkmcnt(7)
  v_exp_f32 v115, v115
  v_mfma_f32_16x16x32_bf16 a[44:47], a[176:179], v[24:27], a[44:47]
  ds_read_b64_tr_b16 a[174:175], v221 offset:12288
  v_cvt_pk_bf16_f32 v113, v114, v115
  v_mfma_f32_16x16x32_bf16 a[48:51], a[184:187], v[0:3], a[48:51]
  v_exp_f32 v120, v120
  v_mfma_f32_16x16x32_bf16 a[48:51], a[188:191], v[32:35], a[48:51]
  ds_read_b64_tr_b16 a[176:177], v222 offset:0
  v_mfma_f32_16x16x32_bf16 a[52:55], a[188:191], v[40:43], a[52:55]
  v_exp_f32 v121, v121
  v_mfma_f32_16x16x32_bf16 a[52:55], a[184:187], v[8:11], a[52:55]
  ds_read_b64_tr_b16 a[178:179], v222 offset:4096
  v_cvt_pk_bf16_f32 v120, v120, v121
  v_mfma_f32_16x16x32_bf16 a[56:59], a[184:187], v[16:19], a[56:59]
  v_exp_f32 v122, v122
  v_mfma_f32_16x16x32_bf16 a[56:59], a[188:191], v[48:51], a[56:59]
  ds_read_b64_tr_b16 a[180:181], v222 offset:8192
  v_mfma_f32_16x16x32_bf16 a[60:63], a[188:191], v[56:59], a[60:63]
  s_waitcnt lgkmcnt(7)
  v_exp_f32 v123, v123
  v_mfma_f32_16x16x32_bf16 a[60:63], a[184:187], v[24:27], a[60:63]
  ds_read_b64_tr_b16 a[182:183], v222 offset:12288
  v_cvt_pk_bf16_f32 v121, v122, v123
  v_mfma_f32_16x16x32_bf16 a[64:67], a[160:163], v[0:3], a[64:67]
  v_exp_f32 v100, v100
  v_mfma_f32_16x16x32_bf16 a[64:67], a[164:167], v[32:35], a[64:67]
  ds_read_b64_tr_b16 a[184:185], v223 offset:0
  v_mfma_f32_16x16x32_bf16 a[68:71], a[164:167], v[40:43], a[68:71]
  v_exp_f32 v101, v101
  v_mfma_f32_16x16x32_bf16 a[68:71], a[160:163], v[8:11], a[68:71]
  ds_read_b64_tr_b16 a[186:187], v223 offset:4096
  v_cvt_pk_bf16_f32 v98, v100, v101
  v_mfma_f32_16x16x32_bf16 a[72:75], a[160:163], v[16:19], a[72:75]
  v_exp_f32 v102, v102
  v_mfma_f32_16x16x32_bf16 a[72:75], a[164:167], v[48:51], a[72:75]
  ds_read_b64_tr_b16 a[188:189], v223 offset:8192
  v_mfma_f32_16x16x32_bf16 a[76:79], a[164:167], v[56:59], a[76:79]
  s_waitcnt lgkmcnt(7)
  v_exp_f32 v103, v103
  v_mfma_f32_16x16x32_bf16 a[76:79], a[160:163], v[24:27], a[76:79]
  ds_read_b64_tr_b16 a[190:191], v223 offset:12288
  v_cvt_pk_bf16_f32 v99, v102, v103
  v_mfma_f32_16x16x32_bf16 a[80:83], a[168:171], v[0:3], a[80:83]
  s_waitcnt vmcnt(11)
  v_exp_f32 v108, v108
  v_mfma_f32_16x16x32_bf16 a[80:83], a[172:175], v[32:35], a[80:83]
  v_mfma_f32_16x16x32_bf16 a[84:87], a[172:175], v[40:43], a[84:87]
  s_barrier
  v_exp_f32 v109, v109
  v_mfma_f32_16x16x32_bf16 a[84:87], a[168:171], v[8:11], a[84:87]
  ds_read_b128 a[128:131], v212 offset:32768
  v_cvt_pk_bf16_f32 v106, v108, v109
  v_mfma_f32_16x16x32_bf16 a[88:91], a[168:171], v[16:19], a[88:91]
  v_exp_f32 v110, v110
  v_mfma_f32_16x16x32_bf16 a[88:91], a[172:175], v[48:51], a[88:91]
  ds_read_b128 a[132:135], v213 offset:32768
  v_mfma_f32_16x16x32_bf16 a[92:95], a[172:175], v[56:59], a[92:95]
  s_waitcnt lgkmcnt(6)
  v_exp_f32 v111, v111
  v_mfma_f32_16x16x32_bf16 a[92:95], a[168:171], v[24:27], a[92:95]
  ds_read_b128 a[136:139], v214 offset:32768
  v_cvt_pk_bf16_f32 v107, v110, v111
  v_mfma_f32_16x16x32_bf16 a[96:99], a[176:179], v[0:3], a[96:99]
  v_exp_f32 v116, v116
  v_mfma_f32_16x16x32_bf16 a[96:99], a[180:183], v[32:35], a[96:99]
  ds_read_b128 a[140:143], v215 offset:32768
  buffer_load_dwordx4 a[228:231], v243, s[24:27], s38 offen sc1
  s_add_u32 s38, s38, 4096
  v_mfma_f32_16x16x32_bf16 a[100:103], a[180:183], v[40:43], a[100:103]
  v_exp_f32 v117, v117
  v_mfma_f32_16x16x32_bf16 a[100:103], a[176:179], v[8:11], a[100:103]
  v_cvt_pk_bf16_f32 v114, v116, v117
  v_mfma_f32_16x16x32_bf16 a[104:107], a[176:179], v[16:19], a[104:107]
  v_exp_f32 v118, v118
  v_mfma_f32_16x16x32_bf16 a[104:107], a[180:183], v[48:51], a[104:107]
  v_mfma_f32_16x16x32_bf16 a[108:111], a[180:183], v[56:59], a[108:111]
  s_waitcnt lgkmcnt(4)
  v_exp_f32 v119, v119
  v_mfma_f32_16x16x32_bf16 a[108:111], a[176:179], v[24:27], a[108:111]
  v_cvt_pk_bf16_f32 v115, v118, v119
  v_mfma_f32_16x16x32_bf16 a[112:115], a[184:187], v[0:3], a[112:115]
  v_exp_f32 v124, v124
  v_mfma_f32_16x16x32_bf16 a[112:115], a[188:191], v[32:35], a[112:115]
  v_mfma_f32_16x16x32_bf16 a[116:119], a[188:191], v[40:43], a[116:119]
  v_exp_f32 v125, v125
  v_mfma_f32_16x16x32_bf16 a[116:119], a[184:187], v[8:11], a[116:119]
  v_cvt_pk_bf16_f32 v122, v124, v125
  v_mfma_f32_16x16x32_bf16 a[120:123], a[184:187], v[16:19], a[120:123]
  v_exp_f32 v126, v126
  v_mfma_f32_16x16x32_bf16 a[120:123], a[188:191], v[48:51], a[120:123]
  v_mfma_f32_16x16x32_bf16 a[124:127], a[188:191], v[56:59], a[124:127]
  s_waitcnt lgkmcnt(0)
  v_exp_f32 v127, v127
  v_mfma_f32_16x16x32_bf16 a[124:127], a[184:187], v[24:27], a[124:127]
  v_cvt_pk_bf16_f32 v123, v126, v127
  v_mfma_f32_16x16x32_bf16 v[0:3], a[128:131], v[128:131], v[192:195]
  s_add_u32 m0, s28, 114688
  s_mov_b32 s20, s88
  s_mov_b32 s21, s89
  v_mfma_f32_16x16x32_bf16 v[0:3], a[132:135], v[132:135], v[0:3]
  ds_read_b128 a[144:147], v212 offset:36864
  s_mov_b32 s22, 5242880
  s_mov_b32 s23, 0x20000
  v_lshrrev_b32 v208, 4, v242
  v_mfma_f32_16x16x32_bf16 v[0:3], a[136:139], v[136:139], v[0:3]
  buffer_load_dwordx4 v236, s[16:19], s29 offen offset:0 lds
  v_mfma_f32_16x16x32_bf16 v[0:3], a[140:143], v[140:143], v[0:3]
  ds_read_b128 a[148:151], v213 offset:36864
  v_and_b32 v209, 1, v208
  v_mfma_f32_16x16x32_bf16 v[8:11], a[140:143], v[156:159], v[196:199]
  v_lshrrev_b32 v208, 1, v208
  v_mul_u32_u24 v208, 0x500, v208
  v_mfma_f32_16x16x32_bf16 v[8:11], a[136:139], v[152:155], v[8:11]
  ds_read_b128 a[152:155], v214 offset:36864
  v_lshl_add_u32 v208, v209, 4, v208
  v_mfma_f32_16x16x32_bf16 v[8:11], a[132:135], v[148:151], v[8:11]
  buffer_load_dwordx4 v237, s[16:19], s29 offen offset:1024 lds
  v_mfma_f32_16x16x32_bf16 v[8:11], a[128:131], v[144:147], v[8:11]
  ds_read_b128 a[156:159], v215 offset:36864
  v_lshrrev_b32 v209, 4, v242
  v_mfma_f32_16x16x32_bf16 v[16:19], a[128:131], v[160:163], v[200:203]
  v_exp_f32 v0, v0
  v_mfma_f32_16x16x32_bf16 v[16:19], a[132:135], v[164:167], v[16:19]
  v_lshrrev_b32 v210, 5, v209
  v_lshlrev_b32 v210, 30, v210
  v_mfma_f32_16x16x32_bf16 v[16:19], a[136:139], v[168:171], v[16:19]
  v_exp_f32 v1, v1
  v_mfma_f32_16x16x32_bf16 v[16:19], a[140:143], v[172:175], v[16:19]
  v_cvt_pk_bf16_f32 v0, v0, v1
  v_or_b32 v210, v210, v208
  v_mfma_f32_16x16x32_bf16 v[24:27], a[140:143], v[188:191], v[204:207]
  v_exp_f32 v2, v2
  v_mfma_f32_16x16x32_bf16 v[24:27], a[136:139], v[184:187], v[24:27]
  buffer_load_dwordx4 v236, s[16:19], s29 offen offset:2048 lds
  v_mfma_f32_16x16x32_bf16 v[24:27], a[132:135], v[180:183], v[24:27]
  s_waitcnt lgkmcnt(0)
  v_exp_f32 v3, v3
  v_mfma_f32_16x16x32_bf16 v[24:27], a[128:131], v[176:179], v[24:27]
  v_cvt_pk_bf16_f32 v1, v2, v3
  v_bfe_u32 v211, v209, 2, 4
  v_mfma_f32_16x16x32_bf16 v[4:7], a[144:147], v[128:131], v[192:195]
  v_exp_f32 v8, v8
  v_mfma_f32_16x16x32_bf16 v[4:7], a[148:151], v[132:135], v[4:7]
  ds_read_b128 a[128:131], v212 offset:40960
  v_and_b32 v209, 3, v209
  v_mfma_f32_16x16x32_bf16 v[4:7], a[152:155], v[136:139], v[4:7]
  v_exp_f32 v9, v9
  v_mfma_f32_16x16x32_bf16 v[4:7], a[156:159], v[140:143], v[4:7]
  ds_read_b128 a[132:135], v213 offset:40960
  v_cvt_pk_bf16_f32 v8, v8, v9
  v_mfma_f32_16x16x32_bf16 v[12:15], a[156:159], v[156:159], v[196:199]
  v_exp_f32 v10, v10
  v_mfma_f32_16x16x32_bf16 v[12:15], a[152:155], v[152:155], v[12:15]
  ds_read_b128 a[136:139], v214 offset:40960
  v_lshlrev_b32 v209, 3, v209
  v_mfma_f32_16x16x32_bf16 v[12:15], a[148:151], v[148:151], v[12:15]
  v_exp_f32 v11, v11
  v_mfma_f32_16x16x32_bf16 v[12:15], a[144:147], v[144:147], v[12:15]
  ds_read_b128 a[140:143], v215 offset:40960
  v_cvt_pk_bf16_f32 v9, v10, v11
  v_mfma_f32_16x16x32_bf16 v[20:23], a[144:147], v[160:163], v[200:203]
  v_exp_f32 v16, v16
  v_mfma_f32_16x16x32_bf16 v[20:23], a[148:151], v[164:167], v[20:23]
  buffer_load_dwordx4 v237, s[16:19], s29 offen offset:3072 lds
  v_mfma_f32_16x16x32_bf16 v[20:23], a[152:155], v[168:171], v[20:23]
  s_add_u32 s29, s29, 16384
  v_exp_f32 v17, v17
  v_mfma_f32_16x16x32_bf16 v[20:23], a[156:159], v[172:175], v[20:23]
  v_cvt_pk_bf16_f32 v16, v16, v17
  v_lshl_add_u32 v209, v211, 5, v209
  v_mfma_f32_16x16x32_bf16 v[28:31], a[156:159], v[188:191], v[204:207]
  s_add_u32 m0, s28, 0
  v_exp_f32 v18, v18
  v_mfma_f32_16x16x32_bf16 v[28:31], a[152:155], v[184:187], v[28:31]
  buffer_load_dwordx4 v232, s[12:15], s29 offen offset:0 lds
  v_mfma_f32_16x16x32_bf16 v[28:31], a[148:151], v[180:183], v[28:31]
  s_waitcnt lgkmcnt(0)
  v_exp_f32 v19, v19
  v_mfma_f32_16x16x32_bf16 v[28:31], a[144:147], v[176:179], v[28:31]
  v_cvt_pk_bf16_f32 v17, v18, v19
  v_add_u32 v209, s50, v209
  v_mfma_f32_16x16x32_bf16 v[32:35], a[128:131], v[128:131], v[192:195]
  s_and_b32 s39, s2, 1
  s_lshl_b32 s39, s39, 2
  s_add_u32 s39, s39, s3
  v_exp_f32 v24, v24
  v_mfma_f32_16x16x32_bf16 v[32:35], a[132:135], v[132:135], v[32:35]
  ds_read_b128 a[144:147], v212 offset:45056
  s_lshr_b32 s31, s2, 1
  s_mul_i32 s30, s31, 40960
  s_mul_i32 s48, s39, 160
  v_mfma_f32_16x16x32_bf16 v[32:35], a[136:139], v[136:139], v[32:35]
  s_add_u32 s30, s30, s48
  s_mul_i32 s31, s31, 5120
  s_mul_i32 s39, s39, 655360
  v_exp_f32 v25, v25
  v_mfma_f32_16x16x32_bf16 v[32:35], a[140:143], v[140:143], v[32:35]
  ds_read_b128 a[148:151], v213 offset:45056
  s_add_u32 s31, s31, s39
  s_add_u32 s31, s31, 3145728
  s_lshr_b32 s39, s2, 3
  v_cvt_pk_bf16_f32 v24, v24, v25
  v_mfma_f32_16x16x32_bf16 v[40:43], a[140:143], v[156:159], v[196:199]
  s_min_u32 s39, s39, 29
  s_and_b32 s48, s2, 7
  s_mul_i32 s48, s48, 30
  v_exp_f32 v26, v26
  v_mfma_f32_16x16x32_bf16 v[40:43], a[136:139], v[152:155], v[40:43]
  ds_read_b128 a[152:155], v214 offset:45056
  s_add_u32 s39, s39, s48
  s_mul_i32 s98, s39, 1639
  s_lshr_b32 s98, s98, 16
  v_mfma_f32_16x16x32_bf16 v[40:43], a[132:135], v[148:151], v[40:43]
  s_mul_i32 s99, s98, 40
  s_sub_u32 s99, s39, s99
  s_min_u32 s39, s3, 2
  v_exp_f32 v27, v27
  v_mfma_f32_16x16x32_bf16 v[40:43], a[128:131], v[144:147], v[40:43]
  ds_read_b128 a[156:159], v215 offset:45056
  s_mul_i32 s48, s98, 3
  s_add_u32 s48, s48, s39
  s_mul_i32 s100, s48, 122880
  v_cvt_pk_bf16_f32 v25, v26, v27
  v_mfma_f32_16x16x32_bf16 v[48:51], a[128:131], v[160:163], v[200:203]
  s_lshl_b32 s39, s99, 5
  s_add_u32 s100, s100, s39
  s_mul_i32 s101, s48, 192
  v_exp_f32 v4, v4
  v_mfma_f32_16x16x32_bf16 v[48:51], a[132:135], v[164:167], v[48:51]
  buffer_load_dwordx4 v233, s[12:15], s29 offen offset:1024 lds
  s_add_u32 s101, s101, 2633728
  s_mov_b32 s51, s50
  v_mfma_f32_16x16x32_bf16 v[48:51], a[136:139], v[168:171], v[48:51]
  v_exp_f32 v5, v5
  v_mfma_f32_16x16x32_bf16 v[48:51], a[140:143], v[172:175], v[48:51]
  v_cvt_pk_bf16_f32 v2, v4, v5
  v_mov_b32 v211, v242
  v_mfma_f32_16x16x32_bf16 v[56:59], a[140:143], v[188:191], v[204:207]
  s_mov_b32 s4, s94
  s_mov_b32 s5, s95
  s_mov_b32 s6, 2211840
  v_exp_f32 v6, v6
  v_mfma_f32_16x16x32_bf16 v[56:59], a[136:139], v[184:187], v[56:59]
  buffer_load_dwordx4 v234, s[12:15], s29 offen offset:2048 lds
  s_mov_b32 s7, 0x20000
  s_getpc_b64 s[8:9]
attn_late_pc:
  s_add_u32 s8, s8, attn_h_ready-attn_late_pc
  s_addc_u32 s9, s9, 0
  v_mfma_f32_16x16x32_bf16 v[56:59], a[132:135], v[180:183], v[56:59]
  s_waitcnt lgkmcnt(0)
  s_lshr_b32 s39, s2, 3
  v_exp_f32 v7, v7
  v_mfma_f32_16x16x32_bf16 v[56:59], a[128:131], v[176:179], v[56:59]
  v_cvt_pk_bf16_f32 v3, v6, v7
  v_lshrrev_b32 v252, 4, v242
  v_mfma_f32_16x16x32_bf16 v[36:39], a[144:147], v[128:131], v[192:195]
  v_exp_f32 v12, v12
  v_mfma_f32_16x16x32_bf16 v[36:39], a[148:151], v[132:135], v[36:39]
  ds_read_b64_tr_b16 a[160:161], v216 offset:16384
  v_min_u32 v252, 11, v252
  v_mfma_f32_16x16x32_bf16 v[36:39], a[152:155], v[136:139], v[36:39]
  v_exp_f32 v13, v13
  v_mfma_f32_16x16x32_bf16 v[36:39], a[156:159], v[140:143], v[36:39]
  ds_read_b64_tr_b16 a[162:163], v216 offset:20480
  v_cvt_pk_bf16_f32 v10, v12, v13
  v_mfma_f32_16x16x32_bf16 v[44:47], a[156:159], v[156:159], v[196:199]
  v_exp_f32 v14, v14
  v_mfma_f32_16x16x32_bf16 v[44:47], a[152:155], v[152:155], v[44:47]
  ds_read_b64_tr_b16 a[164:165], v216 offset:24576
  buffer_load_dwordx4 v235, s[12:15], s29 offen offset:3072 lds
  v_mfma_f32_16x16x32_bf16 v[44:47], a[148:151], v[148:151], v[44:47]
  v_exp_f32 v15, v15
  v_mfma_f32_16x16x32_bf16 v[44:47], a[144:147], v[144:147], v[44:47]
  ds_read_b64_tr_b16 a[166:167], v216 offset:28672
  v_cvt_pk_bf16_f32 v11, v14, v15
  v_mfma_f32_16x16x32_bf16 v[52:55], a[144:147], v[160:163], v[200:203]
  v_exp_f32 v20, v20
  v_mfma_f32_16x16x32_bf16 v[52:55], a[148:151], v[164:167], v[52:55]
  ds_read_b64_tr_b16 a[168:169], v217 offset:16384
  v_lshlrev_b32 v252, 5, v252
  v_mfma_f32_16x16x32_bf16 v[52:55], a[152:155], v[168:171], v[52:55]
  v_exp_f32 v21, v21
  v_mfma_f32_16x16x32_bf16 v[52:55], a[156:159], v[172:175], v[52:55]
  ds_read_b64_tr_b16 a[170:171], v217 offset:20480
  v_cvt_pk_bf16_f32 v18, v20, v21
  v_mfma_f32_16x16x32_bf16 v[60:63], a[156:159], v[188:191], v[204:207]
  v_exp_f32 v22, v22
  v_mfma_f32_16x16x32_bf16 v[60:63], a[152:155], v[184:187], v[60:63]
  ds_read_b64_tr_b16 a[172:173], v217 offset:24576
  v_add_u32 v252, s39, v252
  v_mfma_f32_16x16x32_bf16 v[60:63], a[148:151], v[180:183], v[60:63]
  v_exp_f32 v23, v23
  v_mfma_f32_16x16x32_bf16 v[60:63], a[144:147], v[176:179], v[60:63]
  ds_read_b64_tr_b16 a[174:175], v217 offset:28672
  v_cvt_pk_bf16_f32 v19, v22, v23
  v_mfma_f32_16x16x32_bf16 a[192:195], a[208:211], v[64:67], a[192:195]
  v_exp_f32 v28, v28
  v_mfma_f32_16x16x32_bf16 a[192:195], a[208:211], v[96:99], a[192:195]
  ds_read_b64_tr_b16 a[176:177], v218 offset:16384
  v_lshlrev_b32 v252, 7, v252
  v_mfma_f32_16x16x32_bf16 a[196:199], a[208:211], v[72:75], a[196:199]
  v_exp_f32 v29, v29
  v_mfma_f32_16x16x32_bf16 a[196:199], a[208:211], v[104:107], a[196:199]
  ds_read_b64_tr_b16 a[178:179], v218 offset:20480
  v_cvt_pk_bf16_f32 v26, v28, v29
  v_mfma_f32_16x16x32_bf16 a[200:203], a[208:211], v[80:83], a[200:203]
  v_exp_f32 v30, v30
  v_mfma_f32_16x16x32_bf16 a[200:203], a[208:211], v[112:115], a[200:203]
  ds_read_b64_tr_b16 a[180:181], v218 offset:24576
  v_min_u32 v252, attn_end-attn_h_ready-4, v252
  v_mfma_f32_16x16x32_bf16 a[204:207], a[208:211], v[88:91], a[204:207]
  s_waitcnt lgkmcnt(7)
  v_exp_f32 v31, v31
  v_mfma_f32_16x16x32_bf16 a[204:207], a[208:211], v[120:123], a[204:207]
  ds_read_b64_tr_b16 a[182:183], v218 offset:28672
  v_cvt_pk_bf16_f32 v27, v30, v31
  v_mfma_f32_16x16x32_bf16 a[0:3], a[160:163], v[64:67], a[0:3]
  v_exp_f32 v32, v32
  v_mfma_f32_16x16x32_bf16 a[0:3], a[164:167], v[96:99], a[0:3]
  ds_read_b64_tr_b16 a[184:185], v219 offset:16384
  v_mfma_f32_16x16x32_bf16 a[4:7], a[164:167], v[104:107], a[4:7]
  v_exp_f32 v33, v33
  v_mfma_f32_16x16x32_bf16 a[4:7], a[160:163], v[72:75], a[4:7]
  ds_read_b64_tr_b16 a[186:187], v219 offset:20480
  v_cvt_pk_bf16_f32 v32, v32, v33
  v_mfma_f32_16x16x32_bf16 a[8:11], a[160:163], v[80:83], a[8:11]
  v_exp_f32 v34, v34
  v_mfma_f32_16x16x32_bf16 a[8:11], a[164:167], v[112:115], a[8:11]
  ds_read_b64_tr_b16 a[188:189], v219 offset:24576
  v_mfma_f32_16x16x32_bf16 a[12:15], a[164:167], v[120:123], a[12:15]
  s_waitcnt lgkmcnt(7)
  v_exp_f32 v35, v35
  v_mfma_f32_16x16x32_bf16 a[12:15], a[160:163], v[88:91], a[12:15]
  ds_read_b64_tr_b16 a[190:191], v219 offset:28672
  v_cvt_pk_bf16_f32 v33, v34, v35
  v_mfma_f32_16x16x32_bf16 a[16:19], a[168:171], v[64:67], a[16:19]
  v_exp_f32 v40, v40
  v_mfma_f32_16x16x32_bf16 a[16:19], a[172:175], v[96:99], a[16:19]
  ds_read_b64_tr_b16 a[160:161], v220 offset:16384
  v_mfma_f32_16x16x32_bf16 a[20:23], a[172:175], v[104:107], a[20:23]
  v_exp_f32 v41, v41
  v_mfma_f32_16x16x32_bf16 a[20:23], a[168:171], v[72:75], a[20:23]
  ds_read_b64_tr_b16 a[162:163], v220 offset:20480
  v_cvt_pk_bf16_f32 v40, v40, v41
  v_mfma_f32_16x16x32_bf16 a[24:27], a[168:171], v[80:83], a[24:27]
  v_exp_f32 v42, v42
  v_mfma_f32_16x16x32_bf16 a[24:27], a[172:175], v[112:115], a[24:27]
  ds_read_b64_tr_b16 a[164:165], v220 offset:24576
  v_mfma_f32_16x16x32_bf16 a[28:31], a[172:175], v[120:123], a[28:31]
  s_waitcnt lgkmcnt(7)
  v_exp_f32 v43, v43
  v_mfma_f32_16x16x32_bf16 a[28:31], a[168:171], v[88:91], a[28:31]
  ds_read_b64_tr_b16 a[166:167], v220 offset:28672
  v_cvt_pk_bf16_f32 v41, v42, v43
  v_mfma_f32_16x16x32_bf16 a[32:35], a[176:179], v[64:67], a[32:35]
  v_exp_f32 v48, v48
  v_mfma_f32_16x16x32_bf16 a[32:35], a[180:183], v[96:99], a[32:35]
  ds_read_b64_tr_b16 a[168:169], v221 offset:16384
  v_mfma_f32_16x16x32_bf16 a[36:39], a[180:183], v[104:107], a[36:39]
  v_exp_f32 v49, v49
  v_mfma_f32_16x16x32_bf16 a[36:39], a[176:179], v[72:75], a[36:39]
  ds_read_b64_tr_b16 a[170:171], v221 offset:20480
  v_cvt_pk_bf16_f32 v48, v48, v49
  v_mfma_f32_16x16x32_bf16 a[40:43], a[176:179], v[80:83], a[40:43]
  v_exp_f32 v50, v50
  v_mfma_f32_16x16x32_bf16 a[40:43], a[180:183], v[112:115], a[40:43]
  ds_read_b64_tr_b16 a[172:173], v221 offset:24576
  v_mfma_f32_16x16x32_bf16 a[44:47], a[180:183], v[120:123], a[44:47]
  s_waitcnt lgkmcnt(7)
  v_exp_f32 v51, v51
  v_mfma_f32_16x16x32_bf16 a[44:47], a[176:179], v[88:91], a[44:47]
  ds_read_b64_tr_b16 a[174:175], v221 offset:28672
  v_cvt_pk_bf16_f32 v49, v50, v51
  v_mfma_f32_16x16x32_bf16 a[48:51], a[184:187], v[64:67], a[48:51]
  v_exp_f32 v56, v56
  v_mfma_f32_16x16x32_bf16 a[48:51], a[188:191], v[96:99], a[48:51]
  ds_read_b64_tr_b16 a[176:177], v222 offset:16384
  v_mfma_f32_16x16x32_bf16 a[52:55], a[188:191], v[104:107], a[52:55]
  v_exp_f32 v57, v57
  v_mfma_f32_16x16x32_bf16 a[52:55], a[184:187], v[72:75], a[52:55]
  ds_read_b64_tr_b16 a[178:179], v222 offset:20480
  v_cvt_pk_bf16_f32 v56, v56, v57
  v_mfma_f32_16x16x32_bf16 a[56:59], a[184:187], v[80:83], a[56:59]
  v_exp_f32 v58, v58
  v_mfma_f32_16x16x32_bf16 a[56:59], a[188:191], v[112:115], a[56:59]
  ds_read_b64_tr_b16 a[180:181], v222 offset:24576
  v_mfma_f32_16x16x32_bf16 a[60:63], a[188:191], v[120:123], a[60:63]
  s_waitcnt lgkmcnt(7)
  v_exp_f32 v59, v59
  v_mfma_f32_16x16x32_bf16 a[60:63], a[184:187], v[88:91], a[60:63]
  ds_read_b64_tr_b16 a[182:183], v222 offset:28672
  v_cvt_pk_bf16_f32 v57, v58, v59
  v_mfma_f32_16x16x32_bf16 a[64:67], a[160:163], v[64:67], a[64:67]
  v_exp_f32 v36, v36
  v_mfma_f32_16x16x32_bf16 a[64:67], a[164:167], v[96:99], a[64:67]
  ds_read_b64_tr_b16 a[184:185], v223 offset:16384
  v_mfma_f32_16x16x32_bf16 a[68:71], a[164:167], v[104:107], a[68:71]
  v_exp_f32 v37, v37
  v_mfma_f32_16x16x32_bf16 a[68:71], a[160:163], v[72:75], a[68:71]
  ds_read_b64_tr_b16 a[186:187], v223 offset:20480
  v_cvt_pk_bf16_f32 v34, v36, v37
  v_mfma_f32_16x16x32_bf16 a[72:75], a[160:163], v[80:83], a[72:75]
  v_exp_f32 v38, v38
  v_mfma_f32_16x16x32_bf16 a[72:75], a[164:167], v[112:115], a[72:75]
  ds_read_b64_tr_b16 a[188:189], v223 offset:24576
  v_mfma_f32_16x16x32_bf16 a[76:79], a[164:167], v[120:123], a[76:79]
  s_waitcnt lgkmcnt(7)
  v_exp_f32 v39, v39
  v_mfma_f32_16x16x32_bf16 a[76:79], a[160:163], v[88:91], a[76:79]
  ds_read_b64_tr_b16 a[190:191], v223 offset:28672
  v_cvt_pk_bf16_f32 v35, v38, v39
  v_mfma_f32_16x16x32_bf16 a[80:83], a[168:171], v[64:67], a[80:83]
  s_waitcnt vmcnt(10)
  v_exp_f32 v44, v44
  v_mfma_f32_16x16x32_bf16 a[80:83], a[172:175], v[96:99], a[80:83]
  v_mfma_f32_16x16x32_bf16 a[84:87], a[172:175], v[104:107], a[84:87]
  s_barrier
  v_exp_f32 v45, v45
  v_mfma_f32_16x16x32_bf16 a[84:87], a[168:171], v[72:75], a[84:87]
  ds_read_b128 a[128:131], v212 offset:49152
  v_cvt_pk_bf16_f32 v42, v44, v45
  v_mfma_f32_16x16x32_bf16 a[88:91], a[168:171], v[80:83], a[88:91]
  v_exp_f32 v46, v46
  v_mfma_f32_16x16x32_bf16 a[88:91], a[172:175], v[112:115], a[88:91]
  ds_read_b128 a[132:135], v213 offset:49152
  v_mfma_f32_16x16x32_bf16 a[92:95], a[172:175], v[120:123], a[92:95]
  s_waitcnt lgkmcnt(6)
  v_exp_f32 v47, v47
  v_mfma_f32_16x16x32_bf16 a[92:95], a[168:171], v[88:91], a[92:95]
  ds_read_b128 a[136:139], v214 offset:49152
  v_cvt_pk_bf16_f32 v43, v46, v47
  v_mfma_f32_16x16x32_bf16 a[96:99], a[176:179], v[64:67], a[96:99]
  v_exp_f32 v52, v52
  v_mfma_f32_16x16x32_bf16 a[96:99], a[180:183], v[96:99], a[96:99]
  ds_read_b128 a[140:143], v215 offset:49152
  v_mfma_f32_16x16x32_bf16 a[100:103], a[180:183], v[104:107], a[100:103]
  v_exp_f32 v53, v53
  v_mfma_f32_16x16x32_bf16 a[100:103], a[176:179], v[72:75], a[100:103]
  v_cvt_pk_bf16_f32 v50, v52, v53
  v_mfma_f32_16x16x32_bf16 a[104:107], a[176:179], v[80:83], a[104:107]
  v_exp_f32 v54, v54
  v_mfma_f32_16x16x32_bf16 a[104:107], a[180:183], v[112:115], a[104:107]
  v_mfma_f32_16x16x32_bf16 a[108:111], a[180:183], v[120:123], a[108:111]
  s_waitcnt lgkmcnt(4)
  v_exp_f32 v55, v55
  v_mfma_f32_16x16x32_bf16 a[108:111], a[176:179], v[88:91], a[108:111]
  v_cvt_pk_bf16_f32 v51, v54, v55
  v_mfma_f32_16x16x32_bf16 a[112:115], a[184:187], v[64:67], a[112:115]
  v_exp_f32 v60, v60
  v_mfma_f32_16x16x32_bf16 a[112:115], a[188:191], v[96:99], a[112:115]
  v_mfma_f32_16x16x32_bf16 a[116:119], a[188:191], v[104:107], a[116:119]
  v_exp_f32 v61, v61
  v_mfma_f32_16x16x32_bf16 a[116:119], a[184:187], v[72:75], a[116:119]
  v_cvt_pk_bf16_f32 v58, v60, v61
  v_mfma_f32_16x16x32_bf16 a[120:123], a[184:187], v[80:83], a[120:123]
  v_exp_f32 v62, v62
  v_mfma_f32_16x16x32_bf16 a[120:123], a[188:191], v[112:115], a[120:123]
  v_mfma_f32_16x16x32_bf16 a[124:127], a[188:191], v[120:123], a[124:127]
  s_waitcnt lgkmcnt(0)
  v_exp_f32 v63, v63
  v_mfma_f32_16x16x32_bf16 a[124:127], a[184:187], v[88:91], a[124:127]
  v_cvt_pk_bf16_f32 v59, v62, v63
  v_mfma_f32_16x16x32_bf16 v[64:67], a[128:131], v[128:131], v[192:195]
  s_add_u32 m0, s28, 65536
  v_lshrrev_b32 v224, 4, v242
  v_lshrrev_b32 v225, 4, v224
  v_mfma_f32_16x16x32_bf16 v[64:67], a[132:135], v[132:135], v[64:67]
  ds_read_b128 a[144:147], v212 offset:53248
  v_bfe_u32 v226, v224, 2, 2
  v_mfma_f32_16x16x32_bf16 v[64:67], a[136:139], v[136:139], v[64:67]
  buffer_load_dwordx4 v236, s[16:19], s29 offen offset:0 lds
  v_mfma_f32_16x16x32_bf16 v[64:67], a[140:143], v[140:143], v[64:67]
  ds_read_b128 a[148:151], v213 offset:53248
  v_lshl_add_u32 v225, v225, 3, v226
  v_mfma_f32_16x16x32_bf16 v[72:75], a[140:143], v[156:159], v[196:199]
  v_lshlrev_b32 v225, 4, v225
  v_bfe_u32 v226, v224, 1, 1
  v_mfma_f32_16x16x32_bf16 v[72:75], a[136:139], v[152:155], v[72:75]
  ds_read_b128 a[152:155], v214 offset:53248
  v_mul_u32_u24 v226, 0xc00, v226
  v_mfma_f32_16x16x32_bf16 v[72:75], a[132:135], v[148:151], v[72:75]
  buffer_load_dwordx4 v237, s[16:19], s29 offen offset:1024 lds
  v_mfma_f32_16x16x32_bf16 v[72:75], a[128:131], v[144:147], v[72:75]
  ds_read_b128 a[156:159], v215 offset:53248
  v_add3_u32 v225, v225, v226, s50
  v_mfma_f32_16x16x32_bf16 v[80:83], a[128:131], v[160:163], v[200:203]
  v_exp_f32 v64, v64
  v_mfma_f32_16x16x32_bf16 v[80:83], a[132:135], v[164:167], v[80:83]
  v_and_b32 v226, 1, v224
  v_lshl_add_u32 v225, v226, 3, v225
  v_mfma_f32_16x16x32_bf16 v[80:83], a[136:139], v[168:171], v[80:83]
  s_waitcnt vmcnt(10)
  v_exp_f32 v65, v65
  v_mfma_f32_16x16x32_bf16 v[80:83], a[140:143], v[172:175], v[80:83]
  ds_read_b64_tr_b16 a[232:233], v225 offset:0
  v_cvt_pk_bf16_f32 v64, v64, v65
  v_mfma_f32_16x16x32_bf16 v[88:91], a[140:143], v[188:191], v[204:207]
  v_exp_f32 v66, v66
  v_mfma_f32_16x16x32_bf16 v[88:91], a[136:139], v[184:187], v[88:91]
  buffer_load_dwordx4 v236, s[16:19], s29 offen offset:2048 lds
  v_mfma_f32_16x16x32_bf16 v[88:91], a[132:135], v[180:183], v[88:91]
  s_waitcnt lgkmcnt(1)
  v_exp_f32 v67, v67
  v_mfma_f32_16x16x32_bf16 v[88:91], a[128:131], v[176:179], v[88:91]
  ds_read_b64_tr_b16 a[234:235], v225 offset:64
  v_cvt_pk_bf16_f32 v65, v66, v67
  v_mfma_f32_16x16x32_bf16 v[68:71], a[144:147], v[128:131], v[192:195]
  v_exp_f32 v72, v72
  v_mfma_f32_16x16x32_bf16 v[68:71], a[148:151], v[132:135], v[68:71]
  ds_read_b128 a[128:131], v212 offset:57344
  ds_read_b64_tr_b16 a[236:237], v225 offset:512
  v_mfma_f32_16x16x32_bf16 v[68:71], a[152:155], v[136:139], v[68:71]
  v_exp_f32 v73, v73
  v_mfma_f32_16x16x32_bf16 v[68:71], a[156:159], v[140:143], v[68:71]
  ds_read_b128 a[132:135], v213 offset:57344
  v_cvt_pk_bf16_f32 v72, v72, v73
  v_mfma_f32_16x16x32_bf16 v[76:79], a[156:159], v[156:159], v[196:199]
  v_exp_f32 v74, v74
  v_mfma_f32_16x16x32_bf16 v[76:79], a[152:155], v[152:155], v[76:79]
  ds_read_b128 a[136:139], v214 offset:57344
  ds_read_b64_tr_b16 a[238:239], v225 offset:576
  v_mfma_f32_16x16x32_bf16 v[76:79], a[148:151], v[148:151], v[76:79]
  v_exp_f32 v75, v75
  v_mfma_f32_16x16x32_bf16 v[76:79], a[144:147], v[144:147], v[76:79]
  ds_read_b128 a[140:143], v215 offset:57344
  v_cvt_pk_bf16_f32 v73, v74, v75
  v_mfma_f32_16x16x32_bf16 v[84:87], a[144:147], v[160:163], v[200:203]
  v_exp_f32 v80, v80
  v_mfma_f32_16x16x32_bf16 v[84:87], a[148:151], v[164:167], v[84:87]
  buffer_load_dwordx4 v237, s[16:19], s29 offen offset:3072 lds
  v_mfma_f32_16x16x32_bf16 v[84:87], a[152:155], v[168:171], v[84:87]
  s_add_u32 s29, s29, 16384
  v_exp_f32 v81, v81
  v_mfma_f32_16x16x32_bf16 v[84:87], a[156:159], v[172:175], v[84:87]
  ds_read_b64_tr_b16 a[240:241], v225 offset:1024
  v_cvt_pk_bf16_f32 v80, v80, v81
  v_mfma_f32_16x16x32_bf16 v[92:95], a[156:159], v[188:191], v[204:207]
  s_add_u32 m0, s28, 16384
  v_exp_f32 v82, v82
  v_mfma_f32_16x16x32_bf16 v[92:95], a[152:155], v[184:187], v[92:95]
  buffer_load_dwordx4 v232, s[12:15], s29 offen offset:0 lds
  v_mfma_f32_16x16x32_bf16 v[92:95], a[148:151], v[180:183], v[92:95]
  s_waitcnt lgkmcnt(1)
  v_exp_f32 v83, v83
  v_mfma_f32_16x16x32_bf16 v[92:95], a[144:147], v[176:179], v[92:95]
  ds_read_b64_tr_b16 a[242:243], v225 offset:1088
  v_cvt_pk_bf16_f32 v81, v82, v83
  v_mfma_f32_16x16x32_bf16 v[96:99], a[128:131], v[128:131], v[192:195]
  v_exp_f32 v88, v88
  v_mfma_f32_16x16x32_bf16 v[96:99], a[132:135], v[132:135], v[96:99]
  ds_read_b128 a[144:147], v212 offset:61440
  ds_read_b64_tr_b16 a[244:245], v225 offset:1536
  v_mfma_f32_16x16x32_bf16 v[96:99], a[136:139], v[136:139], v[96:99]
  v_exp_f32 v89, v89
  v_mfma_f32_16x16x32_bf16 v[96:99], a[140:143], v[140:143], v[96:99]
  ds_read_b128 a[148:151], v213 offset:61440
  v_cvt_pk_bf16_f32 v88, v88, v89
  v_mfma_f32_16x16x32_bf16 v[104:107], a[140:143], v[156:159], v[196:199]
  v_exp_f32 v90, v90
  v_mfma_f32_16x16x32_bf16 v[104:107], a[136:139], v[152:155], v[104:107]
  ds_read_b128 a[152:155], v214 offset:61440
  ds_read_b64_tr_b16 a[246:247], v225 offset:1600
  v_mfma_f32_16x16x32_bf16 v[104:107], a[132:135], v[148:151], v[104:107]
  v_exp_f32 v91, v91
  v_mfma_f32_16x16x32_bf16 v[104:107], a[128:131], v[144:147], v[104:107]
  ds_read_b128 a[156:159], v215 offset:61440
  v_cvt_pk_bf16_f32 v89, v90, v91
  v_mfma_f32_16x16x32_bf16 v[112:115], a[128:131], v[160:163], v[200:203]
  v_exp_f32 v68, v68
  v_mfma_f32_16x16x32_bf16 v[112:115], a[132:135], v[164:167], v[112:115]
  buffer_load_dwordx4 v233, s[12:15], s29 offen offset:1024 lds
  v_mfma_f32_16x16x32_bf16 v[112:115], a[136:139], v[168:171], v[112:115]
  v_exp_f32 v69, v69
  v_mfma_f32_16x16x32_bf16 v[112:115], a[140:143], v[172:175], v[112:115]
  ds_read_b64_tr_b16 a[248:249], v225 offset:2048
  v_cvt_pk_bf16_f32 v66, v68, v69
  v_mfma_f32_16x16x32_bf16 v[120:123], a[140:143], v[188:191], v[204:207]
  v_exp_f32 v70, v70
  v_mfma_f32_16x16x32_bf16 v[120:123], a[136:139], v[184:187], v[120:123]
  buffer_load_dwordx4 v234, s[12:15], s29 offen offset:2048 lds
  v_mfma_f32_16x16x32_bf16 v[120:123], a[132:135], v[180:183], v[120:123]
  s_waitcnt lgkmcnt(1)
  v_exp_f32 v71, v71
  v_mfma_f32_16x16x32_bf16 v[120:123], a[128:131], v[176:179], v[120:123]
  ds_read_b64_tr_b16 a[250:251], v225 offset:2112
  v_cvt_pk_bf16_f32 v67, v70, v71
  v_mfma_f32_16x16x32_bf16 v[100:103], a[144:147], v[128:131], v[192:195]
  v_exp_f32 v76, v76
  v_mfma_f32_16x16x32_bf16 v[100:103], a[148:151], v[132:135], v[100:103]
  ds_read_b64_tr_b16 a[160:161], v216 offset:32768
  v_mfma_f32_16x16x32_bf16 v[100:103], a[152:155], v[136:139], v[100:103]
  v_exp_f32 v77, v77
  v_mfma_f32_16x16x32_bf16 v[100:103], a[156:159], v[140:143], v[100:103]
  ds_read_b64_tr_b16 a[162:163], v216 offset:36864
  v_cvt_pk_bf16_f32 v74, v76, v77
  v_mfma_f32_16x16x32_bf16 v[108:111], a[156:159], v[156:159], v[196:199]
  v_exp_f32 v78, v78
  v_mfma_f32_16x16x32_bf16 v[108:111], a[152:155], v[152:155], v[108:111]
  ds_read_b64_tr_b16 a[164:165], v216 offset:40960
  buffer_load_dwordx4 v235, s[12:15], s29 offen offset:3072 lds
  v_mfma_f32_16x16x32_bf16 v[108:111], a[148:151], v[148:151], v[108:111]
  v_exp_f32 v79, v79
  v_mfma_f32_16x16x32_bf16 v[108:111], a[144:147], v[144:147], v[108:111]
  ds_read_b64_tr_b16 a[166:167], v216 offset:45056
  s_waitcnt lgkmcnt(4)
  v_cvt_pk_bf16_f32 v75, v78, v79
  v_mfma_f32_16x16x32_bf16 v[116:119], a[144:147], v[160:163], v[200:203]
  v_exp_f32 v84, v84
  v_mfma_f32_16x16x32_bf16 v[116:119], a[148:151], v[164:167], v[116:119]
  ds_read_b64_tr_b16 a[168:169], v217 offset:32768
  v_mfma_f32_16x16x32_bf16 v[228:231], a[232:235], a[212:215], 0
  v_mfma_f32_16x16x32_bf16 v[228:231], a[236:239], a[216:219], v[228:231]
  v_mfma_f32_16x16x32_bf16 v[228:231], a[240:243], a[220:223], v[228:231]
  v_mfma_f32_16x16x32_bf16 v[228:231], a[244:247], a[224:227], v[228:231]
  v_mfma_f32_16x16x32_bf16 v[228:231], a[248:251], a[228:231], v[228:231]
  v_mfma_f32_16x16x32_bf16 v[116:119], a[152:155], v[168:171], v[116:119]
  s_lshl_b32 s35, s3, 10
  s_add_u32 s35, s35, 159744
  v_exp_f32 v85, v85
  v_mfma_f32_16x16x32_bf16 v[116:119], a[156:159], v[172:175], v[116:119]
  ds_read_b64_tr_b16 a[170:171], v217 offset:36864
  v_cvt_pk_bf16_f32 v82, v84, v85
  v_mfma_f32_16x16x32_bf16 v[124:127], a[156:159], v[188:191], v[204:207]
  v_exp_f32 v86, v86
  v_mfma_f32_16x16x32_bf16 v[124:127], a[152:155], v[184:187], v[124:127]
  ds_read_b64_tr_b16 a[172:173], v217 offset:40960
  v_add_u32 v224, s35, v242
  v_mfma_f32_16x16x32_bf16 v[124:127], a[148:151], v[180:183], v[124:127]
  v_exp_f32 v87, v87
  v_mfma_f32_16x16x32_bf16 v[124:127], a[144:147], v[176:179], v[124:127]
  ds_read_b64_tr_b16 a[174:175], v217 offset:45056
  v_cvt_pk_bf16_f32 v83, v86, v87
  v_mfma_f32_16x16x32_bf16 a[192:195], a[208:211], v[0:3], a[192:195]
  v_exp_f32 v92, v92
  v_mfma_f32_16x16x32_bf16 a[192:195], a[208:211], v[32:35], a[192:195]
  ds_read_b64_tr_b16 a[176:177], v218 offset:32768
  ds_write_b128 v224, v[228:231]
  v_mfma_f32_16x16x32_bf16 a[196:199], a[208:211], v[8:11], a[196:199]
  v_exp_f32 v93, v93
  v_mfma_f32_16x16x32_bf16 a[196:199], a[208:211], v[40:43], a[196:199]
  ds_read_b64_tr_b16 a[178:179], v218 offset:36864
  v_cvt_pk_bf16_f32 v90, v92, v93
  v_mfma_f32_16x16x32_bf16 a[200:203], a[208:211], v[16:19], a[200:203]
  v_exp_f32 v94, v94
  v_mfma_f32_16x16x32_bf16 a[200:203], a[208:211], v[48:51], a[200:203]
  ds_read_b64_tr_b16 a[180:181], v218 offset:40960
  v_mfma_f32_16x16x32_bf16 a[204:207], a[208:211], v[24:27], a[204:207]
  s_waitcnt lgkmcnt(8)
  v_exp_f32 v95, v95
  v_mfma_f32_16x16x32_bf16 a[204:207], a[208:211], v[56:59], a[204:207]
  ds_read_b64_tr_b16 a[182:183], v218 offset:45056
  v_cvt_pk_bf16_f32 v91, v94, v95
  v_mfma_f32_16x16x32_bf16 a[0:3], a[160:163], v[0:3], a[0:3]
  v_exp_f32 v96, v96
  v_mfma_f32_16x16x32_bf16 a[0:3], a[164:167], v[32:35], a[0:3]
  ds_read_b64_tr_b16 a[184:185], v219 offset:32768
  s_waitcnt lgkmcnt(4)
  s_mov_b32 m0, s51
  v_mfma_f32_16x16x32_bf16 a[4:7], a[164:167], v[40:43], a[4:7]
  v_exp_f32 v97, v97
  v_mfma_f32_16x16x32_bf16 a[4:7], a[160:163], v[8:11], a[4:7]
  ds_read_b64_tr_b16 a[186:187], v219 offset:36864
  v_cvt_pk_bf16_f32 v96, v96, v97
  v_mfma_f32_16x16x32_bf16 a[8:11], a[160:163], v[16:19], a[8:11]
  v_exp_f32 v98, v98
  v_mfma_f32_16x16x32_bf16 a[8:11], a[164:167], v[48:51], a[8:11]
  ds_read_b64_tr_b16 a[188:189], v219 offset:40960
  buffer_load_dwordx4 v210, s[4:7], s100 offen lds
  s_add_u32 s100, s100, 20480
  s_add_u32 s51, s51, 512
  v_mfma_f32_16x16x32_bf16 a[12:15], a[164:167], v[56:59], a[12:15]
  v_exp_f32 v99, v99
  v_mfma_f32_16x16x32_bf16 a[12:15], a[160:163], v[24:27], a[12:15]
  ds_read_b64_tr_b16 a[190:191], v219 offset:45056
  v_cvt_pk_bf16_f32 v97, v98, v99
  v_mfma_f32_16x16x32_bf16 a[16:19], a[168:171], v[0:3], a[16:19]
  v_exp_f32 v104, v104
  v_mfma_f32_16x16x32_bf16 a[16:19], a[172:175], v[32:35], a[16:19]
  ds_read_b64_tr_b16 a[160:161], v220 offset:32768
  v_lshrrev_b32 v224, 4, v242
  v_mfma_f32_16x16x32_bf16 a[20:23], a[172:175], v[40:43], a[20:23]
  v_exp_f32 v105, v105
  v_mfma_f32_16x16x32_bf16 a[20:23], a[168:171], v[8:11], a[20:23]
  ds_read_b64_tr_b16 a[162:163], v220 offset:36864
  v_cvt_pk_bf16_f32 v104, v104, v105
  v_mfma_f32_16x16x32_bf16 a[24:27], a[168:171], v[16:19], a[24:27]
  v_exp_f32 v106, v106
  v_mfma_f32_16x16x32_bf16 a[24:27], a[172:175], v[48:51], a[24:27]
  ds_read_b64_tr_b16 a[164:165], v220 offset:40960
  v_bfe_u32 v225, v224, 2, 1
  v_mfma_f32_16x16x32_bf16 a[28:31], a[172:175], v[56:59], a[28:31]
  s_waitcnt lgkmcnt(7)
  v_exp_f32 v107, v107
  v_mfma_f32_16x16x32_bf16 a[28:31], a[168:171], v[24:27], a[28:31]
  ds_read_b64_tr_b16 a[166:167], v220 offset:45056
  v_cvt_pk_bf16_f32 v105, v106, v107
  v_mfma_f32_16x16x32_bf16 a[32:35], a[176:179], v[0:3], a[32:35]
  v_exp_f32 v112, v112
  v_mfma_f32_16x16x32_bf16 a[32:35], a[180:183], v[32:35], a[32:35]
  ds_read_b64_tr_b16 a[168:169], v221 offset:32768
  v_lshlrev_b32 v225, 8, v225
  v_mfma_f32_16x16x32_bf16 a[36:39], a[180:183], v[40:43], a[36:39]
  v_exp_f32 v113, v113
  v_mfma_f32_16x16x32_bf16 a[36:39], a[176:179], v[8:11], a[36:39]
  ds_read_b64_tr_b16 a[170:171], v221 offset:36864
  v_cvt_pk_bf16_f32 v112, v112, v113
  v_mfma_f32_16x16x32_bf16 a[40:43], a[176:179], v[16:19], a[40:43]
  v_exp_f32 v114, v114
  v_mfma_f32_16x16x32_bf16 a[40:43], a[180:183], v[48:51], a[40:43]
  ds_read_b64_tr_b16 a[172:173], v221 offset:40960
  v_lshrrev_b32 v226, 3, v224
  v_mfma_f32_16x16x32_bf16 a[44:47], a[180:183], v[56:59], a[44:47]
  s_waitcnt lgkmcnt(7)
  v_exp_f32 v115, v115
  v_mfma_f32_16x16x32_bf16 a[44:47], a[176:179], v[24:27], a[44:47]
  ds_read_b64_tr_b16 a[174:175], v221 offset:45056
  v_cvt_pk_bf16_f32 v113, v114, v115
  v_mfma_f32_16x16x32_bf16 a[48:51], a[184:187], v[0:3], a[48:51]
  v_exp_f32 v120, v120
  v_mfma_f32_16x16x32_bf16 a[48:51], a[188:191], v[32:35], a[48:51]
  ds_read_b64_tr_b16 a[176:177], v222 offset:32768
  v_lshl_add_u32 v225, v226, 4, v225
  v_mfma_f32_16x16x32_bf16 a[52:55], a[188:191], v[40:43], a[52:55]
  v_exp_f32 v121, v121
  v_mfma_f32_16x16x32_bf16 a[52:55], a[184:187], v[8:11], a[52:55]
  ds_read_b64_tr_b16 a[178:179], v222 offset:36864
  v_cvt_pk_bf16_f32 v120, v120, v121
  v_mfma_f32_16x16x32_bf16 a[56:59], a[184:187], v[16:19], a[56:59]
  v_exp_f32 v122, v122
  v_mfma_f32_16x16x32_bf16 a[56:59], a[188:191], v[48:51], a[56:59]
  ds_read_b64_tr_b16 a[180:181], v222 offset:40960
  v_and_b32 v227, 3, v224
  v_mfma_f32_16x16x32_bf16 a[60:63], a[188:191], v[56:59], a[60:63]
  s_waitcnt lgkmcnt(7)
  v_exp_f32 v123, v123
  v_mfma_f32_16x16x32_bf16 a[60:63], a[184:187], v[24:27], a[60:63]
  ds_read_b64_tr_b16 a[182:183], v222 offset:45056
  v_cvt_pk_bf16_f32 v121, v122, v123
  v_mfma_f32_16x16x32_bf16 a[64:67], a[160:163], v[0:3], a[64:67]
  v_exp_f32 v100, v100
  v_mfma_f32_16x16x32_bf16 a[64:67], a[164:167], v[32:35], a[64:67]
  ds_read_b64_tr_b16 a[184:185], v223 offset:32768
  v_lshl_add_u32 v225, v227, 2, v225
  v_mfma_f32_16x16x32_bf16 a[68:71], a[164:167], v[40:43], a[68:71]
  v_exp_f32 v101, v101
  v_mfma_f32_16x16x32_bf16 a[68:71], a[160:163], v[8:11], a[68:71]
  ds_read_b64_tr_b16 a[186:187], v223 offset:36864
  v_cvt_pk_bf16_f32 v98, v100, v101
  v_mfma_f32_16x16x32_bf16 a[72:75], a[160:163], v[16:19], a[72:75]
  v_exp_f32 v102, v102
  v_mfma_f32_16x16x32_bf16 a[72:75], a[164:167], v[48:51], a[72:75]
  ds_read_b64_tr_b16 a[188:189], v223 offset:40960
  v_add_u32 v225, 159744, v225
  v_mfma_f32_16x16x32_bf16 a[76:79], a[164:167], v[56:59], a[76:79]
  s_waitcnt lgkmcnt(7)
  v_exp_f32 v103, v103
  v_mfma_f32_16x16x32_bf16 a[76:79], a[160:163], v[24:27], a[76:79]
  ds_read_b64_tr_b16 a[190:191], v223 offset:45056
  v_cvt_pk_bf16_f32 v99, v102, v103
  v_mfma_f32_16x16x32_bf16 a[80:83], a[168:171], v[0:3], a[80:83]
  s_waitcnt vmcnt(9)
  v_exp_f32 v108, v108
  v_mfma_f32_16x16x32_bf16 a[80:83], a[172:175], v[32:35], a[80:83]
  v_mfma_f32_16x16x32_bf16 a[84:87], a[172:175], v[40:43], a[84:87]
  s_barrier
  v_exp_f32 v109, v109
  v_mfma_f32_16x16x32_bf16 a[84:87], a[168:171], v[8:11], a[84:87]
  ds_read_b128 a[128:131], v212 offset:0
  v_cvt_pk_bf16_f32 v106, v108, v109
  v_mfma_f32_16x16x32_bf16 a[88:91], a[168:171], v[16:19], a[88:91]
  v_exp_f32 v110, v110
  v_mfma_f32_16x16x32_bf16 a[88:91], a[172:175], v[48:51], a[88:91]
  ds_read_b128 a[132:135], v213 offset:0
  ds_read_b32 v228, v225 offset:0
  v_mfma_f32_16x16x32_bf16 a[92:95], a[172:175], v[56:59], a[92:95]
  s_waitcnt lgkmcnt(7)
  v_exp_f32 v111, v111
  v_mfma_f32_16x16x32_bf16 a[92:95], a[168:171], v[24:27], a[92:95]
  ds_read_b128 a[136:139], v214 offset:0
  v_cvt_pk_bf16_f32 v107, v110, v111
  v_mfma_f32_16x16x32_bf16 a[96:99], a[176:179], v[0:3], a[96:99]
  v_exp_f32 v116, v116
  v_mfma_f32_16x16x32_bf16 a[96:99], a[180:183], v[32:35], a[96:99]
  ds_read_b128 a[140:143], v215 offset:0
  ds_read_b32 v229, v225 offset:1024
  v_mfma_f32_16x16x32_bf16 a[100:103], a[180:183], v[40:43], a[100:103]
  v_exp_f32 v117, v117
  v_mfma_f32_16x16x32_bf16 a[100:103], a[176:179], v[8:11], a[100:103]
  ds_read_b32 v230, v225 offset:2048
  v_cvt_pk_bf16_f32 v114, v116, v117
  v_mfma_f32_16x16x32_bf16 a[104:107], a[176:179], v[16:19], a[104:107]
  v_exp_f32 v118, v118
  v_mfma_f32_16x16x32_bf16 a[104:107], a[180:183], v[48:51], a[104:107]
  ds_read_b32 v231, v225 offset:3072
  ds_read_b32 v238, v225 offset:512
  v_mfma_f32_16x16x32_bf16 a[108:111], a[180:183], v[56:59], a[108:111]
  s_waitcnt lgkmcnt(9)
  v_exp_f32 v119, v119
  v_mfma_f32_16x16x32_bf16 a[108:111], a[176:179], v[24:27], a[108:111]
  ds_read_b32 v239, v225 offset:1536
  v_cvt_pk_bf16_f32 v115, v118, v119
  v_mfma_f32_16x16x32_bf16 a[112:115], a[184:187], v[0:3], a[112:115]
  v_exp_f32 v124, v124
  v_mfma_f32_16x16x32_bf16 a[112:115], a[188:191], v[32:35], a[112:115]
  ds_read_b32 v240, v225 offset:2560
  ds_read_b32 v241, v225 offset:3584
  s_cmp_eq_u32 s3, 0
  s_cselect_b32 s35, 0, 1073741824
  v_mfma_f32_16x16x32_bf16 a[116:119], a[188:191], v[40:43], a[116:119]
  v_exp_f32 v125, v125
  v_mfma_f32_16x16x32_bf16 a[116:119], a[184:187], v[8:11], a[116:119]
  v_cvt_pk_bf16_f32 v122, v124, v125
  v_mul_u32_u24 v226, 0xd80, v226
  v_mfma_f32_16x16x32_bf16 a[120:123], a[184:187], v[16:19], a[120:123]
  v_exp_f32 v126, v126
  v_mfma_f32_16x16x32_bf16 a[120:123], a[188:191], v[48:51], a[120:123]
  v_and_b32 v227, 7, v224
  v_lshl_add_u32 v226, v227, 1, v226
  v_mfma_f32_16x16x32_bf16 a[124:127], a[188:191], v[56:59], a[124:127]
  s_waitcnt lgkmcnt(7)
  v_exp_f32 v127, v127
  v_mfma_f32_16x16x32_bf16 a[124:127], a[184:187], v[24:27], a[124:127]
  v_cvt_pk_bf16_f32 v123, v126, v127
  v_and_b32 v227, 1, v224
  v_lshl_add_u32 v226, v227, 30, v226
  v_or_b32 v226, s35, v226
  v_min_u32 v249, 1, v224
  v_lshlrev_b32 v249, 30, v249
  v_or_b32 v249, s35, v249
  v_mov_b32 v251, v249
  v_mov_b32 v250, 1
  s_mov_b32 s47, 2818048
  s_lshl_b32 s35, s33, 4
  s_add_u32 s35, s35, 2633728
  s_waitcnt lgkmcnt(0)
  v_add_f32 v228, v228, v229
  v_add_f32 v238, v238, v239
  v_add_f32 v230, v230, v231
  v_add_f32 v240, v240, v241
  v_add_f32 v228, v228, v230
  v_add_f32 v238, v238, v240
  v_cvt_pk_bf16_f32 v228, v228, v228
  v_cvt_pk_bf16_f32 v238, v238, v238
  v_lshlrev_b32 v228, 16, v228
  v_lshlrev_b32 v238, 16, v238
  v_mul_f32 v229, 0xbfb8aa3b, v228
  v_exp_f32 v229, v229
  s_nop 0
  v_add_f32 v229, 1.0, v229
  v_rcp_f32 v229, v229
  s_nop 0
  v_mul_f32 v228, v228, v229
  v_cvt_pk_bf16_f32 v228, v228, v228
  v_lshlrev_b32 v228, 16, v228
  v_mul_f32 v228, v228, v238
  s_nop 1
  v_mov_b32_dpp v229, v228 quad_perm:[1,0,3,2] row_mask:0xf bank_mask:0xf
  v_cvt_pk_bf16_f32 v228, v228, v229
  buffer_store_dword v228, v226, s[24:27], s35 offen sc1
  s_mov_b32 s32, 5
attn_loop:
  v_mfma_f32_16x16x32_bf16 v[0:3], a[128:131], v[128:131], v[192:195]
  s_add_u32 m0, s28, 81920
  v_mfma_f32_16x16x32_bf16 v[0:3], a[132:135], v[132:135], v[0:3]
  ds_read_b128 a[144:147], v212 offset:4096
  v_mfma_f32_16x16x32_bf16 v[0:3], a[136:139], v[136:139], v[0:3]
  buffer_load_dwordx4 v236, s[16:19], s29 offen offset:0 lds
  v_mfma_f32_16x16x32_bf16 v[0:3], a[140:143], v[140:143], v[0:3]
  ds_read_b128 a[148:151], v213 offset:4096
  v_mfma_f32_16x16x32_bf16 v[8:11], a[140:143], v[156:159], v[196:199]
  v_mfma_f32_16x16x32_bf16 v[8:11], a[136:139], v[152:155], v[8:11]
  ds_read_b128 a[152:155], v214 offset:4096
  v_mfma_f32_16x16x32_bf16 v[8:11], a[132:135], v[148:151], v[8:11]
  buffer_load_dwordx4 v237, s[16:19], s29 offen offset:1024 lds
  v_mfma_f32_16x16x32_bf16 v[8:11], a[128:131], v[144:147], v[8:11]
  ds_read_b128 a[156:159], v215 offset:4096
  v_mfma_f32_16x16x32_bf16 v[16:19], a[128:131], v[160:163], v[200:203]
  v_exp_f32 v0, v0
  v_mfma_f32_16x16x32_bf16 v[16:19], a[132:135], v[164:167], v[16:19]
  v_mfma_f32_16x16x32_bf16 v[16:19], a[136:139], v[168:171], v[16:19]
  v_exp_f32 v1, v1
  v_mfma_f32_16x16x32_bf16 v[16:19], a[140:143], v[172:175], v[16:19]
  v_cvt_pk_bf16_f32 v0, v0, v1
  v_mfma_f32_16x16x32_bf16 v[24:27], a[140:143], v[188:191], v[204:207]
  v_exp_f32 v2, v2
  v_mfma_f32_16x16x32_bf16 v[24:27], a[136:139], v[184:187], v[24:27]
  buffer_load_dwordx4 v236, s[16:19], s29 offen offset:2048 lds
  v_mfma_f32_16x16x32_bf16 v[24:27], a[132:135], v[180:183], v[24:27]
  s_waitcnt lgkmcnt(0)
  v_exp_f32 v3, v3
  v_mfma_f32_16x16x32_bf16 v[24:27], a[128:131], v[176:179], v[24:27]
  v_cvt_pk_bf16_f32 v1, v2, v3
  v_mfma_f32_16x16x32_bf16 v[4:7], a[144:147], v[128:131], v[192:195]
  v_exp_f32 v8, v8
  v_mfma_f32_16x16x32_bf16 v[4:7], a[148:151], v[132:135], v[4:7]
  ds_read_b128 a[128:131], v212 offset:8192
  v_mfma_f32_16x16x32_bf16 v[4:7], a[152:155], v[136:139], v[4:7]
  v_exp_f32 v9, v9
  v_mfma_f32_16x16x32_bf16 v[4:7], a[156:159], v[140:143], v[4:7]
  ds_read_b128 a[132:135], v213 offset:8192
  v_cvt_pk_bf16_f32 v8, v8, v9
  v_mfma_f32_16x16x32_bf16 v[12:15], a[156:159], v[156:159], v[196:199]
  v_exp_f32 v10, v10
  v_mfma_f32_16x16x32_bf16 v[12:15], a[152:155], v[152:155], v[12:15]
  ds_read_b128 a[136:139], v214 offset:8192
  v_mfma_f32_16x16x32_bf16 v[12:15], a[148:151], v[148:151], v[12:15]
  v_exp_f32 v11, v11
  v_mfma_f32_16x16x32_bf16 v[12:15], a[144:147], v[144:147], v[12:15]
  ds_read_b128 a[140:143], v215 offset:8192
  v_cvt_pk_bf16_f32 v9, v10, v11
  v_mfma_f32_16x16x32_bf16 v[20:23], a[144:147], v[160:163], v[200:203]
  v_exp_f32 v16, v16
  v_mfma_f32_16x16x32_bf16 v[20:23], a[148:151], v[164:167], v[20:23]
  buffer_load_dwordx4 v237, s[16:19], s29 offen offset:3072 lds
  v_mfma_f32_16x16x32_bf16 v[20:23], a[152:155], v[168:171], v[20:23]
  s_add_u32 s29, s29, 16384
  v_exp_f32 v17, v17
  v_mfma_f32_16x16x32_bf16 v[20:23], a[156:159], v[172:175], v[20:23]
  v_cvt_pk_bf16_f32 v16, v16, v17
  v_mfma_f32_16x16x32_bf16 v[28:31], a[156:159], v[188:191], v[204:207]
  s_add_u32 m0, s28, 32768
  v_exp_f32 v18, v18
  v_mfma_f32_16x16x32_bf16 v[28:31], a[152:155], v[184:187], v[28:31]
  buffer_load_dwordx4 v232, s[12:15], s29 offen offset:0 lds
  v_mfma_f32_16x16x32_bf16 v[28:31], a[148:151], v[180:183], v[28:31]
  s_waitcnt lgkmcnt(0)
  v_exp_f32 v19, v19
  v_mfma_f32_16x16x32_bf16 v[28:31], a[144:147], v[176:179], v[28:31]
  v_cvt_pk_bf16_f32 v17, v18, v19
  v_mfma_f32_16x16x32_bf16 v[32:35], a[128:131], v[128:131], v[192:195]
  v_exp_f32 v24, v24
  v_mfma_f32_16x16x32_bf16 v[32:35], a[132:135], v[132:135], v[32:35]
  ds_read_b128 a[144:147], v212 offset:12288
  v_mfma_f32_16x16x32_bf16 v[32:35], a[136:139], v[136:139], v[32:35]
  v_exp_f32 v25, v25
  v_mfma_f32_16x16x32_bf16 v[32:35], a[140:143], v[140:143], v[32:35]
  ds_read_b128 a[148:151], v213 offset:12288
  v_cvt_pk_bf16_f32 v24, v24, v25
  v_mfma_f32_16x16x32_bf16 v[40:43], a[140:143], v[156:159], v[196:199]
  v_exp_f32 v26, v26
  v_mfma_f32_16x16x32_bf16 v[40:43], a[136:139], v[152:155], v[40:43]
  ds_read_b128 a[152:155], v214 offset:12288
  v_mfma_f32_16x16x32_bf16 v[40:43], a[132:135], v[148:151], v[40:43]
  v_exp_f32 v27, v27
  v_mfma_f32_16x16x32_bf16 v[40:43], a[128:131], v[144:147], v[40:43]
  ds_read_b128 a[156:159], v215 offset:12288
  v_cvt_pk_bf16_f32 v25, v26, v27
  v_mfma_f32_16x16x32_bf16 v[48:51], a[128:131], v[160:163], v[200:203]
  v_exp_f32 v4, v4
  v_mfma_f32_16x16x32_bf16 v[48:51], a[132:135], v[164:167], v[48:51]
  buffer_load_dwordx4 v233, s[12:15], s29 offen offset:1024 lds
  v_mfma_f32_16x16x32_bf16 v[48:51], a[136:139], v[168:171], v[48:51]
  v_exp_f32 v5, v5
  v_mfma_f32_16x16x32_bf16 v[48:51], a[140:143], v[172:175], v[48:51]
  v_cvt_pk_bf16_f32 v2, v4, v5
  v_mfma_f32_16x16x32_bf16 v[56:59], a[140:143], v[188:191], v[204:207]
  v_exp_f32 v6, v6
  v_mfma_f32_16x16x32_bf16 v[56:59], a[136:139], v[184:187], v[56:59]
  buffer_load_dwordx4 v234, s[12:15], s29 offen offset:2048 lds
  v_mfma_f32_16x16x32_bf16 v[56:59], a[132:135], v[180:183], v[56:59]
  s_waitcnt lgkmcnt(0)
  v_exp_f32 v7, v7
  v_mfma_f32_16x16x32_bf16 v[56:59], a[128:131], v[176:179], v[56:59]
  v_cvt_pk_bf16_f32 v3, v6, v7
  v_mfma_f32_16x16x32_bf16 v[36:39], a[144:147], v[128:131], v[192:195]
  v_exp_f32 v12, v12
  v_mfma_f32_16x16x32_bf16 v[36:39], a[148:151], v[132:135], v[36:39]
  ds_read_b64_tr_b16 a[160:161], v216 offset:49152
  v_mfma_f32_16x16x32_bf16 v[36:39], a[152:155], v[136:139], v[36:39]
  v_exp_f32 v13, v13
  v_mfma_f32_16x16x32_bf16 v[36:39], a[156:159], v[140:143], v[36:39]
  ds_read_b64_tr_b16 a[162:163], v216 offset:53248
  v_cvt_pk_bf16_f32 v10, v12, v13
  v_mfma_f32_16x16x32_bf16 v[44:47], a[156:159], v[156:159], v[196:199]
  v_exp_f32 v14, v14
  v_mfma_f32_16x16x32_bf16 v[44:47], a[152:155], v[152:155], v[44:47]
  ds_read_b64_tr_b16 a[164:165], v216 offset:57344
  buffer_load_dwordx4 v235, s[12:15], s29 offen offset:3072 lds
  v_mfma_f32_16x16x32_bf16 v[44:47], a[148:151], v[148:151], v[44:47]
  v_exp_f32 v15, v15
  v_mfma_f32_16x16x32_bf16 v[44:47], a[144:147], v[144:147], v[44:47]
  ds_read_b64_tr_b16 a[166:167], v216 offset:61440
  v_cvt_pk_bf16_f32 v11, v14, v15
  v_mfma_f32_16x16x32_bf16 v[52:55], a[144:147], v[160:163], v[200:203]
  s_add_u32 m0, s50, 4096
  v_exp_f32 v20, v20
  v_mfma_f32_16x16x32_bf16 v[52:55], a[148:151], v[164:167], v[52:55]
  ds_read_b64_tr_b16 a[168:169], v217 offset:49152
  buffer_load_dwordx4 v208, s[20:23], s30 offen lds
  s_add_u32 s30, s30, 32
  v_mfma_f32_16x16x32_bf16 v[52:55], a[152:155], v[168:171], v[52:55]
  v_exp_f32 v21, v21
  v_mfma_f32_16x16x32_bf16 v[52:55], a[156:159], v[172:175], v[52:55]
  ds_read_b64_tr_b16 a[170:171], v217 offset:53248
  v_cvt_pk_bf16_f32 v18, v20, v21
  v_mfma_f32_16x16x32_bf16 v[60:63], a[156:159], v[188:191], v[204:207]
  v_exp_f32 v22, v22
  v_mfma_f32_16x16x32_bf16 v[60:63], a[152:155], v[184:187], v[60:63]
  ds_read_b64_tr_b16 a[172:173], v217 offset:57344
  v_mfma_f32_16x16x32_bf16 v[60:63], a[148:151], v[180:183], v[60:63]
  v_exp_f32 v23, v23
  v_mfma_f32_16x16x32_bf16 v[60:63], a[144:147], v[176:179], v[60:63]
  ds_read_b64_tr_b16 a[174:175], v217 offset:61440
  v_cvt_pk_bf16_f32 v19, v22, v23
  v_mfma_f32_16x16x32_bf16 a[192:195], a[208:211], v[64:67], a[192:195]
  v_exp_f32 v28, v28
  v_mfma_f32_16x16x32_bf16 a[192:195], a[208:211], v[96:99], a[192:195]
  ds_read_b64_tr_b16 a[176:177], v218 offset:49152
  v_mfma_f32_16x16x32_bf16 a[196:199], a[208:211], v[72:75], a[196:199]
  v_exp_f32 v29, v29
  v_mfma_f32_16x16x32_bf16 a[196:199], a[208:211], v[104:107], a[196:199]
  ds_read_b64_tr_b16 a[178:179], v218 offset:53248
  v_cvt_pk_bf16_f32 v26, v28, v29
  v_mfma_f32_16x16x32_bf16 a[200:203], a[208:211], v[80:83], a[200:203]
  v_exp_f32 v30, v30
  v_mfma_f32_16x16x32_bf16 a[200:203], a[208:211], v[112:115], a[200:203]
  ds_read_b64_tr_b16 a[180:181], v218 offset:57344
  v_mfma_f32_16x16x32_bf16 a[204:207], a[208:211], v[88:91], a[204:207]
  s_waitcnt lgkmcnt(7)
  v_exp_f32 v31, v31
  v_mfma_f32_16x16x32_bf16 a[204:207], a[208:211], v[120:123], a[204:207]
  ds_read_b64_tr_b16 a[182:183], v218 offset:61440
  v_cvt_pk_bf16_f32 v27, v30, v31
  v_mfma_f32_16x16x32_bf16 a[0:3], a[160:163], v[64:67], a[0:3]
  v_exp_f32 v32, v32
  v_mfma_f32_16x16x32_bf16 a[0:3], a[164:167], v[96:99], a[0:3]
  ds_read_b64_tr_b16 a[184:185], v219 offset:49152
  v_mfma_f32_16x16x32_bf16 a[4:7], a[164:167], v[104:107], a[4:7]
  v_exp_f32 v33, v33
  v_mfma_f32_16x16x32_bf16 a[4:7], a[160:163], v[72:75], a[4:7]
  ds_read_b64_tr_b16 a[186:187], v219 offset:53248
  v_cvt_pk_bf16_f32 v32, v32, v33
  v_mfma_f32_16x16x32_bf16 a[8:11], a[160:163], v[80:83], a[8:11]
  v_exp_f32 v34, v34
  v_mfma_f32_16x16x32_bf16 a[8:11], a[164:167], v[112:115], a[8:11]
  ds_read_b64_tr_b16 a[188:189], v219 offset:57344
  v_mfma_f32_16x16x32_bf16 a[12:15], a[164:167], v[120:123], a[12:15]
  s_waitcnt lgkmcnt(7)
  v_exp_f32 v35, v35
  v_mfma_f32_16x16x32_bf16 a[12:15], a[160:163], v[88:91], a[12:15]
  ds_read_b64_tr_b16 a[190:191], v219 offset:61440
  v_cvt_pk_bf16_f32 v33, v34, v35
  v_mfma_f32_16x16x32_bf16 a[16:19], a[168:171], v[64:67], a[16:19]
  v_exp_f32 v40, v40
  v_mfma_f32_16x16x32_bf16 a[16:19], a[172:175], v[96:99], a[16:19]
  ds_read_b64_tr_b16 a[160:161], v220 offset:49152
  v_mfma_f32_16x16x32_bf16 a[20:23], a[172:175], v[104:107], a[20:23]
  v_exp_f32 v41, v41
  v_mfma_f32_16x16x32_bf16 a[20:23], a[168:171], v[72:75], a[20:23]
  ds_read_b64_tr_b16 a[162:163], v220 offset:53248
  v_cvt_pk_bf16_f32 v40, v40, v41
  v_mfma_f32_16x16x32_bf16 a[24:27], a[168:171], v[80:83], a[24:27]
  v_exp_f32 v42, v42
  v_mfma_f32_16x16x32_bf16 a[24:27], a[172:175], v[112:115], a[24:27]
  ds_read_b64_tr_b16 a[164:165], v220 offset:57344
  v_mfma_f32_16x16x32_bf16 a[28:31], a[172:175], v[120:123], a[28:31]
  s_waitcnt lgkmcnt(7)
  v_exp_f32 v43, v43
  v_mfma_f32_16x16x32_bf16 a[28:31], a[168:171], v[88:91], a[28:31]
  ds_read_b64_tr_b16 a[166:167], v220 offset:61440
  v_cvt_pk_bf16_f32 v41, v42, v43
  v_mfma_f32_16x16x32_bf16 a[32:35], a[176:179], v[64:67], a[32:35]
  v_exp_f32 v48, v48
  v_mfma_f32_16x16x32_bf16 a[32:35], a[180:183], v[96:99], a[32:35]
  ds_read_b64_tr_b16 a[168:169], v221 offset:49152
  v_mfma_f32_16x16x32_bf16 a[36:39], a[180:183], v[104:107], a[36:39]
  v_exp_f32 v49, v49
  v_mfma_f32_16x16x32_bf16 a[36:39], a[176:179], v[72:75], a[36:39]
  ds_read_b64_tr_b16 a[170:171], v221 offset:53248
  v_cvt_pk_bf16_f32 v48, v48, v49
  v_mfma_f32_16x16x32_bf16 a[40:43], a[176:179], v[80:83], a[40:43]
  v_exp_f32 v50, v50
  v_mfma_f32_16x16x32_bf16 a[40:43], a[180:183], v[112:115], a[40:43]
  ds_read_b64_tr_b16 a[172:173], v221 offset:57344
  v_mfma_f32_16x16x32_bf16 a[44:47], a[180:183], v[120:123], a[44:47]
  s_waitcnt lgkmcnt(7)
  v_exp_f32 v51, v51
  v_mfma_f32_16x16x32_bf16 a[44:47], a[176:179], v[88:91], a[44:47]
  ds_read_b64_tr_b16 a[174:175], v221 offset:61440
  v_cvt_pk_bf16_f32 v49, v50, v51
  v_mfma_f32_16x16x32_bf16 a[48:51], a[184:187], v[64:67], a[48:51]
  v_exp_f32 v56, v56
  v_mfma_f32_16x16x32_bf16 a[48:51], a[188:191], v[96:99], a[48:51]
  ds_read_b64_tr_b16 a[176:177], v222 offset:49152
  v_mfma_f32_16x16x32_bf16 a[52:55], a[188:191], v[104:107], a[52:55]
  v_exp_f32 v57, v57
  v_mfma_f32_16x16x32_bf16 a[52:55], a[184:187], v[72:75], a[52:55]
  ds_read_b64_tr_b16 a[178:179], v222 offset:53248
  v_cvt_pk_bf16_f32 v56, v56, v57
  v_mfma_f32_16x16x32_bf16 a[56:59], a[184:187], v[80:83], a[56:59]
  v_exp_f32 v58, v58
  v_mfma_f32_16x16x32_bf16 a[56:59], a[188:191], v[112:115], a[56:59]
  ds_read_b64_tr_b16 a[180:181], v222 offset:57344
  global_load_dword v255, v252, s[8:9]
  v_mfma_f32_16x16x32_bf16 a[60:63], a[188:191], v[120:123], a[60:63]
  s_waitcnt lgkmcnt(7)
  v_exp_f32 v59, v59
  v_mfma_f32_16x16x32_bf16 a[60:63], a[184:187], v[88:91], a[60:63]
  ds_read_b64_tr_b16 a[182:183], v222 offset:61440
  v_cvt_pk_bf16_f32 v57, v58, v59
  v_mfma_f32_16x16x32_bf16 a[64:67], a[160:163], v[64:67], a[64:67]
  v_exp_f32 v36, v36
  v_mfma_f32_16x16x32_bf16 a[64:67], a[164:167], v[96:99], a[64:67]
  ds_read_b64_tr_b16 a[184:185], v223 offset:49152
  v_mfma_f32_16x16x32_bf16 a[68:71], a[164:167], v[104:107], a[68:71]
  v_exp_f32 v37, v37
  v_mfma_f32_16x16x32_bf16 a[68:71], a[160:163], v[72:75], a[68:71]
  ds_read_b64_tr_b16 a[186:187], v223 offset:53248
  v_cvt_pk_bf16_f32 v34, v36, v37
  v_mfma_f32_16x16x32_bf16 a[72:75], a[160:163], v[80:83], a[72:75]
  v_exp_f32 v38, v38
  v_mfma_f32_16x16x32_bf16 a[72:75], a[164:167], v[112:115], a[72:75]
  ds_read_b64_tr_b16 a[188:189], v223 offset:57344
  v_mfma_f32_16x16x32_bf16 a[76:79], a[164:167], v[120:123], a[76:79]
  s_waitcnt lgkmcnt(7)
  v_exp_f32 v39, v39
  v_mfma_f32_16x16x32_bf16 a[76:79], a[160:163], v[88:91], a[76:79]
  ds_read_b64_tr_b16 a[190:191], v223 offset:61440
  v_cvt_pk_bf16_f32 v35, v38, v39
  v_mfma_f32_16x16x32_bf16 a[80:83], a[168:171], v[64:67], a[80:83]
  s_waitcnt vmcnt(12)
  v_exp_f32 v44, v44
  v_mfma_f32_16x16x32_bf16 a[80:83], a[172:175], v[96:99], a[80:83]
  v_mfma_f32_16x16x32_bf16 a[84:87], a[172:175], v[104:107], a[84:87]
  s_barrier
  v_exp_f32 v45, v45
  v_mfma_f32_16x16x32_bf16 a[84:87], a[168:171], v[72:75], a[84:87]
  ds_read_b128 a[128:131], v212 offset:16384
  v_cvt_pk_bf16_f32 v42, v44, v45
  v_mfma_f32_16x16x32_bf16 a[88:91], a[168:171], v[80:83], a[88:91]
  v_exp_f32 v46, v46
  v_mfma_f32_16x16x32_bf16 a[88:91], a[172:175], v[112:115], a[88:91]
  ds_read_b128 a[132:135], v213 offset:16384
  v_mfma_f32_16x16x32_bf16 a[92:95], a[172:175], v[120:123], a[92:95]
  s_waitcnt lgkmcnt(6)
  v_exp_f32 v47, v47
  v_mfma_f32_16x16x32_bf16 a[92:95], a[168:171], v[88:91], a[92:95]
  ds_read_b128 a[136:139], v214 offset:16384
  v_cvt_pk_bf16_f32 v43, v46, v47
  v_mfma_f32_16x16x32_bf16 a[96:99], a[176:179], v[64:67], a[96:99]
  v_exp_f32 v52, v52
  v_mfma_f32_16x16x32_bf16 a[96:99], a[180:183], v[96:99], a[96:99]
  ds_read_b128 a[140:143], v215 offset:16384
  v_mfma_f32_16x16x32_bf16 a[100:103], a[180:183], v[104:107], a[100:103]
  v_exp_f32 v53, v53
  v_mfma_f32_16x16x32_bf16 a[100:103], a[176:179], v[72:75], a[100:103]
  v_cvt_pk_bf16_f32 v50, v52, v53
  v_mfma_f32_16x16x32_bf16 a[104:107], a[176:179], v[80:83], a[104:107]
  v_exp_f32 v54, v54
  v_mfma_f32_16x16x32_bf16 a[104:107], a[180:183], v[112:115], a[104:107]
  v_mfma_f32_16x16x32_bf16 a[108:111], a[180:183], v[120:123], a[108:111]
  s_waitcnt lgkmcnt(4)
  v_exp_f32 v55, v55
  v_mfma_f32_16x16x32_bf16 a[108:111], a[176:179], v[88:91], a[108:111]
  v_cvt_pk_bf16_f32 v51, v54, v55
  v_mfma_f32_16x16x32_bf16 a[112:115], a[184:187], v[64:67], a[112:115]
  v_exp_f32 v60, v60
  v_mfma_f32_16x16x32_bf16 a[112:115], a[188:191], v[96:99], a[112:115]
  v_mfma_f32_16x16x32_bf16 a[116:119], a[188:191], v[104:107], a[116:119]
  v_exp_f32 v61, v61
  v_mfma_f32_16x16x32_bf16 a[116:119], a[184:187], v[72:75], a[116:119]
  v_cvt_pk_bf16_f32 v58, v60, v61
  v_mfma_f32_16x16x32_bf16 a[120:123], a[184:187], v[80:83], a[120:123]
  v_exp_f32 v62, v62
  v_mfma_f32_16x16x32_bf16 a[120:123], a[188:191], v[112:115], a[120:123]
  v_mfma_f32_16x16x32_bf16 a[124:127], a[188:191], v[120:123], a[124:127]
  s_waitcnt lgkmcnt(0)
  v_exp_f32 v63, v63
  v_mfma_f32_16x16x32_bf16 a[124:127], a[184:187], v[88:91], a[124:127]
  v_cvt_pk_bf16_f32 v59, v62, v63
  v_mfma_f32_16x16x32_bf16 v[64:67], a[128:131], v[128:131], v[192:195]
  s_add_u32 m0, s28, 98304
  v_mfma_f32_16x16x32_bf16 v[64:67], a[132:135], v[132:135], v[64:67]
  ds_read_b128 a[144:147], v212 offset:20480
  v_mfma_f32_16x16x32_bf16 v[64:67], a[136:139], v[136:139], v[64:67]
  buffer_load_dwordx4 v236, s[16:19], s29 offen offset:0 lds
  v_mfma_f32_16x16x32_bf16 v[64:67], a[140:143], v[140:143], v[64:67]
  ds_read_b128 a[148:151], v213 offset:20480
  v_mfma_f32_16x16x32_bf16 v[72:75], a[140:143], v[156:159], v[196:199]
  v_mfma_f32_16x16x32_bf16 v[72:75], a[136:139], v[152:155], v[72:75]
  ds_read_b128 a[152:155], v214 offset:20480
  v_mfma_f32_16x16x32_bf16 v[72:75], a[132:135], v[148:151], v[72:75]
  buffer_load_dwordx4 v237, s[16:19], s29 offen offset:1024 lds
  v_mfma_f32_16x16x32_bf16 v[72:75], a[128:131], v[144:147], v[72:75]
  ds_read_b128 a[156:159], v215 offset:20480
  v_mfma_f32_16x16x32_bf16 v[80:83], a[128:131], v[160:163], v[200:203]
  v_exp_f32 v64, v64
  v_mfma_f32_16x16x32_bf16 v[80:83], a[132:135], v[164:167], v[80:83]
  v_mfma_f32_16x16x32_bf16 v[80:83], a[136:139], v[168:171], v[80:83]
  v_exp_f32 v65, v65
  v_mfma_f32_16x16x32_bf16 v[80:83], a[140:143], v[172:175], v[80:83]
  v_cvt_pk_bf16_f32 v64, v64, v65
  v_mfma_f32_16x16x32_bf16 v[88:91], a[140:143], v[188:191], v[204:207]
  v_exp_f32 v66, v66
  v_mfma_f32_16x16x32_bf16 v[88:91], a[136:139], v[184:187], v[88:91]
  buffer_load_dwordx4 v236, s[16:19], s29 offen offset:2048 lds
  v_mfma_f32_16x16x32_bf16 v[88:91], a[132:135], v[180:183], v[88:91]
  s_waitcnt lgkmcnt(0)
  v_exp_f32 v67, v67
  v_mfma_f32_16x16x32_bf16 v[88:91], a[128:131], v[176:179], v[88:91]
  v_cvt_pk_bf16_f32 v65, v66, v67
  v_mfma_f32_16x16x32_bf16 v[68:71], a[144:147], v[128:131], v[192:195]
  v_exp_f32 v72, v72
  v_mfma_f32_16x16x32_bf16 v[68:71], a[148:151], v[132:135], v[68:71]
  ds_read_b128 a[128:131], v212 offset:24576
  v_mfma_f32_16x16x32_bf16 v[68:71], a[152:155], v[136:139], v[68:71]
  v_exp_f32 v73, v73
  v_mfma_f32_16x16x32_bf16 v[68:71], a[156:159], v[140:143], v[68:71]
  ds_read_b128 a[132:135], v213 offset:24576
  v_cvt_pk_bf16_f32 v72, v72, v73
  v_mfma_f32_16x16x32_bf16 v[76:79], a[156:159], v[156:159], v[196:199]
  v_exp_f32 v74, v74
  v_mfma_f32_16x16x32_bf16 v[76:79], a[152:155], v[152:155], v[76:79]
  ds_read_b128 a[136:139], v214 offset:24576
  v_mfma_f32_16x16x32_bf16 v[76:79], a[148:151], v[148:151], v[76:79]
  v_exp_f32 v75, v75
  v_mfma_f32_16x16x32_bf16 v[76:79], a[144:147], v[144:147], v[76:79]
  ds_read_b128 a[140:143], v215 offset:24576
  v_cvt_pk_bf16_f32 v73, v74, v75
  v_mfma_f32_16x16x32_bf16 v[84:87], a[144:147], v[160:163], v[200:203]
  v_exp_f32 v80, v80
  v_mfma_f32_16x16x32_bf16 v[84:87], a[148:151], v[164:167], v[84:87]
  buffer_load_dwordx4 v237, s[16:19], s29 offen offset:3072 lds
  v_mfma_f32_16x16x32_bf16 v[84:87], a[152:155], v[168:171], v[84:87]
  s_add_u32 s29, s29, 16384
  v_exp_f32 v81, v81
  v_mfma_f32_16x16x32_bf16 v[84:87], a[156:159], v[172:175], v[84:87]
  v_cvt_pk_bf16_f32 v80, v80, v81
  v_mfma_f32_16x16x32_bf16 v[92:95], a[156:159], v[188:191], v[204:207]
  s_add_u32 m0, s28, 49152
  v_exp_f32 v82, v82
  v_mfma_f32_16x16x32_bf16 v[92:95], a[152:155], v[184:187], v[92:95]
  buffer_load_dwordx4 v232, s[12:15], s29 offen offset:0 lds
  v_mfma_f32_16x16x32_bf16 v[92:95], a[148:151], v[180:183], v[92:95]
  s_waitcnt lgkmcnt(0)
  v_exp_f32 v83, v83
  v_mfma_f32_16x16x32_bf16 v[92:95], a[144:147], v[176:179], v[92:95]
  v_cvt_pk_bf16_f32 v81, v82, v83
  v_mfma_f32_16x16x32_bf16 v[96:99], a[128:131], v[128:131], v[192:195]
  v_exp_f32 v88, v88
  v_mfma_f32_16x16x32_bf16 v[96:99], a[132:135], v[132:135], v[96:99]
  ds_read_b128 a[144:147], v212 offset:28672
  v_mfma_f32_16x16x32_bf16 v[96:99], a[136:139], v[136:139], v[96:99]
  v_exp_f32 v89, v89
  v_mfma_f32_16x16x32_bf16 v[96:99], a[140:143], v[140:143], v[96:99]
  ds_read_b128 a[148:151], v213 offset:28672
  v_cvt_pk_bf16_f32 v88, v88, v89
  v_mfma_f32_16x16x32_bf16 v[104:107], a[140:143], v[156:159], v[196:199]
  v_exp_f32 v90, v90
  v_mfma_f32_16x16x32_bf16 v[104:107], a[136:139], v[152:155], v[104:107]
  ds_read_b128 a[152:155], v214 offset:28672
  v_mfma_f32_16x16x32_bf16 v[104:107], a[132:135], v[148:151], v[104:107]
  v_exp_f32 v91, v91
  v_mfma_f32_16x16x32_bf16 v[104:107], a[128:131], v[144:147], v[104:107]
  ds_read_b128 a[156:159], v215 offset:28672
  v_cvt_pk_bf16_f32 v89, v90, v91
  v_mfma_f32_16x16x32_bf16 v[112:115], a[128:131], v[160:163], v[200:203]
  v_exp_f32 v68, v68
  v_mfma_f32_16x16x32_bf16 v[112:115], a[132:135], v[164:167], v[112:115]
  buffer_load_dwordx4 v233, s[12:15], s29 offen offset:1024 lds
  v_mfma_f32_16x16x32_bf16 v[112:115], a[136:139], v[168:171], v[112:115]
  v_exp_f32 v69, v69
  v_mfma_f32_16x16x32_bf16 v[112:115], a[140:143], v[172:175], v[112:115]
  v_cvt_pk_bf16_f32 v66, v68, v69
  v_mfma_f32_16x16x32_bf16 v[120:123], a[140:143], v[188:191], v[204:207]
  v_exp_f32 v70, v70
  v_mfma_f32_16x16x32_bf16 v[120:123], a[136:139], v[184:187], v[120:123]
  buffer_load_dwordx4 v234, s[12:15], s29 offen offset:2048 lds
  v_mfma_f32_16x16x32_bf16 v[120:123], a[132:135], v[180:183], v[120:123]
  s_waitcnt lgkmcnt(0)
  v_exp_f32 v71, v71
  v_mfma_f32_16x16x32_bf16 v[120:123], a[128:131], v[176:179], v[120:123]
  v_cvt_pk_bf16_f32 v67, v70, v71
  v_mfma_f32_16x16x32_bf16 v[100:103], a[144:147], v[128:131], v[192:195]
  v_exp_f32 v76, v76
  v_mfma_f32_16x16x32_bf16 v[100:103], a[148:151], v[132:135], v[100:103]
  ds_read_b64_tr_b16 a[160:161], v216 offset:0
  v_mfma_f32_16x16x32_bf16 v[100:103], a[152:155], v[136:139], v[100:103]
  v_exp_f32 v77, v77
  v_mfma_f32_16x16x32_bf16 v[100:103], a[156:159], v[140:143], v[100:103]
  ds_read_b64_tr_b16 a[162:163], v216 offset:4096
  v_cvt_pk_bf16_f32 v74, v76, v77
  v_mfma_f32_16x16x32_bf16 v[108:111], a[156:159], v[156:159], v[196:199]
  v_exp_f32 v78, v78
  v_mfma_f32_16x16x32_bf16 v[108:111], a[152:155], v[152:155], v[108:111]
  ds_read_b64_tr_b16 a[164:165], v216 offset:8192
  buffer_load_dwordx4 v235, s[12:15], s29 offen offset:3072 lds
  v_mfma_f32_16x16x32_bf16 v[108:111], a[148:151], v[148:151], v[108:111]
  v_exp_f32 v79, v79
  v_mfma_f32_16x16x32_bf16 v[108:111], a[144:147], v[144:147], v[108:111]
  ds_read_b64_tr_b16 a[166:167], v216 offset:12288
  v_cvt_pk_bf16_f32 v75, v78, v79
  v_mfma_f32_16x16x32_bf16 v[116:119], a[144:147], v[160:163], v[200:203]
  s_add_u32 m0, s50, 5120
  v_exp_f32 v84, v84
  v_mfma_f32_16x16x32_bf16 v[116:119], a[148:151], v[164:167], v[116:119]
  ds_read_b64_tr_b16 a[168:169], v217 offset:0
  buffer_load_dwordx4 v208, s[20:23], s30 offen lds
  s_add_u32 s30, s30, 32
  v_mfma_f32_16x16x32_bf16 v[116:119], a[152:155], v[168:171], v[116:119]
  v_exp_f32 v85, v85
  v_mfma_f32_16x16x32_bf16 v[116:119], a[156:159], v[172:175], v[116:119]
  ds_read_b64_tr_b16 a[170:171], v217 offset:4096
  v_cvt_pk_bf16_f32 v82, v84, v85
  v_mfma_f32_16x16x32_bf16 v[124:127], a[156:159], v[188:191], v[204:207]
  v_exp_f32 v86, v86
  v_mfma_f32_16x16x32_bf16 v[124:127], a[152:155], v[184:187], v[124:127]
  ds_read_b64_tr_b16 a[172:173], v217 offset:8192
  v_mfma_f32_16x16x32_bf16 v[124:127], a[148:151], v[180:183], v[124:127]
  v_exp_f32 v87, v87
  v_mfma_f32_16x16x32_bf16 v[124:127], a[144:147], v[176:179], v[124:127]
  ds_read_b64_tr_b16 a[174:175], v217 offset:12288
  v_cvt_pk_bf16_f32 v83, v86, v87
  v_mfma_f32_16x16x32_bf16 a[192:195], a[208:211], v[0:3], a[192:195]
  v_exp_f32 v92, v92
  v_mfma_f32_16x16x32_bf16 a[192:195], a[208:211], v[32:35], a[192:195]
  ds_read_b64_tr_b16 a[176:177], v218 offset:0
  v_mfma_f32_16x16x32_bf16 a[196:199], a[208:211], v[8:11], a[196:199]
  v_exp_f32 v93, v93
  v_mfma_f32_16x16x32_bf16 a[196:199], a[208:211], v[40:43], a[196:199]
  ds_read_b64_tr_b16 a[178:179], v218 offset:4096
  v_cvt_pk_bf16_f32 v90, v92, v93
  v_mfma_f32_16x16x32_bf16 a[200:203], a[208:211], v[16:19], a[200:203]
  v_exp_f32 v94, v94
  v_mfma_f32_16x16x32_bf16 a[200:203], a[208:211], v[48:51], a[200:203]
  ds_read_b64_tr_b16 a[180:181], v218 offset:8192
  v_mfma_f32_16x16x32_bf16 a[204:207], a[208:211], v[24:27], a[204:207]
  s_waitcnt lgkmcnt(7)
  v_exp_f32 v95, v95
  v_mfma_f32_16x16x32_bf16 a[204:207], a[208:211], v[56:59], a[204:207]
  ds_read_b64_tr_b16 a[182:183], v218 offset:12288
  v_cvt_pk_bf16_f32 v91, v94, v95
  v_mfma_f32_16x16x32_bf16 a[0:3], a[160:163], v[0:3], a[0:3]
  v_exp_f32 v96, v96
  v_mfma_f32_16x16x32_bf16 a[0:3], a[164:167], v[32:35], a[0:3]
  ds_read_b64_tr_b16 a[184:185], v219 offset:0
  v_mfma_f32_16x16x32_bf16 a[4:7], a[164:167], v[40:43], a[4:7]
  v_exp_f32 v97, v97
  v_mfma_f32_16x16x32_bf16 a[4:7], a[160:163], v[8:11], a[4:7]
  ds_read_b64_tr_b16 a[186:187], v219 offset:4096
  v_cvt_pk_bf16_f32 v96, v96, v97
  v_mfma_f32_16x16x32_bf16 a[8:11], a[160:163], v[16:19], a[8:11]
  v_exp_f32 v98, v98
  v_mfma_f32_16x16x32_bf16 a[8:11], a[164:167], v[48:51], a[8:11]
  ds_read_b64_tr_b16 a[188:189], v219 offset:8192
  v_mfma_f32_16x16x32_bf16 a[12:15], a[164:167], v[56:59], a[12:15]
  s_waitcnt lgkmcnt(7)
  v_exp_f32 v99, v99
  v_mfma_f32_16x16x32_bf16 a[12:15], a[160:163], v[24:27], a[12:15]
  ds_read_b64_tr_b16 a[190:191], v219 offset:12288
  v_cvt_pk_bf16_f32 v97, v98, v99
  v_mfma_f32_16x16x32_bf16 a[16:19], a[168:171], v[0:3], a[16:19]
  v_exp_f32 v104, v104
  v_mfma_f32_16x16x32_bf16 a[16:19], a[172:175], v[32:35], a[16:19]
  ds_read_b64_tr_b16 a[160:161], v220 offset:0
  v_mfma_f32_16x16x32_bf16 a[20:23], a[172:175], v[40:43], a[20:23]
  v_exp_f32 v105, v105
  v_mfma_f32_16x16x32_bf16 a[20:23], a[168:171], v[8:11], a[20:23]
  ds_read_b64_tr_b16 a[162:163], v220 offset:4096
  v_cvt_pk_bf16_f32 v104, v104, v105
  v_mfma_f32_16x16x32_bf16 a[24:27], a[168:171], v[16:19], a[24:27]
  v_exp_f32 v106, v106
  v_mfma_f32_16x16x32_bf16 a[24:27], a[172:175], v[48:51], a[24:27]
  ds_read_b64_tr_b16 a[164:165], v220 offset:8192
  v_mfma_f32_16x16x32_bf16 a[28:31], a[172:175], v[56:59], a[28:31]
  s_waitcnt lgkmcnt(7)
  v_exp_f32 v107, v107
  v_mfma_f32_16x16x32_bf16 a[28:31], a[168:171], v[24:27], a[28:31]
  ds_read_b64_tr_b16 a[166:167], v220 offset:12288
  v_cvt_pk_bf16_f32 v105, v106, v107
  v_mfma_f32_16x16x32_bf16 a[32:35], a[176:179], v[0:3], a[32:35]
  v_exp_f32 v112, v112
  v_mfma_f32_16x16x32_bf16 a[32:35], a[180:183], v[32:35], a[32:35]
  ds_read_b64_tr_b16 a[168:169], v221 offset:0
  v_mfma_f32_16x16x32_bf16 a[36:39], a[180:183], v[40:43], a[36:39]
  v_exp_f32 v113, v113
  v_mfma_f32_16x16x32_bf16 a[36:39], a[176:179], v[8:11], a[36:39]
  ds_read_b64_tr_b16 a[170:171], v221 offset:4096
  v_cvt_pk_bf16_f32 v112, v112, v113
  v_mfma_f32_16x16x32_bf16 a[40:43], a[176:179], v[16:19], a[40:43]
  v_exp_f32 v114, v114
  v_mfma_f32_16x16x32_bf16 a[40:43], a[180:183], v[48:51], a[40:43]
  ds_read_b64_tr_b16 a[172:173], v221 offset:8192
  v_mfma_f32_16x16x32_bf16 a[44:47], a[180:183], v[56:59], a[44:47]
  s_waitcnt lgkmcnt(7)
  v_exp_f32 v115, v115
  v_mfma_f32_16x16x32_bf16 a[44:47], a[176:179], v[24:27], a[44:47]
  ds_read_b64_tr_b16 a[174:175], v221 offset:12288
  v_cvt_pk_bf16_f32 v113, v114, v115
  v_mfma_f32_16x16x32_bf16 a[48:51], a[184:187], v[0:3], a[48:51]
  v_exp_f32 v120, v120
  v_mfma_f32_16x16x32_bf16 a[48:51], a[188:191], v[32:35], a[48:51]
  ds_read_b64_tr_b16 a[176:177], v222 offset:0
  v_mfma_f32_16x16x32_bf16 a[52:55], a[188:191], v[40:43], a[52:55]
  v_exp_f32 v121, v121
  v_mfma_f32_16x16x32_bf16 a[52:55], a[184:187], v[8:11], a[52:55]
  ds_read_b64_tr_b16 a[178:179], v222 offset:4096
  v_cvt_pk_bf16_f32 v120, v120, v121
  v_mfma_f32_16x16x32_bf16 a[56:59], a[184:187], v[16:19], a[56:59]
  v_exp_f32 v122, v122
  v_mfma_f32_16x16x32_bf16 a[56:59], a[188:191], v[48:51], a[56:59]
  ds_read_b64_tr_b16 a[180:181], v222 offset:8192
  v_mfma_f32_16x16x32_bf16 a[60:63], a[188:191], v[56:59], a[60:63]
  s_waitcnt lgkmcnt(7)
  v_exp_f32 v123, v123
  v_mfma_f32_16x16x32_bf16 a[60:63], a[184:187], v[24:27], a[60:63]
  ds_read_b64_tr_b16 a[182:183], v222 offset:12288
  v_cvt_pk_bf16_f32 v121, v122, v123
  v_mfma_f32_16x16x32_bf16 a[64:67], a[160:163], v[0:3], a[64:67]
  v_exp_f32 v100, v100
  v_mfma_f32_16x16x32_bf16 a[64:67], a[164:167], v[32:35], a[64:67]
  ds_read_b64_tr_b16 a[184:185], v223 offset:0
  v_mfma_f32_16x16x32_bf16 a[68:71], a[164:167], v[40:43], a[68:71]
  v_exp_f32 v101, v101
  v_mfma_f32_16x16x32_bf16 a[68:71], a[160:163], v[8:11], a[68:71]
  ds_read_b64_tr_b16 a[186:187], v223 offset:4096
  v_cvt_pk_bf16_f32 v98, v100, v101
  v_mfma_f32_16x16x32_bf16 a[72:75], a[160:163], v[16:19], a[72:75]
  v_exp_f32 v102, v102
  v_mfma_f32_16x16x32_bf16 a[72:75], a[164:167], v[48:51], a[72:75]
  ds_read_b64_tr_b16 a[188:189], v223 offset:8192
  v_mfma_f32_16x16x32_bf16 a[76:79], a[164:167], v[56:59], a[76:79]
  s_waitcnt lgkmcnt(7)
  v_exp_f32 v103, v103
  v_mfma_f32_16x16x32_bf16 a[76:79], a[160:163], v[24:27], a[76:79]
  ds_read_b64_tr_b16 a[190:191], v223 offset:12288
  v_cvt_pk_bf16_f32 v99, v102, v103
  v_mfma_f32_16x16x32_bf16 a[80:83], a[168:171], v[0:3], a[80:83]
  s_waitcnt vmcnt(11)
  v_exp_f32 v108, v108
  v_mfma_f32_16x16x32_bf16 a[80:83], a[172:175], v[32:35], a[80:83]
  v_mfma_f32_16x16x32_bf16 a[84:87], a[172:175], v[40:43], a[84:87]
  s_barrier
  v_exp_f32 v109, v109
  v_mfma_f32_16x16x32_bf16 a[84:87], a[168:171], v[8:11], a[84:87]
  ds_read_b128 a[128:131], v212 offset:32768
  v_cvt_pk_bf16_f32 v106, v108, v109
  v_mfma_f32_16x16x32_bf16 a[88:91], a[168:171], v[16:19], a[88:91]
  v_exp_f32 v110, v110
  v_mfma_f32_16x16x32_bf16 a[88:91], a[172:175], v[48:51], a[88:91]
  ds_read_b128 a[132:135], v213 offset:32768
  buffer_atomic_add v250, v249, s[24:27], s47 offen
  s_cmp_eq_u32 s32, 3
  s_cselect_b32 s39, 0, 1073741824
  v_mfma_f32_16x16x32_bf16 a[92:95], a[172:175], v[56:59], a[92:95]
  s_waitcnt lgkmcnt(6)
  v_exp_f32 v111, v111
  v_mfma_f32_16x16x32_bf16 a[92:95], a[168:171], v[24:27], a[92:95]
  ds_read_b128 a[136:139], v214 offset:32768
  v_cvt_pk_bf16_f32 v107, v110, v111
  v_mfma_f32_16x16x32_bf16 a[96:99], a[176:179], v[0:3], a[96:99]
  v_exp_f32 v116, v116
  v_mfma_f32_16x16x32_bf16 a[96:99], a[180:183], v[32:35], a[96:99]
  ds_read_b128 a[140:143], v215 offset:32768
  v_or_b32 v249, s39, v251
  v_mfma_f32_16x16x32_bf16 a[100:103], a[180:183], v[40:43], a[100:103]
  v_exp_f32 v117, v117
  v_mfma_f32_16x16x32_bf16 a[100:103], a[176:179], v[8:11], a[100:103]
  v_cvt_pk_bf16_f32 v114, v116, v117
  v_mfma_f32_16x16x32_bf16 a[104:107], a[176:179], v[16:19], a[104:107]
  v_exp_f32 v118, v118
  v_mfma_f32_16x16x32_bf16 a[104:107], a[180:183], v[48:51], a[104:107]
  v_mfma_f32_16x16x32_bf16 a[108:111], a[180:183], v[56:59], a[108:111]
  s_waitcnt lgkmcnt(4)
  v_exp_f32 v119, v119
  v_mfma_f32_16x16x32_bf16 a[108:111], a[176:179], v[24:27], a[108:111]
  v_cvt_pk_bf16_f32 v115, v118, v119
  v_mfma_f32_16x16x32_bf16 a[112:115], a[184:187], v[0:3], a[112:115]
  v_exp_f32 v124, v124
  v_mfma_f32_16x16x32_bf16 a[112:115], a[188:191], v[32:35], a[112:115]
  v_mfma_f32_16x16x32_bf16 a[116:119], a[188:191], v[40:43], a[116:119]
  v_exp_f32 v125, v125
  v_mfma_f32_16x16x32_bf16 a[116:119], a[184:187], v[8:11], a[116:119]
  v_cvt_pk_bf16_f32 v122, v124, v125
  v_mfma_f32_16x16x32_bf16 a[120:123], a[184:187], v[16:19], a[120:123]
  v_exp_f32 v126, v126
  v_mfma_f32_16x16x32_bf16 a[120:123], a[188:191], v[48:51], a[120:123]
  v_mfma_f32_16x16x32_bf16 a[124:127], a[188:191], v[56:59], a[124:127]
  s_waitcnt lgkmcnt(0)
  v_exp_f32 v127, v127
  v_mfma_f32_16x16x32_bf16 a[124:127], a[184:187], v[24:27], a[124:127]
  v_cvt_pk_bf16_f32 v123, v126, v127
  v_mfma_f32_16x16x32_bf16 v[0:3], a[128:131], v[128:131], v[192:195]
  s_add_u32 m0, s28, 114688
  v_mfma_f32_16x16x32_bf16 v[0:3], a[132:135], v[132:135], v[0:3]
  ds_read_b128 a[144:147], v212 offset:36864
  v_mfma_f32_16x16x32_bf16 v[0:3], a[136:139], v[136:139], v[0:3]
  buffer_load_dwordx4 v236, s[16:19], s29 offen offset:0 lds
  v_mfma_f32_16x16x32_bf16 v[0:3], a[140:143], v[140:143], v[0:3]
  ds_read_b128 a[148:151], v213 offset:36864
  v_mfma_f32_16x16x32_bf16 v[8:11], a[140:143], v[156:159], v[196:199]
  v_mfma_f32_16x16x32_bf16 v[8:11], a[136:139], v[152:155], v[8:11]
  ds_read_b128 a[152:155], v214 offset:36864
  v_mfma_f32_16x16x32_bf16 v[8:11], a[132:135], v[148:151], v[8:11]
  buffer_load_dwordx4 v237, s[16:19], s29 offen offset:1024 lds
  v_mfma_f32_16x16x32_bf16 v[8:11], a[128:131], v[144:147], v[8:11]
  ds_read_b128 a[156:159], v215 offset:36864
  v_mfma_f32_16x16x32_bf16 v[16:19], a[128:131], v[160:163], v[200:203]
  v_exp_f32 v0, v0
  v_mfma_f32_16x16x32_bf16 v[16:19], a[132:135], v[164:167], v[16:19]
  v_mfma_f32_16x16x32_bf16 v[16:19], a[136:139], v[168:171], v[16:19]
  v_exp_f32 v1, v1
  v_mfma_f32_16x16x32_bf16 v[16:19], a[140:143], v[172:175], v[16:19]
  v_cvt_pk_bf16_f32 v0, v0, v1
  v_mfma_f32_16x16x32_bf16 v[24:27], a[140:143], v[188:191], v[204:207]
  v_exp_f32 v2, v2
  v_mfma_f32_16x16x32_bf16 v[24:27], a[136:139], v[184:187], v[24:27]
  buffer_load_dwordx4 v236, s[16:19], s29 offen offset:2048 lds
  v_mfma_f32_16x16x32_bf16 v[24:27], a[132:135], v[180:183], v[24:27]
  s_waitcnt lgkmcnt(0)
  v_exp_f32 v3, v3
  v_mfma_f32_16x16x32_bf16 v[24:27], a[128:131], v[176:179], v[24:27]
  v_cvt_pk_bf16_f32 v1, v2, v3
  v_mfma_f32_16x16x32_bf16 v[4:7], a[144:147], v[128:131], v[192:195]
  v_exp_f32 v8, v8
  v_mfma_f32_16x16x32_bf16 v[4:7], a[148:151], v[132:135], v[4:7]
  ds_read_b128 a[128:131], v212 offset:40960
  v_mfma_f32_16x16x32_bf16 v[4:7], a[152:155], v[136:139], v[4:7]
  v_exp_f32 v9, v9
  v_mfma_f32_16x16x32_bf16 v[4:7], a[156:159], v[140:143], v[4:7]
  ds_read_b128 a[132:135], v213 offset:40960
  v_cvt_pk_bf16_f32 v8, v8, v9
  v_mfma_f32_16x16x32_bf16 v[12:15], a[156:159], v[156:159], v[196:199]
  v_exp_f32 v10, v10
  v_mfma_f32_16x16x32_bf16 v[12:15], a[152:155], v[152:155], v[12:15]
  ds_read_b128 a[136:139], v214 offset:40960
  v_mfma_f32_16x16x32_bf16 v[12:15], a[148:151], v[148:151], v[12:15]
  v_exp_f32 v11, v11
  v_mfma_f32_16x16x32_bf16 v[12:15], a[144:147], v[144:147], v[12:15]
  ds_read_b128 a[140:143], v215 offset:40960
  v_cvt_pk_bf16_f32 v9, v10, v11
  v_mfma_f32_16x16x32_bf16 v[20:23], a[144:147], v[160:163], v[200:203]
  v_exp_f32 v16, v16
  v_mfma_f32_16x16x32_bf16 v[20:23], a[148:151], v[164:167], v[20:23]
  buffer_load_dwordx4 v237, s[16:19], s29 offen offset:3072 lds
  v_mfma_f32_16x16x32_bf16 v[20:23], a[152:155], v[168:171], v[20:23]
  s_add_u32 s29, s29, 16384
  v_exp_f32 v17, v17
  v_mfma_f32_16x16x32_bf16 v[20:23], a[156:159], v[172:175], v[20:23]
  v_cvt_pk_bf16_f32 v16, v16, v17
  v_mfma_f32_16x16x32_bf16 v[28:31], a[156:159], v[188:191], v[204:207]
  s_add_u32 m0, s28, 0
  v_exp_f32 v18, v18
  v_mfma_f32_16x16x32_bf16 v[28:31], a[152:155], v[184:187], v[28:31]
  buffer_load_dwordx4 v232, s[12:15], s29 offen offset:0 lds
  v_mfma_f32_16x16x32_bf16 v[28:31], a[148:151], v[180:183], v[28:31]
  s_waitcnt lgkmcnt(0)
  v_exp_f32 v19, v19
  v_mfma_f32_16x16x32_bf16 v[28:31], a[144:147], v[176:179], v[28:31]
  v_cvt_pk_bf16_f32 v17, v18, v19
  v_mfma_f32_16x16x32_bf16 v[32:35], a[128:131], v[128:131], v[192:195]
  v_exp_f32 v24, v24
  v_mfma_f32_16x16x32_bf16 v[32:35], a[132:135], v[132:135], v[32:35]
  ds_read_b128 a[144:147], v212 offset:45056
  v_mfma_f32_16x16x32_bf16 v[32:35], a[136:139], v[136:139], v[32:35]
  v_exp_f32 v25, v25
  v_mfma_f32_16x16x32_bf16 v[32:35], a[140:143], v[140:143], v[32:35]
  ds_read_b128 a[148:151], v213 offset:45056
  v_cvt_pk_bf16_f32 v24, v24, v25
  v_mfma_f32_16x16x32_bf16 v[40:43], a[140:143], v[156:159], v[196:199]
  v_exp_f32 v26, v26
  v_mfma_f32_16x16x32_bf16 v[40:43], a[136:139], v[152:155], v[40:43]
  ds_read_b128 a[152:155], v214 offset:45056
  v_mfma_f32_16x16x32_bf16 v[40:43], a[132:135], v[148:151], v[40:43]
  v_exp_f32 v27, v27
  v_mfma_f32_16x16x32_bf16 v[40:43], a[128:131], v[144:147], v[40:43]
  ds_read_b128 a[156:159], v215 offset:45056
  v_cvt_pk_bf16_f32 v25, v26, v27
  v_mfma_f32_16x16x32_bf16 v[48:51], a[128:131], v[160:163], v[200:203]
  v_exp_f32 v4, v4
  v_mfma_f32_16x16x32_bf16 v[48:51], a[132:135], v[164:167], v[48:51]
  buffer_load_dwordx4 v233, s[12:15], s29 offen offset:1024 lds
  v_mfma_f32_16x16x32_bf16 v[48:51], a[136:139], v[168:171], v[48:51]
  v_exp_f32 v5, v5
  v_mfma_f32_16x16x32_bf16 v[48:51], a[140:143], v[172:175], v[48:51]
  v_cvt_pk_bf16_f32 v2, v4, v5
  v_mfma_f32_16x16x32_bf16 v[56:59], a[140:143], v[188:191], v[204:207]
  v_exp_f32 v6, v6
  v_mfma_f32_16x16x32_bf16 v[56:59], a[136:139], v[184:187], v[56:59]
  buffer_load_dwordx4 v234, s[12:15], s29 offen offset:2048 lds
  v_mfma_f32_16x16x32_bf16 v[56:59], a[132:135], v[180:183], v[56:59]
  s_waitcnt lgkmcnt(0)
  v_exp_f32 v7, v7
  v_mfma_f32_16x16x32_bf16 v[56:59], a[128:131], v[176:179], v[56:59]
  v_cvt_pk_bf16_f32 v3, v6, v7
  v_mfma_f32_16x16x32_bf16 v[36:39], a[144:147], v[128:131], v[192:195]
  v_exp_f32 v12, v12
  v_mfma_f32_16x16x32_bf16 v[36:39], a[148:151], v[132:135], v[36:39]
  ds_read_b64_tr_b16 a[160:161], v216 offset:16384
  v_mfma_f32_16x16x32_bf16 v[36:39], a[152:155], v[136:139], v[36:39]
  v_exp_f32 v13, v13
  v_mfma_f32_16x16x32_bf16 v[36:39], a[156:159], v[140:143], v[36:39]
  ds_read_b64_tr_b16 a[162:163], v216 offset:20480
  v_cvt_pk_bf16_f32 v10, v12, v13
  v_mfma_f32_16x16x32_bf16 v[44:47], a[156:159], v[156:159], v[196:199]
  v_exp_f32 v14, v14
  v_mfma_f32_16x16x32_bf16 v[44:47], a[152:155], v[152:155], v[44:47]
  ds_read_b64_tr_b16 a[164:165], v216 offset:24576
  buffer_load_dwordx4 v235, s[12:15], s29 offen offset:3072 lds
  v_mfma_f32_16x16x32_bf16 v[44:47], a[148:151], v[148:151], v[44:47]
  v_exp_f32 v15, v15
  v_mfma_f32_16x16x32_bf16 v[44:47], a[144:147], v[144:147], v[44:47]
  ds_read_b64_tr_b16 a[166:167], v216 offset:28672
  v_cvt_pk_bf16_f32 v11, v14, v15
  v_mfma_f32_16x16x32_bf16 v[52:55], a[144:147], v[160:163], v[200:203]
  s_mov_b32 m0, s51
  v_exp_f32 v20, v20
  v_mfma_f32_16x16x32_bf16 v[52:55], a[148:151], v[164:167], v[52:55]
  ds_read_b64_tr_b16 a[168:169], v217 offset:16384
  buffer_load_dwordx4 v210, s[4:7], s100 offen lds
  s_add_u32 s100, s100, 20480
  s_add_u32 s51, s51, 512
  v_mfma_f32_16x16x32_bf16 v[52:55], a[152:155], v[168:171], v[52:55]
  v_exp_f32 v21, v21
  v_mfma_f32_16x16x32_bf16 v[52:55], a[156:159], v[172:175], v[52:55]
  ds_read_b64_tr_b16 a[170:171], v217 offset:20480
  v_cvt_pk_bf16_f32 v18, v20, v21
  v_mfma_f32_16x16x32_bf16 v[60:63], a[156:159], v[188:191], v[204:207]
  s_waitcnt vmcnt(20)
  v_exp_f32 v22, v22
  v_mfma_f32_16x16x32_bf16 v[60:63], a[152:155], v[184:187], v[60:63]
  ds_read_b64_tr_b16 a[172:173], v217 offset:24576
  ds_read_b64_tr_b16 a[232:233], v209 offset:4096
  v_mfma_f32_16x16x32_bf16 v[60:63], a[148:151], v[180:183], v[60:63]
  v_exp_f32 v23, v23
  v_mfma_f32_16x16x32_bf16 v[60:63], a[144:147], v[176:179], v[60:63]
  ds_read_b64_tr_b16 a[174:175], v217 offset:28672
  v_cvt_pk_bf16_f32 v19, v22, v23
  v_mfma_f32_16x16x32_bf16 a[192:195], a[208:211], v[64:67], a[192:195]
  v_exp_f32 v28, v28
  v_mfma_f32_16x16x32_bf16 a[192:195], a[208:211], v[96:99], a[192:195]
  ds_read_b64_tr_b16 a[176:177], v218 offset:16384
  ds_read_b64_tr_b16 a[234:235], v209 offset:4608
  v_mfma_f32_16x16x32_bf16 a[196:199], a[208:211], v[72:75], a[196:199]
  v_exp_f32 v29, v29
  v_mfma_f32_16x16x32_bf16 a[196:199], a[208:211], v[104:107], a[196:199]
  ds_read_b64_tr_b16 a[178:179], v218 offset:20480
  v_cvt_pk_bf16_f32 v26, v28, v29
  v_mfma_f32_16x16x32_bf16 a[200:203], a[208:211], v[80:83], a[200:203]
  v_exp_f32 v30, v30
  v_mfma_f32_16x16x32_bf16 a[200:203], a[208:211], v[112:115], a[200:203]
  ds_read_b64_tr_b16 a[180:181], v218 offset:24576
  v_mfma_f32_16x16x32_bf16 a[204:207], a[208:211], v[88:91], a[204:207]
  s_waitcnt lgkmcnt(9)
  v_exp_f32 v31, v31
  v_mfma_f32_16x16x32_bf16 a[204:207], a[208:211], v[120:123], a[204:207]
  ds_read_b64_tr_b16 a[182:183], v218 offset:28672
  v_cvt_pk_bf16_f32 v27, v30, v31
  v_mfma_f32_16x16x32_bf16 a[0:3], a[160:163], v[64:67], a[0:3]
  v_exp_f32 v32, v32
  v_mfma_f32_16x16x32_bf16 a[0:3], a[164:167], v[96:99], a[0:3]
  ds_read_b64_tr_b16 a[184:185], v219 offset:16384
  s_waitcnt lgkmcnt(4)
  buffer_store_dwordx4 a[232:235], v211, s[24:27], s31 offen sc1
  s_add_u32 s31, s31, 1024
  s_cmp_gt_u32 s32, 3
  v_mfma_f32_16x16x32_bf16 a[4:7], a[164:167], v[104:107], a[4:7]
  s_cselect_b32 s39, 0, 1073741824
  v_exp_f32 v33, v33
  v_mfma_f32_16x16x32_bf16 a[4:7], a[160:163], v[72:75], a[4:7]
  ds_read_b64_tr_b16 a[186:187], v219 offset:20480
  v_cvt_pk_bf16_f32 v32, v32, v33
  v_mfma_f32_16x16x32_bf16 a[8:11], a[160:163], v[80:83], a[8:11]
  v_exp_f32 v34, v34
  v_mfma_f32_16x16x32_bf16 a[8:11], a[164:167], v[112:115], a[8:11]
  ds_read_b64_tr_b16 a[188:189], v219 offset:24576
  v_or_b32 v211, s39, v211
  v_mfma_f32_16x16x32_bf16 a[12:15], a[164:167], v[120:123], a[12:15]
  v_exp_f32 v35, v35
  v_mfma_f32_16x16x32_bf16 a[12:15], a[160:163], v[88:91], a[12:15]
  ds_read_b64_tr_b16 a[190:191], v219 offset:28672
  v_cvt_pk_bf16_f32 v33, v34, v35
  v_mfma_f32_16x16x32_bf16 a[16:19], a[168:171], v[64:67], a[16:19]
  v_exp_f32 v40, v40
  v_mfma_f32_16x16x32_bf16 a[16:19], a[172:175], v[96:99], a[16:19]
  ds_read_b64_tr_b16 a[160:161], v220 offset:16384
  v_or_b32 v208, s39, v208
  v_mfma_f32_16x16x32_bf16 a[20:23], a[172:175], v[104:107], a[20:23]
  v_exp_f32 v41, v41
  v_mfma_f32_16x16x32_bf16 a[20:23], a[168:171], v[72:75], a[20:23]
  ds_read_b64_tr_b16 a[162:163], v220 offset:20480
  v_cvt_pk_bf16_f32 v40, v40, v41
  v_mfma_f32_16x16x32_bf16 a[24:27], a[168:171], v[80:83], a[24:27]
  v_exp_f32 v42, v42
  v_mfma_f32_16x16x32_bf16 a[24:27], a[172:175], v[112:115], a[24:27]
  ds_read_b64_tr_b16 a[164:165], v220 offset:24576
  v_mfma_f32_16x16x32_bf16 a[28:31], a[172:175], v[120:123], a[28:31]
  s_waitcnt lgkmcnt(7)
  v_exp_f32 v43, v43
  v_mfma_f32_16x16x32_bf16 a[28:31], a[168:171], v[88:91], a[28:31]
  ds_read_b64_tr_b16 a[166:167], v220 offset:28672
  v_cvt_pk_bf16_f32 v41, v42, v43
  v_mfma_f32_16x16x32_bf16 a[32:35], a[176:179], v[64:67], a[32:35]
  v_exp_f32 v48, v48
  v_mfma_f32_16x16x32_bf16 a[32:35], a[180:183], v[96:99], a[32:35]
  ds_read_b64_tr_b16 a[168:169], v221 offset:16384
  v_mfma_f32_16x16x32_bf16 a[36:39], a[180:183], v[104:107], a[36:39]
  v_exp_f32 v49, v49
  v_mfma_f32_16x16x32_bf16 a[36:39], a[176:179], v[72:75], a[36:39]
  ds_read_b64_tr_b16 a[170:171], v221 offset:20480
  v_cvt_pk_bf16_f32 v48, v48, v49
  v_mfma_f32_16x16x32_bf16 a[40:43], a[176:179], v[80:83], a[40:43]
  v_exp_f32 v50, v50
  v_mfma_f32_16x16x32_bf16 a[40:43], a[180:183], v[112:115], a[40:43]
  ds_read_b64_tr_b16 a[172:173], v221 offset:24576
  v_mfma_f32_16x16x32_bf16 a[44:47], a[180:183], v[120:123], a[44:47]
  s_waitcnt lgkmcnt(7)
  v_exp_f32 v51, v51
  v_mfma_f32_16x16x32_bf16 a[44:47], a[176:179], v[88:91], a[44:47]
  ds_read_b64_tr_b16 a[174:175], v221 offset:28672
  v_cvt_pk_bf16_f32 v49, v50, v51
  v_mfma_f32_16x16x32_bf16 a[48:51], a[184:187], v[64:67], a[48:51]
  v_exp_f32 v56, v56
  v_mfma_f32_16x16x32_bf16 a[48:51], a[188:191], v[96:99], a[48:51]
  ds_read_b64_tr_b16 a[176:177], v222 offset:16384
  v_mfma_f32_16x16x32_bf16 a[52:55], a[188:191], v[104:107], a[52:55]
  v_exp_f32 v57, v57
  v_mfma_f32_16x16x32_bf16 a[52:55], a[184:187], v[72:75], a[52:55]
  ds_read_b64_tr_b16 a[178:179], v222 offset:20480
  v_cvt_pk_bf16_f32 v56, v56, v57
  v_mfma_f32_16x16x32_bf16 a[56:59], a[184:187], v[80:83], a[56:59]
  v_exp_f32 v58, v58
  v_mfma_f32_16x16x32_bf16 a[56:59], a[188:191], v[112:115], a[56:59]
  ds_read_b64_tr_b16 a[180:181], v222 offset:24576
  v_mfma_f32_16x16x32_bf16 a[60:63], a[188:191], v[120:123], a[60:63]
  s_waitcnt lgkmcnt(7)
  v_exp_f32 v59, v59
  v_mfma_f32_16x16x32_bf16 a[60:63], a[184:187], v[88:91], a[60:63]
  ds_read_b64_tr_b16 a[182:183], v222 offset:28672
  v_cvt_pk_bf16_f32 v57, v58, v59
  v_mfma_f32_16x16x32_bf16 a[64:67], a[160:163], v[64:67], a[64:67]
  v_exp_f32 v36, v36
  v_mfma_f32_16x16x32_bf16 a[64:67], a[164:167], v[96:99], a[64:67]
  ds_read_b64_tr_b16 a[184:185], v223 offset:16384
  v_mfma_f32_16x16x32_bf16 a[68:71], a[164:167], v[104:107], a[68:71]
  v_exp_f32 v37, v37
  v_mfma_f32_16x16x32_bf16 a[68:71], a[160:163], v[72:75], a[68:71]
  ds_read_b64_tr_b16 a[186:187], v223 offset:20480
  v_cvt_pk_bf16_f32 v34, v36, v37
  v_mfma_f32_16x16x32_bf16 a[72:75], a[160:163], v[80:83], a[72:75]
  v_exp_f32 v38, v38
  v_mfma_f32_16x16x32_bf16 a[72:75], a[164:167], v[112:115], a[72:75]
  ds_read_b64_tr_b16 a[188:189], v223 offset:24576
  v_mfma_f32_16x16x32_bf16 a[76:79], a[164:167], v[120:123], a[76:79]
  s_waitcnt lgkmcnt(7)
  v_exp_f32 v39, v39
  v_mfma_f32_16x16x32_bf16 a[76:79], a[160:163], v[88:91], a[76:79]
  ds_read_b64_tr_b16 a[190:191], v223 offset:28672
  v_cvt_pk_bf16_f32 v35, v38, v39
  v_mfma_f32_16x16x32_bf16 a[80:83], a[168:171], v[64:67], a[80:83]
  s_waitcnt vmcnt(12)
  v_exp_f32 v44, v44
  v_mfma_f32_16x16x32_bf16 a[80:83], a[172:175], v[96:99], a[80:83]
  v_mfma_f32_16x16x32_bf16 a[84:87], a[172:175], v[104:107], a[84:87]
  s_barrier
  v_exp_f32 v45, v45
  v_mfma_f32_16x16x32_bf16 a[84:87], a[168:171], v[72:75], a[84:87]
  ds_read_b128 a[128:131], v212 offset:49152
  v_cvt_pk_bf16_f32 v42, v44, v45
  v_mfma_f32_16x16x32_bf16 a[88:91], a[168:171], v[80:83], a[88:91]
  v_exp_f32 v46, v46
  v_mfma_f32_16x16x32_bf16 a[88:91], a[172:175], v[112:115], a[88:91]
  ds_read_b128 a[132:135], v213 offset:49152
  v_mfma_f32_16x16x32_bf16 a[92:95], a[172:175], v[120:123], a[92:95]
  s_waitcnt lgkmcnt(6)
  v_exp_f32 v47, v47
  v_mfma_f32_16x16x32_bf16 a[92:95], a[168:171], v[88:91], a[92:95]
  ds_read_b128 a[136:139], v214 offset:49152
  v_cvt_pk_bf16_f32 v43, v46, v47
  v_mfma_f32_16x16x32_bf16 a[96:99], a[176:179], v[64:67], a[96:99]
  v_exp_f32 v52, v52
  v_mfma_f32_16x16x32_bf16 a[96:99], a[180:183], v[96:99], a[96:99]
  ds_read_b128 a[140:143], v215 offset:49152
  v_mfma_f32_16x16x32_bf16 a[100:103], a[180:183], v[104:107], a[100:103]
  v_exp_f32 v53, v53
  v_mfma_f32_16x16x32_bf16 a[100:103], a[176:179], v[72:75], a[100:103]
  v_cvt_pk_bf16_f32 v50, v52, v53
  v_mfma_f32_16x16x32_bf16 a[104:107], a[176:179], v[80:83], a[104:107]
  v_exp_f32 v54, v54
  v_mfma_f32_16x16x32_bf16 a[104:107], a[180:183], v[112:115], a[104:107]
  v_mfma_f32_16x16x32_bf16 a[108:111], a[180:183], v[120:123], a[108:111]
  s_waitcnt lgkmcnt(4)
  v_exp_f32 v55, v55
  v_mfma_f32_16x16x32_bf16 a[108:111], a[176:179], v[88:91], a[108:111]
  v_cvt_pk_bf16_f32 v51, v54, v55
  v_mfma_f32_16x16x32_bf16 a[112:115], a[184:187], v[64:67], a[112:115]
  v_exp_f32 v60, v60
  v_mfma_f32_16x16x32_bf16 a[112:115], a[188:191], v[96:99], a[112:115]
  v_mfma_f32_16x16x32_bf16 a[116:119], a[188:191], v[104:107], a[116:119]
  v_exp_f32 v61, v61
  v_mfma_f32_16x16x32_bf16 a[116:119], a[184:187], v[72:75], a[116:119]
  v_cvt_pk_bf16_f32 v58, v60, v61
  v_mfma_f32_16x16x32_bf16 a[120:123], a[184:187], v[80:83], a[120:123]
  v_exp_f32 v62, v62
  v_mfma_f32_16x16x32_bf16 a[120:123], a[188:191], v[112:115], a[120:123]
  v_mfma_f32_16x16x32_bf16 a[124:127], a[188:191], v[120:123], a[124:127]
  s_waitcnt lgkmcnt(0)
  v_exp_f32 v63, v63
  v_mfma_f32_16x16x32_bf16 a[124:127], a[184:187], v[88:91], a[124:127]
  v_cvt_pk_bf16_f32 v59, v62, v63
  v_mfma_f32_16x16x32_bf16 v[64:67], a[128:131], v[128:131], v[192:195]
  s_add_u32 m0, s28, 65536
  v_mfma_f32_16x16x32_bf16 v[64:67], a[132:135], v[132:135], v[64:67]
  ds_read_b128 a[144:147], v212 offset:53248
  v_mfma_f32_16x16x32_bf16 v[64:67], a[136:139], v[136:139], v[64:67]
  buffer_load_dwordx4 v236, s[16:19], s29 offen offset:0 lds
  v_mfma_f32_16x16x32_bf16 v[64:67], a[140:143], v[140:143], v[64:67]
  ds_read_b128 a[148:151], v213 offset:53248
  v_mfma_f32_16x16x32_bf16 v[72:75], a[140:143], v[156:159], v[196:199]
  v_mfma_f32_16x16x32_bf16 v[72:75], a[136:139], v[152:155], v[72:75]
  ds_read_b128 a[152:155], v214 offset:53248
  v_mfma_f32_16x16x32_bf16 v[72:75], a[132:135], v[148:151], v[72:75]
  buffer_load_dwordx4 v237, s[16:19], s29 offen offset:1024 lds
  v_mfma_f32_16x16x32_bf16 v[72:75], a[128:131], v[144:147], v[72:75]
  ds_read_b128 a[156:159], v215 offset:53248
  v_mfma_f32_16x16x32_bf16 v[80:83], a[128:131], v[160:163], v[200:203]
  v_exp_f32 v64, v64
  v_mfma_f32_16x16x32_bf16 v[80:83], a[132:135], v[164:167], v[80:83]
  v_mfma_f32_16x16x32_bf16 v[80:83], a[136:139], v[168:171], v[80:83]
  v_exp_f32 v65, v65
  v_mfma_f32_16x16x32_bf16 v[80:83], a[140:143], v[172:175], v[80:83]
  v_cvt_pk_bf16_f32 v64, v64, v65
  v_mfma_f32_16x16x32_bf16 v[88:91], a[140:143], v[188:191], v[204:207]
  v_exp_f32 v66, v66
  v_mfma_f32_16x16x32_bf16 v[88:91], a[136:139], v[184:187], v[88:91]
  buffer_load_dwordx4 v236, s[16:19], s29 offen offset:2048 lds
  v_mfma_f32_16x16x32_bf16 v[88:91], a[132:135], v[180:183], v[88:91]
  s_waitcnt lgkmcnt(0)
  v_exp_f32 v67, v67
  v_mfma_f32_16x16x32_bf16 v[88:91], a[128:131], v[176:179], v[88:91]
  v_cvt_pk_bf16_f32 v65, v66, v67
  v_mfma_f32_16x16x32_bf16 v[68:71], a[144:147], v[128:131], v[192:195]
  v_exp_f32 v72, v72
  v_mfma_f32_16x16x32_bf16 v[68:71], a[148:151], v[132:135], v[68:71]
  ds_read_b128 a[128:131], v212 offset:57344
  v_mfma_f32_16x16x32_bf16 v[68:71], a[152:155], v[136:139], v[68:71]
  v_exp_f32 v73, v73
  v_mfma_f32_16x16x32_bf16 v[68:71], a[156:159], v[140:143], v[68:71]
  ds_read_b128 a[132:135], v213 offset:57344
  v_cvt_pk_bf16_f32 v72, v72, v73
  v_mfma_f32_16x16x32_bf16 v[76:79], a[156:159], v[156:159], v[196:199]
  v_exp_f32 v74, v74
  v_mfma_f32_16x16x32_bf16 v[76:79], a[152:155], v[152:155], v[76:79]
  ds_read_b128 a[136:139], v214 offset:57344
  v_mfma_f32_16x16x32_bf16 v[76:79], a[148:151], v[148:151], v[76:79]
  v_exp_f32 v75, v75
  v_mfma_f32_16x16x32_bf16 v[76:79], a[144:147], v[144:147], v[76:79]
  ds_read_b128 a[140:143], v215 offset:57344
  v_cvt_pk_bf16_f32 v73, v74, v75
  v_mfma_f32_16x16x32_bf16 v[84:87], a[144:147], v[160:163], v[200:203]
  v_exp_f32 v80, v80
  v_mfma_f32_16x16x32_bf16 v[84:87], a[148:151], v[164:167], v[84:87]
  buffer_load_dwordx4 v237, s[16:19], s29 offen offset:3072 lds
  v_mfma_f32_16x16x32_bf16 v[84:87], a[152:155], v[168:171], v[84:87]
  s_add_u32 s29, s29, 16384
  v_exp_f32 v81, v81
  v_mfma_f32_16x16x32_bf16 v[84:87], a[156:159], v[172:175], v[84:87]
  v_cvt_pk_bf16_f32 v80, v80, v81
  v_mfma_f32_16x16x32_bf16 v[92:95], a[156:159], v[188:191], v[204:207]
  s_add_u32 m0, s28, 16384
  v_exp_f32 v82, v82
  v_mfma_f32_16x16x32_bf16 v[92:95], a[152:155], v[184:187], v[92:95]
  buffer_load_dwordx4 v232, s[12:15], s29 offen offset:0 lds
  v_mfma_f32_16x16x32_bf16 v[92:95], a[148:151], v[180:183], v[92:95]
  s_waitcnt lgkmcnt(0)
  v_exp_f32 v83, v83
  v_mfma_f32_16x16x32_bf16 v[92:95], a[144:147], v[176:179], v[92:95]
  v_cvt_pk_bf16_f32 v81, v82, v83
  v_mfma_f32_16x16x32_bf16 v[96:99], a[128:131], v[128:131], v[192:195]
  v_exp_f32 v88, v88
  v_mfma_f32_16x16x32_bf16 v[96:99], a[132:135], v[132:135], v[96:99]
  ds_read_b128 a[144:147], v212 offset:61440
  v_mfma_f32_16x16x32_bf16 v[96:99], a[136:139], v[136:139], v[96:99]
  v_exp_f32 v89, v89
  v_mfma_f32_16x16x32_bf16 v[96:99], a[140:143], v[140:143], v[96:99]
  ds_read_b128 a[148:151], v213 offset:61440
  v_cvt_pk_bf16_f32 v88, v88, v89
  v_mfma_f32_16x16x32_bf16 v[104:107], a[140:143], v[156:159], v[196:199]
  v_exp_f32 v90, v90
  v_mfma_f32_16x16x32_bf16 v[104:107], a[136:139], v[152:155], v[104:107]
  ds_read_b128 a[152:155], v214 offset:61440
  v_mfma_f32_16x16x32_bf16 v[104:107], a[132:135], v[148:151], v[104:107]
  v_exp_f32 v91, v91
  v_mfma_f32_16x16x32_bf16 v[104:107], a[128:131], v[144:147], v[104:107]
  ds_read_b128 a[156:159], v215 offset:61440
  v_cvt_pk_bf16_f32 v89, v90, v91
  v_mfma_f32_16x16x32_bf16 v[112:115], a[128:131], v[160:163], v[200:203]
  v_exp_f32 v68, v68
  v_mfma_f32_16x16x32_bf16 v[112:115], a[132:135], v[164:167], v[112:115]
  buffer_load_dwordx4 v233, s[12:15], s29 offen offset:1024 lds
  v_mfma_f32_16x16x32_bf16 v[112:115], a[136:139], v[168:171], v[112:115]
  v_exp_f32 v69, v69
  v_mfma_f32_16x16x32_bf16 v[112:115], a[140:143], v[172:175], v[112:115]
  v_cvt_pk_bf16_f32 v66, v68, v69
  v_mfma_f32_16x16x32_bf16 v[120:123], a[140:143], v[188:191], v[204:207]
  v_exp_f32 v70, v70
  v_mfma_f32_16x16x32_bf16 v[120:123], a[136:139], v[184:187], v[120:123]
  buffer_load_dwordx4 v234, s[12:15], s29 offen offset:2048 lds
  v_mfma_f32_16x16x32_bf16 v[120:123], a[132:135], v[180:183], v[120:123]
  s_waitcnt lgkmcnt(0)
  v_exp_f32 v71, v71
  v_mfma_f32_16x16x32_bf16 v[120:123], a[128:131], v[176:179], v[120:123]
  v_cvt_pk_bf16_f32 v67, v70, v71
  v_mfma_f32_16x16x32_bf16 v[100:103], a[144:147], v[128:131], v[192:195]
  v_exp_f32 v76, v76
  v_mfma_f32_16x16x32_bf16 v[100:103], a[148:151], v[132:135], v[100:103]
  ds_read_b64_tr_b16 a[160:161], v216 offset:32768
  v_mfma_f32_16x16x32_bf16 v[100:103], a[152:155], v[136:139], v[100:103]
  v_exp_f32 v77, v77
  v_mfma_f32_16x16x32_bf16 v[100:103], a[156:159], v[140:143], v[100:103]
  ds_read_b64_tr_b16 a[162:163], v216 offset:36864
  v_cvt_pk_bf16_f32 v74, v76, v77
  v_mfma_f32_16x16x32_bf16 v[108:111], a[156:159], v[156:159], v[196:199]
  v_exp_f32 v78, v78
  v_mfma_f32_16x16x32_bf16 v[108:111], a[152:155], v[152:155], v[108:111]
  ds_read_b64_tr_b16 a[164:165], v216 offset:40960
  buffer_load_dwordx4 v235, s[12:15], s29 offen offset:3072 lds
  v_mfma_f32_16x16x32_bf16 v[108:111], a[148:151], v[148:151], v[108:111]
  v_exp_f32 v79, v79
  v_mfma_f32_16x16x32_bf16 v[108:111], a[144:147], v[144:147], v[108:111]
  ds_read_b64_tr_b16 a[166:167], v216 offset:45056
  v_cvt_pk_bf16_f32 v75, v78, v79
  v_mfma_f32_16x16x32_bf16 v[116:119], a[144:147], v[160:163], v[200:203]
  v_exp_f32 v84, v84
  v_mfma_f32_16x16x32_bf16 v[116:119], a[148:151], v[164:167], v[116:119]
  ds_read_b64_tr_b16 a[168:169], v217 offset:32768
  buffer_load_dword v254, off, s[24:27], s47 sc1
  v_mfma_f32_16x16x32_bf16 v[116:119], a[152:155], v[168:171], v[116:119]
  v_exp_f32 v85, v85
  v_mfma_f32_16x16x32_bf16 v[116:119], a[156:159], v[172:175], v[116:119]
  ds_read_b64_tr_b16 a[170:171], v217 offset:36864
  v_cvt_pk_bf16_f32 v82, v84, v85
  v_mfma_f32_16x16x32_bf16 v[124:127], a[156:159], v[188:191], v[204:207]
  s_waitcnt vmcnt(20)
  v_exp_f32 v86, v86
  v_mfma_f32_16x16x32_bf16 v[124:127], a[152:155], v[184:187], v[124:127]
  ds_read_b64_tr_b16 a[172:173], v217 offset:40960
  ds_read_b64_tr_b16 a[232:233], v209 offset:5120
  v_mfma_f32_16x16x32_bf16 v[124:127], a[148:151], v[180:183], v[124:127]
  v_exp_f32 v87, v87
  v_mfma_f32_16x16x32_bf16 v[124:127], a[144:147], v[176:179], v[124:127]
  ds_read_b64_tr_b16 a[174:175], v217 offset:45056
  v_cvt_pk_bf16_f32 v83, v86, v87
  v_mfma_f32_16x16x32_bf16 a[192:195], a[208:211], v[0:3], a[192:195]
  v_exp_f32 v92, v92
  v_mfma_f32_16x16x32_bf16 a[192:195], a[208:211], v[32:35], a[192:195]
  ds_read_b64_tr_b16 a[176:177], v218 offset:32768
  ds_read_b64_tr_b16 a[234:235], v209 offset:5632
  v_mfma_f32_16x16x32_bf16 a[196:199], a[208:211], v[8:11], a[196:199]
  v_exp_f32 v93, v93
  v_mfma_f32_16x16x32_bf16 a[196:199], a[208:211], v[40:43], a[196:199]
  ds_read_b64_tr_b16 a[178:179], v218 offset:36864
  v_cvt_pk_bf16_f32 v90, v92, v93
  v_mfma_f32_16x16x32_bf16 a[200:203], a[208:211], v[16:19], a[200:203]
  v_exp_f32 v94, v94
  v_mfma_f32_16x16x32_bf16 a[200:203], a[208:211], v[48:51], a[200:203]
  ds_read_b64_tr_b16 a[180:181], v218 offset:40960
  v_mfma_f32_16x16x32_bf16 a[204:207], a[208:211], v[24:27], a[204:207]
  s_waitcnt lgkmcnt(9)
  v_exp_f32 v95, v95
  v_mfma_f32_16x16x32_bf16 a[204:207], a[208:211], v[56:59], a[204:207]
  ds_read_b64_tr_b16 a[182:183], v218 offset:45056
  v_cvt_pk_bf16_f32 v91, v94, v95
  v_mfma_f32_16x16x32_bf16 a[0:3], a[160:163], v[0:3], a[0:3]
  v_exp_f32 v96, v96
  v_mfma_f32_16x16x32_bf16 a[0:3], a[164:167], v[32:35], a[0:3]
  ds_read_b64_tr_b16 a[184:185], v219 offset:32768
  s_waitcnt lgkmcnt(4)
  buffer_store_dwordx4 a[232:235], v211, s[24:27], s31 offen sc1
  s_add_u32 s31, s31, 1024
  v_mfma_f32_16x16x32_bf16 a[4:7], a[164:167], v[40:43], a[4:7]
  v_exp_f32 v97, v97
  v_mfma_f32_16x16x32_bf16 a[4:7], a[160:163], v[8:11], a[4:7]
  ds_read_b64_tr_b16 a[186:187], v219 offset:36864
  v_cvt_pk_bf16_f32 v96, v96, v97
  v_mfma_f32_16x16x32_bf16 a[8:11], a[160:163], v[16:19], a[8:11]
  v_exp_f32 v98, v98
  v_mfma_f32_16x16x32_bf16 a[8:11], a[164:167], v[48:51], a[8:11]
  ds_read_b64_tr_b16 a[188:189], v219 offset:40960
  v_mfma_f32_16x16x32_bf16 a[12:15], a[164:167], v[56:59], a[12:15]
  v_exp_f32 v99, v99
  v_mfma_f32_16x16x32_bf16 a[12:15], a[160:163], v[24:27], a[12:15]
  ds_read_b64_tr_b16 a[190:191], v219 offset:45056
  v_cvt_pk_bf16_f32 v97, v98, v99
  v_mfma_f32_16x16x32_bf16 a[16:19], a[168:171], v[0:3], a[16:19]
  v_exp_f32 v104, v104
  v_mfma_f32_16x16x32_bf16 a[16:19], a[172:175], v[32:35], a[16:19]
  ds_read_b64_tr_b16 a[160:161], v220 offset:32768
  v_mfma_f32_16x16x32_bf16 a[20:23], a[172:175], v[40:43], a[20:23]
  v_exp_f32 v105, v105
  v_mfma_f32_16x16x32_bf16 a[20:23], a[168:171], v[8:11], a[20:23]
  ds_read_b64_tr_b16 a[162:163], v220 offset:36864
  v_cvt_pk_bf16_f32 v104, v104, v105
  v_mfma_f32_16x16x32_bf16 a[24:27], a[168:171], v[16:19], a[24:27]
  v_exp_f32 v106, v106
  v_mfma_f32_16x16x32_bf16 a[24:27], a[172:175], v[48:51], a[24:27]
  ds_read_b64_tr_b16 a[164:165], v220 offset:40960
  v_mfma_f32_16x16x32_bf16 a[28:31], a[172:175], v[56:59], a[28:31]
  s_waitcnt lgkmcnt(7)
  v_exp_f32 v107, v107
  v_mfma_f32_16x16x32_bf16 a[28:31], a[168:171], v[24:27], a[28:31]
  ds_read_b64_tr_b16 a[166:167], v220 offset:45056
  v_cvt_pk_bf16_f32 v105, v106, v107
  v_mfma_f32_16x16x32_bf16 a[32:35], a[176:179], v[0:3], a[32:35]
  v_exp_f32 v112, v112
  v_mfma_f32_16x16x32_bf16 a[32:35], a[180:183], v[32:35], a[32:35]
  ds_read_b64_tr_b16 a[168:169], v221 offset:32768
  v_mfma_f32_16x16x32_bf16 a[36:39], a[180:183], v[40:43], a[36:39]
  v_exp_f32 v113, v113
  v_mfma_f32_16x16x32_bf16 a[36:39], a[176:179], v[8:11], a[36:39]
  ds_read_b64_tr_b16 a[170:171], v221 offset:36864
  v_cvt_pk_bf16_f32 v112, v112, v113
  v_mfma_f32_16x16x32_bf16 a[40:43], a[176:179], v[16:19], a[40:43]
  v_exp_f32 v114, v114
  v_mfma_f32_16x16x32_bf16 a[40:43], a[180:183], v[48:51], a[40:43]
  ds_read_b64_tr_b16 a[172:173], v221 offset:40960
  v_mfma_f32_16x16x32_bf16 a[44:47], a[180:183], v[56:59], a[44:47]
  s_waitcnt lgkmcnt(7)
  v_exp_f32 v115, v115
  v_mfma_f32_16x16x32_bf16 a[44:47], a[176:179], v[24:27], a[44:47]
  ds_read_b64_tr_b16 a[174:175], v221 offset:45056
  v_cvt_pk_bf16_f32 v113, v114, v115
  v_mfma_f32_16x16x32_bf16 a[48:51], a[184:187], v[0:3], a[48:51]
  v_exp_f32 v120, v120
  v_mfma_f32_16x16x32_bf16 a[48:51], a[188:191], v[32:35], a[48:51]
  ds_read_b64_tr_b16 a[176:177], v222 offset:32768
  v_mfma_f32_16x16x32_bf16 a[52:55], a[188:191], v[40:43], a[52:55]
  v_exp_f32 v121, v121
  v_mfma_f32_16x16x32_bf16 a[52:55], a[184:187], v[8:11], a[52:55]
  ds_read_b64_tr_b16 a[178:179], v222 offset:36864
  v_cvt_pk_bf16_f32 v120, v120, v121
  v_mfma_f32_16x16x32_bf16 a[56:59], a[184:187], v[16:19], a[56:59]
  v_exp_f32 v122, v122
  v_mfma_f32_16x16x32_bf16 a[56:59], a[188:191], v[48:51], a[56:59]
  ds_read_b64_tr_b16 a[180:181], v222 offset:40960
  v_mfma_f32_16x16x32_bf16 a[60:63], a[188:191], v[56:59], a[60:63]
  s_waitcnt lgkmcnt(7)
  v_exp_f32 v123, v123
  v_mfma_f32_16x16x32_bf16 a[60:63], a[184:187], v[24:27], a[60:63]
  ds_read_b64_tr_b16 a[182:183], v222 offset:45056
  v_cvt_pk_bf16_f32 v121, v122, v123
  v_mfma_f32_16x16x32_bf16 a[64:67], a[160:163], v[0:3], a[64:67]
  v_exp_f32 v100, v100
  v_mfma_f32_16x16x32_bf16 a[64:67], a[164:167], v[32:35], a[64:67]
  ds_read_b64_tr_b16 a[184:185], v223 offset:32768
  v_mfma_f32_16x16x32_bf16 a[68:71], a[164:167], v[40:43], a[68:71]
  v_exp_f32 v101, v101
  v_mfma_f32_16x16x32_bf16 a[68:71], a[160:163], v[8:11], a[68:71]
  ds_read_b64_tr_b16 a[186:187], v223 offset:36864
  v_cvt_pk_bf16_f32 v98, v100, v101
  v_mfma_f32_16x16x32_bf16 a[72:75], a[160:163], v[16:19], a[72:75]
  v_exp_f32 v102, v102
  v_mfma_f32_16x16x32_bf16 a[72:75], a[164:167], v[48:51], a[72:75]
  ds_read_b64_tr_b16 a[188:189], v223 offset:40960
  v_mfma_f32_16x16x32_bf16 a[76:79], a[164:167], v[56:59], a[76:79]
  s_waitcnt lgkmcnt(7)
  v_exp_f32 v103, v103
  v_mfma_f32_16x16x32_bf16 a[76:79], a[160:163], v[24:27], a[76:79]
  ds_read_b64_tr_b16 a[190:191], v223 offset:45056
  v_cvt_pk_bf16_f32 v99, v102, v103
  v_mfma_f32_16x16x32_bf16 a[80:83], a[168:171], v[0:3], a[80:83]
  s_waitcnt vmcnt(12)
  v_exp_f32 v108, v108
  v_mfma_f32_16x16x32_bf16 a[80:83], a[172:175], v[32:35], a[80:83]
  v_mfma_f32_16x16x32_bf16 a[84:87], a[172:175], v[40:43], a[84:87]
  s_barrier
  v_exp_f32 v109, v109
  v_mfma_f32_16x16x32_bf16 a[84:87], a[168:171], v[8:11], a[84:87]
  ds_read_b128 a[128:131], v212 offset:0
  v_cvt_pk_bf16_f32 v106, v108, v109
  v_mfma_f32_16x16x32_bf16 a[88:91], a[168:171], v[16:19], a[88:91]
  v_exp_f32 v110, v110
  v_mfma_f32_16x16x32_bf16 a[88:91], a[172:175], v[48:51], a[88:91]
  ds_read_b128 a[132:135], v213 offset:0
  v_mfma_f32_16x16x32_bf16 a[92:95], a[172:175], v[56:59], a[92:95]
  s_waitcnt lgkmcnt(6)
  v_exp_f32 v111, v111
  v_mfma_f32_16x16x32_bf16 a[92:95], a[168:171], v[24:27], a[92:95]
  ds_read_b128 a[136:139], v214 offset:0
  v_cvt_pk_bf16_f32 v107, v110, v111
  v_mfma_f32_16x16x32_bf16 a[96:99], a[176:179], v[0:3], a[96:99]
  v_exp_f32 v116, v116
  v_mfma_f32_16x16x32_bf16 a[96:99], a[180:183], v[32:35], a[96:99]
  ds_read_b128 a[140:143], v215 offset:0
  v_mfma_f32_16x16x32_bf16 a[100:103], a[180:183], v[40:43], a[100:103]
  v_exp_f32 v117, v117
  v_mfma_f32_16x16x32_bf16 a[100:103], a[176:179], v[8:11], a[100:103]
  v_cvt_pk_bf16_f32 v114, v116, v117
  v_mfma_f32_16x16x32_bf16 a[104:107], a[176:179], v[16:19], a[104:107]
  v_exp_f32 v118, v118
  v_mfma_f32_16x16x32_bf16 a[104:107], a[180:183], v[48:51], a[104:107]
  v_mfma_f32_16x16x32_bf16 a[108:111], a[180:183], v[56:59], a[108:111]
  s_waitcnt lgkmcnt(4)
  v_exp_f32 v119, v119
  v_mfma_f32_16x16x32_bf16 a[108:111], a[176:179], v[24:27], a[108:111]
  v_cvt_pk_bf16_f32 v115, v118, v119
  v_mfma_f32_16x16x32_bf16 a[112:115], a[184:187], v[0:3], a[112:115]
  v_exp_f32 v124, v124
  v_mfma_f32_16x16x32_bf16 a[112:115], a[188:191], v[32:35], a[112:115]
  v_mfma_f32_16x16x32_bf16 a[116:119], a[188:191], v[40:43], a[116:119]
  s_sub_u32 s32, s32, 1
  v_exp_f32 v125, v125
  v_mfma_f32_16x16x32_bf16 a[116:119], a[184:187], v[8:11], a[116:119]
  v_cvt_pk_bf16_f32 v122, v124, v125
  v_mfma_f32_16x16x32_bf16 a[120:123], a[184:187], v[16:19], a[120:123]
  s_cmp_lg_u32 s32, 0
  v_exp_f32 v126, v126
  v_mfma_f32_16x16x32_bf16 a[120:123], a[188:191], v[48:51], a[120:123]
  v_mfma_f32_16x16x32_bf16 a[124:127], a[188:191], v[56:59], a[124:127]
  s_waitcnt lgkmcnt(0)
  v_exp_f32 v127, v127
  v_mfma_f32_16x16x32_bf16 a[124:127], a[184:187], v[24:27], a[124:127]
  v_cvt_pk_bf16_f32 v123, v126, v127
  s_cbranch_scc1 attn_loop
  s_waitcnt vmcnt(1)
  v_readfirstlane_b32 s38, v254
  s_nop 0
  s_cmp_ge_u32 s38, 512
  s_cbranch_scc1 attn_h_ready
  s_mov_b32 s39, 32768
attn_spin:
  s_sleep 4
  buffer_load_dword v254, off, s[24:27], s47 sc1
  s_waitcnt vmcnt(0)
  v_readfirstlane_b32 s38, v254
  s_nop 0
  s_cmp_ge_u32 s38, 512
  s_cbranch_scc1 attn_h_ready
  s_sub_u32 s39, s39, 1
  s_cmp_lg_u32 s39, 0
  s_cbranch_scc1 attn_spin
attn_h_ready:
  v_mfma_f32_16x16x32_bf16 v[0:3], a[128:131], v[128:131], v[192:195]
  s_add_u32 m0, s28, 81920
  s_and_b32 s38, s2, 1
  s_lshl_b32 s38, s38, 2
  v_lshrrev_b32 v224, 4, v242
  v_and_b32 v225, 7, v224
  v_mfma_f32_16x16x32_bf16 v[0:3], a[132:135], v[132:135], v[0:3]
  ds_read_b128 a[144:147], v212 offset:4096
  s_add_u32 s38, s38, s3
  s_mul_i32 s38, s38, 81920
  s_lshr_b32 s39, s2, 5
  v_mul_u32_u24 v225, 0xd80, v225
  v_mfma_f32_16x16x32_bf16 v[0:3], a[136:139], v[136:139], v[0:3]
  buffer_load_dwordx4 v236, s[16:19], s29 offen offset:0 lds
  s_mul_i32 s39, s39, 655360
  s_add_u32 s38, s38, s39
  s_add_u32 s4, s38, 3145728
  v_mfma_f32_16x16x32_bf16 v[0:3], a[140:143], v[140:143], v[0:3]
  ds_read_b128 a[148:151], v213 offset:4096
  s_add_u32 s5, s4, 12288
  s_add_u32 s6, s4, 24576
  s_add_u32 s7, s4, 36864
  v_lshrrev_b32 v224, 4, v224
  v_mfma_f32_16x16x32_bf16 v[8:11], a[140:143], v[156:159], v[196:199]
  s_add_u32 s8, s4, 49152
  s_add_u32 s9, s4, 61440
  s_add_u32 s10, s4, 73728
  v_lshl_add_u32 v225, v224, 4, v225
  v_add_u32 v252, 4096, v242
  v_mfma_f32_16x16x32_bf16 v[8:11], a[136:139], v[152:155], v[8:11]
  ds_read_b128 a[152:155], v214 offset:4096
  buffer_load_dwordx4 a[212:215], v225, s[24:27], s101 offen offset:0 sc1
  v_mfma_f32_16x16x32_bf16 v[8:11], a[132:135], v[148:151], v[8:11]
  buffer_load_dwordx4 v237, s[16:19], s29 offen offset:1024 lds
  v_mfma_f32_16x16x32_bf16 v[8:11], a[128:131], v[144:147], v[8:11]
  ds_read_b128 a[156:159], v215 offset:4096
  buffer_load_dwordx4 a[216:219], v225, s[24:27], s101 offen offset:64 sc1
  v_mfma_f32_16x16x32_bf16 v[16:19], a[128:131], v[160:163], v[200:203]
  v_exp_f32 v0, v0
  v_mfma_f32_16x16x32_bf16 v[16:19], a[132:135], v[164:167], v[16:19]
  buffer_load_dwordx4 a[220:223], v225, s[24:27], s101 offen offset:128 sc1
  v_mfma_f32_16x16x32_bf16 v[16:19], a[136:139], v[168:171], v[16:19]
  v_exp_f32 v1, v1
  v_mfma_f32_16x16x32_bf16 v[16:19], a[140:143], v[172:175], v[16:19]
  v_cvt_pk_bf16_f32 v0, v0, v1
  v_add_u32 v253, 8192, v242
  v_mfma_f32_16x16x32_bf16 v[24:27], a[140:143], v[188:191], v[204:207]
  v_exp_f32 v2, v2
  v_mfma_f32_16x16x32_bf16 v[24:27], a[136:139], v[184:187], v[24:27]
  buffer_load_dwordx4 v236, s[16:19], s29 offen offset:2048 lds
  v_mfma_f32_16x16x32_bf16 v[24:27], a[132:135], v[180:183], v[24:27]
  s_waitcnt lgkmcnt(0)
  v_exp_f32 v3, v3
  v_mfma_f32_16x16x32_bf16 v[24:27], a[128:131], v[176:179], v[24:27]
  v_cvt_pk_bf16_f32 v1, v2, v3
  v_mfma_f32_16x16x32_bf16 v[4:7], a[144:147], v[128:131], v[192:195]
  v_exp_f32 v8, v8
  v_mfma_f32_16x16x32_bf16 v[4:7], a[148:151], v[132:135], v[4:7]
  ds_read_b128 a[128:131], v212 offset:8192
  v_mfma_f32_16x16x32_bf16 v[4:7], a[152:155], v[136:139], v[4:7]
  v_exp_f32 v9, v9
  v_mfma_f32_16x16x32_bf16 v[4:7], a[156:159], v[140:143], v[4:7]
  ds_read_b128 a[132:135], v213 offset:8192
  v_cvt_pk_bf16_f32 v8, v8, v9
  v_mfma_f32_16x16x32_bf16 v[12:15], a[156:159], v[156:159], v[196:199]
  v_exp_f32 v10, v10
  v_mfma_f32_16x16x32_bf16 v[12:15], a[152:155], v[152:155], v[12:15]
  ds_read_b128 a[136:139], v214 offset:8192
  v_mfma_f32_16x16x32_bf16 v[12:15], a[148:151], v[148:151], v[12:15]
  v_exp_f32 v11, v11
  v_mfma_f32_16x16x32_bf16 v[12:15], a[144:147], v[144:147], v[12:15]
  ds_read_b128 a[140:143], v215 offset:8192
  v_cvt_pk_bf16_f32 v9, v10, v11
  v_mfma_f32_16x16x32_bf16 v[20:23], a[144:147], v[160:163], v[200:203]
  v_exp_f32 v16, v16
  v_mfma_f32_16x16x32_bf16 v[20:23], a[148:151], v[164:167], v[20:23]
  buffer_load_dwordx4 v237, s[16:19], s29 offen offset:3072 lds
  v_mfma_f32_16x16x32_bf16 v[20:23], a[152:155], v[168:171], v[20:23]
  s_add_u32 s29, s29, 16384
  v_exp_f32 v17, v17
  v_mfma_f32_16x16x32_bf16 v[20:23], a[156:159], v[172:175], v[20:23]
  v_cvt_pk_bf16_f32 v16, v16, v17
  v_mfma_f32_16x16x32_bf16 v[28:31], a[156:159], v[188:191], v[204:207]
  s_add_u32 m0, s28, 32768
  v_exp_f32 v18, v18
  v_mfma_f32_16x16x32_bf16 v[28:31], a[152:155], v[184:187], v[28:31]
  buffer_load_dwordx4 v232, s[12:15], s29 offen offset:0 lds
  v_mfma_f32_16x16x32_bf16 v[28:31], a[148:151], v[180:183], v[28:31]
  s_waitcnt lgkmcnt(0)
  v_exp_f32 v19, v19
  v_mfma_f32_16x16x32_bf16 v[28:31], a[144:147], v[176:179], v[28:31]
  v_cvt_pk_bf16_f32 v17, v18, v19
  v_mfma_f32_16x16x32_bf16 v[32:35], a[128:131], v[128:131], v[192:195]
  v_exp_f32 v24, v24
  v_mfma_f32_16x16x32_bf16 v[32:35], a[132:135], v[132:135], v[32:35]
  ds_read_b128 a[144:147], v212 offset:12288
  v_mfma_f32_16x16x32_bf16 v[32:35], a[136:139], v[136:139], v[32:35]
  v_exp_f32 v25, v25
  v_mfma_f32_16x16x32_bf16 v[32:35], a[140:143], v[140:143], v[32:35]
  ds_read_b128 a[148:151], v213 offset:12288
  v_cvt_pk_bf16_f32 v24, v24, v25
  v_mfma_f32_16x16x32_bf16 v[40:43], a[140:143], v[156:159], v[196:199]
  v_exp_f32 v26, v26
  v_mfma_f32_16x16x32_bf16 v[40:43], a[136:139], v[152:155], v[40:43]
  ds_read_b128 a[152:155], v214 offset:12288
  v_mfma_f32_16x16x32_bf16 v[40:43], a[132:135], v[148:151], v[40:43]
  v_exp_f32 v27, v27
  v_mfma_f32_16x16x32_bf16 v[40:43], a[128:131], v[144:147], v[40:43]
  ds_read_b128 a[156:159], v215 offset:12288
  v_cvt_pk_bf16_f32 v25, v26, v27
  v_mfma_f32_16x16x32_bf16 v[48:51], a[128:131], v[160:163], v[200:203]
  v_exp_f32 v4, v4
  v_mfma_f32_16x16x32_bf16 v[48:51], a[132:135], v[164:167], v[48:51]
  buffer_load_dwordx4 v233, s[12:15], s29 offen offset:1024 lds
  v_mfma_f32_16x16x32_bf16 v[48:51], a[136:139], v[168:171], v[48:51]
  v_exp_f32 v5, v5
  v_mfma_f32_16x16x32_bf16 v[48:51], a[140:143], v[172:175], v[48:51]
  v_cvt_pk_bf16_f32 v2, v4, v5
  v_mfma_f32_16x16x32_bf16 v[56:59], a[140:143], v[188:191], v[204:207]
  v_exp_f32 v6, v6
  v_mfma_f32_16x16x32_bf16 v[56:59], a[136:139], v[184:187], v[56:59]
  buffer_load_dwordx4 v234, s[12:15], s29 offen offset:2048 lds
  v_mfma_f32_16x16x32_bf16 v[56:59], a[132:135], v[180:183], v[56:59]
  s_waitcnt lgkmcnt(0)
  v_exp_f32 v7, v7
  v_mfma_f32_16x16x32_bf16 v[56:59], a[128:131], v[176:179], v[56:59]
  v_cvt_pk_bf16_f32 v3, v6, v7
  v_mfma_f32_16x16x32_bf16 v[36:39], a[144:147], v[128:131], v[192:195]
  v_exp_f32 v12, v12
  v_mfma_f32_16x16x32_bf16 v[36:39], a[148:151], v[132:135], v[36:39]
  ds_read_b64_tr_b16 a[160:161], v216 offset:49152
  v_mfma_f32_16x16x32_bf16 v[36:39], a[152:155], v[136:139], v[36:39]
  v_exp_f32 v13, v13
  v_mfma_f32_16x16x32_bf16 v[36:39], a[156:159], v[140:143], v[36:39]
  ds_read_b64_tr_b16 a[162:163], v216 offset:53248
  v_cvt_pk_bf16_f32 v10, v12, v13
  v_mfma_f32_16x16x32_bf16 v[44:47], a[156:159], v[156:159], v[196:199]
  v_exp_f32 v14, v14
  v_mfma_f32_16x16x32_bf16 v[44:47], a[152:155], v[152:155], v[44:47]
  ds_read_b64_tr_b16 a[164:165], v216 offset:57344
  buffer_load_dwordx4 v235, s[12:15], s29 offen offset:3072 lds
  v_mfma_f32_16x16x32_bf16 v[44:47], a[148:151], v[148:151], v[44:47]
  v_exp_f32 v15, v15
  v_mfma_f32_16x16x32_bf16 v[44:47], a[144:147], v[144:147], v[44:47]
  ds_read_b64_tr_b16 a[166:167], v216 offset:61440
  v_cvt_pk_bf16_f32 v11, v14, v15
  v_mfma_f32_16x16x32_bf16 v[52:55], a[144:147], v[160:163], v[200:203]
  v_exp_f32 v20, v20
  v_mfma_f32_16x16x32_bf16 v[52:55], a[148:151], v[164:167], v[52:55]
  ds_read_b64_tr_b16 a[168:169], v217 offset:49152
  v_mfma_f32_16x16x32_bf16 v[52:55], a[152:155], v[168:171], v[52:55]
  v_exp_f32 v21, v21
  v_mfma_f32_16x16x32_bf16 v[52:55], a[156:159], v[172:175], v[52:55]
  ds_read_b64_tr_b16 a[170:171], v217 offset:53248
  v_cvt_pk_bf16_f32 v18, v20, v21
  v_mfma_f32_16x16x32_bf16 v[60:63], a[156:159], v[188:191], v[204:207]
  v_exp_f32 v22, v22
  v_mfma_f32_16x16x32_bf16 v[60:63], a[152:155], v[184:187], v[60:63]
  ds_read_b64_tr_b16 a[172:173], v217 offset:57344
  v_mfma_f32_16x16x32_bf16 v[60:63], a[148:151], v[180:183], v[60:63]
  v_exp_f32 v23, v23
  v_mfma_f32_16x16x32_bf16 v[60:63], a[144:147], v[176:179], v[60:63]
  ds_read_b64_tr_b16 a[174:175], v217 offset:61440
  v_cvt_pk_bf16_f32 v19, v22, v23
  v_mfma_f32_16x16x32_bf16 a[192:195], a[208:211], v[64:67], a[192:195]
  v_exp_f32 v28, v28
  v_mfma_f32_16x16x32_bf16 a[192:195], a[208:211], v[96:99], a[192:195]
  ds_read_b64_tr_b16 a[176:177], v218 offset:49152
  v_mfma_f32_16x16x32_bf16 a[196:199], a[208:211], v[72:75], a[196:199]
  v_exp_f32 v29, v29
  v_mfma_f32_16x16x32_bf16 a[196:199], a[208:211], v[104:107], a[196:199]
  ds_read_b64_tr_b16 a[178:179], v218 offset:53248
  v_cvt_pk_bf16_f32 v26, v28, v29
  v_mfma_f32_16x16x32_bf16 a[200:203], a[208:211], v[80:83], a[200:203]
  v_exp_f32 v30, v30
  v_mfma_f32_16x16x32_bf16 a[200:203], a[208:211], v[112:115], a[200:203]
  ds_read_b64_tr_b16 a[180:181], v218 offset:57344
  v_mfma_f32_16x16x32_bf16 a[204:207], a[208:211], v[88:91], a[204:207]
  s_waitcnt lgkmcnt(7)
  v_exp_f32 v31, v31
  v_mfma_f32_16x16x32_bf16 a[204:207], a[208:211], v[120:123], a[204:207]
  ds_read_b64_tr_b16 a[182:183], v218 offset:61440
  v_cvt_pk_bf16_f32 v27, v30, v31
  v_mfma_f32_16x16x32_bf16 a[0:3], a[160:163], v[64:67], a[0:3]
  v_exp_f32 v32, v32
  v_mfma_f32_16x16x32_bf16 a[0:3], a[164:167], v[96:99], a[0:3]
  ds_read_b64_tr_b16 a[184:185], v219 offset:49152
  v_mfma_f32_16x16x32_bf16 a[4:7], a[164:167], v[104:107], a[4:7]
  v_exp_f32 v33, v33
  v_mfma_f32_16x16x32_bf16 a[4:7], a[160:163], v[72:75], a[4:7]
  ds_read_b64_tr_b16 a[186:187], v219 offset:53248
  v_cvt_pk_bf16_f32 v32, v32, v33
  v_mfma_f32_16x16x32_bf16 a[8:11], a[160:163], v[80:83], a[8:11]
  v_exp_f32 v34, v34
  v_mfma_f32_16x16x32_bf16 a[8:11], a[164:167], v[112:115], a[8:11]
  ds_read_b64_tr_b16 a[188:189], v219 offset:57344
  v_mfma_f32_16x16x32_bf16 a[12:15], a[164:167], v[120:123], a[12:15]
  s_waitcnt lgkmcnt(7)
  v_exp_f32 v35, v35
  v_mfma_f32_16x16x32_bf16 a[12:15], a[160:163], v[88:91], a[12:15]
  ds_read_b64_tr_b16 a[190:191], v219 offset:61440
  v_cvt_pk_bf16_f32 v33, v34, v35
  v_mfma_f32_16x16x32_bf16 a[16:19], a[168:171], v[64:67], a[16:19]
  v_exp_f32 v40, v40
  v_mfma_f32_16x16x32_bf16 a[16:19], a[172:175], v[96:99], a[16:19]
  ds_read_b64_tr_b16 a[160:161], v220 offset:49152
  v_mfma_f32_16x16x32_bf16 a[20:23], a[172:175], v[104:107], a[20:23]
  v_exp_f32 v41, v41
  v_mfma_f32_16x16x32_bf16 a[20:23], a[168:171], v[72:75], a[20:23]
  ds_read_b64_tr_b16 a[162:163], v220 offset:53248
  v_cvt_pk_bf16_f32 v40, v40, v41
  v_mfma_f32_16x16x32_bf16 a[24:27], a[168:171], v[80:83], a[24:27]
  v_exp_f32 v42, v42
  v_mfma_f32_16x16x32_bf16 a[24:27], a[172:175], v[112:115], a[24:27]
  ds_read_b64_tr_b16 a[164:165], v220 offset:57344
  v_mfma_f32_16x16x32_bf16 a[28:31], a[172:175], v[120:123], a[28:31]
  s_waitcnt lgkmcnt(7)
  v_exp_f32 v43, v43
  v_mfma_f32_16x16x32_bf16 a[28:31], a[168:171], v[88:91], a[28:31]
  ds_read_b64_tr_b16 a[166:167], v220 offset:61440
  v_cvt_pk_bf16_f32 v41, v42, v43
  v_mfma_f32_16x16x32_bf16 a[32:35], a[176:179], v[64:67], a[32:35]
  v_exp_f32 v48, v48
  v_mfma_f32_16x16x32_bf16 a[32:35], a[180:183], v[96:99], a[32:35]
  ds_read_b64_tr_b16 a[168:169], v221 offset:49152
  v_mfma_f32_16x16x32_bf16 a[36:39], a[180:183], v[104:107], a[36:39]
  v_exp_f32 v49, v49
  v_mfma_f32_16x16x32_bf16 a[36:39], a[176:179], v[72:75], a[36:39]
  ds_read_b64_tr_b16 a[170:171], v221 offset:53248
  v_cvt_pk_bf16_f32 v48, v48, v49
  v_mfma_f32_16x16x32_bf16 a[40:43], a[176:179], v[80:83], a[40:43]
  v_exp_f32 v50, v50
  v_mfma_f32_16x16x32_bf16 a[40:43], a[180:183], v[112:115], a[40:43]
  ds_read_b64_tr_b16 a[172:173], v221 offset:57344
  v_mfma_f32_16x16x32_bf16 a[44:47], a[180:183], v[120:123], a[44:47]
  s_waitcnt lgkmcnt(7)
  v_exp_f32 v51, v51
  v_mfma_f32_16x16x32_bf16 a[44:47], a[176:179], v[88:91], a[44:47]
  ds_read_b64_tr_b16 a[174:175], v221 offset:61440
  v_cvt_pk_bf16_f32 v49, v50, v51
  v_mfma_f32_16x16x32_bf16 a[48:51], a[184:187], v[64:67], a[48:51]
  v_exp_f32 v56, v56
  v_mfma_f32_16x16x32_bf16 a[48:51], a[188:191], v[96:99], a[48:51]
  ds_read_b64_tr_b16 a[176:177], v222 offset:49152
  v_mfma_f32_16x16x32_bf16 a[52:55], a[188:191], v[104:107], a[52:55]
  v_exp_f32 v57, v57
  v_mfma_f32_16x16x32_bf16 a[52:55], a[184:187], v[72:75], a[52:55]
  ds_read_b64_tr_b16 a[178:179], v222 offset:53248
  v_cvt_pk_bf16_f32 v56, v56, v57
  v_mfma_f32_16x16x32_bf16 a[56:59], a[184:187], v[80:83], a[56:59]
  v_exp_f32 v58, v58
  v_mfma_f32_16x16x32_bf16 a[56:59], a[188:191], v[112:115], a[56:59]
  ds_read_b64_tr_b16 a[180:181], v222 offset:57344
  v_mfma_f32_16x16x32_bf16 a[60:63], a[188:191], v[120:123], a[60:63]
  s_waitcnt lgkmcnt(7)
  v_exp_f32 v59, v59
  v_mfma_f32_16x16x32_bf16 a[60:63], a[184:187], v[88:91], a[60:63]
  ds_read_b64_tr_b16 a[182:183], v222 offset:61440
  v_cvt_pk_bf16_f32 v57, v58, v59
  v_mfma_f32_16x16x32_bf16 a[64:67], a[160:163], v[64:67], a[64:67]
  v_exp_f32 v36, v36
  v_mfma_f32_16x16x32_bf16 a[64:67], a[164:167], v[96:99], a[64:67]
  ds_read_b64_tr_b16 a[184:185], v223 offset:49152
  v_mfma_f32_16x16x32_bf16 a[68:71], a[164:167], v[104:107], a[68:71]
  v_exp_f32 v37, v37
  v_mfma_f32_16x16x32_bf16 a[68:71], a[160:163], v[72:75], a[68:71]
  ds_read_b64_tr_b16 a[186:187], v223 offset:53248
  v_cvt_pk_bf16_f32 v34, v36, v37
  v_mfma_f32_16x16x32_bf16 a[72:75], a[160:163], v[80:83], a[72:75]
  v_exp_f32 v38, v38
  v_mfma_f32_16x16x32_bf16 a[72:75], a[164:167], v[112:115], a[72:75]
  ds_read_b64_tr_b16 a[188:189], v223 offset:57344
  v_mfma_f32_16x16x32_bf16 a[76:79], a[164:167], v[120:123], a[76:79]
  s_waitcnt lgkmcnt(7)
  v_exp_f32 v39, v39
  v_mfma_f32_16x16x32_bf16 a[76:79], a[160:163], v[88:91], a[76:79]
  ds_read_b64_tr_b16 a[190:191], v223 offset:61440
  v_cvt_pk_bf16_f32 v35, v38, v39
  v_mfma_f32_16x16x32_bf16 a[80:83], a[168:171], v[64:67], a[80:83]
  v_exp_f32 v44, v44
  v_mfma_f32_16x16x32_bf16 a[80:83], a[172:175], v[96:99], a[80:83]
  v_mfma_f32_16x16x32_bf16 a[84:87], a[172:175], v[104:107], a[84:87]
  s_barrier
  v_exp_f32 v45, v45
  v_mfma_f32_16x16x32_bf16 a[84:87], a[168:171], v[72:75], a[84:87]
  ds_read_b128 a[128:131], v212 offset:16384
  v_cvt_pk_bf16_f32 v42, v44, v45
  v_mfma_f32_16x16x32_bf16 a[88:91], a[168:171], v[80:83], a[88:91]
  v_exp_f32 v46, v46
  v_mfma_f32_16x16x32_bf16 a[88:91], a[172:175], v[112:115], a[88:91]
  ds_read_b128 a[132:135], v213 offset:16384
  v_mfma_f32_16x16x32_bf16 a[92:95], a[172:175], v[120:123], a[92:95]
  s_waitcnt lgkmcnt(6)
  v_exp_f32 v47, v47
  v_mfma_f32_16x16x32_bf16 a[92:95], a[168:171], v[88:91], a[92:95]
  ds_read_b128 a[136:139], v214 offset:16384
  v_cvt_pk_bf16_f32 v43, v46, v47
  v_mfma_f32_16x16x32_bf16 a[96:99], a[176:179], v[64:67], a[96:99]
  v_exp_f32 v52, v52
  v_mfma_f32_16x16x32_bf16 a[96:99], a[180:183], v[96:99], a[96:99]
  ds_read_b128 a[140:143], v215 offset:16384
  v_mfma_f32_16x16x32_bf16 a[100:103], a[180:183], v[104:107], a[100:103]
  v_exp_f32 v53, v53
  v_mfma_f32_16x16x32_bf16 a[100:103], a[176:179], v[72:75], a[100:103]
  v_cvt_pk_bf16_f32 v50, v52, v53
  v_mfma_f32_16x16x32_bf16 a[104:107], a[176:179], v[80:83], a[104:107]
  v_exp_f32 v54, v54
  v_mfma_f32_16x16x32_bf16 a[104:107], a[180:183], v[112:115], a[104:107]
  v_mfma_f32_16x16x32_bf16 a[108:111], a[180:183], v[120:123], a[108:111]
  s_waitcnt lgkmcnt(4)
  v_exp_f32 v55, v55
  v_mfma_f32_16x16x32_bf16 a[108:111], a[176:179], v[88:91], a[108:111]
  v_cvt_pk_bf16_f32 v51, v54, v55
  v_mfma_f32_16x16x32_bf16 a[112:115], a[184:187], v[64:67], a[112:115]
  v_exp_f32 v60, v60
  v_mfma_f32_16x16x32_bf16 a[112:115], a[188:191], v[96:99], a[112:115]
  v_mfma_f32_16x16x32_bf16 a[116:119], a[188:191], v[104:107], a[116:119]
  v_exp_f32 v61, v61
  v_mfma_f32_16x16x32_bf16 a[116:119], a[184:187], v[72:75], a[116:119]
  v_cvt_pk_bf16_f32 v58, v60, v61
  v_mfma_f32_16x16x32_bf16 a[120:123], a[184:187], v[80:83], a[120:123]
  v_exp_f32 v62, v62
  v_mfma_f32_16x16x32_bf16 a[120:123], a[188:191], v[112:115], a[120:123]
  v_mfma_f32_16x16x32_bf16 a[124:127], a[188:191], v[120:123], a[124:127]
  s_waitcnt lgkmcnt(0)
  v_exp_f32 v63, v63
  v_mfma_f32_16x16x32_bf16 a[124:127], a[184:187], v[88:91], a[124:127]
  v_cvt_pk_bf16_f32 v59, v62, v63
  v_mfma_f32_16x16x32_bf16 v[64:67], a[128:131], v[128:131], v[192:195]
  s_add_u32 m0, s28, 98304
  v_mfma_f32_16x16x32_bf16 v[64:67], a[132:135], v[132:135], v[64:67]
  ds_read_b128 a[144:147], v212 offset:20480
  v_mfma_f32_16x16x32_bf16 v[64:67], a[136:139], v[136:139], v[64:67]
  buffer_load_dwordx4 v236, s[16:19], s29 offen offset:0 lds
  v_mfma_f32_16x16x32_bf16 v[64:67], a[140:143], v[140:143], v[64:67]
  ds_read_b128 a[148:151], v213 offset:20480
  v_mfma_f32_16x16x32_bf16 v[72:75], a[140:143], v[156:159], v[196:199]
  v_mfma_f32_16x16x32_bf16 v[72:75], a[136:139], v[152:155], v[72:75]
  ds_read_b128 a[152:155], v214 offset:20480
  v_mfma_f32_16x16x32_bf16 v[72:75], a[132:135], v[148:151], v[72:75]
  buffer_load_dwordx4 v237, s[16:19], s29 offen offset:1024 lds
  v_mfma_f32_16x16x32_bf16 v[72:75], a[128:131], v[144:147], v[72:75]
  ds_read_b128 a[156:159], v215 offset:20480
  v_mfma_f32_16x16x32_bf16 v[80:83], a[128:131], v[160:163], v[200:203]
  v_exp_f32 v64, v64
  v_mfma_f32_16x16x32_bf16 v[80:83], a[132:135], v[164:167], v[80:83]
  v_mfma_f32_16x16x32_bf16 v[80:83], a[136:139], v[168:171], v[80:83]
  v_exp_f32 v65, v65
  v_mfma_f32_16x16x32_bf16 v[80:83], a[140:143], v[172:175], v[80:83]
  v_cvt_pk_bf16_f32 v64, v64, v65
  v_mfma_f32_16x16x32_bf16 v[88:91], a[140:143], v[188:191], v[204:207]
  v_exp_f32 v66, v66
  v_mfma_f32_16x16x32_bf16 v[88:91], a[136:139], v[184:187], v[88:91]
  buffer_load_dwordx4 v236, s[16:19], s29 offen offset:2048 lds
  v_mfma_f32_16x16x32_bf16 v[88:91], a[132:135], v[180:183], v[88:91]
  s_waitcnt lgkmcnt(0)
  v_exp_f32 v67, v67
  v_mfma_f32_16x16x32_bf16 v[88:91], a[128:131], v[176:179], v[88:91]
  v_cvt_pk_bf16_f32 v65, v66, v67
  v_mfma_f32_16x16x32_bf16 v[68:71], a[144:147], v[128:131], v[192:195]
  v_exp_f32 v72, v72
  v_mfma_f32_16x16x32_bf16 v[68:71], a[148:151], v[132:135], v[68:71]
  ds_read_b128 a[128:131], v212 offset:24576
  v_mfma_f32_16x16x32_bf16 v[68:71], a[152:155], v[136:139], v[68:71]
  v_exp_f32 v73, v73
  v_mfma_f32_16x16x32_bf16 v[68:71], a[156:159], v[140:143], v[68:71]
  ds_read_b128 a[132:135], v213 offset:24576
  v_cvt_pk_bf16_f32 v72, v72, v73
  v_mfma_f32_16x16x32_bf16 v[76:79], a[156:159], v[156:159], v[196:199]
  v_exp_f32 v74, v74
  v_mfma_f32_16x16x32_bf16 v[76:79], a[152:155], v[152:155], v[76:79]
  ds_read_b128 a[136:139], v214 offset:24576
  v_lshrrev_b32 v224, 4, v242
  v_mfma_f32_16x16x32_bf16 v[76:79], a[148:151], v[148:151], v[76:79]
  v_exp_f32 v75, v75
  v_mfma_f32_16x16x32_bf16 v[76:79], a[144:147], v[144:147], v[76:79]
  ds_read_b128 a[140:143], v215 offset:24576
  v_cvt_pk_bf16_f32 v73, v74, v75
  v_mfma_f32_16x16x32_bf16 v[84:87], a[144:147], v[160:163], v[200:203]
  v_exp_f32 v80, v80
  v_mfma_f32_16x16x32_bf16 v[84:87], a[148:151], v[164:167], v[84:87]
  buffer_load_dwordx4 v237, s[16:19], s29 offen offset:3072 lds
  v_mfma_f32_16x16x32_bf16 v[84:87], a[152:155], v[168:171], v[84:87]
  s_add_u32 s29, s29, 16384
  v_exp_f32 v81, v81
  v_mfma_f32_16x16x32_bf16 v[84:87], a[156:159], v[172:175], v[84:87]
  v_cvt_pk_bf16_f32 v80, v80, v81
  v_lshrrev_b32 v225, 4, v224
  v_mfma_f32_16x16x32_bf16 v[92:95], a[156:159], v[188:191], v[204:207]
  s_add_u32 m0, s28, 49152
  v_exp_f32 v82, v82
  v_mfma_f32_16x16x32_bf16 v[92:95], a[152:155], v[184:187], v[92:95]
  buffer_load_dwordx4 v232, s[12:15], s29 offen offset:0 lds
  v_mfma_f32_16x16x32_bf16 v[92:95], a[148:151], v[180:183], v[92:95]
  s_waitcnt lgkmcnt(0)
  v_exp_f32 v83, v83
  v_mfma_f32_16x16x32_bf16 v[92:95], a[144:147], v[176:179], v[92:95]
  v_cvt_pk_bf16_f32 v81, v82, v83
  v_bfe_u32 v226, v224, 2, 2
  v_mfma_f32_16x16x32_bf16 v[96:99], a[128:131], v[128:131], v[192:195]
  v_exp_f32 v88, v88
  v_mfma_f32_16x16x32_bf16 v[96:99], a[132:135], v[132:135], v[96:99]
  ds_read_b128 a[144:147], v212 offset:28672
  v_lshl_add_u32 v225, v225, 3, v226
  v_mfma_f32_16x16x32_bf16 v[96:99], a[136:139], v[136:139], v[96:99]
  v_exp_f32 v89, v89
  v_mfma_f32_16x16x32_bf16 v[96:99], a[140:143], v[140:143], v[96:99]
  ds_read_b128 a[148:151], v213 offset:28672
  v_cvt_pk_bf16_f32 v88, v88, v89
  v_mfma_f32_16x16x32_bf16 v[104:107], a[140:143], v[156:159], v[196:199]
  v_exp_f32 v90, v90
  v_mfma_f32_16x16x32_bf16 v[104:107], a[136:139], v[152:155], v[104:107]
  ds_read_b128 a[152:155], v214 offset:28672
  v_lshlrev_b32 v225, 5, v225
  v_mfma_f32_16x16x32_bf16 v[104:107], a[132:135], v[148:151], v[104:107]
  v_exp_f32 v91, v91
  v_mfma_f32_16x16x32_bf16 v[104:107], a[128:131], v[144:147], v[104:107]
  ds_read_b128 a[156:159], v215 offset:28672
  v_cvt_pk_bf16_f32 v89, v90, v91
  v_mfma_f32_16x16x32_bf16 v[112:115], a[128:131], v[160:163], v[200:203]
  v_exp_f32 v68, v68
  v_mfma_f32_16x16x32_bf16 v[112:115], a[132:135], v[164:167], v[112:115]
  buffer_load_dwordx4 v233, s[12:15], s29 offen offset:1024 lds
  v_mfma_f32_16x16x32_bf16 v[112:115], a[136:139], v[168:171], v[112:115]
  v_exp_f32 v69, v69
  v_mfma_f32_16x16x32_bf16 v[112:115], a[140:143], v[172:175], v[112:115]
  v_cvt_pk_bf16_f32 v66, v68, v69
  v_and_b32 v226, 3, v224
  v_mfma_f32_16x16x32_bf16 v[120:123], a[140:143], v[188:191], v[204:207]
  v_exp_f32 v70, v70
  v_mfma_f32_16x16x32_bf16 v[120:123], a[136:139], v[184:187], v[120:123]
  buffer_load_dwordx4 v234, s[12:15], s29 offen offset:2048 lds
  v_mfma_f32_16x16x32_bf16 v[120:123], a[132:135], v[180:183], v[120:123]
  s_waitcnt lgkmcnt(0)
  v_exp_f32 v71, v71
  v_mfma_f32_16x16x32_bf16 v[120:123], a[128:131], v[176:179], v[120:123]
  v_cvt_pk_bf16_f32 v67, v70, v71
  v_lshl_add_u32 v225, v226, 3, v225
  v_mfma_f32_16x16x32_bf16 v[100:103], a[144:147], v[128:131], v[192:195]
  v_exp_f32 v76, v76
  v_mfma_f32_16x16x32_bf16 v[100:103], a[148:151], v[132:135], v[100:103]
  ds_read_b64_tr_b16 a[160:161], v216 offset:0
  v_add_u32 v225, s50, v225
  v_mfma_f32_16x16x32_bf16 v[100:103], a[152:155], v[136:139], v[100:103]
  s_waitcnt vmcnt(13)
  v_exp_f32 v77, v77
  v_mfma_f32_16x16x32_bf16 v[100:103], a[156:159], v[140:143], v[100:103]
  ds_read_b64_tr_b16 a[162:163], v216 offset:4096
  v_cvt_pk_bf16_f32 v74, v76, v77
  v_mfma_f32_16x16x32_bf16 v[108:111], a[156:159], v[156:159], v[196:199]
  v_exp_f32 v78, v78
  v_mfma_f32_16x16x32_bf16 v[108:111], a[152:155], v[152:155], v[108:111]
  ds_read_b64_tr_b16 a[164:165], v216 offset:8192
  buffer_load_dwordx4 v235, s[12:15], s29 offen offset:3072 lds
  v_mfma_f32_16x16x32_bf16 v[108:111], a[148:151], v[148:151], v[108:111]
  v_exp_f32 v79, v79
  v_mfma_f32_16x16x32_bf16 v[108:111], a[144:147], v[144:147], v[108:111]
  ds_read_b64_tr_b16 a[166:167], v216 offset:12288
  v_cvt_pk_bf16_f32 v75, v78, v79
  v_mfma_f32_16x16x32_bf16 v[116:119], a[144:147], v[160:163], v[200:203]
  v_exp_f32 v84, v84
  v_mfma_f32_16x16x32_bf16 v[116:119], a[148:151], v[164:167], v[116:119]
  ds_read_b64_tr_b16 a[168:169], v217 offset:0
  ds_read_b64_tr_b16 a[232:233], v225 offset:0
  s_add_u32 m0, s28, 0
  v_mfma_f32_16x16x32_bf16 v[116:119], a[152:155], v[168:171], v[116:119]
  v_exp_f32 v85, v85
  v_mfma_f32_16x16x32_bf16 v[116:119], a[156:159], v[172:175], v[116:119]
  ds_read_b64_tr_b16 a[170:171], v217 offset:4096
  v_cvt_pk_bf16_f32 v82, v84, v85
  v_mfma_f32_16x16x32_bf16 v[124:127], a[156:159], v[188:191], v[204:207]
  v_exp_f32 v86, v86
  v_mfma_f32_16x16x32_bf16 v[124:127], a[152:155], v[184:187], v[124:127]
  ds_read_b64_tr_b16 a[172:173], v217 offset:8192
  ds_read_b64_tr_b16 a[234:235], v225 offset:128
  v_mfma_f32_16x16x32_bf16 v[124:127], a[148:151], v[180:183], v[124:127]
  v_exp_f32 v87, v87
  v_mfma_f32_16x16x32_bf16 v[124:127], a[144:147], v[176:179], v[124:127]
  ds_read_b64_tr_b16 a[174:175], v217 offset:12288
  v_cvt_pk_bf16_f32 v83, v86, v87
  v_mfma_f32_16x16x32_bf16 a[192:195], a[208:211], v[0:3], a[192:195]
  v_exp_f32 v92, v92
  v_mfma_f32_16x16x32_bf16 a[192:195], a[208:211], v[32:35], a[192:195]
  ds_read_b64_tr_b16 a[176:177], v218 offset:0
  ds_read_b64_tr_b16 a[236:237], v225 offset:1024
  v_mfma_f32_16x16x32_bf16 a[196:199], a[208:211], v[8:11], a[196:199]
  v_exp_f32 v93, v93
  v_mfma_f32_16x16x32_bf16 a[196:199], a[208:211], v[40:43], a[196:199]
  ds_read_b64_tr_b16 a[178:179], v218 offset:4096
  v_cvt_pk_bf16_f32 v90, v92, v93
  v_mfma_f32_16x16x32_bf16 a[200:203], a[208:211], v[16:19], a[200:203]
  v_exp_f32 v94, v94
  v_mfma_f32_16x16x32_bf16 a[200:203], a[208:211], v[48:51], a[200:203]
  ds_read_b64_tr_b16 a[180:181], v218 offset:8192
  ds_read_b64_tr_b16 a[238:239], v225 offset:1152
  v_mfma_f32_16x16x32_bf16 a[204:207], a[208:211], v[24:27], a[204:207]
  s_waitcnt lgkmcnt(11)
  v_exp_f32 v95, v95
  v_mfma_f32_16x16x32_bf16 a[204:207], a[208:211], v[56:59], a[204:207]
  ds_read_b64_tr_b16 a[182:183], v218 offset:12288
  v_cvt_pk_bf16_f32 v91, v94, v95
  v_mfma_f32_16x16x32_bf16 a[0:3], a[160:163], v[0:3], a[0:3]
  v_exp_f32 v96, v96
  v_mfma_f32_16x16x32_bf16 a[0:3], a[164:167], v[32:35], a[0:3]
  ds_read_b64_tr_b16 a[184:185], v219 offset:0
  ds_read_b64_tr_b16 a[240:241], v225 offset:2048
  v_mfma_f32_16x16x32_bf16 a[4:7], a[164:167], v[40:43], a[4:7]
  v_exp_f32 v97, v97
  v_mfma_f32_16x16x32_bf16 a[4:7], a[160:163], v[8:11], a[4:7]
  ds_read_b64_tr_b16 a[186:187], v219 offset:4096
  v_cvt_pk_bf16_f32 v96, v96, v97
  v_mfma_f32_16x16x32_bf16 a[8:11], a[160:163], v[16:19], a[8:11]
  v_exp_f32 v98, v98
  v_mfma_f32_16x16x32_bf16 a[8:11], a[164:167], v[48:51], a[8:11]
  ds_read_b64_tr_b16 a[188:189], v219 offset:8192
  ds_read_b64_tr_b16 a[242:243], v225 offset:2176
  v_mfma_f32_16x16x32_bf16 a[12:15], a[164:167], v[56:59], a[12:15]
  s_waitcnt lgkmcnt(11)
  v_exp_f32 v99, v99
  v_mfma_f32_16x16x32_bf16 a[12:15], a[160:163], v[24:27], a[12:15]
  ds_read_b64_tr_b16 a[190:191], v219 offset:12288
  v_cvt_pk_bf16_f32 v97, v98, v99
  v_mfma_f32_16x16x32_bf16 a[16:19], a[168:171], v[0:3], a[16:19]
  v_exp_f32 v104, v104
  v_mfma_f32_16x16x32_bf16 a[16:19], a[172:175], v[32:35], a[16:19]
  ds_read_b64_tr_b16 a[160:161], v220 offset:0
  buffer_load_dwordx4 v253, s[24:27], s8 offen offset:0 sc1 lds
  v_mfma_f32_16x16x32_bf16 a[20:23], a[172:175], v[40:43], a[20:23]
  v_exp_f32 v105, v105
  v_mfma_f32_16x16x32_bf16 a[20:23], a[168:171], v[8:11], a[20:23]
  ds_read_b64_tr_b16 a[162:163], v220 offset:4096
  v_cvt_pk_bf16_f32 v104, v104, v105
  v_mfma_f32_16x16x32_bf16 a[24:27], a[168:171], v[16:19], a[24:27]
  v_exp_f32 v106, v106
  v_mfma_f32_16x16x32_bf16 a[24:27], a[172:175], v[48:51], a[24:27]
  ds_read_b64_tr_b16 a[164:165], v220 offset:8192
  s_waitcnt lgkmcnt(4)
  buffer_load_dwordx4 v253, s[24:27], s8 offen offset:1024 sc1 lds
  v_mfma_f32_16x16x32_bf16 v[228:231], a[232:235], a[212:215], 0
  v_mfma_f32_16x16x32_bf16 v[228:231], a[236:239], a[216:219], v[228:231]
  v_mfma_f32_16x16x32_bf16 v[228:231], a[240:243], a[220:223], v[228:231]
  v_mfma_f32_16x16x32_bf16 a[28:31], a[172:175], v[56:59], a[28:31]
  s_lshl_b32 s35, s3, 10
  s_add_u32 s35, s35, 159744
  v_exp_f32 v107, v107
  v_mfma_f32_16x16x32_bf16 a[28:31], a[168:171], v[24:27], a[28:31]
  ds_read_b64_tr_b16 a[166:167], v220 offset:12288
  v_cvt_pk_bf16_f32 v105, v106, v107
  v_mfma_f32_16x16x32_bf16 a[32:35], a[176:179], v[0:3], a[32:35]
  v_exp_f32 v112, v112
  v_mfma_f32_16x16x32_bf16 a[32:35], a[180:183], v[32:35], a[32:35]
  ds_read_b64_tr_b16 a[168:169], v221 offset:0
  buffer_load_dwordx4 v253, s[24:27], s8 offen offset:2048 sc1 lds
  v_mfma_f32_16x16x32_bf16 a[36:39], a[180:183], v[40:43], a[36:39]
  v_exp_f32 v113, v113
  v_mfma_f32_16x16x32_bf16 a[36:39], a[176:179], v[8:11], a[36:39]
  ds_read_b64_tr_b16 a[170:171], v221 offset:4096
  v_cvt_pk_bf16_f32 v112, v112, v113
  v_mfma_f32_16x16x32_bf16 a[40:43], a[176:179], v[16:19], a[40:43]
  v_exp_f32 v114, v114
  v_mfma_f32_16x16x32_bf16 a[40:43], a[180:183], v[48:51], a[40:43]
  ds_read_b64_tr_b16 a[172:173], v221 offset:8192
  buffer_load_dwordx4 v253, s[24:27], s8 offen offset:3072 sc1 lds
  v_mfma_f32_16x16x32_bf16 a[44:47], a[180:183], v[56:59], a[44:47]
  s_waitcnt lgkmcnt(7)
  v_exp_f32 v115, v115
  v_mfma_f32_16x16x32_bf16 a[44:47], a[176:179], v[24:27], a[44:47]
  ds_read_b64_tr_b16 a[174:175], v221 offset:12288
  v_cvt_pk_bf16_f32 v113, v114, v115
  v_mfma_f32_16x16x32_bf16 a[48:51], a[184:187], v[0:3], a[48:51]
  v_exp_f32 v120, v120
  v_mfma_f32_16x16x32_bf16 a[48:51], a[188:191], v[32:35], a[48:51]
  ds_read_b64_tr_b16 a[176:177], v222 offset:0
  v_add_u32 v224, s35, v242
  v_mfma_f32_16x16x32_bf16 a[52:55], a[188:191], v[40:43], a[52:55]
  v_exp_f32 v121, v121
  v_mfma_f32_16x16x32_bf16 a[52:55], a[184:187], v[8:11], a[52:55]
  ds_read_b64_tr_b16 a[178:179], v222 offset:4096
  v_cvt_pk_bf16_f32 v120, v120, v121
  v_mfma_f32_16x16x32_bf16 a[56:59], a[184:187], v[16:19], a[56:59]
  v_exp_f32 v122, v122
  v_mfma_f32_16x16x32_bf16 a[56:59], a[188:191], v[48:51], a[56:59]
  ds_read_b64_tr_b16 a[180:181], v222 offset:8192
  ds_write_b128 v224, v[228:231]
  v_mfma_f32_16x16x32_bf16 a[60:63], a[188:191], v[56:59], a[60:63]
  s_waitcnt lgkmcnt(8)
  v_exp_f32 v123, v123
  v_mfma_f32_16x16x32_bf16 a[60:63], a[184:187], v[24:27], a[60:63]
  ds_read_b64_tr_b16 a[182:183], v222 offset:12288
  v_cvt_pk_bf16_f32 v121, v122, v123
  v_mfma_f32_16x16x32_bf16 a[64:67], a[160:163], v[0:3], a[64:67]
  v_exp_f32 v100, v100
  v_mfma_f32_16x16x32_bf16 a[64:67], a[164:167], v[32:35], a[64:67]
  ds_read_b64_tr_b16 a[184:185], v223 offset:0
  v_mfma_f32_16x16x32_bf16 a[68:71], a[164:167], v[40:43], a[68:71]
  v_exp_f32 v101, v101
  v_mfma_f32_16x16x32_bf16 a[68:71], a[160:163], v[8:11], a[68:71]
  ds_read_b64_tr_b16 a[186:187], v223 offset:4096
  v_cvt_pk_bf16_f32 v98, v100, v101
  v_mfma_f32_16x16x32_bf16 a[72:75], a[160:163], v[16:19], a[72:75]
  v_exp_f32 v102, v102
  v_mfma_f32_16x16x32_bf16 a[72:75], a[164:167], v[48:51], a[72:75]
  ds_read_b64_tr_b16 a[188:189], v223 offset:8192
  s_waitcnt lgkmcnt(4)
  v_mfma_f32_16x16x32_bf16 a[76:79], a[164:167], v[56:59], a[76:79]
  v_exp_f32 v103, v103
  v_mfma_f32_16x16x32_bf16 a[76:79], a[160:163], v[24:27], a[76:79]
  ds_read_b64_tr_b16 a[190:191], v223 offset:12288
  v_cvt_pk_bf16_f32 v99, v102, v103
  v_mfma_f32_16x16x32_bf16 a[80:83], a[168:171], v[0:3], a[80:83]
  s_waitcnt vmcnt(12)
  v_exp_f32 v108, v108
  v_mfma_f32_16x16x32_bf16 a[80:83], a[172:175], v[32:35], a[80:83]
  v_mfma_f32_16x16x32_bf16 a[84:87], a[172:175], v[40:43], a[84:87]
  s_barrier
  v_exp_f32 v109, v109
  v_mfma_f32_16x16x32_bf16 a[84:87], a[168:171], v[8:11], a[84:87]
  ds_read_b128 a[128:131], v212 offset:32768
  v_cvt_pk_bf16_f32 v106, v108, v109
  v_mfma_f32_16x16x32_bf16 a[88:91], a[168:171], v[16:19], a[88:91]
  v_exp_f32 v110, v110
  v_mfma_f32_16x16x32_bf16 a[88:91], a[172:175], v[48:51], a[88:91]
  ds_read_b128 a[132:135], v213 offset:32768
  v_mfma_f32_16x16x32_bf16 a[92:95], a[172:175], v[56:59], a[92:95]
  s_waitcnt lgkmcnt(6)
  v_exp_f32 v111, v111
  v_mfma_f32_16x16x32_bf16 a[92:95], a[168:171], v[24:27], a[92:95]
  ds_read_b128 a[136:139], v214 offset:32768
  v_cvt_pk_bf16_f32 v107, v110, v111
  v_mfma_f32_16x16x32_bf16 a[96:99], a[176:179], v[0:3], a[96:99]
  v_exp_f32 v116, v116
  v_mfma_f32_16x16x32_bf16 a[96:99], a[180:183], v[32:35], a[96:99]
  ds_read_b128 a[140:143], v215 offset:32768
  v_mfma_f32_16x16x32_bf16 a[100:103], a[180:183], v[40:43], a[100:103]
  v_exp_f32 v117, v117
  v_mfma_f32_16x16x32_bf16 a[100:103], a[176:179], v[8:11], a[100:103]
  v_cvt_pk_bf16_f32 v114, v116, v117
  v_mfma_f32_16x16x32_bf16 a[104:107], a[176:179], v[16:19], a[104:107]
  v_exp_f32 v118, v118
  v_mfma_f32_16x16x32_bf16 a[104:107], a[180:183], v[48:51], a[104:107]
  v_mfma_f32_16x16x32_bf16 a[108:111], a[180:183], v[56:59], a[108:111]
  s_waitcnt lgkmcnt(4)
  v_exp_f32 v119, v119
  v_mfma_f32_16x16x32_bf16 a[108:111], a[176:179], v[24:27], a[108:111]
  v_cvt_pk_bf16_f32 v115, v118, v119
  v_mfma_f32_16x16x32_bf16 a[112:115], a[184:187], v[0:3], a[112:115]
  v_exp_f32 v124, v124
  v_mfma_f32_16x16x32_bf16 a[112:115], a[188:191], v[32:35], a[112:115]
  v_mfma_f32_16x16x32_bf16 a[116:119], a[188:191], v[40:43], a[116:119]
  v_exp_f32 v125, v125
  v_mfma_f32_16x16x32_bf16 a[116:119], a[184:187], v[8:11], a[116:119]
  v_cvt_pk_bf16_f32 v122, v124, v125
  v_mfma_f32_16x16x32_bf16 a[120:123], a[184:187], v[16:19], a[120:123]
  v_exp_f32 v126, v126
  v_mfma_f32_16x16x32_bf16 a[120:123], a[188:191], v[48:51], a[120:123]
  v_mfma_f32_16x16x32_bf16 a[124:127], a[188:191], v[56:59], a[124:127]
  s_waitcnt lgkmcnt(0)
  v_exp_f32 v127, v127
  v_mfma_f32_16x16x32_bf16 a[124:127], a[184:187], v[24:27], a[124:127]
  v_cvt_pk_bf16_f32 v123, v126, v127
  v_mfma_f32_16x16x32_bf16 v[0:3], a[128:131], v[128:131], v[192:195]
  s_add_u32 m0, s28, 114688
  v_add_u32 v224, 159744, v242
  v_mfma_f32_16x16x32_bf16 v[0:3], a[132:135], v[132:135], v[0:3]
  ds_read_b128 a[144:147], v212 offset:36864
  ds_read_b128 v[228:231], v224 offset:0
  v_mfma_f32_16x16x32_bf16 v[0:3], a[136:139], v[136:139], v[0:3]
  buffer_load_dwordx4 v236, s[16:19], s29 offen offset:0 lds
  v_mfma_f32_16x16x32_bf16 v[0:3], a[140:143], v[140:143], v[0:3]
  ds_read_b128 a[148:151], v213 offset:36864
  ds_read_b128 v[238:241], v224 offset:1024
  v_mfma_f32_16x16x32_bf16 v[8:11], a[140:143], v[156:159], v[196:199]
  ds_read_b128 v[208:211], v224 offset:2048
  v_lshrrev_b32 v224, 4, v242
  v_mfma_f32_16x16x32_bf16 v[8:11], a[136:139], v[152:155], v[8:11]
  ds_read_b128 a[152:155], v214 offset:36864
  s_min_u32 s35, s3, 1
  s_lshl_b32 s35, s35, 30
  v_and_b32 v225, 7, v224
  v_mfma_f32_16x16x32_bf16 v[8:11], a[132:135], v[148:151], v[8:11]
  buffer_load_dwordx4 v237, s[16:19], s29 offen offset:1024 lds
  v_mfma_f32_16x16x32_bf16 v[8:11], a[128:131], v[144:147], v[8:11]
  ds_read_b128 a[156:159], v215 offset:36864
  v_mul_u32_u24 v225, 0xa00, v225
  v_mfma_f32_16x16x32_bf16 v[16:19], a[128:131], v[160:163], v[200:203]
  v_exp_f32 v0, v0
  v_mfma_f32_16x16x32_bf16 v[16:19], a[132:135], v[164:167], v[16:19]
  v_lshrrev_b32 v226, 4, v224
  v_lshl_add_u32 v225, v226, 4, v225
  v_mfma_f32_16x16x32_bf16 v[16:19], a[136:139], v[168:171], v[16:19]
  v_exp_f32 v1, v1
  v_mfma_f32_16x16x32_bf16 v[16:19], a[140:143], v[172:175], v[16:19]
  v_cvt_pk_bf16_f32 v0, v0, v1
  v_bfe_u32 v226, v224, 3, 1
  v_mfma_f32_16x16x32_bf16 v[24:27], a[140:143], v[188:191], v[204:207]
  v_exp_f32 v2, v2
  v_mfma_f32_16x16x32_bf16 v[24:27], a[136:139], v[184:187], v[24:27]
  buffer_load_dwordx4 v236, s[16:19], s29 offen offset:2048 lds
  v_mfma_f32_16x16x32_bf16 v[24:27], a[132:135], v[180:183], v[24:27]
  s_waitcnt lgkmcnt(0)
  v_exp_f32 v3, v3
  v_mfma_f32_16x16x32_bf16 v[24:27], a[128:131], v[176:179], v[24:27]
  v_cvt_pk_bf16_f32 v1, v2, v3
  v_lshl_add_u32 v225, v226, 30, v225
  v_mfma_f32_16x16x32_bf16 v[4:7], a[144:147], v[128:131], v[192:195]
  v_exp_f32 v8, v8
  v_mfma_f32_16x16x32_bf16 v[4:7], a[148:151], v[132:135], v[4:7]
  ds_read_b128 a[128:131], v212 offset:40960
  v_or_b32 v225, s35, v225
  v_mfma_f32_16x16x32_bf16 v[4:7], a[152:155], v[136:139], v[4:7]
  s_mul_i32 s35, s98, 20480
  s_lshl_b32 s38, s99, 6
  s_add_u32 s35, s35, s38
  v_exp_f32 v9, v9
  v_mfma_f32_16x16x32_bf16 v[4:7], a[156:159], v[140:143], v[4:7]
  ds_read_b128 a[132:135], v213 offset:40960
  s_add_u32 s35, s35, 2686976
  v_cvt_pk_bf16_f32 v8, v8, v9
  v_mfma_f32_16x16x32_bf16 v[12:15], a[156:159], v[156:159], v[196:199]
  v_exp_f32 v10, v10
  v_mfma_f32_16x16x32_bf16 v[12:15], a[152:155], v[152:155], v[12:15]
  ds_read_b128 a[136:139], v214 offset:40960
  v_add_f32 v228, v228, v238
  v_mfma_f32_16x16x32_bf16 v[12:15], a[148:151], v[148:151], v[12:15]
  v_exp_f32 v11, v11
  v_mfma_f32_16x16x32_bf16 v[12:15], a[144:147], v[144:147], v[12:15]
  ds_read_b128 a[140:143], v215 offset:40960
  v_cvt_pk_bf16_f32 v9, v10, v11
  v_mfma_f32_16x16x32_bf16 v[20:23], a[144:147], v[160:163], v[200:203]
  v_exp_f32 v16, v16
  v_mfma_f32_16x16x32_bf16 v[20:23], a[148:151], v[164:167], v[20:23]
  buffer_load_dwordx4 v237, s[16:19], s29 offen offset:3072 lds
  v_mfma_f32_16x16x32_bf16 v[20:23], a[152:155], v[168:171], v[20:23]
  s_add_u32 s29, s29, 16384
  v_exp_f32 v17, v17
  v_mfma_f32_16x16x32_bf16 v[20:23], a[156:159], v[172:175], v[20:23]
  v_cvt_pk_bf16_f32 v16, v16, v17
  v_add_f32 v229, v229, v239
  v_mfma_f32_16x16x32_bf16 v[28:31], a[156:159], v[188:191], v[204:207]
  s_add_u32 m0, s28, 16384
  v_exp_f32 v18, v18
  v_mfma_f32_16x16x32_bf16 v[28:31], a[152:155], v[184:187], v[28:31]
  buffer_load_dwordx4 v242, s[24:27], s9 offen offset:0 sc1 lds
  v_mfma_f32_16x16x32_bf16 v[28:31], a[148:151], v[180:183], v[28:31]
  s_waitcnt lgkmcnt(0)
  v_exp_f32 v19, v19
  v_mfma_f32_16x16x32_bf16 v[28:31], a[144:147], v[176:179], v[28:31]
  v_cvt_pk_bf16_f32 v17, v18, v19
  v_add_f32 v230, v230, v240
  v_mfma_f32_16x16x32_bf16 v[32:35], a[128:131], v[128:131], v[192:195]
  v_exp_f32 v24, v24
  v_mfma_f32_16x16x32_bf16 v[32:35], a[132:135], v[132:135], v[32:35]
  ds_read_b128 a[144:147], v212 offset:45056
  v_add_f32 v231, v231, v241
  v_mfma_f32_16x16x32_bf16 v[32:35], a[136:139], v[136:139], v[32:35]
  v_exp_f32 v25, v25
  v_mfma_f32_16x16x32_bf16 v[32:35], a[140:143], v[140:143], v[32:35]
  ds_read_b128 a[148:151], v213 offset:45056
  v_cvt_pk_bf16_f32 v24, v24, v25
  v_mfma_f32_16x16x32_bf16 v[40:43], a[140:143], v[156:159], v[196:199]
  v_exp_f32 v26, v26
  v_mfma_f32_16x16x32_bf16 v[40:43], a[136:139], v[152:155], v[40:43]
  ds_read_b128 a[152:155], v214 offset:45056
  v_add_f32 v228, v228, v208
  v_mfma_f32_16x16x32_bf16 v[40:43], a[132:135], v[148:151], v[40:43]
  v_exp_f32 v27, v27
  v_mfma_f32_16x16x32_bf16 v[40:43], a[128:131], v[144:147], v[40:43]
  ds_read_b128 a[156:159], v215 offset:45056
  v_cvt_pk_bf16_f32 v25, v26, v27
  v_mfma_f32_16x16x32_bf16 v[48:51], a[128:131], v[160:163], v[200:203]
  v_exp_f32 v4, v4
  v_mfma_f32_16x16x32_bf16 v[48:51], a[132:135], v[164:167], v[48:51]
  buffer_load_dwordx4 v242, s[24:27], s9 offen offset:1024 sc1 lds
  v_mfma_f32_16x16x32_bf16 v[48:51], a[136:139], v[168:171], v[48:51]
  v_exp_f32 v5, v5
  v_mfma_f32_16x16x32_bf16 v[48:51], a[140:143], v[172:175], v[48:51]
  v_cvt_pk_bf16_f32 v2, v4, v5
  v_add_f32 v229, v229, v209
  v_mfma_f32_16x16x32_bf16 v[56:59], a[140:143], v[188:191], v[204:207]
  v_exp_f32 v6, v6
  v_mfma_f32_16x16x32_bf16 v[56:59], a[136:139], v[184:187], v[56:59]
  buffer_load_dwordx4 v242, s[24:27], s9 offen offset:2048 sc1 lds
  v_mfma_f32_16x16x32_bf16 v[56:59], a[132:135], v[180:183], v[56:59]
  s_waitcnt lgkmcnt(0)
  v_exp_f32 v7, v7
  v_mfma_f32_16x16x32_bf16 v[56:59], a[128:131], v[176:179], v[56:59]
  v_cvt_pk_bf16_f32 v3, v6, v7
  v_add_f32 v230, v230, v210
  v_mfma_f32_16x16x32_bf16 v[36:39], a[144:147], v[128:131], v[192:195]
  v_exp_f32 v12, v12
  v_mfma_f32_16x16x32_bf16 v[36:39], a[148:151], v[132:135], v[36:39]
  ds_read_b64_tr_b16 a[160:161], v216 offset:16384
  v_add_f32 v231, v231, v211
  v_mfma_f32_16x16x32_bf16 v[36:39], a[152:155], v[136:139], v[36:39]
  v_exp_f32 v13, v13
  v_mfma_f32_16x16x32_bf16 v[36:39], a[156:159], v[140:143], v[36:39]
  ds_read_b64_tr_b16 a[162:163], v216 offset:20480
  v_cvt_pk_bf16_f32 v10, v12, v13
  v_mfma_f32_16x16x32_bf16 v[44:47], a[156:159], v[156:159], v[196:199]
  v_exp_f32 v14, v14
  v_mfma_f32_16x16x32_bf16 v[44:47], a[152:155], v[152:155], v[44:47]
  ds_read_b64_tr_b16 a[164:165], v216 offset:24576
  buffer_load_dwordx4 v242, s[24:27], s9 offen offset:3072 sc1 lds
  v_mfma_f32_16x16x32_bf16 v[44:47], a[148:151], v[148:151], v[44:47]
  v_exp_f32 v15, v15
  v_mfma_f32_16x16x32_bf16 v[44:47], a[144:147], v[144:147], v[44:47]
  ds_read_b64_tr_b16 a[166:167], v216 offset:28672
  v_cvt_pk_bf16_f32 v11, v14, v15
  v_mfma_f32_16x16x32_bf16 v[52:55], a[144:147], v[160:163], v[200:203]
  v_exp_f32 v20, v20
  v_mfma_f32_16x16x32_bf16 v[52:55], a[148:151], v[164:167], v[52:55]
  ds_read_b64_tr_b16 a[168:169], v217 offset:16384
  buffer_store_dwordx4 v[228:231], v225, s[24:27], s35 offen sc1
  v_mfma_f32_16x16x32_bf16 v[52:55], a[152:155], v[168:171], v[52:55]
  v_exp_f32 v21, v21
  v_mfma_f32_16x16x32_bf16 v[52:55], a[156:159], v[172:175], v[52:55]
  ds_read_b64_tr_b16 a[170:171], v217 offset:20480
  v_cvt_pk_bf16_f32 v18, v20, v21
  v_mfma_f32_16x16x32_bf16 v[60:63], a[156:159], v[188:191], v[204:207]
  v_exp_f32 v22, v22
  v_mfma_f32_16x16x32_bf16 v[60:63], a[152:155], v[184:187], v[60:63]
  ds_read_b64_tr_b16 a[172:173], v217 offset:24576
  buffer_load_dwordx4 a[212:215], v242, s[24:27], s4 offen offset:0 sc1
  v_mfma_f32_16x16x32_bf16 v[60:63], a[148:151], v[180:183], v[60:63]
  v_exp_f32 v23, v23
  v_mfma_f32_16x16x32_bf16 v[60:63], a[144:147], v[176:179], v[60:63]
  ds_read_b64_tr_b16 a[174:175], v217 offset:28672
  v_cvt_pk_bf16_f32 v19, v22, v23
  v_mfma_f32_16x16x32_bf16 a[192:195], a[208:211], v[64:67], a[192:195]
  v_exp_f32 v28, v28
  v_mfma_f32_16x16x32_bf16 a[192:195], a[208:211], v[96:99], a[192:195]
  ds_read_b64_tr_b16 a[176:177], v218 offset:16384
  buffer_load_dwordx4 a[216:219], v242, s[24:27], s4 offen offset:1024 sc1
  v_mfma_f32_16x16x32_bf16 a[196:199], a[208:211], v[72:75], a[196:199]
  v_exp_f32 v29, v29
  v_mfma_f32_16x16x32_bf16 a[196:199], a[208:211], v[104:107], a[196:199]
  ds_read_b64_tr_b16 a[178:179], v218 offset:20480
  v_cvt_pk_bf16_f32 v26, v28, v29
  v_mfma_f32_16x16x32_bf16 a[200:203], a[208:211], v[80:83], a[200:203]
  v_exp_f32 v30, v30
  v_mfma_f32_16x16x32_bf16 a[200:203], a[208:211], v[112:115], a[200:203]
  ds_read_b64_tr_b16 a[180:181], v218 offset:24576
  v_mfma_f32_16x16x32_bf16 a[204:207], a[208:211], v[88:91], a[204:207]
  s_waitcnt lgkmcnt(7)
  v_exp_f32 v31, v31
  v_mfma_f32_16x16x32_bf16 a[204:207], a[208:211], v[120:123], a[204:207]
  ds_read_b64_tr_b16 a[182:183], v218 offset:28672
  v_cvt_pk_bf16_f32 v27, v30, v31
  v_mfma_f32_16x16x32_bf16 a[0:3], a[160:163], v[64:67], a[0:3]
  v_exp_f32 v32, v32
  v_mfma_f32_16x16x32_bf16 a[0:3], a[164:167], v[96:99], a[0:3]
  ds_read_b64_tr_b16 a[184:185], v219 offset:16384
  buffer_load_dwordx4 a[220:223], v242, s[24:27], s4 offen offset:2048 sc1
  v_mfma_f32_16x16x32_bf16 a[4:7], a[164:167], v[104:107], a[4:7]
  v_exp_f32 v33, v33
  v_mfma_f32_16x16x32_bf16 a[4:7], a[160:163], v[72:75], a[4:7]
  ds_read_b64_tr_b16 a[186:187], v219 offset:20480
  v_cvt_pk_bf16_f32 v32, v32, v33
  v_mfma_f32_16x16x32_bf16 a[8:11], a[160:163], v[80:83], a[8:11]
  v_exp_f32 v34, v34
  v_mfma_f32_16x16x32_bf16 a[8:11], a[164:167], v[112:115], a[8:11]
  ds_read_b64_tr_b16 a[188:189], v219 offset:24576
  v_mfma_f32_16x16x32_bf16 a[12:15], a[164:167], v[120:123], a[12:15]
  s_waitcnt lgkmcnt(7)
  v_exp_f32 v35, v35
  v_mfma_f32_16x16x32_bf16 a[12:15], a[160:163], v[88:91], a[12:15]
  ds_read_b64_tr_b16 a[190:191], v219 offset:28672
  v_cvt_pk_bf16_f32 v33, v34, v35
  v_mfma_f32_16x16x32_bf16 a[16:19], a[168:171], v[64:67], a[16:19]
  v_exp_f32 v40, v40
  v_mfma_f32_16x16x32_bf16 a[16:19], a[172:175], v[96:99], a[16:19]
  ds_read_b64_tr_b16 a[160:161], v220 offset:16384
  buffer_load_dwordx4 a[224:227], v242, s[24:27], s4 offen offset:3072 sc1
  v_mfma_f32_16x16x32_bf16 a[20:23], a[172:175], v[104:107], a[20:23]
  v_exp_f32 v41, v41
  v_mfma_f32_16x16x32_bf16 a[20:23], a[168:171], v[72:75], a[20:23]
  ds_read_b64_tr_b16 a[162:163], v220 offset:20480
  v_cvt_pk_bf16_f32 v40, v40, v41
  v_mfma_f32_16x16x32_bf16 a[24:27], a[168:171], v[80:83], a[24:27]
  v_exp_f32 v42, v42
  v_mfma_f32_16x16x32_bf16 a[24:27], a[172:175], v[112:115], a[24:27]
  ds_read_b64_tr_b16 a[164:165], v220 offset:24576
  v_mfma_f32_16x16x32_bf16 a[28:31], a[172:175], v[120:123], a[28:31]
  s_waitcnt lgkmcnt(7)
  v_exp_f32 v43, v43
  v_mfma_f32_16x16x32_bf16 a[28:31], a[168:171], v[88:91], a[28:31]
  ds_read_b64_tr_b16 a[166:167], v220 offset:28672
  v_cvt_pk_bf16_f32 v41, v42, v43
  v_mfma_f32_16x16x32_bf16 a[32:35], a[176:179], v[64:67], a[32:35]
  v_exp_f32 v48, v48
  v_mfma_f32_16x16x32_bf16 a[32:35], a[180:183], v[96:99], a[32:35]
  ds_read_b64_tr_b16 a[168:169], v221 offset:16384
  buffer_load_dwordx4 a[228:231], v252, s[24:27], s4 offen offset:0 sc1
  v_mfma_f32_16x16x32_bf16 a[36:39], a[180:183], v[104:107], a[36:39]
  v_exp_f32 v49, v49
  v_mfma_f32_16x16x32_bf16 a[36:39], a[176:179], v[72:75], a[36:39]
  ds_read_b64_tr_b16 a[170:171], v221 offset:20480
  v_cvt_pk_bf16_f32 v48, v48, v49
  v_mfma_f32_16x16x32_bf16 a[40:43], a[176:179], v[80:83], a[40:43]
  v_exp_f32 v50, v50
  v_mfma_f32_16x16x32_bf16 a[40:43], a[180:183], v[112:115], a[40:43]
  ds_read_b64_tr_b16 a[172:173], v221 offset:24576
  v_mfma_f32_16x16x32_bf16 a[44:47], a[180:183], v[120:123], a[44:47]
  s_waitcnt lgkmcnt(7)
  v_exp_f32 v51, v51
  v_mfma_f32_16x16x32_bf16 a[44:47], a[176:179], v[88:91], a[44:47]
  ds_read_b64_tr_b16 a[174:175], v221 offset:28672
  v_cvt_pk_bf16_f32 v49, v50, v51
  v_mfma_f32_16x16x32_bf16 a[48:51], a[184:187], v[64:67], a[48:51]
  v_exp_f32 v56, v56
  v_mfma_f32_16x16x32_bf16 a[48:51], a[188:191], v[96:99], a[48:51]
  ds_read_b64_tr_b16 a[176:177], v222 offset:16384
  buffer_load_dwordx4 a[232:235], v252, s[24:27], s4 offen offset:1024 sc1
  v_mfma_f32_16x16x32_bf16 a[52:55], a[188:191], v[104:107], a[52:55]
  v_exp_f32 v57, v57
  v_mfma_f32_16x16x32_bf16 a[52:55], a[184:187], v[72:75], a[52:55]
  ds_read_b64_tr_b16 a[178:179], v222 offset:20480
  v_cvt_pk_bf16_f32 v56, v56, v57
  v_mfma_f32_16x16x32_bf16 a[56:59], a[184:187], v[80:83], a[56:59]
  v_exp_f32 v58, v58
  v_mfma_f32_16x16x32_bf16 a[56:59], a[188:191], v[112:115], a[56:59]
  ds_read_b64_tr_b16 a[180:181], v222 offset:24576
  v_mfma_f32_16x16x32_bf16 a[60:63], a[188:191], v[120:123], a[60:63]
  s_waitcnt lgkmcnt(7)
  v_exp_f32 v59, v59
  v_mfma_f32_16x16x32_bf16 a[60:63], a[184:187], v[88:91], a[60:63]
  ds_read_b64_tr_b16 a[182:183], v222 offset:28672
  v_cvt_pk_bf16_f32 v57, v58, v59
  v_mfma_f32_16x16x32_bf16 a[64:67], a[160:163], v[64:67], a[64:67]
  v_exp_f32 v36, v36
  v_mfma_f32_16x16x32_bf16 a[64:67], a[164:167], v[96:99], a[64:67]
  ds_read_b64_tr_b16 a[184:185], v223 offset:16384
  v_mfma_f32_16x16x32_bf16 a[68:71], a[164:167], v[104:107], a[68:71]
  v_exp_f32 v37, v37
  v_mfma_f32_16x16x32_bf16 a[68:71], a[160:163], v[72:75], a[68:71]
  ds_read_b64_tr_b16 a[186:187], v223 offset:20480
  v_cvt_pk_bf16_f32 v34, v36, v37
  v_mfma_f32_16x16x32_bf16 a[72:75], a[160:163], v[80:83], a[72:75]
  v_exp_f32 v38, v38
  v_mfma_f32_16x16x32_bf16 a[72:75], a[164:167], v[112:115], a[72:75]
  ds_read_b64_tr_b16 a[188:189], v223 offset:24576
  v_mfma_f32_16x16x32_bf16 a[76:79], a[164:167], v[120:123], a[76:79]
  s_waitcnt lgkmcnt(7)
  v_exp_f32 v39, v39
  v_mfma_f32_16x16x32_bf16 a[76:79], a[160:163], v[88:91], a[76:79]
  ds_read_b64_tr_b16 a[190:191], v223 offset:28672
  v_cvt_pk_bf16_f32 v35, v38, v39
  v_mfma_f32_16x16x32_bf16 a[80:83], a[168:171], v[64:67], a[80:83]
  s_waitcnt vmcnt(19)
  v_exp_f32 v44, v44
  v_mfma_f32_16x16x32_bf16 a[80:83], a[172:175], v[96:99], a[80:83]
  v_mfma_f32_16x16x32_bf16 a[84:87], a[172:175], v[104:107], a[84:87]
  s_barrier
  v_exp_f32 v45, v45
  v_mfma_f32_16x16x32_bf16 a[84:87], a[168:171], v[72:75], a[84:87]
  ds_read_b128 a[128:131], v212 offset:49152
  v_cvt_pk_bf16_f32 v42, v44, v45
  v_mfma_f32_16x16x32_bf16 a[88:91], a[168:171], v[80:83], a[88:91]
  v_exp_f32 v46, v46
  v_mfma_f32_16x16x32_bf16 a[88:91], a[172:175], v[112:115], a[88:91]
  ds_read_b128 a[132:135], v213 offset:49152
  v_mfma_f32_16x16x32_bf16 a[92:95], a[172:175], v[120:123], a[92:95]
  s_waitcnt lgkmcnt(6)
  v_exp_f32 v47, v47
  v_mfma_f32_16x16x32_bf16 a[92:95], a[168:171], v[88:91], a[92:95]
  ds_read_b128 a[136:139], v214 offset:49152
  v_cvt_pk_bf16_f32 v43, v46, v47
  v_mfma_f32_16x16x32_bf16 a[96:99], a[176:179], v[64:67], a[96:99]
  v_exp_f32 v52, v52
  v_mfma_f32_16x16x32_bf16 a[96:99], a[180:183], v[96:99], a[96:99]
  ds_read_b128 a[140:143], v215 offset:49152
  v_mfma_f32_16x16x32_bf16 a[100:103], a[180:183], v[104:107], a[100:103]
  v_exp_f32 v53, v53
  v_mfma_f32_16x16x32_bf16 a[100:103], a[176:179], v[72:75], a[100:103]
  v_cvt_pk_bf16_f32 v50, v52, v53
  v_mfma_f32_16x16x32_bf16 a[104:107], a[176:179], v[80:83], a[104:107]
  v_exp_f32 v54, v54
  v_mfma_f32_16x16x32_bf16 a[104:107], a[180:183], v[112:115], a[104:107]
  v_mfma_f32_16x16x32_bf16 a[108:111], a[180:183], v[120:123], a[108:111]
  s_waitcnt lgkmcnt(4)
  v_exp_f32 v55, v55
  v_mfma_f32_16x16x32_bf16 a[108:111], a[176:179], v[88:91], a[108:111]
  v_cvt_pk_bf16_f32 v51, v54, v55
  v_mfma_f32_16x16x32_bf16 a[112:115], a[184:187], v[64:67], a[112:115]
  v_exp_f32 v60, v60
  v_mfma_f32_16x16x32_bf16 a[112:115], a[188:191], v[96:99], a[112:115]
  v_mfma_f32_16x16x32_bf16 a[116:119], a[188:191], v[104:107], a[116:119]
  v_exp_f32 v61, v61
  v_mfma_f32_16x16x32_bf16 a[116:119], a[184:187], v[72:75], a[116:119]
  v_cvt_pk_bf16_f32 v58, v60, v61
  v_mfma_f32_16x16x32_bf16 a[120:123], a[184:187], v[80:83], a[120:123]
  v_exp_f32 v62, v62
  v_mfma_f32_16x16x32_bf16 a[120:123], a[188:191], v[112:115], a[120:123]
  v_mfma_f32_16x16x32_bf16 a[124:127], a[188:191], v[120:123], a[124:127]
  s_waitcnt lgkmcnt(0)
  v_exp_f32 v63, v63
  v_mfma_f32_16x16x32_bf16 a[124:127], a[184:187], v[88:91], a[124:127]
  v_cvt_pk_bf16_f32 v59, v62, v63
  v_mfma_f32_16x16x32_bf16 v[64:67], a[128:131], v[128:131], v[192:195]
  s_add_u32 m0, s28, 65536
  v_mfma_f32_16x16x32_bf16 v[64:67], a[132:135], v[132:135], v[64:67]
  ds_read_b128 a[144:147], v212 offset:53248
  v_mfma_f32_16x16x32_bf16 v[64:67], a[136:139], v[136:139], v[64:67]
  buffer_load_dwordx4 v253, s[24:27], s9 offen offset:0 sc1 lds
  v_mfma_f32_16x16x32_bf16 v[64:67], a[140:143], v[140:143], v[64:67]
  ds_read_b128 a[148:151], v213 offset:53248
  v_mfma_f32_16x16x32_bf16 v[72:75], a[140:143], v[156:159], v[196:199]
  v_mfma_f32_16x16x32_bf16 v[72:75], a[136:139], v[152:155], v[72:75]
  ds_read_b128 a[152:155], v214 offset:53248
  v_mfma_f32_16x16x32_bf16 v[72:75], a[132:135], v[148:151], v[72:75]
  buffer_load_dwordx4 v253, s[24:27], s9 offen offset:1024 sc1 lds
  v_mfma_f32_16x16x32_bf16 v[72:75], a[128:131], v[144:147], v[72:75]
  ds_read_b128 a[156:159], v215 offset:53248
  v_mfma_f32_16x16x32_bf16 v[80:83], a[128:131], v[160:163], v[200:203]
  v_exp_f32 v64, v64
  v_mfma_f32_16x16x32_bf16 v[80:83], a[132:135], v[164:167], v[80:83]
  v_mfma_f32_16x16x32_bf16 v[80:83], a[136:139], v[168:171], v[80:83]
  v_exp_f32 v65, v65
  v_mfma_f32_16x16x32_bf16 v[80:83], a[140:143], v[172:175], v[80:83]
  v_cvt_pk_bf16_f32 v64, v64, v65
  v_mfma_f32_16x16x32_bf16 v[88:91], a[140:143], v[188:191], v[204:207]
  v_exp_f32 v66, v66
  v_mfma_f32_16x16x32_bf16 v[88:91], a[136:139], v[184:187], v[88:91]
  buffer_load_dwordx4 v253, s[24:27], s9 offen offset:2048 sc1 lds
  v_mfma_f32_16x16x32_bf16 v[88:91], a[132:135], v[180:183], v[88:91]
  s_waitcnt lgkmcnt(0)
  v_exp_f32 v67, v67
  v_mfma_f32_16x16x32_bf16 v[88:91], a[128:131], v[176:179], v[88:91]
  v_cvt_pk_bf16_f32 v65, v66, v67
  v_mfma_f32_16x16x32_bf16 v[68:71], a[144:147], v[128:131], v[192:195]
  v_exp_f32 v72, v72
  v_mfma_f32_16x16x32_bf16 v[68:71], a[148:151], v[132:135], v[68:71]
  ds_read_b128 a[128:131], v212 offset:57344
  v_mfma_f32_16x16x32_bf16 v[68:71], a[152:155], v[136:139], v[68:71]
  v_exp_f32 v73, v73
  v_mfma_f32_16x16x32_bf16 v[68:71], a[156:159], v[140:143], v[68:71]
  ds_read_b128 a[132:135], v213 offset:57344
  v_cvt_pk_bf16_f32 v72, v72, v73
  v_mfma_f32_16x16x32_bf16 v[76:79], a[156:159], v[156:159], v[196:199]
  v_exp_f32 v74, v74
  v_mfma_f32_16x16x32_bf16 v[76:79], a[152:155], v[152:155], v[76:79]
  ds_read_b128 a[136:139], v214 offset:57344
  v_mfma_f32_16x16x32_bf16 v[76:79], a[148:151], v[148:151], v[76:79]
  v_exp_f32 v75, v75
  v_mfma_f32_16x16x32_bf16 v[76:79], a[144:147], v[144:147], v[76:79]
  ds_read_b128 a[140:143], v215 offset:57344
  v_cvt_pk_bf16_f32 v73, v74, v75
  v_mfma_f32_16x16x32_bf16 v[84:87], a[144:147], v[160:163], v[200:203]
  v_exp_f32 v80, v80
  v_mfma_f32_16x16x32_bf16 v[84:87], a[148:151], v[164:167], v[84:87]
  buffer_load_dwordx4 v253, s[24:27], s9 offen offset:3072 sc1 lds
  v_mfma_f32_16x16x32_bf16 v[84:87], a[152:155], v[168:171], v[84:87]
  s_add_u32 s29, s29, 16384
  v_exp_f32 v81, v81
  v_mfma_f32_16x16x32_bf16 v[84:87], a[156:159], v[172:175], v[84:87]
  v_cvt_pk_bf16_f32 v80, v80, v81
  v_mfma_f32_16x16x32_bf16 v[92:95], a[156:159], v[188:191], v[204:207]
  s_add_u32 m0, s28, 32768
  v_exp_f32 v82, v82
  v_mfma_f32_16x16x32_bf16 v[92:95], a[152:155], v[184:187], v[92:95]
  buffer_load_dwordx4 v252, s[24:27], s9 offen offset:0 sc1 lds
  v_mfma_f32_16x16x32_bf16 v[92:95], a[148:151], v[180:183], v[92:95]
  s_waitcnt lgkmcnt(0)
  v_exp_f32 v83, v83
  v_mfma_f32_16x16x32_bf16 v[92:95], a[144:147], v[176:179], v[92:95]
  v_cvt_pk_bf16_f32 v81, v82, v83
  v_mfma_f32_16x16x32_bf16 v[96:99], a[128:131], v[128:131], v[192:195]
  v_exp_f32 v88, v88
  v_mfma_f32_16x16x32_bf16 v[96:99], a[132:135], v[132:135], v[96:99]
  ds_read_b128 a[144:147], v212 offset:61440
  v_mfma_f32_16x16x32_bf16 v[96:99], a[136:139], v[136:139], v[96:99]
  v_exp_f32 v89, v89
  v_mfma_f32_16x16x32_bf16 v[96:99], a[140:143], v[140:143], v[96:99]
  ds_read_b128 a[148:151], v213 offset:61440
  v_cvt_pk_bf16_f32 v88, v88, v89
  v_mfma_f32_16x16x32_bf16 v[104:107], a[140:143], v[156:159], v[196:199]
  v_exp_f32 v90, v90
  v_mfma_f32_16x16x32_bf16 v[104:107], a[136:139], v[152:155], v[104:107]
  ds_read_b128 a[152:155], v214 offset:61440
  v_mfma_f32_16x16x32_bf16 v[104:107], a[132:135], v[148:151], v[104:107]
  v_exp_f32 v91, v91
  v_mfma_f32_16x16x32_bf16 v[104:107], a[128:131], v[144:147], v[104:107]
  ds_read_b128 a[156:159], v215 offset:61440
  v_cvt_pk_bf16_f32 v89, v90, v91
  v_mfma_f32_16x16x32_bf16 v[112:115], a[128:131], v[160:163], v[200:203]
  v_exp_f32 v68, v68
  v_mfma_f32_16x16x32_bf16 v[112:115], a[132:135], v[164:167], v[112:115]
  buffer_load_dwordx4 v252, s[24:27], s9 offen offset:1024 sc1 lds
  v_mfma_f32_16x16x32_bf16 v[112:115], a[136:139], v[168:171], v[112:115]
  v_exp_f32 v69, v69
  v_mfma_f32_16x16x32_bf16 v[112:115], a[140:143], v[172:175], v[112:115]
  v_cvt_pk_bf16_f32 v66, v68, v69
  v_mfma_f32_16x16x32_bf16 v[120:123], a[140:143], v[188:191], v[204:207]
  v_exp_f32 v70, v70
  v_mfma_f32_16x16x32_bf16 v[120:123], a[136:139], v[184:187], v[120:123]
  buffer_load_dwordx4 v252, s[24:27], s9 offen offset:2048 sc1 lds
  v_mfma_f32_16x16x32_bf16 v[120:123], a[132:135], v[180:183], v[120:123]
  s_waitcnt lgkmcnt(0)
  v_exp_f32 v71, v71
  v_mfma_f32_16x16x32_bf16 v[120:123], a[128:131], v[176:179], v[120:123]
  v_cvt_pk_bf16_f32 v67, v70, v71
  v_mfma_f32_16x16x32_bf16 v[100:103], a[144:147], v[128:131], v[192:195]
  v_exp_f32 v76, v76
  v_mfma_f32_16x16x32_bf16 v[100:103], a[148:151], v[132:135], v[100:103]
  ds_read_b64_tr_b16 a[160:161], v216 offset:32768
  v_mfma_f32_16x16x32_bf16 v[100:103], a[152:155], v[136:139], v[100:103]
  v_exp_f32 v77, v77
  v_mfma_f32_16x16x32_bf16 v[100:103], a[156:159], v[140:143], v[100:103]
  ds_read_b64_tr_b16 a[162:163], v216 offset:36864
  v_cvt_pk_bf16_f32 v74, v76, v77
  v_mfma_f32_16x16x32_bf16 v[108:111], a[156:159], v[156:159], v[196:199]
  v_exp_f32 v78, v78
  v_mfma_f32_16x16x32_bf16 v[108:111], a[152:155], v[152:155], v[108:111]
  ds_read_b64_tr_b16 a[164:165], v216 offset:40960
  buffer_load_dwordx4 v252, s[24:27], s9 offen offset:3072 sc1 lds
  v_mfma_f32_16x16x32_bf16 v[108:111], a[148:151], v[148:151], v[108:111]
  v_exp_f32 v79, v79
  v_mfma_f32_16x16x32_bf16 v[108:111], a[144:147], v[144:147], v[108:111]
  ds_read_b64_tr_b16 a[166:167], v216 offset:45056
  v_cvt_pk_bf16_f32 v75, v78, v79
  v_mfma_f32_16x16x32_bf16 v[116:119], a[144:147], v[160:163], v[200:203]
  v_exp_f32 v84, v84
  v_mfma_f32_16x16x32_bf16 v[116:119], a[148:151], v[164:167], v[116:119]
  ds_read_b64_tr_b16 a[168:169], v217 offset:32768
  buffer_load_dwordx4 a[236:239], v252, s[24:27], s4 offen offset:2048 sc1
  v_mfma_f32_16x16x32_bf16 v[116:119], a[152:155], v[168:171], v[116:119]
  v_exp_f32 v85, v85
  v_mfma_f32_16x16x32_bf16 v[116:119], a[156:159], v[172:175], v[116:119]
  ds_read_b64_tr_b16 a[170:171], v217 offset:36864
  v_cvt_pk_bf16_f32 v82, v84, v85
  v_mfma_f32_16x16x32_bf16 v[124:127], a[156:159], v[188:191], v[204:207]
  v_exp_f32 v86, v86
  v_mfma_f32_16x16x32_bf16 v[124:127], a[152:155], v[184:187], v[124:127]
  ds_read_b64_tr_b16 a[172:173], v217 offset:40960
  v_mfma_f32_16x16x32_bf16 v[124:127], a[148:151], v[180:183], v[124:127]
  v_exp_f32 v87, v87
  v_mfma_f32_16x16x32_bf16 v[124:127], a[144:147], v[176:179], v[124:127]
  ds_read_b64_tr_b16 a[174:175], v217 offset:45056
  v_cvt_pk_bf16_f32 v83, v86, v87
  v_mfma_f32_16x16x32_bf16 a[192:195], a[208:211], v[0:3], a[192:195]
  v_exp_f32 v92, v92
  v_mfma_f32_16x16x32_bf16 a[192:195], a[208:211], v[32:35], a[192:195]
  ds_read_b64_tr_b16 a[176:177], v218 offset:32768
  buffer_load_dwordx4 a[240:243], v252, s[24:27], s4 offen offset:3072 sc1
  v_mfma_f32_16x16x32_bf16 a[196:199], a[208:211], v[8:11], a[196:199]
  v_exp_f32 v93, v93
  v_mfma_f32_16x16x32_bf16 a[196:199], a[208:211], v[40:43], a[196:199]
  ds_read_b64_tr_b16 a[178:179], v218 offset:36864
  v_cvt_pk_bf16_f32 v90, v92, v93
  v_mfma_f32_16x16x32_bf16 a[200:203], a[208:211], v[16:19], a[200:203]
  v_exp_f32 v94, v94
  v_mfma_f32_16x16x32_bf16 a[200:203], a[208:211], v[48:51], a[200:203]
  ds_read_b64_tr_b16 a[180:181], v218 offset:40960
  v_mfma_f32_16x16x32_bf16 a[204:207], a[208:211], v[24:27], a[204:207]
  s_waitcnt lgkmcnt(7)
  v_exp_f32 v95, v95
  v_mfma_f32_16x16x32_bf16 a[204:207], a[208:211], v[56:59], a[204:207]
  ds_read_b64_tr_b16 a[182:183], v218 offset:45056
  v_cvt_pk_bf16_f32 v91, v94, v95
  v_mfma_f32_16x16x32_bf16 a[0:3], a[160:163], v[0:3], a[0:3]
  v_exp_f32 v96, v96
  v_mfma_f32_16x16x32_bf16 a[0:3], a[164:167], v[32:35], a[0:3]
  ds_read_b64_tr_b16 a[184:185], v219 offset:32768
  buffer_load_dwordx4 a[244:247], v253, s[24:27], s4 offen offset:0 sc1
  v_mfma_f32_16x16x32_bf16 a[4:7], a[164:167], v[40:43], a[4:7]
  v_exp_f32 v97, v97
  v_mfma_f32_16x16x32_bf16 a[4:7], a[160:163], v[8:11], a[4:7]
  ds_read_b64_tr_b16 a[186:187], v219 offset:36864
  v_cvt_pk_bf16_f32 v96, v96, v97
  v_mfma_f32_16x16x32_bf16 a[8:11], a[160:163], v[16:19], a[8:11]
  v_exp_f32 v98, v98
  v_mfma_f32_16x16x32_bf16 a[8:11], a[164:167], v[48:51], a[8:11]
  ds_read_b64_tr_b16 a[188:189], v219 offset:40960
  v_mfma_f32_16x16x32_bf16 a[12:15], a[164:167], v[56:59], a[12:15]
  s_waitcnt lgkmcnt(7)
  v_exp_f32 v99, v99
  v_mfma_f32_16x16x32_bf16 a[12:15], a[160:163], v[24:27], a[12:15]
  ds_read_b64_tr_b16 a[190:191], v219 offset:45056
  v_cvt_pk_bf16_f32 v97, v98, v99
  v_mfma_f32_16x16x32_bf16 a[16:19], a[168:171], v[0:3], a[16:19]
  v_exp_f32 v104, v104
  v_mfma_f32_16x16x32_bf16 a[16:19], a[172:175], v[32:35], a[16:19]
  ds_read_b64_tr_b16 a[160:161], v220 offset:32768
  buffer_load_dwordx4 a[248:251], v253, s[24:27], s4 offen offset:1024 sc1
  v_mfma_f32_16x16x32_bf16 a[20:23], a[172:175], v[40:43], a[20:23]
  v_exp_f32 v105, v105
  v_mfma_f32_16x16x32_bf16 a[20:23], a[168:171], v[8:11], a[20:23]
  ds_read_b64_tr_b16 a[162:163], v220 offset:36864
  v_cvt_pk_bf16_f32 v104, v104, v105
  v_mfma_f32_16x16x32_bf16 a[24:27], a[168:171], v[16:19], a[24:27]
  v_exp_f32 v106, v106
  v_mfma_f32_16x16x32_bf16 a[24:27], a[172:175], v[48:51], a[24:27]
  ds_read_b64_tr_b16 a[164:165], v220 offset:40960
  v_mfma_f32_16x16x32_bf16 a[28:31], a[172:175], v[56:59], a[28:31]
  s_waitcnt lgkmcnt(7)
  v_exp_f32 v107, v107
  v_mfma_f32_16x16x32_bf16 a[28:31], a[168:171], v[24:27], a[28:31]
  ds_read_b64_tr_b16 a[166:167], v220 offset:45056
  v_cvt_pk_bf16_f32 v105, v106, v107
  v_mfma_f32_16x16x32_bf16 a[32:35], a[176:179], v[0:3], a[32:35]
  v_exp_f32 v112, v112
  v_mfma_f32_16x16x32_bf16 a[32:35], a[180:183], v[32:35], a[32:35]
  ds_read_b64_tr_b16 a[168:169], v221 offset:32768
  buffer_load_dwordx4 a[252:255], v253, s[24:27], s4 offen offset:2048 sc1
  v_mfma_f32_16x16x32_bf16 a[36:39], a[180:183], v[40:43], a[36:39]
  v_exp_f32 v113, v113
  v_mfma_f32_16x16x32_bf16 a[36:39], a[176:179], v[8:11], a[36:39]
  ds_read_b64_tr_b16 a[170:171], v221 offset:36864
  v_cvt_pk_bf16_f32 v112, v112, v113
  v_mfma_f32_16x16x32_bf16 a[40:43], a[176:179], v[16:19], a[40:43]
  v_exp_f32 v114, v114
  v_mfma_f32_16x16x32_bf16 a[40:43], a[180:183], v[48:51], a[40:43]
  ds_read_b64_tr_b16 a[172:173], v221 offset:40960
  v_mfma_f32_16x16x32_bf16 a[44:47], a[180:183], v[56:59], a[44:47]
  s_waitcnt lgkmcnt(7)
  v_exp_f32 v115, v115
  v_mfma_f32_16x16x32_bf16 a[44:47], a[176:179], v[24:27], a[44:47]
  ds_read_b64_tr_b16 a[174:175], v221 offset:45056
  v_cvt_pk_bf16_f32 v113, v114, v115
  v_mfma_f32_16x16x32_bf16 a[48:51], a[184:187], v[0:3], a[48:51]
  v_exp_f32 v120, v120
  v_mfma_f32_16x16x32_bf16 a[48:51], a[188:191], v[32:35], a[48:51]
  ds_read_b64_tr_b16 a[176:177], v222 offset:32768
  v_mfma_f32_16x16x32_bf16 a[52:55], a[188:191], v[40:43], a[52:55]
  v_exp_f32 v121, v121
  v_mfma_f32_16x16x32_bf16 a[52:55], a[184:187], v[8:11], a[52:55]
  ds_read_b64_tr_b16 a[178:179], v222 offset:36864
  v_cvt_pk_bf16_f32 v120, v120, v121
  v_mfma_f32_16x16x32_bf16 a[56:59], a[184:187], v[16:19], a[56:59]
  v_exp_f32 v122, v122
  v_mfma_f32_16x16x32_bf16 a[56:59], a[188:191], v[48:51], a[56:59]
  ds_read_b64_tr_b16 a[180:181], v222 offset:40960
  v_mfma_f32_16x16x32_bf16 a[60:63], a[188:191], v[56:59], a[60:63]
  s_waitcnt lgkmcnt(7)
  v_exp_f32 v123, v123
  v_mfma_f32_16x16x32_bf16 a[60:63], a[184:187], v[24:27], a[60:63]
  ds_read_b64_tr_b16 a[182:183], v222 offset:45056
  v_cvt_pk_bf16_f32 v121, v122, v123
  v_mfma_f32_16x16x32_bf16 a[64:67], a[160:163], v[0:3], a[64:67]
  v_exp_f32 v100, v100
  v_mfma_f32_16x16x32_bf16 a[64:67], a[164:167], v[32:35], a[64:67]
  ds_read_b64_tr_b16 a[184:185], v223 offset:32768
  v_mfma_f32_16x16x32_bf16 a[68:71], a[164:167], v[40:43], a[68:71]
  v_exp_f32 v101, v101
  v_mfma_f32_16x16x32_bf16 a[68:71], a[160:163], v[8:11], a[68:71]
  ds_read_b64_tr_b16 a[186:187], v223 offset:36864
  v_cvt_pk_bf16_f32 v98, v100, v101
  v_mfma_f32_16x16x32_bf16 a[72:75], a[160:163], v[16:19], a[72:75]
  v_exp_f32 v102, v102
  v_mfma_f32_16x16x32_bf16 a[72:75], a[164:167], v[48:51], a[72:75]
  ds_read_b64_tr_b16 a[188:189], v223 offset:40960
  v_mfma_f32_16x16x32_bf16 a[76:79], a[164:167], v[56:59], a[76:79]
  s_waitcnt lgkmcnt(7)
  v_exp_f32 v103, v103
  v_mfma_f32_16x16x32_bf16 a[76:79], a[160:163], v[24:27], a[76:79]
  ds_read_b64_tr_b16 a[190:191], v223 offset:45056
  v_cvt_pk_bf16_f32 v99, v102, v103
  v_mfma_f32_16x16x32_bf16 a[80:83], a[168:171], v[0:3], a[80:83]
  s_waitcnt vmcnt(19)
  v_exp_f32 v108, v108
  v_mfma_f32_16x16x32_bf16 a[80:83], a[172:175], v[32:35], a[80:83]
  v_mfma_f32_16x16x32_bf16 a[84:87], a[172:175], v[40:43], a[84:87]
  s_barrier
  v_exp_f32 v109, v109
  v_mfma_f32_16x16x32_bf16 a[84:87], a[168:171], v[8:11], a[84:87]
  s_mul_i32 s39, s99, 13108
  s_lshr_b32 s39, s39, 16
  s_lshl_b32 s39, s39, 8
  v_cvt_pk_bf16_f32 v106, v108, v109
  v_mfma_f32_16x16x32_bf16 a[88:91], a[168:171], v[16:19], a[88:91]
  s_add_u32 s39, s39, 2818304
  s_cmp_lt_u32 s2, 240
  s_cselect_b32 s48, 0, 1073741824
  v_exp_f32 v110, v110
  v_mfma_f32_16x16x32_bf16 a[88:91], a[172:175], v[48:51], a[88:91]
  v_or_b32 v249, s48, v251
  v_mfma_f32_16x16x32_bf16 a[92:95], a[172:175], v[56:59], a[92:95]
  s_waitcnt lgkmcnt(4)
  v_exp_f32 v111, v111
  v_mfma_f32_16x16x32_bf16 a[92:95], a[168:171], v[24:27], a[92:95]
  buffer_atomic_add v250, v249, s[24:27], s39 offen
  v_cvt_pk_bf16_f32 v107, v110, v111
  v_mfma_f32_16x16x32_bf16 a[96:99], a[176:179], v[0:3], a[96:99]
  v_exp_f32 v116, v116
  v_mfma_f32_16x16x32_bf16 a[96:99], a[180:183], v[32:35], a[96:99]
  v_mfma_f32_16x16x32_bf16 a[100:103], a[180:183], v[40:43], a[100:103]
  v_exp_f32 v117, v117
  v_mfma_f32_16x16x32_bf16 a[100:103], a[176:179], v[8:11], a[100:103]
  v_cvt_pk_bf16_f32 v114, v116, v117
  v_mfma_f32_16x16x32_bf16 a[104:107], a[176:179], v[16:19], a[104:107]
  v_exp_f32 v118, v118
  v_mfma_f32_16x16x32_bf16 a[104:107], a[180:183], v[48:51], a[104:107]
  v_mfma_f32_16x16x32_bf16 a[108:111], a[180:183], v[56:59], a[108:111]
  s_waitcnt lgkmcnt(0)
  v_exp_f32 v119, v119
  v_mfma_f32_16x16x32_bf16 a[108:111], a[176:179], v[24:27], a[108:111]
  v_cvt_pk_bf16_f32 v115, v118, v119
  v_mfma_f32_16x16x32_bf16 a[112:115], a[184:187], v[0:3], a[112:115]
  v_exp_f32 v124, v124
  v_mfma_f32_16x16x32_bf16 a[112:115], a[188:191], v[32:35], a[112:115]
  v_mfma_f32_16x16x32_bf16 a[116:119], a[188:191], v[40:43], a[116:119]
  v_exp_f32 v125, v125
  v_mfma_f32_16x16x32_bf16 a[116:119], a[184:187], v[8:11], a[116:119]
  v_cvt_pk_bf16_f32 v122, v124, v125
  v_mfma_f32_16x16x32_bf16 a[120:123], a[184:187], v[16:19], a[120:123]
  v_exp_f32 v126, v126
  v_mfma_f32_16x16x32_bf16 a[120:123], a[188:191], v[48:51], a[120:123]
  v_mfma_f32_16x16x32_bf16 a[124:127], a[188:191], v[56:59], a[124:127]
  v_exp_f32 v127, v127
  v_mfma_f32_16x16x32_bf16 a[124:127], a[184:187], v[24:27], a[124:127]
  v_cvt_pk_bf16_f32 v123, v126, v127
  ds_read_b64_tr_b16 a[160:161], v216 offset:49152
  ds_read_b64_tr_b16 a[162:163], v216 offset:53248
  ds_read_b64_tr_b16 a[164:165], v216 offset:57344
  ds_read_b64_tr_b16 a[166:167], v216 offset:61440
  ds_read_b64_tr_b16 a[168:169], v217 offset:49152
  ds_read_b64_tr_b16 a[170:171], v217 offset:53248
  ds_read_b64_tr_b16 a[172:173], v217 offset:57344
  ds_read_b64_tr_b16 a[174:175], v217 offset:61440
  s_mov_b32 s48, 0x53800000
  s_lshl_b32 s39, s3, 8
  v_mfma_f32_16x16x32_bf16 a[192:195], a[208:211], v[64:67], a[192:195]
  s_add_u32 m0, s28, 81920
  v_mfma_f32_16x16x32_bf16 a[192:195], a[208:211], v[96:99], a[192:195]
  v_mfma_f32_16x16x32_bf16 a[196:199], a[208:211], v[72:75], a[196:199]
  buffer_load_dwordx4 v242, s[24:27], s10 offen offset:0 sc1 lds
  v_mfma_f32_16x16x32_bf16 a[196:199], a[208:211], v[104:107], a[196:199]
  v_mfma_f32_16x16x32_bf16 a[200:203], a[208:211], v[80:83], a[200:203]
  buffer_load_dwordx4 v242, s[24:27], s10 offen offset:1024 sc1 lds
  v_mfma_f32_16x16x32_bf16 a[200:203], a[208:211], v[112:115], a[200:203]
  v_mfma_f32_16x16x32_bf16 a[204:207], a[208:211], v[88:91], a[204:207]
  buffer_load_dwordx4 v242, s[24:27], s10 offen offset:2048 sc1 lds
  v_mfma_f32_16x16x32_bf16 a[204:207], a[208:211], v[120:123], a[204:207]
  s_waitcnt lgkmcnt(4)
  v_mfma_f32_16x16x32_bf16 a[0:3], a[160:163], v[64:67], a[0:3]
  buffer_load_dwordx4 v242, s[24:27], s10 offen offset:3072 sc1 lds
  v_mfma_f32_16x16x32_bf16 a[0:3], a[164:167], v[96:99], a[0:3]
  ds_read_b64_tr_b16 a[176:177], v218 offset:49152
  v_mfma_f32_16x16x32_bf16 a[4:7], a[164:167], v[104:107], a[4:7]
  buffer_load_dwordx4 a[128:131], v253, s[24:27], s4 offen offset:3072 sc1
  v_mfma_f32_16x16x32_bf16 a[4:7], a[160:163], v[72:75], a[4:7]
  ds_read_b64_tr_b16 a[178:179], v218 offset:53248
  v_accvgpr_read_b32 v208, a192
  v_mfma_f32_16x16x32_bf16 a[8:11], a[160:163], v[80:83], a[8:11]
  v_accvgpr_read_b32 v209, a196
  v_accvgpr_read_b32 v210, a200
  v_mfma_f32_16x16x32_bf16 a[8:11], a[164:167], v[112:115], a[8:11]
  ds_read_b64_tr_b16 a[180:181], v218 offset:57344
  v_accvgpr_read_b32 v211, a204
  v_mfma_f32_16x16x32_bf16 a[12:15], a[164:167], v[120:123], a[12:15]
  v_mov_b32 v245, v208
  v_mov_b32 v246, v209
  v_mfma_f32_16x16x32_bf16 a[12:15], a[160:163], v[88:91], a[12:15]
  ds_read_b64_tr_b16 a[182:183], v218 offset:61440
  s_waitcnt lgkmcnt(4)
  v_mov_b32 v247, v210
  v_mfma_f32_16x16x32_bf16 a[16:19], a[168:171], v[64:67], a[16:19]
  v_mov_b32 v248, v211
  v_permlane16_swap_b32 v208, v245
  v_mfma_f32_16x16x32_bf16 a[16:19], a[172:175], v[96:99], a[16:19]
  ds_read_b64_tr_b16 a[184:185], v219 offset:49152
  v_permlane16_swap_b32 v209, v246
  v_mfma_f32_16x16x32_bf16 a[20:23], a[172:175], v[104:107], a[20:23]
  v_permlane16_swap_b32 v210, v247
  v_permlane16_swap_b32 v211, v248
  v_mfma_f32_16x16x32_bf16 a[20:23], a[168:171], v[72:75], a[20:23]
  ds_read_b64_tr_b16 a[186:187], v219 offset:53248
  v_add_f32 v208, v208, v245
  v_mfma_f32_16x16x32_bf16 a[24:27], a[168:171], v[80:83], a[24:27]
  v_add_f32 v209, v209, v246
  v_add_f32 v210, v210, v247
  v_mfma_f32_16x16x32_bf16 a[24:27], a[172:175], v[112:115], a[24:27]
  ds_read_b64_tr_b16 a[188:189], v219 offset:57344
  v_add_f32 v211, v211, v248
  v_mfma_f32_16x16x32_bf16 a[28:31], a[172:175], v[120:123], a[28:31]
  v_mov_b32 v245, v208
  v_mov_b32 v246, v209
  v_mfma_f32_16x16x32_bf16 a[28:31], a[168:171], v[88:91], a[28:31]
  ds_read_b64_tr_b16 a[190:191], v219 offset:61440
  s_waitcnt lgkmcnt(4)
  v_mov_b32 v247, v210
  v_mfma_f32_16x16x32_bf16 a[32:35], a[176:179], v[64:67], a[32:35]
  v_mov_b32 v248, v211
  v_permlane32_swap_b32 v208, v245
  v_mfma_f32_16x16x32_bf16 a[32:35], a[180:183], v[96:99], a[32:35]
  ds_read_b64_tr_b16 a[160:161], v220 offset:49152
  v_permlane32_swap_b32 v209, v246
  v_mfma_f32_16x16x32_bf16 a[36:39], a[180:183], v[104:107], a[36:39]
  v_permlane32_swap_b32 v210, v247
  v_permlane32_swap_b32 v211, v248
  v_mfma_f32_16x16x32_bf16 a[36:39], a[176:179], v[72:75], a[36:39]
  ds_read_b64_tr_b16 a[162:163], v220 offset:53248
  v_add_f32 v208, v208, v245
  v_mfma_f32_16x16x32_bf16 a[40:43], a[176:179], v[80:83], a[40:43]
  v_add_f32 v209, v209, v246
  v_add_f32 v210, v210, v247
  v_mfma_f32_16x16x32_bf16 a[40:43], a[180:183], v[112:115], a[40:43]
  ds_read_b64_tr_b16 a[164:165], v220 offset:57344
  v_add_f32 v211, v211, v248
  buffer_load_dwordx4 a[132:135], v242, s[24:27], s5 offen offset:0 sc1
  buffer_load_dwordx4 a[136:139], v242, s[24:27], s5 offen offset:1024 sc1
  buffer_load_dwordx4 a[140:143], v242, s[24:27], s5 offen offset:2048 sc1
  buffer_load_dwordx4 a[144:147], v242, s[24:27], s5 offen offset:3072 sc1
  buffer_load_dwordx4 a[148:151], v252, s[24:27], s5 offen offset:0 sc1
  buffer_load_dwordx4 a[152:155], v252, s[24:27], s5 offen offset:1024 sc1
  buffer_load_dwordx4 a[156:159], v252, s[24:27], s5 offen offset:2048 sc1
  v_mfma_f32_16x16x32_bf16 a[44:47], a[180:183], v[120:123], a[44:47]
  v_rcp_f32 v192, v208
  v_mfma_f32_16x16x32_bf16 a[44:47], a[176:179], v[88:91], a[44:47]
  ds_read_b64_tr_b16 a[166:167], v220 offset:61440
  s_waitcnt lgkmcnt(4)
  v_mfma_f32_16x16x32_bf16 a[48:51], a[184:187], v[64:67], a[48:51]
  v_rcp_f32 v196, v209
  v_mfma_f32_16x16x32_bf16 a[48:51], a[188:191], v[96:99], a[48:51]
  ds_read_b64_tr_b16 a[168:169], v221 offset:49152
  v_mfma_f32_16x16x32_bf16 a[52:55], a[188:191], v[104:107], a[52:55]
  v_rcp_f32 v200, v210
  v_mfma_f32_16x16x32_bf16 a[52:55], a[184:187], v[72:75], a[52:55]
  ds_read_b64_tr_b16 a[170:171], v221 offset:53248
  v_mfma_f32_16x16x32_bf16 a[56:59], a[184:187], v[80:83], a[56:59]
  v_rcp_f32 v204, v211
  v_mfma_f32_16x16x32_bf16 a[56:59], a[188:191], v[112:115], a[56:59]
  ds_read_b64_tr_b16 a[172:173], v221 offset:57344
  v_add_f32 v246, v208, v209
  v_mfma_f32_16x16x32_bf16 a[60:63], a[188:191], v[120:123], a[60:63]
  v_add_f32 v247, v210, v211
  v_add_f32 v246, v246, v247
  v_mfma_f32_16x16x32_bf16 a[60:63], a[184:187], v[88:91], a[60:63]
  ds_read_b64_tr_b16 a[174:175], v221 offset:61440
  s_waitcnt lgkmcnt(4)
  v_lshrrev_b32 v247, 2, v242
  v_mfma_f32_16x16x32_bf16 a[64:67], a[160:163], v[64:67], a[64:67]
  v_cmp_nlt_f32 vcc, v246, s48
  v_add_u32 v247, s39, v247
  v_mfma_f32_16x16x32_bf16 a[64:67], a[164:167], v[96:99], a[64:67]
  ds_read_b64_tr_b16 a[176:177], v222 offset:49152
  v_add_u32 v247, 157696, v247
  v_mfma_f32_16x16x32_bf16 a[68:71], a[164:167], v[104:107], a[68:71]
  v_cndmask_b32_e64 v245, 0, 1, vcc
  v_accvgpr_read_b32 v0, a0
  v_mfma_f32_16x16x32_bf16 a[68:71], a[160:163], v[72:75], a[68:71]
  ds_read_b64_tr_b16 a[178:179], v222 offset:53248
  v_accvgpr_read_b32 v1, a1
  v_mfma_f32_16x16x32_bf16 a[72:75], a[160:163], v[80:83], a[72:75]
  v_accvgpr_read_b32 v2, a2
  v_accvgpr_read_b32 v3, a3
  v_mfma_f32_16x16x32_bf16 a[72:75], a[164:167], v[112:115], a[72:75]
  ds_read_b64_tr_b16 a[180:181], v222 offset:57344
  v_accvgpr_read_b32 v4, a16
  v_mfma_f32_16x16x32_bf16 a[76:79], a[164:167], v[120:123], a[76:79]
  v_accvgpr_read_b32 v5, a17
  v_accvgpr_read_b32 v6, a18
  v_mfma_f32_16x16x32_bf16 a[76:79], a[160:163], v[88:91], a[76:79]
  ds_read_b64_tr_b16 a[182:183], v222 offset:61440
  s_waitcnt lgkmcnt(4)
  v_accvgpr_read_b32 v7, a19
  v_mfma_f32_16x16x32_bf16 a[80:83], a[168:171], v[64:67], a[80:83]
  v_mul_f32 v0, v0, v192
  v_mul_f32 v1, v1, v192
  v_mfma_f32_16x16x32_bf16 a[80:83], a[172:175], v[96:99], a[80:83]
  ds_read_b64_tr_b16 a[184:185], v223 offset:49152
  v_mul_f32 v2, v2, v192
  v_mfma_f32_16x16x32_bf16 a[84:87], a[172:175], v[104:107], a[84:87]
  v_mul_f32 v3, v3, v192
  v_mul_f32 v4, v4, v192
  v_mfma_f32_16x16x32_bf16 a[84:87], a[168:171], v[72:75], a[84:87]
  ds_read_b64_tr_b16 a[186:187], v223 offset:53248
  v_mul_f32 v5, v5, v192
  v_mfma_f32_16x16x32_bf16 a[88:91], a[168:171], v[80:83], a[88:91]
  v_mul_f32 v6, v6, v192
  v_mul_f32 v7, v7, v192
  v_mfma_f32_16x16x32_bf16 a[88:91], a[172:175], v[112:115], a[88:91]
  ds_read_b64_tr_b16 a[188:189], v223 offset:57344
  v_cvt_pk_bf16_f32 v0, v0, v1
  v_mfma_f32_16x16x32_bf16 a[92:95], a[172:175], v[120:123], a[92:95]
  v_cvt_pk_bf16_f32 v1, v2, v3
  v_cvt_pk_bf16_f32 v2, v4, v5
  v_mfma_f32_16x16x32_bf16 a[92:95], a[168:171], v[88:91], a[92:95]
  ds_read_b64_tr_b16 a[190:191], v223 offset:61440
  s_waitcnt lgkmcnt(4)
  v_cvt_pk_bf16_f32 v3, v6, v7
  v_mfma_f32_16x16x32_bf16 a[96:99], a[176:179], v[64:67], a[96:99]
  buffer_store_dwordx4 v[0:3], v244, s[24:27], s40 offen offset:0 sc1
  v_mfma_f32_16x16x32_bf16 a[96:99], a[180:183], v[96:99], a[96:99]
  v_accvgpr_read_b32 v8, a4
  v_accvgpr_read_b32 v9, a5
  v_mfma_f32_16x16x32_bf16 a[100:103], a[180:183], v[104:107], a[100:103]
  v_accvgpr_read_b32 v10, a6
  v_accvgpr_read_b32 v11, a7
  v_mfma_f32_16x16x32_bf16 a[100:103], a[176:179], v[72:75], a[100:103]
  v_accvgpr_read_b32 v12, a20
  v_accvgpr_read_b32 v13, a21
  v_mfma_f32_16x16x32_bf16 a[104:107], a[176:179], v[80:83], a[104:107]
  v_accvgpr_read_b32 v14, a22
  v_accvgpr_read_b32 v15, a23
  v_mfma_f32_16x16x32_bf16 a[104:107], a[180:183], v[112:115], a[104:107]
  v_mul_f32 v8, v8, v196
  v_mul_f32 v9, v9, v196
  v_mfma_f32_16x16x32_bf16 a[108:111], a[180:183], v[120:123], a[108:111]
  v_mul_f32 v10, v10, v196
  v_mul_f32 v11, v11, v196
  v_mfma_f32_16x16x32_bf16 a[108:111], a[176:179], v[88:91], a[108:111]
  s_waitcnt lgkmcnt(0)
  v_mul_f32 v12, v12, v196
  v_mul_f32 v13, v13, v196
  v_mfma_f32_16x16x32_bf16 a[112:115], a[184:187], v[64:67], a[112:115]
  v_mul_f32 v14, v14, v196
  v_mul_f32 v15, v15, v196
  v_mfma_f32_16x16x32_bf16 a[112:115], a[188:191], v[96:99], a[112:115]
  v_cvt_pk_bf16_f32 v8, v8, v9
  v_cvt_pk_bf16_f32 v9, v10, v11
  v_mfma_f32_16x16x32_bf16 a[116:119], a[188:191], v[104:107], a[116:119]
  v_cvt_pk_bf16_f32 v10, v12, v13
  v_cvt_pk_bf16_f32 v11, v14, v15
  v_mfma_f32_16x16x32_bf16 a[116:119], a[184:187], v[72:75], a[116:119]
  buffer_store_dwordx4 v[8:11], v244, s[24:27], s40 offen offset:2048 sc1
  v_mfma_f32_16x16x32_bf16 a[120:123], a[184:187], v[80:83], a[120:123]
  v_accvgpr_read_b32 v16, a8
  v_accvgpr_read_b32 v17, a9
  v_mfma_f32_16x16x32_bf16 a[120:123], a[188:191], v[112:115], a[120:123]
  v_accvgpr_read_b32 v18, a10
  v_accvgpr_read_b32 v19, a11
  v_mfma_f32_16x16x32_bf16 a[124:127], a[188:191], v[120:123], a[124:127]
  v_accvgpr_read_b32 v20, a24
  v_accvgpr_read_b32 v21, a25
  v_mfma_f32_16x16x32_bf16 a[124:127], a[184:187], v[88:91], a[124:127]
  v_accvgpr_read_b32 v22, a26
  v_accvgpr_read_b32 v23, a27
  v_pk_mul_f32 v[16:17], v[16:17], v[200:201] op_sel_hi:[1,0]
  v_pk_mul_f32 v[18:19], v[18:19], v[200:201] op_sel_hi:[1,0]
  v_pk_mul_f32 v[20:21], v[20:21], v[200:201] op_sel_hi:[1,0]
  v_pk_mul_f32 v[22:23], v[22:23], v[200:201] op_sel_hi:[1,0]
  v_cvt_pk_bf16_f32 v16, v16, v17
  v_cvt_pk_bf16_f32 v17, v18, v19
  v_cvt_pk_bf16_f32 v18, v20, v21
  v_cvt_pk_bf16_f32 v19, v22, v23
  buffer_store_dwordx4 v[16:19], v244, s[24:27], s41 offen offset:0 sc1
  v_accvgpr_read_b32 v24, a12
  v_accvgpr_read_b32 v25, a13
  v_accvgpr_read_b32 v26, a14
  v_accvgpr_read_b32 v27, a15
  v_accvgpr_read_b32 v28, a28
  v_accvgpr_read_b32 v29, a29
  v_accvgpr_read_b32 v30, a30
  v_accvgpr_read_b32 v31, a31
  v_pk_mul_f32 v[24:25], v[24:25], v[204:205] op_sel_hi:[1,0]
  v_pk_mul_f32 v[26:27], v[26:27], v[204:205] op_sel_hi:[1,0]
  v_pk_mul_f32 v[28:29], v[28:29], v[204:205] op_sel_hi:[1,0]
  v_pk_mul_f32 v[30:31], v[30:31], v[204:205] op_sel_hi:[1,0]
  v_cvt_pk_bf16_f32 v24, v24, v25
  v_cvt_pk_bf16_f32 v25, v26, v27
  v_cvt_pk_bf16_f32 v26, v28, v29
  v_cvt_pk_bf16_f32 v27, v30, v31
  buffer_store_dwordx4 v[24:27], v244, s[24:27], s41 offen offset:2048 sc1
  v_accvgpr_read_b32 v32, a32
  v_accvgpr_read_b32 v33, a33
  v_accvgpr_read_b32 v34, a34
  v_accvgpr_read_b32 v35, a35
  v_accvgpr_read_b32 v36, a48
  v_accvgpr_read_b32 v37, a49
  v_accvgpr_read_b32 v38, a50
  v_accvgpr_read_b32 v39, a51
  v_pk_mul_f32 v[32:33], v[32:33], v[192:193] op_sel_hi:[1,0]
  v_pk_mul_f32 v[34:35], v[34:35], v[192:193] op_sel_hi:[1,0]
  v_pk_mul_f32 v[36:37], v[36:37], v[192:193] op_sel_hi:[1,0]
  v_pk_mul_f32 v[38:39], v[38:39], v[192:193] op_sel_hi:[1,0]
  v_cvt_pk_bf16_f32 v32, v32, v33
  v_cvt_pk_bf16_f32 v33, v34, v35
  v_cvt_pk_bf16_f32 v34, v36, v37
  v_cvt_pk_bf16_f32 v35, v38, v39
  buffer_store_dwordx4 v[32:35], v244, s[24:27], s40 offen offset:1024 sc1
  v_accvgpr_read_b32 v40, a36
  v_accvgpr_read_b32 v41, a37
  v_accvgpr_read_b32 v42, a38
  v_accvgpr_read_b32 v43, a39
  v_accvgpr_read_b32 v44, a52
  v_accvgpr_read_b32 v45, a53
  v_accvgpr_read_b32 v46, a54
  v_accvgpr_read_b32 v47, a55
  v_pk_mul_f32 v[40:41], v[40:41], v[196:197] op_sel_hi:[1,0]
  v_pk_mul_f32 v[42:43], v[42:43], v[196:197] op_sel_hi:[1,0]
  v_pk_mul_f32 v[44:45], v[44:45], v[196:197] op_sel_hi:[1,0]
  v_pk_mul_f32 v[46:47], v[46:47], v[196:197] op_sel_hi:[1,0]
  v_cvt_pk_bf16_f32 v40, v40, v41
  v_cvt_pk_bf16_f32 v41, v42, v43
  v_cvt_pk_bf16_f32 v42, v44, v45
  v_cvt_pk_bf16_f32 v43, v46, v47
  buffer_store_dwordx4 v[40:43], v244, s[24:27], s40 offen offset:3072 sc1
  v_accvgpr_read_b32 v48, a40
  v_accvgpr_read_b32 v49, a41
  v_accvgpr_read_b32 v50, a42
  v_accvgpr_read_b32 v51, a43
  v_accvgpr_read_b32 v52, a56
  v_accvgpr_read_b32 v53, a57
  v_accvgpr_read_b32 v54, a58
  v_accvgpr_read_b32 v55, a59
  v_pk_mul_f32 v[48:49], v[48:49], v[200:201] op_sel_hi:[1,0]
  v_pk_mul_f32 v[50:51], v[50:51], v[200:201] op_sel_hi:[1,0]
  v_pk_mul_f32 v[52:53], v[52:53], v[200:201] op_sel_hi:[1,0]
  v_pk_mul_f32 v[54:55], v[54:55], v[200:201] op_sel_hi:[1,0]
  v_cvt_pk_bf16_f32 v48, v48, v49
  v_cvt_pk_bf16_f32 v49, v50, v51
  v_cvt_pk_bf16_f32 v50, v52, v53
  v_cvt_pk_bf16_f32 v51, v54, v55
  buffer_store_dwordx4 v[48:51], v244, s[24:27], s41 offen offset:1024 sc1
  v_accvgpr_read_b32 v56, a44
  v_accvgpr_read_b32 v57, a45
  v_accvgpr_read_b32 v58, a46
  v_accvgpr_read_b32 v59, a47
  v_accvgpr_read_b32 v60, a60
  v_accvgpr_read_b32 v61, a61
  v_accvgpr_read_b32 v62, a62
  v_accvgpr_read_b32 v63, a63
  v_pk_mul_f32 v[56:57], v[56:57], v[204:205] op_sel_hi:[1,0]
  v_pk_mul_f32 v[58:59], v[58:59], v[204:205] op_sel_hi:[1,0]
  v_pk_mul_f32 v[60:61], v[60:61], v[204:205] op_sel_hi:[1,0]
  v_pk_mul_f32 v[62:63], v[62:63], v[204:205] op_sel_hi:[1,0]
  v_cvt_pk_bf16_f32 v56, v56, v57
  v_cvt_pk_bf16_f32 v57, v58, v59
  v_cvt_pk_bf16_f32 v58, v60, v61
  v_cvt_pk_bf16_f32 v59, v62, v63
  buffer_store_dwordx4 v[56:59], v244, s[24:27], s41 offen offset:3072 sc1
  v_accvgpr_read_b32 v0, a64
  v_accvgpr_read_b32 v1, a65
  v_accvgpr_read_b32 v2, a66
  v_accvgpr_read_b32 v3, a67
  v_accvgpr_read_b32 v4, a80
  v_accvgpr_read_b32 v5, a81
  v_accvgpr_read_b32 v6, a82
  v_accvgpr_read_b32 v7, a83
  v_pk_mul_f32 v[0:1], v[0:1], v[192:193] op_sel_hi:[1,0]
  v_pk_mul_f32 v[2:3], v[2:3], v[192:193] op_sel_hi:[1,0]
  v_pk_mul_f32 v[4:5], v[4:5], v[192:193] op_sel_hi:[1,0]
  v_pk_mul_f32 v[6:7], v[6:7], v[192:193] op_sel_hi:[1,0]
  v_cvt_pk_bf16_f32 v0, v0, v1
  v_cvt_pk_bf16_f32 v1, v2, v3
  v_cvt_pk_bf16_f32 v2, v4, v5
  v_cvt_pk_bf16_f32 v3, v6, v7
  buffer_store_dwordx4 v[0:3], v244, s[24:27], s42 offen offset:0 sc1
  v_accvgpr_read_b32 v8, a68
  v_accvgpr_read_b32 v9, a69
  v_accvgpr_read_b32 v10, a70
  v_accvgpr_read_b32 v11, a71
  v_accvgpr_read_b32 v12, a84
  v_accvgpr_read_b32 v13, a85
  v_accvgpr_read_b32 v14, a86
  v_accvgpr_read_b32 v15, a87
  v_pk_mul_f32 v[8:9], v[8:9], v[196:197] op_sel_hi:[1,0]
  v_pk_mul_f32 v[10:11], v[10:11], v[196:197] op_sel_hi:[1,0]
  v_pk_mul_f32 v[12:13], v[12:13], v[196:197] op_sel_hi:[1,0]
  v_pk_mul_f32 v[14:15], v[14:15], v[196:197] op_sel_hi:[1,0]
  v_cvt_pk_bf16_f32 v8, v8, v9
  v_cvt_pk_bf16_f32 v9, v10, v11
  v_cvt_pk_bf16_f32 v10, v12, v13
  v_cvt_pk_bf16_f32 v11, v14, v15
  buffer_store_dwordx4 v[8:11], v244, s[24:27], s42 offen offset:2048 sc1
  v_accvgpr_read_b32 v16, a72
  v_accvgpr_read_b32 v17, a73
  v_accvgpr_read_b32 v18, a74
  v_accvgpr_read_b32 v19, a75
  v_accvgpr_read_b32 v20, a88
  v_accvgpr_read_b32 v21, a89
  v_accvgpr_read_b32 v22, a90
  v_accvgpr_read_b32 v23, a91
  v_pk_mul_f32 v[16:17], v[16:17], v[200:201] op_sel_hi:[1,0]
  v_pk_mul_f32 v[18:19], v[18:19], v[200:201] op_sel_hi:[1,0]
  v_pk_mul_f32 v[20:21], v[20:21], v[200:201] op_sel_hi:[1,0]
  v_pk_mul_f32 v[22:23], v[22:23], v[200:201] op_sel_hi:[1,0]
  v_cvt_pk_bf16_f32 v16, v16, v17
  v_cvt_pk_bf16_f32 v17, v18, v19
  v_cvt_pk_bf16_f32 v18, v20, v21
  v_cvt_pk_bf16_f32 v19, v22, v23
  buffer_store_dwordx4 v[16:19], v244, s[24:27], s43 offen offset:0 sc1
  v_accvgpr_read_b32 v24, a76
  v_accvgpr_read_b32 v25, a77
  v_accvgpr_read_b32 v26, a78
  v_accvgpr_read_b32 v27, a79
  v_accvgpr_read_b32 v28, a92
  v_accvgpr_read_b32 v29, a93
  v_accvgpr_read_b32 v30, a94
  v_accvgpr_read_b32 v31, a95
  v_pk_mul_f32 v[24:25], v[24:25], v[204:205] op_sel_hi:[1,0]
  v_pk_mul_f32 v[26:27], v[26:27], v[204:205] op_sel_hi:[1,0]
  v_pk_mul_f32 v[28:29], v[28:29], v[204:205] op_sel_hi:[1,0]
  v_pk_mul_f32 v[30:31], v[30:31], v[204:205] op_sel_hi:[1,0]
  v_cvt_pk_bf16_f32 v24, v24, v25
  v_cvt_pk_bf16_f32 v25, v26, v27
  v_cvt_pk_bf16_f32 v26, v28, v29
  v_cvt_pk_bf16_f32 v27, v30, v31
  buffer_store_dwordx4 v[24:27], v244, s[24:27], s43 offen offset:2048 sc1
  v_accvgpr_read_b32 v32, a96
  v_accvgpr_read_b32 v33, a97
  v_accvgpr_read_b32 v34, a98
  v_accvgpr_read_b32 v35, a99
  v_accvgpr_read_b32 v36, a112
  v_accvgpr_read_b32 v37, a113
  v_accvgpr_read_b32 v38, a114
  v_accvgpr_read_b32 v39, a115
  v_pk_mul_f32 v[32:33], v[32:33], v[192:193] op_sel_hi:[1,0]
  v_pk_mul_f32 v[34:35], v[34:35], v[192:193] op_sel_hi:[1,0]
  v_pk_mul_f32 v[36:37], v[36:37], v[192:193] op_sel_hi:[1,0]
  v_pk_mul_f32 v[38:39], v[38:39], v[192:193] op_sel_hi:[1,0]
  v_cvt_pk_bf16_f32 v32, v32, v33
  v_cvt_pk_bf16_f32 v33, v34, v35
  v_cvt_pk_bf16_f32 v34, v36, v37
  v_cvt_pk_bf16_f32 v35, v38, v39
  buffer_store_dwordx4 v[32:35], v244, s[24:27], s42 offen offset:1024 sc1
  v_accvgpr_read_b32 v40, a100
  v_accvgpr_read_b32 v41, a101
  v_accvgpr_read_b32 v42, a102
  v_accvgpr_read_b32 v43, a103
  v_accvgpr_read_b32 v44, a116
  v_accvgpr_read_b32 v45, a117
  v_accvgpr_read_b32 v46, a118
  v_accvgpr_read_b32 v47, a119
  v_pk_mul_f32 v[40:41], v[40:41], v[196:197] op_sel_hi:[1,0]
  v_pk_mul_f32 v[42:43], v[42:43], v[196:197] op_sel_hi:[1,0]
  v_pk_mul_f32 v[44:45], v[44:45], v[196:197] op_sel_hi:[1,0]
  v_pk_mul_f32 v[46:47], v[46:47], v[196:197] op_sel_hi:[1,0]
  v_cvt_pk_bf16_f32 v40, v40, v41
  v_cvt_pk_bf16_f32 v41, v42, v43
  v_cvt_pk_bf16_f32 v42, v44, v45
  v_cvt_pk_bf16_f32 v43, v46, v47
  buffer_store_dwordx4 v[40:43], v244, s[24:27], s42 offen offset:3072 sc1
  v_accvgpr_read_b32 v48, a104
  v_accvgpr_read_b32 v49, a105
  v_accvgpr_read_b32 v50, a106
  v_accvgpr_read_b32 v51, a107
  v_accvgpr_read_b32 v52, a120
  v_accvgpr_read_b32 v53, a121
  v_accvgpr_read_b32 v54, a122
  v_accvgpr_read_b32 v55, a123
  v_pk_mul_f32 v[48:49], v[48:49], v[200:201] op_sel_hi:[1,0]
  v_pk_mul_f32 v[50:51], v[50:51], v[200:201] op_sel_hi:[1,0]
  v_pk_mul_f32 v[52:53], v[52:53], v[200:201] op_sel_hi:[1,0]
  v_pk_mul_f32 v[54:55], v[54:55], v[200:201] op_sel_hi:[1,0]
  v_cvt_pk_bf16_f32 v48, v48, v49
  v_cvt_pk_bf16_f32 v49, v50, v51
  v_cvt_pk_bf16_f32 v50, v52, v53
  v_cvt_pk_bf16_f32 v51, v54, v55
  buffer_store_dwordx4 v[48:51], v244, s[24:27], s43 offen offset:1024 sc1
  v_accvgpr_read_b32 v56, a108
  v_accvgpr_read_b32 v57, a109
  v_accvgpr_read_b32 v58, a110
  v_accvgpr_read_b32 v59, a111
  v_accvgpr_read_b32 v60, a124
  v_accvgpr_read_b32 v61, a125
  v_accvgpr_read_b32 v62, a126
  v_accvgpr_read_b32 v63, a127
  v_pk_mul_f32 v[56:57], v[56:57], v[204:205] op_sel_hi:[1,0]
  v_pk_mul_f32 v[58:59], v[58:59], v[204:205] op_sel_hi:[1,0]
  v_pk_mul_f32 v[60:61], v[60:61], v[204:205] op_sel_hi:[1,0]
  v_pk_mul_f32 v[62:63], v[62:63], v[204:205] op_sel_hi:[1,0]
  v_cvt_pk_bf16_f32 v56, v56, v57
  v_cvt_pk_bf16_f32 v57, v58, v59
  v_cvt_pk_bf16_f32 v58, v60, v61
  v_cvt_pk_bf16_f32 v59, v62, v63
  buffer_store_dwordx4 v[56:59], v244, s[24:27], s43 offen offset:3072 sc1
  ds_write_b32 v247, v245
  buffer_load_dwordx4 a[0:3], v252, s[24:27], s5 offen offset:3072 sc1
  buffer_load_dwordx4 a[4:7], v253, s[24:27], s5 offen offset:0 sc1
  buffer_load_dwordx4 a[8:11], v253, s[24:27], s5 offen offset:1024 sc1
  buffer_load_dwordx4 a[12:15], v253, s[24:27], s5 offen offset:2048 sc1
  buffer_load_dwordx4 a[16:19], v253, s[24:27], s5 offen offset:3072 sc1
  buffer_load_dwordx4 a[20:23], v242, s[24:27], s6 offen offset:0 sc1
  buffer_load_dwordx4 a[24:27], v242, s[24:27], s6 offen offset:1024 sc1
  buffer_load_dwordx4 a[28:31], v242, s[24:27], s6 offen offset:2048 sc1
  buffer_load_dwordx4 a[32:35], v242, s[24:27], s6 offen offset:3072 sc1
  buffer_load_dwordx4 a[36:39], v252, s[24:27], s6 offen offset:0 sc1
  s_and_b32 s39, s2, 63
  s_lshl_b32 s39, s39, 7
  s_add_u32 s39, s39, 2867200
  s_lshl_b32 s38, s3, 26
  v_lshlrev_b32 v64, 22, v242
  v_or_b32 v64, s38, v64
  v_mov_b32 v65, 1
  v_add_u32 v246, 157696, v242
  s_waitcnt vmcnt(10) lgkmcnt(0)
  s_barrier
  ds_read_b128 v[68:71], v246
  s_waitcnt lgkmcnt(0)
  v_or3_b32 v68, v68, v69, v70
  v_or_b32 v68, v68, v71
  v_cmp_ne_u32 vcc, 0, v68
  s_nop 0
  s_cbranch_vccnz attn_redo
tail_go:
  buffer_atomic_add v65, v64, s[24:27], s39 offen
  s_and_b32 s36, s2, 1
  s_bfe_u32 s31, s2, 0x20001
  s_lshl_b32 s31, s31, 2
  s_bfe_u32 s38, s2, 0x20003
  s_add_u32 s31, s31, s38
  s_lshr_b32 s29, s2, 5
  v_mov_b32 v114, v242
  v_add_u32 v115, 0x1000, v114
  v_add_u32 v116, 0x2000, v114
  s_lshl_b32 s38, s36, 2
  s_add_u32 s38, s38, s3
  s_lshl_b32 s30, s38, 16
  buffer_load_dwordx4 a[40:43], v115, s[24:27], s6 offen offset:1024 sc1
  buffer_load_dwordx4 a[44:47], v115, s[24:27], s6 offen offset:2048 sc1
  buffer_load_dwordx4 a[48:51], v115, s[24:27], s6 offen offset:3072 sc1
  buffer_load_dwordx4 a[52:55], v116, s[24:27], s6 offen offset:0 sc1
  v_lshrrev_b32 v125, 4, v114
  v_and_b32 v126, 15, v125
  v_lshrrev_b32 v127, 4, v125
  s_add_u32 s38, s3, 0
  s_and_b32 s38, s38, 3
  s_lshl_b32 s38, s38, 11
  v_add_u32 v110, s38, v114
  s_sub_u32 s38, s3, 0
  s_and_b32 s38, s38, 3
  s_mul_i32 s38, s38, 15360
  s_add_u32 s38, s38, 98304
  v_add_u32 v118, s38, v114
  s_add_u32 s38, s3, 1
  s_and_b32 s38, s38, 3
  s_lshl_b32 s38, s38, 11
  v_add_u32 v111, s38, v114
  s_sub_u32 s38, s3, 1
  s_and_b32 s38, s38, 3
  s_mul_i32 s38, s38, 15360
  s_add_u32 s38, s38, 98304
  v_add_u32 v119, s38, v114
  s_add_u32 s38, s3, 2
  s_and_b32 s38, s38, 3
  s_lshl_b32 s38, s38, 11
  v_add_u32 v112, s38, v114
  s_sub_u32 s38, s3, 2
  s_and_b32 s38, s38, 3
  s_mul_i32 s38, s38, 15360
  s_add_u32 s38, s38, 98304
  v_add_u32 v120, s38, v114
  s_add_u32 s38, s3, 3
  s_and_b32 s38, s38, 3
  s_lshl_b32 s38, s38, 11
  v_add_u32 v113, s38, v114
  s_sub_u32 s38, s3, 3
  s_and_b32 s38, s38, 3
  s_mul_i32 s38, s38, 15360
  s_add_u32 s38, s38, 98304
  v_add_u32 v121, s38, v114
  v_add_u32 v122, s28, v114
  v_add_u32 v135, 0x10000, v122
  s_and_b32 s38, s31, 14
  s_add_u32 s38, s38, s36
  s_lshl_b32 s38, s38, 2
  s_add_u32 s38, s38, s3
  s_lshl_b32 s38, s38, 7
  s_add_u32 s38, s38, 2867200
  s_lshl_b32 s39, s29, 8
  s_add_u32 s39, s39, 2818304
  v_mov_b32 v133, s38
  v_writelane_b32 v133, s39, 1
  v_mov_b32 v134, 4
  v_writelane_b32 v134, 30, 1
  s_lshl_b32 s31, s31, 1
  s_add_u32 s31, s31, s36
  s_add_u32 s30, s30, 8388608
  s_lshl_b32 s38, s31, 19
  s_add_u32 s37, s30, s38
  s_xor_b32 s38, s38, 0x80000
  s_add_u32 s30, s30, s38
  s_lshl_b32 s40, s29, 5
  s_add_u32 s40, s40, s31
  s_lshl_b32 s38, s31, 6
  s_lshl_b32 s39, s3, 4
  s_add_u32 s38, s38, s39
  v_add_u32 v128, s38, v126
  v_mul_u32_u24 v117, 0x500, v128
  v_lshl_add_u32 v117, v127, 3, v117
  s_mul_i32 s38, s29, 160
  v_add_u32 v117, s38, v117
  s_mov_b32 s12, s60
  s_mov_b32 s13, s61
  s_mov_b32 s14, 2621440
  s_mov_b32 s15, 0x20000
  s_mov_b32 s16, s62
  s_mov_b32 s17, s63
  s_mov_b32 s18, 2621440
  s_mov_b32 s19, 0x20000
  s_mul_i32 s38, s31, 81920
  s_lshl_b32 s39, s3, 10
  s_add_u32 s38, s38, s39
  s_mul_i32 s39, s29, 10
  v_lshrrev_b32 v129, 1, v127
  v_add_u32 v129, s39, v129
  v_and_b32 v130, 1, v127
  v_lshlrev_b32 v130, 3, v130
  v_lshl_add_u32 v130, v126, 4, v130
  v_lshrrev_b32 v131, 2, v129
  v_lshl_add_u32 v131, v131, 12, v130
  v_and_b32 v132, 3, v129
  v_lshl_add_u32 v131, v132, 8, v131
  buffer_load_dwordx2 v[156:157], v131, s[24:27], s38 offen sc1
  v_add_u32 v129, 2, v129
  buffer_load_dwordx2 v[80:81], v117, s[12:15], 0 offen offset:0
  v_lshrrev_b32 v131, 2, v129
  v_lshl_add_u32 v131, v131, 12, v130
  v_and_b32 v132, 3, v129
  v_lshl_add_u32 v131, v132, 8, v131
  buffer_load_dwordx2 v[158:159], v131, s[24:27], s38 offen sc1
  v_add_u32 v129, 2, v129
  buffer_load_dwordx2 v[82:83], v117, s[12:15], 0 offen offset:32
  v_lshrrev_b32 v131, 2, v129
  v_lshl_add_u32 v131, v131, 12, v130
  v_and_b32 v132, 3, v129
  v_lshl_add_u32 v131, v132, 8, v131
  buffer_load_dwordx2 v[160:161], v131, s[24:27], s38 offen sc1
  v_add_u32 v129, 2, v129
  buffer_load_dwordx2 v[84:85], v117, s[12:15], 0 offen offset:64
  v_lshrrev_b32 v131, 2, v129
  v_lshl_add_u32 v131, v131, 12, v130
  v_and_b32 v132, 3, v129
  v_lshl_add_u32 v131, v132, 8, v131
  buffer_load_dwordx2 v[162:163], v131, s[24:27], s38 offen sc1
  v_add_u32 v129, 2, v129
  buffer_load_dwordx2 v[86:87], v117, s[12:15], 0 offen offset:96
  v_lshrrev_b32 v131, 2, v129
  v_lshl_add_u32 v131, v131, 12, v130
  v_and_b32 v132, 3, v129
  v_lshl_add_u32 v131, v132, 8, v131
  buffer_load_dwordx2 v[164:165], v131, s[24:27], s38 offen sc1
  v_add_u32 v129, 2, v129
  buffer_load_dwordx2 v[88:89], v117, s[12:15], 0 offen offset:128
  v_mov_b32 v123, 1073741824
  v_bfrev_b32 v124, 1
  v_sub_u32 v128, 0xffff, v128
  s_mov_b32 s34, 0xffff0000
  s_and_b32 s38, s52, 0xffff
  v_cmp_eq_u32 vcc, s38, v128
  v_mov_b32 v129, s52
  v_mov_b32 v130, 0
  v_cndmask_b32 v124, v124, v129, vcc
  v_cndmask_b32 v123, v123, v130, vcc
  s_and_b32 s38, s53, 0xffff
  v_cmp_eq_u32 vcc, s38, v128
  v_mov_b32 v129, s53
  v_mov_b32 v130, 2560
  v_cndmask_b32 v124, v124, v129, vcc
  v_cndmask_b32 v123, v123, v130, vcc
  s_and_b32 s38, s54, 0xffff
  v_cmp_eq_u32 vcc, s38, v128
  v_mov_b32 v129, s54
  v_mov_b32 v130, 5120
  v_cndmask_b32 v124, v124, v129, vcc
  v_cndmask_b32 v123, v123, v130, vcc
  s_and_b32 s38, s55, 0xffff
  v_cmp_eq_u32 vcc, s38, v128
  v_mov_b32 v129, s55
  v_mov_b32 v130, 7680
  v_cndmask_b32 v124, v124, v129, vcc
  v_cndmask_b32 v123, v123, v130, vcc
  s_and_b32 s38, s56, 0xffff
  v_cmp_eq_u32 vcc, s38, v128
  v_mov_b32 v129, s56
  v_mov_b32 v130, 10240
  v_cndmask_b32 v124, v124, v129, vcc
  v_cndmask_b32 v123, v123, v130, vcc
  s_and_b32 s38, s57, 0xffff
  v_cmp_eq_u32 vcc, s38, v128
  v_mov_b32 v129, s57
  v_mov_b32 v130, 12800
  v_cndmask_b32 v124, v124, v129, vcc
  v_cndmask_b32 v123, v123, v130, vcc
  s_and_b32 s38, s58, 0xffff
  v_cmp_eq_u32 vcc, s38, v128
  v_mov_b32 v129, s58
  v_mov_b32 v130, 15360
  v_cndmask_b32 v124, v124, v129, vcc
  v_cndmask_b32 v123, v123, v130, vcc
  s_and_b32 s38, s59, 0xffff
  v_cmp_eq_u32 vcc, s38, v128
  v_mov_b32 v129, s59
  v_mov_b32 v130, 17920
  v_cndmask_b32 v124, v124, v129, vcc
  v_cndmask_b32 v123, v123, v130, vcc
  v_lshl_add_u32 v123, v127, 4, v123
  s_mul_i32 s32, s29, 320
  s_add_u32 s32, s32, 2686976
  v_ashrrev_i32 v129, 31, v124
  v_not_b32 v129, v129
  v_or_b32 v129, 0x80000000, v129
  v_xor_b32 v124, v124, v129
  v_and_b32 v124, s34, v124
  v_mul_f32 v124, 0xbfb8aa3b, v124
  v_exp_f32 v124, v124
  s_nop 0
  v_add_f32 v124, 1.0, v124
  v_rcp_f32 v124, v124
  s_nop 0
  v_cvt_pk_bf16_f32 v124, v124, v124
  v_lshlrev_b32 v124, 16, v124
  buffer_load_dword v128, v133, s[24:27], 0 offen sc1
  buffer_load_dwordx4 a[56:59], v116, s[24:27], s6 offen offset:1024 sc1
  buffer_load_dwordx4 a[60:63], v116, s[24:27], s6 offen offset:2048 sc1
  buffer_load_dwordx4 a[64:67], v116, s[24:27], s6 offen offset:3072 sc1
  buffer_load_dwordx4 a[68:71], v114, s[24:27], s7 offen offset:0 sc1
  buffer_load_dwordx4 a[72:75], v114, s[24:27], s7 offen offset:1024 sc1
  buffer_load_dwordx4 a[76:79], v114, s[24:27], s7 offen offset:2048 sc1
  buffer_load_dwordx4 a[80:83], v114, s[24:27], s7 offen offset:3072 sc1
  buffer_load_dwordx4 a[84:87], v115, s[24:27], s7 offen offset:0 sc1
  buffer_load_dwordx4 a[88:91], v115, s[24:27], s7 offen offset:1024 sc1
  buffer_load_dwordx4 a[92:95], v115, s[24:27], s7 offen offset:2048 sc1
  s_waitcnt vmcnt(20)
  v_lshlrev_b32 v90, 16, v156
  v_and_b32 v91, s34, v156
  v_lshlrev_b32 v92, 16, v157
  v_and_b32 v93, s34, v157
  s_waitcnt vmcnt(18)
  v_lshlrev_b32 v94, 16, v158
  v_and_b32 v95, s34, v158
  v_lshlrev_b32 v96, 16, v159
  v_and_b32 v97, s34, v159
  s_waitcnt vmcnt(16)
  v_lshlrev_b32 v98, 16, v160
  v_and_b32 v99, s34, v160
  v_lshlrev_b32 v100, 16, v161
  v_and_b32 v101, s34, v161
  s_waitcnt vmcnt(14)
  v_lshlrev_b32 v102, 16, v162
  v_and_b32 v103, s34, v162
  v_lshlrev_b32 v104, 16, v163
  v_and_b32 v105, s34, v163
  s_waitcnt vmcnt(12)
  v_lshlrev_b32 v106, 16, v164
  v_and_b32 v107, s34, v164
  v_lshlrev_b32 v108, 16, v165
  v_and_b32 v109, s34, v165
  v_mov_b32 v156, 0
  v_mov_b32 v157, 0
  v_mov_b32 v158, 0
  v_mov_b32 v159, 0
  v_mov_b32 v160, 0
  v_mov_b32 v161, 0
  v_mov_b32 v162, 0
  v_mov_b32 v163, 0
  v_mov_b32 v164, 0
  v_mov_b32 v165, 0
  v_mov_b32 v166, 0
  v_mov_b32 v167, 0
  v_mov_b32 v168, 0
  v_mov_b32 v169, 0
  v_mov_b32 v170, 0
  v_mov_b32 v171, 0
  v_mov_b32 v172, 0
  v_mov_b32 v173, 0
  v_mov_b32 v174, 0
  v_mov_b32 v175, 0
  s_waitcnt vmcnt(10)
  v_cmp_lt_u32 vcc, v128, v134
  s_nop 0
  s_cbranch_vccz tail_ready
  s_waitcnt vmcnt(0)
  s_mov_b32 s35, 32768
  buffer_load_dword v128, v133, s[24:27], 0 offen sc1
  s_sleep 3
  buffer_load_dword v129, v133, s[24:27], 0 offen sc1
  s_sleep 3
tail_spin:
  buffer_load_dword v130, v133, s[24:27], 0 offen sc1
  s_waitcnt vmcnt(2)
  v_cmp_lt_u32 vcc, v128, v134
  s_nop 0
  s_cbranch_vccz tail_ready
  s_sleep 3
  buffer_load_dword v128, v133, s[24:27], 0 offen sc1
  s_waitcnt vmcnt(2)
  v_cmp_lt_u32 vcc, v129, v134
  s_nop 0
  s_cbranch_vccz tail_ready
  s_sleep 3
  buffer_load_dword v129, v133, s[24:27], 0 offen sc1
  s_waitcnt vmcnt(2)
  v_cmp_lt_u32 vcc, v130, v134
  s_nop 0
  s_cbranch_vccz tail_ready
  s_sleep 3
  s_sub_u32 s35, s35, 1
  s_cmp_lg_u32 s35, 0
  s_cbranch_scc1 tail_spin
tail_ready:
  buffer_load_dwordx4 a[180:183], v110, s[24:27], s30 offen offset:0 sc1
  buffer_load_dwordx4 a[184:187], v110, s[24:27], s30 offen offset:1024 sc1
  buffer_load_dwordx4 a[188:191], v111, s[24:27], s30 offen offset:0 sc1
  buffer_load_dwordx4 a[192:195], v111, s[24:27], s30 offen offset:1024 sc1
  buffer_load_dwordx4 a[196:199], v112, s[24:27], s30 offen offset:0 sc1
  buffer_load_dwordx4 a[200:203], v112, s[24:27], s30 offen offset:1024 sc1
  buffer_load_dwordx4 a[204:207], v113, s[24:27], s30 offen offset:0 sc1
  buffer_load_dwordx4 a[208:211], v113, s[24:27], s30 offen offset:1024 sc1
  v_cmp_gt_u32 vcc, 1073741824, v123
  s_nop 0
  s_and_saveexec_b64 s[42:43], vcc
  s_cbranch_execz tail_plain
  s_waitcnt vmcnt(30)
  buffer_load_dwordx4 v[156:159], v123, s[24:27], s32 offen offset:0 sc1
  buffer_load_dwordx4 v[160:163], v123, s[24:27], s32 offen offset:64 sc1
  buffer_load_dwordx4 v[164:167], v123, s[24:27], s32 offen offset:128 sc1
  buffer_load_dwordx4 v[168:171], v123, s[24:27], s32 offen offset:192 sc1
  buffer_load_dwordx4 v[172:175], v123, s[24:27], s32 offen offset:256 sc1
  s_add_u32 s32, s32, 20480
  buffer_load_dwordx4 v[136:139], v123, s[24:27], s32 offen offset:0 sc1
  buffer_load_dwordx4 v[140:143], v123, s[24:27], s32 offen offset:64 sc1
  buffer_load_dwordx4 v[144:147], v123, s[24:27], s32 offen offset:128 sc1
  buffer_load_dwordx4 v[148:151], v123, s[24:27], s32 offen offset:192 sc1
  buffer_load_dwordx4 v[152:155], v123, s[24:27], s32 offen offset:256 sc1
  s_add_u32 s32, s32, 20480
  buffer_load_dwordx4 v[0:3], v123, s[24:27], s32 offen offset:0 sc1
  buffer_load_dwordx4 v[4:7], v123, s[24:27], s32 offen offset:64 sc1
  buffer_load_dwordx4 v[8:11], v123, s[24:27], s32 offen offset:128 sc1
  buffer_load_dwordx4 v[12:15], v123, s[24:27], s32 offen offset:192 sc1
  buffer_load_dwordx4 v[16:19], v123, s[24:27], s32 offen offset:256 sc1
  s_add_u32 s32, s32, 20480
  buffer_load_dwordx4 v[20:23], v123, s[24:27], s32 offen offset:0 sc1
  buffer_load_dwordx4 v[24:27], v123, s[24:27], s32 offen offset:64 sc1
  buffer_load_dwordx4 v[28:31], v123, s[24:27], s32 offen offset:128 sc1
  buffer_load_dwordx4 v[32:35], v123, s[24:27], s32 offen offset:192 sc1
  buffer_load_dwordx4 v[36:39], v123, s[24:27], s32 offen offset:256 sc1
  s_add_u32 s32, s32, 20480
  buffer_load_dwordx4 v[40:43], v123, s[24:27], s32 offen offset:0 sc1
  buffer_load_dwordx4 v[44:47], v123, s[24:27], s32 offen offset:64 sc1
  buffer_load_dwordx4 v[48:51], v123, s[24:27], s32 offen offset:128 sc1
  buffer_load_dwordx4 v[52:55], v123, s[24:27], s32 offen offset:192 sc1
  buffer_load_dwordx4 v[56:59], v123, s[24:27], s32 offen offset:256 sc1
  s_add_u32 s32, s32, 20480
  buffer_load_dwordx4 v[60:63], v123, s[24:27], s32 offen offset:0 sc1
  buffer_load_dwordx4 v[64:67], v123, s[24:27], s32 offen offset:64 sc1
  buffer_load_dwordx4 v[68:71], v123, s[24:27], s32 offen offset:128 sc1
  buffer_load_dwordx4 v[72:75], v123, s[24:27], s32 offen offset:192 sc1
  buffer_load_dwordx4 v[76:79], v123, s[24:27], s32 offen offset:256 sc1
  s_add_u32 s32, s32, 20480
  s_waitcnt vmcnt(0)
  v_add_f32 v156, v156, v136
  v_add_f32 v157, v157, v137
  v_add_f32 v158, v158, v138
  v_add_f32 v159, v159, v139
  v_add_f32 v160, v160, v140
  v_add_f32 v161, v161, v141
  v_add_f32 v162, v162, v142
  v_add_f32 v163, v163, v143
  v_add_f32 v164, v164, v144
  v_add_f32 v165, v165, v145
  v_add_f32 v166, v166, v146
  v_add_f32 v167, v167, v147
  v_add_f32 v168, v168, v148
  v_add_f32 v169, v169, v149
  v_add_f32 v170, v170, v150
  v_add_f32 v171, v171, v151
  v_add_f32 v172, v172, v152
  v_add_f32 v173, v173, v153
  v_add_f32 v174, v174, v154
  v_add_f32 v175, v175, v155
  v_add_f32 v156, v156, v0
  v_add_f32 v157, v157, v1
  v_add_f32 v158, v158, v2
  v_add_f32 v159, v159, v3
  v_add_f32 v160, v160, v4
  v_add_f32 v161, v161, v5
  v_add_f32 v162, v162, v6
  v_add_f32 v163, v163, v7
  v_add_f32 v164, v164, v8
  v_add_f32 v165, v165, v9
  v_add_f32 v166, v166, v10
  v_add_f32 v167, v167, v11
  v_add_f32 v168, v168, v12
  v_add_f32 v169, v169, v13
  v_add_f32 v170, v170, v14
  v_add_f32 v171, v171, v15
  v_add_f32 v172, v172, v16
  v_add_f32 v173, v173, v17
  v_add_f32 v174, v174, v18
  v_add_f32 v175, v175, v19
  v_add_f32 v156, v156, v20
  v_add_f32 v157, v157, v21
  v_add_f32 v158, v158, v22
  v_add_f32 v159, v159, v23
  v_add_f32 v160, v160, v24
  v_add_f32 v161, v161, v25
  v_add_f32 v162, v162, v26
  v_add_f32 v163, v163, v27
  v_add_f32 v164, v164, v28
  v_add_f32 v165, v165, v29
  v_add_f32 v166, v166, v30
  v_add_f32 v167, v167, v31
  v_add_f32 v168, v168, v32
  v_add_f32 v169, v169, v33
  v_add_f32 v170, v170, v34
  v_add_f32 v171, v171, v35
  v_add_f32 v172, v172, v36
  v_add_f32 v173, v173, v37
  v_add_f32 v174, v174, v38
  v_add_f32 v175, v175, v39
  v_add_f32 v156, v156, v40
  v_add_f32 v157, v157, v41
  v_add_f32 v158, v158, v42
  v_add_f32 v159, v159, v43
  v_add_f32 v160, v160, v44
  v_add_f32 v161, v161, v45
  v_add_f32 v162, v162, v46
  v_add_f32 v163, v163, v47
  v_add_f32 v164, v164, v48
  v_add_f32 v165, v165, v49
  v_add_f32 v166, v166, v50
  v_add_f32 v167, v167, v51
  v_add_f32 v168, v168, v52
  v_add_f32 v169, v169, v53
  v_add_f32 v170, v170, v54
  v_add_f32 v171, v171, v55
  v_add_f32 v172, v172, v56
  v_add_f32 v173, v173, v57
  v_add_f32 v174, v174, v58
  v_add_f32 v175, v175, v59
  v_add_f32 v156, v156, v60
  v_add_f32 v157, v157, v61
  v_add_f32 v158, v158, v62
  v_add_f32 v159, v159, v63
  v_add_f32 v160, v160, v64
  v_add_f32 v161, v161, v65
  v_add_f32 v162, v162, v66
  v_add_f32 v163, v163, v67
  v_add_f32 v164, v164, v68
  v_add_f32 v165, v165, v69
  v_add_f32 v166, v166, v70
  v_add_f32 v167, v167, v71
  v_add_f32 v168, v168, v72
  v_add_f32 v169, v169, v73
  v_add_f32 v170, v170, v74
  v_add_f32 v171, v171, v75
  v_add_f32 v172, v172, v76
  v_add_f32 v173, v173, v77
  v_add_f32 v174, v174, v78
  v_add_f32 v175, v175, v79
tail_plain:
  s_mov_b64 exec, s[42:43]
  s_waitcnt vmcnt(0)
  v_mfma_f32_16x16x32_bf16 v[0:3], a[212:215], a[180:183], 0
  s_add_u32 s30, s30, 8192
  buffer_load_dwordx4 v[176:179], v110, s[24:27], s30 offen offset:0 sc1
  v_mfma_f32_16x16x32_bf16 v[0:3], a[232:235], a[184:187], v[0:3]
  v_cvt_pk_bf16_f32 v156, v156, v156
  v_cvt_pk_bf16_f32 v157, v157, v157
  v_mfma_f32_16x16x32_bf16 v[4:7], a[232:235], a[192:195], 0
  buffer_load_dwordx4 a[96:99], v115, s[24:27], s7 offen offset:3072 sc1
  v_mfma_f32_16x16x32_bf16 v[4:7], a[212:215], a[188:191], v[4:7]
  v_cvt_pk_bf16_f32 v158, v158, v158
  v_cvt_pk_bf16_f32 v159, v159, v159
  v_mfma_f32_16x16x32_bf16 v[8:11], a[212:215], a[196:199], 0
  buffer_load_dwordx4 v[180:183], v110, s[24:27], s30 offen offset:1024 sc1
  v_mfma_f32_16x16x32_bf16 v[8:11], a[232:235], a[200:203], v[8:11]
  v_lshlrev_b32 v156, 16, v156
  v_lshlrev_b32 v157, 16, v157
  v_mfma_f32_16x16x32_bf16 v[12:15], a[232:235], a[208:211], 0
  v_lshlrev_b32 v158, 16, v158
  v_lshlrev_b32 v159, 16, v159
  v_mfma_f32_16x16x32_bf16 v[12:15], a[212:215], a[204:207], v[12:15]
  v_mul_f32 v156, v156, v124
  v_mul_f32 v157, v157, v124
  v_mfma_f32_16x16x32_bf16 v[16:19], a[216:219], a[180:183], 0
  buffer_load_dwordx4 v[184:187], v111, s[24:27], s30 offen offset:0 sc1
  v_mfma_f32_16x16x32_bf16 v[16:19], a[236:239], a[184:187], v[16:19]
  v_mul_f32 v158, v158, v124
  v_mul_f32 v159, v159, v124
  v_mfma_f32_16x16x32_bf16 v[20:23], a[236:239], a[192:195], 0
  buffer_load_dwordx4 a[100:103], v116, s[24:27], s7 offen offset:0 sc1
  v_mfma_f32_16x16x32_bf16 v[20:23], a[216:219], a[188:191], v[20:23]
  v_cvt_pk_bf16_f32 v156, v156, v156
  v_cvt_pk_bf16_f32 v157, v157, v157
  v_mfma_f32_16x16x32_bf16 v[24:27], a[216:219], a[196:199], 0
  buffer_load_dwordx4 v[188:191], v111, s[24:27], s30 offen offset:1024 sc1
  v_mfma_f32_16x16x32_bf16 v[24:27], a[236:239], a[200:203], v[24:27]
  v_cvt_pk_bf16_f32 v158, v158, v158
  v_cvt_pk_bf16_f32 v159, v159, v159
  v_mfma_f32_16x16x32_bf16 v[28:31], a[236:239], a[208:211], 0
  v_lshlrev_b32 v156, 16, v156
  v_lshlrev_b32 v157, 16, v157
  v_mfma_f32_16x16x32_bf16 v[28:31], a[216:219], a[204:207], v[28:31]
  v_lshlrev_b32 v158, 16, v158
  v_lshlrev_b32 v159, 16, v159
  v_mfma_f32_16x16x32_bf16 v[32:35], a[220:223], a[180:183], 0
  buffer_load_dwordx4 v[192:195], v112, s[24:27], s30 offen offset:0 sc1
  v_mfma_f32_16x16x32_bf16 v[32:35], a[240:243], a[184:187], v[32:35]
  v_add_f32 v90, v90, v156
  v_add_f32 v91, v91, v157
  v_mfma_f32_16x16x32_bf16 v[36:39], a[240:243], a[192:195], 0
  buffer_load_dwordx4 a[104:107], v116, s[24:27], s7 offen offset:1024 sc1
  v_mfma_f32_16x16x32_bf16 v[36:39], a[220:223], a[188:191], v[36:39]
  v_add_f32 v92, v92, v158
  v_add_f32 v93, v93, v159
  v_mfma_f32_16x16x32_bf16 v[40:43], a[220:223], a[196:199], 0
  buffer_load_dwordx4 v[196:199], v112, s[24:27], s30 offen offset:1024 sc1
  v_mfma_f32_16x16x32_bf16 v[40:43], a[240:243], a[200:203], v[40:43]
  v_cvt_pk_bf16_f32 v90, v90, v90
  v_cvt_pk_bf16_f32 v91, v91, v91
  v_mfma_f32_16x16x32_bf16 v[44:47], a[240:243], a[208:211], 0
  v_cvt_pk_bf16_f32 v92, v92, v92
  v_cvt_pk_bf16_f32 v93, v93, v93
  v_mfma_f32_16x16x32_bf16 v[44:47], a[220:223], a[204:207], v[44:47]
  v_lshlrev_b32 v90, 16, v90
  v_lshlrev_b32 v91, 16, v91
  v_mfma_f32_16x16x32_bf16 v[48:51], a[224:227], a[180:183], 0
  buffer_load_dwordx4 v[200:203], v113, s[24:27], s30 offen offset:0 sc1
  v_mfma_f32_16x16x32_bf16 v[48:51], a[244:247], a[184:187], v[48:51]
  v_lshlrev_b32 v92, 16, v92
  v_lshlrev_b32 v93, 16, v93
  v_mfma_f32_16x16x32_bf16 v[52:55], a[244:247], a[192:195], 0
  buffer_load_dwordx4 a[108:111], v116, s[24:27], s7 offen offset:2048 sc1
  v_mfma_f32_16x16x32_bf16 v[52:55], a[224:227], a[188:191], v[52:55]
  v_mul_f32 v129, 0xbfb8aa3b, v90
  v_mul_f32 v130, 0xbfb8aa3b, v91
  v_mfma_f32_16x16x32_bf16 v[56:59], a[224:227], a[196:199], 0
  buffer_load_dwordx4 v[204:207], v113, s[24:27], s30 offen offset:1024 sc1
  v_mfma_f32_16x16x32_bf16 v[56:59], a[244:247], a[200:203], v[56:59]
  v_mul_f32 v131, 0xbfb8aa3b, v92
  v_mul_f32 v132, 0xbfb8aa3b, v93
  v_mfma_f32_16x16x32_bf16 v[60:63], a[244:247], a[208:211], 0
  v_exp_f32 v129, v129
  v_mfma_f32_16x16x32_bf16 v[60:63], a[224:227], a[204:207], v[60:63]
  v_exp_f32 v130, v130
  v_mfma_f32_16x16x32_bf16 v[64:67], a[228:231], a[180:183], 0
  s_add_u32 s30, s30, 8192
  buffer_load_dwordx4 v[208:211], v110, s[24:27], s30 offen offset:0 sc1
  v_mfma_f32_16x16x32_bf16 v[64:67], a[248:251], a[184:187], v[64:67]
  v_exp_f32 v131, v131
  v_mfma_f32_16x16x32_bf16 v[68:71], a[248:251], a[192:195], 0
  buffer_load_dwordx4 a[112:115], v116, s[24:27], s7 offen offset:3072 sc1
  v_mfma_f32_16x16x32_bf16 v[68:71], a[228:231], a[188:191], v[68:71]
  v_exp_f32 v132, v132
  v_mfma_f32_16x16x32_bf16 v[72:75], a[228:231], a[196:199], 0
  buffer_load_dwordx4 v[212:215], v110, s[24:27], s30 offen offset:1024 sc1
  v_mfma_f32_16x16x32_bf16 v[72:75], a[248:251], a[200:203], v[72:75]
  v_add_f32 v129, 1.0, v129
  v_add_f32 v130, 1.0, v130
  v_mfma_f32_16x16x32_bf16 v[76:79], a[248:251], a[208:211], 0
  v_add_f32 v131, 1.0, v131
  v_add_f32 v132, 1.0, v132
  v_mfma_f32_16x16x32_bf16 v[76:79], a[228:231], a[204:207], v[76:79]
  v_rcp_f32 v129, v129
  s_waitcnt vmcnt(3)
  v_mfma_f32_16x16x32_bf16 v[0:3], a[252:255], v[176:179], v[0:3]
  buffer_load_dwordx4 v[216:219], v111, s[24:27], s30 offen offset:0 sc1
  v_mfma_f32_16x16x32_bf16 v[0:3], a[144:147], v[180:183], v[0:3]
  v_rcp_f32 v130, v130
  v_mfma_f32_16x16x32_bf16 v[4:7], a[144:147], v[188:191], v[4:7]
  buffer_load_dwordx4 a[116:119], v114, s[24:27], s8 offen offset:0 sc1
  v_mfma_f32_16x16x32_bf16 v[4:7], a[252:255], v[184:187], v[4:7]
  v_rcp_f32 v131, v131
  v_mfma_f32_16x16x32_bf16 v[8:11], a[252:255], v[192:195], v[8:11]
  buffer_load_dwordx4 v[220:223], v111, s[24:27], s30 offen offset:1024 sc1
  v_mfma_f32_16x16x32_bf16 v[8:11], a[144:147], v[196:199], v[8:11]
  v_rcp_f32 v132, v132
  v_mfma_f32_16x16x32_bf16 v[12:15], a[144:147], v[204:207], v[12:15]
  v_mul_f32 v90, v90, v129
  v_mul_f32 v91, v91, v130
  v_mfma_f32_16x16x32_bf16 v[12:15], a[252:255], v[200:203], v[12:15]
  v_mul_f32 v92, v92, v131
  v_mul_f32 v93, v93, v132
  v_mfma_f32_16x16x32_bf16 v[16:19], a[128:131], v[176:179], v[16:19]
  buffer_load_dwordx4 v[224:227], v112, s[24:27], s30 offen offset:0 sc1
  v_mfma_f32_16x16x32_bf16 v[16:19], a[148:151], v[180:183], v[16:19]
  v_cvt_pk_bf16_f32 v90, v90, v90
  v_cvt_pk_bf16_f32 v91, v91, v91
  v_mfma_f32_16x16x32_bf16 v[20:23], a[148:151], v[188:191], v[20:23]
  buffer_load_dwordx4 a[120:123], v114, s[24:27], s8 offen offset:1024 sc1
  v_mfma_f32_16x16x32_bf16 v[20:23], a[128:131], v[184:187], v[20:23]
  v_cvt_pk_bf16_f32 v92, v92, v92
  v_cvt_pk_bf16_f32 v93, v93, v93
  v_mfma_f32_16x16x32_bf16 v[24:27], a[128:131], v[192:195], v[24:27]
  buffer_load_dwordx4 v[228:231], v112, s[24:27], s30 offen offset:1024 sc1
  v_mfma_f32_16x16x32_bf16 v[24:27], a[148:151], v[196:199], v[24:27]
  v_lshlrev_b32 v90, 16, v90
  v_lshlrev_b32 v91, 16, v91
  v_mfma_f32_16x16x32_bf16 v[28:31], a[148:151], v[204:207], v[28:31]
  v_lshlrev_b32 v92, 16, v92
  v_lshlrev_b32 v93, 16, v93
  v_mfma_f32_16x16x32_bf16 v[28:31], a[128:131], v[200:203], v[28:31]
  v_cvt_pk_bf16_f32 v160, v160, v160
  v_cvt_pk_bf16_f32 v161, v161, v161
  v_mfma_f32_16x16x32_bf16 v[32:35], a[132:135], v[176:179], v[32:35]
  buffer_load_dwordx4 v[232:235], v113, s[24:27], s30 offen offset:0 sc1
  v_mfma_f32_16x16x32_bf16 v[32:35], a[152:155], v[180:183], v[32:35]
  v_cvt_pk_bf16_f32 v162, v162, v162
  v_cvt_pk_bf16_f32 v163, v163, v163
  v_mfma_f32_16x16x32_bf16 v[36:39], a[152:155], v[188:191], v[36:39]
  buffer_load_dwordx4 a[124:127], v114, s[24:27], s8 offen offset:2048 sc1
  v_mfma_f32_16x16x32_bf16 v[36:39], a[132:135], v[184:187], v[36:39]
  v_lshlrev_b32 v160, 16, v160
  v_lshlrev_b32 v161, 16, v161
  v_mfma_f32_16x16x32_bf16 v[40:43], a[132:135], v[192:195], v[40:43]
  buffer_load_dwordx4 v[236:239], v113, s[24:27], s30 offen offset:1024 sc1
  v_mfma_f32_16x16x32_bf16 v[40:43], a[152:155], v[196:199], v[40:43]
  v_lshlrev_b32 v162, 16, v162
  v_lshlrev_b32 v163, 16, v163
  v_mfma_f32_16x16x32_bf16 v[44:47], a[152:155], v[204:207], v[44:47]
  v_mul_f32 v160, v160, v124
  v_mul_f32 v161, v161, v124
  v_mfma_f32_16x16x32_bf16 v[44:47], a[132:135], v[200:203], v[44:47]
  v_mul_f32 v162, v162, v124
  v_mul_f32 v163, v163, v124
  v_mfma_f32_16x16x32_bf16 v[48:51], a[136:139], v[176:179], v[48:51]
  s_add_u32 s30, s30, 8192
  buffer_load_dwordx4 v[240:243], v110, s[24:27], s30 offen offset:0 sc1
  v_mfma_f32_16x16x32_bf16 v[48:51], a[156:159], v[180:183], v[48:51]
  v_cvt_pk_bf16_f32 v160, v160, v160
  v_cvt_pk_bf16_f32 v161, v161, v161
  v_mfma_f32_16x16x32_bf16 v[52:55], a[156:159], v[188:191], v[52:55]
  buffer_load_dwordx4 a[160:163], v114, s[24:27], s8 offen offset:3072 sc1
  v_mfma_f32_16x16x32_bf16 v[52:55], a[136:139], v[184:187], v[52:55]
  v_cvt_pk_bf16_f32 v162, v162, v162
  v_cvt_pk_bf16_f32 v163, v163, v163
  v_mfma_f32_16x16x32_bf16 v[56:59], a[136:139], v[192:195], v[56:59]
  buffer_load_dwordx4 v[244:247], v110, s[24:27], s30 offen offset:1024 sc1
  v_mfma_f32_16x16x32_bf16 v[56:59], a[156:159], v[196:199], v[56:59]
  v_lshlrev_b32 v160, 16, v160
  v_lshlrev_b32 v161, 16, v161
  v_mfma_f32_16x16x32_bf16 v[60:63], a[156:159], v[204:207], v[60:63]
  v_lshlrev_b32 v162, 16, v162
  v_lshlrev_b32 v163, 16, v163
  v_mfma_f32_16x16x32_bf16 v[60:63], a[136:139], v[200:203], v[60:63]
  v_add_f32 v94, v94, v160
  v_add_f32 v95, v95, v161
  v_mfma_f32_16x16x32_bf16 v[64:67], a[140:143], v[176:179], v[64:67]
  buffer_load_dwordx4 v[248:251], v111, s[24:27], s30 offen offset:0 sc1
  v_mfma_f32_16x16x32_bf16 v[64:67], a[0:3], v[180:183], v[64:67]
  v_add_f32 v96, v96, v162
  v_add_f32 v97, v97, v163
  v_mfma_f32_16x16x32_bf16 v[68:71], a[0:3], v[188:191], v[68:71]
  buffer_load_dwordx4 a[164:167], v115, s[24:27], s8 offen offset:0 sc1
  v_mfma_f32_16x16x32_bf16 v[68:71], a[140:143], v[184:187], v[68:71]
  v_cvt_pk_bf16_f32 v94, v94, v94
  v_cvt_pk_bf16_f32 v95, v95, v95
  v_mfma_f32_16x16x32_bf16 v[72:75], a[140:143], v[192:195], v[72:75]
  buffer_load_dwordx4 v[252:255], v111, s[24:27], s30 offen offset:1024 sc1
  v_mfma_f32_16x16x32_bf16 v[72:75], a[0:3], v[196:199], v[72:75]
  v_cvt_pk_bf16_f32 v96, v96, v96
  v_cvt_pk_bf16_f32 v97, v97, v97
  v_mfma_f32_16x16x32_bf16 v[76:79], a[0:3], v[204:207], v[76:79]
  v_lshlrev_b32 v94, 16, v94
  v_lshlrev_b32 v95, 16, v95
  v_mfma_f32_16x16x32_bf16 v[76:79], a[140:143], v[200:203], v[76:79]
  v_lshlrev_b32 v96, 16, v96
  v_lshlrev_b32 v97, 16, v97
  s_waitcnt vmcnt(6)
  v_mfma_f32_16x16x32_bf16 v[0:3], a[4:7], v[208:211], v[0:3]
  buffer_load_dwordx4 v[136:139], v112, s[24:27], s30 offen offset:0 sc1
  v_mfma_f32_16x16x32_bf16 v[0:3], a[24:27], v[212:215], v[0:3]
  v_mul_f32 v129, 0xbfb8aa3b, v94
  v_mul_f32 v130, 0xbfb8aa3b, v95
  v_mfma_f32_16x16x32_bf16 v[4:7], a[24:27], v[220:223], v[4:7]
  buffer_load_dwordx4 a[168:171], v115, s[24:27], s8 offen offset:1024 sc1
  v_mfma_f32_16x16x32_bf16 v[4:7], a[4:7], v[216:219], v[4:7]
  v_mul_f32 v131, 0xbfb8aa3b, v96
  v_mul_f32 v132, 0xbfb8aa3b, v97
  v_mfma_f32_16x16x32_bf16 v[8:11], a[4:7], v[224:227], v[8:11]
  buffer_load_dwordx4 v[140:143], v112, s[24:27], s30 offen offset:1024 sc1
  v_mfma_f32_16x16x32_bf16 v[8:11], a[24:27], v[228:231], v[8:11]
  v_exp_f32 v129, v129
  v_mfma_f32_16x16x32_bf16 v[12:15], a[24:27], v[236:239], v[12:15]
  v_exp_f32 v130, v130
  v_mfma_f32_16x16x32_bf16 v[12:15], a[4:7], v[232:235], v[12:15]
  v_exp_f32 v131, v131
  v_mfma_f32_16x16x32_bf16 v[16:19], a[8:11], v[208:211], v[16:19]
  buffer_load_dwordx4 v[144:147], v113, s[24:27], s30 offen offset:0 sc1
  v_mfma_f32_16x16x32_bf16 v[16:19], a[28:31], v[212:215], v[16:19]
  v_exp_f32 v132, v132
  v_mfma_f32_16x16x32_bf16 v[20:23], a[28:31], v[220:223], v[20:23]
  buffer_load_dwordx4 a[172:175], v115, s[24:27], s8 offen offset:2048 sc1
  v_mfma_f32_16x16x32_bf16 v[20:23], a[8:11], v[216:219], v[20:23]
  v_add_f32 v129, 1.0, v129
  v_add_f32 v130, 1.0, v130
  v_mfma_f32_16x16x32_bf16 v[24:27], a[8:11], v[224:227], v[24:27]
  buffer_load_dwordx4 v[148:151], v113, s[24:27], s30 offen offset:1024 sc1
  v_mfma_f32_16x16x32_bf16 v[24:27], a[28:31], v[228:231], v[24:27]
  v_add_f32 v131, 1.0, v131
  v_add_f32 v132, 1.0, v132
  v_mfma_f32_16x16x32_bf16 v[28:31], a[28:31], v[236:239], v[28:31]
  v_rcp_f32 v129, v129
  v_mfma_f32_16x16x32_bf16 v[28:31], a[8:11], v[232:235], v[28:31]
  v_rcp_f32 v130, v130
  v_mfma_f32_16x16x32_bf16 v[32:35], a[12:15], v[208:211], v[32:35]
  s_add_u32 s30, s30, 8192
  buffer_load_dwordx4 v[152:155], v110, s[24:27], s30 offen offset:0 sc1
  v_mfma_f32_16x16x32_bf16 v[32:35], a[32:35], v[212:215], v[32:35]
  v_rcp_f32 v131, v131
  v_mfma_f32_16x16x32_bf16 v[36:39], a[32:35], v[220:223], v[36:39]
  buffer_load_dwordx4 a[176:179], v115, s[24:27], s8 offen offset:3072 sc1
  v_mfma_f32_16x16x32_bf16 v[36:39], a[12:15], v[216:219], v[36:39]
  v_rcp_f32 v132, v132
  v_mfma_f32_16x16x32_bf16 v[40:43], a[12:15], v[224:227], v[40:43]
  buffer_load_dwordx4 a[180:183], v110, s[24:27], s30 offen offset:1024 sc1
  v_mfma_f32_16x16x32_bf16 v[40:43], a[32:35], v[228:231], v[40:43]
  v_mul_f32 v94, v94, v129
  v_mul_f32 v95, v95, v130
  v_mfma_f32_16x16x32_bf16 v[44:47], a[32:35], v[236:239], v[44:47]
  v_mul_f32 v96, v96, v131
  v_mul_f32 v97, v97, v132
  v_mfma_f32_16x16x32_bf16 v[44:47], a[12:15], v[232:235], v[44:47]
  v_cvt_pk_bf16_f32 v94, v94, v94
  v_cvt_pk_bf16_f32 v95, v95, v95
  v_mfma_f32_16x16x32_bf16 v[48:51], a[16:19], v[208:211], v[48:51]
  buffer_load_dwordx4 a[184:187], v111, s[24:27], s30 offen offset:0 sc1
  v_mfma_f32_16x16x32_bf16 v[48:51], a[36:39], v[212:215], v[48:51]
  v_cvt_pk_bf16_f32 v96, v96, v96
  v_cvt_pk_bf16_f32 v97, v97, v97
  v_mfma_f32_16x16x32_bf16 v[52:55], a[36:39], v[220:223], v[52:55]
  s_add_u32 m0, s28, 49152
  s_nop 0
  buffer_load_dwordx4 v115, s[24:27], s10 offen offset:0 sc1 lds
  v_mfma_f32_16x16x32_bf16 v[52:55], a[16:19], v[216:219], v[52:55]
  buffer_load_dwordx4 v115, s[24:27], s10 offen offset:1024 sc1 lds
  v_mfma_f32_16x16x32_bf16 v[56:59], a[16:19], v[224:227], v[56:59]
  buffer_load_dwordx4 v115, s[24:27], s10 offen offset:2048 sc1 lds
  v_mfma_f32_16x16x32_bf16 v[56:59], a[36:39], v[228:231], v[56:59]
  buffer_load_dwordx4 v115, s[24:27], s10 offen offset:3072 sc1 lds
  v_mfma_f32_16x16x32_bf16 v[60:63], a[36:39], v[236:239], v[60:63]
  buffer_load_dwordx4 a[188:191], v111, s[24:27], s30 offen offset:1024 sc1
  v_mfma_f32_16x16x32_bf16 v[60:63], a[16:19], v[232:235], v[60:63]
  v_lshlrev_b32 v94, 16, v94
  v_lshlrev_b32 v95, 16, v95
  v_mfma_f32_16x16x32_bf16 v[64:67], a[20:23], v[208:211], v[64:67]
  buffer_load_dwordx4 a[192:195], v112, s[24:27], s30 offen offset:0 sc1
  v_mfma_f32_16x16x32_bf16 v[64:67], a[40:43], v[212:215], v[64:67]
  v_lshlrev_b32 v96, 16, v96
  v_lshlrev_b32 v97, 16, v97
  v_mfma_f32_16x16x32_bf16 v[68:71], a[40:43], v[220:223], v[68:71]
  v_cvt_pk_bf16_f32 v164, v164, v164
  v_cvt_pk_bf16_f32 v165, v165, v165
  v_mfma_f32_16x16x32_bf16 v[68:71], a[20:23], v[216:219], v[68:71]
  v_cvt_pk_bf16_f32 v166, v166, v166
  v_cvt_pk_bf16_f32 v167, v167, v167
  v_mfma_f32_16x16x32_bf16 v[72:75], a[20:23], v[224:227], v[72:75]
  buffer_load_dwordx4 a[196:199], v112, s[24:27], s30 offen offset:1024 sc1
  v_mfma_f32_16x16x32_bf16 v[72:75], a[40:43], v[228:231], v[72:75]
  v_lshlrev_b32 v164, 16, v164
  v_lshlrev_b32 v165, 16, v165
  v_mfma_f32_16x16x32_bf16 v[76:79], a[40:43], v[236:239], v[76:79]
  v_lshlrev_b32 v166, 16, v166
  v_lshlrev_b32 v167, 16, v167
  v_mfma_f32_16x16x32_bf16 v[76:79], a[20:23], v[232:235], v[76:79]
  v_mul_f32 v164, v164, v124
  v_mul_f32 v165, v165, v124
  s_waitcnt vmcnt(11)
  v_mfma_f32_16x16x32_bf16 v[0:3], a[44:47], v[240:243], v[0:3]
  buffer_load_dwordx4 a[200:203], v113, s[24:27], s30 offen offset:0 sc1
  v_mfma_f32_16x16x32_bf16 v[0:3], a[64:67], v[244:247], v[0:3]
  v_mul_f32 v166, v166, v124
  v_mul_f32 v167, v167, v124
  v_mfma_f32_16x16x32_bf16 v[4:7], a[64:67], v[252:255], v[4:7]
  v_cvt_pk_bf16_f32 v164, v164, v164
  v_cvt_pk_bf16_f32 v165, v165, v165
  v_mfma_f32_16x16x32_bf16 v[4:7], a[44:47], v[248:251], v[4:7]
  v_cvt_pk_bf16_f32 v166, v166, v166
  v_cvt_pk_bf16_f32 v167, v167, v167
  v_mfma_f32_16x16x32_bf16 v[8:11], a[44:47], v[136:139], v[8:11]
  buffer_load_dwordx4 a[204:207], v113, s[24:27], s30 offen offset:1024 sc1
  v_mfma_f32_16x16x32_bf16 v[8:11], a[64:67], v[140:143], v[8:11]
  v_lshlrev_b32 v164, 16, v164
  v_lshlrev_b32 v165, 16, v165
  v_mfma_f32_16x16x32_bf16 v[12:15], a[64:67], v[148:151], v[12:15]
  v_lshlrev_b32 v166, 16, v166
  v_lshlrev_b32 v167, 16, v167
  v_mfma_f32_16x16x32_bf16 v[12:15], a[44:47], v[144:147], v[12:15]
  v_add_f32 v98, v98, v164
  v_add_f32 v99, v99, v165
  v_mfma_f32_16x16x32_bf16 v[16:19], a[48:51], v[240:243], v[16:19]
  s_add_u32 s30, s30, 8192
  buffer_load_dwordx4 a[208:211], v110, s[24:27], s30 offen offset:0 sc1
  v_mfma_f32_16x16x32_bf16 v[16:19], a[68:71], v[244:247], v[16:19]
  v_add_f32 v100, v100, v166
  v_add_f32 v101, v101, v167
  v_mfma_f32_16x16x32_bf16 v[20:23], a[68:71], v[252:255], v[20:23]
  v_cvt_pk_bf16_f32 v98, v98, v98
  v_cvt_pk_bf16_f32 v99, v99, v99
  v_mfma_f32_16x16x32_bf16 v[20:23], a[48:51], v[248:251], v[20:23]
  v_cvt_pk_bf16_f32 v100, v100, v100
  v_cvt_pk_bf16_f32 v101, v101, v101
  v_mfma_f32_16x16x32_bf16 v[24:27], a[48:51], v[136:139], v[24:27]
  buffer_load_dwordx4 v[176:179], v110, s[24:27], s30 offen offset:1024 sc1
  v_mfma_f32_16x16x32_bf16 v[24:27], a[68:71], v[140:143], v[24:27]
  v_lshlrev_b32 v98, 16, v98
  v_lshlrev_b32 v99, 16, v99
  v_mfma_f32_16x16x32_bf16 v[28:31], a[68:71], v[148:151], v[28:31]
  v_lshlrev_b32 v100, 16, v100
  v_lshlrev_b32 v101, 16, v101
  v_mfma_f32_16x16x32_bf16 v[28:31], a[48:51], v[144:147], v[28:31]
  v_mul_f32 v129, 0xbfb8aa3b, v98
  v_mul_f32 v130, 0xbfb8aa3b, v99
  v_mfma_f32_16x16x32_bf16 v[32:35], a[52:55], v[240:243], v[32:35]
  buffer_load_dwordx4 v[180:183], v111, s[24:27], s30 offen offset:0 sc1
  v_mfma_f32_16x16x32_bf16 v[32:35], a[72:75], v[244:247], v[32:35]
  v_mul_f32 v131, 0xbfb8aa3b, v100
  v_mul_f32 v132, 0xbfb8aa3b, v101
  v_mfma_f32_16x16x32_bf16 v[36:39], a[72:75], v[252:255], v[36:39]
  v_exp_f32 v129, v129
  v_mfma_f32_16x16x32_bf16 v[36:39], a[52:55], v[248:251], v[36:39]
  v_exp_f32 v130, v130
  v_mfma_f32_16x16x32_bf16 v[40:43], a[52:55], v[136:139], v[40:43]
  buffer_load_dwordx4 v[184:187], v111, s[24:27], s30 offen offset:1024 sc1
  v_mfma_f32_16x16x32_bf16 v[40:43], a[72:75], v[140:143], v[40:43]
  v_exp_f32 v131, v131
  v_mfma_f32_16x16x32_bf16 v[44:47], a[72:75], v[148:151], v[44:47]
  v_exp_f32 v132, v132
  v_mfma_f32_16x16x32_bf16 v[44:47], a[52:55], v[144:147], v[44:47]
  v_add_f32 v129, 1.0, v129
  v_add_f32 v130, 1.0, v130
  v_mfma_f32_16x16x32_bf16 v[48:51], a[56:59], v[240:243], v[48:51]
  buffer_load_dwordx4 v[188:191], v112, s[24:27], s30 offen offset:0 sc1
  v_mfma_f32_16x16x32_bf16 v[48:51], a[76:79], v[244:247], v[48:51]
  v_add_f32 v131, 1.0, v131
  v_add_f32 v132, 1.0, v132
  v_mfma_f32_16x16x32_bf16 v[52:55], a[76:79], v[252:255], v[52:55]
  v_rcp_f32 v129, v129
  v_mfma_f32_16x16x32_bf16 v[52:55], a[56:59], v[248:251], v[52:55]
  v_rcp_f32 v130, v130
  v_mfma_f32_16x16x32_bf16 v[56:59], a[56:59], v[136:139], v[56:59]
  buffer_load_dwordx4 v[192:195], v112, s[24:27], s30 offen offset:1024 sc1
  v_mfma_f32_16x16x32_bf16 v[56:59], a[76:79], v[140:143], v[56:59]
  v_rcp_f32 v131, v131
  v_mfma_f32_16x16x32_bf16 v[60:63], a[76:79], v[148:151], v[60:63]
  v_rcp_f32 v132, v132
  v_mfma_f32_16x16x32_bf16 v[60:63], a[56:59], v[144:147], v[60:63]
  v_mul_f32 v98, v98, v129
  v_mul_f32 v99, v99, v130
  v_mfma_f32_16x16x32_bf16 v[64:67], a[60:63], v[240:243], v[64:67]
  buffer_load_dwordx4 v[196:199], v113, s[24:27], s30 offen offset:0 sc1
  v_mfma_f32_16x16x32_bf16 v[64:67], a[80:83], v[244:247], v[64:67]
  v_mul_f32 v100, v100, v131
  v_mul_f32 v101, v101, v132
  v_mfma_f32_16x16x32_bf16 v[68:71], a[80:83], v[252:255], v[68:71]
  v_cvt_pk_bf16_f32 v98, v98, v98
  v_cvt_pk_bf16_f32 v99, v99, v99
  v_mfma_f32_16x16x32_bf16 v[68:71], a[60:63], v[248:251], v[68:71]
  v_cvt_pk_bf16_f32 v100, v100, v100
  v_cvt_pk_bf16_f32 v101, v101, v101
  v_mfma_f32_16x16x32_bf16 v[72:75], a[60:63], v[136:139], v[72:75]
  buffer_load_dwordx4 v[200:203], v113, s[24:27], s30 offen offset:1024 sc1
  v_mfma_f32_16x16x32_bf16 v[72:75], a[80:83], v[140:143], v[72:75]
  v_lshlrev_b32 v98, 16, v98
  v_lshlrev_b32 v99, 16, v99
  v_mfma_f32_16x16x32_bf16 v[76:79], a[80:83], v[148:151], v[76:79]
  v_lshlrev_b32 v100, 16, v100
  v_lshlrev_b32 v101, 16, v101
  v_mfma_f32_16x16x32_bf16 v[76:79], a[60:63], v[144:147], v[76:79]
  v_cvt_pk_bf16_f32 v168, v168, v168
  v_cvt_pk_bf16_f32 v169, v169, v169
  s_waitcnt vmcnt(8)
  v_mfma_f32_16x16x32_bf16 v[0:3], a[84:87], v[152:155], v[0:3]
  s_add_u32 s30, s30, 8192
  buffer_load_dwordx4 v[204:207], v110, s[24:27], s30 offen offset:0 sc1
  v_mfma_f32_16x16x32_bf16 v[0:3], a[104:107], a[180:183], v[0:3]
  v_cvt_pk_bf16_f32 v170, v170, v170
  v_cvt_pk_bf16_f32 v171, v171, v171
  v_mfma_f32_16x16x32_bf16 v[4:7], a[104:107], a[188:191], v[4:7]
  v_lshlrev_b32 v168, 16, v168
  v_lshlrev_b32 v169, 16, v169
  v_mfma_f32_16x16x32_bf16 v[4:7], a[84:87], a[184:187], v[4:7]
  v_lshlrev_b32 v170, 16, v170
  v_lshlrev_b32 v171, 16, v171
  v_mfma_f32_16x16x32_bf16 v[8:11], a[84:87], a[192:195], v[8:11]
  buffer_load_dwordx4 v[208:211], v110, s[24:27], s30 offen offset:1024 sc1
  v_mfma_f32_16x16x32_bf16 v[8:11], a[104:107], a[196:199], v[8:11]
  v_mul_f32 v168, v168, v124
  v_mul_f32 v169, v169, v124
  v_mfma_f32_16x16x32_bf16 v[12:15], a[104:107], a[204:207], v[12:15]
  v_mul_f32 v170, v170, v124
  v_mul_f32 v171, v171, v124
  v_mfma_f32_16x16x32_bf16 v[12:15], a[84:87], a[200:203], v[12:15]
  v_cvt_pk_bf16_f32 v168, v168, v168
  v_cvt_pk_bf16_f32 v169, v169, v169
  v_mfma_f32_16x16x32_bf16 v[16:19], a[88:91], v[152:155], v[16:19]
  buffer_load_dwordx4 v[212:215], v111, s[24:27], s30 offen offset:0 sc1
  v_mfma_f32_16x16x32_bf16 v[16:19], a[108:111], a[180:183], v[16:19]
  v_cvt_pk_bf16_f32 v170, v170, v170
  v_cvt_pk_bf16_f32 v171, v171, v171
  v_mfma_f32_16x16x32_bf16 v[20:23], a[108:111], a[188:191], v[20:23]
  v_lshlrev_b32 v168, 16, v168
  v_lshlrev_b32 v169, 16, v169
  v_mfma_f32_16x16x32_bf16 v[20:23], a[88:91], a[184:187], v[20:23]
  v_lshlrev_b32 v170, 16, v170
  v_lshlrev_b32 v171, 16, v171
  v_mfma_f32_16x16x32_bf16 v[24:27], a[88:91], a[192:195], v[24:27]
  buffer_load_dwordx4 v[216:219], v111, s[24:27], s30 offen offset:1024 sc1
  v_mfma_f32_16x16x32_bf16 v[24:27], a[108:111], a[196:199], v[24:27]
  v_add_f32 v102, v102, v168
  v_add_f32 v103, v103, v169
  v_mfma_f32_16x16x32_bf16 v[28:31], a[108:111], a[204:207], v[28:31]
  v_add_f32 v104, v104, v170
  v_add_f32 v105, v105, v171
  v_mfma_f32_16x16x32_bf16 v[28:31], a[88:91], a[200:203], v[28:31]
  v_cvt_pk_bf16_f32 v102, v102, v102
  v_cvt_pk_bf16_f32 v103, v103, v103
  v_mfma_f32_16x16x32_bf16 v[32:35], a[92:95], v[152:155], v[32:35]
  buffer_load_dwordx4 v[220:223], v112, s[24:27], s30 offen offset:0 sc1
  v_mfma_f32_16x16x32_bf16 v[32:35], a[112:115], a[180:183], v[32:35]
  v_cvt_pk_bf16_f32 v104, v104, v104
  v_cvt_pk_bf16_f32 v105, v105, v105
  v_mfma_f32_16x16x32_bf16 v[36:39], a[112:115], a[188:191], v[36:39]
  v_lshlrev_b32 v102, 16, v102
  v_lshlrev_b32 v103, 16, v103
  v_mfma_f32_16x16x32_bf16 v[36:39], a[92:95], a[184:187], v[36:39]
  v_lshlrev_b32 v104, 16, v104
  v_lshlrev_b32 v105, 16, v105
  v_mfma_f32_16x16x32_bf16 v[40:43], a[92:95], a[192:195], v[40:43]
  buffer_load_dwordx4 v[224:227], v112, s[24:27], s30 offen offset:1024 sc1
  v_mfma_f32_16x16x32_bf16 v[40:43], a[112:115], a[196:199], v[40:43]
  v_mul_f32 v129, 0xbfb8aa3b, v102
  v_mul_f32 v130, 0xbfb8aa3b, v103
  v_mfma_f32_16x16x32_bf16 v[44:47], a[112:115], a[204:207], v[44:47]
  v_mul_f32 v131, 0xbfb8aa3b, v104
  v_mul_f32 v132, 0xbfb8aa3b, v105
  v_mfma_f32_16x16x32_bf16 v[44:47], a[92:95], a[200:203], v[44:47]
  v_exp_f32 v129, v129
  v_mfma_f32_16x16x32_bf16 v[48:51], a[96:99], v[152:155], v[48:51]
  buffer_load_dwordx4 v[228:231], v113, s[24:27], s30 offen offset:0 sc1
  v_mfma_f32_16x16x32_bf16 v[48:51], a[116:119], a[180:183], v[48:51]
  v_exp_f32 v130, v130
  v_mfma_f32_16x16x32_bf16 v[52:55], a[116:119], a[188:191], v[52:55]
  v_exp_f32 v131, v131
  v_mfma_f32_16x16x32_bf16 v[52:55], a[96:99], a[184:187], v[52:55]
  v_exp_f32 v132, v132
  v_mfma_f32_16x16x32_bf16 v[56:59], a[96:99], a[192:195], v[56:59]
  buffer_load_dwordx4 v[232:235], v113, s[24:27], s30 offen offset:1024 sc1
  v_mfma_f32_16x16x32_bf16 v[56:59], a[116:119], a[196:199], v[56:59]
  v_add_f32 v129, 1.0, v129
  v_add_f32 v130, 1.0, v130
  v_mfma_f32_16x16x32_bf16 v[60:63], a[116:119], a[204:207], v[60:63]
  v_add_f32 v131, 1.0, v131
  v_add_f32 v132, 1.0, v132
  v_mfma_f32_16x16x32_bf16 v[60:63], a[96:99], a[200:203], v[60:63]
  v_rcp_f32 v129, v129
  v_mfma_f32_16x16x32_bf16 v[64:67], a[100:103], v[152:155], v[64:67]
  ds_read_b128 v[236:239], v122 offset:0
  s_add_u32 s30, s30, 8192
  v_rcp_f32 v130, v130
  v_mfma_f32_16x16x32_bf16 v[64:67], a[120:123], a[180:183], v[64:67]
  buffer_load_dwordx4 v[240:243], v110, s[24:27], s30 offen offset:0 sc1
  v_mfma_f32_16x16x32_bf16 v[68:71], a[120:123], a[188:191], v[68:71]
  v_rcp_f32 v131, v131
  v_mfma_f32_16x16x32_bf16 v[68:71], a[100:103], a[184:187], v[68:71]
  v_rcp_f32 v132, v132
  v_mfma_f32_16x16x32_bf16 v[72:75], a[100:103], a[192:195], v[72:75]
  buffer_load_dwordx4 v[244:247], v110, s[24:27], s30 offen offset:1024 sc1
  v_mfma_f32_16x16x32_bf16 v[72:75], a[120:123], a[196:199], v[72:75]
  v_mul_f32 v102, v102, v129
  v_mul_f32 v103, v103, v130
  v_mfma_f32_16x16x32_bf16 v[76:79], a[120:123], a[204:207], v[76:79]
  v_mul_f32 v104, v104, v131
  v_mul_f32 v105, v105, v132
  v_mfma_f32_16x16x32_bf16 v[76:79], a[100:103], a[200:203], v[76:79]
  v_cvt_pk_bf16_f32 v102, v102, v102
  v_cvt_pk_bf16_f32 v103, v103, v103
  s_waitcnt vmcnt(10)
  v_mfma_f32_16x16x32_bf16 v[0:3], a[124:127], a[208:211], v[0:3]
  ds_read_b128 v[248:251], v122 offset:1024
  v_cvt_pk_bf16_f32 v104, v104, v104
  v_mfma_f32_16x16x32_bf16 v[0:3], a[176:179], v[176:179], v[0:3]
  buffer_load_dwordx4 v[252:255], v111, s[24:27], s30 offen offset:0 sc1
  v_mfma_f32_16x16x32_bf16 v[4:7], a[176:179], v[184:187], v[4:7]
  v_cvt_pk_bf16_f32 v105, v105, v105
  v_lshlrev_b32 v102, 16, v102
  v_mfma_f32_16x16x32_bf16 v[4:7], a[124:127], v[180:183], v[4:7]
  v_lshlrev_b32 v103, 16, v103
  v_lshlrev_b32 v104, 16, v104
  v_mfma_f32_16x16x32_bf16 v[8:11], a[124:127], v[188:191], v[8:11]
  buffer_load_dwordx4 v[136:139], v111, s[24:27], s30 offen offset:1024 sc1
  v_mfma_f32_16x16x32_bf16 v[8:11], a[176:179], v[192:195], v[8:11]
  v_lshlrev_b32 v105, 16, v105
  v_cvt_pk_bf16_f32 v172, v172, v172
  v_mfma_f32_16x16x32_bf16 v[12:15], a[176:179], v[200:203], v[12:15]
  v_cvt_pk_bf16_f32 v173, v173, v173
  v_cvt_pk_bf16_f32 v174, v174, v174
  v_mfma_f32_16x16x32_bf16 v[12:15], a[124:127], v[196:199], v[12:15]
  v_cvt_pk_bf16_f32 v175, v175, v175
  v_lshlrev_b32 v172, 16, v172
  s_waitcnt lgkmcnt(1)
  v_mfma_f32_16x16x32_bf16 v[16:19], a[160:163], a[208:211], v[16:19]
  ds_read_b128 v[140:143], v122 offset:2048
  v_lshlrev_b32 v173, 16, v173
  v_mfma_f32_16x16x32_bf16 v[16:19], v[236:239], v[176:179], v[16:19]
  buffer_load_dwordx4 v[144:147], v112, s[24:27], s30 offen offset:0 sc1
  v_mfma_f32_16x16x32_bf16 v[20:23], v[236:239], v[184:187], v[20:23]
  v_lshlrev_b32 v174, 16, v174
  v_lshlrev_b32 v175, 16, v175
  v_mfma_f32_16x16x32_bf16 v[20:23], a[160:163], v[180:183], v[20:23]
  v_mul_f32 v172, v172, v124
  v_mul_f32 v173, v173, v124
  v_mfma_f32_16x16x32_bf16 v[24:27], a[160:163], v[188:191], v[24:27]
  buffer_load_dwordx4 v[148:151], v112, s[24:27], s30 offen offset:1024 sc1
  v_mfma_f32_16x16x32_bf16 v[24:27], v[236:239], v[192:195], v[24:27]
  v_mul_f32 v174, v174, v124
  v_mul_f32 v175, v175, v124
  v_mfma_f32_16x16x32_bf16 v[28:31], v[236:239], v[200:203], v[28:31]
  v_cvt_pk_bf16_f32 v172, v172, v172
  v_cvt_pk_bf16_f32 v173, v173, v173
  v_mfma_f32_16x16x32_bf16 v[28:31], a[160:163], v[196:199], v[28:31]
  v_cvt_pk_bf16_f32 v174, v174, v174
  v_cvt_pk_bf16_f32 v175, v175, v175
  s_waitcnt lgkmcnt(1)
  v_mfma_f32_16x16x32_bf16 v[32:35], a[164:167], a[208:211], v[32:35]
  ds_read_b128 v[152:155], v122 offset:3072
  v_lshlrev_b32 v172, 16, v172
  v_mfma_f32_16x16x32_bf16 v[32:35], v[248:251], v[176:179], v[32:35]
  buffer_load_dwordx4 a[180:183], v113, s[24:27], s30 offen offset:0 sc1
  v_mfma_f32_16x16x32_bf16 v[36:39], v[248:251], v[184:187], v[36:39]
  v_lshlrev_b32 v173, 16, v173
  v_lshlrev_b32 v174, 16, v174
  v_mfma_f32_16x16x32_bf16 v[36:39], a[164:167], v[180:183], v[36:39]
  v_lshlrev_b32 v175, 16, v175
  v_add_f32 v106, v106, v172
  v_mfma_f32_16x16x32_bf16 v[40:43], a[164:167], v[188:191], v[40:43]
  buffer_load_dwordx4 a[184:187], v113, s[24:27], s30 offen offset:1024 sc1
  v_mfma_f32_16x16x32_bf16 v[40:43], v[248:251], v[192:195], v[40:43]
  v_add_f32 v107, v107, v173
  v_add_f32 v108, v108, v174
  v_mfma_f32_16x16x32_bf16 v[44:47], v[248:251], v[200:203], v[44:47]
  v_add_f32 v109, v109, v175
  v_cvt_pk_bf16_f32 v106, v106, v106
  v_mfma_f32_16x16x32_bf16 v[44:47], a[164:167], v[196:199], v[44:47]
  v_cvt_pk_bf16_f32 v107, v107, v107
  v_cvt_pk_bf16_f32 v108, v108, v108
  s_waitcnt lgkmcnt(1)
  v_mfma_f32_16x16x32_bf16 v[48:51], a[168:171], a[208:211], v[48:51]
  ds_read_b128 a[188:191], v122 offset:16384
  ds_read_b128 a[192:195], v122 offset:33792
  s_mov_b32 s30, s37
  v_mfma_f32_16x16x32_bf16 v[48:51], v[140:143], v[176:179], v[48:51]
  buffer_load_dwordx4 a[196:199], v110, s[24:27], s30 offen offset:0 sc1
  v_mfma_f32_16x16x32_bf16 v[52:55], v[140:143], v[184:187], v[52:55]
  v_cvt_pk_bf16_f32 v109, v109, v109
  v_lshlrev_b32 v106, 16, v106
  v_mfma_f32_16x16x32_bf16 v[52:55], a[168:171], v[180:183], v[52:55]
  v_lshlrev_b32 v107, 16, v107
  v_lshlrev_b32 v108, 16, v108
  v_mfma_f32_16x16x32_bf16 v[56:59], a[168:171], v[188:191], v[56:59]
  buffer_load_dwordx4 a[200:203], v110, s[24:27], s30 offen offset:1024 sc1
  v_mfma_f32_16x16x32_bf16 v[56:59], v[140:143], v[192:195], v[56:59]
  v_lshlrev_b32 v109, 16, v109
  v_mul_f32 v129, 0xbfb8aa3b, v106
  v_mfma_f32_16x16x32_bf16 v[60:63], v[140:143], v[200:203], v[60:63]
  v_mul_f32 v130, 0xbfb8aa3b, v107
  v_mul_f32 v131, 0xbfb8aa3b, v108
  v_mfma_f32_16x16x32_bf16 v[60:63], a[168:171], v[196:199], v[60:63]
  v_mul_f32 v132, 0xbfb8aa3b, v109
  v_exp_f32 v129, v129
  s_waitcnt lgkmcnt(2)
  v_mfma_f32_16x16x32_bf16 v[64:67], a[172:175], a[208:211], v[64:67]
  ds_read_b128 a[204:207], v122 offset:17408
  ds_read_b128 v[236:239], v122 offset:34816
  v_mfma_f32_16x16x32_bf16 v[64:67], v[152:155], v[176:179], v[64:67]
  v_exp_f32 v130, v130
  v_mfma_f32_16x16x32_bf16 v[68:71], v[152:155], v[184:187], v[68:71]
  v_exp_f32 v131, v131
  v_mfma_f32_16x16x32_bf16 v[68:71], a[172:175], v[180:183], v[68:71]
  v_exp_f32 v132, v132
  v_mfma_f32_16x16x32_bf16 v[72:75], a[172:175], v[188:191], v[72:75]
  v_add_f32 v129, 1.0, v129
  v_add_f32 v130, 1.0, v130
  v_mfma_f32_16x16x32_bf16 v[72:75], v[152:155], v[192:195], v[72:75]
  v_add_f32 v131, 1.0, v131
  v_add_f32 v132, 1.0, v132
  v_mfma_f32_16x16x32_bf16 v[76:79], v[152:155], v[200:203], v[76:79]
  v_rcp_f32 v129, v129
  v_mfma_f32_16x16x32_bf16 v[76:79], a[172:175], v[196:199], v[76:79]
  v_rcp_f32 v130, v130
  s_waitcnt vmcnt(10) lgkmcnt(2)
  v_mfma_f32_16x16x32_bf16 v[0:3], a[188:191], v[204:207], v[0:3]
  ds_read_b128 v[248:251], v122 offset:18432
  ds_read_b128 v[140:143], v122 offset:35840
  v_mfma_f32_16x16x32_bf16 v[0:3], a[192:195], v[208:211], v[0:3]
  buffer_load_dwordx4 v[152:155], v111, s[24:27], s30 offen offset:0 sc1
  v_mfma_f32_16x16x32_bf16 v[4:7], a[192:195], v[216:219], v[4:7]
  v_rcp_f32 v131, v131
  v_mfma_f32_16x16x32_bf16 v[4:7], a[188:191], v[212:215], v[4:7]
  v_rcp_f32 v132, v132
  v_mfma_f32_16x16x32_bf16 v[8:11], a[188:191], v[220:223], v[8:11]
  buffer_load_dwordx4 a[208:211], v111, s[24:27], s30 offen offset:1024 sc1
  v_mfma_f32_16x16x32_bf16 v[8:11], a[192:195], v[224:227], v[8:11]
  v_mul_f32 v106, v106, v129
  v_mul_f32 v107, v107, v130
  v_mfma_f32_16x16x32_bf16 v[12:15], a[192:195], v[232:235], v[12:15]
  v_mul_f32 v108, v108, v131
  v_mul_f32 v109, v109, v132
  v_mfma_f32_16x16x32_bf16 v[12:15], a[188:191], v[228:231], v[12:15]
  v_cvt_pk_bf16_f32 v106, v106, v106
  v_cvt_pk_bf16_f32 v107, v107, v107
  s_waitcnt lgkmcnt(2)
  v_mfma_f32_16x16x32_bf16 v[16:19], a[204:207], v[204:207], v[16:19]
  ds_read_b128 v[176:179], v122 offset:19456
  ds_read_b128 v[180:183], v135 offset:0
  v_mfma_f32_16x16x32_bf16 v[16:19], v[236:239], v[208:211], v[16:19]
  buffer_load_dwordx4 v[184:187], v112, s[24:27], s30 offen offset:0 sc1
  v_mfma_f32_16x16x32_bf16 v[20:23], v[236:239], v[216:219], v[20:23]
  v_cvt_pk_bf16_f32 v108, v108, v108
  v_cvt_pk_bf16_f32 v109, v109, v109
  v_mfma_f32_16x16x32_bf16 v[20:23], a[204:207], v[212:215], v[20:23]
  v_lshlrev_b32 v106, 16, v106
  v_lshlrev_b32 v107, 16, v107
  v_mfma_f32_16x16x32_bf16 v[24:27], a[204:207], v[220:223], v[24:27]
  buffer_load_dwordx4 v[188:191], v112, s[24:27], s30 offen offset:1024 sc1
  v_mfma_f32_16x16x32_bf16 v[24:27], v[236:239], v[224:227], v[24:27]
  v_lshlrev_b32 v108, 16, v108
  v_lshlrev_b32 v109, 16, v109
  v_mfma_f32_16x16x32_bf16 v[28:31], v[236:239], v[232:235], v[28:31]
  v_lshlrev_b32 v156, 16, v80
  v_and_b32 v157, s34, v80
  v_mfma_f32_16x16x32_bf16 v[28:31], a[204:207], v[228:231], v[28:31]
  v_lshlrev_b32 v158, 16, v81
  v_and_b32 v159, s34, v81
  s_waitcnt lgkmcnt(2)
  v_mfma_f32_16x16x32_bf16 v[32:35], v[248:251], v[204:207], v[32:35]
  ds_read_b128 v[192:195], v122 offset:32768
  ds_read_b128 v[196:199], v135 offset:1024
  v_mfma_f32_16x16x32_bf16 v[32:35], v[140:143], v[208:211], v[32:35]
  buffer_load_dwordx4 v[200:203], v113, s[24:27], s30 offen offset:0 sc1
  v_mfma_f32_16x16x32_bf16 v[36:39], v[140:143], v[216:219], v[36:39]
  v_lshlrev_b32 v160, 16, v82
  v_and_b32 v161, s34, v82
  v_mfma_f32_16x16x32_bf16 v[36:39], v[248:251], v[212:215], v[36:39]
  v_lshlrev_b32 v162, 16, v83
  v_and_b32 v163, s34, v83
  v_mfma_f32_16x16x32_bf16 v[40:43], v[248:251], v[220:223], v[40:43]
  buffer_load_dwordx4 a[188:191], v113, s[24:27], s30 offen offset:1024 sc1
  v_mfma_f32_16x16x32_bf16 v[40:43], v[140:143], v[224:227], v[40:43]
  v_lshlrev_b32 v164, 16, v84
  v_and_b32 v165, s34, v84
  v_mfma_f32_16x16x32_bf16 v[44:47], v[140:143], v[232:235], v[44:47]
  v_lshlrev_b32 v166, 16, v85
  v_and_b32 v167, s34, v85
  v_mfma_f32_16x16x32_bf16 v[44:47], v[248:251], v[228:231], v[44:47]
  v_lshlrev_b32 v168, 16, v86
  v_and_b32 v169, s34, v86
  s_waitcnt lgkmcnt(2)
  v_mfma_f32_16x16x32_bf16 v[48:51], v[176:179], v[204:207], v[48:51]
  ds_read_b128 a[192:195], v135 offset:2048
  ds_read_b128 a[204:207], v135 offset:19456
  s_add_u32 s30, s30, 8192
  v_mfma_f32_16x16x32_bf16 v[48:51], v[180:183], v[208:211], v[48:51]
  buffer_load_dwordx4 v[236:239], v110, s[24:27], s30 offen offset:0 sc1
  v_mfma_f32_16x16x32_bf16 v[52:55], v[180:183], v[216:219], v[52:55]
  v_lshlrev_b32 v170, 16, v87
  v_and_b32 v171, s34, v87
  v_mfma_f32_16x16x32_bf16 v[52:55], v[176:179], v[212:215], v[52:55]
  v_lshlrev_b32 v172, 16, v88
  v_and_b32 v173, s34, v88
  v_mfma_f32_16x16x32_bf16 v[56:59], v[176:179], v[220:223], v[56:59]
  v_lshlrev_b32 v174, 16, v89
  v_and_b32 v175, s34, v89
  v_mfma_f32_16x16x32_bf16 v[56:59], v[180:183], v[224:227], v[56:59]
  s_sub_u32 s41, s3, 1
  s_and_b32 s41, s41, 3
  s_lshl_b32 s41, s41, 12
  v_add_u32 v80, s41, v114
  v_mfma_f32_16x16x32_bf16 v[60:63], v[180:183], v[232:235], v[60:63]
  s_sub_u32 s41, s3, 2
  s_and_b32 s41, s41, 3
  s_lshl_b32 s41, s41, 12
  v_add_u32 v81, s41, v114
  v_mfma_f32_16x16x32_bf16 v[60:63], v[176:179], v[228:231], v[60:63]
  s_sub_u32 s41, s3, 3
  s_and_b32 s41, s41, 3
  s_lshl_b32 s41, s41, 12
  v_add_u32 v82, s41, v114
  v_bfe_u32 v129, v114, 8, 1
  s_waitcnt lgkmcnt(2)
  v_mfma_f32_16x16x32_bf16 v[64:67], v[192:195], v[204:207], v[64:67]
  ds_read_b128 v[248:251], v135 offset:3072
  ds_read_b128 v[140:143], v122 offset:49152
  v_mfma_f32_16x16x32_bf16 v[64:67], v[196:199], v[208:211], v[64:67]
  v_mul_u32_u24 v129, 24, v129
  v_add_u32 v83, v117, v129
  v_mfma_f32_16x16x32_bf16 v[68:71], v[196:199], v[216:219], v[68:71]
  v_mfma_f32_16x16x32_bf16 v[68:71], v[192:195], v[212:215], v[68:71]
  v_mfma_f32_16x16x32_bf16 v[72:75], v[192:195], v[220:223], v[72:75]
  v_mfma_f32_16x16x32_bf16 v[72:75], v[196:199], v[224:227], v[72:75]
  v_mfma_f32_16x16x32_bf16 v[76:79], v[196:199], v[232:235], v[76:79]
  v_mfma_f32_16x16x32_bf16 v[76:79], v[192:195], v[228:231], v[76:79]
  s_waitcnt vmcnt(9) lgkmcnt(2)
  v_mfma_f32_16x16x32_bf16 v[0:3], a[192:195], v[240:243], v[0:3]
  ds_read_b128 v[176:179], v135 offset:16384
  ds_read_b128 v[180:183], v122 offset:50176
  s_xor_b32 s38, s40, 1
  v_mfma_f32_16x16x32_bf16 v[0:3], a[204:207], v[244:247], v[0:3]
  buffer_load_dwordx4 v[192:195], v110, s[24:27], s30 offen offset:1024 sc1
  s_lshl_b32 s38, s38, 2
  s_add_u32 s38, s38, s3
  s_lshl_b32 s38, s38, 13
  v_mfma_f32_16x16x32_bf16 v[4:7], a[204:207], v[136:139], v[4:7]
  s_add_u32 s38, s38, 25165824
  s_add_u32 s39, s38, 4096
  v_lshrrev_b32 v125, 1, v114
  v_mfma_f32_16x16x32_bf16 v[4:7], a[192:195], v[252:255], v[4:7]
  v_mfma_f32_16x16x32_bf16 v[8:11], a[192:195], v[144:147], v[8:11]
  buffer_load_dwordx4 v[196:199], v111, s[24:27], s30 offen offset:0 sc1
  v_mfma_f32_16x16x32_bf16 v[8:11], a[204:207], v[148:151], v[8:11]
  v_mfma_f32_16x16x32_bf16 v[12:15], a[204:207], a[184:187], v[12:15]
  v_mfma_f32_16x16x32_bf16 v[12:15], a[192:195], a[180:183], v[12:15]
  s_waitcnt lgkmcnt(2)
  v_mfma_f32_16x16x32_bf16 v[16:19], v[248:251], v[240:243], v[16:19]
  ds_read_b128 v[204:207], v135 offset:17408
  ds_read_b128 v[208:211], v122 offset:51200
  v_mfma_f32_16x16x32_bf16 v[16:19], v[140:143], v[244:247], v[16:19]
  buffer_load_dwordx4 v[212:215], v111, s[24:27], s30 offen offset:1024 sc1
  v_mfma_f32_16x16x32_bf16 v[20:23], v[140:143], v[136:139], v[20:23]
  ds_write_b128 v118, v[4:7] offset:0
  ds_write_b128 v118, v[8:11] offset:5120
  v_mfma_f32_16x16x32_bf16 v[20:23], v[248:251], v[252:255], v[20:23]
  ds_write_b128 v118, v[12:15] offset:10240
  v_mfma_f32_16x16x32_bf16 v[24:27], v[248:251], v[144:147], v[24:27]
  buffer_load_dwordx4 v[216:219], v112, s[24:27], s30 offen offset:0 sc1
  v_mfma_f32_16x16x32_bf16 v[24:27], v[140:143], v[148:151], v[24:27]
  v_mfma_f32_16x16x32_bf16 v[28:31], v[140:143], a[184:187], v[28:31]
  v_mfma_f32_16x16x32_bf16 v[28:31], v[248:251], a[180:183], v[28:31]
  s_waitcnt lgkmcnt(5)
  v_mfma_f32_16x16x32_bf16 v[32:35], v[176:179], v[240:243], v[32:35]
  ds_read_b128 v[220:223], v135 offset:18432
  ds_read_b128 v[224:227], v122 offset:52224
  v_mfma_f32_16x16x32_bf16 v[32:35], v[180:183], v[244:247], v[32:35]
  buffer_load_dwordx4 v[228:231], v112, s[24:27], s30 offen offset:1024 sc1
  v_mfma_f32_16x16x32_bf16 v[36:39], v[180:183], v[136:139], v[36:39]
  ds_write_b128 v118, v[20:23] offset:1024
  ds_write_b128 v118, v[24:27] offset:6144
  v_mfma_f32_16x16x32_bf16 v[36:39], v[176:179], v[252:255], v[36:39]
  ds_write_b128 v118, v[28:31] offset:11264
  v_mfma_f32_16x16x32_bf16 v[40:43], v[176:179], v[144:147], v[40:43]
  buffer_load_dwordx4 v[232:235], v113, s[24:27], s30 offen offset:0 sc1
  v_mfma_f32_16x16x32_bf16 v[40:43], v[180:183], v[148:151], v[40:43]
  v_mfma_f32_16x16x32_bf16 v[44:47], v[180:183], a[184:187], v[44:47]
  v_mfma_f32_16x16x32_bf16 v[44:47], v[176:179], a[180:183], v[44:47]
  s_waitcnt lgkmcnt(8)
  v_mfma_f32_16x16x32_bf16 v[48:51], v[204:207], v[240:243], v[48:51]
  buffer_load_dwordx4 a[192:195], v113, s[24:27], s30 offen offset:1024 sc1
  v_mfma_f32_16x16x32_bf16 v[48:51], v[208:211], v[244:247], v[48:51]
  ds_write_b128 v118, v[36:39] offset:2048
  v_mfma_f32_16x16x32_bf16 v[52:55], v[208:211], v[136:139], v[52:55]
  ds_write_b128 v118, v[40:43] offset:7168
  v_mfma_f32_16x16x32_bf16 v[52:55], v[204:207], v[252:255], v[52:55]
  ds_write_b128 v118, v[44:47] offset:12288
  v_mfma_f32_16x16x32_bf16 v[56:59], v[204:207], v[144:147], v[56:59]
  s_add_u32 s30, s30, 8192
  buffer_load_dwordx4 a[204:207], v110, s[24:27], s30 offen offset:0 sc1
  v_mfma_f32_16x16x32_bf16 v[56:59], v[208:211], v[148:151], v[56:59]
  v_mfma_f32_16x16x32_bf16 v[60:63], v[208:211], a[184:187], v[60:63]
  v_mfma_f32_16x16x32_bf16 v[60:63], v[204:207], a[180:183], v[60:63]
  s_waitcnt lgkmcnt(6)
  v_mfma_f32_16x16x32_bf16 v[64:67], v[220:223], v[240:243], v[64:67]
  buffer_load_dwordx4 v[248:251], v110, s[24:27], s30 offen offset:1024 sc1
  v_mfma_f32_16x16x32_bf16 v[64:67], v[224:227], v[244:247], v[64:67]
  ds_write_b128 v118, v[52:55] offset:3072
  v_mfma_f32_16x16x32_bf16 v[68:71], v[224:227], v[136:139], v[68:71]
  ds_write_b128 v118, v[56:59] offset:8192
  v_mfma_f32_16x16x32_bf16 v[68:71], v[220:223], v[252:255], v[68:71]
  ds_write_b128 v118, v[60:63] offset:13312
  v_mfma_f32_16x16x32_bf16 v[72:75], v[220:223], v[144:147], v[72:75]
  buffer_load_dwordx4 v[140:143], v111, s[24:27], s30 offen offset:0 sc1
  v_mfma_f32_16x16x32_bf16 v[72:75], v[224:227], v[148:151], v[72:75]
  v_mfma_f32_16x16x32_bf16 v[76:79], v[224:227], a[184:187], v[76:79]
  v_mfma_f32_16x16x32_bf16 v[76:79], v[220:223], a[180:183], v[76:79]
  s_nop 1
  ds_write_b128 v118, v[68:71] offset:4096
  s_nop 2
  ds_write_b128 v118, v[72:75] offset:9216
  s_nop 0
  ds_write_b128 v118, v[76:79] offset:14336
  buffer_load_dwordx4 v[176:179], v111, s[24:27], s30 offen offset:1024 sc1
  buffer_load_dwordx4 v[180:183], v112, s[24:27], s30 offen offset:0 sc1
  buffer_load_dwordx4 v[204:207], v112, s[24:27], s30 offen offset:1024 sc1
  buffer_load_dwordx4 v[208:211], v113, s[24:27], s30 offen offset:0 sc1
  buffer_load_dwordx4 v[220:223], v113, s[24:27], s30 offen offset:1024 sc1
  s_add_u32 s30, s30, 8192
  buffer_load_dwordx4 v[224:227], v110, s[24:27], s30 offen offset:0 sc1
  buffer_load_dwordx4 v[240:243], v110, s[24:27], s30 offen offset:1024 sc1
  buffer_load_dwordx4 v[244:247], v111, s[24:27], s30 offen offset:0 sc1
  buffer_load_dwordx4 v[252:255], v111, s[24:27], s30 offen offset:1024 sc1
  buffer_load_dwordx4 v[136:139], v112, s[24:27], s30 offen offset:0 sc1
  buffer_load_dwordx4 v[144:147], v112, s[24:27], s30 offen offset:1024 sc1
  buffer_load_dwordx4 v[148:151], v113, s[24:27], s30 offen offset:0 sc1
  buffer_load_dwordx4 a[180:183], v113, s[24:27], s30 offen offset:1024 sc1
  s_add_u32 s30, s30, 8192
  buffer_load_dwordx4 a[184:187], v110, s[24:27], s30 offen offset:0 sc1
  s_waitcnt lgkmcnt(0)
  s_barrier
  ds_read_b128 v[4:7], v119 offset:0
  ds_read_b128 v[8:11], v120 offset:5120
  ds_read_b128 v[12:15], v121 offset:10240
  ds_read_b128 v[20:23], v119 offset:1024
  ds_read_b128 v[24:27], v120 offset:6144
  ds_read_b128 v[28:31], v121 offset:11264
  ds_read_b128 v[36:39], v119 offset:2048
  ds_read_b128 v[40:43], v120 offset:7168
  ds_read_b128 v[44:47], v121 offset:12288
  ds_read_b128 v[52:55], v119 offset:3072
  ds_read_b128 v[56:59], v120 offset:8192
  ds_read_b128 v[60:63], v121 offset:13312
  ds_read_b128 v[68:71], v119 offset:4096
  ds_read_b128 v[72:75], v120 offset:9216
  ds_read_b128 v[76:79], v121 offset:14336
  s_waitcnt lgkmcnt(12)
  v_add_f32 v4, v4, v8
  v_add_f32 v5, v5, v9
  v_add_f32 v6, v6, v10
  v_add_f32 v7, v7, v11
  v_add_f32 v0, v0, v12
  v_add_f32 v1, v1, v13
  v_add_f32 v2, v2, v14
  v_add_f32 v3, v3, v15
  v_add_f32 v0, v0, v4
  v_add_f32 v1, v1, v5
  v_add_f32 v2, v2, v6
  v_add_f32 v3, v3, v7
  v_cvt_pk_bf16_f32 v4, v0, v1
  v_cvt_pk_bf16_f32 v5, v2, v3
  buffer_store_dwordx2 v[4:5], v125, s[24:27], s38 offen offset:0 sc1
  s_waitcnt vmcnt(26)
  v_mfma_f32_16x16x32_bf16 v[0:3], a[212:215], a[196:199], 0
  s_waitcnt lgkmcnt(9)
  v_add_f32 v20, v20, v24
  v_add_f32 v21, v21, v25
  v_mfma_f32_16x16x32_bf16 v[0:3], a[232:235], a[200:203], v[0:3]
  v_add_f32 v22, v22, v26
  v_add_f32 v23, v23, v27
  v_mfma_f32_16x16x32_bf16 v[4:7], a[232:235], a[208:211], 0
  v_add_f32 v16, v16, v28
  v_add_f32 v17, v17, v29
  v_mfma_f32_16x16x32_bf16 v[4:7], a[212:215], v[152:155], v[4:7]
  v_add_f32 v18, v18, v30
  v_add_f32 v19, v19, v31
  v_mfma_f32_16x16x32_bf16 v[8:11], a[212:215], v[184:187], 0
  v_add_f32 v16, v16, v20
  v_add_f32 v17, v17, v21
  v_mfma_f32_16x16x32_bf16 v[8:11], a[232:235], v[188:191], v[8:11]
  v_add_f32 v18, v18, v22
  v_add_f32 v19, v19, v23
  v_mfma_f32_16x16x32_bf16 v[12:15], a[232:235], a[188:191], 0
  v_cvt_pk_bf16_f32 v20, v16, v17
  v_cvt_pk_bf16_f32 v21, v18, v19
  v_mfma_f32_16x16x32_bf16 v[12:15], a[212:215], v[200:203], v[12:15]
  buffer_store_dwordx2 v[20:21], v125, s[24:27], s38 offen offset:512 sc1
  s_waitcnt lgkmcnt(6)
  v_mfma_f32_16x16x32_bf16 v[16:19], a[216:219], a[196:199], 0
  buffer_load_dwordx4 a[212:215], v110, s[24:27], s30 offen offset:1024 sc1
  v_mfma_f32_16x16x32_bf16 v[16:19], a[236:239], a[200:203], v[16:19]
  v_add_f32 v36, v36, v40
  v_add_f32 v37, v37, v41
  v_mfma_f32_16x16x32_bf16 v[20:23], a[236:239], a[208:211], 0
  v_add_f32 v38, v38, v42
  v_add_f32 v39, v39, v43
  v_mfma_f32_16x16x32_bf16 v[20:23], a[216:219], v[152:155], v[20:23]
  v_add_f32 v32, v32, v44
  v_add_f32 v33, v33, v45
  v_mfma_f32_16x16x32_bf16 v[24:27], a[216:219], v[184:187], 0
  buffer_load_dwordx4 a[232:235], v111, s[24:27], s30 offen offset:0 sc1
  v_mfma_f32_16x16x32_bf16 v[24:27], a[236:239], v[188:191], v[24:27]
  v_add_f32 v34, v34, v46
  v_add_f32 v35, v35, v47
  v_mfma_f32_16x16x32_bf16 v[28:31], a[236:239], a[188:191], 0
  v_add_f32 v32, v32, v36
  v_add_f32 v33, v33, v37
  v_mfma_f32_16x16x32_bf16 v[28:31], a[216:219], v[200:203], v[28:31]
  v_add_f32 v34, v34, v38
  v_add_f32 v35, v35, v39
  v_cvt_pk_bf16_f32 v36, v32, v33
  v_cvt_pk_bf16_f32 v37, v34, v35
  buffer_store_dwordx2 v[36:37], v125, s[24:27], s38 offen offset:1024 sc1
  v_mfma_f32_16x16x32_bf16 v[32:35], a[220:223], a[196:199], 0
  buffer_load_dwordx4 a[216:219], v111, s[24:27], s30 offen offset:1024 sc1
  s_waitcnt lgkmcnt(3)
  v_mfma_f32_16x16x32_bf16 v[32:35], a[240:243], a[200:203], v[32:35]
  v_add_f32 v52, v52, v56
  v_add_f32 v53, v53, v57
  v_mfma_f32_16x16x32_bf16 v[36:39], a[240:243], a[208:211], 0
  v_add_f32 v54, v54, v58
  v_add_f32 v55, v55, v59
  v_mfma_f32_16x16x32_bf16 v[36:39], a[220:223], v[152:155], v[36:39]
  v_add_f32 v48, v48, v60
  v_add_f32 v49, v49, v61
  v_mfma_f32_16x16x32_bf16 v[40:43], a[220:223], v[184:187], 0
  buffer_load_dwordx4 a[236:239], v112, s[24:27], s30 offen offset:0 sc1
  v_mfma_f32_16x16x32_bf16 v[40:43], a[240:243], v[188:191], v[40:43]
  v_add_f32 v50, v50, v62
  v_add_f32 v51, v51, v63
  v_mfma_f32_16x16x32_bf16 v[44:47], a[240:243], a[188:191], 0
  v_add_f32 v48, v48, v52
  v_add_f32 v49, v49, v53
  v_mfma_f32_16x16x32_bf16 v[44:47], a[220:223], v[200:203], v[44:47]
  v_add_f32 v50, v50, v54
  v_add_f32 v51, v51, v55
  v_cvt_pk_bf16_f32 v52, v48, v49
  v_cvt_pk_bf16_f32 v53, v50, v51
  buffer_store_dwordx2 v[52:53], v125, s[24:27], s38 offen offset:1536 sc1
  v_mfma_f32_16x16x32_bf16 v[48:51], a[224:227], a[196:199], 0
  buffer_load_dwordx4 a[220:223], v112, s[24:27], s30 offen offset:1024 sc1
  s_waitcnt lgkmcnt(0)
  v_mfma_f32_16x16x32_bf16 v[48:51], a[244:247], a[200:203], v[48:51]
  v_add_f32 v68, v68, v72
  v_add_f32 v69, v69, v73
  v_mfma_f32_16x16x32_bf16 v[52:55], a[244:247], a[208:211], 0
  v_add_f32 v70, v70, v74
  v_add_f32 v71, v71, v75
  v_mfma_f32_16x16x32_bf16 v[52:55], a[224:227], v[152:155], v[52:55]
  v_add_f32 v64, v64, v76
  v_add_f32 v65, v65, v77
  v_mfma_f32_16x16x32_bf16 v[56:59], a[224:227], v[184:187], 0
  buffer_load_dwordx4 a[240:243], v113, s[24:27], s30 offen offset:0 sc1
  v_mfma_f32_16x16x32_bf16 v[56:59], a[244:247], v[188:191], v[56:59]
  v_add_f32 v66, v66, v78
  v_add_f32 v67, v67, v79
  v_mfma_f32_16x16x32_bf16 v[60:63], a[244:247], a[188:191], 0
  v_add_f32 v64, v64, v68
  v_add_f32 v65, v65, v69
  v_mfma_f32_16x16x32_bf16 v[60:63], a[224:227], v[200:203], v[60:63]
  v_add_f32 v66, v66, v70
  v_add_f32 v67, v67, v71
  v_cvt_pk_bf16_f32 v68, v64, v65
  v_cvt_pk_bf16_f32 v69, v66, v67
  buffer_store_dwordx2 v[68:69], v125, s[24:27], s38 offen offset:2048 sc1
  v_mfma_f32_16x16x32_bf16 v[64:67], a[228:231], a[196:199], 0
  buffer_load_dwordx4 a[224:227], v113, s[24:27], s30 offen offset:1024 sc1
  s_xor_b32 s38, s40, 1
  s_lshl_b32 s38, s38, 7
  s_add_u32 s38, s38, 2834432
  v_mfma_f32_16x16x32_bf16 v[64:67], a[248:251], a[200:203], v[64:67]
  v_mov_b32 v126, 1073741824
  v_writelane_b32 v126, s38, 0
  v_mfma_f32_16x16x32_bf16 v[68:71], a[248:251], a[208:211], 0
  v_mov_b32 v127, 1
  v_mfma_f32_16x16x32_bf16 v[68:71], a[228:231], v[152:155], v[68:71]
  s_xor_b32 s38, s38, 128
  v_mov_b32 v133, s38
  v_mov_b32 v134, 4
  v_mfma_f32_16x16x32_bf16 v[72:75], a[228:231], v[184:187], 0
  s_add_u32 s30, s30, 8192
  buffer_load_dwordx4 a[244:247], v110, s[24:27], s30 offen offset:0 sc1
  v_mfma_f32_16x16x32_bf16 v[72:75], a[248:251], v[188:191], v[72:75]
  v_mfma_f32_16x16x32_bf16 v[76:79], a[248:251], a[188:191], 0
  v_mfma_f32_16x16x32_bf16 v[76:79], a[228:231], v[200:203], v[76:79]
  s_waitcnt vmcnt(30)
  v_mfma_f32_16x16x32_bf16 v[0:3], a[252:255], v[236:239], v[0:3]
  buffer_load_dwordx4 a[228:231], v110, s[24:27], s30 offen offset:1024 sc1
  v_mfma_f32_16x16x32_bf16 v[0:3], a[144:147], v[192:195], v[0:3]
  v_mfma_f32_16x16x32_bf16 v[4:7], a[144:147], v[212:215], v[4:7]
  v_mfma_f32_16x16x32_bf16 v[4:7], a[252:255], v[196:199], v[4:7]
  v_mfma_f32_16x16x32_bf16 v[8:11], a[252:255], v[216:219], v[8:11]
  buffer_load_dwordx4 a[248:251], v111, s[24:27], s30 offen offset:0 sc1
  v_mfma_f32_16x16x32_bf16 v[8:11], a[144:147], v[228:231], v[8:11]
  v_mfma_f32_16x16x32_bf16 v[12:15], a[144:147], a[192:195], v[12:15]
  v_mfma_f32_16x16x32_bf16 v[12:15], a[252:255], v[232:235], v[12:15]
  v_mfma_f32_16x16x32_bf16 v[16:19], a[128:131], v[236:239], v[16:19]
  buffer_load_dwordx4 a[196:199], v111, s[24:27], s30 offen offset:1024 sc1
  v_mfma_f32_16x16x32_bf16 v[16:19], a[148:151], v[192:195], v[16:19]
  v_mfma_f32_16x16x32_bf16 v[20:23], a[148:151], v[212:215], v[20:23]
  v_mfma_f32_16x16x32_bf16 v[20:23], a[128:131], v[196:199], v[20:23]
  v_mfma_f32_16x16x32_bf16 v[24:27], a[128:131], v[216:219], v[24:27]
  buffer_load_dwordx4 a[200:203], v112, s[24:27], s30 offen offset:0 sc1
  v_mfma_f32_16x16x32_bf16 v[24:27], a[148:151], v[228:231], v[24:27]
  v_mfma_f32_16x16x32_bf16 v[28:31], a[148:151], a[192:195], v[28:31]
  v_mfma_f32_16x16x32_bf16 v[28:31], a[128:131], v[232:235], v[28:31]
  v_mfma_f32_16x16x32_bf16 v[32:35], a[132:135], v[236:239], v[32:35]
  buffer_load_dwordx4 a[208:211], v112, s[24:27], s30 offen offset:1024 sc1
  v_mfma_f32_16x16x32_bf16 v[32:35], a[152:155], v[192:195], v[32:35]
  v_mfma_f32_16x16x32_bf16 v[36:39], a[152:155], v[212:215], v[36:39]
  v_mfma_f32_16x16x32_bf16 v[36:39], a[132:135], v[196:199], v[36:39]
  v_mfma_f32_16x16x32_bf16 v[40:43], a[132:135], v[216:219], v[40:43]
  buffer_load_dwordx4 v[184:187], v113, s[24:27], s30 offen offset:0 sc1
  v_mfma_f32_16x16x32_bf16 v[40:43], a[152:155], v[228:231], v[40:43]
  v_mfma_f32_16x16x32_bf16 v[44:47], a[152:155], a[192:195], v[44:47]
  v_mfma_f32_16x16x32_bf16 v[44:47], a[132:135], v[232:235], v[44:47]
  v_mfma_f32_16x16x32_bf16 v[48:51], a[136:139], v[236:239], v[48:51]
  buffer_load_dwordx4 v[188:191], v113, s[24:27], s30 offen offset:1024 sc1
  v_mfma_f32_16x16x32_bf16 v[48:51], a[156:159], v[192:195], v[48:51]
  v_mfma_f32_16x16x32_bf16 v[52:55], a[156:159], v[212:215], v[52:55]
  v_mfma_f32_16x16x32_bf16 v[52:55], a[136:139], v[196:199], v[52:55]
  v_mfma_f32_16x16x32_bf16 v[56:59], a[136:139], v[216:219], v[56:59]
  s_add_u32 s30, s30, 8192
  buffer_load_dwordx4 v[200:203], v110, s[24:27], s30 offen offset:0 sc1
  v_mfma_f32_16x16x32_bf16 v[56:59], a[156:159], v[228:231], v[56:59]
  v_mfma_f32_16x16x32_bf16 v[60:63], a[156:159], a[192:195], v[60:63]
  v_mfma_f32_16x16x32_bf16 v[60:63], a[136:139], v[232:235], v[60:63]
  v_mfma_f32_16x16x32_bf16 v[64:67], a[140:143], v[236:239], v[64:67]
  buffer_load_dwordx4 a[188:191], v110, s[24:27], s30 offen offset:1024 sc1
  v_mfma_f32_16x16x32_bf16 v[64:67], a[0:3], v[192:195], v[64:67]
  v_mfma_f32_16x16x32_bf16 v[68:71], a[0:3], v[212:215], v[68:71]
  v_mfma_f32_16x16x32_bf16 v[68:71], a[140:143], v[196:199], v[68:71]
  v_mfma_f32_16x16x32_bf16 v[72:75], a[140:143], v[216:219], v[72:75]
  buffer_load_dwordx4 a[252:255], v111, s[24:27], s30 offen offset:0 sc1
  v_mfma_f32_16x16x32_bf16 v[72:75], a[0:3], v[228:231], v[72:75]
  v_mfma_f32_16x16x32_bf16 v[76:79], a[0:3], a[192:195], v[76:79]
  v_mfma_f32_16x16x32_bf16 v[76:79], a[140:143], v[232:235], v[76:79]
  s_waitcnt vmcnt(32)
  v_mfma_f32_16x16x32_bf16 v[0:3], a[4:7], a[204:207], v[0:3]
  buffer_load_dwordx4 a[144:147], v111, s[24:27], s30 offen offset:1024 sc1
  v_mfma_f32_16x16x32_bf16 v[0:3], a[24:27], v[248:251], v[0:3]
  v_mfma_f32_16x16x32_bf16 v[4:7], a[24:27], v[176:179], v[4:7]
  v_mfma_f32_16x16x32_bf16 v[4:7], a[4:7], v[140:143], v[4:7]
  v_mfma_f32_16x16x32_bf16 v[8:11], a[4:7], v[180:183], v[8:11]
  buffer_load_dwordx4 a[128:131], v112, s[24:27], s30 offen offset:0 sc1
  v_mfma_f32_16x16x32_bf16 v[8:11], a[24:27], v[204:207], v[8:11]
  v_mfma_f32_16x16x32_bf16 v[12:15], a[24:27], v[220:223], v[12:15]
  v_mfma_f32_16x16x32_bf16 v[12:15], a[4:7], v[208:211], v[12:15]
  v_mfma_f32_16x16x32_bf16 v[16:19], a[8:11], a[204:207], v[16:19]
  buffer_load_dwordx4 a[148:151], v112, s[24:27], s30 offen offset:1024 sc1
  v_mfma_f32_16x16x32_bf16 v[16:19], a[28:31], v[248:251], v[16:19]
  v_mfma_f32_16x16x32_bf16 v[20:23], a[28:31], v[176:179], v[20:23]
  v_mfma_f32_16x16x32_bf16 v[20:23], a[8:11], v[140:143], v[20:23]
  v_mfma_f32_16x16x32_bf16 v[24:27], a[8:11], v[180:183], v[24:27]
  buffer_load_dwordx4 a[132:135], v113, s[24:27], s30 offen offset:0 sc1
  v_mfma_f32_16x16x32_bf16 v[24:27], a[28:31], v[204:207], v[24:27]
  v_mfma_f32_16x16x32_bf16 v[28:31], a[28:31], v[220:223], v[28:31]
  v_mfma_f32_16x16x32_bf16 v[28:31], a[8:11], v[208:211], v[28:31]
  v_mfma_f32_16x16x32_bf16 v[32:35], a[12:15], a[204:207], v[32:35]
  buffer_load_dwordx4 a[152:155], v113, s[24:27], s30 offen offset:1024 sc1
  v_mfma_f32_16x16x32_bf16 v[32:35], a[32:35], v[248:251], v[32:35]
  v_mfma_f32_16x16x32_bf16 v[36:39], a[32:35], v[176:179], v[36:39]
  v_mfma_f32_16x16x32_bf16 v[36:39], a[12:15], v[140:143], v[36:39]
  v_mfma_f32_16x16x32_bf16 v[40:43], a[12:15], v[180:183], v[40:43]
  s_add_u32 s30, s30, 8192
  buffer_load_dwordx4 a[136:139], v110, s[24:27], s30 offen offset:0 sc1
  v_mfma_f32_16x16x32_bf16 v[40:43], a[32:35], v[204:207], v[40:43]
  v_mfma_f32_16x16x32_bf16 v[44:47], a[32:35], v[220:223], v[44:47]
  v_mfma_f32_16x16x32_bf16 v[44:47], a[12:15], v[208:211], v[44:47]
  v_mfma_f32_16x16x32_bf16 v[48:51], a[16:19], a[204:207], v[48:51]
  buffer_load_dwordx4 a[156:159], v110, s[24:27], s30 offen offset:1024 sc1
  v_mfma_f32_16x16x32_bf16 v[48:51], a[36:39], v[248:251], v[48:51]
  v_mfma_f32_16x16x32_bf16 v[52:55], a[36:39], v[176:179], v[52:55]
  v_mfma_f32_16x16x32_bf16 v[52:55], a[16:19], v[140:143], v[52:55]
  v_mfma_f32_16x16x32_bf16 v[56:59], a[16:19], v[180:183], v[56:59]
  buffer_load_dwordx4 a[140:143], v111, s[24:27], s30 offen offset:0 sc1
  v_mfma_f32_16x16x32_bf16 v[56:59], a[36:39], v[204:207], v[56:59]
  v_mfma_f32_16x16x32_bf16 v[60:63], a[36:39], v[220:223], v[60:63]
  v_mfma_f32_16x16x32_bf16 v[60:63], a[16:19], v[208:211], v[60:63]
  v_mfma_f32_16x16x32_bf16 v[64:67], a[20:23], a[204:207], v[64:67]
  buffer_load_dwordx4 a[0:3], v111, s[24:27], s30 offen offset:1024 sc1
  v_mfma_f32_16x16x32_bf16 v[64:67], a[40:43], v[248:251], v[64:67]
  v_mfma_f32_16x16x32_bf16 v[68:71], a[40:43], v[176:179], v[68:71]
  v_mfma_f32_16x16x32_bf16 v[68:71], a[20:23], v[140:143], v[68:71]
  v_mfma_f32_16x16x32_bf16 v[72:75], a[20:23], v[180:183], v[72:75]
  buffer_load_dwordx4 v[236:239], v112, s[24:27], s30 offen offset:0 sc1
  v_mfma_f32_16x16x32_bf16 v[72:75], a[40:43], v[204:207], v[72:75]
  v_mfma_f32_16x16x32_bf16 v[76:79], a[40:43], v[220:223], v[76:79]
  v_mfma_f32_16x16x32_bf16 v[76:79], a[20:23], v[208:211], v[76:79]
  s_waitcnt vmcnt(34)
  v_mfma_f32_16x16x32_bf16 v[0:3], a[44:47], v[224:227], v[0:3]
  buffer_load_dwordx4 v[192:195], v112, s[24:27], s30 offen offset:1024 sc1
  s_waitcnt vmcnt(23)
  v_mfma_f32_16x16x32_bf16 v[0:3], a[64:67], v[240:243], v[0:3]
  buffer_atomic_add v127, v126, s[24:27], 0 offen
  v_mfma_f32_16x16x32_bf16 v[4:7], a[64:67], v[252:255], v[4:7]
  v_mfma_f32_16x16x32_bf16 v[4:7], a[44:47], v[244:247], v[4:7]
  v_mfma_f32_16x16x32_bf16 v[8:11], a[44:47], v[136:139], v[8:11]
  buffer_load_dwordx4 v[196:199], v113, s[24:27], s30 offen offset:0 sc1
  v_mfma_f32_16x16x32_bf16 v[8:11], a[64:67], v[144:147], v[8:11]
  v_mfma_f32_16x16x32_bf16 v[12:15], a[64:67], a[180:183], v[12:15]
  v_mfma_f32_16x16x32_bf16 v[12:15], a[44:47], v[148:151], v[12:15]
  v_mfma_f32_16x16x32_bf16 v[16:19], a[48:51], v[224:227], v[16:19]
  buffer_load_dwordx4 v[212:215], v113, s[24:27], s30 offen offset:1024 sc1
  v_mfma_f32_16x16x32_bf16 v[16:19], a[68:71], v[240:243], v[16:19]
  v_mfma_f32_16x16x32_bf16 v[20:23], a[68:71], v[252:255], v[20:23]
  v_mfma_f32_16x16x32_bf16 v[20:23], a[48:51], v[244:247], v[20:23]
  v_mfma_f32_16x16x32_bf16 v[24:27], a[48:51], v[136:139], v[24:27]
  s_add_u32 s30, s30, 8192
  v_mfma_f32_16x16x32_bf16 v[24:27], a[68:71], v[144:147], v[24:27]
  v_mfma_f32_16x16x32_bf16 v[28:31], a[68:71], a[180:183], v[28:31]
  v_mfma_f32_16x16x32_bf16 v[28:31], a[48:51], v[148:151], v[28:31]
  v_mfma_f32_16x16x32_bf16 v[32:35], a[52:55], v[224:227], v[32:35]
  v_mfma_f32_16x16x32_bf16 v[32:35], a[72:75], v[240:243], v[32:35]
  v_mfma_f32_16x16x32_bf16 v[36:39], a[72:75], v[252:255], v[36:39]
  v_mfma_f32_16x16x32_bf16 v[36:39], a[52:55], v[244:247], v[36:39]
  v_mfma_f32_16x16x32_bf16 v[40:43], a[52:55], v[136:139], v[40:43]
  v_mfma_f32_16x16x32_bf16 v[40:43], a[72:75], v[144:147], v[40:43]
  v_mfma_f32_16x16x32_bf16 v[44:47], a[72:75], a[180:183], v[44:47]
  v_mfma_f32_16x16x32_bf16 v[44:47], a[52:55], v[148:151], v[44:47]
  v_mfma_f32_16x16x32_bf16 v[48:51], a[56:59], v[224:227], v[48:51]
  v_mfma_f32_16x16x32_bf16 v[48:51], a[76:79], v[240:243], v[48:51]
  v_mfma_f32_16x16x32_bf16 v[52:55], a[76:79], v[252:255], v[52:55]
  v_mfma_f32_16x16x32_bf16 v[52:55], a[56:59], v[244:247], v[52:55]
  v_mfma_f32_16x16x32_bf16 v[56:59], a[56:59], v[136:139], v[56:59]
  v_mfma_f32_16x16x32_bf16 v[56:59], a[76:79], v[144:147], v[56:59]
  v_mfma_f32_16x16x32_bf16 v[60:63], a[76:79], a[180:183], v[60:63]
  v_mfma_f32_16x16x32_bf16 v[60:63], a[56:59], v[148:151], v[60:63]
  v_mfma_f32_16x16x32_bf16 v[64:67], a[60:63], v[224:227], v[64:67]
  v_mfma_f32_16x16x32_bf16 v[64:67], a[80:83], v[240:243], v[64:67]
  v_mfma_f32_16x16x32_bf16 v[68:71], a[80:83], v[252:255], v[68:71]
  v_mfma_f32_16x16x32_bf16 v[68:71], a[60:63], v[244:247], v[68:71]
  v_mfma_f32_16x16x32_bf16 v[72:75], a[60:63], v[136:139], v[72:75]
  v_mfma_f32_16x16x32_bf16 v[72:75], a[80:83], v[144:147], v[72:75]
  v_mfma_f32_16x16x32_bf16 v[76:79], a[80:83], a[180:183], v[76:79]
  v_mfma_f32_16x16x32_bf16 v[76:79], a[60:63], v[148:151], v[76:79]
  s_waitcnt vmcnt(25)
  v_mfma_f32_16x16x32_bf16 v[0:3], a[84:87], a[184:187], v[0:3]
  v_mfma_f32_16x16x32_bf16 v[0:3], a[104:107], a[212:215], v[0:3]
  v_mfma_f32_16x16x32_bf16 v[4:7], a[104:107], a[216:219], v[4:7]
  v_mfma_f32_16x16x32_bf16 v[4:7], a[84:87], a[232:235], v[4:7]
  v_mfma_f32_16x16x32_bf16 v[8:11], a[84:87], a[236:239], v[8:11]
  v_mfma_f32_16x16x32_bf16 v[8:11], a[104:107], a[220:223], v[8:11]
  v_mfma_f32_16x16x32_bf16 v[12:15], a[104:107], a[224:227], v[12:15]
  v_mfma_f32_16x16x32_bf16 v[12:15], a[84:87], a[240:243], v[12:15]
  v_mfma_f32_16x16x32_bf16 v[16:19], a[88:91], a[184:187], v[16:19]
  v_mfma_f32_16x16x32_bf16 v[16:19], a[108:111], a[212:215], v[16:19]
  v_mfma_f32_16x16x32_bf16 v[20:23], a[108:111], a[216:219], v[20:23]
  v_mfma_f32_16x16x32_bf16 v[20:23], a[88:91], a[232:235], v[20:23]
  v_mfma_f32_16x16x32_bf16 v[24:27], a[88:91], a[236:239], v[24:27]
  v_mfma_f32_16x16x32_bf16 v[24:27], a[108:111], a[220:223], v[24:27]
  v_mfma_f32_16x16x32_bf16 v[28:31], a[108:111], a[224:227], v[28:31]
  v_mfma_f32_16x16x32_bf16 v[28:31], a[88:91], a[240:243], v[28:31]
  v_mfma_f32_16x16x32_bf16 v[32:35], a[92:95], a[184:187], v[32:35]
  v_mfma_f32_16x16x32_bf16 v[32:35], a[112:115], a[212:215], v[32:35]
  v_mfma_f32_16x16x32_bf16 v[36:39], a[112:115], a[216:219], v[36:39]
  v_mfma_f32_16x16x32_bf16 v[36:39], a[92:95], a[232:235], v[36:39]
  v_mfma_f32_16x16x32_bf16 v[40:43], a[92:95], a[236:239], v[40:43]
  v_mfma_f32_16x16x32_bf16 v[40:43], a[112:115], a[220:223], v[40:43]
  v_mfma_f32_16x16x32_bf16 v[44:47], a[112:115], a[224:227], v[44:47]
  v_mfma_f32_16x16x32_bf16 v[44:47], a[92:95], a[240:243], v[44:47]
  v_mfma_f32_16x16x32_bf16 v[48:51], a[96:99], a[184:187], v[48:51]
  v_mfma_f32_16x16x32_bf16 v[48:51], a[116:119], a[212:215], v[48:51]
  v_mfma_f32_16x16x32_bf16 v[52:55], a[116:119], a[216:219], v[52:55]
  v_mfma_f32_16x16x32_bf16 v[52:55], a[96:99], a[232:235], v[52:55]
  v_mfma_f32_16x16x32_bf16 v[56:59], a[96:99], a[236:239], v[56:59]
  v_mfma_f32_16x16x32_bf16 v[56:59], a[116:119], a[220:223], v[56:59]
  v_mfma_f32_16x16x32_bf16 v[60:63], a[116:119], a[224:227], v[60:63]
  v_mfma_f32_16x16x32_bf16 v[60:63], a[96:99], a[240:243], v[60:63]
  v_mfma_f32_16x16x32_bf16 v[64:67], a[100:103], a[184:187], v[64:67]
  ds_read_b128 v[216:219], v122 offset:0
  v_mfma_f32_16x16x32_bf16 v[64:67], a[120:123], a[212:215], v[64:67]
  v_mfma_f32_16x16x32_bf16 v[68:71], a[120:123], a[216:219], v[68:71]
  v_mfma_f32_16x16x32_bf16 v[68:71], a[100:103], a[232:235], v[68:71]
  v_mfma_f32_16x16x32_bf16 v[72:75], a[100:103], a[236:239], v[72:75]
  v_mfma_f32_16x16x32_bf16 v[72:75], a[120:123], a[220:223], v[72:75]
  v_mfma_f32_16x16x32_bf16 v[76:79], a[120:123], a[224:227], v[76:79]
  v_mfma_f32_16x16x32_bf16 v[76:79], a[100:103], a[240:243], v[76:79]
  s_waitcnt vmcnt(17)
  v_mfma_f32_16x16x32_bf16 v[0:3], a[124:127], a[244:247], v[0:3]
  ds_read_b128 v[228:231], v122 offset:1024
  buffer_load_dword v128, v133, s[24:27], 0 offen sc1
  s_xor_b32 s38, s40, 0
  s_lshl_b32 s38, s38, 2
  s_add_u32 s38, s38, s3
  v_mfma_f32_16x16x32_bf16 v[0:3], a[176:179], a[228:231], v[0:3]
  s_lshl_b32 s38, s38, 13
  s_add_u32 s38, s38, 25165824
  s_add_u32 s39, s38, 4096
  v_mfma_f32_16x16x32_bf16 v[4:7], a[176:179], a[196:199], v[4:7]
  v_mfma_f32_16x16x32_bf16 v[4:7], a[124:127], a[248:251], v[4:7]
  v_mfma_f32_16x16x32_bf16 v[8:11], a[124:127], a[200:203], v[8:11]
  v_mfma_f32_16x16x32_bf16 v[8:11], a[176:179], a[208:211], v[8:11]
  v_mfma_f32_16x16x32_bf16 v[12:15], a[176:179], v[188:191], v[12:15]
  v_mfma_f32_16x16x32_bf16 v[12:15], a[124:127], v[184:187], v[12:15]
  s_waitcnt lgkmcnt(1)
  v_mfma_f32_16x16x32_bf16 v[16:19], a[160:163], a[244:247], v[16:19]
  ds_read_b128 v[232:235], v122 offset:2048
  v_mfma_f32_16x16x32_bf16 v[16:19], v[216:219], a[228:231], v[16:19]
  v_mfma_f32_16x16x32_bf16 v[20:23], v[216:219], a[196:199], v[20:23]
  v_mfma_f32_16x16x32_bf16 v[20:23], a[160:163], a[248:251], v[20:23]
  v_mfma_f32_16x16x32_bf16 v[24:27], a[160:163], a[200:203], v[24:27]
  v_mfma_f32_16x16x32_bf16 v[24:27], v[216:219], a[208:211], v[24:27]
  v_mfma_f32_16x16x32_bf16 v[28:31], v[216:219], v[188:191], v[28:31]
  v_mfma_f32_16x16x32_bf16 v[28:31], a[160:163], v[184:187], v[28:31]
  s_waitcnt lgkmcnt(1)
  v_mfma_f32_16x16x32_bf16 v[32:35], a[164:167], a[244:247], v[32:35]
  ds_read_b128 a[192:195], v122 offset:3072
  v_mfma_f32_16x16x32_bf16 v[32:35], v[228:231], a[228:231], v[32:35]
  v_mfma_f32_16x16x32_bf16 v[36:39], v[228:231], a[196:199], v[36:39]
  v_mfma_f32_16x16x32_bf16 v[36:39], a[164:167], a[248:251], v[36:39]
  v_mfma_f32_16x16x32_bf16 v[40:43], a[164:167], a[200:203], v[40:43]
  v_mfma_f32_16x16x32_bf16 v[40:43], v[228:231], a[208:211], v[40:43]
  v_mfma_f32_16x16x32_bf16 v[44:47], v[228:231], v[188:191], v[44:47]
  v_mfma_f32_16x16x32_bf16 v[44:47], a[164:167], v[184:187], v[44:47]
  s_waitcnt lgkmcnt(1)
  v_mfma_f32_16x16x32_bf16 v[48:51], a[168:171], a[244:247], v[48:51]
  ds_read_b128 a[4:7], v122 offset:16384
  ds_read_b128 a[24:27], v122 offset:33792
  v_mfma_f32_16x16x32_bf16 v[48:51], v[232:235], a[228:231], v[48:51]
  v_mfma_f32_16x16x32_bf16 v[52:55], v[232:235], a[196:199], v[52:55]
  v_mfma_f32_16x16x32_bf16 v[52:55], a[168:171], a[248:251], v[52:55]
  v_mfma_f32_16x16x32_bf16 v[56:59], a[168:171], a[200:203], v[56:59]
  v_mfma_f32_16x16x32_bf16 v[56:59], v[232:235], a[208:211], v[56:59]
  v_mfma_f32_16x16x32_bf16 v[60:63], v[232:235], v[188:191], v[60:63]
  v_mfma_f32_16x16x32_bf16 v[60:63], a[168:171], v[184:187], v[60:63]
  s_waitcnt lgkmcnt(2)
  v_mfma_f32_16x16x32_bf16 v[64:67], a[172:175], a[244:247], v[64:67]
  ds_read_b128 a[8:11], v122 offset:17408
  ds_read_b128 a[28:31], v122 offset:34816
  v_mfma_f32_16x16x32_bf16 v[64:67], a[192:195], a[228:231], v[64:67]
  v_mfma_f32_16x16x32_bf16 v[68:71], a[192:195], a[196:199], v[68:71]
  v_mfma_f32_16x16x32_bf16 v[68:71], a[172:175], a[248:251], v[68:71]
  v_mfma_f32_16x16x32_bf16 v[72:75], a[172:175], a[200:203], v[72:75]
  v_mfma_f32_16x16x32_bf16 v[72:75], a[192:195], a[208:211], v[72:75]
  v_mfma_f32_16x16x32_bf16 v[76:79], a[192:195], v[188:191], v[76:79]
  v_mfma_f32_16x16x32_bf16 v[76:79], a[172:175], v[184:187], v[76:79]
  s_waitcnt vmcnt(10) lgkmcnt(2)
  v_mfma_f32_16x16x32_bf16 v[0:3], a[4:7], v[200:203], v[0:3]
  ds_read_b128 a[12:15], v122 offset:18432
  ds_read_b128 a[32:35], v122 offset:35840
  v_mfma_f32_16x16x32_bf16 v[0:3], a[24:27], a[188:191], v[0:3]
  v_mfma_f32_16x16x32_bf16 v[4:7], a[24:27], a[144:147], v[4:7]
  v_mfma_f32_16x16x32_bf16 v[4:7], a[4:7], a[252:255], v[4:7]
  v_mfma_f32_16x16x32_bf16 v[8:11], a[4:7], a[128:131], v[8:11]
  v_mfma_f32_16x16x32_bf16 v[8:11], a[24:27], a[148:151], v[8:11]
  v_mfma_f32_16x16x32_bf16 v[12:15], a[24:27], a[152:155], v[12:15]
  v_mfma_f32_16x16x32_bf16 v[12:15], a[4:7], a[132:135], v[12:15]
  s_waitcnt lgkmcnt(2)
  v_mfma_f32_16x16x32_bf16 v[16:19], a[8:11], v[200:203], v[16:19]
  ds_read_b128 a[16:19], v122 offset:19456
  ds_read_b128 a[36:39], v135 offset:0
  v_mfma_f32_16x16x32_bf16 v[16:19], a[28:31], a[188:191], v[16:19]
  v_mfma_f32_16x16x32_bf16 v[20:23], a[28:31], a[144:147], v[20:23]
  v_mfma_f32_16x16x32_bf16 v[20:23], a[8:11], a[252:255], v[20:23]
  v_mfma_f32_16x16x32_bf16 v[24:27], a[8:11], a[128:131], v[24:27]
  v_mfma_f32_16x16x32_bf16 v[24:27], a[28:31], a[148:151], v[24:27]
  v_mfma_f32_16x16x32_bf16 v[28:31], a[28:31], a[152:155], v[28:31]
  v_mfma_f32_16x16x32_bf16 v[28:31], a[8:11], a[132:135], v[28:31]
  s_waitcnt lgkmcnt(2)
  v_mfma_f32_16x16x32_bf16 v[32:35], a[12:15], v[200:203], v[32:35]
  ds_read_b128 a[20:23], v122 offset:32768
  ds_read_b128 a[40:43], v135 offset:1024
  v_mfma_f32_16x16x32_bf16 v[32:35], a[32:35], a[188:191], v[32:35]
  v_mfma_f32_16x16x32_bf16 v[36:39], a[32:35], a[144:147], v[36:39]
  v_mfma_f32_16x16x32_bf16 v[36:39], a[12:15], a[252:255], v[36:39]
  v_mfma_f32_16x16x32_bf16 v[40:43], a[12:15], a[128:131], v[40:43]
  v_mfma_f32_16x16x32_bf16 v[40:43], a[32:35], a[148:151], v[40:43]
  v_mfma_f32_16x16x32_bf16 v[44:47], a[32:35], a[152:155], v[44:47]
  v_mfma_f32_16x16x32_bf16 v[44:47], a[12:15], a[132:135], v[44:47]
  s_waitcnt lgkmcnt(2)
  v_mfma_f32_16x16x32_bf16 v[48:51], a[16:19], v[200:203], v[48:51]
  ds_read_b128 a[204:207], v135 offset:2048
  ds_read_b128 v[248:251], v135 offset:19456
  v_mfma_f32_16x16x32_bf16 v[48:51], a[36:39], a[188:191], v[48:51]
  v_mfma_f32_16x16x32_bf16 v[52:55], a[36:39], a[144:147], v[52:55]
  v_mfma_f32_16x16x32_bf16 v[52:55], a[16:19], a[252:255], v[52:55]
  v_mfma_f32_16x16x32_bf16 v[56:59], a[16:19], a[128:131], v[56:59]
  v_mfma_f32_16x16x32_bf16 v[56:59], a[36:39], a[148:151], v[56:59]
  v_mfma_f32_16x16x32_bf16 v[60:63], a[36:39], a[152:155], v[60:63]
  v_mfma_f32_16x16x32_bf16 v[60:63], a[16:19], a[132:135], v[60:63]
  s_waitcnt lgkmcnt(2)
  v_mfma_f32_16x16x32_bf16 v[64:67], a[20:23], v[200:203], v[64:67]
  ds_read_b128 v[176:179], v135 offset:3072
  ds_read_b128 v[180:183], v122 offset:49152
  v_mfma_f32_16x16x32_bf16 v[64:67], a[40:43], a[188:191], v[64:67]
  v_mfma_f32_16x16x32_bf16 v[68:71], a[40:43], a[144:147], v[68:71]
  v_mfma_f32_16x16x32_bf16 v[68:71], a[20:23], a[252:255], v[68:71]
  v_mfma_f32_16x16x32_bf16 v[72:75], a[20:23], a[128:131], v[72:75]
  v_mfma_f32_16x16x32_bf16 v[72:75], a[40:43], a[148:151], v[72:75]
  v_mfma_f32_16x16x32_bf16 v[76:79], a[40:43], a[152:155], v[76:79]
  v_mfma_f32_16x16x32_bf16 v[76:79], a[20:23], a[132:135], v[76:79]
  s_waitcnt vmcnt(0)
  v_cmp_lt_u32 vcc, v128, v134
  s_nop 0
  s_cbranch_vccz tail_partner
  s_mov_b32 s35, 32768
tail_spin2:
  s_sleep 2
  buffer_load_dword v128, v133, s[24:27], 0 offen sc1
  s_waitcnt vmcnt(0)
  v_cmp_lt_u32 vcc, v128, v134
  s_nop 0
  s_cbranch_vccz tail_partner
  s_sub_u32 s35, s35, 1
  s_cmp_lg_u32 s35, 0
  s_cbranch_scc1 tail_spin2
tail_partner:
  s_waitcnt lgkmcnt(2)
  v_mfma_f32_16x16x32_bf16 v[0:3], a[204:207], a[136:139], v[0:3]
  ds_read_b128 v[204:207], v135 offset:16384
  ds_read_b128 v[208:211], v122 offset:50176
  v_mfma_f32_16x16x32_bf16 v[0:3], v[248:251], a[156:159], v[0:3]
  buffer_load_dwordx2 v[138:139], v125, s[24:27], s38 offen offset:0 sc1
  v_mfma_f32_16x16x32_bf16 v[4:7], v[248:251], a[0:3], v[4:7]
  buffer_load_dwordx2 v[142:143], v125, s[24:27], s38 offen offset:512 sc1
  v_mfma_f32_16x16x32_bf16 v[4:7], a[204:207], a[140:143], v[4:7]
  buffer_load_dwordx2 v[146:147], v125, s[24:27], s38 offen offset:1024 sc1
  v_mfma_f32_16x16x32_bf16 v[8:11], a[204:207], v[236:239], v[8:11]
  buffer_load_dwordx2 v[150:151], v125, s[24:27], s38 offen offset:1536 sc1
  v_mfma_f32_16x16x32_bf16 v[8:11], v[248:251], v[192:195], v[8:11]
  buffer_load_dwordx2 v[154:155], v125, s[24:27], s38 offen offset:2048 sc1
  v_mfma_f32_16x16x32_bf16 v[12:15], v[248:251], v[212:215], v[12:15]
  v_mfma_f32_16x16x32_bf16 v[12:15], a[204:207], v[196:199], v[12:15]
  s_waitcnt lgkmcnt(2)
  v_mfma_f32_16x16x32_bf16 v[16:19], v[176:179], a[136:139], v[16:19]
  ds_read_b128 v[220:223], v135 offset:17408
  ds_read_b128 a[44:47], v122 offset:51200
  v_mfma_f32_16x16x32_bf16 v[16:19], v[180:183], a[156:159], v[16:19]
  ds_write_b128 v122, v[4:7] offset:0
  ds_write_b128 v122, v[8:11] offset:17408
  v_mfma_f32_16x16x32_bf16 v[20:23], v[180:183], a[0:3], v[20:23]
  ds_write_b128 v122, v[12:15] offset:34816
  v_mfma_f32_16x16x32_bf16 v[20:23], v[176:179], a[140:143], v[20:23]
  v_mfma_f32_16x16x32_bf16 v[24:27], v[176:179], v[236:239], v[24:27]
  v_mfma_f32_16x16x32_bf16 v[24:27], v[180:183], v[192:195], v[24:27]
  v_mfma_f32_16x16x32_bf16 v[28:31], v[180:183], v[212:215], v[28:31]
  v_mfma_f32_16x16x32_bf16 v[28:31], v[176:179], v[196:199], v[28:31]
  s_waitcnt lgkmcnt(5)
  v_mfma_f32_16x16x32_bf16 v[32:35], v[204:207], a[136:139], v[32:35]
  ds_read_b128 a[64:67], v135 offset:18432
  ds_read_b128 a[48:51], v122 offset:52224
  v_mfma_f32_16x16x32_bf16 v[32:35], v[208:211], a[156:159], v[32:35]
  ds_write_b128 v122, v[20:23] offset:1024
  ds_write_b128 v122, v[24:27] offset:18432
  v_mfma_f32_16x16x32_bf16 v[36:39], v[208:211], a[0:3], v[36:39]
  ds_write_b128 v122, v[28:31] offset:35840
  v_mfma_f32_16x16x32_bf16 v[36:39], v[204:207], a[140:143], v[36:39]
  v_mfma_f32_16x16x32_bf16 v[40:43], v[204:207], v[236:239], v[40:43]
  v_mfma_f32_16x16x32_bf16 v[40:43], v[208:211], v[192:195], v[40:43]
  v_mfma_f32_16x16x32_bf16 v[44:47], v[208:211], v[212:215], v[44:47]
  v_mfma_f32_16x16x32_bf16 v[44:47], v[204:207], v[196:199], v[44:47]
  s_waitcnt lgkmcnt(8)
  v_mfma_f32_16x16x32_bf16 v[48:51], v[220:223], a[136:139], v[48:51]
  v_mfma_f32_16x16x32_bf16 v[48:51], a[44:47], a[156:159], v[48:51]
  v_mfma_f32_16x16x32_bf16 v[52:55], a[44:47], a[0:3], v[52:55]
  ds_write_b128 v122, v[36:39] offset:2048
  v_mfma_f32_16x16x32_bf16 v[52:55], v[220:223], a[140:143], v[52:55]
  ds_write_b128 v122, v[40:43] offset:19456
  v_mfma_f32_16x16x32_bf16 v[56:59], v[220:223], v[236:239], v[56:59]
  ds_write_b128 v122, v[44:47] offset:49152
  v_mfma_f32_16x16x32_bf16 v[56:59], a[44:47], v[192:195], v[56:59]
  v_mfma_f32_16x16x32_bf16 v[60:63], a[44:47], v[212:215], v[60:63]
  v_mfma_f32_16x16x32_bf16 v[60:63], v[220:223], v[196:199], v[60:63]
  s_waitcnt lgkmcnt(6)
  v_mfma_f32_16x16x32_bf16 v[64:67], a[64:67], a[136:139], v[64:67]
  ds_write_b128 v122, v[52:55] offset:3072
  v_mfma_f32_16x16x32_bf16 v[64:67], a[48:51], a[156:159], v[64:67]
  v_mfma_f32_16x16x32_bf16 v[68:71], a[48:51], a[0:3], v[68:71]
  v_mfma_f32_16x16x32_bf16 v[68:71], a[64:67], a[140:143], v[68:71]
  ds_write_b128 v122, v[56:59] offset:32768
  v_mfma_f32_16x16x32_bf16 v[72:75], a[64:67], v[236:239], v[72:75]
  ds_write_b128 v122, v[60:63] offset:50176
  v_mfma_f32_16x16x32_bf16 v[72:75], a[48:51], v[192:195], v[72:75]
  v_mfma_f32_16x16x32_bf16 v[76:79], a[48:51], v[212:215], v[76:79]
  v_mfma_f32_16x16x32_bf16 v[76:79], a[64:67], v[196:199], v[76:79]
  s_nop 1
  ds_write_b128 v122, v[68:71] offset:16384
  s_nop 2
  ds_write_b128 v122, v[72:75] offset:33792
  s_nop 0
  ds_write_b128 v122, v[76:79] offset:51200
  s_waitcnt lgkmcnt(0)
  s_barrier
  ds_read_b128 v[4:7], v80 offset:0
  ds_read_b128 v[8:11], v81 offset:17408
  ds_read_b128 v[12:15], v82 offset:34816
  ds_read_b128 v[20:23], v80 offset:1024
  ds_read_b128 v[24:27], v81 offset:18432
  ds_read_b128 v[28:31], v82 offset:35840
  ds_read_b128 v[36:39], v80 offset:2048
  ds_read_b128 v[40:43], v81 offset:19456
  ds_read_b128 v[44:47], v82 offset:49152
  ds_read_b128 v[52:55], v80 offset:3072
  ds_read_b128 v[56:59], v81 offset:32768
  ds_read_b128 v[60:63], v82 offset:50176
  ds_read_b128 v[68:71], v80 offset:16384
  ds_read_b128 v[72:75], v81 offset:33792
  ds_read_b128 v[76:79], v82 offset:51200
  s_waitcnt vmcnt(4)
  v_lshlrev_b32 v136, 16, v138
  v_and_b32 v137, s34, v138
  v_lshlrev_b32 v138, 16, v139
  v_and_b32 v139, s34, v139
  v_add_f32 v0, v0, v136
  v_add_f32 v1, v1, v137
  v_add_f32 v2, v2, v138
  v_add_f32 v3, v3, v139
  s_waitcnt lgkmcnt(13)
  v_add_f32 v4, v4, v8
  v_add_f32 v5, v5, v9
  v_add_f32 v6, v6, v10
  v_add_f32 v7, v7, v11
  s_waitcnt lgkmcnt(12)
  v_add_f32 v0, v0, v12
  v_add_f32 v1, v1, v13
  v_add_f32 v2, v2, v14
  v_add_f32 v3, v3, v15
  v_add_f32 v0, v0, v4
  v_add_f32 v1, v1, v5
  v_add_f32 v2, v2, v6
  v_add_f32 v3, v3, v7
  v_cvt_pk_bf16_f32 v4, v0, v1
  v_cvt_pk_bf16_f32 v5, v2, v3
  v_lshlrev_b32 v0, 16, v4
  v_and_b32 v1, s34, v4
  v_lshlrev_b32 v2, 16, v5
  v_and_b32 v3, s34, v5
  v_mul_f32 v0, v0, v90
  v_mul_f32 v1, v1, v91
  v_mul_f32 v2, v2, v92
  v_mul_f32 v3, v3, v93
  v_cvt_pk_bf16_f32 v4, v0, v1
  v_cvt_pk_bf16_f32 v5, v2, v3
  v_lshlrev_b32 v0, 16, v4
  v_and_b32 v1, s34, v4
  v_lshlrev_b32 v2, 16, v5
  v_and_b32 v3, s34, v5
  v_add_f32 v0, v0, v156
  v_add_f32 v1, v1, v157
  v_add_f32 v2, v2, v158
  v_add_f32 v3, v3, v159
  v_cvt_pk_bf16_f32 v4, v0, v1
  v_cvt_pk_bf16_f32 v5, v2, v3
  s_waitcnt vmcnt(3)
  v_lshlrev_b32 v140, 16, v142
  v_and_b32 v141, s34, v142
  v_lshlrev_b32 v142, 16, v143
  v_and_b32 v143, s34, v143
  v_add_f32 v16, v16, v140
  v_add_f32 v17, v17, v141
  v_add_f32 v18, v18, v142
  v_add_f32 v19, v19, v143
  s_waitcnt lgkmcnt(10)
  v_add_f32 v20, v20, v24
  v_add_f32 v21, v21, v25
  v_add_f32 v22, v22, v26
  v_add_f32 v23, v23, v27
  s_waitcnt lgkmcnt(9)
  v_add_f32 v16, v16, v28
  v_add_f32 v17, v17, v29
  v_add_f32 v18, v18, v30
  v_add_f32 v19, v19, v31
  v_add_f32 v16, v16, v20
  v_add_f32 v17, v17, v21
  v_add_f32 v18, v18, v22
  v_add_f32 v19, v19, v23
  v_cvt_pk_bf16_f32 v20, v16, v17
  v_cvt_pk_bf16_f32 v21, v18, v19
  v_lshlrev_b32 v16, 16, v20
  v_and_b32 v17, s34, v20
  v_lshlrev_b32 v18, 16, v21
  v_and_b32 v19, s34, v21
  v_mul_f32 v16, v16, v94
  v_mul_f32 v17, v17, v95
  v_mul_f32 v18, v18, v96
  v_mul_f32 v19, v19, v97
  v_cvt_pk_bf16_f32 v20, v16, v17
  v_cvt_pk_bf16_f32 v21, v18, v19
  v_lshlrev_b32 v16, 16, v20
  v_and_b32 v17, s34, v20
  v_lshlrev_b32 v18, 16, v21
  v_and_b32 v19, s34, v21
  v_add_f32 v16, v16, v160
  v_add_f32 v17, v17, v161
  v_add_f32 v18, v18, v162
  v_add_f32 v19, v19, v163
  v_cvt_pk_bf16_f32 v6, v16, v17
  v_cvt_pk_bf16_f32 v7, v18, v19
  s_nop 0
  v_permlane16_swap_b32 v4, v6
  v_permlane16_swap_b32 v5, v7
  buffer_store_dwordx4 v[4:7], v83, s[16:19], 0 offen offset:0
  s_waitcnt vmcnt(3)
  v_lshlrev_b32 v144, 16, v146
  v_and_b32 v145, s34, v146
  v_lshlrev_b32 v146, 16, v147
  v_and_b32 v147, s34, v147
  v_add_f32 v32, v32, v144
  v_add_f32 v33, v33, v145
  v_add_f32 v34, v34, v146
  v_add_f32 v35, v35, v147
  s_waitcnt lgkmcnt(7)
  v_add_f32 v36, v36, v40
  v_add_f32 v37, v37, v41
  v_add_f32 v38, v38, v42
  v_add_f32 v39, v39, v43
  s_waitcnt lgkmcnt(6)
  v_add_f32 v32, v32, v44
  v_add_f32 v33, v33, v45
  v_add_f32 v34, v34, v46
  v_add_f32 v35, v35, v47
  v_add_f32 v32, v32, v36
  v_add_f32 v33, v33, v37
  v_add_f32 v34, v34, v38
  v_add_f32 v35, v35, v39
  v_cvt_pk_bf16_f32 v36, v32, v33
  v_cvt_pk_bf16_f32 v37, v34, v35
  v_lshlrev_b32 v32, 16, v36
  v_and_b32 v33, s34, v36
  v_lshlrev_b32 v34, 16, v37
  v_and_b32 v35, s34, v37
  v_mul_f32 v32, v32, v98
  v_mul_f32 v33, v33, v99
  v_mul_f32 v34, v34, v100
  v_mul_f32 v35, v35, v101
  v_cvt_pk_bf16_f32 v36, v32, v33
  v_cvt_pk_bf16_f32 v37, v34, v35
  v_lshlrev_b32 v32, 16, v36
  v_and_b32 v33, s34, v36
  v_lshlrev_b32 v34, 16, v37
  v_and_b32 v35, s34, v37
  v_add_f32 v32, v32, v164
  v_add_f32 v33, v33, v165
  v_add_f32 v34, v34, v166
  v_add_f32 v35, v35, v167
  v_cvt_pk_bf16_f32 v36, v32, v33
  v_cvt_pk_bf16_f32 v37, v34, v35
  s_waitcnt vmcnt(2)
  v_lshlrev_b32 v148, 16, v150
  v_and_b32 v149, s34, v150
  v_lshlrev_b32 v150, 16, v151
  v_and_b32 v151, s34, v151
  v_add_f32 v48, v48, v148
  v_add_f32 v49, v49, v149
  v_add_f32 v50, v50, v150
  v_add_f32 v51, v51, v151
  s_waitcnt lgkmcnt(4)
  v_add_f32 v52, v52, v56
  v_add_f32 v53, v53, v57
  v_add_f32 v54, v54, v58
  v_add_f32 v55, v55, v59
  s_waitcnt lgkmcnt(3)
  v_add_f32 v48, v48, v60
  v_add_f32 v49, v49, v61
  v_add_f32 v50, v50, v62
  v_add_f32 v51, v51, v63
  v_add_f32 v48, v48, v52
  v_add_f32 v49, v49, v53
  v_add_f32 v50, v50, v54
  v_add_f32 v51, v51, v55
  v_cvt_pk_bf16_f32 v52, v48, v49
  v_cvt_pk_bf16_f32 v53, v50, v51
  v_lshlrev_b32 v48, 16, v52
  v_and_b32 v49, s34, v52
  v_lshlrev_b32 v50, 16, v53
  v_and_b32 v51, s34, v53
  v_mul_f32 v48, v48, v102
  v_mul_f32 v49, v49, v103
  v_mul_f32 v50, v50, v104
  v_mul_f32 v51, v51, v105
  v_cvt_pk_bf16_f32 v52, v48, v49
  v_cvt_pk_bf16_f32 v53, v50, v51
  v_lshlrev_b32 v48, 16, v52
  v_and_b32 v49, s34, v52
  v_lshlrev_b32 v50, 16, v53
  v_and_b32 v51, s34, v53
  v_add_f32 v48, v48, v168
  v_add_f32 v49, v49, v169
  v_add_f32 v50, v50, v170
  v_add_f32 v51, v51, v171
  v_cvt_pk_bf16_f32 v38, v48, v49
  v_cvt_pk_bf16_f32 v39, v50, v51
  s_nop 0
  v_permlane16_swap_b32 v36, v38
  v_permlane16_swap_b32 v37, v39
  buffer_store_dwordx4 v[36:39], v83, s[16:19], 0 offen offset:64
  s_waitcnt vmcnt(2)
  v_lshlrev_b32 v152, 16, v154
  v_and_b32 v153, s34, v154
  v_lshlrev_b32 v154, 16, v155
  v_and_b32 v155, s34, v155
  v_add_f32 v64, v64, v152
  v_add_f32 v65, v65, v153
  v_add_f32 v66, v66, v154
  v_add_f32 v67, v67, v155
  s_waitcnt lgkmcnt(1)
  v_add_f32 v68, v68, v72
  v_add_f32 v69, v69, v73
  v_add_f32 v70, v70, v74
  v_add_f32 v71, v71, v75
  s_waitcnt lgkmcnt(0)
  v_add_f32 v64, v64, v76
  v_add_f32 v65, v65, v77
  v_add_f32 v66, v66, v78
  v_add_f32 v67, v67, v79
  v_add_f32 v64, v64, v68
  v_add_f32 v65, v65, v69
  v_add_f32 v66, v66, v70
  v_add_f32 v67, v67, v71
  v_cvt_pk_bf16_f32 v68, v64, v65
  v_cvt_pk_bf16_f32 v69, v66, v67
  v_lshlrev_b32 v64, 16, v68
  v_and_b32 v65, s34, v68
  v_lshlrev_b32 v66, 16, v69
  v_and_b32 v67, s34, v69
  v_mul_f32 v64, v64, v106
  v_mul_f32 v65, v65, v107
  v_mul_f32 v66, v66, v108
  v_mul_f32 v67, v67, v109
  v_cvt_pk_bf16_f32 v68, v64, v65
  v_cvt_pk_bf16_f32 v69, v66, v67
  v_lshlrev_b32 v64, 16, v68
  v_and_b32 v65, s34, v68
  v_lshlrev_b32 v66, 16, v69
  v_and_b32 v67, s34, v69
  v_add_f32 v64, v64, v172
  v_add_f32 v65, v65, v173
  v_add_f32 v66, v66, v174
  v_add_f32 v67, v67, v175
  v_cvt_pk_bf16_f32 v68, v64, v65
  v_cvt_pk_bf16_f32 v69, v66, v67
  buffer_store_dwordx2 v[68:69], v117, s[16:19], 0 offen offset:128
attn_end:
  s_endpgm
attn_redo:
  s_waitcnt vmcnt(0)
  v_accvgpr_write_b32 a0, 0
  v_accvgpr_write_b32 a1, 0
  v_accvgpr_write_b32 a2, 0
  v_accvgpr_write_b32 a3, 0
  v_accvgpr_write_b32 a4, 0
  v_accvgpr_write_b32 a5, 0
  v_accvgpr_write_b32 a6, 0
  v_accvgpr_write_b32 a7, 0
  v_accvgpr_write_b32 a8, 0
  v_accvgpr_write_b32 a9, 0
  v_accvgpr_write_b32 a10, 0
  v_accvgpr_write_b32 a11, 0
  v_accvgpr_write_b32 a12, 0
  v_accvgpr_write_b32 a13, 0
  v_accvgpr_write_b32 a14, 0
  v_accvgpr_write_b32 a15, 0
  v_accvgpr_write_b32 a16, 0
  v_accvgpr_write_b32 a17, 0
  v_accvgpr_write_b32 a18, 0
  v_accvgpr_write_b32 a19, 0
  v_accvgpr_write_b32 a20, 0
  v_accvgpr_write_b32 a21, 0
  v_accvgpr_write_b32 a22, 0
  v_accvgpr_write_b32 a23, 0
  v_accvgpr_write_b32 a24, 0
  v_accvgpr_write_b32 a25, 0
  v_accvgpr_write_b32 a26, 0
  v_accvgpr_write_b32 a27, 0
  v_accvgpr_write_b32 a28, 0
  v_accvgpr_write_b32 a29, 0
  v_accvgpr_write_b32 a30, 0
  v_accvgpr_write_b32 a31, 0
  v_accvgpr_write_b32 a32, 0
  v_accvgpr_write_b32 a33, 0
  v_accvgpr_write_b32 a34, 0
  v_accvgpr_write_b32 a35, 0
  v_accvgpr_write_b32 a36, 0
  v_accvgpr_write_b32 a37, 0
  v_accvgpr_write_b32 a38, 0
  v_accvgpr_write_b32 a39, 0
  v_accvgpr_write_b32 a40, 0
  v_accvgpr_write_b32 a41, 0
  v_accvgpr_write_b32 a42, 0
  v_accvgpr_write_b32 a43, 0
  v_accvgpr_write_b32 a44, 0
  v_accvgpr_write_b32 a45, 0
  v_accvgpr_write_b32 a46, 0
  v_accvgpr_write_b32 a47, 0
  v_accvgpr_write_b32 a48, 0
  v_accvgpr_write_b32 a49, 0
  v_accvgpr_write_b32 a50, 0
  v_accvgpr_write_b32 a51, 0
  v_accvgpr_write_b32 a52, 0
  v_accvgpr_write_b32 a53, 0
  v_accvgpr_write_b32 a54, 0
  v_accvgpr_write_b32 a55, 0
  v_accvgpr_write_b32 a56, 0
  v_accvgpr_write_b32 a57, 0
  v_accvgpr_write_b32 a58, 0
  v_accvgpr_write_b32 a59, 0
  v_accvgpr_write_b32 a60, 0
  v_accvgpr_write_b32 a61, 0
  v_accvgpr_write_b32 a62, 0
  v_accvgpr_write_b32 a63, 0
  v_accvgpr_write_b32 a64, 0
  v_accvgpr_write_b32 a65, 0
  v_accvgpr_write_b32 a66, 0
  v_accvgpr_write_b32 a67, 0
  v_accvgpr_write_b32 a68, 0
  v_accvgpr_write_b32 a69, 0
  v_accvgpr_write_b32 a70, 0
  v_accvgpr_write_b32 a71, 0
  v_accvgpr_write_b32 a72, 0
  v_accvgpr_write_b32 a73, 0
  v_accvgpr_write_b32 a74, 0
  v_accvgpr_write_b32 a75, 0
  v_accvgpr_write_b32 a76, 0
  v_accvgpr_write_b32 a77, 0
  v_accvgpr_write_b32 a78, 0
  v_accvgpr_write_b32 a79, 0
  v_accvgpr_write_b32 a80, 0
  v_accvgpr_write_b32 a81, 0
  v_accvgpr_write_b32 a82, 0
  v_accvgpr_write_b32 a83, 0
  v_accvgpr_write_b32 a84, 0
  v_accvgpr_write_b32 a85, 0
  v_accvgpr_write_b32 a86, 0
  v_accvgpr_write_b32 a87, 0
  v_accvgpr_write_b32 a88, 0
  v_accvgpr_write_b32 a89, 0
  v_accvgpr_write_b32 a90, 0
  v_accvgpr_write_b32 a91, 0
  v_accvgpr_write_b32 a92, 0
  v_accvgpr_write_b32 a93, 0
  v_accvgpr_write_b32 a94, 0
  v_accvgpr_write_b32 a95, 0
  v_accvgpr_write_b32 a96, 0
  v_accvgpr_write_b32 a97, 0
  v_accvgpr_write_b32 a98, 0
  v_accvgpr_write_b32 a99, 0
  v_accvgpr_write_b32 a100, 0
  v_accvgpr_write_b32 a101, 0
  v_accvgpr_write_b32 a102, 0
  v_accvgpr_write_b32 a103, 0
  v_accvgpr_write_b32 a104, 0
  v_accvgpr_write_b32 a105, 0
  v_accvgpr_write_b32 a106, 0
  v_accvgpr_write_b32 a107, 0
  v_accvgpr_write_b32 a108, 0
  v_accvgpr_write_b32 a109, 0
  v_accvgpr_write_b32 a110, 0
  v_accvgpr_write_b32 a111, 0
  v_accvgpr_write_b32 a112, 0
  v_accvgpr_write_b32 a113, 0
  v_accvgpr_write_b32 a114, 0
  v_accvgpr_write_b32 a115, 0
  v_accvgpr_write_b32 a116, 0
  v_accvgpr_write_b32 a117, 0
  v_accvgpr_write_b32 a118, 0
  v_accvgpr_write_b32 a119, 0
  v_accvgpr_write_b32 a120, 0
  v_accvgpr_write_b32 a121, 0
  v_accvgpr_write_b32 a122, 0
  v_accvgpr_write_b32 a123, 0
  v_accvgpr_write_b32 a124, 0
  v_accvgpr_write_b32 a125, 0
  v_accvgpr_write_b32 a126, 0
  v_accvgpr_write_b32 a127, 0
  v_mov_b32 v208, 0
  v_mov_b32 v249, 0xff800000
  v_mov_b32 v209, 0
  v_mov_b32 v250, 0xff800000
  v_mov_b32 v210, 0
  v_mov_b32 v251, 0xff800000
  v_mov_b32 v211, 0
  v_mov_b32 v252, 0xff800000
  s_mov_b32 s29, 0
attn_slow:
  s_barrier
  s_add_u32 m0, s28, 49152
  s_nop 0
  buffer_load_dwordx4 v232, s[12:15], s29 offen offset:0 lds
  buffer_load_dwordx4 v233, s[12:15], s29 offen offset:1024 lds
  buffer_load_dwordx4 v234, s[12:15], s29 offen offset:2048 lds
  buffer_load_dwordx4 v235, s[12:15], s29 offen offset:3072 lds
  s_add_u32 m0, s28, 114688
  s_nop 0
  buffer_load_dwordx4 v236, s[16:19], s29 offen offset:0 lds
  buffer_load_dwordx4 v237, s[16:19], s29 offen offset:1024 lds
  buffer_load_dwordx4 v236, s[16:19], s29 offen offset:2048 lds
  buffer_load_dwordx4 v237, s[16:19], s29 offen offset:3072 lds
  s_waitcnt vmcnt(0)
  s_barrier
  ds_read_b128 a[128:131], v212 offset:49152
  ds_read_b128 a[132:135], v213 offset:49152
  ds_read_b128 a[136:139], v214 offset:49152
  ds_read_b128 a[140:143], v215 offset:49152
  s_waitcnt lgkmcnt(3)
  v_mfma_f32_16x16x32_bf16 v[0:3], a[128:131], v[128:131], 0
  s_waitcnt lgkmcnt(2)
  v_mfma_f32_16x16x32_bf16 v[0:3], a[132:135], v[132:135], v[0:3]
  s_waitcnt lgkmcnt(1)
  v_mfma_f32_16x16x32_bf16 v[0:3], a[136:139], v[136:139], v[0:3]
  s_waitcnt lgkmcnt(0)
  v_mfma_f32_16x16x32_bf16 v[0:3], a[140:143], v[140:143], v[0:3]
  v_mfma_f32_16x16x32_bf16 v[8:11], a[140:143], v[156:159], 0
  v_mfma_f32_16x16x32_bf16 v[8:11], a[136:139], v[152:155], v[8:11]
  v_mfma_f32_16x16x32_bf16 v[8:11], a[132:135], v[148:151], v[8:11]
  v_mfma_f32_16x16x32_bf16 v[8:11], a[128:131], v[144:147], v[8:11]
  v_mfma_f32_16x16x32_bf16 v[16:19], a[128:131], v[160:163], 0
  v_mfma_f32_16x16x32_bf16 v[16:19], a[132:135], v[164:167], v[16:19]
  v_mfma_f32_16x16x32_bf16 v[16:19], a[136:139], v[168:171], v[16:19]
  v_mfma_f32_16x16x32_bf16 v[16:19], a[140:143], v[172:175], v[16:19]
  v_mfma_f32_16x16x32_bf16 v[24:27], a[140:143], v[188:191], 0
  v_mfma_f32_16x16x32_bf16 v[24:27], a[136:139], v[184:187], v[24:27]
  v_mfma_f32_16x16x32_bf16 v[24:27], a[132:135], v[180:183], v[24:27]
  v_mfma_f32_16x16x32_bf16 v[24:27], a[128:131], v[176:179], v[24:27]
  ds_read_b128 a[144:147], v212 offset:53248
  ds_read_b128 a[148:151], v213 offset:53248
  ds_read_b128 a[152:155], v214 offset:53248
  ds_read_b128 a[156:159], v215 offset:53248
  s_waitcnt lgkmcnt(3)
  v_mfma_f32_16x16x32_bf16 v[4:7], a[144:147], v[128:131], 0
  s_waitcnt lgkmcnt(2)
  v_mfma_f32_16x16x32_bf16 v[4:7], a[148:151], v[132:135], v[4:7]
  s_waitcnt lgkmcnt(1)
  v_mfma_f32_16x16x32_bf16 v[4:7], a[152:155], v[136:139], v[4:7]
  s_waitcnt lgkmcnt(0)
  v_mfma_f32_16x16x32_bf16 v[4:7], a[156:159], v[140:143], v[4:7]
  v_mfma_f32_16x16x32_bf16 v[12:15], a[156:159], v[156:159], 0
  v_mfma_f32_16x16x32_bf16 v[12:15], a[152:155], v[152:155], v[12:15]
  v_mfma_f32_16x16x32_bf16 v[12:15], a[148:151], v[148:151], v[12:15]
  v_mfma_f32_16x16x32_bf16 v[12:15], a[144:147], v[144:147], v[12:15]
  v_mfma_f32_16x16x32_bf16 v[20:23], a[144:147], v[160:163], 0
  v_mfma_f32_16x16x32_bf16 v[20:23], a[148:151], v[164:167], v[20:23]
  v_mfma_f32_16x16x32_bf16 v[20:23], a[152:155], v[168:171], v[20:23]
  v_mfma_f32_16x16x32_bf16 v[20:23], a[156:159], v[172:175], v[20:23]
  v_mfma_f32_16x16x32_bf16 v[28:31], a[156:159], v[188:191], 0
  v_mfma_f32_16x16x32_bf16 v[28:31], a[152:155], v[184:187], v[28:31]
  v_mfma_f32_16x16x32_bf16 v[28:31], a[148:151], v[180:183], v[28:31]
  v_mfma_f32_16x16x32_bf16 v[28:31], a[144:147], v[176:179], v[28:31]
  ds_read_b128 a[128:131], v212 offset:57344
  ds_read_b128 a[132:135], v213 offset:57344
  ds_read_b128 a[136:139], v214 offset:57344
  ds_read_b128 a[140:143], v215 offset:57344
  s_waitcnt lgkmcnt(3)
  v_mfma_f32_16x16x32_bf16 v[32:35], a[128:131], v[128:131], 0
  s_waitcnt lgkmcnt(2)
  v_mfma_f32_16x16x32_bf16 v[32:35], a[132:135], v[132:135], v[32:35]
  s_waitcnt lgkmcnt(1)
  v_mfma_f32_16x16x32_bf16 v[32:35], a[136:139], v[136:139], v[32:35]
  s_waitcnt lgkmcnt(0)
  v_mfma_f32_16x16x32_bf16 v[32:35], a[140:143], v[140:143], v[32:35]
  v_mfma_f32_16x16x32_bf16 v[40:43], a[140:143], v[156:159], 0
  v_mfma_f32_16x16x32_bf16 v[40:43], a[136:139], v[152:155], v[40:43]
  v_mfma_f32_16x16x32_bf16 v[40:43], a[132:135], v[148:151], v[40:43]
  v_mfma_f32_16x16x32_bf16 v[40:43], a[128:131], v[144:147], v[40:43]
  v_mfma_f32_16x16x32_bf16 v[48:51], a[128:131], v[160:163], 0
  v_mfma_f32_16x16x32_bf16 v[48:51], a[132:135], v[164:167], v[48:51]
  v_mfma_f32_16x16x32_bf16 v[48:51], a[136:139], v[168:171], v[48:51]
  v_mfma_f32_16x16x32_bf16 v[48:51], a[140:143], v[172:175], v[48:51]
  v_mfma_f32_16x16x32_bf16 v[56:59], a[140:143], v[188:191], 0
  v_mfma_f32_16x16x32_bf16 v[56:59], a[136:139], v[184:187], v[56:59]
  v_mfma_f32_16x16x32_bf16 v[56:59], a[132:135], v[180:183], v[56:59]
  v_mfma_f32_16x16x32_bf16 v[56:59], a[128:131], v[176:179], v[56:59]
  ds_read_b128 a[144:147], v212 offset:61440
  ds_read_b128 a[148:151], v213 offset:61440
  ds_read_b128 a[152:155], v214 offset:61440
  ds_read_b128 a[156:159], v215 offset:61440
  s_waitcnt lgkmcnt(3)
  v_mfma_f32_16x16x32_bf16 v[36:39], a[144:147], v[128:131], 0
  s_waitcnt lgkmcnt(2)
  v_mfma_f32_16x16x32_bf16 v[36:39], a[148:151], v[132:135], v[36:39]
  s_waitcnt lgkmcnt(1)
  v_mfma_f32_16x16x32_bf16 v[36:39], a[152:155], v[136:139], v[36:39]
  s_waitcnt lgkmcnt(0)
  v_mfma_f32_16x16x32_bf16 v[36:39], a[156:159], v[140:143], v[36:39]
  v_mfma_f32_16x16x32_bf16 v[44:47], a[156:159], v[156:159], 0
  v_mfma_f32_16x16x32_bf16 v[44:47], a[152:155], v[152:155], v[44:47]
  v_mfma_f32_16x16x32_bf16 v[44:47], a[148:151], v[148:151], v[44:47]
  v_mfma_f32_16x16x32_bf16 v[44:47], a[144:147], v[144:147], v[44:47]
  v_mfma_f32_16x16x32_bf16 v[52:55], a[144:147], v[160:163], 0
  v_mfma_f32_16x16x32_bf16 v[52:55], a[148:151], v[164:167], v[52:55]
  v_mfma_f32_16x16x32_bf16 v[52:55], a[152:155], v[168:171], v[52:55]
  v_mfma_f32_16x16x32_bf16 v[52:55], a[156:159], v[172:175], v[52:55]
  v_mfma_f32_16x16x32_bf16 v[60:63], a[156:159], v[188:191], 0
  v_mfma_f32_16x16x32_bf16 v[60:63], a[152:155], v[184:187], v[60:63]
  v_mfma_f32_16x16x32_bf16 v[60:63], a[148:151], v[180:183], v[60:63]
  v_mfma_f32_16x16x32_bf16 v[60:63], a[144:147], v[176:179], v[60:63]
  v_mov_b32 v192, v249
  v_max3_f32 v192, v192, v0, v1
  v_max3_f32 v192, v192, v2, v3
  v_max3_f32 v192, v192, v4, v5
  v_max3_f32 v192, v192, v6, v7
  v_max3_f32 v192, v192, v32, v33
  v_max3_f32 v192, v192, v34, v35
  v_max3_f32 v192, v192, v36, v37
  v_max3_f32 v192, v192, v38, v39
  v_mov_b32 v245, v192
  s_nop 1
  v_permlane16_swap_b32 v192, v245
  v_max_f32 v192, v192, v245
  v_mov_b32 v245, v192
  s_nop 1
  v_permlane32_swap_b32 v192, v245
  v_max_f32 v192, v192, v245
  v_sub_f32 v193, v249, v192
  v_exp_f32 v193, v193
  v_mov_b32 v249, v192
  v_mul_f32 v208, v208, v193
  v_sub_f32 v0, v0, v192
  v_sub_f32 v1, v1, v192
  v_sub_f32 v2, v2, v192
  v_sub_f32 v3, v3, v192
  v_sub_f32 v4, v4, v192
  v_sub_f32 v5, v5, v192
  v_sub_f32 v6, v6, v192
  v_sub_f32 v7, v7, v192
  v_sub_f32 v32, v32, v192
  v_sub_f32 v33, v33, v192
  v_sub_f32 v34, v34, v192
  v_sub_f32 v35, v35, v192
  v_sub_f32 v36, v36, v192
  v_sub_f32 v37, v37, v192
  v_sub_f32 v38, v38, v192
  v_sub_f32 v39, v39, v192
  v_exp_f32 v0, v0
  v_exp_f32 v1, v1
  v_add_f32 v208, v208, v0
  v_exp_f32 v2, v2
  v_add_f32 v208, v208, v1
  v_cvt_pk_bf16_f32 v0, v0, v1
  v_exp_f32 v3, v3
  v_add_f32 v208, v208, v2
  v_add_f32 v208, v208, v3
  v_cvt_pk_bf16_f32 v1, v2, v3
  v_exp_f32 v4, v4
  v_exp_f32 v5, v5
  v_add_f32 v208, v208, v4
  v_exp_f32 v6, v6
  v_add_f32 v208, v208, v5
  v_cvt_pk_bf16_f32 v2, v4, v5
  v_exp_f32 v7, v7
  v_add_f32 v208, v208, v6
  v_add_f32 v208, v208, v7
  v_cvt_pk_bf16_f32 v3, v6, v7
  v_exp_f32 v32, v32
  v_exp_f32 v33, v33
  v_add_f32 v208, v208, v32
  v_exp_f32 v34, v34
  v_add_f32 v208, v208, v33
  v_cvt_pk_bf16_f32 v32, v32, v33
  v_exp_f32 v35, v35
  v_add_f32 v208, v208, v34
  v_add_f32 v208, v208, v35
  v_cvt_pk_bf16_f32 v33, v34, v35
  v_exp_f32 v36, v36
  v_exp_f32 v37, v37
  v_add_f32 v208, v208, v36
  v_exp_f32 v38, v38
  v_add_f32 v208, v208, v37
  v_cvt_pk_bf16_f32 v34, v36, v37
  v_exp_f32 v39, v39
  v_add_f32 v208, v208, v38
  v_add_f32 v208, v208, v39
  v_cvt_pk_bf16_f32 v35, v38, v39
  v_accvgpr_read_b32 v64, a0
  v_accvgpr_read_b32 v65, a1
  v_accvgpr_read_b32 v66, a2
  v_accvgpr_read_b32 v67, a3
  v_mul_f32 v64, v64, v193
  v_mul_f32 v65, v65, v193
  v_mul_f32 v66, v66, v193
  v_mul_f32 v67, v67, v193
  v_accvgpr_write_b32 a0, v64
  v_accvgpr_write_b32 a1, v65
  v_accvgpr_write_b32 a2, v66
  v_accvgpr_write_b32 a3, v67
  v_accvgpr_read_b32 v64, a16
  v_accvgpr_read_b32 v65, a17
  v_accvgpr_read_b32 v66, a18
  v_accvgpr_read_b32 v67, a19
  v_mul_f32 v64, v64, v193
  v_mul_f32 v65, v65, v193
  v_mul_f32 v66, v66, v193
  v_mul_f32 v67, v67, v193
  v_accvgpr_write_b32 a16, v64
  v_accvgpr_write_b32 a17, v65
  v_accvgpr_write_b32 a18, v66
  v_accvgpr_write_b32 a19, v67
  v_accvgpr_read_b32 v64, a32
  v_accvgpr_read_b32 v65, a33
  v_accvgpr_read_b32 v66, a34
  v_accvgpr_read_b32 v67, a35
  v_mul_f32 v64, v64, v193
  v_mul_f32 v65, v65, v193
  v_mul_f32 v66, v66, v193
  v_mul_f32 v67, v67, v193
  v_accvgpr_write_b32 a32, v64
  v_accvgpr_write_b32 a33, v65
  v_accvgpr_write_b32 a34, v66
  v_accvgpr_write_b32 a35, v67
  v_accvgpr_read_b32 v64, a48
  v_accvgpr_read_b32 v65, a49
  v_accvgpr_read_b32 v66, a50
  v_accvgpr_read_b32 v67, a51
  v_mul_f32 v64, v64, v193
  v_mul_f32 v65, v65, v193
  v_mul_f32 v66, v66, v193
  v_mul_f32 v67, v67, v193
  v_accvgpr_write_b32 a48, v64
  v_accvgpr_write_b32 a49, v65
  v_accvgpr_write_b32 a50, v66
  v_accvgpr_write_b32 a51, v67
  v_accvgpr_read_b32 v64, a64
  v_accvgpr_read_b32 v65, a65
  v_accvgpr_read_b32 v66, a66
  v_accvgpr_read_b32 v67, a67
  v_mul_f32 v64, v64, v193
  v_mul_f32 v65, v65, v193
  v_mul_f32 v66, v66, v193
  v_mul_f32 v67, v67, v193
  v_accvgpr_write_b32 a64, v64
  v_accvgpr_write_b32 a65, v65
  v_accvgpr_write_b32 a66, v66
  v_accvgpr_write_b32 a67, v67
  v_accvgpr_read_b32 v64, a80
  v_accvgpr_read_b32 v65, a81
  v_accvgpr_read_b32 v66, a82
  v_accvgpr_read_b32 v67, a83
  v_mul_f32 v64, v64, v193
  v_mul_f32 v65, v65, v193
  v_mul_f32 v66, v66, v193
  v_mul_f32 v67, v67, v193
  v_accvgpr_write_b32 a80, v64
  v_accvgpr_write_b32 a81, v65
  v_accvgpr_write_b32 a82, v66
  v_accvgpr_write_b32 a83, v67
  v_accvgpr_read_b32 v64, a96
  v_accvgpr_read_b32 v65, a97
  v_accvgpr_read_b32 v66, a98
  v_accvgpr_read_b32 v67, a99
  v_mul_f32 v64, v64, v193
  v_mul_f32 v65, v65, v193
  v_mul_f32 v66, v66, v193
  v_mul_f32 v67, v67, v193
  v_accvgpr_write_b32 a96, v64
  v_accvgpr_write_b32 a97, v65
  v_accvgpr_write_b32 a98, v66
  v_accvgpr_write_b32 a99, v67
  v_accvgpr_read_b32 v64, a112
  v_accvgpr_read_b32 v65, a113
  v_accvgpr_read_b32 v66, a114
  v_accvgpr_read_b32 v67, a115
  v_mul_f32 v64, v64, v193
  v_mul_f32 v65, v65, v193
  v_mul_f32 v66, v66, v193
  v_mul_f32 v67, v67, v193
  v_accvgpr_write_b32 a112, v64
  v_accvgpr_write_b32 a113, v65
  v_accvgpr_write_b32 a114, v66
  v_accvgpr_write_b32 a115, v67
  v_mov_b32 v196, v250
  v_max3_f32 v196, v196, v8, v9
  v_max3_f32 v196, v196, v10, v11
  v_max3_f32 v196, v196, v12, v13
  v_max3_f32 v196, v196, v14, v15
  v_max3_f32 v196, v196, v40, v41
  v_max3_f32 v196, v196, v42, v43
  v_max3_f32 v196, v196, v44, v45
  v_max3_f32 v196, v196, v46, v47
  v_mov_b32 v245, v196
  s_nop 1
  v_permlane16_swap_b32 v196, v245
  v_max_f32 v196, v196, v245
  v_mov_b32 v245, v196
  s_nop 1
  v_permlane32_swap_b32 v196, v245
  v_max_f32 v196, v196, v245
  v_sub_f32 v197, v250, v196
  v_exp_f32 v197, v197
  v_mov_b32 v250, v196
  v_mul_f32 v209, v209, v197
  v_sub_f32 v8, v8, v196
  v_sub_f32 v9, v9, v196
  v_sub_f32 v10, v10, v196
  v_sub_f32 v11, v11, v196
  v_sub_f32 v12, v12, v196
  v_sub_f32 v13, v13, v196
  v_sub_f32 v14, v14, v196
  v_sub_f32 v15, v15, v196
  v_sub_f32 v40, v40, v196
  v_sub_f32 v41, v41, v196
  v_sub_f32 v42, v42, v196
  v_sub_f32 v43, v43, v196
  v_sub_f32 v44, v44, v196
  v_sub_f32 v45, v45, v196
  v_sub_f32 v46, v46, v196
  v_sub_f32 v47, v47, v196
  v_exp_f32 v8, v8
  v_exp_f32 v9, v9
  v_add_f32 v209, v209, v8
  v_exp_f32 v10, v10
  v_add_f32 v209, v209, v9
  v_cvt_pk_bf16_f32 v8, v8, v9
  v_exp_f32 v11, v11
  v_add_f32 v209, v209, v10
  v_add_f32 v209, v209, v11
  v_cvt_pk_bf16_f32 v9, v10, v11
  v_exp_f32 v12, v12
  v_exp_f32 v13, v13
  v_add_f32 v209, v209, v12
  v_exp_f32 v14, v14
  v_add_f32 v209, v209, v13
  v_cvt_pk_bf16_f32 v10, v12, v13
  v_exp_f32 v15, v15
  v_add_f32 v209, v209, v14
  v_add_f32 v209, v209, v15
  v_cvt_pk_bf16_f32 v11, v14, v15
  v_exp_f32 v40, v40
  v_exp_f32 v41, v41
  v_add_f32 v209, v209, v40
  v_exp_f32 v42, v42
  v_add_f32 v209, v209, v41
  v_cvt_pk_bf16_f32 v40, v40, v41
  v_exp_f32 v43, v43
  v_add_f32 v209, v209, v42
  v_add_f32 v209, v209, v43
  v_cvt_pk_bf16_f32 v41, v42, v43
  v_exp_f32 v44, v44
  v_exp_f32 v45, v45
  v_add_f32 v209, v209, v44
  v_exp_f32 v46, v46
  v_add_f32 v209, v209, v45
  v_cvt_pk_bf16_f32 v42, v44, v45
  v_exp_f32 v47, v47
  v_add_f32 v209, v209, v46
  v_add_f32 v209, v209, v47
  v_cvt_pk_bf16_f32 v43, v46, v47
  v_accvgpr_read_b32 v64, a4
  v_accvgpr_read_b32 v65, a5
  v_accvgpr_read_b32 v66, a6
  v_accvgpr_read_b32 v67, a7
  v_mul_f32 v64, v64, v197
  v_mul_f32 v65, v65, v197
  v_mul_f32 v66, v66, v197
  v_mul_f32 v67, v67, v197
  v_accvgpr_write_b32 a4, v64
  v_accvgpr_write_b32 a5, v65
  v_accvgpr_write_b32 a6, v66
  v_accvgpr_write_b32 a7, v67
  v_accvgpr_read_b32 v64, a20
  v_accvgpr_read_b32 v65, a21
  v_accvgpr_read_b32 v66, a22
  v_accvgpr_read_b32 v67, a23
  v_mul_f32 v64, v64, v197
  v_mul_f32 v65, v65, v197
  v_mul_f32 v66, v66, v197
  v_mul_f32 v67, v67, v197
  v_accvgpr_write_b32 a20, v64
  v_accvgpr_write_b32 a21, v65
  v_accvgpr_write_b32 a22, v66
  v_accvgpr_write_b32 a23, v67
  v_accvgpr_read_b32 v64, a36
  v_accvgpr_read_b32 v65, a37
  v_accvgpr_read_b32 v66, a38
  v_accvgpr_read_b32 v67, a39
  v_mul_f32 v64, v64, v197
  v_mul_f32 v65, v65, v197
  v_mul_f32 v66, v66, v197
  v_mul_f32 v67, v67, v197
  v_accvgpr_write_b32 a36, v64
  v_accvgpr_write_b32 a37, v65
  v_accvgpr_write_b32 a38, v66
  v_accvgpr_write_b32 a39, v67
  v_accvgpr_read_b32 v64, a52
  v_accvgpr_read_b32 v65, a53
  v_accvgpr_read_b32 v66, a54
  v_accvgpr_read_b32 v67, a55
  v_mul_f32 v64, v64, v197
  v_mul_f32 v65, v65, v197
  v_mul_f32 v66, v66, v197
  v_mul_f32 v67, v67, v197
  v_accvgpr_write_b32 a52, v64
  v_accvgpr_write_b32 a53, v65
  v_accvgpr_write_b32 a54, v66
  v_accvgpr_write_b32 a55, v67
  v_accvgpr_read_b32 v64, a68
  v_accvgpr_read_b32 v65, a69
  v_accvgpr_read_b32 v66, a70
  v_accvgpr_read_b32 v67, a71
  v_mul_f32 v64, v64, v197
  v_mul_f32 v65, v65, v197
  v_mul_f32 v66, v66, v197
  v_mul_f32 v67, v67, v197
  v_accvgpr_write_b32 a68, v64
  v_accvgpr_write_b32 a69, v65
  v_accvgpr_write_b32 a70, v66
  v_accvgpr_write_b32 a71, v67
  v_accvgpr_read_b32 v64, a84
  v_accvgpr_read_b32 v65, a85
  v_accvgpr_read_b32 v66, a86
  v_accvgpr_read_b32 v67, a87
  v_mul_f32 v64, v64, v197
  v_mul_f32 v65, v65, v197
  v_mul_f32 v66, v66, v197
  v_mul_f32 v67, v67, v197
  v_accvgpr_write_b32 a84, v64
  v_accvgpr_write_b32 a85, v65
  v_accvgpr_write_b32 a86, v66
  v_accvgpr_write_b32 a87, v67
  v_accvgpr_read_b32 v64, a100
  v_accvgpr_read_b32 v65, a101
  v_accvgpr_read_b32 v66, a102
  v_accvgpr_read_b32 v67, a103
  v_mul_f32 v64, v64, v197
  v_mul_f32 v65, v65, v197
  v_mul_f32 v66, v66, v197
  v_mul_f32 v67, v67, v197
  v_accvgpr_write_b32 a100, v64
  v_accvgpr_write_b32 a101, v65
  v_accvgpr_write_b32 a102, v66
  v_accvgpr_write_b32 a103, v67
  v_accvgpr_read_b32 v64, a116
  v_accvgpr_read_b32 v65, a117
  v_accvgpr_read_b32 v66, a118
  v_accvgpr_read_b32 v67, a119
  v_mul_f32 v64, v64, v197
  v_mul_f32 v65, v65, v197
  v_mul_f32 v66, v66, v197
  v_mul_f32 v67, v67, v197
  v_accvgpr_write_b32 a116, v64
  v_accvgpr_write_b32 a117, v65
  v_accvgpr_write_b32 a118, v66
  v_accvgpr_write_b32 a119, v67
  v_mov_b32 v200, v251
  v_max3_f32 v200, v200, v16, v17
  v_max3_f32 v200, v200, v18, v19
  v_max3_f32 v200, v200, v20, v21
  v_max3_f32 v200, v200, v22, v23
  v_max3_f32 v200, v200, v48, v49
  v_max3_f32 v200, v200, v50, v51
  v_max3_f32 v200, v200, v52, v53
  v_max3_f32 v200, v200, v54, v55
  v_mov_b32 v245, v200
  s_nop 1
  v_permlane16_swap_b32 v200, v245
  v_max_f32 v200, v200, v245
  v_mov_b32 v245, v200
  s_nop 1
  v_permlane32_swap_b32 v200, v245
  v_max_f32 v200, v200, v245
  v_sub_f32 v201, v251, v200
  v_exp_f32 v201, v201
  v_mov_b32 v251, v200
  v_mul_f32 v210, v210, v201
  v_sub_f32 v16, v16, v200
  v_sub_f32 v17, v17, v200
  v_sub_f32 v18, v18, v200
  v_sub_f32 v19, v19, v200
  v_sub_f32 v20, v20, v200
  v_sub_f32 v21, v21, v200
  v_sub_f32 v22, v22, v200
  v_sub_f32 v23, v23, v200
  v_sub_f32 v48, v48, v200
  v_sub_f32 v49, v49, v200
  v_sub_f32 v50, v50, v200
  v_sub_f32 v51, v51, v200
  v_sub_f32 v52, v52, v200
  v_sub_f32 v53, v53, v200
  v_sub_f32 v54, v54, v200
  v_sub_f32 v55, v55, v200
  v_exp_f32 v16, v16
  v_exp_f32 v17, v17
  v_add_f32 v210, v210, v16
  v_exp_f32 v18, v18
  v_add_f32 v210, v210, v17
  v_cvt_pk_bf16_f32 v16, v16, v17
  v_exp_f32 v19, v19
  v_add_f32 v210, v210, v18
  v_add_f32 v210, v210, v19
  v_cvt_pk_bf16_f32 v17, v18, v19
  v_exp_f32 v20, v20
  v_exp_f32 v21, v21
  v_add_f32 v210, v210, v20
  v_exp_f32 v22, v22
  v_add_f32 v210, v210, v21
  v_cvt_pk_bf16_f32 v18, v20, v21
  v_exp_f32 v23, v23
  v_add_f32 v210, v210, v22
  v_add_f32 v210, v210, v23
  v_cvt_pk_bf16_f32 v19, v22, v23
  v_exp_f32 v48, v48
  v_exp_f32 v49, v49
  v_add_f32 v210, v210, v48
  v_exp_f32 v50, v50
  v_add_f32 v210, v210, v49
  v_cvt_pk_bf16_f32 v48, v48, v49
  v_exp_f32 v51, v51
  v_add_f32 v210, v210, v50
  v_add_f32 v210, v210, v51
  v_cvt_pk_bf16_f32 v49, v50, v51
  v_exp_f32 v52, v52
  v_exp_f32 v53, v53
  v_add_f32 v210, v210, v52
  v_exp_f32 v54, v54
  v_add_f32 v210, v210, v53
  v_cvt_pk_bf16_f32 v50, v52, v53
  v_exp_f32 v55, v55
  v_add_f32 v210, v210, v54
  v_add_f32 v210, v210, v55
  v_cvt_pk_bf16_f32 v51, v54, v55
  v_accvgpr_read_b32 v64, a8
  v_accvgpr_read_b32 v65, a9
  v_accvgpr_read_b32 v66, a10
  v_accvgpr_read_b32 v67, a11
  v_mul_f32 v64, v64, v201
  v_mul_f32 v65, v65, v201
  v_mul_f32 v66, v66, v201
  v_mul_f32 v67, v67, v201
  v_accvgpr_write_b32 a8, v64
  v_accvgpr_write_b32 a9, v65
  v_accvgpr_write_b32 a10, v66
  v_accvgpr_write_b32 a11, v67
  v_accvgpr_read_b32 v64, a24
  v_accvgpr_read_b32 v65, a25
  v_accvgpr_read_b32 v66, a26
  v_accvgpr_read_b32 v67, a27
  v_mul_f32 v64, v64, v201
  v_mul_f32 v65, v65, v201
  v_mul_f32 v66, v66, v201
  v_mul_f32 v67, v67, v201
  v_accvgpr_write_b32 a24, v64
  v_accvgpr_write_b32 a25, v65
  v_accvgpr_write_b32 a26, v66
  v_accvgpr_write_b32 a27, v67
  v_accvgpr_read_b32 v64, a40
  v_accvgpr_read_b32 v65, a41
  v_accvgpr_read_b32 v66, a42
  v_accvgpr_read_b32 v67, a43
  v_mul_f32 v64, v64, v201
  v_mul_f32 v65, v65, v201
  v_mul_f32 v66, v66, v201
  v_mul_f32 v67, v67, v201
  v_accvgpr_write_b32 a40, v64
  v_accvgpr_write_b32 a41, v65
  v_accvgpr_write_b32 a42, v66
  v_accvgpr_write_b32 a43, v67
  v_accvgpr_read_b32 v64, a56
  v_accvgpr_read_b32 v65, a57
  v_accvgpr_read_b32 v66, a58
  v_accvgpr_read_b32 v67, a59
  v_mul_f32 v64, v64, v201
  v_mul_f32 v65, v65, v201
  v_mul_f32 v66, v66, v201
  v_mul_f32 v67, v67, v201
  v_accvgpr_write_b32 a56, v64
  v_accvgpr_write_b32 a57, v65
  v_accvgpr_write_b32 a58, v66
  v_accvgpr_write_b32 a59, v67
  v_accvgpr_read_b32 v64, a72
  v_accvgpr_read_b32 v65, a73
  v_accvgpr_read_b32 v66, a74
  v_accvgpr_read_b32 v67, a75
  v_mul_f32 v64, v64, v201
  v_mul_f32 v65, v65, v201
  v_mul_f32 v66, v66, v201
  v_mul_f32 v67, v67, v201
  v_accvgpr_write_b32 a72, v64
  v_accvgpr_write_b32 a73, v65
  v_accvgpr_write_b32 a74, v66
  v_accvgpr_write_b32 a75, v67
  v_accvgpr_read_b32 v64, a88
  v_accvgpr_read_b32 v65, a89
  v_accvgpr_read_b32 v66, a90
  v_accvgpr_read_b32 v67, a91
  v_mul_f32 v64, v64, v201
  v_mul_f32 v65, v65, v201
  v_mul_f32 v66, v66, v201
  v_mul_f32 v67, v67, v201
  v_accvgpr_write_b32 a88, v64
  v_accvgpr_write_b32 a89, v65
  v_accvgpr_write_b32 a90, v66
  v_accvgpr_write_b32 a91, v67
  v_accvgpr_read_b32 v64, a104
  v_accvgpr_read_b32 v65, a105
  v_accvgpr_read_b32 v66, a106
  v_accvgpr_read_b32 v67, a107
  v_mul_f32 v64, v64, v201
  v_mul_f32 v65, v65, v201
  v_mul_f32 v66, v66, v201
  v_mul_f32 v67, v67, v201
  v_accvgpr_write_b32 a104, v64
  v_accvgpr_write_b32 a105, v65
  v_accvgpr_write_b32 a106, v66
  v_accvgpr_write_b32 a107, v67
  v_accvgpr_read_b32 v64, a120
  v_accvgpr_read_b32 v65, a121
  v_accvgpr_read_b32 v66, a122
  v_accvgpr_read_b32 v67, a123
  v_mul_f32 v64, v64, v201
  v_mul_f32 v65, v65, v201
  v_mul_f32 v66, v66, v201
  v_mul_f32 v67, v67, v201
  v_accvgpr_write_b32 a120, v64
  v_accvgpr_write_b32 a121, v65
  v_accvgpr_write_b32 a122, v66
  v_accvgpr_write_b32 a123, v67
  v_mov_b32 v204, v252
  v_max3_f32 v204, v204, v24, v25
  v_max3_f32 v204, v204, v26, v27
  v_max3_f32 v204, v204, v28, v29
  v_max3_f32 v204, v204, v30, v31
  v_max3_f32 v204, v204, v56, v57
  v_max3_f32 v204, v204, v58, v59
  v_max3_f32 v204, v204, v60, v61
  v_max3_f32 v204, v204, v62, v63
  v_mov_b32 v245, v204
  s_nop 1
  v_permlane16_swap_b32 v204, v245
  v_max_f32 v204, v204, v245
  v_mov_b32 v245, v204
  s_nop 1
  v_permlane32_swap_b32 v204, v245
  v_max_f32 v204, v204, v245
  v_sub_f32 v205, v252, v204
  v_exp_f32 v205, v205
  v_mov_b32 v252, v204
  v_mul_f32 v211, v211, v205
  v_sub_f32 v24, v24, v204
  v_sub_f32 v25, v25, v204
  v_sub_f32 v26, v26, v204
  v_sub_f32 v27, v27, v204
  v_sub_f32 v28, v28, v204
  v_sub_f32 v29, v29, v204
  v_sub_f32 v30, v30, v204
  v_sub_f32 v31, v31, v204
  v_sub_f32 v56, v56, v204
  v_sub_f32 v57, v57, v204
  v_sub_f32 v58, v58, v204
  v_sub_f32 v59, v59, v204
  v_sub_f32 v60, v60, v204
  v_sub_f32 v61, v61, v204
  v_sub_f32 v62, v62, v204
  v_sub_f32 v63, v63, v204
  v_exp_f32 v24, v24
  v_exp_f32 v25, v25
  v_add_f32 v211, v211, v24
  v_exp_f32 v26, v26
  v_add_f32 v211, v211, v25
  v_cvt_pk_bf16_f32 v24, v24, v25
  v_exp_f32 v27, v27
  v_add_f32 v211, v211, v26
  v_add_f32 v211, v211, v27
  v_cvt_pk_bf16_f32 v25, v26, v27
  v_exp_f32 v28, v28
  v_exp_f32 v29, v29
  v_add_f32 v211, v211, v28
  v_exp_f32 v30, v30
  v_add_f32 v211, v211, v29
  v_cvt_pk_bf16_f32 v26, v28, v29
  v_exp_f32 v31, v31
  v_add_f32 v211, v211, v30
  v_add_f32 v211, v211, v31
  v_cvt_pk_bf16_f32 v27, v30, v31
  v_exp_f32 v56, v56
  v_exp_f32 v57, v57
  v_add_f32 v211, v211, v56
  v_exp_f32 v58, v58
  v_add_f32 v211, v211, v57
  v_cvt_pk_bf16_f32 v56, v56, v57
  v_exp_f32 v59, v59
  v_add_f32 v211, v211, v58
  v_add_f32 v211, v211, v59
  v_cvt_pk_bf16_f32 v57, v58, v59
  v_exp_f32 v60, v60
  v_exp_f32 v61, v61
  v_add_f32 v211, v211, v60
  v_exp_f32 v62, v62
  v_add_f32 v211, v211, v61
  v_cvt_pk_bf16_f32 v58, v60, v61
  v_exp_f32 v63, v63
  v_add_f32 v211, v211, v62
  v_add_f32 v211, v211, v63
  v_cvt_pk_bf16_f32 v59, v62, v63
  v_accvgpr_read_b32 v64, a12
  v_accvgpr_read_b32 v65, a13
  v_accvgpr_read_b32 v66, a14
  v_accvgpr_read_b32 v67, a15
  v_mul_f32 v64, v64, v205
  v_mul_f32 v65, v65, v205
  v_mul_f32 v66, v66, v205
  v_mul_f32 v67, v67, v205
  v_accvgpr_write_b32 a12, v64
  v_accvgpr_write_b32 a13, v65
  v_accvgpr_write_b32 a14, v66
  v_accvgpr_write_b32 a15, v67
  v_accvgpr_read_b32 v64, a28
  v_accvgpr_read_b32 v65, a29
  v_accvgpr_read_b32 v66, a30
  v_accvgpr_read_b32 v67, a31
  v_mul_f32 v64, v64, v205
  v_mul_f32 v65, v65, v205
  v_mul_f32 v66, v66, v205
  v_mul_f32 v67, v67, v205
  v_accvgpr_write_b32 a28, v64
  v_accvgpr_write_b32 a29, v65
  v_accvgpr_write_b32 a30, v66
  v_accvgpr_write_b32 a31, v67
  v_accvgpr_read_b32 v64, a44
  v_accvgpr_read_b32 v65, a45
  v_accvgpr_read_b32 v66, a46
  v_accvgpr_read_b32 v67, a47
  v_mul_f32 v64, v64, v205
  v_mul_f32 v65, v65, v205
  v_mul_f32 v66, v66, v205
  v_mul_f32 v67, v67, v205
  v_accvgpr_write_b32 a44, v64
  v_accvgpr_write_b32 a45, v65
  v_accvgpr_write_b32 a46, v66
  v_accvgpr_write_b32 a47, v67
  v_accvgpr_read_b32 v64, a60
  v_accvgpr_read_b32 v65, a61
  v_accvgpr_read_b32 v66, a62
  v_accvgpr_read_b32 v67, a63
  v_mul_f32 v64, v64, v205
  v_mul_f32 v65, v65, v205
  v_mul_f32 v66, v66, v205
  v_mul_f32 v67, v67, v205
  v_accvgpr_write_b32 a60, v64
  v_accvgpr_write_b32 a61, v65
  v_accvgpr_write_b32 a62, v66
  v_accvgpr_write_b32 a63, v67
  v_accvgpr_read_b32 v64, a76
  v_accvgpr_read_b32 v65, a77
  v_accvgpr_read_b32 v66, a78
  v_accvgpr_read_b32 v67, a79
  v_mul_f32 v64, v64, v205
  v_mul_f32 v65, v65, v205
  v_mul_f32 v66, v66, v205
  v_mul_f32 v67, v67, v205
  v_accvgpr_write_b32 a76, v64
  v_accvgpr_write_b32 a77, v65
  v_accvgpr_write_b32 a78, v66
  v_accvgpr_write_b32 a79, v67
  v_accvgpr_read_b32 v64, a92
  v_accvgpr_read_b32 v65, a93
  v_accvgpr_read_b32 v66, a94
  v_accvgpr_read_b32 v67, a95
  v_mul_f32 v64, v64, v205
  v_mul_f32 v65, v65, v205
  v_mul_f32 v66, v66, v205
  v_mul_f32 v67, v67, v205
  v_accvgpr_write_b32 a92, v64
  v_accvgpr_write_b32 a93, v65
  v_accvgpr_write_b32 a94, v66
  v_accvgpr_write_b32 a95, v67
  v_accvgpr_read_b32 v64, a108
  v_accvgpr_read_b32 v65, a109
  v_accvgpr_read_b32 v66, a110
  v_accvgpr_read_b32 v67, a111
  v_mul_f32 v64, v64, v205
  v_mul_f32 v65, v65, v205
  v_mul_f32 v66, v66, v205
  v_mul_f32 v67, v67, v205
  v_accvgpr_write_b32 a108, v64
  v_accvgpr_write_b32 a109, v65
  v_accvgpr_write_b32 a110, v66
  v_accvgpr_write_b32 a111, v67
  v_accvgpr_read_b32 v64, a124
  v_accvgpr_read_b32 v65, a125
  v_accvgpr_read_b32 v66, a126
  v_accvgpr_read_b32 v67, a127
  v_mul_f32 v64, v64, v205
  v_mul_f32 v65, v65, v205
  v_mul_f32 v66, v66, v205
  v_mul_f32 v67, v67, v205
  v_accvgpr_write_b32 a124, v64
  v_accvgpr_write_b32 a125, v65
  v_accvgpr_write_b32 a126, v66
  v_accvgpr_write_b32 a127, v67
  ds_read_b64_tr_b16 a[160:161], v216 offset:49152
  ds_read_b64_tr_b16 a[162:163], v216 offset:53248
  ds_read_b64_tr_b16 a[164:165], v216 offset:57344
  ds_read_b64_tr_b16 a[166:167], v216 offset:61440
  s_waitcnt lgkmcnt(2)
  v_mfma_f32_16x16x32_bf16 a[0:3], a[160:163], v[0:3], a[0:3]
  s_waitcnt lgkmcnt(0)
  v_mfma_f32_16x16x32_bf16 a[0:3], a[164:167], v[32:35], a[0:3]
  v_mfma_f32_16x16x32_bf16 a[4:7], a[164:167], v[40:43], a[4:7]
  v_mfma_f32_16x16x32_bf16 a[4:7], a[160:163], v[8:11], a[4:7]
  v_mfma_f32_16x16x32_bf16 a[8:11], a[160:163], v[16:19], a[8:11]
  v_mfma_f32_16x16x32_bf16 a[8:11], a[164:167], v[48:51], a[8:11]
  v_mfma_f32_16x16x32_bf16 a[12:15], a[164:167], v[56:59], a[12:15]
  v_mfma_f32_16x16x32_bf16 a[12:15], a[160:163], v[24:27], a[12:15]
  ds_read_b64_tr_b16 a[168:169], v217 offset:49152
  ds_read_b64_tr_b16 a[170:171], v217 offset:53248
  ds_read_b64_tr_b16 a[172:173], v217 offset:57344
  ds_read_b64_tr_b16 a[174:175], v217 offset:61440
  s_waitcnt lgkmcnt(2)
  v_mfma_f32_16x16x32_bf16 a[16:19], a[168:171], v[0:3], a[16:19]
  s_waitcnt lgkmcnt(0)
  v_mfma_f32_16x16x32_bf16 a[16:19], a[172:175], v[32:35], a[16:19]
  v_mfma_f32_16x16x32_bf16 a[20:23], a[172:175], v[40:43], a[20:23]
  v_mfma_f32_16x16x32_bf16 a[20:23], a[168:171], v[8:11], a[20:23]
  v_mfma_f32_16x16x32_bf16 a[24:27], a[168:171], v[16:19], a[24:27]
  v_mfma_f32_16x16x32_bf16 a[24:27], a[172:175], v[48:51], a[24:27]
  v_mfma_f32_16x16x32_bf16 a[28:31], a[172:175], v[56:59], a[28:31]
  v_mfma_f32_16x16x32_bf16 a[28:31], a[168:171], v[24:27], a[28:31]
  ds_read_b64_tr_b16 a[176:177], v218 offset:49152
  ds_read_b64_tr_b16 a[178:179], v218 offset:53248
  ds_read_b64_tr_b16 a[180:181], v218 offset:57344
  ds_read_b64_tr_b16 a[182:183], v218 offset:61440
  s_waitcnt lgkmcnt(2)
  v_mfma_f32_16x16x32_bf16 a[32:35], a[176:179], v[0:3], a[32:35]
  s_waitcnt lgkmcnt(0)
  v_mfma_f32_16x16x32_bf16 a[32:35], a[180:183], v[32:35], a[32:35]
  v_mfma_f32_16x16x32_bf16 a[36:39], a[180:183], v[40:43], a[36:39]
  v_mfma_f32_16x16x32_bf16 a[36:39], a[176:179], v[8:11], a[36:39]
  v_mfma_f32_16x16x32_bf16 a[40:43], a[176:179], v[16:19], a[40:43]
  v_mfma_f32_16x16x32_bf16 a[40:43], a[180:183], v[48:51], a[40:43]
  v_mfma_f32_16x16x32_bf16 a[44:47], a[180:183], v[56:59], a[44:47]
  v_mfma_f32_16x16x32_bf16 a[44:47], a[176:179], v[24:27], a[44:47]
  ds_read_b64_tr_b16 a[184:185], v219 offset:49152
  ds_read_b64_tr_b16 a[186:187], v219 offset:53248
  ds_read_b64_tr_b16 a[188:189], v219 offset:57344
  ds_read_b64_tr_b16 a[190:191], v219 offset:61440
  s_waitcnt lgkmcnt(2)
  v_mfma_f32_16x16x32_bf16 a[48:51], a[184:187], v[0:3], a[48:51]
  s_waitcnt lgkmcnt(0)
  v_mfma_f32_16x16x32_bf16 a[48:51], a[188:191], v[32:35], a[48:51]
  v_mfma_f32_16x16x32_bf16 a[52:55], a[188:191], v[40:43], a[52:55]
  v_mfma_f32_16x16x32_bf16 a[52:55], a[184:187], v[8:11], a[52:55]
  v_mfma_f32_16x16x32_bf16 a[56:59], a[184:187], v[16:19], a[56:59]
  v_mfma_f32_16x16x32_bf16 a[56:59], a[188:191], v[48:51], a[56:59]
  v_mfma_f32_16x16x32_bf16 a[60:63], a[188:191], v[56:59], a[60:63]
  v_mfma_f32_16x16x32_bf16 a[60:63], a[184:187], v[24:27], a[60:63]
  ds_read_b64_tr_b16 a[160:161], v220 offset:49152
  ds_read_b64_tr_b16 a[162:163], v220 offset:53248
  ds_read_b64_tr_b16 a[164:165], v220 offset:57344
  ds_read_b64_tr_b16 a[166:167], v220 offset:61440
  s_waitcnt lgkmcnt(2)
  v_mfma_f32_16x16x32_bf16 a[64:67], a[160:163], v[0:3], a[64:67]
  s_waitcnt lgkmcnt(0)
  v_mfma_f32_16x16x32_bf16 a[64:67], a[164:167], v[32:35], a[64:67]
  v_mfma_f32_16x16x32_bf16 a[68:71], a[164:167], v[40:43], a[68:71]
  v_mfma_f32_16x16x32_bf16 a[68:71], a[160:163], v[8:11], a[68:71]
  v_mfma_f32_16x16x32_bf16 a[72:75], a[160:163], v[16:19], a[72:75]
  v_mfma_f32_16x16x32_bf16 a[72:75], a[164:167], v[48:51], a[72:75]
  v_mfma_f32_16x16x32_bf16 a[76:79], a[164:167], v[56:59], a[76:79]
  v_mfma_f32_16x16x32_bf16 a[76:79], a[160:163], v[24:27], a[76:79]
  ds_read_b64_tr_b16 a[168:169], v221 offset:49152
  ds_read_b64_tr_b16 a[170:171], v221 offset:53248
  ds_read_b64_tr_b16 a[172:173], v221 offset:57344
  ds_read_b64_tr_b16 a[174:175], v221 offset:61440
  s_waitcnt lgkmcnt(2)
  v_mfma_f32_16x16x32_bf16 a[80:83], a[168:171], v[0:3], a[80:83]
  s_waitcnt lgkmcnt(0)
  v_mfma_f32_16x16x32_bf16 a[80:83], a[172:175], v[32:35], a[80:83]
  v_mfma_f32_16x16x32_bf16 a[84:87], a[172:175], v[40:43], a[84:87]
  v_mfma_f32_16x16x32_bf16 a[84:87], a[168:171], v[8:11], a[84:87]
  v_mfma_f32_16x16x32_bf16 a[88:91], a[168:171], v[16:19], a[88:91]
  v_mfma_f32_16x16x32_bf16 a[88:91], a[172:175], v[48:51], a[88:91]
  v_mfma_f32_16x16x32_bf16 a[92:95], a[172:175], v[56:59], a[92:95]
  v_mfma_f32_16x16x32_bf16 a[92:95], a[168:171], v[24:27], a[92:95]
  ds_read_b64_tr_b16 a[176:177], v222 offset:49152
  ds_read_b64_tr_b16 a[178:179], v222 offset:53248
  ds_read_b64_tr_b16 a[180:181], v222 offset:57344
  ds_read_b64_tr_b16 a[182:183], v222 offset:61440
  s_waitcnt lgkmcnt(2)
  v_mfma_f32_16x16x32_bf16 a[96:99], a[176:179], v[0:3], a[96:99]
  s_waitcnt lgkmcnt(0)
  v_mfma_f32_16x16x32_bf16 a[96:99], a[180:183], v[32:35], a[96:99]
  v_mfma_f32_16x16x32_bf16 a[100:103], a[180:183], v[40:43], a[100:103]
  v_mfma_f32_16x16x32_bf16 a[100:103], a[176:179], v[8:11], a[100:103]
  v_mfma_f32_16x16x32_bf16 a[104:107], a[176:179], v[16:19], a[104:107]
  v_mfma_f32_16x16x32_bf16 a[104:107], a[180:183], v[48:51], a[104:107]
  v_mfma_f32_16x16x32_bf16 a[108:111], a[180:183], v[56:59], a[108:111]
  v_mfma_f32_16x16x32_bf16 a[108:111], a[176:179], v[24:27], a[108:111]
  ds_read_b64_tr_b16 a[184:185], v223 offset:49152
  ds_read_b64_tr_b16 a[186:187], v223 offset:53248
  ds_read_b64_tr_b16 a[188:189], v223 offset:57344
  ds_read_b64_tr_b16 a[190:191], v223 offset:61440
  s_waitcnt lgkmcnt(2)
  v_mfma_f32_16x16x32_bf16 a[112:115], a[184:187], v[0:3], a[112:115]
  s_waitcnt lgkmcnt(0)
  v_mfma_f32_16x16x32_bf16 a[112:115], a[188:191], v[32:35], a[112:115]
  v_mfma_f32_16x16x32_bf16 a[116:119], a[188:191], v[40:43], a[116:119]
  v_mfma_f32_16x16x32_bf16 a[116:119], a[184:187], v[8:11], a[116:119]
  v_mfma_f32_16x16x32_bf16 a[120:123], a[184:187], v[16:19], a[120:123]
  v_mfma_f32_16x16x32_bf16 a[120:123], a[188:191], v[48:51], a[120:123]
  v_mfma_f32_16x16x32_bf16 a[124:127], a[188:191], v[56:59], a[124:127]
  v_mfma_f32_16x16x32_bf16 a[124:127], a[184:187], v[24:27], a[124:127]
  s_add_u32 s29, s29, 16384
  s_cmp_lt_u32 s29, 524288
  s_cbranch_scc1 attn_slow
  v_mov_b32 v245, v208
  v_mov_b32 v246, v209
  v_mov_b32 v247, v210
  v_mov_b32 v248, v211
  v_permlane16_swap_b32 v208, v245
  v_permlane16_swap_b32 v209, v246
  v_permlane16_swap_b32 v210, v247
  v_permlane16_swap_b32 v211, v248
  v_add_f32 v208, v208, v245
  v_add_f32 v209, v209, v246
  v_add_f32 v210, v210, v247
  v_add_f32 v211, v211, v248
  v_mov_b32 v245, v208
  v_mov_b32 v246, v209
  v_mov_b32 v247, v210
  v_mov_b32 v248, v211
  v_permlane32_swap_b32 v208, v245
  v_permlane32_swap_b32 v209, v246
  v_permlane32_swap_b32 v210, v247
  v_permlane32_swap_b32 v211, v248
  v_add_f32 v208, v208, v245
  v_add_f32 v209, v209, v246
  v_add_f32 v210, v210, v247
  v_add_f32 v211, v211, v248
  v_rcp_f32 v192, v208
  v_rcp_f32 v196, v209
  v_rcp_f32 v200, v210
  v_rcp_f32 v204, v211
  v_accvgpr_read_b32 v0, a0
  v_accvgpr_read_b32 v1, a1
  v_accvgpr_read_b32 v2, a2
  v_accvgpr_read_b32 v3, a3
  v_accvgpr_read_b32 v4, a16
  v_accvgpr_read_b32 v5, a17
  v_accvgpr_read_b32 v6, a18
  v_accvgpr_read_b32 v7, a19
  v_mul_f32 v0, v0, v192
  v_mul_f32 v1, v1, v192
  v_mul_f32 v2, v2, v192
  v_mul_f32 v3, v3, v192
  v_mul_f32 v4, v4, v192
  v_mul_f32 v5, v5, v192
  v_mul_f32 v6, v6, v192
  v_mul_f32 v7, v7, v192
  v_cvt_pk_bf16_f32 v0, v0, v1
  v_cvt_pk_bf16_f32 v1, v2, v3
  v_cvt_pk_bf16_f32 v2, v4, v5
  v_cvt_pk_bf16_f32 v3, v6, v7
  buffer_store_dwordx4 v[0:3], v244, s[24:27], s40 offen offset:0 sc1
  v_accvgpr_read_b32 v8, a4
  v_accvgpr_read_b32 v9, a5
  v_accvgpr_read_b32 v10, a6
  v_accvgpr_read_b32 v11, a7
  v_accvgpr_read_b32 v12, a20
  v_accvgpr_read_b32 v13, a21
  v_accvgpr_read_b32 v14, a22
  v_accvgpr_read_b32 v15, a23
  v_mul_f32 v8, v8, v196
  v_mul_f32 v9, v9, v196
  v_mul_f32 v10, v10, v196
  v_mul_f32 v11, v11, v196
  v_mul_f32 v12, v12, v196
  v_mul_f32 v13, v13, v196
  v_mul_f32 v14, v14, v196
  v_mul_f32 v15, v15, v196
  v_cvt_pk_bf16_f32 v8, v8, v9
  v_cvt_pk_bf16_f32 v9, v10, v11
  v_cvt_pk_bf16_f32 v10, v12, v13
  v_cvt_pk_bf16_f32 v11, v14, v15
  buffer_store_dwordx4 v[8:11], v244, s[24:27], s40 offen offset:2048 sc1
  v_accvgpr_read_b32 v16, a8
  v_accvgpr_read_b32 v17, a9
  v_accvgpr_read_b32 v18, a10
  v_accvgpr_read_b32 v19, a11
  v_accvgpr_read_b32 v20, a24
  v_accvgpr_read_b32 v21, a25
  v_accvgpr_read_b32 v22, a26
  v_accvgpr_read_b32 v23, a27
  v_mul_f32 v16, v16, v200
  v_mul_f32 v17, v17, v200
  v_mul_f32 v18, v18, v200
  v_mul_f32 v19, v19, v200
  v_mul_f32 v20, v20, v200
  v_mul_f32 v21, v21, v200
  v_mul_f32 v22, v22, v200
  v_mul_f32 v23, v23, v200
  v_cvt_pk_bf16_f32 v16, v16, v17
  v_cvt_pk_bf16_f32 v17, v18, v19
  v_cvt_pk_bf16_f32 v18, v20, v21
  v_cvt_pk_bf16_f32 v19, v22, v23
  buffer_store_dwordx4 v[16:19], v244, s[24:27], s41 offen offset:0 sc1
  v_accvgpr_read_b32 v24, a12
  v_accvgpr_read_b32 v25, a13
  v_accvgpr_read_b32 v26, a14
  v_accvgpr_read_b32 v27, a15
  v_accvgpr_read_b32 v28, a28
  v_accvgpr_read_b32 v29, a29
  v_accvgpr_read_b32 v30, a30
  v_accvgpr_read_b32 v31, a31
  v_mul_f32 v24, v24, v204
  v_mul_f32 v25, v25, v204
  v_mul_f32 v26, v26, v204
  v_mul_f32 v27, v27, v204
  v_mul_f32 v28, v28, v204
  v_mul_f32 v29, v29, v204
  v_mul_f32 v30, v30, v204
  v_mul_f32 v31, v31, v204
  v_cvt_pk_bf16_f32 v24, v24, v25
  v_cvt_pk_bf16_f32 v25, v26, v27
  v_cvt_pk_bf16_f32 v26, v28, v29
  v_cvt_pk_bf16_f32 v27, v30, v31
  buffer_store_dwordx4 v[24:27], v244, s[24:27], s41 offen offset:2048 sc1
  v_accvgpr_read_b32 v32, a32
  v_accvgpr_read_b32 v33, a33
  v_accvgpr_read_b32 v34, a34
  v_accvgpr_read_b32 v35, a35
  v_accvgpr_read_b32 v36, a48
  v_accvgpr_read_b32 v37, a49
  v_accvgpr_read_b32 v38, a50
  v_accvgpr_read_b32 v39, a51
  v_mul_f32 v32, v32, v192
  v_mul_f32 v33, v33, v192
  v_mul_f32 v34, v34, v192
  v_mul_f32 v35, v35, v192
  v_mul_f32 v36, v36, v192
  v_mul_f32 v37, v37, v192
  v_mul_f32 v38, v38, v192
  v_mul_f32 v39, v39, v192
  v_cvt_pk_bf16_f32 v32, v32, v33
  v_cvt_pk_bf16_f32 v33, v34, v35
  v_cvt_pk_bf16_f32 v34, v36, v37
  v_cvt_pk_bf16_f32 v35, v38, v39
  buffer_store_dwordx4 v[32:35], v244, s[24:27], s40 offen offset:1024 sc1
  v_accvgpr_read_b32 v40, a36
  v_accvgpr_read_b32 v41, a37
  v_accvgpr_read_b32 v42, a38
  v_accvgpr_read_b32 v43, a39
  v_accvgpr_read_b32 v44, a52
  v_accvgpr_read_b32 v45, a53
  v_accvgpr_read_b32 v46, a54
  v_accvgpr_read_b32 v47, a55
  v_mul_f32 v40, v40, v196
  v_mul_f32 v41, v41, v196
  v_mul_f32 v42, v42, v196
  v_mul_f32 v43, v43, v196
  v_mul_f32 v44, v44, v196
  v_mul_f32 v45, v45, v196
  v_mul_f32 v46, v46, v196
  v_mul_f32 v47, v47, v196
  v_cvt_pk_bf16_f32 v40, v40, v41
  v_cvt_pk_bf16_f32 v41, v42, v43
  v_cvt_pk_bf16_f32 v42, v44, v45
  v_cvt_pk_bf16_f32 v43, v46, v47
  buffer_store_dwordx4 v[40:43], v244, s[24:27], s40 offen offset:3072 sc1
  v_accvgpr_read_b32 v48, a40
  v_accvgpr_read_b32 v49, a41
  v_accvgpr_read_b32 v50, a42
  v_accvgpr_read_b32 v51, a43
  v_accvgpr_read_b32 v52, a56
  v_accvgpr_read_b32 v53, a57
  v_accvgpr_read_b32 v54, a58
  v_accvgpr_read_b32 v55, a59
  v_mul_f32 v48, v48, v200
  v_mul_f32 v49, v49, v200
  v_mul_f32 v50, v50, v200
  v_mul_f32 v51, v51, v200
  v_mul_f32 v52, v52, v200
  v_mul_f32 v53, v53, v200
  v_mul_f32 v54, v54, v200
  v_mul_f32 v55, v55, v200
  v_cvt_pk_bf16_f32 v48, v48, v49
  v_cvt_pk_bf16_f32 v49, v50, v51
  v_cvt_pk_bf16_f32 v50, v52, v53
  v_cvt_pk_bf16_f32 v51, v54, v55
  buffer_store_dwordx4 v[48:51], v244, s[24:27], s41 offen offset:1024 sc1
  v_accvgpr_read_b32 v56, a44
  v_accvgpr_read_b32 v57, a45
  v_accvgpr_read_b32 v58, a46
  v_accvgpr_read_b32 v59, a47
  v_accvgpr_read_b32 v60, a60
  v_accvgpr_read_b32 v61, a61
  v_accvgpr_read_b32 v62, a62
  v_accvgpr_read_b32 v63, a63
  v_mul_f32 v56, v56, v204
  v_mul_f32 v57, v57, v204
  v_mul_f32 v58, v58, v204
  v_mul_f32 v59, v59, v204
  v_mul_f32 v60, v60, v204
  v_mul_f32 v61, v61, v204
  v_mul_f32 v62, v62, v204
  v_mul_f32 v63, v63, v204
  v_cvt_pk_bf16_f32 v56, v56, v57
  v_cvt_pk_bf16_f32 v57, v58, v59
  v_cvt_pk_bf16_f32 v58, v60, v61
  v_cvt_pk_bf16_f32 v59, v62, v63
  buffer_store_dwordx4 v[56:59], v244, s[24:27], s41 offen offset:3072 sc1
  v_accvgpr_read_b32 v0, a64
  v_accvgpr_read_b32 v1, a65
  v_accvgpr_read_b32 v2, a66
  v_accvgpr_read_b32 v3, a67
  v_accvgpr_read_b32 v4, a80
  v_accvgpr_read_b32 v5, a81
  v_accvgpr_read_b32 v6, a82
  v_accvgpr_read_b32 v7, a83
  v_mul_f32 v0, v0, v192
  v_mul_f32 v1, v1, v192
  v_mul_f32 v2, v2, v192
  v_mul_f32 v3, v3, v192
  v_mul_f32 v4, v4, v192
  v_mul_f32 v5, v5, v192
  v_mul_f32 v6, v6, v192
  v_mul_f32 v7, v7, v192
  v_cvt_pk_bf16_f32 v0, v0, v1
  v_cvt_pk_bf16_f32 v1, v2, v3
  v_cvt_pk_bf16_f32 v2, v4, v5
  v_cvt_pk_bf16_f32 v3, v6, v7
  buffer_store_dwordx4 v[0:3], v244, s[24:27], s42 offen offset:0 sc1
  v_accvgpr_read_b32 v8, a68
  v_accvgpr_read_b32 v9, a69
  v_accvgpr_read_b32 v10, a70
  v_accvgpr_read_b32 v11, a71
  v_accvgpr_read_b32 v12, a84
  v_accvgpr_read_b32 v13, a85
  v_accvgpr_read_b32 v14, a86
  v_accvgpr_read_b32 v15, a87
  v_mul_f32 v8, v8, v196
  v_mul_f32 v9, v9, v196
  v_mul_f32 v10, v10, v196
  v_mul_f32 v11, v11, v196
  v_mul_f32 v12, v12, v196
  v_mul_f32 v13, v13, v196
  v_mul_f32 v14, v14, v196
  v_mul_f32 v15, v15, v196
  v_cvt_pk_bf16_f32 v8, v8, v9
  v_cvt_pk_bf16_f32 v9, v10, v11
  v_cvt_pk_bf16_f32 v10, v12, v13
  v_cvt_pk_bf16_f32 v11, v14, v15
  buffer_store_dwordx4 v[8:11], v244, s[24:27], s42 offen offset:2048 sc1
  v_accvgpr_read_b32 v16, a72
  v_accvgpr_read_b32 v17, a73
  v_accvgpr_read_b32 v18, a74
  v_accvgpr_read_b32 v19, a75
  v_accvgpr_read_b32 v20, a88
  v_accvgpr_read_b32 v21, a89
  v_accvgpr_read_b32 v22, a90
  v_accvgpr_read_b32 v23, a91
  v_mul_f32 v16, v16, v200
  v_mul_f32 v17, v17, v200
  v_mul_f32 v18, v18, v200
  v_mul_f32 v19, v19, v200
  v_mul_f32 v20, v20, v200
  v_mul_f32 v21, v21, v200
  v_mul_f32 v22, v22, v200
  v_mul_f32 v23, v23, v200
  v_cvt_pk_bf16_f32 v16, v16, v17
  v_cvt_pk_bf16_f32 v17, v18, v19
  v_cvt_pk_bf16_f32 v18, v20, v21
  v_cvt_pk_bf16_f32 v19, v22, v23
  buffer_store_dwordx4 v[16:19], v244, s[24:27], s43 offen offset:0 sc1
  v_accvgpr_read_b32 v24, a76
  v_accvgpr_read_b32 v25, a77
  v_accvgpr_read_b32 v26, a78
  v_accvgpr_read_b32 v27, a79
  v_accvgpr_read_b32 v28, a92
  v_accvgpr_read_b32 v29, a93
  v_accvgpr_read_b32 v30, a94
  v_accvgpr_read_b32 v31, a95
  v_mul_f32 v24, v24, v204
  v_mul_f32 v25, v25, v204
  v_mul_f32 v26, v26, v204
  v_mul_f32 v27, v27, v204
  v_mul_f32 v28, v28, v204
  v_mul_f32 v29, v29, v204
  v_mul_f32 v30, v30, v204
  v_mul_f32 v31, v31, v204
  v_cvt_pk_bf16_f32 v24, v24, v25
  v_cvt_pk_bf16_f32 v25, v26, v27
  v_cvt_pk_bf16_f32 v26, v28, v29
  v_cvt_pk_bf16_f32 v27, v30, v31
  buffer_store_dwordx4 v[24:27], v244, s[24:27], s43 offen offset:2048 sc1
  v_accvgpr_read_b32 v32, a96
  v_accvgpr_read_b32 v33, a97
  v_accvgpr_read_b32 v34, a98
  v_accvgpr_read_b32 v35, a99
  v_accvgpr_read_b32 v36, a112
  v_accvgpr_read_b32 v37, a113
  v_accvgpr_read_b32 v38, a114
  v_accvgpr_read_b32 v39, a115
  v_mul_f32 v32, v32, v192
  v_mul_f32 v33, v33, v192
  v_mul_f32 v34, v34, v192
  v_mul_f32 v35, v35, v192
  v_mul_f32 v36, v36, v192
  v_mul_f32 v37, v37, v192
  v_mul_f32 v38, v38, v192
  v_mul_f32 v39, v39, v192
  v_cvt_pk_bf16_f32 v32, v32, v33
  v_cvt_pk_bf16_f32 v33, v34, v35
  v_cvt_pk_bf16_f32 v34, v36, v37
  v_cvt_pk_bf16_f32 v35, v38, v39
  buffer_store_dwordx4 v[32:35], v244, s[24:27], s42 offen offset:1024 sc1
  v_accvgpr_read_b32 v40, a100
  v_accvgpr_read_b32 v41, a101
  v_accvgpr_read_b32 v42, a102
  v_accvgpr_read_b32 v43, a103
  v_accvgpr_read_b32 v44, a116
  v_accvgpr_read_b32 v45, a117
  v_accvgpr_read_b32 v46, a118
  v_accvgpr_read_b32 v47, a119
  v_mul_f32 v40, v40, v196
  v_mul_f32 v41, v41, v196
  v_mul_f32 v42, v42, v196
  v_mul_f32 v43, v43, v196
  v_mul_f32 v44, v44, v196
  v_mul_f32 v45, v45, v196
  v_mul_f32 v46, v46, v196
  v_mul_f32 v47, v47, v196
  v_cvt_pk_bf16_f32 v40, v40, v41
  v_cvt_pk_bf16_f32 v41, v42, v43
  v_cvt_pk_bf16_f32 v42, v44, v45
  v_cvt_pk_bf16_f32 v43, v46, v47
  buffer_store_dwordx4 v[40:43], v244, s[24:27], s42 offen offset:3072 sc1
  v_accvgpr_read_b32 v48, a104
  v_accvgpr_read_b32 v49, a105
  v_accvgpr_read_b32 v50, a106
  v_accvgpr_read_b32 v51, a107
  v_accvgpr_read_b32 v52, a120
  v_accvgpr_read_b32 v53, a121
  v_accvgpr_read_b32 v54, a122
  v_accvgpr_read_b32 v55, a123
  v_mul_f32 v48, v48, v200
  v_mul_f32 v49, v49, v200
  v_mul_f32 v50, v50, v200
  v_mul_f32 v51, v51, v200
  v_mul_f32 v52, v52, v200
  v_mul_f32 v53, v53, v200
  v_mul_f32 v54, v54, v200
  v_mul_f32 v55, v55, v200
  v_cvt_pk_bf16_f32 v48, v48, v49
  v_cvt_pk_bf16_f32 v49, v50, v51
  v_cvt_pk_bf16_f32 v50, v52, v53
  v_cvt_pk_bf16_f32 v51, v54, v55
  buffer_store_dwordx4 v[48:51], v244, s[24:27], s43 offen offset:1024 sc1
  v_accvgpr_read_b32 v56, a108
  v_accvgpr_read_b32 v57, a109
  v_accvgpr_read_b32 v58, a110
  v_accvgpr_read_b32 v59, a111
  v_accvgpr_read_b32 v60, a124
  v_accvgpr_read_b32 v61, a125
  v_accvgpr_read_b32 v62, a126
  v_accvgpr_read_b32 v63, a127
  v_mul_f32 v56, v56, v204
  v_mul_f32 v57, v57, v204
  v_mul_f32 v58, v58, v204
  v_mul_f32 v59, v59, v204
  v_mul_f32 v60, v60, v204
  v_mul_f32 v61, v61, v204
  v_mul_f32 v62, v62, v204
  v_mul_f32 v63, v63, v204
  v_cvt_pk_bf16_f32 v56, v56, v57
  v_cvt_pk_bf16_f32 v57, v58, v59
  v_cvt_pk_bf16_f32 v58, v60, v61
  v_cvt_pk_bf16_f32 v59, v62, v63
  buffer_store_dwordx4 v[56:59], v244, s[24:27], s43 offen offset:3072 sc1
  v_add_u32 v252, 4096, v242
  v_add_u32 v253, 8192, v242
  buffer_load_dwordx4 a[128:131], v253, s[24:27], s4 offen offset:3072 sc1
  buffer_load_dwordx4 a[132:135], v242, s[24:27], s5 offen offset:0 sc1
  buffer_load_dwordx4 a[136:139], v242, s[24:27], s5 offen offset:1024 sc1
  buffer_load_dwordx4 a[140:143], v242, s[24:27], s5 offen offset:2048 sc1
  buffer_load_dwordx4 a[144:147], v242, s[24:27], s5 offen offset:3072 sc1
  buffer_load_dwordx4 a[148:151], v252, s[24:27], s5 offen offset:0 sc1
  buffer_load_dwordx4 a[152:155], v252, s[24:27], s5 offen offset:1024 sc1
  buffer_load_dwordx4 a[156:159], v252, s[24:27], s5 offen offset:2048 sc1
  buffer_load_dwordx4 a[0:3], v252, s[24:27], s5 offen offset:3072 sc1
  buffer_load_dwordx4 a[4:7], v253, s[24:27], s5 offen offset:0 sc1
  buffer_load_dwordx4 a[8:11], v253, s[24:27], s5 offen offset:1024 sc1
  buffer_load_dwordx4 a[12:15], v253, s[24:27], s5 offen offset:2048 sc1
  buffer_load_dwordx4 a[16:19], v253, s[24:27], s5 offen offset:3072 sc1
  buffer_load_dwordx4 a[20:23], v242, s[24:27], s6 offen offset:0 sc1
  buffer_load_dwordx4 a[24:27], v242, s[24:27], s6 offen offset:1024 sc1
  buffer_load_dwordx4 a[28:31], v242, s[24:27], s6 offen offset:2048 sc1
  buffer_load_dwordx4 a[32:35], v242, s[24:27], s6 offen offset:3072 sc1
  buffer_load_dwordx4 a[36:39], v252, s[24:27], s6 offen offset:0 sc1
  s_and_b32 s39, s2, 63
  s_lshl_b32 s39, s39, 7
  s_add_u32 s39, s39, 2867200
  s_lshl_b32 s38, s3, 26
  v_lshlrev_b32 v64, 22, v242
  v_or_b32 v64, s38, v64
  v_mov_b32 v65, 1
  s_waitcnt vmcnt(0)
  s_barrier
  s_branch tail_go
.section .rodata,"a"
.p2align 6
.amdhsa_kernel recurrent_scan__mha_block_cached__moe_arch_mod__prompt_kernel
  .amdhsa_next_free_vgpr 512
  .amdhsa_next_free_sgpr 102
  .amdhsa_accum_offset 256
  .amdhsa_group_segment_fixed_size 0
  .amdhsa_kernarg_size 104
  .amdhsa_user_sgpr_count 2
  .amdhsa_user_sgpr_kernarg_segment_ptr 1
  .amdhsa_system_sgpr_workgroup_id_x 1
.end_amdhsa_kernel
```

```asm
; @launch grid=(256,1,1) block=(256,1,1) lds=163840
.amdgcn_target "amdgcn-amd-amdhsa--gfx950"
.text
.globl recurrent_scan__mha_block_cached__moe_arch_mod__prompt_kernel
.p2align 8
.type recurrent_scan__mha_block_cached__moe_arch_mod__prompt_kernel,@function
recurrent_scan__mha_block_cached__moe_arch_mod__prompt_kernel:
  s_cmp_ge_u32 s2, 256
  s_cbranch_scc1 attn_end
  s_load_dwordx2 s[60:61], s[0:1], 0
  s_load_dwordx2 s[48:49], s[0:1], 48
  s_load_dwordx4 s[4:7], s[0:1], 8
  s_load_dwordx2 s[8:9], s[0:1], 24
  s_load_dwordx2 s[10:11], s[0:1], 96
  s_load_dwordx2 s[88:89], s[0:1], 32
  s_load_dwordx2 s[90:91], s[0:1], 56
  s_load_dwordx4 s[92:95], s[0:1], 64
  s_load_dwordx2 s[62:63], s[0:1], 80
  v_lshrrev_b32 v249, 6, v0
  v_and_b32 v0, 63, v0
  v_mov_b32 v245, v0
  v_readfirstlane_b32 s3, v249
  s_and_b32 s36, s2, 7
  s_lshl_b32 s36, s36, 2
  s_lshr_b32 s37, s2, 6
  s_add_u32 s36, s36, s37
  s_bfe_u32 s37, s2, 0x30003
  s_lshl_b32 s37, s37, 2
  s_add_u32 s37, s37, s3
  s_lshl_b32 s28, s3, 12
  v_lshrrev_b32 v248, 4, v245
  v_and_b32 v247, 15, v245
  s_lshl_b32 s38, s3, 17
  v_lshlrev_b32 v249, 13, v248
  v_add_u32 v249, s38, v249
  v_or_b32 v250, 0, v248
  v_lshlrev_b32 v250, 1, v250
  v_xor_b32 v250, v250, v247
  v_lshl_add_u32 v238, v250, 4, v249
  v_or_b32 v250, 0, v248
  v_lshlrev_b32 v250, 1, v250
  v_xor_b32 v250, v250, v247
  v_lshl_add_u32 v239, v250, 4, v249
  v_add_u32 v239, 31744, v239
  v_or_b32 v250, 4, v248
  v_lshlrev_b32 v250, 1, v250
  v_xor_b32 v250, v250, v247
  v_lshl_add_u32 v240, v250, 4, v249
  v_add_u32 v240, 63488, v240
  v_or_b32 v250, 4, v248
  v_lshlrev_b32 v250, 1, v250
  v_xor_b32 v250, v250, v247
  v_lshl_add_u32 v241, v250, 4, v249
  v_add_u32 v241, 95232, v241
  s_waitcnt lgkmcnt(0)
  s_add_u32 s58, s10, 2830336
  s_addc_u32 s59, s11, 0
  s_load_dword s59, s[58:59], 0
  s_mov_b32 s24, s10
  s_mov_b32 s25, s11
  s_mov_b32 s26, 33554432
  s_mov_b32 s27, 0x20000
  s_lshl_b32 s38, s36, 8
  s_add_u32 s20, s8, s38
  s_addc_u32 s21, s9, 0
  s_mov_b32 s22, 5242880
  s_mov_b32 s23, 0x20000
  s_sub_u32 s22, s22, s38
  s_cmp_ge_u32 s3, 2
  s_cbranch_scc1 front_fetch
  s_mov_b32 s12, s60
  s_mov_b32 s13, s61
  s_mov_b32 s14, 2621440
  s_mov_b32 s15, 0x20000
  s_mov_b32 s16, s48
  s_mov_b32 s17, s49
  s_mov_b32 s18, 1280
  s_mov_b32 s19, 0x20000
  s_lshr_b32 s52, s37, 2
  s_lshl_b32 s52, s52, 5
  s_add_u32 s52, s52, s36
  s_lshl_b32 s52, s52, 1
  s_add_u32 s52, s52, s3
  s_lshl_b32 s52, s52, 2
  s_mul_i32 s53, s52, 1280
  v_lshrrev_b32 v1, 4, v0
  v_and_b32 v2, 15, v0
  v_lshlrev_b32 v3, 4, v2
  v_mul_u32_u24 v4, 0x500, v1
  v_add_u32 v4, v4, v3
  buffer_load_dwordx4 v[8:11], v4, s[12:15], s53 offen offset:0
  buffer_load_dwordx4 v[12:15], v4, s[12:15], s53 offen offset:256
  buffer_load_dwordx4 v[16:19], v4, s[12:15], s53 offen offset:512
  buffer_load_dwordx4 v[20:23], v4, s[12:15], s53 offen offset:768
  buffer_load_dwordx4 v[24:27], v4, s[12:15], s53 offen offset:1024
  buffer_load_dwordx4 v[28:31], v3, s[16:19], 0 offen offset:0
  buffer_load_dwordx4 v[32:35], v3, s[16:19], 0 offen offset:256
  buffer_load_dwordx4 v[36:39], v3, s[16:19], 0 offen offset:512
  buffer_load_dwordx4 v[40:43], v3, s[16:19], 0 offen offset:768
  buffer_load_dwordx4 v[44:47], v3, s[16:19], 0 offen offset:1024
  v_mov_b32 v7, 0
  v_lshlrev_b32 v6, 26, v0
  s_lshl_b32 s53, s2, 7
  s_add_u32 s53, s53, 2834432
  buffer_store_dword v7, v6, s[24:27], s53 offen sc1
  v_lshlrev_b32 v6, 8, v0
  v_lshrrev_b32 v5, 5, v0
  v_lshl_add_u32 v6, v5, 26, v6
  s_cmp_eq_u32 s2, 0
  s_cselect_b32 s53, 0, 1073741824
  v_or_b32 v6, s53, v6
  s_mov_b32 s53, 2818048
  buffer_store_dword v7, v6, s[24:27], s53 offen sc1
  v_lshlrev_b32 v6, 7, v0
  s_cmp_eq_u32 s2, 1
  s_cselect_b32 s53, 0, 1073741824
  v_or_b32 v6, s53, v6
  s_mov_b32 s53, 2867200
  buffer_store_dword v7, v6, s[24:27], s53 offen sc1
  s_lshr_b32 s53, s52, 6
  s_mul_i32 s53, s53, 81920
  s_bfe_u32 s54, s52, 0x20004
  s_lshl_b32 s54, s54, 10
  s_add_u32 s53, s53, s54
  s_and_b32 s54, s52, 15
  s_lshl_b32 s54, s54, 4
  s_add_u32 s53, s53, s54
  v_lshrrev_b32 v5, 2, v2
  v_lshlrev_b32 v5, 12, v5
  v_and_b32 v6, 3, v2
  v_lshl_add_u32 v5, v6, 8, v5
  v_lshl_add_u32 v5, v1, 4, v5
  s_mov_b32 s56, 0xffff0000
  s_waitcnt vmcnt(12)
  v_lshlrev_b32 v48, 16, v8
  v_and_b32 v49, s56, v8
  v_lshlrev_b32 v50, 16, v9
  v_and_b32 v51, s56, v9
  v_lshlrev_b32 v52, 16, v10
  v_and_b32 v53, s56, v10
  v_lshlrev_b32 v54, 16, v11
  v_and_b32 v55, s56, v11
  s_waitcnt vmcnt(11)
  v_lshlrev_b32 v56, 16, v12
  v_and_b32 v57, s56, v12
  v_lshlrev_b32 v58, 16, v13
  v_and_b32 v59, s56, v13
  v_lshlrev_b32 v60, 16, v14
  v_and_b32 v61, s56, v14
  v_lshlrev_b32 v62, 16, v15
  v_and_b32 v63, s56, v15
  s_waitcnt vmcnt(10)
  v_lshlrev_b32 v64, 16, v16
  v_and_b32 v65, s56, v16
  v_lshlrev_b32 v66, 16, v17
  v_and_b32 v67, s56, v17
  v_lshlrev_b32 v68, 16, v18
  v_and_b32 v69, s56, v18
  v_lshlrev_b32 v70, 16, v19
  v_and_b32 v71, s56, v19
  s_waitcnt vmcnt(9)
  v_lshlrev_b32 v72, 16, v20
  v_and_b32 v73, s56, v20
  v_lshlrev_b32 v74, 16, v21
  v_and_b32 v75, s56, v21
  v_lshlrev_b32 v76, 16, v22
  v_and_b32 v77, s56, v22
  v_lshlrev_b32 v78, 16, v23
  v_and_b32 v79, s56, v23
  s_waitcnt vmcnt(8)
  v_lshlrev_b32 v80, 16, v24
  v_and_b32 v81, s56, v24
  v_lshlrev_b32 v82, 16, v25
  v_and_b32 v83, s56, v25
  v_lshlrev_b32 v84, 16, v26
  v_and_b32 v85, s56, v26
  v_lshlrev_b32 v86, 16, v27
  v_and_b32 v87, s56, v27
  v_pk_add_f32 v[88:89], v[48:49], v[50:51]
  v_pk_add_f32 v[90:91], v[52:53], v[54:55]
  v_pk_add_f32 v[88:89], v[88:89], v[56:57]
  v_pk_add_f32 v[90:91], v[90:91], v[58:59]
  v_pk_add_f32 v[88:89], v[88:89], v[60:61]
  v_pk_add_f32 v[90:91], v[90:91], v[62:63]
  v_pk_add_f32 v[88:89], v[88:89], v[64:65]
  v_pk_add_f32 v[90:91], v[90:91], v[66:67]
  v_pk_add_f32 v[88:89], v[88:89], v[68:69]
  v_pk_add_f32 v[90:91], v[90:91], v[70:71]
  v_pk_add_f32 v[88:89], v[88:89], v[72:73]
  v_pk_add_f32 v[90:91], v[90:91], v[74:75]
  v_pk_add_f32 v[88:89], v[88:89], v[76:77]
  v_pk_add_f32 v[90:91], v[90:91], v[78:79]
  v_pk_add_f32 v[88:89], v[88:89], v[80:81]
  v_pk_add_f32 v[90:91], v[90:91], v[82:83]
  v_pk_add_f32 v[88:89], v[88:89], v[84:85]
  v_pk_add_f32 v[90:91], v[90:91], v[86:87]
  v_pk_add_f32 v[88:89], v[88:89], v[90:91]
  v_add_f32 v92, v88, v89
  s_nop 1
  v_add_f32_dpp v92, v92, v92 row_ror:8 row_mask:0xf bank_mask:0xf
  s_nop 1
  v_add_f32_dpp v92, v92, v92 row_ror:4 row_mask:0xf bank_mask:0xf
  s_nop 1
  v_add_f32_dpp v92, v92, v92 row_ror:2 row_mask:0xf bank_mask:0xf
  s_nop 1
  v_add_f32_dpp v92, v92, v92 row_ror:1 row_mask:0xf bank_mask:0xf
  v_mul_f32 v92, 0x3acccccd, v92
  v_pk_add_f32 v[94:95], v[48:49], v[92:93] op_sel_hi:[1,0] neg_lo:[0,1] neg_hi:[0,1]
  v_pk_mul_f32 v[88:89], v[94:95], v[94:95]
  v_pk_add_f32 v[96:97], v[50:51], v[92:93] op_sel_hi:[1,0] neg_lo:[0,1] neg_hi:[0,1]
  v_pk_mul_f32 v[90:91], v[96:97], v[96:97]
  v_pk_add_f32 v[94:95], v[52:53], v[92:93] op_sel_hi:[1,0] neg_lo:[0,1] neg_hi:[0,1]
  v_pk_fma_f32 v[88:89], v[94:95], v[94:95], v[88:89]
  v_pk_add_f32 v[96:97], v[54:55], v[92:93] op_sel_hi:[1,0] neg_lo:[0,1] neg_hi:[0,1]
  v_pk_fma_f32 v[90:91], v[96:97], v[96:97], v[90:91]
  v_pk_add_f32 v[94:95], v[56:57], v[92:93] op_sel_hi:[1,0] neg_lo:[0,1] neg_hi:[0,1]
  v_pk_fma_f32 v[88:89], v[94:95], v[94:95], v[88:89]
  v_pk_add_f32 v[96:97], v[58:59], v[92:93] op_sel_hi:[1,0] neg_lo:[0,1] neg_hi:[0,1]
  v_pk_fma_f32 v[90:91], v[96:97], v[96:97], v[90:91]
  v_pk_add_f32 v[94:95], v[60:61], v[92:93] op_sel_hi:[1,0] neg_lo:[0,1] neg_hi:[0,1]
  v_pk_fma_f32 v[88:89], v[94:95], v[94:95], v[88:89]
  v_pk_add_f32 v[96:97], v[62:63], v[92:93] op_sel_hi:[1,0] neg_lo:[0,1] neg_hi:[0,1]
  v_pk_fma_f32 v[90:91], v[96:97], v[96:97], v[90:91]
  v_pk_add_f32 v[94:95], v[64:65], v[92:93] op_sel_hi:[1,0] neg_lo:[0,1] neg_hi:[0,1]
  v_pk_fma_f32 v[88:89], v[94:95], v[94:95], v[88:89]
  v_pk_add_f32 v[96:97], v[66:67], v[92:93] op_sel_hi:[1,0] neg_lo:[0,1] neg_hi:[0,1]
  v_pk_fma_f32 v[90:91], v[96:97], v[96:97], v[90:91]
  v_pk_add_f32 v[94:95], v[68:69], v[92:93] op_sel_hi:[1,0] neg_lo:[0,1] neg_hi:[0,1]
  v_pk_fma_f32 v[88:89], v[94:95], v[94:95], v[88:89]
  v_pk_add_f32 v[96:97], v[70:71], v[92:93] op_sel_hi:[1,0] neg_lo:[0,1] neg_hi:[0,1]
  v_pk_fma_f32 v[90:91], v[96:97], v[96:97], v[90:91]
  v_pk_add_f32 v[94:95], v[72:73], v[92:93] op_sel_hi:[1,0] neg_lo:[0,1] neg_hi:[0,1]
  v_pk_fma_f32 v[88:89], v[94:95], v[94:95], v[88:89]
  v_pk_add_f32 v[96:97], v[74:75], v[92:93] op_sel_hi:[1,0] neg_lo:[0,1] neg_hi:[0,1]
  v_pk_fma_f32 v[90:91], v[96:97], v[96:97], v[90:91]
  v_pk_add_f32 v[94:95], v[76:77], v[92:93] op_sel_hi:[1,0] neg_lo:[0,1] neg_hi:[0,1]
  v_pk_fma_f32 v[88:89], v[94:95], v[94:95], v[88:89]
  v_pk_add_f32 v[96:97], v[78:79], v[92:93] op_sel_hi:[1,0] neg_lo:[0,1] neg_hi:[0,1]
  v_pk_fma_f32 v[90:91], v[96:97], v[96:97], v[90:91]
  v_pk_add_f32 v[94:95], v[80:81], v[92:93] op_sel_hi:[1,0] neg_lo:[0,1] neg_hi:[0,1]
  v_pk_fma_f32 v[88:89], v[94:95], v[94:95], v[88:89]
  v_pk_add_f32 v[96:97], v[82:83], v[92:93] op_sel_hi:[1,0] neg_lo:[0,1] neg_hi:[0,1]
  v_pk_fma_f32 v[90:91], v[96:97], v[96:97], v[90:91]
  v_pk_add_f32 v[94:95], v[84:85], v[92:93] op_sel_hi:[1,0] neg_lo:[0,1] neg_hi:[0,1]
  v_pk_fma_f32 v[88:89], v[94:95], v[94:95], v[88:89]
  v_pk_add_f32 v[96:97], v[86:87], v[92:93] op_sel_hi:[1,0] neg_lo:[0,1] neg_hi:[0,1]
  v_pk_fma_f32 v[90:91], v[96:97], v[96:97], v[90:91]
  v_pk_add_f32 v[88:89], v[88:89], v[90:91]
  v_add_f32 v98, v88, v89
  s_nop 1
  v_add_f32_dpp v98, v98, v98 row_ror:8 row_mask:0xf bank_mask:0xf
  v_cvt_pk_bf16_f32 v92, v92, v92
  s_nop 0
  v_add_f32_dpp v98, v98, v98 row_ror:4 row_mask:0xf bank_mask:0xf
  v_lshlrev_b32 v92, 16, v92
  s_nop 0
  v_add_f32_dpp v98, v98, v98 row_ror:2 row_mask:0xf bank_mask:0xf
  s_nop 1
  v_add_f32_dpp v98, v98, v98 row_ror:1 row_mask:0xf bank_mask:0xf
  v_mul_f32 v98, 0x3acccccd, v98
  v_cvt_pk_bf16_f32 v98, v98, v98
  v_pk_add_f32 v[48:49], v[48:49], v[92:93] op_sel_hi:[1,0] neg_lo:[0,1] neg_hi:[0,1]
  v_lshlrev_b32 v98, 16, v98
  v_pk_add_f32 v[50:51], v[50:51], v[92:93] op_sel_hi:[1,0] neg_lo:[0,1] neg_hi:[0,1]
  v_add_f32 v98, 0x3727c5ac, v98
  v_pk_add_f32 v[52:53], v[52:53], v[92:93] op_sel_hi:[1,0] neg_lo:[0,1] neg_hi:[0,1]
  v_cvt_pk_bf16_f32 v98, v98, v98
  v_pk_add_f32 v[54:55], v[54:55], v[92:93] op_sel_hi:[1,0] neg_lo:[0,1] neg_hi:[0,1]
  v_lshlrev_b32 v98, 16, v98
  v_pk_add_f32 v[56:57], v[56:57], v[92:93] op_sel_hi:[1,0] neg_lo:[0,1] neg_hi:[0,1]
  v_sqrt_f32 v98, v98
  v_pk_add_f32 v[58:59], v[58:59], v[92:93] op_sel_hi:[1,0] neg_lo:[0,1] neg_hi:[0,1]
  v_cvt_pk_bf16_f32 v98, v98, v98
  v_pk_add_f32 v[60:61], v[60:61], v[92:93] op_sel_hi:[1,0] neg_lo:[0,1] neg_hi:[0,1]
  v_lshlrev_b32 v98, 16, v98
  v_pk_add_f32 v[62:63], v[62:63], v[92:93] op_sel_hi:[1,0] neg_lo:[0,1] neg_hi:[0,1]
  v_rcp_f32 v100, v98
  v_pk_add_f32 v[64:65], v[64:65], v[92:93] op_sel_hi:[1,0] neg_lo:[0,1] neg_hi:[0,1]
  v_pk_add_f32 v[66:67], v[66:67], v[92:93] op_sel_hi:[1,0] neg_lo:[0,1] neg_hi:[0,1]
  v_pk_add_f32 v[68:69], v[68:69], v[92:93] op_sel_hi:[1,0] neg_lo:[0,1] neg_hi:[0,1]
  v_pk_add_f32 v[70:71], v[70:71], v[92:93] op_sel_hi:[1,0] neg_lo:[0,1] neg_hi:[0,1]
  v_pk_add_f32 v[72:73], v[72:73], v[92:93] op_sel_hi:[1,0] neg_lo:[0,1] neg_hi:[0,1]
  v_pk_add_f32 v[74:75], v[74:75], v[92:93] op_sel_hi:[1,0] neg_lo:[0,1] neg_hi:[0,1]
  v_pk_add_f32 v[76:77], v[76:77], v[92:93] op_sel_hi:[1,0] neg_lo:[0,1] neg_hi:[0,1]
  v_pk_add_f32 v[78:79], v[78:79], v[92:93] op_sel_hi:[1,0] neg_lo:[0,1] neg_hi:[0,1]
  v_pk_add_f32 v[80:81], v[80:81], v[92:93] op_sel_hi:[1,0] neg_lo:[0,1] neg_hi:[0,1]
  v_pk_add_f32 v[82:83], v[82:83], v[92:93] op_sel_hi:[1,0] neg_lo:[0,1] neg_hi:[0,1]
  v_pk_add_f32 v[84:85], v[84:85], v[92:93] op_sel_hi:[1,0] neg_lo:[0,1] neg_hi:[0,1]
  v_pk_add_f32 v[86:87], v[86:87], v[92:93] op_sel_hi:[1,0] neg_lo:[0,1] neg_hi:[0,1]
  v_mov_b32 v104, 0
  v_mov_b32 v105, 0
  v_cvt_pk_bf16_f32 v8, v48, v49
  v_cvt_pk_bf16_f32 v9, v50, v51
  v_cvt_pk_bf16_f32 v10, v52, v53
  v_cvt_pk_bf16_f32 v11, v54, v55
  v_cvt_pk_bf16_f32 v12, v56, v57
  v_cvt_pk_bf16_f32 v13, v58, v59
  v_cvt_pk_bf16_f32 v14, v60, v61
  v_cvt_pk_bf16_f32 v15, v62, v63
  v_cvt_pk_bf16_f32 v16, v64, v65
  v_cvt_pk_bf16_f32 v17, v66, v67
  v_cvt_pk_bf16_f32 v18, v68, v69
  v_cvt_pk_bf16_f32 v19, v70, v71
  v_cvt_pk_bf16_f32 v20, v72, v73
  v_cvt_pk_bf16_f32 v21, v74, v75
  v_cvt_pk_bf16_f32 v22, v76, v77
  v_cvt_pk_bf16_f32 v23, v78, v79
  v_cvt_pk_bf16_f32 v24, v80, v81
  v_cvt_pk_bf16_f32 v25, v82, v83
  v_cvt_pk_bf16_f32 v26, v84, v85
  v_cvt_pk_bf16_f32 v27, v86, v87
  v_lshlrev_b32 v48, 16, v8
  v_and_b32 v49, s56, v8
  v_lshlrev_b32 v50, 16, v9
  v_and_b32 v51, s56, v9
  v_lshlrev_b32 v52, 16, v10
  v_and_b32 v53, s56, v10
  v_lshlrev_b32 v54, 16, v11
  v_and_b32 v55, s56, v11
  v_lshlrev_b32 v56, 16, v12
  v_and_b32 v57, s56, v12
  v_lshlrev_b32 v58, 16, v13
  v_and_b32 v59, s56, v13
  v_lshlrev_b32 v60, 16, v14
  v_and_b32 v61, s56, v14
  v_lshlrev_b32 v62, 16, v15
  v_and_b32 v63, s56, v15
  v_lshlrev_b32 v64, 16, v16
  v_and_b32 v65, s56, v16
  v_lshlrev_b32 v66, 16, v17
  v_and_b32 v67, s56, v17
  v_lshlrev_b32 v68, 16, v18
  v_and_b32 v69, s56, v18
  v_lshlrev_b32 v70, 16, v19
  v_and_b32 v71, s56, v19
  v_lshlrev_b32 v72, 16, v20
  v_and_b32 v73, s56, v20
  v_lshlrev_b32 v74, 16, v21
  v_and_b32 v75, s56, v21
  v_lshlrev_b32 v76, 16, v22
  v_and_b32 v77, s56, v22
  v_lshlrev_b32 v78, 16, v23
  v_and_b32 v79, s56, v23
  v_lshlrev_b32 v80, 16, v24
  v_and_b32 v81, s56, v24
  v_lshlrev_b32 v82, 16, v25
  v_and_b32 v83, s56, v25
  v_lshlrev_b32 v84, 16, v26
  v_and_b32 v85, s56, v26
  v_lshlrev_b32 v86, 16, v27
  v_and_b32 v87, s56, v27
  v_pk_mul_f32 v[48:49], v[48:49], v[100:101] op_sel_hi:[1,0]
  v_pk_mul_f32 v[50:51], v[50:51], v[100:101] op_sel_hi:[1,0]
  v_pk_mul_f32 v[52:53], v[52:53], v[100:101] op_sel_hi:[1,0]
  v_pk_mul_f32 v[54:55], v[54:55], v[100:101] op_sel_hi:[1,0]
  v_cvt_pk_bf16_f32 v8, v48, v49
  v_cvt_pk_bf16_f32 v9, v50, v51
  v_cvt_pk_bf16_f32 v10, v52, v53
  v_cvt_pk_bf16_f32 v11, v54, v55
  buffer_store_dwordx4 v[8:11], v5, s[24:27], s53 offen sc1
  s_add_u32 s53, s53, 16384
  v_pk_mul_f32 v[56:57], v[56:57], v[100:101] op_sel_hi:[1,0]
  v_pk_mul_f32 v[58:59], v[58:59], v[100:101] op_sel_hi:[1,0]
  v_pk_mul_f32 v[60:61], v[60:61], v[100:101] op_sel_hi:[1,0]
  v_pk_mul_f32 v[62:63], v[62:63], v[100:101] op_sel_hi:[1,0]
  v_cvt_pk_bf16_f32 v12, v56, v57
  v_cvt_pk_bf16_f32 v13, v58, v59
  v_cvt_pk_bf16_f32 v14, v60, v61
  v_cvt_pk_bf16_f32 v15, v62, v63
  buffer_store_dwordx4 v[12:15], v5, s[24:27], s53 offen sc1
  s_add_u32 s53, s53, 16384
  v_pk_mul_f32 v[64:65], v[64:65], v[100:101] op_sel_hi:[1,0]
  v_pk_mul_f32 v[66:67], v[66:67], v[100:101] op_sel_hi:[1,0]
  v_pk_mul_f32 v[68:69], v[68:69], v[100:101] op_sel_hi:[1,0]
  v_pk_mul_f32 v[70:71], v[70:71], v[100:101] op_sel_hi:[1,0]
  v_cvt_pk_bf16_f32 v16, v64, v65
  v_cvt_pk_bf16_f32 v17, v66, v67
  v_cvt_pk_bf16_f32 v18, v68, v69
  v_cvt_pk_bf16_f32 v19, v70, v71
  buffer_store_dwordx4 v[16:19], v5, s[24:27], s53 offen sc1
  s_add_u32 s53, s53, 16384
  v_pk_mul_f32 v[72:73], v[72:73], v[100:101] op_sel_hi:[1,0]
  v_pk_mul_f32 v[74:75], v[74:75], v[100:101] op_sel_hi:[1,0]
  v_pk_mul_f32 v[76:77], v[76:77], v[100:101] op_sel_hi:[1,0]
  v_pk_mul_f32 v[78:79], v[78:79], v[100:101] op_sel_hi:[1,0]
  v_cvt_pk_bf16_f32 v20, v72, v73
  v_cvt_pk_bf16_f32 v21, v74, v75
  v_cvt_pk_bf16_f32 v22, v76, v77
  v_cvt_pk_bf16_f32 v23, v78, v79
  buffer_store_dwordx4 v[20:23], v5, s[24:27], s53 offen sc1
  s_add_u32 s53, s53, 16384
  v_pk_mul_f32 v[80:81], v[80:81], v[100:101] op_sel_hi:[1,0]
  v_pk_mul_f32 v[82:83], v[82:83], v[100:101] op_sel_hi:[1,0]
  v_pk_mul_f32 v[84:85], v[84:85], v[100:101] op_sel_hi:[1,0]
  v_pk_mul_f32 v[86:87], v[86:87], v[100:101] op_sel_hi:[1,0]
  v_cvt_pk_bf16_f32 v24, v80, v81
  v_cvt_pk_bf16_f32 v25, v82, v83
  v_cvt_pk_bf16_f32 v26, v84, v85
  v_cvt_pk_bf16_f32 v27, v86, v87
  buffer_store_dwordx4 v[24:27], v5, s[24:27], s53 offen sc1
  s_add_u32 s53, s53, 16384
  s_waitcnt vmcnt(12)
  v_dot2_f32_bf16 v104, v8, v28, v104
  v_dot2_f32_bf16 v105, v9, v29, v105
  v_dot2_f32_bf16 v104, v10, v30, v104
  v_dot2_f32_bf16 v105, v11, v31, v105
  s_waitcnt vmcnt(11)
  v_dot2_f32_bf16 v104, v12, v32, v104
  v_dot2_f32_bf16 v105, v13, v33, v105
  v_dot2_f32_bf16 v104, v14, v34, v104
  v_dot2_f32_bf16 v105, v15, v35, v105
  s_waitcnt vmcnt(10)
  v_dot2_f32_bf16 v104, v16, v36, v104
  v_dot2_f32_bf16 v105, v17, v37, v105
  v_dot2_f32_bf16 v104, v18, v38, v104
  v_dot2_f32_bf16 v105, v19, v39, v105
  s_waitcnt vmcnt(9)
  v_dot2_f32_bf16 v104, v20, v40, v104
  v_dot2_f32_bf16 v105, v21, v41, v105
  v_dot2_f32_bf16 v104, v22, v42, v104
  v_dot2_f32_bf16 v105, v23, v43, v105
  s_waitcnt vmcnt(8)
  v_dot2_f32_bf16 v104, v24, v44, v104
  v_dot2_f32_bf16 v105, v25, v45, v105
  v_dot2_f32_bf16 v104, v26, v46, v104
  v_dot2_f32_bf16 v105, v27, v47, v105
  s_nop 2
  v_add_f32 v104, v104, v105
  s_nop 1
  v_add_f32_dpp v104, v104, v104 row_ror:8 row_mask:0xf bank_mask:0xf
  s_nop 1
  v_add_f32_dpp v104, v104, v104 row_ror:4 row_mask:0xf bank_mask:0xf
  s_nop 1
  v_add_f32_dpp v104, v104, v104 row_ror:2 row_mask:0xf bank_mask:0xf
  s_nop 1
  v_add_f32_dpp v104, v104, v104 row_ror:1 row_mask:0xf bank_mask:0xf
  v_cvt_pk_bf16_f32 v104, v104, v104
  v_lshlrev_b32 v104, 16, v104
  v_ashrrev_i32 v105, 31, v104
  v_or_b32 v105, 0x80000000, v105
  v_xor_b32 v104, v104, v105
  v_and_b32 v104, s56, v104
  v_add_u32 v6, s52, v1
  v_sub_u32 v7, 0xffff, v6
  v_or_b32 v104, v104, v7
  v_lshlrev_b32 v6, 2, v6
  v_lshl_add_u32 v6, v2, 26, v6
  s_mov_b32 s53, 2621440
  buffer_store_dword v104, v6, s[24:27], s53 offen sc1
  s_waitcnt vmcnt(0)
  s_branch front_join
front_fetch:
  s_getpc_b64 s[98:99]
attn_hot_pc:
  s_add_u32 s98, s98, attn_hot-attn_hot_pc
  s_addc_u32 s99, s99, 0
  s_lshr_b32 s100, s2, 3
  v_min_u32 v249, 17, v0
  v_lshlrev_b32 v249, 5, v249
  v_add_u32 v249, s100, v249
  v_lshlrev_b32 v249, 7, v249
  v_min_u32 v249, attn_end-attn_hot-4, v249
  global_load_dword v255, v249, s[98:99]
attn_hot:
  v_subrev_u32 v16, 0x40000, v238
  v_subrev_u32 v17, 0x40000, v239
  v_subrev_u32 v18, 0x40000, v240
  v_subrev_u32 v19, 0x40000, v241
  s_mov_b32 s31, 0
  s_add_u32 m0, s28, 90112
  s_nop 0
  buffer_load_dwordx4 v16, s[20:23], s31 offen offset:0 lds
  buffer_load_dwordx4 v17, s[20:23], s31 offen offset:1024 lds
  buffer_load_dwordx4 v18, s[20:23], s31 offen offset:2048 lds
  buffer_load_dwordx4 v19, s[20:23], s31 offen offset:3072 lds
  s_add_u32 m0, s28, 98304
  s_nop 0
  buffer_load_dwordx4 v238, s[20:23], s31 offen offset:0 lds
  buffer_load_dwordx4 v239, s[20:23], s31 offen offset:1024 lds
  buffer_load_dwordx4 v240, s[20:23], s31 offen offset:2048 lds
  buffer_load_dwordx4 v241, s[20:23], s31 offen offset:3072 lds
front_join:
  s_waitcnt lgkmcnt(0)
  s_barrier
  s_mul_i32 s55, s59, 0x9e3779b1
  s_add_u32 s55, s55, 0x7f4a7c15
  s_bfe_u32 s58, s2, 0x30003
  s_lshl_b32 s58, s58, 8
  s_add_u32 s58, s58, 2826240
  s_lshl_b32 s53, s36, 2
  s_lshl_b32 s54, s3, 26
  s_add_u32 s53, s53, s54
  v_min_u32 v1, 1, v0
  v_lshlrev_b32 v1, 28, v1
  v_add_u32 v1, s53, v1
  v_mov_b32 v2, s55
  buffer_store_dword v2, v1, s[24:27], s58 offen sc1
  s_cmp_lt_u32 s3, 2
  s_cbranch_scc1 front_addr
  s_mov_b32 s31, 524288
  s_add_u32 m0, s28, 106496
  s_nop 0
  buffer_load_dwordx4 v16, s[20:23], s31 offen offset:0 lds
  buffer_load_dwordx4 v17, s[20:23], s31 offen offset:1024 lds
  buffer_load_dwordx4 v18, s[20:23], s31 offen offset:2048 lds
  buffer_load_dwordx4 v19, s[20:23], s31 offen offset:3072 lds
  s_add_u32 m0, s28, 114688
  s_nop 0
  buffer_load_dwordx4 v238, s[20:23], s31 offen offset:0 lds
  buffer_load_dwordx4 v239, s[20:23], s31 offen offset:1024 lds
  buffer_load_dwordx4 v240, s[20:23], s31 offen offset:2048 lds
  buffer_load_dwordx4 v241, s[20:23], s31 offen offset:3072 lds
  s_mov_b32 s31, 1048576
  s_add_u32 m0, s28, 24576
  s_nop 0
  buffer_load_dwordx4 v16, s[20:23], s31 offen offset:0 lds
  buffer_load_dwordx4 v17, s[20:23], s31 offen offset:1024 lds
  buffer_load_dwordx4 v18, s[20:23], s31 offen offset:2048 lds
  buffer_load_dwordx4 v19, s[20:23], s31 offen offset:3072 lds
  s_add_u32 m0, s28, 32768
  s_nop 0
  buffer_load_dwordx4 v238, s[20:23], s31 offen offset:0 lds
  buffer_load_dwordx4 v239, s[20:23], s31 offen offset:1024 lds
  buffer_load_dwordx4 v240, s[20:23], s31 offen offset:2048 lds
  buffer_load_dwordx4 v241, s[20:23], s31 offen offset:3072 lds
  s_mov_b32 s31, 1572864
  s_add_u32 m0, s28, 40960
  s_nop 0
  buffer_load_dwordx4 v16, s[20:23], s31 offen offset:0 lds
  buffer_load_dwordx4 v17, s[20:23], s31 offen offset:1024 lds
  buffer_load_dwordx4 v18, s[20:23], s31 offen offset:2048 lds
  buffer_load_dwordx4 v19, s[20:23], s31 offen offset:3072 lds
  s_add_u32 m0, s28, 49152
  s_nop 0
  buffer_load_dwordx4 v238, s[20:23], s31 offen offset:0 lds
  buffer_load_dwordx4 v239, s[20:23], s31 offen offset:1024 lds
  buffer_load_dwordx4 v240, s[20:23], s31 offen offset:2048 lds
  buffer_load_dwordx4 v241, s[20:23], s31 offen offset:3072 lds
front_addr:
  s_mov_b32 s31, 2097152
  v_lshlrev_b32 v242, 4, v245
  v_add_u32 v243, 0x1000, v242
  s_mul_i32 s30, s37, 81920
  s_lshl_b32 s38, s36, 19
  s_add_u32 s12, s4, s38
  s_addc_u32 s13, s5, 0
  s_mov_b32 s14, 524288
  s_mov_b32 s15, 0x20000
  s_add_u32 s16, s6, s38
  s_addc_u32 s17, s7, 0
  s_mov_b32 s18, 524288
  s_mov_b32 s19, 0x20000
  v_lshlrev_b32 v249, 8, v248
  v_add_u32 v249, s28, v249
  v_add_u32 v250, 0, v248
  v_xor_b32 v250, v250, v247
  v_lshl_add_u32 v232, v250, 4, v249
  v_add_u32 v250, 4, v248
  v_xor_b32 v250, v250, v247
  v_lshl_add_u32 v233, v250, 4, v249
  v_add_u32 v250, 8, v248
  v_xor_b32 v250, v250, v247
  v_lshl_add_u32 v234, v250, 4, v249
  v_add_u32 v250, 12, v248
  v_xor_b32 v250, v250, v247
  v_lshl_add_u32 v235, v250, 4, v249
  v_add_u32 v250, 0, v248
  v_lshlrev_b32 v250, 1, v250
  v_xor_b32 v250, v250, v247
  v_lshl_add_u32 v236, v250, 4, v249
  v_add_u32 v250, 4, v248
  v_lshlrev_b32 v250, 1, v250
  v_xor_b32 v250, v250, v247
  v_lshl_add_u32 v237, v250, 4, v249
  v_lshrrev_b32 v249, 1, v248
  v_and_b32 v250, 1, v248
  v_lshl_or_b32 v249, v250, 1, v249
  v_xor_b32 v249, v249, v247
  v_lshlrev_b32 v249, 4, v249
  v_lshl_add_u32 v212, v247, 8, v249
  v_xor_b32 v213, 64, v212
  v_xor_b32 v214, 128, v212
  v_xor_b32 v215, 192, v212
  v_bfe_u32 v246, v245, 2, 2
  v_and_b32 v247, 3, v245
  v_lshlrev_b32 v247, 3, v247
  v_add_u32 v247, 65536, v247
  v_lshl_add_u32 v249, v248, 2, v246
  v_and_b32 v250, 7, v249
  v_lshl_add_u32 v250, v250, 5, v247
  v_lshl_add_u32 v216, v249, 8, v250
  v_lshl_add_u32 v249, v248, 3, v246
  v_and_b32 v250, 1, v248
  v_lshl_add_u32 v250, v250, 2, v246
  v_lshl_add_u32 v250, v250, 5, v247
  v_lshl_add_u32 v224, v249, 8, v250
  v_xor_b32 v217, 32, v216
  v_xor_b32 v225, 32, v224
  v_xor_b32 v218, 64, v216
  v_xor_b32 v226, 64, v224
  v_xor_b32 v219, 96, v216
  v_xor_b32 v227, 96, v224
  v_xor_b32 v220, 128, v216
  v_xor_b32 v228, 128, v224
  v_xor_b32 v221, 160, v216
  v_xor_b32 v229, 160, v224
  v_xor_b32 v222, 192, v216
  v_xor_b32 v230, 192, v224
  v_xor_b32 v223, 224, v216
  v_xor_b32 v231, 224, v224
  v_subrev_u32 v144, 65536, v224
  v_subrev_u32 v145, 65536, v225
  v_subrev_u32 v146, 65536, v226
  v_subrev_u32 v147, 65536, v227
  v_subrev_u32 v148, 65536, v228
  v_subrev_u32 v149, 65536, v229
  v_subrev_u32 v150, 65536, v230
  v_subrev_u32 v151, 65536, v231
  s_lshr_b32 s38, s2, 3
  s_min_u32 s38, s38, 26
  s_and_b32 s39, s2, 7
  s_mul_i32 s39, s39, 27
  s_add_u32 s33, s38, s39
  s_mul_i32 s50, s3, 6144
  s_add_u32 s50, s50, 133120
  v_mov_b32 v244, v242
  s_lshl_b32 s40, s37, 19
  s_lshl_b32 s38, s36, 14
  s_add_u32 s40, s40, s38
  s_add_u32 s40, s40, 8388608
  s_add_u32 s41, s40, 4096
  s_add_u32 s42, s40, 8192
  s_add_u32 s43, s40, 12288
  s_mov_b32 s34, 0x3e0293ee
  s_mov_b32 s29, 0
  v_and_b32 v249, 15, v245
  v_cmp_eq_u32 vcc, 0, v249
  v_mov_b32 v249, 0x3f803f80
  s_nop 0
  v_cndmask_b32 v249, 0, v249, vcc
  v_accvgpr_write_b32 a208, v249
  v_accvgpr_write_b32 a209, v249
  v_accvgpr_write_b32 a210, v249
  v_accvgpr_write_b32 a211, v249
  v_and_b32 v2, 7, v0
  v_lshlrev_b32 v2, 2, v2
  s_lshl_b32 s54, s3, 5
  v_add_u32 v2, s54, v2
  s_mov_b32 s54, 32768
  buffer_load_dword v3, v2, s[24:27], s58 offen sc1
  s_sleep 2
  buffer_load_dword v4, v2, s[24:27], s58 offen sc1
  s_sleep 2
  buffer_load_dword v5, v2, s[24:27], s58 offen sc1
  s_sleep 2
front_poll:
  buffer_load_dword v6, v2, s[24:27], s58 offen sc1
  s_waitcnt vmcnt(3)
  v_cmp_ne_u32 vcc, s55, v3
  s_nop 0
  s_cbranch_vccz front_go
  s_sleep 2
  buffer_load_dword v3, v2, s[24:27], s58 offen sc1
  s_waitcnt vmcnt(3)
  v_cmp_ne_u32 vcc, s55, v4
  s_nop 0
  s_cbranch_vccz front_go
  s_sleep 2
  buffer_load_dword v4, v2, s[24:27], s58 offen sc1
  s_waitcnt vmcnt(3)
  v_cmp_ne_u32 vcc, s55, v5
  s_nop 0
  s_cbranch_vccz front_go
  s_sleep 2
  buffer_load_dword v5, v2, s[24:27], s58 offen sc1
  s_waitcnt vmcnt(3)
  v_cmp_ne_u32 vcc, s55, v6
  s_nop 0
  s_cbranch_vccz front_go
  s_sleep 2
  s_sub_u32 s54, s54, 1
  s_cmp_lg_u32 s54, 0
  s_cbranch_scc1 front_poll
front_go:
  buffer_load_dwordx4 a[0:3], v242, s[24:27], s30 offen offset:0 sc1
  buffer_load_dwordx4 a[4:7], v242, s[24:27], s30 offen offset:1024 sc1
  buffer_load_dwordx4 a[8:11], v242, s[24:27], s30 offen offset:2048 sc1
  buffer_load_dwordx4 a[12:15], v242, s[24:27], s30 offen offset:3072 sc1
  buffer_load_dwordx4 a[16:19], v243, s[24:27], s30 offen offset:0 sc1
  buffer_load_dwordx4 a[20:23], v243, s[24:27], s30 offen offset:1024 sc1
  buffer_load_dwordx4 a[24:27], v243, s[24:27], s30 offen offset:2048 sc1
  buffer_load_dwordx4 a[28:31], v243, s[24:27], s30 offen offset:3072 sc1
  s_add_u32 s30, s30, 8192
  buffer_load_dwordx4 a[32:35], v242, s[24:27], s30 offen offset:0 sc1
  buffer_load_dwordx4 a[36:39], v242, s[24:27], s30 offen offset:1024 sc1
  buffer_load_dwordx4 a[40:43], v242, s[24:27], s30 offen offset:2048 sc1
  buffer_load_dwordx4 a[44:47], v242, s[24:27], s30 offen offset:3072 sc1
  buffer_load_dwordx4 a[48:51], v243, s[24:27], s30 offen offset:0 sc1
  buffer_load_dwordx4 a[52:55], v243, s[24:27], s30 offen offset:1024 sc1
  buffer_load_dwordx4 a[56:59], v243, s[24:27], s30 offen offset:2048 sc1
  buffer_load_dwordx4 a[60:63], v243, s[24:27], s30 offen offset:3072 sc1
  s_add_u32 s30, s30, 8192
  v_lshrrev_b32 v140, 7, v242
  v_lshlrev_b32 v140, 8, v140
  v_and_b32 v136, 0x70, v242
  v_add_u32 v140, v140, v136
  s_mov_b32 s58, 2826240
  buffer_load_dwordx4 v[136:139], v140, s[24:27], s58 offen sc1
  s_barrier
  ds_read_b64_tr_b16 a[160:161], v224 offset:32768
  ds_read_b64_tr_b16 a[162:163], v224 offset:33792
  ds_read_b64_tr_b16 a[164:165], v224 offset:40960
  ds_read_b64_tr_b16 a[166:167], v224 offset:41984
  ds_read_b64_tr_b16 a[168:169], v225 offset:32768
  ds_read_b64_tr_b16 a[170:171], v225 offset:33792
  ds_read_b64_tr_b16 a[172:173], v225 offset:40960
  ds_read_b64_tr_b16 a[174:175], v225 offset:41984
  s_waitcnt vmcnt(9) lgkmcnt(4)
  v_mfma_f32_16x16x32_bf16 v[0:3], a[160:163], a[0:3], 0
  ds_read_b64_tr_b16 a[176:177], v226 offset:32768
  v_mfma_f32_16x16x32_bf16 v[0:3], a[164:167], a[16:19], v[0:3]
  buffer_load_dwordx4 a[64:67], v242, s[24:27], s30 offen offset:0 sc1
  v_mfma_f32_16x16x32_bf16 v[4:7], a[164:167], a[20:23], 0
  ds_read_b64_tr_b16 a[178:179], v226 offset:33792
  v_mfma_f32_16x16x32_bf16 v[4:7], a[160:163], a[4:7], v[4:7]
  buffer_load_dwordx4 a[68:71], v242, s[24:27], s30 offen offset:1024 sc1
  v_mfma_f32_16x16x32_bf16 v[8:11], a[160:163], a[8:11], 0
  ds_read_b64_tr_b16 a[180:181], v226 offset:40960
  v_mfma_f32_16x16x32_bf16 v[8:11], a[164:167], a[24:27], v[8:11]
  v_mfma_f32_16x16x32_bf16 v[12:15], a[164:167], a[28:31], 0
  ds_read_b64_tr_b16 a[182:183], v226 offset:41984
  v_mfma_f32_16x16x32_bf16 v[12:15], a[160:163], a[12:15], v[12:15]
  s_waitcnt lgkmcnt(4)
  buffer_load_dwordx4 a[72:75], v242, s[24:27], s30 offen offset:2048 sc1
  v_mfma_f32_16x16x32_bf16 v[16:19], a[168:171], a[0:3], 0
  ds_read_b64_tr_b16 a[184:185], v227 offset:32768
  v_mfma_f32_16x16x32_bf16 v[16:19], a[172:175], a[16:19], v[16:19]
  v_mfma_f32_16x16x32_bf16 v[20:23], a[172:175], a[20:23], 0
  ds_read_b64_tr_b16 a[186:187], v227 offset:33792
  v_mfma_f32_16x16x32_bf16 v[20:23], a[168:171], a[4:7], v[20:23]
  buffer_load_dwordx4 a[76:79], v242, s[24:27], s30 offen offset:3072 sc1
  v_mfma_f32_16x16x32_bf16 v[24:27], a[168:171], a[8:11], 0
  ds_read_b64_tr_b16 a[188:189], v227 offset:40960
  v_mfma_f32_16x16x32_bf16 v[24:27], a[172:175], a[24:27], v[24:27]
  buffer_load_dwordx4 a[80:83], v243, s[24:27], s30 offen offset:0 sc1
  v_mfma_f32_16x16x32_bf16 v[28:31], a[172:175], a[28:31], 0
  ds_read_b64_tr_b16 a[190:191], v227 offset:41984
  v_mfma_f32_16x16x32_bf16 v[28:31], a[168:171], a[12:15], v[28:31]
  s_waitcnt lgkmcnt(4)
  v_mfma_f32_16x16x32_bf16 v[32:35], a[176:179], a[0:3], 0
  ds_read_b64_tr_b16 a[160:161], v228 offset:32768
  v_mfma_f32_16x16x32_bf16 v[32:35], a[180:183], a[16:19], v[32:35]
  buffer_load_dwordx4 a[84:87], v243, s[24:27], s30 offen offset:1024 sc1
  v_mfma_f32_16x16x32_bf16 v[36:39], a[180:183], a[20:23], 0
  ds_read_b64_tr_b16 a[162:163], v228 offset:33792
  v_mfma_f32_16x16x32_bf16 v[36:39], a[176:179], a[4:7], v[36:39]
  v_mfma_f32_16x16x32_bf16 v[40:43], a[176:179], a[8:11], 0
  ds_read_b64_tr_b16 a[164:165], v228 offset:40960
  v_mfma_f32_16x16x32_bf16 v[40:43], a[180:183], a[24:27], v[40:43]
  buffer_load_dwordx4 a[88:91], v243, s[24:27], s30 offen offset:2048 sc1
  v_mfma_f32_16x16x32_bf16 v[44:47], a[180:183], a[28:31], 0
  ds_read_b64_tr_b16 a[166:167], v228 offset:41984
  v_mfma_f32_16x16x32_bf16 v[44:47], a[176:179], a[12:15], v[44:47]
  s_waitcnt lgkmcnt(4)
  buffer_load_dwordx4 a[92:95], v243, s[24:27], s30 offen offset:3072 sc1
  v_mfma_f32_16x16x32_bf16 v[48:51], a[184:187], a[0:3], 0
  ds_read_b64_tr_b16 a[168:169], v229 offset:32768
  v_mfma_f32_16x16x32_bf16 v[48:51], a[188:191], a[16:19], v[48:51]
  v_mfma_f32_16x16x32_bf16 v[52:55], a[188:191], a[20:23], 0
  ds_read_b64_tr_b16 a[170:171], v229 offset:33792
  v_mfma_f32_16x16x32_bf16 v[52:55], a[184:187], a[4:7], v[52:55]
  s_add_u32 s30, s30, 8192
  v_mfma_f32_16x16x32_bf16 v[56:59], a[184:187], a[8:11], 0
  ds_read_b64_tr_b16 a[172:173], v229 offset:40960
  v_mfma_f32_16x16x32_bf16 v[56:59], a[188:191], a[24:27], v[56:59]
  v_mfma_f32_16x16x32_bf16 v[60:63], a[188:191], a[28:31], 0
  ds_read_b64_tr_b16 a[174:175], v229 offset:41984
  v_mfma_f32_16x16x32_bf16 v[60:63], a[184:187], a[12:15], v[60:63]
  s_waitcnt lgkmcnt(4)
  buffer_load_dwordx4 a[96:99], v242, s[24:27], s30 offen offset:0 sc1
  v_mfma_f32_16x16x32_bf16 v[64:67], a[160:163], a[0:3], 0
  ds_read_b64_tr_b16 a[176:177], v230 offset:32768
  v_mfma_f32_16x16x32_bf16 v[64:67], a[164:167], a[16:19], v[64:67]
  buffer_load_dwordx4 a[100:103], v242, s[24:27], s30 offen offset:1024 sc1
  v_mfma_f32_16x16x32_bf16 v[68:71], a[164:167], a[20:23], 0
  ds_read_b64_tr_b16 a[178:179], v230 offset:33792
  v_mfma_f32_16x16x32_bf16 v[68:71], a[160:163], a[4:7], v[68:71]
  v_mfma_f32_16x16x32_bf16 v[72:75], a[160:163], a[8:11], 0
  ds_read_b64_tr_b16 a[180:181], v230 offset:40960
  v_mfma_f32_16x16x32_bf16 v[72:75], a[164:167], a[24:27], v[72:75]
  buffer_load_dwordx4 a[104:107], v242, s[24:27], s30 offen offset:2048 sc1
  v_mfma_f32_16x16x32_bf16 v[76:79], a[164:167], a[28:31], 0
  ds_read_b64_tr_b16 a[182:183], v230 offset:41984
  v_mfma_f32_16x16x32_bf16 v[76:79], a[160:163], a[12:15], v[76:79]
  s_waitcnt lgkmcnt(4)
  v_mfma_f32_16x16x32_bf16 v[80:83], a[168:171], a[0:3], 0
  ds_read_b64_tr_b16 a[184:185], v231 offset:32768
  v_mfma_f32_16x16x32_bf16 v[80:83], a[172:175], a[16:19], v[80:83]
  buffer_load_dwordx4 a[108:111], v242, s[24:27], s30 offen offset:3072 sc1
  v_mfma_f32_16x16x32_bf16 v[84:87], a[172:175], a[20:23], 0
  ds_read_b64_tr_b16 a[186:187], v231 offset:33792
  v_mfma_f32_16x16x32_bf16 v[84:87], a[168:171], a[4:7], v[84:87]
  buffer_load_dwordx4 a[112:115], v243, s[24:27], s30 offen offset:0 sc1
  v_mfma_f32_16x16x32_bf16 v[88:91], a[168:171], a[8:11], 0
  ds_read_b64_tr_b16 a[188:189], v231 offset:40960
  v_mfma_f32_16x16x32_bf16 v[88:91], a[172:175], a[24:27], v[88:91]
  s_barrier
  v_mfma_f32_16x16x32_bf16 v[92:95], a[172:175], a[28:31], 0
  ds_read_b64_tr_b16 a[190:191], v231 offset:41984
  v_mfma_f32_16x16x32_bf16 v[92:95], a[168:171], a[12:15], v[92:95]
  s_waitcnt lgkmcnt(4)
  buffer_load_dwordx4 a[116:119], v243, s[24:27], s30 offen offset:1024 sc1
  v_mfma_f32_16x16x32_bf16 v[96:99], a[176:179], a[0:3], 0
  ds_read_b64_tr_b16 a[160:161], v224 offset:49152
  v_mfma_f32_16x16x32_bf16 v[96:99], a[180:183], a[16:19], v[96:99]
  v_mfma_f32_16x16x32_bf16 v[100:103], a[180:183], a[20:23], 0
  ds_read_b64_tr_b16 a[162:163], v224 offset:50176
  v_mfma_f32_16x16x32_bf16 v[100:103], a[176:179], a[4:7], v[100:103]
  buffer_load_dwordx4 a[120:123], v243, s[24:27], s30 offen offset:2048 sc1
  v_mfma_f32_16x16x32_bf16 v[104:107], a[176:179], a[8:11], 0
  ds_read_b64_tr_b16 a[164:165], v224 offset:57344
  v_mfma_f32_16x16x32_bf16 v[104:107], a[180:183], a[24:27], v[104:107]
  buffer_load_dwordx4 a[124:127], v243, s[24:27], s30 offen offset:3072 sc1
  v_mfma_f32_16x16x32_bf16 v[108:111], a[180:183], a[28:31], 0
  ds_read_b64_tr_b16 a[166:167], v224 offset:58368
  v_mfma_f32_16x16x32_bf16 v[108:111], a[176:179], a[12:15], v[108:111]
  s_waitcnt lgkmcnt(4)
  v_mfma_f32_16x16x32_bf16 v[112:115], a[184:187], a[0:3], 0
  ds_read_b64_tr_b16 a[168:169], v225 offset:49152
  v_mfma_f32_16x16x32_bf16 v[112:115], a[188:191], a[16:19], v[112:115]
  s_add_u32 s30, s30, 8192
  v_mfma_f32_16x16x32_bf16 v[116:119], a[188:191], a[20:23], 0
  ds_read_b64_tr_b16 a[170:171], v225 offset:50176
  v_mfma_f32_16x16x32_bf16 v[116:119], a[184:187], a[4:7], v[116:119]
  v_mfma_f32_16x16x32_bf16 v[120:123], a[184:187], a[8:11], 0
  ds_read_b64_tr_b16 a[172:173], v225 offset:57344
  v_mfma_f32_16x16x32_bf16 v[120:123], a[188:191], a[24:27], v[120:123]
  v_mfma_f32_16x16x32_bf16 v[124:127], a[188:191], a[28:31], 0
  ds_read_b64_tr_b16 a[174:175], v225 offset:58368
  v_mfma_f32_16x16x32_bf16 v[124:127], a[184:187], a[12:15], v[124:127]
  s_waitcnt vmcnt(17) lgkmcnt(4)
  v_mfma_f32_16x16x32_bf16 v[0:3], a[160:163], a[32:35], v[0:3]
  ds_read_b64_tr_b16 a[176:177], v226 offset:49152
  v_mfma_f32_16x16x32_bf16 v[0:3], a[164:167], a[48:51], v[0:3]
  buffer_load_dwordx4 a[0:3], v242, s[24:27], s30 offen offset:0 sc1
  v_mfma_f32_16x16x32_bf16 v[4:7], a[164:167], a[52:55], v[4:7]
  ds_read_b64_tr_b16 a[178:179], v226 offset:50176
  v_mfma_f32_16x16x32_bf16 v[4:7], a[160:163], a[36:39], v[4:7]
  v_mfma_f32_16x16x32_bf16 v[8:11], a[160:163], a[40:43], v[8:11]
  ds_read_b64_tr_b16 a[180:181], v226 offset:57344
  s_add_u32 m0, s28, 16384
  v_mfma_f32_16x16x32_bf16 v[8:11], a[164:167], a[56:59], v[8:11]
  buffer_load_dwordx4 v238, s[20:23], s31 offen offset:0 lds
  v_mfma_f32_16x16x32_bf16 v[12:15], a[164:167], a[60:63], v[12:15]
  ds_read_b64_tr_b16 a[182:183], v226 offset:58368
  v_mfma_f32_16x16x32_bf16 v[12:15], a[160:163], a[44:47], v[12:15]
  s_waitcnt lgkmcnt(4)
  v_mfma_f32_16x16x32_bf16 v[16:19], a[168:171], a[32:35], v[16:19]
  ds_read_b64_tr_b16 a[184:185], v227 offset:49152
  v_mfma_f32_16x16x32_bf16 v[16:19], a[172:175], a[48:51], v[16:19]
  buffer_load_dwordx4 a[4:7], v242, s[24:27], s30 offen offset:1024 sc1
  v_mfma_f32_16x16x32_bf16 v[20:23], a[172:175], a[52:55], v[20:23]
  ds_read_b64_tr_b16 a[186:187], v227 offset:50176
  v_mfma_f32_16x16x32_bf16 v[20:23], a[168:171], a[36:39], v[20:23]
  v_mfma_f32_16x16x32_bf16 v[24:27], a[168:171], a[40:43], v[24:27]
  ds_read_b64_tr_b16 a[188:189], v227 offset:57344
  v_mfma_f32_16x16x32_bf16 v[24:27], a[172:175], a[56:59], v[24:27]
  v_mfma_f32_16x16x32_bf16 v[28:31], a[172:175], a[60:63], v[28:31]
  ds_read_b64_tr_b16 a[190:191], v227 offset:58368
  v_mfma_f32_16x16x32_bf16 v[28:31], a[168:171], a[44:47], v[28:31]
  s_waitcnt lgkmcnt(4)
  v_mfma_f32_16x16x32_bf16 v[32:35], a[176:179], a[32:35], v[32:35]
  ds_read_b64_tr_b16 a[160:161], v228 offset:49152
  v_mfma_f32_16x16x32_bf16 v[32:35], a[180:183], a[48:51], v[32:35]
  buffer_load_dwordx4 a[8:11], v242, s[24:27], s30 offen offset:2048 sc1
  v_mfma_f32_16x16x32_bf16 v[36:39], a[180:183], a[52:55], v[36:39]
  ds_read_b64_tr_b16 a[162:163], v228 offset:50176
  v_mfma_f32_16x16x32_bf16 v[36:39], a[176:179], a[36:39], v[36:39]
  v_mfma_f32_16x16x32_bf16 v[40:43], a[176:179], a[40:43], v[40:43]
  ds_read_b64_tr_b16 a[164:165], v228 offset:57344
  v_mfma_f32_16x16x32_bf16 v[40:43], a[180:183], a[56:59], v[40:43]
  buffer_load_dwordx4 v239, s[20:23], s31 offen offset:1024 lds
  v_mfma_f32_16x16x32_bf16 v[44:47], a[180:183], a[60:63], v[44:47]
  ds_read_b64_tr_b16 a[166:167], v228 offset:58368
  v_mfma_f32_16x16x32_bf16 v[44:47], a[176:179], a[44:47], v[44:47]
  s_waitcnt lgkmcnt(4)
  v_mfma_f32_16x16x32_bf16 v[48:51], a[184:187], a[32:35], v[48:51]
  ds_read_b64_tr_b16 a[168:169], v229 offset:49152
  v_mfma_f32_16x16x32_bf16 v[48:51], a[188:191], a[48:51], v[48:51]
  buffer_load_dwordx4 a[12:15], v242, s[24:27], s30 offen offset:3072 sc1
  v_mfma_f32_16x16x32_bf16 v[52:55], a[188:191], a[52:55], v[52:55]
  ds_read_b64_tr_b16 a[170:171], v229 offset:50176
  v_mfma_f32_16x16x32_bf16 v[52:55], a[184:187], a[36:39], v[52:55]
  v_mfma_f32_16x16x32_bf16 v[56:59], a[184:187], a[40:43], v[56:59]
  ds_read_b64_tr_b16 a[172:173], v229 offset:57344
  v_mfma_f32_16x16x32_bf16 v[56:59], a[188:191], a[56:59], v[56:59]
  v_mfma_f32_16x16x32_bf16 v[60:63], a[188:191], a[60:63], v[60:63]
  ds_read_b64_tr_b16 a[174:175], v229 offset:58368
  v_mfma_f32_16x16x32_bf16 v[60:63], a[184:187], a[44:47], v[60:63]
  s_waitcnt lgkmcnt(4)
  v_mfma_f32_16x16x32_bf16 v[64:67], a[160:163], a[32:35], v[64:67]
  ds_read_b64_tr_b16 a[176:177], v230 offset:49152
  v_mfma_f32_16x16x32_bf16 v[64:67], a[164:167], a[48:51], v[64:67]
  buffer_load_dwordx4 a[16:19], v243, s[24:27], s30 offen offset:0 sc1
  v_mfma_f32_16x16x32_bf16 v[68:71], a[164:167], a[52:55], v[68:71]
  ds_read_b64_tr_b16 a[178:179], v230 offset:50176
  v_mfma_f32_16x16x32_bf16 v[68:71], a[160:163], a[36:39], v[68:71]
  v_mfma_f32_16x16x32_bf16 v[72:75], a[160:163], a[40:43], v[72:75]
  ds_read_b64_tr_b16 a[180:181], v230 offset:57344
  v_mfma_f32_16x16x32_bf16 v[72:75], a[164:167], a[56:59], v[72:75]
  buffer_load_dwordx4 v240, s[20:23], s31 offen offset:2048 lds
  v_mfma_f32_16x16x32_bf16 v[76:79], a[164:167], a[60:63], v[76:79]
  ds_read_b64_tr_b16 a[182:183], v230 offset:58368
  v_mfma_f32_16x16x32_bf16 v[76:79], a[160:163], a[44:47], v[76:79]
  s_waitcnt lgkmcnt(4)
  v_mfma_f32_16x16x32_bf16 v[80:83], a[168:171], a[32:35], v[80:83]
  ds_read_b64_tr_b16 a[184:185], v231 offset:49152
  v_mfma_f32_16x16x32_bf16 v[80:83], a[172:175], a[48:51], v[80:83]
  buffer_load_dwordx4 a[20:23], v243, s[24:27], s30 offen offset:1024 sc1
  v_mfma_f32_16x16x32_bf16 v[84:87], a[172:175], a[52:55], v[84:87]
  ds_read_b64_tr_b16 a[186:187], v231 offset:50176
  v_mfma_f32_16x16x32_bf16 v[84:87], a[168:171], a[36:39], v[84:87]
  v_mfma_f32_16x16x32_bf16 v[88:91], a[168:171], a[40:43], v[88:91]
  ds_read_b64_tr_b16 a[188:189], v231 offset:57344
  v_mfma_f32_16x16x32_bf16 v[88:91], a[172:175], a[56:59], v[88:91]
  s_barrier
  v_mfma_f32_16x16x32_bf16 v[92:95], a[172:175], a[60:63], v[92:95]
  ds_read_b64_tr_b16 a[190:191], v231 offset:58368
  v_mfma_f32_16x16x32_bf16 v[92:95], a[168:171], a[44:47], v[92:95]
  s_waitcnt lgkmcnt(4)
  v_mfma_f32_16x16x32_bf16 v[96:99], a[176:179], a[32:35], v[96:99]
  ds_read_b64_tr_b16 a[160:161], v144 offset:32768
  v_mfma_f32_16x16x32_bf16 v[96:99], a[180:183], a[48:51], v[96:99]
  buffer_load_dwordx4 a[24:27], v243, s[24:27], s30 offen offset:2048 sc1
  v_mfma_f32_16x16x32_bf16 v[100:103], a[180:183], a[52:55], v[100:103]
  ds_read_b64_tr_b16 a[162:163], v144 offset:33792
  v_mfma_f32_16x16x32_bf16 v[100:103], a[176:179], a[36:39], v[100:103]
  v_mfma_f32_16x16x32_bf16 v[104:107], a[176:179], a[40:43], v[104:107]
  ds_read_b64_tr_b16 a[164:165], v144 offset:40960
  v_mfma_f32_16x16x32_bf16 v[104:107], a[180:183], a[56:59], v[104:107]
  buffer_load_dwordx4 v241, s[20:23], s31 offen offset:3072 lds
  s_add_u32 s31, s31, 0x80000
  v_mfma_f32_16x16x32_bf16 v[108:111], a[180:183], a[60:63], v[108:111]
  ds_read_b64_tr_b16 a[166:167], v144 offset:41984
  v_mfma_f32_16x16x32_bf16 v[108:111], a[176:179], a[44:47], v[108:111]
  s_waitcnt lgkmcnt(4)
  v_mfma_f32_16x16x32_bf16 v[112:115], a[184:187], a[32:35], v[112:115]
  ds_read_b64_tr_b16 a[168:169], v145 offset:32768
  v_mfma_f32_16x16x32_bf16 v[112:115], a[188:191], a[48:51], v[112:115]
  buffer_load_dwordx4 a[28:31], v243, s[24:27], s30 offen offset:3072 sc1
  s_add_u32 s30, s30, 8192
  v_mfma_f32_16x16x32_bf16 v[116:119], a[188:191], a[52:55], v[116:119]
  ds_read_b64_tr_b16 a[170:171], v145 offset:33792
  v_mfma_f32_16x16x32_bf16 v[116:119], a[184:187], a[36:39], v[116:119]
  v_mfma_f32_16x16x32_bf16 v[120:123], a[184:187], a[40:43], v[120:123]
  ds_read_b64_tr_b16 a[172:173], v145 offset:40960
  v_mfma_f32_16x16x32_bf16 v[120:123], a[188:191], a[56:59], v[120:123]
  v_mfma_f32_16x16x32_bf16 v[124:127], a[188:191], a[60:63], v[124:127]
  ds_read_b64_tr_b16 a[174:175], v145 offset:41984
  v_mfma_f32_16x16x32_bf16 v[124:127], a[184:187], a[44:47], v[124:127]
  s_waitcnt vmcnt(20) lgkmcnt(4)
  v_xor_b32 v136, s55, v136
  v_xor_b32 v137, s55, v137
  v_xor_b32 v138, s55, v138
  v_xor_b32 v139, s55, v139
  v_or3_b32 v136, v136, v137, v138
  v_or_b32 v136, v136, v139
  v_cmp_ne_u32 vcc, 0, v136
  s_nop 0
  s_cbranch_vccz front_keys
  s_mov_b32 s54, 32768
front_all:
  s_sleep 2
  buffer_load_dwordx4 v[136:139], v140, s[24:27], s58 offen sc1
  s_waitcnt vmcnt(0)
  v_xor_b32 v136, s55, v136
  v_xor_b32 v137, s55, v137
  v_xor_b32 v138, s55, v138
  v_xor_b32 v139, s55, v139
  v_or3_b32 v136, v136, v137, v138
  v_or_b32 v136, v136, v139
  v_cmp_ne_u32 vcc, 0, v136
  s_nop 0
  s_cbranch_vccz front_keys
  s_sub_u32 s54, s54, 1
  s_cmp_lg_u32 s54, 0
  s_cbranch_scc1 front_all
front_keys:
  s_lshl_b32 s35, s3, 11
  s_add_u32 s35, s35, 2621440
  buffer_load_dwordx4 v[128:131], v242, s[24:27], s35 offen sc1
  buffer_load_dwordx4 v[132:135], v242, s[24:27], s35 offen offset:1024 sc1
  v_mfma_f32_16x16x32_bf16 v[0:3], a[160:163], a[64:67], v[0:3]
  ds_read_b64_tr_b16 a[176:177], v146 offset:32768
  s_add_u32 s59, s59, 1
  s_or_b32 s54, s2, s3
  s_min_u32 s54, s54, 1
  v_mfma_f32_16x16x32_bf16 v[0:3], a[164:167], a[80:83], v[0:3]
  buffer_load_dwordx4 a[32:35], v242, s[24:27], s30 offen offset:0 sc1
  s_lshl_b32 s54, s54, 28
  v_mfma_f32_16x16x32_bf16 v[4:7], a[164:167], a[84:87], v[4:7]
  ds_read_b64_tr_b16 a[178:179], v146 offset:33792
  v_lshlrev_b32 v137, 22, v242
  v_mfma_f32_16x16x32_bf16 v[4:7], a[160:163], a[68:71], v[4:7]
  v_or_b32 v137, s54, v137
  v_mov_b32 v136, s59
  v_mfma_f32_16x16x32_bf16 v[8:11], a[160:163], a[72:75], v[8:11]
  ds_read_b64_tr_b16 a[180:181], v146 offset:40960
  s_add_u32 m0, s28, 0
  s_mov_b32 s58, 2830336
  buffer_store_dword v136, v137, s[24:27], s58 offen sc1
  v_mfma_f32_16x16x32_bf16 v[8:11], a[164:167], a[88:91], v[8:11]
  buffer_load_dwordx4 v238, s[20:23], s31 offen offset:0 lds
  v_mfma_f32_16x16x32_bf16 v[12:15], a[164:167], a[92:95], v[12:15]
  ds_read_b64_tr_b16 a[182:183], v146 offset:41984
  v_mfma_f32_16x16x32_bf16 v[12:15], a[160:163], a[76:79], v[12:15]
  s_waitcnt lgkmcnt(4)
  v_mfma_f32_16x16x32_bf16 v[16:19], a[168:171], a[64:67], v[16:19]
  ds_read_b64_tr_b16 a[184:185], v147 offset:32768
  v_mfma_f32_16x16x32_bf16 v[16:19], a[172:175], a[80:83], v[16:19]
  buffer_load_dwordx4 a[36:39], v242, s[24:27], s30 offen offset:1024 sc1
  v_mfma_f32_16x16x32_bf16 v[20:23], a[172:175], a[84:87], v[20:23]
  ds_read_b64_tr_b16 a[186:187], v147 offset:33792
  v_mfma_f32_16x16x32_bf16 v[20:23], a[168:171], a[68:71], v[20:23]
  v_mfma_f32_16x16x32_bf16 v[24:27], a[168:171], a[72:75], v[24:27]
  ds_read_b64_tr_b16 a[188:189], v147 offset:40960
  v_mfma_f32_16x16x32_bf16 v[24:27], a[172:175], a[88:91], v[24:27]
  v_mfma_f32_16x16x32_bf16 v[28:31], a[172:175], a[92:95], v[28:31]
  ds_read_b64_tr_b16 a[190:191], v147 offset:41984
  v_mfma_f32_16x16x32_bf16 v[28:31], a[168:171], a[76:79], v[28:31]
  s_waitcnt lgkmcnt(4)
  v_mfma_f32_16x16x32_bf16 v[32:35], a[176:179], a[64:67], v[32:35]
  ds_read_b64_tr_b16 a[160:161], v148 offset:32768
  v_mfma_f32_16x16x32_bf16 v[32:35], a[180:183], a[80:83], v[32:35]
  buffer_load_dwordx4 a[40:43], v242, s[24:27], s30 offen offset:2048 sc1
  v_mfma_f32_16x16x32_bf16 v[36:39], a[180:183], a[84:87], v[36:39]
  ds_read_b64_tr_b16 a[162:163], v148 offset:33792
  v_mfma_f32_16x16x32_bf16 v[36:39], a[176:179], a[68:71], v[36:39]
  v_mfma_f32_16x16x32_bf16 v[40:43], a[176:179], a[72:75], v[40:43]
  ds_read_b64_tr_b16 a[164:165], v148 offset:40960
  v_mfma_f32_16x16x32_bf16 v[40:43], a[180:183], a[88:91], v[40:43]
  buffer_load_dwordx4 v239, s[20:23], s31 offen offset:1024 lds
  v_mfma_f32_16x16x32_bf16 v[44:47], a[180:183], a[92:95], v[44:47]
  ds_read_b64_tr_b16 a[166:167], v148 offset:41984
  v_mfma_f32_16x16x32_bf16 v[44:47], a[176:179], a[76:79], v[44:47]
  s_waitcnt lgkmcnt(4)
  v_mfma_f32_16x16x32_bf16 v[48:51], a[184:187], a[64:67], v[48:51]
  ds_read_b64_tr_b16 a[168:169], v149 offset:32768
  v_mfma_f32_16x16x32_bf16 v[48:51], a[188:191], a[80:83], v[48:51]
  buffer_load_dwordx4 a[44:47], v242, s[24:27], s30 offen offset:3072 sc1
  v_mfma_f32_16x16x32_bf16 v[52:55], a[188:191], a[84:87], v[52:55]
  ds_read_b64_tr_b16 a[170:171], v149 offset:33792
  v_mfma_f32_16x16x32_bf16 v[52:55], a[184:187], a[68:71], v[52:55]
  v_mfma_f32_16x16x32_bf16 v[56:59], a[184:187], a[72:75], v[56:59]
  ds_read_b64_tr_b16 a[172:173], v149 offset:40960
  v_mfma_f32_16x16x32_bf16 v[56:59], a[188:191], a[88:91], v[56:59]
  v_mfma_f32_16x16x32_bf16 v[60:63], a[188:191], a[92:95], v[60:63]
  ds_read_b64_tr_b16 a[174:175], v149 offset:41984
  v_mfma_f32_16x16x32_bf16 v[60:63], a[184:187], a[76:79], v[60:63]
  s_waitcnt lgkmcnt(4)
  v_mfma_f32_16x16x32_bf16 v[64:67], a[160:163], a[64:67], v[64:67]
  ds_read_b64_tr_b16 a[176:177], v150 offset:32768
  v_mfma_f32_16x16x32_bf16 v[64:67], a[164:167], a[80:83], v[64:67]
  buffer_load_dwordx4 a[48:51], v243, s[24:27], s30 offen offset:0 sc1
  v_mfma_f32_16x16x32_bf16 v[68:71], a[164:167], a[84:87], v[68:71]
  ds_read_b64_tr_b16 a[178:179], v150 offset:33792
  v_mfma_f32_16x16x32_bf16 v[68:71], a[160:163], a[68:71], v[68:71]
  v_mfma_f32_16x16x32_bf16 v[72:75], a[160:163], a[72:75], v[72:75]
  ds_read_b64_tr_b16 a[180:181], v150 offset:40960
  v_mfma_f32_16x16x32_bf16 v[72:75], a[164:167], a[88:91], v[72:75]
  buffer_load_dwordx4 v240, s[20:23], s31 offen offset:2048 lds
  v_mfma_f32_16x16x32_bf16 v[76:79], a[164:167], a[92:95], v[76:79]
  ds_read_b64_tr_b16 a[182:183], v150 offset:41984
  v_mfma_f32_16x16x32_bf16 v[76:79], a[160:163], a[76:79], v[76:79]
  s_waitcnt lgkmcnt(4)
  v_mfma_f32_16x16x32_bf16 v[80:83], a[168:171], a[64:67], v[80:83]
  ds_read_b64_tr_b16 a[184:185], v151 offset:32768
  v_mfma_f32_16x16x32_bf16 v[80:83], a[172:175], a[80:83], v[80:83]
  buffer_load_dwordx4 a[52:55], v243, s[24:27], s30 offen offset:1024 sc1
  v_mfma_f32_16x16x32_bf16 v[84:87], a[172:175], a[84:87], v[84:87]
  ds_read_b64_tr_b16 a[186:187], v151 offset:33792
  v_mfma_f32_16x16x32_bf16 v[84:87], a[168:171], a[68:71], v[84:87]
  v_mfma_f32_16x16x32_bf16 v[88:91], a[168:171], a[72:75], v[88:91]
  ds_read_b64_tr_b16 a[188:189], v151 offset:40960
  v_mfma_f32_16x16x32_bf16 v[88:91], a[172:175], a[88:91], v[88:91]
  s_barrier
  v_mfma_f32_16x16x32_bf16 v[92:95], a[172:175], a[92:95], v[92:95]
  ds_read_b64_tr_b16 a[190:191], v151 offset:41984
  v_mfma_f32_16x16x32_bf16 v[92:95], a[168:171], a[76:79], v[92:95]
  s_waitcnt lgkmcnt(4)
  v_mfma_f32_16x16x32_bf16 v[96:99], a[176:179], a[64:67], v[96:99]
  ds_read_b64_tr_b16 a[160:161], v144 offset:49152
  v_mfma_f32_16x16x32_bf16 v[96:99], a[180:183], a[80:83], v[96:99]
  buffer_load_dwordx4 a[56:59], v243, s[24:27], s30 offen offset:2048 sc1
  v_mfma_f32_16x16x32_bf16 v[100:103], a[180:183], a[84:87], v[100:103]
  ds_read_b64_tr_b16 a[162:163], v144 offset:50176
  v_mfma_f32_16x16x32_bf16 v[100:103], a[176:179], a[68:71], v[100:103]
  v_mfma_f32_16x16x32_bf16 v[104:107], a[176:179], a[72:75], v[104:107]
  ds_read_b64_tr_b16 a[164:165], v144 offset:57344
  v_mfma_f32_16x16x32_bf16 v[104:107], a[180:183], a[88:91], v[104:107]
  buffer_load_dwordx4 v241, s[20:23], s31 offen offset:3072 lds
  s_add_u32 s31, s31, 0x80000
  v_mfma_f32_16x16x32_bf16 v[108:111], a[180:183], a[92:95], v[108:111]
  ds_read_b64_tr_b16 a[166:167], v144 offset:58368
  v_mfma_f32_16x16x32_bf16 v[108:111], a[176:179], a[76:79], v[108:111]
  s_waitcnt lgkmcnt(4)
  v_mfma_f32_16x16x32_bf16 v[112:115], a[184:187], a[64:67], v[112:115]
  ds_read_b64_tr_b16 a[168:169], v145 offset:49152
  v_mfma_f32_16x16x32_bf16 v[112:115], a[188:191], a[80:83], v[112:115]
  buffer_load_dwordx4 a[60:63], v243, s[24:27], s30 offen offset:3072 sc1
  s_add_u32 s30, s30, 8192
  v_mfma_f32_16x16x32_bf16 v[116:119], a[188:191], a[84:87], v[116:119]
  ds_read_b64_tr_b16 a[170:171], v145 offset:50176
  v_mfma_f32_16x16x32_bf16 v[116:119], a[184:187], a[68:71], v[116:119]
  v_mfma_f32_16x16x32_bf16 v[120:123], a[184:187], a[72:75], v[120:123]
  ds_read_b64_tr_b16 a[172:173], v145 offset:57344
  v_mfma_f32_16x16x32_bf16 v[120:123], a[188:191], a[88:91], v[120:123]
  v_mfma_f32_16x16x32_bf16 v[124:127], a[188:191], a[92:95], v[124:127]
  ds_read_b64_tr_b16 a[174:175], v145 offset:58368
  v_mfma_f32_16x16x32_bf16 v[124:127], a[184:187], a[76:79], v[124:127]
  s_waitcnt vmcnt(27) lgkmcnt(4)
  v_mfma_f32_16x16x32_bf16 v[0:3], a[160:163], a[96:99], v[0:3]
  ds_read_b64_tr_b16 a[176:177], v146 offset:49152
  v_mfma_f32_16x16x32_bf16 v[0:3], a[164:167], a[112:115], v[0:3]
  buffer_load_dwordx4 a[64:67], v242, s[24:27], s30 offen offset:0 sc1
  v_mfma_f32_16x16x32_bf16 v[4:7], a[164:167], a[116:119], v[4:7]
  ds_read_b64_tr_b16 a[178:179], v146 offset:50176
  v_mfma_f32_16x16x32_bf16 v[4:7], a[160:163], a[100:103], v[4:7]
  v_mfma_f32_16x16x32_bf16 v[8:11], a[160:163], a[104:107], v[8:11]
  ds_read_b64_tr_b16 a[180:181], v146 offset:57344
  s_add_u32 m0, s28, 65536
  v_mfma_f32_16x16x32_bf16 v[8:11], a[164:167], a[120:123], v[8:11]
  buffer_load_dwordx4 v238, s[20:23], s31 offen offset:0 lds
  v_mfma_f32_16x16x32_bf16 v[12:15], a[164:167], a[124:127], v[12:15]
  ds_read_b64_tr_b16 a[182:183], v146 offset:58368
  v_mfma_f32_16x16x32_bf16 v[12:15], a[160:163], a[108:111], v[12:15]
  s_waitcnt lgkmcnt(4)
  v_mfma_f32_16x16x32_bf16 v[16:19], a[168:171], a[96:99], v[16:19]
  ds_read_b64_tr_b16 a[184:185], v147 offset:49152
  v_mfma_f32_16x16x32_bf16 v[16:19], a[172:175], a[112:115], v[16:19]
  buffer_load_dwordx4 a[68:71], v242, s[24:27], s30 offen offset:1024 sc1
  v_mfma_f32_16x16x32_bf16 v[20:23], a[172:175], a[116:119], v[20:23]
  ds_read_b64_tr_b16 a[186:187], v147 offset:50176
  v_mfma_f32_16x16x32_bf16 v[20:23], a[168:171], a[100:103], v[20:23]
  v_mfma_f32_16x16x32_bf16 v[24:27], a[168:171], a[104:107], v[24:27]
  ds_read_b64_tr_b16 a[188:189], v147 offset:57344
  v_mfma_f32_16x16x32_bf16 v[24:27], a[172:175], a[120:123], v[24:27]
  v_mfma_f32_16x16x32_bf16 v[28:31], a[172:175], a[124:127], v[28:31]
  ds_read_b64_tr_b16 a[190:191], v147 offset:58368
  v_mfma_f32_16x16x32_bf16 v[28:31], a[168:171], a[108:111], v[28:31]
  s_waitcnt lgkmcnt(4)
  v_mfma_f32_16x16x32_bf16 v[32:35], a[176:179], a[96:99], v[32:35]
  ds_read_b64_tr_b16 a[160:161], v148 offset:49152
  v_mfma_f32_16x16x32_bf16 v[32:35], a[180:183], a[112:115], v[32:35]
  buffer_load_dwordx4 a[72:75], v242, s[24:27], s30 offen offset:2048 sc1
  v_mfma_f32_16x16x32_bf16 v[36:39], a[180:183], a[116:119], v[36:39]
  ds_read_b64_tr_b16 a[162:163], v148 offset:50176
  v_mfma_f32_16x16x32_bf16 v[36:39], a[176:179], a[100:103], v[36:39]
  v_mfma_f32_16x16x32_bf16 v[40:43], a[176:179], a[104:107], v[40:43]
  ds_read_b64_tr_b16 a[164:165], v148 offset:57344
  v_mfma_f32_16x16x32_bf16 v[40:43], a[180:183], a[120:123], v[40:43]
  buffer_load_dwordx4 v239, s[20:23], s31 offen offset:1024 lds
  v_mfma_f32_16x16x32_bf16 v[44:47], a[180:183], a[124:127], v[44:47]
  ds_read_b64_tr_b16 a[166:167], v148 offset:58368
  v_mfma_f32_16x16x32_bf16 v[44:47], a[176:179], a[108:111], v[44:47]
  s_waitcnt lgkmcnt(4)
  v_mfma_f32_16x16x32_bf16 v[48:51], a[184:187], a[96:99], v[48:51]
  ds_read_b64_tr_b16 a[168:169], v149 offset:49152
  v_mfma_f32_16x16x32_bf16 v[48:51], a[188:191], a[112:115], v[48:51]
  buffer_load_dwordx4 a[76:79], v242, s[24:27], s30 offen offset:3072 sc1
  v_mfma_f32_16x16x32_bf16 v[52:55], a[188:191], a[116:119], v[52:55]
  ds_read_b64_tr_b16 a[170:171], v149 offset:50176
  v_mfma_f32_16x16x32_bf16 v[52:55], a[184:187], a[100:103], v[52:55]
  v_mfma_f32_16x16x32_bf16 v[56:59], a[184:187], a[104:107], v[56:59]
  ds_read_b64_tr_b16 a[172:173], v149 offset:57344
  v_mfma_f32_16x16x32_bf16 v[56:59], a[188:191], a[120:123], v[56:59]
  v_mfma_f32_16x16x32_bf16 v[60:63], a[188:191], a[124:127], v[60:63]
  ds_read_b64_tr_b16 a[174:175], v149 offset:58368
  v_mfma_f32_16x16x32_bf16 v[60:63], a[184:187], a[108:111], v[60:63]
  s_waitcnt lgkmcnt(4)
  v_mfma_f32_16x16x32_bf16 v[64:67], a[160:163], a[96:99], v[64:67]
  ds_read_b64_tr_b16 a[176:177], v150 offset:49152
  v_mfma_f32_16x16x32_bf16 v[64:67], a[164:167], a[112:115], v[64:67]
  buffer_load_dwordx4 a[80:83], v243, s[24:27], s30 offen offset:0 sc1
  v_mfma_f32_16x16x32_bf16 v[68:71], a[164:167], a[116:119], v[68:71]
  ds_read_b64_tr_b16 a[178:179], v150 offset:50176
  v_mfma_f32_16x16x32_bf16 v[68:71], a[160:163], a[100:103], v[68:71]
  v_mfma_f32_16x16x32_bf16 v[72:75], a[160:163], a[104:107], v[72:75]
  ds_read_b64_tr_b16 a[180:181], v150 offset:57344
  v_mfma_f32_16x16x32_bf16 v[72:75], a[164:167], a[120:123], v[72:75]
  buffer_load_dwordx4 v240, s[20:23], s31 offen offset:2048 lds
  v_mfma_f32_16x16x32_bf16 v[76:79], a[164:167], a[124:127], v[76:79]
  ds_read_b64_tr_b16 a[182:183], v150 offset:58368
  v_mfma_f32_16x16x32_bf16 v[76:79], a[160:163], a[108:111], v[76:79]
  s_waitcnt lgkmcnt(4)
  v_mfma_f32_16x16x32_bf16 v[80:83], a[168:171], a[96:99], v[80:83]
  ds_read_b64_tr_b16 a[184:185], v151 offset:49152
  v_mfma_f32_16x16x32_bf16 v[80:83], a[172:175], a[112:115], v[80:83]
  buffer_load_dwordx4 a[84:87], v243, s[24:27], s30 offen offset:1024 sc1
  v_mfma_f32_16x16x32_bf16 v[84:87], a[172:175], a[116:119], v[84:87]
  ds_read_b64_tr_b16 a[186:187], v151 offset:50176
  v_mfma_f32_16x16x32_bf16 v[84:87], a[168:171], a[100:103], v[84:87]
  s_waitcnt vmcnt(25)
  v_mfma_f32_16x16x32_bf16 v[88:91], a[168:171], a[104:107], v[88:91]
  ds_read_b64_tr_b16 a[188:189], v151 offset:57344
  v_mfma_f32_16x16x32_bf16 v[88:91], a[172:175], a[120:123], v[88:91]
  s_barrier
  v_mfma_f32_16x16x32_bf16 v[92:95], a[172:175], a[124:127], v[92:95]
  ds_read_b64_tr_b16 a[190:191], v151 offset:58368
  v_mfma_f32_16x16x32_bf16 v[92:95], a[168:171], a[108:111], v[92:95]
  s_waitcnt lgkmcnt(4)
  v_mfma_f32_16x16x32_bf16 v[96:99], a[176:179], a[96:99], v[96:99]
  ds_read_b64_tr_b16 a[160:161], v144 offset:16384
  v_mfma_f32_16x16x32_bf16 v[96:99], a[180:183], a[112:115], v[96:99]
  buffer_load_dwordx4 a[88:91], v243, s[24:27], s30 offen offset:2048 sc1
  v_mfma_f32_16x16x32_bf16 v[100:103], a[180:183], a[116:119], v[100:103]
  ds_read_b64_tr_b16 a[162:163], v144 offset:17408
  v_mfma_f32_16x16x32_bf16 v[100:103], a[176:179], a[100:103], v[100:103]
  v_mfma_f32_16x16x32_bf16 v[104:107], a[176:179], a[104:107], v[104:107]
  ds_read_b64_tr_b16 a[164:165], v144 offset:24576
  v_mfma_f32_16x16x32_bf16 v[104:107], a[180:183], a[120:123], v[104:107]
  buffer_load_dwordx4 v241, s[20:23], s31 offen offset:3072 lds
  s_add_u32 s31, s31, 0x80000
  v_mfma_f32_16x16x32_bf16 v[108:111], a[180:183], a[124:127], v[108:111]
  ds_read_b64_tr_b16 a[166:167], v144 offset:25600
  v_mfma_f32_16x16x32_bf16 v[108:111], a[176:179], a[108:111], v[108:111]
  s_waitcnt lgkmcnt(4)
  v_mfma_f32_16x16x32_bf16 v[112:115], a[184:187], a[96:99], v[112:115]
  ds_read_b64_tr_b16 a[168:169], v145 offset:16384
  v_mfma_f32_16x16x32_bf16 v[112:115], a[188:191], a[112:115], v[112:115]
  buffer_load_dwordx4 a[92:95], v243, s[24:27], s30 offen offset:3072 sc1
  s_add_u32 s30, s30, 8192
  v_mfma_f32_16x16x32_bf16 v[116:119], a[188:191], a[116:119], v[116:119]
  ds_read_b64_tr_b16 a[170:171], v145 offset:17408
  v_mfma_f32_16x16x32_bf16 v[116:119], a[184:187], a[100:103], v[116:119]
  v_mfma_f32_16x16x32_bf16 v[120:123], a[184:187], a[104:107], v[120:123]
  ds_read_b64_tr_b16 a[172:173], v145 offset:24576
  v_mfma_f32_16x16x32_bf16 v[120:123], a[188:191], a[120:123], v[120:123]
  v_mfma_f32_16x16x32_bf16 v[124:127], a[188:191], a[124:127], v[124:127]
  ds_read_b64_tr_b16 a[174:175], v145 offset:25600
  v_mfma_f32_16x16x32_bf16 v[124:127], a[184:187], a[108:111], v[124:127]
  s_waitcnt vmcnt(27) lgkmcnt(4)
  v_mfma_f32_16x16x32_bf16 v[0:3], a[160:163], a[0:3], v[0:3]
  ds_read_b64_tr_b16 a[176:177], v146 offset:16384
  s_waitcnt vmcnt(25)
  s_mov_b32 s51, -1
  v_sub_u32 v137, s51, v128
  v_mfma_f32_16x16x32_bf16 v[0:3], a[164:167], a[16:19], v[0:3]
  buffer_load_dwordx4 a[96:99], v242, s[24:27], s30 offen offset:0 sc1
  v_mfma_f32_16x16x32_bf16 v[4:7], a[164:167], a[20:23], v[4:7]
  ds_read_b64_tr_b16 a[178:179], v146 offset:17408
  v_sub_u32 v138, s51, v129
  v_mfma_f32_16x16x32_bf16 v[4:7], a[160:163], a[4:7], v[4:7]
  v_min_u32 v136, v137, v138
  v_sub_u32 v139, s51, v130
  v_mfma_f32_16x16x32_bf16 v[8:11], a[160:163], a[8:11], v[8:11]
  ds_read_b64_tr_b16 a[180:181], v146 offset:24576
  s_add_u32 m0, s28, 81920
  v_sub_u32 v140, s51, v131
  v_mfma_f32_16x16x32_bf16 v[8:11], a[164:167], a[24:27], v[8:11]
  buffer_load_dwordx4 v238, s[20:23], s31 offen offset:0 lds
  v_mfma_f32_16x16x32_bf16 v[12:15], a[164:167], a[28:31], v[12:15]
  ds_read_b64_tr_b16 a[182:183], v146 offset:25600
  v_min3_u32 v136, v136, v139, v140
  v_mfma_f32_16x16x32_bf16 v[12:15], a[160:163], a[12:15], v[12:15]
  s_waitcnt lgkmcnt(4)
  v_sub_u32 v137, s51, v132
  v_sub_u32 v138, s51, v133
  v_mfma_f32_16x16x32_bf16 v[16:19], a[168:171], a[0:3], v[16:19]
  ds_read_b64_tr_b16 a[184:185], v147 offset:16384
  v_min3_u32 v136, v136, v137, v138
  v_mfma_f32_16x16x32_bf16 v[16:19], a[172:175], a[16:19], v[16:19]
  buffer_load_dwordx4 a[100:103], v242, s[24:27], s30 offen offset:1024 sc1
  v_mfma_f32_16x16x32_bf16 v[20:23], a[172:175], a[20:23], v[20:23]
  ds_read_b64_tr_b16 a[186:187], v147 offset:17408
  v_sub_u32 v139, s51, v134
  v_mfma_f32_16x16x32_bf16 v[20:23], a[168:171], a[4:7], v[20:23]
  v_sub_u32 v140, s51, v135
  v_min3_u32 v136, v136, v139, v140
  v_mfma_f32_16x16x32_bf16 v[24:27], a[168:171], a[8:11], v[24:27]
  ds_read_b64_tr_b16 a[188:189], v147 offset:24576
  v_min_u32_dpp v136, v136, v136 row_ror:8 row_mask:0xf bank_mask:0xf
  v_mfma_f32_16x16x32_bf16 v[24:27], a[172:175], a[24:27], v[24:27]
  v_mfma_f32_16x16x32_bf16 v[28:31], a[172:175], a[28:31], v[28:31]
  ds_read_b64_tr_b16 a[190:191], v147 offset:25600
  v_min_u32_dpp v136, v136, v136 row_ror:4 row_mask:0xf bank_mask:0xf
  v_mfma_f32_16x16x32_bf16 v[28:31], a[168:171], a[12:15], v[28:31]
  s_waitcnt lgkmcnt(4)
  v_min_u32_dpp v136, v136, v136 row_ror:2 row_mask:0xf bank_mask:0xf
  v_mfma_f32_16x16x32_bf16 v[32:35], a[176:179], a[0:3], v[32:35]
  ds_read_b64_tr_b16 a[160:161], v148 offset:16384
  v_min_u32_dpp v136, v136, v136 row_ror:1 row_mask:0xf bank_mask:0xf
  v_mfma_f32_16x16x32_bf16 v[32:35], a[180:183], a[16:19], v[32:35]
  buffer_load_dwordx4 a[104:107], v242, s[24:27], s30 offen offset:2048 sc1
  v_mfma_f32_16x16x32_bf16 v[36:39], a[180:183], a[20:23], v[36:39]
  ds_read_b64_tr_b16 a[162:163], v148 offset:17408
  v_readlane_b32 s98, v136, 0
  v_mfma_f32_16x16x32_bf16 v[36:39], a[176:179], a[4:7], v[36:39]
  v_readlane_b32 s99, v136, 16
  v_readlane_b32 s100, v136, 32
  v_mfma_f32_16x16x32_bf16 v[40:43], a[176:179], a[8:11], v[40:43]
  ds_read_b64_tr_b16 a[164:165], v148 offset:24576
  v_readlane_b32 s101, v136, 48
  v_mfma_f32_16x16x32_bf16 v[40:43], a[180:183], a[24:27], v[40:43]
  buffer_load_dwordx4 v239, s[20:23], s31 offen offset:1024 lds
  s_min_u32 s98, s98, s99
  s_min_u32 s100, s100, s101
  s_min_u32 s98, s98, s100
  v_mfma_f32_16x16x32_bf16 v[44:47], a[180:183], a[28:31], v[44:47]
  ds_read_b64_tr_b16 a[166:167], v148 offset:25600
  s_sub_u32 s52, s51, s98
  s_sub_u32 s51, s52, 1
  v_sub_u32 v137, s51, v128
  v_mfma_f32_16x16x32_bf16 v[44:47], a[176:179], a[12:15], v[44:47]
  s_waitcnt lgkmcnt(4)
  v_sub_u32 v138, s51, v129
  v_min_u32 v136, v137, v138
  v_mfma_f32_16x16x32_bf16 v[48:51], a[184:187], a[0:3], v[48:51]
  ds_read_b64_tr_b16 a[168:169], v149 offset:16384
  v_sub_u32 v139, s51, v130
  v_mfma_f32_16x16x32_bf16 v[48:51], a[188:191], a[16:19], v[48:51]
  buffer_load_dwordx4 a[108:111], v242, s[24:27], s30 offen offset:3072 sc1
  v_mfma_f32_16x16x32_bf16 v[52:55], a[188:191], a[20:23], v[52:55]
  ds_read_b64_tr_b16 a[170:171], v149 offset:17408
  v_sub_u32 v140, s51, v131
  v_mfma_f32_16x16x32_bf16 v[52:55], a[184:187], a[4:7], v[52:55]
  v_min3_u32 v136, v136, v139, v140
  v_sub_u32 v137, s51, v132
  v_mfma_f32_16x16x32_bf16 v[56:59], a[184:187], a[8:11], v[56:59]
  ds_read_b64_tr_b16 a[172:173], v149 offset:24576
  v_sub_u32 v138, s51, v133
  v_mfma_f32_16x16x32_bf16 v[56:59], a[188:191], a[24:27], v[56:59]
  v_min3_u32 v136, v136, v137, v138
  v_sub_u32 v139, s51, v134
  v_mfma_f32_16x16x32_bf16 v[60:63], a[188:191], a[28:31], v[60:63]
  ds_read_b64_tr_b16 a[174:175], v149 offset:25600
  v_sub_u32 v140, s51, v135
  v_mfma_f32_16x16x32_bf16 v[60:63], a[184:187], a[12:15], v[60:63]
  s_waitcnt lgkmcnt(4)
  v_min3_u32 v136, v136, v139, v140
  v_mfma_f32_16x16x32_bf16 v[64:67], a[160:163], a[0:3], v[64:67]
  ds_read_b64_tr_b16 a[176:177], v150 offset:16384
  v_min_u32_dpp v136, v136, v136 row_ror:8 row_mask:0xf bank_mask:0xf
  v_mfma_f32_16x16x32_bf16 v[64:67], a[164:167], a[16:19], v[64:67]
  buffer_load_dwordx4 a[112:115], v243, s[24:27], s30 offen offset:0 sc1
  v_mfma_f32_16x16x32_bf16 v[68:71], a[164:167], a[20:23], v[68:71]
  ds_read_b64_tr_b16 a[178:179], v150 offset:17408
  v_min_u32_dpp v136, v136, v136 row_ror:4 row_mask:0xf bank_mask:0xf
  v_mfma_f32_16x16x32_bf16 v[68:71], a[160:163], a[4:7], v[68:71]
  v_mfma_f32_16x16x32_bf16 v[72:75], a[160:163], a[8:11], v[72:75]
  ds_read_b64_tr_b16 a[180:181], v150 offset:24576
  v_min_u32_dpp v136, v136, v136 row_ror:2 row_mask:0xf bank_mask:0xf
  v_mfma_f32_16x16x32_bf16 v[72:75], a[164:167], a[24:27], v[72:75]
  buffer_load_dwordx4 v240, s[20:23], s31 offen offset:2048 lds
  v_mfma_f32_16x16x32_bf16 v[76:79], a[164:167], a[28:31], v[76:79]
  ds_read_b64_tr_b16 a[182:183], v150 offset:25600
  v_min_u32_dpp v136, v136, v136 row_ror:1 row_mask:0xf bank_mask:0xf
  v_mfma_f32_16x16x32_bf16 v[76:79], a[160:163], a[12:15], v[76:79]
  s_waitcnt lgkmcnt(4)
  v_readlane_b32 s98, v136, 0
  v_readlane_b32 s99, v136, 16
  v_mfma_f32_16x16x32_bf16 v[80:83], a[168:171], a[0:3], v[80:83]
  ds_read_b64_tr_b16 a[184:185], v151 offset:16384
  v_readlane_b32 s100, v136, 32
  v_mfma_f32_16x16x32_bf16 v[80:83], a[172:175], a[16:19], v[80:83]
  buffer_load_dwordx4 a[116:119], v243, s[24:27], s30 offen offset:1024 sc1
  v_mfma_f32_16x16x32_bf16 v[84:87], a[172:175], a[20:23], v[84:87]
  ds_read_b64_tr_b16 a[186:187], v151 offset:17408
  v_readlane_b32 s101, v136, 48
  v_mfma_f32_16x16x32_bf16 v[84:87], a[168:171], a[4:7], v[84:87]
  s_waitcnt vmcnt(22)
  s_min_u32 s98, s98, s99
  s_min_u32 s100, s100, s101
  v_mfma_f32_16x16x32_bf16 v[88:91], a[168:171], a[8:11], v[88:91]
  ds_read_b64_tr_b16 a[188:189], v151 offset:24576
  s_min_u32 s98, s98, s100
  s_sub_u32 s53, s51, s98
  s_sub_u32 s51, s53, 1
  v_sub_u32 v137, s51, v128
  v_mfma_f32_16x16x32_bf16 v[88:91], a[172:175], a[24:27], v[88:91]
  s_barrier
  v_sub_u32 v138, s51, v129
  v_min_u32 v136, v137, v138
  v_mfma_f32_16x16x32_bf16 v[92:95], a[172:175], a[28:31], v[92:95]
  ds_read_b64_tr_b16 a[190:191], v151 offset:25600
  v_sub_u32 v139, s51, v130
  v_mfma_f32_16x16x32_bf16 v[92:95], a[168:171], a[12:15], v[92:95]
  s_waitcnt lgkmcnt(4)
  v_sub_u32 v140, s51, v131
  v_min3_u32 v136, v136, v139, v140
  v_mfma_f32_16x16x32_bf16 v[96:99], a[176:179], a[0:3], v[96:99]
  ds_read_b64_tr_b16 a[160:161], v144 offset:0
  v_sub_u32 v137, s51, v132
  v_mfma_f32_16x16x32_bf16 v[96:99], a[180:183], a[16:19], v[96:99]
  buffer_load_dwordx4 a[120:123], v243, s[24:27], s30 offen offset:2048 sc1
  v_mfma_f32_16x16x32_bf16 v[100:103], a[180:183], a[20:23], v[100:103]
  ds_read_b64_tr_b16 a[162:163], v144 offset:1024
  v_sub_u32 v138, s51, v133
  v_mfma_f32_16x16x32_bf16 v[100:103], a[176:179], a[4:7], v[100:103]
  v_min3_u32 v136, v136, v137, v138
  v_sub_u32 v139, s51, v134
  v_mfma_f32_16x16x32_bf16 v[104:107], a[176:179], a[8:11], v[104:107]
  ds_read_b64_tr_b16 a[164:165], v144 offset:8192
  v_sub_u32 v140, s51, v135
  v_mfma_f32_16x16x32_bf16 v[104:107], a[180:183], a[24:27], v[104:107]
  buffer_load_dwordx4 v241, s[20:23], s31 offen offset:3072 lds
  s_add_u32 s31, s31, 0x80000
  v_mfma_f32_16x16x32_bf16 v[108:111], a[180:183], a[28:31], v[108:111]
  ds_read_b64_tr_b16 a[166:167], v144 offset:9216
  v_min3_u32 v136, v136, v139, v140
  v_mfma_f32_16x16x32_bf16 v[108:111], a[176:179], a[12:15], v[108:111]
  s_waitcnt lgkmcnt(4)
  v_min_u32_dpp v136, v136, v136 row_ror:8 row_mask:0xf bank_mask:0xf
  v_mfma_f32_16x16x32_bf16 v[112:115], a[184:187], a[0:3], v[112:115]
  ds_read_b64_tr_b16 a[168:169], v145 offset:0
  v_min_u32_dpp v136, v136, v136 row_ror:4 row_mask:0xf bank_mask:0xf
  v_mfma_f32_16x16x32_bf16 v[112:115], a[188:191], a[16:19], v[112:115]
  buffer_load_dwordx4 a[124:127], v243, s[24:27], s30 offen offset:3072 sc1
  s_add_u32 s30, s30, 8192
  v_mfma_f32_16x16x32_bf16 v[116:119], a[188:191], a[20:23], v[116:119]
  ds_read_b64_tr_b16 a[170:171], v145 offset:1024
  v_min_u32_dpp v136, v136, v136 row_ror:2 row_mask:0xf bank_mask:0xf
  v_mfma_f32_16x16x32_bf16 v[116:119], a[184:187], a[4:7], v[116:119]
  v_mfma_f32_16x16x32_bf16 v[120:123], a[184:187], a[8:11], v[120:123]
  ds_read_b64_tr_b16 a[172:173], v145 offset:8192
  v_min_u32_dpp v136, v136, v136 row_ror:1 row_mask:0xf bank_mask:0xf
  v_mfma_f32_16x16x32_bf16 v[120:123], a[188:191], a[24:27], v[120:123]
  v_readlane_b32 s98, v136, 0
  v_readlane_b32 s99, v136, 16
  v_mfma_f32_16x16x32_bf16 v[124:127], a[188:191], a[28:31], v[124:127]
  ds_read_b64_tr_b16 a[174:175], v145 offset:9216
  v_readlane_b32 s100, v136, 32
  v_mfma_f32_16x16x32_bf16 v[124:127], a[184:187], a[12:15], v[124:127]
  s_waitcnt vmcnt(24) lgkmcnt(4)
  v_readlane_b32 s101, v136, 48
  v_mfma_f32_16x16x32_bf16 v[0:3], a[160:163], a[32:35], v[0:3]
  ds_read_b64_tr_b16 a[176:177], v146 offset:0
  s_min_u32 s98, s98, s99
  s_min_u32 s100, s100, s101
  s_min_u32 s98, s98, s100
  v_mfma_f32_16x16x32_bf16 v[0:3], a[164:167], a[48:51], v[0:3]
  buffer_load_dwordx4 a[0:3], v242, s[24:27], s30 offen offset:0 sc1
  s_sub_u32 s54, s51, s98
  s_sub_u32 s51, s54, 1
  v_mfma_f32_16x16x32_bf16 v[4:7], a[164:167], a[52:55], v[4:7]
  ds_read_b64_tr_b16 a[178:179], v146 offset:1024
  v_sub_u32 v137, s51, v128
  v_mfma_f32_16x16x32_bf16 v[4:7], a[160:163], a[36:39], v[4:7]
  v_sub_u32 v138, s51, v129
  v_min_u32 v136, v137, v138
  v_mfma_f32_16x16x32_bf16 v[8:11], a[160:163], a[40:43], v[8:11]
  ds_read_b64_tr_b16 a[180:181], v146 offset:8192
  s_add_u32 m0, s28, 98304
  v_sub_u32 v139, s51, v130
  v_mfma_f32_16x16x32_bf16 v[8:11], a[164:167], a[56:59], v[8:11]
  buffer_load_dwordx4 v238, s[20:23], s31 offen offset:0 lds
  v_mfma_f32_16x16x32_bf16 v[12:15], a[164:167], a[60:63], v[12:15]
  ds_read_b64_tr_b16 a[182:183], v146 offset:9216
  v_sub_u32 v140, s51, v131
  v_mfma_f32_16x16x32_bf16 v[12:15], a[160:163], a[44:47], v[12:15]
  s_waitcnt lgkmcnt(4)
  v_min3_u32 v136, v136, v139, v140
  v_sub_u32 v137, s51, v132
  v_mfma_f32_16x16x32_bf16 v[16:19], a[168:171], a[32:35], v[16:19]
  ds_read_b64_tr_b16 a[184:185], v147 offset:0
  v_sub_u32 v138, s51, v133
  v_mfma_f32_16x16x32_bf16 v[16:19], a[172:175], a[48:51], v[16:19]
  buffer_load_dwordx4 a[4:7], v242, s[24:27], s30 offen offset:1024 sc1
  v_mfma_f32_16x16x32_bf16 v[20:23], a[172:175], a[52:55], v[20:23]
  ds_read_b64_tr_b16 a[186:187], v147 offset:1024
  v_min3_u32 v136, v136, v137, v138
  v_mfma_f32_16x16x32_bf16 v[20:23], a[168:171], a[36:39], v[20:23]
  v_sub_u32 v139, s51, v134
  v_sub_u32 v140, s51, v135
  v_mfma_f32_16x16x32_bf16 v[24:27], a[168:171], a[40:43], v[24:27]
  ds_read_b64_tr_b16 a[188:189], v147 offset:8192
  v_min3_u32 v136, v136, v139, v140
  v_mfma_f32_16x16x32_bf16 v[24:27], a[172:175], a[56:59], v[24:27]
  v_mfma_f32_16x16x32_bf16 v[28:31], a[172:175], a[60:63], v[28:31]
  ds_read_b64_tr_b16 a[190:191], v147 offset:9216
  v_min_u32_dpp v136, v136, v136 row_ror:8 row_mask:0xf bank_mask:0xf
  v_mfma_f32_16x16x32_bf16 v[28:31], a[168:171], a[44:47], v[28:31]
  s_waitcnt lgkmcnt(4)
  v_min_u32_dpp v136, v136, v136 row_ror:4 row_mask:0xf bank_mask:0xf
  v_mfma_f32_16x16x32_bf16 v[32:35], a[176:179], a[32:35], v[32:35]
  ds_read_b64_tr_b16 a[160:161], v148 offset:0
  v_min_u32_dpp v136, v136, v136 row_ror:2 row_mask:0xf bank_mask:0xf
  v_mfma_f32_16x16x32_bf16 v[32:35], a[180:183], a[48:51], v[32:35]
  buffer_load_dwordx4 a[8:11], v242, s[24:27], s30 offen offset:2048 sc1
  v_mfma_f32_16x16x32_bf16 v[36:39], a[180:183], a[52:55], v[36:39]
  ds_read_b64_tr_b16 a[162:163], v148 offset:1024
  v_min_u32_dpp v136, v136, v136 row_ror:1 row_mask:0xf bank_mask:0xf
  v_mfma_f32_16x16x32_bf16 v[36:39], a[176:179], a[36:39], v[36:39]
  v_readlane_b32 s98, v136, 0
  v_readlane_b32 s99, v136, 16
  v_mfma_f32_16x16x32_bf16 v[40:43], a[176:179], a[40:43], v[40:43]
  ds_read_b64_tr_b16 a[164:165], v148 offset:8192
  v_readlane_b32 s100, v136, 32
  v_mfma_f32_16x16x32_bf16 v[40:43], a[180:183], a[56:59], v[40:43]
  buffer_load_dwordx4 v239, s[20:23], s31 offen offset:1024 lds
  v_mfma_f32_16x16x32_bf16 v[44:47], a[180:183], a[60:63], v[44:47]
  ds_read_b64_tr_b16 a[166:167], v148 offset:9216
  v_readlane_b32 s101, v136, 48
  v_mfma_f32_16x16x32_bf16 v[44:47], a[176:179], a[44:47], v[44:47]
  s_waitcnt lgkmcnt(4)
  s_min_u32 s98, s98, s99
  s_min_u32 s100, s100, s101
  v_mfma_f32_16x16x32_bf16 v[48:51], a[184:187], a[32:35], v[48:51]
  ds_read_b64_tr_b16 a[168:169], v149 offset:0
  s_min_u32 s98, s98, s100
  s_sub_u32 s55, s51, s98
  s_sub_u32 s51, s55, 1
  v_sub_u32 v137, s51, v128
  v_mfma_f32_16x16x32_bf16 v[48:51], a[188:191], a[48:51], v[48:51]
  buffer_load_dwordx4 a[12:15], v242, s[24:27], s30 offen offset:3072 sc1
  v_mfma_f32_16x16x32_bf16 v[52:55], a[188:191], a[52:55], v[52:55]
  ds_read_b64_tr_b16 a[170:171], v149 offset:1024
  v_sub_u32 v138, s51, v129
  v_mfma_f32_16x16x32_bf16 v[52:55], a[184:187], a[36:39], v[52:55]
  v_min_u32 v136, v137, v138
  v_sub_u32 v139, s51, v130
  v_mfma_f32_16x16x32_bf16 v[56:59], a[184:187], a[40:43], v[56:59]
  ds_read_b64_tr_b16 a[172:173], v149 offset:8192
  v_sub_u32 v140, s51, v131
  v_mfma_f32_16x16x32_bf16 v[56:59], a[188:191], a[56:59], v[56:59]
  v_min3_u32 v136, v136, v139, v140
  v_sub_u32 v137, s51, v132
  v_mfma_f32_16x16x32_bf16 v[60:63], a[188:191], a[60:63], v[60:63]
  ds_read_b64_tr_b16 a[174:175], v149 offset:9216
  v_sub_u32 v138, s51, v133
  v_mfma_f32_16x16x32_bf16 v[60:63], a[184:187], a[44:47], v[60:63]
  s_waitcnt lgkmcnt(4)
  v_min3_u32 v136, v136, v137, v138
  v_sub_u32 v139, s51, v134
  v_mfma_f32_16x16x32_bf16 v[64:67], a[160:163], a[32:35], v[64:67]
  ds_read_b64_tr_b16 a[176:177], v150 offset:0
  v_sub_u32 v140, s51, v135
  v_mfma_f32_16x16x32_bf16 v[64:67], a[164:167], a[48:51], v[64:67]
  buffer_load_dwordx4 a[16:19], v243, s[24:27], s30 offen offset:0 sc1
  v_mfma_f32_16x16x32_bf16 v[68:71], a[164:167], a[52:55], v[68:71]
  ds_read_b64_tr_b16 a[178:179], v150 offset:1024
  v_min3_u32 v136, v136, v139, v140
  v_mfma_f32_16x16x32_bf16 v[68:71], a[160:163], a[36:39], v[68:71]
  v_mfma_f32_16x16x32_bf16 v[72:75], a[160:163], a[40:43], v[72:75]
  ds_read_b64_tr_b16 a[180:181], v150 offset:8192
  v_min_u32_dpp v136, v136, v136 row_ror:8 row_mask:0xf bank_mask:0xf
  v_mfma_f32_16x16x32_bf16 v[72:75], a[164:167], a[56:59], v[72:75]
  buffer_load_dwordx4 v240, s[20:23], s31 offen offset:2048 lds
  v_mfma_f32_16x16x32_bf16 v[76:79], a[164:167], a[60:63], v[76:79]
  ds_read_b64_tr_b16 a[182:183], v150 offset:9216
  v_min_u32_dpp v136, v136, v136 row_ror:4 row_mask:0xf bank_mask:0xf
  v_mfma_f32_16x16x32_bf16 v[76:79], a[160:163], a[44:47], v[76:79]
  s_waitcnt lgkmcnt(4)
  v_min_u32_dpp v136, v136, v136 row_ror:2 row_mask:0xf bank_mask:0xf
  v_mfma_f32_16x16x32_bf16 v[80:83], a[168:171], a[32:35], v[80:83]
  ds_read_b64_tr_b16 a[184:185], v151 offset:0
  v_min_u32_dpp v136, v136, v136 row_ror:1 row_mask:0xf bank_mask:0xf
  v_mfma_f32_16x16x32_bf16 v[80:83], a[172:175], a[48:51], v[80:83]
  buffer_load_dwordx4 a[20:23], v243, s[24:27], s30 offen offset:1024 sc1
  v_mfma_f32_16x16x32_bf16 v[84:87], a[172:175], a[52:55], v[84:87]
  ds_read_b64_tr_b16 a[186:187], v151 offset:1024
  v_readlane_b32 s98, v136, 0
  v_mfma_f32_16x16x32_bf16 v[84:87], a[168:171], a[36:39], v[84:87]
  s_waitcnt vmcnt(22)
  v_readlane_b32 s99, v136, 16
  v_readlane_b32 s100, v136, 32
  v_mfma_f32_16x16x32_bf16 v[88:91], a[168:171], a[40:43], v[88:91]
  ds_read_b64_tr_b16 a[188:189], v151 offset:8192
  v_readlane_b32 s101, v136, 48
  v_mfma_f32_16x16x32_bf16 v[88:91], a[172:175], a[56:59], v[88:91]
  s_barrier
  s_min_u32 s98, s98, s99
  s_min_u32 s100, s100, s101
  v_mfma_f32_16x16x32_bf16 v[92:95], a[172:175], a[60:63], v[92:95]
  ds_read_b64_tr_b16 a[190:191], v151 offset:9216
  s_min_u32 s98, s98, s100
  s_sub_u32 s56, s51, s98
  s_sub_u32 s51, s56, 1
  v_sub_u32 v137, s51, v128
  v_mfma_f32_16x16x32_bf16 v[92:95], a[168:171], a[44:47], v[92:95]
  s_waitcnt lgkmcnt(4)
  v_sub_u32 v138, s51, v129
  v_min_u32 v136, v137, v138
  v_mfma_f32_16x16x32_bf16 v[96:99], a[176:179], a[32:35], v[96:99]
  ds_read_b64_tr_b16 a[160:161], v224 offset:0
  v_sub_u32 v139, s51, v130
  v_mfma_f32_16x16x32_bf16 v[96:99], a[180:183], a[48:51], v[96:99]
  buffer_load_dwordx4 a[24:27], v243, s[24:27], s30 offen offset:2048 sc1
  v_mfma_f32_16x16x32_bf16 v[100:103], a[180:183], a[52:55], v[100:103]
  ds_read_b64_tr_b16 a[162:163], v224 offset:1024
  v_sub_u32 v140, s51, v131
  v_mfma_f32_16x16x32_bf16 v[100:103], a[176:179], a[36:39], v[100:103]
  v_min3_u32 v136, v136, v139, v140
  v_sub_u32 v137, s51, v132
  v_mfma_f32_16x16x32_bf16 v[104:107], a[176:179], a[40:43], v[104:107]
  ds_read_b64_tr_b16 a[164:165], v224 offset:8192
  v_sub_u32 v138, s51, v133
  v_mfma_f32_16x16x32_bf16 v[104:107], a[180:183], a[56:59], v[104:107]
  buffer_load_dwordx4 v241, s[20:23], s31 offen offset:3072 lds
  s_add_u32 s31, s31, 0x80000
  v_mfma_f32_16x16x32_bf16 v[108:111], a[180:183], a[60:63], v[108:111]
  ds_read_b64_tr_b16 a[166:167], v224 offset:9216
  v_min3_u32 v136, v136, v137, v138
  v_mfma_f32_16x16x32_bf16 v[108:111], a[176:179], a[44:47], v[108:111]
  s_waitcnt lgkmcnt(4)
  v_sub_u32 v139, s51, v134
  v_sub_u32 v140, s51, v135
  v_mfma_f32_16x16x32_bf16 v[112:115], a[184:187], a[32:35], v[112:115]
  ds_read_b64_tr_b16 a[168:169], v225 offset:0
  v_min3_u32 v136, v136, v139, v140
  v_mfma_f32_16x16x32_bf16 v[112:115], a[188:191], a[48:51], v[112:115]
  buffer_load_dwordx4 a[28:31], v243, s[24:27], s30 offen offset:3072 sc1
  s_add_u32 s30, s30, 8192
  v_mfma_f32_16x16x32_bf16 v[116:119], a[188:191], a[52:55], v[116:119]
  ds_read_b64_tr_b16 a[170:171], v225 offset:1024
  v_min_u32_dpp v136, v136, v136 row_ror:8 row_mask:0xf bank_mask:0xf
  v_mfma_f32_16x16x32_bf16 v[116:119], a[184:187], a[36:39], v[116:119]
  v_mfma_f32_16x16x32_bf16 v[120:123], a[184:187], a[40:43], v[120:123]
  ds_read_b64_tr_b16 a[172:173], v225 offset:8192
  v_min_u32_dpp v136, v136, v136 row_ror:4 row_mask:0xf bank_mask:0xf
  v_mfma_f32_16x16x32_bf16 v[120:123], a[188:191], a[56:59], v[120:123]
  v_mfma_f32_16x16x32_bf16 v[124:127], a[188:191], a[60:63], v[124:127]
  ds_read_b64_tr_b16 a[174:175], v225 offset:9216
  v_min_u32_dpp v136, v136, v136 row_ror:2 row_mask:0xf bank_mask:0xf
  v_mfma_f32_16x16x32_bf16 v[124:127], a[184:187], a[44:47], v[124:127]
  s_waitcnt vmcnt(24) lgkmcnt(4)
  v_min_u32_dpp v136, v136, v136 row_ror:1 row_mask:0xf bank_mask:0xf
  v_mfma_f32_16x16x32_bf16 v[0:3], a[160:163], a[64:67], v[0:3]
  ds_read_b64_tr_b16 a[176:177], v226 offset:0
  v_readlane_b32 s98, v136, 0
  v_mfma_f32_16x16x32_bf16 v[0:3], a[164:167], a[80:83], v[0:3]
  buffer_load_dwordx4 a[32:35], v242, s[24:27], s30 offen offset:0 sc1
  v_mfma_f32_16x16x32_bf16 v[4:7], a[164:167], a[84:87], v[4:7]
  ds_read_b64_tr_b16 a[178:179], v226 offset:1024
  v_readlane_b32 s99, v136, 16
  v_mfma_f32_16x16x32_bf16 v[4:7], a[160:163], a[68:71], v[4:7]
  v_readlane_b32 s100, v136, 32
  v_readlane_b32 s101, v136, 48
  v_mfma_f32_16x16x32_bf16 v[8:11], a[160:163], a[72:75], v[8:11]
  ds_read_b64_tr_b16 a[180:181], v226 offset:8192
  s_add_u32 m0, s28, 114688
  s_min_u32 s98, s98, s99
  s_min_u32 s100, s100, s101
  v_mfma_f32_16x16x32_bf16 v[8:11], a[164:167], a[88:91], v[8:11]
  buffer_load_dwordx4 v238, s[20:23], s31 offen offset:0 lds
  s_min_u32 s98, s98, s100
  s_sub_u32 s57, s51, s98
  s_sub_u32 s51, s57, 1
  v_mfma_f32_16x16x32_bf16 v[12:15], a[164:167], a[92:95], v[12:15]
  ds_read_b64_tr_b16 a[182:183], v226 offset:9216
  v_sub_u32 v137, s51, v128
  v_mfma_f32_16x16x32_bf16 v[12:15], a[160:163], a[76:79], v[12:15]
  s_waitcnt lgkmcnt(4)
  v_sub_u32 v138, s51, v129
  v_min_u32 v136, v137, v138
  v_mfma_f32_16x16x32_bf16 v[16:19], a[168:171], a[64:67], v[16:19]
  ds_read_b64_tr_b16 a[184:185], v227 offset:0
  v_sub_u32 v139, s51, v130
  v_mfma_f32_16x16x32_bf16 v[16:19], a[172:175], a[80:83], v[16:19]
  buffer_load_dwordx4 a[36:39], v242, s[24:27], s30 offen offset:1024 sc1
  v_mfma_f32_16x16x32_bf16 v[20:23], a[172:175], a[84:87], v[20:23]
  ds_read_b64_tr_b16 a[186:187], v227 offset:1024
  v_sub_u32 v140, s51, v131
  v_mfma_f32_16x16x32_bf16 v[20:23], a[168:171], a[68:71], v[20:23]
  v_min3_u32 v136, v136, v139, v140
  v_sub_u32 v137, s51, v132
  v_mfma_f32_16x16x32_bf16 v[24:27], a[168:171], a[72:75], v[24:27]
  ds_read_b64_tr_b16 a[188:189], v227 offset:8192
  v_sub_u32 v138, s51, v133
  v_mfma_f32_16x16x32_bf16 v[24:27], a[172:175], a[88:91], v[24:27]
  v_min3_u32 v136, v136, v137, v138
  v_sub_u32 v139, s51, v134
  v_mfma_f32_16x16x32_bf16 v[28:31], a[172:175], a[92:95], v[28:31]
  ds_read_b64_tr_b16 a[190:191], v227 offset:9216
  v_sub_u32 v140, s51, v135
  v_mfma_f32_16x16x32_bf16 v[28:31], a[168:171], a[76:79], v[28:31]
  s_waitcnt lgkmcnt(4)
  v_min3_u32 v136, v136, v139, v140
  v_mfma_f32_16x16x32_bf16 v[32:35], a[176:179], a[64:67], v[32:35]
  ds_read_b64_tr_b16 a[160:161], v228 offset:0
  v_min_u32_dpp v136, v136, v136 row_ror:8 row_mask:0xf bank_mask:0xf
  v_mfma_f32_16x16x32_bf16 v[32:35], a[180:183], a[80:83], v[32:35]
  buffer_load_dwordx4 a[40:43], v242, s[24:27], s30 offen offset:2048 sc1
  v_mfma_f32_16x16x32_bf16 v[36:39], a[180:183], a[84:87], v[36:39]
  ds_read_b64_tr_b16 a[162:163], v228 offset:1024
  v_min_u32_dpp v136, v136, v136 row_ror:4 row_mask:0xf bank_mask:0xf
  v_mfma_f32_16x16x32_bf16 v[36:39], a[176:179], a[68:71], v[36:39]
  v_mfma_f32_16x16x32_bf16 v[40:43], a[176:179], a[72:75], v[40:43]
  ds_read_b64_tr_b16 a[164:165], v228 offset:8192
  v_min_u32_dpp v136, v136, v136 row_ror:2 row_mask:0xf bank_mask:0xf
  v_mfma_f32_16x16x32_bf16 v[40:43], a[180:183], a[88:91], v[40:43]
  buffer_load_dwordx4 v239, s[20:23], s31 offen offset:1024 lds
  v_mfma_f32_16x16x32_bf16 v[44:47], a[180:183], a[92:95], v[44:47]
  ds_read_b64_tr_b16 a[166:167], v228 offset:9216
  v_min_u32_dpp v136, v136, v136 row_ror:1 row_mask:0xf bank_mask:0xf
  v_mfma_f32_16x16x32_bf16 v[44:47], a[176:179], a[76:79], v[44:47]
  s_waitcnt lgkmcnt(4)
  v_readlane_b32 s98, v136, 0
  v_readlane_b32 s99, v136, 16
  v_mfma_f32_16x16x32_bf16 v[48:51], a[184:187], a[64:67], v[48:51]
  ds_read_b64_tr_b16 a[168:169], v229 offset:0
  v_readlane_b32 s100, v136, 32
  v_mfma_f32_16x16x32_bf16 v[48:51], a[188:191], a[80:83], v[48:51]
  buffer_load_dwordx4 a[44:47], v242, s[24:27], s30 offen offset:3072 sc1
  v_mfma_f32_16x16x32_bf16 v[52:55], a[188:191], a[84:87], v[52:55]
  ds_read_b64_tr_b16 a[170:171], v229 offset:1024
  v_readlane_b32 s101, v136, 48
  v_mfma_f32_16x16x32_bf16 v[52:55], a[184:187], a[68:71], v[52:55]
  s_min_u32 s98, s98, s99
  s_min_u32 s100, s100, s101
  s_min_u32 s98, s98, s100
  v_mfma_f32_16x16x32_bf16 v[56:59], a[184:187], a[72:75], v[56:59]
  ds_read_b64_tr_b16 a[172:173], v229 offset:8192
  s_sub_u32 s58, s51, s98
  s_sub_u32 s51, s58, 1
  v_sub_u32 v137, s51, v128
  v_mfma_f32_16x16x32_bf16 v[56:59], a[188:191], a[88:91], v[56:59]
  v_sub_u32 v138, s51, v129
  v_min_u32 v136, v137, v138
  v_mfma_f32_16x16x32_bf16 v[60:63], a[188:191], a[92:95], v[60:63]
  ds_read_b64_tr_b16 a[174:175], v229 offset:9216
  v_sub_u32 v139, s51, v130
  v_mfma_f32_16x16x32_bf16 v[60:63], a[184:187], a[76:79], v[60:63]
  s_waitcnt lgkmcnt(4)
  v_sub_u32 v140, s51, v131
  v_min3_u32 v136, v136, v139, v140
  v_mfma_f32_16x16x32_bf16 v[64:67], a[160:163], a[64:67], v[64:67]
  ds_read_b64_tr_b16 a[176:177], v230 offset:0
  v_sub_u32 v137, s51, v132
  v_mfma_f32_16x16x32_bf16 v[64:67], a[164:167], a[80:83], v[64:67]
  buffer_load_dwordx4 a[48:51], v243, s[24:27], s30 offen offset:0 sc1
  v_mfma_f32_16x16x32_bf16 v[68:71], a[164:167], a[84:87], v[68:71]
  ds_read_b64_tr_b16 a[178:179], v230 offset:1024
  v_sub_u32 v138, s51, v133
  v_mfma_f32_16x16x32_bf16 v[68:71], a[160:163], a[68:71], v[68:71]
  v_min3_u32 v136, v136, v137, v138
  v_sub_u32 v139, s51, v134
  v_mfma_f32_16x16x32_bf16 v[72:75], a[160:163], a[72:75], v[72:75]
  ds_read_b64_tr_b16 a[180:181], v230 offset:8192
  v_sub_u32 v140, s51, v135
  v_mfma_f32_16x16x32_bf16 v[72:75], a[164:167], a[88:91], v[72:75]
  buffer_load_dwordx4 v240, s[20:23], s31 offen offset:2048 lds
  v_mfma_f32_16x16x32_bf16 v[76:79], a[164:167], a[92:95], v[76:79]
  ds_read_b64_tr_b16 a[182:183], v230 offset:9216
  v_min3_u32 v136, v136, v139, v140
  v_mfma_f32_16x16x32_bf16 v[76:79], a[160:163], a[76:79], v[76:79]
  s_waitcnt lgkmcnt(4)
  v_min_u32_dpp v136, v136, v136 row_ror:8 row_mask:0xf bank_mask:0xf
  v_mfma_f32_16x16x32_bf16 v[80:83], a[168:171], a[64:67], v[80:83]
  ds_read_b64_tr_b16 a[184:185], v231 offset:0
  v_min_u32_dpp v136, v136, v136 row_ror:4 row_mask:0xf bank_mask:0xf
  v_mfma_f32_16x16x32_bf16 v[80:83], a[172:175], a[80:83], v[80:83]
  buffer_load_dwordx4 a[52:55], v243, s[24:27], s30 offen offset:1024 sc1
  v_mfma_f32_16x16x32_bf16 v[84:87], a[172:175], a[84:87], v[84:87]
  ds_read_b64_tr_b16 a[186:187], v231 offset:1024
  v_min_u32_dpp v136, v136, v136 row_ror:2 row_mask:0xf bank_mask:0xf
  v_mfma_f32_16x16x32_bf16 v[84:87], a[168:171], a[68:71], v[84:87]
  s_waitcnt vmcnt(22)
  v_min_u32_dpp v136, v136, v136 row_ror:1 row_mask:0xf bank_mask:0xf
  v_mfma_f32_16x16x32_bf16 v[88:91], a[168:171], a[72:75], v[88:91]
  ds_read_b64_tr_b16 a[188:189], v231 offset:8192
  v_readlane_b32 s98, v136, 0
  v_readlane_b32 s99, v136, 16
  v_readlane_b32 s100, v136, 32
  v_readlane_b32 s101, v136, 48
  s_min_u32 s98, s98, s99
  s_min_u32 s100, s100, s101
  s_min_u32 s98, s98, s100
  s_sub_u32 s59, s51, s98
  s_sub_u32 s51, s59, 1
  v_writelane_b32 v136, s52, 0
  v_writelane_b32 v136, s53, 1
  v_writelane_b32 v136, s54, 2
  v_writelane_b32 v136, s55, 3
  v_writelane_b32 v136, s56, 4
  v_writelane_b32 v136, s57, 5
  v_writelane_b32 v136, s58, 6
  v_writelane_b32 v136, s59, 7
  s_lshl_b32 s35, s3, 8
  s_add_u32 s35, s35, 158720
  v_lshrrev_b32 v137, 2, v242
  v_add_u32 v137, s35, v137
  ds_write_b32 v137, v136
  s_waitcnt lgkmcnt(0)
  v_mfma_f32_16x16x32_bf16 v[88:91], a[172:175], a[88:91], v[88:91]
  s_barrier
  v_mfma_f32_16x16x32_bf16 v[92:95], a[172:175], a[92:95], v[92:95]
  ds_read_b64_tr_b16 a[190:191], v231 offset:9216
  v_mfma_f32_16x16x32_bf16 v[92:95], a[168:171], a[76:79], v[92:95]
  v_mfma_f32_16x16x32_bf16 v[96:99], a[176:179], a[64:67], v[96:99]
  ds_read_b64_tr_b16 a[160:161], v224 offset:16384
  v_mfma_f32_16x16x32_bf16 v[96:99], a[180:183], a[80:83], v[96:99]
  buffer_load_dwordx4 a[56:59], v243, s[24:27], s30 offen offset:2048 sc1
  v_mfma_f32_16x16x32_bf16 v[100:103], a[180:183], a[84:87], v[100:103]
  ds_read_b64_tr_b16 a[162:163], v224 offset:17408
  v_mfma_f32_16x16x32_bf16 v[100:103], a[176:179], a[68:71], v[100:103]
  v_mfma_f32_16x16x32_bf16 v[104:107], a[176:179], a[72:75], v[104:107]
  ds_read_b64_tr_b16 a[164:165], v224 offset:24576
  v_mfma_f32_16x16x32_bf16 v[104:107], a[180:183], a[88:91], v[104:107]
  buffer_load_dwordx4 v241, s[20:23], s31 offen offset:3072 lds
  s_add_u32 s31, s31, 0x80000
  v_mfma_f32_16x16x32_bf16 v[108:111], a[180:183], a[92:95], v[108:111]
  ds_read_b64_tr_b16 a[166:167], v224 offset:25600
  v_mfma_f32_16x16x32_bf16 v[108:111], a[176:179], a[76:79], v[108:111]
  s_waitcnt lgkmcnt(4)
  v_mfma_f32_16x16x32_bf16 v[112:115], a[184:187], a[64:67], v[112:115]
  ds_read_b64_tr_b16 a[168:169], v225 offset:16384
  v_mfma_f32_16x16x32_bf16 v[112:115], a[188:191], a[80:83], v[112:115]
  buffer_load_dwordx4 a[60:63], v243, s[24:27], s30 offen offset:3072 sc1
  s_add_u32 s30, s30, 8192
  v_mfma_f32_16x16x32_bf16 v[116:119], a[188:191], a[84:87], v[116:119]
  ds_read_b64_tr_b16 a[170:171], v225 offset:17408
  v_mfma_f32_16x16x32_bf16 v[116:119], a[184:187], a[68:71], v[116:119]
  v_mfma_f32_16x16x32_bf16 v[120:123], a[184:187], a[72:75], v[120:123]
  ds_read_b64_tr_b16 a[172:173], v225 offset:24576
  v_mfma_f32_16x16x32_bf16 v[120:123], a[188:191], a[88:91], v[120:123]
  v_mfma_f32_16x16x32_bf16 v[124:127], a[188:191], a[92:95], v[124:127]
  ds_read_b64_tr_b16 a[174:175], v225 offset:25600
  v_mfma_f32_16x16x32_bf16 v[124:127], a[184:187], a[76:79], v[124:127]
  s_waitcnt vmcnt(24) lgkmcnt(4)
  v_mfma_f32_16x16x32_bf16 v[0:3], a[160:163], a[96:99], v[0:3]
  ds_read_b64_tr_b16 a[176:177], v226 offset:16384
  v_lshrrev_b32 v136, 4, v242
  v_mfma_f32_16x16x32_bf16 v[0:3], a[164:167], a[112:115], v[0:3]
  v_bfe_u32 v137, v136, 3, 2
  v_and_b32 v138, 7, v136
  v_mfma_f32_16x16x32_bf16 v[4:7], a[164:167], a[116:119], v[4:7]
  ds_read_b64_tr_b16 a[178:179], v226 offset:17408
  v_lshlrev_b32 v137, 8, v137
  v_mfma_f32_16x16x32_bf16 v[4:7], a[160:163], a[100:103], v[4:7]
  v_lshl_add_u32 v137, v138, 2, v137
  v_add_u32 v137, 158720, v137
  v_mfma_f32_16x16x32_bf16 v[8:11], a[160:163], a[104:107], v[8:11]
  ds_read_b64_tr_b16 a[180:181], v226 offset:24576
  s_add_u32 m0, s28, 0
  ds_read_b32 v128, v137
  v_mfma_f32_16x16x32_bf16 v[8:11], a[164:167], a[120:123], v[8:11]
  buffer_load_dwordx4 v232, s[12:15], s29 offen offset:0 lds
  v_mfma_f32_16x16x32_bf16 v[12:15], a[164:167], a[124:127], v[12:15]
  ds_read_b64_tr_b16 a[182:183], v226 offset:25600
  v_mfma_f32_16x16x32_bf16 v[12:15], a[160:163], a[108:111], v[12:15]
  s_waitcnt lgkmcnt(5)
  v_mfma_f32_16x16x32_bf16 v[16:19], a[168:171], a[96:99], v[16:19]
  ds_read_b64_tr_b16 a[184:185], v227 offset:16384
  v_mfma_f32_16x16x32_bf16 v[16:19], a[172:175], a[112:115], v[16:19]
  v_mfma_f32_16x16x32_bf16 v[20:23], a[172:175], a[116:119], v[20:23]
  ds_read_b64_tr_b16 a[186:187], v227 offset:17408
  v_mfma_f32_16x16x32_bf16 v[20:23], a[168:171], a[100:103], v[20:23]
  v_mfma_f32_16x16x32_bf16 v[24:27], a[168:171], a[104:107], v[24:27]
  ds_read_b64_tr_b16 a[188:189], v227 offset:24576
  s_waitcnt lgkmcnt(4)
  s_mov_b32 s51, -1
  v_sub_u32 v137, s51, v128
  v_mfma_f32_16x16x32_bf16 v[24:27], a[172:175], a[120:123], v[24:27]
  v_mfma_f32_16x16x32_bf16 v[28:31], a[172:175], a[124:127], v[28:31]
  ds_read_b64_tr_b16 a[190:191], v227 offset:25600
  v_min_u32_dpp v137, v137, v137 row_ror:8 row_mask:0xf bank_mask:0xf
  v_mfma_f32_16x16x32_bf16 v[28:31], a[168:171], a[108:111], v[28:31]
  s_waitcnt lgkmcnt(4)
  v_min_u32_dpp v137, v137, v137 row_ror:4 row_mask:0xf bank_mask:0xf
  v_mfma_f32_16x16x32_bf16 v[32:35], a[176:179], a[96:99], v[32:35]
  ds_read_b64_tr_b16 a[160:161], v228 offset:16384
  v_min_u32_dpp v137, v137, v137 row_ror:2 row_mask:0xf bank_mask:0xf
  v_mfma_f32_16x16x32_bf16 v[32:35], a[180:183], a[112:115], v[32:35]
  v_mfma_f32_16x16x32_bf16 v[36:39], a[180:183], a[116:119], v[36:39]
  ds_read_b64_tr_b16 a[162:163], v228 offset:17408
  v_min_u32_dpp v137, v137, v137 row_ror:1 row_mask:0xf bank_mask:0xf
  v_mfma_f32_16x16x32_bf16 v[36:39], a[176:179], a[100:103], v[36:39]
  v_readlane_b32 s98, v137, 0
  v_readlane_b32 s99, v137, 16
  v_mfma_f32_16x16x32_bf16 v[40:43], a[176:179], a[104:107], v[40:43]
  ds_read_b64_tr_b16 a[164:165], v228 offset:24576
  s_min_u32 s98, s98, s99
  s_sub_u32 s52, s51, s98
  s_sub_u32 s51, s52, 1
  v_sub_u32 v137, s51, v128
  v_mfma_f32_16x16x32_bf16 v[40:43], a[180:183], a[120:123], v[40:43]
  buffer_load_dwordx4 v233, s[12:15], s29 offen offset:1024 lds
  v_mfma_f32_16x16x32_bf16 v[44:47], a[180:183], a[124:127], v[44:47]
  ds_read_b64_tr_b16 a[166:167], v228 offset:25600
  v_min_u32_dpp v137, v137, v137 row_ror:8 row_mask:0xf bank_mask:0xf
  v_mfma_f32_16x16x32_bf16 v[44:47], a[176:179], a[108:111], v[44:47]
  s_waitcnt lgkmcnt(4)
  v_min_u32_dpp v137, v137, v137 row_ror:4 row_mask:0xf bank_mask:0xf
  v_mfma_f32_16x16x32_bf16 v[48:51], a[184:187], a[96:99], v[48:51]
  ds_read_b64_tr_b16 a[168:169], v229 offset:16384
  v_min_u32_dpp v137, v137, v137 row_ror:2 row_mask:0xf bank_mask:0xf
  v_mfma_f32_16x16x32_bf16 v[48:51], a[188:191], a[112:115], v[48:51]
  v_mfma_f32_16x16x32_bf16 v[52:55], a[188:191], a[116:119], v[52:55]
  ds_read_b64_tr_b16 a[170:171], v229 offset:17408
  v_min_u32_dpp v137, v137, v137 row_ror:1 row_mask:0xf bank_mask:0xf
  v_mfma_f32_16x16x32_bf16 v[52:55], a[184:187], a[100:103], v[52:55]
  v_readlane_b32 s98, v137, 0
  v_readlane_b32 s99, v137, 16
  v_mfma_f32_16x16x32_bf16 v[56:59], a[184:187], a[104:107], v[56:59]
  ds_read_b64_tr_b16 a[172:173], v229 offset:24576
  s_min_u32 s98, s98, s99
  s_sub_u32 s53, s51, s98
  s_sub_u32 s51, s53, 1
  v_sub_u32 v137, s51, v128
  v_mfma_f32_16x16x32_bf16 v[56:59], a[188:191], a[120:123], v[56:59]
  v_mfma_f32_16x16x32_bf16 v[60:63], a[188:191], a[124:127], v[60:63]
  ds_read_b64_tr_b16 a[174:175], v229 offset:25600
  v_min_u32_dpp v137, v137, v137 row_ror:8 row_mask:0xf bank_mask:0xf
  v_mfma_f32_16x16x32_bf16 v[60:63], a[184:187], a[108:111], v[60:63]
  s_waitcnt lgkmcnt(4)
  v_min_u32_dpp v137, v137, v137 row_ror:4 row_mask:0xf bank_mask:0xf
  v_mfma_f32_16x16x32_bf16 v[64:67], a[160:163], a[96:99], v[64:67]
  ds_read_b64_tr_b16 a[176:177], v230 offset:16384
  v_min_u32_dpp v137, v137, v137 row_ror:2 row_mask:0xf bank_mask:0xf
  v_mfma_f32_16x16x32_bf16 v[64:67], a[164:167], a[112:115], v[64:67]
  v_mfma_f32_16x16x32_bf16 v[68:71], a[164:167], a[116:119], v[68:71]
  ds_read_b64_tr_b16 a[178:179], v230 offset:17408
  v_min_u32_dpp v137, v137, v137 row_ror:1 row_mask:0xf bank_mask:0xf
  v_mfma_f32_16x16x32_bf16 v[68:71], a[160:163], a[100:103], v[68:71]
  v_readlane_b32 s98, v137, 0
  v_readlane_b32 s99, v137, 16
  v_mfma_f32_16x16x32_bf16 v[72:75], a[160:163], a[104:107], v[72:75]
  ds_read_b64_tr_b16 a[180:181], v230 offset:24576
  s_min_u32 s98, s98, s99
  s_sub_u32 s54, s51, s98
  s_sub_u32 s51, s54, 1
  v_sub_u32 v137, s51, v128
  v_mfma_f32_16x16x32_bf16 v[72:75], a[164:167], a[120:123], v[72:75]
  buffer_load_dwordx4 v234, s[12:15], s29 offen offset:2048 lds
  v_mfma_f32_16x16x32_bf16 v[76:79], a[164:167], a[124:127], v[76:79]
  ds_read_b64_tr_b16 a[182:183], v230 offset:25600
  v_min_u32_dpp v137, v137, v137 row_ror:8 row_mask:0xf bank_mask:0xf
  v_mfma_f32_16x16x32_bf16 v[76:79], a[160:163], a[108:111], v[76:79]
  s_waitcnt lgkmcnt(4)
  v_min_u32_dpp v137, v137, v137 row_ror:4 row_mask:0xf bank_mask:0xf
  v_mfma_f32_16x16x32_bf16 v[80:83], a[168:171], a[96:99], v[80:83]
  ds_read_b64_tr_b16 a[184:185], v231 offset:16384
  v_min_u32_dpp v137, v137, v137 row_ror:2 row_mask:0xf bank_mask:0xf
  v_mfma_f32_16x16x32_bf16 v[80:83], a[172:175], a[112:115], v[80:83]
  v_mfma_f32_16x16x32_bf16 v[84:87], a[172:175], a[116:119], v[84:87]
  ds_read_b64_tr_b16 a[186:187], v231 offset:17408
  v_min_u32_dpp v137, v137, v137 row_ror:1 row_mask:0xf bank_mask:0xf
  v_mfma_f32_16x16x32_bf16 v[84:87], a[168:171], a[100:103], v[84:87]
  s_waitcnt vmcnt(16)
  v_readlane_b32 s98, v137, 0
  v_readlane_b32 s99, v137, 16
  v_mfma_f32_16x16x32_bf16 v[88:91], a[168:171], a[104:107], v[88:91]
  ds_read_b64_tr_b16 a[188:189], v231 offset:24576
  s_min_u32 s98, s98, s99
  s_sub_u32 s55, s51, s98
  s_sub_u32 s51, s55, 1
  v_sub_u32 v137, s51, v128
  v_mfma_f32_16x16x32_bf16 v[88:91], a[172:175], a[120:123], v[88:91]
  s_barrier
  v_min_u32_dpp v137, v137, v137 row_ror:8 row_mask:0xf bank_mask:0xf
  v_mfma_f32_16x16x32_bf16 v[92:95], a[172:175], a[124:127], v[92:95]
  ds_read_b64_tr_b16 a[190:191], v231 offset:25600
  v_min_u32_dpp v137, v137, v137 row_ror:4 row_mask:0xf bank_mask:0xf
  v_mfma_f32_16x16x32_bf16 v[92:95], a[168:171], a[108:111], v[92:95]
  s_waitcnt lgkmcnt(4)
  v_min_u32_dpp v137, v137, v137 row_ror:2 row_mask:0xf bank_mask:0xf
  v_mfma_f32_16x16x32_bf16 v[96:99], a[176:179], a[96:99], v[96:99]
  ds_read_b64_tr_b16 a[160:161], v224 offset:32768
  v_min_u32_dpp v137, v137, v137 row_ror:1 row_mask:0xf bank_mask:0xf
  v_mfma_f32_16x16x32_bf16 v[96:99], a[180:183], a[112:115], v[96:99]
  v_readlane_b32 s98, v137, 0
  v_readlane_b32 s99, v137, 16
  v_mfma_f32_16x16x32_bf16 v[100:103], a[180:183], a[116:119], v[100:103]
  ds_read_b64_tr_b16 a[162:163], v224 offset:33792
  s_min_u32 s98, s98, s99
  s_sub_u32 s56, s51, s98
  s_sub_u32 s51, s56, 1
  v_sub_u32 v137, s51, v128
  v_mfma_f32_16x16x32_bf16 v[100:103], a[176:179], a[100:103], v[100:103]
  v_mfma_f32_16x16x32_bf16 v[104:107], a[176:179], a[104:107], v[104:107]
  ds_read_b64_tr_b16 a[164:165], v224 offset:40960
  v_min_u32_dpp v137, v137, v137 row_ror:8 row_mask:0xf bank_mask:0xf
  v_mfma_f32_16x16x32_bf16 v[104:107], a[180:183], a[120:123], v[104:107]
  buffer_load_dwordx4 v235, s[12:15], s29 offen offset:3072 lds
  v_mfma_f32_16x16x32_bf16 v[108:111], a[180:183], a[124:127], v[108:111]
  ds_read_b64_tr_b16 a[166:167], v224 offset:41984
  v_min_u32_dpp v137, v137, v137 row_ror:4 row_mask:0xf bank_mask:0xf
  v_mfma_f32_16x16x32_bf16 v[108:111], a[176:179], a[108:111], v[108:111]
  s_waitcnt lgkmcnt(4)
  v_min_u32_dpp v137, v137, v137 row_ror:2 row_mask:0xf bank_mask:0xf
  v_mfma_f32_16x16x32_bf16 v[112:115], a[184:187], a[96:99], v[112:115]
  ds_read_b64_tr_b16 a[168:169], v225 offset:32768
  v_min_u32_dpp v137, v137, v137 row_ror:1 row_mask:0xf bank_mask:0xf
  v_mfma_f32_16x16x32_bf16 v[112:115], a[188:191], a[112:115], v[112:115]
  v_readlane_b32 s98, v137, 0
  v_readlane_b32 s99, v137, 16
  v_mfma_f32_16x16x32_bf16 v[116:119], a[188:191], a[116:119], v[116:119]
  ds_read_b64_tr_b16 a[170:171], v225 offset:33792
  s_min_u32 s98, s98, s99
  s_sub_u32 s57, s51, s98
  s_sub_u32 s51, s57, 1
  v_sub_u32 v137, s51, v128
  v_mfma_f32_16x16x32_bf16 v[116:119], a[184:187], a[100:103], v[116:119]
  v_mfma_f32_16x16x32_bf16 v[120:123], a[184:187], a[104:107], v[120:123]
  ds_read_b64_tr_b16 a[172:173], v225 offset:40960
  v_min_u32_dpp v137, v137, v137 row_ror:8 row_mask:0xf bank_mask:0xf
  v_mfma_f32_16x16x32_bf16 v[120:123], a[188:191], a[120:123], v[120:123]
  v_mfma_f32_16x16x32_bf16 v[124:127], a[188:191], a[124:127], v[124:127]
  ds_read_b64_tr_b16 a[174:175], v225 offset:41984
  v_min_u32_dpp v137, v137, v137 row_ror:4 row_mask:0xf bank_mask:0xf
  v_mfma_f32_16x16x32_bf16 v[124:127], a[184:187], a[108:111], v[124:127]
  s_waitcnt vmcnt(16) lgkmcnt(4)
  v_min_u32_dpp v137, v137, v137 row_ror:2 row_mask:0xf bank_mask:0xf
  v_mfma_f32_16x16x32_bf16 v[0:3], a[160:163], a[0:3], v[0:3]
  ds_read_b64_tr_b16 a[176:177], v226 offset:32768
  v_min_u32_dpp v137, v137, v137 row_ror:1 row_mask:0xf bank_mask:0xf
  v_mfma_f32_16x16x32_bf16 v[0:3], a[164:167], a[16:19], v[0:3]
  v_readlane_b32 s98, v137, 0
  v_readlane_b32 s99, v137, 16
  v_mfma_f32_16x16x32_bf16 v[4:7], a[164:167], a[20:23], v[4:7]
  ds_read_b64_tr_b16 a[178:179], v226 offset:33792
  s_min_u32 s98, s98, s99
  s_sub_u32 s58, s51, s98
  s_sub_u32 s51, s58, 1
  v_sub_u32 v137, s51, v128
  v_mfma_f32_16x16x32_bf16 v[4:7], a[160:163], a[4:7], v[4:7]
  v_mfma_f32_16x16x32_bf16 v[8:11], a[160:163], a[8:11], v[8:11]
  ds_read_b64_tr_b16 a[180:181], v226 offset:40960
  s_add_u32 m0, s28, 65536
  v_min_u32_dpp v137, v137, v137 row_ror:8 row_mask:0xf bank_mask:0xf
  v_mfma_f32_16x16x32_bf16 v[8:11], a[164:167], a[24:27], v[8:11]
  buffer_load_dwordx4 v236, s[16:19], s29 offen offset:0 lds
  v_mfma_f32_16x16x32_bf16 v[12:15], a[164:167], a[28:31], v[12:15]
  ds_read_b64_tr_b16 a[182:183], v226 offset:41984
  v_min_u32_dpp v137, v137, v137 row_ror:4 row_mask:0xf bank_mask:0xf
  v_mfma_f32_16x16x32_bf16 v[12:15], a[160:163], a[12:15], v[12:15]
  s_waitcnt lgkmcnt(4)
  v_min_u32_dpp v137, v137, v137 row_ror:2 row_mask:0xf bank_mask:0xf
  v_mfma_f32_16x16x32_bf16 v[16:19], a[168:171], a[0:3], v[16:19]
  ds_read_b64_tr_b16 a[184:185], v227 offset:32768
  v_min_u32_dpp v137, v137, v137 row_ror:1 row_mask:0xf bank_mask:0xf
  v_mfma_f32_16x16x32_bf16 v[16:19], a[172:175], a[16:19], v[16:19]
  v_readlane_b32 s98, v137, 0
  v_readlane_b32 s99, v137, 16
  v_mfma_f32_16x16x32_bf16 v[20:23], a[172:175], a[20:23], v[20:23]
  ds_read_b64_tr_b16 a[186:187], v227 offset:33792
  s_min_u32 s98, s98, s99
  s_sub_u32 s59, s51, s98
  s_sub_u32 s51, s59, 1
  v_mov_b32 v128, 0
  v_mfma_f32_16x16x32_bf16 v[20:23], a[168:171], a[4:7], v[20:23]
  v_writelane_b32 v128, s52, 0
  v_writelane_b32 v128, s53, 1
  v_mfma_f32_16x16x32_bf16 v[24:27], a[168:171], a[8:11], v[24:27]
  ds_read_b64_tr_b16 a[188:189], v227 offset:40960
  v_writelane_b32 v128, s54, 2
  v_mfma_f32_16x16x32_bf16 v[24:27], a[172:175], a[24:27], v[24:27]
  v_writelane_b32 v128, s55, 3
  v_writelane_b32 v128, s56, 4
  v_mfma_f32_16x16x32_bf16 v[28:31], a[172:175], a[28:31], v[28:31]
  ds_read_b64_tr_b16 a[190:191], v227 offset:41984
  v_writelane_b32 v128, s57, 5
  v_mfma_f32_16x16x32_bf16 v[28:31], a[168:171], a[12:15], v[28:31]
  s_waitcnt lgkmcnt(4)
  v_writelane_b32 v128, s58, 6
  v_writelane_b32 v128, s59, 7
  v_mfma_f32_16x16x32_bf16 v[32:35], a[176:179], a[0:3], v[32:35]
  ds_read_b64_tr_b16 a[160:161], v228 offset:32768
  v_and_b32 v129, 0xffff, v128
  v_mfma_f32_16x16x32_bf16 v[32:35], a[180:183], a[16:19], v[32:35]
  v_sub_u32 v129, 0xffff, v129
  v_and_b32 v129, 0x7ff, v129
  v_mfma_f32_16x16x32_bf16 v[36:39], a[180:183], a[20:23], v[36:39]
  ds_read_b64_tr_b16 a[162:163], v228 offset:33792
  v_mov_b32 v130, v129
  v_mfma_f32_16x16x32_bf16 v[36:39], a[176:179], a[4:7], v[36:39]
  v_mfma_f32_16x16x32_bf16 v[40:43], a[176:179], a[8:11], v[40:43]
  ds_read_b64_tr_b16 a[164:165], v228 offset:40960
  v_permlane16_swap_b32 v129, v130
  v_mfma_f32_16x16x32_bf16 v[40:43], a[180:183], a[24:27], v[40:43]
  buffer_load_dwordx4 v237, s[16:19], s29 offen offset:1024 lds
  v_mfma_f32_16x16x32_bf16 v[44:47], a[180:183], a[28:31], v[44:47]
  ds_read_b64_tr_b16 a[166:167], v228 offset:41984
  v_mov_b32 v130, v129
  v_mfma_f32_16x16x32_bf16 v[44:47], a[176:179], a[12:15], v[44:47]
  s_waitcnt lgkmcnt(4)
  v_permlane32_swap_b32 v129, v130
  v_lshrrev_b32 v130, 6, v129
  v_mfma_f32_16x16x32_bf16 v[48:51], a[184:187], a[0:3], v[48:51]
  ds_read_b64_tr_b16 a[168:169], v229 offset:32768
  v_mul_u32_u24 v130, 0x14000, v130
  v_mfma_f32_16x16x32_bf16 v[48:51], a[188:191], a[16:19], v[48:51]
  v_bfe_u32 v131, v129, 4, 2
  v_lshl_add_u32 v130, v131, 10, v130
  v_mfma_f32_16x16x32_bf16 v[52:55], a[188:191], a[20:23], v[52:55]
  ds_read_b64_tr_b16 a[170:171], v229 offset:33792
  v_and_b32 v131, 15, v129
  v_mfma_f32_16x16x32_bf16 v[52:55], a[184:187], a[4:7], v[52:55]
  v_lshl_add_u32 v130, v131, 4, v130
  v_lshrrev_b32 v131, 4, v136
  v_mfma_f32_16x16x32_bf16 v[56:59], a[184:187], a[8:11], v[56:59]
  ds_read_b64_tr_b16 a[172:173], v229 offset:40960
  v_lshl_add_u32 v243, v131, 8, v130
  v_mfma_f32_16x16x32_bf16 v[56:59], a[188:191], a[24:27], v[56:59]
  v_mfma_f32_16x16x32_bf16 v[60:63], a[188:191], a[28:31], v[60:63]
  ds_read_b64_tr_b16 a[174:175], v229 offset:41984
  v_mfma_f32_16x16x32_bf16 v[60:63], a[184:187], a[12:15], v[60:63]
  s_waitcnt lgkmcnt(4)
  v_mfma_f32_16x16x32_bf16 v[64:67], a[160:163], a[0:3], v[64:67]
  ds_read_b64_tr_b16 a[176:177], v230 offset:32768
  v_mfma_f32_16x16x32_bf16 v[64:67], a[164:167], a[16:19], v[64:67]
  v_mfma_f32_16x16x32_bf16 v[68:71], a[164:167], a[20:23], v[68:71]
  ds_read_b64_tr_b16 a[178:179], v230 offset:33792
  v_mfma_f32_16x16x32_bf16 v[68:71], a[160:163], a[4:7], v[68:71]
  v_mfma_f32_16x16x32_bf16 v[72:75], a[160:163], a[8:11], v[72:75]
  ds_read_b64_tr_b16 a[180:181], v230 offset:40960
  v_mfma_f32_16x16x32_bf16 v[72:75], a[164:167], a[24:27], v[72:75]
  buffer_load_dwordx4 v236, s[16:19], s29 offen offset:2048 lds
  v_mfma_f32_16x16x32_bf16 v[76:79], a[164:167], a[28:31], v[76:79]
  ds_read_b64_tr_b16 a[182:183], v230 offset:41984
  v_mfma_f32_16x16x32_bf16 v[76:79], a[160:163], a[12:15], v[76:79]
  s_waitcnt lgkmcnt(4)
  v_mfma_f32_16x16x32_bf16 v[80:83], a[168:171], a[0:3], v[80:83]
  ds_read_b64_tr_b16 a[184:185], v231 offset:32768
  v_mfma_f32_16x16x32_bf16 v[80:83], a[172:175], a[16:19], v[80:83]
  v_mfma_f32_16x16x32_bf16 v[84:87], a[172:175], a[20:23], v[84:87]
  ds_read_b64_tr_b16 a[186:187], v231 offset:33792
  v_mfma_f32_16x16x32_bf16 v[84:87], a[168:171], a[4:7], v[84:87]
  s_waitcnt vmcnt(8)
  v_mfma_f32_16x16x32_bf16 v[88:91], a[168:171], a[8:11], v[88:91]
  ds_read_b64_tr_b16 a[188:189], v231 offset:40960
  v_mfma_f32_16x16x32_bf16 v[88:91], a[172:175], a[24:27], v[88:91]
  s_barrier
  v_mfma_f32_16x16x32_bf16 v[92:95], a[172:175], a[28:31], v[92:95]
  ds_read_b64_tr_b16 a[190:191], v231 offset:41984
  v_mfma_f32_16x16x32_bf16 v[92:95], a[168:171], a[12:15], v[92:95]
  s_waitcnt lgkmcnt(4)
  v_mfma_f32_16x16x32_bf16 v[96:99], a[176:179], a[0:3], v[96:99]
  ds_read_b64_tr_b16 a[160:161], v224 offset:49152
  v_mfma_f32_16x16x32_bf16 v[96:99], a[180:183], a[16:19], v[96:99]
  v_mfma_f32_16x16x32_bf16 v[100:103], a[180:183], a[20:23], v[100:103]
  ds_read_b64_tr_b16 a[162:163], v224 offset:50176
  v_mfma_f32_16x16x32_bf16 v[100:103], a[176:179], a[4:7], v[100:103]
  v_mfma_f32_16x16x32_bf16 v[104:107], a[176:179], a[8:11], v[104:107]
  ds_read_b64_tr_b16 a[164:165], v224 offset:57344
  v_mfma_f32_16x16x32_bf16 v[104:107], a[180:183], a[24:27], v[104:107]
  buffer_load_dwordx4 v237, s[16:19], s29 offen offset:3072 lds
  s_add_u32 s29, s29, 16384
  v_mfma_f32_16x16x32_bf16 v[108:111], a[180:183], a[28:31], v[108:111]
  ds_read_b64_tr_b16 a[166:167], v224 offset:58368
  v_mfma_f32_16x16x32_bf16 v[108:111], a[176:179], a[12:15], v[108:111]
  s_waitcnt lgkmcnt(4)
  v_mfma_f32_16x16x32_bf16 v[112:115], a[184:187], a[0:3], v[112:115]
  ds_read_b64_tr_b16 a[168:169], v225 offset:49152
  v_mfma_f32_16x16x32_bf16 v[112:115], a[188:191], a[16:19], v[112:115]
  v_mfma_f32_16x16x32_bf16 v[116:119], a[188:191], a[20:23], v[116:119]
  ds_read_b64_tr_b16 a[170:171], v225 offset:50176
  v_mfma_f32_16x16x32_bf16 v[116:119], a[184:187], a[4:7], v[116:119]
  v_mfma_f32_16x16x32_bf16 v[120:123], a[184:187], a[8:11], v[120:123]
  ds_read_b64_tr_b16 a[172:173], v225 offset:57344
  v_mfma_f32_16x16x32_bf16 v[120:123], a[188:191], a[24:27], v[120:123]
  v_mfma_f32_16x16x32_bf16 v[124:127], a[188:191], a[28:31], v[124:127]
  ds_read_b64_tr_b16 a[174:175], v225 offset:58368
  v_mfma_f32_16x16x32_bf16 v[124:127], a[184:187], a[12:15], v[124:127]
  s_waitcnt vmcnt(8) lgkmcnt(4)
  v_mfma_f32_16x16x32_bf16 v[0:3], a[160:163], a[32:35], v[0:3]
  ds_read_b64_tr_b16 a[176:177], v226 offset:49152
  s_add_u32 m0, s28, 16384
  v_mfma_f32_16x16x32_bf16 v[0:3], a[164:167], a[48:51], v[0:3]
  buffer_load_dwordx4 v232, s[12:15], s29 offen offset:0 lds
  v_mfma_f32_16x16x32_bf16 v[4:7], a[164:167], a[52:55], v[4:7]
  ds_read_b64_tr_b16 a[178:179], v226 offset:50176
  v_mfma_f32_16x16x32_bf16 v[4:7], a[160:163], a[36:39], v[4:7]
  v_mfma_f32_16x16x32_bf16 v[8:11], a[160:163], a[40:43], v[8:11]
  ds_read_b64_tr_b16 a[180:181], v226 offset:57344
  v_mfma_f32_16x16x32_bf16 v[8:11], a[164:167], a[56:59], v[8:11]
  buffer_load_dwordx4 v233, s[12:15], s29 offen offset:1024 lds
  v_mfma_f32_16x16x32_bf16 v[12:15], a[164:167], a[60:63], v[12:15]
  ds_read_b64_tr_b16 a[182:183], v226 offset:58368
  v_mfma_f32_16x16x32_bf16 v[12:15], a[160:163], a[44:47], v[12:15]
  s_waitcnt lgkmcnt(4)
  v_mfma_f32_16x16x32_bf16 v[16:19], a[168:171], a[32:35], v[16:19]
  ds_read_b64_tr_b16 a[184:185], v227 offset:49152
  v_mfma_f32_16x16x32_bf16 v[16:19], a[172:175], a[48:51], v[16:19]
  buffer_load_dwordx4 v234, s[12:15], s29 offen offset:2048 lds
  v_mfma_f32_16x16x32_bf16 v[20:23], a[172:175], a[52:55], v[20:23]
  ds_read_b64_tr_b16 a[186:187], v227 offset:50176
  v_mfma_f32_16x16x32_bf16 v[20:23], a[168:171], a[36:39], v[20:23]
  buffer_load_dwordx4 v235, s[12:15], s29 offen offset:3072 lds
  v_mfma_f32_16x16x32_bf16 v[24:27], a[168:171], a[40:43], v[24:27]
  ds_read_b64_tr_b16 a[188:189], v227 offset:57344
  v_mfma_f32_16x16x32_bf16 v[24:27], a[172:175], a[56:59], v[24:27]
  v_mul_f32 v0, s34, v0
  v_mul_f32 v1, s34, v1
  v_mfma_f32_16x16x32_bf16 v[28:31], a[172:175], a[60:63], v[28:31]
  ds_read_b64_tr_b16 a[190:191], v227 offset:58368
  v_mul_f32 v2, s34, v2
  v_mfma_f32_16x16x32_bf16 v[28:31], a[168:171], a[44:47], v[28:31]
  s_waitcnt lgkmcnt(4)
  v_mul_f32 v3, s34, v3
  v_mul_f32 v16, s34, v16
  v_mfma_f32_16x16x32_bf16 v[32:35], a[176:179], a[32:35], v[32:35]
  ds_read_b64_tr_b16 a[160:161], v228 offset:49152
  v_mul_f32 v17, s34, v17
  v_mfma_f32_16x16x32_bf16 v[32:35], a[180:183], a[48:51], v[32:35]
  v_mul_f32 v18, s34, v18
  v_mul_f32 v19, s34, v19
  v_mfma_f32_16x16x32_bf16 v[36:39], a[180:183], a[52:55], v[36:39]
  ds_read_b64_tr_b16 a[162:163], v228 offset:50176
  v_cvt_pk_bf16_f32 v128, v0, v1
  v_mfma_f32_16x16x32_bf16 v[36:39], a[176:179], a[36:39], v[36:39]
  v_cvt_pk_bf16_f32 v129, v2, v3
  v_cvt_pk_bf16_f32 v130, v16, v17
  v_mfma_f32_16x16x32_bf16 v[40:43], a[176:179], a[40:43], v[40:43]
  ds_read_b64_tr_b16 a[164:165], v228 offset:57344
  v_cvt_pk_bf16_f32 v131, v18, v19
  v_mfma_f32_16x16x32_bf16 v[40:43], a[180:183], a[56:59], v[40:43]
  v_mul_f32 v4, s34, v4
  v_mul_f32 v5, s34, v5
  v_mfma_f32_16x16x32_bf16 v[44:47], a[180:183], a[60:63], v[44:47]
  ds_read_b64_tr_b16 a[166:167], v228 offset:58368
  v_mul_f32 v6, s34, v6
  v_mfma_f32_16x16x32_bf16 v[44:47], a[176:179], a[44:47], v[44:47]
  s_waitcnt lgkmcnt(4)
  v_mul_f32 v7, s34, v7
  v_mul_f32 v20, s34, v20
  v_mfma_f32_16x16x32_bf16 v[48:51], a[184:187], a[32:35], v[48:51]
  ds_read_b64_tr_b16 a[168:169], v229 offset:49152
  v_mul_f32 v21, s34, v21
  v_mfma_f32_16x16x32_bf16 v[48:51], a[188:191], a[48:51], v[48:51]
  v_mul_f32 v22, s34, v22
  v_mul_f32 v23, s34, v23
  v_mfma_f32_16x16x32_bf16 v[52:55], a[188:191], a[52:55], v[52:55]
  ds_read_b64_tr_b16 a[170:171], v229 offset:50176
  v_cvt_pk_bf16_f32 v144, v4, v5
  v_mfma_f32_16x16x32_bf16 v[52:55], a[184:187], a[36:39], v[52:55]
  v_cvt_pk_bf16_f32 v145, v6, v7
  v_cvt_pk_bf16_f32 v146, v20, v21
  v_mfma_f32_16x16x32_bf16 v[56:59], a[184:187], a[40:43], v[56:59]
  ds_read_b64_tr_b16 a[172:173], v229 offset:57344
  v_cvt_pk_bf16_f32 v147, v22, v23
  v_mfma_f32_16x16x32_bf16 v[56:59], a[188:191], a[56:59], v[56:59]
  v_permlane16_swap_b32 v128, v130
  v_permlane16_swap_b32 v129, v131
  v_mfma_f32_16x16x32_bf16 v[60:63], a[188:191], a[60:63], v[60:63]
  ds_read_b64_tr_b16 a[174:175], v229 offset:58368
  v_mul_f32 v8, s34, v8
  v_mfma_f32_16x16x32_bf16 v[60:63], a[184:187], a[44:47], v[60:63]
  s_waitcnt lgkmcnt(4)
  v_mul_f32 v9, s34, v9
  v_mul_f32 v10, s34, v10
  v_mfma_f32_16x16x32_bf16 v[64:67], a[160:163], a[32:35], v[64:67]
  ds_read_b64_tr_b16 a[176:177], v230 offset:49152
  v_mul_f32 v11, s34, v11
  v_mfma_f32_16x16x32_bf16 v[64:67], a[164:167], a[48:51], v[64:67]
  v_mul_f32 v24, s34, v24
  v_mul_f32 v25, s34, v25
  v_mfma_f32_16x16x32_bf16 v[68:71], a[164:167], a[52:55], v[68:71]
  ds_read_b64_tr_b16 a[178:179], v230 offset:50176
  v_mul_f32 v26, s34, v26
  v_mfma_f32_16x16x32_bf16 v[68:71], a[160:163], a[36:39], v[68:71]
  v_mul_f32 v27, s34, v27
  v_cvt_pk_bf16_f32 v160, v8, v9
  v_mfma_f32_16x16x32_bf16 v[72:75], a[160:163], a[40:43], v[72:75]
  ds_read_b64_tr_b16 a[180:181], v230 offset:57344
  v_cvt_pk_bf16_f32 v161, v10, v11
  v_mfma_f32_16x16x32_bf16 v[72:75], a[164:167], a[56:59], v[72:75]
  v_cvt_pk_bf16_f32 v162, v24, v25
  v_cvt_pk_bf16_f32 v163, v26, v27
  v_mfma_f32_16x16x32_bf16 v[76:79], a[164:167], a[60:63], v[76:79]
  ds_read_b64_tr_b16 a[182:183], v230 offset:58368
  v_permlane16_swap_b32 v144, v146
  v_mfma_f32_16x16x32_bf16 v[76:79], a[160:163], a[44:47], v[76:79]
  s_waitcnt lgkmcnt(4)
  v_permlane16_swap_b32 v145, v147
  v_mul_f32 v12, s34, v12
  v_mfma_f32_16x16x32_bf16 v[80:83], a[168:171], a[32:35], v[80:83]
  ds_read_b64_tr_b16 a[184:185], v231 offset:49152
  v_mul_f32 v13, s34, v13
  v_mfma_f32_16x16x32_bf16 v[80:83], a[172:175], a[48:51], v[80:83]
  v_mul_f32 v14, s34, v14
  v_mul_f32 v15, s34, v15
  v_mfma_f32_16x16x32_bf16 v[84:87], a[172:175], a[52:55], v[84:87]
  ds_read_b64_tr_b16 a[186:187], v231 offset:50176
  v_mul_f32 v28, s34, v28
  v_mfma_f32_16x16x32_bf16 v[84:87], a[168:171], a[36:39], v[84:87]
  s_waitcnt vmcnt(8)
  v_mul_f32 v29, s34, v29
  v_mul_f32 v30, s34, v30
  v_mfma_f32_16x16x32_bf16 v[88:91], a[168:171], a[40:43], v[88:91]
  ds_read_b64_tr_b16 a[188:189], v231 offset:57344
  v_mul_f32 v31, s34, v31
  v_mfma_f32_16x16x32_bf16 v[88:91], a[172:175], a[56:59], v[88:91]
  s_barrier
  v_cvt_pk_bf16_f32 v176, v12, v13
  v_cvt_pk_bf16_f32 v177, v14, v15
  v_mfma_f32_16x16x32_bf16 v[92:95], a[172:175], a[60:63], v[92:95]
  ds_read_b64_tr_b16 a[190:191], v231 offset:58368
  v_cvt_pk_bf16_f32 v178, v28, v29
  v_mfma_f32_16x16x32_bf16 v[92:95], a[168:171], a[44:47], v[92:95]
  s_waitcnt lgkmcnt(4)
  v_cvt_pk_bf16_f32 v179, v30, v31
  v_permlane16_swap_b32 v160, v162
  v_mfma_f32_16x16x32_bf16 v[96:99], a[176:179], a[32:35], v[96:99]
  ds_read_b128 a[128:131], v212 offset:0
  v_permlane16_swap_b32 v161, v163
  v_mfma_f32_16x16x32_bf16 v[96:99], a[180:183], a[48:51], v[96:99]
  v_mul_f32 v32, s34, v32
  v_mul_f32 v33, s34, v33
  v_mfma_f32_16x16x32_bf16 v[100:103], a[180:183], a[52:55], v[100:103]
  ds_read_b128 a[132:135], v213 offset:0
  v_mul_f32 v34, s34, v34
  v_mfma_f32_16x16x32_bf16 v[100:103], a[176:179], a[36:39], v[100:103]
  v_mul_f32 v35, s34, v35
  v_mul_f32 v48, s34, v48
  v_mfma_f32_16x16x32_bf16 v[104:107], a[176:179], a[40:43], v[104:107]
  ds_read_b128 a[136:139], v214 offset:0
  v_mul_f32 v49, s34, v49
  v_mfma_f32_16x16x32_bf16 v[104:107], a[180:183], a[56:59], v[104:107]
  v_mul_f32 v50, s34, v50
  v_mul_f32 v51, s34, v51
  v_mfma_f32_16x16x32_bf16 v[108:111], a[180:183], a[60:63], v[108:111]
  ds_read_b128 a[140:143], v215 offset:0
  v_cvt_pk_bf16_f32 v132, v32, v33
  v_mfma_f32_16x16x32_bf16 v[108:111], a[176:179], a[44:47], v[108:111]
  s_waitcnt lgkmcnt(4)
  v_cvt_pk_bf16_f32 v133, v34, v35
  v_cvt_pk_bf16_f32 v134, v48, v49
  v_mfma_f32_16x16x32_bf16 v[112:115], a[184:187], a[32:35], v[112:115]
  v_cvt_pk_bf16_f32 v135, v50, v51
  v_permlane16_swap_b32 v176, v178
  v_mfma_f32_16x16x32_bf16 v[112:115], a[188:191], a[48:51], v[112:115]
  v_permlane16_swap_b32 v177, v179
  v_mul_f32 v36, s34, v36
  v_mfma_f32_16x16x32_bf16 v[116:119], a[188:191], a[52:55], v[116:119]
  v_mul_f32 v37, s34, v37
  v_mul_f32 v38, s34, v38
  v_mfma_f32_16x16x32_bf16 v[116:119], a[184:187], a[36:39], v[116:119]
  v_mul_f32 v39, s34, v39
  v_mul_f32 v52, s34, v52
  v_mfma_f32_16x16x32_bf16 v[120:123], a[184:187], a[40:43], v[120:123]
  v_mul_f32 v53, s34, v53
  v_mul_f32 v54, s34, v54
  v_mfma_f32_16x16x32_bf16 v[120:123], a[188:191], a[56:59], v[120:123]
  v_mul_f32 v55, s34, v55
  v_cvt_pk_bf16_f32 v148, v36, v37
  v_mfma_f32_16x16x32_bf16 v[124:127], a[188:191], a[60:63], v[124:127]
  v_cvt_pk_bf16_f32 v149, v38, v39
  v_cvt_pk_bf16_f32 v150, v52, v53
  v_mfma_f32_16x16x32_bf16 v[124:127], a[184:187], a[44:47], v[124:127]
  s_waitcnt lgkmcnt(0)
  v_cvt_pk_bf16_f32 v151, v54, v55
  v_permlane16_swap_b32 v132, v134
  v_permlane16_swap_b32 v133, v135
  v_pk_mul_f32 v[40:41], v[40:41], s[34:35] op_sel_hi:[1,0]
  v_pk_mul_f32 v[42:43], v[42:43], s[34:35] op_sel_hi:[1,0]
  v_pk_mul_f32 v[56:57], v[56:57], s[34:35] op_sel_hi:[1,0]
  v_pk_mul_f32 v[58:59], v[58:59], s[34:35] op_sel_hi:[1,0]
  v_cvt_pk_bf16_f32 v164, v40, v41
  v_cvt_pk_bf16_f32 v165, v42, v43
  v_cvt_pk_bf16_f32 v166, v56, v57
  v_cvt_pk_bf16_f32 v167, v58, v59
  v_permlane16_swap_b32 v148, v150
  v_permlane16_swap_b32 v149, v151
  v_pk_mul_f32 v[44:45], v[44:45], s[34:35] op_sel_hi:[1,0]
  v_pk_mul_f32 v[46:47], v[46:47], s[34:35] op_sel_hi:[1,0]
  v_pk_mul_f32 v[60:61], v[60:61], s[34:35] op_sel_hi:[1,0]
  v_pk_mul_f32 v[62:63], v[62:63], s[34:35] op_sel_hi:[1,0]
  v_cvt_pk_bf16_f32 v180, v44, v45
  v_cvt_pk_bf16_f32 v181, v46, v47
  v_cvt_pk_bf16_f32 v182, v60, v61
  v_cvt_pk_bf16_f32 v183, v62, v63
  v_permlane16_swap_b32 v164, v166
  v_permlane16_swap_b32 v165, v167
  v_pk_mul_f32 v[64:65], v[64:65], s[34:35] op_sel_hi:[1,0]
  v_pk_mul_f32 v[66:67], v[66:67], s[34:35] op_sel_hi:[1,0]
  v_pk_mul_f32 v[80:81], v[80:81], s[34:35] op_sel_hi:[1,0]
  v_pk_mul_f32 v[82:83], v[82:83], s[34:35] op_sel_hi:[1,0]
  v_cvt_pk_bf16_f32 v136, v64, v65
  v_cvt_pk_bf16_f32 v137, v66, v67
  v_cvt_pk_bf16_f32 v138, v80, v81
  v_cvt_pk_bf16_f32 v139, v82, v83
  v_permlane16_swap_b32 v180, v182
  v_permlane16_swap_b32 v181, v183
  v_pk_mul_f32 v[68:69], v[68:69], s[34:35] op_sel_hi:[1,0]
  v_pk_mul_f32 v[70:71], v[70:71], s[34:35] op_sel_hi:[1,0]
  v_pk_mul_f32 v[84:85], v[84:85], s[34:35] op_sel_hi:[1,0]
  v_pk_mul_f32 v[86:87], v[86:87], s[34:35] op_sel_hi:[1,0]
  v_cvt_pk_bf16_f32 v152, v68, v69
  v_cvt_pk_bf16_f32 v153, v70, v71
  v_cvt_pk_bf16_f32 v154, v84, v85
  v_cvt_pk_bf16_f32 v155, v86, v87
  v_permlane16_swap_b32 v136, v138
  v_permlane16_swap_b32 v137, v139
  v_pk_mul_f32 v[72:73], v[72:73], s[34:35] op_sel_hi:[1,0]
  v_pk_mul_f32 v[74:75], v[74:75], s[34:35] op_sel_hi:[1,0]
  v_pk_mul_f32 v[88:89], v[88:89], s[34:35] op_sel_hi:[1,0]
  v_pk_mul_f32 v[90:91], v[90:91], s[34:35] op_sel_hi:[1,0]
  v_cvt_pk_bf16_f32 v168, v72, v73
  v_cvt_pk_bf16_f32 v169, v74, v75
  v_cvt_pk_bf16_f32 v170, v88, v89
  v_cvt_pk_bf16_f32 v171, v90, v91
  v_permlane16_swap_b32 v152, v154
  v_permlane16_swap_b32 v153, v155
  v_pk_mul_f32 v[76:77], v[76:77], s[34:35] op_sel_hi:[1,0]
  v_pk_mul_f32 v[78:79], v[78:79], s[34:35] op_sel_hi:[1,0]
  v_pk_mul_f32 v[92:93], v[92:93], s[34:35] op_sel_hi:[1,0]
  v_pk_mul_f32 v[94:95], v[94:95], s[34:35] op_sel_hi:[1,0]
  v_cvt_pk_bf16_f32 v184, v76, v77
  v_cvt_pk_bf16_f32 v185, v78, v79
  v_cvt_pk_bf16_f32 v186, v92, v93
  v_cvt_pk_bf16_f32 v187, v94, v95
  v_permlane16_swap_b32 v168, v170
  v_permlane16_swap_b32 v169, v171
  v_pk_mul_f32 v[96:97], v[96:97], s[34:35] op_sel_hi:[1,0]
  v_pk_mul_f32 v[98:99], v[98:99], s[34:35] op_sel_hi:[1,0]
  v_pk_mul_f32 v[112:113], v[112:113], s[34:35] op_sel_hi:[1,0]
  v_pk_mul_f32 v[114:115], v[114:115], s[34:35] op_sel_hi:[1,0]
  v_cvt_pk_bf16_f32 v140, v96, v97
  v_cvt_pk_bf16_f32 v141, v98, v99
  v_cvt_pk_bf16_f32 v142, v112, v113
  v_cvt_pk_bf16_f32 v143, v114, v115
  v_permlane16_swap_b32 v184, v186
  v_permlane16_swap_b32 v185, v187
  v_pk_mul_f32 v[100:101], v[100:101], s[34:35] op_sel_hi:[1,0]
  v_pk_mul_f32 v[102:103], v[102:103], s[34:35] op_sel_hi:[1,0]
  v_pk_mul_f32 v[116:117], v[116:117], s[34:35] op_sel_hi:[1,0]
  v_pk_mul_f32 v[118:119], v[118:119], s[34:35] op_sel_hi:[1,0]
  v_cvt_pk_bf16_f32 v156, v100, v101
  v_cvt_pk_bf16_f32 v157, v102, v103
  v_cvt_pk_bf16_f32 v158, v116, v117
  v_cvt_pk_bf16_f32 v159, v118, v119
  v_permlane16_swap_b32 v140, v142
  v_permlane16_swap_b32 v141, v143
  v_pk_mul_f32 v[104:105], v[104:105], s[34:35] op_sel_hi:[1,0]
  v_pk_mul_f32 v[106:107], v[106:107], s[34:35] op_sel_hi:[1,0]
  v_pk_mul_f32 v[120:121], v[120:121], s[34:35] op_sel_hi:[1,0]
  v_pk_mul_f32 v[122:123], v[122:123], s[34:35] op_sel_hi:[1,0]
  v_cvt_pk_bf16_f32 v172, v104, v105
  v_cvt_pk_bf16_f32 v173, v106, v107
  v_cvt_pk_bf16_f32 v174, v120, v121
  v_cvt_pk_bf16_f32 v175, v122, v123
  v_permlane16_swap_b32 v156, v158
  v_permlane16_swap_b32 v157, v159
  v_pk_mul_f32 v[108:109], v[108:109], s[34:35] op_sel_hi:[1,0]
  v_pk_mul_f32 v[110:111], v[110:111], s[34:35] op_sel_hi:[1,0]
  v_pk_mul_f32 v[124:125], v[124:125], s[34:35] op_sel_hi:[1,0]
  v_pk_mul_f32 v[126:127], v[126:127], s[34:35] op_sel_hi:[1,0]
  v_cvt_pk_bf16_f32 v188, v108, v109
  v_cvt_pk_bf16_f32 v189, v110, v111
  v_cvt_pk_bf16_f32 v190, v124, v125
  v_cvt_pk_bf16_f32 v191, v126, v127
  v_permlane16_swap_b32 v172, v174
  v_permlane16_swap_b32 v173, v175
  v_permlane16_swap_b32 v188, v190
  v_permlane16_swap_b32 v189, v191
  v_mfma_f32_16x16x32_bf16 v[0:3], a[128:131], v[128:131], 0
  s_add_u32 m0, s28, 81920
  ds_read_b128 a[144:147], v212 offset:4096
  s_mov_b32 s20, s90
  s_mov_b32 s21, s91
  v_mfma_f32_16x16x32_bf16 v[0:3], a[132:135], v[132:135], v[0:3]
  buffer_load_dwordx4 v236, s[16:19], s29 offen offset:0 lds
  s_mov_b32 s22, 2211840
  s_mov_b32 s23, 0x20000
  s_mov_b32 s44, s92
  v_mfma_f32_16x16x32_bf16 v[0:3], a[136:139], v[136:139], v[0:3]
  ds_read_b128 a[148:151], v213 offset:4096
  s_mov_b32 s45, s93
  s_mov_b32 s46, 2211840
  s_mov_b32 s47, 0x20000
  v_lshrrev_b32 v253, 4, v242
  v_mfma_f32_16x16x32_bf16 v[0:3], a[140:143], v[140:143], v[0:3]
  buffer_load_dwordx4 v237, s[16:19], s29 offen offset:1024 lds
  v_mfma_f32_16x16x32_bf16 v[8:11], a[140:143], v[156:159], 0
  ds_read_b128 a[152:155], v214 offset:4096
  v_mul_u32_u24 v253, 0xd80, v253
  v_mfma_f32_16x16x32_bf16 v[8:11], a[136:139], v[152:155], v[8:11]
  buffer_load_dwordx4 v236, s[16:19], s29 offen offset:2048 lds
  s_mul_i32 s35, s3, 552960
  s_lshl_b32 s38, s33, 4
  s_add_u32 s35, s35, s38
  v_mfma_f32_16x16x32_bf16 v[8:11], a[132:135], v[148:151], v[8:11]
  ds_read_b128 a[156:159], v215 offset:4096
  v_mfma_f32_16x16x32_bf16 v[8:11], a[128:131], v[144:147], v[8:11]
  buffer_load_dwordx4 v237, s[16:19], s29 offen offset:3072 lds
  v_mfma_f32_16x16x32_bf16 v[16:19], a[128:131], v[160:163], 0
  s_add_u32 s29, s29, 16384
  s_add_u32 m0, s28, 32768
  v_mfma_f32_16x16x32_bf16 v[16:19], a[132:135], v[164:167], v[16:19]
  buffer_load_dwordx4 v232, s[12:15], s29 offen offset:0 lds
  v_mfma_f32_16x16x32_bf16 v[16:19], a[136:139], v[168:171], v[16:19]
  buffer_load_dwordx4 v233, s[12:15], s29 offen offset:1024 lds
  v_mfma_f32_16x16x32_bf16 v[16:19], a[140:143], v[172:175], v[16:19]
  v_max3_f32 v192, v0, v1, v2
  v_max3_f32 v196, v8, v9, v10
  v_mfma_f32_16x16x32_bf16 v[24:27], a[140:143], v[188:191], 0
  v_max_f32 v192, v192, v3
  v_max_f32 v196, v196, v11
  v_mfma_f32_16x16x32_bf16 v[24:27], a[136:139], v[184:187], v[24:27]
  v_mov_b32 v245, v192
  v_mov_b32 v246, v196
  v_mfma_f32_16x16x32_bf16 v[24:27], a[132:135], v[180:183], v[24:27]
  v_permlane16_swap_b32 v192, v245
  v_permlane16_swap_b32 v196, v246
  v_mfma_f32_16x16x32_bf16 v[24:27], a[128:131], v[176:179], v[24:27]
  s_waitcnt lgkmcnt(0)
  v_max_f32 v192, v192, v245
  v_max_f32 v196, v196, v246
  v_mfma_f32_16x16x32_bf16 v[4:7], a[144:147], v[128:131], 0
  ds_read_b128 a[128:131], v212 offset:8192
  v_mov_b32 v245, v192
  v_mfma_f32_16x16x32_bf16 v[4:7], a[148:151], v[132:135], v[4:7]
  v_mov_b32 v246, v196
  v_permlane32_swap_b32 v192, v245
  v_mfma_f32_16x16x32_bf16 v[4:7], a[152:155], v[136:139], v[4:7]
  ds_read_b128 a[132:135], v213 offset:8192
  v_permlane32_swap_b32 v196, v246
  v_mfma_f32_16x16x32_bf16 v[4:7], a[156:159], v[140:143], v[4:7]
  v_max_f32 v192, v192, v245
  v_max_f32 v196, v196, v246
  v_mfma_f32_16x16x32_bf16 v[12:15], a[156:159], v[156:159], 0
  ds_read_b128 a[136:139], v214 offset:8192
  v_sub_f32 v193, 0, v192
  v_mfma_f32_16x16x32_bf16 v[12:15], a[152:155], v[152:155], v[12:15]
  v_sub_f32 v197, 0, v196
  v_sub_f32 v194, 0, v192
  v_mfma_f32_16x16x32_bf16 v[12:15], a[148:151], v[148:151], v[12:15]
  ds_read_b128 a[140:143], v215 offset:8192
  v_sub_f32 v198, 0, v196
  v_mfma_f32_16x16x32_bf16 v[12:15], a[144:147], v[144:147], v[12:15]
  v_sub_f32 v195, 0, v192
  v_sub_f32 v199, 0, v196
  v_mfma_f32_16x16x32_bf16 v[20:23], a[144:147], v[160:163], 0
  buffer_load_dwordx4 v234, s[12:15], s29 offen offset:2048 lds
  v_mfma_f32_16x16x32_bf16 v[20:23], a[148:151], v[164:167], v[20:23]
  v_sub_f32 v192, 0, v192
  v_sub_f32 v196, 0, v196
  v_mfma_f32_16x16x32_bf16 v[20:23], a[152:155], v[168:171], v[20:23]
  buffer_load_dwordx4 v235, s[12:15], s29 offen offset:3072 lds
  v_mfma_f32_16x16x32_bf16 v[20:23], a[156:159], v[172:175], v[20:23]
  v_max3_f32 v200, v16, v17, v18
  v_max3_f32 v204, v24, v25, v26
  v_mfma_f32_16x16x32_bf16 v[28:31], a[156:159], v[188:191], 0
  v_max_f32 v200, v200, v19
  v_max_f32 v204, v204, v27
  v_mfma_f32_16x16x32_bf16 v[28:31], a[152:155], v[184:187], v[28:31]
  v_mov_b32 v247, v200
  v_mov_b32 v248, v204
  v_mfma_f32_16x16x32_bf16 v[28:31], a[148:151], v[180:183], v[28:31]
  v_permlane16_swap_b32 v200, v247
  v_permlane16_swap_b32 v204, v248
  v_max_f32 v200, v200, v247
  v_max_f32 v204, v204, v248
  v_mov_b32 v247, v200
  v_mov_b32 v248, v204
  s_nop 0
  v_permlane32_swap_b32 v200, v247
  v_permlane32_swap_b32 v204, v248
  v_max_f32 v200, v200, v247
  v_max_f32 v204, v204, v248
  v_sub_f32 v201, 0, v200
  v_sub_f32 v205, 0, v204
  v_sub_f32 v202, 0, v200
  v_sub_f32 v206, 0, v204
  v_sub_f32 v203, 0, v200
  v_sub_f32 v207, 0, v204
  v_sub_f32 v200, 0, v200
  v_sub_f32 v204, 0, v204
  v_mfma_f32_16x16x32_bf16 v[28:31], a[144:147], v[176:179], v[28:31]
  s_waitcnt lgkmcnt(0)
  v_add_f32 v0, v192, v0
  v_add_f32 v1, v192, v1
  v_mfma_f32_16x16x32_bf16 v[32:35], a[128:131], v[128:131], v[192:195]
  ds_read_b128 a[144:147], v212 offset:12288
  v_add_f32 v2, v192, v2
  v_mfma_f32_16x16x32_bf16 v[32:35], a[132:135], v[132:135], v[32:35]
  v_add_f32 v3, v192, v3
  v_mfma_f32_16x16x32_bf16 v[32:35], a[136:139], v[136:139], v[32:35]
  ds_read_b128 a[148:151], v213 offset:12288
  v_mfma_f32_16x16x32_bf16 v[32:35], a[140:143], v[140:143], v[32:35]
  v_exp_f32 v0, v0
  v_mfma_f32_16x16x32_bf16 v[40:43], a[140:143], v[156:159], v[196:199]
  ds_read_b128 a[152:155], v214 offset:12288
  v_mfma_f32_16x16x32_bf16 v[40:43], a[136:139], v[152:155], v[40:43]
  v_exp_f32 v1, v1
  v_mfma_f32_16x16x32_bf16 v[40:43], a[132:135], v[148:151], v[40:43]
  ds_read_b128 a[156:159], v215 offset:12288
  v_mfma_f32_16x16x32_bf16 v[40:43], a[128:131], v[144:147], v[40:43]
  v_exp_f32 v2, v2
  v_mfma_f32_16x16x32_bf16 v[48:51], a[128:131], v[160:163], v[200:203]
  s_add_u32 m0, s50, 0
  v_cvt_pk_bf16_f32 v0, v0, v1
  v_mfma_f32_16x16x32_bf16 v[48:51], a[132:135], v[164:167], v[48:51]
  v_exp_f32 v3, v3
  v_mfma_f32_16x16x32_bf16 v[48:51], a[136:139], v[168:171], v[48:51]
  v_add_f32 v8, v196, v8
  v_add_f32 v9, v196, v9
  v_mfma_f32_16x16x32_bf16 v[48:51], a[140:143], v[172:175], v[48:51]
  v_add_f32 v10, v196, v10
  v_add_f32 v11, v196, v11
  v_mfma_f32_16x16x32_bf16 v[56:59], a[140:143], v[188:191], v[204:207]
  v_exp_f32 v8, v8
  v_mfma_f32_16x16x32_bf16 v[56:59], a[136:139], v[184:187], v[56:59]
  v_exp_f32 v9, v9
  buffer_load_dwordx4 v253, s[20:23], s35 offen lds
  v_mfma_f32_16x16x32_bf16 v[56:59], a[132:135], v[180:183], v[56:59]
  v_exp_f32 v10, v10
  v_mfma_f32_16x16x32_bf16 v[56:59], a[128:131], v[176:179], v[56:59]
  s_waitcnt lgkmcnt(0)
  v_cvt_pk_bf16_f32 v8, v8, v9
  v_mfma_f32_16x16x32_bf16 v[36:39], a[144:147], v[128:131], v[192:195]
  s_waitcnt vmcnt(9)
  v_exp_f32 v11, v11
  v_mfma_f32_16x16x32_bf16 v[36:39], a[148:151], v[132:135], v[36:39]
  s_barrier
  v_cvt_pk_bf16_f32 v1, v2, v3
  v_add_f32 v16, v200, v16
  v_mfma_f32_16x16x32_bf16 v[36:39], a[152:155], v[136:139], v[36:39]
  ds_read_b128 a[128:131], v212 offset:16384
  v_add_f32 v17, v200, v17
  v_mfma_f32_16x16x32_bf16 v[36:39], a[156:159], v[140:143], v[36:39]
  v_add_f32 v18, v200, v18
  v_add_f32 v19, v200, v19
  v_mfma_f32_16x16x32_bf16 v[44:47], a[156:159], v[156:159], v[196:199]
  ds_read_b128 a[132:135], v213 offset:16384
  v_mfma_f32_16x16x32_bf16 v[44:47], a[152:155], v[152:155], v[44:47]
  v_exp_f32 v16, v16
  v_mfma_f32_16x16x32_bf16 v[44:47], a[148:151], v[148:151], v[44:47]
  ds_read_b128 a[136:139], v214 offset:16384
  v_mfma_f32_16x16x32_bf16 v[44:47], a[144:147], v[144:147], v[44:47]
  v_exp_f32 v17, v17
  v_mfma_f32_16x16x32_bf16 v[52:55], a[144:147], v[160:163], v[200:203]
  ds_read_b128 a[140:143], v215 offset:16384
  v_mfma_f32_16x16x32_bf16 v[52:55], a[148:151], v[164:167], v[52:55]
  v_exp_f32 v18, v18
  v_mfma_f32_16x16x32_bf16 v[52:55], a[152:155], v[168:171], v[52:55]
  v_cvt_pk_bf16_f32 v16, v16, v17
  v_mfma_f32_16x16x32_bf16 v[52:55], a[156:159], v[172:175], v[52:55]
  v_exp_f32 v19, v19
  v_mfma_f32_16x16x32_bf16 v[60:63], a[156:159], v[188:191], v[204:207]
  v_cvt_pk_bf16_f32 v9, v10, v11
  v_add_f32 v24, v204, v24
  v_mfma_f32_16x16x32_bf16 v[60:63], a[152:155], v[184:187], v[60:63]
  v_add_f32 v25, v204, v25
  v_add_f32 v26, v204, v26
  v_mfma_f32_16x16x32_bf16 v[60:63], a[148:151], v[180:183], v[60:63]
  v_add_f32 v27, v204, v27
  v_mfma_f32_16x16x32_bf16 v[60:63], a[144:147], v[176:179], v[60:63]
  s_waitcnt lgkmcnt(0)
  v_exp_f32 v24, v24
  v_exp_f32 v25, v25
  v_exp_f32 v26, v26
  v_cvt_pk_bf16_f32 v24, v24, v25
  v_exp_f32 v27, v27
  v_cvt_pk_bf16_f32 v17, v18, v19
  v_add_f32 v4, v192, v4
  v_add_f32 v5, v192, v5
  v_add_f32 v6, v192, v6
  v_add_f32 v7, v192, v7
  v_exp_f32 v4, v4
  v_exp_f32 v5, v5
  v_exp_f32 v6, v6
  v_cvt_pk_bf16_f32 v2, v4, v5
  v_exp_f32 v7, v7
  v_cvt_pk_bf16_f32 v25, v26, v27
  v_add_f32 v12, v196, v12
  v_add_f32 v13, v196, v13
  v_add_f32 v14, v196, v14
  v_add_f32 v15, v196, v15
  v_exp_f32 v12, v12
  v_exp_f32 v13, v13
  v_exp_f32 v14, v14
  v_cvt_pk_bf16_f32 v10, v12, v13
  v_exp_f32 v15, v15
  v_cvt_pk_bf16_f32 v3, v6, v7
  v_add_f32 v20, v200, v20
  v_add_f32 v21, v200, v21
  v_add_f32 v22, v200, v22
  v_add_f32 v23, v200, v23
  v_exp_f32 v20, v20
  v_exp_f32 v21, v21
  v_exp_f32 v22, v22
  v_cvt_pk_bf16_f32 v18, v20, v21
  v_exp_f32 v23, v23
  v_cvt_pk_bf16_f32 v11, v14, v15
  v_add_f32 v28, v204, v28
  v_add_f32 v29, v204, v29
  v_add_f32 v30, v204, v30
  v_add_f32 v31, v204, v31
  v_exp_f32 v28, v28
  v_exp_f32 v29, v29
  v_exp_f32 v30, v30
  v_cvt_pk_bf16_f32 v26, v28, v29
  v_exp_f32 v31, v31
  v_cvt_pk_bf16_f32 v19, v22, v23
  v_exp_f32 v32, v32
  v_exp_f32 v33, v33
  v_exp_f32 v34, v34
  v_cvt_pk_bf16_f32 v32, v32, v33
  v_exp_f32 v35, v35
  v_cvt_pk_bf16_f32 v27, v30, v31
  v_exp_f32 v40, v40
  v_exp_f32 v41, v41
  v_exp_f32 v42, v42
  v_cvt_pk_bf16_f32 v40, v40, v41
  v_exp_f32 v43, v43
  v_cvt_pk_bf16_f32 v33, v34, v35
  v_exp_f32 v48, v48
  v_exp_f32 v49, v49
  v_exp_f32 v50, v50
  v_cvt_pk_bf16_f32 v48, v48, v49
  v_exp_f32 v51, v51
  v_cvt_pk_bf16_f32 v41, v42, v43
  v_exp_f32 v56, v56
  v_exp_f32 v57, v57
  v_exp_f32 v58, v58
  v_cvt_pk_bf16_f32 v56, v56, v57
  v_exp_f32 v59, v59
  v_cvt_pk_bf16_f32 v49, v50, v51
  v_exp_f32 v36, v36
  v_exp_f32 v37, v37
  v_exp_f32 v38, v38
  v_cvt_pk_bf16_f32 v34, v36, v37
  v_exp_f32 v39, v39
  v_cvt_pk_bf16_f32 v57, v58, v59
  v_exp_f32 v44, v44
  v_exp_f32 v45, v45
  v_exp_f32 v46, v46
  v_cvt_pk_bf16_f32 v42, v44, v45
  v_exp_f32 v47, v47
  v_cvt_pk_bf16_f32 v35, v38, v39
  v_exp_f32 v52, v52
  v_exp_f32 v53, v53
  v_exp_f32 v54, v54
  v_cvt_pk_bf16_f32 v50, v52, v53
  v_exp_f32 v55, v55
  v_cvt_pk_bf16_f32 v43, v46, v47
  v_exp_f32 v60, v60
  v_exp_f32 v61, v61
  v_exp_f32 v62, v62
  v_cvt_pk_bf16_f32 v58, v60, v61
  v_exp_f32 v63, v63
  v_cvt_pk_bf16_f32 v51, v54, v55
  v_cvt_pk_bf16_f32 v59, v62, v63
  v_mfma_f32_16x16x32_bf16 v[64:67], a[128:131], v[128:131], v[192:195]
  s_add_u32 m0, s28, 98304
  v_mfma_f32_16x16x32_bf16 v[64:67], a[132:135], v[132:135], v[64:67]
  ds_read_b128 a[144:147], v212 offset:20480
  v_mfma_f32_16x16x32_bf16 v[64:67], a[136:139], v[136:139], v[64:67]
  buffer_load_dwordx4 v236, s[16:19], s29 offen offset:0 lds
  v_mfma_f32_16x16x32_bf16 v[64:67], a[140:143], v[140:143], v[64:67]
  ds_read_b128 a[148:151], v213 offset:20480
  v_mfma_f32_16x16x32_bf16 v[72:75], a[140:143], v[156:159], v[196:199]
  v_mfma_f32_16x16x32_bf16 v[72:75], a[136:139], v[152:155], v[72:75]
  ds_read_b128 a[152:155], v214 offset:20480
  v_mfma_f32_16x16x32_bf16 v[72:75], a[132:135], v[148:151], v[72:75]
  buffer_load_dwordx4 v237, s[16:19], s29 offen offset:1024 lds
  v_mfma_f32_16x16x32_bf16 v[72:75], a[128:131], v[144:147], v[72:75]
  ds_read_b128 a[156:159], v215 offset:20480
  v_mfma_f32_16x16x32_bf16 v[80:83], a[128:131], v[160:163], v[200:203]
  v_exp_f32 v64, v64
  v_mfma_f32_16x16x32_bf16 v[80:83], a[132:135], v[164:167], v[80:83]
  v_mfma_f32_16x16x32_bf16 v[80:83], a[136:139], v[168:171], v[80:83]
  v_exp_f32 v65, v65
  v_mfma_f32_16x16x32_bf16 v[80:83], a[140:143], v[172:175], v[80:83]
  v_cvt_pk_bf16_f32 v64, v64, v65
  v_mfma_f32_16x16x32_bf16 v[88:91], a[140:143], v[188:191], v[204:207]
  v_exp_f32 v66, v66
  v_mfma_f32_16x16x32_bf16 v[88:91], a[136:139], v[184:187], v[88:91]
  buffer_load_dwordx4 v236, s[16:19], s29 offen offset:2048 lds
  v_mfma_f32_16x16x32_bf16 v[88:91], a[132:135], v[180:183], v[88:91]
  s_waitcnt lgkmcnt(0)
  v_exp_f32 v67, v67
  v_mfma_f32_16x16x32_bf16 v[88:91], a[128:131], v[176:179], v[88:91]
  v_cvt_pk_bf16_f32 v65, v66, v67
  v_mfma_f32_16x16x32_bf16 v[68:71], a[144:147], v[128:131], v[192:195]
  v_exp_f32 v72, v72
  v_mfma_f32_16x16x32_bf16 v[68:71], a[148:151], v[132:135], v[68:71]
  ds_read_b128 a[128:131], v212 offset:24576
  v_mfma_f32_16x16x32_bf16 v[68:71], a[152:155], v[136:139], v[68:71]
  v_exp_f32 v73, v73
  v_mfma_f32_16x16x32_bf16 v[68:71], a[156:159], v[140:143], v[68:71]
  ds_read_b128 a[132:135], v213 offset:24576
  v_cvt_pk_bf16_f32 v72, v72, v73
  v_mfma_f32_16x16x32_bf16 v[76:79], a[156:159], v[156:159], v[196:199]
  v_exp_f32 v74, v74
  v_mfma_f32_16x16x32_bf16 v[76:79], a[152:155], v[152:155], v[76:79]
  ds_read_b128 a[136:139], v214 offset:24576
  v_mfma_f32_16x16x32_bf16 v[76:79], a[148:151], v[148:151], v[76:79]
  v_exp_f32 v75, v75
  v_mfma_f32_16x16x32_bf16 v[76:79], a[144:147], v[144:147], v[76:79]
  ds_read_b128 a[140:143], v215 offset:24576
  v_cvt_pk_bf16_f32 v73, v74, v75
  v_mfma_f32_16x16x32_bf16 v[84:87], a[144:147], v[160:163], v[200:203]
  v_exp_f32 v80, v80
  v_mfma_f32_16x16x32_bf16 v[84:87], a[148:151], v[164:167], v[84:87]
  buffer_load_dwordx4 v237, s[16:19], s29 offen offset:3072 lds
  v_mfma_f32_16x16x32_bf16 v[84:87], a[152:155], v[168:171], v[84:87]
  s_add_u32 s29, s29, 16384
  v_exp_f32 v81, v81
  v_mfma_f32_16x16x32_bf16 v[84:87], a[156:159], v[172:175], v[84:87]
  v_cvt_pk_bf16_f32 v80, v80, v81
  v_mfma_f32_16x16x32_bf16 v[92:95], a[156:159], v[188:191], v[204:207]
  s_add_u32 m0, s28, 49152
  v_exp_f32 v82, v82
  v_mfma_f32_16x16x32_bf16 v[92:95], a[152:155], v[184:187], v[92:95]
  buffer_load_dwordx4 v232, s[12:15], s29 offen offset:0 lds
  v_mfma_f32_16x16x32_bf16 v[92:95], a[148:151], v[180:183], v[92:95]
  s_waitcnt lgkmcnt(0)
  v_exp_f32 v83, v83
  v_mfma_f32_16x16x32_bf16 v[92:95], a[144:147], v[176:179], v[92:95]
  v_cvt_pk_bf16_f32 v81, v82, v83
  v_mfma_f32_16x16x32_bf16 v[96:99], a[128:131], v[128:131], v[192:195]
  v_exp_f32 v88, v88
  v_mfma_f32_16x16x32_bf16 v[96:99], a[132:135], v[132:135], v[96:99]
  ds_read_b128 a[144:147], v212 offset:28672
  v_mfma_f32_16x16x32_bf16 v[96:99], a[136:139], v[136:139], v[96:99]
  v_exp_f32 v89, v89
  v_mfma_f32_16x16x32_bf16 v[96:99], a[140:143], v[140:143], v[96:99]
  ds_read_b128 a[148:151], v213 offset:28672
  v_cvt_pk_bf16_f32 v88, v88, v89
  v_mfma_f32_16x16x32_bf16 v[104:107], a[140:143], v[156:159], v[196:199]
  v_exp_f32 v90, v90
  v_mfma_f32_16x16x32_bf16 v[104:107], a[136:139], v[152:155], v[104:107]
  ds_read_b128 a[152:155], v214 offset:28672
  v_mfma_f32_16x16x32_bf16 v[104:107], a[132:135], v[148:151], v[104:107]
  v_exp_f32 v91, v91
  v_mfma_f32_16x16x32_bf16 v[104:107], a[128:131], v[144:147], v[104:107]
  ds_read_b128 a[156:159], v215 offset:28672
  v_cvt_pk_bf16_f32 v89, v90, v91
  v_mfma_f32_16x16x32_bf16 v[112:115], a[128:131], v[160:163], v[200:203]
  v_exp_f32 v68, v68
  v_mfma_f32_16x16x32_bf16 v[112:115], a[132:135], v[164:167], v[112:115]
  buffer_load_dwordx4 v233, s[12:15], s29 offen offset:1024 lds
  v_mfma_f32_16x16x32_bf16 v[112:115], a[136:139], v[168:171], v[112:115]
  v_exp_f32 v69, v69
  v_mfma_f32_16x16x32_bf16 v[112:115], a[140:143], v[172:175], v[112:115]
  v_cvt_pk_bf16_f32 v66, v68, v69
  v_mfma_f32_16x16x32_bf16 v[120:123], a[140:143], v[188:191], v[204:207]
  v_exp_f32 v70, v70
  v_mfma_f32_16x16x32_bf16 v[120:123], a[136:139], v[184:187], v[120:123]
  buffer_load_dwordx4 v234, s[12:15], s29 offen offset:2048 lds
  v_mfma_f32_16x16x32_bf16 v[120:123], a[132:135], v[180:183], v[120:123]
  s_waitcnt lgkmcnt(0)
  v_exp_f32 v71, v71
  v_mfma_f32_16x16x32_bf16 v[120:123], a[128:131], v[176:179], v[120:123]
  v_cvt_pk_bf16_f32 v67, v70, v71
  v_mfma_f32_16x16x32_bf16 v[100:103], a[144:147], v[128:131], v[192:195]
  v_exp_f32 v76, v76
  v_mfma_f32_16x16x32_bf16 v[100:103], a[148:151], v[132:135], v[100:103]
  ds_read_b64_tr_b16 a[160:161], v216 offset:0
  v_mfma_f32_16x16x32_bf16 v[100:103], a[152:155], v[136:139], v[100:103]
  v_exp_f32 v77, v77
  v_mfma_f32_16x16x32_bf16 v[100:103], a[156:159], v[140:143], v[100:103]
  ds_read_b64_tr_b16 a[162:163], v216 offset:4096
  v_cvt_pk_bf16_f32 v74, v76, v77
  v_mfma_f32_16x16x32_bf16 v[108:111], a[156:159], v[156:159], v[196:199]
  v_exp_f32 v78, v78
  v_mfma_f32_16x16x32_bf16 v[108:111], a[152:155], v[152:155], v[108:111]
  ds_read_b64_tr_b16 a[164:165], v216 offset:8192
  buffer_load_dwordx4 v235, s[12:15], s29 offen offset:3072 lds
  v_mfma_f32_16x16x32_bf16 v[108:111], a[148:151], v[148:151], v[108:111]
  v_exp_f32 v79, v79
  v_mfma_f32_16x16x32_bf16 v[108:111], a[144:147], v[144:147], v[108:111]
  ds_read_b64_tr_b16 a[166:167], v216 offset:12288
  v_cvt_pk_bf16_f32 v75, v78, v79
  v_mfma_f32_16x16x32_bf16 v[116:119], a[144:147], v[160:163], v[200:203]
  v_exp_f32 v84, v84
  v_mfma_f32_16x16x32_bf16 v[116:119], a[148:151], v[164:167], v[116:119]
  ds_read_b64_tr_b16 a[168:169], v217 offset:0
  s_add_u32 m0, s50, 3072
  v_mfma_f32_16x16x32_bf16 v[116:119], a[152:155], v[168:171], v[116:119]
  v_exp_f32 v85, v85
  v_mfma_f32_16x16x32_bf16 v[116:119], a[156:159], v[172:175], v[116:119]
  ds_read_b64_tr_b16 a[170:171], v217 offset:4096
  v_cvt_pk_bf16_f32 v82, v84, v85
  v_mfma_f32_16x16x32_bf16 v[124:127], a[156:159], v[188:191], v[204:207]
  v_exp_f32 v86, v86
  v_mfma_f32_16x16x32_bf16 v[124:127], a[152:155], v[184:187], v[124:127]
  ds_read_b64_tr_b16 a[172:173], v217 offset:8192
  buffer_load_dwordx4 v253, s[44:47], s35 offen lds
  s_add_u32 s35, s35, 221184
  v_mfma_f32_16x16x32_bf16 v[124:127], a[148:151], v[180:183], v[124:127]
  v_exp_f32 v87, v87
  v_mfma_f32_16x16x32_bf16 v[124:127], a[144:147], v[176:179], v[124:127]
  ds_read_b64_tr_b16 a[174:175], v217 offset:12288
  v_cvt_pk_bf16_f32 v83, v86, v87
  v_mfma_f32_16x16x32_bf16 a[192:195], a[208:211], v[0:3], 0
  v_exp_f32 v92, v92
  v_mfma_f32_16x16x32_bf16 a[192:195], a[208:211], v[32:35], a[192:195]
  ds_read_b64_tr_b16 a[176:177], v218 offset:0
  v_mfma_f32_16x16x32_bf16 a[196:199], a[208:211], v[8:11], 0
  v_exp_f32 v93, v93
  v_mfma_f32_16x16x32_bf16 a[196:199], a[208:211], v[40:43], a[196:199]
  ds_read_b64_tr_b16 a[178:179], v218 offset:4096
  v_cvt_pk_bf16_f32 v90, v92, v93
  v_mfma_f32_16x16x32_bf16 a[200:203], a[208:211], v[16:19], 0
  v_exp_f32 v94, v94
  v_mfma_f32_16x16x32_bf16 a[200:203], a[208:211], v[48:51], a[200:203]
  ds_read_b64_tr_b16 a[180:181], v218 offset:8192
  v_mfma_f32_16x16x32_bf16 a[204:207], a[208:211], v[24:27], 0
  s_waitcnt lgkmcnt(7)
  v_exp_f32 v95, v95
  v_mfma_f32_16x16x32_bf16 a[204:207], a[208:211], v[56:59], a[204:207]
  ds_read_b64_tr_b16 a[182:183], v218 offset:12288
  v_cvt_pk_bf16_f32 v91, v94, v95
  v_mfma_f32_16x16x32_bf16 a[0:3], a[160:163], v[0:3], 0
  v_exp_f32 v96, v96
  v_mfma_f32_16x16x32_bf16 a[0:3], a[164:167], v[32:35], a[0:3]
  ds_read_b64_tr_b16 a[184:185], v219 offset:0
  v_mfma_f32_16x16x32_bf16 a[4:7], a[164:167], v[40:43], 0
  v_exp_f32 v97, v97
  v_mfma_f32_16x16x32_bf16 a[4:7], a[160:163], v[8:11], a[4:7]
  ds_read_b64_tr_b16 a[186:187], v219 offset:4096
  v_cvt_pk_bf16_f32 v96, v96, v97
  v_mfma_f32_16x16x32_bf16 a[8:11], a[160:163], v[16:19], 0
  v_exp_f32 v98, v98
  v_mfma_f32_16x16x32_bf16 a[8:11], a[164:167], v[48:51], a[8:11]
  ds_read_b64_tr_b16 a[188:189], v219 offset:8192
  v_mfma_f32_16x16x32_bf16 a[12:15], a[164:167], v[56:59], 0
  s_waitcnt lgkmcnt(7)
  v_exp_f32 v99, v99
  v_mfma_f32_16x16x32_bf16 a[12:15], a[160:163], v[24:27], a[12:15]
  ds_read_b64_tr_b16 a[190:191], v219 offset:12288
  v_cvt_pk_bf16_f32 v97, v98, v99
  v_mfma_f32_16x16x32_bf16 a[16:19], a[168:171], v[0:3], 0
  v_exp_f32 v104, v104
  v_mfma_f32_16x16x32_bf16 a[16:19], a[172:175], v[32:35], a[16:19]
  ds_read_b64_tr_b16 a[160:161], v220 offset:0
  v_mfma_f32_16x16x32_bf16 a[20:23], a[172:175], v[40:43], 0
  v_exp_f32 v105, v105
  v_mfma_f32_16x16x32_bf16 a[20:23], a[168:171], v[8:11], a[20:23]
  ds_read_b64_tr_b16 a[162:163], v220 offset:4096
  v_cvt_pk_bf16_f32 v104, v104, v105
  v_mfma_f32_16x16x32_bf16 a[24:27], a[168:171], v[16:19], 0
  v_exp_f32 v106, v106
  v_mfma_f32_16x16x32_bf16 a[24:27], a[172:175], v[48:51], a[24:27]
  ds_read_b64_tr_b16 a[164:165], v220 offset:8192
  v_mfma_f32_16x16x32_bf16 a[28:31], a[172:175], v[56:59], 0
  s_waitcnt lgkmcnt(7)
  v_exp_f32 v107, v107
  v_mfma_f32_16x16x32_bf16 a[28:31], a[168:171], v[24:27], a[28:31]
  ds_read_b64_tr_b16 a[166:167], v220 offset:12288
  v_cvt_pk_bf16_f32 v105, v106, v107
  v_mfma_f32_16x16x32_bf16 a[32:35], a[176:179], v[0:3], 0
  v_exp_f32 v112, v112
  v_mfma_f32_16x16x32_bf16 a[32:35], a[180:183], v[32:35], a[32:35]
  ds_read_b64_tr_b16 a[168:169], v221 offset:0
  v_mfma_f32_16x16x32_bf16 a[36:39], a[180:183], v[40:43], 0
  v_exp_f32 v113, v113
  v_mfma_f32_16x16x32_bf16 a[36:39], a[176:179], v[8:11], a[36:39]
  ds_read_b64_tr_b16 a[170:171], v221 offset:4096
  v_cvt_pk_bf16_f32 v112, v112, v113
  v_mfma_f32_16x16x32_bf16 a[40:43], a[176:179], v[16:19], 0
  v_exp_f32 v114, v114
  v_mfma_f32_16x16x32_bf16 a[40:43], a[180:183], v[48:51], a[40:43]
  ds_read_b64_tr_b16 a[172:173], v221 offset:8192
  v_mfma_f32_16x16x32_bf16 a[44:47], a[180:183], v[56:59], 0
  s_waitcnt lgkmcnt(7)
  v_exp_f32 v115, v115
  v_mfma_f32_16x16x32_bf16 a[44:47], a[176:179], v[24:27], a[44:47]
  ds_read_b64_tr_b16 a[174:175], v221 offset:12288
  v_cvt_pk_bf16_f32 v113, v114, v115
  v_mfma_f32_16x16x32_bf16 a[48:51], a[184:187], v[0:3], 0
  v_exp_f32 v120, v120
  v_mfma_f32_16x16x32_bf16 a[48:51], a[188:191], v[32:35], a[48:51]
  ds_read_b64_tr_b16 a[176:177], v222 offset:0
  v_mfma_f32_16x16x32_bf16 a[52:55], a[188:191], v[40:43], 0
  v_exp_f32 v121, v121
  v_mfma_f32_16x16x32_bf16 a[52:55], a[184:187], v[8:11], a[52:55]
  ds_read_b64_tr_b16 a[178:179], v222 offset:4096
  v_cvt_pk_bf16_f32 v120, v120, v121
  v_mfma_f32_16x16x32_bf16 a[56:59], a[184:187], v[16:19], 0
  v_exp_f32 v122, v122
  v_mfma_f32_16x16x32_bf16 a[56:59], a[188:191], v[48:51], a[56:59]
  ds_read_b64_tr_b16 a[180:181], v222 offset:8192
  v_mfma_f32_16x16x32_bf16 a[60:63], a[188:191], v[56:59], 0
  s_waitcnt lgkmcnt(7)
  v_exp_f32 v123, v123
  v_mfma_f32_16x16x32_bf16 a[60:63], a[184:187], v[24:27], a[60:63]
  ds_read_b64_tr_b16 a[182:183], v222 offset:12288
  v_cvt_pk_bf16_f32 v121, v122, v123
  v_mfma_f32_16x16x32_bf16 a[64:67], a[160:163], v[0:3], 0
  v_exp_f32 v100, v100
  v_mfma_f32_16x16x32_bf16 a[64:67], a[164:167], v[32:35], a[64:67]
  ds_read_b64_tr_b16 a[184:185], v223 offset:0
  v_mfma_f32_16x16x32_bf16 a[68:71], a[164:167], v[40:43], 0
  v_exp_f32 v101, v101
  v_mfma_f32_16x16x32_bf16 a[68:71], a[160:163], v[8:11], a[68:71]
  ds_read_b64_tr_b16 a[186:187], v223 offset:4096
  v_cvt_pk_bf16_f32 v98, v100, v101
  v_mfma_f32_16x16x32_bf16 a[72:75], a[160:163], v[16:19], 0
  v_exp_f32 v102, v102
  v_mfma_f32_16x16x32_bf16 a[72:75], a[164:167], v[48:51], a[72:75]
  ds_read_b64_tr_b16 a[188:189], v223 offset:8192
  v_mfma_f32_16x16x32_bf16 a[76:79], a[164:167], v[56:59], 0
  s_waitcnt lgkmcnt(7)
  v_exp_f32 v103, v103
  v_mfma_f32_16x16x32_bf16 a[76:79], a[160:163], v[24:27], a[76:79]
  ds_read_b64_tr_b16 a[190:191], v223 offset:12288
  v_cvt_pk_bf16_f32 v99, v102, v103
  v_mfma_f32_16x16x32_bf16 a[80:83], a[168:171], v[0:3], 0
  s_waitcnt vmcnt(10)
  v_exp_f32 v108, v108
  v_mfma_f32_16x16x32_bf16 a[80:83], a[172:175], v[32:35], a[80:83]
  v_mfma_f32_16x16x32_bf16 a[84:87], a[172:175], v[40:43], 0
  s_barrier
  v_exp_f32 v109, v109
  v_mfma_f32_16x16x32_bf16 a[84:87], a[168:171], v[8:11], a[84:87]
  ds_read_b128 a[128:131], v212 offset:32768
  v_cvt_pk_bf16_f32 v106, v108, v109
  v_mfma_f32_16x16x32_bf16 a[88:91], a[168:171], v[16:19], 0
  v_exp_f32 v110, v110
  v_mfma_f32_16x16x32_bf16 a[88:91], a[172:175], v[48:51], a[88:91]
  ds_read_b128 a[132:135], v213 offset:32768
  v_mfma_f32_16x16x32_bf16 a[92:95], a[172:175], v[56:59], 0
  s_waitcnt lgkmcnt(6)
  v_exp_f32 v111, v111
  v_mfma_f32_16x16x32_bf16 a[92:95], a[168:171], v[24:27], a[92:95]
  ds_read_b128 a[136:139], v214 offset:32768
  v_cvt_pk_bf16_f32 v107, v110, v111
  v_mfma_f32_16x16x32_bf16 a[96:99], a[176:179], v[0:3], 0
  s_mul_i32 s38, s3, 20480
  v_exp_f32 v116, v116
  v_mfma_f32_16x16x32_bf16 a[96:99], a[180:183], v[32:35], a[96:99]
  ds_read_b128 a[140:143], v215 offset:32768
  buffer_load_dwordx4 a[212:215], v243, s[24:27], s38 offen sc1
  s_add_u32 s38, s38, 4096
  v_mfma_f32_16x16x32_bf16 a[100:103], a[180:183], v[40:43], 0
  v_exp_f32 v117, v117
  v_mfma_f32_16x16x32_bf16 a[100:103], a[176:179], v[8:11], a[100:103]
  v_cvt_pk_bf16_f32 v114, v116, v117
  v_mfma_f32_16x16x32_bf16 a[104:107], a[176:179], v[16:19], 0
  v_exp_f32 v118, v118
  v_mfma_f32_16x16x32_bf16 a[104:107], a[180:183], v[48:51], a[104:107]
  v_mfma_f32_16x16x32_bf16 a[108:111], a[180:183], v[56:59], 0
  s_waitcnt lgkmcnt(4)
  v_exp_f32 v119, v119
  v_mfma_f32_16x16x32_bf16 a[108:111], a[176:179], v[24:27], a[108:111]
  v_cvt_pk_bf16_f32 v115, v118, v119
  v_mfma_f32_16x16x32_bf16 a[112:115], a[184:187], v[0:3], 0
  v_exp_f32 v124, v124
  v_mfma_f32_16x16x32_bf16 a[112:115], a[188:191], v[32:35], a[112:115]
  v_mfma_f32_16x16x32_bf16 a[116:119], a[188:191], v[40:43], 0
  v_exp_f32 v125, v125
  v_mfma_f32_16x16x32_bf16 a[116:119], a[184:187], v[8:11], a[116:119]
  v_cvt_pk_bf16_f32 v122, v124, v125
  v_mfma_f32_16x16x32_bf16 a[120:123], a[184:187], v[16:19], 0
  v_exp_f32 v126, v126
  v_mfma_f32_16x16x32_bf16 a[120:123], a[188:191], v[48:51], a[120:123]
  v_mfma_f32_16x16x32_bf16 a[124:127], a[188:191], v[56:59], 0
  s_waitcnt lgkmcnt(0)
  v_exp_f32 v127, v127
  v_mfma_f32_16x16x32_bf16 a[124:127], a[184:187], v[24:27], a[124:127]
  v_cvt_pk_bf16_f32 v123, v126, v127
  v_mfma_f32_16x16x32_bf16 v[0:3], a[128:131], v[128:131], v[192:195]
  s_add_u32 m0, s28, 114688
  v_mfma_f32_16x16x32_bf16 v[0:3], a[132:135], v[132:135], v[0:3]
  ds_read_b128 a[144:147], v212 offset:36864
  v_mfma_f32_16x16x32_bf16 v[0:3], a[136:139], v[136:139], v[0:3]
  buffer_load_dwordx4 v236, s[16:19], s29 offen offset:0 lds
  v_mfma_f32_16x16x32_bf16 v[0:3], a[140:143], v[140:143], v[0:3]
  ds_read_b128 a[148:151], v213 offset:36864
  v_mfma_f32_16x16x32_bf16 v[8:11], a[140:143], v[156:159], v[196:199]
  v_mfma_f32_16x16x32_bf16 v[8:11], a[136:139], v[152:155], v[8:11]
  ds_read_b128 a[152:155], v214 offset:36864
  v_mfma_f32_16x16x32_bf16 v[8:11], a[132:135], v[148:151], v[8:11]
  buffer_load_dwordx4 v237, s[16:19], s29 offen offset:1024 lds
  v_mfma_f32_16x16x32_bf16 v[8:11], a[128:131], v[144:147], v[8:11]
  ds_read_b128 a[156:159], v215 offset:36864
  v_mfma_f32_16x16x32_bf16 v[16:19], a[128:131], v[160:163], v[200:203]
  v_exp_f32 v0, v0
  v_mfma_f32_16x16x32_bf16 v[16:19], a[132:135], v[164:167], v[16:19]
  v_mfma_f32_16x16x32_bf16 v[16:19], a[136:139], v[168:171], v[16:19]
  v_exp_f32 v1, v1
  v_mfma_f32_16x16x32_bf16 v[16:19], a[140:143], v[172:175], v[16:19]
  v_cvt_pk_bf16_f32 v0, v0, v1
  v_mfma_f32_16x16x32_bf16 v[24:27], a[140:143], v[188:191], v[204:207]
  v_exp_f32 v2, v2
  v_mfma_f32_16x16x32_bf16 v[24:27], a[136:139], v[184:187], v[24:27]
  buffer_load_dwordx4 v236, s[16:19], s29 offen offset:2048 lds
  v_mfma_f32_16x16x32_bf16 v[24:27], a[132:135], v[180:183], v[24:27]
  s_waitcnt lgkmcnt(0)
  v_exp_f32 v3, v3
  v_mfma_f32_16x16x32_bf16 v[24:27], a[128:131], v[176:179], v[24:27]
  v_cvt_pk_bf16_f32 v1, v2, v3
  v_mfma_f32_16x16x32_bf16 v[4:7], a[144:147], v[128:131], v[192:195]
  v_exp_f32 v8, v8
  v_mfma_f32_16x16x32_bf16 v[4:7], a[148:151], v[132:135], v[4:7]
  ds_read_b128 a[128:131], v212 offset:40960
  v_mfma_f32_16x16x32_bf16 v[4:7], a[152:155], v[136:139], v[4:7]
  v_exp_f32 v9, v9
  v_mfma_f32_16x16x32_bf16 v[4:7], a[156:159], v[140:143], v[4:7]
  ds_read_b128 a[132:135], v213 offset:40960
  v_cvt_pk_bf16_f32 v8, v8, v9
  v_mfma_f32_16x16x32_bf16 v[12:15], a[156:159], v[156:159], v[196:199]
  v_exp_f32 v10, v10
  v_mfma_f32_16x16x32_bf16 v[12:15], a[152:155], v[152:155], v[12:15]
  ds_read_b128 a[136:139], v214 offset:40960
  v_mfma_f32_16x16x32_bf16 v[12:15], a[148:151], v[148:151], v[12:15]
  v_exp_f32 v11, v11
  v_mfma_f32_16x16x32_bf16 v[12:15], a[144:147], v[144:147], v[12:15]
  ds_read_b128 a[140:143], v215 offset:40960
  v_cvt_pk_bf16_f32 v9, v10, v11
  v_mfma_f32_16x16x32_bf16 v[20:23], a[144:147], v[160:163], v[200:203]
  v_exp_f32 v16, v16
  v_mfma_f32_16x16x32_bf16 v[20:23], a[148:151], v[164:167], v[20:23]
  buffer_load_dwordx4 v237, s[16:19], s29 offen offset:3072 lds
  v_mfma_f32_16x16x32_bf16 v[20:23], a[152:155], v[168:171], v[20:23]
  s_add_u32 s29, s29, 16384
  v_exp_f32 v17, v17
  v_mfma_f32_16x16x32_bf16 v[20:23], a[156:159], v[172:175], v[20:23]
  v_cvt_pk_bf16_f32 v16, v16, v17
  v_mfma_f32_16x16x32_bf16 v[28:31], a[156:159], v[188:191], v[204:207]
  s_add_u32 m0, s28, 0
  v_exp_f32 v18, v18
  v_mfma_f32_16x16x32_bf16 v[28:31], a[152:155], v[184:187], v[28:31]
  buffer_load_dwordx4 v232, s[12:15], s29 offen offset:0 lds
  v_mfma_f32_16x16x32_bf16 v[28:31], a[148:151], v[180:183], v[28:31]
  s_waitcnt lgkmcnt(0)
  v_exp_f32 v19, v19
  v_mfma_f32_16x16x32_bf16 v[28:31], a[144:147], v[176:179], v[28:31]
  v_cvt_pk_bf16_f32 v17, v18, v19
  v_mfma_f32_16x16x32_bf16 v[32:35], a[128:131], v[128:131], v[192:195]
  v_exp_f32 v24, v24
  v_mfma_f32_16x16x32_bf16 v[32:35], a[132:135], v[132:135], v[32:35]
  ds_read_b128 a[144:147], v212 offset:45056
  v_mfma_f32_16x16x32_bf16 v[32:35], a[136:139], v[136:139], v[32:35]
  v_exp_f32 v25, v25
  v_mfma_f32_16x16x32_bf16 v[32:35], a[140:143], v[140:143], v[32:35]
  ds_read_b128 a[148:151], v213 offset:45056
  v_cvt_pk_bf16_f32 v24, v24, v25
  v_mfma_f32_16x16x32_bf16 v[40:43], a[140:143], v[156:159], v[196:199]
  v_exp_f32 v26, v26
  v_mfma_f32_16x16x32_bf16 v[40:43], a[136:139], v[152:155], v[40:43]
  ds_read_b128 a[152:155], v214 offset:45056
  v_mfma_f32_16x16x32_bf16 v[40:43], a[132:135], v[148:151], v[40:43]
  v_exp_f32 v27, v27
  v_mfma_f32_16x16x32_bf16 v[40:43], a[128:131], v[144:147], v[40:43]
  ds_read_b128 a[156:159], v215 offset:45056
  v_cvt_pk_bf16_f32 v25, v26, v27
  v_mfma_f32_16x16x32_bf16 v[48:51], a[128:131], v[160:163], v[200:203]
  v_exp_f32 v4, v4
  v_mfma_f32_16x16x32_bf16 v[48:51], a[132:135], v[164:167], v[48:51]
  buffer_load_dwordx4 v233, s[12:15], s29 offen offset:1024 lds
  v_mfma_f32_16x16x32_bf16 v[48:51], a[136:139], v[168:171], v[48:51]
  v_exp_f32 v5, v5
  v_mfma_f32_16x16x32_bf16 v[48:51], a[140:143], v[172:175], v[48:51]
  v_cvt_pk_bf16_f32 v2, v4, v5
  v_mfma_f32_16x16x32_bf16 v[56:59], a[140:143], v[188:191], v[204:207]
  v_exp_f32 v6, v6
  v_mfma_f32_16x16x32_bf16 v[56:59], a[136:139], v[184:187], v[56:59]
  buffer_load_dwordx4 v234, s[12:15], s29 offen offset:2048 lds
  v_mfma_f32_16x16x32_bf16 v[56:59], a[132:135], v[180:183], v[56:59]
  s_waitcnt lgkmcnt(0)
  v_exp_f32 v7, v7
  v_mfma_f32_16x16x32_bf16 v[56:59], a[128:131], v[176:179], v[56:59]
  v_cvt_pk_bf16_f32 v3, v6, v7
  v_mfma_f32_16x16x32_bf16 v[36:39], a[144:147], v[128:131], v[192:195]
  v_exp_f32 v12, v12
  v_mfma_f32_16x16x32_bf16 v[36:39], a[148:151], v[132:135], v[36:39]
  ds_read_b64_tr_b16 a[160:161], v216 offset:16384
  v_mfma_f32_16x16x32_bf16 v[36:39], a[152:155], v[136:139], v[36:39]
  v_exp_f32 v13, v13
  v_mfma_f32_16x16x32_bf16 v[36:39], a[156:159], v[140:143], v[36:39]
  ds_read_b64_tr_b16 a[162:163], v216 offset:20480
  v_cvt_pk_bf16_f32 v10, v12, v13
  v_mfma_f32_16x16x32_bf16 v[44:47], a[156:159], v[156:159], v[196:199]
  v_exp_f32 v14, v14
  v_mfma_f32_16x16x32_bf16 v[44:47], a[152:155], v[152:155], v[44:47]
  ds_read_b64_tr_b16 a[164:165], v216 offset:24576
  buffer_load_dwordx4 v235, s[12:15], s29 offen offset:3072 lds
  v_mfma_f32_16x16x32_bf16 v[44:47], a[148:151], v[148:151], v[44:47]
  v_exp_f32 v15, v15
  v_mfma_f32_16x16x32_bf16 v[44:47], a[144:147], v[144:147], v[44:47]
  ds_read_b64_tr_b16 a[166:167], v216 offset:28672
  v_cvt_pk_bf16_f32 v11, v14, v15
  v_mfma_f32_16x16x32_bf16 v[52:55], a[144:147], v[160:163], v[200:203]
  v_exp_f32 v20, v20
  v_mfma_f32_16x16x32_bf16 v[52:55], a[148:151], v[164:167], v[52:55]
  ds_read_b64_tr_b16 a[168:169], v217 offset:16384
  s_add_u32 m0, s50, 1024
  v_mfma_f32_16x16x32_bf16 v[52:55], a[152:155], v[168:171], v[52:55]
  v_exp_f32 v21, v21
  v_mfma_f32_16x16x32_bf16 v[52:55], a[156:159], v[172:175], v[52:55]
  ds_read_b64_tr_b16 a[170:171], v217 offset:20480
  v_cvt_pk_bf16_f32 v18, v20, v21
  v_mfma_f32_16x16x32_bf16 v[60:63], a[156:159], v[188:191], v[204:207]
  v_exp_f32 v22, v22
  v_mfma_f32_16x16x32_bf16 v[60:63], a[152:155], v[184:187], v[60:63]
  ds_read_b64_tr_b16 a[172:173], v217 offset:24576
  buffer_load_dwordx4 v253, s[20:23], s35 offen lds
  v_mfma_f32_16x16x32_bf16 v[60:63], a[148:151], v[180:183], v[60:63]
  v_exp_f32 v23, v23
  v_mfma_f32_16x16x32_bf16 v[60:63], a[144:147], v[176:179], v[60:63]
  ds_read_b64_tr_b16 a[174:175], v217 offset:28672
  v_cvt_pk_bf16_f32 v19, v22, v23
  v_mfma_f32_16x16x32_bf16 a[192:195], a[208:211], v[64:67], a[192:195]
  v_exp_f32 v28, v28
  v_mfma_f32_16x16x32_bf16 a[192:195], a[208:211], v[96:99], a[192:195]
  ds_read_b64_tr_b16 a[176:177], v218 offset:16384
  v_mfma_f32_16x16x32_bf16 a[196:199], a[208:211], v[72:75], a[196:199]
  v_exp_f32 v29, v29
  v_mfma_f32_16x16x32_bf16 a[196:199], a[208:211], v[104:107], a[196:199]
  ds_read_b64_tr_b16 a[178:179], v218 offset:20480
  v_cvt_pk_bf16_f32 v26, v28, v29
  v_mfma_f32_16x16x32_bf16 a[200:203], a[208:211], v[80:83], a[200:203]
  v_exp_f32 v30, v30
  v_mfma_f32_16x16x32_bf16 a[200:203], a[208:211], v[112:115], a[200:203]
  ds_read_b64_tr_b16 a[180:181], v218 offset:24576
  v_mfma_f32_16x16x32_bf16 a[204:207], a[208:211], v[88:91], a[204:207]
  s_waitcnt lgkmcnt(7)
  v_exp_f32 v31, v31
  v_mfma_f32_16x16x32_bf16 a[204:207], a[208:211], v[120:123], a[204:207]
  ds_read_b64_tr_b16 a[182:183], v218 offset:28672
  v_cvt_pk_bf16_f32 v27, v30, v31
  v_mfma_f32_16x16x32_bf16 a[0:3], a[160:163], v[64:67], a[0:3]
  v_exp_f32 v32, v32
  v_mfma_f32_16x16x32_bf16 a[0:3], a[164:167], v[96:99], a[0:3]
  ds_read_b64_tr_b16 a[184:185], v219 offset:16384
  v_mfma_f32_16x16x32_bf16 a[4:7], a[164:167], v[104:107], a[4:7]
  v_exp_f32 v33, v33
  v_mfma_f32_16x16x32_bf16 a[4:7], a[160:163], v[72:75], a[4:7]
  ds_read_b64_tr_b16 a[186:187], v219 offset:20480
  v_cvt_pk_bf16_f32 v32, v32, v33
  v_mfma_f32_16x16x32_bf16 a[8:11], a[160:163], v[80:83], a[8:11]
  v_exp_f32 v34, v34
  v_mfma_f32_16x16x32_bf16 a[8:11], a[164:167], v[112:115], a[8:11]
  ds_read_b64_tr_b16 a[188:189], v219 offset:24576
  v_mfma_f32_16x16x32_bf16 a[12:15], a[164:167], v[120:123], a[12:15]
  s_waitcnt lgkmcnt(7)
  v_exp_f32 v35, v35
  v_mfma_f32_16x16x32_bf16 a[12:15], a[160:163], v[88:91], a[12:15]
  ds_read_b64_tr_b16 a[190:191], v219 offset:28672
  v_cvt_pk_bf16_f32 v33, v34, v35
  v_mfma_f32_16x16x32_bf16 a[16:19], a[168:171], v[64:67], a[16:19]
  v_exp_f32 v40, v40
  v_mfma_f32_16x16x32_bf16 a[16:19], a[172:175], v[96:99], a[16:19]
  ds_read_b64_tr_b16 a[160:161], v220 offset:16384
  v_mfma_f32_16x16x32_bf16 a[20:23], a[172:175], v[104:107], a[20:23]
  v_exp_f32 v41, v41
  v_mfma_f32_16x16x32_bf16 a[20:23], a[168:171], v[72:75], a[20:23]
  ds_read_b64_tr_b16 a[162:163], v220 offset:20480
  v_cvt_pk_bf16_f32 v40, v40, v41
  v_mfma_f32_16x16x32_bf16 a[24:27], a[168:171], v[80:83], a[24:27]
  v_exp_f32 v42, v42
  v_mfma_f32_16x16x32_bf16 a[24:27], a[172:175], v[112:115], a[24:27]
  ds_read_b64_tr_b16 a[164:165], v220 offset:24576
  v_mfma_f32_16x16x32_bf16 a[28:31], a[172:175], v[120:123], a[28:31]
  s_waitcnt lgkmcnt(7)
  v_exp_f32 v43, v43
  v_mfma_f32_16x16x32_bf16 a[28:31], a[168:171], v[88:91], a[28:31]
  ds_read_b64_tr_b16 a[166:167], v220 offset:28672
  v_cvt_pk_bf16_f32 v41, v42, v43
  v_mfma_f32_16x16x32_bf16 a[32:35], a[176:179], v[64:67], a[32:35]
  v_exp_f32 v48, v48
  v_mfma_f32_16x16x32_bf16 a[32:35], a[180:183], v[96:99], a[32:35]
  ds_read_b64_tr_b16 a[168:169], v221 offset:16384
  v_mfma_f32_16x16x32_bf16 a[36:39], a[180:183], v[104:107], a[36:39]
  v_exp_f32 v49, v49
  v_mfma_f32_16x16x32_bf16 a[36:39], a[176:179], v[72:75], a[36:39]
  ds_read_b64_tr_b16 a[170:171], v221 offset:20480
  v_cvt_pk_bf16_f32 v48, v48, v49
  v_mfma_f32_16x16x32_bf16 a[40:43], a[176:179], v[80:83], a[40:43]
  v_exp_f32 v50, v50
  v_mfma_f32_16x16x32_bf16 a[40:43], a[180:183], v[112:115], a[40:43]
  ds_read_b64_tr_b16 a[172:173], v221 offset:24576
  v_mfma_f32_16x16x32_bf16 a[44:47], a[180:183], v[120:123], a[44:47]
  s_waitcnt lgkmcnt(7)
  v_exp_f32 v51, v51
  v_mfma_f32_16x16x32_bf16 a[44:47], a[176:179], v[88:91], a[44:47]
  ds_read_b64_tr_b16 a[174:175], v221 offset:28672
  v_cvt_pk_bf16_f32 v49, v50, v51
  v_mfma_f32_16x16x32_bf16 a[48:51], a[184:187], v[64:67], a[48:51]
  v_exp_f32 v56, v56
  v_mfma_f32_16x16x32_bf16 a[48:51], a[188:191], v[96:99], a[48:51]
  ds_read_b64_tr_b16 a[176:177], v222 offset:16384
  v_mfma_f32_16x16x32_bf16 a[52:55], a[188:191], v[104:107], a[52:55]
  v_exp_f32 v57, v57
  v_mfma_f32_16x16x32_bf16 a[52:55], a[184:187], v[72:75], a[52:55]
  ds_read_b64_tr_b16 a[178:179], v222 offset:20480
  v_cvt_pk_bf16_f32 v56, v56, v57
  v_mfma_f32_16x16x32_bf16 a[56:59], a[184:187], v[80:83], a[56:59]
  v_exp_f32 v58, v58
  v_mfma_f32_16x16x32_bf16 a[56:59], a[188:191], v[112:115], a[56:59]
  ds_read_b64_tr_b16 a[180:181], v222 offset:24576
  v_mfma_f32_16x16x32_bf16 a[60:63], a[188:191], v[120:123], a[60:63]
  s_waitcnt lgkmcnt(7)
  v_exp_f32 v59, v59
  v_mfma_f32_16x16x32_bf16 a[60:63], a[184:187], v[88:91], a[60:63]
  ds_read_b64_tr_b16 a[182:183], v222 offset:28672
  v_cvt_pk_bf16_f32 v57, v58, v59
  v_mfma_f32_16x16x32_bf16 a[64:67], a[160:163], v[64:67], a[64:67]
  v_exp_f32 v36, v36
  v_mfma_f32_16x16x32_bf16 a[64:67], a[164:167], v[96:99], a[64:67]
  ds_read_b64_tr_b16 a[184:185], v223 offset:16384
  v_mfma_f32_16x16x32_bf16 a[68:71], a[164:167], v[104:107], a[68:71]
  v_exp_f32 v37, v37
  v_mfma_f32_16x16x32_bf16 a[68:71], a[160:163], v[72:75], a[68:71]
  ds_read_b64_tr_b16 a[186:187], v223 offset:20480
  v_cvt_pk_bf16_f32 v34, v36, v37
  v_mfma_f32_16x16x32_bf16 a[72:75], a[160:163], v[80:83], a[72:75]
  v_exp_f32 v38, v38
  v_mfma_f32_16x16x32_bf16 a[72:75], a[164:167], v[112:115], a[72:75]
  ds_read_b64_tr_b16 a[188:189], v223 offset:24576
  v_mfma_f32_16x16x32_bf16 a[76:79], a[164:167], v[120:123], a[76:79]
  s_waitcnt lgkmcnt(7)
  v_exp_f32 v39, v39
  v_mfma_f32_16x16x32_bf16 a[76:79], a[160:163], v[88:91], a[76:79]
  ds_read_b64_tr_b16 a[190:191], v223 offset:28672
  v_cvt_pk_bf16_f32 v35, v38, v39
  v_mfma_f32_16x16x32_bf16 a[80:83], a[168:171], v[64:67], a[80:83]
  s_waitcnt vmcnt(11)
  v_exp_f32 v44, v44
  v_mfma_f32_16x16x32_bf16 a[80:83], a[172:175], v[96:99], a[80:83]
  v_mfma_f32_16x16x32_bf16 a[84:87], a[172:175], v[104:107], a[84:87]
  s_barrier
  v_exp_f32 v45, v45
  v_mfma_f32_16x16x32_bf16 a[84:87], a[168:171], v[72:75], a[84:87]
  ds_read_b128 a[128:131], v212 offset:49152
  v_cvt_pk_bf16_f32 v42, v44, v45
  v_mfma_f32_16x16x32_bf16 a[88:91], a[168:171], v[80:83], a[88:91]
  v_exp_f32 v46, v46
  v_mfma_f32_16x16x32_bf16 a[88:91], a[172:175], v[112:115], a[88:91]
  ds_read_b128 a[132:135], v213 offset:49152
  v_mfma_f32_16x16x32_bf16 a[92:95], a[172:175], v[120:123], a[92:95]
  s_waitcnt lgkmcnt(6)
  v_exp_f32 v47, v47
  v_mfma_f32_16x16x32_bf16 a[92:95], a[168:171], v[88:91], a[92:95]
  ds_read_b128 a[136:139], v214 offset:49152
  v_cvt_pk_bf16_f32 v43, v46, v47
  v_mfma_f32_16x16x32_bf16 a[96:99], a[176:179], v[64:67], a[96:99]
  v_exp_f32 v52, v52
  v_mfma_f32_16x16x32_bf16 a[96:99], a[180:183], v[96:99], a[96:99]
  ds_read_b128 a[140:143], v215 offset:49152
  buffer_load_dwordx4 a[216:219], v243, s[24:27], s38 offen sc1
  s_add_u32 s38, s38, 4096
  v_mfma_f32_16x16x32_bf16 a[100:103], a[180:183], v[104:107], a[100:103]
  v_exp_f32 v53, v53
  v_mfma_f32_16x16x32_bf16 a[100:103], a[176:179], v[72:75], a[100:103]
  v_cvt_pk_bf16_f32 v50, v52, v53
  v_mfma_f32_16x16x32_bf16 a[104:107], a[176:179], v[80:83], a[104:107]
  v_exp_f32 v54, v54
  v_mfma_f32_16x16x32_bf16 a[104:107], a[180:183], v[112:115], a[104:107]
  v_mfma_f32_16x16x32_bf16 a[108:111], a[180:183], v[120:123], a[108:111]
  s_waitcnt lgkmcnt(4)
  v_exp_f32 v55, v55
  v_mfma_f32_16x16x32_bf16 a[108:111], a[176:179], v[88:91], a[108:111]
  v_cvt_pk_bf16_f32 v51, v54, v55
  v_mfma_f32_16x16x32_bf16 a[112:115], a[184:187], v[64:67], a[112:115]
  v_exp_f32 v60, v60
  v_mfma_f32_16x16x32_bf16 a[112:115], a[188:191], v[96:99], a[112:115]
  v_mfma_f32_16x16x32_bf16 a[116:119], a[188:191], v[104:107], a[116:119]
  v_exp_f32 v61, v61
  v_mfma_f32_16x16x32_bf16 a[116:119], a[184:187], v[72:75], a[116:119]
  v_cvt_pk_bf16_f32 v58, v60, v61
  v_mfma_f32_16x16x32_bf16 a[120:123], a[184:187], v[80:83], a[120:123]
  v_exp_f32 v62, v62
  v_mfma_f32_16x16x32_bf16 a[120:123], a[188:191], v[112:115], a[120:123]
  v_mfma_f32_16x16x32_bf16 a[124:127], a[188:191], v[120:123], a[124:127]
  s_waitcnt lgkmcnt(0)
  v_exp_f32 v63, v63
  v_mfma_f32_16x16x32_bf16 a[124:127], a[184:187], v[88:91], a[124:127]
  v_cvt_pk_bf16_f32 v59, v62, v63
  v_mfma_f32_16x16x32_bf16 v[64:67], a[128:131], v[128:131], v[192:195]
  s_add_u32 m0, s28, 65536
  v_mfma_f32_16x16x32_bf16 v[64:67], a[132:135], v[132:135], v[64:67]
  ds_read_b128 a[144:147], v212 offset:53248
  v_mfma_f32_16x16x32_bf16 v[64:67], a[136:139], v[136:139], v[64:67]
  buffer_load_dwordx4 v236, s[16:19], s29 offen offset:0 lds
  v_mfma_f32_16x16x32_bf16 v[64:67], a[140:143], v[140:143], v[64:67]
  ds_read_b128 a[148:151], v213 offset:53248
  v_mfma_f32_16x16x32_bf16 v[72:75], a[140:143], v[156:159], v[196:199]
  v_mfma_f32_16x16x32_bf16 v[72:75], a[136:139], v[152:155], v[72:75]
  ds_read_b128 a[152:155], v214 offset:53248
  v_mfma_f32_16x16x32_bf16 v[72:75], a[132:135], v[148:151], v[72:75]
  buffer_load_dwordx4 v237, s[16:19], s29 offen offset:1024 lds
  v_mfma_f32_16x16x32_bf16 v[72:75], a[128:131], v[144:147], v[72:75]
  ds_read_b128 a[156:159], v215 offset:53248
  v_mfma_f32_16x16x32_bf16 v[80:83], a[128:131], v[160:163], v[200:203]
  v_exp_f32 v64, v64
  v_mfma_f32_16x16x32_bf16 v[80:83], a[132:135], v[164:167], v[80:83]
  v_mfma_f32_16x16x32_bf16 v[80:83], a[136:139], v[168:171], v[80:83]
  v_exp_f32 v65, v65
  v_mfma_f32_16x16x32_bf16 v[80:83], a[140:143], v[172:175], v[80:83]
  v_cvt_pk_bf16_f32 v64, v64, v65
  v_mfma_f32_16x16x32_bf16 v[88:91], a[140:143], v[188:191], v[204:207]
  v_exp_f32 v66, v66
  v_mfma_f32_16x16x32_bf16 v[88:91], a[136:139], v[184:187], v[88:91]
  buffer_load_dwordx4 v236, s[16:19], s29 offen offset:2048 lds
  v_mfma_f32_16x16x32_bf16 v[88:91], a[132:135], v[180:183], v[88:91]
  s_waitcnt lgkmcnt(0)
  v_exp_f32 v67, v67
  v_mfma_f32_16x16x32_bf16 v[88:91], a[128:131], v[176:179], v[88:91]
  v_cvt_pk_bf16_f32 v65, v66, v67
  v_mfma_f32_16x16x32_bf16 v[68:71], a[144:147], v[128:131], v[192:195]
  v_exp_f32 v72, v72
  v_mfma_f32_16x16x32_bf16 v[68:71], a[148:151], v[132:135], v[68:71]
  ds_read_b128 a[128:131], v212 offset:57344
  v_mfma_f32_16x16x32_bf16 v[68:71], a[152:155], v[136:139], v[68:71]
  v_exp_f32 v73, v73
  v_mfma_f32_16x16x32_bf16 v[68:71], a[156:159], v[140:143], v[68:71]
  ds_read_b128 a[132:135], v213 offset:57344
  v_cvt_pk_bf16_f32 v72, v72, v73
  v_mfma_f32_16x16x32_bf16 v[76:79], a[156:159], v[156:159], v[196:199]
  v_exp_f32 v74, v74
  v_mfma_f32_16x16x32_bf16 v[76:79], a[152:155], v[152:155], v[76:79]
  ds_read_b128 a[136:139], v214 offset:57344
  v_mfma_f32_16x16x32_bf16 v[76:79], a[148:151], v[148:151], v[76:79]
  v_exp_f32 v75, v75
  v_mfma_f32_16x16x32_bf16 v[76:79], a[144:147], v[144:147], v[76:79]
  ds_read_b128 a[140:143], v215 offset:57344
  v_cvt_pk_bf16_f32 v73, v74, v75
  v_mfma_f32_16x16x32_bf16 v[84:87], a[144:147], v[160:163], v[200:203]
  v_exp_f32 v80, v80
  v_mfma_f32_16x16x32_bf16 v[84:87], a[148:151], v[164:167], v[84:87]
  buffer_load_dwordx4 v237, s[16:19], s29 offen offset:3072 lds
  v_mfma_f32_16x16x32_bf16 v[84:87], a[152:155], v[168:171], v[84:87]
  s_add_u32 s29, s29, 16384
  v_exp_f32 v81, v81
  v_mfma_f32_16x16x32_bf16 v[84:87], a[156:159], v[172:175], v[84:87]
  v_cvt_pk_bf16_f32 v80, v80, v81
  v_mfma_f32_16x16x32_bf16 v[92:95], a[156:159], v[188:191], v[204:207]
  s_add_u32 m0, s28, 16384
  v_exp_f32 v82, v82
  v_mfma_f32_16x16x32_bf16 v[92:95], a[152:155], v[184:187], v[92:95]
  buffer_load_dwordx4 v232, s[12:15], s29 offen offset:0 lds
  v_mfma_f32_16x16x32_bf16 v[92:95], a[148:151], v[180:183], v[92:95]
  s_waitcnt lgkmcnt(0)
  v_exp_f32 v83, v83
  v_mfma_f32_16x16x32_bf16 v[92:95], a[144:147], v[176:179], v[92:95]
  v_cvt_pk_bf16_f32 v81, v82, v83
  v_mfma_f32_16x16x32_bf16 v[96:99], a[128:131], v[128:131], v[192:195]
  v_exp_f32 v88, v88
  v_mfma_f32_16x16x32_bf16 v[96:99], a[132:135], v[132:135], v[96:99]
  ds_read_b128 a[144:147], v212 offset:61440
  v_mfma_f32_16x16x32_bf16 v[96:99], a[136:139], v[136:139], v[96:99]
  v_exp_f32 v89, v89
  v_mfma_f32_16x16x32_bf16 v[96:99], a[140:143], v[140:143], v[96:99]
  ds_read_b128 a[148:151], v213 offset:61440
  v_cvt_pk_bf16_f32 v88, v88, v89
  v_mfma_f32_16x16x32_bf16 v[104:107], a[140:143], v[156:159], v[196:199]
  v_exp_f32 v90, v90
  v_mfma_f32_16x16x32_bf16 v[104:107], a[136:139], v[152:155], v[104:107]
  ds_read_b128 a[152:155], v214 offset:61440
  v_mfma_f32_16x16x32_bf16 v[104:107], a[132:135], v[148:151], v[104:107]
  v_exp_f32 v91, v91
  v_mfma_f32_16x16x32_bf16 v[104:107], a[128:131], v[144:147], v[104:107]
  ds_read_b128 a[156:159], v215 offset:61440
  v_cvt_pk_bf16_f32 v89, v90, v91
  v_mfma_f32_16x16x32_bf16 v[112:115], a[128:131], v[160:163], v[200:203]
  v_exp_f32 v68, v68
  v_mfma_f32_16x16x32_bf16 v[112:115], a[132:135], v[164:167], v[112:115]
  buffer_load_dwordx4 v233, s[12:15], s29 offen offset:1024 lds
  v_mfma_f32_16x16x32_bf16 v[112:115], a[136:139], v[168:171], v[112:115]
  v_exp_f32 v69, v69
  v_mfma_f32_16x16x32_bf16 v[112:115], a[140:143], v[172:175], v[112:115]
  v_cvt_pk_bf16_f32 v66, v68, v69
  v_mfma_f32_16x16x32_bf16 v[120:123], a[140:143], v[188:191], v[204:207]
  v_exp_f32 v70, v70
  v_mfma_f32_16x16x32_bf16 v[120:123], a[136:139], v[184:187], v[120:123]
  buffer_load_dwordx4 v234, s[12:15], s29 offen offset:2048 lds
  v_mfma_f32_16x16x32_bf16 v[120:123], a[132:135], v[180:183], v[120:123]
  s_waitcnt lgkmcnt(0)
  v_exp_f32 v71, v71
  v_mfma_f32_16x16x32_bf16 v[120:123], a[128:131], v[176:179], v[120:123]
  v_cvt_pk_bf16_f32 v67, v70, v71
  v_mfma_f32_16x16x32_bf16 v[100:103], a[144:147], v[128:131], v[192:195]
  v_exp_f32 v76, v76
  v_mfma_f32_16x16x32_bf16 v[100:103], a[148:151], v[132:135], v[100:103]
  ds_read_b64_tr_b16 a[160:161], v216 offset:32768
  v_mfma_f32_16x16x32_bf16 v[100:103], a[152:155], v[136:139], v[100:103]
  v_exp_f32 v77, v77
  v_mfma_f32_16x16x32_bf16 v[100:103], a[156:159], v[140:143], v[100:103]
  ds_read_b64_tr_b16 a[162:163], v216 offset:36864
  v_cvt_pk_bf16_f32 v74, v76, v77
  v_mfma_f32_16x16x32_bf16 v[108:111], a[156:159], v[156:159], v[196:199]
  v_exp_f32 v78, v78
  v_mfma_f32_16x16x32_bf16 v[108:111], a[152:155], v[152:155], v[108:111]
  ds_read_b64_tr_b16 a[164:165], v216 offset:40960
  buffer_load_dwordx4 v235, s[12:15], s29 offen offset:3072 lds
  v_mfma_f32_16x16x32_bf16 v[108:111], a[148:151], v[148:151], v[108:111]
  v_exp_f32 v79, v79
  v_mfma_f32_16x16x32_bf16 v[108:111], a[144:147], v[144:147], v[108:111]
  ds_read_b64_tr_b16 a[166:167], v216 offset:45056
  v_cvt_pk_bf16_f32 v75, v78, v79
  v_mfma_f32_16x16x32_bf16 v[116:119], a[144:147], v[160:163], v[200:203]
  v_exp_f32 v84, v84
  v_mfma_f32_16x16x32_bf16 v[116:119], a[148:151], v[164:167], v[116:119]
  ds_read_b64_tr_b16 a[168:169], v217 offset:32768
  s_add_u32 m0, s50, 4096
  v_mfma_f32_16x16x32_bf16 v[116:119], a[152:155], v[168:171], v[116:119]
  v_exp_f32 v85, v85
  v_mfma_f32_16x16x32_bf16 v[116:119], a[156:159], v[172:175], v[116:119]
  ds_read_b64_tr_b16 a[170:171], v217 offset:36864
  v_cvt_pk_bf16_f32 v82, v84, v85
  v_mfma_f32_16x16x32_bf16 v[124:127], a[156:159], v[188:191], v[204:207]
  v_exp_f32 v86, v86
  v_mfma_f32_16x16x32_bf16 v[124:127], a[152:155], v[184:187], v[124:127]
  ds_read_b64_tr_b16 a[172:173], v217 offset:40960
  buffer_load_dwordx4 v253, s[44:47], s35 offen lds
  s_add_u32 s35, s35, 221184
  v_mfma_f32_16x16x32_bf16 v[124:127], a[148:151], v[180:183], v[124:127]
  v_exp_f32 v87, v87
  v_mfma_f32_16x16x32_bf16 v[124:127], a[144:147], v[176:179], v[124:127]
  ds_read_b64_tr_b16 a[174:175], v217 offset:45056
  v_cvt_pk_bf16_f32 v83, v86, v87
  v_mfma_f32_16x16x32_bf16 a[192:195], a[208:211], v[0:3], a[192:195]
  v_exp_f32 v92, v92
  v_mfma_f32_16x16x32_bf16 a[192:195], a[208:211], v[32:35], a[192:195]
  ds_read_b64_tr_b16 a[176:177], v218 offset:32768
  v_lshrrev_b32 v254, 4, v242
  v_mfma_f32_16x16x32_bf16 a[196:199], a[208:211], v[8:11], a[196:199]
  v_exp_f32 v93, v93
  v_mfma_f32_16x16x32_bf16 a[196:199], a[208:211], v[40:43], a[196:199]
  ds_read_b64_tr_b16 a[178:179], v218 offset:36864
  v_cvt_pk_bf16_f32 v90, v92, v93
  v_mfma_f32_16x16x32_bf16 a[200:203], a[208:211], v[16:19], a[200:203]
  v_exp_f32 v94, v94
  v_mfma_f32_16x16x32_bf16 a[200:203], a[208:211], v[48:51], a[200:203]
  ds_read_b64_tr_b16 a[180:181], v218 offset:40960
  v_lshrrev_b32 v254, 5, v254
  v_mfma_f32_16x16x32_bf16 a[204:207], a[208:211], v[24:27], a[204:207]
  s_waitcnt lgkmcnt(7)
  v_exp_f32 v95, v95
  v_mfma_f32_16x16x32_bf16 a[204:207], a[208:211], v[56:59], a[204:207]
  ds_read_b64_tr_b16 a[182:183], v218 offset:45056
  v_cvt_pk_bf16_f32 v91, v94, v95
  v_mfma_f32_16x16x32_bf16 a[0:3], a[160:163], v[0:3], a[0:3]
  v_exp_f32 v96, v96
  v_mfma_f32_16x16x32_bf16 a[0:3], a[164:167], v[32:35], a[0:3]
  ds_read_b64_tr_b16 a[184:185], v219 offset:32768
  v_lshl_add_u32 v253, v254, 30, v253
  v_mfma_f32_16x16x32_bf16 a[4:7], a[164:167], v[40:43], a[4:7]
  v_exp_f32 v97, v97
  v_mfma_f32_16x16x32_bf16 a[4:7], a[160:163], v[8:11], a[4:7]
  ds_read_b64_tr_b16 a[186:187], v219 offset:36864
  v_cvt_pk_bf16_f32 v96, v96, v97
  v_mfma_f32_16x16x32_bf16 a[8:11], a[160:163], v[16:19], a[8:11]
  v_exp_f32 v98, v98
  v_mfma_f32_16x16x32_bf16 a[8:11], a[164:167], v[48:51], a[8:11]
  ds_read_b64_tr_b16 a[188:189], v219 offset:40960
  v_mfma_f32_16x16x32_bf16 a[12:15], a[164:167], v[56:59], a[12:15]
  s_waitcnt lgkmcnt(7)
  v_exp_f32 v99, v99
  v_mfma_f32_16x16x32_bf16 a[12:15], a[160:163], v[24:27], a[12:15]
  ds_read_b64_tr_b16 a[190:191], v219 offset:45056
  v_cvt_pk_bf16_f32 v97, v98, v99
  v_mfma_f32_16x16x32_bf16 a[16:19], a[168:171], v[0:3], a[16:19]
  v_exp_f32 v104, v104
  v_mfma_f32_16x16x32_bf16 a[16:19], a[172:175], v[32:35], a[16:19]
  ds_read_b64_tr_b16 a[160:161], v220 offset:32768
  v_mfma_f32_16x16x32_bf16 a[20:23], a[172:175], v[40:43], a[20:23]
  v_exp_f32 v105, v105
  v_mfma_f32_16x16x32_bf16 a[20:23], a[168:171], v[8:11], a[20:23]
  ds_read_b64_tr_b16 a[162:163], v220 offset:36864
  v_cvt_pk_bf16_f32 v104, v104, v105
  v_mfma_f32_16x16x32_bf16 a[24:27], a[168:171], v[16:19], a[24:27]
  v_exp_f32 v106, v106
  v_mfma_f32_16x16x32_bf16 a[24:27], a[172:175], v[48:51], a[24:27]
  ds_read_b64_tr_b16 a[164:165], v220 offset:40960
  v_mfma_f32_16x16x32_bf16 a[28:31], a[172:175], v[56:59], a[28:31]
  s_waitcnt lgkmcnt(7)
  v_exp_f32 v107, v107
  v_mfma_f32_16x16x32_bf16 a[28:31], a[168:171], v[24:27], a[28:31]
  ds_read_b64_tr_b16 a[166:167], v220 offset:45056
  v_cvt_pk_bf16_f32 v105, v106, v107
  v_mfma_f32_16x16x32_bf16 a[32:35], a[176:179], v[0:3], a[32:35]
  v_exp_f32 v112, v112
  v_mfma_f32_16x16x32_bf16 a[32:35], a[180:183], v[32:35], a[32:35]
  ds_read_b64_tr_b16 a[168:169], v221 offset:32768
  v_mfma_f32_16x16x32_bf16 a[36:39], a[180:183], v[40:43], a[36:39]
  v_exp_f32 v113, v113
  v_mfma_f32_16x16x32_bf16 a[36:39], a[176:179], v[8:11], a[36:39]
  ds_read_b64_tr_b16 a[170:171], v221 offset:36864
  v_cvt_pk_bf16_f32 v112, v112, v113
  v_mfma_f32_16x16x32_bf16 a[40:43], a[176:179], v[16:19], a[40:43]
  v_exp_f32 v114, v114
  v_mfma_f32_16x16x32_bf16 a[40:43], a[180:183], v[48:51], a[40:43]
  ds_read_b64_tr_b16 a[172:173], v221 offset:40960
  v_mfma_f32_16x16x32_bf16 a[44:47], a[180:183], v[56:59], a[44:47]
  s_waitcnt lgkmcnt(7)
  v_exp_f32 v115, v115
  v_mfma_f32_16x16x32_bf16 a[44:47], a[176:179], v[24:27], a[44:47]
  ds_read_b64_tr_b16 a[174:175], v221 offset:45056
  v_cvt_pk_bf16_f32 v113, v114, v115
  v_mfma_f32_16x16x32_bf16 a[48:51], a[184:187], v[0:3], a[48:51]
  v_exp_f32 v120, v120
  v_mfma_f32_16x16x32_bf16 a[48:51], a[188:191], v[32:35], a[48:51]
  ds_read_b64_tr_b16 a[176:177], v222 offset:32768
  v_mfma_f32_16x16x32_bf16 a[52:55], a[188:191], v[40:43], a[52:55]
  v_exp_f32 v121, v121
  v_mfma_f32_16x16x32_bf16 a[52:55], a[184:187], v[8:11], a[52:55]
  ds_read_b64_tr_b16 a[178:179], v222 offset:36864
  v_cvt_pk_bf16_f32 v120, v120, v121
  v_mfma_f32_16x16x32_bf16 a[56:59], a[184:187], v[16:19], a[56:59]
  v_exp_f32 v122, v122
  v_mfma_f32_16x16x32_bf16 a[56:59], a[188:191], v[48:51], a[56:59]
  ds_read_b64_tr_b16 a[180:181], v222 offset:40960
  v_mfma_f32_16x16x32_bf16 a[60:63], a[188:191], v[56:59], a[60:63]
  s_waitcnt lgkmcnt(7)
  v_exp_f32 v123, v123
  v_mfma_f32_16x16x32_bf16 a[60:63], a[184:187], v[24:27], a[60:63]
  ds_read_b64_tr_b16 a[182:183], v222 offset:45056
  v_cvt_pk_bf16_f32 v121, v122, v123
  v_mfma_f32_16x16x32_bf16 a[64:67], a[160:163], v[0:3], a[64:67]
  v_exp_f32 v100, v100
  v_mfma_f32_16x16x32_bf16 a[64:67], a[164:167], v[32:35], a[64:67]
  ds_read_b64_tr_b16 a[184:185], v223 offset:32768
  v_mfma_f32_16x16x32_bf16 a[68:71], a[164:167], v[40:43], a[68:71]
  v_exp_f32 v101, v101
  v_mfma_f32_16x16x32_bf16 a[68:71], a[160:163], v[8:11], a[68:71]
  ds_read_b64_tr_b16 a[186:187], v223 offset:36864
  v_cvt_pk_bf16_f32 v98, v100, v101
  v_mfma_f32_16x16x32_bf16 a[72:75], a[160:163], v[16:19], a[72:75]
  v_exp_f32 v102, v102
  v_mfma_f32_16x16x32_bf16 a[72:75], a[164:167], v[48:51], a[72:75]
  ds_read_b64_tr_b16 a[188:189], v223 offset:40960
  v_mfma_f32_16x16x32_bf16 a[76:79], a[164:167], v[56:59], a[76:79]
  s_waitcnt lgkmcnt(7)
  v_exp_f32 v103, v103
  v_mfma_f32_16x16x32_bf16 a[76:79], a[160:163], v[24:27], a[76:79]
  ds_read_b64_tr_b16 a[190:191], v223 offset:45056
  v_cvt_pk_bf16_f32 v99, v102, v103
  v_mfma_f32_16x16x32_bf16 a[80:83], a[168:171], v[0:3], a[80:83]
  s_waitcnt vmcnt(11)
  v_exp_f32 v108, v108
  v_mfma_f32_16x16x32_bf16 a[80:83], a[172:175], v[32:35], a[80:83]
  v_mfma_f32_16x16x32_bf16 a[84:87], a[172:175], v[40:43], a[84:87]
  s_barrier
  v_exp_f32 v109, v109
  v_mfma_f32_16x16x32_bf16 a[84:87], a[168:171], v[8:11], a[84:87]
  ds_read_b128 a[128:131], v212 offset:0
  v_cvt_pk_bf16_f32 v106, v108, v109
  v_mfma_f32_16x16x32_bf16 a[88:91], a[168:171], v[16:19], a[88:91]
  v_exp_f32 v110, v110
  v_mfma_f32_16x16x32_bf16 a[88:91], a[172:175], v[48:51], a[88:91]
  ds_read_b128 a[132:135], v213 offset:0
  v_mfma_f32_16x16x32_bf16 a[92:95], a[172:175], v[56:59], a[92:95]
  s_waitcnt lgkmcnt(6)
  v_exp_f32 v111, v111
  v_mfma_f32_16x16x32_bf16 a[92:95], a[168:171], v[24:27], a[92:95]
  ds_read_b128 a[136:139], v214 offset:0
  v_cvt_pk_bf16_f32 v107, v110, v111
  v_mfma_f32_16x16x32_bf16 a[96:99], a[176:179], v[0:3], a[96:99]
  v_exp_f32 v116, v116
  v_mfma_f32_16x16x32_bf16 a[96:99], a[180:183], v[32:35], a[96:99]
  ds_read_b128 a[140:143], v215 offset:0
  buffer_load_dwordx4 a[220:223], v243, s[24:27], s38 offen sc1
  s_add_u32 s38, s38, 4096
  v_mfma_f32_16x16x32_bf16 a[100:103], a[180:183], v[40:43], a[100:103]
  v_exp_f32 v117, v117
  v_mfma_f32_16x16x32_bf16 a[100:103], a[176:179], v[8:11], a[100:103]
  v_cvt_pk_bf16_f32 v114, v116, v117
  v_mfma_f32_16x16x32_bf16 a[104:107], a[176:179], v[16:19], a[104:107]
  v_exp_f32 v118, v118
  v_mfma_f32_16x16x32_bf16 a[104:107], a[180:183], v[48:51], a[104:107]
  v_mfma_f32_16x16x32_bf16 a[108:111], a[180:183], v[56:59], a[108:111]
  s_waitcnt lgkmcnt(4)
  v_exp_f32 v119, v119
  v_mfma_f32_16x16x32_bf16 a[108:111], a[176:179], v[24:27], a[108:111]
  v_cvt_pk_bf16_f32 v115, v118, v119
  v_mfma_f32_16x16x32_bf16 a[112:115], a[184:187], v[0:3], a[112:115]
  v_exp_f32 v124, v124
  v_mfma_f32_16x16x32_bf16 a[112:115], a[188:191], v[32:35], a[112:115]
  v_mfma_f32_16x16x32_bf16 a[116:119], a[188:191], v[40:43], a[116:119]
  v_exp_f32 v125, v125
  v_mfma_f32_16x16x32_bf16 a[116:119], a[184:187], v[8:11], a[116:119]
  v_cvt_pk_bf16_f32 v122, v124, v125
  v_mfma_f32_16x16x32_bf16 a[120:123], a[184:187], v[16:19], a[120:123]
  v_exp_f32 v126, v126
  v_mfma_f32_16x16x32_bf16 a[120:123], a[188:191], v[48:51], a[120:123]
  v_mfma_f32_16x16x32_bf16 a[124:127], a[188:191], v[56:59], a[124:127]
  s_waitcnt lgkmcnt(0)
  v_exp_f32 v127, v127
  v_mfma_f32_16x16x32_bf16 a[124:127], a[184:187], v[24:27], a[124:127]
  v_cvt_pk_bf16_f32 v123, v126, v127
  v_mfma_f32_16x16x32_bf16 v[0:3], a[128:131], v[128:131], v[192:195]
  s_add_u32 m0, s28, 81920
  v_mfma_f32_16x16x32_bf16 v[0:3], a[132:135], v[132:135], v[0:3]
  ds_read_b128 a[144:147], v212 offset:4096
  v_mfma_f32_16x16x32_bf16 v[0:3], a[136:139], v[136:139], v[0:3]
  buffer_load_dwordx4 v236, s[16:19], s29 offen offset:0 lds
  v_mfma_f32_16x16x32_bf16 v[0:3], a[140:143], v[140:143], v[0:3]
  ds_read_b128 a[148:151], v213 offset:4096
  v_mfma_f32_16x16x32_bf16 v[8:11], a[140:143], v[156:159], v[196:199]
  v_mfma_f32_16x16x32_bf16 v[8:11], a[136:139], v[152:155], v[8:11]
  ds_read_b128 a[152:155], v214 offset:4096
  v_mfma_f32_16x16x32_bf16 v[8:11], a[132:135], v[148:151], v[8:11]
  buffer_load_dwordx4 v237, s[16:19], s29 offen offset:1024 lds
  v_mfma_f32_16x16x32_bf16 v[8:11], a[128:131], v[144:147], v[8:11]
  ds_read_b128 a[156:159], v215 offset:4096
  v_mfma_f32_16x16x32_bf16 v[16:19], a[128:131], v[160:163], v[200:203]
  v_exp_f32 v0, v0
  v_mfma_f32_16x16x32_bf16 v[16:19], a[132:135], v[164:167], v[16:19]
  v_mfma_f32_16x16x32_bf16 v[16:19], a[136:139], v[168:171], v[16:19]
  v_exp_f32 v1, v1
  v_mfma_f32_16x16x32_bf16 v[16:19], a[140:143], v[172:175], v[16:19]
  v_cvt_pk_bf16_f32 v0, v0, v1
  v_mfma_f32_16x16x32_bf16 v[24:27], a[140:143], v[188:191], v[204:207]
  v_exp_f32 v2, v2
  v_mfma_f32_16x16x32_bf16 v[24:27], a[136:139], v[184:187], v[24:27]
  buffer_load_dwordx4 v236, s[16:19], s29 offen offset:2048 lds
  v_mfma_f32_16x16x32_bf16 v[24:27], a[132:135], v[180:183], v[24:27]
  s_waitcnt lgkmcnt(0)
  v_exp_f32 v3, v3
  v_mfma_f32_16x16x32_bf16 v[24:27], a[128:131], v[176:179], v[24:27]
  v_cvt_pk_bf16_f32 v1, v2, v3
  v_mfma_f32_16x16x32_bf16 v[4:7], a[144:147], v[128:131], v[192:195]
  v_exp_f32 v8, v8
  v_mfma_f32_16x16x32_bf16 v[4:7], a[148:151], v[132:135], v[4:7]
  ds_read_b128 a[128:131], v212 offset:8192
  v_mfma_f32_16x16x32_bf16 v[4:7], a[152:155], v[136:139], v[4:7]
  v_exp_f32 v9, v9
  v_mfma_f32_16x16x32_bf16 v[4:7], a[156:159], v[140:143], v[4:7]
  ds_read_b128 a[132:135], v213 offset:8192
  v_cvt_pk_bf16_f32 v8, v8, v9
  v_mfma_f32_16x16x32_bf16 v[12:15], a[156:159], v[156:159], v[196:199]
  v_exp_f32 v10, v10
  v_mfma_f32_16x16x32_bf16 v[12:15], a[152:155], v[152:155], v[12:15]
  ds_read_b128 a[136:139], v214 offset:8192
  v_mfma_f32_16x16x32_bf16 v[12:15], a[148:151], v[148:151], v[12:15]
  v_exp_f32 v11, v11
  v_mfma_f32_16x16x32_bf16 v[12:15], a[144:147], v[144:147], v[12:15]
  ds_read_b128 a[140:143], v215 offset:8192
  v_cvt_pk_bf16_f32 v9, v10, v11
  v_mfma_f32_16x16x32_bf16 v[20:23], a[144:147], v[160:163], v[200:203]
  v_exp_f32 v16, v16
  v_mfma_f32_16x16x32_bf16 v[20:23], a[148:151], v[164:167], v[20:23]
  buffer_load_dwordx4 v237, s[16:19], s29 offen offset:3072 lds
  v_mfma_f32_16x16x32_bf16 v[20:23], a[152:155], v[168:171], v[20:23]
  s_add_u32 s29, s29, 16384
  v_exp_f32 v17, v17
  v_mfma_f32_16x16x32_bf16 v[20:23], a[156:159], v[172:175], v[20:23]
  v_cvt_pk_bf16_f32 v16, v16, v17
  v_mfma_f32_16x16x32_bf16 v[28:31], a[156:159], v[188:191], v[204:207]
  s_add_u32 m0, s28, 32768
  v_exp_f32 v18, v18
  v_mfma_f32_16x16x32_bf16 v[28:31], a[152:155], v[184:187], v[28:31]
  buffer_load_dwordx4 v232, s[12:15], s29 offen offset:0 lds
  v_mfma_f32_16x16x32_bf16 v[28:31], a[148:151], v[180:183], v[28:31]
  s_waitcnt lgkmcnt(0)
  v_exp_f32 v19, v19
  v_mfma_f32_16x16x32_bf16 v[28:31], a[144:147], v[176:179], v[28:31]
  v_cvt_pk_bf16_f32 v17, v18, v19
  v_mfma_f32_16x16x32_bf16 v[32:35], a[128:131], v[128:131], v[192:195]
  v_exp_f32 v24, v24
  v_mfma_f32_16x16x32_bf16 v[32:35], a[132:135], v[132:135], v[32:35]
  ds_read_b128 a[144:147], v212 offset:12288
  v_mfma_f32_16x16x32_bf16 v[32:35], a[136:139], v[136:139], v[32:35]
  v_exp_f32 v25, v25
  v_mfma_f32_16x16x32_bf16 v[32:35], a[140:143], v[140:143], v[32:35]
  ds_read_b128 a[148:151], v213 offset:12288
  v_cvt_pk_bf16_f32 v24, v24, v25
  v_mfma_f32_16x16x32_bf16 v[40:43], a[140:143], v[156:159], v[196:199]
  v_exp_f32 v26, v26
  v_mfma_f32_16x16x32_bf16 v[40:43], a[136:139], v[152:155], v[40:43]
  ds_read_b128 a[152:155], v214 offset:12288
  v_mfma_f32_16x16x32_bf16 v[40:43], a[132:135], v[148:151], v[40:43]
  v_exp_f32 v27, v27
  v_mfma_f32_16x16x32_bf16 v[40:43], a[128:131], v[144:147], v[40:43]
  ds_read_b128 a[156:159], v215 offset:12288
  v_cvt_pk_bf16_f32 v25, v26, v27
  v_mfma_f32_16x16x32_bf16 v[48:51], a[128:131], v[160:163], v[200:203]
  v_exp_f32 v4, v4
  v_mfma_f32_16x16x32_bf16 v[48:51], a[132:135], v[164:167], v[48:51]
  buffer_load_dwordx4 v233, s[12:15], s29 offen offset:1024 lds
  v_mfma_f32_16x16x32_bf16 v[48:51], a[136:139], v[168:171], v[48:51]
  v_exp_f32 v5, v5
  v_mfma_f32_16x16x32_bf16 v[48:51], a[140:143], v[172:175], v[48:51]
  v_cvt_pk_bf16_f32 v2, v4, v5
  v_mfma_f32_16x16x32_bf16 v[56:59], a[140:143], v[188:191], v[204:207]
  v_exp_f32 v6, v6
  v_mfma_f32_16x16x32_bf16 v[56:59], a[136:139], v[184:187], v[56:59]
  buffer_load_dwordx4 v234, s[12:15], s29 offen offset:2048 lds
  v_mfma_f32_16x16x32_bf16 v[56:59], a[132:135], v[180:183], v[56:59]
  s_waitcnt lgkmcnt(0)
  v_exp_f32 v7, v7
  v_mfma_f32_16x16x32_bf16 v[56:59], a[128:131], v[176:179], v[56:59]
  v_cvt_pk_bf16_f32 v3, v6, v7
  v_mfma_f32_16x16x32_bf16 v[36:39], a[144:147], v[128:131], v[192:195]
  v_exp_f32 v12, v12
  v_mfma_f32_16x16x32_bf16 v[36:39], a[148:151], v[132:135], v[36:39]
  ds_read_b64_tr_b16 a[160:161], v216 offset:49152
  v_mfma_f32_16x16x32_bf16 v[36:39], a[152:155], v[136:139], v[36:39]
  v_exp_f32 v13, v13
  v_mfma_f32_16x16x32_bf16 v[36:39], a[156:159], v[140:143], v[36:39]
  ds_read_b64_tr_b16 a[162:163], v216 offset:53248
  v_cvt_pk_bf16_f32 v10, v12, v13
  v_mfma_f32_16x16x32_bf16 v[44:47], a[156:159], v[156:159], v[196:199]
  v_exp_f32 v14, v14
  v_mfma_f32_16x16x32_bf16 v[44:47], a[152:155], v[152:155], v[44:47]
  ds_read_b64_tr_b16 a[164:165], v216 offset:57344
  buffer_load_dwordx4 v235, s[12:15], s29 offen offset:3072 lds
  v_mfma_f32_16x16x32_bf16 v[44:47], a[148:151], v[148:151], v[44:47]
  v_exp_f32 v15, v15
  v_mfma_f32_16x16x32_bf16 v[44:47], a[144:147], v[144:147], v[44:47]
  ds_read_b64_tr_b16 a[166:167], v216 offset:61440
  v_cvt_pk_bf16_f32 v11, v14, v15
  v_mfma_f32_16x16x32_bf16 v[52:55], a[144:147], v[160:163], v[200:203]
  v_exp_f32 v20, v20
  v_mfma_f32_16x16x32_bf16 v[52:55], a[148:151], v[164:167], v[52:55]
  ds_read_b64_tr_b16 a[168:169], v217 offset:49152
  s_add_u32 m0, s50, 2048
  v_mfma_f32_16x16x32_bf16 v[52:55], a[152:155], v[168:171], v[52:55]
  v_exp_f32 v21, v21
  v_mfma_f32_16x16x32_bf16 v[52:55], a[156:159], v[172:175], v[52:55]
  ds_read_b64_tr_b16 a[170:171], v217 offset:53248
  v_cvt_pk_bf16_f32 v18, v20, v21
  v_mfma_f32_16x16x32_bf16 v[60:63], a[156:159], v[188:191], v[204:207]
  v_exp_f32 v22, v22
  v_mfma_f32_16x16x32_bf16 v[60:63], a[152:155], v[184:187], v[60:63]
  ds_read_b64_tr_b16 a[172:173], v217 offset:57344
  buffer_load_dwordx4 v253, s[20:23], s35 offen lds
  v_mfma_f32_16x16x32_bf16 v[60:63], a[148:151], v[180:183], v[60:63]
  v_exp_f32 v23, v23
  v_mfma_f32_16x16x32_bf16 v[60:63], a[144:147], v[176:179], v[60:63]
  ds_read_b64_tr_b16 a[174:175], v217 offset:61440
  v_cvt_pk_bf16_f32 v19, v22, v23
  v_mfma_f32_16x16x32_bf16 a[192:195], a[208:211], v[64:67], a[192:195]
  v_exp_f32 v28, v28
  v_mfma_f32_16x16x32_bf16 a[192:195], a[208:211], v[96:99], a[192:195]
  ds_read_b64_tr_b16 a[176:177], v218 offset:49152
  v_mfma_f32_16x16x32_bf16 a[196:199], a[208:211], v[72:75], a[196:199]
  v_exp_f32 v29, v29
  v_mfma_f32_16x16x32_bf16 a[196:199], a[208:211], v[104:107], a[196:199]
  ds_read_b64_tr_b16 a[178:179], v218 offset:53248
  v_cvt_pk_bf16_f32 v26, v28, v29
  v_mfma_f32_16x16x32_bf16 a[200:203], a[208:211], v[80:83], a[200:203]
  v_exp_f32 v30, v30
  v_mfma_f32_16x16x32_bf16 a[200:203], a[208:211], v[112:115], a[200:203]
  ds_read_b64_tr_b16 a[180:181], v218 offset:57344
  v_mfma_f32_16x16x32_bf16 a[204:207], a[208:211], v[88:91], a[204:207]
  s_waitcnt lgkmcnt(7)
  v_exp_f32 v31, v31
  v_mfma_f32_16x16x32_bf16 a[204:207], a[208:211], v[120:123], a[204:207]
  ds_read_b64_tr_b16 a[182:183], v218 offset:61440
  v_cvt_pk_bf16_f32 v27, v30, v31
  v_mfma_f32_16x16x32_bf16 a[0:3], a[160:163], v[64:67], a[0:3]
  v_exp_f32 v32, v32
  v_mfma_f32_16x16x32_bf16 a[0:3], a[164:167], v[96:99], a[0:3]
  ds_read_b64_tr_b16 a[184:185], v219 offset:49152
  v_mfma_f32_16x16x32_bf16 a[4:7], a[164:167], v[104:107], a[4:7]
  v_exp_f32 v33, v33
  v_mfma_f32_16x16x32_bf16 a[4:7], a[160:163], v[72:75], a[4:7]
  ds_read_b64_tr_b16 a[186:187], v219 offset:53248
  v_cvt_pk_bf16_f32 v32, v32, v33
  v_mfma_f32_16x16x32_bf16 a[8:11], a[160:163], v[80:83], a[8:11]
  v_exp_f32 v34, v34
  v_mfma_f32_16x16x32_bf16 a[8:11], a[164:167], v[112:115], a[8:11]
  ds_read_b64_tr_b16 a[188:189], v219 offset:57344
  v_mfma_f32_16x16x32_bf16 a[12:15], a[164:167], v[120:123], a[12:15]
  s_waitcnt lgkmcnt(7)
  v_exp_f32 v35, v35
  v_mfma_f32_16x16x32_bf16 a[12:15], a[160:163], v[88:91], a[12:15]
  ds_read_b64_tr_b16 a[190:191], v219 offset:61440
  v_cvt_pk_bf16_f32 v33, v34, v35
  v_mfma_f32_16x16x32_bf16 a[16:19], a[168:171], v[64:67], a[16:19]
  v_exp_f32 v40, v40
  v_mfma_f32_16x16x32_bf16 a[16:19], a[172:175], v[96:99], a[16:19]
  ds_read_b64_tr_b16 a[160:161], v220 offset:49152
  v_mfma_f32_16x16x32_bf16 a[20:23], a[172:175], v[104:107], a[20:23]
  v_exp_f32 v41, v41
  v_mfma_f32_16x16x32_bf16 a[20:23], a[168:171], v[72:75], a[20:23]
  ds_read_b64_tr_b16 a[162:163], v220 offset:53248
  v_cvt_pk_bf16_f32 v40, v40, v41
  v_mfma_f32_16x16x32_bf16 a[24:27], a[168:171], v[80:83], a[24:27]
  v_exp_f32 v42, v42
  v_mfma_f32_16x16x32_bf16 a[24:27], a[172:175], v[112:115], a[24:27]
  ds_read_b64_tr_b16 a[164:165], v220 offset:57344
  v_mfma_f32_16x16x32_bf16 a[28:31], a[172:175], v[120:123], a[28:31]
  s_waitcnt lgkmcnt(7)
  v_exp_f32 v43, v43
  v_mfma_f32_16x16x32_bf16 a[28:31], a[168:171], v[88:91], a[28:31]
  ds_read_b64_tr_b16 a[166:167], v220 offset:61440
  v_cvt_pk_bf16_f32 v41, v42, v43
  v_mfma_f32_16x16x32_bf16 a[32:35], a[176:179], v[64:67], a[32:35]
  v_exp_f32 v48, v48
  v_mfma_f32_16x16x32_bf16 a[32:35], a[180:183], v[96:99], a[32:35]
  ds_read_b64_tr_b16 a[168:169], v221 offset:49152
  v_mfma_f32_16x16x32_bf16 a[36:39], a[180:183], v[104:107], a[36:39]
  v_exp_f32 v49, v49
  v_mfma_f32_16x16x32_bf16 a[36:39], a[176:179], v[72:75], a[36:39]
  ds_read_b64_tr_b16 a[170:171], v221 offset:53248
  v_cvt_pk_bf16_f32 v48, v48, v49
  v_mfma_f32_16x16x32_bf16 a[40:43], a[176:179], v[80:83], a[40:43]
  v_exp_f32 v50, v50
  v_mfma_f32_16x16x32_bf16 a[40:43], a[180:183], v[112:115], a[40:43]
  ds_read_b64_tr_b16 a[172:173], v221 offset:57344
  v_mfma_f32_16x16x32_bf16 a[44:47], a[180:183], v[120:123], a[44:47]
  s_waitcnt lgkmcnt(7)
  v_exp_f32 v51, v51
  v_mfma_f32_16x16x32_bf16 a[44:47], a[176:179], v[88:91], a[44:47]
  ds_read_b64_tr_b16 a[174:175], v221 offset:61440
  v_cvt_pk_bf16_f32 v49, v50, v51
  v_mfma_f32_16x16x32_bf16 a[48:51], a[184:187], v[64:67], a[48:51]
  v_exp_f32 v56, v56
  v_mfma_f32_16x16x32_bf16 a[48:51], a[188:191], v[96:99], a[48:51]
  ds_read_b64_tr_b16 a[176:177], v222 offset:49152
  v_mfma_f32_16x16x32_bf16 a[52:55], a[188:191], v[104:107], a[52:55]
  v_exp_f32 v57, v57
  v_mfma_f32_16x16x32_bf16 a[52:55], a[184:187], v[72:75], a[52:55]
  ds_read_b64_tr_b16 a[178:179], v222 offset:53248
  v_cvt_pk_bf16_f32 v56, v56, v57
  v_mfma_f32_16x16x32_bf16 a[56:59], a[184:187], v[80:83], a[56:59]
  v_exp_f32 v58, v58
  v_mfma_f32_16x16x32_bf16 a[56:59], a[188:191], v[112:115], a[56:59]
  ds_read_b64_tr_b16 a[180:181], v222 offset:57344
  v_mfma_f32_16x16x32_bf16 a[60:63], a[188:191], v[120:123], a[60:63]
  s_waitcnt lgkmcnt(7)
  v_exp_f32 v59, v59
  v_mfma_f32_16x16x32_bf16 a[60:63], a[184:187], v[88:91], a[60:63]
  ds_read_b64_tr_b16 a[182:183], v222 offset:61440
  v_cvt_pk_bf16_f32 v57, v58, v59
  v_mfma_f32_16x16x32_bf16 a[64:67], a[160:163], v[64:67], a[64:67]
  v_exp_f32 v36, v36
  v_mfma_f32_16x16x32_bf16 a[64:67], a[164:167], v[96:99], a[64:67]
  ds_read_b64_tr_b16 a[184:185], v223 offset:49152
  v_mfma_f32_16x16x32_bf16 a[68:71], a[164:167], v[104:107], a[68:71]
  v_exp_f32 v37, v37
  v_mfma_f32_16x16x32_bf16 a[68:71], a[160:163], v[72:75], a[68:71]
  ds_read_b64_tr_b16 a[186:187], v223 offset:53248
  v_cvt_pk_bf16_f32 v34, v36, v37
  v_mfma_f32_16x16x32_bf16 a[72:75], a[160:163], v[80:83], a[72:75]
  v_exp_f32 v38, v38
  v_mfma_f32_16x16x32_bf16 a[72:75], a[164:167], v[112:115], a[72:75]
  ds_read_b64_tr_b16 a[188:189], v223 offset:57344
  v_mfma_f32_16x16x32_bf16 a[76:79], a[164:167], v[120:123], a[76:79]
  s_waitcnt lgkmcnt(7)
  v_exp_f32 v39, v39
  v_mfma_f32_16x16x32_bf16 a[76:79], a[160:163], v[88:91], a[76:79]
  ds_read_b64_tr_b16 a[190:191], v223 offset:61440
  v_cvt_pk_bf16_f32 v35, v38, v39
  v_mfma_f32_16x16x32_bf16 a[80:83], a[168:171], v[64:67], a[80:83]
  s_waitcnt vmcnt(11)
  v_exp_f32 v44, v44
  v_mfma_f32_16x16x32_bf16 a[80:83], a[172:175], v[96:99], a[80:83]
  v_mfma_f32_16x16x32_bf16 a[84:87], a[172:175], v[104:107], a[84:87]
  s_barrier
  v_exp_f32 v45, v45
  v_mfma_f32_16x16x32_bf16 a[84:87], a[168:171], v[72:75], a[84:87]
  ds_read_b128 a[128:131], v212 offset:16384
  v_cvt_pk_bf16_f32 v42, v44, v45
  v_mfma_f32_16x16x32_bf16 a[88:91], a[168:171], v[80:83], a[88:91]
  v_exp_f32 v46, v46
  v_mfma_f32_16x16x32_bf16 a[88:91], a[172:175], v[112:115], a[88:91]
  ds_read_b128 a[132:135], v213 offset:16384
  v_mfma_f32_16x16x32_bf16 a[92:95], a[172:175], v[120:123], a[92:95]
  s_waitcnt lgkmcnt(6)
  v_exp_f32 v47, v47
  v_mfma_f32_16x16x32_bf16 a[92:95], a[168:171], v[88:91], a[92:95]
  ds_read_b128 a[136:139], v214 offset:16384
  v_cvt_pk_bf16_f32 v43, v46, v47
  v_mfma_f32_16x16x32_bf16 a[96:99], a[176:179], v[64:67], a[96:99]
  v_exp_f32 v52, v52
  v_mfma_f32_16x16x32_bf16 a[96:99], a[180:183], v[96:99], a[96:99]
  ds_read_b128 a[140:143], v215 offset:16384
  buffer_load_dwordx4 a[224:227], v243, s[24:27], s38 offen sc1
  s_add_u32 s38, s38, 4096
  v_mfma_f32_16x16x32_bf16 a[100:103], a[180:183], v[104:107], a[100:103]
  v_exp_f32 v53, v53
  v_mfma_f32_16x16x32_bf16 a[100:103], a[176:179], v[72:75], a[100:103]
  v_cvt_pk_bf16_f32 v50, v52, v53
  v_mfma_f32_16x16x32_bf16 a[104:107], a[176:179], v[80:83], a[104:107]
  v_exp_f32 v54, v54
  v_mfma_f32_16x16x32_bf16 a[104:107], a[180:183], v[112:115], a[104:107]
  v_mfma_f32_16x16x32_bf16 a[108:111], a[180:183], v[120:123], a[108:111]
  s_waitcnt lgkmcnt(4)
  v_exp_f32 v55, v55
  v_mfma_f32_16x16x32_bf16 a[108:111], a[176:179], v[88:91], a[108:111]
  v_cvt_pk_bf16_f32 v51, v54, v55
  v_mfma_f32_16x16x32_bf16 a[112:115], a[184:187], v[64:67], a[112:115]
  v_exp_f32 v60, v60
  v_mfma_f32_16x16x32_bf16 a[112:115], a[188:191], v[96:99], a[112:115]
  v_mfma_f32_16x16x32_bf16 a[116:119], a[188:191], v[104:107], a[116:119]
  v_exp_f32 v61, v61
  v_mfma_f32_16x16x32_bf16 a[116:119], a[184:187], v[72:75], a[116:119]
  v_cvt_pk_bf16_f32 v58, v60, v61
  v_mfma_f32_16x16x32_bf16 a[120:123], a[184:187], v[80:83], a[120:123]
  v_exp_f32 v62, v62
  v_mfma_f32_16x16x32_bf16 a[120:123], a[188:191], v[112:115], a[120:123]
  v_mfma_f32_16x16x32_bf16 a[124:127], a[188:191], v[120:123], a[124:127]
  s_waitcnt lgkmcnt(0)
  v_exp_f32 v63, v63
  v_mfma_f32_16x16x32_bf16 a[124:127], a[184:187], v[88:91], a[124:127]
  v_cvt_pk_bf16_f32 v59, v62, v63
  v_mfma_f32_16x16x32_bf16 v[64:67], a[128:131], v[128:131], v[192:195]
  s_add_u32 m0, s28, 98304
  v_mfma_f32_16x16x32_bf16 v[64:67], a[132:135], v[132:135], v[64:67]
  ds_read_b128 a[144:147], v212 offset:20480
  v_mfma_f32_16x16x32_bf16 v[64:67], a[136:139], v[136:139], v[64:67]
  buffer_load_dwordx4 v236, s[16:19], s29 offen offset:0 lds
  v_mfma_f32_16x16x32_bf16 v[64:67], a[140:143], v[140:143], v[64:67]
  ds_read_b128 a[148:151], v213 offset:20480
  v_mfma_f32_16x16x32_bf16 v[72:75], a[140:143], v[156:159], v[196:199]
  v_mfma_f32_16x16x32_bf16 v[72:75], a[136:139], v[152:155], v[72:75]
  ds_read_b128 a[152:155], v214 offset:20480
  v_mfma_f32_16x16x32_bf16 v[72:75], a[132:135], v[148:151], v[72:75]
  buffer_load_dwordx4 v237, s[16:19], s29 offen offset:1024 lds
  v_mfma_f32_16x16x32_bf16 v[72:75], a[128:131], v[144:147], v[72:75]
  ds_read_b128 a[156:159], v215 offset:20480
  v_mfma_f32_16x16x32_bf16 v[80:83], a[128:131], v[160:163], v[200:203]
  v_exp_f32 v64, v64
  v_mfma_f32_16x16x32_bf16 v[80:83], a[132:135], v[164:167], v[80:83]
  v_mfma_f32_16x16x32_bf16 v[80:83], a[136:139], v[168:171], v[80:83]
  v_exp_f32 v65, v65
  v_mfma_f32_16x16x32_bf16 v[80:83], a[140:143], v[172:175], v[80:83]
  v_cvt_pk_bf16_f32 v64, v64, v65
  v_mfma_f32_16x16x32_bf16 v[88:91], a[140:143], v[188:191], v[204:207]
  v_exp_f32 v66, v66
  v_mfma_f32_16x16x32_bf16 v[88:91], a[136:139], v[184:187], v[88:91]
  buffer_load_dwordx4 v236, s[16:19], s29 offen offset:2048 lds
  v_mfma_f32_16x16x32_bf16 v[88:91], a[132:135], v[180:183], v[88:91]
  s_waitcnt lgkmcnt(0)
  v_exp_f32 v67, v67
  v_mfma_f32_16x16x32_bf16 v[88:91], a[128:131], v[176:179], v[88:91]
  v_cvt_pk_bf16_f32 v65, v66, v67
  v_mfma_f32_16x16x32_bf16 v[68:71], a[144:147], v[128:131], v[192:195]
  v_exp_f32 v72, v72
  v_mfma_f32_16x16x32_bf16 v[68:71], a[148:151], v[132:135], v[68:71]
  ds_read_b128 a[128:131], v212 offset:24576
  v_mfma_f32_16x16x32_bf16 v[68:71], a[152:155], v[136:139], v[68:71]
  v_exp_f32 v73, v73
  v_mfma_f32_16x16x32_bf16 v[68:71], a[156:159], v[140:143], v[68:71]
  ds_read_b128 a[132:135], v213 offset:24576
  v_cvt_pk_bf16_f32 v72, v72, v73
  v_mfma_f32_16x16x32_bf16 v[76:79], a[156:159], v[156:159], v[196:199]
  v_exp_f32 v74, v74
  v_mfma_f32_16x16x32_bf16 v[76:79], a[152:155], v[152:155], v[76:79]
  ds_read_b128 a[136:139], v214 offset:24576
  v_mfma_f32_16x16x32_bf16 v[76:79], a[148:151], v[148:151], v[76:79]
  v_exp_f32 v75, v75
  v_mfma_f32_16x16x32_bf16 v[76:79], a[144:147], v[144:147], v[76:79]
  ds_read_b128 a[140:143], v215 offset:24576
  v_cvt_pk_bf16_f32 v73, v74, v75
  v_mfma_f32_16x16x32_bf16 v[84:87], a[144:147], v[160:163], v[200:203]
  v_exp_f32 v80, v80
  v_mfma_f32_16x16x32_bf16 v[84:87], a[148:151], v[164:167], v[84:87]
  buffer_load_dwordx4 v237, s[16:19], s29 offen offset:3072 lds
  v_mfma_f32_16x16x32_bf16 v[84:87], a[152:155], v[168:171], v[84:87]
  s_add_u32 s29, s29, 16384
  v_exp_f32 v81, v81
  v_mfma_f32_16x16x32_bf16 v[84:87], a[156:159], v[172:175], v[84:87]
  v_cvt_pk_bf16_f32 v80, v80, v81
  v_mfma_f32_16x16x32_bf16 v[92:95], a[156:159], v[188:191], v[204:207]
  s_add_u32 m0, s28, 49152
  v_exp_f32 v82, v82
  v_mfma_f32_16x16x32_bf16 v[92:95], a[152:155], v[184:187], v[92:95]
  buffer_load_dwordx4 v232, s[12:15], s29 offen offset:0 lds
  v_mfma_f32_16x16x32_bf16 v[92:95], a[148:151], v[180:183], v[92:95]
  s_waitcnt lgkmcnt(0)
  v_exp_f32 v83, v83
  v_mfma_f32_16x16x32_bf16 v[92:95], a[144:147], v[176:179], v[92:95]
  v_cvt_pk_bf16_f32 v81, v82, v83
  v_mfma_f32_16x16x32_bf16 v[96:99], a[128:131], v[128:131], v[192:195]
  v_exp_f32 v88, v88
  v_mfma_f32_16x16x32_bf16 v[96:99], a[132:135], v[132:135], v[96:99]
  ds_read_b128 a[144:147], v212 offset:28672
  v_mfma_f32_16x16x32_bf16 v[96:99], a[136:139], v[136:139], v[96:99]
  v_exp_f32 v89, v89
  v_mfma_f32_16x16x32_bf16 v[96:99], a[140:143], v[140:143], v[96:99]
  ds_read_b128 a[148:151], v213 offset:28672
  v_cvt_pk_bf16_f32 v88, v88, v89
  v_mfma_f32_16x16x32_bf16 v[104:107], a[140:143], v[156:159], v[196:199]
  v_exp_f32 v90, v90
  v_mfma_f32_16x16x32_bf16 v[104:107], a[136:139], v[152:155], v[104:107]
  ds_read_b128 a[152:155], v214 offset:28672
  v_mfma_f32_16x16x32_bf16 v[104:107], a[132:135], v[148:151], v[104:107]
  v_exp_f32 v91, v91
  v_mfma_f32_16x16x32_bf16 v[104:107], a[128:131], v[144:147], v[104:107]
  ds_read_b128 a[156:159], v215 offset:28672
  v_cvt_pk_bf16_f32 v89, v90, v91
  v_mfma_f32_16x16x32_bf16 v[112:115], a[128:131], v[160:163], v[200:203]
  v_exp_f32 v68, v68
  v_mfma_f32_16x16x32_bf16 v[112:115], a[132:135], v[164:167], v[112:115]
  buffer_load_dwordx4 v233, s[12:15], s29 offen offset:1024 lds
  v_mfma_f32_16x16x32_bf16 v[112:115], a[136:139], v[168:171], v[112:115]
  v_exp_f32 v69, v69
  v_mfma_f32_16x16x32_bf16 v[112:115], a[140:143], v[172:175], v[112:115]
  v_cvt_pk_bf16_f32 v66, v68, v69
  v_mfma_f32_16x16x32_bf16 v[120:123], a[140:143], v[188:191], v[204:207]
  v_exp_f32 v70, v70
  v_mfma_f32_16x16x32_bf16 v[120:123], a[136:139], v[184:187], v[120:123]
  buffer_load_dwordx4 v234, s[12:15], s29 offen offset:2048 lds
  v_mfma_f32_16x16x32_bf16 v[120:123], a[132:135], v[180:183], v[120:123]
  s_waitcnt lgkmcnt(0)
  v_exp_f32 v71, v71
  v_mfma_f32_16x16x32_bf16 v[120:123], a[128:131], v[176:179], v[120:123]
  v_cvt_pk_bf16_f32 v67, v70, v71
  v_mfma_f32_16x16x32_bf16 v[100:103], a[144:147], v[128:131], v[192:195]
  v_exp_f32 v76, v76
  v_mfma_f32_16x16x32_bf16 v[100:103], a[148:151], v[132:135], v[100:103]
  ds_read_b64_tr_b16 a[160:161], v216 offset:0
  v_mfma_f32_16x16x32_bf16 v[100:103], a[152:155], v[136:139], v[100:103]
  v_exp_f32 v77, v77
  v_mfma_f32_16x16x32_bf16 v[100:103], a[156:159], v[140:143], v[100:103]
  ds_read_b64_tr_b16 a[162:163], v216 offset:4096
  v_cvt_pk_bf16_f32 v74, v76, v77
  v_mfma_f32_16x16x32_bf16 v[108:111], a[156:159], v[156:159], v[196:199]
  v_exp_f32 v78, v78
  v_mfma_f32_16x16x32_bf16 v[108:111], a[152:155], v[152:155], v[108:111]
  ds_read_b64_tr_b16 a[164:165], v216 offset:8192
  buffer_load_dwordx4 v235, s[12:15], s29 offen offset:3072 lds
  v_mfma_f32_16x16x32_bf16 v[108:111], a[148:151], v[148:151], v[108:111]
  v_exp_f32 v79, v79
  v_mfma_f32_16x16x32_bf16 v[108:111], a[144:147], v[144:147], v[108:111]
  ds_read_b64_tr_b16 a[166:167], v216 offset:12288
  v_cvt_pk_bf16_f32 v75, v78, v79
  v_mfma_f32_16x16x32_bf16 v[116:119], a[144:147], v[160:163], v[200:203]
  v_exp_f32 v84, v84
  v_mfma_f32_16x16x32_bf16 v[116:119], a[148:151], v[164:167], v[116:119]
  ds_read_b64_tr_b16 a[168:169], v217 offset:0
  s_add_u32 m0, s50, 5120
  v_mfma_f32_16x16x32_bf16 v[116:119], a[152:155], v[168:171], v[116:119]
  v_exp_f32 v85, v85
  v_mfma_f32_16x16x32_bf16 v[116:119], a[156:159], v[172:175], v[116:119]
  ds_read_b64_tr_b16 a[170:171], v217 offset:4096
  v_cvt_pk_bf16_f32 v82, v84, v85
  v_mfma_f32_16x16x32_bf16 v[124:127], a[156:159], v[188:191], v[204:207]
  v_exp_f32 v86, v86
  v_mfma_f32_16x16x32_bf16 v[124:127], a[152:155], v[184:187], v[124:127]
  ds_read_b64_tr_b16 a[172:173], v217 offset:8192
  buffer_load_dwordx4 v253, s[44:47], s35 offen lds
  s_add_u32 s35, s35, 221184
  v_mfma_f32_16x16x32_bf16 v[124:127], a[148:151], v[180:183], v[124:127]
  v_exp_f32 v87, v87
  v_mfma_f32_16x16x32_bf16 v[124:127], a[144:147], v[176:179], v[124:127]
  ds_read_b64_tr_b16 a[174:175], v217 offset:12288
  v_cvt_pk_bf16_f32 v83, v86, v87
  v_mfma_f32_16x16x32_bf16 a[192:195], a[208:211], v[0:3], a[192:195]
  v_exp_f32 v92, v92
  v_mfma_f32_16x16x32_bf16 a[192:195], a[208:211], v[32:35], a[192:195]
  ds_read_b64_tr_b16 a[176:177], v218 offset:0
  v_mfma_f32_16x16x32_bf16 a[196:199], a[208:211], v[8:11], a[196:199]
  v_exp_f32 v93, v93
  v_mfma_f32_16x16x32_bf16 a[196:199], a[208:211], v[40:43], a[196:199]
  ds_read_b64_tr_b16 a[178:179], v218 offset:4096
  v_cvt_pk_bf16_f32 v90, v92, v93
  v_mfma_f32_16x16x32_bf16 a[200:203], a[208:211], v[16:19], a[200:203]
  v_exp_f32 v94, v94
  v_mfma_f32_16x16x32_bf16 a[200:203], a[208:211], v[48:51], a[200:203]
  ds_read_b64_tr_b16 a[180:181], v218 offset:8192
  v_mfma_f32_16x16x32_bf16 a[204:207], a[208:211], v[24:27], a[204:207]
  s_waitcnt lgkmcnt(7)
  v_exp_f32 v95, v95
  v_mfma_f32_16x16x32_bf16 a[204:207], a[208:211], v[56:59], a[204:207]
  ds_read_b64_tr_b16 a[182:183], v218 offset:12288
  v_cvt_pk_bf16_f32 v91, v94, v95
  v_mfma_f32_16x16x32_bf16 a[0:3], a[160:163], v[0:3], a[0:3]
  v_exp_f32 v96, v96
  v_mfma_f32_16x16x32_bf16 a[0:3], a[164:167], v[32:35], a[0:3]
  ds_read_b64_tr_b16 a[184:185], v219 offset:0
  v_mfma_f32_16x16x32_bf16 a[4:7], a[164:167], v[40:43], a[4:7]
  v_exp_f32 v97, v97
  v_mfma_f32_16x16x32_bf16 a[4:7], a[160:163], v[8:11], a[4:7]
  ds_read_b64_tr_b16 a[186:187], v219 offset:4096
  v_cvt_pk_bf16_f32 v96, v96, v97
  v_mfma_f32_16x16x32_bf16 a[8:11], a[160:163], v[16:19], a[8:11]
  v_exp_f32 v98, v98
  v_mfma_f32_16x16x32_bf16 a[8:11], a[164:167], v[48:51], a[8:11]
  ds_read_b64_tr_b16 a[188:189], v219 offset:8192
  v_mfma_f32_16x16x32_bf16 a[12:15], a[164:167], v[56:59], a[12:15]
  s_waitcnt lgkmcnt(7)
  v_exp_f32 v99, v99
  v_mfma_f32_16x16x32_bf16 a[12:15], a[160:163], v[24:27], a[12:15]
  ds_read_b64_tr_b16 a[190:191], v219 offset:12288
  v_cvt_pk_bf16_f32 v97, v98, v99
  v_mfma_f32_16x16x32_bf16 a[16:19], a[168:171], v[0:3], a[16:19]
  v_exp_f32 v104, v104
  v_mfma_f32_16x16x32_bf16 a[16:19], a[172:175], v[32:35], a[16:19]
  ds_read_b64_tr_b16 a[160:161], v220 offset:0
  v_mfma_f32_16x16x32_bf16 a[20:23], a[172:175], v[40:43], a[20:23]
  v_exp_f32 v105, v105
  v_mfma_f32_16x16x32_bf16 a[20:23], a[168:171], v[8:11], a[20:23]
  ds_read_b64_tr_b16 a[162:163], v220 offset:4096
  v_cvt_pk_bf16_f32 v104, v104, v105
  v_mfma_f32_16x16x32_bf16 a[24:27], a[168:171], v[16:19], a[24:27]
  v_exp_f32 v106, v106
  v_mfma_f32_16x16x32_bf16 a[24:27], a[172:175], v[48:51], a[24:27]
  ds_read_b64_tr_b16 a[164:165], v220 offset:8192
  v_mfma_f32_16x16x32_bf16 a[28:31], a[172:175], v[56:59], a[28:31]
  s_waitcnt lgkmcnt(7)
  v_exp_f32 v107, v107
  v_mfma_f32_16x16x32_bf16 a[28:31], a[168:171], v[24:27], a[28:31]
  ds_read_b64_tr_b16 a[166:167], v220 offset:12288
  v_cvt_pk_bf16_f32 v105, v106, v107
  v_mfma_f32_16x16x32_bf16 a[32:35], a[176:179], v[0:3], a[32:35]
  v_exp_f32 v112, v112
  v_mfma_f32_16x16x32_bf16 a[32:35], a[180:183], v[32:35], a[32:35]
  ds_read_b64_tr_b16 a[168:169], v221 offset:0
  v_mfma_f32_16x16x32_bf16 a[36:39], a[180:183], v[40:43], a[36:39]
  v_exp_f32 v113, v113
  v_mfma_f32_16x16x32_bf16 a[36:39], a[176:179], v[8:11], a[36:39]
  ds_read_b64_tr_b16 a[170:171], v221 offset:4096
  v_cvt_pk_bf16_f32 v112, v112, v113
  v_mfma_f32_16x16x32_bf16 a[40:43], a[176:179], v[16:19], a[40:43]
  v_exp_f32 v114, v114
  v_mfma_f32_16x16x32_bf16 a[40:43], a[180:183], v[48:51], a[40:43]
  ds_read_b64_tr_b16 a[172:173], v221 offset:8192
  v_mfma_f32_16x16x32_bf16 a[44:47], a[180:183], v[56:59], a[44:47]
  s_waitcnt lgkmcnt(7)
  v_exp_f32 v115, v115
  v_mfma_f32_16x16x32_bf16 a[44:47], a[176:179], v[24:27], a[44:47]
  ds_read_b64_tr_b16 a[174:175], v221 offset:12288
  v_cvt_pk_bf16_f32 v113, v114, v115
  v_mfma_f32_16x16x32_bf16 a[48:51], a[184:187], v[0:3], a[48:51]
  v_exp_f32 v120, v120
  v_mfma_f32_16x16x32_bf16 a[48:51], a[188:191], v[32:35], a[48:51]
  ds_read_b64_tr_b16 a[176:177], v222 offset:0
  v_mfma_f32_16x16x32_bf16 a[52:55], a[188:191], v[40:43], a[52:55]
  v_exp_f32 v121, v121
  v_mfma_f32_16x16x32_bf16 a[52:55], a[184:187], v[8:11], a[52:55]
  ds_read_b64_tr_b16 a[178:179], v222 offset:4096
  v_cvt_pk_bf16_f32 v120, v120, v121
  v_mfma_f32_16x16x32_bf16 a[56:59], a[184:187], v[16:19], a[56:59]
  v_exp_f32 v122, v122
  v_mfma_f32_16x16x32_bf16 a[56:59], a[188:191], v[48:51], a[56:59]
  ds_read_b64_tr_b16 a[180:181], v222 offset:8192
  v_mfma_f32_16x16x32_bf16 a[60:63], a[188:191], v[56:59], a[60:63]
  s_waitcnt lgkmcnt(7)
  v_exp_f32 v123, v123
  v_mfma_f32_16x16x32_bf16 a[60:63], a[184:187], v[24:27], a[60:63]
  ds_read_b64_tr_b16 a[182:183], v222 offset:12288
  v_cvt_pk_bf16_f32 v121, v122, v123
  v_mfma_f32_16x16x32_bf16 a[64:67], a[160:163], v[0:3], a[64:67]
  v_exp_f32 v100, v100
  v_mfma_f32_16x16x32_bf16 a[64:67], a[164:167], v[32:35], a[64:67]
  ds_read_b64_tr_b16 a[184:185], v223 offset:0
  v_mfma_f32_16x16x32_bf16 a[68:71], a[164:167], v[40:43], a[68:71]
  v_exp_f32 v101, v101
  v_mfma_f32_16x16x32_bf16 a[68:71], a[160:163], v[8:11], a[68:71]
  ds_read_b64_tr_b16 a[186:187], v223 offset:4096
  v_cvt_pk_bf16_f32 v98, v100, v101
  v_mfma_f32_16x16x32_bf16 a[72:75], a[160:163], v[16:19], a[72:75]
  v_exp_f32 v102, v102
  v_mfma_f32_16x16x32_bf16 a[72:75], a[164:167], v[48:51], a[72:75]
  ds_read_b64_tr_b16 a[188:189], v223 offset:8192
  v_mfma_f32_16x16x32_bf16 a[76:79], a[164:167], v[56:59], a[76:79]
  s_waitcnt lgkmcnt(7)
  v_exp_f32 v103, v103
  v_mfma_f32_16x16x32_bf16 a[76:79], a[160:163], v[24:27], a[76:79]
  ds_read_b64_tr_b16 a[190:191], v223 offset:12288
  v_cvt_pk_bf16_f32 v99, v102, v103
  v_mfma_f32_16x16x32_bf16 a[80:83], a[168:171], v[0:3], a[80:83]
  s_waitcnt vmcnt(11)
  v_exp_f32 v108, v108
  v_mfma_f32_16x16x32_bf16 a[80:83], a[172:175], v[32:35], a[80:83]
  v_mfma_f32_16x16x32_bf16 a[84:87], a[172:175], v[40:43], a[84:87]
  s_barrier
  v_exp_f32 v109, v109
  v_mfma_f32_16x16x32_bf16 a[84:87], a[168:171], v[8:11], a[84:87]
  ds_read_b128 a[128:131], v212 offset:32768
  v_cvt_pk_bf16_f32 v106, v108, v109
  v_mfma_f32_16x16x32_bf16 a[88:91], a[168:171], v[16:19], a[88:91]
  v_exp_f32 v110, v110
  v_mfma_f32_16x16x32_bf16 a[88:91], a[172:175], v[48:51], a[88:91]
  ds_read_b128 a[132:135], v213 offset:32768
  v_mfma_f32_16x16x32_bf16 a[92:95], a[172:175], v[56:59], a[92:95]
  s_waitcnt lgkmcnt(6)
  v_exp_f32 v111, v111
  v_mfma_f32_16x16x32_bf16 a[92:95], a[168:171], v[24:27], a[92:95]
  ds_read_b128 a[136:139], v214 offset:32768
  v_cvt_pk_bf16_f32 v107, v110, v111
  v_mfma_f32_16x16x32_bf16 a[96:99], a[176:179], v[0:3], a[96:99]
  v_exp_f32 v116, v116
  v_mfma_f32_16x16x32_bf16 a[96:99], a[180:183], v[32:35], a[96:99]
  ds_read_b128 a[140:143], v215 offset:32768
  buffer_load_dwordx4 a[228:231], v243, s[24:27], s38 offen sc1
  s_add_u32 s38, s38, 4096
  v_mfma_f32_16x16x32_bf16 a[100:103], a[180:183], v[40:43], a[100:103]
  v_exp_f32 v117, v117
  v_mfma_f32_16x16x32_bf16 a[100:103], a[176:179], v[8:11], a[100:103]
  v_cvt_pk_bf16_f32 v114, v116, v117
  v_mfma_f32_16x16x32_bf16 a[104:107], a[176:179], v[16:19], a[104:107]
  v_exp_f32 v118, v118
  v_mfma_f32_16x16x32_bf16 a[104:107], a[180:183], v[48:51], a[104:107]
  v_mfma_f32_16x16x32_bf16 a[108:111], a[180:183], v[56:59], a[108:111]
  s_waitcnt lgkmcnt(4)
  v_exp_f32 v119, v119
  v_mfma_f32_16x16x32_bf16 a[108:111], a[176:179], v[24:27], a[108:111]
  v_cvt_pk_bf16_f32 v115, v118, v119
  v_mfma_f32_16x16x32_bf16 a[112:115], a[184:187], v[0:3], a[112:115]
  v_exp_f32 v124, v124
  v_mfma_f32_16x16x32_bf16 a[112:115], a[188:191], v[32:35], a[112:115]
  v_mfma_f32_16x16x32_bf16 a[116:119], a[188:191], v[40:43], a[116:119]
  v_exp_f32 v125, v125
  v_mfma_f32_16x16x32_bf16 a[116:119], a[184:187], v[8:11], a[116:119]
  v_cvt_pk_bf16_f32 v122, v124, v125
  v_mfma_f32_16x16x32_bf16 a[120:123], a[184:187], v[16:19], a[120:123]
  v_exp_f32 v126, v126
  v_mfma_f32_16x16x32_bf16 a[120:123], a[188:191], v[48:51], a[120:123]
  v_mfma_f32_16x16x32_bf16 a[124:127], a[188:191], v[56:59], a[124:127]
  s_waitcnt lgkmcnt(0)
  v_exp_f32 v127, v127
  v_mfma_f32_16x16x32_bf16 a[124:127], a[184:187], v[24:27], a[124:127]
  v_cvt_pk_bf16_f32 v123, v126, v127
  v_mfma_f32_16x16x32_bf16 v[0:3], a[128:131], v[128:131], v[192:195]
  s_add_u32 m0, s28, 114688
  s_mov_b32 s20, s88
  s_mov_b32 s21, s89
  v_mfma_f32_16x16x32_bf16 v[0:3], a[132:135], v[132:135], v[0:3]
  ds_read_b128 a[144:147], v212 offset:36864
  s_mov_b32 s22, 5242880
  s_mov_b32 s23, 0x20000
  v_lshrrev_b32 v208, 4, v242
  v_mfma_f32_16x16x32_bf16 v[0:3], a[136:139], v[136:139], v[0:3]
  buffer_load_dwordx4 v236, s[16:19], s29 offen offset:0 lds
  v_mfma_f32_16x16x32_bf16 v[0:3], a[140:143], v[140:143], v[0:3]
  ds_read_b128 a[148:151], v213 offset:36864
  v_and_b32 v209, 1, v208
  v_mfma_f32_16x16x32_bf16 v[8:11], a[140:143], v[156:159], v[196:199]
  v_lshrrev_b32 v208, 1, v208
  v_mul_u32_u24 v208, 0x500, v208
  v_mfma_f32_16x16x32_bf16 v[8:11], a[136:139], v[152:155], v[8:11]
  ds_read_b128 a[152:155], v214 offset:36864
  v_lshl_add_u32 v208, v209, 4, v208
  v_mfma_f32_16x16x32_bf16 v[8:11], a[132:135], v[148:151], v[8:11]
  buffer_load_dwordx4 v237, s[16:19], s29 offen offset:1024 lds
  v_mfma_f32_16x16x32_bf16 v[8:11], a[128:131], v[144:147], v[8:11]
  ds_read_b128 a[156:159], v215 offset:36864
  v_lshrrev_b32 v209, 4, v242
  v_mfma_f32_16x16x32_bf16 v[16:19], a[128:131], v[160:163], v[200:203]
  v_exp_f32 v0, v0
  v_mfma_f32_16x16x32_bf16 v[16:19], a[132:135], v[164:167], v[16:19]
  v_lshrrev_b32 v210, 5, v209
  v_lshlrev_b32 v210, 30, v210
  v_mfma_f32_16x16x32_bf16 v[16:19], a[136:139], v[168:171], v[16:19]
  v_exp_f32 v1, v1
  v_mfma_f32_16x16x32_bf16 v[16:19], a[140:143], v[172:175], v[16:19]
  v_cvt_pk_bf16_f32 v0, v0, v1
  v_or_b32 v210, v210, v208
  v_mfma_f32_16x16x32_bf16 v[24:27], a[140:143], v[188:191], v[204:207]
  v_exp_f32 v2, v2
  v_mfma_f32_16x16x32_bf16 v[24:27], a[136:139], v[184:187], v[24:27]
  buffer_load_dwordx4 v236, s[16:19], s29 offen offset:2048 lds
  v_mfma_f32_16x16x32_bf16 v[24:27], a[132:135], v[180:183], v[24:27]
  s_waitcnt lgkmcnt(0)
  v_exp_f32 v3, v3
  v_mfma_f32_16x16x32_bf16 v[24:27], a[128:131], v[176:179], v[24:27]
  v_cvt_pk_bf16_f32 v1, v2, v3
  v_bfe_u32 v211, v209, 2, 4
  v_mfma_f32_16x16x32_bf16 v[4:7], a[144:147], v[128:131], v[192:195]
  v_exp_f32 v8, v8
  v_mfma_f32_16x16x32_bf16 v[4:7], a[148:151], v[132:135], v[4:7]
  ds_read_b128 a[128:131], v212 offset:40960
  v_and_b32 v209, 3, v209
  v_mfma_f32_16x16x32_bf16 v[4:7], a[152:155], v[136:139], v[4:7]
  v_exp_f32 v9, v9
  v_mfma_f32_16x16x32_bf16 v[4:7], a[156:159], v[140:143], v[4:7]
  ds_read_b128 a[132:135], v213 offset:40960
  v_cvt_pk_bf16_f32 v8, v8, v9
  v_mfma_f32_16x16x32_bf16 v[12:15], a[156:159], v[156:159], v[196:199]
  v_exp_f32 v10, v10
  v_mfma_f32_16x16x32_bf16 v[12:15], a[152:155], v[152:155], v[12:15]
  ds_read_b128 a[136:139], v214 offset:40960
  v_lshlrev_b32 v209, 3, v209
  v_mfma_f32_16x16x32_bf16 v[12:15], a[148:151], v[148:151], v[12:15]
  v_exp_f32 v11, v11
  v_mfma_f32_16x16x32_bf16 v[12:15], a[144:147], v[144:147], v[12:15]
  ds_read_b128 a[140:143], v215 offset:40960
  v_cvt_pk_bf16_f32 v9, v10, v11
  v_mfma_f32_16x16x32_bf16 v[20:23], a[144:147], v[160:163], v[200:203]
  v_exp_f32 v16, v16
  v_mfma_f32_16x16x32_bf16 v[20:23], a[148:151], v[164:167], v[20:23]
  buffer_load_dwordx4 v237, s[16:19], s29 offen offset:3072 lds
  v_mfma_f32_16x16x32_bf16 v[20:23], a[152:155], v[168:171], v[20:23]
  s_add_u32 s29, s29, 16384
  v_exp_f32 v17, v17
  v_mfma_f32_16x16x32_bf16 v[20:23], a[156:159], v[172:175], v[20:23]
  v_cvt_pk_bf16_f32 v16, v16, v17
  v_lshl_add_u32 v209, v211, 5, v209
  v_mfma_f32_16x16x32_bf16 v[28:31], a[156:159], v[188:191], v[204:207]
  s_add_u32 m0, s28, 0
  v_exp_f32 v18, v18
  v_mfma_f32_16x16x32_bf16 v[28:31], a[152:155], v[184:187], v[28:31]
  buffer_load_dwordx4 v232, s[12:15], s29 offen offset:0 lds
  v_mfma_f32_16x16x32_bf16 v[28:31], a[148:151], v[180:183], v[28:31]
  s_waitcnt lgkmcnt(0)
  v_exp_f32 v19, v19
  v_mfma_f32_16x16x32_bf16 v[28:31], a[144:147], v[176:179], v[28:31]
  v_cvt_pk_bf16_f32 v17, v18, v19
  v_add_u32 v209, s50, v209
  v_mfma_f32_16x16x32_bf16 v[32:35], a[128:131], v[128:131], v[192:195]
  s_and_b32 s39, s2, 1
  s_lshl_b32 s39, s39, 2
  s_add_u32 s39, s39, s3
  v_exp_f32 v24, v24
  v_mfma_f32_16x16x32_bf16 v[32:35], a[132:135], v[132:135], v[32:35]
  ds_read_b128 a[144:147], v212 offset:45056
  s_lshr_b32 s31, s2, 1
  s_mul_i32 s30, s31, 40960
  s_mul_i32 s48, s39, 160
  v_mfma_f32_16x16x32_bf16 v[32:35], a[136:139], v[136:139], v[32:35]
  s_add_u32 s30, s30, s48
  s_mul_i32 s31, s31, 5120
  s_mul_i32 s39, s39, 655360
  v_exp_f32 v25, v25
  v_mfma_f32_16x16x32_bf16 v[32:35], a[140:143], v[140:143], v[32:35]
  ds_read_b128 a[148:151], v213 offset:45056
  s_add_u32 s31, s31, s39
  s_add_u32 s31, s31, 3145728
  s_lshr_b32 s39, s2, 3
  v_cvt_pk_bf16_f32 v24, v24, v25
  v_mfma_f32_16x16x32_bf16 v[40:43], a[140:143], v[156:159], v[196:199]
  s_min_u32 s39, s39, 29
  s_and_b32 s48, s2, 7
  s_mul_i32 s48, s48, 30
  v_exp_f32 v26, v26
  v_mfma_f32_16x16x32_bf16 v[40:43], a[136:139], v[152:155], v[40:43]
  ds_read_b128 a[152:155], v214 offset:45056
  s_add_u32 s39, s39, s48
  s_mul_i32 s98, s39, 1639
  s_lshr_b32 s98, s98, 16
  v_mfma_f32_16x16x32_bf16 v[40:43], a[132:135], v[148:151], v[40:43]
  s_mul_i32 s99, s98, 40
  s_sub_u32 s99, s39, s99
  s_min_u32 s39, s3, 2
  v_exp_f32 v27, v27
  v_mfma_f32_16x16x32_bf16 v[40:43], a[128:131], v[144:147], v[40:43]
  ds_read_b128 a[156:159], v215 offset:45056
  s_mul_i32 s48, s98, 3
  s_add_u32 s48, s48, s39
  s_mul_i32 s100, s48, 122880
  v_cvt_pk_bf16_f32 v25, v26, v27
  v_mfma_f32_16x16x32_bf16 v[48:51], a[128:131], v[160:163], v[200:203]
  s_lshl_b32 s39, s99, 5
  s_add_u32 s100, s100, s39
  s_mul_i32 s101, s48, 192
  v_exp_f32 v4, v4
  v_mfma_f32_16x16x32_bf16 v[48:51], a[132:135], v[164:167], v[48:51]
  buffer_load_dwordx4 v233, s[12:15], s29 offen offset:1024 lds
  s_add_u32 s101, s101, 2633728
  s_mov_b32 s51, s50
  v_mfma_f32_16x16x32_bf16 v[48:51], a[136:139], v[168:171], v[48:51]
  v_exp_f32 v5, v5
  v_mfma_f32_16x16x32_bf16 v[48:51], a[140:143], v[172:175], v[48:51]
  v_cvt_pk_bf16_f32 v2, v4, v5
  v_mov_b32 v211, v242
  v_mfma_f32_16x16x32_bf16 v[56:59], a[140:143], v[188:191], v[204:207]
  s_mov_b32 s4, s94
  s_mov_b32 s5, s95
  s_mov_b32 s6, 2211840
  v_exp_f32 v6, v6
  v_mfma_f32_16x16x32_bf16 v[56:59], a[136:139], v[184:187], v[56:59]
  buffer_load_dwordx4 v234, s[12:15], s29 offen offset:2048 lds
  s_mov_b32 s7, 0x20000
  s_getpc_b64 s[8:9]
attn_late_pc:
  s_add_u32 s8, s8, attn_h_ready-attn_late_pc
  s_addc_u32 s9, s9, 0
  v_mfma_f32_16x16x32_bf16 v[56:59], a[132:135], v[180:183], v[56:59]
  s_waitcnt lgkmcnt(0)
  s_lshr_b32 s39, s2, 3
  v_exp_f32 v7, v7
  v_mfma_f32_16x16x32_bf16 v[56:59], a[128:131], v[176:179], v[56:59]
  v_cvt_pk_bf16_f32 v3, v6, v7
  v_lshrrev_b32 v252, 4, v242
  v_mfma_f32_16x16x32_bf16 v[36:39], a[144:147], v[128:131], v[192:195]
  v_exp_f32 v12, v12
  v_mfma_f32_16x16x32_bf16 v[36:39], a[148:151], v[132:135], v[36:39]
  ds_read_b64_tr_b16 a[160:161], v216 offset:16384
  v_min_u32 v252, 11, v252
  v_mfma_f32_16x16x32_bf16 v[36:39], a[152:155], v[136:139], v[36:39]
  v_exp_f32 v13, v13
  v_mfma_f32_16x16x32_bf16 v[36:39], a[156:159], v[140:143], v[36:39]
  ds_read_b64_tr_b16 a[162:163], v216 offset:20480
  v_cvt_pk_bf16_f32 v10, v12, v13
  v_mfma_f32_16x16x32_bf16 v[44:47], a[156:159], v[156:159], v[196:199]
  v_exp_f32 v14, v14
  v_mfma_f32_16x16x32_bf16 v[44:47], a[152:155], v[152:155], v[44:47]
  ds_read_b64_tr_b16 a[164:165], v216 offset:24576
  buffer_load_dwordx4 v235, s[12:15], s29 offen offset:3072 lds
  v_mfma_f32_16x16x32_bf16 v[44:47], a[148:151], v[148:151], v[44:47]
  v_exp_f32 v15, v15
  v_mfma_f32_16x16x32_bf16 v[44:47], a[144:147], v[144:147], v[44:47]
  ds_read_b64_tr_b16 a[166:167], v216 offset:28672
  v_cvt_pk_bf16_f32 v11, v14, v15
  v_mfma_f32_16x16x32_bf16 v[52:55], a[144:147], v[160:163], v[200:203]
  v_exp_f32 v20, v20
  v_mfma_f32_16x16x32_bf16 v[52:55], a[148:151], v[164:167], v[52:55]
  ds_read_b64_tr_b16 a[168:169], v217 offset:16384
  v_lshlrev_b32 v252, 5, v252
  v_mfma_f32_16x16x32_bf16 v[52:55], a[152:155], v[168:171], v[52:55]
  v_exp_f32 v21, v21
  v_mfma_f32_16x16x32_bf16 v[52:55], a[156:159], v[172:175], v[52:55]
  ds_read_b64_tr_b16 a[170:171], v217 offset:20480
  v_cvt_pk_bf16_f32 v18, v20, v21
  v_mfma_f32_16x16x32_bf16 v[60:63], a[156:159], v[188:191], v[204:207]
  v_exp_f32 v22, v22
  v_mfma_f32_16x16x32_bf16 v[60:63], a[152:155], v[184:187], v[60:63]
  ds_read_b64_tr_b16 a[172:173], v217 offset:24576
  v_add_u32 v252, s39, v252
  v_mfma_f32_16x16x32_bf16 v[60:63], a[148:151], v[180:183], v[60:63]
  v_exp_f32 v23, v23
  v_mfma_f32_16x16x32_bf16 v[60:63], a[144:147], v[176:179], v[60:63]
  ds_read_b64_tr_b16 a[174:175], v217 offset:28672
  v_cvt_pk_bf16_f32 v19, v22, v23
  v_mfma_f32_16x16x32_bf16 a[192:195], a[208:211], v[64:67], a[192:195]
  v_exp_f32 v28, v28
  v_mfma_f32_16x16x32_bf16 a[192:195], a[208:211], v[96:99], a[192:195]
  ds_read_b64_tr_b16 a[176:177], v218 offset:16384
  v_lshlrev_b32 v252, 7, v252
  v_mfma_f32_16x16x32_bf16 a[196:199], a[208:211], v[72:75], a[196:199]
  v_exp_f32 v29, v29
  v_mfma_f32_16x16x32_bf16 a[196:199], a[208:211], v[104:107], a[196:199]
  ds_read_b64_tr_b16 a[178:179], v218 offset:20480
  v_cvt_pk_bf16_f32 v26, v28, v29
  v_mfma_f32_16x16x32_bf16 a[200:203], a[208:211], v[80:83], a[200:203]
  v_exp_f32 v30, v30
  v_mfma_f32_16x16x32_bf16 a[200:203], a[208:211], v[112:115], a[200:203]
  ds_read_b64_tr_b16 a[180:181], v218 offset:24576
  v_min_u32 v252, attn_end-attn_h_ready-4, v252
  v_mfma_f32_16x16x32_bf16 a[204:207], a[208:211], v[88:91], a[204:207]
  s_waitcnt lgkmcnt(7)
  v_exp_f32 v31, v31
  v_mfma_f32_16x16x32_bf16 a[204:207], a[208:211], v[120:123], a[204:207]
  ds_read_b64_tr_b16 a[182:183], v218 offset:28672
  v_cvt_pk_bf16_f32 v27, v30, v31
  v_mfma_f32_16x16x32_bf16 a[0:3], a[160:163], v[64:67], a[0:3]
  v_exp_f32 v32, v32
  v_mfma_f32_16x16x32_bf16 a[0:3], a[164:167], v[96:99], a[0:3]
  ds_read_b64_tr_b16 a[184:185], v219 offset:16384
  v_mfma_f32_16x16x32_bf16 a[4:7], a[164:167], v[104:107], a[4:7]
  v_exp_f32 v33, v33
  v_mfma_f32_16x16x32_bf16 a[4:7], a[160:163], v[72:75], a[4:7]
  ds_read_b64_tr_b16 a[186:187], v219 offset:20480
  v_cvt_pk_bf16_f32 v32, v32, v33
  v_mfma_f32_16x16x32_bf16 a[8:11], a[160:163], v[80:83], a[8:11]
  v_exp_f32 v34, v34
  v_mfma_f32_16x16x32_bf16 a[8:11], a[164:167], v[112:115], a[8:11]
  ds_read_b64_tr_b16 a[188:189], v219 offset:24576
  v_mfma_f32_16x16x32_bf16 a[12:15], a[164:167], v[120:123], a[12:15]
  s_waitcnt lgkmcnt(7)
  v_exp_f32 v35, v35
  v_mfma_f32_16x16x32_bf16 a[12:15], a[160:163], v[88:91], a[12:15]
  ds_read_b64_tr_b16 a[190:191], v219 offset:28672
  v_cvt_pk_bf16_f32 v33, v34, v35
  v_mfma_f32_16x16x32_bf16 a[16:19], a[168:171], v[64:67], a[16:19]
  v_exp_f32 v40, v40
  v_mfma_f32_16x16x32_bf16 a[16:19], a[172:175], v[96:99], a[16:19]
  ds_read_b64_tr_b16 a[160:161], v220 offset:16384
  v_mfma_f32_16x16x32_bf16 a[20:23], a[172:175], v[104:107], a[20:23]
  v_exp_f32 v41, v41
  v_mfma_f32_16x16x32_bf16 a[20:23], a[168:171], v[72:75], a[20:23]
  ds_read_b64_tr_b16 a[162:163], v220 offset:20480
  v_cvt_pk_bf16_f32 v40, v40, v41
  v_mfma_f32_16x16x32_bf16 a[24:27], a[168:171], v[80:83], a[24:27]
  v_exp_f32 v42, v42
  v_mfma_f32_16x16x32_bf16 a[24:27], a[172:175], v[112:115], a[24:27]
  ds_read_b64_tr_b16 a[164:165], v220 offset:24576
  v_mfma_f32_16x16x32_bf16 a[28:31], a[172:175], v[120:123], a[28:31]
  s_waitcnt lgkmcnt(7)
  v_exp_f32 v43, v43
  v_mfma_f32_16x16x32_bf16 a[28:31], a[168:171], v[88:91], a[28:31]
  ds_read_b64_tr_b16 a[166:167], v220 offset:28672
  v_cvt_pk_bf16_f32 v41, v42, v43
  v_mfma_f32_16x16x32_bf16 a[32:35], a[176:179], v[64:67], a[32:35]
  v_exp_f32 v48, v48
  v_mfma_f32_16x16x32_bf16 a[32:35], a[180:183], v[96:99], a[32:35]
  ds_read_b64_tr_b16 a[168:169], v221 offset:16384
  v_mfma_f32_16x16x32_bf16 a[36:39], a[180:183], v[104:107], a[36:39]
  v_exp_f32 v49, v49
  v_mfma_f32_16x16x32_bf16 a[36:39], a[176:179], v[72:75], a[36:39]
  ds_read_b64_tr_b16 a[170:171], v221 offset:20480
  v_cvt_pk_bf16_f32 v48, v48, v49
  v_mfma_f32_16x16x32_bf16 a[40:43], a[176:179], v[80:83], a[40:43]
  v_exp_f32 v50, v50
  v_mfma_f32_16x16x32_bf16 a[40:43], a[180:183], v[112:115], a[40:43]
  ds_read_b64_tr_b16 a[172:173], v221 offset:24576
  v_mfma_f32_16x16x32_bf16 a[44:47], a[180:183], v[120:123], a[44:47]
  s_waitcnt lgkmcnt(7)
  v_exp_f32 v51, v51
  v_mfma_f32_16x16x32_bf16 a[44:47], a[176:179], v[88:91], a[44:47]
  ds_read_b64_tr_b16 a[174:175], v221 offset:28672
  v_cvt_pk_bf16_f32 v49, v50, v51
  v_mfma_f32_16x16x32_bf16 a[48:51], a[184:187], v[64:67], a[48:51]
  v_exp_f32 v56, v56
  v_mfma_f32_16x16x32_bf16 a[48:51], a[188:191], v[96:99], a[48:51]
  ds_read_b64_tr_b16 a[176:177], v222 offset:16384
  v_mfma_f32_16x16x32_bf16 a[52:55], a[188:191], v[104:107], a[52:55]
  v_exp_f32 v57, v57
  v_mfma_f32_16x16x32_bf16 a[52:55], a[184:187], v[72:75], a[52:55]
  ds_read_b64_tr_b16 a[178:179], v222 offset:20480
  v_cvt_pk_bf16_f32 v56, v56, v57
  v_mfma_f32_16x16x32_bf16 a[56:59], a[184:187], v[80:83], a[56:59]
  v_exp_f32 v58, v58
  v_mfma_f32_16x16x32_bf16 a[56:59], a[188:191], v[112:115], a[56:59]
  ds_read_b64_tr_b16 a[180:181], v222 offset:24576
  v_mfma_f32_16x16x32_bf16 a[60:63], a[188:191], v[120:123], a[60:63]
  s_waitcnt lgkmcnt(7)
  v_exp_f32 v59, v59
  v_mfma_f32_16x16x32_bf16 a[60:63], a[184:187], v[88:91], a[60:63]
  ds_read_b64_tr_b16 a[182:183], v222 offset:28672
  v_cvt_pk_bf16_f32 v57, v58, v59
  v_mfma_f32_16x16x32_bf16 a[64:67], a[160:163], v[64:67], a[64:67]
  v_exp_f32 v36, v36
  v_mfma_f32_16x16x32_bf16 a[64:67], a[164:167], v[96:99], a[64:67]
  ds_read_b64_tr_b16 a[184:185], v223 offset:16384
  v_mfma_f32_16x16x32_bf16 a[68:71], a[164:167], v[104:107], a[68:71]
  v_exp_f32 v37, v37
  v_mfma_f32_16x16x32_bf16 a[68:71], a[160:163], v[72:75], a[68:71]
  ds_read_b64_tr_b16 a[186:187], v223 offset:20480
  v_cvt_pk_bf16_f32 v34, v36, v37
  v_mfma_f32_16x16x32_bf16 a[72:75], a[160:163], v[80:83], a[72:75]
  v_exp_f32 v38, v38
  v_mfma_f32_16x16x32_bf16 a[72:75], a[164:167], v[112:115], a[72:75]
  ds_read_b64_tr_b16 a[188:189], v223 offset:24576
  v_mfma_f32_16x16x32_bf16 a[76:79], a[164:167], v[120:123], a[76:79]
  s_waitcnt lgkmcnt(7)
  v_exp_f32 v39, v39
  v_mfma_f32_16x16x32_bf16 a[76:79], a[160:163], v[88:91], a[76:79]
  ds_read_b64_tr_b16 a[190:191], v223 offset:28672
  v_cvt_pk_bf16_f32 v35, v38, v39
  v_mfma_f32_16x16x32_bf16 a[80:83], a[168:171], v[64:67], a[80:83]
  s_waitcnt vmcnt(10)
  v_exp_f32 v44, v44
  v_mfma_f32_16x16x32_bf16 a[80:83], a[172:175], v[96:99], a[80:83]
  v_mfma_f32_16x16x32_bf16 a[84:87], a[172:175], v[104:107], a[84:87]
  s_barrier
  v_exp_f32 v45, v45
  v_mfma_f32_16x16x32_bf16 a[84:87], a[168:171], v[72:75], a[84:87]
  ds_read_b128 a[128:131], v212 offset:49152
  v_cvt_pk_bf16_f32 v42, v44, v45
  v_mfma_f32_16x16x32_bf16 a[88:91], a[168:171], v[80:83], a[88:91]
  v_exp_f32 v46, v46
  v_mfma_f32_16x16x32_bf16 a[88:91], a[172:175], v[112:115], a[88:91]
  ds_read_b128 a[132:135], v213 offset:49152
  v_mfma_f32_16x16x32_bf16 a[92:95], a[172:175], v[120:123], a[92:95]
  s_waitcnt lgkmcnt(6)
  v_exp_f32 v47, v47
  v_mfma_f32_16x16x32_bf16 a[92:95], a[168:171], v[88:91], a[92:95]
  ds_read_b128 a[136:139], v214 offset:49152
  v_cvt_pk_bf16_f32 v43, v46, v47
  v_mfma_f32_16x16x32_bf16 a[96:99], a[176:179], v[64:67], a[96:99]
  v_exp_f32 v52, v52
  v_mfma_f32_16x16x32_bf16 a[96:99], a[180:183], v[96:99], a[96:99]
  ds_read_b128 a[140:143], v215 offset:49152
  v_mfma_f32_16x16x32_bf16 a[100:103], a[180:183], v[104:107], a[100:103]
  v_exp_f32 v53, v53
  v_mfma_f32_16x16x32_bf16 a[100:103], a[176:179], v[72:75], a[100:103]
  v_cvt_pk_bf16_f32 v50, v52, v53
  v_mfma_f32_16x16x32_bf16 a[104:107], a[176:179], v[80:83], a[104:107]
  v_exp_f32 v54, v54
  v_mfma_f32_16x16x32_bf16 a[104:107], a[180:183], v[112:115], a[104:107]
  v_mfma_f32_16x16x32_bf16 a[108:111], a[180:183], v[120:123], a[108:111]
  s_waitcnt lgkmcnt(4)
  v_exp_f32 v55, v55
  v_mfma_f32_16x16x32_bf16 a[108:111], a[176:179], v[88:91], a[108:111]
  v_cvt_pk_bf16_f32 v51, v54, v55
  v_mfma_f32_16x16x32_bf16 a[112:115], a[184:187], v[64:67], a[112:115]
  v_exp_f32 v60, v60
  v_mfma_f32_16x16x32_bf16 a[112:115], a[188:191], v[96:99], a[112:115]
  v_mfma_f32_16x16x32_bf16 a[116:119], a[188:191], v[104:107], a[116:119]
  v_exp_f32 v61, v61
  v_mfma_f32_16x16x32_bf16 a[116:119], a[184:187], v[72:75], a[116:119]
  v_cvt_pk_bf16_f32 v58, v60, v61
  v_mfma_f32_16x16x32_bf16 a[120:123], a[184:187], v[80:83], a[120:123]
  v_exp_f32 v62, v62
  v_mfma_f32_16x16x32_bf16 a[120:123], a[188:191], v[112:115], a[120:123]
  v_mfma_f32_16x16x32_bf16 a[124:127], a[188:191], v[120:123], a[124:127]
  s_waitcnt lgkmcnt(0)
  v_exp_f32 v63, v63
  v_mfma_f32_16x16x32_bf16 a[124:127], a[184:187], v[88:91], a[124:127]
  v_cvt_pk_bf16_f32 v59, v62, v63
  v_mfma_f32_16x16x32_bf16 v[64:67], a[128:131], v[128:131], v[192:195]
  s_add_u32 m0, s28, 65536
  v_lshrrev_b32 v224, 4, v242
  v_lshrrev_b32 v225, 4, v224
  v_mfma_f32_16x16x32_bf16 v[64:67], a[132:135], v[132:135], v[64:67]
  ds_read_b128 a[144:147], v212 offset:53248
  v_bfe_u32 v226, v224, 2, 2
  v_mfma_f32_16x16x32_bf16 v[64:67], a[136:139], v[136:139], v[64:67]
  buffer_load_dwordx4 v236, s[16:19], s29 offen offset:0 lds
  v_mfma_f32_16x16x32_bf16 v[64:67], a[140:143], v[140:143], v[64:67]
  ds_read_b128 a[148:151], v213 offset:53248
  v_lshl_add_u32 v225, v225, 3, v226
  v_mfma_f32_16x16x32_bf16 v[72:75], a[140:143], v[156:159], v[196:199]
  v_lshlrev_b32 v225, 4, v225
  v_bfe_u32 v226, v224, 1, 1
  v_mfma_f32_16x16x32_bf16 v[72:75], a[136:139], v[152:155], v[72:75]
  ds_read_b128 a[152:155], v214 offset:53248
  v_mul_u32_u24 v226, 0xc00, v226
  v_mfma_f32_16x16x32_bf16 v[72:75], a[132:135], v[148:151], v[72:75]
  buffer_load_dwordx4 v237, s[16:19], s29 offen offset:1024 lds
  v_mfma_f32_16x16x32_bf16 v[72:75], a[128:131], v[144:147], v[72:75]
  ds_read_b128 a[156:159], v215 offset:53248
  v_add3_u32 v225, v225, v226, s50
  v_mfma_f32_16x16x32_bf16 v[80:83], a[128:131], v[160:163], v[200:203]
  v_exp_f32 v64, v64
  v_mfma_f32_16x16x32_bf16 v[80:83], a[132:135], v[164:167], v[80:83]
  v_and_b32 v226, 1, v224
  v_lshl_add_u32 v225, v226, 3, v225
  v_mfma_f32_16x16x32_bf16 v[80:83], a[136:139], v[168:171], v[80:83]
  s_waitcnt vmcnt(10)
  v_exp_f32 v65, v65
  v_mfma_f32_16x16x32_bf16 v[80:83], a[140:143], v[172:175], v[80:83]
  ds_read_b64_tr_b16 a[232:233], v225 offset:0
  v_cvt_pk_bf16_f32 v64, v64, v65
  v_mfma_f32_16x16x32_bf16 v[88:91], a[140:143], v[188:191], v[204:207]
  v_exp_f32 v66, v66
  v_mfma_f32_16x16x32_bf16 v[88:91], a[136:139], v[184:187], v[88:91]
  buffer_load_dwordx4 v236, s[16:19], s29 offen offset:2048 lds
  v_mfma_f32_16x16x32_bf16 v[88:91], a[132:135], v[180:183], v[88:91]
  s_waitcnt lgkmcnt(1)
  v_exp_f32 v67, v67
  v_mfma_f32_16x16x32_bf16 v[88:91], a[128:131], v[176:179], v[88:91]
  ds_read_b64_tr_b16 a[234:235], v225 offset:64
  v_cvt_pk_bf16_f32 v65, v66, v67
  v_mfma_f32_16x16x32_bf16 v[68:71], a[144:147], v[128:131], v[192:195]
  v_exp_f32 v72, v72
  v_mfma_f32_16x16x32_bf16 v[68:71], a[148:151], v[132:135], v[68:71]
  ds_read_b128 a[128:131], v212 offset:57344
  ds_read_b64_tr_b16 a[236:237], v225 offset:512
  v_mfma_f32_16x16x32_bf16 v[68:71], a[152:155], v[136:139], v[68:71]
  v_exp_f32 v73, v73
  v_mfma_f32_16x16x32_bf16 v[68:71], a[156:159], v[140:143], v[68:71]
  ds_read_b128 a[132:135], v213 offset:57344
  v_cvt_pk_bf16_f32 v72, v72, v73
  v_mfma_f32_16x16x32_bf16 v[76:79], a[156:159], v[156:159], v[196:199]
  v_exp_f32 v74, v74
  v_mfma_f32_16x16x32_bf16 v[76:79], a[152:155], v[152:155], v[76:79]
  ds_read_b128 a[136:139], v214 offset:57344
  ds_read_b64_tr_b16 a[238:239], v225 offset:576
  v_mfma_f32_16x16x32_bf16 v[76:79], a[148:151], v[148:151], v[76:79]
  v_exp_f32 v75, v75
  v_mfma_f32_16x16x32_bf16 v[76:79], a[144:147], v[144:147], v[76:79]
  ds_read_b128 a[140:143], v215 offset:57344
  v_cvt_pk_bf16_f32 v73, v74, v75
  v_mfma_f32_16x16x32_bf16 v[84:87], a[144:147], v[160:163], v[200:203]
  v_exp_f32 v80, v80
  v_mfma_f32_16x16x32_bf16 v[84:87], a[148:151], v[164:167], v[84:87]
  buffer_load_dwordx4 v237, s[16:19], s29 offen offset:3072 lds
  v_mfma_f32_16x16x32_bf16 v[84:87], a[152:155], v[168:171], v[84:87]
  s_add_u32 s29, s29, 16384
  v_exp_f32 v81, v81
  v_mfma_f32_16x16x32_bf16 v[84:87], a[156:159], v[172:175], v[84:87]
  ds_read_b64_tr_b16 a[240:241], v225 offset:1024
  v_cvt_pk_bf16_f32 v80, v80, v81
  v_mfma_f32_16x16x32_bf16 v[92:95], a[156:159], v[188:191], v[204:207]
  s_add_u32 m0, s28, 16384
  v_exp_f32 v82, v82
  v_mfma_f32_16x16x32_bf16 v[92:95], a[152:155], v[184:187], v[92:95]
  buffer_load_dwordx4 v232, s[12:15], s29 offen offset:0 lds
  v_mfma_f32_16x16x32_bf16 v[92:95], a[148:151], v[180:183], v[92:95]
  s_waitcnt lgkmcnt(1)
  v_exp_f32 v83, v83
  v_mfma_f32_16x16x32_bf16 v[92:95], a[144:147], v[176:179], v[92:95]
  ds_read_b64_tr_b16 a[242:243], v225 offset:1088
  v_cvt_pk_bf16_f32 v81, v82, v83
  v_mfma_f32_16x16x32_bf16 v[96:99], a[128:131], v[128:131], v[192:195]
  v_exp_f32 v88, v88
  v_mfma_f32_16x16x32_bf16 v[96:99], a[132:135], v[132:135], v[96:99]
  ds_read_b128 a[144:147], v212 offset:61440
  ds_read_b64_tr_b16 a[244:245], v225 offset:1536
  v_mfma_f32_16x16x32_bf16 v[96:99], a[136:139], v[136:139], v[96:99]
  v_exp_f32 v89, v89
  v_mfma_f32_16x16x32_bf16 v[96:99], a[140:143], v[140:143], v[96:99]
  ds_read_b128 a[148:151], v213 offset:61440
  v_cvt_pk_bf16_f32 v88, v88, v89
  v_mfma_f32_16x16x32_bf16 v[104:107], a[140:143], v[156:159], v[196:199]
  v_exp_f32 v90, v90
  v_mfma_f32_16x16x32_bf16 v[104:107], a[136:139], v[152:155], v[104:107]
  ds_read_b128 a[152:155], v214 offset:61440
  ds_read_b64_tr_b16 a[246:247], v225 offset:1600
  v_mfma_f32_16x16x32_bf16 v[104:107], a[132:135], v[148:151], v[104:107]
  v_exp_f32 v91, v91
  v_mfma_f32_16x16x32_bf16 v[104:107], a[128:131], v[144:147], v[104:107]
  ds_read_b128 a[156:159], v215 offset:61440
  v_cvt_pk_bf16_f32 v89, v90, v91
  v_mfma_f32_16x16x32_bf16 v[112:115], a[128:131], v[160:163], v[200:203]
  v_exp_f32 v68, v68
  v_mfma_f32_16x16x32_bf16 v[112:115], a[132:135], v[164:167], v[112:115]
  buffer_load_dwordx4 v233, s[12:15], s29 offen offset:1024 lds
  v_mfma_f32_16x16x32_bf16 v[112:115], a[136:139], v[168:171], v[112:115]
  v_exp_f32 v69, v69
  v_mfma_f32_16x16x32_bf16 v[112:115], a[140:143], v[172:175], v[112:115]
  ds_read_b64_tr_b16 a[248:249], v225 offset:2048
  v_cvt_pk_bf16_f32 v66, v68, v69
  v_mfma_f32_16x16x32_bf16 v[120:123], a[140:143], v[188:191], v[204:207]
  v_exp_f32 v70, v70
  v_mfma_f32_16x16x32_bf16 v[120:123], a[136:139], v[184:187], v[120:123]
  buffer_load_dwordx4 v234, s[12:15], s29 offen offset:2048 lds
  v_mfma_f32_16x16x32_bf16 v[120:123], a[132:135], v[180:183], v[120:123]
  s_waitcnt lgkmcnt(1)
  v_exp_f32 v71, v71
  v_mfma_f32_16x16x32_bf16 v[120:123], a[128:131], v[176:179], v[120:123]
  ds_read_b64_tr_b16 a[250:251], v225 offset:2112
  v_cvt_pk_bf16_f32 v67, v70, v71
  v_mfma_f32_16x16x32_bf16 v[100:103], a[144:147], v[128:131], v[192:195]
  v_exp_f32 v76, v76
  v_mfma_f32_16x16x32_bf16 v[100:103], a[148:151], v[132:135], v[100:103]
  ds_read_b64_tr_b16 a[160:161], v216 offset:32768
  v_mfma_f32_16x16x32_bf16 v[100:103], a[152:155], v[136:139], v[100:103]
  v_exp_f32 v77, v77
  v_mfma_f32_16x16x32_bf16 v[100:103], a[156:159], v[140:143], v[100:103]
  ds_read_b64_tr_b16 a[162:163], v216 offset:36864
  v_cvt_pk_bf16_f32 v74, v76, v77
  v_mfma_f32_16x16x32_bf16 v[108:111], a[156:159], v[156:159], v[196:199]
  v_exp_f32 v78, v78
  v_mfma_f32_16x16x32_bf16 v[108:111], a[152:155], v[152:155], v[108:111]
  ds_read_b64_tr_b16 a[164:165], v216 offset:40960
  buffer_load_dwordx4 v235, s[12:15], s29 offen offset:3072 lds
  v_mfma_f32_16x16x32_bf16 v[108:111], a[148:151], v[148:151], v[108:111]
  v_exp_f32 v79, v79
  v_mfma_f32_16x16x32_bf16 v[108:111], a[144:147], v[144:147], v[108:111]
  ds_read_b64_tr_b16 a[166:167], v216 offset:45056
  s_waitcnt lgkmcnt(4)
  v_cvt_pk_bf16_f32 v75, v78, v79
  v_mfma_f32_16x16x32_bf16 v[116:119], a[144:147], v[160:163], v[200:203]
  v_exp_f32 v84, v84
  v_mfma_f32_16x16x32_bf16 v[116:119], a[148:151], v[164:167], v[116:119]
  ds_read_b64_tr_b16 a[168:169], v217 offset:32768
  v_mfma_f32_16x16x32_bf16 v[228:231], a[232:235], a[212:215], 0
  v_mfma_f32_16x16x32_bf16 v[228:231], a[236:239], a[216:219], v[228:231]
  v_mfma_f32_16x16x32_bf16 v[228:231], a[240:243], a[220:223], v[228:231]
  v_mfma_f32_16x16x32_bf16 v[228:231], a[244:247], a[224:227], v[228:231]
  v_mfma_f32_16x16x32_bf16 v[228:231], a[248:251], a[228:231], v[228:231]
  v_mfma_f32_16x16x32_bf16 v[116:119], a[152:155], v[168:171], v[116:119]
  s_lshl_b32 s35, s3, 10
  s_add_u32 s35, s35, 159744
  v_exp_f32 v85, v85
  v_mfma_f32_16x16x32_bf16 v[116:119], a[156:159], v[172:175], v[116:119]
  ds_read_b64_tr_b16 a[170:171], v217 offset:36864
  v_cvt_pk_bf16_f32 v82, v84, v85
  v_mfma_f32_16x16x32_bf16 v[124:127], a[156:159], v[188:191], v[204:207]
  v_exp_f32 v86, v86
  v_mfma_f32_16x16x32_bf16 v[124:127], a[152:155], v[184:187], v[124:127]
  ds_read_b64_tr_b16 a[172:173], v217 offset:40960
  v_add_u32 v224, s35, v242
  v_mfma_f32_16x16x32_bf16 v[124:127], a[148:151], v[180:183], v[124:127]
  v_exp_f32 v87, v87
  v_mfma_f32_16x16x32_bf16 v[124:127], a[144:147], v[176:179], v[124:127]
  ds_read_b64_tr_b16 a[174:175], v217 offset:45056
  v_cvt_pk_bf16_f32 v83, v86, v87
  v_mfma_f32_16x16x32_bf16 a[192:195], a[208:211], v[0:3], a[192:195]
  v_exp_f32 v92, v92
  v_mfma_f32_16x16x32_bf16 a[192:195], a[208:211], v[32:35], a[192:195]
  ds_read_b64_tr_b16 a[176:177], v218 offset:32768
  ds_write_b128 v224, v[228:231]
  v_mfma_f32_16x16x32_bf16 a[196:199], a[208:211], v[8:11], a[196:199]
  v_exp_f32 v93, v93
  v_mfma_f32_16x16x32_bf16 a[196:199], a[208:211], v[40:43], a[196:199]
  ds_read_b64_tr_b16 a[178:179], v218 offset:36864
  v_cvt_pk_bf16_f32 v90, v92, v93
  v_mfma_f32_16x16x32_bf16 a[200:203], a[208:211], v[16:19], a[200:203]
  v_exp_f32 v94, v94
  v_mfma_f32_16x16x32_bf16 a[200:203], a[208:211], v[48:51], a[200:203]
  ds_read_b64_tr_b16 a[180:181], v218 offset:40960
  v_mfma_f32_16x16x32_bf16 a[204:207], a[208:211], v[24:27], a[204:207]
  s_waitcnt lgkmcnt(8)
  v_exp_f32 v95, v95
  v_mfma_f32_16x16x32_bf16 a[204:207], a[208:211], v[56:59], a[204:207]
  ds_read_b64_tr_b16 a[182:183], v218 offset:45056
  v_cvt_pk_bf16_f32 v91, v94, v95
  v_mfma_f32_16x16x32_bf16 a[0:3], a[160:163], v[0:3], a[0:3]
  v_exp_f32 v96, v96
  v_mfma_f32_16x16x32_bf16 a[0:3], a[164:167], v[32:35], a[0:3]
  ds_read_b64_tr_b16 a[184:185], v219 offset:32768
  s_waitcnt lgkmcnt(4)
  s_mov_b32 m0, s51
  v_mfma_f32_16x16x32_bf16 a[4:7], a[164:167], v[40:43], a[4:7]
  v_exp_f32 v97, v97
  v_mfma_f32_16x16x32_bf16 a[4:7], a[160:163], v[8:11], a[4:7]
  ds_read_b64_tr_b16 a[186:187], v219 offset:36864
  v_cvt_pk_bf16_f32 v96, v96, v97
  v_mfma_f32_16x16x32_bf16 a[8:11], a[160:163], v[16:19], a[8:11]
  v_exp_f32 v98, v98
  v_mfma_f32_16x16x32_bf16 a[8:11], a[164:167], v[48:51], a[8:11]
  ds_read_b64_tr_b16 a[188:189], v219 offset:40960
  buffer_load_dwordx4 v210, s[4:7], s100 offen lds
  s_add_u32 s100, s100, 20480
  s_add_u32 s51, s51, 512
  v_mfma_f32_16x16x32_bf16 a[12:15], a[164:167], v[56:59], a[12:15]
  v_exp_f32 v99, v99
  v_mfma_f32_16x16x32_bf16 a[12:15], a[160:163], v[24:27], a[12:15]
  ds_read_b64_tr_b16 a[190:191], v219 offset:45056
  v_cvt_pk_bf16_f32 v97, v98, v99
  v_mfma_f32_16x16x32_bf16 a[16:19], a[168:171], v[0:3], a[16:19]
  v_exp_f32 v104, v104
  v_mfma_f32_16x16x32_bf16 a[16:19], a[172:175], v[32:35], a[16:19]
  ds_read_b64_tr_b16 a[160:161], v220 offset:32768
  v_lshrrev_b32 v224, 4, v242
  v_mfma_f32_16x16x32_bf16 a[20:23], a[172:175], v[40:43], a[20:23]
  v_exp_f32 v105, v105
  v_mfma_f32_16x16x32_bf16 a[20:23], a[168:171], v[8:11], a[20:23]
  ds_read_b64_tr_b16 a[162:163], v220 offset:36864
  v_cvt_pk_bf16_f32 v104, v104, v105
  v_mfma_f32_16x16x32_bf16 a[24:27], a[168:171], v[16:19], a[24:27]
  v_exp_f32 v106, v106
  v_mfma_f32_16x16x32_bf16 a[24:27], a[172:175], v[48:51], a[24:27]
  ds_read_b64_tr_b16 a[164:165], v220 offset:40960
  v_bfe_u32 v225, v224, 2, 1
  v_mfma_f32_16x16x32_bf16 a[28:31], a[172:175], v[56:59], a[28:31]
  s_waitcnt lgkmcnt(7)
  v_exp_f32 v107, v107
  v_mfma_f32_16x16x32_bf16 a[28:31], a[168:171], v[24:27], a[28:31]
  ds_read_b64_tr_b16 a[166:167], v220 offset:45056
  v_cvt_pk_bf16_f32 v105, v106, v107
  v_mfma_f32_16x16x32_bf16 a[32:35], a[176:179], v[0:3], a[32:35]
  v_exp_f32 v112, v112
  v_mfma_f32_16x16x32_bf16 a[32:35], a[180:183], v[32:35], a[32:35]
  ds_read_b64_tr_b16 a[168:169], v221 offset:32768
  v_lshlrev_b32 v225, 8, v225
  v_mfma_f32_16x16x32_bf16 a[36:39], a[180:183], v[40:43], a[36:39]
  v_exp_f32 v113, v113
  v_mfma_f32_16x16x32_bf16 a[36:39], a[176:179], v[8:11], a[36:39]
  ds_read_b64_tr_b16 a[170:171], v221 offset:36864
  v_cvt_pk_bf16_f32 v112, v112, v113
  v_mfma_f32_16x16x32_bf16 a[40:43], a[176:179], v[16:19], a[40:43]
  v_exp_f32 v114, v114
  v_mfma_f32_16x16x32_bf16 a[40:43], a[180:183], v[48:51], a[40:43]
  ds_read_b64_tr_b16 a[172:173], v221 offset:40960
  v_lshrrev_b32 v226, 3, v224
  v_mfma_f32_16x16x32_bf16 a[44:47], a[180:183], v[56:59], a[44:47]
  s_waitcnt lgkmcnt(7)
  v_exp_f32 v115, v115
  v_mfma_f32_16x16x32_bf16 a[44:47], a[176:179], v[24:27], a[44:47]
  ds_read_b64_tr_b16 a[174:175], v221 offset:45056
  v_cvt_pk_bf16_f32 v113, v114, v115
  v_mfma_f32_16x16x32_bf16 a[48:51], a[184:187], v[0:3], a[48:51]
  v_exp_f32 v120, v120
  v_mfma_f32_16x16x32_bf16 a[48:51], a[188:191], v[32:35], a[48:51]
  ds_read_b64_tr_b16 a[176:177], v222 offset:32768
  v_lshl_add_u32 v225, v226, 4, v225
  v_mfma_f32_16x16x32_bf16 a[52:55], a[188:191], v[40:43], a[52:55]
  v_exp_f32 v121, v121
  v_mfma_f32_16x16x32_bf16 a[52:55], a[184:187], v[8:11], a[52:55]
  ds_read_b64_tr_b16 a[178:179], v222 offset:36864
  v_cvt_pk_bf16_f32 v120, v120, v121
  v_mfma_f32_16x16x32_bf16 a[56:59], a[184:187], v[16:19], a[56:59]
  v_exp_f32 v122, v122
  v_mfma_f32_16x16x32_bf16 a[56:59], a[188:191], v[48:51], a[56:59]
  ds_read_b64_tr_b16 a[180:181], v222 offset:40960
  v_and_b32 v227, 3, v224
  v_mfma_f32_16x16x32_bf16 a[60:63], a[188:191], v[56:59], a[60:63]
  s_waitcnt lgkmcnt(7)
  v_exp_f32 v123, v123
  v_mfma_f32_16x16x32_bf16 a[60:63], a[184:187], v[24:27], a[60:63]
  ds_read_b64_tr_b16 a[182:183], v222 offset:45056
  v_cvt_pk_bf16_f32 v121, v122, v123
  v_mfma_f32_16x16x32_bf16 a[64:67], a[160:163], v[0:3], a[64:67]
  v_exp_f32 v100, v100
  v_mfma_f32_16x16x32_bf16 a[64:67], a[164:167], v[32:35], a[64:67]
  ds_read_b64_tr_b16 a[184:185], v223 offset:32768
  v_lshl_add_u32 v225, v227, 2, v225
  v_mfma_f32_16x16x32_bf16 a[68:71], a[164:167], v[40:43], a[68:71]
  v_exp_f32 v101, v101
  v_mfma_f32_16x16x32_bf16 a[68:71], a[160:163], v[8:11], a[68:71]
  ds_read_b64_tr_b16 a[186:187], v223 offset:36864
  v_cvt_pk_bf16_f32 v98, v100, v101
  v_mfma_f32_16x16x32_bf16 a[72:75], a[160:163], v[16:19], a[72:75]
  v_exp_f32 v102, v102
  v_mfma_f32_16x16x32_bf16 a[72:75], a[164:167], v[48:51], a[72:75]
  ds_read_b64_tr_b16 a[188:189], v223 offset:40960
  v_add_u32 v225, 159744, v225
  v_mfma_f32_16x16x32_bf16 a[76:79], a[164:167], v[56:59], a[76:79]
  s_waitcnt lgkmcnt(7)
  v_exp_f32 v103, v103
  v_mfma_f32_16x16x32_bf16 a[76:79], a[160:163], v[24:27], a[76:79]
  ds_read_b64_tr_b16 a[190:191], v223 offset:45056
  v_cvt_pk_bf16_f32 v99, v102, v103
  v_mfma_f32_16x16x32_bf16 a[80:83], a[168:171], v[0:3], a[80:83]
  s_waitcnt vmcnt(9)
  v_exp_f32 v108, v108
  v_mfma_f32_16x16x32_bf16 a[80:83], a[172:175], v[32:35], a[80:83]
  v_mfma_f32_16x16x32_bf16 a[84:87], a[172:175], v[40:43], a[84:87]
  s_barrier
  v_exp_f32 v109, v109
  v_mfma_f32_16x16x32_bf16 a[84:87], a[168:171], v[8:11], a[84:87]
  ds_read_b128 a[128:131], v212 offset:0
  v_cvt_pk_bf16_f32 v106, v108, v109
  v_mfma_f32_16x16x32_bf16 a[88:91], a[168:171], v[16:19], a[88:91]
  v_exp_f32 v110, v110
  v_mfma_f32_16x16x32_bf16 a[88:91], a[172:175], v[48:51], a[88:91]
  ds_read_b128 a[132:135], v213 offset:0
  ds_read_b32 v228, v225 offset:0
  v_mfma_f32_16x16x32_bf16 a[92:95], a[172:175], v[56:59], a[92:95]
  s_waitcnt lgkmcnt(7)
  v_exp_f32 v111, v111
  v_mfma_f32_16x16x32_bf16 a[92:95], a[168:171], v[24:27], a[92:95]
  ds_read_b128 a[136:139], v214 offset:0
  v_cvt_pk_bf16_f32 v107, v110, v111
  v_mfma_f32_16x16x32_bf16 a[96:99], a[176:179], v[0:3], a[96:99]
  v_exp_f32 v116, v116
  v_mfma_f32_16x16x32_bf16 a[96:99], a[180:183], v[32:35], a[96:99]
  ds_read_b128 a[140:143], v215 offset:0
  ds_read_b32 v229, v225 offset:1024
  v_mfma_f32_16x16x32_bf16 a[100:103], a[180:183], v[40:43], a[100:103]
  v_exp_f32 v117, v117
  v_mfma_f32_16x16x32_bf16 a[100:103], a[176:179], v[8:11], a[100:103]
  ds_read_b32 v230, v225 offset:2048
  v_cvt_pk_bf16_f32 v114, v116, v117
  v_mfma_f32_16x16x32_bf16 a[104:107], a[176:179], v[16:19], a[104:107]
  v_exp_f32 v118, v118
  v_mfma_f32_16x16x32_bf16 a[104:107], a[180:183], v[48:51], a[104:107]
  ds_read_b32 v231, v225 offset:3072
  ds_read_b32 v238, v225 offset:512
  v_mfma_f32_16x16x32_bf16 a[108:111], a[180:183], v[56:59], a[108:111]
  s_waitcnt lgkmcnt(9)
  v_exp_f32 v119, v119
  v_mfma_f32_16x16x32_bf16 a[108:111], a[176:179], v[24:27], a[108:111]
  ds_read_b32 v239, v225 offset:1536
  v_cvt_pk_bf16_f32 v115, v118, v119
  v_mfma_f32_16x16x32_bf16 a[112:115], a[184:187], v[0:3], a[112:115]
  v_exp_f32 v124, v124
  v_mfma_f32_16x16x32_bf16 a[112:115], a[188:191], v[32:35], a[112:115]
  ds_read_b32 v240, v225 offset:2560
  ds_read_b32 v241, v225 offset:3584
  s_cmp_eq_u32 s3, 0
  s_cselect_b32 s35, 0, 1073741824
  v_mfma_f32_16x16x32_bf16 a[116:119], a[188:191], v[40:43], a[116:119]
  v_exp_f32 v125, v125
  v_mfma_f32_16x16x32_bf16 a[116:119], a[184:187], v[8:11], a[116:119]
  v_cvt_pk_bf16_f32 v122, v124, v125
  v_mul_u32_u24 v226, 0xd80, v226
  v_mfma_f32_16x16x32_bf16 a[120:123], a[184:187], v[16:19], a[120:123]
  v_exp_f32 v126, v126
  v_mfma_f32_16x16x32_bf16 a[120:123], a[188:191], v[48:51], a[120:123]
  v_and_b32 v227, 7, v224
  v_lshl_add_u32 v226, v227, 1, v226
  v_mfma_f32_16x16x32_bf16 a[124:127], a[188:191], v[56:59], a[124:127]
  s_waitcnt lgkmcnt(7)
  v_exp_f32 v127, v127
  v_mfma_f32_16x16x32_bf16 a[124:127], a[184:187], v[24:27], a[124:127]
  v_cvt_pk_bf16_f32 v123, v126, v127
  v_and_b32 v227, 1, v224
  v_lshl_add_u32 v226, v227, 30, v226
  v_or_b32 v226, s35, v226
  v_min_u32 v249, 1, v224
  v_lshlrev_b32 v249, 30, v249
  v_or_b32 v249, s35, v249
  v_mov_b32 v251, v249
  v_mov_b32 v250, 1
  s_mov_b32 s47, 2818048
  s_lshl_b32 s35, s33, 4
  s_add_u32 s35, s35, 2633728
  s_waitcnt lgkmcnt(0)
  v_add_f32 v228, v228, v229
  v_add_f32 v238, v238, v239
  v_add_f32 v230, v230, v231
  v_add_f32 v240, v240, v241
  v_add_f32 v228, v228, v230
  v_add_f32 v238, v238, v240
  v_cvt_pk_bf16_f32 v228, v228, v228
  v_cvt_pk_bf16_f32 v238, v238, v238
  v_lshlrev_b32 v228, 16, v228
  v_lshlrev_b32 v238, 16, v238
  v_mul_f32 v229, 0xbfb8aa3b, v228
  v_exp_f32 v229, v229
  s_nop 0
  v_add_f32 v229, 1.0, v229
  v_rcp_f32 v229, v229
  s_nop 0
  v_mul_f32 v228, v228, v229
  v_cvt_pk_bf16_f32 v228, v228, v228
  v_lshlrev_b32 v228, 16, v228
  v_mul_f32 v228, v228, v238
  s_nop 1
  v_mov_b32_dpp v229, v228 quad_perm:[1,0,3,2] row_mask:0xf bank_mask:0xf
  v_cvt_pk_bf16_f32 v228, v228, v229
  buffer_store_dword v228, v226, s[24:27], s35 offen sc1
  s_mov_b32 s32, 5
attn_loop:
  v_mfma_f32_16x16x32_bf16 v[0:3], a[128:131], v[128:131], v[192:195]
  s_add_u32 m0, s28, 81920
  v_mfma_f32_16x16x32_bf16 v[0:3], a[132:135], v[132:135], v[0:3]
  ds_read_b128 a[144:147], v212 offset:4096
  v_mfma_f32_16x16x32_bf16 v[0:3], a[136:139], v[136:139], v[0:3]
  buffer_load_dwordx4 v236, s[16:19], s29 offen offset:0 lds
  v_mfma_f32_16x16x32_bf16 v[0:3], a[140:143], v[140:143], v[0:3]
  ds_read_b128 a[148:151], v213 offset:4096
  v_mfma_f32_16x16x32_bf16 v[8:11], a[140:143], v[156:159], v[196:199]
  v_mfma_f32_16x16x32_bf16 v[8:11], a[136:139], v[152:155], v[8:11]
  ds_read_b128 a[152:155], v214 offset:4096
  v_mfma_f32_16x16x32_bf16 v[8:11], a[132:135], v[148:151], v[8:11]
  buffer_load_dwordx4 v237, s[16:19], s29 offen offset:1024 lds
  v_mfma_f32_16x16x32_bf16 v[8:11], a[128:131], v[144:147], v[8:11]
  ds_read_b128 a[156:159], v215 offset:4096
  v_mfma_f32_16x16x32_bf16 v[16:19], a[128:131], v[160:163], v[200:203]
  v_exp_f32 v0, v0
  v_mfma_f32_16x16x32_bf16 v[16:19], a[132:135], v[164:167], v[16:19]
  v_mfma_f32_16x16x32_bf16 v[16:19], a[136:139], v[168:171], v[16:19]
  v_exp_f32 v1, v1
  v_mfma_f32_16x16x32_bf16 v[16:19], a[140:143], v[172:175], v[16:19]
  v_cvt_pk_bf16_f32 v0, v0, v1
  v_mfma_f32_16x16x32_bf16 v[24:27], a[140:143], v[188:191], v[204:207]
  v_exp_f32 v2, v2
  v_mfma_f32_16x16x32_bf16 v[24:27], a[136:139], v[184:187], v[24:27]
  buffer_load_dwordx4 v236, s[16:19], s29 offen offset:2048 lds
  v_mfma_f32_16x16x32_bf16 v[24:27], a[132:135], v[180:183], v[24:27]
  s_waitcnt lgkmcnt(0)
  v_exp_f32 v3, v3
  v_mfma_f32_16x16x32_bf16 v[24:27], a[128:131], v[176:179], v[24:27]
  v_cvt_pk_bf16_f32 v1, v2, v3
  v_mfma_f32_16x16x32_bf16 v[4:7], a[144:147], v[128:131], v[192:195]
  v_exp_f32 v8, v8
  v_mfma_f32_16x16x32_bf16 v[4:7], a[148:151], v[132:135], v[4:7]
  ds_read_b128 a[128:131], v212 offset:8192
  v_mfma_f32_16x16x32_bf16 v[4:7], a[152:155], v[136:139], v[4:7]
  v_exp_f32 v9, v9
  v_mfma_f32_16x16x32_bf16 v[4:7], a[156:159], v[140:143], v[4:7]
  ds_read_b128 a[132:135], v213 offset:8192
  v_cvt_pk_bf16_f32 v8, v8, v9
  v_mfma_f32_16x16x32_bf16 v[12:15], a[156:159], v[156:159], v[196:199]
  v_exp_f32 v10, v10
  v_mfma_f32_16x16x32_bf16 v[12:15], a[152:155], v[152:155], v[12:15]
  ds_read_b128 a[136:139], v214 offset:8192
  v_mfma_f32_16x16x32_bf16 v[12:15], a[148:151], v[148:151], v[12:15]
  v_exp_f32 v11, v11
  v_mfma_f32_16x16x32_bf16 v[12:15], a[144:147], v[144:147], v[12:15]
  ds_read_b128 a[140:143], v215 offset:8192
  v_cvt_pk_bf16_f32 v9, v10, v11
  v_mfma_f32_16x16x32_bf16 v[20:23], a[144:147], v[160:163], v[200:203]
  v_exp_f32 v16, v16
  v_mfma_f32_16x16x32_bf16 v[20:23], a[148:151], v[164:167], v[20:23]
  buffer_load_dwordx4 v237, s[16:19], s29 offen offset:3072 lds
  v_mfma_f32_16x16x32_bf16 v[20:23], a[152:155], v[168:171], v[20:23]
  s_add_u32 s29, s29, 16384
  v_exp_f32 v17, v17
  v_mfma_f32_16x16x32_bf16 v[20:23], a[156:159], v[172:175], v[20:23]
  v_cvt_pk_bf16_f32 v16, v16, v17
  v_mfma_f32_16x16x32_bf16 v[28:31], a[156:159], v[188:191], v[204:207]
  s_add_u32 m0, s28, 32768
  v_exp_f32 v18, v18
  v_mfma_f32_16x16x32_bf16 v[28:31], a[152:155], v[184:187], v[28:31]
  buffer_load_dwordx4 v232, s[12:15], s29 offen offset:0 lds
  v_mfma_f32_16x16x32_bf16 v[28:31], a[148:151], v[180:183], v[28:31]
  s_waitcnt lgkmcnt(0)
  v_exp_f32 v19, v19
  v_mfma_f32_16x16x32_bf16 v[28:31], a[144:147], v[176:179], v[28:31]
  v_cvt_pk_bf16_f32 v17, v18, v19
  v_mfma_f32_16x16x32_bf16 v[32:35], a[128:131], v[128:131], v[192:195]
  v_exp_f32 v24, v24
  v_mfma_f32_16x16x32_bf16 v[32:35], a[132:135], v[132:135], v[32:35]
  ds_read_b128 a[144:147], v212 offset:12288
  v_mfma_f32_16x16x32_bf16 v[32:35], a[136:139], v[136:139], v[32:35]
  v_exp_f32 v25, v25
  v_mfma_f32_16x16x32_bf16 v[32:35], a[140:143], v[140:143], v[32:35]
  ds_read_b128 a[148:151], v213 offset:12288
  v_cvt_pk_bf16_f32 v24, v24, v25
  v_mfma_f32_16x16x32_bf16 v[40:43], a[140:143], v[156:159], v[196:199]
  v_exp_f32 v26, v26
  v_mfma_f32_16x16x32_bf16 v[40:43], a[136:139], v[152:155], v[40:43]
  ds_read_b128 a[152:155], v214 offset:12288
  v_mfma_f32_16x16x32_bf16 v[40:43], a[132:135], v[148:151], v[40:43]
  v_exp_f32 v27, v27
  v_mfma_f32_16x16x32_bf16 v[40:43], a[128:131], v[144:147], v[40:43]
  ds_read_b128 a[156:159], v215 offset:12288
  v_cvt_pk_bf16_f32 v25, v26, v27
  v_mfma_f32_16x16x32_bf16 v[48:51], a[128:131], v[160:163], v[200:203]
  v_exp_f32 v4, v4
  v_mfma_f32_16x16x32_bf16 v[48:51], a[132:135], v[164:167], v[48:51]
  buffer_load_dwordx4 v233, s[12:15], s29 offen offset:1024 lds
  v_mfma_f32_16x16x32_bf16 v[48:51], a[136:139], v[168:171], v[48:51]
  v_exp_f32 v5, v5
  v_mfma_f32_16x16x32_bf16 v[48:51], a[140:143], v[172:175], v[48:51]
  v_cvt_pk_bf16_f32 v2, v4, v5
  v_mfma_f32_16x16x32_bf16 v[56:59], a[140:143], v[188:191], v[204:207]
  v_exp_f32 v6, v6
  v_mfma_f32_16x16x32_bf16 v[56:59], a[136:139], v[184:187], v[56:59]
  buffer_load_dwordx4 v234, s[12:15], s29 offen offset:2048 lds
  v_mfma_f32_16x16x32_bf16 v[56:59], a[132:135], v[180:183], v[56:59]
  s_waitcnt lgkmcnt(0)
  v_exp_f32 v7, v7
  v_mfma_f32_16x16x32_bf16 v[56:59], a[128:131], v[176:179], v[56:59]
  v_cvt_pk_bf16_f32 v3, v6, v7
  v_mfma_f32_16x16x32_bf16 v[36:39], a[144:147], v[128:131], v[192:195]
  v_exp_f32 v12, v12
  v_mfma_f32_16x16x32_bf16 v[36:39], a[148:151], v[132:135], v[36:39]
  ds_read_b64_tr_b16 a[160:161], v216 offset:49152
  v_mfma_f32_16x16x32_bf16 v[36:39], a[152:155], v[136:139], v[36:39]
  v_exp_f32 v13, v13
  v_mfma_f32_16x16x32_bf16 v[36:39], a[156:159], v[140:143], v[36:39]
  ds_read_b64_tr_b16 a[162:163], v216 offset:53248
  v_cvt_pk_bf16_f32 v10, v12, v13
  v_mfma_f32_16x16x32_bf16 v[44:47], a[156:159], v[156:159], v[196:199]
  v_exp_f32 v14, v14
  v_mfma_f32_16x16x32_bf16 v[44:47], a[152:155], v[152:155], v[44:47]
  ds_read_b64_tr_b16 a[164:165], v216 offset:57344
  buffer_load_dwordx4 v235, s[12:15], s29 offen offset:3072 lds
  v_mfma_f32_16x16x32_bf16 v[44:47], a[148:151], v[148:151], v[44:47]
  v_exp_f32 v15, v15
  v_mfma_f32_16x16x32_bf16 v[44:47], a[144:147], v[144:147], v[44:47]
  ds_read_b64_tr_b16 a[166:167], v216 offset:61440
  v_cvt_pk_bf16_f32 v11, v14, v15
  v_mfma_f32_16x16x32_bf16 v[52:55], a[144:147], v[160:163], v[200:203]
  s_add_u32 m0, s50, 4096
  v_exp_f32 v20, v20
  v_mfma_f32_16x16x32_bf16 v[52:55], a[148:151], v[164:167], v[52:55]
  ds_read_b64_tr_b16 a[168:169], v217 offset:49152
  buffer_load_dwordx4 v208, s[20:23], s30 offen lds
  s_add_u32 s30, s30, 32
  v_mfma_f32_16x16x32_bf16 v[52:55], a[152:155], v[168:171], v[52:55]
  v_exp_f32 v21, v21
  v_mfma_f32_16x16x32_bf16 v[52:55], a[156:159], v[172:175], v[52:55]
  ds_read_b64_tr_b16 a[170:171], v217 offset:53248
  v_cvt_pk_bf16_f32 v18, v20, v21
  v_mfma_f32_16x16x32_bf16 v[60:63], a[156:159], v[188:191], v[204:207]
  v_exp_f32 v22, v22
  v_mfma_f32_16x16x32_bf16 v[60:63], a[152:155], v[184:187], v[60:63]
  ds_read_b64_tr_b16 a[172:173], v217 offset:57344
  v_mfma_f32_16x16x32_bf16 v[60:63], a[148:151], v[180:183], v[60:63]
  v_exp_f32 v23, v23
  v_mfma_f32_16x16x32_bf16 v[60:63], a[144:147], v[176:179], v[60:63]
  ds_read_b64_tr_b16 a[174:175], v217 offset:61440
  v_cvt_pk_bf16_f32 v19, v22, v23
  v_mfma_f32_16x16x32_bf16 a[192:195], a[208:211], v[64:67], a[192:195]
  v_exp_f32 v28, v28
  v_mfma_f32_16x16x32_bf16 a[192:195], a[208:211], v[96:99], a[192:195]
  ds_read_b64_tr_b16 a[176:177], v218 offset:49152
  v_mfma_f32_16x16x32_bf16 a[196:199], a[208:211], v[72:75], a[196:199]
  v_exp_f32 v29, v29
  v_mfma_f32_16x16x32_bf16 a[196:199], a[208:211], v[104:107], a[196:199]
  ds_read_b64_tr_b16 a[178:179], v218 offset:53248
  v_cvt_pk_bf16_f32 v26, v28, v29
  v_mfma_f32_16x16x32_bf16 a[200:203], a[208:211], v[80:83], a[200:203]
  v_exp_f32 v30, v30
  v_mfma_f32_16x16x32_bf16 a[200:203], a[208:211], v[112:115], a[200:203]
  ds_read_b64_tr_b16 a[180:181], v218 offset:57344
  v_mfma_f32_16x16x32_bf16 a[204:207], a[208:211], v[88:91], a[204:207]
  s_waitcnt lgkmcnt(7)
  v_exp_f32 v31, v31
  v_mfma_f32_16x16x32_bf16 a[204:207], a[208:211], v[120:123], a[204:207]
  ds_read_b64_tr_b16 a[182:183], v218 offset:61440
  v_cvt_pk_bf16_f32 v27, v30, v31
  v_mfma_f32_16x16x32_bf16 a[0:3], a[160:163], v[64:67], a[0:3]
  v_exp_f32 v32, v32
  v_mfma_f32_16x16x32_bf16 a[0:3], a[164:167], v[96:99], a[0:3]
  ds_read_b64_tr_b16 a[184:185], v219 offset:49152
  v_mfma_f32_16x16x32_bf16 a[4:7], a[164:167], v[104:107], a[4:7]
  v_exp_f32 v33, v33
  v_mfma_f32_16x16x32_bf16 a[4:7], a[160:163], v[72:75], a[4:7]
  ds_read_b64_tr_b16 a[186:187], v219 offset:53248
  v_cvt_pk_bf16_f32 v32, v32, v33
  v_mfma_f32_16x16x32_bf16 a[8:11], a[160:163], v[80:83], a[8:11]
  v_exp_f32 v34, v34
  v_mfma_f32_16x16x32_bf16 a[8:11], a[164:167], v[112:115], a[8:11]
  ds_read_b64_tr_b16 a[188:189], v219 offset:57344
  v_mfma_f32_16x16x32_bf16 a[12:15], a[164:167], v[120:123], a[12:15]
  s_waitcnt lgkmcnt(7)
  v_exp_f32 v35, v35
  v_mfma_f32_16x16x32_bf16 a[12:15], a[160:163], v[88:91], a[12:15]
  ds_read_b64_tr_b16 a[190:191], v219 offset:61440
  v_cvt_pk_bf16_f32 v33, v34, v35
  v_mfma_f32_16x16x32_bf16 a[16:19], a[168:171], v[64:67], a[16:19]
  v_exp_f32 v40, v40
  v_mfma_f32_16x16x32_bf16 a[16:19], a[172:175], v[96:99], a[16:19]
  ds_read_b64_tr_b16 a[160:161], v220 offset:49152
  v_mfma_f32_16x16x32_bf16 a[20:23], a[172:175], v[104:107], a[20:23]
  v_exp_f32 v41, v41
  v_mfma_f32_16x16x32_bf16 a[20:23], a[168:171], v[72:75], a[20:23]
  ds_read_b64_tr_b16 a[162:163], v220 offset:53248
  v_cvt_pk_bf16_f32 v40, v40, v41
  v_mfma_f32_16x16x32_bf16 a[24:27], a[168:171], v[80:83], a[24:27]
  v_exp_f32 v42, v42
  v_mfma_f32_16x16x32_bf16 a[24:27], a[172:175], v[112:115], a[24:27]
  ds_read_b64_tr_b16 a[164:165], v220 offset:57344
  v_mfma_f32_16x16x32_bf16 a[28:31], a[172:175], v[120:123], a[28:31]
  s_waitcnt lgkmcnt(7)
  v_exp_f32 v43, v43
  v_mfma_f32_16x16x32_bf16 a[28:31], a[168:171], v[88:91], a[28:31]
  ds_read_b64_tr_b16 a[166:167], v220 offset:61440
  v_cvt_pk_bf16_f32 v41, v42, v43
  v_mfma_f32_16x16x32_bf16 a[32:35], a[176:179], v[64:67], a[32:35]
  v_exp_f32 v48, v48
  v_mfma_f32_16x16x32_bf16 a[32:35], a[180:183], v[96:99], a[32:35]
  ds_read_b64_tr_b16 a[168:169], v221 offset:49152
  v_mfma_f32_16x16x32_bf16 a[36:39], a[180:183], v[104:107], a[36:39]
  v_exp_f32 v49, v49
  v_mfma_f32_16x16x32_bf16 a[36:39], a[176:179], v[72:75], a[36:39]
  ds_read_b64_tr_b16 a[170:171], v221 offset:53248
  v_cvt_pk_bf16_f32 v48, v48, v49
  v_mfma_f32_16x16x32_bf16 a[40:43], a[176:179], v[80:83], a[40:43]
  v_exp_f32 v50, v50
  v_mfma_f32_16x16x32_bf16 a[40:43], a[180:183], v[112:115], a[40:43]
  ds_read_b64_tr_b16 a[172:173], v221 offset:57344
  v_mfma_f32_16x16x32_bf16 a[44:47], a[180:183], v[120:123], a[44:47]
  s_waitcnt lgkmcnt(7)
  v_exp_f32 v51, v51
  v_mfma_f32_16x16x32_bf16 a[44:47], a[176:179], v[88:91], a[44:47]
  ds_read_b64_tr_b16 a[174:175], v221 offset:61440
  v_cvt_pk_bf16_f32 v49, v50, v51
  v_mfma_f32_16x16x32_bf16 a[48:51], a[184:187], v[64:67], a[48:51]
  v_exp_f32 v56, v56
  v_mfma_f32_16x16x32_bf16 a[48:51], a[188:191], v[96:99], a[48:51]
  ds_read_b64_tr_b16 a[176:177], v222 offset:49152
  v_mfma_f32_16x16x32_bf16 a[52:55], a[188:191], v[104:107], a[52:55]
  v_exp_f32 v57, v57
  v_mfma_f32_16x16x32_bf16 a[52:55], a[184:187], v[72:75], a[52:55]
  ds_read_b64_tr_b16 a[178:179], v222 offset:53248
  v_cvt_pk_bf16_f32 v56, v56, v57
  v_mfma_f32_16x16x32_bf16 a[56:59], a[184:187], v[80:83], a[56:59]
  v_exp_f32 v58, v58
  v_mfma_f32_16x16x32_bf16 a[56:59], a[188:191], v[112:115], a[56:59]
  ds_read_b64_tr_b16 a[180:181], v222 offset:57344
  global_load_dword v255, v252, s[8:9]
  v_mfma_f32_16x16x32_bf16 a[60:63], a[188:191], v[120:123], a[60:63]
  s_waitcnt lgkmcnt(7)
  v_exp_f32 v59, v59
  v_mfma_f32_16x16x32_bf16 a[60:63], a[184:187], v[88:91], a[60:63]
  ds_read_b64_tr_b16 a[182:183], v222 offset:61440
  v_cvt_pk_bf16_f32 v57, v58, v59
  v_mfma_f32_16x16x32_bf16 a[64:67], a[160:163], v[64:67], a[64:67]
  v_exp_f32 v36, v36
  v_mfma_f32_16x16x32_bf16 a[64:67], a[164:167], v[96:99], a[64:67]
  ds_read_b64_tr_b16 a[184:185], v223 offset:49152
  v_mfma_f32_16x16x32_bf16 a[68:71], a[164:167], v[104:107], a[68:71]
  v_exp_f32 v37, v37
  v_mfma_f32_16x16x32_bf16 a[68:71], a[160:163], v[72:75], a[68:71]
  ds_read_b64_tr_b16 a[186:187], v223 offset:53248
  v_cvt_pk_bf16_f32 v34, v36, v37
  v_mfma_f32_16x16x32_bf16 a[72:75], a[160:163], v[80:83], a[72:75]
  v_exp_f32 v38, v38
  v_mfma_f32_16x16x32_bf16 a[72:75], a[164:167], v[112:115], a[72:75]
  ds_read_b64_tr_b16 a[188:189], v223 offset:57344
  v_mfma_f32_16x16x32_bf16 a[76:79], a[164:167], v[120:123], a[76:79]
  s_waitcnt lgkmcnt(7)
  v_exp_f32 v39, v39
  v_mfma_f32_16x16x32_bf16 a[76:79], a[160:163], v[88:91], a[76:79]
  ds_read_b64_tr_b16 a[190:191], v223 offset:61440
  v_cvt_pk_bf16_f32 v35, v38, v39
  v_mfma_f32_16x16x32_bf16 a[80:83], a[168:171], v[64:67], a[80:83]
  s_waitcnt vmcnt(12)
  v_exp_f32 v44, v44
  v_mfma_f32_16x16x32_bf16 a[80:83], a[172:175], v[96:99], a[80:83]
  v_mfma_f32_16x16x32_bf16 a[84:87], a[172:175], v[104:107], a[84:87]
  s_barrier
  v_exp_f32 v45, v45
  v_mfma_f32_16x16x32_bf16 a[84:87], a[168:171], v[72:75], a[84:87]
  ds_read_b128 a[128:131], v212 offset:16384
  v_cvt_pk_bf16_f32 v42, v44, v45
  v_mfma_f32_16x16x32_bf16 a[88:91], a[168:171], v[80:83], a[88:91]
  v_exp_f32 v46, v46
  v_mfma_f32_16x16x32_bf16 a[88:91], a[172:175], v[112:115], a[88:91]
  ds_read_b128 a[132:135], v213 offset:16384
  v_mfma_f32_16x16x32_bf16 a[92:95], a[172:175], v[120:123], a[92:95]
  s_waitcnt lgkmcnt(6)
  v_exp_f32 v47, v47
  v_mfma_f32_16x16x32_bf16 a[92:95], a[168:171], v[88:91], a[92:95]
  ds_read_b128 a[136:139], v214 offset:16384
  v_cvt_pk_bf16_f32 v43, v46, v47
  v_mfma_f32_16x16x32_bf16 a[96:99], a[176:179], v[64:67], a[96:99]
  v_exp_f32 v52, v52
  v_mfma_f32_16x16x32_bf16 a[96:99], a[180:183], v[96:99], a[96:99]
  ds_read_b128 a[140:143], v215 offset:16384
  v_mfma_f32_16x16x32_bf16 a[100:103], a[180:183], v[104:107], a[100:103]
  v_exp_f32 v53, v53
  v_mfma_f32_16x16x32_bf16 a[100:103], a[176:179], v[72:75], a[100:103]
  v_cvt_pk_bf16_f32 v50, v52, v53
  v_mfma_f32_16x16x32_bf16 a[104:107], a[176:179], v[80:83], a[104:107]
  v_exp_f32 v54, v54
  v_mfma_f32_16x16x32_bf16 a[104:107], a[180:183], v[112:115], a[104:107]
  v_mfma_f32_16x16x32_bf16 a[108:111], a[180:183], v[120:123], a[108:111]
  s_waitcnt lgkmcnt(4)
  v_exp_f32 v55, v55
  v_mfma_f32_16x16x32_bf16 a[108:111], a[176:179], v[88:91], a[108:111]
  v_cvt_pk_bf16_f32 v51, v54, v55
  v_mfma_f32_16x16x32_bf16 a[112:115], a[184:187], v[64:67], a[112:115]
  v_exp_f32 v60, v60
  v_mfma_f32_16x16x32_bf16 a[112:115], a[188:191], v[96:99], a[112:115]
  v_mfma_f32_16x16x32_bf16 a[116:119], a[188:191], v[104:107], a[116:119]
  v_exp_f32 v61, v61
  v_mfma_f32_16x16x32_bf16 a[116:119], a[184:187], v[72:75], a[116:119]
  v_cvt_pk_bf16_f32 v58, v60, v61
  v_mfma_f32_16x16x32_bf16 a[120:123], a[184:187], v[80:83], a[120:123]
  v_exp_f32 v62, v62
  v_mfma_f32_16x16x32_bf16 a[120:123], a[188:191], v[112:115], a[120:123]
  v_mfma_f32_16x16x32_bf16 a[124:127], a[188:191], v[120:123], a[124:127]
  s_waitcnt lgkmcnt(0)
  v_exp_f32 v63, v63
  v_mfma_f32_16x16x32_bf16 a[124:127], a[184:187], v[88:91], a[124:127]
  v_cvt_pk_bf16_f32 v59, v62, v63
  v_mfma_f32_16x16x32_bf16 v[64:67], a[128:131], v[128:131], v[192:195]
  s_add_u32 m0, s28, 98304
  v_mfma_f32_16x16x32_bf16 v[64:67], a[132:135], v[132:135], v[64:67]
  ds_read_b128 a[144:147], v212 offset:20480
  v_mfma_f32_16x16x32_bf16 v[64:67], a[136:139], v[136:139], v[64:67]
  buffer_load_dwordx4 v236, s[16:19], s29 offen offset:0 lds
  v_mfma_f32_16x16x32_bf16 v[64:67], a[140:143], v[140:143], v[64:67]
  ds_read_b128 a[148:151], v213 offset:20480
  v_mfma_f32_16x16x32_bf16 v[72:75], a[140:143], v[156:159], v[196:199]
  v_mfma_f32_16x16x32_bf16 v[72:75], a[136:139], v[152:155], v[72:75]
  ds_read_b128 a[152:155], v214 offset:20480
  v_mfma_f32_16x16x32_bf16 v[72:75], a[132:135], v[148:151], v[72:75]
  buffer_load_dwordx4 v237, s[16:19], s29 offen offset:1024 lds
  v_mfma_f32_16x16x32_bf16 v[72:75], a[128:131], v[144:147], v[72:75]
  ds_read_b128 a[156:159], v215 offset:20480
  v_mfma_f32_16x16x32_bf16 v[80:83], a[128:131], v[160:163], v[200:203]
  v_exp_f32 v64, v64
  v_mfma_f32_16x16x32_bf16 v[80:83], a[132:135], v[164:167], v[80:83]
  v_mfma_f32_16x16x32_bf16 v[80:83], a[136:139], v[168:171], v[80:83]
  v_exp_f32 v65, v65
  v_mfma_f32_16x16x32_bf16 v[80:83], a[140:143], v[172:175], v[80:83]
  v_cvt_pk_bf16_f32 v64, v64, v65
  v_mfma_f32_16x16x32_bf16 v[88:91], a[140:143], v[188:191], v[204:207]
  v_exp_f32 v66, v66
  v_mfma_f32_16x16x32_bf16 v[88:91], a[136:139], v[184:187], v[88:91]
  buffer_load_dwordx4 v236, s[16:19], s29 offen offset:2048 lds
  v_mfma_f32_16x16x32_bf16 v[88:91], a[132:135], v[180:183], v[88:91]
  s_waitcnt lgkmcnt(0)
  v_exp_f32 v67, v67
  v_mfma_f32_16x16x32_bf16 v[88:91], a[128:131], v[176:179], v[88:91]
  v_cvt_pk_bf16_f32 v65, v66, v67
  v_mfma_f32_16x16x32_bf16 v[68:71], a[144:147], v[128:131], v[192:195]
  v_exp_f32 v72, v72
  v_mfma_f32_16x16x32_bf16 v[68:71], a[148:151], v[132:135], v[68:71]
  ds_read_b128 a[128:131], v212 offset:24576
  v_mfma_f32_16x16x32_bf16 v[68:71], a[152:155], v[136:139], v[68:71]
  v_exp_f32 v73, v73
  v_mfma_f32_16x16x32_bf16 v[68:71], a[156:159], v[140:143], v[68:71]
  ds_read_b128 a[132:135], v213 offset:24576
  v_cvt_pk_bf16_f32 v72, v72, v73
  v_mfma_f32_16x16x32_bf16 v[76:79], a[156:159], v[156:159], v[196:199]
  v_exp_f32 v74, v74
  v_mfma_f32_16x16x32_bf16 v[76:79], a[152:155], v[152:155], v[76:79]
  ds_read_b128 a[136:139], v214 offset:24576
  v_mfma_f32_16x16x32_bf16 v[76:79], a[148:151], v[148:151], v[76:79]
  v_exp_f32 v75, v75
  v_mfma_f32_16x16x32_bf16 v[76:79], a[144:147], v[144:147], v[76:79]
  ds_read_b128 a[140:143], v215 offset:24576
  v_cvt_pk_bf16_f32 v73, v74, v75
  v_mfma_f32_16x16x32_bf16 v[84:87], a[144:147], v[160:163], v[200:203]
  v_exp_f32 v80, v80
  v_mfma_f32_16x16x32_bf16 v[84:87], a[148:151], v[164:167], v[84:87]
  buffer_load_dwordx4 v237, s[16:19], s29 offen offset:3072 lds
  v_mfma_f32_16x16x32_bf16 v[84:87], a[152:155], v[168:171], v[84:87]
  s_add_u32 s29, s29, 16384
  v_exp_f32 v81, v81
  v_mfma_f32_16x16x32_bf16 v[84:87], a[156:159], v[172:175], v[84:87]
  v_cvt_pk_bf16_f32 v80, v80, v81
  v_mfma_f32_16x16x32_bf16 v[92:95], a[156:159], v[188:191], v[204:207]
  s_add_u32 m0, s28, 49152
  v_exp_f32 v82, v82
  v_mfma_f32_16x16x32_bf16 v[92:95], a[152:155], v[184:187], v[92:95]
  buffer_load_dwordx4 v232, s[12:15], s29 offen offset:0 lds
  v_mfma_f32_16x16x32_bf16 v[92:95], a[148:151], v[180:183], v[92:95]
  s_waitcnt lgkmcnt(0)
  v_exp_f32 v83, v83
  v_mfma_f32_16x16x32_bf16 v[92:95], a[144:147], v[176:179], v[92:95]
  v_cvt_pk_bf16_f32 v81, v82, v83
  v_mfma_f32_16x16x32_bf16 v[96:99], a[128:131], v[128:131], v[192:195]
  v_exp_f32 v88, v88
  v_mfma_f32_16x16x32_bf16 v[96:99], a[132:135], v[132:135], v[96:99]
  ds_read_b128 a[144:147], v212 offset:28672
  v_mfma_f32_16x16x32_bf16 v[96:99], a[136:139], v[136:139], v[96:99]
  v_exp_f32 v89, v89
  v_mfma_f32_16x16x32_bf16 v[96:99], a[140:143], v[140:143], v[96:99]
  ds_read_b128 a[148:151], v213 offset:28672
  v_cvt_pk_bf16_f32 v88, v88, v89
  v_mfma_f32_16x16x32_bf16 v[104:107], a[140:143], v[156:159], v[196:199]
  v_exp_f32 v90, v90
  v_mfma_f32_16x16x32_bf16 v[104:107], a[136:139], v[152:155], v[104:107]
  ds_read_b128 a[152:155], v214 offset:28672
  v_mfma_f32_16x16x32_bf16 v[104:107], a[132:135], v[148:151], v[104:107]
  v_exp_f32 v91, v91
  v_mfma_f32_16x16x32_bf16 v[104:107], a[128:131], v[144:147], v[104:107]
  ds_read_b128 a[156:159], v215 offset:28672
  v_cvt_pk_bf16_f32 v89, v90, v91
  v_mfma_f32_16x16x32_bf16 v[112:115], a[128:131], v[160:163], v[200:203]
  v_exp_f32 v68, v68
  v_mfma_f32_16x16x32_bf16 v[112:115], a[132:135], v[164:167], v[112:115]
  buffer_load_dwordx4 v233, s[12:15], s29 offen offset:1024 lds
  v_mfma_f32_16x16x32_bf16 v[112:115], a[136:139], v[168:171], v[112:115]
  v_exp_f32 v69, v69
  v_mfma_f32_16x16x32_bf16 v[112:115], a[140:143], v[172:175], v[112:115]
  v_cvt_pk_bf16_f32 v66, v68, v69
  v_mfma_f32_16x16x32_bf16 v[120:123], a[140:143], v[188:191], v[204:207]
  v_exp_f32 v70, v70
  v_mfma_f32_16x16x32_bf16 v[120:123], a[136:139], v[184:187], v[120:123]
  buffer_load_dwordx4 v234, s[12:15], s29 offen offset:2048 lds
  v_mfma_f32_16x16x32_bf16 v[120:123], a[132:135], v[180:183], v[120:123]
  s_waitcnt lgkmcnt(0)
  v_exp_f32 v71, v71
  v_mfma_f32_16x16x32_bf16 v[120:123], a[128:131], v[176:179], v[120:123]
  v_cvt_pk_bf16_f32 v67, v70, v71
  v_mfma_f32_16x16x32_bf16 v[100:103], a[144:147], v[128:131], v[192:195]
  v_exp_f32 v76, v76
  v_mfma_f32_16x16x32_bf16 v[100:103], a[148:151], v[132:135], v[100:103]
  ds_read_b64_tr_b16 a[160:161], v216 offset:0
  v_mfma_f32_16x16x32_bf16 v[100:103], a[152:155], v[136:139], v[100:103]
  v_exp_f32 v77, v77
  v_mfma_f32_16x16x32_bf16 v[100:103], a[156:159], v[140:143], v[100:103]
  ds_read_b64_tr_b16 a[162:163], v216 offset:4096
  v_cvt_pk_bf16_f32 v74, v76, v77
  v_mfma_f32_16x16x32_bf16 v[108:111], a[156:159], v[156:159], v[196:199]
  v_exp_f32 v78, v78
  v_mfma_f32_16x16x32_bf16 v[108:111], a[152:155], v[152:155], v[108:111]
  ds_read_b64_tr_b16 a[164:165], v216 offset:8192
  buffer_load_dwordx4 v235, s[12:15], s29 offen offset:3072 lds
  v_mfma_f32_16x16x32_bf16 v[108:111], a[148:151], v[148:151], v[108:111]
  v_exp_f32 v79, v79
  v_mfma_f32_16x16x32_bf16 v[108:111], a[144:147], v[144:147], v[108:111]
  ds_read_b64_tr_b16 a[166:167], v216 offset:12288
  v_cvt_pk_bf16_f32 v75, v78, v79
  v_mfma_f32_16x16x32_bf16 v[116:119], a[144:147], v[160:163], v[200:203]
  s_add_u32 m0, s50, 5120
  v_exp_f32 v84, v84
  v_mfma_f32_16x16x32_bf16 v[116:119], a[148:151], v[164:167], v[116:119]
  ds_read_b64_tr_b16 a[168:169], v217 offset:0
  buffer_load_dwordx4 v208, s[20:23], s30 offen lds
  s_add_u32 s30, s30, 32
  v_mfma_f32_16x16x32_bf16 v[116:119], a[152:155], v[168:171], v[116:119]
  v_exp_f32 v85, v85
  v_mfma_f32_16x16x32_bf16 v[116:119], a[156:159], v[172:175], v[116:119]
  ds_read_b64_tr_b16 a[170:171], v217 offset:4096
  v_cvt_pk_bf16_f32 v82, v84, v85
  v_mfma_f32_16x16x32_bf16 v[124:127], a[156:159], v[188:191], v[204:207]
  v_exp_f32 v86, v86
  v_mfma_f32_16x16x32_bf16 v[124:127], a[152:155], v[184:187], v[124:127]
  ds_read_b64_tr_b16 a[172:173], v217 offset:8192
  v_mfma_f32_16x16x32_bf16 v[124:127], a[148:151], v[180:183], v[124:127]
  v_exp_f32 v87, v87
  v_mfma_f32_16x16x32_bf16 v[124:127], a[144:147], v[176:179], v[124:127]
  ds_read_b64_tr_b16 a[174:175], v217 offset:12288
  v_cvt_pk_bf16_f32 v83, v86, v87
  v_mfma_f32_16x16x32_bf16 a[192:195], a[208:211], v[0:3], a[192:195]
  v_exp_f32 v92, v92
  v_mfma_f32_16x16x32_bf16 a[192:195], a[208:211], v[32:35], a[192:195]
  ds_read_b64_tr_b16 a[176:177], v218 offset:0
  v_mfma_f32_16x16x32_bf16 a[196:199], a[208:211], v[8:11], a[196:199]
  v_exp_f32 v93, v93
  v_mfma_f32_16x16x32_bf16 a[196:199], a[208:211], v[40:43], a[196:199]
  ds_read_b64_tr_b16 a[178:179], v218 offset:4096
  v_cvt_pk_bf16_f32 v90, v92, v93
  v_mfma_f32_16x16x32_bf16 a[200:203], a[208:211], v[16:19], a[200:203]
  v_exp_f32 v94, v94
  v_mfma_f32_16x16x32_bf16 a[200:203], a[208:211], v[48:51], a[200:203]
  ds_read_b64_tr_b16 a[180:181], v218 offset:8192
  v_mfma_f32_16x16x32_bf16 a[204:207], a[208:211], v[24:27], a[204:207]
  s_waitcnt lgkmcnt(7)
  v_exp_f32 v95, v95
  v_mfma_f32_16x16x32_bf16 a[204:207], a[208:211], v[56:59], a[204:207]
  ds_read_b64_tr_b16 a[182:183], v218 offset:12288
  v_cvt_pk_bf16_f32 v91, v94, v95
  v_mfma_f32_16x16x32_bf16 a[0:3], a[160:163], v[0:3], a[0:3]
  v_exp_f32 v96, v96
  v_mfma_f32_16x16x32_bf16 a[0:3], a[164:167], v[32:35], a[0:3]
  ds_read_b64_tr_b16 a[184:185], v219 offset:0
  v_mfma_f32_16x16x32_bf16 a[4:7], a[164:167], v[40:43], a[4:7]
  v_exp_f32 v97, v97
  v_mfma_f32_16x16x32_bf16 a[4:7], a[160:163], v[8:11], a[4:7]
  ds_read_b64_tr_b16 a[186:187], v219 offset:4096
  v_cvt_pk_bf16_f32 v96, v96, v97
  v_mfma_f32_16x16x32_bf16 a[8:11], a[160:163], v[16:19], a[8:11]
  v_exp_f32 v98, v98
  v_mfma_f32_16x16x32_bf16 a[8:11], a[164:167], v[48:51], a[8:11]
  ds_read_b64_tr_b16 a[188:189], v219 offset:8192
  v_mfma_f32_16x16x32_bf16 a[12:15], a[164:167], v[56:59], a[12:15]
  s_waitcnt lgkmcnt(7)
  v_exp_f32 v99, v99
  v_mfma_f32_16x16x32_bf16 a[12:15], a[160:163], v[24:27], a[12:15]
  ds_read_b64_tr_b16 a[190:191], v219 offset:12288
  v_cvt_pk_bf16_f32 v97, v98, v99
  v_mfma_f32_16x16x32_bf16 a[16:19], a[168:171], v[0:3], a[16:19]
  v_exp_f32 v104, v104
  v_mfma_f32_16x16x32_bf16 a[16:19], a[172:175], v[32:35], a[16:19]
  ds_read_b64_tr_b16 a[160:161], v220 offset:0
  v_mfma_f32_16x16x32_bf16 a[20:23], a[172:175], v[40:43], a[20:23]
  v_exp_f32 v105, v105
  v_mfma_f32_16x16x32_bf16 a[20:23], a[168:171], v[8:11], a[20:23]
  ds_read_b64_tr_b16 a[162:163], v220 offset:4096
  v_cvt_pk_bf16_f32 v104, v104, v105
  v_mfma_f32_16x16x32_bf16 a[24:27], a[168:171], v[16:19], a[24:27]
  v_exp_f32 v106, v106
  v_mfma_f32_16x16x32_bf16 a[24:27], a[172:175], v[48:51], a[24:27]
  ds_read_b64_tr_b16 a[164:165], v220 offset:8192
  v_mfma_f32_16x16x32_bf16 a[28:31], a[172:175], v[56:59], a[28:31]
  s_waitcnt lgkmcnt(7)
  v_exp_f32 v107, v107
  v_mfma_f32_16x16x32_bf16 a[28:31], a[168:171], v[24:27], a[28:31]
  ds_read_b64_tr_b16 a[166:167], v220 offset:12288
  v_cvt_pk_bf16_f32 v105, v106, v107
  v_mfma_f32_16x16x32_bf16 a[32:35], a[176:179], v[0:3], a[32:35]
  v_exp_f32 v112, v112
  v_mfma_f32_16x16x32_bf16 a[32:35], a[180:183], v[32:35], a[32:35]
  ds_read_b64_tr_b16 a[168:169], v221 offset:0
  v_mfma_f32_16x16x32_bf16 a[36:39], a[180:183], v[40:43], a[36:39]
  v_exp_f32 v113, v113
  v_mfma_f32_16x16x32_bf16 a[36:39], a[176:179], v[8:11], a[36:39]
  ds_read_b64_tr_b16 a[170:171], v221 offset:4096
  v_cvt_pk_bf16_f32 v112, v112, v113
  v_mfma_f32_16x16x32_bf16 a[40:43], a[176:179], v[16:19], a[40:43]
  v_exp_f32 v114, v114
  v_mfma_f32_16x16x32_bf16 a[40:43], a[180:183], v[48:51], a[40:43]
  ds_read_b64_tr_b16 a[172:173], v221 offset:8192
  v_mfma_f32_16x16x32_bf16 a[44:47], a[180:183], v[56:59], a[44:47]
  s_waitcnt lgkmcnt(7)
  v_exp_f32 v115, v115
  v_mfma_f32_16x16x32_bf16 a[44:47], a[176:179], v[24:27], a[44:47]
  ds_read_b64_tr_b16 a[174:175], v221 offset:12288
  v_cvt_pk_bf16_f32 v113, v114, v115
  v_mfma_f32_16x16x32_bf16 a[48:51], a[184:187], v[0:3], a[48:51]
  v_exp_f32 v120, v120
  v_mfma_f32_16x16x32_bf16 a[48:51], a[188:191], v[32:35], a[48:51]
  ds_read_b64_tr_b16 a[176:177], v222 offset:0
  v_mfma_f32_16x16x32_bf16 a[52:55], a[188:191], v[40:43], a[52:55]
  v_exp_f32 v121, v121
  v_mfma_f32_16x16x32_bf16 a[52:55], a[184:187], v[8:11], a[52:55]
  ds_read_b64_tr_b16 a[178:179], v222 offset:4096
  v_cvt_pk_bf16_f32 v120, v120, v121
  v_mfma_f32_16x16x32_bf16 a[56:59], a[184:187], v[16:19], a[56:59]
  v_exp_f32 v122, v122
  v_mfma_f32_16x16x32_bf16 a[56:59], a[188:191], v[48:51], a[56:59]
  ds_read_b64_tr_b16 a[180:181], v222 offset:8192
  v_mfma_f32_16x16x32_bf16 a[60:63], a[188:191], v[56:59], a[60:63]
  s_waitcnt lgkmcnt(7)
  v_exp_f32 v123, v123
  v_mfma_f32_16x16x32_bf16 a[60:63], a[184:187], v[24:27], a[60:63]
  ds_read_b64_tr_b16 a[182:183], v222 offset:12288
  v_cvt_pk_bf16_f32 v121, v122, v123
  v_mfma_f32_16x16x32_bf16 a[64:67], a[160:163], v[0:3], a[64:67]
  v_exp_f32 v100, v100
  v_mfma_f32_16x16x32_bf16 a[64:67], a[164:167], v[32:35], a[64:67]
  ds_read_b64_tr_b16 a[184:185], v223 offset:0
  v_mfma_f32_16x16x32_bf16 a[68:71], a[164:167], v[40:43], a[68:71]
  v_exp_f32 v101, v101
  v_mfma_f32_16x16x32_bf16 a[68:71], a[160:163], v[8:11], a[68:71]
  ds_read_b64_tr_b16 a[186:187], v223 offset:4096
  v_cvt_pk_bf16_f32 v98, v100, v101
  v_mfma_f32_16x16x32_bf16 a[72:75], a[160:163], v[16:19], a[72:75]
  v_exp_f32 v102, v102
  v_mfma_f32_16x16x32_bf16 a[72:75], a[164:167], v[48:51], a[72:75]
  ds_read_b64_tr_b16 a[188:189], v223 offset:8192
  v_mfma_f32_16x16x32_bf16 a[76:79], a[164:167], v[56:59], a[76:79]
  s_waitcnt lgkmcnt(7)
  v_exp_f32 v103, v103
  v_mfma_f32_16x16x32_bf16 a[76:79], a[160:163], v[24:27], a[76:79]
  ds_read_b64_tr_b16 a[190:191], v223 offset:12288
  v_cvt_pk_bf16_f32 v99, v102, v103
  v_mfma_f32_16x16x32_bf16 a[80:83], a[168:171], v[0:3], a[80:83]
  s_waitcnt vmcnt(11)
  v_exp_f32 v108, v108
  v_mfma_f32_16x16x32_bf16 a[80:83], a[172:175], v[32:35], a[80:83]
  v_mfma_f32_16x16x32_bf16 a[84:87], a[172:175], v[40:43], a[84:87]
  s_barrier
  v_exp_f32 v109, v109
  v_mfma_f32_16x16x32_bf16 a[84:87], a[168:171], v[8:11], a[84:87]
  ds_read_b128 a[128:131], v212 offset:32768
  v_cvt_pk_bf16_f32 v106, v108, v109
  v_mfma_f32_16x16x32_bf16 a[88:91], a[168:171], v[16:19], a[88:91]
  v_exp_f32 v110, v110
  v_mfma_f32_16x16x32_bf16 a[88:91], a[172:175], v[48:51], a[88:91]
  ds_read_b128 a[132:135], v213 offset:32768
  buffer_atomic_add v250, v249, s[24:27], s47 offen
  s_cmp_eq_u32 s32, 3
  s_cselect_b32 s39, 0, 1073741824
  v_mfma_f32_16x16x32_bf16 a[92:95], a[172:175], v[56:59], a[92:95]
  s_waitcnt lgkmcnt(6)
  v_exp_f32 v111, v111
  v_mfma_f32_16x16x32_bf16 a[92:95], a[168:171], v[24:27], a[92:95]
  ds_read_b128 a[136:139], v214 offset:32768
  v_cvt_pk_bf16_f32 v107, v110, v111
  v_mfma_f32_16x16x32_bf16 a[96:99], a[176:179], v[0:3], a[96:99]
  v_exp_f32 v116, v116
  v_mfma_f32_16x16x32_bf16 a[96:99], a[180:183], v[32:35], a[96:99]
  ds_read_b128 a[140:143], v215 offset:32768
  v_or_b32 v249, s39, v251
  v_mfma_f32_16x16x32_bf16 a[100:103], a[180:183], v[40:43], a[100:103]
  v_exp_f32 v117, v117
  v_mfma_f32_16x16x32_bf16 a[100:103], a[176:179], v[8:11], a[100:103]
  v_cvt_pk_bf16_f32 v114, v116, v117
  v_mfma_f32_16x16x32_bf16 a[104:107], a[176:179], v[16:19], a[104:107]
  v_exp_f32 v118, v118
  v_mfma_f32_16x16x32_bf16 a[104:107], a[180:183], v[48:51], a[104:107]
  v_mfma_f32_16x16x32_bf16 a[108:111], a[180:183], v[56:59], a[108:111]
  s_waitcnt lgkmcnt(4)
  v_exp_f32 v119, v119
  v_mfma_f32_16x16x32_bf16 a[108:111], a[176:179], v[24:27], a[108:111]
  v_cvt_pk_bf16_f32 v115, v118, v119
  v_mfma_f32_16x16x32_bf16 a[112:115], a[184:187], v[0:3], a[112:115]
  v_exp_f32 v124, v124
  v_mfma_f32_16x16x32_bf16 a[112:115], a[188:191], v[32:35], a[112:115]
  v_mfma_f32_16x16x32_bf16 a[116:119], a[188:191], v[40:43], a[116:119]
  v_exp_f32 v125, v125
  v_mfma_f32_16x16x32_bf16 a[116:119], a[184:187], v[8:11], a[116:119]
  v_cvt_pk_bf16_f32 v122, v124, v125
  v_mfma_f32_16x16x32_bf16 a[120:123], a[184:187], v[16:19], a[120:123]
  v_exp_f32 v126, v126
  v_mfma_f32_16x16x32_bf16 a[120:123], a[188:191], v[48:51], a[120:123]
  v_mfma_f32_16x16x32_bf16 a[124:127], a[188:191], v[56:59], a[124:127]
  s_waitcnt lgkmcnt(0)
  v_exp_f32 v127, v127
  v_mfma_f32_16x16x32_bf16 a[124:127], a[184:187], v[24:27], a[124:127]
  v_cvt_pk_bf16_f32 v123, v126, v127
  v_mfma_f32_16x16x32_bf16 v[0:3], a[128:131], v[128:131], v[192:195]
  s_add_u32 m0, s28, 114688
  v_mfma_f32_16x16x32_bf16 v[0:3], a[132:135], v[132:135], v[0:3]
  ds_read_b128 a[144:147], v212 offset:36864
  v_mfma_f32_16x16x32_bf16 v[0:3], a[136:139], v[136:139], v[0:3]
  buffer_load_dwordx4 v236, s[16:19], s29 offen offset:0 lds
  v_mfma_f32_16x16x32_bf16 v[0:3], a[140:143], v[140:143], v[0:3]
  ds_read_b128 a[148:151], v213 offset:36864
  v_mfma_f32_16x16x32_bf16 v[8:11], a[140:143], v[156:159], v[196:199]
  v_mfma_f32_16x16x32_bf16 v[8:11], a[136:139], v[152:155], v[8:11]
  ds_read_b128 a[152:155], v214 offset:36864
  v_mfma_f32_16x16x32_bf16 v[8:11], a[132:135], v[148:151], v[8:11]
  buffer_load_dwordx4 v237, s[16:19], s29 offen offset:1024 lds
  v_mfma_f32_16x16x32_bf16 v[8:11], a[128:131], v[144:147], v[8:11]
  ds_read_b128 a[156:159], v215 offset:36864
  v_mfma_f32_16x16x32_bf16 v[16:19], a[128:131], v[160:163], v[200:203]
  v_exp_f32 v0, v0
  v_mfma_f32_16x16x32_bf16 v[16:19], a[132:135], v[164:167], v[16:19]
  v_mfma_f32_16x16x32_bf16 v[16:19], a[136:139], v[168:171], v[16:19]
  v_exp_f32 v1, v1
  v_mfma_f32_16x16x32_bf16 v[16:19], a[140:143], v[172:175], v[16:19]
  v_cvt_pk_bf16_f32 v0, v0, v1
  v_mfma_f32_16x16x32_bf16 v[24:27], a[140:143], v[188:191], v[204:207]
  v_exp_f32 v2, v2
  v_mfma_f32_16x16x32_bf16 v[24:27], a[136:139], v[184:187], v[24:27]
  buffer_load_dwordx4 v236, s[16:19], s29 offen offset:2048 lds
  v_mfma_f32_16x16x32_bf16 v[24:27], a[132:135], v[180:183], v[24:27]
  s_waitcnt lgkmcnt(0)
  v_exp_f32 v3, v3
  v_mfma_f32_16x16x32_bf16 v[24:27], a[128:131], v[176:179], v[24:27]
  v_cvt_pk_bf16_f32 v1, v2, v3
  v_mfma_f32_16x16x32_bf16 v[4:7], a[144:147], v[128:131], v[192:195]
  v_exp_f32 v8, v8
  v_mfma_f32_16x16x32_bf16 v[4:7], a[148:151], v[132:135], v[4:7]
  ds_read_b128 a[128:131], v212 offset:40960
  v_mfma_f32_16x16x32_bf16 v[4:7], a[152:155], v[136:139], v[4:7]
  v_exp_f32 v9, v9
  v_mfma_f32_16x16x32_bf16 v[4:7], a[156:159], v[140:143], v[4:7]
  ds_read_b128 a[132:135], v213 offset:40960
  v_cvt_pk_bf16_f32 v8, v8, v9
  v_mfma_f32_16x16x32_bf16 v[12:15], a[156:159], v[156:159], v[196:199]
  v_exp_f32 v10, v10
  v_mfma_f32_16x16x32_bf16 v[12:15], a[152:155], v[152:155], v[12:15]
  ds_read_b128 a[136:139], v214 offset:40960
  v_mfma_f32_16x16x32_bf16 v[12:15], a[148:151], v[148:151], v[12:15]
  v_exp_f32 v11, v11
  v_mfma_f32_16x16x32_bf16 v[12:15], a[144:147], v[144:147], v[12:15]
  ds_read_b128 a[140:143], v215 offset:40960
  v_cvt_pk_bf16_f32 v9, v10, v11
  v_mfma_f32_16x16x32_bf16 v[20:23], a[144:147], v[160:163], v[200:203]
  v_exp_f32 v16, v16
  v_mfma_f32_16x16x32_bf16 v[20:23], a[148:151], v[164:167], v[20:23]
  buffer_load_dwordx4 v237, s[16:19], s29 offen offset:3072 lds
  v_mfma_f32_16x16x32_bf16 v[20:23], a[152:155], v[168:171], v[20:23]
  s_add_u32 s29, s29, 16384
  v_exp_f32 v17, v17
  v_mfma_f32_16x16x32_bf16 v[20:23], a[156:159], v[172:175], v[20:23]
  v_cvt_pk_bf16_f32 v16, v16, v17
  v_mfma_f32_16x16x32_bf16 v[28:31], a[156:159], v[188:191], v[204:207]
  s_add_u32 m0, s28, 0
  v_exp_f32 v18, v18
  v_mfma_f32_16x16x32_bf16 v[28:31], a[152:155], v[184:187], v[28:31]
  buffer_load_dwordx4 v232, s[12:15], s29 offen offset:0 lds
  v_mfma_f32_16x16x32_bf16 v[28:31], a[148:151], v[180:183], v[28:31]
  s_waitcnt lgkmcnt(0)
  v_exp_f32 v19, v19
  v_mfma_f32_16x16x32_bf16 v[28:31], a[144:147], v[176:179], v[28:31]
  v_cvt_pk_bf16_f32 v17, v18, v19
  v_mfma_f32_16x16x32_bf16 v[32:35], a[128:131], v[128:131], v[192:195]
  v_exp_f32 v24, v24
  v_mfma_f32_16x16x32_bf16 v[32:35], a[132:135], v[132:135], v[32:35]
  ds_read_b128 a[144:147], v212 offset:45056
  v_mfma_f32_16x16x32_bf16 v[32:35], a[136:139], v[136:139], v[32:35]
  v_exp_f32 v25, v25
  v_mfma_f32_16x16x32_bf16 v[32:35], a[140:143], v[140:143], v[32:35]
  ds_read_b128 a[148:151], v213 offset:45056
  v_cvt_pk_bf16_f32 v24, v24, v25
  v_mfma_f32_16x16x32_bf16 v[40:43], a[140:143], v[156:159], v[196:199]
  v_exp_f32 v26, v26
  v_mfma_f32_16x16x32_bf16 v[40:43], a[136:139], v[152:155], v[40:43]
  ds_read_b128 a[152:155], v214 offset:45056
  v_mfma_f32_16x16x32_bf16 v[40:43], a[132:135], v[148:151], v[40:43]
  v_exp_f32 v27, v27
  v_mfma_f32_16x16x32_bf16 v[40:43], a[128:131], v[144:147], v[40:43]
  ds_read_b128 a[156:159], v215 offset:45056
  v_cvt_pk_bf16_f32 v25, v26, v27
  v_mfma_f32_16x16x32_bf16 v[48:51], a[128:131], v[160:163], v[200:203]
  v_exp_f32 v4, v4
  v_mfma_f32_16x16x32_bf16 v[48:51], a[132:135], v[164:167], v[48:51]
  buffer_load_dwordx4 v233, s[12:15], s29 offen offset:1024 lds
  v_mfma_f32_16x16x32_bf16 v[48:51], a[136:139], v[168:171], v[48:51]
  v_exp_f32 v5, v5
  v_mfma_f32_16x16x32_bf16 v[48:51], a[140:143], v[172:175], v[48:51]
  v_cvt_pk_bf16_f32 v2, v4, v5
  v_mfma_f32_16x16x32_bf16 v[56:59], a[140:143], v[188:191], v[204:207]
  v_exp_f32 v6, v6
  v_mfma_f32_16x16x32_bf16 v[56:59], a[136:139], v[184:187], v[56:59]
  buffer_load_dwordx4 v234, s[12:15], s29 offen offset:2048 lds
  v_mfma_f32_16x16x32_bf16 v[56:59], a[132:135], v[180:183], v[56:59]
  s_waitcnt lgkmcnt(0)
  v_exp_f32 v7, v7
  v_mfma_f32_16x16x32_bf16 v[56:59], a[128:131], v[176:179], v[56:59]
  v_cvt_pk_bf16_f32 v3, v6, v7
  v_mfma_f32_16x16x32_bf16 v[36:39], a[144:147], v[128:131], v[192:195]
  v_exp_f32 v12, v12
  v_mfma_f32_16x16x32_bf16 v[36:39], a[148:151], v[132:135], v[36:39]
  ds_read_b64_tr_b16 a[160:161], v216 offset:16384
  v_mfma_f32_16x16x32_bf16 v[36:39], a[152:155], v[136:139], v[36:39]
  v_exp_f32 v13, v13
  v_mfma_f32_16x16x32_bf16 v[36:39], a[156:159], v[140:143], v[36:39]
  ds_read_b64_tr_b16 a[162:163], v216 offset:20480
  v_cvt_pk_bf16_f32 v10, v12, v13
  v_mfma_f32_16x16x32_bf16 v[44:47], a[156:159], v[156:159], v[196:199]
  v_exp_f32 v14, v14
  v_mfma_f32_16x16x32_bf16 v[44:47], a[152:155], v[152:155], v[44:47]
  ds_read_b64_tr_b16 a[164:165], v216 offset:24576
  buffer_load_dwordx4 v235, s[12:15], s29 offen offset:3072 lds
  v_mfma_f32_16x16x32_bf16 v[44:47], a[148:151], v[148:151], v[44:47]
  v_exp_f32 v15, v15
  v_mfma_f32_16x16x32_bf16 v[44:47], a[144:147], v[144:147], v[44:47]
  ds_read_b64_tr_b16 a[166:167], v216 offset:28672
  v_cvt_pk_bf16_f32 v11, v14, v15
  v_mfma_f32_16x16x32_bf16 v[52:55], a[144:147], v[160:163], v[200:203]
  s_mov_b32 m0, s51
  v_exp_f32 v20, v20
  v_mfma_f32_16x16x32_bf16 v[52:55], a[148:151], v[164:167], v[52:55]
  ds_read_b64_tr_b16 a[168:169], v217 offset:16384
  buffer_load_dwordx4 v210, s[4:7], s100 offen lds
  s_add_u32 s100, s100, 20480
  s_add_u32 s51, s51, 512
  v_mfma_f32_16x16x32_bf16 v[52:55], a[152:155], v[168:171], v[52:55]
  v_exp_f32 v21, v21
  v_mfma_f32_16x16x32_bf16 v[52:55], a[156:159], v[172:175], v[52:55]
  ds_read_b64_tr_b16 a[170:171], v217 offset:20480
  v_cvt_pk_bf16_f32 v18, v20, v21
  v_mfma_f32_16x16x32_bf16 v[60:63], a[156:159], v[188:191], v[204:207]
  s_waitcnt vmcnt(20)
  v_exp_f32 v22, v22
  v_mfma_f32_16x16x32_bf16 v[60:63], a[152:155], v[184:187], v[60:63]
  ds_read_b64_tr_b16 a[172:173], v217 offset:24576
  ds_read_b64_tr_b16 a[232:233], v209 offset:4096
  v_mfma_f32_16x16x32_bf16 v[60:63], a[148:151], v[180:183], v[60:63]
  v_exp_f32 v23, v23
  v_mfma_f32_16x16x32_bf16 v[60:63], a[144:147], v[176:179], v[60:63]
  ds_read_b64_tr_b16 a[174:175], v217 offset:28672
  v_cvt_pk_bf16_f32 v19, v22, v23
  v_mfma_f32_16x16x32_bf16 a[192:195], a[208:211], v[64:67], a[192:195]
  v_exp_f32 v28, v28
  v_mfma_f32_16x16x32_bf16 a[192:195], a[208:211], v[96:99], a[192:195]
  ds_read_b64_tr_b16 a[176:177], v218 offset:16384
  ds_read_b64_tr_b16 a[234:235], v209 offset:4608
  v_mfma_f32_16x16x32_bf16 a[196:199], a[208:211], v[72:75], a[196:199]
  v_exp_f32 v29, v29
  v_mfma_f32_16x16x32_bf16 a[196:199], a[208:211], v[104:107], a[196:199]
  ds_read_b64_tr_b16 a[178:179], v218 offset:20480
  v_cvt_pk_bf16_f32 v26, v28, v29
  v_mfma_f32_16x16x32_bf16 a[200:203], a[208:211], v[80:83], a[200:203]
  v_exp_f32 v30, v30
  v_mfma_f32_16x16x32_bf16 a[200:203], a[208:211], v[112:115], a[200:203]
  ds_read_b64_tr_b16 a[180:181], v218 offset:24576
  v_mfma_f32_16x16x32_bf16 a[204:207], a[208:211], v[88:91], a[204:207]
  s_waitcnt lgkmcnt(9)
  v_exp_f32 v31, v31
  v_mfma_f32_16x16x32_bf16 a[204:207], a[208:211], v[120:123], a[204:207]
  ds_read_b64_tr_b16 a[182:183], v218 offset:28672
  v_cvt_pk_bf16_f32 v27, v30, v31
  v_mfma_f32_16x16x32_bf16 a[0:3], a[160:163], v[64:67], a[0:3]
  v_exp_f32 v32, v32
  v_mfma_f32_16x16x32_bf16 a[0:3], a[164:167], v[96:99], a[0:3]
  ds_read_b64_tr_b16 a[184:185], v219 offset:16384
  s_waitcnt lgkmcnt(4)
  buffer_store_dwordx4 a[232:235], v211, s[24:27], s31 offen sc1
  s_add_u32 s31, s31, 1024
  s_cmp_gt_u32 s32, 3
  v_mfma_f32_16x16x32_bf16 a[4:7], a[164:167], v[104:107], a[4:7]
  s_cselect_b32 s39, 0, 1073741824
  v_exp_f32 v33, v33
  v_mfma_f32_16x16x32_bf16 a[4:7], a[160:163], v[72:75], a[4:7]
  ds_read_b64_tr_b16 a[186:187], v219 offset:20480
  v_cvt_pk_bf16_f32 v32, v32, v33
  v_mfma_f32_16x16x32_bf16 a[8:11], a[160:163], v[80:83], a[8:11]
  v_exp_f32 v34, v34
  v_mfma_f32_16x16x32_bf16 a[8:11], a[164:167], v[112:115], a[8:11]
  ds_read_b64_tr_b16 a[188:189], v219 offset:24576
  v_or_b32 v211, s39, v211
  v_mfma_f32_16x16x32_bf16 a[12:15], a[164:167], v[120:123], a[12:15]
  v_exp_f32 v35, v35
  v_mfma_f32_16x16x32_bf16 a[12:15], a[160:163], v[88:91], a[12:15]
  ds_read_b64_tr_b16 a[190:191], v219 offset:28672
  v_cvt_pk_bf16_f32 v33, v34, v35
  v_mfma_f32_16x16x32_bf16 a[16:19], a[168:171], v[64:67], a[16:19]
  v_exp_f32 v40, v40
  v_mfma_f32_16x16x32_bf16 a[16:19], a[172:175], v[96:99], a[16:19]
  ds_read_b64_tr_b16 a[160:161], v220 offset:16384
  v_or_b32 v208, s39, v208
  v_mfma_f32_16x16x32_bf16 a[20:23], a[172:175], v[104:107], a[20:23]
  v_exp_f32 v41, v41
  v_mfma_f32_16x16x32_bf16 a[20:23], a[168:171], v[72:75], a[20:23]
  ds_read_b64_tr_b16 a[162:163], v220 offset:20480
  v_cvt_pk_bf16_f32 v40, v40, v41
  v_mfma_f32_16x16x32_bf16 a[24:27], a[168:171], v[80:83], a[24:27]
  v_exp_f32 v42, v42
  v_mfma_f32_16x16x32_bf16 a[24:27], a[172:175], v[112:115], a[24:27]
  ds_read_b64_tr_b16 a[164:165], v220 offset:24576
  v_mfma_f32_16x16x32_bf16 a[28:31], a[172:175], v[120:123], a[28:31]
  s_waitcnt lgkmcnt(7)
  v_exp_f32 v43, v43
  v_mfma_f32_16x16x32_bf16 a[28:31], a[168:171], v[88:91], a[28:31]
  ds_read_b64_tr_b16 a[166:167], v220 offset:28672
  v_cvt_pk_bf16_f32 v41, v42, v43
  v_mfma_f32_16x16x32_bf16 a[32:35], a[176:179], v[64:67], a[32:35]
  v_exp_f32 v48, v48
  v_mfma_f32_16x16x32_bf16 a[32:35], a[180:183], v[96:99], a[32:35]
  ds_read_b64_tr_b16 a[168:169], v221 offset:16384
  v_mfma_f32_16x16x32_bf16 a[36:39], a[180:183], v[104:107], a[36:39]
  v_exp_f32 v49, v49
  v_mfma_f32_16x16x32_bf16 a[36:39], a[176:179], v[72:75], a[36:39]
  ds_read_b64_tr_b16 a[170:171], v221 offset:20480
  v_cvt_pk_bf16_f32 v48, v48, v49
  v_mfma_f32_16x16x32_bf16 a[40:43], a[176:179], v[80:83], a[40:43]
  v_exp_f32 v50, v50
  v_mfma_f32_16x16x32_bf16 a[40:43], a[180:183], v[112:115], a[40:43]
  ds_read_b64_tr_b16 a[172:173], v221 offset:24576
  v_mfma_f32_16x16x32_bf16 a[44:47], a[180:183], v[120:123], a[44:47]
  s_waitcnt lgkmcnt(7)
  v_exp_f32 v51, v51
  v_mfma_f32_16x16x32_bf16 a[44:47], a[176:179], v[88:91], a[44:47]
  ds_read_b64_tr_b16 a[174:175], v221 offset:28672
  v_cvt_pk_bf16_f32 v49, v50, v51
  v_mfma_f32_16x16x32_bf16 a[48:51], a[184:187], v[64:67], a[48:51]
  v_exp_f32 v56, v56
  v_mfma_f32_16x16x32_bf16 a[48:51], a[188:191], v[96:99], a[48:51]
  ds_read_b64_tr_b16 a[176:177], v222 offset:16384
  v_mfma_f32_16x16x32_bf16 a[52:55], a[188:191], v[104:107], a[52:55]
  v_exp_f32 v57, v57
  v_mfma_f32_16x16x32_bf16 a[52:55], a[184:187], v[72:75], a[52:55]
  ds_read_b64_tr_b16 a[178:179], v222 offset:20480
  v_cvt_pk_bf16_f32 v56, v56, v57
  v_mfma_f32_16x16x32_bf16 a[56:59], a[184:187], v[80:83], a[56:59]
  v_exp_f32 v58, v58
  v_mfma_f32_16x16x32_bf16 a[56:59], a[188:191], v[112:115], a[56:59]
  ds_read_b64_tr_b16 a[180:181], v222 offset:24576
  v_mfma_f32_16x16x32_bf16 a[60:63], a[188:191], v[120:123], a[60:63]
  s_waitcnt lgkmcnt(7)
  v_exp_f32 v59, v59
  v_mfma_f32_16x16x32_bf16 a[60:63], a[184:187], v[88:91], a[60:63]
  ds_read_b64_tr_b16 a[182:183], v222 offset:28672
  v_cvt_pk_bf16_f32 v57, v58, v59
  v_mfma_f32_16x16x32_bf16 a[64:67], a[160:163], v[64:67], a[64:67]
  v_exp_f32 v36, v36
  v_mfma_f32_16x16x32_bf16 a[64:67], a[164:167], v[96:99], a[64:67]
  ds_read_b64_tr_b16 a[184:185], v223 offset:16384
  v_mfma_f32_16x16x32_bf16 a[68:71], a[164:167], v[104:107], a[68:71]
  v_exp_f32 v37, v37
  v_mfma_f32_16x16x32_bf16 a[68:71], a[160:163], v[72:75], a[68:71]
  ds_read_b64_tr_b16 a[186:187], v223 offset:20480
  v_cvt_pk_bf16_f32 v34, v36, v37
  v_mfma_f32_16x16x32_bf16 a[72:75], a[160:163], v[80:83], a[72:75]
  v_exp_f32 v38, v38
  v_mfma_f32_16x16x32_bf16 a[72:75], a[164:167], v[112:115], a[72:75]
  ds_read_b64_tr_b16 a[188:189], v223 offset:24576
  v_mfma_f32_16x16x32_bf16 a[76:79], a[164:167], v[120:123], a[76:79]
  s_waitcnt lgkmcnt(7)
  v_exp_f32 v39, v39
  v_mfma_f32_16x16x32_bf16 a[76:79], a[160:163], v[88:91], a[76:79]
  ds_read_b64_tr_b16 a[190:191], v223 offset:28672
  v_cvt_pk_bf16_f32 v35, v38, v39
  v_mfma_f32_16x16x32_bf16 a[80:83], a[168:171], v[64:67], a[80:83]
  s_waitcnt vmcnt(12)
  v_exp_f32 v44, v44
  v_mfma_f32_16x16x32_bf16 a[80:83], a[172:175], v[96:99], a[80:83]
  v_mfma_f32_16x16x32_bf16 a[84:87], a[172:175], v[104:107], a[84:87]
  s_barrier
  v_exp_f32 v45, v45
  v_mfma_f32_16x16x32_bf16 a[84:87], a[168:171], v[72:75], a[84:87]
  ds_read_b128 a[128:131], v212 offset:49152
  v_cvt_pk_bf16_f32 v42, v44, v45
  v_mfma_f32_16x16x32_bf16 a[88:91], a[168:171], v[80:83], a[88:91]
  v_exp_f32 v46, v46
  v_mfma_f32_16x16x32_bf16 a[88:91], a[172:175], v[112:115], a[88:91]
  ds_read_b128 a[132:135], v213 offset:49152
  v_mfma_f32_16x16x32_bf16 a[92:95], a[172:175], v[120:123], a[92:95]
  s_waitcnt lgkmcnt(6)
  v_exp_f32 v47, v47
  v_mfma_f32_16x16x32_bf16 a[92:95], a[168:171], v[88:91], a[92:95]
  ds_read_b128 a[136:139], v214 offset:49152
  v_cvt_pk_bf16_f32 v43, v46, v47
  v_mfma_f32_16x16x32_bf16 a[96:99], a[176:179], v[64:67], a[96:99]
  v_exp_f32 v52, v52
  v_mfma_f32_16x16x32_bf16 a[96:99], a[180:183], v[96:99], a[96:99]
  ds_read_b128 a[140:143], v215 offset:49152
  v_mfma_f32_16x16x32_bf16 a[100:103], a[180:183], v[104:107], a[100:103]
  v_exp_f32 v53, v53
  v_mfma_f32_16x16x32_bf16 a[100:103], a[176:179], v[72:75], a[100:103]
  v_cvt_pk_bf16_f32 v50, v52, v53
  v_mfma_f32_16x16x32_bf16 a[104:107], a[176:179], v[80:83], a[104:107]
  v_exp_f32 v54, v54
  v_mfma_f32_16x16x32_bf16 a[104:107], a[180:183], v[112:115], a[104:107]
  v_mfma_f32_16x16x32_bf16 a[108:111], a[180:183], v[120:123], a[108:111]
  s_waitcnt lgkmcnt(4)
  v_exp_f32 v55, v55
  v_mfma_f32_16x16x32_bf16 a[108:111], a[176:179], v[88:91], a[108:111]
  v_cvt_pk_bf16_f32 v51, v54, v55
  v_mfma_f32_16x16x32_bf16 a[112:115], a[184:187], v[64:67], a[112:115]
  v_exp_f32 v60, v60
  v_mfma_f32_16x16x32_bf16 a[112:115], a[188:191], v[96:99], a[112:115]
  v_mfma_f32_16x16x32_bf16 a[116:119], a[188:191], v[104:107], a[116:119]
  v_exp_f32 v61, v61
  v_mfma_f32_16x16x32_bf16 a[116:119], a[184:187], v[72:75], a[116:119]
  v_cvt_pk_bf16_f32 v58, v60, v61
  v_mfma_f32_16x16x32_bf16 a[120:123], a[184:187], v[80:83], a[120:123]
  v_exp_f32 v62, v62
  v_mfma_f32_16x16x32_bf16 a[120:123], a[188:191], v[112:115], a[120:123]
  v_mfma_f32_16x16x32_bf16 a[124:127], a[188:191], v[120:123], a[124:127]
  s_waitcnt lgkmcnt(0)
  v_exp_f32 v63, v63
  v_mfma_f32_16x16x32_bf16 a[124:127], a[184:187], v[88:91], a[124:127]
  v_cvt_pk_bf16_f32 v59, v62, v63
  v_mfma_f32_16x16x32_bf16 v[64:67], a[128:131], v[128:131], v[192:195]
  s_add_u32 m0, s28, 65536
  v_mfma_f32_16x16x32_bf16 v[64:67], a[132:135], v[132:135], v[64:67]
  ds_read_b128 a[144:147], v212 offset:53248
  v_mfma_f32_16x16x32_bf16 v[64:67], a[136:139], v[136:139], v[64:67]
  buffer_load_dwordx4 v236, s[16:19], s29 offen offset:0 lds
  v_mfma_f32_16x16x32_bf16 v[64:67], a[140:143], v[140:143], v[64:67]
  ds_read_b128 a[148:151], v213 offset:53248
  v_mfma_f32_16x16x32_bf16 v[72:75], a[140:143], v[156:159], v[196:199]
  v_mfma_f32_16x16x32_bf16 v[72:75], a[136:139], v[152:155], v[72:75]
  ds_read_b128 a[152:155], v214 offset:53248
  v_mfma_f32_16x16x32_bf16 v[72:75], a[132:135], v[148:151], v[72:75]
  buffer_load_dwordx4 v237, s[16:19], s29 offen offset:1024 lds
  v_mfma_f32_16x16x32_bf16 v[72:75], a[128:131], v[144:147], v[72:75]
  ds_read_b128 a[156:159], v215 offset:53248
  v_mfma_f32_16x16x32_bf16 v[80:83], a[128:131], v[160:163], v[200:203]
  v_exp_f32 v64, v64
  v_mfma_f32_16x16x32_bf16 v[80:83], a[132:135], v[164:167], v[80:83]
  v_mfma_f32_16x16x32_bf16 v[80:83], a[136:139], v[168:171], v[80:83]
  v_exp_f32 v65, v65
  v_mfma_f32_16x16x32_bf16 v[80:83], a[140:143], v[172:175], v[80:83]
  v_cvt_pk_bf16_f32 v64, v64, v65
  v_mfma_f32_16x16x32_bf16 v[88:91], a[140:143], v[188:191], v[204:207]
  v_exp_f32 v66, v66
  v_mfma_f32_16x16x32_bf16 v[88:91], a[136:139], v[184:187], v[88:91]
  buffer_load_dwordx4 v236, s[16:19], s29 offen offset:2048 lds
  v_mfma_f32_16x16x32_bf16 v[88:91], a[132:135], v[180:183], v[88:91]
  s_waitcnt lgkmcnt(0)
  v_exp_f32 v67, v67
  v_mfma_f32_16x16x32_bf16 v[88:91], a[128:131], v[176:179], v[88:91]
  v_cvt_pk_bf16_f32 v65, v66, v67
  v_mfma_f32_16x16x32_bf16 v[68:71], a[144:147], v[128:131], v[192:195]
  v_exp_f32 v72, v72
  v_mfma_f32_16x16x32_bf16 v[68:71], a[148:151], v[132:135], v[68:71]
  ds_read_b128 a[128:131], v212 offset:57344
  v_mfma_f32_16x16x32_bf16 v[68:71], a[152:155], v[136:139], v[68:71]
  v_exp_f32 v73, v73
  v_mfma_f32_16x16x32_bf16 v[68:71], a[156:159], v[140:143], v[68:71]
  ds_read_b128 a[132:135], v213 offset:57344
  v_cvt_pk_bf16_f32 v72, v72, v73
  v_mfma_f32_16x16x32_bf16 v[76:79], a[156:159], v[156:159], v[196:199]
  v_exp_f32 v74, v74
  v_mfma_f32_16x16x32_bf16 v[76:79], a[152:155], v[152:155], v[76:79]
  ds_read_b128 a[136:139], v214 offset:57344
  v_mfma_f32_16x16x32_bf16 v[76:79], a[148:151], v[148:151], v[76:79]
  v_exp_f32 v75, v75
  v_mfma_f32_16x16x32_bf16 v[76:79], a[144:147], v[144:147], v[76:79]
  ds_read_b128 a[140:143], v215 offset:57344
  v_cvt_pk_bf16_f32 v73, v74, v75
  v_mfma_f32_16x16x32_bf16 v[84:87], a[144:147], v[160:163], v[200:203]
  v_exp_f32 v80, v80
  v_mfma_f32_16x16x32_bf16 v[84:87], a[148:151], v[164:167], v[84:87]
  buffer_load_dwordx4 v237, s[16:19], s29 offen offset:3072 lds
  v_mfma_f32_16x16x32_bf16 v[84:87], a[152:155], v[168:171], v[84:87]
  s_add_u32 s29, s29, 16384
  v_exp_f32 v81, v81
  v_mfma_f32_16x16x32_bf16 v[84:87], a[156:159], v[172:175], v[84:87]
  v_cvt_pk_bf16_f32 v80, v80, v81
  v_mfma_f32_16x16x32_bf16 v[92:95], a[156:159], v[188:191], v[204:207]
  s_add_u32 m0, s28, 16384
  v_exp_f32 v82, v82
  v_mfma_f32_16x16x32_bf16 v[92:95], a[152:155], v[184:187], v[92:95]
  buffer_load_dwordx4 v232, s[12:15], s29 offen offset:0 lds
  v_mfma_f32_16x16x32_bf16 v[92:95], a[148:151], v[180:183], v[92:95]
  s_waitcnt lgkmcnt(0)
  v_exp_f32 v83, v83
  v_mfma_f32_16x16x32_bf16 v[92:95], a[144:147], v[176:179], v[92:95]
  v_cvt_pk_bf16_f32 v81, v82, v83
  v_mfma_f32_16x16x32_bf16 v[96:99], a[128:131], v[128:131], v[192:195]
  v_exp_f32 v88, v88
  v_mfma_f32_16x16x32_bf16 v[96:99], a[132:135], v[132:135], v[96:99]
  ds_read_b128 a[144:147], v212 offset:61440
  v_mfma_f32_16x16x32_bf16 v[96:99], a[136:139], v[136:139], v[96:99]
  v_exp_f32 v89, v89
  v_mfma_f32_16x16x32_bf16 v[96:99], a[140:143], v[140:143], v[96:99]
  ds_read_b128 a[148:151], v213 offset:61440
  v_cvt_pk_bf16_f32 v88, v88, v89
  v_mfma_f32_16x16x32_bf16 v[104:107], a[140:143], v[156:159], v[196:199]
  v_exp_f32 v90, v90
  v_mfma_f32_16x16x32_bf16 v[104:107], a[136:139], v[152:155], v[104:107]
  ds_read_b128 a[152:155], v214 offset:61440
  v_mfma_f32_16x16x32_bf16 v[104:107], a[132:135], v[148:151], v[104:107]
  v_exp_f32 v91, v91
  v_mfma_f32_16x16x32_bf16 v[104:107], a[128:131], v[144:147], v[104:107]
  ds_read_b128 a[156:159], v215 offset:61440
  v_cvt_pk_bf16_f32 v89, v90, v91
  v_mfma_f32_16x16x32_bf16 v[112:115], a[128:131], v[160:163], v[200:203]
  v_exp_f32 v68, v68
  v_mfma_f32_16x16x32_bf16 v[112:115], a[132:135], v[164:167], v[112:115]
  buffer_load_dwordx4 v233, s[12:15], s29 offen offset:1024 lds
  v_mfma_f32_16x16x32_bf16 v[112:115], a[136:139], v[168:171], v[112:115]
  v_exp_f32 v69, v69
  v_mfma_f32_16x16x32_bf16 v[112:115], a[140:143], v[172:175], v[112:115]
  v_cvt_pk_bf16_f32 v66, v68, v69
  v_mfma_f32_16x16x32_bf16 v[120:123], a[140:143], v[188:191], v[204:207]
  v_exp_f32 v70, v70
  v_mfma_f32_16x16x32_bf16 v[120:123], a[136:139], v[184:187], v[120:123]
  buffer_load_dwordx4 v234, s[12:15], s29 offen offset:2048 lds
  v_mfma_f32_16x16x32_bf16 v[120:123], a[132:135], v[180:183], v[120:123]
  s_waitcnt lgkmcnt(0)
  v_exp_f32 v71, v71
  v_mfma_f32_16x16x32_bf16 v[120:123], a[128:131], v[176:179], v[120:123]
  v_cvt_pk_bf16_f32 v67, v70, v71
  v_mfma_f32_16x16x32_bf16 v[100:103], a[144:147], v[128:131], v[192:195]
  v_exp_f32 v76, v76
  v_mfma_f32_16x16x32_bf16 v[100:103], a[148:151], v[132:135], v[100:103]
  ds_read_b64_tr_b16 a[160:161], v216 offset:32768
  v_mfma_f32_16x16x32_bf16 v[100:103], a[152:155], v[136:139], v[100:103]
  v_exp_f32 v77, v77
  v_mfma_f32_16x16x32_bf16 v[100:103], a[156:159], v[140:143], v[100:103]
  ds_read_b64_tr_b16 a[162:163], v216 offset:36864
  v_cvt_pk_bf16_f32 v74, v76, v77
  v_mfma_f32_16x16x32_bf16 v[108:111], a[156:159], v[156:159], v[196:199]
  v_exp_f32 v78, v78
  v_mfma_f32_16x16x32_bf16 v[108:111], a[152:155], v[152:155], v[108:111]
  ds_read_b64_tr_b16 a[164:165], v216 offset:40960
  buffer_load_dwordx4 v235, s[12:15], s29 offen offset:3072 lds
  v_mfma_f32_16x16x32_bf16 v[108:111], a[148:151], v[148:151], v[108:111]
  v_exp_f32 v79, v79
  v_mfma_f32_16x16x32_bf16 v[108:111], a[144:147], v[144:147], v[108:111]
  ds_read_b64_tr_b16 a[166:167], v216 offset:45056
  v_cvt_pk_bf16_f32 v75, v78, v79
  v_mfma_f32_16x16x32_bf16 v[116:119], a[144:147], v[160:163], v[200:203]
  v_exp_f32 v84, v84
  v_mfma_f32_16x16x32_bf16 v[116:119], a[148:151], v[164:167], v[116:119]
  ds_read_b64_tr_b16 a[168:169], v217 offset:32768
  buffer_load_dword v254, off, s[24:27], s47 sc1
  v_mfma_f32_16x16x32_bf16 v[116:119], a[152:155], v[168:171], v[116:119]
  v_exp_f32 v85, v85
  v_mfma_f32_16x16x32_bf16 v[116:119], a[156:159], v[172:175], v[116:119]
  ds_read_b64_tr_b16 a[170:171], v217 offset:36864
  v_cvt_pk_bf16_f32 v82, v84, v85
  v_mfma_f32_16x16x32_bf16 v[124:127], a[156:159], v[188:191], v[204:207]
  s_waitcnt vmcnt(20)
  v_exp_f32 v86, v86
  v_mfma_f32_16x16x32_bf16 v[124:127], a[152:155], v[184:187], v[124:127]
  ds_read_b64_tr_b16 a[172:173], v217 offset:40960
  ds_read_b64_tr_b16 a[232:233], v209 offset:5120
  v_mfma_f32_16x16x32_bf16 v[124:127], a[148:151], v[180:183], v[124:127]
  v_exp_f32 v87, v87
  v_mfma_f32_16x16x32_bf16 v[124:127], a[144:147], v[176:179], v[124:127]
  ds_read_b64_tr_b16 a[174:175], v217 offset:45056
  v_cvt_pk_bf16_f32 v83, v86, v87
  v_mfma_f32_16x16x32_bf16 a[192:195], a[208:211], v[0:3], a[192:195]
  v_exp_f32 v92, v92
  v_mfma_f32_16x16x32_bf16 a[192:195], a[208:211], v[32:35], a[192:195]
  ds_read_b64_tr_b16 a[176:177], v218 offset:32768
  ds_read_b64_tr_b16 a[234:235], v209 offset:5632
  v_mfma_f32_16x16x32_bf16 a[196:199], a[208:211], v[8:11], a[196:199]
  v_exp_f32 v93, v93
  v_mfma_f32_16x16x32_bf16 a[196:199], a[208:211], v[40:43], a[196:199]
  ds_read_b64_tr_b16 a[178:179], v218 offset:36864
  v_cvt_pk_bf16_f32 v90, v92, v93
  v_mfma_f32_16x16x32_bf16 a[200:203], a[208:211], v[16:19], a[200:203]
  v_exp_f32 v94, v94
  v_mfma_f32_16x16x32_bf16 a[200:203], a[208:211], v[48:51], a[200:203]
  ds_read_b64_tr_b16 a[180:181], v218 offset:40960
  v_mfma_f32_16x16x32_bf16 a[204:207], a[208:211], v[24:27], a[204:207]
  s_waitcnt lgkmcnt(9)
  v_exp_f32 v95, v95
  v_mfma_f32_16x16x32_bf16 a[204:207], a[208:211], v[56:59], a[204:207]
  ds_read_b64_tr_b16 a[182:183], v218 offset:45056
  v_cvt_pk_bf16_f32 v91, v94, v95
  v_mfma_f32_16x16x32_bf16 a[0:3], a[160:163], v[0:3], a[0:3]
  v_exp_f32 v96, v96
  v_mfma_f32_16x16x32_bf16 a[0:3], a[164:167], v[32:35], a[0:3]
  ds_read_b64_tr_b16 a[184:185], v219 offset:32768
  s_waitcnt lgkmcnt(4)
  buffer_store_dwordx4 a[232:235], v211, s[24:27], s31 offen sc1
  s_add_u32 s31, s31, 1024
  v_mfma_f32_16x16x32_bf16 a[4:7], a[164:167], v[40:43], a[4:7]
  v_exp_f32 v97, v97
  v_mfma_f32_16x16x32_bf16 a[4:7], a[160:163], v[8:11], a[4:7]
  ds_read_b64_tr_b16 a[186:187], v219 offset:36864
  v_cvt_pk_bf16_f32 v96, v96, v97
  v_mfma_f32_16x16x32_bf16 a[8:11], a[160:163], v[16:19], a[8:11]
  v_exp_f32 v98, v98
  v_mfma_f32_16x16x32_bf16 a[8:11], a[164:167], v[48:51], a[8:11]
  ds_read_b64_tr_b16 a[188:189], v219 offset:40960
  v_mfma_f32_16x16x32_bf16 a[12:15], a[164:167], v[56:59], a[12:15]
  v_exp_f32 v99, v99
  v_mfma_f32_16x16x32_bf16 a[12:15], a[160:163], v[24:27], a[12:15]
  ds_read_b64_tr_b16 a[190:191], v219 offset:45056
  v_cvt_pk_bf16_f32 v97, v98, v99
  v_mfma_f32_16x16x32_bf16 a[16:19], a[168:171], v[0:3], a[16:19]
  v_exp_f32 v104, v104
  v_mfma_f32_16x16x32_bf16 a[16:19], a[172:175], v[32:35], a[16:19]
  ds_read_b64_tr_b16 a[160:161], v220 offset:32768
  v_mfma_f32_16x16x32_bf16 a[20:23], a[172:175], v[40:43], a[20:23]
  v_exp_f32 v105, v105
  v_mfma_f32_16x16x32_bf16 a[20:23], a[168:171], v[8:11], a[20:23]
  ds_read_b64_tr_b16 a[162:163], v220 offset:36864
  v_cvt_pk_bf16_f32 v104, v104, v105
  v_mfma_f32_16x16x32_bf16 a[24:27], a[168:171], v[16:19], a[24:27]
  v_exp_f32 v106, v106
  v_mfma_f32_16x16x32_bf16 a[24:27], a[172:175], v[48:51], a[24:27]
  ds_read_b64_tr_b16 a[164:165], v220 offset:40960
  v_mfma_f32_16x16x32_bf16 a[28:31], a[172:175], v[56:59], a[28:31]
  s_waitcnt lgkmcnt(7)
  v_exp_f32 v107, v107
  v_mfma_f32_16x16x32_bf16 a[28:31], a[168:171], v[24:27], a[28:31]
  ds_read_b64_tr_b16 a[166:167], v220 offset:45056
  v_cvt_pk_bf16_f32 v105, v106, v107
  v_mfma_f32_16x16x32_bf16 a[32:35], a[176:179], v[0:3], a[32:35]
  v_exp_f32 v112, v112
  v_mfma_f32_16x16x32_bf16 a[32:35], a[180:183], v[32:35], a[32:35]
  ds_read_b64_tr_b16 a[168:169], v221 offset:32768
  v_mfma_f32_16x16x32_bf16 a[36:39], a[180:183], v[40:43], a[36:39]
  v_exp_f32 v113, v113
  v_mfma_f32_16x16x32_bf16 a[36:39], a[176:179], v[8:11], a[36:39]
  ds_read_b64_tr_b16 a[170:171], v221 offset:36864
  v_cvt_pk_bf16_f32 v112, v112, v113
  v_mfma_f32_16x16x32_bf16 a[40:43], a[176:179], v[16:19], a[40:43]
  v_exp_f32 v114, v114
  v_mfma_f32_16x16x32_bf16 a[40:43], a[180:183], v[48:51], a[40:43]
  ds_read_b64_tr_b16 a[172:173], v221 offset:40960
  v_mfma_f32_16x16x32_bf16 a[44:47], a[180:183], v[56:59], a[44:47]
  s_waitcnt lgkmcnt(7)
  v_exp_f32 v115, v115
  v_mfma_f32_16x16x32_bf16 a[44:47], a[176:179], v[24:27], a[44:47]
  ds_read_b64_tr_b16 a[174:175], v221 offset:45056
  v_cvt_pk_bf16_f32 v113, v114, v115
  v_mfma_f32_16x16x32_bf16 a[48:51], a[184:187], v[0:3], a[48:51]
  v_exp_f32 v120, v120
  v_mfma_f32_16x16x32_bf16 a[48:51], a[188:191], v[32:35], a[48:51]
  ds_read_b64_tr_b16 a[176:177], v222 offset:32768
  v_mfma_f32_16x16x32_bf16 a[52:55], a[188:191], v[40:43], a[52:55]
  v_exp_f32 v121, v121
  v_mfma_f32_16x16x32_bf16 a[52:55], a[184:187], v[8:11], a[52:55]
  ds_read_b64_tr_b16 a[178:179], v222 offset:36864
  v_cvt_pk_bf16_f32 v120, v120, v121
  v_mfma_f32_16x16x32_bf16 a[56:59], a[184:187], v[16:19], a[56:59]
  v_exp_f32 v122, v122
  v_mfma_f32_16x16x32_bf16 a[56:59], a[188:191], v[48:51], a[56:59]
  ds_read_b64_tr_b16 a[180:181], v222 offset:40960
  v_mfma_f32_16x16x32_bf16 a[60:63], a[188:191], v[56:59], a[60:63]
  s_waitcnt lgkmcnt(7)
  v_exp_f32 v123, v123
  v_mfma_f32_16x16x32_bf16 a[60:63], a[184:187], v[24:27], a[60:63]
  ds_read_b64_tr_b16 a[182:183], v222 offset:45056
  v_cvt_pk_bf16_f32 v121, v122, v123
  v_mfma_f32_16x16x32_bf16 a[64:67], a[160:163], v[0:3], a[64:67]
  v_exp_f32 v100, v100
  v_mfma_f32_16x16x32_bf16 a[64:67], a[164:167], v[32:35], a[64:67]
  ds_read_b64_tr_b16 a[184:185], v223 offset:32768
  v_mfma_f32_16x16x32_bf16 a[68:71], a[164:167], v[40:43], a[68:71]
  v_exp_f32 v101, v101
  v_mfma_f32_16x16x32_bf16 a[68:71], a[160:163], v[8:11], a[68:71]
  ds_read_b64_tr_b16 a[186:187], v223 offset:36864
  v_cvt_pk_bf16_f32 v98, v100, v101
  v_mfma_f32_16x16x32_bf16 a[72:75], a[160:163], v[16:19], a[72:75]
  v_exp_f32 v102, v102
  v_mfma_f32_16x16x32_bf16 a[72:75], a[164:167], v[48:51], a[72:75]
  ds_read_b64_tr_b16 a[188:189], v223 offset:40960
  v_mfma_f32_16x16x32_bf16 a[76:79], a[164:167], v[56:59], a[76:79]
  s_waitcnt lgkmcnt(7)
  v_exp_f32 v103, v103
  v_mfma_f32_16x16x32_bf16 a[76:79], a[160:163], v[24:27], a[76:79]
  ds_read_b64_tr_b16 a[190:191], v223 offset:45056
  v_cvt_pk_bf16_f32 v99, v102, v103
  v_mfma_f32_16x16x32_bf16 a[80:83], a[168:171], v[0:3], a[80:83]
  s_waitcnt vmcnt(12)
  v_exp_f32 v108, v108
  v_mfma_f32_16x16x32_bf16 a[80:83], a[172:175], v[32:35], a[80:83]
  v_mfma_f32_16x16x32_bf16 a[84:87], a[172:175], v[40:43], a[84:87]
  s_barrier
  v_exp_f32 v109, v109
  v_mfma_f32_16x16x32_bf16 a[84:87], a[168:171], v[8:11], a[84:87]
  ds_read_b128 a[128:131], v212 offset:0
  v_cvt_pk_bf16_f32 v106, v108, v109
  v_mfma_f32_16x16x32_bf16 a[88:91], a[168:171], v[16:19], a[88:91]
  v_exp_f32 v110, v110
  v_mfma_f32_16x16x32_bf16 a[88:91], a[172:175], v[48:51], a[88:91]
  ds_read_b128 a[132:135], v213 offset:0
  v_mfma_f32_16x16x32_bf16 a[92:95], a[172:175], v[56:59], a[92:95]
  s_waitcnt lgkmcnt(6)
  v_exp_f32 v111, v111
  v_mfma_f32_16x16x32_bf16 a[92:95], a[168:171], v[24:27], a[92:95]
  ds_read_b128 a[136:139], v214 offset:0
  v_cvt_pk_bf16_f32 v107, v110, v111
  v_mfma_f32_16x16x32_bf16 a[96:99], a[176:179], v[0:3], a[96:99]
  v_exp_f32 v116, v116
  v_mfma_f32_16x16x32_bf16 a[96:99], a[180:183], v[32:35], a[96:99]
  ds_read_b128 a[140:143], v215 offset:0
  v_mfma_f32_16x16x32_bf16 a[100:103], a[180:183], v[40:43], a[100:103]
  v_exp_f32 v117, v117
  v_mfma_f32_16x16x32_bf16 a[100:103], a[176:179], v[8:11], a[100:103]
  v_cvt_pk_bf16_f32 v114, v116, v117
  v_mfma_f32_16x16x32_bf16 a[104:107], a[176:179], v[16:19], a[104:107]
  v_exp_f32 v118, v118
  v_mfma_f32_16x16x32_bf16 a[104:107], a[180:183], v[48:51], a[104:107]
  v_mfma_f32_16x16x32_bf16 a[108:111], a[180:183], v[56:59], a[108:111]
  s_waitcnt lgkmcnt(4)
  v_exp_f32 v119, v119
  v_mfma_f32_16x16x32_bf16 a[108:111], a[176:179], v[24:27], a[108:111]
  v_cvt_pk_bf16_f32 v115, v118, v119
  v_mfma_f32_16x16x32_bf16 a[112:115], a[184:187], v[0:3], a[112:115]
  v_exp_f32 v124, v124
  v_mfma_f32_16x16x32_bf16 a[112:115], a[188:191], v[32:35], a[112:115]
  v_mfma_f32_16x16x32_bf16 a[116:119], a[188:191], v[40:43], a[116:119]
  s_sub_u32 s32, s32, 1
  v_exp_f32 v125, v125
  v_mfma_f32_16x16x32_bf16 a[116:119], a[184:187], v[8:11], a[116:119]
  v_cvt_pk_bf16_f32 v122, v124, v125
  v_mfma_f32_16x16x32_bf16 a[120:123], a[184:187], v[16:19], a[120:123]
  s_cmp_lg_u32 s32, 0
  v_exp_f32 v126, v126
  v_mfma_f32_16x16x32_bf16 a[120:123], a[188:191], v[48:51], a[120:123]
  v_mfma_f32_16x16x32_bf16 a[124:127], a[188:191], v[56:59], a[124:127]
  s_waitcnt lgkmcnt(0)
  v_exp_f32 v127, v127
  v_mfma_f32_16x16x32_bf16 a[124:127], a[184:187], v[24:27], a[124:127]
  v_cvt_pk_bf16_f32 v123, v126, v127
  s_cbranch_scc1 attn_loop
  s_waitcnt vmcnt(1)
  v_readfirstlane_b32 s38, v254
  s_nop 0
  s_cmp_ge_u32 s38, 512
  s_cbranch_scc1 attn_h_ready
  s_mov_b32 s39, 32768
attn_spin:
  s_sleep 4
  buffer_load_dword v254, off, s[24:27], s47 sc1
  s_waitcnt vmcnt(0)
  v_readfirstlane_b32 s38, v254
  s_nop 0
  s_cmp_ge_u32 s38, 512
  s_cbranch_scc1 attn_h_ready
  s_sub_u32 s39, s39, 1
  s_cmp_lg_u32 s39, 0
  s_cbranch_scc1 attn_spin
attn_h_ready:
  v_mfma_f32_16x16x32_bf16 v[0:3], a[128:131], v[128:131], v[192:195]
  s_add_u32 m0, s28, 81920
  s_and_b32 s38, s2, 1
  s_lshl_b32 s38, s38, 2
  v_lshrrev_b32 v224, 4, v242
  v_and_b32 v225, 7, v224
  v_mfma_f32_16x16x32_bf16 v[0:3], a[132:135], v[132:135], v[0:3]
  ds_read_b128 a[144:147], v212 offset:4096
  s_add_u32 s38, s38, s3
  s_mul_i32 s38, s38, 81920
  s_lshr_b32 s39, s2, 5
  v_mul_u32_u24 v225, 0xd80, v225
  v_mfma_f32_16x16x32_bf16 v[0:3], a[136:139], v[136:139], v[0:3]
  buffer_load_dwordx4 v236, s[16:19], s29 offen offset:0 lds
  s_mul_i32 s39, s39, 655360
  s_add_u32 s38, s38, s39
  s_add_u32 s4, s38, 3145728
  v_mfma_f32_16x16x32_bf16 v[0:3], a[140:143], v[140:143], v[0:3]
  ds_read_b128 a[148:151], v213 offset:4096
  s_add_u32 s5, s4, 12288
  s_add_u32 s6, s4, 24576
  s_add_u32 s7, s4, 36864
  v_lshrrev_b32 v224, 4, v224
  v_mfma_f32_16x16x32_bf16 v[8:11], a[140:143], v[156:159], v[196:199]
  s_add_u32 s8, s4, 49152
  s_add_u32 s9, s4, 61440
  s_add_u32 s10, s4, 73728
  v_lshl_add_u32 v225, v224, 4, v225
  v_add_u32 v252, 4096, v242
  v_mfma_f32_16x16x32_bf16 v[8:11], a[136:139], v[152:155], v[8:11]
  ds_read_b128 a[152:155], v214 offset:4096
  buffer_load_dwordx4 a[212:215], v225, s[24:27], s101 offen offset:0 sc1
  v_mfma_f32_16x16x32_bf16 v[8:11], a[132:135], v[148:151], v[8:11]
  buffer_load_dwordx4 v237, s[16:19], s29 offen offset:1024 lds
  v_mfma_f32_16x16x32_bf16 v[8:11], a[128:131], v[144:147], v[8:11]
  ds_read_b128 a[156:159], v215 offset:4096
  buffer_load_dwordx4 a[216:219], v225, s[24:27], s101 offen offset:64 sc1
  v_mfma_f32_16x16x32_bf16 v[16:19], a[128:131], v[160:163], v[200:203]
  v_exp_f32 v0, v0
  v_mfma_f32_16x16x32_bf16 v[16:19], a[132:135], v[164:167], v[16:19]
  buffer_load_dwordx4 a[220:223], v225, s[24:27], s101 offen offset:128 sc1
  v_mfma_f32_16x16x32_bf16 v[16:19], a[136:139], v[168:171], v[16:19]
  v_exp_f32 v1, v1
  v_mfma_f32_16x16x32_bf16 v[16:19], a[140:143], v[172:175], v[16:19]
  v_cvt_pk_bf16_f32 v0, v0, v1
  v_add_u32 v253, 8192, v242
  v_mfma_f32_16x16x32_bf16 v[24:27], a[140:143], v[188:191], v[204:207]
  v_exp_f32 v2, v2
  v_mfma_f32_16x16x32_bf16 v[24:27], a[136:139], v[184:187], v[24:27]
  buffer_load_dwordx4 v236, s[16:19], s29 offen offset:2048 lds
  v_mfma_f32_16x16x32_bf16 v[24:27], a[132:135], v[180:183], v[24:27]
  s_waitcnt lgkmcnt(0)
  v_exp_f32 v3, v3
  v_mfma_f32_16x16x32_bf16 v[24:27], a[128:131], v[176:179], v[24:27]
  v_cvt_pk_bf16_f32 v1, v2, v3
  v_mfma_f32_16x16x32_bf16 v[4:7], a[144:147], v[128:131], v[192:195]
  v_exp_f32 v8, v8
  v_mfma_f32_16x16x32_bf16 v[4:7], a[148:151], v[132:135], v[4:7]
  ds_read_b128 a[128:131], v212 offset:8192
  v_mfma_f32_16x16x32_bf16 v[4:7], a[152:155], v[136:139], v[4:7]
  v_exp_f32 v9, v9
  v_mfma_f32_16x16x32_bf16 v[4:7], a[156:159], v[140:143], v[4:7]
  ds_read_b128 a[132:135], v213 offset:8192
  v_cvt_pk_bf16_f32 v8, v8, v9
  v_mfma_f32_16x16x32_bf16 v[12:15], a[156:159], v[156:159], v[196:199]
  v_exp_f32 v10, v10
  v_mfma_f32_16x16x32_bf16 v[12:15], a[152:155], v[152:155], v[12:15]
  ds_read_b128 a[136:139], v214 offset:8192
  v_mfma_f32_16x16x32_bf16 v[12:15], a[148:151], v[148:151], v[12:15]
  v_exp_f32 v11, v11
  v_mfma_f32_16x16x32_bf16 v[12:15], a[144:147], v[144:147], v[12:15]
  ds_read_b128 a[140:143], v215 offset:8192
  v_cvt_pk_bf16_f32 v9, v10, v11
  v_mfma_f32_16x16x32_bf16 v[20:23], a[144:147], v[160:163], v[200:203]
  v_exp_f32 v16, v16
  v_mfma_f32_16x16x32_bf16 v[20:23], a[148:151], v[164:167], v[20:23]
  buffer_load_dwordx4 v237, s[16:19], s29 offen offset:3072 lds
  v_mfma_f32_16x16x32_bf16 v[20:23], a[152:155], v[168:171], v[20:23]
  s_add_u32 s29, s29, 16384
  v_exp_f32 v17, v17
  v_mfma_f32_16x16x32_bf16 v[20:23], a[156:159], v[172:175], v[20:23]
  v_cvt_pk_bf16_f32 v16, v16, v17
  v_mfma_f32_16x16x32_bf16 v[28:31], a[156:159], v[188:191], v[204:207]
  s_add_u32 m0, s28, 32768
  v_exp_f32 v18, v18
  v_mfma_f32_16x16x32_bf16 v[28:31], a[152:155], v[184:187], v[28:31]
  buffer_load_dwordx4 v232, s[12:15], s29 offen offset:0 lds
  v_mfma_f32_16x16x32_bf16 v[28:31], a[148:151], v[180:183], v[28:31]
  s_waitcnt lgkmcnt(0)
  v_exp_f32 v19, v19
  v_mfma_f32_16x16x32_bf16 v[28:31], a[144:147], v[176:179], v[28:31]
  v_cvt_pk_bf16_f32 v17, v18, v19
  v_mfma_f32_16x16x32_bf16 v[32:35], a[128:131], v[128:131], v[192:195]
  v_exp_f32 v24, v24
  v_mfma_f32_16x16x32_bf16 v[32:35], a[132:135], v[132:135], v[32:35]
  ds_read_b128 a[144:147], v212 offset:12288
  v_mfma_f32_16x16x32_bf16 v[32:35], a[136:139], v[136:139], v[32:35]
  v_exp_f32 v25, v25
  v_mfma_f32_16x16x32_bf16 v[32:35], a[140:143], v[140:143], v[32:35]
  ds_read_b128 a[148:151], v213 offset:12288
  v_cvt_pk_bf16_f32 v24, v24, v25
  v_mfma_f32_16x16x32_bf16 v[40:43], a[140:143], v[156:159], v[196:199]
  v_exp_f32 v26, v26
  v_mfma_f32_16x16x32_bf16 v[40:43], a[136:139], v[152:155], v[40:43]
  ds_read_b128 a[152:155], v214 offset:12288
  v_mfma_f32_16x16x32_bf16 v[40:43], a[132:135], v[148:151], v[40:43]
  v_exp_f32 v27, v27
  v_mfma_f32_16x16x32_bf16 v[40:43], a[128:131], v[144:147], v[40:43]
  ds_read_b128 a[156:159], v215 offset:12288
  v_cvt_pk_bf16_f32 v25, v26, v27
  v_mfma_f32_16x16x32_bf16 v[48:51], a[128:131], v[160:163], v[200:203]
  v_exp_f32 v4, v4
  v_mfma_f32_16x16x32_bf16 v[48:51], a[132:135], v[164:167], v[48:51]
  buffer_load_dwordx4 v233, s[12:15], s29 offen offset:1024 lds
  v_mfma_f32_16x16x32_bf16 v[48:51], a[136:139], v[168:171], v[48:51]
  v_exp_f32 v5, v5
  v_mfma_f32_16x16x32_bf16 v[48:51], a[140:143], v[172:175], v[48:51]
  v_cvt_pk_bf16_f32 v2, v4, v5
  v_mfma_f32_16x16x32_bf16 v[56:59], a[140:143], v[188:191], v[204:207]
  v_exp_f32 v6, v6
  v_mfma_f32_16x16x32_bf16 v[56:59], a[136:139], v[184:187], v[56:59]
  buffer_load_dwordx4 v234, s[12:15], s29 offen offset:2048 lds
  v_mfma_f32_16x16x32_bf16 v[56:59], a[132:135], v[180:183], v[56:59]
  s_waitcnt lgkmcnt(0)
  v_exp_f32 v7, v7
  v_mfma_f32_16x16x32_bf16 v[56:59], a[128:131], v[176:179], v[56:59]
  v_cvt_pk_bf16_f32 v3, v6, v7
  v_mfma_f32_16x16x32_bf16 v[36:39], a[144:147], v[128:131], v[192:195]
  v_exp_f32 v12, v12
  v_mfma_f32_16x16x32_bf16 v[36:39], a[148:151], v[132:135], v[36:39]
  ds_read_b64_tr_b16 a[160:161], v216 offset:49152
  v_mfma_f32_16x16x32_bf16 v[36:39], a[152:155], v[136:139], v[36:39]
  v_exp_f32 v13, v13
  v_mfma_f32_16x16x32_bf16 v[36:39], a[156:159], v[140:143], v[36:39]
  ds_read_b64_tr_b16 a[162:163], v216 offset:53248
  v_cvt_pk_bf16_f32 v10, v12, v13
  v_mfma_f32_16x16x32_bf16 v[44:47], a[156:159], v[156:159], v[196:199]
  v_exp_f32 v14, v14
  v_mfma_f32_16x16x32_bf16 v[44:47], a[152:155], v[152:155], v[44:47]
  ds_read_b64_tr_b16 a[164:165], v216 offset:57344
  buffer_load_dwordx4 v235, s[12:15], s29 offen offset:3072 lds
  v_mfma_f32_16x16x32_bf16 v[44:47], a[148:151], v[148:151], v[44:47]
  v_exp_f32 v15, v15
  v_mfma_f32_16x16x32_bf16 v[44:47], a[144:147], v[144:147], v[44:47]
  ds_read_b64_tr_b16 a[166:167], v216 offset:61440
  v_cvt_pk_bf16_f32 v11, v14, v15
  v_mfma_f32_16x16x32_bf16 v[52:55], a[144:147], v[160:163], v[200:203]
  v_exp_f32 v20, v20
  v_mfma_f32_16x16x32_bf16 v[52:55], a[148:151], v[164:167], v[52:55]
  ds_read_b64_tr_b16 a[168:169], v217 offset:49152
  v_mfma_f32_16x16x32_bf16 v[52:55], a[152:155], v[168:171], v[52:55]
  v_exp_f32 v21, v21
  v_mfma_f32_16x16x32_bf16 v[52:55], a[156:159], v[172:175], v[52:55]
  ds_read_b64_tr_b16 a[170:171], v217 offset:53248
  v_cvt_pk_bf16_f32 v18, v20, v21
  v_mfma_f32_16x16x32_bf16 v[60:63], a[156:159], v[188:191], v[204:207]
  v_exp_f32 v22, v22
  v_mfma_f32_16x16x32_bf16 v[60:63], a[152:155], v[184:187], v[60:63]
  ds_read_b64_tr_b16 a[172:173], v217 offset:57344
  v_mfma_f32_16x16x32_bf16 v[60:63], a[148:151], v[180:183], v[60:63]
  v_exp_f32 v23, v23
  v_mfma_f32_16x16x32_bf16 v[60:63], a[144:147], v[176:179], v[60:63]
  ds_read_b64_tr_b16 a[174:175], v217 offset:61440
  v_cvt_pk_bf16_f32 v19, v22, v23
  v_mfma_f32_16x16x32_bf16 a[192:195], a[208:211], v[64:67], a[192:195]
  v_exp_f32 v28, v28
  v_mfma_f32_16x16x32_bf16 a[192:195], a[208:211], v[96:99], a[192:195]
  ds_read_b64_tr_b16 a[176:177], v218 offset:49152
  v_mfma_f32_16x16x32_bf16 a[196:199], a[208:211], v[72:75], a[196:199]
  v_exp_f32 v29, v29
  v_mfma_f32_16x16x32_bf16 a[196:199], a[208:211], v[104:107], a[196:199]
  ds_read_b64_tr_b16 a[178:179], v218 offset:53248
  v_cvt_pk_bf16_f32 v26, v28, v29
  v_mfma_f32_16x16x32_bf16 a[200:203], a[208:211], v[80:83], a[200:203]
  v_exp_f32 v30, v30
  v_mfma_f32_16x16x32_bf16 a[200:203], a[208:211], v[112:115], a[200:203]
  ds_read_b64_tr_b16 a[180:181], v218 offset:57344
  v_mfma_f32_16x16x32_bf16 a[204:207], a[208:211], v[88:91], a[204:207]
  s_waitcnt lgkmcnt(7)
  v_exp_f32 v31, v31
  v_mfma_f32_16x16x32_bf16 a[204:207], a[208:211], v[120:123], a[204:207]
  ds_read_b64_tr_b16 a[182:183], v218 offset:61440
  v_cvt_pk_bf16_f32 v27, v30, v31
  v_mfma_f32_16x16x32_bf16 a[0:3], a[160:163], v[64:67], a[0:3]
  v_exp_f32 v32, v32
  v_mfma_f32_16x16x32_bf16 a[0:3], a[164:167], v[96:99], a[0:3]
  ds_read_b64_tr_b16 a[184:185], v219 offset:49152
  v_mfma_f32_16x16x32_bf16 a[4:7], a[164:167], v[104:107], a[4:7]
  v_exp_f32 v33, v33
  v_mfma_f32_16x16x32_bf16 a[4:7], a[160:163], v[72:75], a[4:7]
  ds_read_b64_tr_b16 a[186:187], v219 offset:53248
  v_cvt_pk_bf16_f32 v32, v32, v33
  v_mfma_f32_16x16x32_bf16 a[8:11], a[160:163], v[80:83], a[8:11]
  v_exp_f32 v34, v34
  v_mfma_f32_16x16x32_bf16 a[8:11], a[164:167], v[112:115], a[8:11]
  ds_read_b64_tr_b16 a[188:189], v219 offset:57344
  v_mfma_f32_16x16x32_bf16 a[12:15], a[164:167], v[120:123], a[12:15]
  s_waitcnt lgkmcnt(7)
  v_exp_f32 v35, v35
  v_mfma_f32_16x16x32_bf16 a[12:15], a[160:163], v[88:91], a[12:15]
  ds_read_b64_tr_b16 a[190:191], v219 offset:61440
  v_cvt_pk_bf16_f32 v33, v34, v35
  v_mfma_f32_16x16x32_bf16 a[16:19], a[168:171], v[64:67], a[16:19]
  v_exp_f32 v40, v40
  v_mfma_f32_16x16x32_bf16 a[16:19], a[172:175], v[96:99], a[16:19]
  ds_read_b64_tr_b16 a[160:161], v220 offset:49152
  v_mfma_f32_16x16x32_bf16 a[20:23], a[172:175], v[104:107], a[20:23]
  v_exp_f32 v41, v41
  v_mfma_f32_16x16x32_bf16 a[20:23], a[168:171], v[72:75], a[20:23]
  ds_read_b64_tr_b16 a[162:163], v220 offset:53248
  v_cvt_pk_bf16_f32 v40, v40, v41
  v_mfma_f32_16x16x32_bf16 a[24:27], a[168:171], v[80:83], a[24:27]
  v_exp_f32 v42, v42
  v_mfma_f32_16x16x32_bf16 a[24:27], a[172:175], v[112:115], a[24:27]
  ds_read_b64_tr_b16 a[164:165], v220 offset:57344
  v_mfma_f32_16x16x32_bf16 a[28:31], a[172:175], v[120:123], a[28:31]
  s_waitcnt lgkmcnt(7)
  v_exp_f32 v43, v43
  v_mfma_f32_16x16x32_bf16 a[28:31], a[168:171], v[88:91], a[28:31]
  ds_read_b64_tr_b16 a[166:167], v220 offset:61440
  v_cvt_pk_bf16_f32 v41, v42, v43
  v_mfma_f32_16x16x32_bf16 a[32:35], a[176:179], v[64:67], a[32:35]
  v_exp_f32 v48, v48
  v_mfma_f32_16x16x32_bf16 a[32:35], a[180:183], v[96:99], a[32:35]
  ds_read_b64_tr_b16 a[168:169], v221 offset:49152
  v_mfma_f32_16x16x32_bf16 a[36:39], a[180:183], v[104:107], a[36:39]
  v_exp_f32 v49, v49
  v_mfma_f32_16x16x32_bf16 a[36:39], a[176:179], v[72:75], a[36:39]
  ds_read_b64_tr_b16 a[170:171], v221 offset:53248
  v_cvt_pk_bf16_f32 v48, v48, v49
  v_mfma_f32_16x16x32_bf16 a[40:43], a[176:179], v[80:83], a[40:43]
  v_exp_f32 v50, v50
  v_mfma_f32_16x16x32_bf16 a[40:43], a[180:183], v[112:115], a[40:43]
  ds_read_b64_tr_b16 a[172:173], v221 offset:57344
  v_mfma_f32_16x16x32_bf16 a[44:47], a[180:183], v[120:123], a[44:47]
  s_waitcnt lgkmcnt(7)
  v_exp_f32 v51, v51
  v_mfma_f32_16x16x32_bf16 a[44:47], a[176:179], v[88:91], a[44:47]
  ds_read_b64_tr_b16 a[174:175], v221 offset:61440
  v_cvt_pk_bf16_f32 v49, v50, v51
  v_mfma_f32_16x16x32_bf16 a[48:51], a[184:187], v[64:67], a[48:51]
  v_exp_f32 v56, v56
  v_mfma_f32_16x16x32_bf16 a[48:51], a[188:191], v[96:99], a[48:51]
  ds_read_b64_tr_b16 a[176:177], v222 offset:49152
  v_mfma_f32_16x16x32_bf16 a[52:55], a[188:191], v[104:107], a[52:55]
  v_exp_f32 v57, v57
  v_mfma_f32_16x16x32_bf16 a[52:55], a[184:187], v[72:75], a[52:55]
  ds_read_b64_tr_b16 a[178:179], v222 offset:53248
  v_cvt_pk_bf16_f32 v56, v56, v57
  v_mfma_f32_16x16x32_bf16 a[56:59], a[184:187], v[80:83], a[56:59]
  v_exp_f32 v58, v58
  v_mfma_f32_16x16x32_bf16 a[56:59], a[188:191], v[112:115], a[56:59]
  ds_read_b64_tr_b16 a[180:181], v222 offset:57344
  v_mfma_f32_16x16x32_bf16 a[60:63], a[188:191], v[120:123], a[60:63]
  s_waitcnt lgkmcnt(7)
  v_exp_f32 v59, v59
  v_mfma_f32_16x16x32_bf16 a[60:63], a[184:187], v[88:91], a[60:63]
  ds_read_b64_tr_b16 a[182:183], v222 offset:61440
  v_cvt_pk_bf16_f32 v57, v58, v59
  v_mfma_f32_16x16x32_bf16 a[64:67], a[160:163], v[64:67], a[64:67]
  v_exp_f32 v36, v36
  v_mfma_f32_16x16x32_bf16 a[64:67], a[164:167], v[96:99], a[64:67]
  ds_read_b64_tr_b16 a[184:185], v223 offset:49152
  v_mfma_f32_16x16x32_bf16 a[68:71], a[164:167], v[104:107], a[68:71]
  v_exp_f32 v37, v37
  v_mfma_f32_16x16x32_bf16 a[68:71], a[160:163], v[72:75], a[68:71]
  ds_read_b64_tr_b16 a[186:187], v223 offset:53248
  v_cvt_pk_bf16_f32 v34, v36, v37
  v_mfma_f32_16x16x32_bf16 a[72:75], a[160:163], v[80:83], a[72:75]
  v_exp_f32 v38, v38
  v_mfma_f32_16x16x32_bf16 a[72:75], a[164:167], v[112:115], a[72:75]
  ds_read_b64_tr_b16 a[188:189], v223 offset:57344
  v_mfma_f32_16x16x32_bf16 a[76:79], a[164:167], v[120:123], a[76:79]
  s_waitcnt lgkmcnt(7)
  v_exp_f32 v39, v39
  v_mfma_f32_16x16x32_bf16 a[76:79], a[160:163], v[88:91], a[76:79]
  ds_read_b64_tr_b16 a[190:191], v223 offset:61440
  v_cvt_pk_bf16_f32 v35, v38, v39
  v_mfma_f32_16x16x32_bf16 a[80:83], a[168:171], v[64:67], a[80:83]
  v_exp_f32 v44, v44
  v_mfma_f32_16x16x32_bf16 a[80:83], a[172:175], v[96:99], a[80:83]
  v_mfma_f32_16x16x32_bf16 a[84:87], a[172:175], v[104:107], a[84:87]
  s_barrier
  v_exp_f32 v45, v45
  v_mfma_f32_16x16x32_bf16 a[84:87], a[168:171], v[72:75], a[84:87]
  ds_read_b128 a[128:131], v212 offset:16384
  v_cvt_pk_bf16_f32 v42, v44, v45
  v_mfma_f32_16x16x32_bf16 a[88:91], a[168:171], v[80:83], a[88:91]
  v_exp_f32 v46, v46
  v_mfma_f32_16x16x32_bf16 a[88:91], a[172:175], v[112:115], a[88:91]
  ds_read_b128 a[132:135], v213 offset:16384
  v_mfma_f32_16x16x32_bf16 a[92:95], a[172:175], v[120:123], a[92:95]
  s_waitcnt lgkmcnt(6)
  v_exp_f32 v47, v47
  v_mfma_f32_16x16x32_bf16 a[92:95], a[168:171], v[88:91], a[92:95]
  ds_read_b128 a[136:139], v214 offset:16384
  v_cvt_pk_bf16_f32 v43, v46, v47
  v_mfma_f32_16x16x32_bf16 a[96:99], a[176:179], v[64:67], a[96:99]
  v_exp_f32 v52, v52
  v_mfma_f32_16x16x32_bf16 a[96:99], a[180:183], v[96:99], a[96:99]
  ds_read_b128 a[140:143], v215 offset:16384
  v_mfma_f32_16x16x32_bf16 a[100:103], a[180:183], v[104:107], a[100:103]
  v_exp_f32 v53, v53
  v_mfma_f32_16x16x32_bf16 a[100:103], a[176:179], v[72:75], a[100:103]
  v_cvt_pk_bf16_f32 v50, v52, v53
  v_mfma_f32_16x16x32_bf16 a[104:107], a[176:179], v[80:83], a[104:107]
  v_exp_f32 v54, v54
  v_mfma_f32_16x16x32_bf16 a[104:107], a[180:183], v[112:115], a[104:107]
  v_mfma_f32_16x16x32_bf16 a[108:111], a[180:183], v[120:123], a[108:111]
  s_waitcnt lgkmcnt(4)
  v_exp_f32 v55, v55
  v_mfma_f32_16x16x32_bf16 a[108:111], a[176:179], v[88:91], a[108:111]
  v_cvt_pk_bf16_f32 v51, v54, v55
  v_mfma_f32_16x16x32_bf16 a[112:115], a[184:187], v[64:67], a[112:115]
  v_exp_f32 v60, v60
  v_mfma_f32_16x16x32_bf16 a[112:115], a[188:191], v[96:99], a[112:115]
  v_mfma_f32_16x16x32_bf16 a[116:119], a[188:191], v[104:107], a[116:119]
  v_exp_f32 v61, v61
  v_mfma_f32_16x16x32_bf16 a[116:119], a[184:187], v[72:75], a[116:119]
  v_cvt_pk_bf16_f32 v58, v60, v61
  v_mfma_f32_16x16x32_bf16 a[120:123], a[184:187], v[80:83], a[120:123]
  v_exp_f32 v62, v62
  v_mfma_f32_16x16x32_bf16 a[120:123], a[188:191], v[112:115], a[120:123]
  v_mfma_f32_16x16x32_bf16 a[124:127], a[188:191], v[120:123], a[124:127]
  s_waitcnt lgkmcnt(0)
  v_exp_f32 v63, v63
  v_mfma_f32_16x16x32_bf16 a[124:127], a[184:187], v[88:91], a[124:127]
  v_cvt_pk_bf16_f32 v59, v62, v63
  v_mfma_f32_16x16x32_bf16 v[64:67], a[128:131], v[128:131], v[192:195]
  s_add_u32 m0, s28, 98304
  v_mfma_f32_16x16x32_bf16 v[64:67], a[132:135], v[132:135], v[64:67]
  ds_read_b128 a[144:147], v212 offset:20480
  v_mfma_f32_16x16x32_bf16 v[64:67], a[136:139], v[136:139], v[64:67]
  buffer_load_dwordx4 v236, s[16:19], s29 offen offset:0 lds
  v_mfma_f32_16x16x32_bf16 v[64:67], a[140:143], v[140:143], v[64:67]
  ds_read_b128 a[148:151], v213 offset:20480
  v_mfma_f32_16x16x32_bf16 v[72:75], a[140:143], v[156:159], v[196:199]
  v_mfma_f32_16x16x32_bf16 v[72:75], a[136:139], v[152:155], v[72:75]
  ds_read_b128 a[152:155], v214 offset:20480
  v_mfma_f32_16x16x32_bf16 v[72:75], a[132:135], v[148:151], v[72:75]
  buffer_load_dwordx4 v237, s[16:19], s29 offen offset:1024 lds
  v_mfma_f32_16x16x32_bf16 v[72:75], a[128:131], v[144:147], v[72:75]
  ds_read_b128 a[156:159], v215 offset:20480
  v_mfma_f32_16x16x32_bf16 v[80:83], a[128:131], v[160:163], v[200:203]
  v_exp_f32 v64, v64
  v_mfma_f32_16x16x32_bf16 v[80:83], a[132:135], v[164:167], v[80:83]
  v_mfma_f32_16x16x32_bf16 v[80:83], a[136:139], v[168:171], v[80:83]
  v_exp_f32 v65, v65
  v_mfma_f32_16x16x32_bf16 v[80:83], a[140:143], v[172:175], v[80:83]
  v_cvt_pk_bf16_f32 v64, v64, v65
  v_mfma_f32_16x16x32_bf16 v[88:91], a[140:143], v[188:191], v[204:207]
  v_exp_f32 v66, v66
  v_mfma_f32_16x16x32_bf16 v[88:91], a[136:139], v[184:187], v[88:91]
  buffer_load_dwordx4 v236, s[16:19], s29 offen offset:2048 lds
  v_mfma_f32_16x16x32_bf16 v[88:91], a[132:135], v[180:183], v[88:91]
  s_waitcnt lgkmcnt(0)
  v_exp_f32 v67, v67
  v_mfma_f32_16x16x32_bf16 v[88:91], a[128:131], v[176:179], v[88:91]
  v_cvt_pk_bf16_f32 v65, v66, v67
  v_mfma_f32_16x16x32_bf16 v[68:71], a[144:147], v[128:131], v[192:195]
  v_exp_f32 v72, v72
  v_mfma_f32_16x16x32_bf16 v[68:71], a[148:151], v[132:135], v[68:71]
  ds_read_b128 a[128:131], v212 offset:24576
  v_mfma_f32_16x16x32_bf16 v[68:71], a[152:155], v[136:139], v[68:71]
  v_exp_f32 v73, v73
  v_mfma_f32_16x16x32_bf16 v[68:71], a[156:159], v[140:143], v[68:71]
  ds_read_b128 a[132:135], v213 offset:24576
  v_cvt_pk_bf16_f32 v72, v72, v73
  v_mfma_f32_16x16x32_bf16 v[76:79], a[156:159], v[156:159], v[196:199]
  v_exp_f32 v74, v74
  v_mfma_f32_16x16x32_bf16 v[76:79], a[152:155], v[152:155], v[76:79]
  ds_read_b128 a[136:139], v214 offset:24576
  v_lshrrev_b32 v224, 4, v242
  v_mfma_f32_16x16x32_bf16 v[76:79], a[148:151], v[148:151], v[76:79]
  v_exp_f32 v75, v75
  v_mfma_f32_16x16x32_bf16 v[76:79], a[144:147], v[144:147], v[76:79]
  ds_read_b128 a[140:143], v215 offset:24576
  v_cvt_pk_bf16_f32 v73, v74, v75
  v_mfma_f32_16x16x32_bf16 v[84:87], a[144:147], v[160:163], v[200:203]
  v_exp_f32 v80, v80
  v_mfma_f32_16x16x32_bf16 v[84:87], a[148:151], v[164:167], v[84:87]
  buffer_load_dwordx4 v237, s[16:19], s29 offen offset:3072 lds
  v_mfma_f32_16x16x32_bf16 v[84:87], a[152:155], v[168:171], v[84:87]
  s_add_u32 s29, s29, 16384
  v_exp_f32 v81, v81
  v_mfma_f32_16x16x32_bf16 v[84:87], a[156:159], v[172:175], v[84:87]
  v_cvt_pk_bf16_f32 v80, v80, v81
  v_lshrrev_b32 v225, 4, v224
  v_mfma_f32_16x16x32_bf16 v[92:95], a[156:159], v[188:191], v[204:207]
  s_add_u32 m0, s28, 49152
  v_exp_f32 v82, v82
  v_mfma_f32_16x16x32_bf16 v[92:95], a[152:155], v[184:187], v[92:95]
  buffer_load_dwordx4 v232, s[12:15], s29 offen offset:0 lds
  v_mfma_f32_16x16x32_bf16 v[92:95], a[148:151], v[180:183], v[92:95]
  s_waitcnt lgkmcnt(0)
  v_exp_f32 v83, v83
  v_mfma_f32_16x16x32_bf16 v[92:95], a[144:147], v[176:179], v[92:95]
  v_cvt_pk_bf16_f32 v81, v82, v83
  v_bfe_u32 v226, v224, 2, 2
  v_mfma_f32_16x16x32_bf16 v[96:99], a[128:131], v[128:131], v[192:195]
  v_exp_f32 v88, v88
  v_mfma_f32_16x16x32_bf16 v[96:99], a[132:135], v[132:135], v[96:99]
  ds_read_b128 a[144:147], v212 offset:28672
  v_lshl_add_u32 v225, v225, 3, v226
  v_mfma_f32_16x16x32_bf16 v[96:99], a[136:139], v[136:139], v[96:99]
  v_exp_f32 v89, v89
  v_mfma_f32_16x16x32_bf16 v[96:99], a[140:143], v[140:143], v[96:99]
  ds_read_b128 a[148:151], v213 offset:28672
  v_cvt_pk_bf16_f32 v88, v88, v89
  v_mfma_f32_16x16x32_bf16 v[104:107], a[140:143], v[156:159], v[196:199]
  v_exp_f32 v90, v90
  v_mfma_f32_16x16x32_bf16 v[104:107], a[136:139], v[152:155], v[104:107]
  ds_read_b128 a[152:155], v214 offset:28672
  v_lshlrev_b32 v225, 5, v225
  v_mfma_f32_16x16x32_bf16 v[104:107], a[132:135], v[148:151], v[104:107]
  v_exp_f32 v91, v91
  v_mfma_f32_16x16x32_bf16 v[104:107], a[128:131], v[144:147], v[104:107]
  ds_read_b128 a[156:159], v215 offset:28672
  v_cvt_pk_bf16_f32 v89, v90, v91
  v_mfma_f32_16x16x32_bf16 v[112:115], a[128:131], v[160:163], v[200:203]
  v_exp_f32 v68, v68
  v_mfma_f32_16x16x32_bf16 v[112:115], a[132:135], v[164:167], v[112:115]
  buffer_load_dwordx4 v233, s[12:15], s29 offen offset:1024 lds
  v_mfma_f32_16x16x32_bf16 v[112:115], a[136:139], v[168:171], v[112:115]
  v_exp_f32 v69, v69
  v_mfma_f32_16x16x32_bf16 v[112:115], a[140:143], v[172:175], v[112:115]
  v_cvt_pk_bf16_f32 v66, v68, v69
  v_and_b32 v226, 3, v224
  v_mfma_f32_16x16x32_bf16 v[120:123], a[140:143], v[188:191], v[204:207]
  v_exp_f32 v70, v70
  v_mfma_f32_16x16x32_bf16 v[120:123], a[136:139], v[184:187], v[120:123]
  buffer_load_dwordx4 v234, s[12:15], s29 offen offset:2048 lds
  v_mfma_f32_16x16x32_bf16 v[120:123], a[132:135], v[180:183], v[120:123]
  s_waitcnt lgkmcnt(0)
  v_exp_f32 v71, v71
  v_mfma_f32_16x16x32_bf16 v[120:123], a[128:131], v[176:179], v[120:123]
  v_cvt_pk_bf16_f32 v67, v70, v71
  v_lshl_add_u32 v225, v226, 3, v225
  v_mfma_f32_16x16x32_bf16 v[100:103], a[144:147], v[128:131], v[192:195]
  v_exp_f32 v76, v76
  v_mfma_f32_16x16x32_bf16 v[100:103], a[148:151], v[132:135], v[100:103]
  ds_read_b64_tr_b16 a[160:161], v216 offset:0
  v_add_u32 v225, s50, v225
  v_mfma_f32_16x16x32_bf16 v[100:103], a[152:155], v[136:139], v[100:103]
  s_waitcnt vmcnt(13)
  v_exp_f32 v77, v77
  v_mfma_f32_16x16x32_bf16 v[100:103], a[156:159], v[140:143], v[100:103]
  ds_read_b64_tr_b16 a[162:163], v216 offset:4096
  v_cvt_pk_bf16_f32 v74, v76, v77
  v_mfma_f32_16x16x32_bf16 v[108:111], a[156:159], v[156:159], v[196:199]
  v_exp_f32 v78, v78
  v_mfma_f32_16x16x32_bf16 v[108:111], a[152:155], v[152:155], v[108:111]
  ds_read_b64_tr_b16 a[164:165], v216 offset:8192
  buffer_load_dwordx4 v235, s[12:15], s29 offen offset:3072 lds
  v_mfma_f32_16x16x32_bf16 v[108:111], a[148:151], v[148:151], v[108:111]
  v_exp_f32 v79, v79
  v_mfma_f32_16x16x32_bf16 v[108:111], a[144:147], v[144:147], v[108:111]
  ds_read_b64_tr_b16 a[166:167], v216 offset:12288
  v_cvt_pk_bf16_f32 v75, v78, v79
  v_mfma_f32_16x16x32_bf16 v[116:119], a[144:147], v[160:163], v[200:203]
  v_exp_f32 v84, v84
  v_mfma_f32_16x16x32_bf16 v[116:119], a[148:151], v[164:167], v[116:119]
  ds_read_b64_tr_b16 a[168:169], v217 offset:0
  ds_read_b64_tr_b16 a[232:233], v225 offset:0
  s_add_u32 m0, s28, 0
  v_mfma_f32_16x16x32_bf16 v[116:119], a[152:155], v[168:171], v[116:119]
  v_exp_f32 v85, v85
  v_mfma_f32_16x16x32_bf16 v[116:119], a[156:159], v[172:175], v[116:119]
  ds_read_b64_tr_b16 a[170:171], v217 offset:4096
  v_cvt_pk_bf16_f32 v82, v84, v85
  v_mfma_f32_16x16x32_bf16 v[124:127], a[156:159], v[188:191], v[204:207]
  v_exp_f32 v86, v86
  v_mfma_f32_16x16x32_bf16 v[124:127], a[152:155], v[184:187], v[124:127]
  ds_read_b64_tr_b16 a[172:173], v217 offset:8192
  ds_read_b64_tr_b16 a[234:235], v225 offset:128
  v_mfma_f32_16x16x32_bf16 v[124:127], a[148:151], v[180:183], v[124:127]
  v_exp_f32 v87, v87
  v_mfma_f32_16x16x32_bf16 v[124:127], a[144:147], v[176:179], v[124:127]
  ds_read_b64_tr_b16 a[174:175], v217 offset:12288
  v_cvt_pk_bf16_f32 v83, v86, v87
  v_mfma_f32_16x16x32_bf16 a[192:195], a[208:211], v[0:3], a[192:195]
  v_exp_f32 v92, v92
  v_mfma_f32_16x16x32_bf16 a[192:195], a[208:211], v[32:35], a[192:195]
  ds_read_b64_tr_b16 a[176:177], v218 offset:0
  ds_read_b64_tr_b16 a[236:237], v225 offset:1024
  v_mfma_f32_16x16x32_bf16 a[196:199], a[208:211], v[8:11], a[196:199]
  v_exp_f32 v93, v93
  v_mfma_f32_16x16x32_bf16 a[196:199], a[208:211], v[40:43], a[196:199]
  ds_read_b64_tr_b16 a[178:179], v218 offset:4096
  v_cvt_pk_bf16_f32 v90, v92, v93
  v_mfma_f32_16x16x32_bf16 a[200:203], a[208:211], v[16:19], a[200:203]
  v_exp_f32 v94, v94
  v_mfma_f32_16x16x32_bf16 a[200:203], a[208:211], v[48:51], a[200:203]
  ds_read_b64_tr_b16 a[180:181], v218 offset:8192
  ds_read_b64_tr_b16 a[238:239], v225 offset:1152
  v_mfma_f32_16x16x32_bf16 a[204:207], a[208:211], v[24:27], a[204:207]
  s_waitcnt lgkmcnt(11)
  v_exp_f32 v95, v95
  v_mfma_f32_16x16x32_bf16 a[204:207], a[208:211], v[56:59], a[204:207]
  ds_read_b64_tr_b16 a[182:183], v218 offset:12288
  v_cvt_pk_bf16_f32 v91, v94, v95
  v_mfma_f32_16x16x32_bf16 a[0:3], a[160:163], v[0:3], a[0:3]
  v_exp_f32 v96, v96
  v_mfma_f32_16x16x32_bf16 a[0:3], a[164:167], v[32:35], a[0:3]
  ds_read_b64_tr_b16 a[184:185], v219 offset:0
  ds_read_b64_tr_b16 a[240:241], v225 offset:2048
  v_mfma_f32_16x16x32_bf16 a[4:7], a[164:167], v[40:43], a[4:7]
  v_exp_f32 v97, v97
  v_mfma_f32_16x16x32_bf16 a[4:7], a[160:163], v[8:11], a[4:7]
  ds_read_b64_tr_b16 a[186:187], v219 offset:4096
  v_cvt_pk_bf16_f32 v96, v96, v97
  v_mfma_f32_16x16x32_bf16 a[8:11], a[160:163], v[16:19], a[8:11]
  v_exp_f32 v98, v98
  v_mfma_f32_16x16x32_bf16 a[8:11], a[164:167], v[48:51], a[8:11]
  ds_read_b64_tr_b16 a[188:189], v219 offset:8192
  ds_read_b64_tr_b16 a[242:243], v225 offset:2176
  v_mfma_f32_16x16x32_bf16 a[12:15], a[164:167], v[56:59], a[12:15]
  s_waitcnt lgkmcnt(11)
  v_exp_f32 v99, v99
  v_mfma_f32_16x16x32_bf16 a[12:15], a[160:163], v[24:27], a[12:15]
  ds_read_b64_tr_b16 a[190:191], v219 offset:12288
  v_cvt_pk_bf16_f32 v97, v98, v99
  v_mfma_f32_16x16x32_bf16 a[16:19], a[168:171], v[0:3], a[16:19]
  v_exp_f32 v104, v104
  v_mfma_f32_16x16x32_bf16 a[16:19], a[172:175], v[32:35], a[16:19]
  ds_read_b64_tr_b16 a[160:161], v220 offset:0
  buffer_load_dwordx4 v253, s[24:27], s8 offen offset:0 sc1 lds
  v_mfma_f32_16x16x32_bf16 a[20:23], a[172:175], v[40:43], a[20:23]
  v_exp_f32 v105, v105
  v_mfma_f32_16x16x32_bf16 a[20:23], a[168:171], v[8:11], a[20:23]
  ds_read_b64_tr_b16 a[162:163], v220 offset:4096
  v_cvt_pk_bf16_f32 v104, v104, v105
  v_mfma_f32_16x16x32_bf16 a[24:27], a[168:171], v[16:19], a[24:27]
  v_exp_f32 v106, v106
  v_mfma_f32_16x16x32_bf16 a[24:27], a[172:175], v[48:51], a[24:27]
  ds_read_b64_tr_b16 a[164:165], v220 offset:8192
  s_waitcnt lgkmcnt(4)
  buffer_load_dwordx4 v253, s[24:27], s8 offen offset:1024 sc1 lds
  v_mfma_f32_16x16x32_bf16 v[228:231], a[232:235], a[212:215], 0
  v_mfma_f32_16x16x32_bf16 v[228:231], a[236:239], a[216:219], v[228:231]
  v_mfma_f32_16x16x32_bf16 v[228:231], a[240:243], a[220:223], v[228:231]
  v_mfma_f32_16x16x32_bf16 a[28:31], a[172:175], v[56:59], a[28:31]
  s_lshl_b32 s35, s3, 10
  s_add_u32 s35, s35, 159744
  v_exp_f32 v107, v107
  v_mfma_f32_16x16x32_bf16 a[28:31], a[168:171], v[24:27], a[28:31]
  ds_read_b64_tr_b16 a[166:167], v220 offset:12288
  v_cvt_pk_bf16_f32 v105, v106, v107
  v_mfma_f32_16x16x32_bf16 a[32:35], a[176:179], v[0:3], a[32:35]
  v_exp_f32 v112, v112
  v_mfma_f32_16x16x32_bf16 a[32:35], a[180:183], v[32:35], a[32:35]
  ds_read_b64_tr_b16 a[168:169], v221 offset:0
  buffer_load_dwordx4 v253, s[24:27], s8 offen offset:2048 sc1 lds
  v_mfma_f32_16x16x32_bf16 a[36:39], a[180:183], v[40:43], a[36:39]
  v_exp_f32 v113, v113
  v_mfma_f32_16x16x32_bf16 a[36:39], a[176:179], v[8:11], a[36:39]
  ds_read_b64_tr_b16 a[170:171], v221 offset:4096
  v_cvt_pk_bf16_f32 v112, v112, v113
  v_mfma_f32_16x16x32_bf16 a[40:43], a[176:179], v[16:19], a[40:43]
  v_exp_f32 v114, v114
  v_mfma_f32_16x16x32_bf16 a[40:43], a[180:183], v[48:51], a[40:43]
  ds_read_b64_tr_b16 a[172:173], v221 offset:8192
  buffer_load_dwordx4 v253, s[24:27], s8 offen offset:3072 sc1 lds
  v_mfma_f32_16x16x32_bf16 a[44:47], a[180:183], v[56:59], a[44:47]
  s_waitcnt lgkmcnt(7)
  v_exp_f32 v115, v115
  v_mfma_f32_16x16x32_bf16 a[44:47], a[176:179], v[24:27], a[44:47]
  ds_read_b64_tr_b16 a[174:175], v221 offset:12288
  v_cvt_pk_bf16_f32 v113, v114, v115
  v_mfma_f32_16x16x32_bf16 a[48:51], a[184:187], v[0:3], a[48:51]
  v_exp_f32 v120, v120
  v_mfma_f32_16x16x32_bf16 a[48:51], a[188:191], v[32:35], a[48:51]
  ds_read_b64_tr_b16 a[176:177], v222 offset:0
  v_add_u32 v224, s35, v242
  v_mfma_f32_16x16x32_bf16 a[52:55], a[188:191], v[40:43], a[52:55]
  v_exp_f32 v121, v121
  v_mfma_f32_16x16x32_bf16 a[52:55], a[184:187], v[8:11], a[52:55]
  ds_read_b64_tr_b16 a[178:179], v222 offset:4096
  v_cvt_pk_bf16_f32 v120, v120, v121
  v_mfma_f32_16x16x32_bf16 a[56:59], a[184:187], v[16:19], a[56:59]
  v_exp_f32 v122, v122
  v_mfma_f32_16x16x32_bf16 a[56:59], a[188:191], v[48:51], a[56:59]
  ds_read_b64_tr_b16 a[180:181], v222 offset:8192
  ds_write_b128 v224, v[228:231]
  v_mfma_f32_16x16x32_bf16 a[60:63], a[188:191], v[56:59], a[60:63]
  s_waitcnt lgkmcnt(8)
  v_exp_f32 v123, v123
  v_mfma_f32_16x16x32_bf16 a[60:63], a[184:187], v[24:27], a[60:63]
  ds_read_b64_tr_b16 a[182:183], v222 offset:12288
  v_cvt_pk_bf16_f32 v121, v122, v123
  v_mfma_f32_16x16x32_bf16 a[64:67], a[160:163], v[0:3], a[64:67]
  v_exp_f32 v100, v100
  v_mfma_f32_16x16x32_bf16 a[64:67], a[164:167], v[32:35], a[64:67]
  ds_read_b64_tr_b16 a[184:185], v223 offset:0
  v_mfma_f32_16x16x32_bf16 a[68:71], a[164:167], v[40:43], a[68:71]
  v_exp_f32 v101, v101
  v_mfma_f32_16x16x32_bf16 a[68:71], a[160:163], v[8:11], a[68:71]
  ds_read_b64_tr_b16 a[186:187], v223 offset:4096
  v_cvt_pk_bf16_f32 v98, v100, v101
  v_mfma_f32_16x16x32_bf16 a[72:75], a[160:163], v[16:19], a[72:75]
  v_exp_f32 v102, v102
  v_mfma_f32_16x16x32_bf16 a[72:75], a[164:167], v[48:51], a[72:75]
  ds_read_b64_tr_b16 a[188:189], v223 offset:8192
  s_waitcnt lgkmcnt(4)
  v_mfma_f32_16x16x32_bf16 a[76:79], a[164:167], v[56:59], a[76:79]
  v_exp_f32 v103, v103
  v_mfma_f32_16x16x32_bf16 a[76:79], a[160:163], v[24:27], a[76:79]
  ds_read_b64_tr_b16 a[190:191], v223 offset:12288
  v_cvt_pk_bf16_f32 v99, v102, v103
  v_mfma_f32_16x16x32_bf16 a[80:83], a[168:171], v[0:3], a[80:83]
  s_waitcnt vmcnt(12)
  v_exp_f32 v108, v108
  v_mfma_f32_16x16x32_bf16 a[80:83], a[172:175], v[32:35], a[80:83]
  v_mfma_f32_16x16x32_bf16 a[84:87], a[172:175], v[40:43], a[84:87]
  s_barrier
  v_exp_f32 v109, v109
  v_mfma_f32_16x16x32_bf16 a[84:87], a[168:171], v[8:11], a[84:87]
  ds_read_b128 a[128:131], v212 offset:32768
  v_cvt_pk_bf16_f32 v106, v108, v109
  v_mfma_f32_16x16x32_bf16 a[88:91], a[168:171], v[16:19], a[88:91]
  v_exp_f32 v110, v110
  v_mfma_f32_16x16x32_bf16 a[88:91], a[172:175], v[48:51], a[88:91]
  ds_read_b128 a[132:135], v213 offset:32768
  v_mfma_f32_16x16x32_bf16 a[92:95], a[172:175], v[56:59], a[92:95]
  s_waitcnt lgkmcnt(6)
  v_exp_f32 v111, v111
  v_mfma_f32_16x16x32_bf16 a[92:95], a[168:171], v[24:27], a[92:95]
  ds_read_b128 a[136:139], v214 offset:32768
  v_cvt_pk_bf16_f32 v107, v110, v111
  v_mfma_f32_16x16x32_bf16 a[96:99], a[176:179], v[0:3], a[96:99]
  v_exp_f32 v116, v116
  v_mfma_f32_16x16x32_bf16 a[96:99], a[180:183], v[32:35], a[96:99]
  ds_read_b128 a[140:143], v215 offset:32768
  v_mfma_f32_16x16x32_bf16 a[100:103], a[180:183], v[40:43], a[100:103]
  v_exp_f32 v117, v117
  v_mfma_f32_16x16x32_bf16 a[100:103], a[176:179], v[8:11], a[100:103]
  v_cvt_pk_bf16_f32 v114, v116, v117
  v_mfma_f32_16x16x32_bf16 a[104:107], a[176:179], v[16:19], a[104:107]
  v_exp_f32 v118, v118
  v_mfma_f32_16x16x32_bf16 a[104:107], a[180:183], v[48:51], a[104:107]
  v_mfma_f32_16x16x32_bf16 a[108:111], a[180:183], v[56:59], a[108:111]
  s_waitcnt lgkmcnt(4)
  v_exp_f32 v119, v119
  v_mfma_f32_16x16x32_bf16 a[108:111], a[176:179], v[24:27], a[108:111]
  v_cvt_pk_bf16_f32 v115, v118, v119
  v_mfma_f32_16x16x32_bf16 a[112:115], a[184:187], v[0:3], a[112:115]
  v_exp_f32 v124, v124
  v_mfma_f32_16x16x32_bf16 a[112:115], a[188:191], v[32:35], a[112:115]
  v_mfma_f32_16x16x32_bf16 a[116:119], a[188:191], v[40:43], a[116:119]
  v_exp_f32 v125, v125
  v_mfma_f32_16x16x32_bf16 a[116:119], a[184:187], v[8:11], a[116:119]
  v_cvt_pk_bf16_f32 v122, v124, v125
  v_mfma_f32_16x16x32_bf16 a[120:123], a[184:187], v[16:19], a[120:123]
  v_exp_f32 v126, v126
  v_mfma_f32_16x16x32_bf16 a[120:123], a[188:191], v[48:51], a[120:123]
  v_mfma_f32_16x16x32_bf16 a[124:127], a[188:191], v[56:59], a[124:127]
  s_waitcnt lgkmcnt(0)
  v_exp_f32 v127, v127
  v_mfma_f32_16x16x32_bf16 a[124:127], a[184:187], v[24:27], a[124:127]
  v_cvt_pk_bf16_f32 v123, v126, v127
  v_mfma_f32_16x16x32_bf16 v[0:3], a[128:131], v[128:131], v[192:195]
  s_add_u32 m0, s28, 114688
  v_add_u32 v224, 159744, v242
  v_mfma_f32_16x16x32_bf16 v[0:3], a[132:135], v[132:135], v[0:3]
  ds_read_b128 a[144:147], v212 offset:36864
  ds_read_b128 v[228:231], v224 offset:0
  v_mfma_f32_16x16x32_bf16 v[0:3], a[136:139], v[136:139], v[0:3]
  buffer_load_dwordx4 v236, s[16:19], s29 offen offset:0 lds
  v_mfma_f32_16x16x32_bf16 v[0:3], a[140:143], v[140:143], v[0:3]
  ds_read_b128 a[148:151], v213 offset:36864
  ds_read_b128 v[238:241], v224 offset:1024
  v_mfma_f32_16x16x32_bf16 v[8:11], a[140:143], v[156:159], v[196:199]
  ds_read_b128 v[208:211], v224 offset:2048
  v_lshrrev_b32 v224, 4, v242
  v_mfma_f32_16x16x32_bf16 v[8:11], a[136:139], v[152:155], v[8:11]
  ds_read_b128 a[152:155], v214 offset:36864
  s_min_u32 s35, s3, 1
  s_lshl_b32 s35, s35, 30
  v_and_b32 v225, 7, v224
  v_mfma_f32_16x16x32_bf16 v[8:11], a[132:135], v[148:151], v[8:11]
  buffer_load_dwordx4 v237, s[16:19], s29 offen offset:1024 lds
  v_mfma_f32_16x16x32_bf16 v[8:11], a[128:131], v[144:147], v[8:11]
  ds_read_b128 a[156:159], v215 offset:36864
  v_mul_u32_u24 v225, 0xa00, v225
  v_mfma_f32_16x16x32_bf16 v[16:19], a[128:131], v[160:163], v[200:203]
  v_exp_f32 v0, v0
  v_mfma_f32_16x16x32_bf16 v[16:19], a[132:135], v[164:167], v[16:19]
  v_lshrrev_b32 v226, 4, v224
  v_lshl_add_u32 v225, v226, 4, v225
  v_mfma_f32_16x16x32_bf16 v[16:19], a[136:139], v[168:171], v[16:19]
  v_exp_f32 v1, v1
  v_mfma_f32_16x16x32_bf16 v[16:19], a[140:143], v[172:175], v[16:19]
  v_cvt_pk_bf16_f32 v0, v0, v1
  v_bfe_u32 v226, v224, 3, 1
  v_mfma_f32_16x16x32_bf16 v[24:27], a[140:143], v[188:191], v[204:207]
  v_exp_f32 v2, v2
  v_mfma_f32_16x16x32_bf16 v[24:27], a[136:139], v[184:187], v[24:27]
  buffer_load_dwordx4 v236, s[16:19], s29 offen offset:2048 lds
  v_mfma_f32_16x16x32_bf16 v[24:27], a[132:135], v[180:183], v[24:27]
  s_waitcnt lgkmcnt(0)
  v_exp_f32 v3, v3
  v_mfma_f32_16x16x32_bf16 v[24:27], a[128:131], v[176:179], v[24:27]
  v_cvt_pk_bf16_f32 v1, v2, v3
  v_lshl_add_u32 v225, v226, 30, v225
  v_mfma_f32_16x16x32_bf16 v[4:7], a[144:147], v[128:131], v[192:195]
  v_exp_f32 v8, v8
  v_mfma_f32_16x16x32_bf16 v[4:7], a[148:151], v[132:135], v[4:7]
  ds_read_b128 a[128:131], v212 offset:40960
  v_or_b32 v225, s35, v225
  v_mfma_f32_16x16x32_bf16 v[4:7], a[152:155], v[136:139], v[4:7]
  s_mul_i32 s35, s98, 20480
  s_lshl_b32 s38, s99, 6
  s_add_u32 s35, s35, s38
  v_exp_f32 v9, v9
  v_mfma_f32_16x16x32_bf16 v[4:7], a[156:159], v[140:143], v[4:7]
  ds_read_b128 a[132:135], v213 offset:40960
  s_add_u32 s35, s35, 2686976
  v_cvt_pk_bf16_f32 v8, v8, v9
  v_mfma_f32_16x16x32_bf16 v[12:15], a[156:159], v[156:159], v[196:199]
  v_exp_f32 v10, v10
  v_mfma_f32_16x16x32_bf16 v[12:15], a[152:155], v[152:155], v[12:15]
  ds_read_b128 a[136:139], v214 offset:40960
  v_add_f32 v228, v228, v238
  v_mfma_f32_16x16x32_bf16 v[12:15], a[148:151], v[148:151], v[12:15]
  v_exp_f32 v11, v11
  v_mfma_f32_16x16x32_bf16 v[12:15], a[144:147], v[144:147], v[12:15]
  ds_read_b128 a[140:143], v215 offset:40960
  v_cvt_pk_bf16_f32 v9, v10, v11
  v_mfma_f32_16x16x32_bf16 v[20:23], a[144:147], v[160:163], v[200:203]
  v_exp_f32 v16, v16
  v_mfma_f32_16x16x32_bf16 v[20:23], a[148:151], v[164:167], v[20:23]
  buffer_load_dwordx4 v237, s[16:19], s29 offen offset:3072 lds
  v_mfma_f32_16x16x32_bf16 v[20:23], a[152:155], v[168:171], v[20:23]
  s_add_u32 s29, s29, 16384
  v_exp_f32 v17, v17
  v_mfma_f32_16x16x32_bf16 v[20:23], a[156:159], v[172:175], v[20:23]
  v_cvt_pk_bf16_f32 v16, v16, v17
  v_add_f32 v229, v229, v239
  v_mfma_f32_16x16x32_bf16 v[28:31], a[156:159], v[188:191], v[204:207]
  s_add_u32 m0, s28, 16384
  v_exp_f32 v18, v18
  v_mfma_f32_16x16x32_bf16 v[28:31], a[152:155], v[184:187], v[28:31]
  buffer_load_dwordx4 v242, s[24:27], s9 offen offset:0 sc1 lds
  v_mfma_f32_16x16x32_bf16 v[28:31], a[148:151], v[180:183], v[28:31]
  s_waitcnt lgkmcnt(0)
  v_exp_f32 v19, v19
  v_mfma_f32_16x16x32_bf16 v[28:31], a[144:147], v[176:179], v[28:31]
  v_cvt_pk_bf16_f32 v17, v18, v19
  v_add_f32 v230, v230, v240
  v_mfma_f32_16x16x32_bf16 v[32:35], a[128:131], v[128:131], v[192:195]
  v_exp_f32 v24, v24
  v_mfma_f32_16x16x32_bf16 v[32:35], a[132:135], v[132:135], v[32:35]
  ds_read_b128 a[144:147], v212 offset:45056
  v_add_f32 v231, v231, v241
  v_mfma_f32_16x16x32_bf16 v[32:35], a[136:139], v[136:139], v[32:35]
  v_exp_f32 v25, v25
  v_mfma_f32_16x16x32_bf16 v[32:35], a[140:143], v[140:143], v[32:35]
  ds_read_b128 a[148:151], v213 offset:45056
  v_cvt_pk_bf16_f32 v24, v24, v25
  v_mfma_f32_16x16x32_bf16 v[40:43], a[140:143], v[156:159], v[196:199]
  v_exp_f32 v26, v26
  v_mfma_f32_16x16x32_bf16 v[40:43], a[136:139], v[152:155], v[40:43]
  ds_read_b128 a[152:155], v214 offset:45056
  v_add_f32 v228, v228, v208
  v_mfma_f32_16x16x32_bf16 v[40:43], a[132:135], v[148:151], v[40:43]
  v_exp_f32 v27, v27
  v_mfma_f32_16x16x32_bf16 v[40:43], a[128:131], v[144:147], v[40:43]
  ds_read_b128 a[156:159], v215 offset:45056
  v_cvt_pk_bf16_f32 v25, v26, v27
  v_mfma_f32_16x16x32_bf16 v[48:51], a[128:131], v[160:163], v[200:203]
  v_exp_f32 v4, v4
  v_mfma_f32_16x16x32_bf16 v[48:51], a[132:135], v[164:167], v[48:51]
  buffer_load_dwordx4 v242, s[24:27], s9 offen offset:1024 sc1 lds
  v_mfma_f32_16x16x32_bf16 v[48:51], a[136:139], v[168:171], v[48:51]
  v_exp_f32 v5, v5
  v_mfma_f32_16x16x32_bf16 v[48:51], a[140:143], v[172:175], v[48:51]
  v_cvt_pk_bf16_f32 v2, v4, v5
  v_add_f32 v229, v229, v209
  v_mfma_f32_16x16x32_bf16 v[56:59], a[140:143], v[188:191], v[204:207]
  v_exp_f32 v6, v6
  v_mfma_f32_16x16x32_bf16 v[56:59], a[136:139], v[184:187], v[56:59]
  buffer_load_dwordx4 v242, s[24:27], s9 offen offset:2048 sc1 lds
  v_mfma_f32_16x16x32_bf16 v[56:59], a[132:135], v[180:183], v[56:59]
  s_waitcnt lgkmcnt(0)
  v_exp_f32 v7, v7
  v_mfma_f32_16x16x32_bf16 v[56:59], a[128:131], v[176:179], v[56:59]
  v_cvt_pk_bf16_f32 v3, v6, v7
  v_add_f32 v230, v230, v210
  v_mfma_f32_16x16x32_bf16 v[36:39], a[144:147], v[128:131], v[192:195]
  v_exp_f32 v12, v12
  v_mfma_f32_16x16x32_bf16 v[36:39], a[148:151], v[132:135], v[36:39]
  ds_read_b64_tr_b16 a[160:161], v216 offset:16384
  v_add_f32 v231, v231, v211
  v_mfma_f32_16x16x32_bf16 v[36:39], a[152:155], v[136:139], v[36:39]
  v_exp_f32 v13, v13
  v_mfma_f32_16x16x32_bf16 v[36:39], a[156:159], v[140:143], v[36:39]
  ds_read_b64_tr_b16 a[162:163], v216 offset:20480
  v_cvt_pk_bf16_f32 v10, v12, v13
  v_mfma_f32_16x16x32_bf16 v[44:47], a[156:159], v[156:159], v[196:199]
  v_exp_f32 v14, v14
  v_mfma_f32_16x16x32_bf16 v[44:47], a[152:155], v[152:155], v[44:47]
  ds_read_b64_tr_b16 a[164:165], v216 offset:24576
  buffer_load_dwordx4 v242, s[24:27], s9 offen offset:3072 sc1 lds
  v_mfma_f32_16x16x32_bf16 v[44:47], a[148:151], v[148:151], v[44:47]
  v_exp_f32 v15, v15
  v_mfma_f32_16x16x32_bf16 v[44:47], a[144:147], v[144:147], v[44:47]
  ds_read_b64_tr_b16 a[166:167], v216 offset:28672
  v_cvt_pk_bf16_f32 v11, v14, v15
  v_mfma_f32_16x16x32_bf16 v[52:55], a[144:147], v[160:163], v[200:203]
  v_exp_f32 v20, v20
  v_mfma_f32_16x16x32_bf16 v[52:55], a[148:151], v[164:167], v[52:55]
  ds_read_b64_tr_b16 a[168:169], v217 offset:16384
  buffer_store_dwordx4 v[228:231], v225, s[24:27], s35 offen sc1
  v_mfma_f32_16x16x32_bf16 v[52:55], a[152:155], v[168:171], v[52:55]
  v_exp_f32 v21, v21
  v_mfma_f32_16x16x32_bf16 v[52:55], a[156:159], v[172:175], v[52:55]
  ds_read_b64_tr_b16 a[170:171], v217 offset:20480
  v_cvt_pk_bf16_f32 v18, v20, v21
  v_mfma_f32_16x16x32_bf16 v[60:63], a[156:159], v[188:191], v[204:207]
  v_exp_f32 v22, v22
  v_mfma_f32_16x16x32_bf16 v[60:63], a[152:155], v[184:187], v[60:63]
  ds_read_b64_tr_b16 a[172:173], v217 offset:24576
  buffer_load_dwordx4 a[212:215], v242, s[24:27], s4 offen offset:0 sc1
  v_mfma_f32_16x16x32_bf16 v[60:63], a[148:151], v[180:183], v[60:63]
  v_exp_f32 v23, v23
  v_mfma_f32_16x16x32_bf16 v[60:63], a[144:147], v[176:179], v[60:63]
  ds_read_b64_tr_b16 a[174:175], v217 offset:28672
  v_cvt_pk_bf16_f32 v19, v22, v23
  v_mfma_f32_16x16x32_bf16 a[192:195], a[208:211], v[64:67], a[192:195]
  v_exp_f32 v28, v28
  v_mfma_f32_16x16x32_bf16 a[192:195], a[208:211], v[96:99], a[192:195]
  ds_read_b64_tr_b16 a[176:177], v218 offset:16384
  buffer_load_dwordx4 a[216:219], v242, s[24:27], s4 offen offset:1024 sc1
  v_mfma_f32_16x16x32_bf16 a[196:199], a[208:211], v[72:75], a[196:199]
  v_exp_f32 v29, v29
  v_mfma_f32_16x16x32_bf16 a[196:199], a[208:211], v[104:107], a[196:199]
  ds_read_b64_tr_b16 a[178:179], v218 offset:20480
  v_cvt_pk_bf16_f32 v26, v28, v29
  v_mfma_f32_16x16x32_bf16 a[200:203], a[208:211], v[80:83], a[200:203]
  v_exp_f32 v30, v30
  v_mfma_f32_16x16x32_bf16 a[200:203], a[208:211], v[112:115], a[200:203]
  ds_read_b64_tr_b16 a[180:181], v218 offset:24576
  v_mfma_f32_16x16x32_bf16 a[204:207], a[208:211], v[88:91], a[204:207]
  s_waitcnt lgkmcnt(7)
  v_exp_f32 v31, v31
  v_mfma_f32_16x16x32_bf16 a[204:207], a[208:211], v[120:123], a[204:207]
  ds_read_b64_tr_b16 a[182:183], v218 offset:28672
  v_cvt_pk_bf16_f32 v27, v30, v31
  v_mfma_f32_16x16x32_bf16 a[0:3], a[160:163], v[64:67], a[0:3]
  v_exp_f32 v32, v32
  v_mfma_f32_16x16x32_bf16 a[0:3], a[164:167], v[96:99], a[0:3]
  ds_read_b64_tr_b16 a[184:185], v219 offset:16384
  buffer_load_dwordx4 a[220:223], v242, s[24:27], s4 offen offset:2048 sc1
  v_mfma_f32_16x16x32_bf16 a[4:7], a[164:167], v[104:107], a[4:7]
  v_exp_f32 v33, v33
  v_mfma_f32_16x16x32_bf16 a[4:7], a[160:163], v[72:75], a[4:7]
  ds_read_b64_tr_b16 a[186:187], v219 offset:20480
  v_cvt_pk_bf16_f32 v32, v32, v33
  v_mfma_f32_16x16x32_bf16 a[8:11], a[160:163], v[80:83], a[8:11]
  v_exp_f32 v34, v34
  v_mfma_f32_16x16x32_bf16 a[8:11], a[164:167], v[112:115], a[8:11]
  ds_read_b64_tr_b16 a[188:189], v219 offset:24576
  v_mfma_f32_16x16x32_bf16 a[12:15], a[164:167], v[120:123], a[12:15]
  s_waitcnt lgkmcnt(7)
  v_exp_f32 v35, v35
  v_mfma_f32_16x16x32_bf16 a[12:15], a[160:163], v[88:91], a[12:15]
  ds_read_b64_tr_b16 a[190:191], v219 offset:28672
  v_cvt_pk_bf16_f32 v33, v34, v35
  v_mfma_f32_16x16x32_bf16 a[16:19], a[168:171], v[64:67], a[16:19]
  v_exp_f32 v40, v40
  v_mfma_f32_16x16x32_bf16 a[16:19], a[172:175], v[96:99], a[16:19]
  ds_read_b64_tr_b16 a[160:161], v220 offset:16384
  buffer_load_dwordx4 a[224:227], v242, s[24:27], s4 offen offset:3072 sc1
  v_mfma_f32_16x16x32_bf16 a[20:23], a[172:175], v[104:107], a[20:23]
  v_exp_f32 v41, v41
  v_mfma_f32_16x16x32_bf16 a[20:23], a[168:171], v[72:75], a[20:23]
  ds_read_b64_tr_b16 a[162:163], v220 offset:20480
  v_cvt_pk_bf16_f32 v40, v40, v41
  v_mfma_f32_16x16x32_bf16 a[24:27], a[168:171], v[80:83], a[24:27]
  v_exp_f32 v42, v42
  v_mfma_f32_16x16x32_bf16 a[24:27], a[172:175], v[112:115], a[24:27]
  ds_read_b64_tr_b16 a[164:165], v220 offset:24576
  v_mfma_f32_16x16x32_bf16 a[28:31], a[172:175], v[120:123], a[28:31]
  s_waitcnt lgkmcnt(7)
  v_exp_f32 v43, v43
  v_mfma_f32_16x16x32_bf16 a[28:31], a[168:171], v[88:91], a[28:31]
  ds_read_b64_tr_b16 a[166:167], v220 offset:28672
  v_cvt_pk_bf16_f32 v41, v42, v43
  v_mfma_f32_16x16x32_bf16 a[32:35], a[176:179], v[64:67], a[32:35]
  v_exp_f32 v48, v48
  v_mfma_f32_16x16x32_bf16 a[32:35], a[180:183], v[96:99], a[32:35]
  ds_read_b64_tr_b16 a[168:169], v221 offset:16384
  buffer_load_dwordx4 a[228:231], v252, s[24:27], s4 offen offset:0 sc1
  v_mfma_f32_16x16x32_bf16 a[36:39], a[180:183], v[104:107], a[36:39]
  v_exp_f32 v49, v49
  v_mfma_f32_16x16x32_bf16 a[36:39], a[176:179], v[72:75], a[36:39]
  ds_read_b64_tr_b16 a[170:171], v221 offset:20480
  v_cvt_pk_bf16_f32 v48, v48, v49
  v_mfma_f32_16x16x32_bf16 a[40:43], a[176:179], v[80:83], a[40:43]
  v_exp_f32 v50, v50
  v_mfma_f32_16x16x32_bf16 a[40:43], a[180:183], v[112:115], a[40:43]
  ds_read_b64_tr_b16 a[172:173], v221 offset:24576
  v_mfma_f32_16x16x32_bf16 a[44:47], a[180:183], v[120:123], a[44:47]
  s_waitcnt lgkmcnt(7)
  v_exp_f32 v51, v51
  v_mfma_f32_16x16x32_bf16 a[44:47], a[176:179], v[88:91], a[44:47]
  ds_read_b64_tr_b16 a[174:175], v221 offset:28672
  v_cvt_pk_bf16_f32 v49, v50, v51
  v_mfma_f32_16x16x32_bf16 a[48:51], a[184:187], v[64:67], a[48:51]
  v_exp_f32 v56, v56
  v_mfma_f32_16x16x32_bf16 a[48:51], a[188:191], v[96:99], a[48:51]
  ds_read_b64_tr_b16 a[176:177], v222 offset:16384
  buffer_load_dwordx4 a[232:235], v252, s[24:27], s4 offen offset:1024 sc1
  v_mfma_f32_16x16x32_bf16 a[52:55], a[188:191], v[104:107], a[52:55]
  v_exp_f32 v57, v57
  v_mfma_f32_16x16x32_bf16 a[52:55], a[184:187], v[72:75], a[52:55]
  ds_read_b64_tr_b16 a[178:179], v222 offset:20480
  v_cvt_pk_bf16_f32 v56, v56, v57
  v_mfma_f32_16x16x32_bf16 a[56:59], a[184:187], v[80:83], a[56:59]
  v_exp_f32 v58, v58
  v_mfma_f32_16x16x32_bf16 a[56:59], a[188:191], v[112:115], a[56:59]
  ds_read_b64_tr_b16 a[180:181], v222 offset:24576
  v_mfma_f32_16x16x32_bf16 a[60:63], a[188:191], v[120:123], a[60:63]
  s_waitcnt lgkmcnt(7)
  v_exp_f32 v59, v59
  v_mfma_f32_16x16x32_bf16 a[60:63], a[184:187], v[88:91], a[60:63]
  ds_read_b64_tr_b16 a[182:183], v222 offset:28672
  v_cvt_pk_bf16_f32 v57, v58, v59
  v_mfma_f32_16x16x32_bf16 a[64:67], a[160:163], v[64:67], a[64:67]
  v_exp_f32 v36, v36
  v_mfma_f32_16x16x32_bf16 a[64:67], a[164:167], v[96:99], a[64:67]
  ds_read_b64_tr_b16 a[184:185], v223 offset:16384
  v_mfma_f32_16x16x32_bf16 a[68:71], a[164:167], v[104:107], a[68:71]
  v_exp_f32 v37, v37
  v_mfma_f32_16x16x32_bf16 a[68:71], a[160:163], v[72:75], a[68:71]
  ds_read_b64_tr_b16 a[186:187], v223 offset:20480
  v_cvt_pk_bf16_f32 v34, v36, v37
  v_mfma_f32_16x16x32_bf16 a[72:75], a[160:163], v[80:83], a[72:75]
  v_exp_f32 v38, v38
  v_mfma_f32_16x16x32_bf16 a[72:75], a[164:167], v[112:115], a[72:75]
  ds_read_b64_tr_b16 a[188:189], v223 offset:24576
  v_mfma_f32_16x16x32_bf16 a[76:79], a[164:167], v[120:123], a[76:79]
  s_waitcnt lgkmcnt(7)
  v_exp_f32 v39, v39
  v_mfma_f32_16x16x32_bf16 a[76:79], a[160:163], v[88:91], a[76:79]
  ds_read_b64_tr_b16 a[190:191], v223 offset:28672
  v_cvt_pk_bf16_f32 v35, v38, v39
  v_mfma_f32_16x16x32_bf16 a[80:83], a[168:171], v[64:67], a[80:83]
  s_waitcnt vmcnt(19)
  v_exp_f32 v44, v44
  v_mfma_f32_16x16x32_bf16 a[80:83], a[172:175], v[96:99], a[80:83]
  v_mfma_f32_16x16x32_bf16 a[84:87], a[172:175], v[104:107], a[84:87]
  s_barrier
  v_exp_f32 v45, v45
  v_mfma_f32_16x16x32_bf16 a[84:87], a[168:171], v[72:75], a[84:87]
  ds_read_b128 a[128:131], v212 offset:49152
  v_cvt_pk_bf16_f32 v42, v44, v45
  v_mfma_f32_16x16x32_bf16 a[88:91], a[168:171], v[80:83], a[88:91]
  v_exp_f32 v46, v46
  v_mfma_f32_16x16x32_bf16 a[88:91], a[172:175], v[112:115], a[88:91]
  ds_read_b128 a[132:135], v213 offset:49152
  v_mfma_f32_16x16x32_bf16 a[92:95], a[172:175], v[120:123], a[92:95]
  s_waitcnt lgkmcnt(6)
  v_exp_f32 v47, v47
  v_mfma_f32_16x16x32_bf16 a[92:95], a[168:171], v[88:91], a[92:95]
  ds_read_b128 a[136:139], v214 offset:49152
  v_cvt_pk_bf16_f32 v43, v46, v47
  v_mfma_f32_16x16x32_bf16 a[96:99], a[176:179], v[64:67], a[96:99]
  v_exp_f32 v52, v52
  v_mfma_f32_16x16x32_bf16 a[96:99], a[180:183], v[96:99], a[96:99]
  ds_read_b128 a[140:143], v215 offset:49152
  v_mfma_f32_16x16x32_bf16 a[100:103], a[180:183], v[104:107], a[100:103]
  v_exp_f32 v53, v53
  v_mfma_f32_16x16x32_bf16 a[100:103], a[176:179], v[72:75], a[100:103]
  v_cvt_pk_bf16_f32 v50, v52, v53
  v_mfma_f32_16x16x32_bf16 a[104:107], a[176:179], v[80:83], a[104:107]
  v_exp_f32 v54, v54
  v_mfma_f32_16x16x32_bf16 a[104:107], a[180:183], v[112:115], a[104:107]
  v_mfma_f32_16x16x32_bf16 a[108:111], a[180:183], v[120:123], a[108:111]
  s_waitcnt lgkmcnt(4)
  v_exp_f32 v55, v55
  v_mfma_f32_16x16x32_bf16 a[108:111], a[176:179], v[88:91], a[108:111]
  v_cvt_pk_bf16_f32 v51, v54, v55
  v_mfma_f32_16x16x32_bf16 a[112:115], a[184:187], v[64:67], a[112:115]
  v_exp_f32 v60, v60
  v_mfma_f32_16x16x32_bf16 a[112:115], a[188:191], v[96:99], a[112:115]
  v_mfma_f32_16x16x32_bf16 a[116:119], a[188:191], v[104:107], a[116:119]
  v_exp_f32 v61, v61
  v_mfma_f32_16x16x32_bf16 a[116:119], a[184:187], v[72:75], a[116:119]
  v_cvt_pk_bf16_f32 v58, v60, v61
  v_mfma_f32_16x16x32_bf16 a[120:123], a[184:187], v[80:83], a[120:123]
  v_exp_f32 v62, v62
  v_mfma_f32_16x16x32_bf16 a[120:123], a[188:191], v[112:115], a[120:123]
  v_mfma_f32_16x16x32_bf16 a[124:127], a[188:191], v[120:123], a[124:127]
  s_waitcnt lgkmcnt(0)
  v_exp_f32 v63, v63
  v_mfma_f32_16x16x32_bf16 a[124:127], a[184:187], v[88:91], a[124:127]
  v_cvt_pk_bf16_f32 v59, v62, v63
  v_mfma_f32_16x16x32_bf16 v[64:67], a[128:131], v[128:131], v[192:195]
  s_add_u32 m0, s28, 65536
  v_mfma_f32_16x16x32_bf16 v[64:67], a[132:135], v[132:135], v[64:67]
  ds_read_b128 a[144:147], v212 offset:53248
  v_mfma_f32_16x16x32_bf16 v[64:67], a[136:139], v[136:139], v[64:67]
  buffer_load_dwordx4 v253, s[24:27], s9 offen offset:0 sc1 lds
  v_mfma_f32_16x16x32_bf16 v[64:67], a[140:143], v[140:143], v[64:67]
  ds_read_b128 a[148:151], v213 offset:53248
  v_mfma_f32_16x16x32_bf16 v[72:75], a[140:143], v[156:159], v[196:199]
  v_mfma_f32_16x16x32_bf16 v[72:75], a[136:139], v[152:155], v[72:75]
  ds_read_b128 a[152:155], v214 offset:53248
  v_mfma_f32_16x16x32_bf16 v[72:75], a[132:135], v[148:151], v[72:75]
  buffer_load_dwordx4 v253, s[24:27], s9 offen offset:1024 sc1 lds
  v_mfma_f32_16x16x32_bf16 v[72:75], a[128:131], v[144:147], v[72:75]
  ds_read_b128 a[156:159], v215 offset:53248
  v_mfma_f32_16x16x32_bf16 v[80:83], a[128:131], v[160:163], v[200:203]
  v_exp_f32 v64, v64
  v_mfma_f32_16x16x32_bf16 v[80:83], a[132:135], v[164:167], v[80:83]
  v_mfma_f32_16x16x32_bf16 v[80:83], a[136:139], v[168:171], v[80:83]
  v_exp_f32 v65, v65
  v_mfma_f32_16x16x32_bf16 v[80:83], a[140:143], v[172:175], v[80:83]
  v_cvt_pk_bf16_f32 v64, v64, v65
  v_mfma_f32_16x16x32_bf16 v[88:91], a[140:143], v[188:191], v[204:207]
  v_exp_f32 v66, v66
  v_mfma_f32_16x16x32_bf16 v[88:91], a[136:139], v[184:187], v[88:91]
  buffer_load_dwordx4 v253, s[24:27], s9 offen offset:2048 sc1 lds
  v_mfma_f32_16x16x32_bf16 v[88:91], a[132:135], v[180:183], v[88:91]
  s_waitcnt lgkmcnt(0)
  v_exp_f32 v67, v67
  v_mfma_f32_16x16x32_bf16 v[88:91], a[128:131], v[176:179], v[88:91]
  v_cvt_pk_bf16_f32 v65, v66, v67
  v_mfma_f32_16x16x32_bf16 v[68:71], a[144:147], v[128:131], v[192:195]
  v_exp_f32 v72, v72
  v_mfma_f32_16x16x32_bf16 v[68:71], a[148:151], v[132:135], v[68:71]
  ds_read_b128 a[128:131], v212 offset:57344
  v_mfma_f32_16x16x32_bf16 v[68:71], a[152:155], v[136:139], v[68:71]
  v_exp_f32 v73, v73
  v_mfma_f32_16x16x32_bf16 v[68:71], a[156:159], v[140:143], v[68:71]
  ds_read_b128 a[132:135], v213 offset:57344
  v_cvt_pk_bf16_f32 v72, v72, v73
  v_mfma_f32_16x16x32_bf16 v[76:79], a[156:159], v[156:159], v[196:199]
  v_exp_f32 v74, v74
  v_mfma_f32_16x16x32_bf16 v[76:79], a[152:155], v[152:155], v[76:79]
  ds_read_b128 a[136:139], v214 offset:57344
  v_mfma_f32_16x16x32_bf16 v[76:79], a[148:151], v[148:151], v[76:79]
  v_exp_f32 v75, v75
  v_mfma_f32_16x16x32_bf16 v[76:79], a[144:147], v[144:147], v[76:79]
  ds_read_b128 a[140:143], v215 offset:57344
  v_cvt_pk_bf16_f32 v73, v74, v75
  v_mfma_f32_16x16x32_bf16 v[84:87], a[144:147], v[160:163], v[200:203]
  v_exp_f32 v80, v80
  v_mfma_f32_16x16x32_bf16 v[84:87], a[148:151], v[164:167], v[84:87]
  buffer_load_dwordx4 v253, s[24:27], s9 offen offset:3072 sc1 lds
  v_mfma_f32_16x16x32_bf16 v[84:87], a[152:155], v[168:171], v[84:87]
  s_add_u32 s29, s29, 16384
  v_exp_f32 v81, v81
  v_mfma_f32_16x16x32_bf16 v[84:87], a[156:159], v[172:175], v[84:87]
  v_cvt_pk_bf16_f32 v80, v80, v81
  v_mfma_f32_16x16x32_bf16 v[92:95], a[156:159], v[188:191], v[204:207]
  s_add_u32 m0, s28, 32768
  v_exp_f32 v82, v82
  v_mfma_f32_16x16x32_bf16 v[92:95], a[152:155], v[184:187], v[92:95]
  buffer_load_dwordx4 v252, s[24:27], s9 offen offset:0 sc1 lds
  v_mfma_f32_16x16x32_bf16 v[92:95], a[148:151], v[180:183], v[92:95]
  s_waitcnt lgkmcnt(0)
  v_exp_f32 v83, v83
  v_mfma_f32_16x16x32_bf16 v[92:95], a[144:147], v[176:179], v[92:95]
  v_cvt_pk_bf16_f32 v81, v82, v83
  v_mfma_f32_16x16x32_bf16 v[96:99], a[128:131], v[128:131], v[192:195]
  v_exp_f32 v88, v88
  v_mfma_f32_16x16x32_bf16 v[96:99], a[132:135], v[132:135], v[96:99]
  ds_read_b128 a[144:147], v212 offset:61440
  v_mfma_f32_16x16x32_bf16 v[96:99], a[136:139], v[136:139], v[96:99]
  v_exp_f32 v89, v89
  v_mfma_f32_16x16x32_bf16 v[96:99], a[140:143], v[140:143], v[96:99]
  ds_read_b128 a[148:151], v213 offset:61440
  v_cvt_pk_bf16_f32 v88, v88, v89
  v_mfma_f32_16x16x32_bf16 v[104:107], a[140:143], v[156:159], v[196:199]
  v_exp_f32 v90, v90
  v_mfma_f32_16x16x32_bf16 v[104:107], a[136:139], v[152:155], v[104:107]
  ds_read_b128 a[152:155], v214 offset:61440
  v_mfma_f32_16x16x32_bf16 v[104:107], a[132:135], v[148:151], v[104:107]
  v_exp_f32 v91, v91
  v_mfma_f32_16x16x32_bf16 v[104:107], a[128:131], v[144:147], v[104:107]
  ds_read_b128 a[156:159], v215 offset:61440
  v_cvt_pk_bf16_f32 v89, v90, v91
  v_mfma_f32_16x16x32_bf16 v[112:115], a[128:131], v[160:163], v[200:203]
  v_exp_f32 v68, v68
  v_mfma_f32_16x16x32_bf16 v[112:115], a[132:135], v[164:167], v[112:115]
  buffer_load_dwordx4 v252, s[24:27], s9 offen offset:1024 sc1 lds
  v_mfma_f32_16x16x32_bf16 v[112:115], a[136:139], v[168:171], v[112:115]
  v_exp_f32 v69, v69
  v_mfma_f32_16x16x32_bf16 v[112:115], a[140:143], v[172:175], v[112:115]
  v_cvt_pk_bf16_f32 v66, v68, v69
  v_mfma_f32_16x16x32_bf16 v[120:123], a[140:143], v[188:191], v[204:207]
  v_exp_f32 v70, v70
  v_mfma_f32_16x16x32_bf16 v[120:123], a[136:139], v[184:187], v[120:123]
  buffer_load_dwordx4 v252, s[24:27], s9 offen offset:2048 sc1 lds
  v_mfma_f32_16x16x32_bf16 v[120:123], a[132:135], v[180:183], v[120:123]
  s_waitcnt lgkmcnt(0)
  v_exp_f32 v71, v71
  v_mfma_f32_16x16x32_bf16 v[120:123], a[128:131], v[176:179], v[120:123]
  v_cvt_pk_bf16_f32 v67, v70, v71
  v_mfma_f32_16x16x32_bf16 v[100:103], a[144:147], v[128:131], v[192:195]
  v_exp_f32 v76, v76
  v_mfma_f32_16x16x32_bf16 v[100:103], a[148:151], v[132:135], v[100:103]
  ds_read_b64_tr_b16 a[160:161], v216 offset:32768
  v_mfma_f32_16x16x32_bf16 v[100:103], a[152:155], v[136:139], v[100:103]
  v_exp_f32 v77, v77
  v_mfma_f32_16x16x32_bf16 v[100:103], a[156:159], v[140:143], v[100:103]
  ds_read_b64_tr_b16 a[162:163], v216 offset:36864
  v_cvt_pk_bf16_f32 v74, v76, v77
  v_mfma_f32_16x16x32_bf16 v[108:111], a[156:159], v[156:159], v[196:199]
  v_exp_f32 v78, v78
  v_mfma_f32_16x16x32_bf16 v[108:111], a[152:155], v[152:155], v[108:111]
  ds_read_b64_tr_b16 a[164:165], v216 offset:40960
  buffer_load_dwordx4 v252, s[24:27], s9 offen offset:3072 sc1 lds
  v_mfma_f32_16x16x32_bf16 v[108:111], a[148:151], v[148:151], v[108:111]
  v_exp_f32 v79, v79
  v_mfma_f32_16x16x32_bf16 v[108:111], a[144:147], v[144:147], v[108:111]
  ds_read_b64_tr_b16 a[166:167], v216 offset:45056
  v_cvt_pk_bf16_f32 v75, v78, v79
  v_mfma_f32_16x16x32_bf16 v[116:119], a[144:147], v[160:163], v[200:203]
  v_exp_f32 v84, v84
  v_mfma_f32_16x16x32_bf16 v[116:119], a[148:151], v[164:167], v[116:119]
  ds_read_b64_tr_b16 a[168:169], v217 offset:32768
  buffer_load_dwordx4 a[236:239], v252, s[24:27], s4 offen offset:2048 sc1
  v_mfma_f32_16x16x32_bf16 v[116:119], a[152:155], v[168:171], v[116:119]
  v_exp_f32 v85, v85
  v_mfma_f32_16x16x32_bf16 v[116:119], a[156:159], v[172:175], v[116:119]
  ds_read_b64_tr_b16 a[170:171], v217 offset:36864
  v_cvt_pk_bf16_f32 v82, v84, v85
  v_mfma_f32_16x16x32_bf16 v[124:127], a[156:159], v[188:191], v[204:207]
  v_exp_f32 v86, v86
  v_mfma_f32_16x16x32_bf16 v[124:127], a[152:155], v[184:187], v[124:127]
  ds_read_b64_tr_b16 a[172:173], v217 offset:40960
  v_mfma_f32_16x16x32_bf16 v[124:127], a[148:151], v[180:183], v[124:127]
  v_exp_f32 v87, v87
  v_mfma_f32_16x16x32_bf16 v[124:127], a[144:147], v[176:179], v[124:127]
  ds_read_b64_tr_b16 a[174:175], v217 offset:45056
  v_cvt_pk_bf16_f32 v83, v86, v87
  v_mfma_f32_16x16x32_bf16 a[192:195], a[208:211], v[0:3], a[192:195]
  v_exp_f32 v92, v92
  v_mfma_f32_16x16x32_bf16 a[192:195], a[208:211], v[32:35], a[192:195]
  ds_read_b64_tr_b16 a[176:177], v218 offset:32768
  buffer_load_dwordx4 a[240:243], v252, s[24:27], s4 offen offset:3072 sc1
  v_mfma_f32_16x16x32_bf16 a[196:199], a[208:211], v[8:11], a[196:199]
  v_exp_f32 v93, v93
  v_mfma_f32_16x16x32_bf16 a[196:199], a[208:211], v[40:43], a[196:199]
  ds_read_b64_tr_b16 a[178:179], v218 offset:36864
  v_cvt_pk_bf16_f32 v90, v92, v93
  v_mfma_f32_16x16x32_bf16 a[200:203], a[208:211], v[16:19], a[200:203]
  v_exp_f32 v94, v94
  v_mfma_f32_16x16x32_bf16 a[200:203], a[208:211], v[48:51], a[200:203]
  ds_read_b64_tr_b16 a[180:181], v218 offset:40960
  v_mfma_f32_16x16x32_bf16 a[204:207], a[208:211], v[24:27], a[204:207]
  s_waitcnt lgkmcnt(7)
  v_exp_f32 v95, v95
  v_mfma_f32_16x16x32_bf16 a[204:207], a[208:211], v[56:59], a[204:207]
  ds_read_b64_tr_b16 a[182:183], v218 offset:45056
  v_cvt_pk_bf16_f32 v91, v94, v95
  v_mfma_f32_16x16x32_bf16 a[0:3], a[160:163], v[0:3], a[0:3]
  v_exp_f32 v96, v96
  v_mfma_f32_16x16x32_bf16 a[0:3], a[164:167], v[32:35], a[0:3]
  ds_read_b64_tr_b16 a[184:185], v219 offset:32768
  buffer_load_dwordx4 a[244:247], v253, s[24:27], s4 offen offset:0 sc1
  v_mfma_f32_16x16x32_bf16 a[4:7], a[164:167], v[40:43], a[4:7]
  v_exp_f32 v97, v97
  v_mfma_f32_16x16x32_bf16 a[4:7], a[160:163], v[8:11], a[4:7]
  ds_read_b64_tr_b16 a[186:187], v219 offset:36864
  v_cvt_pk_bf16_f32 v96, v96, v97
  v_mfma_f32_16x16x32_bf16 a[8:11], a[160:163], v[16:19], a[8:11]
  v_exp_f32 v98, v98
  v_mfma_f32_16x16x32_bf16 a[8:11], a[164:167], v[48:51], a[8:11]
  ds_read_b64_tr_b16 a[188:189], v219 offset:40960
  v_mfma_f32_16x16x32_bf16 a[12:15], a[164:167], v[56:59], a[12:15]
  s_waitcnt lgkmcnt(7)
  v_exp_f32 v99, v99
  v_mfma_f32_16x16x32_bf16 a[12:15], a[160:163], v[24:27], a[12:15]
  ds_read_b64_tr_b16 a[190:191], v219 offset:45056
  v_cvt_pk_bf16_f32 v97, v98, v99
  v_mfma_f32_16x16x32_bf16 a[16:19], a[168:171], v[0:3], a[16:19]
  v_exp_f32 v104, v104
  v_mfma_f32_16x16x32_bf16 a[16:19], a[172:175], v[32:35], a[16:19]
  ds_read_b64_tr_b16 a[160:161], v220 offset:32768
  buffer_load_dwordx4 a[248:251], v253, s[24:27], s4 offen offset:1024 sc1
  v_mfma_f32_16x16x32_bf16 a[20:23], a[172:175], v[40:43], a[20:23]
  v_exp_f32 v105, v105
  v_mfma_f32_16x16x32_bf16 a[20:23], a[168:171], v[8:11], a[20:23]
  ds_read_b64_tr_b16 a[162:163], v220 offset:36864
  v_cvt_pk_bf16_f32 v104, v104, v105
  v_mfma_f32_16x16x32_bf16 a[24:27], a[168:171], v[16:19], a[24:27]
  v_exp_f32 v106, v106
  v_mfma_f32_16x16x32_bf16 a[24:27], a[172:175], v[48:51], a[24:27]
  ds_read_b64_tr_b16 a[164:165], v220 offset:40960
  v_mfma_f32_16x16x32_bf16 a[28:31], a[172:175], v[56:59], a[28:31]
  s_waitcnt lgkmcnt(7)
  v_exp_f32 v107, v107
  v_mfma_f32_16x16x32_bf16 a[28:31], a[168:171], v[24:27], a[28:31]
  ds_read_b64_tr_b16 a[166:167], v220 offset:45056
  v_cvt_pk_bf16_f32 v105, v106, v107
  v_mfma_f32_16x16x32_bf16 a[32:35], a[176:179], v[0:3], a[32:35]
  v_exp_f32 v112, v112
  v_mfma_f32_16x16x32_bf16 a[32:35], a[180:183], v[32:35], a[32:35]
  ds_read_b64_tr_b16 a[168:169], v221 offset:32768
  buffer_load_dwordx4 a[252:255], v253, s[24:27], s4 offen offset:2048 sc1
  v_mfma_f32_16x16x32_bf16 a[36:39], a[180:183], v[40:43], a[36:39]
  v_exp_f32 v113, v113
  v_mfma_f32_16x16x32_bf16 a[36:39], a[176:179], v[8:11], a[36:39]
  ds_read_b64_tr_b16 a[170:171], v221 offset:36864
  v_cvt_pk_bf16_f32 v112, v112, v113
  v_mfma_f32_16x16x32_bf16 a[40:43], a[176:179], v[16:19], a[40:43]
  v_exp_f32 v114, v114
  v_mfma_f32_16x16x32_bf16 a[40:43], a[180:183], v[48:51], a[40:43]
  ds_read_b64_tr_b16 a[172:173], v221 offset:40960
  v_mfma_f32_16x16x32_bf16 a[44:47], a[180:183], v[56:59], a[44:47]
  s_waitcnt lgkmcnt(7)
  v_exp_f32 v115, v115
  v_mfma_f32_16x16x32_bf16 a[44:47], a[176:179], v[24:27], a[44:47]
  ds_read_b64_tr_b16 a[174:175], v221 offset:45056
  v_cvt_pk_bf16_f32 v113, v114, v115
  v_mfma_f32_16x16x32_bf16 a[48:51], a[184:187], v[0:3], a[48:51]
  v_exp_f32 v120, v120
  v_mfma_f32_16x16x32_bf16 a[48:51], a[188:191], v[32:35], a[48:51]
  ds_read_b64_tr_b16 a[176:177], v222 offset:32768
  v_mfma_f32_16x16x32_bf16 a[52:55], a[188:191], v[40:43], a[52:55]
  v_exp_f32 v121, v121
  v_mfma_f32_16x16x32_bf16 a[52:55], a[184:187], v[8:11], a[52:55]
  ds_read_b64_tr_b16 a[178:179], v222 offset:36864
  v_cvt_pk_bf16_f32 v120, v120, v121
  v_mfma_f32_16x16x32_bf16 a[56:59], a[184:187], v[16:19], a[56:59]
  v_exp_f32 v122, v122
  v_mfma_f32_16x16x32_bf16 a[56:59], a[188:191], v[48:51], a[56:59]
  ds_read_b64_tr_b16 a[180:181], v222 offset:40960
  v_mfma_f32_16x16x32_bf16 a[60:63], a[188:191], v[56:59], a[60:63]
  s_waitcnt lgkmcnt(7)
  v_exp_f32 v123, v123
  v_mfma_f32_16x16x32_bf16 a[60:63], a[184:187], v[24:27], a[60:63]
  ds_read_b64_tr_b16 a[182:183], v222 offset:45056
  v_cvt_pk_bf16_f32 v121, v122, v123
  v_mfma_f32_16x16x32_bf16 a[64:67], a[160:163], v[0:3], a[64:67]
  v_exp_f32 v100, v100
  v_mfma_f32_16x16x32_bf16 a[64:67], a[164:167], v[32:35], a[64:67]
  ds_read_b64_tr_b16 a[184:185], v223 offset:32768
  v_mfma_f32_16x16x32_bf16 a[68:71], a[164:167], v[40:43], a[68:71]
  v_exp_f32 v101, v101
  v_mfma_f32_16x16x32_bf16 a[68:71], a[160:163], v[8:11], a[68:71]
  ds_read_b64_tr_b16 a[186:187], v223 offset:36864
  v_cvt_pk_bf16_f32 v98, v100, v101
  v_mfma_f32_16x16x32_bf16 a[72:75], a[160:163], v[16:19], a[72:75]
  v_exp_f32 v102, v102
  v_mfma_f32_16x16x32_bf16 a[72:75], a[164:167], v[48:51], a[72:75]
  ds_read_b64_tr_b16 a[188:189], v223 offset:40960
  v_mfma_f32_16x16x32_bf16 a[76:79], a[164:167], v[56:59], a[76:79]
  s_waitcnt lgkmcnt(7)
  v_exp_f32 v103, v103
  v_mfma_f32_16x16x32_bf16 a[76:79], a[160:163], v[24:27], a[76:79]
  ds_read_b64_tr_b16 a[190:191], v223 offset:45056
  v_cvt_pk_bf16_f32 v99, v102, v103
  v_mfma_f32_16x16x32_bf16 a[80:83], a[168:171], v[0:3], a[80:83]
  s_waitcnt vmcnt(19)
  v_exp_f32 v108, v108
  v_mfma_f32_16x16x32_bf16 a[80:83], a[172:175], v[32:35], a[80:83]
  v_mfma_f32_16x16x32_bf16 a[84:87], a[172:175], v[40:43], a[84:87]
  s_barrier
  v_exp_f32 v109, v109
  v_mfma_f32_16x16x32_bf16 a[84:87], a[168:171], v[8:11], a[84:87]
  s_mul_i32 s39, s99, 13108
  s_lshr_b32 s39, s39, 16
  s_lshl_b32 s39, s39, 8
  v_cvt_pk_bf16_f32 v106, v108, v109
  v_mfma_f32_16x16x32_bf16 a[88:91], a[168:171], v[16:19], a[88:91]
  s_add_u32 s39, s39, 2818304
  s_cmp_lt_u32 s2, 240
  s_cselect_b32 s48, 0, 1073741824
  v_exp_f32 v110, v110
  v_mfma_f32_16x16x32_bf16 a[88:91], a[172:175], v[48:51], a[88:91]
  v_or_b32 v249, s48, v251
  v_mfma_f32_16x16x32_bf16 a[92:95], a[172:175], v[56:59], a[92:95]
  s_waitcnt lgkmcnt(4)
  v_exp_f32 v111, v111
  v_mfma_f32_16x16x32_bf16 a[92:95], a[168:171], v[24:27], a[92:95]
  buffer_atomic_add v250, v249, s[24:27], s39 offen
  v_cvt_pk_bf16_f32 v107, v110, v111
  v_mfma_f32_16x16x32_bf16 a[96:99], a[176:179], v[0:3], a[96:99]
  v_exp_f32 v116, v116
  v_mfma_f32_16x16x32_bf16 a[96:99], a[180:183], v[32:35], a[96:99]
  v_mfma_f32_16x16x32_bf16 a[100:103], a[180:183], v[40:43], a[100:103]
  v_exp_f32 v117, v117
  v_mfma_f32_16x16x32_bf16 a[100:103], a[176:179], v[8:11], a[100:103]
  v_cvt_pk_bf16_f32 v114, v116, v117
  v_mfma_f32_16x16x32_bf16 a[104:107], a[176:179], v[16:19], a[104:107]
  v_exp_f32 v118, v118
  v_mfma_f32_16x16x32_bf16 a[104:107], a[180:183], v[48:51], a[104:107]
  v_mfma_f32_16x16x32_bf16 a[108:111], a[180:183], v[56:59], a[108:111]
  s_waitcnt lgkmcnt(0)
  v_exp_f32 v119, v119
  v_mfma_f32_16x16x32_bf16 a[108:111], a[176:179], v[24:27], a[108:111]
  v_cvt_pk_bf16_f32 v115, v118, v119
  v_mfma_f32_16x16x32_bf16 a[112:115], a[184:187], v[0:3], a[112:115]
  v_exp_f32 v124, v124
  v_mfma_f32_16x16x32_bf16 a[112:115], a[188:191], v[32:35], a[112:115]
  v_mfma_f32_16x16x32_bf16 a[116:119], a[188:191], v[40:43], a[116:119]
  v_exp_f32 v125, v125
  v_mfma_f32_16x16x32_bf16 a[116:119], a[184:187], v[8:11], a[116:119]
  v_cvt_pk_bf16_f32 v122, v124, v125
  v_mfma_f32_16x16x32_bf16 a[120:123], a[184:187], v[16:19], a[120:123]
  v_exp_f32 v126, v126
  v_mfma_f32_16x16x32_bf16 a[120:123], a[188:191], v[48:51], a[120:123]
  v_mfma_f32_16x16x32_bf16 a[124:127], a[188:191], v[56:59], a[124:127]
  v_exp_f32 v127, v127
  v_mfma_f32_16x16x32_bf16 a[124:127], a[184:187], v[24:27], a[124:127]
  v_cvt_pk_bf16_f32 v123, v126, v127
  ds_read_b64_tr_b16 a[160:161], v216 offset:49152
  ds_read_b64_tr_b16 a[162:163], v216 offset:53248
  ds_read_b64_tr_b16 a[164:165], v216 offset:57344
  ds_read_b64_tr_b16 a[166:167], v216 offset:61440
  ds_read_b64_tr_b16 a[168:169], v217 offset:49152
  ds_read_b64_tr_b16 a[170:171], v217 offset:53248
  ds_read_b64_tr_b16 a[172:173], v217 offset:57344
  ds_read_b64_tr_b16 a[174:175], v217 offset:61440
  s_mov_b32 s48, 0x53800000
  s_lshl_b32 s39, s3, 8
  v_mfma_f32_16x16x32_bf16 a[192:195], a[208:211], v[64:67], a[192:195]
  s_add_u32 m0, s28, 81920
  v_mfma_f32_16x16x32_bf16 a[192:195], a[208:211], v[96:99], a[192:195]
  v_mfma_f32_16x16x32_bf16 a[196:199], a[208:211], v[72:75], a[196:199]
  buffer_load_dwordx4 v242, s[24:27], s10 offen offset:0 sc1 lds
  v_mfma_f32_16x16x32_bf16 a[196:199], a[208:211], v[104:107], a[196:199]
  v_mfma_f32_16x16x32_bf16 a[200:203], a[208:211], v[80:83], a[200:203]
  buffer_load_dwordx4 v242, s[24:27], s10 offen offset:1024 sc1 lds
  v_mfma_f32_16x16x32_bf16 a[200:203], a[208:211], v[112:115], a[200:203]
  v_mfma_f32_16x16x32_bf16 a[204:207], a[208:211], v[88:91], a[204:207]
  buffer_load_dwordx4 v242, s[24:27], s10 offen offset:2048 sc1 lds
  v_mfma_f32_16x16x32_bf16 a[204:207], a[208:211], v[120:123], a[204:207]
  s_waitcnt lgkmcnt(4)
  v_mfma_f32_16x16x32_bf16 a[0:3], a[160:163], v[64:67], a[0:3]
  buffer_load_dwordx4 v242, s[24:27], s10 offen offset:3072 sc1 lds
  v_mfma_f32_16x16x32_bf16 a[0:3], a[164:167], v[96:99], a[0:3]
  ds_read_b64_tr_b16 a[176:177], v218 offset:49152
  v_mfma_f32_16x16x32_bf16 a[4:7], a[164:167], v[104:107], a[4:7]
  buffer_load_dwordx4 a[128:131], v253, s[24:27], s4 offen offset:3072 sc1
  v_mfma_f32_16x16x32_bf16 a[4:7], a[160:163], v[72:75], a[4:7]
  ds_read_b64_tr_b16 a[178:179], v218 offset:53248
  v_accvgpr_read_b32 v208, a192
  v_mfma_f32_16x16x32_bf16 a[8:11], a[160:163], v[80:83], a[8:11]
  v_accvgpr_read_b32 v209, a196
  v_accvgpr_read_b32 v210, a200
  v_mfma_f32_16x16x32_bf16 a[8:11], a[164:167], v[112:115], a[8:11]
  ds_read_b64_tr_b16 a[180:181], v218 offset:57344
  v_accvgpr_read_b32 v211, a204
  v_mfma_f32_16x16x32_bf16 a[12:15], a[164:167], v[120:123], a[12:15]
  v_mov_b32 v245, v208
  v_mov_b32 v246, v209
  v_mfma_f32_16x16x32_bf16 a[12:15], a[160:163], v[88:91], a[12:15]
  ds_read_b64_tr_b16 a[182:183], v218 offset:61440
  s_waitcnt lgkmcnt(4)
  v_mov_b32 v247, v210
  v_mfma_f32_16x16x32_bf16 a[16:19], a[168:171], v[64:67], a[16:19]
  v_mov_b32 v248, v211
  v_permlane16_swap_b32 v208, v245
  v_mfma_f32_16x16x32_bf16 a[16:19], a[172:175], v[96:99], a[16:19]
  ds_read_b64_tr_b16 a[184:185], v219 offset:49152
  v_permlane16_swap_b32 v209, v246
  v_mfma_f32_16x16x32_bf16 a[20:23], a[172:175], v[104:107], a[20:23]
  v_permlane16_swap_b32 v210, v247
  v_permlane16_swap_b32 v211, v248
  v_mfma_f32_16x16x32_bf16 a[20:23], a[168:171], v[72:75], a[20:23]
  ds_read_b64_tr_b16 a[186:187], v219 offset:53248
  v_add_f32 v208, v208, v245
  v_mfma_f32_16x16x32_bf16 a[24:27], a[168:171], v[80:83], a[24:27]
  v_add_f32 v209, v209, v246
  v_add_f32 v210, v210, v247
  v_mfma_f32_16x16x32_bf16 a[24:27], a[172:175], v[112:115], a[24:27]
  ds_read_b64_tr_b16 a[188:189], v219 offset:57344
  v_add_f32 v211, v211, v248
  v_mfma_f32_16x16x32_bf16 a[28:31], a[172:175], v[120:123], a[28:31]
  v_mov_b32 v245, v208
  v_mov_b32 v246, v209
  v_mfma_f32_16x16x32_bf16 a[28:31], a[168:171], v[88:91], a[28:31]
  ds_read_b64_tr_b16 a[190:191], v219 offset:61440
  s_waitcnt lgkmcnt(4)
  v_mov_b32 v247, v210
  v_mfma_f32_16x16x32_bf16 a[32:35], a[176:179], v[64:67], a[32:35]
  v_mov_b32 v248, v211
  v_permlane32_swap_b32 v208, v245
  v_mfma_f32_16x16x32_bf16 a[32:35], a[180:183], v[96:99], a[32:35]
  ds_read_b64_tr_b16 a[160:161], v220 offset:49152
  v_permlane32_swap_b32 v209, v246
  v_mfma_f32_16x16x32_bf16 a[36:39], a[180:183], v[104:107], a[36:39]
  v_permlane32_swap_b32 v210, v247
  v_permlane32_swap_b32 v211, v248
  v_mfma_f32_16x16x32_bf16 a[36:39], a[176:179], v[72:75], a[36:39]
  ds_read_b64_tr_b16 a[162:163], v220 offset:53248
  v_add_f32 v208, v208, v245
  v_mfma_f32_16x16x32_bf16 a[40:43], a[176:179], v[80:83], a[40:43]
  v_add_f32 v209, v209, v246
  v_add_f32 v210, v210, v247
  v_mfma_f32_16x16x32_bf16 a[40:43], a[180:183], v[112:115], a[40:43]
  ds_read_b64_tr_b16 a[164:165], v220 offset:57344
  v_add_f32 v211, v211, v248
  buffer_load_dwordx4 a[132:135], v242, s[24:27], s5 offen offset:0 sc1
  buffer_load_dwordx4 a[136:139], v242, s[24:27], s5 offen offset:1024 sc1
  buffer_load_dwordx4 a[140:143], v242, s[24:27], s5 offen offset:2048 sc1
  buffer_load_dwordx4 a[144:147], v242, s[24:27], s5 offen offset:3072 sc1
  buffer_load_dwordx4 a[148:151], v252, s[24:27], s5 offen offset:0 sc1
  buffer_load_dwordx4 a[152:155], v252, s[24:27], s5 offen offset:1024 sc1
  buffer_load_dwordx4 a[156:159], v252, s[24:27], s5 offen offset:2048 sc1
  v_mfma_f32_16x16x32_bf16 a[44:47], a[180:183], v[120:123], a[44:47]
  v_rcp_f32 v192, v208
  v_mfma_f32_16x16x32_bf16 a[44:47], a[176:179], v[88:91], a[44:47]
  ds_read_b64_tr_b16 a[166:167], v220 offset:61440
  s_waitcnt lgkmcnt(4)
  v_mfma_f32_16x16x32_bf16 a[48:51], a[184:187], v[64:67], a[48:51]
  v_rcp_f32 v196, v209
  v_mfma_f32_16x16x32_bf16 a[48:51], a[188:191], v[96:99], a[48:51]
  ds_read_b64_tr_b16 a[168:169], v221 offset:49152
  v_mfma_f32_16x16x32_bf16 a[52:55], a[188:191], v[104:107], a[52:55]
  v_rcp_f32 v200, v210
  v_mfma_f32_16x16x32_bf16 a[52:55], a[184:187], v[72:75], a[52:55]
  ds_read_b64_tr_b16 a[170:171], v221 offset:53248
  v_mfma_f32_16x16x32_bf16 a[56:59], a[184:187], v[80:83], a[56:59]
  v_rcp_f32 v204, v211
  v_mfma_f32_16x16x32_bf16 a[56:59], a[188:191], v[112:115], a[56:59]
  ds_read_b64_tr_b16 a[172:173], v221 offset:57344
  v_add_f32 v246, v208, v209
  v_mfma_f32_16x16x32_bf16 a[60:63], a[188:191], v[120:123], a[60:63]
  v_add_f32 v247, v210, v211
  v_add_f32 v246, v246, v247
  v_mfma_f32_16x16x32_bf16 a[60:63], a[184:187], v[88:91], a[60:63]
  ds_read_b64_tr_b16 a[174:175], v221 offset:61440
  s_waitcnt lgkmcnt(4)
  v_lshrrev_b32 v247, 2, v242
  v_mfma_f32_16x16x32_bf16 a[64:67], a[160:163], v[64:67], a[64:67]
  v_cmp_nlt_f32 vcc, v246, s48
  v_add_u32 v247, s39, v247
  v_mfma_f32_16x16x32_bf16 a[64:67], a[164:167], v[96:99], a[64:67]
  ds_read_b64_tr_b16 a[176:177], v222 offset:49152
  v_add_u32 v247, 157696, v247
  v_mfma_f32_16x16x32_bf16 a[68:71], a[164:167], v[104:107], a[68:71]
  v_cndmask_b32_e64 v245, 0, 1, vcc
  v_accvgpr_read_b32 v0, a0
  v_mfma_f32_16x16x32_bf16 a[68:71], a[160:163], v[72:75], a[68:71]
  ds_read_b64_tr_b16 a[178:179], v222 offset:53248
  v_accvgpr_read_b32 v1, a1
  v_mfma_f32_16x16x32_bf16 a[72:75], a[160:163], v[80:83], a[72:75]
  v_accvgpr_read_b32 v2, a2
  v_accvgpr_read_b32 v3, a3
  v_mfma_f32_16x16x32_bf16 a[72:75], a[164:167], v[112:115], a[72:75]
  ds_read_b64_tr_b16 a[180:181], v222 offset:57344
  v_accvgpr_read_b32 v4, a16
  v_mfma_f32_16x16x32_bf16 a[76:79], a[164:167], v[120:123], a[76:79]
  v_accvgpr_read_b32 v5, a17
  v_accvgpr_read_b32 v6, a18
  v_mfma_f32_16x16x32_bf16 a[76:79], a[160:163], v[88:91], a[76:79]
  ds_read_b64_tr_b16 a[182:183], v222 offset:61440
  s_waitcnt lgkmcnt(4)
  v_accvgpr_read_b32 v7, a19
  v_mfma_f32_16x16x32_bf16 a[80:83], a[168:171], v[64:67], a[80:83]
  v_mul_f32 v0, v0, v192
  v_mul_f32 v1, v1, v192
  v_mfma_f32_16x16x32_bf16 a[80:83], a[172:175], v[96:99], a[80:83]
  ds_read_b64_tr_b16 a[184:185], v223 offset:49152
  v_mul_f32 v2, v2, v192
  v_mfma_f32_16x16x32_bf16 a[84:87], a[172:175], v[104:107], a[84:87]
  v_mul_f32 v3, v3, v192
  v_mul_f32 v4, v4, v192
  v_mfma_f32_16x16x32_bf16 a[84:87], a[168:171], v[72:75], a[84:87]
  ds_read_b64_tr_b16 a[186:187], v223 offset:53248
  v_mul_f32 v5, v5, v192
  v_mfma_f32_16x16x32_bf16 a[88:91], a[168:171], v[80:83], a[88:91]
  v_mul_f32 v6, v6, v192
  v_mul_f32 v7, v7, v192
  v_mfma_f32_16x16x32_bf16 a[88:91], a[172:175], v[112:115], a[88:91]
  ds_read_b64_tr_b16 a[188:189], v223 offset:57344
  v_cvt_pk_bf16_f32 v0, v0, v1
  v_mfma_f32_16x16x32_bf16 a[92:95], a[172:175], v[120:123], a[92:95]
  v_cvt_pk_bf16_f32 v1, v2, v3
  v_cvt_pk_bf16_f32 v2, v4, v5
  v_mfma_f32_16x16x32_bf16 a[92:95], a[168:171], v[88:91], a[92:95]
  ds_read_b64_tr_b16 a[190:191], v223 offset:61440
  s_waitcnt lgkmcnt(4)
  v_cvt_pk_bf16_f32 v3, v6, v7
  v_mfma_f32_16x16x32_bf16 a[96:99], a[176:179], v[64:67], a[96:99]
  buffer_store_dwordx4 v[0:3], v244, s[24:27], s40 offen offset:0 sc1
  v_mfma_f32_16x16x32_bf16 a[96:99], a[180:183], v[96:99], a[96:99]
  v_accvgpr_read_b32 v8, a4
  v_accvgpr_read_b32 v9, a5
  v_mfma_f32_16x16x32_bf16 a[100:103], a[180:183], v[104:107], a[100:103]
  v_accvgpr_read_b32 v10, a6
  v_accvgpr_read_b32 v11, a7
  v_mfma_f32_16x16x32_bf16 a[100:103], a[176:179], v[72:75], a[100:103]
  v_accvgpr_read_b32 v12, a20
  v_accvgpr_read_b32 v13, a21
  v_mfma_f32_16x16x32_bf16 a[104:107], a[176:179], v[80:83], a[104:107]
  v_accvgpr_read_b32 v14, a22
  v_accvgpr_read_b32 v15, a23
  v_mfma_f32_16x16x32_bf16 a[104:107], a[180:183], v[112:115], a[104:107]
  v_mul_f32 v8, v8, v196
  v_mul_f32 v9, v9, v196
  v_mfma_f32_16x16x32_bf16 a[108:111], a[180:183], v[120:123], a[108:111]
  v_mul_f32 v10, v10, v196
  v_mul_f32 v11, v11, v196
  v_mfma_f32_16x16x32_bf16 a[108:111], a[176:179], v[88:91], a[108:111]
  s_waitcnt lgkmcnt(0)
  v_mul_f32 v12, v12, v196
  v_mul_f32 v13, v13, v196
  v_mfma_f32_16x16x32_bf16 a[112:115], a[184:187], v[64:67], a[112:115]
  v_mul_f32 v14, v14, v196
  v_mul_f32 v15, v15, v196
  v_mfma_f32_16x16x32_bf16 a[112:115], a[188:191], v[96:99], a[112:115]
  v_cvt_pk_bf16_f32 v8, v8, v9
  v_cvt_pk_bf16_f32 v9, v10, v11
  v_mfma_f32_16x16x32_bf16 a[116:119], a[188:191], v[104:107], a[116:119]
  v_cvt_pk_bf16_f32 v10, v12, v13
  v_cvt_pk_bf16_f32 v11, v14, v15
  v_mfma_f32_16x16x32_bf16 a[116:119], a[184:187], v[72:75], a[116:119]
  buffer_store_dwordx4 v[8:11], v244, s[24:27], s40 offen offset:2048 sc1
  v_mfma_f32_16x16x32_bf16 a[120:123], a[184:187], v[80:83], a[120:123]
  v_accvgpr_read_b32 v16, a8
  v_accvgpr_read_b32 v17, a9
  v_mfma_f32_16x16x32_bf16 a[120:123], a[188:191], v[112:115], a[120:123]
  v_accvgpr_read_b32 v18, a10
  v_accvgpr_read_b32 v19, a11
  v_mfma_f32_16x16x32_bf16 a[124:127], a[188:191], v[120:123], a[124:127]
  v_accvgpr_read_b32 v20, a24
  v_accvgpr_read_b32 v21, a25
  v_mfma_f32_16x16x32_bf16 a[124:127], a[184:187], v[88:91], a[124:127]
  v_accvgpr_read_b32 v22, a26
  v_accvgpr_read_b32 v23, a27
  v_pk_mul_f32 v[16:17], v[16:17], v[200:201] op_sel_hi:[1,0]
  v_pk_mul_f32 v[18:19], v[18:19], v[200:201] op_sel_hi:[1,0]
  v_pk_mul_f32 v[20:21], v[20:21], v[200:201] op_sel_hi:[1,0]
  v_pk_mul_f32 v[22:23], v[22:23], v[200:201] op_sel_hi:[1,0]
  v_cvt_pk_bf16_f32 v16, v16, v17
  v_cvt_pk_bf16_f32 v17, v18, v19
  v_cvt_pk_bf16_f32 v18, v20, v21
  v_cvt_pk_bf16_f32 v19, v22, v23
  buffer_store_dwordx4 v[16:19], v244, s[24:27], s41 offen offset:0 sc1
  v_accvgpr_read_b32 v24, a12
  v_accvgpr_read_b32 v25, a13
  v_accvgpr_read_b32 v26, a14
  v_accvgpr_read_b32 v27, a15
  v_accvgpr_read_b32 v28, a28
  v_accvgpr_read_b32 v29, a29
  v_accvgpr_read_b32 v30, a30
  v_accvgpr_read_b32 v31, a31
  v_pk_mul_f32 v[24:25], v[24:25], v[204:205] op_sel_hi:[1,0]
  v_pk_mul_f32 v[26:27], v[26:27], v[204:205] op_sel_hi:[1,0]
  v_pk_mul_f32 v[28:29], v[28:29], v[204:205] op_sel_hi:[1,0]
  v_pk_mul_f32 v[30:31], v[30:31], v[204:205] op_sel_hi:[1,0]
  v_cvt_pk_bf16_f32 v24, v24, v25
  v_cvt_pk_bf16_f32 v25, v26, v27
  v_cvt_pk_bf16_f32 v26, v28, v29
  v_cvt_pk_bf16_f32 v27, v30, v31
  buffer_store_dwordx4 v[24:27], v244, s[24:27], s41 offen offset:2048 sc1
  v_accvgpr_read_b32 v32, a32
  v_accvgpr_read_b32 v33, a33
  v_accvgpr_read_b32 v34, a34
  v_accvgpr_read_b32 v35, a35
  v_accvgpr_read_b32 v36, a48
  v_accvgpr_read_b32 v37, a49
  v_accvgpr_read_b32 v38, a50
  v_accvgpr_read_b32 v39, a51
  v_pk_mul_f32 v[32:33], v[32:33], v[192:193] op_sel_hi:[1,0]
  v_pk_mul_f32 v[34:35], v[34:35], v[192:193] op_sel_hi:[1,0]
  v_pk_mul_f32 v[36:37], v[36:37], v[192:193] op_sel_hi:[1,0]
  v_pk_mul_f32 v[38:39], v[38:39], v[192:193] op_sel_hi:[1,0]
  v_cvt_pk_bf16_f32 v32, v32, v33
  v_cvt_pk_bf16_f32 v33, v34, v35
  v_cvt_pk_bf16_f32 v34, v36, v37
  v_cvt_pk_bf16_f32 v35, v38, v39
  buffer_store_dwordx4 v[32:35], v244, s[24:27], s40 offen offset:1024 sc1
  v_accvgpr_read_b32 v40, a36
  v_accvgpr_read_b32 v41, a37
  v_accvgpr_read_b32 v42, a38
  v_accvgpr_read_b32 v43, a39
  v_accvgpr_read_b32 v44, a52
  v_accvgpr_read_b32 v45, a53
  v_accvgpr_read_b32 v46, a54
  v_accvgpr_read_b32 v47, a55
  v_pk_mul_f32 v[40:41], v[40:41], v[196:197] op_sel_hi:[1,0]
  v_pk_mul_f32 v[42:43], v[42:43], v[196:197] op_sel_hi:[1,0]
  v_pk_mul_f32 v[44:45], v[44:45], v[196:197] op_sel_hi:[1,0]
  v_pk_mul_f32 v[46:47], v[46:47], v[196:197] op_sel_hi:[1,0]
  v_cvt_pk_bf16_f32 v40, v40, v41
  v_cvt_pk_bf16_f32 v41, v42, v43
  v_cvt_pk_bf16_f32 v42, v44, v45
  v_cvt_pk_bf16_f32 v43, v46, v47
  buffer_store_dwordx4 v[40:43], v244, s[24:27], s40 offen offset:3072 sc1
  v_accvgpr_read_b32 v48, a40
  v_accvgpr_read_b32 v49, a41
  v_accvgpr_read_b32 v50, a42
  v_accvgpr_read_b32 v51, a43
  v_accvgpr_read_b32 v52, a56
  v_accvgpr_read_b32 v53, a57
  v_accvgpr_read_b32 v54, a58
  v_accvgpr_read_b32 v55, a59
  v_pk_mul_f32 v[48:49], v[48:49], v[200:201] op_sel_hi:[1,0]
  v_pk_mul_f32 v[50:51], v[50:51], v[200:201] op_sel_hi:[1,0]
  v_pk_mul_f32 v[52:53], v[52:53], v[200:201] op_sel_hi:[1,0]
  v_pk_mul_f32 v[54:55], v[54:55], v[200:201] op_sel_hi:[1,0]
  v_cvt_pk_bf16_f32 v48, v48, v49
  v_cvt_pk_bf16_f32 v49, v50, v51
  v_cvt_pk_bf16_f32 v50, v52, v53
  v_cvt_pk_bf16_f32 v51, v54, v55
  buffer_store_dwordx4 v[48:51], v244, s[24:27], s41 offen offset:1024 sc1
  v_accvgpr_read_b32 v56, a44
  v_accvgpr_read_b32 v57, a45
  v_accvgpr_read_b32 v58, a46
  v_accvgpr_read_b32 v59, a47
  v_accvgpr_read_b32 v60, a60
  v_accvgpr_read_b32 v61, a61
  v_accvgpr_read_b32 v62, a62
  v_accvgpr_read_b32 v63, a63
  v_pk_mul_f32 v[56:57], v[56:57], v[204:205] op_sel_hi:[1,0]
  v_pk_mul_f32 v[58:59], v[58:59], v[204:205] op_sel_hi:[1,0]
  v_pk_mul_f32 v[60:61], v[60:61], v[204:205] op_sel_hi:[1,0]
  v_pk_mul_f32 v[62:63], v[62:63], v[204:205] op_sel_hi:[1,0]
  v_cvt_pk_bf16_f32 v56, v56, v57
  v_cvt_pk_bf16_f32 v57, v58, v59
  v_cvt_pk_bf16_f32 v58, v60, v61
  v_cvt_pk_bf16_f32 v59, v62, v63
  buffer_store_dwordx4 v[56:59], v244, s[24:27], s41 offen offset:3072 sc1
  v_accvgpr_read_b32 v0, a64
  v_accvgpr_read_b32 v1, a65
  v_accvgpr_read_b32 v2, a66
  v_accvgpr_read_b32 v3, a67
  v_accvgpr_read_b32 v4, a80
  v_accvgpr_read_b32 v5, a81
  v_accvgpr_read_b32 v6, a82
  v_accvgpr_read_b32 v7, a83
  v_pk_mul_f32 v[0:1], v[0:1], v[192:193] op_sel_hi:[1,0]
  v_pk_mul_f32 v[2:3], v[2:3], v[192:193] op_sel_hi:[1,0]
  v_pk_mul_f32 v[4:5], v[4:5], v[192:193] op_sel_hi:[1,0]
  v_pk_mul_f32 v[6:7], v[6:7], v[192:193] op_sel_hi:[1,0]
  v_cvt_pk_bf16_f32 v0, v0, v1
  v_cvt_pk_bf16_f32 v1, v2, v3
  v_cvt_pk_bf16_f32 v2, v4, v5
  v_cvt_pk_bf16_f32 v3, v6, v7
  buffer_store_dwordx4 v[0:3], v244, s[24:27], s42 offen offset:0 sc1
  v_accvgpr_read_b32 v8, a68
  v_accvgpr_read_b32 v9, a69
  v_accvgpr_read_b32 v10, a70
  v_accvgpr_read_b32 v11, a71
  v_accvgpr_read_b32 v12, a84
  v_accvgpr_read_b32 v13, a85
  v_accvgpr_read_b32 v14, a86
  v_accvgpr_read_b32 v15, a87
  v_pk_mul_f32 v[8:9], v[8:9], v[196:197] op_sel_hi:[1,0]
  v_pk_mul_f32 v[10:11], v[10:11], v[196:197] op_sel_hi:[1,0]
  v_pk_mul_f32 v[12:13], v[12:13], v[196:197] op_sel_hi:[1,0]
  v_pk_mul_f32 v[14:15], v[14:15], v[196:197] op_sel_hi:[1,0]
  v_cvt_pk_bf16_f32 v8, v8, v9
  v_cvt_pk_bf16_f32 v9, v10, v11
  v_cvt_pk_bf16_f32 v10, v12, v13
  v_cvt_pk_bf16_f32 v11, v14, v15
  buffer_store_dwordx4 v[8:11], v244, s[24:27], s42 offen offset:2048 sc1
  v_accvgpr_read_b32 v16, a72
  v_accvgpr_read_b32 v17, a73
  v_accvgpr_read_b32 v18, a74
  v_accvgpr_read_b32 v19, a75
  v_accvgpr_read_b32 v20, a88
  v_accvgpr_read_b32 v21, a89
  v_accvgpr_read_b32 v22, a90
  v_accvgpr_read_b32 v23, a91
  v_pk_mul_f32 v[16:17], v[16:17], v[200:201] op_sel_hi:[1,0]
  v_pk_mul_f32 v[18:19], v[18:19], v[200:201] op_sel_hi:[1,0]
  v_pk_mul_f32 v[20:21], v[20:21], v[200:201] op_sel_hi:[1,0]
  v_pk_mul_f32 v[22:23], v[22:23], v[200:201] op_sel_hi:[1,0]
  v_cvt_pk_bf16_f32 v16, v16, v17
  v_cvt_pk_bf16_f32 v17, v18, v19
  v_cvt_pk_bf16_f32 v18, v20, v21
  v_cvt_pk_bf16_f32 v19, v22, v23
  buffer_store_dwordx4 v[16:19], v244, s[24:27], s43 offen offset:0 sc1
  v_accvgpr_read_b32 v24, a76
  v_accvgpr_read_b32 v25, a77
  v_accvgpr_read_b32 v26, a78
  v_accvgpr_read_b32 v27, a79
  v_accvgpr_read_b32 v28, a92
  v_accvgpr_read_b32 v29, a93
  v_accvgpr_read_b32 v30, a94
  v_accvgpr_read_b32 v31, a95
  v_pk_mul_f32 v[24:25], v[24:25], v[204:205] op_sel_hi:[1,0]
  v_pk_mul_f32 v[26:27], v[26:27], v[204:205] op_sel_hi:[1,0]
  v_pk_mul_f32 v[28:29], v[28:29], v[204:205] op_sel_hi:[1,0]
  v_pk_mul_f32 v[30:31], v[30:31], v[204:205] op_sel_hi:[1,0]
  v_cvt_pk_bf16_f32 v24, v24, v25
  v_cvt_pk_bf16_f32 v25, v26, v27
  v_cvt_pk_bf16_f32 v26, v28, v29
  v_cvt_pk_bf16_f32 v27, v30, v31
  buffer_store_dwordx4 v[24:27], v244, s[24:27], s43 offen offset:2048 sc1
  v_accvgpr_read_b32 v32, a96
  v_accvgpr_read_b32 v33, a97
  v_accvgpr_read_b32 v34, a98
  v_accvgpr_read_b32 v35, a99
  v_accvgpr_read_b32 v36, a112
  v_accvgpr_read_b32 v37, a113
  v_accvgpr_read_b32 v38, a114
  v_accvgpr_read_b32 v39, a115
  v_pk_mul_f32 v[32:33], v[32:33], v[192:193] op_sel_hi:[1,0]
  v_pk_mul_f32 v[34:35], v[34:35], v[192:193] op_sel_hi:[1,0]
  v_pk_mul_f32 v[36:37], v[36:37], v[192:193] op_sel_hi:[1,0]
  v_pk_mul_f32 v[38:39], v[38:39], v[192:193] op_sel_hi:[1,0]
  v_cvt_pk_bf16_f32 v32, v32, v33
  v_cvt_pk_bf16_f32 v33, v34, v35
  v_cvt_pk_bf16_f32 v34, v36, v37
  v_cvt_pk_bf16_f32 v35, v38, v39
  buffer_store_dwordx4 v[32:35], v244, s[24:27], s42 offen offset:1024 sc1
  v_accvgpr_read_b32 v40, a100
  v_accvgpr_read_b32 v41, a101
  v_accvgpr_read_b32 v42, a102
  v_accvgpr_read_b32 v43, a103
  v_accvgpr_read_b32 v44, a116
  v_accvgpr_read_b32 v45, a117
  v_accvgpr_read_b32 v46, a118
  v_accvgpr_read_b32 v47, a119
  v_pk_mul_f32 v[40:41], v[40:41], v[196:197] op_sel_hi:[1,0]
  v_pk_mul_f32 v[42:43], v[42:43], v[196:197] op_sel_hi:[1,0]
  v_pk_mul_f32 v[44:45], v[44:45], v[196:197] op_sel_hi:[1,0]
  v_pk_mul_f32 v[46:47], v[46:47], v[196:197] op_sel_hi:[1,0]
  v_cvt_pk_bf16_f32 v40, v40, v41
  v_cvt_pk_bf16_f32 v41, v42, v43
  v_cvt_pk_bf16_f32 v42, v44, v45
  v_cvt_pk_bf16_f32 v43, v46, v47
  buffer_store_dwordx4 v[40:43], v244, s[24:27], s42 offen offset:3072 sc1
  v_accvgpr_read_b32 v48, a104
  v_accvgpr_read_b32 v49, a105
  v_accvgpr_read_b32 v50, a106
  v_accvgpr_read_b32 v51, a107
  v_accvgpr_read_b32 v52, a120
  v_accvgpr_read_b32 v53, a121
  v_accvgpr_read_b32 v54, a122
  v_accvgpr_read_b32 v55, a123
  v_pk_mul_f32 v[48:49], v[48:49], v[200:201] op_sel_hi:[1,0]
  v_pk_mul_f32 v[50:51], v[50:51], v[200:201] op_sel_hi:[1,0]
  v_pk_mul_f32 v[52:53], v[52:53], v[200:201] op_sel_hi:[1,0]
  v_pk_mul_f32 v[54:55], v[54:55], v[200:201] op_sel_hi:[1,0]
  v_cvt_pk_bf16_f32 v48, v48, v49
  v_cvt_pk_bf16_f32 v49, v50, v51
  v_cvt_pk_bf16_f32 v50, v52, v53
  v_cvt_pk_bf16_f32 v51, v54, v55
  buffer_store_dwordx4 v[48:51], v244, s[24:27], s43 offen offset:1024 sc1
  v_accvgpr_read_b32 v56, a108
  v_accvgpr_read_b32 v57, a109
  v_accvgpr_read_b32 v58, a110
  v_accvgpr_read_b32 v59, a111
  v_accvgpr_read_b32 v60, a124
  v_accvgpr_read_b32 v61, a125
  v_accvgpr_read_b32 v62, a126
  v_accvgpr_read_b32 v63, a127
  v_pk_mul_f32 v[56:57], v[56:57], v[204:205] op_sel_hi:[1,0]
  v_pk_mul_f32 v[58:59], v[58:59], v[204:205] op_sel_hi:[1,0]
  v_pk_mul_f32 v[60:61], v[60:61], v[204:205] op_sel_hi:[1,0]
  v_pk_mul_f32 v[62:63], v[62:63], v[204:205] op_sel_hi:[1,0]
  v_cvt_pk_bf16_f32 v56, v56, v57
  v_cvt_pk_bf16_f32 v57, v58, v59
  v_cvt_pk_bf16_f32 v58, v60, v61
  v_cvt_pk_bf16_f32 v59, v62, v63
  buffer_store_dwordx4 v[56:59], v244, s[24:27], s43 offen offset:3072 sc1
  ds_write_b32 v247, v245
  buffer_load_dwordx4 a[0:3], v252, s[24:27], s5 offen offset:3072 sc1
  buffer_load_dwordx4 a[4:7], v253, s[24:27], s5 offen offset:0 sc1
  buffer_load_dwordx4 a[8:11], v253, s[24:27], s5 offen offset:1024 sc1
  buffer_load_dwordx4 a[12:15], v253, s[24:27], s5 offen offset:2048 sc1
  buffer_load_dwordx4 a[16:19], v253, s[24:27], s5 offen offset:3072 sc1
  buffer_load_dwordx4 a[20:23], v242, s[24:27], s6 offen offset:0 sc1
  buffer_load_dwordx4 a[24:27], v242, s[24:27], s6 offen offset:1024 sc1
  buffer_load_dwordx4 a[28:31], v242, s[24:27], s6 offen offset:2048 sc1
  buffer_load_dwordx4 a[32:35], v242, s[24:27], s6 offen offset:3072 sc1
  buffer_load_dwordx4 a[36:39], v252, s[24:27], s6 offen offset:0 sc1
  s_and_b32 s39, s2, 63
  s_lshl_b32 s39, s39, 7
  s_add_u32 s39, s39, 2867200
  s_lshl_b32 s38, s3, 26
  v_lshlrev_b32 v64, 22, v242
  v_or_b32 v64, s38, v64
  v_mov_b32 v65, 1
  v_add_u32 v246, 157696, v242
  s_waitcnt vmcnt(10) lgkmcnt(0)
  s_barrier
  ds_read_b128 v[68:71], v246
  s_waitcnt lgkmcnt(0)
  v_or3_b32 v68, v68, v69, v70
  v_or_b32 v68, v68, v71
  v_cmp_ne_u32 vcc, 0, v68
  s_nop 0
  s_cbranch_vccnz attn_redo
tail_go:
  buffer_atomic_add v65, v64, s[24:27], s39 offen
  s_and_b32 s36, s2, 1
  s_bfe_u32 s31, s2, 0x20001
  s_lshl_b32 s31, s31, 2
  s_bfe_u32 s38, s2, 0x20003
  s_add_u32 s31, s31, s38
  s_lshr_b32 s29, s2, 5
  v_mov_b32 v114, v242
  v_add_u32 v115, 0x1000, v114
  v_add_u32 v116, 0x2000, v114
  s_lshl_b32 s38, s36, 2
  s_add_u32 s38, s38, s3
  s_lshl_b32 s30, s38, 16
  buffer_load_dwordx4 a[40:43], v115, s[24:27], s6 offen offset:1024 sc1
  buffer_load_dwordx4 a[44:47], v115, s[24:27], s6 offen offset:2048 sc1
  buffer_load_dwordx4 a[48:51], v115, s[24:27], s6 offen offset:3072 sc1
  buffer_load_dwordx4 a[52:55], v116, s[24:27], s6 offen offset:0 sc1
  v_lshrrev_b32 v125, 4, v114
  v_and_b32 v126, 15, v125
  v_lshrrev_b32 v127, 4, v125
  s_add_u32 s38, s3, 0
  s_and_b32 s38, s38, 3
  s_lshl_b32 s38, s38, 11
  v_add_u32 v110, s38, v114
  s_sub_u32 s38, s3, 0
  s_and_b32 s38, s38, 3
  s_mul_i32 s38, s38, 15360
  s_add_u32 s38, s38, 98304
  v_add_u32 v118, s38, v114
  s_add_u32 s38, s3, 1
  s_and_b32 s38, s38, 3
  s_lshl_b32 s38, s38, 11
  v_add_u32 v111, s38, v114
  s_sub_u32 s38, s3, 1
  s_and_b32 s38, s38, 3
  s_mul_i32 s38, s38, 15360
  s_add_u32 s38, s38, 98304
  v_add_u32 v119, s38, v114
  s_add_u32 s38, s3, 2
  s_and_b32 s38, s38, 3
  s_lshl_b32 s38, s38, 11
  v_add_u32 v112, s38, v114
  s_sub_u32 s38, s3, 2
  s_and_b32 s38, s38, 3
  s_mul_i32 s38, s38, 15360
  s_add_u32 s38, s38, 98304
  v_add_u32 v120, s38, v114
  s_add_u32 s38, s3, 3
  s_and_b32 s38, s38, 3
  s_lshl_b32 s38, s38, 11
  v_add_u32 v113, s38, v114
  s_sub_u32 s38, s3, 3
  s_and_b32 s38, s38, 3
  s_mul_i32 s38, s38, 15360
  s_add_u32 s38, s38, 98304
  v_add_u32 v121, s38, v114
  v_add_u32 v122, s28, v114
  v_add_u32 v135, 0x10000, v122
  s_and_b32 s38, s31, 14
  s_add_u32 s38, s38, s36
  s_lshl_b32 s38, s38, 2
  s_add_u32 s38, s38, s3
  s_lshl_b32 s38, s38, 7
  s_add_u32 s38, s38, 2867200
  s_lshl_b32 s39, s29, 8
  s_add_u32 s39, s39, 2818304
  v_mov_b32 v133, s38
  v_writelane_b32 v133, s39, 1
  v_mov_b32 v134, 4
  v_writelane_b32 v134, 30, 1
  s_lshl_b32 s31, s31, 1
  s_add_u32 s31, s31, s36
  s_add_u32 s30, s30, 8388608
  s_lshl_b32 s38, s31, 19
  s_add_u32 s37, s30, s38
  s_xor_b32 s38, s38, 0x80000
  s_add_u32 s30, s30, s38
  s_lshl_b32 s40, s29, 5
  s_add_u32 s40, s40, s31
  s_lshl_b32 s38, s31, 6
  s_lshl_b32 s39, s3, 4
  s_add_u32 s38, s38, s39
  v_add_u32 v128, s38, v126
  v_mul_u32_u24 v117, 0x500, v128
  v_lshl_add_u32 v117, v127, 3, v117
  s_mul_i32 s38, s29, 160
  v_add_u32 v117, s38, v117
  s_mov_b32 s12, s60
  s_mov_b32 s13, s61
  s_mov_b32 s14, 2621440
  s_mov_b32 s15, 0x20000
  s_mov_b32 s16, s62
  s_mov_b32 s17, s63
  s_mov_b32 s18, 2621440
  s_mov_b32 s19, 0x20000
  s_mul_i32 s38, s31, 81920
  s_lshl_b32 s39, s3, 10
  s_add_u32 s38, s38, s39
  s_mul_i32 s39, s29, 10
  v_lshrrev_b32 v129, 1, v127
  v_add_u32 v129, s39, v129
  v_and_b32 v130, 1, v127
  v_lshlrev_b32 v130, 3, v130
  v_lshl_add_u32 v130, v126, 4, v130
  v_lshrrev_b32 v131, 2, v129
  v_lshl_add_u32 v131, v131, 12, v130
  v_and_b32 v132, 3, v129
  v_lshl_add_u32 v131, v132, 8, v131
  buffer_load_dwordx2 v[156:157], v131, s[24:27], s38 offen sc1
  v_add_u32 v129, 2, v129
  buffer_load_dwordx2 v[80:81], v117, s[12:15], 0 offen offset:0
  v_lshrrev_b32 v131, 2, v129
  v_lshl_add_u32 v131, v131, 12, v130
  v_and_b32 v132, 3, v129
  v_lshl_add_u32 v131, v132, 8, v131
  buffer_load_dwordx2 v[158:159], v131, s[24:27], s38 offen sc1
  v_add_u32 v129, 2, v129
  buffer_load_dwordx2 v[82:83], v117, s[12:15], 0 offen offset:32
  v_lshrrev_b32 v131, 2, v129
  v_lshl_add_u32 v131, v131, 12, v130
  v_and_b32 v132, 3, v129
  v_lshl_add_u32 v131, v132, 8, v131
  buffer_load_dwordx2 v[160:161], v131, s[24:27], s38 offen sc1
  v_add_u32 v129, 2, v129
  buffer_load_dwordx2 v[84:85], v117, s[12:15], 0 offen offset:64
  v_lshrrev_b32 v131, 2, v129
  v_lshl_add_u32 v131, v131, 12, v130
  v_and_b32 v132, 3, v129
  v_lshl_add_u32 v131, v132, 8, v131
  buffer_load_dwordx2 v[162:163], v131, s[24:27], s38 offen sc1
  v_add_u32 v129, 2, v129
  buffer_load_dwordx2 v[86:87], v117, s[12:15], 0 offen offset:96
  v_lshrrev_b32 v131, 2, v129
  v_lshl_add_u32 v131, v131, 12, v130
  v_and_b32 v132, 3, v129
  v_lshl_add_u32 v131, v132, 8, v131
  buffer_load_dwordx2 v[164:165], v131, s[24:27], s38 offen sc1
  v_add_u32 v129, 2, v129
  buffer_load_dwordx2 v[88:89], v117, s[12:15], 0 offen offset:128
  v_mov_b32 v123, 1073741824
  v_bfrev_b32 v124, 1
  v_sub_u32 v128, 0xffff, v128
  s_mov_b32 s34, 0xffff0000
  s_and_b32 s38, s52, 0xffff
  v_cmp_eq_u32 vcc, s38, v128
  v_mov_b32 v129, s52
  v_mov_b32 v130, 0
  v_cndmask_b32 v124, v124, v129, vcc
  v_cndmask_b32 v123, v123, v130, vcc
  s_and_b32 s38, s53, 0xffff
  v_cmp_eq_u32 vcc, s38, v128
  v_mov_b32 v129, s53
  v_mov_b32 v130, 2560
  v_cndmask_b32 v124, v124, v129, vcc
  v_cndmask_b32 v123, v123, v130, vcc
  s_and_b32 s38, s54, 0xffff
  v_cmp_eq_u32 vcc, s38, v128
  v_mov_b32 v129, s54
  v_mov_b32 v130, 5120
  v_cndmask_b32 v124, v124, v129, vcc
  v_cndmask_b32 v123, v123, v130, vcc
  s_and_b32 s38, s55, 0xffff
  v_cmp_eq_u32 vcc, s38, v128
  v_mov_b32 v129, s55
  v_mov_b32 v130, 7680
  v_cndmask_b32 v124, v124, v129, vcc
  v_cndmask_b32 v123, v123, v130, vcc
  s_and_b32 s38, s56, 0xffff
  v_cmp_eq_u32 vcc, s38, v128
  v_mov_b32 v129, s56
  v_mov_b32 v130, 10240
  v_cndmask_b32 v124, v124, v129, vcc
  v_cndmask_b32 v123, v123, v130, vcc
  s_and_b32 s38, s57, 0xffff
  v_cmp_eq_u32 vcc, s38, v128
  v_mov_b32 v129, s57
  v_mov_b32 v130, 12800
  v_cndmask_b32 v124, v124, v129, vcc
  v_cndmask_b32 v123, v123, v130, vcc
  s_and_b32 s38, s58, 0xffff
  v_cmp_eq_u32 vcc, s38, v128
  v_mov_b32 v129, s58
  v_mov_b32 v130, 15360
  v_cndmask_b32 v124, v124, v129, vcc
  v_cndmask_b32 v123, v123, v130, vcc
  s_and_b32 s38, s59, 0xffff
  v_cmp_eq_u32 vcc, s38, v128
  v_mov_b32 v129, s59
  v_mov_b32 v130, 17920
  v_cndmask_b32 v124, v124, v129, vcc
  v_cndmask_b32 v123, v123, v130, vcc
  v_lshl_add_u32 v123, v127, 4, v123
  s_mul_i32 s32, s29, 320
  s_add_u32 s32, s32, 2686976
  v_ashrrev_i32 v129, 31, v124
  v_not_b32 v129, v129
  v_or_b32 v129, 0x80000000, v129
  v_xor_b32 v124, v124, v129
  v_and_b32 v124, s34, v124
  v_mul_f32 v124, 0xbfb8aa3b, v124
  v_exp_f32 v124, v124
  s_nop 0
  v_add_f32 v124, 1.0, v124
  v_rcp_f32 v124, v124
  s_nop 0
  v_cvt_pk_bf16_f32 v124, v124, v124
  v_lshlrev_b32 v124, 16, v124
  buffer_load_dword v128, v133, s[24:27], 0 offen sc1
  buffer_load_dwordx4 a[56:59], v116, s[24:27], s6 offen offset:1024 sc1
  buffer_load_dwordx4 a[60:63], v116, s[24:27], s6 offen offset:2048 sc1
  buffer_load_dwordx4 a[64:67], v116, s[24:27], s6 offen offset:3072 sc1
  buffer_load_dwordx4 a[68:71], v114, s[24:27], s7 offen offset:0 sc1
  buffer_load_dwordx4 a[72:75], v114, s[24:27], s7 offen offset:1024 sc1
  buffer_load_dwordx4 a[76:79], v114, s[24:27], s7 offen offset:2048 sc1
  buffer_load_dwordx4 a[80:83], v114, s[24:27], s7 offen offset:3072 sc1
  buffer_load_dwordx4 a[84:87], v115, s[24:27], s7 offen offset:0 sc1
  buffer_load_dwordx4 a[88:91], v115, s[24:27], s7 offen offset:1024 sc1
  buffer_load_dwordx4 a[92:95], v115, s[24:27], s7 offen offset:2048 sc1
  s_waitcnt vmcnt(20)
  v_lshlrev_b32 v90, 16, v156
  v_and_b32 v91, s34, v156
  v_lshlrev_b32 v92, 16, v157
  v_and_b32 v93, s34, v157
  s_waitcnt vmcnt(18)
  v_lshlrev_b32 v94, 16, v158
  v_and_b32 v95, s34, v158
  v_lshlrev_b32 v96, 16, v159
  v_and_b32 v97, s34, v159
  s_waitcnt vmcnt(16)
  v_lshlrev_b32 v98, 16, v160
  v_and_b32 v99, s34, v160
  v_lshlrev_b32 v100, 16, v161
  v_and_b32 v101, s34, v161
  s_waitcnt vmcnt(14)
  v_lshlrev_b32 v102, 16, v162
  v_and_b32 v103, s34, v162
  v_lshlrev_b32 v104, 16, v163
  v_and_b32 v105, s34, v163
  s_waitcnt vmcnt(12)
  v_lshlrev_b32 v106, 16, v164
  v_and_b32 v107, s34, v164
  v_lshlrev_b32 v108, 16, v165
  v_and_b32 v109, s34, v165
  v_mov_b32 v156, 0
  v_mov_b32 v157, 0
  v_mov_b32 v158, 0
  v_mov_b32 v159, 0
  v_mov_b32 v160, 0
  v_mov_b32 v161, 0
  v_mov_b32 v162, 0
  v_mov_b32 v163, 0
  v_mov_b32 v164, 0
  v_mov_b32 v165, 0
  v_mov_b32 v166, 0
  v_mov_b32 v167, 0
  v_mov_b32 v168, 0
  v_mov_b32 v169, 0
  v_mov_b32 v170, 0
  v_mov_b32 v171, 0
  v_mov_b32 v172, 0
  v_mov_b32 v173, 0
  v_mov_b32 v174, 0
  v_mov_b32 v175, 0
  s_waitcnt vmcnt(10)
  v_cmp_lt_u32 vcc, v128, v134
  s_nop 0
  s_cbranch_vccz tail_ready
  s_waitcnt vmcnt(0)
  s_mov_b32 s35, 32768
  buffer_load_dword v128, v133, s[24:27], 0 offen sc1
  s_sleep 3
  buffer_load_dword v129, v133, s[24:27], 0 offen sc1
  s_sleep 3
tail_spin:
  buffer_load_dword v130, v133, s[24:27], 0 offen sc1
  s_waitcnt vmcnt(2)
  v_cmp_lt_u32 vcc, v128, v134
  s_nop 0
  s_cbranch_vccz tail_ready
  s_sleep 3
  buffer_load_dword v128, v133, s[24:27], 0 offen sc1
  s_waitcnt vmcnt(2)
  v_cmp_lt_u32 vcc, v129, v134
  s_nop 0
  s_cbranch_vccz tail_ready
  s_sleep 3
  buffer_load_dword v129, v133, s[24:27], 0 offen sc1
  s_waitcnt vmcnt(2)
  v_cmp_lt_u32 vcc, v130, v134
  s_nop 0
  s_cbranch_vccz tail_ready
  s_sleep 3
  s_sub_u32 s35, s35, 1
  s_cmp_lg_u32 s35, 0
  s_cbranch_scc1 tail_spin
tail_ready:
  buffer_load_dwordx4 a[180:183], v110, s[24:27], s30 offen offset:0 sc1
  buffer_load_dwordx4 a[184:187], v110, s[24:27], s30 offen offset:1024 sc1
  buffer_load_dwordx4 a[188:191], v111, s[24:27], s30 offen offset:0 sc1
  buffer_load_dwordx4 a[192:195], v111, s[24:27], s30 offen offset:1024 sc1
  buffer_load_dwordx4 a[196:199], v112, s[24:27], s30 offen offset:0 sc1
  buffer_load_dwordx4 a[200:203], v112, s[24:27], s30 offen offset:1024 sc1
  buffer_load_dwordx4 a[204:207], v113, s[24:27], s30 offen offset:0 sc1
  buffer_load_dwordx4 a[208:211], v113, s[24:27], s30 offen offset:1024 sc1
  v_cmp_gt_u32 vcc, 1073741824, v123
  s_nop 0
  s_and_saveexec_b64 s[42:43], vcc
  s_cbranch_execz tail_plain
  s_waitcnt vmcnt(30)
  buffer_load_dwordx4 v[156:159], v123, s[24:27], s32 offen offset:0 sc1
  buffer_load_dwordx4 v[160:163], v123, s[24:27], s32 offen offset:64 sc1
  buffer_load_dwordx4 v[164:167], v123, s[24:27], s32 offen offset:128 sc1
  buffer_load_dwordx4 v[168:171], v123, s[24:27], s32 offen offset:192 sc1
  buffer_load_dwordx4 v[172:175], v123, s[24:27], s32 offen offset:256 sc1
  s_add_u32 s32, s32, 20480
  buffer_load_dwordx4 v[136:139], v123, s[24:27], s32 offen offset:0 sc1
  buffer_load_dwordx4 v[140:143], v123, s[24:27], s32 offen offset:64 sc1
  buffer_load_dwordx4 v[144:147], v123, s[24:27], s32 offen offset:128 sc1
  buffer_load_dwordx4 v[148:151], v123, s[24:27], s32 offen offset:192 sc1
  buffer_load_dwordx4 v[152:155], v123, s[24:27], s32 offen offset:256 sc1
  s_add_u32 s32, s32, 20480
  buffer_load_dwordx4 v[0:3], v123, s[24:27], s32 offen offset:0 sc1
  buffer_load_dwordx4 v[4:7], v123, s[24:27], s32 offen offset:64 sc1
  buffer_load_dwordx4 v[8:11], v123, s[24:27], s32 offen offset:128 sc1
  buffer_load_dwordx4 v[12:15], v123, s[24:27], s32 offen offset:192 sc1
  buffer_load_dwordx4 v[16:19], v123, s[24:27], s32 offen offset:256 sc1
  s_add_u32 s32, s32, 20480
  buffer_load_dwordx4 v[20:23], v123, s[24:27], s32 offen offset:0 sc1
  buffer_load_dwordx4 v[24:27], v123, s[24:27], s32 offen offset:64 sc1
  buffer_load_dwordx4 v[28:31], v123, s[24:27], s32 offen offset:128 sc1
  buffer_load_dwordx4 v[32:35], v123, s[24:27], s32 offen offset:192 sc1
  buffer_load_dwordx4 v[36:39], v123, s[24:27], s32 offen offset:256 sc1
  s_add_u32 s32, s32, 20480
  buffer_load_dwordx4 v[40:43], v123, s[24:27], s32 offen offset:0 sc1
  buffer_load_dwordx4 v[44:47], v123, s[24:27], s32 offen offset:64 sc1
  buffer_load_dwordx4 v[48:51], v123, s[24:27], s32 offen offset:128 sc1
  buffer_load_dwordx4 v[52:55], v123, s[24:27], s32 offen offset:192 sc1
  buffer_load_dwordx4 v[56:59], v123, s[24:27], s32 offen offset:256 sc1
  s_add_u32 s32, s32, 20480
  buffer_load_dwordx4 v[60:63], v123, s[24:27], s32 offen offset:0 sc1
  buffer_load_dwordx4 v[64:67], v123, s[24:27], s32 offen offset:64 sc1
  buffer_load_dwordx4 v[68:71], v123, s[24:27], s32 offen offset:128 sc1
  buffer_load_dwordx4 v[72:75], v123, s[24:27], s32 offen offset:192 sc1
  buffer_load_dwordx4 v[76:79], v123, s[24:27], s32 offen offset:256 sc1
  s_add_u32 s32, s32, 20480
  s_waitcnt vmcnt(0)
  v_add_f32 v156, v156, v136
  v_add_f32 v157, v157, v137
  v_add_f32 v158, v158, v138
  v_add_f32 v159, v159, v139
  v_add_f32 v160, v160, v140
  v_add_f32 v161, v161, v141
  v_add_f32 v162, v162, v142
  v_add_f32 v163, v163, v143
  v_add_f32 v164, v164, v144
  v_add_f32 v165, v165, v145
  v_add_f32 v166, v166, v146
  v_add_f32 v167, v167, v147
  v_add_f32 v168, v168, v148
  v_add_f32 v169, v169, v149
  v_add_f32 v170, v170, v150
  v_add_f32 v171, v171, v151
  v_add_f32 v172, v172, v152
  v_add_f32 v173, v173, v153
  v_add_f32 v174, v174, v154
  v_add_f32 v175, v175, v155
  v_add_f32 v156, v156, v0
  v_add_f32 v157, v157, v1
  v_add_f32 v158, v158, v2
  v_add_f32 v159, v159, v3
  v_add_f32 v160, v160, v4
  v_add_f32 v161, v161, v5
  v_add_f32 v162, v162, v6
  v_add_f32 v163, v163, v7
  v_add_f32 v164, v164, v8
  v_add_f32 v165, v165, v9
  v_add_f32 v166, v166, v10
  v_add_f32 v167, v167, v11
  v_add_f32 v168, v168, v12
  v_add_f32 v169, v169, v13
  v_add_f32 v170, v170, v14
  v_add_f32 v171, v171, v15
  v_add_f32 v172, v172, v16
  v_add_f32 v173, v173, v17
  v_add_f32 v174, v174, v18
  v_add_f32 v175, v175, v19
  v_add_f32 v156, v156, v20
  v_add_f32 v157, v157, v21
  v_add_f32 v158, v158, v22
  v_add_f32 v159, v159, v23
  v_add_f32 v160, v160, v24
  v_add_f32 v161, v161, v25
  v_add_f32 v162, v162, v26
  v_add_f32 v163, v163, v27
  v_add_f32 v164, v164, v28
  v_add_f32 v165, v165, v29
  v_add_f32 v166, v166, v30
  v_add_f32 v167, v167, v31
  v_add_f32 v168, v168, v32
  v_add_f32 v169, v169, v33
  v_add_f32 v170, v170, v34
  v_add_f32 v171, v171, v35
  v_add_f32 v172, v172, v36
  v_add_f32 v173, v173, v37
  v_add_f32 v174, v174, v38
  v_add_f32 v175, v175, v39
  v_add_f32 v156, v156, v40
  v_add_f32 v157, v157, v41
  v_add_f32 v158, v158, v42
  v_add_f32 v159, v159, v43
  v_add_f32 v160, v160, v44
  v_add_f32 v161, v161, v45
  v_add_f32 v162, v162, v46
  v_add_f32 v163, v163, v47
  v_add_f32 v164, v164, v48
  v_add_f32 v165, v165, v49
  v_add_f32 v166, v166, v50
  v_add_f32 v167, v167, v51
  v_add_f32 v168, v168, v52
  v_add_f32 v169, v169, v53
  v_add_f32 v170, v170, v54
  v_add_f32 v171, v171, v55
  v_add_f32 v172, v172, v56
  v_add_f32 v173, v173, v57
  v_add_f32 v174, v174, v58
  v_add_f32 v175, v175, v59
  v_add_f32 v156, v156, v60
  v_add_f32 v157, v157, v61
  v_add_f32 v158, v158, v62
  v_add_f32 v159, v159, v63
  v_add_f32 v160, v160, v64
  v_add_f32 v161, v161, v65
  v_add_f32 v162, v162, v66
  v_add_f32 v163, v163, v67
  v_add_f32 v164, v164, v68
  v_add_f32 v165, v165, v69
  v_add_f32 v166, v166, v70
  v_add_f32 v167, v167, v71
  v_add_f32 v168, v168, v72
  v_add_f32 v169, v169, v73
  v_add_f32 v170, v170, v74
  v_add_f32 v171, v171, v75
  v_add_f32 v172, v172, v76
  v_add_f32 v173, v173, v77
  v_add_f32 v174, v174, v78
  v_add_f32 v175, v175, v79
tail_plain:
  s_mov_b64 exec, s[42:43]
  s_waitcnt vmcnt(0)
  v_mfma_f32_16x16x32_bf16 v[0:3], a[212:215], a[180:183], 0
  s_add_u32 s30, s30, 8192
  buffer_load_dwordx4 v[176:179], v110, s[24:27], s30 offen offset:0 sc1
  v_mfma_f32_16x16x32_bf16 v[0:3], a[232:235], a[184:187], v[0:3]
  v_cvt_pk_bf16_f32 v156, v156, v156
  v_cvt_pk_bf16_f32 v157, v157, v157
  v_mfma_f32_16x16x32_bf16 v[4:7], a[232:235], a[192:195], 0
  buffer_load_dwordx4 a[96:99], v115, s[24:27], s7 offen offset:3072 sc1
  v_mfma_f32_16x16x32_bf16 v[4:7], a[212:215], a[188:191], v[4:7]
  v_cvt_pk_bf16_f32 v158, v158, v158
  v_cvt_pk_bf16_f32 v159, v159, v159
  v_mfma_f32_16x16x32_bf16 v[8:11], a[212:215], a[196:199], 0
  buffer_load_dwordx4 v[180:183], v110, s[24:27], s30 offen offset:1024 sc1
  v_mfma_f32_16x16x32_bf16 v[8:11], a[232:235], a[200:203], v[8:11]
  v_lshlrev_b32 v156, 16, v156
  v_lshlrev_b32 v157, 16, v157
  v_mfma_f32_16x16x32_bf16 v[12:15], a[232:235], a[208:211], 0
  v_lshlrev_b32 v158, 16, v158
  v_lshlrev_b32 v159, 16, v159
  v_mfma_f32_16x16x32_bf16 v[12:15], a[212:215], a[204:207], v[12:15]
  v_mul_f32 v156, v156, v124
  v_mul_f32 v157, v157, v124
  v_mfma_f32_16x16x32_bf16 v[16:19], a[216:219], a[180:183], 0
  buffer_load_dwordx4 v[184:187], v111, s[24:27], s30 offen offset:0 sc1
  v_mfma_f32_16x16x32_bf16 v[16:19], a[236:239], a[184:187], v[16:19]
  v_mul_f32 v158, v158, v124
  v_mul_f32 v159, v159, v124
  v_mfma_f32_16x16x32_bf16 v[20:23], a[236:239], a[192:195], 0
  buffer_load_dwordx4 a[100:103], v116, s[24:27], s7 offen offset:0 sc1
  v_mfma_f32_16x16x32_bf16 v[20:23], a[216:219], a[188:191], v[20:23]
  v_cvt_pk_bf16_f32 v156, v156, v156
  v_cvt_pk_bf16_f32 v157, v157, v157
  v_mfma_f32_16x16x32_bf16 v[24:27], a[216:219], a[196:199], 0
  buffer_load_dwordx4 v[188:191], v111, s[24:27], s30 offen offset:1024 sc1
  v_mfma_f32_16x16x32_bf16 v[24:27], a[236:239], a[200:203], v[24:27]
  v_cvt_pk_bf16_f32 v158, v158, v158
  v_cvt_pk_bf16_f32 v159, v159, v159
  v_mfma_f32_16x16x32_bf16 v[28:31], a[236:239], a[208:211], 0
  v_lshlrev_b32 v156, 16, v156
  v_lshlrev_b32 v157, 16, v157
  v_mfma_f32_16x16x32_bf16 v[28:31], a[216:219], a[204:207], v[28:31]
  v_lshlrev_b32 v158, 16, v158
  v_lshlrev_b32 v159, 16, v159
  v_mfma_f32_16x16x32_bf16 v[32:35], a[220:223], a[180:183], 0
  buffer_load_dwordx4 v[192:195], v112, s[24:27], s30 offen offset:0 sc1
  v_mfma_f32_16x16x32_bf16 v[32:35], a[240:243], a[184:187], v[32:35]
  v_add_f32 v90, v90, v156
  v_add_f32 v91, v91, v157
  v_mfma_f32_16x16x32_bf16 v[36:39], a[240:243], a[192:195], 0
  buffer_load_dwordx4 a[104:107], v116, s[24:27], s7 offen offset:1024 sc1
  v_mfma_f32_16x16x32_bf16 v[36:39], a[220:223], a[188:191], v[36:39]
  v_add_f32 v92, v92, v158
  v_add_f32 v93, v93, v159
  v_mfma_f32_16x16x32_bf16 v[40:43], a[220:223], a[196:199], 0
  buffer_load_dwordx4 v[196:199], v112, s[24:27], s30 offen offset:1024 sc1
  v_mfma_f32_16x16x32_bf16 v[40:43], a[240:243], a[200:203], v[40:43]
  v_cvt_pk_bf16_f32 v90, v90, v90
  v_cvt_pk_bf16_f32 v91, v91, v91
  v_mfma_f32_16x16x32_bf16 v[44:47], a[240:243], a[208:211], 0
  v_cvt_pk_bf16_f32 v92, v92, v92
  v_cvt_pk_bf16_f32 v93, v93, v93
  v_mfma_f32_16x16x32_bf16 v[44:47], a[220:223], a[204:207], v[44:47]
  v_lshlrev_b32 v90, 16, v90
  v_lshlrev_b32 v91, 16, v91
  v_mfma_f32_16x16x32_bf16 v[48:51], a[224:227], a[180:183], 0
  buffer_load_dwordx4 v[200:203], v113, s[24:27], s30 offen offset:0 sc1
  v_mfma_f32_16x16x32_bf16 v[48:51], a[244:247], a[184:187], v[48:51]
  v_lshlrev_b32 v92, 16, v92
  v_lshlrev_b32 v93, 16, v93
  v_mfma_f32_16x16x32_bf16 v[52:55], a[244:247], a[192:195], 0
  buffer_load_dwordx4 a[108:111], v116, s[24:27], s7 offen offset:2048 sc1
  v_mfma_f32_16x16x32_bf16 v[52:55], a[224:227], a[188:191], v[52:55]
  v_mul_f32 v129, 0xbfb8aa3b, v90
  v_mul_f32 v130, 0xbfb8aa3b, v91
  v_mfma_f32_16x16x32_bf16 v[56:59], a[224:227], a[196:199], 0
  buffer_load_dwordx4 v[204:207], v113, s[24:27], s30 offen offset:1024 sc1
  v_mfma_f32_16x16x32_bf16 v[56:59], a[244:247], a[200:203], v[56:59]
  v_mul_f32 v131, 0xbfb8aa3b, v92
  v_mul_f32 v132, 0xbfb8aa3b, v93
  v_mfma_f32_16x16x32_bf16 v[60:63], a[244:247], a[208:211], 0
  v_exp_f32 v129, v129
  v_mfma_f32_16x16x32_bf16 v[60:63], a[224:227], a[204:207], v[60:63]
  v_exp_f32 v130, v130
  v_mfma_f32_16x16x32_bf16 v[64:67], a[228:231], a[180:183], 0
  s_add_u32 s30, s30, 8192
  buffer_load_dwordx4 v[208:211], v110, s[24:27], s30 offen offset:0 sc1
  v_mfma_f32_16x16x32_bf16 v[64:67], a[248:251], a[184:187], v[64:67]
  v_exp_f32 v131, v131
  v_mfma_f32_16x16x32_bf16 v[68:71], a[248:251], a[192:195], 0
  buffer_load_dwordx4 a[112:115], v116, s[24:27], s7 offen offset:3072 sc1
  v_mfma_f32_16x16x32_bf16 v[68:71], a[228:231], a[188:191], v[68:71]
  v_exp_f32 v132, v132
  v_mfma_f32_16x16x32_bf16 v[72:75], a[228:231], a[196:199], 0
  buffer_load_dwordx4 v[212:215], v110, s[24:27], s30 offen offset:1024 sc1
  v_mfma_f32_16x16x32_bf16 v[72:75], a[248:251], a[200:203], v[72:75]
  v_add_f32 v129, 1.0, v129
  v_add_f32 v130, 1.0, v130
  v_mfma_f32_16x16x32_bf16 v[76:79], a[248:251], a[208:211], 0
  v_add_f32 v131, 1.0, v131
  v_add_f32 v132, 1.0, v132
  v_mfma_f32_16x16x32_bf16 v[76:79], a[228:231], a[204:207], v[76:79]
  v_rcp_f32 v129, v129
  s_waitcnt vmcnt(3)
  v_mfma_f32_16x16x32_bf16 v[0:3], a[252:255], v[176:179], v[0:3]
  buffer_load_dwordx4 v[216:219], v111, s[24:27], s30 offen offset:0 sc1
  v_mfma_f32_16x16x32_bf16 v[0:3], a[144:147], v[180:183], v[0:3]
  v_rcp_f32 v130, v130
  v_mfma_f32_16x16x32_bf16 v[4:7], a[144:147], v[188:191], v[4:7]
  buffer_load_dwordx4 a[116:119], v114, s[24:27], s8 offen offset:0 sc1
  v_mfma_f32_16x16x32_bf16 v[4:7], a[252:255], v[184:187], v[4:7]
  v_rcp_f32 v131, v131
  v_mfma_f32_16x16x32_bf16 v[8:11], a[252:255], v[192:195], v[8:11]
  buffer_load_dwordx4 v[220:223], v111, s[24:27], s30 offen offset:1024 sc1
  v_mfma_f32_16x16x32_bf16 v[8:11], a[144:147], v[196:199], v[8:11]
  v_rcp_f32 v132, v132
  v_mfma_f32_16x16x32_bf16 v[12:15], a[144:147], v[204:207], v[12:15]
  v_mul_f32 v90, v90, v129
  v_mul_f32 v91, v91, v130
  v_mfma_f32_16x16x32_bf16 v[12:15], a[252:255], v[200:203], v[12:15]
  v_mul_f32 v92, v92, v131
  v_mul_f32 v93, v93, v132
  v_mfma_f32_16x16x32_bf16 v[16:19], a[128:131], v[176:179], v[16:19]
  buffer_load_dwordx4 v[224:227], v112, s[24:27], s30 offen offset:0 sc1
  v_mfma_f32_16x16x32_bf16 v[16:19], a[148:151], v[180:183], v[16:19]
  v_cvt_pk_bf16_f32 v90, v90, v90
  v_cvt_pk_bf16_f32 v91, v91, v91
  v_mfma_f32_16x16x32_bf16 v[20:23], a[148:151], v[188:191], v[20:23]
  buffer_load_dwordx4 a[120:123], v114, s[24:27], s8 offen offset:1024 sc1
  v_mfma_f32_16x16x32_bf16 v[20:23], a[128:131], v[184:187], v[20:23]
  v_cvt_pk_bf16_f32 v92, v92, v92
  v_cvt_pk_bf16_f32 v93, v93, v93
  v_mfma_f32_16x16x32_bf16 v[24:27], a[128:131], v[192:195], v[24:27]
  buffer_load_dwordx4 v[228:231], v112, s[24:27], s30 offen offset:1024 sc1
  v_mfma_f32_16x16x32_bf16 v[24:27], a[148:151], v[196:199], v[24:27]
  v_lshlrev_b32 v90, 16, v90
  v_lshlrev_b32 v91, 16, v91
  v_mfma_f32_16x16x32_bf16 v[28:31], a[148:151], v[204:207], v[28:31]
  v_lshlrev_b32 v92, 16, v92
  v_lshlrev_b32 v93, 16, v93
  v_mfma_f32_16x16x32_bf16 v[28:31], a[128:131], v[200:203], v[28:31]
  v_cvt_pk_bf16_f32 v160, v160, v160
  v_cvt_pk_bf16_f32 v161, v161, v161
  v_mfma_f32_16x16x32_bf16 v[32:35], a[132:135], v[176:179], v[32:35]
  buffer_load_dwordx4 v[232:235], v113, s[24:27], s30 offen offset:0 sc1
  v_mfma_f32_16x16x32_bf16 v[32:35], a[152:155], v[180:183], v[32:35]
  v_cvt_pk_bf16_f32 v162, v162, v162
  v_cvt_pk_bf16_f32 v163, v163, v163
  v_mfma_f32_16x16x32_bf16 v[36:39], a[152:155], v[188:191], v[36:39]
  buffer_load_dwordx4 a[124:127], v114, s[24:27], s8 offen offset:2048 sc1
  v_mfma_f32_16x16x32_bf16 v[36:39], a[132:135], v[184:187], v[36:39]
  v_lshlrev_b32 v160, 16, v160
  v_lshlrev_b32 v161, 16, v161
  v_mfma_f32_16x16x32_bf16 v[40:43], a[132:135], v[192:195], v[40:43]
  buffer_load_dwordx4 v[236:239], v113, s[24:27], s30 offen offset:1024 sc1
  v_mfma_f32_16x16x32_bf16 v[40:43], a[152:155], v[196:199], v[40:43]
  v_lshlrev_b32 v162, 16, v162
  v_lshlrev_b32 v163, 16, v163
  v_mfma_f32_16x16x32_bf16 v[44:47], a[152:155], v[204:207], v[44:47]
  v_mul_f32 v160, v160, v124
  v_mul_f32 v161, v161, v124
  v_mfma_f32_16x16x32_bf16 v[44:47], a[132:135], v[200:203], v[44:47]
  v_mul_f32 v162, v162, v124
  v_mul_f32 v163, v163, v124
  v_mfma_f32_16x16x32_bf16 v[48:51], a[136:139], v[176:179], v[48:51]
  s_add_u32 s30, s30, 8192
  buffer_load_dwordx4 v[240:243], v110, s[24:27], s30 offen offset:0 sc1
  v_mfma_f32_16x16x32_bf16 v[48:51], a[156:159], v[180:183], v[48:51]
  v_cvt_pk_bf16_f32 v160, v160, v160
  v_cvt_pk_bf16_f32 v161, v161, v161
  v_mfma_f32_16x16x32_bf16 v[52:55], a[156:159], v[188:191], v[52:55]
  buffer_load_dwordx4 a[160:163], v114, s[24:27], s8 offen offset:3072 sc1
  v_mfma_f32_16x16x32_bf16 v[52:55], a[136:139], v[184:187], v[52:55]
  v_cvt_pk_bf16_f32 v162, v162, v162
  v_cvt_pk_bf16_f32 v163, v163, v163
  v_mfma_f32_16x16x32_bf16 v[56:59], a[136:139], v[192:195], v[56:59]
  buffer_load_dwordx4 v[244:247], v110, s[24:27], s30 offen offset:1024 sc1
  v_mfma_f32_16x16x32_bf16 v[56:59], a[156:159], v[196:199], v[56:59]
  v_lshlrev_b32 v160, 16, v160
  v_lshlrev_b32 v161, 16, v161
  v_mfma_f32_16x16x32_bf16 v[60:63], a[156:159], v[204:207], v[60:63]
  v_lshlrev_b32 v162, 16, v162
  v_lshlrev_b32 v163, 16, v163
  v_mfma_f32_16x16x32_bf16 v[60:63], a[136:139], v[200:203], v[60:63]
  v_add_f32 v94, v94, v160
  v_add_f32 v95, v95, v161
  v_mfma_f32_16x16x32_bf16 v[64:67], a[140:143], v[176:179], v[64:67]
  buffer_load_dwordx4 v[248:251], v111, s[24:27], s30 offen offset:0 sc1
  v_mfma_f32_16x16x32_bf16 v[64:67], a[0:3], v[180:183], v[64:67]
  v_add_f32 v96, v96, v162
  v_add_f32 v97, v97, v163
  v_mfma_f32_16x16x32_bf16 v[68:71], a[0:3], v[188:191], v[68:71]
  buffer_load_dwordx4 a[164:167], v115, s[24:27], s8 offen offset:0 sc1
  v_mfma_f32_16x16x32_bf16 v[68:71], a[140:143], v[184:187], v[68:71]
  v_cvt_pk_bf16_f32 v94, v94, v94
  v_cvt_pk_bf16_f32 v95, v95, v95
  v_mfma_f32_16x16x32_bf16 v[72:75], a[140:143], v[192:195], v[72:75]
  buffer_load_dwordx4 v[252:255], v111, s[24:27], s30 offen offset:1024 sc1
  v_mfma_f32_16x16x32_bf16 v[72:75], a[0:3], v[196:199], v[72:75]
  v_cvt_pk_bf16_f32 v96, v96, v96
  v_cvt_pk_bf16_f32 v97, v97, v97
  v_mfma_f32_16x16x32_bf16 v[76:79], a[0:3], v[204:207], v[76:79]
  v_lshlrev_b32 v94, 16, v94
  v_lshlrev_b32 v95, 16, v95
  v_mfma_f32_16x16x32_bf16 v[76:79], a[140:143], v[200:203], v[76:79]
  v_lshlrev_b32 v96, 16, v96
  v_lshlrev_b32 v97, 16, v97
  s_waitcnt vmcnt(6)
  v_mfma_f32_16x16x32_bf16 v[0:3], a[4:7], v[208:211], v[0:3]
  buffer_load_dwordx4 v[136:139], v112, s[24:27], s30 offen offset:0 sc1
  v_mfma_f32_16x16x32_bf16 v[0:3], a[24:27], v[212:215], v[0:3]
  v_mul_f32 v129, 0xbfb8aa3b, v94
  v_mul_f32 v130, 0xbfb8aa3b, v95
  v_mfma_f32_16x16x32_bf16 v[4:7], a[24:27], v[220:223], v[4:7]
  buffer_load_dwordx4 a[168:171], v115, s[24:27], s8 offen offset:1024 sc1
  v_mfma_f32_16x16x32_bf16 v[4:7], a[4:7], v[216:219], v[4:7]
  v_mul_f32 v131, 0xbfb8aa3b, v96
  v_mul_f32 v132, 0xbfb8aa3b, v97
  v_mfma_f32_16x16x32_bf16 v[8:11], a[4:7], v[224:227], v[8:11]
  buffer_load_dwordx4 v[140:143], v112, s[24:27], s30 offen offset:1024 sc1
  v_mfma_f32_16x16x32_bf16 v[8:11], a[24:27], v[228:231], v[8:11]
  v_exp_f32 v129, v129
  v_mfma_f32_16x16x32_bf16 v[12:15], a[24:27], v[236:239], v[12:15]
  v_exp_f32 v130, v130
  v_mfma_f32_16x16x32_bf16 v[12:15], a[4:7], v[232:235], v[12:15]
  v_exp_f32 v131, v131
  v_mfma_f32_16x16x32_bf16 v[16:19], a[8:11], v[208:211], v[16:19]
  buffer_load_dwordx4 v[144:147], v113, s[24:27], s30 offen offset:0 sc1
  v_mfma_f32_16x16x32_bf16 v[16:19], a[28:31], v[212:215], v[16:19]
  v_exp_f32 v132, v132
  v_mfma_f32_16x16x32_bf16 v[20:23], a[28:31], v[220:223], v[20:23]
  buffer_load_dwordx4 a[172:175], v115, s[24:27], s8 offen offset:2048 sc1
  v_mfma_f32_16x16x32_bf16 v[20:23], a[8:11], v[216:219], v[20:23]
  v_add_f32 v129, 1.0, v129
  v_add_f32 v130, 1.0, v130
  v_mfma_f32_16x16x32_bf16 v[24:27], a[8:11], v[224:227], v[24:27]
  buffer_load_dwordx4 v[148:151], v113, s[24:27], s30 offen offset:1024 sc1
  v_mfma_f32_16x16x32_bf16 v[24:27], a[28:31], v[228:231], v[24:27]
  v_add_f32 v131, 1.0, v131
  v_add_f32 v132, 1.0, v132
  v_mfma_f32_16x16x32_bf16 v[28:31], a[28:31], v[236:239], v[28:31]
  v_rcp_f32 v129, v129
  v_mfma_f32_16x16x32_bf16 v[28:31], a[8:11], v[232:235], v[28:31]
  v_rcp_f32 v130, v130
  v_mfma_f32_16x16x32_bf16 v[32:35], a[12:15], v[208:211], v[32:35]
  s_add_u32 s30, s30, 8192
  buffer_load_dwordx4 v[152:155], v110, s[24:27], s30 offen offset:0 sc1
  v_mfma_f32_16x16x32_bf16 v[32:35], a[32:35], v[212:215], v[32:35]
  v_rcp_f32 v131, v131
  v_mfma_f32_16x16x32_bf16 v[36:39], a[32:35], v[220:223], v[36:39]
  buffer_load_dwordx4 a[176:179], v115, s[24:27], s8 offen offset:3072 sc1
  v_mfma_f32_16x16x32_bf16 v[36:39], a[12:15], v[216:219], v[36:39]
  v_rcp_f32 v132, v132
  v_mfma_f32_16x16x32_bf16 v[40:43], a[12:15], v[224:227], v[40:43]
  buffer_load_dwordx4 a[180:183], v110, s[24:27], s30 offen offset:1024 sc1
  v_mfma_f32_16x16x32_bf16 v[40:43], a[32:35], v[228:231], v[40:43]
  v_mul_f32 v94, v94, v129
  v_mul_f32 v95, v95, v130
  v_mfma_f32_16x16x32_bf16 v[44:47], a[32:35], v[236:239], v[44:47]
  v_mul_f32 v96, v96, v131
  v_mul_f32 v97, v97, v132
  v_mfma_f32_16x16x32_bf16 v[44:47], a[12:15], v[232:235], v[44:47]
  v_cvt_pk_bf16_f32 v94, v94, v94
  v_cvt_pk_bf16_f32 v95, v95, v95
  v_mfma_f32_16x16x32_bf16 v[48:51], a[16:19], v[208:211], v[48:51]
  buffer_load_dwordx4 a[184:187], v111, s[24:27], s30 offen offset:0 sc1
  v_mfma_f32_16x16x32_bf16 v[48:51], a[36:39], v[212:215], v[48:51]
  v_cvt_pk_bf16_f32 v96, v96, v96
  v_cvt_pk_bf16_f32 v97, v97, v97
  v_mfma_f32_16x16x32_bf16 v[52:55], a[36:39], v[220:223], v[52:55]
  s_add_u32 m0, s28, 49152
  s_nop 0
  buffer_load_dwordx4 v115, s[24:27], s10 offen offset:0 sc1 lds
  v_mfma_f32_16x16x32_bf16 v[52:55], a[16:19], v[216:219], v[52:55]
  buffer_load_dwordx4 v115, s[24:27], s10 offen offset:1024 sc1 lds
  v_mfma_f32_16x16x32_bf16 v[56:59], a[16:19], v[224:227], v[56:59]
  buffer_load_dwordx4 v115, s[24:27], s10 offen offset:2048 sc1 lds
  v_mfma_f32_16x16x32_bf16 v[56:59], a[36:39], v[228:231], v[56:59]
  buffer_load_dwordx4 v115, s[24:27], s10 offen offset:3072 sc1 lds
  v_mfma_f32_16x16x32_bf16 v[60:63], a[36:39], v[236:239], v[60:63]
  buffer_load_dwordx4 a[188:191], v111, s[24:27], s30 offen offset:1024 sc1
  v_mfma_f32_16x16x32_bf16 v[60:63], a[16:19], v[232:235], v[60:63]
  v_lshlrev_b32 v94, 16, v94
  v_lshlrev_b32 v95, 16, v95
  v_mfma_f32_16x16x32_bf16 v[64:67], a[20:23], v[208:211], v[64:67]
  buffer_load_dwordx4 a[192:195], v112, s[24:27], s30 offen offset:0 sc1
  v_mfma_f32_16x16x32_bf16 v[64:67], a[40:43], v[212:215], v[64:67]
  v_lshlrev_b32 v96, 16, v96
  v_lshlrev_b32 v97, 16, v97
  v_mfma_f32_16x16x32_bf16 v[68:71], a[40:43], v[220:223], v[68:71]
  v_cvt_pk_bf16_f32 v164, v164, v164
  v_cvt_pk_bf16_f32 v165, v165, v165
  v_mfma_f32_16x16x32_bf16 v[68:71], a[20:23], v[216:219], v[68:71]
  v_cvt_pk_bf16_f32 v166, v166, v166
  v_cvt_pk_bf16_f32 v167, v167, v167
  v_mfma_f32_16x16x32_bf16 v[72:75], a[20:23], v[224:227], v[72:75]
  buffer_load_dwordx4 a[196:199], v112, s[24:27], s30 offen offset:1024 sc1
  v_mfma_f32_16x16x32_bf16 v[72:75], a[40:43], v[228:231], v[72:75]
  v_lshlrev_b32 v164, 16, v164
  v_lshlrev_b32 v165, 16, v165
  v_mfma_f32_16x16x32_bf16 v[76:79], a[40:43], v[236:239], v[76:79]
  v_lshlrev_b32 v166, 16, v166
  v_lshlrev_b32 v167, 16, v167
  v_mfma_f32_16x16x32_bf16 v[76:79], a[20:23], v[232:235], v[76:79]
  v_mul_f32 v164, v164, v124
  v_mul_f32 v165, v165, v124
  s_waitcnt vmcnt(11)
  v_mfma_f32_16x16x32_bf16 v[0:3], a[44:47], v[240:243], v[0:3]
  buffer_load_dwordx4 a[200:203], v113, s[24:27], s30 offen offset:0 sc1
  v_mfma_f32_16x16x32_bf16 v[0:3], a[64:67], v[244:247], v[0:3]
  v_mul_f32 v166, v166, v124
  v_mul_f32 v167, v167, v124
  v_mfma_f32_16x16x32_bf16 v[4:7], a[64:67], v[252:255], v[4:7]
  v_cvt_pk_bf16_f32 v164, v164, v164
  v_cvt_pk_bf16_f32 v165, v165, v165
  v_mfma_f32_16x16x32_bf16 v[4:7], a[44:47], v[248:251], v[4:7]
  v_cvt_pk_bf16_f32 v166, v166, v166
  v_cvt_pk_bf16_f32 v167, v167, v167
  v_mfma_f32_16x16x32_bf16 v[8:11], a[44:47], v[136:139], v[8:11]
  buffer_load_dwordx4 a[204:207], v113, s[24:27], s30 offen offset:1024 sc1
  v_mfma_f32_16x16x32_bf16 v[8:11], a[64:67], v[140:143], v[8:11]
  v_lshlrev_b32 v164, 16, v164
  v_lshlrev_b32 v165, 16, v165
  v_mfma_f32_16x16x32_bf16 v[12:15], a[64:67], v[148:151], v[12:15]
  v_lshlrev_b32 v166, 16, v166
  v_lshlrev_b32 v167, 16, v167
  v_mfma_f32_16x16x32_bf16 v[12:15], a[44:47], v[144:147], v[12:15]
  v_add_f32 v98, v98, v164
  v_add_f32 v99, v99, v165
  v_mfma_f32_16x16x32_bf16 v[16:19], a[48:51], v[240:243], v[16:19]
  s_add_u32 s30, s30, 8192
  buffer_load_dwordx4 a[208:211], v110, s[24:27], s30 offen offset:0 sc1
  v_mfma_f32_16x16x32_bf16 v[16:19], a[68:71], v[244:247], v[16:19]
  v_add_f32 v100, v100, v166
  v_add_f32 v101, v101, v167
  v_mfma_f32_16x16x32_bf16 v[20:23], a[68:71], v[252:255], v[20:23]
  v_cvt_pk_bf16_f32 v98, v98, v98
  v_cvt_pk_bf16_f32 v99, v99, v99
  v_mfma_f32_16x16x32_bf16 v[20:23], a[48:51], v[248:251], v[20:23]
  v_cvt_pk_bf16_f32 v100, v100, v100
  v_cvt_pk_bf16_f32 v101, v101, v101
  v_mfma_f32_16x16x32_bf16 v[24:27], a[48:51], v[136:139], v[24:27]
  buffer_load_dwordx4 v[176:179], v110, s[24:27], s30 offen offset:1024 sc1
  v_mfma_f32_16x16x32_bf16 v[24:27], a[68:71], v[140:143], v[24:27]
  v_lshlrev_b32 v98, 16, v98
  v_lshlrev_b32 v99, 16, v99
  v_mfma_f32_16x16x32_bf16 v[28:31], a[68:71], v[148:151], v[28:31]
  v_lshlrev_b32 v100, 16, v100
  v_lshlrev_b32 v101, 16, v101
  v_mfma_f32_16x16x32_bf16 v[28:31], a[48:51], v[144:147], v[28:31]
  v_mul_f32 v129, 0xbfb8aa3b, v98
  v_mul_f32 v130, 0xbfb8aa3b, v99
  v_mfma_f32_16x16x32_bf16 v[32:35], a[52:55], v[240:243], v[32:35]
  buffer_load_dwordx4 v[180:183], v111, s[24:27], s30 offen offset:0 sc1
  v_mfma_f32_16x16x32_bf16 v[32:35], a[72:75], v[244:247], v[32:35]
  v_mul_f32 v131, 0xbfb8aa3b, v100
  v_mul_f32 v132, 0xbfb8aa3b, v101
  v_mfma_f32_16x16x32_bf16 v[36:39], a[72:75], v[252:255], v[36:39]
  v_exp_f32 v129, v129
  v_mfma_f32_16x16x32_bf16 v[36:39], a[52:55], v[248:251], v[36:39]
  v_exp_f32 v130, v130
  v_mfma_f32_16x16x32_bf16 v[40:43], a[52:55], v[136:139], v[40:43]
  buffer_load_dwordx4 v[184:187], v111, s[24:27], s30 offen offset:1024 sc1
  v_mfma_f32_16x16x32_bf16 v[40:43], a[72:75], v[140:143], v[40:43]
  v_exp_f32 v131, v131
  v_mfma_f32_16x16x32_bf16 v[44:47], a[72:75], v[148:151], v[44:47]
  v_exp_f32 v132, v132
  v_mfma_f32_16x16x32_bf16 v[44:47], a[52:55], v[144:147], v[44:47]
  v_add_f32 v129, 1.0, v129
  v_add_f32 v130, 1.0, v130
  v_mfma_f32_16x16x32_bf16 v[48:51], a[56:59], v[240:243], v[48:51]
  buffer_load_dwordx4 v[188:191], v112, s[24:27], s30 offen offset:0 sc1
  v_mfma_f32_16x16x32_bf16 v[48:51], a[76:79], v[244:247], v[48:51]
  v_add_f32 v131, 1.0, v131
  v_add_f32 v132, 1.0, v132
  v_mfma_f32_16x16x32_bf16 v[52:55], a[76:79], v[252:255], v[52:55]
  v_rcp_f32 v129, v129
  v_mfma_f32_16x16x32_bf16 v[52:55], a[56:59], v[248:251], v[52:55]
  v_rcp_f32 v130, v130
  v_mfma_f32_16x16x32_bf16 v[56:59], a[56:59], v[136:139], v[56:59]
  buffer_load_dwordx4 v[192:195], v112, s[24:27], s30 offen offset:1024 sc1
  v_mfma_f32_16x16x32_bf16 v[56:59], a[76:79], v[140:143], v[56:59]
  v_rcp_f32 v131, v131
  v_mfma_f32_16x16x32_bf16 v[60:63], a[76:79], v[148:151], v[60:63]
  v_rcp_f32 v132, v132
  v_mfma_f32_16x16x32_bf16 v[60:63], a[56:59], v[144:147], v[60:63]
  v_mul_f32 v98, v98, v129
  v_mul_f32 v99, v99, v130
  v_mfma_f32_16x16x32_bf16 v[64:67], a[60:63], v[240:243], v[64:67]
  buffer_load_dwordx4 v[196:199], v113, s[24:27], s30 offen offset:0 sc1
  v_mfma_f32_16x16x32_bf16 v[64:67], a[80:83], v[244:247], v[64:67]
  v_mul_f32 v100, v100, v131
  v_mul_f32 v101, v101, v132
  v_mfma_f32_16x16x32_bf16 v[68:71], a[80:83], v[252:255], v[68:71]
  v_cvt_pk_bf16_f32 v98, v98, v98
  v_cvt_pk_bf16_f32 v99, v99, v99
  v_mfma_f32_16x16x32_bf16 v[68:71], a[60:63], v[248:251], v[68:71]
  v_cvt_pk_bf16_f32 v100, v100, v100
  v_cvt_pk_bf16_f32 v101, v101, v101
  v_mfma_f32_16x16x32_bf16 v[72:75], a[60:63], v[136:139], v[72:75]
  buffer_load_dwordx4 v[200:203], v113, s[24:27], s30 offen offset:1024 sc1
  v_mfma_f32_16x16x32_bf16 v[72:75], a[80:83], v[140:143], v[72:75]
  v_lshlrev_b32 v98, 16, v98
  v_lshlrev_b32 v99, 16, v99
  v_mfma_f32_16x16x32_bf16 v[76:79], a[80:83], v[148:151], v[76:79]
  v_lshlrev_b32 v100, 16, v100
  v_lshlrev_b32 v101, 16, v101
  v_mfma_f32_16x16x32_bf16 v[76:79], a[60:63], v[144:147], v[76:79]
  v_cvt_pk_bf16_f32 v168, v168, v168
  v_cvt_pk_bf16_f32 v169, v169, v169
  s_waitcnt vmcnt(8)
  v_mfma_f32_16x16x32_bf16 v[0:3], a[84:87], v[152:155], v[0:3]
  s_add_u32 s30, s30, 8192
  buffer_load_dwordx4 v[204:207], v110, s[24:27], s30 offen offset:0 sc1
  v_mfma_f32_16x16x32_bf16 v[0:3], a[104:107], a[180:183], v[0:3]
  v_cvt_pk_bf16_f32 v170, v170, v170
  v_cvt_pk_bf16_f32 v171, v171, v171
  v_mfma_f32_16x16x32_bf16 v[4:7], a[104:107], a[188:191], v[4:7]
  v_lshlrev_b32 v168, 16, v168
  v_lshlrev_b32 v169, 16, v169
  v_mfma_f32_16x16x32_bf16 v[4:7], a[84:87], a[184:187], v[4:7]
  v_lshlrev_b32 v170, 16, v170
  v_lshlrev_b32 v171, 16, v171
  v_mfma_f32_16x16x32_bf16 v[8:11], a[84:87], a[192:195], v[8:11]
  buffer_load_dwordx4 v[208:211], v110, s[24:27], s30 offen offset:1024 sc1
  v_mfma_f32_16x16x32_bf16 v[8:11], a[104:107], a[196:199], v[8:11]
  v_mul_f32 v168, v168, v124
  v_mul_f32 v169, v169, v124
  v_mfma_f32_16x16x32_bf16 v[12:15], a[104:107], a[204:207], v[12:15]
  v_mul_f32 v170, v170, v124
  v_mul_f32 v171, v171, v124
  v_mfma_f32_16x16x32_bf16 v[12:15], a[84:87], a[200:203], v[12:15]
  v_cvt_pk_bf16_f32 v168, v168, v168
  v_cvt_pk_bf16_f32 v169, v169, v169
  v_mfma_f32_16x16x32_bf16 v[16:19], a[88:91], v[152:155], v[16:19]
  buffer_load_dwordx4 v[212:215], v111, s[24:27], s30 offen offset:0 sc1
  v_mfma_f32_16x16x32_bf16 v[16:19], a[108:111], a[180:183], v[16:19]
  v_cvt_pk_bf16_f32 v170, v170, v170
  v_cvt_pk_bf16_f32 v171, v171, v171
  v_mfma_f32_16x16x32_bf16 v[20:23], a[108:111], a[188:191], v[20:23]
  v_lshlrev_b32 v168, 16, v168
  v_lshlrev_b32 v169, 16, v169
  v_mfma_f32_16x16x32_bf16 v[20:23], a[88:91], a[184:187], v[20:23]
  v_lshlrev_b32 v170, 16, v170
  v_lshlrev_b32 v171, 16, v171
  v_mfma_f32_16x16x32_bf16 v[24:27], a[88:91], a[192:195], v[24:27]
  buffer_load_dwordx4 v[216:219], v111, s[24:27], s30 offen offset:1024 sc1
  v_mfma_f32_16x16x32_bf16 v[24:27], a[108:111], a[196:199], v[24:27]
  v_add_f32 v102, v102, v168
  v_add_f32 v103, v103, v169
  v_mfma_f32_16x16x32_bf16 v[28:31], a[108:111], a[204:207], v[28:31]
  v_add_f32 v104, v104, v170
  v_add_f32 v105, v105, v171
  v_mfma_f32_16x16x32_bf16 v[28:31], a[88:91], a[200:203], v[28:31]
  v_cvt_pk_bf16_f32 v102, v102, v102
  v_cvt_pk_bf16_f32 v103, v103, v103
  v_mfma_f32_16x16x32_bf16 v[32:35], a[92:95], v[152:155], v[32:35]
  buffer_load_dwordx4 v[220:223], v112, s[24:27], s30 offen offset:0 sc1
  v_mfma_f32_16x16x32_bf16 v[32:35], a[112:115], a[180:183], v[32:35]
  v_cvt_pk_bf16_f32 v104, v104, v104
  v_cvt_pk_bf16_f32 v105, v105, v105
  v_mfma_f32_16x16x32_bf16 v[36:39], a[112:115], a[188:191], v[36:39]
  v_lshlrev_b32 v102, 16, v102
  v_lshlrev_b32 v103, 16, v103
  v_mfma_f32_16x16x32_bf16 v[36:39], a[92:95], a[184:187], v[36:39]
  v_lshlrev_b32 v104, 16, v104
  v_lshlrev_b32 v105, 16, v105
  v_mfma_f32_16x16x32_bf16 v[40:43], a[92:95], a[192:195], v[40:43]
  buffer_load_dwordx4 v[224:227], v112, s[24:27], s30 offen offset:1024 sc1
  v_mfma_f32_16x16x32_bf16 v[40:43], a[112:115], a[196:199], v[40:43]
  v_mul_f32 v129, 0xbfb8aa3b, v102
  v_mul_f32 v130, 0xbfb8aa3b, v103
  v_mfma_f32_16x16x32_bf16 v[44:47], a[112:115], a[204:207], v[44:47]
  v_mul_f32 v131, 0xbfb8aa3b, v104
  v_mul_f32 v132, 0xbfb8aa3b, v105
  v_mfma_f32_16x16x32_bf16 v[44:47], a[92:95], a[200:203], v[44:47]
  v_exp_f32 v129, v129
  v_mfma_f32_16x16x32_bf16 v[48:51], a[96:99], v[152:155], v[48:51]
  buffer_load_dwordx4 v[228:231], v113, s[24:27], s30 offen offset:0 sc1
  v_mfma_f32_16x16x32_bf16 v[48:51], a[116:119], a[180:183], v[48:51]
  v_exp_f32 v130, v130
  v_mfma_f32_16x16x32_bf16 v[52:55], a[116:119], a[188:191], v[52:55]
  v_exp_f32 v131, v131
  v_mfma_f32_16x16x32_bf16 v[52:55], a[96:99], a[184:187], v[52:55]
  v_exp_f32 v132, v132
  v_mfma_f32_16x16x32_bf16 v[56:59], a[96:99], a[192:195], v[56:59]
  buffer_load_dwordx4 v[232:235], v113, s[24:27], s30 offen offset:1024 sc1
  v_mfma_f32_16x16x32_bf16 v[56:59], a[116:119], a[196:199], v[56:59]
  v_add_f32 v129, 1.0, v129
  v_add_f32 v130, 1.0, v130
  v_mfma_f32_16x16x32_bf16 v[60:63], a[116:119], a[204:207], v[60:63]
  v_add_f32 v131, 1.0, v131
  v_add_f32 v132, 1.0, v132
  v_mfma_f32_16x16x32_bf16 v[60:63], a[96:99], a[200:203], v[60:63]
  v_rcp_f32 v129, v129
  v_mfma_f32_16x16x32_bf16 v[64:67], a[100:103], v[152:155], v[64:67]
  ds_read_b128 v[236:239], v122 offset:0
  s_add_u32 s30, s30, 8192
  v_rcp_f32 v130, v130
  v_mfma_f32_16x16x32_bf16 v[64:67], a[120:123], a[180:183], v[64:67]
  buffer_load_dwordx4 v[240:243], v110, s[24:27], s30 offen offset:0 sc1
  v_mfma_f32_16x16x32_bf16 v[68:71], a[120:123], a[188:191], v[68:71]
  v_rcp_f32 v131, v131
  v_mfma_f32_16x16x32_bf16 v[68:71], a[100:103], a[184:187], v[68:71]
  v_rcp_f32 v132, v132
  v_mfma_f32_16x16x32_bf16 v[72:75], a[100:103], a[192:195], v[72:75]
  buffer_load_dwordx4 v[244:247], v110, s[24:27], s30 offen offset:1024 sc1
  v_mfma_f32_16x16x32_bf16 v[72:75], a[120:123], a[196:199], v[72:75]
  v_mul_f32 v102, v102, v129
  v_mul_f32 v103, v103, v130
  v_mfma_f32_16x16x32_bf16 v[76:79], a[120:123], a[204:207], v[76:79]
  v_mul_f32 v104, v104, v131
  v_mul_f32 v105, v105, v132
  v_mfma_f32_16x16x32_bf16 v[76:79], a[100:103], a[200:203], v[76:79]
  v_cvt_pk_bf16_f32 v102, v102, v102
  v_cvt_pk_bf16_f32 v103, v103, v103
  s_waitcnt vmcnt(10)
  v_mfma_f32_16x16x32_bf16 v[0:3], a[124:127], a[208:211], v[0:3]
  ds_read_b128 v[248:251], v122 offset:1024
  v_cvt_pk_bf16_f32 v104, v104, v104
  v_mfma_f32_16x16x32_bf16 v[0:3], a[176:179], v[176:179], v[0:3]
  buffer_load_dwordx4 v[252:255], v111, s[24:27], s30 offen offset:0 sc1
  v_mfma_f32_16x16x32_bf16 v[4:7], a[176:179], v[184:187], v[4:7]
  v_cvt_pk_bf16_f32 v105, v105, v105
  v_lshlrev_b32 v102, 16, v102
  v_mfma_f32_16x16x32_bf16 v[4:7], a[124:127], v[180:183], v[4:7]
  v_lshlrev_b32 v103, 16, v103
  v_lshlrev_b32 v104, 16, v104
  v_mfma_f32_16x16x32_bf16 v[8:11], a[124:127], v[188:191], v[8:11]
  buffer_load_dwordx4 v[136:139], v111, s[24:27], s30 offen offset:1024 sc1
  v_mfma_f32_16x16x32_bf16 v[8:11], a[176:179], v[192:195], v[8:11]
  v_lshlrev_b32 v105, 16, v105
  v_cvt_pk_bf16_f32 v172, v172, v172
  v_mfma_f32_16x16x32_bf16 v[12:15], a[176:179], v[200:203], v[12:15]
  v_cvt_pk_bf16_f32 v173, v173, v173
  v_cvt_pk_bf16_f32 v174, v174, v174
  v_mfma_f32_16x16x32_bf16 v[12:15], a[124:127], v[196:199], v[12:15]
  v_cvt_pk_bf16_f32 v175, v175, v175
  v_lshlrev_b32 v172, 16, v172
  s_waitcnt lgkmcnt(1)
  v_mfma_f32_16x16x32_bf16 v[16:19], a[160:163], a[208:211], v[16:19]
  ds_read_b128 v[140:143], v122 offset:2048
  v_lshlrev_b32 v173, 16, v173
  v_mfma_f32_16x16x32_bf16 v[16:19], v[236:239], v[176:179], v[16:19]
  buffer_load_dwordx4 v[144:147], v112, s[24:27], s30 offen offset:0 sc1
  v_mfma_f32_16x16x32_bf16 v[20:23], v[236:239], v[184:187], v[20:23]
  v_lshlrev_b32 v174, 16, v174
  v_lshlrev_b32 v175, 16, v175
  v_mfma_f32_16x16x32_bf16 v[20:23], a[160:163], v[180:183], v[20:23]
  v_mul_f32 v172, v172, v124
  v_mul_f32 v173, v173, v124
  v_mfma_f32_16x16x32_bf16 v[24:27], a[160:163], v[188:191], v[24:27]
  buffer_load_dwordx4 v[148:151], v112, s[24:27], s30 offen offset:1024 sc1
  v_mfma_f32_16x16x32_bf16 v[24:27], v[236:239], v[192:195], v[24:27]
  v_mul_f32 v174, v174, v124
  v_mul_f32 v175, v175, v124
  v_mfma_f32_16x16x32_bf16 v[28:31], v[236:239], v[200:203], v[28:31]
  v_cvt_pk_bf16_f32 v172, v172, v172
  v_cvt_pk_bf16_f32 v173, v173, v173
  v_mfma_f32_16x16x32_bf16 v[28:31], a[160:163], v[196:199], v[28:31]
  v_cvt_pk_bf16_f32 v174, v174, v174
  v_cvt_pk_bf16_f32 v175, v175, v175
  s_waitcnt lgkmcnt(1)
  v_mfma_f32_16x16x32_bf16 v[32:35], a[164:167], a[208:211], v[32:35]
  ds_read_b128 v[152:155], v122 offset:3072
  v_lshlrev_b32 v172, 16, v172
  v_mfma_f32_16x16x32_bf16 v[32:35], v[248:251], v[176:179], v[32:35]
  buffer_load_dwordx4 a[180:183], v113, s[24:27], s30 offen offset:0 sc1
  v_mfma_f32_16x16x32_bf16 v[36:39], v[248:251], v[184:187], v[36:39]
  v_lshlrev_b32 v173, 16, v173
  v_lshlrev_b32 v174, 16, v174
  v_mfma_f32_16x16x32_bf16 v[36:39], a[164:167], v[180:183], v[36:39]
  v_lshlrev_b32 v175, 16, v175
  v_add_f32 v106, v106, v172
  v_mfma_f32_16x16x32_bf16 v[40:43], a[164:167], v[188:191], v[40:43]
  buffer_load_dwordx4 a[184:187], v113, s[24:27], s30 offen offset:1024 sc1
  v_mfma_f32_16x16x32_bf16 v[40:43], v[248:251], v[192:195], v[40:43]
  v_add_f32 v107, v107, v173
  v_add_f32 v108, v108, v174
  v_mfma_f32_16x16x32_bf16 v[44:47], v[248:251], v[200:203], v[44:47]
  v_add_f32 v109, v109, v175
  v_cvt_pk_bf16_f32 v106, v106, v106
  v_mfma_f32_16x16x32_bf16 v[44:47], a[164:167], v[196:199], v[44:47]
  v_cvt_pk_bf16_f32 v107, v107, v107
  v_cvt_pk_bf16_f32 v108, v108, v108
  s_waitcnt lgkmcnt(1)
  v_mfma_f32_16x16x32_bf16 v[48:51], a[168:171], a[208:211], v[48:51]
  ds_read_b128 a[188:191], v122 offset:16384
  ds_read_b128 a[192:195], v122 offset:33792
  s_mov_b32 s30, s37
  v_mfma_f32_16x16x32_bf16 v[48:51], v[140:143], v[176:179], v[48:51]
  buffer_load_dwordx4 a[196:199], v110, s[24:27], s30 offen offset:0 sc1
  v_mfma_f32_16x16x32_bf16 v[52:55], v[140:143], v[184:187], v[52:55]
  v_cvt_pk_bf16_f32 v109, v109, v109
  v_lshlrev_b32 v106, 16, v106
  v_mfma_f32_16x16x32_bf16 v[52:55], a[168:171], v[180:183], v[52:55]
  v_lshlrev_b32 v107, 16, v107
  v_lshlrev_b32 v108, 16, v108
  v_mfma_f32_16x16x32_bf16 v[56:59], a[168:171], v[188:191], v[56:59]
  buffer_load_dwordx4 a[200:203], v110, s[24:27], s30 offen offset:1024 sc1
  v_mfma_f32_16x16x32_bf16 v[56:59], v[140:143], v[192:195], v[56:59]
  v_lshlrev_b32 v109, 16, v109
  v_mul_f32 v129, 0xbfb8aa3b, v106
  v_mfma_f32_16x16x32_bf16 v[60:63], v[140:143], v[200:203], v[60:63]
  v_mul_f32 v130, 0xbfb8aa3b, v107
  v_mul_f32 v131, 0xbfb8aa3b, v108
  v_mfma_f32_16x16x32_bf16 v[60:63], a[168:171], v[196:199], v[60:63]
  v_mul_f32 v132, 0xbfb8aa3b, v109
  v_exp_f32 v129, v129
  s_waitcnt lgkmcnt(2)
  v_mfma_f32_16x16x32_bf16 v[64:67], a[172:175], a[208:211], v[64:67]
  ds_read_b128 a[204:207], v122 offset:17408
  ds_read_b128 v[236:239], v122 offset:34816
  v_mfma_f32_16x16x32_bf16 v[64:67], v[152:155], v[176:179], v[64:67]
  v_exp_f32 v130, v130
  v_mfma_f32_16x16x32_bf16 v[68:71], v[152:155], v[184:187], v[68:71]
  v_exp_f32 v131, v131
  v_mfma_f32_16x16x32_bf16 v[68:71], a[172:175], v[180:183], v[68:71]
  v_exp_f32 v132, v132
  v_mfma_f32_16x16x32_bf16 v[72:75], a[172:175], v[188:191], v[72:75]
  v_add_f32 v129, 1.0, v129
  v_add_f32 v130, 1.0, v130
  v_mfma_f32_16x16x32_bf16 v[72:75], v[152:155], v[192:195], v[72:75]
  v_add_f32 v131, 1.0, v131
  v_add_f32 v132, 1.0, v132
  v_mfma_f32_16x16x32_bf16 v[76:79], v[152:155], v[200:203], v[76:79]
  v_rcp_f32 v129, v129
  v_mfma_f32_16x16x32_bf16 v[76:79], a[172:175], v[196:199], v[76:79]
  v_rcp_f32 v130, v130
  s_waitcnt vmcnt(10) lgkmcnt(2)
  v_mfma_f32_16x16x32_bf16 v[0:3], a[188:191], v[204:207], v[0:3]
  ds_read_b128 v[248:251], v122 offset:18432
  ds_read_b128 v[140:143], v122 offset:35840
  v_mfma_f32_16x16x32_bf16 v[0:3], a[192:195], v[208:211], v[0:3]
  buffer_load_dwordx4 v[152:155], v111, s[24:27], s30 offen offset:0 sc1
  v_mfma_f32_16x16x32_bf16 v[4:7], a[192:195], v[216:219], v[4:7]
  v_rcp_f32 v131, v131
  v_mfma_f32_16x16x32_bf16 v[4:7], a[188:191], v[212:215], v[4:7]
  v_rcp_f32 v132, v132
  v_mfma_f32_16x16x32_bf16 v[8:11], a[188:191], v[220:223], v[8:11]
  buffer_load_dwordx4 a[208:211], v111, s[24:27], s30 offen offset:1024 sc1
  v_mfma_f32_16x16x32_bf16 v[8:11], a[192:195], v[224:227], v[8:11]
  v_mul_f32 v106, v106, v129
  v_mul_f32 v107, v107, v130
  v_mfma_f32_16x16x32_bf16 v[12:15], a[192:195], v[232:235], v[12:15]
  v_mul_f32 v108, v108, v131
  v_mul_f32 v109, v109, v132
  v_mfma_f32_16x16x32_bf16 v[12:15], a[188:191], v[228:231], v[12:15]
  v_cvt_pk_bf16_f32 v106, v106, v106
  v_cvt_pk_bf16_f32 v107, v107, v107
  s_waitcnt lgkmcnt(2)
  v_mfma_f32_16x16x32_bf16 v[16:19], a[204:207], v[204:207], v[16:19]
  ds_read_b128 v[176:179], v122 offset:19456
  ds_read_b128 v[180:183], v135 offset:0
  v_mfma_f32_16x16x32_bf16 v[16:19], v[236:239], v[208:211], v[16:19]
  buffer_load_dwordx4 v[184:187], v112, s[24:27], s30 offen offset:0 sc1
  v_mfma_f32_16x16x32_bf16 v[20:23], v[236:239], v[216:219], v[20:23]
  v_cvt_pk_bf16_f32 v108, v108, v108
  v_cvt_pk_bf16_f32 v109, v109, v109
  v_mfma_f32_16x16x32_bf16 v[20:23], a[204:207], v[212:215], v[20:23]
  v_lshlrev_b32 v106, 16, v106
  v_lshlrev_b32 v107, 16, v107
  v_mfma_f32_16x16x32_bf16 v[24:27], a[204:207], v[220:223], v[24:27]
  buffer_load_dwordx4 v[188:191], v112, s[24:27], s30 offen offset:1024 sc1
  v_mfma_f32_16x16x32_bf16 v[24:27], v[236:239], v[224:227], v[24:27]
  v_lshlrev_b32 v108, 16, v108
  v_lshlrev_b32 v109, 16, v109
  v_mfma_f32_16x16x32_bf16 v[28:31], v[236:239], v[232:235], v[28:31]
  v_lshlrev_b32 v156, 16, v80
  v_and_b32 v157, s34, v80
  v_mfma_f32_16x16x32_bf16 v[28:31], a[204:207], v[228:231], v[28:31]
  v_lshlrev_b32 v158, 16, v81
  v_and_b32 v159, s34, v81
  s_waitcnt lgkmcnt(2)
  v_mfma_f32_16x16x32_bf16 v[32:35], v[248:251], v[204:207], v[32:35]
  ds_read_b128 v[192:195], v122 offset:32768
  ds_read_b128 v[196:199], v135 offset:1024
  v_mfma_f32_16x16x32_bf16 v[32:35], v[140:143], v[208:211], v[32:35]
  buffer_load_dwordx4 v[200:203], v113, s[24:27], s30 offen offset:0 sc1
  v_mfma_f32_16x16x32_bf16 v[36:39], v[140:143], v[216:219], v[36:39]
  v_lshlrev_b32 v160, 16, v82
  v_and_b32 v161, s34, v82
  v_mfma_f32_16x16x32_bf16 v[36:39], v[248:251], v[212:215], v[36:39]
  v_lshlrev_b32 v162, 16, v83
  v_and_b32 v163, s34, v83
  v_mfma_f32_16x16x32_bf16 v[40:43], v[248:251], v[220:223], v[40:43]
  buffer_load_dwordx4 a[188:191], v113, s[24:27], s30 offen offset:1024 sc1
  v_mfma_f32_16x16x32_bf16 v[40:43], v[140:143], v[224:227], v[40:43]
  v_lshlrev_b32 v164, 16, v84
  v_and_b32 v165, s34, v84
  v_mfma_f32_16x16x32_bf16 v[44:47], v[140:143], v[232:235], v[44:47]
  v_lshlrev_b32 v166, 16, v85
  v_and_b32 v167, s34, v85
  v_mfma_f32_16x16x32_bf16 v[44:47], v[248:251], v[228:231], v[44:47]
  v_lshlrev_b32 v168, 16, v86
  v_and_b32 v169, s34, v86
  s_waitcnt lgkmcnt(2)
  v_mfma_f32_16x16x32_bf16 v[48:51], v[176:179], v[204:207], v[48:51]
  ds_read_b128 a[192:195], v135 offset:2048
  ds_read_b128 a[204:207], v135 offset:19456
  s_add_u32 s30, s30, 8192
  v_mfma_f32_16x16x32_bf16 v[48:51], v[180:183], v[208:211], v[48:51]
  buffer_load_dwordx4 v[236:239], v110, s[24:27], s30 offen offset:0 sc1
  v_mfma_f32_16x16x32_bf16 v[52:55], v[180:183], v[216:219], v[52:55]
  v_lshlrev_b32 v170, 16, v87
  v_and_b32 v171, s34, v87
  v_mfma_f32_16x16x32_bf16 v[52:55], v[176:179], v[212:215], v[52:55]
  v_lshlrev_b32 v172, 16, v88
  v_and_b32 v173, s34, v88
  v_mfma_f32_16x16x32_bf16 v[56:59], v[176:179], v[220:223], v[56:59]
  v_lshlrev_b32 v174, 16, v89
  v_and_b32 v175, s34, v89
  v_mfma_f32_16x16x32_bf16 v[56:59], v[180:183], v[224:227], v[56:59]
  s_sub_u32 s41, s3, 1
  s_and_b32 s41, s41, 3
  s_lshl_b32 s41, s41, 12
  v_add_u32 v80, s41, v114
  v_mfma_f32_16x16x32_bf16 v[60:63], v[180:183], v[232:235], v[60:63]
  s_sub_u32 s41, s3, 2
  s_and_b32 s41, s41, 3
  s_lshl_b32 s41, s41, 12
  v_add_u32 v81, s41, v114
  v_mfma_f32_16x16x32_bf16 v[60:63], v[176:179], v[228:231], v[60:63]
  s_sub_u32 s41, s3, 3
  s_and_b32 s41, s41, 3
  s_lshl_b32 s41, s41, 12
  v_add_u32 v82, s41, v114
  v_bfe_u32 v129, v114, 8, 1
  s_waitcnt lgkmcnt(2)
  v_mfma_f32_16x16x32_bf16 v[64:67], v[192:195], v[204:207], v[64:67]
  ds_read_b128 v[248:251], v135 offset:3072
  ds_read_b128 v[140:143], v122 offset:49152
  v_mfma_f32_16x16x32_bf16 v[64:67], v[196:199], v[208:211], v[64:67]
  v_mul_u32_u24 v129, 24, v129
  v_add_u32 v83, v117, v129
  v_mfma_f32_16x16x32_bf16 v[68:71], v[196:199], v[216:219], v[68:71]
  v_mfma_f32_16x16x32_bf16 v[68:71], v[192:195], v[212:215], v[68:71]
  v_mfma_f32_16x16x32_bf16 v[72:75], v[192:195], v[220:223], v[72:75]
  v_mfma_f32_16x16x32_bf16 v[72:75], v[196:199], v[224:227], v[72:75]
  v_mfma_f32_16x16x32_bf16 v[76:79], v[196:199], v[232:235], v[76:79]
  v_mfma_f32_16x16x32_bf16 v[76:79], v[192:195], v[228:231], v[76:79]
  s_waitcnt vmcnt(9) lgkmcnt(2)
  v_mfma_f32_16x16x32_bf16 v[0:3], a[192:195], v[240:243], v[0:3]
  ds_read_b128 v[176:179], v135 offset:16384
  ds_read_b128 v[180:183], v122 offset:50176
  s_xor_b32 s38, s40, 1
  v_mfma_f32_16x16x32_bf16 v[0:3], a[204:207], v[244:247], v[0:3]
  buffer_load_dwordx4 v[192:195], v110, s[24:27], s30 offen offset:1024 sc1
  s_lshl_b32 s38, s38, 2
  s_add_u32 s38, s38, s3
  s_lshl_b32 s38, s38, 13
  v_mfma_f32_16x16x32_bf16 v[4:7], a[204:207], v[136:139], v[4:7]
  s_add_u32 s38, s38, 25165824
  s_add_u32 s39, s38, 4096
  v_lshrrev_b32 v125, 1, v114
  v_mfma_f32_16x16x32_bf16 v[4:7], a[192:195], v[252:255], v[4:7]
  v_mfma_f32_16x16x32_bf16 v[8:11], a[192:195], v[144:147], v[8:11]
  buffer_load_dwordx4 v[196:199], v111, s[24:27], s30 offen offset:0 sc1
  v_mfma_f32_16x16x32_bf16 v[8:11], a[204:207], v[148:151], v[8:11]
  v_mfma_f32_16x16x32_bf16 v[12:15], a[204:207], a[184:187], v[12:15]
  v_mfma_f32_16x16x32_bf16 v[12:15], a[192:195], a[180:183], v[12:15]
  s_waitcnt lgkmcnt(2)
  v_mfma_f32_16x16x32_bf16 v[16:19], v[248:251], v[240:243], v[16:19]
  ds_read_b128 v[204:207], v135 offset:17408
  ds_read_b128 v[208:211], v122 offset:51200
  v_mfma_f32_16x16x32_bf16 v[16:19], v[140:143], v[244:247], v[16:19]
  buffer_load_dwordx4 v[212:215], v111, s[24:27], s30 offen offset:1024 sc1
  v_mfma_f32_16x16x32_bf16 v[20:23], v[140:143], v[136:139], v[20:23]
  ds_write_b128 v118, v[4:7] offset:0
  ds_write_b128 v118, v[8:11] offset:5120
  v_mfma_f32_16x16x32_bf16 v[20:23], v[248:251], v[252:255], v[20:23]
  ds_write_b128 v118, v[12:15] offset:10240
  v_mfma_f32_16x16x32_bf16 v[24:27], v[248:251], v[144:147], v[24:27]
  buffer_load_dwordx4 v[216:219], v112, s[24:27], s30 offen offset:0 sc1
  v_mfma_f32_16x16x32_bf16 v[24:27], v[140:143], v[148:151], v[24:27]
  v_mfma_f32_16x16x32_bf16 v[28:31], v[140:143], a[184:187], v[28:31]
  v_mfma_f32_16x16x32_bf16 v[28:31], v[248:251], a[180:183], v[28:31]
  s_waitcnt lgkmcnt(5)
  v_mfma_f32_16x16x32_bf16 v[32:35], v[176:179], v[240:243], v[32:35]
  ds_read_b128 v[220:223], v135 offset:18432
  ds_read_b128 v[224:227], v122 offset:52224
  v_mfma_f32_16x16x32_bf16 v[32:35], v[180:183], v[244:247], v[32:35]
  buffer_load_dwordx4 v[228:231], v112, s[24:27], s30 offen offset:1024 sc1
  v_mfma_f32_16x16x32_bf16 v[36:39], v[180:183], v[136:139], v[36:39]
  ds_write_b128 v118, v[20:23] offset:1024
  ds_write_b128 v118, v[24:27] offset:6144
  v_mfma_f32_16x16x32_bf16 v[36:39], v[176:179], v[252:255], v[36:39]
  ds_write_b128 v118, v[28:31] offset:11264
  v_mfma_f32_16x16x32_bf16 v[40:43], v[176:179], v[144:147], v[40:43]
  buffer_load_dwordx4 v[232:235], v113, s[24:27], s30 offen offset:0 sc1
  v_mfma_f32_16x16x32_bf16 v[40:43], v[180:183], v[148:151], v[40:43]
  v_mfma_f32_16x16x32_bf16 v[44:47], v[180:183], a[184:187], v[44:47]
  v_mfma_f32_16x16x32_bf16 v[44:47], v[176:179], a[180:183], v[44:47]
  s_waitcnt lgkmcnt(8)
  v_mfma_f32_16x16x32_bf16 v[48:51], v[204:207], v[240:243], v[48:51]
  buffer_load_dwordx4 a[192:195], v113, s[24:27], s30 offen offset:1024 sc1
  v_mfma_f32_16x16x32_bf16 v[48:51], v[208:211], v[244:247], v[48:51]
  ds_write_b128 v118, v[36:39] offset:2048
  v_mfma_f32_16x16x32_bf16 v[52:55], v[208:211], v[136:139], v[52:55]
  ds_write_b128 v118, v[40:43] offset:7168
  v_mfma_f32_16x16x32_bf16 v[52:55], v[204:207], v[252:255], v[52:55]
  ds_write_b128 v118, v[44:47] offset:12288
  v_mfma_f32_16x16x32_bf16 v[56:59], v[204:207], v[144:147], v[56:59]
  s_add_u32 s30, s30, 8192
  buffer_load_dwordx4 a[204:207], v110, s[24:27], s30 offen offset:0 sc1
  v_mfma_f32_16x16x32_bf16 v[56:59], v[208:211], v[148:151], v[56:59]
  v_mfma_f32_16x16x32_bf16 v[60:63], v[208:211], a[184:187], v[60:63]
  v_mfma_f32_16x16x32_bf16 v[60:63], v[204:207], a[180:183], v[60:63]
  s_waitcnt lgkmcnt(6)
  v_mfma_f32_16x16x32_bf16 v[64:67], v[220:223], v[240:243], v[64:67]
  buffer_load_dwordx4 v[248:251], v110, s[24:27], s30 offen offset:1024 sc1
  v_mfma_f32_16x16x32_bf16 v[64:67], v[224:227], v[244:247], v[64:67]
  ds_write_b128 v118, v[52:55] offset:3072
  v_mfma_f32_16x16x32_bf16 v[68:71], v[224:227], v[136:139], v[68:71]
  ds_write_b128 v118, v[56:59] offset:8192
  v_mfma_f32_16x16x32_bf16 v[68:71], v[220:223], v[252:255], v[68:71]
  ds_write_b128 v118, v[60:63] offset:13312
  v_mfma_f32_16x16x32_bf16 v[72:75], v[220:223], v[144:147], v[72:75]
  buffer_load_dwordx4 v[140:143], v111, s[24:27], s30 offen offset:0 sc1
  v_mfma_f32_16x16x32_bf16 v[72:75], v[224:227], v[148:151], v[72:75]
  v_mfma_f32_16x16x32_bf16 v[76:79], v[224:227], a[184:187], v[76:79]
  v_mfma_f32_16x16x32_bf16 v[76:79], v[220:223], a[180:183], v[76:79]
  s_nop 1
  ds_write_b128 v118, v[68:71] offset:4096
  s_nop 2
  ds_write_b128 v118, v[72:75] offset:9216
  s_nop 0
  ds_write_b128 v118, v[76:79] offset:14336
  buffer_load_dwordx4 v[176:179], v111, s[24:27], s30 offen offset:1024 sc1
  buffer_load_dwordx4 v[180:183], v112, s[24:27], s30 offen offset:0 sc1
  buffer_load_dwordx4 v[204:207], v112, s[24:27], s30 offen offset:1024 sc1
  buffer_load_dwordx4 v[208:211], v113, s[24:27], s30 offen offset:0 sc1
  buffer_load_dwordx4 v[220:223], v113, s[24:27], s30 offen offset:1024 sc1
  s_add_u32 s30, s30, 8192
  buffer_load_dwordx4 v[224:227], v110, s[24:27], s30 offen offset:0 sc1
  buffer_load_dwordx4 v[240:243], v110, s[24:27], s30 offen offset:1024 sc1
  buffer_load_dwordx4 v[244:247], v111, s[24:27], s30 offen offset:0 sc1
  buffer_load_dwordx4 v[252:255], v111, s[24:27], s30 offen offset:1024 sc1
  buffer_load_dwordx4 v[136:139], v112, s[24:27], s30 offen offset:0 sc1
  buffer_load_dwordx4 v[144:147], v112, s[24:27], s30 offen offset:1024 sc1
  buffer_load_dwordx4 v[148:151], v113, s[24:27], s30 offen offset:0 sc1
  buffer_load_dwordx4 a[180:183], v113, s[24:27], s30 offen offset:1024 sc1
  s_add_u32 s30, s30, 8192
  buffer_load_dwordx4 a[184:187], v110, s[24:27], s30 offen offset:0 sc1
  s_waitcnt lgkmcnt(0)
  s_barrier
  ds_read_b128 v[4:7], v119 offset:0
  ds_read_b128 v[8:11], v120 offset:5120
  ds_read_b128 v[12:15], v121 offset:10240
  ds_read_b128 v[20:23], v119 offset:1024
  ds_read_b128 v[24:27], v120 offset:6144
  ds_read_b128 v[28:31], v121 offset:11264
  ds_read_b128 v[36:39], v119 offset:2048
  ds_read_b128 v[40:43], v120 offset:7168
  ds_read_b128 v[44:47], v121 offset:12288
  ds_read_b128 v[52:55], v119 offset:3072
  ds_read_b128 v[56:59], v120 offset:8192
  ds_read_b128 v[60:63], v121 offset:13312
  ds_read_b128 v[68:71], v119 offset:4096
  ds_read_b128 v[72:75], v120 offset:9216
  ds_read_b128 v[76:79], v121 offset:14336
  s_waitcnt lgkmcnt(12)
  v_add_f32 v4, v4, v8
  v_add_f32 v5, v5, v9
  v_add_f32 v6, v6, v10
  v_add_f32 v7, v7, v11
  v_add_f32 v0, v0, v12
  v_add_f32 v1, v1, v13
  v_add_f32 v2, v2, v14
  v_add_f32 v3, v3, v15
  v_add_f32 v0, v0, v4
  v_add_f32 v1, v1, v5
  v_add_f32 v2, v2, v6
  v_add_f32 v3, v3, v7
  v_cvt_pk_bf16_f32 v4, v0, v1
  v_cvt_pk_bf16_f32 v5, v2, v3
  buffer_store_dwordx2 v[4:5], v125, s[24:27], s38 offen offset:0 sc1
  s_waitcnt vmcnt(26)
  v_mfma_f32_16x16x32_bf16 v[0:3], a[212:215], a[196:199], 0
  s_waitcnt lgkmcnt(9)
  v_add_f32 v20, v20, v24
  v_add_f32 v21, v21, v25
  v_mfma_f32_16x16x32_bf16 v[0:3], a[232:235], a[200:203], v[0:3]
  v_add_f32 v22, v22, v26
  v_add_f32 v23, v23, v27
  v_mfma_f32_16x16x32_bf16 v[4:7], a[232:235], a[208:211], 0
  v_add_f32 v16, v16, v28
  v_add_f32 v17, v17, v29
  v_mfma_f32_16x16x32_bf16 v[4:7], a[212:215], v[152:155], v[4:7]
  v_add_f32 v18, v18, v30
  v_add_f32 v19, v19, v31
  v_mfma_f32_16x16x32_bf16 v[8:11], a[212:215], v[184:187], 0
  v_add_f32 v16, v16, v20
  v_add_f32 v17, v17, v21
  v_mfma_f32_16x16x32_bf16 v[8:11], a[232:235], v[188:191], v[8:11]
  v_add_f32 v18, v18, v22
  v_add_f32 v19, v19, v23
  v_mfma_f32_16x16x32_bf16 v[12:15], a[232:235], a[188:191], 0
  v_cvt_pk_bf16_f32 v20, v16, v17
  v_cvt_pk_bf16_f32 v21, v18, v19
  v_mfma_f32_16x16x32_bf16 v[12:15], a[212:215], v[200:203], v[12:15]
  buffer_store_dwordx2 v[20:21], v125, s[24:27], s38 offen offset:512 sc1
  s_waitcnt lgkmcnt(6)
  v_mfma_f32_16x16x32_bf16 v[16:19], a[216:219], a[196:199], 0
  buffer_load_dwordx4 a[212:215], v110, s[24:27], s30 offen offset:1024 sc1
  v_mfma_f32_16x16x32_bf16 v[16:19], a[236:239], a[200:203], v[16:19]
  v_add_f32 v36, v36, v40
  v_add_f32 v37, v37, v41
  v_mfma_f32_16x16x32_bf16 v[20:23], a[236:239], a[208:211], 0
  v_add_f32 v38, v38, v42
  v_add_f32 v39, v39, v43
  v_mfma_f32_16x16x32_bf16 v[20:23], a[216:219], v[152:155], v[20:23]
  v_add_f32 v32, v32, v44
  v_add_f32 v33, v33, v45
  v_mfma_f32_16x16x32_bf16 v[24:27], a[216:219], v[184:187], 0
  buffer_load_dwordx4 a[232:235], v111, s[24:27], s30 offen offset:0 sc1
  v_mfma_f32_16x16x32_bf16 v[24:27], a[236:239], v[188:191], v[24:27]
  v_add_f32 v34, v34, v46
  v_add_f32 v35, v35, v47
  v_mfma_f32_16x16x32_bf16 v[28:31], a[236:239], a[188:191], 0
  v_add_f32 v32, v32, v36
  v_add_f32 v33, v33, v37
  v_mfma_f32_16x16x32_bf16 v[28:31], a[216:219], v[200:203], v[28:31]
  v_add_f32 v34, v34, v38
  v_add_f32 v35, v35, v39
  v_cvt_pk_bf16_f32 v36, v32, v33
  v_cvt_pk_bf16_f32 v37, v34, v35
  buffer_store_dwordx2 v[36:37], v125, s[24:27], s38 offen offset:1024 sc1
  v_mfma_f32_16x16x32_bf16 v[32:35], a[220:223], a[196:199], 0
  buffer_load_dwordx4 a[216:219], v111, s[24:27], s30 offen offset:1024 sc1
  s_waitcnt lgkmcnt(3)
  v_mfma_f32_16x16x32_bf16 v[32:35], a[240:243], a[200:203], v[32:35]
  v_add_f32 v52, v52, v56
  v_add_f32 v53, v53, v57
  v_mfma_f32_16x16x32_bf16 v[36:39], a[240:243], a[208:211], 0
  v_add_f32 v54, v54, v58
  v_add_f32 v55, v55, v59
  v_mfma_f32_16x16x32_bf16 v[36:39], a[220:223], v[152:155], v[36:39]
  v_add_f32 v48, v48, v60
  v_add_f32 v49, v49, v61
  v_mfma_f32_16x16x32_bf16 v[40:43], a[220:223], v[184:187], 0
  buffer_load_dwordx4 a[236:239], v112, s[24:27], s30 offen offset:0 sc1
  v_mfma_f32_16x16x32_bf16 v[40:43], a[240:243], v[188:191], v[40:43]
  v_add_f32 v50, v50, v62
  v_add_f32 v51, v51, v63
  v_mfma_f32_16x16x32_bf16 v[44:47], a[240:243], a[188:191], 0
  v_add_f32 v48, v48, v52
  v_add_f32 v49, v49, v53
  v_mfma_f32_16x16x32_bf16 v[44:47], a[220:223], v[200:203], v[44:47]
  v_add_f32 v50, v50, v54
  v_add_f32 v51, v51, v55
  v_cvt_pk_bf16_f32 v52, v48, v49
  v_cvt_pk_bf16_f32 v53, v50, v51
  buffer_store_dwordx2 v[52:53], v125, s[24:27], s38 offen offset:1536 sc1
  v_mfma_f32_16x16x32_bf16 v[48:51], a[224:227], a[196:199], 0
  buffer_load_dwordx4 a[220:223], v112, s[24:27], s30 offen offset:1024 sc1
  s_waitcnt lgkmcnt(0)
  v_mfma_f32_16x16x32_bf16 v[48:51], a[244:247], a[200:203], v[48:51]
  v_add_f32 v68, v68, v72
  v_add_f32 v69, v69, v73
  v_mfma_f32_16x16x32_bf16 v[52:55], a[244:247], a[208:211], 0
  v_add_f32 v70, v70, v74
  v_add_f32 v71, v71, v75
  v_mfma_f32_16x16x32_bf16 v[52:55], a[224:227], v[152:155], v[52:55]
  v_add_f32 v64, v64, v76
  v_add_f32 v65, v65, v77
  v_mfma_f32_16x16x32_bf16 v[56:59], a[224:227], v[184:187], 0
  buffer_load_dwordx4 a[240:243], v113, s[24:27], s30 offen offset:0 sc1
  v_mfma_f32_16x16x32_bf16 v[56:59], a[244:247], v[188:191], v[56:59]
  v_add_f32 v66, v66, v78
  v_add_f32 v67, v67, v79
  v_mfma_f32_16x16x32_bf16 v[60:63], a[244:247], a[188:191], 0
  v_add_f32 v64, v64, v68
  v_add_f32 v65, v65, v69
  v_mfma_f32_16x16x32_bf16 v[60:63], a[224:227], v[200:203], v[60:63]
  v_add_f32 v66, v66, v70
  v_add_f32 v67, v67, v71
  v_cvt_pk_bf16_f32 v68, v64, v65
  v_cvt_pk_bf16_f32 v69, v66, v67
  buffer_store_dwordx2 v[68:69], v125, s[24:27], s38 offen offset:2048 sc1
  v_mfma_f32_16x16x32_bf16 v[64:67], a[228:231], a[196:199], 0
  buffer_load_dwordx4 a[224:227], v113, s[24:27], s30 offen offset:1024 sc1
  s_xor_b32 s38, s40, 1
  s_lshl_b32 s38, s38, 7
  s_add_u32 s38, s38, 2834432
  v_mfma_f32_16x16x32_bf16 v[64:67], a[248:251], a[200:203], v[64:67]
  v_mov_b32 v126, 1073741824
  v_writelane_b32 v126, s38, 0
  v_mfma_f32_16x16x32_bf16 v[68:71], a[248:251], a[208:211], 0
  v_mov_b32 v127, 1
  v_mfma_f32_16x16x32_bf16 v[68:71], a[228:231], v[152:155], v[68:71]
  s_xor_b32 s38, s38, 128
  v_mov_b32 v133, s38
  v_mov_b32 v134, 4
  v_mfma_f32_16x16x32_bf16 v[72:75], a[228:231], v[184:187], 0
  s_add_u32 s30, s30, 8192
  buffer_load_dwordx4 a[244:247], v110, s[24:27], s30 offen offset:0 sc1
  v_mfma_f32_16x16x32_bf16 v[72:75], a[248:251], v[188:191], v[72:75]
  v_mfma_f32_16x16x32_bf16 v[76:79], a[248:251], a[188:191], 0
  v_mfma_f32_16x16x32_bf16 v[76:79], a[228:231], v[200:203], v[76:79]
  s_waitcnt vmcnt(30)
  v_mfma_f32_16x16x32_bf16 v[0:3], a[252:255], v[236:239], v[0:3]
  buffer_load_dwordx4 a[228:231], v110, s[24:27], s30 offen offset:1024 sc1
  v_mfma_f32_16x16x32_bf16 v[0:3], a[144:147], v[192:195], v[0:3]
  v_mfma_f32_16x16x32_bf16 v[4:7], a[144:147], v[212:215], v[4:7]
  v_mfma_f32_16x16x32_bf16 v[4:7], a[252:255], v[196:199], v[4:7]
  v_mfma_f32_16x16x32_bf16 v[8:11], a[252:255], v[216:219], v[8:11]
  buffer_load_dwordx4 a[248:251], v111, s[24:27], s30 offen offset:0 sc1
  v_mfma_f32_16x16x32_bf16 v[8:11], a[144:147], v[228:231], v[8:11]
  v_mfma_f32_16x16x32_bf16 v[12:15], a[144:147], a[192:195], v[12:15]
  v_mfma_f32_16x16x32_bf16 v[12:15], a[252:255], v[232:235], v[12:15]
  v_mfma_f32_16x16x32_bf16 v[16:19], a[128:131], v[236:239], v[16:19]
  buffer_load_dwordx4 a[196:199], v111, s[24:27], s30 offen offset:1024 sc1
  v_mfma_f32_16x16x32_bf16 v[16:19], a[148:151], v[192:195], v[16:19]
  v_mfma_f32_16x16x32_bf16 v[20:23], a[148:151], v[212:215], v[20:23]
  v_mfma_f32_16x16x32_bf16 v[20:23], a[128:131], v[196:199], v[20:23]
  v_mfma_f32_16x16x32_bf16 v[24:27], a[128:131], v[216:219], v[24:27]
  buffer_load_dwordx4 a[200:203], v112, s[24:27], s30 offen offset:0 sc1
  v_mfma_f32_16x16x32_bf16 v[24:27], a[148:151], v[228:231], v[24:27]
  v_mfma_f32_16x16x32_bf16 v[28:31], a[148:151], a[192:195], v[28:31]
  v_mfma_f32_16x16x32_bf16 v[28:31], a[128:131], v[232:235], v[28:31]
  v_mfma_f32_16x16x32_bf16 v[32:35], a[132:135], v[236:239], v[32:35]
  buffer_load_dwordx4 a[208:211], v112, s[24:27], s30 offen offset:1024 sc1
  v_mfma_f32_16x16x32_bf16 v[32:35], a[152:155], v[192:195], v[32:35]
  v_mfma_f32_16x16x32_bf16 v[36:39], a[152:155], v[212:215], v[36:39]
  v_mfma_f32_16x16x32_bf16 v[36:39], a[132:135], v[196:199], v[36:39]
  v_mfma_f32_16x16x32_bf16 v[40:43], a[132:135], v[216:219], v[40:43]
  buffer_load_dwordx4 v[184:187], v113, s[24:27], s30 offen offset:0 sc1
  v_mfma_f32_16x16x32_bf16 v[40:43], a[152:155], v[228:231], v[40:43]
  v_mfma_f32_16x16x32_bf16 v[44:47], a[152:155], a[192:195], v[44:47]
  v_mfma_f32_16x16x32_bf16 v[44:47], a[132:135], v[232:235], v[44:47]
  v_mfma_f32_16x16x32_bf16 v[48:51], a[136:139], v[236:239], v[48:51]
  buffer_load_dwordx4 v[188:191], v113, s[24:27], s30 offen offset:1024 sc1
  v_mfma_f32_16x16x32_bf16 v[48:51], a[156:159], v[192:195], v[48:51]
  v_mfma_f32_16x16x32_bf16 v[52:55], a[156:159], v[212:215], v[52:55]
  v_mfma_f32_16x16x32_bf16 v[52:55], a[136:139], v[196:199], v[52:55]
  v_mfma_f32_16x16x32_bf16 v[56:59], a[136:139], v[216:219], v[56:59]
  s_add_u32 s30, s30, 8192
  buffer_load_dwordx4 v[200:203], v110, s[24:27], s30 offen offset:0 sc1
  v_mfma_f32_16x16x32_bf16 v[56:59], a[156:159], v[228:231], v[56:59]
  v_mfma_f32_16x16x32_bf16 v[60:63], a[156:159], a[192:195], v[60:63]
  v_mfma_f32_16x16x32_bf16 v[60:63], a[136:139], v[232:235], v[60:63]
  v_mfma_f32_16x16x32_bf16 v[64:67], a[140:143], v[236:239], v[64:67]
  buffer_load_dwordx4 a[188:191], v110, s[24:27], s30 offen offset:1024 sc1
  v_mfma_f32_16x16x32_bf16 v[64:67], a[0:3], v[192:195], v[64:67]
  v_mfma_f32_16x16x32_bf16 v[68:71], a[0:3], v[212:215], v[68:71]
  v_mfma_f32_16x16x32_bf16 v[68:71], a[140:143], v[196:199], v[68:71]
  v_mfma_f32_16x16x32_bf16 v[72:75], a[140:143], v[216:219], v[72:75]
  buffer_load_dwordx4 a[252:255], v111, s[24:27], s30 offen offset:0 sc1
  v_mfma_f32_16x16x32_bf16 v[72:75], a[0:3], v[228:231], v[72:75]
  v_mfma_f32_16x16x32_bf16 v[76:79], a[0:3], a[192:195], v[76:79]
  v_mfma_f32_16x16x32_bf16 v[76:79], a[140:143], v[232:235], v[76:79]
  s_waitcnt vmcnt(32)
  v_mfma_f32_16x16x32_bf16 v[0:3], a[4:7], a[204:207], v[0:3]
  buffer_load_dwordx4 a[144:147], v111, s[24:27], s30 offen offset:1024 sc1
  v_mfma_f32_16x16x32_bf16 v[0:3], a[24:27], v[248:251], v[0:3]
  v_mfma_f32_16x16x32_bf16 v[4:7], a[24:27], v[176:179], v[4:7]
  v_mfma_f32_16x16x32_bf16 v[4:7], a[4:7], v[140:143], v[4:7]
  v_mfma_f32_16x16x32_bf16 v[8:11], a[4:7], v[180:183], v[8:11]
  buffer_load_dwordx4 a[128:131], v112, s[24:27], s30 offen offset:0 sc1
  v_mfma_f32_16x16x32_bf16 v[8:11], a[24:27], v[204:207], v[8:11]
  v_mfma_f32_16x16x32_bf16 v[12:15], a[24:27], v[220:223], v[12:15]
  v_mfma_f32_16x16x32_bf16 v[12:15], a[4:7], v[208:211], v[12:15]
  v_mfma_f32_16x16x32_bf16 v[16:19], a[8:11], a[204:207], v[16:19]
  buffer_load_dwordx4 a[148:151], v112, s[24:27], s30 offen offset:1024 sc1
  v_mfma_f32_16x16x32_bf16 v[16:19], a[28:31], v[248:251], v[16:19]
  v_mfma_f32_16x16x32_bf16 v[20:23], a[28:31], v[176:179], v[20:23]
  v_mfma_f32_16x16x32_bf16 v[20:23], a[8:11], v[140:143], v[20:23]
  v_mfma_f32_16x16x32_bf16 v[24:27], a[8:11], v[180:183], v[24:27]
  buffer_load_dwordx4 a[132:135], v113, s[24:27], s30 offen offset:0 sc1
  v_mfma_f32_16x16x32_bf16 v[24:27], a[28:31], v[204:207], v[24:27]
  v_mfma_f32_16x16x32_bf16 v[28:31], a[28:31], v[220:223], v[28:31]
  v_mfma_f32_16x16x32_bf16 v[28:31], a[8:11], v[208:211], v[28:31]
  v_mfma_f32_16x16x32_bf16 v[32:35], a[12:15], a[204:207], v[32:35]
  buffer_load_dwordx4 a[152:155], v113, s[24:27], s30 offen offset:1024 sc1
  v_mfma_f32_16x16x32_bf16 v[32:35], a[32:35], v[248:251], v[32:35]
  v_mfma_f32_16x16x32_bf16 v[36:39], a[32:35], v[176:179], v[36:39]
  v_mfma_f32_16x16x32_bf16 v[36:39], a[12:15], v[140:143], v[36:39]
  v_mfma_f32_16x16x32_bf16 v[40:43], a[12:15], v[180:183], v[40:43]
  s_add_u32 s30, s30, 8192
  buffer_load_dwordx4 a[136:139], v110, s[24:27], s30 offen offset:0 sc1
  v_mfma_f32_16x16x32_bf16 v[40:43], a[32:35], v[204:207], v[40:43]
  v_mfma_f32_16x16x32_bf16 v[44:47], a[32:35], v[220:223], v[44:47]
  v_mfma_f32_16x16x32_bf16 v[44:47], a[12:15], v[208:211], v[44:47]
  v_mfma_f32_16x16x32_bf16 v[48:51], a[16:19], a[204:207], v[48:51]
  buffer_load_dwordx4 a[156:159], v110, s[24:27], s30 offen offset:1024 sc1
  v_mfma_f32_16x16x32_bf16 v[48:51], a[36:39], v[248:251], v[48:51]
  v_mfma_f32_16x16x32_bf16 v[52:55], a[36:39], v[176:179], v[52:55]
  v_mfma_f32_16x16x32_bf16 v[52:55], a[16:19], v[140:143], v[52:55]
  v_mfma_f32_16x16x32_bf16 v[56:59], a[16:19], v[180:183], v[56:59]
  buffer_load_dwordx4 a[140:143], v111, s[24:27], s30 offen offset:0 sc1
  v_mfma_f32_16x16x32_bf16 v[56:59], a[36:39], v[204:207], v[56:59]
  v_mfma_f32_16x16x32_bf16 v[60:63], a[36:39], v[220:223], v[60:63]
  v_mfma_f32_16x16x32_bf16 v[60:63], a[16:19], v[208:211], v[60:63]
  v_mfma_f32_16x16x32_bf16 v[64:67], a[20:23], a[204:207], v[64:67]
  buffer_load_dwordx4 a[0:3], v111, s[24:27], s30 offen offset:1024 sc1
  v_mfma_f32_16x16x32_bf16 v[64:67], a[40:43], v[248:251], v[64:67]
  v_mfma_f32_16x16x32_bf16 v[68:71], a[40:43], v[176:179], v[68:71]
  v_mfma_f32_16x16x32_bf16 v[68:71], a[20:23], v[140:143], v[68:71]
  v_mfma_f32_16x16x32_bf16 v[72:75], a[20:23], v[180:183], v[72:75]
  buffer_load_dwordx4 v[236:239], v112, s[24:27], s30 offen offset:0 sc1
  v_mfma_f32_16x16x32_bf16 v[72:75], a[40:43], v[204:207], v[72:75]
  v_mfma_f32_16x16x32_bf16 v[76:79], a[40:43], v[220:223], v[76:79]
  v_mfma_f32_16x16x32_bf16 v[76:79], a[20:23], v[208:211], v[76:79]
  s_waitcnt vmcnt(34)
  v_mfma_f32_16x16x32_bf16 v[0:3], a[44:47], v[224:227], v[0:3]
  buffer_load_dwordx4 v[192:195], v112, s[24:27], s30 offen offset:1024 sc1
  s_waitcnt vmcnt(23)
  v_mfma_f32_16x16x32_bf16 v[0:3], a[64:67], v[240:243], v[0:3]
  buffer_atomic_add v127, v126, s[24:27], 0 offen
  v_mfma_f32_16x16x32_bf16 v[4:7], a[64:67], v[252:255], v[4:7]
  v_mfma_f32_16x16x32_bf16 v[4:7], a[44:47], v[244:247], v[4:7]
  v_mfma_f32_16x16x32_bf16 v[8:11], a[44:47], v[136:139], v[8:11]
  buffer_load_dwordx4 v[196:199], v113, s[24:27], s30 offen offset:0 sc1
  v_mfma_f32_16x16x32_bf16 v[8:11], a[64:67], v[144:147], v[8:11]
  v_mfma_f32_16x16x32_bf16 v[12:15], a[64:67], a[180:183], v[12:15]
  v_mfma_f32_16x16x32_bf16 v[12:15], a[44:47], v[148:151], v[12:15]
  v_mfma_f32_16x16x32_bf16 v[16:19], a[48:51], v[224:227], v[16:19]
  buffer_load_dwordx4 v[212:215], v113, s[24:27], s30 offen offset:1024 sc1
  v_mfma_f32_16x16x32_bf16 v[16:19], a[68:71], v[240:243], v[16:19]
  v_mfma_f32_16x16x32_bf16 v[20:23], a[68:71], v[252:255], v[20:23]
  v_mfma_f32_16x16x32_bf16 v[20:23], a[48:51], v[244:247], v[20:23]
  v_mfma_f32_16x16x32_bf16 v[24:27], a[48:51], v[136:139], v[24:27]
  s_add_u32 s30, s30, 8192
  v_mfma_f32_16x16x32_bf16 v[24:27], a[68:71], v[144:147], v[24:27]
  v_mfma_f32_16x16x32_bf16 v[28:31], a[68:71], a[180:183], v[28:31]
  v_mfma_f32_16x16x32_bf16 v[28:31], a[48:51], v[148:151], v[28:31]
  v_mfma_f32_16x16x32_bf16 v[32:35], a[52:55], v[224:227], v[32:35]
  v_mfma_f32_16x16x32_bf16 v[32:35], a[72:75], v[240:243], v[32:35]
  v_mfma_f32_16x16x32_bf16 v[36:39], a[72:75], v[252:255], v[36:39]
  v_mfma_f32_16x16x32_bf16 v[36:39], a[52:55], v[244:247], v[36:39]
  v_mfma_f32_16x16x32_bf16 v[40:43], a[52:55], v[136:139], v[40:43]
  v_mfma_f32_16x16x32_bf16 v[40:43], a[72:75], v[144:147], v[40:43]
  v_mfma_f32_16x16x32_bf16 v[44:47], a[72:75], a[180:183], v[44:47]
  v_mfma_f32_16x16x32_bf16 v[44:47], a[52:55], v[148:151], v[44:47]
  v_mfma_f32_16x16x32_bf16 v[48:51], a[56:59], v[224:227], v[48:51]
  v_mfma_f32_16x16x32_bf16 v[48:51], a[76:79], v[240:243], v[48:51]
  v_mfma_f32_16x16x32_bf16 v[52:55], a[76:79], v[252:255], v[52:55]
  v_mfma_f32_16x16x32_bf16 v[52:55], a[56:59], v[244:247], v[52:55]
  v_mfma_f32_16x16x32_bf16 v[56:59], a[56:59], v[136:139], v[56:59]
  v_mfma_f32_16x16x32_bf16 v[56:59], a[76:79], v[144:147], v[56:59]
  v_mfma_f32_16x16x32_bf16 v[60:63], a[76:79], a[180:183], v[60:63]
  v_mfma_f32_16x16x32_bf16 v[60:63], a[56:59], v[148:151], v[60:63]
  v_mfma_f32_16x16x32_bf16 v[64:67], a[60:63], v[224:227], v[64:67]
  v_mfma_f32_16x16x32_bf16 v[64:67], a[80:83], v[240:243], v[64:67]
  v_mfma_f32_16x16x32_bf16 v[68:71], a[80:83], v[252:255], v[68:71]
  v_mfma_f32_16x16x32_bf16 v[68:71], a[60:63], v[244:247], v[68:71]
  v_mfma_f32_16x16x32_bf16 v[72:75], a[60:63], v[136:139], v[72:75]
  v_mfma_f32_16x16x32_bf16 v[72:75], a[80:83], v[144:147], v[72:75]
  v_mfma_f32_16x16x32_bf16 v[76:79], a[80:83], a[180:183], v[76:79]
  v_mfma_f32_16x16x32_bf16 v[76:79], a[60:63], v[148:151], v[76:79]
  s_waitcnt vmcnt(25)
  v_mfma_f32_16x16x32_bf16 v[0:3], a[84:87], a[184:187], v[0:3]
  v_mfma_f32_16x16x32_bf16 v[0:3], a[104:107], a[212:215], v[0:3]
  v_mfma_f32_16x16x32_bf16 v[4:7], a[104:107], a[216:219], v[4:7]
  v_mfma_f32_16x16x32_bf16 v[4:7], a[84:87], a[232:235], v[4:7]
  v_mfma_f32_16x16x32_bf16 v[8:11], a[84:87], a[236:239], v[8:11]
  v_mfma_f32_16x16x32_bf16 v[8:11], a[104:107], a[220:223], v[8:11]
  v_mfma_f32_16x16x32_bf16 v[12:15], a[104:107], a[224:227], v[12:15]
  v_mfma_f32_16x16x32_bf16 v[12:15], a[84:87], a[240:243], v[12:15]
  v_mfma_f32_16x16x32_bf16 v[16:19], a[88:91], a[184:187], v[16:19]
  v_mfma_f32_16x16x32_bf16 v[16:19], a[108:111], a[212:215], v[16:19]
  v_mfma_f32_16x16x32_bf16 v[20:23], a[108:111], a[216:219], v[20:23]
  v_mfma_f32_16x16x32_bf16 v[20:23], a[88:91], a[232:235], v[20:23]
  v_mfma_f32_16x16x32_bf16 v[24:27], a[88:91], a[236:239], v[24:27]
  v_mfma_f32_16x16x32_bf16 v[24:27], a[108:111], a[220:223], v[24:27]
  v_mfma_f32_16x16x32_bf16 v[28:31], a[108:111], a[224:227], v[28:31]
  v_mfma_f32_16x16x32_bf16 v[28:31], a[88:91], a[240:243], v[28:31]
  v_mfma_f32_16x16x32_bf16 v[32:35], a[92:95], a[184:187], v[32:35]
  v_mfma_f32_16x16x32_bf16 v[32:35], a[112:115], a[212:215], v[32:35]
  v_mfma_f32_16x16x32_bf16 v[36:39], a[112:115], a[216:219], v[36:39]
  v_mfma_f32_16x16x32_bf16 v[36:39], a[92:95], a[232:235], v[36:39]
  v_mfma_f32_16x16x32_bf16 v[40:43], a[92:95], a[236:239], v[40:43]
  v_mfma_f32_16x16x32_bf16 v[40:43], a[112:115], a[220:223], v[40:43]
  v_mfma_f32_16x16x32_bf16 v[44:47], a[112:115], a[224:227], v[44:47]
  v_mfma_f32_16x16x32_bf16 v[44:47], a[92:95], a[240:243], v[44:47]
  v_mfma_f32_16x16x32_bf16 v[48:51], a[96:99], a[184:187], v[48:51]
  v_mfma_f32_16x16x32_bf16 v[48:51], a[116:119], a[212:215], v[48:51]
  v_mfma_f32_16x16x32_bf16 v[52:55], a[116:119], a[216:219], v[52:55]
  v_mfma_f32_16x16x32_bf16 v[52:55], a[96:99], a[232:235], v[52:55]
  v_mfma_f32_16x16x32_bf16 v[56:59], a[96:99], a[236:239], v[56:59]
  v_mfma_f32_16x16x32_bf16 v[56:59], a[116:119], a[220:223], v[56:59]
  v_mfma_f32_16x16x32_bf16 v[60:63], a[116:119], a[224:227], v[60:63]
  v_mfma_f32_16x16x32_bf16 v[60:63], a[96:99], a[240:243], v[60:63]
  v_mfma_f32_16x16x32_bf16 v[64:67], a[100:103], a[184:187], v[64:67]
  ds_read_b128 v[216:219], v122 offset:0
  v_mfma_f32_16x16x32_bf16 v[64:67], a[120:123], a[212:215], v[64:67]
  v_mfma_f32_16x16x32_bf16 v[68:71], a[120:123], a[216:219], v[68:71]
  v_mfma_f32_16x16x32_bf16 v[68:71], a[100:103], a[232:235], v[68:71]
  v_mfma_f32_16x16x32_bf16 v[72:75], a[100:103], a[236:239], v[72:75]
  v_mfma_f32_16x16x32_bf16 v[72:75], a[120:123], a[220:223], v[72:75]
  v_mfma_f32_16x16x32_bf16 v[76:79], a[120:123], a[224:227], v[76:79]
  v_mfma_f32_16x16x32_bf16 v[76:79], a[100:103], a[240:243], v[76:79]
  s_waitcnt vmcnt(17)
  v_mfma_f32_16x16x32_bf16 v[0:3], a[124:127], a[244:247], v[0:3]
  ds_read_b128 v[228:231], v122 offset:1024
  buffer_load_dword v128, v133, s[24:27], 0 offen sc1
  s_xor_b32 s38, s40, 0
  s_lshl_b32 s38, s38, 2
  s_add_u32 s38, s38, s3
  v_mfma_f32_16x16x32_bf16 v[0:3], a[176:179], a[228:231], v[0:3]
  s_lshl_b32 s38, s38, 13
  s_add_u32 s38, s38, 25165824
  s_add_u32 s39, s38, 4096
  v_mfma_f32_16x16x32_bf16 v[4:7], a[176:179], a[196:199], v[4:7]
  v_mfma_f32_16x16x32_bf16 v[4:7], a[124:127], a[248:251], v[4:7]
  v_mfma_f32_16x16x32_bf16 v[8:11], a[124:127], a[200:203], v[8:11]
  v_mfma_f32_16x16x32_bf16 v[8:11], a[176:179], a[208:211], v[8:11]
  v_mfma_f32_16x16x32_bf16 v[12:15], a[176:179], v[188:191], v[12:15]
  v_mfma_f32_16x16x32_bf16 v[12:15], a[124:127], v[184:187], v[12:15]
  s_waitcnt lgkmcnt(1)
  v_mfma_f32_16x16x32_bf16 v[16:19], a[160:163], a[244:247], v[16:19]
  ds_read_b128 v[232:235], v122 offset:2048
  v_mfma_f32_16x16x32_bf16 v[16:19], v[216:219], a[228:231], v[16:19]
  v_mfma_f32_16x16x32_bf16 v[20:23], v[216:219], a[196:199], v[20:23]
  v_mfma_f32_16x16x32_bf16 v[20:23], a[160:163], a[248:251], v[20:23]
  v_mfma_f32_16x16x32_bf16 v[24:27], a[160:163], a[200:203], v[24:27]
  v_mfma_f32_16x16x32_bf16 v[24:27], v[216:219], a[208:211], v[24:27]
  v_mfma_f32_16x16x32_bf16 v[28:31], v[216:219], v[188:191], v[28:31]
  v_mfma_f32_16x16x32_bf16 v[28:31], a[160:163], v[184:187], v[28:31]
  s_waitcnt lgkmcnt(1)
  v_mfma_f32_16x16x32_bf16 v[32:35], a[164:167], a[244:247], v[32:35]
  ds_read_b128 a[192:195], v122 offset:3072
  v_mfma_f32_16x16x32_bf16 v[32:35], v[228:231], a[228:231], v[32:35]
  v_mfma_f32_16x16x32_bf16 v[36:39], v[228:231], a[196:199], v[36:39]
  v_mfma_f32_16x16x32_bf16 v[36:39], a[164:167], a[248:251], v[36:39]
  v_mfma_f32_16x16x32_bf16 v[40:43], a[164:167], a[200:203], v[40:43]
  v_mfma_f32_16x16x32_bf16 v[40:43], v[228:231], a[208:211], v[40:43]
  v_mfma_f32_16x16x32_bf16 v[44:47], v[228:231], v[188:191], v[44:47]
  v_mfma_f32_16x16x32_bf16 v[44:47], a[164:167], v[184:187], v[44:47]
  s_waitcnt lgkmcnt(1)
  v_mfma_f32_16x16x32_bf16 v[48:51], a[168:171], a[244:247], v[48:51]
  ds_read_b128 a[4:7], v122 offset:16384
  ds_read_b128 a[24:27], v122 offset:33792
  v_mfma_f32_16x16x32_bf16 v[48:51], v[232:235], a[228:231], v[48:51]
  v_mfma_f32_16x16x32_bf16 v[52:55], v[232:235], a[196:199], v[52:55]
  v_mfma_f32_16x16x32_bf16 v[52:55], a[168:171], a[248:251], v[52:55]
  v_mfma_f32_16x16x32_bf16 v[56:59], a[168:171], a[200:203], v[56:59]
  v_mfma_f32_16x16x32_bf16 v[56:59], v[232:235], a[208:211], v[56:59]
  v_mfma_f32_16x16x32_bf16 v[60:63], v[232:235], v[188:191], v[60:63]
  v_mfma_f32_16x16x32_bf16 v[60:63], a[168:171], v[184:187], v[60:63]
  s_waitcnt lgkmcnt(2)
  v_mfma_f32_16x16x32_bf16 v[64:67], a[172:175], a[244:247], v[64:67]
  ds_read_b128 a[8:11], v122 offset:17408
  ds_read_b128 a[28:31], v122 offset:34816
  v_mfma_f32_16x16x32_bf16 v[64:67], a[192:195], a[228:231], v[64:67]
  v_mfma_f32_16x16x32_bf16 v[68:71], a[192:195], a[196:199], v[68:71]
  v_mfma_f32_16x16x32_bf16 v[68:71], a[172:175], a[248:251], v[68:71]
  v_mfma_f32_16x16x32_bf16 v[72:75], a[172:175], a[200:203], v[72:75]
  v_mfma_f32_16x16x32_bf16 v[72:75], a[192:195], a[208:211], v[72:75]
  v_mfma_f32_16x16x32_bf16 v[76:79], a[192:195], v[188:191], v[76:79]
  v_mfma_f32_16x16x32_bf16 v[76:79], a[172:175], v[184:187], v[76:79]
  s_waitcnt vmcnt(10) lgkmcnt(2)
  v_mfma_f32_16x16x32_bf16 v[0:3], a[4:7], v[200:203], v[0:3]
  ds_read_b128 a[12:15], v122 offset:18432
  ds_read_b128 a[32:35], v122 offset:35840
  v_mfma_f32_16x16x32_bf16 v[0:3], a[24:27], a[188:191], v[0:3]
  v_mfma_f32_16x16x32_bf16 v[4:7], a[24:27], a[144:147], v[4:7]
  v_mfma_f32_16x16x32_bf16 v[4:7], a[4:7], a[252:255], v[4:7]
  v_mfma_f32_16x16x32_bf16 v[8:11], a[4:7], a[128:131], v[8:11]
  v_mfma_f32_16x16x32_bf16 v[8:11], a[24:27], a[148:151], v[8:11]
  v_mfma_f32_16x16x32_bf16 v[12:15], a[24:27], a[152:155], v[12:15]
  v_mfma_f32_16x16x32_bf16 v[12:15], a[4:7], a[132:135], v[12:15]
  s_waitcnt lgkmcnt(2)
  v_mfma_f32_16x16x32_bf16 v[16:19], a[8:11], v[200:203], v[16:19]
  ds_read_b128 a[16:19], v122 offset:19456
  ds_read_b128 a[36:39], v135 offset:0
  v_mfma_f32_16x16x32_bf16 v[16:19], a[28:31], a[188:191], v[16:19]
  v_mfma_f32_16x16x32_bf16 v[20:23], a[28:31], a[144:147], v[20:23]
  v_mfma_f32_16x16x32_bf16 v[20:23], a[8:11], a[252:255], v[20:23]
  v_mfma_f32_16x16x32_bf16 v[24:27], a[8:11], a[128:131], v[24:27]
  v_mfma_f32_16x16x32_bf16 v[24:27], a[28:31], a[148:151], v[24:27]
  v_mfma_f32_16x16x32_bf16 v[28:31], a[28:31], a[152:155], v[28:31]
  v_mfma_f32_16x16x32_bf16 v[28:31], a[8:11], a[132:135], v[28:31]
  s_waitcnt lgkmcnt(2)
  v_mfma_f32_16x16x32_bf16 v[32:35], a[12:15], v[200:203], v[32:35]
  ds_read_b128 a[20:23], v122 offset:32768
  ds_read_b128 a[40:43], v135 offset:1024
  v_mfma_f32_16x16x32_bf16 v[32:35], a[32:35], a[188:191], v[32:35]
  v_mfma_f32_16x16x32_bf16 v[36:39], a[32:35], a[144:147], v[36:39]
  v_mfma_f32_16x16x32_bf16 v[36:39], a[12:15], a[252:255], v[36:39]
  v_mfma_f32_16x16x32_bf16 v[40:43], a[12:15], a[128:131], v[40:43]
  v_mfma_f32_16x16x32_bf16 v[40:43], a[32:35], a[148:151], v[40:43]
  v_mfma_f32_16x16x32_bf16 v[44:47], a[32:35], a[152:155], v[44:47]
  v_mfma_f32_16x16x32_bf16 v[44:47], a[12:15], a[132:135], v[44:47]
  s_waitcnt lgkmcnt(2)
  v_mfma_f32_16x16x32_bf16 v[48:51], a[16:19], v[200:203], v[48:51]
  ds_read_b128 a[204:207], v135 offset:2048
  ds_read_b128 v[248:251], v135 offset:19456
  v_mfma_f32_16x16x32_bf16 v[48:51], a[36:39], a[188:191], v[48:51]
  v_mfma_f32_16x16x32_bf16 v[52:55], a[36:39], a[144:147], v[52:55]
  v_mfma_f32_16x16x32_bf16 v[52:55], a[16:19], a[252:255], v[52:55]
  v_mfma_f32_16x16x32_bf16 v[56:59], a[16:19], a[128:131], v[56:59]
  v_mfma_f32_16x16x32_bf16 v[56:59], a[36:39], a[148:151], v[56:59]
  v_mfma_f32_16x16x32_bf16 v[60:63], a[36:39], a[152:155], v[60:63]
  v_mfma_f32_16x16x32_bf16 v[60:63], a[16:19], a[132:135], v[60:63]
  s_waitcnt lgkmcnt(2)
  v_mfma_f32_16x16x32_bf16 v[64:67], a[20:23], v[200:203], v[64:67]
  ds_read_b128 v[176:179], v135 offset:3072
  ds_read_b128 v[180:183], v122 offset:49152
  v_mfma_f32_16x16x32_bf16 v[64:67], a[40:43], a[188:191], v[64:67]
  v_mfma_f32_16x16x32_bf16 v[68:71], a[40:43], a[144:147], v[68:71]
  v_mfma_f32_16x16x32_bf16 v[68:71], a[20:23], a[252:255], v[68:71]
  v_mfma_f32_16x16x32_bf16 v[72:75], a[20:23], a[128:131], v[72:75]
  v_mfma_f32_16x16x32_bf16 v[72:75], a[40:43], a[148:151], v[72:75]
  v_mfma_f32_16x16x32_bf16 v[76:79], a[40:43], a[152:155], v[76:79]
  v_mfma_f32_16x16x32_bf16 v[76:79], a[20:23], a[132:135], v[76:79]
  s_waitcnt vmcnt(0)
  v_cmp_lt_u32 vcc, v128, v134
  s_nop 0
  s_cbranch_vccz tail_partner
  s_mov_b32 s35, 32768
tail_spin2:
  s_sleep 2
  buffer_load_dword v128, v133, s[24:27], 0 offen sc1
  s_waitcnt vmcnt(0)
  v_cmp_lt_u32 vcc, v128, v134
  s_nop 0
  s_cbranch_vccz tail_partner
  s_sub_u32 s35, s35, 1
  s_cmp_lg_u32 s35, 0
  s_cbranch_scc1 tail_spin2
tail_partner:
  s_waitcnt lgkmcnt(2)
  v_mfma_f32_16x16x32_bf16 v[0:3], a[204:207], a[136:139], v[0:3]
  ds_read_b128 v[204:207], v135 offset:16384
  ds_read_b128 v[208:211], v122 offset:50176
  v_mfma_f32_16x16x32_bf16 v[0:3], v[248:251], a[156:159], v[0:3]
  buffer_load_dwordx2 v[138:139], v125, s[24:27], s38 offen offset:0 sc1
  v_mfma_f32_16x16x32_bf16 v[4:7], v[248:251], a[0:3], v[4:7]
  buffer_load_dwordx2 v[142:143], v125, s[24:27], s38 offen offset:512 sc1
  v_mfma_f32_16x16x32_bf16 v[4:7], a[204:207], a[140:143], v[4:7]
  buffer_load_dwordx2 v[146:147], v125, s[24:27], s38 offen offset:1024 sc1
  v_mfma_f32_16x16x32_bf16 v[8:11], a[204:207], v[236:239], v[8:11]
  buffer_load_dwordx2 v[150:151], v125, s[24:27], s38 offen offset:1536 sc1
  v_mfma_f32_16x16x32_bf16 v[8:11], v[248:251], v[192:195], v[8:11]
  buffer_load_dwordx2 v[154:155], v125, s[24:27], s38 offen offset:2048 sc1
  v_mfma_f32_16x16x32_bf16 v[12:15], v[248:251], v[212:215], v[12:15]
  v_mfma_f32_16x16x32_bf16 v[12:15], a[204:207], v[196:199], v[12:15]
  s_waitcnt lgkmcnt(2)
  v_mfma_f32_16x16x32_bf16 v[16:19], v[176:179], a[136:139], v[16:19]
  ds_read_b128 v[220:223], v135 offset:17408
  ds_read_b128 a[44:47], v122 offset:51200
  v_mfma_f32_16x16x32_bf16 v[16:19], v[180:183], a[156:159], v[16:19]
  ds_write_b128 v122, v[4:7] offset:0
  ds_write_b128 v122, v[8:11] offset:17408
  v_mfma_f32_16x16x32_bf16 v[20:23], v[180:183], a[0:3], v[20:23]
  ds_write_b128 v122, v[12:15] offset:34816
  v_mfma_f32_16x16x32_bf16 v[20:23], v[176:179], a[140:143], v[20:23]
  v_mfma_f32_16x16x32_bf16 v[24:27], v[176:179], v[236:239], v[24:27]
  v_mfma_f32_16x16x32_bf16 v[24:27], v[180:183], v[192:195], v[24:27]
  v_mfma_f32_16x16x32_bf16 v[28:31], v[180:183], v[212:215], v[28:31]
  v_mfma_f32_16x16x32_bf16 v[28:31], v[176:179], v[196:199], v[28:31]
  s_waitcnt lgkmcnt(5)
  v_mfma_f32_16x16x32_bf16 v[32:35], v[204:207], a[136:139], v[32:35]
  ds_read_b128 a[64:67], v135 offset:18432
  ds_read_b128 a[48:51], v122 offset:52224
  v_mfma_f32_16x16x32_bf16 v[32:35], v[208:211], a[156:159], v[32:35]
  ds_write_b128 v122, v[20:23] offset:1024
  ds_write_b128 v122, v[24:27] offset:18432
  v_mfma_f32_16x16x32_bf16 v[36:39], v[208:211], a[0:3], v[36:39]
  ds_write_b128 v122, v[28:31] offset:35840
  v_mfma_f32_16x16x32_bf16 v[36:39], v[204:207], a[140:143], v[36:39]
  v_mfma_f32_16x16x32_bf16 v[40:43], v[204:207], v[236:239], v[40:43]
  v_mfma_f32_16x16x32_bf16 v[40:43], v[208:211], v[192:195], v[40:43]
  v_mfma_f32_16x16x32_bf16 v[44:47], v[208:211], v[212:215], v[44:47]
  v_mfma_f32_16x16x32_bf16 v[44:47], v[204:207], v[196:199], v[44:47]
  s_waitcnt lgkmcnt(8)
  v_mfma_f32_16x16x32_bf16 v[48:51], v[220:223], a[136:139], v[48:51]
  v_mfma_f32_16x16x32_bf16 v[48:51], a[44:47], a[156:159], v[48:51]
  v_mfma_f32_16x16x32_bf16 v[52:55], a[44:47], a[0:3], v[52:55]
  ds_write_b128 v122, v[36:39] offset:2048
  v_mfma_f32_16x16x32_bf16 v[52:55], v[220:223], a[140:143], v[52:55]
  ds_write_b128 v122, v[40:43] offset:19456
  v_mfma_f32_16x16x32_bf16 v[56:59], v[220:223], v[236:239], v[56:59]
  ds_write_b128 v122, v[44:47] offset:49152
  v_mfma_f32_16x16x32_bf16 v[56:59], a[44:47], v[192:195], v[56:59]
  v_mfma_f32_16x16x32_bf16 v[60:63], a[44:47], v[212:215], v[60:63]
  v_mfma_f32_16x16x32_bf16 v[60:63], v[220:223], v[196:199], v[60:63]
  s_waitcnt lgkmcnt(6)
  v_mfma_f32_16x16x32_bf16 v[64:67], a[64:67], a[136:139], v[64:67]
  ds_write_b128 v122, v[52:55] offset:3072
  v_mfma_f32_16x16x32_bf16 v[64:67], a[48:51], a[156:159], v[64:67]
  v_mfma_f32_16x16x32_bf16 v[68:71], a[48:51], a[0:3], v[68:71]
  v_mfma_f32_16x16x32_bf16 v[68:71], a[64:67], a[140:143], v[68:71]
  ds_write_b128 v122, v[56:59] offset:32768
  v_mfma_f32_16x16x32_bf16 v[72:75], a[64:67], v[236:239], v[72:75]
  ds_write_b128 v122, v[60:63] offset:50176
  v_mfma_f32_16x16x32_bf16 v[72:75], a[48:51], v[192:195], v[72:75]
  v_mfma_f32_16x16x32_bf16 v[76:79], a[48:51], v[212:215], v[76:79]
  v_mfma_f32_16x16x32_bf16 v[76:79], a[64:67], v[196:199], v[76:79]
  s_nop 1
  ds_write_b128 v122, v[68:71] offset:16384
  s_nop 2
  ds_write_b128 v122, v[72:75] offset:33792
  s_nop 0
  ds_write_b128 v122, v[76:79] offset:51200
  s_waitcnt lgkmcnt(0)
  s_barrier
  ds_read_b128 v[4:7], v80 offset:0
  ds_read_b128 v[8:11], v81 offset:17408
  ds_read_b128 v[12:15], v82 offset:34816
  ds_read_b128 v[20:23], v80 offset:1024
  ds_read_b128 v[24:27], v81 offset:18432
  ds_read_b128 v[28:31], v82 offset:35840
  ds_read_b128 v[36:39], v80 offset:2048
  ds_read_b128 v[40:43], v81 offset:19456
  ds_read_b128 v[44:47], v82 offset:49152
  ds_read_b128 v[52:55], v80 offset:3072
  ds_read_b128 v[56:59], v81 offset:32768
  ds_read_b128 v[60:63], v82 offset:50176
  ds_read_b128 v[68:71], v80 offset:16384
  ds_read_b128 v[72:75], v81 offset:33792
  ds_read_b128 v[76:79], v82 offset:51200
  s_waitcnt vmcnt(4)
  v_lshlrev_b32 v136, 16, v138
  v_and_b32 v137, s34, v138
  v_lshlrev_b32 v138, 16, v139
  v_and_b32 v139, s34, v139
  v_pk_add_f32 v[0:1], v[0:1], v[136:137]
  v_pk_add_f32 v[2:3], v[2:3], v[138:139]
  s_waitcnt lgkmcnt(13)
  v_pk_add_f32 v[4:5], v[4:5], v[8:9]
  v_pk_add_f32 v[6:7], v[6:7], v[10:11]
  s_waitcnt lgkmcnt(12)
  v_pk_add_f32 v[0:1], v[0:1], v[12:13]
  v_pk_add_f32 v[2:3], v[2:3], v[14:15]
  v_pk_add_f32 v[0:1], v[0:1], v[4:5]
  v_pk_add_f32 v[2:3], v[2:3], v[6:7]
  v_cvt_pk_bf16_f32 v4, v0, v1
  v_cvt_pk_bf16_f32 v5, v2, v3
  v_lshlrev_b32 v0, 16, v4
  v_and_b32 v1, s34, v4
  v_lshlrev_b32 v2, 16, v5
  v_and_b32 v3, s34, v5
  v_pk_mul_f32 v[0:1], v[0:1], v[90:91]
  v_pk_mul_f32 v[2:3], v[2:3], v[92:93]
  v_cvt_pk_bf16_f32 v4, v0, v1
  v_cvt_pk_bf16_f32 v5, v2, v3
  v_lshlrev_b32 v0, 16, v4
  v_and_b32 v1, s34, v4
  v_lshlrev_b32 v2, 16, v5
  v_and_b32 v3, s34, v5
  v_pk_add_f32 v[0:1], v[0:1], v[156:157]
  v_pk_add_f32 v[2:3], v[2:3], v[158:159]
  v_cvt_pk_bf16_f32 v4, v0, v1
  v_cvt_pk_bf16_f32 v5, v2, v3
  s_waitcnt vmcnt(3)
  v_lshlrev_b32 v140, 16, v142
  v_and_b32 v141, s34, v142
  v_lshlrev_b32 v142, 16, v143
  v_and_b32 v143, s34, v143
  v_pk_add_f32 v[16:17], v[16:17], v[140:141]
  v_pk_add_f32 v[18:19], v[18:19], v[142:143]
  s_waitcnt lgkmcnt(10)
  v_pk_add_f32 v[20:21], v[20:21], v[24:25]
  v_pk_add_f32 v[22:23], v[22:23], v[26:27]
  s_waitcnt lgkmcnt(9)
  v_pk_add_f32 v[16:17], v[16:17], v[28:29]
  v_pk_add_f32 v[18:19], v[18:19], v[30:31]
  v_pk_add_f32 v[16:17], v[16:17], v[20:21]
  v_pk_add_f32 v[18:19], v[18:19], v[22:23]
  v_cvt_pk_bf16_f32 v20, v16, v17
  v_cvt_pk_bf16_f32 v21, v18, v19
  v_lshlrev_b32 v16, 16, v20
  v_and_b32 v17, s34, v20
  v_lshlrev_b32 v18, 16, v21
  v_and_b32 v19, s34, v21
  v_pk_mul_f32 v[16:17], v[16:17], v[94:95]
  v_pk_mul_f32 v[18:19], v[18:19], v[96:97]
  v_cvt_pk_bf16_f32 v20, v16, v17
  v_cvt_pk_bf16_f32 v21, v18, v19
  v_lshlrev_b32 v16, 16, v20
  v_and_b32 v17, s34, v20
  v_lshlrev_b32 v18, 16, v21
  v_and_b32 v19, s34, v21
  v_pk_add_f32 v[16:17], v[16:17], v[160:161]
  v_pk_add_f32 v[18:19], v[18:19], v[162:163]
  v_cvt_pk_bf16_f32 v6, v16, v17
  v_cvt_pk_bf16_f32 v7, v18, v19
  s_nop 0
  v_permlane16_swap_b32 v4, v6
  v_permlane16_swap_b32 v5, v7
  buffer_store_dwordx4 v[4:7], v83, s[16:19], 0 offen offset:0
  s_waitcnt vmcnt(3)
  v_lshlrev_b32 v144, 16, v146
  v_and_b32 v145, s34, v146
  v_lshlrev_b32 v146, 16, v147
  v_and_b32 v147, s34, v147
  v_pk_add_f32 v[32:33], v[32:33], v[144:145]
  v_pk_add_f32 v[34:35], v[34:35], v[146:147]
  s_waitcnt lgkmcnt(7)
  v_pk_add_f32 v[36:37], v[36:37], v[40:41]
  v_pk_add_f32 v[38:39], v[38:39], v[42:43]
  s_waitcnt lgkmcnt(6)
  v_pk_add_f32 v[32:33], v[32:33], v[44:45]
  v_pk_add_f32 v[34:35], v[34:35], v[46:47]
  v_pk_add_f32 v[32:33], v[32:33], v[36:37]
  v_pk_add_f32 v[34:35], v[34:35], v[38:39]
  v_cvt_pk_bf16_f32 v36, v32, v33
  v_cvt_pk_bf16_f32 v37, v34, v35
  v_lshlrev_b32 v32, 16, v36
  v_and_b32 v33, s34, v36
  v_lshlrev_b32 v34, 16, v37
  v_and_b32 v35, s34, v37
  v_pk_mul_f32 v[32:33], v[32:33], v[98:99]
  v_pk_mul_f32 v[34:35], v[34:35], v[100:101]
  v_cvt_pk_bf16_f32 v36, v32, v33
  v_cvt_pk_bf16_f32 v37, v34, v35
  v_lshlrev_b32 v32, 16, v36
  v_and_b32 v33, s34, v36
  v_lshlrev_b32 v34, 16, v37
  v_and_b32 v35, s34, v37
  v_pk_add_f32 v[32:33], v[32:33], v[164:165]
  v_pk_add_f32 v[34:35], v[34:35], v[166:167]
  v_cvt_pk_bf16_f32 v36, v32, v33
  v_cvt_pk_bf16_f32 v37, v34, v35
  s_waitcnt vmcnt(2)
  v_lshlrev_b32 v148, 16, v150
  v_and_b32 v149, s34, v150
  v_lshlrev_b32 v150, 16, v151
  v_and_b32 v151, s34, v151
  v_pk_add_f32 v[48:49], v[48:49], v[148:149]
  v_pk_add_f32 v[50:51], v[50:51], v[150:151]
  s_waitcnt lgkmcnt(4)
  v_pk_add_f32 v[52:53], v[52:53], v[56:57]
  v_pk_add_f32 v[54:55], v[54:55], v[58:59]
  s_waitcnt lgkmcnt(3)
  v_pk_add_f32 v[48:49], v[48:49], v[60:61]
  v_pk_add_f32 v[50:51], v[50:51], v[62:63]
  v_pk_add_f32 v[48:49], v[48:49], v[52:53]
  v_pk_add_f32 v[50:51], v[50:51], v[54:55]
  v_cvt_pk_bf16_f32 v52, v48, v49
  v_cvt_pk_bf16_f32 v53, v50, v51
  v_lshlrev_b32 v48, 16, v52
  v_and_b32 v49, s34, v52
  v_lshlrev_b32 v50, 16, v53
  v_and_b32 v51, s34, v53
  v_pk_mul_f32 v[48:49], v[48:49], v[102:103]
  v_pk_mul_f32 v[50:51], v[50:51], v[104:105]
  v_cvt_pk_bf16_f32 v52, v48, v49
  v_cvt_pk_bf16_f32 v53, v50, v51
  v_lshlrev_b32 v48, 16, v52
  v_and_b32 v49, s34, v52
  v_lshlrev_b32 v50, 16, v53
  v_and_b32 v51, s34, v53
  v_pk_add_f32 v[48:49], v[48:49], v[168:169]
  v_pk_add_f32 v[50:51], v[50:51], v[170:171]
  v_cvt_pk_bf16_f32 v38, v48, v49
  v_cvt_pk_bf16_f32 v39, v50, v51
  s_nop 0
  v_permlane16_swap_b32 v36, v38
  v_permlane16_swap_b32 v37, v39
  buffer_store_dwordx4 v[36:39], v83, s[16:19], 0 offen offset:64
  s_waitcnt vmcnt(2)
  v_lshlrev_b32 v152, 16, v154
  v_and_b32 v153, s34, v154
  v_lshlrev_b32 v154, 16, v155
  v_and_b32 v155, s34, v155
  v_pk_add_f32 v[64:65], v[64:65], v[152:153]
  v_pk_add_f32 v[66:67], v[66:67], v[154:155]
  s_waitcnt lgkmcnt(1)
  v_pk_add_f32 v[68:69], v[68:69], v[72:73]
  v_pk_add_f32 v[70:71], v[70:71], v[74:75]
  s_waitcnt lgkmcnt(0)
  v_pk_add_f32 v[64:65], v[64:65], v[76:77]
  v_pk_add_f32 v[66:67], v[66:67], v[78:79]
  v_pk_add_f32 v[64:65], v[64:65], v[68:69]
  v_pk_add_f32 v[66:67], v[66:67], v[70:71]
  v_cvt_pk_bf16_f32 v68, v64, v65
  v_cvt_pk_bf16_f32 v69, v66, v67
  v_lshlrev_b32 v64, 16, v68
  v_and_b32 v65, s34, v68
  v_lshlrev_b32 v66, 16, v69
  v_and_b32 v67, s34, v69
  v_pk_mul_f32 v[64:65], v[64:65], v[106:107]
  v_pk_mul_f32 v[66:67], v[66:67], v[108:109]
  v_cvt_pk_bf16_f32 v68, v64, v65
  v_cvt_pk_bf16_f32 v69, v66, v67
  v_lshlrev_b32 v64, 16, v68
  v_and_b32 v65, s34, v68
  v_lshlrev_b32 v66, 16, v69
  v_and_b32 v67, s34, v69
  v_pk_add_f32 v[64:65], v[64:65], v[172:173]
  v_pk_add_f32 v[66:67], v[66:67], v[174:175]
  v_cvt_pk_bf16_f32 v68, v64, v65
  v_cvt_pk_bf16_f32 v69, v66, v67
  buffer_store_dwordx2 v[68:69], v117, s[16:19], 0 offen offset:128
attn_end:
  s_endpgm
attn_redo:
  s_waitcnt vmcnt(0)
  v_accvgpr_write_b32 a0, 0
  v_accvgpr_write_b32 a1, 0
  v_accvgpr_write_b32 a2, 0
  v_accvgpr_write_b32 a3, 0
  v_accvgpr_write_b32 a4, 0
  v_accvgpr_write_b32 a5, 0
  v_accvgpr_write_b32 a6, 0
  v_accvgpr_write_b32 a7, 0
  v_accvgpr_write_b32 a8, 0
  v_accvgpr_write_b32 a9, 0
  v_accvgpr_write_b32 a10, 0
  v_accvgpr_write_b32 a11, 0
  v_accvgpr_write_b32 a12, 0
  v_accvgpr_write_b32 a13, 0
  v_accvgpr_write_b32 a14, 0
  v_accvgpr_write_b32 a15, 0
  v_accvgpr_write_b32 a16, 0
  v_accvgpr_write_b32 a17, 0
  v_accvgpr_write_b32 a18, 0
  v_accvgpr_write_b32 a19, 0
  v_accvgpr_write_b32 a20, 0
  v_accvgpr_write_b32 a21, 0
  v_accvgpr_write_b32 a22, 0
  v_accvgpr_write_b32 a23, 0
  v_accvgpr_write_b32 a24, 0
  v_accvgpr_write_b32 a25, 0
  v_accvgpr_write_b32 a26, 0
  v_accvgpr_write_b32 a27, 0
  v_accvgpr_write_b32 a28, 0
  v_accvgpr_write_b32 a29, 0
  v_accvgpr_write_b32 a30, 0
  v_accvgpr_write_b32 a31, 0
  v_accvgpr_write_b32 a32, 0
  v_accvgpr_write_b32 a33, 0
  v_accvgpr_write_b32 a34, 0
  v_accvgpr_write_b32 a35, 0
  v_accvgpr_write_b32 a36, 0
  v_accvgpr_write_b32 a37, 0
  v_accvgpr_write_b32 a38, 0
  v_accvgpr_write_b32 a39, 0
  v_accvgpr_write_b32 a40, 0
  v_accvgpr_write_b32 a41, 0
  v_accvgpr_write_b32 a42, 0
  v_accvgpr_write_b32 a43, 0
  v_accvgpr_write_b32 a44, 0
  v_accvgpr_write_b32 a45, 0
  v_accvgpr_write_b32 a46, 0
  v_accvgpr_write_b32 a47, 0
  v_accvgpr_write_b32 a48, 0
  v_accvgpr_write_b32 a49, 0
  v_accvgpr_write_b32 a50, 0
  v_accvgpr_write_b32 a51, 0
  v_accvgpr_write_b32 a52, 0
  v_accvgpr_write_b32 a53, 0
  v_accvgpr_write_b32 a54, 0
  v_accvgpr_write_b32 a55, 0
  v_accvgpr_write_b32 a56, 0
  v_accvgpr_write_b32 a57, 0
  v_accvgpr_write_b32 a58, 0
  v_accvgpr_write_b32 a59, 0
  v_accvgpr_write_b32 a60, 0
  v_accvgpr_write_b32 a61, 0
  v_accvgpr_write_b32 a62, 0
  v_accvgpr_write_b32 a63, 0
  v_accvgpr_write_b32 a64, 0
  v_accvgpr_write_b32 a65, 0
  v_accvgpr_write_b32 a66, 0
  v_accvgpr_write_b32 a67, 0
  v_accvgpr_write_b32 a68, 0
  v_accvgpr_write_b32 a69, 0
  v_accvgpr_write_b32 a70, 0
  v_accvgpr_write_b32 a71, 0
  v_accvgpr_write_b32 a72, 0
  v_accvgpr_write_b32 a73, 0
  v_accvgpr_write_b32 a74, 0
  v_accvgpr_write_b32 a75, 0
  v_accvgpr_write_b32 a76, 0
  v_accvgpr_write_b32 a77, 0
  v_accvgpr_write_b32 a78, 0
  v_accvgpr_write_b32 a79, 0
  v_accvgpr_write_b32 a80, 0
  v_accvgpr_write_b32 a81, 0
  v_accvgpr_write_b32 a82, 0
  v_accvgpr_write_b32 a83, 0
  v_accvgpr_write_b32 a84, 0
  v_accvgpr_write_b32 a85, 0
  v_accvgpr_write_b32 a86, 0
  v_accvgpr_write_b32 a87, 0
  v_accvgpr_write_b32 a88, 0
  v_accvgpr_write_b32 a89, 0
  v_accvgpr_write_b32 a90, 0
  v_accvgpr_write_b32 a91, 0
  v_accvgpr_write_b32 a92, 0
  v_accvgpr_write_b32 a93, 0
  v_accvgpr_write_b32 a94, 0
  v_accvgpr_write_b32 a95, 0
  v_accvgpr_write_b32 a96, 0
  v_accvgpr_write_b32 a97, 0
  v_accvgpr_write_b32 a98, 0
  v_accvgpr_write_b32 a99, 0
  v_accvgpr_write_b32 a100, 0
  v_accvgpr_write_b32 a101, 0
  v_accvgpr_write_b32 a102, 0
  v_accvgpr_write_b32 a103, 0
  v_accvgpr_write_b32 a104, 0
  v_accvgpr_write_b32 a105, 0
  v_accvgpr_write_b32 a106, 0
  v_accvgpr_write_b32 a107, 0
  v_accvgpr_write_b32 a108, 0
  v_accvgpr_write_b32 a109, 0
  v_accvgpr_write_b32 a110, 0
  v_accvgpr_write_b32 a111, 0
  v_accvgpr_write_b32 a112, 0
  v_accvgpr_write_b32 a113, 0
  v_accvgpr_write_b32 a114, 0
  v_accvgpr_write_b32 a115, 0
  v_accvgpr_write_b32 a116, 0
  v_accvgpr_write_b32 a117, 0
  v_accvgpr_write_b32 a118, 0
  v_accvgpr_write_b32 a119, 0
  v_accvgpr_write_b32 a120, 0
  v_accvgpr_write_b32 a121, 0
  v_accvgpr_write_b32 a122, 0
  v_accvgpr_write_b32 a123, 0
  v_accvgpr_write_b32 a124, 0
  v_accvgpr_write_b32 a125, 0
  v_accvgpr_write_b32 a126, 0
  v_accvgpr_write_b32 a127, 0
  v_mov_b32 v208, 0
  v_mov_b32 v249, 0xff800000
  v_mov_b32 v209, 0
  v_mov_b32 v250, 0xff800000
  v_mov_b32 v210, 0
  v_mov_b32 v251, 0xff800000
  v_mov_b32 v211, 0
  v_mov_b32 v252, 0xff800000
  s_mov_b32 s29, 0
attn_slow:
  s_barrier
  s_add_u32 m0, s28, 49152
  s_nop 0
  buffer_load_dwordx4 v232, s[12:15], s29 offen offset:0 lds
  buffer_load_dwordx4 v233, s[12:15], s29 offen offset:1024 lds
  buffer_load_dwordx4 v234, s[12:15], s29 offen offset:2048 lds
  buffer_load_dwordx4 v235, s[12:15], s29 offen offset:3072 lds
  s_add_u32 m0, s28, 114688
  s_nop 0
  buffer_load_dwordx4 v236, s[16:19], s29 offen offset:0 lds
  buffer_load_dwordx4 v237, s[16:19], s29 offen offset:1024 lds
  buffer_load_dwordx4 v236, s[16:19], s29 offen offset:2048 lds
  buffer_load_dwordx4 v237, s[16:19], s29 offen offset:3072 lds
  s_waitcnt vmcnt(0)
  s_barrier
  ds_read_b128 a[128:131], v212 offset:49152
  ds_read_b128 a[132:135], v213 offset:49152
  ds_read_b128 a[136:139], v214 offset:49152
  ds_read_b128 a[140:143], v215 offset:49152
  s_waitcnt lgkmcnt(3)
  v_mfma_f32_16x16x32_bf16 v[0:3], a[128:131], v[128:131], 0
  s_waitcnt lgkmcnt(2)
  v_mfma_f32_16x16x32_bf16 v[0:3], a[132:135], v[132:135], v[0:3]
  s_waitcnt lgkmcnt(1)
  v_mfma_f32_16x16x32_bf16 v[0:3], a[136:139], v[136:139], v[0:3]
  s_waitcnt lgkmcnt(0)
  v_mfma_f32_16x16x32_bf16 v[0:3], a[140:143], v[140:143], v[0:3]
  v_mfma_f32_16x16x32_bf16 v[8:11], a[140:143], v[156:159], 0
  v_mfma_f32_16x16x32_bf16 v[8:11], a[136:139], v[152:155], v[8:11]
  v_mfma_f32_16x16x32_bf16 v[8:11], a[132:135], v[148:151], v[8:11]
  v_mfma_f32_16x16x32_bf16 v[8:11], a[128:131], v[144:147], v[8:11]
  v_mfma_f32_16x16x32_bf16 v[16:19], a[128:131], v[160:163], 0
  v_mfma_f32_16x16x32_bf16 v[16:19], a[132:135], v[164:167], v[16:19]
  v_mfma_f32_16x16x32_bf16 v[16:19], a[136:139], v[168:171], v[16:19]
  v_mfma_f32_16x16x32_bf16 v[16:19], a[140:143], v[172:175], v[16:19]
  v_mfma_f32_16x16x32_bf16 v[24:27], a[140:143], v[188:191], 0
  v_mfma_f32_16x16x32_bf16 v[24:27], a[136:139], v[184:187], v[24:27]
  v_mfma_f32_16x16x32_bf16 v[24:27], a[132:135], v[180:183], v[24:27]
  v_mfma_f32_16x16x32_bf16 v[24:27], a[128:131], v[176:179], v[24:27]
  ds_read_b128 a[144:147], v212 offset:53248
  ds_read_b128 a[148:151], v213 offset:53248
  ds_read_b128 a[152:155], v214 offset:53248
  ds_read_b128 a[156:159], v215 offset:53248
  s_waitcnt lgkmcnt(3)
  v_mfma_f32_16x16x32_bf16 v[4:7], a[144:147], v[128:131], 0
  s_waitcnt lgkmcnt(2)
  v_mfma_f32_16x16x32_bf16 v[4:7], a[148:151], v[132:135], v[4:7]
  s_waitcnt lgkmcnt(1)
  v_mfma_f32_16x16x32_bf16 v[4:7], a[152:155], v[136:139], v[4:7]
  s_waitcnt lgkmcnt(0)
  v_mfma_f32_16x16x32_bf16 v[4:7], a[156:159], v[140:143], v[4:7]
  v_mfma_f32_16x16x32_bf16 v[12:15], a[156:159], v[156:159], 0
  v_mfma_f32_16x16x32_bf16 v[12:15], a[152:155], v[152:155], v[12:15]
  v_mfma_f32_16x16x32_bf16 v[12:15], a[148:151], v[148:151], v[12:15]
  v_mfma_f32_16x16x32_bf16 v[12:15], a[144:147], v[144:147], v[12:15]
  v_mfma_f32_16x16x32_bf16 v[20:23], a[144:147], v[160:163], 0
  v_mfma_f32_16x16x32_bf16 v[20:23], a[148:151], v[164:167], v[20:23]
  v_mfma_f32_16x16x32_bf16 v[20:23], a[152:155], v[168:171], v[20:23]
  v_mfma_f32_16x16x32_bf16 v[20:23], a[156:159], v[172:175], v[20:23]
  v_mfma_f32_16x16x32_bf16 v[28:31], a[156:159], v[188:191], 0
  v_mfma_f32_16x16x32_bf16 v[28:31], a[152:155], v[184:187], v[28:31]
  v_mfma_f32_16x16x32_bf16 v[28:31], a[148:151], v[180:183], v[28:31]
  v_mfma_f32_16x16x32_bf16 v[28:31], a[144:147], v[176:179], v[28:31]
  ds_read_b128 a[128:131], v212 offset:57344
  ds_read_b128 a[132:135], v213 offset:57344
  ds_read_b128 a[136:139], v214 offset:57344
  ds_read_b128 a[140:143], v215 offset:57344
  s_waitcnt lgkmcnt(3)
  v_mfma_f32_16x16x32_bf16 v[32:35], a[128:131], v[128:131], 0
  s_waitcnt lgkmcnt(2)
  v_mfma_f32_16x16x32_bf16 v[32:35], a[132:135], v[132:135], v[32:35]
  s_waitcnt lgkmcnt(1)
  v_mfma_f32_16x16x32_bf16 v[32:35], a[136:139], v[136:139], v[32:35]
  s_waitcnt lgkmcnt(0)
  v_mfma_f32_16x16x32_bf16 v[32:35], a[140:143], v[140:143], v[32:35]
  v_mfma_f32_16x16x32_bf16 v[40:43], a[140:143], v[156:159], 0
  v_mfma_f32_16x16x32_bf16 v[40:43], a[136:139], v[152:155], v[40:43]
  v_mfma_f32_16x16x32_bf16 v[40:43], a[132:135], v[148:151], v[40:43]
  v_mfma_f32_16x16x32_bf16 v[40:43], a[128:131], v[144:147], v[40:43]
  v_mfma_f32_16x16x32_bf16 v[48:51], a[128:131], v[160:163], 0
  v_mfma_f32_16x16x32_bf16 v[48:51], a[132:135], v[164:167], v[48:51]
  v_mfma_f32_16x16x32_bf16 v[48:51], a[136:139], v[168:171], v[48:51]
  v_mfma_f32_16x16x32_bf16 v[48:51], a[140:143], v[172:175], v[48:51]
  v_mfma_f32_16x16x32_bf16 v[56:59], a[140:143], v[188:191], 0
  v_mfma_f32_16x16x32_bf16 v[56:59], a[136:139], v[184:187], v[56:59]
  v_mfma_f32_16x16x32_bf16 v[56:59], a[132:135], v[180:183], v[56:59]
  v_mfma_f32_16x16x32_bf16 v[56:59], a[128:131], v[176:179], v[56:59]
  ds_read_b128 a[144:147], v212 offset:61440
  ds_read_b128 a[148:151], v213 offset:61440
  ds_read_b128 a[152:155], v214 offset:61440
  ds_read_b128 a[156:159], v215 offset:61440
  s_waitcnt lgkmcnt(3)
  v_mfma_f32_16x16x32_bf16 v[36:39], a[144:147], v[128:131], 0
  s_waitcnt lgkmcnt(2)
  v_mfma_f32_16x16x32_bf16 v[36:39], a[148:151], v[132:135], v[36:39]
  s_waitcnt lgkmcnt(1)
  v_mfma_f32_16x16x32_bf16 v[36:39], a[152:155], v[136:139], v[36:39]
  s_waitcnt lgkmcnt(0)
  v_mfma_f32_16x16x32_bf16 v[36:39], a[156:159], v[140:143], v[36:39]
  v_mfma_f32_16x16x32_bf16 v[44:47], a[156:159], v[156:159], 0
  v_mfma_f32_16x16x32_bf16 v[44:47], a[152:155], v[152:155], v[44:47]
  v_mfma_f32_16x16x32_bf16 v[44:47], a[148:151], v[148:151], v[44:47]
  v_mfma_f32_16x16x32_bf16 v[44:47], a[144:147], v[144:147], v[44:47]
  v_mfma_f32_16x16x32_bf16 v[52:55], a[144:147], v[160:163], 0
  v_mfma_f32_16x16x32_bf16 v[52:55], a[148:151], v[164:167], v[52:55]
  v_mfma_f32_16x16x32_bf16 v[52:55], a[152:155], v[168:171], v[52:55]
  v_mfma_f32_16x16x32_bf16 v[52:55], a[156:159], v[172:175], v[52:55]
  v_mfma_f32_16x16x32_bf16 v[60:63], a[156:159], v[188:191], 0
  v_mfma_f32_16x16x32_bf16 v[60:63], a[152:155], v[184:187], v[60:63]
  v_mfma_f32_16x16x32_bf16 v[60:63], a[148:151], v[180:183], v[60:63]
  v_mfma_f32_16x16x32_bf16 v[60:63], a[144:147], v[176:179], v[60:63]
  v_mov_b32 v192, v249
  v_max3_f32 v192, v192, v0, v1
  v_max3_f32 v192, v192, v2, v3
  v_max3_f32 v192, v192, v4, v5
  v_max3_f32 v192, v192, v6, v7
  v_max3_f32 v192, v192, v32, v33
  v_max3_f32 v192, v192, v34, v35
  v_max3_f32 v192, v192, v36, v37
  v_max3_f32 v192, v192, v38, v39
  v_mov_b32 v245, v192
  s_nop 1
  v_permlane16_swap_b32 v192, v245
  v_max_f32 v192, v192, v245
  v_mov_b32 v245, v192
  s_nop 1
  v_permlane32_swap_b32 v192, v245
  v_max_f32 v192, v192, v245
  v_sub_f32 v193, v249, v192
  v_exp_f32 v193, v193
  v_mov_b32 v249, v192
  v_mul_f32 v208, v208, v193
  v_sub_f32 v0, v0, v192
  v_sub_f32 v1, v1, v192
  v_sub_f32 v2, v2, v192
  v_sub_f32 v3, v3, v192
  v_sub_f32 v4, v4, v192
  v_sub_f32 v5, v5, v192
  v_sub_f32 v6, v6, v192
  v_sub_f32 v7, v7, v192
  v_sub_f32 v32, v32, v192
  v_sub_f32 v33, v33, v192
  v_sub_f32 v34, v34, v192
  v_sub_f32 v35, v35, v192
  v_sub_f32 v36, v36, v192
  v_sub_f32 v37, v37, v192
  v_sub_f32 v38, v38, v192
  v_sub_f32 v39, v39, v192
  v_exp_f32 v0, v0
  v_exp_f32 v1, v1
  v_add_f32 v208, v208, v0
  v_exp_f32 v2, v2
  v_add_f32 v208, v208, v1
  v_cvt_pk_bf16_f32 v0, v0, v1
  v_exp_f32 v3, v3
  v_add_f32 v208, v208, v2
  v_add_f32 v208, v208, v3
  v_cvt_pk_bf16_f32 v1, v2, v3
  v_exp_f32 v4, v4
  v_exp_f32 v5, v5
  v_add_f32 v208, v208, v4
  v_exp_f32 v6, v6
  v_add_f32 v208, v208, v5
  v_cvt_pk_bf16_f32 v2, v4, v5
  v_exp_f32 v7, v7
  v_add_f32 v208, v208, v6
  v_add_f32 v208, v208, v7
  v_cvt_pk_bf16_f32 v3, v6, v7
  v_exp_f32 v32, v32
  v_exp_f32 v33, v33
  v_add_f32 v208, v208, v32
  v_exp_f32 v34, v34
  v_add_f32 v208, v208, v33
  v_cvt_pk_bf16_f32 v32, v32, v33
  v_exp_f32 v35, v35
  v_add_f32 v208, v208, v34
  v_add_f32 v208, v208, v35
  v_cvt_pk_bf16_f32 v33, v34, v35
  v_exp_f32 v36, v36
  v_exp_f32 v37, v37
  v_add_f32 v208, v208, v36
  v_exp_f32 v38, v38
  v_add_f32 v208, v208, v37
  v_cvt_pk_bf16_f32 v34, v36, v37
  v_exp_f32 v39, v39
  v_add_f32 v208, v208, v38
  v_add_f32 v208, v208, v39
  v_cvt_pk_bf16_f32 v35, v38, v39
  v_accvgpr_read_b32 v64, a0
  v_accvgpr_read_b32 v65, a1
  v_accvgpr_read_b32 v66, a2
  v_accvgpr_read_b32 v67, a3
  v_mul_f32 v64, v64, v193
  v_mul_f32 v65, v65, v193
  v_mul_f32 v66, v66, v193
  v_mul_f32 v67, v67, v193
  v_accvgpr_write_b32 a0, v64
  v_accvgpr_write_b32 a1, v65
  v_accvgpr_write_b32 a2, v66
  v_accvgpr_write_b32 a3, v67
  v_accvgpr_read_b32 v64, a16
  v_accvgpr_read_b32 v65, a17
  v_accvgpr_read_b32 v66, a18
  v_accvgpr_read_b32 v67, a19
  v_mul_f32 v64, v64, v193
  v_mul_f32 v65, v65, v193
  v_mul_f32 v66, v66, v193
  v_mul_f32 v67, v67, v193
  v_accvgpr_write_b32 a16, v64
  v_accvgpr_write_b32 a17, v65
  v_accvgpr_write_b32 a18, v66
  v_accvgpr_write_b32 a19, v67
  v_accvgpr_read_b32 v64, a32
  v_accvgpr_read_b32 v65, a33
  v_accvgpr_read_b32 v66, a34
  v_accvgpr_read_b32 v67, a35
  v_mul_f32 v64, v64, v193
  v_mul_f32 v65, v65, v193
  v_mul_f32 v66, v66, v193
  v_mul_f32 v67, v67, v193
  v_accvgpr_write_b32 a32, v64
  v_accvgpr_write_b32 a33, v65
  v_accvgpr_write_b32 a34, v66
  v_accvgpr_write_b32 a35, v67
  v_accvgpr_read_b32 v64, a48
  v_accvgpr_read_b32 v65, a49
  v_accvgpr_read_b32 v66, a50
  v_accvgpr_read_b32 v67, a51
  v_mul_f32 v64, v64, v193
  v_mul_f32 v65, v65, v193
  v_mul_f32 v66, v66, v193
  v_mul_f32 v67, v67, v193
  v_accvgpr_write_b32 a48, v64
  v_accvgpr_write_b32 a49, v65
  v_accvgpr_write_b32 a50, v66
  v_accvgpr_write_b32 a51, v67
  v_accvgpr_read_b32 v64, a64
  v_accvgpr_read_b32 v65, a65
  v_accvgpr_read_b32 v66, a66
  v_accvgpr_read_b32 v67, a67
  v_mul_f32 v64, v64, v193
  v_mul_f32 v65, v65, v193
  v_mul_f32 v66, v66, v193
  v_mul_f32 v67, v67, v193
  v_accvgpr_write_b32 a64, v64
  v_accvgpr_write_b32 a65, v65
  v_accvgpr_write_b32 a66, v66
  v_accvgpr_write_b32 a67, v67
  v_accvgpr_read_b32 v64, a80
  v_accvgpr_read_b32 v65, a81
  v_accvgpr_read_b32 v66, a82
  v_accvgpr_read_b32 v67, a83
  v_mul_f32 v64, v64, v193
  v_mul_f32 v65, v65, v193
  v_mul_f32 v66, v66, v193
  v_mul_f32 v67, v67, v193
  v_accvgpr_write_b32 a80, v64
  v_accvgpr_write_b32 a81, v65
  v_accvgpr_write_b32 a82, v66
  v_accvgpr_write_b32 a83, v67
  v_accvgpr_read_b32 v64, a96
  v_accvgpr_read_b32 v65, a97
  v_accvgpr_read_b32 v66, a98
  v_accvgpr_read_b32 v67, a99
  v_mul_f32 v64, v64, v193
  v_mul_f32 v65, v65, v193
  v_mul_f32 v66, v66, v193
  v_mul_f32 v67, v67, v193
  v_accvgpr_write_b32 a96, v64
  v_accvgpr_write_b32 a97, v65
  v_accvgpr_write_b32 a98, v66
  v_accvgpr_write_b32 a99, v67
  v_accvgpr_read_b32 v64, a112
  v_accvgpr_read_b32 v65, a113
  v_accvgpr_read_b32 v66, a114
  v_accvgpr_read_b32 v67, a115
  v_mul_f32 v64, v64, v193
  v_mul_f32 v65, v65, v193
  v_mul_f32 v66, v66, v193
  v_mul_f32 v67, v67, v193
  v_accvgpr_write_b32 a112, v64
  v_accvgpr_write_b32 a113, v65
  v_accvgpr_write_b32 a114, v66
  v_accvgpr_write_b32 a115, v67
  v_mov_b32 v196, v250
  v_max3_f32 v196, v196, v8, v9
  v_max3_f32 v196, v196, v10, v11
  v_max3_f32 v196, v196, v12, v13
  v_max3_f32 v196, v196, v14, v15
  v_max3_f32 v196, v196, v40, v41
  v_max3_f32 v196, v196, v42, v43
  v_max3_f32 v196, v196, v44, v45
  v_max3_f32 v196, v196, v46, v47
  v_mov_b32 v245, v196
  s_nop 1
  v_permlane16_swap_b32 v196, v245
  v_max_f32 v196, v196, v245
  v_mov_b32 v245, v196
  s_nop 1
  v_permlane32_swap_b32 v196, v245
  v_max_f32 v196, v196, v245
  v_sub_f32 v197, v250, v196
  v_exp_f32 v197, v197
  v_mov_b32 v250, v196
  v_mul_f32 v209, v209, v197
  v_sub_f32 v8, v8, v196
  v_sub_f32 v9, v9, v196
  v_sub_f32 v10, v10, v196
  v_sub_f32 v11, v11, v196
  v_sub_f32 v12, v12, v196
  v_sub_f32 v13, v13, v196
  v_sub_f32 v14, v14, v196
  v_sub_f32 v15, v15, v196
  v_sub_f32 v40, v40, v196
  v_sub_f32 v41, v41, v196
  v_sub_f32 v42, v42, v196
  v_sub_f32 v43, v43, v196
  v_sub_f32 v44, v44, v196
  v_sub_f32 v45, v45, v196
  v_sub_f32 v46, v46, v196
  v_sub_f32 v47, v47, v196
  v_exp_f32 v8, v8
  v_exp_f32 v9, v9
  v_add_f32 v209, v209, v8
  v_exp_f32 v10, v10
  v_add_f32 v209, v209, v9
  v_cvt_pk_bf16_f32 v8, v8, v9
  v_exp_f32 v11, v11
  v_add_f32 v209, v209, v10
  v_add_f32 v209, v209, v11
  v_cvt_pk_bf16_f32 v9, v10, v11
  v_exp_f32 v12, v12
  v_exp_f32 v13, v13
  v_add_f32 v209, v209, v12
  v_exp_f32 v14, v14
  v_add_f32 v209, v209, v13
  v_cvt_pk_bf16_f32 v10, v12, v13
  v_exp_f32 v15, v15
  v_add_f32 v209, v209, v14
  v_add_f32 v209, v209, v15
  v_cvt_pk_bf16_f32 v11, v14, v15
  v_exp_f32 v40, v40
  v_exp_f32 v41, v41
  v_add_f32 v209, v209, v40
  v_exp_f32 v42, v42
  v_add_f32 v209, v209, v41
  v_cvt_pk_bf16_f32 v40, v40, v41
  v_exp_f32 v43, v43
  v_add_f32 v209, v209, v42
  v_add_f32 v209, v209, v43
  v_cvt_pk_bf16_f32 v41, v42, v43
  v_exp_f32 v44, v44
  v_exp_f32 v45, v45
  v_add_f32 v209, v209, v44
  v_exp_f32 v46, v46
  v_add_f32 v209, v209, v45
  v_cvt_pk_bf16_f32 v42, v44, v45
  v_exp_f32 v47, v47
  v_add_f32 v209, v209, v46
  v_add_f32 v209, v209, v47
  v_cvt_pk_bf16_f32 v43, v46, v47
  v_accvgpr_read_b32 v64, a4
  v_accvgpr_read_b32 v65, a5
  v_accvgpr_read_b32 v66, a6
  v_accvgpr_read_b32 v67, a7
  v_mul_f32 v64, v64, v197
  v_mul_f32 v65, v65, v197
  v_mul_f32 v66, v66, v197
  v_mul_f32 v67, v67, v197
  v_accvgpr_write_b32 a4, v64
  v_accvgpr_write_b32 a5, v65
  v_accvgpr_write_b32 a6, v66
  v_accvgpr_write_b32 a7, v67
  v_accvgpr_read_b32 v64, a20
  v_accvgpr_read_b32 v65, a21
  v_accvgpr_read_b32 v66, a22
  v_accvgpr_read_b32 v67, a23
  v_mul_f32 v64, v64, v197
  v_mul_f32 v65, v65, v197
  v_mul_f32 v66, v66, v197
  v_mul_f32 v67, v67, v197
  v_accvgpr_write_b32 a20, v64
  v_accvgpr_write_b32 a21, v65
  v_accvgpr_write_b32 a22, v66
  v_accvgpr_write_b32 a23, v67
  v_accvgpr_read_b32 v64, a36
  v_accvgpr_read_b32 v65, a37
  v_accvgpr_read_b32 v66, a38
  v_accvgpr_read_b32 v67, a39
  v_mul_f32 v64, v64, v197
  v_mul_f32 v65, v65, v197
  v_mul_f32 v66, v66, v197
  v_mul_f32 v67, v67, v197
  v_accvgpr_write_b32 a36, v64
  v_accvgpr_write_b32 a37, v65
  v_accvgpr_write_b32 a38, v66
  v_accvgpr_write_b32 a39, v67
  v_accvgpr_read_b32 v64, a52
  v_accvgpr_read_b32 v65, a53
  v_accvgpr_read_b32 v66, a54
  v_accvgpr_read_b32 v67, a55
  v_mul_f32 v64, v64, v197
  v_mul_f32 v65, v65, v197
  v_mul_f32 v66, v66, v197
  v_mul_f32 v67, v67, v197
  v_accvgpr_write_b32 a52, v64
  v_accvgpr_write_b32 a53, v65
  v_accvgpr_write_b32 a54, v66
  v_accvgpr_write_b32 a55, v67
  v_accvgpr_read_b32 v64, a68
  v_accvgpr_read_b32 v65, a69
  v_accvgpr_read_b32 v66, a70
  v_accvgpr_read_b32 v67, a71
  v_mul_f32 v64, v64, v197
  v_mul_f32 v65, v65, v197
  v_mul_f32 v66, v66, v197
  v_mul_f32 v67, v67, v197
  v_accvgpr_write_b32 a68, v64
  v_accvgpr_write_b32 a69, v65
  v_accvgpr_write_b32 a70, v66
  v_accvgpr_write_b32 a71, v67
  v_accvgpr_read_b32 v64, a84
  v_accvgpr_read_b32 v65, a85
  v_accvgpr_read_b32 v66, a86
  v_accvgpr_read_b32 v67, a87
  v_mul_f32 v64, v64, v197
  v_mul_f32 v65, v65, v197
  v_mul_f32 v66, v66, v197
  v_mul_f32 v67, v67, v197
  v_accvgpr_write_b32 a84, v64
  v_accvgpr_write_b32 a85, v65
  v_accvgpr_write_b32 a86, v66
  v_accvgpr_write_b32 a87, v67
  v_accvgpr_read_b32 v64, a100
  v_accvgpr_read_b32 v65, a101
  v_accvgpr_read_b32 v66, a102
  v_accvgpr_read_b32 v67, a103
  v_mul_f32 v64, v64, v197
  v_mul_f32 v65, v65, v197
  v_mul_f32 v66, v66, v197
  v_mul_f32 v67, v67, v197
  v_accvgpr_write_b32 a100, v64
  v_accvgpr_write_b32 a101, v65
  v_accvgpr_write_b32 a102, v66
  v_accvgpr_write_b32 a103, v67
  v_accvgpr_read_b32 v64, a116
  v_accvgpr_read_b32 v65, a117
  v_accvgpr_read_b32 v66, a118
  v_accvgpr_read_b32 v67, a119
  v_mul_f32 v64, v64, v197
  v_mul_f32 v65, v65, v197
  v_mul_f32 v66, v66, v197
  v_mul_f32 v67, v67, v197
  v_accvgpr_write_b32 a116, v64
  v_accvgpr_write_b32 a117, v65
  v_accvgpr_write_b32 a118, v66
  v_accvgpr_write_b32 a119, v67
  v_mov_b32 v200, v251
  v_max3_f32 v200, v200, v16, v17
  v_max3_f32 v200, v200, v18, v19
  v_max3_f32 v200, v200, v20, v21
  v_max3_f32 v200, v200, v22, v23
  v_max3_f32 v200, v200, v48, v49
  v_max3_f32 v200, v200, v50, v51
  v_max3_f32 v200, v200, v52, v53
  v_max3_f32 v200, v200, v54, v55
  v_mov_b32 v245, v200
  s_nop 1
  v_permlane16_swap_b32 v200, v245
  v_max_f32 v200, v200, v245
  v_mov_b32 v245, v200
  s_nop 1
  v_permlane32_swap_b32 v200, v245
  v_max_f32 v200, v200, v245
  v_sub_f32 v201, v251, v200
  v_exp_f32 v201, v201
  v_mov_b32 v251, v200
  v_mul_f32 v210, v210, v201
  v_sub_f32 v16, v16, v200
  v_sub_f32 v17, v17, v200
  v_sub_f32 v18, v18, v200
  v_sub_f32 v19, v19, v200
  v_sub_f32 v20, v20, v200
  v_sub_f32 v21, v21, v200
  v_sub_f32 v22, v22, v200
  v_sub_f32 v23, v23, v200
  v_sub_f32 v48, v48, v200
  v_sub_f32 v49, v49, v200
  v_sub_f32 v50, v50, v200
  v_sub_f32 v51, v51, v200
  v_sub_f32 v52, v52, v200
  v_sub_f32 v53, v53, v200
  v_sub_f32 v54, v54, v200
  v_sub_f32 v55, v55, v200
  v_exp_f32 v16, v16
  v_exp_f32 v17, v17
  v_add_f32 v210, v210, v16
  v_exp_f32 v18, v18
  v_add_f32 v210, v210, v17
  v_cvt_pk_bf16_f32 v16, v16, v17
  v_exp_f32 v19, v19
  v_add_f32 v210, v210, v18
  v_add_f32 v210, v210, v19
  v_cvt_pk_bf16_f32 v17, v18, v19
  v_exp_f32 v20, v20
  v_exp_f32 v21, v21
  v_add_f32 v210, v210, v20
  v_exp_f32 v22, v22
  v_add_f32 v210, v210, v21
  v_cvt_pk_bf16_f32 v18, v20, v21
  v_exp_f32 v23, v23
  v_add_f32 v210, v210, v22
  v_add_f32 v210, v210, v23
  v_cvt_pk_bf16_f32 v19, v22, v23
  v_exp_f32 v48, v48
  v_exp_f32 v49, v49
  v_add_f32 v210, v210, v48
  v_exp_f32 v50, v50
  v_add_f32 v210, v210, v49
  v_cvt_pk_bf16_f32 v48, v48, v49
  v_exp_f32 v51, v51
  v_add_f32 v210, v210, v50
  v_add_f32 v210, v210, v51
  v_cvt_pk_bf16_f32 v49, v50, v51
  v_exp_f32 v52, v52
  v_exp_f32 v53, v53
  v_add_f32 v210, v210, v52
  v_exp_f32 v54, v54
  v_add_f32 v210, v210, v53
  v_cvt_pk_bf16_f32 v50, v52, v53
  v_exp_f32 v55, v55
  v_add_f32 v210, v210, v54
  v_add_f32 v210, v210, v55
  v_cvt_pk_bf16_f32 v51, v54, v55
  v_accvgpr_read_b32 v64, a8
  v_accvgpr_read_b32 v65, a9
  v_accvgpr_read_b32 v66, a10
  v_accvgpr_read_b32 v67, a11
  v_mul_f32 v64, v64, v201
  v_mul_f32 v65, v65, v201
  v_mul_f32 v66, v66, v201
  v_mul_f32 v67, v67, v201
  v_accvgpr_write_b32 a8, v64
  v_accvgpr_write_b32 a9, v65
  v_accvgpr_write_b32 a10, v66
  v_accvgpr_write_b32 a11, v67
  v_accvgpr_read_b32 v64, a24
  v_accvgpr_read_b32 v65, a25
  v_accvgpr_read_b32 v66, a26
  v_accvgpr_read_b32 v67, a27
  v_mul_f32 v64, v64, v201
  v_mul_f32 v65, v65, v201
  v_mul_f32 v66, v66, v201
  v_mul_f32 v67, v67, v201
  v_accvgpr_write_b32 a24, v64
  v_accvgpr_write_b32 a25, v65
  v_accvgpr_write_b32 a26, v66
  v_accvgpr_write_b32 a27, v67
  v_accvgpr_read_b32 v64, a40
  v_accvgpr_read_b32 v65, a41
  v_accvgpr_read_b32 v66, a42
  v_accvgpr_read_b32 v67, a43
  v_mul_f32 v64, v64, v201
  v_mul_f32 v65, v65, v201
  v_mul_f32 v66, v66, v201
  v_mul_f32 v67, v67, v201
  v_accvgpr_write_b32 a40, v64
  v_accvgpr_write_b32 a41, v65
  v_accvgpr_write_b32 a42, v66
  v_accvgpr_write_b32 a43, v67
  v_accvgpr_read_b32 v64, a56
  v_accvgpr_read_b32 v65, a57
  v_accvgpr_read_b32 v66, a58
  v_accvgpr_read_b32 v67, a59
  v_mul_f32 v64, v64, v201
  v_mul_f32 v65, v65, v201
  v_mul_f32 v66, v66, v201
  v_mul_f32 v67, v67, v201
  v_accvgpr_write_b32 a56, v64
  v_accvgpr_write_b32 a57, v65
  v_accvgpr_write_b32 a58, v66
  v_accvgpr_write_b32 a59, v67
  v_accvgpr_read_b32 v64, a72
  v_accvgpr_read_b32 v65, a73
  v_accvgpr_read_b32 v66, a74
  v_accvgpr_read_b32 v67, a75
  v_mul_f32 v64, v64, v201
  v_mul_f32 v65, v65, v201
  v_mul_f32 v66, v66, v201
  v_mul_f32 v67, v67, v201
  v_accvgpr_write_b32 a72, v64
  v_accvgpr_write_b32 a73, v65
  v_accvgpr_write_b32 a74, v66
  v_accvgpr_write_b32 a75, v67
  v_accvgpr_read_b32 v64, a88
  v_accvgpr_read_b32 v65, a89
  v_accvgpr_read_b32 v66, a90
  v_accvgpr_read_b32 v67, a91
  v_mul_f32 v64, v64, v201
  v_mul_f32 v65, v65, v201
  v_mul_f32 v66, v66, v201
  v_mul_f32 v67, v67, v201
  v_accvgpr_write_b32 a88, v64
  v_accvgpr_write_b32 a89, v65
  v_accvgpr_write_b32 a90, v66
  v_accvgpr_write_b32 a91, v67
  v_accvgpr_read_b32 v64, a104
  v_accvgpr_read_b32 v65, a105
  v_accvgpr_read_b32 v66, a106
  v_accvgpr_read_b32 v67, a107
  v_mul_f32 v64, v64, v201
  v_mul_f32 v65, v65, v201
  v_mul_f32 v66, v66, v201
  v_mul_f32 v67, v67, v201
  v_accvgpr_write_b32 a104, v64
  v_accvgpr_write_b32 a105, v65
  v_accvgpr_write_b32 a106, v66
  v_accvgpr_write_b32 a107, v67
  v_accvgpr_read_b32 v64, a120
  v_accvgpr_read_b32 v65, a121
  v_accvgpr_read_b32 v66, a122
  v_accvgpr_read_b32 v67, a123
  v_mul_f32 v64, v64, v201
  v_mul_f32 v65, v65, v201
  v_mul_f32 v66, v66, v201
  v_mul_f32 v67, v67, v201
  v_accvgpr_write_b32 a120, v64
  v_accvgpr_write_b32 a121, v65
  v_accvgpr_write_b32 a122, v66
  v_accvgpr_write_b32 a123, v67
  v_mov_b32 v204, v252
  v_max3_f32 v204, v204, v24, v25
  v_max3_f32 v204, v204, v26, v27
  v_max3_f32 v204, v204, v28, v29
  v_max3_f32 v204, v204, v30, v31
  v_max3_f32 v204, v204, v56, v57
  v_max3_f32 v204, v204, v58, v59
  v_max3_f32 v204, v204, v60, v61
  v_max3_f32 v204, v204, v62, v63
  v_mov_b32 v245, v204
  s_nop 1
  v_permlane16_swap_b32 v204, v245
  v_max_f32 v204, v204, v245
  v_mov_b32 v245, v204
  s_nop 1
  v_permlane32_swap_b32 v204, v245
  v_max_f32 v204, v204, v245
  v_sub_f32 v205, v252, v204
  v_exp_f32 v205, v205
  v_mov_b32 v252, v204
  v_mul_f32 v211, v211, v205
  v_sub_f32 v24, v24, v204
  v_sub_f32 v25, v25, v204
  v_sub_f32 v26, v26, v204
  v_sub_f32 v27, v27, v204
  v_sub_f32 v28, v28, v204
  v_sub_f32 v29, v29, v204
  v_sub_f32 v30, v30, v204
  v_sub_f32 v31, v31, v204
  v_sub_f32 v56, v56, v204
  v_sub_f32 v57, v57, v204
  v_sub_f32 v58, v58, v204
  v_sub_f32 v59, v59, v204
  v_sub_f32 v60, v60, v204
  v_sub_f32 v61, v61, v204
  v_sub_f32 v62, v62, v204
  v_sub_f32 v63, v63, v204
  v_exp_f32 v24, v24
  v_exp_f32 v25, v25
  v_add_f32 v211, v211, v24
  v_exp_f32 v26, v26
  v_add_f32 v211, v211, v25
  v_cvt_pk_bf16_f32 v24, v24, v25
  v_exp_f32 v27, v27
  v_add_f32 v211, v211, v26
  v_add_f32 v211, v211, v27
  v_cvt_pk_bf16_f32 v25, v26, v27
  v_exp_f32 v28, v28
  v_exp_f32 v29, v29
  v_add_f32 v211, v211, v28
  v_exp_f32 v30, v30
  v_add_f32 v211, v211, v29
  v_cvt_pk_bf16_f32 v26, v28, v29
  v_exp_f32 v31, v31
  v_add_f32 v211, v211, v30
  v_add_f32 v211, v211, v31
  v_cvt_pk_bf16_f32 v27, v30, v31
  v_exp_f32 v56, v56
  v_exp_f32 v57, v57
  v_add_f32 v211, v211, v56
  v_exp_f32 v58, v58
  v_add_f32 v211, v211, v57
  v_cvt_pk_bf16_f32 v56, v56, v57
  v_exp_f32 v59, v59
  v_add_f32 v211, v211, v58
  v_add_f32 v211, v211, v59
  v_cvt_pk_bf16_f32 v57, v58, v59
  v_exp_f32 v60, v60
  v_exp_f32 v61, v61
  v_add_f32 v211, v211, v60
  v_exp_f32 v62, v62
  v_add_f32 v211, v211, v61
  v_cvt_pk_bf16_f32 v58, v60, v61
  v_exp_f32 v63, v63
  v_add_f32 v211, v211, v62
  v_add_f32 v211, v211, v63
  v_cvt_pk_bf16_f32 v59, v62, v63
  v_accvgpr_read_b32 v64, a12
  v_accvgpr_read_b32 v65, a13
  v_accvgpr_read_b32 v66, a14
  v_accvgpr_read_b32 v67, a15
  v_mul_f32 v64, v64, v205
  v_mul_f32 v65, v65, v205
  v_mul_f32 v66, v66, v205
  v_mul_f32 v67, v67, v205
  v_accvgpr_write_b32 a12, v64
  v_accvgpr_write_b32 a13, v65
  v_accvgpr_write_b32 a14, v66
  v_accvgpr_write_b32 a15, v67
  v_accvgpr_read_b32 v64, a28
  v_accvgpr_read_b32 v65, a29
  v_accvgpr_read_b32 v66, a30
  v_accvgpr_read_b32 v67, a31
  v_mul_f32 v64, v64, v205
  v_mul_f32 v65, v65, v205
  v_mul_f32 v66, v66, v205
  v_mul_f32 v67, v67, v205
  v_accvgpr_write_b32 a28, v64
  v_accvgpr_write_b32 a29, v65
  v_accvgpr_write_b32 a30, v66
  v_accvgpr_write_b32 a31, v67
  v_accvgpr_read_b32 v64, a44
  v_accvgpr_read_b32 v65, a45
  v_accvgpr_read_b32 v66, a46
  v_accvgpr_read_b32 v67, a47
  v_mul_f32 v64, v64, v205
  v_mul_f32 v65, v65, v205
  v_mul_f32 v66, v66, v205
  v_mul_f32 v67, v67, v205
  v_accvgpr_write_b32 a44, v64
  v_accvgpr_write_b32 a45, v65
  v_accvgpr_write_b32 a46, v66
  v_accvgpr_write_b32 a47, v67
  v_accvgpr_read_b32 v64, a60
  v_accvgpr_read_b32 v65, a61
  v_accvgpr_read_b32 v66, a62
  v_accvgpr_read_b32 v67, a63
  v_mul_f32 v64, v64, v205
  v_mul_f32 v65, v65, v205
  v_mul_f32 v66, v66, v205
  v_mul_f32 v67, v67, v205
  v_accvgpr_write_b32 a60, v64
  v_accvgpr_write_b32 a61, v65
  v_accvgpr_write_b32 a62, v66
  v_accvgpr_write_b32 a63, v67
  v_accvgpr_read_b32 v64, a76
  v_accvgpr_read_b32 v65, a77
  v_accvgpr_read_b32 v66, a78
  v_accvgpr_read_b32 v67, a79
  v_mul_f32 v64, v64, v205
  v_mul_f32 v65, v65, v205
  v_mul_f32 v66, v66, v205
  v_mul_f32 v67, v67, v205
  v_accvgpr_write_b32 a76, v64
  v_accvgpr_write_b32 a77, v65
  v_accvgpr_write_b32 a78, v66
  v_accvgpr_write_b32 a79, v67
  v_accvgpr_read_b32 v64, a92
  v_accvgpr_read_b32 v65, a93
  v_accvgpr_read_b32 v66, a94
  v_accvgpr_read_b32 v67, a95
  v_mul_f32 v64, v64, v205
  v_mul_f32 v65, v65, v205
  v_mul_f32 v66, v66, v205
  v_mul_f32 v67, v67, v205
  v_accvgpr_write_b32 a92, v64
  v_accvgpr_write_b32 a93, v65
  v_accvgpr_write_b32 a94, v66
  v_accvgpr_write_b32 a95, v67
  v_accvgpr_read_b32 v64, a108
  v_accvgpr_read_b32 v65, a109
  v_accvgpr_read_b32 v66, a110
  v_accvgpr_read_b32 v67, a111
  v_mul_f32 v64, v64, v205
  v_mul_f32 v65, v65, v205
  v_mul_f32 v66, v66, v205
  v_mul_f32 v67, v67, v205
  v_accvgpr_write_b32 a108, v64
  v_accvgpr_write_b32 a109, v65
  v_accvgpr_write_b32 a110, v66
  v_accvgpr_write_b32 a111, v67
  v_accvgpr_read_b32 v64, a124
  v_accvgpr_read_b32 v65, a125
  v_accvgpr_read_b32 v66, a126
  v_accvgpr_read_b32 v67, a127
  v_mul_f32 v64, v64, v205
  v_mul_f32 v65, v65, v205
  v_mul_f32 v66, v66, v205
  v_mul_f32 v67, v67, v205
  v_accvgpr_write_b32 a124, v64
  v_accvgpr_write_b32 a125, v65
  v_accvgpr_write_b32 a126, v66
  v_accvgpr_write_b32 a127, v67
  ds_read_b64_tr_b16 a[160:161], v216 offset:49152
  ds_read_b64_tr_b16 a[162:163], v216 offset:53248
  ds_read_b64_tr_b16 a[164:165], v216 offset:57344
  ds_read_b64_tr_b16 a[166:167], v216 offset:61440
  s_waitcnt lgkmcnt(2)
  v_mfma_f32_16x16x32_bf16 a[0:3], a[160:163], v[0:3], a[0:3]
  s_waitcnt lgkmcnt(0)
  v_mfma_f32_16x16x32_bf16 a[0:3], a[164:167], v[32:35], a[0:3]
  v_mfma_f32_16x16x32_bf16 a[4:7], a[164:167], v[40:43], a[4:7]
  v_mfma_f32_16x16x32_bf16 a[4:7], a[160:163], v[8:11], a[4:7]
  v_mfma_f32_16x16x32_bf16 a[8:11], a[160:163], v[16:19], a[8:11]
  v_mfma_f32_16x16x32_bf16 a[8:11], a[164:167], v[48:51], a[8:11]
  v_mfma_f32_16x16x32_bf16 a[12:15], a[164:167], v[56:59], a[12:15]
  v_mfma_f32_16x16x32_bf16 a[12:15], a[160:163], v[24:27], a[12:15]
  ds_read_b64_tr_b16 a[168:169], v217 offset:49152
  ds_read_b64_tr_b16 a[170:171], v217 offset:53248
  ds_read_b64_tr_b16 a[172:173], v217 offset:57344
  ds_read_b64_tr_b16 a[174:175], v217 offset:61440
  s_waitcnt lgkmcnt(2)
  v_mfma_f32_16x16x32_bf16 a[16:19], a[168:171], v[0:3], a[16:19]
  s_waitcnt lgkmcnt(0)
  v_mfma_f32_16x16x32_bf16 a[16:19], a[172:175], v[32:35], a[16:19]
  v_mfma_f32_16x16x32_bf16 a[20:23], a[172:175], v[40:43], a[20:23]
  v_mfma_f32_16x16x32_bf16 a[20:23], a[168:171], v[8:11], a[20:23]
  v_mfma_f32_16x16x32_bf16 a[24:27], a[168:171], v[16:19], a[24:27]
  v_mfma_f32_16x16x32_bf16 a[24:27], a[172:175], v[48:51], a[24:27]
  v_mfma_f32_16x16x32_bf16 a[28:31], a[172:175], v[56:59], a[28:31]
  v_mfma_f32_16x16x32_bf16 a[28:31], a[168:171], v[24:27], a[28:31]
  ds_read_b64_tr_b16 a[176:177], v218 offset:49152
  ds_read_b64_tr_b16 a[178:179], v218 offset:53248
  ds_read_b64_tr_b16 a[180:181], v218 offset:57344
  ds_read_b64_tr_b16 a[182:183], v218 offset:61440
  s_waitcnt lgkmcnt(2)
  v_mfma_f32_16x16x32_bf16 a[32:35], a[176:179], v[0:3], a[32:35]
  s_waitcnt lgkmcnt(0)
  v_mfma_f32_16x16x32_bf16 a[32:35], a[180:183], v[32:35], a[32:35]
  v_mfma_f32_16x16x32_bf16 a[36:39], a[180:183], v[40:43], a[36:39]
  v_mfma_f32_16x16x32_bf16 a[36:39], a[176:179], v[8:11], a[36:39]
  v_mfma_f32_16x16x32_bf16 a[40:43], a[176:179], v[16:19], a[40:43]
  v_mfma_f32_16x16x32_bf16 a[40:43], a[180:183], v[48:51], a[40:43]
  v_mfma_f32_16x16x32_bf16 a[44:47], a[180:183], v[56:59], a[44:47]
  v_mfma_f32_16x16x32_bf16 a[44:47], a[176:179], v[24:27], a[44:47]
  ds_read_b64_tr_b16 a[184:185], v219 offset:49152
  ds_read_b64_tr_b16 a[186:187], v219 offset:53248
  ds_read_b64_tr_b16 a[188:189], v219 offset:57344
  ds_read_b64_tr_b16 a[190:191], v219 offset:61440
  s_waitcnt lgkmcnt(2)
  v_mfma_f32_16x16x32_bf16 a[48:51], a[184:187], v[0:3], a[48:51]
  s_waitcnt lgkmcnt(0)
  v_mfma_f32_16x16x32_bf16 a[48:51], a[188:191], v[32:35], a[48:51]
  v_mfma_f32_16x16x32_bf16 a[52:55], a[188:191], v[40:43], a[52:55]
  v_mfma_f32_16x16x32_bf16 a[52:55], a[184:187], v[8:11], a[52:55]
  v_mfma_f32_16x16x32_bf16 a[56:59], a[184:187], v[16:19], a[56:59]
  v_mfma_f32_16x16x32_bf16 a[56:59], a[188:191], v[48:51], a[56:59]
  v_mfma_f32_16x16x32_bf16 a[60:63], a[188:191], v[56:59], a[60:63]
  v_mfma_f32_16x16x32_bf16 a[60:63], a[184:187], v[24:27], a[60:63]
  ds_read_b64_tr_b16 a[160:161], v220 offset:49152
  ds_read_b64_tr_b16 a[162:163], v220 offset:53248
  ds_read_b64_tr_b16 a[164:165], v220 offset:57344
  ds_read_b64_tr_b16 a[166:167], v220 offset:61440
  s_waitcnt lgkmcnt(2)
  v_mfma_f32_16x16x32_bf16 a[64:67], a[160:163], v[0:3], a[64:67]
  s_waitcnt lgkmcnt(0)
  v_mfma_f32_16x16x32_bf16 a[64:67], a[164:167], v[32:35], a[64:67]
  v_mfma_f32_16x16x32_bf16 a[68:71], a[164:167], v[40:43], a[68:71]
  v_mfma_f32_16x16x32_bf16 a[68:71], a[160:163], v[8:11], a[68:71]
  v_mfma_f32_16x16x32_bf16 a[72:75], a[160:163], v[16:19], a[72:75]
  v_mfma_f32_16x16x32_bf16 a[72:75], a[164:167], v[48:51], a[72:75]
  v_mfma_f32_16x16x32_bf16 a[76:79], a[164:167], v[56:59], a[76:79]
  v_mfma_f32_16x16x32_bf16 a[76:79], a[160:163], v[24:27], a[76:79]
  ds_read_b64_tr_b16 a[168:169], v221 offset:49152
  ds_read_b64_tr_b16 a[170:171], v221 offset:53248
  ds_read_b64_tr_b16 a[172:173], v221 offset:57344
  ds_read_b64_tr_b16 a[174:175], v221 offset:61440
  s_waitcnt lgkmcnt(2)
  v_mfma_f32_16x16x32_bf16 a[80:83], a[168:171], v[0:3], a[80:83]
  s_waitcnt lgkmcnt(0)
  v_mfma_f32_16x16x32_bf16 a[80:83], a[172:175], v[32:35], a[80:83]
  v_mfma_f32_16x16x32_bf16 a[84:87], a[172:175], v[40:43], a[84:87]
  v_mfma_f32_16x16x32_bf16 a[84:87], a[168:171], v[8:11], a[84:87]
  v_mfma_f32_16x16x32_bf16 a[88:91], a[168:171], v[16:19], a[88:91]
  v_mfma_f32_16x16x32_bf16 a[88:91], a[172:175], v[48:51], a[88:91]
  v_mfma_f32_16x16x32_bf16 a[92:95], a[172:175], v[56:59], a[92:95]
  v_mfma_f32_16x16x32_bf16 a[92:95], a[168:171], v[24:27], a[92:95]
  ds_read_b64_tr_b16 a[176:177], v222 offset:49152
  ds_read_b64_tr_b16 a[178:179], v222 offset:53248
  ds_read_b64_tr_b16 a[180:181], v222 offset:57344
  ds_read_b64_tr_b16 a[182:183], v222 offset:61440
  s_waitcnt lgkmcnt(2)
  v_mfma_f32_16x16x32_bf16 a[96:99], a[176:179], v[0:3], a[96:99]
  s_waitcnt lgkmcnt(0)
  v_mfma_f32_16x16x32_bf16 a[96:99], a[180:183], v[32:35], a[96:99]
  v_mfma_f32_16x16x32_bf16 a[100:103], a[180:183], v[40:43], a[100:103]
  v_mfma_f32_16x16x32_bf16 a[100:103], a[176:179], v[8:11], a[100:103]
  v_mfma_f32_16x16x32_bf16 a[104:107], a[176:179], v[16:19], a[104:107]
  v_mfma_f32_16x16x32_bf16 a[104:107], a[180:183], v[48:51], a[104:107]
  v_mfma_f32_16x16x32_bf16 a[108:111], a[180:183], v[56:59], a[108:111]
  v_mfma_f32_16x16x32_bf16 a[108:111], a[176:179], v[24:27], a[108:111]
  ds_read_b64_tr_b16 a[184:185], v223 offset:49152
  ds_read_b64_tr_b16 a[186:187], v223 offset:53248
  ds_read_b64_tr_b16 a[188:189], v223 offset:57344
  ds_read_b64_tr_b16 a[190:191], v223 offset:61440
  s_waitcnt lgkmcnt(2)
  v_mfma_f32_16x16x32_bf16 a[112:115], a[184:187], v[0:3], a[112:115]
  s_waitcnt lgkmcnt(0)
  v_mfma_f32_16x16x32_bf16 a[112:115], a[188:191], v[32:35], a[112:115]
  v_mfma_f32_16x16x32_bf16 a[116:119], a[188:191], v[40:43], a[116:119]
  v_mfma_f32_16x16x32_bf16 a[116:119], a[184:187], v[8:11], a[116:119]
  v_mfma_f32_16x16x32_bf16 a[120:123], a[184:187], v[16:19], a[120:123]
  v_mfma_f32_16x16x32_bf16 a[120:123], a[188:191], v[48:51], a[120:123]
  v_mfma_f32_16x16x32_bf16 a[124:127], a[188:191], v[56:59], a[124:127]
  v_mfma_f32_16x16x32_bf16 a[124:127], a[184:187], v[24:27], a[124:127]
  s_add_u32 s29, s29, 16384
  s_cmp_lt_u32 s29, 524288
  s_cbranch_scc1 attn_slow
  v_mov_b32 v245, v208
  v_mov_b32 v246, v209
  v_mov_b32 v247, v210
  v_mov_b32 v248, v211
  v_permlane16_swap_b32 v208, v245
  v_permlane16_swap_b32 v209, v246
  v_permlane16_swap_b32 v210, v247
  v_permlane16_swap_b32 v211, v248
  v_add_f32 v208, v208, v245
  v_add_f32 v209, v209, v246
  v_add_f32 v210, v210, v247
  v_add_f32 v211, v211, v248
  v_mov_b32 v245, v208
  v_mov_b32 v246, v209
  v_mov_b32 v247, v210
  v_mov_b32 v248, v211
  v_permlane32_swap_b32 v208, v245
  v_permlane32_swap_b32 v209, v246
  v_permlane32_swap_b32 v210, v247
  v_permlane32_swap_b32 v211, v248
  v_add_f32 v208, v208, v245
  v_add_f32 v209, v209, v246
  v_add_f32 v210, v210, v247
  v_add_f32 v211, v211, v248
  v_rcp_f32 v192, v208
  v_rcp_f32 v196, v209
  v_rcp_f32 v200, v210
  v_rcp_f32 v204, v211
  v_accvgpr_read_b32 v0, a0
  v_accvgpr_read_b32 v1, a1
  v_accvgpr_read_b32 v2, a2
  v_accvgpr_read_b32 v3, a3
  v_accvgpr_read_b32 v4, a16
  v_accvgpr_read_b32 v5, a17
  v_accvgpr_read_b32 v6, a18
  v_accvgpr_read_b32 v7, a19
  v_mul_f32 v0, v0, v192
  v_mul_f32 v1, v1, v192
  v_mul_f32 v2, v2, v192
  v_mul_f32 v3, v3, v192
  v_mul_f32 v4, v4, v192
  v_mul_f32 v5, v5, v192
  v_mul_f32 v6, v6, v192
  v_mul_f32 v7, v7, v192
  v_cvt_pk_bf16_f32 v0, v0, v1
  v_cvt_pk_bf16_f32 v1, v2, v3
  v_cvt_pk_bf16_f32 v2, v4, v5
  v_cvt_pk_bf16_f32 v3, v6, v7
  buffer_store_dwordx4 v[0:3], v244, s[24:27], s40 offen offset:0 sc1
  v_accvgpr_read_b32 v8, a4
  v_accvgpr_read_b32 v9, a5
  v_accvgpr_read_b32 v10, a6
  v_accvgpr_read_b32 v11, a7
  v_accvgpr_read_b32 v12, a20
  v_accvgpr_read_b32 v13, a21
  v_accvgpr_read_b32 v14, a22
  v_accvgpr_read_b32 v15, a23
  v_mul_f32 v8, v8, v196
  v_mul_f32 v9, v9, v196
  v_mul_f32 v10, v10, v196
  v_mul_f32 v11, v11, v196
  v_mul_f32 v12, v12, v196
  v_mul_f32 v13, v13, v196
  v_mul_f32 v14, v14, v196
  v_mul_f32 v15, v15, v196
  v_cvt_pk_bf16_f32 v8, v8, v9
  v_cvt_pk_bf16_f32 v9, v10, v11
  v_cvt_pk_bf16_f32 v10, v12, v13
  v_cvt_pk_bf16_f32 v11, v14, v15
  buffer_store_dwordx4 v[8:11], v244, s[24:27], s40 offen offset:2048 sc1
  v_accvgpr_read_b32 v16, a8
  v_accvgpr_read_b32 v17, a9
  v_accvgpr_read_b32 v18, a10
  v_accvgpr_read_b32 v19, a11
  v_accvgpr_read_b32 v20, a24
  v_accvgpr_read_b32 v21, a25
  v_accvgpr_read_b32 v22, a26
  v_accvgpr_read_b32 v23, a27
  v_mul_f32 v16, v16, v200
  v_mul_f32 v17, v17, v200
  v_mul_f32 v18, v18, v200
  v_mul_f32 v19, v19, v200
  v_mul_f32 v20, v20, v200
  v_mul_f32 v21, v21, v200
  v_mul_f32 v22, v22, v200
  v_mul_f32 v23, v23, v200
  v_cvt_pk_bf16_f32 v16, v16, v17
  v_cvt_pk_bf16_f32 v17, v18, v19
  v_cvt_pk_bf16_f32 v18, v20, v21
  v_cvt_pk_bf16_f32 v19, v22, v23
  buffer_store_dwordx4 v[16:19], v244, s[24:27], s41 offen offset:0 sc1
  v_accvgpr_read_b32 v24, a12
  v_accvgpr_read_b32 v25, a13
  v_accvgpr_read_b32 v26, a14
  v_accvgpr_read_b32 v27, a15
  v_accvgpr_read_b32 v28, a28
  v_accvgpr_read_b32 v29, a29
  v_accvgpr_read_b32 v30, a30
  v_accvgpr_read_b32 v31, a31
  v_mul_f32 v24, v24, v204
  v_mul_f32 v25, v25, v204
  v_mul_f32 v26, v26, v204
  v_mul_f32 v27, v27, v204
  v_mul_f32 v28, v28, v204
  v_mul_f32 v29, v29, v204
  v_mul_f32 v30, v30, v204
  v_mul_f32 v31, v31, v204
  v_cvt_pk_bf16_f32 v24, v24, v25
  v_cvt_pk_bf16_f32 v25, v26, v27
  v_cvt_pk_bf16_f32 v26, v28, v29
  v_cvt_pk_bf16_f32 v27, v30, v31
  buffer_store_dwordx4 v[24:27], v244, s[24:27], s41 offen offset:2048 sc1
  v_accvgpr_read_b32 v32, a32
  v_accvgpr_read_b32 v33, a33
  v_accvgpr_read_b32 v34, a34
  v_accvgpr_read_b32 v35, a35
  v_accvgpr_read_b32 v36, a48
  v_accvgpr_read_b32 v37, a49
  v_accvgpr_read_b32 v38, a50
  v_accvgpr_read_b32 v39, a51
  v_mul_f32 v32, v32, v192
  v_mul_f32 v33, v33, v192
  v_mul_f32 v34, v34, v192
  v_mul_f32 v35, v35, v192
  v_mul_f32 v36, v36, v192
  v_mul_f32 v37, v37, v192
  v_mul_f32 v38, v38, v192
  v_mul_f32 v39, v39, v192
  v_cvt_pk_bf16_f32 v32, v32, v33
  v_cvt_pk_bf16_f32 v33, v34, v35
  v_cvt_pk_bf16_f32 v34, v36, v37
  v_cvt_pk_bf16_f32 v35, v38, v39
  buffer_store_dwordx4 v[32:35], v244, s[24:27], s40 offen offset:1024 sc1
  v_accvgpr_read_b32 v40, a36
  v_accvgpr_read_b32 v41, a37
  v_accvgpr_read_b32 v42, a38
  v_accvgpr_read_b32 v43, a39
  v_accvgpr_read_b32 v44, a52
  v_accvgpr_read_b32 v45, a53
  v_accvgpr_read_b32 v46, a54
  v_accvgpr_read_b32 v47, a55
  v_mul_f32 v40, v40, v196
  v_mul_f32 v41, v41, v196
  v_mul_f32 v42, v42, v196
  v_mul_f32 v43, v43, v196
  v_mul_f32 v44, v44, v196
  v_mul_f32 v45, v45, v196
  v_mul_f32 v46, v46, v196
  v_mul_f32 v47, v47, v196
  v_cvt_pk_bf16_f32 v40, v40, v41
  v_cvt_pk_bf16_f32 v41, v42, v43
  v_cvt_pk_bf16_f32 v42, v44, v45
  v_cvt_pk_bf16_f32 v43, v46, v47
  buffer_store_dwordx4 v[40:43], v244, s[24:27], s40 offen offset:3072 sc1
  v_accvgpr_read_b32 v48, a40
  v_accvgpr_read_b32 v49, a41
  v_accvgpr_read_b32 v50, a42
  v_accvgpr_read_b32 v51, a43
  v_accvgpr_read_b32 v52, a56
  v_accvgpr_read_b32 v53, a57
  v_accvgpr_read_b32 v54, a58
  v_accvgpr_read_b32 v55, a59
  v_mul_f32 v48, v48, v200
  v_mul_f32 v49, v49, v200
  v_mul_f32 v50, v50, v200
  v_mul_f32 v51, v51, v200
  v_mul_f32 v52, v52, v200
  v_mul_f32 v53, v53, v200
  v_mul_f32 v54, v54, v200
  v_mul_f32 v55, v55, v200
  v_cvt_pk_bf16_f32 v48, v48, v49
  v_cvt_pk_bf16_f32 v49, v50, v51
  v_cvt_pk_bf16_f32 v50, v52, v53
  v_cvt_pk_bf16_f32 v51, v54, v55
  buffer_store_dwordx4 v[48:51], v244, s[24:27], s41 offen offset:1024 sc1
  v_accvgpr_read_b32 v56, a44
  v_accvgpr_read_b32 v57, a45
  v_accvgpr_read_b32 v58, a46
  v_accvgpr_read_b32 v59, a47
  v_accvgpr_read_b32 v60, a60
  v_accvgpr_read_b32 v61, a61
  v_accvgpr_read_b32 v62, a62
  v_accvgpr_read_b32 v63, a63
  v_mul_f32 v56, v56, v204
  v_mul_f32 v57, v57, v204
  v_mul_f32 v58, v58, v204
  v_mul_f32 v59, v59, v204
  v_mul_f32 v60, v60, v204
  v_mul_f32 v61, v61, v204
  v_mul_f32 v62, v62, v204
  v_mul_f32 v63, v63, v204
  v_cvt_pk_bf16_f32 v56, v56, v57
  v_cvt_pk_bf16_f32 v57, v58, v59
  v_cvt_pk_bf16_f32 v58, v60, v61
  v_cvt_pk_bf16_f32 v59, v62, v63
  buffer_store_dwordx4 v[56:59], v244, s[24:27], s41 offen offset:3072 sc1
  v_accvgpr_read_b32 v0, a64
  v_accvgpr_read_b32 v1, a65
  v_accvgpr_read_b32 v2, a66
  v_accvgpr_read_b32 v3, a67
  v_accvgpr_read_b32 v4, a80
  v_accvgpr_read_b32 v5, a81
  v_accvgpr_read_b32 v6, a82
  v_accvgpr_read_b32 v7, a83
  v_mul_f32 v0, v0, v192
  v_mul_f32 v1, v1, v192
  v_mul_f32 v2, v2, v192
  v_mul_f32 v3, v3, v192
  v_mul_f32 v4, v4, v192
  v_mul_f32 v5, v5, v192
  v_mul_f32 v6, v6, v192
  v_mul_f32 v7, v7, v192
  v_cvt_pk_bf16_f32 v0, v0, v1
  v_cvt_pk_bf16_f32 v1, v2, v3
  v_cvt_pk_bf16_f32 v2, v4, v5
  v_cvt_pk_bf16_f32 v3, v6, v7
  buffer_store_dwordx4 v[0:3], v244, s[24:27], s42 offen offset:0 sc1
  v_accvgpr_read_b32 v8, a68
  v_accvgpr_read_b32 v9, a69
  v_accvgpr_read_b32 v10, a70
  v_accvgpr_read_b32 v11, a71
  v_accvgpr_read_b32 v12, a84
  v_accvgpr_read_b32 v13, a85
  v_accvgpr_read_b32 v14, a86
  v_accvgpr_read_b32 v15, a87
  v_mul_f32 v8, v8, v196
  v_mul_f32 v9, v9, v196
  v_mul_f32 v10, v10, v196
  v_mul_f32 v11, v11, v196
  v_mul_f32 v12, v12, v196
  v_mul_f32 v13, v13, v196
  v_mul_f32 v14, v14, v196
  v_mul_f32 v15, v15, v196
  v_cvt_pk_bf16_f32 v8, v8, v9
  v_cvt_pk_bf16_f32 v9, v10, v11
  v_cvt_pk_bf16_f32 v10, v12, v13
  v_cvt_pk_bf16_f32 v11, v14, v15
  buffer_store_dwordx4 v[8:11], v244, s[24:27], s42 offen offset:2048 sc1
  v_accvgpr_read_b32 v16, a72
  v_accvgpr_read_b32 v17, a73
  v_accvgpr_read_b32 v18, a74
  v_accvgpr_read_b32 v19, a75
  v_accvgpr_read_b32 v20, a88
  v_accvgpr_read_b32 v21, a89
  v_accvgpr_read_b32 v22, a90
  v_accvgpr_read_b32 v23, a91
  v_mul_f32 v16, v16, v200
  v_mul_f32 v17, v17, v200
  v_mul_f32 v18, v18, v200
  v_mul_f32 v19, v19, v200
  v_mul_f32 v20, v20, v200
  v_mul_f32 v21, v21, v200
  v_mul_f32 v22, v22, v200
  v_mul_f32 v23, v23, v200
  v_cvt_pk_bf16_f32 v16, v16, v17
  v_cvt_pk_bf16_f32 v17, v18, v19
  v_cvt_pk_bf16_f32 v18, v20, v21
  v_cvt_pk_bf16_f32 v19, v22, v23
  buffer_store_dwordx4 v[16:19], v244, s[24:27], s43 offen offset:0 sc1
  v_accvgpr_read_b32 v24, a76
  v_accvgpr_read_b32 v25, a77
  v_accvgpr_read_b32 v26, a78
  v_accvgpr_read_b32 v27, a79
  v_accvgpr_read_b32 v28, a92
  v_accvgpr_read_b32 v29, a93
  v_accvgpr_read_b32 v30, a94
  v_accvgpr_read_b32 v31, a95
  v_mul_f32 v24, v24, v204
  v_mul_f32 v25, v25, v204
  v_mul_f32 v26, v26, v204
  v_mul_f32 v27, v27, v204
  v_mul_f32 v28, v28, v204
  v_mul_f32 v29, v29, v204
  v_mul_f32 v30, v30, v204
  v_mul_f32 v31, v31, v204
  v_cvt_pk_bf16_f32 v24, v24, v25
  v_cvt_pk_bf16_f32 v25, v26, v27
  v_cvt_pk_bf16_f32 v26, v28, v29
  v_cvt_pk_bf16_f32 v27, v30, v31
  buffer_store_dwordx4 v[24:27], v244, s[24:27], s43 offen offset:2048 sc1
  v_accvgpr_read_b32 v32, a96
  v_accvgpr_read_b32 v33, a97
  v_accvgpr_read_b32 v34, a98
  v_accvgpr_read_b32 v35, a99
  v_accvgpr_read_b32 v36, a112
  v_accvgpr_read_b32 v37, a113
  v_accvgpr_read_b32 v38, a114
  v_accvgpr_read_b32 v39, a115
  v_mul_f32 v32, v32, v192
  v_mul_f32 v33, v33, v192
  v_mul_f32 v34, v34, v192
  v_mul_f32 v35, v35, v192
  v_mul_f32 v36, v36, v192
  v_mul_f32 v37, v37, v192
  v_mul_f32 v38, v38, v192
  v_mul_f32 v39, v39, v192
  v_cvt_pk_bf16_f32 v32, v32, v33
  v_cvt_pk_bf16_f32 v33, v34, v35
  v_cvt_pk_bf16_f32 v34, v36, v37
  v_cvt_pk_bf16_f32 v35, v38, v39
  buffer_store_dwordx4 v[32:35], v244, s[24:27], s42 offen offset:1024 sc1
  v_accvgpr_read_b32 v40, a100
  v_accvgpr_read_b32 v41, a101
  v_accvgpr_read_b32 v42, a102
  v_accvgpr_read_b32 v43, a103
  v_accvgpr_read_b32 v44, a116
  v_accvgpr_read_b32 v45, a117
  v_accvgpr_read_b32 v46, a118
  v_accvgpr_read_b32 v47, a119
  v_mul_f32 v40, v40, v196
  v_mul_f32 v41, v41, v196
  v_mul_f32 v42, v42, v196
  v_mul_f32 v43, v43, v196
  v_mul_f32 v44, v44, v196
  v_mul_f32 v45, v45, v196
  v_mul_f32 v46, v46, v196
  v_mul_f32 v47, v47, v196
  v_cvt_pk_bf16_f32 v40, v40, v41
  v_cvt_pk_bf16_f32 v41, v42, v43
  v_cvt_pk_bf16_f32 v42, v44, v45
  v_cvt_pk_bf16_f32 v43, v46, v47
  buffer_store_dwordx4 v[40:43], v244, s[24:27], s42 offen offset:3072 sc1
  v_accvgpr_read_b32 v48, a104
  v_accvgpr_read_b32 v49, a105
  v_accvgpr_read_b32 v50, a106
  v_accvgpr_read_b32 v51, a107
  v_accvgpr_read_b32 v52, a120
  v_accvgpr_read_b32 v53, a121
  v_accvgpr_read_b32 v54, a122
  v_accvgpr_read_b32 v55, a123
  v_mul_f32 v48, v48, v200
  v_mul_f32 v49, v49, v200
  v_mul_f32 v50, v50, v200
  v_mul_f32 v51, v51, v200
  v_mul_f32 v52, v52, v200
  v_mul_f32 v53, v53, v200
  v_mul_f32 v54, v54, v200
  v_mul_f32 v55, v55, v200
  v_cvt_pk_bf16_f32 v48, v48, v49
  v_cvt_pk_bf16_f32 v49, v50, v51
  v_cvt_pk_bf16_f32 v50, v52, v53
  v_cvt_pk_bf16_f32 v51, v54, v55
  buffer_store_dwordx4 v[48:51], v244, s[24:27], s43 offen offset:1024 sc1
  v_accvgpr_read_b32 v56, a108
  v_accvgpr_read_b32 v57, a109
  v_accvgpr_read_b32 v58, a110
  v_accvgpr_read_b32 v59, a111
  v_accvgpr_read_b32 v60, a124
  v_accvgpr_read_b32 v61, a125
  v_accvgpr_read_b32 v62, a126
  v_accvgpr_read_b32 v63, a127
  v_mul_f32 v56, v56, v204
  v_mul_f32 v57, v57, v204
  v_mul_f32 v58, v58, v204
  v_mul_f32 v59, v59, v204
  v_mul_f32 v60, v60, v204
  v_mul_f32 v61, v61, v204
  v_mul_f32 v62, v62, v204
  v_mul_f32 v63, v63, v204
  v_cvt_pk_bf16_f32 v56, v56, v57
  v_cvt_pk_bf16_f32 v57, v58, v59
  v_cvt_pk_bf16_f32 v58, v60, v61
  v_cvt_pk_bf16_f32 v59, v62, v63
  buffer_store_dwordx4 v[56:59], v244, s[24:27], s43 offen offset:3072 sc1
  v_add_u32 v252, 4096, v242
  v_add_u32 v253, 8192, v242
  buffer_load_dwordx4 a[128:131], v253, s[24:27], s4 offen offset:3072 sc1
  buffer_load_dwordx4 a[132:135], v242, s[24:27], s5 offen offset:0 sc1
  buffer_load_dwordx4 a[136:139], v242, s[24:27], s5 offen offset:1024 sc1
  buffer_load_dwordx4 a[140:143], v242, s[24:27], s5 offen offset:2048 sc1
  buffer_load_dwordx4 a[144:147], v242, s[24:27], s5 offen offset:3072 sc1
  buffer_load_dwordx4 a[148:151], v252, s[24:27], s5 offen offset:0 sc1
  buffer_load_dwordx4 a[152:155], v252, s[24:27], s5 offen offset:1024 sc1
  buffer_load_dwordx4 a[156:159], v252, s[24:27], s5 offen offset:2048 sc1
  buffer_load_dwordx4 a[0:3], v252, s[24:27], s5 offen offset:3072 sc1
  buffer_load_dwordx4 a[4:7], v253, s[24:27], s5 offen offset:0 sc1
  buffer_load_dwordx4 a[8:11], v253, s[24:27], s5 offen offset:1024 sc1
  buffer_load_dwordx4 a[12:15], v253, s[24:27], s5 offen offset:2048 sc1
  buffer_load_dwordx4 a[16:19], v253, s[24:27], s5 offen offset:3072 sc1
  buffer_load_dwordx4 a[20:23], v242, s[24:27], s6 offen offset:0 sc1
  buffer_load_dwordx4 a[24:27], v242, s[24:27], s6 offen offset:1024 sc1
  buffer_load_dwordx4 a[28:31], v242, s[24:27], s6 offen offset:2048 sc1
  buffer_load_dwordx4 a[32:35], v242, s[24:27], s6 offen offset:3072 sc1
  buffer_load_dwordx4 a[36:39], v252, s[24:27], s6 offen offset:0 sc1
  s_and_b32 s39, s2, 63
  s_lshl_b32 s39, s39, 7
  s_add_u32 s39, s39, 2867200
  s_lshl_b32 s38, s3, 26
  v_lshlrev_b32 v64, 22, v242
  v_or_b32 v64, s38, v64
  v_mov_b32 v65, 1
  s_waitcnt vmcnt(0)
  s_barrier
  s_branch tail_go
.section .rodata,"a"
.p2align 6
.amdhsa_kernel recurrent_scan__mha_block_cached__moe_arch_mod__prompt_kernel
  .amdhsa_next_free_vgpr 512
  .amdhsa_next_free_sgpr 102
  .amdhsa_accum_offset 256
  .amdhsa_group_segment_fixed_size 0
  .amdhsa_kernarg_size 104
  .amdhsa_user_sgpr_count 2
  .amdhsa_user_sgpr_kernarg_segment_ptr 1
  .amdhsa_system_sgpr_workgroup_id_x 1
.end_amdhsa_kernel
```

```asm
; @launch grid=(256,1,1) block=(256,1,1) lds=163840
.amdgcn_target "amdgcn-amd-amdhsa--gfx950"
.text
.globl recurrent_scan__mha_block_cached__moe_arch_mod__prompt_kernel
.p2align 8
.type recurrent_scan__mha_block_cached__moe_arch_mod__prompt_kernel,@function
recurrent_scan__mha_block_cached__moe_arch_mod__prompt_kernel:
  s_cmp_ge_u32 s2, 256
  s_cbranch_scc1 attn_end
  s_load_dwordx2 s[60:61], s[0:1], 0
  s_load_dwordx2 s[48:49], s[0:1], 48
  s_load_dwordx4 s[4:7], s[0:1], 8
  s_load_dwordx2 s[8:9], s[0:1], 24
  s_load_dwordx2 s[10:11], s[0:1], 96
  s_load_dwordx2 s[88:89], s[0:1], 32
  s_load_dwordx2 s[90:91], s[0:1], 56
  s_load_dwordx4 s[92:95], s[0:1], 64
  s_load_dwordx2 s[62:63], s[0:1], 80
  v_lshrrev_b32 v249, 6, v0
  v_and_b32 v0, 63, v0
  v_mov_b32 v245, v0
  v_readfirstlane_b32 s3, v249
  s_and_b32 s36, s2, 7
  s_lshl_b32 s36, s36, 2
  s_lshr_b32 s37, s2, 6
  s_add_u32 s36, s36, s37
  s_bfe_u32 s37, s2, 0x30003
  s_lshl_b32 s37, s37, 2
  s_add_u32 s37, s37, s3
  s_lshl_b32 s28, s3, 12
  v_lshrrev_b32 v248, 4, v245
  v_and_b32 v247, 15, v245
  s_lshl_b32 s38, s3, 17
  v_lshlrev_b32 v249, 13, v248
  v_add_u32 v249, s38, v249
  v_or_b32 v250, 0, v248
  v_lshlrev_b32 v250, 1, v250
  v_xor_b32 v250, v250, v247
  v_lshl_add_u32 v238, v250, 4, v249
  v_or_b32 v250, 0, v248
  v_lshlrev_b32 v250, 1, v250
  v_xor_b32 v250, v250, v247
  v_lshl_add_u32 v239, v250, 4, v249
  v_add_u32 v239, 31744, v239
  v_or_b32 v250, 4, v248
  v_lshlrev_b32 v250, 1, v250
  v_xor_b32 v250, v250, v247
  v_lshl_add_u32 v240, v250, 4, v249
  v_add_u32 v240, 63488, v240
  v_or_b32 v250, 4, v248
  v_lshlrev_b32 v250, 1, v250
  v_xor_b32 v250, v250, v247
  v_lshl_add_u32 v241, v250, 4, v249
  v_add_u32 v241, 95232, v241
  s_waitcnt lgkmcnt(0)
  s_add_u32 s58, s10, 2830336
  s_addc_u32 s59, s11, 0
  s_load_dword s59, s[58:59], 0
  s_mov_b32 s24, s10
  s_mov_b32 s25, s11
  s_mov_b32 s26, 29360128
  s_mov_b32 s27, 0x20000
  s_lshl_b32 s38, s36, 8
  s_add_u32 s20, s8, s38
  s_addc_u32 s21, s9, 0
  s_mov_b32 s22, 5242880
  s_mov_b32 s23, 0x20000
  s_sub_u32 s22, s22, s38
  s_cmp_ge_u32 s3, 2
  s_cbranch_scc1 front_fetch
  s_mov_b32 s12, s60
  s_mov_b32 s13, s61
  s_mov_b32 s14, 2621440
  s_mov_b32 s15, 0x20000
  s_mov_b32 s16, s48
  s_mov_b32 s17, s49
  s_mov_b32 s18, 1280
  s_mov_b32 s19, 0x20000
  s_lshr_b32 s52, s37, 2
  s_lshl_b32 s52, s52, 5
  s_add_u32 s52, s52, s36
  s_lshl_b32 s52, s52, 1
  s_add_u32 s52, s52, s3
  s_lshl_b32 s52, s52, 2
  s_mul_i32 s53, s52, 1280
  v_lshrrev_b32 v1, 4, v0
  v_and_b32 v2, 15, v0
  v_lshlrev_b32 v3, 4, v2
  v_mul_u32_u24 v4, 0x500, v1
  v_add_u32 v4, v4, v3
  buffer_load_dwordx4 v[8:11], v4, s[12:15], s53 offen offset:0
  buffer_load_dwordx4 v[12:15], v4, s[12:15], s53 offen offset:256
  buffer_load_dwordx4 v[16:19], v4, s[12:15], s53 offen offset:512
  buffer_load_dwordx4 v[20:23], v4, s[12:15], s53 offen offset:768
  buffer_load_dwordx4 v[24:27], v4, s[12:15], s53 offen offset:1024
  buffer_load_dwordx4 v[28:31], v3, s[16:19], 0 offen offset:0
  buffer_load_dwordx4 v[32:35], v3, s[16:19], 0 offen offset:256
  buffer_load_dwordx4 v[36:39], v3, s[16:19], 0 offen offset:512
  buffer_load_dwordx4 v[40:43], v3, s[16:19], 0 offen offset:768
  buffer_load_dwordx4 v[44:47], v3, s[16:19], 0 offen offset:1024
  v_mov_b32 v7, 0
  v_lshlrev_b32 v6, 26, v0
  s_lshl_b32 s53, s2, 7
  s_add_u32 s53, s53, 2834432
  buffer_store_dword v7, v6, s[24:27], s53 offen sc1
  v_lshlrev_b32 v6, 8, v0
  v_lshrrev_b32 v5, 5, v0
  v_lshl_add_u32 v6, v5, 26, v6
  s_cmp_eq_u32 s2, 0
  s_cselect_b32 s53, 0, 1073741824
  v_or_b32 v6, s53, v6
  s_mov_b32 s53, 2818048
  buffer_store_dword v7, v6, s[24:27], s53 offen sc1
  v_lshlrev_b32 v6, 7, v0
  s_cmp_eq_u32 s2, 1
  s_cselect_b32 s53, 0, 1073741824
  v_or_b32 v6, s53, v6
  s_mov_b32 s53, 2867200
  buffer_store_dword v7, v6, s[24:27], s53 offen sc1
  s_lshr_b32 s53, s52, 6
  s_mul_i32 s53, s53, 81920
  s_bfe_u32 s54, s52, 0x20004
  s_lshl_b32 s54, s54, 10
  s_add_u32 s53, s53, s54
  s_and_b32 s54, s52, 15
  s_lshl_b32 s54, s54, 4
  s_add_u32 s53, s53, s54
  v_lshrrev_b32 v5, 2, v2
  v_lshlrev_b32 v5, 12, v5
  v_and_b32 v6, 3, v2
  v_lshl_add_u32 v5, v6, 8, v5
  v_lshl_add_u32 v5, v1, 4, v5
  s_mov_b32 s56, 0xffff0000
  s_waitcnt vmcnt(12)
  v_lshlrev_b32 v48, 16, v8
  v_and_b32 v49, s56, v8
  v_lshlrev_b32 v50, 16, v9
  v_and_b32 v51, s56, v9
  v_lshlrev_b32 v52, 16, v10
  v_and_b32 v53, s56, v10
  v_lshlrev_b32 v54, 16, v11
  v_and_b32 v55, s56, v11
  s_waitcnt vmcnt(11)
  v_lshlrev_b32 v56, 16, v12
  v_and_b32 v57, s56, v12
  v_lshlrev_b32 v58, 16, v13
  v_and_b32 v59, s56, v13
  v_lshlrev_b32 v60, 16, v14
  v_and_b32 v61, s56, v14
  v_lshlrev_b32 v62, 16, v15
  v_and_b32 v63, s56, v15
  s_waitcnt vmcnt(10)
  v_lshlrev_b32 v64, 16, v16
  v_and_b32 v65, s56, v16
  v_lshlrev_b32 v66, 16, v17
  v_and_b32 v67, s56, v17
  v_lshlrev_b32 v68, 16, v18
  v_and_b32 v69, s56, v18
  v_lshlrev_b32 v70, 16, v19
  v_and_b32 v71, s56, v19
  s_waitcnt vmcnt(9)
  v_lshlrev_b32 v72, 16, v20
  v_and_b32 v73, s56, v20
  v_lshlrev_b32 v74, 16, v21
  v_and_b32 v75, s56, v21
  v_lshlrev_b32 v76, 16, v22
  v_and_b32 v77, s56, v22
  v_lshlrev_b32 v78, 16, v23
  v_and_b32 v79, s56, v23
  s_waitcnt vmcnt(8)
  v_lshlrev_b32 v80, 16, v24
  v_and_b32 v81, s56, v24
  v_lshlrev_b32 v82, 16, v25
  v_and_b32 v83, s56, v25
  v_lshlrev_b32 v84, 16, v26
  v_and_b32 v85, s56, v26
  v_lshlrev_b32 v86, 16, v27
  v_and_b32 v87, s56, v27
  v_pk_add_f32 v[88:89], v[48:49], v[50:51]
  v_pk_add_f32 v[90:91], v[52:53], v[54:55]
  v_pk_add_f32 v[88:89], v[88:89], v[56:57]
  v_pk_add_f32 v[90:91], v[90:91], v[58:59]
  v_pk_add_f32 v[88:89], v[88:89], v[60:61]
  v_pk_add_f32 v[90:91], v[90:91], v[62:63]
  v_pk_add_f32 v[88:89], v[88:89], v[64:65]
  v_pk_add_f32 v[90:91], v[90:91], v[66:67]
  v_pk_add_f32 v[88:89], v[88:89], v[68:69]
  v_pk_add_f32 v[90:91], v[90:91], v[70:71]
  v_pk_add_f32 v[88:89], v[88:89], v[72:73]
  v_pk_add_f32 v[90:91], v[90:91], v[74:75]
  v_pk_add_f32 v[88:89], v[88:89], v[76:77]
  v_pk_add_f32 v[90:91], v[90:91], v[78:79]
  v_pk_add_f32 v[88:89], v[88:89], v[80:81]
  v_pk_add_f32 v[90:91], v[90:91], v[82:83]
  v_pk_add_f32 v[88:89], v[88:89], v[84:85]
  v_pk_add_f32 v[90:91], v[90:91], v[86:87]
  v_pk_add_f32 v[88:89], v[88:89], v[90:91]
  v_add_f32 v92, v88, v89
  s_nop 1
  v_add_f32_dpp v92, v92, v92 row_ror:8 row_mask:0xf bank_mask:0xf
  s_nop 1
  v_add_f32_dpp v92, v92, v92 row_ror:4 row_mask:0xf bank_mask:0xf
  s_nop 1
  v_add_f32_dpp v92, v92, v92 row_ror:2 row_mask:0xf bank_mask:0xf
  s_nop 1
  v_add_f32_dpp v92, v92, v92 row_ror:1 row_mask:0xf bank_mask:0xf
  v_mul_f32 v92, 0x3acccccd, v92
  v_pk_add_f32 v[94:95], v[48:49], v[92:93] op_sel_hi:[1,0] neg_lo:[0,1] neg_hi:[0,1]
  v_pk_mul_f32 v[88:89], v[94:95], v[94:95]
  v_pk_add_f32 v[96:97], v[50:51], v[92:93] op_sel_hi:[1,0] neg_lo:[0,1] neg_hi:[0,1]
  v_pk_mul_f32 v[90:91], v[96:97], v[96:97]
  v_pk_add_f32 v[94:95], v[52:53], v[92:93] op_sel_hi:[1,0] neg_lo:[0,1] neg_hi:[0,1]
  v_pk_fma_f32 v[88:89], v[94:95], v[94:95], v[88:89]
  v_pk_add_f32 v[96:97], v[54:55], v[92:93] op_sel_hi:[1,0] neg_lo:[0,1] neg_hi:[0,1]
  v_pk_fma_f32 v[90:91], v[96:97], v[96:97], v[90:91]
  v_pk_add_f32 v[94:95], v[56:57], v[92:93] op_sel_hi:[1,0] neg_lo:[0,1] neg_hi:[0,1]
  v_pk_fma_f32 v[88:89], v[94:95], v[94:95], v[88:89]
  v_pk_add_f32 v[96:97], v[58:59], v[92:93] op_sel_hi:[1,0] neg_lo:[0,1] neg_hi:[0,1]
  v_pk_fma_f32 v[90:91], v[96:97], v[96:97], v[90:91]
  v_pk_add_f32 v[94:95], v[60:61], v[92:93] op_sel_hi:[1,0] neg_lo:[0,1] neg_hi:[0,1]
  v_pk_fma_f32 v[88:89], v[94:95], v[94:95], v[88:89]
  v_pk_add_f32 v[96:97], v[62:63], v[92:93] op_sel_hi:[1,0] neg_lo:[0,1] neg_hi:[0,1]
  v_pk_fma_f32 v[90:91], v[96:97], v[96:97], v[90:91]
  v_pk_add_f32 v[94:95], v[64:65], v[92:93] op_sel_hi:[1,0] neg_lo:[0,1] neg_hi:[0,1]
  v_pk_fma_f32 v[88:89], v[94:95], v[94:95], v[88:89]
  v_pk_add_f32 v[96:97], v[66:67], v[92:93] op_sel_hi:[1,0] neg_lo:[0,1] neg_hi:[0,1]
  v_pk_fma_f32 v[90:91], v[96:97], v[96:97], v[90:91]
  v_pk_add_f32 v[94:95], v[68:69], v[92:93] op_sel_hi:[1,0] neg_lo:[0,1] neg_hi:[0,1]
  v_pk_fma_f32 v[88:89], v[94:95], v[94:95], v[88:89]
  v_pk_add_f32 v[96:97], v[70:71], v[92:93] op_sel_hi:[1,0] neg_lo:[0,1] neg_hi:[0,1]
  v_pk_fma_f32 v[90:91], v[96:97], v[96:97], v[90:91]
  v_pk_add_f32 v[94:95], v[72:73], v[92:93] op_sel_hi:[1,0] neg_lo:[0,1] neg_hi:[0,1]
  v_pk_fma_f32 v[88:89], v[94:95], v[94:95], v[88:89]
  v_pk_add_f32 v[96:97], v[74:75], v[92:93] op_sel_hi:[1,0] neg_lo:[0,1] neg_hi:[0,1]
  v_pk_fma_f32 v[90:91], v[96:97], v[96:97], v[90:91]
  v_pk_add_f32 v[94:95], v[76:77], v[92:93] op_sel_hi:[1,0] neg_lo:[0,1] neg_hi:[0,1]
  v_pk_fma_f32 v[88:89], v[94:95], v[94:95], v[88:89]
  v_pk_add_f32 v[96:97], v[78:79], v[92:93] op_sel_hi:[1,0] neg_lo:[0,1] neg_hi:[0,1]
  v_pk_fma_f32 v[90:91], v[96:97], v[96:97], v[90:91]
  v_pk_add_f32 v[94:95], v[80:81], v[92:93] op_sel_hi:[1,0] neg_lo:[0,1] neg_hi:[0,1]
  v_pk_fma_f32 v[88:89], v[94:95], v[94:95], v[88:89]
  v_pk_add_f32 v[96:97], v[82:83], v[92:93] op_sel_hi:[1,0] neg_lo:[0,1] neg_hi:[0,1]
  v_pk_fma_f32 v[90:91], v[96:97], v[96:97], v[90:91]
  v_pk_add_f32 v[94:95], v[84:85], v[92:93] op_sel_hi:[1,0] neg_lo:[0,1] neg_hi:[0,1]
  v_pk_fma_f32 v[88:89], v[94:95], v[94:95], v[88:89]
  v_pk_add_f32 v[96:97], v[86:87], v[92:93] op_sel_hi:[1,0] neg_lo:[0,1] neg_hi:[0,1]
  v_pk_fma_f32 v[90:91], v[96:97], v[96:97], v[90:91]
  v_pk_add_f32 v[88:89], v[88:89], v[90:91]
  v_add_f32 v98, v88, v89
  s_nop 1
  v_add_f32_dpp v98, v98, v98 row_ror:8 row_mask:0xf bank_mask:0xf
  v_cvt_pk_bf16_f32 v92, v92, v92
  s_nop 0
  v_add_f32_dpp v98, v98, v98 row_ror:4 row_mask:0xf bank_mask:0xf
  v_lshlrev_b32 v92, 16, v92
  s_nop 0
  v_add_f32_dpp v98, v98, v98 row_ror:2 row_mask:0xf bank_mask:0xf
  s_nop 1
  v_add_f32_dpp v98, v98, v98 row_ror:1 row_mask:0xf bank_mask:0xf
  v_mul_f32 v98, 0x3acccccd, v98
  v_cvt_pk_bf16_f32 v98, v98, v98
  v_pk_add_f32 v[48:49], v[48:49], v[92:93] op_sel_hi:[1,0] neg_lo:[0,1] neg_hi:[0,1]
  v_lshlrev_b32 v98, 16, v98
  v_pk_add_f32 v[50:51], v[50:51], v[92:93] op_sel_hi:[1,0] neg_lo:[0,1] neg_hi:[0,1]
  v_add_f32 v98, 0x3727c5ac, v98
  v_pk_add_f32 v[52:53], v[52:53], v[92:93] op_sel_hi:[1,0] neg_lo:[0,1] neg_hi:[0,1]
  v_cvt_pk_bf16_f32 v98, v98, v98
  v_pk_add_f32 v[54:55], v[54:55], v[92:93] op_sel_hi:[1,0] neg_lo:[0,1] neg_hi:[0,1]
  v_lshlrev_b32 v98, 16, v98
  v_pk_add_f32 v[56:57], v[56:57], v[92:93] op_sel_hi:[1,0] neg_lo:[0,1] neg_hi:[0,1]
  v_sqrt_f32 v98, v98
  v_pk_add_f32 v[58:59], v[58:59], v[92:93] op_sel_hi:[1,0] neg_lo:[0,1] neg_hi:[0,1]
  v_cvt_pk_bf16_f32 v98, v98, v98
  v_pk_add_f32 v[60:61], v[60:61], v[92:93] op_sel_hi:[1,0] neg_lo:[0,1] neg_hi:[0,1]
  v_lshlrev_b32 v98, 16, v98
  v_pk_add_f32 v[62:63], v[62:63], v[92:93] op_sel_hi:[1,0] neg_lo:[0,1] neg_hi:[0,1]
  v_rcp_f32 v100, v98
  v_pk_add_f32 v[64:65], v[64:65], v[92:93] op_sel_hi:[1,0] neg_lo:[0,1] neg_hi:[0,1]
  v_pk_add_f32 v[66:67], v[66:67], v[92:93] op_sel_hi:[1,0] neg_lo:[0,1] neg_hi:[0,1]
  v_pk_add_f32 v[68:69], v[68:69], v[92:93] op_sel_hi:[1,0] neg_lo:[0,1] neg_hi:[0,1]
  v_pk_add_f32 v[70:71], v[70:71], v[92:93] op_sel_hi:[1,0] neg_lo:[0,1] neg_hi:[0,1]
  v_pk_add_f32 v[72:73], v[72:73], v[92:93] op_sel_hi:[1,0] neg_lo:[0,1] neg_hi:[0,1]
  v_pk_add_f32 v[74:75], v[74:75], v[92:93] op_sel_hi:[1,0] neg_lo:[0,1] neg_hi:[0,1]
  v_pk_add_f32 v[76:77], v[76:77], v[92:93] op_sel_hi:[1,0] neg_lo:[0,1] neg_hi:[0,1]
  v_pk_add_f32 v[78:79], v[78:79], v[92:93] op_sel_hi:[1,0] neg_lo:[0,1] neg_hi:[0,1]
  v_pk_add_f32 v[80:81], v[80:81], v[92:93] op_sel_hi:[1,0] neg_lo:[0,1] neg_hi:[0,1]
  v_pk_add_f32 v[82:83], v[82:83], v[92:93] op_sel_hi:[1,0] neg_lo:[0,1] neg_hi:[0,1]
  v_pk_add_f32 v[84:85], v[84:85], v[92:93] op_sel_hi:[1,0] neg_lo:[0,1] neg_hi:[0,1]
  v_pk_add_f32 v[86:87], v[86:87], v[92:93] op_sel_hi:[1,0] neg_lo:[0,1] neg_hi:[0,1]
  v_mov_b32 v104, 0
  v_mov_b32 v105, 0
  v_cvt_pk_bf16_f32 v8, v48, v49
  v_cvt_pk_bf16_f32 v9, v50, v51
  v_cvt_pk_bf16_f32 v10, v52, v53
  v_cvt_pk_bf16_f32 v11, v54, v55
  v_cvt_pk_bf16_f32 v12, v56, v57
  v_cvt_pk_bf16_f32 v13, v58, v59
  v_cvt_pk_bf16_f32 v14, v60, v61
  v_cvt_pk_bf16_f32 v15, v62, v63
  v_cvt_pk_bf16_f32 v16, v64, v65
  v_cvt_pk_bf16_f32 v17, v66, v67
  v_cvt_pk_bf16_f32 v18, v68, v69
  v_cvt_pk_bf16_f32 v19, v70, v71
  v_cvt_pk_bf16_f32 v20, v72, v73
  v_cvt_pk_bf16_f32 v21, v74, v75
  v_cvt_pk_bf16_f32 v22, v76, v77
  v_cvt_pk_bf16_f32 v23, v78, v79
  v_cvt_pk_bf16_f32 v24, v80, v81
  v_cvt_pk_bf16_f32 v25, v82, v83
  v_cvt_pk_bf16_f32 v26, v84, v85
  v_cvt_pk_bf16_f32 v27, v86, v87
  v_lshlrev_b32 v48, 16, v8
  v_and_b32 v49, s56, v8
  v_lshlrev_b32 v50, 16, v9
  v_and_b32 v51, s56, v9
  v_lshlrev_b32 v52, 16, v10
  v_and_b32 v53, s56, v10
  v_lshlrev_b32 v54, 16, v11
  v_and_b32 v55, s56, v11
  v_lshlrev_b32 v56, 16, v12
  v_and_b32 v57, s56, v12
  v_lshlrev_b32 v58, 16, v13
  v_and_b32 v59, s56, v13
  v_lshlrev_b32 v60, 16, v14
  v_and_b32 v61, s56, v14
  v_lshlrev_b32 v62, 16, v15
  v_and_b32 v63, s56, v15
  v_lshlrev_b32 v64, 16, v16
  v_and_b32 v65, s56, v16
  v_lshlrev_b32 v66, 16, v17
  v_and_b32 v67, s56, v17
  v_lshlrev_b32 v68, 16, v18
  v_and_b32 v69, s56, v18
  v_lshlrev_b32 v70, 16, v19
  v_and_b32 v71, s56, v19
  v_lshlrev_b32 v72, 16, v20
  v_and_b32 v73, s56, v20
  v_lshlrev_b32 v74, 16, v21
  v_and_b32 v75, s56, v21
  v_lshlrev_b32 v76, 16, v22
  v_and_b32 v77, s56, v22
  v_lshlrev_b32 v78, 16, v23
  v_and_b32 v79, s56, v23
  v_lshlrev_b32 v80, 16, v24
  v_and_b32 v81, s56, v24
  v_lshlrev_b32 v82, 16, v25
  v_and_b32 v83, s56, v25
  v_lshlrev_b32 v84, 16, v26
  v_and_b32 v85, s56, v26
  v_lshlrev_b32 v86, 16, v27
  v_and_b32 v87, s56, v27
  v_pk_mul_f32 v[48:49], v[48:49], v[100:101] op_sel_hi:[1,0]
  v_pk_mul_f32 v[50:51], v[50:51], v[100:101] op_sel_hi:[1,0]
  v_pk_mul_f32 v[52:53], v[52:53], v[100:101] op_sel_hi:[1,0]
  v_pk_mul_f32 v[54:55], v[54:55], v[100:101] op_sel_hi:[1,0]
  v_cvt_pk_bf16_f32 v8, v48, v49
  v_cvt_pk_bf16_f32 v9, v50, v51
  v_cvt_pk_bf16_f32 v10, v52, v53
  v_cvt_pk_bf16_f32 v11, v54, v55
  buffer_store_dwordx4 v[8:11], v5, s[24:27], s53 offen sc1
  s_add_u32 s53, s53, 16384
  v_pk_mul_f32 v[56:57], v[56:57], v[100:101] op_sel_hi:[1,0]
  v_pk_mul_f32 v[58:59], v[58:59], v[100:101] op_sel_hi:[1,0]
  v_pk_mul_f32 v[60:61], v[60:61], v[100:101] op_sel_hi:[1,0]
  v_pk_mul_f32 v[62:63], v[62:63], v[100:101] op_sel_hi:[1,0]
  v_cvt_pk_bf16_f32 v12, v56, v57
  v_cvt_pk_bf16_f32 v13, v58, v59
  v_cvt_pk_bf16_f32 v14, v60, v61
  v_cvt_pk_bf16_f32 v15, v62, v63
  buffer_store_dwordx4 v[12:15], v5, s[24:27], s53 offen sc1
  s_add_u32 s53, s53, 16384
  v_pk_mul_f32 v[64:65], v[64:65], v[100:101] op_sel_hi:[1,0]
  v_pk_mul_f32 v[66:67], v[66:67], v[100:101] op_sel_hi:[1,0]
  v_pk_mul_f32 v[68:69], v[68:69], v[100:101] op_sel_hi:[1,0]
  v_pk_mul_f32 v[70:71], v[70:71], v[100:101] op_sel_hi:[1,0]
  v_cvt_pk_bf16_f32 v16, v64, v65
  v_cvt_pk_bf16_f32 v17, v66, v67
  v_cvt_pk_bf16_f32 v18, v68, v69
  v_cvt_pk_bf16_f32 v19, v70, v71
  buffer_store_dwordx4 v[16:19], v5, s[24:27], s53 offen sc1
  s_add_u32 s53, s53, 16384
  v_pk_mul_f32 v[72:73], v[72:73], v[100:101] op_sel_hi:[1,0]
  v_pk_mul_f32 v[74:75], v[74:75], v[100:101] op_sel_hi:[1,0]
  v_pk_mul_f32 v[76:77], v[76:77], v[100:101] op_sel_hi:[1,0]
  v_pk_mul_f32 v[78:79], v[78:79], v[100:101] op_sel_hi:[1,0]
  v_cvt_pk_bf16_f32 v20, v72, v73
  v_cvt_pk_bf16_f32 v21, v74, v75
  v_cvt_pk_bf16_f32 v22, v76, v77
  v_cvt_pk_bf16_f32 v23, v78, v79
  buffer_store_dwordx4 v[20:23], v5, s[24:27], s53 offen sc1
  s_add_u32 s53, s53, 16384
  v_pk_mul_f32 v[80:81], v[80:81], v[100:101] op_sel_hi:[1,0]
  v_pk_mul_f32 v[82:83], v[82:83], v[100:101] op_sel_hi:[1,0]
  v_pk_mul_f32 v[84:85], v[84:85], v[100:101] op_sel_hi:[1,0]
  v_pk_mul_f32 v[86:87], v[86:87], v[100:101] op_sel_hi:[1,0]
  v_cvt_pk_bf16_f32 v24, v80, v81
  v_cvt_pk_bf16_f32 v25, v82, v83
  v_cvt_pk_bf16_f32 v26, v84, v85
  v_cvt_pk_bf16_f32 v27, v86, v87
  buffer_store_dwordx4 v[24:27], v5, s[24:27], s53 offen sc1
  s_add_u32 s53, s53, 16384
  s_waitcnt vmcnt(12)
  v_dot2_f32_bf16 v104, v8, v28, v104
  v_dot2_f32_bf16 v105, v9, v29, v105
  v_dot2_f32_bf16 v104, v10, v30, v104
  v_dot2_f32_bf16 v105, v11, v31, v105
  s_waitcnt vmcnt(11)
  v_dot2_f32_bf16 v104, v12, v32, v104
  v_dot2_f32_bf16 v105, v13, v33, v105
  v_dot2_f32_bf16 v104, v14, v34, v104
  v_dot2_f32_bf16 v105, v15, v35, v105
  s_waitcnt vmcnt(10)
  v_dot2_f32_bf16 v104, v16, v36, v104
  v_dot2_f32_bf16 v105, v17, v37, v105
  v_dot2_f32_bf16 v104, v18, v38, v104
  v_dot2_f32_bf16 v105, v19, v39, v105
  s_waitcnt vmcnt(9)
  v_dot2_f32_bf16 v104, v20, v40, v104
  v_dot2_f32_bf16 v105, v21, v41, v105
  v_dot2_f32_bf16 v104, v22, v42, v104
  v_dot2_f32_bf16 v105, v23, v43, v105
  s_waitcnt vmcnt(8)
  v_dot2_f32_bf16 v104, v24, v44, v104
  v_dot2_f32_bf16 v105, v25, v45, v105
  v_dot2_f32_bf16 v104, v26, v46, v104
  v_dot2_f32_bf16 v105, v27, v47, v105
  s_nop 2
  v_add_f32 v104, v104, v105
  s_nop 1
  v_add_f32_dpp v104, v104, v104 row_ror:8 row_mask:0xf bank_mask:0xf
  s_nop 1
  v_add_f32_dpp v104, v104, v104 row_ror:4 row_mask:0xf bank_mask:0xf
  s_nop 1
  v_add_f32_dpp v104, v104, v104 row_ror:2 row_mask:0xf bank_mask:0xf
  s_nop 1
  v_add_f32_dpp v104, v104, v104 row_ror:1 row_mask:0xf bank_mask:0xf
  v_cvt_pk_bf16_f32 v104, v104, v104
  v_lshlrev_b32 v104, 16, v104
  v_ashrrev_i32 v105, 31, v104
  v_or_b32 v105, 0x80000000, v105
  v_xor_b32 v104, v104, v105
  v_and_b32 v104, s56, v104
  v_add_u32 v6, s52, v1
  v_sub_u32 v7, 0xffff, v6
  v_or_b32 v104, v104, v7
  v_lshlrev_b32 v6, 2, v6
  v_lshl_add_u32 v6, v2, 26, v6
  s_mov_b32 s53, 2621440
  buffer_store_dword v104, v6, s[24:27], s53 offen sc1
  s_waitcnt vmcnt(0)
  s_branch front_join
front_fetch:
  s_getpc_b64 s[98:99]
attn_hot_pc:
  s_add_u32 s98, s98, attn_hot-attn_hot_pc
  s_addc_u32 s99, s99, 0
  s_lshr_b32 s100, s2, 3
  v_min_u32 v249, 17, v0
  v_lshlrev_b32 v249, 5, v249
  v_add_u32 v249, s100, v249
  v_lshlrev_b32 v249, 7, v249
  v_min_u32 v249, attn_end-attn_hot-4, v249
  global_load_dword v255, v249, s[98:99]
attn_hot:
  v_subrev_u32 v16, 0x40000, v238
  v_subrev_u32 v17, 0x40000, v239
  v_subrev_u32 v18, 0x40000, v240
  v_subrev_u32 v19, 0x40000, v241
  s_mov_b32 s31, 0
  s_add_u32 m0, s28, 90112
  s_nop 0
  buffer_load_dwordx4 v16, s[20:23], s31 offen offset:0 lds
  buffer_load_dwordx4 v17, s[20:23], s31 offen offset:1024 lds
  buffer_load_dwordx4 v18, s[20:23], s31 offen offset:2048 lds
  buffer_load_dwordx4 v19, s[20:23], s31 offen offset:3072 lds
  s_add_u32 m0, s28, 98304
  s_nop 0
  buffer_load_dwordx4 v238, s[20:23], s31 offen offset:0 lds
  buffer_load_dwordx4 v239, s[20:23], s31 offen offset:1024 lds
  buffer_load_dwordx4 v240, s[20:23], s31 offen offset:2048 lds
  buffer_load_dwordx4 v241, s[20:23], s31 offen offset:3072 lds
front_join:
  s_waitcnt lgkmcnt(0)
  s_barrier
  s_mul_i32 s55, s59, 0x9e3779b1
  s_add_u32 s55, s55, 0x7f4a7c15
  s_bfe_u32 s58, s2, 0x30003
  s_lshl_b32 s58, s58, 8
  s_add_u32 s58, s58, 2826240
  s_lshl_b32 s53, s36, 2
  s_lshl_b32 s54, s3, 26
  s_add_u32 s53, s53, s54
  v_min_u32 v1, 1, v0
  v_lshlrev_b32 v1, 28, v1
  v_add_u32 v1, s53, v1
  v_mov_b32 v2, s55
  buffer_store_dword v2, v1, s[24:27], s58 offen sc1
  s_cmp_lt_u32 s3, 2
  s_cbranch_scc1 front_addr
  s_mov_b32 s31, 524288
  s_add_u32 m0, s28, 106496
  s_nop 0
  buffer_load_dwordx4 v16, s[20:23], s31 offen offset:0 lds
  buffer_load_dwordx4 v17, s[20:23], s31 offen offset:1024 lds
  buffer_load_dwordx4 v18, s[20:23], s31 offen offset:2048 lds
  buffer_load_dwordx4 v19, s[20:23], s31 offen offset:3072 lds
  s_add_u32 m0, s28, 114688
  s_nop 0
  buffer_load_dwordx4 v238, s[20:23], s31 offen offset:0 lds
  buffer_load_dwordx4 v239, s[20:23], s31 offen offset:1024 lds
  buffer_load_dwordx4 v240, s[20:23], s31 offen offset:2048 lds
  buffer_load_dwordx4 v241, s[20:23], s31 offen offset:3072 lds
  s_mov_b32 s31, 1048576
  s_add_u32 m0, s28, 24576
  s_nop 0
  buffer_load_dwordx4 v16, s[20:23], s31 offen offset:0 lds
  buffer_load_dwordx4 v17, s[20:23], s31 offen offset:1024 lds
  buffer_load_dwordx4 v18, s[20:23], s31 offen offset:2048 lds
  buffer_load_dwordx4 v19, s[20:23], s31 offen offset:3072 lds
  s_add_u32 m0, s28, 32768
  s_nop 0
  buffer_load_dwordx4 v238, s[20:23], s31 offen offset:0 lds
  buffer_load_dwordx4 v239, s[20:23], s31 offen offset:1024 lds
  buffer_load_dwordx4 v240, s[20:23], s31 offen offset:2048 lds
  buffer_load_dwordx4 v241, s[20:23], s31 offen offset:3072 lds
  s_mov_b32 s31, 1572864
  s_add_u32 m0, s28, 40960
  s_nop 0
  buffer_load_dwordx4 v16, s[20:23], s31 offen offset:0 lds
  buffer_load_dwordx4 v17, s[20:23], s31 offen offset:1024 lds
  buffer_load_dwordx4 v18, s[20:23], s31 offen offset:2048 lds
  buffer_load_dwordx4 v19, s[20:23], s31 offen offset:3072 lds
  s_add_u32 m0, s28, 49152
  s_nop 0
  buffer_load_dwordx4 v238, s[20:23], s31 offen offset:0 lds
  buffer_load_dwordx4 v239, s[20:23], s31 offen offset:1024 lds
  buffer_load_dwordx4 v240, s[20:23], s31 offen offset:2048 lds
  buffer_load_dwordx4 v241, s[20:23], s31 offen offset:3072 lds
front_addr:
  s_mov_b32 s31, 2097152
  v_lshlrev_b32 v242, 4, v245
  v_add_u32 v243, 0x1000, v242
  s_mul_i32 s30, s37, 81920
  s_lshl_b32 s38, s36, 19
  s_add_u32 s12, s4, s38
  s_addc_u32 s13, s5, 0
  s_mov_b32 s14, 524288
  s_mov_b32 s15, 0x20000
  s_add_u32 s16, s6, s38
  s_addc_u32 s17, s7, 0
  s_mov_b32 s18, 524288
  s_mov_b32 s19, 0x20000
  v_lshlrev_b32 v249, 8, v248
  v_add_u32 v249, s28, v249
  v_add_u32 v250, 0, v248
  v_xor_b32 v250, v250, v247
  v_lshl_add_u32 v232, v250, 4, v249
  v_add_u32 v250, 4, v248
  v_xor_b32 v250, v250, v247
  v_lshl_add_u32 v233, v250, 4, v249
  v_add_u32 v250, 8, v248
  v_xor_b32 v250, v250, v247
  v_lshl_add_u32 v234, v250, 4, v249
  v_add_u32 v250, 12, v248
  v_xor_b32 v250, v250, v247
  v_lshl_add_u32 v235, v250, 4, v249
  v_add_u32 v250, 0, v248
  v_lshlrev_b32 v250, 1, v250
  v_xor_b32 v250, v250, v247
  v_lshl_add_u32 v236, v250, 4, v249
  v_add_u32 v250, 4, v248
  v_lshlrev_b32 v250, 1, v250
  v_xor_b32 v250, v250, v247
  v_lshl_add_u32 v237, v250, 4, v249
  v_lshrrev_b32 v249, 1, v248
  v_and_b32 v250, 1, v248
  v_lshl_or_b32 v249, v250, 1, v249
  v_xor_b32 v249, v249, v247
  v_lshlrev_b32 v249, 4, v249
  v_lshl_add_u32 v212, v247, 8, v249
  v_xor_b32 v213, 64, v212
  v_xor_b32 v214, 128, v212
  v_xor_b32 v215, 192, v212
  v_bfe_u32 v246, v245, 2, 2
  v_and_b32 v247, 3, v245
  v_lshlrev_b32 v247, 3, v247
  v_add_u32 v247, 65536, v247
  v_lshl_add_u32 v249, v248, 2, v246
  v_and_b32 v250, 7, v249
  v_lshl_add_u32 v250, v250, 5, v247
  v_lshl_add_u32 v216, v249, 8, v250
  v_lshl_add_u32 v249, v248, 3, v246
  v_and_b32 v250, 1, v248
  v_lshl_add_u32 v250, v250, 2, v246
  v_lshl_add_u32 v250, v250, 5, v247
  v_lshl_add_u32 v224, v249, 8, v250
  v_xor_b32 v217, 32, v216
  v_xor_b32 v225, 32, v224
  v_xor_b32 v218, 64, v216
  v_xor_b32 v226, 64, v224
  v_xor_b32 v219, 96, v216
  v_xor_b32 v227, 96, v224
  v_xor_b32 v220, 128, v216
  v_xor_b32 v228, 128, v224
  v_xor_b32 v221, 160, v216
  v_xor_b32 v229, 160, v224
  v_xor_b32 v222, 192, v216
  v_xor_b32 v230, 192, v224
  v_xor_b32 v223, 224, v216
  v_xor_b32 v231, 224, v224
  v_subrev_u32 v144, 65536, v224
  v_subrev_u32 v145, 65536, v225
  v_subrev_u32 v146, 65536, v226
  v_subrev_u32 v147, 65536, v227
  v_subrev_u32 v148, 65536, v228
  v_subrev_u32 v149, 65536, v229
  v_subrev_u32 v150, 65536, v230
  v_subrev_u32 v151, 65536, v231
  s_lshr_b32 s38, s2, 3
  s_min_u32 s38, s38, 26
  s_and_b32 s39, s2, 7
  s_mul_i32 s39, s39, 27
  s_add_u32 s33, s38, s39
  s_mul_i32 s50, s3, 6144
  s_add_u32 s50, s50, 133120
  v_mov_b32 v244, v242
  s_lshl_b32 s40, s37, 19
  s_lshl_b32 s38, s36, 14
  s_add_u32 s40, s40, s38
  s_add_u32 s40, s40, 8388608
  s_add_u32 s41, s40, 4096
  s_add_u32 s42, s40, 8192
  s_add_u32 s43, s40, 12288
  s_mov_b32 s34, 0x3e0293ee
  s_mov_b32 s29, 0
  v_and_b32 v249, 15, v245
  v_cmp_eq_u32 vcc, 0, v249
  v_mov_b32 v249, 0x3f803f80
  s_nop 0
  v_cndmask_b32 v249, 0, v249, vcc
  v_accvgpr_write_b32 a208, v249
  v_accvgpr_write_b32 a209, v249
  v_accvgpr_write_b32 a210, v249
  v_accvgpr_write_b32 a211, v249
  v_and_b32 v2, 7, v0
  v_lshlrev_b32 v2, 2, v2
  s_lshl_b32 s54, s3, 5
  v_add_u32 v2, s54, v2
  s_mov_b32 s54, 32768
  buffer_load_dword v3, v2, s[24:27], s58 offen sc1
  s_sleep 2
  buffer_load_dword v4, v2, s[24:27], s58 offen sc1
  s_sleep 2
  buffer_load_dword v5, v2, s[24:27], s58 offen sc1
  s_sleep 2
front_poll:
  buffer_load_dword v6, v2, s[24:27], s58 offen sc1
  s_waitcnt vmcnt(3)
  v_cmp_ne_u32 vcc, s55, v3
  s_nop 0
  s_cbranch_vccz front_go
  s_sleep 2
  buffer_load_dword v3, v2, s[24:27], s58 offen sc1
  s_waitcnt vmcnt(3)
  v_cmp_ne_u32 vcc, s55, v4
  s_nop 0
  s_cbranch_vccz front_go
  s_sleep 2
  buffer_load_dword v4, v2, s[24:27], s58 offen sc1
  s_waitcnt vmcnt(3)
  v_cmp_ne_u32 vcc, s55, v5
  s_nop 0
  s_cbranch_vccz front_go
  s_sleep 2
  buffer_load_dword v5, v2, s[24:27], s58 offen sc1
  s_waitcnt vmcnt(3)
  v_cmp_ne_u32 vcc, s55, v6
  s_nop 0
  s_cbranch_vccz front_go
  s_sleep 2
  s_sub_u32 s54, s54, 1
  s_cmp_lg_u32 s54, 0
  s_cbranch_scc1 front_poll
front_go:
  buffer_load_dwordx4 a[0:3], v242, s[24:27], s30 offen offset:0 sc1
  buffer_load_dwordx4 a[4:7], v242, s[24:27], s30 offen offset:1024 sc1
  buffer_load_dwordx4 a[8:11], v242, s[24:27], s30 offen offset:2048 sc1
  buffer_load_dwordx4 a[12:15], v242, s[24:27], s30 offen offset:3072 sc1
  buffer_load_dwordx4 a[16:19], v243, s[24:27], s30 offen offset:0 sc1
  buffer_load_dwordx4 a[20:23], v243, s[24:27], s30 offen offset:1024 sc1
  buffer_load_dwordx4 a[24:27], v243, s[24:27], s30 offen offset:2048 sc1
  buffer_load_dwordx4 a[28:31], v243, s[24:27], s30 offen offset:3072 sc1
  s_add_u32 s30, s30, 8192
  buffer_load_dwordx4 a[32:35], v242, s[24:27], s30 offen offset:0 sc1
  buffer_load_dwordx4 a[36:39], v242, s[24:27], s30 offen offset:1024 sc1
  buffer_load_dwordx4 a[40:43], v242, s[24:27], s30 offen offset:2048 sc1
  buffer_load_dwordx4 a[44:47], v242, s[24:27], s30 offen offset:3072 sc1
  buffer_load_dwordx4 a[48:51], v243, s[24:27], s30 offen offset:0 sc1
  buffer_load_dwordx4 a[52:55], v243, s[24:27], s30 offen offset:1024 sc1
  buffer_load_dwordx4 a[56:59], v243, s[24:27], s30 offen offset:2048 sc1
  buffer_load_dwordx4 a[60:63], v243, s[24:27], s30 offen offset:3072 sc1
  s_add_u32 s30, s30, 8192
  v_lshrrev_b32 v140, 7, v242
  v_lshlrev_b32 v140, 8, v140
  v_and_b32 v136, 0x70, v242
  v_add_u32 v140, v140, v136
  s_mov_b32 s58, 2826240
  buffer_load_dwordx4 v[136:139], v140, s[24:27], s58 offen sc1
  s_barrier
  ds_read_b64_tr_b16 a[160:161], v224 offset:32768
  ds_read_b64_tr_b16 a[162:163], v224 offset:33792
  ds_read_b64_tr_b16 a[164:165], v224 offset:40960
  ds_read_b64_tr_b16 a[166:167], v224 offset:41984
  ds_read_b64_tr_b16 a[168:169], v225 offset:32768
  ds_read_b64_tr_b16 a[170:171], v225 offset:33792
  ds_read_b64_tr_b16 a[172:173], v225 offset:40960
  ds_read_b64_tr_b16 a[174:175], v225 offset:41984
  s_waitcnt vmcnt(9) lgkmcnt(4)
  v_mfma_f32_16x16x32_bf16 v[0:3], a[160:163], a[0:3], 0
  ds_read_b64_tr_b16 a[176:177], v226 offset:32768
  v_mfma_f32_16x16x32_bf16 v[0:3], a[164:167], a[16:19], v[0:3]
  buffer_load_dwordx4 a[64:67], v242, s[24:27], s30 offen offset:0 sc1
  v_mfma_f32_16x16x32_bf16 v[4:7], a[164:167], a[20:23], 0
  ds_read_b64_tr_b16 a[178:179], v226 offset:33792
  v_mfma_f32_16x16x32_bf16 v[4:7], a[160:163], a[4:7], v[4:7]
  buffer_load_dwordx4 a[68:71], v242, s[24:27], s30 offen offset:1024 sc1
  v_mfma_f32_16x16x32_bf16 v[8:11], a[160:163], a[8:11], 0
  ds_read_b64_tr_b16 a[180:181], v226 offset:40960
  v_mfma_f32_16x16x32_bf16 v[8:11], a[164:167], a[24:27], v[8:11]
  v_mfma_f32_16x16x32_bf16 v[12:15], a[164:167], a[28:31], 0
  ds_read_b64_tr_b16 a[182:183], v226 offset:41984
  v_mfma_f32_16x16x32_bf16 v[12:15], a[160:163], a[12:15], v[12:15]
  s_waitcnt lgkmcnt(4)
  buffer_load_dwordx4 a[72:75], v242, s[24:27], s30 offen offset:2048 sc1
  v_mfma_f32_16x16x32_bf16 v[16:19], a[168:171], a[0:3], 0
  ds_read_b64_tr_b16 a[184:185], v227 offset:32768
  v_mfma_f32_16x16x32_bf16 v[16:19], a[172:175], a[16:19], v[16:19]
  v_mfma_f32_16x16x32_bf16 v[20:23], a[172:175], a[20:23], 0
  ds_read_b64_tr_b16 a[186:187], v227 offset:33792
  v_mfma_f32_16x16x32_bf16 v[20:23], a[168:171], a[4:7], v[20:23]
  buffer_load_dwordx4 a[76:79], v242, s[24:27], s30 offen offset:3072 sc1
  v_mfma_f32_16x16x32_bf16 v[24:27], a[168:171], a[8:11], 0
  ds_read_b64_tr_b16 a[188:189], v227 offset:40960
  v_mfma_f32_16x16x32_bf16 v[24:27], a[172:175], a[24:27], v[24:27]
  buffer_load_dwordx4 a[80:83], v243, s[24:27], s30 offen offset:0 sc1
  v_mfma_f32_16x16x32_bf16 v[28:31], a[172:175], a[28:31], 0
  ds_read_b64_tr_b16 a[190:191], v227 offset:41984
  v_mfma_f32_16x16x32_bf16 v[28:31], a[168:171], a[12:15], v[28:31]
  s_waitcnt lgkmcnt(4)
  v_mfma_f32_16x16x32_bf16 v[32:35], a[176:179], a[0:3], 0
  ds_read_b64_tr_b16 a[160:161], v228 offset:32768
  v_mfma_f32_16x16x32_bf16 v[32:35], a[180:183], a[16:19], v[32:35]
  buffer_load_dwordx4 a[84:87], v243, s[24:27], s30 offen offset:1024 sc1
  v_mfma_f32_16x16x32_bf16 v[36:39], a[180:183], a[20:23], 0
  ds_read_b64_tr_b16 a[162:163], v228 offset:33792
  v_mfma_f32_16x16x32_bf16 v[36:39], a[176:179], a[4:7], v[36:39]
  v_mfma_f32_16x16x32_bf16 v[40:43], a[176:179], a[8:11], 0
  ds_read_b64_tr_b16 a[164:165], v228 offset:40960
  v_mfma_f32_16x16x32_bf16 v[40:43], a[180:183], a[24:27], v[40:43]
  buffer_load_dwordx4 a[88:91], v243, s[24:27], s30 offen offset:2048 sc1
  v_mfma_f32_16x16x32_bf16 v[44:47], a[180:183], a[28:31], 0
  ds_read_b64_tr_b16 a[166:167], v228 offset:41984
  v_mfma_f32_16x16x32_bf16 v[44:47], a[176:179], a[12:15], v[44:47]
  s_waitcnt lgkmcnt(4)
  buffer_load_dwordx4 a[92:95], v243, s[24:27], s30 offen offset:3072 sc1
  v_mfma_f32_16x16x32_bf16 v[48:51], a[184:187], a[0:3], 0
  ds_read_b64_tr_b16 a[168:169], v229 offset:32768
  v_mfma_f32_16x16x32_bf16 v[48:51], a[188:191], a[16:19], v[48:51]
  v_mfma_f32_16x16x32_bf16 v[52:55], a[188:191], a[20:23], 0
  ds_read_b64_tr_b16 a[170:171], v229 offset:33792
  v_mfma_f32_16x16x32_bf16 v[52:55], a[184:187], a[4:7], v[52:55]
  s_add_u32 s30, s30, 8192
  v_mfma_f32_16x16x32_bf16 v[56:59], a[184:187], a[8:11], 0
  ds_read_b64_tr_b16 a[172:173], v229 offset:40960
  v_mfma_f32_16x16x32_bf16 v[56:59], a[188:191], a[24:27], v[56:59]
  v_mfma_f32_16x16x32_bf16 v[60:63], a[188:191], a[28:31], 0
  ds_read_b64_tr_b16 a[174:175], v229 offset:41984
  v_mfma_f32_16x16x32_bf16 v[60:63], a[184:187], a[12:15], v[60:63]
  s_waitcnt lgkmcnt(4)
  buffer_load_dwordx4 a[96:99], v242, s[24:27], s30 offen offset:0 sc1
  v_mfma_f32_16x16x32_bf16 v[64:67], a[160:163], a[0:3], 0
  ds_read_b64_tr_b16 a[176:177], v230 offset:32768
  v_mfma_f32_16x16x32_bf16 v[64:67], a[164:167], a[16:19], v[64:67]
  buffer_load_dwordx4 a[100:103], v242, s[24:27], s30 offen offset:1024 sc1
  v_mfma_f32_16x16x32_bf16 v[68:71], a[164:167], a[20:23], 0
  ds_read_b64_tr_b16 a[178:179], v230 offset:33792
  v_mfma_f32_16x16x32_bf16 v[68:71], a[160:163], a[4:7], v[68:71]
  v_mfma_f32_16x16x32_bf16 v[72:75], a[160:163], a[8:11], 0
  ds_read_b64_tr_b16 a[180:181], v230 offset:40960
  v_mfma_f32_16x16x32_bf16 v[72:75], a[164:167], a[24:27], v[72:75]
  buffer_load_dwordx4 a[104:107], v242, s[24:27], s30 offen offset:2048 sc1
  v_mfma_f32_16x16x32_bf16 v[76:79], a[164:167], a[28:31], 0
  ds_read_b64_tr_b16 a[182:183], v230 offset:41984
  v_mfma_f32_16x16x32_bf16 v[76:79], a[160:163], a[12:15], v[76:79]
  s_waitcnt lgkmcnt(4)
  v_mfma_f32_16x16x32_bf16 v[80:83], a[168:171], a[0:3], 0
  ds_read_b64_tr_b16 a[184:185], v231 offset:32768
  v_mfma_f32_16x16x32_bf16 v[80:83], a[172:175], a[16:19], v[80:83]
  buffer_load_dwordx4 a[108:111], v242, s[24:27], s30 offen offset:3072 sc1
  v_mfma_f32_16x16x32_bf16 v[84:87], a[172:175], a[20:23], 0
  ds_read_b64_tr_b16 a[186:187], v231 offset:33792
  v_mfma_f32_16x16x32_bf16 v[84:87], a[168:171], a[4:7], v[84:87]
  buffer_load_dwordx4 a[112:115], v243, s[24:27], s30 offen offset:0 sc1
  v_mfma_f32_16x16x32_bf16 v[88:91], a[168:171], a[8:11], 0
  ds_read_b64_tr_b16 a[188:189], v231 offset:40960
  v_mfma_f32_16x16x32_bf16 v[88:91], a[172:175], a[24:27], v[88:91]
  s_barrier
  v_mfma_f32_16x16x32_bf16 v[92:95], a[172:175], a[28:31], 0
  ds_read_b64_tr_b16 a[190:191], v231 offset:41984
  v_mfma_f32_16x16x32_bf16 v[92:95], a[168:171], a[12:15], v[92:95]
  s_waitcnt lgkmcnt(4)
  buffer_load_dwordx4 a[116:119], v243, s[24:27], s30 offen offset:1024 sc1
  v_mfma_f32_16x16x32_bf16 v[96:99], a[176:179], a[0:3], 0
  ds_read_b64_tr_b16 a[160:161], v224 offset:49152
  v_mfma_f32_16x16x32_bf16 v[96:99], a[180:183], a[16:19], v[96:99]
  v_mfma_f32_16x16x32_bf16 v[100:103], a[180:183], a[20:23], 0
  ds_read_b64_tr_b16 a[162:163], v224 offset:50176
  v_mfma_f32_16x16x32_bf16 v[100:103], a[176:179], a[4:7], v[100:103]
  buffer_load_dwordx4 a[120:123], v243, s[24:27], s30 offen offset:2048 sc1
  v_mfma_f32_16x16x32_bf16 v[104:107], a[176:179], a[8:11], 0
  ds_read_b64_tr_b16 a[164:165], v224 offset:57344
  v_mfma_f32_16x16x32_bf16 v[104:107], a[180:183], a[24:27], v[104:107]
  buffer_load_dwordx4 a[124:127], v243, s[24:27], s30 offen offset:3072 sc1
  v_mfma_f32_16x16x32_bf16 v[108:111], a[180:183], a[28:31], 0
  ds_read_b64_tr_b16 a[166:167], v224 offset:58368
  v_mfma_f32_16x16x32_bf16 v[108:111], a[176:179], a[12:15], v[108:111]
  s_waitcnt lgkmcnt(4)
  v_mfma_f32_16x16x32_bf16 v[112:115], a[184:187], a[0:3], 0
  ds_read_b64_tr_b16 a[168:169], v225 offset:49152
  v_mfma_f32_16x16x32_bf16 v[112:115], a[188:191], a[16:19], v[112:115]
  s_add_u32 s30, s30, 8192
  v_mfma_f32_16x16x32_bf16 v[116:119], a[188:191], a[20:23], 0
  ds_read_b64_tr_b16 a[170:171], v225 offset:50176
  v_mfma_f32_16x16x32_bf16 v[116:119], a[184:187], a[4:7], v[116:119]
  v_mfma_f32_16x16x32_bf16 v[120:123], a[184:187], a[8:11], 0
  ds_read_b64_tr_b16 a[172:173], v225 offset:57344
  v_mfma_f32_16x16x32_bf16 v[120:123], a[188:191], a[24:27], v[120:123]
  v_mfma_f32_16x16x32_bf16 v[124:127], a[188:191], a[28:31], 0
  ds_read_b64_tr_b16 a[174:175], v225 offset:58368
  v_mfma_f32_16x16x32_bf16 v[124:127], a[184:187], a[12:15], v[124:127]
  s_waitcnt vmcnt(17) lgkmcnt(4)
  v_mfma_f32_16x16x32_bf16 v[0:3], a[160:163], a[32:35], v[0:3]
  ds_read_b64_tr_b16 a[176:177], v226 offset:49152
  v_mfma_f32_16x16x32_bf16 v[0:3], a[164:167], a[48:51], v[0:3]
  buffer_load_dwordx4 a[0:3], v242, s[24:27], s30 offen offset:0 sc1
  v_mfma_f32_16x16x32_bf16 v[4:7], a[164:167], a[52:55], v[4:7]
  ds_read_b64_tr_b16 a[178:179], v226 offset:50176
  v_mfma_f32_16x16x32_bf16 v[4:7], a[160:163], a[36:39], v[4:7]
  v_mfma_f32_16x16x32_bf16 v[8:11], a[160:163], a[40:43], v[8:11]
  ds_read_b64_tr_b16 a[180:181], v226 offset:57344
  s_add_u32 m0, s28, 16384
  v_mfma_f32_16x16x32_bf16 v[8:11], a[164:167], a[56:59], v[8:11]
  buffer_load_dwordx4 v238, s[20:23], s31 offen offset:0 lds
  v_mfma_f32_16x16x32_bf16 v[12:15], a[164:167], a[60:63], v[12:15]
  ds_read_b64_tr_b16 a[182:183], v226 offset:58368
  v_mfma_f32_16x16x32_bf16 v[12:15], a[160:163], a[44:47], v[12:15]
  s_waitcnt lgkmcnt(4)
  v_mfma_f32_16x16x32_bf16 v[16:19], a[168:171], a[32:35], v[16:19]
  ds_read_b64_tr_b16 a[184:185], v227 offset:49152
  v_mfma_f32_16x16x32_bf16 v[16:19], a[172:175], a[48:51], v[16:19]
  buffer_load_dwordx4 a[4:7], v242, s[24:27], s30 offen offset:1024 sc1
  v_mfma_f32_16x16x32_bf16 v[20:23], a[172:175], a[52:55], v[20:23]
  ds_read_b64_tr_b16 a[186:187], v227 offset:50176
  v_mfma_f32_16x16x32_bf16 v[20:23], a[168:171], a[36:39], v[20:23]
  v_mfma_f32_16x16x32_bf16 v[24:27], a[168:171], a[40:43], v[24:27]
  ds_read_b64_tr_b16 a[188:189], v227 offset:57344
  v_mfma_f32_16x16x32_bf16 v[24:27], a[172:175], a[56:59], v[24:27]
  v_mfma_f32_16x16x32_bf16 v[28:31], a[172:175], a[60:63], v[28:31]
  ds_read_b64_tr_b16 a[190:191], v227 offset:58368
  v_mfma_f32_16x16x32_bf16 v[28:31], a[168:171], a[44:47], v[28:31]
  s_waitcnt lgkmcnt(4)
  v_mfma_f32_16x16x32_bf16 v[32:35], a[176:179], a[32:35], v[32:35]
  ds_read_b64_tr_b16 a[160:161], v228 offset:49152
  v_mfma_f32_16x16x32_bf16 v[32:35], a[180:183], a[48:51], v[32:35]
  buffer_load_dwordx4 a[8:11], v242, s[24:27], s30 offen offset:2048 sc1
  v_mfma_f32_16x16x32_bf16 v[36:39], a[180:183], a[52:55], v[36:39]
  ds_read_b64_tr_b16 a[162:163], v228 offset:50176
  v_mfma_f32_16x16x32_bf16 v[36:39], a[176:179], a[36:39], v[36:39]
  v_mfma_f32_16x16x32_bf16 v[40:43], a[176:179], a[40:43], v[40:43]
  ds_read_b64_tr_b16 a[164:165], v228 offset:57344
  v_mfma_f32_16x16x32_bf16 v[40:43], a[180:183], a[56:59], v[40:43]
  buffer_load_dwordx4 v239, s[20:23], s31 offen offset:1024 lds
  v_mfma_f32_16x16x32_bf16 v[44:47], a[180:183], a[60:63], v[44:47]
  ds_read_b64_tr_b16 a[166:167], v228 offset:58368
  v_mfma_f32_16x16x32_bf16 v[44:47], a[176:179], a[44:47], v[44:47]
  s_waitcnt lgkmcnt(4)
  v_mfma_f32_16x16x32_bf16 v[48:51], a[184:187], a[32:35], v[48:51]
  ds_read_b64_tr_b16 a[168:169], v229 offset:49152
  v_mfma_f32_16x16x32_bf16 v[48:51], a[188:191], a[48:51], v[48:51]
  buffer_load_dwordx4 a[12:15], v242, s[24:27], s30 offen offset:3072 sc1
  v_mfma_f32_16x16x32_bf16 v[52:55], a[188:191], a[52:55], v[52:55]
  ds_read_b64_tr_b16 a[170:171], v229 offset:50176
  v_mfma_f32_16x16x32_bf16 v[52:55], a[184:187], a[36:39], v[52:55]
  v_mfma_f32_16x16x32_bf16 v[56:59], a[184:187], a[40:43], v[56:59]
  ds_read_b64_tr_b16 a[172:173], v229 offset:57344
  v_mfma_f32_16x16x32_bf16 v[56:59], a[188:191], a[56:59], v[56:59]
  v_mfma_f32_16x16x32_bf16 v[60:63], a[188:191], a[60:63], v[60:63]
  ds_read_b64_tr_b16 a[174:175], v229 offset:58368
  v_mfma_f32_16x16x32_bf16 v[60:63], a[184:187], a[44:47], v[60:63]
  s_waitcnt lgkmcnt(4)
  v_mfma_f32_16x16x32_bf16 v[64:67], a[160:163], a[32:35], v[64:67]
  ds_read_b64_tr_b16 a[176:177], v230 offset:49152
  v_mfma_f32_16x16x32_bf16 v[64:67], a[164:167], a[48:51], v[64:67]
  buffer_load_dwordx4 a[16:19], v243, s[24:27], s30 offen offset:0 sc1
  v_mfma_f32_16x16x32_bf16 v[68:71], a[164:167], a[52:55], v[68:71]
  ds_read_b64_tr_b16 a[178:179], v230 offset:50176
  v_mfma_f32_16x16x32_bf16 v[68:71], a[160:163], a[36:39], v[68:71]
  v_mfma_f32_16x16x32_bf16 v[72:75], a[160:163], a[40:43], v[72:75]
  ds_read_b64_tr_b16 a[180:181], v230 offset:57344
  v_mfma_f32_16x16x32_bf16 v[72:75], a[164:167], a[56:59], v[72:75]
  buffer_load_dwordx4 v240, s[20:23], s31 offen offset:2048 lds
  v_mfma_f32_16x16x32_bf16 v[76:79], a[164:167], a[60:63], v[76:79]
  ds_read_b64_tr_b16 a[182:183], v230 offset:58368
  v_mfma_f32_16x16x32_bf16 v[76:79], a[160:163], a[44:47], v[76:79]
  s_waitcnt lgkmcnt(4)
  v_mfma_f32_16x16x32_bf16 v[80:83], a[168:171], a[32:35], v[80:83]
  ds_read_b64_tr_b16 a[184:185], v231 offset:49152
  v_mfma_f32_16x16x32_bf16 v[80:83], a[172:175], a[48:51], v[80:83]
  buffer_load_dwordx4 a[20:23], v243, s[24:27], s30 offen offset:1024 sc1
  v_mfma_f32_16x16x32_bf16 v[84:87], a[172:175], a[52:55], v[84:87]
  ds_read_b64_tr_b16 a[186:187], v231 offset:50176
  v_mfma_f32_16x16x32_bf16 v[84:87], a[168:171], a[36:39], v[84:87]
  v_mfma_f32_16x16x32_bf16 v[88:91], a[168:171], a[40:43], v[88:91]
  ds_read_b64_tr_b16 a[188:189], v231 offset:57344
  v_mfma_f32_16x16x32_bf16 v[88:91], a[172:175], a[56:59], v[88:91]
  s_barrier
  v_mfma_f32_16x16x32_bf16 v[92:95], a[172:175], a[60:63], v[92:95]
  ds_read_b64_tr_b16 a[190:191], v231 offset:58368
  v_mfma_f32_16x16x32_bf16 v[92:95], a[168:171], a[44:47], v[92:95]
  s_waitcnt lgkmcnt(4)
  v_mfma_f32_16x16x32_bf16 v[96:99], a[176:179], a[32:35], v[96:99]
  ds_read_b64_tr_b16 a[160:161], v144 offset:32768
  v_mfma_f32_16x16x32_bf16 v[96:99], a[180:183], a[48:51], v[96:99]
  buffer_load_dwordx4 a[24:27], v243, s[24:27], s30 offen offset:2048 sc1
  v_mfma_f32_16x16x32_bf16 v[100:103], a[180:183], a[52:55], v[100:103]
  ds_read_b64_tr_b16 a[162:163], v144 offset:33792
  v_mfma_f32_16x16x32_bf16 v[100:103], a[176:179], a[36:39], v[100:103]
  v_mfma_f32_16x16x32_bf16 v[104:107], a[176:179], a[40:43], v[104:107]
  ds_read_b64_tr_b16 a[164:165], v144 offset:40960
  v_mfma_f32_16x16x32_bf16 v[104:107], a[180:183], a[56:59], v[104:107]
  buffer_load_dwordx4 v241, s[20:23], s31 offen offset:3072 lds
  s_add_u32 s31, s31, 0x80000
  v_mfma_f32_16x16x32_bf16 v[108:111], a[180:183], a[60:63], v[108:111]
  ds_read_b64_tr_b16 a[166:167], v144 offset:41984
  v_mfma_f32_16x16x32_bf16 v[108:111], a[176:179], a[44:47], v[108:111]
  s_waitcnt lgkmcnt(4)
  v_mfma_f32_16x16x32_bf16 v[112:115], a[184:187], a[32:35], v[112:115]
  ds_read_b64_tr_b16 a[168:169], v145 offset:32768
  v_mfma_f32_16x16x32_bf16 v[112:115], a[188:191], a[48:51], v[112:115]
  buffer_load_dwordx4 a[28:31], v243, s[24:27], s30 offen offset:3072 sc1
  s_add_u32 s30, s30, 8192
  v_mfma_f32_16x16x32_bf16 v[116:119], a[188:191], a[52:55], v[116:119]
  ds_read_b64_tr_b16 a[170:171], v145 offset:33792
  v_mfma_f32_16x16x32_bf16 v[116:119], a[184:187], a[36:39], v[116:119]
  v_mfma_f32_16x16x32_bf16 v[120:123], a[184:187], a[40:43], v[120:123]
  ds_read_b64_tr_b16 a[172:173], v145 offset:40960
  v_mfma_f32_16x16x32_bf16 v[120:123], a[188:191], a[56:59], v[120:123]
  v_mfma_f32_16x16x32_bf16 v[124:127], a[188:191], a[60:63], v[124:127]
  ds_read_b64_tr_b16 a[174:175], v145 offset:41984
  v_mfma_f32_16x16x32_bf16 v[124:127], a[184:187], a[44:47], v[124:127]
  s_waitcnt vmcnt(20) lgkmcnt(4)
  v_xor_b32 v136, s55, v136
  v_xor_b32 v137, s55, v137
  v_xor_b32 v138, s55, v138
  v_xor_b32 v139, s55, v139
  v_or3_b32 v136, v136, v137, v138
  v_or_b32 v136, v136, v139
  v_cmp_ne_u32 vcc, 0, v136
  s_nop 0
  s_cbranch_vccz front_keys
  s_mov_b32 s54, 32768
front_all:
  s_sleep 2
  buffer_load_dwordx4 v[136:139], v140, s[24:27], s58 offen sc1
  s_waitcnt vmcnt(0)
  v_xor_b32 v136, s55, v136
  v_xor_b32 v137, s55, v137
  v_xor_b32 v138, s55, v138
  v_xor_b32 v139, s55, v139
  v_or3_b32 v136, v136, v137, v138
  v_or_b32 v136, v136, v139
  v_cmp_ne_u32 vcc, 0, v136
  s_nop 0
  s_cbranch_vccz front_keys
  s_sub_u32 s54, s54, 1
  s_cmp_lg_u32 s54, 0
  s_cbranch_scc1 front_all
front_keys:
  s_lshl_b32 s35, s3, 11
  s_add_u32 s35, s35, 2621440
  buffer_load_dwordx4 v[128:131], v242, s[24:27], s35 offen sc1
  buffer_load_dwordx4 v[132:135], v242, s[24:27], s35 offen offset:1024 sc1
  v_mfma_f32_16x16x32_bf16 v[0:3], a[160:163], a[64:67], v[0:3]
  ds_read_b64_tr_b16 a[176:177], v146 offset:32768
  s_add_u32 s59, s59, 1
  s_or_b32 s54, s2, s3
  s_min_u32 s54, s54, 1
  v_mfma_f32_16x16x32_bf16 v[0:3], a[164:167], a[80:83], v[0:3]
  buffer_load_dwordx4 a[32:35], v242, s[24:27], s30 offen offset:0 sc1
  s_lshl_b32 s54, s54, 28
  v_mfma_f32_16x16x32_bf16 v[4:7], a[164:167], a[84:87], v[4:7]
  ds_read_b64_tr_b16 a[178:179], v146 offset:33792
  v_lshlrev_b32 v137, 22, v242
  v_mfma_f32_16x16x32_bf16 v[4:7], a[160:163], a[68:71], v[4:7]
  v_or_b32 v137, s54, v137
  v_mov_b32 v136, s59
  v_mfma_f32_16x16x32_bf16 v[8:11], a[160:163], a[72:75], v[8:11]
  ds_read_b64_tr_b16 a[180:181], v146 offset:40960
  s_add_u32 m0, s28, 0
  s_mov_b32 s58, 2830336
  buffer_store_dword v136, v137, s[24:27], s58 offen sc1
  v_mfma_f32_16x16x32_bf16 v[8:11], a[164:167], a[88:91], v[8:11]
  buffer_load_dwordx4 v238, s[20:23], s31 offen offset:0 lds
  v_mfma_f32_16x16x32_bf16 v[12:15], a[164:167], a[92:95], v[12:15]
  ds_read_b64_tr_b16 a[182:183], v146 offset:41984
  v_mfma_f32_16x16x32_bf16 v[12:15], a[160:163], a[76:79], v[12:15]
  s_waitcnt lgkmcnt(4)
  v_mfma_f32_16x16x32_bf16 v[16:19], a[168:171], a[64:67], v[16:19]
  ds_read_b64_tr_b16 a[184:185], v147 offset:32768
  v_mfma_f32_16x16x32_bf16 v[16:19], a[172:175], a[80:83], v[16:19]
  buffer_load_dwordx4 a[36:39], v242, s[24:27], s30 offen offset:1024 sc1
  v_mfma_f32_16x16x32_bf16 v[20:23], a[172:175], a[84:87], v[20:23]
  ds_read_b64_tr_b16 a[186:187], v147 offset:33792
  v_mfma_f32_16x16x32_bf16 v[20:23], a[168:171], a[68:71], v[20:23]
  v_mfma_f32_16x16x32_bf16 v[24:27], a[168:171], a[72:75], v[24:27]
  ds_read_b64_tr_b16 a[188:189], v147 offset:40960
  v_mfma_f32_16x16x32_bf16 v[24:27], a[172:175], a[88:91], v[24:27]
  v_mfma_f32_16x16x32_bf16 v[28:31], a[172:175], a[92:95], v[28:31]
  ds_read_b64_tr_b16 a[190:191], v147 offset:41984
  v_mfma_f32_16x16x32_bf16 v[28:31], a[168:171], a[76:79], v[28:31]
  s_waitcnt lgkmcnt(4)
  v_mfma_f32_16x16x32_bf16 v[32:35], a[176:179], a[64:67], v[32:35]
  ds_read_b64_tr_b16 a[160:161], v148 offset:32768
  v_mfma_f32_16x16x32_bf16 v[32:35], a[180:183], a[80:83], v[32:35]
  buffer_load_dwordx4 a[40:43], v242, s[24:27], s30 offen offset:2048 sc1
  v_mfma_f32_16x16x32_bf16 v[36:39], a[180:183], a[84:87], v[36:39]
  ds_read_b64_tr_b16 a[162:163], v148 offset:33792
  v_mfma_f32_16x16x32_bf16 v[36:39], a[176:179], a[68:71], v[36:39]
  v_mfma_f32_16x16x32_bf16 v[40:43], a[176:179], a[72:75], v[40:43]
  ds_read_b64_tr_b16 a[164:165], v148 offset:40960
  v_mfma_f32_16x16x32_bf16 v[40:43], a[180:183], a[88:91], v[40:43]
  buffer_load_dwordx4 v239, s[20:23], s31 offen offset:1024 lds
  v_mfma_f32_16x16x32_bf16 v[44:47], a[180:183], a[92:95], v[44:47]
  ds_read_b64_tr_b16 a[166:167], v148 offset:41984
  v_mfma_f32_16x16x32_bf16 v[44:47], a[176:179], a[76:79], v[44:47]
  s_waitcnt lgkmcnt(4)
  v_mfma_f32_16x16x32_bf16 v[48:51], a[184:187], a[64:67], v[48:51]
  ds_read_b64_tr_b16 a[168:169], v149 offset:32768
  v_mfma_f32_16x16x32_bf16 v[48:51], a[188:191], a[80:83], v[48:51]
  buffer_load_dwordx4 a[44:47], v242, s[24:27], s30 offen offset:3072 sc1
  v_mfma_f32_16x16x32_bf16 v[52:55], a[188:191], a[84:87], v[52:55]
  ds_read_b64_tr_b16 a[170:171], v149 offset:33792
  v_mfma_f32_16x16x32_bf16 v[52:55], a[184:187], a[68:71], v[52:55]
  v_mfma_f32_16x16x32_bf16 v[56:59], a[184:187], a[72:75], v[56:59]
  ds_read_b64_tr_b16 a[172:173], v149 offset:40960
  v_mfma_f32_16x16x32_bf16 v[56:59], a[188:191], a[88:91], v[56:59]
  v_mfma_f32_16x16x32_bf16 v[60:63], a[188:191], a[92:95], v[60:63]
  ds_read_b64_tr_b16 a[174:175], v149 offset:41984
  v_mfma_f32_16x16x32_bf16 v[60:63], a[184:187], a[76:79], v[60:63]
  s_waitcnt lgkmcnt(4)
  v_mfma_f32_16x16x32_bf16 v[64:67], a[160:163], a[64:67], v[64:67]
  ds_read_b64_tr_b16 a[176:177], v150 offset:32768
  v_mfma_f32_16x16x32_bf16 v[64:67], a[164:167], a[80:83], v[64:67]
  buffer_load_dwordx4 a[48:51], v243, s[24:27], s30 offen offset:0 sc1
  v_mfma_f32_16x16x32_bf16 v[68:71], a[164:167], a[84:87], v[68:71]
  ds_read_b64_tr_b16 a[178:179], v150 offset:33792
  v_mfma_f32_16x16x32_bf16 v[68:71], a[160:163], a[68:71], v[68:71]
  v_mfma_f32_16x16x32_bf16 v[72:75], a[160:163], a[72:75], v[72:75]
  ds_read_b64_tr_b16 a[180:181], v150 offset:40960
  v_mfma_f32_16x16x32_bf16 v[72:75], a[164:167], a[88:91], v[72:75]
  buffer_load_dwordx4 v240, s[20:23], s31 offen offset:2048 lds
  v_mfma_f32_16x16x32_bf16 v[76:79], a[164:167], a[92:95], v[76:79]
  ds_read_b64_tr_b16 a[182:183], v150 offset:41984
  v_mfma_f32_16x16x32_bf16 v[76:79], a[160:163], a[76:79], v[76:79]
  s_waitcnt lgkmcnt(4)
  v_mfma_f32_16x16x32_bf16 v[80:83], a[168:171], a[64:67], v[80:83]
  ds_read_b64_tr_b16 a[184:185], v151 offset:32768
  v_mfma_f32_16x16x32_bf16 v[80:83], a[172:175], a[80:83], v[80:83]
  buffer_load_dwordx4 a[52:55], v243, s[24:27], s30 offen offset:1024 sc1
  v_mfma_f32_16x16x32_bf16 v[84:87], a[172:175], a[84:87], v[84:87]
  ds_read_b64_tr_b16 a[186:187], v151 offset:33792
  v_mfma_f32_16x16x32_bf16 v[84:87], a[168:171], a[68:71], v[84:87]
  v_mfma_f32_16x16x32_bf16 v[88:91], a[168:171], a[72:75], v[88:91]
  ds_read_b64_tr_b16 a[188:189], v151 offset:40960
  v_mfma_f32_16x16x32_bf16 v[88:91], a[172:175], a[88:91], v[88:91]
  s_barrier
  v_mfma_f32_16x16x32_bf16 v[92:95], a[172:175], a[92:95], v[92:95]
  ds_read_b64_tr_b16 a[190:191], v151 offset:41984
  v_mfma_f32_16x16x32_bf16 v[92:95], a[168:171], a[76:79], v[92:95]
  s_waitcnt lgkmcnt(4)
  v_mfma_f32_16x16x32_bf16 v[96:99], a[176:179], a[64:67], v[96:99]
  ds_read_b64_tr_b16 a[160:161], v144 offset:49152
  v_mfma_f32_16x16x32_bf16 v[96:99], a[180:183], a[80:83], v[96:99]
  buffer_load_dwordx4 a[56:59], v243, s[24:27], s30 offen offset:2048 sc1
  v_mfma_f32_16x16x32_bf16 v[100:103], a[180:183], a[84:87], v[100:103]
  ds_read_b64_tr_b16 a[162:163], v144 offset:50176
  v_mfma_f32_16x16x32_bf16 v[100:103], a[176:179], a[68:71], v[100:103]
  v_mfma_f32_16x16x32_bf16 v[104:107], a[176:179], a[72:75], v[104:107]
  ds_read_b64_tr_b16 a[164:165], v144 offset:57344
  v_mfma_f32_16x16x32_bf16 v[104:107], a[180:183], a[88:91], v[104:107]
  buffer_load_dwordx4 v241, s[20:23], s31 offen offset:3072 lds
  s_add_u32 s31, s31, 0x80000
  v_mfma_f32_16x16x32_bf16 v[108:111], a[180:183], a[92:95], v[108:111]
  ds_read_b64_tr_b16 a[166:167], v144 offset:58368
  v_mfma_f32_16x16x32_bf16 v[108:111], a[176:179], a[76:79], v[108:111]
  s_waitcnt lgkmcnt(4)
  v_mfma_f32_16x16x32_bf16 v[112:115], a[184:187], a[64:67], v[112:115]
  ds_read_b64_tr_b16 a[168:169], v145 offset:49152
  v_mfma_f32_16x16x32_bf16 v[112:115], a[188:191], a[80:83], v[112:115]
  buffer_load_dwordx4 a[60:63], v243, s[24:27], s30 offen offset:3072 sc1
  s_add_u32 s30, s30, 8192
  v_mfma_f32_16x16x32_bf16 v[116:119], a[188:191], a[84:87], v[116:119]
  ds_read_b64_tr_b16 a[170:171], v145 offset:50176
  v_mfma_f32_16x16x32_bf16 v[116:119], a[184:187], a[68:71], v[116:119]
  v_mfma_f32_16x16x32_bf16 v[120:123], a[184:187], a[72:75], v[120:123]
  ds_read_b64_tr_b16 a[172:173], v145 offset:57344
  v_mfma_f32_16x16x32_bf16 v[120:123], a[188:191], a[88:91], v[120:123]
  v_mfma_f32_16x16x32_bf16 v[124:127], a[188:191], a[92:95], v[124:127]
  ds_read_b64_tr_b16 a[174:175], v145 offset:58368
  v_mfma_f32_16x16x32_bf16 v[124:127], a[184:187], a[76:79], v[124:127]
  s_waitcnt vmcnt(27) lgkmcnt(4)
  v_mfma_f32_16x16x32_bf16 v[0:3], a[160:163], a[96:99], v[0:3]
  ds_read_b64_tr_b16 a[176:177], v146 offset:49152
  v_mfma_f32_16x16x32_bf16 v[0:3], a[164:167], a[112:115], v[0:3]
  buffer_load_dwordx4 a[64:67], v242, s[24:27], s30 offen offset:0 sc1
  v_mfma_f32_16x16x32_bf16 v[4:7], a[164:167], a[116:119], v[4:7]
  ds_read_b64_tr_b16 a[178:179], v146 offset:50176
  v_mfma_f32_16x16x32_bf16 v[4:7], a[160:163], a[100:103], v[4:7]
  v_mfma_f32_16x16x32_bf16 v[8:11], a[160:163], a[104:107], v[8:11]
  ds_read_b64_tr_b16 a[180:181], v146 offset:57344
  s_add_u32 m0, s28, 65536
  v_mfma_f32_16x16x32_bf16 v[8:11], a[164:167], a[120:123], v[8:11]
  buffer_load_dwordx4 v238, s[20:23], s31 offen offset:0 lds
  v_mfma_f32_16x16x32_bf16 v[12:15], a[164:167], a[124:127], v[12:15]
  ds_read_b64_tr_b16 a[182:183], v146 offset:58368
  v_mfma_f32_16x16x32_bf16 v[12:15], a[160:163], a[108:111], v[12:15]
  s_waitcnt lgkmcnt(4)
  v_mfma_f32_16x16x32_bf16 v[16:19], a[168:171], a[96:99], v[16:19]
  ds_read_b64_tr_b16 a[184:185], v147 offset:49152
  v_mfma_f32_16x16x32_bf16 v[16:19], a[172:175], a[112:115], v[16:19]
  buffer_load_dwordx4 a[68:71], v242, s[24:27], s30 offen offset:1024 sc1
  v_mfma_f32_16x16x32_bf16 v[20:23], a[172:175], a[116:119], v[20:23]
  ds_read_b64_tr_b16 a[186:187], v147 offset:50176
  v_mfma_f32_16x16x32_bf16 v[20:23], a[168:171], a[100:103], v[20:23]
  v_mfma_f32_16x16x32_bf16 v[24:27], a[168:171], a[104:107], v[24:27]
  ds_read_b64_tr_b16 a[188:189], v147 offset:57344
  v_mfma_f32_16x16x32_bf16 v[24:27], a[172:175], a[120:123], v[24:27]
  v_mfma_f32_16x16x32_bf16 v[28:31], a[172:175], a[124:127], v[28:31]
  ds_read_b64_tr_b16 a[190:191], v147 offset:58368
  v_mfma_f32_16x16x32_bf16 v[28:31], a[168:171], a[108:111], v[28:31]
  s_waitcnt lgkmcnt(4)
  v_mfma_f32_16x16x32_bf16 v[32:35], a[176:179], a[96:99], v[32:35]
  ds_read_b64_tr_b16 a[160:161], v148 offset:49152
  v_mfma_f32_16x16x32_bf16 v[32:35], a[180:183], a[112:115], v[32:35]
  buffer_load_dwordx4 a[72:75], v242, s[24:27], s30 offen offset:2048 sc1
  v_mfma_f32_16x16x32_bf16 v[36:39], a[180:183], a[116:119], v[36:39]
  ds_read_b64_tr_b16 a[162:163], v148 offset:50176
  v_mfma_f32_16x16x32_bf16 v[36:39], a[176:179], a[100:103], v[36:39]
  v_mfma_f32_16x16x32_bf16 v[40:43], a[176:179], a[104:107], v[40:43]
  ds_read_b64_tr_b16 a[164:165], v148 offset:57344
  v_mfma_f32_16x16x32_bf16 v[40:43], a[180:183], a[120:123], v[40:43]
  buffer_load_dwordx4 v239, s[20:23], s31 offen offset:1024 lds
  v_mfma_f32_16x16x32_bf16 v[44:47], a[180:183], a[124:127], v[44:47]
  ds_read_b64_tr_b16 a[166:167], v148 offset:58368
  v_mfma_f32_16x16x32_bf16 v[44:47], a[176:179], a[108:111], v[44:47]
  s_waitcnt lgkmcnt(4)
  v_mfma_f32_16x16x32_bf16 v[48:51], a[184:187], a[96:99], v[48:51]
  ds_read_b64_tr_b16 a[168:169], v149 offset:49152
  v_mfma_f32_16x16x32_bf16 v[48:51], a[188:191], a[112:115], v[48:51]
  buffer_load_dwordx4 a[76:79], v242, s[24:27], s30 offen offset:3072 sc1
  v_mfma_f32_16x16x32_bf16 v[52:55], a[188:191], a[116:119], v[52:55]
  ds_read_b64_tr_b16 a[170:171], v149 offset:50176
  v_mfma_f32_16x16x32_bf16 v[52:55], a[184:187], a[100:103], v[52:55]
  v_mfma_f32_16x16x32_bf16 v[56:59], a[184:187], a[104:107], v[56:59]
  ds_read_b64_tr_b16 a[172:173], v149 offset:57344
  v_mfma_f32_16x16x32_bf16 v[56:59], a[188:191], a[120:123], v[56:59]
  v_mfma_f32_16x16x32_bf16 v[60:63], a[188:191], a[124:127], v[60:63]
  ds_read_b64_tr_b16 a[174:175], v149 offset:58368
  v_mfma_f32_16x16x32_bf16 v[60:63], a[184:187], a[108:111], v[60:63]
  s_waitcnt lgkmcnt(4)
  v_mfma_f32_16x16x32_bf16 v[64:67], a[160:163], a[96:99], v[64:67]
  ds_read_b64_tr_b16 a[176:177], v150 offset:49152
  v_mfma_f32_16x16x32_bf16 v[64:67], a[164:167], a[112:115], v[64:67]
  buffer_load_dwordx4 a[80:83], v243, s[24:27], s30 offen offset:0 sc1
  v_mfma_f32_16x16x32_bf16 v[68:71], a[164:167], a[116:119], v[68:71]
  ds_read_b64_tr_b16 a[178:179], v150 offset:50176
  v_mfma_f32_16x16x32_bf16 v[68:71], a[160:163], a[100:103], v[68:71]
  v_mfma_f32_16x16x32_bf16 v[72:75], a[160:163], a[104:107], v[72:75]
  ds_read_b64_tr_b16 a[180:181], v150 offset:57344
  v_mfma_f32_16x16x32_bf16 v[72:75], a[164:167], a[120:123], v[72:75]
  buffer_load_dwordx4 v240, s[20:23], s31 offen offset:2048 lds
  v_mfma_f32_16x16x32_bf16 v[76:79], a[164:167], a[124:127], v[76:79]
  ds_read_b64_tr_b16 a[182:183], v150 offset:58368
  v_mfma_f32_16x16x32_bf16 v[76:79], a[160:163], a[108:111], v[76:79]
  s_waitcnt lgkmcnt(4)
  v_mfma_f32_16x16x32_bf16 v[80:83], a[168:171], a[96:99], v[80:83]
  ds_read_b64_tr_b16 a[184:185], v151 offset:49152
  v_mfma_f32_16x16x32_bf16 v[80:83], a[172:175], a[112:115], v[80:83]
  buffer_load_dwordx4 a[84:87], v243, s[24:27], s30 offen offset:1024 sc1
  v_mfma_f32_16x16x32_bf16 v[84:87], a[172:175], a[116:119], v[84:87]
  ds_read_b64_tr_b16 a[186:187], v151 offset:50176
  v_mfma_f32_16x16x32_bf16 v[84:87], a[168:171], a[100:103], v[84:87]
  s_waitcnt vmcnt(25)
  v_mfma_f32_16x16x32_bf16 v[88:91], a[168:171], a[104:107], v[88:91]
  ds_read_b64_tr_b16 a[188:189], v151 offset:57344
  v_mfma_f32_16x16x32_bf16 v[88:91], a[172:175], a[120:123], v[88:91]
  s_barrier
  v_mfma_f32_16x16x32_bf16 v[92:95], a[172:175], a[124:127], v[92:95]
  ds_read_b64_tr_b16 a[190:191], v151 offset:58368
  v_mfma_f32_16x16x32_bf16 v[92:95], a[168:171], a[108:111], v[92:95]
  s_waitcnt lgkmcnt(4)
  v_mfma_f32_16x16x32_bf16 v[96:99], a[176:179], a[96:99], v[96:99]
  ds_read_b64_tr_b16 a[160:161], v144 offset:16384
  v_mfma_f32_16x16x32_bf16 v[96:99], a[180:183], a[112:115], v[96:99]
  buffer_load_dwordx4 a[88:91], v243, s[24:27], s30 offen offset:2048 sc1
  v_mfma_f32_16x16x32_bf16 v[100:103], a[180:183], a[116:119], v[100:103]
  ds_read_b64_tr_b16 a[162:163], v144 offset:17408
  v_mfma_f32_16x16x32_bf16 v[100:103], a[176:179], a[100:103], v[100:103]
  v_mfma_f32_16x16x32_bf16 v[104:107], a[176:179], a[104:107], v[104:107]
  ds_read_b64_tr_b16 a[164:165], v144 offset:24576
  v_mfma_f32_16x16x32_bf16 v[104:107], a[180:183], a[120:123], v[104:107]
  buffer_load_dwordx4 v241, s[20:23], s31 offen offset:3072 lds
  s_add_u32 s31, s31, 0x80000
  v_mfma_f32_16x16x32_bf16 v[108:111], a[180:183], a[124:127], v[108:111]
  ds_read_b64_tr_b16 a[166:167], v144 offset:25600
  v_mfma_f32_16x16x32_bf16 v[108:111], a[176:179], a[108:111], v[108:111]
  s_waitcnt lgkmcnt(4)
  v_mfma_f32_16x16x32_bf16 v[112:115], a[184:187], a[96:99], v[112:115]
  ds_read_b64_tr_b16 a[168:169], v145 offset:16384
  v_mfma_f32_16x16x32_bf16 v[112:115], a[188:191], a[112:115], v[112:115]
  buffer_load_dwordx4 a[92:95], v243, s[24:27], s30 offen offset:3072 sc1
  s_add_u32 s30, s30, 8192
  v_mfma_f32_16x16x32_bf16 v[116:119], a[188:191], a[116:119], v[116:119]
  ds_read_b64_tr_b16 a[170:171], v145 offset:17408
  v_mfma_f32_16x16x32_bf16 v[116:119], a[184:187], a[100:103], v[116:119]
  v_mfma_f32_16x16x32_bf16 v[120:123], a[184:187], a[104:107], v[120:123]
  ds_read_b64_tr_b16 a[172:173], v145 offset:24576
  v_mfma_f32_16x16x32_bf16 v[120:123], a[188:191], a[120:123], v[120:123]
  v_mfma_f32_16x16x32_bf16 v[124:127], a[188:191], a[124:127], v[124:127]
  ds_read_b64_tr_b16 a[174:175], v145 offset:25600
  v_mfma_f32_16x16x32_bf16 v[124:127], a[184:187], a[108:111], v[124:127]
  s_waitcnt vmcnt(27) lgkmcnt(4)
  v_mfma_f32_16x16x32_bf16 v[0:3], a[160:163], a[0:3], v[0:3]
  ds_read_b64_tr_b16 a[176:177], v146 offset:16384
  s_waitcnt vmcnt(25)
  s_mov_b32 s51, -1
  v_sub_u32 v137, s51, v128
  v_mfma_f32_16x16x32_bf16 v[0:3], a[164:167], a[16:19], v[0:3]
  buffer_load_dwordx4 a[96:99], v242, s[24:27], s30 offen offset:0 sc1
  v_mfma_f32_16x16x32_bf16 v[4:7], a[164:167], a[20:23], v[4:7]
  ds_read_b64_tr_b16 a[178:179], v146 offset:17408
  v_sub_u32 v138, s51, v129
  v_mfma_f32_16x16x32_bf16 v[4:7], a[160:163], a[4:7], v[4:7]
  v_min_u32 v136, v137, v138
  v_sub_u32 v139, s51, v130
  v_mfma_f32_16x16x32_bf16 v[8:11], a[160:163], a[8:11], v[8:11]
  ds_read_b64_tr_b16 a[180:181], v146 offset:24576
  s_add_u32 m0, s28, 81920
  v_sub_u32 v140, s51, v131
  v_mfma_f32_16x16x32_bf16 v[8:11], a[164:167], a[24:27], v[8:11]
  buffer_load_dwordx4 v238, s[20:23], s31 offen offset:0 lds
  v_mfma_f32_16x16x32_bf16 v[12:15], a[164:167], a[28:31], v[12:15]
  ds_read_b64_tr_b16 a[182:183], v146 offset:25600
  v_min3_u32 v136, v136, v139, v140
  v_mfma_f32_16x16x32_bf16 v[12:15], a[160:163], a[12:15], v[12:15]
  s_waitcnt lgkmcnt(4)
  v_sub_u32 v137, s51, v132
  v_sub_u32 v138, s51, v133
  v_mfma_f32_16x16x32_bf16 v[16:19], a[168:171], a[0:3], v[16:19]
  ds_read_b64_tr_b16 a[184:185], v147 offset:16384
  v_min3_u32 v136, v136, v137, v138
  v_mfma_f32_16x16x32_bf16 v[16:19], a[172:175], a[16:19], v[16:19]
  buffer_load_dwordx4 a[100:103], v242, s[24:27], s30 offen offset:1024 sc1
  v_mfma_f32_16x16x32_bf16 v[20:23], a[172:175], a[20:23], v[20:23]
  ds_read_b64_tr_b16 a[186:187], v147 offset:17408
  v_sub_u32 v139, s51, v134
  v_mfma_f32_16x16x32_bf16 v[20:23], a[168:171], a[4:7], v[20:23]
  v_sub_u32 v140, s51, v135
  v_min3_u32 v136, v136, v139, v140
  v_mfma_f32_16x16x32_bf16 v[24:27], a[168:171], a[8:11], v[24:27]
  ds_read_b64_tr_b16 a[188:189], v147 offset:24576
  v_min_u32_dpp v136, v136, v136 row_ror:8 row_mask:0xf bank_mask:0xf
  v_mfma_f32_16x16x32_bf16 v[24:27], a[172:175], a[24:27], v[24:27]
  v_mfma_f32_16x16x32_bf16 v[28:31], a[172:175], a[28:31], v[28:31]
  ds_read_b64_tr_b16 a[190:191], v147 offset:25600
  v_min_u32_dpp v136, v136, v136 row_ror:4 row_mask:0xf bank_mask:0xf
  v_mfma_f32_16x16x32_bf16 v[28:31], a[168:171], a[12:15], v[28:31]
  s_waitcnt lgkmcnt(4)
  v_min_u32_dpp v136, v136, v136 row_ror:2 row_mask:0xf bank_mask:0xf
  v_mfma_f32_16x16x32_bf16 v[32:35], a[176:179], a[0:3], v[32:35]
  ds_read_b64_tr_b16 a[160:161], v148 offset:16384
  v_min_u32_dpp v136, v136, v136 row_ror:1 row_mask:0xf bank_mask:0xf
  v_mfma_f32_16x16x32_bf16 v[32:35], a[180:183], a[16:19], v[32:35]
  buffer_load_dwordx4 a[104:107], v242, s[24:27], s30 offen offset:2048 sc1
  v_mfma_f32_16x16x32_bf16 v[36:39], a[180:183], a[20:23], v[36:39]
  ds_read_b64_tr_b16 a[162:163], v148 offset:17408
  v_readlane_b32 s98, v136, 0
  v_mfma_f32_16x16x32_bf16 v[36:39], a[176:179], a[4:7], v[36:39]
  v_readlane_b32 s99, v136, 16
  v_readlane_b32 s100, v136, 32
  v_mfma_f32_16x16x32_bf16 v[40:43], a[176:179], a[8:11], v[40:43]
  ds_read_b64_tr_b16 a[164:165], v148 offset:24576
  v_readlane_b32 s101, v136, 48
  v_mfma_f32_16x16x32_bf16 v[40:43], a[180:183], a[24:27], v[40:43]
  buffer_load_dwordx4 v239, s[20:23], s31 offen offset:1024 lds
  s_min_u32 s98, s98, s99
  s_min_u32 s100, s100, s101
  s_min_u32 s98, s98, s100
  v_mfma_f32_16x16x32_bf16 v[44:47], a[180:183], a[28:31], v[44:47]
  ds_read_b64_tr_b16 a[166:167], v148 offset:25600
  s_sub_u32 s52, s51, s98
  s_sub_u32 s51, s52, 1
  v_sub_u32 v137, s51, v128
  v_mfma_f32_16x16x32_bf16 v[44:47], a[176:179], a[12:15], v[44:47]
  s_waitcnt lgkmcnt(4)
  v_sub_u32 v138, s51, v129
  v_min_u32 v136, v137, v138
  v_mfma_f32_16x16x32_bf16 v[48:51], a[184:187], a[0:3], v[48:51]
  ds_read_b64_tr_b16 a[168:169], v149 offset:16384
  v_sub_u32 v139, s51, v130
  v_mfma_f32_16x16x32_bf16 v[48:51], a[188:191], a[16:19], v[48:51]
  buffer_load_dwordx4 a[108:111], v242, s[24:27], s30 offen offset:3072 sc1
  v_mfma_f32_16x16x32_bf16 v[52:55], a[188:191], a[20:23], v[52:55]
  ds_read_b64_tr_b16 a[170:171], v149 offset:17408
  v_sub_u32 v140, s51, v131
  v_mfma_f32_16x16x32_bf16 v[52:55], a[184:187], a[4:7], v[52:55]
  v_min3_u32 v136, v136, v139, v140
  v_sub_u32 v137, s51, v132
  v_mfma_f32_16x16x32_bf16 v[56:59], a[184:187], a[8:11], v[56:59]
  ds_read_b64_tr_b16 a[172:173], v149 offset:24576
  v_sub_u32 v138, s51, v133
  v_mfma_f32_16x16x32_bf16 v[56:59], a[188:191], a[24:27], v[56:59]
  v_min3_u32 v136, v136, v137, v138
  v_sub_u32 v139, s51, v134
  v_mfma_f32_16x16x32_bf16 v[60:63], a[188:191], a[28:31], v[60:63]
  ds_read_b64_tr_b16 a[174:175], v149 offset:25600
  v_sub_u32 v140, s51, v135
  v_mfma_f32_16x16x32_bf16 v[60:63], a[184:187], a[12:15], v[60:63]
  s_waitcnt lgkmcnt(4)
  v_min3_u32 v136, v136, v139, v140
  v_mfma_f32_16x16x32_bf16 v[64:67], a[160:163], a[0:3], v[64:67]
  ds_read_b64_tr_b16 a[176:177], v150 offset:16384
  v_min_u32_dpp v136, v136, v136 row_ror:8 row_mask:0xf bank_mask:0xf
  v_mfma_f32_16x16x32_bf16 v[64:67], a[164:167], a[16:19], v[64:67]
  buffer_load_dwordx4 a[112:115], v243, s[24:27], s30 offen offset:0 sc1
  v_mfma_f32_16x16x32_bf16 v[68:71], a[164:167], a[20:23], v[68:71]
  ds_read_b64_tr_b16 a[178:179], v150 offset:17408
  v_min_u32_dpp v136, v136, v136 row_ror:4 row_mask:0xf bank_mask:0xf
  v_mfma_f32_16x16x32_bf16 v[68:71], a[160:163], a[4:7], v[68:71]
  v_mfma_f32_16x16x32_bf16 v[72:75], a[160:163], a[8:11], v[72:75]
  ds_read_b64_tr_b16 a[180:181], v150 offset:24576
  v_min_u32_dpp v136, v136, v136 row_ror:2 row_mask:0xf bank_mask:0xf
  v_mfma_f32_16x16x32_bf16 v[72:75], a[164:167], a[24:27], v[72:75]
  buffer_load_dwordx4 v240, s[20:23], s31 offen offset:2048 lds
  v_mfma_f32_16x16x32_bf16 v[76:79], a[164:167], a[28:31], v[76:79]
  ds_read_b64_tr_b16 a[182:183], v150 offset:25600
  v_min_u32_dpp v136, v136, v136 row_ror:1 row_mask:0xf bank_mask:0xf
  v_mfma_f32_16x16x32_bf16 v[76:79], a[160:163], a[12:15], v[76:79]
  s_waitcnt lgkmcnt(4)
  v_readlane_b32 s98, v136, 0
  v_readlane_b32 s99, v136, 16
  v_mfma_f32_16x16x32_bf16 v[80:83], a[168:171], a[0:3], v[80:83]
  ds_read_b64_tr_b16 a[184:185], v151 offset:16384
  v_readlane_b32 s100, v136, 32
  v_mfma_f32_16x16x32_bf16 v[80:83], a[172:175], a[16:19], v[80:83]
  buffer_load_dwordx4 a[116:119], v243, s[24:27], s30 offen offset:1024 sc1
  v_mfma_f32_16x16x32_bf16 v[84:87], a[172:175], a[20:23], v[84:87]
  ds_read_b64_tr_b16 a[186:187], v151 offset:17408
  v_readlane_b32 s101, v136, 48
  v_mfma_f32_16x16x32_bf16 v[84:87], a[168:171], a[4:7], v[84:87]
  s_waitcnt vmcnt(22)
  s_min_u32 s98, s98, s99
  s_min_u32 s100, s100, s101
  v_mfma_f32_16x16x32_bf16 v[88:91], a[168:171], a[8:11], v[88:91]
  ds_read_b64_tr_b16 a[188:189], v151 offset:24576
  s_min_u32 s98, s98, s100
  s_sub_u32 s53, s51, s98
  s_sub_u32 s51, s53, 1
  v_sub_u32 v137, s51, v128
  v_mfma_f32_16x16x32_bf16 v[88:91], a[172:175], a[24:27], v[88:91]
  s_barrier
  v_sub_u32 v138, s51, v129
  v_min_u32 v136, v137, v138
  v_mfma_f32_16x16x32_bf16 v[92:95], a[172:175], a[28:31], v[92:95]
  ds_read_b64_tr_b16 a[190:191], v151 offset:25600
  v_sub_u32 v139, s51, v130
  v_mfma_f32_16x16x32_bf16 v[92:95], a[168:171], a[12:15], v[92:95]
  s_waitcnt lgkmcnt(4)
  v_sub_u32 v140, s51, v131
  v_min3_u32 v136, v136, v139, v140
  v_mfma_f32_16x16x32_bf16 v[96:99], a[176:179], a[0:3], v[96:99]
  ds_read_b64_tr_b16 a[160:161], v144 offset:0
  v_sub_u32 v137, s51, v132
  v_mfma_f32_16x16x32_bf16 v[96:99], a[180:183], a[16:19], v[96:99]
  buffer_load_dwordx4 a[120:123], v243, s[24:27], s30 offen offset:2048 sc1
  v_mfma_f32_16x16x32_bf16 v[100:103], a[180:183], a[20:23], v[100:103]
  ds_read_b64_tr_b16 a[162:163], v144 offset:1024
  v_sub_u32 v138, s51, v133
  v_mfma_f32_16x16x32_bf16 v[100:103], a[176:179], a[4:7], v[100:103]
  v_min3_u32 v136, v136, v137, v138
  v_sub_u32 v139, s51, v134
  v_mfma_f32_16x16x32_bf16 v[104:107], a[176:179], a[8:11], v[104:107]
  ds_read_b64_tr_b16 a[164:165], v144 offset:8192
  v_sub_u32 v140, s51, v135
  v_mfma_f32_16x16x32_bf16 v[104:107], a[180:183], a[24:27], v[104:107]
  buffer_load_dwordx4 v241, s[20:23], s31 offen offset:3072 lds
  s_add_u32 s31, s31, 0x80000
  v_mfma_f32_16x16x32_bf16 v[108:111], a[180:183], a[28:31], v[108:111]
  ds_read_b64_tr_b16 a[166:167], v144 offset:9216
  v_min3_u32 v136, v136, v139, v140
  v_mfma_f32_16x16x32_bf16 v[108:111], a[176:179], a[12:15], v[108:111]
  s_waitcnt lgkmcnt(4)
  v_min_u32_dpp v136, v136, v136 row_ror:8 row_mask:0xf bank_mask:0xf
  v_mfma_f32_16x16x32_bf16 v[112:115], a[184:187], a[0:3], v[112:115]
  ds_read_b64_tr_b16 a[168:169], v145 offset:0
  v_min_u32_dpp v136, v136, v136 row_ror:4 row_mask:0xf bank_mask:0xf
  v_mfma_f32_16x16x32_bf16 v[112:115], a[188:191], a[16:19], v[112:115]
  buffer_load_dwordx4 a[124:127], v243, s[24:27], s30 offen offset:3072 sc1
  s_add_u32 s30, s30, 8192
  v_mfma_f32_16x16x32_bf16 v[116:119], a[188:191], a[20:23], v[116:119]
  ds_read_b64_tr_b16 a[170:171], v145 offset:1024
  v_min_u32_dpp v136, v136, v136 row_ror:2 row_mask:0xf bank_mask:0xf
  v_mfma_f32_16x16x32_bf16 v[116:119], a[184:187], a[4:7], v[116:119]
  v_mfma_f32_16x16x32_bf16 v[120:123], a[184:187], a[8:11], v[120:123]
  ds_read_b64_tr_b16 a[172:173], v145 offset:8192
  v_min_u32_dpp v136, v136, v136 row_ror:1 row_mask:0xf bank_mask:0xf
  v_mfma_f32_16x16x32_bf16 v[120:123], a[188:191], a[24:27], v[120:123]
  v_readlane_b32 s98, v136, 0
  v_readlane_b32 s99, v136, 16
  v_mfma_f32_16x16x32_bf16 v[124:127], a[188:191], a[28:31], v[124:127]
  ds_read_b64_tr_b16 a[174:175], v145 offset:9216
  v_readlane_b32 s100, v136, 32
  v_mfma_f32_16x16x32_bf16 v[124:127], a[184:187], a[12:15], v[124:127]
  s_waitcnt vmcnt(24) lgkmcnt(4)
  v_readlane_b32 s101, v136, 48
  v_mfma_f32_16x16x32_bf16 v[0:3], a[160:163], a[32:35], v[0:3]
  ds_read_b64_tr_b16 a[176:177], v146 offset:0
  s_min_u32 s98, s98, s99
  s_min_u32 s100, s100, s101
  s_min_u32 s98, s98, s100
  v_mfma_f32_16x16x32_bf16 v[0:3], a[164:167], a[48:51], v[0:3]
  buffer_load_dwordx4 a[0:3], v242, s[24:27], s30 offen offset:0 sc1
  s_sub_u32 s54, s51, s98
  s_sub_u32 s51, s54, 1
  v_mfma_f32_16x16x32_bf16 v[4:7], a[164:167], a[52:55], v[4:7]
  ds_read_b64_tr_b16 a[178:179], v146 offset:1024
  v_sub_u32 v137, s51, v128
  v_mfma_f32_16x16x32_bf16 v[4:7], a[160:163], a[36:39], v[4:7]
  v_sub_u32 v138, s51, v129
  v_min_u32 v136, v137, v138
  v_mfma_f32_16x16x32_bf16 v[8:11], a[160:163], a[40:43], v[8:11]
  ds_read_b64_tr_b16 a[180:181], v146 offset:8192
  s_add_u32 m0, s28, 98304
  v_sub_u32 v139, s51, v130
  v_mfma_f32_16x16x32_bf16 v[8:11], a[164:167], a[56:59], v[8:11]
  buffer_load_dwordx4 v238, s[20:23], s31 offen offset:0 lds
  v_mfma_f32_16x16x32_bf16 v[12:15], a[164:167], a[60:63], v[12:15]
  ds_read_b64_tr_b16 a[182:183], v146 offset:9216
  v_sub_u32 v140, s51, v131
  v_mfma_f32_16x16x32_bf16 v[12:15], a[160:163], a[44:47], v[12:15]
  s_waitcnt lgkmcnt(4)
  v_min3_u32 v136, v136, v139, v140
  v_sub_u32 v137, s51, v132
  v_mfma_f32_16x16x32_bf16 v[16:19], a[168:171], a[32:35], v[16:19]
  ds_read_b64_tr_b16 a[184:185], v147 offset:0
  v_sub_u32 v138, s51, v133
  v_mfma_f32_16x16x32_bf16 v[16:19], a[172:175], a[48:51], v[16:19]
  buffer_load_dwordx4 a[4:7], v242, s[24:27], s30 offen offset:1024 sc1
  v_mfma_f32_16x16x32_bf16 v[20:23], a[172:175], a[52:55], v[20:23]
  ds_read_b64_tr_b16 a[186:187], v147 offset:1024
  v_min3_u32 v136, v136, v137, v138
  v_mfma_f32_16x16x32_bf16 v[20:23], a[168:171], a[36:39], v[20:23]
  v_sub_u32 v139, s51, v134
  v_sub_u32 v140, s51, v135
  v_mfma_f32_16x16x32_bf16 v[24:27], a[168:171], a[40:43], v[24:27]
  ds_read_b64_tr_b16 a[188:189], v147 offset:8192
  v_min3_u32 v136, v136, v139, v140
  v_mfma_f32_16x16x32_bf16 v[24:27], a[172:175], a[56:59], v[24:27]
  v_mfma_f32_16x16x32_bf16 v[28:31], a[172:175], a[60:63], v[28:31]
  ds_read_b64_tr_b16 a[190:191], v147 offset:9216
  v_min_u32_dpp v136, v136, v136 row_ror:8 row_mask:0xf bank_mask:0xf
  v_mfma_f32_16x16x32_bf16 v[28:31], a[168:171], a[44:47], v[28:31]
  s_waitcnt lgkmcnt(4)
  v_min_u32_dpp v136, v136, v136 row_ror:4 row_mask:0xf bank_mask:0xf
  v_mfma_f32_16x16x32_bf16 v[32:35], a[176:179], a[32:35], v[32:35]
  ds_read_b64_tr_b16 a[160:161], v148 offset:0
  v_min_u32_dpp v136, v136, v136 row_ror:2 row_mask:0xf bank_mask:0xf
  v_mfma_f32_16x16x32_bf16 v[32:35], a[180:183], a[48:51], v[32:35]
  buffer_load_dwordx4 a[8:11], v242, s[24:27], s30 offen offset:2048 sc1
  v_mfma_f32_16x16x32_bf16 v[36:39], a[180:183], a[52:55], v[36:39]
  ds_read_b64_tr_b16 a[162:163], v148 offset:1024
  v_min_u32_dpp v136, v136, v136 row_ror:1 row_mask:0xf bank_mask:0xf
  v_mfma_f32_16x16x32_bf16 v[36:39], a[176:179], a[36:39], v[36:39]
  v_readlane_b32 s98, v136, 0
  v_readlane_b32 s99, v136, 16
  v_mfma_f32_16x16x32_bf16 v[40:43], a[176:179], a[40:43], v[40:43]
  ds_read_b64_tr_b16 a[164:165], v148 offset:8192
  v_readlane_b32 s100, v136, 32
  v_mfma_f32_16x16x32_bf16 v[40:43], a[180:183], a[56:59], v[40:43]
  buffer_load_dwordx4 v239, s[20:23], s31 offen offset:1024 lds
  v_mfma_f32_16x16x32_bf16 v[44:47], a[180:183], a[60:63], v[44:47]
  ds_read_b64_tr_b16 a[166:167], v148 offset:9216
  v_readlane_b32 s101, v136, 48
  v_mfma_f32_16x16x32_bf16 v[44:47], a[176:179], a[44:47], v[44:47]
  s_waitcnt lgkmcnt(4)
  s_min_u32 s98, s98, s99
  s_min_u32 s100, s100, s101
  v_mfma_f32_16x16x32_bf16 v[48:51], a[184:187], a[32:35], v[48:51]
  ds_read_b64_tr_b16 a[168:169], v149 offset:0
  s_min_u32 s98, s98, s100
  s_sub_u32 s55, s51, s98
  s_sub_u32 s51, s55, 1
  v_sub_u32 v137, s51, v128
  v_mfma_f32_16x16x32_bf16 v[48:51], a[188:191], a[48:51], v[48:51]
  buffer_load_dwordx4 a[12:15], v242, s[24:27], s30 offen offset:3072 sc1
  v_mfma_f32_16x16x32_bf16 v[52:55], a[188:191], a[52:55], v[52:55]
  ds_read_b64_tr_b16 a[170:171], v149 offset:1024
  v_sub_u32 v138, s51, v129
  v_mfma_f32_16x16x32_bf16 v[52:55], a[184:187], a[36:39], v[52:55]
  v_min_u32 v136, v137, v138
  v_sub_u32 v139, s51, v130
  v_mfma_f32_16x16x32_bf16 v[56:59], a[184:187], a[40:43], v[56:59]
  ds_read_b64_tr_b16 a[172:173], v149 offset:8192
  v_sub_u32 v140, s51, v131
  v_mfma_f32_16x16x32_bf16 v[56:59], a[188:191], a[56:59], v[56:59]
  v_min3_u32 v136, v136, v139, v140
  v_sub_u32 v137, s51, v132
  v_mfma_f32_16x16x32_bf16 v[60:63], a[188:191], a[60:63], v[60:63]
  ds_read_b64_tr_b16 a[174:175], v149 offset:9216
  v_sub_u32 v138, s51, v133
  v_mfma_f32_16x16x32_bf16 v[60:63], a[184:187], a[44:47], v[60:63]
  s_waitcnt lgkmcnt(4)
  v_min3_u32 v136, v136, v137, v138
  v_sub_u32 v139, s51, v134
  v_mfma_f32_16x16x32_bf16 v[64:67], a[160:163], a[32:35], v[64:67]
  ds_read_b64_tr_b16 a[176:177], v150 offset:0
  v_sub_u32 v140, s51, v135
  v_mfma_f32_16x16x32_bf16 v[64:67], a[164:167], a[48:51], v[64:67]
  buffer_load_dwordx4 a[16:19], v243, s[24:27], s30 offen offset:0 sc1
  v_mfma_f32_16x16x32_bf16 v[68:71], a[164:167], a[52:55], v[68:71]
  ds_read_b64_tr_b16 a[178:179], v150 offset:1024
  v_min3_u32 v136, v136, v139, v140
  v_mfma_f32_16x16x32_bf16 v[68:71], a[160:163], a[36:39], v[68:71]
  v_mfma_f32_16x16x32_bf16 v[72:75], a[160:163], a[40:43], v[72:75]
  ds_read_b64_tr_b16 a[180:181], v150 offset:8192
  v_min_u32_dpp v136, v136, v136 row_ror:8 row_mask:0xf bank_mask:0xf
  v_mfma_f32_16x16x32_bf16 v[72:75], a[164:167], a[56:59], v[72:75]
  buffer_load_dwordx4 v240, s[20:23], s31 offen offset:2048 lds
  v_mfma_f32_16x16x32_bf16 v[76:79], a[164:167], a[60:63], v[76:79]
  ds_read_b64_tr_b16 a[182:183], v150 offset:9216
  v_min_u32_dpp v136, v136, v136 row_ror:4 row_mask:0xf bank_mask:0xf
  v_mfma_f32_16x16x32_bf16 v[76:79], a[160:163], a[44:47], v[76:79]
  s_waitcnt lgkmcnt(4)
  v_min_u32_dpp v136, v136, v136 row_ror:2 row_mask:0xf bank_mask:0xf
  v_mfma_f32_16x16x32_bf16 v[80:83], a[168:171], a[32:35], v[80:83]
  ds_read_b64_tr_b16 a[184:185], v151 offset:0
  v_min_u32_dpp v136, v136, v136 row_ror:1 row_mask:0xf bank_mask:0xf
  v_mfma_f32_16x16x32_bf16 v[80:83], a[172:175], a[48:51], v[80:83]
  buffer_load_dwordx4 a[20:23], v243, s[24:27], s30 offen offset:1024 sc1
  v_mfma_f32_16x16x32_bf16 v[84:87], a[172:175], a[52:55], v[84:87]
  ds_read_b64_tr_b16 a[186:187], v151 offset:1024
  v_readlane_b32 s98, v136, 0
  v_mfma_f32_16x16x32_bf16 v[84:87], a[168:171], a[36:39], v[84:87]
  s_waitcnt vmcnt(22)
  v_readlane_b32 s99, v136, 16
  v_readlane_b32 s100, v136, 32
  v_mfma_f32_16x16x32_bf16 v[88:91], a[168:171], a[40:43], v[88:91]
  ds_read_b64_tr_b16 a[188:189], v151 offset:8192
  v_readlane_b32 s101, v136, 48
  v_mfma_f32_16x16x32_bf16 v[88:91], a[172:175], a[56:59], v[88:91]
  s_barrier
  s_min_u32 s98, s98, s99
  s_min_u32 s100, s100, s101
  v_mfma_f32_16x16x32_bf16 v[92:95], a[172:175], a[60:63], v[92:95]
  ds_read_b64_tr_b16 a[190:191], v151 offset:9216
  s_min_u32 s98, s98, s100
  s_sub_u32 s56, s51, s98
  s_sub_u32 s51, s56, 1
  v_sub_u32 v137, s51, v128
  v_mfma_f32_16x16x32_bf16 v[92:95], a[168:171], a[44:47], v[92:95]
  s_waitcnt lgkmcnt(4)
  v_sub_u32 v138, s51, v129
  v_min_u32 v136, v137, v138
  v_mfma_f32_16x16x32_bf16 v[96:99], a[176:179], a[32:35], v[96:99]
  ds_read_b64_tr_b16 a[160:161], v224 offset:0
  v_sub_u32 v139, s51, v130
  v_mfma_f32_16x16x32_bf16 v[96:99], a[180:183], a[48:51], v[96:99]
  buffer_load_dwordx4 a[24:27], v243, s[24:27], s30 offen offset:2048 sc1
  v_mfma_f32_16x16x32_bf16 v[100:103], a[180:183], a[52:55], v[100:103]
  ds_read_b64_tr_b16 a[162:163], v224 offset:1024
  v_sub_u32 v140, s51, v131
  v_mfma_f32_16x16x32_bf16 v[100:103], a[176:179], a[36:39], v[100:103]
  v_min3_u32 v136, v136, v139, v140
  v_sub_u32 v137, s51, v132
  v_mfma_f32_16x16x32_bf16 v[104:107], a[176:179], a[40:43], v[104:107]
  ds_read_b64_tr_b16 a[164:165], v224 offset:8192
  v_sub_u32 v138, s51, v133
  v_mfma_f32_16x16x32_bf16 v[104:107], a[180:183], a[56:59], v[104:107]
  buffer_load_dwordx4 v241, s[20:23], s31 offen offset:3072 lds
  s_add_u32 s31, s31, 0x80000
  v_mfma_f32_16x16x32_bf16 v[108:111], a[180:183], a[60:63], v[108:111]
  ds_read_b64_tr_b16 a[166:167], v224 offset:9216
  v_min3_u32 v136, v136, v137, v138
  v_mfma_f32_16x16x32_bf16 v[108:111], a[176:179], a[44:47], v[108:111]
  s_waitcnt lgkmcnt(4)
  v_sub_u32 v139, s51, v134
  v_sub_u32 v140, s51, v135
  v_mfma_f32_16x16x32_bf16 v[112:115], a[184:187], a[32:35], v[112:115]
  ds_read_b64_tr_b16 a[168:169], v225 offset:0
  v_min3_u32 v136, v136, v139, v140
  v_mfma_f32_16x16x32_bf16 v[112:115], a[188:191], a[48:51], v[112:115]
  buffer_load_dwordx4 a[28:31], v243, s[24:27], s30 offen offset:3072 sc1
  s_add_u32 s30, s30, 8192
  v_mfma_f32_16x16x32_bf16 v[116:119], a[188:191], a[52:55], v[116:119]
  ds_read_b64_tr_b16 a[170:171], v225 offset:1024
  v_min_u32_dpp v136, v136, v136 row_ror:8 row_mask:0xf bank_mask:0xf
  v_mfma_f32_16x16x32_bf16 v[116:119], a[184:187], a[36:39], v[116:119]
  v_mfma_f32_16x16x32_bf16 v[120:123], a[184:187], a[40:43], v[120:123]
  ds_read_b64_tr_b16 a[172:173], v225 offset:8192
  v_min_u32_dpp v136, v136, v136 row_ror:4 row_mask:0xf bank_mask:0xf
  v_mfma_f32_16x16x32_bf16 v[120:123], a[188:191], a[56:59], v[120:123]
  v_mfma_f32_16x16x32_bf16 v[124:127], a[188:191], a[60:63], v[124:127]
  ds_read_b64_tr_b16 a[174:175], v225 offset:9216
  v_min_u32_dpp v136, v136, v136 row_ror:2 row_mask:0xf bank_mask:0xf
  v_mfma_f32_16x16x32_bf16 v[124:127], a[184:187], a[44:47], v[124:127]
  s_waitcnt vmcnt(24) lgkmcnt(4)
  v_min_u32_dpp v136, v136, v136 row_ror:1 row_mask:0xf bank_mask:0xf
  v_mfma_f32_16x16x32_bf16 v[0:3], a[160:163], a[64:67], v[0:3]
  ds_read_b64_tr_b16 a[176:177], v226 offset:0
  v_readlane_b32 s98, v136, 0
  v_mfma_f32_16x16x32_bf16 v[0:3], a[164:167], a[80:83], v[0:3]
  buffer_load_dwordx4 a[32:35], v242, s[24:27], s30 offen offset:0 sc1
  v_mfma_f32_16x16x32_bf16 v[4:7], a[164:167], a[84:87], v[4:7]
  ds_read_b64_tr_b16 a[178:179], v226 offset:1024
  v_readlane_b32 s99, v136, 16
  v_mfma_f32_16x16x32_bf16 v[4:7], a[160:163], a[68:71], v[4:7]
  v_readlane_b32 s100, v136, 32
  v_readlane_b32 s101, v136, 48
  v_mfma_f32_16x16x32_bf16 v[8:11], a[160:163], a[72:75], v[8:11]
  ds_read_b64_tr_b16 a[180:181], v226 offset:8192
  s_add_u32 m0, s28, 114688
  s_min_u32 s98, s98, s99
  s_min_u32 s100, s100, s101
  v_mfma_f32_16x16x32_bf16 v[8:11], a[164:167], a[88:91], v[8:11]
  buffer_load_dwordx4 v238, s[20:23], s31 offen offset:0 lds
  s_min_u32 s98, s98, s100
  s_sub_u32 s57, s51, s98
  s_sub_u32 s51, s57, 1
  v_mfma_f32_16x16x32_bf16 v[12:15], a[164:167], a[92:95], v[12:15]
  ds_read_b64_tr_b16 a[182:183], v226 offset:9216
  v_sub_u32 v137, s51, v128
  v_mfma_f32_16x16x32_bf16 v[12:15], a[160:163], a[76:79], v[12:15]
  s_waitcnt lgkmcnt(4)
  v_sub_u32 v138, s51, v129
  v_min_u32 v136, v137, v138
  v_mfma_f32_16x16x32_bf16 v[16:19], a[168:171], a[64:67], v[16:19]
  ds_read_b64_tr_b16 a[184:185], v227 offset:0
  v_sub_u32 v139, s51, v130
  v_mfma_f32_16x16x32_bf16 v[16:19], a[172:175], a[80:83], v[16:19]
  buffer_load_dwordx4 a[36:39], v242, s[24:27], s30 offen offset:1024 sc1
  v_mfma_f32_16x16x32_bf16 v[20:23], a[172:175], a[84:87], v[20:23]
  ds_read_b64_tr_b16 a[186:187], v227 offset:1024
  v_sub_u32 v140, s51, v131
  v_mfma_f32_16x16x32_bf16 v[20:23], a[168:171], a[68:71], v[20:23]
  v_min3_u32 v136, v136, v139, v140
  v_sub_u32 v137, s51, v132
  v_mfma_f32_16x16x32_bf16 v[24:27], a[168:171], a[72:75], v[24:27]
  ds_read_b64_tr_b16 a[188:189], v227 offset:8192
  v_sub_u32 v138, s51, v133
  v_mfma_f32_16x16x32_bf16 v[24:27], a[172:175], a[88:91], v[24:27]
  v_min3_u32 v136, v136, v137, v138
  v_sub_u32 v139, s51, v134
  v_mfma_f32_16x16x32_bf16 v[28:31], a[172:175], a[92:95], v[28:31]
  ds_read_b64_tr_b16 a[190:191], v227 offset:9216
  v_sub_u32 v140, s51, v135
  v_mfma_f32_16x16x32_bf16 v[28:31], a[168:171], a[76:79], v[28:31]
  s_waitcnt lgkmcnt(4)
  v_min3_u32 v136, v136, v139, v140
  v_mfma_f32_16x16x32_bf16 v[32:35], a[176:179], a[64:67], v[32:35]
  ds_read_b64_tr_b16 a[160:161], v228 offset:0
  v_min_u32_dpp v136, v136, v136 row_ror:8 row_mask:0xf bank_mask:0xf
  v_mfma_f32_16x16x32_bf16 v[32:35], a[180:183], a[80:83], v[32:35]
  buffer_load_dwordx4 a[40:43], v242, s[24:27], s30 offen offset:2048 sc1
  v_mfma_f32_16x16x32_bf16 v[36:39], a[180:183], a[84:87], v[36:39]
  ds_read_b64_tr_b16 a[162:163], v228 offset:1024
  v_min_u32_dpp v136, v136, v136 row_ror:4 row_mask:0xf bank_mask:0xf
  v_mfma_f32_16x16x32_bf16 v[36:39], a[176:179], a[68:71], v[36:39]
  v_mfma_f32_16x16x32_bf16 v[40:43], a[176:179], a[72:75], v[40:43]
  ds_read_b64_tr_b16 a[164:165], v228 offset:8192
  v_min_u32_dpp v136, v136, v136 row_ror:2 row_mask:0xf bank_mask:0xf
  v_mfma_f32_16x16x32_bf16 v[40:43], a[180:183], a[88:91], v[40:43]
  buffer_load_dwordx4 v239, s[20:23], s31 offen offset:1024 lds
  v_mfma_f32_16x16x32_bf16 v[44:47], a[180:183], a[92:95], v[44:47]
  ds_read_b64_tr_b16 a[166:167], v228 offset:9216
  v_min_u32_dpp v136, v136, v136 row_ror:1 row_mask:0xf bank_mask:0xf
  v_mfma_f32_16x16x32_bf16 v[44:47], a[176:179], a[76:79], v[44:47]
  s_waitcnt lgkmcnt(4)
  v_readlane_b32 s98, v136, 0
  v_readlane_b32 s99, v136, 16
  v_mfma_f32_16x16x32_bf16 v[48:51], a[184:187], a[64:67], v[48:51]
  ds_read_b64_tr_b16 a[168:169], v229 offset:0
  v_readlane_b32 s100, v136, 32
  v_mfma_f32_16x16x32_bf16 v[48:51], a[188:191], a[80:83], v[48:51]
  buffer_load_dwordx4 a[44:47], v242, s[24:27], s30 offen offset:3072 sc1
  v_mfma_f32_16x16x32_bf16 v[52:55], a[188:191], a[84:87], v[52:55]
  ds_read_b64_tr_b16 a[170:171], v229 offset:1024
  v_readlane_b32 s101, v136, 48
  v_mfma_f32_16x16x32_bf16 v[52:55], a[184:187], a[68:71], v[52:55]
  s_min_u32 s98, s98, s99
  s_min_u32 s100, s100, s101
  s_min_u32 s98, s98, s100
  v_mfma_f32_16x16x32_bf16 v[56:59], a[184:187], a[72:75], v[56:59]
  ds_read_b64_tr_b16 a[172:173], v229 offset:8192
  s_sub_u32 s58, s51, s98
  s_sub_u32 s51, s58, 1
  v_sub_u32 v137, s51, v128
  v_mfma_f32_16x16x32_bf16 v[56:59], a[188:191], a[88:91], v[56:59]
  v_sub_u32 v138, s51, v129
  v_min_u32 v136, v137, v138
  v_mfma_f32_16x16x32_bf16 v[60:63], a[188:191], a[92:95], v[60:63]
  ds_read_b64_tr_b16 a[174:175], v229 offset:9216
  v_sub_u32 v139, s51, v130
  v_mfma_f32_16x16x32_bf16 v[60:63], a[184:187], a[76:79], v[60:63]
  s_waitcnt lgkmcnt(4)
  v_sub_u32 v140, s51, v131
  v_min3_u32 v136, v136, v139, v140
  v_mfma_f32_16x16x32_bf16 v[64:67], a[160:163], a[64:67], v[64:67]
  ds_read_b64_tr_b16 a[176:177], v230 offset:0
  v_sub_u32 v137, s51, v132
  v_mfma_f32_16x16x32_bf16 v[64:67], a[164:167], a[80:83], v[64:67]
  buffer_load_dwordx4 a[48:51], v243, s[24:27], s30 offen offset:0 sc1
  v_mfma_f32_16x16x32_bf16 v[68:71], a[164:167], a[84:87], v[68:71]
  ds_read_b64_tr_b16 a[178:179], v230 offset:1024
  v_sub_u32 v138, s51, v133
  v_mfma_f32_16x16x32_bf16 v[68:71], a[160:163], a[68:71], v[68:71]
  v_min3_u32 v136, v136, v137, v138
  v_sub_u32 v139, s51, v134
  v_mfma_f32_16x16x32_bf16 v[72:75], a[160:163], a[72:75], v[72:75]
  ds_read_b64_tr_b16 a[180:181], v230 offset:8192
  v_sub_u32 v140, s51, v135
  v_mfma_f32_16x16x32_bf16 v[72:75], a[164:167], a[88:91], v[72:75]
  buffer_load_dwordx4 v240, s[20:23], s31 offen offset:2048 lds
  v_mfma_f32_16x16x32_bf16 v[76:79], a[164:167], a[92:95], v[76:79]
  ds_read_b64_tr_b16 a[182:183], v230 offset:9216
  v_min3_u32 v136, v136, v139, v140
  v_mfma_f32_16x16x32_bf16 v[76:79], a[160:163], a[76:79], v[76:79]
  s_waitcnt lgkmcnt(4)
  v_min_u32_dpp v136, v136, v136 row_ror:8 row_mask:0xf bank_mask:0xf
  v_mfma_f32_16x16x32_bf16 v[80:83], a[168:171], a[64:67], v[80:83]
  ds_read_b64_tr_b16 a[184:185], v231 offset:0
  v_min_u32_dpp v136, v136, v136 row_ror:4 row_mask:0xf bank_mask:0xf
  v_mfma_f32_16x16x32_bf16 v[80:83], a[172:175], a[80:83], v[80:83]
  buffer_load_dwordx4 a[52:55], v243, s[24:27], s30 offen offset:1024 sc1
  v_mfma_f32_16x16x32_bf16 v[84:87], a[172:175], a[84:87], v[84:87]
  ds_read_b64_tr_b16 a[186:187], v231 offset:1024
  v_min_u32_dpp v136, v136, v136 row_ror:2 row_mask:0xf bank_mask:0xf
  v_mfma_f32_16x16x32_bf16 v[84:87], a[168:171], a[68:71], v[84:87]
  s_waitcnt vmcnt(22)
  v_min_u32_dpp v136, v136, v136 row_ror:1 row_mask:0xf bank_mask:0xf
  v_mfma_f32_16x16x32_bf16 v[88:91], a[168:171], a[72:75], v[88:91]
  ds_read_b64_tr_b16 a[188:189], v231 offset:8192
  v_readlane_b32 s98, v136, 0
  v_readlane_b32 s99, v136, 16
  v_readlane_b32 s100, v136, 32
  v_readlane_b32 s101, v136, 48
  s_min_u32 s98, s98, s99
  s_min_u32 s100, s100, s101
  s_min_u32 s98, s98, s100
  s_sub_u32 s59, s51, s98
  s_sub_u32 s51, s59, 1
  v_writelane_b32 v136, s52, 0
  v_writelane_b32 v136, s53, 1
  v_writelane_b32 v136, s54, 2
  v_writelane_b32 v136, s55, 3
  v_writelane_b32 v136, s56, 4
  v_writelane_b32 v136, s57, 5
  v_writelane_b32 v136, s58, 6
  v_writelane_b32 v136, s59, 7
  s_lshl_b32 s35, s3, 8
  s_add_u32 s35, s35, 158720
  v_lshrrev_b32 v137, 2, v242
  v_add_u32 v137, s35, v137
  ds_write_b32 v137, v136
  s_waitcnt lgkmcnt(0)
  v_mfma_f32_16x16x32_bf16 v[88:91], a[172:175], a[88:91], v[88:91]
  s_barrier
  v_mfma_f32_16x16x32_bf16 v[92:95], a[172:175], a[92:95], v[92:95]
  ds_read_b64_tr_b16 a[190:191], v231 offset:9216
  v_mfma_f32_16x16x32_bf16 v[92:95], a[168:171], a[76:79], v[92:95]
  v_mfma_f32_16x16x32_bf16 v[96:99], a[176:179], a[64:67], v[96:99]
  ds_read_b64_tr_b16 a[160:161], v224 offset:16384
  v_mfma_f32_16x16x32_bf16 v[96:99], a[180:183], a[80:83], v[96:99]
  buffer_load_dwordx4 a[56:59], v243, s[24:27], s30 offen offset:2048 sc1
  v_mfma_f32_16x16x32_bf16 v[100:103], a[180:183], a[84:87], v[100:103]
  ds_read_b64_tr_b16 a[162:163], v224 offset:17408
  v_mfma_f32_16x16x32_bf16 v[100:103], a[176:179], a[68:71], v[100:103]
  v_mfma_f32_16x16x32_bf16 v[104:107], a[176:179], a[72:75], v[104:107]
  ds_read_b64_tr_b16 a[164:165], v224 offset:24576
  v_mfma_f32_16x16x32_bf16 v[104:107], a[180:183], a[88:91], v[104:107]
  buffer_load_dwordx4 v241, s[20:23], s31 offen offset:3072 lds
  s_add_u32 s31, s31, 0x80000
  v_mfma_f32_16x16x32_bf16 v[108:111], a[180:183], a[92:95], v[108:111]
  ds_read_b64_tr_b16 a[166:167], v224 offset:25600
  v_mfma_f32_16x16x32_bf16 v[108:111], a[176:179], a[76:79], v[108:111]
  s_waitcnt lgkmcnt(4)
  v_mfma_f32_16x16x32_bf16 v[112:115], a[184:187], a[64:67], v[112:115]
  ds_read_b64_tr_b16 a[168:169], v225 offset:16384
  v_mfma_f32_16x16x32_bf16 v[112:115], a[188:191], a[80:83], v[112:115]
  buffer_load_dwordx4 a[60:63], v243, s[24:27], s30 offen offset:3072 sc1
  s_add_u32 s30, s30, 8192
  v_mfma_f32_16x16x32_bf16 v[116:119], a[188:191], a[84:87], v[116:119]
  ds_read_b64_tr_b16 a[170:171], v225 offset:17408
  v_mfma_f32_16x16x32_bf16 v[116:119], a[184:187], a[68:71], v[116:119]
  v_mfma_f32_16x16x32_bf16 v[120:123], a[184:187], a[72:75], v[120:123]
  ds_read_b64_tr_b16 a[172:173], v225 offset:24576
  v_mfma_f32_16x16x32_bf16 v[120:123], a[188:191], a[88:91], v[120:123]
  v_mfma_f32_16x16x32_bf16 v[124:127], a[188:191], a[92:95], v[124:127]
  ds_read_b64_tr_b16 a[174:175], v225 offset:25600
  v_mfma_f32_16x16x32_bf16 v[124:127], a[184:187], a[76:79], v[124:127]
  s_waitcnt vmcnt(24) lgkmcnt(4)
  v_mfma_f32_16x16x32_bf16 v[0:3], a[160:163], a[96:99], v[0:3]
  ds_read_b64_tr_b16 a[176:177], v226 offset:16384
  v_lshrrev_b32 v136, 4, v242
  v_mfma_f32_16x16x32_bf16 v[0:3], a[164:167], a[112:115], v[0:3]
  v_bfe_u32 v137, v136, 3, 2
  v_and_b32 v138, 7, v136
  v_mfma_f32_16x16x32_bf16 v[4:7], a[164:167], a[116:119], v[4:7]
  ds_read_b64_tr_b16 a[178:179], v226 offset:17408
  v_lshlrev_b32 v137, 8, v137
  v_mfma_f32_16x16x32_bf16 v[4:7], a[160:163], a[100:103], v[4:7]
  v_lshl_add_u32 v137, v138, 2, v137
  v_add_u32 v137, 158720, v137
  v_mfma_f32_16x16x32_bf16 v[8:11], a[160:163], a[104:107], v[8:11]
  ds_read_b64_tr_b16 a[180:181], v226 offset:24576
  s_add_u32 m0, s28, 0
  ds_read_b32 v128, v137
  v_mfma_f32_16x16x32_bf16 v[8:11], a[164:167], a[120:123], v[8:11]
  buffer_load_dwordx4 v232, s[12:15], s29 offen offset:0 lds
  v_mfma_f32_16x16x32_bf16 v[12:15], a[164:167], a[124:127], v[12:15]
  ds_read_b64_tr_b16 a[182:183], v226 offset:25600
  v_mfma_f32_16x16x32_bf16 v[12:15], a[160:163], a[108:111], v[12:15]
  s_waitcnt lgkmcnt(5)
  v_mfma_f32_16x16x32_bf16 v[16:19], a[168:171], a[96:99], v[16:19]
  ds_read_b64_tr_b16 a[184:185], v227 offset:16384
  v_mfma_f32_16x16x32_bf16 v[16:19], a[172:175], a[112:115], v[16:19]
  v_mfma_f32_16x16x32_bf16 v[20:23], a[172:175], a[116:119], v[20:23]
  ds_read_b64_tr_b16 a[186:187], v227 offset:17408
  v_mfma_f32_16x16x32_bf16 v[20:23], a[168:171], a[100:103], v[20:23]
  v_mfma_f32_16x16x32_bf16 v[24:27], a[168:171], a[104:107], v[24:27]
  ds_read_b64_tr_b16 a[188:189], v227 offset:24576
  s_waitcnt lgkmcnt(4)
  s_mov_b32 s51, -1
  v_sub_u32 v137, s51, v128
  v_mfma_f32_16x16x32_bf16 v[24:27], a[172:175], a[120:123], v[24:27]
  v_mfma_f32_16x16x32_bf16 v[28:31], a[172:175], a[124:127], v[28:31]
  ds_read_b64_tr_b16 a[190:191], v227 offset:25600
  v_min_u32_dpp v137, v137, v137 row_ror:8 row_mask:0xf bank_mask:0xf
  v_mfma_f32_16x16x32_bf16 v[28:31], a[168:171], a[108:111], v[28:31]
  s_waitcnt lgkmcnt(4)
  v_min_u32_dpp v137, v137, v137 row_ror:4 row_mask:0xf bank_mask:0xf
  v_mfma_f32_16x16x32_bf16 v[32:35], a[176:179], a[96:99], v[32:35]
  ds_read_b64_tr_b16 a[160:161], v228 offset:16384
  v_min_u32_dpp v137, v137, v137 row_ror:2 row_mask:0xf bank_mask:0xf
  v_mfma_f32_16x16x32_bf16 v[32:35], a[180:183], a[112:115], v[32:35]
  v_mfma_f32_16x16x32_bf16 v[36:39], a[180:183], a[116:119], v[36:39]
  ds_read_b64_tr_b16 a[162:163], v228 offset:17408
  v_min_u32_dpp v137, v137, v137 row_ror:1 row_mask:0xf bank_mask:0xf
  v_mfma_f32_16x16x32_bf16 v[36:39], a[176:179], a[100:103], v[36:39]
  v_readlane_b32 s98, v137, 0
  v_readlane_b32 s99, v137, 16
  v_mfma_f32_16x16x32_bf16 v[40:43], a[176:179], a[104:107], v[40:43]
  ds_read_b64_tr_b16 a[164:165], v228 offset:24576
  s_min_u32 s98, s98, s99
  s_sub_u32 s52, s51, s98
  s_sub_u32 s51, s52, 1
  v_sub_u32 v137, s51, v128
  v_mfma_f32_16x16x32_bf16 v[40:43], a[180:183], a[120:123], v[40:43]
  buffer_load_dwordx4 v233, s[12:15], s29 offen offset:1024 lds
  v_mfma_f32_16x16x32_bf16 v[44:47], a[180:183], a[124:127], v[44:47]
  ds_read_b64_tr_b16 a[166:167], v228 offset:25600
  v_min_u32_dpp v137, v137, v137 row_ror:8 row_mask:0xf bank_mask:0xf
  v_mfma_f32_16x16x32_bf16 v[44:47], a[176:179], a[108:111], v[44:47]
  s_waitcnt lgkmcnt(4)
  v_min_u32_dpp v137, v137, v137 row_ror:4 row_mask:0xf bank_mask:0xf
  v_mfma_f32_16x16x32_bf16 v[48:51], a[184:187], a[96:99], v[48:51]
  ds_read_b64_tr_b16 a[168:169], v229 offset:16384
  v_min_u32_dpp v137, v137, v137 row_ror:2 row_mask:0xf bank_mask:0xf
  v_mfma_f32_16x16x32_bf16 v[48:51], a[188:191], a[112:115], v[48:51]
  v_mfma_f32_16x16x32_bf16 v[52:55], a[188:191], a[116:119], v[52:55]
  ds_read_b64_tr_b16 a[170:171], v229 offset:17408
  v_min_u32_dpp v137, v137, v137 row_ror:1 row_mask:0xf bank_mask:0xf
  v_mfma_f32_16x16x32_bf16 v[52:55], a[184:187], a[100:103], v[52:55]
  v_readlane_b32 s98, v137, 0
  v_readlane_b32 s99, v137, 16
  v_mfma_f32_16x16x32_bf16 v[56:59], a[184:187], a[104:107], v[56:59]
  ds_read_b64_tr_b16 a[172:173], v229 offset:24576
  s_min_u32 s98, s98, s99
  s_sub_u32 s53, s51, s98
  s_sub_u32 s51, s53, 1
  v_sub_u32 v137, s51, v128
  v_mfma_f32_16x16x32_bf16 v[56:59], a[188:191], a[120:123], v[56:59]
  v_mfma_f32_16x16x32_bf16 v[60:63], a[188:191], a[124:127], v[60:63]
  ds_read_b64_tr_b16 a[174:175], v229 offset:25600
  v_min_u32_dpp v137, v137, v137 row_ror:8 row_mask:0xf bank_mask:0xf
  v_mfma_f32_16x16x32_bf16 v[60:63], a[184:187], a[108:111], v[60:63]
  s_waitcnt lgkmcnt(4)
  v_min_u32_dpp v137, v137, v137 row_ror:4 row_mask:0xf bank_mask:0xf
  v_mfma_f32_16x16x32_bf16 v[64:67], a[160:163], a[96:99], v[64:67]
  ds_read_b64_tr_b16 a[176:177], v230 offset:16384
  v_min_u32_dpp v137, v137, v137 row_ror:2 row_mask:0xf bank_mask:0xf
  v_mfma_f32_16x16x32_bf16 v[64:67], a[164:167], a[112:115], v[64:67]
  v_mfma_f32_16x16x32_bf16 v[68:71], a[164:167], a[116:119], v[68:71]
  ds_read_b64_tr_b16 a[178:179], v230 offset:17408
  v_min_u32_dpp v137, v137, v137 row_ror:1 row_mask:0xf bank_mask:0xf
  v_mfma_f32_16x16x32_bf16 v[68:71], a[160:163], a[100:103], v[68:71]
  v_readlane_b32 s98, v137, 0
  v_readlane_b32 s99, v137, 16
  v_mfma_f32_16x16x32_bf16 v[72:75], a[160:163], a[104:107], v[72:75]
  ds_read_b64_tr_b16 a[180:181], v230 offset:24576
  s_min_u32 s98, s98, s99
  s_sub_u32 s54, s51, s98
  s_sub_u32 s51, s54, 1
  v_sub_u32 v137, s51, v128
  v_mfma_f32_16x16x32_bf16 v[72:75], a[164:167], a[120:123], v[72:75]
  buffer_load_dwordx4 v234, s[12:15], s29 offen offset:2048 lds
  v_mfma_f32_16x16x32_bf16 v[76:79], a[164:167], a[124:127], v[76:79]
  ds_read_b64_tr_b16 a[182:183], v230 offset:25600
  v_min_u32_dpp v137, v137, v137 row_ror:8 row_mask:0xf bank_mask:0xf
  v_mfma_f32_16x16x32_bf16 v[76:79], a[160:163], a[108:111], v[76:79]
  s_waitcnt lgkmcnt(4)
  v_min_u32_dpp v137, v137, v137 row_ror:4 row_mask:0xf bank_mask:0xf
  v_mfma_f32_16x16x32_bf16 v[80:83], a[168:171], a[96:99], v[80:83]
  ds_read_b64_tr_b16 a[184:185], v231 offset:16384
  v_min_u32_dpp v137, v137, v137 row_ror:2 row_mask:0xf bank_mask:0xf
  v_mfma_f32_16x16x32_bf16 v[80:83], a[172:175], a[112:115], v[80:83]
  v_mfma_f32_16x16x32_bf16 v[84:87], a[172:175], a[116:119], v[84:87]
  ds_read_b64_tr_b16 a[186:187], v231 offset:17408
  v_min_u32_dpp v137, v137, v137 row_ror:1 row_mask:0xf bank_mask:0xf
  v_mfma_f32_16x16x32_bf16 v[84:87], a[168:171], a[100:103], v[84:87]
  s_waitcnt vmcnt(16)
  v_readlane_b32 s98, v137, 0
  v_readlane_b32 s99, v137, 16
  v_mfma_f32_16x16x32_bf16 v[88:91], a[168:171], a[104:107], v[88:91]
  ds_read_b64_tr_b16 a[188:189], v231 offset:24576
  s_min_u32 s98, s98, s99
  s_sub_u32 s55, s51, s98
  s_sub_u32 s51, s55, 1
  v_sub_u32 v137, s51, v128
  v_mfma_f32_16x16x32_bf16 v[88:91], a[172:175], a[120:123], v[88:91]
  s_barrier
  v_min_u32_dpp v137, v137, v137 row_ror:8 row_mask:0xf bank_mask:0xf
  v_mfma_f32_16x16x32_bf16 v[92:95], a[172:175], a[124:127], v[92:95]
  ds_read_b64_tr_b16 a[190:191], v231 offset:25600
  v_min_u32_dpp v137, v137, v137 row_ror:4 row_mask:0xf bank_mask:0xf
  v_mfma_f32_16x16x32_bf16 v[92:95], a[168:171], a[108:111], v[92:95]
  s_waitcnt lgkmcnt(4)
  v_min_u32_dpp v137, v137, v137 row_ror:2 row_mask:0xf bank_mask:0xf
  v_mfma_f32_16x16x32_bf16 v[96:99], a[176:179], a[96:99], v[96:99]
  ds_read_b64_tr_b16 a[160:161], v224 offset:32768
  v_min_u32_dpp v137, v137, v137 row_ror:1 row_mask:0xf bank_mask:0xf
  v_mfma_f32_16x16x32_bf16 v[96:99], a[180:183], a[112:115], v[96:99]
  v_readlane_b32 s98, v137, 0
  v_readlane_b32 s99, v137, 16
  v_mfma_f32_16x16x32_bf16 v[100:103], a[180:183], a[116:119], v[100:103]
  ds_read_b64_tr_b16 a[162:163], v224 offset:33792
  s_min_u32 s98, s98, s99
  s_sub_u32 s56, s51, s98
  s_sub_u32 s51, s56, 1
  v_sub_u32 v137, s51, v128
  v_mfma_f32_16x16x32_bf16 v[100:103], a[176:179], a[100:103], v[100:103]
  v_mfma_f32_16x16x32_bf16 v[104:107], a[176:179], a[104:107], v[104:107]
  ds_read_b64_tr_b16 a[164:165], v224 offset:40960
  v_min_u32_dpp v137, v137, v137 row_ror:8 row_mask:0xf bank_mask:0xf
  v_mfma_f32_16x16x32_bf16 v[104:107], a[180:183], a[120:123], v[104:107]
  buffer_load_dwordx4 v235, s[12:15], s29 offen offset:3072 lds
  v_mfma_f32_16x16x32_bf16 v[108:111], a[180:183], a[124:127], v[108:111]
  ds_read_b64_tr_b16 a[166:167], v224 offset:41984
  v_min_u32_dpp v137, v137, v137 row_ror:4 row_mask:0xf bank_mask:0xf
  v_mfma_f32_16x16x32_bf16 v[108:111], a[176:179], a[108:111], v[108:111]
  s_waitcnt lgkmcnt(4)
  v_min_u32_dpp v137, v137, v137 row_ror:2 row_mask:0xf bank_mask:0xf
  v_mfma_f32_16x16x32_bf16 v[112:115], a[184:187], a[96:99], v[112:115]
  ds_read_b64_tr_b16 a[168:169], v225 offset:32768
  v_min_u32_dpp v137, v137, v137 row_ror:1 row_mask:0xf bank_mask:0xf
  v_mfma_f32_16x16x32_bf16 v[112:115], a[188:191], a[112:115], v[112:115]
  v_readlane_b32 s98, v137, 0
  v_readlane_b32 s99, v137, 16
  v_mfma_f32_16x16x32_bf16 v[116:119], a[188:191], a[116:119], v[116:119]
  ds_read_b64_tr_b16 a[170:171], v225 offset:33792
  s_min_u32 s98, s98, s99
  s_sub_u32 s57, s51, s98
  s_sub_u32 s51, s57, 1
  v_sub_u32 v137, s51, v128
  v_mfma_f32_16x16x32_bf16 v[116:119], a[184:187], a[100:103], v[116:119]
  v_mfma_f32_16x16x32_bf16 v[120:123], a[184:187], a[104:107], v[120:123]
  ds_read_b64_tr_b16 a[172:173], v225 offset:40960
  v_min_u32_dpp v137, v137, v137 row_ror:8 row_mask:0xf bank_mask:0xf
  v_mfma_f32_16x16x32_bf16 v[120:123], a[188:191], a[120:123], v[120:123]
  v_mfma_f32_16x16x32_bf16 v[124:127], a[188:191], a[124:127], v[124:127]
  ds_read_b64_tr_b16 a[174:175], v225 offset:41984
  v_min_u32_dpp v137, v137, v137 row_ror:4 row_mask:0xf bank_mask:0xf
  v_mfma_f32_16x16x32_bf16 v[124:127], a[184:187], a[108:111], v[124:127]
  s_waitcnt vmcnt(16) lgkmcnt(4)
  v_min_u32_dpp v137, v137, v137 row_ror:2 row_mask:0xf bank_mask:0xf
  v_mfma_f32_16x16x32_bf16 v[0:3], a[160:163], a[0:3], v[0:3]
  ds_read_b64_tr_b16 a[176:177], v226 offset:32768
  v_min_u32_dpp v137, v137, v137 row_ror:1 row_mask:0xf bank_mask:0xf
  v_mfma_f32_16x16x32_bf16 v[0:3], a[164:167], a[16:19], v[0:3]
  v_readlane_b32 s98, v137, 0
  v_readlane_b32 s99, v137, 16
  v_mfma_f32_16x16x32_bf16 v[4:7], a[164:167], a[20:23], v[4:7]
  ds_read_b64_tr_b16 a[178:179], v226 offset:33792
  s_min_u32 s98, s98, s99
  s_sub_u32 s58, s51, s98
  s_sub_u32 s51, s58, 1
  v_sub_u32 v137, s51, v128
  v_mfma_f32_16x16x32_bf16 v[4:7], a[160:163], a[4:7], v[4:7]
  v_mfma_f32_16x16x32_bf16 v[8:11], a[160:163], a[8:11], v[8:11]
  ds_read_b64_tr_b16 a[180:181], v226 offset:40960
  s_add_u32 m0, s28, 65536
  v_min_u32_dpp v137, v137, v137 row_ror:8 row_mask:0xf bank_mask:0xf
  v_mfma_f32_16x16x32_bf16 v[8:11], a[164:167], a[24:27], v[8:11]
  buffer_load_dwordx4 v236, s[16:19], s29 offen offset:0 lds
  v_mfma_f32_16x16x32_bf16 v[12:15], a[164:167], a[28:31], v[12:15]
  ds_read_b64_tr_b16 a[182:183], v226 offset:41984
  v_min_u32_dpp v137, v137, v137 row_ror:4 row_mask:0xf bank_mask:0xf
  v_mfma_f32_16x16x32_bf16 v[12:15], a[160:163], a[12:15], v[12:15]
  s_waitcnt lgkmcnt(4)
  v_min_u32_dpp v137, v137, v137 row_ror:2 row_mask:0xf bank_mask:0xf
  v_mfma_f32_16x16x32_bf16 v[16:19], a[168:171], a[0:3], v[16:19]
  ds_read_b64_tr_b16 a[184:185], v227 offset:32768
  v_min_u32_dpp v137, v137, v137 row_ror:1 row_mask:0xf bank_mask:0xf
  v_mfma_f32_16x16x32_bf16 v[16:19], a[172:175], a[16:19], v[16:19]
  v_readlane_b32 s98, v137, 0
  v_readlane_b32 s99, v137, 16
  v_mfma_f32_16x16x32_bf16 v[20:23], a[172:175], a[20:23], v[20:23]
  ds_read_b64_tr_b16 a[186:187], v227 offset:33792
  s_min_u32 s98, s98, s99
  s_sub_u32 s59, s51, s98
  s_sub_u32 s51, s59, 1
  v_mov_b32 v128, 0
  v_mfma_f32_16x16x32_bf16 v[20:23], a[168:171], a[4:7], v[20:23]
  v_writelane_b32 v128, s52, 0
  v_writelane_b32 v128, s53, 1
  v_mfma_f32_16x16x32_bf16 v[24:27], a[168:171], a[8:11], v[24:27]
  ds_read_b64_tr_b16 a[188:189], v227 offset:40960
  v_writelane_b32 v128, s54, 2
  v_mfma_f32_16x16x32_bf16 v[24:27], a[172:175], a[24:27], v[24:27]
  v_writelane_b32 v128, s55, 3
  v_writelane_b32 v128, s56, 4
  v_mfma_f32_16x16x32_bf16 v[28:31], a[172:175], a[28:31], v[28:31]
  ds_read_b64_tr_b16 a[190:191], v227 offset:41984
  v_writelane_b32 v128, s57, 5
  v_mfma_f32_16x16x32_bf16 v[28:31], a[168:171], a[12:15], v[28:31]
  s_waitcnt lgkmcnt(4)
  v_writelane_b32 v128, s58, 6
  v_writelane_b32 v128, s59, 7
  v_mfma_f32_16x16x32_bf16 v[32:35], a[176:179], a[0:3], v[32:35]
  ds_read_b64_tr_b16 a[160:161], v228 offset:32768
  v_and_b32 v129, 0xffff, v128
  v_mfma_f32_16x16x32_bf16 v[32:35], a[180:183], a[16:19], v[32:35]
  v_sub_u32 v129, 0xffff, v129
  v_and_b32 v129, 0x7ff, v129
  v_mfma_f32_16x16x32_bf16 v[36:39], a[180:183], a[20:23], v[36:39]
  ds_read_b64_tr_b16 a[162:163], v228 offset:33792
  v_mov_b32 v130, v129
  v_mfma_f32_16x16x32_bf16 v[36:39], a[176:179], a[4:7], v[36:39]
  v_mfma_f32_16x16x32_bf16 v[40:43], a[176:179], a[8:11], v[40:43]
  ds_read_b64_tr_b16 a[164:165], v228 offset:40960
  v_permlane16_swap_b32 v129, v130
  v_mfma_f32_16x16x32_bf16 v[40:43], a[180:183], a[24:27], v[40:43]
  buffer_load_dwordx4 v237, s[16:19], s29 offen offset:1024 lds
  v_mfma_f32_16x16x32_bf16 v[44:47], a[180:183], a[28:31], v[44:47]
  ds_read_b64_tr_b16 a[166:167], v228 offset:41984
  v_mov_b32 v130, v129
  v_mfma_f32_16x16x32_bf16 v[44:47], a[176:179], a[12:15], v[44:47]
  s_waitcnt lgkmcnt(4)
  v_permlane32_swap_b32 v129, v130
  v_lshrrev_b32 v130, 6, v129
  v_mfma_f32_16x16x32_bf16 v[48:51], a[184:187], a[0:3], v[48:51]
  ds_read_b64_tr_b16 a[168:169], v229 offset:32768
  v_mul_u32_u24 v130, 0x14000, v130
  v_mfma_f32_16x16x32_bf16 v[48:51], a[188:191], a[16:19], v[48:51]
  v_bfe_u32 v131, v129, 4, 2
  v_lshl_add_u32 v130, v131, 10, v130
  v_mfma_f32_16x16x32_bf16 v[52:55], a[188:191], a[20:23], v[52:55]
  ds_read_b64_tr_b16 a[170:171], v229 offset:33792
  v_and_b32 v131, 15, v129
  v_mfma_f32_16x16x32_bf16 v[52:55], a[184:187], a[4:7], v[52:55]
  v_lshl_add_u32 v130, v131, 4, v130
  v_lshrrev_b32 v131, 4, v136
  v_mfma_f32_16x16x32_bf16 v[56:59], a[184:187], a[8:11], v[56:59]
  ds_read_b64_tr_b16 a[172:173], v229 offset:40960
  v_lshl_add_u32 v243, v131, 8, v130
  v_mfma_f32_16x16x32_bf16 v[56:59], a[188:191], a[24:27], v[56:59]
  v_mfma_f32_16x16x32_bf16 v[60:63], a[188:191], a[28:31], v[60:63]
  ds_read_b64_tr_b16 a[174:175], v229 offset:41984
  v_mfma_f32_16x16x32_bf16 v[60:63], a[184:187], a[12:15], v[60:63]
  s_waitcnt lgkmcnt(4)
  v_mfma_f32_16x16x32_bf16 v[64:67], a[160:163], a[0:3], v[64:67]
  ds_read_b64_tr_b16 a[176:177], v230 offset:32768
  v_mfma_f32_16x16x32_bf16 v[64:67], a[164:167], a[16:19], v[64:67]
  v_mfma_f32_16x16x32_bf16 v[68:71], a[164:167], a[20:23], v[68:71]
  ds_read_b64_tr_b16 a[178:179], v230 offset:33792
  v_mfma_f32_16x16x32_bf16 v[68:71], a[160:163], a[4:7], v[68:71]
  v_mfma_f32_16x16x32_bf16 v[72:75], a[160:163], a[8:11], v[72:75]
  ds_read_b64_tr_b16 a[180:181], v230 offset:40960
  v_mfma_f32_16x16x32_bf16 v[72:75], a[164:167], a[24:27], v[72:75]
  buffer_load_dwordx4 v236, s[16:19], s29 offen offset:2048 lds
  v_mfma_f32_16x16x32_bf16 v[76:79], a[164:167], a[28:31], v[76:79]
  ds_read_b64_tr_b16 a[182:183], v230 offset:41984
  v_mfma_f32_16x16x32_bf16 v[76:79], a[160:163], a[12:15], v[76:79]
  s_waitcnt lgkmcnt(4)
  v_mfma_f32_16x16x32_bf16 v[80:83], a[168:171], a[0:3], v[80:83]
  ds_read_b64_tr_b16 a[184:185], v231 offset:32768
  v_mfma_f32_16x16x32_bf16 v[80:83], a[172:175], a[16:19], v[80:83]
  v_mfma_f32_16x16x32_bf16 v[84:87], a[172:175], a[20:23], v[84:87]
  ds_read_b64_tr_b16 a[186:187], v231 offset:33792
  v_mfma_f32_16x16x32_bf16 v[84:87], a[168:171], a[4:7], v[84:87]
  s_waitcnt vmcnt(8)
  v_mfma_f32_16x16x32_bf16 v[88:91], a[168:171], a[8:11], v[88:91]
  ds_read_b64_tr_b16 a[188:189], v231 offset:40960
  v_mfma_f32_16x16x32_bf16 v[88:91], a[172:175], a[24:27], v[88:91]
  s_barrier
  v_mfma_f32_16x16x32_bf16 v[92:95], a[172:175], a[28:31], v[92:95]
  ds_read_b64_tr_b16 a[190:191], v231 offset:41984
  v_mfma_f32_16x16x32_bf16 v[92:95], a[168:171], a[12:15], v[92:95]
  s_waitcnt lgkmcnt(4)
  v_mfma_f32_16x16x32_bf16 v[96:99], a[176:179], a[0:3], v[96:99]
  ds_read_b64_tr_b16 a[160:161], v224 offset:49152
  v_mfma_f32_16x16x32_bf16 v[96:99], a[180:183], a[16:19], v[96:99]
  v_mfma_f32_16x16x32_bf16 v[100:103], a[180:183], a[20:23], v[100:103]
  ds_read_b64_tr_b16 a[162:163], v224 offset:50176
  v_mfma_f32_16x16x32_bf16 v[100:103], a[176:179], a[4:7], v[100:103]
  v_mfma_f32_16x16x32_bf16 v[104:107], a[176:179], a[8:11], v[104:107]
  ds_read_b64_tr_b16 a[164:165], v224 offset:57344
  v_mfma_f32_16x16x32_bf16 v[104:107], a[180:183], a[24:27], v[104:107]
  buffer_load_dwordx4 v237, s[16:19], s29 offen offset:3072 lds
  s_add_u32 s29, s29, 16384
  v_mfma_f32_16x16x32_bf16 v[108:111], a[180:183], a[28:31], v[108:111]
  ds_read_b64_tr_b16 a[166:167], v224 offset:58368
  v_mfma_f32_16x16x32_bf16 v[108:111], a[176:179], a[12:15], v[108:111]
  s_waitcnt lgkmcnt(4)
  v_mfma_f32_16x16x32_bf16 v[112:115], a[184:187], a[0:3], v[112:115]
  ds_read_b64_tr_b16 a[168:169], v225 offset:49152
  v_mfma_f32_16x16x32_bf16 v[112:115], a[188:191], a[16:19], v[112:115]
  v_mfma_f32_16x16x32_bf16 v[116:119], a[188:191], a[20:23], v[116:119]
  ds_read_b64_tr_b16 a[170:171], v225 offset:50176
  v_mfma_f32_16x16x32_bf16 v[116:119], a[184:187], a[4:7], v[116:119]
  v_mfma_f32_16x16x32_bf16 v[120:123], a[184:187], a[8:11], v[120:123]
  ds_read_b64_tr_b16 a[172:173], v225 offset:57344
  v_mfma_f32_16x16x32_bf16 v[120:123], a[188:191], a[24:27], v[120:123]
  v_mfma_f32_16x16x32_bf16 v[124:127], a[188:191], a[28:31], v[124:127]
  ds_read_b64_tr_b16 a[174:175], v225 offset:58368
  v_mfma_f32_16x16x32_bf16 v[124:127], a[184:187], a[12:15], v[124:127]
  s_waitcnt vmcnt(8) lgkmcnt(4)
  v_mfma_f32_16x16x32_bf16 v[0:3], a[160:163], a[32:35], v[0:3]
  ds_read_b64_tr_b16 a[176:177], v226 offset:49152
  s_add_u32 m0, s28, 16384
  v_mfma_f32_16x16x32_bf16 v[0:3], a[164:167], a[48:51], v[0:3]
  buffer_load_dwordx4 v232, s[12:15], s29 offen offset:0 lds
  v_mfma_f32_16x16x32_bf16 v[4:7], a[164:167], a[52:55], v[4:7]
  ds_read_b64_tr_b16 a[178:179], v226 offset:50176
  v_mfma_f32_16x16x32_bf16 v[4:7], a[160:163], a[36:39], v[4:7]
  v_mfma_f32_16x16x32_bf16 v[8:11], a[160:163], a[40:43], v[8:11]
  ds_read_b64_tr_b16 a[180:181], v226 offset:57344
  v_mfma_f32_16x16x32_bf16 v[8:11], a[164:167], a[56:59], v[8:11]
  buffer_load_dwordx4 v233, s[12:15], s29 offen offset:1024 lds
  v_mfma_f32_16x16x32_bf16 v[12:15], a[164:167], a[60:63], v[12:15]
  ds_read_b64_tr_b16 a[182:183], v226 offset:58368
  v_mfma_f32_16x16x32_bf16 v[12:15], a[160:163], a[44:47], v[12:15]
  s_waitcnt lgkmcnt(4)
  v_mfma_f32_16x16x32_bf16 v[16:19], a[168:171], a[32:35], v[16:19]
  ds_read_b64_tr_b16 a[184:185], v227 offset:49152
  v_mfma_f32_16x16x32_bf16 v[16:19], a[172:175], a[48:51], v[16:19]
  buffer_load_dwordx4 v234, s[12:15], s29 offen offset:2048 lds
  v_mfma_f32_16x16x32_bf16 v[20:23], a[172:175], a[52:55], v[20:23]
  ds_read_b64_tr_b16 a[186:187], v227 offset:50176
  v_mfma_f32_16x16x32_bf16 v[20:23], a[168:171], a[36:39], v[20:23]
  buffer_load_dwordx4 v235, s[12:15], s29 offen offset:3072 lds
  v_mfma_f32_16x16x32_bf16 v[24:27], a[168:171], a[40:43], v[24:27]
  ds_read_b64_tr_b16 a[188:189], v227 offset:57344
  v_mfma_f32_16x16x32_bf16 v[24:27], a[172:175], a[56:59], v[24:27]
  v_mul_f32 v0, s34, v0
  v_mul_f32 v1, s34, v1
  v_mfma_f32_16x16x32_bf16 v[28:31], a[172:175], a[60:63], v[28:31]
  ds_read_b64_tr_b16 a[190:191], v227 offset:58368
  v_mul_f32 v2, s34, v2
  v_mfma_f32_16x16x32_bf16 v[28:31], a[168:171], a[44:47], v[28:31]
  s_waitcnt lgkmcnt(4)
  v_mul_f32 v3, s34, v3
  v_mul_f32 v16, s34, v16
  v_mfma_f32_16x16x32_bf16 v[32:35], a[176:179], a[32:35], v[32:35]
  ds_read_b64_tr_b16 a[160:161], v228 offset:49152
  v_mul_f32 v17, s34, v17
  v_mfma_f32_16x16x32_bf16 v[32:35], a[180:183], a[48:51], v[32:35]
  v_mul_f32 v18, s34, v18
  v_mul_f32 v19, s34, v19
  v_mfma_f32_16x16x32_bf16 v[36:39], a[180:183], a[52:55], v[36:39]
  ds_read_b64_tr_b16 a[162:163], v228 offset:50176
  v_cvt_pk_bf16_f32 v128, v0, v1
  v_mfma_f32_16x16x32_bf16 v[36:39], a[176:179], a[36:39], v[36:39]
  v_cvt_pk_bf16_f32 v129, v2, v3
  v_cvt_pk_bf16_f32 v130, v16, v17
  v_mfma_f32_16x16x32_bf16 v[40:43], a[176:179], a[40:43], v[40:43]
  ds_read_b64_tr_b16 a[164:165], v228 offset:57344
  v_cvt_pk_bf16_f32 v131, v18, v19
  v_mfma_f32_16x16x32_bf16 v[40:43], a[180:183], a[56:59], v[40:43]
  v_mul_f32 v4, s34, v4
  v_mul_f32 v5, s34, v5
  v_mfma_f32_16x16x32_bf16 v[44:47], a[180:183], a[60:63], v[44:47]
  ds_read_b64_tr_b16 a[166:167], v228 offset:58368
  v_mul_f32 v6, s34, v6
  v_mfma_f32_16x16x32_bf16 v[44:47], a[176:179], a[44:47], v[44:47]
  s_waitcnt lgkmcnt(4)
  v_mul_f32 v7, s34, v7
  v_mul_f32 v20, s34, v20
  v_mfma_f32_16x16x32_bf16 v[48:51], a[184:187], a[32:35], v[48:51]
  ds_read_b64_tr_b16 a[168:169], v229 offset:49152
  v_mul_f32 v21, s34, v21
  v_mfma_f32_16x16x32_bf16 v[48:51], a[188:191], a[48:51], v[48:51]
  v_mul_f32 v22, s34, v22
  v_mul_f32 v23, s34, v23
  v_mfma_f32_16x16x32_bf16 v[52:55], a[188:191], a[52:55], v[52:55]
  ds_read_b64_tr_b16 a[170:171], v229 offset:50176
  v_cvt_pk_bf16_f32 v144, v4, v5
  v_mfma_f32_16x16x32_bf16 v[52:55], a[184:187], a[36:39], v[52:55]
  v_cvt_pk_bf16_f32 v145, v6, v7
  v_cvt_pk_bf16_f32 v146, v20, v21
  v_mfma_f32_16x16x32_bf16 v[56:59], a[184:187], a[40:43], v[56:59]
  ds_read_b64_tr_b16 a[172:173], v229 offset:57344
  v_cvt_pk_bf16_f32 v147, v22, v23
  v_mfma_f32_16x16x32_bf16 v[56:59], a[188:191], a[56:59], v[56:59]
  v_permlane16_swap_b32 v128, v130
  v_permlane16_swap_b32 v129, v131
  v_mfma_f32_16x16x32_bf16 v[60:63], a[188:191], a[60:63], v[60:63]
  ds_read_b64_tr_b16 a[174:175], v229 offset:58368
  v_mul_f32 v8, s34, v8
  v_mfma_f32_16x16x32_bf16 v[60:63], a[184:187], a[44:47], v[60:63]
  s_waitcnt lgkmcnt(4)
  v_mul_f32 v9, s34, v9
  v_mul_f32 v10, s34, v10
  v_mfma_f32_16x16x32_bf16 v[64:67], a[160:163], a[32:35], v[64:67]
  ds_read_b64_tr_b16 a[176:177], v230 offset:49152
  v_mul_f32 v11, s34, v11
  v_mfma_f32_16x16x32_bf16 v[64:67], a[164:167], a[48:51], v[64:67]
  v_mul_f32 v24, s34, v24
  v_mul_f32 v25, s34, v25
  v_mfma_f32_16x16x32_bf16 v[68:71], a[164:167], a[52:55], v[68:71]
  ds_read_b64_tr_b16 a[178:179], v230 offset:50176
  v_mul_f32 v26, s34, v26
  v_mfma_f32_16x16x32_bf16 v[68:71], a[160:163], a[36:39], v[68:71]
  v_mul_f32 v27, s34, v27
  v_cvt_pk_bf16_f32 v160, v8, v9
  v_mfma_f32_16x16x32_bf16 v[72:75], a[160:163], a[40:43], v[72:75]
  ds_read_b64_tr_b16 a[180:181], v230 offset:57344
  v_cvt_pk_bf16_f32 v161, v10, v11
  v_mfma_f32_16x16x32_bf16 v[72:75], a[164:167], a[56:59], v[72:75]
  v_cvt_pk_bf16_f32 v162, v24, v25
  v_cvt_pk_bf16_f32 v163, v26, v27
  v_mfma_f32_16x16x32_bf16 v[76:79], a[164:167], a[60:63], v[76:79]
  ds_read_b64_tr_b16 a[182:183], v230 offset:58368
  v_permlane16_swap_b32 v144, v146
  v_mfma_f32_16x16x32_bf16 v[76:79], a[160:163], a[44:47], v[76:79]
  s_waitcnt lgkmcnt(4)
  v_permlane16_swap_b32 v145, v147
  v_mul_f32 v12, s34, v12
  v_mfma_f32_16x16x32_bf16 v[80:83], a[168:171], a[32:35], v[80:83]
  ds_read_b64_tr_b16 a[184:185], v231 offset:49152
  v_mul_f32 v13, s34, v13
  v_mfma_f32_16x16x32_bf16 v[80:83], a[172:175], a[48:51], v[80:83]
  v_mul_f32 v14, s34, v14
  v_mul_f32 v15, s34, v15
  v_mfma_f32_16x16x32_bf16 v[84:87], a[172:175], a[52:55], v[84:87]
  ds_read_b64_tr_b16 a[186:187], v231 offset:50176
  v_mul_f32 v28, s34, v28
  v_mfma_f32_16x16x32_bf16 v[84:87], a[168:171], a[36:39], v[84:87]
  s_waitcnt vmcnt(8)
  v_mul_f32 v29, s34, v29
  v_mul_f32 v30, s34, v30
  v_mfma_f32_16x16x32_bf16 v[88:91], a[168:171], a[40:43], v[88:91]
  ds_read_b64_tr_b16 a[188:189], v231 offset:57344
  v_mul_f32 v31, s34, v31
  v_mfma_f32_16x16x32_bf16 v[88:91], a[172:175], a[56:59], v[88:91]
  s_barrier
  v_cvt_pk_bf16_f32 v176, v12, v13
  v_cvt_pk_bf16_f32 v177, v14, v15
  v_mfma_f32_16x16x32_bf16 v[92:95], a[172:175], a[60:63], v[92:95]
  ds_read_b64_tr_b16 a[190:191], v231 offset:58368
  v_cvt_pk_bf16_f32 v178, v28, v29
  v_mfma_f32_16x16x32_bf16 v[92:95], a[168:171], a[44:47], v[92:95]
  s_waitcnt lgkmcnt(4)
  v_cvt_pk_bf16_f32 v179, v30, v31
  v_permlane16_swap_b32 v160, v162
  v_mfma_f32_16x16x32_bf16 v[96:99], a[176:179], a[32:35], v[96:99]
  ds_read_b128 a[128:131], v212 offset:0
  v_permlane16_swap_b32 v161, v163
  v_mfma_f32_16x16x32_bf16 v[96:99], a[180:183], a[48:51], v[96:99]
  v_mul_f32 v32, s34, v32
  v_mul_f32 v33, s34, v33
  v_mfma_f32_16x16x32_bf16 v[100:103], a[180:183], a[52:55], v[100:103]
  ds_read_b128 a[132:135], v213 offset:0
  v_mul_f32 v34, s34, v34
  v_mfma_f32_16x16x32_bf16 v[100:103], a[176:179], a[36:39], v[100:103]
  v_mul_f32 v35, s34, v35
  v_mul_f32 v48, s34, v48
  v_mfma_f32_16x16x32_bf16 v[104:107], a[176:179], a[40:43], v[104:107]
  ds_read_b128 a[136:139], v214 offset:0
  v_mul_f32 v49, s34, v49
  v_mfma_f32_16x16x32_bf16 v[104:107], a[180:183], a[56:59], v[104:107]
  v_mul_f32 v50, s34, v50
  v_mul_f32 v51, s34, v51
  v_mfma_f32_16x16x32_bf16 v[108:111], a[180:183], a[60:63], v[108:111]
  ds_read_b128 a[140:143], v215 offset:0
  v_cvt_pk_bf16_f32 v132, v32, v33
  v_mfma_f32_16x16x32_bf16 v[108:111], a[176:179], a[44:47], v[108:111]
  s_waitcnt lgkmcnt(4)
  v_cvt_pk_bf16_f32 v133, v34, v35
  v_cvt_pk_bf16_f32 v134, v48, v49
  v_mfma_f32_16x16x32_bf16 v[112:115], a[184:187], a[32:35], v[112:115]
  v_cvt_pk_bf16_f32 v135, v50, v51
  v_permlane16_swap_b32 v176, v178
  v_mfma_f32_16x16x32_bf16 v[112:115], a[188:191], a[48:51], v[112:115]
  v_permlane16_swap_b32 v177, v179
  v_mul_f32 v36, s34, v36
  v_mfma_f32_16x16x32_bf16 v[116:119], a[188:191], a[52:55], v[116:119]
  v_mul_f32 v37, s34, v37
  v_mul_f32 v38, s34, v38
  v_mfma_f32_16x16x32_bf16 v[116:119], a[184:187], a[36:39], v[116:119]
  v_mul_f32 v39, s34, v39
  v_mul_f32 v52, s34, v52
  v_mfma_f32_16x16x32_bf16 v[120:123], a[184:187], a[40:43], v[120:123]
  v_mul_f32 v53, s34, v53
  v_mul_f32 v54, s34, v54
  v_mfma_f32_16x16x32_bf16 v[120:123], a[188:191], a[56:59], v[120:123]
  v_mul_f32 v55, s34, v55
  v_cvt_pk_bf16_f32 v148, v36, v37
  v_mfma_f32_16x16x32_bf16 v[124:127], a[188:191], a[60:63], v[124:127]
  v_cvt_pk_bf16_f32 v149, v38, v39
  v_cvt_pk_bf16_f32 v150, v52, v53
  v_mfma_f32_16x16x32_bf16 v[124:127], a[184:187], a[44:47], v[124:127]
  s_waitcnt lgkmcnt(0)
  v_cvt_pk_bf16_f32 v151, v54, v55
  v_permlane16_swap_b32 v132, v134
  v_permlane16_swap_b32 v133, v135
  v_pk_mul_f32 v[40:41], v[40:41], s[34:35] op_sel_hi:[1,0]
  v_pk_mul_f32 v[42:43], v[42:43], s[34:35] op_sel_hi:[1,0]
  v_pk_mul_f32 v[56:57], v[56:57], s[34:35] op_sel_hi:[1,0]
  v_pk_mul_f32 v[58:59], v[58:59], s[34:35] op_sel_hi:[1,0]
  v_cvt_pk_bf16_f32 v164, v40, v41
  v_cvt_pk_bf16_f32 v165, v42, v43
  v_cvt_pk_bf16_f32 v166, v56, v57
  v_cvt_pk_bf16_f32 v167, v58, v59
  v_permlane16_swap_b32 v148, v150
  v_permlane16_swap_b32 v149, v151
  v_pk_mul_f32 v[44:45], v[44:45], s[34:35] op_sel_hi:[1,0]
  v_pk_mul_f32 v[46:47], v[46:47], s[34:35] op_sel_hi:[1,0]
  v_pk_mul_f32 v[60:61], v[60:61], s[34:35] op_sel_hi:[1,0]
  v_pk_mul_f32 v[62:63], v[62:63], s[34:35] op_sel_hi:[1,0]
  v_cvt_pk_bf16_f32 v180, v44, v45
  v_cvt_pk_bf16_f32 v181, v46, v47
  v_cvt_pk_bf16_f32 v182, v60, v61
  v_cvt_pk_bf16_f32 v183, v62, v63
  v_permlane16_swap_b32 v164, v166
  v_permlane16_swap_b32 v165, v167
  v_pk_mul_f32 v[64:65], v[64:65], s[34:35] op_sel_hi:[1,0]
  v_pk_mul_f32 v[66:67], v[66:67], s[34:35] op_sel_hi:[1,0]
  v_pk_mul_f32 v[80:81], v[80:81], s[34:35] op_sel_hi:[1,0]
  v_pk_mul_f32 v[82:83], v[82:83], s[34:35] op_sel_hi:[1,0]
  v_cvt_pk_bf16_f32 v136, v64, v65
  v_cvt_pk_bf16_f32 v137, v66, v67
  v_cvt_pk_bf16_f32 v138, v80, v81
  v_cvt_pk_bf16_f32 v139, v82, v83
  v_permlane16_swap_b32 v180, v182
  v_permlane16_swap_b32 v181, v183
  v_pk_mul_f32 v[68:69], v[68:69], s[34:35] op_sel_hi:[1,0]
  v_pk_mul_f32 v[70:71], v[70:71], s[34:35] op_sel_hi:[1,0]
  v_pk_mul_f32 v[84:85], v[84:85], s[34:35] op_sel_hi:[1,0]
  v_pk_mul_f32 v[86:87], v[86:87], s[34:35] op_sel_hi:[1,0]
  v_cvt_pk_bf16_f32 v152, v68, v69
  v_cvt_pk_bf16_f32 v153, v70, v71
  v_cvt_pk_bf16_f32 v154, v84, v85
  v_cvt_pk_bf16_f32 v155, v86, v87
  v_permlane16_swap_b32 v136, v138
  v_permlane16_swap_b32 v137, v139
  v_pk_mul_f32 v[72:73], v[72:73], s[34:35] op_sel_hi:[1,0]
  v_pk_mul_f32 v[74:75], v[74:75], s[34:35] op_sel_hi:[1,0]
  v_pk_mul_f32 v[88:89], v[88:89], s[34:35] op_sel_hi:[1,0]
  v_pk_mul_f32 v[90:91], v[90:91], s[34:35] op_sel_hi:[1,0]
  v_cvt_pk_bf16_f32 v168, v72, v73
  v_cvt_pk_bf16_f32 v169, v74, v75
  v_cvt_pk_bf16_f32 v170, v88, v89
  v_cvt_pk_bf16_f32 v171, v90, v91
  v_permlane16_swap_b32 v152, v154
  v_permlane16_swap_b32 v153, v155
  v_pk_mul_f32 v[76:77], v[76:77], s[34:35] op_sel_hi:[1,0]
  v_pk_mul_f32 v[78:79], v[78:79], s[34:35] op_sel_hi:[1,0]
  v_pk_mul_f32 v[92:93], v[92:93], s[34:35] op_sel_hi:[1,0]
  v_pk_mul_f32 v[94:95], v[94:95], s[34:35] op_sel_hi:[1,0]
  v_cvt_pk_bf16_f32 v184, v76, v77
  v_cvt_pk_bf16_f32 v185, v78, v79
  v_cvt_pk_bf16_f32 v186, v92, v93
  v_cvt_pk_bf16_f32 v187, v94, v95
  v_permlane16_swap_b32 v168, v170
  v_permlane16_swap_b32 v169, v171
  v_pk_mul_f32 v[96:97], v[96:97], s[34:35] op_sel_hi:[1,0]
  v_pk_mul_f32 v[98:99], v[98:99], s[34:35] op_sel_hi:[1,0]
  v_pk_mul_f32 v[112:113], v[112:113], s[34:35] op_sel_hi:[1,0]
  v_pk_mul_f32 v[114:115], v[114:115], s[34:35] op_sel_hi:[1,0]
  v_cvt_pk_bf16_f32 v140, v96, v97
  v_cvt_pk_bf16_f32 v141, v98, v99
  v_cvt_pk_bf16_f32 v142, v112, v113
  v_cvt_pk_bf16_f32 v143, v114, v115
  v_permlane16_swap_b32 v184, v186
  v_permlane16_swap_b32 v185, v187
  v_pk_mul_f32 v[100:101], v[100:101], s[34:35] op_sel_hi:[1,0]
  v_pk_mul_f32 v[102:103], v[102:103], s[34:35] op_sel_hi:[1,0]
  v_pk_mul_f32 v[116:117], v[116:117], s[34:35] op_sel_hi:[1,0]
  v_pk_mul_f32 v[118:119], v[118:119], s[34:35] op_sel_hi:[1,0]
  v_cvt_pk_bf16_f32 v156, v100, v101
  v_cvt_pk_bf16_f32 v157, v102, v103
  v_cvt_pk_bf16_f32 v158, v116, v117
  v_cvt_pk_bf16_f32 v159, v118, v119
  v_permlane16_swap_b32 v140, v142
  v_permlane16_swap_b32 v141, v143
  v_pk_mul_f32 v[104:105], v[104:105], s[34:35] op_sel_hi:[1,0]
  v_pk_mul_f32 v[106:107], v[106:107], s[34:35] op_sel_hi:[1,0]
  v_pk_mul_f32 v[120:121], v[120:121], s[34:35] op_sel_hi:[1,0]
  v_pk_mul_f32 v[122:123], v[122:123], s[34:35] op_sel_hi:[1,0]
  v_cvt_pk_bf16_f32 v172, v104, v105
  v_cvt_pk_bf16_f32 v173, v106, v107
  v_cvt_pk_bf16_f32 v174, v120, v121
  v_cvt_pk_bf16_f32 v175, v122, v123
  v_permlane16_swap_b32 v156, v158
  v_permlane16_swap_b32 v157, v159
  v_pk_mul_f32 v[108:109], v[108:109], s[34:35] op_sel_hi:[1,0]
  v_pk_mul_f32 v[110:111], v[110:111], s[34:35] op_sel_hi:[1,0]
  v_pk_mul_f32 v[124:125], v[124:125], s[34:35] op_sel_hi:[1,0]
  v_pk_mul_f32 v[126:127], v[126:127], s[34:35] op_sel_hi:[1,0]
  v_cvt_pk_bf16_f32 v188, v108, v109
  v_cvt_pk_bf16_f32 v189, v110, v111
  v_cvt_pk_bf16_f32 v190, v124, v125
  v_cvt_pk_bf16_f32 v191, v126, v127
  v_permlane16_swap_b32 v172, v174
  v_permlane16_swap_b32 v173, v175
  v_permlane16_swap_b32 v188, v190
  v_permlane16_swap_b32 v189, v191
  v_mfma_f32_16x16x32_bf16 v[0:3], a[128:131], v[128:131], 0
  s_add_u32 m0, s28, 81920
  ds_read_b128 a[144:147], v212 offset:4096
  s_mov_b32 s20, s90
  s_mov_b32 s21, s91
  v_mfma_f32_16x16x32_bf16 v[0:3], a[132:135], v[132:135], v[0:3]
  buffer_load_dwordx4 v236, s[16:19], s29 offen offset:0 lds
  s_mov_b32 s22, 2211840
  s_mov_b32 s23, 0x20000
  s_mov_b32 s44, s92
  v_mfma_f32_16x16x32_bf16 v[0:3], a[136:139], v[136:139], v[0:3]
  ds_read_b128 a[148:151], v213 offset:4096
  s_mov_b32 s45, s93
  s_mov_b32 s46, 2211840
  s_mov_b32 s47, 0x20000
  v_lshrrev_b32 v253, 4, v242
  v_mfma_f32_16x16x32_bf16 v[0:3], a[140:143], v[140:143], v[0:3]
  buffer_load_dwordx4 v237, s[16:19], s29 offen offset:1024 lds
  v_mfma_f32_16x16x32_bf16 v[8:11], a[140:143], v[156:159], 0
  ds_read_b128 a[152:155], v214 offset:4096
  v_mul_u32_u24 v253, 0xd80, v253
  v_mfma_f32_16x16x32_bf16 v[8:11], a[136:139], v[152:155], v[8:11]
  buffer_load_dwordx4 v236, s[16:19], s29 offen offset:2048 lds
  s_mul_i32 s35, s3, 552960
  s_lshl_b32 s38, s33, 4
  s_add_u32 s35, s35, s38
  v_mfma_f32_16x16x32_bf16 v[8:11], a[132:135], v[148:151], v[8:11]
  ds_read_b128 a[156:159], v215 offset:4096
  v_mfma_f32_16x16x32_bf16 v[8:11], a[128:131], v[144:147], v[8:11]
  buffer_load_dwordx4 v237, s[16:19], s29 offen offset:3072 lds
  v_mfma_f32_16x16x32_bf16 v[16:19], a[128:131], v[160:163], 0
  s_add_u32 s29, s29, 16384
  s_add_u32 m0, s28, 32768
  v_mfma_f32_16x16x32_bf16 v[16:19], a[132:135], v[164:167], v[16:19]
  buffer_load_dwordx4 v232, s[12:15], s29 offen offset:0 lds
  v_mfma_f32_16x16x32_bf16 v[16:19], a[136:139], v[168:171], v[16:19]
  buffer_load_dwordx4 v233, s[12:15], s29 offen offset:1024 lds
  v_mfma_f32_16x16x32_bf16 v[16:19], a[140:143], v[172:175], v[16:19]
  v_max3_f32 v192, v0, v1, v2
  v_max3_f32 v196, v8, v9, v10
  v_mfma_f32_16x16x32_bf16 v[24:27], a[140:143], v[188:191], 0
  v_max_f32 v192, v192, v3
  v_max_f32 v196, v196, v11
  v_mfma_f32_16x16x32_bf16 v[24:27], a[136:139], v[184:187], v[24:27]
  v_mov_b32 v245, v192
  v_mov_b32 v246, v196
  v_mfma_f32_16x16x32_bf16 v[24:27], a[132:135], v[180:183], v[24:27]
  v_permlane16_swap_b32 v192, v245
  v_permlane16_swap_b32 v196, v246
  v_mfma_f32_16x16x32_bf16 v[24:27], a[128:131], v[176:179], v[24:27]
  s_waitcnt lgkmcnt(0)
  v_max_f32 v192, v192, v245
  v_max_f32 v196, v196, v246
  v_mfma_f32_16x16x32_bf16 v[4:7], a[144:147], v[128:131], 0
  ds_read_b128 a[128:131], v212 offset:8192
  v_mov_b32 v245, v192
  v_mfma_f32_16x16x32_bf16 v[4:7], a[148:151], v[132:135], v[4:7]
  v_mov_b32 v246, v196
  v_permlane32_swap_b32 v192, v245
  v_mfma_f32_16x16x32_bf16 v[4:7], a[152:155], v[136:139], v[4:7]
  ds_read_b128 a[132:135], v213 offset:8192
  v_permlane32_swap_b32 v196, v246
  v_mfma_f32_16x16x32_bf16 v[4:7], a[156:159], v[140:143], v[4:7]
  v_max_f32 v192, v192, v245
  v_max_f32 v196, v196, v246
  v_mfma_f32_16x16x32_bf16 v[12:15], a[156:159], v[156:159], 0
  ds_read_b128 a[136:139], v214 offset:8192
  v_sub_f32 v193, 0, v192
  v_mfma_f32_16x16x32_bf16 v[12:15], a[152:155], v[152:155], v[12:15]
  v_sub_f32 v197, 0, v196
  v_sub_f32 v194, 0, v192
  v_mfma_f32_16x16x32_bf16 v[12:15], a[148:151], v[148:151], v[12:15]
  ds_read_b128 a[140:143], v215 offset:8192
  v_sub_f32 v198, 0, v196
  v_mfma_f32_16x16x32_bf16 v[12:15], a[144:147], v[144:147], v[12:15]
  v_sub_f32 v195, 0, v192
  v_sub_f32 v199, 0, v196
  v_mfma_f32_16x16x32_bf16 v[20:23], a[144:147], v[160:163], 0
  buffer_load_dwordx4 v234, s[12:15], s29 offen offset:2048 lds
  v_mfma_f32_16x16x32_bf16 v[20:23], a[148:151], v[164:167], v[20:23]
  v_sub_f32 v192, 0, v192
  v_sub_f32 v196, 0, v196
  v_mfma_f32_16x16x32_bf16 v[20:23], a[152:155], v[168:171], v[20:23]
  buffer_load_dwordx4 v235, s[12:15], s29 offen offset:3072 lds
  v_mfma_f32_16x16x32_bf16 v[20:23], a[156:159], v[172:175], v[20:23]
  v_max3_f32 v200, v16, v17, v18
  v_max3_f32 v204, v24, v25, v26
  v_mfma_f32_16x16x32_bf16 v[28:31], a[156:159], v[188:191], 0
  v_max_f32 v200, v200, v19
  v_max_f32 v204, v204, v27
  v_mfma_f32_16x16x32_bf16 v[28:31], a[152:155], v[184:187], v[28:31]
  v_mov_b32 v247, v200
  v_mov_b32 v248, v204
  v_mfma_f32_16x16x32_bf16 v[28:31], a[148:151], v[180:183], v[28:31]
  v_permlane16_swap_b32 v200, v247
  v_permlane16_swap_b32 v204, v248
  v_max_f32 v200, v200, v247
  v_max_f32 v204, v204, v248
  v_mov_b32 v247, v200
  v_mov_b32 v248, v204
  s_nop 0
  v_permlane32_swap_b32 v200, v247
  v_permlane32_swap_b32 v204, v248
  v_max_f32 v200, v200, v247
  v_max_f32 v204, v204, v248
  v_sub_f32 v201, 0, v200
  v_sub_f32 v205, 0, v204
  v_sub_f32 v202, 0, v200
  v_sub_f32 v206, 0, v204
  v_sub_f32 v203, 0, v200
  v_sub_f32 v207, 0, v204
  v_sub_f32 v200, 0, v200
  v_sub_f32 v204, 0, v204
  v_mfma_f32_16x16x32_bf16 v[28:31], a[144:147], v[176:179], v[28:31]
  s_waitcnt lgkmcnt(0)
  v_add_f32 v0, v192, v0
  v_add_f32 v1, v192, v1
  v_mfma_f32_16x16x32_bf16 v[32:35], a[128:131], v[128:131], v[192:195]
  ds_read_b128 a[144:147], v212 offset:12288
  v_add_f32 v2, v192, v2
  v_mfma_f32_16x16x32_bf16 v[32:35], a[132:135], v[132:135], v[32:35]
  v_add_f32 v3, v192, v3
  v_mfma_f32_16x16x32_bf16 v[32:35], a[136:139], v[136:139], v[32:35]
  ds_read_b128 a[148:151], v213 offset:12288
  v_mfma_f32_16x16x32_bf16 v[32:35], a[140:143], v[140:143], v[32:35]
  v_exp_f32 v0, v0
  v_mfma_f32_16x16x32_bf16 v[40:43], a[140:143], v[156:159], v[196:199]
  ds_read_b128 a[152:155], v214 offset:12288
  v_mfma_f32_16x16x32_bf16 v[40:43], a[136:139], v[152:155], v[40:43]
  v_exp_f32 v1, v1
  v_mfma_f32_16x16x32_bf16 v[40:43], a[132:135], v[148:151], v[40:43]
  ds_read_b128 a[156:159], v215 offset:12288
  v_mfma_f32_16x16x32_bf16 v[40:43], a[128:131], v[144:147], v[40:43]
  v_exp_f32 v2, v2
  v_mfma_f32_16x16x32_bf16 v[48:51], a[128:131], v[160:163], v[200:203]
  s_add_u32 m0, s50, 0
  v_cvt_pk_bf16_f32 v0, v0, v1
  v_mfma_f32_16x16x32_bf16 v[48:51], a[132:135], v[164:167], v[48:51]
  v_exp_f32 v3, v3
  v_mfma_f32_16x16x32_bf16 v[48:51], a[136:139], v[168:171], v[48:51]
  v_add_f32 v8, v196, v8
  v_add_f32 v9, v196, v9
  v_mfma_f32_16x16x32_bf16 v[48:51], a[140:143], v[172:175], v[48:51]
  v_add_f32 v10, v196, v10
  v_add_f32 v11, v196, v11
  v_mfma_f32_16x16x32_bf16 v[56:59], a[140:143], v[188:191], v[204:207]
  v_exp_f32 v8, v8
  v_mfma_f32_16x16x32_bf16 v[56:59], a[136:139], v[184:187], v[56:59]
  v_exp_f32 v9, v9
  buffer_load_dwordx4 v253, s[20:23], s35 offen lds
  v_mfma_f32_16x16x32_bf16 v[56:59], a[132:135], v[180:183], v[56:59]
  v_exp_f32 v10, v10
  v_mfma_f32_16x16x32_bf16 v[56:59], a[128:131], v[176:179], v[56:59]
  s_waitcnt lgkmcnt(0)
  v_cvt_pk_bf16_f32 v8, v8, v9
  v_mfma_f32_16x16x32_bf16 v[36:39], a[144:147], v[128:131], v[192:195]
  s_waitcnt vmcnt(9)
  v_exp_f32 v11, v11
  v_mfma_f32_16x16x32_bf16 v[36:39], a[148:151], v[132:135], v[36:39]
  s_barrier
  v_cvt_pk_bf16_f32 v1, v2, v3
  v_add_f32 v16, v200, v16
  v_mfma_f32_16x16x32_bf16 v[36:39], a[152:155], v[136:139], v[36:39]
  ds_read_b128 a[128:131], v212 offset:16384
  v_add_f32 v17, v200, v17
  v_mfma_f32_16x16x32_bf16 v[36:39], a[156:159], v[140:143], v[36:39]
  v_add_f32 v18, v200, v18
  v_add_f32 v19, v200, v19
  v_mfma_f32_16x16x32_bf16 v[44:47], a[156:159], v[156:159], v[196:199]
  ds_read_b128 a[132:135], v213 offset:16384
  v_mfma_f32_16x16x32_bf16 v[44:47], a[152:155], v[152:155], v[44:47]
  v_exp_f32 v16, v16
  v_mfma_f32_16x16x32_bf16 v[44:47], a[148:151], v[148:151], v[44:47]
  ds_read_b128 a[136:139], v214 offset:16384
  v_mfma_f32_16x16x32_bf16 v[44:47], a[144:147], v[144:147], v[44:47]
  v_exp_f32 v17, v17
  v_mfma_f32_16x16x32_bf16 v[52:55], a[144:147], v[160:163], v[200:203]
  ds_read_b128 a[140:143], v215 offset:16384
  v_mfma_f32_16x16x32_bf16 v[52:55], a[148:151], v[164:167], v[52:55]
  v_exp_f32 v18, v18
  v_mfma_f32_16x16x32_bf16 v[52:55], a[152:155], v[168:171], v[52:55]
  v_cvt_pk_bf16_f32 v16, v16, v17
  v_mfma_f32_16x16x32_bf16 v[52:55], a[156:159], v[172:175], v[52:55]
  v_exp_f32 v19, v19
  v_mfma_f32_16x16x32_bf16 v[60:63], a[156:159], v[188:191], v[204:207]
  v_cvt_pk_bf16_f32 v9, v10, v11
  v_add_f32 v24, v204, v24
  v_mfma_f32_16x16x32_bf16 v[60:63], a[152:155], v[184:187], v[60:63]
  v_add_f32 v25, v204, v25
  v_add_f32 v26, v204, v26
  v_mfma_f32_16x16x32_bf16 v[60:63], a[148:151], v[180:183], v[60:63]
  v_add_f32 v27, v204, v27
  v_mfma_f32_16x16x32_bf16 v[60:63], a[144:147], v[176:179], v[60:63]
  s_waitcnt lgkmcnt(0)
  v_exp_f32 v24, v24
  v_exp_f32 v25, v25
  v_exp_f32 v26, v26
  v_cvt_pk_bf16_f32 v24, v24, v25
  v_exp_f32 v27, v27
  v_cvt_pk_bf16_f32 v17, v18, v19
  v_add_f32 v4, v192, v4
  v_add_f32 v5, v192, v5
  v_add_f32 v6, v192, v6
  v_add_f32 v7, v192, v7
  v_exp_f32 v4, v4
  v_exp_f32 v5, v5
  v_exp_f32 v6, v6
  v_cvt_pk_bf16_f32 v2, v4, v5
  v_exp_f32 v7, v7
  v_cvt_pk_bf16_f32 v25, v26, v27
  v_add_f32 v12, v196, v12
  v_add_f32 v13, v196, v13
  v_add_f32 v14, v196, v14
  v_add_f32 v15, v196, v15
  v_exp_f32 v12, v12
  v_exp_f32 v13, v13
  v_exp_f32 v14, v14
  v_cvt_pk_bf16_f32 v10, v12, v13
  v_exp_f32 v15, v15
  v_cvt_pk_bf16_f32 v3, v6, v7
  v_add_f32 v20, v200, v20
  v_add_f32 v21, v200, v21
  v_add_f32 v22, v200, v22
  v_add_f32 v23, v200, v23
  v_exp_f32 v20, v20
  v_exp_f32 v21, v21
  v_exp_f32 v22, v22
  v_cvt_pk_bf16_f32 v18, v20, v21
  v_exp_f32 v23, v23
  v_cvt_pk_bf16_f32 v11, v14, v15
  v_add_f32 v28, v204, v28
  v_add_f32 v29, v204, v29
  v_add_f32 v30, v204, v30
  v_add_f32 v31, v204, v31
  v_exp_f32 v28, v28
  v_exp_f32 v29, v29
  v_exp_f32 v30, v30
  v_cvt_pk_bf16_f32 v26, v28, v29
  v_exp_f32 v31, v31
  v_cvt_pk_bf16_f32 v19, v22, v23
  v_exp_f32 v32, v32
  v_exp_f32 v33, v33
  v_exp_f32 v34, v34
  v_cvt_pk_bf16_f32 v32, v32, v33
  v_exp_f32 v35, v35
  v_cvt_pk_bf16_f32 v27, v30, v31
  v_exp_f32 v40, v40
  v_exp_f32 v41, v41
  v_exp_f32 v42, v42
  v_cvt_pk_bf16_f32 v40, v40, v41
  v_exp_f32 v43, v43
  v_cvt_pk_bf16_f32 v33, v34, v35
  v_exp_f32 v48, v48
  v_exp_f32 v49, v49
  v_exp_f32 v50, v50
  v_cvt_pk_bf16_f32 v48, v48, v49
  v_exp_f32 v51, v51
  v_cvt_pk_bf16_f32 v41, v42, v43
  v_exp_f32 v56, v56
  v_exp_f32 v57, v57
  v_exp_f32 v58, v58
  v_cvt_pk_bf16_f32 v56, v56, v57
  v_exp_f32 v59, v59
  v_cvt_pk_bf16_f32 v49, v50, v51
  v_exp_f32 v36, v36
  v_exp_f32 v37, v37
  v_exp_f32 v38, v38
  v_cvt_pk_bf16_f32 v34, v36, v37
  v_exp_f32 v39, v39
  v_cvt_pk_bf16_f32 v57, v58, v59
  v_exp_f32 v44, v44
  v_exp_f32 v45, v45
  v_exp_f32 v46, v46
  v_cvt_pk_bf16_f32 v42, v44, v45
  v_exp_f32 v47, v47
  v_cvt_pk_bf16_f32 v35, v38, v39
  v_exp_f32 v52, v52
  v_exp_f32 v53, v53
  v_exp_f32 v54, v54
  v_cvt_pk_bf16_f32 v50, v52, v53
  v_exp_f32 v55, v55
  v_cvt_pk_bf16_f32 v43, v46, v47
  v_exp_f32 v60, v60
  v_exp_f32 v61, v61
  v_exp_f32 v62, v62
  v_cvt_pk_bf16_f32 v58, v60, v61
  v_exp_f32 v63, v63
  v_cvt_pk_bf16_f32 v51, v54, v55
  v_cvt_pk_bf16_f32 v59, v62, v63
  v_mfma_f32_16x16x32_bf16 v[64:67], a[128:131], v[128:131], v[192:195]
  s_add_u32 m0, s28, 98304
  v_mfma_f32_16x16x32_bf16 v[64:67], a[132:135], v[132:135], v[64:67]
  ds_read_b128 a[144:147], v212 offset:20480
  v_mfma_f32_16x16x32_bf16 v[64:67], a[136:139], v[136:139], v[64:67]
  buffer_load_dwordx4 v236, s[16:19], s29 offen offset:0 lds
  v_mfma_f32_16x16x32_bf16 v[64:67], a[140:143], v[140:143], v[64:67]
  ds_read_b128 a[148:151], v213 offset:20480
  v_mfma_f32_16x16x32_bf16 v[72:75], a[140:143], v[156:159], v[196:199]
  v_mfma_f32_16x16x32_bf16 v[72:75], a[136:139], v[152:155], v[72:75]
  ds_read_b128 a[152:155], v214 offset:20480
  v_mfma_f32_16x16x32_bf16 v[72:75], a[132:135], v[148:151], v[72:75]
  buffer_load_dwordx4 v237, s[16:19], s29 offen offset:1024 lds
  v_mfma_f32_16x16x32_bf16 v[72:75], a[128:131], v[144:147], v[72:75]
  ds_read_b128 a[156:159], v215 offset:20480
  v_mfma_f32_16x16x32_bf16 v[80:83], a[128:131], v[160:163], v[200:203]
  v_exp_f32 v64, v64
  v_mfma_f32_16x16x32_bf16 v[80:83], a[132:135], v[164:167], v[80:83]
  v_mfma_f32_16x16x32_bf16 v[80:83], a[136:139], v[168:171], v[80:83]
  v_exp_f32 v65, v65
  v_mfma_f32_16x16x32_bf16 v[80:83], a[140:143], v[172:175], v[80:83]
  v_cvt_pk_bf16_f32 v64, v64, v65
  v_mfma_f32_16x16x32_bf16 v[88:91], a[140:143], v[188:191], v[204:207]
  v_exp_f32 v66, v66
  v_mfma_f32_16x16x32_bf16 v[88:91], a[136:139], v[184:187], v[88:91]
  buffer_load_dwordx4 v236, s[16:19], s29 offen offset:2048 lds
  v_mfma_f32_16x16x32_bf16 v[88:91], a[132:135], v[180:183], v[88:91]
  s_waitcnt lgkmcnt(0)
  v_exp_f32 v67, v67
  v_mfma_f32_16x16x32_bf16 v[88:91], a[128:131], v[176:179], v[88:91]
  v_cvt_pk_bf16_f32 v65, v66, v67
  v_mfma_f32_16x16x32_bf16 v[68:71], a[144:147], v[128:131], v[192:195]
  v_exp_f32 v72, v72
  v_mfma_f32_16x16x32_bf16 v[68:71], a[148:151], v[132:135], v[68:71]
  ds_read_b128 a[128:131], v212 offset:24576
  v_mfma_f32_16x16x32_bf16 v[68:71], a[152:155], v[136:139], v[68:71]
  v_exp_f32 v73, v73
  v_mfma_f32_16x16x32_bf16 v[68:71], a[156:159], v[140:143], v[68:71]
  ds_read_b128 a[132:135], v213 offset:24576
  v_cvt_pk_bf16_f32 v72, v72, v73
  v_mfma_f32_16x16x32_bf16 v[76:79], a[156:159], v[156:159], v[196:199]
  v_exp_f32 v74, v74
  v_mfma_f32_16x16x32_bf16 v[76:79], a[152:155], v[152:155], v[76:79]
  ds_read_b128 a[136:139], v214 offset:24576
  v_mfma_f32_16x16x32_bf16 v[76:79], a[148:151], v[148:151], v[76:79]
  v_exp_f32 v75, v75
  v_mfma_f32_16x16x32_bf16 v[76:79], a[144:147], v[144:147], v[76:79]
  ds_read_b128 a[140:143], v215 offset:24576
  v_cvt_pk_bf16_f32 v73, v74, v75
  v_mfma_f32_16x16x32_bf16 v[84:87], a[144:147], v[160:163], v[200:203]
  v_exp_f32 v80, v80
  v_mfma_f32_16x16x32_bf16 v[84:87], a[148:151], v[164:167], v[84:87]
  buffer_load_dwordx4 v237, s[16:19], s29 offen offset:3072 lds
  v_mfma_f32_16x16x32_bf16 v[84:87], a[152:155], v[168:171], v[84:87]
  s_add_u32 s29, s29, 16384
  v_exp_f32 v81, v81
  v_mfma_f32_16x16x32_bf16 v[84:87], a[156:159], v[172:175], v[84:87]
  v_cvt_pk_bf16_f32 v80, v80, v81
  v_mfma_f32_16x16x32_bf16 v[92:95], a[156:159], v[188:191], v[204:207]
  s_add_u32 m0, s28, 49152
  v_exp_f32 v82, v82
  v_mfma_f32_16x16x32_bf16 v[92:95], a[152:155], v[184:187], v[92:95]
  buffer_load_dwordx4 v232, s[12:15], s29 offen offset:0 lds
  v_mfma_f32_16x16x32_bf16 v[92:95], a[148:151], v[180:183], v[92:95]
  s_waitcnt lgkmcnt(0)
  v_exp_f32 v83, v83
  v_mfma_f32_16x16x32_bf16 v[92:95], a[144:147], v[176:179], v[92:95]
  v_cvt_pk_bf16_f32 v81, v82, v83
  v_mfma_f32_16x16x32_bf16 v[96:99], a[128:131], v[128:131], v[192:195]
  v_exp_f32 v88, v88
  v_mfma_f32_16x16x32_bf16 v[96:99], a[132:135], v[132:135], v[96:99]
  ds_read_b128 a[144:147], v212 offset:28672
  v_mfma_f32_16x16x32_bf16 v[96:99], a[136:139], v[136:139], v[96:99]
  v_exp_f32 v89, v89
  v_mfma_f32_16x16x32_bf16 v[96:99], a[140:143], v[140:143], v[96:99]
  ds_read_b128 a[148:151], v213 offset:28672
  v_cvt_pk_bf16_f32 v88, v88, v89
  v_mfma_f32_16x16x32_bf16 v[104:107], a[140:143], v[156:159], v[196:199]
  v_exp_f32 v90, v90
  v_mfma_f32_16x16x32_bf16 v[104:107], a[136:139], v[152:155], v[104:107]
  ds_read_b128 a[152:155], v214 offset:28672
  v_mfma_f32_16x16x32_bf16 v[104:107], a[132:135], v[148:151], v[104:107]
  v_exp_f32 v91, v91
  v_mfma_f32_16x16x32_bf16 v[104:107], a[128:131], v[144:147], v[104:107]
  ds_read_b128 a[156:159], v215 offset:28672
  v_cvt_pk_bf16_f32 v89, v90, v91
  v_mfma_f32_16x16x32_bf16 v[112:115], a[128:131], v[160:163], v[200:203]
  v_exp_f32 v68, v68
  v_mfma_f32_16x16x32_bf16 v[112:115], a[132:135], v[164:167], v[112:115]
  buffer_load_dwordx4 v233, s[12:15], s29 offen offset:1024 lds
  v_mfma_f32_16x16x32_bf16 v[112:115], a[136:139], v[168:171], v[112:115]
  v_exp_f32 v69, v69
  v_mfma_f32_16x16x32_bf16 v[112:115], a[140:143], v[172:175], v[112:115]
  v_cvt_pk_bf16_f32 v66, v68, v69
  v_mfma_f32_16x16x32_bf16 v[120:123], a[140:143], v[188:191], v[204:207]
  v_exp_f32 v70, v70
  v_mfma_f32_16x16x32_bf16 v[120:123], a[136:139], v[184:187], v[120:123]
  buffer_load_dwordx4 v234, s[12:15], s29 offen offset:2048 lds
  v_mfma_f32_16x16x32_bf16 v[120:123], a[132:135], v[180:183], v[120:123]
  s_waitcnt lgkmcnt(0)
  v_exp_f32 v71, v71
  v_mfma_f32_16x16x32_bf16 v[120:123], a[128:131], v[176:179], v[120:123]
  v_cvt_pk_bf16_f32 v67, v70, v71
  v_mfma_f32_16x16x32_bf16 v[100:103], a[144:147], v[128:131], v[192:195]
  v_exp_f32 v76, v76
  v_mfma_f32_16x16x32_bf16 v[100:103], a[148:151], v[132:135], v[100:103]
  ds_read_b64_tr_b16 a[160:161], v216 offset:0
  v_mfma_f32_16x16x32_bf16 v[100:103], a[152:155], v[136:139], v[100:103]
  v_exp_f32 v77, v77
  v_mfma_f32_16x16x32_bf16 v[100:103], a[156:159], v[140:143], v[100:103]
  ds_read_b64_tr_b16 a[162:163], v216 offset:4096
  v_cvt_pk_bf16_f32 v74, v76, v77
  v_mfma_f32_16x16x32_bf16 v[108:111], a[156:159], v[156:159], v[196:199]
  v_exp_f32 v78, v78
  v_mfma_f32_16x16x32_bf16 v[108:111], a[152:155], v[152:155], v[108:111]
  ds_read_b64_tr_b16 a[164:165], v216 offset:8192
  buffer_load_dwordx4 v235, s[12:15], s29 offen offset:3072 lds
  v_mfma_f32_16x16x32_bf16 v[108:111], a[148:151], v[148:151], v[108:111]
  v_exp_f32 v79, v79
  v_mfma_f32_16x16x32_bf16 v[108:111], a[144:147], v[144:147], v[108:111]
  ds_read_b64_tr_b16 a[166:167], v216 offset:12288
  v_cvt_pk_bf16_f32 v75, v78, v79
  v_mfma_f32_16x16x32_bf16 v[116:119], a[144:147], v[160:163], v[200:203]
  v_exp_f32 v84, v84
  v_mfma_f32_16x16x32_bf16 v[116:119], a[148:151], v[164:167], v[116:119]
  ds_read_b64_tr_b16 a[168:169], v217 offset:0
  s_add_u32 m0, s50, 3072
  v_mfma_f32_16x16x32_bf16 v[116:119], a[152:155], v[168:171], v[116:119]
  v_exp_f32 v85, v85
  v_mfma_f32_16x16x32_bf16 v[116:119], a[156:159], v[172:175], v[116:119]
  ds_read_b64_tr_b16 a[170:171], v217 offset:4096
  v_cvt_pk_bf16_f32 v82, v84, v85
  v_mfma_f32_16x16x32_bf16 v[124:127], a[156:159], v[188:191], v[204:207]
  v_exp_f32 v86, v86
  v_mfma_f32_16x16x32_bf16 v[124:127], a[152:155], v[184:187], v[124:127]
  ds_read_b64_tr_b16 a[172:173], v217 offset:8192
  buffer_load_dwordx4 v253, s[44:47], s35 offen lds
  s_add_u32 s35, s35, 221184
  v_mfma_f32_16x16x32_bf16 v[124:127], a[148:151], v[180:183], v[124:127]
  v_exp_f32 v87, v87
  v_mfma_f32_16x16x32_bf16 v[124:127], a[144:147], v[176:179], v[124:127]
  ds_read_b64_tr_b16 a[174:175], v217 offset:12288
  v_cvt_pk_bf16_f32 v83, v86, v87
  v_mfma_f32_16x16x32_bf16 a[192:195], a[208:211], v[0:3], 0
  v_exp_f32 v92, v92
  v_mfma_f32_16x16x32_bf16 a[192:195], a[208:211], v[32:35], a[192:195]
  ds_read_b64_tr_b16 a[176:177], v218 offset:0
  v_mfma_f32_16x16x32_bf16 a[196:199], a[208:211], v[8:11], 0
  v_exp_f32 v93, v93
  v_mfma_f32_16x16x32_bf16 a[196:199], a[208:211], v[40:43], a[196:199]
  ds_read_b64_tr_b16 a[178:179], v218 offset:4096
  v_cvt_pk_bf16_f32 v90, v92, v93
  v_mfma_f32_16x16x32_bf16 a[200:203], a[208:211], v[16:19], 0
  v_exp_f32 v94, v94
  v_mfma_f32_16x16x32_bf16 a[200:203], a[208:211], v[48:51], a[200:203]
  ds_read_b64_tr_b16 a[180:181], v218 offset:8192
  v_mfma_f32_16x16x32_bf16 a[204:207], a[208:211], v[24:27], 0
  s_waitcnt lgkmcnt(7)
  v_exp_f32 v95, v95
  v_mfma_f32_16x16x32_bf16 a[204:207], a[208:211], v[56:59], a[204:207]
  ds_read_b64_tr_b16 a[182:183], v218 offset:12288
  v_cvt_pk_bf16_f32 v91, v94, v95
  v_mfma_f32_16x16x32_bf16 a[0:3], a[160:163], v[0:3], 0
  v_exp_f32 v96, v96
  v_mfma_f32_16x16x32_bf16 a[0:3], a[164:167], v[32:35], a[0:3]
  ds_read_b64_tr_b16 a[184:185], v219 offset:0
  v_mfma_f32_16x16x32_bf16 a[4:7], a[164:167], v[40:43], 0
  v_exp_f32 v97, v97
  v_mfma_f32_16x16x32_bf16 a[4:7], a[160:163], v[8:11], a[4:7]
  ds_read_b64_tr_b16 a[186:187], v219 offset:4096
  v_cvt_pk_bf16_f32 v96, v96, v97
  v_mfma_f32_16x16x32_bf16 a[8:11], a[160:163], v[16:19], 0
  v_exp_f32 v98, v98
  v_mfma_f32_16x16x32_bf16 a[8:11], a[164:167], v[48:51], a[8:11]
  ds_read_b64_tr_b16 a[188:189], v219 offset:8192
  v_mfma_f32_16x16x32_bf16 a[12:15], a[164:167], v[56:59], 0
  s_waitcnt lgkmcnt(7)
  v_exp_f32 v99, v99
  v_mfma_f32_16x16x32_bf16 a[12:15], a[160:163], v[24:27], a[12:15]
  ds_read_b64_tr_b16 a[190:191], v219 offset:12288
  v_cvt_pk_bf16_f32 v97, v98, v99
  v_mfma_f32_16x16x32_bf16 a[16:19], a[168:171], v[0:3], 0
  v_exp_f32 v104, v104
  v_mfma_f32_16x16x32_bf16 a[16:19], a[172:175], v[32:35], a[16:19]
  ds_read_b64_tr_b16 a[160:161], v220 offset:0
  v_mfma_f32_16x16x32_bf16 a[20:23], a[172:175], v[40:43], 0
  v_exp_f32 v105, v105
  v_mfma_f32_16x16x32_bf16 a[20:23], a[168:171], v[8:11], a[20:23]
  ds_read_b64_tr_b16 a[162:163], v220 offset:4096
  v_cvt_pk_bf16_f32 v104, v104, v105
  v_mfma_f32_16x16x32_bf16 a[24:27], a[168:171], v[16:19], 0
  v_exp_f32 v106, v106
  v_mfma_f32_16x16x32_bf16 a[24:27], a[172:175], v[48:51], a[24:27]
  ds_read_b64_tr_b16 a[164:165], v220 offset:8192
  v_mfma_f32_16x16x32_bf16 a[28:31], a[172:175], v[56:59], 0
  s_waitcnt lgkmcnt(7)
  v_exp_f32 v107, v107
  v_mfma_f32_16x16x32_bf16 a[28:31], a[168:171], v[24:27], a[28:31]
  ds_read_b64_tr_b16 a[166:167], v220 offset:12288
  v_cvt_pk_bf16_f32 v105, v106, v107
  v_mfma_f32_16x16x32_bf16 a[32:35], a[176:179], v[0:3], 0
  v_exp_f32 v112, v112
  v_mfma_f32_16x16x32_bf16 a[32:35], a[180:183], v[32:35], a[32:35]
  ds_read_b64_tr_b16 a[168:169], v221 offset:0
  v_mfma_f32_16x16x32_bf16 a[36:39], a[180:183], v[40:43], 0
  v_exp_f32 v113, v113
  v_mfma_f32_16x16x32_bf16 a[36:39], a[176:179], v[8:11], a[36:39]
  ds_read_b64_tr_b16 a[170:171], v221 offset:4096
  v_cvt_pk_bf16_f32 v112, v112, v113
  v_mfma_f32_16x16x32_bf16 a[40:43], a[176:179], v[16:19], 0
  v_exp_f32 v114, v114
  v_mfma_f32_16x16x32_bf16 a[40:43], a[180:183], v[48:51], a[40:43]
  ds_read_b64_tr_b16 a[172:173], v221 offset:8192
  v_mfma_f32_16x16x32_bf16 a[44:47], a[180:183], v[56:59], 0
  s_waitcnt lgkmcnt(7)
  v_exp_f32 v115, v115
  v_mfma_f32_16x16x32_bf16 a[44:47], a[176:179], v[24:27], a[44:47]
  ds_read_b64_tr_b16 a[174:175], v221 offset:12288
  v_cvt_pk_bf16_f32 v113, v114, v115
  v_mfma_f32_16x16x32_bf16 a[48:51], a[184:187], v[0:3], 0
  v_exp_f32 v120, v120
  v_mfma_f32_16x16x32_bf16 a[48:51], a[188:191], v[32:35], a[48:51]
  ds_read_b64_tr_b16 a[176:177], v222 offset:0
  v_mfma_f32_16x16x32_bf16 a[52:55], a[188:191], v[40:43], 0
  v_exp_f32 v121, v121
  v_mfma_f32_16x16x32_bf16 a[52:55], a[184:187], v[8:11], a[52:55]
  ds_read_b64_tr_b16 a[178:179], v222 offset:4096
  v_cvt_pk_bf16_f32 v120, v120, v121
  v_mfma_f32_16x16x32_bf16 a[56:59], a[184:187], v[16:19], 0
  v_exp_f32 v122, v122
  v_mfma_f32_16x16x32_bf16 a[56:59], a[188:191], v[48:51], a[56:59]
  ds_read_b64_tr_b16 a[180:181], v222 offset:8192
  v_mfma_f32_16x16x32_bf16 a[60:63], a[188:191], v[56:59], 0
  s_waitcnt lgkmcnt(7)
  v_exp_f32 v123, v123
  v_mfma_f32_16x16x32_bf16 a[60:63], a[184:187], v[24:27], a[60:63]
  ds_read_b64_tr_b16 a[182:183], v222 offset:12288
  v_cvt_pk_bf16_f32 v121, v122, v123
  v_mfma_f32_16x16x32_bf16 a[64:67], a[160:163], v[0:3], 0
  v_exp_f32 v100, v100
  v_mfma_f32_16x16x32_bf16 a[64:67], a[164:167], v[32:35], a[64:67]
  ds_read_b64_tr_b16 a[184:185], v223 offset:0
  v_mfma_f32_16x16x32_bf16 a[68:71], a[164:167], v[40:43], 0
  v_exp_f32 v101, v101
  v_mfma_f32_16x16x32_bf16 a[68:71], a[160:163], v[8:11], a[68:71]
  ds_read_b64_tr_b16 a[186:187], v223 offset:4096
  v_cvt_pk_bf16_f32 v98, v100, v101
  v_mfma_f32_16x16x32_bf16 a[72:75], a[160:163], v[16:19], 0
  v_exp_f32 v102, v102
  v_mfma_f32_16x16x32_bf16 a[72:75], a[164:167], v[48:51], a[72:75]
  ds_read_b64_tr_b16 a[188:189], v223 offset:8192
  v_mfma_f32_16x16x32_bf16 a[76:79], a[164:167], v[56:59], 0
  s_waitcnt lgkmcnt(7)
  v_exp_f32 v103, v103
  v_mfma_f32_16x16x32_bf16 a[76:79], a[160:163], v[24:27], a[76:79]
  ds_read_b64_tr_b16 a[190:191], v223 offset:12288
  v_cvt_pk_bf16_f32 v99, v102, v103
  v_mfma_f32_16x16x32_bf16 a[80:83], a[168:171], v[0:3], 0
  s_waitcnt vmcnt(10)
  v_exp_f32 v108, v108
  v_mfma_f32_16x16x32_bf16 a[80:83], a[172:175], v[32:35], a[80:83]
  v_mfma_f32_16x16x32_bf16 a[84:87], a[172:175], v[40:43], 0
  s_barrier
  v_exp_f32 v109, v109
  v_mfma_f32_16x16x32_bf16 a[84:87], a[168:171], v[8:11], a[84:87]
  ds_read_b128 a[128:131], v212 offset:32768
  v_cvt_pk_bf16_f32 v106, v108, v109
  v_mfma_f32_16x16x32_bf16 a[88:91], a[168:171], v[16:19], 0
  v_exp_f32 v110, v110
  v_mfma_f32_16x16x32_bf16 a[88:91], a[172:175], v[48:51], a[88:91]
  ds_read_b128 a[132:135], v213 offset:32768
  v_mfma_f32_16x16x32_bf16 a[92:95], a[172:175], v[56:59], 0
  s_waitcnt lgkmcnt(6)
  v_exp_f32 v111, v111
  v_mfma_f32_16x16x32_bf16 a[92:95], a[168:171], v[24:27], a[92:95]
  ds_read_b128 a[136:139], v214 offset:32768
  v_cvt_pk_bf16_f32 v107, v110, v111
  v_mfma_f32_16x16x32_bf16 a[96:99], a[176:179], v[0:3], 0
  s_mul_i32 s38, s3, 20480
  v_exp_f32 v116, v116
  v_mfma_f32_16x16x32_bf16 a[96:99], a[180:183], v[32:35], a[96:99]
  ds_read_b128 a[140:143], v215 offset:32768
  buffer_load_dwordx4 a[212:215], v243, s[24:27], s38 offen sc1
  s_add_u32 s38, s38, 4096
  v_mfma_f32_16x16x32_bf16 a[100:103], a[180:183], v[40:43], 0
  v_exp_f32 v117, v117
  v_mfma_f32_16x16x32_bf16 a[100:103], a[176:179], v[8:11], a[100:103]
  v_cvt_pk_bf16_f32 v114, v116, v117
  v_mfma_f32_16x16x32_bf16 a[104:107], a[176:179], v[16:19], 0
  v_exp_f32 v118, v118
  v_mfma_f32_16x16x32_bf16 a[104:107], a[180:183], v[48:51], a[104:107]
  v_mfma_f32_16x16x32_bf16 a[108:111], a[180:183], v[56:59], 0
  s_waitcnt lgkmcnt(4)
  v_exp_f32 v119, v119
  v_mfma_f32_16x16x32_bf16 a[108:111], a[176:179], v[24:27], a[108:111]
  v_cvt_pk_bf16_f32 v115, v118, v119
  v_mfma_f32_16x16x32_bf16 a[112:115], a[184:187], v[0:3], 0
  v_exp_f32 v124, v124
  v_mfma_f32_16x16x32_bf16 a[112:115], a[188:191], v[32:35], a[112:115]
  v_mfma_f32_16x16x32_bf16 a[116:119], a[188:191], v[40:43], 0
  v_exp_f32 v125, v125
  v_mfma_f32_16x16x32_bf16 a[116:119], a[184:187], v[8:11], a[116:119]
  v_cvt_pk_bf16_f32 v122, v124, v125
  v_mfma_f32_16x16x32_bf16 a[120:123], a[184:187], v[16:19], 0
  v_exp_f32 v126, v126
  v_mfma_f32_16x16x32_bf16 a[120:123], a[188:191], v[48:51], a[120:123]
  v_mfma_f32_16x16x32_bf16 a[124:127], a[188:191], v[56:59], 0
  s_waitcnt lgkmcnt(0)
  v_exp_f32 v127, v127
  v_mfma_f32_16x16x32_bf16 a[124:127], a[184:187], v[24:27], a[124:127]
  v_cvt_pk_bf16_f32 v123, v126, v127
  v_mfma_f32_16x16x32_bf16 v[0:3], a[128:131], v[128:131], v[192:195]
  s_add_u32 m0, s28, 114688
  v_mfma_f32_16x16x32_bf16 v[0:3], a[132:135], v[132:135], v[0:3]
  ds_read_b128 a[144:147], v212 offset:36864
  v_mfma_f32_16x16x32_bf16 v[0:3], a[136:139], v[136:139], v[0:3]
  buffer_load_dwordx4 v236, s[16:19], s29 offen offset:0 lds
  v_mfma_f32_16x16x32_bf16 v[0:3], a[140:143], v[140:143], v[0:3]
  ds_read_b128 a[148:151], v213 offset:36864
  v_mfma_f32_16x16x32_bf16 v[8:11], a[140:143], v[156:159], v[196:199]
  v_mfma_f32_16x16x32_bf16 v[8:11], a[136:139], v[152:155], v[8:11]
  ds_read_b128 a[152:155], v214 offset:36864
  v_mfma_f32_16x16x32_bf16 v[8:11], a[132:135], v[148:151], v[8:11]
  buffer_load_dwordx4 v237, s[16:19], s29 offen offset:1024 lds
  v_mfma_f32_16x16x32_bf16 v[8:11], a[128:131], v[144:147], v[8:11]
  ds_read_b128 a[156:159], v215 offset:36864
  v_mfma_f32_16x16x32_bf16 v[16:19], a[128:131], v[160:163], v[200:203]
  v_exp_f32 v0, v0
  v_mfma_f32_16x16x32_bf16 v[16:19], a[132:135], v[164:167], v[16:19]
  v_mfma_f32_16x16x32_bf16 v[16:19], a[136:139], v[168:171], v[16:19]
  v_exp_f32 v1, v1
  v_mfma_f32_16x16x32_bf16 v[16:19], a[140:143], v[172:175], v[16:19]
  v_cvt_pk_bf16_f32 v0, v0, v1
  v_mfma_f32_16x16x32_bf16 v[24:27], a[140:143], v[188:191], v[204:207]
  v_exp_f32 v2, v2
  v_mfma_f32_16x16x32_bf16 v[24:27], a[136:139], v[184:187], v[24:27]
  buffer_load_dwordx4 v236, s[16:19], s29 offen offset:2048 lds
  v_mfma_f32_16x16x32_bf16 v[24:27], a[132:135], v[180:183], v[24:27]
  s_waitcnt lgkmcnt(0)
  v_exp_f32 v3, v3
  v_mfma_f32_16x16x32_bf16 v[24:27], a[128:131], v[176:179], v[24:27]
  v_cvt_pk_bf16_f32 v1, v2, v3
  v_mfma_f32_16x16x32_bf16 v[4:7], a[144:147], v[128:131], v[192:195]
  v_exp_f32 v8, v8
  v_mfma_f32_16x16x32_bf16 v[4:7], a[148:151], v[132:135], v[4:7]
  ds_read_b128 a[128:131], v212 offset:40960
  v_mfma_f32_16x16x32_bf16 v[4:7], a[152:155], v[136:139], v[4:7]
  v_exp_f32 v9, v9
  v_mfma_f32_16x16x32_bf16 v[4:7], a[156:159], v[140:143], v[4:7]
  ds_read_b128 a[132:135], v213 offset:40960
  v_cvt_pk_bf16_f32 v8, v8, v9
  v_mfma_f32_16x16x32_bf16 v[12:15], a[156:159], v[156:159], v[196:199]
  v_exp_f32 v10, v10
  v_mfma_f32_16x16x32_bf16 v[12:15], a[152:155], v[152:155], v[12:15]
  ds_read_b128 a[136:139], v214 offset:40960
  v_mfma_f32_16x16x32_bf16 v[12:15], a[148:151], v[148:151], v[12:15]
  v_exp_f32 v11, v11
  v_mfma_f32_16x16x32_bf16 v[12:15], a[144:147], v[144:147], v[12:15]
  ds_read_b128 a[140:143], v215 offset:40960
  v_cvt_pk_bf16_f32 v9, v10, v11
  v_mfma_f32_16x16x32_bf16 v[20:23], a[144:147], v[160:163], v[200:203]
  v_exp_f32 v16, v16
  v_mfma_f32_16x16x32_bf16 v[20:23], a[148:151], v[164:167], v[20:23]
  buffer_load_dwordx4 v237, s[16:19], s29 offen offset:3072 lds
  v_mfma_f32_16x16x32_bf16 v[20:23], a[152:155], v[168:171], v[20:23]
  s_add_u32 s29, s29, 16384
  v_exp_f32 v17, v17
  v_mfma_f32_16x16x32_bf16 v[20:23], a[156:159], v[172:175], v[20:23]
  v_cvt_pk_bf16_f32 v16, v16, v17
  v_mfma_f32_16x16x32_bf16 v[28:31], a[156:159], v[188:191], v[204:207]
  s_add_u32 m0, s28, 0
  v_exp_f32 v18, v18
  v_mfma_f32_16x16x32_bf16 v[28:31], a[152:155], v[184:187], v[28:31]
  buffer_load_dwordx4 v232, s[12:15], s29 offen offset:0 lds
  v_mfma_f32_16x16x32_bf16 v[28:31], a[148:151], v[180:183], v[28:31]
  s_waitcnt lgkmcnt(0)
  v_exp_f32 v19, v19
  v_mfma_f32_16x16x32_bf16 v[28:31], a[144:147], v[176:179], v[28:31]
  v_cvt_pk_bf16_f32 v17, v18, v19
  v_mfma_f32_16x16x32_bf16 v[32:35], a[128:131], v[128:131], v[192:195]
  v_exp_f32 v24, v24
  v_mfma_f32_16x16x32_bf16 v[32:35], a[132:135], v[132:135], v[32:35]
  ds_read_b128 a[144:147], v212 offset:45056
  v_mfma_f32_16x16x32_bf16 v[32:35], a[136:139], v[136:139], v[32:35]
  v_exp_f32 v25, v25
  v_mfma_f32_16x16x32_bf16 v[32:35], a[140:143], v[140:143], v[32:35]
  ds_read_b128 a[148:151], v213 offset:45056
  v_cvt_pk_bf16_f32 v24, v24, v25
  v_mfma_f32_16x16x32_bf16 v[40:43], a[140:143], v[156:159], v[196:199]
  v_exp_f32 v26, v26
  v_mfma_f32_16x16x32_bf16 v[40:43], a[136:139], v[152:155], v[40:43]
  ds_read_b128 a[152:155], v214 offset:45056
  v_mfma_f32_16x16x32_bf16 v[40:43], a[132:135], v[148:151], v[40:43]
  v_exp_f32 v27, v27
  v_mfma_f32_16x16x32_bf16 v[40:43], a[128:131], v[144:147], v[40:43]
  ds_read_b128 a[156:159], v215 offset:45056
  v_cvt_pk_bf16_f32 v25, v26, v27
  v_mfma_f32_16x16x32_bf16 v[48:51], a[128:131], v[160:163], v[200:203]
  v_exp_f32 v4, v4
  v_mfma_f32_16x16x32_bf16 v[48:51], a[132:135], v[164:167], v[48:51]
  buffer_load_dwordx4 v233, s[12:15], s29 offen offset:1024 lds
  v_mfma_f32_16x16x32_bf16 v[48:51], a[136:139], v[168:171], v[48:51]
  v_exp_f32 v5, v5
  v_mfma_f32_16x16x32_bf16 v[48:51], a[140:143], v[172:175], v[48:51]
  v_cvt_pk_bf16_f32 v2, v4, v5
  v_mfma_f32_16x16x32_bf16 v[56:59], a[140:143], v[188:191], v[204:207]
  v_exp_f32 v6, v6
  v_mfma_f32_16x16x32_bf16 v[56:59], a[136:139], v[184:187], v[56:59]
  buffer_load_dwordx4 v234, s[12:15], s29 offen offset:2048 lds
  v_mfma_f32_16x16x32_bf16 v[56:59], a[132:135], v[180:183], v[56:59]
  s_waitcnt lgkmcnt(0)
  v_exp_f32 v7, v7
  v_mfma_f32_16x16x32_bf16 v[56:59], a[128:131], v[176:179], v[56:59]
  v_cvt_pk_bf16_f32 v3, v6, v7
  v_mfma_f32_16x16x32_bf16 v[36:39], a[144:147], v[128:131], v[192:195]
  v_exp_f32 v12, v12
  v_mfma_f32_16x16x32_bf16 v[36:39], a[148:151], v[132:135], v[36:39]
  ds_read_b64_tr_b16 a[160:161], v216 offset:16384
  v_mfma_f32_16x16x32_bf16 v[36:39], a[152:155], v[136:139], v[36:39]
  v_exp_f32 v13, v13
  v_mfma_f32_16x16x32_bf16 v[36:39], a[156:159], v[140:143], v[36:39]
  ds_read_b64_tr_b16 a[162:163], v216 offset:20480
  v_cvt_pk_bf16_f32 v10, v12, v13
  v_mfma_f32_16x16x32_bf16 v[44:47], a[156:159], v[156:159], v[196:199]
  v_exp_f32 v14, v14
  v_mfma_f32_16x16x32_bf16 v[44:47], a[152:155], v[152:155], v[44:47]
  ds_read_b64_tr_b16 a[164:165], v216 offset:24576
  buffer_load_dwordx4 v235, s[12:15], s29 offen offset:3072 lds
  v_mfma_f32_16x16x32_bf16 v[44:47], a[148:151], v[148:151], v[44:47]
  v_exp_f32 v15, v15
  v_mfma_f32_16x16x32_bf16 v[44:47], a[144:147], v[144:147], v[44:47]
  ds_read_b64_tr_b16 a[166:167], v216 offset:28672
  v_cvt_pk_bf16_f32 v11, v14, v15
  v_mfma_f32_16x16x32_bf16 v[52:55], a[144:147], v[160:163], v[200:203]
  v_exp_f32 v20, v20
  v_mfma_f32_16x16x32_bf16 v[52:55], a[148:151], v[164:167], v[52:55]
  ds_read_b64_tr_b16 a[168:169], v217 offset:16384
  s_add_u32 m0, s50, 1024
  v_mfma_f32_16x16x32_bf16 v[52:55], a[152:155], v[168:171], v[52:55]
  v_exp_f32 v21, v21
  v_mfma_f32_16x16x32_bf16 v[52:55], a[156:159], v[172:175], v[52:55]
  ds_read_b64_tr_b16 a[170:171], v217 offset:20480
  v_cvt_pk_bf16_f32 v18, v20, v21
  v_mfma_f32_16x16x32_bf16 v[60:63], a[156:159], v[188:191], v[204:207]
  v_exp_f32 v22, v22
  v_mfma_f32_16x16x32_bf16 v[60:63], a[152:155], v[184:187], v[60:63]
  ds_read_b64_tr_b16 a[172:173], v217 offset:24576
  buffer_load_dwordx4 v253, s[20:23], s35 offen lds
  v_mfma_f32_16x16x32_bf16 v[60:63], a[148:151], v[180:183], v[60:63]
  v_exp_f32 v23, v23
  v_mfma_f32_16x16x32_bf16 v[60:63], a[144:147], v[176:179], v[60:63]
  ds_read_b64_tr_b16 a[174:175], v217 offset:28672
  v_cvt_pk_bf16_f32 v19, v22, v23
  v_mfma_f32_16x16x32_bf16 a[192:195], a[208:211], v[64:67], a[192:195]
  v_exp_f32 v28, v28
  v_mfma_f32_16x16x32_bf16 a[192:195], a[208:211], v[96:99], a[192:195]
  ds_read_b64_tr_b16 a[176:177], v218 offset:16384
  v_mfma_f32_16x16x32_bf16 a[196:199], a[208:211], v[72:75], a[196:199]
  v_exp_f32 v29, v29
  v_mfma_f32_16x16x32_bf16 a[196:199], a[208:211], v[104:107], a[196:199]
  ds_read_b64_tr_b16 a[178:179], v218 offset:20480
  v_cvt_pk_bf16_f32 v26, v28, v29
  v_mfma_f32_16x16x32_bf16 a[200:203], a[208:211], v[80:83], a[200:203]
  v_exp_f32 v30, v30
  v_mfma_f32_16x16x32_bf16 a[200:203], a[208:211], v[112:115], a[200:203]
  ds_read_b64_tr_b16 a[180:181], v218 offset:24576
  v_mfma_f32_16x16x32_bf16 a[204:207], a[208:211], v[88:91], a[204:207]
  s_waitcnt lgkmcnt(7)
  v_exp_f32 v31, v31
  v_mfma_f32_16x16x32_bf16 a[204:207], a[208:211], v[120:123], a[204:207]
  ds_read_b64_tr_b16 a[182:183], v218 offset:28672
  v_cvt_pk_bf16_f32 v27, v30, v31
  v_mfma_f32_16x16x32_bf16 a[0:3], a[160:163], v[64:67], a[0:3]
  v_exp_f32 v32, v32
  v_mfma_f32_16x16x32_bf16 a[0:3], a[164:167], v[96:99], a[0:3]
  ds_read_b64_tr_b16 a[184:185], v219 offset:16384
  v_mfma_f32_16x16x32_bf16 a[4:7], a[164:167], v[104:107], a[4:7]
  v_exp_f32 v33, v33
  v_mfma_f32_16x16x32_bf16 a[4:7], a[160:163], v[72:75], a[4:7]
  ds_read_b64_tr_b16 a[186:187], v219 offset:20480
  v_cvt_pk_bf16_f32 v32, v32, v33
  v_mfma_f32_16x16x32_bf16 a[8:11], a[160:163], v[80:83], a[8:11]
  v_exp_f32 v34, v34
  v_mfma_f32_16x16x32_bf16 a[8:11], a[164:167], v[112:115], a[8:11]
  ds_read_b64_tr_b16 a[188:189], v219 offset:24576
  v_mfma_f32_16x16x32_bf16 a[12:15], a[164:167], v[120:123], a[12:15]
  s_waitcnt lgkmcnt(7)
  v_exp_f32 v35, v35
  v_mfma_f32_16x16x32_bf16 a[12:15], a[160:163], v[88:91], a[12:15]
  ds_read_b64_tr_b16 a[190:191], v219 offset:28672
  v_cvt_pk_bf16_f32 v33, v34, v35
  v_mfma_f32_16x16x32_bf16 a[16:19], a[168:171], v[64:67], a[16:19]
  v_exp_f32 v40, v40
  v_mfma_f32_16x16x32_bf16 a[16:19], a[172:175], v[96:99], a[16:19]
  ds_read_b64_tr_b16 a[160:161], v220 offset:16384
  v_mfma_f32_16x16x32_bf16 a[20:23], a[172:175], v[104:107], a[20:23]
  v_exp_f32 v41, v41
  v_mfma_f32_16x16x32_bf16 a[20:23], a[168:171], v[72:75], a[20:23]
  ds_read_b64_tr_b16 a[162:163], v220 offset:20480
  v_cvt_pk_bf16_f32 v40, v40, v41
  v_mfma_f32_16x16x32_bf16 a[24:27], a[168:171], v[80:83], a[24:27]
  v_exp_f32 v42, v42
  v_mfma_f32_16x16x32_bf16 a[24:27], a[172:175], v[112:115], a[24:27]
  ds_read_b64_tr_b16 a[164:165], v220 offset:24576
  v_mfma_f32_16x16x32_bf16 a[28:31], a[172:175], v[120:123], a[28:31]
  s_waitcnt lgkmcnt(7)
  v_exp_f32 v43, v43
  v_mfma_f32_16x16x32_bf16 a[28:31], a[168:171], v[88:91], a[28:31]
  ds_read_b64_tr_b16 a[166:167], v220 offset:28672
  v_cvt_pk_bf16_f32 v41, v42, v43
  v_mfma_f32_16x16x32_bf16 a[32:35], a[176:179], v[64:67], a[32:35]
  v_exp_f32 v48, v48
  v_mfma_f32_16x16x32_bf16 a[32:35], a[180:183], v[96:99], a[32:35]
  ds_read_b64_tr_b16 a[168:169], v221 offset:16384
  v_mfma_f32_16x16x32_bf16 a[36:39], a[180:183], v[104:107], a[36:39]
  v_exp_f32 v49, v49
  v_mfma_f32_16x16x32_bf16 a[36:39], a[176:179], v[72:75], a[36:39]
  ds_read_b64_tr_b16 a[170:171], v221 offset:20480
  v_cvt_pk_bf16_f32 v48, v48, v49
  v_mfma_f32_16x16x32_bf16 a[40:43], a[176:179], v[80:83], a[40:43]
  v_exp_f32 v50, v50
  v_mfma_f32_16x16x32_bf16 a[40:43], a[180:183], v[112:115], a[40:43]
  ds_read_b64_tr_b16 a[172:173], v221 offset:24576
  v_mfma_f32_16x16x32_bf16 a[44:47], a[180:183], v[120:123], a[44:47]
  s_waitcnt lgkmcnt(7)
  v_exp_f32 v51, v51
  v_mfma_f32_16x16x32_bf16 a[44:47], a[176:179], v[88:91], a[44:47]
  ds_read_b64_tr_b16 a[174:175], v221 offset:28672
  v_cvt_pk_bf16_f32 v49, v50, v51
  v_mfma_f32_16x16x32_bf16 a[48:51], a[184:187], v[64:67], a[48:51]
  v_exp_f32 v56, v56
  v_mfma_f32_16x16x32_bf16 a[48:51], a[188:191], v[96:99], a[48:51]
  ds_read_b64_tr_b16 a[176:177], v222 offset:16384
  v_mfma_f32_16x16x32_bf16 a[52:55], a[188:191], v[104:107], a[52:55]
  v_exp_f32 v57, v57
  v_mfma_f32_16x16x32_bf16 a[52:55], a[184:187], v[72:75], a[52:55]
  ds_read_b64_tr_b16 a[178:179], v222 offset:20480
  v_cvt_pk_bf16_f32 v56, v56, v57
  v_mfma_f32_16x16x32_bf16 a[56:59], a[184:187], v[80:83], a[56:59]
  v_exp_f32 v58, v58
  v_mfma_f32_16x16x32_bf16 a[56:59], a[188:191], v[112:115], a[56:59]
  ds_read_b64_tr_b16 a[180:181], v222 offset:24576
  v_mfma_f32_16x16x32_bf16 a[60:63], a[188:191], v[120:123], a[60:63]
  s_waitcnt lgkmcnt(7)
  v_exp_f32 v59, v59
  v_mfma_f32_16x16x32_bf16 a[60:63], a[184:187], v[88:91], a[60:63]
  ds_read_b64_tr_b16 a[182:183], v222 offset:28672
  v_cvt_pk_bf16_f32 v57, v58, v59
  v_mfma_f32_16x16x32_bf16 a[64:67], a[160:163], v[64:67], a[64:67]
  v_exp_f32 v36, v36
  v_mfma_f32_16x16x32_bf16 a[64:67], a[164:167], v[96:99], a[64:67]
  ds_read_b64_tr_b16 a[184:185], v223 offset:16384
  v_mfma_f32_16x16x32_bf16 a[68:71], a[164:167], v[104:107], a[68:71]
  v_exp_f32 v37, v37
  v_mfma_f32_16x16x32_bf16 a[68:71], a[160:163], v[72:75], a[68:71]
  ds_read_b64_tr_b16 a[186:187], v223 offset:20480
  v_cvt_pk_bf16_f32 v34, v36, v37
  v_mfma_f32_16x16x32_bf16 a[72:75], a[160:163], v[80:83], a[72:75]
  v_exp_f32 v38, v38
  v_mfma_f32_16x16x32_bf16 a[72:75], a[164:167], v[112:115], a[72:75]
  ds_read_b64_tr_b16 a[188:189], v223 offset:24576
  v_mfma_f32_16x16x32_bf16 a[76:79], a[164:167], v[120:123], a[76:79]
  s_waitcnt lgkmcnt(7)
  v_exp_f32 v39, v39
  v_mfma_f32_16x16x32_bf16 a[76:79], a[160:163], v[88:91], a[76:79]
  ds_read_b64_tr_b16 a[190:191], v223 offset:28672
  v_cvt_pk_bf16_f32 v35, v38, v39
  v_mfma_f32_16x16x32_bf16 a[80:83], a[168:171], v[64:67], a[80:83]
  s_waitcnt vmcnt(11)
  v_exp_f32 v44, v44
  v_mfma_f32_16x16x32_bf16 a[80:83], a[172:175], v[96:99], a[80:83]
  v_mfma_f32_16x16x32_bf16 a[84:87], a[172:175], v[104:107], a[84:87]
  s_barrier
  v_exp_f32 v45, v45
  v_mfma_f32_16x16x32_bf16 a[84:87], a[168:171], v[72:75], a[84:87]
  ds_read_b128 a[128:131], v212 offset:49152
  v_cvt_pk_bf16_f32 v42, v44, v45
  v_mfma_f32_16x16x32_bf16 a[88:91], a[168:171], v[80:83], a[88:91]
  v_exp_f32 v46, v46
  v_mfma_f32_16x16x32_bf16 a[88:91], a[172:175], v[112:115], a[88:91]
  ds_read_b128 a[132:135], v213 offset:49152
  v_mfma_f32_16x16x32_bf16 a[92:95], a[172:175], v[120:123], a[92:95]
  s_waitcnt lgkmcnt(6)
  v_exp_f32 v47, v47
  v_mfma_f32_16x16x32_bf16 a[92:95], a[168:171], v[88:91], a[92:95]
  ds_read_b128 a[136:139], v214 offset:49152
  v_cvt_pk_bf16_f32 v43, v46, v47
  v_mfma_f32_16x16x32_bf16 a[96:99], a[176:179], v[64:67], a[96:99]
  v_exp_f32 v52, v52
  v_mfma_f32_16x16x32_bf16 a[96:99], a[180:183], v[96:99], a[96:99]
  ds_read_b128 a[140:143], v215 offset:49152
  buffer_load_dwordx4 a[216:219], v243, s[24:27], s38 offen sc1
  s_add_u32 s38, s38, 4096
  v_mfma_f32_16x16x32_bf16 a[100:103], a[180:183], v[104:107], a[100:103]
  v_exp_f32 v53, v53
  v_mfma_f32_16x16x32_bf16 a[100:103], a[176:179], v[72:75], a[100:103]
  v_cvt_pk_bf16_f32 v50, v52, v53
  v_mfma_f32_16x16x32_bf16 a[104:107], a[176:179], v[80:83], a[104:107]
  v_exp_f32 v54, v54
  v_mfma_f32_16x16x32_bf16 a[104:107], a[180:183], v[112:115], a[104:107]
  v_mfma_f32_16x16x32_bf16 a[108:111], a[180:183], v[120:123], a[108:111]
  s_waitcnt lgkmcnt(4)
  v_exp_f32 v55, v55
  v_mfma_f32_16x16x32_bf16 a[108:111], a[176:179], v[88:91], a[108:111]
  v_cvt_pk_bf16_f32 v51, v54, v55
  v_mfma_f32_16x16x32_bf16 a[112:115], a[184:187], v[64:67], a[112:115]
  v_exp_f32 v60, v60
  v_mfma_f32_16x16x32_bf16 a[112:115], a[188:191], v[96:99], a[112:115]
  v_mfma_f32_16x16x32_bf16 a[116:119], a[188:191], v[104:107], a[116:119]
  v_exp_f32 v61, v61
  v_mfma_f32_16x16x32_bf16 a[116:119], a[184:187], v[72:75], a[116:119]
  v_cvt_pk_bf16_f32 v58, v60, v61
  v_mfma_f32_16x16x32_bf16 a[120:123], a[184:187], v[80:83], a[120:123]
  v_exp_f32 v62, v62
  v_mfma_f32_16x16x32_bf16 a[120:123], a[188:191], v[112:115], a[120:123]
  v_mfma_f32_16x16x32_bf16 a[124:127], a[188:191], v[120:123], a[124:127]
  s_waitcnt lgkmcnt(0)
  v_exp_f32 v63, v63
  v_mfma_f32_16x16x32_bf16 a[124:127], a[184:187], v[88:91], a[124:127]
  v_cvt_pk_bf16_f32 v59, v62, v63
  v_mfma_f32_16x16x32_bf16 v[64:67], a[128:131], v[128:131], v[192:195]
  s_add_u32 m0, s28, 65536
  v_mfma_f32_16x16x32_bf16 v[64:67], a[132:135], v[132:135], v[64:67]
  ds_read_b128 a[144:147], v212 offset:53248
  v_mfma_f32_16x16x32_bf16 v[64:67], a[136:139], v[136:139], v[64:67]
  buffer_load_dwordx4 v236, s[16:19], s29 offen offset:0 lds
  v_mfma_f32_16x16x32_bf16 v[64:67], a[140:143], v[140:143], v[64:67]
  ds_read_b128 a[148:151], v213 offset:53248
  v_mfma_f32_16x16x32_bf16 v[72:75], a[140:143], v[156:159], v[196:199]
  v_mfma_f32_16x16x32_bf16 v[72:75], a[136:139], v[152:155], v[72:75]
  ds_read_b128 a[152:155], v214 offset:53248
  v_mfma_f32_16x16x32_bf16 v[72:75], a[132:135], v[148:151], v[72:75]
  buffer_load_dwordx4 v237, s[16:19], s29 offen offset:1024 lds
  v_mfma_f32_16x16x32_bf16 v[72:75], a[128:131], v[144:147], v[72:75]
  ds_read_b128 a[156:159], v215 offset:53248
  v_mfma_f32_16x16x32_bf16 v[80:83], a[128:131], v[160:163], v[200:203]
  v_exp_f32 v64, v64
  v_mfma_f32_16x16x32_bf16 v[80:83], a[132:135], v[164:167], v[80:83]
  v_mfma_f32_16x16x32_bf16 v[80:83], a[136:139], v[168:171], v[80:83]
  v_exp_f32 v65, v65
  v_mfma_f32_16x16x32_bf16 v[80:83], a[140:143], v[172:175], v[80:83]
  v_cvt_pk_bf16_f32 v64, v64, v65
  v_mfma_f32_16x16x32_bf16 v[88:91], a[140:143], v[188:191], v[204:207]
  v_exp_f32 v66, v66
  v_mfma_f32_16x16x32_bf16 v[88:91], a[136:139], v[184:187], v[88:91]
  buffer_load_dwordx4 v236, s[16:19], s29 offen offset:2048 lds
  v_mfma_f32_16x16x32_bf16 v[88:91], a[132:135], v[180:183], v[88:91]
  s_waitcnt lgkmcnt(0)
  v_exp_f32 v67, v67
  v_mfma_f32_16x16x32_bf16 v[88:91], a[128:131], v[176:179], v[88:91]
  v_cvt_pk_bf16_f32 v65, v66, v67
  v_mfma_f32_16x16x32_bf16 v[68:71], a[144:147], v[128:131], v[192:195]
  v_exp_f32 v72, v72
  v_mfma_f32_16x16x32_bf16 v[68:71], a[148:151], v[132:135], v[68:71]
  ds_read_b128 a[128:131], v212 offset:57344
  v_mfma_f32_16x16x32_bf16 v[68:71], a[152:155], v[136:139], v[68:71]
  v_exp_f32 v73, v73
  v_mfma_f32_16x16x32_bf16 v[68:71], a[156:159], v[140:143], v[68:71]
  ds_read_b128 a[132:135], v213 offset:57344
  v_cvt_pk_bf16_f32 v72, v72, v73
  v_mfma_f32_16x16x32_bf16 v[76:79], a[156:159], v[156:159], v[196:199]
  v_exp_f32 v74, v74
  v_mfma_f32_16x16x32_bf16 v[76:79], a[152:155], v[152:155], v[76:79]
  ds_read_b128 a[136:139], v214 offset:57344
  v_mfma_f32_16x16x32_bf16 v[76:79], a[148:151], v[148:151], v[76:79]
  v_exp_f32 v75, v75
  v_mfma_f32_16x16x32_bf16 v[76:79], a[144:147], v[144:147], v[76:79]
  ds_read_b128 a[140:143], v215 offset:57344
  v_cvt_pk_bf16_f32 v73, v74, v75
  v_mfma_f32_16x16x32_bf16 v[84:87], a[144:147], v[160:163], v[200:203]
  v_exp_f32 v80, v80
  v_mfma_f32_16x16x32_bf16 v[84:87], a[148:151], v[164:167], v[84:87]
  buffer_load_dwordx4 v237, s[16:19], s29 offen offset:3072 lds
  v_mfma_f32_16x16x32_bf16 v[84:87], a[152:155], v[168:171], v[84:87]
  s_add_u32 s29, s29, 16384
  v_exp_f32 v81, v81
  v_mfma_f32_16x16x32_bf16 v[84:87], a[156:159], v[172:175], v[84:87]
  v_cvt_pk_bf16_f32 v80, v80, v81
  v_mfma_f32_16x16x32_bf16 v[92:95], a[156:159], v[188:191], v[204:207]
  s_add_u32 m0, s28, 16384
  v_exp_f32 v82, v82
  v_mfma_f32_16x16x32_bf16 v[92:95], a[152:155], v[184:187], v[92:95]
  buffer_load_dwordx4 v232, s[12:15], s29 offen offset:0 lds
  v_mfma_f32_16x16x32_bf16 v[92:95], a[148:151], v[180:183], v[92:95]
  s_waitcnt lgkmcnt(0)
  v_exp_f32 v83, v83
  v_mfma_f32_16x16x32_bf16 v[92:95], a[144:147], v[176:179], v[92:95]
  v_cvt_pk_bf16_f32 v81, v82, v83
  v_mfma_f32_16x16x32_bf16 v[96:99], a[128:131], v[128:131], v[192:195]
  v_exp_f32 v88, v88
  v_mfma_f32_16x16x32_bf16 v[96:99], a[132:135], v[132:135], v[96:99]
  ds_read_b128 a[144:147], v212 offset:61440
  v_mfma_f32_16x16x32_bf16 v[96:99], a[136:139], v[136:139], v[96:99]
  v_exp_f32 v89, v89
  v_mfma_f32_16x16x32_bf16 v[96:99], a[140:143], v[140:143], v[96:99]
  ds_read_b128 a[148:151], v213 offset:61440
  v_cvt_pk_bf16_f32 v88, v88, v89
  v_mfma_f32_16x16x32_bf16 v[104:107], a[140:143], v[156:159], v[196:199]
  v_exp_f32 v90, v90
  v_mfma_f32_16x16x32_bf16 v[104:107], a[136:139], v[152:155], v[104:107]
  ds_read_b128 a[152:155], v214 offset:61440
  v_mfma_f32_16x16x32_bf16 v[104:107], a[132:135], v[148:151], v[104:107]
  v_exp_f32 v91, v91
  v_mfma_f32_16x16x32_bf16 v[104:107], a[128:131], v[144:147], v[104:107]
  ds_read_b128 a[156:159], v215 offset:61440
  v_cvt_pk_bf16_f32 v89, v90, v91
  v_mfma_f32_16x16x32_bf16 v[112:115], a[128:131], v[160:163], v[200:203]
  v_exp_f32 v68, v68
  v_mfma_f32_16x16x32_bf16 v[112:115], a[132:135], v[164:167], v[112:115]
  buffer_load_dwordx4 v233, s[12:15], s29 offen offset:1024 lds
  v_mfma_f32_16x16x32_bf16 v[112:115], a[136:139], v[168:171], v[112:115]
  v_exp_f32 v69, v69
  v_mfma_f32_16x16x32_bf16 v[112:115], a[140:143], v[172:175], v[112:115]
  v_cvt_pk_bf16_f32 v66, v68, v69
  v_mfma_f32_16x16x32_bf16 v[120:123], a[140:143], v[188:191], v[204:207]
  v_exp_f32 v70, v70
  v_mfma_f32_16x16x32_bf16 v[120:123], a[136:139], v[184:187], v[120:123]
  buffer_load_dwordx4 v234, s[12:15], s29 offen offset:2048 lds
  v_mfma_f32_16x16x32_bf16 v[120:123], a[132:135], v[180:183], v[120:123]
  s_waitcnt lgkmcnt(0)
  v_exp_f32 v71, v71
  v_mfma_f32_16x16x32_bf16 v[120:123], a[128:131], v[176:179], v[120:123]
  v_cvt_pk_bf16_f32 v67, v70, v71
  v_mfma_f32_16x16x32_bf16 v[100:103], a[144:147], v[128:131], v[192:195]
  v_exp_f32 v76, v76
  v_mfma_f32_16x16x32_bf16 v[100:103], a[148:151], v[132:135], v[100:103]
  ds_read_b64_tr_b16 a[160:161], v216 offset:32768
  v_mfma_f32_16x16x32_bf16 v[100:103], a[152:155], v[136:139], v[100:103]
  v_exp_f32 v77, v77
  v_mfma_f32_16x16x32_bf16 v[100:103], a[156:159], v[140:143], v[100:103]
  ds_read_b64_tr_b16 a[162:163], v216 offset:36864
  v_cvt_pk_bf16_f32 v74, v76, v77
  v_mfma_f32_16x16x32_bf16 v[108:111], a[156:159], v[156:159], v[196:199]
  v_exp_f32 v78, v78
  v_mfma_f32_16x16x32_bf16 v[108:111], a[152:155], v[152:155], v[108:111]
  ds_read_b64_tr_b16 a[164:165], v216 offset:40960
  buffer_load_dwordx4 v235, s[12:15], s29 offen offset:3072 lds
  v_mfma_f32_16x16x32_bf16 v[108:111], a[148:151], v[148:151], v[108:111]
  v_exp_f32 v79, v79
  v_mfma_f32_16x16x32_bf16 v[108:111], a[144:147], v[144:147], v[108:111]
  ds_read_b64_tr_b16 a[166:167], v216 offset:45056
  v_cvt_pk_bf16_f32 v75, v78, v79
  v_mfma_f32_16x16x32_bf16 v[116:119], a[144:147], v[160:163], v[200:203]
  v_exp_f32 v84, v84
  v_mfma_f32_16x16x32_bf16 v[116:119], a[148:151], v[164:167], v[116:119]
  ds_read_b64_tr_b16 a[168:169], v217 offset:32768
  s_add_u32 m0, s50, 4096
  v_mfma_f32_16x16x32_bf16 v[116:119], a[152:155], v[168:171], v[116:119]
  v_exp_f32 v85, v85
  v_mfma_f32_16x16x32_bf16 v[116:119], a[156:159], v[172:175], v[116:119]
  ds_read_b64_tr_b16 a[170:171], v217 offset:36864
  v_cvt_pk_bf16_f32 v82, v84, v85
  v_mfma_f32_16x16x32_bf16 v[124:127], a[156:159], v[188:191], v[204:207]
  v_exp_f32 v86, v86
  v_mfma_f32_16x16x32_bf16 v[124:127], a[152:155], v[184:187], v[124:127]
  ds_read_b64_tr_b16 a[172:173], v217 offset:40960
  buffer_load_dwordx4 v253, s[44:47], s35 offen lds
  s_add_u32 s35, s35, 221184
  v_mfma_f32_16x16x32_bf16 v[124:127], a[148:151], v[180:183], v[124:127]
  v_exp_f32 v87, v87
  v_mfma_f32_16x16x32_bf16 v[124:127], a[144:147], v[176:179], v[124:127]
  ds_read_b64_tr_b16 a[174:175], v217 offset:45056
  v_cvt_pk_bf16_f32 v83, v86, v87
  v_mfma_f32_16x16x32_bf16 a[192:195], a[208:211], v[0:3], a[192:195]
  v_exp_f32 v92, v92
  v_mfma_f32_16x16x32_bf16 a[192:195], a[208:211], v[32:35], a[192:195]
  ds_read_b64_tr_b16 a[176:177], v218 offset:32768
  v_lshrrev_b32 v254, 4, v242
  v_mfma_f32_16x16x32_bf16 a[196:199], a[208:211], v[8:11], a[196:199]
  v_exp_f32 v93, v93
  v_mfma_f32_16x16x32_bf16 a[196:199], a[208:211], v[40:43], a[196:199]
  ds_read_b64_tr_b16 a[178:179], v218 offset:36864
  v_cvt_pk_bf16_f32 v90, v92, v93
  v_mfma_f32_16x16x32_bf16 a[200:203], a[208:211], v[16:19], a[200:203]
  v_exp_f32 v94, v94
  v_mfma_f32_16x16x32_bf16 a[200:203], a[208:211], v[48:51], a[200:203]
  ds_read_b64_tr_b16 a[180:181], v218 offset:40960
  v_lshrrev_b32 v254, 5, v254
  v_mfma_f32_16x16x32_bf16 a[204:207], a[208:211], v[24:27], a[204:207]
  s_waitcnt lgkmcnt(7)
  v_exp_f32 v95, v95
  v_mfma_f32_16x16x32_bf16 a[204:207], a[208:211], v[56:59], a[204:207]
  ds_read_b64_tr_b16 a[182:183], v218 offset:45056
  v_cvt_pk_bf16_f32 v91, v94, v95
  v_mfma_f32_16x16x32_bf16 a[0:3], a[160:163], v[0:3], a[0:3]
  v_exp_f32 v96, v96
  v_mfma_f32_16x16x32_bf16 a[0:3], a[164:167], v[32:35], a[0:3]
  ds_read_b64_tr_b16 a[184:185], v219 offset:32768
  v_lshl_add_u32 v253, v254, 30, v253
  v_mfma_f32_16x16x32_bf16 a[4:7], a[164:167], v[40:43], a[4:7]
  v_exp_f32 v97, v97
  v_mfma_f32_16x16x32_bf16 a[4:7], a[160:163], v[8:11], a[4:7]
  ds_read_b64_tr_b16 a[186:187], v219 offset:36864
  v_cvt_pk_bf16_f32 v96, v96, v97
  v_mfma_f32_16x16x32_bf16 a[8:11], a[160:163], v[16:19], a[8:11]
  v_exp_f32 v98, v98
  v_mfma_f32_16x16x32_bf16 a[8:11], a[164:167], v[48:51], a[8:11]
  ds_read_b64_tr_b16 a[188:189], v219 offset:40960
  v_mfma_f32_16x16x32_bf16 a[12:15], a[164:167], v[56:59], a[12:15]
  s_waitcnt lgkmcnt(7)
  v_exp_f32 v99, v99
  v_mfma_f32_16x16x32_bf16 a[12:15], a[160:163], v[24:27], a[12:15]
  ds_read_b64_tr_b16 a[190:191], v219 offset:45056
  v_cvt_pk_bf16_f32 v97, v98, v99
  v_mfma_f32_16x16x32_bf16 a[16:19], a[168:171], v[0:3], a[16:19]
  v_exp_f32 v104, v104
  v_mfma_f32_16x16x32_bf16 a[16:19], a[172:175], v[32:35], a[16:19]
  ds_read_b64_tr_b16 a[160:161], v220 offset:32768
  v_mfma_f32_16x16x32_bf16 a[20:23], a[172:175], v[40:43], a[20:23]
  v_exp_f32 v105, v105
  v_mfma_f32_16x16x32_bf16 a[20:23], a[168:171], v[8:11], a[20:23]
  ds_read_b64_tr_b16 a[162:163], v220 offset:36864
  v_cvt_pk_bf16_f32 v104, v104, v105
  v_mfma_f32_16x16x32_bf16 a[24:27], a[168:171], v[16:19], a[24:27]
  v_exp_f32 v106, v106
  v_mfma_f32_16x16x32_bf16 a[24:27], a[172:175], v[48:51], a[24:27]
  ds_read_b64_tr_b16 a[164:165], v220 offset:40960
  v_mfma_f32_16x16x32_bf16 a[28:31], a[172:175], v[56:59], a[28:31]
  s_waitcnt lgkmcnt(7)
  v_exp_f32 v107, v107
  v_mfma_f32_16x16x32_bf16 a[28:31], a[168:171], v[24:27], a[28:31]
  ds_read_b64_tr_b16 a[166:167], v220 offset:45056
  v_cvt_pk_bf16_f32 v105, v106, v107
  v_mfma_f32_16x16x32_bf16 a[32:35], a[176:179], v[0:3], a[32:35]
  v_exp_f32 v112, v112
  v_mfma_f32_16x16x32_bf16 a[32:35], a[180:183], v[32:35], a[32:35]
  ds_read_b64_tr_b16 a[168:169], v221 offset:32768
  v_mfma_f32_16x16x32_bf16 a[36:39], a[180:183], v[40:43], a[36:39]
  v_exp_f32 v113, v113
  v_mfma_f32_16x16x32_bf16 a[36:39], a[176:179], v[8:11], a[36:39]
  ds_read_b64_tr_b16 a[170:171], v221 offset:36864
  v_cvt_pk_bf16_f32 v112, v112, v113
  v_mfma_f32_16x16x32_bf16 a[40:43], a[176:179], v[16:19], a[40:43]
  v_exp_f32 v114, v114
  v_mfma_f32_16x16x32_bf16 a[40:43], a[180:183], v[48:51], a[40:43]
  ds_read_b64_tr_b16 a[172:173], v221 offset:40960
  v_mfma_f32_16x16x32_bf16 a[44:47], a[180:183], v[56:59], a[44:47]
  s_waitcnt lgkmcnt(7)
  v_exp_f32 v115, v115
  v_mfma_f32_16x16x32_bf16 a[44:47], a[176:179], v[24:27], a[44:47]
  ds_read_b64_tr_b16 a[174:175], v221 offset:45056
  v_cvt_pk_bf16_f32 v113, v114, v115
  v_mfma_f32_16x16x32_bf16 a[48:51], a[184:187], v[0:3], a[48:51]
  v_exp_f32 v120, v120
  v_mfma_f32_16x16x32_bf16 a[48:51], a[188:191], v[32:35], a[48:51]
  ds_read_b64_tr_b16 a[176:177], v222 offset:32768
  v_mfma_f32_16x16x32_bf16 a[52:55], a[188:191], v[40:43], a[52:55]
  v_exp_f32 v121, v121
  v_mfma_f32_16x16x32_bf16 a[52:55], a[184:187], v[8:11], a[52:55]
  ds_read_b64_tr_b16 a[178:179], v222 offset:36864
  v_cvt_pk_bf16_f32 v120, v120, v121
  v_mfma_f32_16x16x32_bf16 a[56:59], a[184:187], v[16:19], a[56:59]
  v_exp_f32 v122, v122
  v_mfma_f32_16x16x32_bf16 a[56:59], a[188:191], v[48:51], a[56:59]
  ds_read_b64_tr_b16 a[180:181], v222 offset:40960
  v_mfma_f32_16x16x32_bf16 a[60:63], a[188:191], v[56:59], a[60:63]
  s_waitcnt lgkmcnt(7)
  v_exp_f32 v123, v123
  v_mfma_f32_16x16x32_bf16 a[60:63], a[184:187], v[24:27], a[60:63]
  ds_read_b64_tr_b16 a[182:183], v222 offset:45056
  v_cvt_pk_bf16_f32 v121, v122, v123
  v_mfma_f32_16x16x32_bf16 a[64:67], a[160:163], v[0:3], a[64:67]
  v_exp_f32 v100, v100
  v_mfma_f32_16x16x32_bf16 a[64:67], a[164:167], v[32:35], a[64:67]
  ds_read_b64_tr_b16 a[184:185], v223 offset:32768
  v_mfma_f32_16x16x32_bf16 a[68:71], a[164:167], v[40:43], a[68:71]
  v_exp_f32 v101, v101
  v_mfma_f32_16x16x32_bf16 a[68:71], a[160:163], v[8:11], a[68:71]
  ds_read_b64_tr_b16 a[186:187], v223 offset:36864
  v_cvt_pk_bf16_f32 v98, v100, v101
  v_mfma_f32_16x16x32_bf16 a[72:75], a[160:163], v[16:19], a[72:75]
  v_exp_f32 v102, v102
  v_mfma_f32_16x16x32_bf16 a[72:75], a[164:167], v[48:51], a[72:75]
  ds_read_b64_tr_b16 a[188:189], v223 offset:40960
  v_mfma_f32_16x16x32_bf16 a[76:79], a[164:167], v[56:59], a[76:79]
  s_waitcnt lgkmcnt(7)
  v_exp_f32 v103, v103
  v_mfma_f32_16x16x32_bf16 a[76:79], a[160:163], v[24:27], a[76:79]
  ds_read_b64_tr_b16 a[190:191], v223 offset:45056
  v_cvt_pk_bf16_f32 v99, v102, v103
  v_mfma_f32_16x16x32_bf16 a[80:83], a[168:171], v[0:3], a[80:83]
  s_waitcnt vmcnt(11)
  v_exp_f32 v108, v108
  v_mfma_f32_16x16x32_bf16 a[80:83], a[172:175], v[32:35], a[80:83]
  v_mfma_f32_16x16x32_bf16 a[84:87], a[172:175], v[40:43], a[84:87]
  s_barrier
  v_exp_f32 v109, v109
  v_mfma_f32_16x16x32_bf16 a[84:87], a[168:171], v[8:11], a[84:87]
  ds_read_b128 a[128:131], v212 offset:0
  v_cvt_pk_bf16_f32 v106, v108, v109
  v_mfma_f32_16x16x32_bf16 a[88:91], a[168:171], v[16:19], a[88:91]
  v_exp_f32 v110, v110
  v_mfma_f32_16x16x32_bf16 a[88:91], a[172:175], v[48:51], a[88:91]
  ds_read_b128 a[132:135], v213 offset:0
  v_mfma_f32_16x16x32_bf16 a[92:95], a[172:175], v[56:59], a[92:95]
  s_waitcnt lgkmcnt(6)
  v_exp_f32 v111, v111
  v_mfma_f32_16x16x32_bf16 a[92:95], a[168:171], v[24:27], a[92:95]
  ds_read_b128 a[136:139], v214 offset:0
  v_cvt_pk_bf16_f32 v107, v110, v111
  v_mfma_f32_16x16x32_bf16 a[96:99], a[176:179], v[0:3], a[96:99]
  v_exp_f32 v116, v116
  v_mfma_f32_16x16x32_bf16 a[96:99], a[180:183], v[32:35], a[96:99]
  ds_read_b128 a[140:143], v215 offset:0
  buffer_load_dwordx4 a[220:223], v243, s[24:27], s38 offen sc1
  s_add_u32 s38, s38, 4096
  v_mfma_f32_16x16x32_bf16 a[100:103], a[180:183], v[40:43], a[100:103]
  v_exp_f32 v117, v117
  v_mfma_f32_16x16x32_bf16 a[100:103], a[176:179], v[8:11], a[100:103]
  v_cvt_pk_bf16_f32 v114, v116, v117
  v_mfma_f32_16x16x32_bf16 a[104:107], a[176:179], v[16:19], a[104:107]
  v_exp_f32 v118, v118
  v_mfma_f32_16x16x32_bf16 a[104:107], a[180:183], v[48:51], a[104:107]
  v_mfma_f32_16x16x32_bf16 a[108:111], a[180:183], v[56:59], a[108:111]
  s_waitcnt lgkmcnt(4)
  v_exp_f32 v119, v119
  v_mfma_f32_16x16x32_bf16 a[108:111], a[176:179], v[24:27], a[108:111]
  v_cvt_pk_bf16_f32 v115, v118, v119
  v_mfma_f32_16x16x32_bf16 a[112:115], a[184:187], v[0:3], a[112:115]
  v_exp_f32 v124, v124
  v_mfma_f32_16x16x32_bf16 a[112:115], a[188:191], v[32:35], a[112:115]
  v_mfma_f32_16x16x32_bf16 a[116:119], a[188:191], v[40:43], a[116:119]
  v_exp_f32 v125, v125
  v_mfma_f32_16x16x32_bf16 a[116:119], a[184:187], v[8:11], a[116:119]
  v_cvt_pk_bf16_f32 v122, v124, v125
  v_mfma_f32_16x16x32_bf16 a[120:123], a[184:187], v[16:19], a[120:123]
  v_exp_f32 v126, v126
  v_mfma_f32_16x16x32_bf16 a[120:123], a[188:191], v[48:51], a[120:123]
  v_mfma_f32_16x16x32_bf16 a[124:127], a[188:191], v[56:59], a[124:127]
  s_waitcnt lgkmcnt(0)
  v_exp_f32 v127, v127
  v_mfma_f32_16x16x32_bf16 a[124:127], a[184:187], v[24:27], a[124:127]
  v_cvt_pk_bf16_f32 v123, v126, v127
  v_mfma_f32_16x16x32_bf16 v[0:3], a[128:131], v[128:131], v[192:195]
  s_add_u32 m0, s28, 81920
  v_mfma_f32_16x16x32_bf16 v[0:3], a[132:135], v[132:135], v[0:3]
  ds_read_b128 a[144:147], v212 offset:4096
  v_mfma_f32_16x16x32_bf16 v[0:3], a[136:139], v[136:139], v[0:3]
  buffer_load_dwordx4 v236, s[16:19], s29 offen offset:0 lds
  v_mfma_f32_16x16x32_bf16 v[0:3], a[140:143], v[140:143], v[0:3]
  ds_read_b128 a[148:151], v213 offset:4096
  v_mfma_f32_16x16x32_bf16 v[8:11], a[140:143], v[156:159], v[196:199]
  v_mfma_f32_16x16x32_bf16 v[8:11], a[136:139], v[152:155], v[8:11]
  ds_read_b128 a[152:155], v214 offset:4096
  v_mfma_f32_16x16x32_bf16 v[8:11], a[132:135], v[148:151], v[8:11]
  buffer_load_dwordx4 v237, s[16:19], s29 offen offset:1024 lds
  v_mfma_f32_16x16x32_bf16 v[8:11], a[128:131], v[144:147], v[8:11]
  ds_read_b128 a[156:159], v215 offset:4096
  v_mfma_f32_16x16x32_bf16 v[16:19], a[128:131], v[160:163], v[200:203]
  v_exp_f32 v0, v0
  v_mfma_f32_16x16x32_bf16 v[16:19], a[132:135], v[164:167], v[16:19]
  v_mfma_f32_16x16x32_bf16 v[16:19], a[136:139], v[168:171], v[16:19]
  v_exp_f32 v1, v1
  v_mfma_f32_16x16x32_bf16 v[16:19], a[140:143], v[172:175], v[16:19]
  v_cvt_pk_bf16_f32 v0, v0, v1
  v_mfma_f32_16x16x32_bf16 v[24:27], a[140:143], v[188:191], v[204:207]
  v_exp_f32 v2, v2
  v_mfma_f32_16x16x32_bf16 v[24:27], a[136:139], v[184:187], v[24:27]
  buffer_load_dwordx4 v236, s[16:19], s29 offen offset:2048 lds
  v_mfma_f32_16x16x32_bf16 v[24:27], a[132:135], v[180:183], v[24:27]
  s_waitcnt lgkmcnt(0)
  v_exp_f32 v3, v3
  v_mfma_f32_16x16x32_bf16 v[24:27], a[128:131], v[176:179], v[24:27]
  v_cvt_pk_bf16_f32 v1, v2, v3
  v_mfma_f32_16x16x32_bf16 v[4:7], a[144:147], v[128:131], v[192:195]
  v_exp_f32 v8, v8
  v_mfma_f32_16x16x32_bf16 v[4:7], a[148:151], v[132:135], v[4:7]
  ds_read_b128 a[128:131], v212 offset:8192
  v_mfma_f32_16x16x32_bf16 v[4:7], a[152:155], v[136:139], v[4:7]
  v_exp_f32 v9, v9
  v_mfma_f32_16x16x32_bf16 v[4:7], a[156:159], v[140:143], v[4:7]
  ds_read_b128 a[132:135], v213 offset:8192
  v_cvt_pk_bf16_f32 v8, v8, v9
  v_mfma_f32_16x16x32_bf16 v[12:15], a[156:159], v[156:159], v[196:199]
  v_exp_f32 v10, v10
  v_mfma_f32_16x16x32_bf16 v[12:15], a[152:155], v[152:155], v[12:15]
  ds_read_b128 a[136:139], v214 offset:8192
  v_mfma_f32_16x16x32_bf16 v[12:15], a[148:151], v[148:151], v[12:15]
  v_exp_f32 v11, v11
  v_mfma_f32_16x16x32_bf16 v[12:15], a[144:147], v[144:147], v[12:15]
  ds_read_b128 a[140:143], v215 offset:8192
  v_cvt_pk_bf16_f32 v9, v10, v11
  v_mfma_f32_16x16x32_bf16 v[20:23], a[144:147], v[160:163], v[200:203]
  v_exp_f32 v16, v16
  v_mfma_f32_16x16x32_bf16 v[20:23], a[148:151], v[164:167], v[20:23]
  buffer_load_dwordx4 v237, s[16:19], s29 offen offset:3072 lds
  v_mfma_f32_16x16x32_bf16 v[20:23], a[152:155], v[168:171], v[20:23]
  s_add_u32 s29, s29, 16384
  v_exp_f32 v17, v17
  v_mfma_f32_16x16x32_bf16 v[20:23], a[156:159], v[172:175], v[20:23]
  v_cvt_pk_bf16_f32 v16, v16, v17
  v_mfma_f32_16x16x32_bf16 v[28:31], a[156:159], v[188:191], v[204:207]
  s_add_u32 m0, s28, 32768
  v_exp_f32 v18, v18
  v_mfma_f32_16x16x32_bf16 v[28:31], a[152:155], v[184:187], v[28:31]
  buffer_load_dwordx4 v232, s[12:15], s29 offen offset:0 lds
  v_mfma_f32_16x16x32_bf16 v[28:31], a[148:151], v[180:183], v[28:31]
  s_waitcnt lgkmcnt(0)
  v_exp_f32 v19, v19
  v_mfma_f32_16x16x32_bf16 v[28:31], a[144:147], v[176:179], v[28:31]
  v_cvt_pk_bf16_f32 v17, v18, v19
  v_mfma_f32_16x16x32_bf16 v[32:35], a[128:131], v[128:131], v[192:195]
  v_exp_f32 v24, v24
  v_mfma_f32_16x16x32_bf16 v[32:35], a[132:135], v[132:135], v[32:35]
  ds_read_b128 a[144:147], v212 offset:12288
  v_mfma_f32_16x16x32_bf16 v[32:35], a[136:139], v[136:139], v[32:35]
  v_exp_f32 v25, v25
  v_mfma_f32_16x16x32_bf16 v[32:35], a[140:143], v[140:143], v[32:35]
  ds_read_b128 a[148:151], v213 offset:12288
  v_cvt_pk_bf16_f32 v24, v24, v25
  v_mfma_f32_16x16x32_bf16 v[40:43], a[140:143], v[156:159], v[196:199]
  v_exp_f32 v26, v26
  v_mfma_f32_16x16x32_bf16 v[40:43], a[136:139], v[152:155], v[40:43]
  ds_read_b128 a[152:155], v214 offset:12288
  v_mfma_f32_16x16x32_bf16 v[40:43], a[132:135], v[148:151], v[40:43]
  v_exp_f32 v27, v27
  v_mfma_f32_16x16x32_bf16 v[40:43], a[128:131], v[144:147], v[40:43]
  ds_read_b128 a[156:159], v215 offset:12288
  v_cvt_pk_bf16_f32 v25, v26, v27
  v_mfma_f32_16x16x32_bf16 v[48:51], a[128:131], v[160:163], v[200:203]
  v_exp_f32 v4, v4
  v_mfma_f32_16x16x32_bf16 v[48:51], a[132:135], v[164:167], v[48:51]
  buffer_load_dwordx4 v233, s[12:15], s29 offen offset:1024 lds
  v_mfma_f32_16x16x32_bf16 v[48:51], a[136:139], v[168:171], v[48:51]
  v_exp_f32 v5, v5
  v_mfma_f32_16x16x32_bf16 v[48:51], a[140:143], v[172:175], v[48:51]
  v_cvt_pk_bf16_f32 v2, v4, v5
  v_mfma_f32_16x16x32_bf16 v[56:59], a[140:143], v[188:191], v[204:207]
  v_exp_f32 v6, v6
  v_mfma_f32_16x16x32_bf16 v[56:59], a[136:139], v[184:187], v[56:59]
  buffer_load_dwordx4 v234, s[12:15], s29 offen offset:2048 lds
  v_mfma_f32_16x16x32_bf16 v[56:59], a[132:135], v[180:183], v[56:59]
  s_waitcnt lgkmcnt(0)
  v_exp_f32 v7, v7
  v_mfma_f32_16x16x32_bf16 v[56:59], a[128:131], v[176:179], v[56:59]
  v_cvt_pk_bf16_f32 v3, v6, v7
  v_mfma_f32_16x16x32_bf16 v[36:39], a[144:147], v[128:131], v[192:195]
  v_exp_f32 v12, v12
  v_mfma_f32_16x16x32_bf16 v[36:39], a[148:151], v[132:135], v[36:39]
  ds_read_b64_tr_b16 a[160:161], v216 offset:49152
  v_mfma_f32_16x16x32_bf16 v[36:39], a[152:155], v[136:139], v[36:39]
  v_exp_f32 v13, v13
  v_mfma_f32_16x16x32_bf16 v[36:39], a[156:159], v[140:143], v[36:39]
  ds_read_b64_tr_b16 a[162:163], v216 offset:53248
  v_cvt_pk_bf16_f32 v10, v12, v13
  v_mfma_f32_16x16x32_bf16 v[44:47], a[156:159], v[156:159], v[196:199]
  v_exp_f32 v14, v14
  v_mfma_f32_16x16x32_bf16 v[44:47], a[152:155], v[152:155], v[44:47]
  ds_read_b64_tr_b16 a[164:165], v216 offset:57344
  buffer_load_dwordx4 v235, s[12:15], s29 offen offset:3072 lds
  v_mfma_f32_16x16x32_bf16 v[44:47], a[148:151], v[148:151], v[44:47]
  v_exp_f32 v15, v15
  v_mfma_f32_16x16x32_bf16 v[44:47], a[144:147], v[144:147], v[44:47]
  ds_read_b64_tr_b16 a[166:167], v216 offset:61440
  v_cvt_pk_bf16_f32 v11, v14, v15
  v_mfma_f32_16x16x32_bf16 v[52:55], a[144:147], v[160:163], v[200:203]
  v_exp_f32 v20, v20
  v_mfma_f32_16x16x32_bf16 v[52:55], a[148:151], v[164:167], v[52:55]
  ds_read_b64_tr_b16 a[168:169], v217 offset:49152
  s_add_u32 m0, s50, 2048
  v_mfma_f32_16x16x32_bf16 v[52:55], a[152:155], v[168:171], v[52:55]
  v_exp_f32 v21, v21
  v_mfma_f32_16x16x32_bf16 v[52:55], a[156:159], v[172:175], v[52:55]
  ds_read_b64_tr_b16 a[170:171], v217 offset:53248
  v_cvt_pk_bf16_f32 v18, v20, v21
  v_mfma_f32_16x16x32_bf16 v[60:63], a[156:159], v[188:191], v[204:207]
  v_exp_f32 v22, v22
  v_mfma_f32_16x16x32_bf16 v[60:63], a[152:155], v[184:187], v[60:63]
  ds_read_b64_tr_b16 a[172:173], v217 offset:57344
  buffer_load_dwordx4 v253, s[20:23], s35 offen lds
  v_mfma_f32_16x16x32_bf16 v[60:63], a[148:151], v[180:183], v[60:63]
  v_exp_f32 v23, v23
  v_mfma_f32_16x16x32_bf16 v[60:63], a[144:147], v[176:179], v[60:63]
  ds_read_b64_tr_b16 a[174:175], v217 offset:61440
  v_cvt_pk_bf16_f32 v19, v22, v23
  v_mfma_f32_16x16x32_bf16 a[192:195], a[208:211], v[64:67], a[192:195]
  v_exp_f32 v28, v28
  v_mfma_f32_16x16x32_bf16 a[192:195], a[208:211], v[96:99], a[192:195]
  ds_read_b64_tr_b16 a[176:177], v218 offset:49152
  v_mfma_f32_16x16x32_bf16 a[196:199], a[208:211], v[72:75], a[196:199]
  v_exp_f32 v29, v29
  v_mfma_f32_16x16x32_bf16 a[196:199], a[208:211], v[104:107], a[196:199]
  ds_read_b64_tr_b16 a[178:179], v218 offset:53248
  v_cvt_pk_bf16_f32 v26, v28, v29
  v_mfma_f32_16x16x32_bf16 a[200:203], a[208:211], v[80:83], a[200:203]
  v_exp_f32 v30, v30
  v_mfma_f32_16x16x32_bf16 a[200:203], a[208:211], v[112:115], a[200:203]
  ds_read_b64_tr_b16 a[180:181], v218 offset:57344
  v_mfma_f32_16x16x32_bf16 a[204:207], a[208:211], v[88:91], a[204:207]
  s_waitcnt lgkmcnt(7)
  v_exp_f32 v31, v31
  v_mfma_f32_16x16x32_bf16 a[204:207], a[208:211], v[120:123], a[204:207]
  ds_read_b64_tr_b16 a[182:183], v218 offset:61440
  v_cvt_pk_bf16_f32 v27, v30, v31
  v_mfma_f32_16x16x32_bf16 a[0:3], a[160:163], v[64:67], a[0:3]
  v_exp_f32 v32, v32
  v_mfma_f32_16x16x32_bf16 a[0:3], a[164:167], v[96:99], a[0:3]
  ds_read_b64_tr_b16 a[184:185], v219 offset:49152
  v_mfma_f32_16x16x32_bf16 a[4:7], a[164:167], v[104:107], a[4:7]
  v_exp_f32 v33, v33
  v_mfma_f32_16x16x32_bf16 a[4:7], a[160:163], v[72:75], a[4:7]
  ds_read_b64_tr_b16 a[186:187], v219 offset:53248
  v_cvt_pk_bf16_f32 v32, v32, v33
  v_mfma_f32_16x16x32_bf16 a[8:11], a[160:163], v[80:83], a[8:11]
  v_exp_f32 v34, v34
  v_mfma_f32_16x16x32_bf16 a[8:11], a[164:167], v[112:115], a[8:11]
  ds_read_b64_tr_b16 a[188:189], v219 offset:57344
  v_mfma_f32_16x16x32_bf16 a[12:15], a[164:167], v[120:123], a[12:15]
  s_waitcnt lgkmcnt(7)
  v_exp_f32 v35, v35
  v_mfma_f32_16x16x32_bf16 a[12:15], a[160:163], v[88:91], a[12:15]
  ds_read_b64_tr_b16 a[190:191], v219 offset:61440
  v_cvt_pk_bf16_f32 v33, v34, v35
  v_mfma_f32_16x16x32_bf16 a[16:19], a[168:171], v[64:67], a[16:19]
  v_exp_f32 v40, v40
  v_mfma_f32_16x16x32_bf16 a[16:19], a[172:175], v[96:99], a[16:19]
  ds_read_b64_tr_b16 a[160:161], v220 offset:49152
  v_mfma_f32_16x16x32_bf16 a[20:23], a[172:175], v[104:107], a[20:23]
  v_exp_f32 v41, v41
  v_mfma_f32_16x16x32_bf16 a[20:23], a[168:171], v[72:75], a[20:23]
  ds_read_b64_tr_b16 a[162:163], v220 offset:53248
  v_cvt_pk_bf16_f32 v40, v40, v41
  v_mfma_f32_16x16x32_bf16 a[24:27], a[168:171], v[80:83], a[24:27]
  v_exp_f32 v42, v42
  v_mfma_f32_16x16x32_bf16 a[24:27], a[172:175], v[112:115], a[24:27]
  ds_read_b64_tr_b16 a[164:165], v220 offset:57344
  v_mfma_f32_16x16x32_bf16 a[28:31], a[172:175], v[120:123], a[28:31]
  s_waitcnt lgkmcnt(7)
  v_exp_f32 v43, v43
  v_mfma_f32_16x16x32_bf16 a[28:31], a[168:171], v[88:91], a[28:31]
  ds_read_b64_tr_b16 a[166:167], v220 offset:61440
  v_cvt_pk_bf16_f32 v41, v42, v43
  v_mfma_f32_16x16x32_bf16 a[32:35], a[176:179], v[64:67], a[32:35]
  v_exp_f32 v48, v48
  v_mfma_f32_16x16x32_bf16 a[32:35], a[180:183], v[96:99], a[32:35]
  ds_read_b64_tr_b16 a[168:169], v221 offset:49152
  v_mfma_f32_16x16x32_bf16 a[36:39], a[180:183], v[104:107], a[36:39]
  v_exp_f32 v49, v49
  v_mfma_f32_16x16x32_bf16 a[36:39], a[176:179], v[72:75], a[36:39]
  ds_read_b64_tr_b16 a[170:171], v221 offset:53248
  v_cvt_pk_bf16_f32 v48, v48, v49
  v_mfma_f32_16x16x32_bf16 a[40:43], a[176:179], v[80:83], a[40:43]
  v_exp_f32 v50, v50
  v_mfma_f32_16x16x32_bf16 a[40:43], a[180:183], v[112:115], a[40:43]
  ds_read_b64_tr_b16 a[172:173], v221 offset:57344
  v_mfma_f32_16x16x32_bf16 a[44:47], a[180:183], v[120:123], a[44:47]
  s_waitcnt lgkmcnt(7)
  v_exp_f32 v51, v51
  v_mfma_f32_16x16x32_bf16 a[44:47], a[176:179], v[88:91], a[44:47]
  ds_read_b64_tr_b16 a[174:175], v221 offset:61440
  v_cvt_pk_bf16_f32 v49, v50, v51
  v_mfma_f32_16x16x32_bf16 a[48:51], a[184:187], v[64:67], a[48:51]
  v_exp_f32 v56, v56
  v_mfma_f32_16x16x32_bf16 a[48:51], a[188:191], v[96:99], a[48:51]
  ds_read_b64_tr_b16 a[176:177], v222 offset:49152
  v_mfma_f32_16x16x32_bf16 a[52:55], a[188:191], v[104:107], a[52:55]
  v_exp_f32 v57, v57
  v_mfma_f32_16x16x32_bf16 a[52:55], a[184:187], v[72:75], a[52:55]
  ds_read_b64_tr_b16 a[178:179], v222 offset:53248
  v_cvt_pk_bf16_f32 v56, v56, v57
  v_mfma_f32_16x16x32_bf16 a[56:59], a[184:187], v[80:83], a[56:59]
  v_exp_f32 v58, v58
  v_mfma_f32_16x16x32_bf16 a[56:59], a[188:191], v[112:115], a[56:59]
  ds_read_b64_tr_b16 a[180:181], v222 offset:57344
  v_mfma_f32_16x16x32_bf16 a[60:63], a[188:191], v[120:123], a[60:63]
  s_waitcnt lgkmcnt(7)
  v_exp_f32 v59, v59
  v_mfma_f32_16x16x32_bf16 a[60:63], a[184:187], v[88:91], a[60:63]
  ds_read_b64_tr_b16 a[182:183], v222 offset:61440
  v_cvt_pk_bf16_f32 v57, v58, v59
  v_mfma_f32_16x16x32_bf16 a[64:67], a[160:163], v[64:67], a[64:67]
  v_exp_f32 v36, v36
  v_mfma_f32_16x16x32_bf16 a[64:67], a[164:167], v[96:99], a[64:67]
  ds_read_b64_tr_b16 a[184:185], v223 offset:49152
  v_mfma_f32_16x16x32_bf16 a[68:71], a[164:167], v[104:107], a[68:71]
  v_exp_f32 v37, v37
  v_mfma_f32_16x16x32_bf16 a[68:71], a[160:163], v[72:75], a[68:71]
  ds_read_b64_tr_b16 a[186:187], v223 offset:53248
  v_cvt_pk_bf16_f32 v34, v36, v37
  v_mfma_f32_16x16x32_bf16 a[72:75], a[160:163], v[80:83], a[72:75]
  v_exp_f32 v38, v38
  v_mfma_f32_16x16x32_bf16 a[72:75], a[164:167], v[112:115], a[72:75]
  ds_read_b64_tr_b16 a[188:189], v223 offset:57344
  v_mfma_f32_16x16x32_bf16 a[76:79], a[164:167], v[120:123], a[76:79]
  s_waitcnt lgkmcnt(7)
  v_exp_f32 v39, v39
  v_mfma_f32_16x16x32_bf16 a[76:79], a[160:163], v[88:91], a[76:79]
  ds_read_b64_tr_b16 a[190:191], v223 offset:61440
  v_cvt_pk_bf16_f32 v35, v38, v39
  v_mfma_f32_16x16x32_bf16 a[80:83], a[168:171], v[64:67], a[80:83]
  s_waitcnt vmcnt(11)
  v_exp_f32 v44, v44
  v_mfma_f32_16x16x32_bf16 a[80:83], a[172:175], v[96:99], a[80:83]
  v_mfma_f32_16x16x32_bf16 a[84:87], a[172:175], v[104:107], a[84:87]
  s_barrier
  v_exp_f32 v45, v45
  v_mfma_f32_16x16x32_bf16 a[84:87], a[168:171], v[72:75], a[84:87]
  ds_read_b128 a[128:131], v212 offset:16384
  v_cvt_pk_bf16_f32 v42, v44, v45
  v_mfma_f32_16x16x32_bf16 a[88:91], a[168:171], v[80:83], a[88:91]
  v_exp_f32 v46, v46
  v_mfma_f32_16x16x32_bf16 a[88:91], a[172:175], v[112:115], a[88:91]
  ds_read_b128 a[132:135], v213 offset:16384
  v_mfma_f32_16x16x32_bf16 a[92:95], a[172:175], v[120:123], a[92:95]
  s_waitcnt lgkmcnt(6)
  v_exp_f32 v47, v47
  v_mfma_f32_16x16x32_bf16 a[92:95], a[168:171], v[88:91], a[92:95]
  ds_read_b128 a[136:139], v214 offset:16384
  v_cvt_pk_bf16_f32 v43, v46, v47
  v_mfma_f32_16x16x32_bf16 a[96:99], a[176:179], v[64:67], a[96:99]
  v_exp_f32 v52, v52
  v_mfma_f32_16x16x32_bf16 a[96:99], a[180:183], v[96:99], a[96:99]
  ds_read_b128 a[140:143], v215 offset:16384
  buffer_load_dwordx4 a[224:227], v243, s[24:27], s38 offen sc1
  s_add_u32 s38, s38, 4096
  v_mfma_f32_16x16x32_bf16 a[100:103], a[180:183], v[104:107], a[100:103]
  v_exp_f32 v53, v53
  v_mfma_f32_16x16x32_bf16 a[100:103], a[176:179], v[72:75], a[100:103]
  v_cvt_pk_bf16_f32 v50, v52, v53
  v_mfma_f32_16x16x32_bf16 a[104:107], a[176:179], v[80:83], a[104:107]
  v_exp_f32 v54, v54
  v_mfma_f32_16x16x32_bf16 a[104:107], a[180:183], v[112:115], a[104:107]
  v_mfma_f32_16x16x32_bf16 a[108:111], a[180:183], v[120:123], a[108:111]
  s_waitcnt lgkmcnt(4)
  v_exp_f32 v55, v55
  v_mfma_f32_16x16x32_bf16 a[108:111], a[176:179], v[88:91], a[108:111]
  v_cvt_pk_bf16_f32 v51, v54, v55
  v_mfma_f32_16x16x32_bf16 a[112:115], a[184:187], v[64:67], a[112:115]
  v_exp_f32 v60, v60
  v_mfma_f32_16x16x32_bf16 a[112:115], a[188:191], v[96:99], a[112:115]
  v_mfma_f32_16x16x32_bf16 a[116:119], a[188:191], v[104:107], a[116:119]
  v_exp_f32 v61, v61
  v_mfma_f32_16x16x32_bf16 a[116:119], a[184:187], v[72:75], a[116:119]
  v_cvt_pk_bf16_f32 v58, v60, v61
  v_mfma_f32_16x16x32_bf16 a[120:123], a[184:187], v[80:83], a[120:123]
  v_exp_f32 v62, v62
  v_mfma_f32_16x16x32_bf16 a[120:123], a[188:191], v[112:115], a[120:123]
  v_mfma_f32_16x16x32_bf16 a[124:127], a[188:191], v[120:123], a[124:127]
  s_waitcnt lgkmcnt(0)
  v_exp_f32 v63, v63
  v_mfma_f32_16x16x32_bf16 a[124:127], a[184:187], v[88:91], a[124:127]
  v_cvt_pk_bf16_f32 v59, v62, v63
  v_mfma_f32_16x16x32_bf16 v[64:67], a[128:131], v[128:131], v[192:195]
  s_add_u32 m0, s28, 98304
  v_mfma_f32_16x16x32_bf16 v[64:67], a[132:135], v[132:135], v[64:67]
  ds_read_b128 a[144:147], v212 offset:20480
  v_mfma_f32_16x16x32_bf16 v[64:67], a[136:139], v[136:139], v[64:67]
  buffer_load_dwordx4 v236, s[16:19], s29 offen offset:0 lds
  v_mfma_f32_16x16x32_bf16 v[64:67], a[140:143], v[140:143], v[64:67]
  ds_read_b128 a[148:151], v213 offset:20480
  v_mfma_f32_16x16x32_bf16 v[72:75], a[140:143], v[156:159], v[196:199]
  v_mfma_f32_16x16x32_bf16 v[72:75], a[136:139], v[152:155], v[72:75]
  ds_read_b128 a[152:155], v214 offset:20480
  v_mfma_f32_16x16x32_bf16 v[72:75], a[132:135], v[148:151], v[72:75]
  buffer_load_dwordx4 v237, s[16:19], s29 offen offset:1024 lds
  v_mfma_f32_16x16x32_bf16 v[72:75], a[128:131], v[144:147], v[72:75]
  ds_read_b128 a[156:159], v215 offset:20480
  v_mfma_f32_16x16x32_bf16 v[80:83], a[128:131], v[160:163], v[200:203]
  v_exp_f32 v64, v64
  v_mfma_f32_16x16x32_bf16 v[80:83], a[132:135], v[164:167], v[80:83]
  v_mfma_f32_16x16x32_bf16 v[80:83], a[136:139], v[168:171], v[80:83]
  v_exp_f32 v65, v65
  v_mfma_f32_16x16x32_bf16 v[80:83], a[140:143], v[172:175], v[80:83]
  v_cvt_pk_bf16_f32 v64, v64, v65
  v_mfma_f32_16x16x32_bf16 v[88:91], a[140:143], v[188:191], v[204:207]
  v_exp_f32 v66, v66
  v_mfma_f32_16x16x32_bf16 v[88:91], a[136:139], v[184:187], v[88:91]
  buffer_load_dwordx4 v236, s[16:19], s29 offen offset:2048 lds
  v_mfma_f32_16x16x32_bf16 v[88:91], a[132:135], v[180:183], v[88:91]
  s_waitcnt lgkmcnt(0)
  v_exp_f32 v67, v67
  v_mfma_f32_16x16x32_bf16 v[88:91], a[128:131], v[176:179], v[88:91]
  v_cvt_pk_bf16_f32 v65, v66, v67
  v_mfma_f32_16x16x32_bf16 v[68:71], a[144:147], v[128:131], v[192:195]
  v_exp_f32 v72, v72
  v_mfma_f32_16x16x32_bf16 v[68:71], a[148:151], v[132:135], v[68:71]
  ds_read_b128 a[128:131], v212 offset:24576
  v_mfma_f32_16x16x32_bf16 v[68:71], a[152:155], v[136:139], v[68:71]
  v_exp_f32 v73, v73
  v_mfma_f32_16x16x32_bf16 v[68:71], a[156:159], v[140:143], v[68:71]
  ds_read_b128 a[132:135], v213 offset:24576
  v_cvt_pk_bf16_f32 v72, v72, v73
  v_mfma_f32_16x16x32_bf16 v[76:79], a[156:159], v[156:159], v[196:199]
  v_exp_f32 v74, v74
  v_mfma_f32_16x16x32_bf16 v[76:79], a[152:155], v[152:155], v[76:79]
  ds_read_b128 a[136:139], v214 offset:24576
  v_mfma_f32_16x16x32_bf16 v[76:79], a[148:151], v[148:151], v[76:79]
  v_exp_f32 v75, v75
  v_mfma_f32_16x16x32_bf16 v[76:79], a[144:147], v[144:147], v[76:79]
  ds_read_b128 a[140:143], v215 offset:24576
  v_cvt_pk_bf16_f32 v73, v74, v75
  v_mfma_f32_16x16x32_bf16 v[84:87], a[144:147], v[160:163], v[200:203]
  v_exp_f32 v80, v80
  v_mfma_f32_16x16x32_bf16 v[84:87], a[148:151], v[164:167], v[84:87]
  buffer_load_dwordx4 v237, s[16:19], s29 offen offset:3072 lds
  v_mfma_f32_16x16x32_bf16 v[84:87], a[152:155], v[168:171], v[84:87]
  s_add_u32 s29, s29, 16384
  v_exp_f32 v81, v81
  v_mfma_f32_16x16x32_bf16 v[84:87], a[156:159], v[172:175], v[84:87]
  v_cvt_pk_bf16_f32 v80, v80, v81
  v_mfma_f32_16x16x32_bf16 v[92:95], a[156:159], v[188:191], v[204:207]
  s_add_u32 m0, s28, 49152
  v_exp_f32 v82, v82
  v_mfma_f32_16x16x32_bf16 v[92:95], a[152:155], v[184:187], v[92:95]
  buffer_load_dwordx4 v232, s[12:15], s29 offen offset:0 lds
  v_mfma_f32_16x16x32_bf16 v[92:95], a[148:151], v[180:183], v[92:95]
  s_waitcnt lgkmcnt(0)
  v_exp_f32 v83, v83
  v_mfma_f32_16x16x32_bf16 v[92:95], a[144:147], v[176:179], v[92:95]
  v_cvt_pk_bf16_f32 v81, v82, v83
  v_mfma_f32_16x16x32_bf16 v[96:99], a[128:131], v[128:131], v[192:195]
  v_exp_f32 v88, v88
  v_mfma_f32_16x16x32_bf16 v[96:99], a[132:135], v[132:135], v[96:99]
  ds_read_b128 a[144:147], v212 offset:28672
  v_mfma_f32_16x16x32_bf16 v[96:99], a[136:139], v[136:139], v[96:99]
  v_exp_f32 v89, v89
  v_mfma_f32_16x16x32_bf16 v[96:99], a[140:143], v[140:143], v[96:99]
  ds_read_b128 a[148:151], v213 offset:28672
  v_cvt_pk_bf16_f32 v88, v88, v89
  v_mfma_f32_16x16x32_bf16 v[104:107], a[140:143], v[156:159], v[196:199]
  v_exp_f32 v90, v90
  v_mfma_f32_16x16x32_bf16 v[104:107], a[136:139], v[152:155], v[104:107]
  ds_read_b128 a[152:155], v214 offset:28672
  v_mfma_f32_16x16x32_bf16 v[104:107], a[132:135], v[148:151], v[104:107]
  v_exp_f32 v91, v91
  v_mfma_f32_16x16x32_bf16 v[104:107], a[128:131], v[144:147], v[104:107]
  ds_read_b128 a[156:159], v215 offset:28672
  v_cvt_pk_bf16_f32 v89, v90, v91
  v_mfma_f32_16x16x32_bf16 v[112:115], a[128:131], v[160:163], v[200:203]
  v_exp_f32 v68, v68
  v_mfma_f32_16x16x32_bf16 v[112:115], a[132:135], v[164:167], v[112:115]
  buffer_load_dwordx4 v233, s[12:15], s29 offen offset:1024 lds
  v_mfma_f32_16x16x32_bf16 v[112:115], a[136:139], v[168:171], v[112:115]
  v_exp_f32 v69, v69
  v_mfma_f32_16x16x32_bf16 v[112:115], a[140:143], v[172:175], v[112:115]
  v_cvt_pk_bf16_f32 v66, v68, v69
  v_mfma_f32_16x16x32_bf16 v[120:123], a[140:143], v[188:191], v[204:207]
  v_exp_f32 v70, v70
  v_mfma_f32_16x16x32_bf16 v[120:123], a[136:139], v[184:187], v[120:123]
  buffer_load_dwordx4 v234, s[12:15], s29 offen offset:2048 lds
  v_mfma_f32_16x16x32_bf16 v[120:123], a[132:135], v[180:183], v[120:123]
  s_waitcnt lgkmcnt(0)
  v_exp_f32 v71, v71
  v_mfma_f32_16x16x32_bf16 v[120:123], a[128:131], v[176:179], v[120:123]
  v_cvt_pk_bf16_f32 v67, v70, v71
  v_mfma_f32_16x16x32_bf16 v[100:103], a[144:147], v[128:131], v[192:195]
  v_exp_f32 v76, v76
  v_mfma_f32_16x16x32_bf16 v[100:103], a[148:151], v[132:135], v[100:103]
  ds_read_b64_tr_b16 a[160:161], v216 offset:0
  v_mfma_f32_16x16x32_bf16 v[100:103], a[152:155], v[136:139], v[100:103]
  v_exp_f32 v77, v77
  v_mfma_f32_16x16x32_bf16 v[100:103], a[156:159], v[140:143], v[100:103]
  ds_read_b64_tr_b16 a[162:163], v216 offset:4096
  v_cvt_pk_bf16_f32 v74, v76, v77
  v_mfma_f32_16x16x32_bf16 v[108:111], a[156:159], v[156:159], v[196:199]
  v_exp_f32 v78, v78
  v_mfma_f32_16x16x32_bf16 v[108:111], a[152:155], v[152:155], v[108:111]
  ds_read_b64_tr_b16 a[164:165], v216 offset:8192
  buffer_load_dwordx4 v235, s[12:15], s29 offen offset:3072 lds
  v_mfma_f32_16x16x32_bf16 v[108:111], a[148:151], v[148:151], v[108:111]
  v_exp_f32 v79, v79
  v_mfma_f32_16x16x32_bf16 v[108:111], a[144:147], v[144:147], v[108:111]
  ds_read_b64_tr_b16 a[166:167], v216 offset:12288
  v_cvt_pk_bf16_f32 v75, v78, v79
  v_mfma_f32_16x16x32_bf16 v[116:119], a[144:147], v[160:163], v[200:203]
  v_exp_f32 v84, v84
  v_mfma_f32_16x16x32_bf16 v[116:119], a[148:151], v[164:167], v[116:119]
  ds_read_b64_tr_b16 a[168:169], v217 offset:0
  s_add_u32 m0, s50, 5120
  v_mfma_f32_16x16x32_bf16 v[116:119], a[152:155], v[168:171], v[116:119]
  v_exp_f32 v85, v85
  v_mfma_f32_16x16x32_bf16 v[116:119], a[156:159], v[172:175], v[116:119]
  ds_read_b64_tr_b16 a[170:171], v217 offset:4096
  v_cvt_pk_bf16_f32 v82, v84, v85
  v_mfma_f32_16x16x32_bf16 v[124:127], a[156:159], v[188:191], v[204:207]
  v_exp_f32 v86, v86
  v_mfma_f32_16x16x32_bf16 v[124:127], a[152:155], v[184:187], v[124:127]
  ds_read_b64_tr_b16 a[172:173], v217 offset:8192
  buffer_load_dwordx4 v253, s[44:47], s35 offen lds
  s_add_u32 s35, s35, 221184
  v_mfma_f32_16x16x32_bf16 v[124:127], a[148:151], v[180:183], v[124:127]
  v_exp_f32 v87, v87
  v_mfma_f32_16x16x32_bf16 v[124:127], a[144:147], v[176:179], v[124:127]
  ds_read_b64_tr_b16 a[174:175], v217 offset:12288
  v_cvt_pk_bf16_f32 v83, v86, v87
  v_mfma_f32_16x16x32_bf16 a[192:195], a[208:211], v[0:3], a[192:195]
  v_exp_f32 v92, v92
  v_mfma_f32_16x16x32_bf16 a[192:195], a[208:211], v[32:35], a[192:195]
  ds_read_b64_tr_b16 a[176:177], v218 offset:0
  v_mfma_f32_16x16x32_bf16 a[196:199], a[208:211], v[8:11], a[196:199]
  v_exp_f32 v93, v93
  v_mfma_f32_16x16x32_bf16 a[196:199], a[208:211], v[40:43], a[196:199]
  ds_read_b64_tr_b16 a[178:179], v218 offset:4096
  v_cvt_pk_bf16_f32 v90, v92, v93
  v_mfma_f32_16x16x32_bf16 a[200:203], a[208:211], v[16:19], a[200:203]
  v_exp_f32 v94, v94
  v_mfma_f32_16x16x32_bf16 a[200:203], a[208:211], v[48:51], a[200:203]
  ds_read_b64_tr_b16 a[180:181], v218 offset:8192
  v_mfma_f32_16x16x32_bf16 a[204:207], a[208:211], v[24:27], a[204:207]
  s_waitcnt lgkmcnt(7)
  v_exp_f32 v95, v95
  v_mfma_f32_16x16x32_bf16 a[204:207], a[208:211], v[56:59], a[204:207]
  ds_read_b64_tr_b16 a[182:183], v218 offset:12288
  v_cvt_pk_bf16_f32 v91, v94, v95
  v_mfma_f32_16x16x32_bf16 a[0:3], a[160:163], v[0:3], a[0:3]
  v_exp_f32 v96, v96
  v_mfma_f32_16x16x32_bf16 a[0:3], a[164:167], v[32:35], a[0:3]
  ds_read_b64_tr_b16 a[184:185], v219 offset:0
  v_mfma_f32_16x16x32_bf16 a[4:7], a[164:167], v[40:43], a[4:7]
  v_exp_f32 v97, v97
  v_mfma_f32_16x16x32_bf16 a[4:7], a[160:163], v[8:11], a[4:7]
  ds_read_b64_tr_b16 a[186:187], v219 offset:4096
  v_cvt_pk_bf16_f32 v96, v96, v97
  v_mfma_f32_16x16x32_bf16 a[8:11], a[160:163], v[16:19], a[8:11]
  v_exp_f32 v98, v98
  v_mfma_f32_16x16x32_bf16 a[8:11], a[164:167], v[48:51], a[8:11]
  ds_read_b64_tr_b16 a[188:189], v219 offset:8192
  v_mfma_f32_16x16x32_bf16 a[12:15], a[164:167], v[56:59], a[12:15]
  s_waitcnt lgkmcnt(7)
  v_exp_f32 v99, v99
  v_mfma_f32_16x16x32_bf16 a[12:15], a[160:163], v[24:27], a[12:15]
  ds_read_b64_tr_b16 a[190:191], v219 offset:12288
  v_cvt_pk_bf16_f32 v97, v98, v99
  v_mfma_f32_16x16x32_bf16 a[16:19], a[168:171], v[0:3], a[16:19]
  v_exp_f32 v104, v104
  v_mfma_f32_16x16x32_bf16 a[16:19], a[172:175], v[32:35], a[16:19]
  ds_read_b64_tr_b16 a[160:161], v220 offset:0
  v_mfma_f32_16x16x32_bf16 a[20:23], a[172:175], v[40:43], a[20:23]
  v_exp_f32 v105, v105
  v_mfma_f32_16x16x32_bf16 a[20:23], a[168:171], v[8:11], a[20:23]
  ds_read_b64_tr_b16 a[162:163], v220 offset:4096
  v_cvt_pk_bf16_f32 v104, v104, v105
  v_mfma_f32_16x16x32_bf16 a[24:27], a[168:171], v[16:19], a[24:27]
  v_exp_f32 v106, v106
  v_mfma_f32_16x16x32_bf16 a[24:27], a[172:175], v[48:51], a[24:27]
  ds_read_b64_tr_b16 a[164:165], v220 offset:8192
  v_mfma_f32_16x16x32_bf16 a[28:31], a[172:175], v[56:59], a[28:31]
  s_waitcnt lgkmcnt(7)
  v_exp_f32 v107, v107
  v_mfma_f32_16x16x32_bf16 a[28:31], a[168:171], v[24:27], a[28:31]
  ds_read_b64_tr_b16 a[166:167], v220 offset:12288
  v_cvt_pk_bf16_f32 v105, v106, v107
  v_mfma_f32_16x16x32_bf16 a[32:35], a[176:179], v[0:3], a[32:35]
  v_exp_f32 v112, v112
  v_mfma_f32_16x16x32_bf16 a[32:35], a[180:183], v[32:35], a[32:35]
  ds_read_b64_tr_b16 a[168:169], v221 offset:0
  v_mfma_f32_16x16x32_bf16 a[36:39], a[180:183], v[40:43], a[36:39]
  v_exp_f32 v113, v113
  v_mfma_f32_16x16x32_bf16 a[36:39], a[176:179], v[8:11], a[36:39]
  ds_read_b64_tr_b16 a[170:171], v221 offset:4096
  v_cvt_pk_bf16_f32 v112, v112, v113
  v_mfma_f32_16x16x32_bf16 a[40:43], a[176:179], v[16:19], a[40:43]
  v_exp_f32 v114, v114
  v_mfma_f32_16x16x32_bf16 a[40:43], a[180:183], v[48:51], a[40:43]
  ds_read_b64_tr_b16 a[172:173], v221 offset:8192
  v_mfma_f32_16x16x32_bf16 a[44:47], a[180:183], v[56:59], a[44:47]
  s_waitcnt lgkmcnt(7)
  v_exp_f32 v115, v115
  v_mfma_f32_16x16x32_bf16 a[44:47], a[176:179], v[24:27], a[44:47]
  ds_read_b64_tr_b16 a[174:175], v221 offset:12288
  v_cvt_pk_bf16_f32 v113, v114, v115
  v_mfma_f32_16x16x32_bf16 a[48:51], a[184:187], v[0:3], a[48:51]
  v_exp_f32 v120, v120
  v_mfma_f32_16x16x32_bf16 a[48:51], a[188:191], v[32:35], a[48:51]
  ds_read_b64_tr_b16 a[176:177], v222 offset:0
  v_mfma_f32_16x16x32_bf16 a[52:55], a[188:191], v[40:43], a[52:55]
  v_exp_f32 v121, v121
  v_mfma_f32_16x16x32_bf16 a[52:55], a[184:187], v[8:11], a[52:55]
  ds_read_b64_tr_b16 a[178:179], v222 offset:4096
  v_cvt_pk_bf16_f32 v120, v120, v121
  v_mfma_f32_16x16x32_bf16 a[56:59], a[184:187], v[16:19], a[56:59]
  v_exp_f32 v122, v122
  v_mfma_f32_16x16x32_bf16 a[56:59], a[188:191], v[48:51], a[56:59]
  ds_read_b64_tr_b16 a[180:181], v222 offset:8192
  v_mfma_f32_16x16x32_bf16 a[60:63], a[188:191], v[56:59], a[60:63]
  s_waitcnt lgkmcnt(7)
  v_exp_f32 v123, v123
  v_mfma_f32_16x16x32_bf16 a[60:63], a[184:187], v[24:27], a[60:63]
  ds_read_b64_tr_b16 a[182:183], v222 offset:12288
  v_cvt_pk_bf16_f32 v121, v122, v123
  v_mfma_f32_16x16x32_bf16 a[64:67], a[160:163], v[0:3], a[64:67]
  v_exp_f32 v100, v100
  v_mfma_f32_16x16x32_bf16 a[64:67], a[164:167], v[32:35], a[64:67]
  ds_read_b64_tr_b16 a[184:185], v223 offset:0
  v_mfma_f32_16x16x32_bf16 a[68:71], a[164:167], v[40:43], a[68:71]
  v_exp_f32 v101, v101
  v_mfma_f32_16x16x32_bf16 a[68:71], a[160:163], v[8:11], a[68:71]
  ds_read_b64_tr_b16 a[186:187], v223 offset:4096
  v_cvt_pk_bf16_f32 v98, v100, v101
  v_mfma_f32_16x16x32_bf16 a[72:75], a[160:163], v[16:19], a[72:75]
  v_exp_f32 v102, v102
  v_mfma_f32_16x16x32_bf16 a[72:75], a[164:167], v[48:51], a[72:75]
  ds_read_b64_tr_b16 a[188:189], v223 offset:8192
  v_mfma_f32_16x16x32_bf16 a[76:79], a[164:167], v[56:59], a[76:79]
  s_waitcnt lgkmcnt(7)
  v_exp_f32 v103, v103
  v_mfma_f32_16x16x32_bf16 a[76:79], a[160:163], v[24:27], a[76:79]
  ds_read_b64_tr_b16 a[190:191], v223 offset:12288
  v_cvt_pk_bf16_f32 v99, v102, v103
  v_mfma_f32_16x16x32_bf16 a[80:83], a[168:171], v[0:3], a[80:83]
  s_waitcnt vmcnt(11)
  v_exp_f32 v108, v108
  v_mfma_f32_16x16x32_bf16 a[80:83], a[172:175], v[32:35], a[80:83]
  v_mfma_f32_16x16x32_bf16 a[84:87], a[172:175], v[40:43], a[84:87]
  s_barrier
  v_exp_f32 v109, v109
  v_mfma_f32_16x16x32_bf16 a[84:87], a[168:171], v[8:11], a[84:87]
  ds_read_b128 a[128:131], v212 offset:32768
  v_cvt_pk_bf16_f32 v106, v108, v109
  v_mfma_f32_16x16x32_bf16 a[88:91], a[168:171], v[16:19], a[88:91]
  v_exp_f32 v110, v110
  v_mfma_f32_16x16x32_bf16 a[88:91], a[172:175], v[48:51], a[88:91]
  ds_read_b128 a[132:135], v213 offset:32768
  v_mfma_f32_16x16x32_bf16 a[92:95], a[172:175], v[56:59], a[92:95]
  s_waitcnt lgkmcnt(6)
  v_exp_f32 v111, v111
  v_mfma_f32_16x16x32_bf16 a[92:95], a[168:171], v[24:27], a[92:95]
  ds_read_b128 a[136:139], v214 offset:32768
  v_cvt_pk_bf16_f32 v107, v110, v111
  v_mfma_f32_16x16x32_bf16 a[96:99], a[176:179], v[0:3], a[96:99]
  v_exp_f32 v116, v116
  v_mfma_f32_16x16x32_bf16 a[96:99], a[180:183], v[32:35], a[96:99]
  ds_read_b128 a[140:143], v215 offset:32768
  buffer_load_dwordx4 a[228:231], v243, s[24:27], s38 offen sc1
  s_add_u32 s38, s38, 4096
  v_mfma_f32_16x16x32_bf16 a[100:103], a[180:183], v[40:43], a[100:103]
  v_exp_f32 v117, v117
  v_mfma_f32_16x16x32_bf16 a[100:103], a[176:179], v[8:11], a[100:103]
  v_cvt_pk_bf16_f32 v114, v116, v117
  v_mfma_f32_16x16x32_bf16 a[104:107], a[176:179], v[16:19], a[104:107]
  v_exp_f32 v118, v118
  v_mfma_f32_16x16x32_bf16 a[104:107], a[180:183], v[48:51], a[104:107]
  v_mfma_f32_16x16x32_bf16 a[108:111], a[180:183], v[56:59], a[108:111]
  s_waitcnt lgkmcnt(4)
  v_exp_f32 v119, v119
  v_mfma_f32_16x16x32_bf16 a[108:111], a[176:179], v[24:27], a[108:111]
  v_cvt_pk_bf16_f32 v115, v118, v119
  v_mfma_f32_16x16x32_bf16 a[112:115], a[184:187], v[0:3], a[112:115]
  v_exp_f32 v124, v124
  v_mfma_f32_16x16x32_bf16 a[112:115], a[188:191], v[32:35], a[112:115]
  v_mfma_f32_16x16x32_bf16 a[116:119], a[188:191], v[40:43], a[116:119]
  v_exp_f32 v125, v125
  v_mfma_f32_16x16x32_bf16 a[116:119], a[184:187], v[8:11], a[116:119]
  v_cvt_pk_bf16_f32 v122, v124, v125
  v_mfma_f32_16x16x32_bf16 a[120:123], a[184:187], v[16:19], a[120:123]
  v_exp_f32 v126, v126
  v_mfma_f32_16x16x32_bf16 a[120:123], a[188:191], v[48:51], a[120:123]
  v_mfma_f32_16x16x32_bf16 a[124:127], a[188:191], v[56:59], a[124:127]
  s_waitcnt lgkmcnt(0)
  v_exp_f32 v127, v127
  v_mfma_f32_16x16x32_bf16 a[124:127], a[184:187], v[24:27], a[124:127]
  v_cvt_pk_bf16_f32 v123, v126, v127
  v_mfma_f32_16x16x32_bf16 v[0:3], a[128:131], v[128:131], v[192:195]
  s_add_u32 m0, s28, 114688
  s_mov_b32 s20, s88
  s_mov_b32 s21, s89
  v_mfma_f32_16x16x32_bf16 v[0:3], a[132:135], v[132:135], v[0:3]
  ds_read_b128 a[144:147], v212 offset:36864
  s_mov_b32 s22, 5242880
  s_mov_b32 s23, 0x20000
  v_lshrrev_b32 v208, 4, v242
  v_mfma_f32_16x16x32_bf16 v[0:3], a[136:139], v[136:139], v[0:3]
  buffer_load_dwordx4 v236, s[16:19], s29 offen offset:0 lds
  v_mfma_f32_16x16x32_bf16 v[0:3], a[140:143], v[140:143], v[0:3]
  ds_read_b128 a[148:151], v213 offset:36864
  v_and_b32 v209, 1, v208
  v_mfma_f32_16x16x32_bf16 v[8:11], a[140:143], v[156:159], v[196:199]
  v_lshrrev_b32 v208, 1, v208
  v_mul_u32_u24 v208, 0x500, v208
  v_mfma_f32_16x16x32_bf16 v[8:11], a[136:139], v[152:155], v[8:11]
  ds_read_b128 a[152:155], v214 offset:36864
  v_lshl_add_u32 v208, v209, 4, v208
  v_mfma_f32_16x16x32_bf16 v[8:11], a[132:135], v[148:151], v[8:11]
  buffer_load_dwordx4 v237, s[16:19], s29 offen offset:1024 lds
  v_mfma_f32_16x16x32_bf16 v[8:11], a[128:131], v[144:147], v[8:11]
  ds_read_b128 a[156:159], v215 offset:36864
  v_lshrrev_b32 v209, 4, v242
  v_mfma_f32_16x16x32_bf16 v[16:19], a[128:131], v[160:163], v[200:203]
  v_exp_f32 v0, v0
  v_mfma_f32_16x16x32_bf16 v[16:19], a[132:135], v[164:167], v[16:19]
  v_lshrrev_b32 v210, 5, v209
  v_lshlrev_b32 v210, 30, v210
  v_mfma_f32_16x16x32_bf16 v[16:19], a[136:139], v[168:171], v[16:19]
  v_exp_f32 v1, v1
  v_mfma_f32_16x16x32_bf16 v[16:19], a[140:143], v[172:175], v[16:19]
  v_cvt_pk_bf16_f32 v0, v0, v1
  v_or_b32 v210, v210, v208
  v_mfma_f32_16x16x32_bf16 v[24:27], a[140:143], v[188:191], v[204:207]
  v_exp_f32 v2, v2
  v_mfma_f32_16x16x32_bf16 v[24:27], a[136:139], v[184:187], v[24:27]
  buffer_load_dwordx4 v236, s[16:19], s29 offen offset:2048 lds
  v_mfma_f32_16x16x32_bf16 v[24:27], a[132:135], v[180:183], v[24:27]
  s_waitcnt lgkmcnt(0)
  v_exp_f32 v3, v3
  v_mfma_f32_16x16x32_bf16 v[24:27], a[128:131], v[176:179], v[24:27]
  v_cvt_pk_bf16_f32 v1, v2, v3
  v_bfe_u32 v211, v209, 2, 4
  v_mfma_f32_16x16x32_bf16 v[4:7], a[144:147], v[128:131], v[192:195]
  v_exp_f32 v8, v8
  v_mfma_f32_16x16x32_bf16 v[4:7], a[148:151], v[132:135], v[4:7]
  ds_read_b128 a[128:131], v212 offset:40960
  v_and_b32 v209, 3, v209
  v_mfma_f32_16x16x32_bf16 v[4:7], a[152:155], v[136:139], v[4:7]
  v_exp_f32 v9, v9
  v_mfma_f32_16x16x32_bf16 v[4:7], a[156:159], v[140:143], v[4:7]
  ds_read_b128 a[132:135], v213 offset:40960
  v_cvt_pk_bf16_f32 v8, v8, v9
  v_mfma_f32_16x16x32_bf16 v[12:15], a[156:159], v[156:159], v[196:199]
  v_exp_f32 v10, v10
  v_mfma_f32_16x16x32_bf16 v[12:15], a[152:155], v[152:155], v[12:15]
  ds_read_b128 a[136:139], v214 offset:40960
  v_lshlrev_b32 v209, 3, v209
  v_mfma_f32_16x16x32_bf16 v[12:15], a[148:151], v[148:151], v[12:15]
  v_exp_f32 v11, v11
  v_mfma_f32_16x16x32_bf16 v[12:15], a[144:147], v[144:147], v[12:15]
  ds_read_b128 a[140:143], v215 offset:40960
  v_cvt_pk_bf16_f32 v9, v10, v11
  v_mfma_f32_16x16x32_bf16 v[20:23], a[144:147], v[160:163], v[200:203]
  v_exp_f32 v16, v16
  v_mfma_f32_16x16x32_bf16 v[20:23], a[148:151], v[164:167], v[20:23]
  buffer_load_dwordx4 v237, s[16:19], s29 offen offset:3072 lds
  v_mfma_f32_16x16x32_bf16 v[20:23], a[152:155], v[168:171], v[20:23]
  s_add_u32 s29, s29, 16384
  v_exp_f32 v17, v17
  v_mfma_f32_16x16x32_bf16 v[20:23], a[156:159], v[172:175], v[20:23]
  v_cvt_pk_bf16_f32 v16, v16, v17
  v_lshl_add_u32 v209, v211, 5, v209
  v_mfma_f32_16x16x32_bf16 v[28:31], a[156:159], v[188:191], v[204:207]
  s_add_u32 m0, s28, 0
  v_exp_f32 v18, v18
  v_mfma_f32_16x16x32_bf16 v[28:31], a[152:155], v[184:187], v[28:31]
  buffer_load_dwordx4 v232, s[12:15], s29 offen offset:0 lds
  v_mfma_f32_16x16x32_bf16 v[28:31], a[148:151], v[180:183], v[28:31]
  s_waitcnt lgkmcnt(0)
  v_exp_f32 v19, v19
  v_mfma_f32_16x16x32_bf16 v[28:31], a[144:147], v[176:179], v[28:31]
  v_cvt_pk_bf16_f32 v17, v18, v19
  v_add_u32 v209, s50, v209
  v_mfma_f32_16x16x32_bf16 v[32:35], a[128:131], v[128:131], v[192:195]
  s_and_b32 s39, s2, 1
  s_lshl_b32 s39, s39, 2
  s_add_u32 s39, s39, s3
  v_exp_f32 v24, v24
  v_mfma_f32_16x16x32_bf16 v[32:35], a[132:135], v[132:135], v[32:35]
  ds_read_b128 a[144:147], v212 offset:45056
  s_lshr_b32 s31, s2, 1
  s_mul_i32 s30, s31, 40960
  s_mul_i32 s48, s39, 160
  v_mfma_f32_16x16x32_bf16 v[32:35], a[136:139], v[136:139], v[32:35]
  s_add_u32 s30, s30, s48
  s_mul_i32 s31, s31, 5120
  s_mul_i32 s39, s39, 655360
  v_exp_f32 v25, v25
  v_mfma_f32_16x16x32_bf16 v[32:35], a[140:143], v[140:143], v[32:35]
  ds_read_b128 a[148:151], v213 offset:45056
  s_add_u32 s31, s31, s39
  s_add_u32 s31, s31, 3145728
  s_lshr_b32 s39, s2, 3
  v_cvt_pk_bf16_f32 v24, v24, v25
  v_mfma_f32_16x16x32_bf16 v[40:43], a[140:143], v[156:159], v[196:199]
  s_min_u32 s39, s39, 29
  s_and_b32 s48, s2, 7
  s_mul_i32 s48, s48, 30
  v_exp_f32 v26, v26
  v_mfma_f32_16x16x32_bf16 v[40:43], a[136:139], v[152:155], v[40:43]
  ds_read_b128 a[152:155], v214 offset:45056
  s_add_u32 s39, s39, s48
  s_mul_i32 s98, s39, 1639
  s_lshr_b32 s98, s98, 16
  v_mfma_f32_16x16x32_bf16 v[40:43], a[132:135], v[148:151], v[40:43]
  s_mul_i32 s99, s98, 40
  s_sub_u32 s99, s39, s99
  s_min_u32 s39, s3, 2
  v_exp_f32 v27, v27
  v_mfma_f32_16x16x32_bf16 v[40:43], a[128:131], v[144:147], v[40:43]
  ds_read_b128 a[156:159], v215 offset:45056
  s_mul_i32 s48, s98, 3
  s_add_u32 s48, s48, s39
  s_mul_i32 s100, s48, 122880
  v_cvt_pk_bf16_f32 v25, v26, v27
  v_mfma_f32_16x16x32_bf16 v[48:51], a[128:131], v[160:163], v[200:203]
  s_lshl_b32 s39, s99, 5
  s_add_u32 s100, s100, s39
  s_mul_i32 s101, s48, 192
  v_exp_f32 v4, v4
  v_mfma_f32_16x16x32_bf16 v[48:51], a[132:135], v[164:167], v[48:51]
  buffer_load_dwordx4 v233, s[12:15], s29 offen offset:1024 lds
  s_add_u32 s101, s101, 2633728
  s_mov_b32 s51, s50
  v_mfma_f32_16x16x32_bf16 v[48:51], a[136:139], v[168:171], v[48:51]
  v_exp_f32 v5, v5
  v_mfma_f32_16x16x32_bf16 v[48:51], a[140:143], v[172:175], v[48:51]
  v_cvt_pk_bf16_f32 v2, v4, v5
  v_mov_b32 v211, v242
  v_mfma_f32_16x16x32_bf16 v[56:59], a[140:143], v[188:191], v[204:207]
  s_mov_b32 s4, s94
  s_mov_b32 s5, s95
  s_mov_b32 s6, 2211840
  v_exp_f32 v6, v6
  v_mfma_f32_16x16x32_bf16 v[56:59], a[136:139], v[184:187], v[56:59]
  buffer_load_dwordx4 v234, s[12:15], s29 offen offset:2048 lds
  s_mov_b32 s7, 0x20000
  s_getpc_b64 s[8:9]
attn_late_pc:
  s_add_u32 s8, s8, attn_h_ready-attn_late_pc
  s_addc_u32 s9, s9, 0
  v_mfma_f32_16x16x32_bf16 v[56:59], a[132:135], v[180:183], v[56:59]
  s_waitcnt lgkmcnt(0)
  s_lshr_b32 s39, s2, 3
  v_exp_f32 v7, v7
  v_mfma_f32_16x16x32_bf16 v[56:59], a[128:131], v[176:179], v[56:59]
  v_cvt_pk_bf16_f32 v3, v6, v7
  v_lshrrev_b32 v252, 4, v242
  v_mfma_f32_16x16x32_bf16 v[36:39], a[144:147], v[128:131], v[192:195]
  v_exp_f32 v12, v12
  v_mfma_f32_16x16x32_bf16 v[36:39], a[148:151], v[132:135], v[36:39]
  ds_read_b64_tr_b16 a[160:161], v216 offset:16384
  v_min_u32 v252, 11, v252
  v_mfma_f32_16x16x32_bf16 v[36:39], a[152:155], v[136:139], v[36:39]
  v_exp_f32 v13, v13
  v_mfma_f32_16x16x32_bf16 v[36:39], a[156:159], v[140:143], v[36:39]
  ds_read_b64_tr_b16 a[162:163], v216 offset:20480
  v_cvt_pk_bf16_f32 v10, v12, v13
  v_mfma_f32_16x16x32_bf16 v[44:47], a[156:159], v[156:159], v[196:199]
  v_exp_f32 v14, v14
  v_mfma_f32_16x16x32_bf16 v[44:47], a[152:155], v[152:155], v[44:47]
  ds_read_b64_tr_b16 a[164:165], v216 offset:24576
  buffer_load_dwordx4 v235, s[12:15], s29 offen offset:3072 lds
  v_mfma_f32_16x16x32_bf16 v[44:47], a[148:151], v[148:151], v[44:47]
  v_exp_f32 v15, v15
  v_mfma_f32_16x16x32_bf16 v[44:47], a[144:147], v[144:147], v[44:47]
  ds_read_b64_tr_b16 a[166:167], v216 offset:28672
  v_cvt_pk_bf16_f32 v11, v14, v15
  v_mfma_f32_16x16x32_bf16 v[52:55], a[144:147], v[160:163], v[200:203]
  v_exp_f32 v20, v20
  v_mfma_f32_16x16x32_bf16 v[52:55], a[148:151], v[164:167], v[52:55]
  ds_read_b64_tr_b16 a[168:169], v217 offset:16384
  v_lshlrev_b32 v252, 5, v252
  v_mfma_f32_16x16x32_bf16 v[52:55], a[152:155], v[168:171], v[52:55]
  v_exp_f32 v21, v21
  v_mfma_f32_16x16x32_bf16 v[52:55], a[156:159], v[172:175], v[52:55]
  ds_read_b64_tr_b16 a[170:171], v217 offset:20480
  v_cvt_pk_bf16_f32 v18, v20, v21
  v_mfma_f32_16x16x32_bf16 v[60:63], a[156:159], v[188:191], v[204:207]
  v_exp_f32 v22, v22
  v_mfma_f32_16x16x32_bf16 v[60:63], a[152:155], v[184:187], v[60:63]
  ds_read_b64_tr_b16 a[172:173], v217 offset:24576
  v_add_u32 v252, s39, v252
  v_mfma_f32_16x16x32_bf16 v[60:63], a[148:151], v[180:183], v[60:63]
  v_exp_f32 v23, v23
  v_mfma_f32_16x16x32_bf16 v[60:63], a[144:147], v[176:179], v[60:63]
  ds_read_b64_tr_b16 a[174:175], v217 offset:28672
  v_cvt_pk_bf16_f32 v19, v22, v23
  v_mfma_f32_16x16x32_bf16 a[192:195], a[208:211], v[64:67], a[192:195]
  v_exp_f32 v28, v28
  v_mfma_f32_16x16x32_bf16 a[192:195], a[208:211], v[96:99], a[192:195]
  ds_read_b64_tr_b16 a[176:177], v218 offset:16384
  v_lshlrev_b32 v252, 7, v252
  v_mfma_f32_16x16x32_bf16 a[196:199], a[208:211], v[72:75], a[196:199]
  v_exp_f32 v29, v29
  v_mfma_f32_16x16x32_bf16 a[196:199], a[208:211], v[104:107], a[196:199]
  ds_read_b64_tr_b16 a[178:179], v218 offset:20480
  v_cvt_pk_bf16_f32 v26, v28, v29
  v_mfma_f32_16x16x32_bf16 a[200:203], a[208:211], v[80:83], a[200:203]
  v_exp_f32 v30, v30
  v_mfma_f32_16x16x32_bf16 a[200:203], a[208:211], v[112:115], a[200:203]
  ds_read_b64_tr_b16 a[180:181], v218 offset:24576
  v_min_u32 v252, attn_end-attn_h_ready-4, v252
  v_mfma_f32_16x16x32_bf16 a[204:207], a[208:211], v[88:91], a[204:207]
  s_waitcnt lgkmcnt(7)
  v_exp_f32 v31, v31
  v_mfma_f32_16x16x32_bf16 a[204:207], a[208:211], v[120:123], a[204:207]
  ds_read_b64_tr_b16 a[182:183], v218 offset:28672
  v_cvt_pk_bf16_f32 v27, v30, v31
  v_mfma_f32_16x16x32_bf16 a[0:3], a[160:163], v[64:67], a[0:3]
  v_exp_f32 v32, v32
  v_mfma_f32_16x16x32_bf16 a[0:3], a[164:167], v[96:99], a[0:3]
  ds_read_b64_tr_b16 a[184:185], v219 offset:16384
  v_mfma_f32_16x16x32_bf16 a[4:7], a[164:167], v[104:107], a[4:7]
  v_exp_f32 v33, v33
  v_mfma_f32_16x16x32_bf16 a[4:7], a[160:163], v[72:75], a[4:7]
  ds_read_b64_tr_b16 a[186:187], v219 offset:20480
  v_cvt_pk_bf16_f32 v32, v32, v33
  v_mfma_f32_16x16x32_bf16 a[8:11], a[160:163], v[80:83], a[8:11]
  v_exp_f32 v34, v34
  v_mfma_f32_16x16x32_bf16 a[8:11], a[164:167], v[112:115], a[8:11]
  ds_read_b64_tr_b16 a[188:189], v219 offset:24576
  v_mfma_f32_16x16x32_bf16 a[12:15], a[164:167], v[120:123], a[12:15]
  s_waitcnt lgkmcnt(7)
  v_exp_f32 v35, v35
  v_mfma_f32_16x16x32_bf16 a[12:15], a[160:163], v[88:91], a[12:15]
  ds_read_b64_tr_b16 a[190:191], v219 offset:28672
  v_cvt_pk_bf16_f32 v33, v34, v35
  v_mfma_f32_16x16x32_bf16 a[16:19], a[168:171], v[64:67], a[16:19]
  v_exp_f32 v40, v40
  v_mfma_f32_16x16x32_bf16 a[16:19], a[172:175], v[96:99], a[16:19]
  ds_read_b64_tr_b16 a[160:161], v220 offset:16384
  v_mfma_f32_16x16x32_bf16 a[20:23], a[172:175], v[104:107], a[20:23]
  v_exp_f32 v41, v41
  v_mfma_f32_16x16x32_bf16 a[20:23], a[168:171], v[72:75], a[20:23]
  ds_read_b64_tr_b16 a[162:163], v220 offset:20480
  v_cvt_pk_bf16_f32 v40, v40, v41
  v_mfma_f32_16x16x32_bf16 a[24:27], a[168:171], v[80:83], a[24:27]
  v_exp_f32 v42, v42
  v_mfma_f32_16x16x32_bf16 a[24:27], a[172:175], v[112:115], a[24:27]
  ds_read_b64_tr_b16 a[164:165], v220 offset:24576
  v_mfma_f32_16x16x32_bf16 a[28:31], a[172:175], v[120:123], a[28:31]
  s_waitcnt lgkmcnt(7)
  v_exp_f32 v43, v43
  v_mfma_f32_16x16x32_bf16 a[28:31], a[168:171], v[88:91], a[28:31]
  ds_read_b64_tr_b16 a[166:167], v220 offset:28672
  v_cvt_pk_bf16_f32 v41, v42, v43
  v_mfma_f32_16x16x32_bf16 a[32:35], a[176:179], v[64:67], a[32:35]
  v_exp_f32 v48, v48
  v_mfma_f32_16x16x32_bf16 a[32:35], a[180:183], v[96:99], a[32:35]
  ds_read_b64_tr_b16 a[168:169], v221 offset:16384
  v_mfma_f32_16x16x32_bf16 a[36:39], a[180:183], v[104:107], a[36:39]
  v_exp_f32 v49, v49
  v_mfma_f32_16x16x32_bf16 a[36:39], a[176:179], v[72:75], a[36:39]
  ds_read_b64_tr_b16 a[170:171], v221 offset:20480
  v_cvt_pk_bf16_f32 v48, v48, v49
  v_mfma_f32_16x16x32_bf16 a[40:43], a[176:179], v[80:83], a[40:43]
  v_exp_f32 v50, v50
  v_mfma_f32_16x16x32_bf16 a[40:43], a[180:183], v[112:115], a[40:43]
  ds_read_b64_tr_b16 a[172:173], v221 offset:24576
  v_mfma_f32_16x16x32_bf16 a[44:47], a[180:183], v[120:123], a[44:47]
  s_waitcnt lgkmcnt(7)
  v_exp_f32 v51, v51
  v_mfma_f32_16x16x32_bf16 a[44:47], a[176:179], v[88:91], a[44:47]
  ds_read_b64_tr_b16 a[174:175], v221 offset:28672
  v_cvt_pk_bf16_f32 v49, v50, v51
  v_mfma_f32_16x16x32_bf16 a[48:51], a[184:187], v[64:67], a[48:51]
  v_exp_f32 v56, v56
  v_mfma_f32_16x16x32_bf16 a[48:51], a[188:191], v[96:99], a[48:51]
  ds_read_b64_tr_b16 a[176:177], v222 offset:16384
  v_mfma_f32_16x16x32_bf16 a[52:55], a[188:191], v[104:107], a[52:55]
  v_exp_f32 v57, v57
  v_mfma_f32_16x16x32_bf16 a[52:55], a[184:187], v[72:75], a[52:55]
  ds_read_b64_tr_b16 a[178:179], v222 offset:20480
  v_cvt_pk_bf16_f32 v56, v56, v57
  v_mfma_f32_16x16x32_bf16 a[56:59], a[184:187], v[80:83], a[56:59]
  v_exp_f32 v58, v58
  v_mfma_f32_16x16x32_bf16 a[56:59], a[188:191], v[112:115], a[56:59]
  ds_read_b64_tr_b16 a[180:181], v222 offset:24576
  v_mfma_f32_16x16x32_bf16 a[60:63], a[188:191], v[120:123], a[60:63]
  s_waitcnt lgkmcnt(7)
  v_exp_f32 v59, v59
  v_mfma_f32_16x16x32_bf16 a[60:63], a[184:187], v[88:91], a[60:63]
  ds_read_b64_tr_b16 a[182:183], v222 offset:28672
  v_cvt_pk_bf16_f32 v57, v58, v59
  v_mfma_f32_16x16x32_bf16 a[64:67], a[160:163], v[64:67], a[64:67]
  v_exp_f32 v36, v36
  v_mfma_f32_16x16x32_bf16 a[64:67], a[164:167], v[96:99], a[64:67]
  ds_read_b64_tr_b16 a[184:185], v223 offset:16384
  v_mfma_f32_16x16x32_bf16 a[68:71], a[164:167], v[104:107], a[68:71]
  v_exp_f32 v37, v37
  v_mfma_f32_16x16x32_bf16 a[68:71], a[160:163], v[72:75], a[68:71]
  ds_read_b64_tr_b16 a[186:187], v223 offset:20480
  v_cvt_pk_bf16_f32 v34, v36, v37
  v_mfma_f32_16x16x32_bf16 a[72:75], a[160:163], v[80:83], a[72:75]
  v_exp_f32 v38, v38
  v_mfma_f32_16x16x32_bf16 a[72:75], a[164:167], v[112:115], a[72:75]
  ds_read_b64_tr_b16 a[188:189], v223 offset:24576
  v_mfma_f32_16x16x32_bf16 a[76:79], a[164:167], v[120:123], a[76:79]
  s_waitcnt lgkmcnt(7)
  v_exp_f32 v39, v39
  v_mfma_f32_16x16x32_bf16 a[76:79], a[160:163], v[88:91], a[76:79]
  ds_read_b64_tr_b16 a[190:191], v223 offset:28672
  v_cvt_pk_bf16_f32 v35, v38, v39
  v_mfma_f32_16x16x32_bf16 a[80:83], a[168:171], v[64:67], a[80:83]
  s_waitcnt vmcnt(10)
  v_exp_f32 v44, v44
  v_mfma_f32_16x16x32_bf16 a[80:83], a[172:175], v[96:99], a[80:83]
  v_mfma_f32_16x16x32_bf16 a[84:87], a[172:175], v[104:107], a[84:87]
  s_barrier
  v_exp_f32 v45, v45
  v_mfma_f32_16x16x32_bf16 a[84:87], a[168:171], v[72:75], a[84:87]
  ds_read_b128 a[128:131], v212 offset:49152
  v_cvt_pk_bf16_f32 v42, v44, v45
  v_mfma_f32_16x16x32_bf16 a[88:91], a[168:171], v[80:83], a[88:91]
  v_exp_f32 v46, v46
  v_mfma_f32_16x16x32_bf16 a[88:91], a[172:175], v[112:115], a[88:91]
  ds_read_b128 a[132:135], v213 offset:49152
  v_mfma_f32_16x16x32_bf16 a[92:95], a[172:175], v[120:123], a[92:95]
  s_waitcnt lgkmcnt(6)
  v_exp_f32 v47, v47
  v_mfma_f32_16x16x32_bf16 a[92:95], a[168:171], v[88:91], a[92:95]
  ds_read_b128 a[136:139], v214 offset:49152
  v_cvt_pk_bf16_f32 v43, v46, v47
  v_mfma_f32_16x16x32_bf16 a[96:99], a[176:179], v[64:67], a[96:99]
  v_exp_f32 v52, v52
  v_mfma_f32_16x16x32_bf16 a[96:99], a[180:183], v[96:99], a[96:99]
  ds_read_b128 a[140:143], v215 offset:49152
  v_mfma_f32_16x16x32_bf16 a[100:103], a[180:183], v[104:107], a[100:103]
  v_exp_f32 v53, v53
  v_mfma_f32_16x16x32_bf16 a[100:103], a[176:179], v[72:75], a[100:103]
  v_cvt_pk_bf16_f32 v50, v52, v53
  v_mfma_f32_16x16x32_bf16 a[104:107], a[176:179], v[80:83], a[104:107]
  v_exp_f32 v54, v54
  v_mfma_f32_16x16x32_bf16 a[104:107], a[180:183], v[112:115], a[104:107]
  v_mfma_f32_16x16x32_bf16 a[108:111], a[180:183], v[120:123], a[108:111]
  s_waitcnt lgkmcnt(4)
  v_exp_f32 v55, v55
  v_mfma_f32_16x16x32_bf16 a[108:111], a[176:179], v[88:91], a[108:111]
  v_cvt_pk_bf16_f32 v51, v54, v55
  v_mfma_f32_16x16x32_bf16 a[112:115], a[184:187], v[64:67], a[112:115]
  v_exp_f32 v60, v60
  v_mfma_f32_16x16x32_bf16 a[112:115], a[188:191], v[96:99], a[112:115]
  v_mfma_f32_16x16x32_bf16 a[116:119], a[188:191], v[104:107], a[116:119]
  v_exp_f32 v61, v61
  v_mfma_f32_16x16x32_bf16 a[116:119], a[184:187], v[72:75], a[116:119]
  v_cvt_pk_bf16_f32 v58, v60, v61
  v_mfma_f32_16x16x32_bf16 a[120:123], a[184:187], v[80:83], a[120:123]
  v_exp_f32 v62, v62
  v_mfma_f32_16x16x32_bf16 a[120:123], a[188:191], v[112:115], a[120:123]
  v_mfma_f32_16x16x32_bf16 a[124:127], a[188:191], v[120:123], a[124:127]
  s_waitcnt lgkmcnt(0)
  v_exp_f32 v63, v63
  v_mfma_f32_16x16x32_bf16 a[124:127], a[184:187], v[88:91], a[124:127]
  v_cvt_pk_bf16_f32 v59, v62, v63
  v_mfma_f32_16x16x32_bf16 v[64:67], a[128:131], v[128:131], v[192:195]
  s_add_u32 m0, s28, 65536
  v_lshrrev_b32 v224, 4, v242
  v_lshrrev_b32 v225, 4, v224
  v_mfma_f32_16x16x32_bf16 v[64:67], a[132:135], v[132:135], v[64:67]
  ds_read_b128 a[144:147], v212 offset:53248
  v_bfe_u32 v226, v224, 2, 2
  v_mfma_f32_16x16x32_bf16 v[64:67], a[136:139], v[136:139], v[64:67]
  buffer_load_dwordx4 v236, s[16:19], s29 offen offset:0 lds
  v_mfma_f32_16x16x32_bf16 v[64:67], a[140:143], v[140:143], v[64:67]
  ds_read_b128 a[148:151], v213 offset:53248
  v_lshl_add_u32 v225, v225, 3, v226
  v_mfma_f32_16x16x32_bf16 v[72:75], a[140:143], v[156:159], v[196:199]
  v_lshlrev_b32 v225, 4, v225
  v_bfe_u32 v226, v224, 1, 1
  v_mfma_f32_16x16x32_bf16 v[72:75], a[136:139], v[152:155], v[72:75]
  ds_read_b128 a[152:155], v214 offset:53248
  v_mul_u32_u24 v226, 0xc00, v226
  v_mfma_f32_16x16x32_bf16 v[72:75], a[132:135], v[148:151], v[72:75]
  buffer_load_dwordx4 v237, s[16:19], s29 offen offset:1024 lds
  v_mfma_f32_16x16x32_bf16 v[72:75], a[128:131], v[144:147], v[72:75]
  ds_read_b128 a[156:159], v215 offset:53248
  v_add3_u32 v225, v225, v226, s50
  v_mfma_f32_16x16x32_bf16 v[80:83], a[128:131], v[160:163], v[200:203]
  v_exp_f32 v64, v64
  v_mfma_f32_16x16x32_bf16 v[80:83], a[132:135], v[164:167], v[80:83]
  v_and_b32 v226, 1, v224
  v_lshl_add_u32 v225, v226, 3, v225
  v_mfma_f32_16x16x32_bf16 v[80:83], a[136:139], v[168:171], v[80:83]
  s_waitcnt vmcnt(10)
  v_exp_f32 v65, v65
  v_mfma_f32_16x16x32_bf16 v[80:83], a[140:143], v[172:175], v[80:83]
  ds_read_b64_tr_b16 a[232:233], v225 offset:0
  v_cvt_pk_bf16_f32 v64, v64, v65
  v_mfma_f32_16x16x32_bf16 v[88:91], a[140:143], v[188:191], v[204:207]
  v_exp_f32 v66, v66
  v_mfma_f32_16x16x32_bf16 v[88:91], a[136:139], v[184:187], v[88:91]
  buffer_load_dwordx4 v236, s[16:19], s29 offen offset:2048 lds
  v_mfma_f32_16x16x32_bf16 v[88:91], a[132:135], v[180:183], v[88:91]
  s_waitcnt lgkmcnt(1)
  v_exp_f32 v67, v67
  v_mfma_f32_16x16x32_bf16 v[88:91], a[128:131], v[176:179], v[88:91]
  ds_read_b64_tr_b16 a[234:235], v225 offset:64
  v_cvt_pk_bf16_f32 v65, v66, v67
  v_mfma_f32_16x16x32_bf16 v[68:71], a[144:147], v[128:131], v[192:195]
  v_exp_f32 v72, v72
  v_mfma_f32_16x16x32_bf16 v[68:71], a[148:151], v[132:135], v[68:71]
  ds_read_b128 a[128:131], v212 offset:57344
  ds_read_b64_tr_b16 a[236:237], v225 offset:512
  v_mfma_f32_16x16x32_bf16 v[68:71], a[152:155], v[136:139], v[68:71]
  v_exp_f32 v73, v73
  v_mfma_f32_16x16x32_bf16 v[68:71], a[156:159], v[140:143], v[68:71]
  ds_read_b128 a[132:135], v213 offset:57344
  v_cvt_pk_bf16_f32 v72, v72, v73
  v_mfma_f32_16x16x32_bf16 v[76:79], a[156:159], v[156:159], v[196:199]
  v_exp_f32 v74, v74
  v_mfma_f32_16x16x32_bf16 v[76:79], a[152:155], v[152:155], v[76:79]
  ds_read_b128 a[136:139], v214 offset:57344
  ds_read_b64_tr_b16 a[238:239], v225 offset:576
  v_mfma_f32_16x16x32_bf16 v[76:79], a[148:151], v[148:151], v[76:79]
  v_exp_f32 v75, v75
  v_mfma_f32_16x16x32_bf16 v[76:79], a[144:147], v[144:147], v[76:79]
  ds_read_b128 a[140:143], v215 offset:57344
  v_cvt_pk_bf16_f32 v73, v74, v75
  v_mfma_f32_16x16x32_bf16 v[84:87], a[144:147], v[160:163], v[200:203]
  v_exp_f32 v80, v80
  v_mfma_f32_16x16x32_bf16 v[84:87], a[148:151], v[164:167], v[84:87]
  buffer_load_dwordx4 v237, s[16:19], s29 offen offset:3072 lds
  v_mfma_f32_16x16x32_bf16 v[84:87], a[152:155], v[168:171], v[84:87]
  s_add_u32 s29, s29, 16384
  v_exp_f32 v81, v81
  v_mfma_f32_16x16x32_bf16 v[84:87], a[156:159], v[172:175], v[84:87]
  ds_read_b64_tr_b16 a[240:241], v225 offset:1024
  v_cvt_pk_bf16_f32 v80, v80, v81
  v_mfma_f32_16x16x32_bf16 v[92:95], a[156:159], v[188:191], v[204:207]
  s_add_u32 m0, s28, 16384
  v_exp_f32 v82, v82
  v_mfma_f32_16x16x32_bf16 v[92:95], a[152:155], v[184:187], v[92:95]
  buffer_load_dwordx4 v232, s[12:15], s29 offen offset:0 lds
  v_mfma_f32_16x16x32_bf16 v[92:95], a[148:151], v[180:183], v[92:95]
  s_waitcnt lgkmcnt(1)
  v_exp_f32 v83, v83
  v_mfma_f32_16x16x32_bf16 v[92:95], a[144:147], v[176:179], v[92:95]
  ds_read_b64_tr_b16 a[242:243], v225 offset:1088
  v_cvt_pk_bf16_f32 v81, v82, v83
  v_mfma_f32_16x16x32_bf16 v[96:99], a[128:131], v[128:131], v[192:195]
  v_exp_f32 v88, v88
  v_mfma_f32_16x16x32_bf16 v[96:99], a[132:135], v[132:135], v[96:99]
  ds_read_b128 a[144:147], v212 offset:61440
  ds_read_b64_tr_b16 a[244:245], v225 offset:1536
  v_mfma_f32_16x16x32_bf16 v[96:99], a[136:139], v[136:139], v[96:99]
  v_exp_f32 v89, v89
  v_mfma_f32_16x16x32_bf16 v[96:99], a[140:143], v[140:143], v[96:99]
  ds_read_b128 a[148:151], v213 offset:61440
  v_cvt_pk_bf16_f32 v88, v88, v89
  v_mfma_f32_16x16x32_bf16 v[104:107], a[140:143], v[156:159], v[196:199]
  v_exp_f32 v90, v90
  v_mfma_f32_16x16x32_bf16 v[104:107], a[136:139], v[152:155], v[104:107]
  ds_read_b128 a[152:155], v214 offset:61440
  ds_read_b64_tr_b16 a[246:247], v225 offset:1600
  v_mfma_f32_16x16x32_bf16 v[104:107], a[132:135], v[148:151], v[104:107]
  v_exp_f32 v91, v91
  v_mfma_f32_16x16x32_bf16 v[104:107], a[128:131], v[144:147], v[104:107]
  ds_read_b128 a[156:159], v215 offset:61440
  v_cvt_pk_bf16_f32 v89, v90, v91
  v_mfma_f32_16x16x32_bf16 v[112:115], a[128:131], v[160:163], v[200:203]
  v_exp_f32 v68, v68
  v_mfma_f32_16x16x32_bf16 v[112:115], a[132:135], v[164:167], v[112:115]
  buffer_load_dwordx4 v233, s[12:15], s29 offen offset:1024 lds
  v_mfma_f32_16x16x32_bf16 v[112:115], a[136:139], v[168:171], v[112:115]
  v_exp_f32 v69, v69
  v_mfma_f32_16x16x32_bf16 v[112:115], a[140:143], v[172:175], v[112:115]
  ds_read_b64_tr_b16 a[248:249], v225 offset:2048
  v_cvt_pk_bf16_f32 v66, v68, v69
  v_mfma_f32_16x16x32_bf16 v[120:123], a[140:143], v[188:191], v[204:207]
  v_exp_f32 v70, v70
  v_mfma_f32_16x16x32_bf16 v[120:123], a[136:139], v[184:187], v[120:123]
  buffer_load_dwordx4 v234, s[12:15], s29 offen offset:2048 lds
  v_mfma_f32_16x16x32_bf16 v[120:123], a[132:135], v[180:183], v[120:123]
  s_waitcnt lgkmcnt(1)
  v_exp_f32 v71, v71
  v_mfma_f32_16x16x32_bf16 v[120:123], a[128:131], v[176:179], v[120:123]
  ds_read_b64_tr_b16 a[250:251], v225 offset:2112
  v_cvt_pk_bf16_f32 v67, v70, v71
  v_mfma_f32_16x16x32_bf16 v[100:103], a[144:147], v[128:131], v[192:195]
  v_exp_f32 v76, v76
  v_mfma_f32_16x16x32_bf16 v[100:103], a[148:151], v[132:135], v[100:103]
  ds_read_b64_tr_b16 a[160:161], v216 offset:32768
  v_mfma_f32_16x16x32_bf16 v[100:103], a[152:155], v[136:139], v[100:103]
  v_exp_f32 v77, v77
  v_mfma_f32_16x16x32_bf16 v[100:103], a[156:159], v[140:143], v[100:103]
  ds_read_b64_tr_b16 a[162:163], v216 offset:36864
  v_cvt_pk_bf16_f32 v74, v76, v77
  v_mfma_f32_16x16x32_bf16 v[108:111], a[156:159], v[156:159], v[196:199]
  v_exp_f32 v78, v78
  v_mfma_f32_16x16x32_bf16 v[108:111], a[152:155], v[152:155], v[108:111]
  ds_read_b64_tr_b16 a[164:165], v216 offset:40960
  buffer_load_dwordx4 v235, s[12:15], s29 offen offset:3072 lds
  v_mfma_f32_16x16x32_bf16 v[108:111], a[148:151], v[148:151], v[108:111]
  v_exp_f32 v79, v79
  v_mfma_f32_16x16x32_bf16 v[108:111], a[144:147], v[144:147], v[108:111]
  ds_read_b64_tr_b16 a[166:167], v216 offset:45056
  s_waitcnt lgkmcnt(4)
  v_cvt_pk_bf16_f32 v75, v78, v79
  v_mfma_f32_16x16x32_bf16 v[116:119], a[144:147], v[160:163], v[200:203]
  v_exp_f32 v84, v84
  v_mfma_f32_16x16x32_bf16 v[116:119], a[148:151], v[164:167], v[116:119]
  ds_read_b64_tr_b16 a[168:169], v217 offset:32768
  v_mfma_f32_16x16x32_bf16 v[228:231], a[232:235], a[212:215], 0
  v_mfma_f32_16x16x32_bf16 v[228:231], a[236:239], a[216:219], v[228:231]
  v_mfma_f32_16x16x32_bf16 v[228:231], a[240:243], a[220:223], v[228:231]
  v_mfma_f32_16x16x32_bf16 v[228:231], a[244:247], a[224:227], v[228:231]
  v_mfma_f32_16x16x32_bf16 v[228:231], a[248:251], a[228:231], v[228:231]
  v_mfma_f32_16x16x32_bf16 v[116:119], a[152:155], v[168:171], v[116:119]
  s_lshl_b32 s35, s3, 10
  s_add_u32 s35, s35, 159744
  v_exp_f32 v85, v85
  v_mfma_f32_16x16x32_bf16 v[116:119], a[156:159], v[172:175], v[116:119]
  ds_read_b64_tr_b16 a[170:171], v217 offset:36864
  v_cvt_pk_bf16_f32 v82, v84, v85
  v_mfma_f32_16x16x32_bf16 v[124:127], a[156:159], v[188:191], v[204:207]
  v_exp_f32 v86, v86
  v_mfma_f32_16x16x32_bf16 v[124:127], a[152:155], v[184:187], v[124:127]
  ds_read_b64_tr_b16 a[172:173], v217 offset:40960
  v_add_u32 v224, s35, v242
  v_mfma_f32_16x16x32_bf16 v[124:127], a[148:151], v[180:183], v[124:127]
  v_exp_f32 v87, v87
  v_mfma_f32_16x16x32_bf16 v[124:127], a[144:147], v[176:179], v[124:127]
  ds_read_b64_tr_b16 a[174:175], v217 offset:45056
  v_cvt_pk_bf16_f32 v83, v86, v87
  v_mfma_f32_16x16x32_bf16 a[192:195], a[208:211], v[0:3], a[192:195]
  v_exp_f32 v92, v92
  v_mfma_f32_16x16x32_bf16 a[192:195], a[208:211], v[32:35], a[192:195]
  ds_read_b64_tr_b16 a[176:177], v218 offset:32768
  ds_write_b128 v224, v[228:231]
  v_mfma_f32_16x16x32_bf16 a[196:199], a[208:211], v[8:11], a[196:199]
  v_exp_f32 v93, v93
  v_mfma_f32_16x16x32_bf16 a[196:199], a[208:211], v[40:43], a[196:199]
  ds_read_b64_tr_b16 a[178:179], v218 offset:36864
  v_cvt_pk_bf16_f32 v90, v92, v93
  v_mfma_f32_16x16x32_bf16 a[200:203], a[208:211], v[16:19], a[200:203]
  v_exp_f32 v94, v94
  v_mfma_f32_16x16x32_bf16 a[200:203], a[208:211], v[48:51], a[200:203]
  ds_read_b64_tr_b16 a[180:181], v218 offset:40960
  v_mfma_f32_16x16x32_bf16 a[204:207], a[208:211], v[24:27], a[204:207]
  s_waitcnt lgkmcnt(8)
  v_exp_f32 v95, v95
  v_mfma_f32_16x16x32_bf16 a[204:207], a[208:211], v[56:59], a[204:207]
  ds_read_b64_tr_b16 a[182:183], v218 offset:45056
  v_cvt_pk_bf16_f32 v91, v94, v95
  v_mfma_f32_16x16x32_bf16 a[0:3], a[160:163], v[0:3], a[0:3]
  v_exp_f32 v96, v96
  v_mfma_f32_16x16x32_bf16 a[0:3], a[164:167], v[32:35], a[0:3]
  ds_read_b64_tr_b16 a[184:185], v219 offset:32768
  s_waitcnt lgkmcnt(4)
  s_mov_b32 m0, s51
  v_mfma_f32_16x16x32_bf16 a[4:7], a[164:167], v[40:43], a[4:7]
  v_exp_f32 v97, v97
  v_mfma_f32_16x16x32_bf16 a[4:7], a[160:163], v[8:11], a[4:7]
  ds_read_b64_tr_b16 a[186:187], v219 offset:36864
  v_cvt_pk_bf16_f32 v96, v96, v97
  v_mfma_f32_16x16x32_bf16 a[8:11], a[160:163], v[16:19], a[8:11]
  v_exp_f32 v98, v98
  v_mfma_f32_16x16x32_bf16 a[8:11], a[164:167], v[48:51], a[8:11]
  ds_read_b64_tr_b16 a[188:189], v219 offset:40960
  buffer_load_dwordx4 v210, s[4:7], s100 offen lds
  s_add_u32 s100, s100, 20480
  s_add_u32 s51, s51, 512
  v_mfma_f32_16x16x32_bf16 a[12:15], a[164:167], v[56:59], a[12:15]
  v_exp_f32 v99, v99
  v_mfma_f32_16x16x32_bf16 a[12:15], a[160:163], v[24:27], a[12:15]
  ds_read_b64_tr_b16 a[190:191], v219 offset:45056
  v_cvt_pk_bf16_f32 v97, v98, v99
  v_mfma_f32_16x16x32_bf16 a[16:19], a[168:171], v[0:3], a[16:19]
  v_exp_f32 v104, v104
  v_mfma_f32_16x16x32_bf16 a[16:19], a[172:175], v[32:35], a[16:19]
  ds_read_b64_tr_b16 a[160:161], v220 offset:32768
  v_lshrrev_b32 v224, 4, v242
  v_mfma_f32_16x16x32_bf16 a[20:23], a[172:175], v[40:43], a[20:23]
  v_exp_f32 v105, v105
  v_mfma_f32_16x16x32_bf16 a[20:23], a[168:171], v[8:11], a[20:23]
  ds_read_b64_tr_b16 a[162:163], v220 offset:36864
  v_cvt_pk_bf16_f32 v104, v104, v105
  v_mfma_f32_16x16x32_bf16 a[24:27], a[168:171], v[16:19], a[24:27]
  v_exp_f32 v106, v106
  v_mfma_f32_16x16x32_bf16 a[24:27], a[172:175], v[48:51], a[24:27]
  ds_read_b64_tr_b16 a[164:165], v220 offset:40960
  v_bfe_u32 v225, v224, 2, 1
  v_mfma_f32_16x16x32_bf16 a[28:31], a[172:175], v[56:59], a[28:31]
  s_waitcnt lgkmcnt(7)
  v_exp_f32 v107, v107
  v_mfma_f32_16x16x32_bf16 a[28:31], a[168:171], v[24:27], a[28:31]
  ds_read_b64_tr_b16 a[166:167], v220 offset:45056
  v_cvt_pk_bf16_f32 v105, v106, v107
  v_mfma_f32_16x16x32_bf16 a[32:35], a[176:179], v[0:3], a[32:35]
  v_exp_f32 v112, v112
  v_mfma_f32_16x16x32_bf16 a[32:35], a[180:183], v[32:35], a[32:35]
  ds_read_b64_tr_b16 a[168:169], v221 offset:32768
  v_lshlrev_b32 v225, 8, v225
  v_mfma_f32_16x16x32_bf16 a[36:39], a[180:183], v[40:43], a[36:39]
  v_exp_f32 v113, v113
  v_mfma_f32_16x16x32_bf16 a[36:39], a[176:179], v[8:11], a[36:39]
  ds_read_b64_tr_b16 a[170:171], v221 offset:36864
  v_cvt_pk_bf16_f32 v112, v112, v113
  v_mfma_f32_16x16x32_bf16 a[40:43], a[176:179], v[16:19], a[40:43]
  v_exp_f32 v114, v114
  v_mfma_f32_16x16x32_bf16 a[40:43], a[180:183], v[48:51], a[40:43]
  ds_read_b64_tr_b16 a[172:173], v221 offset:40960
  v_lshrrev_b32 v226, 3, v224
  v_mfma_f32_16x16x32_bf16 a[44:47], a[180:183], v[56:59], a[44:47]
  s_waitcnt lgkmcnt(7)
  v_exp_f32 v115, v115
  v_mfma_f32_16x16x32_bf16 a[44:47], a[176:179], v[24:27], a[44:47]
  ds_read_b64_tr_b16 a[174:175], v221 offset:45056
  v_cvt_pk_bf16_f32 v113, v114, v115
  v_mfma_f32_16x16x32_bf16 a[48:51], a[184:187], v[0:3], a[48:51]
  v_exp_f32 v120, v120
  v_mfma_f32_16x16x32_bf16 a[48:51], a[188:191], v[32:35], a[48:51]
  ds_read_b64_tr_b16 a[176:177], v222 offset:32768
  v_lshl_add_u32 v225, v226, 4, v225
  v_mfma_f32_16x16x32_bf16 a[52:55], a[188:191], v[40:43], a[52:55]
  v_exp_f32 v121, v121
  v_mfma_f32_16x16x32_bf16 a[52:55], a[184:187], v[8:11], a[52:55]
  ds_read_b64_tr_b16 a[178:179], v222 offset:36864
  v_cvt_pk_bf16_f32 v120, v120, v121
  v_mfma_f32_16x16x32_bf16 a[56:59], a[184:187], v[16:19], a[56:59]
  v_exp_f32 v122, v122
  v_mfma_f32_16x16x32_bf16 a[56:59], a[188:191], v[48:51], a[56:59]
  ds_read_b64_tr_b16 a[180:181], v222 offset:40960
  v_and_b32 v227, 3, v224
  v_mfma_f32_16x16x32_bf16 a[60:63], a[188:191], v[56:59], a[60:63]
  s_waitcnt lgkmcnt(7)
  v_exp_f32 v123, v123
  v_mfma_f32_16x16x32_bf16 a[60:63], a[184:187], v[24:27], a[60:63]
  ds_read_b64_tr_b16 a[182:183], v222 offset:45056
  v_cvt_pk_bf16_f32 v121, v122, v123
  v_mfma_f32_16x16x32_bf16 a[64:67], a[160:163], v[0:3], a[64:67]
  v_exp_f32 v100, v100
  v_mfma_f32_16x16x32_bf16 a[64:67], a[164:167], v[32:35], a[64:67]
  ds_read_b64_tr_b16 a[184:185], v223 offset:32768
  v_lshl_add_u32 v225, v227, 2, v225
  v_mfma_f32_16x16x32_bf16 a[68:71], a[164:167], v[40:43], a[68:71]
  v_exp_f32 v101, v101
  v_mfma_f32_16x16x32_bf16 a[68:71], a[160:163], v[8:11], a[68:71]
  ds_read_b64_tr_b16 a[186:187], v223 offset:36864
  v_cvt_pk_bf16_f32 v98, v100, v101
  v_mfma_f32_16x16x32_bf16 a[72:75], a[160:163], v[16:19], a[72:75]
  v_exp_f32 v102, v102
  v_mfma_f32_16x16x32_bf16 a[72:75], a[164:167], v[48:51], a[72:75]
  ds_read_b64_tr_b16 a[188:189], v223 offset:40960
  v_add_u32 v225, 159744, v225
  v_mfma_f32_16x16x32_bf16 a[76:79], a[164:167], v[56:59], a[76:79]
  s_waitcnt lgkmcnt(7)
  v_exp_f32 v103, v103
  v_mfma_f32_16x16x32_bf16 a[76:79], a[160:163], v[24:27], a[76:79]
  ds_read_b64_tr_b16 a[190:191], v223 offset:45056
  v_cvt_pk_bf16_f32 v99, v102, v103
  v_mfma_f32_16x16x32_bf16 a[80:83], a[168:171], v[0:3], a[80:83]
  s_waitcnt vmcnt(9)
  v_exp_f32 v108, v108
  v_mfma_f32_16x16x32_bf16 a[80:83], a[172:175], v[32:35], a[80:83]
  v_mfma_f32_16x16x32_bf16 a[84:87], a[172:175], v[40:43], a[84:87]
  s_barrier
  v_exp_f32 v109, v109
  v_mfma_f32_16x16x32_bf16 a[84:87], a[168:171], v[8:11], a[84:87]
  ds_read_b128 a[128:131], v212 offset:0
  v_cvt_pk_bf16_f32 v106, v108, v109
  v_mfma_f32_16x16x32_bf16 a[88:91], a[168:171], v[16:19], a[88:91]
  v_exp_f32 v110, v110
  v_mfma_f32_16x16x32_bf16 a[88:91], a[172:175], v[48:51], a[88:91]
  ds_read_b128 a[132:135], v213 offset:0
  ds_read_b32 v228, v225 offset:0
  v_mfma_f32_16x16x32_bf16 a[92:95], a[172:175], v[56:59], a[92:95]
  s_waitcnt lgkmcnt(7)
  v_exp_f32 v111, v111
  v_mfma_f32_16x16x32_bf16 a[92:95], a[168:171], v[24:27], a[92:95]
  ds_read_b128 a[136:139], v214 offset:0
  v_cvt_pk_bf16_f32 v107, v110, v111
  v_mfma_f32_16x16x32_bf16 a[96:99], a[176:179], v[0:3], a[96:99]
  v_exp_f32 v116, v116
  v_mfma_f32_16x16x32_bf16 a[96:99], a[180:183], v[32:35], a[96:99]
  ds_read_b128 a[140:143], v215 offset:0
  ds_read_b32 v229, v225 offset:1024
  v_mfma_f32_16x16x32_bf16 a[100:103], a[180:183], v[40:43], a[100:103]
  v_exp_f32 v117, v117
  v_mfma_f32_16x16x32_bf16 a[100:103], a[176:179], v[8:11], a[100:103]
  ds_read_b32 v230, v225 offset:2048
  v_cvt_pk_bf16_f32 v114, v116, v117
  v_mfma_f32_16x16x32_bf16 a[104:107], a[176:179], v[16:19], a[104:107]
  v_exp_f32 v118, v118
  v_mfma_f32_16x16x32_bf16 a[104:107], a[180:183], v[48:51], a[104:107]
  ds_read_b32 v231, v225 offset:3072
  ds_read_b32 v238, v225 offset:512
  v_mfma_f32_16x16x32_bf16 a[108:111], a[180:183], v[56:59], a[108:111]
  s_waitcnt lgkmcnt(9)
  v_exp_f32 v119, v119
  v_mfma_f32_16x16x32_bf16 a[108:111], a[176:179], v[24:27], a[108:111]
  ds_read_b32 v239, v225 offset:1536
  v_cvt_pk_bf16_f32 v115, v118, v119
  v_mfma_f32_16x16x32_bf16 a[112:115], a[184:187], v[0:3], a[112:115]
  v_exp_f32 v124, v124
  v_mfma_f32_16x16x32_bf16 a[112:115], a[188:191], v[32:35], a[112:115]
  ds_read_b32 v240, v225 offset:2560
  ds_read_b32 v241, v225 offset:3584
  s_cmp_eq_u32 s3, 0
  s_cselect_b32 s35, 0, 1073741824
  v_mfma_f32_16x16x32_bf16 a[116:119], a[188:191], v[40:43], a[116:119]
  v_exp_f32 v125, v125
  v_mfma_f32_16x16x32_bf16 a[116:119], a[184:187], v[8:11], a[116:119]
  v_cvt_pk_bf16_f32 v122, v124, v125
  v_mul_u32_u24 v226, 0xd80, v226
  v_mfma_f32_16x16x32_bf16 a[120:123], a[184:187], v[16:19], a[120:123]
  v_exp_f32 v126, v126
  v_mfma_f32_16x16x32_bf16 a[120:123], a[188:191], v[48:51], a[120:123]
  v_and_b32 v227, 7, v224
  v_lshl_add_u32 v226, v227, 1, v226
  v_mfma_f32_16x16x32_bf16 a[124:127], a[188:191], v[56:59], a[124:127]
  s_waitcnt lgkmcnt(7)
  v_exp_f32 v127, v127
  v_mfma_f32_16x16x32_bf16 a[124:127], a[184:187], v[24:27], a[124:127]
  v_cvt_pk_bf16_f32 v123, v126, v127
  v_and_b32 v227, 1, v224
  v_lshl_add_u32 v226, v227, 30, v226
  v_or_b32 v226, s35, v226
  v_min_u32 v249, 1, v224
  v_lshlrev_b32 v249, 30, v249
  v_or_b32 v249, s35, v249
  v_mov_b32 v251, v249
  v_mov_b32 v250, 1
  s_mov_b32 s47, 2818048
  s_lshl_b32 s35, s33, 4
  s_add_u32 s35, s35, 2633728
  s_waitcnt lgkmcnt(0)
  v_add_f32 v228, v228, v229
  v_add_f32 v238, v238, v239
  v_add_f32 v230, v230, v231
  v_add_f32 v240, v240, v241
  v_add_f32 v228, v228, v230
  v_add_f32 v238, v238, v240
  v_cvt_pk_bf16_f32 v228, v228, v228
  v_cvt_pk_bf16_f32 v238, v238, v238
  v_lshlrev_b32 v228, 16, v228
  v_lshlrev_b32 v238, 16, v238
  v_mul_f32 v229, 0xbfb8aa3b, v228
  v_exp_f32 v229, v229
  s_nop 0
  v_add_f32 v229, 1.0, v229
  v_rcp_f32 v229, v229
  s_nop 0
  v_mul_f32 v228, v228, v229
  v_cvt_pk_bf16_f32 v228, v228, v228
  v_lshlrev_b32 v228, 16, v228
  v_mul_f32 v228, v228, v238
  s_nop 1
  v_mov_b32_dpp v229, v228 quad_perm:[1,0,3,2] row_mask:0xf bank_mask:0xf
  v_cvt_pk_bf16_f32 v228, v228, v229
  buffer_store_dword v228, v226, s[24:27], s35 offen sc1
  s_mov_b32 s32, 5
attn_loop:
  v_mfma_f32_16x16x32_bf16 v[0:3], a[128:131], v[128:131], v[192:195]
  s_add_u32 m0, s28, 81920
  v_mfma_f32_16x16x32_bf16 v[0:3], a[132:135], v[132:135], v[0:3]
  ds_read_b128 a[144:147], v212 offset:4096
  v_mfma_f32_16x16x32_bf16 v[0:3], a[136:139], v[136:139], v[0:3]
  buffer_load_dwordx4 v236, s[16:19], s29 offen offset:0 lds
  v_mfma_f32_16x16x32_bf16 v[0:3], a[140:143], v[140:143], v[0:3]
  ds_read_b128 a[148:151], v213 offset:4096
  v_mfma_f32_16x16x32_bf16 v[8:11], a[140:143], v[156:159], v[196:199]
  v_mfma_f32_16x16x32_bf16 v[8:11], a[136:139], v[152:155], v[8:11]
  ds_read_b128 a[152:155], v214 offset:4096
  v_mfma_f32_16x16x32_bf16 v[8:11], a[132:135], v[148:151], v[8:11]
  buffer_load_dwordx4 v237, s[16:19], s29 offen offset:1024 lds
  v_mfma_f32_16x16x32_bf16 v[8:11], a[128:131], v[144:147], v[8:11]
  ds_read_b128 a[156:159], v215 offset:4096
  v_mfma_f32_16x16x32_bf16 v[16:19], a[128:131], v[160:163], v[200:203]
  v_exp_f32 v0, v0
  v_mfma_f32_16x16x32_bf16 v[16:19], a[132:135], v[164:167], v[16:19]
  v_mfma_f32_16x16x32_bf16 v[16:19], a[136:139], v[168:171], v[16:19]
  v_exp_f32 v1, v1
  v_mfma_f32_16x16x32_bf16 v[16:19], a[140:143], v[172:175], v[16:19]
  v_cvt_pk_bf16_f32 v0, v0, v1
  v_mfma_f32_16x16x32_bf16 v[24:27], a[140:143], v[188:191], v[204:207]
  v_exp_f32 v2, v2
  v_mfma_f32_16x16x32_bf16 v[24:27], a[136:139], v[184:187], v[24:27]
  buffer_load_dwordx4 v236, s[16:19], s29 offen offset:2048 lds
  v_mfma_f32_16x16x32_bf16 v[24:27], a[132:135], v[180:183], v[24:27]
  s_waitcnt lgkmcnt(0)
  v_exp_f32 v3, v3
  v_mfma_f32_16x16x32_bf16 v[24:27], a[128:131], v[176:179], v[24:27]
  v_cvt_pk_bf16_f32 v1, v2, v3
  v_mfma_f32_16x16x32_bf16 v[4:7], a[144:147], v[128:131], v[192:195]
  v_exp_f32 v8, v8
  v_mfma_f32_16x16x32_bf16 v[4:7], a[148:151], v[132:135], v[4:7]
  ds_read_b128 a[128:131], v212 offset:8192
  v_mfma_f32_16x16x32_bf16 v[4:7], a[152:155], v[136:139], v[4:7]
  v_exp_f32 v9, v9
  v_mfma_f32_16x16x32_bf16 v[4:7], a[156:159], v[140:143], v[4:7]
  ds_read_b128 a[132:135], v213 offset:8192
  v_cvt_pk_bf16_f32 v8, v8, v9
  v_mfma_f32_16x16x32_bf16 v[12:15], a[156:159], v[156:159], v[196:199]
  v_exp_f32 v10, v10
  v_mfma_f32_16x16x32_bf16 v[12:15], a[152:155], v[152:155], v[12:15]
  ds_read_b128 a[136:139], v214 offset:8192
  v_mfma_f32_16x16x32_bf16 v[12:15], a[148:151], v[148:151], v[12:15]
  v_exp_f32 v11, v11
  v_mfma_f32_16x16x32_bf16 v[12:15], a[144:147], v[144:147], v[12:15]
  ds_read_b128 a[140:143], v215 offset:8192
  v_cvt_pk_bf16_f32 v9, v10, v11
  v_mfma_f32_16x16x32_bf16 v[20:23], a[144:147], v[160:163], v[200:203]
  v_exp_f32 v16, v16
  v_mfma_f32_16x16x32_bf16 v[20:23], a[148:151], v[164:167], v[20:23]
  buffer_load_dwordx4 v237, s[16:19], s29 offen offset:3072 lds
  v_mfma_f32_16x16x32_bf16 v[20:23], a[152:155], v[168:171], v[20:23]
  s_add_u32 s29, s29, 16384
  v_exp_f32 v17, v17
  v_mfma_f32_16x16x32_bf16 v[20:23], a[156:159], v[172:175], v[20:23]
  v_cvt_pk_bf16_f32 v16, v16, v17
  v_mfma_f32_16x16x32_bf16 v[28:31], a[156:159], v[188:191], v[204:207]
  s_add_u32 m0, s28, 32768
  v_exp_f32 v18, v18
  v_mfma_f32_16x16x32_bf16 v[28:31], a[152:155], v[184:187], v[28:31]
  buffer_load_dwordx4 v232, s[12:15], s29 offen offset:0 lds
  v_mfma_f32_16x16x32_bf16 v[28:31], a[148:151], v[180:183], v[28:31]
  s_waitcnt lgkmcnt(0)
  v_exp_f32 v19, v19
  v_mfma_f32_16x16x32_bf16 v[28:31], a[144:147], v[176:179], v[28:31]
  v_cvt_pk_bf16_f32 v17, v18, v19
  v_mfma_f32_16x16x32_bf16 v[32:35], a[128:131], v[128:131], v[192:195]
  v_exp_f32 v24, v24
  v_mfma_f32_16x16x32_bf16 v[32:35], a[132:135], v[132:135], v[32:35]
  ds_read_b128 a[144:147], v212 offset:12288
  v_mfma_f32_16x16x32_bf16 v[32:35], a[136:139], v[136:139], v[32:35]
  v_exp_f32 v25, v25
  v_mfma_f32_16x16x32_bf16 v[32:35], a[140:143], v[140:143], v[32:35]
  ds_read_b128 a[148:151], v213 offset:12288
  v_cvt_pk_bf16_f32 v24, v24, v25
  v_mfma_f32_16x16x32_bf16 v[40:43], a[140:143], v[156:159], v[196:199]
  v_exp_f32 v26, v26
  v_mfma_f32_16x16x32_bf16 v[40:43], a[136:139], v[152:155], v[40:43]
  ds_read_b128 a[152:155], v214 offset:12288
  v_mfma_f32_16x16x32_bf16 v[40:43], a[132:135], v[148:151], v[40:43]
  v_exp_f32 v27, v27
  v_mfma_f32_16x16x32_bf16 v[40:43], a[128:131], v[144:147], v[40:43]
  ds_read_b128 a[156:159], v215 offset:12288
  v_cvt_pk_bf16_f32 v25, v26, v27
  v_mfma_f32_16x16x32_bf16 v[48:51], a[128:131], v[160:163], v[200:203]
  v_exp_f32 v4, v4
  v_mfma_f32_16x16x32_bf16 v[48:51], a[132:135], v[164:167], v[48:51]
  buffer_load_dwordx4 v233, s[12:15], s29 offen offset:1024 lds
  v_mfma_f32_16x16x32_bf16 v[48:51], a[136:139], v[168:171], v[48:51]
  v_exp_f32 v5, v5
  v_mfma_f32_16x16x32_bf16 v[48:51], a[140:143], v[172:175], v[48:51]
  v_cvt_pk_bf16_f32 v2, v4, v5
  v_mfma_f32_16x16x32_bf16 v[56:59], a[140:143], v[188:191], v[204:207]
  v_exp_f32 v6, v6
  v_mfma_f32_16x16x32_bf16 v[56:59], a[136:139], v[184:187], v[56:59]
  buffer_load_dwordx4 v234, s[12:15], s29 offen offset:2048 lds
  v_mfma_f32_16x16x32_bf16 v[56:59], a[132:135], v[180:183], v[56:59]
  s_waitcnt lgkmcnt(0)
  v_exp_f32 v7, v7
  v_mfma_f32_16x16x32_bf16 v[56:59], a[128:131], v[176:179], v[56:59]
  v_cvt_pk_bf16_f32 v3, v6, v7
  v_mfma_f32_16x16x32_bf16 v[36:39], a[144:147], v[128:131], v[192:195]
  v_exp_f32 v12, v12
  v_mfma_f32_16x16x32_bf16 v[36:39], a[148:151], v[132:135], v[36:39]
  ds_read_b64_tr_b16 a[160:161], v216 offset:49152
  v_mfma_f32_16x16x32_bf16 v[36:39], a[152:155], v[136:139], v[36:39]
  v_exp_f32 v13, v13
  v_mfma_f32_16x16x32_bf16 v[36:39], a[156:159], v[140:143], v[36:39]
  ds_read_b64_tr_b16 a[162:163], v216 offset:53248
  v_cvt_pk_bf16_f32 v10, v12, v13
  v_mfma_f32_16x16x32_bf16 v[44:47], a[156:159], v[156:159], v[196:199]
  v_exp_f32 v14, v14
  v_mfma_f32_16x16x32_bf16 v[44:47], a[152:155], v[152:155], v[44:47]
  ds_read_b64_tr_b16 a[164:165], v216 offset:57344
  buffer_load_dwordx4 v235, s[12:15], s29 offen offset:3072 lds
  v_mfma_f32_16x16x32_bf16 v[44:47], a[148:151], v[148:151], v[44:47]
  v_exp_f32 v15, v15
  v_mfma_f32_16x16x32_bf16 v[44:47], a[144:147], v[144:147], v[44:47]
  ds_read_b64_tr_b16 a[166:167], v216 offset:61440
  v_cvt_pk_bf16_f32 v11, v14, v15
  v_mfma_f32_16x16x32_bf16 v[52:55], a[144:147], v[160:163], v[200:203]
  s_add_u32 m0, s50, 4096
  v_exp_f32 v20, v20
  v_mfma_f32_16x16x32_bf16 v[52:55], a[148:151], v[164:167], v[52:55]
  ds_read_b64_tr_b16 a[168:169], v217 offset:49152
  buffer_load_dwordx4 v208, s[20:23], s30 offen lds
  s_add_u32 s30, s30, 32
  v_mfma_f32_16x16x32_bf16 v[52:55], a[152:155], v[168:171], v[52:55]
  v_exp_f32 v21, v21
  v_mfma_f32_16x16x32_bf16 v[52:55], a[156:159], v[172:175], v[52:55]
  ds_read_b64_tr_b16 a[170:171], v217 offset:53248
  v_cvt_pk_bf16_f32 v18, v20, v21
  v_mfma_f32_16x16x32_bf16 v[60:63], a[156:159], v[188:191], v[204:207]
  v_exp_f32 v22, v22
  v_mfma_f32_16x16x32_bf16 v[60:63], a[152:155], v[184:187], v[60:63]
  ds_read_b64_tr_b16 a[172:173], v217 offset:57344
  v_mfma_f32_16x16x32_bf16 v[60:63], a[148:151], v[180:183], v[60:63]
  v_exp_f32 v23, v23
  v_mfma_f32_16x16x32_bf16 v[60:63], a[144:147], v[176:179], v[60:63]
  ds_read_b64_tr_b16 a[174:175], v217 offset:61440
  v_cvt_pk_bf16_f32 v19, v22, v23
  v_mfma_f32_16x16x32_bf16 a[192:195], a[208:211], v[64:67], a[192:195]
  v_exp_f32 v28, v28
  v_mfma_f32_16x16x32_bf16 a[192:195], a[208:211], v[96:99], a[192:195]
  ds_read_b64_tr_b16 a[176:177], v218 offset:49152
  v_mfma_f32_16x16x32_bf16 a[196:199], a[208:211], v[72:75], a[196:199]
  v_exp_f32 v29, v29
  v_mfma_f32_16x16x32_bf16 a[196:199], a[208:211], v[104:107], a[196:199]
  ds_read_b64_tr_b16 a[178:179], v218 offset:53248
  v_cvt_pk_bf16_f32 v26, v28, v29
  v_mfma_f32_16x16x32_bf16 a[200:203], a[208:211], v[80:83], a[200:203]
  v_exp_f32 v30, v30
  v_mfma_f32_16x16x32_bf16 a[200:203], a[208:211], v[112:115], a[200:203]
  ds_read_b64_tr_b16 a[180:181], v218 offset:57344
  v_mfma_f32_16x16x32_bf16 a[204:207], a[208:211], v[88:91], a[204:207]
  s_waitcnt lgkmcnt(7)
  v_exp_f32 v31, v31
  v_mfma_f32_16x16x32_bf16 a[204:207], a[208:211], v[120:123], a[204:207]
  ds_read_b64_tr_b16 a[182:183], v218 offset:61440
  v_cvt_pk_bf16_f32 v27, v30, v31
  v_mfma_f32_16x16x32_bf16 a[0:3], a[160:163], v[64:67], a[0:3]
  v_exp_f32 v32, v32
  v_mfma_f32_16x16x32_bf16 a[0:3], a[164:167], v[96:99], a[0:3]
  ds_read_b64_tr_b16 a[184:185], v219 offset:49152
  v_mfma_f32_16x16x32_bf16 a[4:7], a[164:167], v[104:107], a[4:7]
  v_exp_f32 v33, v33
  v_mfma_f32_16x16x32_bf16 a[4:7], a[160:163], v[72:75], a[4:7]
  ds_read_b64_tr_b16 a[186:187], v219 offset:53248
  v_cvt_pk_bf16_f32 v32, v32, v33
  v_mfma_f32_16x16x32_bf16 a[8:11], a[160:163], v[80:83], a[8:11]
  v_exp_f32 v34, v34
  v_mfma_f32_16x16x32_bf16 a[8:11], a[164:167], v[112:115], a[8:11]
  ds_read_b64_tr_b16 a[188:189], v219 offset:57344
  v_mfma_f32_16x16x32_bf16 a[12:15], a[164:167], v[120:123], a[12:15]
  s_waitcnt lgkmcnt(7)
  v_exp_f32 v35, v35
  v_mfma_f32_16x16x32_bf16 a[12:15], a[160:163], v[88:91], a[12:15]
  ds_read_b64_tr_b16 a[190:191], v219 offset:61440
  v_cvt_pk_bf16_f32 v33, v34, v35
  v_mfma_f32_16x16x32_bf16 a[16:19], a[168:171], v[64:67], a[16:19]
  v_exp_f32 v40, v40
  v_mfma_f32_16x16x32_bf16 a[16:19], a[172:175], v[96:99], a[16:19]
  ds_read_b64_tr_b16 a[160:161], v220 offset:49152
  v_mfma_f32_16x16x32_bf16 a[20:23], a[172:175], v[104:107], a[20:23]
  v_exp_f32 v41, v41
  v_mfma_f32_16x16x32_bf16 a[20:23], a[168:171], v[72:75], a[20:23]
  ds_read_b64_tr_b16 a[162:163], v220 offset:53248
  v_cvt_pk_bf16_f32 v40, v40, v41
  v_mfma_f32_16x16x32_bf16 a[24:27], a[168:171], v[80:83], a[24:27]
  v_exp_f32 v42, v42
  v_mfma_f32_16x16x32_bf16 a[24:27], a[172:175], v[112:115], a[24:27]
  ds_read_b64_tr_b16 a[164:165], v220 offset:57344
  v_mfma_f32_16x16x32_bf16 a[28:31], a[172:175], v[120:123], a[28:31]
  s_waitcnt lgkmcnt(7)
  v_exp_f32 v43, v43
  v_mfma_f32_16x16x32_bf16 a[28:31], a[168:171], v[88:91], a[28:31]
  ds_read_b64_tr_b16 a[166:167], v220 offset:61440
  v_cvt_pk_bf16_f32 v41, v42, v43
  v_mfma_f32_16x16x32_bf16 a[32:35], a[176:179], v[64:67], a[32:35]
  v_exp_f32 v48, v48
  v_mfma_f32_16x16x32_bf16 a[32:35], a[180:183], v[96:99], a[32:35]
  ds_read_b64_tr_b16 a[168:169], v221 offset:49152
  v_mfma_f32_16x16x32_bf16 a[36:39], a[180:183], v[104:107], a[36:39]
  v_exp_f32 v49, v49
  v_mfma_f32_16x16x32_bf16 a[36:39], a[176:179], v[72:75], a[36:39]
  ds_read_b64_tr_b16 a[170:171], v221 offset:53248
  v_cvt_pk_bf16_f32 v48, v48, v49
  v_mfma_f32_16x16x32_bf16 a[40:43], a[176:179], v[80:83], a[40:43]
  v_exp_f32 v50, v50
  v_mfma_f32_16x16x32_bf16 a[40:43], a[180:183], v[112:115], a[40:43]
  ds_read_b64_tr_b16 a[172:173], v221 offset:57344
  v_mfma_f32_16x16x32_bf16 a[44:47], a[180:183], v[120:123], a[44:47]
  s_waitcnt lgkmcnt(7)
  v_exp_f32 v51, v51
  v_mfma_f32_16x16x32_bf16 a[44:47], a[176:179], v[88:91], a[44:47]
  ds_read_b64_tr_b16 a[174:175], v221 offset:61440
  v_cvt_pk_bf16_f32 v49, v50, v51
  v_mfma_f32_16x16x32_bf16 a[48:51], a[184:187], v[64:67], a[48:51]
  v_exp_f32 v56, v56
  v_mfma_f32_16x16x32_bf16 a[48:51], a[188:191], v[96:99], a[48:51]
  ds_read_b64_tr_b16 a[176:177], v222 offset:49152
  v_mfma_f32_16x16x32_bf16 a[52:55], a[188:191], v[104:107], a[52:55]
  v_exp_f32 v57, v57
  v_mfma_f32_16x16x32_bf16 a[52:55], a[184:187], v[72:75], a[52:55]
  ds_read_b64_tr_b16 a[178:179], v222 offset:53248
  v_cvt_pk_bf16_f32 v56, v56, v57
  v_mfma_f32_16x16x32_bf16 a[56:59], a[184:187], v[80:83], a[56:59]
  v_exp_f32 v58, v58
  v_mfma_f32_16x16x32_bf16 a[56:59], a[188:191], v[112:115], a[56:59]
  ds_read_b64_tr_b16 a[180:181], v222 offset:57344
  global_load_dword v255, v252, s[8:9]
  v_mfma_f32_16x16x32_bf16 a[60:63], a[188:191], v[120:123], a[60:63]
  s_waitcnt lgkmcnt(7)
  v_exp_f32 v59, v59
  v_mfma_f32_16x16x32_bf16 a[60:63], a[184:187], v[88:91], a[60:63]
  ds_read_b64_tr_b16 a[182:183], v222 offset:61440
  v_cvt_pk_bf16_f32 v57, v58, v59
  v_mfma_f32_16x16x32_bf16 a[64:67], a[160:163], v[64:67], a[64:67]
  v_exp_f32 v36, v36
  v_mfma_f32_16x16x32_bf16 a[64:67], a[164:167], v[96:99], a[64:67]
  ds_read_b64_tr_b16 a[184:185], v223 offset:49152
  v_mfma_f32_16x16x32_bf16 a[68:71], a[164:167], v[104:107], a[68:71]
  v_exp_f32 v37, v37
  v_mfma_f32_16x16x32_bf16 a[68:71], a[160:163], v[72:75], a[68:71]
  ds_read_b64_tr_b16 a[186:187], v223 offset:53248
  v_cvt_pk_bf16_f32 v34, v36, v37
  v_mfma_f32_16x16x32_bf16 a[72:75], a[160:163], v[80:83], a[72:75]
  v_exp_f32 v38, v38
  v_mfma_f32_16x16x32_bf16 a[72:75], a[164:167], v[112:115], a[72:75]
  ds_read_b64_tr_b16 a[188:189], v223 offset:57344
  v_mfma_f32_16x16x32_bf16 a[76:79], a[164:167], v[120:123], a[76:79]
  s_waitcnt lgkmcnt(7)
  v_exp_f32 v39, v39
  v_mfma_f32_16x16x32_bf16 a[76:79], a[160:163], v[88:91], a[76:79]
  ds_read_b64_tr_b16 a[190:191], v223 offset:61440
  v_cvt_pk_bf16_f32 v35, v38, v39
  v_mfma_f32_16x16x32_bf16 a[80:83], a[168:171], v[64:67], a[80:83]
  s_waitcnt vmcnt(12)
  v_exp_f32 v44, v44
  v_mfma_f32_16x16x32_bf16 a[80:83], a[172:175], v[96:99], a[80:83]
  v_mfma_f32_16x16x32_bf16 a[84:87], a[172:175], v[104:107], a[84:87]
  s_barrier
  v_exp_f32 v45, v45
  v_mfma_f32_16x16x32_bf16 a[84:87], a[168:171], v[72:75], a[84:87]
  ds_read_b128 a[128:131], v212 offset:16384
  v_cvt_pk_bf16_f32 v42, v44, v45
  v_mfma_f32_16x16x32_bf16 a[88:91], a[168:171], v[80:83], a[88:91]
  v_exp_f32 v46, v46
  v_mfma_f32_16x16x32_bf16 a[88:91], a[172:175], v[112:115], a[88:91]
  ds_read_b128 a[132:135], v213 offset:16384
  v_mfma_f32_16x16x32_bf16 a[92:95], a[172:175], v[120:123], a[92:95]
  s_waitcnt lgkmcnt(6)
  v_exp_f32 v47, v47
  v_mfma_f32_16x16x32_bf16 a[92:95], a[168:171], v[88:91], a[92:95]
  ds_read_b128 a[136:139], v214 offset:16384
  v_cvt_pk_bf16_f32 v43, v46, v47
  v_mfma_f32_16x16x32_bf16 a[96:99], a[176:179], v[64:67], a[96:99]
  v_exp_f32 v52, v52
  v_mfma_f32_16x16x32_bf16 a[96:99], a[180:183], v[96:99], a[96:99]
  ds_read_b128 a[140:143], v215 offset:16384
  v_mfma_f32_16x16x32_bf16 a[100:103], a[180:183], v[104:107], a[100:103]
  v_exp_f32 v53, v53
  v_mfma_f32_16x16x32_bf16 a[100:103], a[176:179], v[72:75], a[100:103]
  v_cvt_pk_bf16_f32 v50, v52, v53
  v_mfma_f32_16x16x32_bf16 a[104:107], a[176:179], v[80:83], a[104:107]
  v_exp_f32 v54, v54
  v_mfma_f32_16x16x32_bf16 a[104:107], a[180:183], v[112:115], a[104:107]
  v_mfma_f32_16x16x32_bf16 a[108:111], a[180:183], v[120:123], a[108:111]
  s_waitcnt lgkmcnt(4)
  v_exp_f32 v55, v55
  v_mfma_f32_16x16x32_bf16 a[108:111], a[176:179], v[88:91], a[108:111]
  v_cvt_pk_bf16_f32 v51, v54, v55
  v_mfma_f32_16x16x32_bf16 a[112:115], a[184:187], v[64:67], a[112:115]
  v_exp_f32 v60, v60
  v_mfma_f32_16x16x32_bf16 a[112:115], a[188:191], v[96:99], a[112:115]
  v_mfma_f32_16x16x32_bf16 a[116:119], a[188:191], v[104:107], a[116:119]
  v_exp_f32 v61, v61
  v_mfma_f32_16x16x32_bf16 a[116:119], a[184:187], v[72:75], a[116:119]
  v_cvt_pk_bf16_f32 v58, v60, v61
  v_mfma_f32_16x16x32_bf16 a[120:123], a[184:187], v[80:83], a[120:123]
  v_exp_f32 v62, v62
  v_mfma_f32_16x16x32_bf16 a[120:123], a[188:191], v[112:115], a[120:123]
  v_mfma_f32_16x16x32_bf16 a[124:127], a[188:191], v[120:123], a[124:127]
  s_waitcnt lgkmcnt(0)
  v_exp_f32 v63, v63
  v_mfma_f32_16x16x32_bf16 a[124:127], a[184:187], v[88:91], a[124:127]
  v_cvt_pk_bf16_f32 v59, v62, v63
  v_mfma_f32_16x16x32_bf16 v[64:67], a[128:131], v[128:131], v[192:195]
  s_add_u32 m0, s28, 98304
  v_mfma_f32_16x16x32_bf16 v[64:67], a[132:135], v[132:135], v[64:67]
  ds_read_b128 a[144:147], v212 offset:20480
  v_mfma_f32_16x16x32_bf16 v[64:67], a[136:139], v[136:139], v[64:67]
  buffer_load_dwordx4 v236, s[16:19], s29 offen offset:0 lds
  v_mfma_f32_16x16x32_bf16 v[64:67], a[140:143], v[140:143], v[64:67]
  ds_read_b128 a[148:151], v213 offset:20480
  v_mfma_f32_16x16x32_bf16 v[72:75], a[140:143], v[156:159], v[196:199]
  v_mfma_f32_16x16x32_bf16 v[72:75], a[136:139], v[152:155], v[72:75]
  ds_read_b128 a[152:155], v214 offset:20480
  v_mfma_f32_16x16x32_bf16 v[72:75], a[132:135], v[148:151], v[72:75]
  buffer_load_dwordx4 v237, s[16:19], s29 offen offset:1024 lds
  v_mfma_f32_16x16x32_bf16 v[72:75], a[128:131], v[144:147], v[72:75]
  ds_read_b128 a[156:159], v215 offset:20480
  v_mfma_f32_16x16x32_bf16 v[80:83], a[128:131], v[160:163], v[200:203]
  v_exp_f32 v64, v64
  v_mfma_f32_16x16x32_bf16 v[80:83], a[132:135], v[164:167], v[80:83]
  v_mfma_f32_16x16x32_bf16 v[80:83], a[136:139], v[168:171], v[80:83]
  v_exp_f32 v65, v65
  v_mfma_f32_16x16x32_bf16 v[80:83], a[140:143], v[172:175], v[80:83]
  v_cvt_pk_bf16_f32 v64, v64, v65
  v_mfma_f32_16x16x32_bf16 v[88:91], a[140:143], v[188:191], v[204:207]
  v_exp_f32 v66, v66
  v_mfma_f32_16x16x32_bf16 v[88:91], a[136:139], v[184:187], v[88:91]
  buffer_load_dwordx4 v236, s[16:19], s29 offen offset:2048 lds
  v_mfma_f32_16x16x32_bf16 v[88:91], a[132:135], v[180:183], v[88:91]
  s_waitcnt lgkmcnt(0)
  v_exp_f32 v67, v67
  v_mfma_f32_16x16x32_bf16 v[88:91], a[128:131], v[176:179], v[88:91]
  v_cvt_pk_bf16_f32 v65, v66, v67
  v_mfma_f32_16x16x32_bf16 v[68:71], a[144:147], v[128:131], v[192:195]
  v_exp_f32 v72, v72
  v_mfma_f32_16x16x32_bf16 v[68:71], a[148:151], v[132:135], v[68:71]
  ds_read_b128 a[128:131], v212 offset:24576
  v_mfma_f32_16x16x32_bf16 v[68:71], a[152:155], v[136:139], v[68:71]
  v_exp_f32 v73, v73
  v_mfma_f32_16x16x32_bf16 v[68:71], a[156:159], v[140:143], v[68:71]
  ds_read_b128 a[132:135], v213 offset:24576
  v_cvt_pk_bf16_f32 v72, v72, v73
  v_mfma_f32_16x16x32_bf16 v[76:79], a[156:159], v[156:159], v[196:199]
  v_exp_f32 v74, v74
  v_mfma_f32_16x16x32_bf16 v[76:79], a[152:155], v[152:155], v[76:79]
  ds_read_b128 a[136:139], v214 offset:24576
  v_mfma_f32_16x16x32_bf16 v[76:79], a[148:151], v[148:151], v[76:79]
  v_exp_f32 v75, v75
  v_mfma_f32_16x16x32_bf16 v[76:79], a[144:147], v[144:147], v[76:79]
  ds_read_b128 a[140:143], v215 offset:24576
  v_cvt_pk_bf16_f32 v73, v74, v75
  v_mfma_f32_16x16x32_bf16 v[84:87], a[144:147], v[160:163], v[200:203]
  v_exp_f32 v80, v80
  v_mfma_f32_16x16x32_bf16 v[84:87], a[148:151], v[164:167], v[84:87]
  buffer_load_dwordx4 v237, s[16:19], s29 offen offset:3072 lds
  v_mfma_f32_16x16x32_bf16 v[84:87], a[152:155], v[168:171], v[84:87]
  s_add_u32 s29, s29, 16384
  v_exp_f32 v81, v81
  v_mfma_f32_16x16x32_bf16 v[84:87], a[156:159], v[172:175], v[84:87]
  v_cvt_pk_bf16_f32 v80, v80, v81
  v_mfma_f32_16x16x32_bf16 v[92:95], a[156:159], v[188:191], v[204:207]
  s_add_u32 m0, s28, 49152
  v_exp_f32 v82, v82
  v_mfma_f32_16x16x32_bf16 v[92:95], a[152:155], v[184:187], v[92:95]
  buffer_load_dwordx4 v232, s[12:15], s29 offen offset:0 lds
  v_mfma_f32_16x16x32_bf16 v[92:95], a[148:151], v[180:183], v[92:95]
  s_waitcnt lgkmcnt(0)
  v_exp_f32 v83, v83
  v_mfma_f32_16x16x32_bf16 v[92:95], a[144:147], v[176:179], v[92:95]
  v_cvt_pk_bf16_f32 v81, v82, v83
  v_mfma_f32_16x16x32_bf16 v[96:99], a[128:131], v[128:131], v[192:195]
  v_exp_f32 v88, v88
  v_mfma_f32_16x16x32_bf16 v[96:99], a[132:135], v[132:135], v[96:99]
  ds_read_b128 a[144:147], v212 offset:28672
  v_mfma_f32_16x16x32_bf16 v[96:99], a[136:139], v[136:139], v[96:99]
  v_exp_f32 v89, v89
  v_mfma_f32_16x16x32_bf16 v[96:99], a[140:143], v[140:143], v[96:99]
  ds_read_b128 a[148:151], v213 offset:28672
  v_cvt_pk_bf16_f32 v88, v88, v89
  v_mfma_f32_16x16x32_bf16 v[104:107], a[140:143], v[156:159], v[196:199]
  v_exp_f32 v90, v90
  v_mfma_f32_16x16x32_bf16 v[104:107], a[136:139], v[152:155], v[104:107]
  ds_read_b128 a[152:155], v214 offset:28672
  v_mfma_f32_16x16x32_bf16 v[104:107], a[132:135], v[148:151], v[104:107]
  v_exp_f32 v91, v91
  v_mfma_f32_16x16x32_bf16 v[104:107], a[128:131], v[144:147], v[104:107]
  ds_read_b128 a[156:159], v215 offset:28672
  v_cvt_pk_bf16_f32 v89, v90, v91
  v_mfma_f32_16x16x32_bf16 v[112:115], a[128:131], v[160:163], v[200:203]
  v_exp_f32 v68, v68
  v_mfma_f32_16x16x32_bf16 v[112:115], a[132:135], v[164:167], v[112:115]
  buffer_load_dwordx4 v233, s[12:15], s29 offen offset:1024 lds
  v_mfma_f32_16x16x32_bf16 v[112:115], a[136:139], v[168:171], v[112:115]
  v_exp_f32 v69, v69
  v_mfma_f32_16x16x32_bf16 v[112:115], a[140:143], v[172:175], v[112:115]
  v_cvt_pk_bf16_f32 v66, v68, v69
  v_mfma_f32_16x16x32_bf16 v[120:123], a[140:143], v[188:191], v[204:207]
  v_exp_f32 v70, v70
  v_mfma_f32_16x16x32_bf16 v[120:123], a[136:139], v[184:187], v[120:123]
  buffer_load_dwordx4 v234, s[12:15], s29 offen offset:2048 lds
  v_mfma_f32_16x16x32_bf16 v[120:123], a[132:135], v[180:183], v[120:123]
  s_waitcnt lgkmcnt(0)
  v_exp_f32 v71, v71
  v_mfma_f32_16x16x32_bf16 v[120:123], a[128:131], v[176:179], v[120:123]
  v_cvt_pk_bf16_f32 v67, v70, v71
  v_mfma_f32_16x16x32_bf16 v[100:103], a[144:147], v[128:131], v[192:195]
  v_exp_f32 v76, v76
  v_mfma_f32_16x16x32_bf16 v[100:103], a[148:151], v[132:135], v[100:103]
  ds_read_b64_tr_b16 a[160:161], v216 offset:0
  v_mfma_f32_16x16x32_bf16 v[100:103], a[152:155], v[136:139], v[100:103]
  v_exp_f32 v77, v77
  v_mfma_f32_16x16x32_bf16 v[100:103], a[156:159], v[140:143], v[100:103]
  ds_read_b64_tr_b16 a[162:163], v216 offset:4096
  v_cvt_pk_bf16_f32 v74, v76, v77
  v_mfma_f32_16x16x32_bf16 v[108:111], a[156:159], v[156:159], v[196:199]
  v_exp_f32 v78, v78
  v_mfma_f32_16x16x32_bf16 v[108:111], a[152:155], v[152:155], v[108:111]
  ds_read_b64_tr_b16 a[164:165], v216 offset:8192
  buffer_load_dwordx4 v235, s[12:15], s29 offen offset:3072 lds
  v_mfma_f32_16x16x32_bf16 v[108:111], a[148:151], v[148:151], v[108:111]
  v_exp_f32 v79, v79
  v_mfma_f32_16x16x32_bf16 v[108:111], a[144:147], v[144:147], v[108:111]
  ds_read_b64_tr_b16 a[166:167], v216 offset:12288
  v_cvt_pk_bf16_f32 v75, v78, v79
  v_mfma_f32_16x16x32_bf16 v[116:119], a[144:147], v[160:163], v[200:203]
  s_add_u32 m0, s50, 5120
  v_exp_f32 v84, v84
  v_mfma_f32_16x16x32_bf16 v[116:119], a[148:151], v[164:167], v[116:119]
  ds_read_b64_tr_b16 a[168:169], v217 offset:0
  buffer_load_dwordx4 v208, s[20:23], s30 offen lds
  s_add_u32 s30, s30, 32
  v_mfma_f32_16x16x32_bf16 v[116:119], a[152:155], v[168:171], v[116:119]
  v_exp_f32 v85, v85
  v_mfma_f32_16x16x32_bf16 v[116:119], a[156:159], v[172:175], v[116:119]
  ds_read_b64_tr_b16 a[170:171], v217 offset:4096
  v_cvt_pk_bf16_f32 v82, v84, v85
  v_mfma_f32_16x16x32_bf16 v[124:127], a[156:159], v[188:191], v[204:207]
  v_exp_f32 v86, v86
  v_mfma_f32_16x16x32_bf16 v[124:127], a[152:155], v[184:187], v[124:127]
  ds_read_b64_tr_b16 a[172:173], v217 offset:8192
  v_mfma_f32_16x16x32_bf16 v[124:127], a[148:151], v[180:183], v[124:127]
  v_exp_f32 v87, v87
  v_mfma_f32_16x16x32_bf16 v[124:127], a[144:147], v[176:179], v[124:127]
  ds_read_b64_tr_b16 a[174:175], v217 offset:12288
  v_cvt_pk_bf16_f32 v83, v86, v87
  v_mfma_f32_16x16x32_bf16 a[192:195], a[208:211], v[0:3], a[192:195]
  v_exp_f32 v92, v92
  v_mfma_f32_16x16x32_bf16 a[192:195], a[208:211], v[32:35], a[192:195]
  ds_read_b64_tr_b16 a[176:177], v218 offset:0
  v_mfma_f32_16x16x32_bf16 a[196:199], a[208:211], v[8:11], a[196:199]
  v_exp_f32 v93, v93
  v_mfma_f32_16x16x32_bf16 a[196:199], a[208:211], v[40:43], a[196:199]
  ds_read_b64_tr_b16 a[178:179], v218 offset:4096
  v_cvt_pk_bf16_f32 v90, v92, v93
  v_mfma_f32_16x16x32_bf16 a[200:203], a[208:211], v[16:19], a[200:203]
  v_exp_f32 v94, v94
  v_mfma_f32_16x16x32_bf16 a[200:203], a[208:211], v[48:51], a[200:203]
  ds_read_b64_tr_b16 a[180:181], v218 offset:8192
  v_mfma_f32_16x16x32_bf16 a[204:207], a[208:211], v[24:27], a[204:207]
  s_waitcnt lgkmcnt(7)
  v_exp_f32 v95, v95
  v_mfma_f32_16x16x32_bf16 a[204:207], a[208:211], v[56:59], a[204:207]
  ds_read_b64_tr_b16 a[182:183], v218 offset:12288
  v_cvt_pk_bf16_f32 v91, v94, v95
  v_mfma_f32_16x16x32_bf16 a[0:3], a[160:163], v[0:3], a[0:3]
  v_exp_f32 v96, v96
  v_mfma_f32_16x16x32_bf16 a[0:3], a[164:167], v[32:35], a[0:3]
  ds_read_b64_tr_b16 a[184:185], v219 offset:0
  v_mfma_f32_16x16x32_bf16 a[4:7], a[164:167], v[40:43], a[4:7]
  v_exp_f32 v97, v97
  v_mfma_f32_16x16x32_bf16 a[4:7], a[160:163], v[8:11], a[4:7]
  ds_read_b64_tr_b16 a[186:187], v219 offset:4096
  v_cvt_pk_bf16_f32 v96, v96, v97
  v_mfma_f32_16x16x32_bf16 a[8:11], a[160:163], v[16:19], a[8:11]
  v_exp_f32 v98, v98
  v_mfma_f32_16x16x32_bf16 a[8:11], a[164:167], v[48:51], a[8:11]
  ds_read_b64_tr_b16 a[188:189], v219 offset:8192
  v_mfma_f32_16x16x32_bf16 a[12:15], a[164:167], v[56:59], a[12:15]
  s_waitcnt lgkmcnt(7)
  v_exp_f32 v99, v99
  v_mfma_f32_16x16x32_bf16 a[12:15], a[160:163], v[24:27], a[12:15]
  ds_read_b64_tr_b16 a[190:191], v219 offset:12288
  v_cvt_pk_bf16_f32 v97, v98, v99
  v_mfma_f32_16x16x32_bf16 a[16:19], a[168:171], v[0:3], a[16:19]
  v_exp_f32 v104, v104
  v_mfma_f32_16x16x32_bf16 a[16:19], a[172:175], v[32:35], a[16:19]
  ds_read_b64_tr_b16 a[160:161], v220 offset:0
  v_mfma_f32_16x16x32_bf16 a[20:23], a[172:175], v[40:43], a[20:23]
  v_exp_f32 v105, v105
  v_mfma_f32_16x16x32_bf16 a[20:23], a[168:171], v[8:11], a[20:23]
  ds_read_b64_tr_b16 a[162:163], v220 offset:4096
  v_cvt_pk_bf16_f32 v104, v104, v105
  v_mfma_f32_16x16x32_bf16 a[24:27], a[168:171], v[16:19], a[24:27]
  v_exp_f32 v106, v106
  v_mfma_f32_16x16x32_bf16 a[24:27], a[172:175], v[48:51], a[24:27]
  ds_read_b64_tr_b16 a[164:165], v220 offset:8192
  v_mfma_f32_16x16x32_bf16 a[28:31], a[172:175], v[56:59], a[28:31]
  s_waitcnt lgkmcnt(7)
  v_exp_f32 v107, v107
  v_mfma_f32_16x16x32_bf16 a[28:31], a[168:171], v[24:27], a[28:31]
  ds_read_b64_tr_b16 a[166:167], v220 offset:12288
  v_cvt_pk_bf16_f32 v105, v106, v107
  v_mfma_f32_16x16x32_bf16 a[32:35], a[176:179], v[0:3], a[32:35]
  v_exp_f32 v112, v112
  v_mfma_f32_16x16x32_bf16 a[32:35], a[180:183], v[32:35], a[32:35]
  ds_read_b64_tr_b16 a[168:169], v221 offset:0
  v_mfma_f32_16x16x32_bf16 a[36:39], a[180:183], v[40:43], a[36:39]
  v_exp_f32 v113, v113
  v_mfma_f32_16x16x32_bf16 a[36:39], a[176:179], v[8:11], a[36:39]
  ds_read_b64_tr_b16 a[170:171], v221 offset:4096
  v_cvt_pk_bf16_f32 v112, v112, v113
  v_mfma_f32_16x16x32_bf16 a[40:43], a[176:179], v[16:19], a[40:43]
  v_exp_f32 v114, v114
  v_mfma_f32_16x16x32_bf16 a[40:43], a[180:183], v[48:51], a[40:43]
  ds_read_b64_tr_b16 a[172:173], v221 offset:8192
  v_mfma_f32_16x16x32_bf16 a[44:47], a[180:183], v[56:59], a[44:47]
  s_waitcnt lgkmcnt(7)
  v_exp_f32 v115, v115
  v_mfma_f32_16x16x32_bf16 a[44:47], a[176:179], v[24:27], a[44:47]
  ds_read_b64_tr_b16 a[174:175], v221 offset:12288
  v_cvt_pk_bf16_f32 v113, v114, v115
  v_mfma_f32_16x16x32_bf16 a[48:51], a[184:187], v[0:3], a[48:51]
  v_exp_f32 v120, v120
  v_mfma_f32_16x16x32_bf16 a[48:51], a[188:191], v[32:35], a[48:51]
  ds_read_b64_tr_b16 a[176:177], v222 offset:0
  v_mfma_f32_16x16x32_bf16 a[52:55], a[188:191], v[40:43], a[52:55]
  v_exp_f32 v121, v121
  v_mfma_f32_16x16x32_bf16 a[52:55], a[184:187], v[8:11], a[52:55]
  ds_read_b64_tr_b16 a[178:179], v222 offset:4096
  v_cvt_pk_bf16_f32 v120, v120, v121
  v_mfma_f32_16x16x32_bf16 a[56:59], a[184:187], v[16:19], a[56:59]
  v_exp_f32 v122, v122
  v_mfma_f32_16x16x32_bf16 a[56:59], a[188:191], v[48:51], a[56:59]
  ds_read_b64_tr_b16 a[180:181], v222 offset:8192
  v_mfma_f32_16x16x32_bf16 a[60:63], a[188:191], v[56:59], a[60:63]
  s_waitcnt lgkmcnt(7)
  v_exp_f32 v123, v123
  v_mfma_f32_16x16x32_bf16 a[60:63], a[184:187], v[24:27], a[60:63]
  ds_read_b64_tr_b16 a[182:183], v222 offset:12288
  v_cvt_pk_bf16_f32 v121, v122, v123
  v_mfma_f32_16x16x32_bf16 a[64:67], a[160:163], v[0:3], a[64:67]
  v_exp_f32 v100, v100
  v_mfma_f32_16x16x32_bf16 a[64:67], a[164:167], v[32:35], a[64:67]
  ds_read_b64_tr_b16 a[184:185], v223 offset:0
  v_mfma_f32_16x16x32_bf16 a[68:71], a[164:167], v[40:43], a[68:71]
  v_exp_f32 v101, v101
  v_mfma_f32_16x16x32_bf16 a[68:71], a[160:163], v[8:11], a[68:71]
  ds_read_b64_tr_b16 a[186:187], v223 offset:4096
  v_cvt_pk_bf16_f32 v98, v100, v101
  v_mfma_f32_16x16x32_bf16 a[72:75], a[160:163], v[16:19], a[72:75]
  v_exp_f32 v102, v102
  v_mfma_f32_16x16x32_bf16 a[72:75], a[164:167], v[48:51], a[72:75]
  ds_read_b64_tr_b16 a[188:189], v223 offset:8192
  v_mfma_f32_16x16x32_bf16 a[76:79], a[164:167], v[56:59], a[76:79]
  s_waitcnt lgkmcnt(7)
  v_exp_f32 v103, v103
  v_mfma_f32_16x16x32_bf16 a[76:79], a[160:163], v[24:27], a[76:79]
  ds_read_b64_tr_b16 a[190:191], v223 offset:12288
  v_cvt_pk_bf16_f32 v99, v102, v103
  v_mfma_f32_16x16x32_bf16 a[80:83], a[168:171], v[0:3], a[80:83]
  s_waitcnt vmcnt(11)
  v_exp_f32 v108, v108
  v_mfma_f32_16x16x32_bf16 a[80:83], a[172:175], v[32:35], a[80:83]
  v_mfma_f32_16x16x32_bf16 a[84:87], a[172:175], v[40:43], a[84:87]
  s_barrier
  v_exp_f32 v109, v109
  v_mfma_f32_16x16x32_bf16 a[84:87], a[168:171], v[8:11], a[84:87]
  ds_read_b128 a[128:131], v212 offset:32768
  v_cvt_pk_bf16_f32 v106, v108, v109
  v_mfma_f32_16x16x32_bf16 a[88:91], a[168:171], v[16:19], a[88:91]
  v_exp_f32 v110, v110
  v_mfma_f32_16x16x32_bf16 a[88:91], a[172:175], v[48:51], a[88:91]
  ds_read_b128 a[132:135], v213 offset:32768
  buffer_atomic_add v250, v249, s[24:27], s47 offen
  s_cmp_eq_u32 s32, 3
  s_cselect_b32 s39, 0, 1073741824
  v_mfma_f32_16x16x32_bf16 a[92:95], a[172:175], v[56:59], a[92:95]
  s_waitcnt lgkmcnt(6)
  v_exp_f32 v111, v111
  v_mfma_f32_16x16x32_bf16 a[92:95], a[168:171], v[24:27], a[92:95]
  ds_read_b128 a[136:139], v214 offset:32768
  v_cvt_pk_bf16_f32 v107, v110, v111
  v_mfma_f32_16x16x32_bf16 a[96:99], a[176:179], v[0:3], a[96:99]
  v_exp_f32 v116, v116
  v_mfma_f32_16x16x32_bf16 a[96:99], a[180:183], v[32:35], a[96:99]
  ds_read_b128 a[140:143], v215 offset:32768
  v_or_b32 v249, s39, v251
  v_mfma_f32_16x16x32_bf16 a[100:103], a[180:183], v[40:43], a[100:103]
  v_exp_f32 v117, v117
  v_mfma_f32_16x16x32_bf16 a[100:103], a[176:179], v[8:11], a[100:103]
  v_cvt_pk_bf16_f32 v114, v116, v117
  v_mfma_f32_16x16x32_bf16 a[104:107], a[176:179], v[16:19], a[104:107]
  v_exp_f32 v118, v118
  v_mfma_f32_16x16x32_bf16 a[104:107], a[180:183], v[48:51], a[104:107]
  v_mfma_f32_16x16x32_bf16 a[108:111], a[180:183], v[56:59], a[108:111]
  s_waitcnt lgkmcnt(4)
  v_exp_f32 v119, v119
  v_mfma_f32_16x16x32_bf16 a[108:111], a[176:179], v[24:27], a[108:111]
  v_cvt_pk_bf16_f32 v115, v118, v119
  v_mfma_f32_16x16x32_bf16 a[112:115], a[184:187], v[0:3], a[112:115]
  v_exp_f32 v124, v124
  v_mfma_f32_16x16x32_bf16 a[112:115], a[188:191], v[32:35], a[112:115]
  v_mfma_f32_16x16x32_bf16 a[116:119], a[188:191], v[40:43], a[116:119]
  v_exp_f32 v125, v125
  v_mfma_f32_16x16x32_bf16 a[116:119], a[184:187], v[8:11], a[116:119]
  v_cvt_pk_bf16_f32 v122, v124, v125
  v_mfma_f32_16x16x32_bf16 a[120:123], a[184:187], v[16:19], a[120:123]
  v_exp_f32 v126, v126
  v_mfma_f32_16x16x32_bf16 a[120:123], a[188:191], v[48:51], a[120:123]
  v_mfma_f32_16x16x32_bf16 a[124:127], a[188:191], v[56:59], a[124:127]
  s_waitcnt lgkmcnt(0)
  v_exp_f32 v127, v127
  v_mfma_f32_16x16x32_bf16 a[124:127], a[184:187], v[24:27], a[124:127]
  v_cvt_pk_bf16_f32 v123, v126, v127
  v_mfma_f32_16x16x32_bf16 v[0:3], a[128:131], v[128:131], v[192:195]
  s_add_u32 m0, s28, 114688
  v_mfma_f32_16x16x32_bf16 v[0:3], a[132:135], v[132:135], v[0:3]
  ds_read_b128 a[144:147], v212 offset:36864
  v_mfma_f32_16x16x32_bf16 v[0:3], a[136:139], v[136:139], v[0:3]
  buffer_load_dwordx4 v236, s[16:19], s29 offen offset:0 lds
  v_mfma_f32_16x16x32_bf16 v[0:3], a[140:143], v[140:143], v[0:3]
  ds_read_b128 a[148:151], v213 offset:36864
  v_mfma_f32_16x16x32_bf16 v[8:11], a[140:143], v[156:159], v[196:199]
  v_mfma_f32_16x16x32_bf16 v[8:11], a[136:139], v[152:155], v[8:11]
  ds_read_b128 a[152:155], v214 offset:36864
  v_mfma_f32_16x16x32_bf16 v[8:11], a[132:135], v[148:151], v[8:11]
  buffer_load_dwordx4 v237, s[16:19], s29 offen offset:1024 lds
  v_mfma_f32_16x16x32_bf16 v[8:11], a[128:131], v[144:147], v[8:11]
  ds_read_b128 a[156:159], v215 offset:36864
  v_mfma_f32_16x16x32_bf16 v[16:19], a[128:131], v[160:163], v[200:203]
  v_exp_f32 v0, v0
  v_mfma_f32_16x16x32_bf16 v[16:19], a[132:135], v[164:167], v[16:19]
  v_mfma_f32_16x16x32_bf16 v[16:19], a[136:139], v[168:171], v[16:19]
  v_exp_f32 v1, v1
  v_mfma_f32_16x16x32_bf16 v[16:19], a[140:143], v[172:175], v[16:19]
  v_cvt_pk_bf16_f32 v0, v0, v1
  v_mfma_f32_16x16x32_bf16 v[24:27], a[140:143], v[188:191], v[204:207]
  v_exp_f32 v2, v2
  v_mfma_f32_16x16x32_bf16 v[24:27], a[136:139], v[184:187], v[24:27]
  buffer_load_dwordx4 v236, s[16:19], s29 offen offset:2048 lds
  v_mfma_f32_16x16x32_bf16 v[24:27], a[132:135], v[180:183], v[24:27]
  s_waitcnt lgkmcnt(0)
  v_exp_f32 v3, v3
  v_mfma_f32_16x16x32_bf16 v[24:27], a[128:131], v[176:179], v[24:27]
  v_cvt_pk_bf16_f32 v1, v2, v3
  v_mfma_f32_16x16x32_bf16 v[4:7], a[144:147], v[128:131], v[192:195]
  v_exp_f32 v8, v8
  v_mfma_f32_16x16x32_bf16 v[4:7], a[148:151], v[132:135], v[4:7]
  ds_read_b128 a[128:131], v212 offset:40960
  v_mfma_f32_16x16x32_bf16 v[4:7], a[152:155], v[136:139], v[4:7]
  v_exp_f32 v9, v9
  v_mfma_f32_16x16x32_bf16 v[4:7], a[156:159], v[140:143], v[4:7]
  ds_read_b128 a[132:135], v213 offset:40960
  v_cvt_pk_bf16_f32 v8, v8, v9
  v_mfma_f32_16x16x32_bf16 v[12:15], a[156:159], v[156:159], v[196:199]
  v_exp_f32 v10, v10
  v_mfma_f32_16x16x32_bf16 v[12:15], a[152:155], v[152:155], v[12:15]
  ds_read_b128 a[136:139], v214 offset:40960
  v_mfma_f32_16x16x32_bf16 v[12:15], a[148:151], v[148:151], v[12:15]
  v_exp_f32 v11, v11
  v_mfma_f32_16x16x32_bf16 v[12:15], a[144:147], v[144:147], v[12:15]
  ds_read_b128 a[140:143], v215 offset:40960
  v_cvt_pk_bf16_f32 v9, v10, v11
  v_mfma_f32_16x16x32_bf16 v[20:23], a[144:147], v[160:163], v[200:203]
  v_exp_f32 v16, v16
  v_mfma_f32_16x16x32_bf16 v[20:23], a[148:151], v[164:167], v[20:23]
  buffer_load_dwordx4 v237, s[16:19], s29 offen offset:3072 lds
  v_mfma_f32_16x16x32_bf16 v[20:23], a[152:155], v[168:171], v[20:23]
  s_add_u32 s29, s29, 16384
  v_exp_f32 v17, v17
  v_mfma_f32_16x16x32_bf16 v[20:23], a[156:159], v[172:175], v[20:23]
  v_cvt_pk_bf16_f32 v16, v16, v17
  v_mfma_f32_16x16x32_bf16 v[28:31], a[156:159], v[188:191], v[204:207]
  s_add_u32 m0, s28, 0
  v_exp_f32 v18, v18
  v_mfma_f32_16x16x32_bf16 v[28:31], a[152:155], v[184:187], v[28:31]
  buffer_load_dwordx4 v232, s[12:15], s29 offen offset:0 lds
  v_mfma_f32_16x16x32_bf16 v[28:31], a[148:151], v[180:183], v[28:31]
  s_waitcnt lgkmcnt(0)
  v_exp_f32 v19, v19
  v_mfma_f32_16x16x32_bf16 v[28:31], a[144:147], v[176:179], v[28:31]
  v_cvt_pk_bf16_f32 v17, v18, v19
  v_mfma_f32_16x16x32_bf16 v[32:35], a[128:131], v[128:131], v[192:195]
  v_exp_f32 v24, v24
  v_mfma_f32_16x16x32_bf16 v[32:35], a[132:135], v[132:135], v[32:35]
  ds_read_b128 a[144:147], v212 offset:45056
  v_mfma_f32_16x16x32_bf16 v[32:35], a[136:139], v[136:139], v[32:35]
  v_exp_f32 v25, v25
  v_mfma_f32_16x16x32_bf16 v[32:35], a[140:143], v[140:143], v[32:35]
  ds_read_b128 a[148:151], v213 offset:45056
  v_cvt_pk_bf16_f32 v24, v24, v25
  v_mfma_f32_16x16x32_bf16 v[40:43], a[140:143], v[156:159], v[196:199]
  v_exp_f32 v26, v26
  v_mfma_f32_16x16x32_bf16 v[40:43], a[136:139], v[152:155], v[40:43]
  ds_read_b128 a[152:155], v214 offset:45056
  v_mfma_f32_16x16x32_bf16 v[40:43], a[132:135], v[148:151], v[40:43]
  v_exp_f32 v27, v27
  v_mfma_f32_16x16x32_bf16 v[40:43], a[128:131], v[144:147], v[40:43]
  ds_read_b128 a[156:159], v215 offset:45056
  v_cvt_pk_bf16_f32 v25, v26, v27
  v_mfma_f32_16x16x32_bf16 v[48:51], a[128:131], v[160:163], v[200:203]
  v_exp_f32 v4, v4
  v_mfma_f32_16x16x32_bf16 v[48:51], a[132:135], v[164:167], v[48:51]
  buffer_load_dwordx4 v233, s[12:15], s29 offen offset:1024 lds
  v_mfma_f32_16x16x32_bf16 v[48:51], a[136:139], v[168:171], v[48:51]
  v_exp_f32 v5, v5
  v_mfma_f32_16x16x32_bf16 v[48:51], a[140:143], v[172:175], v[48:51]
  v_cvt_pk_bf16_f32 v2, v4, v5
  v_mfma_f32_16x16x32_bf16 v[56:59], a[140:143], v[188:191], v[204:207]
  v_exp_f32 v6, v6
  v_mfma_f32_16x16x32_bf16 v[56:59], a[136:139], v[184:187], v[56:59]
  buffer_load_dwordx4 v234, s[12:15], s29 offen offset:2048 lds
  v_mfma_f32_16x16x32_bf16 v[56:59], a[132:135], v[180:183], v[56:59]
  s_waitcnt lgkmcnt(0)
  v_exp_f32 v7, v7
  v_mfma_f32_16x16x32_bf16 v[56:59], a[128:131], v[176:179], v[56:59]
  v_cvt_pk_bf16_f32 v3, v6, v7
  v_mfma_f32_16x16x32_bf16 v[36:39], a[144:147], v[128:131], v[192:195]
  v_exp_f32 v12, v12
  v_mfma_f32_16x16x32_bf16 v[36:39], a[148:151], v[132:135], v[36:39]
  ds_read_b64_tr_b16 a[160:161], v216 offset:16384
  v_mfma_f32_16x16x32_bf16 v[36:39], a[152:155], v[136:139], v[36:39]
  v_exp_f32 v13, v13
  v_mfma_f32_16x16x32_bf16 v[36:39], a[156:159], v[140:143], v[36:39]
  ds_read_b64_tr_b16 a[162:163], v216 offset:20480
  v_cvt_pk_bf16_f32 v10, v12, v13
  v_mfma_f32_16x16x32_bf16 v[44:47], a[156:159], v[156:159], v[196:199]
  v_exp_f32 v14, v14
  v_mfma_f32_16x16x32_bf16 v[44:47], a[152:155], v[152:155], v[44:47]
  ds_read_b64_tr_b16 a[164:165], v216 offset:24576
  buffer_load_dwordx4 v235, s[12:15], s29 offen offset:3072 lds
  v_mfma_f32_16x16x32_bf16 v[44:47], a[148:151], v[148:151], v[44:47]
  v_exp_f32 v15, v15
  v_mfma_f32_16x16x32_bf16 v[44:47], a[144:147], v[144:147], v[44:47]
  ds_read_b64_tr_b16 a[166:167], v216 offset:28672
  v_cvt_pk_bf16_f32 v11, v14, v15
  v_mfma_f32_16x16x32_bf16 v[52:55], a[144:147], v[160:163], v[200:203]
  s_mov_b32 m0, s51
  v_exp_f32 v20, v20
  v_mfma_f32_16x16x32_bf16 v[52:55], a[148:151], v[164:167], v[52:55]
  ds_read_b64_tr_b16 a[168:169], v217 offset:16384
  buffer_load_dwordx4 v210, s[4:7], s100 offen lds
  s_add_u32 s100, s100, 20480
  s_add_u32 s51, s51, 512
  v_mfma_f32_16x16x32_bf16 v[52:55], a[152:155], v[168:171], v[52:55]
  v_exp_f32 v21, v21
  v_mfma_f32_16x16x32_bf16 v[52:55], a[156:159], v[172:175], v[52:55]
  ds_read_b64_tr_b16 a[170:171], v217 offset:20480
  v_cvt_pk_bf16_f32 v18, v20, v21
  v_mfma_f32_16x16x32_bf16 v[60:63], a[156:159], v[188:191], v[204:207]
  s_waitcnt vmcnt(20)
  v_exp_f32 v22, v22
  v_mfma_f32_16x16x32_bf16 v[60:63], a[152:155], v[184:187], v[60:63]
  ds_read_b64_tr_b16 a[172:173], v217 offset:24576
  ds_read_b64_tr_b16 a[232:233], v209 offset:4096
  v_mfma_f32_16x16x32_bf16 v[60:63], a[148:151], v[180:183], v[60:63]
  v_exp_f32 v23, v23
  v_mfma_f32_16x16x32_bf16 v[60:63], a[144:147], v[176:179], v[60:63]
  ds_read_b64_tr_b16 a[174:175], v217 offset:28672
  v_cvt_pk_bf16_f32 v19, v22, v23
  v_mfma_f32_16x16x32_bf16 a[192:195], a[208:211], v[64:67], a[192:195]
  v_exp_f32 v28, v28
  v_mfma_f32_16x16x32_bf16 a[192:195], a[208:211], v[96:99], a[192:195]
  ds_read_b64_tr_b16 a[176:177], v218 offset:16384
  ds_read_b64_tr_b16 a[234:235], v209 offset:4608
  v_mfma_f32_16x16x32_bf16 a[196:199], a[208:211], v[72:75], a[196:199]
  v_exp_f32 v29, v29
  v_mfma_f32_16x16x32_bf16 a[196:199], a[208:211], v[104:107], a[196:199]
  ds_read_b64_tr_b16 a[178:179], v218 offset:20480
  v_cvt_pk_bf16_f32 v26, v28, v29
  v_mfma_f32_16x16x32_bf16 a[200:203], a[208:211], v[80:83], a[200:203]
  v_exp_f32 v30, v30
  v_mfma_f32_16x16x32_bf16 a[200:203], a[208:211], v[112:115], a[200:203]
  ds_read_b64_tr_b16 a[180:181], v218 offset:24576
  v_mfma_f32_16x16x32_bf16 a[204:207], a[208:211], v[88:91], a[204:207]
  s_waitcnt lgkmcnt(9)
  v_exp_f32 v31, v31
  v_mfma_f32_16x16x32_bf16 a[204:207], a[208:211], v[120:123], a[204:207]
  ds_read_b64_tr_b16 a[182:183], v218 offset:28672
  v_cvt_pk_bf16_f32 v27, v30, v31
  v_mfma_f32_16x16x32_bf16 a[0:3], a[160:163], v[64:67], a[0:3]
  v_exp_f32 v32, v32
  v_mfma_f32_16x16x32_bf16 a[0:3], a[164:167], v[96:99], a[0:3]
  ds_read_b64_tr_b16 a[184:185], v219 offset:16384
  s_waitcnt lgkmcnt(4)
  buffer_store_dwordx4 a[232:235], v211, s[24:27], s31 offen sc1
  s_add_u32 s31, s31, 1024
  s_cmp_gt_u32 s32, 3
  v_mfma_f32_16x16x32_bf16 a[4:7], a[164:167], v[104:107], a[4:7]
  s_cselect_b32 s39, 0, 1073741824
  v_exp_f32 v33, v33
  v_mfma_f32_16x16x32_bf16 a[4:7], a[160:163], v[72:75], a[4:7]
  ds_read_b64_tr_b16 a[186:187], v219 offset:20480
  v_cvt_pk_bf16_f32 v32, v32, v33
  v_mfma_f32_16x16x32_bf16 a[8:11], a[160:163], v[80:83], a[8:11]
  v_exp_f32 v34, v34
  v_mfma_f32_16x16x32_bf16 a[8:11], a[164:167], v[112:115], a[8:11]
  ds_read_b64_tr_b16 a[188:189], v219 offset:24576
  v_or_b32 v211, s39, v211
  v_mfma_f32_16x16x32_bf16 a[12:15], a[164:167], v[120:123], a[12:15]
  v_exp_f32 v35, v35
  v_mfma_f32_16x16x32_bf16 a[12:15], a[160:163], v[88:91], a[12:15]
  ds_read_b64_tr_b16 a[190:191], v219 offset:28672
  v_cvt_pk_bf16_f32 v33, v34, v35
  v_mfma_f32_16x16x32_bf16 a[16:19], a[168:171], v[64:67], a[16:19]
  v_exp_f32 v40, v40
  v_mfma_f32_16x16x32_bf16 a[16:19], a[172:175], v[96:99], a[16:19]
  ds_read_b64_tr_b16 a[160:161], v220 offset:16384
  v_or_b32 v208, s39, v208
  v_mfma_f32_16x16x32_bf16 a[20:23], a[172:175], v[104:107], a[20:23]
  v_exp_f32 v41, v41
  v_mfma_f32_16x16x32_bf16 a[20:23], a[168:171], v[72:75], a[20:23]
  ds_read_b64_tr_b16 a[162:163], v220 offset:20480
  v_cvt_pk_bf16_f32 v40, v40, v41
  v_mfma_f32_16x16x32_bf16 a[24:27], a[168:171], v[80:83], a[24:27]
  v_exp_f32 v42, v42
  v_mfma_f32_16x16x32_bf16 a[24:27], a[172:175], v[112:115], a[24:27]
  ds_read_b64_tr_b16 a[164:165], v220 offset:24576
  v_mfma_f32_16x16x32_bf16 a[28:31], a[172:175], v[120:123], a[28:31]
  s_waitcnt lgkmcnt(7)
  v_exp_f32 v43, v43
  v_mfma_f32_16x16x32_bf16 a[28:31], a[168:171], v[88:91], a[28:31]
  ds_read_b64_tr_b16 a[166:167], v220 offset:28672
  v_cvt_pk_bf16_f32 v41, v42, v43
  v_mfma_f32_16x16x32_bf16 a[32:35], a[176:179], v[64:67], a[32:35]
  v_exp_f32 v48, v48
  v_mfma_f32_16x16x32_bf16 a[32:35], a[180:183], v[96:99], a[32:35]
  ds_read_b64_tr_b16 a[168:169], v221 offset:16384
  v_mfma_f32_16x16x32_bf16 a[36:39], a[180:183], v[104:107], a[36:39]
  v_exp_f32 v49, v49
  v_mfma_f32_16x16x32_bf16 a[36:39], a[176:179], v[72:75], a[36:39]
  ds_read_b64_tr_b16 a[170:171], v221 offset:20480
  v_cvt_pk_bf16_f32 v48, v48, v49
  v_mfma_f32_16x16x32_bf16 a[40:43], a[176:179], v[80:83], a[40:43]
  v_exp_f32 v50, v50
  v_mfma_f32_16x16x32_bf16 a[40:43], a[180:183], v[112:115], a[40:43]
  ds_read_b64_tr_b16 a[172:173], v221 offset:24576
  v_mfma_f32_16x16x32_bf16 a[44:47], a[180:183], v[120:123], a[44:47]
  s_waitcnt lgkmcnt(7)
  v_exp_f32 v51, v51
  v_mfma_f32_16x16x32_bf16 a[44:47], a[176:179], v[88:91], a[44:47]
  ds_read_b64_tr_b16 a[174:175], v221 offset:28672
  v_cvt_pk_bf16_f32 v49, v50, v51
  v_mfma_f32_16x16x32_bf16 a[48:51], a[184:187], v[64:67], a[48:51]
  v_exp_f32 v56, v56
  v_mfma_f32_16x16x32_bf16 a[48:51], a[188:191], v[96:99], a[48:51]
  ds_read_b64_tr_b16 a[176:177], v222 offset:16384
  v_mfma_f32_16x16x32_bf16 a[52:55], a[188:191], v[104:107], a[52:55]
  v_exp_f32 v57, v57
  v_mfma_f32_16x16x32_bf16 a[52:55], a[184:187], v[72:75], a[52:55]
  ds_read_b64_tr_b16 a[178:179], v222 offset:20480
  v_cvt_pk_bf16_f32 v56, v56, v57
  v_mfma_f32_16x16x32_bf16 a[56:59], a[184:187], v[80:83], a[56:59]
  v_exp_f32 v58, v58
  v_mfma_f32_16x16x32_bf16 a[56:59], a[188:191], v[112:115], a[56:59]
  ds_read_b64_tr_b16 a[180:181], v222 offset:24576
  v_mfma_f32_16x16x32_bf16 a[60:63], a[188:191], v[120:123], a[60:63]
  s_waitcnt lgkmcnt(7)
  v_exp_f32 v59, v59
  v_mfma_f32_16x16x32_bf16 a[60:63], a[184:187], v[88:91], a[60:63]
  ds_read_b64_tr_b16 a[182:183], v222 offset:28672
  v_cvt_pk_bf16_f32 v57, v58, v59
  v_mfma_f32_16x16x32_bf16 a[64:67], a[160:163], v[64:67], a[64:67]
  v_exp_f32 v36, v36
  v_mfma_f32_16x16x32_bf16 a[64:67], a[164:167], v[96:99], a[64:67]
  ds_read_b64_tr_b16 a[184:185], v223 offset:16384
  v_mfma_f32_16x16x32_bf16 a[68:71], a[164:167], v[104:107], a[68:71]
  v_exp_f32 v37, v37
  v_mfma_f32_16x16x32_bf16 a[68:71], a[160:163], v[72:75], a[68:71]
  ds_read_b64_tr_b16 a[186:187], v223 offset:20480
  v_cvt_pk_bf16_f32 v34, v36, v37
  v_mfma_f32_16x16x32_bf16 a[72:75], a[160:163], v[80:83], a[72:75]
  v_exp_f32 v38, v38
  v_mfma_f32_16x16x32_bf16 a[72:75], a[164:167], v[112:115], a[72:75]
  ds_read_b64_tr_b16 a[188:189], v223 offset:24576
  v_mfma_f32_16x16x32_bf16 a[76:79], a[164:167], v[120:123], a[76:79]
  s_waitcnt lgkmcnt(7)
  v_exp_f32 v39, v39
  v_mfma_f32_16x16x32_bf16 a[76:79], a[160:163], v[88:91], a[76:79]
  ds_read_b64_tr_b16 a[190:191], v223 offset:28672
  v_cvt_pk_bf16_f32 v35, v38, v39
  v_mfma_f32_16x16x32_bf16 a[80:83], a[168:171], v[64:67], a[80:83]
  s_waitcnt vmcnt(12)
  v_exp_f32 v44, v44
  v_mfma_f32_16x16x32_bf16 a[80:83], a[172:175], v[96:99], a[80:83]
  v_mfma_f32_16x16x32_bf16 a[84:87], a[172:175], v[104:107], a[84:87]
  s_barrier
  v_exp_f32 v45, v45
  v_mfma_f32_16x16x32_bf16 a[84:87], a[168:171], v[72:75], a[84:87]
  ds_read_b128 a[128:131], v212 offset:49152
  v_cvt_pk_bf16_f32 v42, v44, v45
  v_mfma_f32_16x16x32_bf16 a[88:91], a[168:171], v[80:83], a[88:91]
  v_exp_f32 v46, v46
  v_mfma_f32_16x16x32_bf16 a[88:91], a[172:175], v[112:115], a[88:91]
  ds_read_b128 a[132:135], v213 offset:49152
  v_mfma_f32_16x16x32_bf16 a[92:95], a[172:175], v[120:123], a[92:95]
  s_waitcnt lgkmcnt(6)
  v_exp_f32 v47, v47
  v_mfma_f32_16x16x32_bf16 a[92:95], a[168:171], v[88:91], a[92:95]
  ds_read_b128 a[136:139], v214 offset:49152
  v_cvt_pk_bf16_f32 v43, v46, v47
  v_mfma_f32_16x16x32_bf16 a[96:99], a[176:179], v[64:67], a[96:99]
  v_exp_f32 v52, v52
  v_mfma_f32_16x16x32_bf16 a[96:99], a[180:183], v[96:99], a[96:99]
  ds_read_b128 a[140:143], v215 offset:49152
  v_mfma_f32_16x16x32_bf16 a[100:103], a[180:183], v[104:107], a[100:103]
  v_exp_f32 v53, v53
  v_mfma_f32_16x16x32_bf16 a[100:103], a[176:179], v[72:75], a[100:103]
  v_cvt_pk_bf16_f32 v50, v52, v53
  v_mfma_f32_16x16x32_bf16 a[104:107], a[176:179], v[80:83], a[104:107]
  v_exp_f32 v54, v54
  v_mfma_f32_16x16x32_bf16 a[104:107], a[180:183], v[112:115], a[104:107]
  v_mfma_f32_16x16x32_bf16 a[108:111], a[180:183], v[120:123], a[108:111]
  s_waitcnt lgkmcnt(4)
  v_exp_f32 v55, v55
  v_mfma_f32_16x16x32_bf16 a[108:111], a[176:179], v[88:91], a[108:111]
  v_cvt_pk_bf16_f32 v51, v54, v55
  v_mfma_f32_16x16x32_bf16 a[112:115], a[184:187], v[64:67], a[112:115]
  v_exp_f32 v60, v60
  v_mfma_f32_16x16x32_bf16 a[112:115], a[188:191], v[96:99], a[112:115]
  v_mfma_f32_16x16x32_bf16 a[116:119], a[188:191], v[104:107], a[116:119]
  v_exp_f32 v61, v61
  v_mfma_f32_16x16x32_bf16 a[116:119], a[184:187], v[72:75], a[116:119]
  v_cvt_pk_bf16_f32 v58, v60, v61
  v_mfma_f32_16x16x32_bf16 a[120:123], a[184:187], v[80:83], a[120:123]
  v_exp_f32 v62, v62
  v_mfma_f32_16x16x32_bf16 a[120:123], a[188:191], v[112:115], a[120:123]
  v_mfma_f32_16x16x32_bf16 a[124:127], a[188:191], v[120:123], a[124:127]
  s_waitcnt lgkmcnt(0)
  v_exp_f32 v63, v63
  v_mfma_f32_16x16x32_bf16 a[124:127], a[184:187], v[88:91], a[124:127]
  v_cvt_pk_bf16_f32 v59, v62, v63
  v_mfma_f32_16x16x32_bf16 v[64:67], a[128:131], v[128:131], v[192:195]
  s_add_u32 m0, s28, 65536
  v_mfma_f32_16x16x32_bf16 v[64:67], a[132:135], v[132:135], v[64:67]
  ds_read_b128 a[144:147], v212 offset:53248
  v_mfma_f32_16x16x32_bf16 v[64:67], a[136:139], v[136:139], v[64:67]
  buffer_load_dwordx4 v236, s[16:19], s29 offen offset:0 lds
  v_mfma_f32_16x16x32_bf16 v[64:67], a[140:143], v[140:143], v[64:67]
  ds_read_b128 a[148:151], v213 offset:53248
  v_mfma_f32_16x16x32_bf16 v[72:75], a[140:143], v[156:159], v[196:199]
  v_mfma_f32_16x16x32_bf16 v[72:75], a[136:139], v[152:155], v[72:75]
  ds_read_b128 a[152:155], v214 offset:53248
  v_mfma_f32_16x16x32_bf16 v[72:75], a[132:135], v[148:151], v[72:75]
  buffer_load_dwordx4 v237, s[16:19], s29 offen offset:1024 lds
  v_mfma_f32_16x16x32_bf16 v[72:75], a[128:131], v[144:147], v[72:75]
  ds_read_b128 a[156:159], v215 offset:53248
  v_mfma_f32_16x16x32_bf16 v[80:83], a[128:131], v[160:163], v[200:203]
  v_exp_f32 v64, v64
  v_mfma_f32_16x16x32_bf16 v[80:83], a[132:135], v[164:167], v[80:83]
  v_mfma_f32_16x16x32_bf16 v[80:83], a[136:139], v[168:171], v[80:83]
  v_exp_f32 v65, v65
  v_mfma_f32_16x16x32_bf16 v[80:83], a[140:143], v[172:175], v[80:83]
  v_cvt_pk_bf16_f32 v64, v64, v65
  v_mfma_f32_16x16x32_bf16 v[88:91], a[140:143], v[188:191], v[204:207]
  v_exp_f32 v66, v66
  v_mfma_f32_16x16x32_bf16 v[88:91], a[136:139], v[184:187], v[88:91]
  buffer_load_dwordx4 v236, s[16:19], s29 offen offset:2048 lds
  v_mfma_f32_16x16x32_bf16 v[88:91], a[132:135], v[180:183], v[88:91]
  s_waitcnt lgkmcnt(0)
  v_exp_f32 v67, v67
  v_mfma_f32_16x16x32_bf16 v[88:91], a[128:131], v[176:179], v[88:91]
  v_cvt_pk_bf16_f32 v65, v66, v67
  v_mfma_f32_16x16x32_bf16 v[68:71], a[144:147], v[128:131], v[192:195]
  v_exp_f32 v72, v72
  v_mfma_f32_16x16x32_bf16 v[68:71], a[148:151], v[132:135], v[68:71]
  ds_read_b128 a[128:131], v212 offset:57344
  v_mfma_f32_16x16x32_bf16 v[68:71], a[152:155], v[136:139], v[68:71]
  v_exp_f32 v73, v73
  v_mfma_f32_16x16x32_bf16 v[68:71], a[156:159], v[140:143], v[68:71]
  ds_read_b128 a[132:135], v213 offset:57344
  v_cvt_pk_bf16_f32 v72, v72, v73
  v_mfma_f32_16x16x32_bf16 v[76:79], a[156:159], v[156:159], v[196:199]
  v_exp_f32 v74, v74
  v_mfma_f32_16x16x32_bf16 v[76:79], a[152:155], v[152:155], v[76:79]
  ds_read_b128 a[136:139], v214 offset:57344
  v_mfma_f32_16x16x32_bf16 v[76:79], a[148:151], v[148:151], v[76:79]
  v_exp_f32 v75, v75
  v_mfma_f32_16x16x32_bf16 v[76:79], a[144:147], v[144:147], v[76:79]
  ds_read_b128 a[140:143], v215 offset:57344
  v_cvt_pk_bf16_f32 v73, v74, v75
  v_mfma_f32_16x16x32_bf16 v[84:87], a[144:147], v[160:163], v[200:203]
  v_exp_f32 v80, v80
  v_mfma_f32_16x16x32_bf16 v[84:87], a[148:151], v[164:167], v[84:87]
  buffer_load_dwordx4 v237, s[16:19], s29 offen offset:3072 lds
  v_mfma_f32_16x16x32_bf16 v[84:87], a[152:155], v[168:171], v[84:87]
  s_add_u32 s29, s29, 16384
  v_exp_f32 v81, v81
  v_mfma_f32_16x16x32_bf16 v[84:87], a[156:159], v[172:175], v[84:87]
  v_cvt_pk_bf16_f32 v80, v80, v81
  v_mfma_f32_16x16x32_bf16 v[92:95], a[156:159], v[188:191], v[204:207]
  s_add_u32 m0, s28, 16384
  v_exp_f32 v82, v82
  v_mfma_f32_16x16x32_bf16 v[92:95], a[152:155], v[184:187], v[92:95]
  buffer_load_dwordx4 v232, s[12:15], s29 offen offset:0 lds
  v_mfma_f32_16x16x32_bf16 v[92:95], a[148:151], v[180:183], v[92:95]
  s_waitcnt lgkmcnt(0)
  v_exp_f32 v83, v83
  v_mfma_f32_16x16x32_bf16 v[92:95], a[144:147], v[176:179], v[92:95]
  v_cvt_pk_bf16_f32 v81, v82, v83
  v_mfma_f32_16x16x32_bf16 v[96:99], a[128:131], v[128:131], v[192:195]
  v_exp_f32 v88, v88
  v_mfma_f32_16x16x32_bf16 v[96:99], a[132:135], v[132:135], v[96:99]
  ds_read_b128 a[144:147], v212 offset:61440
  v_mfma_f32_16x16x32_bf16 v[96:99], a[136:139], v[136:139], v[96:99]
  v_exp_f32 v89, v89
  v_mfma_f32_16x16x32_bf16 v[96:99], a[140:143], v[140:143], v[96:99]
  ds_read_b128 a[148:151], v213 offset:61440
  v_cvt_pk_bf16_f32 v88, v88, v89
  v_mfma_f32_16x16x32_bf16 v[104:107], a[140:143], v[156:159], v[196:199]
  v_exp_f32 v90, v90
  v_mfma_f32_16x16x32_bf16 v[104:107], a[136:139], v[152:155], v[104:107]
  ds_read_b128 a[152:155], v214 offset:61440
  v_mfma_f32_16x16x32_bf16 v[104:107], a[132:135], v[148:151], v[104:107]
  v_exp_f32 v91, v91
  v_mfma_f32_16x16x32_bf16 v[104:107], a[128:131], v[144:147], v[104:107]
  ds_read_b128 a[156:159], v215 offset:61440
  v_cvt_pk_bf16_f32 v89, v90, v91
  v_mfma_f32_16x16x32_bf16 v[112:115], a[128:131], v[160:163], v[200:203]
  v_exp_f32 v68, v68
  v_mfma_f32_16x16x32_bf16 v[112:115], a[132:135], v[164:167], v[112:115]
  buffer_load_dwordx4 v233, s[12:15], s29 offen offset:1024 lds
  v_mfma_f32_16x16x32_bf16 v[112:115], a[136:139], v[168:171], v[112:115]
  v_exp_f32 v69, v69
  v_mfma_f32_16x16x32_bf16 v[112:115], a[140:143], v[172:175], v[112:115]
  v_cvt_pk_bf16_f32 v66, v68, v69
  v_mfma_f32_16x16x32_bf16 v[120:123], a[140:143], v[188:191], v[204:207]
  v_exp_f32 v70, v70
  v_mfma_f32_16x16x32_bf16 v[120:123], a[136:139], v[184:187], v[120:123]
  buffer_load_dwordx4 v234, s[12:15], s29 offen offset:2048 lds
  v_mfma_f32_16x16x32_bf16 v[120:123], a[132:135], v[180:183], v[120:123]
  s_waitcnt lgkmcnt(0)
  v_exp_f32 v71, v71
  v_mfma_f32_16x16x32_bf16 v[120:123], a[128:131], v[176:179], v[120:123]
  v_cvt_pk_bf16_f32 v67, v70, v71
  v_mfma_f32_16x16x32_bf16 v[100:103], a[144:147], v[128:131], v[192:195]
  v_exp_f32 v76, v76
  v_mfma_f32_16x16x32_bf16 v[100:103], a[148:151], v[132:135], v[100:103]
  ds_read_b64_tr_b16 a[160:161], v216 offset:32768
  v_mfma_f32_16x16x32_bf16 v[100:103], a[152:155], v[136:139], v[100:103]
  v_exp_f32 v77, v77
  v_mfma_f32_16x16x32_bf16 v[100:103], a[156:159], v[140:143], v[100:103]
  ds_read_b64_tr_b16 a[162:163], v216 offset:36864
  v_cvt_pk_bf16_f32 v74, v76, v77
  v_mfma_f32_16x16x32_bf16 v[108:111], a[156:159], v[156:159], v[196:199]
  v_exp_f32 v78, v78
  v_mfma_f32_16x16x32_bf16 v[108:111], a[152:155], v[152:155], v[108:111]
  ds_read_b64_tr_b16 a[164:165], v216 offset:40960
  buffer_load_dwordx4 v235, s[12:15], s29 offen offset:3072 lds
  v_mfma_f32_16x16x32_bf16 v[108:111], a[148:151], v[148:151], v[108:111]
  v_exp_f32 v79, v79
  v_mfma_f32_16x16x32_bf16 v[108:111], a[144:147], v[144:147], v[108:111]
  ds_read_b64_tr_b16 a[166:167], v216 offset:45056
  v_cvt_pk_bf16_f32 v75, v78, v79
  v_mfma_f32_16x16x32_bf16 v[116:119], a[144:147], v[160:163], v[200:203]
  v_exp_f32 v84, v84
  v_mfma_f32_16x16x32_bf16 v[116:119], a[148:151], v[164:167], v[116:119]
  ds_read_b64_tr_b16 a[168:169], v217 offset:32768
  buffer_load_dword v254, off, s[24:27], s47 sc1
  v_mfma_f32_16x16x32_bf16 v[116:119], a[152:155], v[168:171], v[116:119]
  v_exp_f32 v85, v85
  v_mfma_f32_16x16x32_bf16 v[116:119], a[156:159], v[172:175], v[116:119]
  ds_read_b64_tr_b16 a[170:171], v217 offset:36864
  v_cvt_pk_bf16_f32 v82, v84, v85
  v_mfma_f32_16x16x32_bf16 v[124:127], a[156:159], v[188:191], v[204:207]
  s_waitcnt vmcnt(20)
  v_exp_f32 v86, v86
  v_mfma_f32_16x16x32_bf16 v[124:127], a[152:155], v[184:187], v[124:127]
  ds_read_b64_tr_b16 a[172:173], v217 offset:40960
  ds_read_b64_tr_b16 a[232:233], v209 offset:5120
  v_mfma_f32_16x16x32_bf16 v[124:127], a[148:151], v[180:183], v[124:127]
  v_exp_f32 v87, v87
  v_mfma_f32_16x16x32_bf16 v[124:127], a[144:147], v[176:179], v[124:127]
  ds_read_b64_tr_b16 a[174:175], v217 offset:45056
  v_cvt_pk_bf16_f32 v83, v86, v87
  v_mfma_f32_16x16x32_bf16 a[192:195], a[208:211], v[0:3], a[192:195]
  v_exp_f32 v92, v92
  v_mfma_f32_16x16x32_bf16 a[192:195], a[208:211], v[32:35], a[192:195]
  ds_read_b64_tr_b16 a[176:177], v218 offset:32768
  ds_read_b64_tr_b16 a[234:235], v209 offset:5632
  v_mfma_f32_16x16x32_bf16 a[196:199], a[208:211], v[8:11], a[196:199]
  v_exp_f32 v93, v93
  v_mfma_f32_16x16x32_bf16 a[196:199], a[208:211], v[40:43], a[196:199]
  ds_read_b64_tr_b16 a[178:179], v218 offset:36864
  v_cvt_pk_bf16_f32 v90, v92, v93
  v_mfma_f32_16x16x32_bf16 a[200:203], a[208:211], v[16:19], a[200:203]
  v_exp_f32 v94, v94
  v_mfma_f32_16x16x32_bf16 a[200:203], a[208:211], v[48:51], a[200:203]
  ds_read_b64_tr_b16 a[180:181], v218 offset:40960
  v_mfma_f32_16x16x32_bf16 a[204:207], a[208:211], v[24:27], a[204:207]
  s_waitcnt lgkmcnt(9)
  v_exp_f32 v95, v95
  v_mfma_f32_16x16x32_bf16 a[204:207], a[208:211], v[56:59], a[204:207]
  ds_read_b64_tr_b16 a[182:183], v218 offset:45056
  v_cvt_pk_bf16_f32 v91, v94, v95
  v_mfma_f32_16x16x32_bf16 a[0:3], a[160:163], v[0:3], a[0:3]
  v_exp_f32 v96, v96
  v_mfma_f32_16x16x32_bf16 a[0:3], a[164:167], v[32:35], a[0:3]
  ds_read_b64_tr_b16 a[184:185], v219 offset:32768
  s_waitcnt lgkmcnt(4)
  buffer_store_dwordx4 a[232:235], v211, s[24:27], s31 offen sc1
  s_add_u32 s31, s31, 1024
  v_mfma_f32_16x16x32_bf16 a[4:7], a[164:167], v[40:43], a[4:7]
  v_exp_f32 v97, v97
  v_mfma_f32_16x16x32_bf16 a[4:7], a[160:163], v[8:11], a[4:7]
  ds_read_b64_tr_b16 a[186:187], v219 offset:36864
  v_cvt_pk_bf16_f32 v96, v96, v97
  v_mfma_f32_16x16x32_bf16 a[8:11], a[160:163], v[16:19], a[8:11]
  v_exp_f32 v98, v98
  v_mfma_f32_16x16x32_bf16 a[8:11], a[164:167], v[48:51], a[8:11]
  ds_read_b64_tr_b16 a[188:189], v219 offset:40960
  v_mfma_f32_16x16x32_bf16 a[12:15], a[164:167], v[56:59], a[12:15]
  v_exp_f32 v99, v99
  v_mfma_f32_16x16x32_bf16 a[12:15], a[160:163], v[24:27], a[12:15]
  ds_read_b64_tr_b16 a[190:191], v219 offset:45056
  v_cvt_pk_bf16_f32 v97, v98, v99
  v_mfma_f32_16x16x32_bf16 a[16:19], a[168:171], v[0:3], a[16:19]
  v_exp_f32 v104, v104
  v_mfma_f32_16x16x32_bf16 a[16:19], a[172:175], v[32:35], a[16:19]
  ds_read_b64_tr_b16 a[160:161], v220 offset:32768
  v_mfma_f32_16x16x32_bf16 a[20:23], a[172:175], v[40:43], a[20:23]
  v_exp_f32 v105, v105
  v_mfma_f32_16x16x32_bf16 a[20:23], a[168:171], v[8:11], a[20:23]
  ds_read_b64_tr_b16 a[162:163], v220 offset:36864
  v_cvt_pk_bf16_f32 v104, v104, v105
  v_mfma_f32_16x16x32_bf16 a[24:27], a[168:171], v[16:19], a[24:27]
  v_exp_f32 v106, v106
  v_mfma_f32_16x16x32_bf16 a[24:27], a[172:175], v[48:51], a[24:27]
  ds_read_b64_tr_b16 a[164:165], v220 offset:40960
  v_mfma_f32_16x16x32_bf16 a[28:31], a[172:175], v[56:59], a[28:31]
  s_waitcnt lgkmcnt(7)
  v_exp_f32 v107, v107
  v_mfma_f32_16x16x32_bf16 a[28:31], a[168:171], v[24:27], a[28:31]
  ds_read_b64_tr_b16 a[166:167], v220 offset:45056
  v_cvt_pk_bf16_f32 v105, v106, v107
  v_mfma_f32_16x16x32_bf16 a[32:35], a[176:179], v[0:3], a[32:35]
  v_exp_f32 v112, v112
  v_mfma_f32_16x16x32_bf16 a[32:35], a[180:183], v[32:35], a[32:35]
  ds_read_b64_tr_b16 a[168:169], v221 offset:32768
  v_mfma_f32_16x16x32_bf16 a[36:39], a[180:183], v[40:43], a[36:39]
  v_exp_f32 v113, v113
  v_mfma_f32_16x16x32_bf16 a[36:39], a[176:179], v[8:11], a[36:39]
  ds_read_b64_tr_b16 a[170:171], v221 offset:36864
  v_cvt_pk_bf16_f32 v112, v112, v113
  v_mfma_f32_16x16x32_bf16 a[40:43], a[176:179], v[16:19], a[40:43]
  v_exp_f32 v114, v114
  v_mfma_f32_16x16x32_bf16 a[40:43], a[180:183], v[48:51], a[40:43]
  ds_read_b64_tr_b16 a[172:173], v221 offset:40960
  v_mfma_f32_16x16x32_bf16 a[44:47], a[180:183], v[56:59], a[44:47]
  s_waitcnt lgkmcnt(7)
  v_exp_f32 v115, v115
  v_mfma_f32_16x16x32_bf16 a[44:47], a[176:179], v[24:27], a[44:47]
  ds_read_b64_tr_b16 a[174:175], v221 offset:45056
  v_cvt_pk_bf16_f32 v113, v114, v115
  v_mfma_f32_16x16x32_bf16 a[48:51], a[184:187], v[0:3], a[48:51]
  v_exp_f32 v120, v120
  v_mfma_f32_16x16x32_bf16 a[48:51], a[188:191], v[32:35], a[48:51]
  ds_read_b64_tr_b16 a[176:177], v222 offset:32768
  v_mfma_f32_16x16x32_bf16 a[52:55], a[188:191], v[40:43], a[52:55]
  v_exp_f32 v121, v121
  v_mfma_f32_16x16x32_bf16 a[52:55], a[184:187], v[8:11], a[52:55]
  ds_read_b64_tr_b16 a[178:179], v222 offset:36864
  v_cvt_pk_bf16_f32 v120, v120, v121
  v_mfma_f32_16x16x32_bf16 a[56:59], a[184:187], v[16:19], a[56:59]
  v_exp_f32 v122, v122
  v_mfma_f32_16x16x32_bf16 a[56:59], a[188:191], v[48:51], a[56:59]
  ds_read_b64_tr_b16 a[180:181], v222 offset:40960
  v_mfma_f32_16x16x32_bf16 a[60:63], a[188:191], v[56:59], a[60:63]
  s_waitcnt lgkmcnt(7)
  v_exp_f32 v123, v123
  v_mfma_f32_16x16x32_bf16 a[60:63], a[184:187], v[24:27], a[60:63]
  ds_read_b64_tr_b16 a[182:183], v222 offset:45056
  v_cvt_pk_bf16_f32 v121, v122, v123
  v_mfma_f32_16x16x32_bf16 a[64:67], a[160:163], v[0:3], a[64:67]
  v_exp_f32 v100, v100
  v_mfma_f32_16x16x32_bf16 a[64:67], a[164:167], v[32:35], a[64:67]
  ds_read_b64_tr_b16 a[184:185], v223 offset:32768
  v_mfma_f32_16x16x32_bf16 a[68:71], a[164:167], v[40:43], a[68:71]
  v_exp_f32 v101, v101
  v_mfma_f32_16x16x32_bf16 a[68:71], a[160:163], v[8:11], a[68:71]
  ds_read_b64_tr_b16 a[186:187], v223 offset:36864
  v_cvt_pk_bf16_f32 v98, v100, v101
  v_mfma_f32_16x16x32_bf16 a[72:75], a[160:163], v[16:19], a[72:75]
  v_exp_f32 v102, v102
  v_mfma_f32_16x16x32_bf16 a[72:75], a[164:167], v[48:51], a[72:75]
  ds_read_b64_tr_b16 a[188:189], v223 offset:40960
  v_mfma_f32_16x16x32_bf16 a[76:79], a[164:167], v[56:59], a[76:79]
  s_waitcnt lgkmcnt(7)
  v_exp_f32 v103, v103
  v_mfma_f32_16x16x32_bf16 a[76:79], a[160:163], v[24:27], a[76:79]
  ds_read_b64_tr_b16 a[190:191], v223 offset:45056
  v_cvt_pk_bf16_f32 v99, v102, v103
  v_mfma_f32_16x16x32_bf16 a[80:83], a[168:171], v[0:3], a[80:83]
  s_waitcnt vmcnt(12)
  v_exp_f32 v108, v108
  v_mfma_f32_16x16x32_bf16 a[80:83], a[172:175], v[32:35], a[80:83]
  v_mfma_f32_16x16x32_bf16 a[84:87], a[172:175], v[40:43], a[84:87]
  s_barrier
  v_exp_f32 v109, v109
  v_mfma_f32_16x16x32_bf16 a[84:87], a[168:171], v[8:11], a[84:87]
  ds_read_b128 a[128:131], v212 offset:0
  v_cvt_pk_bf16_f32 v106, v108, v109
  v_mfma_f32_16x16x32_bf16 a[88:91], a[168:171], v[16:19], a[88:91]
  v_exp_f32 v110, v110
  v_mfma_f32_16x16x32_bf16 a[88:91], a[172:175], v[48:51], a[88:91]
  ds_read_b128 a[132:135], v213 offset:0
  v_mfma_f32_16x16x32_bf16 a[92:95], a[172:175], v[56:59], a[92:95]
  s_waitcnt lgkmcnt(6)
  v_exp_f32 v111, v111
  v_mfma_f32_16x16x32_bf16 a[92:95], a[168:171], v[24:27], a[92:95]
  ds_read_b128 a[136:139], v214 offset:0
  v_cvt_pk_bf16_f32 v107, v110, v111
  v_mfma_f32_16x16x32_bf16 a[96:99], a[176:179], v[0:3], a[96:99]
  v_exp_f32 v116, v116
  v_mfma_f32_16x16x32_bf16 a[96:99], a[180:183], v[32:35], a[96:99]
  ds_read_b128 a[140:143], v215 offset:0
  v_mfma_f32_16x16x32_bf16 a[100:103], a[180:183], v[40:43], a[100:103]
  v_exp_f32 v117, v117
  v_mfma_f32_16x16x32_bf16 a[100:103], a[176:179], v[8:11], a[100:103]
  v_cvt_pk_bf16_f32 v114, v116, v117
  v_mfma_f32_16x16x32_bf16 a[104:107], a[176:179], v[16:19], a[104:107]
  v_exp_f32 v118, v118
  v_mfma_f32_16x16x32_bf16 a[104:107], a[180:183], v[48:51], a[104:107]
  v_mfma_f32_16x16x32_bf16 a[108:111], a[180:183], v[56:59], a[108:111]
  s_waitcnt lgkmcnt(4)
  v_exp_f32 v119, v119
  v_mfma_f32_16x16x32_bf16 a[108:111], a[176:179], v[24:27], a[108:111]
  v_cvt_pk_bf16_f32 v115, v118, v119
  v_mfma_f32_16x16x32_bf16 a[112:115], a[184:187], v[0:3], a[112:115]
  v_exp_f32 v124, v124
  v_mfma_f32_16x16x32_bf16 a[112:115], a[188:191], v[32:35], a[112:115]
  v_mfma_f32_16x16x32_bf16 a[116:119], a[188:191], v[40:43], a[116:119]
  s_sub_u32 s32, s32, 1
  v_exp_f32 v125, v125
  v_mfma_f32_16x16x32_bf16 a[116:119], a[184:187], v[8:11], a[116:119]
  v_cvt_pk_bf16_f32 v122, v124, v125
  v_mfma_f32_16x16x32_bf16 a[120:123], a[184:187], v[16:19], a[120:123]
  s_cmp_lg_u32 s32, 0
  v_exp_f32 v126, v126
  v_mfma_f32_16x16x32_bf16 a[120:123], a[188:191], v[48:51], a[120:123]
  v_mfma_f32_16x16x32_bf16 a[124:127], a[188:191], v[56:59], a[124:127]
  s_waitcnt lgkmcnt(0)
  v_exp_f32 v127, v127
  v_mfma_f32_16x16x32_bf16 a[124:127], a[184:187], v[24:27], a[124:127]
  v_cvt_pk_bf16_f32 v123, v126, v127
  s_cbranch_scc1 attn_loop
  s_waitcnt vmcnt(1)
  v_readfirstlane_b32 s38, v254
  s_nop 0
  s_cmp_ge_u32 s38, 512
  s_cbranch_scc1 attn_h_ready
  s_mov_b32 s39, 32768
attn_spin:
  s_sleep 4
  buffer_load_dword v254, off, s[24:27], s47 sc1
  s_waitcnt vmcnt(0)
  v_readfirstlane_b32 s38, v254
  s_nop 0
  s_cmp_ge_u32 s38, 512
  s_cbranch_scc1 attn_h_ready
  s_sub_u32 s39, s39, 1
  s_cmp_lg_u32 s39, 0
  s_cbranch_scc1 attn_spin
attn_h_ready:
  v_mfma_f32_16x16x32_bf16 v[0:3], a[128:131], v[128:131], v[192:195]
  s_add_u32 m0, s28, 81920
  s_and_b32 s38, s2, 1
  s_lshl_b32 s38, s38, 2
  v_lshrrev_b32 v224, 4, v242
  v_and_b32 v225, 7, v224
  v_mfma_f32_16x16x32_bf16 v[0:3], a[132:135], v[132:135], v[0:3]
  ds_read_b128 a[144:147], v212 offset:4096
  s_add_u32 s38, s38, s3
  s_mul_i32 s38, s38, 81920
  s_lshr_b32 s39, s2, 5
  v_mul_u32_u24 v225, 0xd80, v225
  v_mfma_f32_16x16x32_bf16 v[0:3], a[136:139], v[136:139], v[0:3]
  buffer_load_dwordx4 v236, s[16:19], s29 offen offset:0 lds
  s_mul_i32 s39, s39, 655360
  s_add_u32 s38, s38, s39
  s_add_u32 s4, s38, 3145728
  v_mfma_f32_16x16x32_bf16 v[0:3], a[140:143], v[140:143], v[0:3]
  ds_read_b128 a[148:151], v213 offset:4096
  s_add_u32 s5, s4, 12288
  s_add_u32 s6, s4, 24576
  s_add_u32 s7, s4, 36864
  v_lshrrev_b32 v224, 4, v224
  v_mfma_f32_16x16x32_bf16 v[8:11], a[140:143], v[156:159], v[196:199]
  s_add_u32 s8, s4, 49152
  s_add_u32 s9, s4, 61440
  s_add_u32 s10, s4, 73728
  v_lshl_add_u32 v225, v224, 4, v225
  v_add_u32 v252, 4096, v242
  v_mfma_f32_16x16x32_bf16 v[8:11], a[136:139], v[152:155], v[8:11]
  ds_read_b128 a[152:155], v214 offset:4096
  buffer_load_dwordx4 a[212:215], v225, s[24:27], s101 offen offset:0 sc1
  v_mfma_f32_16x16x32_bf16 v[8:11], a[132:135], v[148:151], v[8:11]
  buffer_load_dwordx4 v237, s[16:19], s29 offen offset:1024 lds
  v_mfma_f32_16x16x32_bf16 v[8:11], a[128:131], v[144:147], v[8:11]
  ds_read_b128 a[156:159], v215 offset:4096
  buffer_load_dwordx4 a[216:219], v225, s[24:27], s101 offen offset:64 sc1
  v_mfma_f32_16x16x32_bf16 v[16:19], a[128:131], v[160:163], v[200:203]
  v_exp_f32 v0, v0
  v_mfma_f32_16x16x32_bf16 v[16:19], a[132:135], v[164:167], v[16:19]
  buffer_load_dwordx4 a[220:223], v225, s[24:27], s101 offen offset:128 sc1
  v_mfma_f32_16x16x32_bf16 v[16:19], a[136:139], v[168:171], v[16:19]
  v_exp_f32 v1, v1
  v_mfma_f32_16x16x32_bf16 v[16:19], a[140:143], v[172:175], v[16:19]
  v_cvt_pk_bf16_f32 v0, v0, v1
  v_add_u32 v253, 8192, v242
  v_mfma_f32_16x16x32_bf16 v[24:27], a[140:143], v[188:191], v[204:207]
  v_exp_f32 v2, v2
  v_mfma_f32_16x16x32_bf16 v[24:27], a[136:139], v[184:187], v[24:27]
  buffer_load_dwordx4 v236, s[16:19], s29 offen offset:2048 lds
  v_mfma_f32_16x16x32_bf16 v[24:27], a[132:135], v[180:183], v[24:27]
  s_waitcnt lgkmcnt(0)
  v_exp_f32 v3, v3
  v_mfma_f32_16x16x32_bf16 v[24:27], a[128:131], v[176:179], v[24:27]
  v_cvt_pk_bf16_f32 v1, v2, v3
  v_mfma_f32_16x16x32_bf16 v[4:7], a[144:147], v[128:131], v[192:195]
  v_exp_f32 v8, v8
  v_mfma_f32_16x16x32_bf16 v[4:7], a[148:151], v[132:135], v[4:7]
  ds_read_b128 a[128:131], v212 offset:8192
  v_mfma_f32_16x16x32_bf16 v[4:7], a[152:155], v[136:139], v[4:7]
  v_exp_f32 v9, v9
  v_mfma_f32_16x16x32_bf16 v[4:7], a[156:159], v[140:143], v[4:7]
  ds_read_b128 a[132:135], v213 offset:8192
  v_cvt_pk_bf16_f32 v8, v8, v9
  v_mfma_f32_16x16x32_bf16 v[12:15], a[156:159], v[156:159], v[196:199]
  v_exp_f32 v10, v10
  v_mfma_f32_16x16x32_bf16 v[12:15], a[152:155], v[152:155], v[12:15]
  ds_read_b128 a[136:139], v214 offset:8192
  v_mfma_f32_16x16x32_bf16 v[12:15], a[148:151], v[148:151], v[12:15]
  v_exp_f32 v11, v11
  v_mfma_f32_16x16x32_bf16 v[12:15], a[144:147], v[144:147], v[12:15]
  ds_read_b128 a[140:143], v215 offset:8192
  v_cvt_pk_bf16_f32 v9, v10, v11
  v_mfma_f32_16x16x32_bf16 v[20:23], a[144:147], v[160:163], v[200:203]
  v_exp_f32 v16, v16
  v_mfma_f32_16x16x32_bf16 v[20:23], a[148:151], v[164:167], v[20:23]
  buffer_load_dwordx4 v237, s[16:19], s29 offen offset:3072 lds
  v_mfma_f32_16x16x32_bf16 v[20:23], a[152:155], v[168:171], v[20:23]
  s_add_u32 s29, s29, 16384
  v_exp_f32 v17, v17
  v_mfma_f32_16x16x32_bf16 v[20:23], a[156:159], v[172:175], v[20:23]
  v_cvt_pk_bf16_f32 v16, v16, v17
  v_mfma_f32_16x16x32_bf16 v[28:31], a[156:159], v[188:191], v[204:207]
  s_add_u32 m0, s28, 32768
  v_exp_f32 v18, v18
  v_mfma_f32_16x16x32_bf16 v[28:31], a[152:155], v[184:187], v[28:31]
  buffer_load_dwordx4 v232, s[12:15], s29 offen offset:0 lds
  v_mfma_f32_16x16x32_bf16 v[28:31], a[148:151], v[180:183], v[28:31]
  s_waitcnt lgkmcnt(0)
  v_exp_f32 v19, v19
  v_mfma_f32_16x16x32_bf16 v[28:31], a[144:147], v[176:179], v[28:31]
  v_cvt_pk_bf16_f32 v17, v18, v19
  v_mfma_f32_16x16x32_bf16 v[32:35], a[128:131], v[128:131], v[192:195]
  v_exp_f32 v24, v24
  v_mfma_f32_16x16x32_bf16 v[32:35], a[132:135], v[132:135], v[32:35]
  ds_read_b128 a[144:147], v212 offset:12288
  v_mfma_f32_16x16x32_bf16 v[32:35], a[136:139], v[136:139], v[32:35]
  v_exp_f32 v25, v25
  v_mfma_f32_16x16x32_bf16 v[32:35], a[140:143], v[140:143], v[32:35]
  ds_read_b128 a[148:151], v213 offset:12288
  v_cvt_pk_bf16_f32 v24, v24, v25
  v_mfma_f32_16x16x32_bf16 v[40:43], a[140:143], v[156:159], v[196:199]
  v_exp_f32 v26, v26
  v_mfma_f32_16x16x32_bf16 v[40:43], a[136:139], v[152:155], v[40:43]
  ds_read_b128 a[152:155], v214 offset:12288
  v_mfma_f32_16x16x32_bf16 v[40:43], a[132:135], v[148:151], v[40:43]
  v_exp_f32 v27, v27
  v_mfma_f32_16x16x32_bf16 v[40:43], a[128:131], v[144:147], v[40:43]
  ds_read_b128 a[156:159], v215 offset:12288
  v_cvt_pk_bf16_f32 v25, v26, v27
  v_mfma_f32_16x16x32_bf16 v[48:51], a[128:131], v[160:163], v[200:203]
  v_exp_f32 v4, v4
  v_mfma_f32_16x16x32_bf16 v[48:51], a[132:135], v[164:167], v[48:51]
  buffer_load_dwordx4 v233, s[12:15], s29 offen offset:1024 lds
  v_mfma_f32_16x16x32_bf16 v[48:51], a[136:139], v[168:171], v[48:51]
  v_exp_f32 v5, v5
  v_mfma_f32_16x16x32_bf16 v[48:51], a[140:143], v[172:175], v[48:51]
  v_cvt_pk_bf16_f32 v2, v4, v5
  v_mfma_f32_16x16x32_bf16 v[56:59], a[140:143], v[188:191], v[204:207]
  v_exp_f32 v6, v6
  v_mfma_f32_16x16x32_bf16 v[56:59], a[136:139], v[184:187], v[56:59]
  buffer_load_dwordx4 v234, s[12:15], s29 offen offset:2048 lds
  v_mfma_f32_16x16x32_bf16 v[56:59], a[132:135], v[180:183], v[56:59]
  s_waitcnt lgkmcnt(0)
  v_exp_f32 v7, v7
  v_mfma_f32_16x16x32_bf16 v[56:59], a[128:131], v[176:179], v[56:59]
  v_cvt_pk_bf16_f32 v3, v6, v7
  v_mfma_f32_16x16x32_bf16 v[36:39], a[144:147], v[128:131], v[192:195]
  v_exp_f32 v12, v12
  v_mfma_f32_16x16x32_bf16 v[36:39], a[148:151], v[132:135], v[36:39]
  ds_read_b64_tr_b16 a[160:161], v216 offset:49152
  v_mfma_f32_16x16x32_bf16 v[36:39], a[152:155], v[136:139], v[36:39]
  v_exp_f32 v13, v13
  v_mfma_f32_16x16x32_bf16 v[36:39], a[156:159], v[140:143], v[36:39]
  ds_read_b64_tr_b16 a[162:163], v216 offset:53248
  v_cvt_pk_bf16_f32 v10, v12, v13
  v_mfma_f32_16x16x32_bf16 v[44:47], a[156:159], v[156:159], v[196:199]
  v_exp_f32 v14, v14
  v_mfma_f32_16x16x32_bf16 v[44:47], a[152:155], v[152:155], v[44:47]
  ds_read_b64_tr_b16 a[164:165], v216 offset:57344
  buffer_load_dwordx4 v235, s[12:15], s29 offen offset:3072 lds
  v_mfma_f32_16x16x32_bf16 v[44:47], a[148:151], v[148:151], v[44:47]
  v_exp_f32 v15, v15
  v_mfma_f32_16x16x32_bf16 v[44:47], a[144:147], v[144:147], v[44:47]
  ds_read_b64_tr_b16 a[166:167], v216 offset:61440
  v_cvt_pk_bf16_f32 v11, v14, v15
  v_mfma_f32_16x16x32_bf16 v[52:55], a[144:147], v[160:163], v[200:203]
  v_exp_f32 v20, v20
  v_mfma_f32_16x16x32_bf16 v[52:55], a[148:151], v[164:167], v[52:55]
  ds_read_b64_tr_b16 a[168:169], v217 offset:49152
  v_mfma_f32_16x16x32_bf16 v[52:55], a[152:155], v[168:171], v[52:55]
  v_exp_f32 v21, v21
  v_mfma_f32_16x16x32_bf16 v[52:55], a[156:159], v[172:175], v[52:55]
  ds_read_b64_tr_b16 a[170:171], v217 offset:53248
  v_cvt_pk_bf16_f32 v18, v20, v21
  v_mfma_f32_16x16x32_bf16 v[60:63], a[156:159], v[188:191], v[204:207]
  v_exp_f32 v22, v22
  v_mfma_f32_16x16x32_bf16 v[60:63], a[152:155], v[184:187], v[60:63]
  ds_read_b64_tr_b16 a[172:173], v217 offset:57344
  v_mfma_f32_16x16x32_bf16 v[60:63], a[148:151], v[180:183], v[60:63]
  v_exp_f32 v23, v23
  v_mfma_f32_16x16x32_bf16 v[60:63], a[144:147], v[176:179], v[60:63]
  ds_read_b64_tr_b16 a[174:175], v217 offset:61440
  v_cvt_pk_bf16_f32 v19, v22, v23
  v_mfma_f32_16x16x32_bf16 a[192:195], a[208:211], v[64:67], a[192:195]
  v_exp_f32 v28, v28
  v_mfma_f32_16x16x32_bf16 a[192:195], a[208:211], v[96:99], a[192:195]
  ds_read_b64_tr_b16 a[176:177], v218 offset:49152
  v_mfma_f32_16x16x32_bf16 a[196:199], a[208:211], v[72:75], a[196:199]
  v_exp_f32 v29, v29
  v_mfma_f32_16x16x32_bf16 a[196:199], a[208:211], v[104:107], a[196:199]
  ds_read_b64_tr_b16 a[178:179], v218 offset:53248
  v_cvt_pk_bf16_f32 v26, v28, v29
  v_mfma_f32_16x16x32_bf16 a[200:203], a[208:211], v[80:83], a[200:203]
  v_exp_f32 v30, v30
  v_mfma_f32_16x16x32_bf16 a[200:203], a[208:211], v[112:115], a[200:203]
  ds_read_b64_tr_b16 a[180:181], v218 offset:57344
  v_mfma_f32_16x16x32_bf16 a[204:207], a[208:211], v[88:91], a[204:207]
  s_waitcnt lgkmcnt(7)
  v_exp_f32 v31, v31
  v_mfma_f32_16x16x32_bf16 a[204:207], a[208:211], v[120:123], a[204:207]
  ds_read_b64_tr_b16 a[182:183], v218 offset:61440
  v_cvt_pk_bf16_f32 v27, v30, v31
  v_mfma_f32_16x16x32_bf16 a[0:3], a[160:163], v[64:67], a[0:3]
  v_exp_f32 v32, v32
  v_mfma_f32_16x16x32_bf16 a[0:3], a[164:167], v[96:99], a[0:3]
  ds_read_b64_tr_b16 a[184:185], v219 offset:49152
  v_mfma_f32_16x16x32_bf16 a[4:7], a[164:167], v[104:107], a[4:7]
  v_exp_f32 v33, v33
  v_mfma_f32_16x16x32_bf16 a[4:7], a[160:163], v[72:75], a[4:7]
  ds_read_b64_tr_b16 a[186:187], v219 offset:53248
  v_cvt_pk_bf16_f32 v32, v32, v33
  v_mfma_f32_16x16x32_bf16 a[8:11], a[160:163], v[80:83], a[8:11]
  v_exp_f32 v34, v34
  v_mfma_f32_16x16x32_bf16 a[8:11], a[164:167], v[112:115], a[8:11]
  ds_read_b64_tr_b16 a[188:189], v219 offset:57344
  v_mfma_f32_16x16x32_bf16 a[12:15], a[164:167], v[120:123], a[12:15]
  s_waitcnt lgkmcnt(7)
  v_exp_f32 v35, v35
  v_mfma_f32_16x16x32_bf16 a[12:15], a[160:163], v[88:91], a[12:15]
  ds_read_b64_tr_b16 a[190:191], v219 offset:61440
  v_cvt_pk_bf16_f32 v33, v34, v35
  v_mfma_f32_16x16x32_bf16 a[16:19], a[168:171], v[64:67], a[16:19]
  v_exp_f32 v40, v40
  v_mfma_f32_16x16x32_bf16 a[16:19], a[172:175], v[96:99], a[16:19]
  ds_read_b64_tr_b16 a[160:161], v220 offset:49152
  v_mfma_f32_16x16x32_bf16 a[20:23], a[172:175], v[104:107], a[20:23]
  v_exp_f32 v41, v41
  v_mfma_f32_16x16x32_bf16 a[20:23], a[168:171], v[72:75], a[20:23]
  ds_read_b64_tr_b16 a[162:163], v220 offset:53248
  v_cvt_pk_bf16_f32 v40, v40, v41
  v_mfma_f32_16x16x32_bf16 a[24:27], a[168:171], v[80:83], a[24:27]
  v_exp_f32 v42, v42
  v_mfma_f32_16x16x32_bf16 a[24:27], a[172:175], v[112:115], a[24:27]
  ds_read_b64_tr_b16 a[164:165], v220 offset:57344
  v_mfma_f32_16x16x32_bf16 a[28:31], a[172:175], v[120:123], a[28:31]
  s_waitcnt lgkmcnt(7)
  v_exp_f32 v43, v43
  v_mfma_f32_16x16x32_bf16 a[28:31], a[168:171], v[88:91], a[28:31]
  ds_read_b64_tr_b16 a[166:167], v220 offset:61440
  v_cvt_pk_bf16_f32 v41, v42, v43
  v_mfma_f32_16x16x32_bf16 a[32:35], a[176:179], v[64:67], a[32:35]
  v_exp_f32 v48, v48
  v_mfma_f32_16x16x32_bf16 a[32:35], a[180:183], v[96:99], a[32:35]
  ds_read_b64_tr_b16 a[168:169], v221 offset:49152
  v_mfma_f32_16x16x32_bf16 a[36:39], a[180:183], v[104:107], a[36:39]
  v_exp_f32 v49, v49
  v_mfma_f32_16x16x32_bf16 a[36:39], a[176:179], v[72:75], a[36:39]
  ds_read_b64_tr_b16 a[170:171], v221 offset:53248
  v_cvt_pk_bf16_f32 v48, v48, v49
  v_mfma_f32_16x16x32_bf16 a[40:43], a[176:179], v[80:83], a[40:43]
  v_exp_f32 v50, v50
  v_mfma_f32_16x16x32_bf16 a[40:43], a[180:183], v[112:115], a[40:43]
  ds_read_b64_tr_b16 a[172:173], v221 offset:57344
  v_mfma_f32_16x16x32_bf16 a[44:47], a[180:183], v[120:123], a[44:47]
  s_waitcnt lgkmcnt(7)
  v_exp_f32 v51, v51
  v_mfma_f32_16x16x32_bf16 a[44:47], a[176:179], v[88:91], a[44:47]
  ds_read_b64_tr_b16 a[174:175], v221 offset:61440
  v_cvt_pk_bf16_f32 v49, v50, v51
  v_mfma_f32_16x16x32_bf16 a[48:51], a[184:187], v[64:67], a[48:51]
  v_exp_f32 v56, v56
  v_mfma_f32_16x16x32_bf16 a[48:51], a[188:191], v[96:99], a[48:51]
  ds_read_b64_tr_b16 a[176:177], v222 offset:49152
  v_mfma_f32_16x16x32_bf16 a[52:55], a[188:191], v[104:107], a[52:55]
  v_exp_f32 v57, v57
  v_mfma_f32_16x16x32_bf16 a[52:55], a[184:187], v[72:75], a[52:55]
  ds_read_b64_tr_b16 a[178:179], v222 offset:53248
  v_cvt_pk_bf16_f32 v56, v56, v57
  v_mfma_f32_16x16x32_bf16 a[56:59], a[184:187], v[80:83], a[56:59]
  v_exp_f32 v58, v58
  v_mfma_f32_16x16x32_bf16 a[56:59], a[188:191], v[112:115], a[56:59]
  ds_read_b64_tr_b16 a[180:181], v222 offset:57344
  v_mfma_f32_16x16x32_bf16 a[60:63], a[188:191], v[120:123], a[60:63]
  s_waitcnt lgkmcnt(7)
  v_exp_f32 v59, v59
  v_mfma_f32_16x16x32_bf16 a[60:63], a[184:187], v[88:91], a[60:63]
  ds_read_b64_tr_b16 a[182:183], v222 offset:61440
  v_cvt_pk_bf16_f32 v57, v58, v59
  v_mfma_f32_16x16x32_bf16 a[64:67], a[160:163], v[64:67], a[64:67]
  v_exp_f32 v36, v36
  v_mfma_f32_16x16x32_bf16 a[64:67], a[164:167], v[96:99], a[64:67]
  ds_read_b64_tr_b16 a[184:185], v223 offset:49152
  v_mfma_f32_16x16x32_bf16 a[68:71], a[164:167], v[104:107], a[68:71]
  v_exp_f32 v37, v37
  v_mfma_f32_16x16x32_bf16 a[68:71], a[160:163], v[72:75], a[68:71]
  ds_read_b64_tr_b16 a[186:187], v223 offset:53248
  v_cvt_pk_bf16_f32 v34, v36, v37
  v_mfma_f32_16x16x32_bf16 a[72:75], a[160:163], v[80:83], a[72:75]
  v_exp_f32 v38, v38
  v_mfma_f32_16x16x32_bf16 a[72:75], a[164:167], v[112:115], a[72:75]
  ds_read_b64_tr_b16 a[188:189], v223 offset:57344
  v_mfma_f32_16x16x32_bf16 a[76:79], a[164:167], v[120:123], a[76:79]
  s_waitcnt lgkmcnt(7)
  v_exp_f32 v39, v39
  v_mfma_f32_16x16x32_bf16 a[76:79], a[160:163], v[88:91], a[76:79]
  ds_read_b64_tr_b16 a[190:191], v223 offset:61440
  v_cvt_pk_bf16_f32 v35, v38, v39
  v_mfma_f32_16x16x32_bf16 a[80:83], a[168:171], v[64:67], a[80:83]
  v_exp_f32 v44, v44
  v_mfma_f32_16x16x32_bf16 a[80:83], a[172:175], v[96:99], a[80:83]
  v_mfma_f32_16x16x32_bf16 a[84:87], a[172:175], v[104:107], a[84:87]
  s_barrier
  v_exp_f32 v45, v45
  v_mfma_f32_16x16x32_bf16 a[84:87], a[168:171], v[72:75], a[84:87]
  ds_read_b128 a[128:131], v212 offset:16384
  v_cvt_pk_bf16_f32 v42, v44, v45
  v_mfma_f32_16x16x32_bf16 a[88:91], a[168:171], v[80:83], a[88:91]
  v_exp_f32 v46, v46
  v_mfma_f32_16x16x32_bf16 a[88:91], a[172:175], v[112:115], a[88:91]
  ds_read_b128 a[132:135], v213 offset:16384
  v_mfma_f32_16x16x32_bf16 a[92:95], a[172:175], v[120:123], a[92:95]
  s_waitcnt lgkmcnt(6)
  v_exp_f32 v47, v47
  v_mfma_f32_16x16x32_bf16 a[92:95], a[168:171], v[88:91], a[92:95]
  ds_read_b128 a[136:139], v214 offset:16384
  v_cvt_pk_bf16_f32 v43, v46, v47
  v_mfma_f32_16x16x32_bf16 a[96:99], a[176:179], v[64:67], a[96:99]
  v_exp_f32 v52, v52
  v_mfma_f32_16x16x32_bf16 a[96:99], a[180:183], v[96:99], a[96:99]
  ds_read_b128 a[140:143], v215 offset:16384
  v_mfma_f32_16x16x32_bf16 a[100:103], a[180:183], v[104:107], a[100:103]
  v_exp_f32 v53, v53
  v_mfma_f32_16x16x32_bf16 a[100:103], a[176:179], v[72:75], a[100:103]
  v_cvt_pk_bf16_f32 v50, v52, v53
  v_mfma_f32_16x16x32_bf16 a[104:107], a[176:179], v[80:83], a[104:107]
  v_exp_f32 v54, v54
  v_mfma_f32_16x16x32_bf16 a[104:107], a[180:183], v[112:115], a[104:107]
  v_mfma_f32_16x16x32_bf16 a[108:111], a[180:183], v[120:123], a[108:111]
  s_waitcnt lgkmcnt(4)
  v_exp_f32 v55, v55
  v_mfma_f32_16x16x32_bf16 a[108:111], a[176:179], v[88:91], a[108:111]
  v_cvt_pk_bf16_f32 v51, v54, v55
  v_mfma_f32_16x16x32_bf16 a[112:115], a[184:187], v[64:67], a[112:115]
  v_exp_f32 v60, v60
  v_mfma_f32_16x16x32_bf16 a[112:115], a[188:191], v[96:99], a[112:115]
  v_mfma_f32_16x16x32_bf16 a[116:119], a[188:191], v[104:107], a[116:119]
  v_exp_f32 v61, v61
  v_mfma_f32_16x16x32_bf16 a[116:119], a[184:187], v[72:75], a[116:119]
  v_cvt_pk_bf16_f32 v58, v60, v61
  v_mfma_f32_16x16x32_bf16 a[120:123], a[184:187], v[80:83], a[120:123]
  v_exp_f32 v62, v62
  v_mfma_f32_16x16x32_bf16 a[120:123], a[188:191], v[112:115], a[120:123]
  v_mfma_f32_16x16x32_bf16 a[124:127], a[188:191], v[120:123], a[124:127]
  s_waitcnt lgkmcnt(0)
  v_exp_f32 v63, v63
  v_mfma_f32_16x16x32_bf16 a[124:127], a[184:187], v[88:91], a[124:127]
  v_cvt_pk_bf16_f32 v59, v62, v63
  v_mfma_f32_16x16x32_bf16 v[64:67], a[128:131], v[128:131], v[192:195]
  s_add_u32 m0, s28, 98304
  v_mfma_f32_16x16x32_bf16 v[64:67], a[132:135], v[132:135], v[64:67]
  ds_read_b128 a[144:147], v212 offset:20480
  v_mfma_f32_16x16x32_bf16 v[64:67], a[136:139], v[136:139], v[64:67]
  buffer_load_dwordx4 v236, s[16:19], s29 offen offset:0 lds
  v_mfma_f32_16x16x32_bf16 v[64:67], a[140:143], v[140:143], v[64:67]
  ds_read_b128 a[148:151], v213 offset:20480
  v_mfma_f32_16x16x32_bf16 v[72:75], a[140:143], v[156:159], v[196:199]
  v_mfma_f32_16x16x32_bf16 v[72:75], a[136:139], v[152:155], v[72:75]
  ds_read_b128 a[152:155], v214 offset:20480
  v_mfma_f32_16x16x32_bf16 v[72:75], a[132:135], v[148:151], v[72:75]
  buffer_load_dwordx4 v237, s[16:19], s29 offen offset:1024 lds
  v_mfma_f32_16x16x32_bf16 v[72:75], a[128:131], v[144:147], v[72:75]
  ds_read_b128 a[156:159], v215 offset:20480
  v_mfma_f32_16x16x32_bf16 v[80:83], a[128:131], v[160:163], v[200:203]
  v_exp_f32 v64, v64
  v_mfma_f32_16x16x32_bf16 v[80:83], a[132:135], v[164:167], v[80:83]
  v_mfma_f32_16x16x32_bf16 v[80:83], a[136:139], v[168:171], v[80:83]
  v_exp_f32 v65, v65
  v_mfma_f32_16x16x32_bf16 v[80:83], a[140:143], v[172:175], v[80:83]
  v_cvt_pk_bf16_f32 v64, v64, v65
  v_mfma_f32_16x16x32_bf16 v[88:91], a[140:143], v[188:191], v[204:207]
  v_exp_f32 v66, v66
  v_mfma_f32_16x16x32_bf16 v[88:91], a[136:139], v[184:187], v[88:91]
  buffer_load_dwordx4 v236, s[16:19], s29 offen offset:2048 lds
  v_mfma_f32_16x16x32_bf16 v[88:91], a[132:135], v[180:183], v[88:91]
  s_waitcnt lgkmcnt(0)
  v_exp_f32 v67, v67
  v_mfma_f32_16x16x32_bf16 v[88:91], a[128:131], v[176:179], v[88:91]
  v_cvt_pk_bf16_f32 v65, v66, v67
  v_mfma_f32_16x16x32_bf16 v[68:71], a[144:147], v[128:131], v[192:195]
  v_exp_f32 v72, v72
  v_mfma_f32_16x16x32_bf16 v[68:71], a[148:151], v[132:135], v[68:71]
  ds_read_b128 a[128:131], v212 offset:24576
  v_mfma_f32_16x16x32_bf16 v[68:71], a[152:155], v[136:139], v[68:71]
  v_exp_f32 v73, v73
  v_mfma_f32_16x16x32_bf16 v[68:71], a[156:159], v[140:143], v[68:71]
  ds_read_b128 a[132:135], v213 offset:24576
  v_cvt_pk_bf16_f32 v72, v72, v73
  v_mfma_f32_16x16x32_bf16 v[76:79], a[156:159], v[156:159], v[196:199]
  v_exp_f32 v74, v74
  v_mfma_f32_16x16x32_bf16 v[76:79], a[152:155], v[152:155], v[76:79]
  ds_read_b128 a[136:139], v214 offset:24576
  v_lshrrev_b32 v224, 4, v242
  v_mfma_f32_16x16x32_bf16 v[76:79], a[148:151], v[148:151], v[76:79]
  v_exp_f32 v75, v75
  v_mfma_f32_16x16x32_bf16 v[76:79], a[144:147], v[144:147], v[76:79]
  ds_read_b128 a[140:143], v215 offset:24576
  v_cvt_pk_bf16_f32 v73, v74, v75
  v_mfma_f32_16x16x32_bf16 v[84:87], a[144:147], v[160:163], v[200:203]
  v_exp_f32 v80, v80
  v_mfma_f32_16x16x32_bf16 v[84:87], a[148:151], v[164:167], v[84:87]
  buffer_load_dwordx4 v237, s[16:19], s29 offen offset:3072 lds
  v_mfma_f32_16x16x32_bf16 v[84:87], a[152:155], v[168:171], v[84:87]
  s_add_u32 s29, s29, 16384
  v_exp_f32 v81, v81
  v_mfma_f32_16x16x32_bf16 v[84:87], a[156:159], v[172:175], v[84:87]
  v_cvt_pk_bf16_f32 v80, v80, v81
  v_lshrrev_b32 v225, 4, v224
  v_mfma_f32_16x16x32_bf16 v[92:95], a[156:159], v[188:191], v[204:207]
  s_add_u32 m0, s28, 49152
  v_exp_f32 v82, v82
  v_mfma_f32_16x16x32_bf16 v[92:95], a[152:155], v[184:187], v[92:95]
  buffer_load_dwordx4 v232, s[12:15], s29 offen offset:0 lds
  v_mfma_f32_16x16x32_bf16 v[92:95], a[148:151], v[180:183], v[92:95]
  s_waitcnt lgkmcnt(0)
  v_exp_f32 v83, v83
  v_mfma_f32_16x16x32_bf16 v[92:95], a[144:147], v[176:179], v[92:95]
  v_cvt_pk_bf16_f32 v81, v82, v83
  v_bfe_u32 v226, v224, 2, 2
  v_mfma_f32_16x16x32_bf16 v[96:99], a[128:131], v[128:131], v[192:195]
  v_exp_f32 v88, v88
  v_mfma_f32_16x16x32_bf16 v[96:99], a[132:135], v[132:135], v[96:99]
  ds_read_b128 a[144:147], v212 offset:28672
  v_lshl_add_u32 v225, v225, 3, v226
  v_mfma_f32_16x16x32_bf16 v[96:99], a[136:139], v[136:139], v[96:99]
  v_exp_f32 v89, v89
  v_mfma_f32_16x16x32_bf16 v[96:99], a[140:143], v[140:143], v[96:99]
  ds_read_b128 a[148:151], v213 offset:28672
  v_cvt_pk_bf16_f32 v88, v88, v89
  v_mfma_f32_16x16x32_bf16 v[104:107], a[140:143], v[156:159], v[196:199]
  v_exp_f32 v90, v90
  v_mfma_f32_16x16x32_bf16 v[104:107], a[136:139], v[152:155], v[104:107]
  ds_read_b128 a[152:155], v214 offset:28672
  v_lshlrev_b32 v225, 5, v225
  v_mfma_f32_16x16x32_bf16 v[104:107], a[132:135], v[148:151], v[104:107]
  v_exp_f32 v91, v91
  v_mfma_f32_16x16x32_bf16 v[104:107], a[128:131], v[144:147], v[104:107]
  ds_read_b128 a[156:159], v215 offset:28672
  v_cvt_pk_bf16_f32 v89, v90, v91
  v_mfma_f32_16x16x32_bf16 v[112:115], a[128:131], v[160:163], v[200:203]
  v_exp_f32 v68, v68
  v_mfma_f32_16x16x32_bf16 v[112:115], a[132:135], v[164:167], v[112:115]
  buffer_load_dwordx4 v233, s[12:15], s29 offen offset:1024 lds
  v_mfma_f32_16x16x32_bf16 v[112:115], a[136:139], v[168:171], v[112:115]
  v_exp_f32 v69, v69
  v_mfma_f32_16x16x32_bf16 v[112:115], a[140:143], v[172:175], v[112:115]
  v_cvt_pk_bf16_f32 v66, v68, v69
  v_and_b32 v226, 3, v224
  v_mfma_f32_16x16x32_bf16 v[120:123], a[140:143], v[188:191], v[204:207]
  v_exp_f32 v70, v70
  v_mfma_f32_16x16x32_bf16 v[120:123], a[136:139], v[184:187], v[120:123]
  buffer_load_dwordx4 v234, s[12:15], s29 offen offset:2048 lds
  v_mfma_f32_16x16x32_bf16 v[120:123], a[132:135], v[180:183], v[120:123]
  s_waitcnt lgkmcnt(0)
  v_exp_f32 v71, v71
  v_mfma_f32_16x16x32_bf16 v[120:123], a[128:131], v[176:179], v[120:123]
  v_cvt_pk_bf16_f32 v67, v70, v71
  v_lshl_add_u32 v225, v226, 3, v225
  v_mfma_f32_16x16x32_bf16 v[100:103], a[144:147], v[128:131], v[192:195]
  v_exp_f32 v76, v76
  v_mfma_f32_16x16x32_bf16 v[100:103], a[148:151], v[132:135], v[100:103]
  ds_read_b64_tr_b16 a[160:161], v216 offset:0
  v_add_u32 v225, s50, v225
  v_mfma_f32_16x16x32_bf16 v[100:103], a[152:155], v[136:139], v[100:103]
  s_waitcnt vmcnt(13)
  v_exp_f32 v77, v77
  v_mfma_f32_16x16x32_bf16 v[100:103], a[156:159], v[140:143], v[100:103]
  ds_read_b64_tr_b16 a[162:163], v216 offset:4096
  v_cvt_pk_bf16_f32 v74, v76, v77
  v_mfma_f32_16x16x32_bf16 v[108:111], a[156:159], v[156:159], v[196:199]
  v_exp_f32 v78, v78
  v_mfma_f32_16x16x32_bf16 v[108:111], a[152:155], v[152:155], v[108:111]
  ds_read_b64_tr_b16 a[164:165], v216 offset:8192
  buffer_load_dwordx4 v235, s[12:15], s29 offen offset:3072 lds
  v_mfma_f32_16x16x32_bf16 v[108:111], a[148:151], v[148:151], v[108:111]
  v_exp_f32 v79, v79
  v_mfma_f32_16x16x32_bf16 v[108:111], a[144:147], v[144:147], v[108:111]
  ds_read_b64_tr_b16 a[166:167], v216 offset:12288
  v_cvt_pk_bf16_f32 v75, v78, v79
  v_mfma_f32_16x16x32_bf16 v[116:119], a[144:147], v[160:163], v[200:203]
  v_exp_f32 v84, v84
  v_mfma_f32_16x16x32_bf16 v[116:119], a[148:151], v[164:167], v[116:119]
  ds_read_b64_tr_b16 a[168:169], v217 offset:0
  ds_read_b64_tr_b16 a[232:233], v225 offset:0
  s_add_u32 m0, s28, 0
  v_mfma_f32_16x16x32_bf16 v[116:119], a[152:155], v[168:171], v[116:119]
  v_exp_f32 v85, v85
  v_mfma_f32_16x16x32_bf16 v[116:119], a[156:159], v[172:175], v[116:119]
  ds_read_b64_tr_b16 a[170:171], v217 offset:4096
  v_cvt_pk_bf16_f32 v82, v84, v85
  v_mfma_f32_16x16x32_bf16 v[124:127], a[156:159], v[188:191], v[204:207]
  v_exp_f32 v86, v86
  v_mfma_f32_16x16x32_bf16 v[124:127], a[152:155], v[184:187], v[124:127]
  ds_read_b64_tr_b16 a[172:173], v217 offset:8192
  ds_read_b64_tr_b16 a[234:235], v225 offset:128
  v_mfma_f32_16x16x32_bf16 v[124:127], a[148:151], v[180:183], v[124:127]
  v_exp_f32 v87, v87
  v_mfma_f32_16x16x32_bf16 v[124:127], a[144:147], v[176:179], v[124:127]
  ds_read_b64_tr_b16 a[174:175], v217 offset:12288
  v_cvt_pk_bf16_f32 v83, v86, v87
  v_mfma_f32_16x16x32_bf16 a[192:195], a[208:211], v[0:3], a[192:195]
  v_exp_f32 v92, v92
  v_mfma_f32_16x16x32_bf16 a[192:195], a[208:211], v[32:35], a[192:195]
  ds_read_b64_tr_b16 a[176:177], v218 offset:0
  ds_read_b64_tr_b16 a[236:237], v225 offset:1024
  v_mfma_f32_16x16x32_bf16 a[196:199], a[208:211], v[8:11], a[196:199]
  v_exp_f32 v93, v93
  v_mfma_f32_16x16x32_bf16 a[196:199], a[208:211], v[40:43], a[196:199]
  ds_read_b64_tr_b16 a[178:179], v218 offset:4096
  v_cvt_pk_bf16_f32 v90, v92, v93
  v_mfma_f32_16x16x32_bf16 a[200:203], a[208:211], v[16:19], a[200:203]
  v_exp_f32 v94, v94
  v_mfma_f32_16x16x32_bf16 a[200:203], a[208:211], v[48:51], a[200:203]
  ds_read_b64_tr_b16 a[180:181], v218 offset:8192
  ds_read_b64_tr_b16 a[238:239], v225 offset:1152
  v_mfma_f32_16x16x32_bf16 a[204:207], a[208:211], v[24:27], a[204:207]
  s_waitcnt lgkmcnt(11)
  v_exp_f32 v95, v95
  v_mfma_f32_16x16x32_bf16 a[204:207], a[208:211], v[56:59], a[204:207]
  ds_read_b64_tr_b16 a[182:183], v218 offset:12288
  v_cvt_pk_bf16_f32 v91, v94, v95
  v_mfma_f32_16x16x32_bf16 a[0:3], a[160:163], v[0:3], a[0:3]
  v_exp_f32 v96, v96
  v_mfma_f32_16x16x32_bf16 a[0:3], a[164:167], v[32:35], a[0:3]
  ds_read_b64_tr_b16 a[184:185], v219 offset:0
  ds_read_b64_tr_b16 a[240:241], v225 offset:2048
  v_mfma_f32_16x16x32_bf16 a[4:7], a[164:167], v[40:43], a[4:7]
  v_exp_f32 v97, v97
  v_mfma_f32_16x16x32_bf16 a[4:7], a[160:163], v[8:11], a[4:7]
  ds_read_b64_tr_b16 a[186:187], v219 offset:4096
  v_cvt_pk_bf16_f32 v96, v96, v97
  v_mfma_f32_16x16x32_bf16 a[8:11], a[160:163], v[16:19], a[8:11]
  v_exp_f32 v98, v98
  v_mfma_f32_16x16x32_bf16 a[8:11], a[164:167], v[48:51], a[8:11]
  ds_read_b64_tr_b16 a[188:189], v219 offset:8192
  ds_read_b64_tr_b16 a[242:243], v225 offset:2176
  v_mfma_f32_16x16x32_bf16 a[12:15], a[164:167], v[56:59], a[12:15]
  s_waitcnt lgkmcnt(11)
  v_exp_f32 v99, v99
  v_mfma_f32_16x16x32_bf16 a[12:15], a[160:163], v[24:27], a[12:15]
  ds_read_b64_tr_b16 a[190:191], v219 offset:12288
  v_cvt_pk_bf16_f32 v97, v98, v99
  v_mfma_f32_16x16x32_bf16 a[16:19], a[168:171], v[0:3], a[16:19]
  v_exp_f32 v104, v104
  v_mfma_f32_16x16x32_bf16 a[16:19], a[172:175], v[32:35], a[16:19]
  ds_read_b64_tr_b16 a[160:161], v220 offset:0
  buffer_load_dwordx4 v253, s[24:27], s8 offen offset:0 sc1 lds
  v_mfma_f32_16x16x32_bf16 a[20:23], a[172:175], v[40:43], a[20:23]
  v_exp_f32 v105, v105
  v_mfma_f32_16x16x32_bf16 a[20:23], a[168:171], v[8:11], a[20:23]
  ds_read_b64_tr_b16 a[162:163], v220 offset:4096
  v_cvt_pk_bf16_f32 v104, v104, v105
  v_mfma_f32_16x16x32_bf16 a[24:27], a[168:171], v[16:19], a[24:27]
  v_exp_f32 v106, v106
  v_mfma_f32_16x16x32_bf16 a[24:27], a[172:175], v[48:51], a[24:27]
  ds_read_b64_tr_b16 a[164:165], v220 offset:8192
  s_waitcnt lgkmcnt(4)
  buffer_load_dwordx4 v253, s[24:27], s8 offen offset:1024 sc1 lds
  v_mfma_f32_16x16x32_bf16 v[228:231], a[232:235], a[212:215], 0
  v_mfma_f32_16x16x32_bf16 v[228:231], a[236:239], a[216:219], v[228:231]
  v_mfma_f32_16x16x32_bf16 v[228:231], a[240:243], a[220:223], v[228:231]
  v_mfma_f32_16x16x32_bf16 a[28:31], a[172:175], v[56:59], a[28:31]
  s_lshl_b32 s35, s3, 10
  s_add_u32 s35, s35, 159744
  v_exp_f32 v107, v107
  v_mfma_f32_16x16x32_bf16 a[28:31], a[168:171], v[24:27], a[28:31]
  ds_read_b64_tr_b16 a[166:167], v220 offset:12288
  v_cvt_pk_bf16_f32 v105, v106, v107
  v_mfma_f32_16x16x32_bf16 a[32:35], a[176:179], v[0:3], a[32:35]
  v_exp_f32 v112, v112
  v_mfma_f32_16x16x32_bf16 a[32:35], a[180:183], v[32:35], a[32:35]
  ds_read_b64_tr_b16 a[168:169], v221 offset:0
  buffer_load_dwordx4 v253, s[24:27], s8 offen offset:2048 sc1 lds
  v_mfma_f32_16x16x32_bf16 a[36:39], a[180:183], v[40:43], a[36:39]
  v_exp_f32 v113, v113
  v_mfma_f32_16x16x32_bf16 a[36:39], a[176:179], v[8:11], a[36:39]
  ds_read_b64_tr_b16 a[170:171], v221 offset:4096
  v_cvt_pk_bf16_f32 v112, v112, v113
  v_mfma_f32_16x16x32_bf16 a[40:43], a[176:179], v[16:19], a[40:43]
  v_exp_f32 v114, v114
  v_mfma_f32_16x16x32_bf16 a[40:43], a[180:183], v[48:51], a[40:43]
  ds_read_b64_tr_b16 a[172:173], v221 offset:8192
  buffer_load_dwordx4 v253, s[24:27], s8 offen offset:3072 sc1 lds
  v_mfma_f32_16x16x32_bf16 a[44:47], a[180:183], v[56:59], a[44:47]
  s_waitcnt lgkmcnt(7)
  v_exp_f32 v115, v115
  v_mfma_f32_16x16x32_bf16 a[44:47], a[176:179], v[24:27], a[44:47]
  ds_read_b64_tr_b16 a[174:175], v221 offset:12288
  v_cvt_pk_bf16_f32 v113, v114, v115
  v_mfma_f32_16x16x32_bf16 a[48:51], a[184:187], v[0:3], a[48:51]
  v_exp_f32 v120, v120
  v_mfma_f32_16x16x32_bf16 a[48:51], a[188:191], v[32:35], a[48:51]
  ds_read_b64_tr_b16 a[176:177], v222 offset:0
  v_add_u32 v224, s35, v242
  v_mfma_f32_16x16x32_bf16 a[52:55], a[188:191], v[40:43], a[52:55]
  v_exp_f32 v121, v121
  v_mfma_f32_16x16x32_bf16 a[52:55], a[184:187], v[8:11], a[52:55]
  ds_read_b64_tr_b16 a[178:179], v222 offset:4096
  v_cvt_pk_bf16_f32 v120, v120, v121
  v_mfma_f32_16x16x32_bf16 a[56:59], a[184:187], v[16:19], a[56:59]
  v_exp_f32 v122, v122
  v_mfma_f32_16x16x32_bf16 a[56:59], a[188:191], v[48:51], a[56:59]
  ds_read_b64_tr_b16 a[180:181], v222 offset:8192
  ds_write_b128 v224, v[228:231]
  v_mfma_f32_16x16x32_bf16 a[60:63], a[188:191], v[56:59], a[60:63]
  s_waitcnt lgkmcnt(8)
  v_exp_f32 v123, v123
  v_mfma_f32_16x16x32_bf16 a[60:63], a[184:187], v[24:27], a[60:63]
  ds_read_b64_tr_b16 a[182:183], v222 offset:12288
  v_cvt_pk_bf16_f32 v121, v122, v123
  v_mfma_f32_16x16x32_bf16 a[64:67], a[160:163], v[0:3], a[64:67]
  v_exp_f32 v100, v100
  v_mfma_f32_16x16x32_bf16 a[64:67], a[164:167], v[32:35], a[64:67]
  ds_read_b64_tr_b16 a[184:185], v223 offset:0
  v_mfma_f32_16x16x32_bf16 a[68:71], a[164:167], v[40:43], a[68:71]
  v_exp_f32 v101, v101
  v_mfma_f32_16x16x32_bf16 a[68:71], a[160:163], v[8:11], a[68:71]
  ds_read_b64_tr_b16 a[186:187], v223 offset:4096
  v_cvt_pk_bf16_f32 v98, v100, v101
  v_mfma_f32_16x16x32_bf16 a[72:75], a[160:163], v[16:19], a[72:75]
  v_exp_f32 v102, v102
  v_mfma_f32_16x16x32_bf16 a[72:75], a[164:167], v[48:51], a[72:75]
  ds_read_b64_tr_b16 a[188:189], v223 offset:8192
  s_waitcnt lgkmcnt(4)
  v_mfma_f32_16x16x32_bf16 a[76:79], a[164:167], v[56:59], a[76:79]
  v_exp_f32 v103, v103
  v_mfma_f32_16x16x32_bf16 a[76:79], a[160:163], v[24:27], a[76:79]
  ds_read_b64_tr_b16 a[190:191], v223 offset:12288
  v_cvt_pk_bf16_f32 v99, v102, v103
  v_mfma_f32_16x16x32_bf16 a[80:83], a[168:171], v[0:3], a[80:83]
  s_waitcnt vmcnt(12)
  v_exp_f32 v108, v108
  v_mfma_f32_16x16x32_bf16 a[80:83], a[172:175], v[32:35], a[80:83]
  v_mfma_f32_16x16x32_bf16 a[84:87], a[172:175], v[40:43], a[84:87]
  s_barrier
  v_exp_f32 v109, v109
  v_mfma_f32_16x16x32_bf16 a[84:87], a[168:171], v[8:11], a[84:87]
  ds_read_b128 a[128:131], v212 offset:32768
  v_cvt_pk_bf16_f32 v106, v108, v109
  v_mfma_f32_16x16x32_bf16 a[88:91], a[168:171], v[16:19], a[88:91]
  v_exp_f32 v110, v110
  v_mfma_f32_16x16x32_bf16 a[88:91], a[172:175], v[48:51], a[88:91]
  ds_read_b128 a[132:135], v213 offset:32768
  v_mfma_f32_16x16x32_bf16 a[92:95], a[172:175], v[56:59], a[92:95]
  s_waitcnt lgkmcnt(6)
  v_exp_f32 v111, v111
  v_mfma_f32_16x16x32_bf16 a[92:95], a[168:171], v[24:27], a[92:95]
  ds_read_b128 a[136:139], v214 offset:32768
  v_cvt_pk_bf16_f32 v107, v110, v111
  v_mfma_f32_16x16x32_bf16 a[96:99], a[176:179], v[0:3], a[96:99]
  v_exp_f32 v116, v116
  v_mfma_f32_16x16x32_bf16 a[96:99], a[180:183], v[32:35], a[96:99]
  ds_read_b128 a[140:143], v215 offset:32768
  v_mfma_f32_16x16x32_bf16 a[100:103], a[180:183], v[40:43], a[100:103]
  v_exp_f32 v117, v117
  v_mfma_f32_16x16x32_bf16 a[100:103], a[176:179], v[8:11], a[100:103]
  v_cvt_pk_bf16_f32 v114, v116, v117
  v_mfma_f32_16x16x32_bf16 a[104:107], a[176:179], v[16:19], a[104:107]
  v_exp_f32 v118, v118
  v_mfma_f32_16x16x32_bf16 a[104:107], a[180:183], v[48:51], a[104:107]
  v_mfma_f32_16x16x32_bf16 a[108:111], a[180:183], v[56:59], a[108:111]
  s_waitcnt lgkmcnt(4)
  v_exp_f32 v119, v119
  v_mfma_f32_16x16x32_bf16 a[108:111], a[176:179], v[24:27], a[108:111]
  v_cvt_pk_bf16_f32 v115, v118, v119
  v_mfma_f32_16x16x32_bf16 a[112:115], a[184:187], v[0:3], a[112:115]
  v_exp_f32 v124, v124
  v_mfma_f32_16x16x32_bf16 a[112:115], a[188:191], v[32:35], a[112:115]
  v_mfma_f32_16x16x32_bf16 a[116:119], a[188:191], v[40:43], a[116:119]
  v_exp_f32 v125, v125
  v_mfma_f32_16x16x32_bf16 a[116:119], a[184:187], v[8:11], a[116:119]
  v_cvt_pk_bf16_f32 v122, v124, v125
  v_mfma_f32_16x16x32_bf16 a[120:123], a[184:187], v[16:19], a[120:123]
  v_exp_f32 v126, v126
  v_mfma_f32_16x16x32_bf16 a[120:123], a[188:191], v[48:51], a[120:123]
  v_mfma_f32_16x16x32_bf16 a[124:127], a[188:191], v[56:59], a[124:127]
  s_waitcnt lgkmcnt(0)
  v_exp_f32 v127, v127
  v_mfma_f32_16x16x32_bf16 a[124:127], a[184:187], v[24:27], a[124:127]
  v_cvt_pk_bf16_f32 v123, v126, v127
  v_mfma_f32_16x16x32_bf16 v[0:3], a[128:131], v[128:131], v[192:195]
  s_add_u32 m0, s28, 114688
  v_add_u32 v224, 159744, v242
  v_mfma_f32_16x16x32_bf16 v[0:3], a[132:135], v[132:135], v[0:3]
  ds_read_b128 a[144:147], v212 offset:36864
  ds_read_b128 v[228:231], v224 offset:0
  v_mfma_f32_16x16x32_bf16 v[0:3], a[136:139], v[136:139], v[0:3]
  buffer_load_dwordx4 v236, s[16:19], s29 offen offset:0 lds
  v_mfma_f32_16x16x32_bf16 v[0:3], a[140:143], v[140:143], v[0:3]
  ds_read_b128 a[148:151], v213 offset:36864
  ds_read_b128 v[238:241], v224 offset:1024
  v_mfma_f32_16x16x32_bf16 v[8:11], a[140:143], v[156:159], v[196:199]
  ds_read_b128 v[208:211], v224 offset:2048
  v_lshrrev_b32 v224, 4, v242
  v_mfma_f32_16x16x32_bf16 v[8:11], a[136:139], v[152:155], v[8:11]
  ds_read_b128 a[152:155], v214 offset:36864
  s_min_u32 s35, s3, 1
  s_lshl_b32 s35, s35, 30
  v_and_b32 v225, 7, v224
  v_mfma_f32_16x16x32_bf16 v[8:11], a[132:135], v[148:151], v[8:11]
  buffer_load_dwordx4 v237, s[16:19], s29 offen offset:1024 lds
  v_mfma_f32_16x16x32_bf16 v[8:11], a[128:131], v[144:147], v[8:11]
  ds_read_b128 a[156:159], v215 offset:36864
  v_mul_u32_u24 v225, 0xa00, v225
  v_mfma_f32_16x16x32_bf16 v[16:19], a[128:131], v[160:163], v[200:203]
  v_exp_f32 v0, v0
  v_mfma_f32_16x16x32_bf16 v[16:19], a[132:135], v[164:167], v[16:19]
  v_lshrrev_b32 v226, 4, v224
  v_lshl_add_u32 v225, v226, 4, v225
  v_mfma_f32_16x16x32_bf16 v[16:19], a[136:139], v[168:171], v[16:19]
  v_exp_f32 v1, v1
  v_mfma_f32_16x16x32_bf16 v[16:19], a[140:143], v[172:175], v[16:19]
  v_cvt_pk_bf16_f32 v0, v0, v1
  v_bfe_u32 v226, v224, 3, 1
  v_mfma_f32_16x16x32_bf16 v[24:27], a[140:143], v[188:191], v[204:207]
  v_exp_f32 v2, v2
  v_mfma_f32_16x16x32_bf16 v[24:27], a[136:139], v[184:187], v[24:27]
  buffer_load_dwordx4 v236, s[16:19], s29 offen offset:2048 lds
  v_mfma_f32_16x16x32_bf16 v[24:27], a[132:135], v[180:183], v[24:27]
  s_waitcnt lgkmcnt(0)
  v_exp_f32 v3, v3
  v_mfma_f32_16x16x32_bf16 v[24:27], a[128:131], v[176:179], v[24:27]
  v_cvt_pk_bf16_f32 v1, v2, v3
  v_lshl_add_u32 v225, v226, 30, v225
  v_mfma_f32_16x16x32_bf16 v[4:7], a[144:147], v[128:131], v[192:195]
  v_exp_f32 v8, v8
  v_mfma_f32_16x16x32_bf16 v[4:7], a[148:151], v[132:135], v[4:7]
  ds_read_b128 a[128:131], v212 offset:40960
  v_or_b32 v225, s35, v225
  v_mfma_f32_16x16x32_bf16 v[4:7], a[152:155], v[136:139], v[4:7]
  s_mul_i32 s35, s98, 20480
  s_lshl_b32 s38, s99, 6
  s_add_u32 s35, s35, s38
  v_exp_f32 v9, v9
  v_mfma_f32_16x16x32_bf16 v[4:7], a[156:159], v[140:143], v[4:7]
  ds_read_b128 a[132:135], v213 offset:40960
  s_add_u32 s35, s35, 2686976
  v_cvt_pk_bf16_f32 v8, v8, v9
  v_mfma_f32_16x16x32_bf16 v[12:15], a[156:159], v[156:159], v[196:199]
  v_exp_f32 v10, v10
  v_mfma_f32_16x16x32_bf16 v[12:15], a[152:155], v[152:155], v[12:15]
  ds_read_b128 a[136:139], v214 offset:40960
  v_add_f32 v228, v228, v238
  v_mfma_f32_16x16x32_bf16 v[12:15], a[148:151], v[148:151], v[12:15]
  v_exp_f32 v11, v11
  v_mfma_f32_16x16x32_bf16 v[12:15], a[144:147], v[144:147], v[12:15]
  ds_read_b128 a[140:143], v215 offset:40960
  v_cvt_pk_bf16_f32 v9, v10, v11
  v_mfma_f32_16x16x32_bf16 v[20:23], a[144:147], v[160:163], v[200:203]
  v_exp_f32 v16, v16
  v_mfma_f32_16x16x32_bf16 v[20:23], a[148:151], v[164:167], v[20:23]
  buffer_load_dwordx4 v237, s[16:19], s29 offen offset:3072 lds
  v_mfma_f32_16x16x32_bf16 v[20:23], a[152:155], v[168:171], v[20:23]
  s_add_u32 s29, s29, 16384
  v_exp_f32 v17, v17
  v_mfma_f32_16x16x32_bf16 v[20:23], a[156:159], v[172:175], v[20:23]
  v_cvt_pk_bf16_f32 v16, v16, v17
  v_add_f32 v229, v229, v239
  v_mfma_f32_16x16x32_bf16 v[28:31], a[156:159], v[188:191], v[204:207]
  s_add_u32 m0, s28, 16384
  v_exp_f32 v18, v18
  v_mfma_f32_16x16x32_bf16 v[28:31], a[152:155], v[184:187], v[28:31]
  buffer_load_dwordx4 v242, s[24:27], s9 offen offset:0 sc1 lds
  v_mfma_f32_16x16x32_bf16 v[28:31], a[148:151], v[180:183], v[28:31]
  s_waitcnt lgkmcnt(0)
  v_exp_f32 v19, v19
  v_mfma_f32_16x16x32_bf16 v[28:31], a[144:147], v[176:179], v[28:31]
  v_cvt_pk_bf16_f32 v17, v18, v19
  v_add_f32 v230, v230, v240
  v_mfma_f32_16x16x32_bf16 v[32:35], a[128:131], v[128:131], v[192:195]
  v_exp_f32 v24, v24
  v_mfma_f32_16x16x32_bf16 v[32:35], a[132:135], v[132:135], v[32:35]
  ds_read_b128 a[144:147], v212 offset:45056
  v_add_f32 v231, v231, v241
  v_mfma_f32_16x16x32_bf16 v[32:35], a[136:139], v[136:139], v[32:35]
  v_exp_f32 v25, v25
  v_mfma_f32_16x16x32_bf16 v[32:35], a[140:143], v[140:143], v[32:35]
  ds_read_b128 a[148:151], v213 offset:45056
  v_cvt_pk_bf16_f32 v24, v24, v25
  v_mfma_f32_16x16x32_bf16 v[40:43], a[140:143], v[156:159], v[196:199]
  v_exp_f32 v26, v26
  v_mfma_f32_16x16x32_bf16 v[40:43], a[136:139], v[152:155], v[40:43]
  ds_read_b128 a[152:155], v214 offset:45056
  v_add_f32 v228, v228, v208
  v_mfma_f32_16x16x32_bf16 v[40:43], a[132:135], v[148:151], v[40:43]
  v_exp_f32 v27, v27
  v_mfma_f32_16x16x32_bf16 v[40:43], a[128:131], v[144:147], v[40:43]
  ds_read_b128 a[156:159], v215 offset:45056
  v_cvt_pk_bf16_f32 v25, v26, v27
  v_mfma_f32_16x16x32_bf16 v[48:51], a[128:131], v[160:163], v[200:203]
  v_exp_f32 v4, v4
  v_mfma_f32_16x16x32_bf16 v[48:51], a[132:135], v[164:167], v[48:51]
  buffer_load_dwordx4 v242, s[24:27], s9 offen offset:1024 sc1 lds
  v_mfma_f32_16x16x32_bf16 v[48:51], a[136:139], v[168:171], v[48:51]
  v_exp_f32 v5, v5
  v_mfma_f32_16x16x32_bf16 v[48:51], a[140:143], v[172:175], v[48:51]
  v_cvt_pk_bf16_f32 v2, v4, v5
  v_add_f32 v229, v229, v209
  v_mfma_f32_16x16x32_bf16 v[56:59], a[140:143], v[188:191], v[204:207]
  v_exp_f32 v6, v6
  v_mfma_f32_16x16x32_bf16 v[56:59], a[136:139], v[184:187], v[56:59]
  buffer_load_dwordx4 v242, s[24:27], s9 offen offset:2048 sc1 lds
  v_mfma_f32_16x16x32_bf16 v[56:59], a[132:135], v[180:183], v[56:59]
  s_waitcnt lgkmcnt(0)
  v_exp_f32 v7, v7
  v_mfma_f32_16x16x32_bf16 v[56:59], a[128:131], v[176:179], v[56:59]
  v_cvt_pk_bf16_f32 v3, v6, v7
  v_add_f32 v230, v230, v210
  v_mfma_f32_16x16x32_bf16 v[36:39], a[144:147], v[128:131], v[192:195]
  v_exp_f32 v12, v12
  v_mfma_f32_16x16x32_bf16 v[36:39], a[148:151], v[132:135], v[36:39]
  ds_read_b64_tr_b16 a[160:161], v216 offset:16384
  v_add_f32 v231, v231, v211
  v_mfma_f32_16x16x32_bf16 v[36:39], a[152:155], v[136:139], v[36:39]
  v_exp_f32 v13, v13
  v_mfma_f32_16x16x32_bf16 v[36:39], a[156:159], v[140:143], v[36:39]
  ds_read_b64_tr_b16 a[162:163], v216 offset:20480
  v_cvt_pk_bf16_f32 v10, v12, v13
  v_mfma_f32_16x16x32_bf16 v[44:47], a[156:159], v[156:159], v[196:199]
  v_exp_f32 v14, v14
  v_mfma_f32_16x16x32_bf16 v[44:47], a[152:155], v[152:155], v[44:47]
  ds_read_b64_tr_b16 a[164:165], v216 offset:24576
  buffer_load_dwordx4 v242, s[24:27], s9 offen offset:3072 sc1 lds
  v_mfma_f32_16x16x32_bf16 v[44:47], a[148:151], v[148:151], v[44:47]
  v_exp_f32 v15, v15
  v_mfma_f32_16x16x32_bf16 v[44:47], a[144:147], v[144:147], v[44:47]
  ds_read_b64_tr_b16 a[166:167], v216 offset:28672
  v_cvt_pk_bf16_f32 v11, v14, v15
  v_mfma_f32_16x16x32_bf16 v[52:55], a[144:147], v[160:163], v[200:203]
  v_exp_f32 v20, v20
  v_mfma_f32_16x16x32_bf16 v[52:55], a[148:151], v[164:167], v[52:55]
  ds_read_b64_tr_b16 a[168:169], v217 offset:16384
  buffer_store_dwordx4 v[228:231], v225, s[24:27], s35 offen sc1
  v_mfma_f32_16x16x32_bf16 v[52:55], a[152:155], v[168:171], v[52:55]
  v_exp_f32 v21, v21
  v_mfma_f32_16x16x32_bf16 v[52:55], a[156:159], v[172:175], v[52:55]
  ds_read_b64_tr_b16 a[170:171], v217 offset:20480
  v_cvt_pk_bf16_f32 v18, v20, v21
  v_mfma_f32_16x16x32_bf16 v[60:63], a[156:159], v[188:191], v[204:207]
  v_exp_f32 v22, v22
  v_mfma_f32_16x16x32_bf16 v[60:63], a[152:155], v[184:187], v[60:63]
  ds_read_b64_tr_b16 a[172:173], v217 offset:24576
  buffer_load_dwordx4 a[212:215], v242, s[24:27], s4 offen offset:0 sc1
  v_mfma_f32_16x16x32_bf16 v[60:63], a[148:151], v[180:183], v[60:63]
  v_exp_f32 v23, v23
  v_mfma_f32_16x16x32_bf16 v[60:63], a[144:147], v[176:179], v[60:63]
  ds_read_b64_tr_b16 a[174:175], v217 offset:28672
  v_cvt_pk_bf16_f32 v19, v22, v23
  v_mfma_f32_16x16x32_bf16 a[192:195], a[208:211], v[64:67], a[192:195]
  v_exp_f32 v28, v28
  v_mfma_f32_16x16x32_bf16 a[192:195], a[208:211], v[96:99], a[192:195]
  ds_read_b64_tr_b16 a[176:177], v218 offset:16384
  buffer_load_dwordx4 a[216:219], v242, s[24:27], s4 offen offset:1024 sc1
  v_mfma_f32_16x16x32_bf16 a[196:199], a[208:211], v[72:75], a[196:199]
  v_exp_f32 v29, v29
  v_mfma_f32_16x16x32_bf16 a[196:199], a[208:211], v[104:107], a[196:199]
  ds_read_b64_tr_b16 a[178:179], v218 offset:20480
  v_cvt_pk_bf16_f32 v26, v28, v29
  v_mfma_f32_16x16x32_bf16 a[200:203], a[208:211], v[80:83], a[200:203]
  v_exp_f32 v30, v30
  v_mfma_f32_16x16x32_bf16 a[200:203], a[208:211], v[112:115], a[200:203]
  ds_read_b64_tr_b16 a[180:181], v218 offset:24576
  v_mfma_f32_16x16x32_bf16 a[204:207], a[208:211], v[88:91], a[204:207]
  s_waitcnt lgkmcnt(7)
  v_exp_f32 v31, v31
  v_mfma_f32_16x16x32_bf16 a[204:207], a[208:211], v[120:123], a[204:207]
  ds_read_b64_tr_b16 a[182:183], v218 offset:28672
  v_cvt_pk_bf16_f32 v27, v30, v31
  v_mfma_f32_16x16x32_bf16 a[0:3], a[160:163], v[64:67], a[0:3]
  v_exp_f32 v32, v32
  v_mfma_f32_16x16x32_bf16 a[0:3], a[164:167], v[96:99], a[0:3]
  ds_read_b64_tr_b16 a[184:185], v219 offset:16384
  buffer_load_dwordx4 a[220:223], v242, s[24:27], s4 offen offset:2048 sc1
  v_mfma_f32_16x16x32_bf16 a[4:7], a[164:167], v[104:107], a[4:7]
  v_exp_f32 v33, v33
  v_mfma_f32_16x16x32_bf16 a[4:7], a[160:163], v[72:75], a[4:7]
  ds_read_b64_tr_b16 a[186:187], v219 offset:20480
  v_cvt_pk_bf16_f32 v32, v32, v33
  v_mfma_f32_16x16x32_bf16 a[8:11], a[160:163], v[80:83], a[8:11]
  v_exp_f32 v34, v34
  v_mfma_f32_16x16x32_bf16 a[8:11], a[164:167], v[112:115], a[8:11]
  ds_read_b64_tr_b16 a[188:189], v219 offset:24576
  v_mfma_f32_16x16x32_bf16 a[12:15], a[164:167], v[120:123], a[12:15]
  s_waitcnt lgkmcnt(7)
  v_exp_f32 v35, v35
  v_mfma_f32_16x16x32_bf16 a[12:15], a[160:163], v[88:91], a[12:15]
  ds_read_b64_tr_b16 a[190:191], v219 offset:28672
  v_cvt_pk_bf16_f32 v33, v34, v35
  v_mfma_f32_16x16x32_bf16 a[16:19], a[168:171], v[64:67], a[16:19]
  v_exp_f32 v40, v40
  v_mfma_f32_16x16x32_bf16 a[16:19], a[172:175], v[96:99], a[16:19]
  ds_read_b64_tr_b16 a[160:161], v220 offset:16384
  buffer_load_dwordx4 a[224:227], v242, s[24:27], s4 offen offset:3072 sc1
  v_mfma_f32_16x16x32_bf16 a[20:23], a[172:175], v[104:107], a[20:23]
  v_exp_f32 v41, v41
  v_mfma_f32_16x16x32_bf16 a[20:23], a[168:171], v[72:75], a[20:23]
  ds_read_b64_tr_b16 a[162:163], v220 offset:20480
  v_cvt_pk_bf16_f32 v40, v40, v41
  v_mfma_f32_16x16x32_bf16 a[24:27], a[168:171], v[80:83], a[24:27]
  v_exp_f32 v42, v42
  v_mfma_f32_16x16x32_bf16 a[24:27], a[172:175], v[112:115], a[24:27]
  ds_read_b64_tr_b16 a[164:165], v220 offset:24576
  v_mfma_f32_16x16x32_bf16 a[28:31], a[172:175], v[120:123], a[28:31]
  s_waitcnt lgkmcnt(7)
  v_exp_f32 v43, v43
  v_mfma_f32_16x16x32_bf16 a[28:31], a[168:171], v[88:91], a[28:31]
  ds_read_b64_tr_b16 a[166:167], v220 offset:28672
  v_cvt_pk_bf16_f32 v41, v42, v43
  v_mfma_f32_16x16x32_bf16 a[32:35], a[176:179], v[64:67], a[32:35]
  v_exp_f32 v48, v48
  v_mfma_f32_16x16x32_bf16 a[32:35], a[180:183], v[96:99], a[32:35]
  ds_read_b64_tr_b16 a[168:169], v221 offset:16384
  buffer_load_dwordx4 a[228:231], v252, s[24:27], s4 offen offset:0 sc1
  v_mfma_f32_16x16x32_bf16 a[36:39], a[180:183], v[104:107], a[36:39]
  v_exp_f32 v49, v49
  v_mfma_f32_16x16x32_bf16 a[36:39], a[176:179], v[72:75], a[36:39]
  ds_read_b64_tr_b16 a[170:171], v221 offset:20480
  v_cvt_pk_bf16_f32 v48, v48, v49
  v_mfma_f32_16x16x32_bf16 a[40:43], a[176:179], v[80:83], a[40:43]
  v_exp_f32 v50, v50
  v_mfma_f32_16x16x32_bf16 a[40:43], a[180:183], v[112:115], a[40:43]
  ds_read_b64_tr_b16 a[172:173], v221 offset:24576
  v_mfma_f32_16x16x32_bf16 a[44:47], a[180:183], v[120:123], a[44:47]
  s_waitcnt lgkmcnt(7)
  v_exp_f32 v51, v51
  v_mfma_f32_16x16x32_bf16 a[44:47], a[176:179], v[88:91], a[44:47]
  ds_read_b64_tr_b16 a[174:175], v221 offset:28672
  v_cvt_pk_bf16_f32 v49, v50, v51
  v_mfma_f32_16x16x32_bf16 a[48:51], a[184:187], v[64:67], a[48:51]
  v_exp_f32 v56, v56
  v_mfma_f32_16x16x32_bf16 a[48:51], a[188:191], v[96:99], a[48:51]
  ds_read_b64_tr_b16 a[176:177], v222 offset:16384
  buffer_load_dwordx4 a[232:235], v252, s[24:27], s4 offen offset:1024 sc1
  v_mfma_f32_16x16x32_bf16 a[52:55], a[188:191], v[104:107], a[52:55]
  v_exp_f32 v57, v57
  v_mfma_f32_16x16x32_bf16 a[52:55], a[184:187], v[72:75], a[52:55]
  ds_read_b64_tr_b16 a[178:179], v222 offset:20480
  v_cvt_pk_bf16_f32 v56, v56, v57
  v_mfma_f32_16x16x32_bf16 a[56:59], a[184:187], v[80:83], a[56:59]
  v_exp_f32 v58, v58
  v_mfma_f32_16x16x32_bf16 a[56:59], a[188:191], v[112:115], a[56:59]
  ds_read_b64_tr_b16 a[180:181], v222 offset:24576
  v_mfma_f32_16x16x32_bf16 a[60:63], a[188:191], v[120:123], a[60:63]
  s_waitcnt lgkmcnt(7)
  v_exp_f32 v59, v59
  v_mfma_f32_16x16x32_bf16 a[60:63], a[184:187], v[88:91], a[60:63]
  ds_read_b64_tr_b16 a[182:183], v222 offset:28672
  v_cvt_pk_bf16_f32 v57, v58, v59
  v_mfma_f32_16x16x32_bf16 a[64:67], a[160:163], v[64:67], a[64:67]
  v_exp_f32 v36, v36
  v_mfma_f32_16x16x32_bf16 a[64:67], a[164:167], v[96:99], a[64:67]
  ds_read_b64_tr_b16 a[184:185], v223 offset:16384
  v_mfma_f32_16x16x32_bf16 a[68:71], a[164:167], v[104:107], a[68:71]
  v_exp_f32 v37, v37
  v_mfma_f32_16x16x32_bf16 a[68:71], a[160:163], v[72:75], a[68:71]
  ds_read_b64_tr_b16 a[186:187], v223 offset:20480
  v_cvt_pk_bf16_f32 v34, v36, v37
  v_mfma_f32_16x16x32_bf16 a[72:75], a[160:163], v[80:83], a[72:75]
  v_exp_f32 v38, v38
  v_mfma_f32_16x16x32_bf16 a[72:75], a[164:167], v[112:115], a[72:75]
  ds_read_b64_tr_b16 a[188:189], v223 offset:24576
  v_mfma_f32_16x16x32_bf16 a[76:79], a[164:167], v[120:123], a[76:79]
  s_waitcnt lgkmcnt(7)
  v_exp_f32 v39, v39
  v_mfma_f32_16x16x32_bf16 a[76:79], a[160:163], v[88:91], a[76:79]
  ds_read_b64_tr_b16 a[190:191], v223 offset:28672
  v_cvt_pk_bf16_f32 v35, v38, v39
  v_mfma_f32_16x16x32_bf16 a[80:83], a[168:171], v[64:67], a[80:83]
  s_waitcnt vmcnt(19)
  v_exp_f32 v44, v44
  v_mfma_f32_16x16x32_bf16 a[80:83], a[172:175], v[96:99], a[80:83]
  v_mfma_f32_16x16x32_bf16 a[84:87], a[172:175], v[104:107], a[84:87]
  s_barrier
  v_exp_f32 v45, v45
  v_mfma_f32_16x16x32_bf16 a[84:87], a[168:171], v[72:75], a[84:87]
  ds_read_b128 a[128:131], v212 offset:49152
  v_cvt_pk_bf16_f32 v42, v44, v45
  v_mfma_f32_16x16x32_bf16 a[88:91], a[168:171], v[80:83], a[88:91]
  v_exp_f32 v46, v46
  v_mfma_f32_16x16x32_bf16 a[88:91], a[172:175], v[112:115], a[88:91]
  ds_read_b128 a[132:135], v213 offset:49152
  v_mfma_f32_16x16x32_bf16 a[92:95], a[172:175], v[120:123], a[92:95]
  s_waitcnt lgkmcnt(6)
  v_exp_f32 v47, v47
  v_mfma_f32_16x16x32_bf16 a[92:95], a[168:171], v[88:91], a[92:95]
  ds_read_b128 a[136:139], v214 offset:49152
  v_cvt_pk_bf16_f32 v43, v46, v47
  v_mfma_f32_16x16x32_bf16 a[96:99], a[176:179], v[64:67], a[96:99]
  v_exp_f32 v52, v52
  v_mfma_f32_16x16x32_bf16 a[96:99], a[180:183], v[96:99], a[96:99]
  ds_read_b128 a[140:143], v215 offset:49152
  v_mfma_f32_16x16x32_bf16 a[100:103], a[180:183], v[104:107], a[100:103]
  v_exp_f32 v53, v53
  v_mfma_f32_16x16x32_bf16 a[100:103], a[176:179], v[72:75], a[100:103]
  v_cvt_pk_bf16_f32 v50, v52, v53
  v_mfma_f32_16x16x32_bf16 a[104:107], a[176:179], v[80:83], a[104:107]
  v_exp_f32 v54, v54
  v_mfma_f32_16x16x32_bf16 a[104:107], a[180:183], v[112:115], a[104:107]
  v_mfma_f32_16x16x32_bf16 a[108:111], a[180:183], v[120:123], a[108:111]
  s_waitcnt lgkmcnt(4)
  v_exp_f32 v55, v55
  v_mfma_f32_16x16x32_bf16 a[108:111], a[176:179], v[88:91], a[108:111]
  v_cvt_pk_bf16_f32 v51, v54, v55
  v_mfma_f32_16x16x32_bf16 a[112:115], a[184:187], v[64:67], a[112:115]
  v_exp_f32 v60, v60
  v_mfma_f32_16x16x32_bf16 a[112:115], a[188:191], v[96:99], a[112:115]
  v_mfma_f32_16x16x32_bf16 a[116:119], a[188:191], v[104:107], a[116:119]
  v_exp_f32 v61, v61
  v_mfma_f32_16x16x32_bf16 a[116:119], a[184:187], v[72:75], a[116:119]
  v_cvt_pk_bf16_f32 v58, v60, v61
  v_mfma_f32_16x16x32_bf16 a[120:123], a[184:187], v[80:83], a[120:123]
  v_exp_f32 v62, v62
  v_mfma_f32_16x16x32_bf16 a[120:123], a[188:191], v[112:115], a[120:123]
  v_mfma_f32_16x16x32_bf16 a[124:127], a[188:191], v[120:123], a[124:127]
  s_waitcnt lgkmcnt(0)
  v_exp_f32 v63, v63
  v_mfma_f32_16x16x32_bf16 a[124:127], a[184:187], v[88:91], a[124:127]
  v_cvt_pk_bf16_f32 v59, v62, v63
  v_mfma_f32_16x16x32_bf16 v[64:67], a[128:131], v[128:131], v[192:195]
  s_add_u32 m0, s28, 65536
  v_mfma_f32_16x16x32_bf16 v[64:67], a[132:135], v[132:135], v[64:67]
  ds_read_b128 a[144:147], v212 offset:53248
  v_mfma_f32_16x16x32_bf16 v[64:67], a[136:139], v[136:139], v[64:67]
  buffer_load_dwordx4 v253, s[24:27], s9 offen offset:0 sc1 lds
  v_mfma_f32_16x16x32_bf16 v[64:67], a[140:143], v[140:143], v[64:67]
  ds_read_b128 a[148:151], v213 offset:53248
  v_mfma_f32_16x16x32_bf16 v[72:75], a[140:143], v[156:159], v[196:199]
  v_mfma_f32_16x16x32_bf16 v[72:75], a[136:139], v[152:155], v[72:75]
  ds_read_b128 a[152:155], v214 offset:53248
  v_mfma_f32_16x16x32_bf16 v[72:75], a[132:135], v[148:151], v[72:75]
  buffer_load_dwordx4 v253, s[24:27], s9 offen offset:1024 sc1 lds
  v_mfma_f32_16x16x32_bf16 v[72:75], a[128:131], v[144:147], v[72:75]
  ds_read_b128 a[156:159], v215 offset:53248
  v_mfma_f32_16x16x32_bf16 v[80:83], a[128:131], v[160:163], v[200:203]
  v_exp_f32 v64, v64
  v_mfma_f32_16x16x32_bf16 v[80:83], a[132:135], v[164:167], v[80:83]
  v_mfma_f32_16x16x32_bf16 v[80:83], a[136:139], v[168:171], v[80:83]
  v_exp_f32 v65, v65
  v_mfma_f32_16x16x32_bf16 v[80:83], a[140:143], v[172:175], v[80:83]
  v_cvt_pk_bf16_f32 v64, v64, v65
  v_mfma_f32_16x16x32_bf16 v[88:91], a[140:143], v[188:191], v[204:207]
  v_exp_f32 v66, v66
  v_mfma_f32_16x16x32_bf16 v[88:91], a[136:139], v[184:187], v[88:91]
  buffer_load_dwordx4 v253, s[24:27], s9 offen offset:2048 sc1 lds
  v_mfma_f32_16x16x32_bf16 v[88:91], a[132:135], v[180:183], v[88:91]
  s_waitcnt lgkmcnt(0)
  v_exp_f32 v67, v67
  v_mfma_f32_16x16x32_bf16 v[88:91], a[128:131], v[176:179], v[88:91]
  v_cvt_pk_bf16_f32 v65, v66, v67
  v_mfma_f32_16x16x32_bf16 v[68:71], a[144:147], v[128:131], v[192:195]
  v_exp_f32 v72, v72
  v_mfma_f32_16x16x32_bf16 v[68:71], a[148:151], v[132:135], v[68:71]
  ds_read_b128 a[128:131], v212 offset:57344
  v_mfma_f32_16x16x32_bf16 v[68:71], a[152:155], v[136:139], v[68:71]
  v_exp_f32 v73, v73
  v_mfma_f32_16x16x32_bf16 v[68:71], a[156:159], v[140:143], v[68:71]
  ds_read_b128 a[132:135], v213 offset:57344
  v_cvt_pk_bf16_f32 v72, v72, v73
  v_mfma_f32_16x16x32_bf16 v[76:79], a[156:159], v[156:159], v[196:199]
  v_exp_f32 v74, v74
  v_mfma_f32_16x16x32_bf16 v[76:79], a[152:155], v[152:155], v[76:79]
  ds_read_b128 a[136:139], v214 offset:57344
  v_mfma_f32_16x16x32_bf16 v[76:79], a[148:151], v[148:151], v[76:79]
  v_exp_f32 v75, v75
  v_mfma_f32_16x16x32_bf16 v[76:79], a[144:147], v[144:147], v[76:79]
  ds_read_b128 a[140:143], v215 offset:57344
  v_cvt_pk_bf16_f32 v73, v74, v75
  v_mfma_f32_16x16x32_bf16 v[84:87], a[144:147], v[160:163], v[200:203]
  v_exp_f32 v80, v80
  v_mfma_f32_16x16x32_bf16 v[84:87], a[148:151], v[164:167], v[84:87]
  buffer_load_dwordx4 v253, s[24:27], s9 offen offset:3072 sc1 lds
  v_mfma_f32_16x16x32_bf16 v[84:87], a[152:155], v[168:171], v[84:87]
  s_add_u32 s29, s29, 16384
  v_exp_f32 v81, v81
  v_mfma_f32_16x16x32_bf16 v[84:87], a[156:159], v[172:175], v[84:87]
  v_cvt_pk_bf16_f32 v80, v80, v81
  v_mfma_f32_16x16x32_bf16 v[92:95], a[156:159], v[188:191], v[204:207]
  s_add_u32 m0, s28, 32768
  v_exp_f32 v82, v82
  v_mfma_f32_16x16x32_bf16 v[92:95], a[152:155], v[184:187], v[92:95]
  buffer_load_dwordx4 v252, s[24:27], s9 offen offset:0 sc1 lds
  v_mfma_f32_16x16x32_bf16 v[92:95], a[148:151], v[180:183], v[92:95]
  s_waitcnt lgkmcnt(0)
  v_exp_f32 v83, v83
  v_mfma_f32_16x16x32_bf16 v[92:95], a[144:147], v[176:179], v[92:95]
  v_cvt_pk_bf16_f32 v81, v82, v83
  v_mfma_f32_16x16x32_bf16 v[96:99], a[128:131], v[128:131], v[192:195]
  v_exp_f32 v88, v88
  v_mfma_f32_16x16x32_bf16 v[96:99], a[132:135], v[132:135], v[96:99]
  ds_read_b128 a[144:147], v212 offset:61440
  v_mfma_f32_16x16x32_bf16 v[96:99], a[136:139], v[136:139], v[96:99]
  v_exp_f32 v89, v89
  v_mfma_f32_16x16x32_bf16 v[96:99], a[140:143], v[140:143], v[96:99]
  ds_read_b128 a[148:151], v213 offset:61440
  v_cvt_pk_bf16_f32 v88, v88, v89
  v_mfma_f32_16x16x32_bf16 v[104:107], a[140:143], v[156:159], v[196:199]
  v_exp_f32 v90, v90
  v_mfma_f32_16x16x32_bf16 v[104:107], a[136:139], v[152:155], v[104:107]
  ds_read_b128 a[152:155], v214 offset:61440
  v_mfma_f32_16x16x32_bf16 v[104:107], a[132:135], v[148:151], v[104:107]
  v_exp_f32 v91, v91
  v_mfma_f32_16x16x32_bf16 v[104:107], a[128:131], v[144:147], v[104:107]
  ds_read_b128 a[156:159], v215 offset:61440
  v_cvt_pk_bf16_f32 v89, v90, v91
  v_mfma_f32_16x16x32_bf16 v[112:115], a[128:131], v[160:163], v[200:203]
  v_exp_f32 v68, v68
  v_mfma_f32_16x16x32_bf16 v[112:115], a[132:135], v[164:167], v[112:115]
  buffer_load_dwordx4 v252, s[24:27], s9 offen offset:1024 sc1 lds
  v_mfma_f32_16x16x32_bf16 v[112:115], a[136:139], v[168:171], v[112:115]
  v_exp_f32 v69, v69
  v_mfma_f32_16x16x32_bf16 v[112:115], a[140:143], v[172:175], v[112:115]
  v_cvt_pk_bf16_f32 v66, v68, v69
  v_mfma_f32_16x16x32_bf16 v[120:123], a[140:143], v[188:191], v[204:207]
  v_exp_f32 v70, v70
  v_mfma_f32_16x16x32_bf16 v[120:123], a[136:139], v[184:187], v[120:123]
  buffer_load_dwordx4 v252, s[24:27], s9 offen offset:2048 sc1 lds
  v_mfma_f32_16x16x32_bf16 v[120:123], a[132:135], v[180:183], v[120:123]
  s_waitcnt lgkmcnt(0)
  v_exp_f32 v71, v71
  v_mfma_f32_16x16x32_bf16 v[120:123], a[128:131], v[176:179], v[120:123]
  v_cvt_pk_bf16_f32 v67, v70, v71
  v_mfma_f32_16x16x32_bf16 v[100:103], a[144:147], v[128:131], v[192:195]
  v_exp_f32 v76, v76
  v_mfma_f32_16x16x32_bf16 v[100:103], a[148:151], v[132:135], v[100:103]
  ds_read_b64_tr_b16 a[160:161], v216 offset:32768
  v_mfma_f32_16x16x32_bf16 v[100:103], a[152:155], v[136:139], v[100:103]
  v_exp_f32 v77, v77
  v_mfma_f32_16x16x32_bf16 v[100:103], a[156:159], v[140:143], v[100:103]
  ds_read_b64_tr_b16 a[162:163], v216 offset:36864
  v_cvt_pk_bf16_f32 v74, v76, v77
  v_mfma_f32_16x16x32_bf16 v[108:111], a[156:159], v[156:159], v[196:199]
  v_exp_f32 v78, v78
  v_mfma_f32_16x16x32_bf16 v[108:111], a[152:155], v[152:155], v[108:111]
  ds_read_b64_tr_b16 a[164:165], v216 offset:40960
  buffer_load_dwordx4 v252, s[24:27], s9 offen offset:3072 sc1 lds
  v_mfma_f32_16x16x32_bf16 v[108:111], a[148:151], v[148:151], v[108:111]
  v_exp_f32 v79, v79
  v_mfma_f32_16x16x32_bf16 v[108:111], a[144:147], v[144:147], v[108:111]
  ds_read_b64_tr_b16 a[166:167], v216 offset:45056
  v_cvt_pk_bf16_f32 v75, v78, v79
  v_mfma_f32_16x16x32_bf16 v[116:119], a[144:147], v[160:163], v[200:203]
  v_exp_f32 v84, v84
  v_mfma_f32_16x16x32_bf16 v[116:119], a[148:151], v[164:167], v[116:119]
  ds_read_b64_tr_b16 a[168:169], v217 offset:32768
  buffer_load_dwordx4 a[236:239], v252, s[24:27], s4 offen offset:2048 sc1
  v_mfma_f32_16x16x32_bf16 v[116:119], a[152:155], v[168:171], v[116:119]
  v_exp_f32 v85, v85
  v_mfma_f32_16x16x32_bf16 v[116:119], a[156:159], v[172:175], v[116:119]
  ds_read_b64_tr_b16 a[170:171], v217 offset:36864
  v_cvt_pk_bf16_f32 v82, v84, v85
  v_mfma_f32_16x16x32_bf16 v[124:127], a[156:159], v[188:191], v[204:207]
  v_exp_f32 v86, v86
  v_mfma_f32_16x16x32_bf16 v[124:127], a[152:155], v[184:187], v[124:127]
  ds_read_b64_tr_b16 a[172:173], v217 offset:40960
  v_mfma_f32_16x16x32_bf16 v[124:127], a[148:151], v[180:183], v[124:127]
  v_exp_f32 v87, v87
  v_mfma_f32_16x16x32_bf16 v[124:127], a[144:147], v[176:179], v[124:127]
  ds_read_b64_tr_b16 a[174:175], v217 offset:45056
  v_cvt_pk_bf16_f32 v83, v86, v87
  v_mfma_f32_16x16x32_bf16 a[192:195], a[208:211], v[0:3], a[192:195]
  v_exp_f32 v92, v92
  v_mfma_f32_16x16x32_bf16 a[192:195], a[208:211], v[32:35], a[192:195]
  ds_read_b64_tr_b16 a[176:177], v218 offset:32768
  buffer_load_dwordx4 a[240:243], v252, s[24:27], s4 offen offset:3072 sc1
  v_mfma_f32_16x16x32_bf16 a[196:199], a[208:211], v[8:11], a[196:199]
  v_exp_f32 v93, v93
  v_mfma_f32_16x16x32_bf16 a[196:199], a[208:211], v[40:43], a[196:199]
  ds_read_b64_tr_b16 a[178:179], v218 offset:36864
  v_cvt_pk_bf16_f32 v90, v92, v93
  v_mfma_f32_16x16x32_bf16 a[200:203], a[208:211], v[16:19], a[200:203]
  v_exp_f32 v94, v94
  v_mfma_f32_16x16x32_bf16 a[200:203], a[208:211], v[48:51], a[200:203]
  ds_read_b64_tr_b16 a[180:181], v218 offset:40960
  v_mfma_f32_16x16x32_bf16 a[204:207], a[208:211], v[24:27], a[204:207]
  s_waitcnt lgkmcnt(7)
  v_exp_f32 v95, v95
  v_mfma_f32_16x16x32_bf16 a[204:207], a[208:211], v[56:59], a[204:207]
  ds_read_b64_tr_b16 a[182:183], v218 offset:45056
  v_cvt_pk_bf16_f32 v91, v94, v95
  v_mfma_f32_16x16x32_bf16 a[0:3], a[160:163], v[0:3], a[0:3]
  v_exp_f32 v96, v96
  v_mfma_f32_16x16x32_bf16 a[0:3], a[164:167], v[32:35], a[0:3]
  ds_read_b64_tr_b16 a[184:185], v219 offset:32768
  buffer_load_dwordx4 a[244:247], v253, s[24:27], s4 offen offset:0 sc1
  v_mfma_f32_16x16x32_bf16 a[4:7], a[164:167], v[40:43], a[4:7]
  v_exp_f32 v97, v97
  v_mfma_f32_16x16x32_bf16 a[4:7], a[160:163], v[8:11], a[4:7]
  ds_read_b64_tr_b16 a[186:187], v219 offset:36864
  v_cvt_pk_bf16_f32 v96, v96, v97
  v_mfma_f32_16x16x32_bf16 a[8:11], a[160:163], v[16:19], a[8:11]
  v_exp_f32 v98, v98
  v_mfma_f32_16x16x32_bf16 a[8:11], a[164:167], v[48:51], a[8:11]
  ds_read_b64_tr_b16 a[188:189], v219 offset:40960
  v_mfma_f32_16x16x32_bf16 a[12:15], a[164:167], v[56:59], a[12:15]
  s_waitcnt lgkmcnt(7)
  v_exp_f32 v99, v99
  v_mfma_f32_16x16x32_bf16 a[12:15], a[160:163], v[24:27], a[12:15]
  ds_read_b64_tr_b16 a[190:191], v219 offset:45056
  v_cvt_pk_bf16_f32 v97, v98, v99
  v_mfma_f32_16x16x32_bf16 a[16:19], a[168:171], v[0:3], a[16:19]
  v_exp_f32 v104, v104
  v_mfma_f32_16x16x32_bf16 a[16:19], a[172:175], v[32:35], a[16:19]
  ds_read_b64_tr_b16 a[160:161], v220 offset:32768
  buffer_load_dwordx4 a[248:251], v253, s[24:27], s4 offen offset:1024 sc1
  v_mfma_f32_16x16x32_bf16 a[20:23], a[172:175], v[40:43], a[20:23]
  v_exp_f32 v105, v105
  v_mfma_f32_16x16x32_bf16 a[20:23], a[168:171], v[8:11], a[20:23]
  ds_read_b64_tr_b16 a[162:163], v220 offset:36864
  v_cvt_pk_bf16_f32 v104, v104, v105
  v_mfma_f32_16x16x32_bf16 a[24:27], a[168:171], v[16:19], a[24:27]
  v_exp_f32 v106, v106
  v_mfma_f32_16x16x32_bf16 a[24:27], a[172:175], v[48:51], a[24:27]
  ds_read_b64_tr_b16 a[164:165], v220 offset:40960
  v_mfma_f32_16x16x32_bf16 a[28:31], a[172:175], v[56:59], a[28:31]
  s_waitcnt lgkmcnt(7)
  v_exp_f32 v107, v107
  v_mfma_f32_16x16x32_bf16 a[28:31], a[168:171], v[24:27], a[28:31]
  ds_read_b64_tr_b16 a[166:167], v220 offset:45056
  v_cvt_pk_bf16_f32 v105, v106, v107
  v_mfma_f32_16x16x32_bf16 a[32:35], a[176:179], v[0:3], a[32:35]
  v_exp_f32 v112, v112
  v_mfma_f32_16x16x32_bf16 a[32:35], a[180:183], v[32:35], a[32:35]
  ds_read_b64_tr_b16 a[168:169], v221 offset:32768
  buffer_load_dwordx4 a[252:255], v253, s[24:27], s4 offen offset:2048 sc1
  v_mfma_f32_16x16x32_bf16 a[36:39], a[180:183], v[40:43], a[36:39]
  v_exp_f32 v113, v113
  v_mfma_f32_16x16x32_bf16 a[36:39], a[176:179], v[8:11], a[36:39]
  ds_read_b64_tr_b16 a[170:171], v221 offset:36864
  v_cvt_pk_bf16_f32 v112, v112, v113
  v_mfma_f32_16x16x32_bf16 a[40:43], a[176:179], v[16:19], a[40:43]
  v_exp_f32 v114, v114
  v_mfma_f32_16x16x32_bf16 a[40:43], a[180:183], v[48:51], a[40:43]
  ds_read_b64_tr_b16 a[172:173], v221 offset:40960
  v_mfma_f32_16x16x32_bf16 a[44:47], a[180:183], v[56:59], a[44:47]
  s_waitcnt lgkmcnt(7)
  v_exp_f32 v115, v115
  v_mfma_f32_16x16x32_bf16 a[44:47], a[176:179], v[24:27], a[44:47]
  ds_read_b64_tr_b16 a[174:175], v221 offset:45056
  v_cvt_pk_bf16_f32 v113, v114, v115
  v_mfma_f32_16x16x32_bf16 a[48:51], a[184:187], v[0:3], a[48:51]
  v_exp_f32 v120, v120
  v_mfma_f32_16x16x32_bf16 a[48:51], a[188:191], v[32:35], a[48:51]
  ds_read_b64_tr_b16 a[176:177], v222 offset:32768
  v_mfma_f32_16x16x32_bf16 a[52:55], a[188:191], v[40:43], a[52:55]
  v_exp_f32 v121, v121
  v_mfma_f32_16x16x32_bf16 a[52:55], a[184:187], v[8:11], a[52:55]
  ds_read_b64_tr_b16 a[178:179], v222 offset:36864
  v_cvt_pk_bf16_f32 v120, v120, v121
  v_mfma_f32_16x16x32_bf16 a[56:59], a[184:187], v[16:19], a[56:59]
  v_exp_f32 v122, v122
  v_mfma_f32_16x16x32_bf16 a[56:59], a[188:191], v[48:51], a[56:59]
  ds_read_b64_tr_b16 a[180:181], v222 offset:40960
  v_mfma_f32_16x16x32_bf16 a[60:63], a[188:191], v[56:59], a[60:63]
  s_waitcnt lgkmcnt(7)
  v_exp_f32 v123, v123
  v_mfma_f32_16x16x32_bf16 a[60:63], a[184:187], v[24:27], a[60:63]
  ds_read_b64_tr_b16 a[182:183], v222 offset:45056
  v_cvt_pk_bf16_f32 v121, v122, v123
  v_mfma_f32_16x16x32_bf16 a[64:67], a[160:163], v[0:3], a[64:67]
  v_exp_f32 v100, v100
  v_mfma_f32_16x16x32_bf16 a[64:67], a[164:167], v[32:35], a[64:67]
  ds_read_b64_tr_b16 a[184:185], v223 offset:32768
  v_mfma_f32_16x16x32_bf16 a[68:71], a[164:167], v[40:43], a[68:71]
  v_exp_f32 v101, v101
  v_mfma_f32_16x16x32_bf16 a[68:71], a[160:163], v[8:11], a[68:71]
  ds_read_b64_tr_b16 a[186:187], v223 offset:36864
  v_cvt_pk_bf16_f32 v98, v100, v101
  v_mfma_f32_16x16x32_bf16 a[72:75], a[160:163], v[16:19], a[72:75]
  v_exp_f32 v102, v102
  v_mfma_f32_16x16x32_bf16 a[72:75], a[164:167], v[48:51], a[72:75]
  ds_read_b64_tr_b16 a[188:189], v223 offset:40960
  v_mfma_f32_16x16x32_bf16 a[76:79], a[164:167], v[56:59], a[76:79]
  s_waitcnt lgkmcnt(7)
  v_exp_f32 v103, v103
  v_mfma_f32_16x16x32_bf16 a[76:79], a[160:163], v[24:27], a[76:79]
  ds_read_b64_tr_b16 a[190:191], v223 offset:45056
  v_cvt_pk_bf16_f32 v99, v102, v103
  v_mfma_f32_16x16x32_bf16 a[80:83], a[168:171], v[0:3], a[80:83]
  s_waitcnt vmcnt(19)
  v_exp_f32 v108, v108
  v_mfma_f32_16x16x32_bf16 a[80:83], a[172:175], v[32:35], a[80:83]
  v_mfma_f32_16x16x32_bf16 a[84:87], a[172:175], v[40:43], a[84:87]
  s_barrier
  v_exp_f32 v109, v109
  v_mfma_f32_16x16x32_bf16 a[84:87], a[168:171], v[8:11], a[84:87]
  s_mul_i32 s39, s99, 13108
  s_lshr_b32 s39, s39, 16
  s_lshl_b32 s39, s39, 8
  v_cvt_pk_bf16_f32 v106, v108, v109
  v_mfma_f32_16x16x32_bf16 a[88:91], a[168:171], v[16:19], a[88:91]
  s_add_u32 s39, s39, 2818304
  s_cmp_lt_u32 s2, 240
  s_cselect_b32 s48, 0, 1073741824
  v_exp_f32 v110, v110
  v_mfma_f32_16x16x32_bf16 a[88:91], a[172:175], v[48:51], a[88:91]
  v_or_b32 v249, s48, v251
  v_mfma_f32_16x16x32_bf16 a[92:95], a[172:175], v[56:59], a[92:95]
  s_waitcnt lgkmcnt(4)
  v_exp_f32 v111, v111
  v_mfma_f32_16x16x32_bf16 a[92:95], a[168:171], v[24:27], a[92:95]
  buffer_atomic_add v250, v249, s[24:27], s39 offen
  v_cvt_pk_bf16_f32 v107, v110, v111
  v_mfma_f32_16x16x32_bf16 a[96:99], a[176:179], v[0:3], a[96:99]
  v_exp_f32 v116, v116
  v_mfma_f32_16x16x32_bf16 a[96:99], a[180:183], v[32:35], a[96:99]
  v_mfma_f32_16x16x32_bf16 a[100:103], a[180:183], v[40:43], a[100:103]
  v_exp_f32 v117, v117
  v_mfma_f32_16x16x32_bf16 a[100:103], a[176:179], v[8:11], a[100:103]
  v_cvt_pk_bf16_f32 v114, v116, v117
  v_mfma_f32_16x16x32_bf16 a[104:107], a[176:179], v[16:19], a[104:107]
  v_exp_f32 v118, v118
  v_mfma_f32_16x16x32_bf16 a[104:107], a[180:183], v[48:51], a[104:107]
  v_mfma_f32_16x16x32_bf16 a[108:111], a[180:183], v[56:59], a[108:111]
  s_waitcnt lgkmcnt(0)
  v_exp_f32 v119, v119
  v_mfma_f32_16x16x32_bf16 a[108:111], a[176:179], v[24:27], a[108:111]
  v_cvt_pk_bf16_f32 v115, v118, v119
  v_mfma_f32_16x16x32_bf16 a[112:115], a[184:187], v[0:3], a[112:115]
  v_exp_f32 v124, v124
  v_mfma_f32_16x16x32_bf16 a[112:115], a[188:191], v[32:35], a[112:115]
  v_mfma_f32_16x16x32_bf16 a[116:119], a[188:191], v[40:43], a[116:119]
  v_exp_f32 v125, v125
  v_mfma_f32_16x16x32_bf16 a[116:119], a[184:187], v[8:11], a[116:119]
  v_cvt_pk_bf16_f32 v122, v124, v125
  v_mfma_f32_16x16x32_bf16 a[120:123], a[184:187], v[16:19], a[120:123]
  v_exp_f32 v126, v126
  v_mfma_f32_16x16x32_bf16 a[120:123], a[188:191], v[48:51], a[120:123]
  v_mfma_f32_16x16x32_bf16 a[124:127], a[188:191], v[56:59], a[124:127]
  v_exp_f32 v127, v127
  v_mfma_f32_16x16x32_bf16 a[124:127], a[184:187], v[24:27], a[124:127]
  v_cvt_pk_bf16_f32 v123, v126, v127
  ds_read_b64_tr_b16 a[160:161], v216 offset:49152
  ds_read_b64_tr_b16 a[162:163], v216 offset:53248
  ds_read_b64_tr_b16 a[164:165], v216 offset:57344
  ds_read_b64_tr_b16 a[166:167], v216 offset:61440
  ds_read_b64_tr_b16 a[168:169], v217 offset:49152
  ds_read_b64_tr_b16 a[170:171], v217 offset:53248
  ds_read_b64_tr_b16 a[172:173], v217 offset:57344
  ds_read_b64_tr_b16 a[174:175], v217 offset:61440
  s_mov_b32 s48, 0x53800000
  s_lshl_b32 s39, s3, 8
  v_mfma_f32_16x16x32_bf16 a[192:195], a[208:211], v[64:67], a[192:195]
  s_add_u32 m0, s28, 81920
  v_mfma_f32_16x16x32_bf16 a[192:195], a[208:211], v[96:99], a[192:195]
  v_mfma_f32_16x16x32_bf16 a[196:199], a[208:211], v[72:75], a[196:199]
  buffer_load_dwordx4 v242, s[24:27], s10 offen offset:0 sc1 lds
  v_mfma_f32_16x16x32_bf16 a[196:199], a[208:211], v[104:107], a[196:199]
  v_mfma_f32_16x16x32_bf16 a[200:203], a[208:211], v[80:83], a[200:203]
  buffer_load_dwordx4 v242, s[24:27], s10 offen offset:1024 sc1 lds
  v_mfma_f32_16x16x32_bf16 a[200:203], a[208:211], v[112:115], a[200:203]
  v_mfma_f32_16x16x32_bf16 a[204:207], a[208:211], v[88:91], a[204:207]
  buffer_load_dwordx4 v242, s[24:27], s10 offen offset:2048 sc1 lds
  v_mfma_f32_16x16x32_bf16 a[204:207], a[208:211], v[120:123], a[204:207]
  s_waitcnt lgkmcnt(4)
  v_mfma_f32_16x16x32_bf16 a[0:3], a[160:163], v[64:67], a[0:3]
  buffer_load_dwordx4 v242, s[24:27], s10 offen offset:3072 sc1 lds
  v_mfma_f32_16x16x32_bf16 a[0:3], a[164:167], v[96:99], a[0:3]
  ds_read_b64_tr_b16 a[176:177], v218 offset:49152
  v_mfma_f32_16x16x32_bf16 a[4:7], a[164:167], v[104:107], a[4:7]
  buffer_load_dwordx4 a[128:131], v253, s[24:27], s4 offen offset:3072 sc1
  v_mfma_f32_16x16x32_bf16 a[4:7], a[160:163], v[72:75], a[4:7]
  ds_read_b64_tr_b16 a[178:179], v218 offset:53248
  v_accvgpr_read_b32 v208, a192
  v_mfma_f32_16x16x32_bf16 a[8:11], a[160:163], v[80:83], a[8:11]
  v_accvgpr_read_b32 v209, a196
  v_accvgpr_read_b32 v210, a200
  v_mfma_f32_16x16x32_bf16 a[8:11], a[164:167], v[112:115], a[8:11]
  ds_read_b64_tr_b16 a[180:181], v218 offset:57344
  v_accvgpr_read_b32 v211, a204
  v_mfma_f32_16x16x32_bf16 a[12:15], a[164:167], v[120:123], a[12:15]
  v_mov_b32 v245, v208
  v_mov_b32 v246, v209
  v_mfma_f32_16x16x32_bf16 a[12:15], a[160:163], v[88:91], a[12:15]
  ds_read_b64_tr_b16 a[182:183], v218 offset:61440
  s_waitcnt lgkmcnt(4)
  v_mov_b32 v247, v210
  v_mfma_f32_16x16x32_bf16 a[16:19], a[168:171], v[64:67], a[16:19]
  v_mov_b32 v248, v211
  v_permlane16_swap_b32 v208, v245
  v_mfma_f32_16x16x32_bf16 a[16:19], a[172:175], v[96:99], a[16:19]
  ds_read_b64_tr_b16 a[184:185], v219 offset:49152
  v_permlane16_swap_b32 v209, v246
  v_mfma_f32_16x16x32_bf16 a[20:23], a[172:175], v[104:107], a[20:23]
  v_permlane16_swap_b32 v210, v247
  v_permlane16_swap_b32 v211, v248
  v_mfma_f32_16x16x32_bf16 a[20:23], a[168:171], v[72:75], a[20:23]
  ds_read_b64_tr_b16 a[186:187], v219 offset:53248
  v_add_f32 v208, v208, v245
  v_mfma_f32_16x16x32_bf16 a[24:27], a[168:171], v[80:83], a[24:27]
  v_add_f32 v209, v209, v246
  v_add_f32 v210, v210, v247
  v_mfma_f32_16x16x32_bf16 a[24:27], a[172:175], v[112:115], a[24:27]
  ds_read_b64_tr_b16 a[188:189], v219 offset:57344
  v_add_f32 v211, v211, v248
  v_mfma_f32_16x16x32_bf16 a[28:31], a[172:175], v[120:123], a[28:31]
  v_mov_b32 v245, v208
  v_mov_b32 v246, v209
  v_mfma_f32_16x16x32_bf16 a[28:31], a[168:171], v[88:91], a[28:31]
  ds_read_b64_tr_b16 a[190:191], v219 offset:61440
  s_waitcnt lgkmcnt(4)
  v_mov_b32 v247, v210
  v_mfma_f32_16x16x32_bf16 a[32:35], a[176:179], v[64:67], a[32:35]
  v_mov_b32 v248, v211
  v_permlane32_swap_b32 v208, v245
  v_mfma_f32_16x16x32_bf16 a[32:35], a[180:183], v[96:99], a[32:35]
  ds_read_b64_tr_b16 a[160:161], v220 offset:49152
  v_permlane32_swap_b32 v209, v246
  v_mfma_f32_16x16x32_bf16 a[36:39], a[180:183], v[104:107], a[36:39]
  v_permlane32_swap_b32 v210, v247
  v_permlane32_swap_b32 v211, v248
  v_mfma_f32_16x16x32_bf16 a[36:39], a[176:179], v[72:75], a[36:39]
  ds_read_b64_tr_b16 a[162:163], v220 offset:53248
  v_add_f32 v208, v208, v245
  v_mfma_f32_16x16x32_bf16 a[40:43], a[176:179], v[80:83], a[40:43]
  v_add_f32 v209, v209, v246
  v_add_f32 v210, v210, v247
  v_mfma_f32_16x16x32_bf16 a[40:43], a[180:183], v[112:115], a[40:43]
  ds_read_b64_tr_b16 a[164:165], v220 offset:57344
  v_add_f32 v211, v211, v248
  buffer_load_dwordx4 a[132:135], v242, s[24:27], s5 offen offset:0 sc1
  buffer_load_dwordx4 a[136:139], v242, s[24:27], s5 offen offset:1024 sc1
  buffer_load_dwordx4 a[140:143], v242, s[24:27], s5 offen offset:2048 sc1
  buffer_load_dwordx4 a[144:147], v242, s[24:27], s5 offen offset:3072 sc1
  buffer_load_dwordx4 a[148:151], v252, s[24:27], s5 offen offset:0 sc1
  buffer_load_dwordx4 a[152:155], v252, s[24:27], s5 offen offset:1024 sc1
  buffer_load_dwordx4 a[156:159], v252, s[24:27], s5 offen offset:2048 sc1
  v_mfma_f32_16x16x32_bf16 a[44:47], a[180:183], v[120:123], a[44:47]
  v_rcp_f32 v192, v208
  v_mfma_f32_16x16x32_bf16 a[44:47], a[176:179], v[88:91], a[44:47]
  ds_read_b64_tr_b16 a[166:167], v220 offset:61440
  s_waitcnt lgkmcnt(4)
  v_mfma_f32_16x16x32_bf16 a[48:51], a[184:187], v[64:67], a[48:51]
  v_rcp_f32 v196, v209
  v_mfma_f32_16x16x32_bf16 a[48:51], a[188:191], v[96:99], a[48:51]
  ds_read_b64_tr_b16 a[168:169], v221 offset:49152
  v_mfma_f32_16x16x32_bf16 a[52:55], a[188:191], v[104:107], a[52:55]
  v_rcp_f32 v200, v210
  v_mfma_f32_16x16x32_bf16 a[52:55], a[184:187], v[72:75], a[52:55]
  ds_read_b64_tr_b16 a[170:171], v221 offset:53248
  v_mfma_f32_16x16x32_bf16 a[56:59], a[184:187], v[80:83], a[56:59]
  v_rcp_f32 v204, v211
  v_mfma_f32_16x16x32_bf16 a[56:59], a[188:191], v[112:115], a[56:59]
  ds_read_b64_tr_b16 a[172:173], v221 offset:57344
  v_add_f32 v246, v208, v209
  v_mfma_f32_16x16x32_bf16 a[60:63], a[188:191], v[120:123], a[60:63]
  v_add_f32 v247, v210, v211
  v_add_f32 v246, v246, v247
  v_mfma_f32_16x16x32_bf16 a[60:63], a[184:187], v[88:91], a[60:63]
  ds_read_b64_tr_b16 a[174:175], v221 offset:61440
  s_waitcnt lgkmcnt(4)
  v_lshrrev_b32 v247, 2, v242
  v_mfma_f32_16x16x32_bf16 a[64:67], a[160:163], v[64:67], a[64:67]
  v_cmp_nlt_f32 vcc, v246, s48
  v_add_u32 v247, s39, v247
  v_mfma_f32_16x16x32_bf16 a[64:67], a[164:167], v[96:99], a[64:67]
  ds_read_b64_tr_b16 a[176:177], v222 offset:49152
  v_add_u32 v247, 157696, v247
  v_mfma_f32_16x16x32_bf16 a[68:71], a[164:167], v[104:107], a[68:71]
  v_cndmask_b32_e64 v245, 0, 1, vcc
  v_accvgpr_read_b32 v0, a0
  v_mfma_f32_16x16x32_bf16 a[68:71], a[160:163], v[72:75], a[68:71]
  ds_read_b64_tr_b16 a[178:179], v222 offset:53248
  v_accvgpr_read_b32 v1, a1
  v_mfma_f32_16x16x32_bf16 a[72:75], a[160:163], v[80:83], a[72:75]
  v_accvgpr_read_b32 v2, a2
  v_accvgpr_read_b32 v3, a3
  v_mfma_f32_16x16x32_bf16 a[72:75], a[164:167], v[112:115], a[72:75]
  ds_read_b64_tr_b16 a[180:181], v222 offset:57344
  v_accvgpr_read_b32 v4, a16
  v_mfma_f32_16x16x32_bf16 a[76:79], a[164:167], v[120:123], a[76:79]
  v_accvgpr_read_b32 v5, a17
  v_accvgpr_read_b32 v6, a18
  v_mfma_f32_16x16x32_bf16 a[76:79], a[160:163], v[88:91], a[76:79]
  ds_read_b64_tr_b16 a[182:183], v222 offset:61440
  s_waitcnt lgkmcnt(4)
  v_accvgpr_read_b32 v7, a19
  v_mfma_f32_16x16x32_bf16 a[80:83], a[168:171], v[64:67], a[80:83]
  v_mul_f32 v0, v0, v192
  v_mul_f32 v1, v1, v192
  v_mfma_f32_16x16x32_bf16 a[80:83], a[172:175], v[96:99], a[80:83]
  ds_read_b64_tr_b16 a[184:185], v223 offset:49152
  v_mul_f32 v2, v2, v192
  v_mfma_f32_16x16x32_bf16 a[84:87], a[172:175], v[104:107], a[84:87]
  v_mul_f32 v3, v3, v192
  v_mul_f32 v4, v4, v192
  v_mfma_f32_16x16x32_bf16 a[84:87], a[168:171], v[72:75], a[84:87]
  ds_read_b64_tr_b16 a[186:187], v223 offset:53248
  v_mul_f32 v5, v5, v192
  v_mfma_f32_16x16x32_bf16 a[88:91], a[168:171], v[80:83], a[88:91]
  v_mul_f32 v6, v6, v192
  v_mul_f32 v7, v7, v192
  v_mfma_f32_16x16x32_bf16 a[88:91], a[172:175], v[112:115], a[88:91]
  ds_read_b64_tr_b16 a[188:189], v223 offset:57344
  v_cvt_pk_bf16_f32 v0, v0, v1
  v_mfma_f32_16x16x32_bf16 a[92:95], a[172:175], v[120:123], a[92:95]
  v_cvt_pk_bf16_f32 v1, v2, v3
  v_cvt_pk_bf16_f32 v2, v4, v5
  v_mfma_f32_16x16x32_bf16 a[92:95], a[168:171], v[88:91], a[92:95]
  ds_read_b64_tr_b16 a[190:191], v223 offset:61440
  s_waitcnt lgkmcnt(4)
  v_cvt_pk_bf16_f32 v3, v6, v7
  v_mfma_f32_16x16x32_bf16 a[96:99], a[176:179], v[64:67], a[96:99]
  buffer_store_dwordx4 v[0:3], v244, s[24:27], s40 offen offset:0 sc1
  v_mfma_f32_16x16x32_bf16 a[96:99], a[180:183], v[96:99], a[96:99]
  v_accvgpr_read_b32 v8, a4
  v_accvgpr_read_b32 v9, a5
  v_mfma_f32_16x16x32_bf16 a[100:103], a[180:183], v[104:107], a[100:103]
  v_accvgpr_read_b32 v10, a6
  v_accvgpr_read_b32 v11, a7
  v_mfma_f32_16x16x32_bf16 a[100:103], a[176:179], v[72:75], a[100:103]
  v_accvgpr_read_b32 v12, a20
  v_accvgpr_read_b32 v13, a21
  v_mfma_f32_16x16x32_bf16 a[104:107], a[176:179], v[80:83], a[104:107]
  v_accvgpr_read_b32 v14, a22
  v_accvgpr_read_b32 v15, a23
  v_mfma_f32_16x16x32_bf16 a[104:107], a[180:183], v[112:115], a[104:107]
  v_mul_f32 v8, v8, v196
  v_mul_f32 v9, v9, v196
  v_mfma_f32_16x16x32_bf16 a[108:111], a[180:183], v[120:123], a[108:111]
  v_mul_f32 v10, v10, v196
  v_mul_f32 v11, v11, v196
  v_mfma_f32_16x16x32_bf16 a[108:111], a[176:179], v[88:91], a[108:111]
  s_waitcnt lgkmcnt(0)
  v_mul_f32 v12, v12, v196
  v_mul_f32 v13, v13, v196
  v_mfma_f32_16x16x32_bf16 a[112:115], a[184:187], v[64:67], a[112:115]
  v_mul_f32 v14, v14, v196
  v_mul_f32 v15, v15, v196
  v_mfma_f32_16x16x32_bf16 a[112:115], a[188:191], v[96:99], a[112:115]
  v_cvt_pk_bf16_f32 v8, v8, v9
  v_cvt_pk_bf16_f32 v9, v10, v11
  v_mfma_f32_16x16x32_bf16 a[116:119], a[188:191], v[104:107], a[116:119]
  v_cvt_pk_bf16_f32 v10, v12, v13
  v_cvt_pk_bf16_f32 v11, v14, v15
  v_mfma_f32_16x16x32_bf16 a[116:119], a[184:187], v[72:75], a[116:119]
  buffer_store_dwordx4 v[8:11], v244, s[24:27], s40 offen offset:2048 sc1
  v_mfma_f32_16x16x32_bf16 a[120:123], a[184:187], v[80:83], a[120:123]
  v_accvgpr_read_b32 v16, a8
  v_accvgpr_read_b32 v17, a9
  v_mfma_f32_16x16x32_bf16 a[120:123], a[188:191], v[112:115], a[120:123]
  v_accvgpr_read_b32 v18, a10
  v_accvgpr_read_b32 v19, a11
  v_mfma_f32_16x16x32_bf16 a[124:127], a[188:191], v[120:123], a[124:127]
  v_accvgpr_read_b32 v20, a24
  v_accvgpr_read_b32 v21, a25
  v_mfma_f32_16x16x32_bf16 a[124:127], a[184:187], v[88:91], a[124:127]
  v_accvgpr_read_b32 v22, a26
  v_accvgpr_read_b32 v23, a27
  v_pk_mul_f32 v[16:17], v[16:17], v[200:201] op_sel_hi:[1,0]
  v_pk_mul_f32 v[18:19], v[18:19], v[200:201] op_sel_hi:[1,0]
  v_pk_mul_f32 v[20:21], v[20:21], v[200:201] op_sel_hi:[1,0]
  v_pk_mul_f32 v[22:23], v[22:23], v[200:201] op_sel_hi:[1,0]
  v_cvt_pk_bf16_f32 v16, v16, v17
  v_cvt_pk_bf16_f32 v17, v18, v19
  v_cvt_pk_bf16_f32 v18, v20, v21
  v_cvt_pk_bf16_f32 v19, v22, v23
  buffer_store_dwordx4 v[16:19], v244, s[24:27], s41 offen offset:0 sc1
  v_accvgpr_read_b32 v24, a12
  v_accvgpr_read_b32 v25, a13
  v_accvgpr_read_b32 v26, a14
  v_accvgpr_read_b32 v27, a15
  v_accvgpr_read_b32 v28, a28
  v_accvgpr_read_b32 v29, a29
  v_accvgpr_read_b32 v30, a30
  v_accvgpr_read_b32 v31, a31
  v_pk_mul_f32 v[24:25], v[24:25], v[204:205] op_sel_hi:[1,0]
  v_pk_mul_f32 v[26:27], v[26:27], v[204:205] op_sel_hi:[1,0]
  v_pk_mul_f32 v[28:29], v[28:29], v[204:205] op_sel_hi:[1,0]
  v_pk_mul_f32 v[30:31], v[30:31], v[204:205] op_sel_hi:[1,0]
  v_cvt_pk_bf16_f32 v24, v24, v25
  v_cvt_pk_bf16_f32 v25, v26, v27
  v_cvt_pk_bf16_f32 v26, v28, v29
  v_cvt_pk_bf16_f32 v27, v30, v31
  buffer_store_dwordx4 v[24:27], v244, s[24:27], s41 offen offset:2048 sc1
  v_accvgpr_read_b32 v32, a32
  v_accvgpr_read_b32 v33, a33
  v_accvgpr_read_b32 v34, a34
  v_accvgpr_read_b32 v35, a35
  v_accvgpr_read_b32 v36, a48
  v_accvgpr_read_b32 v37, a49
  v_accvgpr_read_b32 v38, a50
  v_accvgpr_read_b32 v39, a51
  v_pk_mul_f32 v[32:33], v[32:33], v[192:193] op_sel_hi:[1,0]
  v_pk_mul_f32 v[34:35], v[34:35], v[192:193] op_sel_hi:[1,0]
  v_pk_mul_f32 v[36:37], v[36:37], v[192:193] op_sel_hi:[1,0]
  v_pk_mul_f32 v[38:39], v[38:39], v[192:193] op_sel_hi:[1,0]
  v_cvt_pk_bf16_f32 v32, v32, v33
  v_cvt_pk_bf16_f32 v33, v34, v35
  v_cvt_pk_bf16_f32 v34, v36, v37
  v_cvt_pk_bf16_f32 v35, v38, v39
  buffer_store_dwordx4 v[32:35], v244, s[24:27], s40 offen offset:1024 sc1
  v_accvgpr_read_b32 v40, a36
  v_accvgpr_read_b32 v41, a37
  v_accvgpr_read_b32 v42, a38
  v_accvgpr_read_b32 v43, a39
  v_accvgpr_read_b32 v44, a52
  v_accvgpr_read_b32 v45, a53
  v_accvgpr_read_b32 v46, a54
  v_accvgpr_read_b32 v47, a55
  v_pk_mul_f32 v[40:41], v[40:41], v[196:197] op_sel_hi:[1,0]
  v_pk_mul_f32 v[42:43], v[42:43], v[196:197] op_sel_hi:[1,0]
  v_pk_mul_f32 v[44:45], v[44:45], v[196:197] op_sel_hi:[1,0]
  v_pk_mul_f32 v[46:47], v[46:47], v[196:197] op_sel_hi:[1,0]
  v_cvt_pk_bf16_f32 v40, v40, v41
  v_cvt_pk_bf16_f32 v41, v42, v43
  v_cvt_pk_bf16_f32 v42, v44, v45
  v_cvt_pk_bf16_f32 v43, v46, v47
  buffer_store_dwordx4 v[40:43], v244, s[24:27], s40 offen offset:3072 sc1
  v_accvgpr_read_b32 v48, a40
  v_accvgpr_read_b32 v49, a41
  v_accvgpr_read_b32 v50, a42
  v_accvgpr_read_b32 v51, a43
  v_accvgpr_read_b32 v52, a56
  v_accvgpr_read_b32 v53, a57
  v_accvgpr_read_b32 v54, a58
  v_accvgpr_read_b32 v55, a59
  v_pk_mul_f32 v[48:49], v[48:49], v[200:201] op_sel_hi:[1,0]
  v_pk_mul_f32 v[50:51], v[50:51], v[200:201] op_sel_hi:[1,0]
  v_pk_mul_f32 v[52:53], v[52:53], v[200:201] op_sel_hi:[1,0]
  v_pk_mul_f32 v[54:55], v[54:55], v[200:201] op_sel_hi:[1,0]
  v_cvt_pk_bf16_f32 v48, v48, v49
  v_cvt_pk_bf16_f32 v49, v50, v51
  v_cvt_pk_bf16_f32 v50, v52, v53
  v_cvt_pk_bf16_f32 v51, v54, v55
  buffer_store_dwordx4 v[48:51], v244, s[24:27], s41 offen offset:1024 sc1
  v_accvgpr_read_b32 v56, a44
  v_accvgpr_read_b32 v57, a45
  v_accvgpr_read_b32 v58, a46
  v_accvgpr_read_b32 v59, a47
  v_accvgpr_read_b32 v60, a60
  v_accvgpr_read_b32 v61, a61
  v_accvgpr_read_b32 v62, a62
  v_accvgpr_read_b32 v63, a63
  v_pk_mul_f32 v[56:57], v[56:57], v[204:205] op_sel_hi:[1,0]
  v_pk_mul_f32 v[58:59], v[58:59], v[204:205] op_sel_hi:[1,0]
  v_pk_mul_f32 v[60:61], v[60:61], v[204:205] op_sel_hi:[1,0]
  v_pk_mul_f32 v[62:63], v[62:63], v[204:205] op_sel_hi:[1,0]
  v_cvt_pk_bf16_f32 v56, v56, v57
  v_cvt_pk_bf16_f32 v57, v58, v59
  v_cvt_pk_bf16_f32 v58, v60, v61
  v_cvt_pk_bf16_f32 v59, v62, v63
  buffer_store_dwordx4 v[56:59], v244, s[24:27], s41 offen offset:3072 sc1
  v_accvgpr_read_b32 v0, a64
  v_accvgpr_read_b32 v1, a65
  v_accvgpr_read_b32 v2, a66
  v_accvgpr_read_b32 v3, a67
  v_accvgpr_read_b32 v4, a80
  v_accvgpr_read_b32 v5, a81
  v_accvgpr_read_b32 v6, a82
  v_accvgpr_read_b32 v7, a83
  v_pk_mul_f32 v[0:1], v[0:1], v[192:193] op_sel_hi:[1,0]
  v_pk_mul_f32 v[2:3], v[2:3], v[192:193] op_sel_hi:[1,0]
  v_pk_mul_f32 v[4:5], v[4:5], v[192:193] op_sel_hi:[1,0]
  v_pk_mul_f32 v[6:7], v[6:7], v[192:193] op_sel_hi:[1,0]
  v_cvt_pk_bf16_f32 v0, v0, v1
  v_cvt_pk_bf16_f32 v1, v2, v3
  v_cvt_pk_bf16_f32 v2, v4, v5
  v_cvt_pk_bf16_f32 v3, v6, v7
  buffer_store_dwordx4 v[0:3], v244, s[24:27], s42 offen offset:0 sc1
  v_accvgpr_read_b32 v8, a68
  v_accvgpr_read_b32 v9, a69
  v_accvgpr_read_b32 v10, a70
  v_accvgpr_read_b32 v11, a71
  v_accvgpr_read_b32 v12, a84
  v_accvgpr_read_b32 v13, a85
  v_accvgpr_read_b32 v14, a86
  v_accvgpr_read_b32 v15, a87
  v_pk_mul_f32 v[8:9], v[8:9], v[196:197] op_sel_hi:[1,0]
  v_pk_mul_f32 v[10:11], v[10:11], v[196:197] op_sel_hi:[1,0]
  v_pk_mul_f32 v[12:13], v[12:13], v[196:197] op_sel_hi:[1,0]
  v_pk_mul_f32 v[14:15], v[14:15], v[196:197] op_sel_hi:[1,0]
  v_cvt_pk_bf16_f32 v8, v8, v9
  v_cvt_pk_bf16_f32 v9, v10, v11
  v_cvt_pk_bf16_f32 v10, v12, v13
  v_cvt_pk_bf16_f32 v11, v14, v15
  buffer_store_dwordx4 v[8:11], v244, s[24:27], s42 offen offset:2048 sc1
  v_accvgpr_read_b32 v16, a72
  v_accvgpr_read_b32 v17, a73
  v_accvgpr_read_b32 v18, a74
  v_accvgpr_read_b32 v19, a75
  v_accvgpr_read_b32 v20, a88
  v_accvgpr_read_b32 v21, a89
  v_accvgpr_read_b32 v22, a90
  v_accvgpr_read_b32 v23, a91
  v_pk_mul_f32 v[16:17], v[16:17], v[200:201] op_sel_hi:[1,0]
  v_pk_mul_f32 v[18:19], v[18:19], v[200:201] op_sel_hi:[1,0]
  v_pk_mul_f32 v[20:21], v[20:21], v[200:201] op_sel_hi:[1,0]
  v_pk_mul_f32 v[22:23], v[22:23], v[200:201] op_sel_hi:[1,0]
  v_cvt_pk_bf16_f32 v16, v16, v17
  v_cvt_pk_bf16_f32 v17, v18, v19
  v_cvt_pk_bf16_f32 v18, v20, v21
  v_cvt_pk_bf16_f32 v19, v22, v23
  buffer_store_dwordx4 v[16:19], v244, s[24:27], s43 offen offset:0 sc1
  v_accvgpr_read_b32 v24, a76
  v_accvgpr_read_b32 v25, a77
  v_accvgpr_read_b32 v26, a78
  v_accvgpr_read_b32 v27, a79
  v_accvgpr_read_b32 v28, a92
  v_accvgpr_read_b32 v29, a93
  v_accvgpr_read_b32 v30, a94
  v_accvgpr_read_b32 v31, a95
  v_pk_mul_f32 v[24:25], v[24:25], v[204:205] op_sel_hi:[1,0]
  v_pk_mul_f32 v[26:27], v[26:27], v[204:205] op_sel_hi:[1,0]
  v_pk_mul_f32 v[28:29], v[28:29], v[204:205] op_sel_hi:[1,0]
  v_pk_mul_f32 v[30:31], v[30:31], v[204:205] op_sel_hi:[1,0]
  v_cvt_pk_bf16_f32 v24, v24, v25
  v_cvt_pk_bf16_f32 v25, v26, v27
  v_cvt_pk_bf16_f32 v26, v28, v29
  v_cvt_pk_bf16_f32 v27, v30, v31
  buffer_store_dwordx4 v[24:27], v244, s[24:27], s43 offen offset:2048 sc1
  v_accvgpr_read_b32 v32, a96
  v_accvgpr_read_b32 v33, a97
  v_accvgpr_read_b32 v34, a98
  v_accvgpr_read_b32 v35, a99
  v_accvgpr_read_b32 v36, a112
  v_accvgpr_read_b32 v37, a113
  v_accvgpr_read_b32 v38, a114
  v_accvgpr_read_b32 v39, a115
  v_pk_mul_f32 v[32:33], v[32:33], v[192:193] op_sel_hi:[1,0]
  v_pk_mul_f32 v[34:35], v[34:35], v[192:193] op_sel_hi:[1,0]
  v_pk_mul_f32 v[36:37], v[36:37], v[192:193] op_sel_hi:[1,0]
  v_pk_mul_f32 v[38:39], v[38:39], v[192:193] op_sel_hi:[1,0]
  v_cvt_pk_bf16_f32 v32, v32, v33
  v_cvt_pk_bf16_f32 v33, v34, v35
  v_cvt_pk_bf16_f32 v34, v36, v37
  v_cvt_pk_bf16_f32 v35, v38, v39
  buffer_store_dwordx4 v[32:35], v244, s[24:27], s42 offen offset:1024 sc1
  v_accvgpr_read_b32 v40, a100
  v_accvgpr_read_b32 v41, a101
  v_accvgpr_read_b32 v42, a102
  v_accvgpr_read_b32 v43, a103
  v_accvgpr_read_b32 v44, a116
  v_accvgpr_read_b32 v45, a117
  v_accvgpr_read_b32 v46, a118
  v_accvgpr_read_b32 v47, a119
  v_pk_mul_f32 v[40:41], v[40:41], v[196:197] op_sel_hi:[1,0]
  v_pk_mul_f32 v[42:43], v[42:43], v[196:197] op_sel_hi:[1,0]
  v_pk_mul_f32 v[44:45], v[44:45], v[196:197] op_sel_hi:[1,0]
  v_pk_mul_f32 v[46:47], v[46:47], v[196:197] op_sel_hi:[1,0]
  v_cvt_pk_bf16_f32 v40, v40, v41
  v_cvt_pk_bf16_f32 v41, v42, v43
  v_cvt_pk_bf16_f32 v42, v44, v45
  v_cvt_pk_bf16_f32 v43, v46, v47
  buffer_store_dwordx4 v[40:43], v244, s[24:27], s42 offen offset:3072 sc1
  v_accvgpr_read_b32 v48, a104
  v_accvgpr_read_b32 v49, a105
  v_accvgpr_read_b32 v50, a106
  v_accvgpr_read_b32 v51, a107
  v_accvgpr_read_b32 v52, a120
  v_accvgpr_read_b32 v53, a121
  v_accvgpr_read_b32 v54, a122
  v_accvgpr_read_b32 v55, a123
  v_pk_mul_f32 v[48:49], v[48:49], v[200:201] op_sel_hi:[1,0]
  v_pk_mul_f32 v[50:51], v[50:51], v[200:201] op_sel_hi:[1,0]
  v_pk_mul_f32 v[52:53], v[52:53], v[200:201] op_sel_hi:[1,0]
  v_pk_mul_f32 v[54:55], v[54:55], v[200:201] op_sel_hi:[1,0]
  v_cvt_pk_bf16_f32 v48, v48, v49
  v_cvt_pk_bf16_f32 v49, v50, v51
  v_cvt_pk_bf16_f32 v50, v52, v53
  v_cvt_pk_bf16_f32 v51, v54, v55
  buffer_store_dwordx4 v[48:51], v244, s[24:27], s43 offen offset:1024 sc1
  v_accvgpr_read_b32 v56, a108
  v_accvgpr_read_b32 v57, a109
  v_accvgpr_read_b32 v58, a110
  v_accvgpr_read_b32 v59, a111
  v_accvgpr_read_b32 v60, a124
  v_accvgpr_read_b32 v61, a125
  v_accvgpr_read_b32 v62, a126
  v_accvgpr_read_b32 v63, a127
  v_pk_mul_f32 v[56:57], v[56:57], v[204:205] op_sel_hi:[1,0]
  v_pk_mul_f32 v[58:59], v[58:59], v[204:205] op_sel_hi:[1,0]
  v_pk_mul_f32 v[60:61], v[60:61], v[204:205] op_sel_hi:[1,0]
  v_pk_mul_f32 v[62:63], v[62:63], v[204:205] op_sel_hi:[1,0]
  v_cvt_pk_bf16_f32 v56, v56, v57
  v_cvt_pk_bf16_f32 v57, v58, v59
  v_cvt_pk_bf16_f32 v58, v60, v61
  v_cvt_pk_bf16_f32 v59, v62, v63
  buffer_store_dwordx4 v[56:59], v244, s[24:27], s43 offen offset:3072 sc1
  ds_write_b32 v247, v245
  buffer_load_dwordx4 a[0:3], v252, s[24:27], s5 offen offset:3072 sc1
  buffer_load_dwordx4 a[4:7], v253, s[24:27], s5 offen offset:0 sc1
  buffer_load_dwordx4 a[8:11], v253, s[24:27], s5 offen offset:1024 sc1
  buffer_load_dwordx4 a[12:15], v253, s[24:27], s5 offen offset:2048 sc1
  buffer_load_dwordx4 a[16:19], v253, s[24:27], s5 offen offset:3072 sc1
  buffer_load_dwordx4 a[20:23], v242, s[24:27], s6 offen offset:0 sc1
  buffer_load_dwordx4 a[24:27], v242, s[24:27], s6 offen offset:1024 sc1
  buffer_load_dwordx4 a[28:31], v242, s[24:27], s6 offen offset:2048 sc1
  buffer_load_dwordx4 a[32:35], v242, s[24:27], s6 offen offset:3072 sc1
  buffer_load_dwordx4 a[36:39], v252, s[24:27], s6 offen offset:0 sc1
  s_and_b32 s39, s2, 63
  s_lshl_b32 s39, s39, 7
  s_add_u32 s39, s39, 2867200
  s_lshl_b32 s38, s3, 26
  v_lshlrev_b32 v64, 22, v242
  v_or_b32 v64, s38, v64
  v_mov_b32 v65, 1
  v_add_u32 v246, 157696, v242
  s_waitcnt vmcnt(10) lgkmcnt(0)
  s_barrier
  ds_read_b128 v[68:71], v246
  s_waitcnt lgkmcnt(0)
  v_or3_b32 v68, v68, v69, v70
  v_or_b32 v68, v68, v71
  v_cmp_ne_u32 vcc, 0, v68
  s_nop 0
  s_cbranch_vccnz attn_redo
tail_go:
  buffer_atomic_add v65, v64, s[24:27], s39 offen
  s_and_b32 s36, s2, 1
  s_bfe_u32 s31, s2, 0x20001
  s_lshl_b32 s31, s31, 2
  s_bfe_u32 s38, s2, 0x20003
  s_add_u32 s31, s31, s38
  s_lshr_b32 s29, s2, 5
  v_mov_b32 v114, v242
  v_add_u32 v115, 0x1000, v114
  v_add_u32 v116, 0x2000, v114
  s_lshl_b32 s38, s36, 2
  s_add_u32 s38, s38, s3
  s_lshl_b32 s30, s38, 16
  buffer_load_dwordx4 a[40:43], v115, s[24:27], s6 offen offset:1024 sc1
  buffer_load_dwordx4 a[44:47], v115, s[24:27], s6 offen offset:2048 sc1
  buffer_load_dwordx4 a[48:51], v115, s[24:27], s6 offen offset:3072 sc1
  buffer_load_dwordx4 a[52:55], v116, s[24:27], s6 offen offset:0 sc1
  v_lshrrev_b32 v125, 4, v114
  v_and_b32 v126, 15, v125
  v_lshrrev_b32 v127, 4, v125
  s_add_u32 s38, s3, 0
  s_and_b32 s38, s38, 3
  s_lshl_b32 s38, s38, 11
  v_add_u32 v110, s38, v114
  s_sub_u32 s38, s3, 0
  s_and_b32 s38, s38, 3
  s_mul_i32 s38, s38, 15360
  s_add_u32 s38, s38, 98304
  v_add_u32 v118, s38, v114
  s_add_u32 s38, s3, 1
  s_and_b32 s38, s38, 3
  s_lshl_b32 s38, s38, 11
  v_add_u32 v111, s38, v114
  s_sub_u32 s38, s3, 1
  s_and_b32 s38, s38, 3
  s_mul_i32 s38, s38, 15360
  s_add_u32 s38, s38, 98304
  v_add_u32 v119, s38, v114
  s_add_u32 s38, s3, 2
  s_and_b32 s38, s38, 3
  s_lshl_b32 s38, s38, 11
  v_add_u32 v112, s38, v114
  s_sub_u32 s38, s3, 2
  s_and_b32 s38, s38, 3
  s_mul_i32 s38, s38, 15360
  s_add_u32 s38, s38, 98304
  v_add_u32 v120, s38, v114
  s_add_u32 s38, s3, 3
  s_and_b32 s38, s38, 3
  s_lshl_b32 s38, s38, 11
  v_add_u32 v113, s38, v114
  s_sub_u32 s38, s3, 3
  s_and_b32 s38, s38, 3
  s_mul_i32 s38, s38, 15360
  s_add_u32 s38, s38, 98304
  v_add_u32 v121, s38, v114
  v_add_u32 v122, s28, v114
  v_add_u32 v135, 0x10000, v122
  s_and_b32 s38, s31, 14
  s_add_u32 s38, s38, s36
  s_lshl_b32 s38, s38, 2
  s_add_u32 s38, s38, s3
  s_lshl_b32 s38, s38, 7
  s_add_u32 s38, s38, 2867200
  s_lshl_b32 s39, s29, 8
  s_add_u32 s39, s39, 2818304
  v_mov_b32 v133, s38
  v_writelane_b32 v133, s39, 1
  v_mov_b32 v134, 4
  v_writelane_b32 v134, 30, 1
  s_lshl_b32 s31, s31, 1
  s_add_u32 s31, s31, s36
  s_add_u32 s30, s30, 8388608
  s_lshl_b32 s38, s31, 19
  s_add_u32 s37, s30, s38
  s_xor_b32 s38, s38, 0x80000
  s_add_u32 s30, s30, s38
  s_lshl_b32 s40, s29, 5
  s_add_u32 s40, s40, s31
  s_lshl_b32 s38, s31, 6
  s_lshl_b32 s39, s3, 4
  s_add_u32 s38, s38, s39
  v_add_u32 v128, s38, v126
  v_mul_u32_u24 v117, 0x500, v128
  v_lshl_add_u32 v117, v127, 3, v117
  s_mul_i32 s38, s29, 160
  v_add_u32 v117, s38, v117
  s_mov_b32 s12, s60
  s_mov_b32 s13, s61
  s_mov_b32 s14, 2621440
  s_mov_b32 s15, 0x20000
  s_mov_b32 s16, s62
  s_mov_b32 s17, s63
  s_mov_b32 s18, 2621440
  s_mov_b32 s19, 0x20000
  s_mul_i32 s38, s31, 81920
  s_lshl_b32 s39, s3, 10
  s_add_u32 s38, s38, s39
  s_mul_i32 s39, s29, 10
  v_lshrrev_b32 v129, 1, v127
  v_add_u32 v129, s39, v129
  v_and_b32 v130, 1, v127
  v_lshlrev_b32 v130, 3, v130
  v_lshl_add_u32 v130, v126, 4, v130
  v_lshrrev_b32 v131, 2, v129
  v_lshl_add_u32 v131, v131, 12, v130
  v_and_b32 v132, 3, v129
  v_lshl_add_u32 v131, v132, 8, v131
  buffer_load_dwordx2 v[156:157], v131, s[24:27], s38 offen sc1
  v_add_u32 v129, 2, v129
  buffer_load_dwordx2 v[80:81], v117, s[12:15], 0 offen offset:0
  v_lshrrev_b32 v131, 2, v129
  v_lshl_add_u32 v131, v131, 12, v130
  v_and_b32 v132, 3, v129
  v_lshl_add_u32 v131, v132, 8, v131
  buffer_load_dwordx2 v[158:159], v131, s[24:27], s38 offen sc1
  v_add_u32 v129, 2, v129
  buffer_load_dwordx2 v[82:83], v117, s[12:15], 0 offen offset:32
  v_lshrrev_b32 v131, 2, v129
  v_lshl_add_u32 v131, v131, 12, v130
  v_and_b32 v132, 3, v129
  v_lshl_add_u32 v131, v132, 8, v131
  buffer_load_dwordx2 v[160:161], v131, s[24:27], s38 offen sc1
  v_add_u32 v129, 2, v129
  buffer_load_dwordx2 v[84:85], v117, s[12:15], 0 offen offset:64
  v_lshrrev_b32 v131, 2, v129
  v_lshl_add_u32 v131, v131, 12, v130
  v_and_b32 v132, 3, v129
  v_lshl_add_u32 v131, v132, 8, v131
  buffer_load_dwordx2 v[162:163], v131, s[24:27], s38 offen sc1
  v_add_u32 v129, 2, v129
  buffer_load_dwordx2 v[86:87], v117, s[12:15], 0 offen offset:96
  v_lshrrev_b32 v131, 2, v129
  v_lshl_add_u32 v131, v131, 12, v130
  v_and_b32 v132, 3, v129
  v_lshl_add_u32 v131, v132, 8, v131
  buffer_load_dwordx2 v[164:165], v131, s[24:27], s38 offen sc1
  v_add_u32 v129, 2, v129
  buffer_load_dwordx2 v[88:89], v117, s[12:15], 0 offen offset:128
  v_mov_b32 v123, 1073741824
  v_bfrev_b32 v124, 1
  v_sub_u32 v128, 0xffff, v128
  s_mov_b32 s34, 0xffff0000
  s_and_b32 s38, s52, 0xffff
  v_cmp_eq_u32 vcc, s38, v128
  v_mov_b32 v129, s52
  v_mov_b32 v130, 0
  v_cndmask_b32 v124, v124, v129, vcc
  v_cndmask_b32 v123, v123, v130, vcc
  s_and_b32 s38, s53, 0xffff
  v_cmp_eq_u32 vcc, s38, v128
  v_mov_b32 v129, s53
  v_mov_b32 v130, 2560
  v_cndmask_b32 v124, v124, v129, vcc
  v_cndmask_b32 v123, v123, v130, vcc
  s_and_b32 s38, s54, 0xffff
  v_cmp_eq_u32 vcc, s38, v128
  v_mov_b32 v129, s54
  v_mov_b32 v130, 5120
  v_cndmask_b32 v124, v124, v129, vcc
  v_cndmask_b32 v123, v123, v130, vcc
  s_and_b32 s38, s55, 0xffff
  v_cmp_eq_u32 vcc, s38, v128
  v_mov_b32 v129, s55
  v_mov_b32 v130, 7680
  v_cndmask_b32 v124, v124, v129, vcc
  v_cndmask_b32 v123, v123, v130, vcc
  s_and_b32 s38, s56, 0xffff
  v_cmp_eq_u32 vcc, s38, v128
  v_mov_b32 v129, s56
  v_mov_b32 v130, 10240
  v_cndmask_b32 v124, v124, v129, vcc
  v_cndmask_b32 v123, v123, v130, vcc
  s_and_b32 s38, s57, 0xffff
  v_cmp_eq_u32 vcc, s38, v128
  v_mov_b32 v129, s57
  v_mov_b32 v130, 12800
  v_cndmask_b32 v124, v124, v129, vcc
  v_cndmask_b32 v123, v123, v130, vcc
  s_and_b32 s38, s58, 0xffff
  v_cmp_eq_u32 vcc, s38, v128
  v_mov_b32 v129, s58
  v_mov_b32 v130, 15360
  v_cndmask_b32 v124, v124, v129, vcc
  v_cndmask_b32 v123, v123, v130, vcc
  s_and_b32 s38, s59, 0xffff
  v_cmp_eq_u32 vcc, s38, v128
  v_mov_b32 v129, s59
  v_mov_b32 v130, 17920
  v_cndmask_b32 v124, v124, v129, vcc
  v_cndmask_b32 v123, v123, v130, vcc
  v_lshl_add_u32 v123, v127, 4, v123
  s_mul_i32 s32, s29, 320
  s_add_u32 s32, s32, 2686976
  v_ashrrev_i32 v129, 31, v124
  v_not_b32 v129, v129
  v_or_b32 v129, 0x80000000, v129
  v_xor_b32 v124, v124, v129
  v_and_b32 v124, s34, v124
  v_mul_f32 v124, 0xbfb8aa3b, v124
  v_exp_f32 v124, v124
  s_nop 0
  v_add_f32 v124, 1.0, v124
  v_rcp_f32 v124, v124
  s_nop 0
  v_cvt_pk_bf16_f32 v124, v124, v124
  v_lshlrev_b32 v124, 16, v124
  buffer_load_dword v128, v133, s[24:27], 0 offen sc1
  buffer_load_dwordx4 a[56:59], v116, s[24:27], s6 offen offset:1024 sc1
  buffer_load_dwordx4 a[60:63], v116, s[24:27], s6 offen offset:2048 sc1
  buffer_load_dwordx4 a[64:67], v116, s[24:27], s6 offen offset:3072 sc1
  buffer_load_dwordx4 a[68:71], v114, s[24:27], s7 offen offset:0 sc1
  buffer_load_dwordx4 a[72:75], v114, s[24:27], s7 offen offset:1024 sc1
  buffer_load_dwordx4 a[76:79], v114, s[24:27], s7 offen offset:2048 sc1
  buffer_load_dwordx4 a[80:83], v114, s[24:27], s7 offen offset:3072 sc1
  buffer_load_dwordx4 a[84:87], v115, s[24:27], s7 offen offset:0 sc1
  buffer_load_dwordx4 a[88:91], v115, s[24:27], s7 offen offset:1024 sc1
  buffer_load_dwordx4 a[92:95], v115, s[24:27], s7 offen offset:2048 sc1
  s_waitcnt vmcnt(20)
  v_lshlrev_b32 v90, 16, v156
  v_and_b32 v91, s34, v156
  v_lshlrev_b32 v92, 16, v157
  v_and_b32 v93, s34, v157
  s_waitcnt vmcnt(18)
  v_lshlrev_b32 v94, 16, v158
  v_and_b32 v95, s34, v158
  v_lshlrev_b32 v96, 16, v159
  v_and_b32 v97, s34, v159
  s_waitcnt vmcnt(16)
  v_lshlrev_b32 v98, 16, v160
  v_and_b32 v99, s34, v160
  v_lshlrev_b32 v100, 16, v161
  v_and_b32 v101, s34, v161
  s_waitcnt vmcnt(14)
  v_lshlrev_b32 v102, 16, v162
  v_and_b32 v103, s34, v162
  v_lshlrev_b32 v104, 16, v163
  v_and_b32 v105, s34, v163
  s_waitcnt vmcnt(12)
  v_lshlrev_b32 v106, 16, v164
  v_and_b32 v107, s34, v164
  v_lshlrev_b32 v108, 16, v165
  v_and_b32 v109, s34, v165
  v_mov_b32 v156, 0
  v_mov_b32 v157, 0
  v_mov_b32 v158, 0
  v_mov_b32 v159, 0
  v_mov_b32 v160, 0
  v_mov_b32 v161, 0
  v_mov_b32 v162, 0
  v_mov_b32 v163, 0
  v_mov_b32 v164, 0
  v_mov_b32 v165, 0
  v_mov_b32 v166, 0
  v_mov_b32 v167, 0
  v_mov_b32 v168, 0
  v_mov_b32 v169, 0
  v_mov_b32 v170, 0
  v_mov_b32 v171, 0
  v_mov_b32 v172, 0
  v_mov_b32 v173, 0
  v_mov_b32 v174, 0
  v_mov_b32 v175, 0
  s_waitcnt vmcnt(10)
  v_cmp_lt_u32 vcc, v128, v134
  s_nop 0
  s_cbranch_vccz tail_ready
  s_waitcnt vmcnt(0)
  s_mov_b32 s35, 32768
  buffer_load_dword v128, v133, s[24:27], 0 offen sc1
  s_sleep 3
  buffer_load_dword v129, v133, s[24:27], 0 offen sc1
  s_sleep 3
tail_spin:
  buffer_load_dword v130, v133, s[24:27], 0 offen sc1
  s_waitcnt vmcnt(2)
  v_cmp_lt_u32 vcc, v128, v134
  s_nop 0
  s_cbranch_vccz tail_ready
  s_sleep 3
  buffer_load_dword v128, v133, s[24:27], 0 offen sc1
  s_waitcnt vmcnt(2)
  v_cmp_lt_u32 vcc, v129, v134
  s_nop 0
  s_cbranch_vccz tail_ready
  s_sleep 3
  buffer_load_dword v129, v133, s[24:27], 0 offen sc1
  s_waitcnt vmcnt(2)
  v_cmp_lt_u32 vcc, v130, v134
  s_nop 0
  s_cbranch_vccz tail_ready
  s_sleep 3
  s_sub_u32 s35, s35, 1
  s_cmp_lg_u32 s35, 0
  s_cbranch_scc1 tail_spin
tail_ready:
  buffer_load_dwordx4 a[180:183], v110, s[24:27], s30 offen offset:0 sc1
  buffer_load_dwordx4 a[184:187], v110, s[24:27], s30 offen offset:1024 sc1
  buffer_load_dwordx4 a[188:191], v111, s[24:27], s30 offen offset:0 sc1
  buffer_load_dwordx4 a[192:195], v111, s[24:27], s30 offen offset:1024 sc1
  buffer_load_dwordx4 a[196:199], v112, s[24:27], s30 offen offset:0 sc1
  buffer_load_dwordx4 a[200:203], v112, s[24:27], s30 offen offset:1024 sc1
  buffer_load_dwordx4 a[204:207], v113, s[24:27], s30 offen offset:0 sc1
  buffer_load_dwordx4 a[208:211], v113, s[24:27], s30 offen offset:1024 sc1
  v_cmp_gt_u32 vcc, 1073741824, v123
  s_nop 0
  s_and_saveexec_b64 s[42:43], vcc
  s_cbranch_execz tail_plain
  s_waitcnt vmcnt(30)
  buffer_load_dwordx4 v[156:159], v123, s[24:27], s32 offen offset:0 sc1
  buffer_load_dwordx4 v[160:163], v123, s[24:27], s32 offen offset:64 sc1
  buffer_load_dwordx4 v[164:167], v123, s[24:27], s32 offen offset:128 sc1
  buffer_load_dwordx4 v[168:171], v123, s[24:27], s32 offen offset:192 sc1
  buffer_load_dwordx4 v[172:175], v123, s[24:27], s32 offen offset:256 sc1
  s_add_u32 s32, s32, 20480
  buffer_load_dwordx4 v[136:139], v123, s[24:27], s32 offen offset:0 sc1
  buffer_load_dwordx4 v[140:143], v123, s[24:27], s32 offen offset:64 sc1
  buffer_load_dwordx4 v[144:147], v123, s[24:27], s32 offen offset:128 sc1
  buffer_load_dwordx4 v[148:151], v123, s[24:27], s32 offen offset:192 sc1
  buffer_load_dwordx4 v[152:155], v123, s[24:27], s32 offen offset:256 sc1
  s_add_u32 s32, s32, 20480
  buffer_load_dwordx4 v[0:3], v123, s[24:27], s32 offen offset:0 sc1
  buffer_load_dwordx4 v[4:7], v123, s[24:27], s32 offen offset:64 sc1
  buffer_load_dwordx4 v[8:11], v123, s[24:27], s32 offen offset:128 sc1
  buffer_load_dwordx4 v[12:15], v123, s[24:27], s32 offen offset:192 sc1
  buffer_load_dwordx4 v[16:19], v123, s[24:27], s32 offen offset:256 sc1
  s_add_u32 s32, s32, 20480
  buffer_load_dwordx4 v[20:23], v123, s[24:27], s32 offen offset:0 sc1
  buffer_load_dwordx4 v[24:27], v123, s[24:27], s32 offen offset:64 sc1
  buffer_load_dwordx4 v[28:31], v123, s[24:27], s32 offen offset:128 sc1
  buffer_load_dwordx4 v[32:35], v123, s[24:27], s32 offen offset:192 sc1
  buffer_load_dwordx4 v[36:39], v123, s[24:27], s32 offen offset:256 sc1
  s_add_u32 s32, s32, 20480
  buffer_load_dwordx4 v[40:43], v123, s[24:27], s32 offen offset:0 sc1
  buffer_load_dwordx4 v[44:47], v123, s[24:27], s32 offen offset:64 sc1
  buffer_load_dwordx4 v[48:51], v123, s[24:27], s32 offen offset:128 sc1
  buffer_load_dwordx4 v[52:55], v123, s[24:27], s32 offen offset:192 sc1
  buffer_load_dwordx4 v[56:59], v123, s[24:27], s32 offen offset:256 sc1
  s_add_u32 s32, s32, 20480
  buffer_load_dwordx4 v[60:63], v123, s[24:27], s32 offen offset:0 sc1
  buffer_load_dwordx4 v[64:67], v123, s[24:27], s32 offen offset:64 sc1
  buffer_load_dwordx4 v[68:71], v123, s[24:27], s32 offen offset:128 sc1
  buffer_load_dwordx4 v[72:75], v123, s[24:27], s32 offen offset:192 sc1
  buffer_load_dwordx4 v[76:79], v123, s[24:27], s32 offen offset:256 sc1
  s_add_u32 s32, s32, 20480
  s_waitcnt vmcnt(0)
  v_add_f32 v156, v156, v136
  v_add_f32 v157, v157, v137
  v_add_f32 v158, v158, v138
  v_add_f32 v159, v159, v139
  v_add_f32 v160, v160, v140
  v_add_f32 v161, v161, v141
  v_add_f32 v162, v162, v142
  v_add_f32 v163, v163, v143
  v_add_f32 v164, v164, v144
  v_add_f32 v165, v165, v145
  v_add_f32 v166, v166, v146
  v_add_f32 v167, v167, v147
  v_add_f32 v168, v168, v148
  v_add_f32 v169, v169, v149
  v_add_f32 v170, v170, v150
  v_add_f32 v171, v171, v151
  v_add_f32 v172, v172, v152
  v_add_f32 v173, v173, v153
  v_add_f32 v174, v174, v154
  v_add_f32 v175, v175, v155
  v_add_f32 v156, v156, v0
  v_add_f32 v157, v157, v1
  v_add_f32 v158, v158, v2
  v_add_f32 v159, v159, v3
  v_add_f32 v160, v160, v4
  v_add_f32 v161, v161, v5
  v_add_f32 v162, v162, v6
  v_add_f32 v163, v163, v7
  v_add_f32 v164, v164, v8
  v_add_f32 v165, v165, v9
  v_add_f32 v166, v166, v10
  v_add_f32 v167, v167, v11
  v_add_f32 v168, v168, v12
  v_add_f32 v169, v169, v13
  v_add_f32 v170, v170, v14
  v_add_f32 v171, v171, v15
  v_add_f32 v172, v172, v16
  v_add_f32 v173, v173, v17
  v_add_f32 v174, v174, v18
  v_add_f32 v175, v175, v19
  v_add_f32 v156, v156, v20
  v_add_f32 v157, v157, v21
  v_add_f32 v158, v158, v22
  v_add_f32 v159, v159, v23
  v_add_f32 v160, v160, v24
  v_add_f32 v161, v161, v25
  v_add_f32 v162, v162, v26
  v_add_f32 v163, v163, v27
  v_add_f32 v164, v164, v28
  v_add_f32 v165, v165, v29
  v_add_f32 v166, v166, v30
  v_add_f32 v167, v167, v31
  v_add_f32 v168, v168, v32
  v_add_f32 v169, v169, v33
  v_add_f32 v170, v170, v34
  v_add_f32 v171, v171, v35
  v_add_f32 v172, v172, v36
  v_add_f32 v173, v173, v37
  v_add_f32 v174, v174, v38
  v_add_f32 v175, v175, v39
  v_add_f32 v156, v156, v40
  v_add_f32 v157, v157, v41
  v_add_f32 v158, v158, v42
  v_add_f32 v159, v159, v43
  v_add_f32 v160, v160, v44
  v_add_f32 v161, v161, v45
  v_add_f32 v162, v162, v46
  v_add_f32 v163, v163, v47
  v_add_f32 v164, v164, v48
  v_add_f32 v165, v165, v49
  v_add_f32 v166, v166, v50
  v_add_f32 v167, v167, v51
  v_add_f32 v168, v168, v52
  v_add_f32 v169, v169, v53
  v_add_f32 v170, v170, v54
  v_add_f32 v171, v171, v55
  v_add_f32 v172, v172, v56
  v_add_f32 v173, v173, v57
  v_add_f32 v174, v174, v58
  v_add_f32 v175, v175, v59
  v_add_f32 v156, v156, v60
  v_add_f32 v157, v157, v61
  v_add_f32 v158, v158, v62
  v_add_f32 v159, v159, v63
  v_add_f32 v160, v160, v64
  v_add_f32 v161, v161, v65
  v_add_f32 v162, v162, v66
  v_add_f32 v163, v163, v67
  v_add_f32 v164, v164, v68
  v_add_f32 v165, v165, v69
  v_add_f32 v166, v166, v70
  v_add_f32 v167, v167, v71
  v_add_f32 v168, v168, v72
  v_add_f32 v169, v169, v73
  v_add_f32 v170, v170, v74
  v_add_f32 v171, v171, v75
  v_add_f32 v172, v172, v76
  v_add_f32 v173, v173, v77
  v_add_f32 v174, v174, v78
  v_add_f32 v175, v175, v79
tail_plain:
  s_mov_b64 exec, s[42:43]
  s_waitcnt vmcnt(0)
  v_mfma_f32_16x16x32_bf16 v[0:3], a[212:215], a[180:183], 0
  s_add_u32 s30, s30, 8192
  buffer_load_dwordx4 v[176:179], v110, s[24:27], s30 offen offset:0 sc1
  v_mfma_f32_16x16x32_bf16 v[0:3], a[232:235], a[184:187], v[0:3]
  v_cvt_pk_bf16_f32 v156, v156, v156
  v_cvt_pk_bf16_f32 v157, v157, v157
  v_mfma_f32_16x16x32_bf16 v[4:7], a[232:235], a[192:195], 0
  buffer_load_dwordx4 a[96:99], v115, s[24:27], s7 offen offset:3072 sc1
  v_mfma_f32_16x16x32_bf16 v[4:7], a[212:215], a[188:191], v[4:7]
  v_cvt_pk_bf16_f32 v158, v158, v158
  v_cvt_pk_bf16_f32 v159, v159, v159
  v_mfma_f32_16x16x32_bf16 v[8:11], a[212:215], a[196:199], 0
  buffer_load_dwordx4 v[180:183], v110, s[24:27], s30 offen offset:1024 sc1
  v_mfma_f32_16x16x32_bf16 v[8:11], a[232:235], a[200:203], v[8:11]
  v_lshlrev_b32 v156, 16, v156
  v_lshlrev_b32 v157, 16, v157
  v_mfma_f32_16x16x32_bf16 v[12:15], a[232:235], a[208:211], 0
  v_lshlrev_b32 v158, 16, v158
  v_lshlrev_b32 v159, 16, v159
  v_mfma_f32_16x16x32_bf16 v[12:15], a[212:215], a[204:207], v[12:15]
  v_mul_f32 v156, v156, v124
  v_mul_f32 v157, v157, v124
  v_mfma_f32_16x16x32_bf16 v[16:19], a[216:219], a[180:183], 0
  buffer_load_dwordx4 v[184:187], v111, s[24:27], s30 offen offset:0 sc1
  v_mfma_f32_16x16x32_bf16 v[16:19], a[236:239], a[184:187], v[16:19]
  v_mul_f32 v158, v158, v124
  v_mul_f32 v159, v159, v124
  v_mfma_f32_16x16x32_bf16 v[20:23], a[236:239], a[192:195], 0
  buffer_load_dwordx4 a[100:103], v116, s[24:27], s7 offen offset:0 sc1
  v_mfma_f32_16x16x32_bf16 v[20:23], a[216:219], a[188:191], v[20:23]
  v_cvt_pk_bf16_f32 v156, v156, v156
  v_cvt_pk_bf16_f32 v157, v157, v157
  v_mfma_f32_16x16x32_bf16 v[24:27], a[216:219], a[196:199], 0
  buffer_load_dwordx4 v[188:191], v111, s[24:27], s30 offen offset:1024 sc1
  v_mfma_f32_16x16x32_bf16 v[24:27], a[236:239], a[200:203], v[24:27]
  v_cvt_pk_bf16_f32 v158, v158, v158
  v_cvt_pk_bf16_f32 v159, v159, v159
  v_mfma_f32_16x16x32_bf16 v[28:31], a[236:239], a[208:211], 0
  v_lshlrev_b32 v156, 16, v156
  v_lshlrev_b32 v157, 16, v157
  v_mfma_f32_16x16x32_bf16 v[28:31], a[216:219], a[204:207], v[28:31]
  v_lshlrev_b32 v158, 16, v158
  v_lshlrev_b32 v159, 16, v159
  v_mfma_f32_16x16x32_bf16 v[32:35], a[220:223], a[180:183], 0
  buffer_load_dwordx4 v[192:195], v112, s[24:27], s30 offen offset:0 sc1
  v_mfma_f32_16x16x32_bf16 v[32:35], a[240:243], a[184:187], v[32:35]
  v_add_f32 v90, v90, v156
  v_add_f32 v91, v91, v157
  v_mfma_f32_16x16x32_bf16 v[36:39], a[240:243], a[192:195], 0
  buffer_load_dwordx4 a[104:107], v116, s[24:27], s7 offen offset:1024 sc1
  v_mfma_f32_16x16x32_bf16 v[36:39], a[220:223], a[188:191], v[36:39]
  v_add_f32 v92, v92, v158
  v_add_f32 v93, v93, v159
  v_mfma_f32_16x16x32_bf16 v[40:43], a[220:223], a[196:199], 0
  buffer_load_dwordx4 v[196:199], v112, s[24:27], s30 offen offset:1024 sc1
  v_mfma_f32_16x16x32_bf16 v[40:43], a[240:243], a[200:203], v[40:43]
  v_cvt_pk_bf16_f32 v90, v90, v90
  v_cvt_pk_bf16_f32 v91, v91, v91
  v_mfma_f32_16x16x32_bf16 v[44:47], a[240:243], a[208:211], 0
  v_cvt_pk_bf16_f32 v92, v92, v92
  v_cvt_pk_bf16_f32 v93, v93, v93
  v_mfma_f32_16x16x32_bf16 v[44:47], a[220:223], a[204:207], v[44:47]
  v_lshlrev_b32 v90, 16, v90
  v_lshlrev_b32 v91, 16, v91
  v_mfma_f32_16x16x32_bf16 v[48:51], a[224:227], a[180:183], 0
  buffer_load_dwordx4 v[200:203], v113, s[24:27], s30 offen offset:0 sc1
  v_mfma_f32_16x16x32_bf16 v[48:51], a[244:247], a[184:187], v[48:51]
  v_lshlrev_b32 v92, 16, v92
  v_lshlrev_b32 v93, 16, v93
  v_mfma_f32_16x16x32_bf16 v[52:55], a[244:247], a[192:195], 0
  buffer_load_dwordx4 a[108:111], v116, s[24:27], s7 offen offset:2048 sc1
  v_mfma_f32_16x16x32_bf16 v[52:55], a[224:227], a[188:191], v[52:55]
  v_mul_f32 v129, 0xbfb8aa3b, v90
  v_mul_f32 v130, 0xbfb8aa3b, v91
  v_mfma_f32_16x16x32_bf16 v[56:59], a[224:227], a[196:199], 0
  buffer_load_dwordx4 v[204:207], v113, s[24:27], s30 offen offset:1024 sc1
  v_mfma_f32_16x16x32_bf16 v[56:59], a[244:247], a[200:203], v[56:59]
  v_mul_f32 v131, 0xbfb8aa3b, v92
  v_mul_f32 v132, 0xbfb8aa3b, v93
  v_mfma_f32_16x16x32_bf16 v[60:63], a[244:247], a[208:211], 0
  v_exp_f32 v129, v129
  v_mfma_f32_16x16x32_bf16 v[60:63], a[224:227], a[204:207], v[60:63]
  v_exp_f32 v130, v130
  v_mfma_f32_16x16x32_bf16 v[64:67], a[228:231], a[180:183], 0
  s_add_u32 s30, s30, 8192
  buffer_load_dwordx4 v[208:211], v110, s[24:27], s30 offen offset:0 sc1
  v_mfma_f32_16x16x32_bf16 v[64:67], a[248:251], a[184:187], v[64:67]
  v_exp_f32 v131, v131
  v_mfma_f32_16x16x32_bf16 v[68:71], a[248:251], a[192:195], 0
  buffer_load_dwordx4 a[112:115], v116, s[24:27], s7 offen offset:3072 sc1
  v_mfma_f32_16x16x32_bf16 v[68:71], a[228:231], a[188:191], v[68:71]
  v_exp_f32 v132, v132
  v_mfma_f32_16x16x32_bf16 v[72:75], a[228:231], a[196:199], 0
  buffer_load_dwordx4 v[212:215], v110, s[24:27], s30 offen offset:1024 sc1
  v_mfma_f32_16x16x32_bf16 v[72:75], a[248:251], a[200:203], v[72:75]
  v_add_f32 v129, 1.0, v129
  v_add_f32 v130, 1.0, v130
  v_mfma_f32_16x16x32_bf16 v[76:79], a[248:251], a[208:211], 0
  v_add_f32 v131, 1.0, v131
  v_add_f32 v132, 1.0, v132
  v_mfma_f32_16x16x32_bf16 v[76:79], a[228:231], a[204:207], v[76:79]
  v_rcp_f32 v129, v129
  s_waitcnt vmcnt(3)
  v_mfma_f32_16x16x32_bf16 v[0:3], a[252:255], v[176:179], v[0:3]
  buffer_load_dwordx4 v[216:219], v111, s[24:27], s30 offen offset:0 sc1
  v_mfma_f32_16x16x32_bf16 v[0:3], a[144:147], v[180:183], v[0:3]
  v_rcp_f32 v130, v130
  v_mfma_f32_16x16x32_bf16 v[4:7], a[144:147], v[188:191], v[4:7]
  buffer_load_dwordx4 a[116:119], v114, s[24:27], s8 offen offset:0 sc1
  v_mfma_f32_16x16x32_bf16 v[4:7], a[252:255], v[184:187], v[4:7]
  v_rcp_f32 v131, v131
  v_mfma_f32_16x16x32_bf16 v[8:11], a[252:255], v[192:195], v[8:11]
  buffer_load_dwordx4 v[220:223], v111, s[24:27], s30 offen offset:1024 sc1
  v_mfma_f32_16x16x32_bf16 v[8:11], a[144:147], v[196:199], v[8:11]
  v_rcp_f32 v132, v132
  v_mfma_f32_16x16x32_bf16 v[12:15], a[144:147], v[204:207], v[12:15]
  v_mul_f32 v90, v90, v129
  v_mul_f32 v91, v91, v130
  v_mfma_f32_16x16x32_bf16 v[12:15], a[252:255], v[200:203], v[12:15]
  v_mul_f32 v92, v92, v131
  v_mul_f32 v93, v93, v132
  v_mfma_f32_16x16x32_bf16 v[16:19], a[128:131], v[176:179], v[16:19]
  buffer_load_dwordx4 v[224:227], v112, s[24:27], s30 offen offset:0 sc1
  v_mfma_f32_16x16x32_bf16 v[16:19], a[148:151], v[180:183], v[16:19]
  v_cvt_pk_bf16_f32 v90, v90, v90
  v_cvt_pk_bf16_f32 v91, v91, v91
  v_mfma_f32_16x16x32_bf16 v[20:23], a[148:151], v[188:191], v[20:23]
  buffer_load_dwordx4 a[120:123], v114, s[24:27], s8 offen offset:1024 sc1
  v_mfma_f32_16x16x32_bf16 v[20:23], a[128:131], v[184:187], v[20:23]
  v_cvt_pk_bf16_f32 v92, v92, v92
  v_cvt_pk_bf16_f32 v93, v93, v93
  v_mfma_f32_16x16x32_bf16 v[24:27], a[128:131], v[192:195], v[24:27]
  buffer_load_dwordx4 v[228:231], v112, s[24:27], s30 offen offset:1024 sc1
  v_mfma_f32_16x16x32_bf16 v[24:27], a[148:151], v[196:199], v[24:27]
  v_lshlrev_b32 v90, 16, v90
  v_lshlrev_b32 v91, 16, v91
  v_mfma_f32_16x16x32_bf16 v[28:31], a[148:151], v[204:207], v[28:31]
  v_lshlrev_b32 v92, 16, v92
  v_lshlrev_b32 v93, 16, v93
  v_mfma_f32_16x16x32_bf16 v[28:31], a[128:131], v[200:203], v[28:31]
  v_cvt_pk_bf16_f32 v160, v160, v160
  v_cvt_pk_bf16_f32 v161, v161, v161
  v_mfma_f32_16x16x32_bf16 v[32:35], a[132:135], v[176:179], v[32:35]
  buffer_load_dwordx4 v[232:235], v113, s[24:27], s30 offen offset:0 sc1
  v_mfma_f32_16x16x32_bf16 v[32:35], a[152:155], v[180:183], v[32:35]
  v_cvt_pk_bf16_f32 v162, v162, v162
  v_cvt_pk_bf16_f32 v163, v163, v163
  v_mfma_f32_16x16x32_bf16 v[36:39], a[152:155], v[188:191], v[36:39]
  buffer_load_dwordx4 a[124:127], v114, s[24:27], s8 offen offset:2048 sc1
  v_mfma_f32_16x16x32_bf16 v[36:39], a[132:135], v[184:187], v[36:39]
  v_lshlrev_b32 v160, 16, v160
  v_lshlrev_b32 v161, 16, v161
  v_mfma_f32_16x16x32_bf16 v[40:43], a[132:135], v[192:195], v[40:43]
  buffer_load_dwordx4 v[236:239], v113, s[24:27], s30 offen offset:1024 sc1
  v_mfma_f32_16x16x32_bf16 v[40:43], a[152:155], v[196:199], v[40:43]
  v_lshlrev_b32 v162, 16, v162
  v_lshlrev_b32 v163, 16, v163
  v_mfma_f32_16x16x32_bf16 v[44:47], a[152:155], v[204:207], v[44:47]
  v_mul_f32 v160, v160, v124
  v_mul_f32 v161, v161, v124
  v_mfma_f32_16x16x32_bf16 v[44:47], a[132:135], v[200:203], v[44:47]
  v_mul_f32 v162, v162, v124
  v_mul_f32 v163, v163, v124
  v_mfma_f32_16x16x32_bf16 v[48:51], a[136:139], v[176:179], v[48:51]
  s_add_u32 s30, s30, 8192
  buffer_load_dwordx4 v[240:243], v110, s[24:27], s30 offen offset:0 sc1
  v_mfma_f32_16x16x32_bf16 v[48:51], a[156:159], v[180:183], v[48:51]
  v_cvt_pk_bf16_f32 v160, v160, v160
  v_cvt_pk_bf16_f32 v161, v161, v161
  v_mfma_f32_16x16x32_bf16 v[52:55], a[156:159], v[188:191], v[52:55]
  buffer_load_dwordx4 a[160:163], v114, s[24:27], s8 offen offset:3072 sc1
  v_mfma_f32_16x16x32_bf16 v[52:55], a[136:139], v[184:187], v[52:55]
  v_cvt_pk_bf16_f32 v162, v162, v162
  v_cvt_pk_bf16_f32 v163, v163, v163
  v_mfma_f32_16x16x32_bf16 v[56:59], a[136:139], v[192:195], v[56:59]
  buffer_load_dwordx4 v[244:247], v110, s[24:27], s30 offen offset:1024 sc1
  v_mfma_f32_16x16x32_bf16 v[56:59], a[156:159], v[196:199], v[56:59]
  v_lshlrev_b32 v160, 16, v160
  v_lshlrev_b32 v161, 16, v161
  v_mfma_f32_16x16x32_bf16 v[60:63], a[156:159], v[204:207], v[60:63]
  v_lshlrev_b32 v162, 16, v162
  v_lshlrev_b32 v163, 16, v163
  v_mfma_f32_16x16x32_bf16 v[60:63], a[136:139], v[200:203], v[60:63]
  v_add_f32 v94, v94, v160
  v_add_f32 v95, v95, v161
  v_mfma_f32_16x16x32_bf16 v[64:67], a[140:143], v[176:179], v[64:67]
  buffer_load_dwordx4 v[248:251], v111, s[24:27], s30 offen offset:0 sc1
  v_mfma_f32_16x16x32_bf16 v[64:67], a[0:3], v[180:183], v[64:67]
  v_add_f32 v96, v96, v162
  v_add_f32 v97, v97, v163
  v_mfma_f32_16x16x32_bf16 v[68:71], a[0:3], v[188:191], v[68:71]
  buffer_load_dwordx4 a[164:167], v115, s[24:27], s8 offen offset:0 sc1
  v_mfma_f32_16x16x32_bf16 v[68:71], a[140:143], v[184:187], v[68:71]
  v_cvt_pk_bf16_f32 v94, v94, v94
  v_cvt_pk_bf16_f32 v95, v95, v95
  v_mfma_f32_16x16x32_bf16 v[72:75], a[140:143], v[192:195], v[72:75]
  buffer_load_dwordx4 v[252:255], v111, s[24:27], s30 offen offset:1024 sc1
  v_mfma_f32_16x16x32_bf16 v[72:75], a[0:3], v[196:199], v[72:75]
  v_cvt_pk_bf16_f32 v96, v96, v96
  v_cvt_pk_bf16_f32 v97, v97, v97
  v_mfma_f32_16x16x32_bf16 v[76:79], a[0:3], v[204:207], v[76:79]
  v_lshlrev_b32 v94, 16, v94
  v_lshlrev_b32 v95, 16, v95
  v_mfma_f32_16x16x32_bf16 v[76:79], a[140:143], v[200:203], v[76:79]
  v_lshlrev_b32 v96, 16, v96
  v_lshlrev_b32 v97, 16, v97
  s_waitcnt vmcnt(6)
  v_mfma_f32_16x16x32_bf16 v[0:3], a[4:7], v[208:211], v[0:3]
  buffer_load_dwordx4 v[136:139], v112, s[24:27], s30 offen offset:0 sc1
  v_mfma_f32_16x16x32_bf16 v[0:3], a[24:27], v[212:215], v[0:3]
  v_mul_f32 v129, 0xbfb8aa3b, v94
  v_mul_f32 v130, 0xbfb8aa3b, v95
  v_mfma_f32_16x16x32_bf16 v[4:7], a[24:27], v[220:223], v[4:7]
  buffer_load_dwordx4 a[168:171], v115, s[24:27], s8 offen offset:1024 sc1
  v_mfma_f32_16x16x32_bf16 v[4:7], a[4:7], v[216:219], v[4:7]
  v_mul_f32 v131, 0xbfb8aa3b, v96
  v_mul_f32 v132, 0xbfb8aa3b, v97
  v_mfma_f32_16x16x32_bf16 v[8:11], a[4:7], v[224:227], v[8:11]
  buffer_load_dwordx4 v[140:143], v112, s[24:27], s30 offen offset:1024 sc1
  v_mfma_f32_16x16x32_bf16 v[8:11], a[24:27], v[228:231], v[8:11]
  v_exp_f32 v129, v129
  v_mfma_f32_16x16x32_bf16 v[12:15], a[24:27], v[236:239], v[12:15]
  v_exp_f32 v130, v130
  v_mfma_f32_16x16x32_bf16 v[12:15], a[4:7], v[232:235], v[12:15]
  v_exp_f32 v131, v131
  v_mfma_f32_16x16x32_bf16 v[16:19], a[8:11], v[208:211], v[16:19]
  buffer_load_dwordx4 v[144:147], v113, s[24:27], s30 offen offset:0 sc1
  v_mfma_f32_16x16x32_bf16 v[16:19], a[28:31], v[212:215], v[16:19]
  v_exp_f32 v132, v132
  v_mfma_f32_16x16x32_bf16 v[20:23], a[28:31], v[220:223], v[20:23]
  buffer_load_dwordx4 a[172:175], v115, s[24:27], s8 offen offset:2048 sc1
  v_mfma_f32_16x16x32_bf16 v[20:23], a[8:11], v[216:219], v[20:23]
  v_add_f32 v129, 1.0, v129
  v_add_f32 v130, 1.0, v130
  v_mfma_f32_16x16x32_bf16 v[24:27], a[8:11], v[224:227], v[24:27]
  buffer_load_dwordx4 v[148:151], v113, s[24:27], s30 offen offset:1024 sc1
  v_mfma_f32_16x16x32_bf16 v[24:27], a[28:31], v[228:231], v[24:27]
  v_add_f32 v131, 1.0, v131
  v_add_f32 v132, 1.0, v132
  v_mfma_f32_16x16x32_bf16 v[28:31], a[28:31], v[236:239], v[28:31]
  v_rcp_f32 v129, v129
  v_mfma_f32_16x16x32_bf16 v[28:31], a[8:11], v[232:235], v[28:31]
  v_rcp_f32 v130, v130
  v_mfma_f32_16x16x32_bf16 v[32:35], a[12:15], v[208:211], v[32:35]
  s_add_u32 s30, s30, 8192
  buffer_load_dwordx4 v[152:155], v110, s[24:27], s30 offen offset:0 sc1
  v_mfma_f32_16x16x32_bf16 v[32:35], a[32:35], v[212:215], v[32:35]
  v_rcp_f32 v131, v131
  v_mfma_f32_16x16x32_bf16 v[36:39], a[32:35], v[220:223], v[36:39]
  buffer_load_dwordx4 a[176:179], v115, s[24:27], s8 offen offset:3072 sc1
  v_mfma_f32_16x16x32_bf16 v[36:39], a[12:15], v[216:219], v[36:39]
  v_rcp_f32 v132, v132
  v_mfma_f32_16x16x32_bf16 v[40:43], a[12:15], v[224:227], v[40:43]
  buffer_load_dwordx4 a[180:183], v110, s[24:27], s30 offen offset:1024 sc1
  v_mfma_f32_16x16x32_bf16 v[40:43], a[32:35], v[228:231], v[40:43]
  v_mul_f32 v94, v94, v129
  v_mul_f32 v95, v95, v130
  v_mfma_f32_16x16x32_bf16 v[44:47], a[32:35], v[236:239], v[44:47]
  v_mul_f32 v96, v96, v131
  v_mul_f32 v97, v97, v132
  v_mfma_f32_16x16x32_bf16 v[44:47], a[12:15], v[232:235], v[44:47]
  v_cvt_pk_bf16_f32 v94, v94, v94
  v_cvt_pk_bf16_f32 v95, v95, v95
  v_mfma_f32_16x16x32_bf16 v[48:51], a[16:19], v[208:211], v[48:51]
  buffer_load_dwordx4 a[184:187], v111, s[24:27], s30 offen offset:0 sc1
  v_mfma_f32_16x16x32_bf16 v[48:51], a[36:39], v[212:215], v[48:51]
  v_cvt_pk_bf16_f32 v96, v96, v96
  v_cvt_pk_bf16_f32 v97, v97, v97
  v_mfma_f32_16x16x32_bf16 v[52:55], a[36:39], v[220:223], v[52:55]
  s_add_u32 m0, s28, 49152
  s_nop 0
  buffer_load_dwordx4 v115, s[24:27], s10 offen offset:0 sc1 lds
  v_mfma_f32_16x16x32_bf16 v[52:55], a[16:19], v[216:219], v[52:55]
  buffer_load_dwordx4 v115, s[24:27], s10 offen offset:1024 sc1 lds
  v_mfma_f32_16x16x32_bf16 v[56:59], a[16:19], v[224:227], v[56:59]
  buffer_load_dwordx4 v115, s[24:27], s10 offen offset:2048 sc1 lds
  v_mfma_f32_16x16x32_bf16 v[56:59], a[36:39], v[228:231], v[56:59]
  buffer_load_dwordx4 v115, s[24:27], s10 offen offset:3072 sc1 lds
  v_mfma_f32_16x16x32_bf16 v[60:63], a[36:39], v[236:239], v[60:63]
  buffer_load_dwordx4 a[188:191], v111, s[24:27], s30 offen offset:1024 sc1
  v_mfma_f32_16x16x32_bf16 v[60:63], a[16:19], v[232:235], v[60:63]
  v_lshlrev_b32 v94, 16, v94
  v_lshlrev_b32 v95, 16, v95
  v_mfma_f32_16x16x32_bf16 v[64:67], a[20:23], v[208:211], v[64:67]
  buffer_load_dwordx4 a[192:195], v112, s[24:27], s30 offen offset:0 sc1
  v_mfma_f32_16x16x32_bf16 v[64:67], a[40:43], v[212:215], v[64:67]
  v_lshlrev_b32 v96, 16, v96
  v_lshlrev_b32 v97, 16, v97
  v_mfma_f32_16x16x32_bf16 v[68:71], a[40:43], v[220:223], v[68:71]
  v_cvt_pk_bf16_f32 v164, v164, v164
  v_cvt_pk_bf16_f32 v165, v165, v165
  v_mfma_f32_16x16x32_bf16 v[68:71], a[20:23], v[216:219], v[68:71]
  v_cvt_pk_bf16_f32 v166, v166, v166
  v_cvt_pk_bf16_f32 v167, v167, v167
  v_mfma_f32_16x16x32_bf16 v[72:75], a[20:23], v[224:227], v[72:75]
  buffer_load_dwordx4 a[196:199], v112, s[24:27], s30 offen offset:1024 sc1
  v_mfma_f32_16x16x32_bf16 v[72:75], a[40:43], v[228:231], v[72:75]
  v_lshlrev_b32 v164, 16, v164
  v_lshlrev_b32 v165, 16, v165
  v_mfma_f32_16x16x32_bf16 v[76:79], a[40:43], v[236:239], v[76:79]
  v_lshlrev_b32 v166, 16, v166
  v_lshlrev_b32 v167, 16, v167
  v_mfma_f32_16x16x32_bf16 v[76:79], a[20:23], v[232:235], v[76:79]
  v_mul_f32 v164, v164, v124
  v_mul_f32 v165, v165, v124
  s_waitcnt vmcnt(11)
  v_mfma_f32_16x16x32_bf16 v[0:3], a[44:47], v[240:243], v[0:3]
  buffer_load_dwordx4 a[200:203], v113, s[24:27], s30 offen offset:0 sc1
  v_mfma_f32_16x16x32_bf16 v[0:3], a[64:67], v[244:247], v[0:3]
  v_mul_f32 v166, v166, v124
  v_mul_f32 v167, v167, v124
  v_mfma_f32_16x16x32_bf16 v[4:7], a[64:67], v[252:255], v[4:7]
  v_cvt_pk_bf16_f32 v164, v164, v164
  v_cvt_pk_bf16_f32 v165, v165, v165
  v_mfma_f32_16x16x32_bf16 v[4:7], a[44:47], v[248:251], v[4:7]
  v_cvt_pk_bf16_f32 v166, v166, v166
  v_cvt_pk_bf16_f32 v167, v167, v167
  v_mfma_f32_16x16x32_bf16 v[8:11], a[44:47], v[136:139], v[8:11]
  buffer_load_dwordx4 a[204:207], v113, s[24:27], s30 offen offset:1024 sc1
  v_mfma_f32_16x16x32_bf16 v[8:11], a[64:67], v[140:143], v[8:11]
  v_lshlrev_b32 v164, 16, v164
  v_lshlrev_b32 v165, 16, v165
  v_mfma_f32_16x16x32_bf16 v[12:15], a[64:67], v[148:151], v[12:15]
  v_lshlrev_b32 v166, 16, v166
  v_lshlrev_b32 v167, 16, v167
  v_mfma_f32_16x16x32_bf16 v[12:15], a[44:47], v[144:147], v[12:15]
  v_add_f32 v98, v98, v164
  v_add_f32 v99, v99, v165
  v_mfma_f32_16x16x32_bf16 v[16:19], a[48:51], v[240:243], v[16:19]
  s_add_u32 s30, s30, 8192
  buffer_load_dwordx4 a[208:211], v110, s[24:27], s30 offen offset:0 sc1
  v_mfma_f32_16x16x32_bf16 v[16:19], a[68:71], v[244:247], v[16:19]
  v_add_f32 v100, v100, v166
  v_add_f32 v101, v101, v167
  v_mfma_f32_16x16x32_bf16 v[20:23], a[68:71], v[252:255], v[20:23]
  v_cvt_pk_bf16_f32 v98, v98, v98
  v_cvt_pk_bf16_f32 v99, v99, v99
  v_mfma_f32_16x16x32_bf16 v[20:23], a[48:51], v[248:251], v[20:23]
  v_cvt_pk_bf16_f32 v100, v100, v100
  v_cvt_pk_bf16_f32 v101, v101, v101
  v_mfma_f32_16x16x32_bf16 v[24:27], a[48:51], v[136:139], v[24:27]
  buffer_load_dwordx4 v[176:179], v110, s[24:27], s30 offen offset:1024 sc1
  v_mfma_f32_16x16x32_bf16 v[24:27], a[68:71], v[140:143], v[24:27]
  v_lshlrev_b32 v98, 16, v98
  v_lshlrev_b32 v99, 16, v99
  v_mfma_f32_16x16x32_bf16 v[28:31], a[68:71], v[148:151], v[28:31]
  v_lshlrev_b32 v100, 16, v100
  v_lshlrev_b32 v101, 16, v101
  v_mfma_f32_16x16x32_bf16 v[28:31], a[48:51], v[144:147], v[28:31]
  v_mul_f32 v129, 0xbfb8aa3b, v98
  v_mul_f32 v130, 0xbfb8aa3b, v99
  v_mfma_f32_16x16x32_bf16 v[32:35], a[52:55], v[240:243], v[32:35]
  buffer_load_dwordx4 v[180:183], v111, s[24:27], s30 offen offset:0 sc1
  v_mfma_f32_16x16x32_bf16 v[32:35], a[72:75], v[244:247], v[32:35]
  v_mul_f32 v131, 0xbfb8aa3b, v100
  v_mul_f32 v132, 0xbfb8aa3b, v101
  v_mfma_f32_16x16x32_bf16 v[36:39], a[72:75], v[252:255], v[36:39]
  v_exp_f32 v129, v129
  v_mfma_f32_16x16x32_bf16 v[36:39], a[52:55], v[248:251], v[36:39]
  v_exp_f32 v130, v130
  v_mfma_f32_16x16x32_bf16 v[40:43], a[52:55], v[136:139], v[40:43]
  buffer_load_dwordx4 v[184:187], v111, s[24:27], s30 offen offset:1024 sc1
  v_mfma_f32_16x16x32_bf16 v[40:43], a[72:75], v[140:143], v[40:43]
  v_exp_f32 v131, v131
  v_mfma_f32_16x16x32_bf16 v[44:47], a[72:75], v[148:151], v[44:47]
  v_exp_f32 v132, v132
  v_mfma_f32_16x16x32_bf16 v[44:47], a[52:55], v[144:147], v[44:47]
  v_add_f32 v129, 1.0, v129
  v_add_f32 v130, 1.0, v130
  v_mfma_f32_16x16x32_bf16 v[48:51], a[56:59], v[240:243], v[48:51]
  buffer_load_dwordx4 v[188:191], v112, s[24:27], s30 offen offset:0 sc1
  v_mfma_f32_16x16x32_bf16 v[48:51], a[76:79], v[244:247], v[48:51]
  v_add_f32 v131, 1.0, v131
  v_add_f32 v132, 1.0, v132
  v_mfma_f32_16x16x32_bf16 v[52:55], a[76:79], v[252:255], v[52:55]
  v_rcp_f32 v129, v129
  v_mfma_f32_16x16x32_bf16 v[52:55], a[56:59], v[248:251], v[52:55]
  v_rcp_f32 v130, v130
  v_mfma_f32_16x16x32_bf16 v[56:59], a[56:59], v[136:139], v[56:59]
  buffer_load_dwordx4 v[192:195], v112, s[24:27], s30 offen offset:1024 sc1
  v_mfma_f32_16x16x32_bf16 v[56:59], a[76:79], v[140:143], v[56:59]
  v_rcp_f32 v131, v131
  v_mfma_f32_16x16x32_bf16 v[60:63], a[76:79], v[148:151], v[60:63]
  v_rcp_f32 v132, v132
  v_mfma_f32_16x16x32_bf16 v[60:63], a[56:59], v[144:147], v[60:63]
  v_mul_f32 v98, v98, v129
  v_mul_f32 v99, v99, v130
  v_mfma_f32_16x16x32_bf16 v[64:67], a[60:63], v[240:243], v[64:67]
  buffer_load_dwordx4 v[196:199], v113, s[24:27], s30 offen offset:0 sc1
  v_mfma_f32_16x16x32_bf16 v[64:67], a[80:83], v[244:247], v[64:67]
  v_mul_f32 v100, v100, v131
  v_mul_f32 v101, v101, v132
  v_mfma_f32_16x16x32_bf16 v[68:71], a[80:83], v[252:255], v[68:71]
  v_cvt_pk_bf16_f32 v98, v98, v98
  v_cvt_pk_bf16_f32 v99, v99, v99
  v_mfma_f32_16x16x32_bf16 v[68:71], a[60:63], v[248:251], v[68:71]
  v_cvt_pk_bf16_f32 v100, v100, v100
  v_cvt_pk_bf16_f32 v101, v101, v101
  v_mfma_f32_16x16x32_bf16 v[72:75], a[60:63], v[136:139], v[72:75]
  buffer_load_dwordx4 v[200:203], v113, s[24:27], s30 offen offset:1024 sc1
  v_mfma_f32_16x16x32_bf16 v[72:75], a[80:83], v[140:143], v[72:75]
  v_lshlrev_b32 v98, 16, v98
  v_lshlrev_b32 v99, 16, v99
  v_mfma_f32_16x16x32_bf16 v[76:79], a[80:83], v[148:151], v[76:79]
  v_lshlrev_b32 v100, 16, v100
  v_lshlrev_b32 v101, 16, v101
  v_mfma_f32_16x16x32_bf16 v[76:79], a[60:63], v[144:147], v[76:79]
  v_cvt_pk_bf16_f32 v168, v168, v168
  v_cvt_pk_bf16_f32 v169, v169, v169
  s_waitcnt vmcnt(8)
  v_mfma_f32_16x16x32_bf16 v[0:3], a[84:87], v[152:155], v[0:3]
  s_add_u32 s30, s30, 8192
  buffer_load_dwordx4 v[204:207], v110, s[24:27], s30 offen offset:0 sc1
  v_mfma_f32_16x16x32_bf16 v[0:3], a[104:107], a[180:183], v[0:3]
  v_cvt_pk_bf16_f32 v170, v170, v170
  v_cvt_pk_bf16_f32 v171, v171, v171
  v_mfma_f32_16x16x32_bf16 v[4:7], a[104:107], a[188:191], v[4:7]
  v_lshlrev_b32 v168, 16, v168
  v_lshlrev_b32 v169, 16, v169
  v_mfma_f32_16x16x32_bf16 v[4:7], a[84:87], a[184:187], v[4:7]
  v_lshlrev_b32 v170, 16, v170
  v_lshlrev_b32 v171, 16, v171
  v_mfma_f32_16x16x32_bf16 v[8:11], a[84:87], a[192:195], v[8:11]
  buffer_load_dwordx4 v[208:211], v110, s[24:27], s30 offen offset:1024 sc1
  v_mfma_f32_16x16x32_bf16 v[8:11], a[104:107], a[196:199], v[8:11]
  v_mul_f32 v168, v168, v124
  v_mul_f32 v169, v169, v124
  v_mfma_f32_16x16x32_bf16 v[12:15], a[104:107], a[204:207], v[12:15]
  v_mul_f32 v170, v170, v124
  v_mul_f32 v171, v171, v124
  v_mfma_f32_16x16x32_bf16 v[12:15], a[84:87], a[200:203], v[12:15]
  v_cvt_pk_bf16_f32 v168, v168, v168
  v_cvt_pk_bf16_f32 v169, v169, v169
  v_mfma_f32_16x16x32_bf16 v[16:19], a[88:91], v[152:155], v[16:19]
  buffer_load_dwordx4 v[212:215], v111, s[24:27], s30 offen offset:0 sc1
  v_mfma_f32_16x16x32_bf16 v[16:19], a[108:111], a[180:183], v[16:19]
  v_cvt_pk_bf16_f32 v170, v170, v170
  v_cvt_pk_bf16_f32 v171, v171, v171
  v_mfma_f32_16x16x32_bf16 v[20:23], a[108:111], a[188:191], v[20:23]
  v_lshlrev_b32 v168, 16, v168
  v_lshlrev_b32 v169, 16, v169
  v_mfma_f32_16x16x32_bf16 v[20:23], a[88:91], a[184:187], v[20:23]
  v_lshlrev_b32 v170, 16, v170
  v_lshlrev_b32 v171, 16, v171
  v_mfma_f32_16x16x32_bf16 v[24:27], a[88:91], a[192:195], v[24:27]
  buffer_load_dwordx4 v[216:219], v111, s[24:27], s30 offen offset:1024 sc1
  v_mfma_f32_16x16x32_bf16 v[24:27], a[108:111], a[196:199], v[24:27]
  v_add_f32 v102, v102, v168
  v_add_f32 v103, v103, v169
  v_mfma_f32_16x16x32_bf16 v[28:31], a[108:111], a[204:207], v[28:31]
  v_add_f32 v104, v104, v170
  v_add_f32 v105, v105, v171
  v_mfma_f32_16x16x32_bf16 v[28:31], a[88:91], a[200:203], v[28:31]
  v_cvt_pk_bf16_f32 v102, v102, v102
  v_cvt_pk_bf16_f32 v103, v103, v103
  v_mfma_f32_16x16x32_bf16 v[32:35], a[92:95], v[152:155], v[32:35]
  buffer_load_dwordx4 v[220:223], v112, s[24:27], s30 offen offset:0 sc1
  v_mfma_f32_16x16x32_bf16 v[32:35], a[112:115], a[180:183], v[32:35]
  v_cvt_pk_bf16_f32 v104, v104, v104
  v_cvt_pk_bf16_f32 v105, v105, v105
  v_mfma_f32_16x16x32_bf16 v[36:39], a[112:115], a[188:191], v[36:39]
  v_lshlrev_b32 v102, 16, v102
  v_lshlrev_b32 v103, 16, v103
  v_mfma_f32_16x16x32_bf16 v[36:39], a[92:95], a[184:187], v[36:39]
  v_lshlrev_b32 v104, 16, v104
  v_lshlrev_b32 v105, 16, v105
  v_mfma_f32_16x16x32_bf16 v[40:43], a[92:95], a[192:195], v[40:43]
  buffer_load_dwordx4 v[224:227], v112, s[24:27], s30 offen offset:1024 sc1
  v_mfma_f32_16x16x32_bf16 v[40:43], a[112:115], a[196:199], v[40:43]
  v_mul_f32 v129, 0xbfb8aa3b, v102
  v_mul_f32 v130, 0xbfb8aa3b, v103
  v_mfma_f32_16x16x32_bf16 v[44:47], a[112:115], a[204:207], v[44:47]
  v_mul_f32 v131, 0xbfb8aa3b, v104
  v_mul_f32 v132, 0xbfb8aa3b, v105
  v_mfma_f32_16x16x32_bf16 v[44:47], a[92:95], a[200:203], v[44:47]
  v_exp_f32 v129, v129
  v_mfma_f32_16x16x32_bf16 v[48:51], a[96:99], v[152:155], v[48:51]
  buffer_load_dwordx4 v[228:231], v113, s[24:27], s30 offen offset:0 sc1
  v_mfma_f32_16x16x32_bf16 v[48:51], a[116:119], a[180:183], v[48:51]
  v_exp_f32 v130, v130
  v_mfma_f32_16x16x32_bf16 v[52:55], a[116:119], a[188:191], v[52:55]
  v_exp_f32 v131, v131
  v_mfma_f32_16x16x32_bf16 v[52:55], a[96:99], a[184:187], v[52:55]
  v_exp_f32 v132, v132
  v_mfma_f32_16x16x32_bf16 v[56:59], a[96:99], a[192:195], v[56:59]
  buffer_load_dwordx4 v[232:235], v113, s[24:27], s30 offen offset:1024 sc1
  v_mfma_f32_16x16x32_bf16 v[56:59], a[116:119], a[196:199], v[56:59]
  v_add_f32 v129, 1.0, v129
  v_add_f32 v130, 1.0, v130
  v_mfma_f32_16x16x32_bf16 v[60:63], a[116:119], a[204:207], v[60:63]
  v_add_f32 v131, 1.0, v131
  v_add_f32 v132, 1.0, v132
  v_mfma_f32_16x16x32_bf16 v[60:63], a[96:99], a[200:203], v[60:63]
  v_rcp_f32 v129, v129
  v_mfma_f32_16x16x32_bf16 v[64:67], a[100:103], v[152:155], v[64:67]
  ds_read_b128 v[236:239], v122 offset:0
  s_add_u32 s30, s30, 8192
  v_rcp_f32 v130, v130
  v_mfma_f32_16x16x32_bf16 v[64:67], a[120:123], a[180:183], v[64:67]
  buffer_load_dwordx4 v[240:243], v110, s[24:27], s30 offen offset:0 sc1
  v_mfma_f32_16x16x32_bf16 v[68:71], a[120:123], a[188:191], v[68:71]
  v_rcp_f32 v131, v131
  v_mfma_f32_16x16x32_bf16 v[68:71], a[100:103], a[184:187], v[68:71]
  v_rcp_f32 v132, v132
  v_mfma_f32_16x16x32_bf16 v[72:75], a[100:103], a[192:195], v[72:75]
  buffer_load_dwordx4 v[244:247], v110, s[24:27], s30 offen offset:1024 sc1
  v_mfma_f32_16x16x32_bf16 v[72:75], a[120:123], a[196:199], v[72:75]
  v_mul_f32 v102, v102, v129
  v_mul_f32 v103, v103, v130
  v_mfma_f32_16x16x32_bf16 v[76:79], a[120:123], a[204:207], v[76:79]
  v_mul_f32 v104, v104, v131
  v_mul_f32 v105, v105, v132
  v_mfma_f32_16x16x32_bf16 v[76:79], a[100:103], a[200:203], v[76:79]
  v_cvt_pk_bf16_f32 v102, v102, v102
  v_cvt_pk_bf16_f32 v103, v103, v103
  s_waitcnt vmcnt(10)
  v_mfma_f32_16x16x32_bf16 v[0:3], a[124:127], a[208:211], v[0:3]
  ds_read_b128 v[248:251], v122 offset:1024
  v_cvt_pk_bf16_f32 v104, v104, v104
  v_mfma_f32_16x16x32_bf16 v[0:3], a[176:179], v[176:179], v[0:3]
  buffer_load_dwordx4 v[252:255], v111, s[24:27], s30 offen offset:0 sc1
  v_mfma_f32_16x16x32_bf16 v[4:7], a[176:179], v[184:187], v[4:7]
  v_cvt_pk_bf16_f32 v105, v105, v105
  v_lshlrev_b32 v102, 16, v102
  v_mfma_f32_16x16x32_bf16 v[4:7], a[124:127], v[180:183], v[4:7]
  v_lshlrev_b32 v103, 16, v103
  v_lshlrev_b32 v104, 16, v104
  v_mfma_f32_16x16x32_bf16 v[8:11], a[124:127], v[188:191], v[8:11]
  buffer_load_dwordx4 v[136:139], v111, s[24:27], s30 offen offset:1024 sc1
  v_mfma_f32_16x16x32_bf16 v[8:11], a[176:179], v[192:195], v[8:11]
  v_lshlrev_b32 v105, 16, v105
  v_cvt_pk_bf16_f32 v172, v172, v172
  v_mfma_f32_16x16x32_bf16 v[12:15], a[176:179], v[200:203], v[12:15]
  v_cvt_pk_bf16_f32 v173, v173, v173
  v_cvt_pk_bf16_f32 v174, v174, v174
  v_mfma_f32_16x16x32_bf16 v[12:15], a[124:127], v[196:199], v[12:15]
  v_cvt_pk_bf16_f32 v175, v175, v175
  v_lshlrev_b32 v172, 16, v172
  s_waitcnt lgkmcnt(1)
  v_mfma_f32_16x16x32_bf16 v[16:19], a[160:163], a[208:211], v[16:19]
  ds_read_b128 v[140:143], v122 offset:2048
  v_lshlrev_b32 v173, 16, v173
  v_mfma_f32_16x16x32_bf16 v[16:19], v[236:239], v[176:179], v[16:19]
  buffer_load_dwordx4 v[144:147], v112, s[24:27], s30 offen offset:0 sc1
  v_mfma_f32_16x16x32_bf16 v[20:23], v[236:239], v[184:187], v[20:23]
  v_lshlrev_b32 v174, 16, v174
  v_lshlrev_b32 v175, 16, v175
  v_mfma_f32_16x16x32_bf16 v[20:23], a[160:163], v[180:183], v[20:23]
  v_mul_f32 v172, v172, v124
  v_mul_f32 v173, v173, v124
  v_mfma_f32_16x16x32_bf16 v[24:27], a[160:163], v[188:191], v[24:27]
  buffer_load_dwordx4 v[148:151], v112, s[24:27], s30 offen offset:1024 sc1
  v_mfma_f32_16x16x32_bf16 v[24:27], v[236:239], v[192:195], v[24:27]
  v_mul_f32 v174, v174, v124
  v_mul_f32 v175, v175, v124
  v_mfma_f32_16x16x32_bf16 v[28:31], v[236:239], v[200:203], v[28:31]
  v_cvt_pk_bf16_f32 v172, v172, v172
  v_cvt_pk_bf16_f32 v173, v173, v173
  v_mfma_f32_16x16x32_bf16 v[28:31], a[160:163], v[196:199], v[28:31]
  v_cvt_pk_bf16_f32 v174, v174, v174
  v_cvt_pk_bf16_f32 v175, v175, v175
  s_waitcnt lgkmcnt(1)
  v_mfma_f32_16x16x32_bf16 v[32:35], a[164:167], a[208:211], v[32:35]
  ds_read_b128 v[152:155], v122 offset:3072
  v_lshlrev_b32 v172, 16, v172
  v_mfma_f32_16x16x32_bf16 v[32:35], v[248:251], v[176:179], v[32:35]
  buffer_load_dwordx4 a[180:183], v113, s[24:27], s30 offen offset:0 sc1
  v_mfma_f32_16x16x32_bf16 v[36:39], v[248:251], v[184:187], v[36:39]
  v_lshlrev_b32 v173, 16, v173
  v_lshlrev_b32 v174, 16, v174
  v_mfma_f32_16x16x32_bf16 v[36:39], a[164:167], v[180:183], v[36:39]
  v_lshlrev_b32 v175, 16, v175
  v_add_f32 v106, v106, v172
  v_mfma_f32_16x16x32_bf16 v[40:43], a[164:167], v[188:191], v[40:43]
  buffer_load_dwordx4 a[184:187], v113, s[24:27], s30 offen offset:1024 sc1
  v_mfma_f32_16x16x32_bf16 v[40:43], v[248:251], v[192:195], v[40:43]
  v_add_f32 v107, v107, v173
  v_add_f32 v108, v108, v174
  v_mfma_f32_16x16x32_bf16 v[44:47], v[248:251], v[200:203], v[44:47]
  v_add_f32 v109, v109, v175
  v_cvt_pk_bf16_f32 v106, v106, v106
  v_mfma_f32_16x16x32_bf16 v[44:47], a[164:167], v[196:199], v[44:47]
  v_cvt_pk_bf16_f32 v107, v107, v107
  v_cvt_pk_bf16_f32 v108, v108, v108
  s_waitcnt lgkmcnt(1)
  v_mfma_f32_16x16x32_bf16 v[48:51], a[168:171], a[208:211], v[48:51]
  ds_read_b128 a[188:191], v122 offset:16384
  ds_read_b128 a[192:195], v122 offset:33792
  s_mov_b32 s30, s37
  v_mfma_f32_16x16x32_bf16 v[48:51], v[140:143], v[176:179], v[48:51]
  buffer_load_dwordx4 a[196:199], v110, s[24:27], s30 offen offset:0 sc1
  v_mfma_f32_16x16x32_bf16 v[52:55], v[140:143], v[184:187], v[52:55]
  v_cvt_pk_bf16_f32 v109, v109, v109
  v_lshlrev_b32 v106, 16, v106
  v_mfma_f32_16x16x32_bf16 v[52:55], a[168:171], v[180:183], v[52:55]
  v_lshlrev_b32 v107, 16, v107
  v_lshlrev_b32 v108, 16, v108
  v_mfma_f32_16x16x32_bf16 v[56:59], a[168:171], v[188:191], v[56:59]
  buffer_load_dwordx4 a[200:203], v110, s[24:27], s30 offen offset:1024 sc1
  v_mfma_f32_16x16x32_bf16 v[56:59], v[140:143], v[192:195], v[56:59]
  v_lshlrev_b32 v109, 16, v109
  v_mul_f32 v129, 0xbfb8aa3b, v106
  v_mfma_f32_16x16x32_bf16 v[60:63], v[140:143], v[200:203], v[60:63]
  v_mul_f32 v130, 0xbfb8aa3b, v107
  v_mul_f32 v131, 0xbfb8aa3b, v108
  v_mfma_f32_16x16x32_bf16 v[60:63], a[168:171], v[196:199], v[60:63]
  v_mul_f32 v132, 0xbfb8aa3b, v109
  v_exp_f32 v129, v129
  s_waitcnt lgkmcnt(2)
  v_mfma_f32_16x16x32_bf16 v[64:67], a[172:175], a[208:211], v[64:67]
  ds_read_b128 a[204:207], v122 offset:17408
  ds_read_b128 v[236:239], v122 offset:34816
  v_mfma_f32_16x16x32_bf16 v[64:67], v[152:155], v[176:179], v[64:67]
  v_exp_f32 v130, v130
  v_mfma_f32_16x16x32_bf16 v[68:71], v[152:155], v[184:187], v[68:71]
  v_exp_f32 v131, v131
  v_mfma_f32_16x16x32_bf16 v[68:71], a[172:175], v[180:183], v[68:71]
  v_exp_f32 v132, v132
  v_mfma_f32_16x16x32_bf16 v[72:75], a[172:175], v[188:191], v[72:75]
  v_add_f32 v129, 1.0, v129
  v_add_f32 v130, 1.0, v130
  v_mfma_f32_16x16x32_bf16 v[72:75], v[152:155], v[192:195], v[72:75]
  v_add_f32 v131, 1.0, v131
  v_add_f32 v132, 1.0, v132
  v_mfma_f32_16x16x32_bf16 v[76:79], v[152:155], v[200:203], v[76:79]
  v_rcp_f32 v129, v129
  v_mfma_f32_16x16x32_bf16 v[76:79], a[172:175], v[196:199], v[76:79]
  v_rcp_f32 v130, v130
  s_waitcnt vmcnt(10) lgkmcnt(2)
  v_mfma_f32_16x16x32_bf16 v[0:3], a[188:191], v[204:207], v[0:3]
  ds_read_b128 v[248:251], v122 offset:18432
  ds_read_b128 v[140:143], v122 offset:35840
  v_mfma_f32_16x16x32_bf16 v[0:3], a[192:195], v[208:211], v[0:3]
  buffer_load_dwordx4 v[152:155], v111, s[24:27], s30 offen offset:0 sc1
  v_mfma_f32_16x16x32_bf16 v[4:7], a[192:195], v[216:219], v[4:7]
  v_rcp_f32 v131, v131
  v_mfma_f32_16x16x32_bf16 v[4:7], a[188:191], v[212:215], v[4:7]
  v_rcp_f32 v132, v132
  v_mfma_f32_16x16x32_bf16 v[8:11], a[188:191], v[220:223], v[8:11]
  buffer_load_dwordx4 a[208:211], v111, s[24:27], s30 offen offset:1024 sc1
  v_mfma_f32_16x16x32_bf16 v[8:11], a[192:195], v[224:227], v[8:11]
  v_mul_f32 v106, v106, v129
  v_mul_f32 v107, v107, v130
  v_mfma_f32_16x16x32_bf16 v[12:15], a[192:195], v[232:235], v[12:15]
  v_mul_f32 v108, v108, v131
  v_mul_f32 v109, v109, v132
  v_mfma_f32_16x16x32_bf16 v[12:15], a[188:191], v[228:231], v[12:15]
  v_cvt_pk_bf16_f32 v106, v106, v106
  v_cvt_pk_bf16_f32 v107, v107, v107
  s_waitcnt lgkmcnt(2)
  v_mfma_f32_16x16x32_bf16 v[16:19], a[204:207], v[204:207], v[16:19]
  ds_read_b128 v[176:179], v122 offset:19456
  ds_read_b128 v[180:183], v135 offset:0
  v_mfma_f32_16x16x32_bf16 v[16:19], v[236:239], v[208:211], v[16:19]
  buffer_load_dwordx4 v[184:187], v112, s[24:27], s30 offen offset:0 sc1
  v_mfma_f32_16x16x32_bf16 v[20:23], v[236:239], v[216:219], v[20:23]
  v_cvt_pk_bf16_f32 v108, v108, v108
  v_cvt_pk_bf16_f32 v109, v109, v109
  v_mfma_f32_16x16x32_bf16 v[20:23], a[204:207], v[212:215], v[20:23]
  v_lshlrev_b32 v106, 16, v106
  v_lshlrev_b32 v107, 16, v107
  v_mfma_f32_16x16x32_bf16 v[24:27], a[204:207], v[220:223], v[24:27]
  buffer_load_dwordx4 v[188:191], v112, s[24:27], s30 offen offset:1024 sc1
  v_mfma_f32_16x16x32_bf16 v[24:27], v[236:239], v[224:227], v[24:27]
  v_lshlrev_b32 v108, 16, v108
  v_lshlrev_b32 v109, 16, v109
  v_mfma_f32_16x16x32_bf16 v[28:31], v[236:239], v[232:235], v[28:31]
  v_lshlrev_b32 v156, 16, v80
  v_and_b32 v157, s34, v80
  v_mfma_f32_16x16x32_bf16 v[28:31], a[204:207], v[228:231], v[28:31]
  v_lshlrev_b32 v158, 16, v81
  v_and_b32 v159, s34, v81
  s_waitcnt lgkmcnt(2)
  v_mfma_f32_16x16x32_bf16 v[32:35], v[248:251], v[204:207], v[32:35]
  ds_read_b128 v[192:195], v122 offset:32768
  ds_read_b128 v[196:199], v135 offset:1024
  v_mfma_f32_16x16x32_bf16 v[32:35], v[140:143], v[208:211], v[32:35]
  buffer_load_dwordx4 v[200:203], v113, s[24:27], s30 offen offset:0 sc1
  v_mfma_f32_16x16x32_bf16 v[36:39], v[140:143], v[216:219], v[36:39]
  v_lshlrev_b32 v160, 16, v82
  v_and_b32 v161, s34, v82
  v_mfma_f32_16x16x32_bf16 v[36:39], v[248:251], v[212:215], v[36:39]
  v_lshlrev_b32 v162, 16, v83
  v_and_b32 v163, s34, v83
  v_mfma_f32_16x16x32_bf16 v[40:43], v[248:251], v[220:223], v[40:43]
  buffer_load_dwordx4 a[188:191], v113, s[24:27], s30 offen offset:1024 sc1
  v_mfma_f32_16x16x32_bf16 v[40:43], v[140:143], v[224:227], v[40:43]
  v_lshlrev_b32 v164, 16, v84
  v_and_b32 v165, s34, v84
  v_mfma_f32_16x16x32_bf16 v[44:47], v[140:143], v[232:235], v[44:47]
  v_lshlrev_b32 v166, 16, v85
  v_and_b32 v167, s34, v85
  v_mfma_f32_16x16x32_bf16 v[44:47], v[248:251], v[228:231], v[44:47]
  v_lshlrev_b32 v168, 16, v86
  v_and_b32 v169, s34, v86
  s_waitcnt lgkmcnt(2)
  v_mfma_f32_16x16x32_bf16 v[48:51], v[176:179], v[204:207], v[48:51]
  ds_read_b128 a[192:195], v135 offset:2048
  ds_read_b128 a[204:207], v135 offset:19456
  s_add_u32 s30, s30, 8192
  v_mfma_f32_16x16x32_bf16 v[48:51], v[180:183], v[208:211], v[48:51]
  buffer_load_dwordx4 v[236:239], v110, s[24:27], s30 offen offset:0 sc1
  v_mfma_f32_16x16x32_bf16 v[52:55], v[180:183], v[216:219], v[52:55]
  v_lshlrev_b32 v170, 16, v87
  v_and_b32 v171, s34, v87
  v_mfma_f32_16x16x32_bf16 v[52:55], v[176:179], v[212:215], v[52:55]
  v_lshlrev_b32 v172, 16, v88
  v_and_b32 v173, s34, v88
  v_mfma_f32_16x16x32_bf16 v[56:59], v[176:179], v[220:223], v[56:59]
  v_lshlrev_b32 v174, 16, v89
  v_and_b32 v175, s34, v89
  v_mfma_f32_16x16x32_bf16 v[56:59], v[180:183], v[224:227], v[56:59]
  s_sub_u32 s41, s3, 1
  s_and_b32 s41, s41, 3
  s_lshl_b32 s41, s41, 12
  v_add_u32 v80, s41, v114
  v_mfma_f32_16x16x32_bf16 v[60:63], v[180:183], v[232:235], v[60:63]
  s_sub_u32 s41, s3, 2
  s_and_b32 s41, s41, 3
  s_lshl_b32 s41, s41, 12
  v_add_u32 v81, s41, v114
  v_mfma_f32_16x16x32_bf16 v[60:63], v[176:179], v[228:231], v[60:63]
  s_sub_u32 s41, s3, 3
  s_and_b32 s41, s41, 3
  s_lshl_b32 s41, s41, 12
  v_add_u32 v82, s41, v114
  v_bfe_u32 v129, v114, 8, 1
  s_waitcnt lgkmcnt(2)
  v_mfma_f32_16x16x32_bf16 v[64:67], v[192:195], v[204:207], v[64:67]
  ds_read_b128 v[248:251], v135 offset:3072
  ds_read_b128 v[140:143], v122 offset:49152
  v_mfma_f32_16x16x32_bf16 v[64:67], v[196:199], v[208:211], v[64:67]
  v_mul_u32_u24 v129, 24, v129
  v_add_u32 v83, v117, v129
  v_mfma_f32_16x16x32_bf16 v[68:71], v[196:199], v[216:219], v[68:71]
  v_mfma_f32_16x16x32_bf16 v[68:71], v[192:195], v[212:215], v[68:71]
  v_mfma_f32_16x16x32_bf16 v[72:75], v[192:195], v[220:223], v[72:75]
  v_mfma_f32_16x16x32_bf16 v[72:75], v[196:199], v[224:227], v[72:75]
  v_mfma_f32_16x16x32_bf16 v[76:79], v[196:199], v[232:235], v[76:79]
  v_mfma_f32_16x16x32_bf16 v[76:79], v[192:195], v[228:231], v[76:79]
  s_waitcnt vmcnt(9) lgkmcnt(2)
  v_mfma_f32_16x16x32_bf16 v[0:3], a[192:195], v[240:243], v[0:3]
  ds_read_b128 v[176:179], v135 offset:16384
  ds_read_b128 v[180:183], v122 offset:50176
  s_xor_b32 s38, s40, 1
  v_mfma_f32_16x16x32_bf16 v[0:3], a[204:207], v[244:247], v[0:3]
  buffer_load_dwordx4 v[192:195], v110, s[24:27], s30 offen offset:1024 sc1
  s_lshl_b32 s38, s38, 2
  s_add_u32 s38, s38, s3
  s_lshl_b32 s38, s38, 12
  v_mfma_f32_16x16x32_bf16 v[4:7], a[204:207], v[136:139], v[4:7]
  s_add_u32 s38, s38, 25165824
  v_lshrrev_b32 v125, 1, v114
  v_mfma_f32_16x16x32_bf16 v[4:7], a[192:195], v[252:255], v[4:7]
  v_mfma_f32_16x16x32_bf16 v[8:11], a[192:195], v[144:147], v[8:11]
  buffer_load_dwordx4 v[196:199], v111, s[24:27], s30 offen offset:0 sc1
  v_mfma_f32_16x16x32_bf16 v[8:11], a[204:207], v[148:151], v[8:11]
  v_mfma_f32_16x16x32_bf16 v[12:15], a[204:207], a[184:187], v[12:15]
  v_mfma_f32_16x16x32_bf16 v[12:15], a[192:195], a[180:183], v[12:15]
  s_waitcnt lgkmcnt(2)
  v_mfma_f32_16x16x32_bf16 v[16:19], v[248:251], v[240:243], v[16:19]
  ds_read_b128 v[204:207], v135 offset:17408
  ds_read_b128 v[208:211], v122 offset:51200
  v_mfma_f32_16x16x32_bf16 v[16:19], v[140:143], v[244:247], v[16:19]
  buffer_load_dwordx4 v[212:215], v111, s[24:27], s30 offen offset:1024 sc1
  v_mfma_f32_16x16x32_bf16 v[20:23], v[140:143], v[136:139], v[20:23]
  ds_write_b128 v118, v[4:7] offset:0
  ds_write_b128 v118, v[8:11] offset:5120
  v_mfma_f32_16x16x32_bf16 v[20:23], v[248:251], v[252:255], v[20:23]
  ds_write_b128 v118, v[12:15] offset:10240
  v_mfma_f32_16x16x32_bf16 v[24:27], v[248:251], v[144:147], v[24:27]
  buffer_load_dwordx4 v[216:219], v112, s[24:27], s30 offen offset:0 sc1
  v_mfma_f32_16x16x32_bf16 v[24:27], v[140:143], v[148:151], v[24:27]
  v_mfma_f32_16x16x32_bf16 v[28:31], v[140:143], a[184:187], v[28:31]
  v_mfma_f32_16x16x32_bf16 v[28:31], v[248:251], a[180:183], v[28:31]
  s_waitcnt lgkmcnt(5)
  v_mfma_f32_16x16x32_bf16 v[32:35], v[176:179], v[240:243], v[32:35]
  ds_read_b128 v[220:223], v135 offset:18432
  ds_read_b128 v[224:227], v122 offset:52224
  v_mfma_f32_16x16x32_bf16 v[32:35], v[180:183], v[244:247], v[32:35]
  buffer_load_dwordx4 v[228:231], v112, s[24:27], s30 offen offset:1024 sc1
  v_mfma_f32_16x16x32_bf16 v[36:39], v[180:183], v[136:139], v[36:39]
  ds_write_b128 v118, v[20:23] offset:1024
  ds_write_b128 v118, v[24:27] offset:6144
  v_mfma_f32_16x16x32_bf16 v[36:39], v[176:179], v[252:255], v[36:39]
  ds_write_b128 v118, v[28:31] offset:11264
  v_mfma_f32_16x16x32_bf16 v[40:43], v[176:179], v[144:147], v[40:43]
  buffer_load_dwordx4 v[232:235], v113, s[24:27], s30 offen offset:0 sc1
  v_mfma_f32_16x16x32_bf16 v[40:43], v[180:183], v[148:151], v[40:43]
  v_mfma_f32_16x16x32_bf16 v[44:47], v[180:183], a[184:187], v[44:47]
  v_mfma_f32_16x16x32_bf16 v[44:47], v[176:179], a[180:183], v[44:47]
  s_waitcnt lgkmcnt(8)
  v_mfma_f32_16x16x32_bf16 v[48:51], v[204:207], v[240:243], v[48:51]
  buffer_load_dwordx4 a[192:195], v113, s[24:27], s30 offen offset:1024 sc1
  v_mfma_f32_16x16x32_bf16 v[48:51], v[208:211], v[244:247], v[48:51]
  ds_write_b128 v118, v[36:39] offset:2048
  v_mfma_f32_16x16x32_bf16 v[52:55], v[208:211], v[136:139], v[52:55]
  ds_write_b128 v118, v[40:43] offset:7168
  v_mfma_f32_16x16x32_bf16 v[52:55], v[204:207], v[252:255], v[52:55]
  ds_write_b128 v118, v[44:47] offset:12288
  v_mfma_f32_16x16x32_bf16 v[56:59], v[204:207], v[144:147], v[56:59]
  s_add_u32 s30, s30, 8192
  buffer_load_dwordx4 a[204:207], v110, s[24:27], s30 offen offset:0 sc1
  v_mfma_f32_16x16x32_bf16 v[56:59], v[208:211], v[148:151], v[56:59]
  v_mfma_f32_16x16x32_bf16 v[60:63], v[208:211], a[184:187], v[60:63]
  v_mfma_f32_16x16x32_bf16 v[60:63], v[204:207], a[180:183], v[60:63]
  s_waitcnt lgkmcnt(6)
  v_mfma_f32_16x16x32_bf16 v[64:67], v[220:223], v[240:243], v[64:67]
  buffer_load_dwordx4 v[248:251], v110, s[24:27], s30 offen offset:1024 sc1
  v_mfma_f32_16x16x32_bf16 v[64:67], v[224:227], v[244:247], v[64:67]
  ds_write_b128 v118, v[52:55] offset:3072
  v_mfma_f32_16x16x32_bf16 v[68:71], v[224:227], v[136:139], v[68:71]
  ds_write_b128 v118, v[56:59] offset:8192
  v_mfma_f32_16x16x32_bf16 v[68:71], v[220:223], v[252:255], v[68:71]
  ds_write_b128 v118, v[60:63] offset:13312
  v_mfma_f32_16x16x32_bf16 v[72:75], v[220:223], v[144:147], v[72:75]
  buffer_load_dwordx4 v[140:143], v111, s[24:27], s30 offen offset:0 sc1
  v_mfma_f32_16x16x32_bf16 v[72:75], v[224:227], v[148:151], v[72:75]
  v_mfma_f32_16x16x32_bf16 v[76:79], v[224:227], a[184:187], v[76:79]
  v_mfma_f32_16x16x32_bf16 v[76:79], v[220:223], a[180:183], v[76:79]
  s_nop 1
  ds_write_b128 v118, v[68:71] offset:4096
  s_nop 2
  ds_write_b128 v118, v[72:75] offset:9216
  s_nop 0
  ds_write_b128 v118, v[76:79] offset:14336
  buffer_load_dwordx4 v[176:179], v111, s[24:27], s30 offen offset:1024 sc1
  buffer_load_dwordx4 v[180:183], v112, s[24:27], s30 offen offset:0 sc1
  buffer_load_dwordx4 v[204:207], v112, s[24:27], s30 offen offset:1024 sc1
  buffer_load_dwordx4 v[208:211], v113, s[24:27], s30 offen offset:0 sc1
  buffer_load_dwordx4 v[220:223], v113, s[24:27], s30 offen offset:1024 sc1
  s_add_u32 s30, s30, 8192
  buffer_load_dwordx4 v[224:227], v110, s[24:27], s30 offen offset:0 sc1
  buffer_load_dwordx4 v[240:243], v110, s[24:27], s30 offen offset:1024 sc1
  buffer_load_dwordx4 v[244:247], v111, s[24:27], s30 offen offset:0 sc1
  buffer_load_dwordx4 v[252:255], v111, s[24:27], s30 offen offset:1024 sc1
  buffer_load_dwordx4 v[136:139], v112, s[24:27], s30 offen offset:0 sc1
  buffer_load_dwordx4 v[144:147], v112, s[24:27], s30 offen offset:1024 sc1
  buffer_load_dwordx4 v[148:151], v113, s[24:27], s30 offen offset:0 sc1
  buffer_load_dwordx4 a[180:183], v113, s[24:27], s30 offen offset:1024 sc1
  s_add_u32 s30, s30, 8192
  buffer_load_dwordx4 a[184:187], v110, s[24:27], s30 offen offset:0 sc1
  s_waitcnt lgkmcnt(0)
  s_barrier
  ds_read_b128 v[4:7], v119 offset:0
  ds_read_b128 v[8:11], v120 offset:5120
  ds_read_b128 v[12:15], v121 offset:10240
  ds_read_b128 v[20:23], v119 offset:1024
  ds_read_b128 v[24:27], v120 offset:6144
  ds_read_b128 v[28:31], v121 offset:11264
  ds_read_b128 v[36:39], v119 offset:2048
  ds_read_b128 v[40:43], v120 offset:7168
  ds_read_b128 v[44:47], v121 offset:12288
  ds_read_b128 v[52:55], v119 offset:3072
  ds_read_b128 v[56:59], v120 offset:8192
  ds_read_b128 v[60:63], v121 offset:13312
  ds_read_b128 v[68:71], v119 offset:4096
  ds_read_b128 v[72:75], v120 offset:9216
  ds_read_b128 v[76:79], v121 offset:14336
  s_waitcnt lgkmcnt(12)
  v_add_f32 v4, v4, v8
  v_add_f32 v5, v5, v9
  v_add_f32 v6, v6, v10
  v_add_f32 v7, v7, v11
  v_add_f32 v0, v0, v12
  v_add_f32 v1, v1, v13
  v_add_f32 v2, v2, v14
  v_add_f32 v3, v3, v15
  v_add_f32 v0, v0, v4
  v_add_f32 v1, v1, v5
  v_add_f32 v2, v2, v6
  v_add_f32 v3, v3, v7
  v_cvt_pk_bf16_f32 v4, v0, v1
  v_cvt_pk_bf16_f32 v5, v2, v3
  buffer_store_dwordx2 v[4:5], v125, s[24:27], s38 offen offset:0 sc1
  s_waitcnt vmcnt(26)
  v_mfma_f32_16x16x32_bf16 v[0:3], a[212:215], a[196:199], 0
  s_waitcnt lgkmcnt(9)
  v_add_f32 v20, v20, v24
  v_add_f32 v21, v21, v25
  v_mfma_f32_16x16x32_bf16 v[0:3], a[232:235], a[200:203], v[0:3]
  v_add_f32 v22, v22, v26
  v_add_f32 v23, v23, v27
  v_mfma_f32_16x16x32_bf16 v[4:7], a[232:235], a[208:211], 0
  v_add_f32 v16, v16, v28
  v_add_f32 v17, v17, v29
  v_mfma_f32_16x16x32_bf16 v[4:7], a[212:215], v[152:155], v[4:7]
  v_add_f32 v18, v18, v30
  v_add_f32 v19, v19, v31
  v_mfma_f32_16x16x32_bf16 v[8:11], a[212:215], v[184:187], 0
  v_add_f32 v16, v16, v20
  v_add_f32 v17, v17, v21
  v_mfma_f32_16x16x32_bf16 v[8:11], a[232:235], v[188:191], v[8:11]
  v_add_f32 v18, v18, v22
  v_add_f32 v19, v19, v23
  v_mfma_f32_16x16x32_bf16 v[12:15], a[232:235], a[188:191], 0
  v_cvt_pk_bf16_f32 v20, v16, v17
  v_cvt_pk_bf16_f32 v21, v18, v19
  v_mfma_f32_16x16x32_bf16 v[12:15], a[212:215], v[200:203], v[12:15]
  buffer_store_dwordx2 v[20:21], v125, s[24:27], s38 offen offset:512 sc1
  s_waitcnt lgkmcnt(6)
  v_mfma_f32_16x16x32_bf16 v[16:19], a[216:219], a[196:199], 0
  buffer_load_dwordx4 a[212:215], v110, s[24:27], s30 offen offset:1024 sc1
  v_mfma_f32_16x16x32_bf16 v[16:19], a[236:239], a[200:203], v[16:19]
  v_add_f32 v36, v36, v40
  v_add_f32 v37, v37, v41
  v_mfma_f32_16x16x32_bf16 v[20:23], a[236:239], a[208:211], 0
  v_add_f32 v38, v38, v42
  v_add_f32 v39, v39, v43
  v_mfma_f32_16x16x32_bf16 v[20:23], a[216:219], v[152:155], v[20:23]
  v_add_f32 v32, v32, v44
  v_add_f32 v33, v33, v45
  v_mfma_f32_16x16x32_bf16 v[24:27], a[216:219], v[184:187], 0
  buffer_load_dwordx4 a[232:235], v111, s[24:27], s30 offen offset:0 sc1
  v_mfma_f32_16x16x32_bf16 v[24:27], a[236:239], v[188:191], v[24:27]
  v_add_f32 v34, v34, v46
  v_add_f32 v35, v35, v47
  v_mfma_f32_16x16x32_bf16 v[28:31], a[236:239], a[188:191], 0
  v_add_f32 v32, v32, v36
  v_add_f32 v33, v33, v37
  v_mfma_f32_16x16x32_bf16 v[28:31], a[216:219], v[200:203], v[28:31]
  v_add_f32 v34, v34, v38
  v_add_f32 v35, v35, v39
  v_cvt_pk_bf16_f32 v36, v32, v33
  v_cvt_pk_bf16_f32 v37, v34, v35
  buffer_store_dwordx2 v[36:37], v125, s[24:27], s38 offen offset:1024 sc1
  v_mfma_f32_16x16x32_bf16 v[32:35], a[220:223], a[196:199], 0
  buffer_load_dwordx4 a[216:219], v111, s[24:27], s30 offen offset:1024 sc1
  s_waitcnt lgkmcnt(3)
  v_mfma_f32_16x16x32_bf16 v[32:35], a[240:243], a[200:203], v[32:35]
  v_add_f32 v52, v52, v56
  v_add_f32 v53, v53, v57
  v_mfma_f32_16x16x32_bf16 v[36:39], a[240:243], a[208:211], 0
  v_add_f32 v54, v54, v58
  v_add_f32 v55, v55, v59
  v_mfma_f32_16x16x32_bf16 v[36:39], a[220:223], v[152:155], v[36:39]
  v_add_f32 v48, v48, v60
  v_add_f32 v49, v49, v61
  v_mfma_f32_16x16x32_bf16 v[40:43], a[220:223], v[184:187], 0
  buffer_load_dwordx4 a[236:239], v112, s[24:27], s30 offen offset:0 sc1
  v_mfma_f32_16x16x32_bf16 v[40:43], a[240:243], v[188:191], v[40:43]
  v_add_f32 v50, v50, v62
  v_add_f32 v51, v51, v63
  v_mfma_f32_16x16x32_bf16 v[44:47], a[240:243], a[188:191], 0
  v_add_f32 v48, v48, v52
  v_add_f32 v49, v49, v53
  v_mfma_f32_16x16x32_bf16 v[44:47], a[220:223], v[200:203], v[44:47]
  v_add_f32 v50, v50, v54
  v_add_f32 v51, v51, v55
  v_cvt_pk_bf16_f32 v52, v48, v49
  v_cvt_pk_bf16_f32 v53, v50, v51
  buffer_store_dwordx2 v[52:53], v125, s[24:27], s38 offen offset:1536 sc1
  v_mfma_f32_16x16x32_bf16 v[48:51], a[224:227], a[196:199], 0
  buffer_load_dwordx4 a[220:223], v112, s[24:27], s30 offen offset:1024 sc1
  s_waitcnt lgkmcnt(0)
  v_mfma_f32_16x16x32_bf16 v[48:51], a[244:247], a[200:203], v[48:51]
  v_add_f32 v68, v68, v72
  v_add_f32 v69, v69, v73
  v_mfma_f32_16x16x32_bf16 v[52:55], a[244:247], a[208:211], 0
  v_add_f32 v70, v70, v74
  v_add_f32 v71, v71, v75
  v_mfma_f32_16x16x32_bf16 v[52:55], a[224:227], v[152:155], v[52:55]
  v_add_f32 v64, v64, v76
  v_add_f32 v65, v65, v77
  v_mfma_f32_16x16x32_bf16 v[56:59], a[224:227], v[184:187], 0
  buffer_load_dwordx4 a[240:243], v113, s[24:27], s30 offen offset:0 sc1
  v_mfma_f32_16x16x32_bf16 v[56:59], a[244:247], v[188:191], v[56:59]
  v_add_f32 v66, v66, v78
  v_add_f32 v67, v67, v79
  v_mfma_f32_16x16x32_bf16 v[60:63], a[244:247], a[188:191], 0
  v_add_f32 v64, v64, v68
  v_add_f32 v65, v65, v69
  v_mfma_f32_16x16x32_bf16 v[60:63], a[224:227], v[200:203], v[60:63]
  v_add_f32 v66, v66, v70
  v_add_f32 v67, v67, v71
  v_cvt_pk_bf16_f32 v68, v64, v65
  v_cvt_pk_bf16_f32 v69, v66, v67
  buffer_store_dwordx2 v[68:69], v125, s[24:27], s38 offen offset:2048 sc1
  v_mfma_f32_16x16x32_bf16 v[64:67], a[228:231], a[196:199], 0
  buffer_load_dwordx4 a[224:227], v113, s[24:27], s30 offen offset:1024 sc1
  s_xor_b32 s38, s40, 1
  s_lshl_b32 s38, s38, 7
  s_add_u32 s38, s38, 2834432
  v_mfma_f32_16x16x32_bf16 v[64:67], a[248:251], a[200:203], v[64:67]
  v_mov_b32 v126, 1073741824
  v_writelane_b32 v126, s38, 0
  v_mfma_f32_16x16x32_bf16 v[68:71], a[248:251], a[208:211], 0
  v_mov_b32 v127, 1
  v_mfma_f32_16x16x32_bf16 v[68:71], a[228:231], v[152:155], v[68:71]
  s_xor_b32 s38, s38, 128
  v_mov_b32 v133, s38
  v_mov_b32 v134, 4
  v_mfma_f32_16x16x32_bf16 v[72:75], a[228:231], v[184:187], 0
  s_add_u32 s30, s30, 8192
  buffer_load_dwordx4 a[244:247], v110, s[24:27], s30 offen offset:0 sc1
  v_mfma_f32_16x16x32_bf16 v[72:75], a[248:251], v[188:191], v[72:75]
  v_mfma_f32_16x16x32_bf16 v[76:79], a[248:251], a[188:191], 0
  v_mfma_f32_16x16x32_bf16 v[76:79], a[228:231], v[200:203], v[76:79]
  s_waitcnt vmcnt(30)
  v_mfma_f32_16x16x32_bf16 v[0:3], a[252:255], v[236:239], v[0:3]
  buffer_load_dwordx4 a[228:231], v110, s[24:27], s30 offen offset:1024 sc1
  v_mfma_f32_16x16x32_bf16 v[0:3], a[144:147], v[192:195], v[0:3]
  v_mfma_f32_16x16x32_bf16 v[4:7], a[144:147], v[212:215], v[4:7]
  v_mfma_f32_16x16x32_bf16 v[4:7], a[252:255], v[196:199], v[4:7]
  v_mfma_f32_16x16x32_bf16 v[8:11], a[252:255], v[216:219], v[8:11]
  buffer_load_dwordx4 a[248:251], v111, s[24:27], s30 offen offset:0 sc1
  v_mfma_f32_16x16x32_bf16 v[8:11], a[144:147], v[228:231], v[8:11]
  v_mfma_f32_16x16x32_bf16 v[12:15], a[144:147], a[192:195], v[12:15]
  v_mfma_f32_16x16x32_bf16 v[12:15], a[252:255], v[232:235], v[12:15]
  v_mfma_f32_16x16x32_bf16 v[16:19], a[128:131], v[236:239], v[16:19]
  buffer_load_dwordx4 a[196:199], v111, s[24:27], s30 offen offset:1024 sc1
  v_mfma_f32_16x16x32_bf16 v[16:19], a[148:151], v[192:195], v[16:19]
  v_mfma_f32_16x16x32_bf16 v[20:23], a[148:151], v[212:215], v[20:23]
  v_mfma_f32_16x16x32_bf16 v[20:23], a[128:131], v[196:199], v[20:23]
  v_mfma_f32_16x16x32_bf16 v[24:27], a[128:131], v[216:219], v[24:27]
  buffer_load_dwordx4 a[200:203], v112, s[24:27], s30 offen offset:0 sc1
  v_mfma_f32_16x16x32_bf16 v[24:27], a[148:151], v[228:231], v[24:27]
  v_mfma_f32_16x16x32_bf16 v[28:31], a[148:151], a[192:195], v[28:31]
  v_mfma_f32_16x16x32_bf16 v[28:31], a[128:131], v[232:235], v[28:31]
  v_mfma_f32_16x16x32_bf16 v[32:35], a[132:135], v[236:239], v[32:35]
  buffer_load_dwordx4 a[208:211], v112, s[24:27], s30 offen offset:1024 sc1
  v_mfma_f32_16x16x32_bf16 v[32:35], a[152:155], v[192:195], v[32:35]
  v_mfma_f32_16x16x32_bf16 v[36:39], a[152:155], v[212:215], v[36:39]
  v_mfma_f32_16x16x32_bf16 v[36:39], a[132:135], v[196:199], v[36:39]
  v_mfma_f32_16x16x32_bf16 v[40:43], a[132:135], v[216:219], v[40:43]
  buffer_load_dwordx4 v[184:187], v113, s[24:27], s30 offen offset:0 sc1
  v_mfma_f32_16x16x32_bf16 v[40:43], a[152:155], v[228:231], v[40:43]
  v_mfma_f32_16x16x32_bf16 v[44:47], a[152:155], a[192:195], v[44:47]
  v_mfma_f32_16x16x32_bf16 v[44:47], a[132:135], v[232:235], v[44:47]
  v_mfma_f32_16x16x32_bf16 v[48:51], a[136:139], v[236:239], v[48:51]
  buffer_load_dwordx4 v[188:191], v113, s[24:27], s30 offen offset:1024 sc1
  v_mfma_f32_16x16x32_bf16 v[48:51], a[156:159], v[192:195], v[48:51]
  v_mfma_f32_16x16x32_bf16 v[52:55], a[156:159], v[212:215], v[52:55]
  v_mfma_f32_16x16x32_bf16 v[52:55], a[136:139], v[196:199], v[52:55]
  v_mfma_f32_16x16x32_bf16 v[56:59], a[136:139], v[216:219], v[56:59]
  s_add_u32 s30, s30, 8192
  buffer_load_dwordx4 v[200:203], v110, s[24:27], s30 offen offset:0 sc1
  v_mfma_f32_16x16x32_bf16 v[56:59], a[156:159], v[228:231], v[56:59]
  v_mfma_f32_16x16x32_bf16 v[60:63], a[156:159], a[192:195], v[60:63]
  v_mfma_f32_16x16x32_bf16 v[60:63], a[136:139], v[232:235], v[60:63]
  v_mfma_f32_16x16x32_bf16 v[64:67], a[140:143], v[236:239], v[64:67]
  buffer_load_dwordx4 a[188:191], v110, s[24:27], s30 offen offset:1024 sc1
  v_mfma_f32_16x16x32_bf16 v[64:67], a[0:3], v[192:195], v[64:67]
  v_mfma_f32_16x16x32_bf16 v[68:71], a[0:3], v[212:215], v[68:71]
  v_mfma_f32_16x16x32_bf16 v[68:71], a[140:143], v[196:199], v[68:71]
  v_mfma_f32_16x16x32_bf16 v[72:75], a[140:143], v[216:219], v[72:75]
  buffer_load_dwordx4 a[252:255], v111, s[24:27], s30 offen offset:0 sc1
  v_mfma_f32_16x16x32_bf16 v[72:75], a[0:3], v[228:231], v[72:75]
  v_mfma_f32_16x16x32_bf16 v[76:79], a[0:3], a[192:195], v[76:79]
  v_mfma_f32_16x16x32_bf16 v[76:79], a[140:143], v[232:235], v[76:79]
  s_waitcnt vmcnt(32)
  v_mfma_f32_16x16x32_bf16 v[0:3], a[4:7], a[204:207], v[0:3]
  buffer_load_dwordx4 a[144:147], v111, s[24:27], s30 offen offset:1024 sc1
  v_mfma_f32_16x16x32_bf16 v[0:3], a[24:27], v[248:251], v[0:3]
  v_mfma_f32_16x16x32_bf16 v[4:7], a[24:27], v[176:179], v[4:7]
  v_mfma_f32_16x16x32_bf16 v[4:7], a[4:7], v[140:143], v[4:7]
  v_mfma_f32_16x16x32_bf16 v[8:11], a[4:7], v[180:183], v[8:11]
  buffer_load_dwordx4 a[128:131], v112, s[24:27], s30 offen offset:0 sc1
  v_mfma_f32_16x16x32_bf16 v[8:11], a[24:27], v[204:207], v[8:11]
  v_mfma_f32_16x16x32_bf16 v[12:15], a[24:27], v[220:223], v[12:15]
  v_mfma_f32_16x16x32_bf16 v[12:15], a[4:7], v[208:211], v[12:15]
  v_mfma_f32_16x16x32_bf16 v[16:19], a[8:11], a[204:207], v[16:19]
  buffer_load_dwordx4 a[148:151], v112, s[24:27], s30 offen offset:1024 sc1
  v_mfma_f32_16x16x32_bf16 v[16:19], a[28:31], v[248:251], v[16:19]
  v_mfma_f32_16x16x32_bf16 v[20:23], a[28:31], v[176:179], v[20:23]
  v_mfma_f32_16x16x32_bf16 v[20:23], a[8:11], v[140:143], v[20:23]
  v_mfma_f32_16x16x32_bf16 v[24:27], a[8:11], v[180:183], v[24:27]
  buffer_load_dwordx4 a[132:135], v113, s[24:27], s30 offen offset:0 sc1
  v_mfma_f32_16x16x32_bf16 v[24:27], a[28:31], v[204:207], v[24:27]
  v_mfma_f32_16x16x32_bf16 v[28:31], a[28:31], v[220:223], v[28:31]
  v_mfma_f32_16x16x32_bf16 v[28:31], a[8:11], v[208:211], v[28:31]
  v_mfma_f32_16x16x32_bf16 v[32:35], a[12:15], a[204:207], v[32:35]
  buffer_load_dwordx4 a[152:155], v113, s[24:27], s30 offen offset:1024 sc1
  v_mfma_f32_16x16x32_bf16 v[32:35], a[32:35], v[248:251], v[32:35]
  v_mfma_f32_16x16x32_bf16 v[36:39], a[32:35], v[176:179], v[36:39]
  v_mfma_f32_16x16x32_bf16 v[36:39], a[12:15], v[140:143], v[36:39]
  v_mfma_f32_16x16x32_bf16 v[40:43], a[12:15], v[180:183], v[40:43]
  s_add_u32 s30, s30, 8192
  buffer_load_dwordx4 a[136:139], v110, s[24:27], s30 offen offset:0 sc1
  v_mfma_f32_16x16x32_bf16 v[40:43], a[32:35], v[204:207], v[40:43]
  v_mfma_f32_16x16x32_bf16 v[44:47], a[32:35], v[220:223], v[44:47]
  v_mfma_f32_16x16x32_bf16 v[44:47], a[12:15], v[208:211], v[44:47]
  v_mfma_f32_16x16x32_bf16 v[48:51], a[16:19], a[204:207], v[48:51]
  buffer_load_dwordx4 a[156:159], v110, s[24:27], s30 offen offset:1024 sc1
  v_mfma_f32_16x16x32_bf16 v[48:51], a[36:39], v[248:251], v[48:51]
  v_mfma_f32_16x16x32_bf16 v[52:55], a[36:39], v[176:179], v[52:55]
  v_mfma_f32_16x16x32_bf16 v[52:55], a[16:19], v[140:143], v[52:55]
  v_mfma_f32_16x16x32_bf16 v[56:59], a[16:19], v[180:183], v[56:59]
  buffer_load_dwordx4 a[140:143], v111, s[24:27], s30 offen offset:0 sc1
  v_mfma_f32_16x16x32_bf16 v[56:59], a[36:39], v[204:207], v[56:59]
  v_mfma_f32_16x16x32_bf16 v[60:63], a[36:39], v[220:223], v[60:63]
  v_mfma_f32_16x16x32_bf16 v[60:63], a[16:19], v[208:211], v[60:63]
  v_mfma_f32_16x16x32_bf16 v[64:67], a[20:23], a[204:207], v[64:67]
  buffer_load_dwordx4 a[0:3], v111, s[24:27], s30 offen offset:1024 sc1
  v_mfma_f32_16x16x32_bf16 v[64:67], a[40:43], v[248:251], v[64:67]
  v_mfma_f32_16x16x32_bf16 v[68:71], a[40:43], v[176:179], v[68:71]
  v_mfma_f32_16x16x32_bf16 v[68:71], a[20:23], v[140:143], v[68:71]
  v_mfma_f32_16x16x32_bf16 v[72:75], a[20:23], v[180:183], v[72:75]
  buffer_load_dwordx4 v[236:239], v112, s[24:27], s30 offen offset:0 sc1
  v_mfma_f32_16x16x32_bf16 v[72:75], a[40:43], v[204:207], v[72:75]
  v_mfma_f32_16x16x32_bf16 v[76:79], a[40:43], v[220:223], v[76:79]
  v_mfma_f32_16x16x32_bf16 v[76:79], a[20:23], v[208:211], v[76:79]
  s_waitcnt vmcnt(34)
  v_mfma_f32_16x16x32_bf16 v[0:3], a[44:47], v[224:227], v[0:3]
  buffer_load_dwordx4 v[192:195], v112, s[24:27], s30 offen offset:1024 sc1
  s_waitcnt vmcnt(23)
  v_mfma_f32_16x16x32_bf16 v[0:3], a[64:67], v[240:243], v[0:3]
  buffer_atomic_add v127, v126, s[24:27], 0 offen
  v_mfma_f32_16x16x32_bf16 v[4:7], a[64:67], v[252:255], v[4:7]
  v_mfma_f32_16x16x32_bf16 v[4:7], a[44:47], v[244:247], v[4:7]
  v_mfma_f32_16x16x32_bf16 v[8:11], a[44:47], v[136:139], v[8:11]
  buffer_load_dwordx4 v[196:199], v113, s[24:27], s30 offen offset:0 sc1
  v_mfma_f32_16x16x32_bf16 v[8:11], a[64:67], v[144:147], v[8:11]
  v_mfma_f32_16x16x32_bf16 v[12:15], a[64:67], a[180:183], v[12:15]
  v_mfma_f32_16x16x32_bf16 v[12:15], a[44:47], v[148:151], v[12:15]
  v_mfma_f32_16x16x32_bf16 v[16:19], a[48:51], v[224:227], v[16:19]
  buffer_load_dwordx4 v[212:215], v113, s[24:27], s30 offen offset:1024 sc1
  v_mfma_f32_16x16x32_bf16 v[16:19], a[68:71], v[240:243], v[16:19]
  v_mfma_f32_16x16x32_bf16 v[20:23], a[68:71], v[252:255], v[20:23]
  v_mfma_f32_16x16x32_bf16 v[20:23], a[48:51], v[244:247], v[20:23]
  v_mfma_f32_16x16x32_bf16 v[24:27], a[48:51], v[136:139], v[24:27]
  s_add_u32 s30, s30, 8192
  v_mfma_f32_16x16x32_bf16 v[24:27], a[68:71], v[144:147], v[24:27]
  v_mfma_f32_16x16x32_bf16 v[28:31], a[68:71], a[180:183], v[28:31]
  v_mfma_f32_16x16x32_bf16 v[28:31], a[48:51], v[148:151], v[28:31]
  v_mfma_f32_16x16x32_bf16 v[32:35], a[52:55], v[224:227], v[32:35]
  v_mfma_f32_16x16x32_bf16 v[32:35], a[72:75], v[240:243], v[32:35]
  v_mfma_f32_16x16x32_bf16 v[36:39], a[72:75], v[252:255], v[36:39]
  v_mfma_f32_16x16x32_bf16 v[36:39], a[52:55], v[244:247], v[36:39]
  v_mfma_f32_16x16x32_bf16 v[40:43], a[52:55], v[136:139], v[40:43]
  v_mfma_f32_16x16x32_bf16 v[40:43], a[72:75], v[144:147], v[40:43]
  v_mfma_f32_16x16x32_bf16 v[44:47], a[72:75], a[180:183], v[44:47]
  v_mfma_f32_16x16x32_bf16 v[44:47], a[52:55], v[148:151], v[44:47]
  v_mfma_f32_16x16x32_bf16 v[48:51], a[56:59], v[224:227], v[48:51]
  v_mfma_f32_16x16x32_bf16 v[48:51], a[76:79], v[240:243], v[48:51]
  v_mfma_f32_16x16x32_bf16 v[52:55], a[76:79], v[252:255], v[52:55]
  v_mfma_f32_16x16x32_bf16 v[52:55], a[56:59], v[244:247], v[52:55]
  v_mfma_f32_16x16x32_bf16 v[56:59], a[56:59], v[136:139], v[56:59]
  v_mfma_f32_16x16x32_bf16 v[56:59], a[76:79], v[144:147], v[56:59]
  v_mfma_f32_16x16x32_bf16 v[60:63], a[76:79], a[180:183], v[60:63]
  v_mfma_f32_16x16x32_bf16 v[60:63], a[56:59], v[148:151], v[60:63]
  v_mfma_f32_16x16x32_bf16 v[64:67], a[60:63], v[224:227], v[64:67]
  v_mfma_f32_16x16x32_bf16 v[64:67], a[80:83], v[240:243], v[64:67]
  v_mfma_f32_16x16x32_bf16 v[68:71], a[80:83], v[252:255], v[68:71]
  v_mfma_f32_16x16x32_bf16 v[68:71], a[60:63], v[244:247], v[68:71]
  v_mfma_f32_16x16x32_bf16 v[72:75], a[60:63], v[136:139], v[72:75]
  v_mfma_f32_16x16x32_bf16 v[72:75], a[80:83], v[144:147], v[72:75]
  v_mfma_f32_16x16x32_bf16 v[76:79], a[80:83], a[180:183], v[76:79]
  v_mfma_f32_16x16x32_bf16 v[76:79], a[60:63], v[148:151], v[76:79]
  s_waitcnt vmcnt(25)
  v_mfma_f32_16x16x32_bf16 v[0:3], a[84:87], a[184:187], v[0:3]
  v_mfma_f32_16x16x32_bf16 v[0:3], a[104:107], a[212:215], v[0:3]
  v_mfma_f32_16x16x32_bf16 v[4:7], a[104:107], a[216:219], v[4:7]
  v_mfma_f32_16x16x32_bf16 v[4:7], a[84:87], a[232:235], v[4:7]
  v_mfma_f32_16x16x32_bf16 v[8:11], a[84:87], a[236:239], v[8:11]
  v_mfma_f32_16x16x32_bf16 v[8:11], a[104:107], a[220:223], v[8:11]
  v_mfma_f32_16x16x32_bf16 v[12:15], a[104:107], a[224:227], v[12:15]
  v_mfma_f32_16x16x32_bf16 v[12:15], a[84:87], a[240:243], v[12:15]
  v_mfma_f32_16x16x32_bf16 v[16:19], a[88:91], a[184:187], v[16:19]
  v_mfma_f32_16x16x32_bf16 v[16:19], a[108:111], a[212:215], v[16:19]
  v_mfma_f32_16x16x32_bf16 v[20:23], a[108:111], a[216:219], v[20:23]
  v_mfma_f32_16x16x32_bf16 v[20:23], a[88:91], a[232:235], v[20:23]
  v_mfma_f32_16x16x32_bf16 v[24:27], a[88:91], a[236:239], v[24:27]
  v_mfma_f32_16x16x32_bf16 v[24:27], a[108:111], a[220:223], v[24:27]
  v_mfma_f32_16x16x32_bf16 v[28:31], a[108:111], a[224:227], v[28:31]
  v_mfma_f32_16x16x32_bf16 v[28:31], a[88:91], a[240:243], v[28:31]
  v_mfma_f32_16x16x32_bf16 v[32:35], a[92:95], a[184:187], v[32:35]
  v_mfma_f32_16x16x32_bf16 v[32:35], a[112:115], a[212:215], v[32:35]
  v_mfma_f32_16x16x32_bf16 v[36:39], a[112:115], a[216:219], v[36:39]
  v_mfma_f32_16x16x32_bf16 v[36:39], a[92:95], a[232:235], v[36:39]
  v_mfma_f32_16x16x32_bf16 v[40:43], a[92:95], a[236:239], v[40:43]
  v_mfma_f32_16x16x32_bf16 v[40:43], a[112:115], a[220:223], v[40:43]
  v_mfma_f32_16x16x32_bf16 v[44:47], a[112:115], a[224:227], v[44:47]
  v_mfma_f32_16x16x32_bf16 v[44:47], a[92:95], a[240:243], v[44:47]
  v_mfma_f32_16x16x32_bf16 v[48:51], a[96:99], a[184:187], v[48:51]
  v_mfma_f32_16x16x32_bf16 v[48:51], a[116:119], a[212:215], v[48:51]
  v_mfma_f32_16x16x32_bf16 v[52:55], a[116:119], a[216:219], v[52:55]
  v_mfma_f32_16x16x32_bf16 v[52:55], a[96:99], a[232:235], v[52:55]
  v_mfma_f32_16x16x32_bf16 v[56:59], a[96:99], a[236:239], v[56:59]
  v_mfma_f32_16x16x32_bf16 v[56:59], a[116:119], a[220:223], v[56:59]
  v_mfma_f32_16x16x32_bf16 v[60:63], a[116:119], a[224:227], v[60:63]
  v_mfma_f32_16x16x32_bf16 v[60:63], a[96:99], a[240:243], v[60:63]
  v_mfma_f32_16x16x32_bf16 v[64:67], a[100:103], a[184:187], v[64:67]
  ds_read_b128 v[216:219], v122 offset:0
  v_mfma_f32_16x16x32_bf16 v[64:67], a[120:123], a[212:215], v[64:67]
  v_mfma_f32_16x16x32_bf16 v[68:71], a[120:123], a[216:219], v[68:71]
  v_mfma_f32_16x16x32_bf16 v[68:71], a[100:103], a[232:235], v[68:71]
  v_mfma_f32_16x16x32_bf16 v[72:75], a[100:103], a[236:239], v[72:75]
  v_mfma_f32_16x16x32_bf16 v[72:75], a[120:123], a[220:223], v[72:75]
  v_mfma_f32_16x16x32_bf16 v[76:79], a[120:123], a[224:227], v[76:79]
  v_mfma_f32_16x16x32_bf16 v[76:79], a[100:103], a[240:243], v[76:79]
  s_waitcnt vmcnt(17)
  v_mfma_f32_16x16x32_bf16 v[0:3], a[124:127], a[244:247], v[0:3]
  ds_read_b128 v[228:231], v122 offset:1024
  buffer_load_dword v128, v133, s[24:27], 0 offen sc1
  s_xor_b32 s38, s40, 0
  s_lshl_b32 s38, s38, 2
  s_add_u32 s38, s38, s3
  v_mfma_f32_16x16x32_bf16 v[0:3], a[176:179], a[228:231], v[0:3]
  s_lshl_b32 s38, s38, 12
  s_add_u32 s38, s38, 25165824
  v_mfma_f32_16x16x32_bf16 v[4:7], a[176:179], a[196:199], v[4:7]
  v_mfma_f32_16x16x32_bf16 v[4:7], a[124:127], a[248:251], v[4:7]
  v_mfma_f32_16x16x32_bf16 v[8:11], a[124:127], a[200:203], v[8:11]
  v_mfma_f32_16x16x32_bf16 v[8:11], a[176:179], a[208:211], v[8:11]
  v_mfma_f32_16x16x32_bf16 v[12:15], a[176:179], v[188:191], v[12:15]
  v_mfma_f32_16x16x32_bf16 v[12:15], a[124:127], v[184:187], v[12:15]
  s_waitcnt lgkmcnt(1)
  v_mfma_f32_16x16x32_bf16 v[16:19], a[160:163], a[244:247], v[16:19]
  ds_read_b128 v[232:235], v122 offset:2048
  v_mfma_f32_16x16x32_bf16 v[16:19], v[216:219], a[228:231], v[16:19]
  v_mfma_f32_16x16x32_bf16 v[20:23], v[216:219], a[196:199], v[20:23]
  v_mfma_f32_16x16x32_bf16 v[20:23], a[160:163], a[248:251], v[20:23]
  v_mfma_f32_16x16x32_bf16 v[24:27], a[160:163], a[200:203], v[24:27]
  v_mfma_f32_16x16x32_bf16 v[24:27], v[216:219], a[208:211], v[24:27]
  v_mfma_f32_16x16x32_bf16 v[28:31], v[216:219], v[188:191], v[28:31]
  v_mfma_f32_16x16x32_bf16 v[28:31], a[160:163], v[184:187], v[28:31]
  s_waitcnt lgkmcnt(1)
  v_mfma_f32_16x16x32_bf16 v[32:35], a[164:167], a[244:247], v[32:35]
  ds_read_b128 a[192:195], v122 offset:3072
  v_mfma_f32_16x16x32_bf16 v[32:35], v[228:231], a[228:231], v[32:35]
  v_mfma_f32_16x16x32_bf16 v[36:39], v[228:231], a[196:199], v[36:39]
  v_mfma_f32_16x16x32_bf16 v[36:39], a[164:167], a[248:251], v[36:39]
  v_mfma_f32_16x16x32_bf16 v[40:43], a[164:167], a[200:203], v[40:43]
  v_mfma_f32_16x16x32_bf16 v[40:43], v[228:231], a[208:211], v[40:43]
  v_mfma_f32_16x16x32_bf16 v[44:47], v[228:231], v[188:191], v[44:47]
  v_mfma_f32_16x16x32_bf16 v[44:47], a[164:167], v[184:187], v[44:47]
  s_waitcnt lgkmcnt(1)
  v_mfma_f32_16x16x32_bf16 v[48:51], a[168:171], a[244:247], v[48:51]
  ds_read_b128 a[4:7], v122 offset:16384
  ds_read_b128 a[24:27], v122 offset:33792
  v_mfma_f32_16x16x32_bf16 v[48:51], v[232:235], a[228:231], v[48:51]
  v_mfma_f32_16x16x32_bf16 v[52:55], v[232:235], a[196:199], v[52:55]
  v_mfma_f32_16x16x32_bf16 v[52:55], a[168:171], a[248:251], v[52:55]
  v_mfma_f32_16x16x32_bf16 v[56:59], a[168:171], a[200:203], v[56:59]
  v_mfma_f32_16x16x32_bf16 v[56:59], v[232:235], a[208:211], v[56:59]
  v_mfma_f32_16x16x32_bf16 v[60:63], v[232:235], v[188:191], v[60:63]
  v_mfma_f32_16x16x32_bf16 v[60:63], a[168:171], v[184:187], v[60:63]
  s_waitcnt lgkmcnt(2)
  v_mfma_f32_16x16x32_bf16 v[64:67], a[172:175], a[244:247], v[64:67]
  ds_read_b128 a[8:11], v122 offset:17408
  ds_read_b128 a[28:31], v122 offset:34816
  v_mfma_f32_16x16x32_bf16 v[64:67], a[192:195], a[228:231], v[64:67]
  v_mfma_f32_16x16x32_bf16 v[68:71], a[192:195], a[196:199], v[68:71]
  v_mfma_f32_16x16x32_bf16 v[68:71], a[172:175], a[248:251], v[68:71]
  v_mfma_f32_16x16x32_bf16 v[72:75], a[172:175], a[200:203], v[72:75]
  v_mfma_f32_16x16x32_bf16 v[72:75], a[192:195], a[208:211], v[72:75]
  v_mfma_f32_16x16x32_bf16 v[76:79], a[192:195], v[188:191], v[76:79]
  v_mfma_f32_16x16x32_bf16 v[76:79], a[172:175], v[184:187], v[76:79]
  s_waitcnt vmcnt(10) lgkmcnt(2)
  v_mfma_f32_16x16x32_bf16 v[0:3], a[4:7], v[200:203], v[0:3]
  ds_read_b128 a[12:15], v122 offset:18432
  ds_read_b128 a[32:35], v122 offset:35840
  v_mfma_f32_16x16x32_bf16 v[0:3], a[24:27], a[188:191], v[0:3]
  v_mfma_f32_16x16x32_bf16 v[4:7], a[24:27], a[144:147], v[4:7]
  v_mfma_f32_16x16x32_bf16 v[4:7], a[4:7], a[252:255], v[4:7]
  v_mfma_f32_16x16x32_bf16 v[8:11], a[4:7], a[128:131], v[8:11]
  v_mfma_f32_16x16x32_bf16 v[8:11], a[24:27], a[148:151], v[8:11]
  v_mfma_f32_16x16x32_bf16 v[12:15], a[24:27], a[152:155], v[12:15]
  v_mfma_f32_16x16x32_bf16 v[12:15], a[4:7], a[132:135], v[12:15]
  s_waitcnt lgkmcnt(2)
  v_mfma_f32_16x16x32_bf16 v[16:19], a[8:11], v[200:203], v[16:19]
  ds_read_b128 a[16:19], v122 offset:19456
  ds_read_b128 a[36:39], v135 offset:0
  v_mfma_f32_16x16x32_bf16 v[16:19], a[28:31], a[188:191], v[16:19]
  v_mfma_f32_16x16x32_bf16 v[20:23], a[28:31], a[144:147], v[20:23]
  v_mfma_f32_16x16x32_bf16 v[20:23], a[8:11], a[252:255], v[20:23]
  v_mfma_f32_16x16x32_bf16 v[24:27], a[8:11], a[128:131], v[24:27]
  v_mfma_f32_16x16x32_bf16 v[24:27], a[28:31], a[148:151], v[24:27]
  v_mfma_f32_16x16x32_bf16 v[28:31], a[28:31], a[152:155], v[28:31]
  v_mfma_f32_16x16x32_bf16 v[28:31], a[8:11], a[132:135], v[28:31]
  s_waitcnt lgkmcnt(2)
  v_mfma_f32_16x16x32_bf16 v[32:35], a[12:15], v[200:203], v[32:35]
  ds_read_b128 a[20:23], v122 offset:32768
  ds_read_b128 a[40:43], v135 offset:1024
  v_mfma_f32_16x16x32_bf16 v[32:35], a[32:35], a[188:191], v[32:35]
  v_mfma_f32_16x16x32_bf16 v[36:39], a[32:35], a[144:147], v[36:39]
  v_mfma_f32_16x16x32_bf16 v[36:39], a[12:15], a[252:255], v[36:39]
  v_mfma_f32_16x16x32_bf16 v[40:43], a[12:15], a[128:131], v[40:43]
  v_mfma_f32_16x16x32_bf16 v[40:43], a[32:35], a[148:151], v[40:43]
  v_mfma_f32_16x16x32_bf16 v[44:47], a[32:35], a[152:155], v[44:47]
  v_mfma_f32_16x16x32_bf16 v[44:47], a[12:15], a[132:135], v[44:47]
  s_waitcnt lgkmcnt(2)
  v_mfma_f32_16x16x32_bf16 v[48:51], a[16:19], v[200:203], v[48:51]
  ds_read_b128 a[204:207], v135 offset:2048
  ds_read_b128 v[248:251], v135 offset:19456
  v_mfma_f32_16x16x32_bf16 v[48:51], a[36:39], a[188:191], v[48:51]
  v_mfma_f32_16x16x32_bf16 v[52:55], a[36:39], a[144:147], v[52:55]
  v_mfma_f32_16x16x32_bf16 v[52:55], a[16:19], a[252:255], v[52:55]
  v_mfma_f32_16x16x32_bf16 v[56:59], a[16:19], a[128:131], v[56:59]
  v_mfma_f32_16x16x32_bf16 v[56:59], a[36:39], a[148:151], v[56:59]
  v_mfma_f32_16x16x32_bf16 v[60:63], a[36:39], a[152:155], v[60:63]
  v_mfma_f32_16x16x32_bf16 v[60:63], a[16:19], a[132:135], v[60:63]
  s_waitcnt lgkmcnt(2)
  v_mfma_f32_16x16x32_bf16 v[64:67], a[20:23], v[200:203], v[64:67]
  ds_read_b128 v[176:179], v135 offset:3072
  ds_read_b128 v[180:183], v122 offset:49152
  v_mfma_f32_16x16x32_bf16 v[64:67], a[40:43], a[188:191], v[64:67]
  v_mfma_f32_16x16x32_bf16 v[68:71], a[40:43], a[144:147], v[68:71]
  v_mfma_f32_16x16x32_bf16 v[68:71], a[20:23], a[252:255], v[68:71]
  v_mfma_f32_16x16x32_bf16 v[72:75], a[20:23], a[128:131], v[72:75]
  v_mfma_f32_16x16x32_bf16 v[72:75], a[40:43], a[148:151], v[72:75]
  v_mfma_f32_16x16x32_bf16 v[76:79], a[40:43], a[152:155], v[76:79]
  v_mfma_f32_16x16x32_bf16 v[76:79], a[20:23], a[132:135], v[76:79]
  s_waitcnt vmcnt(0)
  v_cmp_lt_u32 vcc, v128, v134
  s_nop 0
  s_cbranch_vccz tail_partner
  s_mov_b32 s35, 32768
tail_spin2:
  s_sleep 2
  buffer_load_dword v128, v133, s[24:27], 0 offen sc1
  s_waitcnt vmcnt(0)
  v_cmp_lt_u32 vcc, v128, v134
  s_nop 0
  s_cbranch_vccz tail_partner
  s_sub_u32 s35, s35, 1
  s_cmp_lg_u32 s35, 0
  s_cbranch_scc1 tail_spin2
tail_partner:
  s_waitcnt lgkmcnt(2)
  v_mfma_f32_16x16x32_bf16 v[0:3], a[204:207], a[136:139], v[0:3]
  ds_read_b128 v[204:207], v135 offset:16384
  ds_read_b128 v[208:211], v122 offset:50176
  v_mfma_f32_16x16x32_bf16 v[0:3], v[248:251], a[156:159], v[0:3]
  buffer_load_dwordx2 v[138:139], v125, s[24:27], s38 offen offset:0 sc1
  v_mfma_f32_16x16x32_bf16 v[4:7], v[248:251], a[0:3], v[4:7]
  buffer_load_dwordx2 v[142:143], v125, s[24:27], s38 offen offset:512 sc1
  v_mfma_f32_16x16x32_bf16 v[4:7], a[204:207], a[140:143], v[4:7]
  buffer_load_dwordx2 v[146:147], v125, s[24:27], s38 offen offset:1024 sc1
  v_mfma_f32_16x16x32_bf16 v[8:11], a[204:207], v[236:239], v[8:11]
  buffer_load_dwordx2 v[150:151], v125, s[24:27], s38 offen offset:1536 sc1
  v_mfma_f32_16x16x32_bf16 v[8:11], v[248:251], v[192:195], v[8:11]
  buffer_load_dwordx2 v[154:155], v125, s[24:27], s38 offen offset:2048 sc1
  v_mfma_f32_16x16x32_bf16 v[12:15], v[248:251], v[212:215], v[12:15]
  v_mfma_f32_16x16x32_bf16 v[12:15], a[204:207], v[196:199], v[12:15]
  s_waitcnt lgkmcnt(2)
  v_mfma_f32_16x16x32_bf16 v[16:19], v[176:179], a[136:139], v[16:19]
  ds_read_b128 v[220:223], v135 offset:17408
  ds_read_b128 a[44:47], v122 offset:51200
  v_mfma_f32_16x16x32_bf16 v[16:19], v[180:183], a[156:159], v[16:19]
  ds_write_b128 v122, v[4:7] offset:0
  ds_write_b128 v122, v[8:11] offset:17408
  v_mfma_f32_16x16x32_bf16 v[20:23], v[180:183], a[0:3], v[20:23]
  ds_write_b128 v122, v[12:15] offset:34816
  v_mfma_f32_16x16x32_bf16 v[20:23], v[176:179], a[140:143], v[20:23]
  v_mfma_f32_16x16x32_bf16 v[24:27], v[176:179], v[236:239], v[24:27]
  v_mfma_f32_16x16x32_bf16 v[24:27], v[180:183], v[192:195], v[24:27]
  v_mfma_f32_16x16x32_bf16 v[28:31], v[180:183], v[212:215], v[28:31]
  v_mfma_f32_16x16x32_bf16 v[28:31], v[176:179], v[196:199], v[28:31]
  s_waitcnt lgkmcnt(5)
  v_mfma_f32_16x16x32_bf16 v[32:35], v[204:207], a[136:139], v[32:35]
  ds_read_b128 a[64:67], v135 offset:18432
  ds_read_b128 a[48:51], v122 offset:52224
  v_mfma_f32_16x16x32_bf16 v[32:35], v[208:211], a[156:159], v[32:35]
  ds_write_b128 v122, v[20:23] offset:1024
  ds_write_b128 v122, v[24:27] offset:18432
  v_mfma_f32_16x16x32_bf16 v[36:39], v[208:211], a[0:3], v[36:39]
  ds_write_b128 v122, v[28:31] offset:35840
  v_mfma_f32_16x16x32_bf16 v[36:39], v[204:207], a[140:143], v[36:39]
  v_mfma_f32_16x16x32_bf16 v[40:43], v[204:207], v[236:239], v[40:43]
  v_mfma_f32_16x16x32_bf16 v[40:43], v[208:211], v[192:195], v[40:43]
  v_mfma_f32_16x16x32_bf16 v[44:47], v[208:211], v[212:215], v[44:47]
  v_mfma_f32_16x16x32_bf16 v[44:47], v[204:207], v[196:199], v[44:47]
  s_waitcnt lgkmcnt(8)
  v_mfma_f32_16x16x32_bf16 v[48:51], v[220:223], a[136:139], v[48:51]
  v_mfma_f32_16x16x32_bf16 v[48:51], a[44:47], a[156:159], v[48:51]
  v_mfma_f32_16x16x32_bf16 v[52:55], a[44:47], a[0:3], v[52:55]
  ds_write_b128 v122, v[36:39] offset:2048
  v_mfma_f32_16x16x32_bf16 v[52:55], v[220:223], a[140:143], v[52:55]
  ds_write_b128 v122, v[40:43] offset:19456
  v_mfma_f32_16x16x32_bf16 v[56:59], v[220:223], v[236:239], v[56:59]
  ds_write_b128 v122, v[44:47] offset:49152
  v_mfma_f32_16x16x32_bf16 v[56:59], a[44:47], v[192:195], v[56:59]
  v_mfma_f32_16x16x32_bf16 v[60:63], a[44:47], v[212:215], v[60:63]
  v_mfma_f32_16x16x32_bf16 v[60:63], v[220:223], v[196:199], v[60:63]
  s_waitcnt lgkmcnt(6)
  v_mfma_f32_16x16x32_bf16 v[64:67], a[64:67], a[136:139], v[64:67]
  ds_write_b128 v122, v[52:55] offset:3072
  v_mfma_f32_16x16x32_bf16 v[64:67], a[48:51], a[156:159], v[64:67]
  v_mfma_f32_16x16x32_bf16 v[68:71], a[48:51], a[0:3], v[68:71]
  v_mfma_f32_16x16x32_bf16 v[68:71], a[64:67], a[140:143], v[68:71]
  ds_write_b128 v122, v[56:59] offset:32768
  v_mfma_f32_16x16x32_bf16 v[72:75], a[64:67], v[236:239], v[72:75]
  ds_write_b128 v122, v[60:63] offset:50176
  v_mfma_f32_16x16x32_bf16 v[72:75], a[48:51], v[192:195], v[72:75]
  v_mfma_f32_16x16x32_bf16 v[76:79], a[48:51], v[212:215], v[76:79]
  v_mfma_f32_16x16x32_bf16 v[76:79], a[64:67], v[196:199], v[76:79]
  s_nop 1
  ds_write_b128 v122, v[68:71] offset:16384
  s_nop 2
  ds_write_b128 v122, v[72:75] offset:33792
  s_nop 0
  ds_write_b128 v122, v[76:79] offset:51200
  s_waitcnt vmcnt(4)
  v_lshlrev_b32 v136, 16, v138
  v_and_b32 v137, s34, v138
  v_lshlrev_b32 v138, 16, v139
  v_and_b32 v139, s34, v139
  v_pk_add_f32 v[0:1], v[0:1], v[136:137]
  v_pk_add_f32 v[2:3], v[2:3], v[138:139]
  s_waitcnt vmcnt(3)
  v_lshlrev_b32 v140, 16, v142
  v_and_b32 v141, s34, v142
  v_lshlrev_b32 v142, 16, v143
  v_and_b32 v143, s34, v143
  v_pk_add_f32 v[16:17], v[16:17], v[140:141]
  v_pk_add_f32 v[18:19], v[18:19], v[142:143]
  s_waitcnt vmcnt(2)
  v_lshlrev_b32 v144, 16, v146
  v_and_b32 v145, s34, v146
  v_lshlrev_b32 v146, 16, v147
  v_and_b32 v147, s34, v147
  v_pk_add_f32 v[32:33], v[32:33], v[144:145]
  v_pk_add_f32 v[34:35], v[34:35], v[146:147]
  s_waitcnt vmcnt(1)
  v_lshlrev_b32 v148, 16, v150
  v_and_b32 v149, s34, v150
  v_lshlrev_b32 v150, 16, v151
  v_and_b32 v151, s34, v151
  v_pk_add_f32 v[48:49], v[48:49], v[148:149]
  v_pk_add_f32 v[50:51], v[50:51], v[150:151]
  s_waitcnt vmcnt(0)
  v_lshlrev_b32 v152, 16, v154
  v_and_b32 v153, s34, v154
  v_lshlrev_b32 v154, 16, v155
  v_and_b32 v155, s34, v155
  v_pk_add_f32 v[64:65], v[64:65], v[152:153]
  v_pk_add_f32 v[66:67], v[66:67], v[154:155]
  s_waitcnt lgkmcnt(0)
  s_barrier
  ds_read_b128 v[4:7], v80 offset:0
  ds_read_b128 v[8:11], v81 offset:17408
  ds_read_b128 v[12:15], v82 offset:34816
  ds_read_b128 v[20:23], v80 offset:1024
  ds_read_b128 v[24:27], v81 offset:18432
  ds_read_b128 v[28:31], v82 offset:35840
  ds_read_b128 v[36:39], v80 offset:2048
  ds_read_b128 v[40:43], v81 offset:19456
  ds_read_b128 v[44:47], v82 offset:49152
  ds_read_b128 v[52:55], v80 offset:3072
  ds_read_b128 v[56:59], v81 offset:32768
  ds_read_b128 v[60:63], v82 offset:50176
  ds_read_b128 v[68:71], v80 offset:16384
  ds_read_b128 v[72:75], v81 offset:33792
  ds_read_b128 v[76:79], v82 offset:51200
  s_waitcnt lgkmcnt(13)
  v_pk_add_f32 v[4:5], v[4:5], v[8:9]
  v_pk_add_f32 v[6:7], v[6:7], v[10:11]
  s_waitcnt lgkmcnt(12)
  v_pk_add_f32 v[0:1], v[0:1], v[12:13]
  v_pk_add_f32 v[2:3], v[2:3], v[14:15]
  v_pk_add_f32 v[0:1], v[0:1], v[4:5]
  v_pk_add_f32 v[2:3], v[2:3], v[6:7]
  v_cvt_pk_bf16_f32 v4, v0, v1
  v_cvt_pk_bf16_f32 v5, v2, v3
  v_lshlrev_b32 v0, 16, v4
  v_and_b32 v1, s34, v4
  v_lshlrev_b32 v2, 16, v5
  v_and_b32 v3, s34, v5
  v_pk_mul_f32 v[0:1], v[0:1], v[90:91]
  v_pk_mul_f32 v[2:3], v[2:3], v[92:93]
  v_cvt_pk_bf16_f32 v4, v0, v1
  v_cvt_pk_bf16_f32 v5, v2, v3
  v_lshlrev_b32 v0, 16, v4
  v_and_b32 v1, s34, v4
  v_lshlrev_b32 v2, 16, v5
  v_and_b32 v3, s34, v5
  v_pk_add_f32 v[0:1], v[0:1], v[156:157]
  v_pk_add_f32 v[2:3], v[2:3], v[158:159]
  v_cvt_pk_bf16_f32 v4, v0, v1
  v_cvt_pk_bf16_f32 v5, v2, v3
  s_waitcnt lgkmcnt(10)
  v_pk_add_f32 v[20:21], v[20:21], v[24:25]
  v_pk_add_f32 v[22:23], v[22:23], v[26:27]
  s_waitcnt lgkmcnt(9)
  v_pk_add_f32 v[16:17], v[16:17], v[28:29]
  v_pk_add_f32 v[18:19], v[18:19], v[30:31]
  v_pk_add_f32 v[16:17], v[16:17], v[20:21]
  v_pk_add_f32 v[18:19], v[18:19], v[22:23]
  v_cvt_pk_bf16_f32 v20, v16, v17
  v_cvt_pk_bf16_f32 v21, v18, v19
  v_lshlrev_b32 v16, 16, v20
  v_and_b32 v17, s34, v20
  v_lshlrev_b32 v18, 16, v21
  v_and_b32 v19, s34, v21
  v_pk_mul_f32 v[16:17], v[16:17], v[94:95]
  v_pk_mul_f32 v[18:19], v[18:19], v[96:97]
  v_cvt_pk_bf16_f32 v20, v16, v17
  v_cvt_pk_bf16_f32 v21, v18, v19
  v_lshlrev_b32 v16, 16, v20
  v_and_b32 v17, s34, v20
  v_lshlrev_b32 v18, 16, v21
  v_and_b32 v19, s34, v21
  v_pk_add_f32 v[16:17], v[16:17], v[160:161]
  v_pk_add_f32 v[18:19], v[18:19], v[162:163]
  v_cvt_pk_bf16_f32 v6, v16, v17
  v_cvt_pk_bf16_f32 v7, v18, v19
  s_nop 0
  v_permlane16_swap_b32 v4, v6
  v_permlane16_swap_b32 v5, v7
  buffer_store_dwordx4 v[4:7], v83, s[16:19], 0 offen offset:0
  s_waitcnt lgkmcnt(7)
  v_pk_add_f32 v[36:37], v[36:37], v[40:41]
  v_pk_add_f32 v[38:39], v[38:39], v[42:43]
  s_waitcnt lgkmcnt(6)
  v_pk_add_f32 v[32:33], v[32:33], v[44:45]
  v_pk_add_f32 v[34:35], v[34:35], v[46:47]
  v_pk_add_f32 v[32:33], v[32:33], v[36:37]
  v_pk_add_f32 v[34:35], v[34:35], v[38:39]
  v_cvt_pk_bf16_f32 v36, v32, v33
  v_cvt_pk_bf16_f32 v37, v34, v35
  v_lshlrev_b32 v32, 16, v36
  v_and_b32 v33, s34, v36
  v_lshlrev_b32 v34, 16, v37
  v_and_b32 v35, s34, v37
  v_pk_mul_f32 v[32:33], v[32:33], v[98:99]
  v_pk_mul_f32 v[34:35], v[34:35], v[100:101]
  v_cvt_pk_bf16_f32 v36, v32, v33
  v_cvt_pk_bf16_f32 v37, v34, v35
  v_lshlrev_b32 v32, 16, v36
  v_and_b32 v33, s34, v36
  v_lshlrev_b32 v34, 16, v37
  v_and_b32 v35, s34, v37
  v_pk_add_f32 v[32:33], v[32:33], v[164:165]
  v_pk_add_f32 v[34:35], v[34:35], v[166:167]
  v_cvt_pk_bf16_f32 v36, v32, v33
  v_cvt_pk_bf16_f32 v37, v34, v35
  s_waitcnt lgkmcnt(4)
  v_pk_add_f32 v[52:53], v[52:53], v[56:57]
  v_pk_add_f32 v[54:55], v[54:55], v[58:59]
  s_waitcnt lgkmcnt(3)
  v_pk_add_f32 v[48:49], v[48:49], v[60:61]
  v_pk_add_f32 v[50:51], v[50:51], v[62:63]
  v_pk_add_f32 v[48:49], v[48:49], v[52:53]
  v_pk_add_f32 v[50:51], v[50:51], v[54:55]
  v_cvt_pk_bf16_f32 v52, v48, v49
  v_cvt_pk_bf16_f32 v53, v50, v51
  v_lshlrev_b32 v48, 16, v52
  v_and_b32 v49, s34, v52
  v_lshlrev_b32 v50, 16, v53
  v_and_b32 v51, s34, v53
  v_pk_mul_f32 v[48:49], v[48:49], v[102:103]
  v_pk_mul_f32 v[50:51], v[50:51], v[104:105]
  v_cvt_pk_bf16_f32 v52, v48, v49
  v_cvt_pk_bf16_f32 v53, v50, v51
  v_lshlrev_b32 v48, 16, v52
  v_and_b32 v49, s34, v52
  v_lshlrev_b32 v50, 16, v53
  v_and_b32 v51, s34, v53
  v_pk_add_f32 v[48:49], v[48:49], v[168:169]
  v_pk_add_f32 v[50:51], v[50:51], v[170:171]
  v_cvt_pk_bf16_f32 v38, v48, v49
  v_cvt_pk_bf16_f32 v39, v50, v51
  s_nop 0
  v_permlane16_swap_b32 v36, v38
  v_permlane16_swap_b32 v37, v39
  buffer_store_dwordx4 v[36:39], v83, s[16:19], 0 offen offset:64
  s_waitcnt lgkmcnt(1)
  v_pk_add_f32 v[68:69], v[68:69], v[72:73]
  v_pk_add_f32 v[70:71], v[70:71], v[74:75]
  s_waitcnt lgkmcnt(0)
  v_pk_add_f32 v[64:65], v[64:65], v[76:77]
  v_pk_add_f32 v[66:67], v[66:67], v[78:79]
  v_pk_add_f32 v[64:65], v[64:65], v[68:69]
  v_pk_add_f32 v[66:67], v[66:67], v[70:71]
  v_cvt_pk_bf16_f32 v68, v64, v65
  v_cvt_pk_bf16_f32 v69, v66, v67
  v_lshlrev_b32 v64, 16, v68
  v_and_b32 v65, s34, v68
  v_lshlrev_b32 v66, 16, v69
  v_and_b32 v67, s34, v69
  v_pk_mul_f32 v[64:65], v[64:65], v[106:107]
  v_pk_mul_f32 v[66:67], v[66:67], v[108:109]
  v_cvt_pk_bf16_f32 v68, v64, v65
  v_cvt_pk_bf16_f32 v69, v66, v67
  v_lshlrev_b32 v64, 16, v68
  v_and_b32 v65, s34, v68
  v_lshlrev_b32 v66, 16, v69
  v_and_b32 v67, s34, v69
  v_pk_add_f32 v[64:65], v[64:65], v[172:173]
  v_pk_add_f32 v[66:67], v[66:67], v[174:175]
  v_cvt_pk_bf16_f32 v68, v64, v65
  v_cvt_pk_bf16_f32 v69, v66, v67
  buffer_store_dwordx2 v[68:69], v117, s[16:19], 0 offen offset:128
attn_end:
  s_endpgm
attn_redo:
  s_waitcnt vmcnt(0)
  v_accvgpr_write_b32 a0, 0
  v_accvgpr_write_b32 a1, 0
  v_accvgpr_write_b32 a2, 0
  v_accvgpr_write_b32 a3, 0
  v_accvgpr_write_b32 a4, 0
  v_accvgpr_write_b32 a5, 0
  v_accvgpr_write_b32 a6, 0
  v_accvgpr_write_b32 a7, 0
  v_accvgpr_write_b32 a8, 0
  v_accvgpr_write_b32 a9, 0
  v_accvgpr_write_b32 a10, 0
  v_accvgpr_write_b32 a11, 0
  v_accvgpr_write_b32 a12, 0
  v_accvgpr_write_b32 a13, 0
  v_accvgpr_write_b32 a14, 0
  v_accvgpr_write_b32 a15, 0
  v_accvgpr_write_b32 a16, 0
  v_accvgpr_write_b32 a17, 0
  v_accvgpr_write_b32 a18, 0
  v_accvgpr_write_b32 a19, 0
  v_accvgpr_write_b32 a20, 0
  v_accvgpr_write_b32 a21, 0
  v_accvgpr_write_b32 a22, 0
  v_accvgpr_write_b32 a23, 0
  v_accvgpr_write_b32 a24, 0
  v_accvgpr_write_b32 a25, 0
  v_accvgpr_write_b32 a26, 0
  v_accvgpr_write_b32 a27, 0
  v_accvgpr_write_b32 a28, 0
  v_accvgpr_write_b32 a29, 0
  v_accvgpr_write_b32 a30, 0
  v_accvgpr_write_b32 a31, 0
  v_accvgpr_write_b32 a32, 0
  v_accvgpr_write_b32 a33, 0
  v_accvgpr_write_b32 a34, 0
  v_accvgpr_write_b32 a35, 0
  v_accvgpr_write_b32 a36, 0
  v_accvgpr_write_b32 a37, 0
  v_accvgpr_write_b32 a38, 0
  v_accvgpr_write_b32 a39, 0
  v_accvgpr_write_b32 a40, 0
  v_accvgpr_write_b32 a41, 0
  v_accvgpr_write_b32 a42, 0
  v_accvgpr_write_b32 a43, 0
  v_accvgpr_write_b32 a44, 0
  v_accvgpr_write_b32 a45, 0
  v_accvgpr_write_b32 a46, 0
  v_accvgpr_write_b32 a47, 0
  v_accvgpr_write_b32 a48, 0
  v_accvgpr_write_b32 a49, 0
  v_accvgpr_write_b32 a50, 0
  v_accvgpr_write_b32 a51, 0
  v_accvgpr_write_b32 a52, 0
  v_accvgpr_write_b32 a53, 0
  v_accvgpr_write_b32 a54, 0
  v_accvgpr_write_b32 a55, 0
  v_accvgpr_write_b32 a56, 0
  v_accvgpr_write_b32 a57, 0
  v_accvgpr_write_b32 a58, 0
  v_accvgpr_write_b32 a59, 0
  v_accvgpr_write_b32 a60, 0
  v_accvgpr_write_b32 a61, 0
  v_accvgpr_write_b32 a62, 0
  v_accvgpr_write_b32 a63, 0
  v_accvgpr_write_b32 a64, 0
  v_accvgpr_write_b32 a65, 0
  v_accvgpr_write_b32 a66, 0
  v_accvgpr_write_b32 a67, 0
  v_accvgpr_write_b32 a68, 0
  v_accvgpr_write_b32 a69, 0
  v_accvgpr_write_b32 a70, 0
  v_accvgpr_write_b32 a71, 0
  v_accvgpr_write_b32 a72, 0
  v_accvgpr_write_b32 a73, 0
  v_accvgpr_write_b32 a74, 0
  v_accvgpr_write_b32 a75, 0
  v_accvgpr_write_b32 a76, 0
  v_accvgpr_write_b32 a77, 0
  v_accvgpr_write_b32 a78, 0
  v_accvgpr_write_b32 a79, 0
  v_accvgpr_write_b32 a80, 0
  v_accvgpr_write_b32 a81, 0
  v_accvgpr_write_b32 a82, 0
  v_accvgpr_write_b32 a83, 0
  v_accvgpr_write_b32 a84, 0
  v_accvgpr_write_b32 a85, 0
  v_accvgpr_write_b32 a86, 0
  v_accvgpr_write_b32 a87, 0
  v_accvgpr_write_b32 a88, 0
  v_accvgpr_write_b32 a89, 0
  v_accvgpr_write_b32 a90, 0
  v_accvgpr_write_b32 a91, 0
  v_accvgpr_write_b32 a92, 0
  v_accvgpr_write_b32 a93, 0
  v_accvgpr_write_b32 a94, 0
  v_accvgpr_write_b32 a95, 0
  v_accvgpr_write_b32 a96, 0
  v_accvgpr_write_b32 a97, 0
  v_accvgpr_write_b32 a98, 0
  v_accvgpr_write_b32 a99, 0
  v_accvgpr_write_b32 a100, 0
  v_accvgpr_write_b32 a101, 0
  v_accvgpr_write_b32 a102, 0
  v_accvgpr_write_b32 a103, 0
  v_accvgpr_write_b32 a104, 0
  v_accvgpr_write_b32 a105, 0
  v_accvgpr_write_b32 a106, 0
  v_accvgpr_write_b32 a107, 0
  v_accvgpr_write_b32 a108, 0
  v_accvgpr_write_b32 a109, 0
  v_accvgpr_write_b32 a110, 0
  v_accvgpr_write_b32 a111, 0
  v_accvgpr_write_b32 a112, 0
  v_accvgpr_write_b32 a113, 0
  v_accvgpr_write_b32 a114, 0
  v_accvgpr_write_b32 a115, 0
  v_accvgpr_write_b32 a116, 0
  v_accvgpr_write_b32 a117, 0
  v_accvgpr_write_b32 a118, 0
  v_accvgpr_write_b32 a119, 0
  v_accvgpr_write_b32 a120, 0
  v_accvgpr_write_b32 a121, 0
  v_accvgpr_write_b32 a122, 0
  v_accvgpr_write_b32 a123, 0
  v_accvgpr_write_b32 a124, 0
  v_accvgpr_write_b32 a125, 0
  v_accvgpr_write_b32 a126, 0
  v_accvgpr_write_b32 a127, 0
  v_mov_b32 v208, 0
  v_mov_b32 v249, 0xff800000
  v_mov_b32 v209, 0
  v_mov_b32 v250, 0xff800000
  v_mov_b32 v210, 0
  v_mov_b32 v251, 0xff800000
  v_mov_b32 v211, 0
  v_mov_b32 v252, 0xff800000
  s_mov_b32 s29, 0
attn_slow:
  s_barrier
  s_add_u32 m0, s28, 49152
  s_nop 0
  buffer_load_dwordx4 v232, s[12:15], s29 offen offset:0 lds
  buffer_load_dwordx4 v233, s[12:15], s29 offen offset:1024 lds
  buffer_load_dwordx4 v234, s[12:15], s29 offen offset:2048 lds
  buffer_load_dwordx4 v235, s[12:15], s29 offen offset:3072 lds
  s_add_u32 m0, s28, 114688
  s_nop 0
  buffer_load_dwordx4 v236, s[16:19], s29 offen offset:0 lds
  buffer_load_dwordx4 v237, s[16:19], s29 offen offset:1024 lds
  buffer_load_dwordx4 v236, s[16:19], s29 offen offset:2048 lds
  buffer_load_dwordx4 v237, s[16:19], s29 offen offset:3072 lds
  s_waitcnt vmcnt(0)
  s_barrier
  ds_read_b128 a[128:131], v212 offset:49152
  ds_read_b128 a[132:135], v213 offset:49152
  ds_read_b128 a[136:139], v214 offset:49152
  ds_read_b128 a[140:143], v215 offset:49152
  s_waitcnt lgkmcnt(3)
  v_mfma_f32_16x16x32_bf16 v[0:3], a[128:131], v[128:131], 0
  s_waitcnt lgkmcnt(2)
  v_mfma_f32_16x16x32_bf16 v[0:3], a[132:135], v[132:135], v[0:3]
  s_waitcnt lgkmcnt(1)
  v_mfma_f32_16x16x32_bf16 v[0:3], a[136:139], v[136:139], v[0:3]
  s_waitcnt lgkmcnt(0)
  v_mfma_f32_16x16x32_bf16 v[0:3], a[140:143], v[140:143], v[0:3]
  v_mfma_f32_16x16x32_bf16 v[8:11], a[140:143], v[156:159], 0
  v_mfma_f32_16x16x32_bf16 v[8:11], a[136:139], v[152:155], v[8:11]
  v_mfma_f32_16x16x32_bf16 v[8:11], a[132:135], v[148:151], v[8:11]
  v_mfma_f32_16x16x32_bf16 v[8:11], a[128:131], v[144:147], v[8:11]
  v_mfma_f32_16x16x32_bf16 v[16:19], a[128:131], v[160:163], 0
  v_mfma_f32_16x16x32_bf16 v[16:19], a[132:135], v[164:167], v[16:19]
  v_mfma_f32_16x16x32_bf16 v[16:19], a[136:139], v[168:171], v[16:19]
  v_mfma_f32_16x16x32_bf16 v[16:19], a[140:143], v[172:175], v[16:19]
  v_mfma_f32_16x16x32_bf16 v[24:27], a[140:143], v[188:191], 0
  v_mfma_f32_16x16x32_bf16 v[24:27], a[136:139], v[184:187], v[24:27]
  v_mfma_f32_16x16x32_bf16 v[24:27], a[132:135], v[180:183], v[24:27]
  v_mfma_f32_16x16x32_bf16 v[24:27], a[128:131], v[176:179], v[24:27]
  ds_read_b128 a[144:147], v212 offset:53248
  ds_read_b128 a[148:151], v213 offset:53248
  ds_read_b128 a[152:155], v214 offset:53248
  ds_read_b128 a[156:159], v215 offset:53248
  s_waitcnt lgkmcnt(3)
  v_mfma_f32_16x16x32_bf16 v[4:7], a[144:147], v[128:131], 0
  s_waitcnt lgkmcnt(2)
  v_mfma_f32_16x16x32_bf16 v[4:7], a[148:151], v[132:135], v[4:7]
  s_waitcnt lgkmcnt(1)
  v_mfma_f32_16x16x32_bf16 v[4:7], a[152:155], v[136:139], v[4:7]
  s_waitcnt lgkmcnt(0)
  v_mfma_f32_16x16x32_bf16 v[4:7], a[156:159], v[140:143], v[4:7]
  v_mfma_f32_16x16x32_bf16 v[12:15], a[156:159], v[156:159], 0
  v_mfma_f32_16x16x32_bf16 v[12:15], a[152:155], v[152:155], v[12:15]
  v_mfma_f32_16x16x32_bf16 v[12:15], a[148:151], v[148:151], v[12:15]
  v_mfma_f32_16x16x32_bf16 v[12:15], a[144:147], v[144:147], v[12:15]
  v_mfma_f32_16x16x32_bf16 v[20:23], a[144:147], v[160:163], 0
  v_mfma_f32_16x16x32_bf16 v[20:23], a[148:151], v[164:167], v[20:23]
  v_mfma_f32_16x16x32_bf16 v[20:23], a[152:155], v[168:171], v[20:23]
  v_mfma_f32_16x16x32_bf16 v[20:23], a[156:159], v[172:175], v[20:23]
  v_mfma_f32_16x16x32_bf16 v[28:31], a[156:159], v[188:191], 0
  v_mfma_f32_16x16x32_bf16 v[28:31], a[152:155], v[184:187], v[28:31]
  v_mfma_f32_16x16x32_bf16 v[28:31], a[148:151], v[180:183], v[28:31]
  v_mfma_f32_16x16x32_bf16 v[28:31], a[144:147], v[176:179], v[28:31]
  ds_read_b128 a[128:131], v212 offset:57344
  ds_read_b128 a[132:135], v213 offset:57344
  ds_read_b128 a[136:139], v214 offset:57344
  ds_read_b128 a[140:143], v215 offset:57344
  s_waitcnt lgkmcnt(3)
  v_mfma_f32_16x16x32_bf16 v[32:35], a[128:131], v[128:131], 0
  s_waitcnt lgkmcnt(2)
  v_mfma_f32_16x16x32_bf16 v[32:35], a[132:135], v[132:135], v[32:35]
  s_waitcnt lgkmcnt(1)
  v_mfma_f32_16x16x32_bf16 v[32:35], a[136:139], v[136:139], v[32:35]
  s_waitcnt lgkmcnt(0)
  v_mfma_f32_16x16x32_bf16 v[32:35], a[140:143], v[140:143], v[32:35]
  v_mfma_f32_16x16x32_bf16 v[40:43], a[140:143], v[156:159], 0
  v_mfma_f32_16x16x32_bf16 v[40:43], a[136:139], v[152:155], v[40:43]
  v_mfma_f32_16x16x32_bf16 v[40:43], a[132:135], v[148:151], v[40:43]
  v_mfma_f32_16x16x32_bf16 v[40:43], a[128:131], v[144:147], v[40:43]
  v_mfma_f32_16x16x32_bf16 v[48:51], a[128:131], v[160:163], 0
  v_mfma_f32_16x16x32_bf16 v[48:51], a[132:135], v[164:167], v[48:51]
  v_mfma_f32_16x16x32_bf16 v[48:51], a[136:139], v[168:171], v[48:51]
  v_mfma_f32_16x16x32_bf16 v[48:51], a[140:143], v[172:175], v[48:51]
  v_mfma_f32_16x16x32_bf16 v[56:59], a[140:143], v[188:191], 0
  v_mfma_f32_16x16x32_bf16 v[56:59], a[136:139], v[184:187], v[56:59]
  v_mfma_f32_16x16x32_bf16 v[56:59], a[132:135], v[180:183], v[56:59]
  v_mfma_f32_16x16x32_bf16 v[56:59], a[128:131], v[176:179], v[56:59]
  ds_read_b128 a[144:147], v212 offset:61440
  ds_read_b128 a[148:151], v213 offset:61440
  ds_read_b128 a[152:155], v214 offset:61440
  ds_read_b128 a[156:159], v215 offset:61440
  s_waitcnt lgkmcnt(3)
  v_mfma_f32_16x16x32_bf16 v[36:39], a[144:147], v[128:131], 0
  s_waitcnt lgkmcnt(2)
  v_mfma_f32_16x16x32_bf16 v[36:39], a[148:151], v[132:135], v[36:39]
  s_waitcnt lgkmcnt(1)
  v_mfma_f32_16x16x32_bf16 v[36:39], a[152:155], v[136:139], v[36:39]
  s_waitcnt lgkmcnt(0)
  v_mfma_f32_16x16x32_bf16 v[36:39], a[156:159], v[140:143], v[36:39]
  v_mfma_f32_16x16x32_bf16 v[44:47], a[156:159], v[156:159], 0
  v_mfma_f32_16x16x32_bf16 v[44:47], a[152:155], v[152:155], v[44:47]
  v_mfma_f32_16x16x32_bf16 v[44:47], a[148:151], v[148:151], v[44:47]
  v_mfma_f32_16x16x32_bf16 v[44:47], a[144:147], v[144:147], v[44:47]
  v_mfma_f32_16x16x32_bf16 v[52:55], a[144:147], v[160:163], 0
  v_mfma_f32_16x16x32_bf16 v[52:55], a[148:151], v[164:167], v[52:55]
  v_mfma_f32_16x16x32_bf16 v[52:55], a[152:155], v[168:171], v[52:55]
  v_mfma_f32_16x16x32_bf16 v[52:55], a[156:159], v[172:175], v[52:55]
  v_mfma_f32_16x16x32_bf16 v[60:63], a[156:159], v[188:191], 0
  v_mfma_f32_16x16x32_bf16 v[60:63], a[152:155], v[184:187], v[60:63]
  v_mfma_f32_16x16x32_bf16 v[60:63], a[148:151], v[180:183], v[60:63]
  v_mfma_f32_16x16x32_bf16 v[60:63], a[144:147], v[176:179], v[60:63]
  v_mov_b32 v192, v249
  v_max3_f32 v192, v192, v0, v1
  v_max3_f32 v192, v192, v2, v3
  v_max3_f32 v192, v192, v4, v5
  v_max3_f32 v192, v192, v6, v7
  v_max3_f32 v192, v192, v32, v33
  v_max3_f32 v192, v192, v34, v35
  v_max3_f32 v192, v192, v36, v37
  v_max3_f32 v192, v192, v38, v39
  v_mov_b32 v245, v192
  s_nop 1
  v_permlane16_swap_b32 v192, v245
  v_max_f32 v192, v192, v245
  v_mov_b32 v245, v192
  s_nop 1
  v_permlane32_swap_b32 v192, v245
  v_max_f32 v192, v192, v245
  v_sub_f32 v193, v249, v192
  v_exp_f32 v193, v193
  v_mov_b32 v249, v192
  v_mul_f32 v208, v208, v193
  v_sub_f32 v0, v0, v192
  v_sub_f32 v1, v1, v192
  v_sub_f32 v2, v2, v192
  v_sub_f32 v3, v3, v192
  v_sub_f32 v4, v4, v192
  v_sub_f32 v5, v5, v192
  v_sub_f32 v6, v6, v192
  v_sub_f32 v7, v7, v192
  v_sub_f32 v32, v32, v192
  v_sub_f32 v33, v33, v192
  v_sub_f32 v34, v34, v192
  v_sub_f32 v35, v35, v192
  v_sub_f32 v36, v36, v192
  v_sub_f32 v37, v37, v192
  v_sub_f32 v38, v38, v192
  v_sub_f32 v39, v39, v192
  v_exp_f32 v0, v0
  v_exp_f32 v1, v1
  v_add_f32 v208, v208, v0
  v_exp_f32 v2, v2
  v_add_f32 v208, v208, v1
  v_cvt_pk_bf16_f32 v0, v0, v1
  v_exp_f32 v3, v3
  v_add_f32 v208, v208, v2
  v_add_f32 v208, v208, v3
  v_cvt_pk_bf16_f32 v1, v2, v3
  v_exp_f32 v4, v4
  v_exp_f32 v5, v5
  v_add_f32 v208, v208, v4
  v_exp_f32 v6, v6
  v_add_f32 v208, v208, v5
  v_cvt_pk_bf16_f32 v2, v4, v5
  v_exp_f32 v7, v7
  v_add_f32 v208, v208, v6
  v_add_f32 v208, v208, v7
  v_cvt_pk_bf16_f32 v3, v6, v7
  v_exp_f32 v32, v32
  v_exp_f32 v33, v33
  v_add_f32 v208, v208, v32
  v_exp_f32 v34, v34
  v_add_f32 v208, v208, v33
  v_cvt_pk_bf16_f32 v32, v32, v33
  v_exp_f32 v35, v35
  v_add_f32 v208, v208, v34
  v_add_f32 v208, v208, v35
  v_cvt_pk_bf16_f32 v33, v34, v35
  v_exp_f32 v36, v36
  v_exp_f32 v37, v37
  v_add_f32 v208, v208, v36
  v_exp_f32 v38, v38
  v_add_f32 v208, v208, v37
  v_cvt_pk_bf16_f32 v34, v36, v37
  v_exp_f32 v39, v39
  v_add_f32 v208, v208, v38
  v_add_f32 v208, v208, v39
  v_cvt_pk_bf16_f32 v35, v38, v39
  v_accvgpr_read_b32 v64, a0
  v_accvgpr_read_b32 v65, a1
  v_accvgpr_read_b32 v66, a2
  v_accvgpr_read_b32 v67, a3
  v_mul_f32 v64, v64, v193
  v_mul_f32 v65, v65, v193
  v_mul_f32 v66, v66, v193
  v_mul_f32 v67, v67, v193
  v_accvgpr_write_b32 a0, v64
  v_accvgpr_write_b32 a1, v65
  v_accvgpr_write_b32 a2, v66
  v_accvgpr_write_b32 a3, v67
  v_accvgpr_read_b32 v64, a16
  v_accvgpr_read_b32 v65, a17
  v_accvgpr_read_b32 v66, a18
  v_accvgpr_read_b32 v67, a19
  v_mul_f32 v64, v64, v193
  v_mul_f32 v65, v65, v193
  v_mul_f32 v66, v66, v193
  v_mul_f32 v67, v67, v193
  v_accvgpr_write_b32 a16, v64
  v_accvgpr_write_b32 a17, v65
  v_accvgpr_write_b32 a18, v66
  v_accvgpr_write_b32 a19, v67
  v_accvgpr_read_b32 v64, a32
  v_accvgpr_read_b32 v65, a33
  v_accvgpr_read_b32 v66, a34
  v_accvgpr_read_b32 v67, a35
  v_mul_f32 v64, v64, v193
  v_mul_f32 v65, v65, v193
  v_mul_f32 v66, v66, v193
  v_mul_f32 v67, v67, v193
  v_accvgpr_write_b32 a32, v64
  v_accvgpr_write_b32 a33, v65
  v_accvgpr_write_b32 a34, v66
  v_accvgpr_write_b32 a35, v67
  v_accvgpr_read_b32 v64, a48
  v_accvgpr_read_b32 v65, a49
  v_accvgpr_read_b32 v66, a50
  v_accvgpr_read_b32 v67, a51
  v_mul_f32 v64, v64, v193
  v_mul_f32 v65, v65, v193
  v_mul_f32 v66, v66, v193
  v_mul_f32 v67, v67, v193
  v_accvgpr_write_b32 a48, v64
  v_accvgpr_write_b32 a49, v65
  v_accvgpr_write_b32 a50, v66
  v_accvgpr_write_b32 a51, v67
  v_accvgpr_read_b32 v64, a64
  v_accvgpr_read_b32 v65, a65
  v_accvgpr_read_b32 v66, a66
  v_accvgpr_read_b32 v67, a67
  v_mul_f32 v64, v64, v193
  v_mul_f32 v65, v65, v193
  v_mul_f32 v66, v66, v193
  v_mul_f32 v67, v67, v193
  v_accvgpr_write_b32 a64, v64
  v_accvgpr_write_b32 a65, v65
  v_accvgpr_write_b32 a66, v66
  v_accvgpr_write_b32 a67, v67
  v_accvgpr_read_b32 v64, a80
  v_accvgpr_read_b32 v65, a81
  v_accvgpr_read_b32 v66, a82
  v_accvgpr_read_b32 v67, a83
  v_mul_f32 v64, v64, v193
  v_mul_f32 v65, v65, v193
  v_mul_f32 v66, v66, v193
  v_mul_f32 v67, v67, v193
  v_accvgpr_write_b32 a80, v64
  v_accvgpr_write_b32 a81, v65
  v_accvgpr_write_b32 a82, v66
  v_accvgpr_write_b32 a83, v67
  v_accvgpr_read_b32 v64, a96
  v_accvgpr_read_b32 v65, a97
  v_accvgpr_read_b32 v66, a98
  v_accvgpr_read_b32 v67, a99
  v_mul_f32 v64, v64, v193
  v_mul_f32 v65, v65, v193
  v_mul_f32 v66, v66, v193
  v_mul_f32 v67, v67, v193
  v_accvgpr_write_b32 a96, v64
  v_accvgpr_write_b32 a97, v65
  v_accvgpr_write_b32 a98, v66
  v_accvgpr_write_b32 a99, v67
  v_accvgpr_read_b32 v64, a112
  v_accvgpr_read_b32 v65, a113
  v_accvgpr_read_b32 v66, a114
  v_accvgpr_read_b32 v67, a115
  v_mul_f32 v64, v64, v193
  v_mul_f32 v65, v65, v193
  v_mul_f32 v66, v66, v193
  v_mul_f32 v67, v67, v193
  v_accvgpr_write_b32 a112, v64
  v_accvgpr_write_b32 a113, v65
  v_accvgpr_write_b32 a114, v66
  v_accvgpr_write_b32 a115, v67
  v_mov_b32 v196, v250
  v_max3_f32 v196, v196, v8, v9
  v_max3_f32 v196, v196, v10, v11
  v_max3_f32 v196, v196, v12, v13
  v_max3_f32 v196, v196, v14, v15
  v_max3_f32 v196, v196, v40, v41
  v_max3_f32 v196, v196, v42, v43
  v_max3_f32 v196, v196, v44, v45
  v_max3_f32 v196, v196, v46, v47
  v_mov_b32 v245, v196
  s_nop 1
  v_permlane16_swap_b32 v196, v245
  v_max_f32 v196, v196, v245
  v_mov_b32 v245, v196
  s_nop 1
  v_permlane32_swap_b32 v196, v245
  v_max_f32 v196, v196, v245
  v_sub_f32 v197, v250, v196
  v_exp_f32 v197, v197
  v_mov_b32 v250, v196
  v_mul_f32 v209, v209, v197
  v_sub_f32 v8, v8, v196
  v_sub_f32 v9, v9, v196
  v_sub_f32 v10, v10, v196
  v_sub_f32 v11, v11, v196
  v_sub_f32 v12, v12, v196
  v_sub_f32 v13, v13, v196
  v_sub_f32 v14, v14, v196
  v_sub_f32 v15, v15, v196
  v_sub_f32 v40, v40, v196
  v_sub_f32 v41, v41, v196
  v_sub_f32 v42, v42, v196
  v_sub_f32 v43, v43, v196
  v_sub_f32 v44, v44, v196
  v_sub_f32 v45, v45, v196
  v_sub_f32 v46, v46, v196
  v_sub_f32 v47, v47, v196
  v_exp_f32 v8, v8
  v_exp_f32 v9, v9
  v_add_f32 v209, v209, v8
  v_exp_f32 v10, v10
  v_add_f32 v209, v209, v9
  v_cvt_pk_bf16_f32 v8, v8, v9
  v_exp_f32 v11, v11
  v_add_f32 v209, v209, v10
  v_add_f32 v209, v209, v11
  v_cvt_pk_bf16_f32 v9, v10, v11
  v_exp_f32 v12, v12
  v_exp_f32 v13, v13
  v_add_f32 v209, v209, v12
  v_exp_f32 v14, v14
  v_add_f32 v209, v209, v13
  v_cvt_pk_bf16_f32 v10, v12, v13
  v_exp_f32 v15, v15
  v_add_f32 v209, v209, v14
  v_add_f32 v209, v209, v15
  v_cvt_pk_bf16_f32 v11, v14, v15
  v_exp_f32 v40, v40
  v_exp_f32 v41, v41
  v_add_f32 v209, v209, v40
  v_exp_f32 v42, v42
  v_add_f32 v209, v209, v41
  v_cvt_pk_bf16_f32 v40, v40, v41
  v_exp_f32 v43, v43
  v_add_f32 v209, v209, v42
  v_add_f32 v209, v209, v43
  v_cvt_pk_bf16_f32 v41, v42, v43
  v_exp_f32 v44, v44
  v_exp_f32 v45, v45
  v_add_f32 v209, v209, v44
  v_exp_f32 v46, v46
  v_add_f32 v209, v209, v45
  v_cvt_pk_bf16_f32 v42, v44, v45
  v_exp_f32 v47, v47
  v_add_f32 v209, v209, v46
  v_add_f32 v209, v209, v47
  v_cvt_pk_bf16_f32 v43, v46, v47
  v_accvgpr_read_b32 v64, a4
  v_accvgpr_read_b32 v65, a5
  v_accvgpr_read_b32 v66, a6
  v_accvgpr_read_b32 v67, a7
  v_mul_f32 v64, v64, v197
  v_mul_f32 v65, v65, v197
  v_mul_f32 v66, v66, v197
  v_mul_f32 v67, v67, v197
  v_accvgpr_write_b32 a4, v64
  v_accvgpr_write_b32 a5, v65
  v_accvgpr_write_b32 a6, v66
  v_accvgpr_write_b32 a7, v67
  v_accvgpr_read_b32 v64, a20
  v_accvgpr_read_b32 v65, a21
  v_accvgpr_read_b32 v66, a22
  v_accvgpr_read_b32 v67, a23
  v_mul_f32 v64, v64, v197
  v_mul_f32 v65, v65, v197
  v_mul_f32 v66, v66, v197
  v_mul_f32 v67, v67, v197
  v_accvgpr_write_b32 a20, v64
  v_accvgpr_write_b32 a21, v65
  v_accvgpr_write_b32 a22, v66
  v_accvgpr_write_b32 a23, v67
  v_accvgpr_read_b32 v64, a36
  v_accvgpr_read_b32 v65, a37
  v_accvgpr_read_b32 v66, a38
  v_accvgpr_read_b32 v67, a39
  v_mul_f32 v64, v64, v197
  v_mul_f32 v65, v65, v197
  v_mul_f32 v66, v66, v197
  v_mul_f32 v67, v67, v197
  v_accvgpr_write_b32 a36, v64
  v_accvgpr_write_b32 a37, v65
  v_accvgpr_write_b32 a38, v66
  v_accvgpr_write_b32 a39, v67
  v_accvgpr_read_b32 v64, a52
  v_accvgpr_read_b32 v65, a53
  v_accvgpr_read_b32 v66, a54
  v_accvgpr_read_b32 v67, a55
  v_mul_f32 v64, v64, v197
  v_mul_f32 v65, v65, v197
  v_mul_f32 v66, v66, v197
  v_mul_f32 v67, v67, v197
  v_accvgpr_write_b32 a52, v64
  v_accvgpr_write_b32 a53, v65
  v_accvgpr_write_b32 a54, v66
  v_accvgpr_write_b32 a55, v67
  v_accvgpr_read_b32 v64, a68
  v_accvgpr_read_b32 v65, a69
  v_accvgpr_read_b32 v66, a70
  v_accvgpr_read_b32 v67, a71
  v_mul_f32 v64, v64, v197
  v_mul_f32 v65, v65, v197
  v_mul_f32 v66, v66, v197
  v_mul_f32 v67, v67, v197
  v_accvgpr_write_b32 a68, v64
  v_accvgpr_write_b32 a69, v65
  v_accvgpr_write_b32 a70, v66
  v_accvgpr_write_b32 a71, v67
  v_accvgpr_read_b32 v64, a84
  v_accvgpr_read_b32 v65, a85
  v_accvgpr_read_b32 v66, a86
  v_accvgpr_read_b32 v67, a87
  v_mul_f32 v64, v64, v197
  v_mul_f32 v65, v65, v197
  v_mul_f32 v66, v66, v197
  v_mul_f32 v67, v67, v197
  v_accvgpr_write_b32 a84, v64
  v_accvgpr_write_b32 a85, v65
  v_accvgpr_write_b32 a86, v66
  v_accvgpr_write_b32 a87, v67
  v_accvgpr_read_b32 v64, a100
  v_accvgpr_read_b32 v65, a101
  v_accvgpr_read_b32 v66, a102
  v_accvgpr_read_b32 v67, a103
  v_mul_f32 v64, v64, v197
  v_mul_f32 v65, v65, v197
  v_mul_f32 v66, v66, v197
  v_mul_f32 v67, v67, v197
  v_accvgpr_write_b32 a100, v64
  v_accvgpr_write_b32 a101, v65
  v_accvgpr_write_b32 a102, v66
  v_accvgpr_write_b32 a103, v67
  v_accvgpr_read_b32 v64, a116
  v_accvgpr_read_b32 v65, a117
  v_accvgpr_read_b32 v66, a118
  v_accvgpr_read_b32 v67, a119
  v_mul_f32 v64, v64, v197
  v_mul_f32 v65, v65, v197
  v_mul_f32 v66, v66, v197
  v_mul_f32 v67, v67, v197
  v_accvgpr_write_b32 a116, v64
  v_accvgpr_write_b32 a117, v65
  v_accvgpr_write_b32 a118, v66
  v_accvgpr_write_b32 a119, v67
  v_mov_b32 v200, v251
  v_max3_f32 v200, v200, v16, v17
  v_max3_f32 v200, v200, v18, v19
  v_max3_f32 v200, v200, v20, v21
  v_max3_f32 v200, v200, v22, v23
  v_max3_f32 v200, v200, v48, v49
  v_max3_f32 v200, v200, v50, v51
  v_max3_f32 v200, v200, v52, v53
  v_max3_f32 v200, v200, v54, v55
  v_mov_b32 v245, v200
  s_nop 1
  v_permlane16_swap_b32 v200, v245
  v_max_f32 v200, v200, v245
  v_mov_b32 v245, v200
  s_nop 1
  v_permlane32_swap_b32 v200, v245
  v_max_f32 v200, v200, v245
  v_sub_f32 v201, v251, v200
  v_exp_f32 v201, v201
  v_mov_b32 v251, v200
  v_mul_f32 v210, v210, v201
  v_sub_f32 v16, v16, v200
  v_sub_f32 v17, v17, v200
  v_sub_f32 v18, v18, v200
  v_sub_f32 v19, v19, v200
  v_sub_f32 v20, v20, v200
  v_sub_f32 v21, v21, v200
  v_sub_f32 v22, v22, v200
  v_sub_f32 v23, v23, v200
  v_sub_f32 v48, v48, v200
  v_sub_f32 v49, v49, v200
  v_sub_f32 v50, v50, v200
  v_sub_f32 v51, v51, v200
  v_sub_f32 v52, v52, v200
  v_sub_f32 v53, v53, v200
  v_sub_f32 v54, v54, v200
  v_sub_f32 v55, v55, v200
  v_exp_f32 v16, v16
  v_exp_f32 v17, v17
  v_add_f32 v210, v210, v16
  v_exp_f32 v18, v18
  v_add_f32 v210, v210, v17
  v_cvt_pk_bf16_f32 v16, v16, v17
  v_exp_f32 v19, v19
  v_add_f32 v210, v210, v18
  v_add_f32 v210, v210, v19
  v_cvt_pk_bf16_f32 v17, v18, v19
  v_exp_f32 v20, v20
  v_exp_f32 v21, v21
  v_add_f32 v210, v210, v20
  v_exp_f32 v22, v22
  v_add_f32 v210, v210, v21
  v_cvt_pk_bf16_f32 v18, v20, v21
  v_exp_f32 v23, v23
  v_add_f32 v210, v210, v22
  v_add_f32 v210, v210, v23
  v_cvt_pk_bf16_f32 v19, v22, v23
  v_exp_f32 v48, v48
  v_exp_f32 v49, v49
  v_add_f32 v210, v210, v48
  v_exp_f32 v50, v50
  v_add_f32 v210, v210, v49
  v_cvt_pk_bf16_f32 v48, v48, v49
  v_exp_f32 v51, v51
  v_add_f32 v210, v210, v50
  v_add_f32 v210, v210, v51
  v_cvt_pk_bf16_f32 v49, v50, v51
  v_exp_f32 v52, v52
  v_exp_f32 v53, v53
  v_add_f32 v210, v210, v52
  v_exp_f32 v54, v54
  v_add_f32 v210, v210, v53
  v_cvt_pk_bf16_f32 v50, v52, v53
  v_exp_f32 v55, v55
  v_add_f32 v210, v210, v54
  v_add_f32 v210, v210, v55
  v_cvt_pk_bf16_f32 v51, v54, v55
  v_accvgpr_read_b32 v64, a8
  v_accvgpr_read_b32 v65, a9
  v_accvgpr_read_b32 v66, a10
  v_accvgpr_read_b32 v67, a11
  v_mul_f32 v64, v64, v201
  v_mul_f32 v65, v65, v201
  v_mul_f32 v66, v66, v201
  v_mul_f32 v67, v67, v201
  v_accvgpr_write_b32 a8, v64
  v_accvgpr_write_b32 a9, v65
  v_accvgpr_write_b32 a10, v66
  v_accvgpr_write_b32 a11, v67
  v_accvgpr_read_b32 v64, a24
  v_accvgpr_read_b32 v65, a25
  v_accvgpr_read_b32 v66, a26
  v_accvgpr_read_b32 v67, a27
  v_mul_f32 v64, v64, v201
  v_mul_f32 v65, v65, v201
  v_mul_f32 v66, v66, v201
  v_mul_f32 v67, v67, v201
  v_accvgpr_write_b32 a24, v64
  v_accvgpr_write_b32 a25, v65
  v_accvgpr_write_b32 a26, v66
  v_accvgpr_write_b32 a27, v67
  v_accvgpr_read_b32 v64, a40
  v_accvgpr_read_b32 v65, a41
  v_accvgpr_read_b32 v66, a42
  v_accvgpr_read_b32 v67, a43
  v_mul_f32 v64, v64, v201
  v_mul_f32 v65, v65, v201
  v_mul_f32 v66, v66, v201
  v_mul_f32 v67, v67, v201
  v_accvgpr_write_b32 a40, v64
  v_accvgpr_write_b32 a41, v65
  v_accvgpr_write_b32 a42, v66
  v_accvgpr_write_b32 a43, v67
  v_accvgpr_read_b32 v64, a56
  v_accvgpr_read_b32 v65, a57
  v_accvgpr_read_b32 v66, a58
  v_accvgpr_read_b32 v67, a59
  v_mul_f32 v64, v64, v201
  v_mul_f32 v65, v65, v201
  v_mul_f32 v66, v66, v201
  v_mul_f32 v67, v67, v201
  v_accvgpr_write_b32 a56, v64
  v_accvgpr_write_b32 a57, v65
  v_accvgpr_write_b32 a58, v66
  v_accvgpr_write_b32 a59, v67
  v_accvgpr_read_b32 v64, a72
  v_accvgpr_read_b32 v65, a73
  v_accvgpr_read_b32 v66, a74
  v_accvgpr_read_b32 v67, a75
  v_mul_f32 v64, v64, v201
  v_mul_f32 v65, v65, v201
  v_mul_f32 v66, v66, v201
  v_mul_f32 v67, v67, v201
  v_accvgpr_write_b32 a72, v64
  v_accvgpr_write_b32 a73, v65
  v_accvgpr_write_b32 a74, v66
  v_accvgpr_write_b32 a75, v67
  v_accvgpr_read_b32 v64, a88
  v_accvgpr_read_b32 v65, a89
  v_accvgpr_read_b32 v66, a90
  v_accvgpr_read_b32 v67, a91
  v_mul_f32 v64, v64, v201
  v_mul_f32 v65, v65, v201
  v_mul_f32 v66, v66, v201
  v_mul_f32 v67, v67, v201
  v_accvgpr_write_b32 a88, v64
  v_accvgpr_write_b32 a89, v65
  v_accvgpr_write_b32 a90, v66
  v_accvgpr_write_b32 a91, v67
  v_accvgpr_read_b32 v64, a104
  v_accvgpr_read_b32 v65, a105
  v_accvgpr_read_b32 v66, a106
  v_accvgpr_read_b32 v67, a107
  v_mul_f32 v64, v64, v201
  v_mul_f32 v65, v65, v201
  v_mul_f32 v66, v66, v201
  v_mul_f32 v67, v67, v201
  v_accvgpr_write_b32 a104, v64
  v_accvgpr_write_b32 a105, v65
  v_accvgpr_write_b32 a106, v66
  v_accvgpr_write_b32 a107, v67
  v_accvgpr_read_b32 v64, a120
  v_accvgpr_read_b32 v65, a121
  v_accvgpr_read_b32 v66, a122
  v_accvgpr_read_b32 v67, a123
  v_mul_f32 v64, v64, v201
  v_mul_f32 v65, v65, v201
  v_mul_f32 v66, v66, v201
  v_mul_f32 v67, v67, v201
  v_accvgpr_write_b32 a120, v64
  v_accvgpr_write_b32 a121, v65
  v_accvgpr_write_b32 a122, v66
  v_accvgpr_write_b32 a123, v67
  v_mov_b32 v204, v252
  v_max3_f32 v204, v204, v24, v25
  v_max3_f32 v204, v204, v26, v27
  v_max3_f32 v204, v204, v28, v29
  v_max3_f32 v204, v204, v30, v31
  v_max3_f32 v204, v204, v56, v57
  v_max3_f32 v204, v204, v58, v59
  v_max3_f32 v204, v204, v60, v61
  v_max3_f32 v204, v204, v62, v63
  v_mov_b32 v245, v204
  s_nop 1
  v_permlane16_swap_b32 v204, v245
  v_max_f32 v204, v204, v245
  v_mov_b32 v245, v204
  s_nop 1
  v_permlane32_swap_b32 v204, v245
  v_max_f32 v204, v204, v245
  v_sub_f32 v205, v252, v204
  v_exp_f32 v205, v205
  v_mov_b32 v252, v204
  v_mul_f32 v211, v211, v205
  v_sub_f32 v24, v24, v204
  v_sub_f32 v25, v25, v204
  v_sub_f32 v26, v26, v204
  v_sub_f32 v27, v27, v204
  v_sub_f32 v28, v28, v204
  v_sub_f32 v29, v29, v204
  v_sub_f32 v30, v30, v204
  v_sub_f32 v31, v31, v204
  v_sub_f32 v56, v56, v204
  v_sub_f32 v57, v57, v204
  v_sub_f32 v58, v58, v204
  v_sub_f32 v59, v59, v204
  v_sub_f32 v60, v60, v204
  v_sub_f32 v61, v61, v204
  v_sub_f32 v62, v62, v204
  v_sub_f32 v63, v63, v204
  v_exp_f32 v24, v24
  v_exp_f32 v25, v25
  v_add_f32 v211, v211, v24
  v_exp_f32 v26, v26
  v_add_f32 v211, v211, v25
  v_cvt_pk_bf16_f32 v24, v24, v25
  v_exp_f32 v27, v27
  v_add_f32 v211, v211, v26
  v_add_f32 v211, v211, v27
  v_cvt_pk_bf16_f32 v25, v26, v27
  v_exp_f32 v28, v28
  v_exp_f32 v29, v29
  v_add_f32 v211, v211, v28
  v_exp_f32 v30, v30
  v_add_f32 v211, v211, v29
  v_cvt_pk_bf16_f32 v26, v28, v29
  v_exp_f32 v31, v31
  v_add_f32 v211, v211, v30
  v_add_f32 v211, v211, v31
  v_cvt_pk_bf16_f32 v27, v30, v31
  v_exp_f32 v56, v56
  v_exp_f32 v57, v57
  v_add_f32 v211, v211, v56
  v_exp_f32 v58, v58
  v_add_f32 v211, v211, v57
  v_cvt_pk_bf16_f32 v56, v56, v57
  v_exp_f32 v59, v59
  v_add_f32 v211, v211, v58
  v_add_f32 v211, v211, v59
  v_cvt_pk_bf16_f32 v57, v58, v59
  v_exp_f32 v60, v60
  v_exp_f32 v61, v61
  v_add_f32 v211, v211, v60
  v_exp_f32 v62, v62
  v_add_f32 v211, v211, v61
  v_cvt_pk_bf16_f32 v58, v60, v61
  v_exp_f32 v63, v63
  v_add_f32 v211, v211, v62
  v_add_f32 v211, v211, v63
  v_cvt_pk_bf16_f32 v59, v62, v63
  v_accvgpr_read_b32 v64, a12
  v_accvgpr_read_b32 v65, a13
  v_accvgpr_read_b32 v66, a14
  v_accvgpr_read_b32 v67, a15
  v_mul_f32 v64, v64, v205
  v_mul_f32 v65, v65, v205
  v_mul_f32 v66, v66, v205
  v_mul_f32 v67, v67, v205
  v_accvgpr_write_b32 a12, v64
  v_accvgpr_write_b32 a13, v65
  v_accvgpr_write_b32 a14, v66
  v_accvgpr_write_b32 a15, v67
  v_accvgpr_read_b32 v64, a28
  v_accvgpr_read_b32 v65, a29
  v_accvgpr_read_b32 v66, a30
  v_accvgpr_read_b32 v67, a31
  v_mul_f32 v64, v64, v205
  v_mul_f32 v65, v65, v205
  v_mul_f32 v66, v66, v205
  v_mul_f32 v67, v67, v205
  v_accvgpr_write_b32 a28, v64
  v_accvgpr_write_b32 a29, v65
  v_accvgpr_write_b32 a30, v66
  v_accvgpr_write_b32 a31, v67
  v_accvgpr_read_b32 v64, a44
  v_accvgpr_read_b32 v65, a45
  v_accvgpr_read_b32 v66, a46
  v_accvgpr_read_b32 v67, a47
  v_mul_f32 v64, v64, v205
  v_mul_f32 v65, v65, v205
  v_mul_f32 v66, v66, v205
  v_mul_f32 v67, v67, v205
  v_accvgpr_write_b32 a44, v64
  v_accvgpr_write_b32 a45, v65
  v_accvgpr_write_b32 a46, v66
  v_accvgpr_write_b32 a47, v67
  v_accvgpr_read_b32 v64, a60
  v_accvgpr_read_b32 v65, a61
  v_accvgpr_read_b32 v66, a62
  v_accvgpr_read_b32 v67, a63
  v_mul_f32 v64, v64, v205
  v_mul_f32 v65, v65, v205
  v_mul_f32 v66, v66, v205
  v_mul_f32 v67, v67, v205
  v_accvgpr_write_b32 a60, v64
  v_accvgpr_write_b32 a61, v65
  v_accvgpr_write_b32 a62, v66
  v_accvgpr_write_b32 a63, v67
  v_accvgpr_read_b32 v64, a76
  v_accvgpr_read_b32 v65, a77
  v_accvgpr_read_b32 v66, a78
  v_accvgpr_read_b32 v67, a79
  v_mul_f32 v64, v64, v205
  v_mul_f32 v65, v65, v205
  v_mul_f32 v66, v66, v205
  v_mul_f32 v67, v67, v205
  v_accvgpr_write_b32 a76, v64
  v_accvgpr_write_b32 a77, v65
  v_accvgpr_write_b32 a78, v66
  v_accvgpr_write_b32 a79, v67
  v_accvgpr_read_b32 v64, a92
  v_accvgpr_read_b32 v65, a93
  v_accvgpr_read_b32 v66, a94
  v_accvgpr_read_b32 v67, a95
  v_mul_f32 v64, v64, v205
  v_mul_f32 v65, v65, v205
  v_mul_f32 v66, v66, v205
  v_mul_f32 v67, v67, v205
  v_accvgpr_write_b32 a92, v64
  v_accvgpr_write_b32 a93, v65
  v_accvgpr_write_b32 a94, v66
  v_accvgpr_write_b32 a95, v67
  v_accvgpr_read_b32 v64, a108
  v_accvgpr_read_b32 v65, a109
  v_accvgpr_read_b32 v66, a110
  v_accvgpr_read_b32 v67, a111
  v_mul_f32 v64, v64, v205
  v_mul_f32 v65, v65, v205
  v_mul_f32 v66, v66, v205
  v_mul_f32 v67, v67, v205
  v_accvgpr_write_b32 a108, v64
  v_accvgpr_write_b32 a109, v65
  v_accvgpr_write_b32 a110, v66
  v_accvgpr_write_b32 a111, v67
  v_accvgpr_read_b32 v64, a124
  v_accvgpr_read_b32 v65, a125
  v_accvgpr_read_b32 v66, a126
  v_accvgpr_read_b32 v67, a127
  v_mul_f32 v64, v64, v205
  v_mul_f32 v65, v65, v205
  v_mul_f32 v66, v66, v205
  v_mul_f32 v67, v67, v205
  v_accvgpr_write_b32 a124, v64
  v_accvgpr_write_b32 a125, v65
  v_accvgpr_write_b32 a126, v66
  v_accvgpr_write_b32 a127, v67
  ds_read_b64_tr_b16 a[160:161], v216 offset:49152
  ds_read_b64_tr_b16 a[162:163], v216 offset:53248
  ds_read_b64_tr_b16 a[164:165], v216 offset:57344
  ds_read_b64_tr_b16 a[166:167], v216 offset:61440
  s_waitcnt lgkmcnt(2)
  v_mfma_f32_16x16x32_bf16 a[0:3], a[160:163], v[0:3], a[0:3]
  s_waitcnt lgkmcnt(0)
  v_mfma_f32_16x16x32_bf16 a[0:3], a[164:167], v[32:35], a[0:3]
  v_mfma_f32_16x16x32_bf16 a[4:7], a[164:167], v[40:43], a[4:7]
  v_mfma_f32_16x16x32_bf16 a[4:7], a[160:163], v[8:11], a[4:7]
  v_mfma_f32_16x16x32_bf16 a[8:11], a[160:163], v[16:19], a[8:11]
  v_mfma_f32_16x16x32_bf16 a[8:11], a[164:167], v[48:51], a[8:11]
  v_mfma_f32_16x16x32_bf16 a[12:15], a[164:167], v[56:59], a[12:15]
  v_mfma_f32_16x16x32_bf16 a[12:15], a[160:163], v[24:27], a[12:15]
  ds_read_b64_tr_b16 a[168:169], v217 offset:49152
  ds_read_b64_tr_b16 a[170:171], v217 offset:53248
  ds_read_b64_tr_b16 a[172:173], v217 offset:57344
  ds_read_b64_tr_b16 a[174:175], v217 offset:61440
  s_waitcnt lgkmcnt(2)
  v_mfma_f32_16x16x32_bf16 a[16:19], a[168:171], v[0:3], a[16:19]
  s_waitcnt lgkmcnt(0)
  v_mfma_f32_16x16x32_bf16 a[16:19], a[172:175], v[32:35], a[16:19]
  v_mfma_f32_16x16x32_bf16 a[20:23], a[172:175], v[40:43], a[20:23]
  v_mfma_f32_16x16x32_bf16 a[20:23], a[168:171], v[8:11], a[20:23]
  v_mfma_f32_16x16x32_bf16 a[24:27], a[168:171], v[16:19], a[24:27]
  v_mfma_f32_16x16x32_bf16 a[24:27], a[172:175], v[48:51], a[24:27]
  v_mfma_f32_16x16x32_bf16 a[28:31], a[172:175], v[56:59], a[28:31]
  v_mfma_f32_16x16x32_bf16 a[28:31], a[168:171], v[24:27], a[28:31]
  ds_read_b64_tr_b16 a[176:177], v218 offset:49152
  ds_read_b64_tr_b16 a[178:179], v218 offset:53248
  ds_read_b64_tr_b16 a[180:181], v218 offset:57344
  ds_read_b64_tr_b16 a[182:183], v218 offset:61440
  s_waitcnt lgkmcnt(2)
  v_mfma_f32_16x16x32_bf16 a[32:35], a[176:179], v[0:3], a[32:35]
  s_waitcnt lgkmcnt(0)
  v_mfma_f32_16x16x32_bf16 a[32:35], a[180:183], v[32:35], a[32:35]
  v_mfma_f32_16x16x32_bf16 a[36:39], a[180:183], v[40:43], a[36:39]
  v_mfma_f32_16x16x32_bf16 a[36:39], a[176:179], v[8:11], a[36:39]
  v_mfma_f32_16x16x32_bf16 a[40:43], a[176:179], v[16:19], a[40:43]
  v_mfma_f32_16x16x32_bf16 a[40:43], a[180:183], v[48:51], a[40:43]
  v_mfma_f32_16x16x32_bf16 a[44:47], a[180:183], v[56:59], a[44:47]
  v_mfma_f32_16x16x32_bf16 a[44:47], a[176:179], v[24:27], a[44:47]
  ds_read_b64_tr_b16 a[184:185], v219 offset:49152
  ds_read_b64_tr_b16 a[186:187], v219 offset:53248
  ds_read_b64_tr_b16 a[188:189], v219 offset:57344
  ds_read_b64_tr_b16 a[190:191], v219 offset:61440
  s_waitcnt lgkmcnt(2)
  v_mfma_f32_16x16x32_bf16 a[48:51], a[184:187], v[0:3], a[48:51]
  s_waitcnt lgkmcnt(0)
  v_mfma_f32_16x16x32_bf16 a[48:51], a[188:191], v[32:35], a[48:51]
  v_mfma_f32_16x16x32_bf16 a[52:55], a[188:191], v[40:43], a[52:55]
  v_mfma_f32_16x16x32_bf16 a[52:55], a[184:187], v[8:11], a[52:55]
  v_mfma_f32_16x16x32_bf16 a[56:59], a[184:187], v[16:19], a[56:59]
  v_mfma_f32_16x16x32_bf16 a[56:59], a[188:191], v[48:51], a[56:59]
  v_mfma_f32_16x16x32_bf16 a[60:63], a[188:191], v[56:59], a[60:63]
  v_mfma_f32_16x16x32_bf16 a[60:63], a[184:187], v[24:27], a[60:63]
  ds_read_b64_tr_b16 a[160:161], v220 offset:49152
  ds_read_b64_tr_b16 a[162:163], v220 offset:53248
  ds_read_b64_tr_b16 a[164:165], v220 offset:57344
  ds_read_b64_tr_b16 a[166:167], v220 offset:61440
  s_waitcnt lgkmcnt(2)
  v_mfma_f32_16x16x32_bf16 a[64:67], a[160:163], v[0:3], a[64:67]
  s_waitcnt lgkmcnt(0)
  v_mfma_f32_16x16x32_bf16 a[64:67], a[164:167], v[32:35], a[64:67]
  v_mfma_f32_16x16x32_bf16 a[68:71], a[164:167], v[40:43], a[68:71]
  v_mfma_f32_16x16x32_bf16 a[68:71], a[160:163], v[8:11], a[68:71]
  v_mfma_f32_16x16x32_bf16 a[72:75], a[160:163], v[16:19], a[72:75]
  v_mfma_f32_16x16x32_bf16 a[72:75], a[164:167], v[48:51], a[72:75]
  v_mfma_f32_16x16x32_bf16 a[76:79], a[164:167], v[56:59], a[76:79]
  v_mfma_f32_16x16x32_bf16 a[76:79], a[160:163], v[24:27], a[76:79]
  ds_read_b64_tr_b16 a[168:169], v221 offset:49152
  ds_read_b64_tr_b16 a[170:171], v221 offset:53248
  ds_read_b64_tr_b16 a[172:173], v221 offset:57344
  ds_read_b64_tr_b16 a[174:175], v221 offset:61440
  s_waitcnt lgkmcnt(2)
  v_mfma_f32_16x16x32_bf16 a[80:83], a[168:171], v[0:3], a[80:83]
  s_waitcnt lgkmcnt(0)
  v_mfma_f32_16x16x32_bf16 a[80:83], a[172:175], v[32:35], a[80:83]
  v_mfma_f32_16x16x32_bf16 a[84:87], a[172:175], v[40:43], a[84:87]
  v_mfma_f32_16x16x32_bf16 a[84:87], a[168:171], v[8:11], a[84:87]
  v_mfma_f32_16x16x32_bf16 a[88:91], a[168:171], v[16:19], a[88:91]
  v_mfma_f32_16x16x32_bf16 a[88:91], a[172:175], v[48:51], a[88:91]
  v_mfma_f32_16x16x32_bf16 a[92:95], a[172:175], v[56:59], a[92:95]
  v_mfma_f32_16x16x32_bf16 a[92:95], a[168:171], v[24:27], a[92:95]
  ds_read_b64_tr_b16 a[176:177], v222 offset:49152
  ds_read_b64_tr_b16 a[178:179], v222 offset:53248
  ds_read_b64_tr_b16 a[180:181], v222 offset:57344
  ds_read_b64_tr_b16 a[182:183], v222 offset:61440
  s_waitcnt lgkmcnt(2)
  v_mfma_f32_16x16x32_bf16 a[96:99], a[176:179], v[0:3], a[96:99]
  s_waitcnt lgkmcnt(0)
  v_mfma_f32_16x16x32_bf16 a[96:99], a[180:183], v[32:35], a[96:99]
  v_mfma_f32_16x16x32_bf16 a[100:103], a[180:183], v[40:43], a[100:103]
  v_mfma_f32_16x16x32_bf16 a[100:103], a[176:179], v[8:11], a[100:103]
  v_mfma_f32_16x16x32_bf16 a[104:107], a[176:179], v[16:19], a[104:107]
  v_mfma_f32_16x16x32_bf16 a[104:107], a[180:183], v[48:51], a[104:107]
  v_mfma_f32_16x16x32_bf16 a[108:111], a[180:183], v[56:59], a[108:111]
  v_mfma_f32_16x16x32_bf16 a[108:111], a[176:179], v[24:27], a[108:111]
  ds_read_b64_tr_b16 a[184:185], v223 offset:49152
  ds_read_b64_tr_b16 a[186:187], v223 offset:53248
  ds_read_b64_tr_b16 a[188:189], v223 offset:57344
  ds_read_b64_tr_b16 a[190:191], v223 offset:61440
  s_waitcnt lgkmcnt(2)
  v_mfma_f32_16x16x32_bf16 a[112:115], a[184:187], v[0:3], a[112:115]
  s_waitcnt lgkmcnt(0)
  v_mfma_f32_16x16x32_bf16 a[112:115], a[188:191], v[32:35], a[112:115]
  v_mfma_f32_16x16x32_bf16 a[116:119], a[188:191], v[40:43], a[116:119]
  v_mfma_f32_16x16x32_bf16 a[116:119], a[184:187], v[8:11], a[116:119]
  v_mfma_f32_16x16x32_bf16 a[120:123], a[184:187], v[16:19], a[120:123]
  v_mfma_f32_16x16x32_bf16 a[120:123], a[188:191], v[48:51], a[120:123]
  v_mfma_f32_16x16x32_bf16 a[124:127], a[188:191], v[56:59], a[124:127]
  v_mfma_f32_16x16x32_bf16 a[124:127], a[184:187], v[24:27], a[124:127]
  s_add_u32 s29, s29, 16384
  s_cmp_lt_u32 s29, 524288
  s_cbranch_scc1 attn_slow
  v_mov_b32 v245, v208
  v_mov_b32 v246, v209
  v_mov_b32 v247, v210
  v_mov_b32 v248, v211
  v_permlane16_swap_b32 v208, v245
  v_permlane16_swap_b32 v209, v246
  v_permlane16_swap_b32 v210, v247
  v_permlane16_swap_b32 v211, v248
  v_add_f32 v208, v208, v245
  v_add_f32 v209, v209, v246
  v_add_f32 v210, v210, v247
  v_add_f32 v211, v211, v248
  v_mov_b32 v245, v208
  v_mov_b32 v246, v209
  v_mov_b32 v247, v210
  v_mov_b32 v248, v211
  v_permlane32_swap_b32 v208, v245
  v_permlane32_swap_b32 v209, v246
  v_permlane32_swap_b32 v210, v247
  v_permlane32_swap_b32 v211, v248
  v_add_f32 v208, v208, v245
  v_add_f32 v209, v209, v246
  v_add_f32 v210, v210, v247
  v_add_f32 v211, v211, v248
  v_rcp_f32 v192, v208
  v_rcp_f32 v196, v209
  v_rcp_f32 v200, v210
  v_rcp_f32 v204, v211
  v_accvgpr_read_b32 v0, a0
  v_accvgpr_read_b32 v1, a1
  v_accvgpr_read_b32 v2, a2
  v_accvgpr_read_b32 v3, a3
  v_accvgpr_read_b32 v4, a16
  v_accvgpr_read_b32 v5, a17
  v_accvgpr_read_b32 v6, a18
  v_accvgpr_read_b32 v7, a19
  v_mul_f32 v0, v0, v192
  v_mul_f32 v1, v1, v192
  v_mul_f32 v2, v2, v192
  v_mul_f32 v3, v3, v192
  v_mul_f32 v4, v4, v192
  v_mul_f32 v5, v5, v192
  v_mul_f32 v6, v6, v192
  v_mul_f32 v7, v7, v192
  v_cvt_pk_bf16_f32 v0, v0, v1
  v_cvt_pk_bf16_f32 v1, v2, v3
  v_cvt_pk_bf16_f32 v2, v4, v5
  v_cvt_pk_bf16_f32 v3, v6, v7
  buffer_store_dwordx4 v[0:3], v244, s[24:27], s40 offen offset:0 sc1
  v_accvgpr_read_b32 v8, a4
  v_accvgpr_read_b32 v9, a5
  v_accvgpr_read_b32 v10, a6
  v_accvgpr_read_b32 v11, a7
  v_accvgpr_read_b32 v12, a20
  v_accvgpr_read_b32 v13, a21
  v_accvgpr_read_b32 v14, a22
  v_accvgpr_read_b32 v15, a23
  v_mul_f32 v8, v8, v196
  v_mul_f32 v9, v9, v196
  v_mul_f32 v10, v10, v196
  v_mul_f32 v11, v11, v196
  v_mul_f32 v12, v12, v196
  v_mul_f32 v13, v13, v196
  v_mul_f32 v14, v14, v196
  v_mul_f32 v15, v15, v196
  v_cvt_pk_bf16_f32 v8, v8, v9
  v_cvt_pk_bf16_f32 v9, v10, v11
  v_cvt_pk_bf16_f32 v10, v12, v13
  v_cvt_pk_bf16_f32 v11, v14, v15
  buffer_store_dwordx4 v[8:11], v244, s[24:27], s40 offen offset:2048 sc1
  v_accvgpr_read_b32 v16, a8
  v_accvgpr_read_b32 v17, a9
  v_accvgpr_read_b32 v18, a10
  v_accvgpr_read_b32 v19, a11
  v_accvgpr_read_b32 v20, a24
  v_accvgpr_read_b32 v21, a25
  v_accvgpr_read_b32 v22, a26
  v_accvgpr_read_b32 v23, a27
  v_mul_f32 v16, v16, v200
  v_mul_f32 v17, v17, v200
  v_mul_f32 v18, v18, v200
  v_mul_f32 v19, v19, v200
  v_mul_f32 v20, v20, v200
  v_mul_f32 v21, v21, v200
  v_mul_f32 v22, v22, v200
  v_mul_f32 v23, v23, v200
  v_cvt_pk_bf16_f32 v16, v16, v17
  v_cvt_pk_bf16_f32 v17, v18, v19
  v_cvt_pk_bf16_f32 v18, v20, v21
  v_cvt_pk_bf16_f32 v19, v22, v23
  buffer_store_dwordx4 v[16:19], v244, s[24:27], s41 offen offset:0 sc1
  v_accvgpr_read_b32 v24, a12
  v_accvgpr_read_b32 v25, a13
  v_accvgpr_read_b32 v26, a14
  v_accvgpr_read_b32 v27, a15
  v_accvgpr_read_b32 v28, a28
  v_accvgpr_read_b32 v29, a29
  v_accvgpr_read_b32 v30, a30
  v_accvgpr_read_b32 v31, a31
  v_mul_f32 v24, v24, v204
  v_mul_f32 v25, v25, v204
  v_mul_f32 v26, v26, v204
  v_mul_f32 v27, v27, v204
  v_mul_f32 v28, v28, v204
  v_mul_f32 v29, v29, v204
  v_mul_f32 v30, v30, v204
  v_mul_f32 v31, v31, v204
  v_cvt_pk_bf16_f32 v24, v24, v25
  v_cvt_pk_bf16_f32 v25, v26, v27
  v_cvt_pk_bf16_f32 v26, v28, v29
  v_cvt_pk_bf16_f32 v27, v30, v31
  buffer_store_dwordx4 v[24:27], v244, s[24:27], s41 offen offset:2048 sc1
  v_accvgpr_read_b32 v32, a32
  v_accvgpr_read_b32 v33, a33
  v_accvgpr_read_b32 v34, a34
  v_accvgpr_read_b32 v35, a35
  v_accvgpr_read_b32 v36, a48
  v_accvgpr_read_b32 v37, a49
  v_accvgpr_read_b32 v38, a50
  v_accvgpr_read_b32 v39, a51
  v_mul_f32 v32, v32, v192
  v_mul_f32 v33, v33, v192
  v_mul_f32 v34, v34, v192
  v_mul_f32 v35, v35, v192
  v_mul_f32 v36, v36, v192
  v_mul_f32 v37, v37, v192
  v_mul_f32 v38, v38, v192
  v_mul_f32 v39, v39, v192
  v_cvt_pk_bf16_f32 v32, v32, v33
  v_cvt_pk_bf16_f32 v33, v34, v35
  v_cvt_pk_bf16_f32 v34, v36, v37
  v_cvt_pk_bf16_f32 v35, v38, v39
  buffer_store_dwordx4 v[32:35], v244, s[24:27], s40 offen offset:1024 sc1
  v_accvgpr_read_b32 v40, a36
  v_accvgpr_read_b32 v41, a37
  v_accvgpr_read_b32 v42, a38
  v_accvgpr_read_b32 v43, a39
  v_accvgpr_read_b32 v44, a52
  v_accvgpr_read_b32 v45, a53
  v_accvgpr_read_b32 v46, a54
  v_accvgpr_read_b32 v47, a55
  v_mul_f32 v40, v40, v196
  v_mul_f32 v41, v41, v196
  v_mul_f32 v42, v42, v196
  v_mul_f32 v43, v43, v196
  v_mul_f32 v44, v44, v196
  v_mul_f32 v45, v45, v196
  v_mul_f32 v46, v46, v196
  v_mul_f32 v47, v47, v196
  v_cvt_pk_bf16_f32 v40, v40, v41
  v_cvt_pk_bf16_f32 v41, v42, v43
  v_cvt_pk_bf16_f32 v42, v44, v45
  v_cvt_pk_bf16_f32 v43, v46, v47
  buffer_store_dwordx4 v[40:43], v244, s[24:27], s40 offen offset:3072 sc1
  v_accvgpr_read_b32 v48, a40
  v_accvgpr_read_b32 v49, a41
  v_accvgpr_read_b32 v50, a42
  v_accvgpr_read_b32 v51, a43
  v_accvgpr_read_b32 v52, a56
  v_accvgpr_read_b32 v53, a57
  v_accvgpr_read_b32 v54, a58
  v_accvgpr_read_b32 v55, a59
  v_mul_f32 v48, v48, v200
  v_mul_f32 v49, v49, v200
  v_mul_f32 v50, v50, v200
  v_mul_f32 v51, v51, v200
  v_mul_f32 v52, v52, v200
  v_mul_f32 v53, v53, v200
  v_mul_f32 v54, v54, v200
  v_mul_f32 v55, v55, v200
  v_cvt_pk_bf16_f32 v48, v48, v49
  v_cvt_pk_bf16_f32 v49, v50, v51
  v_cvt_pk_bf16_f32 v50, v52, v53
  v_cvt_pk_bf16_f32 v51, v54, v55
  buffer_store_dwordx4 v[48:51], v244, s[24:27], s41 offen offset:1024 sc1
  v_accvgpr_read_b32 v56, a44
  v_accvgpr_read_b32 v57, a45
  v_accvgpr_read_b32 v58, a46
  v_accvgpr_read_b32 v59, a47
  v_accvgpr_read_b32 v60, a60
  v_accvgpr_read_b32 v61, a61
  v_accvgpr_read_b32 v62, a62
  v_accvgpr_read_b32 v63, a63
  v_mul_f32 v56, v56, v204
  v_mul_f32 v57, v57, v204
  v_mul_f32 v58, v58, v204
  v_mul_f32 v59, v59, v204
  v_mul_f32 v60, v60, v204
  v_mul_f32 v61, v61, v204
  v_mul_f32 v62, v62, v204
  v_mul_f32 v63, v63, v204
  v_cvt_pk_bf16_f32 v56, v56, v57
  v_cvt_pk_bf16_f32 v57, v58, v59
  v_cvt_pk_bf16_f32 v58, v60, v61
  v_cvt_pk_bf16_f32 v59, v62, v63
  buffer_store_dwordx4 v[56:59], v244, s[24:27], s41 offen offset:3072 sc1
  v_accvgpr_read_b32 v0, a64
  v_accvgpr_read_b32 v1, a65
  v_accvgpr_read_b32 v2, a66
  v_accvgpr_read_b32 v3, a67
  v_accvgpr_read_b32 v4, a80
  v_accvgpr_read_b32 v5, a81
  v_accvgpr_read_b32 v6, a82
  v_accvgpr_read_b32 v7, a83
  v_mul_f32 v0, v0, v192
  v_mul_f32 v1, v1, v192
  v_mul_f32 v2, v2, v192
  v_mul_f32 v3, v3, v192
  v_mul_f32 v4, v4, v192
  v_mul_f32 v5, v5, v192
  v_mul_f32 v6, v6, v192
  v_mul_f32 v7, v7, v192
  v_cvt_pk_bf16_f32 v0, v0, v1
  v_cvt_pk_bf16_f32 v1, v2, v3
  v_cvt_pk_bf16_f32 v2, v4, v5
  v_cvt_pk_bf16_f32 v3, v6, v7
  buffer_store_dwordx4 v[0:3], v244, s[24:27], s42 offen offset:0 sc1
  v_accvgpr_read_b32 v8, a68
  v_accvgpr_read_b32 v9, a69
  v_accvgpr_read_b32 v10, a70
  v_accvgpr_read_b32 v11, a71
  v_accvgpr_read_b32 v12, a84
  v_accvgpr_read_b32 v13, a85
  v_accvgpr_read_b32 v14, a86
  v_accvgpr_read_b32 v15, a87
  v_mul_f32 v8, v8, v196
  v_mul_f32 v9, v9, v196
  v_mul_f32 v10, v10, v196
  v_mul_f32 v11, v11, v196
  v_mul_f32 v12, v12, v196
  v_mul_f32 v13, v13, v196
  v_mul_f32 v14, v14, v196
  v_mul_f32 v15, v15, v196
  v_cvt_pk_bf16_f32 v8, v8, v9
  v_cvt_pk_bf16_f32 v9, v10, v11
  v_cvt_pk_bf16_f32 v10, v12, v13
  v_cvt_pk_bf16_f32 v11, v14, v15
  buffer_store_dwordx4 v[8:11], v244, s[24:27], s42 offen offset:2048 sc1
  v_accvgpr_read_b32 v16, a72
  v_accvgpr_read_b32 v17, a73
  v_accvgpr_read_b32 v18, a74
  v_accvgpr_read_b32 v19, a75
  v_accvgpr_read_b32 v20, a88
  v_accvgpr_read_b32 v21, a89
  v_accvgpr_read_b32 v22, a90
  v_accvgpr_read_b32 v23, a91
  v_mul_f32 v16, v16, v200
  v_mul_f32 v17, v17, v200
  v_mul_f32 v18, v18, v200
  v_mul_f32 v19, v19, v200
  v_mul_f32 v20, v20, v200
  v_mul_f32 v21, v21, v200
  v_mul_f32 v22, v22, v200
  v_mul_f32 v23, v23, v200
  v_cvt_pk_bf16_f32 v16, v16, v17
  v_cvt_pk_bf16_f32 v17, v18, v19
  v_cvt_pk_bf16_f32 v18, v20, v21
  v_cvt_pk_bf16_f32 v19, v22, v23
  buffer_store_dwordx4 v[16:19], v244, s[24:27], s43 offen offset:0 sc1
  v_accvgpr_read_b32 v24, a76
  v_accvgpr_read_b32 v25, a77
  v_accvgpr_read_b32 v26, a78
  v_accvgpr_read_b32 v27, a79
  v_accvgpr_read_b32 v28, a92
  v_accvgpr_read_b32 v29, a93
  v_accvgpr_read_b32 v30, a94
  v_accvgpr_read_b32 v31, a95
  v_mul_f32 v24, v24, v204
  v_mul_f32 v25, v25, v204
  v_mul_f32 v26, v26, v204
  v_mul_f32 v27, v27, v204
  v_mul_f32 v28, v28, v204
  v_mul_f32 v29, v29, v204
  v_mul_f32 v30, v30, v204
  v_mul_f32 v31, v31, v204
  v_cvt_pk_bf16_f32 v24, v24, v25
  v_cvt_pk_bf16_f32 v25, v26, v27
  v_cvt_pk_bf16_f32 v26, v28, v29
  v_cvt_pk_bf16_f32 v27, v30, v31
  buffer_store_dwordx4 v[24:27], v244, s[24:27], s43 offen offset:2048 sc1
  v_accvgpr_read_b32 v32, a96
  v_accvgpr_read_b32 v33, a97
  v_accvgpr_read_b32 v34, a98
  v_accvgpr_read_b32 v35, a99
  v_accvgpr_read_b32 v36, a112
  v_accvgpr_read_b32 v37, a113
  v_accvgpr_read_b32 v38, a114
  v_accvgpr_read_b32 v39, a115
  v_mul_f32 v32, v32, v192
  v_mul_f32 v33, v33, v192
  v_mul_f32 v34, v34, v192
  v_mul_f32 v35, v35, v192
  v_mul_f32 v36, v36, v192
  v_mul_f32 v37, v37, v192
  v_mul_f32 v38, v38, v192
  v_mul_f32 v39, v39, v192
  v_cvt_pk_bf16_f32 v32, v32, v33
  v_cvt_pk_bf16_f32 v33, v34, v35
  v_cvt_pk_bf16_f32 v34, v36, v37
  v_cvt_pk_bf16_f32 v35, v38, v39
  buffer_store_dwordx4 v[32:35], v244, s[24:27], s42 offen offset:1024 sc1
  v_accvgpr_read_b32 v40, a100
  v_accvgpr_read_b32 v41, a101
  v_accvgpr_read_b32 v42, a102
  v_accvgpr_read_b32 v43, a103
  v_accvgpr_read_b32 v44, a116
  v_accvgpr_read_b32 v45, a117
  v_accvgpr_read_b32 v46, a118
  v_accvgpr_read_b32 v47, a119
  v_mul_f32 v40, v40, v196
  v_mul_f32 v41, v41, v196
  v_mul_f32 v42, v42, v196
  v_mul_f32 v43, v43, v196
  v_mul_f32 v44, v44, v196
  v_mul_f32 v45, v45, v196
  v_mul_f32 v46, v46, v196
  v_mul_f32 v47, v47, v196
  v_cvt_pk_bf16_f32 v40, v40, v41
  v_cvt_pk_bf16_f32 v41, v42, v43
  v_cvt_pk_bf16_f32 v42, v44, v45
  v_cvt_pk_bf16_f32 v43, v46, v47
  buffer_store_dwordx4 v[40:43], v244, s[24:27], s42 offen offset:3072 sc1
  v_accvgpr_read_b32 v48, a104
  v_accvgpr_read_b32 v49, a105
  v_accvgpr_read_b32 v50, a106
  v_accvgpr_read_b32 v51, a107
  v_accvgpr_read_b32 v52, a120
  v_accvgpr_read_b32 v53, a121
  v_accvgpr_read_b32 v54, a122
  v_accvgpr_read_b32 v55, a123
  v_mul_f32 v48, v48, v200
  v_mul_f32 v49, v49, v200
  v_mul_f32 v50, v50, v200
  v_mul_f32 v51, v51, v200
  v_mul_f32 v52, v52, v200
  v_mul_f32 v53, v53, v200
  v_mul_f32 v54, v54, v200
  v_mul_f32 v55, v55, v200
  v_cvt_pk_bf16_f32 v48, v48, v49
  v_cvt_pk_bf16_f32 v49, v50, v51
  v_cvt_pk_bf16_f32 v50, v52, v53
  v_cvt_pk_bf16_f32 v51, v54, v55
  buffer_store_dwordx4 v[48:51], v244, s[24:27], s43 offen offset:1024 sc1
  v_accvgpr_read_b32 v56, a108
  v_accvgpr_read_b32 v57, a109
  v_accvgpr_read_b32 v58, a110
  v_accvgpr_read_b32 v59, a111
  v_accvgpr_read_b32 v60, a124
  v_accvgpr_read_b32 v61, a125
  v_accvgpr_read_b32 v62, a126
  v_accvgpr_read_b32 v63, a127
  v_mul_f32 v56, v56, v204
  v_mul_f32 v57, v57, v204
  v_mul_f32 v58, v58, v204
  v_mul_f32 v59, v59, v204
  v_mul_f32 v60, v60, v204
  v_mul_f32 v61, v61, v204
  v_mul_f32 v62, v62, v204
  v_mul_f32 v63, v63, v204
  v_cvt_pk_bf16_f32 v56, v56, v57
  v_cvt_pk_bf16_f32 v57, v58, v59
  v_cvt_pk_bf16_f32 v58, v60, v61
  v_cvt_pk_bf16_f32 v59, v62, v63
  buffer_store_dwordx4 v[56:59], v244, s[24:27], s43 offen offset:3072 sc1
  v_add_u32 v252, 4096, v242
  v_add_u32 v253, 8192, v242
  buffer_load_dwordx4 a[128:131], v253, s[24:27], s4 offen offset:3072 sc1
  buffer_load_dwordx4 a[132:135], v242, s[24:27], s5 offen offset:0 sc1
  buffer_load_dwordx4 a[136:139], v242, s[24:27], s5 offen offset:1024 sc1
  buffer_load_dwordx4 a[140:143], v242, s[24:27], s5 offen offset:2048 sc1
  buffer_load_dwordx4 a[144:147], v242, s[24:27], s5 offen offset:3072 sc1
  buffer_load_dwordx4 a[148:151], v252, s[24:27], s5 offen offset:0 sc1
  buffer_load_dwordx4 a[152:155], v252, s[24:27], s5 offen offset:1024 sc1
  buffer_load_dwordx4 a[156:159], v252, s[24:27], s5 offen offset:2048 sc1
  buffer_load_dwordx4 a[0:3], v252, s[24:27], s5 offen offset:3072 sc1
  buffer_load_dwordx4 a[4:7], v253, s[24:27], s5 offen offset:0 sc1
  buffer_load_dwordx4 a[8:11], v253, s[24:27], s5 offen offset:1024 sc1
  buffer_load_dwordx4 a[12:15], v253, s[24:27], s5 offen offset:2048 sc1
  buffer_load_dwordx4 a[16:19], v253, s[24:27], s5 offen offset:3072 sc1
  buffer_load_dwordx4 a[20:23], v242, s[24:27], s6 offen offset:0 sc1
  buffer_load_dwordx4 a[24:27], v242, s[24:27], s6 offen offset:1024 sc1
  buffer_load_dwordx4 a[28:31], v242, s[24:27], s6 offen offset:2048 sc1
  buffer_load_dwordx4 a[32:35], v242, s[24:27], s6 offen offset:3072 sc1
  buffer_load_dwordx4 a[36:39], v252, s[24:27], s6 offen offset:0 sc1
  s_and_b32 s39, s2, 63
  s_lshl_b32 s39, s39, 7
  s_add_u32 s39, s39, 2867200
  s_lshl_b32 s38, s3, 26
  v_lshlrev_b32 v64, 22, v242
  v_or_b32 v64, s38, v64
  v_mov_b32 v65, 1
  s_waitcnt vmcnt(0)
  s_barrier
  s_branch tail_go
.section .rodata,"a"
.p2align 6
.amdhsa_kernel recurrent_scan__mha_block_cached__moe_arch_mod__prompt_kernel
  .amdhsa_next_free_vgpr 512
  .amdhsa_next_free_sgpr 102
  .amdhsa_accum_offset 256
  .amdhsa_group_segment_fixed_size 0
  .amdhsa_kernarg_size 104
  .amdhsa_user_sgpr_count 2
  .amdhsa_user_sgpr_kernarg_segment_ptr 1
  .amdhsa_system_sgpr_workgroup_id_x 1
.end_amdhsa_kernel
```

```asm
; @launch grid=(256,1,1) block=(256,1,1) lds=163840
.amdgcn_target "amdgcn-amd-amdhsa--gfx950"
.text
.globl recurrent_scan__mha_block_cached__moe_arch_mod__prompt_kernel
.p2align 8
.type recurrent_scan__mha_block_cached__moe_arch_mod__prompt_kernel,@function
recurrent_scan__mha_block_cached__moe_arch_mod__prompt_kernel:
  s_cmp_ge_u32 s2, 256
  s_cbranch_scc1 attn_end
  s_load_dwordx2 s[60:61], s[0:1], 0
  s_load_dwordx2 s[48:49], s[0:1], 48
  s_load_dwordx4 s[4:7], s[0:1], 8
  s_load_dwordx2 s[8:9], s[0:1], 24
  s_load_dwordx2 s[10:11], s[0:1], 96
  s_load_dwordx2 s[88:89], s[0:1], 32
  s_load_dwordx2 s[90:91], s[0:1], 56
  s_load_dwordx4 s[92:95], s[0:1], 64
  s_load_dwordx2 s[62:63], s[0:1], 80
  v_lshrrev_b32 v249, 6, v0
  v_and_b32 v0, 63, v0
  v_mov_b32 v245, v0
  v_readfirstlane_b32 s3, v249
  s_and_b32 s36, s2, 7
  s_lshl_b32 s36, s36, 2
  s_lshr_b32 s37, s2, 6
  s_add_u32 s36, s36, s37
  s_bfe_u32 s37, s2, 196611
  s_lshl_b32 s37, s37, 2
  s_add_u32 s37, s37, s3
  s_lshl_b32 s28, s3, 12
  v_lshrrev_b32 v248, 4, v245
  v_and_b32 v247, 15, v245
  s_lshl_b32 s38, s3, 17
  v_lshlrev_b32 v249, 13, v248
  v_add_u32 v249, s38, v249
  v_or_b32 v250, 0, v248
  v_lshlrev_b32 v250, 1, v250
  v_xor_b32 v250, v250, v247
  v_lshl_add_u32 v238, v250, 4, v249
  v_or_b32 v250, 0, v248
  v_lshlrev_b32 v250, 1, v250
  v_xor_b32 v250, v250, v247
  v_lshl_add_u32 v239, v250, 4, v249
  v_add_u32 v239, 31744, v239
  v_or_b32 v250, 4, v248
  v_lshlrev_b32 v250, 1, v250
  v_xor_b32 v250, v250, v247
  v_lshl_add_u32 v240, v250, 4, v249
  v_add_u32 v240, 63488, v240
  v_or_b32 v250, 4, v248
  v_lshlrev_b32 v250, 1, v250
  v_xor_b32 v250, v250, v247
  v_lshl_add_u32 v241, v250, 4, v249
  v_add_u32 v241, 95232, v241
  s_waitcnt lgkmcnt(0)
  s_add_u32 s58, s10, 2830336
  s_addc_u32 s59, s11, 0
  s_load_dword s59, s[58:59], 0
  s_mov_b32 s24, s10
  s_mov_b32 s25, s11
  s_mov_b32 s26, 29360128
  s_mov_b32 s27, 0x20000
  s_lshl_b32 s38, s36, 8
  s_add_u32 s20, s8, s38
  s_addc_u32 s21, s9, 0
  s_mov_b32 s22, 5242880
  s_mov_b32 s23, 0x20000
  s_sub_u32 s22, s22, s38
  s_cmp_ge_u32 s3, 2
  s_cbranch_scc1 front_fetch
  s_mov_b32 s12, s60
  s_mov_b32 s13, s61
  s_mov_b32 s14, 2621440
  s_mov_b32 s15, 0x20000
  s_mov_b32 s16, s48
  s_mov_b32 s17, s49
  s_mov_b32 s18, 1280
  s_mov_b32 s19, 0x20000
  s_lshr_b32 s52, s37, 2
  s_lshl_b32 s52, s52, 5
  s_add_u32 s52, s52, s36
  s_lshl_b32 s52, s52, 1
  s_add_u32 s52, s52, s3
  s_lshl_b32 s52, s52, 2
  s_mul_i32 s53, s52, 1280
  v_lshrrev_b32 v1, 4, v0
  v_and_b32 v2, 15, v0
  v_lshlrev_b32 v3, 4, v2
  v_mul_u32_u24 v4, 0x500, v1
  v_add_u32 v4, v4, v3
  buffer_load_dwordx4 v[8:11], v4, s[12:15], s53 offen offset:0
  buffer_load_dwordx4 v[12:15], v4, s[12:15], s53 offen offset:256
  buffer_load_dwordx4 v[16:19], v4, s[12:15], s53 offen offset:512
  buffer_load_dwordx4 v[20:23], v4, s[12:15], s53 offen offset:768
  buffer_load_dwordx4 v[24:27], v4, s[12:15], s53 offen offset:1024
  buffer_load_dwordx4 v[28:31], v3, s[16:19], 0 offen offset:0
  buffer_load_dwordx4 v[32:35], v3, s[16:19], 0 offen offset:256
  buffer_load_dwordx4 v[36:39], v3, s[16:19], 0 offen offset:512
  buffer_load_dwordx4 v[40:43], v3, s[16:19], 0 offen offset:768
  buffer_load_dwordx4 v[44:47], v3, s[16:19], 0 offen offset:1024
  v_mov_b32 v7, 0
  v_lshlrev_b32 v6, 26, v0
  s_lshl_b32 s53, s2, 7
  s_add_u32 s53, s53, 2834432
  buffer_store_dword v7, v6, s[24:27], s53 offen sc1
  v_lshlrev_b32 v6, 8, v0
  v_lshrrev_b32 v5, 5, v0
  v_lshl_add_u32 v6, v5, 26, v6
  s_cmp_eq_u32 s2, 0
  s_cselect_b32 s53, 0, 1073741824
  v_or_b32 v6, s53, v6
  s_mov_b32 s53, 2818048
  buffer_store_dword v7, v6, s[24:27], s53 offen sc1
  v_lshlrev_b32 v6, 7, v0
  s_cmp_eq_u32 s2, 1
  s_cselect_b32 s53, 0, 1073741824
  v_or_b32 v6, s53, v6
  s_mov_b32 s53, 2867200
  buffer_store_dword v7, v6, s[24:27], s53 offen sc1
  s_lshr_b32 s53, s52, 6
  s_mul_i32 s53, s53, 81920
  s_bfe_u32 s54, s52, 0x20004
  s_lshl_b32 s54, s54, 10
  s_add_u32 s53, s53, s54
  s_and_b32 s54, s52, 15
  s_lshl_b32 s54, s54, 4
  s_add_u32 s53, s53, s54
  v_lshrrev_b32 v5, 2, v2
  v_lshlrev_b32 v5, 12, v5
  v_and_b32 v6, 3, v2
  v_lshl_add_u32 v5, v6, 8, v5
  v_lshl_add_u32 v5, v1, 4, v5
  s_mov_b32 s56, 0xffff0000
  s_waitcnt vmcnt(12)
  v_lshlrev_b32 v48, 16, v8
  v_and_b32 v49, s56, v8
  v_lshlrev_b32 v50, 16, v9
  v_and_b32 v51, s56, v9
  v_lshlrev_b32 v52, 16, v10
  v_and_b32 v53, s56, v10
  v_lshlrev_b32 v54, 16, v11
  v_and_b32 v55, s56, v11
  s_waitcnt vmcnt(11)
  v_lshlrev_b32 v56, 16, v12
  v_and_b32 v57, s56, v12
  v_lshlrev_b32 v58, 16, v13
  v_and_b32 v59, s56, v13
  v_lshlrev_b32 v60, 16, v14
  v_and_b32 v61, s56, v14
  v_lshlrev_b32 v62, 16, v15
  v_and_b32 v63, s56, v15
  s_waitcnt vmcnt(10)
  v_lshlrev_b32 v64, 16, v16
  v_and_b32 v65, s56, v16
  v_lshlrev_b32 v66, 16, v17
  v_and_b32 v67, s56, v17
  v_lshlrev_b32 v68, 16, v18
  v_and_b32 v69, s56, v18
  v_lshlrev_b32 v70, 16, v19
  v_and_b32 v71, s56, v19
  s_waitcnt vmcnt(9)
  v_lshlrev_b32 v72, 16, v20
  v_and_b32 v73, s56, v20
  v_lshlrev_b32 v74, 16, v21
  v_and_b32 v75, s56, v21
  v_lshlrev_b32 v76, 16, v22
  v_and_b32 v77, s56, v22
  v_lshlrev_b32 v78, 16, v23
  v_and_b32 v79, s56, v23
  s_waitcnt vmcnt(8)
  v_lshlrev_b32 v80, 16, v24
  v_and_b32 v81, s56, v24
  v_lshlrev_b32 v82, 16, v25
  v_and_b32 v83, s56, v25
  v_lshlrev_b32 v84, 16, v26
  v_and_b32 v85, s56, v26
  v_lshlrev_b32 v86, 16, v27
  v_and_b32 v87, s56, v27
  v_pk_add_f32 v[88:89], v[48:49], v[50:51]
  v_pk_add_f32 v[90:91], v[52:53], v[54:55]
  v_pk_add_f32 v[88:89], v[88:89], v[56:57]
  v_pk_add_f32 v[90:91], v[90:91], v[58:59]
  v_pk_add_f32 v[88:89], v[88:89], v[60:61]
  v_pk_add_f32 v[90:91], v[90:91], v[62:63]
  v_pk_add_f32 v[88:89], v[88:89], v[64:65]
  v_pk_add_f32 v[90:91], v[90:91], v[66:67]
  v_pk_add_f32 v[88:89], v[88:89], v[68:69]
  v_pk_add_f32 v[90:91], v[90:91], v[70:71]
  v_pk_add_f32 v[88:89], v[88:89], v[72:73]
  v_pk_add_f32 v[90:91], v[90:91], v[74:75]
  v_pk_add_f32 v[88:89], v[88:89], v[76:77]
  v_pk_add_f32 v[90:91], v[90:91], v[78:79]
  v_pk_add_f32 v[88:89], v[88:89], v[80:81]
  v_pk_add_f32 v[90:91], v[90:91], v[82:83]
  v_pk_add_f32 v[88:89], v[88:89], v[84:85]
  v_pk_add_f32 v[90:91], v[90:91], v[86:87]
  v_pk_add_f32 v[88:89], v[88:89], v[90:91]
  v_add_f32 v92, v88, v89
  s_nop 1
  v_add_f32_dpp v92, v92, v92 row_ror:8 row_mask:0xf bank_mask:0xf
  s_nop 1
  v_add_f32_dpp v92, v92, v92 row_ror:4 row_mask:0xf bank_mask:0xf
  s_nop 1
  v_add_f32_dpp v92, v92, v92 row_ror:2 row_mask:0xf bank_mask:0xf
  s_nop 1
  v_add_f32_dpp v92, v92, v92 row_ror:1 row_mask:0xf bank_mask:0xf
  v_mul_f32 v92, 0x3acccccd, v92
  v_pk_add_f32 v[94:95], v[48:49], v[92:93] op_sel_hi:[1,0] neg_lo:[0,1] neg_hi:[0,1]
  v_pk_mul_f32 v[88:89], v[94:95], v[94:95]
  v_pk_add_f32 v[96:97], v[50:51], v[92:93] op_sel_hi:[1,0] neg_lo:[0,1] neg_hi:[0,1]
  v_pk_mul_f32 v[90:91], v[96:97], v[96:97]
  v_pk_add_f32 v[94:95], v[52:53], v[92:93] op_sel_hi:[1,0] neg_lo:[0,1] neg_hi:[0,1]
  v_pk_fma_f32 v[88:89], v[94:95], v[94:95], v[88:89]
  v_pk_add_f32 v[96:97], v[54:55], v[92:93] op_sel_hi:[1,0] neg_lo:[0,1] neg_hi:[0,1]
  v_pk_fma_f32 v[90:91], v[96:97], v[96:97], v[90:91]
  v_pk_add_f32 v[94:95], v[56:57], v[92:93] op_sel_hi:[1,0] neg_lo:[0,1] neg_hi:[0,1]
  v_pk_fma_f32 v[88:89], v[94:95], v[94:95], v[88:89]
  v_pk_add_f32 v[96:97], v[58:59], v[92:93] op_sel_hi:[1,0] neg_lo:[0,1] neg_hi:[0,1]
  v_pk_fma_f32 v[90:91], v[96:97], v[96:97], v[90:91]
  v_pk_add_f32 v[94:95], v[60:61], v[92:93] op_sel_hi:[1,0] neg_lo:[0,1] neg_hi:[0,1]
  v_pk_fma_f32 v[88:89], v[94:95], v[94:95], v[88:89]
  v_pk_add_f32 v[96:97], v[62:63], v[92:93] op_sel_hi:[1,0] neg_lo:[0,1] neg_hi:[0,1]
  v_pk_fma_f32 v[90:91], v[96:97], v[96:97], v[90:91]
  v_pk_add_f32 v[94:95], v[64:65], v[92:93] op_sel_hi:[1,0] neg_lo:[0,1] neg_hi:[0,1]
  v_pk_fma_f32 v[88:89], v[94:95], v[94:95], v[88:89]
  v_pk_add_f32 v[96:97], v[66:67], v[92:93] op_sel_hi:[1,0] neg_lo:[0,1] neg_hi:[0,1]
  v_pk_fma_f32 v[90:91], v[96:97], v[96:97], v[90:91]
  v_pk_add_f32 v[94:95], v[68:69], v[92:93] op_sel_hi:[1,0] neg_lo:[0,1] neg_hi:[0,1]
  v_pk_fma_f32 v[88:89], v[94:95], v[94:95], v[88:89]
  v_pk_add_f32 v[96:97], v[70:71], v[92:93] op_sel_hi:[1,0] neg_lo:[0,1] neg_hi:[0,1]
  v_pk_fma_f32 v[90:91], v[96:97], v[96:97], v[90:91]
  v_pk_add_f32 v[94:95], v[72:73], v[92:93] op_sel_hi:[1,0] neg_lo:[0,1] neg_hi:[0,1]
  v_pk_fma_f32 v[88:89], v[94:95], v[94:95], v[88:89]
  v_pk_add_f32 v[96:97], v[74:75], v[92:93] op_sel_hi:[1,0] neg_lo:[0,1] neg_hi:[0,1]
  v_pk_fma_f32 v[90:91], v[96:97], v[96:97], v[90:91]
  v_pk_add_f32 v[94:95], v[76:77], v[92:93] op_sel_hi:[1,0] neg_lo:[0,1] neg_hi:[0,1]
  v_pk_fma_f32 v[88:89], v[94:95], v[94:95], v[88:89]
  v_pk_add_f32 v[96:97], v[78:79], v[92:93] op_sel_hi:[1,0] neg_lo:[0,1] neg_hi:[0,1]
  v_pk_fma_f32 v[90:91], v[96:97], v[96:97], v[90:91]
  v_pk_add_f32 v[94:95], v[80:81], v[92:93] op_sel_hi:[1,0] neg_lo:[0,1] neg_hi:[0,1]
  v_pk_fma_f32 v[88:89], v[94:95], v[94:95], v[88:89]
  v_pk_add_f32 v[96:97], v[82:83], v[92:93] op_sel_hi:[1,0] neg_lo:[0,1] neg_hi:[0,1]
  v_pk_fma_f32 v[90:91], v[96:97], v[96:97], v[90:91]
  v_pk_add_f32 v[94:95], v[84:85], v[92:93] op_sel_hi:[1,0] neg_lo:[0,1] neg_hi:[0,1]
  v_pk_fma_f32 v[88:89], v[94:95], v[94:95], v[88:89]
  v_pk_add_f32 v[96:97], v[86:87], v[92:93] op_sel_hi:[1,0] neg_lo:[0,1] neg_hi:[0,1]
  v_pk_fma_f32 v[90:91], v[96:97], v[96:97], v[90:91]
  v_pk_add_f32 v[88:89], v[88:89], v[90:91]
  v_add_f32 v98, v88, v89
  s_nop 1
  v_add_f32_dpp v98, v98, v98 row_ror:8 row_mask:0xf bank_mask:0xf
  v_cvt_pk_bf16_f32 v92, v92, v92
  s_nop 0
  v_add_f32_dpp v98, v98, v98 row_ror:4 row_mask:0xf bank_mask:0xf
  v_lshlrev_b32 v92, 16, v92
  s_nop 0
  v_add_f32_dpp v98, v98, v98 row_ror:2 row_mask:0xf bank_mask:0xf
  s_nop 1
  v_add_f32_dpp v98, v98, v98 row_ror:1 row_mask:0xf bank_mask:0xf
  v_mul_f32 v98, 0x3acccccd, v98
  v_cvt_pk_bf16_f32 v98, v98, v98
  v_pk_add_f32 v[48:49], v[48:49], v[92:93] op_sel_hi:[1,0] neg_lo:[0,1] neg_hi:[0,1]
  v_lshlrev_b32 v98, 16, v98
  v_pk_add_f32 v[50:51], v[50:51], v[92:93] op_sel_hi:[1,0] neg_lo:[0,1] neg_hi:[0,1]
  v_add_f32 v98, 0x3727c5ac, v98
  v_pk_add_f32 v[52:53], v[52:53], v[92:93] op_sel_hi:[1,0] neg_lo:[0,1] neg_hi:[0,1]
  v_cvt_pk_bf16_f32 v98, v98, v98
  v_pk_add_f32 v[54:55], v[54:55], v[92:93] op_sel_hi:[1,0] neg_lo:[0,1] neg_hi:[0,1]
  v_lshlrev_b32 v98, 16, v98
  v_pk_add_f32 v[56:57], v[56:57], v[92:93] op_sel_hi:[1,0] neg_lo:[0,1] neg_hi:[0,1]
  v_sqrt_f32 v98, v98
  v_pk_add_f32 v[58:59], v[58:59], v[92:93] op_sel_hi:[1,0] neg_lo:[0,1] neg_hi:[0,1]
  v_cvt_pk_bf16_f32 v98, v98, v98
  v_pk_add_f32 v[60:61], v[60:61], v[92:93] op_sel_hi:[1,0] neg_lo:[0,1] neg_hi:[0,1]
  v_lshlrev_b32 v98, 16, v98
  v_pk_add_f32 v[62:63], v[62:63], v[92:93] op_sel_hi:[1,0] neg_lo:[0,1] neg_hi:[0,1]
  v_rcp_f32 v100, v98
  v_pk_add_f32 v[64:65], v[64:65], v[92:93] op_sel_hi:[1,0] neg_lo:[0,1] neg_hi:[0,1]
  v_pk_add_f32 v[66:67], v[66:67], v[92:93] op_sel_hi:[1,0] neg_lo:[0,1] neg_hi:[0,1]
  v_pk_add_f32 v[68:69], v[68:69], v[92:93] op_sel_hi:[1,0] neg_lo:[0,1] neg_hi:[0,1]
  v_pk_add_f32 v[70:71], v[70:71], v[92:93] op_sel_hi:[1,0] neg_lo:[0,1] neg_hi:[0,1]
  v_pk_add_f32 v[72:73], v[72:73], v[92:93] op_sel_hi:[1,0] neg_lo:[0,1] neg_hi:[0,1]
  v_pk_add_f32 v[74:75], v[74:75], v[92:93] op_sel_hi:[1,0] neg_lo:[0,1] neg_hi:[0,1]
  v_pk_add_f32 v[76:77], v[76:77], v[92:93] op_sel_hi:[1,0] neg_lo:[0,1] neg_hi:[0,1]
  v_pk_add_f32 v[78:79], v[78:79], v[92:93] op_sel_hi:[1,0] neg_lo:[0,1] neg_hi:[0,1]
  v_pk_add_f32 v[80:81], v[80:81], v[92:93] op_sel_hi:[1,0] neg_lo:[0,1] neg_hi:[0,1]
  v_pk_add_f32 v[82:83], v[82:83], v[92:93] op_sel_hi:[1,0] neg_lo:[0,1] neg_hi:[0,1]
  v_pk_add_f32 v[84:85], v[84:85], v[92:93] op_sel_hi:[1,0] neg_lo:[0,1] neg_hi:[0,1]
  v_pk_add_f32 v[86:87], v[86:87], v[92:93] op_sel_hi:[1,0] neg_lo:[0,1] neg_hi:[0,1]
  v_mov_b32 v104, 0
  v_mov_b32 v105, 0
  v_cvt_pk_bf16_f32 v8, v48, v49
  v_cvt_pk_bf16_f32 v9, v50, v51
  v_cvt_pk_bf16_f32 v10, v52, v53
  v_cvt_pk_bf16_f32 v11, v54, v55
  v_cvt_pk_bf16_f32 v12, v56, v57
  v_cvt_pk_bf16_f32 v13, v58, v59
  v_cvt_pk_bf16_f32 v14, v60, v61
  v_cvt_pk_bf16_f32 v15, v62, v63
  v_cvt_pk_bf16_f32 v16, v64, v65
  v_cvt_pk_bf16_f32 v17, v66, v67
  v_cvt_pk_bf16_f32 v18, v68, v69
  v_cvt_pk_bf16_f32 v19, v70, v71
  v_cvt_pk_bf16_f32 v20, v72, v73
  v_cvt_pk_bf16_f32 v21, v74, v75
  v_cvt_pk_bf16_f32 v22, v76, v77
  v_cvt_pk_bf16_f32 v23, v78, v79
  v_cvt_pk_bf16_f32 v24, v80, v81
  v_cvt_pk_bf16_f32 v25, v82, v83
  v_cvt_pk_bf16_f32 v26, v84, v85
  v_cvt_pk_bf16_f32 v27, v86, v87
  v_lshlrev_b32 v48, 16, v8
  v_and_b32 v49, s56, v8
  v_lshlrev_b32 v50, 16, v9
  v_and_b32 v51, s56, v9
  v_lshlrev_b32 v52, 16, v10
  v_and_b32 v53, s56, v10
  v_lshlrev_b32 v54, 16, v11
  v_and_b32 v55, s56, v11
  v_lshlrev_b32 v56, 16, v12
  v_and_b32 v57, s56, v12
  v_lshlrev_b32 v58, 16, v13
  v_and_b32 v59, s56, v13
  v_lshlrev_b32 v60, 16, v14
  v_and_b32 v61, s56, v14
  v_lshlrev_b32 v62, 16, v15
  v_and_b32 v63, s56, v15
  v_lshlrev_b32 v64, 16, v16
  v_and_b32 v65, s56, v16
  v_lshlrev_b32 v66, 16, v17
  v_and_b32 v67, s56, v17
  v_lshlrev_b32 v68, 16, v18
  v_and_b32 v69, s56, v18
  v_lshlrev_b32 v70, 16, v19
  v_and_b32 v71, s56, v19
  v_lshlrev_b32 v72, 16, v20
  v_and_b32 v73, s56, v20
  v_lshlrev_b32 v74, 16, v21
  v_and_b32 v75, s56, v21
  v_lshlrev_b32 v76, 16, v22
  v_and_b32 v77, s56, v22
  v_lshlrev_b32 v78, 16, v23
  v_and_b32 v79, s56, v23
  v_lshlrev_b32 v80, 16, v24
  v_and_b32 v81, s56, v24
  v_lshlrev_b32 v82, 16, v25
  v_and_b32 v83, s56, v25
  v_lshlrev_b32 v84, 16, v26
  v_and_b32 v85, s56, v26
  v_lshlrev_b32 v86, 16, v27
  v_and_b32 v87, s56, v27
  v_pk_mul_f32 v[48:49], v[48:49], v[100:101] op_sel_hi:[1,0]
  v_pk_mul_f32 v[50:51], v[50:51], v[100:101] op_sel_hi:[1,0]
  v_pk_mul_f32 v[52:53], v[52:53], v[100:101] op_sel_hi:[1,0]
  v_pk_mul_f32 v[54:55], v[54:55], v[100:101] op_sel_hi:[1,0]
  v_cvt_pk_bf16_f32 v8, v48, v49
  v_cvt_pk_bf16_f32 v9, v50, v51
  v_cvt_pk_bf16_f32 v10, v52, v53
  v_cvt_pk_bf16_f32 v11, v54, v55
  buffer_store_dwordx4 v[8:11], v5, s[24:27], s53 offen sc1
  s_add_u32 s53, s53, 16384
  v_pk_mul_f32 v[56:57], v[56:57], v[100:101] op_sel_hi:[1,0]
  v_pk_mul_f32 v[58:59], v[58:59], v[100:101] op_sel_hi:[1,0]
  v_pk_mul_f32 v[60:61], v[60:61], v[100:101] op_sel_hi:[1,0]
  v_pk_mul_f32 v[62:63], v[62:63], v[100:101] op_sel_hi:[1,0]
  v_cvt_pk_bf16_f32 v12, v56, v57
  v_cvt_pk_bf16_f32 v13, v58, v59
  v_cvt_pk_bf16_f32 v14, v60, v61
  v_cvt_pk_bf16_f32 v15, v62, v63
  buffer_store_dwordx4 v[12:15], v5, s[24:27], s53 offen sc1
  s_add_u32 s53, s53, 16384
  v_pk_mul_f32 v[64:65], v[64:65], v[100:101] op_sel_hi:[1,0]
  v_pk_mul_f32 v[66:67], v[66:67], v[100:101] op_sel_hi:[1,0]
  v_pk_mul_f32 v[68:69], v[68:69], v[100:101] op_sel_hi:[1,0]
  v_pk_mul_f32 v[70:71], v[70:71], v[100:101] op_sel_hi:[1,0]
  v_cvt_pk_bf16_f32 v16, v64, v65
  v_cvt_pk_bf16_f32 v17, v66, v67
  v_cvt_pk_bf16_f32 v18, v68, v69
  v_cvt_pk_bf16_f32 v19, v70, v71
  buffer_store_dwordx4 v[16:19], v5, s[24:27], s53 offen sc1
  s_add_u32 s53, s53, 16384
  v_pk_mul_f32 v[72:73], v[72:73], v[100:101] op_sel_hi:[1,0]
  v_pk_mul_f32 v[74:75], v[74:75], v[100:101] op_sel_hi:[1,0]
  v_pk_mul_f32 v[76:77], v[76:77], v[100:101] op_sel_hi:[1,0]
  v_pk_mul_f32 v[78:79], v[78:79], v[100:101] op_sel_hi:[1,0]
  v_cvt_pk_bf16_f32 v20, v72, v73
  v_cvt_pk_bf16_f32 v21, v74, v75
  v_cvt_pk_bf16_f32 v22, v76, v77
  v_cvt_pk_bf16_f32 v23, v78, v79
  buffer_store_dwordx4 v[20:23], v5, s[24:27], s53 offen sc1
  s_add_u32 s53, s53, 16384
  v_pk_mul_f32 v[80:81], v[80:81], v[100:101] op_sel_hi:[1,0]
  v_pk_mul_f32 v[82:83], v[82:83], v[100:101] op_sel_hi:[1,0]
  v_pk_mul_f32 v[84:85], v[84:85], v[100:101] op_sel_hi:[1,0]
  v_pk_mul_f32 v[86:87], v[86:87], v[100:101] op_sel_hi:[1,0]
  v_cvt_pk_bf16_f32 v24, v80, v81
  v_cvt_pk_bf16_f32 v25, v82, v83
  v_cvt_pk_bf16_f32 v26, v84, v85
  v_cvt_pk_bf16_f32 v27, v86, v87
  buffer_store_dwordx4 v[24:27], v5, s[24:27], s53 offen sc1
  s_add_u32 s53, s53, 16384
  s_waitcnt vmcnt(12)
  v_dot2_f32_bf16 v104, v8, v28, v104
  v_dot2_f32_bf16 v105, v9, v29, v105
  v_dot2_f32_bf16 v104, v10, v30, v104
  v_dot2_f32_bf16 v105, v11, v31, v105
  s_waitcnt vmcnt(11)
  v_dot2_f32_bf16 v104, v12, v32, v104
  v_dot2_f32_bf16 v105, v13, v33, v105
  v_dot2_f32_bf16 v104, v14, v34, v104
  v_dot2_f32_bf16 v105, v15, v35, v105
  s_waitcnt vmcnt(10)
  v_dot2_f32_bf16 v104, v16, v36, v104
  v_dot2_f32_bf16 v105, v17, v37, v105
  v_dot2_f32_bf16 v104, v18, v38, v104
  v_dot2_f32_bf16 v105, v19, v39, v105
  s_waitcnt vmcnt(9)
  v_dot2_f32_bf16 v104, v20, v40, v104
  v_dot2_f32_bf16 v105, v21, v41, v105
  v_dot2_f32_bf16 v104, v22, v42, v104
  v_dot2_f32_bf16 v105, v23, v43, v105
  s_waitcnt vmcnt(8)
  v_dot2_f32_bf16 v104, v24, v44, v104
  v_dot2_f32_bf16 v105, v25, v45, v105
  v_dot2_f32_bf16 v104, v26, v46, v104
  v_dot2_f32_bf16 v105, v27, v47, v105
  s_nop 2
  v_add_f32 v104, v104, v105
  s_nop 1
  v_add_f32_dpp v104, v104, v104 row_ror:8 row_mask:0xf bank_mask:0xf
  s_nop 1
  v_add_f32_dpp v104, v104, v104 row_ror:4 row_mask:0xf bank_mask:0xf
  s_nop 1
  v_add_f32_dpp v104, v104, v104 row_ror:2 row_mask:0xf bank_mask:0xf
  s_nop 1
  v_add_f32_dpp v104, v104, v104 row_ror:1 row_mask:0xf bank_mask:0xf
  v_cvt_pk_bf16_f32 v104, v104, v104
  v_lshlrev_b32 v104, 16, v104
  v_ashrrev_i32 v105, 31, v104
  v_or_b32 v105, 0x80000000, v105
  v_xor_b32 v104, v104, v105
  v_and_b32 v104, s56, v104
  v_add_u32 v6, s52, v1
  v_sub_u32 v7, 0xffff, v6
  v_or_b32 v104, v104, v7
  v_lshlrev_b32 v6, 2, v6
  v_lshl_add_u32 v6, v2, 26, v6
  s_mov_b32 s53, 2621440
  buffer_store_dword v104, v6, s[24:27], s53 offen sc1
  s_waitcnt vmcnt(0)
  s_branch front_join
front_fetch:
  s_getpc_b64 s[98:99]
attn_hot_pc:
  s_add_u32 s98, s98, attn_hot-attn_hot_pc
  s_addc_u32 s99, s99, 0
  s_lshr_b32 s100, s2, 3
  v_min_u32 v249, 17, v0
  v_lshlrev_b32 v249, 5, v249
  v_add_u32 v249, s100, v249
  v_lshlrev_b32 v249, 7, v249
  v_min_u32 v249, attn_end-attn_hot-4, v249
  global_load_dword v255, v249, s[98:99]
attn_hot:
  v_subrev_u32 v16, 0x40000, v238
  v_subrev_u32 v17, 0x40000, v239
  v_subrev_u32 v18, 0x40000, v240
  v_subrev_u32 v19, 0x40000, v241
  s_mov_b32 s31, 0
  s_add_u32 m0, s28, 90112
  s_nop 0
  buffer_load_dwordx4 v16, s[20:23], s31 offen offset:0 lds
  buffer_load_dwordx4 v17, s[20:23], s31 offen offset:1024 lds
  buffer_load_dwordx4 v18, s[20:23], s31 offen offset:2048 lds
  buffer_load_dwordx4 v19, s[20:23], s31 offen offset:3072 lds
  s_add_u32 m0, s28, 98304
  s_nop 0
  buffer_load_dwordx4 v238, s[20:23], s31 offen offset:0 lds
  buffer_load_dwordx4 v239, s[20:23], s31 offen offset:1024 lds
  buffer_load_dwordx4 v240, s[20:23], s31 offen offset:2048 lds
  buffer_load_dwordx4 v241, s[20:23], s31 offen offset:3072 lds
front_join:
  s_waitcnt lgkmcnt(0)
  s_barrier
  s_mul_i32 s55, s59, 0x9e3779b1
  s_add_u32 s55, s55, 0x7f4a7c15
  s_lshr_b32 s58, s37, 2
  s_lshl_b32 s58, s58, 8
  s_add_u32 s58, s58, 2826240
  s_lshl_b32 s53, s36, 2
  s_lshl_b32 s54, s3, 26
  s_add_u32 s53, s53, s54
  v_min_u32 v1, 1, v0
  v_lshlrev_b32 v1, 28, v1
  v_add_u32 v1, s53, v1
  v_mov_b32 v2, s55
  buffer_store_dword v2, v1, s[24:27], s58 offen sc1
  s_cmp_lt_u32 s3, 2
  s_cbranch_scc1 front_addr
  s_mov_b32 s31, 524288
  s_add_u32 m0, s28, 106496
  s_nop 0
  buffer_load_dwordx4 v16, s[20:23], s31 offen offset:0 lds
  buffer_load_dwordx4 v17, s[20:23], s31 offen offset:1024 lds
  buffer_load_dwordx4 v18, s[20:23], s31 offen offset:2048 lds
  buffer_load_dwordx4 v19, s[20:23], s31 offen offset:3072 lds
  s_add_u32 m0, s28, 114688
  s_nop 0
  buffer_load_dwordx4 v238, s[20:23], s31 offen offset:0 lds
  buffer_load_dwordx4 v239, s[20:23], s31 offen offset:1024 lds
  buffer_load_dwordx4 v240, s[20:23], s31 offen offset:2048 lds
  buffer_load_dwordx4 v241, s[20:23], s31 offen offset:3072 lds
  s_mov_b32 s31, 1048576
  s_add_u32 m0, s28, 24576
  s_nop 0
  buffer_load_dwordx4 v16, s[20:23], s31 offen offset:0 lds
  buffer_load_dwordx4 v17, s[20:23], s31 offen offset:1024 lds
  buffer_load_dwordx4 v18, s[20:23], s31 offen offset:2048 lds
  buffer_load_dwordx4 v19, s[20:23], s31 offen offset:3072 lds
  s_add_u32 m0, s28, 32768
  s_nop 0
  buffer_load_dwordx4 v238, s[20:23], s31 offen offset:0 lds
  buffer_load_dwordx4 v239, s[20:23], s31 offen offset:1024 lds
  buffer_load_dwordx4 v240, s[20:23], s31 offen offset:2048 lds
  buffer_load_dwordx4 v241, s[20:23], s31 offen offset:3072 lds
  s_mov_b32 s31, 1572864
  s_add_u32 m0, s28, 40960
  s_nop 0
  buffer_load_dwordx4 v16, s[20:23], s31 offen offset:0 lds
  buffer_load_dwordx4 v17, s[20:23], s31 offen offset:1024 lds
  buffer_load_dwordx4 v18, s[20:23], s31 offen offset:2048 lds
  buffer_load_dwordx4 v19, s[20:23], s31 offen offset:3072 lds
  s_add_u32 m0, s28, 49152
  s_nop 0
  buffer_load_dwordx4 v238, s[20:23], s31 offen offset:0 lds
  buffer_load_dwordx4 v239, s[20:23], s31 offen offset:1024 lds
  buffer_load_dwordx4 v240, s[20:23], s31 offen offset:2048 lds
  buffer_load_dwordx4 v241, s[20:23], s31 offen offset:3072 lds
front_addr:
  s_mov_b32 s31, 2097152
  v_lshlrev_b32 v242, 4, v245
  v_add_u32 v243, 0x1000, v242
  s_mul_i32 s30, s37, 81920
  s_lshl_b32 s38, s36, 19
  s_add_u32 s12, s4, s38
  s_addc_u32 s13, s5, 0
  s_mov_b32 s14, 524288
  s_mov_b32 s15, 0x20000
  s_add_u32 s16, s6, s38
  s_addc_u32 s17, s7, 0
  s_mov_b32 s18, 524288
  s_mov_b32 s19, 0x20000
  v_lshlrev_b32 v249, 8, v248
  v_add_u32 v249, s28, v249
  v_add_u32 v250, 0, v248
  v_xor_b32 v250, v250, v247
  v_lshl_add_u32 v232, v250, 4, v249
  v_add_u32 v250, 4, v248
  v_xor_b32 v250, v250, v247
  v_lshl_add_u32 v233, v250, 4, v249
  v_add_u32 v250, 8, v248
  v_xor_b32 v250, v250, v247
  v_lshl_add_u32 v234, v250, 4, v249
  v_add_u32 v250, 12, v248
  v_xor_b32 v250, v250, v247
  v_lshl_add_u32 v235, v250, 4, v249
  v_add_u32 v250, 0, v248
  v_lshlrev_b32 v250, 1, v250
  v_xor_b32 v250, v250, v247
  v_lshl_add_u32 v236, v250, 4, v249
  v_add_u32 v250, 4, v248
  v_lshlrev_b32 v250, 1, v250
  v_xor_b32 v250, v250, v247
  v_lshl_add_u32 v237, v250, 4, v249
  v_lshrrev_b32 v249, 1, v248
  v_and_b32 v250, 1, v248
  v_lshl_or_b32 v249, v250, 1, v249
  v_xor_b32 v249, v249, v247
  v_lshlrev_b32 v249, 4, v249
  v_lshl_add_u32 v212, v247, 8, v249
  v_xor_b32 v213, 64, v212
  v_xor_b32 v214, 128, v212
  v_xor_b32 v215, 192, v212
  v_bfe_u32 v246, v245, 2, 2
  v_and_b32 v247, 3, v245
  v_lshlrev_b32 v247, 3, v247
  v_add_u32 v247, 65536, v247
  v_lshl_add_u32 v249, v248, 2, v246
  v_and_b32 v250, 7, v249
  v_lshl_add_u32 v250, v250, 5, v247
  v_lshl_add_u32 v216, v249, 8, v250
  v_lshl_add_u32 v249, v248, 3, v246
  v_and_b32 v250, 1, v248
  v_lshl_add_u32 v250, v250, 2, v246
  v_lshl_add_u32 v250, v250, 5, v247
  v_lshl_add_u32 v224, v249, 8, v250
  v_xor_b32 v217, 32, v216
  v_xor_b32 v225, 32, v224
  v_xor_b32 v218, 64, v216
  v_xor_b32 v226, 64, v224
  v_xor_b32 v219, 96, v216
  v_xor_b32 v227, 96, v224
  v_xor_b32 v220, 128, v216
  v_xor_b32 v228, 128, v224
  v_xor_b32 v221, 160, v216
  v_xor_b32 v229, 160, v224
  v_xor_b32 v222, 192, v216
  v_xor_b32 v230, 192, v224
  v_xor_b32 v223, 224, v216
  v_xor_b32 v231, 224, v224
  v_subrev_u32 v148, 65536, v224
  v_subrev_u32 v149, 65536, v225
  v_subrev_u32 v150, 65536, v226
  v_subrev_u32 v151, 65536, v227
  v_subrev_u32 v152, 65536, v228
  v_subrev_u32 v153, 65536, v229
  v_subrev_u32 v154, 65536, v230
  v_subrev_u32 v155, 65536, v231
  s_lshr_b32 s38, s2, 3
  s_min_u32 s38, s38, 26
  s_and_b32 s39, s2, 7
  s_mul_i32 s39, s39, 27
  s_add_u32 s33, s38, s39
  s_mul_i32 s50, s3, 6144
  s_add_u32 s50, s50, 133120
  v_mov_b32 v244, v242
  s_lshl_b32 s40, s37, 19
  s_lshl_b32 s38, s36, 14
  s_add_u32 s40, s40, s38
  s_add_u32 s40, s40, 8388608
  s_add_u32 s41, s40, 4096
  s_add_u32 s42, s40, 8192
  s_add_u32 s43, s40, 12288
  s_mov_b32 s34, 0x3e0293ee
  s_mov_b32 s29, 0
  v_and_b32 v249, 15, v245
  v_cmp_eq_u32 vcc, 0, v249
  v_mov_b32 v249, 0x3f803f80
  s_nop 0
  v_cndmask_b32 v249, 0, v249, vcc
  v_accvgpr_write_b32 a208, v249
  v_accvgpr_write_b32 a209, v249
  v_accvgpr_write_b32 a210, v249
  v_accvgpr_write_b32 a211, v249
  v_and_b32 v2, 7, v0
  v_lshlrev_b32 v2, 2, v2
  s_lshl_b32 s54, s3, 5
  v_add_u32 v2, s54, v2
  s_mov_b32 s54, 32768
  buffer_load_dword v3, v2, s[24:27], s58 offen sc1
  s_sleep 2
  buffer_load_dword v4, v2, s[24:27], s58 offen sc1
  s_sleep 2
  buffer_load_dword v5, v2, s[24:27], s58 offen sc1
  s_sleep 2
front_poll:
  buffer_load_dword v6, v2, s[24:27], s58 offen sc1
  s_waitcnt vmcnt(3)
  v_cmp_ne_u32 vcc, s55, v3
  s_nop 0
  s_cbranch_vccz front_go
  s_sleep 2
  buffer_load_dword v3, v2, s[24:27], s58 offen sc1
  s_waitcnt vmcnt(3)
  v_cmp_ne_u32 vcc, s55, v4
  s_nop 0
  s_cbranch_vccz front_go
  s_sleep 2
  buffer_load_dword v4, v2, s[24:27], s58 offen sc1
  s_waitcnt vmcnt(3)
  v_cmp_ne_u32 vcc, s55, v5
  s_nop 0
  s_cbranch_vccz front_go
  s_sleep 2
  buffer_load_dword v5, v2, s[24:27], s58 offen sc1
  s_waitcnt vmcnt(3)
  v_cmp_ne_u32 vcc, s55, v6
  s_nop 0
  s_cbranch_vccz front_go
  s_sleep 2
  s_sub_u32 s54, s54, 1
  s_cmp_lg_u32 s54, 0
  s_cbranch_scc1 front_poll
front_go:
  buffer_load_dwordx4 a[0:3], v242, s[24:27], s30 offen offset:0 sc1
  buffer_load_dwordx4 a[4:7], v242, s[24:27], s30 offen offset:1024 sc1
  buffer_load_dwordx4 a[8:11], v242, s[24:27], s30 offen offset:2048 sc1
  buffer_load_dwordx4 a[12:15], v242, s[24:27], s30 offen offset:3072 sc1
  buffer_load_dwordx4 a[16:19], v243, s[24:27], s30 offen offset:0 sc1
  buffer_load_dwordx4 a[20:23], v243, s[24:27], s30 offen offset:1024 sc1
  buffer_load_dwordx4 a[24:27], v243, s[24:27], s30 offen offset:2048 sc1
  buffer_load_dwordx4 a[28:31], v243, s[24:27], s30 offen offset:3072 sc1
  s_add_u32 s30, s30, 8192
  buffer_load_dwordx4 a[32:35], v242, s[24:27], s30 offen offset:0 sc1
  buffer_load_dwordx4 a[36:39], v242, s[24:27], s30 offen offset:1024 sc1
  buffer_load_dwordx4 a[40:43], v242, s[24:27], s30 offen offset:2048 sc1
  buffer_load_dwordx4 a[44:47], v242, s[24:27], s30 offen offset:3072 sc1
  buffer_load_dwordx4 a[48:51], v243, s[24:27], s30 offen offset:0 sc1
  buffer_load_dwordx4 a[52:55], v243, s[24:27], s30 offen offset:1024 sc1
  buffer_load_dwordx4 a[56:59], v243, s[24:27], s30 offen offset:2048 sc1
  buffer_load_dwordx4 a[60:63], v243, s[24:27], s30 offen offset:3072 sc1
  s_add_u32 s30, s30, 8192
  v_lshrrev_b32 v140, 7, v242
  v_lshlrev_b32 v140, 8, v140
  v_and_b32 v136, 0x70, v242
  v_add_u32 v140, v140, v136
  s_mov_b32 s58, 2826240
  buffer_load_dwordx4 v[136:139], v140, s[24:27], s58 offen sc1
  s_barrier
  ds_read_b64_tr_b16 a[160:161], v224 offset:32768
  ds_read_b64_tr_b16 a[162:163], v224 offset:33792
  ds_read_b64_tr_b16 a[164:165], v224 offset:40960
  ds_read_b64_tr_b16 a[166:167], v224 offset:41984
  ds_read_b64_tr_b16 a[168:169], v225 offset:32768
  ds_read_b64_tr_b16 a[170:171], v225 offset:33792
  ds_read_b64_tr_b16 a[172:173], v225 offset:40960
  ds_read_b64_tr_b16 a[174:175], v225 offset:41984
  s_waitcnt vmcnt(9) lgkmcnt(4)
  v_mfma_f32_16x16x32_bf16 v[0:3], a[160:163], a[0:3], 0
  ds_read_b64_tr_b16 a[176:177], v226 offset:32768
  v_mfma_f32_16x16x32_bf16 v[0:3], a[164:167], a[16:19], v[0:3]
  buffer_load_dwordx4 a[64:67], v242, s[24:27], s30 offen offset:0 sc1
  v_mfma_f32_16x16x32_bf16 v[4:7], a[164:167], a[20:23], 0
  ds_read_b64_tr_b16 a[178:179], v226 offset:33792
  v_mfma_f32_16x16x32_bf16 v[4:7], a[160:163], a[4:7], v[4:7]
  buffer_load_dwordx4 a[68:71], v242, s[24:27], s30 offen offset:1024 sc1
  v_mfma_f32_16x16x32_bf16 v[8:11], a[160:163], a[8:11], 0
  ds_read_b64_tr_b16 a[180:181], v226 offset:40960
  v_mfma_f32_16x16x32_bf16 v[8:11], a[164:167], a[24:27], v[8:11]
  v_mfma_f32_16x16x32_bf16 v[12:15], a[164:167], a[28:31], 0
  ds_read_b64_tr_b16 a[182:183], v226 offset:41984
  v_mfma_f32_16x16x32_bf16 v[12:15], a[160:163], a[12:15], v[12:15]
  s_waitcnt lgkmcnt(4)
  buffer_load_dwordx4 a[72:75], v242, s[24:27], s30 offen offset:2048 sc1
  v_mfma_f32_16x16x32_bf16 v[16:19], a[168:171], a[0:3], 0
  ds_read_b64_tr_b16 a[184:185], v227 offset:32768
  v_mfma_f32_16x16x32_bf16 v[16:19], a[172:175], a[16:19], v[16:19]
  v_mfma_f32_16x16x32_bf16 v[20:23], a[172:175], a[20:23], 0
  ds_read_b64_tr_b16 a[186:187], v227 offset:33792
  v_mfma_f32_16x16x32_bf16 v[20:23], a[168:171], a[4:7], v[20:23]
  buffer_load_dwordx4 a[76:79], v242, s[24:27], s30 offen offset:3072 sc1
  v_mfma_f32_16x16x32_bf16 v[24:27], a[168:171], a[8:11], 0
  ds_read_b64_tr_b16 a[188:189], v227 offset:40960
  v_mfma_f32_16x16x32_bf16 v[24:27], a[172:175], a[24:27], v[24:27]
  buffer_load_dwordx4 a[80:83], v243, s[24:27], s30 offen offset:0 sc1
  v_mfma_f32_16x16x32_bf16 v[28:31], a[172:175], a[28:31], 0
  ds_read_b64_tr_b16 a[190:191], v227 offset:41984
  v_mfma_f32_16x16x32_bf16 v[28:31], a[168:171], a[12:15], v[28:31]
  s_waitcnt lgkmcnt(4)
  v_mfma_f32_16x16x32_bf16 v[32:35], a[176:179], a[0:3], 0
  ds_read_b64_tr_b16 a[160:161], v228 offset:32768
  v_mfma_f32_16x16x32_bf16 v[32:35], a[180:183], a[16:19], v[32:35]
  buffer_load_dwordx4 a[84:87], v243, s[24:27], s30 offen offset:1024 sc1
  v_mfma_f32_16x16x32_bf16 v[36:39], a[180:183], a[20:23], 0
  ds_read_b64_tr_b16 a[162:163], v228 offset:33792
  v_mfma_f32_16x16x32_bf16 v[36:39], a[176:179], a[4:7], v[36:39]
  v_mfma_f32_16x16x32_bf16 v[40:43], a[176:179], a[8:11], 0
  ds_read_b64_tr_b16 a[164:165], v228 offset:40960
  v_mfma_f32_16x16x32_bf16 v[40:43], a[180:183], a[24:27], v[40:43]
  buffer_load_dwordx4 a[88:91], v243, s[24:27], s30 offen offset:2048 sc1
  v_mfma_f32_16x16x32_bf16 v[44:47], a[180:183], a[28:31], 0
  ds_read_b64_tr_b16 a[166:167], v228 offset:41984
  v_mfma_f32_16x16x32_bf16 v[44:47], a[176:179], a[12:15], v[44:47]
  s_waitcnt lgkmcnt(4)
  buffer_load_dwordx4 a[92:95], v243, s[24:27], s30 offen offset:3072 sc1
  v_mfma_f32_16x16x32_bf16 v[48:51], a[184:187], a[0:3], 0
  ds_read_b64_tr_b16 a[168:169], v229 offset:32768
  v_mfma_f32_16x16x32_bf16 v[48:51], a[188:191], a[16:19], v[48:51]
  v_mfma_f32_16x16x32_bf16 v[52:55], a[188:191], a[20:23], 0
  ds_read_b64_tr_b16 a[170:171], v229 offset:33792
  v_mfma_f32_16x16x32_bf16 v[52:55], a[184:187], a[4:7], v[52:55]
  s_add_u32 s30, s30, 8192
  v_mfma_f32_16x16x32_bf16 v[56:59], a[184:187], a[8:11], 0
  ds_read_b64_tr_b16 a[172:173], v229 offset:40960
  v_mfma_f32_16x16x32_bf16 v[56:59], a[188:191], a[24:27], v[56:59]
  v_mfma_f32_16x16x32_bf16 v[60:63], a[188:191], a[28:31], 0
  ds_read_b64_tr_b16 a[174:175], v229 offset:41984
  v_mfma_f32_16x16x32_bf16 v[60:63], a[184:187], a[12:15], v[60:63]
  s_waitcnt lgkmcnt(4)
  buffer_load_dwordx4 a[96:99], v242, s[24:27], s30 offen offset:0 sc1
  v_mfma_f32_16x16x32_bf16 v[64:67], a[160:163], a[0:3], 0
  ds_read_b64_tr_b16 a[176:177], v230 offset:32768
  v_mfma_f32_16x16x32_bf16 v[64:67], a[164:167], a[16:19], v[64:67]
  buffer_load_dwordx4 a[100:103], v242, s[24:27], s30 offen offset:1024 sc1
  v_mfma_f32_16x16x32_bf16 v[68:71], a[164:167], a[20:23], 0
  ds_read_b64_tr_b16 a[178:179], v230 offset:33792
  v_mfma_f32_16x16x32_bf16 v[68:71], a[160:163], a[4:7], v[68:71]
  v_mfma_f32_16x16x32_bf16 v[72:75], a[160:163], a[8:11], 0
  ds_read_b64_tr_b16 a[180:181], v230 offset:40960
  v_mfma_f32_16x16x32_bf16 v[72:75], a[164:167], a[24:27], v[72:75]
  buffer_load_dwordx4 a[104:107], v242, s[24:27], s30 offen offset:2048 sc1
  v_mfma_f32_16x16x32_bf16 v[76:79], a[164:167], a[28:31], 0
  ds_read_b64_tr_b16 a[182:183], v230 offset:41984
  v_mfma_f32_16x16x32_bf16 v[76:79], a[160:163], a[12:15], v[76:79]
  s_waitcnt lgkmcnt(4)
  v_mfma_f32_16x16x32_bf16 v[80:83], a[168:171], a[0:3], 0
  ds_read_b64_tr_b16 a[184:185], v231 offset:32768
  v_mfma_f32_16x16x32_bf16 v[80:83], a[172:175], a[16:19], v[80:83]
  buffer_load_dwordx4 a[108:111], v242, s[24:27], s30 offen offset:3072 sc1
  v_mfma_f32_16x16x32_bf16 v[84:87], a[172:175], a[20:23], 0
  ds_read_b64_tr_b16 a[186:187], v231 offset:33792
  v_mfma_f32_16x16x32_bf16 v[84:87], a[168:171], a[4:7], v[84:87]
  buffer_load_dwordx4 a[112:115], v243, s[24:27], s30 offen offset:0 sc1
  v_mfma_f32_16x16x32_bf16 v[88:91], a[168:171], a[8:11], 0
  ds_read_b64_tr_b16 a[188:189], v231 offset:40960
  v_mfma_f32_16x16x32_bf16 v[88:91], a[172:175], a[24:27], v[88:91]
  s_barrier
  v_mfma_f32_16x16x32_bf16 v[92:95], a[172:175], a[28:31], 0
  ds_read_b64_tr_b16 a[190:191], v231 offset:41984
  v_mfma_f32_16x16x32_bf16 v[92:95], a[168:171], a[12:15], v[92:95]
  s_waitcnt lgkmcnt(4)
  buffer_load_dwordx4 a[116:119], v243, s[24:27], s30 offen offset:1024 sc1
  v_mfma_f32_16x16x32_bf16 v[96:99], a[176:179], a[0:3], 0
  ds_read_b64_tr_b16 a[160:161], v224 offset:49152
  v_mfma_f32_16x16x32_bf16 v[96:99], a[180:183], a[16:19], v[96:99]
  v_mfma_f32_16x16x32_bf16 v[100:103], a[180:183], a[20:23], 0
  ds_read_b64_tr_b16 a[162:163], v224 offset:50176
  v_mfma_f32_16x16x32_bf16 v[100:103], a[176:179], a[4:7], v[100:103]
  buffer_load_dwordx4 a[120:123], v243, s[24:27], s30 offen offset:2048 sc1
  v_mfma_f32_16x16x32_bf16 v[104:107], a[176:179], a[8:11], 0
  ds_read_b64_tr_b16 a[164:165], v224 offset:57344
  v_mfma_f32_16x16x32_bf16 v[104:107], a[180:183], a[24:27], v[104:107]
  buffer_load_dwordx4 a[124:127], v243, s[24:27], s30 offen offset:3072 sc1
  v_mfma_f32_16x16x32_bf16 v[108:111], a[180:183], a[28:31], 0
  ds_read_b64_tr_b16 a[166:167], v224 offset:58368
  v_mfma_f32_16x16x32_bf16 v[108:111], a[176:179], a[12:15], v[108:111]
  s_waitcnt lgkmcnt(4)
  v_mfma_f32_16x16x32_bf16 v[112:115], a[184:187], a[0:3], 0
  ds_read_b64_tr_b16 a[168:169], v225 offset:49152
  v_mfma_f32_16x16x32_bf16 v[112:115], a[188:191], a[16:19], v[112:115]
  s_add_u32 s30, s30, 8192
  v_mfma_f32_16x16x32_bf16 v[116:119], a[188:191], a[20:23], 0
  ds_read_b64_tr_b16 a[170:171], v225 offset:50176
  v_mfma_f32_16x16x32_bf16 v[116:119], a[184:187], a[4:7], v[116:119]
  v_mfma_f32_16x16x32_bf16 v[120:123], a[184:187], a[8:11], 0
  ds_read_b64_tr_b16 a[172:173], v225 offset:57344
  v_mfma_f32_16x16x32_bf16 v[120:123], a[188:191], a[24:27], v[120:123]
  v_mfma_f32_16x16x32_bf16 v[124:127], a[188:191], a[28:31], 0
  ds_read_b64_tr_b16 a[174:175], v225 offset:58368
  v_mfma_f32_16x16x32_bf16 v[124:127], a[184:187], a[12:15], v[124:127]
  s_waitcnt vmcnt(17) lgkmcnt(4)
  v_mfma_f32_16x16x32_bf16 v[0:3], a[160:163], a[32:35], v[0:3]
  ds_read_b64_tr_b16 a[176:177], v226 offset:49152
  v_mfma_f32_16x16x32_bf16 v[0:3], a[164:167], a[48:51], v[0:3]
  buffer_load_dwordx4 a[0:3], v242, s[24:27], s30 offen offset:0 sc1
  v_mfma_f32_16x16x32_bf16 v[4:7], a[164:167], a[52:55], v[4:7]
  ds_read_b64_tr_b16 a[178:179], v226 offset:50176
  v_mfma_f32_16x16x32_bf16 v[4:7], a[160:163], a[36:39], v[4:7]
  v_mfma_f32_16x16x32_bf16 v[8:11], a[160:163], a[40:43], v[8:11]
  ds_read_b64_tr_b16 a[180:181], v226 offset:57344
  s_add_u32 m0, s28, 16384
  v_mfma_f32_16x16x32_bf16 v[8:11], a[164:167], a[56:59], v[8:11]
  buffer_load_dwordx4 v238, s[20:23], s31 offen offset:0 lds
  v_mfma_f32_16x16x32_bf16 v[12:15], a[164:167], a[60:63], v[12:15]
  ds_read_b64_tr_b16 a[182:183], v226 offset:58368
  v_mfma_f32_16x16x32_bf16 v[12:15], a[160:163], a[44:47], v[12:15]
  s_waitcnt lgkmcnt(4)
  v_mfma_f32_16x16x32_bf16 v[16:19], a[168:171], a[32:35], v[16:19]
  ds_read_b64_tr_b16 a[184:185], v227 offset:49152
  v_mfma_f32_16x16x32_bf16 v[16:19], a[172:175], a[48:51], v[16:19]
  buffer_load_dwordx4 a[4:7], v242, s[24:27], s30 offen offset:1024 sc1
  v_mfma_f32_16x16x32_bf16 v[20:23], a[172:175], a[52:55], v[20:23]
  ds_read_b64_tr_b16 a[186:187], v227 offset:50176
  v_mfma_f32_16x16x32_bf16 v[20:23], a[168:171], a[36:39], v[20:23]
  v_mfma_f32_16x16x32_bf16 v[24:27], a[168:171], a[40:43], v[24:27]
  ds_read_b64_tr_b16 a[188:189], v227 offset:57344
  v_mfma_f32_16x16x32_bf16 v[24:27], a[172:175], a[56:59], v[24:27]
  v_mfma_f32_16x16x32_bf16 v[28:31], a[172:175], a[60:63], v[28:31]
  ds_read_b64_tr_b16 a[190:191], v227 offset:58368
  v_mfma_f32_16x16x32_bf16 v[28:31], a[168:171], a[44:47], v[28:31]
  s_waitcnt lgkmcnt(4)
  v_mfma_f32_16x16x32_bf16 v[32:35], a[176:179], a[32:35], v[32:35]
  ds_read_b64_tr_b16 a[160:161], v228 offset:49152
  v_mfma_f32_16x16x32_bf16 v[32:35], a[180:183], a[48:51], v[32:35]
  buffer_load_dwordx4 a[8:11], v242, s[24:27], s30 offen offset:2048 sc1
  v_mfma_f32_16x16x32_bf16 v[36:39], a[180:183], a[52:55], v[36:39]
  ds_read_b64_tr_b16 a[162:163], v228 offset:50176
  v_mfma_f32_16x16x32_bf16 v[36:39], a[176:179], a[36:39], v[36:39]
  v_mfma_f32_16x16x32_bf16 v[40:43], a[176:179], a[40:43], v[40:43]
  ds_read_b64_tr_b16 a[164:165], v228 offset:57344
  v_mfma_f32_16x16x32_bf16 v[40:43], a[180:183], a[56:59], v[40:43]
  buffer_load_dwordx4 v239, s[20:23], s31 offen offset:1024 lds
  v_mfma_f32_16x16x32_bf16 v[44:47], a[180:183], a[60:63], v[44:47]
  ds_read_b64_tr_b16 a[166:167], v228 offset:58368
  v_mfma_f32_16x16x32_bf16 v[44:47], a[176:179], a[44:47], v[44:47]
  s_waitcnt lgkmcnt(4)
  v_mfma_f32_16x16x32_bf16 v[48:51], a[184:187], a[32:35], v[48:51]
  ds_read_b64_tr_b16 a[168:169], v229 offset:49152
  v_mfma_f32_16x16x32_bf16 v[48:51], a[188:191], a[48:51], v[48:51]
  buffer_load_dwordx4 a[12:15], v242, s[24:27], s30 offen offset:3072 sc1
  v_mfma_f32_16x16x32_bf16 v[52:55], a[188:191], a[52:55], v[52:55]
  ds_read_b64_tr_b16 a[170:171], v229 offset:50176
  v_mfma_f32_16x16x32_bf16 v[52:55], a[184:187], a[36:39], v[52:55]
  v_mfma_f32_16x16x32_bf16 v[56:59], a[184:187], a[40:43], v[56:59]
  ds_read_b64_tr_b16 a[172:173], v229 offset:57344
  v_mfma_f32_16x16x32_bf16 v[56:59], a[188:191], a[56:59], v[56:59]
  v_mfma_f32_16x16x32_bf16 v[60:63], a[188:191], a[60:63], v[60:63]
  ds_read_b64_tr_b16 a[174:175], v229 offset:58368
  v_mfma_f32_16x16x32_bf16 v[60:63], a[184:187], a[44:47], v[60:63]
  s_waitcnt lgkmcnt(4)
  v_mfma_f32_16x16x32_bf16 v[64:67], a[160:163], a[32:35], v[64:67]
  ds_read_b64_tr_b16 a[176:177], v230 offset:49152
  v_mfma_f32_16x16x32_bf16 v[64:67], a[164:167], a[48:51], v[64:67]
  buffer_load_dwordx4 a[16:19], v243, s[24:27], s30 offen offset:0 sc1
  v_mfma_f32_16x16x32_bf16 v[68:71], a[164:167], a[52:55], v[68:71]
  ds_read_b64_tr_b16 a[178:179], v230 offset:50176
  v_mfma_f32_16x16x32_bf16 v[68:71], a[160:163], a[36:39], v[68:71]
  v_mfma_f32_16x16x32_bf16 v[72:75], a[160:163], a[40:43], v[72:75]
  ds_read_b64_tr_b16 a[180:181], v230 offset:57344
  v_mfma_f32_16x16x32_bf16 v[72:75], a[164:167], a[56:59], v[72:75]
  buffer_load_dwordx4 v240, s[20:23], s31 offen offset:2048 lds
  v_mfma_f32_16x16x32_bf16 v[76:79], a[164:167], a[60:63], v[76:79]
  ds_read_b64_tr_b16 a[182:183], v230 offset:58368
  v_mfma_f32_16x16x32_bf16 v[76:79], a[160:163], a[44:47], v[76:79]
  s_waitcnt lgkmcnt(4)
  v_mfma_f32_16x16x32_bf16 v[80:83], a[168:171], a[32:35], v[80:83]
  ds_read_b64_tr_b16 a[184:185], v231 offset:49152
  v_mfma_f32_16x16x32_bf16 v[80:83], a[172:175], a[48:51], v[80:83]
  buffer_load_dwordx4 a[20:23], v243, s[24:27], s30 offen offset:1024 sc1
  v_mfma_f32_16x16x32_bf16 v[84:87], a[172:175], a[52:55], v[84:87]
  ds_read_b64_tr_b16 a[186:187], v231 offset:50176
  v_mfma_f32_16x16x32_bf16 v[84:87], a[168:171], a[36:39], v[84:87]
  v_mfma_f32_16x16x32_bf16 v[88:91], a[168:171], a[40:43], v[88:91]
  ds_read_b64_tr_b16 a[188:189], v231 offset:57344
  v_mfma_f32_16x16x32_bf16 v[88:91], a[172:175], a[56:59], v[88:91]
  s_barrier
  v_mfma_f32_16x16x32_bf16 v[92:95], a[172:175], a[60:63], v[92:95]
  ds_read_b64_tr_b16 a[190:191], v231 offset:58368
  v_mfma_f32_16x16x32_bf16 v[92:95], a[168:171], a[44:47], v[92:95]
  s_waitcnt lgkmcnt(4)
  v_mfma_f32_16x16x32_bf16 v[96:99], a[176:179], a[32:35], v[96:99]
  ds_read_b64_tr_b16 a[160:161], v148 offset:32768
  v_mfma_f32_16x16x32_bf16 v[96:99], a[180:183], a[48:51], v[96:99]
  buffer_load_dwordx4 a[24:27], v243, s[24:27], s30 offen offset:2048 sc1
  v_mfma_f32_16x16x32_bf16 v[100:103], a[180:183], a[52:55], v[100:103]
  ds_read_b64_tr_b16 a[162:163], v148 offset:33792
  v_mfma_f32_16x16x32_bf16 v[100:103], a[176:179], a[36:39], v[100:103]
  v_mfma_f32_16x16x32_bf16 v[104:107], a[176:179], a[40:43], v[104:107]
  ds_read_b64_tr_b16 a[164:165], v148 offset:40960
  v_mfma_f32_16x16x32_bf16 v[104:107], a[180:183], a[56:59], v[104:107]
  buffer_load_dwordx4 v241, s[20:23], s31 offen offset:3072 lds
  s_add_u32 s31, s31, 0x80000
  v_mfma_f32_16x16x32_bf16 v[108:111], a[180:183], a[60:63], v[108:111]
  ds_read_b64_tr_b16 a[166:167], v148 offset:41984
  v_mfma_f32_16x16x32_bf16 v[108:111], a[176:179], a[44:47], v[108:111]
  s_waitcnt lgkmcnt(4)
  v_mfma_f32_16x16x32_bf16 v[112:115], a[184:187], a[32:35], v[112:115]
  ds_read_b64_tr_b16 a[168:169], v149 offset:32768
  v_mfma_f32_16x16x32_bf16 v[112:115], a[188:191], a[48:51], v[112:115]
  buffer_load_dwordx4 a[28:31], v243, s[24:27], s30 offen offset:3072 sc1
  s_add_u32 s30, s30, 8192
  v_mfma_f32_16x16x32_bf16 v[116:119], a[188:191], a[52:55], v[116:119]
  ds_read_b64_tr_b16 a[170:171], v149 offset:33792
  v_mfma_f32_16x16x32_bf16 v[116:119], a[184:187], a[36:39], v[116:119]
  v_mfma_f32_16x16x32_bf16 v[120:123], a[184:187], a[40:43], v[120:123]
  ds_read_b64_tr_b16 a[172:173], v149 offset:40960
  v_mfma_f32_16x16x32_bf16 v[120:123], a[188:191], a[56:59], v[120:123]
  v_mfma_f32_16x16x32_bf16 v[124:127], a[188:191], a[60:63], v[124:127]
  ds_read_b64_tr_b16 a[174:175], v149 offset:41984
  v_mfma_f32_16x16x32_bf16 v[124:127], a[184:187], a[44:47], v[124:127]
  s_waitcnt vmcnt(20) lgkmcnt(4)
  v_xor_b32 v136, s55, v136
  v_xor_b32 v137, s55, v137
  v_xor_b32 v138, s55, v138
  v_xor_b32 v139, s55, v139
  v_or3_b32 v136, v136, v137, v138
  v_or_b32 v136, v136, v139
  v_cmp_ne_u32 vcc, 0, v136
  s_nop 0
  s_cbranch_vccz front_keys
  s_mov_b32 s54, 32768
front_all:
  s_sleep 2
  buffer_load_dwordx4 v[136:139], v140, s[24:27], s58 offen sc1
  s_waitcnt vmcnt(0)
  v_xor_b32 v136, s55, v136
  v_xor_b32 v137, s55, v137
  v_xor_b32 v138, s55, v138
  v_xor_b32 v139, s55, v139
  v_or3_b32 v136, v136, v137, v138
  v_or_b32 v136, v136, v139
  v_cmp_ne_u32 vcc, 0, v136
  s_nop 0
  s_cbranch_vccz front_keys
  s_sub_u32 s54, s54, 1
  s_cmp_lg_u32 s54, 0
  s_cbranch_scc1 front_all
front_keys:
  s_lshl_b32 s35, s3, 11
  s_add_u32 s35, s35, 2621440
  buffer_load_dwordx4 v[128:131], v242, s[24:27], s35 offen sc1
  buffer_load_dwordx4 v[132:135], v242, s[24:27], s35 offen offset:1024 sc1
  v_mfma_f32_16x16x32_bf16 v[0:3], a[160:163], a[64:67], v[0:3]
  ds_read_b64_tr_b16 a[176:177], v150 offset:32768
  s_add_u32 s59, s59, 1
  s_or_b32 s54, s2, s3
  s_min_u32 s54, s54, 1
  v_mfma_f32_16x16x32_bf16 v[0:3], a[164:167], a[80:83], v[0:3]
  buffer_load_dwordx4 a[32:35], v242, s[24:27], s30 offen offset:0 sc1
  s_lshl_b32 s54, s54, 28
  v_mfma_f32_16x16x32_bf16 v[4:7], a[164:167], a[84:87], v[4:7]
  ds_read_b64_tr_b16 a[178:179], v150 offset:33792
  v_lshlrev_b32 v137, 22, v242
  v_mfma_f32_16x16x32_bf16 v[4:7], a[160:163], a[68:71], v[4:7]
  v_or_b32 v137, s54, v137
  v_mov_b32 v136, s59
  v_mfma_f32_16x16x32_bf16 v[8:11], a[160:163], a[72:75], v[8:11]
  ds_read_b64_tr_b16 a[180:181], v150 offset:40960
  s_add_u32 m0, s28, 0
  s_mov_b32 s58, 2830336
  buffer_store_dword v136, v137, s[24:27], s58 offen sc1
  v_mfma_f32_16x16x32_bf16 v[8:11], a[164:167], a[88:91], v[8:11]
  buffer_load_dwordx4 v238, s[20:23], s31 offen offset:0 lds
  v_mfma_f32_16x16x32_bf16 v[12:15], a[164:167], a[92:95], v[12:15]
  ds_read_b64_tr_b16 a[182:183], v150 offset:41984
  v_mfma_f32_16x16x32_bf16 v[12:15], a[160:163], a[76:79], v[12:15]
  s_waitcnt lgkmcnt(4)
  v_mfma_f32_16x16x32_bf16 v[16:19], a[168:171], a[64:67], v[16:19]
  ds_read_b64_tr_b16 a[184:185], v151 offset:32768
  v_mfma_f32_16x16x32_bf16 v[16:19], a[172:175], a[80:83], v[16:19]
  buffer_load_dwordx4 a[36:39], v242, s[24:27], s30 offen offset:1024 sc1
  v_mfma_f32_16x16x32_bf16 v[20:23], a[172:175], a[84:87], v[20:23]
  ds_read_b64_tr_b16 a[186:187], v151 offset:33792
  v_mfma_f32_16x16x32_bf16 v[20:23], a[168:171], a[68:71], v[20:23]
  v_mfma_f32_16x16x32_bf16 v[24:27], a[168:171], a[72:75], v[24:27]
  ds_read_b64_tr_b16 a[188:189], v151 offset:40960
  v_mfma_f32_16x16x32_bf16 v[24:27], a[172:175], a[88:91], v[24:27]
  v_mfma_f32_16x16x32_bf16 v[28:31], a[172:175], a[92:95], v[28:31]
  ds_read_b64_tr_b16 a[190:191], v151 offset:41984
  v_mfma_f32_16x16x32_bf16 v[28:31], a[168:171], a[76:79], v[28:31]
  s_waitcnt lgkmcnt(4)
  v_mfma_f32_16x16x32_bf16 v[32:35], a[176:179], a[64:67], v[32:35]
  ds_read_b64_tr_b16 a[160:161], v152 offset:32768
  v_mfma_f32_16x16x32_bf16 v[32:35], a[180:183], a[80:83], v[32:35]
  buffer_load_dwordx4 a[40:43], v242, s[24:27], s30 offen offset:2048 sc1
  v_mfma_f32_16x16x32_bf16 v[36:39], a[180:183], a[84:87], v[36:39]
  ds_read_b64_tr_b16 a[162:163], v152 offset:33792
  v_mfma_f32_16x16x32_bf16 v[36:39], a[176:179], a[68:71], v[36:39]
  v_mfma_f32_16x16x32_bf16 v[40:43], a[176:179], a[72:75], v[40:43]
  ds_read_b64_tr_b16 a[164:165], v152 offset:40960
  v_mfma_f32_16x16x32_bf16 v[40:43], a[180:183], a[88:91], v[40:43]
  buffer_load_dwordx4 v239, s[20:23], s31 offen offset:1024 lds
  v_mfma_f32_16x16x32_bf16 v[44:47], a[180:183], a[92:95], v[44:47]
  ds_read_b64_tr_b16 a[166:167], v152 offset:41984
  v_mfma_f32_16x16x32_bf16 v[44:47], a[176:179], a[76:79], v[44:47]
  s_waitcnt lgkmcnt(4)
  v_mfma_f32_16x16x32_bf16 v[48:51], a[184:187], a[64:67], v[48:51]
  ds_read_b64_tr_b16 a[168:169], v153 offset:32768
  v_mfma_f32_16x16x32_bf16 v[48:51], a[188:191], a[80:83], v[48:51]
  buffer_load_dwordx4 a[44:47], v242, s[24:27], s30 offen offset:3072 sc1
  v_mfma_f32_16x16x32_bf16 v[52:55], a[188:191], a[84:87], v[52:55]
  ds_read_b64_tr_b16 a[170:171], v153 offset:33792
  v_mfma_f32_16x16x32_bf16 v[52:55], a[184:187], a[68:71], v[52:55]
  v_mfma_f32_16x16x32_bf16 v[56:59], a[184:187], a[72:75], v[56:59]
  ds_read_b64_tr_b16 a[172:173], v153 offset:40960
  v_mfma_f32_16x16x32_bf16 v[56:59], a[188:191], a[88:91], v[56:59]
  v_mfma_f32_16x16x32_bf16 v[60:63], a[188:191], a[92:95], v[60:63]
  ds_read_b64_tr_b16 a[174:175], v153 offset:41984
  v_mfma_f32_16x16x32_bf16 v[60:63], a[184:187], a[76:79], v[60:63]
  s_waitcnt lgkmcnt(4)
  v_mfma_f32_16x16x32_bf16 v[64:67], a[160:163], a[64:67], v[64:67]
  ds_read_b64_tr_b16 a[176:177], v154 offset:32768
  v_mfma_f32_16x16x32_bf16 v[64:67], a[164:167], a[80:83], v[64:67]
  buffer_load_dwordx4 a[48:51], v243, s[24:27], s30 offen offset:0 sc1
  v_mfma_f32_16x16x32_bf16 v[68:71], a[164:167], a[84:87], v[68:71]
  ds_read_b64_tr_b16 a[178:179], v154 offset:33792
  v_mfma_f32_16x16x32_bf16 v[68:71], a[160:163], a[68:71], v[68:71]
  v_mfma_f32_16x16x32_bf16 v[72:75], a[160:163], a[72:75], v[72:75]
  ds_read_b64_tr_b16 a[180:181], v154 offset:40960
  v_mfma_f32_16x16x32_bf16 v[72:75], a[164:167], a[88:91], v[72:75]
  buffer_load_dwordx4 v240, s[20:23], s31 offen offset:2048 lds
  v_mfma_f32_16x16x32_bf16 v[76:79], a[164:167], a[92:95], v[76:79]
  ds_read_b64_tr_b16 a[182:183], v154 offset:41984
  v_mfma_f32_16x16x32_bf16 v[76:79], a[160:163], a[76:79], v[76:79]
  s_waitcnt lgkmcnt(4)
  v_mfma_f32_16x16x32_bf16 v[80:83], a[168:171], a[64:67], v[80:83]
  ds_read_b64_tr_b16 a[184:185], v155 offset:32768
  v_mfma_f32_16x16x32_bf16 v[80:83], a[172:175], a[80:83], v[80:83]
  buffer_load_dwordx4 a[52:55], v243, s[24:27], s30 offen offset:1024 sc1
  v_mfma_f32_16x16x32_bf16 v[84:87], a[172:175], a[84:87], v[84:87]
  ds_read_b64_tr_b16 a[186:187], v155 offset:33792
  v_mfma_f32_16x16x32_bf16 v[84:87], a[168:171], a[68:71], v[84:87]
  v_mfma_f32_16x16x32_bf16 v[88:91], a[168:171], a[72:75], v[88:91]
  ds_read_b64_tr_b16 a[188:189], v155 offset:40960
  v_mfma_f32_16x16x32_bf16 v[88:91], a[172:175], a[88:91], v[88:91]
  s_barrier
  v_mfma_f32_16x16x32_bf16 v[92:95], a[172:175], a[92:95], v[92:95]
  ds_read_b64_tr_b16 a[190:191], v155 offset:41984
  v_mfma_f32_16x16x32_bf16 v[92:95], a[168:171], a[76:79], v[92:95]
  s_waitcnt lgkmcnt(4)
  v_mfma_f32_16x16x32_bf16 v[96:99], a[176:179], a[64:67], v[96:99]
  ds_read_b64_tr_b16 a[160:161], v148 offset:49152
  v_mfma_f32_16x16x32_bf16 v[96:99], a[180:183], a[80:83], v[96:99]
  buffer_load_dwordx4 a[56:59], v243, s[24:27], s30 offen offset:2048 sc1
  v_mfma_f32_16x16x32_bf16 v[100:103], a[180:183], a[84:87], v[100:103]
  ds_read_b64_tr_b16 a[162:163], v148 offset:50176
  v_mfma_f32_16x16x32_bf16 v[100:103], a[176:179], a[68:71], v[100:103]
  v_mfma_f32_16x16x32_bf16 v[104:107], a[176:179], a[72:75], v[104:107]
  ds_read_b64_tr_b16 a[164:165], v148 offset:57344
  v_mfma_f32_16x16x32_bf16 v[104:107], a[180:183], a[88:91], v[104:107]
  buffer_load_dwordx4 v241, s[20:23], s31 offen offset:3072 lds
  s_add_u32 s31, s31, 0x80000
  v_mfma_f32_16x16x32_bf16 v[108:111], a[180:183], a[92:95], v[108:111]
  ds_read_b64_tr_b16 a[166:167], v148 offset:58368
  v_mfma_f32_16x16x32_bf16 v[108:111], a[176:179], a[76:79], v[108:111]
  s_waitcnt lgkmcnt(4)
  v_mfma_f32_16x16x32_bf16 v[112:115], a[184:187], a[64:67], v[112:115]
  ds_read_b64_tr_b16 a[168:169], v149 offset:49152
  v_mfma_f32_16x16x32_bf16 v[112:115], a[188:191], a[80:83], v[112:115]
  buffer_load_dwordx4 a[60:63], v243, s[24:27], s30 offen offset:3072 sc1
  s_add_u32 s30, s30, 8192
  v_mfma_f32_16x16x32_bf16 v[116:119], a[188:191], a[84:87], v[116:119]
  ds_read_b64_tr_b16 a[170:171], v149 offset:50176
  v_mfma_f32_16x16x32_bf16 v[116:119], a[184:187], a[68:71], v[116:119]
  v_mfma_f32_16x16x32_bf16 v[120:123], a[184:187], a[72:75], v[120:123]
  ds_read_b64_tr_b16 a[172:173], v149 offset:57344
  v_mfma_f32_16x16x32_bf16 v[120:123], a[188:191], a[88:91], v[120:123]
  v_mfma_f32_16x16x32_bf16 v[124:127], a[188:191], a[92:95], v[124:127]
  ds_read_b64_tr_b16 a[174:175], v149 offset:58368
  v_mfma_f32_16x16x32_bf16 v[124:127], a[184:187], a[76:79], v[124:127]
  s_waitcnt vmcnt(27) lgkmcnt(4)
  v_mfma_f32_16x16x32_bf16 v[0:3], a[160:163], a[96:99], v[0:3]
  ds_read_b64_tr_b16 a[176:177], v150 offset:49152
  v_mfma_f32_16x16x32_bf16 v[0:3], a[164:167], a[112:115], v[0:3]
  buffer_load_dwordx4 a[64:67], v242, s[24:27], s30 offen offset:0 sc1
  v_mfma_f32_16x16x32_bf16 v[4:7], a[164:167], a[116:119], v[4:7]
  ds_read_b64_tr_b16 a[178:179], v150 offset:50176
  v_mfma_f32_16x16x32_bf16 v[4:7], a[160:163], a[100:103], v[4:7]
  v_mfma_f32_16x16x32_bf16 v[8:11], a[160:163], a[104:107], v[8:11]
  ds_read_b64_tr_b16 a[180:181], v150 offset:57344
  s_add_u32 m0, s28, 65536
  v_mfma_f32_16x16x32_bf16 v[8:11], a[164:167], a[120:123], v[8:11]
  buffer_load_dwordx4 v238, s[20:23], s31 offen offset:0 lds
  v_mfma_f32_16x16x32_bf16 v[12:15], a[164:167], a[124:127], v[12:15]
  ds_read_b64_tr_b16 a[182:183], v150 offset:58368
  v_mfma_f32_16x16x32_bf16 v[12:15], a[160:163], a[108:111], v[12:15]
  s_waitcnt lgkmcnt(4)
  v_mfma_f32_16x16x32_bf16 v[16:19], a[168:171], a[96:99], v[16:19]
  ds_read_b64_tr_b16 a[184:185], v151 offset:49152
  v_mfma_f32_16x16x32_bf16 v[16:19], a[172:175], a[112:115], v[16:19]
  buffer_load_dwordx4 a[68:71], v242, s[24:27], s30 offen offset:1024 sc1
  v_mfma_f32_16x16x32_bf16 v[20:23], a[172:175], a[116:119], v[20:23]
  ds_read_b64_tr_b16 a[186:187], v151 offset:50176
  v_mfma_f32_16x16x32_bf16 v[20:23], a[168:171], a[100:103], v[20:23]
  v_mfma_f32_16x16x32_bf16 v[24:27], a[168:171], a[104:107], v[24:27]
  ds_read_b64_tr_b16 a[188:189], v151 offset:57344
  v_mfma_f32_16x16x32_bf16 v[24:27], a[172:175], a[120:123], v[24:27]
  v_mfma_f32_16x16x32_bf16 v[28:31], a[172:175], a[124:127], v[28:31]
  ds_read_b64_tr_b16 a[190:191], v151 offset:58368
  v_mfma_f32_16x16x32_bf16 v[28:31], a[168:171], a[108:111], v[28:31]
  s_waitcnt lgkmcnt(4)
  v_mfma_f32_16x16x32_bf16 v[32:35], a[176:179], a[96:99], v[32:35]
  ds_read_b64_tr_b16 a[160:161], v152 offset:49152
  v_mfma_f32_16x16x32_bf16 v[32:35], a[180:183], a[112:115], v[32:35]
  buffer_load_dwordx4 a[72:75], v242, s[24:27], s30 offen offset:2048 sc1
  v_mfma_f32_16x16x32_bf16 v[36:39], a[180:183], a[116:119], v[36:39]
  ds_read_b64_tr_b16 a[162:163], v152 offset:50176
  v_mfma_f32_16x16x32_bf16 v[36:39], a[176:179], a[100:103], v[36:39]
  v_mfma_f32_16x16x32_bf16 v[40:43], a[176:179], a[104:107], v[40:43]
  ds_read_b64_tr_b16 a[164:165], v152 offset:57344
  v_mfma_f32_16x16x32_bf16 v[40:43], a[180:183], a[120:123], v[40:43]
  buffer_load_dwordx4 v239, s[20:23], s31 offen offset:1024 lds
  v_mfma_f32_16x16x32_bf16 v[44:47], a[180:183], a[124:127], v[44:47]
  ds_read_b64_tr_b16 a[166:167], v152 offset:58368
  v_mfma_f32_16x16x32_bf16 v[44:47], a[176:179], a[108:111], v[44:47]
  s_waitcnt lgkmcnt(4)
  v_mfma_f32_16x16x32_bf16 v[48:51], a[184:187], a[96:99], v[48:51]
  ds_read_b64_tr_b16 a[168:169], v153 offset:49152
  v_mfma_f32_16x16x32_bf16 v[48:51], a[188:191], a[112:115], v[48:51]
  buffer_load_dwordx4 a[76:79], v242, s[24:27], s30 offen offset:3072 sc1
  v_mfma_f32_16x16x32_bf16 v[52:55], a[188:191], a[116:119], v[52:55]
  ds_read_b64_tr_b16 a[170:171], v153 offset:50176
  v_mfma_f32_16x16x32_bf16 v[52:55], a[184:187], a[100:103], v[52:55]
  v_mfma_f32_16x16x32_bf16 v[56:59], a[184:187], a[104:107], v[56:59]
  ds_read_b64_tr_b16 a[172:173], v153 offset:57344
  v_mfma_f32_16x16x32_bf16 v[56:59], a[188:191], a[120:123], v[56:59]
  v_mfma_f32_16x16x32_bf16 v[60:63], a[188:191], a[124:127], v[60:63]
  ds_read_b64_tr_b16 a[174:175], v153 offset:58368
  v_mfma_f32_16x16x32_bf16 v[60:63], a[184:187], a[108:111], v[60:63]
  s_waitcnt lgkmcnt(4)
  v_mfma_f32_16x16x32_bf16 v[64:67], a[160:163], a[96:99], v[64:67]
  ds_read_b64_tr_b16 a[176:177], v154 offset:49152
  v_mfma_f32_16x16x32_bf16 v[64:67], a[164:167], a[112:115], v[64:67]
  buffer_load_dwordx4 a[80:83], v243, s[24:27], s30 offen offset:0 sc1
  v_mfma_f32_16x16x32_bf16 v[68:71], a[164:167], a[116:119], v[68:71]
  ds_read_b64_tr_b16 a[178:179], v154 offset:50176
  v_mfma_f32_16x16x32_bf16 v[68:71], a[160:163], a[100:103], v[68:71]
  v_mfma_f32_16x16x32_bf16 v[72:75], a[160:163], a[104:107], v[72:75]
  ds_read_b64_tr_b16 a[180:181], v154 offset:57344
  v_mfma_f32_16x16x32_bf16 v[72:75], a[164:167], a[120:123], v[72:75]
  buffer_load_dwordx4 v240, s[20:23], s31 offen offset:2048 lds
  v_mfma_f32_16x16x32_bf16 v[76:79], a[164:167], a[124:127], v[76:79]
  ds_read_b64_tr_b16 a[182:183], v154 offset:58368
  v_mfma_f32_16x16x32_bf16 v[76:79], a[160:163], a[108:111], v[76:79]
  s_waitcnt lgkmcnt(4)
  v_mfma_f32_16x16x32_bf16 v[80:83], a[168:171], a[96:99], v[80:83]
  ds_read_b64_tr_b16 a[184:185], v155 offset:49152
  v_mfma_f32_16x16x32_bf16 v[80:83], a[172:175], a[112:115], v[80:83]
  buffer_load_dwordx4 a[84:87], v243, s[24:27], s30 offen offset:1024 sc1
  v_mfma_f32_16x16x32_bf16 v[84:87], a[172:175], a[116:119], v[84:87]
  ds_read_b64_tr_b16 a[186:187], v155 offset:50176
  v_mfma_f32_16x16x32_bf16 v[84:87], a[168:171], a[100:103], v[84:87]
  s_waitcnt vmcnt(25)
  v_mfma_f32_16x16x32_bf16 v[88:91], a[168:171], a[104:107], v[88:91]
  ds_read_b64_tr_b16 a[188:189], v155 offset:57344
  v_mfma_f32_16x16x32_bf16 v[88:91], a[172:175], a[120:123], v[88:91]
  s_barrier
  v_mfma_f32_16x16x32_bf16 v[92:95], a[172:175], a[124:127], v[92:95]
  ds_read_b64_tr_b16 a[190:191], v155 offset:58368
  v_mfma_f32_16x16x32_bf16 v[92:95], a[168:171], a[108:111], v[92:95]
  s_waitcnt lgkmcnt(4)
  v_mfma_f32_16x16x32_bf16 v[96:99], a[176:179], a[96:99], v[96:99]
  ds_read_b64_tr_b16 a[160:161], v148 offset:16384
  v_mfma_f32_16x16x32_bf16 v[96:99], a[180:183], a[112:115], v[96:99]
  buffer_load_dwordx4 a[88:91], v243, s[24:27], s30 offen offset:2048 sc1
  v_mfma_f32_16x16x32_bf16 v[100:103], a[180:183], a[116:119], v[100:103]
  ds_read_b64_tr_b16 a[162:163], v148 offset:17408
  v_mfma_f32_16x16x32_bf16 v[100:103], a[176:179], a[100:103], v[100:103]
  v_mfma_f32_16x16x32_bf16 v[104:107], a[176:179], a[104:107], v[104:107]
  ds_read_b64_tr_b16 a[164:165], v148 offset:24576
  v_mfma_f32_16x16x32_bf16 v[104:107], a[180:183], a[120:123], v[104:107]
  buffer_load_dwordx4 v241, s[20:23], s31 offen offset:3072 lds
  s_add_u32 s31, s31, 0x80000
  v_mfma_f32_16x16x32_bf16 v[108:111], a[180:183], a[124:127], v[108:111]
  ds_read_b64_tr_b16 a[166:167], v148 offset:25600
  v_mfma_f32_16x16x32_bf16 v[108:111], a[176:179], a[108:111], v[108:111]
  s_waitcnt lgkmcnt(4)
  v_mfma_f32_16x16x32_bf16 v[112:115], a[184:187], a[96:99], v[112:115]
  ds_read_b64_tr_b16 a[168:169], v149 offset:16384
  v_mfma_f32_16x16x32_bf16 v[112:115], a[188:191], a[112:115], v[112:115]
  buffer_load_dwordx4 a[92:95], v243, s[24:27], s30 offen offset:3072 sc1
  s_add_u32 s30, s30, 8192
  v_mfma_f32_16x16x32_bf16 v[116:119], a[188:191], a[116:119], v[116:119]
  ds_read_b64_tr_b16 a[170:171], v149 offset:17408
  v_mfma_f32_16x16x32_bf16 v[116:119], a[184:187], a[100:103], v[116:119]
  v_mfma_f32_16x16x32_bf16 v[120:123], a[184:187], a[104:107], v[120:123]
  ds_read_b64_tr_b16 a[172:173], v149 offset:24576
  v_mfma_f32_16x16x32_bf16 v[120:123], a[188:191], a[120:123], v[120:123]
  v_mfma_f32_16x16x32_bf16 v[124:127], a[188:191], a[124:127], v[124:127]
  ds_read_b64_tr_b16 a[174:175], v149 offset:25600
  v_mfma_f32_16x16x32_bf16 v[124:127], a[184:187], a[108:111], v[124:127]
  s_waitcnt vmcnt(27) lgkmcnt(4)
  v_mfma_f32_16x16x32_bf16 v[0:3], a[160:163], a[0:3], v[0:3]
  ds_read_b64_tr_b16 a[176:177], v150 offset:16384
  s_waitcnt vmcnt(25)
  v_mov_b32 v136, -1
  v_mfma_f32_16x16x32_bf16 v[0:3], a[164:167], a[16:19], v[0:3]
  buffer_load_dwordx4 a[96:99], v242, s[24:27], s30 offen offset:0 sc1
  v_mfma_f32_16x16x32_bf16 v[4:7], a[164:167], a[20:23], v[4:7]
  ds_read_b64_tr_b16 a[178:179], v150 offset:17408
  v_sub_u32 v139, v136, v128
  v_mfma_f32_16x16x32_bf16 v[4:7], a[160:163], a[4:7], v[4:7]
  v_sub_u32 v140, v136, v129
  v_min_u32 v138, v139, v140
  v_mfma_f32_16x16x32_bf16 v[8:11], a[160:163], a[8:11], v[8:11]
  ds_read_b64_tr_b16 a[180:181], v150 offset:24576
  s_add_u32 m0, s28, 81920
  v_sub_u32 v141, v136, v130
  v_mfma_f32_16x16x32_bf16 v[8:11], a[164:167], a[24:27], v[8:11]
  buffer_load_dwordx4 v238, s[20:23], s31 offen offset:0 lds
  v_mfma_f32_16x16x32_bf16 v[12:15], a[164:167], a[28:31], v[12:15]
  ds_read_b64_tr_b16 a[182:183], v150 offset:25600
  v_sub_u32 v142, v136, v131
  v_mfma_f32_16x16x32_bf16 v[12:15], a[160:163], a[12:15], v[12:15]
  s_waitcnt lgkmcnt(4)
  v_min3_u32 v138, v138, v141, v142
  v_sub_u32 v139, v136, v132
  v_mfma_f32_16x16x32_bf16 v[16:19], a[168:171], a[0:3], v[16:19]
  ds_read_b64_tr_b16 a[184:185], v151 offset:16384
  v_sub_u32 v140, v136, v133
  v_mfma_f32_16x16x32_bf16 v[16:19], a[172:175], a[16:19], v[16:19]
  buffer_load_dwordx4 a[100:103], v242, s[24:27], s30 offen offset:1024 sc1
  v_mfma_f32_16x16x32_bf16 v[20:23], a[172:175], a[20:23], v[20:23]
  ds_read_b64_tr_b16 a[186:187], v151 offset:17408
  v_min3_u32 v138, v138, v139, v140
  v_mfma_f32_16x16x32_bf16 v[20:23], a[168:171], a[4:7], v[20:23]
  v_sub_u32 v141, v136, v134
  v_sub_u32 v142, v136, v135
  v_mfma_f32_16x16x32_bf16 v[24:27], a[168:171], a[8:11], v[24:27]
  ds_read_b64_tr_b16 a[188:189], v151 offset:24576
  v_min3_u32 v138, v138, v141, v142
  v_mfma_f32_16x16x32_bf16 v[24:27], a[172:175], a[24:27], v[24:27]
  v_mfma_f32_16x16x32_bf16 v[28:31], a[172:175], a[28:31], v[28:31]
  ds_read_b64_tr_b16 a[190:191], v151 offset:25600
  v_min_u32_dpp v138, v138, v138 row_ror:8 row_mask:0xf bank_mask:0xf
  v_mfma_f32_16x16x32_bf16 v[28:31], a[168:171], a[12:15], v[28:31]
  s_waitcnt lgkmcnt(4)
  v_min_u32_dpp v138, v138, v138 row_ror:4 row_mask:0xf bank_mask:0xf
  v_mfma_f32_16x16x32_bf16 v[32:35], a[176:179], a[0:3], v[32:35]
  ds_read_b64_tr_b16 a[160:161], v152 offset:16384
  v_min_u32_dpp v138, v138, v138 row_ror:2 row_mask:0xf bank_mask:0xf
  v_mfma_f32_16x16x32_bf16 v[32:35], a[180:183], a[16:19], v[32:35]
  buffer_load_dwordx4 a[104:107], v242, s[24:27], s30 offen offset:2048 sc1
  v_mfma_f32_16x16x32_bf16 v[36:39], a[180:183], a[20:23], v[36:39]
  ds_read_b64_tr_b16 a[162:163], v152 offset:17408
  v_min_u32_dpp v138, v138, v138 row_ror:1 row_mask:0xf bank_mask:0xf
  v_mfma_f32_16x16x32_bf16 v[36:39], a[176:179], a[4:7], v[36:39]
  v_sub_u32 v137, v136, v138
  v_add_u32 v136, -1, v137
  v_mfma_f32_16x16x32_bf16 v[40:43], a[176:179], a[8:11], v[40:43]
  ds_read_b64_tr_b16 a[164:165], v152 offset:24576
  v_sub_u32 v139, v136, v128
  v_mfma_f32_16x16x32_bf16 v[40:43], a[180:183], a[24:27], v[40:43]
  buffer_load_dwordx4 v239, s[20:23], s31 offen offset:1024 lds
  v_mfma_f32_16x16x32_bf16 v[44:47], a[180:183], a[28:31], v[44:47]
  ds_read_b64_tr_b16 a[166:167], v152 offset:25600
  v_mov_b32_dpp v144, v137 quad_perm:[0,1,2,3] row_mask:0xf bank_mask:0x1
  v_mfma_f32_16x16x32_bf16 v[44:47], a[176:179], a[12:15], v[44:47]
  s_waitcnt lgkmcnt(4)
  v_sub_u32 v140, v136, v129
  v_min_u32 v138, v139, v140
  v_mfma_f32_16x16x32_bf16 v[48:51], a[184:187], a[0:3], v[48:51]
  ds_read_b64_tr_b16 a[168:169], v153 offset:16384
  v_sub_u32 v141, v136, v130
  v_mfma_f32_16x16x32_bf16 v[48:51], a[188:191], a[16:19], v[48:51]
  buffer_load_dwordx4 a[108:111], v242, s[24:27], s30 offen offset:3072 sc1
  v_mfma_f32_16x16x32_bf16 v[52:55], a[188:191], a[20:23], v[52:55]
  ds_read_b64_tr_b16 a[170:171], v153 offset:17408
  v_sub_u32 v142, v136, v131
  v_mfma_f32_16x16x32_bf16 v[52:55], a[184:187], a[4:7], v[52:55]
  v_min3_u32 v138, v138, v141, v142
  v_sub_u32 v139, v136, v132
  v_mfma_f32_16x16x32_bf16 v[56:59], a[184:187], a[8:11], v[56:59]
  ds_read_b64_tr_b16 a[172:173], v153 offset:24576
  v_sub_u32 v140, v136, v133
  v_mfma_f32_16x16x32_bf16 v[56:59], a[188:191], a[24:27], v[56:59]
  v_min3_u32 v138, v138, v139, v140
  v_sub_u32 v141, v136, v134
  v_mfma_f32_16x16x32_bf16 v[60:63], a[188:191], a[28:31], v[60:63]
  ds_read_b64_tr_b16 a[174:175], v153 offset:25600
  v_sub_u32 v142, v136, v135
  v_mfma_f32_16x16x32_bf16 v[60:63], a[184:187], a[12:15], v[60:63]
  s_waitcnt lgkmcnt(4)
  v_min3_u32 v138, v138, v141, v142
  v_mfma_f32_16x16x32_bf16 v[64:67], a[160:163], a[0:3], v[64:67]
  ds_read_b64_tr_b16 a[176:177], v154 offset:16384
  v_min_u32_dpp v138, v138, v138 row_ror:8 row_mask:0xf bank_mask:0xf
  v_mfma_f32_16x16x32_bf16 v[64:67], a[164:167], a[16:19], v[64:67]
  buffer_load_dwordx4 a[112:115], v243, s[24:27], s30 offen offset:0 sc1
  v_mfma_f32_16x16x32_bf16 v[68:71], a[164:167], a[20:23], v[68:71]
  ds_read_b64_tr_b16 a[178:179], v154 offset:17408
  v_min_u32_dpp v138, v138, v138 row_ror:4 row_mask:0xf bank_mask:0xf
  v_mfma_f32_16x16x32_bf16 v[68:71], a[160:163], a[4:7], v[68:71]
  v_mfma_f32_16x16x32_bf16 v[72:75], a[160:163], a[8:11], v[72:75]
  ds_read_b64_tr_b16 a[180:181], v154 offset:24576
  v_min_u32_dpp v138, v138, v138 row_ror:2 row_mask:0xf bank_mask:0xf
  v_mfma_f32_16x16x32_bf16 v[72:75], a[164:167], a[24:27], v[72:75]
  buffer_load_dwordx4 v240, s[20:23], s31 offen offset:2048 lds
  v_mfma_f32_16x16x32_bf16 v[76:79], a[164:167], a[28:31], v[76:79]
  ds_read_b64_tr_b16 a[182:183], v154 offset:25600
  v_min_u32_dpp v138, v138, v138 row_ror:1 row_mask:0xf bank_mask:0xf
  v_mfma_f32_16x16x32_bf16 v[76:79], a[160:163], a[12:15], v[76:79]
  s_waitcnt lgkmcnt(4)
  v_sub_u32 v137, v136, v138
  v_add_u32 v136, -1, v137
  v_mfma_f32_16x16x32_bf16 v[80:83], a[168:171], a[0:3], v[80:83]
  ds_read_b64_tr_b16 a[184:185], v155 offset:16384
  v_sub_u32 v139, v136, v128
  v_mfma_f32_16x16x32_bf16 v[80:83], a[172:175], a[16:19], v[80:83]
  buffer_load_dwordx4 a[116:119], v243, s[24:27], s30 offen offset:1024 sc1
  v_mfma_f32_16x16x32_bf16 v[84:87], a[172:175], a[20:23], v[84:87]
  ds_read_b64_tr_b16 a[186:187], v155 offset:17408
  v_mov_b32_dpp v144, v137 quad_perm:[0,1,2,3] row_mask:0xf bank_mask:0x2
  v_mfma_f32_16x16x32_bf16 v[84:87], a[168:171], a[4:7], v[84:87]
  s_waitcnt vmcnt(22)
  v_sub_u32 v140, v136, v129
  v_min_u32 v138, v139, v140
  v_mfma_f32_16x16x32_bf16 v[88:91], a[168:171], a[8:11], v[88:91]
  ds_read_b64_tr_b16 a[188:189], v155 offset:24576
  v_sub_u32 v141, v136, v130
  v_mfma_f32_16x16x32_bf16 v[88:91], a[172:175], a[24:27], v[88:91]
  s_barrier
  v_sub_u32 v142, v136, v131
  v_min3_u32 v138, v138, v141, v142
  v_mfma_f32_16x16x32_bf16 v[92:95], a[172:175], a[28:31], v[92:95]
  ds_read_b64_tr_b16 a[190:191], v155 offset:25600
  v_sub_u32 v139, v136, v132
  v_mfma_f32_16x16x32_bf16 v[92:95], a[168:171], a[12:15], v[92:95]
  s_waitcnt lgkmcnt(4)
  v_sub_u32 v140, v136, v133
  v_min3_u32 v138, v138, v139, v140
  v_mfma_f32_16x16x32_bf16 v[96:99], a[176:179], a[0:3], v[96:99]
  ds_read_b64_tr_b16 a[160:161], v148 offset:0
  v_sub_u32 v141, v136, v134
  v_mfma_f32_16x16x32_bf16 v[96:99], a[180:183], a[16:19], v[96:99]
  buffer_load_dwordx4 a[120:123], v243, s[24:27], s30 offen offset:2048 sc1
  v_mfma_f32_16x16x32_bf16 v[100:103], a[180:183], a[20:23], v[100:103]
  ds_read_b64_tr_b16 a[162:163], v148 offset:1024
  v_sub_u32 v142, v136, v135
  v_mfma_f32_16x16x32_bf16 v[100:103], a[176:179], a[4:7], v[100:103]
  v_min3_u32 v138, v138, v141, v142
  v_mfma_f32_16x16x32_bf16 v[104:107], a[176:179], a[8:11], v[104:107]
  ds_read_b64_tr_b16 a[164:165], v148 offset:8192
  v_min_u32_dpp v138, v138, v138 row_ror:8 row_mask:0xf bank_mask:0xf
  v_mfma_f32_16x16x32_bf16 v[104:107], a[180:183], a[24:27], v[104:107]
  buffer_load_dwordx4 v241, s[20:23], s31 offen offset:3072 lds
  s_add_u32 s31, s31, 0x80000
  v_mfma_f32_16x16x32_bf16 v[108:111], a[180:183], a[28:31], v[108:111]
  ds_read_b64_tr_b16 a[166:167], v148 offset:9216
  v_min_u32_dpp v138, v138, v138 row_ror:4 row_mask:0xf bank_mask:0xf
  v_mfma_f32_16x16x32_bf16 v[108:111], a[176:179], a[12:15], v[108:111]
  s_waitcnt lgkmcnt(4)
  v_min_u32_dpp v138, v138, v138 row_ror:2 row_mask:0xf bank_mask:0xf
  v_mfma_f32_16x16x32_bf16 v[112:115], a[184:187], a[0:3], v[112:115]
  ds_read_b64_tr_b16 a[168:169], v149 offset:0
  v_min_u32_dpp v138, v138, v138 row_ror:1 row_mask:0xf bank_mask:0xf
  v_mfma_f32_16x16x32_bf16 v[112:115], a[188:191], a[16:19], v[112:115]
  buffer_load_dwordx4 a[124:127], v243, s[24:27], s30 offen offset:3072 sc1
  s_add_u32 s30, s30, 8192
  v_mfma_f32_16x16x32_bf16 v[116:119], a[188:191], a[20:23], v[116:119]
  ds_read_b64_tr_b16 a[170:171], v149 offset:1024
  v_sub_u32 v137, v136, v138
  v_mfma_f32_16x16x32_bf16 v[116:119], a[184:187], a[4:7], v[116:119]
  v_add_u32 v136, -1, v137
  v_sub_u32 v139, v136, v128
  v_mfma_f32_16x16x32_bf16 v[120:123], a[184:187], a[8:11], v[120:123]
  ds_read_b64_tr_b16 a[172:173], v149 offset:8192
  v_mov_b32_dpp v144, v137 quad_perm:[0,1,2,3] row_mask:0xf bank_mask:0x4
  v_mfma_f32_16x16x32_bf16 v[120:123], a[188:191], a[24:27], v[120:123]
  v_sub_u32 v140, v136, v129
  v_min_u32 v138, v139, v140
  v_mfma_f32_16x16x32_bf16 v[124:127], a[188:191], a[28:31], v[124:127]
  ds_read_b64_tr_b16 a[174:175], v149 offset:9216
  v_sub_u32 v141, v136, v130
  v_mfma_f32_16x16x32_bf16 v[124:127], a[184:187], a[12:15], v[124:127]
  s_waitcnt vmcnt(24) lgkmcnt(4)
  v_sub_u32 v142, v136, v131
  v_min3_u32 v138, v138, v141, v142
  v_mfma_f32_16x16x32_bf16 v[0:3], a[160:163], a[32:35], v[0:3]
  ds_read_b64_tr_b16 a[176:177], v150 offset:0
  v_sub_u32 v139, v136, v132
  v_mfma_f32_16x16x32_bf16 v[0:3], a[164:167], a[48:51], v[0:3]
  buffer_load_dwordx4 a[0:3], v242, s[24:27], s30 offen offset:0 sc1
  v_mfma_f32_16x16x32_bf16 v[4:7], a[164:167], a[52:55], v[4:7]
  ds_read_b64_tr_b16 a[178:179], v150 offset:1024
  v_sub_u32 v140, v136, v133
  v_mfma_f32_16x16x32_bf16 v[4:7], a[160:163], a[36:39], v[4:7]
  v_min3_u32 v138, v138, v139, v140
  v_sub_u32 v141, v136, v134
  v_mfma_f32_16x16x32_bf16 v[8:11], a[160:163], a[40:43], v[8:11]
  ds_read_b64_tr_b16 a[180:181], v150 offset:8192
  s_add_u32 m0, s28, 98304
  v_sub_u32 v142, v136, v135
  v_mfma_f32_16x16x32_bf16 v[8:11], a[164:167], a[56:59], v[8:11]
  buffer_load_dwordx4 v238, s[20:23], s31 offen offset:0 lds
  v_mfma_f32_16x16x32_bf16 v[12:15], a[164:167], a[60:63], v[12:15]
  ds_read_b64_tr_b16 a[182:183], v150 offset:9216
  v_min3_u32 v138, v138, v141, v142
  v_mfma_f32_16x16x32_bf16 v[12:15], a[160:163], a[44:47], v[12:15]
  s_waitcnt lgkmcnt(4)
  v_min_u32_dpp v138, v138, v138 row_ror:8 row_mask:0xf bank_mask:0xf
  v_mfma_f32_16x16x32_bf16 v[16:19], a[168:171], a[32:35], v[16:19]
  ds_read_b64_tr_b16 a[184:185], v151 offset:0
  v_min_u32_dpp v138, v138, v138 row_ror:4 row_mask:0xf bank_mask:0xf
  v_mfma_f32_16x16x32_bf16 v[16:19], a[172:175], a[48:51], v[16:19]
  buffer_load_dwordx4 a[4:7], v242, s[24:27], s30 offen offset:1024 sc1
  v_mfma_f32_16x16x32_bf16 v[20:23], a[172:175], a[52:55], v[20:23]
  ds_read_b64_tr_b16 a[186:187], v151 offset:1024
  v_min_u32_dpp v138, v138, v138 row_ror:2 row_mask:0xf bank_mask:0xf
  v_mfma_f32_16x16x32_bf16 v[20:23], a[168:171], a[36:39], v[20:23]
  v_mfma_f32_16x16x32_bf16 v[24:27], a[168:171], a[40:43], v[24:27]
  ds_read_b64_tr_b16 a[188:189], v151 offset:8192
  v_min_u32_dpp v138, v138, v138 row_ror:1 row_mask:0xf bank_mask:0xf
  v_mfma_f32_16x16x32_bf16 v[24:27], a[172:175], a[56:59], v[24:27]
  v_sub_u32 v137, v136, v138
  v_add_u32 v136, -1, v137
  v_mfma_f32_16x16x32_bf16 v[28:31], a[172:175], a[60:63], v[28:31]
  ds_read_b64_tr_b16 a[190:191], v151 offset:9216
  v_sub_u32 v139, v136, v128
  v_mfma_f32_16x16x32_bf16 v[28:31], a[168:171], a[44:47], v[28:31]
  s_waitcnt lgkmcnt(4)
  v_mov_b32_dpp v144, v137 quad_perm:[0,1,2,3] row_mask:0xf bank_mask:0x8
  v_sub_u32 v140, v136, v129
  v_mfma_f32_16x16x32_bf16 v[32:35], a[176:179], a[32:35], v[32:35]
  ds_read_b64_tr_b16 a[160:161], v152 offset:0
  v_min_u32 v138, v139, v140
  v_mfma_f32_16x16x32_bf16 v[32:35], a[180:183], a[48:51], v[32:35]
  buffer_load_dwordx4 a[8:11], v242, s[24:27], s30 offen offset:2048 sc1
  v_mfma_f32_16x16x32_bf16 v[36:39], a[180:183], a[52:55], v[36:39]
  ds_read_b64_tr_b16 a[162:163], v152 offset:1024
  v_sub_u32 v141, v136, v130
  v_mfma_f32_16x16x32_bf16 v[36:39], a[176:179], a[36:39], v[36:39]
  v_sub_u32 v142, v136, v131
  v_min3_u32 v138, v138, v141, v142
  v_mfma_f32_16x16x32_bf16 v[40:43], a[176:179], a[40:43], v[40:43]
  ds_read_b64_tr_b16 a[164:165], v152 offset:8192
  v_sub_u32 v139, v136, v132
  v_mfma_f32_16x16x32_bf16 v[40:43], a[180:183], a[56:59], v[40:43]
  buffer_load_dwordx4 v239, s[20:23], s31 offen offset:1024 lds
  v_mfma_f32_16x16x32_bf16 v[44:47], a[180:183], a[60:63], v[44:47]
  ds_read_b64_tr_b16 a[166:167], v152 offset:9216
  v_sub_u32 v140, v136, v133
  v_mfma_f32_16x16x32_bf16 v[44:47], a[176:179], a[44:47], v[44:47]
  s_waitcnt lgkmcnt(4)
  v_min3_u32 v138, v138, v139, v140
  v_sub_u32 v141, v136, v134
  v_mfma_f32_16x16x32_bf16 v[48:51], a[184:187], a[32:35], v[48:51]
  ds_read_b64_tr_b16 a[168:169], v153 offset:0
  v_sub_u32 v142, v136, v135
  v_mfma_f32_16x16x32_bf16 v[48:51], a[188:191], a[48:51], v[48:51]
  buffer_load_dwordx4 a[12:15], v242, s[24:27], s30 offen offset:3072 sc1
  v_mfma_f32_16x16x32_bf16 v[52:55], a[188:191], a[52:55], v[52:55]
  ds_read_b64_tr_b16 a[170:171], v153 offset:1024
  v_min3_u32 v138, v138, v141, v142
  v_mfma_f32_16x16x32_bf16 v[52:55], a[184:187], a[36:39], v[52:55]
  v_mfma_f32_16x16x32_bf16 v[56:59], a[184:187], a[40:43], v[56:59]
  ds_read_b64_tr_b16 a[172:173], v153 offset:8192
  v_min_u32_dpp v138, v138, v138 row_ror:8 row_mask:0xf bank_mask:0xf
  v_mfma_f32_16x16x32_bf16 v[56:59], a[188:191], a[56:59], v[56:59]
  v_mfma_f32_16x16x32_bf16 v[60:63], a[188:191], a[60:63], v[60:63]
  ds_read_b64_tr_b16 a[174:175], v153 offset:9216
  v_min_u32_dpp v138, v138, v138 row_ror:4 row_mask:0xf bank_mask:0xf
  v_mfma_f32_16x16x32_bf16 v[60:63], a[184:187], a[44:47], v[60:63]
  s_waitcnt lgkmcnt(4)
  v_min_u32_dpp v138, v138, v138 row_ror:2 row_mask:0xf bank_mask:0xf
  v_mfma_f32_16x16x32_bf16 v[64:67], a[160:163], a[32:35], v[64:67]
  ds_read_b64_tr_b16 a[176:177], v154 offset:0
  v_min_u32_dpp v138, v138, v138 row_ror:1 row_mask:0xf bank_mask:0xf
  v_mfma_f32_16x16x32_bf16 v[64:67], a[164:167], a[48:51], v[64:67]
  buffer_load_dwordx4 a[16:19], v243, s[24:27], s30 offen offset:0 sc1
  v_mfma_f32_16x16x32_bf16 v[68:71], a[164:167], a[52:55], v[68:71]
  ds_read_b64_tr_b16 a[178:179], v154 offset:1024
  v_sub_u32 v137, v136, v138
  v_mfma_f32_16x16x32_bf16 v[68:71], a[160:163], a[36:39], v[68:71]
  v_add_u32 v136, -1, v137
  v_sub_u32 v139, v136, v128
  v_mfma_f32_16x16x32_bf16 v[72:75], a[160:163], a[40:43], v[72:75]
  ds_read_b64_tr_b16 a[180:181], v154 offset:8192
  v_mov_b32_dpp v145, v137 quad_perm:[0,1,2,3] row_mask:0xf bank_mask:0x1
  v_mfma_f32_16x16x32_bf16 v[72:75], a[164:167], a[56:59], v[72:75]
  buffer_load_dwordx4 v240, s[20:23], s31 offen offset:2048 lds
  v_mfma_f32_16x16x32_bf16 v[76:79], a[164:167], a[60:63], v[76:79]
  ds_read_b64_tr_b16 a[182:183], v154 offset:9216
  v_sub_u32 v140, v136, v129
  v_mfma_f32_16x16x32_bf16 v[76:79], a[160:163], a[44:47], v[76:79]
  s_waitcnt lgkmcnt(4)
  v_min_u32 v138, v139, v140
  v_sub_u32 v141, v136, v130
  v_mfma_f32_16x16x32_bf16 v[80:83], a[168:171], a[32:35], v[80:83]
  ds_read_b64_tr_b16 a[184:185], v155 offset:0
  v_sub_u32 v142, v136, v131
  v_mfma_f32_16x16x32_bf16 v[80:83], a[172:175], a[48:51], v[80:83]
  buffer_load_dwordx4 a[20:23], v243, s[24:27], s30 offen offset:1024 sc1
  v_mfma_f32_16x16x32_bf16 v[84:87], a[172:175], a[52:55], v[84:87]
  ds_read_b64_tr_b16 a[186:187], v155 offset:1024
  v_min3_u32 v138, v138, v141, v142
  v_mfma_f32_16x16x32_bf16 v[84:87], a[168:171], a[36:39], v[84:87]
  s_waitcnt vmcnt(22)
  v_sub_u32 v139, v136, v132
  v_sub_u32 v140, v136, v133
  v_mfma_f32_16x16x32_bf16 v[88:91], a[168:171], a[40:43], v[88:91]
  ds_read_b64_tr_b16 a[188:189], v155 offset:8192
  v_min3_u32 v138, v138, v139, v140
  v_mfma_f32_16x16x32_bf16 v[88:91], a[172:175], a[56:59], v[88:91]
  s_barrier
  v_sub_u32 v141, v136, v134
  v_sub_u32 v142, v136, v135
  v_mfma_f32_16x16x32_bf16 v[92:95], a[172:175], a[60:63], v[92:95]
  ds_read_b64_tr_b16 a[190:191], v155 offset:9216
  v_min3_u32 v138, v138, v141, v142
  v_mfma_f32_16x16x32_bf16 v[92:95], a[168:171], a[44:47], v[92:95]
  s_waitcnt lgkmcnt(4)
  v_min_u32_dpp v138, v138, v138 row_ror:8 row_mask:0xf bank_mask:0xf
  v_mfma_f32_16x16x32_bf16 v[96:99], a[176:179], a[32:35], v[96:99]
  ds_read_b64_tr_b16 a[160:161], v224 offset:0
  v_min_u32_dpp v138, v138, v138 row_ror:4 row_mask:0xf bank_mask:0xf
  v_mfma_f32_16x16x32_bf16 v[96:99], a[180:183], a[48:51], v[96:99]
  buffer_load_dwordx4 a[24:27], v243, s[24:27], s30 offen offset:2048 sc1
  v_mfma_f32_16x16x32_bf16 v[100:103], a[180:183], a[52:55], v[100:103]
  ds_read_b64_tr_b16 a[162:163], v224 offset:1024
  v_min_u32_dpp v138, v138, v138 row_ror:2 row_mask:0xf bank_mask:0xf
  v_mfma_f32_16x16x32_bf16 v[100:103], a[176:179], a[36:39], v[100:103]
  v_mfma_f32_16x16x32_bf16 v[104:107], a[176:179], a[40:43], v[104:107]
  ds_read_b64_tr_b16 a[164:165], v224 offset:8192
  v_min_u32_dpp v138, v138, v138 row_ror:1 row_mask:0xf bank_mask:0xf
  v_mfma_f32_16x16x32_bf16 v[104:107], a[180:183], a[56:59], v[104:107]
  buffer_load_dwordx4 v241, s[20:23], s31 offen offset:3072 lds
  s_add_u32 s31, s31, 0x80000
  v_mfma_f32_16x16x32_bf16 v[108:111], a[180:183], a[60:63], v[108:111]
  ds_read_b64_tr_b16 a[166:167], v224 offset:9216
  v_sub_u32 v137, v136, v138
  v_mfma_f32_16x16x32_bf16 v[108:111], a[176:179], a[44:47], v[108:111]
  s_waitcnt lgkmcnt(4)
  v_add_u32 v136, -1, v137
  v_sub_u32 v139, v136, v128
  v_mfma_f32_16x16x32_bf16 v[112:115], a[184:187], a[32:35], v[112:115]
  ds_read_b64_tr_b16 a[168:169], v225 offset:0
  v_mov_b32_dpp v145, v137 quad_perm:[0,1,2,3] row_mask:0xf bank_mask:0x2
  v_mfma_f32_16x16x32_bf16 v[112:115], a[188:191], a[48:51], v[112:115]
  buffer_load_dwordx4 a[28:31], v243, s[24:27], s30 offen offset:3072 sc1
  s_add_u32 s30, s30, 8192
  v_mfma_f32_16x16x32_bf16 v[116:119], a[188:191], a[52:55], v[116:119]
  ds_read_b64_tr_b16 a[170:171], v225 offset:1024
  v_sub_u32 v140, v136, v129
  v_mfma_f32_16x16x32_bf16 v[116:119], a[184:187], a[36:39], v[116:119]
  v_min_u32 v138, v139, v140
  v_sub_u32 v141, v136, v130
  v_mfma_f32_16x16x32_bf16 v[120:123], a[184:187], a[40:43], v[120:123]
  ds_read_b64_tr_b16 a[172:173], v225 offset:8192
  v_sub_u32 v142, v136, v131
  v_mfma_f32_16x16x32_bf16 v[120:123], a[188:191], a[56:59], v[120:123]
  v_min3_u32 v138, v138, v141, v142
  v_sub_u32 v139, v136, v132
  v_mfma_f32_16x16x32_bf16 v[124:127], a[188:191], a[60:63], v[124:127]
  ds_read_b64_tr_b16 a[174:175], v225 offset:9216
  v_sub_u32 v140, v136, v133
  v_mfma_f32_16x16x32_bf16 v[124:127], a[184:187], a[44:47], v[124:127]
  s_waitcnt vmcnt(24) lgkmcnt(4)
  v_min3_u32 v138, v138, v139, v140
  v_sub_u32 v141, v136, v134
  v_mfma_f32_16x16x32_bf16 v[0:3], a[160:163], a[64:67], v[0:3]
  ds_read_b64_tr_b16 a[176:177], v226 offset:0
  v_sub_u32 v142, v136, v135
  v_mfma_f32_16x16x32_bf16 v[0:3], a[164:167], a[80:83], v[0:3]
  buffer_load_dwordx4 a[32:35], v242, s[24:27], s30 offen offset:0 sc1
  v_mfma_f32_16x16x32_bf16 v[4:7], a[164:167], a[84:87], v[4:7]
  ds_read_b64_tr_b16 a[178:179], v226 offset:1024
  v_min3_u32 v138, v138, v141, v142
  v_mfma_f32_16x16x32_bf16 v[4:7], a[160:163], a[68:71], v[4:7]
  v_mfma_f32_16x16x32_bf16 v[8:11], a[160:163], a[72:75], v[8:11]
  ds_read_b64_tr_b16 a[180:181], v226 offset:8192
  s_add_u32 m0, s28, 114688
  v_min_u32_dpp v138, v138, v138 row_ror:8 row_mask:0xf bank_mask:0xf
  v_mfma_f32_16x16x32_bf16 v[8:11], a[164:167], a[88:91], v[8:11]
  buffer_load_dwordx4 v238, s[20:23], s31 offen offset:0 lds
  v_mfma_f32_16x16x32_bf16 v[12:15], a[164:167], a[92:95], v[12:15]
  ds_read_b64_tr_b16 a[182:183], v226 offset:9216
  v_min_u32_dpp v138, v138, v138 row_ror:4 row_mask:0xf bank_mask:0xf
  v_mfma_f32_16x16x32_bf16 v[12:15], a[160:163], a[76:79], v[12:15]
  s_waitcnt lgkmcnt(4)
  v_min_u32_dpp v138, v138, v138 row_ror:2 row_mask:0xf bank_mask:0xf
  v_mfma_f32_16x16x32_bf16 v[16:19], a[168:171], a[64:67], v[16:19]
  ds_read_b64_tr_b16 a[184:185], v227 offset:0
  v_min_u32_dpp v138, v138, v138 row_ror:1 row_mask:0xf bank_mask:0xf
  v_mfma_f32_16x16x32_bf16 v[16:19], a[172:175], a[80:83], v[16:19]
  buffer_load_dwordx4 a[36:39], v242, s[24:27], s30 offen offset:1024 sc1
  v_mfma_f32_16x16x32_bf16 v[20:23], a[172:175], a[84:87], v[20:23]
  ds_read_b64_tr_b16 a[186:187], v227 offset:1024
  v_sub_u32 v137, v136, v138
  v_mfma_f32_16x16x32_bf16 v[20:23], a[168:171], a[68:71], v[20:23]
  v_add_u32 v136, -1, v137
  v_sub_u32 v139, v136, v128
  v_mfma_f32_16x16x32_bf16 v[24:27], a[168:171], a[72:75], v[24:27]
  ds_read_b64_tr_b16 a[188:189], v227 offset:8192
  v_mov_b32_dpp v145, v137 quad_perm:[0,1,2,3] row_mask:0xf bank_mask:0x4
  v_mfma_f32_16x16x32_bf16 v[24:27], a[172:175], a[88:91], v[24:27]
  v_sub_u32 v140, v136, v129
  v_min_u32 v138, v139, v140
  v_mfma_f32_16x16x32_bf16 v[28:31], a[172:175], a[92:95], v[28:31]
  ds_read_b64_tr_b16 a[190:191], v227 offset:9216
  v_sub_u32 v141, v136, v130
  v_mfma_f32_16x16x32_bf16 v[28:31], a[168:171], a[76:79], v[28:31]
  s_waitcnt lgkmcnt(4)
  v_sub_u32 v142, v136, v131
  v_min3_u32 v138, v138, v141, v142
  v_mfma_f32_16x16x32_bf16 v[32:35], a[176:179], a[64:67], v[32:35]
  ds_read_b64_tr_b16 a[160:161], v228 offset:0
  v_sub_u32 v139, v136, v132
  v_mfma_f32_16x16x32_bf16 v[32:35], a[180:183], a[80:83], v[32:35]
  buffer_load_dwordx4 a[40:43], v242, s[24:27], s30 offen offset:2048 sc1
  v_mfma_f32_16x16x32_bf16 v[36:39], a[180:183], a[84:87], v[36:39]
  ds_read_b64_tr_b16 a[162:163], v228 offset:1024
  v_sub_u32 v140, v136, v133
  v_mfma_f32_16x16x32_bf16 v[36:39], a[176:179], a[68:71], v[36:39]
  v_min3_u32 v138, v138, v139, v140
  v_sub_u32 v141, v136, v134
  v_mfma_f32_16x16x32_bf16 v[40:43], a[176:179], a[72:75], v[40:43]
  ds_read_b64_tr_b16 a[164:165], v228 offset:8192
  v_sub_u32 v142, v136, v135
  v_mfma_f32_16x16x32_bf16 v[40:43], a[180:183], a[88:91], v[40:43]
  buffer_load_dwordx4 v239, s[20:23], s31 offen offset:1024 lds
  v_mfma_f32_16x16x32_bf16 v[44:47], a[180:183], a[92:95], v[44:47]
  ds_read_b64_tr_b16 a[166:167], v228 offset:9216
  v_min3_u32 v138, v138, v141, v142
  v_mfma_f32_16x16x32_bf16 v[44:47], a[176:179], a[76:79], v[44:47]
  s_waitcnt lgkmcnt(4)
  v_min_u32_dpp v138, v138, v138 row_ror:8 row_mask:0xf bank_mask:0xf
  v_mfma_f32_16x16x32_bf16 v[48:51], a[184:187], a[64:67], v[48:51]
  ds_read_b64_tr_b16 a[168:169], v229 offset:0
  v_min_u32_dpp v138, v138, v138 row_ror:4 row_mask:0xf bank_mask:0xf
  v_mfma_f32_16x16x32_bf16 v[48:51], a[188:191], a[80:83], v[48:51]
  buffer_load_dwordx4 a[44:47], v242, s[24:27], s30 offen offset:3072 sc1
  v_mfma_f32_16x16x32_bf16 v[52:55], a[188:191], a[84:87], v[52:55]
  ds_read_b64_tr_b16 a[170:171], v229 offset:1024
  v_min_u32_dpp v138, v138, v138 row_ror:2 row_mask:0xf bank_mask:0xf
  v_mfma_f32_16x16x32_bf16 v[52:55], a[184:187], a[68:71], v[52:55]
  v_mfma_f32_16x16x32_bf16 v[56:59], a[184:187], a[72:75], v[56:59]
  ds_read_b64_tr_b16 a[172:173], v229 offset:8192
  v_min_u32_dpp v138, v138, v138 row_ror:1 row_mask:0xf bank_mask:0xf
  v_mfma_f32_16x16x32_bf16 v[56:59], a[188:191], a[88:91], v[56:59]
  v_sub_u32 v137, v136, v138
  v_add_u32 v136, -1, v137
  v_mfma_f32_16x16x32_bf16 v[60:63], a[188:191], a[92:95], v[60:63]
  ds_read_b64_tr_b16 a[174:175], v229 offset:9216
  v_mov_b32_dpp v145, v137 quad_perm:[0,1,2,3] row_mask:0xf bank_mask:0x8
  v_mfma_f32_16x16x32_bf16 v[60:63], a[184:187], a[76:79], v[60:63]
  s_waitcnt lgkmcnt(4)
  s_lshl_b32 s35, s3, 9
  s_add_u32 s35, s35, 157696
  v_lshrrev_b32 v136, 1, v242
  v_add_u32 v136, s35, v136
  v_mfma_f32_16x16x32_bf16 v[64:67], a[160:163], a[64:67], v[64:67]
  ds_read_b64_tr_b16 a[176:177], v230 offset:0
  ds_write_b64 v136, v[144:145]
  v_mfma_f32_16x16x32_bf16 v[64:67], a[164:167], a[80:83], v[64:67]
  buffer_load_dwordx4 a[48:51], v243, s[24:27], s30 offen offset:0 sc1
  v_mfma_f32_16x16x32_bf16 v[68:71], a[164:167], a[84:87], v[68:71]
  ds_read_b64_tr_b16 a[178:179], v230 offset:1024
  v_mfma_f32_16x16x32_bf16 v[68:71], a[160:163], a[68:71], v[68:71]
  v_mfma_f32_16x16x32_bf16 v[72:75], a[160:163], a[72:75], v[72:75]
  ds_read_b64_tr_b16 a[180:181], v230 offset:8192
  v_mfma_f32_16x16x32_bf16 v[72:75], a[164:167], a[88:91], v[72:75]
  buffer_load_dwordx4 v240, s[20:23], s31 offen offset:2048 lds
  v_mfma_f32_16x16x32_bf16 v[76:79], a[164:167], a[92:95], v[76:79]
  ds_read_b64_tr_b16 a[182:183], v230 offset:9216
  v_mfma_f32_16x16x32_bf16 v[76:79], a[160:163], a[76:79], v[76:79]
  s_waitcnt lgkmcnt(5)
  v_mfma_f32_16x16x32_bf16 v[80:83], a[168:171], a[64:67], v[80:83]
  ds_read_b64_tr_b16 a[184:185], v231 offset:0
  s_waitcnt lgkmcnt(4)
  v_mfma_f32_16x16x32_bf16 v[80:83], a[172:175], a[80:83], v[80:83]
  buffer_load_dwordx4 a[52:55], v243, s[24:27], s30 offen offset:1024 sc1
  v_mfma_f32_16x16x32_bf16 v[84:87], a[172:175], a[84:87], v[84:87]
  ds_read_b64_tr_b16 a[186:187], v231 offset:1024
  v_mfma_f32_16x16x32_bf16 v[84:87], a[168:171], a[68:71], v[84:87]
  s_waitcnt vmcnt(22)
  v_mfma_f32_16x16x32_bf16 v[88:91], a[168:171], a[72:75], v[88:91]
  ds_read_b64_tr_b16 a[188:189], v231 offset:8192
  v_mfma_f32_16x16x32_bf16 v[88:91], a[172:175], a[88:91], v[88:91]
  s_barrier
  v_mfma_f32_16x16x32_bf16 v[92:95], a[172:175], a[92:95], v[92:95]
  ds_read_b64_tr_b16 a[190:191], v231 offset:9216
  v_lshlrev_b32 v137, 1, v242
  v_mfma_f32_16x16x32_bf16 v[92:95], a[168:171], a[76:79], v[92:95]
  s_waitcnt lgkmcnt(4)
  v_add_u32 v137, 157696, v137
  v_mfma_f32_16x16x32_bf16 v[96:99], a[176:179], a[64:67], v[96:99]
  ds_read_b64_tr_b16 a[160:161], v224 offset:16384
  ds_read_b64 v[128:129], v137
  v_mfma_f32_16x16x32_bf16 v[96:99], a[180:183], a[80:83], v[96:99]
  buffer_load_dwordx4 a[56:59], v243, s[24:27], s30 offen offset:2048 sc1
  v_mfma_f32_16x16x32_bf16 v[100:103], a[180:183], a[84:87], v[100:103]
  ds_read_b64_tr_b16 a[162:163], v224 offset:17408
  v_mfma_f32_16x16x32_bf16 v[100:103], a[176:179], a[68:71], v[100:103]
  v_mfma_f32_16x16x32_bf16 v[104:107], a[176:179], a[72:75], v[104:107]
  ds_read_b64_tr_b16 a[164:165], v224 offset:24576
  v_mfma_f32_16x16x32_bf16 v[104:107], a[180:183], a[88:91], v[104:107]
  buffer_load_dwordx4 v241, s[20:23], s31 offen offset:3072 lds
  s_add_u32 s31, s31, 0x80000
  v_mfma_f32_16x16x32_bf16 v[108:111], a[180:183], a[92:95], v[108:111]
  ds_read_b64_tr_b16 a[166:167], v224 offset:25600
  v_mfma_f32_16x16x32_bf16 v[108:111], a[176:179], a[76:79], v[108:111]
  s_waitcnt lgkmcnt(5)
  v_mfma_f32_16x16x32_bf16 v[112:115], a[184:187], a[64:67], v[112:115]
  ds_read_b64_tr_b16 a[168:169], v225 offset:16384
  s_waitcnt lgkmcnt(4)
  v_mov_b32 v137, -1
  v_mfma_f32_16x16x32_bf16 v[112:115], a[188:191], a[80:83], v[112:115]
  buffer_load_dwordx4 a[60:63], v243, s[24:27], s30 offen offset:3072 sc1
  s_add_u32 s30, s30, 8192
  v_mfma_f32_16x16x32_bf16 v[116:119], a[188:191], a[84:87], v[116:119]
  ds_read_b64_tr_b16 a[170:171], v225 offset:17408
  v_sub_u32 v140, v137, v128
  v_mfma_f32_16x16x32_bf16 v[116:119], a[184:187], a[68:71], v[116:119]
  v_sub_u32 v141, v137, v129
  v_min_u32 v139, v140, v141
  v_mfma_f32_16x16x32_bf16 v[120:123], a[184:187], a[72:75], v[120:123]
  ds_read_b64_tr_b16 a[172:173], v225 offset:24576
  v_min_u32_dpp v139, v139, v139 row_ror:8 row_mask:0xf bank_mask:0xf
  v_mfma_f32_16x16x32_bf16 v[120:123], a[188:191], a[88:91], v[120:123]
  v_mfma_f32_16x16x32_bf16 v[124:127], a[188:191], a[92:95], v[124:127]
  ds_read_b64_tr_b16 a[174:175], v225 offset:25600
  v_min_u32_dpp v139, v139, v139 row_ror:4 row_mask:0xf bank_mask:0xf
  v_mfma_f32_16x16x32_bf16 v[124:127], a[184:187], a[76:79], v[124:127]
  s_waitcnt vmcnt(24) lgkmcnt(4)
  v_min_u32_dpp v139, v139, v139 row_ror:2 row_mask:0xf bank_mask:0xf
  v_mfma_f32_16x16x32_bf16 v[0:3], a[160:163], a[96:99], v[0:3]
  ds_read_b64_tr_b16 a[176:177], v226 offset:16384
  v_min_u32_dpp v139, v139, v139 row_ror:1 row_mask:0xf bank_mask:0xf
  v_mfma_f32_16x16x32_bf16 v[0:3], a[164:167], a[112:115], v[0:3]
  v_mov_b32 v140, v139
  v_mfma_f32_16x16x32_bf16 v[4:7], a[164:167], a[116:119], v[4:7]
  ds_read_b64_tr_b16 a[178:179], v226 offset:17408
  v_permlane16_swap_b32 v139, v140
  v_mfma_f32_16x16x32_bf16 v[4:7], a[160:163], a[100:103], v[4:7]
  v_min_u32 v139, v139, v140
  v_mov_b32 v140, v139
  v_mfma_f32_16x16x32_bf16 v[8:11], a[160:163], a[104:107], v[8:11]
  ds_read_b64_tr_b16 a[180:181], v226 offset:24576
  s_add_u32 m0, s28, 0
  v_permlane32_swap_b32 v139, v140
  v_mfma_f32_16x16x32_bf16 v[8:11], a[164:167], a[120:123], v[8:11]
  buffer_load_dwordx4 v232, s[12:15], s29 offen offset:0 lds
  v_mfma_f32_16x16x32_bf16 v[12:15], a[164:167], a[124:127], v[12:15]
  ds_read_b64_tr_b16 a[182:183], v226 offset:25600
  v_min_u32 v139, v139, v140
  v_mfma_f32_16x16x32_bf16 v[12:15], a[160:163], a[108:111], v[12:15]
  s_waitcnt lgkmcnt(4)
  v_sub_u32 v138, v137, v139
  v_add_u32 v137, -1, v138
  v_mfma_f32_16x16x32_bf16 v[16:19], a[168:171], a[96:99], v[16:19]
  ds_read_b64_tr_b16 a[184:185], v227 offset:16384
  v_sub_u32 v140, v137, v128
  v_mfma_f32_16x16x32_bf16 v[16:19], a[172:175], a[112:115], v[16:19]
  v_readfirstlane_b32 s52, v138
  v_sub_u32 v141, v137, v129
  v_mfma_f32_16x16x32_bf16 v[20:23], a[172:175], a[116:119], v[20:23]
  ds_read_b64_tr_b16 a[186:187], v227 offset:17408
  v_min_u32 v139, v140, v141
  v_mfma_f32_16x16x32_bf16 v[20:23], a[168:171], a[100:103], v[20:23]
  v_mfma_f32_16x16x32_bf16 v[24:27], a[168:171], a[104:107], v[24:27]
  ds_read_b64_tr_b16 a[188:189], v227 offset:24576
  v_min_u32_dpp v139, v139, v139 row_ror:8 row_mask:0xf bank_mask:0xf
  v_mfma_f32_16x16x32_bf16 v[24:27], a[172:175], a[120:123], v[24:27]
  v_mfma_f32_16x16x32_bf16 v[28:31], a[172:175], a[124:127], v[28:31]
  ds_read_b64_tr_b16 a[190:191], v227 offset:25600
  v_min_u32_dpp v139, v139, v139 row_ror:4 row_mask:0xf bank_mask:0xf
  v_mfma_f32_16x16x32_bf16 v[28:31], a[168:171], a[108:111], v[28:31]
  s_waitcnt lgkmcnt(4)
  v_min_u32_dpp v139, v139, v139 row_ror:2 row_mask:0xf bank_mask:0xf
  v_mfma_f32_16x16x32_bf16 v[32:35], a[176:179], a[96:99], v[32:35]
  ds_read_b64_tr_b16 a[160:161], v228 offset:16384
  v_min_u32_dpp v139, v139, v139 row_ror:1 row_mask:0xf bank_mask:0xf
  v_mfma_f32_16x16x32_bf16 v[32:35], a[180:183], a[112:115], v[32:35]
  v_mov_b32 v140, v139
  v_mfma_f32_16x16x32_bf16 v[36:39], a[180:183], a[116:119], v[36:39]
  ds_read_b64_tr_b16 a[162:163], v228 offset:17408
  v_permlane16_swap_b32 v139, v140
  v_mfma_f32_16x16x32_bf16 v[36:39], a[176:179], a[100:103], v[36:39]
  v_min_u32 v139, v139, v140
  v_mov_b32 v140, v139
  v_mfma_f32_16x16x32_bf16 v[40:43], a[176:179], a[104:107], v[40:43]
  ds_read_b64_tr_b16 a[164:165], v228 offset:24576
  v_permlane32_swap_b32 v139, v140
  v_mfma_f32_16x16x32_bf16 v[40:43], a[180:183], a[120:123], v[40:43]
  buffer_load_dwordx4 v233, s[12:15], s29 offen offset:1024 lds
  v_mfma_f32_16x16x32_bf16 v[44:47], a[180:183], a[124:127], v[44:47]
  ds_read_b64_tr_b16 a[166:167], v228 offset:25600
  v_min_u32 v139, v139, v140
  v_mfma_f32_16x16x32_bf16 v[44:47], a[176:179], a[108:111], v[44:47]
  s_waitcnt lgkmcnt(4)
  v_sub_u32 v138, v137, v139
  v_add_u32 v137, -1, v138
  v_mfma_f32_16x16x32_bf16 v[48:51], a[184:187], a[96:99], v[48:51]
  ds_read_b64_tr_b16 a[168:169], v229 offset:16384
  v_sub_u32 v140, v137, v128
  v_mfma_f32_16x16x32_bf16 v[48:51], a[188:191], a[112:115], v[48:51]
  v_readfirstlane_b32 s53, v138
  v_sub_u32 v141, v137, v129
  v_mfma_f32_16x16x32_bf16 v[52:55], a[188:191], a[116:119], v[52:55]
  ds_read_b64_tr_b16 a[170:171], v229 offset:17408
  v_min_u32 v139, v140, v141
  v_mfma_f32_16x16x32_bf16 v[52:55], a[184:187], a[100:103], v[52:55]
  v_mfma_f32_16x16x32_bf16 v[56:59], a[184:187], a[104:107], v[56:59]
  ds_read_b64_tr_b16 a[172:173], v229 offset:24576
  v_min_u32_dpp v139, v139, v139 row_ror:8 row_mask:0xf bank_mask:0xf
  v_mfma_f32_16x16x32_bf16 v[56:59], a[188:191], a[120:123], v[56:59]
  v_mfma_f32_16x16x32_bf16 v[60:63], a[188:191], a[124:127], v[60:63]
  ds_read_b64_tr_b16 a[174:175], v229 offset:25600
  v_min_u32_dpp v139, v139, v139 row_ror:4 row_mask:0xf bank_mask:0xf
  v_mfma_f32_16x16x32_bf16 v[60:63], a[184:187], a[108:111], v[60:63]
  s_waitcnt lgkmcnt(4)
  v_min_u32_dpp v139, v139, v139 row_ror:2 row_mask:0xf bank_mask:0xf
  v_mfma_f32_16x16x32_bf16 v[64:67], a[160:163], a[96:99], v[64:67]
  ds_read_b64_tr_b16 a[176:177], v230 offset:16384
  v_min_u32_dpp v139, v139, v139 row_ror:1 row_mask:0xf bank_mask:0xf
  v_mfma_f32_16x16x32_bf16 v[64:67], a[164:167], a[112:115], v[64:67]
  v_mov_b32 v140, v139
  v_mfma_f32_16x16x32_bf16 v[68:71], a[164:167], a[116:119], v[68:71]
  ds_read_b64_tr_b16 a[178:179], v230 offset:17408
  v_permlane16_swap_b32 v139, v140
  v_mfma_f32_16x16x32_bf16 v[68:71], a[160:163], a[100:103], v[68:71]
  v_min_u32 v139, v139, v140
  v_mov_b32 v140, v139
  v_mfma_f32_16x16x32_bf16 v[72:75], a[160:163], a[104:107], v[72:75]
  ds_read_b64_tr_b16 a[180:181], v230 offset:24576
  v_permlane32_swap_b32 v139, v140
  v_mfma_f32_16x16x32_bf16 v[72:75], a[164:167], a[120:123], v[72:75]
  buffer_load_dwordx4 v234, s[12:15], s29 offen offset:2048 lds
  v_mfma_f32_16x16x32_bf16 v[76:79], a[164:167], a[124:127], v[76:79]
  ds_read_b64_tr_b16 a[182:183], v230 offset:25600
  v_min_u32 v139, v139, v140
  v_mfma_f32_16x16x32_bf16 v[76:79], a[160:163], a[108:111], v[76:79]
  s_waitcnt lgkmcnt(4)
  v_sub_u32 v138, v137, v139
  v_add_u32 v137, -1, v138
  v_mfma_f32_16x16x32_bf16 v[80:83], a[168:171], a[96:99], v[80:83]
  ds_read_b64_tr_b16 a[184:185], v231 offset:16384
  v_sub_u32 v140, v137, v128
  v_mfma_f32_16x16x32_bf16 v[80:83], a[172:175], a[112:115], v[80:83]
  v_readfirstlane_b32 s54, v138
  v_sub_u32 v141, v137, v129
  v_mfma_f32_16x16x32_bf16 v[84:87], a[172:175], a[116:119], v[84:87]
  ds_read_b64_tr_b16 a[186:187], v231 offset:17408
  v_min_u32 v139, v140, v141
  v_mfma_f32_16x16x32_bf16 v[84:87], a[168:171], a[100:103], v[84:87]
  s_waitcnt vmcnt(16)
  v_min_u32_dpp v139, v139, v139 row_ror:8 row_mask:0xf bank_mask:0xf
  v_mfma_f32_16x16x32_bf16 v[88:91], a[168:171], a[104:107], v[88:91]
  ds_read_b64_tr_b16 a[188:189], v231 offset:24576
  v_min_u32_dpp v139, v139, v139 row_ror:4 row_mask:0xf bank_mask:0xf
  v_mfma_f32_16x16x32_bf16 v[88:91], a[172:175], a[120:123], v[88:91]
  s_barrier
  v_min_u32_dpp v139, v139, v139 row_ror:2 row_mask:0xf bank_mask:0xf
  v_mfma_f32_16x16x32_bf16 v[92:95], a[172:175], a[124:127], v[92:95]
  ds_read_b64_tr_b16 a[190:191], v231 offset:25600
  v_min_u32_dpp v139, v139, v139 row_ror:1 row_mask:0xf bank_mask:0xf
  v_mfma_f32_16x16x32_bf16 v[92:95], a[168:171], a[108:111], v[92:95]
  s_waitcnt lgkmcnt(4)
  v_mov_b32 v140, v139
  v_mfma_f32_16x16x32_bf16 v[96:99], a[176:179], a[96:99], v[96:99]
  ds_read_b64_tr_b16 a[160:161], v224 offset:32768
  v_permlane16_swap_b32 v139, v140
  v_mfma_f32_16x16x32_bf16 v[96:99], a[180:183], a[112:115], v[96:99]
  v_min_u32 v139, v139, v140
  v_mov_b32 v140, v139
  v_mfma_f32_16x16x32_bf16 v[100:103], a[180:183], a[116:119], v[100:103]
  ds_read_b64_tr_b16 a[162:163], v224 offset:33792
  v_permlane32_swap_b32 v139, v140
  v_mfma_f32_16x16x32_bf16 v[100:103], a[176:179], a[100:103], v[100:103]
  v_min_u32 v139, v139, v140
  v_sub_u32 v138, v137, v139
  v_mfma_f32_16x16x32_bf16 v[104:107], a[176:179], a[104:107], v[104:107]
  ds_read_b64_tr_b16 a[164:165], v224 offset:40960
  v_add_u32 v137, -1, v138
  v_mfma_f32_16x16x32_bf16 v[104:107], a[180:183], a[120:123], v[104:107]
  buffer_load_dwordx4 v235, s[12:15], s29 offen offset:3072 lds
  v_mfma_f32_16x16x32_bf16 v[108:111], a[180:183], a[124:127], v[108:111]
  ds_read_b64_tr_b16 a[166:167], v224 offset:41984
  v_sub_u32 v140, v137, v128
  v_mfma_f32_16x16x32_bf16 v[108:111], a[176:179], a[108:111], v[108:111]
  s_waitcnt lgkmcnt(4)
  v_readfirstlane_b32 s55, v138
  v_sub_u32 v141, v137, v129
  v_mfma_f32_16x16x32_bf16 v[112:115], a[184:187], a[96:99], v[112:115]
  ds_read_b64_tr_b16 a[168:169], v225 offset:32768
  v_min_u32 v139, v140, v141
  v_mfma_f32_16x16x32_bf16 v[112:115], a[188:191], a[112:115], v[112:115]
  v_mfma_f32_16x16x32_bf16 v[116:119], a[188:191], a[116:119], v[116:119]
  ds_read_b64_tr_b16 a[170:171], v225 offset:33792
  v_min_u32_dpp v139, v139, v139 row_ror:8 row_mask:0xf bank_mask:0xf
  v_mfma_f32_16x16x32_bf16 v[116:119], a[184:187], a[100:103], v[116:119]
  v_mfma_f32_16x16x32_bf16 v[120:123], a[184:187], a[104:107], v[120:123]
  ds_read_b64_tr_b16 a[172:173], v225 offset:40960
  v_min_u32_dpp v139, v139, v139 row_ror:4 row_mask:0xf bank_mask:0xf
  v_mfma_f32_16x16x32_bf16 v[120:123], a[188:191], a[120:123], v[120:123]
  v_mfma_f32_16x16x32_bf16 v[124:127], a[188:191], a[124:127], v[124:127]
  ds_read_b64_tr_b16 a[174:175], v225 offset:41984
  v_min_u32_dpp v139, v139, v139 row_ror:2 row_mask:0xf bank_mask:0xf
  v_mfma_f32_16x16x32_bf16 v[124:127], a[184:187], a[108:111], v[124:127]
  s_waitcnt vmcnt(16) lgkmcnt(4)
  v_min_u32_dpp v139, v139, v139 row_ror:1 row_mask:0xf bank_mask:0xf
  v_mov_b32 v140, v139
  v_mfma_f32_16x16x32_bf16 v[0:3], a[160:163], a[0:3], v[0:3]
  ds_read_b64_tr_b16 a[176:177], v226 offset:32768
  v_permlane16_swap_b32 v139, v140
  v_mfma_f32_16x16x32_bf16 v[0:3], a[164:167], a[16:19], v[0:3]
  v_min_u32 v139, v139, v140
  v_mov_b32 v140, v139
  v_mfma_f32_16x16x32_bf16 v[4:7], a[164:167], a[20:23], v[4:7]
  ds_read_b64_tr_b16 a[178:179], v226 offset:33792
  v_permlane32_swap_b32 v139, v140
  v_mfma_f32_16x16x32_bf16 v[4:7], a[160:163], a[4:7], v[4:7]
  v_min_u32 v139, v139, v140
  v_sub_u32 v138, v137, v139
  v_mfma_f32_16x16x32_bf16 v[8:11], a[160:163], a[8:11], v[8:11]
  ds_read_b64_tr_b16 a[180:181], v226 offset:40960
  s_add_u32 m0, s28, 65536
  v_add_u32 v137, -1, v138
  v_mfma_f32_16x16x32_bf16 v[8:11], a[164:167], a[24:27], v[8:11]
  buffer_load_dwordx4 v236, s[16:19], s29 offen offset:0 lds
  v_mfma_f32_16x16x32_bf16 v[12:15], a[164:167], a[28:31], v[12:15]
  ds_read_b64_tr_b16 a[182:183], v226 offset:41984
  v_sub_u32 v140, v137, v128
  v_mfma_f32_16x16x32_bf16 v[12:15], a[160:163], a[12:15], v[12:15]
  s_waitcnt lgkmcnt(4)
  v_readfirstlane_b32 s56, v138
  v_sub_u32 v141, v137, v129
  v_mfma_f32_16x16x32_bf16 v[16:19], a[168:171], a[0:3], v[16:19]
  ds_read_b64_tr_b16 a[184:185], v227 offset:32768
  v_min_u32 v139, v140, v141
  v_mfma_f32_16x16x32_bf16 v[16:19], a[172:175], a[16:19], v[16:19]
  v_mfma_f32_16x16x32_bf16 v[20:23], a[172:175], a[20:23], v[20:23]
  ds_read_b64_tr_b16 a[186:187], v227 offset:33792
  v_min_u32_dpp v139, v139, v139 row_ror:8 row_mask:0xf bank_mask:0xf
  v_mfma_f32_16x16x32_bf16 v[20:23], a[168:171], a[4:7], v[20:23]
  v_mfma_f32_16x16x32_bf16 v[24:27], a[168:171], a[8:11], v[24:27]
  ds_read_b64_tr_b16 a[188:189], v227 offset:40960
  v_min_u32_dpp v139, v139, v139 row_ror:4 row_mask:0xf bank_mask:0xf
  v_mfma_f32_16x16x32_bf16 v[24:27], a[172:175], a[24:27], v[24:27]
  v_mfma_f32_16x16x32_bf16 v[28:31], a[172:175], a[28:31], v[28:31]
  ds_read_b64_tr_b16 a[190:191], v227 offset:41984
  v_min_u32_dpp v139, v139, v139 row_ror:2 row_mask:0xf bank_mask:0xf
  v_mfma_f32_16x16x32_bf16 v[28:31], a[168:171], a[12:15], v[28:31]
  s_waitcnt lgkmcnt(4)
  v_min_u32_dpp v139, v139, v139 row_ror:1 row_mask:0xf bank_mask:0xf
  v_mov_b32 v140, v139
  v_mfma_f32_16x16x32_bf16 v[32:35], a[176:179], a[0:3], v[32:35]
  ds_read_b64_tr_b16 a[160:161], v228 offset:32768
  v_permlane16_swap_b32 v139, v140
  v_mfma_f32_16x16x32_bf16 v[32:35], a[180:183], a[16:19], v[32:35]
  v_min_u32 v139, v139, v140
  v_mov_b32 v140, v139
  v_mfma_f32_16x16x32_bf16 v[36:39], a[180:183], a[20:23], v[36:39]
  ds_read_b64_tr_b16 a[162:163], v228 offset:33792
  v_permlane32_swap_b32 v139, v140
  v_mfma_f32_16x16x32_bf16 v[36:39], a[176:179], a[4:7], v[36:39]
  v_min_u32 v139, v139, v140
  v_sub_u32 v138, v137, v139
  v_mfma_f32_16x16x32_bf16 v[40:43], a[176:179], a[8:11], v[40:43]
  ds_read_b64_tr_b16 a[164:165], v228 offset:40960
  v_add_u32 v137, -1, v138
  v_mfma_f32_16x16x32_bf16 v[40:43], a[180:183], a[24:27], v[40:43]
  buffer_load_dwordx4 v237, s[16:19], s29 offen offset:1024 lds
  v_mfma_f32_16x16x32_bf16 v[44:47], a[180:183], a[28:31], v[44:47]
  ds_read_b64_tr_b16 a[166:167], v228 offset:41984
  v_sub_u32 v140, v137, v128
  v_mfma_f32_16x16x32_bf16 v[44:47], a[176:179], a[12:15], v[44:47]
  s_waitcnt lgkmcnt(4)
  v_readfirstlane_b32 s57, v138
  v_sub_u32 v141, v137, v129
  v_mfma_f32_16x16x32_bf16 v[48:51], a[184:187], a[0:3], v[48:51]
  ds_read_b64_tr_b16 a[168:169], v229 offset:32768
  v_min_u32 v139, v140, v141
  v_mfma_f32_16x16x32_bf16 v[48:51], a[188:191], a[16:19], v[48:51]
  v_mfma_f32_16x16x32_bf16 v[52:55], a[188:191], a[20:23], v[52:55]
  ds_read_b64_tr_b16 a[170:171], v229 offset:33792
  v_min_u32_dpp v139, v139, v139 row_ror:8 row_mask:0xf bank_mask:0xf
  v_mfma_f32_16x16x32_bf16 v[52:55], a[184:187], a[4:7], v[52:55]
  v_mfma_f32_16x16x32_bf16 v[56:59], a[184:187], a[8:11], v[56:59]
  ds_read_b64_tr_b16 a[172:173], v229 offset:40960
  v_min_u32_dpp v139, v139, v139 row_ror:4 row_mask:0xf bank_mask:0xf
  v_mfma_f32_16x16x32_bf16 v[56:59], a[188:191], a[24:27], v[56:59]
  v_mfma_f32_16x16x32_bf16 v[60:63], a[188:191], a[28:31], v[60:63]
  ds_read_b64_tr_b16 a[174:175], v229 offset:41984
  v_min_u32_dpp v139, v139, v139 row_ror:2 row_mask:0xf bank_mask:0xf
  v_mfma_f32_16x16x32_bf16 v[60:63], a[184:187], a[12:15], v[60:63]
  s_waitcnt lgkmcnt(4)
  v_min_u32_dpp v139, v139, v139 row_ror:1 row_mask:0xf bank_mask:0xf
  v_mov_b32 v140, v139
  v_mfma_f32_16x16x32_bf16 v[64:67], a[160:163], a[0:3], v[64:67]
  ds_read_b64_tr_b16 a[176:177], v230 offset:32768
  v_permlane16_swap_b32 v139, v140
  v_mfma_f32_16x16x32_bf16 v[64:67], a[164:167], a[16:19], v[64:67]
  v_min_u32 v139, v139, v140
  v_mov_b32 v140, v139
  v_mfma_f32_16x16x32_bf16 v[68:71], a[164:167], a[20:23], v[68:71]
  ds_read_b64_tr_b16 a[178:179], v230 offset:33792
  v_permlane32_swap_b32 v139, v140
  v_mfma_f32_16x16x32_bf16 v[68:71], a[160:163], a[4:7], v[68:71]
  v_min_u32 v139, v139, v140
  v_sub_u32 v138, v137, v139
  v_mfma_f32_16x16x32_bf16 v[72:75], a[160:163], a[8:11], v[72:75]
  ds_read_b64_tr_b16 a[180:181], v230 offset:40960
  v_add_u32 v137, -1, v138
  v_mfma_f32_16x16x32_bf16 v[72:75], a[164:167], a[24:27], v[72:75]
  buffer_load_dwordx4 v236, s[16:19], s29 offen offset:2048 lds
  v_mfma_f32_16x16x32_bf16 v[76:79], a[164:167], a[28:31], v[76:79]
  ds_read_b64_tr_b16 a[182:183], v230 offset:41984
  v_sub_u32 v140, v137, v128
  v_mfma_f32_16x16x32_bf16 v[76:79], a[160:163], a[12:15], v[76:79]
  s_waitcnt lgkmcnt(4)
  v_readfirstlane_b32 s58, v138
  v_sub_u32 v141, v137, v129
  v_mfma_f32_16x16x32_bf16 v[80:83], a[168:171], a[0:3], v[80:83]
  ds_read_b64_tr_b16 a[184:185], v231 offset:32768
  v_min_u32 v139, v140, v141
  v_mfma_f32_16x16x32_bf16 v[80:83], a[172:175], a[16:19], v[80:83]
  v_mfma_f32_16x16x32_bf16 v[84:87], a[172:175], a[20:23], v[84:87]
  ds_read_b64_tr_b16 a[186:187], v231 offset:33792
  v_min_u32_dpp v139, v139, v139 row_ror:8 row_mask:0xf bank_mask:0xf
  v_mfma_f32_16x16x32_bf16 v[84:87], a[168:171], a[4:7], v[84:87]
  s_waitcnt vmcnt(8)
  v_min_u32_dpp v139, v139, v139 row_ror:4 row_mask:0xf bank_mask:0xf
  v_mfma_f32_16x16x32_bf16 v[88:91], a[168:171], a[8:11], v[88:91]
  ds_read_b64_tr_b16 a[188:189], v231 offset:40960
  v_min_u32_dpp v139, v139, v139 row_ror:2 row_mask:0xf bank_mask:0xf
  v_mfma_f32_16x16x32_bf16 v[88:91], a[172:175], a[24:27], v[88:91]
  s_barrier
  v_min_u32_dpp v139, v139, v139 row_ror:1 row_mask:0xf bank_mask:0xf
  v_mov_b32 v140, v139
  v_mfma_f32_16x16x32_bf16 v[92:95], a[172:175], a[28:31], v[92:95]
  ds_read_b64_tr_b16 a[190:191], v231 offset:41984
  v_permlane16_swap_b32 v139, v140
  v_mfma_f32_16x16x32_bf16 v[92:95], a[168:171], a[12:15], v[92:95]
  s_waitcnt lgkmcnt(4)
  v_min_u32 v139, v139, v140
  v_mov_b32 v140, v139
  v_mfma_f32_16x16x32_bf16 v[96:99], a[176:179], a[0:3], v[96:99]
  ds_read_b64_tr_b16 a[160:161], v224 offset:49152
  v_permlane32_swap_b32 v139, v140
  v_mfma_f32_16x16x32_bf16 v[96:99], a[180:183], a[16:19], v[96:99]
  v_min_u32 v139, v139, v140
  v_sub_u32 v138, v137, v139
  v_mfma_f32_16x16x32_bf16 v[100:103], a[180:183], a[20:23], v[100:103]
  ds_read_b64_tr_b16 a[162:163], v224 offset:50176
  v_add_u32 v137, -1, v138
  v_mfma_f32_16x16x32_bf16 v[100:103], a[176:179], a[4:7], v[100:103]
  v_readfirstlane_b32 s59, v138
  v_lshrrev_b32 v136, 4, v242
  v_mfma_f32_16x16x32_bf16 v[104:107], a[176:179], a[8:11], v[104:107]
  ds_read_b64_tr_b16 a[164:165], v224 offset:57344
  v_mov_b32 v128, 0
  v_mfma_f32_16x16x32_bf16 v[104:107], a[180:183], a[24:27], v[104:107]
  buffer_load_dwordx4 v237, s[16:19], s29 offen offset:3072 lds
  s_add_u32 s29, s29, 16384
  v_mfma_f32_16x16x32_bf16 v[108:111], a[180:183], a[28:31], v[108:111]
  ds_read_b64_tr_b16 a[166:167], v224 offset:58368
  v_writelane_b32 v128, s52, 0
  v_mfma_f32_16x16x32_bf16 v[108:111], a[176:179], a[12:15], v[108:111]
  s_waitcnt lgkmcnt(4)
  v_writelane_b32 v128, s53, 1
  v_writelane_b32 v128, s54, 2
  v_mfma_f32_16x16x32_bf16 v[112:115], a[184:187], a[0:3], v[112:115]
  ds_read_b64_tr_b16 a[168:169], v225 offset:49152
  v_writelane_b32 v128, s55, 3
  v_mfma_f32_16x16x32_bf16 v[112:115], a[188:191], a[16:19], v[112:115]
  v_writelane_b32 v128, s56, 4
  v_writelane_b32 v128, s57, 5
  v_mfma_f32_16x16x32_bf16 v[116:119], a[188:191], a[20:23], v[116:119]
  ds_read_b64_tr_b16 a[170:171], v225 offset:50176
  v_writelane_b32 v128, s58, 6
  v_mfma_f32_16x16x32_bf16 v[116:119], a[184:187], a[4:7], v[116:119]
  v_writelane_b32 v128, s59, 7
  v_and_b32 v129, 0xffff, v128
  v_mfma_f32_16x16x32_bf16 v[120:123], a[184:187], a[8:11], v[120:123]
  ds_read_b64_tr_b16 a[172:173], v225 offset:57344
  v_sub_u32 v129, 0xffff, v129
  v_mfma_f32_16x16x32_bf16 v[120:123], a[188:191], a[24:27], v[120:123]
  v_and_b32 v129, 0x7ff, v129
  v_mov_b32 v130, v129
  v_mfma_f32_16x16x32_bf16 v[124:127], a[188:191], a[28:31], v[124:127]
  ds_read_b64_tr_b16 a[174:175], v225 offset:58368
  v_permlane16_swap_b32 v129, v130
  v_mfma_f32_16x16x32_bf16 v[124:127], a[184:187], a[12:15], v[124:127]
  s_waitcnt vmcnt(8) lgkmcnt(4)
  v_mov_b32 v130, v129
  v_mfma_f32_16x16x32_bf16 v[0:3], a[160:163], a[32:35], v[0:3]
  ds_read_b64_tr_b16 a[176:177], v226 offset:49152
  s_add_u32 m0, s28, 16384
  v_permlane32_swap_b32 v129, v130
  v_mfma_f32_16x16x32_bf16 v[0:3], a[164:167], a[48:51], v[0:3]
  buffer_load_dwordx4 v232, s[12:15], s29 offen offset:0 lds
  v_mfma_f32_16x16x32_bf16 v[4:7], a[164:167], a[52:55], v[4:7]
  ds_read_b64_tr_b16 a[178:179], v226 offset:50176
  v_lshrrev_b32 v130, 6, v129
  v_mfma_f32_16x16x32_bf16 v[4:7], a[160:163], a[36:39], v[4:7]
  v_mul_u32_u24 v130, 0x14000, v130
  v_bfe_u32 v131, v129, 4, 2
  v_mfma_f32_16x16x32_bf16 v[8:11], a[160:163], a[40:43], v[8:11]
  ds_read_b64_tr_b16 a[180:181], v226 offset:57344
  v_lshl_add_u32 v130, v131, 10, v130
  v_mfma_f32_16x16x32_bf16 v[8:11], a[164:167], a[56:59], v[8:11]
  buffer_load_dwordx4 v233, s[12:15], s29 offen offset:1024 lds
  v_mfma_f32_16x16x32_bf16 v[12:15], a[164:167], a[60:63], v[12:15]
  ds_read_b64_tr_b16 a[182:183], v226 offset:58368
  v_and_b32 v131, 15, v129
  v_mfma_f32_16x16x32_bf16 v[12:15], a[160:163], a[44:47], v[12:15]
  s_waitcnt lgkmcnt(4)
  v_lshl_add_u32 v130, v131, 4, v130
  v_lshrrev_b32 v131, 4, v136
  v_mfma_f32_16x16x32_bf16 v[16:19], a[168:171], a[32:35], v[16:19]
  ds_read_b64_tr_b16 a[184:185], v227 offset:49152
  v_lshl_add_u32 v243, v131, 8, v130
  v_mfma_f32_16x16x32_bf16 v[16:19], a[172:175], a[48:51], v[16:19]
  buffer_load_dwordx4 v234, s[12:15], s29 offen offset:2048 lds
  v_mfma_f32_16x16x32_bf16 v[20:23], a[172:175], a[52:55], v[20:23]
  ds_read_b64_tr_b16 a[186:187], v227 offset:50176
  v_mfma_f32_16x16x32_bf16 v[20:23], a[168:171], a[36:39], v[20:23]
  buffer_load_dwordx4 v235, s[12:15], s29 offen offset:3072 lds
  v_mfma_f32_16x16x32_bf16 v[24:27], a[168:171], a[40:43], v[24:27]
  ds_read_b64_tr_b16 a[188:189], v227 offset:57344
  v_mfma_f32_16x16x32_bf16 v[24:27], a[172:175], a[56:59], v[24:27]
  v_mul_f32 v0, s34, v0
  v_mul_f32 v1, s34, v1
  v_mfma_f32_16x16x32_bf16 v[28:31], a[172:175], a[60:63], v[28:31]
  ds_read_b64_tr_b16 a[190:191], v227 offset:58368
  v_mul_f32 v2, s34, v2
  v_mfma_f32_16x16x32_bf16 v[28:31], a[168:171], a[44:47], v[28:31]
  s_waitcnt lgkmcnt(4)
  v_mul_f32 v3, s34, v3
  v_mul_f32 v16, s34, v16
  v_mfma_f32_16x16x32_bf16 v[32:35], a[176:179], a[32:35], v[32:35]
  ds_read_b64_tr_b16 a[160:161], v228 offset:49152
  v_mul_f32 v17, s34, v17
  v_mfma_f32_16x16x32_bf16 v[32:35], a[180:183], a[48:51], v[32:35]
  v_mul_f32 v18, s34, v18
  v_mul_f32 v19, s34, v19
  v_mfma_f32_16x16x32_bf16 v[36:39], a[180:183], a[52:55], v[36:39]
  ds_read_b64_tr_b16 a[162:163], v228 offset:50176
  v_cvt_pk_bf16_f32 v128, v0, v1
  v_mfma_f32_16x16x32_bf16 v[36:39], a[176:179], a[36:39], v[36:39]
  v_cvt_pk_bf16_f32 v129, v2, v3
  v_cvt_pk_bf16_f32 v130, v16, v17
  v_mfma_f32_16x16x32_bf16 v[40:43], a[176:179], a[40:43], v[40:43]
  ds_read_b64_tr_b16 a[164:165], v228 offset:57344
  v_cvt_pk_bf16_f32 v131, v18, v19
  v_mfma_f32_16x16x32_bf16 v[40:43], a[180:183], a[56:59], v[40:43]
  v_mul_f32 v4, s34, v4
  v_mul_f32 v5, s34, v5
  v_mfma_f32_16x16x32_bf16 v[44:47], a[180:183], a[60:63], v[44:47]
  ds_read_b64_tr_b16 a[166:167], v228 offset:58368
  v_mul_f32 v6, s34, v6
  v_mfma_f32_16x16x32_bf16 v[44:47], a[176:179], a[44:47], v[44:47]
  s_waitcnt lgkmcnt(4)
  v_mul_f32 v7, s34, v7
  v_mul_f32 v20, s34, v20
  v_mfma_f32_16x16x32_bf16 v[48:51], a[184:187], a[32:35], v[48:51]
  ds_read_b64_tr_b16 a[168:169], v229 offset:49152
  v_mul_f32 v21, s34, v21
  v_mfma_f32_16x16x32_bf16 v[48:51], a[188:191], a[48:51], v[48:51]
  v_mul_f32 v22, s34, v22
  v_mul_f32 v23, s34, v23
  v_mfma_f32_16x16x32_bf16 v[52:55], a[188:191], a[52:55], v[52:55]
  ds_read_b64_tr_b16 a[170:171], v229 offset:50176
  v_cvt_pk_bf16_f32 v144, v4, v5
  v_mfma_f32_16x16x32_bf16 v[52:55], a[184:187], a[36:39], v[52:55]
  v_cvt_pk_bf16_f32 v145, v6, v7
  v_cvt_pk_bf16_f32 v146, v20, v21
  v_mfma_f32_16x16x32_bf16 v[56:59], a[184:187], a[40:43], v[56:59]
  ds_read_b64_tr_b16 a[172:173], v229 offset:57344
  v_cvt_pk_bf16_f32 v147, v22, v23
  v_mfma_f32_16x16x32_bf16 v[56:59], a[188:191], a[56:59], v[56:59]
  v_permlane16_swap_b32 v128, v130
  v_permlane16_swap_b32 v129, v131
  v_mfma_f32_16x16x32_bf16 v[60:63], a[188:191], a[60:63], v[60:63]
  ds_read_b64_tr_b16 a[174:175], v229 offset:58368
  v_mul_f32 v8, s34, v8
  v_mfma_f32_16x16x32_bf16 v[60:63], a[184:187], a[44:47], v[60:63]
  s_waitcnt lgkmcnt(4)
  v_mul_f32 v9, s34, v9
  v_mul_f32 v10, s34, v10
  v_mfma_f32_16x16x32_bf16 v[64:67], a[160:163], a[32:35], v[64:67]
  ds_read_b64_tr_b16 a[176:177], v230 offset:49152
  v_mul_f32 v11, s34, v11
  v_mfma_f32_16x16x32_bf16 v[64:67], a[164:167], a[48:51], v[64:67]
  v_mul_f32 v24, s34, v24
  v_mul_f32 v25, s34, v25
  v_mfma_f32_16x16x32_bf16 v[68:71], a[164:167], a[52:55], v[68:71]
  ds_read_b64_tr_b16 a[178:179], v230 offset:50176
  v_mul_f32 v26, s34, v26
  v_mfma_f32_16x16x32_bf16 v[68:71], a[160:163], a[36:39], v[68:71]
  v_mul_f32 v27, s34, v27
  v_cvt_pk_bf16_f32 v160, v8, v9
  v_mfma_f32_16x16x32_bf16 v[72:75], a[160:163], a[40:43], v[72:75]
  ds_read_b64_tr_b16 a[180:181], v230 offset:57344
  v_cvt_pk_bf16_f32 v161, v10, v11
  v_mfma_f32_16x16x32_bf16 v[72:75], a[164:167], a[56:59], v[72:75]
  v_cvt_pk_bf16_f32 v162, v24, v25
  v_cvt_pk_bf16_f32 v163, v26, v27
  v_mfma_f32_16x16x32_bf16 v[76:79], a[164:167], a[60:63], v[76:79]
  ds_read_b64_tr_b16 a[182:183], v230 offset:58368
  v_permlane16_swap_b32 v144, v146
  v_mfma_f32_16x16x32_bf16 v[76:79], a[160:163], a[44:47], v[76:79]
  s_waitcnt lgkmcnt(4)
  v_permlane16_swap_b32 v145, v147
  v_mul_f32 v12, s34, v12
  v_mfma_f32_16x16x32_bf16 v[80:83], a[168:171], a[32:35], v[80:83]
  ds_read_b64_tr_b16 a[184:185], v231 offset:49152
  v_mul_f32 v13, s34, v13
  v_mfma_f32_16x16x32_bf16 v[80:83], a[172:175], a[48:51], v[80:83]
  v_mul_f32 v14, s34, v14
  v_mul_f32 v15, s34, v15
  v_mfma_f32_16x16x32_bf16 v[84:87], a[172:175], a[52:55], v[84:87]
  ds_read_b64_tr_b16 a[186:187], v231 offset:50176
  v_mul_f32 v28, s34, v28
  v_mfma_f32_16x16x32_bf16 v[84:87], a[168:171], a[36:39], v[84:87]
  s_waitcnt vmcnt(8)
  v_mul_f32 v29, s34, v29
  v_mul_f32 v30, s34, v30
  v_mfma_f32_16x16x32_bf16 v[88:91], a[168:171], a[40:43], v[88:91]
  ds_read_b64_tr_b16 a[188:189], v231 offset:57344
  v_mul_f32 v31, s34, v31
  v_mfma_f32_16x16x32_bf16 v[88:91], a[172:175], a[56:59], v[88:91]
  s_barrier
  v_cvt_pk_bf16_f32 v176, v12, v13
  v_cvt_pk_bf16_f32 v177, v14, v15
  v_mfma_f32_16x16x32_bf16 v[92:95], a[172:175], a[60:63], v[92:95]
  ds_read_b64_tr_b16 a[190:191], v231 offset:58368
  v_cvt_pk_bf16_f32 v178, v28, v29
  v_mfma_f32_16x16x32_bf16 v[92:95], a[168:171], a[44:47], v[92:95]
  s_waitcnt lgkmcnt(4)
  v_cvt_pk_bf16_f32 v179, v30, v31
  v_permlane16_swap_b32 v160, v162
  v_mfma_f32_16x16x32_bf16 v[96:99], a[176:179], a[32:35], v[96:99]
  ds_read_b128 a[128:131], v212 offset:0
  v_permlane16_swap_b32 v161, v163
  v_mfma_f32_16x16x32_bf16 v[96:99], a[180:183], a[48:51], v[96:99]
  v_mul_f32 v32, s34, v32
  v_mul_f32 v33, s34, v33
  v_mfma_f32_16x16x32_bf16 v[100:103], a[180:183], a[52:55], v[100:103]
  ds_read_b128 a[132:135], v213 offset:0
  v_mul_f32 v34, s34, v34
  v_mfma_f32_16x16x32_bf16 v[100:103], a[176:179], a[36:39], v[100:103]
  v_mul_f32 v35, s34, v35
  v_mul_f32 v48, s34, v48
  v_mfma_f32_16x16x32_bf16 v[104:107], a[176:179], a[40:43], v[104:107]
  ds_read_b128 a[136:139], v214 offset:0
  v_mul_f32 v49, s34, v49
  v_mfma_f32_16x16x32_bf16 v[104:107], a[180:183], a[56:59], v[104:107]
  v_mul_f32 v50, s34, v50
  v_mul_f32 v51, s34, v51
  v_mfma_f32_16x16x32_bf16 v[108:111], a[180:183], a[60:63], v[108:111]
  ds_read_b128 a[140:143], v215 offset:0
  v_cvt_pk_bf16_f32 v132, v32, v33
  v_mfma_f32_16x16x32_bf16 v[108:111], a[176:179], a[44:47], v[108:111]
  s_waitcnt lgkmcnt(4)
  v_cvt_pk_bf16_f32 v133, v34, v35
  v_cvt_pk_bf16_f32 v134, v48, v49
  v_mfma_f32_16x16x32_bf16 v[112:115], a[184:187], a[32:35], v[112:115]
  v_cvt_pk_bf16_f32 v135, v50, v51
  v_permlane16_swap_b32 v176, v178
  v_mfma_f32_16x16x32_bf16 v[112:115], a[188:191], a[48:51], v[112:115]
  v_permlane16_swap_b32 v177, v179
  v_mul_f32 v36, s34, v36
  v_mfma_f32_16x16x32_bf16 v[116:119], a[188:191], a[52:55], v[116:119]
  v_mul_f32 v37, s34, v37
  v_mul_f32 v38, s34, v38
  v_mfma_f32_16x16x32_bf16 v[116:119], a[184:187], a[36:39], v[116:119]
  v_mul_f32 v39, s34, v39
  v_mul_f32 v52, s34, v52
  v_mfma_f32_16x16x32_bf16 v[120:123], a[184:187], a[40:43], v[120:123]
  v_mul_f32 v53, s34, v53
  v_mul_f32 v54, s34, v54
  v_mfma_f32_16x16x32_bf16 v[120:123], a[188:191], a[56:59], v[120:123]
  v_mul_f32 v55, s34, v55
  v_cvt_pk_bf16_f32 v148, v36, v37
  v_mfma_f32_16x16x32_bf16 v[124:127], a[188:191], a[60:63], v[124:127]
  v_cvt_pk_bf16_f32 v149, v38, v39
  v_cvt_pk_bf16_f32 v150, v52, v53
  v_mfma_f32_16x16x32_bf16 v[124:127], a[184:187], a[44:47], v[124:127]
  s_waitcnt lgkmcnt(0)
  v_cvt_pk_bf16_f32 v151, v54, v55
  v_permlane16_swap_b32 v132, v134
  v_permlane16_swap_b32 v133, v135
  v_pk_mul_f32 v[40:41], v[40:41], s[34:35] op_sel_hi:[1,0]
  v_pk_mul_f32 v[42:43], v[42:43], s[34:35] op_sel_hi:[1,0]
  v_pk_mul_f32 v[56:57], v[56:57], s[34:35] op_sel_hi:[1,0]
  v_pk_mul_f32 v[58:59], v[58:59], s[34:35] op_sel_hi:[1,0]
  v_cvt_pk_bf16_f32 v164, v40, v41
  v_cvt_pk_bf16_f32 v165, v42, v43
  v_cvt_pk_bf16_f32 v166, v56, v57
  v_cvt_pk_bf16_f32 v167, v58, v59
  v_permlane16_swap_b32 v148, v150
  v_permlane16_swap_b32 v149, v151
  v_pk_mul_f32 v[44:45], v[44:45], s[34:35] op_sel_hi:[1,0]
  v_pk_mul_f32 v[46:47], v[46:47], s[34:35] op_sel_hi:[1,0]
  v_pk_mul_f32 v[60:61], v[60:61], s[34:35] op_sel_hi:[1,0]
  v_pk_mul_f32 v[62:63], v[62:63], s[34:35] op_sel_hi:[1,0]
  v_cvt_pk_bf16_f32 v180, v44, v45
  v_cvt_pk_bf16_f32 v181, v46, v47
  v_cvt_pk_bf16_f32 v182, v60, v61
  v_cvt_pk_bf16_f32 v183, v62, v63
  v_permlane16_swap_b32 v164, v166
  v_permlane16_swap_b32 v165, v167
  v_pk_mul_f32 v[64:65], v[64:65], s[34:35] op_sel_hi:[1,0]
  v_pk_mul_f32 v[66:67], v[66:67], s[34:35] op_sel_hi:[1,0]
  v_pk_mul_f32 v[80:81], v[80:81], s[34:35] op_sel_hi:[1,0]
  v_pk_mul_f32 v[82:83], v[82:83], s[34:35] op_sel_hi:[1,0]
  v_cvt_pk_bf16_f32 v136, v64, v65
  v_cvt_pk_bf16_f32 v137, v66, v67
  v_cvt_pk_bf16_f32 v138, v80, v81
  v_cvt_pk_bf16_f32 v139, v82, v83
  v_permlane16_swap_b32 v180, v182
  v_permlane16_swap_b32 v181, v183
  v_pk_mul_f32 v[68:69], v[68:69], s[34:35] op_sel_hi:[1,0]
  v_pk_mul_f32 v[70:71], v[70:71], s[34:35] op_sel_hi:[1,0]
  v_pk_mul_f32 v[84:85], v[84:85], s[34:35] op_sel_hi:[1,0]
  v_pk_mul_f32 v[86:87], v[86:87], s[34:35] op_sel_hi:[1,0]
  v_cvt_pk_bf16_f32 v152, v68, v69
  v_cvt_pk_bf16_f32 v153, v70, v71
  v_cvt_pk_bf16_f32 v154, v84, v85
  v_cvt_pk_bf16_f32 v155, v86, v87
  v_permlane16_swap_b32 v136, v138
  v_permlane16_swap_b32 v137, v139
  v_pk_mul_f32 v[72:73], v[72:73], s[34:35] op_sel_hi:[1,0]
  v_pk_mul_f32 v[74:75], v[74:75], s[34:35] op_sel_hi:[1,0]
  v_pk_mul_f32 v[88:89], v[88:89], s[34:35] op_sel_hi:[1,0]
  v_pk_mul_f32 v[90:91], v[90:91], s[34:35] op_sel_hi:[1,0]
  v_cvt_pk_bf16_f32 v168, v72, v73
  v_cvt_pk_bf16_f32 v169, v74, v75
  v_cvt_pk_bf16_f32 v170, v88, v89
  v_cvt_pk_bf16_f32 v171, v90, v91
  v_permlane16_swap_b32 v152, v154
  v_permlane16_swap_b32 v153, v155
  v_pk_mul_f32 v[76:77], v[76:77], s[34:35] op_sel_hi:[1,0]
  v_pk_mul_f32 v[78:79], v[78:79], s[34:35] op_sel_hi:[1,0]
  v_pk_mul_f32 v[92:93], v[92:93], s[34:35] op_sel_hi:[1,0]
  v_pk_mul_f32 v[94:95], v[94:95], s[34:35] op_sel_hi:[1,0]
  v_cvt_pk_bf16_f32 v184, v76, v77
  v_cvt_pk_bf16_f32 v185, v78, v79
  v_cvt_pk_bf16_f32 v186, v92, v93
  v_cvt_pk_bf16_f32 v187, v94, v95
  v_permlane16_swap_b32 v168, v170
  v_permlane16_swap_b32 v169, v171
  v_pk_mul_f32 v[96:97], v[96:97], s[34:35] op_sel_hi:[1,0]
  v_pk_mul_f32 v[98:99], v[98:99], s[34:35] op_sel_hi:[1,0]
  v_pk_mul_f32 v[112:113], v[112:113], s[34:35] op_sel_hi:[1,0]
  v_pk_mul_f32 v[114:115], v[114:115], s[34:35] op_sel_hi:[1,0]
  v_cvt_pk_bf16_f32 v140, v96, v97
  v_cvt_pk_bf16_f32 v141, v98, v99
  v_cvt_pk_bf16_f32 v142, v112, v113
  v_cvt_pk_bf16_f32 v143, v114, v115
  v_permlane16_swap_b32 v184, v186
  v_permlane16_swap_b32 v185, v187
  v_pk_mul_f32 v[100:101], v[100:101], s[34:35] op_sel_hi:[1,0]
  v_pk_mul_f32 v[102:103], v[102:103], s[34:35] op_sel_hi:[1,0]
  v_pk_mul_f32 v[116:117], v[116:117], s[34:35] op_sel_hi:[1,0]
  v_pk_mul_f32 v[118:119], v[118:119], s[34:35] op_sel_hi:[1,0]
  v_cvt_pk_bf16_f32 v156, v100, v101
  v_cvt_pk_bf16_f32 v157, v102, v103
  v_cvt_pk_bf16_f32 v158, v116, v117
  v_cvt_pk_bf16_f32 v159, v118, v119
  v_permlane16_swap_b32 v140, v142
  v_permlane16_swap_b32 v141, v143
  v_pk_mul_f32 v[104:105], v[104:105], s[34:35] op_sel_hi:[1,0]
  v_pk_mul_f32 v[106:107], v[106:107], s[34:35] op_sel_hi:[1,0]
  v_pk_mul_f32 v[120:121], v[120:121], s[34:35] op_sel_hi:[1,0]
  v_pk_mul_f32 v[122:123], v[122:123], s[34:35] op_sel_hi:[1,0]
  v_cvt_pk_bf16_f32 v172, v104, v105
  v_cvt_pk_bf16_f32 v173, v106, v107
  v_cvt_pk_bf16_f32 v174, v120, v121
  v_cvt_pk_bf16_f32 v175, v122, v123
  v_permlane16_swap_b32 v156, v158
  v_permlane16_swap_b32 v157, v159
  v_pk_mul_f32 v[108:109], v[108:109], s[34:35] op_sel_hi:[1,0]
  v_pk_mul_f32 v[110:111], v[110:111], s[34:35] op_sel_hi:[1,0]
  v_pk_mul_f32 v[124:125], v[124:125], s[34:35] op_sel_hi:[1,0]
  v_pk_mul_f32 v[126:127], v[126:127], s[34:35] op_sel_hi:[1,0]
  v_cvt_pk_bf16_f32 v188, v108, v109
  v_cvt_pk_bf16_f32 v189, v110, v111
  v_cvt_pk_bf16_f32 v190, v124, v125
  v_cvt_pk_bf16_f32 v191, v126, v127
  v_permlane16_swap_b32 v172, v174
  v_permlane16_swap_b32 v173, v175
  v_permlane16_swap_b32 v188, v190
  v_permlane16_swap_b32 v189, v191
  v_mfma_f32_16x16x32_bf16 v[0:3], a[128:131], v[128:131], 0
  s_add_u32 m0, s28, 81920
  ds_read_b128 a[144:147], v212 offset:4096
  s_mov_b32 s20, s90
  s_mov_b32 s21, s91
  v_mfma_f32_16x16x32_bf16 v[0:3], a[132:135], v[132:135], v[0:3]
  buffer_load_dwordx4 v236, s[16:19], s29 offen offset:0 lds
  s_mov_b32 s22, 2211840
  s_mov_b32 s23, 0x20000
  s_mov_b32 s44, s92
  v_mfma_f32_16x16x32_bf16 v[0:3], a[136:139], v[136:139], v[0:3]
  ds_read_b128 a[148:151], v213 offset:4096
  s_mov_b32 s45, s93
  s_mov_b32 s46, 2211840
  s_mov_b32 s47, 0x20000
  v_lshrrev_b32 v253, 4, v242
  v_mfma_f32_16x16x32_bf16 v[0:3], a[140:143], v[140:143], v[0:3]
  buffer_load_dwordx4 v237, s[16:19], s29 offen offset:1024 lds
  v_mfma_f32_16x16x32_bf16 v[8:11], a[140:143], v[156:159], 0
  ds_read_b128 a[152:155], v214 offset:4096
  v_mul_u32_u24 v253, 0xd80, v253
  v_mfma_f32_16x16x32_bf16 v[8:11], a[136:139], v[152:155], v[8:11]
  buffer_load_dwordx4 v236, s[16:19], s29 offen offset:2048 lds
  s_mul_i32 s35, s3, 552960
  s_lshl_b32 s38, s33, 4
  s_add_u32 s35, s35, s38
  v_mfma_f32_16x16x32_bf16 v[8:11], a[132:135], v[148:151], v[8:11]
  ds_read_b128 a[156:159], v215 offset:4096
  v_mfma_f32_16x16x32_bf16 v[8:11], a[128:131], v[144:147], v[8:11]
  buffer_load_dwordx4 v237, s[16:19], s29 offen offset:3072 lds
  v_mfma_f32_16x16x32_bf16 v[16:19], a[128:131], v[160:163], 0
  s_add_u32 s29, s29, 16384
  s_add_u32 m0, s28, 32768
  v_mfma_f32_16x16x32_bf16 v[16:19], a[132:135], v[164:167], v[16:19]
  buffer_load_dwordx4 v232, s[12:15], s29 offen offset:0 lds
  v_mfma_f32_16x16x32_bf16 v[16:19], a[136:139], v[168:171], v[16:19]
  buffer_load_dwordx4 v233, s[12:15], s29 offen offset:1024 lds
  v_mfma_f32_16x16x32_bf16 v[16:19], a[140:143], v[172:175], v[16:19]
  v_max3_f32 v192, v0, v1, v2
  v_max3_f32 v196, v8, v9, v10
  v_mfma_f32_16x16x32_bf16 v[24:27], a[140:143], v[188:191], 0
  v_max_f32 v192, v192, v3
  v_max_f32 v196, v196, v11
  v_mfma_f32_16x16x32_bf16 v[24:27], a[136:139], v[184:187], v[24:27]
  v_mov_b32 v245, v192
  v_mov_b32 v246, v196
  v_mfma_f32_16x16x32_bf16 v[24:27], a[132:135], v[180:183], v[24:27]
  v_permlane16_swap_b32 v192, v245
  v_permlane16_swap_b32 v196, v246
  v_mfma_f32_16x16x32_bf16 v[24:27], a[128:131], v[176:179], v[24:27]
  s_waitcnt lgkmcnt(0)
  v_max_f32 v192, v192, v245
  v_max_f32 v196, v196, v246
  v_mfma_f32_16x16x32_bf16 v[4:7], a[144:147], v[128:131], 0
  ds_read_b128 a[128:131], v212 offset:8192
  v_mov_b32 v245, v192
  v_mfma_f32_16x16x32_bf16 v[4:7], a[148:151], v[132:135], v[4:7]
  v_mov_b32 v246, v196
  v_permlane32_swap_b32 v192, v245
  v_mfma_f32_16x16x32_bf16 v[4:7], a[152:155], v[136:139], v[4:7]
  ds_read_b128 a[132:135], v213 offset:8192
  v_permlane32_swap_b32 v196, v246
  v_mfma_f32_16x16x32_bf16 v[4:7], a[156:159], v[140:143], v[4:7]
  v_max_f32 v192, v192, v245
  v_max_f32 v196, v196, v246
  v_mfma_f32_16x16x32_bf16 v[12:15], a[156:159], v[156:159], 0
  ds_read_b128 a[136:139], v214 offset:8192
  v_sub_f32 v193, 0, v192
  v_mfma_f32_16x16x32_bf16 v[12:15], a[152:155], v[152:155], v[12:15]
  v_sub_f32 v197, 0, v196
  v_sub_f32 v194, 0, v192
  v_mfma_f32_16x16x32_bf16 v[12:15], a[148:151], v[148:151], v[12:15]
  ds_read_b128 a[140:143], v215 offset:8192
  v_sub_f32 v198, 0, v196
  v_mfma_f32_16x16x32_bf16 v[12:15], a[144:147], v[144:147], v[12:15]
  v_sub_f32 v195, 0, v192
  v_sub_f32 v199, 0, v196
  v_mfma_f32_16x16x32_bf16 v[20:23], a[144:147], v[160:163], 0
  buffer_load_dwordx4 v234, s[12:15], s29 offen offset:2048 lds
  v_mfma_f32_16x16x32_bf16 v[20:23], a[148:151], v[164:167], v[20:23]
  v_sub_f32 v192, 0, v192
  v_sub_f32 v196, 0, v196
  v_mfma_f32_16x16x32_bf16 v[20:23], a[152:155], v[168:171], v[20:23]
  buffer_load_dwordx4 v235, s[12:15], s29 offen offset:3072 lds
  v_mfma_f32_16x16x32_bf16 v[20:23], a[156:159], v[172:175], v[20:23]
  v_max3_f32 v200, v16, v17, v18
  v_max3_f32 v204, v24, v25, v26
  v_mfma_f32_16x16x32_bf16 v[28:31], a[156:159], v[188:191], 0
  v_max_f32 v200, v200, v19
  v_max_f32 v204, v204, v27
  v_mfma_f32_16x16x32_bf16 v[28:31], a[152:155], v[184:187], v[28:31]
  v_mov_b32 v247, v200
  v_mov_b32 v248, v204
  v_mfma_f32_16x16x32_bf16 v[28:31], a[148:151], v[180:183], v[28:31]
  v_permlane16_swap_b32 v200, v247
  v_permlane16_swap_b32 v204, v248
  v_max_f32 v200, v200, v247
  v_max_f32 v204, v204, v248
  v_mov_b32 v247, v200
  v_mov_b32 v248, v204
  s_nop 0
  v_permlane32_swap_b32 v200, v247
  v_permlane32_swap_b32 v204, v248
  v_max_f32 v200, v200, v247
  v_max_f32 v204, v204, v248
  v_sub_f32 v201, 0, v200
  v_sub_f32 v205, 0, v204
  v_sub_f32 v202, 0, v200
  v_sub_f32 v206, 0, v204
  v_sub_f32 v203, 0, v200
  v_sub_f32 v207, 0, v204
  v_sub_f32 v200, 0, v200
  v_sub_f32 v204, 0, v204
  v_mfma_f32_16x16x32_bf16 v[28:31], a[144:147], v[176:179], v[28:31]
  s_waitcnt lgkmcnt(0)
  v_add_f32 v0, v192, v0
  v_add_f32 v1, v192, v1
  v_mfma_f32_16x16x32_bf16 v[32:35], a[128:131], v[128:131], v[192:195]
  ds_read_b128 a[144:147], v212 offset:12288
  v_add_f32 v2, v192, v2
  v_mfma_f32_16x16x32_bf16 v[32:35], a[132:135], v[132:135], v[32:35]
  v_add_f32 v3, v192, v3
  v_mfma_f32_16x16x32_bf16 v[32:35], a[136:139], v[136:139], v[32:35]
  ds_read_b128 a[148:151], v213 offset:12288
  v_mfma_f32_16x16x32_bf16 v[32:35], a[140:143], v[140:143], v[32:35]
  v_exp_f32 v0, v0
  v_mfma_f32_16x16x32_bf16 v[40:43], a[140:143], v[156:159], v[196:199]
  ds_read_b128 a[152:155], v214 offset:12288
  v_mfma_f32_16x16x32_bf16 v[40:43], a[136:139], v[152:155], v[40:43]
  v_exp_f32 v1, v1
  v_mfma_f32_16x16x32_bf16 v[40:43], a[132:135], v[148:151], v[40:43]
  ds_read_b128 a[156:159], v215 offset:12288
  v_mfma_f32_16x16x32_bf16 v[40:43], a[128:131], v[144:147], v[40:43]
  v_exp_f32 v2, v2
  v_mfma_f32_16x16x32_bf16 v[48:51], a[128:131], v[160:163], v[200:203]
  s_add_u32 m0, s50, 0
  v_cvt_pk_bf16_f32 v0, v0, v1
  v_mfma_f32_16x16x32_bf16 v[48:51], a[132:135], v[164:167], v[48:51]
  v_exp_f32 v3, v3
  v_mfma_f32_16x16x32_bf16 v[48:51], a[136:139], v[168:171], v[48:51]
  v_add_f32 v8, v196, v8
  v_add_f32 v9, v196, v9
  v_mfma_f32_16x16x32_bf16 v[48:51], a[140:143], v[172:175], v[48:51]
  v_add_f32 v10, v196, v10
  v_add_f32 v11, v196, v11
  v_mfma_f32_16x16x32_bf16 v[56:59], a[140:143], v[188:191], v[204:207]
  v_exp_f32 v8, v8
  v_mfma_f32_16x16x32_bf16 v[56:59], a[136:139], v[184:187], v[56:59]
  v_exp_f32 v9, v9
  buffer_load_dwordx4 v253, s[20:23], s35 offen lds
  v_mfma_f32_16x16x32_bf16 v[56:59], a[132:135], v[180:183], v[56:59]
  v_exp_f32 v10, v10
  v_mfma_f32_16x16x32_bf16 v[56:59], a[128:131], v[176:179], v[56:59]
  s_waitcnt lgkmcnt(0)
  v_cvt_pk_bf16_f32 v8, v8, v9
  v_mfma_f32_16x16x32_bf16 v[36:39], a[144:147], v[128:131], v[192:195]
  s_waitcnt vmcnt(9)
  v_exp_f32 v11, v11
  v_mfma_f32_16x16x32_bf16 v[36:39], a[148:151], v[132:135], v[36:39]
  s_barrier
  v_cvt_pk_bf16_f32 v1, v2, v3
  v_add_f32 v16, v200, v16
  v_mfma_f32_16x16x32_bf16 v[36:39], a[152:155], v[136:139], v[36:39]
  ds_read_b128 a[128:131], v212 offset:16384
  v_add_f32 v17, v200, v17
  v_mfma_f32_16x16x32_bf16 v[36:39], a[156:159], v[140:143], v[36:39]
  v_add_f32 v18, v200, v18
  v_add_f32 v19, v200, v19
  v_mfma_f32_16x16x32_bf16 v[44:47], a[156:159], v[156:159], v[196:199]
  ds_read_b128 a[132:135], v213 offset:16384
  v_mfma_f32_16x16x32_bf16 v[44:47], a[152:155], v[152:155], v[44:47]
  v_exp_f32 v16, v16
  v_mfma_f32_16x16x32_bf16 v[44:47], a[148:151], v[148:151], v[44:47]
  ds_read_b128 a[136:139], v214 offset:16384
  v_mfma_f32_16x16x32_bf16 v[44:47], a[144:147], v[144:147], v[44:47]
  v_exp_f32 v17, v17
  v_mfma_f32_16x16x32_bf16 v[52:55], a[144:147], v[160:163], v[200:203]
  ds_read_b128 a[140:143], v215 offset:16384
  v_mfma_f32_16x16x32_bf16 v[52:55], a[148:151], v[164:167], v[52:55]
  v_exp_f32 v18, v18
  v_mfma_f32_16x16x32_bf16 v[52:55], a[152:155], v[168:171], v[52:55]
  v_cvt_pk_bf16_f32 v16, v16, v17
  v_mfma_f32_16x16x32_bf16 v[52:55], a[156:159], v[172:175], v[52:55]
  v_exp_f32 v19, v19
  v_mfma_f32_16x16x32_bf16 v[60:63], a[156:159], v[188:191], v[204:207]
  v_cvt_pk_bf16_f32 v9, v10, v11
  v_add_f32 v24, v204, v24
  v_mfma_f32_16x16x32_bf16 v[60:63], a[152:155], v[184:187], v[60:63]
  v_add_f32 v25, v204, v25
  v_add_f32 v26, v204, v26
  v_mfma_f32_16x16x32_bf16 v[60:63], a[148:151], v[180:183], v[60:63]
  v_add_f32 v27, v204, v27
  v_mfma_f32_16x16x32_bf16 v[60:63], a[144:147], v[176:179], v[60:63]
  s_waitcnt lgkmcnt(0)
  v_exp_f32 v24, v24
  v_exp_f32 v25, v25
  v_exp_f32 v26, v26
  v_cvt_pk_bf16_f32 v24, v24, v25
  v_exp_f32 v27, v27
  v_cvt_pk_bf16_f32 v17, v18, v19
  v_add_f32 v4, v192, v4
  v_add_f32 v5, v192, v5
  v_add_f32 v6, v192, v6
  v_add_f32 v7, v192, v7
  v_exp_f32 v4, v4
  v_exp_f32 v5, v5
  v_exp_f32 v6, v6
  v_cvt_pk_bf16_f32 v2, v4, v5
  v_exp_f32 v7, v7
  v_cvt_pk_bf16_f32 v25, v26, v27
  v_add_f32 v12, v196, v12
  v_add_f32 v13, v196, v13
  v_add_f32 v14, v196, v14
  v_add_f32 v15, v196, v15
  v_exp_f32 v12, v12
  v_exp_f32 v13, v13
  v_exp_f32 v14, v14
  v_cvt_pk_bf16_f32 v10, v12, v13
  v_exp_f32 v15, v15
  v_cvt_pk_bf16_f32 v3, v6, v7
  v_add_f32 v20, v200, v20
  v_add_f32 v21, v200, v21
  v_add_f32 v22, v200, v22
  v_add_f32 v23, v200, v23
  v_exp_f32 v20, v20
  v_exp_f32 v21, v21
  v_exp_f32 v22, v22
  v_cvt_pk_bf16_f32 v18, v20, v21
  v_exp_f32 v23, v23
  v_cvt_pk_bf16_f32 v11, v14, v15
  v_add_f32 v28, v204, v28
  v_add_f32 v29, v204, v29
  v_add_f32 v30, v204, v30
  v_add_f32 v31, v204, v31
  v_exp_f32 v28, v28
  v_exp_f32 v29, v29
  v_exp_f32 v30, v30
  v_cvt_pk_bf16_f32 v26, v28, v29
  v_exp_f32 v31, v31
  v_cvt_pk_bf16_f32 v19, v22, v23
  v_exp_f32 v32, v32
  v_exp_f32 v33, v33
  v_exp_f32 v34, v34
  v_cvt_pk_bf16_f32 v32, v32, v33
  v_exp_f32 v35, v35
  v_cvt_pk_bf16_f32 v27, v30, v31
  v_exp_f32 v40, v40
  v_exp_f32 v41, v41
  v_exp_f32 v42, v42
  v_cvt_pk_bf16_f32 v40, v40, v41
  v_exp_f32 v43, v43
  v_cvt_pk_bf16_f32 v33, v34, v35
  v_exp_f32 v48, v48
  v_exp_f32 v49, v49
  v_exp_f32 v50, v50
  v_cvt_pk_bf16_f32 v48, v48, v49
  v_exp_f32 v51, v51
  v_cvt_pk_bf16_f32 v41, v42, v43
  v_exp_f32 v56, v56
  v_exp_f32 v57, v57
  v_exp_f32 v58, v58
  v_cvt_pk_bf16_f32 v56, v56, v57
  v_exp_f32 v59, v59
  v_cvt_pk_bf16_f32 v49, v50, v51
  v_exp_f32 v36, v36
  v_exp_f32 v37, v37
  v_exp_f32 v38, v38
  v_cvt_pk_bf16_f32 v34, v36, v37
  v_exp_f32 v39, v39
  v_cvt_pk_bf16_f32 v57, v58, v59
  v_exp_f32 v44, v44
  v_exp_f32 v45, v45
  v_exp_f32 v46, v46
  v_cvt_pk_bf16_f32 v42, v44, v45
  v_exp_f32 v47, v47
  v_cvt_pk_bf16_f32 v35, v38, v39
  v_exp_f32 v52, v52
  v_exp_f32 v53, v53
  v_exp_f32 v54, v54
  v_cvt_pk_bf16_f32 v50, v52, v53
  v_exp_f32 v55, v55
  v_cvt_pk_bf16_f32 v43, v46, v47
  v_exp_f32 v60, v60
  v_exp_f32 v61, v61
  v_exp_f32 v62, v62
  v_cvt_pk_bf16_f32 v58, v60, v61
  v_exp_f32 v63, v63
  v_cvt_pk_bf16_f32 v51, v54, v55
  v_cvt_pk_bf16_f32 v59, v62, v63
  v_mfma_f32_16x16x32_bf16 v[64:67], a[128:131], v[128:131], v[192:195]
  s_add_u32 m0, s28, 98304
  v_mfma_f32_16x16x32_bf16 v[64:67], a[132:135], v[132:135], v[64:67]
  ds_read_b128 a[144:147], v212 offset:20480
  v_mfma_f32_16x16x32_bf16 v[64:67], a[136:139], v[136:139], v[64:67]
  buffer_load_dwordx4 v236, s[16:19], s29 offen offset:0 lds
  v_mfma_f32_16x16x32_bf16 v[64:67], a[140:143], v[140:143], v[64:67]
  ds_read_b128 a[148:151], v213 offset:20480
  v_mfma_f32_16x16x32_bf16 v[72:75], a[140:143], v[156:159], v[196:199]
  v_mfma_f32_16x16x32_bf16 v[72:75], a[136:139], v[152:155], v[72:75]
  ds_read_b128 a[152:155], v214 offset:20480
  v_mfma_f32_16x16x32_bf16 v[72:75], a[132:135], v[148:151], v[72:75]
  buffer_load_dwordx4 v237, s[16:19], s29 offen offset:1024 lds
  v_mfma_f32_16x16x32_bf16 v[72:75], a[128:131], v[144:147], v[72:75]
  ds_read_b128 a[156:159], v215 offset:20480
  v_mfma_f32_16x16x32_bf16 v[80:83], a[128:131], v[160:163], v[200:203]
  v_exp_f32 v64, v64
  v_mfma_f32_16x16x32_bf16 v[80:83], a[132:135], v[164:167], v[80:83]
  v_mfma_f32_16x16x32_bf16 v[80:83], a[136:139], v[168:171], v[80:83]
  v_exp_f32 v65, v65
  v_mfma_f32_16x16x32_bf16 v[80:83], a[140:143], v[172:175], v[80:83]
  v_cvt_pk_bf16_f32 v64, v64, v65
  v_mfma_f32_16x16x32_bf16 v[88:91], a[140:143], v[188:191], v[204:207]
  v_exp_f32 v66, v66
  v_mfma_f32_16x16x32_bf16 v[88:91], a[136:139], v[184:187], v[88:91]
  buffer_load_dwordx4 v236, s[16:19], s29 offen offset:2048 lds
  v_mfma_f32_16x16x32_bf16 v[88:91], a[132:135], v[180:183], v[88:91]
  s_waitcnt lgkmcnt(0)
  v_exp_f32 v67, v67
  v_mfma_f32_16x16x32_bf16 v[88:91], a[128:131], v[176:179], v[88:91]
  v_cvt_pk_bf16_f32 v65, v66, v67
  v_mfma_f32_16x16x32_bf16 v[68:71], a[144:147], v[128:131], v[192:195]
  v_exp_f32 v72, v72
  v_mfma_f32_16x16x32_bf16 v[68:71], a[148:151], v[132:135], v[68:71]
  ds_read_b128 a[128:131], v212 offset:24576
  v_mfma_f32_16x16x32_bf16 v[68:71], a[152:155], v[136:139], v[68:71]
  v_exp_f32 v73, v73
  v_mfma_f32_16x16x32_bf16 v[68:71], a[156:159], v[140:143], v[68:71]
  ds_read_b128 a[132:135], v213 offset:24576
  v_cvt_pk_bf16_f32 v72, v72, v73
  v_mfma_f32_16x16x32_bf16 v[76:79], a[156:159], v[156:159], v[196:199]
  v_exp_f32 v74, v74
  v_mfma_f32_16x16x32_bf16 v[76:79], a[152:155], v[152:155], v[76:79]
  ds_read_b128 a[136:139], v214 offset:24576
  v_mfma_f32_16x16x32_bf16 v[76:79], a[148:151], v[148:151], v[76:79]
  v_exp_f32 v75, v75
  v_mfma_f32_16x16x32_bf16 v[76:79], a[144:147], v[144:147], v[76:79]
  ds_read_b128 a[140:143], v215 offset:24576
  v_cvt_pk_bf16_f32 v73, v74, v75
  v_mfma_f32_16x16x32_bf16 v[84:87], a[144:147], v[160:163], v[200:203]
  v_exp_f32 v80, v80
  v_mfma_f32_16x16x32_bf16 v[84:87], a[148:151], v[164:167], v[84:87]
  buffer_load_dwordx4 v237, s[16:19], s29 offen offset:3072 lds
  v_mfma_f32_16x16x32_bf16 v[84:87], a[152:155], v[168:171], v[84:87]
  s_add_u32 s29, s29, 16384
  v_exp_f32 v81, v81
  v_mfma_f32_16x16x32_bf16 v[84:87], a[156:159], v[172:175], v[84:87]
  v_cvt_pk_bf16_f32 v80, v80, v81
  v_mfma_f32_16x16x32_bf16 v[92:95], a[156:159], v[188:191], v[204:207]
  s_add_u32 m0, s28, 49152
  v_exp_f32 v82, v82
  v_mfma_f32_16x16x32_bf16 v[92:95], a[152:155], v[184:187], v[92:95]
  buffer_load_dwordx4 v232, s[12:15], s29 offen offset:0 lds
  v_mfma_f32_16x16x32_bf16 v[92:95], a[148:151], v[180:183], v[92:95]
  s_waitcnt lgkmcnt(0)
  v_exp_f32 v83, v83
  v_mfma_f32_16x16x32_bf16 v[92:95], a[144:147], v[176:179], v[92:95]
  v_cvt_pk_bf16_f32 v81, v82, v83
  v_mfma_f32_16x16x32_bf16 v[96:99], a[128:131], v[128:131], v[192:195]
  v_exp_f32 v88, v88
  v_mfma_f32_16x16x32_bf16 v[96:99], a[132:135], v[132:135], v[96:99]
  ds_read_b128 a[144:147], v212 offset:28672
  v_mfma_f32_16x16x32_bf16 v[96:99], a[136:139], v[136:139], v[96:99]
  v_exp_f32 v89, v89
  v_mfma_f32_16x16x32_bf16 v[96:99], a[140:143], v[140:143], v[96:99]
  ds_read_b128 a[148:151], v213 offset:28672
  v_cvt_pk_bf16_f32 v88, v88, v89
  v_mfma_f32_16x16x32_bf16 v[104:107], a[140:143], v[156:159], v[196:199]
  v_exp_f32 v90, v90
  v_mfma_f32_16x16x32_bf16 v[104:107], a[136:139], v[152:155], v[104:107]
  ds_read_b128 a[152:155], v214 offset:28672
  v_mfma_f32_16x16x32_bf16 v[104:107], a[132:135], v[148:151], v[104:107]
  v_exp_f32 v91, v91
  v_mfma_f32_16x16x32_bf16 v[104:107], a[128:131], v[144:147], v[104:107]
  ds_read_b128 a[156:159], v215 offset:28672
  v_cvt_pk_bf16_f32 v89, v90, v91
  v_mfma_f32_16x16x32_bf16 v[112:115], a[128:131], v[160:163], v[200:203]
  v_exp_f32 v68, v68
  v_mfma_f32_16x16x32_bf16 v[112:115], a[132:135], v[164:167], v[112:115]
  buffer_load_dwordx4 v233, s[12:15], s29 offen offset:1024 lds
  v_mfma_f32_16x16x32_bf16 v[112:115], a[136:139], v[168:171], v[112:115]
  v_exp_f32 v69, v69
  v_mfma_f32_16x16x32_bf16 v[112:115], a[140:143], v[172:175], v[112:115]
  v_cvt_pk_bf16_f32 v66, v68, v69
  v_mfma_f32_16x16x32_bf16 v[120:123], a[140:143], v[188:191], v[204:207]
  v_exp_f32 v70, v70
  v_mfma_f32_16x16x32_bf16 v[120:123], a[136:139], v[184:187], v[120:123]
  buffer_load_dwordx4 v234, s[12:15], s29 offen offset:2048 lds
  v_mfma_f32_16x16x32_bf16 v[120:123], a[132:135], v[180:183], v[120:123]
  s_waitcnt lgkmcnt(0)
  v_exp_f32 v71, v71
  v_mfma_f32_16x16x32_bf16 v[120:123], a[128:131], v[176:179], v[120:123]
  v_cvt_pk_bf16_f32 v67, v70, v71
  v_mfma_f32_16x16x32_bf16 v[100:103], a[144:147], v[128:131], v[192:195]
  v_exp_f32 v76, v76
  v_mfma_f32_16x16x32_bf16 v[100:103], a[148:151], v[132:135], v[100:103]
  ds_read_b64_tr_b16 a[160:161], v216 offset:0
  v_mfma_f32_16x16x32_bf16 v[100:103], a[152:155], v[136:139], v[100:103]
  v_exp_f32 v77, v77
  v_mfma_f32_16x16x32_bf16 v[100:103], a[156:159], v[140:143], v[100:103]
  ds_read_b64_tr_b16 a[162:163], v216 offset:4096
  v_cvt_pk_bf16_f32 v74, v76, v77
  v_mfma_f32_16x16x32_bf16 v[108:111], a[156:159], v[156:159], v[196:199]
  v_exp_f32 v78, v78
  v_mfma_f32_16x16x32_bf16 v[108:111], a[152:155], v[152:155], v[108:111]
  ds_read_b64_tr_b16 a[164:165], v216 offset:8192
  buffer_load_dwordx4 v235, s[12:15], s29 offen offset:3072 lds
  v_mfma_f32_16x16x32_bf16 v[108:111], a[148:151], v[148:151], v[108:111]
  v_exp_f32 v79, v79
  v_mfma_f32_16x16x32_bf16 v[108:111], a[144:147], v[144:147], v[108:111]
  ds_read_b64_tr_b16 a[166:167], v216 offset:12288
  v_cvt_pk_bf16_f32 v75, v78, v79
  v_mfma_f32_16x16x32_bf16 v[116:119], a[144:147], v[160:163], v[200:203]
  v_exp_f32 v84, v84
  v_mfma_f32_16x16x32_bf16 v[116:119], a[148:151], v[164:167], v[116:119]
  ds_read_b64_tr_b16 a[168:169], v217 offset:0
  s_add_u32 m0, s50, 3072
  v_mfma_f32_16x16x32_bf16 v[116:119], a[152:155], v[168:171], v[116:119]
  v_exp_f32 v85, v85
  v_mfma_f32_16x16x32_bf16 v[116:119], a[156:159], v[172:175], v[116:119]
  ds_read_b64_tr_b16 a[170:171], v217 offset:4096
  v_cvt_pk_bf16_f32 v82, v84, v85
  v_mfma_f32_16x16x32_bf16 v[124:127], a[156:159], v[188:191], v[204:207]
  v_exp_f32 v86, v86
  v_mfma_f32_16x16x32_bf16 v[124:127], a[152:155], v[184:187], v[124:127]
  ds_read_b64_tr_b16 a[172:173], v217 offset:8192
  buffer_load_dwordx4 v253, s[44:47], s35 offen lds
  s_add_u32 s35, s35, 221184
  v_mfma_f32_16x16x32_bf16 v[124:127], a[148:151], v[180:183], v[124:127]
  v_exp_f32 v87, v87
  v_mfma_f32_16x16x32_bf16 v[124:127], a[144:147], v[176:179], v[124:127]
  ds_read_b64_tr_b16 a[174:175], v217 offset:12288
  v_cvt_pk_bf16_f32 v83, v86, v87
  v_mfma_f32_16x16x32_bf16 a[192:195], a[208:211], v[0:3], 0
  v_exp_f32 v92, v92
  v_mfma_f32_16x16x32_bf16 a[192:195], a[208:211], v[32:35], a[192:195]
  ds_read_b64_tr_b16 a[176:177], v218 offset:0
  v_mfma_f32_16x16x32_bf16 a[196:199], a[208:211], v[8:11], 0
  v_exp_f32 v93, v93
  v_mfma_f32_16x16x32_bf16 a[196:199], a[208:211], v[40:43], a[196:199]
  ds_read_b64_tr_b16 a[178:179], v218 offset:4096
  v_cvt_pk_bf16_f32 v90, v92, v93
  v_mfma_f32_16x16x32_bf16 a[200:203], a[208:211], v[16:19], 0
  v_exp_f32 v94, v94
  v_mfma_f32_16x16x32_bf16 a[200:203], a[208:211], v[48:51], a[200:203]
  ds_read_b64_tr_b16 a[180:181], v218 offset:8192
  v_mfma_f32_16x16x32_bf16 a[204:207], a[208:211], v[24:27], 0
  s_waitcnt lgkmcnt(7)
  v_exp_f32 v95, v95
  v_mfma_f32_16x16x32_bf16 a[204:207], a[208:211], v[56:59], a[204:207]
  ds_read_b64_tr_b16 a[182:183], v218 offset:12288
  v_cvt_pk_bf16_f32 v91, v94, v95
  v_mfma_f32_16x16x32_bf16 a[0:3], a[160:163], v[0:3], 0
  v_exp_f32 v96, v96
  v_mfma_f32_16x16x32_bf16 a[0:3], a[164:167], v[32:35], a[0:3]
  ds_read_b64_tr_b16 a[184:185], v219 offset:0
  v_mfma_f32_16x16x32_bf16 a[4:7], a[164:167], v[40:43], 0
  v_exp_f32 v97, v97
  v_mfma_f32_16x16x32_bf16 a[4:7], a[160:163], v[8:11], a[4:7]
  ds_read_b64_tr_b16 a[186:187], v219 offset:4096
  v_cvt_pk_bf16_f32 v96, v96, v97
  v_mfma_f32_16x16x32_bf16 a[8:11], a[160:163], v[16:19], 0
  v_exp_f32 v98, v98
  v_mfma_f32_16x16x32_bf16 a[8:11], a[164:167], v[48:51], a[8:11]
  ds_read_b64_tr_b16 a[188:189], v219 offset:8192
  v_mfma_f32_16x16x32_bf16 a[12:15], a[164:167], v[56:59], 0
  s_waitcnt lgkmcnt(7)
  v_exp_f32 v99, v99
  v_mfma_f32_16x16x32_bf16 a[12:15], a[160:163], v[24:27], a[12:15]
  ds_read_b64_tr_b16 a[190:191], v219 offset:12288
  v_cvt_pk_bf16_f32 v97, v98, v99
  v_mfma_f32_16x16x32_bf16 a[16:19], a[168:171], v[0:3], 0
  v_exp_f32 v104, v104
  v_mfma_f32_16x16x32_bf16 a[16:19], a[172:175], v[32:35], a[16:19]
  ds_read_b64_tr_b16 a[160:161], v220 offset:0
  v_mfma_f32_16x16x32_bf16 a[20:23], a[172:175], v[40:43], 0
  v_exp_f32 v105, v105
  v_mfma_f32_16x16x32_bf16 a[20:23], a[168:171], v[8:11], a[20:23]
  ds_read_b64_tr_b16 a[162:163], v220 offset:4096
  v_cvt_pk_bf16_f32 v104, v104, v105
  v_mfma_f32_16x16x32_bf16 a[24:27], a[168:171], v[16:19], 0
  v_exp_f32 v106, v106
  v_mfma_f32_16x16x32_bf16 a[24:27], a[172:175], v[48:51], a[24:27]
  ds_read_b64_tr_b16 a[164:165], v220 offset:8192
  v_mfma_f32_16x16x32_bf16 a[28:31], a[172:175], v[56:59], 0
  s_waitcnt lgkmcnt(7)
  v_exp_f32 v107, v107
  v_mfma_f32_16x16x32_bf16 a[28:31], a[168:171], v[24:27], a[28:31]
  ds_read_b64_tr_b16 a[166:167], v220 offset:12288
  v_cvt_pk_bf16_f32 v105, v106, v107
  v_mfma_f32_16x16x32_bf16 a[32:35], a[176:179], v[0:3], 0
  v_exp_f32 v112, v112
  v_mfma_f32_16x16x32_bf16 a[32:35], a[180:183], v[32:35], a[32:35]
  ds_read_b64_tr_b16 a[168:169], v221 offset:0
  v_mfma_f32_16x16x32_bf16 a[36:39], a[180:183], v[40:43], 0
  v_exp_f32 v113, v113
  v_mfma_f32_16x16x32_bf16 a[36:39], a[176:179], v[8:11], a[36:39]
  ds_read_b64_tr_b16 a[170:171], v221 offset:4096
  v_cvt_pk_bf16_f32 v112, v112, v113
  v_mfma_f32_16x16x32_bf16 a[40:43], a[176:179], v[16:19], 0
  v_exp_f32 v114, v114
  v_mfma_f32_16x16x32_bf16 a[40:43], a[180:183], v[48:51], a[40:43]
  ds_read_b64_tr_b16 a[172:173], v221 offset:8192
  v_mfma_f32_16x16x32_bf16 a[44:47], a[180:183], v[56:59], 0
  s_waitcnt lgkmcnt(7)
  v_exp_f32 v115, v115
  v_mfma_f32_16x16x32_bf16 a[44:47], a[176:179], v[24:27], a[44:47]
  ds_read_b64_tr_b16 a[174:175], v221 offset:12288
  v_cvt_pk_bf16_f32 v113, v114, v115
  v_mfma_f32_16x16x32_bf16 a[48:51], a[184:187], v[0:3], 0
  v_exp_f32 v120, v120
  v_mfma_f32_16x16x32_bf16 a[48:51], a[188:191], v[32:35], a[48:51]
  ds_read_b64_tr_b16 a[176:177], v222 offset:0
  v_mfma_f32_16x16x32_bf16 a[52:55], a[188:191], v[40:43], 0
  v_exp_f32 v121, v121
  v_mfma_f32_16x16x32_bf16 a[52:55], a[184:187], v[8:11], a[52:55]
  ds_read_b64_tr_b16 a[178:179], v222 offset:4096
  v_cvt_pk_bf16_f32 v120, v120, v121
  v_mfma_f32_16x16x32_bf16 a[56:59], a[184:187], v[16:19], 0
  v_exp_f32 v122, v122
  v_mfma_f32_16x16x32_bf16 a[56:59], a[188:191], v[48:51], a[56:59]
  ds_read_b64_tr_b16 a[180:181], v222 offset:8192
  v_mfma_f32_16x16x32_bf16 a[60:63], a[188:191], v[56:59], 0
  s_waitcnt lgkmcnt(7)
  v_exp_f32 v123, v123
  v_mfma_f32_16x16x32_bf16 a[60:63], a[184:187], v[24:27], a[60:63]
  ds_read_b64_tr_b16 a[182:183], v222 offset:12288
  v_cvt_pk_bf16_f32 v121, v122, v123
  v_mfma_f32_16x16x32_bf16 a[64:67], a[160:163], v[0:3], 0
  v_exp_f32 v100, v100
  v_mfma_f32_16x16x32_bf16 a[64:67], a[164:167], v[32:35], a[64:67]
  ds_read_b64_tr_b16 a[184:185], v223 offset:0
  v_mfma_f32_16x16x32_bf16 a[68:71], a[164:167], v[40:43], 0
  v_exp_f32 v101, v101
  v_mfma_f32_16x16x32_bf16 a[68:71], a[160:163], v[8:11], a[68:71]
  ds_read_b64_tr_b16 a[186:187], v223 offset:4096
  v_cvt_pk_bf16_f32 v98, v100, v101
  v_mfma_f32_16x16x32_bf16 a[72:75], a[160:163], v[16:19], 0
  v_exp_f32 v102, v102
  v_mfma_f32_16x16x32_bf16 a[72:75], a[164:167], v[48:51], a[72:75]
  ds_read_b64_tr_b16 a[188:189], v223 offset:8192
  v_mfma_f32_16x16x32_bf16 a[76:79], a[164:167], v[56:59], 0
  s_waitcnt lgkmcnt(7)
  v_exp_f32 v103, v103
  v_mfma_f32_16x16x32_bf16 a[76:79], a[160:163], v[24:27], a[76:79]
  ds_read_b64_tr_b16 a[190:191], v223 offset:12288
  v_cvt_pk_bf16_f32 v99, v102, v103
  v_mfma_f32_16x16x32_bf16 a[80:83], a[168:171], v[0:3], 0
  s_waitcnt vmcnt(10)
  v_exp_f32 v108, v108
  v_mfma_f32_16x16x32_bf16 a[80:83], a[172:175], v[32:35], a[80:83]
  v_mfma_f32_16x16x32_bf16 a[84:87], a[172:175], v[40:43], 0
  s_barrier
  v_exp_f32 v109, v109
  v_mfma_f32_16x16x32_bf16 a[84:87], a[168:171], v[8:11], a[84:87]
  ds_read_b128 a[128:131], v212 offset:32768
  v_cvt_pk_bf16_f32 v106, v108, v109
  v_mfma_f32_16x16x32_bf16 a[88:91], a[168:171], v[16:19], 0
  v_exp_f32 v110, v110
  v_mfma_f32_16x16x32_bf16 a[88:91], a[172:175], v[48:51], a[88:91]
  ds_read_b128 a[132:135], v213 offset:32768
  v_mfma_f32_16x16x32_bf16 a[92:95], a[172:175], v[56:59], 0
  s_waitcnt lgkmcnt(6)
  v_exp_f32 v111, v111
  v_mfma_f32_16x16x32_bf16 a[92:95], a[168:171], v[24:27], a[92:95]
  ds_read_b128 a[136:139], v214 offset:32768
  v_cvt_pk_bf16_f32 v107, v110, v111
  v_mfma_f32_16x16x32_bf16 a[96:99], a[176:179], v[0:3], 0
  s_mul_i32 s38, s3, 20480
  v_exp_f32 v116, v116
  v_mfma_f32_16x16x32_bf16 a[96:99], a[180:183], v[32:35], a[96:99]
  ds_read_b128 a[140:143], v215 offset:32768
  buffer_load_dwordx4 a[212:215], v243, s[24:27], s38 offen sc1
  s_add_u32 s38, s38, 4096
  v_mfma_f32_16x16x32_bf16 a[100:103], a[180:183], v[40:43], 0
  v_exp_f32 v117, v117
  v_mfma_f32_16x16x32_bf16 a[100:103], a[176:179], v[8:11], a[100:103]
  v_cvt_pk_bf16_f32 v114, v116, v117
  v_mfma_f32_16x16x32_bf16 a[104:107], a[176:179], v[16:19], 0
  v_exp_f32 v118, v118
  v_mfma_f32_16x16x32_bf16 a[104:107], a[180:183], v[48:51], a[104:107]
  v_mfma_f32_16x16x32_bf16 a[108:111], a[180:183], v[56:59], 0
  s_waitcnt lgkmcnt(4)
  v_exp_f32 v119, v119
  v_mfma_f32_16x16x32_bf16 a[108:111], a[176:179], v[24:27], a[108:111]
  v_cvt_pk_bf16_f32 v115, v118, v119
  v_mfma_f32_16x16x32_bf16 a[112:115], a[184:187], v[0:3], 0
  v_exp_f32 v124, v124
  v_mfma_f32_16x16x32_bf16 a[112:115], a[188:191], v[32:35], a[112:115]
  v_mfma_f32_16x16x32_bf16 a[116:119], a[188:191], v[40:43], 0
  v_exp_f32 v125, v125
  v_mfma_f32_16x16x32_bf16 a[116:119], a[184:187], v[8:11], a[116:119]
  v_cvt_pk_bf16_f32 v122, v124, v125
  v_mfma_f32_16x16x32_bf16 a[120:123], a[184:187], v[16:19], 0
  v_exp_f32 v126, v126
  v_mfma_f32_16x16x32_bf16 a[120:123], a[188:191], v[48:51], a[120:123]
  v_mfma_f32_16x16x32_bf16 a[124:127], a[188:191], v[56:59], 0
  s_waitcnt lgkmcnt(0)
  v_exp_f32 v127, v127
  v_mfma_f32_16x16x32_bf16 a[124:127], a[184:187], v[24:27], a[124:127]
  v_cvt_pk_bf16_f32 v123, v126, v127
  v_mfma_f32_16x16x32_bf16 v[0:3], a[128:131], v[128:131], v[192:195]
  s_add_u32 m0, s28, 114688
  v_mfma_f32_16x16x32_bf16 v[0:3], a[132:135], v[132:135], v[0:3]
  ds_read_b128 a[144:147], v212 offset:36864
  v_mfma_f32_16x16x32_bf16 v[0:3], a[136:139], v[136:139], v[0:3]
  buffer_load_dwordx4 v236, s[16:19], s29 offen offset:0 lds
  v_mfma_f32_16x16x32_bf16 v[0:3], a[140:143], v[140:143], v[0:3]
  ds_read_b128 a[148:151], v213 offset:36864
  v_mfma_f32_16x16x32_bf16 v[8:11], a[140:143], v[156:159], v[196:199]
  v_mfma_f32_16x16x32_bf16 v[8:11], a[136:139], v[152:155], v[8:11]
  ds_read_b128 a[152:155], v214 offset:36864
  v_mfma_f32_16x16x32_bf16 v[8:11], a[132:135], v[148:151], v[8:11]
  buffer_load_dwordx4 v237, s[16:19], s29 offen offset:1024 lds
  v_mfma_f32_16x16x32_bf16 v[8:11], a[128:131], v[144:147], v[8:11]
  ds_read_b128 a[156:159], v215 offset:36864
  v_mfma_f32_16x16x32_bf16 v[16:19], a[128:131], v[160:163], v[200:203]
  v_exp_f32 v0, v0
  v_mfma_f32_16x16x32_bf16 v[16:19], a[132:135], v[164:167], v[16:19]
  v_mfma_f32_16x16x32_bf16 v[16:19], a[136:139], v[168:171], v[16:19]
  v_exp_f32 v1, v1
  v_mfma_f32_16x16x32_bf16 v[16:19], a[140:143], v[172:175], v[16:19]
  v_cvt_pk_bf16_f32 v0, v0, v1
  v_mfma_f32_16x16x32_bf16 v[24:27], a[140:143], v[188:191], v[204:207]
  v_exp_f32 v2, v2
  v_mfma_f32_16x16x32_bf16 v[24:27], a[136:139], v[184:187], v[24:27]
  buffer_load_dwordx4 v236, s[16:19], s29 offen offset:2048 lds
  v_mfma_f32_16x16x32_bf16 v[24:27], a[132:135], v[180:183], v[24:27]
  s_waitcnt lgkmcnt(0)
  v_exp_f32 v3, v3
  v_mfma_f32_16x16x32_bf16 v[24:27], a[128:131], v[176:179], v[24:27]
  v_cvt_pk_bf16_f32 v1, v2, v3
  v_mfma_f32_16x16x32_bf16 v[4:7], a[144:147], v[128:131], v[192:195]
  v_exp_f32 v8, v8
  v_mfma_f32_16x16x32_bf16 v[4:7], a[148:151], v[132:135], v[4:7]
  ds_read_b128 a[128:131], v212 offset:40960
  v_mfma_f32_16x16x32_bf16 v[4:7], a[152:155], v[136:139], v[4:7]
  v_exp_f32 v9, v9
  v_mfma_f32_16x16x32_bf16 v[4:7], a[156:159], v[140:143], v[4:7]
  ds_read_b128 a[132:135], v213 offset:40960
  v_cvt_pk_bf16_f32 v8, v8, v9
  v_mfma_f32_16x16x32_bf16 v[12:15], a[156:159], v[156:159], v[196:199]
  v_exp_f32 v10, v10
  v_mfma_f32_16x16x32_bf16 v[12:15], a[152:155], v[152:155], v[12:15]
  ds_read_b128 a[136:139], v214 offset:40960
  v_mfma_f32_16x16x32_bf16 v[12:15], a[148:151], v[148:151], v[12:15]
  v_exp_f32 v11, v11
  v_mfma_f32_16x16x32_bf16 v[12:15], a[144:147], v[144:147], v[12:15]
  ds_read_b128 a[140:143], v215 offset:40960
  v_cvt_pk_bf16_f32 v9, v10, v11
  v_mfma_f32_16x16x32_bf16 v[20:23], a[144:147], v[160:163], v[200:203]
  v_exp_f32 v16, v16
  v_mfma_f32_16x16x32_bf16 v[20:23], a[148:151], v[164:167], v[20:23]
  buffer_load_dwordx4 v237, s[16:19], s29 offen offset:3072 lds
  v_mfma_f32_16x16x32_bf16 v[20:23], a[152:155], v[168:171], v[20:23]
  s_add_u32 s29, s29, 16384
  v_exp_f32 v17, v17
  v_mfma_f32_16x16x32_bf16 v[20:23], a[156:159], v[172:175], v[20:23]
  v_cvt_pk_bf16_f32 v16, v16, v17
  v_mfma_f32_16x16x32_bf16 v[28:31], a[156:159], v[188:191], v[204:207]
  s_add_u32 m0, s28, 0
  v_exp_f32 v18, v18
  v_mfma_f32_16x16x32_bf16 v[28:31], a[152:155], v[184:187], v[28:31]
  buffer_load_dwordx4 v232, s[12:15], s29 offen offset:0 lds
  v_mfma_f32_16x16x32_bf16 v[28:31], a[148:151], v[180:183], v[28:31]
  s_waitcnt lgkmcnt(0)
  v_exp_f32 v19, v19
  v_mfma_f32_16x16x32_bf16 v[28:31], a[144:147], v[176:179], v[28:31]
  v_cvt_pk_bf16_f32 v17, v18, v19
  v_mfma_f32_16x16x32_bf16 v[32:35], a[128:131], v[128:131], v[192:195]
  v_exp_f32 v24, v24
  v_mfma_f32_16x16x32_bf16 v[32:35], a[132:135], v[132:135], v[32:35]
  ds_read_b128 a[144:147], v212 offset:45056
  v_mfma_f32_16x16x32_bf16 v[32:35], a[136:139], v[136:139], v[32:35]
  v_exp_f32 v25, v25
  v_mfma_f32_16x16x32_bf16 v[32:35], a[140:143], v[140:143], v[32:35]
  ds_read_b128 a[148:151], v213 offset:45056
  v_cvt_pk_bf16_f32 v24, v24, v25
  v_mfma_f32_16x16x32_bf16 v[40:43], a[140:143], v[156:159], v[196:199]
  v_exp_f32 v26, v26
  v_mfma_f32_16x16x32_bf16 v[40:43], a[136:139], v[152:155], v[40:43]
  ds_read_b128 a[152:155], v214 offset:45056
  v_mfma_f32_16x16x32_bf16 v[40:43], a[132:135], v[148:151], v[40:43]
  v_exp_f32 v27, v27
  v_mfma_f32_16x16x32_bf16 v[40:43], a[128:131], v[144:147], v[40:43]
  ds_read_b128 a[156:159], v215 offset:45056
  v_cvt_pk_bf16_f32 v25, v26, v27
  v_mfma_f32_16x16x32_bf16 v[48:51], a[128:131], v[160:163], v[200:203]
  v_exp_f32 v4, v4
  v_mfma_f32_16x16x32_bf16 v[48:51], a[132:135], v[164:167], v[48:51]
  buffer_load_dwordx4 v233, s[12:15], s29 offen offset:1024 lds
  v_mfma_f32_16x16x32_bf16 v[48:51], a[136:139], v[168:171], v[48:51]
  v_exp_f32 v5, v5
  v_mfma_f32_16x16x32_bf16 v[48:51], a[140:143], v[172:175], v[48:51]
  v_cvt_pk_bf16_f32 v2, v4, v5
  v_mfma_f32_16x16x32_bf16 v[56:59], a[140:143], v[188:191], v[204:207]
  v_exp_f32 v6, v6
  v_mfma_f32_16x16x32_bf16 v[56:59], a[136:139], v[184:187], v[56:59]
  buffer_load_dwordx4 v234, s[12:15], s29 offen offset:2048 lds
  v_mfma_f32_16x16x32_bf16 v[56:59], a[132:135], v[180:183], v[56:59]
  s_waitcnt lgkmcnt(0)
  v_exp_f32 v7, v7
  v_mfma_f32_16x16x32_bf16 v[56:59], a[128:131], v[176:179], v[56:59]
  v_cvt_pk_bf16_f32 v3, v6, v7
  v_mfma_f32_16x16x32_bf16 v[36:39], a[144:147], v[128:131], v[192:195]
  v_exp_f32 v12, v12
  v_mfma_f32_16x16x32_bf16 v[36:39], a[148:151], v[132:135], v[36:39]
  ds_read_b64_tr_b16 a[160:161], v216 offset:16384
  v_mfma_f32_16x16x32_bf16 v[36:39], a[152:155], v[136:139], v[36:39]
  v_exp_f32 v13, v13
  v_mfma_f32_16x16x32_bf16 v[36:39], a[156:159], v[140:143], v[36:39]
  ds_read_b64_tr_b16 a[162:163], v216 offset:20480
  v_cvt_pk_bf16_f32 v10, v12, v13
  v_mfma_f32_16x16x32_bf16 v[44:47], a[156:159], v[156:159], v[196:199]
  v_exp_f32 v14, v14
  v_mfma_f32_16x16x32_bf16 v[44:47], a[152:155], v[152:155], v[44:47]
  ds_read_b64_tr_b16 a[164:165], v216 offset:24576
  buffer_load_dwordx4 v235, s[12:15], s29 offen offset:3072 lds
  v_mfma_f32_16x16x32_bf16 v[44:47], a[148:151], v[148:151], v[44:47]
  v_exp_f32 v15, v15
  v_mfma_f32_16x16x32_bf16 v[44:47], a[144:147], v[144:147], v[44:47]
  ds_read_b64_tr_b16 a[166:167], v216 offset:28672
  v_cvt_pk_bf16_f32 v11, v14, v15
  v_mfma_f32_16x16x32_bf16 v[52:55], a[144:147], v[160:163], v[200:203]
  v_exp_f32 v20, v20
  v_mfma_f32_16x16x32_bf16 v[52:55], a[148:151], v[164:167], v[52:55]
  ds_read_b64_tr_b16 a[168:169], v217 offset:16384
  s_add_u32 m0, s50, 1024
  v_mfma_f32_16x16x32_bf16 v[52:55], a[152:155], v[168:171], v[52:55]
  v_exp_f32 v21, v21
  v_mfma_f32_16x16x32_bf16 v[52:55], a[156:159], v[172:175], v[52:55]
  ds_read_b64_tr_b16 a[170:171], v217 offset:20480
  v_cvt_pk_bf16_f32 v18, v20, v21
  v_mfma_f32_16x16x32_bf16 v[60:63], a[156:159], v[188:191], v[204:207]
  v_exp_f32 v22, v22
  v_mfma_f32_16x16x32_bf16 v[60:63], a[152:155], v[184:187], v[60:63]
  ds_read_b64_tr_b16 a[172:173], v217 offset:24576
  buffer_load_dwordx4 v253, s[20:23], s35 offen lds
  v_mfma_f32_16x16x32_bf16 v[60:63], a[148:151], v[180:183], v[60:63]
  v_exp_f32 v23, v23
  v_mfma_f32_16x16x32_bf16 v[60:63], a[144:147], v[176:179], v[60:63]
  ds_read_b64_tr_b16 a[174:175], v217 offset:28672
  v_cvt_pk_bf16_f32 v19, v22, v23
  v_mfma_f32_16x16x32_bf16 a[192:195], a[208:211], v[64:67], a[192:195]
  v_exp_f32 v28, v28
  v_mfma_f32_16x16x32_bf16 a[192:195], a[208:211], v[96:99], a[192:195]
  ds_read_b64_tr_b16 a[176:177], v218 offset:16384
  v_mfma_f32_16x16x32_bf16 a[196:199], a[208:211], v[72:75], a[196:199]
  v_exp_f32 v29, v29
  v_mfma_f32_16x16x32_bf16 a[196:199], a[208:211], v[104:107], a[196:199]
  ds_read_b64_tr_b16 a[178:179], v218 offset:20480
  v_cvt_pk_bf16_f32 v26, v28, v29
  v_mfma_f32_16x16x32_bf16 a[200:203], a[208:211], v[80:83], a[200:203]
  v_exp_f32 v30, v30
  v_mfma_f32_16x16x32_bf16 a[200:203], a[208:211], v[112:115], a[200:203]
  ds_read_b64_tr_b16 a[180:181], v218 offset:24576
  v_mfma_f32_16x16x32_bf16 a[204:207], a[208:211], v[88:91], a[204:207]
  s_waitcnt lgkmcnt(7)
  v_exp_f32 v31, v31
  v_mfma_f32_16x16x32_bf16 a[204:207], a[208:211], v[120:123], a[204:207]
  ds_read_b64_tr_b16 a[182:183], v218 offset:28672
  v_cvt_pk_bf16_f32 v27, v30, v31
  v_mfma_f32_16x16x32_bf16 a[0:3], a[160:163], v[64:67], a[0:3]
  v_exp_f32 v32, v32
  v_mfma_f32_16x16x32_bf16 a[0:3], a[164:167], v[96:99], a[0:3]
  ds_read_b64_tr_b16 a[184:185], v219 offset:16384
  v_mfma_f32_16x16x32_bf16 a[4:7], a[164:167], v[104:107], a[4:7]
  v_exp_f32 v33, v33
  v_mfma_f32_16x16x32_bf16 a[4:7], a[160:163], v[72:75], a[4:7]
  ds_read_b64_tr_b16 a[186:187], v219 offset:20480
  v_cvt_pk_bf16_f32 v32, v32, v33
  v_mfma_f32_16x16x32_bf16 a[8:11], a[160:163], v[80:83], a[8:11]
  v_exp_f32 v34, v34
  v_mfma_f32_16x16x32_bf16 a[8:11], a[164:167], v[112:115], a[8:11]
  ds_read_b64_tr_b16 a[188:189], v219 offset:24576
  v_mfma_f32_16x16x32_bf16 a[12:15], a[164:167], v[120:123], a[12:15]
  s_waitcnt lgkmcnt(7)
  v_exp_f32 v35, v35
  v_mfma_f32_16x16x32_bf16 a[12:15], a[160:163], v[88:91], a[12:15]
  ds_read_b64_tr_b16 a[190:191], v219 offset:28672
  v_cvt_pk_bf16_f32 v33, v34, v35
  v_mfma_f32_16x16x32_bf16 a[16:19], a[168:171], v[64:67], a[16:19]
  v_exp_f32 v40, v40
  v_mfma_f32_16x16x32_bf16 a[16:19], a[172:175], v[96:99], a[16:19]
  ds_read_b64_tr_b16 a[160:161], v220 offset:16384
  v_mfma_f32_16x16x32_bf16 a[20:23], a[172:175], v[104:107], a[20:23]
  v_exp_f32 v41, v41
  v_mfma_f32_16x16x32_bf16 a[20:23], a[168:171], v[72:75], a[20:23]
  ds_read_b64_tr_b16 a[162:163], v220 offset:20480
  v_cvt_pk_bf16_f32 v40, v40, v41
  v_mfma_f32_16x16x32_bf16 a[24:27], a[168:171], v[80:83], a[24:27]
  v_exp_f32 v42, v42
  v_mfma_f32_16x16x32_bf16 a[24:27], a[172:175], v[112:115], a[24:27]
  ds_read_b64_tr_b16 a[164:165], v220 offset:24576
  v_mfma_f32_16x16x32_bf16 a[28:31], a[172:175], v[120:123], a[28:31]
  s_waitcnt lgkmcnt(7)
  v_exp_f32 v43, v43
  v_mfma_f32_16x16x32_bf16 a[28:31], a[168:171], v[88:91], a[28:31]
  ds_read_b64_tr_b16 a[166:167], v220 offset:28672
  v_cvt_pk_bf16_f32 v41, v42, v43
  v_mfma_f32_16x16x32_bf16 a[32:35], a[176:179], v[64:67], a[32:35]
  v_exp_f32 v48, v48
  v_mfma_f32_16x16x32_bf16 a[32:35], a[180:183], v[96:99], a[32:35]
  ds_read_b64_tr_b16 a[168:169], v221 offset:16384
  v_mfma_f32_16x16x32_bf16 a[36:39], a[180:183], v[104:107], a[36:39]
  v_exp_f32 v49, v49
  v_mfma_f32_16x16x32_bf16 a[36:39], a[176:179], v[72:75], a[36:39]
  ds_read_b64_tr_b16 a[170:171], v221 offset:20480
  v_cvt_pk_bf16_f32 v48, v48, v49
  v_mfma_f32_16x16x32_bf16 a[40:43], a[176:179], v[80:83], a[40:43]
  v_exp_f32 v50, v50
  v_mfma_f32_16x16x32_bf16 a[40:43], a[180:183], v[112:115], a[40:43]
  ds_read_b64_tr_b16 a[172:173], v221 offset:24576
  v_mfma_f32_16x16x32_bf16 a[44:47], a[180:183], v[120:123], a[44:47]
  s_waitcnt lgkmcnt(7)
  v_exp_f32 v51, v51
  v_mfma_f32_16x16x32_bf16 a[44:47], a[176:179], v[88:91], a[44:47]
  ds_read_b64_tr_b16 a[174:175], v221 offset:28672
  v_cvt_pk_bf16_f32 v49, v50, v51
  v_mfma_f32_16x16x32_bf16 a[48:51], a[184:187], v[64:67], a[48:51]
  v_exp_f32 v56, v56
  v_mfma_f32_16x16x32_bf16 a[48:51], a[188:191], v[96:99], a[48:51]
  ds_read_b64_tr_b16 a[176:177], v222 offset:16384
  v_mfma_f32_16x16x32_bf16 a[52:55], a[188:191], v[104:107], a[52:55]
  v_exp_f32 v57, v57
  v_mfma_f32_16x16x32_bf16 a[52:55], a[184:187], v[72:75], a[52:55]
  ds_read_b64_tr_b16 a[178:179], v222 offset:20480
  v_cvt_pk_bf16_f32 v56, v56, v57
  v_mfma_f32_16x16x32_bf16 a[56:59], a[184:187], v[80:83], a[56:59]
  v_exp_f32 v58, v58
  v_mfma_f32_16x16x32_bf16 a[56:59], a[188:191], v[112:115], a[56:59]
  ds_read_b64_tr_b16 a[180:181], v222 offset:24576
  v_mfma_f32_16x16x32_bf16 a[60:63], a[188:191], v[120:123], a[60:63]
  s_waitcnt lgkmcnt(7)
  v_exp_f32 v59, v59
  v_mfma_f32_16x16x32_bf16 a[60:63], a[184:187], v[88:91], a[60:63]
  ds_read_b64_tr_b16 a[182:183], v222 offset:28672
  v_cvt_pk_bf16_f32 v57, v58, v59
  v_mfma_f32_16x16x32_bf16 a[64:67], a[160:163], v[64:67], a[64:67]
  v_exp_f32 v36, v36
  v_mfma_f32_16x16x32_bf16 a[64:67], a[164:167], v[96:99], a[64:67]
  ds_read_b64_tr_b16 a[184:185], v223 offset:16384
  v_mfma_f32_16x16x32_bf16 a[68:71], a[164:167], v[104:107], a[68:71]
  v_exp_f32 v37, v37
  v_mfma_f32_16x16x32_bf16 a[68:71], a[160:163], v[72:75], a[68:71]
  ds_read_b64_tr_b16 a[186:187], v223 offset:20480
  v_cvt_pk_bf16_f32 v34, v36, v37
  v_mfma_f32_16x16x32_bf16 a[72:75], a[160:163], v[80:83], a[72:75]
  v_exp_f32 v38, v38
  v_mfma_f32_16x16x32_bf16 a[72:75], a[164:167], v[112:115], a[72:75]
  ds_read_b64_tr_b16 a[188:189], v223 offset:24576
  v_mfma_f32_16x16x32_bf16 a[76:79], a[164:167], v[120:123], a[76:79]
  s_waitcnt lgkmcnt(7)
  v_exp_f32 v39, v39
  v_mfma_f32_16x16x32_bf16 a[76:79], a[160:163], v[88:91], a[76:79]
  ds_read_b64_tr_b16 a[190:191], v223 offset:28672
  v_cvt_pk_bf16_f32 v35, v38, v39
  v_mfma_f32_16x16x32_bf16 a[80:83], a[168:171], v[64:67], a[80:83]
  s_waitcnt vmcnt(11)
  v_exp_f32 v44, v44
  v_mfma_f32_16x16x32_bf16 a[80:83], a[172:175], v[96:99], a[80:83]
  v_mfma_f32_16x16x32_bf16 a[84:87], a[172:175], v[104:107], a[84:87]
  s_barrier
  v_exp_f32 v45, v45
  v_mfma_f32_16x16x32_bf16 a[84:87], a[168:171], v[72:75], a[84:87]
  ds_read_b128 a[128:131], v212 offset:49152
  v_cvt_pk_bf16_f32 v42, v44, v45
  v_mfma_f32_16x16x32_bf16 a[88:91], a[168:171], v[80:83], a[88:91]
  v_exp_f32 v46, v46
  v_mfma_f32_16x16x32_bf16 a[88:91], a[172:175], v[112:115], a[88:91]
  ds_read_b128 a[132:135], v213 offset:49152
  v_mfma_f32_16x16x32_bf16 a[92:95], a[172:175], v[120:123], a[92:95]
  s_waitcnt lgkmcnt(6)
  v_exp_f32 v47, v47
  v_mfma_f32_16x16x32_bf16 a[92:95], a[168:171], v[88:91], a[92:95]
  ds_read_b128 a[136:139], v214 offset:49152
  v_cvt_pk_bf16_f32 v43, v46, v47
  v_mfma_f32_16x16x32_bf16 a[96:99], a[176:179], v[64:67], a[96:99]
  v_exp_f32 v52, v52
  v_mfma_f32_16x16x32_bf16 a[96:99], a[180:183], v[96:99], a[96:99]
  ds_read_b128 a[140:143], v215 offset:49152
  buffer_load_dwordx4 a[216:219], v243, s[24:27], s38 offen sc1
  s_add_u32 s38, s38, 4096
  v_mfma_f32_16x16x32_bf16 a[100:103], a[180:183], v[104:107], a[100:103]
  v_exp_f32 v53, v53
  v_mfma_f32_16x16x32_bf16 a[100:103], a[176:179], v[72:75], a[100:103]
  v_cvt_pk_bf16_f32 v50, v52, v53
  v_mfma_f32_16x16x32_bf16 a[104:107], a[176:179], v[80:83], a[104:107]
  v_exp_f32 v54, v54
  v_mfma_f32_16x16x32_bf16 a[104:107], a[180:183], v[112:115], a[104:107]
  v_mfma_f32_16x16x32_bf16 a[108:111], a[180:183], v[120:123], a[108:111]
  s_waitcnt lgkmcnt(4)
  v_exp_f32 v55, v55
  v_mfma_f32_16x16x32_bf16 a[108:111], a[176:179], v[88:91], a[108:111]
  v_cvt_pk_bf16_f32 v51, v54, v55
  v_mfma_f32_16x16x32_bf16 a[112:115], a[184:187], v[64:67], a[112:115]
  v_exp_f32 v60, v60
  v_mfma_f32_16x16x32_bf16 a[112:115], a[188:191], v[96:99], a[112:115]
  v_mfma_f32_16x16x32_bf16 a[116:119], a[188:191], v[104:107], a[116:119]
  v_exp_f32 v61, v61
  v_mfma_f32_16x16x32_bf16 a[116:119], a[184:187], v[72:75], a[116:119]
  v_cvt_pk_bf16_f32 v58, v60, v61
  v_mfma_f32_16x16x32_bf16 a[120:123], a[184:187], v[80:83], a[120:123]
  v_exp_f32 v62, v62
  v_mfma_f32_16x16x32_bf16 a[120:123], a[188:191], v[112:115], a[120:123]
  v_mfma_f32_16x16x32_bf16 a[124:127], a[188:191], v[120:123], a[124:127]
  s_waitcnt lgkmcnt(0)
  v_exp_f32 v63, v63
  v_mfma_f32_16x16x32_bf16 a[124:127], a[184:187], v[88:91], a[124:127]
  v_cvt_pk_bf16_f32 v59, v62, v63
  v_mfma_f32_16x16x32_bf16 v[64:67], a[128:131], v[128:131], v[192:195]
  s_add_u32 m0, s28, 65536
  v_mfma_f32_16x16x32_bf16 v[64:67], a[132:135], v[132:135], v[64:67]
  ds_read_b128 a[144:147], v212 offset:53248
  v_mfma_f32_16x16x32_bf16 v[64:67], a[136:139], v[136:139], v[64:67]
  buffer_load_dwordx4 v236, s[16:19], s29 offen offset:0 lds
  v_mfma_f32_16x16x32_bf16 v[64:67], a[140:143], v[140:143], v[64:67]
  ds_read_b128 a[148:151], v213 offset:53248
  v_mfma_f32_16x16x32_bf16 v[72:75], a[140:143], v[156:159], v[196:199]
  v_mfma_f32_16x16x32_bf16 v[72:75], a[136:139], v[152:155], v[72:75]
  ds_read_b128 a[152:155], v214 offset:53248
  v_mfma_f32_16x16x32_bf16 v[72:75], a[132:135], v[148:151], v[72:75]
  buffer_load_dwordx4 v237, s[16:19], s29 offen offset:1024 lds
  v_mfma_f32_16x16x32_bf16 v[72:75], a[128:131], v[144:147], v[72:75]
  ds_read_b128 a[156:159], v215 offset:53248
  v_mfma_f32_16x16x32_bf16 v[80:83], a[128:131], v[160:163], v[200:203]
  v_exp_f32 v64, v64
  v_mfma_f32_16x16x32_bf16 v[80:83], a[132:135], v[164:167], v[80:83]
  v_mfma_f32_16x16x32_bf16 v[80:83], a[136:139], v[168:171], v[80:83]
  v_exp_f32 v65, v65
  v_mfma_f32_16x16x32_bf16 v[80:83], a[140:143], v[172:175], v[80:83]
  v_cvt_pk_bf16_f32 v64, v64, v65
  v_mfma_f32_16x16x32_bf16 v[88:91], a[140:143], v[188:191], v[204:207]
  v_exp_f32 v66, v66
  v_mfma_f32_16x16x32_bf16 v[88:91], a[136:139], v[184:187], v[88:91]
  buffer_load_dwordx4 v236, s[16:19], s29 offen offset:2048 lds
  v_mfma_f32_16x16x32_bf16 v[88:91], a[132:135], v[180:183], v[88:91]
  s_waitcnt lgkmcnt(0)
  v_exp_f32 v67, v67
  v_mfma_f32_16x16x32_bf16 v[88:91], a[128:131], v[176:179], v[88:91]
  v_cvt_pk_bf16_f32 v65, v66, v67
  v_mfma_f32_16x16x32_bf16 v[68:71], a[144:147], v[128:131], v[192:195]
  v_exp_f32 v72, v72
  v_mfma_f32_16x16x32_bf16 v[68:71], a[148:151], v[132:135], v[68:71]
  ds_read_b128 a[128:131], v212 offset:57344
  v_mfma_f32_16x16x32_bf16 v[68:71], a[152:155], v[136:139], v[68:71]
  v_exp_f32 v73, v73
  v_mfma_f32_16x16x32_bf16 v[68:71], a[156:159], v[140:143], v[68:71]
  ds_read_b128 a[132:135], v213 offset:57344
  v_cvt_pk_bf16_f32 v72, v72, v73
  v_mfma_f32_16x16x32_bf16 v[76:79], a[156:159], v[156:159], v[196:199]
  v_exp_f32 v74, v74
  v_mfma_f32_16x16x32_bf16 v[76:79], a[152:155], v[152:155], v[76:79]
  ds_read_b128 a[136:139], v214 offset:57344
  v_mfma_f32_16x16x32_bf16 v[76:79], a[148:151], v[148:151], v[76:79]
  v_exp_f32 v75, v75
  v_mfma_f32_16x16x32_bf16 v[76:79], a[144:147], v[144:147], v[76:79]
  ds_read_b128 a[140:143], v215 offset:57344
  v_cvt_pk_bf16_f32 v73, v74, v75
  v_mfma_f32_16x16x32_bf16 v[84:87], a[144:147], v[160:163], v[200:203]
  v_exp_f32 v80, v80
  v_mfma_f32_16x16x32_bf16 v[84:87], a[148:151], v[164:167], v[84:87]
  buffer_load_dwordx4 v237, s[16:19], s29 offen offset:3072 lds
  v_mfma_f32_16x16x32_bf16 v[84:87], a[152:155], v[168:171], v[84:87]
  s_add_u32 s29, s29, 16384
  v_exp_f32 v81, v81
  v_mfma_f32_16x16x32_bf16 v[84:87], a[156:159], v[172:175], v[84:87]
  v_cvt_pk_bf16_f32 v80, v80, v81
  v_mfma_f32_16x16x32_bf16 v[92:95], a[156:159], v[188:191], v[204:207]
  s_add_u32 m0, s28, 16384
  v_exp_f32 v82, v82
  v_mfma_f32_16x16x32_bf16 v[92:95], a[152:155], v[184:187], v[92:95]
  buffer_load_dwordx4 v232, s[12:15], s29 offen offset:0 lds
  v_mfma_f32_16x16x32_bf16 v[92:95], a[148:151], v[180:183], v[92:95]
  s_waitcnt lgkmcnt(0)
  v_exp_f32 v83, v83
  v_mfma_f32_16x16x32_bf16 v[92:95], a[144:147], v[176:179], v[92:95]
  v_cvt_pk_bf16_f32 v81, v82, v83
  v_mfma_f32_16x16x32_bf16 v[96:99], a[128:131], v[128:131], v[192:195]
  v_exp_f32 v88, v88
  v_mfma_f32_16x16x32_bf16 v[96:99], a[132:135], v[132:135], v[96:99]
  ds_read_b128 a[144:147], v212 offset:61440
  v_mfma_f32_16x16x32_bf16 v[96:99], a[136:139], v[136:139], v[96:99]
  v_exp_f32 v89, v89
  v_mfma_f32_16x16x32_bf16 v[96:99], a[140:143], v[140:143], v[96:99]
  ds_read_b128 a[148:151], v213 offset:61440
  v_cvt_pk_bf16_f32 v88, v88, v89
  v_mfma_f32_16x16x32_bf16 v[104:107], a[140:143], v[156:159], v[196:199]
  v_exp_f32 v90, v90
  v_mfma_f32_16x16x32_bf16 v[104:107], a[136:139], v[152:155], v[104:107]
  ds_read_b128 a[152:155], v214 offset:61440
  v_mfma_f32_16x16x32_bf16 v[104:107], a[132:135], v[148:151], v[104:107]
  v_exp_f32 v91, v91
  v_mfma_f32_16x16x32_bf16 v[104:107], a[128:131], v[144:147], v[104:107]
  ds_read_b128 a[156:159], v215 offset:61440
  v_cvt_pk_bf16_f32 v89, v90, v91
  v_mfma_f32_16x16x32_bf16 v[112:115], a[128:131], v[160:163], v[200:203]
  v_exp_f32 v68, v68
  v_mfma_f32_16x16x32_bf16 v[112:115], a[132:135], v[164:167], v[112:115]
  buffer_load_dwordx4 v233, s[12:15], s29 offen offset:1024 lds
  v_mfma_f32_16x16x32_bf16 v[112:115], a[136:139], v[168:171], v[112:115]
  v_exp_f32 v69, v69
  v_mfma_f32_16x16x32_bf16 v[112:115], a[140:143], v[172:175], v[112:115]
  v_cvt_pk_bf16_f32 v66, v68, v69
  v_mfma_f32_16x16x32_bf16 v[120:123], a[140:143], v[188:191], v[204:207]
  v_exp_f32 v70, v70
  v_mfma_f32_16x16x32_bf16 v[120:123], a[136:139], v[184:187], v[120:123]
  buffer_load_dwordx4 v234, s[12:15], s29 offen offset:2048 lds
  v_mfma_f32_16x16x32_bf16 v[120:123], a[132:135], v[180:183], v[120:123]
  s_waitcnt lgkmcnt(0)
  v_exp_f32 v71, v71
  v_mfma_f32_16x16x32_bf16 v[120:123], a[128:131], v[176:179], v[120:123]
  v_cvt_pk_bf16_f32 v67, v70, v71
  v_mfma_f32_16x16x32_bf16 v[100:103], a[144:147], v[128:131], v[192:195]
  v_exp_f32 v76, v76
  v_mfma_f32_16x16x32_bf16 v[100:103], a[148:151], v[132:135], v[100:103]
  ds_read_b64_tr_b16 a[160:161], v216 offset:32768
  v_mfma_f32_16x16x32_bf16 v[100:103], a[152:155], v[136:139], v[100:103]
  v_exp_f32 v77, v77
  v_mfma_f32_16x16x32_bf16 v[100:103], a[156:159], v[140:143], v[100:103]
  ds_read_b64_tr_b16 a[162:163], v216 offset:36864
  v_cvt_pk_bf16_f32 v74, v76, v77
  v_mfma_f32_16x16x32_bf16 v[108:111], a[156:159], v[156:159], v[196:199]
  v_exp_f32 v78, v78
  v_mfma_f32_16x16x32_bf16 v[108:111], a[152:155], v[152:155], v[108:111]
  ds_read_b64_tr_b16 a[164:165], v216 offset:40960
  buffer_load_dwordx4 v235, s[12:15], s29 offen offset:3072 lds
  v_mfma_f32_16x16x32_bf16 v[108:111], a[148:151], v[148:151], v[108:111]
  v_exp_f32 v79, v79
  v_mfma_f32_16x16x32_bf16 v[108:111], a[144:147], v[144:147], v[108:111]
  ds_read_b64_tr_b16 a[166:167], v216 offset:45056
  v_cvt_pk_bf16_f32 v75, v78, v79
  v_mfma_f32_16x16x32_bf16 v[116:119], a[144:147], v[160:163], v[200:203]
  v_exp_f32 v84, v84
  v_mfma_f32_16x16x32_bf16 v[116:119], a[148:151], v[164:167], v[116:119]
  ds_read_b64_tr_b16 a[168:169], v217 offset:32768
  s_add_u32 m0, s50, 4096
  v_mfma_f32_16x16x32_bf16 v[116:119], a[152:155], v[168:171], v[116:119]
  v_exp_f32 v85, v85
  v_mfma_f32_16x16x32_bf16 v[116:119], a[156:159], v[172:175], v[116:119]
  ds_read_b64_tr_b16 a[170:171], v217 offset:36864
  v_cvt_pk_bf16_f32 v82, v84, v85
  v_mfma_f32_16x16x32_bf16 v[124:127], a[156:159], v[188:191], v[204:207]
  v_exp_f32 v86, v86
  v_mfma_f32_16x16x32_bf16 v[124:127], a[152:155], v[184:187], v[124:127]
  ds_read_b64_tr_b16 a[172:173], v217 offset:40960
  buffer_load_dwordx4 v253, s[44:47], s35 offen lds
  s_add_u32 s35, s35, 221184
  v_mfma_f32_16x16x32_bf16 v[124:127], a[148:151], v[180:183], v[124:127]
  v_exp_f32 v87, v87
  v_mfma_f32_16x16x32_bf16 v[124:127], a[144:147], v[176:179], v[124:127]
  ds_read_b64_tr_b16 a[174:175], v217 offset:45056
  v_cvt_pk_bf16_f32 v83, v86, v87
  v_mfma_f32_16x16x32_bf16 a[192:195], a[208:211], v[0:3], a[192:195]
  v_exp_f32 v92, v92
  v_mfma_f32_16x16x32_bf16 a[192:195], a[208:211], v[32:35], a[192:195]
  ds_read_b64_tr_b16 a[176:177], v218 offset:32768
  v_lshrrev_b32 v254, 4, v242
  v_mfma_f32_16x16x32_bf16 a[196:199], a[208:211], v[8:11], a[196:199]
  v_exp_f32 v93, v93
  v_mfma_f32_16x16x32_bf16 a[196:199], a[208:211], v[40:43], a[196:199]
  ds_read_b64_tr_b16 a[178:179], v218 offset:36864
  v_cvt_pk_bf16_f32 v90, v92, v93
  v_mfma_f32_16x16x32_bf16 a[200:203], a[208:211], v[16:19], a[200:203]
  v_exp_f32 v94, v94
  v_mfma_f32_16x16x32_bf16 a[200:203], a[208:211], v[48:51], a[200:203]
  ds_read_b64_tr_b16 a[180:181], v218 offset:40960
  v_lshrrev_b32 v254, 5, v254
  v_mfma_f32_16x16x32_bf16 a[204:207], a[208:211], v[24:27], a[204:207]
  s_waitcnt lgkmcnt(7)
  v_exp_f32 v95, v95
  v_mfma_f32_16x16x32_bf16 a[204:207], a[208:211], v[56:59], a[204:207]
  ds_read_b64_tr_b16 a[182:183], v218 offset:45056
  v_cvt_pk_bf16_f32 v91, v94, v95
  v_mfma_f32_16x16x32_bf16 a[0:3], a[160:163], v[0:3], a[0:3]
  v_exp_f32 v96, v96
  v_mfma_f32_16x16x32_bf16 a[0:3], a[164:167], v[32:35], a[0:3]
  ds_read_b64_tr_b16 a[184:185], v219 offset:32768
  v_lshl_add_u32 v253, v254, 30, v253
  v_mfma_f32_16x16x32_bf16 a[4:7], a[164:167], v[40:43], a[4:7]
  v_exp_f32 v97, v97
  v_mfma_f32_16x16x32_bf16 a[4:7], a[160:163], v[8:11], a[4:7]
  ds_read_b64_tr_b16 a[186:187], v219 offset:36864
  v_cvt_pk_bf16_f32 v96, v96, v97
  v_mfma_f32_16x16x32_bf16 a[8:11], a[160:163], v[16:19], a[8:11]
  v_exp_f32 v98, v98
  v_mfma_f32_16x16x32_bf16 a[8:11], a[164:167], v[48:51], a[8:11]
  ds_read_b64_tr_b16 a[188:189], v219 offset:40960
  v_mfma_f32_16x16x32_bf16 a[12:15], a[164:167], v[56:59], a[12:15]
  s_waitcnt lgkmcnt(7)
  v_exp_f32 v99, v99
  v_mfma_f32_16x16x32_bf16 a[12:15], a[160:163], v[24:27], a[12:15]
  ds_read_b64_tr_b16 a[190:191], v219 offset:45056
  v_cvt_pk_bf16_f32 v97, v98, v99
  v_mfma_f32_16x16x32_bf16 a[16:19], a[168:171], v[0:3], a[16:19]
  v_exp_f32 v104, v104
  v_mfma_f32_16x16x32_bf16 a[16:19], a[172:175], v[32:35], a[16:19]
  ds_read_b64_tr_b16 a[160:161], v220 offset:32768
  v_mfma_f32_16x16x32_bf16 a[20:23], a[172:175], v[40:43], a[20:23]
  v_exp_f32 v105, v105
  v_mfma_f32_16x16x32_bf16 a[20:23], a[168:171], v[8:11], a[20:23]
  ds_read_b64_tr_b16 a[162:163], v220 offset:36864
  v_cvt_pk_bf16_f32 v104, v104, v105
  v_mfma_f32_16x16x32_bf16 a[24:27], a[168:171], v[16:19], a[24:27]
  v_exp_f32 v106, v106
  v_mfma_f32_16x16x32_bf16 a[24:27], a[172:175], v[48:51], a[24:27]
  ds_read_b64_tr_b16 a[164:165], v220 offset:40960
  v_mfma_f32_16x16x32_bf16 a[28:31], a[172:175], v[56:59], a[28:31]
  s_waitcnt lgkmcnt(7)
  v_exp_f32 v107, v107
  v_mfma_f32_16x16x32_bf16 a[28:31], a[168:171], v[24:27], a[28:31]
  ds_read_b64_tr_b16 a[166:167], v220 offset:45056
  v_cvt_pk_bf16_f32 v105, v106, v107
  v_mfma_f32_16x16x32_bf16 a[32:35], a[176:179], v[0:3], a[32:35]
  v_exp_f32 v112, v112
  v_mfma_f32_16x16x32_bf16 a[32:35], a[180:183], v[32:35], a[32:35]
  ds_read_b64_tr_b16 a[168:169], v221 offset:32768
  v_mfma_f32_16x16x32_bf16 a[36:39], a[180:183], v[40:43], a[36:39]
  v_exp_f32 v113, v113
  v_mfma_f32_16x16x32_bf16 a[36:39], a[176:179], v[8:11], a[36:39]
  ds_read_b64_tr_b16 a[170:171], v221 offset:36864
  v_cvt_pk_bf16_f32 v112, v112, v113
  v_mfma_f32_16x16x32_bf16 a[40:43], a[176:179], v[16:19], a[40:43]
  v_exp_f32 v114, v114
  v_mfma_f32_16x16x32_bf16 a[40:43], a[180:183], v[48:51], a[40:43]
  ds_read_b64_tr_b16 a[172:173], v221 offset:40960
  v_mfma_f32_16x16x32_bf16 a[44:47], a[180:183], v[56:59], a[44:47]
  s_waitcnt lgkmcnt(7)
  v_exp_f32 v115, v115
  v_mfma_f32_16x16x32_bf16 a[44:47], a[176:179], v[24:27], a[44:47]
  ds_read_b64_tr_b16 a[174:175], v221 offset:45056
  v_cvt_pk_bf16_f32 v113, v114, v115
  v_mfma_f32_16x16x32_bf16 a[48:51], a[184:187], v[0:3], a[48:51]
  v_exp_f32 v120, v120
  v_mfma_f32_16x16x32_bf16 a[48:51], a[188:191], v[32:35], a[48:51]
  ds_read_b64_tr_b16 a[176:177], v222 offset:32768
  v_mfma_f32_16x16x32_bf16 a[52:55], a[188:191], v[40:43], a[52:55]
  v_exp_f32 v121, v121
  v_mfma_f32_16x16x32_bf16 a[52:55], a[184:187], v[8:11], a[52:55]
  ds_read_b64_tr_b16 a[178:179], v222 offset:36864
  v_cvt_pk_bf16_f32 v120, v120, v121
  v_mfma_f32_16x16x32_bf16 a[56:59], a[184:187], v[16:19], a[56:59]
  v_exp_f32 v122, v122
  v_mfma_f32_16x16x32_bf16 a[56:59], a[188:191], v[48:51], a[56:59]
  ds_read_b64_tr_b16 a[180:181], v222 offset:40960
  v_mfma_f32_16x16x32_bf16 a[60:63], a[188:191], v[56:59], a[60:63]
  s_waitcnt lgkmcnt(7)
  v_exp_f32 v123, v123
  v_mfma_f32_16x16x32_bf16 a[60:63], a[184:187], v[24:27], a[60:63]
  ds_read_b64_tr_b16 a[182:183], v222 offset:45056
  v_cvt_pk_bf16_f32 v121, v122, v123
  v_mfma_f32_16x16x32_bf16 a[64:67], a[160:163], v[0:3], a[64:67]
  v_exp_f32 v100, v100
  v_mfma_f32_16x16x32_bf16 a[64:67], a[164:167], v[32:35], a[64:67]
  ds_read_b64_tr_b16 a[184:185], v223 offset:32768
  v_mfma_f32_16x16x32_bf16 a[68:71], a[164:167], v[40:43], a[68:71]
  v_exp_f32 v101, v101
  v_mfma_f32_16x16x32_bf16 a[68:71], a[160:163], v[8:11], a[68:71]
  ds_read_b64_tr_b16 a[186:187], v223 offset:36864
  v_cvt_pk_bf16_f32 v98, v100, v101
  v_mfma_f32_16x16x32_bf16 a[72:75], a[160:163], v[16:19], a[72:75]
  v_exp_f32 v102, v102
  v_mfma_f32_16x16x32_bf16 a[72:75], a[164:167], v[48:51], a[72:75]
  ds_read_b64_tr_b16 a[188:189], v223 offset:40960
  v_mfma_f32_16x16x32_bf16 a[76:79], a[164:167], v[56:59], a[76:79]
  s_waitcnt lgkmcnt(7)
  v_exp_f32 v103, v103
  v_mfma_f32_16x16x32_bf16 a[76:79], a[160:163], v[24:27], a[76:79]
  ds_read_b64_tr_b16 a[190:191], v223 offset:45056
  v_cvt_pk_bf16_f32 v99, v102, v103
  v_mfma_f32_16x16x32_bf16 a[80:83], a[168:171], v[0:3], a[80:83]
  s_waitcnt vmcnt(11)
  v_exp_f32 v108, v108
  v_mfma_f32_16x16x32_bf16 a[80:83], a[172:175], v[32:35], a[80:83]
  v_mfma_f32_16x16x32_bf16 a[84:87], a[172:175], v[40:43], a[84:87]
  s_barrier
  v_exp_f32 v109, v109
  v_mfma_f32_16x16x32_bf16 a[84:87], a[168:171], v[8:11], a[84:87]
  ds_read_b128 a[128:131], v212 offset:0
  v_cvt_pk_bf16_f32 v106, v108, v109
  v_mfma_f32_16x16x32_bf16 a[88:91], a[168:171], v[16:19], a[88:91]
  v_exp_f32 v110, v110
  v_mfma_f32_16x16x32_bf16 a[88:91], a[172:175], v[48:51], a[88:91]
  ds_read_b128 a[132:135], v213 offset:0
  v_mfma_f32_16x16x32_bf16 a[92:95], a[172:175], v[56:59], a[92:95]
  s_waitcnt lgkmcnt(6)
  v_exp_f32 v111, v111
  v_mfma_f32_16x16x32_bf16 a[92:95], a[168:171], v[24:27], a[92:95]
  ds_read_b128 a[136:139], v214 offset:0
  v_cvt_pk_bf16_f32 v107, v110, v111
  v_mfma_f32_16x16x32_bf16 a[96:99], a[176:179], v[0:3], a[96:99]
  v_exp_f32 v116, v116
  v_mfma_f32_16x16x32_bf16 a[96:99], a[180:183], v[32:35], a[96:99]
  ds_read_b128 a[140:143], v215 offset:0
  buffer_load_dwordx4 a[220:223], v243, s[24:27], s38 offen sc1
  s_add_u32 s38, s38, 4096
  v_mfma_f32_16x16x32_bf16 a[100:103], a[180:183], v[40:43], a[100:103]
  v_exp_f32 v117, v117
  v_mfma_f32_16x16x32_bf16 a[100:103], a[176:179], v[8:11], a[100:103]
  v_cvt_pk_bf16_f32 v114, v116, v117
  v_mfma_f32_16x16x32_bf16 a[104:107], a[176:179], v[16:19], a[104:107]
  v_exp_f32 v118, v118
  v_mfma_f32_16x16x32_bf16 a[104:107], a[180:183], v[48:51], a[104:107]
  v_mfma_f32_16x16x32_bf16 a[108:111], a[180:183], v[56:59], a[108:111]
  s_waitcnt lgkmcnt(4)
  v_exp_f32 v119, v119
  v_mfma_f32_16x16x32_bf16 a[108:111], a[176:179], v[24:27], a[108:111]
  v_cvt_pk_bf16_f32 v115, v118, v119
  v_mfma_f32_16x16x32_bf16 a[112:115], a[184:187], v[0:3], a[112:115]
  v_exp_f32 v124, v124
  v_mfma_f32_16x16x32_bf16 a[112:115], a[188:191], v[32:35], a[112:115]
  v_mfma_f32_16x16x32_bf16 a[116:119], a[188:191], v[40:43], a[116:119]
  v_exp_f32 v125, v125
  v_mfma_f32_16x16x32_bf16 a[116:119], a[184:187], v[8:11], a[116:119]
  v_cvt_pk_bf16_f32 v122, v124, v125
  v_mfma_f32_16x16x32_bf16 a[120:123], a[184:187], v[16:19], a[120:123]
  v_exp_f32 v126, v126
  v_mfma_f32_16x16x32_bf16 a[120:123], a[188:191], v[48:51], a[120:123]
  v_mfma_f32_16x16x32_bf16 a[124:127], a[188:191], v[56:59], a[124:127]
  s_waitcnt lgkmcnt(0)
  v_exp_f32 v127, v127
  v_mfma_f32_16x16x32_bf16 a[124:127], a[184:187], v[24:27], a[124:127]
  v_cvt_pk_bf16_f32 v123, v126, v127
  v_mfma_f32_16x16x32_bf16 v[0:3], a[128:131], v[128:131], v[192:195]
  s_add_u32 m0, s28, 81920
  v_mfma_f32_16x16x32_bf16 v[0:3], a[132:135], v[132:135], v[0:3]
  ds_read_b128 a[144:147], v212 offset:4096
  v_mfma_f32_16x16x32_bf16 v[0:3], a[136:139], v[136:139], v[0:3]
  buffer_load_dwordx4 v236, s[16:19], s29 offen offset:0 lds
  v_mfma_f32_16x16x32_bf16 v[0:3], a[140:143], v[140:143], v[0:3]
  ds_read_b128 a[148:151], v213 offset:4096
  v_mfma_f32_16x16x32_bf16 v[8:11], a[140:143], v[156:159], v[196:199]
  v_mfma_f32_16x16x32_bf16 v[8:11], a[136:139], v[152:155], v[8:11]
  ds_read_b128 a[152:155], v214 offset:4096
  v_mfma_f32_16x16x32_bf16 v[8:11], a[132:135], v[148:151], v[8:11]
  buffer_load_dwordx4 v237, s[16:19], s29 offen offset:1024 lds
  v_mfma_f32_16x16x32_bf16 v[8:11], a[128:131], v[144:147], v[8:11]
  ds_read_b128 a[156:159], v215 offset:4096
  v_mfma_f32_16x16x32_bf16 v[16:19], a[128:131], v[160:163], v[200:203]
  v_exp_f32 v0, v0
  v_mfma_f32_16x16x32_bf16 v[16:19], a[132:135], v[164:167], v[16:19]
  v_mfma_f32_16x16x32_bf16 v[16:19], a[136:139], v[168:171], v[16:19]
  v_exp_f32 v1, v1
  v_mfma_f32_16x16x32_bf16 v[16:19], a[140:143], v[172:175], v[16:19]
  v_cvt_pk_bf16_f32 v0, v0, v1
  v_mfma_f32_16x16x32_bf16 v[24:27], a[140:143], v[188:191], v[204:207]
  v_exp_f32 v2, v2
  v_mfma_f32_16x16x32_bf16 v[24:27], a[136:139], v[184:187], v[24:27]
  buffer_load_dwordx4 v236, s[16:19], s29 offen offset:2048 lds
  v_mfma_f32_16x16x32_bf16 v[24:27], a[132:135], v[180:183], v[24:27]
  s_waitcnt lgkmcnt(0)
  v_exp_f32 v3, v3
  v_mfma_f32_16x16x32_bf16 v[24:27], a[128:131], v[176:179], v[24:27]
  v_cvt_pk_bf16_f32 v1, v2, v3
  v_mfma_f32_16x16x32_bf16 v[4:7], a[144:147], v[128:131], v[192:195]
  v_exp_f32 v8, v8
  v_mfma_f32_16x16x32_bf16 v[4:7], a[148:151], v[132:135], v[4:7]
  ds_read_b128 a[128:131], v212 offset:8192
  v_mfma_f32_16x16x32_bf16 v[4:7], a[152:155], v[136:139], v[4:7]
  v_exp_f32 v9, v9
  v_mfma_f32_16x16x32_bf16 v[4:7], a[156:159], v[140:143], v[4:7]
  ds_read_b128 a[132:135], v213 offset:8192
  v_cvt_pk_bf16_f32 v8, v8, v9
  v_mfma_f32_16x16x32_bf16 v[12:15], a[156:159], v[156:159], v[196:199]
  v_exp_f32 v10, v10
  v_mfma_f32_16x16x32_bf16 v[12:15], a[152:155], v[152:155], v[12:15]
  ds_read_b128 a[136:139], v214 offset:8192
  v_mfma_f32_16x16x32_bf16 v[12:15], a[148:151], v[148:151], v[12:15]
  v_exp_f32 v11, v11
  v_mfma_f32_16x16x32_bf16 v[12:15], a[144:147], v[144:147], v[12:15]
  ds_read_b128 a[140:143], v215 offset:8192
  v_cvt_pk_bf16_f32 v9, v10, v11
  v_mfma_f32_16x16x32_bf16 v[20:23], a[144:147], v[160:163], v[200:203]
  v_exp_f32 v16, v16
  v_mfma_f32_16x16x32_bf16 v[20:23], a[148:151], v[164:167], v[20:23]
  buffer_load_dwordx4 v237, s[16:19], s29 offen offset:3072 lds
  v_mfma_f32_16x16x32_bf16 v[20:23], a[152:155], v[168:171], v[20:23]
  s_add_u32 s29, s29, 16384
  v_exp_f32 v17, v17
  v_mfma_f32_16x16x32_bf16 v[20:23], a[156:159], v[172:175], v[20:23]
  v_cvt_pk_bf16_f32 v16, v16, v17
  v_mfma_f32_16x16x32_bf16 v[28:31], a[156:159], v[188:191], v[204:207]
  s_add_u32 m0, s28, 32768
  v_exp_f32 v18, v18
  v_mfma_f32_16x16x32_bf16 v[28:31], a[152:155], v[184:187], v[28:31]
  buffer_load_dwordx4 v232, s[12:15], s29 offen offset:0 lds
  v_mfma_f32_16x16x32_bf16 v[28:31], a[148:151], v[180:183], v[28:31]
  s_waitcnt lgkmcnt(0)
  v_exp_f32 v19, v19
  v_mfma_f32_16x16x32_bf16 v[28:31], a[144:147], v[176:179], v[28:31]
  v_cvt_pk_bf16_f32 v17, v18, v19
  v_mfma_f32_16x16x32_bf16 v[32:35], a[128:131], v[128:131], v[192:195]
  v_exp_f32 v24, v24
  v_mfma_f32_16x16x32_bf16 v[32:35], a[132:135], v[132:135], v[32:35]
  ds_read_b128 a[144:147], v212 offset:12288
  v_mfma_f32_16x16x32_bf16 v[32:35], a[136:139], v[136:139], v[32:35]
  v_exp_f32 v25, v25
  v_mfma_f32_16x16x32_bf16 v[32:35], a[140:143], v[140:143], v[32:35]
  ds_read_b128 a[148:151], v213 offset:12288
  v_cvt_pk_bf16_f32 v24, v24, v25
  v_mfma_f32_16x16x32_bf16 v[40:43], a[140:143], v[156:159], v[196:199]
  v_exp_f32 v26, v26
  v_mfma_f32_16x16x32_bf16 v[40:43], a[136:139], v[152:155], v[40:43]
  ds_read_b128 a[152:155], v214 offset:12288
  v_mfma_f32_16x16x32_bf16 v[40:43], a[132:135], v[148:151], v[40:43]
  v_exp_f32 v27, v27
  v_mfma_f32_16x16x32_bf16 v[40:43], a[128:131], v[144:147], v[40:43]
  ds_read_b128 a[156:159], v215 offset:12288
  v_cvt_pk_bf16_f32 v25, v26, v27
  v_mfma_f32_16x16x32_bf16 v[48:51], a[128:131], v[160:163], v[200:203]
  v_exp_f32 v4, v4
  v_mfma_f32_16x16x32_bf16 v[48:51], a[132:135], v[164:167], v[48:51]
  buffer_load_dwordx4 v233, s[12:15], s29 offen offset:1024 lds
  v_mfma_f32_16x16x32_bf16 v[48:51], a[136:139], v[168:171], v[48:51]
  v_exp_f32 v5, v5
  v_mfma_f32_16x16x32_bf16 v[48:51], a[140:143], v[172:175], v[48:51]
  v_cvt_pk_bf16_f32 v2, v4, v5
  v_mfma_f32_16x16x32_bf16 v[56:59], a[140:143], v[188:191], v[204:207]
  v_exp_f32 v6, v6
  v_mfma_f32_16x16x32_bf16 v[56:59], a[136:139], v[184:187], v[56:59]
  buffer_load_dwordx4 v234, s[12:15], s29 offen offset:2048 lds
  v_mfma_f32_16x16x32_bf16 v[56:59], a[132:135], v[180:183], v[56:59]
  s_waitcnt lgkmcnt(0)
  v_exp_f32 v7, v7
  v_mfma_f32_16x16x32_bf16 v[56:59], a[128:131], v[176:179], v[56:59]
  v_cvt_pk_bf16_f32 v3, v6, v7
  v_mfma_f32_16x16x32_bf16 v[36:39], a[144:147], v[128:131], v[192:195]
  v_exp_f32 v12, v12
  v_mfma_f32_16x16x32_bf16 v[36:39], a[148:151], v[132:135], v[36:39]
  ds_read_b64_tr_b16 a[160:161], v216 offset:49152
  v_mfma_f32_16x16x32_bf16 v[36:39], a[152:155], v[136:139], v[36:39]
  v_exp_f32 v13, v13
  v_mfma_f32_16x16x32_bf16 v[36:39], a[156:159], v[140:143], v[36:39]
  ds_read_b64_tr_b16 a[162:163], v216 offset:53248
  v_cvt_pk_bf16_f32 v10, v12, v13
  v_mfma_f32_16x16x32_bf16 v[44:47], a[156:159], v[156:159], v[196:199]
  v_exp_f32 v14, v14
  v_mfma_f32_16x16x32_bf16 v[44:47], a[152:155], v[152:155], v[44:47]
  ds_read_b64_tr_b16 a[164:165], v216 offset:57344
  buffer_load_dwordx4 v235, s[12:15], s29 offen offset:3072 lds
  v_mfma_f32_16x16x32_bf16 v[44:47], a[148:151], v[148:151], v[44:47]
  v_exp_f32 v15, v15
  v_mfma_f32_16x16x32_bf16 v[44:47], a[144:147], v[144:147], v[44:47]
  ds_read_b64_tr_b16 a[166:167], v216 offset:61440
  v_cvt_pk_bf16_f32 v11, v14, v15
  v_mfma_f32_16x16x32_bf16 v[52:55], a[144:147], v[160:163], v[200:203]
  v_exp_f32 v20, v20
  v_mfma_f32_16x16x32_bf16 v[52:55], a[148:151], v[164:167], v[52:55]
  ds_read_b64_tr_b16 a[168:169], v217 offset:49152
  s_add_u32 m0, s50, 2048
  v_mfma_f32_16x16x32_bf16 v[52:55], a[152:155], v[168:171], v[52:55]
  v_exp_f32 v21, v21
  v_mfma_f32_16x16x32_bf16 v[52:55], a[156:159], v[172:175], v[52:55]
  ds_read_b64_tr_b16 a[170:171], v217 offset:53248
  v_cvt_pk_bf16_f32 v18, v20, v21
  v_mfma_f32_16x16x32_bf16 v[60:63], a[156:159], v[188:191], v[204:207]
  v_exp_f32 v22, v22
  v_mfma_f32_16x16x32_bf16 v[60:63], a[152:155], v[184:187], v[60:63]
  ds_read_b64_tr_b16 a[172:173], v217 offset:57344
  buffer_load_dwordx4 v253, s[20:23], s35 offen lds
  v_mfma_f32_16x16x32_bf16 v[60:63], a[148:151], v[180:183], v[60:63]
  v_exp_f32 v23, v23
  v_mfma_f32_16x16x32_bf16 v[60:63], a[144:147], v[176:179], v[60:63]
  ds_read_b64_tr_b16 a[174:175], v217 offset:61440
  v_cvt_pk_bf16_f32 v19, v22, v23
  v_mfma_f32_16x16x32_bf16 a[192:195], a[208:211], v[64:67], a[192:195]
  v_exp_f32 v28, v28
  v_mfma_f32_16x16x32_bf16 a[192:195], a[208:211], v[96:99], a[192:195]
  ds_read_b64_tr_b16 a[176:177], v218 offset:49152
  v_mfma_f32_16x16x32_bf16 a[196:199], a[208:211], v[72:75], a[196:199]
  v_exp_f32 v29, v29
  v_mfma_f32_16x16x32_bf16 a[196:199], a[208:211], v[104:107], a[196:199]
  ds_read_b64_tr_b16 a[178:179], v218 offset:53248
  v_cvt_pk_bf16_f32 v26, v28, v29
  v_mfma_f32_16x16x32_bf16 a[200:203], a[208:211], v[80:83], a[200:203]
  v_exp_f32 v30, v30
  v_mfma_f32_16x16x32_bf16 a[200:203], a[208:211], v[112:115], a[200:203]
  ds_read_b64_tr_b16 a[180:181], v218 offset:57344
  v_mfma_f32_16x16x32_bf16 a[204:207], a[208:211], v[88:91], a[204:207]
  s_waitcnt lgkmcnt(7)
  v_exp_f32 v31, v31
  v_mfma_f32_16x16x32_bf16 a[204:207], a[208:211], v[120:123], a[204:207]
  ds_read_b64_tr_b16 a[182:183], v218 offset:61440
  v_cvt_pk_bf16_f32 v27, v30, v31
  v_mfma_f32_16x16x32_bf16 a[0:3], a[160:163], v[64:67], a[0:3]
  v_exp_f32 v32, v32
  v_mfma_f32_16x16x32_bf16 a[0:3], a[164:167], v[96:99], a[0:3]
  ds_read_b64_tr_b16 a[184:185], v219 offset:49152
  v_mfma_f32_16x16x32_bf16 a[4:7], a[164:167], v[104:107], a[4:7]
  v_exp_f32 v33, v33
  v_mfma_f32_16x16x32_bf16 a[4:7], a[160:163], v[72:75], a[4:7]
  ds_read_b64_tr_b16 a[186:187], v219 offset:53248
  v_cvt_pk_bf16_f32 v32, v32, v33
  v_mfma_f32_16x16x32_bf16 a[8:11], a[160:163], v[80:83], a[8:11]
  v_exp_f32 v34, v34
  v_mfma_f32_16x16x32_bf16 a[8:11], a[164:167], v[112:115], a[8:11]
  ds_read_b64_tr_b16 a[188:189], v219 offset:57344
  v_mfma_f32_16x16x32_bf16 a[12:15], a[164:167], v[120:123], a[12:15]
  s_waitcnt lgkmcnt(7)
  v_exp_f32 v35, v35
  v_mfma_f32_16x16x32_bf16 a[12:15], a[160:163], v[88:91], a[12:15]
  ds_read_b64_tr_b16 a[190:191], v219 offset:61440
  v_cvt_pk_bf16_f32 v33, v34, v35
  v_mfma_f32_16x16x32_bf16 a[16:19], a[168:171], v[64:67], a[16:19]
  v_exp_f32 v40, v40
  v_mfma_f32_16x16x32_bf16 a[16:19], a[172:175], v[96:99], a[16:19]
  ds_read_b64_tr_b16 a[160:161], v220 offset:49152
  v_mfma_f32_16x16x32_bf16 a[20:23], a[172:175], v[104:107], a[20:23]
  v_exp_f32 v41, v41
  v_mfma_f32_16x16x32_bf16 a[20:23], a[168:171], v[72:75], a[20:23]
  ds_read_b64_tr_b16 a[162:163], v220 offset:53248
  v_cvt_pk_bf16_f32 v40, v40, v41
  v_mfma_f32_16x16x32_bf16 a[24:27], a[168:171], v[80:83], a[24:27]
  v_exp_f32 v42, v42
  v_mfma_f32_16x16x32_bf16 a[24:27], a[172:175], v[112:115], a[24:27]
  ds_read_b64_tr_b16 a[164:165], v220 offset:57344
  v_mfma_f32_16x16x32_bf16 a[28:31], a[172:175], v[120:123], a[28:31]
  s_waitcnt lgkmcnt(7)
  v_exp_f32 v43, v43
  v_mfma_f32_16x16x32_bf16 a[28:31], a[168:171], v[88:91], a[28:31]
  ds_read_b64_tr_b16 a[166:167], v220 offset:61440
  v_cvt_pk_bf16_f32 v41, v42, v43
  v_mfma_f32_16x16x32_bf16 a[32:35], a[176:179], v[64:67], a[32:35]
  v_exp_f32 v48, v48
  v_mfma_f32_16x16x32_bf16 a[32:35], a[180:183], v[96:99], a[32:35]
  ds_read_b64_tr_b16 a[168:169], v221 offset:49152
  v_mfma_f32_16x16x32_bf16 a[36:39], a[180:183], v[104:107], a[36:39]
  v_exp_f32 v49, v49
  v_mfma_f32_16x16x32_bf16 a[36:39], a[176:179], v[72:75], a[36:39]
  ds_read_b64_tr_b16 a[170:171], v221 offset:53248
  v_cvt_pk_bf16_f32 v48, v48, v49
  v_mfma_f32_16x16x32_bf16 a[40:43], a[176:179], v[80:83], a[40:43]
  v_exp_f32 v50, v50
  v_mfma_f32_16x16x32_bf16 a[40:43], a[180:183], v[112:115], a[40:43]
  ds_read_b64_tr_b16 a[172:173], v221 offset:57344
  v_mfma_f32_16x16x32_bf16 a[44:47], a[180:183], v[120:123], a[44:47]
  s_waitcnt lgkmcnt(7)
  v_exp_f32 v51, v51
  v_mfma_f32_16x16x32_bf16 a[44:47], a[176:179], v[88:91], a[44:47]
  ds_read_b64_tr_b16 a[174:175], v221 offset:61440
  v_cvt_pk_bf16_f32 v49, v50, v51
  v_mfma_f32_16x16x32_bf16 a[48:51], a[184:187], v[64:67], a[48:51]
  v_exp_f32 v56, v56
  v_mfma_f32_16x16x32_bf16 a[48:51], a[188:191], v[96:99], a[48:51]
  ds_read_b64_tr_b16 a[176:177], v222 offset:49152
  v_mfma_f32_16x16x32_bf16 a[52:55], a[188:191], v[104:107], a[52:55]
  v_exp_f32 v57, v57
  v_mfma_f32_16x16x32_bf16 a[52:55], a[184:187], v[72:75], a[52:55]
  ds_read_b64_tr_b16 a[178:179], v222 offset:53248
  v_cvt_pk_bf16_f32 v56, v56, v57
  v_mfma_f32_16x16x32_bf16 a[56:59], a[184:187], v[80:83], a[56:59]
  v_exp_f32 v58, v58
  v_mfma_f32_16x16x32_bf16 a[56:59], a[188:191], v[112:115], a[56:59]
  ds_read_b64_tr_b16 a[180:181], v222 offset:57344
  v_mfma_f32_16x16x32_bf16 a[60:63], a[188:191], v[120:123], a[60:63]
  s_waitcnt lgkmcnt(7)
  v_exp_f32 v59, v59
  v_mfma_f32_16x16x32_bf16 a[60:63], a[184:187], v[88:91], a[60:63]
  ds_read_b64_tr_b16 a[182:183], v222 offset:61440
  v_cvt_pk_bf16_f32 v57, v58, v59
  v_mfma_f32_16x16x32_bf16 a[64:67], a[160:163], v[64:67], a[64:67]
  v_exp_f32 v36, v36
  v_mfma_f32_16x16x32_bf16 a[64:67], a[164:167], v[96:99], a[64:67]
  ds_read_b64_tr_b16 a[184:185], v223 offset:49152
  v_mfma_f32_16x16x32_bf16 a[68:71], a[164:167], v[104:107], a[68:71]
  v_exp_f32 v37, v37
  v_mfma_f32_16x16x32_bf16 a[68:71], a[160:163], v[72:75], a[68:71]
  ds_read_b64_tr_b16 a[186:187], v223 offset:53248
  v_cvt_pk_bf16_f32 v34, v36, v37
  v_mfma_f32_16x16x32_bf16 a[72:75], a[160:163], v[80:83], a[72:75]
  v_exp_f32 v38, v38
  v_mfma_f32_16x16x32_bf16 a[72:75], a[164:167], v[112:115], a[72:75]
  ds_read_b64_tr_b16 a[188:189], v223 offset:57344
  v_mfma_f32_16x16x32_bf16 a[76:79], a[164:167], v[120:123], a[76:79]
  s_waitcnt lgkmcnt(7)
  v_exp_f32 v39, v39
  v_mfma_f32_16x16x32_bf16 a[76:79], a[160:163], v[88:91], a[76:79]
  ds_read_b64_tr_b16 a[190:191], v223 offset:61440
  v_cvt_pk_bf16_f32 v35, v38, v39
  v_mfma_f32_16x16x32_bf16 a[80:83], a[168:171], v[64:67], a[80:83]
  s_waitcnt vmcnt(11)
  v_exp_f32 v44, v44
  v_mfma_f32_16x16x32_bf16 a[80:83], a[172:175], v[96:99], a[80:83]
  v_mfma_f32_16x16x32_bf16 a[84:87], a[172:175], v[104:107], a[84:87]
  s_barrier
  v_exp_f32 v45, v45
  v_mfma_f32_16x16x32_bf16 a[84:87], a[168:171], v[72:75], a[84:87]
  ds_read_b128 a[128:131], v212 offset:16384
  v_cvt_pk_bf16_f32 v42, v44, v45
  v_mfma_f32_16x16x32_bf16 a[88:91], a[168:171], v[80:83], a[88:91]
  v_exp_f32 v46, v46
  v_mfma_f32_16x16x32_bf16 a[88:91], a[172:175], v[112:115], a[88:91]
  ds_read_b128 a[132:135], v213 offset:16384
  v_mfma_f32_16x16x32_bf16 a[92:95], a[172:175], v[120:123], a[92:95]
  s_waitcnt lgkmcnt(6)
  v_exp_f32 v47, v47
  v_mfma_f32_16x16x32_bf16 a[92:95], a[168:171], v[88:91], a[92:95]
  ds_read_b128 a[136:139], v214 offset:16384
  v_cvt_pk_bf16_f32 v43, v46, v47
  v_mfma_f32_16x16x32_bf16 a[96:99], a[176:179], v[64:67], a[96:99]
  v_exp_f32 v52, v52
  v_mfma_f32_16x16x32_bf16 a[96:99], a[180:183], v[96:99], a[96:99]
  ds_read_b128 a[140:143], v215 offset:16384
  buffer_load_dwordx4 a[224:227], v243, s[24:27], s38 offen sc1
  s_add_u32 s38, s38, 4096
  v_mfma_f32_16x16x32_bf16 a[100:103], a[180:183], v[104:107], a[100:103]
  v_exp_f32 v53, v53
  v_mfma_f32_16x16x32_bf16 a[100:103], a[176:179], v[72:75], a[100:103]
  v_cvt_pk_bf16_f32 v50, v52, v53
  v_mfma_f32_16x16x32_bf16 a[104:107], a[176:179], v[80:83], a[104:107]
  v_exp_f32 v54, v54
  v_mfma_f32_16x16x32_bf16 a[104:107], a[180:183], v[112:115], a[104:107]
  v_mfma_f32_16x16x32_bf16 a[108:111], a[180:183], v[120:123], a[108:111]
  s_waitcnt lgkmcnt(4)
  v_exp_f32 v55, v55
  v_mfma_f32_16x16x32_bf16 a[108:111], a[176:179], v[88:91], a[108:111]
  v_cvt_pk_bf16_f32 v51, v54, v55
  v_mfma_f32_16x16x32_bf16 a[112:115], a[184:187], v[64:67], a[112:115]
  v_exp_f32 v60, v60
  v_mfma_f32_16x16x32_bf16 a[112:115], a[188:191], v[96:99], a[112:115]
  v_mfma_f32_16x16x32_bf16 a[116:119], a[188:191], v[104:107], a[116:119]
  v_exp_f32 v61, v61
  v_mfma_f32_16x16x32_bf16 a[116:119], a[184:187], v[72:75], a[116:119]
  v_cvt_pk_bf16_f32 v58, v60, v61
  v_mfma_f32_16x16x32_bf16 a[120:123], a[184:187], v[80:83], a[120:123]
  v_exp_f32 v62, v62
  v_mfma_f32_16x16x32_bf16 a[120:123], a[188:191], v[112:115], a[120:123]
  v_mfma_f32_16x16x32_bf16 a[124:127], a[188:191], v[120:123], a[124:127]
  s_waitcnt lgkmcnt(0)
  v_exp_f32 v63, v63
  v_mfma_f32_16x16x32_bf16 a[124:127], a[184:187], v[88:91], a[124:127]
  v_cvt_pk_bf16_f32 v59, v62, v63
  v_mfma_f32_16x16x32_bf16 v[64:67], a[128:131], v[128:131], v[192:195]
  s_add_u32 m0, s28, 98304
  v_mfma_f32_16x16x32_bf16 v[64:67], a[132:135], v[132:135], v[64:67]
  ds_read_b128 a[144:147], v212 offset:20480
  v_mfma_f32_16x16x32_bf16 v[64:67], a[136:139], v[136:139], v[64:67]
  buffer_load_dwordx4 v236, s[16:19], s29 offen offset:0 lds
  v_mfma_f32_16x16x32_bf16 v[64:67], a[140:143], v[140:143], v[64:67]
  ds_read_b128 a[148:151], v213 offset:20480
  v_mfma_f32_16x16x32_bf16 v[72:75], a[140:143], v[156:159], v[196:199]
  v_mfma_f32_16x16x32_bf16 v[72:75], a[136:139], v[152:155], v[72:75]
  ds_read_b128 a[152:155], v214 offset:20480
  v_mfma_f32_16x16x32_bf16 v[72:75], a[132:135], v[148:151], v[72:75]
  buffer_load_dwordx4 v237, s[16:19], s29 offen offset:1024 lds
  v_mfma_f32_16x16x32_bf16 v[72:75], a[128:131], v[144:147], v[72:75]
  ds_read_b128 a[156:159], v215 offset:20480
  v_mfma_f32_16x16x32_bf16 v[80:83], a[128:131], v[160:163], v[200:203]
  v_exp_f32 v64, v64
  v_mfma_f32_16x16x32_bf16 v[80:83], a[132:135], v[164:167], v[80:83]
  v_mfma_f32_16x16x32_bf16 v[80:83], a[136:139], v[168:171], v[80:83]
  v_exp_f32 v65, v65
  v_mfma_f32_16x16x32_bf16 v[80:83], a[140:143], v[172:175], v[80:83]
  v_cvt_pk_bf16_f32 v64, v64, v65
  v_mfma_f32_16x16x32_bf16 v[88:91], a[140:143], v[188:191], v[204:207]
  v_exp_f32 v66, v66
  v_mfma_f32_16x16x32_bf16 v[88:91], a[136:139], v[184:187], v[88:91]
  buffer_load_dwordx4 v236, s[16:19], s29 offen offset:2048 lds
  v_mfma_f32_16x16x32_bf16 v[88:91], a[132:135], v[180:183], v[88:91]
  s_waitcnt lgkmcnt(0)
  v_exp_f32 v67, v67
  v_mfma_f32_16x16x32_bf16 v[88:91], a[128:131], v[176:179], v[88:91]
  v_cvt_pk_bf16_f32 v65, v66, v67
  v_mfma_f32_16x16x32_bf16 v[68:71], a[144:147], v[128:131], v[192:195]
  v_exp_f32 v72, v72
  v_mfma_f32_16x16x32_bf16 v[68:71], a[148:151], v[132:135], v[68:71]
  ds_read_b128 a[128:131], v212 offset:24576
  v_mfma_f32_16x16x32_bf16 v[68:71], a[152:155], v[136:139], v[68:71]
  v_exp_f32 v73, v73
  v_mfma_f32_16x16x32_bf16 v[68:71], a[156:159], v[140:143], v[68:71]
  ds_read_b128 a[132:135], v213 offset:24576
  v_cvt_pk_bf16_f32 v72, v72, v73
  v_mfma_f32_16x16x32_bf16 v[76:79], a[156:159], v[156:159], v[196:199]
  v_exp_f32 v74, v74
  v_mfma_f32_16x16x32_bf16 v[76:79], a[152:155], v[152:155], v[76:79]
  ds_read_b128 a[136:139], v214 offset:24576
  v_mfma_f32_16x16x32_bf16 v[76:79], a[148:151], v[148:151], v[76:79]
  v_exp_f32 v75, v75
  v_mfma_f32_16x16x32_bf16 v[76:79], a[144:147], v[144:147], v[76:79]
  ds_read_b128 a[140:143], v215 offset:24576
  v_cvt_pk_bf16_f32 v73, v74, v75
  v_mfma_f32_16x16x32_bf16 v[84:87], a[144:147], v[160:163], v[200:203]
  v_exp_f32 v80, v80
  v_mfma_f32_16x16x32_bf16 v[84:87], a[148:151], v[164:167], v[84:87]
  buffer_load_dwordx4 v237, s[16:19], s29 offen offset:3072 lds
  v_mfma_f32_16x16x32_bf16 v[84:87], a[152:155], v[168:171], v[84:87]
  s_add_u32 s29, s29, 16384
  v_exp_f32 v81, v81
  v_mfma_f32_16x16x32_bf16 v[84:87], a[156:159], v[172:175], v[84:87]
  v_cvt_pk_bf16_f32 v80, v80, v81
  v_mfma_f32_16x16x32_bf16 v[92:95], a[156:159], v[188:191], v[204:207]
  s_add_u32 m0, s28, 49152
  v_exp_f32 v82, v82
  v_mfma_f32_16x16x32_bf16 v[92:95], a[152:155], v[184:187], v[92:95]
  buffer_load_dwordx4 v232, s[12:15], s29 offen offset:0 lds
  v_mfma_f32_16x16x32_bf16 v[92:95], a[148:151], v[180:183], v[92:95]
  s_waitcnt lgkmcnt(0)
  v_exp_f32 v83, v83
  v_mfma_f32_16x16x32_bf16 v[92:95], a[144:147], v[176:179], v[92:95]
  v_cvt_pk_bf16_f32 v81, v82, v83
  v_mfma_f32_16x16x32_bf16 v[96:99], a[128:131], v[128:131], v[192:195]
  v_exp_f32 v88, v88
  v_mfma_f32_16x16x32_bf16 v[96:99], a[132:135], v[132:135], v[96:99]
  ds_read_b128 a[144:147], v212 offset:28672
  v_mfma_f32_16x16x32_bf16 v[96:99], a[136:139], v[136:139], v[96:99]
  v_exp_f32 v89, v89
  v_mfma_f32_16x16x32_bf16 v[96:99], a[140:143], v[140:143], v[96:99]
  ds_read_b128 a[148:151], v213 offset:28672
  v_cvt_pk_bf16_f32 v88, v88, v89
  v_mfma_f32_16x16x32_bf16 v[104:107], a[140:143], v[156:159], v[196:199]
  v_exp_f32 v90, v90
  v_mfma_f32_16x16x32_bf16 v[104:107], a[136:139], v[152:155], v[104:107]
  ds_read_b128 a[152:155], v214 offset:28672
  v_mfma_f32_16x16x32_bf16 v[104:107], a[132:135], v[148:151], v[104:107]
  v_exp_f32 v91, v91
  v_mfma_f32_16x16x32_bf16 v[104:107], a[128:131], v[144:147], v[104:107]
  ds_read_b128 a[156:159], v215 offset:28672
  v_cvt_pk_bf16_f32 v89, v90, v91
  v_mfma_f32_16x16x32_bf16 v[112:115], a[128:131], v[160:163], v[200:203]
  v_exp_f32 v68, v68
  v_mfma_f32_16x16x32_bf16 v[112:115], a[132:135], v[164:167], v[112:115]
  buffer_load_dwordx4 v233, s[12:15], s29 offen offset:1024 lds
  v_mfma_f32_16x16x32_bf16 v[112:115], a[136:139], v[168:171], v[112:115]
  v_exp_f32 v69, v69
  v_mfma_f32_16x16x32_bf16 v[112:115], a[140:143], v[172:175], v[112:115]
  v_cvt_pk_bf16_f32 v66, v68, v69
  v_mfma_f32_16x16x32_bf16 v[120:123], a[140:143], v[188:191], v[204:207]
  v_exp_f32 v70, v70
  v_mfma_f32_16x16x32_bf16 v[120:123], a[136:139], v[184:187], v[120:123]
  buffer_load_dwordx4 v234, s[12:15], s29 offen offset:2048 lds
  v_mfma_f32_16x16x32_bf16 v[120:123], a[132:135], v[180:183], v[120:123]
  s_waitcnt lgkmcnt(0)
  v_exp_f32 v71, v71
  v_mfma_f32_16x16x32_bf16 v[120:123], a[128:131], v[176:179], v[120:123]
  v_cvt_pk_bf16_f32 v67, v70, v71
  v_mfma_f32_16x16x32_bf16 v[100:103], a[144:147], v[128:131], v[192:195]
  v_exp_f32 v76, v76
  v_mfma_f32_16x16x32_bf16 v[100:103], a[148:151], v[132:135], v[100:103]
  ds_read_b64_tr_b16 a[160:161], v216 offset:0
  v_mfma_f32_16x16x32_bf16 v[100:103], a[152:155], v[136:139], v[100:103]
  v_exp_f32 v77, v77
  v_mfma_f32_16x16x32_bf16 v[100:103], a[156:159], v[140:143], v[100:103]
  ds_read_b64_tr_b16 a[162:163], v216 offset:4096
  v_cvt_pk_bf16_f32 v74, v76, v77
  v_mfma_f32_16x16x32_bf16 v[108:111], a[156:159], v[156:159], v[196:199]
  v_exp_f32 v78, v78
  v_mfma_f32_16x16x32_bf16 v[108:111], a[152:155], v[152:155], v[108:111]
  ds_read_b64_tr_b16 a[164:165], v216 offset:8192
  buffer_load_dwordx4 v235, s[12:15], s29 offen offset:3072 lds
  v_mfma_f32_16x16x32_bf16 v[108:111], a[148:151], v[148:151], v[108:111]
  v_exp_f32 v79, v79
  v_mfma_f32_16x16x32_bf16 v[108:111], a[144:147], v[144:147], v[108:111]
  ds_read_b64_tr_b16 a[166:167], v216 offset:12288
  v_cvt_pk_bf16_f32 v75, v78, v79
  v_mfma_f32_16x16x32_bf16 v[116:119], a[144:147], v[160:163], v[200:203]
  v_exp_f32 v84, v84
  v_mfma_f32_16x16x32_bf16 v[116:119], a[148:151], v[164:167], v[116:119]
  ds_read_b64_tr_b16 a[168:169], v217 offset:0
  s_add_u32 m0, s50, 5120
  v_mfma_f32_16x16x32_bf16 v[116:119], a[152:155], v[168:171], v[116:119]
  v_exp_f32 v85, v85
  v_mfma_f32_16x16x32_bf16 v[116:119], a[156:159], v[172:175], v[116:119]
  ds_read_b64_tr_b16 a[170:171], v217 offset:4096
  v_cvt_pk_bf16_f32 v82, v84, v85
  v_mfma_f32_16x16x32_bf16 v[124:127], a[156:159], v[188:191], v[204:207]
  v_exp_f32 v86, v86
  v_mfma_f32_16x16x32_bf16 v[124:127], a[152:155], v[184:187], v[124:127]
  ds_read_b64_tr_b16 a[172:173], v217 offset:8192
  buffer_load_dwordx4 v253, s[44:47], s35 offen lds
  s_add_u32 s35, s35, 221184
  v_mfma_f32_16x16x32_bf16 v[124:127], a[148:151], v[180:183], v[124:127]
  v_exp_f32 v87, v87
  v_mfma_f32_16x16x32_bf16 v[124:127], a[144:147], v[176:179], v[124:127]
  ds_read_b64_tr_b16 a[174:175], v217 offset:12288
  v_cvt_pk_bf16_f32 v83, v86, v87
  v_mfma_f32_16x16x32_bf16 a[192:195], a[208:211], v[0:3], a[192:195]
  v_exp_f32 v92, v92
  v_mfma_f32_16x16x32_bf16 a[192:195], a[208:211], v[32:35], a[192:195]
  ds_read_b64_tr_b16 a[176:177], v218 offset:0
  v_mfma_f32_16x16x32_bf16 a[196:199], a[208:211], v[8:11], a[196:199]
  v_exp_f32 v93, v93
  v_mfma_f32_16x16x32_bf16 a[196:199], a[208:211], v[40:43], a[196:199]
  ds_read_b64_tr_b16 a[178:179], v218 offset:4096
  v_cvt_pk_bf16_f32 v90, v92, v93
  v_mfma_f32_16x16x32_bf16 a[200:203], a[208:211], v[16:19], a[200:203]
  v_exp_f32 v94, v94
  v_mfma_f32_16x16x32_bf16 a[200:203], a[208:211], v[48:51], a[200:203]
  ds_read_b64_tr_b16 a[180:181], v218 offset:8192
  v_mfma_f32_16x16x32_bf16 a[204:207], a[208:211], v[24:27], a[204:207]
  s_waitcnt lgkmcnt(7)
  v_exp_f32 v95, v95
  v_mfma_f32_16x16x32_bf16 a[204:207], a[208:211], v[56:59], a[204:207]
  ds_read_b64_tr_b16 a[182:183], v218 offset:12288
  v_cvt_pk_bf16_f32 v91, v94, v95
  v_mfma_f32_16x16x32_bf16 a[0:3], a[160:163], v[0:3], a[0:3]
  v_exp_f32 v96, v96
  v_mfma_f32_16x16x32_bf16 a[0:3], a[164:167], v[32:35], a[0:3]
  ds_read_b64_tr_b16 a[184:185], v219 offset:0
  v_mfma_f32_16x16x32_bf16 a[4:7], a[164:167], v[40:43], a[4:7]
  v_exp_f32 v97, v97
  v_mfma_f32_16x16x32_bf16 a[4:7], a[160:163], v[8:11], a[4:7]
  ds_read_b64_tr_b16 a[186:187], v219 offset:4096
  v_cvt_pk_bf16_f32 v96, v96, v97
  v_mfma_f32_16x16x32_bf16 a[8:11], a[160:163], v[16:19], a[8:11]
  v_exp_f32 v98, v98
  v_mfma_f32_16x16x32_bf16 a[8:11], a[164:167], v[48:51], a[8:11]
  ds_read_b64_tr_b16 a[188:189], v219 offset:8192
  v_mfma_f32_16x16x32_bf16 a[12:15], a[164:167], v[56:59], a[12:15]
  s_waitcnt lgkmcnt(7)
  v_exp_f32 v99, v99
  v_mfma_f32_16x16x32_bf16 a[12:15], a[160:163], v[24:27], a[12:15]
  ds_read_b64_tr_b16 a[190:191], v219 offset:12288
  v_cvt_pk_bf16_f32 v97, v98, v99
  v_mfma_f32_16x16x32_bf16 a[16:19], a[168:171], v[0:3], a[16:19]
  v_exp_f32 v104, v104
  v_mfma_f32_16x16x32_bf16 a[16:19], a[172:175], v[32:35], a[16:19]
  ds_read_b64_tr_b16 a[160:161], v220 offset:0
  v_mfma_f32_16x16x32_bf16 a[20:23], a[172:175], v[40:43], a[20:23]
  v_exp_f32 v105, v105
  v_mfma_f32_16x16x32_bf16 a[20:23], a[168:171], v[8:11], a[20:23]
  ds_read_b64_tr_b16 a[162:163], v220 offset:4096
  v_cvt_pk_bf16_f32 v104, v104, v105
  v_mfma_f32_16x16x32_bf16 a[24:27], a[168:171], v[16:19], a[24:27]
  v_exp_f32 v106, v106
  v_mfma_f32_16x16x32_bf16 a[24:27], a[172:175], v[48:51], a[24:27]
  ds_read_b64_tr_b16 a[164:165], v220 offset:8192
  v_mfma_f32_16x16x32_bf16 a[28:31], a[172:175], v[56:59], a[28:31]
  s_waitcnt lgkmcnt(7)
  v_exp_f32 v107, v107
  v_mfma_f32_16x16x32_bf16 a[28:31], a[168:171], v[24:27], a[28:31]
  ds_read_b64_tr_b16 a[166:167], v220 offset:12288
  v_cvt_pk_bf16_f32 v105, v106, v107
  v_mfma_f32_16x16x32_bf16 a[32:35], a[176:179], v[0:3], a[32:35]
  v_exp_f32 v112, v112
  v_mfma_f32_16x16x32_bf16 a[32:35], a[180:183], v[32:35], a[32:35]
  ds_read_b64_tr_b16 a[168:169], v221 offset:0
  v_mfma_f32_16x16x32_bf16 a[36:39], a[180:183], v[40:43], a[36:39]
  v_exp_f32 v113, v113
  v_mfma_f32_16x16x32_bf16 a[36:39], a[176:179], v[8:11], a[36:39]
  ds_read_b64_tr_b16 a[170:171], v221 offset:4096
  v_cvt_pk_bf16_f32 v112, v112, v113
  v_mfma_f32_16x16x32_bf16 a[40:43], a[176:179], v[16:19], a[40:43]
  v_exp_f32 v114, v114
  v_mfma_f32_16x16x32_bf16 a[40:43], a[180:183], v[48:51], a[40:43]
  ds_read_b64_tr_b16 a[172:173], v221 offset:8192
  v_mfma_f32_16x16x32_bf16 a[44:47], a[180:183], v[56:59], a[44:47]
  s_waitcnt lgkmcnt(7)
  v_exp_f32 v115, v115
  v_mfma_f32_16x16x32_bf16 a[44:47], a[176:179], v[24:27], a[44:47]
  ds_read_b64_tr_b16 a[174:175], v221 offset:12288
  v_cvt_pk_bf16_f32 v113, v114, v115
  v_mfma_f32_16x16x32_bf16 a[48:51], a[184:187], v[0:3], a[48:51]
  v_exp_f32 v120, v120
  v_mfma_f32_16x16x32_bf16 a[48:51], a[188:191], v[32:35], a[48:51]
  ds_read_b64_tr_b16 a[176:177], v222 offset:0
  v_mfma_f32_16x16x32_bf16 a[52:55], a[188:191], v[40:43], a[52:55]
  v_exp_f32 v121, v121
  v_mfma_f32_16x16x32_bf16 a[52:55], a[184:187], v[8:11], a[52:55]
  ds_read_b64_tr_b16 a[178:179], v222 offset:4096
  v_cvt_pk_bf16_f32 v120, v120, v121
  v_mfma_f32_16x16x32_bf16 a[56:59], a[184:187], v[16:19], a[56:59]
  v_exp_f32 v122, v122
  v_mfma_f32_16x16x32_bf16 a[56:59], a[188:191], v[48:51], a[56:59]
  ds_read_b64_tr_b16 a[180:181], v222 offset:8192
  v_mfma_f32_16x16x32_bf16 a[60:63], a[188:191], v[56:59], a[60:63]
  s_waitcnt lgkmcnt(7)
  v_exp_f32 v123, v123
  v_mfma_f32_16x16x32_bf16 a[60:63], a[184:187], v[24:27], a[60:63]
  ds_read_b64_tr_b16 a[182:183], v222 offset:12288
  v_cvt_pk_bf16_f32 v121, v122, v123
  v_mfma_f32_16x16x32_bf16 a[64:67], a[160:163], v[0:3], a[64:67]
  v_exp_f32 v100, v100
  v_mfma_f32_16x16x32_bf16 a[64:67], a[164:167], v[32:35], a[64:67]
  ds_read_b64_tr_b16 a[184:185], v223 offset:0
  v_mfma_f32_16x16x32_bf16 a[68:71], a[164:167], v[40:43], a[68:71]
  v_exp_f32 v101, v101
  v_mfma_f32_16x16x32_bf16 a[68:71], a[160:163], v[8:11], a[68:71]
  ds_read_b64_tr_b16 a[186:187], v223 offset:4096
  v_cvt_pk_bf16_f32 v98, v100, v101
  v_mfma_f32_16x16x32_bf16 a[72:75], a[160:163], v[16:19], a[72:75]
  v_exp_f32 v102, v102
  v_mfma_f32_16x16x32_bf16 a[72:75], a[164:167], v[48:51], a[72:75]
  ds_read_b64_tr_b16 a[188:189], v223 offset:8192
  v_mfma_f32_16x16x32_bf16 a[76:79], a[164:167], v[56:59], a[76:79]
  s_waitcnt lgkmcnt(7)
  v_exp_f32 v103, v103
  v_mfma_f32_16x16x32_bf16 a[76:79], a[160:163], v[24:27], a[76:79]
  ds_read_b64_tr_b16 a[190:191], v223 offset:12288
  v_cvt_pk_bf16_f32 v99, v102, v103
  v_mfma_f32_16x16x32_bf16 a[80:83], a[168:171], v[0:3], a[80:83]
  s_waitcnt vmcnt(11)
  v_exp_f32 v108, v108
  v_mfma_f32_16x16x32_bf16 a[80:83], a[172:175], v[32:35], a[80:83]
  v_mfma_f32_16x16x32_bf16 a[84:87], a[172:175], v[40:43], a[84:87]
  s_barrier
  v_exp_f32 v109, v109
  v_mfma_f32_16x16x32_bf16 a[84:87], a[168:171], v[8:11], a[84:87]
  ds_read_b128 a[128:131], v212 offset:32768
  v_cvt_pk_bf16_f32 v106, v108, v109
  v_mfma_f32_16x16x32_bf16 a[88:91], a[168:171], v[16:19], a[88:91]
  v_exp_f32 v110, v110
  v_mfma_f32_16x16x32_bf16 a[88:91], a[172:175], v[48:51], a[88:91]
  ds_read_b128 a[132:135], v213 offset:32768
  v_mfma_f32_16x16x32_bf16 a[92:95], a[172:175], v[56:59], a[92:95]
  s_waitcnt lgkmcnt(6)
  v_exp_f32 v111, v111
  v_mfma_f32_16x16x32_bf16 a[92:95], a[168:171], v[24:27], a[92:95]
  ds_read_b128 a[136:139], v214 offset:32768
  v_cvt_pk_bf16_f32 v107, v110, v111
  v_mfma_f32_16x16x32_bf16 a[96:99], a[176:179], v[0:3], a[96:99]
  v_exp_f32 v116, v116
  v_mfma_f32_16x16x32_bf16 a[96:99], a[180:183], v[32:35], a[96:99]
  ds_read_b128 a[140:143], v215 offset:32768
  buffer_load_dwordx4 a[228:231], v243, s[24:27], s38 offen sc1
  s_add_u32 s38, s38, 4096
  v_mfma_f32_16x16x32_bf16 a[100:103], a[180:183], v[40:43], a[100:103]
  v_exp_f32 v117, v117
  v_mfma_f32_16x16x32_bf16 a[100:103], a[176:179], v[8:11], a[100:103]
  v_cvt_pk_bf16_f32 v114, v116, v117
  v_mfma_f32_16x16x32_bf16 a[104:107], a[176:179], v[16:19], a[104:107]
  v_exp_f32 v118, v118
  v_mfma_f32_16x16x32_bf16 a[104:107], a[180:183], v[48:51], a[104:107]
  v_mfma_f32_16x16x32_bf16 a[108:111], a[180:183], v[56:59], a[108:111]
  s_waitcnt lgkmcnt(4)
  v_exp_f32 v119, v119
  v_mfma_f32_16x16x32_bf16 a[108:111], a[176:179], v[24:27], a[108:111]
  v_cvt_pk_bf16_f32 v115, v118, v119
  v_mfma_f32_16x16x32_bf16 a[112:115], a[184:187], v[0:3], a[112:115]
  v_exp_f32 v124, v124
  v_mfma_f32_16x16x32_bf16 a[112:115], a[188:191], v[32:35], a[112:115]
  v_mfma_f32_16x16x32_bf16 a[116:119], a[188:191], v[40:43], a[116:119]
  v_exp_f32 v125, v125
  v_mfma_f32_16x16x32_bf16 a[116:119], a[184:187], v[8:11], a[116:119]
  v_cvt_pk_bf16_f32 v122, v124, v125
  v_mfma_f32_16x16x32_bf16 a[120:123], a[184:187], v[16:19], a[120:123]
  v_exp_f32 v126, v126
  v_mfma_f32_16x16x32_bf16 a[120:123], a[188:191], v[48:51], a[120:123]
  v_mfma_f32_16x16x32_bf16 a[124:127], a[188:191], v[56:59], a[124:127]
  s_waitcnt lgkmcnt(0)
  v_exp_f32 v127, v127
  v_mfma_f32_16x16x32_bf16 a[124:127], a[184:187], v[24:27], a[124:127]
  v_cvt_pk_bf16_f32 v123, v126, v127
  v_mfma_f32_16x16x32_bf16 v[0:3], a[128:131], v[128:131], v[192:195]
  s_add_u32 m0, s28, 114688
  s_mov_b32 s20, s88
  s_mov_b32 s21, s89
  v_mfma_f32_16x16x32_bf16 v[0:3], a[132:135], v[132:135], v[0:3]
  ds_read_b128 a[144:147], v212 offset:36864
  s_mov_b32 s22, 5242880
  s_mov_b32 s23, 0x20000
  v_lshrrev_b32 v208, 4, v242
  v_mfma_f32_16x16x32_bf16 v[0:3], a[136:139], v[136:139], v[0:3]
  buffer_load_dwordx4 v236, s[16:19], s29 offen offset:0 lds
  v_mfma_f32_16x16x32_bf16 v[0:3], a[140:143], v[140:143], v[0:3]
  ds_read_b128 a[148:151], v213 offset:36864
  v_and_b32 v209, 1, v208
  v_mfma_f32_16x16x32_bf16 v[8:11], a[140:143], v[156:159], v[196:199]
  v_lshrrev_b32 v208, 1, v208
  v_mul_u32_u24 v208, 0x500, v208
  v_mfma_f32_16x16x32_bf16 v[8:11], a[136:139], v[152:155], v[8:11]
  ds_read_b128 a[152:155], v214 offset:36864
  v_lshl_add_u32 v208, v209, 4, v208
  v_mfma_f32_16x16x32_bf16 v[8:11], a[132:135], v[148:151], v[8:11]
  buffer_load_dwordx4 v237, s[16:19], s29 offen offset:1024 lds
  v_mfma_f32_16x16x32_bf16 v[8:11], a[128:131], v[144:147], v[8:11]
  ds_read_b128 a[156:159], v215 offset:36864
  v_lshrrev_b32 v209, 4, v242
  v_mfma_f32_16x16x32_bf16 v[16:19], a[128:131], v[160:163], v[200:203]
  v_exp_f32 v0, v0
  v_mfma_f32_16x16x32_bf16 v[16:19], a[132:135], v[164:167], v[16:19]
  v_lshrrev_b32 v210, 5, v209
  v_lshlrev_b32 v210, 30, v210
  v_mfma_f32_16x16x32_bf16 v[16:19], a[136:139], v[168:171], v[16:19]
  v_exp_f32 v1, v1
  v_mfma_f32_16x16x32_bf16 v[16:19], a[140:143], v[172:175], v[16:19]
  v_cvt_pk_bf16_f32 v0, v0, v1
  v_or_b32 v210, v210, v208
  v_mfma_f32_16x16x32_bf16 v[24:27], a[140:143], v[188:191], v[204:207]
  v_exp_f32 v2, v2
  v_mfma_f32_16x16x32_bf16 v[24:27], a[136:139], v[184:187], v[24:27]
  buffer_load_dwordx4 v236, s[16:19], s29 offen offset:2048 lds
  v_mfma_f32_16x16x32_bf16 v[24:27], a[132:135], v[180:183], v[24:27]
  s_waitcnt lgkmcnt(0)
  v_exp_f32 v3, v3
  v_mfma_f32_16x16x32_bf16 v[24:27], a[128:131], v[176:179], v[24:27]
  v_cvt_pk_bf16_f32 v1, v2, v3
  v_bfe_u32 v211, v209, 2, 4
  v_mfma_f32_16x16x32_bf16 v[4:7], a[144:147], v[128:131], v[192:195]
  v_exp_f32 v8, v8
  v_mfma_f32_16x16x32_bf16 v[4:7], a[148:151], v[132:135], v[4:7]
  ds_read_b128 a[128:131], v212 offset:40960
  v_and_b32 v209, 3, v209
  v_mfma_f32_16x16x32_bf16 v[4:7], a[152:155], v[136:139], v[4:7]
  v_exp_f32 v9, v9
  v_mfma_f32_16x16x32_bf16 v[4:7], a[156:159], v[140:143], v[4:7]
  ds_read_b128 a[132:135], v213 offset:40960
  v_cvt_pk_bf16_f32 v8, v8, v9
  v_mfma_f32_16x16x32_bf16 v[12:15], a[156:159], v[156:159], v[196:199]
  v_exp_f32 v10, v10
  v_mfma_f32_16x16x32_bf16 v[12:15], a[152:155], v[152:155], v[12:15]
  ds_read_b128 a[136:139], v214 offset:40960
  v_lshlrev_b32 v209, 3, v209
  v_mfma_f32_16x16x32_bf16 v[12:15], a[148:151], v[148:151], v[12:15]
  v_exp_f32 v11, v11
  v_mfma_f32_16x16x32_bf16 v[12:15], a[144:147], v[144:147], v[12:15]
  ds_read_b128 a[140:143], v215 offset:40960
  v_cvt_pk_bf16_f32 v9, v10, v11
  v_mfma_f32_16x16x32_bf16 v[20:23], a[144:147], v[160:163], v[200:203]
  v_exp_f32 v16, v16
  v_mfma_f32_16x16x32_bf16 v[20:23], a[148:151], v[164:167], v[20:23]
  buffer_load_dwordx4 v237, s[16:19], s29 offen offset:3072 lds
  v_mfma_f32_16x16x32_bf16 v[20:23], a[152:155], v[168:171], v[20:23]
  s_add_u32 s29, s29, 16384
  v_exp_f32 v17, v17
  v_mfma_f32_16x16x32_bf16 v[20:23], a[156:159], v[172:175], v[20:23]
  v_cvt_pk_bf16_f32 v16, v16, v17
  v_lshl_add_u32 v209, v211, 5, v209
  v_mfma_f32_16x16x32_bf16 v[28:31], a[156:159], v[188:191], v[204:207]
  s_add_u32 m0, s28, 0
  v_exp_f32 v18, v18
  v_mfma_f32_16x16x32_bf16 v[28:31], a[152:155], v[184:187], v[28:31]
  buffer_load_dwordx4 v232, s[12:15], s29 offen offset:0 lds
  v_mfma_f32_16x16x32_bf16 v[28:31], a[148:151], v[180:183], v[28:31]
  s_waitcnt lgkmcnt(0)
  v_exp_f32 v19, v19
  v_mfma_f32_16x16x32_bf16 v[28:31], a[144:147], v[176:179], v[28:31]
  v_cvt_pk_bf16_f32 v17, v18, v19
  v_add_u32 v209, s50, v209
  v_mfma_f32_16x16x32_bf16 v[32:35], a[128:131], v[128:131], v[192:195]
  s_and_b32 s39, s2, 1
  s_lshl_b32 s39, s39, 2
  s_add_u32 s39, s39, s3
  v_exp_f32 v24, v24
  v_mfma_f32_16x16x32_bf16 v[32:35], a[132:135], v[132:135], v[32:35]
  ds_read_b128 a[144:147], v212 offset:45056
  s_lshr_b32 s31, s2, 1
  s_mul_i32 s30, s31, 40960
  s_mul_i32 s48, s39, 160
  v_mfma_f32_16x16x32_bf16 v[32:35], a[136:139], v[136:139], v[32:35]
  s_add_u32 s30, s30, s48
  s_mul_i32 s31, s31, 5120
  s_mul_i32 s39, s39, 655360
  v_exp_f32 v25, v25
  v_mfma_f32_16x16x32_bf16 v[32:35], a[140:143], v[140:143], v[32:35]
  ds_read_b128 a[148:151], v213 offset:45056
  s_add_u32 s31, s31, s39
  s_add_u32 s31, s31, 3145728
  s_lshr_b32 s39, s2, 3
  v_cvt_pk_bf16_f32 v24, v24, v25
  v_mfma_f32_16x16x32_bf16 v[40:43], a[140:143], v[156:159], v[196:199]
  s_min_u32 s39, s39, 29
  s_and_b32 s48, s2, 7
  s_mul_i32 s48, s48, 30
  v_exp_f32 v26, v26
  v_mfma_f32_16x16x32_bf16 v[40:43], a[136:139], v[152:155], v[40:43]
  ds_read_b128 a[152:155], v214 offset:45056
  s_add_u32 s39, s39, s48
  s_mul_i32 s98, s39, 1639
  s_lshr_b32 s98, s98, 16
  v_mfma_f32_16x16x32_bf16 v[40:43], a[132:135], v[148:151], v[40:43]
  s_mul_i32 s99, s98, 40
  s_sub_u32 s99, s39, s99
  s_min_u32 s39, s3, 2
  v_exp_f32 v27, v27
  v_mfma_f32_16x16x32_bf16 v[40:43], a[128:131], v[144:147], v[40:43]
  ds_read_b128 a[156:159], v215 offset:45056
  s_mul_i32 s48, s98, 3
  s_add_u32 s48, s48, s39
  s_mul_i32 s100, s48, 122880
  v_cvt_pk_bf16_f32 v25, v26, v27
  v_mfma_f32_16x16x32_bf16 v[48:51], a[128:131], v[160:163], v[200:203]
  s_lshl_b32 s39, s99, 5
  s_add_u32 s100, s100, s39
  s_mul_i32 s101, s48, 192
  v_exp_f32 v4, v4
  v_mfma_f32_16x16x32_bf16 v[48:51], a[132:135], v[164:167], v[48:51]
  buffer_load_dwordx4 v233, s[12:15], s29 offen offset:1024 lds
  s_add_u32 s101, s101, 2633728
  s_mov_b32 s51, s50
  v_mfma_f32_16x16x32_bf16 v[48:51], a[136:139], v[168:171], v[48:51]
  v_exp_f32 v5, v5
  v_mfma_f32_16x16x32_bf16 v[48:51], a[140:143], v[172:175], v[48:51]
  v_cvt_pk_bf16_f32 v2, v4, v5
  v_mov_b32 v211, v242
  v_mfma_f32_16x16x32_bf16 v[56:59], a[140:143], v[188:191], v[204:207]
  s_mov_b32 s4, s94
  s_mov_b32 s5, s95
  s_mov_b32 s6, 2211840
  v_exp_f32 v6, v6
  v_mfma_f32_16x16x32_bf16 v[56:59], a[136:139], v[184:187], v[56:59]
  buffer_load_dwordx4 v234, s[12:15], s29 offen offset:2048 lds
  s_mov_b32 s7, 0x20000
  s_getpc_b64 s[8:9]
attn_late_pc:
  s_add_u32 s8, s8, attn_h_ready-attn_late_pc
  s_addc_u32 s9, s9, 0
  v_mfma_f32_16x16x32_bf16 v[56:59], a[132:135], v[180:183], v[56:59]
  s_waitcnt lgkmcnt(0)
  s_lshr_b32 s39, s2, 3
  v_exp_f32 v7, v7
  v_mfma_f32_16x16x32_bf16 v[56:59], a[128:131], v[176:179], v[56:59]
  v_cvt_pk_bf16_f32 v3, v6, v7
  v_lshrrev_b32 v252, 4, v242
  v_mfma_f32_16x16x32_bf16 v[36:39], a[144:147], v[128:131], v[192:195]
  v_exp_f32 v12, v12
  v_mfma_f32_16x16x32_bf16 v[36:39], a[148:151], v[132:135], v[36:39]
  ds_read_b64_tr_b16 a[160:161], v216 offset:16384
  v_min_u32 v252, 11, v252
  v_mfma_f32_16x16x32_bf16 v[36:39], a[152:155], v[136:139], v[36:39]
  v_exp_f32 v13, v13
  v_mfma_f32_16x16x32_bf16 v[36:39], a[156:159], v[140:143], v[36:39]
  ds_read_b64_tr_b16 a[162:163], v216 offset:20480
  v_cvt_pk_bf16_f32 v10, v12, v13
  v_mfma_f32_16x16x32_bf16 v[44:47], a[156:159], v[156:159], v[196:199]
  v_exp_f32 v14, v14
  v_mfma_f32_16x16x32_bf16 v[44:47], a[152:155], v[152:155], v[44:47]
  ds_read_b64_tr_b16 a[164:165], v216 offset:24576
  buffer_load_dwordx4 v235, s[12:15], s29 offen offset:3072 lds
  v_mfma_f32_16x16x32_bf16 v[44:47], a[148:151], v[148:151], v[44:47]
  v_exp_f32 v15, v15
  v_mfma_f32_16x16x32_bf16 v[44:47], a[144:147], v[144:147], v[44:47]
  ds_read_b64_tr_b16 a[166:167], v216 offset:28672
  v_cvt_pk_bf16_f32 v11, v14, v15
  v_mfma_f32_16x16x32_bf16 v[52:55], a[144:147], v[160:163], v[200:203]
  v_exp_f32 v20, v20
  v_mfma_f32_16x16x32_bf16 v[52:55], a[148:151], v[164:167], v[52:55]
  ds_read_b64_tr_b16 a[168:169], v217 offset:16384
  v_lshlrev_b32 v252, 5, v252
  v_mfma_f32_16x16x32_bf16 v[52:55], a[152:155], v[168:171], v[52:55]
  v_exp_f32 v21, v21
  v_mfma_f32_16x16x32_bf16 v[52:55], a[156:159], v[172:175], v[52:55]
  ds_read_b64_tr_b16 a[170:171], v217 offset:20480
  v_cvt_pk_bf16_f32 v18, v20, v21
  v_mfma_f32_16x16x32_bf16 v[60:63], a[156:159], v[188:191], v[204:207]
  v_exp_f32 v22, v22
  v_mfma_f32_16x16x32_bf16 v[60:63], a[152:155], v[184:187], v[60:63]
  ds_read_b64_tr_b16 a[172:173], v217 offset:24576
  v_add_u32 v252, s39, v252
  v_mfma_f32_16x16x32_bf16 v[60:63], a[148:151], v[180:183], v[60:63]
  v_exp_f32 v23, v23
  v_mfma_f32_16x16x32_bf16 v[60:63], a[144:147], v[176:179], v[60:63]
  ds_read_b64_tr_b16 a[174:175], v217 offset:28672
  v_cvt_pk_bf16_f32 v19, v22, v23
  v_mfma_f32_16x16x32_bf16 a[192:195], a[208:211], v[64:67], a[192:195]
  v_exp_f32 v28, v28
  v_mfma_f32_16x16x32_bf16 a[192:195], a[208:211], v[96:99], a[192:195]
  ds_read_b64_tr_b16 a[176:177], v218 offset:16384
  v_lshlrev_b32 v252, 7, v252
  v_mfma_f32_16x16x32_bf16 a[196:199], a[208:211], v[72:75], a[196:199]
  v_exp_f32 v29, v29
  v_mfma_f32_16x16x32_bf16 a[196:199], a[208:211], v[104:107], a[196:199]
  ds_read_b64_tr_b16 a[178:179], v218 offset:20480
  v_cvt_pk_bf16_f32 v26, v28, v29
  v_mfma_f32_16x16x32_bf16 a[200:203], a[208:211], v[80:83], a[200:203]
  v_exp_f32 v30, v30
  v_mfma_f32_16x16x32_bf16 a[200:203], a[208:211], v[112:115], a[200:203]
  ds_read_b64_tr_b16 a[180:181], v218 offset:24576
  v_min_u32 v252, attn_end-attn_h_ready-4, v252
  v_mfma_f32_16x16x32_bf16 a[204:207], a[208:211], v[88:91], a[204:207]
  s_waitcnt lgkmcnt(7)
  v_exp_f32 v31, v31
  v_mfma_f32_16x16x32_bf16 a[204:207], a[208:211], v[120:123], a[204:207]
  ds_read_b64_tr_b16 a[182:183], v218 offset:28672
  v_cvt_pk_bf16_f32 v27, v30, v31
  v_mfma_f32_16x16x32_bf16 a[0:3], a[160:163], v[64:67], a[0:3]
  v_exp_f32 v32, v32
  v_mfma_f32_16x16x32_bf16 a[0:3], a[164:167], v[96:99], a[0:3]
  ds_read_b64_tr_b16 a[184:185], v219 offset:16384
  v_mfma_f32_16x16x32_bf16 a[4:7], a[164:167], v[104:107], a[4:7]
  v_exp_f32 v33, v33
  v_mfma_f32_16x16x32_bf16 a[4:7], a[160:163], v[72:75], a[4:7]
  ds_read_b64_tr_b16 a[186:187], v219 offset:20480
  v_cvt_pk_bf16_f32 v32, v32, v33
  v_mfma_f32_16x16x32_bf16 a[8:11], a[160:163], v[80:83], a[8:11]
  v_exp_f32 v34, v34
  v_mfma_f32_16x16x32_bf16 a[8:11], a[164:167], v[112:115], a[8:11]
  ds_read_b64_tr_b16 a[188:189], v219 offset:24576
  v_mfma_f32_16x16x32_bf16 a[12:15], a[164:167], v[120:123], a[12:15]
  s_waitcnt lgkmcnt(7)
  v_exp_f32 v35, v35
  v_mfma_f32_16x16x32_bf16 a[12:15], a[160:163], v[88:91], a[12:15]
  ds_read_b64_tr_b16 a[190:191], v219 offset:28672
  v_cvt_pk_bf16_f32 v33, v34, v35
  v_mfma_f32_16x16x32_bf16 a[16:19], a[168:171], v[64:67], a[16:19]
  v_exp_f32 v40, v40
  v_mfma_f32_16x16x32_bf16 a[16:19], a[172:175], v[96:99], a[16:19]
  ds_read_b64_tr_b16 a[160:161], v220 offset:16384
  v_mfma_f32_16x16x32_bf16 a[20:23], a[172:175], v[104:107], a[20:23]
  v_exp_f32 v41, v41
  v_mfma_f32_16x16x32_bf16 a[20:23], a[168:171], v[72:75], a[20:23]
  ds_read_b64_tr_b16 a[162:163], v220 offset:20480
  v_cvt_pk_bf16_f32 v40, v40, v41
  v_mfma_f32_16x16x32_bf16 a[24:27], a[168:171], v[80:83], a[24:27]
  v_exp_f32 v42, v42
  v_mfma_f32_16x16x32_bf16 a[24:27], a[172:175], v[112:115], a[24:27]
  ds_read_b64_tr_b16 a[164:165], v220 offset:24576
  v_mfma_f32_16x16x32_bf16 a[28:31], a[172:175], v[120:123], a[28:31]
  s_waitcnt lgkmcnt(7)
  v_exp_f32 v43, v43
  v_mfma_f32_16x16x32_bf16 a[28:31], a[168:171], v[88:91], a[28:31]
  ds_read_b64_tr_b16 a[166:167], v220 offset:28672
  v_cvt_pk_bf16_f32 v41, v42, v43
  v_mfma_f32_16x16x32_bf16 a[32:35], a[176:179], v[64:67], a[32:35]
  v_exp_f32 v48, v48
  v_mfma_f32_16x16x32_bf16 a[32:35], a[180:183], v[96:99], a[32:35]
  ds_read_b64_tr_b16 a[168:169], v221 offset:16384
  v_mfma_f32_16x16x32_bf16 a[36:39], a[180:183], v[104:107], a[36:39]
  v_exp_f32 v49, v49
  v_mfma_f32_16x16x32_bf16 a[36:39], a[176:179], v[72:75], a[36:39]
  ds_read_b64_tr_b16 a[170:171], v221 offset:20480
  v_cvt_pk_bf16_f32 v48, v48, v49
  v_mfma_f32_16x16x32_bf16 a[40:43], a[176:179], v[80:83], a[40:43]
  v_exp_f32 v50, v50
  v_mfma_f32_16x16x32_bf16 a[40:43], a[180:183], v[112:115], a[40:43]
  ds_read_b64_tr_b16 a[172:173], v221 offset:24576
  v_mfma_f32_16x16x32_bf16 a[44:47], a[180:183], v[120:123], a[44:47]
  s_waitcnt lgkmcnt(7)
  v_exp_f32 v51, v51
  v_mfma_f32_16x16x32_bf16 a[44:47], a[176:179], v[88:91], a[44:47]
  ds_read_b64_tr_b16 a[174:175], v221 offset:28672
  v_cvt_pk_bf16_f32 v49, v50, v51
  v_mfma_f32_16x16x32_bf16 a[48:51], a[184:187], v[64:67], a[48:51]
  v_exp_f32 v56, v56
  v_mfma_f32_16x16x32_bf16 a[48:51], a[188:191], v[96:99], a[48:51]
  ds_read_b64_tr_b16 a[176:177], v222 offset:16384
  v_mfma_f32_16x16x32_bf16 a[52:55], a[188:191], v[104:107], a[52:55]
  v_exp_f32 v57, v57
  v_mfma_f32_16x16x32_bf16 a[52:55], a[184:187], v[72:75], a[52:55]
  ds_read_b64_tr_b16 a[178:179], v222 offset:20480
  v_cvt_pk_bf16_f32 v56, v56, v57
  v_mfma_f32_16x16x32_bf16 a[56:59], a[184:187], v[80:83], a[56:59]
  v_exp_f32 v58, v58
  v_mfma_f32_16x16x32_bf16 a[56:59], a[188:191], v[112:115], a[56:59]
  ds_read_b64_tr_b16 a[180:181], v222 offset:24576
  v_mfma_f32_16x16x32_bf16 a[60:63], a[188:191], v[120:123], a[60:63]
  s_waitcnt lgkmcnt(7)
  v_exp_f32 v59, v59
  v_mfma_f32_16x16x32_bf16 a[60:63], a[184:187], v[88:91], a[60:63]
  ds_read_b64_tr_b16 a[182:183], v222 offset:28672
  v_cvt_pk_bf16_f32 v57, v58, v59
  v_mfma_f32_16x16x32_bf16 a[64:67], a[160:163], v[64:67], a[64:67]
  v_exp_f32 v36, v36
  v_mfma_f32_16x16x32_bf16 a[64:67], a[164:167], v[96:99], a[64:67]
  ds_read_b64_tr_b16 a[184:185], v223 offset:16384
  v_mfma_f32_16x16x32_bf16 a[68:71], a[164:167], v[104:107], a[68:71]
  v_exp_f32 v37, v37
  v_mfma_f32_16x16x32_bf16 a[68:71], a[160:163], v[72:75], a[68:71]
  ds_read_b64_tr_b16 a[186:187], v223 offset:20480
  v_cvt_pk_bf16_f32 v34, v36, v37
  v_mfma_f32_16x16x32_bf16 a[72:75], a[160:163], v[80:83], a[72:75]
  v_exp_f32 v38, v38
  v_mfma_f32_16x16x32_bf16 a[72:75], a[164:167], v[112:115], a[72:75]
  ds_read_b64_tr_b16 a[188:189], v223 offset:24576
  v_mfma_f32_16x16x32_bf16 a[76:79], a[164:167], v[120:123], a[76:79]
  s_waitcnt lgkmcnt(7)
  v_exp_f32 v39, v39
  v_mfma_f32_16x16x32_bf16 a[76:79], a[160:163], v[88:91], a[76:79]
  ds_read_b64_tr_b16 a[190:191], v223 offset:28672
  v_cvt_pk_bf16_f32 v35, v38, v39
  v_mfma_f32_16x16x32_bf16 a[80:83], a[168:171], v[64:67], a[80:83]
  s_waitcnt vmcnt(10)
  v_exp_f32 v44, v44
  v_mfma_f32_16x16x32_bf16 a[80:83], a[172:175], v[96:99], a[80:83]
  v_mfma_f32_16x16x32_bf16 a[84:87], a[172:175], v[104:107], a[84:87]
  s_barrier
  v_exp_f32 v45, v45
  v_mfma_f32_16x16x32_bf16 a[84:87], a[168:171], v[72:75], a[84:87]
  ds_read_b128 a[128:131], v212 offset:49152
  v_cvt_pk_bf16_f32 v42, v44, v45
  v_mfma_f32_16x16x32_bf16 a[88:91], a[168:171], v[80:83], a[88:91]
  v_exp_f32 v46, v46
  v_mfma_f32_16x16x32_bf16 a[88:91], a[172:175], v[112:115], a[88:91]
  ds_read_b128 a[132:135], v213 offset:49152
  v_mfma_f32_16x16x32_bf16 a[92:95], a[172:175], v[120:123], a[92:95]
  s_waitcnt lgkmcnt(6)
  v_exp_f32 v47, v47
  v_mfma_f32_16x16x32_bf16 a[92:95], a[168:171], v[88:91], a[92:95]
  ds_read_b128 a[136:139], v214 offset:49152
  v_cvt_pk_bf16_f32 v43, v46, v47
  v_mfma_f32_16x16x32_bf16 a[96:99], a[176:179], v[64:67], a[96:99]
  v_exp_f32 v52, v52
  v_mfma_f32_16x16x32_bf16 a[96:99], a[180:183], v[96:99], a[96:99]
  ds_read_b128 a[140:143], v215 offset:49152
  v_mfma_f32_16x16x32_bf16 a[100:103], a[180:183], v[104:107], a[100:103]
  v_exp_f32 v53, v53
  v_mfma_f32_16x16x32_bf16 a[100:103], a[176:179], v[72:75], a[100:103]
  v_cvt_pk_bf16_f32 v50, v52, v53
  v_mfma_f32_16x16x32_bf16 a[104:107], a[176:179], v[80:83], a[104:107]
  v_exp_f32 v54, v54
  v_mfma_f32_16x16x32_bf16 a[104:107], a[180:183], v[112:115], a[104:107]
  v_mfma_f32_16x16x32_bf16 a[108:111], a[180:183], v[120:123], a[108:111]
  s_waitcnt lgkmcnt(4)
  v_exp_f32 v55, v55
  v_mfma_f32_16x16x32_bf16 a[108:111], a[176:179], v[88:91], a[108:111]
  v_cvt_pk_bf16_f32 v51, v54, v55
  v_mfma_f32_16x16x32_bf16 a[112:115], a[184:187], v[64:67], a[112:115]
  v_exp_f32 v60, v60
  v_mfma_f32_16x16x32_bf16 a[112:115], a[188:191], v[96:99], a[112:115]
  v_mfma_f32_16x16x32_bf16 a[116:119], a[188:191], v[104:107], a[116:119]
  v_exp_f32 v61, v61
  v_mfma_f32_16x16x32_bf16 a[116:119], a[184:187], v[72:75], a[116:119]
  v_cvt_pk_bf16_f32 v58, v60, v61
  v_mfma_f32_16x16x32_bf16 a[120:123], a[184:187], v[80:83], a[120:123]
  v_exp_f32 v62, v62
  v_mfma_f32_16x16x32_bf16 a[120:123], a[188:191], v[112:115], a[120:123]
  v_mfma_f32_16x16x32_bf16 a[124:127], a[188:191], v[120:123], a[124:127]
  s_waitcnt lgkmcnt(0)
  v_exp_f32 v63, v63
  v_mfma_f32_16x16x32_bf16 a[124:127], a[184:187], v[88:91], a[124:127]
  v_cvt_pk_bf16_f32 v59, v62, v63
  v_mfma_f32_16x16x32_bf16 v[64:67], a[128:131], v[128:131], v[192:195]
  s_add_u32 m0, s28, 65536
  v_lshrrev_b32 v224, 4, v242
  v_lshrrev_b32 v225, 4, v224
  v_mfma_f32_16x16x32_bf16 v[64:67], a[132:135], v[132:135], v[64:67]
  ds_read_b128 a[144:147], v212 offset:53248
  v_bfe_u32 v226, v224, 2, 2
  v_mfma_f32_16x16x32_bf16 v[64:67], a[136:139], v[136:139], v[64:67]
  buffer_load_dwordx4 v236, s[16:19], s29 offen offset:0 lds
  v_mfma_f32_16x16x32_bf16 v[64:67], a[140:143], v[140:143], v[64:67]
  ds_read_b128 a[148:151], v213 offset:53248
  v_lshl_add_u32 v225, v225, 3, v226
  v_mfma_f32_16x16x32_bf16 v[72:75], a[140:143], v[156:159], v[196:199]
  v_lshlrev_b32 v225, 4, v225
  v_bfe_u32 v226, v224, 1, 1
  v_mfma_f32_16x16x32_bf16 v[72:75], a[136:139], v[152:155], v[72:75]
  ds_read_b128 a[152:155], v214 offset:53248
  v_mul_u32_u24 v226, 0xc00, v226
  v_mfma_f32_16x16x32_bf16 v[72:75], a[132:135], v[148:151], v[72:75]
  buffer_load_dwordx4 v237, s[16:19], s29 offen offset:1024 lds
  v_mfma_f32_16x16x32_bf16 v[72:75], a[128:131], v[144:147], v[72:75]
  ds_read_b128 a[156:159], v215 offset:53248
  v_add3_u32 v225, v225, v226, s50
  v_mfma_f32_16x16x32_bf16 v[80:83], a[128:131], v[160:163], v[200:203]
  v_exp_f32 v64, v64
  v_mfma_f32_16x16x32_bf16 v[80:83], a[132:135], v[164:167], v[80:83]
  v_and_b32 v226, 1, v224
  v_lshl_add_u32 v225, v226, 3, v225
  v_mfma_f32_16x16x32_bf16 v[80:83], a[136:139], v[168:171], v[80:83]
  s_waitcnt vmcnt(10)
  v_exp_f32 v65, v65
  v_mfma_f32_16x16x32_bf16 v[80:83], a[140:143], v[172:175], v[80:83]
  ds_read_b64_tr_b16 a[232:233], v225 offset:0
  v_cvt_pk_bf16_f32 v64, v64, v65
  v_mfma_f32_16x16x32_bf16 v[88:91], a[140:143], v[188:191], v[204:207]
  v_exp_f32 v66, v66
  v_mfma_f32_16x16x32_bf16 v[88:91], a[136:139], v[184:187], v[88:91]
  buffer_load_dwordx4 v236, s[16:19], s29 offen offset:2048 lds
  v_mfma_f32_16x16x32_bf16 v[88:91], a[132:135], v[180:183], v[88:91]
  s_waitcnt lgkmcnt(1)
  v_exp_f32 v67, v67
  v_mfma_f32_16x16x32_bf16 v[88:91], a[128:131], v[176:179], v[88:91]
  ds_read_b64_tr_b16 a[234:235], v225 offset:64
  v_cvt_pk_bf16_f32 v65, v66, v67
  v_mfma_f32_16x16x32_bf16 v[68:71], a[144:147], v[128:131], v[192:195]
  v_exp_f32 v72, v72
  v_mfma_f32_16x16x32_bf16 v[68:71], a[148:151], v[132:135], v[68:71]
  ds_read_b128 a[128:131], v212 offset:57344
  ds_read_b64_tr_b16 a[236:237], v225 offset:512
  v_mfma_f32_16x16x32_bf16 v[68:71], a[152:155], v[136:139], v[68:71]
  v_exp_f32 v73, v73
  v_mfma_f32_16x16x32_bf16 v[68:71], a[156:159], v[140:143], v[68:71]
  ds_read_b128 a[132:135], v213 offset:57344
  v_cvt_pk_bf16_f32 v72, v72, v73
  v_mfma_f32_16x16x32_bf16 v[76:79], a[156:159], v[156:159], v[196:199]
  v_exp_f32 v74, v74
  v_mfma_f32_16x16x32_bf16 v[76:79], a[152:155], v[152:155], v[76:79]
  ds_read_b128 a[136:139], v214 offset:57344
  ds_read_b64_tr_b16 a[238:239], v225 offset:576
  v_mfma_f32_16x16x32_bf16 v[76:79], a[148:151], v[148:151], v[76:79]
  v_exp_f32 v75, v75
  v_mfma_f32_16x16x32_bf16 v[76:79], a[144:147], v[144:147], v[76:79]
  ds_read_b128 a[140:143], v215 offset:57344
  v_cvt_pk_bf16_f32 v73, v74, v75
  v_mfma_f32_16x16x32_bf16 v[84:87], a[144:147], v[160:163], v[200:203]
  v_exp_f32 v80, v80
  v_mfma_f32_16x16x32_bf16 v[84:87], a[148:151], v[164:167], v[84:87]
  buffer_load_dwordx4 v237, s[16:19], s29 offen offset:3072 lds
  v_mfma_f32_16x16x32_bf16 v[84:87], a[152:155], v[168:171], v[84:87]
  s_add_u32 s29, s29, 16384
  v_exp_f32 v81, v81
  v_mfma_f32_16x16x32_bf16 v[84:87], a[156:159], v[172:175], v[84:87]
  ds_read_b64_tr_b16 a[240:241], v225 offset:1024
  v_cvt_pk_bf16_f32 v80, v80, v81
  v_mfma_f32_16x16x32_bf16 v[92:95], a[156:159], v[188:191], v[204:207]
  s_add_u32 m0, s28, 16384
  v_exp_f32 v82, v82
  v_mfma_f32_16x16x32_bf16 v[92:95], a[152:155], v[184:187], v[92:95]
  buffer_load_dwordx4 v232, s[12:15], s29 offen offset:0 lds
  v_mfma_f32_16x16x32_bf16 v[92:95], a[148:151], v[180:183], v[92:95]
  s_waitcnt lgkmcnt(1)
  v_exp_f32 v83, v83
  v_mfma_f32_16x16x32_bf16 v[92:95], a[144:147], v[176:179], v[92:95]
  ds_read_b64_tr_b16 a[242:243], v225 offset:1088
  v_cvt_pk_bf16_f32 v81, v82, v83
  v_mfma_f32_16x16x32_bf16 v[96:99], a[128:131], v[128:131], v[192:195]
  v_exp_f32 v88, v88
  v_mfma_f32_16x16x32_bf16 v[96:99], a[132:135], v[132:135], v[96:99]
  ds_read_b128 a[144:147], v212 offset:61440
  ds_read_b64_tr_b16 a[244:245], v225 offset:1536
  v_mfma_f32_16x16x32_bf16 v[96:99], a[136:139], v[136:139], v[96:99]
  v_exp_f32 v89, v89
  v_mfma_f32_16x16x32_bf16 v[96:99], a[140:143], v[140:143], v[96:99]
  ds_read_b128 a[148:151], v213 offset:61440
  v_cvt_pk_bf16_f32 v88, v88, v89
  v_mfma_f32_16x16x32_bf16 v[104:107], a[140:143], v[156:159], v[196:199]
  v_exp_f32 v90, v90
  v_mfma_f32_16x16x32_bf16 v[104:107], a[136:139], v[152:155], v[104:107]
  ds_read_b128 a[152:155], v214 offset:61440
  ds_read_b64_tr_b16 a[246:247], v225 offset:1600
  v_mfma_f32_16x16x32_bf16 v[104:107], a[132:135], v[148:151], v[104:107]
  v_exp_f32 v91, v91
  v_mfma_f32_16x16x32_bf16 v[104:107], a[128:131], v[144:147], v[104:107]
  ds_read_b128 a[156:159], v215 offset:61440
  v_cvt_pk_bf16_f32 v89, v90, v91
  v_mfma_f32_16x16x32_bf16 v[112:115], a[128:131], v[160:163], v[200:203]
  v_exp_f32 v68, v68
  v_mfma_f32_16x16x32_bf16 v[112:115], a[132:135], v[164:167], v[112:115]
  buffer_load_dwordx4 v233, s[12:15], s29 offen offset:1024 lds
  v_mfma_f32_16x16x32_bf16 v[112:115], a[136:139], v[168:171], v[112:115]
  v_exp_f32 v69, v69
  v_mfma_f32_16x16x32_bf16 v[112:115], a[140:143], v[172:175], v[112:115]
  ds_read_b64_tr_b16 a[248:249], v225 offset:2048
  v_cvt_pk_bf16_f32 v66, v68, v69
  v_mfma_f32_16x16x32_bf16 v[120:123], a[140:143], v[188:191], v[204:207]
  v_exp_f32 v70, v70
  v_mfma_f32_16x16x32_bf16 v[120:123], a[136:139], v[184:187], v[120:123]
  buffer_load_dwordx4 v234, s[12:15], s29 offen offset:2048 lds
  v_mfma_f32_16x16x32_bf16 v[120:123], a[132:135], v[180:183], v[120:123]
  s_waitcnt lgkmcnt(1)
  v_exp_f32 v71, v71
  v_mfma_f32_16x16x32_bf16 v[120:123], a[128:131], v[176:179], v[120:123]
  ds_read_b64_tr_b16 a[250:251], v225 offset:2112
  v_cvt_pk_bf16_f32 v67, v70, v71
  v_mfma_f32_16x16x32_bf16 v[100:103], a[144:147], v[128:131], v[192:195]
  v_exp_f32 v76, v76
  v_mfma_f32_16x16x32_bf16 v[100:103], a[148:151], v[132:135], v[100:103]
  ds_read_b64_tr_b16 a[160:161], v216 offset:32768
  v_mfma_f32_16x16x32_bf16 v[100:103], a[152:155], v[136:139], v[100:103]
  v_exp_f32 v77, v77
  v_mfma_f32_16x16x32_bf16 v[100:103], a[156:159], v[140:143], v[100:103]
  ds_read_b64_tr_b16 a[162:163], v216 offset:36864
  v_cvt_pk_bf16_f32 v74, v76, v77
  v_mfma_f32_16x16x32_bf16 v[108:111], a[156:159], v[156:159], v[196:199]
  v_exp_f32 v78, v78
  v_mfma_f32_16x16x32_bf16 v[108:111], a[152:155], v[152:155], v[108:111]
  ds_read_b64_tr_b16 a[164:165], v216 offset:40960
  buffer_load_dwordx4 v235, s[12:15], s29 offen offset:3072 lds
  v_mfma_f32_16x16x32_bf16 v[108:111], a[148:151], v[148:151], v[108:111]
  v_exp_f32 v79, v79
  v_mfma_f32_16x16x32_bf16 v[108:111], a[144:147], v[144:147], v[108:111]
  ds_read_b64_tr_b16 a[166:167], v216 offset:45056
  s_waitcnt lgkmcnt(4)
  v_cvt_pk_bf16_f32 v75, v78, v79
  v_mfma_f32_16x16x32_bf16 v[116:119], a[144:147], v[160:163], v[200:203]
  v_exp_f32 v84, v84
  v_mfma_f32_16x16x32_bf16 v[116:119], a[148:151], v[164:167], v[116:119]
  ds_read_b64_tr_b16 a[168:169], v217 offset:32768
  v_mfma_f32_16x16x32_bf16 v[228:231], a[232:235], a[212:215], 0
  v_mfma_f32_16x16x32_bf16 v[228:231], a[236:239], a[216:219], v[228:231]
  v_mfma_f32_16x16x32_bf16 v[228:231], a[240:243], a[220:223], v[228:231]
  v_mfma_f32_16x16x32_bf16 v[228:231], a[244:247], a[224:227], v[228:231]
  v_mfma_f32_16x16x32_bf16 v[228:231], a[248:251], a[228:231], v[228:231]
  v_mfma_f32_16x16x32_bf16 v[116:119], a[152:155], v[168:171], v[116:119]
  s_lshl_b32 s35, s3, 10
  s_add_u32 s35, s35, 159744
  v_exp_f32 v85, v85
  v_mfma_f32_16x16x32_bf16 v[116:119], a[156:159], v[172:175], v[116:119]
  ds_read_b64_tr_b16 a[170:171], v217 offset:36864
  v_cvt_pk_bf16_f32 v82, v84, v85
  v_mfma_f32_16x16x32_bf16 v[124:127], a[156:159], v[188:191], v[204:207]
  v_exp_f32 v86, v86
  v_mfma_f32_16x16x32_bf16 v[124:127], a[152:155], v[184:187], v[124:127]
  ds_read_b64_tr_b16 a[172:173], v217 offset:40960
  v_add_u32 v224, s35, v242
  v_mfma_f32_16x16x32_bf16 v[124:127], a[148:151], v[180:183], v[124:127]
  v_exp_f32 v87, v87
  v_mfma_f32_16x16x32_bf16 v[124:127], a[144:147], v[176:179], v[124:127]
  ds_read_b64_tr_b16 a[174:175], v217 offset:45056
  v_cvt_pk_bf16_f32 v83, v86, v87
  v_mfma_f32_16x16x32_bf16 a[192:195], a[208:211], v[0:3], a[192:195]
  v_exp_f32 v92, v92
  v_mfma_f32_16x16x32_bf16 a[192:195], a[208:211], v[32:35], a[192:195]
  ds_read_b64_tr_b16 a[176:177], v218 offset:32768
  ds_write_b128 v224, v[228:231]
  v_mfma_f32_16x16x32_bf16 a[196:199], a[208:211], v[8:11], a[196:199]
  v_exp_f32 v93, v93
  v_mfma_f32_16x16x32_bf16 a[196:199], a[208:211], v[40:43], a[196:199]
  ds_read_b64_tr_b16 a[178:179], v218 offset:36864
  v_cvt_pk_bf16_f32 v90, v92, v93
  v_mfma_f32_16x16x32_bf16 a[200:203], a[208:211], v[16:19], a[200:203]
  v_exp_f32 v94, v94
  v_mfma_f32_16x16x32_bf16 a[200:203], a[208:211], v[48:51], a[200:203]
  ds_read_b64_tr_b16 a[180:181], v218 offset:40960
  v_mfma_f32_16x16x32_bf16 a[204:207], a[208:211], v[24:27], a[204:207]
  s_waitcnt lgkmcnt(8)
  v_exp_f32 v95, v95
  v_mfma_f32_16x16x32_bf16 a[204:207], a[208:211], v[56:59], a[204:207]
  ds_read_b64_tr_b16 a[182:183], v218 offset:45056
  v_cvt_pk_bf16_f32 v91, v94, v95
  v_mfma_f32_16x16x32_bf16 a[0:3], a[160:163], v[0:3], a[0:3]
  v_exp_f32 v96, v96
  v_mfma_f32_16x16x32_bf16 a[0:3], a[164:167], v[32:35], a[0:3]
  ds_read_b64_tr_b16 a[184:185], v219 offset:32768
  s_waitcnt lgkmcnt(4)
  s_mov_b32 m0, s51
  v_mfma_f32_16x16x32_bf16 a[4:7], a[164:167], v[40:43], a[4:7]
  v_exp_f32 v97, v97
  v_mfma_f32_16x16x32_bf16 a[4:7], a[160:163], v[8:11], a[4:7]
  ds_read_b64_tr_b16 a[186:187], v219 offset:36864
  v_cvt_pk_bf16_f32 v96, v96, v97
  v_mfma_f32_16x16x32_bf16 a[8:11], a[160:163], v[16:19], a[8:11]
  v_exp_f32 v98, v98
  v_mfma_f32_16x16x32_bf16 a[8:11], a[164:167], v[48:51], a[8:11]
  ds_read_b64_tr_b16 a[188:189], v219 offset:40960
  buffer_load_dwordx4 v210, s[4:7], s100 offen lds
  s_add_u32 s100, s100, 20480
  s_add_u32 s51, s51, 512
  v_mfma_f32_16x16x32_bf16 a[12:15], a[164:167], v[56:59], a[12:15]
  v_exp_f32 v99, v99
  v_mfma_f32_16x16x32_bf16 a[12:15], a[160:163], v[24:27], a[12:15]
  ds_read_b64_tr_b16 a[190:191], v219 offset:45056
  v_cvt_pk_bf16_f32 v97, v98, v99
  v_mfma_f32_16x16x32_bf16 a[16:19], a[168:171], v[0:3], a[16:19]
  v_exp_f32 v104, v104
  v_mfma_f32_16x16x32_bf16 a[16:19], a[172:175], v[32:35], a[16:19]
  ds_read_b64_tr_b16 a[160:161], v220 offset:32768
  v_lshrrev_b32 v224, 4, v242
  v_mfma_f32_16x16x32_bf16 a[20:23], a[172:175], v[40:43], a[20:23]
  v_exp_f32 v105, v105
  v_mfma_f32_16x16x32_bf16 a[20:23], a[168:171], v[8:11], a[20:23]
  ds_read_b64_tr_b16 a[162:163], v220 offset:36864
  v_cvt_pk_bf16_f32 v104, v104, v105
  v_mfma_f32_16x16x32_bf16 a[24:27], a[168:171], v[16:19], a[24:27]
  v_exp_f32 v106, v106
  v_mfma_f32_16x16x32_bf16 a[24:27], a[172:175], v[48:51], a[24:27]
  ds_read_b64_tr_b16 a[164:165], v220 offset:40960
  v_bfe_u32 v225, v224, 2, 1
  v_mfma_f32_16x16x32_bf16 a[28:31], a[172:175], v[56:59], a[28:31]
  s_waitcnt lgkmcnt(7)
  v_exp_f32 v107, v107
  v_mfma_f32_16x16x32_bf16 a[28:31], a[168:171], v[24:27], a[28:31]
  ds_read_b64_tr_b16 a[166:167], v220 offset:45056
  v_cvt_pk_bf16_f32 v105, v106, v107
  v_mfma_f32_16x16x32_bf16 a[32:35], a[176:179], v[0:3], a[32:35]
  v_exp_f32 v112, v112
  v_mfma_f32_16x16x32_bf16 a[32:35], a[180:183], v[32:35], a[32:35]
  ds_read_b64_tr_b16 a[168:169], v221 offset:32768
  v_lshlrev_b32 v225, 8, v225
  v_mfma_f32_16x16x32_bf16 a[36:39], a[180:183], v[40:43], a[36:39]
  v_exp_f32 v113, v113
  v_mfma_f32_16x16x32_bf16 a[36:39], a[176:179], v[8:11], a[36:39]
  ds_read_b64_tr_b16 a[170:171], v221 offset:36864
  v_cvt_pk_bf16_f32 v112, v112, v113
  v_mfma_f32_16x16x32_bf16 a[40:43], a[176:179], v[16:19], a[40:43]
  v_exp_f32 v114, v114
  v_mfma_f32_16x16x32_bf16 a[40:43], a[180:183], v[48:51], a[40:43]
  ds_read_b64_tr_b16 a[172:173], v221 offset:40960
  v_lshrrev_b32 v226, 3, v224
  v_mfma_f32_16x16x32_bf16 a[44:47], a[180:183], v[56:59], a[44:47]
  s_waitcnt lgkmcnt(7)
  v_exp_f32 v115, v115
  v_mfma_f32_16x16x32_bf16 a[44:47], a[176:179], v[24:27], a[44:47]
  ds_read_b64_tr_b16 a[174:175], v221 offset:45056
  v_cvt_pk_bf16_f32 v113, v114, v115
  v_mfma_f32_16x16x32_bf16 a[48:51], a[184:187], v[0:3], a[48:51]
  v_exp_f32 v120, v120
  v_mfma_f32_16x16x32_bf16 a[48:51], a[188:191], v[32:35], a[48:51]
  ds_read_b64_tr_b16 a[176:177], v222 offset:32768
  v_lshl_add_u32 v225, v226, 4, v225
  v_mfma_f32_16x16x32_bf16 a[52:55], a[188:191], v[40:43], a[52:55]
  v_exp_f32 v121, v121
  v_mfma_f32_16x16x32_bf16 a[52:55], a[184:187], v[8:11], a[52:55]
  ds_read_b64_tr_b16 a[178:179], v222 offset:36864
  v_cvt_pk_bf16_f32 v120, v120, v121
  v_mfma_f32_16x16x32_bf16 a[56:59], a[184:187], v[16:19], a[56:59]
  v_exp_f32 v122, v122
  v_mfma_f32_16x16x32_bf16 a[56:59], a[188:191], v[48:51], a[56:59]
  ds_read_b64_tr_b16 a[180:181], v222 offset:40960
  v_and_b32 v227, 3, v224
  v_mfma_f32_16x16x32_bf16 a[60:63], a[188:191], v[56:59], a[60:63]
  s_waitcnt lgkmcnt(7)
  v_exp_f32 v123, v123
  v_mfma_f32_16x16x32_bf16 a[60:63], a[184:187], v[24:27], a[60:63]
  ds_read_b64_tr_b16 a[182:183], v222 offset:45056
  v_cvt_pk_bf16_f32 v121, v122, v123
  v_mfma_f32_16x16x32_bf16 a[64:67], a[160:163], v[0:3], a[64:67]
  v_exp_f32 v100, v100
  v_mfma_f32_16x16x32_bf16 a[64:67], a[164:167], v[32:35], a[64:67]
  ds_read_b64_tr_b16 a[184:185], v223 offset:32768
  v_lshl_add_u32 v225, v227, 2, v225
  v_mfma_f32_16x16x32_bf16 a[68:71], a[164:167], v[40:43], a[68:71]
  v_exp_f32 v101, v101
  v_mfma_f32_16x16x32_bf16 a[68:71], a[160:163], v[8:11], a[68:71]
  ds_read_b64_tr_b16 a[186:187], v223 offset:36864
  v_cvt_pk_bf16_f32 v98, v100, v101
  v_mfma_f32_16x16x32_bf16 a[72:75], a[160:163], v[16:19], a[72:75]
  v_exp_f32 v102, v102
  v_mfma_f32_16x16x32_bf16 a[72:75], a[164:167], v[48:51], a[72:75]
  ds_read_b64_tr_b16 a[188:189], v223 offset:40960
  v_add_u32 v225, 159744, v225
  v_mfma_f32_16x16x32_bf16 a[76:79], a[164:167], v[56:59], a[76:79]
  s_waitcnt lgkmcnt(7)
  v_exp_f32 v103, v103
  v_mfma_f32_16x16x32_bf16 a[76:79], a[160:163], v[24:27], a[76:79]
  ds_read_b64_tr_b16 a[190:191], v223 offset:45056
  v_cvt_pk_bf16_f32 v99, v102, v103
  v_mfma_f32_16x16x32_bf16 a[80:83], a[168:171], v[0:3], a[80:83]
  s_waitcnt vmcnt(9)
  v_exp_f32 v108, v108
  v_mfma_f32_16x16x32_bf16 a[80:83], a[172:175], v[32:35], a[80:83]
  v_mfma_f32_16x16x32_bf16 a[84:87], a[172:175], v[40:43], a[84:87]
  s_barrier
  v_exp_f32 v109, v109
  v_mfma_f32_16x16x32_bf16 a[84:87], a[168:171], v[8:11], a[84:87]
  ds_read_b128 a[128:131], v212 offset:0
  v_cvt_pk_bf16_f32 v106, v108, v109
  v_mfma_f32_16x16x32_bf16 a[88:91], a[168:171], v[16:19], a[88:91]
  v_exp_f32 v110, v110
  v_mfma_f32_16x16x32_bf16 a[88:91], a[172:175], v[48:51], a[88:91]
  ds_read_b128 a[132:135], v213 offset:0
  ds_read_b32 v228, v225 offset:0
  v_mfma_f32_16x16x32_bf16 a[92:95], a[172:175], v[56:59], a[92:95]
  s_waitcnt lgkmcnt(7)
  v_exp_f32 v111, v111
  v_mfma_f32_16x16x32_bf16 a[92:95], a[168:171], v[24:27], a[92:95]
  ds_read_b128 a[136:139], v214 offset:0
  v_cvt_pk_bf16_f32 v107, v110, v111
  v_mfma_f32_16x16x32_bf16 a[96:99], a[176:179], v[0:3], a[96:99]
  v_exp_f32 v116, v116
  v_mfma_f32_16x16x32_bf16 a[96:99], a[180:183], v[32:35], a[96:99]
  ds_read_b128 a[140:143], v215 offset:0
  ds_read_b32 v229, v225 offset:1024
  v_mfma_f32_16x16x32_bf16 a[100:103], a[180:183], v[40:43], a[100:103]
  v_exp_f32 v117, v117
  v_mfma_f32_16x16x32_bf16 a[100:103], a[176:179], v[8:11], a[100:103]
  ds_read_b32 v230, v225 offset:2048
  v_cvt_pk_bf16_f32 v114, v116, v117
  v_mfma_f32_16x16x32_bf16 a[104:107], a[176:179], v[16:19], a[104:107]
  v_exp_f32 v118, v118
  v_mfma_f32_16x16x32_bf16 a[104:107], a[180:183], v[48:51], a[104:107]
  ds_read_b32 v231, v225 offset:3072
  ds_read_b32 v238, v225 offset:512
  v_mfma_f32_16x16x32_bf16 a[108:111], a[180:183], v[56:59], a[108:111]
  s_waitcnt lgkmcnt(9)
  v_exp_f32 v119, v119
  v_mfma_f32_16x16x32_bf16 a[108:111], a[176:179], v[24:27], a[108:111]
  ds_read_b32 v239, v225 offset:1536
  v_cvt_pk_bf16_f32 v115, v118, v119
  v_mfma_f32_16x16x32_bf16 a[112:115], a[184:187], v[0:3], a[112:115]
  v_exp_f32 v124, v124
  v_mfma_f32_16x16x32_bf16 a[112:115], a[188:191], v[32:35], a[112:115]
  ds_read_b32 v240, v225 offset:2560
  ds_read_b32 v241, v225 offset:3584
  s_cmp_eq_u32 s3, 0
  s_cselect_b32 s35, 0, 1073741824
  v_mfma_f32_16x16x32_bf16 a[116:119], a[188:191], v[40:43], a[116:119]
  v_exp_f32 v125, v125
  v_mfma_f32_16x16x32_bf16 a[116:119], a[184:187], v[8:11], a[116:119]
  v_cvt_pk_bf16_f32 v122, v124, v125
  v_mul_u32_u24 v226, 0xd80, v226
  v_mfma_f32_16x16x32_bf16 a[120:123], a[184:187], v[16:19], a[120:123]
  v_exp_f32 v126, v126
  v_mfma_f32_16x16x32_bf16 a[120:123], a[188:191], v[48:51], a[120:123]
  v_and_b32 v227, 7, v224
  v_lshl_add_u32 v226, v227, 1, v226
  v_mfma_f32_16x16x32_bf16 a[124:127], a[188:191], v[56:59], a[124:127]
  s_waitcnt lgkmcnt(7)
  v_exp_f32 v127, v127
  v_mfma_f32_16x16x32_bf16 a[124:127], a[184:187], v[24:27], a[124:127]
  v_cvt_pk_bf16_f32 v123, v126, v127
  v_and_b32 v227, 1, v224
  v_lshl_add_u32 v226, v227, 30, v226
  v_or_b32 v226, s35, v226
  v_min_u32 v249, 1, v224
  v_lshlrev_b32 v249, 30, v249
  v_or_b32 v249, s35, v249
  v_mov_b32 v251, v249
  v_mov_b32 v250, 1
  s_mov_b32 s47, 2818048
  s_lshl_b32 s35, s33, 4
  s_add_u32 s35, s35, 2633728
  s_waitcnt lgkmcnt(0)
  v_add_f32 v228, v228, v229
  v_add_f32 v238, v238, v239
  v_add_f32 v230, v230, v231
  v_add_f32 v240, v240, v241
  v_add_f32 v228, v228, v230
  v_add_f32 v238, v238, v240
  v_cvt_pk_bf16_f32 v228, v228, v228
  v_cvt_pk_bf16_f32 v238, v238, v238
  v_lshlrev_b32 v228, 16, v228
  v_lshlrev_b32 v238, 16, v238
  v_mul_f32 v229, 0xbfb8aa3b, v228
  v_exp_f32 v229, v229
  s_nop 0
  v_add_f32 v229, 1.0, v229
  v_rcp_f32 v229, v229
  s_nop 0
  v_mul_f32 v228, v228, v229
  v_cvt_pk_bf16_f32 v228, v228, v228
  v_lshlrev_b32 v228, 16, v228
  v_mul_f32 v228, v228, v238
  s_nop 1
  v_mov_b32_dpp v229, v228 quad_perm:[1,0,3,2] row_mask:0xf bank_mask:0xf
  v_cvt_pk_bf16_f32 v228, v228, v229
  buffer_store_dword v228, v226, s[24:27], s35 offen sc1
  s_mov_b32 s32, 5
attn_loop:
  v_mfma_f32_16x16x32_bf16 v[0:3], a[128:131], v[128:131], v[192:195]
  s_add_u32 m0, s28, 81920
  v_mfma_f32_16x16x32_bf16 v[0:3], a[132:135], v[132:135], v[0:3]
  ds_read_b128 a[144:147], v212 offset:4096
  v_mfma_f32_16x16x32_bf16 v[0:3], a[136:139], v[136:139], v[0:3]
  buffer_load_dwordx4 v236, s[16:19], s29 offen offset:0 lds
  v_mfma_f32_16x16x32_bf16 v[0:3], a[140:143], v[140:143], v[0:3]
  ds_read_b128 a[148:151], v213 offset:4096
  v_mfma_f32_16x16x32_bf16 v[8:11], a[140:143], v[156:159], v[196:199]
  v_mfma_f32_16x16x32_bf16 v[8:11], a[136:139], v[152:155], v[8:11]
  ds_read_b128 a[152:155], v214 offset:4096
  v_mfma_f32_16x16x32_bf16 v[8:11], a[132:135], v[148:151], v[8:11]
  buffer_load_dwordx4 v237, s[16:19], s29 offen offset:1024 lds
  v_mfma_f32_16x16x32_bf16 v[8:11], a[128:131], v[144:147], v[8:11]
  ds_read_b128 a[156:159], v215 offset:4096
  v_mfma_f32_16x16x32_bf16 v[16:19], a[128:131], v[160:163], v[200:203]
  v_exp_f32 v0, v0
  v_mfma_f32_16x16x32_bf16 v[16:19], a[132:135], v[164:167], v[16:19]
  v_mfma_f32_16x16x32_bf16 v[16:19], a[136:139], v[168:171], v[16:19]
  v_exp_f32 v1, v1
  v_mfma_f32_16x16x32_bf16 v[16:19], a[140:143], v[172:175], v[16:19]
  v_cvt_pk_bf16_f32 v0, v0, v1
  v_mfma_f32_16x16x32_bf16 v[24:27], a[140:143], v[188:191], v[204:207]
  v_exp_f32 v2, v2
  v_mfma_f32_16x16x32_bf16 v[24:27], a[136:139], v[184:187], v[24:27]
  buffer_load_dwordx4 v236, s[16:19], s29 offen offset:2048 lds
  v_mfma_f32_16x16x32_bf16 v[24:27], a[132:135], v[180:183], v[24:27]
  s_waitcnt lgkmcnt(0)
  v_exp_f32 v3, v3
  v_mfma_f32_16x16x32_bf16 v[24:27], a[128:131], v[176:179], v[24:27]
  v_cvt_pk_bf16_f32 v1, v2, v3
  v_mfma_f32_16x16x32_bf16 v[4:7], a[144:147], v[128:131], v[192:195]
  v_exp_f32 v8, v8
  v_mfma_f32_16x16x32_bf16 v[4:7], a[148:151], v[132:135], v[4:7]
  ds_read_b128 a[128:131], v212 offset:8192
  v_mfma_f32_16x16x32_bf16 v[4:7], a[152:155], v[136:139], v[4:7]
  v_exp_f32 v9, v9
  v_mfma_f32_16x16x32_bf16 v[4:7], a[156:159], v[140:143], v[4:7]
  ds_read_b128 a[132:135], v213 offset:8192
  v_cvt_pk_bf16_f32 v8, v8, v9
  v_mfma_f32_16x16x32_bf16 v[12:15], a[156:159], v[156:159], v[196:199]
  v_exp_f32 v10, v10
  v_mfma_f32_16x16x32_bf16 v[12:15], a[152:155], v[152:155], v[12:15]
  ds_read_b128 a[136:139], v214 offset:8192
  v_mfma_f32_16x16x32_bf16 v[12:15], a[148:151], v[148:151], v[12:15]
  v_exp_f32 v11, v11
  v_mfma_f32_16x16x32_bf16 v[12:15], a[144:147], v[144:147], v[12:15]
  ds_read_b128 a[140:143], v215 offset:8192
  v_cvt_pk_bf16_f32 v9, v10, v11
  v_mfma_f32_16x16x32_bf16 v[20:23], a[144:147], v[160:163], v[200:203]
  v_exp_f32 v16, v16
  v_mfma_f32_16x16x32_bf16 v[20:23], a[148:151], v[164:167], v[20:23]
  buffer_load_dwordx4 v237, s[16:19], s29 offen offset:3072 lds
  v_mfma_f32_16x16x32_bf16 v[20:23], a[152:155], v[168:171], v[20:23]
  s_add_u32 s29, s29, 16384
  v_exp_f32 v17, v17
  v_mfma_f32_16x16x32_bf16 v[20:23], a[156:159], v[172:175], v[20:23]
  v_cvt_pk_bf16_f32 v16, v16, v17
  v_mfma_f32_16x16x32_bf16 v[28:31], a[156:159], v[188:191], v[204:207]
  s_add_u32 m0, s28, 32768
  v_exp_f32 v18, v18
  v_mfma_f32_16x16x32_bf16 v[28:31], a[152:155], v[184:187], v[28:31]
  buffer_load_dwordx4 v232, s[12:15], s29 offen offset:0 lds
  v_mfma_f32_16x16x32_bf16 v[28:31], a[148:151], v[180:183], v[28:31]
  s_waitcnt lgkmcnt(0)
  v_exp_f32 v19, v19
  v_mfma_f32_16x16x32_bf16 v[28:31], a[144:147], v[176:179], v[28:31]
  v_cvt_pk_bf16_f32 v17, v18, v19
  v_mfma_f32_16x16x32_bf16 v[32:35], a[128:131], v[128:131], v[192:195]
  v_exp_f32 v24, v24
  v_mfma_f32_16x16x32_bf16 v[32:35], a[132:135], v[132:135], v[32:35]
  ds_read_b128 a[144:147], v212 offset:12288
  v_mfma_f32_16x16x32_bf16 v[32:35], a[136:139], v[136:139], v[32:35]
  v_exp_f32 v25, v25
  v_mfma_f32_16x16x32_bf16 v[32:35], a[140:143], v[140:143], v[32:35]
  ds_read_b128 a[148:151], v213 offset:12288
  v_cvt_pk_bf16_f32 v24, v24, v25
  v_mfma_f32_16x16x32_bf16 v[40:43], a[140:143], v[156:159], v[196:199]
  v_exp_f32 v26, v26
  v_mfma_f32_16x16x32_bf16 v[40:43], a[136:139], v[152:155], v[40:43]
  ds_read_b128 a[152:155], v214 offset:12288
  v_mfma_f32_16x16x32_bf16 v[40:43], a[132:135], v[148:151], v[40:43]
  v_exp_f32 v27, v27
  v_mfma_f32_16x16x32_bf16 v[40:43], a[128:131], v[144:147], v[40:43]
  ds_read_b128 a[156:159], v215 offset:12288
  v_cvt_pk_bf16_f32 v25, v26, v27
  v_mfma_f32_16x16x32_bf16 v[48:51], a[128:131], v[160:163], v[200:203]
  v_exp_f32 v4, v4
  v_mfma_f32_16x16x32_bf16 v[48:51], a[132:135], v[164:167], v[48:51]
  buffer_load_dwordx4 v233, s[12:15], s29 offen offset:1024 lds
  v_mfma_f32_16x16x32_bf16 v[48:51], a[136:139], v[168:171], v[48:51]
  v_exp_f32 v5, v5
  v_mfma_f32_16x16x32_bf16 v[48:51], a[140:143], v[172:175], v[48:51]
  v_cvt_pk_bf16_f32 v2, v4, v5
  v_mfma_f32_16x16x32_bf16 v[56:59], a[140:143], v[188:191], v[204:207]
  v_exp_f32 v6, v6
  v_mfma_f32_16x16x32_bf16 v[56:59], a[136:139], v[184:187], v[56:59]
  buffer_load_dwordx4 v234, s[12:15], s29 offen offset:2048 lds
  v_mfma_f32_16x16x32_bf16 v[56:59], a[132:135], v[180:183], v[56:59]
  s_waitcnt lgkmcnt(0)
  v_exp_f32 v7, v7
  v_mfma_f32_16x16x32_bf16 v[56:59], a[128:131], v[176:179], v[56:59]
  v_cvt_pk_bf16_f32 v3, v6, v7
  v_mfma_f32_16x16x32_bf16 v[36:39], a[144:147], v[128:131], v[192:195]
  v_exp_f32 v12, v12
  v_mfma_f32_16x16x32_bf16 v[36:39], a[148:151], v[132:135], v[36:39]
  ds_read_b64_tr_b16 a[160:161], v216 offset:49152
  v_mfma_f32_16x16x32_bf16 v[36:39], a[152:155], v[136:139], v[36:39]
  v_exp_f32 v13, v13
  v_mfma_f32_16x16x32_bf16 v[36:39], a[156:159], v[140:143], v[36:39]
  ds_read_b64_tr_b16 a[162:163], v216 offset:53248
  v_cvt_pk_bf16_f32 v10, v12, v13
  v_mfma_f32_16x16x32_bf16 v[44:47], a[156:159], v[156:159], v[196:199]
  v_exp_f32 v14, v14
  v_mfma_f32_16x16x32_bf16 v[44:47], a[152:155], v[152:155], v[44:47]
  ds_read_b64_tr_b16 a[164:165], v216 offset:57344
  buffer_load_dwordx4 v235, s[12:15], s29 offen offset:3072 lds
  v_mfma_f32_16x16x32_bf16 v[44:47], a[148:151], v[148:151], v[44:47]
  v_exp_f32 v15, v15
  v_mfma_f32_16x16x32_bf16 v[44:47], a[144:147], v[144:147], v[44:47]
  ds_read_b64_tr_b16 a[166:167], v216 offset:61440
  v_cvt_pk_bf16_f32 v11, v14, v15
  v_mfma_f32_16x16x32_bf16 v[52:55], a[144:147], v[160:163], v[200:203]
  s_add_u32 m0, s50, 4096
  v_exp_f32 v20, v20
  v_mfma_f32_16x16x32_bf16 v[52:55], a[148:151], v[164:167], v[52:55]
  ds_read_b64_tr_b16 a[168:169], v217 offset:49152
  buffer_load_dwordx4 v208, s[20:23], s30 offen lds
  s_add_u32 s30, s30, 32
  v_mfma_f32_16x16x32_bf16 v[52:55], a[152:155], v[168:171], v[52:55]
  v_exp_f32 v21, v21
  v_mfma_f32_16x16x32_bf16 v[52:55], a[156:159], v[172:175], v[52:55]
  ds_read_b64_tr_b16 a[170:171], v217 offset:53248
  v_cvt_pk_bf16_f32 v18, v20, v21
  v_mfma_f32_16x16x32_bf16 v[60:63], a[156:159], v[188:191], v[204:207]
  v_exp_f32 v22, v22
  v_mfma_f32_16x16x32_bf16 v[60:63], a[152:155], v[184:187], v[60:63]
  ds_read_b64_tr_b16 a[172:173], v217 offset:57344
  v_mfma_f32_16x16x32_bf16 v[60:63], a[148:151], v[180:183], v[60:63]
  v_exp_f32 v23, v23
  v_mfma_f32_16x16x32_bf16 v[60:63], a[144:147], v[176:179], v[60:63]
  ds_read_b64_tr_b16 a[174:175], v217 offset:61440
  v_cvt_pk_bf16_f32 v19, v22, v23
  v_mfma_f32_16x16x32_bf16 a[192:195], a[208:211], v[64:67], a[192:195]
  v_exp_f32 v28, v28
  v_mfma_f32_16x16x32_bf16 a[192:195], a[208:211], v[96:99], a[192:195]
  ds_read_b64_tr_b16 a[176:177], v218 offset:49152
  v_mfma_f32_16x16x32_bf16 a[196:199], a[208:211], v[72:75], a[196:199]
  v_exp_f32 v29, v29
  v_mfma_f32_16x16x32_bf16 a[196:199], a[208:211], v[104:107], a[196:199]
  ds_read_b64_tr_b16 a[178:179], v218 offset:53248
  v_cvt_pk_bf16_f32 v26, v28, v29
  v_mfma_f32_16x16x32_bf16 a[200:203], a[208:211], v[80:83], a[200:203]
  v_exp_f32 v30, v30
  v_mfma_f32_16x16x32_bf16 a[200:203], a[208:211], v[112:115], a[200:203]
  ds_read_b64_tr_b16 a[180:181], v218 offset:57344
  v_mfma_f32_16x16x32_bf16 a[204:207], a[208:211], v[88:91], a[204:207]
  s_waitcnt lgkmcnt(7)
  v_exp_f32 v31, v31
  v_mfma_f32_16x16x32_bf16 a[204:207], a[208:211], v[120:123], a[204:207]
  ds_read_b64_tr_b16 a[182:183], v218 offset:61440
  v_cvt_pk_bf16_f32 v27, v30, v31
  v_mfma_f32_16x16x32_bf16 a[0:3], a[160:163], v[64:67], a[0:3]
  v_exp_f32 v32, v32
  v_mfma_f32_16x16x32_bf16 a[0:3], a[164:167], v[96:99], a[0:3]
  ds_read_b64_tr_b16 a[184:185], v219 offset:49152
  v_mfma_f32_16x16x32_bf16 a[4:7], a[164:167], v[104:107], a[4:7]
  v_exp_f32 v33, v33
  v_mfma_f32_16x16x32_bf16 a[4:7], a[160:163], v[72:75], a[4:7]
  ds_read_b64_tr_b16 a[186:187], v219 offset:53248
  v_cvt_pk_bf16_f32 v32, v32, v33
  v_mfma_f32_16x16x32_bf16 a[8:11], a[160:163], v[80:83], a[8:11]
  v_exp_f32 v34, v34
  v_mfma_f32_16x16x32_bf16 a[8:11], a[164:167], v[112:115], a[8:11]
  ds_read_b64_tr_b16 a[188:189], v219 offset:57344
  v_mfma_f32_16x16x32_bf16 a[12:15], a[164:167], v[120:123], a[12:15]
  s_waitcnt lgkmcnt(7)
  v_exp_f32 v35, v35
  v_mfma_f32_16x16x32_bf16 a[12:15], a[160:163], v[88:91], a[12:15]
  ds_read_b64_tr_b16 a[190:191], v219 offset:61440
  v_cvt_pk_bf16_f32 v33, v34, v35
  v_mfma_f32_16x16x32_bf16 a[16:19], a[168:171], v[64:67], a[16:19]
  v_exp_f32 v40, v40
  v_mfma_f32_16x16x32_bf16 a[16:19], a[172:175], v[96:99], a[16:19]
  ds_read_b64_tr_b16 a[160:161], v220 offset:49152
  v_mfma_f32_16x16x32_bf16 a[20:23], a[172:175], v[104:107], a[20:23]
  v_exp_f32 v41, v41
  v_mfma_f32_16x16x32_bf16 a[20:23], a[168:171], v[72:75], a[20:23]
  ds_read_b64_tr_b16 a[162:163], v220 offset:53248
  v_cvt_pk_bf16_f32 v40, v40, v41
  v_mfma_f32_16x16x32_bf16 a[24:27], a[168:171], v[80:83], a[24:27]
  v_exp_f32 v42, v42
  v_mfma_f32_16x16x32_bf16 a[24:27], a[172:175], v[112:115], a[24:27]
  ds_read_b64_tr_b16 a[164:165], v220 offset:57344
  v_mfma_f32_16x16x32_bf16 a[28:31], a[172:175], v[120:123], a[28:31]
  s_waitcnt lgkmcnt(7)
  v_exp_f32 v43, v43
  v_mfma_f32_16x16x32_bf16 a[28:31], a[168:171], v[88:91], a[28:31]
  ds_read_b64_tr_b16 a[166:167], v220 offset:61440
  v_cvt_pk_bf16_f32 v41, v42, v43
  v_mfma_f32_16x16x32_bf16 a[32:35], a[176:179], v[64:67], a[32:35]
  v_exp_f32 v48, v48
  v_mfma_f32_16x16x32_bf16 a[32:35], a[180:183], v[96:99], a[32:35]
  ds_read_b64_tr_b16 a[168:169], v221 offset:49152
  v_mfma_f32_16x16x32_bf16 a[36:39], a[180:183], v[104:107], a[36:39]
  v_exp_f32 v49, v49
  v_mfma_f32_16x16x32_bf16 a[36:39], a[176:179], v[72:75], a[36:39]
  ds_read_b64_tr_b16 a[170:171], v221 offset:53248
  v_cvt_pk_bf16_f32 v48, v48, v49
  v_mfma_f32_16x16x32_bf16 a[40:43], a[176:179], v[80:83], a[40:43]
  v_exp_f32 v50, v50
  v_mfma_f32_16x16x32_bf16 a[40:43], a[180:183], v[112:115], a[40:43]
  ds_read_b64_tr_b16 a[172:173], v221 offset:57344
  v_mfma_f32_16x16x32_bf16 a[44:47], a[180:183], v[120:123], a[44:47]
  s_waitcnt lgkmcnt(7)
  v_exp_f32 v51, v51
  v_mfma_f32_16x16x32_bf16 a[44:47], a[176:179], v[88:91], a[44:47]
  ds_read_b64_tr_b16 a[174:175], v221 offset:61440
  v_cvt_pk_bf16_f32 v49, v50, v51
  v_mfma_f32_16x16x32_bf16 a[48:51], a[184:187], v[64:67], a[48:51]
  v_exp_f32 v56, v56
  v_mfma_f32_16x16x32_bf16 a[48:51], a[188:191], v[96:99], a[48:51]
  ds_read_b64_tr_b16 a[176:177], v222 offset:49152
  v_mfma_f32_16x16x32_bf16 a[52:55], a[188:191], v[104:107], a[52:55]
  v_exp_f32 v57, v57
  v_mfma_f32_16x16x32_bf16 a[52:55], a[184:187], v[72:75], a[52:55]
  ds_read_b64_tr_b16 a[178:179], v222 offset:53248
  v_cvt_pk_bf16_f32 v56, v56, v57
  v_mfma_f32_16x16x32_bf16 a[56:59], a[184:187], v[80:83], a[56:59]
  v_exp_f32 v58, v58
  v_mfma_f32_16x16x32_bf16 a[56:59], a[188:191], v[112:115], a[56:59]
  ds_read_b64_tr_b16 a[180:181], v222 offset:57344
  global_load_dword v255, v252, s[8:9]
  v_mfma_f32_16x16x32_bf16 a[60:63], a[188:191], v[120:123], a[60:63]
  s_waitcnt lgkmcnt(7)
  v_exp_f32 v59, v59
  v_mfma_f32_16x16x32_bf16 a[60:63], a[184:187], v[88:91], a[60:63]
  ds_read_b64_tr_b16 a[182:183], v222 offset:61440
  v_cvt_pk_bf16_f32 v57, v58, v59
  v_mfma_f32_16x16x32_bf16 a[64:67], a[160:163], v[64:67], a[64:67]
  v_exp_f32 v36, v36
  v_mfma_f32_16x16x32_bf16 a[64:67], a[164:167], v[96:99], a[64:67]
  ds_read_b64_tr_b16 a[184:185], v223 offset:49152
  v_mfma_f32_16x16x32_bf16 a[68:71], a[164:167], v[104:107], a[68:71]
  v_exp_f32 v37, v37
  v_mfma_f32_16x16x32_bf16 a[68:71], a[160:163], v[72:75], a[68:71]
  ds_read_b64_tr_b16 a[186:187], v223 offset:53248
  v_cvt_pk_bf16_f32 v34, v36, v37
  v_mfma_f32_16x16x32_bf16 a[72:75], a[160:163], v[80:83], a[72:75]
  v_exp_f32 v38, v38
  v_mfma_f32_16x16x32_bf16 a[72:75], a[164:167], v[112:115], a[72:75]
  ds_read_b64_tr_b16 a[188:189], v223 offset:57344
  v_mfma_f32_16x16x32_bf16 a[76:79], a[164:167], v[120:123], a[76:79]
  s_waitcnt lgkmcnt(7)
  v_exp_f32 v39, v39
  v_mfma_f32_16x16x32_bf16 a[76:79], a[160:163], v[88:91], a[76:79]
  ds_read_b64_tr_b16 a[190:191], v223 offset:61440
  v_cvt_pk_bf16_f32 v35, v38, v39
  v_mfma_f32_16x16x32_bf16 a[80:83], a[168:171], v[64:67], a[80:83]
  s_waitcnt vmcnt(12)
  v_exp_f32 v44, v44
  v_mfma_f32_16x16x32_bf16 a[80:83], a[172:175], v[96:99], a[80:83]
  v_mfma_f32_16x16x32_bf16 a[84:87], a[172:175], v[104:107], a[84:87]
  s_barrier
  v_exp_f32 v45, v45
  v_mfma_f32_16x16x32_bf16 a[84:87], a[168:171], v[72:75], a[84:87]
  ds_read_b128 a[128:131], v212 offset:16384
  v_cvt_pk_bf16_f32 v42, v44, v45
  v_mfma_f32_16x16x32_bf16 a[88:91], a[168:171], v[80:83], a[88:91]
  v_exp_f32 v46, v46
  v_mfma_f32_16x16x32_bf16 a[88:91], a[172:175], v[112:115], a[88:91]
  ds_read_b128 a[132:135], v213 offset:16384
  v_mfma_f32_16x16x32_bf16 a[92:95], a[172:175], v[120:123], a[92:95]
  s_waitcnt lgkmcnt(6)
  v_exp_f32 v47, v47
  v_mfma_f32_16x16x32_bf16 a[92:95], a[168:171], v[88:91], a[92:95]
  ds_read_b128 a[136:139], v214 offset:16384
  v_cvt_pk_bf16_f32 v43, v46, v47
  v_mfma_f32_16x16x32_bf16 a[96:99], a[176:179], v[64:67], a[96:99]
  v_exp_f32 v52, v52
  v_mfma_f32_16x16x32_bf16 a[96:99], a[180:183], v[96:99], a[96:99]
  ds_read_b128 a[140:143], v215 offset:16384
  v_mfma_f32_16x16x32_bf16 a[100:103], a[180:183], v[104:107], a[100:103]
  v_exp_f32 v53, v53
  v_mfma_f32_16x16x32_bf16 a[100:103], a[176:179], v[72:75], a[100:103]
  v_cvt_pk_bf16_f32 v50, v52, v53
  v_mfma_f32_16x16x32_bf16 a[104:107], a[176:179], v[80:83], a[104:107]
  v_exp_f32 v54, v54
  v_mfma_f32_16x16x32_bf16 a[104:107], a[180:183], v[112:115], a[104:107]
  v_mfma_f32_16x16x32_bf16 a[108:111], a[180:183], v[120:123], a[108:111]
  s_waitcnt lgkmcnt(4)
  v_exp_f32 v55, v55
  v_mfma_f32_16x16x32_bf16 a[108:111], a[176:179], v[88:91], a[108:111]
  v_cvt_pk_bf16_f32 v51, v54, v55
  v_mfma_f32_16x16x32_bf16 a[112:115], a[184:187], v[64:67], a[112:115]
  v_exp_f32 v60, v60
  v_mfma_f32_16x16x32_bf16 a[112:115], a[188:191], v[96:99], a[112:115]
  v_mfma_f32_16x16x32_bf16 a[116:119], a[188:191], v[104:107], a[116:119]
  v_exp_f32 v61, v61
  v_mfma_f32_16x16x32_bf16 a[116:119], a[184:187], v[72:75], a[116:119]
  v_cvt_pk_bf16_f32 v58, v60, v61
  v_mfma_f32_16x16x32_bf16 a[120:123], a[184:187], v[80:83], a[120:123]
  v_exp_f32 v62, v62
  v_mfma_f32_16x16x32_bf16 a[120:123], a[188:191], v[112:115], a[120:123]
  v_mfma_f32_16x16x32_bf16 a[124:127], a[188:191], v[120:123], a[124:127]
  s_waitcnt lgkmcnt(0)
  v_exp_f32 v63, v63
  v_mfma_f32_16x16x32_bf16 a[124:127], a[184:187], v[88:91], a[124:127]
  v_cvt_pk_bf16_f32 v59, v62, v63
  v_mfma_f32_16x16x32_bf16 v[64:67], a[128:131], v[128:131], v[192:195]
  s_add_u32 m0, s28, 98304
  v_mfma_f32_16x16x32_bf16 v[64:67], a[132:135], v[132:135], v[64:67]
  ds_read_b128 a[144:147], v212 offset:20480
  v_mfma_f32_16x16x32_bf16 v[64:67], a[136:139], v[136:139], v[64:67]
  buffer_load_dwordx4 v236, s[16:19], s29 offen offset:0 lds
  v_mfma_f32_16x16x32_bf16 v[64:67], a[140:143], v[140:143], v[64:67]
  ds_read_b128 a[148:151], v213 offset:20480
  v_mfma_f32_16x16x32_bf16 v[72:75], a[140:143], v[156:159], v[196:199]
  v_mfma_f32_16x16x32_bf16 v[72:75], a[136:139], v[152:155], v[72:75]
  ds_read_b128 a[152:155], v214 offset:20480
  v_mfma_f32_16x16x32_bf16 v[72:75], a[132:135], v[148:151], v[72:75]
  buffer_load_dwordx4 v237, s[16:19], s29 offen offset:1024 lds
  v_mfma_f32_16x16x32_bf16 v[72:75], a[128:131], v[144:147], v[72:75]
  ds_read_b128 a[156:159], v215 offset:20480
  v_mfma_f32_16x16x32_bf16 v[80:83], a[128:131], v[160:163], v[200:203]
  v_exp_f32 v64, v64
  v_mfma_f32_16x16x32_bf16 v[80:83], a[132:135], v[164:167], v[80:83]
  v_mfma_f32_16x16x32_bf16 v[80:83], a[136:139], v[168:171], v[80:83]
  v_exp_f32 v65, v65
  v_mfma_f32_16x16x32_bf16 v[80:83], a[140:143], v[172:175], v[80:83]
  v_cvt_pk_bf16_f32 v64, v64, v65
  v_mfma_f32_16x16x32_bf16 v[88:91], a[140:143], v[188:191], v[204:207]
  v_exp_f32 v66, v66
  v_mfma_f32_16x16x32_bf16 v[88:91], a[136:139], v[184:187], v[88:91]
  buffer_load_dwordx4 v236, s[16:19], s29 offen offset:2048 lds
  v_mfma_f32_16x16x32_bf16 v[88:91], a[132:135], v[180:183], v[88:91]
  s_waitcnt lgkmcnt(0)
  v_exp_f32 v67, v67
  v_mfma_f32_16x16x32_bf16 v[88:91], a[128:131], v[176:179], v[88:91]
  v_cvt_pk_bf16_f32 v65, v66, v67
  v_mfma_f32_16x16x32_bf16 v[68:71], a[144:147], v[128:131], v[192:195]
  v_exp_f32 v72, v72
  v_mfma_f32_16x16x32_bf16 v[68:71], a[148:151], v[132:135], v[68:71]
  ds_read_b128 a[128:131], v212 offset:24576
  v_mfma_f32_16x16x32_bf16 v[68:71], a[152:155], v[136:139], v[68:71]
  v_exp_f32 v73, v73
  v_mfma_f32_16x16x32_bf16 v[68:71], a[156:159], v[140:143], v[68:71]
  ds_read_b128 a[132:135], v213 offset:24576
  v_cvt_pk_bf16_f32 v72, v72, v73
  v_mfma_f32_16x16x32_bf16 v[76:79], a[156:159], v[156:159], v[196:199]
  v_exp_f32 v74, v74
  v_mfma_f32_16x16x32_bf16 v[76:79], a[152:155], v[152:155], v[76:79]
  ds_read_b128 a[136:139], v214 offset:24576
  v_mfma_f32_16x16x32_bf16 v[76:79], a[148:151], v[148:151], v[76:79]
  v_exp_f32 v75, v75
  v_mfma_f32_16x16x32_bf16 v[76:79], a[144:147], v[144:147], v[76:79]
  ds_read_b128 a[140:143], v215 offset:24576
  v_cvt_pk_bf16_f32 v73, v74, v75
  v_mfma_f32_16x16x32_bf16 v[84:87], a[144:147], v[160:163], v[200:203]
  v_exp_f32 v80, v80
  v_mfma_f32_16x16x32_bf16 v[84:87], a[148:151], v[164:167], v[84:87]
  buffer_load_dwordx4 v237, s[16:19], s29 offen offset:3072 lds
  v_mfma_f32_16x16x32_bf16 v[84:87], a[152:155], v[168:171], v[84:87]
  s_add_u32 s29, s29, 16384
  v_exp_f32 v81, v81
  v_mfma_f32_16x16x32_bf16 v[84:87], a[156:159], v[172:175], v[84:87]
  v_cvt_pk_bf16_f32 v80, v80, v81
  v_mfma_f32_16x16x32_bf16 v[92:95], a[156:159], v[188:191], v[204:207]
  s_add_u32 m0, s28, 49152
  v_exp_f32 v82, v82
  v_mfma_f32_16x16x32_bf16 v[92:95], a[152:155], v[184:187], v[92:95]
  buffer_load_dwordx4 v232, s[12:15], s29 offen offset:0 lds
  v_mfma_f32_16x16x32_bf16 v[92:95], a[148:151], v[180:183], v[92:95]
  s_waitcnt lgkmcnt(0)
  v_exp_f32 v83, v83
  v_mfma_f32_16x16x32_bf16 v[92:95], a[144:147], v[176:179], v[92:95]
  v_cvt_pk_bf16_f32 v81, v82, v83
  v_mfma_f32_16x16x32_bf16 v[96:99], a[128:131], v[128:131], v[192:195]
  v_exp_f32 v88, v88
  v_mfma_f32_16x16x32_bf16 v[96:99], a[132:135], v[132:135], v[96:99]
  ds_read_b128 a[144:147], v212 offset:28672
  v_mfma_f32_16x16x32_bf16 v[96:99], a[136:139], v[136:139], v[96:99]
  v_exp_f32 v89, v89
  v_mfma_f32_16x16x32_bf16 v[96:99], a[140:143], v[140:143], v[96:99]
  ds_read_b128 a[148:151], v213 offset:28672
  v_cvt_pk_bf16_f32 v88, v88, v89
  v_mfma_f32_16x16x32_bf16 v[104:107], a[140:143], v[156:159], v[196:199]
  v_exp_f32 v90, v90
  v_mfma_f32_16x16x32_bf16 v[104:107], a[136:139], v[152:155], v[104:107]
  ds_read_b128 a[152:155], v214 offset:28672
  v_mfma_f32_16x16x32_bf16 v[104:107], a[132:135], v[148:151], v[104:107]
  v_exp_f32 v91, v91
  v_mfma_f32_16x16x32_bf16 v[104:107], a[128:131], v[144:147], v[104:107]
  ds_read_b128 a[156:159], v215 offset:28672
  v_cvt_pk_bf16_f32 v89, v90, v91
  v_mfma_f32_16x16x32_bf16 v[112:115], a[128:131], v[160:163], v[200:203]
  v_exp_f32 v68, v68
  v_mfma_f32_16x16x32_bf16 v[112:115], a[132:135], v[164:167], v[112:115]
  buffer_load_dwordx4 v233, s[12:15], s29 offen offset:1024 lds
  v_mfma_f32_16x16x32_bf16 v[112:115], a[136:139], v[168:171], v[112:115]
  v_exp_f32 v69, v69
  v_mfma_f32_16x16x32_bf16 v[112:115], a[140:143], v[172:175], v[112:115]
  v_cvt_pk_bf16_f32 v66, v68, v69
  v_mfma_f32_16x16x32_bf16 v[120:123], a[140:143], v[188:191], v[204:207]
  v_exp_f32 v70, v70
  v_mfma_f32_16x16x32_bf16 v[120:123], a[136:139], v[184:187], v[120:123]
  buffer_load_dwordx4 v234, s[12:15], s29 offen offset:2048 lds
  v_mfma_f32_16x16x32_bf16 v[120:123], a[132:135], v[180:183], v[120:123]
  s_waitcnt lgkmcnt(0)
  v_exp_f32 v71, v71
  v_mfma_f32_16x16x32_bf16 v[120:123], a[128:131], v[176:179], v[120:123]
  v_cvt_pk_bf16_f32 v67, v70, v71
  v_mfma_f32_16x16x32_bf16 v[100:103], a[144:147], v[128:131], v[192:195]
  v_exp_f32 v76, v76
  v_mfma_f32_16x16x32_bf16 v[100:103], a[148:151], v[132:135], v[100:103]
  ds_read_b64_tr_b16 a[160:161], v216 offset:0
  v_mfma_f32_16x16x32_bf16 v[100:103], a[152:155], v[136:139], v[100:103]
  v_exp_f32 v77, v77
  v_mfma_f32_16x16x32_bf16 v[100:103], a[156:159], v[140:143], v[100:103]
  ds_read_b64_tr_b16 a[162:163], v216 offset:4096
  v_cvt_pk_bf16_f32 v74, v76, v77
  v_mfma_f32_16x16x32_bf16 v[108:111], a[156:159], v[156:159], v[196:199]
  v_exp_f32 v78, v78
  v_mfma_f32_16x16x32_bf16 v[108:111], a[152:155], v[152:155], v[108:111]
  ds_read_b64_tr_b16 a[164:165], v216 offset:8192
  buffer_load_dwordx4 v235, s[12:15], s29 offen offset:3072 lds
  v_mfma_f32_16x16x32_bf16 v[108:111], a[148:151], v[148:151], v[108:111]
  v_exp_f32 v79, v79
  v_mfma_f32_16x16x32_bf16 v[108:111], a[144:147], v[144:147], v[108:111]
  ds_read_b64_tr_b16 a[166:167], v216 offset:12288
  v_cvt_pk_bf16_f32 v75, v78, v79
  v_mfma_f32_16x16x32_bf16 v[116:119], a[144:147], v[160:163], v[200:203]
  s_add_u32 m0, s50, 5120
  v_exp_f32 v84, v84
  v_mfma_f32_16x16x32_bf16 v[116:119], a[148:151], v[164:167], v[116:119]
  ds_read_b64_tr_b16 a[168:169], v217 offset:0
  buffer_load_dwordx4 v208, s[20:23], s30 offen lds
  s_add_u32 s30, s30, 32
  v_mfma_f32_16x16x32_bf16 v[116:119], a[152:155], v[168:171], v[116:119]
  v_exp_f32 v85, v85
  v_mfma_f32_16x16x32_bf16 v[116:119], a[156:159], v[172:175], v[116:119]
  ds_read_b64_tr_b16 a[170:171], v217 offset:4096
  v_cvt_pk_bf16_f32 v82, v84, v85
  v_mfma_f32_16x16x32_bf16 v[124:127], a[156:159], v[188:191], v[204:207]
  v_exp_f32 v86, v86
  v_mfma_f32_16x16x32_bf16 v[124:127], a[152:155], v[184:187], v[124:127]
  ds_read_b64_tr_b16 a[172:173], v217 offset:8192
  v_mfma_f32_16x16x32_bf16 v[124:127], a[148:151], v[180:183], v[124:127]
  v_exp_f32 v87, v87
  v_mfma_f32_16x16x32_bf16 v[124:127], a[144:147], v[176:179], v[124:127]
  ds_read_b64_tr_b16 a[174:175], v217 offset:12288
  v_cvt_pk_bf16_f32 v83, v86, v87
  v_mfma_f32_16x16x32_bf16 a[192:195], a[208:211], v[0:3], a[192:195]
  v_exp_f32 v92, v92
  v_mfma_f32_16x16x32_bf16 a[192:195], a[208:211], v[32:35], a[192:195]
  ds_read_b64_tr_b16 a[176:177], v218 offset:0
  v_mfma_f32_16x16x32_bf16 a[196:199], a[208:211], v[8:11], a[196:199]
  v_exp_f32 v93, v93
  v_mfma_f32_16x16x32_bf16 a[196:199], a[208:211], v[40:43], a[196:199]
  ds_read_b64_tr_b16 a[178:179], v218 offset:4096
  v_cvt_pk_bf16_f32 v90, v92, v93
  v_mfma_f32_16x16x32_bf16 a[200:203], a[208:211], v[16:19], a[200:203]
  v_exp_f32 v94, v94
  v_mfma_f32_16x16x32_bf16 a[200:203], a[208:211], v[48:51], a[200:203]
  ds_read_b64_tr_b16 a[180:181], v218 offset:8192
  v_mfma_f32_16x16x32_bf16 a[204:207], a[208:211], v[24:27], a[204:207]
  s_waitcnt lgkmcnt(7)
  v_exp_f32 v95, v95
  v_mfma_f32_16x16x32_bf16 a[204:207], a[208:211], v[56:59], a[204:207]
  ds_read_b64_tr_b16 a[182:183], v218 offset:12288
  v_cvt_pk_bf16_f32 v91, v94, v95
  v_mfma_f32_16x16x32_bf16 a[0:3], a[160:163], v[0:3], a[0:3]
  v_exp_f32 v96, v96
  v_mfma_f32_16x16x32_bf16 a[0:3], a[164:167], v[32:35], a[0:3]
  ds_read_b64_tr_b16 a[184:185], v219 offset:0
  v_mfma_f32_16x16x32_bf16 a[4:7], a[164:167], v[40:43], a[4:7]
  v_exp_f32 v97, v97
  v_mfma_f32_16x16x32_bf16 a[4:7], a[160:163], v[8:11], a[4:7]
  ds_read_b64_tr_b16 a[186:187], v219 offset:4096
  v_cvt_pk_bf16_f32 v96, v96, v97
  v_mfma_f32_16x16x32_bf16 a[8:11], a[160:163], v[16:19], a[8:11]
  v_exp_f32 v98, v98
  v_mfma_f32_16x16x32_bf16 a[8:11], a[164:167], v[48:51], a[8:11]
  ds_read_b64_tr_b16 a[188:189], v219 offset:8192
  v_mfma_f32_16x16x32_bf16 a[12:15], a[164:167], v[56:59], a[12:15]
  s_waitcnt lgkmcnt(7)
  v_exp_f32 v99, v99
  v_mfma_f32_16x16x32_bf16 a[12:15], a[160:163], v[24:27], a[12:15]
  ds_read_b64_tr_b16 a[190:191], v219 offset:12288
  v_cvt_pk_bf16_f32 v97, v98, v99
  v_mfma_f32_16x16x32_bf16 a[16:19], a[168:171], v[0:3], a[16:19]
  v_exp_f32 v104, v104
  v_mfma_f32_16x16x32_bf16 a[16:19], a[172:175], v[32:35], a[16:19]
  ds_read_b64_tr_b16 a[160:161], v220 offset:0
  v_mfma_f32_16x16x32_bf16 a[20:23], a[172:175], v[40:43], a[20:23]
  v_exp_f32 v105, v105
  v_mfma_f32_16x16x32_bf16 a[20:23], a[168:171], v[8:11], a[20:23]
  ds_read_b64_tr_b16 a[162:163], v220 offset:4096
  v_cvt_pk_bf16_f32 v104, v104, v105
  v_mfma_f32_16x16x32_bf16 a[24:27], a[168:171], v[16:19], a[24:27]
  v_exp_f32 v106, v106
  v_mfma_f32_16x16x32_bf16 a[24:27], a[172:175], v[48:51], a[24:27]
  ds_read_b64_tr_b16 a[164:165], v220 offset:8192
  v_mfma_f32_16x16x32_bf16 a[28:31], a[172:175], v[56:59], a[28:31]
  s_waitcnt lgkmcnt(7)
  v_exp_f32 v107, v107
  v_mfma_f32_16x16x32_bf16 a[28:31], a[168:171], v[24:27], a[28:31]
  ds_read_b64_tr_b16 a[166:167], v220 offset:12288
  v_cvt_pk_bf16_f32 v105, v106, v107
  v_mfma_f32_16x16x32_bf16 a[32:35], a[176:179], v[0:3], a[32:35]
  v_exp_f32 v112, v112
  v_mfma_f32_16x16x32_bf16 a[32:35], a[180:183], v[32:35], a[32:35]
  ds_read_b64_tr_b16 a[168:169], v221 offset:0
  v_mfma_f32_16x16x32_bf16 a[36:39], a[180:183], v[40:43], a[36:39]
  v_exp_f32 v113, v113
  v_mfma_f32_16x16x32_bf16 a[36:39], a[176:179], v[8:11], a[36:39]
  ds_read_b64_tr_b16 a[170:171], v221 offset:4096
  v_cvt_pk_bf16_f32 v112, v112, v113
  v_mfma_f32_16x16x32_bf16 a[40:43], a[176:179], v[16:19], a[40:43]
  v_exp_f32 v114, v114
  v_mfma_f32_16x16x32_bf16 a[40:43], a[180:183], v[48:51], a[40:43]
  ds_read_b64_tr_b16 a[172:173], v221 offset:8192
  v_mfma_f32_16x16x32_bf16 a[44:47], a[180:183], v[56:59], a[44:47]
  s_waitcnt lgkmcnt(7)
  v_exp_f32 v115, v115
  v_mfma_f32_16x16x32_bf16 a[44:47], a[176:179], v[24:27], a[44:47]
  ds_read_b64_tr_b16 a[174:175], v221 offset:12288
  v_cvt_pk_bf16_f32 v113, v114, v115
  v_mfma_f32_16x16x32_bf16 a[48:51], a[184:187], v[0:3], a[48:51]
  v_exp_f32 v120, v120
  v_mfma_f32_16x16x32_bf16 a[48:51], a[188:191], v[32:35], a[48:51]
  ds_read_b64_tr_b16 a[176:177], v222 offset:0
  v_mfma_f32_16x16x32_bf16 a[52:55], a[188:191], v[40:43], a[52:55]
  v_exp_f32 v121, v121
  v_mfma_f32_16x16x32_bf16 a[52:55], a[184:187], v[8:11], a[52:55]
  ds_read_b64_tr_b16 a[178:179], v222 offset:4096
  v_cvt_pk_bf16_f32 v120, v120, v121
  v_mfma_f32_16x16x32_bf16 a[56:59], a[184:187], v[16:19], a[56:59]
  v_exp_f32 v122, v122
  v_mfma_f32_16x16x32_bf16 a[56:59], a[188:191], v[48:51], a[56:59]
  ds_read_b64_tr_b16 a[180:181], v222 offset:8192
  v_mfma_f32_16x16x32_bf16 a[60:63], a[188:191], v[56:59], a[60:63]
  s_waitcnt lgkmcnt(7)
  v_exp_f32 v123, v123
  v_mfma_f32_16x16x32_bf16 a[60:63], a[184:187], v[24:27], a[60:63]
  ds_read_b64_tr_b16 a[182:183], v222 offset:12288
  v_cvt_pk_bf16_f32 v121, v122, v123
  v_mfma_f32_16x16x32_bf16 a[64:67], a[160:163], v[0:3], a[64:67]
  v_exp_f32 v100, v100
  v_mfma_f32_16x16x32_bf16 a[64:67], a[164:167], v[32:35], a[64:67]
  ds_read_b64_tr_b16 a[184:185], v223 offset:0
  v_mfma_f32_16x16x32_bf16 a[68:71], a[164:167], v[40:43], a[68:71]
  v_exp_f32 v101, v101
  v_mfma_f32_16x16x32_bf16 a[68:71], a[160:163], v[8:11], a[68:71]
  ds_read_b64_tr_b16 a[186:187], v223 offset:4096
  v_cvt_pk_bf16_f32 v98, v100, v101
  v_mfma_f32_16x16x32_bf16 a[72:75], a[160:163], v[16:19], a[72:75]
  v_exp_f32 v102, v102
  v_mfma_f32_16x16x32_bf16 a[72:75], a[164:167], v[48:51], a[72:75]
  ds_read_b64_tr_b16 a[188:189], v223 offset:8192
  v_mfma_f32_16x16x32_bf16 a[76:79], a[164:167], v[56:59], a[76:79]
  s_waitcnt lgkmcnt(7)
  v_exp_f32 v103, v103
  v_mfma_f32_16x16x32_bf16 a[76:79], a[160:163], v[24:27], a[76:79]
  ds_read_b64_tr_b16 a[190:191], v223 offset:12288
  v_cvt_pk_bf16_f32 v99, v102, v103
  v_mfma_f32_16x16x32_bf16 a[80:83], a[168:171], v[0:3], a[80:83]
  s_waitcnt vmcnt(11)
  v_exp_f32 v108, v108
  v_mfma_f32_16x16x32_bf16 a[80:83], a[172:175], v[32:35], a[80:83]
  v_mfma_f32_16x16x32_bf16 a[84:87], a[172:175], v[40:43], a[84:87]
  s_barrier
  v_exp_f32 v109, v109
  v_mfma_f32_16x16x32_bf16 a[84:87], a[168:171], v[8:11], a[84:87]
  ds_read_b128 a[128:131], v212 offset:32768
  v_cvt_pk_bf16_f32 v106, v108, v109
  v_mfma_f32_16x16x32_bf16 a[88:91], a[168:171], v[16:19], a[88:91]
  v_exp_f32 v110, v110
  v_mfma_f32_16x16x32_bf16 a[88:91], a[172:175], v[48:51], a[88:91]
  ds_read_b128 a[132:135], v213 offset:32768
  buffer_atomic_add v250, v249, s[24:27], s47 offen
  s_cmp_eq_u32 s32, 3
  s_cselect_b32 s39, 0, 1073741824
  v_mfma_f32_16x16x32_bf16 a[92:95], a[172:175], v[56:59], a[92:95]
  s_waitcnt lgkmcnt(6)
  v_exp_f32 v111, v111
  v_mfma_f32_16x16x32_bf16 a[92:95], a[168:171], v[24:27], a[92:95]
  ds_read_b128 a[136:139], v214 offset:32768
  v_cvt_pk_bf16_f32 v107, v110, v111
  v_mfma_f32_16x16x32_bf16 a[96:99], a[176:179], v[0:3], a[96:99]
  v_exp_f32 v116, v116
  v_mfma_f32_16x16x32_bf16 a[96:99], a[180:183], v[32:35], a[96:99]
  ds_read_b128 a[140:143], v215 offset:32768
  v_or_b32 v249, s39, v251
  v_mfma_f32_16x16x32_bf16 a[100:103], a[180:183], v[40:43], a[100:103]
  v_exp_f32 v117, v117
  v_mfma_f32_16x16x32_bf16 a[100:103], a[176:179], v[8:11], a[100:103]
  v_cvt_pk_bf16_f32 v114, v116, v117
  v_mfma_f32_16x16x32_bf16 a[104:107], a[176:179], v[16:19], a[104:107]
  v_exp_f32 v118, v118
  v_mfma_f32_16x16x32_bf16 a[104:107], a[180:183], v[48:51], a[104:107]
  v_mfma_f32_16x16x32_bf16 a[108:111], a[180:183], v[56:59], a[108:111]
  s_waitcnt lgkmcnt(4)
  v_exp_f32 v119, v119
  v_mfma_f32_16x16x32_bf16 a[108:111], a[176:179], v[24:27], a[108:111]
  v_cvt_pk_bf16_f32 v115, v118, v119
  v_mfma_f32_16x16x32_bf16 a[112:115], a[184:187], v[0:3], a[112:115]
  v_exp_f32 v124, v124
  v_mfma_f32_16x16x32_bf16 a[112:115], a[188:191], v[32:35], a[112:115]
  v_mfma_f32_16x16x32_bf16 a[116:119], a[188:191], v[40:43], a[116:119]
  v_exp_f32 v125, v125
  v_mfma_f32_16x16x32_bf16 a[116:119], a[184:187], v[8:11], a[116:119]
  v_cvt_pk_bf16_f32 v122, v124, v125
  v_mfma_f32_16x16x32_bf16 a[120:123], a[184:187], v[16:19], a[120:123]
  v_exp_f32 v126, v126
  v_mfma_f32_16x16x32_bf16 a[120:123], a[188:191], v[48:51], a[120:123]
  v_mfma_f32_16x16x32_bf16 a[124:127], a[188:191], v[56:59], a[124:127]
  s_waitcnt lgkmcnt(0)
  v_exp_f32 v127, v127
  v_mfma_f32_16x16x32_bf16 a[124:127], a[184:187], v[24:27], a[124:127]
  v_cvt_pk_bf16_f32 v123, v126, v127
  v_mfma_f32_16x16x32_bf16 v[0:3], a[128:131], v[128:131], v[192:195]
  s_add_u32 m0, s28, 114688
  v_mfma_f32_16x16x32_bf16 v[0:3], a[132:135], v[132:135], v[0:3]
  ds_read_b128 a[144:147], v212 offset:36864
  v_mfma_f32_16x16x32_bf16 v[0:3], a[136:139], v[136:139], v[0:3]
  buffer_load_dwordx4 v236, s[16:19], s29 offen offset:0 lds
  v_mfma_f32_16x16x32_bf16 v[0:3], a[140:143], v[140:143], v[0:3]
  ds_read_b128 a[148:151], v213 offset:36864
  v_mfma_f32_16x16x32_bf16 v[8:11], a[140:143], v[156:159], v[196:199]
  v_mfma_f32_16x16x32_bf16 v[8:11], a[136:139], v[152:155], v[8:11]
  ds_read_b128 a[152:155], v214 offset:36864
  v_mfma_f32_16x16x32_bf16 v[8:11], a[132:135], v[148:151], v[8:11]
  buffer_load_dwordx4 v237, s[16:19], s29 offen offset:1024 lds
  v_mfma_f32_16x16x32_bf16 v[8:11], a[128:131], v[144:147], v[8:11]
  ds_read_b128 a[156:159], v215 offset:36864
  v_mfma_f32_16x16x32_bf16 v[16:19], a[128:131], v[160:163], v[200:203]
  v_exp_f32 v0, v0
  v_mfma_f32_16x16x32_bf16 v[16:19], a[132:135], v[164:167], v[16:19]
  v_mfma_f32_16x16x32_bf16 v[16:19], a[136:139], v[168:171], v[16:19]
  v_exp_f32 v1, v1
  v_mfma_f32_16x16x32_bf16 v[16:19], a[140:143], v[172:175], v[16:19]
  v_cvt_pk_bf16_f32 v0, v0, v1
  v_mfma_f32_16x16x32_bf16 v[24:27], a[140:143], v[188:191], v[204:207]
  v_exp_f32 v2, v2
  v_mfma_f32_16x16x32_bf16 v[24:27], a[136:139], v[184:187], v[24:27]
  buffer_load_dwordx4 v236, s[16:19], s29 offen offset:2048 lds
  v_mfma_f32_16x16x32_bf16 v[24:27], a[132:135], v[180:183], v[24:27]
  s_waitcnt lgkmcnt(0)
  v_exp_f32 v3, v3
  v_mfma_f32_16x16x32_bf16 v[24:27], a[128:131], v[176:179], v[24:27]
  v_cvt_pk_bf16_f32 v1, v2, v3
  v_mfma_f32_16x16x32_bf16 v[4:7], a[144:147], v[128:131], v[192:195]
  v_exp_f32 v8, v8
  v_mfma_f32_16x16x32_bf16 v[4:7], a[148:151], v[132:135], v[4:7]
  ds_read_b128 a[128:131], v212 offset:40960
  v_mfma_f32_16x16x32_bf16 v[4:7], a[152:155], v[136:139], v[4:7]
  v_exp_f32 v9, v9
  v_mfma_f32_16x16x32_bf16 v[4:7], a[156:159], v[140:143], v[4:7]
  ds_read_b128 a[132:135], v213 offset:40960
  v_cvt_pk_bf16_f32 v8, v8, v9
  v_mfma_f32_16x16x32_bf16 v[12:15], a[156:159], v[156:159], v[196:199]
  v_exp_f32 v10, v10
  v_mfma_f32_16x16x32_bf16 v[12:15], a[152:155], v[152:155], v[12:15]
  ds_read_b128 a[136:139], v214 offset:40960
  v_mfma_f32_16x16x32_bf16 v[12:15], a[148:151], v[148:151], v[12:15]
  v_exp_f32 v11, v11
  v_mfma_f32_16x16x32_bf16 v[12:15], a[144:147], v[144:147], v[12:15]
  ds_read_b128 a[140:143], v215 offset:40960
  v_cvt_pk_bf16_f32 v9, v10, v11
  v_mfma_f32_16x16x32_bf16 v[20:23], a[144:147], v[160:163], v[200:203]
  v_exp_f32 v16, v16
  v_mfma_f32_16x16x32_bf16 v[20:23], a[148:151], v[164:167], v[20:23]
  buffer_load_dwordx4 v237, s[16:19], s29 offen offset:3072 lds
  v_mfma_f32_16x16x32_bf16 v[20:23], a[152:155], v[168:171], v[20:23]
  s_add_u32 s29, s29, 16384
  v_exp_f32 v17, v17
  v_mfma_f32_16x16x32_bf16 v[20:23], a[156:159], v[172:175], v[20:23]
  v_cvt_pk_bf16_f32 v16, v16, v17
  v_mfma_f32_16x16x32_bf16 v[28:31], a[156:159], v[188:191], v[204:207]
  s_add_u32 m0, s28, 0
  v_exp_f32 v18, v18
  v_mfma_f32_16x16x32_bf16 v[28:31], a[152:155], v[184:187], v[28:31]
  buffer_load_dwordx4 v232, s[12:15], s29 offen offset:0 lds
  v_mfma_f32_16x16x32_bf16 v[28:31], a[148:151], v[180:183], v[28:31]
  s_waitcnt lgkmcnt(0)
  v_exp_f32 v19, v19
  v_mfma_f32_16x16x32_bf16 v[28:31], a[144:147], v[176:179], v[28:31]
  v_cvt_pk_bf16_f32 v17, v18, v19
  v_mfma_f32_16x16x32_bf16 v[32:35], a[128:131], v[128:131], v[192:195]
  v_exp_f32 v24, v24
  v_mfma_f32_16x16x32_bf16 v[32:35], a[132:135], v[132:135], v[32:35]
  ds_read_b128 a[144:147], v212 offset:45056
  v_mfma_f32_16x16x32_bf16 v[32:35], a[136:139], v[136:139], v[32:35]
  v_exp_f32 v25, v25
  v_mfma_f32_16x16x32_bf16 v[32:35], a[140:143], v[140:143], v[32:35]
  ds_read_b128 a[148:151], v213 offset:45056
  v_cvt_pk_bf16_f32 v24, v24, v25
  v_mfma_f32_16x16x32_bf16 v[40:43], a[140:143], v[156:159], v[196:199]
  v_exp_f32 v26, v26
  v_mfma_f32_16x16x32_bf16 v[40:43], a[136:139], v[152:155], v[40:43]
  ds_read_b128 a[152:155], v214 offset:45056
  v_mfma_f32_16x16x32_bf16 v[40:43], a[132:135], v[148:151], v[40:43]
  v_exp_f32 v27, v27
  v_mfma_f32_16x16x32_bf16 v[40:43], a[128:131], v[144:147], v[40:43]
  ds_read_b128 a[156:159], v215 offset:45056
  v_cvt_pk_bf16_f32 v25, v26, v27
  v_mfma_f32_16x16x32_bf16 v[48:51], a[128:131], v[160:163], v[200:203]
  v_exp_f32 v4, v4
  v_mfma_f32_16x16x32_bf16 v[48:51], a[132:135], v[164:167], v[48:51]
  buffer_load_dwordx4 v233, s[12:15], s29 offen offset:1024 lds
  v_mfma_f32_16x16x32_bf16 v[48:51], a[136:139], v[168:171], v[48:51]
  v_exp_f32 v5, v5
  v_mfma_f32_16x16x32_bf16 v[48:51], a[140:143], v[172:175], v[48:51]
  v_cvt_pk_bf16_f32 v2, v4, v5
  v_mfma_f32_16x16x32_bf16 v[56:59], a[140:143], v[188:191], v[204:207]
  v_exp_f32 v6, v6
  v_mfma_f32_16x16x32_bf16 v[56:59], a[136:139], v[184:187], v[56:59]
  buffer_load_dwordx4 v234, s[12:15], s29 offen offset:2048 lds
  v_mfma_f32_16x16x32_bf16 v[56:59], a[132:135], v[180:183], v[56:59]
  s_waitcnt lgkmcnt(0)
  v_exp_f32 v7, v7
  v_mfma_f32_16x16x32_bf16 v[56:59], a[128:131], v[176:179], v[56:59]
  v_cvt_pk_bf16_f32 v3, v6, v7
  v_mfma_f32_16x16x32_bf16 v[36:39], a[144:147], v[128:131], v[192:195]
  v_exp_f32 v12, v12
  v_mfma_f32_16x16x32_bf16 v[36:39], a[148:151], v[132:135], v[36:39]
  ds_read_b64_tr_b16 a[160:161], v216 offset:16384
  v_mfma_f32_16x16x32_bf16 v[36:39], a[152:155], v[136:139], v[36:39]
  v_exp_f32 v13, v13
  v_mfma_f32_16x16x32_bf16 v[36:39], a[156:159], v[140:143], v[36:39]
  ds_read_b64_tr_b16 a[162:163], v216 offset:20480
  v_cvt_pk_bf16_f32 v10, v12, v13
  v_mfma_f32_16x16x32_bf16 v[44:47], a[156:159], v[156:159], v[196:199]
  v_exp_f32 v14, v14
  v_mfma_f32_16x16x32_bf16 v[44:47], a[152:155], v[152:155], v[44:47]
  ds_read_b64_tr_b16 a[164:165], v216 offset:24576
  buffer_load_dwordx4 v235, s[12:15], s29 offen offset:3072 lds
  v_mfma_f32_16x16x32_bf16 v[44:47], a[148:151], v[148:151], v[44:47]
  v_exp_f32 v15, v15
  v_mfma_f32_16x16x32_bf16 v[44:47], a[144:147], v[144:147], v[44:47]
  ds_read_b64_tr_b16 a[166:167], v216 offset:28672
  v_cvt_pk_bf16_f32 v11, v14, v15
  v_mfma_f32_16x16x32_bf16 v[52:55], a[144:147], v[160:163], v[200:203]
  s_mov_b32 m0, s51
  v_exp_f32 v20, v20
  v_mfma_f32_16x16x32_bf16 v[52:55], a[148:151], v[164:167], v[52:55]
  ds_read_b64_tr_b16 a[168:169], v217 offset:16384
  buffer_load_dwordx4 v210, s[4:7], s100 offen lds
  s_add_u32 s100, s100, 20480
  s_add_u32 s51, s51, 512
  v_mfma_f32_16x16x32_bf16 v[52:55], a[152:155], v[168:171], v[52:55]
  v_exp_f32 v21, v21
  v_mfma_f32_16x16x32_bf16 v[52:55], a[156:159], v[172:175], v[52:55]
  ds_read_b64_tr_b16 a[170:171], v217 offset:20480
  v_cvt_pk_bf16_f32 v18, v20, v21
  v_mfma_f32_16x16x32_bf16 v[60:63], a[156:159], v[188:191], v[204:207]
  s_waitcnt vmcnt(20)
  v_exp_f32 v22, v22
  v_mfma_f32_16x16x32_bf16 v[60:63], a[152:155], v[184:187], v[60:63]
  ds_read_b64_tr_b16 a[172:173], v217 offset:24576
  ds_read_b64_tr_b16 a[232:233], v209 offset:4096
  v_mfma_f32_16x16x32_bf16 v[60:63], a[148:151], v[180:183], v[60:63]
  v_exp_f32 v23, v23
  v_mfma_f32_16x16x32_bf16 v[60:63], a[144:147], v[176:179], v[60:63]
  ds_read_b64_tr_b16 a[174:175], v217 offset:28672
  v_cvt_pk_bf16_f32 v19, v22, v23
  v_mfma_f32_16x16x32_bf16 a[192:195], a[208:211], v[64:67], a[192:195]
  v_exp_f32 v28, v28
  v_mfma_f32_16x16x32_bf16 a[192:195], a[208:211], v[96:99], a[192:195]
  ds_read_b64_tr_b16 a[176:177], v218 offset:16384
  ds_read_b64_tr_b16 a[234:235], v209 offset:4608
  v_mfma_f32_16x16x32_bf16 a[196:199], a[208:211], v[72:75], a[196:199]
  v_exp_f32 v29, v29
  v_mfma_f32_16x16x32_bf16 a[196:199], a[208:211], v[104:107], a[196:199]
  ds_read_b64_tr_b16 a[178:179], v218 offset:20480
  v_cvt_pk_bf16_f32 v26, v28, v29
  v_mfma_f32_16x16x32_bf16 a[200:203], a[208:211], v[80:83], a[200:203]
  v_exp_f32 v30, v30
  v_mfma_f32_16x16x32_bf16 a[200:203], a[208:211], v[112:115], a[200:203]
  ds_read_b64_tr_b16 a[180:181], v218 offset:24576
  v_mfma_f32_16x16x32_bf16 a[204:207], a[208:211], v[88:91], a[204:207]
  s_waitcnt lgkmcnt(9)
  v_exp_f32 v31, v31
  v_mfma_f32_16x16x32_bf16 a[204:207], a[208:211], v[120:123], a[204:207]
  ds_read_b64_tr_b16 a[182:183], v218 offset:28672
  v_cvt_pk_bf16_f32 v27, v30, v31
  v_mfma_f32_16x16x32_bf16 a[0:3], a[160:163], v[64:67], a[0:3]
  v_exp_f32 v32, v32
  v_mfma_f32_16x16x32_bf16 a[0:3], a[164:167], v[96:99], a[0:3]
  ds_read_b64_tr_b16 a[184:185], v219 offset:16384
  s_waitcnt lgkmcnt(4)
  buffer_store_dwordx4 a[232:235], v211, s[24:27], s31 offen sc1
  s_add_u32 s31, s31, 1024
  s_cmp_gt_u32 s32, 3
  v_mfma_f32_16x16x32_bf16 a[4:7], a[164:167], v[104:107], a[4:7]
  s_cselect_b32 s39, 0, 1073741824
  v_exp_f32 v33, v33
  v_mfma_f32_16x16x32_bf16 a[4:7], a[160:163], v[72:75], a[4:7]
  ds_read_b64_tr_b16 a[186:187], v219 offset:20480
  v_cvt_pk_bf16_f32 v32, v32, v33
  v_mfma_f32_16x16x32_bf16 a[8:11], a[160:163], v[80:83], a[8:11]
  v_exp_f32 v34, v34
  v_mfma_f32_16x16x32_bf16 a[8:11], a[164:167], v[112:115], a[8:11]
  ds_read_b64_tr_b16 a[188:189], v219 offset:24576
  v_or_b32 v211, s39, v211
  v_mfma_f32_16x16x32_bf16 a[12:15], a[164:167], v[120:123], a[12:15]
  v_exp_f32 v35, v35
  v_mfma_f32_16x16x32_bf16 a[12:15], a[160:163], v[88:91], a[12:15]
  ds_read_b64_tr_b16 a[190:191], v219 offset:28672
  v_cvt_pk_bf16_f32 v33, v34, v35
  v_mfma_f32_16x16x32_bf16 a[16:19], a[168:171], v[64:67], a[16:19]
  v_exp_f32 v40, v40
  v_mfma_f32_16x16x32_bf16 a[16:19], a[172:175], v[96:99], a[16:19]
  ds_read_b64_tr_b16 a[160:161], v220 offset:16384
  v_or_b32 v208, s39, v208
  v_mfma_f32_16x16x32_bf16 a[20:23], a[172:175], v[104:107], a[20:23]
  v_exp_f32 v41, v41
  v_mfma_f32_16x16x32_bf16 a[20:23], a[168:171], v[72:75], a[20:23]
  ds_read_b64_tr_b16 a[162:163], v220 offset:20480
  v_cvt_pk_bf16_f32 v40, v40, v41
  v_mfma_f32_16x16x32_bf16 a[24:27], a[168:171], v[80:83], a[24:27]
  v_exp_f32 v42, v42
  v_mfma_f32_16x16x32_bf16 a[24:27], a[172:175], v[112:115], a[24:27]
  ds_read_b64_tr_b16 a[164:165], v220 offset:24576
  v_mfma_f32_16x16x32_bf16 a[28:31], a[172:175], v[120:123], a[28:31]
  s_waitcnt lgkmcnt(7)
  v_exp_f32 v43, v43
  v_mfma_f32_16x16x32_bf16 a[28:31], a[168:171], v[88:91], a[28:31]
  ds_read_b64_tr_b16 a[166:167], v220 offset:28672
  v_cvt_pk_bf16_f32 v41, v42, v43
  v_mfma_f32_16x16x32_bf16 a[32:35], a[176:179], v[64:67], a[32:35]
  v_exp_f32 v48, v48
  v_mfma_f32_16x16x32_bf16 a[32:35], a[180:183], v[96:99], a[32:35]
  ds_read_b64_tr_b16 a[168:169], v221 offset:16384
  v_mfma_f32_16x16x32_bf16 a[36:39], a[180:183], v[104:107], a[36:39]
  v_exp_f32 v49, v49
  v_mfma_f32_16x16x32_bf16 a[36:39], a[176:179], v[72:75], a[36:39]
  ds_read_b64_tr_b16 a[170:171], v221 offset:20480
  v_cvt_pk_bf16_f32 v48, v48, v49
  v_mfma_f32_16x16x32_bf16 a[40:43], a[176:179], v[80:83], a[40:43]
  v_exp_f32 v50, v50
  v_mfma_f32_16x16x32_bf16 a[40:43], a[180:183], v[112:115], a[40:43]
  ds_read_b64_tr_b16 a[172:173], v221 offset:24576
  v_mfma_f32_16x16x32_bf16 a[44:47], a[180:183], v[120:123], a[44:47]
  s_waitcnt lgkmcnt(7)
  v_exp_f32 v51, v51
  v_mfma_f32_16x16x32_bf16 a[44:47], a[176:179], v[88:91], a[44:47]
  ds_read_b64_tr_b16 a[174:175], v221 offset:28672
  v_cvt_pk_bf16_f32 v49, v50, v51
  v_mfma_f32_16x16x32_bf16 a[48:51], a[184:187], v[64:67], a[48:51]
  v_exp_f32 v56, v56
  v_mfma_f32_16x16x32_bf16 a[48:51], a[188:191], v[96:99], a[48:51]
  ds_read_b64_tr_b16 a[176:177], v222 offset:16384
  v_mfma_f32_16x16x32_bf16 a[52:55], a[188:191], v[104:107], a[52:55]
  v_exp_f32 v57, v57
  v_mfma_f32_16x16x32_bf16 a[52:55], a[184:187], v[72:75], a[52:55]
  ds_read_b64_tr_b16 a[178:179], v222 offset:20480
  v_cvt_pk_bf16_f32 v56, v56, v57
  v_mfma_f32_16x16x32_bf16 a[56:59], a[184:187], v[80:83], a[56:59]
  v_exp_f32 v58, v58
  v_mfma_f32_16x16x32_bf16 a[56:59], a[188:191], v[112:115], a[56:59]
  ds_read_b64_tr_b16 a[180:181], v222 offset:24576
  v_mfma_f32_16x16x32_bf16 a[60:63], a[188:191], v[120:123], a[60:63]
  s_waitcnt lgkmcnt(7)
  v_exp_f32 v59, v59
  v_mfma_f32_16x16x32_bf16 a[60:63], a[184:187], v[88:91], a[60:63]
  ds_read_b64_tr_b16 a[182:183], v222 offset:28672
  v_cvt_pk_bf16_f32 v57, v58, v59
  v_mfma_f32_16x16x32_bf16 a[64:67], a[160:163], v[64:67], a[64:67]
  v_exp_f32 v36, v36
  v_mfma_f32_16x16x32_bf16 a[64:67], a[164:167], v[96:99], a[64:67]
  ds_read_b64_tr_b16 a[184:185], v223 offset:16384
  v_mfma_f32_16x16x32_bf16 a[68:71], a[164:167], v[104:107], a[68:71]
  v_exp_f32 v37, v37
  v_mfma_f32_16x16x32_bf16 a[68:71], a[160:163], v[72:75], a[68:71]
  ds_read_b64_tr_b16 a[186:187], v223 offset:20480
  v_cvt_pk_bf16_f32 v34, v36, v37
  v_mfma_f32_16x16x32_bf16 a[72:75], a[160:163], v[80:83], a[72:75]
  v_exp_f32 v38, v38
  v_mfma_f32_16x16x32_bf16 a[72:75], a[164:167], v[112:115], a[72:75]
  ds_read_b64_tr_b16 a[188:189], v223 offset:24576
  v_mfma_f32_16x16x32_bf16 a[76:79], a[164:167], v[120:123], a[76:79]
  s_waitcnt lgkmcnt(7)
  v_exp_f32 v39, v39
  v_mfma_f32_16x16x32_bf16 a[76:79], a[160:163], v[88:91], a[76:79]
  ds_read_b64_tr_b16 a[190:191], v223 offset:28672
  v_cvt_pk_bf16_f32 v35, v38, v39
  v_mfma_f32_16x16x32_bf16 a[80:83], a[168:171], v[64:67], a[80:83]
  s_waitcnt vmcnt(12)
  v_exp_f32 v44, v44
  v_mfma_f32_16x16x32_bf16 a[80:83], a[172:175], v[96:99], a[80:83]
  v_mfma_f32_16x16x32_bf16 a[84:87], a[172:175], v[104:107], a[84:87]
  s_barrier
  v_exp_f32 v45, v45
  v_mfma_f32_16x16x32_bf16 a[84:87], a[168:171], v[72:75], a[84:87]
  ds_read_b128 a[128:131], v212 offset:49152
  v_cvt_pk_bf16_f32 v42, v44, v45
  v_mfma_f32_16x16x32_bf16 a[88:91], a[168:171], v[80:83], a[88:91]
  v_exp_f32 v46, v46
  v_mfma_f32_16x16x32_bf16 a[88:91], a[172:175], v[112:115], a[88:91]
  ds_read_b128 a[132:135], v213 offset:49152
  v_mfma_f32_16x16x32_bf16 a[92:95], a[172:175], v[120:123], a[92:95]
  s_waitcnt lgkmcnt(6)
  v_exp_f32 v47, v47
  v_mfma_f32_16x16x32_bf16 a[92:95], a[168:171], v[88:91], a[92:95]
  ds_read_b128 a[136:139], v214 offset:49152
  v_cvt_pk_bf16_f32 v43, v46, v47
  v_mfma_f32_16x16x32_bf16 a[96:99], a[176:179], v[64:67], a[96:99]
  v_exp_f32 v52, v52
  v_mfma_f32_16x16x32_bf16 a[96:99], a[180:183], v[96:99], a[96:99]
  ds_read_b128 a[140:143], v215 offset:49152
  v_mfma_f32_16x16x32_bf16 a[100:103], a[180:183], v[104:107], a[100:103]
  v_exp_f32 v53, v53
  v_mfma_f32_16x16x32_bf16 a[100:103], a[176:179], v[72:75], a[100:103]
  v_cvt_pk_bf16_f32 v50, v52, v53
  v_mfma_f32_16x16x32_bf16 a[104:107], a[176:179], v[80:83], a[104:107]
  v_exp_f32 v54, v54
  v_mfma_f32_16x16x32_bf16 a[104:107], a[180:183], v[112:115], a[104:107]
  v_mfma_f32_16x16x32_bf16 a[108:111], a[180:183], v[120:123], a[108:111]
  s_waitcnt lgkmcnt(4)
  v_exp_f32 v55, v55
  v_mfma_f32_16x16x32_bf16 a[108:111], a[176:179], v[88:91], a[108:111]
  v_cvt_pk_bf16_f32 v51, v54, v55
  v_mfma_f32_16x16x32_bf16 a[112:115], a[184:187], v[64:67], a[112:115]
  v_exp_f32 v60, v60
  v_mfma_f32_16x16x32_bf16 a[112:115], a[188:191], v[96:99], a[112:115]
  v_mfma_f32_16x16x32_bf16 a[116:119], a[188:191], v[104:107], a[116:119]
  v_exp_f32 v61, v61
  v_mfma_f32_16x16x32_bf16 a[116:119], a[184:187], v[72:75], a[116:119]
  v_cvt_pk_bf16_f32 v58, v60, v61
  v_mfma_f32_16x16x32_bf16 a[120:123], a[184:187], v[80:83], a[120:123]
  v_exp_f32 v62, v62
  v_mfma_f32_16x16x32_bf16 a[120:123], a[188:191], v[112:115], a[120:123]
  v_mfma_f32_16x16x32_bf16 a[124:127], a[188:191], v[120:123], a[124:127]
  s_waitcnt lgkmcnt(0)
  v_exp_f32 v63, v63
  v_mfma_f32_16x16x32_bf16 a[124:127], a[184:187], v[88:91], a[124:127]
  v_cvt_pk_bf16_f32 v59, v62, v63
  v_mfma_f32_16x16x32_bf16 v[64:67], a[128:131], v[128:131], v[192:195]
  s_add_u32 m0, s28, 65536
  v_mfma_f32_16x16x32_bf16 v[64:67], a[132:135], v[132:135], v[64:67]
  ds_read_b128 a[144:147], v212 offset:53248
  v_mfma_f32_16x16x32_bf16 v[64:67], a[136:139], v[136:139], v[64:67]
  buffer_load_dwordx4 v236, s[16:19], s29 offen offset:0 lds
  v_mfma_f32_16x16x32_bf16 v[64:67], a[140:143], v[140:143], v[64:67]
  ds_read_b128 a[148:151], v213 offset:53248
  v_mfma_f32_16x16x32_bf16 v[72:75], a[140:143], v[156:159], v[196:199]
  v_mfma_f32_16x16x32_bf16 v[72:75], a[136:139], v[152:155], v[72:75]
  ds_read_b128 a[152:155], v214 offset:53248
  v_mfma_f32_16x16x32_bf16 v[72:75], a[132:135], v[148:151], v[72:75]
  buffer_load_dwordx4 v237, s[16:19], s29 offen offset:1024 lds
  v_mfma_f32_16x16x32_bf16 v[72:75], a[128:131], v[144:147], v[72:75]
  ds_read_b128 a[156:159], v215 offset:53248
  v_mfma_f32_16x16x32_bf16 v[80:83], a[128:131], v[160:163], v[200:203]
  v_exp_f32 v64, v64
  v_mfma_f32_16x16x32_bf16 v[80:83], a[132:135], v[164:167], v[80:83]
  v_mfma_f32_16x16x32_bf16 v[80:83], a[136:139], v[168:171], v[80:83]
  v_exp_f32 v65, v65
  v_mfma_f32_16x16x32_bf16 v[80:83], a[140:143], v[172:175], v[80:83]
  v_cvt_pk_bf16_f32 v64, v64, v65
  v_mfma_f32_16x16x32_bf16 v[88:91], a[140:143], v[188:191], v[204:207]
  v_exp_f32 v66, v66
  v_mfma_f32_16x16x32_bf16 v[88:91], a[136:139], v[184:187], v[88:91]
  buffer_load_dwordx4 v236, s[16:19], s29 offen offset:2048 lds
  v_mfma_f32_16x16x32_bf16 v[88:91], a[132:135], v[180:183], v[88:91]
  s_waitcnt lgkmcnt(0)
  v_exp_f32 v67, v67
  v_mfma_f32_16x16x32_bf16 v[88:91], a[128:131], v[176:179], v[88:91]
  v_cvt_pk_bf16_f32 v65, v66, v67
  v_mfma_f32_16x16x32_bf16 v[68:71], a[144:147], v[128:131], v[192:195]
  v_exp_f32 v72, v72
  v_mfma_f32_16x16x32_bf16 v[68:71], a[148:151], v[132:135], v[68:71]
  ds_read_b128 a[128:131], v212 offset:57344
  v_mfma_f32_16x16x32_bf16 v[68:71], a[152:155], v[136:139], v[68:71]
  v_exp_f32 v73, v73
  v_mfma_f32_16x16x32_bf16 v[68:71], a[156:159], v[140:143], v[68:71]
  ds_read_b128 a[132:135], v213 offset:57344
  v_cvt_pk_bf16_f32 v72, v72, v73
  v_mfma_f32_16x16x32_bf16 v[76:79], a[156:159], v[156:159], v[196:199]
  v_exp_f32 v74, v74
  v_mfma_f32_16x16x32_bf16 v[76:79], a[152:155], v[152:155], v[76:79]
  ds_read_b128 a[136:139], v214 offset:57344
  v_mfma_f32_16x16x32_bf16 v[76:79], a[148:151], v[148:151], v[76:79]
  v_exp_f32 v75, v75
  v_mfma_f32_16x16x32_bf16 v[76:79], a[144:147], v[144:147], v[76:79]
  ds_read_b128 a[140:143], v215 offset:57344
  v_cvt_pk_bf16_f32 v73, v74, v75
  v_mfma_f32_16x16x32_bf16 v[84:87], a[144:147], v[160:163], v[200:203]
  v_exp_f32 v80, v80
  v_mfma_f32_16x16x32_bf16 v[84:87], a[148:151], v[164:167], v[84:87]
  buffer_load_dwordx4 v237, s[16:19], s29 offen offset:3072 lds
  v_mfma_f32_16x16x32_bf16 v[84:87], a[152:155], v[168:171], v[84:87]
  s_add_u32 s29, s29, 16384
  v_exp_f32 v81, v81
  v_mfma_f32_16x16x32_bf16 v[84:87], a[156:159], v[172:175], v[84:87]
  v_cvt_pk_bf16_f32 v80, v80, v81
  v_mfma_f32_16x16x32_bf16 v[92:95], a[156:159], v[188:191], v[204:207]
  s_add_u32 m0, s28, 16384
  v_exp_f32 v82, v82
  v_mfma_f32_16x16x32_bf16 v[92:95], a[152:155], v[184:187], v[92:95]
  buffer_load_dwordx4 v232, s[12:15], s29 offen offset:0 lds
  v_mfma_f32_16x16x32_bf16 v[92:95], a[148:151], v[180:183], v[92:95]
  s_waitcnt lgkmcnt(0)
  v_exp_f32 v83, v83
  v_mfma_f32_16x16x32_bf16 v[92:95], a[144:147], v[176:179], v[92:95]
  v_cvt_pk_bf16_f32 v81, v82, v83
  v_mfma_f32_16x16x32_bf16 v[96:99], a[128:131], v[128:131], v[192:195]
  v_exp_f32 v88, v88
  v_mfma_f32_16x16x32_bf16 v[96:99], a[132:135], v[132:135], v[96:99]
  ds_read_b128 a[144:147], v212 offset:61440
  v_mfma_f32_16x16x32_bf16 v[96:99], a[136:139], v[136:139], v[96:99]
  v_exp_f32 v89, v89
  v_mfma_f32_16x16x32_bf16 v[96:99], a[140:143], v[140:143], v[96:99]
  ds_read_b128 a[148:151], v213 offset:61440
  v_cvt_pk_bf16_f32 v88, v88, v89
  v_mfma_f32_16x16x32_bf16 v[104:107], a[140:143], v[156:159], v[196:199]
  v_exp_f32 v90, v90
  v_mfma_f32_16x16x32_bf16 v[104:107], a[136:139], v[152:155], v[104:107]
  ds_read_b128 a[152:155], v214 offset:61440
  v_mfma_f32_16x16x32_bf16 v[104:107], a[132:135], v[148:151], v[104:107]
  v_exp_f32 v91, v91
  v_mfma_f32_16x16x32_bf16 v[104:107], a[128:131], v[144:147], v[104:107]
  ds_read_b128 a[156:159], v215 offset:61440
  v_cvt_pk_bf16_f32 v89, v90, v91
  v_mfma_f32_16x16x32_bf16 v[112:115], a[128:131], v[160:163], v[200:203]
  v_exp_f32 v68, v68
  v_mfma_f32_16x16x32_bf16 v[112:115], a[132:135], v[164:167], v[112:115]
  buffer_load_dwordx4 v233, s[12:15], s29 offen offset:1024 lds
  v_mfma_f32_16x16x32_bf16 v[112:115], a[136:139], v[168:171], v[112:115]
  v_exp_f32 v69, v69
  v_mfma_f32_16x16x32_bf16 v[112:115], a[140:143], v[172:175], v[112:115]
  v_cvt_pk_bf16_f32 v66, v68, v69
  v_mfma_f32_16x16x32_bf16 v[120:123], a[140:143], v[188:191], v[204:207]
  v_exp_f32 v70, v70
  v_mfma_f32_16x16x32_bf16 v[120:123], a[136:139], v[184:187], v[120:123]
  buffer_load_dwordx4 v234, s[12:15], s29 offen offset:2048 lds
  v_mfma_f32_16x16x32_bf16 v[120:123], a[132:135], v[180:183], v[120:123]
  s_waitcnt lgkmcnt(0)
  v_exp_f32 v71, v71
  v_mfma_f32_16x16x32_bf16 v[120:123], a[128:131], v[176:179], v[120:123]
  v_cvt_pk_bf16_f32 v67, v70, v71
  v_mfma_f32_16x16x32_bf16 v[100:103], a[144:147], v[128:131], v[192:195]
  v_exp_f32 v76, v76
  v_mfma_f32_16x16x32_bf16 v[100:103], a[148:151], v[132:135], v[100:103]
  ds_read_b64_tr_b16 a[160:161], v216 offset:32768
  v_mfma_f32_16x16x32_bf16 v[100:103], a[152:155], v[136:139], v[100:103]
  v_exp_f32 v77, v77
  v_mfma_f32_16x16x32_bf16 v[100:103], a[156:159], v[140:143], v[100:103]
  ds_read_b64_tr_b16 a[162:163], v216 offset:36864
  v_cvt_pk_bf16_f32 v74, v76, v77
  v_mfma_f32_16x16x32_bf16 v[108:111], a[156:159], v[156:159], v[196:199]
  v_exp_f32 v78, v78
  v_mfma_f32_16x16x32_bf16 v[108:111], a[152:155], v[152:155], v[108:111]
  ds_read_b64_tr_b16 a[164:165], v216 offset:40960
  buffer_load_dwordx4 v235, s[12:15], s29 offen offset:3072 lds
  v_mfma_f32_16x16x32_bf16 v[108:111], a[148:151], v[148:151], v[108:111]
  v_exp_f32 v79, v79
  v_mfma_f32_16x16x32_bf16 v[108:111], a[144:147], v[144:147], v[108:111]
  ds_read_b64_tr_b16 a[166:167], v216 offset:45056
  v_cvt_pk_bf16_f32 v75, v78, v79
  v_mfma_f32_16x16x32_bf16 v[116:119], a[144:147], v[160:163], v[200:203]
  v_exp_f32 v84, v84
  v_mfma_f32_16x16x32_bf16 v[116:119], a[148:151], v[164:167], v[116:119]
  ds_read_b64_tr_b16 a[168:169], v217 offset:32768
  buffer_load_dword v254, off, s[24:27], s47 sc1
  v_mfma_f32_16x16x32_bf16 v[116:119], a[152:155], v[168:171], v[116:119]
  v_exp_f32 v85, v85
  v_mfma_f32_16x16x32_bf16 v[116:119], a[156:159], v[172:175], v[116:119]
  ds_read_b64_tr_b16 a[170:171], v217 offset:36864
  v_cvt_pk_bf16_f32 v82, v84, v85
  v_mfma_f32_16x16x32_bf16 v[124:127], a[156:159], v[188:191], v[204:207]
  s_waitcnt vmcnt(20)
  v_exp_f32 v86, v86
  v_mfma_f32_16x16x32_bf16 v[124:127], a[152:155], v[184:187], v[124:127]
  ds_read_b64_tr_b16 a[172:173], v217 offset:40960
  ds_read_b64_tr_b16 a[232:233], v209 offset:5120
  v_mfma_f32_16x16x32_bf16 v[124:127], a[148:151], v[180:183], v[124:127]
  v_exp_f32 v87, v87
  v_mfma_f32_16x16x32_bf16 v[124:127], a[144:147], v[176:179], v[124:127]
  ds_read_b64_tr_b16 a[174:175], v217 offset:45056
  v_cvt_pk_bf16_f32 v83, v86, v87
  v_mfma_f32_16x16x32_bf16 a[192:195], a[208:211], v[0:3], a[192:195]
  v_exp_f32 v92, v92
  v_mfma_f32_16x16x32_bf16 a[192:195], a[208:211], v[32:35], a[192:195]
  ds_read_b64_tr_b16 a[176:177], v218 offset:32768
  ds_read_b64_tr_b16 a[234:235], v209 offset:5632
  v_mfma_f32_16x16x32_bf16 a[196:199], a[208:211], v[8:11], a[196:199]
  v_exp_f32 v93, v93
  v_mfma_f32_16x16x32_bf16 a[196:199], a[208:211], v[40:43], a[196:199]
  ds_read_b64_tr_b16 a[178:179], v218 offset:36864
  v_cvt_pk_bf16_f32 v90, v92, v93
  v_mfma_f32_16x16x32_bf16 a[200:203], a[208:211], v[16:19], a[200:203]
  v_exp_f32 v94, v94
  v_mfma_f32_16x16x32_bf16 a[200:203], a[208:211], v[48:51], a[200:203]
  ds_read_b64_tr_b16 a[180:181], v218 offset:40960
  v_mfma_f32_16x16x32_bf16 a[204:207], a[208:211], v[24:27], a[204:207]
  s_waitcnt lgkmcnt(9)
  v_exp_f32 v95, v95
  v_mfma_f32_16x16x32_bf16 a[204:207], a[208:211], v[56:59], a[204:207]
  ds_read_b64_tr_b16 a[182:183], v218 offset:45056
  v_cvt_pk_bf16_f32 v91, v94, v95
  v_mfma_f32_16x16x32_bf16 a[0:3], a[160:163], v[0:3], a[0:3]
  v_exp_f32 v96, v96
  v_mfma_f32_16x16x32_bf16 a[0:3], a[164:167], v[32:35], a[0:3]
  ds_read_b64_tr_b16 a[184:185], v219 offset:32768
  s_waitcnt lgkmcnt(4)
  buffer_store_dwordx4 a[232:235], v211, s[24:27], s31 offen sc1
  s_add_u32 s31, s31, 1024
  v_mfma_f32_16x16x32_bf16 a[4:7], a[164:167], v[40:43], a[4:7]
  v_exp_f32 v97, v97
  v_mfma_f32_16x16x32_bf16 a[4:7], a[160:163], v[8:11], a[4:7]
  ds_read_b64_tr_b16 a[186:187], v219 offset:36864
  v_cvt_pk_bf16_f32 v96, v96, v97
  v_mfma_f32_16x16x32_bf16 a[8:11], a[160:163], v[16:19], a[8:11]
  v_exp_f32 v98, v98
  v_mfma_f32_16x16x32_bf16 a[8:11], a[164:167], v[48:51], a[8:11]
  ds_read_b64_tr_b16 a[188:189], v219 offset:40960
  v_mfma_f32_16x16x32_bf16 a[12:15], a[164:167], v[56:59], a[12:15]
  v_exp_f32 v99, v99
  v_mfma_f32_16x16x32_bf16 a[12:15], a[160:163], v[24:27], a[12:15]
  ds_read_b64_tr_b16 a[190:191], v219 offset:45056
  v_cvt_pk_bf16_f32 v97, v98, v99
  v_mfma_f32_16x16x32_bf16 a[16:19], a[168:171], v[0:3], a[16:19]
  v_exp_f32 v104, v104
  v_mfma_f32_16x16x32_bf16 a[16:19], a[172:175], v[32:35], a[16:19]
  ds_read_b64_tr_b16 a[160:161], v220 offset:32768
  v_mfma_f32_16x16x32_bf16 a[20:23], a[172:175], v[40:43], a[20:23]
  v_exp_f32 v105, v105
  v_mfma_f32_16x16x32_bf16 a[20:23], a[168:171], v[8:11], a[20:23]
  ds_read_b64_tr_b16 a[162:163], v220 offset:36864
  v_cvt_pk_bf16_f32 v104, v104, v105
  v_mfma_f32_16x16x32_bf16 a[24:27], a[168:171], v[16:19], a[24:27]
  v_exp_f32 v106, v106
  v_mfma_f32_16x16x32_bf16 a[24:27], a[172:175], v[48:51], a[24:27]
  ds_read_b64_tr_b16 a[164:165], v220 offset:40960
  v_mfma_f32_16x16x32_bf16 a[28:31], a[172:175], v[56:59], a[28:31]
  s_waitcnt lgkmcnt(7)
  v_exp_f32 v107, v107
  v_mfma_f32_16x16x32_bf16 a[28:31], a[168:171], v[24:27], a[28:31]
  ds_read_b64_tr_b16 a[166:167], v220 offset:45056
  v_cvt_pk_bf16_f32 v105, v106, v107
  v_mfma_f32_16x16x32_bf16 a[32:35], a[176:179], v[0:3], a[32:35]
  v_exp_f32 v112, v112
  v_mfma_f32_16x16x32_bf16 a[32:35], a[180:183], v[32:35], a[32:35]
  ds_read_b64_tr_b16 a[168:169], v221 offset:32768
  v_mfma_f32_16x16x32_bf16 a[36:39], a[180:183], v[40:43], a[36:39]
  v_exp_f32 v113, v113
  v_mfma_f32_16x16x32_bf16 a[36:39], a[176:179], v[8:11], a[36:39]
  ds_read_b64_tr_b16 a[170:171], v221 offset:36864
  v_cvt_pk_bf16_f32 v112, v112, v113
  v_mfma_f32_16x16x32_bf16 a[40:43], a[176:179], v[16:19], a[40:43]
  v_exp_f32 v114, v114
  v_mfma_f32_16x16x32_bf16 a[40:43], a[180:183], v[48:51], a[40:43]
  ds_read_b64_tr_b16 a[172:173], v221 offset:40960
  v_mfma_f32_16x16x32_bf16 a[44:47], a[180:183], v[56:59], a[44:47]
  s_waitcnt lgkmcnt(7)
  v_exp_f32 v115, v115
  v_mfma_f32_16x16x32_bf16 a[44:47], a[176:179], v[24:27], a[44:47]
  ds_read_b64_tr_b16 a[174:175], v221 offset:45056
  v_cvt_pk_bf16_f32 v113, v114, v115
  v_mfma_f32_16x16x32_bf16 a[48:51], a[184:187], v[0:3], a[48:51]
  v_exp_f32 v120, v120
  v_mfma_f32_16x16x32_bf16 a[48:51], a[188:191], v[32:35], a[48:51]
  ds_read_b64_tr_b16 a[176:177], v222 offset:32768
  v_mfma_f32_16x16x32_bf16 a[52:55], a[188:191], v[40:43], a[52:55]
  v_exp_f32 v121, v121
  v_mfma_f32_16x16x32_bf16 a[52:55], a[184:187], v[8:11], a[52:55]
  ds_read_b64_tr_b16 a[178:179], v222 offset:36864
  v_cvt_pk_bf16_f32 v120, v120, v121
  v_mfma_f32_16x16x32_bf16 a[56:59], a[184:187], v[16:19], a[56:59]
  v_exp_f32 v122, v122
  v_mfma_f32_16x16x32_bf16 a[56:59], a[188:191], v[48:51], a[56:59]
  ds_read_b64_tr_b16 a[180:181], v222 offset:40960
  v_mfma_f32_16x16x32_bf16 a[60:63], a[188:191], v[56:59], a[60:63]
  s_waitcnt lgkmcnt(7)
  v_exp_f32 v123, v123
  v_mfma_f32_16x16x32_bf16 a[60:63], a[184:187], v[24:27], a[60:63]
  ds_read_b64_tr_b16 a[182:183], v222 offset:45056
  v_cvt_pk_bf16_f32 v121, v122, v123
  v_mfma_f32_16x16x32_bf16 a[64:67], a[160:163], v[0:3], a[64:67]
  v_exp_f32 v100, v100
  v_mfma_f32_16x16x32_bf16 a[64:67], a[164:167], v[32:35], a[64:67]
  ds_read_b64_tr_b16 a[184:185], v223 offset:32768
  v_mfma_f32_16x16x32_bf16 a[68:71], a[164:167], v[40:43], a[68:71]
  v_exp_f32 v101, v101
  v_mfma_f32_16x16x32_bf16 a[68:71], a[160:163], v[8:11], a[68:71]
  ds_read_b64_tr_b16 a[186:187], v223 offset:36864
  v_cvt_pk_bf16_f32 v98, v100, v101
  v_mfma_f32_16x16x32_bf16 a[72:75], a[160:163], v[16:19], a[72:75]
  v_exp_f32 v102, v102
  v_mfma_f32_16x16x32_bf16 a[72:75], a[164:167], v[48:51], a[72:75]
  ds_read_b64_tr_b16 a[188:189], v223 offset:40960
  v_mfma_f32_16x16x32_bf16 a[76:79], a[164:167], v[56:59], a[76:79]
  s_waitcnt lgkmcnt(7)
  v_exp_f32 v103, v103
  v_mfma_f32_16x16x32_bf16 a[76:79], a[160:163], v[24:27], a[76:79]
  ds_read_b64_tr_b16 a[190:191], v223 offset:45056
  v_cvt_pk_bf16_f32 v99, v102, v103
  v_mfma_f32_16x16x32_bf16 a[80:83], a[168:171], v[0:3], a[80:83]
  s_waitcnt vmcnt(12)
  v_exp_f32 v108, v108
  v_mfma_f32_16x16x32_bf16 a[80:83], a[172:175], v[32:35], a[80:83]
  v_mfma_f32_16x16x32_bf16 a[84:87], a[172:175], v[40:43], a[84:87]
  s_barrier
  v_exp_f32 v109, v109
  v_mfma_f32_16x16x32_bf16 a[84:87], a[168:171], v[8:11], a[84:87]
  ds_read_b128 a[128:131], v212 offset:0
  v_cvt_pk_bf16_f32 v106, v108, v109
  v_mfma_f32_16x16x32_bf16 a[88:91], a[168:171], v[16:19], a[88:91]
  v_exp_f32 v110, v110
  v_mfma_f32_16x16x32_bf16 a[88:91], a[172:175], v[48:51], a[88:91]
  ds_read_b128 a[132:135], v213 offset:0
  v_mfma_f32_16x16x32_bf16 a[92:95], a[172:175], v[56:59], a[92:95]
  s_waitcnt lgkmcnt(6)
  v_exp_f32 v111, v111
  v_mfma_f32_16x16x32_bf16 a[92:95], a[168:171], v[24:27], a[92:95]
  ds_read_b128 a[136:139], v214 offset:0
  v_cvt_pk_bf16_f32 v107, v110, v111
  v_mfma_f32_16x16x32_bf16 a[96:99], a[176:179], v[0:3], a[96:99]
  v_exp_f32 v116, v116
  v_mfma_f32_16x16x32_bf16 a[96:99], a[180:183], v[32:35], a[96:99]
  ds_read_b128 a[140:143], v215 offset:0
  v_mfma_f32_16x16x32_bf16 a[100:103], a[180:183], v[40:43], a[100:103]
  v_exp_f32 v117, v117
  v_mfma_f32_16x16x32_bf16 a[100:103], a[176:179], v[8:11], a[100:103]
  v_cvt_pk_bf16_f32 v114, v116, v117
  v_mfma_f32_16x16x32_bf16 a[104:107], a[176:179], v[16:19], a[104:107]
  v_exp_f32 v118, v118
  v_mfma_f32_16x16x32_bf16 a[104:107], a[180:183], v[48:51], a[104:107]
  v_mfma_f32_16x16x32_bf16 a[108:111], a[180:183], v[56:59], a[108:111]
  s_waitcnt lgkmcnt(4)
  v_exp_f32 v119, v119
  v_mfma_f32_16x16x32_bf16 a[108:111], a[176:179], v[24:27], a[108:111]
  v_cvt_pk_bf16_f32 v115, v118, v119
  v_mfma_f32_16x16x32_bf16 a[112:115], a[184:187], v[0:3], a[112:115]
  v_exp_f32 v124, v124
  v_mfma_f32_16x16x32_bf16 a[112:115], a[188:191], v[32:35], a[112:115]
  v_mfma_f32_16x16x32_bf16 a[116:119], a[188:191], v[40:43], a[116:119]
  s_sub_u32 s32, s32, 1
  v_exp_f32 v125, v125
  v_mfma_f32_16x16x32_bf16 a[116:119], a[184:187], v[8:11], a[116:119]
  v_cvt_pk_bf16_f32 v122, v124, v125
  v_mfma_f32_16x16x32_bf16 a[120:123], a[184:187], v[16:19], a[120:123]
  s_cmp_lg_u32 s32, 0
  v_exp_f32 v126, v126
  v_mfma_f32_16x16x32_bf16 a[120:123], a[188:191], v[48:51], a[120:123]
  v_mfma_f32_16x16x32_bf16 a[124:127], a[188:191], v[56:59], a[124:127]
  s_waitcnt lgkmcnt(0)
  v_exp_f32 v127, v127
  v_mfma_f32_16x16x32_bf16 a[124:127], a[184:187], v[24:27], a[124:127]
  v_cvt_pk_bf16_f32 v123, v126, v127
  s_cbranch_scc1 attn_loop
  s_waitcnt vmcnt(1)
  v_readfirstlane_b32 s38, v254
  s_nop 0
  s_cmp_ge_u32 s38, 512
  s_cbranch_scc1 attn_h_ready
  s_mov_b32 s39, 32768
attn_spin:
  s_sleep 4
  buffer_load_dword v254, off, s[24:27], s47 sc1
  s_waitcnt vmcnt(0)
  v_readfirstlane_b32 s38, v254
  s_nop 0
  s_cmp_ge_u32 s38, 512
  s_cbranch_scc1 attn_h_ready
  s_sub_u32 s39, s39, 1
  s_cmp_lg_u32 s39, 0
  s_cbranch_scc1 attn_spin
attn_h_ready:
  v_mfma_f32_16x16x32_bf16 v[0:3], a[128:131], v[128:131], v[192:195]
  s_add_u32 m0, s28, 81920
  s_and_b32 s38, s2, 1
  s_lshl_b32 s38, s38, 2
  v_lshrrev_b32 v224, 4, v242
  v_and_b32 v225, 7, v224
  v_mfma_f32_16x16x32_bf16 v[0:3], a[132:135], v[132:135], v[0:3]
  ds_read_b128 a[144:147], v212 offset:4096
  s_add_u32 s38, s38, s3
  s_mul_i32 s38, s38, 81920
  s_lshr_b32 s39, s2, 5
  v_mul_u32_u24 v225, 0xd80, v225
  v_mfma_f32_16x16x32_bf16 v[0:3], a[136:139], v[136:139], v[0:3]
  buffer_load_dwordx4 v236, s[16:19], s29 offen offset:0 lds
  s_mul_i32 s39, s39, 655360
  s_add_u32 s38, s38, s39
  s_add_u32 s4, s38, 3145728
  v_mfma_f32_16x16x32_bf16 v[0:3], a[140:143], v[140:143], v[0:3]
  ds_read_b128 a[148:151], v213 offset:4096
  s_add_u32 s5, s4, 12288
  s_add_u32 s6, s4, 24576
  s_add_u32 s7, s4, 36864
  v_lshrrev_b32 v224, 4, v224
  v_mfma_f32_16x16x32_bf16 v[8:11], a[140:143], v[156:159], v[196:199]
  s_add_u32 s8, s4, 49152
  s_add_u32 s9, s4, 61440
  s_add_u32 s10, s4, 73728
  v_lshl_add_u32 v225, v224, 4, v225
  v_add_u32 v252, 4096, v242
  v_mfma_f32_16x16x32_bf16 v[8:11], a[136:139], v[152:155], v[8:11]
  ds_read_b128 a[152:155], v214 offset:4096
  buffer_load_dwordx4 a[212:215], v225, s[24:27], s101 offen offset:0 sc1
  v_mfma_f32_16x16x32_bf16 v[8:11], a[132:135], v[148:151], v[8:11]
  buffer_load_dwordx4 v237, s[16:19], s29 offen offset:1024 lds
  v_mfma_f32_16x16x32_bf16 v[8:11], a[128:131], v[144:147], v[8:11]
  ds_read_b128 a[156:159], v215 offset:4096
  buffer_load_dwordx4 a[216:219], v225, s[24:27], s101 offen offset:64 sc1
  v_mfma_f32_16x16x32_bf16 v[16:19], a[128:131], v[160:163], v[200:203]
  v_exp_f32 v0, v0
  v_mfma_f32_16x16x32_bf16 v[16:19], a[132:135], v[164:167], v[16:19]
  buffer_load_dwordx4 a[220:223], v225, s[24:27], s101 offen offset:128 sc1
  v_mfma_f32_16x16x32_bf16 v[16:19], a[136:139], v[168:171], v[16:19]
  v_exp_f32 v1, v1
  v_mfma_f32_16x16x32_bf16 v[16:19], a[140:143], v[172:175], v[16:19]
  v_cvt_pk_bf16_f32 v0, v0, v1
  v_add_u32 v253, 8192, v242
  v_mfma_f32_16x16x32_bf16 v[24:27], a[140:143], v[188:191], v[204:207]
  v_exp_f32 v2, v2
  v_mfma_f32_16x16x32_bf16 v[24:27], a[136:139], v[184:187], v[24:27]
  buffer_load_dwordx4 v236, s[16:19], s29 offen offset:2048 lds
  v_mfma_f32_16x16x32_bf16 v[24:27], a[132:135], v[180:183], v[24:27]
  s_waitcnt lgkmcnt(0)
  v_exp_f32 v3, v3
  v_mfma_f32_16x16x32_bf16 v[24:27], a[128:131], v[176:179], v[24:27]
  v_cvt_pk_bf16_f32 v1, v2, v3
  v_mfma_f32_16x16x32_bf16 v[4:7], a[144:147], v[128:131], v[192:195]
  v_exp_f32 v8, v8
  v_mfma_f32_16x16x32_bf16 v[4:7], a[148:151], v[132:135], v[4:7]
  ds_read_b128 a[128:131], v212 offset:8192
  v_mfma_f32_16x16x32_bf16 v[4:7], a[152:155], v[136:139], v[4:7]
  v_exp_f32 v9, v9
  v_mfma_f32_16x16x32_bf16 v[4:7], a[156:159], v[140:143], v[4:7]
  ds_read_b128 a[132:135], v213 offset:8192
  v_cvt_pk_bf16_f32 v8, v8, v9
  v_mfma_f32_16x16x32_bf16 v[12:15], a[156:159], v[156:159], v[196:199]
  v_exp_f32 v10, v10
  v_mfma_f32_16x16x32_bf16 v[12:15], a[152:155], v[152:155], v[12:15]
  ds_read_b128 a[136:139], v214 offset:8192
  v_mfma_f32_16x16x32_bf16 v[12:15], a[148:151], v[148:151], v[12:15]
  v_exp_f32 v11, v11
  v_mfma_f32_16x16x32_bf16 v[12:15], a[144:147], v[144:147], v[12:15]
  ds_read_b128 a[140:143], v215 offset:8192
  v_cvt_pk_bf16_f32 v9, v10, v11
  v_mfma_f32_16x16x32_bf16 v[20:23], a[144:147], v[160:163], v[200:203]
  v_exp_f32 v16, v16
  v_mfma_f32_16x16x32_bf16 v[20:23], a[148:151], v[164:167], v[20:23]
  buffer_load_dwordx4 v237, s[16:19], s29 offen offset:3072 lds
  v_mfma_f32_16x16x32_bf16 v[20:23], a[152:155], v[168:171], v[20:23]
  s_add_u32 s29, s29, 16384
  v_exp_f32 v17, v17
  v_mfma_f32_16x16x32_bf16 v[20:23], a[156:159], v[172:175], v[20:23]
  v_cvt_pk_bf16_f32 v16, v16, v17
  v_mfma_f32_16x16x32_bf16 v[28:31], a[156:159], v[188:191], v[204:207]
  s_add_u32 m0, s28, 32768
  v_exp_f32 v18, v18
  v_mfma_f32_16x16x32_bf16 v[28:31], a[152:155], v[184:187], v[28:31]
  buffer_load_dwordx4 v232, s[12:15], s29 offen offset:0 lds
  v_mfma_f32_16x16x32_bf16 v[28:31], a[148:151], v[180:183], v[28:31]
  s_waitcnt lgkmcnt(0)
  v_exp_f32 v19, v19
  v_mfma_f32_16x16x32_bf16 v[28:31], a[144:147], v[176:179], v[28:31]
  v_cvt_pk_bf16_f32 v17, v18, v19
  v_mfma_f32_16x16x32_bf16 v[32:35], a[128:131], v[128:131], v[192:195]
  v_exp_f32 v24, v24
  v_mfma_f32_16x16x32_bf16 v[32:35], a[132:135], v[132:135], v[32:35]
  ds_read_b128 a[144:147], v212 offset:12288
  v_mfma_f32_16x16x32_bf16 v[32:35], a[136:139], v[136:139], v[32:35]
  v_exp_f32 v25, v25
  v_mfma_f32_16x16x32_bf16 v[32:35], a[140:143], v[140:143], v[32:35]
  ds_read_b128 a[148:151], v213 offset:12288
  v_cvt_pk_bf16_f32 v24, v24, v25
  v_mfma_f32_16x16x32_bf16 v[40:43], a[140:143], v[156:159], v[196:199]
  v_exp_f32 v26, v26
  v_mfma_f32_16x16x32_bf16 v[40:43], a[136:139], v[152:155], v[40:43]
  ds_read_b128 a[152:155], v214 offset:12288
  v_mfma_f32_16x16x32_bf16 v[40:43], a[132:135], v[148:151], v[40:43]
  v_exp_f32 v27, v27
  v_mfma_f32_16x16x32_bf16 v[40:43], a[128:131], v[144:147], v[40:43]
  ds_read_b128 a[156:159], v215 offset:12288
  v_cvt_pk_bf16_f32 v25, v26, v27
  v_mfma_f32_16x16x32_bf16 v[48:51], a[128:131], v[160:163], v[200:203]
  v_exp_f32 v4, v4
  v_mfma_f32_16x16x32_bf16 v[48:51], a[132:135], v[164:167], v[48:51]
  buffer_load_dwordx4 v233, s[12:15], s29 offen offset:1024 lds
  v_mfma_f32_16x16x32_bf16 v[48:51], a[136:139], v[168:171], v[48:51]
  v_exp_f32 v5, v5
  v_mfma_f32_16x16x32_bf16 v[48:51], a[140:143], v[172:175], v[48:51]
  v_cvt_pk_bf16_f32 v2, v4, v5
  v_mfma_f32_16x16x32_bf16 v[56:59], a[140:143], v[188:191], v[204:207]
  v_exp_f32 v6, v6
  v_mfma_f32_16x16x32_bf16 v[56:59], a[136:139], v[184:187], v[56:59]
  buffer_load_dwordx4 v234, s[12:15], s29 offen offset:2048 lds
  v_mfma_f32_16x16x32_bf16 v[56:59], a[132:135], v[180:183], v[56:59]
  s_waitcnt lgkmcnt(0)
  v_exp_f32 v7, v7
  v_mfma_f32_16x16x32_bf16 v[56:59], a[128:131], v[176:179], v[56:59]
  v_cvt_pk_bf16_f32 v3, v6, v7
  v_mfma_f32_16x16x32_bf16 v[36:39], a[144:147], v[128:131], v[192:195]
  v_exp_f32 v12, v12
  v_mfma_f32_16x16x32_bf16 v[36:39], a[148:151], v[132:135], v[36:39]
  ds_read_b64_tr_b16 a[160:161], v216 offset:49152
  v_mfma_f32_16x16x32_bf16 v[36:39], a[152:155], v[136:139], v[36:39]
  v_exp_f32 v13, v13
  v_mfma_f32_16x16x32_bf16 v[36:39], a[156:159], v[140:143], v[36:39]
  ds_read_b64_tr_b16 a[162:163], v216 offset:53248
  v_cvt_pk_bf16_f32 v10, v12, v13
  v_mfma_f32_16x16x32_bf16 v[44:47], a[156:159], v[156:159], v[196:199]
  v_exp_f32 v14, v14
  v_mfma_f32_16x16x32_bf16 v[44:47], a[152:155], v[152:155], v[44:47]
  ds_read_b64_tr_b16 a[164:165], v216 offset:57344
  buffer_load_dwordx4 v235, s[12:15], s29 offen offset:3072 lds
  v_mfma_f32_16x16x32_bf16 v[44:47], a[148:151], v[148:151], v[44:47]
  v_exp_f32 v15, v15
  v_mfma_f32_16x16x32_bf16 v[44:47], a[144:147], v[144:147], v[44:47]
  ds_read_b64_tr_b16 a[166:167], v216 offset:61440
  v_cvt_pk_bf16_f32 v11, v14, v15
  v_mfma_f32_16x16x32_bf16 v[52:55], a[144:147], v[160:163], v[200:203]
  v_exp_f32 v20, v20
  v_mfma_f32_16x16x32_bf16 v[52:55], a[148:151], v[164:167], v[52:55]
  ds_read_b64_tr_b16 a[168:169], v217 offset:49152
  v_mfma_f32_16x16x32_bf16 v[52:55], a[152:155], v[168:171], v[52:55]
  v_exp_f32 v21, v21
  v_mfma_f32_16x16x32_bf16 v[52:55], a[156:159], v[172:175], v[52:55]
  ds_read_b64_tr_b16 a[170:171], v217 offset:53248
  v_cvt_pk_bf16_f32 v18, v20, v21
  v_mfma_f32_16x16x32_bf16 v[60:63], a[156:159], v[188:191], v[204:207]
  v_exp_f32 v22, v22
  v_mfma_f32_16x16x32_bf16 v[60:63], a[152:155], v[184:187], v[60:63]
  ds_read_b64_tr_b16 a[172:173], v217 offset:57344
  v_mfma_f32_16x16x32_bf16 v[60:63], a[148:151], v[180:183], v[60:63]
  v_exp_f32 v23, v23
  v_mfma_f32_16x16x32_bf16 v[60:63], a[144:147], v[176:179], v[60:63]
  ds_read_b64_tr_b16 a[174:175], v217 offset:61440
  v_cvt_pk_bf16_f32 v19, v22, v23
  v_mfma_f32_16x16x32_bf16 a[192:195], a[208:211], v[64:67], a[192:195]
  v_exp_f32 v28, v28
  v_mfma_f32_16x16x32_bf16 a[192:195], a[208:211], v[96:99], a[192:195]
  ds_read_b64_tr_b16 a[176:177], v218 offset:49152
  v_mfma_f32_16x16x32_bf16 a[196:199], a[208:211], v[72:75], a[196:199]
  v_exp_f32 v29, v29
  v_mfma_f32_16x16x32_bf16 a[196:199], a[208:211], v[104:107], a[196:199]
  ds_read_b64_tr_b16 a[178:179], v218 offset:53248
  v_cvt_pk_bf16_f32 v26, v28, v29
  v_mfma_f32_16x16x32_bf16 a[200:203], a[208:211], v[80:83], a[200:203]
  v_exp_f32 v30, v30
  v_mfma_f32_16x16x32_bf16 a[200:203], a[208:211], v[112:115], a[200:203]
  ds_read_b64_tr_b16 a[180:181], v218 offset:57344
  v_mfma_f32_16x16x32_bf16 a[204:207], a[208:211], v[88:91], a[204:207]
  s_waitcnt lgkmcnt(7)
  v_exp_f32 v31, v31
  v_mfma_f32_16x16x32_bf16 a[204:207], a[208:211], v[120:123], a[204:207]
  ds_read_b64_tr_b16 a[182:183], v218 offset:61440
  v_cvt_pk_bf16_f32 v27, v30, v31
  v_mfma_f32_16x16x32_bf16 a[0:3], a[160:163], v[64:67], a[0:3]
  v_exp_f32 v32, v32
  v_mfma_f32_16x16x32_bf16 a[0:3], a[164:167], v[96:99], a[0:3]
  ds_read_b64_tr_b16 a[184:185], v219 offset:49152
  v_mfma_f32_16x16x32_bf16 a[4:7], a[164:167], v[104:107], a[4:7]
  v_exp_f32 v33, v33
  v_mfma_f32_16x16x32_bf16 a[4:7], a[160:163], v[72:75], a[4:7]
  ds_read_b64_tr_b16 a[186:187], v219 offset:53248
  v_cvt_pk_bf16_f32 v32, v32, v33
  v_mfma_f32_16x16x32_bf16 a[8:11], a[160:163], v[80:83], a[8:11]
  v_exp_f32 v34, v34
  v_mfma_f32_16x16x32_bf16 a[8:11], a[164:167], v[112:115], a[8:11]
  ds_read_b64_tr_b16 a[188:189], v219 offset:57344
  v_mfma_f32_16x16x32_bf16 a[12:15], a[164:167], v[120:123], a[12:15]
  s_waitcnt lgkmcnt(7)
  v_exp_f32 v35, v35
  v_mfma_f32_16x16x32_bf16 a[12:15], a[160:163], v[88:91], a[12:15]
  ds_read_b64_tr_b16 a[190:191], v219 offset:61440
  v_cvt_pk_bf16_f32 v33, v34, v35
  v_mfma_f32_16x16x32_bf16 a[16:19], a[168:171], v[64:67], a[16:19]
  v_exp_f32 v40, v40
  v_mfma_f32_16x16x32_bf16 a[16:19], a[172:175], v[96:99], a[16:19]
  ds_read_b64_tr_b16 a[160:161], v220 offset:49152
  v_mfma_f32_16x16x32_bf16 a[20:23], a[172:175], v[104:107], a[20:23]
  v_exp_f32 v41, v41
  v_mfma_f32_16x16x32_bf16 a[20:23], a[168:171], v[72:75], a[20:23]
  ds_read_b64_tr_b16 a[162:163], v220 offset:53248
  v_cvt_pk_bf16_f32 v40, v40, v41
  v_mfma_f32_16x16x32_bf16 a[24:27], a[168:171], v[80:83], a[24:27]
  v_exp_f32 v42, v42
  v_mfma_f32_16x16x32_bf16 a[24:27], a[172:175], v[112:115], a[24:27]
  ds_read_b64_tr_b16 a[164:165], v220 offset:57344
  v_mfma_f32_16x16x32_bf16 a[28:31], a[172:175], v[120:123], a[28:31]
  s_waitcnt lgkmcnt(7)
  v_exp_f32 v43, v43
  v_mfma_f32_16x16x32_bf16 a[28:31], a[168:171], v[88:91], a[28:31]
  ds_read_b64_tr_b16 a[166:167], v220 offset:61440
  v_cvt_pk_bf16_f32 v41, v42, v43
  v_mfma_f32_16x16x32_bf16 a[32:35], a[176:179], v[64:67], a[32:35]
  v_exp_f32 v48, v48
  v_mfma_f32_16x16x32_bf16 a[32:35], a[180:183], v[96:99], a[32:35]
  ds_read_b64_tr_b16 a[168:169], v221 offset:49152
  v_mfma_f32_16x16x32_bf16 a[36:39], a[180:183], v[104:107], a[36:39]
  v_exp_f32 v49, v49
  v_mfma_f32_16x16x32_bf16 a[36:39], a[176:179], v[72:75], a[36:39]
  ds_read_b64_tr_b16 a[170:171], v221 offset:53248
  v_cvt_pk_bf16_f32 v48, v48, v49
  v_mfma_f32_16x16x32_bf16 a[40:43], a[176:179], v[80:83], a[40:43]
  v_exp_f32 v50, v50
  v_mfma_f32_16x16x32_bf16 a[40:43], a[180:183], v[112:115], a[40:43]
  ds_read_b64_tr_b16 a[172:173], v221 offset:57344
  v_mfma_f32_16x16x32_bf16 a[44:47], a[180:183], v[120:123], a[44:47]
  s_waitcnt lgkmcnt(7)
  v_exp_f32 v51, v51
  v_mfma_f32_16x16x32_bf16 a[44:47], a[176:179], v[88:91], a[44:47]
  ds_read_b64_tr_b16 a[174:175], v221 offset:61440
  v_cvt_pk_bf16_f32 v49, v50, v51
  v_mfma_f32_16x16x32_bf16 a[48:51], a[184:187], v[64:67], a[48:51]
  v_exp_f32 v56, v56
  v_mfma_f32_16x16x32_bf16 a[48:51], a[188:191], v[96:99], a[48:51]
  ds_read_b64_tr_b16 a[176:177], v222 offset:49152
  v_mfma_f32_16x16x32_bf16 a[52:55], a[188:191], v[104:107], a[52:55]
  v_exp_f32 v57, v57
  v_mfma_f32_16x16x32_bf16 a[52:55], a[184:187], v[72:75], a[52:55]
  ds_read_b64_tr_b16 a[178:179], v222 offset:53248
  v_cvt_pk_bf16_f32 v56, v56, v57
  v_mfma_f32_16x16x32_bf16 a[56:59], a[184:187], v[80:83], a[56:59]
  v_exp_f32 v58, v58
  v_mfma_f32_16x16x32_bf16 a[56:59], a[188:191], v[112:115], a[56:59]
  ds_read_b64_tr_b16 a[180:181], v222 offset:57344
  v_mfma_f32_16x16x32_bf16 a[60:63], a[188:191], v[120:123], a[60:63]
  s_waitcnt lgkmcnt(7)
  v_exp_f32 v59, v59
  v_mfma_f32_16x16x32_bf16 a[60:63], a[184:187], v[88:91], a[60:63]
  ds_read_b64_tr_b16 a[182:183], v222 offset:61440
  v_cvt_pk_bf16_f32 v57, v58, v59
  v_mfma_f32_16x16x32_bf16 a[64:67], a[160:163], v[64:67], a[64:67]
  v_exp_f32 v36, v36
  v_mfma_f32_16x16x32_bf16 a[64:67], a[164:167], v[96:99], a[64:67]
  ds_read_b64_tr_b16 a[184:185], v223 offset:49152
  v_mfma_f32_16x16x32_bf16 a[68:71], a[164:167], v[104:107], a[68:71]
  v_exp_f32 v37, v37
  v_mfma_f32_16x16x32_bf16 a[68:71], a[160:163], v[72:75], a[68:71]
  ds_read_b64_tr_b16 a[186:187], v223 offset:53248
  v_cvt_pk_bf16_f32 v34, v36, v37
  v_mfma_f32_16x16x32_bf16 a[72:75], a[160:163], v[80:83], a[72:75]
  v_exp_f32 v38, v38
  v_mfma_f32_16x16x32_bf16 a[72:75], a[164:167], v[112:115], a[72:75]
  ds_read_b64_tr_b16 a[188:189], v223 offset:57344
  v_mfma_f32_16x16x32_bf16 a[76:79], a[164:167], v[120:123], a[76:79]
  s_waitcnt lgkmcnt(7)
  v_exp_f32 v39, v39
  v_mfma_f32_16x16x32_bf16 a[76:79], a[160:163], v[88:91], a[76:79]
  ds_read_b64_tr_b16 a[190:191], v223 offset:61440
  v_cvt_pk_bf16_f32 v35, v38, v39
  v_mfma_f32_16x16x32_bf16 a[80:83], a[168:171], v[64:67], a[80:83]
  v_exp_f32 v44, v44
  v_mfma_f32_16x16x32_bf16 a[80:83], a[172:175], v[96:99], a[80:83]
  v_mfma_f32_16x16x32_bf16 a[84:87], a[172:175], v[104:107], a[84:87]
  s_barrier
  v_exp_f32 v45, v45
  v_mfma_f32_16x16x32_bf16 a[84:87], a[168:171], v[72:75], a[84:87]
  ds_read_b128 a[128:131], v212 offset:16384
  v_cvt_pk_bf16_f32 v42, v44, v45
  v_mfma_f32_16x16x32_bf16 a[88:91], a[168:171], v[80:83], a[88:91]
  v_exp_f32 v46, v46
  v_mfma_f32_16x16x32_bf16 a[88:91], a[172:175], v[112:115], a[88:91]
  ds_read_b128 a[132:135], v213 offset:16384
  v_mfma_f32_16x16x32_bf16 a[92:95], a[172:175], v[120:123], a[92:95]
  s_waitcnt lgkmcnt(6)
  v_exp_f32 v47, v47
  v_mfma_f32_16x16x32_bf16 a[92:95], a[168:171], v[88:91], a[92:95]
  ds_read_b128 a[136:139], v214 offset:16384
  v_cvt_pk_bf16_f32 v43, v46, v47
  v_mfma_f32_16x16x32_bf16 a[96:99], a[176:179], v[64:67], a[96:99]
  v_exp_f32 v52, v52
  v_mfma_f32_16x16x32_bf16 a[96:99], a[180:183], v[96:99], a[96:99]
  ds_read_b128 a[140:143], v215 offset:16384
  v_mfma_f32_16x16x32_bf16 a[100:103], a[180:183], v[104:107], a[100:103]
  v_exp_f32 v53, v53
  v_mfma_f32_16x16x32_bf16 a[100:103], a[176:179], v[72:75], a[100:103]
  v_cvt_pk_bf16_f32 v50, v52, v53
  v_mfma_f32_16x16x32_bf16 a[104:107], a[176:179], v[80:83], a[104:107]
  v_exp_f32 v54, v54
  v_mfma_f32_16x16x32_bf16 a[104:107], a[180:183], v[112:115], a[104:107]
  v_mfma_f32_16x16x32_bf16 a[108:111], a[180:183], v[120:123], a[108:111]
  s_waitcnt lgkmcnt(4)
  v_exp_f32 v55, v55
  v_mfma_f32_16x16x32_bf16 a[108:111], a[176:179], v[88:91], a[108:111]
  v_cvt_pk_bf16_f32 v51, v54, v55
  v_mfma_f32_16x16x32_bf16 a[112:115], a[184:187], v[64:67], a[112:115]
  v_exp_f32 v60, v60
  v_mfma_f32_16x16x32_bf16 a[112:115], a[188:191], v[96:99], a[112:115]
  v_mfma_f32_16x16x32_bf16 a[116:119], a[188:191], v[104:107], a[116:119]
  v_exp_f32 v61, v61
  v_mfma_f32_16x16x32_bf16 a[116:119], a[184:187], v[72:75], a[116:119]
  v_cvt_pk_bf16_f32 v58, v60, v61
  v_mfma_f32_16x16x32_bf16 a[120:123], a[184:187], v[80:83], a[120:123]
  v_exp_f32 v62, v62
  v_mfma_f32_16x16x32_bf16 a[120:123], a[188:191], v[112:115], a[120:123]
  v_mfma_f32_16x16x32_bf16 a[124:127], a[188:191], v[120:123], a[124:127]
  s_waitcnt lgkmcnt(0)
  v_exp_f32 v63, v63
  v_mfma_f32_16x16x32_bf16 a[124:127], a[184:187], v[88:91], a[124:127]
  v_cvt_pk_bf16_f32 v59, v62, v63
  v_mfma_f32_16x16x32_bf16 v[64:67], a[128:131], v[128:131], v[192:195]
  s_add_u32 m0, s28, 98304
  v_mfma_f32_16x16x32_bf16 v[64:67], a[132:135], v[132:135], v[64:67]
  ds_read_b128 a[144:147], v212 offset:20480
  v_mfma_f32_16x16x32_bf16 v[64:67], a[136:139], v[136:139], v[64:67]
  buffer_load_dwordx4 v236, s[16:19], s29 offen offset:0 lds
  v_mfma_f32_16x16x32_bf16 v[64:67], a[140:143], v[140:143], v[64:67]
  ds_read_b128 a[148:151], v213 offset:20480
  v_mfma_f32_16x16x32_bf16 v[72:75], a[140:143], v[156:159], v[196:199]
  v_mfma_f32_16x16x32_bf16 v[72:75], a[136:139], v[152:155], v[72:75]
  ds_read_b128 a[152:155], v214 offset:20480
  v_mfma_f32_16x16x32_bf16 v[72:75], a[132:135], v[148:151], v[72:75]
  buffer_load_dwordx4 v237, s[16:19], s29 offen offset:1024 lds
  v_mfma_f32_16x16x32_bf16 v[72:75], a[128:131], v[144:147], v[72:75]
  ds_read_b128 a[156:159], v215 offset:20480
  v_mfma_f32_16x16x32_bf16 v[80:83], a[128:131], v[160:163], v[200:203]
  v_exp_f32 v64, v64
  v_mfma_f32_16x16x32_bf16 v[80:83], a[132:135], v[164:167], v[80:83]
  v_mfma_f32_16x16x32_bf16 v[80:83], a[136:139], v[168:171], v[80:83]
  v_exp_f32 v65, v65
  v_mfma_f32_16x16x32_bf16 v[80:83], a[140:143], v[172:175], v[80:83]
  v_cvt_pk_bf16_f32 v64, v64, v65
  v_mfma_f32_16x16x32_bf16 v[88:91], a[140:143], v[188:191], v[204:207]
  v_exp_f32 v66, v66
  v_mfma_f32_16x16x32_bf16 v[88:91], a[136:139], v[184:187], v[88:91]
  buffer_load_dwordx4 v236, s[16:19], s29 offen offset:2048 lds
  v_mfma_f32_16x16x32_bf16 v[88:91], a[132:135], v[180:183], v[88:91]
  s_waitcnt lgkmcnt(0)
  v_exp_f32 v67, v67
  v_mfma_f32_16x16x32_bf16 v[88:91], a[128:131], v[176:179], v[88:91]
  v_cvt_pk_bf16_f32 v65, v66, v67
  v_mfma_f32_16x16x32_bf16 v[68:71], a[144:147], v[128:131], v[192:195]
  v_exp_f32 v72, v72
  v_mfma_f32_16x16x32_bf16 v[68:71], a[148:151], v[132:135], v[68:71]
  ds_read_b128 a[128:131], v212 offset:24576
  v_mfma_f32_16x16x32_bf16 v[68:71], a[152:155], v[136:139], v[68:71]
  v_exp_f32 v73, v73
  v_mfma_f32_16x16x32_bf16 v[68:71], a[156:159], v[140:143], v[68:71]
  ds_read_b128 a[132:135], v213 offset:24576
  v_cvt_pk_bf16_f32 v72, v72, v73
  v_mfma_f32_16x16x32_bf16 v[76:79], a[156:159], v[156:159], v[196:199]
  v_exp_f32 v74, v74
  v_mfma_f32_16x16x32_bf16 v[76:79], a[152:155], v[152:155], v[76:79]
  ds_read_b128 a[136:139], v214 offset:24576
  v_lshrrev_b32 v224, 4, v242
  v_mfma_f32_16x16x32_bf16 v[76:79], a[148:151], v[148:151], v[76:79]
  v_exp_f32 v75, v75
  v_mfma_f32_16x16x32_bf16 v[76:79], a[144:147], v[144:147], v[76:79]
  ds_read_b128 a[140:143], v215 offset:24576
  v_cvt_pk_bf16_f32 v73, v74, v75
  v_mfma_f32_16x16x32_bf16 v[84:87], a[144:147], v[160:163], v[200:203]
  v_exp_f32 v80, v80
  v_mfma_f32_16x16x32_bf16 v[84:87], a[148:151], v[164:167], v[84:87]
  buffer_load_dwordx4 v237, s[16:19], s29 offen offset:3072 lds
  v_mfma_f32_16x16x32_bf16 v[84:87], a[152:155], v[168:171], v[84:87]
  s_add_u32 s29, s29, 16384
  v_exp_f32 v81, v81
  v_mfma_f32_16x16x32_bf16 v[84:87], a[156:159], v[172:175], v[84:87]
  v_cvt_pk_bf16_f32 v80, v80, v81
  v_lshrrev_b32 v225, 4, v224
  v_mfma_f32_16x16x32_bf16 v[92:95], a[156:159], v[188:191], v[204:207]
  s_add_u32 m0, s28, 49152
  v_exp_f32 v82, v82
  v_mfma_f32_16x16x32_bf16 v[92:95], a[152:155], v[184:187], v[92:95]
  buffer_load_dwordx4 v232, s[12:15], s29 offen offset:0 lds
  v_mfma_f32_16x16x32_bf16 v[92:95], a[148:151], v[180:183], v[92:95]
  s_waitcnt lgkmcnt(0)
  v_exp_f32 v83, v83
  v_mfma_f32_16x16x32_bf16 v[92:95], a[144:147], v[176:179], v[92:95]
  v_cvt_pk_bf16_f32 v81, v82, v83
  v_bfe_u32 v226, v224, 2, 2
  v_mfma_f32_16x16x32_bf16 v[96:99], a[128:131], v[128:131], v[192:195]
  v_exp_f32 v88, v88
  v_mfma_f32_16x16x32_bf16 v[96:99], a[132:135], v[132:135], v[96:99]
  ds_read_b128 a[144:147], v212 offset:28672
  v_lshl_add_u32 v225, v225, 3, v226
  v_mfma_f32_16x16x32_bf16 v[96:99], a[136:139], v[136:139], v[96:99]
  v_exp_f32 v89, v89
  v_mfma_f32_16x16x32_bf16 v[96:99], a[140:143], v[140:143], v[96:99]
  ds_read_b128 a[148:151], v213 offset:28672
  v_cvt_pk_bf16_f32 v88, v88, v89
  v_mfma_f32_16x16x32_bf16 v[104:107], a[140:143], v[156:159], v[196:199]
  v_exp_f32 v90, v90
  v_mfma_f32_16x16x32_bf16 v[104:107], a[136:139], v[152:155], v[104:107]
  ds_read_b128 a[152:155], v214 offset:28672
  v_lshlrev_b32 v225, 5, v225
  v_mfma_f32_16x16x32_bf16 v[104:107], a[132:135], v[148:151], v[104:107]
  v_exp_f32 v91, v91
  v_mfma_f32_16x16x32_bf16 v[104:107], a[128:131], v[144:147], v[104:107]
  ds_read_b128 a[156:159], v215 offset:28672
  v_cvt_pk_bf16_f32 v89, v90, v91
  v_mfma_f32_16x16x32_bf16 v[112:115], a[128:131], v[160:163], v[200:203]
  v_exp_f32 v68, v68
  v_mfma_f32_16x16x32_bf16 v[112:115], a[132:135], v[164:167], v[112:115]
  buffer_load_dwordx4 v233, s[12:15], s29 offen offset:1024 lds
  v_mfma_f32_16x16x32_bf16 v[112:115], a[136:139], v[168:171], v[112:115]
  v_exp_f32 v69, v69
  v_mfma_f32_16x16x32_bf16 v[112:115], a[140:143], v[172:175], v[112:115]
  v_cvt_pk_bf16_f32 v66, v68, v69
  v_and_b32 v226, 3, v224
  v_mfma_f32_16x16x32_bf16 v[120:123], a[140:143], v[188:191], v[204:207]
  v_exp_f32 v70, v70
  v_mfma_f32_16x16x32_bf16 v[120:123], a[136:139], v[184:187], v[120:123]
  buffer_load_dwordx4 v234, s[12:15], s29 offen offset:2048 lds
  v_mfma_f32_16x16x32_bf16 v[120:123], a[132:135], v[180:183], v[120:123]
  s_waitcnt lgkmcnt(0)
  v_exp_f32 v71, v71
  v_mfma_f32_16x16x32_bf16 v[120:123], a[128:131], v[176:179], v[120:123]
  v_cvt_pk_bf16_f32 v67, v70, v71
  v_lshl_add_u32 v225, v226, 3, v225
  v_mfma_f32_16x16x32_bf16 v[100:103], a[144:147], v[128:131], v[192:195]
  v_exp_f32 v76, v76
  v_mfma_f32_16x16x32_bf16 v[100:103], a[148:151], v[132:135], v[100:103]
  ds_read_b64_tr_b16 a[160:161], v216 offset:0
  v_add_u32 v225, s50, v225
  v_mfma_f32_16x16x32_bf16 v[100:103], a[152:155], v[136:139], v[100:103]
  s_waitcnt vmcnt(13)
  v_exp_f32 v77, v77
  v_mfma_f32_16x16x32_bf16 v[100:103], a[156:159], v[140:143], v[100:103]
  ds_read_b64_tr_b16 a[162:163], v216 offset:4096
  v_cvt_pk_bf16_f32 v74, v76, v77
  v_mfma_f32_16x16x32_bf16 v[108:111], a[156:159], v[156:159], v[196:199]
  v_exp_f32 v78, v78
  v_mfma_f32_16x16x32_bf16 v[108:111], a[152:155], v[152:155], v[108:111]
  ds_read_b64_tr_b16 a[164:165], v216 offset:8192
  buffer_load_dwordx4 v235, s[12:15], s29 offen offset:3072 lds
  v_mfma_f32_16x16x32_bf16 v[108:111], a[148:151], v[148:151], v[108:111]
  v_exp_f32 v79, v79
  v_mfma_f32_16x16x32_bf16 v[108:111], a[144:147], v[144:147], v[108:111]
  ds_read_b64_tr_b16 a[166:167], v216 offset:12288
  v_cvt_pk_bf16_f32 v75, v78, v79
  v_mfma_f32_16x16x32_bf16 v[116:119], a[144:147], v[160:163], v[200:203]
  v_exp_f32 v84, v84
  v_mfma_f32_16x16x32_bf16 v[116:119], a[148:151], v[164:167], v[116:119]
  ds_read_b64_tr_b16 a[168:169], v217 offset:0
  ds_read_b64_tr_b16 a[232:233], v225 offset:0
  s_add_u32 m0, s28, 0
  v_mfma_f32_16x16x32_bf16 v[116:119], a[152:155], v[168:171], v[116:119]
  v_exp_f32 v85, v85
  v_mfma_f32_16x16x32_bf16 v[116:119], a[156:159], v[172:175], v[116:119]
  ds_read_b64_tr_b16 a[170:171], v217 offset:4096
  v_cvt_pk_bf16_f32 v82, v84, v85
  v_mfma_f32_16x16x32_bf16 v[124:127], a[156:159], v[188:191], v[204:207]
  v_exp_f32 v86, v86
  v_mfma_f32_16x16x32_bf16 v[124:127], a[152:155], v[184:187], v[124:127]
  ds_read_b64_tr_b16 a[172:173], v217 offset:8192
  ds_read_b64_tr_b16 a[234:235], v225 offset:128
  v_mfma_f32_16x16x32_bf16 v[124:127], a[148:151], v[180:183], v[124:127]
  v_exp_f32 v87, v87
  v_mfma_f32_16x16x32_bf16 v[124:127], a[144:147], v[176:179], v[124:127]
  ds_read_b64_tr_b16 a[174:175], v217 offset:12288
  v_cvt_pk_bf16_f32 v83, v86, v87
  v_mfma_f32_16x16x32_bf16 a[192:195], a[208:211], v[0:3], a[192:195]
  v_exp_f32 v92, v92
  v_mfma_f32_16x16x32_bf16 a[192:195], a[208:211], v[32:35], a[192:195]
  ds_read_b64_tr_b16 a[176:177], v218 offset:0
  ds_read_b64_tr_b16 a[236:237], v225 offset:1024
  v_mfma_f32_16x16x32_bf16 a[196:199], a[208:211], v[8:11], a[196:199]
  v_exp_f32 v93, v93
  v_mfma_f32_16x16x32_bf16 a[196:199], a[208:211], v[40:43], a[196:199]
  ds_read_b64_tr_b16 a[178:179], v218 offset:4096
  v_cvt_pk_bf16_f32 v90, v92, v93
  v_mfma_f32_16x16x32_bf16 a[200:203], a[208:211], v[16:19], a[200:203]
  v_exp_f32 v94, v94
  v_mfma_f32_16x16x32_bf16 a[200:203], a[208:211], v[48:51], a[200:203]
  ds_read_b64_tr_b16 a[180:181], v218 offset:8192
  ds_read_b64_tr_b16 a[238:239], v225 offset:1152
  v_mfma_f32_16x16x32_bf16 a[204:207], a[208:211], v[24:27], a[204:207]
  s_waitcnt lgkmcnt(11)
  v_exp_f32 v95, v95
  v_mfma_f32_16x16x32_bf16 a[204:207], a[208:211], v[56:59], a[204:207]
  ds_read_b64_tr_b16 a[182:183], v218 offset:12288
  v_cvt_pk_bf16_f32 v91, v94, v95
  v_mfma_f32_16x16x32_bf16 a[0:3], a[160:163], v[0:3], a[0:3]
  v_exp_f32 v96, v96
  v_mfma_f32_16x16x32_bf16 a[0:3], a[164:167], v[32:35], a[0:3]
  ds_read_b64_tr_b16 a[184:185], v219 offset:0
  ds_read_b64_tr_b16 a[240:241], v225 offset:2048
  v_mfma_f32_16x16x32_bf16 a[4:7], a[164:167], v[40:43], a[4:7]
  v_exp_f32 v97, v97
  v_mfma_f32_16x16x32_bf16 a[4:7], a[160:163], v[8:11], a[4:7]
  ds_read_b64_tr_b16 a[186:187], v219 offset:4096
  v_cvt_pk_bf16_f32 v96, v96, v97
  v_mfma_f32_16x16x32_bf16 a[8:11], a[160:163], v[16:19], a[8:11]
  v_exp_f32 v98, v98
  v_mfma_f32_16x16x32_bf16 a[8:11], a[164:167], v[48:51], a[8:11]
  ds_read_b64_tr_b16 a[188:189], v219 offset:8192
  ds_read_b64_tr_b16 a[242:243], v225 offset:2176
  v_mfma_f32_16x16x32_bf16 a[12:15], a[164:167], v[56:59], a[12:15]
  s_waitcnt lgkmcnt(11)
  v_exp_f32 v99, v99
  v_mfma_f32_16x16x32_bf16 a[12:15], a[160:163], v[24:27], a[12:15]
  ds_read_b64_tr_b16 a[190:191], v219 offset:12288
  v_cvt_pk_bf16_f32 v97, v98, v99
  v_mfma_f32_16x16x32_bf16 a[16:19], a[168:171], v[0:3], a[16:19]
  v_exp_f32 v104, v104
  v_mfma_f32_16x16x32_bf16 a[16:19], a[172:175], v[32:35], a[16:19]
  ds_read_b64_tr_b16 a[160:161], v220 offset:0
  buffer_load_dwordx4 v253, s[24:27], s8 offen offset:0 sc1 lds
  v_mfma_f32_16x16x32_bf16 a[20:23], a[172:175], v[40:43], a[20:23]
  v_exp_f32 v105, v105
  v_mfma_f32_16x16x32_bf16 a[20:23], a[168:171], v[8:11], a[20:23]
  ds_read_b64_tr_b16 a[162:163], v220 offset:4096
  v_cvt_pk_bf16_f32 v104, v104, v105
  v_mfma_f32_16x16x32_bf16 a[24:27], a[168:171], v[16:19], a[24:27]
  v_exp_f32 v106, v106
  v_mfma_f32_16x16x32_bf16 a[24:27], a[172:175], v[48:51], a[24:27]
  ds_read_b64_tr_b16 a[164:165], v220 offset:8192
  s_waitcnt lgkmcnt(4)
  buffer_load_dwordx4 v253, s[24:27], s8 offen offset:1024 sc1 lds
  v_mfma_f32_16x16x32_bf16 v[228:231], a[232:235], a[212:215], 0
  v_mfma_f32_16x16x32_bf16 v[228:231], a[236:239], a[216:219], v[228:231]
  v_mfma_f32_16x16x32_bf16 v[228:231], a[240:243], a[220:223], v[228:231]
  v_mfma_f32_16x16x32_bf16 a[28:31], a[172:175], v[56:59], a[28:31]
  s_lshl_b32 s35, s3, 10
  s_add_u32 s35, s35, 159744
  v_exp_f32 v107, v107
  v_mfma_f32_16x16x32_bf16 a[28:31], a[168:171], v[24:27], a[28:31]
  ds_read_b64_tr_b16 a[166:167], v220 offset:12288
  v_cvt_pk_bf16_f32 v105, v106, v107
  v_mfma_f32_16x16x32_bf16 a[32:35], a[176:179], v[0:3], a[32:35]
  v_exp_f32 v112, v112
  v_mfma_f32_16x16x32_bf16 a[32:35], a[180:183], v[32:35], a[32:35]
  ds_read_b64_tr_b16 a[168:169], v221 offset:0
  buffer_load_dwordx4 v253, s[24:27], s8 offen offset:2048 sc1 lds
  v_mfma_f32_16x16x32_bf16 a[36:39], a[180:183], v[40:43], a[36:39]
  v_exp_f32 v113, v113
  v_mfma_f32_16x16x32_bf16 a[36:39], a[176:179], v[8:11], a[36:39]
  ds_read_b64_tr_b16 a[170:171], v221 offset:4096
  v_cvt_pk_bf16_f32 v112, v112, v113
  v_mfma_f32_16x16x32_bf16 a[40:43], a[176:179], v[16:19], a[40:43]
  v_exp_f32 v114, v114
  v_mfma_f32_16x16x32_bf16 a[40:43], a[180:183], v[48:51], a[40:43]
  ds_read_b64_tr_b16 a[172:173], v221 offset:8192
  buffer_load_dwordx4 v253, s[24:27], s8 offen offset:3072 sc1 lds
  v_mfma_f32_16x16x32_bf16 a[44:47], a[180:183], v[56:59], a[44:47]
  s_waitcnt lgkmcnt(7)
  v_exp_f32 v115, v115
  v_mfma_f32_16x16x32_bf16 a[44:47], a[176:179], v[24:27], a[44:47]
  ds_read_b64_tr_b16 a[174:175], v221 offset:12288
  v_cvt_pk_bf16_f32 v113, v114, v115
  v_mfma_f32_16x16x32_bf16 a[48:51], a[184:187], v[0:3], a[48:51]
  v_exp_f32 v120, v120
  v_mfma_f32_16x16x32_bf16 a[48:51], a[188:191], v[32:35], a[48:51]
  ds_read_b64_tr_b16 a[176:177], v222 offset:0
  v_add_u32 v224, s35, v242
  v_mfma_f32_16x16x32_bf16 a[52:55], a[188:191], v[40:43], a[52:55]
  v_exp_f32 v121, v121
  v_mfma_f32_16x16x32_bf16 a[52:55], a[184:187], v[8:11], a[52:55]
  ds_read_b64_tr_b16 a[178:179], v222 offset:4096
  v_cvt_pk_bf16_f32 v120, v120, v121
  v_mfma_f32_16x16x32_bf16 a[56:59], a[184:187], v[16:19], a[56:59]
  v_exp_f32 v122, v122
  v_mfma_f32_16x16x32_bf16 a[56:59], a[188:191], v[48:51], a[56:59]
  ds_read_b64_tr_b16 a[180:181], v222 offset:8192
  ds_write_b128 v224, v[228:231]
  v_mfma_f32_16x16x32_bf16 a[60:63], a[188:191], v[56:59], a[60:63]
  s_waitcnt lgkmcnt(8)
  v_exp_f32 v123, v123
  v_mfma_f32_16x16x32_bf16 a[60:63], a[184:187], v[24:27], a[60:63]
  ds_read_b64_tr_b16 a[182:183], v222 offset:12288
  v_cvt_pk_bf16_f32 v121, v122, v123
  v_mfma_f32_16x16x32_bf16 a[64:67], a[160:163], v[0:3], a[64:67]
  v_exp_f32 v100, v100
  v_mfma_f32_16x16x32_bf16 a[64:67], a[164:167], v[32:35], a[64:67]
  ds_read_b64_tr_b16 a[184:185], v223 offset:0
  v_mfma_f32_16x16x32_bf16 a[68:71], a[164:167], v[40:43], a[68:71]
  v_exp_f32 v101, v101
  v_mfma_f32_16x16x32_bf16 a[68:71], a[160:163], v[8:11], a[68:71]
  ds_read_b64_tr_b16 a[186:187], v223 offset:4096
  v_cvt_pk_bf16_f32 v98, v100, v101
  v_mfma_f32_16x16x32_bf16 a[72:75], a[160:163], v[16:19], a[72:75]
  v_exp_f32 v102, v102
  v_mfma_f32_16x16x32_bf16 a[72:75], a[164:167], v[48:51], a[72:75]
  ds_read_b64_tr_b16 a[188:189], v223 offset:8192
  s_waitcnt lgkmcnt(4)
  v_mfma_f32_16x16x32_bf16 a[76:79], a[164:167], v[56:59], a[76:79]
  v_exp_f32 v103, v103
  v_mfma_f32_16x16x32_bf16 a[76:79], a[160:163], v[24:27], a[76:79]
  ds_read_b64_tr_b16 a[190:191], v223 offset:12288
  v_cvt_pk_bf16_f32 v99, v102, v103
  v_mfma_f32_16x16x32_bf16 a[80:83], a[168:171], v[0:3], a[80:83]
  s_waitcnt vmcnt(12)
  v_exp_f32 v108, v108
  v_mfma_f32_16x16x32_bf16 a[80:83], a[172:175], v[32:35], a[80:83]
  v_mfma_f32_16x16x32_bf16 a[84:87], a[172:175], v[40:43], a[84:87]
  s_barrier
  v_exp_f32 v109, v109
  v_mfma_f32_16x16x32_bf16 a[84:87], a[168:171], v[8:11], a[84:87]
  ds_read_b128 a[128:131], v212 offset:32768
  v_cvt_pk_bf16_f32 v106, v108, v109
  v_mfma_f32_16x16x32_bf16 a[88:91], a[168:171], v[16:19], a[88:91]
  v_exp_f32 v110, v110
  v_mfma_f32_16x16x32_bf16 a[88:91], a[172:175], v[48:51], a[88:91]
  ds_read_b128 a[132:135], v213 offset:32768
  v_mfma_f32_16x16x32_bf16 a[92:95], a[172:175], v[56:59], a[92:95]
  s_waitcnt lgkmcnt(6)
  v_exp_f32 v111, v111
  v_mfma_f32_16x16x32_bf16 a[92:95], a[168:171], v[24:27], a[92:95]
  ds_read_b128 a[136:139], v214 offset:32768
  v_cvt_pk_bf16_f32 v107, v110, v111
  v_mfma_f32_16x16x32_bf16 a[96:99], a[176:179], v[0:3], a[96:99]
  v_exp_f32 v116, v116
  v_mfma_f32_16x16x32_bf16 a[96:99], a[180:183], v[32:35], a[96:99]
  ds_read_b128 a[140:143], v215 offset:32768
  v_mfma_f32_16x16x32_bf16 a[100:103], a[180:183], v[40:43], a[100:103]
  v_exp_f32 v117, v117
  v_mfma_f32_16x16x32_bf16 a[100:103], a[176:179], v[8:11], a[100:103]
  v_cvt_pk_bf16_f32 v114, v116, v117
  v_mfma_f32_16x16x32_bf16 a[104:107], a[176:179], v[16:19], a[104:107]
  v_exp_f32 v118, v118
  v_mfma_f32_16x16x32_bf16 a[104:107], a[180:183], v[48:51], a[104:107]
  v_mfma_f32_16x16x32_bf16 a[108:111], a[180:183], v[56:59], a[108:111]
  s_waitcnt lgkmcnt(4)
  v_exp_f32 v119, v119
  v_mfma_f32_16x16x32_bf16 a[108:111], a[176:179], v[24:27], a[108:111]
  v_cvt_pk_bf16_f32 v115, v118, v119
  v_mfma_f32_16x16x32_bf16 a[112:115], a[184:187], v[0:3], a[112:115]
  v_exp_f32 v124, v124
  v_mfma_f32_16x16x32_bf16 a[112:115], a[188:191], v[32:35], a[112:115]
  v_mfma_f32_16x16x32_bf16 a[116:119], a[188:191], v[40:43], a[116:119]
  v_exp_f32 v125, v125
  v_mfma_f32_16x16x32_bf16 a[116:119], a[184:187], v[8:11], a[116:119]
  v_cvt_pk_bf16_f32 v122, v124, v125
  v_mfma_f32_16x16x32_bf16 a[120:123], a[184:187], v[16:19], a[120:123]
  v_exp_f32 v126, v126
  v_mfma_f32_16x16x32_bf16 a[120:123], a[188:191], v[48:51], a[120:123]
  v_mfma_f32_16x16x32_bf16 a[124:127], a[188:191], v[56:59], a[124:127]
  s_waitcnt lgkmcnt(0)
  v_exp_f32 v127, v127
  v_mfma_f32_16x16x32_bf16 a[124:127], a[184:187], v[24:27], a[124:127]
  v_cvt_pk_bf16_f32 v123, v126, v127
  v_mfma_f32_16x16x32_bf16 v[0:3], a[128:131], v[128:131], v[192:195]
  s_add_u32 m0, s28, 114688
  v_add_u32 v224, 159744, v242
  v_mfma_f32_16x16x32_bf16 v[0:3], a[132:135], v[132:135], v[0:3]
  ds_read_b128 a[144:147], v212 offset:36864
  ds_read_b128 v[228:231], v224 offset:0
  v_mfma_f32_16x16x32_bf16 v[0:3], a[136:139], v[136:139], v[0:3]
  buffer_load_dwordx4 v236, s[16:19], s29 offen offset:0 lds
  v_mfma_f32_16x16x32_bf16 v[0:3], a[140:143], v[140:143], v[0:3]
  ds_read_b128 a[148:151], v213 offset:36864
  ds_read_b128 v[238:241], v224 offset:1024
  v_mfma_f32_16x16x32_bf16 v[8:11], a[140:143], v[156:159], v[196:199]
  ds_read_b128 v[208:211], v224 offset:2048
  v_lshrrev_b32 v224, 4, v242
  v_mfma_f32_16x16x32_bf16 v[8:11], a[136:139], v[152:155], v[8:11]
  ds_read_b128 a[152:155], v214 offset:36864
  s_min_u32 s35, s3, 1
  s_lshl_b32 s35, s35, 30
  v_and_b32 v225, 7, v224
  v_mfma_f32_16x16x32_bf16 v[8:11], a[132:135], v[148:151], v[8:11]
  buffer_load_dwordx4 v237, s[16:19], s29 offen offset:1024 lds
  v_mfma_f32_16x16x32_bf16 v[8:11], a[128:131], v[144:147], v[8:11]
  ds_read_b128 a[156:159], v215 offset:36864
  v_mul_u32_u24 v225, 0xa00, v225
  v_mfma_f32_16x16x32_bf16 v[16:19], a[128:131], v[160:163], v[200:203]
  v_exp_f32 v0, v0
  v_mfma_f32_16x16x32_bf16 v[16:19], a[132:135], v[164:167], v[16:19]
  v_lshrrev_b32 v226, 4, v224
  v_lshl_add_u32 v225, v226, 4, v225
  v_mfma_f32_16x16x32_bf16 v[16:19], a[136:139], v[168:171], v[16:19]
  v_exp_f32 v1, v1
  v_mfma_f32_16x16x32_bf16 v[16:19], a[140:143], v[172:175], v[16:19]
  v_cvt_pk_bf16_f32 v0, v0, v1
  v_bfe_u32 v226, v224, 3, 1
  v_mfma_f32_16x16x32_bf16 v[24:27], a[140:143], v[188:191], v[204:207]
  v_exp_f32 v2, v2
  v_mfma_f32_16x16x32_bf16 v[24:27], a[136:139], v[184:187], v[24:27]
  buffer_load_dwordx4 v236, s[16:19], s29 offen offset:2048 lds
  v_mfma_f32_16x16x32_bf16 v[24:27], a[132:135], v[180:183], v[24:27]
  s_waitcnt lgkmcnt(0)
  v_exp_f32 v3, v3
  v_mfma_f32_16x16x32_bf16 v[24:27], a[128:131], v[176:179], v[24:27]
  v_cvt_pk_bf16_f32 v1, v2, v3
  v_lshl_add_u32 v225, v226, 30, v225
  v_mfma_f32_16x16x32_bf16 v[4:7], a[144:147], v[128:131], v[192:195]
  v_exp_f32 v8, v8
  v_mfma_f32_16x16x32_bf16 v[4:7], a[148:151], v[132:135], v[4:7]
  ds_read_b128 a[128:131], v212 offset:40960
  v_or_b32 v225, s35, v225
  v_mfma_f32_16x16x32_bf16 v[4:7], a[152:155], v[136:139], v[4:7]
  s_mul_i32 s35, s98, 20480
  s_lshl_b32 s38, s99, 6
  s_add_u32 s35, s35, s38
  v_exp_f32 v9, v9
  v_mfma_f32_16x16x32_bf16 v[4:7], a[156:159], v[140:143], v[4:7]
  ds_read_b128 a[132:135], v213 offset:40960
  s_add_u32 s35, s35, 2686976
  v_cvt_pk_bf16_f32 v8, v8, v9
  v_mfma_f32_16x16x32_bf16 v[12:15], a[156:159], v[156:159], v[196:199]
  v_exp_f32 v10, v10
  v_mfma_f32_16x16x32_bf16 v[12:15], a[152:155], v[152:155], v[12:15]
  ds_read_b128 a[136:139], v214 offset:40960
  v_add_f32 v228, v228, v238
  v_mfma_f32_16x16x32_bf16 v[12:15], a[148:151], v[148:151], v[12:15]
  v_exp_f32 v11, v11
  v_mfma_f32_16x16x32_bf16 v[12:15], a[144:147], v[144:147], v[12:15]
  ds_read_b128 a[140:143], v215 offset:40960
  v_cvt_pk_bf16_f32 v9, v10, v11
  v_mfma_f32_16x16x32_bf16 v[20:23], a[144:147], v[160:163], v[200:203]
  v_exp_f32 v16, v16
  v_mfma_f32_16x16x32_bf16 v[20:23], a[148:151], v[164:167], v[20:23]
  buffer_load_dwordx4 v237, s[16:19], s29 offen offset:3072 lds
  v_mfma_f32_16x16x32_bf16 v[20:23], a[152:155], v[168:171], v[20:23]
  s_add_u32 s29, s29, 16384
  v_exp_f32 v17, v17
  v_mfma_f32_16x16x32_bf16 v[20:23], a[156:159], v[172:175], v[20:23]
  v_cvt_pk_bf16_f32 v16, v16, v17
  v_add_f32 v229, v229, v239
  v_mfma_f32_16x16x32_bf16 v[28:31], a[156:159], v[188:191], v[204:207]
  s_add_u32 m0, s28, 16384
  v_exp_f32 v18, v18
  v_mfma_f32_16x16x32_bf16 v[28:31], a[152:155], v[184:187], v[28:31]
  buffer_load_dwordx4 v242, s[24:27], s9 offen offset:0 sc1 lds
  v_mfma_f32_16x16x32_bf16 v[28:31], a[148:151], v[180:183], v[28:31]
  s_waitcnt lgkmcnt(0)
  v_exp_f32 v19, v19
  v_mfma_f32_16x16x32_bf16 v[28:31], a[144:147], v[176:179], v[28:31]
  v_cvt_pk_bf16_f32 v17, v18, v19
  v_add_f32 v230, v230, v240
  v_mfma_f32_16x16x32_bf16 v[32:35], a[128:131], v[128:131], v[192:195]
  v_exp_f32 v24, v24
  v_mfma_f32_16x16x32_bf16 v[32:35], a[132:135], v[132:135], v[32:35]
  ds_read_b128 a[144:147], v212 offset:45056
  v_add_f32 v231, v231, v241
  v_mfma_f32_16x16x32_bf16 v[32:35], a[136:139], v[136:139], v[32:35]
  v_exp_f32 v25, v25
  v_mfma_f32_16x16x32_bf16 v[32:35], a[140:143], v[140:143], v[32:35]
  ds_read_b128 a[148:151], v213 offset:45056
  v_cvt_pk_bf16_f32 v24, v24, v25
  v_mfma_f32_16x16x32_bf16 v[40:43], a[140:143], v[156:159], v[196:199]
  v_exp_f32 v26, v26
  v_mfma_f32_16x16x32_bf16 v[40:43], a[136:139], v[152:155], v[40:43]
  ds_read_b128 a[152:155], v214 offset:45056
  v_add_f32 v228, v228, v208
  v_mfma_f32_16x16x32_bf16 v[40:43], a[132:135], v[148:151], v[40:43]
  v_exp_f32 v27, v27
  v_mfma_f32_16x16x32_bf16 v[40:43], a[128:131], v[144:147], v[40:43]
  ds_read_b128 a[156:159], v215 offset:45056
  v_cvt_pk_bf16_f32 v25, v26, v27
  v_mfma_f32_16x16x32_bf16 v[48:51], a[128:131], v[160:163], v[200:203]
  v_exp_f32 v4, v4
  v_mfma_f32_16x16x32_bf16 v[48:51], a[132:135], v[164:167], v[48:51]
  buffer_load_dwordx4 v242, s[24:27], s9 offen offset:1024 sc1 lds
  v_mfma_f32_16x16x32_bf16 v[48:51], a[136:139], v[168:171], v[48:51]
  v_exp_f32 v5, v5
  v_mfma_f32_16x16x32_bf16 v[48:51], a[140:143], v[172:175], v[48:51]
  v_cvt_pk_bf16_f32 v2, v4, v5
  v_add_f32 v229, v229, v209
  v_mfma_f32_16x16x32_bf16 v[56:59], a[140:143], v[188:191], v[204:207]
  v_exp_f32 v6, v6
  v_mfma_f32_16x16x32_bf16 v[56:59], a[136:139], v[184:187], v[56:59]
  buffer_load_dwordx4 v242, s[24:27], s9 offen offset:2048 sc1 lds
  v_mfma_f32_16x16x32_bf16 v[56:59], a[132:135], v[180:183], v[56:59]
  s_waitcnt lgkmcnt(0)
  v_exp_f32 v7, v7
  v_mfma_f32_16x16x32_bf16 v[56:59], a[128:131], v[176:179], v[56:59]
  v_cvt_pk_bf16_f32 v3, v6, v7
  v_add_f32 v230, v230, v210
  v_mfma_f32_16x16x32_bf16 v[36:39], a[144:147], v[128:131], v[192:195]
  v_exp_f32 v12, v12
  v_mfma_f32_16x16x32_bf16 v[36:39], a[148:151], v[132:135], v[36:39]
  ds_read_b64_tr_b16 a[160:161], v216 offset:16384
  v_add_f32 v231, v231, v211
  v_mfma_f32_16x16x32_bf16 v[36:39], a[152:155], v[136:139], v[36:39]
  v_exp_f32 v13, v13
  v_mfma_f32_16x16x32_bf16 v[36:39], a[156:159], v[140:143], v[36:39]
  ds_read_b64_tr_b16 a[162:163], v216 offset:20480
  v_cvt_pk_bf16_f32 v10, v12, v13
  v_mfma_f32_16x16x32_bf16 v[44:47], a[156:159], v[156:159], v[196:199]
  v_exp_f32 v14, v14
  v_mfma_f32_16x16x32_bf16 v[44:47], a[152:155], v[152:155], v[44:47]
  ds_read_b64_tr_b16 a[164:165], v216 offset:24576
  buffer_load_dwordx4 v242, s[24:27], s9 offen offset:3072 sc1 lds
  v_mfma_f32_16x16x32_bf16 v[44:47], a[148:151], v[148:151], v[44:47]
  v_exp_f32 v15, v15
  v_mfma_f32_16x16x32_bf16 v[44:47], a[144:147], v[144:147], v[44:47]
  ds_read_b64_tr_b16 a[166:167], v216 offset:28672
  v_cvt_pk_bf16_f32 v11, v14, v15
  v_mfma_f32_16x16x32_bf16 v[52:55], a[144:147], v[160:163], v[200:203]
  v_exp_f32 v20, v20
  v_mfma_f32_16x16x32_bf16 v[52:55], a[148:151], v[164:167], v[52:55]
  ds_read_b64_tr_b16 a[168:169], v217 offset:16384
  buffer_store_dwordx4 v[228:231], v225, s[24:27], s35 offen sc1
  v_mfma_f32_16x16x32_bf16 v[52:55], a[152:155], v[168:171], v[52:55]
  v_exp_f32 v21, v21
  v_mfma_f32_16x16x32_bf16 v[52:55], a[156:159], v[172:175], v[52:55]
  ds_read_b64_tr_b16 a[170:171], v217 offset:20480
  v_cvt_pk_bf16_f32 v18, v20, v21
  v_mfma_f32_16x16x32_bf16 v[60:63], a[156:159], v[188:191], v[204:207]
  v_exp_f32 v22, v22
  v_mfma_f32_16x16x32_bf16 v[60:63], a[152:155], v[184:187], v[60:63]
  ds_read_b64_tr_b16 a[172:173], v217 offset:24576
  buffer_load_dwordx4 a[212:215], v242, s[24:27], s4 offen offset:0 sc1
  v_mfma_f32_16x16x32_bf16 v[60:63], a[148:151], v[180:183], v[60:63]
  v_exp_f32 v23, v23
  v_mfma_f32_16x16x32_bf16 v[60:63], a[144:147], v[176:179], v[60:63]
  ds_read_b64_tr_b16 a[174:175], v217 offset:28672
  v_cvt_pk_bf16_f32 v19, v22, v23
  v_mfma_f32_16x16x32_bf16 a[192:195], a[208:211], v[64:67], a[192:195]
  v_exp_f32 v28, v28
  v_mfma_f32_16x16x32_bf16 a[192:195], a[208:211], v[96:99], a[192:195]
  ds_read_b64_tr_b16 a[176:177], v218 offset:16384
  buffer_load_dwordx4 a[216:219], v242, s[24:27], s4 offen offset:1024 sc1
  v_mfma_f32_16x16x32_bf16 a[196:199], a[208:211], v[72:75], a[196:199]
  v_exp_f32 v29, v29
  v_mfma_f32_16x16x32_bf16 a[196:199], a[208:211], v[104:107], a[196:199]
  ds_read_b64_tr_b16 a[178:179], v218 offset:20480
  v_cvt_pk_bf16_f32 v26, v28, v29
  v_mfma_f32_16x16x32_bf16 a[200:203], a[208:211], v[80:83], a[200:203]
  v_exp_f32 v30, v30
  v_mfma_f32_16x16x32_bf16 a[200:203], a[208:211], v[112:115], a[200:203]
  ds_read_b64_tr_b16 a[180:181], v218 offset:24576
  v_mfma_f32_16x16x32_bf16 a[204:207], a[208:211], v[88:91], a[204:207]
  s_waitcnt lgkmcnt(7)
  v_exp_f32 v31, v31
  v_mfma_f32_16x16x32_bf16 a[204:207], a[208:211], v[120:123], a[204:207]
  ds_read_b64_tr_b16 a[182:183], v218 offset:28672
  v_cvt_pk_bf16_f32 v27, v30, v31
  v_mfma_f32_16x16x32_bf16 a[0:3], a[160:163], v[64:67], a[0:3]
  v_exp_f32 v32, v32
  v_mfma_f32_16x16x32_bf16 a[0:3], a[164:167], v[96:99], a[0:3]
  ds_read_b64_tr_b16 a[184:185], v219 offset:16384
  buffer_load_dwordx4 a[220:223], v242, s[24:27], s4 offen offset:2048 sc1
  v_mfma_f32_16x16x32_bf16 a[4:7], a[164:167], v[104:107], a[4:7]
  v_exp_f32 v33, v33
  v_mfma_f32_16x16x32_bf16 a[4:7], a[160:163], v[72:75], a[4:7]
  ds_read_b64_tr_b16 a[186:187], v219 offset:20480
  v_cvt_pk_bf16_f32 v32, v32, v33
  v_mfma_f32_16x16x32_bf16 a[8:11], a[160:163], v[80:83], a[8:11]
  v_exp_f32 v34, v34
  v_mfma_f32_16x16x32_bf16 a[8:11], a[164:167], v[112:115], a[8:11]
  ds_read_b64_tr_b16 a[188:189], v219 offset:24576
  v_mfma_f32_16x16x32_bf16 a[12:15], a[164:167], v[120:123], a[12:15]
  s_waitcnt lgkmcnt(7)
  v_exp_f32 v35, v35
  v_mfma_f32_16x16x32_bf16 a[12:15], a[160:163], v[88:91], a[12:15]
  ds_read_b64_tr_b16 a[190:191], v219 offset:28672
  v_cvt_pk_bf16_f32 v33, v34, v35
  v_mfma_f32_16x16x32_bf16 a[16:19], a[168:171], v[64:67], a[16:19]
  v_exp_f32 v40, v40
  v_mfma_f32_16x16x32_bf16 a[16:19], a[172:175], v[96:99], a[16:19]
  ds_read_b64_tr_b16 a[160:161], v220 offset:16384
  buffer_load_dwordx4 a[224:227], v242, s[24:27], s4 offen offset:3072 sc1
  v_mfma_f32_16x16x32_bf16 a[20:23], a[172:175], v[104:107], a[20:23]
  v_exp_f32 v41, v41
  v_mfma_f32_16x16x32_bf16 a[20:23], a[168:171], v[72:75], a[20:23]
  ds_read_b64_tr_b16 a[162:163], v220 offset:20480
  v_cvt_pk_bf16_f32 v40, v40, v41
  v_mfma_f32_16x16x32_bf16 a[24:27], a[168:171], v[80:83], a[24:27]
  v_exp_f32 v42, v42
  v_mfma_f32_16x16x32_bf16 a[24:27], a[172:175], v[112:115], a[24:27]
  ds_read_b64_tr_b16 a[164:165], v220 offset:24576
  v_mfma_f32_16x16x32_bf16 a[28:31], a[172:175], v[120:123], a[28:31]
  s_waitcnt lgkmcnt(7)
  v_exp_f32 v43, v43
  v_mfma_f32_16x16x32_bf16 a[28:31], a[168:171], v[88:91], a[28:31]
  ds_read_b64_tr_b16 a[166:167], v220 offset:28672
  v_cvt_pk_bf16_f32 v41, v42, v43
  v_mfma_f32_16x16x32_bf16 a[32:35], a[176:179], v[64:67], a[32:35]
  v_exp_f32 v48, v48
  v_mfma_f32_16x16x32_bf16 a[32:35], a[180:183], v[96:99], a[32:35]
  ds_read_b64_tr_b16 a[168:169], v221 offset:16384
  buffer_load_dwordx4 a[228:231], v252, s[24:27], s4 offen offset:0 sc1
  v_mfma_f32_16x16x32_bf16 a[36:39], a[180:183], v[104:107], a[36:39]
  v_exp_f32 v49, v49
  v_mfma_f32_16x16x32_bf16 a[36:39], a[176:179], v[72:75], a[36:39]
  ds_read_b64_tr_b16 a[170:171], v221 offset:20480
  v_cvt_pk_bf16_f32 v48, v48, v49
  v_mfma_f32_16x16x32_bf16 a[40:43], a[176:179], v[80:83], a[40:43]
  v_exp_f32 v50, v50
  v_mfma_f32_16x16x32_bf16 a[40:43], a[180:183], v[112:115], a[40:43]
  ds_read_b64_tr_b16 a[172:173], v221 offset:24576
  v_mfma_f32_16x16x32_bf16 a[44:47], a[180:183], v[120:123], a[44:47]
  s_waitcnt lgkmcnt(7)
  v_exp_f32 v51, v51
  v_mfma_f32_16x16x32_bf16 a[44:47], a[176:179], v[88:91], a[44:47]
  ds_read_b64_tr_b16 a[174:175], v221 offset:28672
  v_cvt_pk_bf16_f32 v49, v50, v51
  v_mfma_f32_16x16x32_bf16 a[48:51], a[184:187], v[64:67], a[48:51]
  v_exp_f32 v56, v56
  v_mfma_f32_16x16x32_bf16 a[48:51], a[188:191], v[96:99], a[48:51]
  ds_read_b64_tr_b16 a[176:177], v222 offset:16384
  buffer_load_dwordx4 a[232:235], v252, s[24:27], s4 offen offset:1024 sc1
  v_mfma_f32_16x16x32_bf16 a[52:55], a[188:191], v[104:107], a[52:55]
  v_exp_f32 v57, v57
  v_mfma_f32_16x16x32_bf16 a[52:55], a[184:187], v[72:75], a[52:55]
  ds_read_b64_tr_b16 a[178:179], v222 offset:20480
  v_cvt_pk_bf16_f32 v56, v56, v57
  v_mfma_f32_16x16x32_bf16 a[56:59], a[184:187], v[80:83], a[56:59]
  v_exp_f32 v58, v58
  v_mfma_f32_16x16x32_bf16 a[56:59], a[188:191], v[112:115], a[56:59]
  ds_read_b64_tr_b16 a[180:181], v222 offset:24576
  v_mfma_f32_16x16x32_bf16 a[60:63], a[188:191], v[120:123], a[60:63]
  s_waitcnt lgkmcnt(7)
  v_exp_f32 v59, v59
  v_mfma_f32_16x16x32_bf16 a[60:63], a[184:187], v[88:91], a[60:63]
  ds_read_b64_tr_b16 a[182:183], v222 offset:28672
  v_cvt_pk_bf16_f32 v57, v58, v59
  v_mfma_f32_16x16x32_bf16 a[64:67], a[160:163], v[64:67], a[64:67]
  v_exp_f32 v36, v36
  v_mfma_f32_16x16x32_bf16 a[64:67], a[164:167], v[96:99], a[64:67]
  ds_read_b64_tr_b16 a[184:185], v223 offset:16384
  v_mfma_f32_16x16x32_bf16 a[68:71], a[164:167], v[104:107], a[68:71]
  v_exp_f32 v37, v37
  v_mfma_f32_16x16x32_bf16 a[68:71], a[160:163], v[72:75], a[68:71]
  ds_read_b64_tr_b16 a[186:187], v223 offset:20480
  v_cvt_pk_bf16_f32 v34, v36, v37
  v_mfma_f32_16x16x32_bf16 a[72:75], a[160:163], v[80:83], a[72:75]
  v_exp_f32 v38, v38
  v_mfma_f32_16x16x32_bf16 a[72:75], a[164:167], v[112:115], a[72:75]
  ds_read_b64_tr_b16 a[188:189], v223 offset:24576
  v_mfma_f32_16x16x32_bf16 a[76:79], a[164:167], v[120:123], a[76:79]
  s_waitcnt lgkmcnt(7)
  v_exp_f32 v39, v39
  v_mfma_f32_16x16x32_bf16 a[76:79], a[160:163], v[88:91], a[76:79]
  ds_read_b64_tr_b16 a[190:191], v223 offset:28672
  v_cvt_pk_bf16_f32 v35, v38, v39
  v_mfma_f32_16x16x32_bf16 a[80:83], a[168:171], v[64:67], a[80:83]
  s_waitcnt vmcnt(19)
  v_exp_f32 v44, v44
  v_mfma_f32_16x16x32_bf16 a[80:83], a[172:175], v[96:99], a[80:83]
  v_mfma_f32_16x16x32_bf16 a[84:87], a[172:175], v[104:107], a[84:87]
  s_barrier
  v_exp_f32 v45, v45
  v_mfma_f32_16x16x32_bf16 a[84:87], a[168:171], v[72:75], a[84:87]
  ds_read_b128 a[128:131], v212 offset:49152
  v_cvt_pk_bf16_f32 v42, v44, v45
  v_mfma_f32_16x16x32_bf16 a[88:91], a[168:171], v[80:83], a[88:91]
  v_exp_f32 v46, v46
  v_mfma_f32_16x16x32_bf16 a[88:91], a[172:175], v[112:115], a[88:91]
  ds_read_b128 a[132:135], v213 offset:49152
  v_mfma_f32_16x16x32_bf16 a[92:95], a[172:175], v[120:123], a[92:95]
  s_waitcnt lgkmcnt(6)
  v_exp_f32 v47, v47
  v_mfma_f32_16x16x32_bf16 a[92:95], a[168:171], v[88:91], a[92:95]
  ds_read_b128 a[136:139], v214 offset:49152
  v_cvt_pk_bf16_f32 v43, v46, v47
  v_mfma_f32_16x16x32_bf16 a[96:99], a[176:179], v[64:67], a[96:99]
  v_exp_f32 v52, v52
  v_mfma_f32_16x16x32_bf16 a[96:99], a[180:183], v[96:99], a[96:99]
  ds_read_b128 a[140:143], v215 offset:49152
  v_mfma_f32_16x16x32_bf16 a[100:103], a[180:183], v[104:107], a[100:103]
  v_exp_f32 v53, v53
  v_mfma_f32_16x16x32_bf16 a[100:103], a[176:179], v[72:75], a[100:103]
  v_cvt_pk_bf16_f32 v50, v52, v53
  v_mfma_f32_16x16x32_bf16 a[104:107], a[176:179], v[80:83], a[104:107]
  v_exp_f32 v54, v54
  v_mfma_f32_16x16x32_bf16 a[104:107], a[180:183], v[112:115], a[104:107]
  v_mfma_f32_16x16x32_bf16 a[108:111], a[180:183], v[120:123], a[108:111]
  s_waitcnt lgkmcnt(4)
  v_exp_f32 v55, v55
  v_mfma_f32_16x16x32_bf16 a[108:111], a[176:179], v[88:91], a[108:111]
  v_cvt_pk_bf16_f32 v51, v54, v55
  v_mfma_f32_16x16x32_bf16 a[112:115], a[184:187], v[64:67], a[112:115]
  v_exp_f32 v60, v60
  v_mfma_f32_16x16x32_bf16 a[112:115], a[188:191], v[96:99], a[112:115]
  v_mfma_f32_16x16x32_bf16 a[116:119], a[188:191], v[104:107], a[116:119]
  v_exp_f32 v61, v61
  v_mfma_f32_16x16x32_bf16 a[116:119], a[184:187], v[72:75], a[116:119]
  v_cvt_pk_bf16_f32 v58, v60, v61
  v_mfma_f32_16x16x32_bf16 a[120:123], a[184:187], v[80:83], a[120:123]
  v_exp_f32 v62, v62
  v_mfma_f32_16x16x32_bf16 a[120:123], a[188:191], v[112:115], a[120:123]
  v_mfma_f32_16x16x32_bf16 a[124:127], a[188:191], v[120:123], a[124:127]
  s_waitcnt lgkmcnt(0)
  v_exp_f32 v63, v63
  v_mfma_f32_16x16x32_bf16 a[124:127], a[184:187], v[88:91], a[124:127]
  v_cvt_pk_bf16_f32 v59, v62, v63
  v_mfma_f32_16x16x32_bf16 v[64:67], a[128:131], v[128:131], v[192:195]
  s_add_u32 m0, s28, 65536
  v_mfma_f32_16x16x32_bf16 v[64:67], a[132:135], v[132:135], v[64:67]
  ds_read_b128 a[144:147], v212 offset:53248
  v_mfma_f32_16x16x32_bf16 v[64:67], a[136:139], v[136:139], v[64:67]
  buffer_load_dwordx4 v253, s[24:27], s9 offen offset:0 sc1 lds
  v_mfma_f32_16x16x32_bf16 v[64:67], a[140:143], v[140:143], v[64:67]
  ds_read_b128 a[148:151], v213 offset:53248
  v_mfma_f32_16x16x32_bf16 v[72:75], a[140:143], v[156:159], v[196:199]
  v_mfma_f32_16x16x32_bf16 v[72:75], a[136:139], v[152:155], v[72:75]
  ds_read_b128 a[152:155], v214 offset:53248
  v_mfma_f32_16x16x32_bf16 v[72:75], a[132:135], v[148:151], v[72:75]
  buffer_load_dwordx4 v253, s[24:27], s9 offen offset:1024 sc1 lds
  v_mfma_f32_16x16x32_bf16 v[72:75], a[128:131], v[144:147], v[72:75]
  ds_read_b128 a[156:159], v215 offset:53248
  v_mfma_f32_16x16x32_bf16 v[80:83], a[128:131], v[160:163], v[200:203]
  v_exp_f32 v64, v64
  v_mfma_f32_16x16x32_bf16 v[80:83], a[132:135], v[164:167], v[80:83]
  v_mfma_f32_16x16x32_bf16 v[80:83], a[136:139], v[168:171], v[80:83]
  v_exp_f32 v65, v65
  v_mfma_f32_16x16x32_bf16 v[80:83], a[140:143], v[172:175], v[80:83]
  v_cvt_pk_bf16_f32 v64, v64, v65
  v_mfma_f32_16x16x32_bf16 v[88:91], a[140:143], v[188:191], v[204:207]
  v_exp_f32 v66, v66
  v_mfma_f32_16x16x32_bf16 v[88:91], a[136:139], v[184:187], v[88:91]
  buffer_load_dwordx4 v253, s[24:27], s9 offen offset:2048 sc1 lds
  v_mfma_f32_16x16x32_bf16 v[88:91], a[132:135], v[180:183], v[88:91]
  s_waitcnt lgkmcnt(0)
  v_exp_f32 v67, v67
  v_mfma_f32_16x16x32_bf16 v[88:91], a[128:131], v[176:179], v[88:91]
  v_cvt_pk_bf16_f32 v65, v66, v67
  v_mfma_f32_16x16x32_bf16 v[68:71], a[144:147], v[128:131], v[192:195]
  v_exp_f32 v72, v72
  v_mfma_f32_16x16x32_bf16 v[68:71], a[148:151], v[132:135], v[68:71]
  ds_read_b128 a[128:131], v212 offset:57344
  v_mfma_f32_16x16x32_bf16 v[68:71], a[152:155], v[136:139], v[68:71]
  v_exp_f32 v73, v73
  v_mfma_f32_16x16x32_bf16 v[68:71], a[156:159], v[140:143], v[68:71]
  ds_read_b128 a[132:135], v213 offset:57344
  v_cvt_pk_bf16_f32 v72, v72, v73
  v_mfma_f32_16x16x32_bf16 v[76:79], a[156:159], v[156:159], v[196:199]
  v_exp_f32 v74, v74
  v_mfma_f32_16x16x32_bf16 v[76:79], a[152:155], v[152:155], v[76:79]
  ds_read_b128 a[136:139], v214 offset:57344
  v_mfma_f32_16x16x32_bf16 v[76:79], a[148:151], v[148:151], v[76:79]
  v_exp_f32 v75, v75
  v_mfma_f32_16x16x32_bf16 v[76:79], a[144:147], v[144:147], v[76:79]
  ds_read_b128 a[140:143], v215 offset:57344
  v_cvt_pk_bf16_f32 v73, v74, v75
  v_mfma_f32_16x16x32_bf16 v[84:87], a[144:147], v[160:163], v[200:203]
  v_exp_f32 v80, v80
  v_mfma_f32_16x16x32_bf16 v[84:87], a[148:151], v[164:167], v[84:87]
  buffer_load_dwordx4 v253, s[24:27], s9 offen offset:3072 sc1 lds
  v_mfma_f32_16x16x32_bf16 v[84:87], a[152:155], v[168:171], v[84:87]
  s_add_u32 s29, s29, 16384
  v_exp_f32 v81, v81
  v_mfma_f32_16x16x32_bf16 v[84:87], a[156:159], v[172:175], v[84:87]
  v_cvt_pk_bf16_f32 v80, v80, v81
  v_mfma_f32_16x16x32_bf16 v[92:95], a[156:159], v[188:191], v[204:207]
  s_add_u32 m0, s28, 32768
  v_exp_f32 v82, v82
  v_mfma_f32_16x16x32_bf16 v[92:95], a[152:155], v[184:187], v[92:95]
  buffer_load_dwordx4 v252, s[24:27], s9 offen offset:0 sc1 lds
  v_mfma_f32_16x16x32_bf16 v[92:95], a[148:151], v[180:183], v[92:95]
  s_waitcnt lgkmcnt(0)
  v_exp_f32 v83, v83
  v_mfma_f32_16x16x32_bf16 v[92:95], a[144:147], v[176:179], v[92:95]
  v_cvt_pk_bf16_f32 v81, v82, v83
  v_mfma_f32_16x16x32_bf16 v[96:99], a[128:131], v[128:131], v[192:195]
  v_exp_f32 v88, v88
  v_mfma_f32_16x16x32_bf16 v[96:99], a[132:135], v[132:135], v[96:99]
  ds_read_b128 a[144:147], v212 offset:61440
  v_mfma_f32_16x16x32_bf16 v[96:99], a[136:139], v[136:139], v[96:99]
  v_exp_f32 v89, v89
  v_mfma_f32_16x16x32_bf16 v[96:99], a[140:143], v[140:143], v[96:99]
  ds_read_b128 a[148:151], v213 offset:61440
  v_cvt_pk_bf16_f32 v88, v88, v89
  v_mfma_f32_16x16x32_bf16 v[104:107], a[140:143], v[156:159], v[196:199]
  v_exp_f32 v90, v90
  v_mfma_f32_16x16x32_bf16 v[104:107], a[136:139], v[152:155], v[104:107]
  ds_read_b128 a[152:155], v214 offset:61440
  v_mfma_f32_16x16x32_bf16 v[104:107], a[132:135], v[148:151], v[104:107]
  v_exp_f32 v91, v91
  v_mfma_f32_16x16x32_bf16 v[104:107], a[128:131], v[144:147], v[104:107]
  ds_read_b128 a[156:159], v215 offset:61440
  v_cvt_pk_bf16_f32 v89, v90, v91
  v_mfma_f32_16x16x32_bf16 v[112:115], a[128:131], v[160:163], v[200:203]
  v_exp_f32 v68, v68
  v_mfma_f32_16x16x32_bf16 v[112:115], a[132:135], v[164:167], v[112:115]
  buffer_load_dwordx4 v252, s[24:27], s9 offen offset:1024 sc1 lds
  v_mfma_f32_16x16x32_bf16 v[112:115], a[136:139], v[168:171], v[112:115]
  v_exp_f32 v69, v69
  v_mfma_f32_16x16x32_bf16 v[112:115], a[140:143], v[172:175], v[112:115]
  v_cvt_pk_bf16_f32 v66, v68, v69
  v_mfma_f32_16x16x32_bf16 v[120:123], a[140:143], v[188:191], v[204:207]
  v_exp_f32 v70, v70
  v_mfma_f32_16x16x32_bf16 v[120:123], a[136:139], v[184:187], v[120:123]
  buffer_load_dwordx4 v252, s[24:27], s9 offen offset:2048 sc1 lds
  v_mfma_f32_16x16x32_bf16 v[120:123], a[132:135], v[180:183], v[120:123]
  s_waitcnt lgkmcnt(0)
  v_exp_f32 v71, v71
  v_mfma_f32_16x16x32_bf16 v[120:123], a[128:131], v[176:179], v[120:123]
  v_cvt_pk_bf16_f32 v67, v70, v71
  v_mfma_f32_16x16x32_bf16 v[100:103], a[144:147], v[128:131], v[192:195]
  v_exp_f32 v76, v76
  v_mfma_f32_16x16x32_bf16 v[100:103], a[148:151], v[132:135], v[100:103]
  ds_read_b64_tr_b16 a[160:161], v216 offset:32768
  v_mfma_f32_16x16x32_bf16 v[100:103], a[152:155], v[136:139], v[100:103]
  v_exp_f32 v77, v77
  v_mfma_f32_16x16x32_bf16 v[100:103], a[156:159], v[140:143], v[100:103]
  ds_read_b64_tr_b16 a[162:163], v216 offset:36864
  v_cvt_pk_bf16_f32 v74, v76, v77
  v_mfma_f32_16x16x32_bf16 v[108:111], a[156:159], v[156:159], v[196:199]
  v_exp_f32 v78, v78
  v_mfma_f32_16x16x32_bf16 v[108:111], a[152:155], v[152:155], v[108:111]
  ds_read_b64_tr_b16 a[164:165], v216 offset:40960
  buffer_load_dwordx4 v252, s[24:27], s9 offen offset:3072 sc1 lds
  v_mfma_f32_16x16x32_bf16 v[108:111], a[148:151], v[148:151], v[108:111]
  v_exp_f32 v79, v79
  v_mfma_f32_16x16x32_bf16 v[108:111], a[144:147], v[144:147], v[108:111]
  ds_read_b64_tr_b16 a[166:167], v216 offset:45056
  v_cvt_pk_bf16_f32 v75, v78, v79
  v_mfma_f32_16x16x32_bf16 v[116:119], a[144:147], v[160:163], v[200:203]
  v_exp_f32 v84, v84
  v_mfma_f32_16x16x32_bf16 v[116:119], a[148:151], v[164:167], v[116:119]
  ds_read_b64_tr_b16 a[168:169], v217 offset:32768
  buffer_load_dwordx4 a[236:239], v252, s[24:27], s4 offen offset:2048 sc1
  v_mfma_f32_16x16x32_bf16 v[116:119], a[152:155], v[168:171], v[116:119]
  v_exp_f32 v85, v85
  v_mfma_f32_16x16x32_bf16 v[116:119], a[156:159], v[172:175], v[116:119]
  ds_read_b64_tr_b16 a[170:171], v217 offset:36864
  v_cvt_pk_bf16_f32 v82, v84, v85
  v_mfma_f32_16x16x32_bf16 v[124:127], a[156:159], v[188:191], v[204:207]
  v_exp_f32 v86, v86
  v_mfma_f32_16x16x32_bf16 v[124:127], a[152:155], v[184:187], v[124:127]
  ds_read_b64_tr_b16 a[172:173], v217 offset:40960
  v_mfma_f32_16x16x32_bf16 v[124:127], a[148:151], v[180:183], v[124:127]
  v_exp_f32 v87, v87
  v_mfma_f32_16x16x32_bf16 v[124:127], a[144:147], v[176:179], v[124:127]
  ds_read_b64_tr_b16 a[174:175], v217 offset:45056
  v_cvt_pk_bf16_f32 v83, v86, v87
  v_mfma_f32_16x16x32_bf16 a[192:195], a[208:211], v[0:3], a[192:195]
  v_exp_f32 v92, v92
  v_mfma_f32_16x16x32_bf16 a[192:195], a[208:211], v[32:35], a[192:195]
  ds_read_b64_tr_b16 a[176:177], v218 offset:32768
  buffer_load_dwordx4 a[240:243], v252, s[24:27], s4 offen offset:3072 sc1
  v_mfma_f32_16x16x32_bf16 a[196:199], a[208:211], v[8:11], a[196:199]
  v_exp_f32 v93, v93
  v_mfma_f32_16x16x32_bf16 a[196:199], a[208:211], v[40:43], a[196:199]
  ds_read_b64_tr_b16 a[178:179], v218 offset:36864
  v_cvt_pk_bf16_f32 v90, v92, v93
  v_mfma_f32_16x16x32_bf16 a[200:203], a[208:211], v[16:19], a[200:203]
  v_exp_f32 v94, v94
  v_mfma_f32_16x16x32_bf16 a[200:203], a[208:211], v[48:51], a[200:203]
  ds_read_b64_tr_b16 a[180:181], v218 offset:40960
  v_mfma_f32_16x16x32_bf16 a[204:207], a[208:211], v[24:27], a[204:207]
  s_waitcnt lgkmcnt(7)
  v_exp_f32 v95, v95
  v_mfma_f32_16x16x32_bf16 a[204:207], a[208:211], v[56:59], a[204:207]
  ds_read_b64_tr_b16 a[182:183], v218 offset:45056
  v_cvt_pk_bf16_f32 v91, v94, v95
  v_mfma_f32_16x16x32_bf16 a[0:3], a[160:163], v[0:3], a[0:3]
  v_exp_f32 v96, v96
  v_mfma_f32_16x16x32_bf16 a[0:3], a[164:167], v[32:35], a[0:3]
  ds_read_b64_tr_b16 a[184:185], v219 offset:32768
  buffer_load_dwordx4 a[244:247], v253, s[24:27], s4 offen offset:0 sc1
  v_mfma_f32_16x16x32_bf16 a[4:7], a[164:167], v[40:43], a[4:7]
  v_exp_f32 v97, v97
  v_mfma_f32_16x16x32_bf16 a[4:7], a[160:163], v[8:11], a[4:7]
  ds_read_b64_tr_b16 a[186:187], v219 offset:36864
  v_cvt_pk_bf16_f32 v96, v96, v97
  v_mfma_f32_16x16x32_bf16 a[8:11], a[160:163], v[16:19], a[8:11]
  v_exp_f32 v98, v98
  v_mfma_f32_16x16x32_bf16 a[8:11], a[164:167], v[48:51], a[8:11]
  ds_read_b64_tr_b16 a[188:189], v219 offset:40960
  v_mfma_f32_16x16x32_bf16 a[12:15], a[164:167], v[56:59], a[12:15]
  s_waitcnt lgkmcnt(7)
  v_exp_f32 v99, v99
  v_mfma_f32_16x16x32_bf16 a[12:15], a[160:163], v[24:27], a[12:15]
  ds_read_b64_tr_b16 a[190:191], v219 offset:45056
  v_cvt_pk_bf16_f32 v97, v98, v99
  v_mfma_f32_16x16x32_bf16 a[16:19], a[168:171], v[0:3], a[16:19]
  v_exp_f32 v104, v104
  v_mfma_f32_16x16x32_bf16 a[16:19], a[172:175], v[32:35], a[16:19]
  ds_read_b64_tr_b16 a[160:161], v220 offset:32768
  buffer_load_dwordx4 a[248:251], v253, s[24:27], s4 offen offset:1024 sc1
  v_mfma_f32_16x16x32_bf16 a[20:23], a[172:175], v[40:43], a[20:23]
  v_exp_f32 v105, v105
  v_mfma_f32_16x16x32_bf16 a[20:23], a[168:171], v[8:11], a[20:23]
  ds_read_b64_tr_b16 a[162:163], v220 offset:36864
  v_cvt_pk_bf16_f32 v104, v104, v105
  v_mfma_f32_16x16x32_bf16 a[24:27], a[168:171], v[16:19], a[24:27]
  v_exp_f32 v106, v106
  v_mfma_f32_16x16x32_bf16 a[24:27], a[172:175], v[48:51], a[24:27]
  ds_read_b64_tr_b16 a[164:165], v220 offset:40960
  v_mfma_f32_16x16x32_bf16 a[28:31], a[172:175], v[56:59], a[28:31]
  s_waitcnt lgkmcnt(7)
  v_exp_f32 v107, v107
  v_mfma_f32_16x16x32_bf16 a[28:31], a[168:171], v[24:27], a[28:31]
  ds_read_b64_tr_b16 a[166:167], v220 offset:45056
  v_cvt_pk_bf16_f32 v105, v106, v107
  v_mfma_f32_16x16x32_bf16 a[32:35], a[176:179], v[0:3], a[32:35]
  v_exp_f32 v112, v112
  v_mfma_f32_16x16x32_bf16 a[32:35], a[180:183], v[32:35], a[32:35]
  ds_read_b64_tr_b16 a[168:169], v221 offset:32768
  buffer_load_dwordx4 a[252:255], v253, s[24:27], s4 offen offset:2048 sc1
  v_mfma_f32_16x16x32_bf16 a[36:39], a[180:183], v[40:43], a[36:39]
  v_exp_f32 v113, v113
  v_mfma_f32_16x16x32_bf16 a[36:39], a[176:179], v[8:11], a[36:39]
  ds_read_b64_tr_b16 a[170:171], v221 offset:36864
  v_cvt_pk_bf16_f32 v112, v112, v113
  v_mfma_f32_16x16x32_bf16 a[40:43], a[176:179], v[16:19], a[40:43]
  v_exp_f32 v114, v114
  v_mfma_f32_16x16x32_bf16 a[40:43], a[180:183], v[48:51], a[40:43]
  ds_read_b64_tr_b16 a[172:173], v221 offset:40960
  v_mfma_f32_16x16x32_bf16 a[44:47], a[180:183], v[56:59], a[44:47]
  s_waitcnt lgkmcnt(7)
  v_exp_f32 v115, v115
  v_mfma_f32_16x16x32_bf16 a[44:47], a[176:179], v[24:27], a[44:47]
  ds_read_b64_tr_b16 a[174:175], v221 offset:45056
  v_cvt_pk_bf16_f32 v113, v114, v115
  v_mfma_f32_16x16x32_bf16 a[48:51], a[184:187], v[0:3], a[48:51]
  v_exp_f32 v120, v120
  v_mfma_f32_16x16x32_bf16 a[48:51], a[188:191], v[32:35], a[48:51]
  ds_read_b64_tr_b16 a[176:177], v222 offset:32768
  v_mfma_f32_16x16x32_bf16 a[52:55], a[188:191], v[40:43], a[52:55]
  v_exp_f32 v121, v121
  v_mfma_f32_16x16x32_bf16 a[52:55], a[184:187], v[8:11], a[52:55]
  ds_read_b64_tr_b16 a[178:179], v222 offset:36864
  v_cvt_pk_bf16_f32 v120, v120, v121
  v_mfma_f32_16x16x32_bf16 a[56:59], a[184:187], v[16:19], a[56:59]
  v_exp_f32 v122, v122
  v_mfma_f32_16x16x32_bf16 a[56:59], a[188:191], v[48:51], a[56:59]
  ds_read_b64_tr_b16 a[180:181], v222 offset:40960
  v_mfma_f32_16x16x32_bf16 a[60:63], a[188:191], v[56:59], a[60:63]
  s_waitcnt lgkmcnt(7)
  v_exp_f32 v123, v123
  v_mfma_f32_16x16x32_bf16 a[60:63], a[184:187], v[24:27], a[60:63]
  ds_read_b64_tr_b16 a[182:183], v222 offset:45056
  v_cvt_pk_bf16_f32 v121, v122, v123
  v_mfma_f32_16x16x32_bf16 a[64:67], a[160:163], v[0:3], a[64:67]
  v_exp_f32 v100, v100
  v_mfma_f32_16x16x32_bf16 a[64:67], a[164:167], v[32:35], a[64:67]
  ds_read_b64_tr_b16 a[184:185], v223 offset:32768
  v_mfma_f32_16x16x32_bf16 a[68:71], a[164:167], v[40:43], a[68:71]
  v_exp_f32 v101, v101
  v_mfma_f32_16x16x32_bf16 a[68:71], a[160:163], v[8:11], a[68:71]
  ds_read_b64_tr_b16 a[186:187], v223 offset:36864
  v_cvt_pk_bf16_f32 v98, v100, v101
  v_mfma_f32_16x16x32_bf16 a[72:75], a[160:163], v[16:19], a[72:75]
  v_exp_f32 v102, v102
  v_mfma_f32_16x16x32_bf16 a[72:75], a[164:167], v[48:51], a[72:75]
  ds_read_b64_tr_b16 a[188:189], v223 offset:40960
  v_mfma_f32_16x16x32_bf16 a[76:79], a[164:167], v[56:59], a[76:79]
  s_waitcnt lgkmcnt(7)
  v_exp_f32 v103, v103
  v_mfma_f32_16x16x32_bf16 a[76:79], a[160:163], v[24:27], a[76:79]
  ds_read_b64_tr_b16 a[190:191], v223 offset:45056
  v_cvt_pk_bf16_f32 v99, v102, v103
  v_mfma_f32_16x16x32_bf16 a[80:83], a[168:171], v[0:3], a[80:83]
  s_waitcnt vmcnt(19)
  v_exp_f32 v108, v108
  v_mfma_f32_16x16x32_bf16 a[80:83], a[172:175], v[32:35], a[80:83]
  v_mfma_f32_16x16x32_bf16 a[84:87], a[172:175], v[40:43], a[84:87]
  s_barrier
  v_exp_f32 v109, v109
  v_mfma_f32_16x16x32_bf16 a[84:87], a[168:171], v[8:11], a[84:87]
  s_mul_i32 s39, s99, 13108
  s_lshr_b32 s39, s39, 16
  s_lshl_b32 s39, s39, 8
  v_cvt_pk_bf16_f32 v106, v108, v109
  v_mfma_f32_16x16x32_bf16 a[88:91], a[168:171], v[16:19], a[88:91]
  s_add_u32 s39, s39, 2818304
  s_cmp_lt_u32 s2, 240
  s_cselect_b32 s48, 0, 1073741824
  v_exp_f32 v110, v110
  v_mfma_f32_16x16x32_bf16 a[88:91], a[172:175], v[48:51], a[88:91]
  v_or_b32 v249, s48, v251
  v_mfma_f32_16x16x32_bf16 a[92:95], a[172:175], v[56:59], a[92:95]
  s_waitcnt lgkmcnt(4)
  v_exp_f32 v111, v111
  v_mfma_f32_16x16x32_bf16 a[92:95], a[168:171], v[24:27], a[92:95]
  buffer_atomic_add v250, v249, s[24:27], s39 offen
  v_cvt_pk_bf16_f32 v107, v110, v111
  v_mfma_f32_16x16x32_bf16 a[96:99], a[176:179], v[0:3], a[96:99]
  v_exp_f32 v116, v116
  v_mfma_f32_16x16x32_bf16 a[96:99], a[180:183], v[32:35], a[96:99]
  v_mfma_f32_16x16x32_bf16 a[100:103], a[180:183], v[40:43], a[100:103]
  v_exp_f32 v117, v117
  v_mfma_f32_16x16x32_bf16 a[100:103], a[176:179], v[8:11], a[100:103]
  v_cvt_pk_bf16_f32 v114, v116, v117
  v_mfma_f32_16x16x32_bf16 a[104:107], a[176:179], v[16:19], a[104:107]
  v_exp_f32 v118, v118
  v_mfma_f32_16x16x32_bf16 a[104:107], a[180:183], v[48:51], a[104:107]
  v_mfma_f32_16x16x32_bf16 a[108:111], a[180:183], v[56:59], a[108:111]
  s_waitcnt lgkmcnt(0)
  v_exp_f32 v119, v119
  v_mfma_f32_16x16x32_bf16 a[108:111], a[176:179], v[24:27], a[108:111]
  v_cvt_pk_bf16_f32 v115, v118, v119
  v_mfma_f32_16x16x32_bf16 a[112:115], a[184:187], v[0:3], a[112:115]
  v_exp_f32 v124, v124
  v_mfma_f32_16x16x32_bf16 a[112:115], a[188:191], v[32:35], a[112:115]
  v_mfma_f32_16x16x32_bf16 a[116:119], a[188:191], v[40:43], a[116:119]
  v_exp_f32 v125, v125
  v_mfma_f32_16x16x32_bf16 a[116:119], a[184:187], v[8:11], a[116:119]
  v_cvt_pk_bf16_f32 v122, v124, v125
  v_mfma_f32_16x16x32_bf16 a[120:123], a[184:187], v[16:19], a[120:123]
  v_exp_f32 v126, v126
  v_mfma_f32_16x16x32_bf16 a[120:123], a[188:191], v[48:51], a[120:123]
  v_mfma_f32_16x16x32_bf16 a[124:127], a[188:191], v[56:59], a[124:127]
  v_exp_f32 v127, v127
  v_mfma_f32_16x16x32_bf16 a[124:127], a[184:187], v[24:27], a[124:127]
  v_cvt_pk_bf16_f32 v123, v126, v127
  ds_read_b64_tr_b16 a[160:161], v216 offset:49152
  ds_read_b64_tr_b16 a[162:163], v216 offset:53248
  ds_read_b64_tr_b16 a[164:165], v216 offset:57344
  ds_read_b64_tr_b16 a[166:167], v216 offset:61440
  ds_read_b64_tr_b16 a[168:169], v217 offset:49152
  ds_read_b64_tr_b16 a[170:171], v217 offset:53248
  ds_read_b64_tr_b16 a[172:173], v217 offset:57344
  ds_read_b64_tr_b16 a[174:175], v217 offset:61440
  s_mov_b32 s48, 0x53800000
  s_lshl_b32 s39, s3, 8
  v_mfma_f32_16x16x32_bf16 a[192:195], a[208:211], v[64:67], a[192:195]
  s_add_u32 m0, s28, 81920
  v_mfma_f32_16x16x32_bf16 a[192:195], a[208:211], v[96:99], a[192:195]
  v_mfma_f32_16x16x32_bf16 a[196:199], a[208:211], v[72:75], a[196:199]
  buffer_load_dwordx4 v242, s[24:27], s10 offen offset:0 sc1 lds
  v_mfma_f32_16x16x32_bf16 a[196:199], a[208:211], v[104:107], a[196:199]
  v_mfma_f32_16x16x32_bf16 a[200:203], a[208:211], v[80:83], a[200:203]
  buffer_load_dwordx4 v242, s[24:27], s10 offen offset:1024 sc1 lds
  v_mfma_f32_16x16x32_bf16 a[200:203], a[208:211], v[112:115], a[200:203]
  v_mfma_f32_16x16x32_bf16 a[204:207], a[208:211], v[88:91], a[204:207]
  buffer_load_dwordx4 v242, s[24:27], s10 offen offset:2048 sc1 lds
  v_mfma_f32_16x16x32_bf16 a[204:207], a[208:211], v[120:123], a[204:207]
  s_waitcnt lgkmcnt(4)
  v_mfma_f32_16x16x32_bf16 a[0:3], a[160:163], v[64:67], a[0:3]
  buffer_load_dwordx4 v242, s[24:27], s10 offen offset:3072 sc1 lds
  v_mfma_f32_16x16x32_bf16 a[0:3], a[164:167], v[96:99], a[0:3]
  ds_read_b64_tr_b16 a[176:177], v218 offset:49152
  v_mfma_f32_16x16x32_bf16 a[4:7], a[164:167], v[104:107], a[4:7]
  buffer_load_dwordx4 a[128:131], v253, s[24:27], s4 offen offset:3072 sc1
  v_mfma_f32_16x16x32_bf16 a[4:7], a[160:163], v[72:75], a[4:7]
  ds_read_b64_tr_b16 a[178:179], v218 offset:53248
  v_accvgpr_read_b32 v208, a192
  v_mfma_f32_16x16x32_bf16 a[8:11], a[160:163], v[80:83], a[8:11]
  v_accvgpr_read_b32 v209, a196
  v_accvgpr_read_b32 v210, a200
  v_mfma_f32_16x16x32_bf16 a[8:11], a[164:167], v[112:115], a[8:11]
  ds_read_b64_tr_b16 a[180:181], v218 offset:57344
  v_accvgpr_read_b32 v211, a204
  v_mfma_f32_16x16x32_bf16 a[12:15], a[164:167], v[120:123], a[12:15]
  v_mov_b32 v245, v208
  v_mov_b32 v246, v209
  v_mfma_f32_16x16x32_bf16 a[12:15], a[160:163], v[88:91], a[12:15]
  ds_read_b64_tr_b16 a[182:183], v218 offset:61440
  s_waitcnt lgkmcnt(4)
  v_mov_b32 v247, v210
  v_mfma_f32_16x16x32_bf16 a[16:19], a[168:171], v[64:67], a[16:19]
  v_mov_b32 v248, v211
  v_permlane16_swap_b32 v208, v245
  v_mfma_f32_16x16x32_bf16 a[16:19], a[172:175], v[96:99], a[16:19]
  ds_read_b64_tr_b16 a[184:185], v219 offset:49152
  v_permlane16_swap_b32 v209, v246
  v_mfma_f32_16x16x32_bf16 a[20:23], a[172:175], v[104:107], a[20:23]
  v_permlane16_swap_b32 v210, v247
  v_permlane16_swap_b32 v211, v248
  v_mfma_f32_16x16x32_bf16 a[20:23], a[168:171], v[72:75], a[20:23]
  ds_read_b64_tr_b16 a[186:187], v219 offset:53248
  v_add_f32 v208, v208, v245
  v_mfma_f32_16x16x32_bf16 a[24:27], a[168:171], v[80:83], a[24:27]
  v_add_f32 v209, v209, v246
  v_add_f32 v210, v210, v247
  v_mfma_f32_16x16x32_bf16 a[24:27], a[172:175], v[112:115], a[24:27]
  ds_read_b64_tr_b16 a[188:189], v219 offset:57344
  v_add_f32 v211, v211, v248
  v_mfma_f32_16x16x32_bf16 a[28:31], a[172:175], v[120:123], a[28:31]
  v_mov_b32 v245, v208
  v_mov_b32 v246, v209
  v_mfma_f32_16x16x32_bf16 a[28:31], a[168:171], v[88:91], a[28:31]
  ds_read_b64_tr_b16 a[190:191], v219 offset:61440
  s_waitcnt lgkmcnt(4)
  v_mov_b32 v247, v210
  v_mfma_f32_16x16x32_bf16 a[32:35], a[176:179], v[64:67], a[32:35]
  v_mov_b32 v248, v211
  v_permlane32_swap_b32 v208, v245
  v_mfma_f32_16x16x32_bf16 a[32:35], a[180:183], v[96:99], a[32:35]
  ds_read_b64_tr_b16 a[160:161], v220 offset:49152
  v_permlane32_swap_b32 v209, v246
  v_mfma_f32_16x16x32_bf16 a[36:39], a[180:183], v[104:107], a[36:39]
  v_permlane32_swap_b32 v210, v247
  v_permlane32_swap_b32 v211, v248
  v_mfma_f32_16x16x32_bf16 a[36:39], a[176:179], v[72:75], a[36:39]
  ds_read_b64_tr_b16 a[162:163], v220 offset:53248
  v_add_f32 v208, v208, v245
  v_mfma_f32_16x16x32_bf16 a[40:43], a[176:179], v[80:83], a[40:43]
  v_add_f32 v209, v209, v246
  v_add_f32 v210, v210, v247
  v_mfma_f32_16x16x32_bf16 a[40:43], a[180:183], v[112:115], a[40:43]
  ds_read_b64_tr_b16 a[164:165], v220 offset:57344
  v_add_f32 v211, v211, v248
  buffer_load_dwordx4 a[132:135], v242, s[24:27], s5 offen offset:0 sc1
  buffer_load_dwordx4 a[136:139], v242, s[24:27], s5 offen offset:1024 sc1
  buffer_load_dwordx4 a[140:143], v242, s[24:27], s5 offen offset:2048 sc1
  buffer_load_dwordx4 a[144:147], v242, s[24:27], s5 offen offset:3072 sc1
  buffer_load_dwordx4 a[148:151], v252, s[24:27], s5 offen offset:0 sc1
  buffer_load_dwordx4 a[152:155], v252, s[24:27], s5 offen offset:1024 sc1
  buffer_load_dwordx4 a[156:159], v252, s[24:27], s5 offen offset:2048 sc1
  v_mfma_f32_16x16x32_bf16 a[44:47], a[180:183], v[120:123], a[44:47]
  v_rcp_f32 v192, v208
  v_mfma_f32_16x16x32_bf16 a[44:47], a[176:179], v[88:91], a[44:47]
  ds_read_b64_tr_b16 a[166:167], v220 offset:61440
  s_waitcnt lgkmcnt(4)
  v_mfma_f32_16x16x32_bf16 a[48:51], a[184:187], v[64:67], a[48:51]
  v_rcp_f32 v196, v209
  v_mfma_f32_16x16x32_bf16 a[48:51], a[188:191], v[96:99], a[48:51]
  ds_read_b64_tr_b16 a[168:169], v221 offset:49152
  v_mfma_f32_16x16x32_bf16 a[52:55], a[188:191], v[104:107], a[52:55]
  v_rcp_f32 v200, v210
  v_mfma_f32_16x16x32_bf16 a[52:55], a[184:187], v[72:75], a[52:55]
  ds_read_b64_tr_b16 a[170:171], v221 offset:53248
  v_mfma_f32_16x16x32_bf16 a[56:59], a[184:187], v[80:83], a[56:59]
  v_rcp_f32 v204, v211
  v_mfma_f32_16x16x32_bf16 a[56:59], a[188:191], v[112:115], a[56:59]
  ds_read_b64_tr_b16 a[172:173], v221 offset:57344
  v_add_f32 v246, v208, v209
  v_mfma_f32_16x16x32_bf16 a[60:63], a[188:191], v[120:123], a[60:63]
  v_add_f32 v247, v210, v211
  v_add_f32 v246, v246, v247
  v_mfma_f32_16x16x32_bf16 a[60:63], a[184:187], v[88:91], a[60:63]
  ds_read_b64_tr_b16 a[174:175], v221 offset:61440
  s_waitcnt lgkmcnt(4)
  v_lshrrev_b32 v247, 2, v242
  v_mfma_f32_16x16x32_bf16 a[64:67], a[160:163], v[64:67], a[64:67]
  v_cmp_nlt_f32 vcc, v246, s48
  v_add_u32 v247, s39, v247
  v_mfma_f32_16x16x32_bf16 a[64:67], a[164:167], v[96:99], a[64:67]
  ds_read_b64_tr_b16 a[176:177], v222 offset:49152
  v_add_u32 v247, 157696, v247
  v_mfma_f32_16x16x32_bf16 a[68:71], a[164:167], v[104:107], a[68:71]
  v_cndmask_b32_e64 v245, 0, 1, vcc
  v_accvgpr_read_b32 v0, a0
  v_mfma_f32_16x16x32_bf16 a[68:71], a[160:163], v[72:75], a[68:71]
  ds_read_b64_tr_b16 a[178:179], v222 offset:53248
  v_accvgpr_read_b32 v1, a1
  v_mfma_f32_16x16x32_bf16 a[72:75], a[160:163], v[80:83], a[72:75]
  v_accvgpr_read_b32 v2, a2
  v_accvgpr_read_b32 v3, a3
  v_mfma_f32_16x16x32_bf16 a[72:75], a[164:167], v[112:115], a[72:75]
  ds_read_b64_tr_b16 a[180:181], v222 offset:57344
  v_accvgpr_read_b32 v4, a16
  v_mfma_f32_16x16x32_bf16 a[76:79], a[164:167], v[120:123], a[76:79]
  v_accvgpr_read_b32 v5, a17
  v_accvgpr_read_b32 v6, a18
  v_mfma_f32_16x16x32_bf16 a[76:79], a[160:163], v[88:91], a[76:79]
  ds_read_b64_tr_b16 a[182:183], v222 offset:61440
  s_waitcnt lgkmcnt(4)
  v_accvgpr_read_b32 v7, a19
  v_mfma_f32_16x16x32_bf16 a[80:83], a[168:171], v[64:67], a[80:83]
  v_mul_f32 v0, v0, v192
  v_mul_f32 v1, v1, v192
  v_mfma_f32_16x16x32_bf16 a[80:83], a[172:175], v[96:99], a[80:83]
  ds_read_b64_tr_b16 a[184:185], v223 offset:49152
  v_mul_f32 v2, v2, v192
  v_mfma_f32_16x16x32_bf16 a[84:87], a[172:175], v[104:107], a[84:87]
  v_mul_f32 v3, v3, v192
  v_mul_f32 v4, v4, v192
  v_mfma_f32_16x16x32_bf16 a[84:87], a[168:171], v[72:75], a[84:87]
  ds_read_b64_tr_b16 a[186:187], v223 offset:53248
  v_mul_f32 v5, v5, v192
  v_mfma_f32_16x16x32_bf16 a[88:91], a[168:171], v[80:83], a[88:91]
  v_mul_f32 v6, v6, v192
  v_mul_f32 v7, v7, v192
  v_mfma_f32_16x16x32_bf16 a[88:91], a[172:175], v[112:115], a[88:91]
  ds_read_b64_tr_b16 a[188:189], v223 offset:57344
  v_cvt_pk_bf16_f32 v0, v0, v1
  v_mfma_f32_16x16x32_bf16 a[92:95], a[172:175], v[120:123], a[92:95]
  v_cvt_pk_bf16_f32 v1, v2, v3
  v_cvt_pk_bf16_f32 v2, v4, v5
  v_mfma_f32_16x16x32_bf16 a[92:95], a[168:171], v[88:91], a[92:95]
  ds_read_b64_tr_b16 a[190:191], v223 offset:61440
  s_waitcnt lgkmcnt(4)
  v_cvt_pk_bf16_f32 v3, v6, v7
  v_mfma_f32_16x16x32_bf16 a[96:99], a[176:179], v[64:67], a[96:99]
  buffer_store_dwordx4 v[0:3], v244, s[24:27], s40 offen offset:0 sc1
  v_mfma_f32_16x16x32_bf16 a[96:99], a[180:183], v[96:99], a[96:99]
  v_accvgpr_read_b32 v8, a4
  v_accvgpr_read_b32 v9, a5
  v_mfma_f32_16x16x32_bf16 a[100:103], a[180:183], v[104:107], a[100:103]
  v_accvgpr_read_b32 v10, a6
  v_accvgpr_read_b32 v11, a7
  v_mfma_f32_16x16x32_bf16 a[100:103], a[176:179], v[72:75], a[100:103]
  v_accvgpr_read_b32 v12, a20
  v_accvgpr_read_b32 v13, a21
  v_mfma_f32_16x16x32_bf16 a[104:107], a[176:179], v[80:83], a[104:107]
  v_accvgpr_read_b32 v14, a22
  v_accvgpr_read_b32 v15, a23
  v_mfma_f32_16x16x32_bf16 a[104:107], a[180:183], v[112:115], a[104:107]
  v_mul_f32 v8, v8, v196
  v_mul_f32 v9, v9, v196
  v_mfma_f32_16x16x32_bf16 a[108:111], a[180:183], v[120:123], a[108:111]
  v_mul_f32 v10, v10, v196
  v_mul_f32 v11, v11, v196
  v_mfma_f32_16x16x32_bf16 a[108:111], a[176:179], v[88:91], a[108:111]
  s_waitcnt lgkmcnt(0)
  v_mul_f32 v12, v12, v196
  v_mul_f32 v13, v13, v196
  v_mfma_f32_16x16x32_bf16 a[112:115], a[184:187], v[64:67], a[112:115]
  v_mul_f32 v14, v14, v196
  v_mul_f32 v15, v15, v196
  v_mfma_f32_16x16x32_bf16 a[112:115], a[188:191], v[96:99], a[112:115]
  v_cvt_pk_bf16_f32 v8, v8, v9
  v_cvt_pk_bf16_f32 v9, v10, v11
  v_mfma_f32_16x16x32_bf16 a[116:119], a[188:191], v[104:107], a[116:119]
  v_cvt_pk_bf16_f32 v10, v12, v13
  v_cvt_pk_bf16_f32 v11, v14, v15
  v_mfma_f32_16x16x32_bf16 a[116:119], a[184:187], v[72:75], a[116:119]
  buffer_store_dwordx4 v[8:11], v244, s[24:27], s40 offen offset:2048 sc1
  v_mfma_f32_16x16x32_bf16 a[120:123], a[184:187], v[80:83], a[120:123]
  v_accvgpr_read_b32 v16, a8
  v_accvgpr_read_b32 v17, a9
  v_mfma_f32_16x16x32_bf16 a[120:123], a[188:191], v[112:115], a[120:123]
  v_accvgpr_read_b32 v18, a10
  v_accvgpr_read_b32 v19, a11
  v_mfma_f32_16x16x32_bf16 a[124:127], a[188:191], v[120:123], a[124:127]
  v_accvgpr_read_b32 v20, a24
  v_accvgpr_read_b32 v21, a25
  v_mfma_f32_16x16x32_bf16 a[124:127], a[184:187], v[88:91], a[124:127]
  v_accvgpr_read_b32 v22, a26
  v_accvgpr_read_b32 v23, a27
  v_pk_mul_f32 v[16:17], v[16:17], v[200:201] op_sel_hi:[1,0]
  v_pk_mul_f32 v[18:19], v[18:19], v[200:201] op_sel_hi:[1,0]
  v_pk_mul_f32 v[20:21], v[20:21], v[200:201] op_sel_hi:[1,0]
  v_pk_mul_f32 v[22:23], v[22:23], v[200:201] op_sel_hi:[1,0]
  v_cvt_pk_bf16_f32 v16, v16, v17
  v_cvt_pk_bf16_f32 v17, v18, v19
  v_cvt_pk_bf16_f32 v18, v20, v21
  v_cvt_pk_bf16_f32 v19, v22, v23
  buffer_store_dwordx4 v[16:19], v244, s[24:27], s41 offen offset:0 sc1
  v_accvgpr_read_b32 v24, a12
  v_accvgpr_read_b32 v25, a13
  v_accvgpr_read_b32 v26, a14
  v_accvgpr_read_b32 v27, a15
  v_accvgpr_read_b32 v28, a28
  v_accvgpr_read_b32 v29, a29
  v_accvgpr_read_b32 v30, a30
  v_accvgpr_read_b32 v31, a31
  v_pk_mul_f32 v[24:25], v[24:25], v[204:205] op_sel_hi:[1,0]
  v_pk_mul_f32 v[26:27], v[26:27], v[204:205] op_sel_hi:[1,0]
  v_pk_mul_f32 v[28:29], v[28:29], v[204:205] op_sel_hi:[1,0]
  v_pk_mul_f32 v[30:31], v[30:31], v[204:205] op_sel_hi:[1,0]
  v_cvt_pk_bf16_f32 v24, v24, v25
  v_cvt_pk_bf16_f32 v25, v26, v27
  v_cvt_pk_bf16_f32 v26, v28, v29
  v_cvt_pk_bf16_f32 v27, v30, v31
  buffer_store_dwordx4 v[24:27], v244, s[24:27], s41 offen offset:2048 sc1
  v_accvgpr_read_b32 v32, a32
  v_accvgpr_read_b32 v33, a33
  v_accvgpr_read_b32 v34, a34
  v_accvgpr_read_b32 v35, a35
  v_accvgpr_read_b32 v36, a48
  v_accvgpr_read_b32 v37, a49
  v_accvgpr_read_b32 v38, a50
  v_accvgpr_read_b32 v39, a51
  v_pk_mul_f32 v[32:33], v[32:33], v[192:193] op_sel_hi:[1,0]
  v_pk_mul_f32 v[34:35], v[34:35], v[192:193] op_sel_hi:[1,0]
  v_pk_mul_f32 v[36:37], v[36:37], v[192:193] op_sel_hi:[1,0]
  v_pk_mul_f32 v[38:39], v[38:39], v[192:193] op_sel_hi:[1,0]
  v_cvt_pk_bf16_f32 v32, v32, v33
  v_cvt_pk_bf16_f32 v33, v34, v35
  v_cvt_pk_bf16_f32 v34, v36, v37
  v_cvt_pk_bf16_f32 v35, v38, v39
  buffer_store_dwordx4 v[32:35], v244, s[24:27], s40 offen offset:1024 sc1
  v_accvgpr_read_b32 v40, a36
  v_accvgpr_read_b32 v41, a37
  v_accvgpr_read_b32 v42, a38
  v_accvgpr_read_b32 v43, a39
  v_accvgpr_read_b32 v44, a52
  v_accvgpr_read_b32 v45, a53
  v_accvgpr_read_b32 v46, a54
  v_accvgpr_read_b32 v47, a55
  v_pk_mul_f32 v[40:41], v[40:41], v[196:197] op_sel_hi:[1,0]
  v_pk_mul_f32 v[42:43], v[42:43], v[196:197] op_sel_hi:[1,0]
  v_pk_mul_f32 v[44:45], v[44:45], v[196:197] op_sel_hi:[1,0]
  v_pk_mul_f32 v[46:47], v[46:47], v[196:197] op_sel_hi:[1,0]
  v_cvt_pk_bf16_f32 v40, v40, v41
  v_cvt_pk_bf16_f32 v41, v42, v43
  v_cvt_pk_bf16_f32 v42, v44, v45
  v_cvt_pk_bf16_f32 v43, v46, v47
  buffer_store_dwordx4 v[40:43], v244, s[24:27], s40 offen offset:3072 sc1
  v_accvgpr_read_b32 v48, a40
  v_accvgpr_read_b32 v49, a41
  v_accvgpr_read_b32 v50, a42
  v_accvgpr_read_b32 v51, a43
  v_accvgpr_read_b32 v52, a56
  v_accvgpr_read_b32 v53, a57
  v_accvgpr_read_b32 v54, a58
  v_accvgpr_read_b32 v55, a59
  v_pk_mul_f32 v[48:49], v[48:49], v[200:201] op_sel_hi:[1,0]
  v_pk_mul_f32 v[50:51], v[50:51], v[200:201] op_sel_hi:[1,0]
  v_pk_mul_f32 v[52:53], v[52:53], v[200:201] op_sel_hi:[1,0]
  v_pk_mul_f32 v[54:55], v[54:55], v[200:201] op_sel_hi:[1,0]
  v_cvt_pk_bf16_f32 v48, v48, v49
  v_cvt_pk_bf16_f32 v49, v50, v51
  v_cvt_pk_bf16_f32 v50, v52, v53
  v_cvt_pk_bf16_f32 v51, v54, v55
  buffer_store_dwordx4 v[48:51], v244, s[24:27], s41 offen offset:1024 sc1
  v_accvgpr_read_b32 v56, a44
  v_accvgpr_read_b32 v57, a45
  v_accvgpr_read_b32 v58, a46
  v_accvgpr_read_b32 v59, a47
  v_accvgpr_read_b32 v60, a60
  v_accvgpr_read_b32 v61, a61
  v_accvgpr_read_b32 v62, a62
  v_accvgpr_read_b32 v63, a63
  v_pk_mul_f32 v[56:57], v[56:57], v[204:205] op_sel_hi:[1,0]
  v_pk_mul_f32 v[58:59], v[58:59], v[204:205] op_sel_hi:[1,0]
  v_pk_mul_f32 v[60:61], v[60:61], v[204:205] op_sel_hi:[1,0]
  v_pk_mul_f32 v[62:63], v[62:63], v[204:205] op_sel_hi:[1,0]
  v_cvt_pk_bf16_f32 v56, v56, v57
  v_cvt_pk_bf16_f32 v57, v58, v59
  v_cvt_pk_bf16_f32 v58, v60, v61
  v_cvt_pk_bf16_f32 v59, v62, v63
  buffer_store_dwordx4 v[56:59], v244, s[24:27], s41 offen offset:3072 sc1
  v_accvgpr_read_b32 v0, a64
  v_accvgpr_read_b32 v1, a65
  v_accvgpr_read_b32 v2, a66
  v_accvgpr_read_b32 v3, a67
  v_accvgpr_read_b32 v4, a80
  v_accvgpr_read_b32 v5, a81
  v_accvgpr_read_b32 v6, a82
  v_accvgpr_read_b32 v7, a83
  v_pk_mul_f32 v[0:1], v[0:1], v[192:193] op_sel_hi:[1,0]
  v_pk_mul_f32 v[2:3], v[2:3], v[192:193] op_sel_hi:[1,0]
  v_pk_mul_f32 v[4:5], v[4:5], v[192:193] op_sel_hi:[1,0]
  v_pk_mul_f32 v[6:7], v[6:7], v[192:193] op_sel_hi:[1,0]
  v_cvt_pk_bf16_f32 v0, v0, v1
  v_cvt_pk_bf16_f32 v1, v2, v3
  v_cvt_pk_bf16_f32 v2, v4, v5
  v_cvt_pk_bf16_f32 v3, v6, v7
  buffer_store_dwordx4 v[0:3], v244, s[24:27], s42 offen offset:0 sc1
  v_accvgpr_read_b32 v8, a68
  v_accvgpr_read_b32 v9, a69
  v_accvgpr_read_b32 v10, a70
  v_accvgpr_read_b32 v11, a71
  v_accvgpr_read_b32 v12, a84
  v_accvgpr_read_b32 v13, a85
  v_accvgpr_read_b32 v14, a86
  v_accvgpr_read_b32 v15, a87
  v_pk_mul_f32 v[8:9], v[8:9], v[196:197] op_sel_hi:[1,0]
  v_pk_mul_f32 v[10:11], v[10:11], v[196:197] op_sel_hi:[1,0]
  v_pk_mul_f32 v[12:13], v[12:13], v[196:197] op_sel_hi:[1,0]
  v_pk_mul_f32 v[14:15], v[14:15], v[196:197] op_sel_hi:[1,0]
  v_cvt_pk_bf16_f32 v8, v8, v9
  v_cvt_pk_bf16_f32 v9, v10, v11
  v_cvt_pk_bf16_f32 v10, v12, v13
  v_cvt_pk_bf16_f32 v11, v14, v15
  buffer_store_dwordx4 v[8:11], v244, s[24:27], s42 offen offset:2048 sc1
  v_accvgpr_read_b32 v16, a72
  v_accvgpr_read_b32 v17, a73
  v_accvgpr_read_b32 v18, a74
  v_accvgpr_read_b32 v19, a75
  v_accvgpr_read_b32 v20, a88
  v_accvgpr_read_b32 v21, a89
  v_accvgpr_read_b32 v22, a90
  v_accvgpr_read_b32 v23, a91
  v_pk_mul_f32 v[16:17], v[16:17], v[200:201] op_sel_hi:[1,0]
  v_pk_mul_f32 v[18:19], v[18:19], v[200:201] op_sel_hi:[1,0]
  v_pk_mul_f32 v[20:21], v[20:21], v[200:201] op_sel_hi:[1,0]
  v_pk_mul_f32 v[22:23], v[22:23], v[200:201] op_sel_hi:[1,0]
  v_cvt_pk_bf16_f32 v16, v16, v17
  v_cvt_pk_bf16_f32 v17, v18, v19
  v_cvt_pk_bf16_f32 v18, v20, v21
  v_cvt_pk_bf16_f32 v19, v22, v23
  buffer_store_dwordx4 v[16:19], v244, s[24:27], s43 offen offset:0 sc1
  v_accvgpr_read_b32 v24, a76
  v_accvgpr_read_b32 v25, a77
  v_accvgpr_read_b32 v26, a78
  v_accvgpr_read_b32 v27, a79
  v_accvgpr_read_b32 v28, a92
  v_accvgpr_read_b32 v29, a93
  v_accvgpr_read_b32 v30, a94
  v_accvgpr_read_b32 v31, a95
  v_pk_mul_f32 v[24:25], v[24:25], v[204:205] op_sel_hi:[1,0]
  v_pk_mul_f32 v[26:27], v[26:27], v[204:205] op_sel_hi:[1,0]
  v_pk_mul_f32 v[28:29], v[28:29], v[204:205] op_sel_hi:[1,0]
  v_pk_mul_f32 v[30:31], v[30:31], v[204:205] op_sel_hi:[1,0]
  v_cvt_pk_bf16_f32 v24, v24, v25
  v_cvt_pk_bf16_f32 v25, v26, v27
  v_cvt_pk_bf16_f32 v26, v28, v29
  v_cvt_pk_bf16_f32 v27, v30, v31
  buffer_store_dwordx4 v[24:27], v244, s[24:27], s43 offen offset:2048 sc1
  v_accvgpr_read_b32 v32, a96
  v_accvgpr_read_b32 v33, a97
  v_accvgpr_read_b32 v34, a98
  v_accvgpr_read_b32 v35, a99
  v_accvgpr_read_b32 v36, a112
  v_accvgpr_read_b32 v37, a113
  v_accvgpr_read_b32 v38, a114
  v_accvgpr_read_b32 v39, a115
  v_pk_mul_f32 v[32:33], v[32:33], v[192:193] op_sel_hi:[1,0]
  v_pk_mul_f32 v[34:35], v[34:35], v[192:193] op_sel_hi:[1,0]
  v_pk_mul_f32 v[36:37], v[36:37], v[192:193] op_sel_hi:[1,0]
  v_pk_mul_f32 v[38:39], v[38:39], v[192:193] op_sel_hi:[1,0]
  v_cvt_pk_bf16_f32 v32, v32, v33
  v_cvt_pk_bf16_f32 v33, v34, v35
  v_cvt_pk_bf16_f32 v34, v36, v37
  v_cvt_pk_bf16_f32 v35, v38, v39
  buffer_store_dwordx4 v[32:35], v244, s[24:27], s42 offen offset:1024 sc1
  v_accvgpr_read_b32 v40, a100
  v_accvgpr_read_b32 v41, a101
  v_accvgpr_read_b32 v42, a102
  v_accvgpr_read_b32 v43, a103
  v_accvgpr_read_b32 v44, a116
  v_accvgpr_read_b32 v45, a117
  v_accvgpr_read_b32 v46, a118
  v_accvgpr_read_b32 v47, a119
  v_pk_mul_f32 v[40:41], v[40:41], v[196:197] op_sel_hi:[1,0]
  v_pk_mul_f32 v[42:43], v[42:43], v[196:197] op_sel_hi:[1,0]
  v_pk_mul_f32 v[44:45], v[44:45], v[196:197] op_sel_hi:[1,0]
  v_pk_mul_f32 v[46:47], v[46:47], v[196:197] op_sel_hi:[1,0]
  v_cvt_pk_bf16_f32 v40, v40, v41
  v_cvt_pk_bf16_f32 v41, v42, v43
  v_cvt_pk_bf16_f32 v42, v44, v45
  v_cvt_pk_bf16_f32 v43, v46, v47
  buffer_store_dwordx4 v[40:43], v244, s[24:27], s42 offen offset:3072 sc1
  v_accvgpr_read_b32 v48, a104
  v_accvgpr_read_b32 v49, a105
  v_accvgpr_read_b32 v50, a106
  v_accvgpr_read_b32 v51, a107
  v_accvgpr_read_b32 v52, a120
  v_accvgpr_read_b32 v53, a121
  v_accvgpr_read_b32 v54, a122
  v_accvgpr_read_b32 v55, a123
  v_pk_mul_f32 v[48:49], v[48:49], v[200:201] op_sel_hi:[1,0]
  v_pk_mul_f32 v[50:51], v[50:51], v[200:201] op_sel_hi:[1,0]
  v_pk_mul_f32 v[52:53], v[52:53], v[200:201] op_sel_hi:[1,0]
  v_pk_mul_f32 v[54:55], v[54:55], v[200:201] op_sel_hi:[1,0]
  v_cvt_pk_bf16_f32 v48, v48, v49
  v_cvt_pk_bf16_f32 v49, v50, v51
  v_cvt_pk_bf16_f32 v50, v52, v53
  v_cvt_pk_bf16_f32 v51, v54, v55
  buffer_store_dwordx4 v[48:51], v244, s[24:27], s43 offen offset:1024 sc1
  v_accvgpr_read_b32 v56, a108
  v_accvgpr_read_b32 v57, a109
  v_accvgpr_read_b32 v58, a110
  v_accvgpr_read_b32 v59, a111
  v_accvgpr_read_b32 v60, a124
  v_accvgpr_read_b32 v61, a125
  v_accvgpr_read_b32 v62, a126
  v_accvgpr_read_b32 v63, a127
  v_pk_mul_f32 v[56:57], v[56:57], v[204:205] op_sel_hi:[1,0]
  v_pk_mul_f32 v[58:59], v[58:59], v[204:205] op_sel_hi:[1,0]
  v_pk_mul_f32 v[60:61], v[60:61], v[204:205] op_sel_hi:[1,0]
  v_pk_mul_f32 v[62:63], v[62:63], v[204:205] op_sel_hi:[1,0]
  v_cvt_pk_bf16_f32 v56, v56, v57
  v_cvt_pk_bf16_f32 v57, v58, v59
  v_cvt_pk_bf16_f32 v58, v60, v61
  v_cvt_pk_bf16_f32 v59, v62, v63
  buffer_store_dwordx4 v[56:59], v244, s[24:27], s43 offen offset:3072 sc1
  ds_write_b32 v247, v245
  buffer_load_dwordx4 a[0:3], v252, s[24:27], s5 offen offset:3072 sc1
  buffer_load_dwordx4 a[4:7], v253, s[24:27], s5 offen offset:0 sc1
  buffer_load_dwordx4 a[8:11], v253, s[24:27], s5 offen offset:1024 sc1
  buffer_load_dwordx4 a[12:15], v253, s[24:27], s5 offen offset:2048 sc1
  buffer_load_dwordx4 a[16:19], v253, s[24:27], s5 offen offset:3072 sc1
  buffer_load_dwordx4 a[20:23], v242, s[24:27], s6 offen offset:0 sc1
  buffer_load_dwordx4 a[24:27], v242, s[24:27], s6 offen offset:1024 sc1
  buffer_load_dwordx4 a[28:31], v242, s[24:27], s6 offen offset:2048 sc1
  buffer_load_dwordx4 a[32:35], v242, s[24:27], s6 offen offset:3072 sc1
  buffer_load_dwordx4 a[36:39], v252, s[24:27], s6 offen offset:0 sc1
  s_lshr_b32 s39, s37, 2
  s_lshl_b32 s39, s39, 3
  s_lshr_b32 s38, s36, 2
  s_add_u32 s39, s39, s38
  s_lshl_b32 s39, s39, 7
  s_add_u32 s39, s39, 2867200
  s_lshl_b32 s38, s3, 26
  v_lshlrev_b32 v64, 22, v242
  v_or_b32 v64, s38, v64
  v_mov_b32 v65, 1
  v_add_u32 v246, 157696, v242
  s_waitcnt vmcnt(10) lgkmcnt(0)
  s_barrier
  ds_read_b128 v[68:71], v246
  s_waitcnt lgkmcnt(0)
  v_or3_b32 v68, v68, v69, v70
  v_or_b32 v68, v68, v71
  v_cmp_ne_u32 vcc, 0, v68
  s_nop 0
  s_cbranch_vccnz attn_redo
tail_go:
  buffer_atomic_add v65, v64, s[24:27], s39 offen
  s_and_b32 s36, s2, 1
  s_bfe_u32 s31, s2, 0x20001
  s_lshl_b32 s31, s31, 2
  s_bfe_u32 s38, s2, 0x20003
  s_add_u32 s31, s31, s38
  s_lshr_b32 s29, s2, 5
  v_mov_b32 v114, v242
  v_add_u32 v115, 0x1000, v114
  v_add_u32 v116, 0x2000, v114
  s_lshl_b32 s38, s36, 2
  s_add_u32 s38, s38, s3
  s_lshl_b32 s30, s38, 16
  buffer_load_dwordx4 a[40:43], v115, s[24:27], s6 offen offset:1024 sc1
  buffer_load_dwordx4 a[44:47], v115, s[24:27], s6 offen offset:2048 sc1
  buffer_load_dwordx4 a[48:51], v115, s[24:27], s6 offen offset:3072 sc1
  buffer_load_dwordx4 a[52:55], v116, s[24:27], s6 offen offset:0 sc1
  v_lshrrev_b32 v125, 4, v114
  v_and_b32 v126, 15, v125
  v_lshrrev_b32 v127, 4, v125
  s_add_u32 s38, s3, 0
  s_and_b32 s38, s38, 3
  s_lshl_b32 s38, s38, 11
  v_add_u32 v110, s38, v114
  s_sub_u32 s38, s3, 0
  s_and_b32 s38, s38, 3
  s_mul_i32 s38, s38, 15360
  s_add_u32 s38, s38, 98304
  v_add_u32 v118, s38, v114
  s_add_u32 s38, s3, 1
  s_and_b32 s38, s38, 3
  s_lshl_b32 s38, s38, 11
  v_add_u32 v111, s38, v114
  s_sub_u32 s38, s3, 1
  s_and_b32 s38, s38, 3
  s_mul_i32 s38, s38, 15360
  s_add_u32 s38, s38, 98304
  v_add_u32 v119, s38, v114
  s_add_u32 s38, s3, 2
  s_and_b32 s38, s38, 3
  s_lshl_b32 s38, s38, 11
  v_add_u32 v112, s38, v114
  s_sub_u32 s38, s3, 2
  s_and_b32 s38, s38, 3
  s_mul_i32 s38, s38, 15360
  s_add_u32 s38, s38, 98304
  v_add_u32 v120, s38, v114
  s_add_u32 s38, s3, 3
  s_and_b32 s38, s38, 3
  s_lshl_b32 s38, s38, 11
  v_add_u32 v113, s38, v114
  s_sub_u32 s38, s3, 3
  s_and_b32 s38, s38, 3
  s_mul_i32 s38, s38, 15360
  s_add_u32 s38, s38, 98304
  v_add_u32 v121, s38, v114
  v_add_u32 v122, s28, v114
  v_add_u32 v135, 0x10000, v122
  s_and_b32 s38, s31, 14
  s_add_u32 s38, s38, s36
  s_lshl_b32 s38, s38, 2
  s_add_u32 s38, s38, s3
  s_lshl_b32 s38, s38, 7
  s_add_u32 s38, s38, 2867200
  s_lshl_b32 s39, s29, 8
  s_add_u32 s39, s39, 2818304
  v_mov_b32 v133, s38
  v_writelane_b32 v133, s39, 1
  v_mov_b32 v134, 4
  v_writelane_b32 v134, 30, 1
  s_lshl_b32 s31, s31, 1
  s_add_u32 s31, s31, s36
  s_add_u32 s30, s30, 8388608
  s_lshl_b32 s38, s31, 19
  s_add_u32 s37, s30, s38
  s_xor_b32 s38, s38, 0x80000
  s_add_u32 s30, s30, s38
  s_lshl_b32 s40, s29, 5
  s_add_u32 s40, s40, s31
  s_lshl_b32 s38, s31, 6
  s_lshl_b32 s39, s3, 4
  s_add_u32 s38, s38, s39
  v_add_u32 v128, s38, v126
  v_mul_u32_u24 v117, 0x500, v128
  v_lshl_add_u32 v117, v127, 3, v117
  s_mul_i32 s38, s29, 160
  v_add_u32 v117, s38, v117
  s_mov_b32 s12, s60
  s_mov_b32 s13, s61
  s_mov_b32 s14, 2621440
  s_mov_b32 s15, 0x20000
  s_mov_b32 s16, s62
  s_mov_b32 s17, s63
  s_mov_b32 s18, 2621440
  s_mov_b32 s19, 0x20000
  s_mul_i32 s38, s31, 81920
  s_lshl_b32 s39, s3, 10
  s_add_u32 s38, s38, s39
  s_mul_i32 s39, s29, 10
  v_lshrrev_b32 v129, 1, v127
  v_add_u32 v129, s39, v129
  v_and_b32 v130, 1, v127
  v_lshlrev_b32 v130, 3, v130
  v_lshl_add_u32 v130, v126, 4, v130
  v_lshrrev_b32 v131, 2, v129
  v_lshl_add_u32 v131, v131, 12, v130
  v_and_b32 v132, 3, v129
  v_lshl_add_u32 v131, v132, 8, v131
  buffer_load_dwordx2 v[156:157], v131, s[24:27], s38 offen sc1
  v_add_u32 v129, 2, v129
  buffer_load_dwordx2 v[80:81], v117, s[12:15], 0 offen offset:0
  v_lshrrev_b32 v131, 2, v129
  v_lshl_add_u32 v131, v131, 12, v130
  v_and_b32 v132, 3, v129
  v_lshl_add_u32 v131, v132, 8, v131
  buffer_load_dwordx2 v[158:159], v131, s[24:27], s38 offen sc1
  v_add_u32 v129, 2, v129
  buffer_load_dwordx2 v[82:83], v117, s[12:15], 0 offen offset:32
  v_lshrrev_b32 v131, 2, v129
  v_lshl_add_u32 v131, v131, 12, v130
  v_and_b32 v132, 3, v129
  v_lshl_add_u32 v131, v132, 8, v131
  buffer_load_dwordx2 v[160:161], v131, s[24:27], s38 offen sc1
  v_add_u32 v129, 2, v129
  buffer_load_dwordx2 v[84:85], v117, s[12:15], 0 offen offset:64
  v_lshrrev_b32 v131, 2, v129
  v_lshl_add_u32 v131, v131, 12, v130
  v_and_b32 v132, 3, v129
  v_lshl_add_u32 v131, v132, 8, v131
  buffer_load_dwordx2 v[162:163], v131, s[24:27], s38 offen sc1
  v_add_u32 v129, 2, v129
  buffer_load_dwordx2 v[86:87], v117, s[12:15], 0 offen offset:96
  v_lshrrev_b32 v131, 2, v129
  v_lshl_add_u32 v131, v131, 12, v130
  v_and_b32 v132, 3, v129
  v_lshl_add_u32 v131, v132, 8, v131
  buffer_load_dwordx2 v[164:165], v131, s[24:27], s38 offen sc1
  v_add_u32 v129, 2, v129
  buffer_load_dwordx2 v[88:89], v117, s[12:15], 0 offen offset:128
  v_mov_b32 v123, 1073741824
  v_bfrev_b32 v124, 1
  v_sub_u32 v128, 0xffff, v128
  s_mov_b32 s34, 0xffff0000
  s_and_b32 s38, s52, 0xffff
  v_cmp_eq_u32 vcc, s38, v128
  v_mov_b32 v129, s52
  v_mov_b32 v130, 0
  v_cndmask_b32 v124, v124, v129, vcc
  v_cndmask_b32 v123, v123, v130, vcc
  s_and_b32 s38, s53, 0xffff
  v_cmp_eq_u32 vcc, s38, v128
  v_mov_b32 v129, s53
  v_mov_b32 v130, 2560
  v_cndmask_b32 v124, v124, v129, vcc
  v_cndmask_b32 v123, v123, v130, vcc
  s_and_b32 s38, s54, 0xffff
  v_cmp_eq_u32 vcc, s38, v128
  v_mov_b32 v129, s54
  v_mov_b32 v130, 5120
  v_cndmask_b32 v124, v124, v129, vcc
  v_cndmask_b32 v123, v123, v130, vcc
  s_and_b32 s38, s55, 0xffff
  v_cmp_eq_u32 vcc, s38, v128
  v_mov_b32 v129, s55
  v_mov_b32 v130, 7680
  v_cndmask_b32 v124, v124, v129, vcc
  v_cndmask_b32 v123, v123, v130, vcc
  s_and_b32 s38, s56, 0xffff
  v_cmp_eq_u32 vcc, s38, v128
  v_mov_b32 v129, s56
  v_mov_b32 v130, 10240
  v_cndmask_b32 v124, v124, v129, vcc
  v_cndmask_b32 v123, v123, v130, vcc
  s_and_b32 s38, s57, 0xffff
  v_cmp_eq_u32 vcc, s38, v128
  v_mov_b32 v129, s57
  v_mov_b32 v130, 12800
  v_cndmask_b32 v124, v124, v129, vcc
  v_cndmask_b32 v123, v123, v130, vcc
  s_and_b32 s38, s58, 0xffff
  v_cmp_eq_u32 vcc, s38, v128
  v_mov_b32 v129, s58
  v_mov_b32 v130, 15360
  v_cndmask_b32 v124, v124, v129, vcc
  v_cndmask_b32 v123, v123, v130, vcc
  s_and_b32 s38, s59, 0xffff
  v_cmp_eq_u32 vcc, s38, v128
  v_mov_b32 v129, s59
  v_mov_b32 v130, 17920
  v_cndmask_b32 v124, v124, v129, vcc
  v_cndmask_b32 v123, v123, v130, vcc
  v_lshl_add_u32 v123, v127, 4, v123
  s_mul_i32 s32, s29, 320
  s_add_u32 s32, s32, 2686976
  v_ashrrev_i32 v129, 31, v124
  v_not_b32 v129, v129
  v_or_b32 v129, 0x80000000, v129
  v_xor_b32 v124, v124, v129
  v_and_b32 v124, s34, v124
  v_mul_f32 v124, 0xbfb8aa3b, v124
  v_exp_f32 v124, v124
  s_nop 0
  v_add_f32 v124, 1.0, v124
  v_rcp_f32 v124, v124
  s_nop 0
  v_cvt_pk_bf16_f32 v124, v124, v124
  v_lshlrev_b32 v124, 16, v124
  buffer_load_dword v128, v133, s[24:27], 0 offen sc1
  buffer_load_dwordx4 a[56:59], v116, s[24:27], s6 offen offset:1024 sc1
  buffer_load_dwordx4 a[60:63], v116, s[24:27], s6 offen offset:2048 sc1
  buffer_load_dwordx4 a[64:67], v116, s[24:27], s6 offen offset:3072 sc1
  buffer_load_dwordx4 a[68:71], v114, s[24:27], s7 offen offset:0 sc1
  buffer_load_dwordx4 a[72:75], v114, s[24:27], s7 offen offset:1024 sc1
  buffer_load_dwordx4 a[76:79], v114, s[24:27], s7 offen offset:2048 sc1
  buffer_load_dwordx4 a[80:83], v114, s[24:27], s7 offen offset:3072 sc1
  buffer_load_dwordx4 a[84:87], v115, s[24:27], s7 offen offset:0 sc1
  buffer_load_dwordx4 a[88:91], v115, s[24:27], s7 offen offset:1024 sc1
  buffer_load_dwordx4 a[92:95], v115, s[24:27], s7 offen offset:2048 sc1
  s_waitcnt vmcnt(20)
  v_lshlrev_b32 v90, 16, v156
  v_and_b32 v91, s34, v156
  v_lshlrev_b32 v92, 16, v157
  v_and_b32 v93, s34, v157
  s_waitcnt vmcnt(18)
  v_lshlrev_b32 v94, 16, v158
  v_and_b32 v95, s34, v158
  v_lshlrev_b32 v96, 16, v159
  v_and_b32 v97, s34, v159
  s_waitcnt vmcnt(16)
  v_lshlrev_b32 v98, 16, v160
  v_and_b32 v99, s34, v160
  v_lshlrev_b32 v100, 16, v161
  v_and_b32 v101, s34, v161
  s_waitcnt vmcnt(14)
  v_lshlrev_b32 v102, 16, v162
  v_and_b32 v103, s34, v162
  v_lshlrev_b32 v104, 16, v163
  v_and_b32 v105, s34, v163
  s_waitcnt vmcnt(12)
  v_lshlrev_b32 v106, 16, v164
  v_and_b32 v107, s34, v164
  v_lshlrev_b32 v108, 16, v165
  v_and_b32 v109, s34, v165
  v_mov_b32 v156, 0
  v_mov_b32 v157, 0
  v_mov_b32 v158, 0
  v_mov_b32 v159, 0
  v_mov_b32 v160, 0
  v_mov_b32 v161, 0
  v_mov_b32 v162, 0
  v_mov_b32 v163, 0
  v_mov_b32 v164, 0
  v_mov_b32 v165, 0
  v_mov_b32 v166, 0
  v_mov_b32 v167, 0
  v_mov_b32 v168, 0
  v_mov_b32 v169, 0
  v_mov_b32 v170, 0
  v_mov_b32 v171, 0
  v_mov_b32 v172, 0
  v_mov_b32 v173, 0
  v_mov_b32 v174, 0
  v_mov_b32 v175, 0
  s_waitcnt vmcnt(10)
  v_cmp_lt_u32 vcc, v128, v134
  s_nop 0
  s_cbranch_vccz tail_ready
  s_waitcnt vmcnt(0)
  s_mov_b32 s35, 32768
  buffer_load_dword v128, v133, s[24:27], 0 offen sc1
  s_sleep 3
  buffer_load_dword v129, v133, s[24:27], 0 offen sc1
  s_sleep 3
tail_spin:
  buffer_load_dword v130, v133, s[24:27], 0 offen sc1
  s_waitcnt vmcnt(2)
  v_cmp_lt_u32 vcc, v128, v134
  s_nop 0
  s_cbranch_vccz tail_ready
  s_sleep 3
  buffer_load_dword v128, v133, s[24:27], 0 offen sc1
  s_waitcnt vmcnt(2)
  v_cmp_lt_u32 vcc, v129, v134
  s_nop 0
  s_cbranch_vccz tail_ready
  s_sleep 3
  buffer_load_dword v129, v133, s[24:27], 0 offen sc1
  s_waitcnt vmcnt(2)
  v_cmp_lt_u32 vcc, v130, v134
  s_nop 0
  s_cbranch_vccz tail_ready
  s_sleep 3
  s_sub_u32 s35, s35, 1
  s_cmp_lg_u32 s35, 0
  s_cbranch_scc1 tail_spin
tail_ready:
  buffer_load_dwordx4 a[180:183], v110, s[24:27], s30 offen offset:0 sc1
  buffer_load_dwordx4 a[184:187], v110, s[24:27], s30 offen offset:1024 sc1
  buffer_load_dwordx4 a[188:191], v111, s[24:27], s30 offen offset:0 sc1
  buffer_load_dwordx4 a[192:195], v111, s[24:27], s30 offen offset:1024 sc1
  buffer_load_dwordx4 a[196:199], v112, s[24:27], s30 offen offset:0 sc1
  buffer_load_dwordx4 a[200:203], v112, s[24:27], s30 offen offset:1024 sc1
  buffer_load_dwordx4 a[204:207], v113, s[24:27], s30 offen offset:0 sc1
  buffer_load_dwordx4 a[208:211], v113, s[24:27], s30 offen offset:1024 sc1
  v_cmp_gt_u32 vcc, 1073741824, v123
  s_nop 0
  s_and_saveexec_b64 s[42:43], vcc
  s_cbranch_execz tail_plain
  s_waitcnt vmcnt(30)
  buffer_load_dwordx4 v[156:159], v123, s[24:27], s32 offen offset:0 sc1
  buffer_load_dwordx4 v[160:163], v123, s[24:27], s32 offen offset:64 sc1
  buffer_load_dwordx4 v[164:167], v123, s[24:27], s32 offen offset:128 sc1
  buffer_load_dwordx4 v[168:171], v123, s[24:27], s32 offen offset:192 sc1
  buffer_load_dwordx4 v[172:175], v123, s[24:27], s32 offen offset:256 sc1
  s_add_u32 s32, s32, 20480
  buffer_load_dwordx4 v[136:139], v123, s[24:27], s32 offen offset:0 sc1
  buffer_load_dwordx4 v[140:143], v123, s[24:27], s32 offen offset:64 sc1
  buffer_load_dwordx4 v[144:147], v123, s[24:27], s32 offen offset:128 sc1
  buffer_load_dwordx4 v[148:151], v123, s[24:27], s32 offen offset:192 sc1
  buffer_load_dwordx4 v[152:155], v123, s[24:27], s32 offen offset:256 sc1
  s_add_u32 s32, s32, 20480
  buffer_load_dwordx4 v[0:3], v123, s[24:27], s32 offen offset:0 sc1
  buffer_load_dwordx4 v[4:7], v123, s[24:27], s32 offen offset:64 sc1
  buffer_load_dwordx4 v[8:11], v123, s[24:27], s32 offen offset:128 sc1
  buffer_load_dwordx4 v[12:15], v123, s[24:27], s32 offen offset:192 sc1
  buffer_load_dwordx4 v[16:19], v123, s[24:27], s32 offen offset:256 sc1
  s_add_u32 s32, s32, 20480
  buffer_load_dwordx4 v[20:23], v123, s[24:27], s32 offen offset:0 sc1
  buffer_load_dwordx4 v[24:27], v123, s[24:27], s32 offen offset:64 sc1
  buffer_load_dwordx4 v[28:31], v123, s[24:27], s32 offen offset:128 sc1
  buffer_load_dwordx4 v[32:35], v123, s[24:27], s32 offen offset:192 sc1
  buffer_load_dwordx4 v[36:39], v123, s[24:27], s32 offen offset:256 sc1
  s_add_u32 s32, s32, 20480
  buffer_load_dwordx4 v[40:43], v123, s[24:27], s32 offen offset:0 sc1
  buffer_load_dwordx4 v[44:47], v123, s[24:27], s32 offen offset:64 sc1
  buffer_load_dwordx4 v[48:51], v123, s[24:27], s32 offen offset:128 sc1
  buffer_load_dwordx4 v[52:55], v123, s[24:27], s32 offen offset:192 sc1
  buffer_load_dwordx4 v[56:59], v123, s[24:27], s32 offen offset:256 sc1
  s_add_u32 s32, s32, 20480
  buffer_load_dwordx4 v[60:63], v123, s[24:27], s32 offen offset:0 sc1
  buffer_load_dwordx4 v[64:67], v123, s[24:27], s32 offen offset:64 sc1
  buffer_load_dwordx4 v[68:71], v123, s[24:27], s32 offen offset:128 sc1
  buffer_load_dwordx4 v[72:75], v123, s[24:27], s32 offen offset:192 sc1
  buffer_load_dwordx4 v[76:79], v123, s[24:27], s32 offen offset:256 sc1
  s_add_u32 s32, s32, 20480
  s_waitcnt vmcnt(0)
  v_add_f32 v156, v156, v136
  v_add_f32 v157, v157, v137
  v_add_f32 v158, v158, v138
  v_add_f32 v159, v159, v139
  v_add_f32 v160, v160, v140
  v_add_f32 v161, v161, v141
  v_add_f32 v162, v162, v142
  v_add_f32 v163, v163, v143
  v_add_f32 v164, v164, v144
  v_add_f32 v165, v165, v145
  v_add_f32 v166, v166, v146
  v_add_f32 v167, v167, v147
  v_add_f32 v168, v168, v148
  v_add_f32 v169, v169, v149
  v_add_f32 v170, v170, v150
  v_add_f32 v171, v171, v151
  v_add_f32 v172, v172, v152
  v_add_f32 v173, v173, v153
  v_add_f32 v174, v174, v154
  v_add_f32 v175, v175, v155
  v_add_f32 v156, v156, v0
  v_add_f32 v157, v157, v1
  v_add_f32 v158, v158, v2
  v_add_f32 v159, v159, v3
  v_add_f32 v160, v160, v4
  v_add_f32 v161, v161, v5
  v_add_f32 v162, v162, v6
  v_add_f32 v163, v163, v7
  v_add_f32 v164, v164, v8
  v_add_f32 v165, v165, v9
  v_add_f32 v166, v166, v10
  v_add_f32 v167, v167, v11
  v_add_f32 v168, v168, v12
  v_add_f32 v169, v169, v13
  v_add_f32 v170, v170, v14
  v_add_f32 v171, v171, v15
  v_add_f32 v172, v172, v16
  v_add_f32 v173, v173, v17
  v_add_f32 v174, v174, v18
  v_add_f32 v175, v175, v19
  v_add_f32 v156, v156, v20
  v_add_f32 v157, v157, v21
  v_add_f32 v158, v158, v22
  v_add_f32 v159, v159, v23
  v_add_f32 v160, v160, v24
  v_add_f32 v161, v161, v25
  v_add_f32 v162, v162, v26
  v_add_f32 v163, v163, v27
  v_add_f32 v164, v164, v28
  v_add_f32 v165, v165, v29
  v_add_f32 v166, v166, v30
  v_add_f32 v167, v167, v31
  v_add_f32 v168, v168, v32
  v_add_f32 v169, v169, v33
  v_add_f32 v170, v170, v34
  v_add_f32 v171, v171, v35
  v_add_f32 v172, v172, v36
  v_add_f32 v173, v173, v37
  v_add_f32 v174, v174, v38
  v_add_f32 v175, v175, v39
  v_add_f32 v156, v156, v40
  v_add_f32 v157, v157, v41
  v_add_f32 v158, v158, v42
  v_add_f32 v159, v159, v43
  v_add_f32 v160, v160, v44
  v_add_f32 v161, v161, v45
  v_add_f32 v162, v162, v46
  v_add_f32 v163, v163, v47
  v_add_f32 v164, v164, v48
  v_add_f32 v165, v165, v49
  v_add_f32 v166, v166, v50
  v_add_f32 v167, v167, v51
  v_add_f32 v168, v168, v52
  v_add_f32 v169, v169, v53
  v_add_f32 v170, v170, v54
  v_add_f32 v171, v171, v55
  v_add_f32 v172, v172, v56
  v_add_f32 v173, v173, v57
  v_add_f32 v174, v174, v58
  v_add_f32 v175, v175, v59
  v_add_f32 v156, v156, v60
  v_add_f32 v157, v157, v61
  v_add_f32 v158, v158, v62
  v_add_f32 v159, v159, v63
  v_add_f32 v160, v160, v64
  v_add_f32 v161, v161, v65
  v_add_f32 v162, v162, v66
  v_add_f32 v163, v163, v67
  v_add_f32 v164, v164, v68
  v_add_f32 v165, v165, v69
  v_add_f32 v166, v166, v70
  v_add_f32 v167, v167, v71
  v_add_f32 v168, v168, v72
  v_add_f32 v169, v169, v73
  v_add_f32 v170, v170, v74
  v_add_f32 v171, v171, v75
  v_add_f32 v172, v172, v76
  v_add_f32 v173, v173, v77
  v_add_f32 v174, v174, v78
  v_add_f32 v175, v175, v79
tail_plain:
  s_mov_b64 exec, s[42:43]
  s_waitcnt vmcnt(0)
  v_mfma_f32_16x16x32_bf16 v[0:3], a[212:215], a[180:183], 0
  s_add_u32 s30, s30, 8192
  buffer_load_dwordx4 v[176:179], v110, s[24:27], s30 offen offset:0 sc1
  v_mfma_f32_16x16x32_bf16 v[0:3], a[232:235], a[184:187], v[0:3]
  v_cvt_pk_bf16_f32 v156, v156, v156
  v_cvt_pk_bf16_f32 v157, v157, v157
  v_mfma_f32_16x16x32_bf16 v[4:7], a[232:235], a[192:195], 0
  buffer_load_dwordx4 a[96:99], v115, s[24:27], s7 offen offset:3072 sc1
  v_mfma_f32_16x16x32_bf16 v[4:7], a[212:215], a[188:191], v[4:7]
  v_cvt_pk_bf16_f32 v158, v158, v158
  v_cvt_pk_bf16_f32 v159, v159, v159
  v_mfma_f32_16x16x32_bf16 v[8:11], a[212:215], a[196:199], 0
  buffer_load_dwordx4 v[180:183], v110, s[24:27], s30 offen offset:1024 sc1
  v_mfma_f32_16x16x32_bf16 v[8:11], a[232:235], a[200:203], v[8:11]
  v_lshlrev_b32 v156, 16, v156
  v_lshlrev_b32 v157, 16, v157
  v_mfma_f32_16x16x32_bf16 v[12:15], a[232:235], a[208:211], 0
  v_lshlrev_b32 v158, 16, v158
  v_lshlrev_b32 v159, 16, v159
  v_mfma_f32_16x16x32_bf16 v[12:15], a[212:215], a[204:207], v[12:15]
  v_mul_f32 v156, v156, v124
  v_mul_f32 v157, v157, v124
  v_mfma_f32_16x16x32_bf16 v[16:19], a[216:219], a[180:183], 0
  buffer_load_dwordx4 v[184:187], v111, s[24:27], s30 offen offset:0 sc1
  v_mfma_f32_16x16x32_bf16 v[16:19], a[236:239], a[184:187], v[16:19]
  v_mul_f32 v158, v158, v124
  v_mul_f32 v159, v159, v124
  v_mfma_f32_16x16x32_bf16 v[20:23], a[236:239], a[192:195], 0
  buffer_load_dwordx4 a[100:103], v116, s[24:27], s7 offen offset:0 sc1
  v_mfma_f32_16x16x32_bf16 v[20:23], a[216:219], a[188:191], v[20:23]
  v_cvt_pk_bf16_f32 v156, v156, v156
  v_cvt_pk_bf16_f32 v157, v157, v157
  v_mfma_f32_16x16x32_bf16 v[24:27], a[216:219], a[196:199], 0
  buffer_load_dwordx4 v[188:191], v111, s[24:27], s30 offen offset:1024 sc1
  v_mfma_f32_16x16x32_bf16 v[24:27], a[236:239], a[200:203], v[24:27]
  v_cvt_pk_bf16_f32 v158, v158, v158
  v_cvt_pk_bf16_f32 v159, v159, v159
  v_mfma_f32_16x16x32_bf16 v[28:31], a[236:239], a[208:211], 0
  v_lshlrev_b32 v156, 16, v156
  v_lshlrev_b32 v157, 16, v157
  v_mfma_f32_16x16x32_bf16 v[28:31], a[216:219], a[204:207], v[28:31]
  v_lshlrev_b32 v158, 16, v158
  v_lshlrev_b32 v159, 16, v159
  v_mfma_f32_16x16x32_bf16 v[32:35], a[220:223], a[180:183], 0
  buffer_load_dwordx4 v[192:195], v112, s[24:27], s30 offen offset:0 sc1
  v_mfma_f32_16x16x32_bf16 v[32:35], a[240:243], a[184:187], v[32:35]
  v_add_f32 v90, v90, v156
  v_add_f32 v91, v91, v157
  v_mfma_f32_16x16x32_bf16 v[36:39], a[240:243], a[192:195], 0
  buffer_load_dwordx4 a[104:107], v116, s[24:27], s7 offen offset:1024 sc1
  v_mfma_f32_16x16x32_bf16 v[36:39], a[220:223], a[188:191], v[36:39]
  v_add_f32 v92, v92, v158
  v_add_f32 v93, v93, v159
  v_mfma_f32_16x16x32_bf16 v[40:43], a[220:223], a[196:199], 0
  buffer_load_dwordx4 v[196:199], v112, s[24:27], s30 offen offset:1024 sc1
  v_mfma_f32_16x16x32_bf16 v[40:43], a[240:243], a[200:203], v[40:43]
  v_cvt_pk_bf16_f32 v90, v90, v90
  v_cvt_pk_bf16_f32 v91, v91, v91
  v_mfma_f32_16x16x32_bf16 v[44:47], a[240:243], a[208:211], 0
  v_cvt_pk_bf16_f32 v92, v92, v92
  v_cvt_pk_bf16_f32 v93, v93, v93
  v_mfma_f32_16x16x32_bf16 v[44:47], a[220:223], a[204:207], v[44:47]
  v_lshlrev_b32 v90, 16, v90
  v_lshlrev_b32 v91, 16, v91
  v_mfma_f32_16x16x32_bf16 v[48:51], a[224:227], a[180:183], 0
  buffer_load_dwordx4 v[200:203], v113, s[24:27], s30 offen offset:0 sc1
  v_mfma_f32_16x16x32_bf16 v[48:51], a[244:247], a[184:187], v[48:51]
  v_lshlrev_b32 v92, 16, v92
  v_lshlrev_b32 v93, 16, v93
  v_mfma_f32_16x16x32_bf16 v[52:55], a[244:247], a[192:195], 0
  buffer_load_dwordx4 a[108:111], v116, s[24:27], s7 offen offset:2048 sc1
  v_mfma_f32_16x16x32_bf16 v[52:55], a[224:227], a[188:191], v[52:55]
  v_mul_f32 v129, 0xbfb8aa3b, v90
  v_mul_f32 v130, 0xbfb8aa3b, v91
  v_mfma_f32_16x16x32_bf16 v[56:59], a[224:227], a[196:199], 0
  buffer_load_dwordx4 v[204:207], v113, s[24:27], s30 offen offset:1024 sc1
  v_mfma_f32_16x16x32_bf16 v[56:59], a[244:247], a[200:203], v[56:59]
  v_mul_f32 v131, 0xbfb8aa3b, v92
  v_mul_f32 v132, 0xbfb8aa3b, v93
  v_mfma_f32_16x16x32_bf16 v[60:63], a[244:247], a[208:211], 0
  v_exp_f32 v129, v129
  v_mfma_f32_16x16x32_bf16 v[60:63], a[224:227], a[204:207], v[60:63]
  v_exp_f32 v130, v130
  v_mfma_f32_16x16x32_bf16 v[64:67], a[228:231], a[180:183], 0
  s_add_u32 s30, s30, 8192
  buffer_load_dwordx4 v[208:211], v110, s[24:27], s30 offen offset:0 sc1
  v_mfma_f32_16x16x32_bf16 v[64:67], a[248:251], a[184:187], v[64:67]
  v_exp_f32 v131, v131
  v_mfma_f32_16x16x32_bf16 v[68:71], a[248:251], a[192:195], 0
  buffer_load_dwordx4 a[112:115], v116, s[24:27], s7 offen offset:3072 sc1
  v_mfma_f32_16x16x32_bf16 v[68:71], a[228:231], a[188:191], v[68:71]
  v_exp_f32 v132, v132
  v_mfma_f32_16x16x32_bf16 v[72:75], a[228:231], a[196:199], 0
  buffer_load_dwordx4 v[212:215], v110, s[24:27], s30 offen offset:1024 sc1
  v_mfma_f32_16x16x32_bf16 v[72:75], a[248:251], a[200:203], v[72:75]
  v_add_f32 v129, 1.0, v129
  v_add_f32 v130, 1.0, v130
  v_mfma_f32_16x16x32_bf16 v[76:79], a[248:251], a[208:211], 0
  v_add_f32 v131, 1.0, v131
  v_add_f32 v132, 1.0, v132
  v_mfma_f32_16x16x32_bf16 v[76:79], a[228:231], a[204:207], v[76:79]
  v_rcp_f32 v129, v129
  s_waitcnt vmcnt(3)
  v_mfma_f32_16x16x32_bf16 v[0:3], a[252:255], v[176:179], v[0:3]
  buffer_load_dwordx4 v[216:219], v111, s[24:27], s30 offen offset:0 sc1
  v_mfma_f32_16x16x32_bf16 v[0:3], a[144:147], v[180:183], v[0:3]
  v_rcp_f32 v130, v130
  v_mfma_f32_16x16x32_bf16 v[4:7], a[144:147], v[188:191], v[4:7]
  buffer_load_dwordx4 a[116:119], v114, s[24:27], s8 offen offset:0 sc1
  v_mfma_f32_16x16x32_bf16 v[4:7], a[252:255], v[184:187], v[4:7]
  v_rcp_f32 v131, v131
  v_mfma_f32_16x16x32_bf16 v[8:11], a[252:255], v[192:195], v[8:11]
  buffer_load_dwordx4 v[220:223], v111, s[24:27], s30 offen offset:1024 sc1
  v_mfma_f32_16x16x32_bf16 v[8:11], a[144:147], v[196:199], v[8:11]
  v_rcp_f32 v132, v132
  v_mfma_f32_16x16x32_bf16 v[12:15], a[144:147], v[204:207], v[12:15]
  v_mul_f32 v90, v90, v129
  v_mul_f32 v91, v91, v130
  v_mfma_f32_16x16x32_bf16 v[12:15], a[252:255], v[200:203], v[12:15]
  v_mul_f32 v92, v92, v131
  v_mul_f32 v93, v93, v132
  v_mfma_f32_16x16x32_bf16 v[16:19], a[128:131], v[176:179], v[16:19]
  buffer_load_dwordx4 v[224:227], v112, s[24:27], s30 offen offset:0 sc1
  v_mfma_f32_16x16x32_bf16 v[16:19], a[148:151], v[180:183], v[16:19]
  v_cvt_pk_bf16_f32 v90, v90, v90
  v_cvt_pk_bf16_f32 v91, v91, v91
  v_mfma_f32_16x16x32_bf16 v[20:23], a[148:151], v[188:191], v[20:23]
  buffer_load_dwordx4 a[120:123], v114, s[24:27], s8 offen offset:1024 sc1
  v_mfma_f32_16x16x32_bf16 v[20:23], a[128:131], v[184:187], v[20:23]
  v_cvt_pk_bf16_f32 v92, v92, v92
  v_cvt_pk_bf16_f32 v93, v93, v93
  v_mfma_f32_16x16x32_bf16 v[24:27], a[128:131], v[192:195], v[24:27]
  buffer_load_dwordx4 v[228:231], v112, s[24:27], s30 offen offset:1024 sc1
  v_mfma_f32_16x16x32_bf16 v[24:27], a[148:151], v[196:199], v[24:27]
  v_lshlrev_b32 v90, 16, v90
  v_lshlrev_b32 v91, 16, v91
  v_mfma_f32_16x16x32_bf16 v[28:31], a[148:151], v[204:207], v[28:31]
  v_lshlrev_b32 v92, 16, v92
  v_lshlrev_b32 v93, 16, v93
  v_mfma_f32_16x16x32_bf16 v[28:31], a[128:131], v[200:203], v[28:31]
  v_cvt_pk_bf16_f32 v160, v160, v160
  v_cvt_pk_bf16_f32 v161, v161, v161
  v_mfma_f32_16x16x32_bf16 v[32:35], a[132:135], v[176:179], v[32:35]
  buffer_load_dwordx4 v[232:235], v113, s[24:27], s30 offen offset:0 sc1
  v_mfma_f32_16x16x32_bf16 v[32:35], a[152:155], v[180:183], v[32:35]
  v_cvt_pk_bf16_f32 v162, v162, v162
  v_cvt_pk_bf16_f32 v163, v163, v163
  v_mfma_f32_16x16x32_bf16 v[36:39], a[152:155], v[188:191], v[36:39]
  buffer_load_dwordx4 a[124:127], v114, s[24:27], s8 offen offset:2048 sc1
  v_mfma_f32_16x16x32_bf16 v[36:39], a[132:135], v[184:187], v[36:39]
  v_lshlrev_b32 v160, 16, v160
  v_lshlrev_b32 v161, 16, v161
  v_mfma_f32_16x16x32_bf16 v[40:43], a[132:135], v[192:195], v[40:43]
  buffer_load_dwordx4 v[236:239], v113, s[24:27], s30 offen offset:1024 sc1
  v_mfma_f32_16x16x32_bf16 v[40:43], a[152:155], v[196:199], v[40:43]
  v_lshlrev_b32 v162, 16, v162
  v_lshlrev_b32 v163, 16, v163
  v_mfma_f32_16x16x32_bf16 v[44:47], a[152:155], v[204:207], v[44:47]
  v_mul_f32 v160, v160, v124
  v_mul_f32 v161, v161, v124
  v_mfma_f32_16x16x32_bf16 v[44:47], a[132:135], v[200:203], v[44:47]
  v_mul_f32 v162, v162, v124
  v_mul_f32 v163, v163, v124
  v_mfma_f32_16x16x32_bf16 v[48:51], a[136:139], v[176:179], v[48:51]
  s_add_u32 s30, s30, 8192
  buffer_load_dwordx4 v[240:243], v110, s[24:27], s30 offen offset:0 sc1
  v_mfma_f32_16x16x32_bf16 v[48:51], a[156:159], v[180:183], v[48:51]
  v_cvt_pk_bf16_f32 v160, v160, v160
  v_cvt_pk_bf16_f32 v161, v161, v161
  v_mfma_f32_16x16x32_bf16 v[52:55], a[156:159], v[188:191], v[52:55]
  buffer_load_dwordx4 a[160:163], v114, s[24:27], s8 offen offset:3072 sc1
  v_mfma_f32_16x16x32_bf16 v[52:55], a[136:139], v[184:187], v[52:55]
  v_cvt_pk_bf16_f32 v162, v162, v162
  v_cvt_pk_bf16_f32 v163, v163, v163
  v_mfma_f32_16x16x32_bf16 v[56:59], a[136:139], v[192:195], v[56:59]
  buffer_load_dwordx4 v[244:247], v110, s[24:27], s30 offen offset:1024 sc1
  v_mfma_f32_16x16x32_bf16 v[56:59], a[156:159], v[196:199], v[56:59]
  v_lshlrev_b32 v160, 16, v160
  v_lshlrev_b32 v161, 16, v161
  v_mfma_f32_16x16x32_bf16 v[60:63], a[156:159], v[204:207], v[60:63]
  v_lshlrev_b32 v162, 16, v162
  v_lshlrev_b32 v163, 16, v163
  v_mfma_f32_16x16x32_bf16 v[60:63], a[136:139], v[200:203], v[60:63]
  v_add_f32 v94, v94, v160
  v_add_f32 v95, v95, v161
  v_mfma_f32_16x16x32_bf16 v[64:67], a[140:143], v[176:179], v[64:67]
  buffer_load_dwordx4 v[248:251], v111, s[24:27], s30 offen offset:0 sc1
  v_mfma_f32_16x16x32_bf16 v[64:67], a[0:3], v[180:183], v[64:67]
  v_add_f32 v96, v96, v162
  v_add_f32 v97, v97, v163
  v_mfma_f32_16x16x32_bf16 v[68:71], a[0:3], v[188:191], v[68:71]
  buffer_load_dwordx4 a[164:167], v115, s[24:27], s8 offen offset:0 sc1
  v_mfma_f32_16x16x32_bf16 v[68:71], a[140:143], v[184:187], v[68:71]
  v_cvt_pk_bf16_f32 v94, v94, v94
  v_cvt_pk_bf16_f32 v95, v95, v95
  v_mfma_f32_16x16x32_bf16 v[72:75], a[140:143], v[192:195], v[72:75]
  buffer_load_dwordx4 v[252:255], v111, s[24:27], s30 offen offset:1024 sc1
  v_mfma_f32_16x16x32_bf16 v[72:75], a[0:3], v[196:199], v[72:75]
  v_cvt_pk_bf16_f32 v96, v96, v96
  v_cvt_pk_bf16_f32 v97, v97, v97
  v_mfma_f32_16x16x32_bf16 v[76:79], a[0:3], v[204:207], v[76:79]
  v_lshlrev_b32 v94, 16, v94
  v_lshlrev_b32 v95, 16, v95
  v_mfma_f32_16x16x32_bf16 v[76:79], a[140:143], v[200:203], v[76:79]
  v_lshlrev_b32 v96, 16, v96
  v_lshlrev_b32 v97, 16, v97
  s_waitcnt vmcnt(6)
  v_mfma_f32_16x16x32_bf16 v[0:3], a[4:7], v[208:211], v[0:3]
  buffer_load_dwordx4 v[136:139], v112, s[24:27], s30 offen offset:0 sc1
  v_mfma_f32_16x16x32_bf16 v[0:3], a[24:27], v[212:215], v[0:3]
  v_mul_f32 v129, 0xbfb8aa3b, v94
  v_mul_f32 v130, 0xbfb8aa3b, v95
  v_mfma_f32_16x16x32_bf16 v[4:7], a[24:27], v[220:223], v[4:7]
  buffer_load_dwordx4 a[168:171], v115, s[24:27], s8 offen offset:1024 sc1
  v_mfma_f32_16x16x32_bf16 v[4:7], a[4:7], v[216:219], v[4:7]
  v_mul_f32 v131, 0xbfb8aa3b, v96
  v_mul_f32 v132, 0xbfb8aa3b, v97
  v_mfma_f32_16x16x32_bf16 v[8:11], a[4:7], v[224:227], v[8:11]
  buffer_load_dwordx4 v[140:143], v112, s[24:27], s30 offen offset:1024 sc1
  v_mfma_f32_16x16x32_bf16 v[8:11], a[24:27], v[228:231], v[8:11]
  v_exp_f32 v129, v129
  v_mfma_f32_16x16x32_bf16 v[12:15], a[24:27], v[236:239], v[12:15]
  v_exp_f32 v130, v130
  v_mfma_f32_16x16x32_bf16 v[12:15], a[4:7], v[232:235], v[12:15]
  v_exp_f32 v131, v131
  v_mfma_f32_16x16x32_bf16 v[16:19], a[8:11], v[208:211], v[16:19]
  buffer_load_dwordx4 v[144:147], v113, s[24:27], s30 offen offset:0 sc1
  v_mfma_f32_16x16x32_bf16 v[16:19], a[28:31], v[212:215], v[16:19]
  v_exp_f32 v132, v132
  v_mfma_f32_16x16x32_bf16 v[20:23], a[28:31], v[220:223], v[20:23]
  buffer_load_dwordx4 a[172:175], v115, s[24:27], s8 offen offset:2048 sc1
  v_mfma_f32_16x16x32_bf16 v[20:23], a[8:11], v[216:219], v[20:23]
  v_add_f32 v129, 1.0, v129
  v_add_f32 v130, 1.0, v130
  v_mfma_f32_16x16x32_bf16 v[24:27], a[8:11], v[224:227], v[24:27]
  buffer_load_dwordx4 v[148:151], v113, s[24:27], s30 offen offset:1024 sc1
  v_mfma_f32_16x16x32_bf16 v[24:27], a[28:31], v[228:231], v[24:27]
  v_add_f32 v131, 1.0, v131
  v_add_f32 v132, 1.0, v132
  v_mfma_f32_16x16x32_bf16 v[28:31], a[28:31], v[236:239], v[28:31]
  v_rcp_f32 v129, v129
  v_mfma_f32_16x16x32_bf16 v[28:31], a[8:11], v[232:235], v[28:31]
  v_rcp_f32 v130, v130
  v_mfma_f32_16x16x32_bf16 v[32:35], a[12:15], v[208:211], v[32:35]
  s_add_u32 s30, s30, 8192
  buffer_load_dwordx4 v[152:155], v110, s[24:27], s30 offen offset:0 sc1
  v_mfma_f32_16x16x32_bf16 v[32:35], a[32:35], v[212:215], v[32:35]
  v_rcp_f32 v131, v131
  v_mfma_f32_16x16x32_bf16 v[36:39], a[32:35], v[220:223], v[36:39]
  buffer_load_dwordx4 a[176:179], v115, s[24:27], s8 offen offset:3072 sc1
  v_mfma_f32_16x16x32_bf16 v[36:39], a[12:15], v[216:219], v[36:39]
  v_rcp_f32 v132, v132
  v_mfma_f32_16x16x32_bf16 v[40:43], a[12:15], v[224:227], v[40:43]
  buffer_load_dwordx4 a[180:183], v110, s[24:27], s30 offen offset:1024 sc1
  v_mfma_f32_16x16x32_bf16 v[40:43], a[32:35], v[228:231], v[40:43]
  v_mul_f32 v94, v94, v129
  v_mul_f32 v95, v95, v130
  v_mfma_f32_16x16x32_bf16 v[44:47], a[32:35], v[236:239], v[44:47]
  v_mul_f32 v96, v96, v131
  v_mul_f32 v97, v97, v132
  v_mfma_f32_16x16x32_bf16 v[44:47], a[12:15], v[232:235], v[44:47]
  v_cvt_pk_bf16_f32 v94, v94, v94
  v_cvt_pk_bf16_f32 v95, v95, v95
  v_mfma_f32_16x16x32_bf16 v[48:51], a[16:19], v[208:211], v[48:51]
  buffer_load_dwordx4 a[184:187], v111, s[24:27], s30 offen offset:0 sc1
  v_mfma_f32_16x16x32_bf16 v[48:51], a[36:39], v[212:215], v[48:51]
  v_cvt_pk_bf16_f32 v96, v96, v96
  v_cvt_pk_bf16_f32 v97, v97, v97
  v_mfma_f32_16x16x32_bf16 v[52:55], a[36:39], v[220:223], v[52:55]
  s_add_u32 m0, s28, 49152
  s_nop 0
  buffer_load_dwordx4 v115, s[24:27], s10 offen offset:0 sc1 lds
  v_mfma_f32_16x16x32_bf16 v[52:55], a[16:19], v[216:219], v[52:55]
  buffer_load_dwordx4 v115, s[24:27], s10 offen offset:1024 sc1 lds
  v_mfma_f32_16x16x32_bf16 v[56:59], a[16:19], v[224:227], v[56:59]
  buffer_load_dwordx4 v115, s[24:27], s10 offen offset:2048 sc1 lds
  v_mfma_f32_16x16x32_bf16 v[56:59], a[36:39], v[228:231], v[56:59]
  buffer_load_dwordx4 v115, s[24:27], s10 offen offset:3072 sc1 lds
  v_mfma_f32_16x16x32_bf16 v[60:63], a[36:39], v[236:239], v[60:63]
  buffer_load_dwordx4 a[188:191], v111, s[24:27], s30 offen offset:1024 sc1
  v_mfma_f32_16x16x32_bf16 v[60:63], a[16:19], v[232:235], v[60:63]
  v_lshlrev_b32 v94, 16, v94
  v_lshlrev_b32 v95, 16, v95
  v_mfma_f32_16x16x32_bf16 v[64:67], a[20:23], v[208:211], v[64:67]
  buffer_load_dwordx4 a[192:195], v112, s[24:27], s30 offen offset:0 sc1
  v_mfma_f32_16x16x32_bf16 v[64:67], a[40:43], v[212:215], v[64:67]
  v_lshlrev_b32 v96, 16, v96
  v_lshlrev_b32 v97, 16, v97
  v_mfma_f32_16x16x32_bf16 v[68:71], a[40:43], v[220:223], v[68:71]
  v_cvt_pk_bf16_f32 v164, v164, v164
  v_cvt_pk_bf16_f32 v165, v165, v165
  v_mfma_f32_16x16x32_bf16 v[68:71], a[20:23], v[216:219], v[68:71]
  v_cvt_pk_bf16_f32 v166, v166, v166
  v_cvt_pk_bf16_f32 v167, v167, v167
  v_mfma_f32_16x16x32_bf16 v[72:75], a[20:23], v[224:227], v[72:75]
  buffer_load_dwordx4 a[196:199], v112, s[24:27], s30 offen offset:1024 sc1
  v_mfma_f32_16x16x32_bf16 v[72:75], a[40:43], v[228:231], v[72:75]
  v_lshlrev_b32 v164, 16, v164
  v_lshlrev_b32 v165, 16, v165
  v_mfma_f32_16x16x32_bf16 v[76:79], a[40:43], v[236:239], v[76:79]
  v_lshlrev_b32 v166, 16, v166
  v_lshlrev_b32 v167, 16, v167
  v_mfma_f32_16x16x32_bf16 v[76:79], a[20:23], v[232:235], v[76:79]
  v_mul_f32 v164, v164, v124
  v_mul_f32 v165, v165, v124
  s_waitcnt vmcnt(11)
  v_mfma_f32_16x16x32_bf16 v[0:3], a[44:47], v[240:243], v[0:3]
  buffer_load_dwordx4 a[200:203], v113, s[24:27], s30 offen offset:0 sc1
  v_mfma_f32_16x16x32_bf16 v[0:3], a[64:67], v[244:247], v[0:3]
  v_mul_f32 v166, v166, v124
  v_mul_f32 v167, v167, v124
  v_mfma_f32_16x16x32_bf16 v[4:7], a[64:67], v[252:255], v[4:7]
  v_cvt_pk_bf16_f32 v164, v164, v164
  v_cvt_pk_bf16_f32 v165, v165, v165
  v_mfma_f32_16x16x32_bf16 v[4:7], a[44:47], v[248:251], v[4:7]
  v_cvt_pk_bf16_f32 v166, v166, v166
  v_cvt_pk_bf16_f32 v167, v167, v167
  v_mfma_f32_16x16x32_bf16 v[8:11], a[44:47], v[136:139], v[8:11]
  buffer_load_dwordx4 a[204:207], v113, s[24:27], s30 offen offset:1024 sc1
  v_mfma_f32_16x16x32_bf16 v[8:11], a[64:67], v[140:143], v[8:11]
  v_lshlrev_b32 v164, 16, v164
  v_lshlrev_b32 v165, 16, v165
  v_mfma_f32_16x16x32_bf16 v[12:15], a[64:67], v[148:151], v[12:15]
  v_lshlrev_b32 v166, 16, v166
  v_lshlrev_b32 v167, 16, v167
  v_mfma_f32_16x16x32_bf16 v[12:15], a[44:47], v[144:147], v[12:15]
  v_add_f32 v98, v98, v164
  v_add_f32 v99, v99, v165
  v_mfma_f32_16x16x32_bf16 v[16:19], a[48:51], v[240:243], v[16:19]
  s_add_u32 s30, s30, 8192
  buffer_load_dwordx4 a[208:211], v110, s[24:27], s30 offen offset:0 sc1
  v_mfma_f32_16x16x32_bf16 v[16:19], a[68:71], v[244:247], v[16:19]
  v_add_f32 v100, v100, v166
  v_add_f32 v101, v101, v167
  v_mfma_f32_16x16x32_bf16 v[20:23], a[68:71], v[252:255], v[20:23]
  v_cvt_pk_bf16_f32 v98, v98, v98
  v_cvt_pk_bf16_f32 v99, v99, v99
  v_mfma_f32_16x16x32_bf16 v[20:23], a[48:51], v[248:251], v[20:23]
  v_cvt_pk_bf16_f32 v100, v100, v100
  v_cvt_pk_bf16_f32 v101, v101, v101
  v_mfma_f32_16x16x32_bf16 v[24:27], a[48:51], v[136:139], v[24:27]
  buffer_load_dwordx4 v[176:179], v110, s[24:27], s30 offen offset:1024 sc1
  v_mfma_f32_16x16x32_bf16 v[24:27], a[68:71], v[140:143], v[24:27]
  v_lshlrev_b32 v98, 16, v98
  v_lshlrev_b32 v99, 16, v99
  v_mfma_f32_16x16x32_bf16 v[28:31], a[68:71], v[148:151], v[28:31]
  v_lshlrev_b32 v100, 16, v100
  v_lshlrev_b32 v101, 16, v101
  v_mfma_f32_16x16x32_bf16 v[28:31], a[48:51], v[144:147], v[28:31]
  v_mul_f32 v129, 0xbfb8aa3b, v98
  v_mul_f32 v130, 0xbfb8aa3b, v99
  v_mfma_f32_16x16x32_bf16 v[32:35], a[52:55], v[240:243], v[32:35]
  buffer_load_dwordx4 v[180:183], v111, s[24:27], s30 offen offset:0 sc1
  v_mfma_f32_16x16x32_bf16 v[32:35], a[72:75], v[244:247], v[32:35]
  v_mul_f32 v131, 0xbfb8aa3b, v100
  v_mul_f32 v132, 0xbfb8aa3b, v101
  v_mfma_f32_16x16x32_bf16 v[36:39], a[72:75], v[252:255], v[36:39]
  v_exp_f32 v129, v129
  v_mfma_f32_16x16x32_bf16 v[36:39], a[52:55], v[248:251], v[36:39]
  v_exp_f32 v130, v130
  v_mfma_f32_16x16x32_bf16 v[40:43], a[52:55], v[136:139], v[40:43]
  buffer_load_dwordx4 v[184:187], v111, s[24:27], s30 offen offset:1024 sc1
  v_mfma_f32_16x16x32_bf16 v[40:43], a[72:75], v[140:143], v[40:43]
  v_exp_f32 v131, v131
  v_mfma_f32_16x16x32_bf16 v[44:47], a[72:75], v[148:151], v[44:47]
  v_exp_f32 v132, v132
  v_mfma_f32_16x16x32_bf16 v[44:47], a[52:55], v[144:147], v[44:47]
  v_add_f32 v129, 1.0, v129
  v_add_f32 v130, 1.0, v130
  v_mfma_f32_16x16x32_bf16 v[48:51], a[56:59], v[240:243], v[48:51]
  buffer_load_dwordx4 v[188:191], v112, s[24:27], s30 offen offset:0 sc1
  v_mfma_f32_16x16x32_bf16 v[48:51], a[76:79], v[244:247], v[48:51]
  v_add_f32 v131, 1.0, v131
  v_add_f32 v132, 1.0, v132
  v_mfma_f32_16x16x32_bf16 v[52:55], a[76:79], v[252:255], v[52:55]
  v_rcp_f32 v129, v129
  v_mfma_f32_16x16x32_bf16 v[52:55], a[56:59], v[248:251], v[52:55]
  v_rcp_f32 v130, v130
  v_mfma_f32_16x16x32_bf16 v[56:59], a[56:59], v[136:139], v[56:59]
  buffer_load_dwordx4 v[192:195], v112, s[24:27], s30 offen offset:1024 sc1
  v_mfma_f32_16x16x32_bf16 v[56:59], a[76:79], v[140:143], v[56:59]
  v_rcp_f32 v131, v131
  v_mfma_f32_16x16x32_bf16 v[60:63], a[76:79], v[148:151], v[60:63]
  v_rcp_f32 v132, v132
  v_mfma_f32_16x16x32_bf16 v[60:63], a[56:59], v[144:147], v[60:63]
  v_mul_f32 v98, v98, v129
  v_mul_f32 v99, v99, v130
  v_mfma_f32_16x16x32_bf16 v[64:67], a[60:63], v[240:243], v[64:67]
  buffer_load_dwordx4 v[196:199], v113, s[24:27], s30 offen offset:0 sc1
  v_mfma_f32_16x16x32_bf16 v[64:67], a[80:83], v[244:247], v[64:67]
  v_mul_f32 v100, v100, v131
  v_mul_f32 v101, v101, v132
  v_mfma_f32_16x16x32_bf16 v[68:71], a[80:83], v[252:255], v[68:71]
  v_cvt_pk_bf16_f32 v98, v98, v98
  v_cvt_pk_bf16_f32 v99, v99, v99
  v_mfma_f32_16x16x32_bf16 v[68:71], a[60:63], v[248:251], v[68:71]
  v_cvt_pk_bf16_f32 v100, v100, v100
  v_cvt_pk_bf16_f32 v101, v101, v101
  v_mfma_f32_16x16x32_bf16 v[72:75], a[60:63], v[136:139], v[72:75]
  buffer_load_dwordx4 v[200:203], v113, s[24:27], s30 offen offset:1024 sc1
  v_mfma_f32_16x16x32_bf16 v[72:75], a[80:83], v[140:143], v[72:75]
  v_lshlrev_b32 v98, 16, v98
  v_lshlrev_b32 v99, 16, v99
  v_mfma_f32_16x16x32_bf16 v[76:79], a[80:83], v[148:151], v[76:79]
  v_lshlrev_b32 v100, 16, v100
  v_lshlrev_b32 v101, 16, v101
  v_mfma_f32_16x16x32_bf16 v[76:79], a[60:63], v[144:147], v[76:79]
  v_cvt_pk_bf16_f32 v168, v168, v168
  v_cvt_pk_bf16_f32 v169, v169, v169
  s_waitcnt vmcnt(8)
  v_mfma_f32_16x16x32_bf16 v[0:3], a[84:87], v[152:155], v[0:3]
  s_add_u32 s30, s30, 8192
  buffer_load_dwordx4 v[204:207], v110, s[24:27], s30 offen offset:0 sc1
  v_mfma_f32_16x16x32_bf16 v[0:3], a[104:107], a[180:183], v[0:3]
  v_cvt_pk_bf16_f32 v170, v170, v170
  v_cvt_pk_bf16_f32 v171, v171, v171
  v_mfma_f32_16x16x32_bf16 v[4:7], a[104:107], a[188:191], v[4:7]
  v_lshlrev_b32 v168, 16, v168
  v_lshlrev_b32 v169, 16, v169
  v_mfma_f32_16x16x32_bf16 v[4:7], a[84:87], a[184:187], v[4:7]
  v_lshlrev_b32 v170, 16, v170
  v_lshlrev_b32 v171, 16, v171
  v_mfma_f32_16x16x32_bf16 v[8:11], a[84:87], a[192:195], v[8:11]
  buffer_load_dwordx4 v[208:211], v110, s[24:27], s30 offen offset:1024 sc1
  v_mfma_f32_16x16x32_bf16 v[8:11], a[104:107], a[196:199], v[8:11]
  v_mul_f32 v168, v168, v124
  v_mul_f32 v169, v169, v124
  v_mfma_f32_16x16x32_bf16 v[12:15], a[104:107], a[204:207], v[12:15]
  v_mul_f32 v170, v170, v124
  v_mul_f32 v171, v171, v124
  v_mfma_f32_16x16x32_bf16 v[12:15], a[84:87], a[200:203], v[12:15]
  v_cvt_pk_bf16_f32 v168, v168, v168
  v_cvt_pk_bf16_f32 v169, v169, v169
  v_mfma_f32_16x16x32_bf16 v[16:19], a[88:91], v[152:155], v[16:19]
  buffer_load_dwordx4 v[212:215], v111, s[24:27], s30 offen offset:0 sc1
  v_mfma_f32_16x16x32_bf16 v[16:19], a[108:111], a[180:183], v[16:19]
  v_cvt_pk_bf16_f32 v170, v170, v170
  v_cvt_pk_bf16_f32 v171, v171, v171
  v_mfma_f32_16x16x32_bf16 v[20:23], a[108:111], a[188:191], v[20:23]
  v_lshlrev_b32 v168, 16, v168
  v_lshlrev_b32 v169, 16, v169
  v_mfma_f32_16x16x32_bf16 v[20:23], a[88:91], a[184:187], v[20:23]
  v_lshlrev_b32 v170, 16, v170
  v_lshlrev_b32 v171, 16, v171
  v_mfma_f32_16x16x32_bf16 v[24:27], a[88:91], a[192:195], v[24:27]
  buffer_load_dwordx4 v[216:219], v111, s[24:27], s30 offen offset:1024 sc1
  v_mfma_f32_16x16x32_bf16 v[24:27], a[108:111], a[196:199], v[24:27]
  v_add_f32 v102, v102, v168
  v_add_f32 v103, v103, v169
  v_mfma_f32_16x16x32_bf16 v[28:31], a[108:111], a[204:207], v[28:31]
  v_add_f32 v104, v104, v170
  v_add_f32 v105, v105, v171
  v_mfma_f32_16x16x32_bf16 v[28:31], a[88:91], a[200:203], v[28:31]
  v_cvt_pk_bf16_f32 v102, v102, v102
  v_cvt_pk_bf16_f32 v103, v103, v103
  v_mfma_f32_16x16x32_bf16 v[32:35], a[92:95], v[152:155], v[32:35]
  buffer_load_dwordx4 v[220:223], v112, s[24:27], s30 offen offset:0 sc1
  v_mfma_f32_16x16x32_bf16 v[32:35], a[112:115], a[180:183], v[32:35]
  v_cvt_pk_bf16_f32 v104, v104, v104
  v_cvt_pk_bf16_f32 v105, v105, v105
  v_mfma_f32_16x16x32_bf16 v[36:39], a[112:115], a[188:191], v[36:39]
  v_lshlrev_b32 v102, 16, v102
  v_lshlrev_b32 v103, 16, v103
  v_mfma_f32_16x16x32_bf16 v[36:39], a[92:95], a[184:187], v[36:39]
  v_lshlrev_b32 v104, 16, v104
  v_lshlrev_b32 v105, 16, v105
  v_mfma_f32_16x16x32_bf16 v[40:43], a[92:95], a[192:195], v[40:43]
  buffer_load_dwordx4 v[224:227], v112, s[24:27], s30 offen offset:1024 sc1
  v_mfma_f32_16x16x32_bf16 v[40:43], a[112:115], a[196:199], v[40:43]
  v_mul_f32 v129, 0xbfb8aa3b, v102
  v_mul_f32 v130, 0xbfb8aa3b, v103
  v_mfma_f32_16x16x32_bf16 v[44:47], a[112:115], a[204:207], v[44:47]
  v_mul_f32 v131, 0xbfb8aa3b, v104
  v_mul_f32 v132, 0xbfb8aa3b, v105
  v_mfma_f32_16x16x32_bf16 v[44:47], a[92:95], a[200:203], v[44:47]
  v_exp_f32 v129, v129
  v_mfma_f32_16x16x32_bf16 v[48:51], a[96:99], v[152:155], v[48:51]
  buffer_load_dwordx4 v[228:231], v113, s[24:27], s30 offen offset:0 sc1
  v_mfma_f32_16x16x32_bf16 v[48:51], a[116:119], a[180:183], v[48:51]
  v_exp_f32 v130, v130
  v_mfma_f32_16x16x32_bf16 v[52:55], a[116:119], a[188:191], v[52:55]
  v_exp_f32 v131, v131
  v_mfma_f32_16x16x32_bf16 v[52:55], a[96:99], a[184:187], v[52:55]
  v_exp_f32 v132, v132
  v_mfma_f32_16x16x32_bf16 v[56:59], a[96:99], a[192:195], v[56:59]
  buffer_load_dwordx4 v[232:235], v113, s[24:27], s30 offen offset:1024 sc1
  v_mfma_f32_16x16x32_bf16 v[56:59], a[116:119], a[196:199], v[56:59]
  v_add_f32 v129, 1.0, v129
  v_add_f32 v130, 1.0, v130
  v_mfma_f32_16x16x32_bf16 v[60:63], a[116:119], a[204:207], v[60:63]
  v_add_f32 v131, 1.0, v131
  v_add_f32 v132, 1.0, v132
  v_mfma_f32_16x16x32_bf16 v[60:63], a[96:99], a[200:203], v[60:63]
  v_rcp_f32 v129, v129
  v_mfma_f32_16x16x32_bf16 v[64:67], a[100:103], v[152:155], v[64:67]
  ds_read_b128 v[236:239], v122 offset:0
  s_add_u32 s30, s30, 8192
  v_rcp_f32 v130, v130
  v_mfma_f32_16x16x32_bf16 v[64:67], a[120:123], a[180:183], v[64:67]
  buffer_load_dwordx4 v[240:243], v110, s[24:27], s30 offen offset:0 sc1
  v_mfma_f32_16x16x32_bf16 v[68:71], a[120:123], a[188:191], v[68:71]
  v_rcp_f32 v131, v131
  v_mfma_f32_16x16x32_bf16 v[68:71], a[100:103], a[184:187], v[68:71]
  v_rcp_f32 v132, v132
  v_mfma_f32_16x16x32_bf16 v[72:75], a[100:103], a[192:195], v[72:75]
  buffer_load_dwordx4 v[244:247], v110, s[24:27], s30 offen offset:1024 sc1
  v_mfma_f32_16x16x32_bf16 v[72:75], a[120:123], a[196:199], v[72:75]
  v_mul_f32 v102, v102, v129
  v_mul_f32 v103, v103, v130
  v_mfma_f32_16x16x32_bf16 v[76:79], a[120:123], a[204:207], v[76:79]
  v_mul_f32 v104, v104, v131
  v_mul_f32 v105, v105, v132
  v_mfma_f32_16x16x32_bf16 v[76:79], a[100:103], a[200:203], v[76:79]
  v_cvt_pk_bf16_f32 v102, v102, v102
  v_cvt_pk_bf16_f32 v103, v103, v103
  s_waitcnt vmcnt(10)
  v_mfma_f32_16x16x32_bf16 v[0:3], a[124:127], a[208:211], v[0:3]
  ds_read_b128 v[248:251], v122 offset:1024
  v_cvt_pk_bf16_f32 v104, v104, v104
  v_mfma_f32_16x16x32_bf16 v[0:3], a[176:179], v[176:179], v[0:3]
  buffer_load_dwordx4 v[252:255], v111, s[24:27], s30 offen offset:0 sc1
  v_mfma_f32_16x16x32_bf16 v[4:7], a[176:179], v[184:187], v[4:7]
  v_cvt_pk_bf16_f32 v105, v105, v105
  v_lshlrev_b32 v102, 16, v102
  v_mfma_f32_16x16x32_bf16 v[4:7], a[124:127], v[180:183], v[4:7]
  v_lshlrev_b32 v103, 16, v103
  v_lshlrev_b32 v104, 16, v104
  v_mfma_f32_16x16x32_bf16 v[8:11], a[124:127], v[188:191], v[8:11]
  buffer_load_dwordx4 v[136:139], v111, s[24:27], s30 offen offset:1024 sc1
  v_mfma_f32_16x16x32_bf16 v[8:11], a[176:179], v[192:195], v[8:11]
  v_lshlrev_b32 v105, 16, v105
  v_cvt_pk_bf16_f32 v172, v172, v172
  v_mfma_f32_16x16x32_bf16 v[12:15], a[176:179], v[200:203], v[12:15]
  v_cvt_pk_bf16_f32 v173, v173, v173
  v_cvt_pk_bf16_f32 v174, v174, v174
  v_mfma_f32_16x16x32_bf16 v[12:15], a[124:127], v[196:199], v[12:15]
  v_cvt_pk_bf16_f32 v175, v175, v175
  v_lshlrev_b32 v172, 16, v172
  s_waitcnt lgkmcnt(1)
  v_mfma_f32_16x16x32_bf16 v[16:19], a[160:163], a[208:211], v[16:19]
  ds_read_b128 v[140:143], v122 offset:2048
  v_lshlrev_b32 v173, 16, v173
  v_mfma_f32_16x16x32_bf16 v[16:19], v[236:239], v[176:179], v[16:19]
  buffer_load_dwordx4 v[144:147], v112, s[24:27], s30 offen offset:0 sc1
  v_mfma_f32_16x16x32_bf16 v[20:23], v[236:239], v[184:187], v[20:23]
  v_lshlrev_b32 v174, 16, v174
  v_lshlrev_b32 v175, 16, v175
  v_mfma_f32_16x16x32_bf16 v[20:23], a[160:163], v[180:183], v[20:23]
  v_mul_f32 v172, v172, v124
  v_mul_f32 v173, v173, v124
  v_mfma_f32_16x16x32_bf16 v[24:27], a[160:163], v[188:191], v[24:27]
  buffer_load_dwordx4 v[148:151], v112, s[24:27], s30 offen offset:1024 sc1
  v_mfma_f32_16x16x32_bf16 v[24:27], v[236:239], v[192:195], v[24:27]
  v_mul_f32 v174, v174, v124
  v_mul_f32 v175, v175, v124
  v_mfma_f32_16x16x32_bf16 v[28:31], v[236:239], v[200:203], v[28:31]
  v_cvt_pk_bf16_f32 v172, v172, v172
  v_cvt_pk_bf16_f32 v173, v173, v173
  v_mfma_f32_16x16x32_bf16 v[28:31], a[160:163], v[196:199], v[28:31]
  v_cvt_pk_bf16_f32 v174, v174, v174
  v_cvt_pk_bf16_f32 v175, v175, v175
  s_waitcnt lgkmcnt(1)
  v_mfma_f32_16x16x32_bf16 v[32:35], a[164:167], a[208:211], v[32:35]
  ds_read_b128 v[152:155], v122 offset:3072
  v_lshlrev_b32 v172, 16, v172
  v_mfma_f32_16x16x32_bf16 v[32:35], v[248:251], v[176:179], v[32:35]
  buffer_load_dwordx4 a[180:183], v113, s[24:27], s30 offen offset:0 sc1
  v_mfma_f32_16x16x32_bf16 v[36:39], v[248:251], v[184:187], v[36:39]
  v_lshlrev_b32 v173, 16, v173
  v_lshlrev_b32 v174, 16, v174
  v_mfma_f32_16x16x32_bf16 v[36:39], a[164:167], v[180:183], v[36:39]
  v_lshlrev_b32 v175, 16, v175
  v_add_f32 v106, v106, v172
  v_mfma_f32_16x16x32_bf16 v[40:43], a[164:167], v[188:191], v[40:43]
  buffer_load_dwordx4 a[184:187], v113, s[24:27], s30 offen offset:1024 sc1
  v_mfma_f32_16x16x32_bf16 v[40:43], v[248:251], v[192:195], v[40:43]
  v_add_f32 v107, v107, v173
  v_add_f32 v108, v108, v174
  v_mfma_f32_16x16x32_bf16 v[44:47], v[248:251], v[200:203], v[44:47]
  v_add_f32 v109, v109, v175
  v_cvt_pk_bf16_f32 v106, v106, v106
  v_mfma_f32_16x16x32_bf16 v[44:47], a[164:167], v[196:199], v[44:47]
  v_cvt_pk_bf16_f32 v107, v107, v107
  v_cvt_pk_bf16_f32 v108, v108, v108
  s_waitcnt lgkmcnt(1)
  v_mfma_f32_16x16x32_bf16 v[48:51], a[168:171], a[208:211], v[48:51]
  ds_read_b128 a[188:191], v122 offset:16384
  ds_read_b128 a[192:195], v122 offset:33792
  s_mov_b32 s30, s37
  v_mfma_f32_16x16x32_bf16 v[48:51], v[140:143], v[176:179], v[48:51]
  buffer_load_dwordx4 a[196:199], v110, s[24:27], s30 offen offset:0 sc1
  v_mfma_f32_16x16x32_bf16 v[52:55], v[140:143], v[184:187], v[52:55]
  v_cvt_pk_bf16_f32 v109, v109, v109
  v_lshlrev_b32 v106, 16, v106
  v_mfma_f32_16x16x32_bf16 v[52:55], a[168:171], v[180:183], v[52:55]
  v_lshlrev_b32 v107, 16, v107
  v_lshlrev_b32 v108, 16, v108
  v_mfma_f32_16x16x32_bf16 v[56:59], a[168:171], v[188:191], v[56:59]
  buffer_load_dwordx4 a[200:203], v110, s[24:27], s30 offen offset:1024 sc1
  v_mfma_f32_16x16x32_bf16 v[56:59], v[140:143], v[192:195], v[56:59]
  v_lshlrev_b32 v109, 16, v109
  v_mul_f32 v129, 0xbfb8aa3b, v106
  v_mfma_f32_16x16x32_bf16 v[60:63], v[140:143], v[200:203], v[60:63]
  v_mul_f32 v130, 0xbfb8aa3b, v107
  v_mul_f32 v131, 0xbfb8aa3b, v108
  v_mfma_f32_16x16x32_bf16 v[60:63], a[168:171], v[196:199], v[60:63]
  v_mul_f32 v132, 0xbfb8aa3b, v109
  v_exp_f32 v129, v129
  s_waitcnt lgkmcnt(2)
  v_mfma_f32_16x16x32_bf16 v[64:67], a[172:175], a[208:211], v[64:67]
  ds_read_b128 a[204:207], v122 offset:17408
  ds_read_b128 v[236:239], v122 offset:34816
  v_mfma_f32_16x16x32_bf16 v[64:67], v[152:155], v[176:179], v[64:67]
  v_exp_f32 v130, v130
  v_mfma_f32_16x16x32_bf16 v[68:71], v[152:155], v[184:187], v[68:71]
  v_exp_f32 v131, v131
  v_mfma_f32_16x16x32_bf16 v[68:71], a[172:175], v[180:183], v[68:71]
  v_exp_f32 v132, v132
  v_mfma_f32_16x16x32_bf16 v[72:75], a[172:175], v[188:191], v[72:75]
  v_add_f32 v129, 1.0, v129
  v_add_f32 v130, 1.0, v130
  v_mfma_f32_16x16x32_bf16 v[72:75], v[152:155], v[192:195], v[72:75]
  v_add_f32 v131, 1.0, v131
  v_add_f32 v132, 1.0, v132
  v_mfma_f32_16x16x32_bf16 v[76:79], v[152:155], v[200:203], v[76:79]
  v_rcp_f32 v129, v129
  v_mfma_f32_16x16x32_bf16 v[76:79], a[172:175], v[196:199], v[76:79]
  v_rcp_f32 v130, v130
  s_waitcnt vmcnt(10) lgkmcnt(2)
  v_mfma_f32_16x16x32_bf16 v[0:3], a[188:191], v[204:207], v[0:3]
  ds_read_b128 v[248:251], v122 offset:18432
  ds_read_b128 v[140:143], v122 offset:35840
  v_mfma_f32_16x16x32_bf16 v[0:3], a[192:195], v[208:211], v[0:3]
  buffer_load_dwordx4 v[152:155], v111, s[24:27], s30 offen offset:0 sc1
  v_mfma_f32_16x16x32_bf16 v[4:7], a[192:195], v[216:219], v[4:7]
  v_rcp_f32 v131, v131
  v_mfma_f32_16x16x32_bf16 v[4:7], a[188:191], v[212:215], v[4:7]
  v_rcp_f32 v132, v132
  v_mfma_f32_16x16x32_bf16 v[8:11], a[188:191], v[220:223], v[8:11]
  buffer_load_dwordx4 a[208:211], v111, s[24:27], s30 offen offset:1024 sc1
  v_mfma_f32_16x16x32_bf16 v[8:11], a[192:195], v[224:227], v[8:11]
  v_mul_f32 v106, v106, v129
  v_mul_f32 v107, v107, v130
  v_mfma_f32_16x16x32_bf16 v[12:15], a[192:195], v[232:235], v[12:15]
  v_mul_f32 v108, v108, v131
  v_mul_f32 v109, v109, v132
  v_mfma_f32_16x16x32_bf16 v[12:15], a[188:191], v[228:231], v[12:15]
  v_cvt_pk_bf16_f32 v106, v106, v106
  v_cvt_pk_bf16_f32 v107, v107, v107
  s_waitcnt lgkmcnt(2)
  v_mfma_f32_16x16x32_bf16 v[16:19], a[204:207], v[204:207], v[16:19]
  ds_read_b128 v[176:179], v122 offset:19456
  ds_read_b128 v[180:183], v135 offset:0
  v_mfma_f32_16x16x32_bf16 v[16:19], v[236:239], v[208:211], v[16:19]
  buffer_load_dwordx4 v[184:187], v112, s[24:27], s30 offen offset:0 sc1
  v_mfma_f32_16x16x32_bf16 v[20:23], v[236:239], v[216:219], v[20:23]
  v_cvt_pk_bf16_f32 v108, v108, v108
  v_cvt_pk_bf16_f32 v109, v109, v109
  v_mfma_f32_16x16x32_bf16 v[20:23], a[204:207], v[212:215], v[20:23]
  v_lshlrev_b32 v106, 16, v106
  v_lshlrev_b32 v107, 16, v107
  v_mfma_f32_16x16x32_bf16 v[24:27], a[204:207], v[220:223], v[24:27]
  buffer_load_dwordx4 v[188:191], v112, s[24:27], s30 offen offset:1024 sc1
  v_mfma_f32_16x16x32_bf16 v[24:27], v[236:239], v[224:227], v[24:27]
  v_lshlrev_b32 v108, 16, v108
  v_lshlrev_b32 v109, 16, v109
  v_mfma_f32_16x16x32_bf16 v[28:31], v[236:239], v[232:235], v[28:31]
  v_lshlrev_b32 v156, 16, v80
  v_and_b32 v157, s34, v80
  v_mfma_f32_16x16x32_bf16 v[28:31], a[204:207], v[228:231], v[28:31]
  v_lshlrev_b32 v158, 16, v81
  v_and_b32 v159, s34, v81
  s_waitcnt lgkmcnt(2)
  v_mfma_f32_16x16x32_bf16 v[32:35], v[248:251], v[204:207], v[32:35]
  ds_read_b128 v[192:195], v122 offset:32768
  ds_read_b128 v[196:199], v135 offset:1024
  v_mfma_f32_16x16x32_bf16 v[32:35], v[140:143], v[208:211], v[32:35]
  buffer_load_dwordx4 v[200:203], v113, s[24:27], s30 offen offset:0 sc1
  v_mfma_f32_16x16x32_bf16 v[36:39], v[140:143], v[216:219], v[36:39]
  v_lshlrev_b32 v160, 16, v82
  v_and_b32 v161, s34, v82
  v_mfma_f32_16x16x32_bf16 v[36:39], v[248:251], v[212:215], v[36:39]
  v_lshlrev_b32 v162, 16, v83
  v_and_b32 v163, s34, v83
  v_mfma_f32_16x16x32_bf16 v[40:43], v[248:251], v[220:223], v[40:43]
  buffer_load_dwordx4 a[188:191], v113, s[24:27], s30 offen offset:1024 sc1
  v_mfma_f32_16x16x32_bf16 v[40:43], v[140:143], v[224:227], v[40:43]
  v_lshlrev_b32 v164, 16, v84
  v_and_b32 v165, s34, v84
  v_mfma_f32_16x16x32_bf16 v[44:47], v[140:143], v[232:235], v[44:47]
  v_lshlrev_b32 v166, 16, v85
  v_and_b32 v167, s34, v85
  v_mfma_f32_16x16x32_bf16 v[44:47], v[248:251], v[228:231], v[44:47]
  v_lshlrev_b32 v168, 16, v86
  v_and_b32 v169, s34, v86
  s_waitcnt lgkmcnt(2)
  v_mfma_f32_16x16x32_bf16 v[48:51], v[176:179], v[204:207], v[48:51]
  ds_read_b128 a[192:195], v135 offset:2048
  ds_read_b128 a[204:207], v135 offset:19456
  s_add_u32 s30, s30, 8192
  v_mfma_f32_16x16x32_bf16 v[48:51], v[180:183], v[208:211], v[48:51]
  buffer_load_dwordx4 v[236:239], v110, s[24:27], s30 offen offset:0 sc1
  v_mfma_f32_16x16x32_bf16 v[52:55], v[180:183], v[216:219], v[52:55]
  v_lshlrev_b32 v170, 16, v87
  v_and_b32 v171, s34, v87
  v_mfma_f32_16x16x32_bf16 v[52:55], v[176:179], v[212:215], v[52:55]
  v_lshlrev_b32 v172, 16, v88
  v_and_b32 v173, s34, v88
  v_mfma_f32_16x16x32_bf16 v[56:59], v[176:179], v[220:223], v[56:59]
  v_lshlrev_b32 v174, 16, v89
  v_and_b32 v175, s34, v89
  v_mfma_f32_16x16x32_bf16 v[56:59], v[180:183], v[224:227], v[56:59]
  s_sub_u32 s41, s3, 1
  s_and_b32 s41, s41, 3
  s_lshl_b32 s41, s41, 12
  v_add_u32 v80, s41, v114
  v_mfma_f32_16x16x32_bf16 v[60:63], v[180:183], v[232:235], v[60:63]
  s_sub_u32 s41, s3, 2
  s_and_b32 s41, s41, 3
  s_lshl_b32 s41, s41, 12
  v_add_u32 v81, s41, v114
  v_mfma_f32_16x16x32_bf16 v[60:63], v[176:179], v[228:231], v[60:63]
  s_sub_u32 s41, s3, 3
  s_and_b32 s41, s41, 3
  s_lshl_b32 s41, s41, 12
  v_add_u32 v82, s41, v114
  v_bfe_u32 v129, v114, 8, 1
  s_waitcnt lgkmcnt(2)
  v_mfma_f32_16x16x32_bf16 v[64:67], v[192:195], v[204:207], v[64:67]
  ds_read_b128 v[248:251], v135 offset:3072
  ds_read_b128 v[140:143], v122 offset:49152
  v_mfma_f32_16x16x32_bf16 v[64:67], v[196:199], v[208:211], v[64:67]
  v_mul_u32_u24 v129, 24, v129
  v_add_u32 v83, v117, v129
  v_mfma_f32_16x16x32_bf16 v[68:71], v[196:199], v[216:219], v[68:71]
  v_mfma_f32_16x16x32_bf16 v[68:71], v[192:195], v[212:215], v[68:71]
  v_mfma_f32_16x16x32_bf16 v[72:75], v[192:195], v[220:223], v[72:75]
  v_mfma_f32_16x16x32_bf16 v[72:75], v[196:199], v[224:227], v[72:75]
  v_mfma_f32_16x16x32_bf16 v[76:79], v[196:199], v[232:235], v[76:79]
  v_mfma_f32_16x16x32_bf16 v[76:79], v[192:195], v[228:231], v[76:79]
  s_waitcnt vmcnt(9) lgkmcnt(2)
  v_mfma_f32_16x16x32_bf16 v[0:3], a[192:195], v[240:243], v[0:3]
  ds_read_b128 v[176:179], v135 offset:16384
  ds_read_b128 v[180:183], v122 offset:50176
  s_xor_b32 s38, s40, 1
  v_mfma_f32_16x16x32_bf16 v[0:3], a[204:207], v[244:247], v[0:3]
  buffer_load_dwordx4 v[192:195], v110, s[24:27], s30 offen offset:1024 sc1
  s_lshl_b32 s38, s38, 2
  s_add_u32 s38, s38, s3
  s_lshl_b32 s38, s38, 12
  v_mfma_f32_16x16x32_bf16 v[4:7], a[204:207], v[136:139], v[4:7]
  s_add_u32 s38, s38, 25165824
  v_lshrrev_b32 v125, 1, v114
  v_mfma_f32_16x16x32_bf16 v[4:7], a[192:195], v[252:255], v[4:7]
  v_mfma_f32_16x16x32_bf16 v[8:11], a[192:195], v[144:147], v[8:11]
  buffer_load_dwordx4 v[196:199], v111, s[24:27], s30 offen offset:0 sc1
  v_mfma_f32_16x16x32_bf16 v[8:11], a[204:207], v[148:151], v[8:11]
  v_mfma_f32_16x16x32_bf16 v[12:15], a[204:207], a[184:187], v[12:15]
  v_mfma_f32_16x16x32_bf16 v[12:15], a[192:195], a[180:183], v[12:15]
  s_waitcnt lgkmcnt(2)
  v_mfma_f32_16x16x32_bf16 v[16:19], v[248:251], v[240:243], v[16:19]
  ds_read_b128 v[204:207], v135 offset:17408
  ds_read_b128 v[208:211], v122 offset:51200
  v_mfma_f32_16x16x32_bf16 v[16:19], v[140:143], v[244:247], v[16:19]
  buffer_load_dwordx4 v[212:215], v111, s[24:27], s30 offen offset:1024 sc1
  v_mfma_f32_16x16x32_bf16 v[20:23], v[140:143], v[136:139], v[20:23]
  ds_write_b128 v118, v[4:7] offset:0
  ds_write_b128 v118, v[8:11] offset:5120
  v_mfma_f32_16x16x32_bf16 v[20:23], v[248:251], v[252:255], v[20:23]
  ds_write_b128 v118, v[12:15] offset:10240
  v_mfma_f32_16x16x32_bf16 v[24:27], v[248:251], v[144:147], v[24:27]
  buffer_load_dwordx4 v[216:219], v112, s[24:27], s30 offen offset:0 sc1
  v_mfma_f32_16x16x32_bf16 v[24:27], v[140:143], v[148:151], v[24:27]
  v_mfma_f32_16x16x32_bf16 v[28:31], v[140:143], a[184:187], v[28:31]
  v_mfma_f32_16x16x32_bf16 v[28:31], v[248:251], a[180:183], v[28:31]
  s_waitcnt lgkmcnt(5)
  v_mfma_f32_16x16x32_bf16 v[32:35], v[176:179], v[240:243], v[32:35]
  ds_read_b128 v[220:223], v135 offset:18432
  ds_read_b128 v[224:227], v122 offset:52224
  v_mfma_f32_16x16x32_bf16 v[32:35], v[180:183], v[244:247], v[32:35]
  buffer_load_dwordx4 v[228:231], v112, s[24:27], s30 offen offset:1024 sc1
  v_mfma_f32_16x16x32_bf16 v[36:39], v[180:183], v[136:139], v[36:39]
  ds_write_b128 v118, v[20:23] offset:1024
  ds_write_b128 v118, v[24:27] offset:6144
  v_mfma_f32_16x16x32_bf16 v[36:39], v[176:179], v[252:255], v[36:39]
  ds_write_b128 v118, v[28:31] offset:11264
  v_mfma_f32_16x16x32_bf16 v[40:43], v[176:179], v[144:147], v[40:43]
  buffer_load_dwordx4 v[232:235], v113, s[24:27], s30 offen offset:0 sc1
  v_mfma_f32_16x16x32_bf16 v[40:43], v[180:183], v[148:151], v[40:43]
  v_mfma_f32_16x16x32_bf16 v[44:47], v[180:183], a[184:187], v[44:47]
  v_mfma_f32_16x16x32_bf16 v[44:47], v[176:179], a[180:183], v[44:47]
  s_waitcnt lgkmcnt(8)
  v_mfma_f32_16x16x32_bf16 v[48:51], v[204:207], v[240:243], v[48:51]
  buffer_load_dwordx4 a[192:195], v113, s[24:27], s30 offen offset:1024 sc1
  v_mfma_f32_16x16x32_bf16 v[48:51], v[208:211], v[244:247], v[48:51]
  ds_write_b128 v118, v[36:39] offset:2048
  v_mfma_f32_16x16x32_bf16 v[52:55], v[208:211], v[136:139], v[52:55]
  ds_write_b128 v118, v[40:43] offset:7168
  v_mfma_f32_16x16x32_bf16 v[52:55], v[204:207], v[252:255], v[52:55]
  ds_write_b128 v118, v[44:47] offset:12288
  v_mfma_f32_16x16x32_bf16 v[56:59], v[204:207], v[144:147], v[56:59]
  s_add_u32 s30, s30, 8192
  buffer_load_dwordx4 a[204:207], v110, s[24:27], s30 offen offset:0 sc1
  v_mfma_f32_16x16x32_bf16 v[56:59], v[208:211], v[148:151], v[56:59]
  v_mfma_f32_16x16x32_bf16 v[60:63], v[208:211], a[184:187], v[60:63]
  v_mfma_f32_16x16x32_bf16 v[60:63], v[204:207], a[180:183], v[60:63]
  s_waitcnt lgkmcnt(6)
  v_mfma_f32_16x16x32_bf16 v[64:67], v[220:223], v[240:243], v[64:67]
  buffer_load_dwordx4 v[248:251], v110, s[24:27], s30 offen offset:1024 sc1
  v_mfma_f32_16x16x32_bf16 v[64:67], v[224:227], v[244:247], v[64:67]
  ds_write_b128 v118, v[52:55] offset:3072
  v_mfma_f32_16x16x32_bf16 v[68:71], v[224:227], v[136:139], v[68:71]
  ds_write_b128 v118, v[56:59] offset:8192
  v_mfma_f32_16x16x32_bf16 v[68:71], v[220:223], v[252:255], v[68:71]
  ds_write_b128 v118, v[60:63] offset:13312
  v_mfma_f32_16x16x32_bf16 v[72:75], v[220:223], v[144:147], v[72:75]
  buffer_load_dwordx4 v[140:143], v111, s[24:27], s30 offen offset:0 sc1
  v_mfma_f32_16x16x32_bf16 v[72:75], v[224:227], v[148:151], v[72:75]
  v_mfma_f32_16x16x32_bf16 v[76:79], v[224:227], a[184:187], v[76:79]
  v_mfma_f32_16x16x32_bf16 v[76:79], v[220:223], a[180:183], v[76:79]
  s_nop 1
  ds_write_b128 v118, v[68:71] offset:4096
  s_nop 2
  ds_write_b128 v118, v[72:75] offset:9216
  s_nop 0
  ds_write_b128 v118, v[76:79] offset:14336
  buffer_load_dwordx4 v[176:179], v111, s[24:27], s30 offen offset:1024 sc1
  buffer_load_dwordx4 v[180:183], v112, s[24:27], s30 offen offset:0 sc1
  buffer_load_dwordx4 v[204:207], v112, s[24:27], s30 offen offset:1024 sc1
  buffer_load_dwordx4 v[208:211], v113, s[24:27], s30 offen offset:0 sc1
  buffer_load_dwordx4 v[220:223], v113, s[24:27], s30 offen offset:1024 sc1
  s_add_u32 s30, s30, 8192
  buffer_load_dwordx4 v[224:227], v110, s[24:27], s30 offen offset:0 sc1
  buffer_load_dwordx4 v[240:243], v110, s[24:27], s30 offen offset:1024 sc1
  buffer_load_dwordx4 v[244:247], v111, s[24:27], s30 offen offset:0 sc1
  buffer_load_dwordx4 v[252:255], v111, s[24:27], s30 offen offset:1024 sc1
  buffer_load_dwordx4 v[136:139], v112, s[24:27], s30 offen offset:0 sc1
  buffer_load_dwordx4 v[144:147], v112, s[24:27], s30 offen offset:1024 sc1
  buffer_load_dwordx4 v[148:151], v113, s[24:27], s30 offen offset:0 sc1
  buffer_load_dwordx4 a[180:183], v113, s[24:27], s30 offen offset:1024 sc1
  s_add_u32 s30, s30, 8192
  buffer_load_dwordx4 a[184:187], v110, s[24:27], s30 offen offset:0 sc1
  s_waitcnt lgkmcnt(0)
  s_barrier
  ds_read_b128 v[4:7], v119 offset:0
  ds_read_b128 v[8:11], v120 offset:5120
  ds_read_b128 v[12:15], v121 offset:10240
  ds_read_b128 v[20:23], v119 offset:1024
  ds_read_b128 v[24:27], v120 offset:6144
  ds_read_b128 v[28:31], v121 offset:11264
  ds_read_b128 v[36:39], v119 offset:2048
  ds_read_b128 v[40:43], v120 offset:7168
  ds_read_b128 v[44:47], v121 offset:12288
  ds_read_b128 v[52:55], v119 offset:3072
  ds_read_b128 v[56:59], v120 offset:8192
  ds_read_b128 v[60:63], v121 offset:13312
  ds_read_b128 v[68:71], v119 offset:4096
  ds_read_b128 v[72:75], v120 offset:9216
  ds_read_b128 v[76:79], v121 offset:14336
  s_waitcnt lgkmcnt(12)
  v_add_f32 v4, v4, v8
  v_add_f32 v5, v5, v9
  v_add_f32 v6, v6, v10
  v_add_f32 v7, v7, v11
  v_add_f32 v0, v0, v12
  v_add_f32 v1, v1, v13
  v_add_f32 v2, v2, v14
  v_add_f32 v3, v3, v15
  v_add_f32 v0, v0, v4
  v_add_f32 v1, v1, v5
  v_add_f32 v2, v2, v6
  v_add_f32 v3, v3, v7
  v_cvt_pk_bf16_f32 v4, v0, v1
  v_cvt_pk_bf16_f32 v5, v2, v3
  buffer_store_dwordx2 v[4:5], v125, s[24:27], s38 offen offset:0 sc1
  s_waitcnt vmcnt(26)
  v_mfma_f32_16x16x32_bf16 v[0:3], a[212:215], a[196:199], 0
  s_waitcnt lgkmcnt(9)
  v_add_f32 v20, v20, v24
  v_add_f32 v21, v21, v25
  v_mfma_f32_16x16x32_bf16 v[0:3], a[232:235], a[200:203], v[0:3]
  v_add_f32 v22, v22, v26
  v_add_f32 v23, v23, v27
  v_mfma_f32_16x16x32_bf16 v[4:7], a[232:235], a[208:211], 0
  v_add_f32 v16, v16, v28
  v_add_f32 v17, v17, v29
  v_mfma_f32_16x16x32_bf16 v[4:7], a[212:215], v[152:155], v[4:7]
  v_add_f32 v18, v18, v30
  v_add_f32 v19, v19, v31
  v_mfma_f32_16x16x32_bf16 v[8:11], a[212:215], v[184:187], 0
  v_add_f32 v16, v16, v20
  v_add_f32 v17, v17, v21
  v_mfma_f32_16x16x32_bf16 v[8:11], a[232:235], v[188:191], v[8:11]
  v_add_f32 v18, v18, v22
  v_add_f32 v19, v19, v23
  v_mfma_f32_16x16x32_bf16 v[12:15], a[232:235], a[188:191], 0
  v_cvt_pk_bf16_f32 v20, v16, v17
  v_cvt_pk_bf16_f32 v21, v18, v19
  v_mfma_f32_16x16x32_bf16 v[12:15], a[212:215], v[200:203], v[12:15]
  buffer_store_dwordx2 v[20:21], v125, s[24:27], s38 offen offset:512 sc1
  s_waitcnt lgkmcnt(6)
  v_mfma_f32_16x16x32_bf16 v[16:19], a[216:219], a[196:199], 0
  buffer_load_dwordx4 a[212:215], v110, s[24:27], s30 offen offset:1024 sc1
  v_mfma_f32_16x16x32_bf16 v[16:19], a[236:239], a[200:203], v[16:19]
  v_add_f32 v36, v36, v40
  v_add_f32 v37, v37, v41
  v_mfma_f32_16x16x32_bf16 v[20:23], a[236:239], a[208:211], 0
  v_add_f32 v38, v38, v42
  v_add_f32 v39, v39, v43
  v_mfma_f32_16x16x32_bf16 v[20:23], a[216:219], v[152:155], v[20:23]
  v_add_f32 v32, v32, v44
  v_add_f32 v33, v33, v45
  v_mfma_f32_16x16x32_bf16 v[24:27], a[216:219], v[184:187], 0
  buffer_load_dwordx4 a[232:235], v111, s[24:27], s30 offen offset:0 sc1
  v_mfma_f32_16x16x32_bf16 v[24:27], a[236:239], v[188:191], v[24:27]
  v_add_f32 v34, v34, v46
  v_add_f32 v35, v35, v47
  v_mfma_f32_16x16x32_bf16 v[28:31], a[236:239], a[188:191], 0
  v_add_f32 v32, v32, v36
  v_add_f32 v33, v33, v37
  v_mfma_f32_16x16x32_bf16 v[28:31], a[216:219], v[200:203], v[28:31]
  v_add_f32 v34, v34, v38
  v_add_f32 v35, v35, v39
  v_cvt_pk_bf16_f32 v36, v32, v33
  v_cvt_pk_bf16_f32 v37, v34, v35
  buffer_store_dwordx2 v[36:37], v125, s[24:27], s38 offen offset:1024 sc1
  v_mfma_f32_16x16x32_bf16 v[32:35], a[220:223], a[196:199], 0
  buffer_load_dwordx4 a[216:219], v111, s[24:27], s30 offen offset:1024 sc1
  s_waitcnt lgkmcnt(3)
  v_mfma_f32_16x16x32_bf16 v[32:35], a[240:243], a[200:203], v[32:35]
  v_add_f32 v52, v52, v56
  v_add_f32 v53, v53, v57
  v_mfma_f32_16x16x32_bf16 v[36:39], a[240:243], a[208:211], 0
  v_add_f32 v54, v54, v58
  v_add_f32 v55, v55, v59
  v_mfma_f32_16x16x32_bf16 v[36:39], a[220:223], v[152:155], v[36:39]
  v_add_f32 v48, v48, v60
  v_add_f32 v49, v49, v61
  v_mfma_f32_16x16x32_bf16 v[40:43], a[220:223], v[184:187], 0
  buffer_load_dwordx4 a[236:239], v112, s[24:27], s30 offen offset:0 sc1
  v_mfma_f32_16x16x32_bf16 v[40:43], a[240:243], v[188:191], v[40:43]
  v_add_f32 v50, v50, v62
  v_add_f32 v51, v51, v63
  v_mfma_f32_16x16x32_bf16 v[44:47], a[240:243], a[188:191], 0
  v_add_f32 v48, v48, v52
  v_add_f32 v49, v49, v53
  v_mfma_f32_16x16x32_bf16 v[44:47], a[220:223], v[200:203], v[44:47]
  v_add_f32 v50, v50, v54
  v_add_f32 v51, v51, v55
  v_cvt_pk_bf16_f32 v52, v48, v49
  v_cvt_pk_bf16_f32 v53, v50, v51
  buffer_store_dwordx2 v[52:53], v125, s[24:27], s38 offen offset:1536 sc1
  v_mfma_f32_16x16x32_bf16 v[48:51], a[224:227], a[196:199], 0
  buffer_load_dwordx4 a[220:223], v112, s[24:27], s30 offen offset:1024 sc1
  s_waitcnt lgkmcnt(0)
  v_mfma_f32_16x16x32_bf16 v[48:51], a[244:247], a[200:203], v[48:51]
  v_add_f32 v68, v68, v72
  v_add_f32 v69, v69, v73
  v_mfma_f32_16x16x32_bf16 v[52:55], a[244:247], a[208:211], 0
  v_add_f32 v70, v70, v74
  v_add_f32 v71, v71, v75
  v_mfma_f32_16x16x32_bf16 v[52:55], a[224:227], v[152:155], v[52:55]
  v_add_f32 v64, v64, v76
  v_add_f32 v65, v65, v77
  v_mfma_f32_16x16x32_bf16 v[56:59], a[224:227], v[184:187], 0
  buffer_load_dwordx4 a[240:243], v113, s[24:27], s30 offen offset:0 sc1
  v_mfma_f32_16x16x32_bf16 v[56:59], a[244:247], v[188:191], v[56:59]
  v_add_f32 v66, v66, v78
  v_add_f32 v67, v67, v79
  v_mfma_f32_16x16x32_bf16 v[60:63], a[244:247], a[188:191], 0
  v_add_f32 v64, v64, v68
  v_add_f32 v65, v65, v69
  v_mfma_f32_16x16x32_bf16 v[60:63], a[224:227], v[200:203], v[60:63]
  v_add_f32 v66, v66, v70
  v_add_f32 v67, v67, v71
  v_cvt_pk_bf16_f32 v68, v64, v65
  v_cvt_pk_bf16_f32 v69, v66, v67
  buffer_store_dwordx2 v[68:69], v125, s[24:27], s38 offen offset:2048 sc1
  v_mfma_f32_16x16x32_bf16 v[64:67], a[228:231], a[196:199], 0
  buffer_load_dwordx4 a[224:227], v113, s[24:27], s30 offen offset:1024 sc1
  s_xor_b32 s38, s40, 1
  s_lshl_b32 s38, s38, 7
  s_add_u32 s38, s38, 2834432
  v_mfma_f32_16x16x32_bf16 v[64:67], a[248:251], a[200:203], v[64:67]
  v_mov_b32 v126, 1073741824
  v_writelane_b32 v126, s38, 0
  v_mfma_f32_16x16x32_bf16 v[68:71], a[248:251], a[208:211], 0
  v_mov_b32 v127, 1
  v_mfma_f32_16x16x32_bf16 v[68:71], a[228:231], v[152:155], v[68:71]
  s_xor_b32 s38, s38, 128
  v_mov_b32 v133, s38
  v_mov_b32 v134, 4
  v_mfma_f32_16x16x32_bf16 v[72:75], a[228:231], v[184:187], 0
  s_add_u32 s30, s30, 8192
  buffer_load_dwordx4 a[244:247], v110, s[24:27], s30 offen offset:0 sc1
  v_mfma_f32_16x16x32_bf16 v[72:75], a[248:251], v[188:191], v[72:75]
  v_mfma_f32_16x16x32_bf16 v[76:79], a[248:251], a[188:191], 0
  v_mfma_f32_16x16x32_bf16 v[76:79], a[228:231], v[200:203], v[76:79]
  s_waitcnt vmcnt(30)
  v_mfma_f32_16x16x32_bf16 v[0:3], a[252:255], v[236:239], v[0:3]
  buffer_load_dwordx4 a[228:231], v110, s[24:27], s30 offen offset:1024 sc1
  v_mfma_f32_16x16x32_bf16 v[0:3], a[144:147], v[192:195], v[0:3]
  v_mfma_f32_16x16x32_bf16 v[4:7], a[144:147], v[212:215], v[4:7]
  v_mfma_f32_16x16x32_bf16 v[4:7], a[252:255], v[196:199], v[4:7]
  v_mfma_f32_16x16x32_bf16 v[8:11], a[252:255], v[216:219], v[8:11]
  buffer_load_dwordx4 a[248:251], v111, s[24:27], s30 offen offset:0 sc1
  v_mfma_f32_16x16x32_bf16 v[8:11], a[144:147], v[228:231], v[8:11]
  v_mfma_f32_16x16x32_bf16 v[12:15], a[144:147], a[192:195], v[12:15]
  v_mfma_f32_16x16x32_bf16 v[12:15], a[252:255], v[232:235], v[12:15]
  v_mfma_f32_16x16x32_bf16 v[16:19], a[128:131], v[236:239], v[16:19]
  buffer_load_dwordx4 a[196:199], v111, s[24:27], s30 offen offset:1024 sc1
  v_mfma_f32_16x16x32_bf16 v[16:19], a[148:151], v[192:195], v[16:19]
  v_mfma_f32_16x16x32_bf16 v[20:23], a[148:151], v[212:215], v[20:23]
  v_mfma_f32_16x16x32_bf16 v[20:23], a[128:131], v[196:199], v[20:23]
  v_mfma_f32_16x16x32_bf16 v[24:27], a[128:131], v[216:219], v[24:27]
  buffer_load_dwordx4 a[200:203], v112, s[24:27], s30 offen offset:0 sc1
  v_mfma_f32_16x16x32_bf16 v[24:27], a[148:151], v[228:231], v[24:27]
  v_mfma_f32_16x16x32_bf16 v[28:31], a[148:151], a[192:195], v[28:31]
  v_mfma_f32_16x16x32_bf16 v[28:31], a[128:131], v[232:235], v[28:31]
  v_mfma_f32_16x16x32_bf16 v[32:35], a[132:135], v[236:239], v[32:35]
  buffer_load_dwordx4 a[208:211], v112, s[24:27], s30 offen offset:1024 sc1
  v_mfma_f32_16x16x32_bf16 v[32:35], a[152:155], v[192:195], v[32:35]
  v_mfma_f32_16x16x32_bf16 v[36:39], a[152:155], v[212:215], v[36:39]
  v_mfma_f32_16x16x32_bf16 v[36:39], a[132:135], v[196:199], v[36:39]
  v_mfma_f32_16x16x32_bf16 v[40:43], a[132:135], v[216:219], v[40:43]
  buffer_load_dwordx4 v[184:187], v113, s[24:27], s30 offen offset:0 sc1
  v_mfma_f32_16x16x32_bf16 v[40:43], a[152:155], v[228:231], v[40:43]
  v_mfma_f32_16x16x32_bf16 v[44:47], a[152:155], a[192:195], v[44:47]
  v_mfma_f32_16x16x32_bf16 v[44:47], a[132:135], v[232:235], v[44:47]
  v_mfma_f32_16x16x32_bf16 v[48:51], a[136:139], v[236:239], v[48:51]
  buffer_load_dwordx4 v[188:191], v113, s[24:27], s30 offen offset:1024 sc1
  v_mfma_f32_16x16x32_bf16 v[48:51], a[156:159], v[192:195], v[48:51]
  v_mfma_f32_16x16x32_bf16 v[52:55], a[156:159], v[212:215], v[52:55]
  v_mfma_f32_16x16x32_bf16 v[52:55], a[136:139], v[196:199], v[52:55]
  v_mfma_f32_16x16x32_bf16 v[56:59], a[136:139], v[216:219], v[56:59]
  s_add_u32 s30, s30, 8192
  buffer_load_dwordx4 v[200:203], v110, s[24:27], s30 offen offset:0 sc1
  v_mfma_f32_16x16x32_bf16 v[56:59], a[156:159], v[228:231], v[56:59]
  v_mfma_f32_16x16x32_bf16 v[60:63], a[156:159], a[192:195], v[60:63]
  v_mfma_f32_16x16x32_bf16 v[60:63], a[136:139], v[232:235], v[60:63]
  v_mfma_f32_16x16x32_bf16 v[64:67], a[140:143], v[236:239], v[64:67]
  buffer_load_dwordx4 a[188:191], v110, s[24:27], s30 offen offset:1024 sc1
  v_mfma_f32_16x16x32_bf16 v[64:67], a[0:3], v[192:195], v[64:67]
  v_mfma_f32_16x16x32_bf16 v[68:71], a[0:3], v[212:215], v[68:71]
  v_mfma_f32_16x16x32_bf16 v[68:71], a[140:143], v[196:199], v[68:71]
  v_mfma_f32_16x16x32_bf16 v[72:75], a[140:143], v[216:219], v[72:75]
  buffer_load_dwordx4 a[252:255], v111, s[24:27], s30 offen offset:0 sc1
  v_mfma_f32_16x16x32_bf16 v[72:75], a[0:3], v[228:231], v[72:75]
  v_mfma_f32_16x16x32_bf16 v[76:79], a[0:3], a[192:195], v[76:79]
  v_mfma_f32_16x16x32_bf16 v[76:79], a[140:143], v[232:235], v[76:79]
  s_waitcnt vmcnt(32)
  v_mfma_f32_16x16x32_bf16 v[0:3], a[4:7], a[204:207], v[0:3]
  buffer_load_dwordx4 a[144:147], v111, s[24:27], s30 offen offset:1024 sc1
  v_mfma_f32_16x16x32_bf16 v[0:3], a[24:27], v[248:251], v[0:3]
  v_mfma_f32_16x16x32_bf16 v[4:7], a[24:27], v[176:179], v[4:7]
  v_mfma_f32_16x16x32_bf16 v[4:7], a[4:7], v[140:143], v[4:7]
  v_mfma_f32_16x16x32_bf16 v[8:11], a[4:7], v[180:183], v[8:11]
  buffer_load_dwordx4 a[128:131], v112, s[24:27], s30 offen offset:0 sc1
  v_mfma_f32_16x16x32_bf16 v[8:11], a[24:27], v[204:207], v[8:11]
  v_mfma_f32_16x16x32_bf16 v[12:15], a[24:27], v[220:223], v[12:15]
  v_mfma_f32_16x16x32_bf16 v[12:15], a[4:7], v[208:211], v[12:15]
  v_mfma_f32_16x16x32_bf16 v[16:19], a[8:11], a[204:207], v[16:19]
  buffer_load_dwordx4 a[148:151], v112, s[24:27], s30 offen offset:1024 sc1
  v_mfma_f32_16x16x32_bf16 v[16:19], a[28:31], v[248:251], v[16:19]
  v_mfma_f32_16x16x32_bf16 v[20:23], a[28:31], v[176:179], v[20:23]
  v_mfma_f32_16x16x32_bf16 v[20:23], a[8:11], v[140:143], v[20:23]
  v_mfma_f32_16x16x32_bf16 v[24:27], a[8:11], v[180:183], v[24:27]
  buffer_load_dwordx4 a[132:135], v113, s[24:27], s30 offen offset:0 sc1
  v_mfma_f32_16x16x32_bf16 v[24:27], a[28:31], v[204:207], v[24:27]
  v_mfma_f32_16x16x32_bf16 v[28:31], a[28:31], v[220:223], v[28:31]
  v_mfma_f32_16x16x32_bf16 v[28:31], a[8:11], v[208:211], v[28:31]
  v_mfma_f32_16x16x32_bf16 v[32:35], a[12:15], a[204:207], v[32:35]
  buffer_load_dwordx4 a[152:155], v113, s[24:27], s30 offen offset:1024 sc1
  v_mfma_f32_16x16x32_bf16 v[32:35], a[32:35], v[248:251], v[32:35]
  v_mfma_f32_16x16x32_bf16 v[36:39], a[32:35], v[176:179], v[36:39]
  v_mfma_f32_16x16x32_bf16 v[36:39], a[12:15], v[140:143], v[36:39]
  v_mfma_f32_16x16x32_bf16 v[40:43], a[12:15], v[180:183], v[40:43]
  s_add_u32 s30, s30, 8192
  buffer_load_dwordx4 a[136:139], v110, s[24:27], s30 offen offset:0 sc1
  v_mfma_f32_16x16x32_bf16 v[40:43], a[32:35], v[204:207], v[40:43]
  v_mfma_f32_16x16x32_bf16 v[44:47], a[32:35], v[220:223], v[44:47]
  v_mfma_f32_16x16x32_bf16 v[44:47], a[12:15], v[208:211], v[44:47]
  v_mfma_f32_16x16x32_bf16 v[48:51], a[16:19], a[204:207], v[48:51]
  buffer_load_dwordx4 a[156:159], v110, s[24:27], s30 offen offset:1024 sc1
  v_mfma_f32_16x16x32_bf16 v[48:51], a[36:39], v[248:251], v[48:51]
  v_mfma_f32_16x16x32_bf16 v[52:55], a[36:39], v[176:179], v[52:55]
  v_mfma_f32_16x16x32_bf16 v[52:55], a[16:19], v[140:143], v[52:55]
  v_mfma_f32_16x16x32_bf16 v[56:59], a[16:19], v[180:183], v[56:59]
  buffer_load_dwordx4 a[140:143], v111, s[24:27], s30 offen offset:0 sc1
  v_mfma_f32_16x16x32_bf16 v[56:59], a[36:39], v[204:207], v[56:59]
  v_mfma_f32_16x16x32_bf16 v[60:63], a[36:39], v[220:223], v[60:63]
  v_mfma_f32_16x16x32_bf16 v[60:63], a[16:19], v[208:211], v[60:63]
  v_mfma_f32_16x16x32_bf16 v[64:67], a[20:23], a[204:207], v[64:67]
  buffer_load_dwordx4 a[0:3], v111, s[24:27], s30 offen offset:1024 sc1
  v_mfma_f32_16x16x32_bf16 v[64:67], a[40:43], v[248:251], v[64:67]
  v_mfma_f32_16x16x32_bf16 v[68:71], a[40:43], v[176:179], v[68:71]
  v_mfma_f32_16x16x32_bf16 v[68:71], a[20:23], v[140:143], v[68:71]
  v_mfma_f32_16x16x32_bf16 v[72:75], a[20:23], v[180:183], v[72:75]
  buffer_load_dwordx4 v[236:239], v112, s[24:27], s30 offen offset:0 sc1
  v_mfma_f32_16x16x32_bf16 v[72:75], a[40:43], v[204:207], v[72:75]
  v_mfma_f32_16x16x32_bf16 v[76:79], a[40:43], v[220:223], v[76:79]
  v_mfma_f32_16x16x32_bf16 v[76:79], a[20:23], v[208:211], v[76:79]
  s_waitcnt vmcnt(34)
  v_mfma_f32_16x16x32_bf16 v[0:3], a[44:47], v[224:227], v[0:3]
  buffer_load_dwordx4 v[192:195], v112, s[24:27], s30 offen offset:1024 sc1
  s_waitcnt vmcnt(23)
  v_mfma_f32_16x16x32_bf16 v[0:3], a[64:67], v[240:243], v[0:3]
  buffer_atomic_add v127, v126, s[24:27], 0 offen
  v_mfma_f32_16x16x32_bf16 v[4:7], a[64:67], v[252:255], v[4:7]
  v_mfma_f32_16x16x32_bf16 v[4:7], a[44:47], v[244:247], v[4:7]
  v_mfma_f32_16x16x32_bf16 v[8:11], a[44:47], v[136:139], v[8:11]
  buffer_load_dwordx4 v[196:199], v113, s[24:27], s30 offen offset:0 sc1
  v_mfma_f32_16x16x32_bf16 v[8:11], a[64:67], v[144:147], v[8:11]
  v_mfma_f32_16x16x32_bf16 v[12:15], a[64:67], a[180:183], v[12:15]
  v_mfma_f32_16x16x32_bf16 v[12:15], a[44:47], v[148:151], v[12:15]
  v_mfma_f32_16x16x32_bf16 v[16:19], a[48:51], v[224:227], v[16:19]
  buffer_load_dwordx4 v[212:215], v113, s[24:27], s30 offen offset:1024 sc1
  v_mfma_f32_16x16x32_bf16 v[16:19], a[68:71], v[240:243], v[16:19]
  v_mfma_f32_16x16x32_bf16 v[20:23], a[68:71], v[252:255], v[20:23]
  v_mfma_f32_16x16x32_bf16 v[20:23], a[48:51], v[244:247], v[20:23]
  v_mfma_f32_16x16x32_bf16 v[24:27], a[48:51], v[136:139], v[24:27]
  s_add_u32 s30, s30, 8192
  v_mfma_f32_16x16x32_bf16 v[24:27], a[68:71], v[144:147], v[24:27]
  v_mfma_f32_16x16x32_bf16 v[28:31], a[68:71], a[180:183], v[28:31]
  v_mfma_f32_16x16x32_bf16 v[28:31], a[48:51], v[148:151], v[28:31]
  v_mfma_f32_16x16x32_bf16 v[32:35], a[52:55], v[224:227], v[32:35]
  v_mfma_f32_16x16x32_bf16 v[32:35], a[72:75], v[240:243], v[32:35]
  v_mfma_f32_16x16x32_bf16 v[36:39], a[72:75], v[252:255], v[36:39]
  v_mfma_f32_16x16x32_bf16 v[36:39], a[52:55], v[244:247], v[36:39]
  v_mfma_f32_16x16x32_bf16 v[40:43], a[52:55], v[136:139], v[40:43]
  v_mfma_f32_16x16x32_bf16 v[40:43], a[72:75], v[144:147], v[40:43]
  v_mfma_f32_16x16x32_bf16 v[44:47], a[72:75], a[180:183], v[44:47]
  v_mfma_f32_16x16x32_bf16 v[44:47], a[52:55], v[148:151], v[44:47]
  v_mfma_f32_16x16x32_bf16 v[48:51], a[56:59], v[224:227], v[48:51]
  v_mfma_f32_16x16x32_bf16 v[48:51], a[76:79], v[240:243], v[48:51]
  v_mfma_f32_16x16x32_bf16 v[52:55], a[76:79], v[252:255], v[52:55]
  v_mfma_f32_16x16x32_bf16 v[52:55], a[56:59], v[244:247], v[52:55]
  v_mfma_f32_16x16x32_bf16 v[56:59], a[56:59], v[136:139], v[56:59]
  v_mfma_f32_16x16x32_bf16 v[56:59], a[76:79], v[144:147], v[56:59]
  v_mfma_f32_16x16x32_bf16 v[60:63], a[76:79], a[180:183], v[60:63]
  v_mfma_f32_16x16x32_bf16 v[60:63], a[56:59], v[148:151], v[60:63]
  v_mfma_f32_16x16x32_bf16 v[64:67], a[60:63], v[224:227], v[64:67]
  v_mfma_f32_16x16x32_bf16 v[64:67], a[80:83], v[240:243], v[64:67]
  v_mfma_f32_16x16x32_bf16 v[68:71], a[80:83], v[252:255], v[68:71]
  v_mfma_f32_16x16x32_bf16 v[68:71], a[60:63], v[244:247], v[68:71]
  v_mfma_f32_16x16x32_bf16 v[72:75], a[60:63], v[136:139], v[72:75]
  v_mfma_f32_16x16x32_bf16 v[72:75], a[80:83], v[144:147], v[72:75]
  v_mfma_f32_16x16x32_bf16 v[76:79], a[80:83], a[180:183], v[76:79]
  v_mfma_f32_16x16x32_bf16 v[76:79], a[60:63], v[148:151], v[76:79]
  s_waitcnt vmcnt(25)
  v_mfma_f32_16x16x32_bf16 v[0:3], a[84:87], a[184:187], v[0:3]
  v_mfma_f32_16x16x32_bf16 v[0:3], a[104:107], a[212:215], v[0:3]
  v_mfma_f32_16x16x32_bf16 v[4:7], a[104:107], a[216:219], v[4:7]
  v_mfma_f32_16x16x32_bf16 v[4:7], a[84:87], a[232:235], v[4:7]
  v_mfma_f32_16x16x32_bf16 v[8:11], a[84:87], a[236:239], v[8:11]
  v_mfma_f32_16x16x32_bf16 v[8:11], a[104:107], a[220:223], v[8:11]
  v_mfma_f32_16x16x32_bf16 v[12:15], a[104:107], a[224:227], v[12:15]
  v_mfma_f32_16x16x32_bf16 v[12:15], a[84:87], a[240:243], v[12:15]
  v_mfma_f32_16x16x32_bf16 v[16:19], a[88:91], a[184:187], v[16:19]
  v_mfma_f32_16x16x32_bf16 v[16:19], a[108:111], a[212:215], v[16:19]
  v_mfma_f32_16x16x32_bf16 v[20:23], a[108:111], a[216:219], v[20:23]
  v_mfma_f32_16x16x32_bf16 v[20:23], a[88:91], a[232:235], v[20:23]
  v_mfma_f32_16x16x32_bf16 v[24:27], a[88:91], a[236:239], v[24:27]
  v_mfma_f32_16x16x32_bf16 v[24:27], a[108:111], a[220:223], v[24:27]
  v_mfma_f32_16x16x32_bf16 v[28:31], a[108:111], a[224:227], v[28:31]
  v_mfma_f32_16x16x32_bf16 v[28:31], a[88:91], a[240:243], v[28:31]
  v_mfma_f32_16x16x32_bf16 v[32:35], a[92:95], a[184:187], v[32:35]
  v_mfma_f32_16x16x32_bf16 v[32:35], a[112:115], a[212:215], v[32:35]
  v_mfma_f32_16x16x32_bf16 v[36:39], a[112:115], a[216:219], v[36:39]
  v_mfma_f32_16x16x32_bf16 v[36:39], a[92:95], a[232:235], v[36:39]
  v_mfma_f32_16x16x32_bf16 v[40:43], a[92:95], a[236:239], v[40:43]
  v_mfma_f32_16x16x32_bf16 v[40:43], a[112:115], a[220:223], v[40:43]
  v_mfma_f32_16x16x32_bf16 v[44:47], a[112:115], a[224:227], v[44:47]
  v_mfma_f32_16x16x32_bf16 v[44:47], a[92:95], a[240:243], v[44:47]
  v_mfma_f32_16x16x32_bf16 v[48:51], a[96:99], a[184:187], v[48:51]
  v_mfma_f32_16x16x32_bf16 v[48:51], a[116:119], a[212:215], v[48:51]
  v_mfma_f32_16x16x32_bf16 v[52:55], a[116:119], a[216:219], v[52:55]
  v_mfma_f32_16x16x32_bf16 v[52:55], a[96:99], a[232:235], v[52:55]
  v_mfma_f32_16x16x32_bf16 v[56:59], a[96:99], a[236:239], v[56:59]
  v_mfma_f32_16x16x32_bf16 v[56:59], a[116:119], a[220:223], v[56:59]
  v_mfma_f32_16x16x32_bf16 v[60:63], a[116:119], a[224:227], v[60:63]
  v_mfma_f32_16x16x32_bf16 v[60:63], a[96:99], a[240:243], v[60:63]
  v_mfma_f32_16x16x32_bf16 v[64:67], a[100:103], a[184:187], v[64:67]
  ds_read_b128 v[216:219], v122 offset:0
  v_mfma_f32_16x16x32_bf16 v[64:67], a[120:123], a[212:215], v[64:67]
  v_mfma_f32_16x16x32_bf16 v[68:71], a[120:123], a[216:219], v[68:71]
  v_mfma_f32_16x16x32_bf16 v[68:71], a[100:103], a[232:235], v[68:71]
  v_mfma_f32_16x16x32_bf16 v[72:75], a[100:103], a[236:239], v[72:75]
  v_mfma_f32_16x16x32_bf16 v[72:75], a[120:123], a[220:223], v[72:75]
  v_mfma_f32_16x16x32_bf16 v[76:79], a[120:123], a[224:227], v[76:79]
  v_mfma_f32_16x16x32_bf16 v[76:79], a[100:103], a[240:243], v[76:79]
  s_waitcnt vmcnt(17)
  v_mfma_f32_16x16x32_bf16 v[0:3], a[124:127], a[244:247], v[0:3]
  ds_read_b128 v[228:231], v122 offset:1024
  buffer_load_dword v128, v133, s[24:27], 0 offen sc1
  s_xor_b32 s38, s40, 0
  s_lshl_b32 s38, s38, 2
  s_add_u32 s38, s38, s3
  v_mfma_f32_16x16x32_bf16 v[0:3], a[176:179], a[228:231], v[0:3]
  s_lshl_b32 s38, s38, 12
  s_add_u32 s38, s38, 25165824
  v_mfma_f32_16x16x32_bf16 v[4:7], a[176:179], a[196:199], v[4:7]
  v_mfma_f32_16x16x32_bf16 v[4:7], a[124:127], a[248:251], v[4:7]
  v_mfma_f32_16x16x32_bf16 v[8:11], a[124:127], a[200:203], v[8:11]
  v_mfma_f32_16x16x32_bf16 v[8:11], a[176:179], a[208:211], v[8:11]
  v_mfma_f32_16x16x32_bf16 v[12:15], a[176:179], v[188:191], v[12:15]
  v_mfma_f32_16x16x32_bf16 v[12:15], a[124:127], v[184:187], v[12:15]
  s_waitcnt lgkmcnt(1)
  v_mfma_f32_16x16x32_bf16 v[16:19], a[160:163], a[244:247], v[16:19]
  ds_read_b128 v[232:235], v122 offset:2048
  v_mfma_f32_16x16x32_bf16 v[16:19], v[216:219], a[228:231], v[16:19]
  v_mfma_f32_16x16x32_bf16 v[20:23], v[216:219], a[196:199], v[20:23]
  v_mfma_f32_16x16x32_bf16 v[20:23], a[160:163], a[248:251], v[20:23]
  v_mfma_f32_16x16x32_bf16 v[24:27], a[160:163], a[200:203], v[24:27]
  v_mfma_f32_16x16x32_bf16 v[24:27], v[216:219], a[208:211], v[24:27]
  v_mfma_f32_16x16x32_bf16 v[28:31], v[216:219], v[188:191], v[28:31]
  v_mfma_f32_16x16x32_bf16 v[28:31], a[160:163], v[184:187], v[28:31]
  s_waitcnt lgkmcnt(1)
  v_mfma_f32_16x16x32_bf16 v[32:35], a[164:167], a[244:247], v[32:35]
  ds_read_b128 a[192:195], v122 offset:3072
  v_mfma_f32_16x16x32_bf16 v[32:35], v[228:231], a[228:231], v[32:35]
  v_mfma_f32_16x16x32_bf16 v[36:39], v[228:231], a[196:199], v[36:39]
  v_mfma_f32_16x16x32_bf16 v[36:39], a[164:167], a[248:251], v[36:39]
  v_mfma_f32_16x16x32_bf16 v[40:43], a[164:167], a[200:203], v[40:43]
  v_mfma_f32_16x16x32_bf16 v[40:43], v[228:231], a[208:211], v[40:43]
  v_mfma_f32_16x16x32_bf16 v[44:47], v[228:231], v[188:191], v[44:47]
  v_mfma_f32_16x16x32_bf16 v[44:47], a[164:167], v[184:187], v[44:47]
  s_waitcnt lgkmcnt(1)
  v_mfma_f32_16x16x32_bf16 v[48:51], a[168:171], a[244:247], v[48:51]
  ds_read_b128 a[4:7], v122 offset:16384
  ds_read_b128 a[24:27], v122 offset:33792
  v_mfma_f32_16x16x32_bf16 v[48:51], v[232:235], a[228:231], v[48:51]
  v_mfma_f32_16x16x32_bf16 v[52:55], v[232:235], a[196:199], v[52:55]
  v_mfma_f32_16x16x32_bf16 v[52:55], a[168:171], a[248:251], v[52:55]
  v_mfma_f32_16x16x32_bf16 v[56:59], a[168:171], a[200:203], v[56:59]
  v_mfma_f32_16x16x32_bf16 v[56:59], v[232:235], a[208:211], v[56:59]
  v_mfma_f32_16x16x32_bf16 v[60:63], v[232:235], v[188:191], v[60:63]
  v_mfma_f32_16x16x32_bf16 v[60:63], a[168:171], v[184:187], v[60:63]
  s_waitcnt lgkmcnt(2)
  v_mfma_f32_16x16x32_bf16 v[64:67], a[172:175], a[244:247], v[64:67]
  ds_read_b128 a[8:11], v122 offset:17408
  ds_read_b128 a[28:31], v122 offset:34816
  v_mfma_f32_16x16x32_bf16 v[64:67], a[192:195], a[228:231], v[64:67]
  v_mfma_f32_16x16x32_bf16 v[68:71], a[192:195], a[196:199], v[68:71]
  v_mfma_f32_16x16x32_bf16 v[68:71], a[172:175], a[248:251], v[68:71]
  v_mfma_f32_16x16x32_bf16 v[72:75], a[172:175], a[200:203], v[72:75]
  v_mfma_f32_16x16x32_bf16 v[72:75], a[192:195], a[208:211], v[72:75]
  v_mfma_f32_16x16x32_bf16 v[76:79], a[192:195], v[188:191], v[76:79]
  v_mfma_f32_16x16x32_bf16 v[76:79], a[172:175], v[184:187], v[76:79]
  s_waitcnt vmcnt(10) lgkmcnt(2)
  v_mfma_f32_16x16x32_bf16 v[0:3], a[4:7], v[200:203], v[0:3]
  ds_read_b128 a[12:15], v122 offset:18432
  ds_read_b128 a[32:35], v122 offset:35840
  v_mfma_f32_16x16x32_bf16 v[0:3], a[24:27], a[188:191], v[0:3]
  v_mfma_f32_16x16x32_bf16 v[4:7], a[24:27], a[144:147], v[4:7]
  v_mfma_f32_16x16x32_bf16 v[4:7], a[4:7], a[252:255], v[4:7]
  v_mfma_f32_16x16x32_bf16 v[8:11], a[4:7], a[128:131], v[8:11]
  v_mfma_f32_16x16x32_bf16 v[8:11], a[24:27], a[148:151], v[8:11]
  v_mfma_f32_16x16x32_bf16 v[12:15], a[24:27], a[152:155], v[12:15]
  v_mfma_f32_16x16x32_bf16 v[12:15], a[4:7], a[132:135], v[12:15]
  s_waitcnt lgkmcnt(2)
  v_mfma_f32_16x16x32_bf16 v[16:19], a[8:11], v[200:203], v[16:19]
  ds_read_b128 a[16:19], v122 offset:19456
  ds_read_b128 a[36:39], v135 offset:0
  v_mfma_f32_16x16x32_bf16 v[16:19], a[28:31], a[188:191], v[16:19]
  v_mfma_f32_16x16x32_bf16 v[20:23], a[28:31], a[144:147], v[20:23]
  v_mfma_f32_16x16x32_bf16 v[20:23], a[8:11], a[252:255], v[20:23]
  v_mfma_f32_16x16x32_bf16 v[24:27], a[8:11], a[128:131], v[24:27]
  v_mfma_f32_16x16x32_bf16 v[24:27], a[28:31], a[148:151], v[24:27]
  v_mfma_f32_16x16x32_bf16 v[28:31], a[28:31], a[152:155], v[28:31]
  v_mfma_f32_16x16x32_bf16 v[28:31], a[8:11], a[132:135], v[28:31]
  s_waitcnt lgkmcnt(2)
  v_mfma_f32_16x16x32_bf16 v[32:35], a[12:15], v[200:203], v[32:35]
  ds_read_b128 a[20:23], v122 offset:32768
  ds_read_b128 a[40:43], v135 offset:1024
  v_mfma_f32_16x16x32_bf16 v[32:35], a[32:35], a[188:191], v[32:35]
  v_mfma_f32_16x16x32_bf16 v[36:39], a[32:35], a[144:147], v[36:39]
  v_mfma_f32_16x16x32_bf16 v[36:39], a[12:15], a[252:255], v[36:39]
  v_mfma_f32_16x16x32_bf16 v[40:43], a[12:15], a[128:131], v[40:43]
  v_mfma_f32_16x16x32_bf16 v[40:43], a[32:35], a[148:151], v[40:43]
  v_mfma_f32_16x16x32_bf16 v[44:47], a[32:35], a[152:155], v[44:47]
  v_mfma_f32_16x16x32_bf16 v[44:47], a[12:15], a[132:135], v[44:47]
  s_waitcnt lgkmcnt(2)
  v_mfma_f32_16x16x32_bf16 v[48:51], a[16:19], v[200:203], v[48:51]
  ds_read_b128 a[204:207], v135 offset:2048
  ds_read_b128 v[248:251], v135 offset:19456
  v_mfma_f32_16x16x32_bf16 v[48:51], a[36:39], a[188:191], v[48:51]
  v_mfma_f32_16x16x32_bf16 v[52:55], a[36:39], a[144:147], v[52:55]
  v_mfma_f32_16x16x32_bf16 v[52:55], a[16:19], a[252:255], v[52:55]
  v_mfma_f32_16x16x32_bf16 v[56:59], a[16:19], a[128:131], v[56:59]
  v_mfma_f32_16x16x32_bf16 v[56:59], a[36:39], a[148:151], v[56:59]
  v_mfma_f32_16x16x32_bf16 v[60:63], a[36:39], a[152:155], v[60:63]
  v_mfma_f32_16x16x32_bf16 v[60:63], a[16:19], a[132:135], v[60:63]
  s_waitcnt lgkmcnt(2)
  v_mfma_f32_16x16x32_bf16 v[64:67], a[20:23], v[200:203], v[64:67]
  ds_read_b128 v[176:179], v135 offset:3072
  ds_read_b128 v[180:183], v122 offset:49152
  v_mfma_f32_16x16x32_bf16 v[64:67], a[40:43], a[188:191], v[64:67]
  v_mfma_f32_16x16x32_bf16 v[68:71], a[40:43], a[144:147], v[68:71]
  v_mfma_f32_16x16x32_bf16 v[68:71], a[20:23], a[252:255], v[68:71]
  v_mfma_f32_16x16x32_bf16 v[72:75], a[20:23], a[128:131], v[72:75]
  v_mfma_f32_16x16x32_bf16 v[72:75], a[40:43], a[148:151], v[72:75]
  v_mfma_f32_16x16x32_bf16 v[76:79], a[40:43], a[152:155], v[76:79]
  v_mfma_f32_16x16x32_bf16 v[76:79], a[20:23], a[132:135], v[76:79]
  s_waitcnt vmcnt(0)
  v_cmp_lt_u32 vcc, v128, v134
  s_nop 0
  s_cbranch_vccz tail_partner
  s_mov_b32 s35, 32768
tail_spin2:
  s_sleep 2
  buffer_load_dword v128, v133, s[24:27], 0 offen sc1
  s_waitcnt vmcnt(0)
  v_cmp_lt_u32 vcc, v128, v134
  s_nop 0
  s_cbranch_vccz tail_partner
  s_sub_u32 s35, s35, 1
  s_cmp_lg_u32 s35, 0
  s_cbranch_scc1 tail_spin2
tail_partner:
  s_waitcnt lgkmcnt(2)
  v_mfma_f32_16x16x32_bf16 v[0:3], a[204:207], a[136:139], v[0:3]
  ds_read_b128 v[204:207], v135 offset:16384
  ds_read_b128 v[208:211], v122 offset:50176
  v_mfma_f32_16x16x32_bf16 v[0:3], v[248:251], a[156:159], v[0:3]
  buffer_load_dwordx2 v[138:139], v125, s[24:27], s38 offen offset:0 sc1
  v_mfma_f32_16x16x32_bf16 v[4:7], v[248:251], a[0:3], v[4:7]
  buffer_load_dwordx2 v[142:143], v125, s[24:27], s38 offen offset:512 sc1
  v_mfma_f32_16x16x32_bf16 v[4:7], a[204:207], a[140:143], v[4:7]
  buffer_load_dwordx2 v[146:147], v125, s[24:27], s38 offen offset:1024 sc1
  v_mfma_f32_16x16x32_bf16 v[8:11], a[204:207], v[236:239], v[8:11]
  buffer_load_dwordx2 v[150:151], v125, s[24:27], s38 offen offset:1536 sc1
  v_mfma_f32_16x16x32_bf16 v[8:11], v[248:251], v[192:195], v[8:11]
  buffer_load_dwordx2 v[154:155], v125, s[24:27], s38 offen offset:2048 sc1
  v_mfma_f32_16x16x32_bf16 v[12:15], v[248:251], v[212:215], v[12:15]
  v_mfma_f32_16x16x32_bf16 v[12:15], a[204:207], v[196:199], v[12:15]
  s_waitcnt lgkmcnt(2)
  v_mfma_f32_16x16x32_bf16 v[16:19], v[176:179], a[136:139], v[16:19]
  ds_read_b128 v[220:223], v135 offset:17408
  ds_read_b128 a[44:47], v122 offset:51200
  v_mfma_f32_16x16x32_bf16 v[16:19], v[180:183], a[156:159], v[16:19]
  ds_write_b128 v122, v[4:7] offset:0
  ds_write_b128 v122, v[8:11] offset:17408
  v_mfma_f32_16x16x32_bf16 v[20:23], v[180:183], a[0:3], v[20:23]
  ds_write_b128 v122, v[12:15] offset:34816
  v_mfma_f32_16x16x32_bf16 v[20:23], v[176:179], a[140:143], v[20:23]
  v_mfma_f32_16x16x32_bf16 v[24:27], v[176:179], v[236:239], v[24:27]
  v_mfma_f32_16x16x32_bf16 v[24:27], v[180:183], v[192:195], v[24:27]
  v_mfma_f32_16x16x32_bf16 v[28:31], v[180:183], v[212:215], v[28:31]
  v_mfma_f32_16x16x32_bf16 v[28:31], v[176:179], v[196:199], v[28:31]
  s_waitcnt lgkmcnt(5)
  v_mfma_f32_16x16x32_bf16 v[32:35], v[204:207], a[136:139], v[32:35]
  ds_read_b128 a[64:67], v135 offset:18432
  ds_read_b128 a[48:51], v122 offset:52224
  v_mfma_f32_16x16x32_bf16 v[32:35], v[208:211], a[156:159], v[32:35]
  ds_write_b128 v122, v[20:23] offset:1024
  ds_write_b128 v122, v[24:27] offset:18432
  v_mfma_f32_16x16x32_bf16 v[36:39], v[208:211], a[0:3], v[36:39]
  ds_write_b128 v122, v[28:31] offset:35840
  v_mfma_f32_16x16x32_bf16 v[36:39], v[204:207], a[140:143], v[36:39]
  v_mfma_f32_16x16x32_bf16 v[40:43], v[204:207], v[236:239], v[40:43]
  v_mfma_f32_16x16x32_bf16 v[40:43], v[208:211], v[192:195], v[40:43]
  v_mfma_f32_16x16x32_bf16 v[44:47], v[208:211], v[212:215], v[44:47]
  v_mfma_f32_16x16x32_bf16 v[44:47], v[204:207], v[196:199], v[44:47]
  s_waitcnt lgkmcnt(8)
  v_mfma_f32_16x16x32_bf16 v[48:51], v[220:223], a[136:139], v[48:51]
  v_mfma_f32_16x16x32_bf16 v[48:51], a[44:47], a[156:159], v[48:51]
  v_mfma_f32_16x16x32_bf16 v[52:55], a[44:47], a[0:3], v[52:55]
  ds_write_b128 v122, v[36:39] offset:2048
  v_mfma_f32_16x16x32_bf16 v[52:55], v[220:223], a[140:143], v[52:55]
  ds_write_b128 v122, v[40:43] offset:19456
  v_mfma_f32_16x16x32_bf16 v[56:59], v[220:223], v[236:239], v[56:59]
  ds_write_b128 v122, v[44:47] offset:49152
  v_mfma_f32_16x16x32_bf16 v[56:59], a[44:47], v[192:195], v[56:59]
  v_mfma_f32_16x16x32_bf16 v[60:63], a[44:47], v[212:215], v[60:63]
  v_mfma_f32_16x16x32_bf16 v[60:63], v[220:223], v[196:199], v[60:63]
  s_waitcnt lgkmcnt(6)
  v_mfma_f32_16x16x32_bf16 v[64:67], a[64:67], a[136:139], v[64:67]
  ds_write_b128 v122, v[52:55] offset:3072
  v_mfma_f32_16x16x32_bf16 v[64:67], a[48:51], a[156:159], v[64:67]
  v_mfma_f32_16x16x32_bf16 v[68:71], a[48:51], a[0:3], v[68:71]
  v_mfma_f32_16x16x32_bf16 v[68:71], a[64:67], a[140:143], v[68:71]
  ds_write_b128 v122, v[56:59] offset:32768
  v_mfma_f32_16x16x32_bf16 v[72:75], a[64:67], v[236:239], v[72:75]
  ds_write_b128 v122, v[60:63] offset:50176
  v_mfma_f32_16x16x32_bf16 v[72:75], a[48:51], v[192:195], v[72:75]
  v_mfma_f32_16x16x32_bf16 v[76:79], a[48:51], v[212:215], v[76:79]
  v_mfma_f32_16x16x32_bf16 v[76:79], a[64:67], v[196:199], v[76:79]
  s_nop 1
  ds_write_b128 v122, v[68:71] offset:16384
  s_nop 2
  ds_write_b128 v122, v[72:75] offset:33792
  s_nop 0
  ds_write_b128 v122, v[76:79] offset:51200
  s_waitcnt vmcnt(4)
  v_lshlrev_b32 v136, 16, v138
  v_and_b32 v137, s34, v138
  v_lshlrev_b32 v138, 16, v139
  v_and_b32 v139, s34, v139
  v_pk_add_f32 v[0:1], v[0:1], v[136:137]
  v_pk_add_f32 v[2:3], v[2:3], v[138:139]
  s_waitcnt vmcnt(3)
  v_lshlrev_b32 v140, 16, v142
  v_and_b32 v141, s34, v142
  v_lshlrev_b32 v142, 16, v143
  v_and_b32 v143, s34, v143
  v_pk_add_f32 v[16:17], v[16:17], v[140:141]
  v_pk_add_f32 v[18:19], v[18:19], v[142:143]
  s_waitcnt vmcnt(2)
  v_lshlrev_b32 v144, 16, v146
  v_and_b32 v145, s34, v146
  v_lshlrev_b32 v146, 16, v147
  v_and_b32 v147, s34, v147
  v_pk_add_f32 v[32:33], v[32:33], v[144:145]
  v_pk_add_f32 v[34:35], v[34:35], v[146:147]
  s_waitcnt vmcnt(1)
  v_lshlrev_b32 v148, 16, v150
  v_and_b32 v149, s34, v150
  v_lshlrev_b32 v150, 16, v151
  v_and_b32 v151, s34, v151
  v_pk_add_f32 v[48:49], v[48:49], v[148:149]
  v_pk_add_f32 v[50:51], v[50:51], v[150:151]
  s_waitcnt vmcnt(0)
  v_lshlrev_b32 v152, 16, v154
  v_and_b32 v153, s34, v154
  v_lshlrev_b32 v154, 16, v155
  v_and_b32 v155, s34, v155
  v_pk_add_f32 v[64:65], v[64:65], v[152:153]
  v_pk_add_f32 v[66:67], v[66:67], v[154:155]
  s_waitcnt lgkmcnt(0)
  s_barrier
  ds_read_b128 v[4:7], v80 offset:0
  ds_read_b128 v[8:11], v81 offset:17408
  ds_read_b128 v[12:15], v82 offset:34816
  ds_read_b128 v[20:23], v80 offset:1024
  ds_read_b128 v[24:27], v81 offset:18432
  ds_read_b128 v[28:31], v82 offset:35840
  ds_read_b128 v[36:39], v80 offset:2048
  ds_read_b128 v[40:43], v81 offset:19456
  ds_read_b128 v[44:47], v82 offset:49152
  ds_read_b128 v[52:55], v80 offset:3072
  ds_read_b128 v[56:59], v81 offset:32768
  ds_read_b128 v[60:63], v82 offset:50176
  ds_read_b128 v[68:71], v80 offset:16384
  ds_read_b128 v[72:75], v81 offset:33792
  ds_read_b128 v[76:79], v82 offset:51200
  s_waitcnt lgkmcnt(13)
  v_pk_add_f32 v[4:5], v[4:5], v[8:9]
  v_pk_add_f32 v[6:7], v[6:7], v[10:11]
  s_waitcnt lgkmcnt(12)
  v_pk_add_f32 v[0:1], v[0:1], v[12:13]
  v_pk_add_f32 v[2:3], v[2:3], v[14:15]
  v_pk_add_f32 v[0:1], v[0:1], v[4:5]
  v_pk_add_f32 v[2:3], v[2:3], v[6:7]
  v_cvt_pk_bf16_f32 v4, v0, v1
  v_cvt_pk_bf16_f32 v5, v2, v3
  v_lshlrev_b32 v0, 16, v4
  v_and_b32 v1, s34, v4
  v_lshlrev_b32 v2, 16, v5
  v_and_b32 v3, s34, v5
  v_pk_mul_f32 v[0:1], v[0:1], v[90:91]
  v_pk_mul_f32 v[2:3], v[2:3], v[92:93]
  v_cvt_pk_bf16_f32 v4, v0, v1
  v_cvt_pk_bf16_f32 v5, v2, v3
  v_lshlrev_b32 v0, 16, v4
  v_and_b32 v1, s34, v4
  v_lshlrev_b32 v2, 16, v5
  v_and_b32 v3, s34, v5
  v_pk_add_f32 v[0:1], v[0:1], v[156:157]
  v_pk_add_f32 v[2:3], v[2:3], v[158:159]
  v_cvt_pk_bf16_f32 v4, v0, v1
  v_cvt_pk_bf16_f32 v5, v2, v3
  s_waitcnt lgkmcnt(10)
  v_pk_add_f32 v[20:21], v[20:21], v[24:25]
  v_pk_add_f32 v[22:23], v[22:23], v[26:27]
  s_waitcnt lgkmcnt(9)
  v_pk_add_f32 v[16:17], v[16:17], v[28:29]
  v_pk_add_f32 v[18:19], v[18:19], v[30:31]
  v_pk_add_f32 v[16:17], v[16:17], v[20:21]
  v_pk_add_f32 v[18:19], v[18:19], v[22:23]
  v_cvt_pk_bf16_f32 v20, v16, v17
  v_cvt_pk_bf16_f32 v21, v18, v19
  v_lshlrev_b32 v16, 16, v20
  v_and_b32 v17, s34, v20
  v_lshlrev_b32 v18, 16, v21
  v_and_b32 v19, s34, v21
  v_pk_mul_f32 v[16:17], v[16:17], v[94:95]
  v_pk_mul_f32 v[18:19], v[18:19], v[96:97]
  v_cvt_pk_bf16_f32 v20, v16, v17
  v_cvt_pk_bf16_f32 v21, v18, v19
  v_lshlrev_b32 v16, 16, v20
  v_and_b32 v17, s34, v20
  v_lshlrev_b32 v18, 16, v21
  v_and_b32 v19, s34, v21
  v_pk_add_f32 v[16:17], v[16:17], v[160:161]
  v_pk_add_f32 v[18:19], v[18:19], v[162:163]
  v_cvt_pk_bf16_f32 v6, v16, v17
  v_cvt_pk_bf16_f32 v7, v18, v19
  s_nop 0
  v_permlane16_swap_b32 v4, v6
  v_permlane16_swap_b32 v5, v7
  buffer_store_dwordx4 v[4:7], v83, s[16:19], 0 offen offset:0
  s_waitcnt lgkmcnt(7)
  v_pk_add_f32 v[36:37], v[36:37], v[40:41]
  v_pk_add_f32 v[38:39], v[38:39], v[42:43]
  s_waitcnt lgkmcnt(6)
  v_pk_add_f32 v[32:33], v[32:33], v[44:45]
  v_pk_add_f32 v[34:35], v[34:35], v[46:47]
  v_pk_add_f32 v[32:33], v[32:33], v[36:37]
  v_pk_add_f32 v[34:35], v[34:35], v[38:39]
  v_cvt_pk_bf16_f32 v36, v32, v33
  v_cvt_pk_bf16_f32 v37, v34, v35
  v_lshlrev_b32 v32, 16, v36
  v_and_b32 v33, s34, v36
  v_lshlrev_b32 v34, 16, v37
  v_and_b32 v35, s34, v37
  v_pk_mul_f32 v[32:33], v[32:33], v[98:99]
  v_pk_mul_f32 v[34:35], v[34:35], v[100:101]
  v_cvt_pk_bf16_f32 v36, v32, v33
  v_cvt_pk_bf16_f32 v37, v34, v35
  v_lshlrev_b32 v32, 16, v36
  v_and_b32 v33, s34, v36
  v_lshlrev_b32 v34, 16, v37
  v_and_b32 v35, s34, v37
  v_pk_add_f32 v[32:33], v[32:33], v[164:165]
  v_pk_add_f32 v[34:35], v[34:35], v[166:167]
  v_cvt_pk_bf16_f32 v36, v32, v33
  v_cvt_pk_bf16_f32 v37, v34, v35
  s_waitcnt lgkmcnt(4)
  v_pk_add_f32 v[52:53], v[52:53], v[56:57]
  v_pk_add_f32 v[54:55], v[54:55], v[58:59]
  s_waitcnt lgkmcnt(3)
  v_pk_add_f32 v[48:49], v[48:49], v[60:61]
  v_pk_add_f32 v[50:51], v[50:51], v[62:63]
  v_pk_add_f32 v[48:49], v[48:49], v[52:53]
  v_pk_add_f32 v[50:51], v[50:51], v[54:55]
  v_cvt_pk_bf16_f32 v52, v48, v49
  v_cvt_pk_bf16_f32 v53, v50, v51
  v_lshlrev_b32 v48, 16, v52
  v_and_b32 v49, s34, v52
  v_lshlrev_b32 v50, 16, v53
  v_and_b32 v51, s34, v53
  v_pk_mul_f32 v[48:49], v[48:49], v[102:103]
  v_pk_mul_f32 v[50:51], v[50:51], v[104:105]
  v_cvt_pk_bf16_f32 v52, v48, v49
  v_cvt_pk_bf16_f32 v53, v50, v51
  v_lshlrev_b32 v48, 16, v52
  v_and_b32 v49, s34, v52
  v_lshlrev_b32 v50, 16, v53
  v_and_b32 v51, s34, v53
  v_pk_add_f32 v[48:49], v[48:49], v[168:169]
  v_pk_add_f32 v[50:51], v[50:51], v[170:171]
  v_cvt_pk_bf16_f32 v38, v48, v49
  v_cvt_pk_bf16_f32 v39, v50, v51
  s_nop 0
  v_permlane16_swap_b32 v36, v38
  v_permlane16_swap_b32 v37, v39
  buffer_store_dwordx4 v[36:39], v83, s[16:19], 0 offen offset:64
  s_waitcnt lgkmcnt(1)
  v_pk_add_f32 v[68:69], v[68:69], v[72:73]
  v_pk_add_f32 v[70:71], v[70:71], v[74:75]
  s_waitcnt lgkmcnt(0)
  v_pk_add_f32 v[64:65], v[64:65], v[76:77]
  v_pk_add_f32 v[66:67], v[66:67], v[78:79]
  v_pk_add_f32 v[64:65], v[64:65], v[68:69]
  v_pk_add_f32 v[66:67], v[66:67], v[70:71]
  v_cvt_pk_bf16_f32 v68, v64, v65
  v_cvt_pk_bf16_f32 v69, v66, v67
  v_lshlrev_b32 v64, 16, v68
  v_and_b32 v65, s34, v68
  v_lshlrev_b32 v66, 16, v69
  v_and_b32 v67, s34, v69
  v_pk_mul_f32 v[64:65], v[64:65], v[106:107]
  v_pk_mul_f32 v[66:67], v[66:67], v[108:109]
  v_cvt_pk_bf16_f32 v68, v64, v65
  v_cvt_pk_bf16_f32 v69, v66, v67
  v_lshlrev_b32 v64, 16, v68
  v_and_b32 v65, s34, v68
  v_lshlrev_b32 v66, 16, v69
  v_and_b32 v67, s34, v69
  v_pk_add_f32 v[64:65], v[64:65], v[172:173]
  v_pk_add_f32 v[66:67], v[66:67], v[174:175]
  v_cvt_pk_bf16_f32 v68, v64, v65
  v_cvt_pk_bf16_f32 v69, v66, v67
  buffer_store_dwordx2 v[68:69], v117, s[16:19], 0 offen offset:128
attn_end:
  s_endpgm
attn_redo:
  s_waitcnt vmcnt(0)
  v_accvgpr_write_b32 a0, 0
  v_accvgpr_write_b32 a1, 0
  v_accvgpr_write_b32 a2, 0
  v_accvgpr_write_b32 a3, 0
  v_accvgpr_write_b32 a4, 0
  v_accvgpr_write_b32 a5, 0
  v_accvgpr_write_b32 a6, 0
  v_accvgpr_write_b32 a7, 0
  v_accvgpr_write_b32 a8, 0
  v_accvgpr_write_b32 a9, 0
  v_accvgpr_write_b32 a10, 0
  v_accvgpr_write_b32 a11, 0
  v_accvgpr_write_b32 a12, 0
  v_accvgpr_write_b32 a13, 0
  v_accvgpr_write_b32 a14, 0
  v_accvgpr_write_b32 a15, 0
  v_accvgpr_write_b32 a16, 0
  v_accvgpr_write_b32 a17, 0
  v_accvgpr_write_b32 a18, 0
  v_accvgpr_write_b32 a19, 0
  v_accvgpr_write_b32 a20, 0
  v_accvgpr_write_b32 a21, 0
  v_accvgpr_write_b32 a22, 0
  v_accvgpr_write_b32 a23, 0
  v_accvgpr_write_b32 a24, 0
  v_accvgpr_write_b32 a25, 0
  v_accvgpr_write_b32 a26, 0
  v_accvgpr_write_b32 a27, 0
  v_accvgpr_write_b32 a28, 0
  v_accvgpr_write_b32 a29, 0
  v_accvgpr_write_b32 a30, 0
  v_accvgpr_write_b32 a31, 0
  v_accvgpr_write_b32 a32, 0
  v_accvgpr_write_b32 a33, 0
  v_accvgpr_write_b32 a34, 0
  v_accvgpr_write_b32 a35, 0
  v_accvgpr_write_b32 a36, 0
  v_accvgpr_write_b32 a37, 0
  v_accvgpr_write_b32 a38, 0
  v_accvgpr_write_b32 a39, 0
  v_accvgpr_write_b32 a40, 0
  v_accvgpr_write_b32 a41, 0
  v_accvgpr_write_b32 a42, 0
  v_accvgpr_write_b32 a43, 0
  v_accvgpr_write_b32 a44, 0
  v_accvgpr_write_b32 a45, 0
  v_accvgpr_write_b32 a46, 0
  v_accvgpr_write_b32 a47, 0
  v_accvgpr_write_b32 a48, 0
  v_accvgpr_write_b32 a49, 0
  v_accvgpr_write_b32 a50, 0
  v_accvgpr_write_b32 a51, 0
  v_accvgpr_write_b32 a52, 0
  v_accvgpr_write_b32 a53, 0
  v_accvgpr_write_b32 a54, 0
  v_accvgpr_write_b32 a55, 0
  v_accvgpr_write_b32 a56, 0
  v_accvgpr_write_b32 a57, 0
  v_accvgpr_write_b32 a58, 0
  v_accvgpr_write_b32 a59, 0
  v_accvgpr_write_b32 a60, 0
  v_accvgpr_write_b32 a61, 0
  v_accvgpr_write_b32 a62, 0
  v_accvgpr_write_b32 a63, 0
  v_accvgpr_write_b32 a64, 0
  v_accvgpr_write_b32 a65, 0
  v_accvgpr_write_b32 a66, 0
  v_accvgpr_write_b32 a67, 0
  v_accvgpr_write_b32 a68, 0
  v_accvgpr_write_b32 a69, 0
  v_accvgpr_write_b32 a70, 0
  v_accvgpr_write_b32 a71, 0
  v_accvgpr_write_b32 a72, 0
  v_accvgpr_write_b32 a73, 0
  v_accvgpr_write_b32 a74, 0
  v_accvgpr_write_b32 a75, 0
  v_accvgpr_write_b32 a76, 0
  v_accvgpr_write_b32 a77, 0
  v_accvgpr_write_b32 a78, 0
  v_accvgpr_write_b32 a79, 0
  v_accvgpr_write_b32 a80, 0
  v_accvgpr_write_b32 a81, 0
  v_accvgpr_write_b32 a82, 0
  v_accvgpr_write_b32 a83, 0
  v_accvgpr_write_b32 a84, 0
  v_accvgpr_write_b32 a85, 0
  v_accvgpr_write_b32 a86, 0
  v_accvgpr_write_b32 a87, 0
  v_accvgpr_write_b32 a88, 0
  v_accvgpr_write_b32 a89, 0
  v_accvgpr_write_b32 a90, 0
  v_accvgpr_write_b32 a91, 0
  v_accvgpr_write_b32 a92, 0
  v_accvgpr_write_b32 a93, 0
  v_accvgpr_write_b32 a94, 0
  v_accvgpr_write_b32 a95, 0
  v_accvgpr_write_b32 a96, 0
  v_accvgpr_write_b32 a97, 0
  v_accvgpr_write_b32 a98, 0
  v_accvgpr_write_b32 a99, 0
  v_accvgpr_write_b32 a100, 0
  v_accvgpr_write_b32 a101, 0
  v_accvgpr_write_b32 a102, 0
  v_accvgpr_write_b32 a103, 0
  v_accvgpr_write_b32 a104, 0
  v_accvgpr_write_b32 a105, 0
  v_accvgpr_write_b32 a106, 0
  v_accvgpr_write_b32 a107, 0
  v_accvgpr_write_b32 a108, 0
  v_accvgpr_write_b32 a109, 0
  v_accvgpr_write_b32 a110, 0
  v_accvgpr_write_b32 a111, 0
  v_accvgpr_write_b32 a112, 0
  v_accvgpr_write_b32 a113, 0
  v_accvgpr_write_b32 a114, 0
  v_accvgpr_write_b32 a115, 0
  v_accvgpr_write_b32 a116, 0
  v_accvgpr_write_b32 a117, 0
  v_accvgpr_write_b32 a118, 0
  v_accvgpr_write_b32 a119, 0
  v_accvgpr_write_b32 a120, 0
  v_accvgpr_write_b32 a121, 0
  v_accvgpr_write_b32 a122, 0
  v_accvgpr_write_b32 a123, 0
  v_accvgpr_write_b32 a124, 0
  v_accvgpr_write_b32 a125, 0
  v_accvgpr_write_b32 a126, 0
  v_accvgpr_write_b32 a127, 0
  v_mov_b32 v208, 0
  v_mov_b32 v249, 0xff800000
  v_mov_b32 v209, 0
  v_mov_b32 v250, 0xff800000
  v_mov_b32 v210, 0
  v_mov_b32 v251, 0xff800000
  v_mov_b32 v211, 0
  v_mov_b32 v252, 0xff800000
  s_mov_b32 s29, 0
attn_slow:
  s_barrier
  s_add_u32 m0, s28, 49152
  s_nop 0
  buffer_load_dwordx4 v232, s[12:15], s29 offen offset:0 lds
  buffer_load_dwordx4 v233, s[12:15], s29 offen offset:1024 lds
  buffer_load_dwordx4 v234, s[12:15], s29 offen offset:2048 lds
  buffer_load_dwordx4 v235, s[12:15], s29 offen offset:3072 lds
  s_add_u32 m0, s28, 114688
  s_nop 0
  buffer_load_dwordx4 v236, s[16:19], s29 offen offset:0 lds
  buffer_load_dwordx4 v237, s[16:19], s29 offen offset:1024 lds
  buffer_load_dwordx4 v236, s[16:19], s29 offen offset:2048 lds
  buffer_load_dwordx4 v237, s[16:19], s29 offen offset:3072 lds
  s_waitcnt vmcnt(0)
  s_barrier
  ds_read_b128 a[128:131], v212 offset:49152
  ds_read_b128 a[132:135], v213 offset:49152
  ds_read_b128 a[136:139], v214 offset:49152
  ds_read_b128 a[140:143], v215 offset:49152
  s_waitcnt lgkmcnt(3)
  v_mfma_f32_16x16x32_bf16 v[0:3], a[128:131], v[128:131], 0
  s_waitcnt lgkmcnt(2)
  v_mfma_f32_16x16x32_bf16 v[0:3], a[132:135], v[132:135], v[0:3]
  s_waitcnt lgkmcnt(1)
  v_mfma_f32_16x16x32_bf16 v[0:3], a[136:139], v[136:139], v[0:3]
  s_waitcnt lgkmcnt(0)
  v_mfma_f32_16x16x32_bf16 v[0:3], a[140:143], v[140:143], v[0:3]
  v_mfma_f32_16x16x32_bf16 v[8:11], a[140:143], v[156:159], 0
  v_mfma_f32_16x16x32_bf16 v[8:11], a[136:139], v[152:155], v[8:11]
  v_mfma_f32_16x16x32_bf16 v[8:11], a[132:135], v[148:151], v[8:11]
  v_mfma_f32_16x16x32_bf16 v[8:11], a[128:131], v[144:147], v[8:11]
  v_mfma_f32_16x16x32_bf16 v[16:19], a[128:131], v[160:163], 0
  v_mfma_f32_16x16x32_bf16 v[16:19], a[132:135], v[164:167], v[16:19]
  v_mfma_f32_16x16x32_bf16 v[16:19], a[136:139], v[168:171], v[16:19]
  v_mfma_f32_16x16x32_bf16 v[16:19], a[140:143], v[172:175], v[16:19]
  v_mfma_f32_16x16x32_bf16 v[24:27], a[140:143], v[188:191], 0
  v_mfma_f32_16x16x32_bf16 v[24:27], a[136:139], v[184:187], v[24:27]
  v_mfma_f32_16x16x32_bf16 v[24:27], a[132:135], v[180:183], v[24:27]
  v_mfma_f32_16x16x32_bf16 v[24:27], a[128:131], v[176:179], v[24:27]
  ds_read_b128 a[144:147], v212 offset:53248
  ds_read_b128 a[148:151], v213 offset:53248
  ds_read_b128 a[152:155], v214 offset:53248
  ds_read_b128 a[156:159], v215 offset:53248
  s_waitcnt lgkmcnt(3)
  v_mfma_f32_16x16x32_bf16 v[4:7], a[144:147], v[128:131], 0
  s_waitcnt lgkmcnt(2)
  v_mfma_f32_16x16x32_bf16 v[4:7], a[148:151], v[132:135], v[4:7]
  s_waitcnt lgkmcnt(1)
  v_mfma_f32_16x16x32_bf16 v[4:7], a[152:155], v[136:139], v[4:7]
  s_waitcnt lgkmcnt(0)
  v_mfma_f32_16x16x32_bf16 v[4:7], a[156:159], v[140:143], v[4:7]
  v_mfma_f32_16x16x32_bf16 v[12:15], a[156:159], v[156:159], 0
  v_mfma_f32_16x16x32_bf16 v[12:15], a[152:155], v[152:155], v[12:15]
  v_mfma_f32_16x16x32_bf16 v[12:15], a[148:151], v[148:151], v[12:15]
  v_mfma_f32_16x16x32_bf16 v[12:15], a[144:147], v[144:147], v[12:15]
  v_mfma_f32_16x16x32_bf16 v[20:23], a[144:147], v[160:163], 0
  v_mfma_f32_16x16x32_bf16 v[20:23], a[148:151], v[164:167], v[20:23]
  v_mfma_f32_16x16x32_bf16 v[20:23], a[152:155], v[168:171], v[20:23]
  v_mfma_f32_16x16x32_bf16 v[20:23], a[156:159], v[172:175], v[20:23]
  v_mfma_f32_16x16x32_bf16 v[28:31], a[156:159], v[188:191], 0
  v_mfma_f32_16x16x32_bf16 v[28:31], a[152:155], v[184:187], v[28:31]
  v_mfma_f32_16x16x32_bf16 v[28:31], a[148:151], v[180:183], v[28:31]
  v_mfma_f32_16x16x32_bf16 v[28:31], a[144:147], v[176:179], v[28:31]
  ds_read_b128 a[128:131], v212 offset:57344
  ds_read_b128 a[132:135], v213 offset:57344
  ds_read_b128 a[136:139], v214 offset:57344
  ds_read_b128 a[140:143], v215 offset:57344
  s_waitcnt lgkmcnt(3)
  v_mfma_f32_16x16x32_bf16 v[32:35], a[128:131], v[128:131], 0
  s_waitcnt lgkmcnt(2)
  v_mfma_f32_16x16x32_bf16 v[32:35], a[132:135], v[132:135], v[32:35]
  s_waitcnt lgkmcnt(1)
  v_mfma_f32_16x16x32_bf16 v[32:35], a[136:139], v[136:139], v[32:35]
  s_waitcnt lgkmcnt(0)
  v_mfma_f32_16x16x32_bf16 v[32:35], a[140:143], v[140:143], v[32:35]
  v_mfma_f32_16x16x32_bf16 v[40:43], a[140:143], v[156:159], 0
  v_mfma_f32_16x16x32_bf16 v[40:43], a[136:139], v[152:155], v[40:43]
  v_mfma_f32_16x16x32_bf16 v[40:43], a[132:135], v[148:151], v[40:43]
  v_mfma_f32_16x16x32_bf16 v[40:43], a[128:131], v[144:147], v[40:43]
  v_mfma_f32_16x16x32_bf16 v[48:51], a[128:131], v[160:163], 0
  v_mfma_f32_16x16x32_bf16 v[48:51], a[132:135], v[164:167], v[48:51]
  v_mfma_f32_16x16x32_bf16 v[48:51], a[136:139], v[168:171], v[48:51]
  v_mfma_f32_16x16x32_bf16 v[48:51], a[140:143], v[172:175], v[48:51]
  v_mfma_f32_16x16x32_bf16 v[56:59], a[140:143], v[188:191], 0
  v_mfma_f32_16x16x32_bf16 v[56:59], a[136:139], v[184:187], v[56:59]
  v_mfma_f32_16x16x32_bf16 v[56:59], a[132:135], v[180:183], v[56:59]
  v_mfma_f32_16x16x32_bf16 v[56:59], a[128:131], v[176:179], v[56:59]
  ds_read_b128 a[144:147], v212 offset:61440
  ds_read_b128 a[148:151], v213 offset:61440
  ds_read_b128 a[152:155], v214 offset:61440
  ds_read_b128 a[156:159], v215 offset:61440
  s_waitcnt lgkmcnt(3)
  v_mfma_f32_16x16x32_bf16 v[36:39], a[144:147], v[128:131], 0
  s_waitcnt lgkmcnt(2)
  v_mfma_f32_16x16x32_bf16 v[36:39], a[148:151], v[132:135], v[36:39]
  s_waitcnt lgkmcnt(1)
  v_mfma_f32_16x16x32_bf16 v[36:39], a[152:155], v[136:139], v[36:39]
  s_waitcnt lgkmcnt(0)
  v_mfma_f32_16x16x32_bf16 v[36:39], a[156:159], v[140:143], v[36:39]
  v_mfma_f32_16x16x32_bf16 v[44:47], a[156:159], v[156:159], 0
  v_mfma_f32_16x16x32_bf16 v[44:47], a[152:155], v[152:155], v[44:47]
  v_mfma_f32_16x16x32_bf16 v[44:47], a[148:151], v[148:151], v[44:47]
  v_mfma_f32_16x16x32_bf16 v[44:47], a[144:147], v[144:147], v[44:47]
  v_mfma_f32_16x16x32_bf16 v[52:55], a[144:147], v[160:163], 0
  v_mfma_f32_16x16x32_bf16 v[52:55], a[148:151], v[164:167], v[52:55]
  v_mfma_f32_16x16x32_bf16 v[52:55], a[152:155], v[168:171], v[52:55]
  v_mfma_f32_16x16x32_bf16 v[52:55], a[156:159], v[172:175], v[52:55]
  v_mfma_f32_16x16x32_bf16 v[60:63], a[156:159], v[188:191], 0
  v_mfma_f32_16x16x32_bf16 v[60:63], a[152:155], v[184:187], v[60:63]
  v_mfma_f32_16x16x32_bf16 v[60:63], a[148:151], v[180:183], v[60:63]
  v_mfma_f32_16x16x32_bf16 v[60:63], a[144:147], v[176:179], v[60:63]
  v_mov_b32 v192, v249
  v_max3_f32 v192, v192, v0, v1
  v_max3_f32 v192, v192, v2, v3
  v_max3_f32 v192, v192, v4, v5
  v_max3_f32 v192, v192, v6, v7
  v_max3_f32 v192, v192, v32, v33
  v_max3_f32 v192, v192, v34, v35
  v_max3_f32 v192, v192, v36, v37
  v_max3_f32 v192, v192, v38, v39
  v_mov_b32 v245, v192
  s_nop 1
  v_permlane16_swap_b32 v192, v245
  v_max_f32 v192, v192, v245
  v_mov_b32 v245, v192
  s_nop 1
  v_permlane32_swap_b32 v192, v245
  v_max_f32 v192, v192, v245
  v_sub_f32 v193, v249, v192
  v_exp_f32 v193, v193
  v_mov_b32 v249, v192
  v_mul_f32 v208, v208, v193
  v_sub_f32 v0, v0, v192
  v_sub_f32 v1, v1, v192
  v_sub_f32 v2, v2, v192
  v_sub_f32 v3, v3, v192
  v_sub_f32 v4, v4, v192
  v_sub_f32 v5, v5, v192
  v_sub_f32 v6, v6, v192
  v_sub_f32 v7, v7, v192
  v_sub_f32 v32, v32, v192
  v_sub_f32 v33, v33, v192
  v_sub_f32 v34, v34, v192
  v_sub_f32 v35, v35, v192
  v_sub_f32 v36, v36, v192
  v_sub_f32 v37, v37, v192
  v_sub_f32 v38, v38, v192
  v_sub_f32 v39, v39, v192
  v_exp_f32 v0, v0
  v_exp_f32 v1, v1
  v_add_f32 v208, v208, v0
  v_exp_f32 v2, v2
  v_add_f32 v208, v208, v1
  v_cvt_pk_bf16_f32 v0, v0, v1
  v_exp_f32 v3, v3
  v_add_f32 v208, v208, v2
  v_add_f32 v208, v208, v3
  v_cvt_pk_bf16_f32 v1, v2, v3
  v_exp_f32 v4, v4
  v_exp_f32 v5, v5
  v_add_f32 v208, v208, v4
  v_exp_f32 v6, v6
  v_add_f32 v208, v208, v5
  v_cvt_pk_bf16_f32 v2, v4, v5
  v_exp_f32 v7, v7
  v_add_f32 v208, v208, v6
  v_add_f32 v208, v208, v7
  v_cvt_pk_bf16_f32 v3, v6, v7
  v_exp_f32 v32, v32
  v_exp_f32 v33, v33
  v_add_f32 v208, v208, v32
  v_exp_f32 v34, v34
  v_add_f32 v208, v208, v33
  v_cvt_pk_bf16_f32 v32, v32, v33
  v_exp_f32 v35, v35
  v_add_f32 v208, v208, v34
  v_add_f32 v208, v208, v35
  v_cvt_pk_bf16_f32 v33, v34, v35
  v_exp_f32 v36, v36
  v_exp_f32 v37, v37
  v_add_f32 v208, v208, v36
  v_exp_f32 v38, v38
  v_add_f32 v208, v208, v37
  v_cvt_pk_bf16_f32 v34, v36, v37
  v_exp_f32 v39, v39
  v_add_f32 v208, v208, v38
  v_add_f32 v208, v208, v39
  v_cvt_pk_bf16_f32 v35, v38, v39
  v_accvgpr_read_b32 v64, a0
  v_accvgpr_read_b32 v65, a1
  v_accvgpr_read_b32 v66, a2
  v_accvgpr_read_b32 v67, a3
  v_mul_f32 v64, v64, v193
  v_mul_f32 v65, v65, v193
  v_mul_f32 v66, v66, v193
  v_mul_f32 v67, v67, v193
  v_accvgpr_write_b32 a0, v64
  v_accvgpr_write_b32 a1, v65
  v_accvgpr_write_b32 a2, v66
  v_accvgpr_write_b32 a3, v67
  v_accvgpr_read_b32 v64, a16
  v_accvgpr_read_b32 v65, a17
  v_accvgpr_read_b32 v66, a18
  v_accvgpr_read_b32 v67, a19
  v_mul_f32 v64, v64, v193
  v_mul_f32 v65, v65, v193
  v_mul_f32 v66, v66, v193
  v_mul_f32 v67, v67, v193
  v_accvgpr_write_b32 a16, v64
  v_accvgpr_write_b32 a17, v65
  v_accvgpr_write_b32 a18, v66
  v_accvgpr_write_b32 a19, v67
  v_accvgpr_read_b32 v64, a32
  v_accvgpr_read_b32 v65, a33
  v_accvgpr_read_b32 v66, a34
  v_accvgpr_read_b32 v67, a35
  v_mul_f32 v64, v64, v193
  v_mul_f32 v65, v65, v193
  v_mul_f32 v66, v66, v193
  v_mul_f32 v67, v67, v193
  v_accvgpr_write_b32 a32, v64
  v_accvgpr_write_b32 a33, v65
  v_accvgpr_write_b32 a34, v66
  v_accvgpr_write_b32 a35, v67
  v_accvgpr_read_b32 v64, a48
  v_accvgpr_read_b32 v65, a49
  v_accvgpr_read_b32 v66, a50
  v_accvgpr_read_b32 v67, a51
  v_mul_f32 v64, v64, v193
  v_mul_f32 v65, v65, v193
  v_mul_f32 v66, v66, v193
  v_mul_f32 v67, v67, v193
  v_accvgpr_write_b32 a48, v64
  v_accvgpr_write_b32 a49, v65
  v_accvgpr_write_b32 a50, v66
  v_accvgpr_write_b32 a51, v67
  v_accvgpr_read_b32 v64, a64
  v_accvgpr_read_b32 v65, a65
  v_accvgpr_read_b32 v66, a66
  v_accvgpr_read_b32 v67, a67
  v_mul_f32 v64, v64, v193
  v_mul_f32 v65, v65, v193
  v_mul_f32 v66, v66, v193
  v_mul_f32 v67, v67, v193
  v_accvgpr_write_b32 a64, v64
  v_accvgpr_write_b32 a65, v65
  v_accvgpr_write_b32 a66, v66
  v_accvgpr_write_b32 a67, v67
  v_accvgpr_read_b32 v64, a80
  v_accvgpr_read_b32 v65, a81
  v_accvgpr_read_b32 v66, a82
  v_accvgpr_read_b32 v67, a83
  v_mul_f32 v64, v64, v193
  v_mul_f32 v65, v65, v193
  v_mul_f32 v66, v66, v193
  v_mul_f32 v67, v67, v193
  v_accvgpr_write_b32 a80, v64
  v_accvgpr_write_b32 a81, v65
  v_accvgpr_write_b32 a82, v66
  v_accvgpr_write_b32 a83, v67
  v_accvgpr_read_b32 v64, a96
  v_accvgpr_read_b32 v65, a97
  v_accvgpr_read_b32 v66, a98
  v_accvgpr_read_b32 v67, a99
  v_mul_f32 v64, v64, v193
  v_mul_f32 v65, v65, v193
  v_mul_f32 v66, v66, v193
  v_mul_f32 v67, v67, v193
  v_accvgpr_write_b32 a96, v64
  v_accvgpr_write_b32 a97, v65
  v_accvgpr_write_b32 a98, v66
  v_accvgpr_write_b32 a99, v67
  v_accvgpr_read_b32 v64, a112
  v_accvgpr_read_b32 v65, a113
  v_accvgpr_read_b32 v66, a114
  v_accvgpr_read_b32 v67, a115
  v_mul_f32 v64, v64, v193
  v_mul_f32 v65, v65, v193
  v_mul_f32 v66, v66, v193
  v_mul_f32 v67, v67, v193
  v_accvgpr_write_b32 a112, v64
  v_accvgpr_write_b32 a113, v65
  v_accvgpr_write_b32 a114, v66
  v_accvgpr_write_b32 a115, v67
  v_mov_b32 v196, v250
  v_max3_f32 v196, v196, v8, v9
  v_max3_f32 v196, v196, v10, v11
  v_max3_f32 v196, v196, v12, v13
  v_max3_f32 v196, v196, v14, v15
  v_max3_f32 v196, v196, v40, v41
  v_max3_f32 v196, v196, v42, v43
  v_max3_f32 v196, v196, v44, v45
  v_max3_f32 v196, v196, v46, v47
  v_mov_b32 v245, v196
  s_nop 1
  v_permlane16_swap_b32 v196, v245
  v_max_f32 v196, v196, v245
  v_mov_b32 v245, v196
  s_nop 1
  v_permlane32_swap_b32 v196, v245
  v_max_f32 v196, v196, v245
  v_sub_f32 v197, v250, v196
  v_exp_f32 v197, v197
  v_mov_b32 v250, v196
  v_mul_f32 v209, v209, v197
  v_sub_f32 v8, v8, v196
  v_sub_f32 v9, v9, v196
  v_sub_f32 v10, v10, v196
  v_sub_f32 v11, v11, v196
  v_sub_f32 v12, v12, v196
  v_sub_f32 v13, v13, v196
  v_sub_f32 v14, v14, v196
  v_sub_f32 v15, v15, v196
  v_sub_f32 v40, v40, v196
  v_sub_f32 v41, v41, v196
  v_sub_f32 v42, v42, v196
  v_sub_f32 v43, v43, v196
  v_sub_f32 v44, v44, v196
  v_sub_f32 v45, v45, v196
  v_sub_f32 v46, v46, v196
  v_sub_f32 v47, v47, v196
  v_exp_f32 v8, v8
  v_exp_f32 v9, v9
  v_add_f32 v209, v209, v8
  v_exp_f32 v10, v10
  v_add_f32 v209, v209, v9
  v_cvt_pk_bf16_f32 v8, v8, v9
  v_exp_f32 v11, v11
  v_add_f32 v209, v209, v10
  v_add_f32 v209, v209, v11
  v_cvt_pk_bf16_f32 v9, v10, v11
  v_exp_f32 v12, v12
  v_exp_f32 v13, v13
  v_add_f32 v209, v209, v12
  v_exp_f32 v14, v14
  v_add_f32 v209, v209, v13
  v_cvt_pk_bf16_f32 v10, v12, v13
  v_exp_f32 v15, v15
  v_add_f32 v209, v209, v14
  v_add_f32 v209, v209, v15
  v_cvt_pk_bf16_f32 v11, v14, v15
  v_exp_f32 v40, v40
  v_exp_f32 v41, v41
  v_add_f32 v209, v209, v40
  v_exp_f32 v42, v42
  v_add_f32 v209, v209, v41
  v_cvt_pk_bf16_f32 v40, v40, v41
  v_exp_f32 v43, v43
  v_add_f32 v209, v209, v42
  v_add_f32 v209, v209, v43
  v_cvt_pk_bf16_f32 v41, v42, v43
  v_exp_f32 v44, v44
  v_exp_f32 v45, v45
  v_add_f32 v209, v209, v44
  v_exp_f32 v46, v46
  v_add_f32 v209, v209, v45
  v_cvt_pk_bf16_f32 v42, v44, v45
  v_exp_f32 v47, v47
  v_add_f32 v209, v209, v46
  v_add_f32 v209, v209, v47
  v_cvt_pk_bf16_f32 v43, v46, v47
  v_accvgpr_read_b32 v64, a4
  v_accvgpr_read_b32 v65, a5
  v_accvgpr_read_b32 v66, a6
  v_accvgpr_read_b32 v67, a7
  v_mul_f32 v64, v64, v197
  v_mul_f32 v65, v65, v197
  v_mul_f32 v66, v66, v197
  v_mul_f32 v67, v67, v197
  v_accvgpr_write_b32 a4, v64
  v_accvgpr_write_b32 a5, v65
  v_accvgpr_write_b32 a6, v66
  v_accvgpr_write_b32 a7, v67
  v_accvgpr_read_b32 v64, a20
  v_accvgpr_read_b32 v65, a21
  v_accvgpr_read_b32 v66, a22
  v_accvgpr_read_b32 v67, a23
  v_mul_f32 v64, v64, v197
  v_mul_f32 v65, v65, v197
  v_mul_f32 v66, v66, v197
  v_mul_f32 v67, v67, v197
  v_accvgpr_write_b32 a20, v64
  v_accvgpr_write_b32 a21, v65
  v_accvgpr_write_b32 a22, v66
  v_accvgpr_write_b32 a23, v67
  v_accvgpr_read_b32 v64, a36
  v_accvgpr_read_b32 v65, a37
  v_accvgpr_read_b32 v66, a38
  v_accvgpr_read_b32 v67, a39
  v_mul_f32 v64, v64, v197
  v_mul_f32 v65, v65, v197
  v_mul_f32 v66, v66, v197
  v_mul_f32 v67, v67, v197
  v_accvgpr_write_b32 a36, v64
  v_accvgpr_write_b32 a37, v65
  v_accvgpr_write_b32 a38, v66
  v_accvgpr_write_b32 a39, v67
  v_accvgpr_read_b32 v64, a52
  v_accvgpr_read_b32 v65, a53
  v_accvgpr_read_b32 v66, a54
  v_accvgpr_read_b32 v67, a55
  v_mul_f32 v64, v64, v197
  v_mul_f32 v65, v65, v197
  v_mul_f32 v66, v66, v197
  v_mul_f32 v67, v67, v197
  v_accvgpr_write_b32 a52, v64
  v_accvgpr_write_b32 a53, v65
  v_accvgpr_write_b32 a54, v66
  v_accvgpr_write_b32 a55, v67
  v_accvgpr_read_b32 v64, a68
  v_accvgpr_read_b32 v65, a69
  v_accvgpr_read_b32 v66, a70
  v_accvgpr_read_b32 v67, a71
  v_mul_f32 v64, v64, v197
  v_mul_f32 v65, v65, v197
  v_mul_f32 v66, v66, v197
  v_mul_f32 v67, v67, v197
  v_accvgpr_write_b32 a68, v64
  v_accvgpr_write_b32 a69, v65
  v_accvgpr_write_b32 a70, v66
  v_accvgpr_write_b32 a71, v67
  v_accvgpr_read_b32 v64, a84
  v_accvgpr_read_b32 v65, a85
  v_accvgpr_read_b32 v66, a86
  v_accvgpr_read_b32 v67, a87
  v_mul_f32 v64, v64, v197
  v_mul_f32 v65, v65, v197
  v_mul_f32 v66, v66, v197
  v_mul_f32 v67, v67, v197
  v_accvgpr_write_b32 a84, v64
  v_accvgpr_write_b32 a85, v65
  v_accvgpr_write_b32 a86, v66
  v_accvgpr_write_b32 a87, v67
  v_accvgpr_read_b32 v64, a100
  v_accvgpr_read_b32 v65, a101
  v_accvgpr_read_b32 v66, a102
  v_accvgpr_read_b32 v67, a103
  v_mul_f32 v64, v64, v197
  v_mul_f32 v65, v65, v197
  v_mul_f32 v66, v66, v197
  v_mul_f32 v67, v67, v197
  v_accvgpr_write_b32 a100, v64
  v_accvgpr_write_b32 a101, v65
  v_accvgpr_write_b32 a102, v66
  v_accvgpr_write_b32 a103, v67
  v_accvgpr_read_b32 v64, a116
  v_accvgpr_read_b32 v65, a117
  v_accvgpr_read_b32 v66, a118
  v_accvgpr_read_b32 v67, a119
  v_mul_f32 v64, v64, v197
  v_mul_f32 v65, v65, v197
  v_mul_f32 v66, v66, v197
  v_mul_f32 v67, v67, v197
  v_accvgpr_write_b32 a116, v64
  v_accvgpr_write_b32 a117, v65
  v_accvgpr_write_b32 a118, v66
  v_accvgpr_write_b32 a119, v67
  v_mov_b32 v200, v251
  v_max3_f32 v200, v200, v16, v17
  v_max3_f32 v200, v200, v18, v19
  v_max3_f32 v200, v200, v20, v21
  v_max3_f32 v200, v200, v22, v23
  v_max3_f32 v200, v200, v48, v49
  v_max3_f32 v200, v200, v50, v51
  v_max3_f32 v200, v200, v52, v53
  v_max3_f32 v200, v200, v54, v55
  v_mov_b32 v245, v200
  s_nop 1
  v_permlane16_swap_b32 v200, v245
  v_max_f32 v200, v200, v245
  v_mov_b32 v245, v200
  s_nop 1
  v_permlane32_swap_b32 v200, v245
  v_max_f32 v200, v200, v245
  v_sub_f32 v201, v251, v200
  v_exp_f32 v201, v201
  v_mov_b32 v251, v200
  v_mul_f32 v210, v210, v201
  v_sub_f32 v16, v16, v200
  v_sub_f32 v17, v17, v200
  v_sub_f32 v18, v18, v200
  v_sub_f32 v19, v19, v200
  v_sub_f32 v20, v20, v200
  v_sub_f32 v21, v21, v200
  v_sub_f32 v22, v22, v200
  v_sub_f32 v23, v23, v200
  v_sub_f32 v48, v48, v200
  v_sub_f32 v49, v49, v200
  v_sub_f32 v50, v50, v200
  v_sub_f32 v51, v51, v200
  v_sub_f32 v52, v52, v200
  v_sub_f32 v53, v53, v200
  v_sub_f32 v54, v54, v200
  v_sub_f32 v55, v55, v200
  v_exp_f32 v16, v16
  v_exp_f32 v17, v17
  v_add_f32 v210, v210, v16
  v_exp_f32 v18, v18
  v_add_f32 v210, v210, v17
  v_cvt_pk_bf16_f32 v16, v16, v17
  v_exp_f32 v19, v19
  v_add_f32 v210, v210, v18
  v_add_f32 v210, v210, v19
  v_cvt_pk_bf16_f32 v17, v18, v19
  v_exp_f32 v20, v20
  v_exp_f32 v21, v21
  v_add_f32 v210, v210, v20
  v_exp_f32 v22, v22
  v_add_f32 v210, v210, v21
  v_cvt_pk_bf16_f32 v18, v20, v21
  v_exp_f32 v23, v23
  v_add_f32 v210, v210, v22
  v_add_f32 v210, v210, v23
  v_cvt_pk_bf16_f32 v19, v22, v23
  v_exp_f32 v48, v48
  v_exp_f32 v49, v49
  v_add_f32 v210, v210, v48
  v_exp_f32 v50, v50
  v_add_f32 v210, v210, v49
  v_cvt_pk_bf16_f32 v48, v48, v49
  v_exp_f32 v51, v51
  v_add_f32 v210, v210, v50
  v_add_f32 v210, v210, v51
  v_cvt_pk_bf16_f32 v49, v50, v51
  v_exp_f32 v52, v52
  v_exp_f32 v53, v53
  v_add_f32 v210, v210, v52
  v_exp_f32 v54, v54
  v_add_f32 v210, v210, v53
  v_cvt_pk_bf16_f32 v50, v52, v53
  v_exp_f32 v55, v55
  v_add_f32 v210, v210, v54
  v_add_f32 v210, v210, v55
  v_cvt_pk_bf16_f32 v51, v54, v55
  v_accvgpr_read_b32 v64, a8
  v_accvgpr_read_b32 v65, a9
  v_accvgpr_read_b32 v66, a10
  v_accvgpr_read_b32 v67, a11
  v_mul_f32 v64, v64, v201
  v_mul_f32 v65, v65, v201
  v_mul_f32 v66, v66, v201
  v_mul_f32 v67, v67, v201
  v_accvgpr_write_b32 a8, v64
  v_accvgpr_write_b32 a9, v65
  v_accvgpr_write_b32 a10, v66
  v_accvgpr_write_b32 a11, v67
  v_accvgpr_read_b32 v64, a24
  v_accvgpr_read_b32 v65, a25
  v_accvgpr_read_b32 v66, a26
  v_accvgpr_read_b32 v67, a27
  v_mul_f32 v64, v64, v201
  v_mul_f32 v65, v65, v201
  v_mul_f32 v66, v66, v201
  v_mul_f32 v67, v67, v201
  v_accvgpr_write_b32 a24, v64
  v_accvgpr_write_b32 a25, v65
  v_accvgpr_write_b32 a26, v66
  v_accvgpr_write_b32 a27, v67
  v_accvgpr_read_b32 v64, a40
  v_accvgpr_read_b32 v65, a41
  v_accvgpr_read_b32 v66, a42
  v_accvgpr_read_b32 v67, a43
  v_mul_f32 v64, v64, v201
  v_mul_f32 v65, v65, v201
  v_mul_f32 v66, v66, v201
  v_mul_f32 v67, v67, v201
  v_accvgpr_write_b32 a40, v64
  v_accvgpr_write_b32 a41, v65
  v_accvgpr_write_b32 a42, v66
  v_accvgpr_write_b32 a43, v67
  v_accvgpr_read_b32 v64, a56
  v_accvgpr_read_b32 v65, a57
  v_accvgpr_read_b32 v66, a58
  v_accvgpr_read_b32 v67, a59
  v_mul_f32 v64, v64, v201
  v_mul_f32 v65, v65, v201
  v_mul_f32 v66, v66, v201
  v_mul_f32 v67, v67, v201
  v_accvgpr_write_b32 a56, v64
  v_accvgpr_write_b32 a57, v65
  v_accvgpr_write_b32 a58, v66
  v_accvgpr_write_b32 a59, v67
  v_accvgpr_read_b32 v64, a72
  v_accvgpr_read_b32 v65, a73
  v_accvgpr_read_b32 v66, a74
  v_accvgpr_read_b32 v67, a75
  v_mul_f32 v64, v64, v201
  v_mul_f32 v65, v65, v201
  v_mul_f32 v66, v66, v201
  v_mul_f32 v67, v67, v201
  v_accvgpr_write_b32 a72, v64
  v_accvgpr_write_b32 a73, v65
  v_accvgpr_write_b32 a74, v66
  v_accvgpr_write_b32 a75, v67
  v_accvgpr_read_b32 v64, a88
  v_accvgpr_read_b32 v65, a89
  v_accvgpr_read_b32 v66, a90
  v_accvgpr_read_b32 v67, a91
  v_mul_f32 v64, v64, v201
  v_mul_f32 v65, v65, v201
  v_mul_f32 v66, v66, v201
  v_mul_f32 v67, v67, v201
  v_accvgpr_write_b32 a88, v64
  v_accvgpr_write_b32 a89, v65
  v_accvgpr_write_b32 a90, v66
  v_accvgpr_write_b32 a91, v67
  v_accvgpr_read_b32 v64, a104
  v_accvgpr_read_b32 v65, a105
  v_accvgpr_read_b32 v66, a106
  v_accvgpr_read_b32 v67, a107
  v_mul_f32 v64, v64, v201
  v_mul_f32 v65, v65, v201
  v_mul_f32 v66, v66, v201
  v_mul_f32 v67, v67, v201
  v_accvgpr_write_b32 a104, v64
  v_accvgpr_write_b32 a105, v65
  v_accvgpr_write_b32 a106, v66
  v_accvgpr_write_b32 a107, v67
  v_accvgpr_read_b32 v64, a120
  v_accvgpr_read_b32 v65, a121
  v_accvgpr_read_b32 v66, a122
  v_accvgpr_read_b32 v67, a123
  v_mul_f32 v64, v64, v201
  v_mul_f32 v65, v65, v201
  v_mul_f32 v66, v66, v201
  v_mul_f32 v67, v67, v201
  v_accvgpr_write_b32 a120, v64
  v_accvgpr_write_b32 a121, v65
  v_accvgpr_write_b32 a122, v66
  v_accvgpr_write_b32 a123, v67
  v_mov_b32 v204, v252
  v_max3_f32 v204, v204, v24, v25
  v_max3_f32 v204, v204, v26, v27
  v_max3_f32 v204, v204, v28, v29
  v_max3_f32 v204, v204, v30, v31
  v_max3_f32 v204, v204, v56, v57
  v_max3_f32 v204, v204, v58, v59
  v_max3_f32 v204, v204, v60, v61
  v_max3_f32 v204, v204, v62, v63
  v_mov_b32 v245, v204
  s_nop 1
  v_permlane16_swap_b32 v204, v245
  v_max_f32 v204, v204, v245
  v_mov_b32 v245, v204
  s_nop 1
  v_permlane32_swap_b32 v204, v245
  v_max_f32 v204, v204, v245
  v_sub_f32 v205, v252, v204
  v_exp_f32 v205, v205
  v_mov_b32 v252, v204
  v_mul_f32 v211, v211, v205
  v_sub_f32 v24, v24, v204
  v_sub_f32 v25, v25, v204
  v_sub_f32 v26, v26, v204
  v_sub_f32 v27, v27, v204
  v_sub_f32 v28, v28, v204
  v_sub_f32 v29, v29, v204
  v_sub_f32 v30, v30, v204
  v_sub_f32 v31, v31, v204
  v_sub_f32 v56, v56, v204
  v_sub_f32 v57, v57, v204
  v_sub_f32 v58, v58, v204
  v_sub_f32 v59, v59, v204
  v_sub_f32 v60, v60, v204
  v_sub_f32 v61, v61, v204
  v_sub_f32 v62, v62, v204
  v_sub_f32 v63, v63, v204
  v_exp_f32 v24, v24
  v_exp_f32 v25, v25
  v_add_f32 v211, v211, v24
  v_exp_f32 v26, v26
  v_add_f32 v211, v211, v25
  v_cvt_pk_bf16_f32 v24, v24, v25
  v_exp_f32 v27, v27
  v_add_f32 v211, v211, v26
  v_add_f32 v211, v211, v27
  v_cvt_pk_bf16_f32 v25, v26, v27
  v_exp_f32 v28, v28
  v_exp_f32 v29, v29
  v_add_f32 v211, v211, v28
  v_exp_f32 v30, v30
  v_add_f32 v211, v211, v29
  v_cvt_pk_bf16_f32 v26, v28, v29
  v_exp_f32 v31, v31
  v_add_f32 v211, v211, v30
  v_add_f32 v211, v211, v31
  v_cvt_pk_bf16_f32 v27, v30, v31
  v_exp_f32 v56, v56
  v_exp_f32 v57, v57
  v_add_f32 v211, v211, v56
  v_exp_f32 v58, v58
  v_add_f32 v211, v211, v57
  v_cvt_pk_bf16_f32 v56, v56, v57
  v_exp_f32 v59, v59
  v_add_f32 v211, v211, v58
  v_add_f32 v211, v211, v59
  v_cvt_pk_bf16_f32 v57, v58, v59
  v_exp_f32 v60, v60
  v_exp_f32 v61, v61
  v_add_f32 v211, v211, v60
  v_exp_f32 v62, v62
  v_add_f32 v211, v211, v61
  v_cvt_pk_bf16_f32 v58, v60, v61
  v_exp_f32 v63, v63
  v_add_f32 v211, v211, v62
  v_add_f32 v211, v211, v63
  v_cvt_pk_bf16_f32 v59, v62, v63
  v_accvgpr_read_b32 v64, a12
  v_accvgpr_read_b32 v65, a13
  v_accvgpr_read_b32 v66, a14
  v_accvgpr_read_b32 v67, a15
  v_mul_f32 v64, v64, v205
  v_mul_f32 v65, v65, v205
  v_mul_f32 v66, v66, v205
  v_mul_f32 v67, v67, v205
  v_accvgpr_write_b32 a12, v64
  v_accvgpr_write_b32 a13, v65
  v_accvgpr_write_b32 a14, v66
  v_accvgpr_write_b32 a15, v67
  v_accvgpr_read_b32 v64, a28
  v_accvgpr_read_b32 v65, a29
  v_accvgpr_read_b32 v66, a30
  v_accvgpr_read_b32 v67, a31
  v_mul_f32 v64, v64, v205
  v_mul_f32 v65, v65, v205
  v_mul_f32 v66, v66, v205
  v_mul_f32 v67, v67, v205
  v_accvgpr_write_b32 a28, v64
  v_accvgpr_write_b32 a29, v65
  v_accvgpr_write_b32 a30, v66
  v_accvgpr_write_b32 a31, v67
  v_accvgpr_read_b32 v64, a44
  v_accvgpr_read_b32 v65, a45
  v_accvgpr_read_b32 v66, a46
  v_accvgpr_read_b32 v67, a47
  v_mul_f32 v64, v64, v205
  v_mul_f32 v65, v65, v205
  v_mul_f32 v66, v66, v205
  v_mul_f32 v67, v67, v205
  v_accvgpr_write_b32 a44, v64
  v_accvgpr_write_b32 a45, v65
  v_accvgpr_write_b32 a46, v66
  v_accvgpr_write_b32 a47, v67
  v_accvgpr_read_b32 v64, a60
  v_accvgpr_read_b32 v65, a61
  v_accvgpr_read_b32 v66, a62
  v_accvgpr_read_b32 v67, a63
  v_mul_f32 v64, v64, v205
  v_mul_f32 v65, v65, v205
  v_mul_f32 v66, v66, v205
  v_mul_f32 v67, v67, v205
  v_accvgpr_write_b32 a60, v64
  v_accvgpr_write_b32 a61, v65
  v_accvgpr_write_b32 a62, v66
  v_accvgpr_write_b32 a63, v67
  v_accvgpr_read_b32 v64, a76
  v_accvgpr_read_b32 v65, a77
  v_accvgpr_read_b32 v66, a78
  v_accvgpr_read_b32 v67, a79
  v_mul_f32 v64, v64, v205
  v_mul_f32 v65, v65, v205
  v_mul_f32 v66, v66, v205
  v_mul_f32 v67, v67, v205
  v_accvgpr_write_b32 a76, v64
  v_accvgpr_write_b32 a77, v65
  v_accvgpr_write_b32 a78, v66
  v_accvgpr_write_b32 a79, v67
  v_accvgpr_read_b32 v64, a92
  v_accvgpr_read_b32 v65, a93
  v_accvgpr_read_b32 v66, a94
  v_accvgpr_read_b32 v67, a95
  v_mul_f32 v64, v64, v205
  v_mul_f32 v65, v65, v205
  v_mul_f32 v66, v66, v205
  v_mul_f32 v67, v67, v205
  v_accvgpr_write_b32 a92, v64
  v_accvgpr_write_b32 a93, v65
  v_accvgpr_write_b32 a94, v66
  v_accvgpr_write_b32 a95, v67
  v_accvgpr_read_b32 v64, a108
  v_accvgpr_read_b32 v65, a109
  v_accvgpr_read_b32 v66, a110
  v_accvgpr_read_b32 v67, a111
  v_mul_f32 v64, v64, v205
  v_mul_f32 v65, v65, v205
  v_mul_f32 v66, v66, v205
  v_mul_f32 v67, v67, v205
  v_accvgpr_write_b32 a108, v64
  v_accvgpr_write_b32 a109, v65
  v_accvgpr_write_b32 a110, v66
  v_accvgpr_write_b32 a111, v67
  v_accvgpr_read_b32 v64, a124
  v_accvgpr_read_b32 v65, a125
  v_accvgpr_read_b32 v66, a126
  v_accvgpr_read_b32 v67, a127
  v_mul_f32 v64, v64, v205
  v_mul_f32 v65, v65, v205
  v_mul_f32 v66, v66, v205
  v_mul_f32 v67, v67, v205
  v_accvgpr_write_b32 a124, v64
  v_accvgpr_write_b32 a125, v65
  v_accvgpr_write_b32 a126, v66
  v_accvgpr_write_b32 a127, v67
  ds_read_b64_tr_b16 a[160:161], v216 offset:49152
  ds_read_b64_tr_b16 a[162:163], v216 offset:53248
  ds_read_b64_tr_b16 a[164:165], v216 offset:57344
  ds_read_b64_tr_b16 a[166:167], v216 offset:61440
  s_waitcnt lgkmcnt(2)
  v_mfma_f32_16x16x32_bf16 a[0:3], a[160:163], v[0:3], a[0:3]
  s_waitcnt lgkmcnt(0)
  v_mfma_f32_16x16x32_bf16 a[0:3], a[164:167], v[32:35], a[0:3]
  v_mfma_f32_16x16x32_bf16 a[4:7], a[164:167], v[40:43], a[4:7]
  v_mfma_f32_16x16x32_bf16 a[4:7], a[160:163], v[8:11], a[4:7]
  v_mfma_f32_16x16x32_bf16 a[8:11], a[160:163], v[16:19], a[8:11]
  v_mfma_f32_16x16x32_bf16 a[8:11], a[164:167], v[48:51], a[8:11]
  v_mfma_f32_16x16x32_bf16 a[12:15], a[164:167], v[56:59], a[12:15]
  v_mfma_f32_16x16x32_bf16 a[12:15], a[160:163], v[24:27], a[12:15]
  ds_read_b64_tr_b16 a[168:169], v217 offset:49152
  ds_read_b64_tr_b16 a[170:171], v217 offset:53248
  ds_read_b64_tr_b16 a[172:173], v217 offset:57344
  ds_read_b64_tr_b16 a[174:175], v217 offset:61440
  s_waitcnt lgkmcnt(2)
  v_mfma_f32_16x16x32_bf16 a[16:19], a[168:171], v[0:3], a[16:19]
  s_waitcnt lgkmcnt(0)
  v_mfma_f32_16x16x32_bf16 a[16:19], a[172:175], v[32:35], a[16:19]
  v_mfma_f32_16x16x32_bf16 a[20:23], a[172:175], v[40:43], a[20:23]
  v_mfma_f32_16x16x32_bf16 a[20:23], a[168:171], v[8:11], a[20:23]
  v_mfma_f32_16x16x32_bf16 a[24:27], a[168:171], v[16:19], a[24:27]
  v_mfma_f32_16x16x32_bf16 a[24:27], a[172:175], v[48:51], a[24:27]
  v_mfma_f32_16x16x32_bf16 a[28:31], a[172:175], v[56:59], a[28:31]
  v_mfma_f32_16x16x32_bf16 a[28:31], a[168:171], v[24:27], a[28:31]
  ds_read_b64_tr_b16 a[176:177], v218 offset:49152
  ds_read_b64_tr_b16 a[178:179], v218 offset:53248
  ds_read_b64_tr_b16 a[180:181], v218 offset:57344
  ds_read_b64_tr_b16 a[182:183], v218 offset:61440
  s_waitcnt lgkmcnt(2)
  v_mfma_f32_16x16x32_bf16 a[32:35], a[176:179], v[0:3], a[32:35]
  s_waitcnt lgkmcnt(0)
  v_mfma_f32_16x16x32_bf16 a[32:35], a[180:183], v[32:35], a[32:35]
  v_mfma_f32_16x16x32_bf16 a[36:39], a[180:183], v[40:43], a[36:39]
  v_mfma_f32_16x16x32_bf16 a[36:39], a[176:179], v[8:11], a[36:39]
  v_mfma_f32_16x16x32_bf16 a[40:43], a[176:179], v[16:19], a[40:43]
  v_mfma_f32_16x16x32_bf16 a[40:43], a[180:183], v[48:51], a[40:43]
  v_mfma_f32_16x16x32_bf16 a[44:47], a[180:183], v[56:59], a[44:47]
  v_mfma_f32_16x16x32_bf16 a[44:47], a[176:179], v[24:27], a[44:47]
  ds_read_b64_tr_b16 a[184:185], v219 offset:49152
  ds_read_b64_tr_b16 a[186:187], v219 offset:53248
  ds_read_b64_tr_b16 a[188:189], v219 offset:57344
  ds_read_b64_tr_b16 a[190:191], v219 offset:61440
  s_waitcnt lgkmcnt(2)
  v_mfma_f32_16x16x32_bf16 a[48:51], a[184:187], v[0:3], a[48:51]
  s_waitcnt lgkmcnt(0)
  v_mfma_f32_16x16x32_bf16 a[48:51], a[188:191], v[32:35], a[48:51]
  v_mfma_f32_16x16x32_bf16 a[52:55], a[188:191], v[40:43], a[52:55]
  v_mfma_f32_16x16x32_bf16 a[52:55], a[184:187], v[8:11], a[52:55]
  v_mfma_f32_16x16x32_bf16 a[56:59], a[184:187], v[16:19], a[56:59]
  v_mfma_f32_16x16x32_bf16 a[56:59], a[188:191], v[48:51], a[56:59]
  v_mfma_f32_16x16x32_bf16 a[60:63], a[188:191], v[56:59], a[60:63]
  v_mfma_f32_16x16x32_bf16 a[60:63], a[184:187], v[24:27], a[60:63]
  ds_read_b64_tr_b16 a[160:161], v220 offset:49152
  ds_read_b64_tr_b16 a[162:163], v220 offset:53248
  ds_read_b64_tr_b16 a[164:165], v220 offset:57344
  ds_read_b64_tr_b16 a[166:167], v220 offset:61440
  s_waitcnt lgkmcnt(2)
  v_mfma_f32_16x16x32_bf16 a[64:67], a[160:163], v[0:3], a[64:67]
  s_waitcnt lgkmcnt(0)
  v_mfma_f32_16x16x32_bf16 a[64:67], a[164:167], v[32:35], a[64:67]
  v_mfma_f32_16x16x32_bf16 a[68:71], a[164:167], v[40:43], a[68:71]
  v_mfma_f32_16x16x32_bf16 a[68:71], a[160:163], v[8:11], a[68:71]
  v_mfma_f32_16x16x32_bf16 a[72:75], a[160:163], v[16:19], a[72:75]
  v_mfma_f32_16x16x32_bf16 a[72:75], a[164:167], v[48:51], a[72:75]
  v_mfma_f32_16x16x32_bf16 a[76:79], a[164:167], v[56:59], a[76:79]
  v_mfma_f32_16x16x32_bf16 a[76:79], a[160:163], v[24:27], a[76:79]
  ds_read_b64_tr_b16 a[168:169], v221 offset:49152
  ds_read_b64_tr_b16 a[170:171], v221 offset:53248
  ds_read_b64_tr_b16 a[172:173], v221 offset:57344
  ds_read_b64_tr_b16 a[174:175], v221 offset:61440
  s_waitcnt lgkmcnt(2)
  v_mfma_f32_16x16x32_bf16 a[80:83], a[168:171], v[0:3], a[80:83]
  s_waitcnt lgkmcnt(0)
  v_mfma_f32_16x16x32_bf16 a[80:83], a[172:175], v[32:35], a[80:83]
  v_mfma_f32_16x16x32_bf16 a[84:87], a[172:175], v[40:43], a[84:87]
  v_mfma_f32_16x16x32_bf16 a[84:87], a[168:171], v[8:11], a[84:87]
  v_mfma_f32_16x16x32_bf16 a[88:91], a[168:171], v[16:19], a[88:91]
  v_mfma_f32_16x16x32_bf16 a[88:91], a[172:175], v[48:51], a[88:91]
  v_mfma_f32_16x16x32_bf16 a[92:95], a[172:175], v[56:59], a[92:95]
  v_mfma_f32_16x16x32_bf16 a[92:95], a[168:171], v[24:27], a[92:95]
  ds_read_b64_tr_b16 a[176:177], v222 offset:49152
  ds_read_b64_tr_b16 a[178:179], v222 offset:53248
  ds_read_b64_tr_b16 a[180:181], v222 offset:57344
  ds_read_b64_tr_b16 a[182:183], v222 offset:61440
  s_waitcnt lgkmcnt(2)
  v_mfma_f32_16x16x32_bf16 a[96:99], a[176:179], v[0:3], a[96:99]
  s_waitcnt lgkmcnt(0)
  v_mfma_f32_16x16x32_bf16 a[96:99], a[180:183], v[32:35], a[96:99]
  v_mfma_f32_16x16x32_bf16 a[100:103], a[180:183], v[40:43], a[100:103]
  v_mfma_f32_16x16x32_bf16 a[100:103], a[176:179], v[8:11], a[100:103]
  v_mfma_f32_16x16x32_bf16 a[104:107], a[176:179], v[16:19], a[104:107]
  v_mfma_f32_16x16x32_bf16 a[104:107], a[180:183], v[48:51], a[104:107]
  v_mfma_f32_16x16x32_bf16 a[108:111], a[180:183], v[56:59], a[108:111]
  v_mfma_f32_16x16x32_bf16 a[108:111], a[176:179], v[24:27], a[108:111]
  ds_read_b64_tr_b16 a[184:185], v223 offset:49152
  ds_read_b64_tr_b16 a[186:187], v223 offset:53248
  ds_read_b64_tr_b16 a[188:189], v223 offset:57344
  ds_read_b64_tr_b16 a[190:191], v223 offset:61440
  s_waitcnt lgkmcnt(2)
  v_mfma_f32_16x16x32_bf16 a[112:115], a[184:187], v[0:3], a[112:115]
  s_waitcnt lgkmcnt(0)
  v_mfma_f32_16x16x32_bf16 a[112:115], a[188:191], v[32:35], a[112:115]
  v_mfma_f32_16x16x32_bf16 a[116:119], a[188:191], v[40:43], a[116:119]
  v_mfma_f32_16x16x32_bf16 a[116:119], a[184:187], v[8:11], a[116:119]
  v_mfma_f32_16x16x32_bf16 a[120:123], a[184:187], v[16:19], a[120:123]
  v_mfma_f32_16x16x32_bf16 a[120:123], a[188:191], v[48:51], a[120:123]
  v_mfma_f32_16x16x32_bf16 a[124:127], a[188:191], v[56:59], a[124:127]
  v_mfma_f32_16x16x32_bf16 a[124:127], a[184:187], v[24:27], a[124:127]
  s_add_u32 s29, s29, 16384
  s_cmp_lt_u32 s29, 524288
  s_cbranch_scc1 attn_slow
  v_mov_b32 v245, v208
  v_mov_b32 v246, v209
  v_mov_b32 v247, v210
  v_mov_b32 v248, v211
  v_permlane16_swap_b32 v208, v245
  v_permlane16_swap_b32 v209, v246
  v_permlane16_swap_b32 v210, v247
  v_permlane16_swap_b32 v211, v248
  v_add_f32 v208, v208, v245
  v_add_f32 v209, v209, v246
  v_add_f32 v210, v210, v247
  v_add_f32 v211, v211, v248
  v_mov_b32 v245, v208
  v_mov_b32 v246, v209
  v_mov_b32 v247, v210
  v_mov_b32 v248, v211
  v_permlane32_swap_b32 v208, v245
  v_permlane32_swap_b32 v209, v246
  v_permlane32_swap_b32 v210, v247
  v_permlane32_swap_b32 v211, v248
  v_add_f32 v208, v208, v245
  v_add_f32 v209, v209, v246
  v_add_f32 v210, v210, v247
  v_add_f32 v211, v211, v248
  v_rcp_f32 v192, v208
  v_rcp_f32 v196, v209
  v_rcp_f32 v200, v210
  v_rcp_f32 v204, v211
  v_accvgpr_read_b32 v0, a0
  v_accvgpr_read_b32 v1, a1
  v_accvgpr_read_b32 v2, a2
  v_accvgpr_read_b32 v3, a3
  v_accvgpr_read_b32 v4, a16
  v_accvgpr_read_b32 v5, a17
  v_accvgpr_read_b32 v6, a18
  v_accvgpr_read_b32 v7, a19
  v_mul_f32 v0, v0, v192
  v_mul_f32 v1, v1, v192
  v_mul_f32 v2, v2, v192
  v_mul_f32 v3, v3, v192
  v_mul_f32 v4, v4, v192
  v_mul_f32 v5, v5, v192
  v_mul_f32 v6, v6, v192
  v_mul_f32 v7, v7, v192
  v_cvt_pk_bf16_f32 v0, v0, v1
  v_cvt_pk_bf16_f32 v1, v2, v3
  v_cvt_pk_bf16_f32 v2, v4, v5
  v_cvt_pk_bf16_f32 v3, v6, v7
  buffer_store_dwordx4 v[0:3], v244, s[24:27], s40 offen offset:0 sc1
  v_accvgpr_read_b32 v8, a4
  v_accvgpr_read_b32 v9, a5
  v_accvgpr_read_b32 v10, a6
  v_accvgpr_read_b32 v11, a7
  v_accvgpr_read_b32 v12, a20
  v_accvgpr_read_b32 v13, a21
  v_accvgpr_read_b32 v14, a22
  v_accvgpr_read_b32 v15, a23
  v_mul_f32 v8, v8, v196
  v_mul_f32 v9, v9, v196
  v_mul_f32 v10, v10, v196
  v_mul_f32 v11, v11, v196
  v_mul_f32 v12, v12, v196
  v_mul_f32 v13, v13, v196
  v_mul_f32 v14, v14, v196
  v_mul_f32 v15, v15, v196
  v_cvt_pk_bf16_f32 v8, v8, v9
  v_cvt_pk_bf16_f32 v9, v10, v11
  v_cvt_pk_bf16_f32 v10, v12, v13
  v_cvt_pk_bf16_f32 v11, v14, v15
  buffer_store_dwordx4 v[8:11], v244, s[24:27], s40 offen offset:2048 sc1
  v_accvgpr_read_b32 v16, a8
  v_accvgpr_read_b32 v17, a9
  v_accvgpr_read_b32 v18, a10
  v_accvgpr_read_b32 v19, a11
  v_accvgpr_read_b32 v20, a24
  v_accvgpr_read_b32 v21, a25
  v_accvgpr_read_b32 v22, a26
  v_accvgpr_read_b32 v23, a27
  v_mul_f32 v16, v16, v200
  v_mul_f32 v17, v17, v200
  v_mul_f32 v18, v18, v200
  v_mul_f32 v19, v19, v200
  v_mul_f32 v20, v20, v200
  v_mul_f32 v21, v21, v200
  v_mul_f32 v22, v22, v200
  v_mul_f32 v23, v23, v200
  v_cvt_pk_bf16_f32 v16, v16, v17
  v_cvt_pk_bf16_f32 v17, v18, v19
  v_cvt_pk_bf16_f32 v18, v20, v21
  v_cvt_pk_bf16_f32 v19, v22, v23
  buffer_store_dwordx4 v[16:19], v244, s[24:27], s41 offen offset:0 sc1
  v_accvgpr_read_b32 v24, a12
  v_accvgpr_read_b32 v25, a13
  v_accvgpr_read_b32 v26, a14
  v_accvgpr_read_b32 v27, a15
  v_accvgpr_read_b32 v28, a28
  v_accvgpr_read_b32 v29, a29
  v_accvgpr_read_b32 v30, a30
  v_accvgpr_read_b32 v31, a31
  v_mul_f32 v24, v24, v204
  v_mul_f32 v25, v25, v204
  v_mul_f32 v26, v26, v204
  v_mul_f32 v27, v27, v204
  v_mul_f32 v28, v28, v204
  v_mul_f32 v29, v29, v204
  v_mul_f32 v30, v30, v204
  v_mul_f32 v31, v31, v204
  v_cvt_pk_bf16_f32 v24, v24, v25
  v_cvt_pk_bf16_f32 v25, v26, v27
  v_cvt_pk_bf16_f32 v26, v28, v29
  v_cvt_pk_bf16_f32 v27, v30, v31
  buffer_store_dwordx4 v[24:27], v244, s[24:27], s41 offen offset:2048 sc1
  v_accvgpr_read_b32 v32, a32
  v_accvgpr_read_b32 v33, a33
  v_accvgpr_read_b32 v34, a34
  v_accvgpr_read_b32 v35, a35
  v_accvgpr_read_b32 v36, a48
  v_accvgpr_read_b32 v37, a49
  v_accvgpr_read_b32 v38, a50
  v_accvgpr_read_b32 v39, a51
  v_mul_f32 v32, v32, v192
  v_mul_f32 v33, v33, v192
  v_mul_f32 v34, v34, v192
  v_mul_f32 v35, v35, v192
  v_mul_f32 v36, v36, v192
  v_mul_f32 v37, v37, v192
  v_mul_f32 v38, v38, v192
  v_mul_f32 v39, v39, v192
  v_cvt_pk_bf16_f32 v32, v32, v33
  v_cvt_pk_bf16_f32 v33, v34, v35
  v_cvt_pk_bf16_f32 v34, v36, v37
  v_cvt_pk_bf16_f32 v35, v38, v39
  buffer_store_dwordx4 v[32:35], v244, s[24:27], s40 offen offset:1024 sc1
  v_accvgpr_read_b32 v40, a36
  v_accvgpr_read_b32 v41, a37
  v_accvgpr_read_b32 v42, a38
  v_accvgpr_read_b32 v43, a39
  v_accvgpr_read_b32 v44, a52
  v_accvgpr_read_b32 v45, a53
  v_accvgpr_read_b32 v46, a54
  v_accvgpr_read_b32 v47, a55
  v_mul_f32 v40, v40, v196
  v_mul_f32 v41, v41, v196
  v_mul_f32 v42, v42, v196
  v_mul_f32 v43, v43, v196
  v_mul_f32 v44, v44, v196
  v_mul_f32 v45, v45, v196
  v_mul_f32 v46, v46, v196
  v_mul_f32 v47, v47, v196
  v_cvt_pk_bf16_f32 v40, v40, v41
  v_cvt_pk_bf16_f32 v41, v42, v43
  v_cvt_pk_bf16_f32 v42, v44, v45
  v_cvt_pk_bf16_f32 v43, v46, v47
  buffer_store_dwordx4 v[40:43], v244, s[24:27], s40 offen offset:3072 sc1
  v_accvgpr_read_b32 v48, a40
  v_accvgpr_read_b32 v49, a41
  v_accvgpr_read_b32 v50, a42
  v_accvgpr_read_b32 v51, a43
  v_accvgpr_read_b32 v52, a56
  v_accvgpr_read_b32 v53, a57
  v_accvgpr_read_b32 v54, a58
  v_accvgpr_read_b32 v55, a59
  v_mul_f32 v48, v48, v200
  v_mul_f32 v49, v49, v200
  v_mul_f32 v50, v50, v200
  v_mul_f32 v51, v51, v200
  v_mul_f32 v52, v52, v200
  v_mul_f32 v53, v53, v200
  v_mul_f32 v54, v54, v200
  v_mul_f32 v55, v55, v200
  v_cvt_pk_bf16_f32 v48, v48, v49
  v_cvt_pk_bf16_f32 v49, v50, v51
  v_cvt_pk_bf16_f32 v50, v52, v53
  v_cvt_pk_bf16_f32 v51, v54, v55
  buffer_store_dwordx4 v[48:51], v244, s[24:27], s41 offen offset:1024 sc1
  v_accvgpr_read_b32 v56, a44
  v_accvgpr_read_b32 v57, a45
  v_accvgpr_read_b32 v58, a46
  v_accvgpr_read_b32 v59, a47
  v_accvgpr_read_b32 v60, a60
  v_accvgpr_read_b32 v61, a61
  v_accvgpr_read_b32 v62, a62
  v_accvgpr_read_b32 v63, a63
  v_mul_f32 v56, v56, v204
  v_mul_f32 v57, v57, v204
  v_mul_f32 v58, v58, v204
  v_mul_f32 v59, v59, v204
  v_mul_f32 v60, v60, v204
  v_mul_f32 v61, v61, v204
  v_mul_f32 v62, v62, v204
  v_mul_f32 v63, v63, v204
  v_cvt_pk_bf16_f32 v56, v56, v57
  v_cvt_pk_bf16_f32 v57, v58, v59
  v_cvt_pk_bf16_f32 v58, v60, v61
  v_cvt_pk_bf16_f32 v59, v62, v63
  buffer_store_dwordx4 v[56:59], v244, s[24:27], s41 offen offset:3072 sc1
  v_accvgpr_read_b32 v0, a64
  v_accvgpr_read_b32 v1, a65
  v_accvgpr_read_b32 v2, a66
  v_accvgpr_read_b32 v3, a67
  v_accvgpr_read_b32 v4, a80
  v_accvgpr_read_b32 v5, a81
  v_accvgpr_read_b32 v6, a82
  v_accvgpr_read_b32 v7, a83
  v_mul_f32 v0, v0, v192
  v_mul_f32 v1, v1, v192
  v_mul_f32 v2, v2, v192
  v_mul_f32 v3, v3, v192
  v_mul_f32 v4, v4, v192
  v_mul_f32 v5, v5, v192
  v_mul_f32 v6, v6, v192
  v_mul_f32 v7, v7, v192
  v_cvt_pk_bf16_f32 v0, v0, v1
  v_cvt_pk_bf16_f32 v1, v2, v3
  v_cvt_pk_bf16_f32 v2, v4, v5
  v_cvt_pk_bf16_f32 v3, v6, v7
  buffer_store_dwordx4 v[0:3], v244, s[24:27], s42 offen offset:0 sc1
  v_accvgpr_read_b32 v8, a68
  v_accvgpr_read_b32 v9, a69
  v_accvgpr_read_b32 v10, a70
  v_accvgpr_read_b32 v11, a71
  v_accvgpr_read_b32 v12, a84
  v_accvgpr_read_b32 v13, a85
  v_accvgpr_read_b32 v14, a86
  v_accvgpr_read_b32 v15, a87
  v_mul_f32 v8, v8, v196
  v_mul_f32 v9, v9, v196
  v_mul_f32 v10, v10, v196
  v_mul_f32 v11, v11, v196
  v_mul_f32 v12, v12, v196
  v_mul_f32 v13, v13, v196
  v_mul_f32 v14, v14, v196
  v_mul_f32 v15, v15, v196
  v_cvt_pk_bf16_f32 v8, v8, v9
  v_cvt_pk_bf16_f32 v9, v10, v11
  v_cvt_pk_bf16_f32 v10, v12, v13
  v_cvt_pk_bf16_f32 v11, v14, v15
  buffer_store_dwordx4 v[8:11], v244, s[24:27], s42 offen offset:2048 sc1
  v_accvgpr_read_b32 v16, a72
  v_accvgpr_read_b32 v17, a73
  v_accvgpr_read_b32 v18, a74
  v_accvgpr_read_b32 v19, a75
  v_accvgpr_read_b32 v20, a88
  v_accvgpr_read_b32 v21, a89
  v_accvgpr_read_b32 v22, a90
  v_accvgpr_read_b32 v23, a91
  v_mul_f32 v16, v16, v200
  v_mul_f32 v17, v17, v200
  v_mul_f32 v18, v18, v200
  v_mul_f32 v19, v19, v200
  v_mul_f32 v20, v20, v200
  v_mul_f32 v21, v21, v200
  v_mul_f32 v22, v22, v200
  v_mul_f32 v23, v23, v200
  v_cvt_pk_bf16_f32 v16, v16, v17
  v_cvt_pk_bf16_f32 v17, v18, v19
  v_cvt_pk_bf16_f32 v18, v20, v21
  v_cvt_pk_bf16_f32 v19, v22, v23
  buffer_store_dwordx4 v[16:19], v244, s[24:27], s43 offen offset:0 sc1
  v_accvgpr_read_b32 v24, a76
  v_accvgpr_read_b32 v25, a77
  v_accvgpr_read_b32 v26, a78
  v_accvgpr_read_b32 v27, a79
  v_accvgpr_read_b32 v28, a92
  v_accvgpr_read_b32 v29, a93
  v_accvgpr_read_b32 v30, a94
  v_accvgpr_read_b32 v31, a95
  v_mul_f32 v24, v24, v204
  v_mul_f32 v25, v25, v204
  v_mul_f32 v26, v26, v204
  v_mul_f32 v27, v27, v204
  v_mul_f32 v28, v28, v204
  v_mul_f32 v29, v29, v204
  v_mul_f32 v30, v30, v204
  v_mul_f32 v31, v31, v204
  v_cvt_pk_bf16_f32 v24, v24, v25
  v_cvt_pk_bf16_f32 v25, v26, v27
  v_cvt_pk_bf16_f32 v26, v28, v29
  v_cvt_pk_bf16_f32 v27, v30, v31
  buffer_store_dwordx4 v[24:27], v244, s[24:27], s43 offen offset:2048 sc1
  v_accvgpr_read_b32 v32, a96
  v_accvgpr_read_b32 v33, a97
  v_accvgpr_read_b32 v34, a98
  v_accvgpr_read_b32 v35, a99
  v_accvgpr_read_b32 v36, a112
  v_accvgpr_read_b32 v37, a113
  v_accvgpr_read_b32 v38, a114
  v_accvgpr_read_b32 v39, a115
  v_mul_f32 v32, v32, v192
  v_mul_f32 v33, v33, v192
  v_mul_f32 v34, v34, v192
  v_mul_f32 v35, v35, v192
  v_mul_f32 v36, v36, v192
  v_mul_f32 v37, v37, v192
  v_mul_f32 v38, v38, v192
  v_mul_f32 v39, v39, v192
  v_cvt_pk_bf16_f32 v32, v32, v33
  v_cvt_pk_bf16_f32 v33, v34, v35
  v_cvt_pk_bf16_f32 v34, v36, v37
  v_cvt_pk_bf16_f32 v35, v38, v39
  buffer_store_dwordx4 v[32:35], v244, s[24:27], s42 offen offset:1024 sc1
  v_accvgpr_read_b32 v40, a100
  v_accvgpr_read_b32 v41, a101
  v_accvgpr_read_b32 v42, a102
  v_accvgpr_read_b32 v43, a103
  v_accvgpr_read_b32 v44, a116
  v_accvgpr_read_b32 v45, a117
  v_accvgpr_read_b32 v46, a118
  v_accvgpr_read_b32 v47, a119
  v_mul_f32 v40, v40, v196
  v_mul_f32 v41, v41, v196
  v_mul_f32 v42, v42, v196
  v_mul_f32 v43, v43, v196
  v_mul_f32 v44, v44, v196
  v_mul_f32 v45, v45, v196
  v_mul_f32 v46, v46, v196
  v_mul_f32 v47, v47, v196
  v_cvt_pk_bf16_f32 v40, v40, v41
  v_cvt_pk_bf16_f32 v41, v42, v43
  v_cvt_pk_bf16_f32 v42, v44, v45
  v_cvt_pk_bf16_f32 v43, v46, v47
  buffer_store_dwordx4 v[40:43], v244, s[24:27], s42 offen offset:3072 sc1
  v_accvgpr_read_b32 v48, a104
  v_accvgpr_read_b32 v49, a105
  v_accvgpr_read_b32 v50, a106
  v_accvgpr_read_b32 v51, a107
  v_accvgpr_read_b32 v52, a120
  v_accvgpr_read_b32 v53, a121
  v_accvgpr_read_b32 v54, a122
  v_accvgpr_read_b32 v55, a123
  v_mul_f32 v48, v48, v200
  v_mul_f32 v49, v49, v200
  v_mul_f32 v50, v50, v200
  v_mul_f32 v51, v51, v200
  v_mul_f32 v52, v52, v200
  v_mul_f32 v53, v53, v200
  v_mul_f32 v54, v54, v200
  v_mul_f32 v55, v55, v200
  v_cvt_pk_bf16_f32 v48, v48, v49
  v_cvt_pk_bf16_f32 v49, v50, v51
  v_cvt_pk_bf16_f32 v50, v52, v53
  v_cvt_pk_bf16_f32 v51, v54, v55
  buffer_store_dwordx4 v[48:51], v244, s[24:27], s43 offen offset:1024 sc1
  v_accvgpr_read_b32 v56, a108
  v_accvgpr_read_b32 v57, a109
  v_accvgpr_read_b32 v58, a110
  v_accvgpr_read_b32 v59, a111
  v_accvgpr_read_b32 v60, a124
  v_accvgpr_read_b32 v61, a125
  v_accvgpr_read_b32 v62, a126
  v_accvgpr_read_b32 v63, a127
  v_mul_f32 v56, v56, v204
  v_mul_f32 v57, v57, v204
  v_mul_f32 v58, v58, v204
  v_mul_f32 v59, v59, v204
  v_mul_f32 v60, v60, v204
  v_mul_f32 v61, v61, v204
  v_mul_f32 v62, v62, v204
  v_mul_f32 v63, v63, v204
  v_cvt_pk_bf16_f32 v56, v56, v57
  v_cvt_pk_bf16_f32 v57, v58, v59
  v_cvt_pk_bf16_f32 v58, v60, v61
  v_cvt_pk_bf16_f32 v59, v62, v63
  buffer_store_dwordx4 v[56:59], v244, s[24:27], s43 offen offset:3072 sc1
  v_add_u32 v252, 4096, v242
  v_add_u32 v253, 8192, v242
  buffer_load_dwordx4 a[128:131], v253, s[24:27], s4 offen offset:3072 sc1
  buffer_load_dwordx4 a[132:135], v242, s[24:27], s5 offen offset:0 sc1
  buffer_load_dwordx4 a[136:139], v242, s[24:27], s5 offen offset:1024 sc1
  buffer_load_dwordx4 a[140:143], v242, s[24:27], s5 offen offset:2048 sc1
  buffer_load_dwordx4 a[144:147], v242, s[24:27], s5 offen offset:3072 sc1
  buffer_load_dwordx4 a[148:151], v252, s[24:27], s5 offen offset:0 sc1
  buffer_load_dwordx4 a[152:155], v252, s[24:27], s5 offen offset:1024 sc1
  buffer_load_dwordx4 a[156:159], v252, s[24:27], s5 offen offset:2048 sc1
  buffer_load_dwordx4 a[0:3], v252, s[24:27], s5 offen offset:3072 sc1
  buffer_load_dwordx4 a[4:7], v253, s[24:27], s5 offen offset:0 sc1
  buffer_load_dwordx4 a[8:11], v253, s[24:27], s5 offen offset:1024 sc1
  buffer_load_dwordx4 a[12:15], v253, s[24:27], s5 offen offset:2048 sc1
  buffer_load_dwordx4 a[16:19], v253, s[24:27], s5 offen offset:3072 sc1
  buffer_load_dwordx4 a[20:23], v242, s[24:27], s6 offen offset:0 sc1
  buffer_load_dwordx4 a[24:27], v242, s[24:27], s6 offen offset:1024 sc1
  buffer_load_dwordx4 a[28:31], v242, s[24:27], s6 offen offset:2048 sc1
  buffer_load_dwordx4 a[32:35], v242, s[24:27], s6 offen offset:3072 sc1
  buffer_load_dwordx4 a[36:39], v252, s[24:27], s6 offen offset:0 sc1
  s_lshr_b32 s39, s37, 2
  s_lshl_b32 s39, s39, 3
  s_lshr_b32 s38, s36, 2
  s_add_u32 s39, s39, s38
  s_lshl_b32 s39, s39, 7
  s_add_u32 s39, s39, 2867200
  s_lshl_b32 s38, s3, 26
  v_lshlrev_b32 v64, 22, v242
  v_or_b32 v64, s38, v64
  v_mov_b32 v65, 1
  s_waitcnt vmcnt(0)
  s_barrier
  s_branch tail_go
.section .rodata,"a"
.p2align 6
.amdhsa_kernel recurrent_scan__mha_block_cached__moe_arch_mod__prompt_kernel
  .amdhsa_next_free_vgpr 512
  .amdhsa_next_free_sgpr 102
  .amdhsa_accum_offset 256
  .amdhsa_group_segment_fixed_size 0
  .amdhsa_kernarg_size 104
  .amdhsa_user_sgpr_count 2
  .amdhsa_user_sgpr_kernarg_segment_ptr 1
  .amdhsa_system_sgpr_workgroup_id_x 1
.end_amdhsa_kernel
```

```asm
; @launch grid=(256,1,1) block=(256,1,1) lds=163840
.amdgcn_target "amdgcn-amd-amdhsa--gfx950"
.text
.globl recurrent_scan__mha_block_cached__moe_arch_mod__prompt_kernel
.p2align 8
.type recurrent_scan__mha_block_cached__moe_arch_mod__prompt_kernel,@function
recurrent_scan__mha_block_cached__moe_arch_mod__prompt_kernel:
  s_cmp_ge_u32 s2, 256
  s_cbranch_scc1 attn_end
  s_load_dwordx2 s[60:61], s[0:1], 0
  s_load_dwordx2 s[48:49], s[0:1], 48
  s_load_dwordx4 s[4:7], s[0:1], 8
  s_load_dwordx2 s[8:9], s[0:1], 24
  s_load_dwordx2 s[10:11], s[0:1], 96
  s_load_dwordx2 s[88:89], s[0:1], 32
  s_load_dwordx2 s[90:91], s[0:1], 56
  s_load_dwordx4 s[92:95], s[0:1], 64
  s_load_dwordx2 s[62:63], s[0:1], 80
  v_lshrrev_b32 v249, 6, v0
  v_and_b32 v0, 63, v0
  v_mov_b32 v245, v0
  v_readfirstlane_b32 s3, v249
  s_and_b32 s36, s2, 7
  s_lshl_b32 s36, s36, 2
  s_lshr_b32 s37, s2, 6
  s_add_u32 s36, s36, s37
  s_bfe_u32 s37, s2, 196611
  s_lshl_b32 s37, s37, 2
  s_add_u32 s37, s37, s3
  s_lshl_b32 s28, s3, 12
  v_lshrrev_b32 v248, 4, v245
  v_and_b32 v247, 15, v245
  s_lshl_b32 s38, s3, 17
  v_lshlrev_b32 v249, 13, v248
  v_add_u32 v249, s38, v249
  v_or_b32 v250, 0, v248
  v_lshlrev_b32 v250, 1, v250
  v_xor_b32 v250, v250, v247
  v_lshl_add_u32 v238, v250, 4, v249
  v_or_b32 v250, 0, v248
  v_lshlrev_b32 v250, 1, v250
  v_xor_b32 v250, v250, v247
  v_lshl_add_u32 v239, v250, 4, v249
  v_add_u32 v239, 31744, v239
  v_or_b32 v250, 4, v248
  v_lshlrev_b32 v250, 1, v250
  v_xor_b32 v250, v250, v247
  v_lshl_add_u32 v240, v250, 4, v249
  v_add_u32 v240, 63488, v240
  v_or_b32 v250, 4, v248
  v_lshlrev_b32 v250, 1, v250
  v_xor_b32 v250, v250, v247
  v_lshl_add_u32 v241, v250, 4, v249
  v_add_u32 v241, 95232, v241
  s_waitcnt lgkmcnt(0)
  s_add_u32 s58, s10, 2830336
  s_addc_u32 s59, s11, 0
  s_load_dword s59, s[58:59], 0
  s_mov_b32 s24, s10
  s_mov_b32 s25, s11
  s_mov_b32 s26, 29360128
  s_mov_b32 s27, 0x20000
  s_lshl_b32 s38, s36, 8
  s_add_u32 s20, s8, s38
  s_addc_u32 s21, s9, 0
  s_mov_b32 s22, 5242880
  s_mov_b32 s23, 0x20000
  s_sub_u32 s22, s22, s38
  s_cmp_ge_u32 s3, 2
  s_cbranch_scc1 front_fetch
  s_mov_b32 s12, s60
  s_mov_b32 s13, s61
  s_mov_b32 s14, 2621440
  s_mov_b32 s15, 0x20000
  s_mov_b32 s16, s48
  s_mov_b32 s17, s49
  s_mov_b32 s18, 1280
  s_mov_b32 s19, 0x20000
  s_lshr_b32 s52, s37, 2
  s_lshl_b32 s52, s52, 5
  s_add_u32 s52, s52, s36
  s_lshl_b32 s52, s52, 1
  s_add_u32 s52, s52, s3
  s_lshl_b32 s52, s52, 2
  s_mul_i32 s53, s52, 1280
  v_lshrrev_b32 v1, 4, v0
  v_and_b32 v2, 15, v0
  v_lshlrev_b32 v3, 4, v2
  v_mul_u32_u24 v4, 0x500, v1
  v_add_u32 v4, v4, v3
  buffer_load_dwordx4 v[8:11], v4, s[12:15], s53 offen offset:0
  buffer_load_dwordx4 v[12:15], v4, s[12:15], s53 offen offset:256
  buffer_load_dwordx4 v[16:19], v4, s[12:15], s53 offen offset:512
  buffer_load_dwordx4 v[20:23], v4, s[12:15], s53 offen offset:768
  buffer_load_dwordx4 v[24:27], v4, s[12:15], s53 offen offset:1024
  buffer_load_dwordx4 v[28:31], v3, s[16:19], 0 offen offset:0
  buffer_load_dwordx4 v[32:35], v3, s[16:19], 0 offen offset:256
  buffer_load_dwordx4 v[36:39], v3, s[16:19], 0 offen offset:512
  buffer_load_dwordx4 v[40:43], v3, s[16:19], 0 offen offset:768
  buffer_load_dwordx4 v[44:47], v3, s[16:19], 0 offen offset:1024
  v_mov_b32 v7, 0
  v_lshlrev_b32 v6, 26, v0
  s_lshl_b32 s53, s2, 7
  s_add_u32 s53, s53, 2834432
  buffer_store_dword v7, v6, s[24:27], s53 offen sc1
  v_lshlrev_b32 v6, 8, v0
  v_lshrrev_b32 v5, 5, v0
  v_lshl_add_u32 v6, v5, 26, v6
  s_cmp_eq_u32 s2, 0
  s_cselect_b32 s53, 0, 1073741824
  v_or_b32 v6, s53, v6
  s_mov_b32 s53, 2818048
  buffer_store_dword v7, v6, s[24:27], s53 offen sc1
  v_lshlrev_b32 v6, 7, v0
  s_cmp_eq_u32 s2, 1
  s_cselect_b32 s53, 0, 1073741824
  v_or_b32 v6, s53, v6
  s_mov_b32 s53, 2867200
  buffer_store_dword v7, v6, s[24:27], s53 offen sc1
  s_lshr_b32 s53, s52, 6
  s_mul_i32 s53, s53, 81920
  s_bfe_u32 s54, s52, 0x20004
  s_lshl_b32 s54, s54, 10
  s_add_u32 s53, s53, s54
  s_and_b32 s54, s52, 15
  s_lshl_b32 s54, s54, 4
  s_add_u32 s53, s53, s54
  v_lshrrev_b32 v5, 2, v2
  v_lshlrev_b32 v5, 12, v5
  v_and_b32 v6, 3, v2
  v_lshl_add_u32 v5, v6, 8, v5
  v_lshl_add_u32 v5, v1, 4, v5
  s_mov_b32 s56, 0xffff0000
  s_waitcnt vmcnt(12)
  v_lshlrev_b32 v48, 16, v8
  v_and_b32 v49, s56, v8
  v_lshlrev_b32 v50, 16, v9
  v_and_b32 v51, s56, v9
  v_lshlrev_b32 v52, 16, v10
  v_and_b32 v53, s56, v10
  v_lshlrev_b32 v54, 16, v11
  v_and_b32 v55, s56, v11
  s_waitcnt vmcnt(11)
  v_lshlrev_b32 v56, 16, v12
  v_and_b32 v57, s56, v12
  v_lshlrev_b32 v58, 16, v13
  v_and_b32 v59, s56, v13
  v_lshlrev_b32 v60, 16, v14
  v_and_b32 v61, s56, v14
  v_lshlrev_b32 v62, 16, v15
  v_and_b32 v63, s56, v15
  s_waitcnt vmcnt(10)
  v_lshlrev_b32 v64, 16, v16
  v_and_b32 v65, s56, v16
  v_lshlrev_b32 v66, 16, v17
  v_and_b32 v67, s56, v17
  v_lshlrev_b32 v68, 16, v18
  v_and_b32 v69, s56, v18
  v_lshlrev_b32 v70, 16, v19
  v_and_b32 v71, s56, v19
  s_waitcnt vmcnt(9)
  v_lshlrev_b32 v72, 16, v20
  v_and_b32 v73, s56, v20
  v_lshlrev_b32 v74, 16, v21
  v_and_b32 v75, s56, v21
  v_lshlrev_b32 v76, 16, v22
  v_and_b32 v77, s56, v22
  v_lshlrev_b32 v78, 16, v23
  v_and_b32 v79, s56, v23
  s_waitcnt vmcnt(8)
  v_lshlrev_b32 v80, 16, v24
  v_and_b32 v81, s56, v24
  v_lshlrev_b32 v82, 16, v25
  v_and_b32 v83, s56, v25
  v_lshlrev_b32 v84, 16, v26
  v_and_b32 v85, s56, v26
  v_lshlrev_b32 v86, 16, v27
  v_and_b32 v87, s56, v27
  v_pk_add_f32 v[88:89], v[48:49], v[50:51]
  v_pk_add_f32 v[90:91], v[52:53], v[54:55]
  v_pk_add_f32 v[88:89], v[88:89], v[56:57]
  v_pk_add_f32 v[90:91], v[90:91], v[58:59]
  v_pk_add_f32 v[88:89], v[88:89], v[60:61]
  v_pk_add_f32 v[90:91], v[90:91], v[62:63]
  v_pk_add_f32 v[88:89], v[88:89], v[64:65]
  v_pk_add_f32 v[90:91], v[90:91], v[66:67]
  v_pk_add_f32 v[88:89], v[88:89], v[68:69]
  v_pk_add_f32 v[90:91], v[90:91], v[70:71]
  v_pk_add_f32 v[88:89], v[88:89], v[72:73]
  v_pk_add_f32 v[90:91], v[90:91], v[74:75]
  v_pk_add_f32 v[88:89], v[88:89], v[76:77]
  v_pk_add_f32 v[90:91], v[90:91], v[78:79]
  v_pk_add_f32 v[88:89], v[88:89], v[80:81]
  v_pk_add_f32 v[90:91], v[90:91], v[82:83]
  v_pk_add_f32 v[88:89], v[88:89], v[84:85]
  v_pk_add_f32 v[90:91], v[90:91], v[86:87]
  v_pk_add_f32 v[88:89], v[88:89], v[90:91]
  v_add_f32 v92, v88, v89
  s_nop 1
  v_add_f32_dpp v92, v92, v92 row_ror:8 row_mask:0xf bank_mask:0xf
  s_nop 1
  v_add_f32_dpp v92, v92, v92 row_ror:4 row_mask:0xf bank_mask:0xf
  s_nop 1
  v_add_f32_dpp v92, v92, v92 row_ror:2 row_mask:0xf bank_mask:0xf
  s_nop 1
  v_add_f32_dpp v92, v92, v92 row_ror:1 row_mask:0xf bank_mask:0xf
  v_mul_f32 v92, 0x3acccccd, v92
  v_pk_add_f32 v[94:95], v[48:49], v[92:93] op_sel_hi:[1,0] neg_lo:[0,1] neg_hi:[0,1]
  v_pk_mul_f32 v[88:89], v[94:95], v[94:95]
  v_pk_add_f32 v[96:97], v[50:51], v[92:93] op_sel_hi:[1,0] neg_lo:[0,1] neg_hi:[0,1]
  v_pk_mul_f32 v[90:91], v[96:97], v[96:97]
  v_pk_add_f32 v[94:95], v[52:53], v[92:93] op_sel_hi:[1,0] neg_lo:[0,1] neg_hi:[0,1]
  v_pk_fma_f32 v[88:89], v[94:95], v[94:95], v[88:89]
  v_pk_add_f32 v[96:97], v[54:55], v[92:93] op_sel_hi:[1,0] neg_lo:[0,1] neg_hi:[0,1]
  v_pk_fma_f32 v[90:91], v[96:97], v[96:97], v[90:91]
  v_pk_add_f32 v[94:95], v[56:57], v[92:93] op_sel_hi:[1,0] neg_lo:[0,1] neg_hi:[0,1]
  v_pk_fma_f32 v[88:89], v[94:95], v[94:95], v[88:89]
  v_pk_add_f32 v[96:97], v[58:59], v[92:93] op_sel_hi:[1,0] neg_lo:[0,1] neg_hi:[0,1]
  v_pk_fma_f32 v[90:91], v[96:97], v[96:97], v[90:91]
  v_pk_add_f32 v[94:95], v[60:61], v[92:93] op_sel_hi:[1,0] neg_lo:[0,1] neg_hi:[0,1]
  v_pk_fma_f32 v[88:89], v[94:95], v[94:95], v[88:89]
  v_pk_add_f32 v[96:97], v[62:63], v[92:93] op_sel_hi:[1,0] neg_lo:[0,1] neg_hi:[0,1]
  v_pk_fma_f32 v[90:91], v[96:97], v[96:97], v[90:91]
  v_pk_add_f32 v[94:95], v[64:65], v[92:93] op_sel_hi:[1,0] neg_lo:[0,1] neg_hi:[0,1]
  v_pk_fma_f32 v[88:89], v[94:95], v[94:95], v[88:89]
  v_pk_add_f32 v[96:97], v[66:67], v[92:93] op_sel_hi:[1,0] neg_lo:[0,1] neg_hi:[0,1]
  v_pk_fma_f32 v[90:91], v[96:97], v[96:97], v[90:91]
  v_pk_add_f32 v[94:95], v[68:69], v[92:93] op_sel_hi:[1,0] neg_lo:[0,1] neg_hi:[0,1]
  v_pk_fma_f32 v[88:89], v[94:95], v[94:95], v[88:89]
  v_pk_add_f32 v[96:97], v[70:71], v[92:93] op_sel_hi:[1,0] neg_lo:[0,1] neg_hi:[0,1]
  v_pk_fma_f32 v[90:91], v[96:97], v[96:97], v[90:91]
  v_pk_add_f32 v[94:95], v[72:73], v[92:93] op_sel_hi:[1,0] neg_lo:[0,1] neg_hi:[0,1]
  v_pk_fma_f32 v[88:89], v[94:95], v[94:95], v[88:89]
  v_pk_add_f32 v[96:97], v[74:75], v[92:93] op_sel_hi:[1,0] neg_lo:[0,1] neg_hi:[0,1]
  v_pk_fma_f32 v[90:91], v[96:97], v[96:97], v[90:91]
  v_pk_add_f32 v[94:95], v[76:77], v[92:93] op_sel_hi:[1,0] neg_lo:[0,1] neg_hi:[0,1]
  v_pk_fma_f32 v[88:89], v[94:95], v[94:95], v[88:89]
  v_pk_add_f32 v[96:97], v[78:79], v[92:93] op_sel_hi:[1,0] neg_lo:[0,1] neg_hi:[0,1]
  v_pk_fma_f32 v[90:91], v[96:97], v[96:97], v[90:91]
  v_pk_add_f32 v[94:95], v[80:81], v[92:93] op_sel_hi:[1,0] neg_lo:[0,1] neg_hi:[0,1]
  v_pk_fma_f32 v[88:89], v[94:95], v[94:95], v[88:89]
  v_pk_add_f32 v[96:97], v[82:83], v[92:93] op_sel_hi:[1,0] neg_lo:[0,1] neg_hi:[0,1]
  v_pk_fma_f32 v[90:91], v[96:97], v[96:97], v[90:91]
  v_pk_add_f32 v[94:95], v[84:85], v[92:93] op_sel_hi:[1,0] neg_lo:[0,1] neg_hi:[0,1]
  v_pk_fma_f32 v[88:89], v[94:95], v[94:95], v[88:89]
  v_pk_add_f32 v[96:97], v[86:87], v[92:93] op_sel_hi:[1,0] neg_lo:[0,1] neg_hi:[0,1]
  v_pk_fma_f32 v[90:91], v[96:97], v[96:97], v[90:91]
  v_pk_add_f32 v[88:89], v[88:89], v[90:91]
  v_add_f32 v98, v88, v89
  s_nop 1
  v_add_f32_dpp v98, v98, v98 row_ror:8 row_mask:0xf bank_mask:0xf
  v_cvt_pk_bf16_f32 v92, v92, v92
  s_nop 0
  v_add_f32_dpp v98, v98, v98 row_ror:4 row_mask:0xf bank_mask:0xf
  v_lshlrev_b32 v92, 16, v92
  s_nop 0
  v_add_f32_dpp v98, v98, v98 row_ror:2 row_mask:0xf bank_mask:0xf
  s_nop 1
  v_add_f32_dpp v98, v98, v98 row_ror:1 row_mask:0xf bank_mask:0xf
  v_mul_f32 v98, 0x3acccccd, v98
  v_cvt_pk_bf16_f32 v98, v98, v98
  v_pk_add_f32 v[48:49], v[48:49], v[92:93] op_sel_hi:[1,0] neg_lo:[0,1] neg_hi:[0,1]
  v_lshlrev_b32 v98, 16, v98
  v_pk_add_f32 v[50:51], v[50:51], v[92:93] op_sel_hi:[1,0] neg_lo:[0,1] neg_hi:[0,1]
  v_add_f32 v98, 0x3727c5ac, v98
  v_pk_add_f32 v[52:53], v[52:53], v[92:93] op_sel_hi:[1,0] neg_lo:[0,1] neg_hi:[0,1]
  v_cvt_pk_bf16_f32 v98, v98, v98
  v_pk_add_f32 v[54:55], v[54:55], v[92:93] op_sel_hi:[1,0] neg_lo:[0,1] neg_hi:[0,1]
  v_lshlrev_b32 v98, 16, v98
  v_pk_add_f32 v[56:57], v[56:57], v[92:93] op_sel_hi:[1,0] neg_lo:[0,1] neg_hi:[0,1]
  v_sqrt_f32 v98, v98
  v_pk_add_f32 v[58:59], v[58:59], v[92:93] op_sel_hi:[1,0] neg_lo:[0,1] neg_hi:[0,1]
  v_cvt_pk_bf16_f32 v98, v98, v98
  v_pk_add_f32 v[60:61], v[60:61], v[92:93] op_sel_hi:[1,0] neg_lo:[0,1] neg_hi:[0,1]
  v_lshlrev_b32 v98, 16, v98
  v_pk_add_f32 v[62:63], v[62:63], v[92:93] op_sel_hi:[1,0] neg_lo:[0,1] neg_hi:[0,1]
  v_rcp_f32 v100, v98
  v_pk_add_f32 v[64:65], v[64:65], v[92:93] op_sel_hi:[1,0] neg_lo:[0,1] neg_hi:[0,1]
  v_pk_add_f32 v[66:67], v[66:67], v[92:93] op_sel_hi:[1,0] neg_lo:[0,1] neg_hi:[0,1]
  v_pk_add_f32 v[68:69], v[68:69], v[92:93] op_sel_hi:[1,0] neg_lo:[0,1] neg_hi:[0,1]
  v_pk_add_f32 v[70:71], v[70:71], v[92:93] op_sel_hi:[1,0] neg_lo:[0,1] neg_hi:[0,1]
  v_pk_add_f32 v[72:73], v[72:73], v[92:93] op_sel_hi:[1,0] neg_lo:[0,1] neg_hi:[0,1]
  v_pk_add_f32 v[74:75], v[74:75], v[92:93] op_sel_hi:[1,0] neg_lo:[0,1] neg_hi:[0,1]
  v_pk_add_f32 v[76:77], v[76:77], v[92:93] op_sel_hi:[1,0] neg_lo:[0,1] neg_hi:[0,1]
  v_pk_add_f32 v[78:79], v[78:79], v[92:93] op_sel_hi:[1,0] neg_lo:[0,1] neg_hi:[0,1]
  v_pk_add_f32 v[80:81], v[80:81], v[92:93] op_sel_hi:[1,0] neg_lo:[0,1] neg_hi:[0,1]
  v_pk_add_f32 v[82:83], v[82:83], v[92:93] op_sel_hi:[1,0] neg_lo:[0,1] neg_hi:[0,1]
  v_pk_add_f32 v[84:85], v[84:85], v[92:93] op_sel_hi:[1,0] neg_lo:[0,1] neg_hi:[0,1]
  v_pk_add_f32 v[86:87], v[86:87], v[92:93] op_sel_hi:[1,0] neg_lo:[0,1] neg_hi:[0,1]
  v_mov_b32 v104, 0
  v_mov_b32 v105, 0
  v_cvt_pk_bf16_f32 v8, v48, v49
  v_cvt_pk_bf16_f32 v9, v50, v51
  v_cvt_pk_bf16_f32 v10, v52, v53
  v_cvt_pk_bf16_f32 v11, v54, v55
  v_cvt_pk_bf16_f32 v12, v56, v57
  v_cvt_pk_bf16_f32 v13, v58, v59
  v_cvt_pk_bf16_f32 v14, v60, v61
  v_cvt_pk_bf16_f32 v15, v62, v63
  v_cvt_pk_bf16_f32 v16, v64, v65
  v_cvt_pk_bf16_f32 v17, v66, v67
  v_cvt_pk_bf16_f32 v18, v68, v69
  v_cvt_pk_bf16_f32 v19, v70, v71
  v_cvt_pk_bf16_f32 v20, v72, v73
  v_cvt_pk_bf16_f32 v21, v74, v75
  v_cvt_pk_bf16_f32 v22, v76, v77
  v_cvt_pk_bf16_f32 v23, v78, v79
  v_cvt_pk_bf16_f32 v24, v80, v81
  v_cvt_pk_bf16_f32 v25, v82, v83
  v_cvt_pk_bf16_f32 v26, v84, v85
  v_cvt_pk_bf16_f32 v27, v86, v87
  v_lshlrev_b32 v48, 16, v8
  v_and_b32 v49, s56, v8
  v_lshlrev_b32 v50, 16, v9
  v_and_b32 v51, s56, v9
  v_lshlrev_b32 v52, 16, v10
  v_and_b32 v53, s56, v10
  v_lshlrev_b32 v54, 16, v11
  v_and_b32 v55, s56, v11
  v_lshlrev_b32 v56, 16, v12
  v_and_b32 v57, s56, v12
  v_lshlrev_b32 v58, 16, v13
  v_and_b32 v59, s56, v13
  v_lshlrev_b32 v60, 16, v14
  v_and_b32 v61, s56, v14
  v_lshlrev_b32 v62, 16, v15
  v_and_b32 v63, s56, v15
  v_lshlrev_b32 v64, 16, v16
  v_and_b32 v65, s56, v16
  v_lshlrev_b32 v66, 16, v17
  v_and_b32 v67, s56, v17
  v_lshlrev_b32 v68, 16, v18
  v_and_b32 v69, s56, v18
  v_lshlrev_b32 v70, 16, v19
  v_and_b32 v71, s56, v19
  v_lshlrev_b32 v72, 16, v20
  v_and_b32 v73, s56, v20
  v_lshlrev_b32 v74, 16, v21
  v_and_b32 v75, s56, v21
  v_lshlrev_b32 v76, 16, v22
  v_and_b32 v77, s56, v22
  v_lshlrev_b32 v78, 16, v23
  v_and_b32 v79, s56, v23
  v_lshlrev_b32 v80, 16, v24
  v_and_b32 v81, s56, v24
  v_lshlrev_b32 v82, 16, v25
  v_and_b32 v83, s56, v25
  v_lshlrev_b32 v84, 16, v26
  v_and_b32 v85, s56, v26
  v_lshlrev_b32 v86, 16, v27
  v_and_b32 v87, s56, v27
  v_pk_mul_f32 v[48:49], v[48:49], v[100:101] op_sel_hi:[1,0]
  v_pk_mul_f32 v[50:51], v[50:51], v[100:101] op_sel_hi:[1,0]
  v_pk_mul_f32 v[52:53], v[52:53], v[100:101] op_sel_hi:[1,0]
  v_pk_mul_f32 v[54:55], v[54:55], v[100:101] op_sel_hi:[1,0]
  v_cvt_pk_bf16_f32 v8, v48, v49
  v_cvt_pk_bf16_f32 v9, v50, v51
  v_cvt_pk_bf16_f32 v10, v52, v53
  v_cvt_pk_bf16_f32 v11, v54, v55
  buffer_store_dwordx4 v[8:11], v5, s[24:27], s53 offen sc1
  s_add_u32 s53, s53, 16384
  v_pk_mul_f32 v[56:57], v[56:57], v[100:101] op_sel_hi:[1,0]
  v_pk_mul_f32 v[58:59], v[58:59], v[100:101] op_sel_hi:[1,0]
  v_pk_mul_f32 v[60:61], v[60:61], v[100:101] op_sel_hi:[1,0]
  v_pk_mul_f32 v[62:63], v[62:63], v[100:101] op_sel_hi:[1,0]
  v_cvt_pk_bf16_f32 v12, v56, v57
  v_cvt_pk_bf16_f32 v13, v58, v59
  v_cvt_pk_bf16_f32 v14, v60, v61
  v_cvt_pk_bf16_f32 v15, v62, v63
  buffer_store_dwordx4 v[12:15], v5, s[24:27], s53 offen sc1
  s_add_u32 s53, s53, 16384
  v_pk_mul_f32 v[64:65], v[64:65], v[100:101] op_sel_hi:[1,0]
  v_pk_mul_f32 v[66:67], v[66:67], v[100:101] op_sel_hi:[1,0]
  v_pk_mul_f32 v[68:69], v[68:69], v[100:101] op_sel_hi:[1,0]
  v_pk_mul_f32 v[70:71], v[70:71], v[100:101] op_sel_hi:[1,0]
  v_cvt_pk_bf16_f32 v16, v64, v65
  v_cvt_pk_bf16_f32 v17, v66, v67
  v_cvt_pk_bf16_f32 v18, v68, v69
  v_cvt_pk_bf16_f32 v19, v70, v71
  buffer_store_dwordx4 v[16:19], v5, s[24:27], s53 offen sc1
  s_add_u32 s53, s53, 16384
  v_pk_mul_f32 v[72:73], v[72:73], v[100:101] op_sel_hi:[1,0]
  v_pk_mul_f32 v[74:75], v[74:75], v[100:101] op_sel_hi:[1,0]
  v_pk_mul_f32 v[76:77], v[76:77], v[100:101] op_sel_hi:[1,0]
  v_pk_mul_f32 v[78:79], v[78:79], v[100:101] op_sel_hi:[1,0]
  v_cvt_pk_bf16_f32 v20, v72, v73
  v_cvt_pk_bf16_f32 v21, v74, v75
  v_cvt_pk_bf16_f32 v22, v76, v77
  v_cvt_pk_bf16_f32 v23, v78, v79
  buffer_store_dwordx4 v[20:23], v5, s[24:27], s53 offen sc1
  s_add_u32 s53, s53, 16384
  v_pk_mul_f32 v[80:81], v[80:81], v[100:101] op_sel_hi:[1,0]
  v_pk_mul_f32 v[82:83], v[82:83], v[100:101] op_sel_hi:[1,0]
  v_pk_mul_f32 v[84:85], v[84:85], v[100:101] op_sel_hi:[1,0]
  v_pk_mul_f32 v[86:87], v[86:87], v[100:101] op_sel_hi:[1,0]
  v_cvt_pk_bf16_f32 v24, v80, v81
  v_cvt_pk_bf16_f32 v25, v82, v83
  v_cvt_pk_bf16_f32 v26, v84, v85
  v_cvt_pk_bf16_f32 v27, v86, v87
  buffer_store_dwordx4 v[24:27], v5, s[24:27], s53 offen sc1
  s_add_u32 s53, s53, 16384
  s_waitcnt vmcnt(12)
  v_dot2_f32_bf16 v104, v8, v28, v104
  v_dot2_f32_bf16 v105, v9, v29, v105
  v_dot2_f32_bf16 v104, v10, v30, v104
  v_dot2_f32_bf16 v105, v11, v31, v105
  s_waitcnt vmcnt(11)
  v_dot2_f32_bf16 v104, v12, v32, v104
  v_dot2_f32_bf16 v105, v13, v33, v105
  v_dot2_f32_bf16 v104, v14, v34, v104
  v_dot2_f32_bf16 v105, v15, v35, v105
  s_waitcnt vmcnt(10)
  v_dot2_f32_bf16 v104, v16, v36, v104
  v_dot2_f32_bf16 v105, v17, v37, v105
  v_dot2_f32_bf16 v104, v18, v38, v104
  v_dot2_f32_bf16 v105, v19, v39, v105
  s_waitcnt vmcnt(9)
  v_dot2_f32_bf16 v104, v20, v40, v104
  v_dot2_f32_bf16 v105, v21, v41, v105
  v_dot2_f32_bf16 v104, v22, v42, v104
  v_dot2_f32_bf16 v105, v23, v43, v105
  s_waitcnt vmcnt(8)
  v_dot2_f32_bf16 v104, v24, v44, v104
  v_dot2_f32_bf16 v105, v25, v45, v105
  v_dot2_f32_bf16 v104, v26, v46, v104
  v_dot2_f32_bf16 v105, v27, v47, v105
  s_nop 2
  v_add_f32 v104, v104, v105
  s_nop 1
  v_add_f32_dpp v104, v104, v104 row_ror:8 row_mask:0xf bank_mask:0xf
  s_nop 1
  v_add_f32_dpp v104, v104, v104 row_ror:4 row_mask:0xf bank_mask:0xf
  s_nop 1
  v_add_f32_dpp v104, v104, v104 row_ror:2 row_mask:0xf bank_mask:0xf
  s_nop 1
  v_add_f32_dpp v104, v104, v104 row_ror:1 row_mask:0xf bank_mask:0xf
  v_cvt_pk_bf16_f32 v104, v104, v104
  v_lshlrev_b32 v104, 16, v104
  v_ashrrev_i32 v105, 31, v104
  v_or_b32 v105, 0x80000000, v105
  v_xor_b32 v104, v104, v105
  v_and_b32 v104, s56, v104
  v_add_u32 v6, s52, v1
  v_sub_u32 v7, 0xffff, v6
  v_or_b32 v104, v104, v7
  v_lshlrev_b32 v6, 2, v6
  v_lshl_add_u32 v6, v2, 26, v6
  s_mov_b32 s53, 2621440
  buffer_store_dword v104, v6, s[24:27], s53 offen sc1
  s_waitcnt vmcnt(0)
  s_branch front_join
front_fetch:
  s_getpc_b64 s[98:99]
attn_hot_pc:
  s_add_u32 s98, s98, attn_hot-attn_hot_pc
  s_addc_u32 s99, s99, 0
  s_lshr_b32 s100, s2, 3
  v_min_u32 v249, 17, v0
  v_lshlrev_b32 v249, 5, v249
  v_add_u32 v249, s100, v249
  v_lshlrev_b32 v249, 7, v249
  v_min_u32 v249, attn_end-attn_hot-4, v249
  global_load_dword v255, v249, s[98:99]
attn_hot:
  v_subrev_u32 v16, 0x40000, v238
  v_subrev_u32 v17, 0x40000, v239
  v_subrev_u32 v18, 0x40000, v240
  v_subrev_u32 v19, 0x40000, v241
  s_mov_b32 s31, 0
  s_add_u32 m0, s28, 90112
  s_nop 0
  buffer_load_dwordx4 v16, s[20:23], s31 offen offset:0 lds
  buffer_load_dwordx4 v17, s[20:23], s31 offen offset:1024 lds
  buffer_load_dwordx4 v18, s[20:23], s31 offen offset:2048 lds
  buffer_load_dwordx4 v19, s[20:23], s31 offen offset:3072 lds
  s_add_u32 m0, s28, 98304
  s_nop 0
  buffer_load_dwordx4 v238, s[20:23], s31 offen offset:0 lds
  buffer_load_dwordx4 v239, s[20:23], s31 offen offset:1024 lds
  buffer_load_dwordx4 v240, s[20:23], s31 offen offset:2048 lds
  buffer_load_dwordx4 v241, s[20:23], s31 offen offset:3072 lds
front_join:
  s_waitcnt lgkmcnt(0)
  s_barrier
  s_mul_i32 s55, s59, 0x9e3779b1
  s_add_u32 s55, s55, 0x7f4a7c15
  s_lshr_b32 s58, s37, 2
  s_lshl_b32 s58, s58, 8
  s_add_u32 s58, s58, 2826240
  s_lshl_b32 s53, s36, 2
  s_lshl_b32 s54, s3, 26
  s_add_u32 s53, s53, s54
  v_min_u32 v1, 1, v0
  v_lshlrev_b32 v1, 28, v1
  v_add_u32 v1, s53, v1
  v_mov_b32 v2, s55
  buffer_store_dword v2, v1, s[24:27], s58 offen sc1
  s_cmp_lt_u32 s3, 2
  s_cbranch_scc1 front_addr
  s_mov_b32 s31, 524288
  s_add_u32 m0, s28, 106496
  s_nop 0
  buffer_load_dwordx4 v16, s[20:23], s31 offen offset:0 lds
  buffer_load_dwordx4 v17, s[20:23], s31 offen offset:1024 lds
  buffer_load_dwordx4 v18, s[20:23], s31 offen offset:2048 lds
  buffer_load_dwordx4 v19, s[20:23], s31 offen offset:3072 lds
  s_add_u32 m0, s28, 114688
  s_nop 0
  buffer_load_dwordx4 v238, s[20:23], s31 offen offset:0 lds
  buffer_load_dwordx4 v239, s[20:23], s31 offen offset:1024 lds
  buffer_load_dwordx4 v240, s[20:23], s31 offen offset:2048 lds
  buffer_load_dwordx4 v241, s[20:23], s31 offen offset:3072 lds
  s_mov_b32 s31, 1048576
  s_add_u32 m0, s28, 24576
  s_nop 0
  buffer_load_dwordx4 v16, s[20:23], s31 offen offset:0 lds
  buffer_load_dwordx4 v17, s[20:23], s31 offen offset:1024 lds
  buffer_load_dwordx4 v18, s[20:23], s31 offen offset:2048 lds
  buffer_load_dwordx4 v19, s[20:23], s31 offen offset:3072 lds
  s_add_u32 m0, s28, 32768
  s_nop 0
  buffer_load_dwordx4 v238, s[20:23], s31 offen offset:0 lds
  buffer_load_dwordx4 v239, s[20:23], s31 offen offset:1024 lds
  buffer_load_dwordx4 v240, s[20:23], s31 offen offset:2048 lds
  buffer_load_dwordx4 v241, s[20:23], s31 offen offset:3072 lds
  s_mov_b32 s31, 1572864
  s_add_u32 m0, s28, 40960
  s_nop 0
  buffer_load_dwordx4 v16, s[20:23], s31 offen offset:0 lds
  buffer_load_dwordx4 v17, s[20:23], s31 offen offset:1024 lds
  buffer_load_dwordx4 v18, s[20:23], s31 offen offset:2048 lds
  buffer_load_dwordx4 v19, s[20:23], s31 offen offset:3072 lds
  s_add_u32 m0, s28, 49152
  s_nop 0
  buffer_load_dwordx4 v238, s[20:23], s31 offen offset:0 lds
  buffer_load_dwordx4 v239, s[20:23], s31 offen offset:1024 lds
  buffer_load_dwordx4 v240, s[20:23], s31 offen offset:2048 lds
  buffer_load_dwordx4 v241, s[20:23], s31 offen offset:3072 lds
front_addr:
  s_mov_b32 s31, 2097152
  v_lshlrev_b32 v242, 4, v245
  v_add_u32 v243, 0x1000, v242
  s_mul_i32 s30, s37, 81920
  s_lshl_b32 s38, s36, 19
  s_add_u32 s12, s4, s38
  s_addc_u32 s13, s5, 0
  s_mov_b32 s14, 524288
  s_mov_b32 s15, 0x20000
  s_add_u32 s16, s6, s38
  s_addc_u32 s17, s7, 0
  s_mov_b32 s18, 524288
  s_mov_b32 s19, 0x20000
  v_lshlrev_b32 v249, 8, v248
  v_add_u32 v249, s28, v249
  v_add_u32 v250, 0, v248
  v_xor_b32 v250, v250, v247
  v_lshl_add_u32 v232, v250, 4, v249
  v_add_u32 v250, 4, v248
  v_xor_b32 v250, v250, v247
  v_lshl_add_u32 v233, v250, 4, v249
  v_add_u32 v250, 8, v248
  v_xor_b32 v250, v250, v247
  v_lshl_add_u32 v234, v250, 4, v249
  v_add_u32 v250, 12, v248
  v_xor_b32 v250, v250, v247
  v_lshl_add_u32 v235, v250, 4, v249
  v_add_u32 v250, 0, v248
  v_lshlrev_b32 v250, 1, v250
  v_xor_b32 v250, v250, v247
  v_lshl_add_u32 v236, v250, 4, v249
  v_add_u32 v250, 4, v248
  v_lshlrev_b32 v250, 1, v250
  v_xor_b32 v250, v250, v247
  v_lshl_add_u32 v237, v250, 4, v249
  v_lshrrev_b32 v249, 1, v248
  v_and_b32 v250, 1, v248
  v_lshl_or_b32 v249, v250, 1, v249
  v_xor_b32 v249, v249, v247
  v_lshlrev_b32 v249, 4, v249
  v_lshl_add_u32 v212, v247, 8, v249
  v_xor_b32 v213, 64, v212
  v_xor_b32 v214, 128, v212
  v_xor_b32 v215, 192, v212
  v_bfe_u32 v246, v245, 2, 2
  v_and_b32 v247, 3, v245
  v_lshlrev_b32 v247, 3, v247
  v_add_u32 v247, 65536, v247
  v_lshl_add_u32 v249, v248, 2, v246
  v_and_b32 v250, 7, v249
  v_lshl_add_u32 v250, v250, 5, v247
  v_lshl_add_u32 v216, v249, 8, v250
  v_lshl_add_u32 v249, v248, 3, v246
  v_and_b32 v250, 1, v248
  v_lshl_add_u32 v250, v250, 2, v246
  v_lshl_add_u32 v250, v250, 5, v247
  v_lshl_add_u32 v224, v249, 8, v250
  v_xor_b32 v217, 32, v216
  v_xor_b32 v225, 32, v224
  v_xor_b32 v218, 64, v216
  v_xor_b32 v226, 64, v224
  v_xor_b32 v219, 96, v216
  v_xor_b32 v227, 96, v224
  v_xor_b32 v220, 128, v216
  v_xor_b32 v228, 128, v224
  v_xor_b32 v221, 160, v216
  v_xor_b32 v229, 160, v224
  v_xor_b32 v222, 192, v216
  v_xor_b32 v230, 192, v224
  v_xor_b32 v223, 224, v216
  v_xor_b32 v231, 224, v224
  v_subrev_u32 v148, 65536, v224
  v_subrev_u32 v149, 65536, v225
  v_subrev_u32 v150, 65536, v226
  v_subrev_u32 v151, 65536, v227
  v_subrev_u32 v152, 65536, v228
  v_subrev_u32 v153, 65536, v229
  v_subrev_u32 v154, 65536, v230
  v_subrev_u32 v155, 65536, v231
  s_lshr_b32 s38, s2, 3
  s_min_u32 s38, s38, 26
  s_and_b32 s39, s2, 7
  s_mul_i32 s39, s39, 27
  s_add_u32 s33, s38, s39
  s_mul_i32 s50, s3, 6144
  s_add_u32 s50, s50, 133120
  v_mov_b32 v244, v242
  s_lshl_b32 s40, s37, 19
  s_lshl_b32 s38, s36, 14
  s_add_u32 s40, s40, s38
  s_add_u32 s40, s40, 8388608
  s_add_u32 s41, s40, 4096
  s_add_u32 s42, s40, 8192
  s_add_u32 s43, s40, 12288
  s_mov_b32 s34, 0x3e0293ee
  s_mov_b32 s29, 0
  v_and_b32 v249, 15, v245
  v_cmp_eq_u32 vcc, 0, v249
  v_mov_b32 v249, 0x3f803f80
  s_nop 0
  v_cndmask_b32 v249, 0, v249, vcc
  v_accvgpr_write_b32 a208, v249
  v_accvgpr_write_b32 a209, v249
  v_accvgpr_write_b32 a210, v249
  v_accvgpr_write_b32 a211, v249
  v_and_b32 v2, 7, v0
  v_lshlrev_b32 v2, 2, v2
  s_lshl_b32 s54, s3, 5
  v_add_u32 v2, s54, v2
  s_mov_b32 s54, 32768
  buffer_load_dword v3, v2, s[24:27], s58 offen sc1
  s_sleep 2
  buffer_load_dword v4, v2, s[24:27], s58 offen sc1
  s_sleep 2
  buffer_load_dword v5, v2, s[24:27], s58 offen sc1
  s_sleep 2
front_poll:
  buffer_load_dword v6, v2, s[24:27], s58 offen sc1
  s_waitcnt vmcnt(3)
  v_cmp_ne_u32 vcc, s55, v3
  s_nop 0
  s_cbranch_vccz front_go
  s_sleep 2
  buffer_load_dword v3, v2, s[24:27], s58 offen sc1
  s_waitcnt vmcnt(3)
  v_cmp_ne_u32 vcc, s55, v4
  s_nop 0
  s_cbranch_vccz front_go
  s_sleep 2
  buffer_load_dword v4, v2, s[24:27], s58 offen sc1
  s_waitcnt vmcnt(3)
  v_cmp_ne_u32 vcc, s55, v5
  s_nop 0
  s_cbranch_vccz front_go
  s_sleep 2
  buffer_load_dword v5, v2, s[24:27], s58 offen sc1
  s_waitcnt vmcnt(3)
  v_cmp_ne_u32 vcc, s55, v6
  s_nop 0
  s_cbranch_vccz front_go
  s_sleep 2
  s_sub_u32 s54, s54, 1
  s_cmp_lg_u32 s54, 0
  s_cbranch_scc1 front_poll
front_go:
  buffer_load_dwordx4 a[0:3], v242, s[24:27], s30 offen offset:0 sc1
  buffer_load_dwordx4 a[4:7], v242, s[24:27], s30 offen offset:1024 sc1
  buffer_load_dwordx4 a[8:11], v242, s[24:27], s30 offen offset:2048 sc1
  buffer_load_dwordx4 a[12:15], v242, s[24:27], s30 offen offset:3072 sc1
  buffer_load_dwordx4 a[16:19], v243, s[24:27], s30 offen offset:0 sc1
  buffer_load_dwordx4 a[20:23], v243, s[24:27], s30 offen offset:1024 sc1
  buffer_load_dwordx4 a[24:27], v243, s[24:27], s30 offen offset:2048 sc1
  buffer_load_dwordx4 a[28:31], v243, s[24:27], s30 offen offset:3072 sc1
  s_add_u32 s30, s30, 8192
  buffer_load_dwordx4 a[32:35], v242, s[24:27], s30 offen offset:0 sc1
  buffer_load_dwordx4 a[36:39], v242, s[24:27], s30 offen offset:1024 sc1
  buffer_load_dwordx4 a[40:43], v242, s[24:27], s30 offen offset:2048 sc1
  buffer_load_dwordx4 a[44:47], v242, s[24:27], s30 offen offset:3072 sc1
  buffer_load_dwordx4 a[48:51], v243, s[24:27], s30 offen offset:0 sc1
  buffer_load_dwordx4 a[52:55], v243, s[24:27], s30 offen offset:1024 sc1
  buffer_load_dwordx4 a[56:59], v243, s[24:27], s30 offen offset:2048 sc1
  buffer_load_dwordx4 a[60:63], v243, s[24:27], s30 offen offset:3072 sc1
  s_add_u32 s30, s30, 8192
  v_lshrrev_b32 v140, 7, v242
  v_lshlrev_b32 v140, 8, v140
  v_and_b32 v136, 0x70, v242
  v_add_u32 v140, v140, v136
  s_mov_b32 s58, 2826240
  buffer_load_dwordx4 v[136:139], v140, s[24:27], s58 offen sc1
  s_barrier
  ds_read_b64_tr_b16 a[160:161], v224 offset:32768
  ds_read_b64_tr_b16 a[162:163], v224 offset:33792
  ds_read_b64_tr_b16 a[164:165], v224 offset:40960
  ds_read_b64_tr_b16 a[166:167], v224 offset:41984
  ds_read_b64_tr_b16 a[168:169], v225 offset:32768
  ds_read_b64_tr_b16 a[170:171], v225 offset:33792
  ds_read_b64_tr_b16 a[172:173], v225 offset:40960
  ds_read_b64_tr_b16 a[174:175], v225 offset:41984
  s_waitcnt vmcnt(9) lgkmcnt(4)
  v_mfma_f32_16x16x32_bf16 v[0:3], a[160:163], a[0:3], 0
  ds_read_b64_tr_b16 a[176:177], v226 offset:32768
  v_mfma_f32_16x16x32_bf16 v[0:3], a[164:167], a[16:19], v[0:3]
  buffer_load_dwordx4 a[64:67], v242, s[24:27], s30 offen offset:0 sc1
  v_mfma_f32_16x16x32_bf16 v[4:7], a[164:167], a[20:23], 0
  ds_read_b64_tr_b16 a[178:179], v226 offset:33792
  v_mfma_f32_16x16x32_bf16 v[4:7], a[160:163], a[4:7], v[4:7]
  buffer_load_dwordx4 a[68:71], v242, s[24:27], s30 offen offset:1024 sc1
  v_mfma_f32_16x16x32_bf16 v[8:11], a[160:163], a[8:11], 0
  ds_read_b64_tr_b16 a[180:181], v226 offset:40960
  v_mfma_f32_16x16x32_bf16 v[8:11], a[164:167], a[24:27], v[8:11]
  v_mfma_f32_16x16x32_bf16 v[12:15], a[164:167], a[28:31], 0
  ds_read_b64_tr_b16 a[182:183], v226 offset:41984
  v_mfma_f32_16x16x32_bf16 v[12:15], a[160:163], a[12:15], v[12:15]
  s_waitcnt lgkmcnt(4)
  buffer_load_dwordx4 a[72:75], v242, s[24:27], s30 offen offset:2048 sc1
  v_mfma_f32_16x16x32_bf16 v[16:19], a[168:171], a[0:3], 0
  ds_read_b64_tr_b16 a[184:185], v227 offset:32768
  v_mfma_f32_16x16x32_bf16 v[16:19], a[172:175], a[16:19], v[16:19]
  v_mfma_f32_16x16x32_bf16 v[20:23], a[172:175], a[20:23], 0
  ds_read_b64_tr_b16 a[186:187], v227 offset:33792
  v_mfma_f32_16x16x32_bf16 v[20:23], a[168:171], a[4:7], v[20:23]
  buffer_load_dwordx4 a[76:79], v242, s[24:27], s30 offen offset:3072 sc1
  v_mfma_f32_16x16x32_bf16 v[24:27], a[168:171], a[8:11], 0
  ds_read_b64_tr_b16 a[188:189], v227 offset:40960
  v_mfma_f32_16x16x32_bf16 v[24:27], a[172:175], a[24:27], v[24:27]
  buffer_load_dwordx4 a[80:83], v243, s[24:27], s30 offen offset:0 sc1
  v_mfma_f32_16x16x32_bf16 v[28:31], a[172:175], a[28:31], 0
  ds_read_b64_tr_b16 a[190:191], v227 offset:41984
  v_mfma_f32_16x16x32_bf16 v[28:31], a[168:171], a[12:15], v[28:31]
  s_waitcnt lgkmcnt(4)
  v_mfma_f32_16x16x32_bf16 v[32:35], a[176:179], a[0:3], 0
  ds_read_b64_tr_b16 a[160:161], v228 offset:32768
  v_mfma_f32_16x16x32_bf16 v[32:35], a[180:183], a[16:19], v[32:35]
  buffer_load_dwordx4 a[84:87], v243, s[24:27], s30 offen offset:1024 sc1
  v_mfma_f32_16x16x32_bf16 v[36:39], a[180:183], a[20:23], 0
  ds_read_b64_tr_b16 a[162:163], v228 offset:33792
  v_mfma_f32_16x16x32_bf16 v[36:39], a[176:179], a[4:7], v[36:39]
  v_mfma_f32_16x16x32_bf16 v[40:43], a[176:179], a[8:11], 0
  ds_read_b64_tr_b16 a[164:165], v228 offset:40960
  v_mfma_f32_16x16x32_bf16 v[40:43], a[180:183], a[24:27], v[40:43]
  buffer_load_dwordx4 a[88:91], v243, s[24:27], s30 offen offset:2048 sc1
  v_mfma_f32_16x16x32_bf16 v[44:47], a[180:183], a[28:31], 0
  ds_read_b64_tr_b16 a[166:167], v228 offset:41984
  v_mfma_f32_16x16x32_bf16 v[44:47], a[176:179], a[12:15], v[44:47]
  s_waitcnt lgkmcnt(4)
  buffer_load_dwordx4 a[92:95], v243, s[24:27], s30 offen offset:3072 sc1
  v_mfma_f32_16x16x32_bf16 v[48:51], a[184:187], a[0:3], 0
  ds_read_b64_tr_b16 a[168:169], v229 offset:32768
  v_mfma_f32_16x16x32_bf16 v[48:51], a[188:191], a[16:19], v[48:51]
  v_mfma_f32_16x16x32_bf16 v[52:55], a[188:191], a[20:23], 0
  ds_read_b64_tr_b16 a[170:171], v229 offset:33792
  v_mfma_f32_16x16x32_bf16 v[52:55], a[184:187], a[4:7], v[52:55]
  s_add_u32 s30, s30, 8192
  v_mfma_f32_16x16x32_bf16 v[56:59], a[184:187], a[8:11], 0
  ds_read_b64_tr_b16 a[172:173], v229 offset:40960
  v_mfma_f32_16x16x32_bf16 v[56:59], a[188:191], a[24:27], v[56:59]
  v_mfma_f32_16x16x32_bf16 v[60:63], a[188:191], a[28:31], 0
  ds_read_b64_tr_b16 a[174:175], v229 offset:41984
  v_mfma_f32_16x16x32_bf16 v[60:63], a[184:187], a[12:15], v[60:63]
  s_waitcnt lgkmcnt(4)
  buffer_load_dwordx4 a[96:99], v242, s[24:27], s30 offen offset:0 sc1
  v_mfma_f32_16x16x32_bf16 v[64:67], a[160:163], a[0:3], 0
  ds_read_b64_tr_b16 a[176:177], v230 offset:32768
  v_mfma_f32_16x16x32_bf16 v[64:67], a[164:167], a[16:19], v[64:67]
  buffer_load_dwordx4 a[100:103], v242, s[24:27], s30 offen offset:1024 sc1
  v_mfma_f32_16x16x32_bf16 v[68:71], a[164:167], a[20:23], 0
  ds_read_b64_tr_b16 a[178:179], v230 offset:33792
  v_mfma_f32_16x16x32_bf16 v[68:71], a[160:163], a[4:7], v[68:71]
  v_mfma_f32_16x16x32_bf16 v[72:75], a[160:163], a[8:11], 0
  ds_read_b64_tr_b16 a[180:181], v230 offset:40960
  v_mfma_f32_16x16x32_bf16 v[72:75], a[164:167], a[24:27], v[72:75]
  buffer_load_dwordx4 a[104:107], v242, s[24:27], s30 offen offset:2048 sc1
  v_mfma_f32_16x16x32_bf16 v[76:79], a[164:167], a[28:31], 0
  ds_read_b64_tr_b16 a[182:183], v230 offset:41984
  v_mfma_f32_16x16x32_bf16 v[76:79], a[160:163], a[12:15], v[76:79]
  s_waitcnt lgkmcnt(4)
  v_mfma_f32_16x16x32_bf16 v[80:83], a[168:171], a[0:3], 0
  ds_read_b64_tr_b16 a[184:185], v231 offset:32768
  v_mfma_f32_16x16x32_bf16 v[80:83], a[172:175], a[16:19], v[80:83]
  buffer_load_dwordx4 a[108:111], v242, s[24:27], s30 offen offset:3072 sc1
  v_mfma_f32_16x16x32_bf16 v[84:87], a[172:175], a[20:23], 0
  ds_read_b64_tr_b16 a[186:187], v231 offset:33792
  v_mfma_f32_16x16x32_bf16 v[84:87], a[168:171], a[4:7], v[84:87]
  buffer_load_dwordx4 a[112:115], v243, s[24:27], s30 offen offset:0 sc1
  v_mfma_f32_16x16x32_bf16 v[88:91], a[168:171], a[8:11], 0
  ds_read_b64_tr_b16 a[188:189], v231 offset:40960
  v_mfma_f32_16x16x32_bf16 v[88:91], a[172:175], a[24:27], v[88:91]
  s_barrier
  v_mfma_f32_16x16x32_bf16 v[92:95], a[172:175], a[28:31], 0
  ds_read_b64_tr_b16 a[190:191], v231 offset:41984
  v_mfma_f32_16x16x32_bf16 v[92:95], a[168:171], a[12:15], v[92:95]
  s_waitcnt lgkmcnt(4)
  buffer_load_dwordx4 a[116:119], v243, s[24:27], s30 offen offset:1024 sc1
  v_mfma_f32_16x16x32_bf16 v[96:99], a[176:179], a[0:3], 0
  ds_read_b64_tr_b16 a[160:161], v224 offset:49152
  v_mfma_f32_16x16x32_bf16 v[96:99], a[180:183], a[16:19], v[96:99]
  v_mfma_f32_16x16x32_bf16 v[100:103], a[180:183], a[20:23], 0
  ds_read_b64_tr_b16 a[162:163], v224 offset:50176
  v_mfma_f32_16x16x32_bf16 v[100:103], a[176:179], a[4:7], v[100:103]
  buffer_load_dwordx4 a[120:123], v243, s[24:27], s30 offen offset:2048 sc1
  v_mfma_f32_16x16x32_bf16 v[104:107], a[176:179], a[8:11], 0
  ds_read_b64_tr_b16 a[164:165], v224 offset:57344
  v_mfma_f32_16x16x32_bf16 v[104:107], a[180:183], a[24:27], v[104:107]
  buffer_load_dwordx4 a[124:127], v243, s[24:27], s30 offen offset:3072 sc1
  v_mfma_f32_16x16x32_bf16 v[108:111], a[180:183], a[28:31], 0
  ds_read_b64_tr_b16 a[166:167], v224 offset:58368
  v_mfma_f32_16x16x32_bf16 v[108:111], a[176:179], a[12:15], v[108:111]
  s_waitcnt lgkmcnt(4)
  v_mfma_f32_16x16x32_bf16 v[112:115], a[184:187], a[0:3], 0
  ds_read_b64_tr_b16 a[168:169], v225 offset:49152
  v_mfma_f32_16x16x32_bf16 v[112:115], a[188:191], a[16:19], v[112:115]
  s_add_u32 s30, s30, 8192
  v_mfma_f32_16x16x32_bf16 v[116:119], a[188:191], a[20:23], 0
  ds_read_b64_tr_b16 a[170:171], v225 offset:50176
  v_mfma_f32_16x16x32_bf16 v[116:119], a[184:187], a[4:7], v[116:119]
  v_mfma_f32_16x16x32_bf16 v[120:123], a[184:187], a[8:11], 0
  ds_read_b64_tr_b16 a[172:173], v225 offset:57344
  v_mfma_f32_16x16x32_bf16 v[120:123], a[188:191], a[24:27], v[120:123]
  v_mfma_f32_16x16x32_bf16 v[124:127], a[188:191], a[28:31], 0
  ds_read_b64_tr_b16 a[174:175], v225 offset:58368
  v_mfma_f32_16x16x32_bf16 v[124:127], a[184:187], a[12:15], v[124:127]
  s_waitcnt vmcnt(17) lgkmcnt(4)
  v_mfma_f32_16x16x32_bf16 v[0:3], a[160:163], a[32:35], v[0:3]
  ds_read_b64_tr_b16 a[176:177], v226 offset:49152
  v_mfma_f32_16x16x32_bf16 v[0:3], a[164:167], a[48:51], v[0:3]
  buffer_load_dwordx4 a[0:3], v242, s[24:27], s30 offen offset:0 sc1
  v_mfma_f32_16x16x32_bf16 v[4:7], a[164:167], a[52:55], v[4:7]
  ds_read_b64_tr_b16 a[178:179], v226 offset:50176
  v_mfma_f32_16x16x32_bf16 v[4:7], a[160:163], a[36:39], v[4:7]
  v_mfma_f32_16x16x32_bf16 v[8:11], a[160:163], a[40:43], v[8:11]
  ds_read_b64_tr_b16 a[180:181], v226 offset:57344
  s_add_u32 m0, s28, 16384
  v_mfma_f32_16x16x32_bf16 v[8:11], a[164:167], a[56:59], v[8:11]
  buffer_load_dwordx4 v238, s[20:23], s31 offen offset:0 lds
  v_mfma_f32_16x16x32_bf16 v[12:15], a[164:167], a[60:63], v[12:15]
  ds_read_b64_tr_b16 a[182:183], v226 offset:58368
  v_mfma_f32_16x16x32_bf16 v[12:15], a[160:163], a[44:47], v[12:15]
  s_waitcnt lgkmcnt(4)
  v_mfma_f32_16x16x32_bf16 v[16:19], a[168:171], a[32:35], v[16:19]
  ds_read_b64_tr_b16 a[184:185], v227 offset:49152
  v_mfma_f32_16x16x32_bf16 v[16:19], a[172:175], a[48:51], v[16:19]
  buffer_load_dwordx4 a[4:7], v242, s[24:27], s30 offen offset:1024 sc1
  v_mfma_f32_16x16x32_bf16 v[20:23], a[172:175], a[52:55], v[20:23]
  ds_read_b64_tr_b16 a[186:187], v227 offset:50176
  v_mfma_f32_16x16x32_bf16 v[20:23], a[168:171], a[36:39], v[20:23]
  v_mfma_f32_16x16x32_bf16 v[24:27], a[168:171], a[40:43], v[24:27]
  ds_read_b64_tr_b16 a[188:189], v227 offset:57344
  v_mfma_f32_16x16x32_bf16 v[24:27], a[172:175], a[56:59], v[24:27]
  v_mfma_f32_16x16x32_bf16 v[28:31], a[172:175], a[60:63], v[28:31]
  ds_read_b64_tr_b16 a[190:191], v227 offset:58368
  v_mfma_f32_16x16x32_bf16 v[28:31], a[168:171], a[44:47], v[28:31]
  s_waitcnt lgkmcnt(4)
  v_mfma_f32_16x16x32_bf16 v[32:35], a[176:179], a[32:35], v[32:35]
  ds_read_b64_tr_b16 a[160:161], v228 offset:49152
  v_mfma_f32_16x16x32_bf16 v[32:35], a[180:183], a[48:51], v[32:35]
  buffer_load_dwordx4 a[8:11], v242, s[24:27], s30 offen offset:2048 sc1
  v_mfma_f32_16x16x32_bf16 v[36:39], a[180:183], a[52:55], v[36:39]
  ds_read_b64_tr_b16 a[162:163], v228 offset:50176
  v_mfma_f32_16x16x32_bf16 v[36:39], a[176:179], a[36:39], v[36:39]
  v_mfma_f32_16x16x32_bf16 v[40:43], a[176:179], a[40:43], v[40:43]
  ds_read_b64_tr_b16 a[164:165], v228 offset:57344
  v_mfma_f32_16x16x32_bf16 v[40:43], a[180:183], a[56:59], v[40:43]
  buffer_load_dwordx4 v239, s[20:23], s31 offen offset:1024 lds
  v_mfma_f32_16x16x32_bf16 v[44:47], a[180:183], a[60:63], v[44:47]
  ds_read_b64_tr_b16 a[166:167], v228 offset:58368
  v_mfma_f32_16x16x32_bf16 v[44:47], a[176:179], a[44:47], v[44:47]
  s_waitcnt lgkmcnt(4)
  v_mfma_f32_16x16x32_bf16 v[48:51], a[184:187], a[32:35], v[48:51]
  ds_read_b64_tr_b16 a[168:169], v229 offset:49152
  v_mfma_f32_16x16x32_bf16 v[48:51], a[188:191], a[48:51], v[48:51]
  buffer_load_dwordx4 a[12:15], v242, s[24:27], s30 offen offset:3072 sc1
  v_mfma_f32_16x16x32_bf16 v[52:55], a[188:191], a[52:55], v[52:55]
  ds_read_b64_tr_b16 a[170:171], v229 offset:50176
  v_mfma_f32_16x16x32_bf16 v[52:55], a[184:187], a[36:39], v[52:55]
  v_mfma_f32_16x16x32_bf16 v[56:59], a[184:187], a[40:43], v[56:59]
  ds_read_b64_tr_b16 a[172:173], v229 offset:57344
  v_mfma_f32_16x16x32_bf16 v[56:59], a[188:191], a[56:59], v[56:59]
  v_mfma_f32_16x16x32_bf16 v[60:63], a[188:191], a[60:63], v[60:63]
  ds_read_b64_tr_b16 a[174:175], v229 offset:58368
  v_mfma_f32_16x16x32_bf16 v[60:63], a[184:187], a[44:47], v[60:63]
  s_waitcnt lgkmcnt(4)
  v_mfma_f32_16x16x32_bf16 v[64:67], a[160:163], a[32:35], v[64:67]
  ds_read_b64_tr_b16 a[176:177], v230 offset:49152
  v_mfma_f32_16x16x32_bf16 v[64:67], a[164:167], a[48:51], v[64:67]
  buffer_load_dwordx4 a[16:19], v243, s[24:27], s30 offen offset:0 sc1
  v_mfma_f32_16x16x32_bf16 v[68:71], a[164:167], a[52:55], v[68:71]
  ds_read_b64_tr_b16 a[178:179], v230 offset:50176
  v_mfma_f32_16x16x32_bf16 v[68:71], a[160:163], a[36:39], v[68:71]
  v_mfma_f32_16x16x32_bf16 v[72:75], a[160:163], a[40:43], v[72:75]
  ds_read_b64_tr_b16 a[180:181], v230 offset:57344
  v_mfma_f32_16x16x32_bf16 v[72:75], a[164:167], a[56:59], v[72:75]
  buffer_load_dwordx4 v240, s[20:23], s31 offen offset:2048 lds
  v_mfma_f32_16x16x32_bf16 v[76:79], a[164:167], a[60:63], v[76:79]
  ds_read_b64_tr_b16 a[182:183], v230 offset:58368
  v_mfma_f32_16x16x32_bf16 v[76:79], a[160:163], a[44:47], v[76:79]
  s_waitcnt lgkmcnt(4)
  v_mfma_f32_16x16x32_bf16 v[80:83], a[168:171], a[32:35], v[80:83]
  ds_read_b64_tr_b16 a[184:185], v231 offset:49152
  v_mfma_f32_16x16x32_bf16 v[80:83], a[172:175], a[48:51], v[80:83]
  buffer_load_dwordx4 a[20:23], v243, s[24:27], s30 offen offset:1024 sc1
  v_mfma_f32_16x16x32_bf16 v[84:87], a[172:175], a[52:55], v[84:87]
  ds_read_b64_tr_b16 a[186:187], v231 offset:50176
  v_mfma_f32_16x16x32_bf16 v[84:87], a[168:171], a[36:39], v[84:87]
  v_mfma_f32_16x16x32_bf16 v[88:91], a[168:171], a[40:43], v[88:91]
  ds_read_b64_tr_b16 a[188:189], v231 offset:57344
  v_mfma_f32_16x16x32_bf16 v[88:91], a[172:175], a[56:59], v[88:91]
  s_barrier
  v_mfma_f32_16x16x32_bf16 v[92:95], a[172:175], a[60:63], v[92:95]
  ds_read_b64_tr_b16 a[190:191], v231 offset:58368
  v_mfma_f32_16x16x32_bf16 v[92:95], a[168:171], a[44:47], v[92:95]
  s_waitcnt lgkmcnt(4)
  v_mfma_f32_16x16x32_bf16 v[96:99], a[176:179], a[32:35], v[96:99]
  ds_read_b64_tr_b16 a[160:161], v148 offset:32768
  v_mfma_f32_16x16x32_bf16 v[96:99], a[180:183], a[48:51], v[96:99]
  buffer_load_dwordx4 a[24:27], v243, s[24:27], s30 offen offset:2048 sc1
  v_mfma_f32_16x16x32_bf16 v[100:103], a[180:183], a[52:55], v[100:103]
  ds_read_b64_tr_b16 a[162:163], v148 offset:33792
  v_mfma_f32_16x16x32_bf16 v[100:103], a[176:179], a[36:39], v[100:103]
  v_mfma_f32_16x16x32_bf16 v[104:107], a[176:179], a[40:43], v[104:107]
  ds_read_b64_tr_b16 a[164:165], v148 offset:40960
  v_mfma_f32_16x16x32_bf16 v[104:107], a[180:183], a[56:59], v[104:107]
  buffer_load_dwordx4 v241, s[20:23], s31 offen offset:3072 lds
  s_add_u32 s31, s31, 0x80000
  v_mfma_f32_16x16x32_bf16 v[108:111], a[180:183], a[60:63], v[108:111]
  ds_read_b64_tr_b16 a[166:167], v148 offset:41984
  v_mfma_f32_16x16x32_bf16 v[108:111], a[176:179], a[44:47], v[108:111]
  s_waitcnt lgkmcnt(4)
  v_mfma_f32_16x16x32_bf16 v[112:115], a[184:187], a[32:35], v[112:115]
  ds_read_b64_tr_b16 a[168:169], v149 offset:32768
  v_mfma_f32_16x16x32_bf16 v[112:115], a[188:191], a[48:51], v[112:115]
  buffer_load_dwordx4 a[28:31], v243, s[24:27], s30 offen offset:3072 sc1
  s_add_u32 s30, s30, 8192
  v_mfma_f32_16x16x32_bf16 v[116:119], a[188:191], a[52:55], v[116:119]
  ds_read_b64_tr_b16 a[170:171], v149 offset:33792
  v_mfma_f32_16x16x32_bf16 v[116:119], a[184:187], a[36:39], v[116:119]
  v_mfma_f32_16x16x32_bf16 v[120:123], a[184:187], a[40:43], v[120:123]
  ds_read_b64_tr_b16 a[172:173], v149 offset:40960
  v_mfma_f32_16x16x32_bf16 v[120:123], a[188:191], a[56:59], v[120:123]
  v_mfma_f32_16x16x32_bf16 v[124:127], a[188:191], a[60:63], v[124:127]
  ds_read_b64_tr_b16 a[174:175], v149 offset:41984
  v_mfma_f32_16x16x32_bf16 v[124:127], a[184:187], a[44:47], v[124:127]
  s_waitcnt vmcnt(20) lgkmcnt(4)
  v_xor_b32 v136, s55, v136
  v_xor_b32 v137, s55, v137
  v_xor_b32 v138, s55, v138
  v_xor_b32 v139, s55, v139
  v_or3_b32 v136, v136, v137, v138
  v_or_b32 v136, v136, v139
  v_cmp_ne_u32 vcc, 0, v136
  s_nop 0
  s_cbranch_vccz front_keys
  s_mov_b32 s54, 32768
front_all:
  s_sleep 2
  buffer_load_dwordx4 v[136:139], v140, s[24:27], s58 offen sc1
  s_waitcnt vmcnt(0)
  v_xor_b32 v136, s55, v136
  v_xor_b32 v137, s55, v137
  v_xor_b32 v138, s55, v138
  v_xor_b32 v139, s55, v139
  v_or3_b32 v136, v136, v137, v138
  v_or_b32 v136, v136, v139
  v_cmp_ne_u32 vcc, 0, v136
  s_nop 0
  s_cbranch_vccz front_keys
  s_sub_u32 s54, s54, 1
  s_cmp_lg_u32 s54, 0
  s_cbranch_scc1 front_all
front_keys:
  s_lshl_b32 s35, s3, 11
  s_add_u32 s35, s35, 2621440
  buffer_load_dwordx4 v[128:131], v242, s[24:27], s35 offen sc1
  buffer_load_dwordx4 v[132:135], v242, s[24:27], s35 offen offset:1024 sc1
  v_mfma_f32_16x16x32_bf16 v[0:3], a[160:163], a[64:67], v[0:3]
  ds_read_b64_tr_b16 a[176:177], v150 offset:32768
  s_add_u32 s59, s59, 1
  s_or_b32 s54, s2, s3
  s_min_u32 s54, s54, 1
  v_mfma_f32_16x16x32_bf16 v[0:3], a[164:167], a[80:83], v[0:3]
  buffer_load_dwordx4 a[32:35], v242, s[24:27], s30 offen offset:0 sc1
  s_lshl_b32 s54, s54, 28
  v_mfma_f32_16x16x32_bf16 v[4:7], a[164:167], a[84:87], v[4:7]
  ds_read_b64_tr_b16 a[178:179], v150 offset:33792
  v_lshlrev_b32 v137, 22, v242
  v_mfma_f32_16x16x32_bf16 v[4:7], a[160:163], a[68:71], v[4:7]
  v_or_b32 v137, s54, v137
  v_mov_b32 v136, s59
  v_mfma_f32_16x16x32_bf16 v[8:11], a[160:163], a[72:75], v[8:11]
  ds_read_b64_tr_b16 a[180:181], v150 offset:40960
  s_add_u32 m0, s28, 0
  s_mov_b32 s58, 2830336
  buffer_store_dword v136, v137, s[24:27], s58 offen sc1
  v_mfma_f32_16x16x32_bf16 v[8:11], a[164:167], a[88:91], v[8:11]
  buffer_load_dwordx4 v238, s[20:23], s31 offen offset:0 lds
  v_mfma_f32_16x16x32_bf16 v[12:15], a[164:167], a[92:95], v[12:15]
  ds_read_b64_tr_b16 a[182:183], v150 offset:41984
  v_mfma_f32_16x16x32_bf16 v[12:15], a[160:163], a[76:79], v[12:15]
  s_waitcnt lgkmcnt(4)
  v_mfma_f32_16x16x32_bf16 v[16:19], a[168:171], a[64:67], v[16:19]
  ds_read_b64_tr_b16 a[184:185], v151 offset:32768
  v_mfma_f32_16x16x32_bf16 v[16:19], a[172:175], a[80:83], v[16:19]
  buffer_load_dwordx4 a[36:39], v242, s[24:27], s30 offen offset:1024 sc1
  v_mfma_f32_16x16x32_bf16 v[20:23], a[172:175], a[84:87], v[20:23]
  ds_read_b64_tr_b16 a[186:187], v151 offset:33792
  v_mfma_f32_16x16x32_bf16 v[20:23], a[168:171], a[68:71], v[20:23]
  v_mfma_f32_16x16x32_bf16 v[24:27], a[168:171], a[72:75], v[24:27]
  ds_read_b64_tr_b16 a[188:189], v151 offset:40960
  v_mfma_f32_16x16x32_bf16 v[24:27], a[172:175], a[88:91], v[24:27]
  v_mfma_f32_16x16x32_bf16 v[28:31], a[172:175], a[92:95], v[28:31]
  ds_read_b64_tr_b16 a[190:191], v151 offset:41984
  v_mfma_f32_16x16x32_bf16 v[28:31], a[168:171], a[76:79], v[28:31]
  s_waitcnt lgkmcnt(4)
  v_mfma_f32_16x16x32_bf16 v[32:35], a[176:179], a[64:67], v[32:35]
  ds_read_b64_tr_b16 a[160:161], v152 offset:32768
  v_mfma_f32_16x16x32_bf16 v[32:35], a[180:183], a[80:83], v[32:35]
  buffer_load_dwordx4 a[40:43], v242, s[24:27], s30 offen offset:2048 sc1
  v_mfma_f32_16x16x32_bf16 v[36:39], a[180:183], a[84:87], v[36:39]
  ds_read_b64_tr_b16 a[162:163], v152 offset:33792
  v_mfma_f32_16x16x32_bf16 v[36:39], a[176:179], a[68:71], v[36:39]
  v_mfma_f32_16x16x32_bf16 v[40:43], a[176:179], a[72:75], v[40:43]
  ds_read_b64_tr_b16 a[164:165], v152 offset:40960
  v_mfma_f32_16x16x32_bf16 v[40:43], a[180:183], a[88:91], v[40:43]
  buffer_load_dwordx4 v239, s[20:23], s31 offen offset:1024 lds
  v_mfma_f32_16x16x32_bf16 v[44:47], a[180:183], a[92:95], v[44:47]
  ds_read_b64_tr_b16 a[166:167], v152 offset:41984
  v_mfma_f32_16x16x32_bf16 v[44:47], a[176:179], a[76:79], v[44:47]
  s_waitcnt lgkmcnt(4)
  v_mfma_f32_16x16x32_bf16 v[48:51], a[184:187], a[64:67], v[48:51]
  ds_read_b64_tr_b16 a[168:169], v153 offset:32768
  v_mfma_f32_16x16x32_bf16 v[48:51], a[188:191], a[80:83], v[48:51]
  buffer_load_dwordx4 a[44:47], v242, s[24:27], s30 offen offset:3072 sc1
  v_mfma_f32_16x16x32_bf16 v[52:55], a[188:191], a[84:87], v[52:55]
  ds_read_b64_tr_b16 a[170:171], v153 offset:33792
  v_mfma_f32_16x16x32_bf16 v[52:55], a[184:187], a[68:71], v[52:55]
  v_mfma_f32_16x16x32_bf16 v[56:59], a[184:187], a[72:75], v[56:59]
  ds_read_b64_tr_b16 a[172:173], v153 offset:40960
  v_mfma_f32_16x16x32_bf16 v[56:59], a[188:191], a[88:91], v[56:59]
  v_mfma_f32_16x16x32_bf16 v[60:63], a[188:191], a[92:95], v[60:63]
  ds_read_b64_tr_b16 a[174:175], v153 offset:41984
  v_mfma_f32_16x16x32_bf16 v[60:63], a[184:187], a[76:79], v[60:63]
  s_waitcnt lgkmcnt(4)
  v_mfma_f32_16x16x32_bf16 v[64:67], a[160:163], a[64:67], v[64:67]
  ds_read_b64_tr_b16 a[176:177], v154 offset:32768
  v_mfma_f32_16x16x32_bf16 v[64:67], a[164:167], a[80:83], v[64:67]
  buffer_load_dwordx4 a[48:51], v243, s[24:27], s30 offen offset:0 sc1
  v_mfma_f32_16x16x32_bf16 v[68:71], a[164:167], a[84:87], v[68:71]
  ds_read_b64_tr_b16 a[178:179], v154 offset:33792
  v_mfma_f32_16x16x32_bf16 v[68:71], a[160:163], a[68:71], v[68:71]
  v_mfma_f32_16x16x32_bf16 v[72:75], a[160:163], a[72:75], v[72:75]
  ds_read_b64_tr_b16 a[180:181], v154 offset:40960
  v_mfma_f32_16x16x32_bf16 v[72:75], a[164:167], a[88:91], v[72:75]
  buffer_load_dwordx4 v240, s[20:23], s31 offen offset:2048 lds
  v_mfma_f32_16x16x32_bf16 v[76:79], a[164:167], a[92:95], v[76:79]
  ds_read_b64_tr_b16 a[182:183], v154 offset:41984
  v_mfma_f32_16x16x32_bf16 v[76:79], a[160:163], a[76:79], v[76:79]
  s_waitcnt lgkmcnt(4)
  v_mfma_f32_16x16x32_bf16 v[80:83], a[168:171], a[64:67], v[80:83]
  ds_read_b64_tr_b16 a[184:185], v155 offset:32768
  v_mfma_f32_16x16x32_bf16 v[80:83], a[172:175], a[80:83], v[80:83]
  buffer_load_dwordx4 a[52:55], v243, s[24:27], s30 offen offset:1024 sc1
  v_mfma_f32_16x16x32_bf16 v[84:87], a[172:175], a[84:87], v[84:87]
  ds_read_b64_tr_b16 a[186:187], v155 offset:33792
  v_mfma_f32_16x16x32_bf16 v[84:87], a[168:171], a[68:71], v[84:87]
  v_mfma_f32_16x16x32_bf16 v[88:91], a[168:171], a[72:75], v[88:91]
  ds_read_b64_tr_b16 a[188:189], v155 offset:40960
  v_mfma_f32_16x16x32_bf16 v[88:91], a[172:175], a[88:91], v[88:91]
  s_barrier
  v_mfma_f32_16x16x32_bf16 v[92:95], a[172:175], a[92:95], v[92:95]
  ds_read_b64_tr_b16 a[190:191], v155 offset:41984
  v_mfma_f32_16x16x32_bf16 v[92:95], a[168:171], a[76:79], v[92:95]
  s_waitcnt lgkmcnt(4)
  v_mfma_f32_16x16x32_bf16 v[96:99], a[176:179], a[64:67], v[96:99]
  ds_read_b64_tr_b16 a[160:161], v148 offset:49152
  v_mfma_f32_16x16x32_bf16 v[96:99], a[180:183], a[80:83], v[96:99]
  buffer_load_dwordx4 a[56:59], v243, s[24:27], s30 offen offset:2048 sc1
  v_mfma_f32_16x16x32_bf16 v[100:103], a[180:183], a[84:87], v[100:103]
  ds_read_b64_tr_b16 a[162:163], v148 offset:50176
  v_mfma_f32_16x16x32_bf16 v[100:103], a[176:179], a[68:71], v[100:103]
  v_mfma_f32_16x16x32_bf16 v[104:107], a[176:179], a[72:75], v[104:107]
  ds_read_b64_tr_b16 a[164:165], v148 offset:57344
  v_mfma_f32_16x16x32_bf16 v[104:107], a[180:183], a[88:91], v[104:107]
  buffer_load_dwordx4 v241, s[20:23], s31 offen offset:3072 lds
  s_add_u32 s31, s31, 0x80000
  v_mfma_f32_16x16x32_bf16 v[108:111], a[180:183], a[92:95], v[108:111]
  ds_read_b64_tr_b16 a[166:167], v148 offset:58368
  v_mfma_f32_16x16x32_bf16 v[108:111], a[176:179], a[76:79], v[108:111]
  s_waitcnt lgkmcnt(4)
  v_mfma_f32_16x16x32_bf16 v[112:115], a[184:187], a[64:67], v[112:115]
  ds_read_b64_tr_b16 a[168:169], v149 offset:49152
  v_mfma_f32_16x16x32_bf16 v[112:115], a[188:191], a[80:83], v[112:115]
  buffer_load_dwordx4 a[60:63], v243, s[24:27], s30 offen offset:3072 sc1
  s_add_u32 s30, s30, 8192
  v_mfma_f32_16x16x32_bf16 v[116:119], a[188:191], a[84:87], v[116:119]
  ds_read_b64_tr_b16 a[170:171], v149 offset:50176
  v_mfma_f32_16x16x32_bf16 v[116:119], a[184:187], a[68:71], v[116:119]
  v_mfma_f32_16x16x32_bf16 v[120:123], a[184:187], a[72:75], v[120:123]
  ds_read_b64_tr_b16 a[172:173], v149 offset:57344
  v_mfma_f32_16x16x32_bf16 v[120:123], a[188:191], a[88:91], v[120:123]
  v_mfma_f32_16x16x32_bf16 v[124:127], a[188:191], a[92:95], v[124:127]
  ds_read_b64_tr_b16 a[174:175], v149 offset:58368
  v_mfma_f32_16x16x32_bf16 v[124:127], a[184:187], a[76:79], v[124:127]
  s_waitcnt vmcnt(27) lgkmcnt(4)
  v_mfma_f32_16x16x32_bf16 v[0:3], a[160:163], a[96:99], v[0:3]
  ds_read_b64_tr_b16 a[176:177], v150 offset:49152
  v_mfma_f32_16x16x32_bf16 v[0:3], a[164:167], a[112:115], v[0:3]
  buffer_load_dwordx4 a[64:67], v242, s[24:27], s30 offen offset:0 sc1
  v_mfma_f32_16x16x32_bf16 v[4:7], a[164:167], a[116:119], v[4:7]
  ds_read_b64_tr_b16 a[178:179], v150 offset:50176
  v_mfma_f32_16x16x32_bf16 v[4:7], a[160:163], a[100:103], v[4:7]
  v_mfma_f32_16x16x32_bf16 v[8:11], a[160:163], a[104:107], v[8:11]
  ds_read_b64_tr_b16 a[180:181], v150 offset:57344
  s_add_u32 m0, s28, 65536
  v_mfma_f32_16x16x32_bf16 v[8:11], a[164:167], a[120:123], v[8:11]
  buffer_load_dwordx4 v238, s[20:23], s31 offen offset:0 lds
  v_mfma_f32_16x16x32_bf16 v[12:15], a[164:167], a[124:127], v[12:15]
  ds_read_b64_tr_b16 a[182:183], v150 offset:58368
  v_mfma_f32_16x16x32_bf16 v[12:15], a[160:163], a[108:111], v[12:15]
  s_waitcnt lgkmcnt(4)
  v_mfma_f32_16x16x32_bf16 v[16:19], a[168:171], a[96:99], v[16:19]
  ds_read_b64_tr_b16 a[184:185], v151 offset:49152
  v_mfma_f32_16x16x32_bf16 v[16:19], a[172:175], a[112:115], v[16:19]
  buffer_load_dwordx4 a[68:71], v242, s[24:27], s30 offen offset:1024 sc1
  v_mfma_f32_16x16x32_bf16 v[20:23], a[172:175], a[116:119], v[20:23]
  ds_read_b64_tr_b16 a[186:187], v151 offset:50176
  v_mfma_f32_16x16x32_bf16 v[20:23], a[168:171], a[100:103], v[20:23]
  v_mfma_f32_16x16x32_bf16 v[24:27], a[168:171], a[104:107], v[24:27]
  ds_read_b64_tr_b16 a[188:189], v151 offset:57344
  v_mfma_f32_16x16x32_bf16 v[24:27], a[172:175], a[120:123], v[24:27]
  v_mfma_f32_16x16x32_bf16 v[28:31], a[172:175], a[124:127], v[28:31]
  ds_read_b64_tr_b16 a[190:191], v151 offset:58368
  v_mfma_f32_16x16x32_bf16 v[28:31], a[168:171], a[108:111], v[28:31]
  s_waitcnt lgkmcnt(4)
  v_mfma_f32_16x16x32_bf16 v[32:35], a[176:179], a[96:99], v[32:35]
  ds_read_b64_tr_b16 a[160:161], v152 offset:49152
  v_mfma_f32_16x16x32_bf16 v[32:35], a[180:183], a[112:115], v[32:35]
  buffer_load_dwordx4 a[72:75], v242, s[24:27], s30 offen offset:2048 sc1
  v_mfma_f32_16x16x32_bf16 v[36:39], a[180:183], a[116:119], v[36:39]
  ds_read_b64_tr_b16 a[162:163], v152 offset:50176
  v_mfma_f32_16x16x32_bf16 v[36:39], a[176:179], a[100:103], v[36:39]
  v_mfma_f32_16x16x32_bf16 v[40:43], a[176:179], a[104:107], v[40:43]
  ds_read_b64_tr_b16 a[164:165], v152 offset:57344
  v_mfma_f32_16x16x32_bf16 v[40:43], a[180:183], a[120:123], v[40:43]
  buffer_load_dwordx4 v239, s[20:23], s31 offen offset:1024 lds
  v_mfma_f32_16x16x32_bf16 v[44:47], a[180:183], a[124:127], v[44:47]
  ds_read_b64_tr_b16 a[166:167], v152 offset:58368
  v_mfma_f32_16x16x32_bf16 v[44:47], a[176:179], a[108:111], v[44:47]
  s_waitcnt lgkmcnt(4)
  v_mfma_f32_16x16x32_bf16 v[48:51], a[184:187], a[96:99], v[48:51]
  ds_read_b64_tr_b16 a[168:169], v153 offset:49152
  v_mfma_f32_16x16x32_bf16 v[48:51], a[188:191], a[112:115], v[48:51]
  buffer_load_dwordx4 a[76:79], v242, s[24:27], s30 offen offset:3072 sc1
  v_mfma_f32_16x16x32_bf16 v[52:55], a[188:191], a[116:119], v[52:55]
  ds_read_b64_tr_b16 a[170:171], v153 offset:50176
  v_mfma_f32_16x16x32_bf16 v[52:55], a[184:187], a[100:103], v[52:55]
  v_mfma_f32_16x16x32_bf16 v[56:59], a[184:187], a[104:107], v[56:59]
  ds_read_b64_tr_b16 a[172:173], v153 offset:57344
  v_mfma_f32_16x16x32_bf16 v[56:59], a[188:191], a[120:123], v[56:59]
  v_mfma_f32_16x16x32_bf16 v[60:63], a[188:191], a[124:127], v[60:63]
  ds_read_b64_tr_b16 a[174:175], v153 offset:58368
  v_mfma_f32_16x16x32_bf16 v[60:63], a[184:187], a[108:111], v[60:63]
  s_waitcnt lgkmcnt(4)
  v_mfma_f32_16x16x32_bf16 v[64:67], a[160:163], a[96:99], v[64:67]
  ds_read_b64_tr_b16 a[176:177], v154 offset:49152
  v_mfma_f32_16x16x32_bf16 v[64:67], a[164:167], a[112:115], v[64:67]
  buffer_load_dwordx4 a[80:83], v243, s[24:27], s30 offen offset:0 sc1
  v_mfma_f32_16x16x32_bf16 v[68:71], a[164:167], a[116:119], v[68:71]
  ds_read_b64_tr_b16 a[178:179], v154 offset:50176
  v_mfma_f32_16x16x32_bf16 v[68:71], a[160:163], a[100:103], v[68:71]
  v_mfma_f32_16x16x32_bf16 v[72:75], a[160:163], a[104:107], v[72:75]
  ds_read_b64_tr_b16 a[180:181], v154 offset:57344
  v_mfma_f32_16x16x32_bf16 v[72:75], a[164:167], a[120:123], v[72:75]
  buffer_load_dwordx4 v240, s[20:23], s31 offen offset:2048 lds
  v_mfma_f32_16x16x32_bf16 v[76:79], a[164:167], a[124:127], v[76:79]
  ds_read_b64_tr_b16 a[182:183], v154 offset:58368
  v_mfma_f32_16x16x32_bf16 v[76:79], a[160:163], a[108:111], v[76:79]
  s_waitcnt lgkmcnt(4)
  v_mfma_f32_16x16x32_bf16 v[80:83], a[168:171], a[96:99], v[80:83]
  ds_read_b64_tr_b16 a[184:185], v155 offset:49152
  v_mfma_f32_16x16x32_bf16 v[80:83], a[172:175], a[112:115], v[80:83]
  buffer_load_dwordx4 a[84:87], v243, s[24:27], s30 offen offset:1024 sc1
  v_mfma_f32_16x16x32_bf16 v[84:87], a[172:175], a[116:119], v[84:87]
  ds_read_b64_tr_b16 a[186:187], v155 offset:50176
  v_mfma_f32_16x16x32_bf16 v[84:87], a[168:171], a[100:103], v[84:87]
  s_waitcnt vmcnt(25)
  v_mfma_f32_16x16x32_bf16 v[88:91], a[168:171], a[104:107], v[88:91]
  ds_read_b64_tr_b16 a[188:189], v155 offset:57344
  v_mfma_f32_16x16x32_bf16 v[88:91], a[172:175], a[120:123], v[88:91]
  s_barrier
  v_mfma_f32_16x16x32_bf16 v[92:95], a[172:175], a[124:127], v[92:95]
  ds_read_b64_tr_b16 a[190:191], v155 offset:58368
  v_mfma_f32_16x16x32_bf16 v[92:95], a[168:171], a[108:111], v[92:95]
  s_waitcnt lgkmcnt(4)
  v_mfma_f32_16x16x32_bf16 v[96:99], a[176:179], a[96:99], v[96:99]
  ds_read_b64_tr_b16 a[160:161], v148 offset:16384
  v_mfma_f32_16x16x32_bf16 v[96:99], a[180:183], a[112:115], v[96:99]
  buffer_load_dwordx4 a[88:91], v243, s[24:27], s30 offen offset:2048 sc1
  v_mfma_f32_16x16x32_bf16 v[100:103], a[180:183], a[116:119], v[100:103]
  ds_read_b64_tr_b16 a[162:163], v148 offset:17408
  v_mfma_f32_16x16x32_bf16 v[100:103], a[176:179], a[100:103], v[100:103]
  v_mfma_f32_16x16x32_bf16 v[104:107], a[176:179], a[104:107], v[104:107]
  ds_read_b64_tr_b16 a[164:165], v148 offset:24576
  v_mfma_f32_16x16x32_bf16 v[104:107], a[180:183], a[120:123], v[104:107]
  buffer_load_dwordx4 v241, s[20:23], s31 offen offset:3072 lds
  s_add_u32 s31, s31, 0x80000
  v_mfma_f32_16x16x32_bf16 v[108:111], a[180:183], a[124:127], v[108:111]
  ds_read_b64_tr_b16 a[166:167], v148 offset:25600
  v_mfma_f32_16x16x32_bf16 v[108:111], a[176:179], a[108:111], v[108:111]
  s_waitcnt lgkmcnt(4)
  v_mfma_f32_16x16x32_bf16 v[112:115], a[184:187], a[96:99], v[112:115]
  ds_read_b64_tr_b16 a[168:169], v149 offset:16384
  v_mfma_f32_16x16x32_bf16 v[112:115], a[188:191], a[112:115], v[112:115]
  buffer_load_dwordx4 a[92:95], v243, s[24:27], s30 offen offset:3072 sc1
  s_add_u32 s30, s30, 8192
  v_mfma_f32_16x16x32_bf16 v[116:119], a[188:191], a[116:119], v[116:119]
  ds_read_b64_tr_b16 a[170:171], v149 offset:17408
  v_mfma_f32_16x16x32_bf16 v[116:119], a[184:187], a[100:103], v[116:119]
  v_mfma_f32_16x16x32_bf16 v[120:123], a[184:187], a[104:107], v[120:123]
  ds_read_b64_tr_b16 a[172:173], v149 offset:24576
  v_mfma_f32_16x16x32_bf16 v[120:123], a[188:191], a[120:123], v[120:123]
  v_mfma_f32_16x16x32_bf16 v[124:127], a[188:191], a[124:127], v[124:127]
  ds_read_b64_tr_b16 a[174:175], v149 offset:25600
  v_mfma_f32_16x16x32_bf16 v[124:127], a[184:187], a[108:111], v[124:127]
  s_waitcnt vmcnt(27) lgkmcnt(4)
  v_mfma_f32_16x16x32_bf16 v[0:3], a[160:163], a[0:3], v[0:3]
  ds_read_b64_tr_b16 a[176:177], v150 offset:16384
  s_waitcnt vmcnt(25)
  v_mov_b32 v136, -1
  v_mfma_f32_16x16x32_bf16 v[0:3], a[164:167], a[16:19], v[0:3]
  buffer_load_dwordx4 a[96:99], v242, s[24:27], s30 offen offset:0 sc1
  v_mfma_f32_16x16x32_bf16 v[4:7], a[164:167], a[20:23], v[4:7]
  ds_read_b64_tr_b16 a[178:179], v150 offset:17408
  v_sub_u32 v139, v136, v128
  v_mfma_f32_16x16x32_bf16 v[4:7], a[160:163], a[4:7], v[4:7]
  v_sub_u32 v140, v136, v129
  v_min_u32 v138, v139, v140
  v_mfma_f32_16x16x32_bf16 v[8:11], a[160:163], a[8:11], v[8:11]
  ds_read_b64_tr_b16 a[180:181], v150 offset:24576
  s_add_u32 m0, s28, 81920
  v_sub_u32 v141, v136, v130
  v_mfma_f32_16x16x32_bf16 v[8:11], a[164:167], a[24:27], v[8:11]
  buffer_load_dwordx4 v238, s[20:23], s31 offen offset:0 lds
  v_mfma_f32_16x16x32_bf16 v[12:15], a[164:167], a[28:31], v[12:15]
  ds_read_b64_tr_b16 a[182:183], v150 offset:25600
  v_sub_u32 v142, v136, v131
  v_mfma_f32_16x16x32_bf16 v[12:15], a[160:163], a[12:15], v[12:15]
  s_waitcnt lgkmcnt(4)
  v_min3_u32 v138, v138, v141, v142
  v_sub_u32 v139, v136, v132
  v_mfma_f32_16x16x32_bf16 v[16:19], a[168:171], a[0:3], v[16:19]
  ds_read_b64_tr_b16 a[184:185], v151 offset:16384
  v_sub_u32 v140, v136, v133
  v_mfma_f32_16x16x32_bf16 v[16:19], a[172:175], a[16:19], v[16:19]
  buffer_load_dwordx4 a[100:103], v242, s[24:27], s30 offen offset:1024 sc1
  v_mfma_f32_16x16x32_bf16 v[20:23], a[172:175], a[20:23], v[20:23]
  ds_read_b64_tr_b16 a[186:187], v151 offset:17408
  v_min3_u32 v138, v138, v139, v140
  v_mfma_f32_16x16x32_bf16 v[20:23], a[168:171], a[4:7], v[20:23]
  v_sub_u32 v141, v136, v134
  v_sub_u32 v142, v136, v135
  v_mfma_f32_16x16x32_bf16 v[24:27], a[168:171], a[8:11], v[24:27]
  ds_read_b64_tr_b16 a[188:189], v151 offset:24576
  v_min3_u32 v138, v138, v141, v142
  v_mfma_f32_16x16x32_bf16 v[24:27], a[172:175], a[24:27], v[24:27]
  v_mfma_f32_16x16x32_bf16 v[28:31], a[172:175], a[28:31], v[28:31]
  ds_read_b64_tr_b16 a[190:191], v151 offset:25600
  v_min_u32_dpp v138, v138, v138 row_ror:8 row_mask:0xf bank_mask:0xf
  v_mfma_f32_16x16x32_bf16 v[28:31], a[168:171], a[12:15], v[28:31]
  s_waitcnt lgkmcnt(4)
  v_min_u32_dpp v138, v138, v138 row_ror:4 row_mask:0xf bank_mask:0xf
  v_mfma_f32_16x16x32_bf16 v[32:35], a[176:179], a[0:3], v[32:35]
  ds_read_b64_tr_b16 a[160:161], v152 offset:16384
  v_min_u32_dpp v138, v138, v138 row_ror:2 row_mask:0xf bank_mask:0xf
  v_mfma_f32_16x16x32_bf16 v[32:35], a[180:183], a[16:19], v[32:35]
  buffer_load_dwordx4 a[104:107], v242, s[24:27], s30 offen offset:2048 sc1
  v_mfma_f32_16x16x32_bf16 v[36:39], a[180:183], a[20:23], v[36:39]
  ds_read_b64_tr_b16 a[162:163], v152 offset:17408
  v_min_u32_dpp v138, v138, v138 row_ror:1 row_mask:0xf bank_mask:0xf
  v_mfma_f32_16x16x32_bf16 v[36:39], a[176:179], a[4:7], v[36:39]
  v_sub_u32 v137, v136, v138
  v_add_u32 v136, -1, v137
  v_mfma_f32_16x16x32_bf16 v[40:43], a[176:179], a[8:11], v[40:43]
  ds_read_b64_tr_b16 a[164:165], v152 offset:24576
  v_sub_u32 v139, v136, v128
  v_mfma_f32_16x16x32_bf16 v[40:43], a[180:183], a[24:27], v[40:43]
  buffer_load_dwordx4 v239, s[20:23], s31 offen offset:1024 lds
  v_mfma_f32_16x16x32_bf16 v[44:47], a[180:183], a[28:31], v[44:47]
  ds_read_b64_tr_b16 a[166:167], v152 offset:25600
  v_mov_b32_dpp v144, v137 quad_perm:[0,1,2,3] row_mask:0xf bank_mask:0x1
  v_mfma_f32_16x16x32_bf16 v[44:47], a[176:179], a[12:15], v[44:47]
  s_waitcnt lgkmcnt(4)
  v_sub_u32 v140, v136, v129
  v_min_u32 v138, v139, v140
  v_mfma_f32_16x16x32_bf16 v[48:51], a[184:187], a[0:3], v[48:51]
  ds_read_b64_tr_b16 a[168:169], v153 offset:16384
  v_sub_u32 v141, v136, v130
  v_mfma_f32_16x16x32_bf16 v[48:51], a[188:191], a[16:19], v[48:51]
  buffer_load_dwordx4 a[108:111], v242, s[24:27], s30 offen offset:3072 sc1
  v_mfma_f32_16x16x32_bf16 v[52:55], a[188:191], a[20:23], v[52:55]
  ds_read_b64_tr_b16 a[170:171], v153 offset:17408
  v_sub_u32 v142, v136, v131
  v_mfma_f32_16x16x32_bf16 v[52:55], a[184:187], a[4:7], v[52:55]
  v_min3_u32 v138, v138, v141, v142
  v_sub_u32 v139, v136, v132
  v_mfma_f32_16x16x32_bf16 v[56:59], a[184:187], a[8:11], v[56:59]
  ds_read_b64_tr_b16 a[172:173], v153 offset:24576
  v_sub_u32 v140, v136, v133
  v_mfma_f32_16x16x32_bf16 v[56:59], a[188:191], a[24:27], v[56:59]
  v_min3_u32 v138, v138, v139, v140
  v_sub_u32 v141, v136, v134
  v_mfma_f32_16x16x32_bf16 v[60:63], a[188:191], a[28:31], v[60:63]
  ds_read_b64_tr_b16 a[174:175], v153 offset:25600
  v_sub_u32 v142, v136, v135
  v_mfma_f32_16x16x32_bf16 v[60:63], a[184:187], a[12:15], v[60:63]
  s_waitcnt lgkmcnt(4)
  v_min3_u32 v138, v138, v141, v142
  v_mfma_f32_16x16x32_bf16 v[64:67], a[160:163], a[0:3], v[64:67]
  ds_read_b64_tr_b16 a[176:177], v154 offset:16384
  v_min_u32_dpp v138, v138, v138 row_ror:8 row_mask:0xf bank_mask:0xf
  v_mfma_f32_16x16x32_bf16 v[64:67], a[164:167], a[16:19], v[64:67]
  buffer_load_dwordx4 a[112:115], v243, s[24:27], s30 offen offset:0 sc1
  v_mfma_f32_16x16x32_bf16 v[68:71], a[164:167], a[20:23], v[68:71]
  ds_read_b64_tr_b16 a[178:179], v154 offset:17408
  v_min_u32_dpp v138, v138, v138 row_ror:4 row_mask:0xf bank_mask:0xf
  v_mfma_f32_16x16x32_bf16 v[68:71], a[160:163], a[4:7], v[68:71]
  v_mfma_f32_16x16x32_bf16 v[72:75], a[160:163], a[8:11], v[72:75]
  ds_read_b64_tr_b16 a[180:181], v154 offset:24576
  v_min_u32_dpp v138, v138, v138 row_ror:2 row_mask:0xf bank_mask:0xf
  v_mfma_f32_16x16x32_bf16 v[72:75], a[164:167], a[24:27], v[72:75]
  buffer_load_dwordx4 v240, s[20:23], s31 offen offset:2048 lds
  v_mfma_f32_16x16x32_bf16 v[76:79], a[164:167], a[28:31], v[76:79]
  ds_read_b64_tr_b16 a[182:183], v154 offset:25600
  v_min_u32_dpp v138, v138, v138 row_ror:1 row_mask:0xf bank_mask:0xf
  v_mfma_f32_16x16x32_bf16 v[76:79], a[160:163], a[12:15], v[76:79]
  s_waitcnt lgkmcnt(4)
  v_sub_u32 v137, v136, v138
  v_add_u32 v136, -1, v137
  v_mfma_f32_16x16x32_bf16 v[80:83], a[168:171], a[0:3], v[80:83]
  ds_read_b64_tr_b16 a[184:185], v155 offset:16384
  v_sub_u32 v139, v136, v128
  v_mfma_f32_16x16x32_bf16 v[80:83], a[172:175], a[16:19], v[80:83]
  buffer_load_dwordx4 a[116:119], v243, s[24:27], s30 offen offset:1024 sc1
  v_mfma_f32_16x16x32_bf16 v[84:87], a[172:175], a[20:23], v[84:87]
  ds_read_b64_tr_b16 a[186:187], v155 offset:17408
  v_mov_b32_dpp v144, v137 quad_perm:[0,1,2,3] row_mask:0xf bank_mask:0x2
  v_mfma_f32_16x16x32_bf16 v[84:87], a[168:171], a[4:7], v[84:87]
  s_waitcnt vmcnt(22)
  v_sub_u32 v140, v136, v129
  v_min_u32 v138, v139, v140
  v_mfma_f32_16x16x32_bf16 v[88:91], a[168:171], a[8:11], v[88:91]
  ds_read_b64_tr_b16 a[188:189], v155 offset:24576
  v_sub_u32 v141, v136, v130
  v_mfma_f32_16x16x32_bf16 v[88:91], a[172:175], a[24:27], v[88:91]
  s_barrier
  v_sub_u32 v142, v136, v131
  v_min3_u32 v138, v138, v141, v142
  v_mfma_f32_16x16x32_bf16 v[92:95], a[172:175], a[28:31], v[92:95]
  ds_read_b64_tr_b16 a[190:191], v155 offset:25600
  v_sub_u32 v139, v136, v132
  v_mfma_f32_16x16x32_bf16 v[92:95], a[168:171], a[12:15], v[92:95]
  s_waitcnt lgkmcnt(4)
  v_sub_u32 v140, v136, v133
  v_min3_u32 v138, v138, v139, v140
  v_mfma_f32_16x16x32_bf16 v[96:99], a[176:179], a[0:3], v[96:99]
  ds_read_b64_tr_b16 a[160:161], v148 offset:0
  v_sub_u32 v141, v136, v134
  v_mfma_f32_16x16x32_bf16 v[96:99], a[180:183], a[16:19], v[96:99]
  buffer_load_dwordx4 a[120:123], v243, s[24:27], s30 offen offset:2048 sc1
  v_mfma_f32_16x16x32_bf16 v[100:103], a[180:183], a[20:23], v[100:103]
  ds_read_b64_tr_b16 a[162:163], v148 offset:1024
  v_sub_u32 v142, v136, v135
  v_mfma_f32_16x16x32_bf16 v[100:103], a[176:179], a[4:7], v[100:103]
  v_min3_u32 v138, v138, v141, v142
  v_mfma_f32_16x16x32_bf16 v[104:107], a[176:179], a[8:11], v[104:107]
  ds_read_b64_tr_b16 a[164:165], v148 offset:8192
  v_min_u32_dpp v138, v138, v138 row_ror:8 row_mask:0xf bank_mask:0xf
  v_mfma_f32_16x16x32_bf16 v[104:107], a[180:183], a[24:27], v[104:107]
  buffer_load_dwordx4 v241, s[20:23], s31 offen offset:3072 lds
  s_add_u32 s31, s31, 0x80000
  v_mfma_f32_16x16x32_bf16 v[108:111], a[180:183], a[28:31], v[108:111]
  ds_read_b64_tr_b16 a[166:167], v148 offset:9216
  v_min_u32_dpp v138, v138, v138 row_ror:4 row_mask:0xf bank_mask:0xf
  v_mfma_f32_16x16x32_bf16 v[108:111], a[176:179], a[12:15], v[108:111]
  s_waitcnt lgkmcnt(4)
  v_min_u32_dpp v138, v138, v138 row_ror:2 row_mask:0xf bank_mask:0xf
  v_mfma_f32_16x16x32_bf16 v[112:115], a[184:187], a[0:3], v[112:115]
  ds_read_b64_tr_b16 a[168:169], v149 offset:0
  v_min_u32_dpp v138, v138, v138 row_ror:1 row_mask:0xf bank_mask:0xf
  v_mfma_f32_16x16x32_bf16 v[112:115], a[188:191], a[16:19], v[112:115]
  buffer_load_dwordx4 a[124:127], v243, s[24:27], s30 offen offset:3072 sc1
  s_add_u32 s30, s30, 8192
  v_mfma_f32_16x16x32_bf16 v[116:119], a[188:191], a[20:23], v[116:119]
  ds_read_b64_tr_b16 a[170:171], v149 offset:1024
  v_sub_u32 v137, v136, v138
  v_mfma_f32_16x16x32_bf16 v[116:119], a[184:187], a[4:7], v[116:119]
  v_add_u32 v136, -1, v137
  v_sub_u32 v139, v136, v128
  v_mfma_f32_16x16x32_bf16 v[120:123], a[184:187], a[8:11], v[120:123]
  ds_read_b64_tr_b16 a[172:173], v149 offset:8192
  v_mov_b32_dpp v144, v137 quad_perm:[0,1,2,3] row_mask:0xf bank_mask:0x4
  v_mfma_f32_16x16x32_bf16 v[120:123], a[188:191], a[24:27], v[120:123]
  v_sub_u32 v140, v136, v129
  v_min_u32 v138, v139, v140
  v_mfma_f32_16x16x32_bf16 v[124:127], a[188:191], a[28:31], v[124:127]
  ds_read_b64_tr_b16 a[174:175], v149 offset:9216
  v_sub_u32 v141, v136, v130
  v_mfma_f32_16x16x32_bf16 v[124:127], a[184:187], a[12:15], v[124:127]
  s_waitcnt vmcnt(24) lgkmcnt(4)
  v_sub_u32 v142, v136, v131
  v_min3_u32 v138, v138, v141, v142
  v_mfma_f32_16x16x32_bf16 v[0:3], a[160:163], a[32:35], v[0:3]
  ds_read_b64_tr_b16 a[176:177], v150 offset:0
  v_sub_u32 v139, v136, v132
  v_mfma_f32_16x16x32_bf16 v[0:3], a[164:167], a[48:51], v[0:3]
  buffer_load_dwordx4 a[0:3], v242, s[24:27], s30 offen offset:0 sc1
  v_mfma_f32_16x16x32_bf16 v[4:7], a[164:167], a[52:55], v[4:7]
  ds_read_b64_tr_b16 a[178:179], v150 offset:1024
  v_sub_u32 v140, v136, v133
  v_mfma_f32_16x16x32_bf16 v[4:7], a[160:163], a[36:39], v[4:7]
  v_min3_u32 v138, v138, v139, v140
  v_sub_u32 v141, v136, v134
  v_mfma_f32_16x16x32_bf16 v[8:11], a[160:163], a[40:43], v[8:11]
  ds_read_b64_tr_b16 a[180:181], v150 offset:8192
  s_add_u32 m0, s28, 98304
  v_sub_u32 v142, v136, v135
  v_mfma_f32_16x16x32_bf16 v[8:11], a[164:167], a[56:59], v[8:11]
  buffer_load_dwordx4 v238, s[20:23], s31 offen offset:0 lds
  v_mfma_f32_16x16x32_bf16 v[12:15], a[164:167], a[60:63], v[12:15]
  ds_read_b64_tr_b16 a[182:183], v150 offset:9216
  v_min3_u32 v138, v138, v141, v142
  v_mfma_f32_16x16x32_bf16 v[12:15], a[160:163], a[44:47], v[12:15]
  s_waitcnt lgkmcnt(4)
  v_min_u32_dpp v138, v138, v138 row_ror:8 row_mask:0xf bank_mask:0xf
  v_mfma_f32_16x16x32_bf16 v[16:19], a[168:171], a[32:35], v[16:19]
  ds_read_b64_tr_b16 a[184:185], v151 offset:0
  v_min_u32_dpp v138, v138, v138 row_ror:4 row_mask:0xf bank_mask:0xf
  v_mfma_f32_16x16x32_bf16 v[16:19], a[172:175], a[48:51], v[16:19]
  buffer_load_dwordx4 a[4:7], v242, s[24:27], s30 offen offset:1024 sc1
  v_mfma_f32_16x16x32_bf16 v[20:23], a[172:175], a[52:55], v[20:23]
  ds_read_b64_tr_b16 a[186:187], v151 offset:1024
  v_min_u32_dpp v138, v138, v138 row_ror:2 row_mask:0xf bank_mask:0xf
  v_mfma_f32_16x16x32_bf16 v[20:23], a[168:171], a[36:39], v[20:23]
  v_mfma_f32_16x16x32_bf16 v[24:27], a[168:171], a[40:43], v[24:27]
  ds_read_b64_tr_b16 a[188:189], v151 offset:8192
  v_min_u32_dpp v138, v138, v138 row_ror:1 row_mask:0xf bank_mask:0xf
  v_mfma_f32_16x16x32_bf16 v[24:27], a[172:175], a[56:59], v[24:27]
  v_sub_u32 v137, v136, v138
  v_add_u32 v136, -1, v137
  v_mfma_f32_16x16x32_bf16 v[28:31], a[172:175], a[60:63], v[28:31]
  ds_read_b64_tr_b16 a[190:191], v151 offset:9216
  v_sub_u32 v139, v136, v128
  v_mfma_f32_16x16x32_bf16 v[28:31], a[168:171], a[44:47], v[28:31]
  s_waitcnt lgkmcnt(4)
  v_mov_b32_dpp v144, v137 quad_perm:[0,1,2,3] row_mask:0xf bank_mask:0x8
  v_sub_u32 v140, v136, v129
  v_mfma_f32_16x16x32_bf16 v[32:35], a[176:179], a[32:35], v[32:35]
  ds_read_b64_tr_b16 a[160:161], v152 offset:0
  v_min_u32 v138, v139, v140
  v_mfma_f32_16x16x32_bf16 v[32:35], a[180:183], a[48:51], v[32:35]
  buffer_load_dwordx4 a[8:11], v242, s[24:27], s30 offen offset:2048 sc1
  v_mfma_f32_16x16x32_bf16 v[36:39], a[180:183], a[52:55], v[36:39]
  ds_read_b64_tr_b16 a[162:163], v152 offset:1024
  v_sub_u32 v141, v136, v130
  v_mfma_f32_16x16x32_bf16 v[36:39], a[176:179], a[36:39], v[36:39]
  v_sub_u32 v142, v136, v131
  v_min3_u32 v138, v138, v141, v142
  v_mfma_f32_16x16x32_bf16 v[40:43], a[176:179], a[40:43], v[40:43]
  ds_read_b64_tr_b16 a[164:165], v152 offset:8192
  v_sub_u32 v139, v136, v132
  v_mfma_f32_16x16x32_bf16 v[40:43], a[180:183], a[56:59], v[40:43]
  buffer_load_dwordx4 v239, s[20:23], s31 offen offset:1024 lds
  v_mfma_f32_16x16x32_bf16 v[44:47], a[180:183], a[60:63], v[44:47]
  ds_read_b64_tr_b16 a[166:167], v152 offset:9216
  v_sub_u32 v140, v136, v133
  v_mfma_f32_16x16x32_bf16 v[44:47], a[176:179], a[44:47], v[44:47]
  s_waitcnt lgkmcnt(4)
  v_min3_u32 v138, v138, v139, v140
  v_sub_u32 v141, v136, v134
  v_mfma_f32_16x16x32_bf16 v[48:51], a[184:187], a[32:35], v[48:51]
  ds_read_b64_tr_b16 a[168:169], v153 offset:0
  v_sub_u32 v142, v136, v135
  v_mfma_f32_16x16x32_bf16 v[48:51], a[188:191], a[48:51], v[48:51]
  buffer_load_dwordx4 a[12:15], v242, s[24:27], s30 offen offset:3072 sc1
  v_mfma_f32_16x16x32_bf16 v[52:55], a[188:191], a[52:55], v[52:55]
  ds_read_b64_tr_b16 a[170:171], v153 offset:1024
  v_min3_u32 v138, v138, v141, v142
  v_mfma_f32_16x16x32_bf16 v[52:55], a[184:187], a[36:39], v[52:55]
  v_mfma_f32_16x16x32_bf16 v[56:59], a[184:187], a[40:43], v[56:59]
  ds_read_b64_tr_b16 a[172:173], v153 offset:8192
  v_min_u32_dpp v138, v138, v138 row_ror:8 row_mask:0xf bank_mask:0xf
  v_mfma_f32_16x16x32_bf16 v[56:59], a[188:191], a[56:59], v[56:59]
  v_mfma_f32_16x16x32_bf16 v[60:63], a[188:191], a[60:63], v[60:63]
  ds_read_b64_tr_b16 a[174:175], v153 offset:9216
  v_min_u32_dpp v138, v138, v138 row_ror:4 row_mask:0xf bank_mask:0xf
  v_mfma_f32_16x16x32_bf16 v[60:63], a[184:187], a[44:47], v[60:63]
  s_waitcnt lgkmcnt(4)
  v_min_u32_dpp v138, v138, v138 row_ror:2 row_mask:0xf bank_mask:0xf
  v_mfma_f32_16x16x32_bf16 v[64:67], a[160:163], a[32:35], v[64:67]
  ds_read_b64_tr_b16 a[176:177], v154 offset:0
  v_min_u32_dpp v138, v138, v138 row_ror:1 row_mask:0xf bank_mask:0xf
  v_mfma_f32_16x16x32_bf16 v[64:67], a[164:167], a[48:51], v[64:67]
  buffer_load_dwordx4 a[16:19], v243, s[24:27], s30 offen offset:0 sc1
  v_mfma_f32_16x16x32_bf16 v[68:71], a[164:167], a[52:55], v[68:71]
  ds_read_b64_tr_b16 a[178:179], v154 offset:1024
  v_sub_u32 v137, v136, v138
  v_mfma_f32_16x16x32_bf16 v[68:71], a[160:163], a[36:39], v[68:71]
  v_add_u32 v136, -1, v137
  v_sub_u32 v139, v136, v128
  v_mfma_f32_16x16x32_bf16 v[72:75], a[160:163], a[40:43], v[72:75]
  ds_read_b64_tr_b16 a[180:181], v154 offset:8192
  v_mov_b32_dpp v145, v137 quad_perm:[0,1,2,3] row_mask:0xf bank_mask:0x1
  v_mfma_f32_16x16x32_bf16 v[72:75], a[164:167], a[56:59], v[72:75]
  buffer_load_dwordx4 v240, s[20:23], s31 offen offset:2048 lds
  v_mfma_f32_16x16x32_bf16 v[76:79], a[164:167], a[60:63], v[76:79]
  ds_read_b64_tr_b16 a[182:183], v154 offset:9216
  v_sub_u32 v140, v136, v129
  v_mfma_f32_16x16x32_bf16 v[76:79], a[160:163], a[44:47], v[76:79]
  s_waitcnt lgkmcnt(4)
  v_min_u32 v138, v139, v140
  v_sub_u32 v141, v136, v130
  v_mfma_f32_16x16x32_bf16 v[80:83], a[168:171], a[32:35], v[80:83]
  ds_read_b64_tr_b16 a[184:185], v155 offset:0
  v_sub_u32 v142, v136, v131
  v_mfma_f32_16x16x32_bf16 v[80:83], a[172:175], a[48:51], v[80:83]
  buffer_load_dwordx4 a[20:23], v243, s[24:27], s30 offen offset:1024 sc1
  v_mfma_f32_16x16x32_bf16 v[84:87], a[172:175], a[52:55], v[84:87]
  ds_read_b64_tr_b16 a[186:187], v155 offset:1024
  v_min3_u32 v138, v138, v141, v142
  v_mfma_f32_16x16x32_bf16 v[84:87], a[168:171], a[36:39], v[84:87]
  s_waitcnt vmcnt(22)
  v_sub_u32 v139, v136, v132
  v_sub_u32 v140, v136, v133
  v_mfma_f32_16x16x32_bf16 v[88:91], a[168:171], a[40:43], v[88:91]
  ds_read_b64_tr_b16 a[188:189], v155 offset:8192
  v_min3_u32 v138, v138, v139, v140
  v_mfma_f32_16x16x32_bf16 v[88:91], a[172:175], a[56:59], v[88:91]
  s_barrier
  v_sub_u32 v141, v136, v134
  v_sub_u32 v142, v136, v135
  v_mfma_f32_16x16x32_bf16 v[92:95], a[172:175], a[60:63], v[92:95]
  ds_read_b64_tr_b16 a[190:191], v155 offset:9216
  v_min3_u32 v138, v138, v141, v142
  v_mfma_f32_16x16x32_bf16 v[92:95], a[168:171], a[44:47], v[92:95]
  s_waitcnt lgkmcnt(4)
  v_min_u32_dpp v138, v138, v138 row_ror:8 row_mask:0xf bank_mask:0xf
  v_mfma_f32_16x16x32_bf16 v[96:99], a[176:179], a[32:35], v[96:99]
  ds_read_b64_tr_b16 a[160:161], v224 offset:0
  v_min_u32_dpp v138, v138, v138 row_ror:4 row_mask:0xf bank_mask:0xf
  v_mfma_f32_16x16x32_bf16 v[96:99], a[180:183], a[48:51], v[96:99]
  buffer_load_dwordx4 a[24:27], v243, s[24:27], s30 offen offset:2048 sc1
  v_mfma_f32_16x16x32_bf16 v[100:103], a[180:183], a[52:55], v[100:103]
  ds_read_b64_tr_b16 a[162:163], v224 offset:1024
  v_min_u32_dpp v138, v138, v138 row_ror:2 row_mask:0xf bank_mask:0xf
  v_mfma_f32_16x16x32_bf16 v[100:103], a[176:179], a[36:39], v[100:103]
  v_mfma_f32_16x16x32_bf16 v[104:107], a[176:179], a[40:43], v[104:107]
  ds_read_b64_tr_b16 a[164:165], v224 offset:8192
  v_min_u32_dpp v138, v138, v138 row_ror:1 row_mask:0xf bank_mask:0xf
  v_mfma_f32_16x16x32_bf16 v[104:107], a[180:183], a[56:59], v[104:107]
  buffer_load_dwordx4 v241, s[20:23], s31 offen offset:3072 lds
  s_add_u32 s31, s31, 0x80000
  v_mfma_f32_16x16x32_bf16 v[108:111], a[180:183], a[60:63], v[108:111]
  ds_read_b64_tr_b16 a[166:167], v224 offset:9216
  v_sub_u32 v137, v136, v138
  v_mfma_f32_16x16x32_bf16 v[108:111], a[176:179], a[44:47], v[108:111]
  s_waitcnt lgkmcnt(4)
  v_add_u32 v136, -1, v137
  v_sub_u32 v139, v136, v128
  v_mfma_f32_16x16x32_bf16 v[112:115], a[184:187], a[32:35], v[112:115]
  ds_read_b64_tr_b16 a[168:169], v225 offset:0
  v_mov_b32_dpp v145, v137 quad_perm:[0,1,2,3] row_mask:0xf bank_mask:0x2
  v_mfma_f32_16x16x32_bf16 v[112:115], a[188:191], a[48:51], v[112:115]
  buffer_load_dwordx4 a[28:31], v243, s[24:27], s30 offen offset:3072 sc1
  s_add_u32 s30, s30, 8192
  v_mfma_f32_16x16x32_bf16 v[116:119], a[188:191], a[52:55], v[116:119]
  ds_read_b64_tr_b16 a[170:171], v225 offset:1024
  v_sub_u32 v140, v136, v129
  v_mfma_f32_16x16x32_bf16 v[116:119], a[184:187], a[36:39], v[116:119]
  v_min_u32 v138, v139, v140
  v_sub_u32 v141, v136, v130
  v_mfma_f32_16x16x32_bf16 v[120:123], a[184:187], a[40:43], v[120:123]
  ds_read_b64_tr_b16 a[172:173], v225 offset:8192
  v_sub_u32 v142, v136, v131
  v_mfma_f32_16x16x32_bf16 v[120:123], a[188:191], a[56:59], v[120:123]
  v_min3_u32 v138, v138, v141, v142
  v_sub_u32 v139, v136, v132
  v_mfma_f32_16x16x32_bf16 v[124:127], a[188:191], a[60:63], v[124:127]
  ds_read_b64_tr_b16 a[174:175], v225 offset:9216
  v_sub_u32 v140, v136, v133
  v_mfma_f32_16x16x32_bf16 v[124:127], a[184:187], a[44:47], v[124:127]
  s_waitcnt vmcnt(24) lgkmcnt(4)
  v_min3_u32 v138, v138, v139, v140
  v_sub_u32 v141, v136, v134
  v_mfma_f32_16x16x32_bf16 v[0:3], a[160:163], a[64:67], v[0:3]
  ds_read_b64_tr_b16 a[176:177], v226 offset:0
  v_sub_u32 v142, v136, v135
  v_mfma_f32_16x16x32_bf16 v[0:3], a[164:167], a[80:83], v[0:3]
  buffer_load_dwordx4 a[32:35], v242, s[24:27], s30 offen offset:0 sc1
  v_mfma_f32_16x16x32_bf16 v[4:7], a[164:167], a[84:87], v[4:7]
  ds_read_b64_tr_b16 a[178:179], v226 offset:1024
  v_min3_u32 v138, v138, v141, v142
  v_mfma_f32_16x16x32_bf16 v[4:7], a[160:163], a[68:71], v[4:7]
  v_mfma_f32_16x16x32_bf16 v[8:11], a[160:163], a[72:75], v[8:11]
  ds_read_b64_tr_b16 a[180:181], v226 offset:8192
  s_add_u32 m0, s28, 114688
  v_min_u32_dpp v138, v138, v138 row_ror:8 row_mask:0xf bank_mask:0xf
  v_mfma_f32_16x16x32_bf16 v[8:11], a[164:167], a[88:91], v[8:11]
  buffer_load_dwordx4 v238, s[20:23], s31 offen offset:0 lds
  v_mfma_f32_16x16x32_bf16 v[12:15], a[164:167], a[92:95], v[12:15]
  ds_read_b64_tr_b16 a[182:183], v226 offset:9216
  v_min_u32_dpp v138, v138, v138 row_ror:4 row_mask:0xf bank_mask:0xf
  v_mfma_f32_16x16x32_bf16 v[12:15], a[160:163], a[76:79], v[12:15]
  s_waitcnt lgkmcnt(4)
  v_min_u32_dpp v138, v138, v138 row_ror:2 row_mask:0xf bank_mask:0xf
  v_mfma_f32_16x16x32_bf16 v[16:19], a[168:171], a[64:67], v[16:19]
  ds_read_b64_tr_b16 a[184:185], v227 offset:0
  v_min_u32_dpp v138, v138, v138 row_ror:1 row_mask:0xf bank_mask:0xf
  v_mfma_f32_16x16x32_bf16 v[16:19], a[172:175], a[80:83], v[16:19]
  buffer_load_dwordx4 a[36:39], v242, s[24:27], s30 offen offset:1024 sc1
  v_mfma_f32_16x16x32_bf16 v[20:23], a[172:175], a[84:87], v[20:23]
  ds_read_b64_tr_b16 a[186:187], v227 offset:1024
  v_sub_u32 v137, v136, v138
  v_mfma_f32_16x16x32_bf16 v[20:23], a[168:171], a[68:71], v[20:23]
  v_add_u32 v136, -1, v137
  v_sub_u32 v139, v136, v128
  v_mfma_f32_16x16x32_bf16 v[24:27], a[168:171], a[72:75], v[24:27]
  ds_read_b64_tr_b16 a[188:189], v227 offset:8192
  v_mov_b32_dpp v145, v137 quad_perm:[0,1,2,3] row_mask:0xf bank_mask:0x4
  v_mfma_f32_16x16x32_bf16 v[24:27], a[172:175], a[88:91], v[24:27]
  v_sub_u32 v140, v136, v129
  v_min_u32 v138, v139, v140
  v_mfma_f32_16x16x32_bf16 v[28:31], a[172:175], a[92:95], v[28:31]
  ds_read_b64_tr_b16 a[190:191], v227 offset:9216
  v_sub_u32 v141, v136, v130
  v_mfma_f32_16x16x32_bf16 v[28:31], a[168:171], a[76:79], v[28:31]
  s_waitcnt lgkmcnt(4)
  v_sub_u32 v142, v136, v131
  v_min3_u32 v138, v138, v141, v142
  v_mfma_f32_16x16x32_bf16 v[32:35], a[176:179], a[64:67], v[32:35]
  ds_read_b64_tr_b16 a[160:161], v228 offset:0
  v_sub_u32 v139, v136, v132
  v_mfma_f32_16x16x32_bf16 v[32:35], a[180:183], a[80:83], v[32:35]
  buffer_load_dwordx4 a[40:43], v242, s[24:27], s30 offen offset:2048 sc1
  v_mfma_f32_16x16x32_bf16 v[36:39], a[180:183], a[84:87], v[36:39]
  ds_read_b64_tr_b16 a[162:163], v228 offset:1024
  v_sub_u32 v140, v136, v133
  v_mfma_f32_16x16x32_bf16 v[36:39], a[176:179], a[68:71], v[36:39]
  v_min3_u32 v138, v138, v139, v140
  v_sub_u32 v141, v136, v134
  v_mfma_f32_16x16x32_bf16 v[40:43], a[176:179], a[72:75], v[40:43]
  ds_read_b64_tr_b16 a[164:165], v228 offset:8192
  v_sub_u32 v142, v136, v135
  v_mfma_f32_16x16x32_bf16 v[40:43], a[180:183], a[88:91], v[40:43]
  buffer_load_dwordx4 v239, s[20:23], s31 offen offset:1024 lds
  v_mfma_f32_16x16x32_bf16 v[44:47], a[180:183], a[92:95], v[44:47]
  ds_read_b64_tr_b16 a[166:167], v228 offset:9216
  v_min3_u32 v138, v138, v141, v142
  v_mfma_f32_16x16x32_bf16 v[44:47], a[176:179], a[76:79], v[44:47]
  s_waitcnt lgkmcnt(4)
  v_min_u32_dpp v138, v138, v138 row_ror:8 row_mask:0xf bank_mask:0xf
  v_mfma_f32_16x16x32_bf16 v[48:51], a[184:187], a[64:67], v[48:51]
  ds_read_b64_tr_b16 a[168:169], v229 offset:0
  v_min_u32_dpp v138, v138, v138 row_ror:4 row_mask:0xf bank_mask:0xf
  v_mfma_f32_16x16x32_bf16 v[48:51], a[188:191], a[80:83], v[48:51]
  buffer_load_dwordx4 a[44:47], v242, s[24:27], s30 offen offset:3072 sc1
  v_mfma_f32_16x16x32_bf16 v[52:55], a[188:191], a[84:87], v[52:55]
  ds_read_b64_tr_b16 a[170:171], v229 offset:1024
  v_min_u32_dpp v138, v138, v138 row_ror:2 row_mask:0xf bank_mask:0xf
  v_mfma_f32_16x16x32_bf16 v[52:55], a[184:187], a[68:71], v[52:55]
  v_mfma_f32_16x16x32_bf16 v[56:59], a[184:187], a[72:75], v[56:59]
  ds_read_b64_tr_b16 a[172:173], v229 offset:8192
  v_min_u32_dpp v138, v138, v138 row_ror:1 row_mask:0xf bank_mask:0xf
  v_mfma_f32_16x16x32_bf16 v[56:59], a[188:191], a[88:91], v[56:59]
  v_sub_u32 v137, v136, v138
  v_add_u32 v136, -1, v137
  v_mfma_f32_16x16x32_bf16 v[60:63], a[188:191], a[92:95], v[60:63]
  ds_read_b64_tr_b16 a[174:175], v229 offset:9216
  v_mov_b32_dpp v145, v137 quad_perm:[0,1,2,3] row_mask:0xf bank_mask:0x8
  v_mfma_f32_16x16x32_bf16 v[60:63], a[184:187], a[76:79], v[60:63]
  s_waitcnt lgkmcnt(4)
  s_lshl_b32 s35, s3, 9
  s_add_u32 s35, s35, 157696
  v_lshrrev_b32 v136, 1, v242
  v_add_u32 v136, s35, v136
  v_mfma_f32_16x16x32_bf16 v[64:67], a[160:163], a[64:67], v[64:67]
  ds_read_b64_tr_b16 a[176:177], v230 offset:0
  ds_write_b64 v136, v[144:145]
  v_mfma_f32_16x16x32_bf16 v[64:67], a[164:167], a[80:83], v[64:67]
  buffer_load_dwordx4 a[48:51], v243, s[24:27], s30 offen offset:0 sc1
  v_mfma_f32_16x16x32_bf16 v[68:71], a[164:167], a[84:87], v[68:71]
  ds_read_b64_tr_b16 a[178:179], v230 offset:1024
  v_mfma_f32_16x16x32_bf16 v[68:71], a[160:163], a[68:71], v[68:71]
  v_mfma_f32_16x16x32_bf16 v[72:75], a[160:163], a[72:75], v[72:75]
  ds_read_b64_tr_b16 a[180:181], v230 offset:8192
  v_mfma_f32_16x16x32_bf16 v[72:75], a[164:167], a[88:91], v[72:75]
  buffer_load_dwordx4 v240, s[20:23], s31 offen offset:2048 lds
  v_mfma_f32_16x16x32_bf16 v[76:79], a[164:167], a[92:95], v[76:79]
  ds_read_b64_tr_b16 a[182:183], v230 offset:9216
  v_mfma_f32_16x16x32_bf16 v[76:79], a[160:163], a[76:79], v[76:79]
  s_waitcnt lgkmcnt(5)
  v_mfma_f32_16x16x32_bf16 v[80:83], a[168:171], a[64:67], v[80:83]
  ds_read_b64_tr_b16 a[184:185], v231 offset:0
  s_waitcnt lgkmcnt(4)
  v_mfma_f32_16x16x32_bf16 v[80:83], a[172:175], a[80:83], v[80:83]
  buffer_load_dwordx4 a[52:55], v243, s[24:27], s30 offen offset:1024 sc1
  v_mfma_f32_16x16x32_bf16 v[84:87], a[172:175], a[84:87], v[84:87]
  ds_read_b64_tr_b16 a[186:187], v231 offset:1024
  v_mfma_f32_16x16x32_bf16 v[84:87], a[168:171], a[68:71], v[84:87]
  s_waitcnt vmcnt(22)
  v_mfma_f32_16x16x32_bf16 v[88:91], a[168:171], a[72:75], v[88:91]
  ds_read_b64_tr_b16 a[188:189], v231 offset:8192
  v_mfma_f32_16x16x32_bf16 v[88:91], a[172:175], a[88:91], v[88:91]
  s_barrier
  v_mfma_f32_16x16x32_bf16 v[92:95], a[172:175], a[92:95], v[92:95]
  ds_read_b64_tr_b16 a[190:191], v231 offset:9216
  v_lshlrev_b32 v137, 1, v242
  v_mfma_f32_16x16x32_bf16 v[92:95], a[168:171], a[76:79], v[92:95]
  s_waitcnt lgkmcnt(4)
  v_add_u32 v137, 157696, v137
  v_mfma_f32_16x16x32_bf16 v[96:99], a[176:179], a[64:67], v[96:99]
  ds_read_b64_tr_b16 a[160:161], v224 offset:16384
  ds_read_b64 v[128:129], v137
  v_mfma_f32_16x16x32_bf16 v[96:99], a[180:183], a[80:83], v[96:99]
  buffer_load_dwordx4 a[56:59], v243, s[24:27], s30 offen offset:2048 sc1
  v_mfma_f32_16x16x32_bf16 v[100:103], a[180:183], a[84:87], v[100:103]
  ds_read_b64_tr_b16 a[162:163], v224 offset:17408
  v_mfma_f32_16x16x32_bf16 v[100:103], a[176:179], a[68:71], v[100:103]
  v_mfma_f32_16x16x32_bf16 v[104:107], a[176:179], a[72:75], v[104:107]
  ds_read_b64_tr_b16 a[164:165], v224 offset:24576
  v_mfma_f32_16x16x32_bf16 v[104:107], a[180:183], a[88:91], v[104:107]
  buffer_load_dwordx4 v241, s[20:23], s31 offen offset:3072 lds
  s_add_u32 s31, s31, 0x80000
  v_mfma_f32_16x16x32_bf16 v[108:111], a[180:183], a[92:95], v[108:111]
  ds_read_b64_tr_b16 a[166:167], v224 offset:25600
  v_mfma_f32_16x16x32_bf16 v[108:111], a[176:179], a[76:79], v[108:111]
  s_waitcnt lgkmcnt(5)
  v_mfma_f32_16x16x32_bf16 v[112:115], a[184:187], a[64:67], v[112:115]
  ds_read_b64_tr_b16 a[168:169], v225 offset:16384
  s_waitcnt lgkmcnt(4)
  v_mov_b32 v137, -1
  v_mfma_f32_16x16x32_bf16 v[112:115], a[188:191], a[80:83], v[112:115]
  buffer_load_dwordx4 a[60:63], v243, s[24:27], s30 offen offset:3072 sc1
  s_add_u32 s30, s30, 8192
  v_mfma_f32_16x16x32_bf16 v[116:119], a[188:191], a[84:87], v[116:119]
  ds_read_b64_tr_b16 a[170:171], v225 offset:17408
  v_sub_u32 v140, v137, v128
  v_mfma_f32_16x16x32_bf16 v[116:119], a[184:187], a[68:71], v[116:119]
  v_sub_u32 v141, v137, v129
  v_min_u32 v139, v140, v141
  v_mfma_f32_16x16x32_bf16 v[120:123], a[184:187], a[72:75], v[120:123]
  ds_read_b64_tr_b16 a[172:173], v225 offset:24576
  v_min_u32_dpp v139, v139, v139 row_ror:8 row_mask:0xf bank_mask:0xf
  v_mfma_f32_16x16x32_bf16 v[120:123], a[188:191], a[88:91], v[120:123]
  v_mfma_f32_16x16x32_bf16 v[124:127], a[188:191], a[92:95], v[124:127]
  ds_read_b64_tr_b16 a[174:175], v225 offset:25600
  v_min_u32_dpp v139, v139, v139 row_ror:4 row_mask:0xf bank_mask:0xf
  v_mfma_f32_16x16x32_bf16 v[124:127], a[184:187], a[76:79], v[124:127]
  s_waitcnt vmcnt(24) lgkmcnt(4)
  v_min_u32_dpp v139, v139, v139 row_ror:2 row_mask:0xf bank_mask:0xf
  v_mfma_f32_16x16x32_bf16 v[0:3], a[160:163], a[96:99], v[0:3]
  ds_read_b64_tr_b16 a[176:177], v226 offset:16384
  v_min_u32_dpp v139, v139, v139 row_ror:1 row_mask:0xf bank_mask:0xf
  v_mfma_f32_16x16x32_bf16 v[0:3], a[164:167], a[112:115], v[0:3]
  v_mov_b32 v140, v139
  v_mfma_f32_16x16x32_bf16 v[4:7], a[164:167], a[116:119], v[4:7]
  ds_read_b64_tr_b16 a[178:179], v226 offset:17408
  v_permlane16_swap_b32 v139, v140
  v_mfma_f32_16x16x32_bf16 v[4:7], a[160:163], a[100:103], v[4:7]
  v_min_u32 v139, v139, v140
  v_mov_b32 v140, v139
  v_mfma_f32_16x16x32_bf16 v[8:11], a[160:163], a[104:107], v[8:11]
  ds_read_b64_tr_b16 a[180:181], v226 offset:24576
  s_add_u32 m0, s28, 0
  v_permlane32_swap_b32 v139, v140
  v_mfma_f32_16x16x32_bf16 v[8:11], a[164:167], a[120:123], v[8:11]
  buffer_load_dwordx4 v232, s[12:15], s29 offen offset:0 lds
  v_mfma_f32_16x16x32_bf16 v[12:15], a[164:167], a[124:127], v[12:15]
  ds_read_b64_tr_b16 a[182:183], v226 offset:25600
  v_min_u32 v139, v139, v140
  v_mfma_f32_16x16x32_bf16 v[12:15], a[160:163], a[108:111], v[12:15]
  s_waitcnt lgkmcnt(4)
  v_sub_u32 v138, v137, v139
  v_add_u32 v137, -1, v138
  v_mfma_f32_16x16x32_bf16 v[16:19], a[168:171], a[96:99], v[16:19]
  ds_read_b64_tr_b16 a[184:185], v227 offset:16384
  v_sub_u32 v140, v137, v128
  v_mfma_f32_16x16x32_bf16 v[16:19], a[172:175], a[112:115], v[16:19]
  v_readfirstlane_b32 s52, v138
  v_sub_u32 v141, v137, v129
  v_mfma_f32_16x16x32_bf16 v[20:23], a[172:175], a[116:119], v[20:23]
  ds_read_b64_tr_b16 a[186:187], v227 offset:17408
  v_min_u32 v139, v140, v141
  v_mfma_f32_16x16x32_bf16 v[20:23], a[168:171], a[100:103], v[20:23]
  v_mfma_f32_16x16x32_bf16 v[24:27], a[168:171], a[104:107], v[24:27]
  ds_read_b64_tr_b16 a[188:189], v227 offset:24576
  v_min_u32_dpp v139, v139, v139 row_ror:8 row_mask:0xf bank_mask:0xf
  v_mfma_f32_16x16x32_bf16 v[24:27], a[172:175], a[120:123], v[24:27]
  v_mfma_f32_16x16x32_bf16 v[28:31], a[172:175], a[124:127], v[28:31]
  ds_read_b64_tr_b16 a[190:191], v227 offset:25600
  v_min_u32_dpp v139, v139, v139 row_ror:4 row_mask:0xf bank_mask:0xf
  v_mfma_f32_16x16x32_bf16 v[28:31], a[168:171], a[108:111], v[28:31]
  s_waitcnt lgkmcnt(4)
  v_min_u32_dpp v139, v139, v139 row_ror:2 row_mask:0xf bank_mask:0xf
  v_mfma_f32_16x16x32_bf16 v[32:35], a[176:179], a[96:99], v[32:35]
  ds_read_b64_tr_b16 a[160:161], v228 offset:16384
  v_min_u32_dpp v139, v139, v139 row_ror:1 row_mask:0xf bank_mask:0xf
  v_mfma_f32_16x16x32_bf16 v[32:35], a[180:183], a[112:115], v[32:35]
  v_mov_b32 v140, v139
  v_mfma_f32_16x16x32_bf16 v[36:39], a[180:183], a[116:119], v[36:39]
  ds_read_b64_tr_b16 a[162:163], v228 offset:17408
  v_permlane16_swap_b32 v139, v140
  v_mfma_f32_16x16x32_bf16 v[36:39], a[176:179], a[100:103], v[36:39]
  v_min_u32 v139, v139, v140
  v_mov_b32 v140, v139
  v_mfma_f32_16x16x32_bf16 v[40:43], a[176:179], a[104:107], v[40:43]
  ds_read_b64_tr_b16 a[164:165], v228 offset:24576
  v_permlane32_swap_b32 v139, v140
  v_mfma_f32_16x16x32_bf16 v[40:43], a[180:183], a[120:123], v[40:43]
  buffer_load_dwordx4 v233, s[12:15], s29 offen offset:1024 lds
  v_mfma_f32_16x16x32_bf16 v[44:47], a[180:183], a[124:127], v[44:47]
  ds_read_b64_tr_b16 a[166:167], v228 offset:25600
  v_min_u32 v139, v139, v140
  v_mfma_f32_16x16x32_bf16 v[44:47], a[176:179], a[108:111], v[44:47]
  s_waitcnt lgkmcnt(4)
  v_sub_u32 v138, v137, v139
  v_add_u32 v137, -1, v138
  v_mfma_f32_16x16x32_bf16 v[48:51], a[184:187], a[96:99], v[48:51]
  ds_read_b64_tr_b16 a[168:169], v229 offset:16384
  v_sub_u32 v140, v137, v128
  v_mfma_f32_16x16x32_bf16 v[48:51], a[188:191], a[112:115], v[48:51]
  v_readfirstlane_b32 s53, v138
  v_sub_u32 v141, v137, v129
  v_mfma_f32_16x16x32_bf16 v[52:55], a[188:191], a[116:119], v[52:55]
  ds_read_b64_tr_b16 a[170:171], v229 offset:17408
  v_min_u32 v139, v140, v141
  v_mfma_f32_16x16x32_bf16 v[52:55], a[184:187], a[100:103], v[52:55]
  v_mfma_f32_16x16x32_bf16 v[56:59], a[184:187], a[104:107], v[56:59]
  ds_read_b64_tr_b16 a[172:173], v229 offset:24576
  v_min_u32_dpp v139, v139, v139 row_ror:8 row_mask:0xf bank_mask:0xf
  v_mfma_f32_16x16x32_bf16 v[56:59], a[188:191], a[120:123], v[56:59]
  v_mfma_f32_16x16x32_bf16 v[60:63], a[188:191], a[124:127], v[60:63]
  ds_read_b64_tr_b16 a[174:175], v229 offset:25600
  v_min_u32_dpp v139, v139, v139 row_ror:4 row_mask:0xf bank_mask:0xf
  v_mfma_f32_16x16x32_bf16 v[60:63], a[184:187], a[108:111], v[60:63]
  s_waitcnt lgkmcnt(4)
  v_min_u32_dpp v139, v139, v139 row_ror:2 row_mask:0xf bank_mask:0xf
  v_mfma_f32_16x16x32_bf16 v[64:67], a[160:163], a[96:99], v[64:67]
  ds_read_b64_tr_b16 a[176:177], v230 offset:16384
  v_min_u32_dpp v139, v139, v139 row_ror:1 row_mask:0xf bank_mask:0xf
  v_mfma_f32_16x16x32_bf16 v[64:67], a[164:167], a[112:115], v[64:67]
  v_mov_b32 v140, v139
  v_mfma_f32_16x16x32_bf16 v[68:71], a[164:167], a[116:119], v[68:71]
  ds_read_b64_tr_b16 a[178:179], v230 offset:17408
  v_permlane16_swap_b32 v139, v140
  v_mfma_f32_16x16x32_bf16 v[68:71], a[160:163], a[100:103], v[68:71]
  v_min_u32 v139, v139, v140
  v_mov_b32 v140, v139
  v_mfma_f32_16x16x32_bf16 v[72:75], a[160:163], a[104:107], v[72:75]
  ds_read_b64_tr_b16 a[180:181], v230 offset:24576
  v_permlane32_swap_b32 v139, v140
  v_mfma_f32_16x16x32_bf16 v[72:75], a[164:167], a[120:123], v[72:75]
  buffer_load_dwordx4 v234, s[12:15], s29 offen offset:2048 lds
  v_mfma_f32_16x16x32_bf16 v[76:79], a[164:167], a[124:127], v[76:79]
  ds_read_b64_tr_b16 a[182:183], v230 offset:25600
  v_min_u32 v139, v139, v140
  v_mfma_f32_16x16x32_bf16 v[76:79], a[160:163], a[108:111], v[76:79]
  s_waitcnt lgkmcnt(4)
  v_sub_u32 v138, v137, v139
  v_add_u32 v137, -1, v138
  v_mfma_f32_16x16x32_bf16 v[80:83], a[168:171], a[96:99], v[80:83]
  ds_read_b64_tr_b16 a[184:185], v231 offset:16384
  v_sub_u32 v140, v137, v128
  v_mfma_f32_16x16x32_bf16 v[80:83], a[172:175], a[112:115], v[80:83]
  v_readfirstlane_b32 s54, v138
  v_sub_u32 v141, v137, v129
  v_mfma_f32_16x16x32_bf16 v[84:87], a[172:175], a[116:119], v[84:87]
  ds_read_b64_tr_b16 a[186:187], v231 offset:17408
  v_min_u32 v139, v140, v141
  v_mfma_f32_16x16x32_bf16 v[84:87], a[168:171], a[100:103], v[84:87]
  s_waitcnt vmcnt(16)
  v_min_u32_dpp v139, v139, v139 row_ror:8 row_mask:0xf bank_mask:0xf
  v_mfma_f32_16x16x32_bf16 v[88:91], a[168:171], a[104:107], v[88:91]
  ds_read_b64_tr_b16 a[188:189], v231 offset:24576
  v_min_u32_dpp v139, v139, v139 row_ror:4 row_mask:0xf bank_mask:0xf
  v_mfma_f32_16x16x32_bf16 v[88:91], a[172:175], a[120:123], v[88:91]
  s_barrier
  v_min_u32_dpp v139, v139, v139 row_ror:2 row_mask:0xf bank_mask:0xf
  v_mfma_f32_16x16x32_bf16 v[92:95], a[172:175], a[124:127], v[92:95]
  ds_read_b64_tr_b16 a[190:191], v231 offset:25600
  v_min_u32_dpp v139, v139, v139 row_ror:1 row_mask:0xf bank_mask:0xf
  v_mfma_f32_16x16x32_bf16 v[92:95], a[168:171], a[108:111], v[92:95]
  s_waitcnt lgkmcnt(4)
  v_mov_b32 v140, v139
  v_mfma_f32_16x16x32_bf16 v[96:99], a[176:179], a[96:99], v[96:99]
  ds_read_b64_tr_b16 a[160:161], v224 offset:32768
  v_permlane16_swap_b32 v139, v140
  v_mfma_f32_16x16x32_bf16 v[96:99], a[180:183], a[112:115], v[96:99]
  v_min_u32 v139, v139, v140
  v_mov_b32 v140, v139
  v_mfma_f32_16x16x32_bf16 v[100:103], a[180:183], a[116:119], v[100:103]
  ds_read_b64_tr_b16 a[162:163], v224 offset:33792
  v_permlane32_swap_b32 v139, v140
  v_mfma_f32_16x16x32_bf16 v[100:103], a[176:179], a[100:103], v[100:103]
  v_min_u32 v139, v139, v140
  v_sub_u32 v138, v137, v139
  v_mfma_f32_16x16x32_bf16 v[104:107], a[176:179], a[104:107], v[104:107]
  ds_read_b64_tr_b16 a[164:165], v224 offset:40960
  v_add_u32 v137, -1, v138
  v_mfma_f32_16x16x32_bf16 v[104:107], a[180:183], a[120:123], v[104:107]
  buffer_load_dwordx4 v235, s[12:15], s29 offen offset:3072 lds
  v_mfma_f32_16x16x32_bf16 v[108:111], a[180:183], a[124:127], v[108:111]
  ds_read_b64_tr_b16 a[166:167], v224 offset:41984
  v_sub_u32 v140, v137, v128
  v_mfma_f32_16x16x32_bf16 v[108:111], a[176:179], a[108:111], v[108:111]
  s_waitcnt lgkmcnt(4)
  v_readfirstlane_b32 s55, v138
  v_sub_u32 v141, v137, v129
  v_mfma_f32_16x16x32_bf16 v[112:115], a[184:187], a[96:99], v[112:115]
  ds_read_b64_tr_b16 a[168:169], v225 offset:32768
  v_min_u32 v139, v140, v141
  v_mfma_f32_16x16x32_bf16 v[112:115], a[188:191], a[112:115], v[112:115]
  v_mfma_f32_16x16x32_bf16 v[116:119], a[188:191], a[116:119], v[116:119]
  ds_read_b64_tr_b16 a[170:171], v225 offset:33792
  v_min_u32_dpp v139, v139, v139 row_ror:8 row_mask:0xf bank_mask:0xf
  v_mfma_f32_16x16x32_bf16 v[116:119], a[184:187], a[100:103], v[116:119]
  v_mfma_f32_16x16x32_bf16 v[120:123], a[184:187], a[104:107], v[120:123]
  ds_read_b64_tr_b16 a[172:173], v225 offset:40960
  v_min_u32_dpp v139, v139, v139 row_ror:4 row_mask:0xf bank_mask:0xf
  v_mfma_f32_16x16x32_bf16 v[120:123], a[188:191], a[120:123], v[120:123]
  v_mfma_f32_16x16x32_bf16 v[124:127], a[188:191], a[124:127], v[124:127]
  ds_read_b64_tr_b16 a[174:175], v225 offset:41984
  v_min_u32_dpp v139, v139, v139 row_ror:2 row_mask:0xf bank_mask:0xf
  v_mfma_f32_16x16x32_bf16 v[124:127], a[184:187], a[108:111], v[124:127]
  s_waitcnt vmcnt(16) lgkmcnt(4)
  v_min_u32_dpp v139, v139, v139 row_ror:1 row_mask:0xf bank_mask:0xf
  v_mov_b32 v140, v139
  v_mfma_f32_16x16x32_bf16 v[0:3], a[160:163], a[0:3], v[0:3]
  ds_read_b64_tr_b16 a[176:177], v226 offset:32768
  v_permlane16_swap_b32 v139, v140
  v_mfma_f32_16x16x32_bf16 v[0:3], a[164:167], a[16:19], v[0:3]
  v_min_u32 v139, v139, v140
  v_mov_b32 v140, v139
  v_mfma_f32_16x16x32_bf16 v[4:7], a[164:167], a[20:23], v[4:7]
  ds_read_b64_tr_b16 a[178:179], v226 offset:33792
  v_permlane32_swap_b32 v139, v140
  v_mfma_f32_16x16x32_bf16 v[4:7], a[160:163], a[4:7], v[4:7]
  v_min_u32 v139, v139, v140
  v_sub_u32 v138, v137, v139
  v_mfma_f32_16x16x32_bf16 v[8:11], a[160:163], a[8:11], v[8:11]
  ds_read_b64_tr_b16 a[180:181], v226 offset:40960
  s_add_u32 m0, s28, 65536
  v_add_u32 v137, -1, v138
  v_mfma_f32_16x16x32_bf16 v[8:11], a[164:167], a[24:27], v[8:11]
  buffer_load_dwordx4 v236, s[16:19], s29 offen offset:0 lds
  v_mfma_f32_16x16x32_bf16 v[12:15], a[164:167], a[28:31], v[12:15]
  ds_read_b64_tr_b16 a[182:183], v226 offset:41984
  v_sub_u32 v140, v137, v128
  v_mfma_f32_16x16x32_bf16 v[12:15], a[160:163], a[12:15], v[12:15]
  s_waitcnt lgkmcnt(4)
  v_readfirstlane_b32 s56, v138
  v_sub_u32 v141, v137, v129
  v_mfma_f32_16x16x32_bf16 v[16:19], a[168:171], a[0:3], v[16:19]
  ds_read_b64_tr_b16 a[184:185], v227 offset:32768
  v_min_u32 v139, v140, v141
  v_mfma_f32_16x16x32_bf16 v[16:19], a[172:175], a[16:19], v[16:19]
  v_mfma_f32_16x16x32_bf16 v[20:23], a[172:175], a[20:23], v[20:23]
  ds_read_b64_tr_b16 a[186:187], v227 offset:33792
  v_min_u32_dpp v139, v139, v139 row_ror:8 row_mask:0xf bank_mask:0xf
  v_mfma_f32_16x16x32_bf16 v[20:23], a[168:171], a[4:7], v[20:23]
  v_mfma_f32_16x16x32_bf16 v[24:27], a[168:171], a[8:11], v[24:27]
  ds_read_b64_tr_b16 a[188:189], v227 offset:40960
  v_min_u32_dpp v139, v139, v139 row_ror:4 row_mask:0xf bank_mask:0xf
  v_mfma_f32_16x16x32_bf16 v[24:27], a[172:175], a[24:27], v[24:27]
  v_mfma_f32_16x16x32_bf16 v[28:31], a[172:175], a[28:31], v[28:31]
  ds_read_b64_tr_b16 a[190:191], v227 offset:41984
  v_min_u32_dpp v139, v139, v139 row_ror:2 row_mask:0xf bank_mask:0xf
  v_mfma_f32_16x16x32_bf16 v[28:31], a[168:171], a[12:15], v[28:31]
  s_waitcnt lgkmcnt(4)
  v_min_u32_dpp v139, v139, v139 row_ror:1 row_mask:0xf bank_mask:0xf
  v_mov_b32 v140, v139
  v_mfma_f32_16x16x32_bf16 v[32:35], a[176:179], a[0:3], v[32:35]
  ds_read_b64_tr_b16 a[160:161], v228 offset:32768
  v_permlane16_swap_b32 v139, v140
  v_mfma_f32_16x16x32_bf16 v[32:35], a[180:183], a[16:19], v[32:35]
  v_min_u32 v139, v139, v140
  v_mov_b32 v140, v139
  v_mfma_f32_16x16x32_bf16 v[36:39], a[180:183], a[20:23], v[36:39]
  ds_read_b64_tr_b16 a[162:163], v228 offset:33792
  v_permlane32_swap_b32 v139, v140
  v_mfma_f32_16x16x32_bf16 v[36:39], a[176:179], a[4:7], v[36:39]
  v_min_u32 v139, v139, v140
  v_sub_u32 v138, v137, v139
  v_mfma_f32_16x16x32_bf16 v[40:43], a[176:179], a[8:11], v[40:43]
  ds_read_b64_tr_b16 a[164:165], v228 offset:40960
  v_add_u32 v137, -1, v138
  v_mfma_f32_16x16x32_bf16 v[40:43], a[180:183], a[24:27], v[40:43]
  buffer_load_dwordx4 v237, s[16:19], s29 offen offset:1024 lds
  v_mfma_f32_16x16x32_bf16 v[44:47], a[180:183], a[28:31], v[44:47]
  ds_read_b64_tr_b16 a[166:167], v228 offset:41984
  v_sub_u32 v140, v137, v128
  v_mfma_f32_16x16x32_bf16 v[44:47], a[176:179], a[12:15], v[44:47]
  s_waitcnt lgkmcnt(4)
  v_readfirstlane_b32 s57, v138
  v_sub_u32 v141, v137, v129
  v_mfma_f32_16x16x32_bf16 v[48:51], a[184:187], a[0:3], v[48:51]
  ds_read_b64_tr_b16 a[168:169], v229 offset:32768
  v_min_u32 v139, v140, v141
  v_mfma_f32_16x16x32_bf16 v[48:51], a[188:191], a[16:19], v[48:51]
  v_mfma_f32_16x16x32_bf16 v[52:55], a[188:191], a[20:23], v[52:55]
  ds_read_b64_tr_b16 a[170:171], v229 offset:33792
  v_min_u32_dpp v139, v139, v139 row_ror:8 row_mask:0xf bank_mask:0xf
  v_mfma_f32_16x16x32_bf16 v[52:55], a[184:187], a[4:7], v[52:55]
  v_mfma_f32_16x16x32_bf16 v[56:59], a[184:187], a[8:11], v[56:59]
  ds_read_b64_tr_b16 a[172:173], v229 offset:40960
  v_min_u32_dpp v139, v139, v139 row_ror:4 row_mask:0xf bank_mask:0xf
  v_mfma_f32_16x16x32_bf16 v[56:59], a[188:191], a[24:27], v[56:59]
  v_mfma_f32_16x16x32_bf16 v[60:63], a[188:191], a[28:31], v[60:63]
  ds_read_b64_tr_b16 a[174:175], v229 offset:41984
  v_min_u32_dpp v139, v139, v139 row_ror:2 row_mask:0xf bank_mask:0xf
  v_mfma_f32_16x16x32_bf16 v[60:63], a[184:187], a[12:15], v[60:63]
  s_waitcnt lgkmcnt(4)
  v_min_u32_dpp v139, v139, v139 row_ror:1 row_mask:0xf bank_mask:0xf
  v_mov_b32 v140, v139
  v_mfma_f32_16x16x32_bf16 v[64:67], a[160:163], a[0:3], v[64:67]
  ds_read_b64_tr_b16 a[176:177], v230 offset:32768
  v_permlane16_swap_b32 v139, v140
  v_mfma_f32_16x16x32_bf16 v[64:67], a[164:167], a[16:19], v[64:67]
  v_min_u32 v139, v139, v140
  v_mov_b32 v140, v139
  v_mfma_f32_16x16x32_bf16 v[68:71], a[164:167], a[20:23], v[68:71]
  ds_read_b64_tr_b16 a[178:179], v230 offset:33792
  v_permlane32_swap_b32 v139, v140
  v_mfma_f32_16x16x32_bf16 v[68:71], a[160:163], a[4:7], v[68:71]
  v_min_u32 v139, v139, v140
  v_sub_u32 v138, v137, v139
  v_mfma_f32_16x16x32_bf16 v[72:75], a[160:163], a[8:11], v[72:75]
  ds_read_b64_tr_b16 a[180:181], v230 offset:40960
  v_add_u32 v137, -1, v138
  v_mfma_f32_16x16x32_bf16 v[72:75], a[164:167], a[24:27], v[72:75]
  buffer_load_dwordx4 v236, s[16:19], s29 offen offset:2048 lds
  v_mfma_f32_16x16x32_bf16 v[76:79], a[164:167], a[28:31], v[76:79]
  ds_read_b64_tr_b16 a[182:183], v230 offset:41984
  v_sub_u32 v140, v137, v128
  v_mfma_f32_16x16x32_bf16 v[76:79], a[160:163], a[12:15], v[76:79]
  s_waitcnt lgkmcnt(4)
  v_readfirstlane_b32 s58, v138
  v_sub_u32 v141, v137, v129
  v_mfma_f32_16x16x32_bf16 v[80:83], a[168:171], a[0:3], v[80:83]
  ds_read_b64_tr_b16 a[184:185], v231 offset:32768
  v_min_u32 v139, v140, v141
  v_mfma_f32_16x16x32_bf16 v[80:83], a[172:175], a[16:19], v[80:83]
  v_mfma_f32_16x16x32_bf16 v[84:87], a[172:175], a[20:23], v[84:87]
  ds_read_b64_tr_b16 a[186:187], v231 offset:33792
  v_min_u32_dpp v139, v139, v139 row_ror:8 row_mask:0xf bank_mask:0xf
  v_mfma_f32_16x16x32_bf16 v[84:87], a[168:171], a[4:7], v[84:87]
  s_waitcnt vmcnt(8)
  v_min_u32_dpp v139, v139, v139 row_ror:4 row_mask:0xf bank_mask:0xf
  v_mfma_f32_16x16x32_bf16 v[88:91], a[168:171], a[8:11], v[88:91]
  ds_read_b64_tr_b16 a[188:189], v231 offset:40960
  v_min_u32_dpp v139, v139, v139 row_ror:2 row_mask:0xf bank_mask:0xf
  v_mfma_f32_16x16x32_bf16 v[88:91], a[172:175], a[24:27], v[88:91]
  s_barrier
  v_min_u32_dpp v139, v139, v139 row_ror:1 row_mask:0xf bank_mask:0xf
  v_mov_b32 v140, v139
  v_mfma_f32_16x16x32_bf16 v[92:95], a[172:175], a[28:31], v[92:95]
  ds_read_b64_tr_b16 a[190:191], v231 offset:41984
  v_permlane16_swap_b32 v139, v140
  v_mfma_f32_16x16x32_bf16 v[92:95], a[168:171], a[12:15], v[92:95]
  s_waitcnt lgkmcnt(4)
  v_min_u32 v139, v139, v140
  v_mov_b32 v140, v139
  v_mfma_f32_16x16x32_bf16 v[96:99], a[176:179], a[0:3], v[96:99]
  ds_read_b64_tr_b16 a[160:161], v224 offset:49152
  v_permlane32_swap_b32 v139, v140
  v_mfma_f32_16x16x32_bf16 v[96:99], a[180:183], a[16:19], v[96:99]
  v_min_u32 v139, v139, v140
  v_sub_u32 v138, v137, v139
  v_mfma_f32_16x16x32_bf16 v[100:103], a[180:183], a[20:23], v[100:103]
  ds_read_b64_tr_b16 a[162:163], v224 offset:50176
  v_add_u32 v137, -1, v138
  v_mfma_f32_16x16x32_bf16 v[100:103], a[176:179], a[4:7], v[100:103]
  v_readfirstlane_b32 s59, v138
  v_lshrrev_b32 v136, 4, v242
  v_mfma_f32_16x16x32_bf16 v[104:107], a[176:179], a[8:11], v[104:107]
  ds_read_b64_tr_b16 a[164:165], v224 offset:57344
  v_mov_b32 v128, 0
  v_mfma_f32_16x16x32_bf16 v[104:107], a[180:183], a[24:27], v[104:107]
  buffer_load_dwordx4 v237, s[16:19], s29 offen offset:3072 lds
  s_add_u32 s29, s29, 16384
  v_mfma_f32_16x16x32_bf16 v[108:111], a[180:183], a[28:31], v[108:111]
  ds_read_b64_tr_b16 a[166:167], v224 offset:58368
  v_writelane_b32 v128, s52, 0
  v_mfma_f32_16x16x32_bf16 v[108:111], a[176:179], a[12:15], v[108:111]
  s_waitcnt lgkmcnt(4)
  v_writelane_b32 v128, s53, 1
  v_writelane_b32 v128, s54, 2
  v_mfma_f32_16x16x32_bf16 v[112:115], a[184:187], a[0:3], v[112:115]
  ds_read_b64_tr_b16 a[168:169], v225 offset:49152
  v_writelane_b32 v128, s55, 3
  v_mfma_f32_16x16x32_bf16 v[112:115], a[188:191], a[16:19], v[112:115]
  v_writelane_b32 v128, s56, 4
  v_writelane_b32 v128, s57, 5
  v_mfma_f32_16x16x32_bf16 v[116:119], a[188:191], a[20:23], v[116:119]
  ds_read_b64_tr_b16 a[170:171], v225 offset:50176
  v_writelane_b32 v128, s58, 6
  v_mfma_f32_16x16x32_bf16 v[116:119], a[184:187], a[4:7], v[116:119]
  v_writelane_b32 v128, s59, 7
  v_and_b32 v129, 0xffff, v128
  v_mfma_f32_16x16x32_bf16 v[120:123], a[184:187], a[8:11], v[120:123]
  ds_read_b64_tr_b16 a[172:173], v225 offset:57344
  v_sub_u32 v129, 0xffff, v129
  v_mfma_f32_16x16x32_bf16 v[120:123], a[188:191], a[24:27], v[120:123]
  v_and_b32 v129, 0x7ff, v129
  v_mov_b32 v130, v129
  v_mfma_f32_16x16x32_bf16 v[124:127], a[188:191], a[28:31], v[124:127]
  ds_read_b64_tr_b16 a[174:175], v225 offset:58368
  v_permlane16_swap_b32 v129, v130
  v_mfma_f32_16x16x32_bf16 v[124:127], a[184:187], a[12:15], v[124:127]
  s_waitcnt vmcnt(8) lgkmcnt(4)
  v_mov_b32 v130, v129
  v_mfma_f32_16x16x32_bf16 v[0:3], a[160:163], a[32:35], v[0:3]
  ds_read_b64_tr_b16 a[176:177], v226 offset:49152
  s_add_u32 m0, s28, 16384
  v_permlane32_swap_b32 v129, v130
  v_mfma_f32_16x16x32_bf16 v[0:3], a[164:167], a[48:51], v[0:3]
  buffer_load_dwordx4 v232, s[12:15], s29 offen offset:0 lds
  v_mfma_f32_16x16x32_bf16 v[4:7], a[164:167], a[52:55], v[4:7]
  ds_read_b64_tr_b16 a[178:179], v226 offset:50176
  v_lshrrev_b32 v130, 6, v129
  v_mfma_f32_16x16x32_bf16 v[4:7], a[160:163], a[36:39], v[4:7]
  v_mul_u32_u24 v130, 0x14000, v130
  v_bfe_u32 v131, v129, 4, 2
  v_mfma_f32_16x16x32_bf16 v[8:11], a[160:163], a[40:43], v[8:11]
  ds_read_b64_tr_b16 a[180:181], v226 offset:57344
  v_lshl_add_u32 v130, v131, 10, v130
  v_mfma_f32_16x16x32_bf16 v[8:11], a[164:167], a[56:59], v[8:11]
  buffer_load_dwordx4 v233, s[12:15], s29 offen offset:1024 lds
  v_mfma_f32_16x16x32_bf16 v[12:15], a[164:167], a[60:63], v[12:15]
  ds_read_b64_tr_b16 a[182:183], v226 offset:58368
  v_and_b32 v131, 15, v129
  v_mfma_f32_16x16x32_bf16 v[12:15], a[160:163], a[44:47], v[12:15]
  s_waitcnt lgkmcnt(4)
  v_lshl_add_u32 v130, v131, 4, v130
  v_lshrrev_b32 v131, 4, v136
  v_mfma_f32_16x16x32_bf16 v[16:19], a[168:171], a[32:35], v[16:19]
  ds_read_b64_tr_b16 a[184:185], v227 offset:49152
  v_lshl_add_u32 v243, v131, 8, v130
  v_mfma_f32_16x16x32_bf16 v[16:19], a[172:175], a[48:51], v[16:19]
  buffer_load_dwordx4 v234, s[12:15], s29 offen offset:2048 lds
  v_mfma_f32_16x16x32_bf16 v[20:23], a[172:175], a[52:55], v[20:23]
  ds_read_b64_tr_b16 a[186:187], v227 offset:50176
  v_mfma_f32_16x16x32_bf16 v[20:23], a[168:171], a[36:39], v[20:23]
  buffer_load_dwordx4 v235, s[12:15], s29 offen offset:3072 lds
  v_mfma_f32_16x16x32_bf16 v[24:27], a[168:171], a[40:43], v[24:27]
  ds_read_b64_tr_b16 a[188:189], v227 offset:57344
  v_mfma_f32_16x16x32_bf16 v[24:27], a[172:175], a[56:59], v[24:27]
  v_mul_f32 v0, s34, v0
  v_mul_f32 v1, s34, v1
  v_mfma_f32_16x16x32_bf16 v[28:31], a[172:175], a[60:63], v[28:31]
  ds_read_b64_tr_b16 a[190:191], v227 offset:58368
  v_mul_f32 v2, s34, v2
  v_mfma_f32_16x16x32_bf16 v[28:31], a[168:171], a[44:47], v[28:31]
  s_waitcnt lgkmcnt(4)
  v_mul_f32 v3, s34, v3
  v_mul_f32 v16, s34, v16
  v_mfma_f32_16x16x32_bf16 v[32:35], a[176:179], a[32:35], v[32:35]
  ds_read_b64_tr_b16 a[160:161], v228 offset:49152
  v_mul_f32 v17, s34, v17
  v_mfma_f32_16x16x32_bf16 v[32:35], a[180:183], a[48:51], v[32:35]
  v_mul_f32 v18, s34, v18
  v_mul_f32 v19, s34, v19
  v_mfma_f32_16x16x32_bf16 v[36:39], a[180:183], a[52:55], v[36:39]
  ds_read_b64_tr_b16 a[162:163], v228 offset:50176
  v_cvt_pk_bf16_f32 v128, v0, v1
  v_mfma_f32_16x16x32_bf16 v[36:39], a[176:179], a[36:39], v[36:39]
  v_cvt_pk_bf16_f32 v129, v2, v3
  v_cvt_pk_bf16_f32 v130, v16, v17
  v_mfma_f32_16x16x32_bf16 v[40:43], a[176:179], a[40:43], v[40:43]
  ds_read_b64_tr_b16 a[164:165], v228 offset:57344
  v_cvt_pk_bf16_f32 v131, v18, v19
  v_mfma_f32_16x16x32_bf16 v[40:43], a[180:183], a[56:59], v[40:43]
  v_mul_f32 v4, s34, v4
  v_mul_f32 v5, s34, v5
  v_mfma_f32_16x16x32_bf16 v[44:47], a[180:183], a[60:63], v[44:47]
  ds_read_b64_tr_b16 a[166:167], v228 offset:58368
  v_mul_f32 v6, s34, v6
  v_mfma_f32_16x16x32_bf16 v[44:47], a[176:179], a[44:47], v[44:47]
  s_waitcnt lgkmcnt(4)
  v_mul_f32 v7, s34, v7
  v_mul_f32 v20, s34, v20
  v_mfma_f32_16x16x32_bf16 v[48:51], a[184:187], a[32:35], v[48:51]
  ds_read_b64_tr_b16 a[168:169], v229 offset:49152
  v_mul_f32 v21, s34, v21
  v_mfma_f32_16x16x32_bf16 v[48:51], a[188:191], a[48:51], v[48:51]
  v_mul_f32 v22, s34, v22
  v_mul_f32 v23, s34, v23
  v_mfma_f32_16x16x32_bf16 v[52:55], a[188:191], a[52:55], v[52:55]
  ds_read_b64_tr_b16 a[170:171], v229 offset:50176
  v_cvt_pk_bf16_f32 v144, v4, v5
  v_mfma_f32_16x16x32_bf16 v[52:55], a[184:187], a[36:39], v[52:55]
  v_cvt_pk_bf16_f32 v145, v6, v7
  v_cvt_pk_bf16_f32 v146, v20, v21
  v_mfma_f32_16x16x32_bf16 v[56:59], a[184:187], a[40:43], v[56:59]
  ds_read_b64_tr_b16 a[172:173], v229 offset:57344
  v_cvt_pk_bf16_f32 v147, v22, v23
  v_mfma_f32_16x16x32_bf16 v[56:59], a[188:191], a[56:59], v[56:59]
  v_permlane16_swap_b32 v128, v130
  v_permlane16_swap_b32 v129, v131
  v_mfma_f32_16x16x32_bf16 v[60:63], a[188:191], a[60:63], v[60:63]
  ds_read_b64_tr_b16 a[174:175], v229 offset:58368
  v_mul_f32 v8, s34, v8
  v_mfma_f32_16x16x32_bf16 v[60:63], a[184:187], a[44:47], v[60:63]
  s_waitcnt lgkmcnt(4)
  v_mul_f32 v9, s34, v9
  v_mul_f32 v10, s34, v10
  v_mfma_f32_16x16x32_bf16 v[64:67], a[160:163], a[32:35], v[64:67]
  ds_read_b64_tr_b16 a[176:177], v230 offset:49152
  v_mul_f32 v11, s34, v11
  v_mfma_f32_16x16x32_bf16 v[64:67], a[164:167], a[48:51], v[64:67]
  v_mul_f32 v24, s34, v24
  v_mul_f32 v25, s34, v25
  v_mfma_f32_16x16x32_bf16 v[68:71], a[164:167], a[52:55], v[68:71]
  ds_read_b64_tr_b16 a[178:179], v230 offset:50176
  v_mul_f32 v26, s34, v26
  v_mfma_f32_16x16x32_bf16 v[68:71], a[160:163], a[36:39], v[68:71]
  v_mul_f32 v27, s34, v27
  v_cvt_pk_bf16_f32 v160, v8, v9
  v_mfma_f32_16x16x32_bf16 v[72:75], a[160:163], a[40:43], v[72:75]
  ds_read_b64_tr_b16 a[180:181], v230 offset:57344
  v_cvt_pk_bf16_f32 v161, v10, v11
  v_mfma_f32_16x16x32_bf16 v[72:75], a[164:167], a[56:59], v[72:75]
  v_cvt_pk_bf16_f32 v162, v24, v25
  v_cvt_pk_bf16_f32 v163, v26, v27
  v_mfma_f32_16x16x32_bf16 v[76:79], a[164:167], a[60:63], v[76:79]
  ds_read_b64_tr_b16 a[182:183], v230 offset:58368
  v_permlane16_swap_b32 v144, v146
  v_mfma_f32_16x16x32_bf16 v[76:79], a[160:163], a[44:47], v[76:79]
  s_waitcnt lgkmcnt(4)
  v_permlane16_swap_b32 v145, v147
  v_mul_f32 v12, s34, v12
  v_mfma_f32_16x16x32_bf16 v[80:83], a[168:171], a[32:35], v[80:83]
  ds_read_b64_tr_b16 a[184:185], v231 offset:49152
  v_mul_f32 v13, s34, v13
  v_mfma_f32_16x16x32_bf16 v[80:83], a[172:175], a[48:51], v[80:83]
  v_mul_f32 v14, s34, v14
  v_mul_f32 v15, s34, v15
  v_mfma_f32_16x16x32_bf16 v[84:87], a[172:175], a[52:55], v[84:87]
  ds_read_b64_tr_b16 a[186:187], v231 offset:50176
  v_mul_f32 v28, s34, v28
  v_mfma_f32_16x16x32_bf16 v[84:87], a[168:171], a[36:39], v[84:87]
  s_waitcnt vmcnt(8)
  v_mul_f32 v29, s34, v29
  v_mul_f32 v30, s34, v30
  v_mfma_f32_16x16x32_bf16 v[88:91], a[168:171], a[40:43], v[88:91]
  ds_read_b64_tr_b16 a[188:189], v231 offset:57344
  v_mul_f32 v31, s34, v31
  v_mfma_f32_16x16x32_bf16 v[88:91], a[172:175], a[56:59], v[88:91]
  s_barrier
  v_cvt_pk_bf16_f32 v176, v12, v13
  v_cvt_pk_bf16_f32 v177, v14, v15
  v_mfma_f32_16x16x32_bf16 v[92:95], a[172:175], a[60:63], v[92:95]
  ds_read_b64_tr_b16 a[190:191], v231 offset:58368
  v_cvt_pk_bf16_f32 v178, v28, v29
  v_mfma_f32_16x16x32_bf16 v[92:95], a[168:171], a[44:47], v[92:95]
  s_waitcnt lgkmcnt(4)
  v_cvt_pk_bf16_f32 v179, v30, v31
  v_permlane16_swap_b32 v160, v162
  v_mfma_f32_16x16x32_bf16 v[96:99], a[176:179], a[32:35], v[96:99]
  ds_read_b128 a[128:131], v212 offset:0
  v_permlane16_swap_b32 v161, v163
  v_mfma_f32_16x16x32_bf16 v[96:99], a[180:183], a[48:51], v[96:99]
  v_mul_f32 v32, s34, v32
  v_mul_f32 v33, s34, v33
  v_mfma_f32_16x16x32_bf16 v[100:103], a[180:183], a[52:55], v[100:103]
  ds_read_b128 a[132:135], v213 offset:0
  v_mul_f32 v34, s34, v34
  v_mfma_f32_16x16x32_bf16 v[100:103], a[176:179], a[36:39], v[100:103]
  v_mul_f32 v35, s34, v35
  v_mul_f32 v48, s34, v48
  v_mfma_f32_16x16x32_bf16 v[104:107], a[176:179], a[40:43], v[104:107]
  ds_read_b128 a[136:139], v214 offset:0
  v_mul_f32 v49, s34, v49
  v_mfma_f32_16x16x32_bf16 v[104:107], a[180:183], a[56:59], v[104:107]
  v_mul_f32 v50, s34, v50
  v_mul_f32 v51, s34, v51
  v_mfma_f32_16x16x32_bf16 v[108:111], a[180:183], a[60:63], v[108:111]
  ds_read_b128 a[140:143], v215 offset:0
  v_cvt_pk_bf16_f32 v132, v32, v33
  v_mfma_f32_16x16x32_bf16 v[108:111], a[176:179], a[44:47], v[108:111]
  s_waitcnt lgkmcnt(4)
  v_cvt_pk_bf16_f32 v133, v34, v35
  v_cvt_pk_bf16_f32 v134, v48, v49
  v_mfma_f32_16x16x32_bf16 v[112:115], a[184:187], a[32:35], v[112:115]
  v_cvt_pk_bf16_f32 v135, v50, v51
  v_permlane16_swap_b32 v176, v178
  v_mfma_f32_16x16x32_bf16 v[112:115], a[188:191], a[48:51], v[112:115]
  v_permlane16_swap_b32 v177, v179
  v_mul_f32 v36, s34, v36
  v_mfma_f32_16x16x32_bf16 v[116:119], a[188:191], a[52:55], v[116:119]
  v_mul_f32 v37, s34, v37
  v_mul_f32 v38, s34, v38
  v_mfma_f32_16x16x32_bf16 v[116:119], a[184:187], a[36:39], v[116:119]
  v_mul_f32 v39, s34, v39
  v_mul_f32 v52, s34, v52
  v_mfma_f32_16x16x32_bf16 v[120:123], a[184:187], a[40:43], v[120:123]
  v_mul_f32 v53, s34, v53
  v_mul_f32 v54, s34, v54
  v_mfma_f32_16x16x32_bf16 v[120:123], a[188:191], a[56:59], v[120:123]
  v_mul_f32 v55, s34, v55
  v_cvt_pk_bf16_f32 v148, v36, v37
  v_mfma_f32_16x16x32_bf16 v[124:127], a[188:191], a[60:63], v[124:127]
  v_cvt_pk_bf16_f32 v149, v38, v39
  v_cvt_pk_bf16_f32 v150, v52, v53
  v_mfma_f32_16x16x32_bf16 v[124:127], a[184:187], a[44:47], v[124:127]
  s_waitcnt lgkmcnt(0)
  v_cvt_pk_bf16_f32 v151, v54, v55
  v_permlane16_swap_b32 v132, v134
  v_permlane16_swap_b32 v133, v135
  v_pk_mul_f32 v[40:41], v[40:41], s[34:35] op_sel_hi:[1,0]
  v_pk_mul_f32 v[42:43], v[42:43], s[34:35] op_sel_hi:[1,0]
  v_pk_mul_f32 v[56:57], v[56:57], s[34:35] op_sel_hi:[1,0]
  v_pk_mul_f32 v[58:59], v[58:59], s[34:35] op_sel_hi:[1,0]
  v_cvt_pk_bf16_f32 v164, v40, v41
  v_cvt_pk_bf16_f32 v165, v42, v43
  v_cvt_pk_bf16_f32 v166, v56, v57
  v_cvt_pk_bf16_f32 v167, v58, v59
  v_permlane16_swap_b32 v148, v150
  v_permlane16_swap_b32 v149, v151
  v_pk_mul_f32 v[44:45], v[44:45], s[34:35] op_sel_hi:[1,0]
  v_pk_mul_f32 v[46:47], v[46:47], s[34:35] op_sel_hi:[1,0]
  v_pk_mul_f32 v[60:61], v[60:61], s[34:35] op_sel_hi:[1,0]
  v_pk_mul_f32 v[62:63], v[62:63], s[34:35] op_sel_hi:[1,0]
  v_cvt_pk_bf16_f32 v180, v44, v45
  v_cvt_pk_bf16_f32 v181, v46, v47
  v_cvt_pk_bf16_f32 v182, v60, v61
  v_cvt_pk_bf16_f32 v183, v62, v63
  v_permlane16_swap_b32 v164, v166
  v_permlane16_swap_b32 v165, v167
  v_pk_mul_f32 v[64:65], v[64:65], s[34:35] op_sel_hi:[1,0]
  v_pk_mul_f32 v[66:67], v[66:67], s[34:35] op_sel_hi:[1,0]
  v_pk_mul_f32 v[80:81], v[80:81], s[34:35] op_sel_hi:[1,0]
  v_pk_mul_f32 v[82:83], v[82:83], s[34:35] op_sel_hi:[1,0]
  v_cvt_pk_bf16_f32 v136, v64, v65
  v_cvt_pk_bf16_f32 v137, v66, v67
  v_cvt_pk_bf16_f32 v138, v80, v81
  v_cvt_pk_bf16_f32 v139, v82, v83
  v_permlane16_swap_b32 v180, v182
  v_permlane16_swap_b32 v181, v183
  v_pk_mul_f32 v[68:69], v[68:69], s[34:35] op_sel_hi:[1,0]
  v_pk_mul_f32 v[70:71], v[70:71], s[34:35] op_sel_hi:[1,0]
  v_pk_mul_f32 v[84:85], v[84:85], s[34:35] op_sel_hi:[1,0]
  v_pk_mul_f32 v[86:87], v[86:87], s[34:35] op_sel_hi:[1,0]
  v_cvt_pk_bf16_f32 v152, v68, v69
  v_cvt_pk_bf16_f32 v153, v70, v71
  v_cvt_pk_bf16_f32 v154, v84, v85
  v_cvt_pk_bf16_f32 v155, v86, v87
  v_permlane16_swap_b32 v136, v138
  v_permlane16_swap_b32 v137, v139
  v_pk_mul_f32 v[72:73], v[72:73], s[34:35] op_sel_hi:[1,0]
  v_pk_mul_f32 v[74:75], v[74:75], s[34:35] op_sel_hi:[1,0]
  v_pk_mul_f32 v[88:89], v[88:89], s[34:35] op_sel_hi:[1,0]
  v_pk_mul_f32 v[90:91], v[90:91], s[34:35] op_sel_hi:[1,0]
  v_cvt_pk_bf16_f32 v168, v72, v73
  v_cvt_pk_bf16_f32 v169, v74, v75
  v_cvt_pk_bf16_f32 v170, v88, v89
  v_cvt_pk_bf16_f32 v171, v90, v91
  v_permlane16_swap_b32 v152, v154
  v_permlane16_swap_b32 v153, v155
  v_pk_mul_f32 v[76:77], v[76:77], s[34:35] op_sel_hi:[1,0]
  v_pk_mul_f32 v[78:79], v[78:79], s[34:35] op_sel_hi:[1,0]
  v_pk_mul_f32 v[92:93], v[92:93], s[34:35] op_sel_hi:[1,0]
  v_pk_mul_f32 v[94:95], v[94:95], s[34:35] op_sel_hi:[1,0]
  v_cvt_pk_bf16_f32 v184, v76, v77
  v_cvt_pk_bf16_f32 v185, v78, v79
  v_cvt_pk_bf16_f32 v186, v92, v93
  v_cvt_pk_bf16_f32 v187, v94, v95
  v_permlane16_swap_b32 v168, v170
  v_permlane16_swap_b32 v169, v171
  v_pk_mul_f32 v[96:97], v[96:97], s[34:35] op_sel_hi:[1,0]
  v_pk_mul_f32 v[98:99], v[98:99], s[34:35] op_sel_hi:[1,0]
  v_pk_mul_f32 v[112:113], v[112:113], s[34:35] op_sel_hi:[1,0]
  v_pk_mul_f32 v[114:115], v[114:115], s[34:35] op_sel_hi:[1,0]
  v_cvt_pk_bf16_f32 v140, v96, v97
  v_cvt_pk_bf16_f32 v141, v98, v99
  v_cvt_pk_bf16_f32 v142, v112, v113
  v_cvt_pk_bf16_f32 v143, v114, v115
  v_permlane16_swap_b32 v184, v186
  v_permlane16_swap_b32 v185, v187
  v_pk_mul_f32 v[100:101], v[100:101], s[34:35] op_sel_hi:[1,0]
  v_pk_mul_f32 v[102:103], v[102:103], s[34:35] op_sel_hi:[1,0]
  v_pk_mul_f32 v[116:117], v[116:117], s[34:35] op_sel_hi:[1,0]
  v_pk_mul_f32 v[118:119], v[118:119], s[34:35] op_sel_hi:[1,0]
  v_cvt_pk_bf16_f32 v156, v100, v101
  v_cvt_pk_bf16_f32 v157, v102, v103
  v_cvt_pk_bf16_f32 v158, v116, v117
  v_cvt_pk_bf16_f32 v159, v118, v119
  v_permlane16_swap_b32 v140, v142
  v_permlane16_swap_b32 v141, v143
  v_pk_mul_f32 v[104:105], v[104:105], s[34:35] op_sel_hi:[1,0]
  v_pk_mul_f32 v[106:107], v[106:107], s[34:35] op_sel_hi:[1,0]
  v_pk_mul_f32 v[120:121], v[120:121], s[34:35] op_sel_hi:[1,0]
  v_pk_mul_f32 v[122:123], v[122:123], s[34:35] op_sel_hi:[1,0]
  v_cvt_pk_bf16_f32 v172, v104, v105
  v_cvt_pk_bf16_f32 v173, v106, v107
  v_cvt_pk_bf16_f32 v174, v120, v121
  v_cvt_pk_bf16_f32 v175, v122, v123
  v_permlane16_swap_b32 v156, v158
  v_permlane16_swap_b32 v157, v159
  v_pk_mul_f32 v[108:109], v[108:109], s[34:35] op_sel_hi:[1,0]
  v_pk_mul_f32 v[110:111], v[110:111], s[34:35] op_sel_hi:[1,0]
  v_pk_mul_f32 v[124:125], v[124:125], s[34:35] op_sel_hi:[1,0]
  v_pk_mul_f32 v[126:127], v[126:127], s[34:35] op_sel_hi:[1,0]
  v_cvt_pk_bf16_f32 v188, v108, v109
  v_cvt_pk_bf16_f32 v189, v110, v111
  v_cvt_pk_bf16_f32 v190, v124, v125
  v_cvt_pk_bf16_f32 v191, v126, v127
  v_permlane16_swap_b32 v172, v174
  v_permlane16_swap_b32 v173, v175
  v_permlane16_swap_b32 v188, v190
  v_permlane16_swap_b32 v189, v191
  v_mfma_f32_16x16x32_bf16 v[0:3], a[128:131], v[128:131], 0
  s_add_u32 m0, s28, 81920
  ds_read_b128 a[144:147], v212 offset:4096
  s_mov_b32 s20, s90
  s_mov_b32 s21, s91
  v_mfma_f32_16x16x32_bf16 v[0:3], a[132:135], v[132:135], v[0:3]
  buffer_load_dwordx4 v236, s[16:19], s29 offen offset:0 lds
  s_mov_b32 s22, 2211840
  s_mov_b32 s23, 0x20000
  s_mov_b32 s44, s92
  v_mfma_f32_16x16x32_bf16 v[0:3], a[136:139], v[136:139], v[0:3]
  ds_read_b128 a[148:151], v213 offset:4096
  s_mov_b32 s45, s93
  s_mov_b32 s46, 2211840
  s_mov_b32 s47, 0x20000
  v_lshrrev_b32 v253, 4, v242
  v_mfma_f32_16x16x32_bf16 v[0:3], a[140:143], v[140:143], v[0:3]
  buffer_load_dwordx4 v237, s[16:19], s29 offen offset:1024 lds
  v_mfma_f32_16x16x32_bf16 v[8:11], a[140:143], v[156:159], 0
  ds_read_b128 a[152:155], v214 offset:4096
  v_mul_u32_u24 v253, 0xd80, v253
  v_mfma_f32_16x16x32_bf16 v[8:11], a[136:139], v[152:155], v[8:11]
  buffer_load_dwordx4 v236, s[16:19], s29 offen offset:2048 lds
  s_mul_i32 s35, s3, 552960
  s_lshl_b32 s38, s33, 4
  s_add_u32 s35, s35, s38
  v_mfma_f32_16x16x32_bf16 v[8:11], a[132:135], v[148:151], v[8:11]
  ds_read_b128 a[156:159], v215 offset:4096
  v_mfma_f32_16x16x32_bf16 v[8:11], a[128:131], v[144:147], v[8:11]
  buffer_load_dwordx4 v237, s[16:19], s29 offen offset:3072 lds
  v_mfma_f32_16x16x32_bf16 v[16:19], a[128:131], v[160:163], 0
  s_add_u32 s29, s29, 16384
  s_add_u32 m0, s28, 32768
  v_mfma_f32_16x16x32_bf16 v[16:19], a[132:135], v[164:167], v[16:19]
  buffer_load_dwordx4 v232, s[12:15], s29 offen offset:0 lds
  v_mfma_f32_16x16x32_bf16 v[16:19], a[136:139], v[168:171], v[16:19]
  buffer_load_dwordx4 v233, s[12:15], s29 offen offset:1024 lds
  v_mfma_f32_16x16x32_bf16 v[16:19], a[140:143], v[172:175], v[16:19]
  v_max3_f32 v192, v0, v1, v2
  v_max3_f32 v196, v8, v9, v10
  v_mfma_f32_16x16x32_bf16 v[24:27], a[140:143], v[188:191], 0
  v_max_f32 v192, v192, v3
  v_max_f32 v196, v196, v11
  v_mfma_f32_16x16x32_bf16 v[24:27], a[136:139], v[184:187], v[24:27]
  v_mov_b32 v245, v192
  v_mov_b32 v246, v196
  v_mfma_f32_16x16x32_bf16 v[24:27], a[132:135], v[180:183], v[24:27]
  v_permlane16_swap_b32 v192, v245
  v_permlane16_swap_b32 v196, v246
  v_mfma_f32_16x16x32_bf16 v[24:27], a[128:131], v[176:179], v[24:27]
  s_waitcnt lgkmcnt(0)
  v_max_f32 v192, v192, v245
  v_max_f32 v196, v196, v246
  v_mfma_f32_16x16x32_bf16 v[4:7], a[144:147], v[128:131], 0
  ds_read_b128 a[128:131], v212 offset:8192
  v_mov_b32 v245, v192
  v_mfma_f32_16x16x32_bf16 v[4:7], a[148:151], v[132:135], v[4:7]
  v_mov_b32 v246, v196
  v_permlane32_swap_b32 v192, v245
  v_mfma_f32_16x16x32_bf16 v[4:7], a[152:155], v[136:139], v[4:7]
  ds_read_b128 a[132:135], v213 offset:8192
  v_permlane32_swap_b32 v196, v246
  v_mfma_f32_16x16x32_bf16 v[4:7], a[156:159], v[140:143], v[4:7]
  v_max_f32 v192, v192, v245
  v_max_f32 v196, v196, v246
  v_mfma_f32_16x16x32_bf16 v[12:15], a[156:159], v[156:159], 0
  ds_read_b128 a[136:139], v214 offset:8192
  v_sub_f32 v193, 0, v192
  v_mfma_f32_16x16x32_bf16 v[12:15], a[152:155], v[152:155], v[12:15]
  v_sub_f32 v197, 0, v196
  v_sub_f32 v194, 0, v192
  v_mfma_f32_16x16x32_bf16 v[12:15], a[148:151], v[148:151], v[12:15]
  ds_read_b128 a[140:143], v215 offset:8192
  v_sub_f32 v198, 0, v196
  v_mfma_f32_16x16x32_bf16 v[12:15], a[144:147], v[144:147], v[12:15]
  v_sub_f32 v195, 0, v192
  v_sub_f32 v199, 0, v196
  v_mfma_f32_16x16x32_bf16 v[20:23], a[144:147], v[160:163], 0
  buffer_load_dwordx4 v234, s[12:15], s29 offen offset:2048 lds
  v_mfma_f32_16x16x32_bf16 v[20:23], a[148:151], v[164:167], v[20:23]
  v_sub_f32 v192, 0, v192
  v_sub_f32 v196, 0, v196
  v_mfma_f32_16x16x32_bf16 v[20:23], a[152:155], v[168:171], v[20:23]
  buffer_load_dwordx4 v235, s[12:15], s29 offen offset:3072 lds
  v_mfma_f32_16x16x32_bf16 v[20:23], a[156:159], v[172:175], v[20:23]
  v_max3_f32 v200, v16, v17, v18
  v_max3_f32 v204, v24, v25, v26
  v_mfma_f32_16x16x32_bf16 v[28:31], a[156:159], v[188:191], 0
  v_max_f32 v200, v200, v19
  v_max_f32 v204, v204, v27
  v_mfma_f32_16x16x32_bf16 v[28:31], a[152:155], v[184:187], v[28:31]
  v_mov_b32 v247, v200
  v_mov_b32 v248, v204
  v_mfma_f32_16x16x32_bf16 v[28:31], a[148:151], v[180:183], v[28:31]
  v_permlane16_swap_b32 v200, v247
  v_permlane16_swap_b32 v204, v248
  v_max_f32 v200, v200, v247
  v_max_f32 v204, v204, v248
  v_mov_b32 v247, v200
  v_mov_b32 v248, v204
  s_nop 0
  v_permlane32_swap_b32 v200, v247
  v_permlane32_swap_b32 v204, v248
  v_max_f32 v200, v200, v247
  v_max_f32 v204, v204, v248
  v_sub_f32 v201, 0, v200
  v_sub_f32 v205, 0, v204
  v_sub_f32 v202, 0, v200
  v_sub_f32 v206, 0, v204
  v_sub_f32 v203, 0, v200
  v_sub_f32 v207, 0, v204
  v_sub_f32 v200, 0, v200
  v_sub_f32 v204, 0, v204
  v_mfma_f32_16x16x32_bf16 v[28:31], a[144:147], v[176:179], v[28:31]
  s_waitcnt lgkmcnt(0)
  v_add_f32 v0, v192, v0
  v_add_f32 v1, v192, v1
  v_mfma_f32_16x16x32_bf16 v[32:35], a[128:131], v[128:131], v[192:195]
  ds_read_b128 a[144:147], v212 offset:12288
  v_add_f32 v2, v192, v2
  v_mfma_f32_16x16x32_bf16 v[32:35], a[132:135], v[132:135], v[32:35]
  v_add_f32 v3, v192, v3
  v_mfma_f32_16x16x32_bf16 v[32:35], a[136:139], v[136:139], v[32:35]
  ds_read_b128 a[148:151], v213 offset:12288
  v_mfma_f32_16x16x32_bf16 v[32:35], a[140:143], v[140:143], v[32:35]
  v_exp_f32 v0, v0
  v_mfma_f32_16x16x32_bf16 v[40:43], a[140:143], v[156:159], v[196:199]
  ds_read_b128 a[152:155], v214 offset:12288
  v_mfma_f32_16x16x32_bf16 v[40:43], a[136:139], v[152:155], v[40:43]
  v_exp_f32 v1, v1
  v_mfma_f32_16x16x32_bf16 v[40:43], a[132:135], v[148:151], v[40:43]
  ds_read_b128 a[156:159], v215 offset:12288
  v_mfma_f32_16x16x32_bf16 v[40:43], a[128:131], v[144:147], v[40:43]
  v_exp_f32 v2, v2
  v_mfma_f32_16x16x32_bf16 v[48:51], a[128:131], v[160:163], v[200:203]
  s_add_u32 m0, s50, 0
  v_cvt_pk_bf16_f32 v0, v0, v1
  v_mfma_f32_16x16x32_bf16 v[48:51], a[132:135], v[164:167], v[48:51]
  v_exp_f32 v3, v3
  v_mfma_f32_16x16x32_bf16 v[48:51], a[136:139], v[168:171], v[48:51]
  v_add_f32 v8, v196, v8
  v_add_f32 v9, v196, v9
  v_mfma_f32_16x16x32_bf16 v[48:51], a[140:143], v[172:175], v[48:51]
  v_add_f32 v10, v196, v10
  v_add_f32 v11, v196, v11
  v_mfma_f32_16x16x32_bf16 v[56:59], a[140:143], v[188:191], v[204:207]
  v_exp_f32 v8, v8
  v_mfma_f32_16x16x32_bf16 v[56:59], a[136:139], v[184:187], v[56:59]
  v_exp_f32 v9, v9
  buffer_load_dwordx4 v253, s[20:23], s35 offen lds
  v_mfma_f32_16x16x32_bf16 v[56:59], a[132:135], v[180:183], v[56:59]
  v_exp_f32 v10, v10
  v_mfma_f32_16x16x32_bf16 v[56:59], a[128:131], v[176:179], v[56:59]
  s_waitcnt lgkmcnt(0)
  v_cvt_pk_bf16_f32 v8, v8, v9
  v_mfma_f32_16x16x32_bf16 v[36:39], a[144:147], v[128:131], v[192:195]
  s_waitcnt vmcnt(9)
  v_exp_f32 v11, v11
  v_mfma_f32_16x16x32_bf16 v[36:39], a[148:151], v[132:135], v[36:39]
  s_barrier
  v_cvt_pk_bf16_f32 v1, v2, v3
  v_add_f32 v16, v200, v16
  v_mfma_f32_16x16x32_bf16 v[36:39], a[152:155], v[136:139], v[36:39]
  ds_read_b128 a[128:131], v212 offset:16384
  v_add_f32 v17, v200, v17
  v_mfma_f32_16x16x32_bf16 v[36:39], a[156:159], v[140:143], v[36:39]
  v_add_f32 v18, v200, v18
  v_add_f32 v19, v200, v19
  v_mfma_f32_16x16x32_bf16 v[44:47], a[156:159], v[156:159], v[196:199]
  ds_read_b128 a[132:135], v213 offset:16384
  v_mfma_f32_16x16x32_bf16 v[44:47], a[152:155], v[152:155], v[44:47]
  v_exp_f32 v16, v16
  v_mfma_f32_16x16x32_bf16 v[44:47], a[148:151], v[148:151], v[44:47]
  ds_read_b128 a[136:139], v214 offset:16384
  v_mfma_f32_16x16x32_bf16 v[44:47], a[144:147], v[144:147], v[44:47]
  v_exp_f32 v17, v17
  v_mfma_f32_16x16x32_bf16 v[52:55], a[144:147], v[160:163], v[200:203]
  ds_read_b128 a[140:143], v215 offset:16384
  v_mfma_f32_16x16x32_bf16 v[52:55], a[148:151], v[164:167], v[52:55]
  v_exp_f32 v18, v18
  v_mfma_f32_16x16x32_bf16 v[52:55], a[152:155], v[168:171], v[52:55]
  v_cvt_pk_bf16_f32 v16, v16, v17
  v_mfma_f32_16x16x32_bf16 v[52:55], a[156:159], v[172:175], v[52:55]
  v_exp_f32 v19, v19
  v_mfma_f32_16x16x32_bf16 v[60:63], a[156:159], v[188:191], v[204:207]
  v_cvt_pk_bf16_f32 v9, v10, v11
  v_add_f32 v24, v204, v24
  v_mfma_f32_16x16x32_bf16 v[60:63], a[152:155], v[184:187], v[60:63]
  v_add_f32 v25, v204, v25
  v_add_f32 v26, v204, v26
  v_mfma_f32_16x16x32_bf16 v[60:63], a[148:151], v[180:183], v[60:63]
  v_add_f32 v27, v204, v27
  v_mfma_f32_16x16x32_bf16 v[60:63], a[144:147], v[176:179], v[60:63]
  s_waitcnt lgkmcnt(0)
  v_exp_f32 v24, v24
  v_exp_f32 v25, v25
  v_exp_f32 v26, v26
  v_cvt_pk_bf16_f32 v24, v24, v25
  v_exp_f32 v27, v27
  v_cvt_pk_bf16_f32 v17, v18, v19
  v_add_f32 v4, v192, v4
  v_add_f32 v5, v192, v5
  v_add_f32 v6, v192, v6
  v_add_f32 v7, v192, v7
  v_exp_f32 v4, v4
  v_exp_f32 v5, v5
  v_exp_f32 v6, v6
  v_cvt_pk_bf16_f32 v2, v4, v5
  v_exp_f32 v7, v7
  v_cvt_pk_bf16_f32 v25, v26, v27
  v_add_f32 v12, v196, v12
  v_add_f32 v13, v196, v13
  v_add_f32 v14, v196, v14
  v_add_f32 v15, v196, v15
  v_exp_f32 v12, v12
  v_exp_f32 v13, v13
  v_exp_f32 v14, v14
  v_cvt_pk_bf16_f32 v10, v12, v13
  v_exp_f32 v15, v15
  v_cvt_pk_bf16_f32 v3, v6, v7
  v_add_f32 v20, v200, v20
  v_add_f32 v21, v200, v21
  v_add_f32 v22, v200, v22
  v_add_f32 v23, v200, v23
  v_exp_f32 v20, v20
  v_exp_f32 v21, v21
  v_exp_f32 v22, v22
  v_cvt_pk_bf16_f32 v18, v20, v21
  v_exp_f32 v23, v23
  v_cvt_pk_bf16_f32 v11, v14, v15
  v_add_f32 v28, v204, v28
  v_add_f32 v29, v204, v29
  v_add_f32 v30, v204, v30
  v_add_f32 v31, v204, v31
  v_exp_f32 v28, v28
  v_exp_f32 v29, v29
  v_exp_f32 v30, v30
  v_cvt_pk_bf16_f32 v26, v28, v29
  v_exp_f32 v31, v31
  v_cvt_pk_bf16_f32 v19, v22, v23
  v_exp_f32 v32, v32
  v_exp_f32 v33, v33
  v_exp_f32 v34, v34
  v_cvt_pk_bf16_f32 v32, v32, v33
  v_exp_f32 v35, v35
  v_cvt_pk_bf16_f32 v27, v30, v31
  v_exp_f32 v40, v40
  v_exp_f32 v41, v41
  v_exp_f32 v42, v42
  v_cvt_pk_bf16_f32 v40, v40, v41
  v_exp_f32 v43, v43
  v_cvt_pk_bf16_f32 v33, v34, v35
  v_exp_f32 v48, v48
  v_exp_f32 v49, v49
  v_exp_f32 v50, v50
  v_cvt_pk_bf16_f32 v48, v48, v49
  v_exp_f32 v51, v51
  v_cvt_pk_bf16_f32 v41, v42, v43
  v_exp_f32 v56, v56
  v_exp_f32 v57, v57
  v_exp_f32 v58, v58
  v_cvt_pk_bf16_f32 v56, v56, v57
  v_exp_f32 v59, v59
  v_cvt_pk_bf16_f32 v49, v50, v51
  v_exp_f32 v36, v36
  v_exp_f32 v37, v37
  v_exp_f32 v38, v38
  v_cvt_pk_bf16_f32 v34, v36, v37
  v_exp_f32 v39, v39
  v_cvt_pk_bf16_f32 v57, v58, v59
  v_exp_f32 v44, v44
  v_exp_f32 v45, v45
  v_exp_f32 v46, v46
  v_cvt_pk_bf16_f32 v42, v44, v45
  v_exp_f32 v47, v47
  v_cvt_pk_bf16_f32 v35, v38, v39
  v_exp_f32 v52, v52
  v_exp_f32 v53, v53
  v_exp_f32 v54, v54
  v_cvt_pk_bf16_f32 v50, v52, v53
  v_exp_f32 v55, v55
  v_cvt_pk_bf16_f32 v43, v46, v47
  v_exp_f32 v60, v60
  v_exp_f32 v61, v61
  v_exp_f32 v62, v62
  v_cvt_pk_bf16_f32 v58, v60, v61
  v_exp_f32 v63, v63
  v_cvt_pk_bf16_f32 v51, v54, v55
  v_cvt_pk_bf16_f32 v59, v62, v63
  v_mfma_f32_16x16x32_bf16 v[64:67], a[128:131], v[128:131], v[192:195]
  s_add_u32 m0, s28, 98304
  v_mfma_f32_16x16x32_bf16 v[64:67], a[132:135], v[132:135], v[64:67]
  ds_read_b128 a[144:147], v212 offset:20480
  v_mfma_f32_16x16x32_bf16 v[64:67], a[136:139], v[136:139], v[64:67]
  buffer_load_dwordx4 v236, s[16:19], s29 offen offset:0 lds
  v_mfma_f32_16x16x32_bf16 v[64:67], a[140:143], v[140:143], v[64:67]
  ds_read_b128 a[148:151], v213 offset:20480
  v_mfma_f32_16x16x32_bf16 v[72:75], a[140:143], v[156:159], v[196:199]
  v_mfma_f32_16x16x32_bf16 v[72:75], a[136:139], v[152:155], v[72:75]
  ds_read_b128 a[152:155], v214 offset:20480
  v_mfma_f32_16x16x32_bf16 v[72:75], a[132:135], v[148:151], v[72:75]
  buffer_load_dwordx4 v237, s[16:19], s29 offen offset:1024 lds
  v_mfma_f32_16x16x32_bf16 v[72:75], a[128:131], v[144:147], v[72:75]
  ds_read_b128 a[156:159], v215 offset:20480
  v_mfma_f32_16x16x32_bf16 v[80:83], a[128:131], v[160:163], v[200:203]
  v_exp_f32 v64, v64
  v_mfma_f32_16x16x32_bf16 v[80:83], a[132:135], v[164:167], v[80:83]
  v_mfma_f32_16x16x32_bf16 v[80:83], a[136:139], v[168:171], v[80:83]
  v_exp_f32 v65, v65
  v_mfma_f32_16x16x32_bf16 v[80:83], a[140:143], v[172:175], v[80:83]
  v_cvt_pk_bf16_f32 v64, v64, v65
  v_mfma_f32_16x16x32_bf16 v[88:91], a[140:143], v[188:191], v[204:207]
  v_exp_f32 v66, v66
  v_mfma_f32_16x16x32_bf16 v[88:91], a[136:139], v[184:187], v[88:91]
  buffer_load_dwordx4 v236, s[16:19], s29 offen offset:2048 lds
  v_mfma_f32_16x16x32_bf16 v[88:91], a[132:135], v[180:183], v[88:91]
  s_waitcnt lgkmcnt(0)
  v_exp_f32 v67, v67
  v_mfma_f32_16x16x32_bf16 v[88:91], a[128:131], v[176:179], v[88:91]
  v_cvt_pk_bf16_f32 v65, v66, v67
  v_mfma_f32_16x16x32_bf16 v[68:71], a[144:147], v[128:131], v[192:195]
  v_exp_f32 v72, v72
  v_mfma_f32_16x16x32_bf16 v[68:71], a[148:151], v[132:135], v[68:71]
  ds_read_b128 a[128:131], v212 offset:24576
  v_mfma_f32_16x16x32_bf16 v[68:71], a[152:155], v[136:139], v[68:71]
  v_exp_f32 v73, v73
  v_mfma_f32_16x16x32_bf16 v[68:71], a[156:159], v[140:143], v[68:71]
  ds_read_b128 a[132:135], v213 offset:24576
  v_cvt_pk_bf16_f32 v72, v72, v73
  v_mfma_f32_16x16x32_bf16 v[76:79], a[156:159], v[156:159], v[196:199]
  v_exp_f32 v74, v74
  v_mfma_f32_16x16x32_bf16 v[76:79], a[152:155], v[152:155], v[76:79]
  ds_read_b128 a[136:139], v214 offset:24576
  v_mfma_f32_16x16x32_bf16 v[76:79], a[148:151], v[148:151], v[76:79]
  v_exp_f32 v75, v75
  v_mfma_f32_16x16x32_bf16 v[76:79], a[144:147], v[144:147], v[76:79]
  ds_read_b128 a[140:143], v215 offset:24576
  v_cvt_pk_bf16_f32 v73, v74, v75
  v_mfma_f32_16x16x32_bf16 v[84:87], a[144:147], v[160:163], v[200:203]
  v_exp_f32 v80, v80
  v_mfma_f32_16x16x32_bf16 v[84:87], a[148:151], v[164:167], v[84:87]
  buffer_load_dwordx4 v237, s[16:19], s29 offen offset:3072 lds
  v_mfma_f32_16x16x32_bf16 v[84:87], a[152:155], v[168:171], v[84:87]
  s_add_u32 s29, s29, 16384
  v_exp_f32 v81, v81
  v_mfma_f32_16x16x32_bf16 v[84:87], a[156:159], v[172:175], v[84:87]
  v_cvt_pk_bf16_f32 v80, v80, v81
  v_mfma_f32_16x16x32_bf16 v[92:95], a[156:159], v[188:191], v[204:207]
  s_add_u32 m0, s28, 49152
  v_exp_f32 v82, v82
  v_mfma_f32_16x16x32_bf16 v[92:95], a[152:155], v[184:187], v[92:95]
  buffer_load_dwordx4 v232, s[12:15], s29 offen offset:0 lds
  v_mfma_f32_16x16x32_bf16 v[92:95], a[148:151], v[180:183], v[92:95]
  s_waitcnt lgkmcnt(0)
  v_exp_f32 v83, v83
  v_mfma_f32_16x16x32_bf16 v[92:95], a[144:147], v[176:179], v[92:95]
  v_cvt_pk_bf16_f32 v81, v82, v83
  v_mfma_f32_16x16x32_bf16 v[96:99], a[128:131], v[128:131], v[192:195]
  v_exp_f32 v88, v88
  v_mfma_f32_16x16x32_bf16 v[96:99], a[132:135], v[132:135], v[96:99]
  ds_read_b128 a[144:147], v212 offset:28672
  v_mfma_f32_16x16x32_bf16 v[96:99], a[136:139], v[136:139], v[96:99]
  v_exp_f32 v89, v89
  v_mfma_f32_16x16x32_bf16 v[96:99], a[140:143], v[140:143], v[96:99]
  ds_read_b128 a[148:151], v213 offset:28672
  v_cvt_pk_bf16_f32 v88, v88, v89
  v_mfma_f32_16x16x32_bf16 v[104:107], a[140:143], v[156:159], v[196:199]
  v_exp_f32 v90, v90
  v_mfma_f32_16x16x32_bf16 v[104:107], a[136:139], v[152:155], v[104:107]
  ds_read_b128 a[152:155], v214 offset:28672
  v_mfma_f32_16x16x32_bf16 v[104:107], a[132:135], v[148:151], v[104:107]
  v_exp_f32 v91, v91
  v_mfma_f32_16x16x32_bf16 v[104:107], a[128:131], v[144:147], v[104:107]
  ds_read_b128 a[156:159], v215 offset:28672
  v_cvt_pk_bf16_f32 v89, v90, v91
  v_mfma_f32_16x16x32_bf16 v[112:115], a[128:131], v[160:163], v[200:203]
  v_exp_f32 v68, v68
  v_mfma_f32_16x16x32_bf16 v[112:115], a[132:135], v[164:167], v[112:115]
  buffer_load_dwordx4 v233, s[12:15], s29 offen offset:1024 lds
  v_mfma_f32_16x16x32_bf16 v[112:115], a[136:139], v[168:171], v[112:115]
  v_exp_f32 v69, v69
  v_mfma_f32_16x16x32_bf16 v[112:115], a[140:143], v[172:175], v[112:115]
  v_cvt_pk_bf16_f32 v66, v68, v69
  v_mfma_f32_16x16x32_bf16 v[120:123], a[140:143], v[188:191], v[204:207]
  v_exp_f32 v70, v70
  v_mfma_f32_16x16x32_bf16 v[120:123], a[136:139], v[184:187], v[120:123]
  buffer_load_dwordx4 v234, s[12:15], s29 offen offset:2048 lds
  v_mfma_f32_16x16x32_bf16 v[120:123], a[132:135], v[180:183], v[120:123]
  s_waitcnt lgkmcnt(0)
  v_exp_f32 v71, v71
  v_mfma_f32_16x16x32_bf16 v[120:123], a[128:131], v[176:179], v[120:123]
  v_cvt_pk_bf16_f32 v67, v70, v71
  v_mfma_f32_16x16x32_bf16 v[100:103], a[144:147], v[128:131], v[192:195]
  v_exp_f32 v76, v76
  v_mfma_f32_16x16x32_bf16 v[100:103], a[148:151], v[132:135], v[100:103]
  ds_read_b64_tr_b16 a[160:161], v216 offset:0
  v_mfma_f32_16x16x32_bf16 v[100:103], a[152:155], v[136:139], v[100:103]
  v_exp_f32 v77, v77
  v_mfma_f32_16x16x32_bf16 v[100:103], a[156:159], v[140:143], v[100:103]
  ds_read_b64_tr_b16 a[162:163], v216 offset:4096
  v_cvt_pk_bf16_f32 v74, v76, v77
  v_mfma_f32_16x16x32_bf16 v[108:111], a[156:159], v[156:159], v[196:199]
  v_exp_f32 v78, v78
  v_mfma_f32_16x16x32_bf16 v[108:111], a[152:155], v[152:155], v[108:111]
  ds_read_b64_tr_b16 a[164:165], v216 offset:8192
  buffer_load_dwordx4 v235, s[12:15], s29 offen offset:3072 lds
  v_mfma_f32_16x16x32_bf16 v[108:111], a[148:151], v[148:151], v[108:111]
  v_exp_f32 v79, v79
  v_mfma_f32_16x16x32_bf16 v[108:111], a[144:147], v[144:147], v[108:111]
  ds_read_b64_tr_b16 a[166:167], v216 offset:12288
  v_cvt_pk_bf16_f32 v75, v78, v79
  v_mfma_f32_16x16x32_bf16 v[116:119], a[144:147], v[160:163], v[200:203]
  v_exp_f32 v84, v84
  v_mfma_f32_16x16x32_bf16 v[116:119], a[148:151], v[164:167], v[116:119]
  ds_read_b64_tr_b16 a[168:169], v217 offset:0
  s_add_u32 m0, s50, 3072
  v_mfma_f32_16x16x32_bf16 v[116:119], a[152:155], v[168:171], v[116:119]
  v_exp_f32 v85, v85
  v_mfma_f32_16x16x32_bf16 v[116:119], a[156:159], v[172:175], v[116:119]
  ds_read_b64_tr_b16 a[170:171], v217 offset:4096
  v_cvt_pk_bf16_f32 v82, v84, v85
  v_mfma_f32_16x16x32_bf16 v[124:127], a[156:159], v[188:191], v[204:207]
  v_exp_f32 v86, v86
  v_mfma_f32_16x16x32_bf16 v[124:127], a[152:155], v[184:187], v[124:127]
  ds_read_b64_tr_b16 a[172:173], v217 offset:8192
  buffer_load_dwordx4 v253, s[44:47], s35 offen lds
  s_add_u32 s35, s35, 221184
  v_mfma_f32_16x16x32_bf16 v[124:127], a[148:151], v[180:183], v[124:127]
  v_exp_f32 v87, v87
  v_mfma_f32_16x16x32_bf16 v[124:127], a[144:147], v[176:179], v[124:127]
  ds_read_b64_tr_b16 a[174:175], v217 offset:12288
  v_cvt_pk_bf16_f32 v83, v86, v87
  v_mfma_f32_16x16x32_bf16 a[192:195], a[208:211], v[0:3], 0
  v_exp_f32 v92, v92
  v_mfma_f32_16x16x32_bf16 a[192:195], a[208:211], v[32:35], a[192:195]
  ds_read_b64_tr_b16 a[176:177], v218 offset:0
  v_mfma_f32_16x16x32_bf16 a[196:199], a[208:211], v[8:11], 0
  v_exp_f32 v93, v93
  v_mfma_f32_16x16x32_bf16 a[196:199], a[208:211], v[40:43], a[196:199]
  ds_read_b64_tr_b16 a[178:179], v218 offset:4096
  v_cvt_pk_bf16_f32 v90, v92, v93
  v_mfma_f32_16x16x32_bf16 a[200:203], a[208:211], v[16:19], 0
  v_exp_f32 v94, v94
  v_mfma_f32_16x16x32_bf16 a[200:203], a[208:211], v[48:51], a[200:203]
  ds_read_b64_tr_b16 a[180:181], v218 offset:8192
  v_mfma_f32_16x16x32_bf16 a[204:207], a[208:211], v[24:27], 0
  s_waitcnt lgkmcnt(7)
  v_exp_f32 v95, v95
  v_mfma_f32_16x16x32_bf16 a[204:207], a[208:211], v[56:59], a[204:207]
  ds_read_b64_tr_b16 a[182:183], v218 offset:12288
  v_cvt_pk_bf16_f32 v91, v94, v95
  v_mfma_f32_16x16x32_bf16 a[0:3], a[160:163], v[0:3], 0
  v_exp_f32 v96, v96
  v_mfma_f32_16x16x32_bf16 a[0:3], a[164:167], v[32:35], a[0:3]
  ds_read_b64_tr_b16 a[184:185], v219 offset:0
  v_mfma_f32_16x16x32_bf16 a[4:7], a[164:167], v[40:43], 0
  v_exp_f32 v97, v97
  v_mfma_f32_16x16x32_bf16 a[4:7], a[160:163], v[8:11], a[4:7]
  ds_read_b64_tr_b16 a[186:187], v219 offset:4096
  v_cvt_pk_bf16_f32 v96, v96, v97
  v_mfma_f32_16x16x32_bf16 a[8:11], a[160:163], v[16:19], 0
  v_exp_f32 v98, v98
  v_mfma_f32_16x16x32_bf16 a[8:11], a[164:167], v[48:51], a[8:11]
  ds_read_b64_tr_b16 a[188:189], v219 offset:8192
  v_mfma_f32_16x16x32_bf16 a[12:15], a[164:167], v[56:59], 0
  s_waitcnt lgkmcnt(7)
  v_exp_f32 v99, v99
  v_mfma_f32_16x16x32_bf16 a[12:15], a[160:163], v[24:27], a[12:15]
  ds_read_b64_tr_b16 a[190:191], v219 offset:12288
  v_cvt_pk_bf16_f32 v97, v98, v99
  v_mfma_f32_16x16x32_bf16 a[16:19], a[168:171], v[0:3], 0
  v_exp_f32 v104, v104
  v_mfma_f32_16x16x32_bf16 a[16:19], a[172:175], v[32:35], a[16:19]
  ds_read_b64_tr_b16 a[160:161], v220 offset:0
  v_mfma_f32_16x16x32_bf16 a[20:23], a[172:175], v[40:43], 0
  v_exp_f32 v105, v105
  v_mfma_f32_16x16x32_bf16 a[20:23], a[168:171], v[8:11], a[20:23]
  ds_read_b64_tr_b16 a[162:163], v220 offset:4096
  v_cvt_pk_bf16_f32 v104, v104, v105
  v_mfma_f32_16x16x32_bf16 a[24:27], a[168:171], v[16:19], 0
  v_exp_f32 v106, v106
  v_mfma_f32_16x16x32_bf16 a[24:27], a[172:175], v[48:51], a[24:27]
  ds_read_b64_tr_b16 a[164:165], v220 offset:8192
  v_mfma_f32_16x16x32_bf16 a[28:31], a[172:175], v[56:59], 0
  s_waitcnt lgkmcnt(7)
  v_exp_f32 v107, v107
  v_mfma_f32_16x16x32_bf16 a[28:31], a[168:171], v[24:27], a[28:31]
  ds_read_b64_tr_b16 a[166:167], v220 offset:12288
  v_cvt_pk_bf16_f32 v105, v106, v107
  v_mfma_f32_16x16x32_bf16 a[32:35], a[176:179], v[0:3], 0
  v_exp_f32 v112, v112
  v_mfma_f32_16x16x32_bf16 a[32:35], a[180:183], v[32:35], a[32:35]
  ds_read_b64_tr_b16 a[168:169], v221 offset:0
  v_mfma_f32_16x16x32_bf16 a[36:39], a[180:183], v[40:43], 0
  v_exp_f32 v113, v113
  v_mfma_f32_16x16x32_bf16 a[36:39], a[176:179], v[8:11], a[36:39]
  ds_read_b64_tr_b16 a[170:171], v221 offset:4096
  v_cvt_pk_bf16_f32 v112, v112, v113
  v_mfma_f32_16x16x32_bf16 a[40:43], a[176:179], v[16:19], 0
  v_exp_f32 v114, v114
  v_mfma_f32_16x16x32_bf16 a[40:43], a[180:183], v[48:51], a[40:43]
  ds_read_b64_tr_b16 a[172:173], v221 offset:8192
  v_mfma_f32_16x16x32_bf16 a[44:47], a[180:183], v[56:59], 0
  s_waitcnt lgkmcnt(7)
  v_exp_f32 v115, v115
  v_mfma_f32_16x16x32_bf16 a[44:47], a[176:179], v[24:27], a[44:47]
  ds_read_b64_tr_b16 a[174:175], v221 offset:12288
  v_cvt_pk_bf16_f32 v113, v114, v115
  v_mfma_f32_16x16x32_bf16 a[48:51], a[184:187], v[0:3], 0
  v_exp_f32 v120, v120
  v_mfma_f32_16x16x32_bf16 a[48:51], a[188:191], v[32:35], a[48:51]
  ds_read_b64_tr_b16 a[176:177], v222 offset:0
  v_mfma_f32_16x16x32_bf16 a[52:55], a[188:191], v[40:43], 0
  v_exp_f32 v121, v121
  v_mfma_f32_16x16x32_bf16 a[52:55], a[184:187], v[8:11], a[52:55]
  ds_read_b64_tr_b16 a[178:179], v222 offset:4096
  v_cvt_pk_bf16_f32 v120, v120, v121
  v_mfma_f32_16x16x32_bf16 a[56:59], a[184:187], v[16:19], 0
  v_exp_f32 v122, v122
  v_mfma_f32_16x16x32_bf16 a[56:59], a[188:191], v[48:51], a[56:59]
  ds_read_b64_tr_b16 a[180:181], v222 offset:8192
  v_mfma_f32_16x16x32_bf16 a[60:63], a[188:191], v[56:59], 0
  s_waitcnt lgkmcnt(7)
  v_exp_f32 v123, v123
  v_mfma_f32_16x16x32_bf16 a[60:63], a[184:187], v[24:27], a[60:63]
  ds_read_b64_tr_b16 a[182:183], v222 offset:12288
  v_cvt_pk_bf16_f32 v121, v122, v123
  v_mfma_f32_16x16x32_bf16 a[64:67], a[160:163], v[0:3], 0
  v_exp_f32 v100, v100
  v_mfma_f32_16x16x32_bf16 a[64:67], a[164:167], v[32:35], a[64:67]
  ds_read_b64_tr_b16 a[184:185], v223 offset:0
  v_mfma_f32_16x16x32_bf16 a[68:71], a[164:167], v[40:43], 0
  v_exp_f32 v101, v101
  v_mfma_f32_16x16x32_bf16 a[68:71], a[160:163], v[8:11], a[68:71]
  ds_read_b64_tr_b16 a[186:187], v223 offset:4096
  v_cvt_pk_bf16_f32 v98, v100, v101
  v_mfma_f32_16x16x32_bf16 a[72:75], a[160:163], v[16:19], 0
  v_exp_f32 v102, v102
  v_mfma_f32_16x16x32_bf16 a[72:75], a[164:167], v[48:51], a[72:75]
  ds_read_b64_tr_b16 a[188:189], v223 offset:8192
  v_mfma_f32_16x16x32_bf16 a[76:79], a[164:167], v[56:59], 0
  s_waitcnt lgkmcnt(7)
  v_exp_f32 v103, v103
  v_mfma_f32_16x16x32_bf16 a[76:79], a[160:163], v[24:27], a[76:79]
  ds_read_b64_tr_b16 a[190:191], v223 offset:12288
  v_cvt_pk_bf16_f32 v99, v102, v103
  v_mfma_f32_16x16x32_bf16 a[80:83], a[168:171], v[0:3], 0
  s_waitcnt vmcnt(10)
  v_exp_f32 v108, v108
  v_mfma_f32_16x16x32_bf16 a[80:83], a[172:175], v[32:35], a[80:83]
  v_mfma_f32_16x16x32_bf16 a[84:87], a[172:175], v[40:43], 0
  s_barrier
  v_exp_f32 v109, v109
  v_mfma_f32_16x16x32_bf16 a[84:87], a[168:171], v[8:11], a[84:87]
  ds_read_b128 a[128:131], v212 offset:32768
  v_cvt_pk_bf16_f32 v106, v108, v109
  v_mfma_f32_16x16x32_bf16 a[88:91], a[168:171], v[16:19], 0
  v_exp_f32 v110, v110
  v_mfma_f32_16x16x32_bf16 a[88:91], a[172:175], v[48:51], a[88:91]
  ds_read_b128 a[132:135], v213 offset:32768
  v_mfma_f32_16x16x32_bf16 a[92:95], a[172:175], v[56:59], 0
  s_waitcnt lgkmcnt(6)
  v_exp_f32 v111, v111
  v_mfma_f32_16x16x32_bf16 a[92:95], a[168:171], v[24:27], a[92:95]
  ds_read_b128 a[136:139], v214 offset:32768
  v_cvt_pk_bf16_f32 v107, v110, v111
  v_mfma_f32_16x16x32_bf16 a[96:99], a[176:179], v[0:3], 0
  s_mul_i32 s38, s3, 20480
  v_exp_f32 v116, v116
  v_mfma_f32_16x16x32_bf16 a[96:99], a[180:183], v[32:35], a[96:99]
  ds_read_b128 a[140:143], v215 offset:32768
  buffer_load_dwordx4 a[212:215], v243, s[24:27], s38 offen sc1
  s_add_u32 s38, s38, 4096
  v_mfma_f32_16x16x32_bf16 a[100:103], a[180:183], v[40:43], 0
  v_exp_f32 v117, v117
  v_mfma_f32_16x16x32_bf16 a[100:103], a[176:179], v[8:11], a[100:103]
  v_cvt_pk_bf16_f32 v114, v116, v117
  v_mfma_f32_16x16x32_bf16 a[104:107], a[176:179], v[16:19], 0
  v_exp_f32 v118, v118
  v_mfma_f32_16x16x32_bf16 a[104:107], a[180:183], v[48:51], a[104:107]
  v_mfma_f32_16x16x32_bf16 a[108:111], a[180:183], v[56:59], 0
  s_waitcnt lgkmcnt(4)
  v_exp_f32 v119, v119
  v_mfma_f32_16x16x32_bf16 a[108:111], a[176:179], v[24:27], a[108:111]
  v_cvt_pk_bf16_f32 v115, v118, v119
  v_mfma_f32_16x16x32_bf16 a[112:115], a[184:187], v[0:3], 0
  v_exp_f32 v124, v124
  v_mfma_f32_16x16x32_bf16 a[112:115], a[188:191], v[32:35], a[112:115]
  v_mfma_f32_16x16x32_bf16 a[116:119], a[188:191], v[40:43], 0
  v_exp_f32 v125, v125
  v_mfma_f32_16x16x32_bf16 a[116:119], a[184:187], v[8:11], a[116:119]
  v_cvt_pk_bf16_f32 v122, v124, v125
  v_mfma_f32_16x16x32_bf16 a[120:123], a[184:187], v[16:19], 0
  v_exp_f32 v126, v126
  v_mfma_f32_16x16x32_bf16 a[120:123], a[188:191], v[48:51], a[120:123]
  v_mfma_f32_16x16x32_bf16 a[124:127], a[188:191], v[56:59], 0
  s_waitcnt lgkmcnt(0)
  v_exp_f32 v127, v127
  v_mfma_f32_16x16x32_bf16 a[124:127], a[184:187], v[24:27], a[124:127]
  v_cvt_pk_bf16_f32 v123, v126, v127
  v_mfma_f32_16x16x32_bf16 v[0:3], a[128:131], v[128:131], v[192:195]
  s_add_u32 m0, s28, 114688
  v_mfma_f32_16x16x32_bf16 v[0:3], a[132:135], v[132:135], v[0:3]
  ds_read_b128 a[144:147], v212 offset:36864
  v_mfma_f32_16x16x32_bf16 v[0:3], a[136:139], v[136:139], v[0:3]
  buffer_load_dwordx4 v236, s[16:19], s29 offen offset:0 lds
  v_mfma_f32_16x16x32_bf16 v[0:3], a[140:143], v[140:143], v[0:3]
  ds_read_b128 a[148:151], v213 offset:36864
  v_mfma_f32_16x16x32_bf16 v[8:11], a[140:143], v[156:159], v[196:199]
  v_mfma_f32_16x16x32_bf16 v[8:11], a[136:139], v[152:155], v[8:11]
  ds_read_b128 a[152:155], v214 offset:36864
  v_mfma_f32_16x16x32_bf16 v[8:11], a[132:135], v[148:151], v[8:11]
  buffer_load_dwordx4 v237, s[16:19], s29 offen offset:1024 lds
  v_mfma_f32_16x16x32_bf16 v[8:11], a[128:131], v[144:147], v[8:11]
  ds_read_b128 a[156:159], v215 offset:36864
  v_mfma_f32_16x16x32_bf16 v[16:19], a[128:131], v[160:163], v[200:203]
  v_exp_f32 v0, v0
  v_mfma_f32_16x16x32_bf16 v[16:19], a[132:135], v[164:167], v[16:19]
  v_mfma_f32_16x16x32_bf16 v[16:19], a[136:139], v[168:171], v[16:19]
  v_exp_f32 v1, v1
  v_mfma_f32_16x16x32_bf16 v[16:19], a[140:143], v[172:175], v[16:19]
  v_cvt_pk_bf16_f32 v0, v0, v1
  v_mfma_f32_16x16x32_bf16 v[24:27], a[140:143], v[188:191], v[204:207]
  v_exp_f32 v2, v2
  v_mfma_f32_16x16x32_bf16 v[24:27], a[136:139], v[184:187], v[24:27]
  buffer_load_dwordx4 v236, s[16:19], s29 offen offset:2048 lds
  v_mfma_f32_16x16x32_bf16 v[24:27], a[132:135], v[180:183], v[24:27]
  s_waitcnt lgkmcnt(0)
  v_exp_f32 v3, v3
  v_mfma_f32_16x16x32_bf16 v[24:27], a[128:131], v[176:179], v[24:27]
  v_cvt_pk_bf16_f32 v1, v2, v3
  v_mfma_f32_16x16x32_bf16 v[4:7], a[144:147], v[128:131], v[192:195]
  v_exp_f32 v8, v8
  v_mfma_f32_16x16x32_bf16 v[4:7], a[148:151], v[132:135], v[4:7]
  ds_read_b128 a[128:131], v212 offset:40960
  v_mfma_f32_16x16x32_bf16 v[4:7], a[152:155], v[136:139], v[4:7]
  v_exp_f32 v9, v9
  v_mfma_f32_16x16x32_bf16 v[4:7], a[156:159], v[140:143], v[4:7]
  ds_read_b128 a[132:135], v213 offset:40960
  v_cvt_pk_bf16_f32 v8, v8, v9
  v_mfma_f32_16x16x32_bf16 v[12:15], a[156:159], v[156:159], v[196:199]
  v_exp_f32 v10, v10
  v_mfma_f32_16x16x32_bf16 v[12:15], a[152:155], v[152:155], v[12:15]
  ds_read_b128 a[136:139], v214 offset:40960
  v_mfma_f32_16x16x32_bf16 v[12:15], a[148:151], v[148:151], v[12:15]
  v_exp_f32 v11, v11
  v_mfma_f32_16x16x32_bf16 v[12:15], a[144:147], v[144:147], v[12:15]
  ds_read_b128 a[140:143], v215 offset:40960
  v_cvt_pk_bf16_f32 v9, v10, v11
  v_mfma_f32_16x16x32_bf16 v[20:23], a[144:147], v[160:163], v[200:203]
  v_exp_f32 v16, v16
  v_mfma_f32_16x16x32_bf16 v[20:23], a[148:151], v[164:167], v[20:23]
  buffer_load_dwordx4 v237, s[16:19], s29 offen offset:3072 lds
  v_mfma_f32_16x16x32_bf16 v[20:23], a[152:155], v[168:171], v[20:23]
  s_add_u32 s29, s29, 16384
  v_exp_f32 v17, v17
  v_mfma_f32_16x16x32_bf16 v[20:23], a[156:159], v[172:175], v[20:23]
  v_cvt_pk_bf16_f32 v16, v16, v17
  v_mfma_f32_16x16x32_bf16 v[28:31], a[156:159], v[188:191], v[204:207]
  s_add_u32 m0, s28, 0
  v_exp_f32 v18, v18
  v_mfma_f32_16x16x32_bf16 v[28:31], a[152:155], v[184:187], v[28:31]
  buffer_load_dwordx4 v232, s[12:15], s29 offen offset:0 lds
  v_mfma_f32_16x16x32_bf16 v[28:31], a[148:151], v[180:183], v[28:31]
  s_waitcnt lgkmcnt(0)
  v_exp_f32 v19, v19
  v_mfma_f32_16x16x32_bf16 v[28:31], a[144:147], v[176:179], v[28:31]
  v_cvt_pk_bf16_f32 v17, v18, v19
  v_mfma_f32_16x16x32_bf16 v[32:35], a[128:131], v[128:131], v[192:195]
  v_exp_f32 v24, v24
  v_mfma_f32_16x16x32_bf16 v[32:35], a[132:135], v[132:135], v[32:35]
  ds_read_b128 a[144:147], v212 offset:45056
  v_mfma_f32_16x16x32_bf16 v[32:35], a[136:139], v[136:139], v[32:35]
  v_exp_f32 v25, v25
  v_mfma_f32_16x16x32_bf16 v[32:35], a[140:143], v[140:143], v[32:35]
  ds_read_b128 a[148:151], v213 offset:45056
  v_cvt_pk_bf16_f32 v24, v24, v25
  v_mfma_f32_16x16x32_bf16 v[40:43], a[140:143], v[156:159], v[196:199]
  v_exp_f32 v26, v26
  v_mfma_f32_16x16x32_bf16 v[40:43], a[136:139], v[152:155], v[40:43]
  ds_read_b128 a[152:155], v214 offset:45056
  v_mfma_f32_16x16x32_bf16 v[40:43], a[132:135], v[148:151], v[40:43]
  v_exp_f32 v27, v27
  v_mfma_f32_16x16x32_bf16 v[40:43], a[128:131], v[144:147], v[40:43]
  ds_read_b128 a[156:159], v215 offset:45056
  v_cvt_pk_bf16_f32 v25, v26, v27
  v_mfma_f32_16x16x32_bf16 v[48:51], a[128:131], v[160:163], v[200:203]
  v_exp_f32 v4, v4
  v_mfma_f32_16x16x32_bf16 v[48:51], a[132:135], v[164:167], v[48:51]
  buffer_load_dwordx4 v233, s[12:15], s29 offen offset:1024 lds
  v_mfma_f32_16x16x32_bf16 v[48:51], a[136:139], v[168:171], v[48:51]
  v_exp_f32 v5, v5
  v_mfma_f32_16x16x32_bf16 v[48:51], a[140:143], v[172:175], v[48:51]
  v_cvt_pk_bf16_f32 v2, v4, v5
  v_mfma_f32_16x16x32_bf16 v[56:59], a[140:143], v[188:191], v[204:207]
  v_exp_f32 v6, v6
  v_mfma_f32_16x16x32_bf16 v[56:59], a[136:139], v[184:187], v[56:59]
  buffer_load_dwordx4 v234, s[12:15], s29 offen offset:2048 lds
  v_mfma_f32_16x16x32_bf16 v[56:59], a[132:135], v[180:183], v[56:59]
  s_waitcnt lgkmcnt(0)
  v_exp_f32 v7, v7
  v_mfma_f32_16x16x32_bf16 v[56:59], a[128:131], v[176:179], v[56:59]
  v_cvt_pk_bf16_f32 v3, v6, v7
  v_mfma_f32_16x16x32_bf16 v[36:39], a[144:147], v[128:131], v[192:195]
  v_exp_f32 v12, v12
  v_mfma_f32_16x16x32_bf16 v[36:39], a[148:151], v[132:135], v[36:39]
  ds_read_b64_tr_b16 a[160:161], v216 offset:16384
  v_mfma_f32_16x16x32_bf16 v[36:39], a[152:155], v[136:139], v[36:39]
  v_exp_f32 v13, v13
  v_mfma_f32_16x16x32_bf16 v[36:39], a[156:159], v[140:143], v[36:39]
  ds_read_b64_tr_b16 a[162:163], v216 offset:20480
  v_cvt_pk_bf16_f32 v10, v12, v13
  v_mfma_f32_16x16x32_bf16 v[44:47], a[156:159], v[156:159], v[196:199]
  v_exp_f32 v14, v14
  v_mfma_f32_16x16x32_bf16 v[44:47], a[152:155], v[152:155], v[44:47]
  ds_read_b64_tr_b16 a[164:165], v216 offset:24576
  buffer_load_dwordx4 v235, s[12:15], s29 offen offset:3072 lds
  v_mfma_f32_16x16x32_bf16 v[44:47], a[148:151], v[148:151], v[44:47]
  v_exp_f32 v15, v15
  v_mfma_f32_16x16x32_bf16 v[44:47], a[144:147], v[144:147], v[44:47]
  ds_read_b64_tr_b16 a[166:167], v216 offset:28672
  v_cvt_pk_bf16_f32 v11, v14, v15
  v_mfma_f32_16x16x32_bf16 v[52:55], a[144:147], v[160:163], v[200:203]
  v_exp_f32 v20, v20
  v_mfma_f32_16x16x32_bf16 v[52:55], a[148:151], v[164:167], v[52:55]
  ds_read_b64_tr_b16 a[168:169], v217 offset:16384
  s_add_u32 m0, s50, 1024
  v_mfma_f32_16x16x32_bf16 v[52:55], a[152:155], v[168:171], v[52:55]
  v_exp_f32 v21, v21
  v_mfma_f32_16x16x32_bf16 v[52:55], a[156:159], v[172:175], v[52:55]
  ds_read_b64_tr_b16 a[170:171], v217 offset:20480
  v_cvt_pk_bf16_f32 v18, v20, v21
  v_mfma_f32_16x16x32_bf16 v[60:63], a[156:159], v[188:191], v[204:207]
  v_exp_f32 v22, v22
  v_mfma_f32_16x16x32_bf16 v[60:63], a[152:155], v[184:187], v[60:63]
  ds_read_b64_tr_b16 a[172:173], v217 offset:24576
  buffer_load_dwordx4 v253, s[20:23], s35 offen lds
  v_mfma_f32_16x16x32_bf16 v[60:63], a[148:151], v[180:183], v[60:63]
  v_exp_f32 v23, v23
  v_mfma_f32_16x16x32_bf16 v[60:63], a[144:147], v[176:179], v[60:63]
  ds_read_b64_tr_b16 a[174:175], v217 offset:28672
  v_cvt_pk_bf16_f32 v19, v22, v23
  v_mfma_f32_16x16x32_bf16 a[192:195], a[208:211], v[64:67], a[192:195]
  v_exp_f32 v28, v28
  v_mfma_f32_16x16x32_bf16 a[192:195], a[208:211], v[96:99], a[192:195]
  ds_read_b64_tr_b16 a[176:177], v218 offset:16384
  v_mfma_f32_16x16x32_bf16 a[196:199], a[208:211], v[72:75], a[196:199]
  v_exp_f32 v29, v29
  v_mfma_f32_16x16x32_bf16 a[196:199], a[208:211], v[104:107], a[196:199]
  ds_read_b64_tr_b16 a[178:179], v218 offset:20480
  v_cvt_pk_bf16_f32 v26, v28, v29
  v_mfma_f32_16x16x32_bf16 a[200:203], a[208:211], v[80:83], a[200:203]
  v_exp_f32 v30, v30
  v_mfma_f32_16x16x32_bf16 a[200:203], a[208:211], v[112:115], a[200:203]
  ds_read_b64_tr_b16 a[180:181], v218 offset:24576
  v_mfma_f32_16x16x32_bf16 a[204:207], a[208:211], v[88:91], a[204:207]
  s_waitcnt lgkmcnt(7)
  v_exp_f32 v31, v31
  v_mfma_f32_16x16x32_bf16 a[204:207], a[208:211], v[120:123], a[204:207]
  ds_read_b64_tr_b16 a[182:183], v218 offset:28672
  v_cvt_pk_bf16_f32 v27, v30, v31
  v_mfma_f32_16x16x32_bf16 a[0:3], a[160:163], v[64:67], a[0:3]
  v_exp_f32 v32, v32
  v_mfma_f32_16x16x32_bf16 a[0:3], a[164:167], v[96:99], a[0:3]
  ds_read_b64_tr_b16 a[184:185], v219 offset:16384
  v_mfma_f32_16x16x32_bf16 a[4:7], a[164:167], v[104:107], a[4:7]
  v_exp_f32 v33, v33
  v_mfma_f32_16x16x32_bf16 a[4:7], a[160:163], v[72:75], a[4:7]
  ds_read_b64_tr_b16 a[186:187], v219 offset:20480
  v_cvt_pk_bf16_f32 v32, v32, v33
  v_mfma_f32_16x16x32_bf16 a[8:11], a[160:163], v[80:83], a[8:11]
  v_exp_f32 v34, v34
  v_mfma_f32_16x16x32_bf16 a[8:11], a[164:167], v[112:115], a[8:11]
  ds_read_b64_tr_b16 a[188:189], v219 offset:24576
  v_mfma_f32_16x16x32_bf16 a[12:15], a[164:167], v[120:123], a[12:15]
  s_waitcnt lgkmcnt(7)
  v_exp_f32 v35, v35
  v_mfma_f32_16x16x32_bf16 a[12:15], a[160:163], v[88:91], a[12:15]
  ds_read_b64_tr_b16 a[190:191], v219 offset:28672
  v_cvt_pk_bf16_f32 v33, v34, v35
  v_mfma_f32_16x16x32_bf16 a[16:19], a[168:171], v[64:67], a[16:19]
  v_exp_f32 v40, v40
  v_mfma_f32_16x16x32_bf16 a[16:19], a[172:175], v[96:99], a[16:19]
  ds_read_b64_tr_b16 a[160:161], v220 offset:16384
  v_mfma_f32_16x16x32_bf16 a[20:23], a[172:175], v[104:107], a[20:23]
  v_exp_f32 v41, v41
  v_mfma_f32_16x16x32_bf16 a[20:23], a[168:171], v[72:75], a[20:23]
  ds_read_b64_tr_b16 a[162:163], v220 offset:20480
  v_cvt_pk_bf16_f32 v40, v40, v41
  v_mfma_f32_16x16x32_bf16 a[24:27], a[168:171], v[80:83], a[24:27]
  v_exp_f32 v42, v42
  v_mfma_f32_16x16x32_bf16 a[24:27], a[172:175], v[112:115], a[24:27]
  ds_read_b64_tr_b16 a[164:165], v220 offset:24576
  v_mfma_f32_16x16x32_bf16 a[28:31], a[172:175], v[120:123], a[28:31]
  s_waitcnt lgkmcnt(7)
  v_exp_f32 v43, v43
  v_mfma_f32_16x16x32_bf16 a[28:31], a[168:171], v[88:91], a[28:31]
  ds_read_b64_tr_b16 a[166:167], v220 offset:28672
  v_cvt_pk_bf16_f32 v41, v42, v43
  v_mfma_f32_16x16x32_bf16 a[32:35], a[176:179], v[64:67], a[32:35]
  v_exp_f32 v48, v48
  v_mfma_f32_16x16x32_bf16 a[32:35], a[180:183], v[96:99], a[32:35]
  ds_read_b64_tr_b16 a[168:169], v221 offset:16384
  v_mfma_f32_16x16x32_bf16 a[36:39], a[180:183], v[104:107], a[36:39]
  v_exp_f32 v49, v49
  v_mfma_f32_16x16x32_bf16 a[36:39], a[176:179], v[72:75], a[36:39]
  ds_read_b64_tr_b16 a[170:171], v221 offset:20480
  v_cvt_pk_bf16_f32 v48, v48, v49
  v_mfma_f32_16x16x32_bf16 a[40:43], a[176:179], v[80:83], a[40:43]
  v_exp_f32 v50, v50
  v_mfma_f32_16x16x32_bf16 a[40:43], a[180:183], v[112:115], a[40:43]
  ds_read_b64_tr_b16 a[172:173], v221 offset:24576
  v_mfma_f32_16x16x32_bf16 a[44:47], a[180:183], v[120:123], a[44:47]
  s_waitcnt lgkmcnt(7)
  v_exp_f32 v51, v51
  v_mfma_f32_16x16x32_bf16 a[44:47], a[176:179], v[88:91], a[44:47]
  ds_read_b64_tr_b16 a[174:175], v221 offset:28672
  v_cvt_pk_bf16_f32 v49, v50, v51
  v_mfma_f32_16x16x32_bf16 a[48:51], a[184:187], v[64:67], a[48:51]
  v_exp_f32 v56, v56
  v_mfma_f32_16x16x32_bf16 a[48:51], a[188:191], v[96:99], a[48:51]
  ds_read_b64_tr_b16 a[176:177], v222 offset:16384
  v_mfma_f32_16x16x32_bf16 a[52:55], a[188:191], v[104:107], a[52:55]
  v_exp_f32 v57, v57
  v_mfma_f32_16x16x32_bf16 a[52:55], a[184:187], v[72:75], a[52:55]
  ds_read_b64_tr_b16 a[178:179], v222 offset:20480
  v_cvt_pk_bf16_f32 v56, v56, v57
  v_mfma_f32_16x16x32_bf16 a[56:59], a[184:187], v[80:83], a[56:59]
  v_exp_f32 v58, v58
  v_mfma_f32_16x16x32_bf16 a[56:59], a[188:191], v[112:115], a[56:59]
  ds_read_b64_tr_b16 a[180:181], v222 offset:24576
  v_mfma_f32_16x16x32_bf16 a[60:63], a[188:191], v[120:123], a[60:63]
  s_waitcnt lgkmcnt(7)
  v_exp_f32 v59, v59
  v_mfma_f32_16x16x32_bf16 a[60:63], a[184:187], v[88:91], a[60:63]
  ds_read_b64_tr_b16 a[182:183], v222 offset:28672
  v_cvt_pk_bf16_f32 v57, v58, v59
  v_mfma_f32_16x16x32_bf16 a[64:67], a[160:163], v[64:67], a[64:67]
  v_exp_f32 v36, v36
  v_mfma_f32_16x16x32_bf16 a[64:67], a[164:167], v[96:99], a[64:67]
  ds_read_b64_tr_b16 a[184:185], v223 offset:16384
  v_mfma_f32_16x16x32_bf16 a[68:71], a[164:167], v[104:107], a[68:71]
  v_exp_f32 v37, v37
  v_mfma_f32_16x16x32_bf16 a[68:71], a[160:163], v[72:75], a[68:71]
  ds_read_b64_tr_b16 a[186:187], v223 offset:20480
  v_cvt_pk_bf16_f32 v34, v36, v37
  v_mfma_f32_16x16x32_bf16 a[72:75], a[160:163], v[80:83], a[72:75]
  v_exp_f32 v38, v38
  v_mfma_f32_16x16x32_bf16 a[72:75], a[164:167], v[112:115], a[72:75]
  ds_read_b64_tr_b16 a[188:189], v223 offset:24576
  v_mfma_f32_16x16x32_bf16 a[76:79], a[164:167], v[120:123], a[76:79]
  s_waitcnt lgkmcnt(7)
  v_exp_f32 v39, v39
  v_mfma_f32_16x16x32_bf16 a[76:79], a[160:163], v[88:91], a[76:79]
  ds_read_b64_tr_b16 a[190:191], v223 offset:28672
  v_cvt_pk_bf16_f32 v35, v38, v39
  v_mfma_f32_16x16x32_bf16 a[80:83], a[168:171], v[64:67], a[80:83]
  s_waitcnt vmcnt(11)
  v_exp_f32 v44, v44
  v_mfma_f32_16x16x32_bf16 a[80:83], a[172:175], v[96:99], a[80:83]
  v_mfma_f32_16x16x32_bf16 a[84:87], a[172:175], v[104:107], a[84:87]
  s_barrier
  v_exp_f32 v45, v45
  v_mfma_f32_16x16x32_bf16 a[84:87], a[168:171], v[72:75], a[84:87]
  ds_read_b128 a[128:131], v212 offset:49152
  v_cvt_pk_bf16_f32 v42, v44, v45
  v_mfma_f32_16x16x32_bf16 a[88:91], a[168:171], v[80:83], a[88:91]
  v_exp_f32 v46, v46
  v_mfma_f32_16x16x32_bf16 a[88:91], a[172:175], v[112:115], a[88:91]
  ds_read_b128 a[132:135], v213 offset:49152
  v_mfma_f32_16x16x32_bf16 a[92:95], a[172:175], v[120:123], a[92:95]
  s_waitcnt lgkmcnt(6)
  v_exp_f32 v47, v47
  v_mfma_f32_16x16x32_bf16 a[92:95], a[168:171], v[88:91], a[92:95]
  ds_read_b128 a[136:139], v214 offset:49152
  v_cvt_pk_bf16_f32 v43, v46, v47
  v_mfma_f32_16x16x32_bf16 a[96:99], a[176:179], v[64:67], a[96:99]
  v_exp_f32 v52, v52
  v_mfma_f32_16x16x32_bf16 a[96:99], a[180:183], v[96:99], a[96:99]
  ds_read_b128 a[140:143], v215 offset:49152
  buffer_load_dwordx4 a[216:219], v243, s[24:27], s38 offen sc1
  s_add_u32 s38, s38, 4096
  v_mfma_f32_16x16x32_bf16 a[100:103], a[180:183], v[104:107], a[100:103]
  v_exp_f32 v53, v53
  v_mfma_f32_16x16x32_bf16 a[100:103], a[176:179], v[72:75], a[100:103]
  v_cvt_pk_bf16_f32 v50, v52, v53
  v_mfma_f32_16x16x32_bf16 a[104:107], a[176:179], v[80:83], a[104:107]
  v_exp_f32 v54, v54
  v_mfma_f32_16x16x32_bf16 a[104:107], a[180:183], v[112:115], a[104:107]
  v_mfma_f32_16x16x32_bf16 a[108:111], a[180:183], v[120:123], a[108:111]
  s_waitcnt lgkmcnt(4)
  v_exp_f32 v55, v55
  v_mfma_f32_16x16x32_bf16 a[108:111], a[176:179], v[88:91], a[108:111]
  v_cvt_pk_bf16_f32 v51, v54, v55
  v_mfma_f32_16x16x32_bf16 a[112:115], a[184:187], v[64:67], a[112:115]
  v_exp_f32 v60, v60
  v_mfma_f32_16x16x32_bf16 a[112:115], a[188:191], v[96:99], a[112:115]
  v_mfma_f32_16x16x32_bf16 a[116:119], a[188:191], v[104:107], a[116:119]
  v_exp_f32 v61, v61
  v_mfma_f32_16x16x32_bf16 a[116:119], a[184:187], v[72:75], a[116:119]
  v_cvt_pk_bf16_f32 v58, v60, v61
  v_mfma_f32_16x16x32_bf16 a[120:123], a[184:187], v[80:83], a[120:123]
  v_exp_f32 v62, v62
  v_mfma_f32_16x16x32_bf16 a[120:123], a[188:191], v[112:115], a[120:123]
  v_mfma_f32_16x16x32_bf16 a[124:127], a[188:191], v[120:123], a[124:127]
  s_waitcnt lgkmcnt(0)
  v_exp_f32 v63, v63
  v_mfma_f32_16x16x32_bf16 a[124:127], a[184:187], v[88:91], a[124:127]
  v_cvt_pk_bf16_f32 v59, v62, v63
  v_mfma_f32_16x16x32_bf16 v[64:67], a[128:131], v[128:131], v[192:195]
  s_add_u32 m0, s28, 65536
  v_mfma_f32_16x16x32_bf16 v[64:67], a[132:135], v[132:135], v[64:67]
  ds_read_b128 a[144:147], v212 offset:53248
  v_mfma_f32_16x16x32_bf16 v[64:67], a[136:139], v[136:139], v[64:67]
  buffer_load_dwordx4 v236, s[16:19], s29 offen offset:0 lds
  v_mfma_f32_16x16x32_bf16 v[64:67], a[140:143], v[140:143], v[64:67]
  ds_read_b128 a[148:151], v213 offset:53248
  v_mfma_f32_16x16x32_bf16 v[72:75], a[140:143], v[156:159], v[196:199]
  v_mfma_f32_16x16x32_bf16 v[72:75], a[136:139], v[152:155], v[72:75]
  ds_read_b128 a[152:155], v214 offset:53248
  v_mfma_f32_16x16x32_bf16 v[72:75], a[132:135], v[148:151], v[72:75]
  buffer_load_dwordx4 v237, s[16:19], s29 offen offset:1024 lds
  v_mfma_f32_16x16x32_bf16 v[72:75], a[128:131], v[144:147], v[72:75]
  ds_read_b128 a[156:159], v215 offset:53248
  v_mfma_f32_16x16x32_bf16 v[80:83], a[128:131], v[160:163], v[200:203]
  v_exp_f32 v64, v64
  v_mfma_f32_16x16x32_bf16 v[80:83], a[132:135], v[164:167], v[80:83]
  v_mfma_f32_16x16x32_bf16 v[80:83], a[136:139], v[168:171], v[80:83]
  v_exp_f32 v65, v65
  v_mfma_f32_16x16x32_bf16 v[80:83], a[140:143], v[172:175], v[80:83]
  v_cvt_pk_bf16_f32 v64, v64, v65
  v_mfma_f32_16x16x32_bf16 v[88:91], a[140:143], v[188:191], v[204:207]
  v_exp_f32 v66, v66
  v_mfma_f32_16x16x32_bf16 v[88:91], a[136:139], v[184:187], v[88:91]
  buffer_load_dwordx4 v236, s[16:19], s29 offen offset:2048 lds
  v_mfma_f32_16x16x32_bf16 v[88:91], a[132:135], v[180:183], v[88:91]
  s_waitcnt lgkmcnt(0)
  v_exp_f32 v67, v67
  v_mfma_f32_16x16x32_bf16 v[88:91], a[128:131], v[176:179], v[88:91]
  v_cvt_pk_bf16_f32 v65, v66, v67
  v_mfma_f32_16x16x32_bf16 v[68:71], a[144:147], v[128:131], v[192:195]
  v_exp_f32 v72, v72
  v_mfma_f32_16x16x32_bf16 v[68:71], a[148:151], v[132:135], v[68:71]
  ds_read_b128 a[128:131], v212 offset:57344
  v_mfma_f32_16x16x32_bf16 v[68:71], a[152:155], v[136:139], v[68:71]
  v_exp_f32 v73, v73
  v_mfma_f32_16x16x32_bf16 v[68:71], a[156:159], v[140:143], v[68:71]
  ds_read_b128 a[132:135], v213 offset:57344
  v_cvt_pk_bf16_f32 v72, v72, v73
  v_mfma_f32_16x16x32_bf16 v[76:79], a[156:159], v[156:159], v[196:199]
  v_exp_f32 v74, v74
  v_mfma_f32_16x16x32_bf16 v[76:79], a[152:155], v[152:155], v[76:79]
  ds_read_b128 a[136:139], v214 offset:57344
  v_mfma_f32_16x16x32_bf16 v[76:79], a[148:151], v[148:151], v[76:79]
  v_exp_f32 v75, v75
  v_mfma_f32_16x16x32_bf16 v[76:79], a[144:147], v[144:147], v[76:79]
  ds_read_b128 a[140:143], v215 offset:57344
  v_cvt_pk_bf16_f32 v73, v74, v75
  v_mfma_f32_16x16x32_bf16 v[84:87], a[144:147], v[160:163], v[200:203]
  v_exp_f32 v80, v80
  v_mfma_f32_16x16x32_bf16 v[84:87], a[148:151], v[164:167], v[84:87]
  buffer_load_dwordx4 v237, s[16:19], s29 offen offset:3072 lds
  v_mfma_f32_16x16x32_bf16 v[84:87], a[152:155], v[168:171], v[84:87]
  s_add_u32 s29, s29, 16384
  v_exp_f32 v81, v81
  v_mfma_f32_16x16x32_bf16 v[84:87], a[156:159], v[172:175], v[84:87]
  v_cvt_pk_bf16_f32 v80, v80, v81
  v_mfma_f32_16x16x32_bf16 v[92:95], a[156:159], v[188:191], v[204:207]
  s_add_u32 m0, s28, 16384
  v_exp_f32 v82, v82
  v_mfma_f32_16x16x32_bf16 v[92:95], a[152:155], v[184:187], v[92:95]
  buffer_load_dwordx4 v232, s[12:15], s29 offen offset:0 lds
  v_mfma_f32_16x16x32_bf16 v[92:95], a[148:151], v[180:183], v[92:95]
  s_waitcnt lgkmcnt(0)
  v_exp_f32 v83, v83
  v_mfma_f32_16x16x32_bf16 v[92:95], a[144:147], v[176:179], v[92:95]
  v_cvt_pk_bf16_f32 v81, v82, v83
  v_mfma_f32_16x16x32_bf16 v[96:99], a[128:131], v[128:131], v[192:195]
  v_exp_f32 v88, v88
  v_mfma_f32_16x16x32_bf16 v[96:99], a[132:135], v[132:135], v[96:99]
  ds_read_b128 a[144:147], v212 offset:61440
  v_mfma_f32_16x16x32_bf16 v[96:99], a[136:139], v[136:139], v[96:99]
  v_exp_f32 v89, v89
  v_mfma_f32_16x16x32_bf16 v[96:99], a[140:143], v[140:143], v[96:99]
  ds_read_b128 a[148:151], v213 offset:61440
  v_cvt_pk_bf16_f32 v88, v88, v89
  v_mfma_f32_16x16x32_bf16 v[104:107], a[140:143], v[156:159], v[196:199]
  v_exp_f32 v90, v90
  v_mfma_f32_16x16x32_bf16 v[104:107], a[136:139], v[152:155], v[104:107]
  ds_read_b128 a[152:155], v214 offset:61440
  v_mfma_f32_16x16x32_bf16 v[104:107], a[132:135], v[148:151], v[104:107]
  v_exp_f32 v91, v91
  v_mfma_f32_16x16x32_bf16 v[104:107], a[128:131], v[144:147], v[104:107]
  ds_read_b128 a[156:159], v215 offset:61440
  v_cvt_pk_bf16_f32 v89, v90, v91
  v_mfma_f32_16x16x32_bf16 v[112:115], a[128:131], v[160:163], v[200:203]
  v_exp_f32 v68, v68
  v_mfma_f32_16x16x32_bf16 v[112:115], a[132:135], v[164:167], v[112:115]
  buffer_load_dwordx4 v233, s[12:15], s29 offen offset:1024 lds
  v_mfma_f32_16x16x32_bf16 v[112:115], a[136:139], v[168:171], v[112:115]
  v_exp_f32 v69, v69
  v_mfma_f32_16x16x32_bf16 v[112:115], a[140:143], v[172:175], v[112:115]
  v_cvt_pk_bf16_f32 v66, v68, v69
  v_mfma_f32_16x16x32_bf16 v[120:123], a[140:143], v[188:191], v[204:207]
  v_exp_f32 v70, v70
  v_mfma_f32_16x16x32_bf16 v[120:123], a[136:139], v[184:187], v[120:123]
  buffer_load_dwordx4 v234, s[12:15], s29 offen offset:2048 lds
  v_mfma_f32_16x16x32_bf16 v[120:123], a[132:135], v[180:183], v[120:123]
  s_waitcnt lgkmcnt(0)
  v_exp_f32 v71, v71
  v_mfma_f32_16x16x32_bf16 v[120:123], a[128:131], v[176:179], v[120:123]
  v_cvt_pk_bf16_f32 v67, v70, v71
  v_mfma_f32_16x16x32_bf16 v[100:103], a[144:147], v[128:131], v[192:195]
  v_exp_f32 v76, v76
  v_mfma_f32_16x16x32_bf16 v[100:103], a[148:151], v[132:135], v[100:103]
  ds_read_b64_tr_b16 a[160:161], v216 offset:32768
  v_mfma_f32_16x16x32_bf16 v[100:103], a[152:155], v[136:139], v[100:103]
  v_exp_f32 v77, v77
  v_mfma_f32_16x16x32_bf16 v[100:103], a[156:159], v[140:143], v[100:103]
  ds_read_b64_tr_b16 a[162:163], v216 offset:36864
  v_cvt_pk_bf16_f32 v74, v76, v77
  v_mfma_f32_16x16x32_bf16 v[108:111], a[156:159], v[156:159], v[196:199]
  v_exp_f32 v78, v78
  v_mfma_f32_16x16x32_bf16 v[108:111], a[152:155], v[152:155], v[108:111]
  ds_read_b64_tr_b16 a[164:165], v216 offset:40960
  buffer_load_dwordx4 v235, s[12:15], s29 offen offset:3072 lds
  v_mfma_f32_16x16x32_bf16 v[108:111], a[148:151], v[148:151], v[108:111]
  v_exp_f32 v79, v79
  v_mfma_f32_16x16x32_bf16 v[108:111], a[144:147], v[144:147], v[108:111]
  ds_read_b64_tr_b16 a[166:167], v216 offset:45056
  v_cvt_pk_bf16_f32 v75, v78, v79
  v_mfma_f32_16x16x32_bf16 v[116:119], a[144:147], v[160:163], v[200:203]
  v_exp_f32 v84, v84
  v_mfma_f32_16x16x32_bf16 v[116:119], a[148:151], v[164:167], v[116:119]
  ds_read_b64_tr_b16 a[168:169], v217 offset:32768
  s_add_u32 m0, s50, 4096
  v_mfma_f32_16x16x32_bf16 v[116:119], a[152:155], v[168:171], v[116:119]
  v_exp_f32 v85, v85
  v_mfma_f32_16x16x32_bf16 v[116:119], a[156:159], v[172:175], v[116:119]
  ds_read_b64_tr_b16 a[170:171], v217 offset:36864
  v_cvt_pk_bf16_f32 v82, v84, v85
  v_mfma_f32_16x16x32_bf16 v[124:127], a[156:159], v[188:191], v[204:207]
  v_exp_f32 v86, v86
  v_mfma_f32_16x16x32_bf16 v[124:127], a[152:155], v[184:187], v[124:127]
  ds_read_b64_tr_b16 a[172:173], v217 offset:40960
  buffer_load_dwordx4 v253, s[44:47], s35 offen lds
  s_add_u32 s35, s35, 221184
  v_mfma_f32_16x16x32_bf16 v[124:127], a[148:151], v[180:183], v[124:127]
  v_exp_f32 v87, v87
  v_mfma_f32_16x16x32_bf16 v[124:127], a[144:147], v[176:179], v[124:127]
  ds_read_b64_tr_b16 a[174:175], v217 offset:45056
  v_cvt_pk_bf16_f32 v83, v86, v87
  v_mfma_f32_16x16x32_bf16 a[192:195], a[208:211], v[0:3], a[192:195]
  v_exp_f32 v92, v92
  v_mfma_f32_16x16x32_bf16 a[192:195], a[208:211], v[32:35], a[192:195]
  ds_read_b64_tr_b16 a[176:177], v218 offset:32768
  v_lshrrev_b32 v254, 4, v242
  v_mfma_f32_16x16x32_bf16 a[196:199], a[208:211], v[8:11], a[196:199]
  v_exp_f32 v93, v93
  v_mfma_f32_16x16x32_bf16 a[196:199], a[208:211], v[40:43], a[196:199]
  ds_read_b64_tr_b16 a[178:179], v218 offset:36864
  v_cvt_pk_bf16_f32 v90, v92, v93
  v_mfma_f32_16x16x32_bf16 a[200:203], a[208:211], v[16:19], a[200:203]
  v_exp_f32 v94, v94
  v_mfma_f32_16x16x32_bf16 a[200:203], a[208:211], v[48:51], a[200:203]
  ds_read_b64_tr_b16 a[180:181], v218 offset:40960
  v_lshrrev_b32 v254, 5, v254
  v_mfma_f32_16x16x32_bf16 a[204:207], a[208:211], v[24:27], a[204:207]
  s_waitcnt lgkmcnt(7)
  v_exp_f32 v95, v95
  v_mfma_f32_16x16x32_bf16 a[204:207], a[208:211], v[56:59], a[204:207]
  ds_read_b64_tr_b16 a[182:183], v218 offset:45056
  v_cvt_pk_bf16_f32 v91, v94, v95
  v_mfma_f32_16x16x32_bf16 a[0:3], a[160:163], v[0:3], a[0:3]
  v_exp_f32 v96, v96
  v_mfma_f32_16x16x32_bf16 a[0:3], a[164:167], v[32:35], a[0:3]
  ds_read_b64_tr_b16 a[184:185], v219 offset:32768
  v_lshl_add_u32 v253, v254, 30, v253
  v_mfma_f32_16x16x32_bf16 a[4:7], a[164:167], v[40:43], a[4:7]
  v_exp_f32 v97, v97
  v_mfma_f32_16x16x32_bf16 a[4:7], a[160:163], v[8:11], a[4:7]
  ds_read_b64_tr_b16 a[186:187], v219 offset:36864
  v_cvt_pk_bf16_f32 v96, v96, v97
  v_mfma_f32_16x16x32_bf16 a[8:11], a[160:163], v[16:19], a[8:11]
  v_exp_f32 v98, v98
  v_mfma_f32_16x16x32_bf16 a[8:11], a[164:167], v[48:51], a[8:11]
  ds_read_b64_tr_b16 a[188:189], v219 offset:40960
  v_mfma_f32_16x16x32_bf16 a[12:15], a[164:167], v[56:59], a[12:15]
  s_waitcnt lgkmcnt(7)
  v_exp_f32 v99, v99
  v_mfma_f32_16x16x32_bf16 a[12:15], a[160:163], v[24:27], a[12:15]
  ds_read_b64_tr_b16 a[190:191], v219 offset:45056
  v_cvt_pk_bf16_f32 v97, v98, v99
  v_mfma_f32_16x16x32_bf16 a[16:19], a[168:171], v[0:3], a[16:19]
  v_exp_f32 v104, v104
  v_mfma_f32_16x16x32_bf16 a[16:19], a[172:175], v[32:35], a[16:19]
  ds_read_b64_tr_b16 a[160:161], v220 offset:32768
  v_mfma_f32_16x16x32_bf16 a[20:23], a[172:175], v[40:43], a[20:23]
  v_exp_f32 v105, v105
  v_mfma_f32_16x16x32_bf16 a[20:23], a[168:171], v[8:11], a[20:23]
  ds_read_b64_tr_b16 a[162:163], v220 offset:36864
  v_cvt_pk_bf16_f32 v104, v104, v105
  v_mfma_f32_16x16x32_bf16 a[24:27], a[168:171], v[16:19], a[24:27]
  v_exp_f32 v106, v106
  v_mfma_f32_16x16x32_bf16 a[24:27], a[172:175], v[48:51], a[24:27]
  ds_read_b64_tr_b16 a[164:165], v220 offset:40960
  v_mfma_f32_16x16x32_bf16 a[28:31], a[172:175], v[56:59], a[28:31]
  s_waitcnt lgkmcnt(7)
  v_exp_f32 v107, v107
  v_mfma_f32_16x16x32_bf16 a[28:31], a[168:171], v[24:27], a[28:31]
  ds_read_b64_tr_b16 a[166:167], v220 offset:45056
  v_cvt_pk_bf16_f32 v105, v106, v107
  v_mfma_f32_16x16x32_bf16 a[32:35], a[176:179], v[0:3], a[32:35]
  v_exp_f32 v112, v112
  v_mfma_f32_16x16x32_bf16 a[32:35], a[180:183], v[32:35], a[32:35]
  ds_read_b64_tr_b16 a[168:169], v221 offset:32768
  v_mfma_f32_16x16x32_bf16 a[36:39], a[180:183], v[40:43], a[36:39]
  v_exp_f32 v113, v113
  v_mfma_f32_16x16x32_bf16 a[36:39], a[176:179], v[8:11], a[36:39]
  ds_read_b64_tr_b16 a[170:171], v221 offset:36864
  v_cvt_pk_bf16_f32 v112, v112, v113
  v_mfma_f32_16x16x32_bf16 a[40:43], a[176:179], v[16:19], a[40:43]
  v_exp_f32 v114, v114
  v_mfma_f32_16x16x32_bf16 a[40:43], a[180:183], v[48:51], a[40:43]
  ds_read_b64_tr_b16 a[172:173], v221 offset:40960
  v_mfma_f32_16x16x32_bf16 a[44:47], a[180:183], v[56:59], a[44:47]
  s_waitcnt lgkmcnt(7)
  v_exp_f32 v115, v115
  v_mfma_f32_16x16x32_bf16 a[44:47], a[176:179], v[24:27], a[44:47]
  ds_read_b64_tr_b16 a[174:175], v221 offset:45056
  v_cvt_pk_bf16_f32 v113, v114, v115
  v_mfma_f32_16x16x32_bf16 a[48:51], a[184:187], v[0:3], a[48:51]
  v_exp_f32 v120, v120
  v_mfma_f32_16x16x32_bf16 a[48:51], a[188:191], v[32:35], a[48:51]
  ds_read_b64_tr_b16 a[176:177], v222 offset:32768
  v_mfma_f32_16x16x32_bf16 a[52:55], a[188:191], v[40:43], a[52:55]
  v_exp_f32 v121, v121
  v_mfma_f32_16x16x32_bf16 a[52:55], a[184:187], v[8:11], a[52:55]
  ds_read_b64_tr_b16 a[178:179], v222 offset:36864
  v_cvt_pk_bf16_f32 v120, v120, v121
  v_mfma_f32_16x16x32_bf16 a[56:59], a[184:187], v[16:19], a[56:59]
  v_exp_f32 v122, v122
  v_mfma_f32_16x16x32_bf16 a[56:59], a[188:191], v[48:51], a[56:59]
  ds_read_b64_tr_b16 a[180:181], v222 offset:40960
  v_mfma_f32_16x16x32_bf16 a[60:63], a[188:191], v[56:59], a[60:63]
  s_waitcnt lgkmcnt(7)
  v_exp_f32 v123, v123
  v_mfma_f32_16x16x32_bf16 a[60:63], a[184:187], v[24:27], a[60:63]
  ds_read_b64_tr_b16 a[182:183], v222 offset:45056
  v_cvt_pk_bf16_f32 v121, v122, v123
  v_mfma_f32_16x16x32_bf16 a[64:67], a[160:163], v[0:3], a[64:67]
  v_exp_f32 v100, v100
  v_mfma_f32_16x16x32_bf16 a[64:67], a[164:167], v[32:35], a[64:67]
  ds_read_b64_tr_b16 a[184:185], v223 offset:32768
  v_mfma_f32_16x16x32_bf16 a[68:71], a[164:167], v[40:43], a[68:71]
  v_exp_f32 v101, v101
  v_mfma_f32_16x16x32_bf16 a[68:71], a[160:163], v[8:11], a[68:71]
  ds_read_b64_tr_b16 a[186:187], v223 offset:36864
  v_cvt_pk_bf16_f32 v98, v100, v101
  v_mfma_f32_16x16x32_bf16 a[72:75], a[160:163], v[16:19], a[72:75]
  v_exp_f32 v102, v102
  v_mfma_f32_16x16x32_bf16 a[72:75], a[164:167], v[48:51], a[72:75]
  ds_read_b64_tr_b16 a[188:189], v223 offset:40960
  v_mfma_f32_16x16x32_bf16 a[76:79], a[164:167], v[56:59], a[76:79]
  s_waitcnt lgkmcnt(7)
  v_exp_f32 v103, v103
  v_mfma_f32_16x16x32_bf16 a[76:79], a[160:163], v[24:27], a[76:79]
  ds_read_b64_tr_b16 a[190:191], v223 offset:45056
  v_cvt_pk_bf16_f32 v99, v102, v103
  v_mfma_f32_16x16x32_bf16 a[80:83], a[168:171], v[0:3], a[80:83]
  s_waitcnt vmcnt(11)
  v_exp_f32 v108, v108
  v_mfma_f32_16x16x32_bf16 a[80:83], a[172:175], v[32:35], a[80:83]
  v_mfma_f32_16x16x32_bf16 a[84:87], a[172:175], v[40:43], a[84:87]
  s_barrier
  v_exp_f32 v109, v109
  v_mfma_f32_16x16x32_bf16 a[84:87], a[168:171], v[8:11], a[84:87]
  ds_read_b128 a[128:131], v212 offset:0
  v_cvt_pk_bf16_f32 v106, v108, v109
  v_mfma_f32_16x16x32_bf16 a[88:91], a[168:171], v[16:19], a[88:91]
  v_exp_f32 v110, v110
  v_mfma_f32_16x16x32_bf16 a[88:91], a[172:175], v[48:51], a[88:91]
  ds_read_b128 a[132:135], v213 offset:0
  v_mfma_f32_16x16x32_bf16 a[92:95], a[172:175], v[56:59], a[92:95]
  s_waitcnt lgkmcnt(6)
  v_exp_f32 v111, v111
  v_mfma_f32_16x16x32_bf16 a[92:95], a[168:171], v[24:27], a[92:95]
  ds_read_b128 a[136:139], v214 offset:0
  v_cvt_pk_bf16_f32 v107, v110, v111
  v_mfma_f32_16x16x32_bf16 a[96:99], a[176:179], v[0:3], a[96:99]
  v_exp_f32 v116, v116
  v_mfma_f32_16x16x32_bf16 a[96:99], a[180:183], v[32:35], a[96:99]
  ds_read_b128 a[140:143], v215 offset:0
  buffer_load_dwordx4 a[220:223], v243, s[24:27], s38 offen sc1
  s_add_u32 s38, s38, 4096
  v_mfma_f32_16x16x32_bf16 a[100:103], a[180:183], v[40:43], a[100:103]
  v_exp_f32 v117, v117
  v_mfma_f32_16x16x32_bf16 a[100:103], a[176:179], v[8:11], a[100:103]
  v_cvt_pk_bf16_f32 v114, v116, v117
  v_mfma_f32_16x16x32_bf16 a[104:107], a[176:179], v[16:19], a[104:107]
  v_exp_f32 v118, v118
  v_mfma_f32_16x16x32_bf16 a[104:107], a[180:183], v[48:51], a[104:107]
  v_mfma_f32_16x16x32_bf16 a[108:111], a[180:183], v[56:59], a[108:111]
  s_waitcnt lgkmcnt(4)
  v_exp_f32 v119, v119
  v_mfma_f32_16x16x32_bf16 a[108:111], a[176:179], v[24:27], a[108:111]
  v_cvt_pk_bf16_f32 v115, v118, v119
  v_mfma_f32_16x16x32_bf16 a[112:115], a[184:187], v[0:3], a[112:115]
  v_exp_f32 v124, v124
  v_mfma_f32_16x16x32_bf16 a[112:115], a[188:191], v[32:35], a[112:115]
  v_mfma_f32_16x16x32_bf16 a[116:119], a[188:191], v[40:43], a[116:119]
  v_exp_f32 v125, v125
  v_mfma_f32_16x16x32_bf16 a[116:119], a[184:187], v[8:11], a[116:119]
  v_cvt_pk_bf16_f32 v122, v124, v125
  v_mfma_f32_16x16x32_bf16 a[120:123], a[184:187], v[16:19], a[120:123]
  v_exp_f32 v126, v126
  v_mfma_f32_16x16x32_bf16 a[120:123], a[188:191], v[48:51], a[120:123]
  v_mfma_f32_16x16x32_bf16 a[124:127], a[188:191], v[56:59], a[124:127]
  s_waitcnt lgkmcnt(0)
  v_exp_f32 v127, v127
  v_mfma_f32_16x16x32_bf16 a[124:127], a[184:187], v[24:27], a[124:127]
  v_cvt_pk_bf16_f32 v123, v126, v127
  v_mfma_f32_16x16x32_bf16 v[0:3], a[128:131], v[128:131], v[192:195]
  s_add_u32 m0, s28, 81920
  v_mfma_f32_16x16x32_bf16 v[0:3], a[132:135], v[132:135], v[0:3]
  ds_read_b128 a[144:147], v212 offset:4096
  v_mfma_f32_16x16x32_bf16 v[0:3], a[136:139], v[136:139], v[0:3]
  buffer_load_dwordx4 v236, s[16:19], s29 offen offset:0 lds
  v_mfma_f32_16x16x32_bf16 v[0:3], a[140:143], v[140:143], v[0:3]
  ds_read_b128 a[148:151], v213 offset:4096
  v_mfma_f32_16x16x32_bf16 v[8:11], a[140:143], v[156:159], v[196:199]
  v_mfma_f32_16x16x32_bf16 v[8:11], a[136:139], v[152:155], v[8:11]
  ds_read_b128 a[152:155], v214 offset:4096
  v_mfma_f32_16x16x32_bf16 v[8:11], a[132:135], v[148:151], v[8:11]
  buffer_load_dwordx4 v237, s[16:19], s29 offen offset:1024 lds
  v_mfma_f32_16x16x32_bf16 v[8:11], a[128:131], v[144:147], v[8:11]
  ds_read_b128 a[156:159], v215 offset:4096
  v_mfma_f32_16x16x32_bf16 v[16:19], a[128:131], v[160:163], v[200:203]
  v_exp_f32 v0, v0
  v_mfma_f32_16x16x32_bf16 v[16:19], a[132:135], v[164:167], v[16:19]
  v_mfma_f32_16x16x32_bf16 v[16:19], a[136:139], v[168:171], v[16:19]
  v_exp_f32 v1, v1
  v_mfma_f32_16x16x32_bf16 v[16:19], a[140:143], v[172:175], v[16:19]
  v_cvt_pk_bf16_f32 v0, v0, v1
  v_mfma_f32_16x16x32_bf16 v[24:27], a[140:143], v[188:191], v[204:207]
  v_exp_f32 v2, v2
  v_mfma_f32_16x16x32_bf16 v[24:27], a[136:139], v[184:187], v[24:27]
  buffer_load_dwordx4 v236, s[16:19], s29 offen offset:2048 lds
  v_mfma_f32_16x16x32_bf16 v[24:27], a[132:135], v[180:183], v[24:27]
  s_waitcnt lgkmcnt(0)
  v_exp_f32 v3, v3
  v_mfma_f32_16x16x32_bf16 v[24:27], a[128:131], v[176:179], v[24:27]
  v_cvt_pk_bf16_f32 v1, v2, v3
  v_mfma_f32_16x16x32_bf16 v[4:7], a[144:147], v[128:131], v[192:195]
  v_exp_f32 v8, v8
  v_mfma_f32_16x16x32_bf16 v[4:7], a[148:151], v[132:135], v[4:7]
  ds_read_b128 a[128:131], v212 offset:8192
  v_mfma_f32_16x16x32_bf16 v[4:7], a[152:155], v[136:139], v[4:7]
  v_exp_f32 v9, v9
  v_mfma_f32_16x16x32_bf16 v[4:7], a[156:159], v[140:143], v[4:7]
  ds_read_b128 a[132:135], v213 offset:8192
  v_cvt_pk_bf16_f32 v8, v8, v9
  v_mfma_f32_16x16x32_bf16 v[12:15], a[156:159], v[156:159], v[196:199]
  v_exp_f32 v10, v10
  v_mfma_f32_16x16x32_bf16 v[12:15], a[152:155], v[152:155], v[12:15]
  ds_read_b128 a[136:139], v214 offset:8192
  v_mfma_f32_16x16x32_bf16 v[12:15], a[148:151], v[148:151], v[12:15]
  v_exp_f32 v11, v11
  v_mfma_f32_16x16x32_bf16 v[12:15], a[144:147], v[144:147], v[12:15]
  ds_read_b128 a[140:143], v215 offset:8192
  v_cvt_pk_bf16_f32 v9, v10, v11
  v_mfma_f32_16x16x32_bf16 v[20:23], a[144:147], v[160:163], v[200:203]
  v_exp_f32 v16, v16
  v_mfma_f32_16x16x32_bf16 v[20:23], a[148:151], v[164:167], v[20:23]
  buffer_load_dwordx4 v237, s[16:19], s29 offen offset:3072 lds
  v_mfma_f32_16x16x32_bf16 v[20:23], a[152:155], v[168:171], v[20:23]
  s_add_u32 s29, s29, 16384
  v_exp_f32 v17, v17
  v_mfma_f32_16x16x32_bf16 v[20:23], a[156:159], v[172:175], v[20:23]
  v_cvt_pk_bf16_f32 v16, v16, v17
  v_mfma_f32_16x16x32_bf16 v[28:31], a[156:159], v[188:191], v[204:207]
  s_add_u32 m0, s28, 32768
  v_exp_f32 v18, v18
  v_mfma_f32_16x16x32_bf16 v[28:31], a[152:155], v[184:187], v[28:31]
  buffer_load_dwordx4 v232, s[12:15], s29 offen offset:0 lds
  v_mfma_f32_16x16x32_bf16 v[28:31], a[148:151], v[180:183], v[28:31]
  s_waitcnt lgkmcnt(0)
  v_exp_f32 v19, v19
  v_mfma_f32_16x16x32_bf16 v[28:31], a[144:147], v[176:179], v[28:31]
  v_cvt_pk_bf16_f32 v17, v18, v19
  v_mfma_f32_16x16x32_bf16 v[32:35], a[128:131], v[128:131], v[192:195]
  v_exp_f32 v24, v24
  v_mfma_f32_16x16x32_bf16 v[32:35], a[132:135], v[132:135], v[32:35]
  ds_read_b128 a[144:147], v212 offset:12288
  v_mfma_f32_16x16x32_bf16 v[32:35], a[136:139], v[136:139], v[32:35]
  v_exp_f32 v25, v25
  v_mfma_f32_16x16x32_bf16 v[32:35], a[140:143], v[140:143], v[32:35]
  ds_read_b128 a[148:151], v213 offset:12288
  v_cvt_pk_bf16_f32 v24, v24, v25
  v_mfma_f32_16x16x32_bf16 v[40:43], a[140:143], v[156:159], v[196:199]
  v_exp_f32 v26, v26
  v_mfma_f32_16x16x32_bf16 v[40:43], a[136:139], v[152:155], v[40:43]
  ds_read_b128 a[152:155], v214 offset:12288
  v_mfma_f32_16x16x32_bf16 v[40:43], a[132:135], v[148:151], v[40:43]
  v_exp_f32 v27, v27
  v_mfma_f32_16x16x32_bf16 v[40:43], a[128:131], v[144:147], v[40:43]
  ds_read_b128 a[156:159], v215 offset:12288
  v_cvt_pk_bf16_f32 v25, v26, v27
  v_mfma_f32_16x16x32_bf16 v[48:51], a[128:131], v[160:163], v[200:203]
  v_exp_f32 v4, v4
  v_mfma_f32_16x16x32_bf16 v[48:51], a[132:135], v[164:167], v[48:51]
  buffer_load_dwordx4 v233, s[12:15], s29 offen offset:1024 lds
  v_mfma_f32_16x16x32_bf16 v[48:51], a[136:139], v[168:171], v[48:51]
  v_exp_f32 v5, v5
  v_mfma_f32_16x16x32_bf16 v[48:51], a[140:143], v[172:175], v[48:51]
  v_cvt_pk_bf16_f32 v2, v4, v5
  v_mfma_f32_16x16x32_bf16 v[56:59], a[140:143], v[188:191], v[204:207]
  v_exp_f32 v6, v6
  v_mfma_f32_16x16x32_bf16 v[56:59], a[136:139], v[184:187], v[56:59]
  buffer_load_dwordx4 v234, s[12:15], s29 offen offset:2048 lds
  v_mfma_f32_16x16x32_bf16 v[56:59], a[132:135], v[180:183], v[56:59]
  s_waitcnt lgkmcnt(0)
  v_exp_f32 v7, v7
  v_mfma_f32_16x16x32_bf16 v[56:59], a[128:131], v[176:179], v[56:59]
  v_cvt_pk_bf16_f32 v3, v6, v7
  v_mfma_f32_16x16x32_bf16 v[36:39], a[144:147], v[128:131], v[192:195]
  v_exp_f32 v12, v12
  v_mfma_f32_16x16x32_bf16 v[36:39], a[148:151], v[132:135], v[36:39]
  ds_read_b64_tr_b16 a[160:161], v216 offset:49152
  v_mfma_f32_16x16x32_bf16 v[36:39], a[152:155], v[136:139], v[36:39]
  v_exp_f32 v13, v13
  v_mfma_f32_16x16x32_bf16 v[36:39], a[156:159], v[140:143], v[36:39]
  ds_read_b64_tr_b16 a[162:163], v216 offset:53248
  v_cvt_pk_bf16_f32 v10, v12, v13
  v_mfma_f32_16x16x32_bf16 v[44:47], a[156:159], v[156:159], v[196:199]
  v_exp_f32 v14, v14
  v_mfma_f32_16x16x32_bf16 v[44:47], a[152:155], v[152:155], v[44:47]
  ds_read_b64_tr_b16 a[164:165], v216 offset:57344
  buffer_load_dwordx4 v235, s[12:15], s29 offen offset:3072 lds
  v_mfma_f32_16x16x32_bf16 v[44:47], a[148:151], v[148:151], v[44:47]
  v_exp_f32 v15, v15
  v_mfma_f32_16x16x32_bf16 v[44:47], a[144:147], v[144:147], v[44:47]
  ds_read_b64_tr_b16 a[166:167], v216 offset:61440
  v_cvt_pk_bf16_f32 v11, v14, v15
  v_mfma_f32_16x16x32_bf16 v[52:55], a[144:147], v[160:163], v[200:203]
  v_exp_f32 v20, v20
  v_mfma_f32_16x16x32_bf16 v[52:55], a[148:151], v[164:167], v[52:55]
  ds_read_b64_tr_b16 a[168:169], v217 offset:49152
  s_add_u32 m0, s50, 2048
  v_mfma_f32_16x16x32_bf16 v[52:55], a[152:155], v[168:171], v[52:55]
  v_exp_f32 v21, v21
  v_mfma_f32_16x16x32_bf16 v[52:55], a[156:159], v[172:175], v[52:55]
  ds_read_b64_tr_b16 a[170:171], v217 offset:53248
  v_cvt_pk_bf16_f32 v18, v20, v21
  v_mfma_f32_16x16x32_bf16 v[60:63], a[156:159], v[188:191], v[204:207]
  v_exp_f32 v22, v22
  v_mfma_f32_16x16x32_bf16 v[60:63], a[152:155], v[184:187], v[60:63]
  ds_read_b64_tr_b16 a[172:173], v217 offset:57344
  buffer_load_dwordx4 v253, s[20:23], s35 offen lds
  v_mfma_f32_16x16x32_bf16 v[60:63], a[148:151], v[180:183], v[60:63]
  v_exp_f32 v23, v23
  v_mfma_f32_16x16x32_bf16 v[60:63], a[144:147], v[176:179], v[60:63]
  ds_read_b64_tr_b16 a[174:175], v217 offset:61440
  v_cvt_pk_bf16_f32 v19, v22, v23
  v_mfma_f32_16x16x32_bf16 a[192:195], a[208:211], v[64:67], a[192:195]
  v_exp_f32 v28, v28
  v_mfma_f32_16x16x32_bf16 a[192:195], a[208:211], v[96:99], a[192:195]
  ds_read_b64_tr_b16 a[176:177], v218 offset:49152
  v_mfma_f32_16x16x32_bf16 a[196:199], a[208:211], v[72:75], a[196:199]
  v_exp_f32 v29, v29
  v_mfma_f32_16x16x32_bf16 a[196:199], a[208:211], v[104:107], a[196:199]
  ds_read_b64_tr_b16 a[178:179], v218 offset:53248
  v_cvt_pk_bf16_f32 v26, v28, v29
  v_mfma_f32_16x16x32_bf16 a[200:203], a[208:211], v[80:83], a[200:203]
  v_exp_f32 v30, v30
  v_mfma_f32_16x16x32_bf16 a[200:203], a[208:211], v[112:115], a[200:203]
  ds_read_b64_tr_b16 a[180:181], v218 offset:57344
  v_mfma_f32_16x16x32_bf16 a[204:207], a[208:211], v[88:91], a[204:207]
  s_waitcnt lgkmcnt(7)
  v_exp_f32 v31, v31
  v_mfma_f32_16x16x32_bf16 a[204:207], a[208:211], v[120:123], a[204:207]
  ds_read_b64_tr_b16 a[182:183], v218 offset:61440
  v_cvt_pk_bf16_f32 v27, v30, v31
  v_mfma_f32_16x16x32_bf16 a[0:3], a[160:163], v[64:67], a[0:3]
  v_exp_f32 v32, v32
  v_mfma_f32_16x16x32_bf16 a[0:3], a[164:167], v[96:99], a[0:3]
  ds_read_b64_tr_b16 a[184:185], v219 offset:49152
  v_mfma_f32_16x16x32_bf16 a[4:7], a[164:167], v[104:107], a[4:7]
  v_exp_f32 v33, v33
  v_mfma_f32_16x16x32_bf16 a[4:7], a[160:163], v[72:75], a[4:7]
  ds_read_b64_tr_b16 a[186:187], v219 offset:53248
  v_cvt_pk_bf16_f32 v32, v32, v33
  v_mfma_f32_16x16x32_bf16 a[8:11], a[160:163], v[80:83], a[8:11]
  v_exp_f32 v34, v34
  v_mfma_f32_16x16x32_bf16 a[8:11], a[164:167], v[112:115], a[8:11]
  ds_read_b64_tr_b16 a[188:189], v219 offset:57344
  v_mfma_f32_16x16x32_bf16 a[12:15], a[164:167], v[120:123], a[12:15]
  s_waitcnt lgkmcnt(7)
  v_exp_f32 v35, v35
  v_mfma_f32_16x16x32_bf16 a[12:15], a[160:163], v[88:91], a[12:15]
  ds_read_b64_tr_b16 a[190:191], v219 offset:61440
  v_cvt_pk_bf16_f32 v33, v34, v35
  v_mfma_f32_16x16x32_bf16 a[16:19], a[168:171], v[64:67], a[16:19]
  v_exp_f32 v40, v40
  v_mfma_f32_16x16x32_bf16 a[16:19], a[172:175], v[96:99], a[16:19]
  ds_read_b64_tr_b16 a[160:161], v220 offset:49152
  v_mfma_f32_16x16x32_bf16 a[20:23], a[172:175], v[104:107], a[20:23]
  v_exp_f32 v41, v41
  v_mfma_f32_16x16x32_bf16 a[20:23], a[168:171], v[72:75], a[20:23]
  ds_read_b64_tr_b16 a[162:163], v220 offset:53248
  v_cvt_pk_bf16_f32 v40, v40, v41
  v_mfma_f32_16x16x32_bf16 a[24:27], a[168:171], v[80:83], a[24:27]
  v_exp_f32 v42, v42
  v_mfma_f32_16x16x32_bf16 a[24:27], a[172:175], v[112:115], a[24:27]
  ds_read_b64_tr_b16 a[164:165], v220 offset:57344
  v_mfma_f32_16x16x32_bf16 a[28:31], a[172:175], v[120:123], a[28:31]
  s_waitcnt lgkmcnt(7)
  v_exp_f32 v43, v43
  v_mfma_f32_16x16x32_bf16 a[28:31], a[168:171], v[88:91], a[28:31]
  ds_read_b64_tr_b16 a[166:167], v220 offset:61440
  v_cvt_pk_bf16_f32 v41, v42, v43
  v_mfma_f32_16x16x32_bf16 a[32:35], a[176:179], v[64:67], a[32:35]
  v_exp_f32 v48, v48
  v_mfma_f32_16x16x32_bf16 a[32:35], a[180:183], v[96:99], a[32:35]
  ds_read_b64_tr_b16 a[168:169], v221 offset:49152
  v_mfma_f32_16x16x32_bf16 a[36:39], a[180:183], v[104:107], a[36:39]
  v_exp_f32 v49, v49
  v_mfma_f32_16x16x32_bf16 a[36:39], a[176:179], v[72:75], a[36:39]
  ds_read_b64_tr_b16 a[170:171], v221 offset:53248
  v_cvt_pk_bf16_f32 v48, v48, v49
  v_mfma_f32_16x16x32_bf16 a[40:43], a[176:179], v[80:83], a[40:43]
  v_exp_f32 v50, v50
  v_mfma_f32_16x16x32_bf16 a[40:43], a[180:183], v[112:115], a[40:43]
  ds_read_b64_tr_b16 a[172:173], v221 offset:57344
  v_mfma_f32_16x16x32_bf16 a[44:47], a[180:183], v[120:123], a[44:47]
  s_waitcnt lgkmcnt(7)
  v_exp_f32 v51, v51
  v_mfma_f32_16x16x32_bf16 a[44:47], a[176:179], v[88:91], a[44:47]
  ds_read_b64_tr_b16 a[174:175], v221 offset:61440
  v_cvt_pk_bf16_f32 v49, v50, v51
  v_mfma_f32_16x16x32_bf16 a[48:51], a[184:187], v[64:67], a[48:51]
  v_exp_f32 v56, v56
  v_mfma_f32_16x16x32_bf16 a[48:51], a[188:191], v[96:99], a[48:51]
  ds_read_b64_tr_b16 a[176:177], v222 offset:49152
  v_mfma_f32_16x16x32_bf16 a[52:55], a[188:191], v[104:107], a[52:55]
  v_exp_f32 v57, v57
  v_mfma_f32_16x16x32_bf16 a[52:55], a[184:187], v[72:75], a[52:55]
  ds_read_b64_tr_b16 a[178:179], v222 offset:53248
  v_cvt_pk_bf16_f32 v56, v56, v57
  v_mfma_f32_16x16x32_bf16 a[56:59], a[184:187], v[80:83], a[56:59]
  v_exp_f32 v58, v58
  v_mfma_f32_16x16x32_bf16 a[56:59], a[188:191], v[112:115], a[56:59]
  ds_read_b64_tr_b16 a[180:181], v222 offset:57344
  v_mfma_f32_16x16x32_bf16 a[60:63], a[188:191], v[120:123], a[60:63]
  s_waitcnt lgkmcnt(7)
  v_exp_f32 v59, v59
  v_mfma_f32_16x16x32_bf16 a[60:63], a[184:187], v[88:91], a[60:63]
  ds_read_b64_tr_b16 a[182:183], v222 offset:61440
  v_cvt_pk_bf16_f32 v57, v58, v59
  v_mfma_f32_16x16x32_bf16 a[64:67], a[160:163], v[64:67], a[64:67]
  v_exp_f32 v36, v36
  v_mfma_f32_16x16x32_bf16 a[64:67], a[164:167], v[96:99], a[64:67]
  ds_read_b64_tr_b16 a[184:185], v223 offset:49152
  v_mfma_f32_16x16x32_bf16 a[68:71], a[164:167], v[104:107], a[68:71]
  v_exp_f32 v37, v37
  v_mfma_f32_16x16x32_bf16 a[68:71], a[160:163], v[72:75], a[68:71]
  ds_read_b64_tr_b16 a[186:187], v223 offset:53248
  v_cvt_pk_bf16_f32 v34, v36, v37
  v_mfma_f32_16x16x32_bf16 a[72:75], a[160:163], v[80:83], a[72:75]
  v_exp_f32 v38, v38
  v_mfma_f32_16x16x32_bf16 a[72:75], a[164:167], v[112:115], a[72:75]
  ds_read_b64_tr_b16 a[188:189], v223 offset:57344
  v_mfma_f32_16x16x32_bf16 a[76:79], a[164:167], v[120:123], a[76:79]
  s_waitcnt lgkmcnt(7)
  v_exp_f32 v39, v39
  v_mfma_f32_16x16x32_bf16 a[76:79], a[160:163], v[88:91], a[76:79]
  ds_read_b64_tr_b16 a[190:191], v223 offset:61440
  v_cvt_pk_bf16_f32 v35, v38, v39
  v_mfma_f32_16x16x32_bf16 a[80:83], a[168:171], v[64:67], a[80:83]
  s_waitcnt vmcnt(11)
  v_exp_f32 v44, v44
  v_mfma_f32_16x16x32_bf16 a[80:83], a[172:175], v[96:99], a[80:83]
  v_mfma_f32_16x16x32_bf16 a[84:87], a[172:175], v[104:107], a[84:87]
  s_barrier
  v_exp_f32 v45, v45
  v_mfma_f32_16x16x32_bf16 a[84:87], a[168:171], v[72:75], a[84:87]
  ds_read_b128 a[128:131], v212 offset:16384
  v_cvt_pk_bf16_f32 v42, v44, v45
  v_mfma_f32_16x16x32_bf16 a[88:91], a[168:171], v[80:83], a[88:91]
  v_exp_f32 v46, v46
  v_mfma_f32_16x16x32_bf16 a[88:91], a[172:175], v[112:115], a[88:91]
  ds_read_b128 a[132:135], v213 offset:16384
  v_mfma_f32_16x16x32_bf16 a[92:95], a[172:175], v[120:123], a[92:95]
  s_waitcnt lgkmcnt(6)
  v_exp_f32 v47, v47
  v_mfma_f32_16x16x32_bf16 a[92:95], a[168:171], v[88:91], a[92:95]
  ds_read_b128 a[136:139], v214 offset:16384
  v_cvt_pk_bf16_f32 v43, v46, v47
  v_mfma_f32_16x16x32_bf16 a[96:99], a[176:179], v[64:67], a[96:99]
  v_exp_f32 v52, v52
  v_mfma_f32_16x16x32_bf16 a[96:99], a[180:183], v[96:99], a[96:99]
  ds_read_b128 a[140:143], v215 offset:16384
  buffer_load_dwordx4 a[224:227], v243, s[24:27], s38 offen sc1
  s_add_u32 s38, s38, 4096
  v_mfma_f32_16x16x32_bf16 a[100:103], a[180:183], v[104:107], a[100:103]
  v_exp_f32 v53, v53
  v_mfma_f32_16x16x32_bf16 a[100:103], a[176:179], v[72:75], a[100:103]
  v_cvt_pk_bf16_f32 v50, v52, v53
  v_mfma_f32_16x16x32_bf16 a[104:107], a[176:179], v[80:83], a[104:107]
  v_exp_f32 v54, v54
  v_mfma_f32_16x16x32_bf16 a[104:107], a[180:183], v[112:115], a[104:107]
  v_mfma_f32_16x16x32_bf16 a[108:111], a[180:183], v[120:123], a[108:111]
  s_waitcnt lgkmcnt(4)
  v_exp_f32 v55, v55
  v_mfma_f32_16x16x32_bf16 a[108:111], a[176:179], v[88:91], a[108:111]
  v_cvt_pk_bf16_f32 v51, v54, v55
  v_mfma_f32_16x16x32_bf16 a[112:115], a[184:187], v[64:67], a[112:115]
  v_exp_f32 v60, v60
  v_mfma_f32_16x16x32_bf16 a[112:115], a[188:191], v[96:99], a[112:115]
  v_mfma_f32_16x16x32_bf16 a[116:119], a[188:191], v[104:107], a[116:119]
  v_exp_f32 v61, v61
  v_mfma_f32_16x16x32_bf16 a[116:119], a[184:187], v[72:75], a[116:119]
  v_cvt_pk_bf16_f32 v58, v60, v61
  v_mfma_f32_16x16x32_bf16 a[120:123], a[184:187], v[80:83], a[120:123]
  v_exp_f32 v62, v62
  v_mfma_f32_16x16x32_bf16 a[120:123], a[188:191], v[112:115], a[120:123]
  v_mfma_f32_16x16x32_bf16 a[124:127], a[188:191], v[120:123], a[124:127]
  s_waitcnt lgkmcnt(0)
  v_exp_f32 v63, v63
  v_mfma_f32_16x16x32_bf16 a[124:127], a[184:187], v[88:91], a[124:127]
  v_cvt_pk_bf16_f32 v59, v62, v63
  v_mfma_f32_16x16x32_bf16 v[64:67], a[128:131], v[128:131], v[192:195]
  s_add_u32 m0, s28, 98304
  v_mfma_f32_16x16x32_bf16 v[64:67], a[132:135], v[132:135], v[64:67]
  ds_read_b128 a[144:147], v212 offset:20480
  v_mfma_f32_16x16x32_bf16 v[64:67], a[136:139], v[136:139], v[64:67]
  buffer_load_dwordx4 v236, s[16:19], s29 offen offset:0 lds
  v_mfma_f32_16x16x32_bf16 v[64:67], a[140:143], v[140:143], v[64:67]
  ds_read_b128 a[148:151], v213 offset:20480
  v_mfma_f32_16x16x32_bf16 v[72:75], a[140:143], v[156:159], v[196:199]
  v_mfma_f32_16x16x32_bf16 v[72:75], a[136:139], v[152:155], v[72:75]
  ds_read_b128 a[152:155], v214 offset:20480
  v_mfma_f32_16x16x32_bf16 v[72:75], a[132:135], v[148:151], v[72:75]
  buffer_load_dwordx4 v237, s[16:19], s29 offen offset:1024 lds
  v_mfma_f32_16x16x32_bf16 v[72:75], a[128:131], v[144:147], v[72:75]
  ds_read_b128 a[156:159], v215 offset:20480
  v_mfma_f32_16x16x32_bf16 v[80:83], a[128:131], v[160:163], v[200:203]
  v_exp_f32 v64, v64
  v_mfma_f32_16x16x32_bf16 v[80:83], a[132:135], v[164:167], v[80:83]
  v_mfma_f32_16x16x32_bf16 v[80:83], a[136:139], v[168:171], v[80:83]
  v_exp_f32 v65, v65
  v_mfma_f32_16x16x32_bf16 v[80:83], a[140:143], v[172:175], v[80:83]
  v_cvt_pk_bf16_f32 v64, v64, v65
  v_mfma_f32_16x16x32_bf16 v[88:91], a[140:143], v[188:191], v[204:207]
  v_exp_f32 v66, v66
  v_mfma_f32_16x16x32_bf16 v[88:91], a[136:139], v[184:187], v[88:91]
  buffer_load_dwordx4 v236, s[16:19], s29 offen offset:2048 lds
  v_mfma_f32_16x16x32_bf16 v[88:91], a[132:135], v[180:183], v[88:91]
  s_waitcnt lgkmcnt(0)
  v_exp_f32 v67, v67
  v_mfma_f32_16x16x32_bf16 v[88:91], a[128:131], v[176:179], v[88:91]
  v_cvt_pk_bf16_f32 v65, v66, v67
  v_mfma_f32_16x16x32_bf16 v[68:71], a[144:147], v[128:131], v[192:195]
  v_exp_f32 v72, v72
  v_mfma_f32_16x16x32_bf16 v[68:71], a[148:151], v[132:135], v[68:71]
  ds_read_b128 a[128:131], v212 offset:24576
  v_mfma_f32_16x16x32_bf16 v[68:71], a[152:155], v[136:139], v[68:71]
  v_exp_f32 v73, v73
  v_mfma_f32_16x16x32_bf16 v[68:71], a[156:159], v[140:143], v[68:71]
  ds_read_b128 a[132:135], v213 offset:24576
  v_cvt_pk_bf16_f32 v72, v72, v73
  v_mfma_f32_16x16x32_bf16 v[76:79], a[156:159], v[156:159], v[196:199]
  v_exp_f32 v74, v74
  v_mfma_f32_16x16x32_bf16 v[76:79], a[152:155], v[152:155], v[76:79]
  ds_read_b128 a[136:139], v214 offset:24576
  v_mfma_f32_16x16x32_bf16 v[76:79], a[148:151], v[148:151], v[76:79]
  v_exp_f32 v75, v75
  v_mfma_f32_16x16x32_bf16 v[76:79], a[144:147], v[144:147], v[76:79]
  ds_read_b128 a[140:143], v215 offset:24576
  v_cvt_pk_bf16_f32 v73, v74, v75
  v_mfma_f32_16x16x32_bf16 v[84:87], a[144:147], v[160:163], v[200:203]
  v_exp_f32 v80, v80
  v_mfma_f32_16x16x32_bf16 v[84:87], a[148:151], v[164:167], v[84:87]
  buffer_load_dwordx4 v237, s[16:19], s29 offen offset:3072 lds
  v_mfma_f32_16x16x32_bf16 v[84:87], a[152:155], v[168:171], v[84:87]
  s_add_u32 s29, s29, 16384
  v_exp_f32 v81, v81
  v_mfma_f32_16x16x32_bf16 v[84:87], a[156:159], v[172:175], v[84:87]
  v_cvt_pk_bf16_f32 v80, v80, v81
  v_mfma_f32_16x16x32_bf16 v[92:95], a[156:159], v[188:191], v[204:207]
  s_add_u32 m0, s28, 49152
  v_exp_f32 v82, v82
  v_mfma_f32_16x16x32_bf16 v[92:95], a[152:155], v[184:187], v[92:95]
  buffer_load_dwordx4 v232, s[12:15], s29 offen offset:0 lds
  v_mfma_f32_16x16x32_bf16 v[92:95], a[148:151], v[180:183], v[92:95]
  s_waitcnt lgkmcnt(0)
  v_exp_f32 v83, v83
  v_mfma_f32_16x16x32_bf16 v[92:95], a[144:147], v[176:179], v[92:95]
  v_cvt_pk_bf16_f32 v81, v82, v83
  v_mfma_f32_16x16x32_bf16 v[96:99], a[128:131], v[128:131], v[192:195]
  v_exp_f32 v88, v88
  v_mfma_f32_16x16x32_bf16 v[96:99], a[132:135], v[132:135], v[96:99]
  ds_read_b128 a[144:147], v212 offset:28672
  v_mfma_f32_16x16x32_bf16 v[96:99], a[136:139], v[136:139], v[96:99]
  v_exp_f32 v89, v89
  v_mfma_f32_16x16x32_bf16 v[96:99], a[140:143], v[140:143], v[96:99]
  ds_read_b128 a[148:151], v213 offset:28672
  v_cvt_pk_bf16_f32 v88, v88, v89
  v_mfma_f32_16x16x32_bf16 v[104:107], a[140:143], v[156:159], v[196:199]
  v_exp_f32 v90, v90
  v_mfma_f32_16x16x32_bf16 v[104:107], a[136:139], v[152:155], v[104:107]
  ds_read_b128 a[152:155], v214 offset:28672
  v_mfma_f32_16x16x32_bf16 v[104:107], a[132:135], v[148:151], v[104:107]
  v_exp_f32 v91, v91
  v_mfma_f32_16x16x32_bf16 v[104:107], a[128:131], v[144:147], v[104:107]
  ds_read_b128 a[156:159], v215 offset:28672
  v_cvt_pk_bf16_f32 v89, v90, v91
  v_mfma_f32_16x16x32_bf16 v[112:115], a[128:131], v[160:163], v[200:203]
  v_exp_f32 v68, v68
  v_mfma_f32_16x16x32_bf16 v[112:115], a[132:135], v[164:167], v[112:115]
  buffer_load_dwordx4 v233, s[12:15], s29 offen offset:1024 lds
  v_mfma_f32_16x16x32_bf16 v[112:115], a[136:139], v[168:171], v[112:115]
  v_exp_f32 v69, v69
  v_mfma_f32_16x16x32_bf16 v[112:115], a[140:143], v[172:175], v[112:115]
  v_cvt_pk_bf16_f32 v66, v68, v69
  v_mfma_f32_16x16x32_bf16 v[120:123], a[140:143], v[188:191], v[204:207]
  v_exp_f32 v70, v70
  v_mfma_f32_16x16x32_bf16 v[120:123], a[136:139], v[184:187], v[120:123]
  buffer_load_dwordx4 v234, s[12:15], s29 offen offset:2048 lds
  v_mfma_f32_16x16x32_bf16 v[120:123], a[132:135], v[180:183], v[120:123]
  s_waitcnt lgkmcnt(0)
  v_exp_f32 v71, v71
  v_mfma_f32_16x16x32_bf16 v[120:123], a[128:131], v[176:179], v[120:123]
  v_cvt_pk_bf16_f32 v67, v70, v71
  v_mfma_f32_16x16x32_bf16 v[100:103], a[144:147], v[128:131], v[192:195]
  v_exp_f32 v76, v76
  v_mfma_f32_16x16x32_bf16 v[100:103], a[148:151], v[132:135], v[100:103]
  ds_read_b64_tr_b16 a[160:161], v216 offset:0
  v_mfma_f32_16x16x32_bf16 v[100:103], a[152:155], v[136:139], v[100:103]
  v_exp_f32 v77, v77
  v_mfma_f32_16x16x32_bf16 v[100:103], a[156:159], v[140:143], v[100:103]
  ds_read_b64_tr_b16 a[162:163], v216 offset:4096
  v_cvt_pk_bf16_f32 v74, v76, v77
  v_mfma_f32_16x16x32_bf16 v[108:111], a[156:159], v[156:159], v[196:199]
  v_exp_f32 v78, v78
  v_mfma_f32_16x16x32_bf16 v[108:111], a[152:155], v[152:155], v[108:111]
  ds_read_b64_tr_b16 a[164:165], v216 offset:8192
  buffer_load_dwordx4 v235, s[12:15], s29 offen offset:3072 lds
  v_mfma_f32_16x16x32_bf16 v[108:111], a[148:151], v[148:151], v[108:111]
  v_exp_f32 v79, v79
  v_mfma_f32_16x16x32_bf16 v[108:111], a[144:147], v[144:147], v[108:111]
  ds_read_b64_tr_b16 a[166:167], v216 offset:12288
  v_cvt_pk_bf16_f32 v75, v78, v79
  v_mfma_f32_16x16x32_bf16 v[116:119], a[144:147], v[160:163], v[200:203]
  v_exp_f32 v84, v84
  v_mfma_f32_16x16x32_bf16 v[116:119], a[148:151], v[164:167], v[116:119]
  ds_read_b64_tr_b16 a[168:169], v217 offset:0
  s_add_u32 m0, s50, 5120
  v_mfma_f32_16x16x32_bf16 v[116:119], a[152:155], v[168:171], v[116:119]
  v_exp_f32 v85, v85
  v_mfma_f32_16x16x32_bf16 v[116:119], a[156:159], v[172:175], v[116:119]
  ds_read_b64_tr_b16 a[170:171], v217 offset:4096
  v_cvt_pk_bf16_f32 v82, v84, v85
  v_mfma_f32_16x16x32_bf16 v[124:127], a[156:159], v[188:191], v[204:207]
  v_exp_f32 v86, v86
  v_mfma_f32_16x16x32_bf16 v[124:127], a[152:155], v[184:187], v[124:127]
  ds_read_b64_tr_b16 a[172:173], v217 offset:8192
  buffer_load_dwordx4 v253, s[44:47], s35 offen lds
  s_add_u32 s35, s35, 221184
  v_mfma_f32_16x16x32_bf16 v[124:127], a[148:151], v[180:183], v[124:127]
  v_exp_f32 v87, v87
  v_mfma_f32_16x16x32_bf16 v[124:127], a[144:147], v[176:179], v[124:127]
  ds_read_b64_tr_b16 a[174:175], v217 offset:12288
  v_cvt_pk_bf16_f32 v83, v86, v87
  v_mfma_f32_16x16x32_bf16 a[192:195], a[208:211], v[0:3], a[192:195]
  v_exp_f32 v92, v92
  v_mfma_f32_16x16x32_bf16 a[192:195], a[208:211], v[32:35], a[192:195]
  ds_read_b64_tr_b16 a[176:177], v218 offset:0
  v_mfma_f32_16x16x32_bf16 a[196:199], a[208:211], v[8:11], a[196:199]
  v_exp_f32 v93, v93
  v_mfma_f32_16x16x32_bf16 a[196:199], a[208:211], v[40:43], a[196:199]
  ds_read_b64_tr_b16 a[178:179], v218 offset:4096
  v_cvt_pk_bf16_f32 v90, v92, v93
  v_mfma_f32_16x16x32_bf16 a[200:203], a[208:211], v[16:19], a[200:203]
  v_exp_f32 v94, v94
  v_mfma_f32_16x16x32_bf16 a[200:203], a[208:211], v[48:51], a[200:203]
  ds_read_b64_tr_b16 a[180:181], v218 offset:8192
  v_mfma_f32_16x16x32_bf16 a[204:207], a[208:211], v[24:27], a[204:207]
  s_waitcnt lgkmcnt(7)
  v_exp_f32 v95, v95
  v_mfma_f32_16x16x32_bf16 a[204:207], a[208:211], v[56:59], a[204:207]
  ds_read_b64_tr_b16 a[182:183], v218 offset:12288
  v_cvt_pk_bf16_f32 v91, v94, v95
  v_mfma_f32_16x16x32_bf16 a[0:3], a[160:163], v[0:3], a[0:3]
  v_exp_f32 v96, v96
  v_mfma_f32_16x16x32_bf16 a[0:3], a[164:167], v[32:35], a[0:3]
  ds_read_b64_tr_b16 a[184:185], v219 offset:0
  v_mfma_f32_16x16x32_bf16 a[4:7], a[164:167], v[40:43], a[4:7]
  v_exp_f32 v97, v97
  v_mfma_f32_16x16x32_bf16 a[4:7], a[160:163], v[8:11], a[4:7]
  ds_read_b64_tr_b16 a[186:187], v219 offset:4096
  v_cvt_pk_bf16_f32 v96, v96, v97
  v_mfma_f32_16x16x32_bf16 a[8:11], a[160:163], v[16:19], a[8:11]
  v_exp_f32 v98, v98
  v_mfma_f32_16x16x32_bf16 a[8:11], a[164:167], v[48:51], a[8:11]
  ds_read_b64_tr_b16 a[188:189], v219 offset:8192
  v_mfma_f32_16x16x32_bf16 a[12:15], a[164:167], v[56:59], a[12:15]
  s_waitcnt lgkmcnt(7)
  v_exp_f32 v99, v99
  v_mfma_f32_16x16x32_bf16 a[12:15], a[160:163], v[24:27], a[12:15]
  ds_read_b64_tr_b16 a[190:191], v219 offset:12288
  v_cvt_pk_bf16_f32 v97, v98, v99
  v_mfma_f32_16x16x32_bf16 a[16:19], a[168:171], v[0:3], a[16:19]
  v_exp_f32 v104, v104
  v_mfma_f32_16x16x32_bf16 a[16:19], a[172:175], v[32:35], a[16:19]
  ds_read_b64_tr_b16 a[160:161], v220 offset:0
  v_mfma_f32_16x16x32_bf16 a[20:23], a[172:175], v[40:43], a[20:23]
  v_exp_f32 v105, v105
  v_mfma_f32_16x16x32_bf16 a[20:23], a[168:171], v[8:11], a[20:23]
  ds_read_b64_tr_b16 a[162:163], v220 offset:4096
  v_cvt_pk_bf16_f32 v104, v104, v105
  v_mfma_f32_16x16x32_bf16 a[24:27], a[168:171], v[16:19], a[24:27]
  v_exp_f32 v106, v106
  v_mfma_f32_16x16x32_bf16 a[24:27], a[172:175], v[48:51], a[24:27]
  ds_read_b64_tr_b16 a[164:165], v220 offset:8192
  v_mfma_f32_16x16x32_bf16 a[28:31], a[172:175], v[56:59], a[28:31]
  s_waitcnt lgkmcnt(7)
  v_exp_f32 v107, v107
  v_mfma_f32_16x16x32_bf16 a[28:31], a[168:171], v[24:27], a[28:31]
  ds_read_b64_tr_b16 a[166:167], v220 offset:12288
  v_cvt_pk_bf16_f32 v105, v106, v107
  v_mfma_f32_16x16x32_bf16 a[32:35], a[176:179], v[0:3], a[32:35]
  v_exp_f32 v112, v112
  v_mfma_f32_16x16x32_bf16 a[32:35], a[180:183], v[32:35], a[32:35]
  ds_read_b64_tr_b16 a[168:169], v221 offset:0
  v_mfma_f32_16x16x32_bf16 a[36:39], a[180:183], v[40:43], a[36:39]
  v_exp_f32 v113, v113
  v_mfma_f32_16x16x32_bf16 a[36:39], a[176:179], v[8:11], a[36:39]
  ds_read_b64_tr_b16 a[170:171], v221 offset:4096
  v_cvt_pk_bf16_f32 v112, v112, v113
  v_mfma_f32_16x16x32_bf16 a[40:43], a[176:179], v[16:19], a[40:43]
  v_exp_f32 v114, v114
  v_mfma_f32_16x16x32_bf16 a[40:43], a[180:183], v[48:51], a[40:43]
  ds_read_b64_tr_b16 a[172:173], v221 offset:8192
  v_mfma_f32_16x16x32_bf16 a[44:47], a[180:183], v[56:59], a[44:47]
  s_waitcnt lgkmcnt(7)
  v_exp_f32 v115, v115
  v_mfma_f32_16x16x32_bf16 a[44:47], a[176:179], v[24:27], a[44:47]
  ds_read_b64_tr_b16 a[174:175], v221 offset:12288
  v_cvt_pk_bf16_f32 v113, v114, v115
  v_mfma_f32_16x16x32_bf16 a[48:51], a[184:187], v[0:3], a[48:51]
  v_exp_f32 v120, v120
  v_mfma_f32_16x16x32_bf16 a[48:51], a[188:191], v[32:35], a[48:51]
  ds_read_b64_tr_b16 a[176:177], v222 offset:0
  v_mfma_f32_16x16x32_bf16 a[52:55], a[188:191], v[40:43], a[52:55]
  v_exp_f32 v121, v121
  v_mfma_f32_16x16x32_bf16 a[52:55], a[184:187], v[8:11], a[52:55]
  ds_read_b64_tr_b16 a[178:179], v222 offset:4096
  v_cvt_pk_bf16_f32 v120, v120, v121
  v_mfma_f32_16x16x32_bf16 a[56:59], a[184:187], v[16:19], a[56:59]
  v_exp_f32 v122, v122
  v_mfma_f32_16x16x32_bf16 a[56:59], a[188:191], v[48:51], a[56:59]
  ds_read_b64_tr_b16 a[180:181], v222 offset:8192
  v_mfma_f32_16x16x32_bf16 a[60:63], a[188:191], v[56:59], a[60:63]
  s_waitcnt lgkmcnt(7)
  v_exp_f32 v123, v123
  v_mfma_f32_16x16x32_bf16 a[60:63], a[184:187], v[24:27], a[60:63]
  ds_read_b64_tr_b16 a[182:183], v222 offset:12288
  v_cvt_pk_bf16_f32 v121, v122, v123
  v_mfma_f32_16x16x32_bf16 a[64:67], a[160:163], v[0:3], a[64:67]
  v_exp_f32 v100, v100
  v_mfma_f32_16x16x32_bf16 a[64:67], a[164:167], v[32:35], a[64:67]
  ds_read_b64_tr_b16 a[184:185], v223 offset:0
  v_mfma_f32_16x16x32_bf16 a[68:71], a[164:167], v[40:43], a[68:71]
  v_exp_f32 v101, v101
  v_mfma_f32_16x16x32_bf16 a[68:71], a[160:163], v[8:11], a[68:71]
  ds_read_b64_tr_b16 a[186:187], v223 offset:4096
  v_cvt_pk_bf16_f32 v98, v100, v101
  v_mfma_f32_16x16x32_bf16 a[72:75], a[160:163], v[16:19], a[72:75]
  v_exp_f32 v102, v102
  v_mfma_f32_16x16x32_bf16 a[72:75], a[164:167], v[48:51], a[72:75]
  ds_read_b64_tr_b16 a[188:189], v223 offset:8192
  v_mfma_f32_16x16x32_bf16 a[76:79], a[164:167], v[56:59], a[76:79]
  s_waitcnt lgkmcnt(7)
  v_exp_f32 v103, v103
  v_mfma_f32_16x16x32_bf16 a[76:79], a[160:163], v[24:27], a[76:79]
  ds_read_b64_tr_b16 a[190:191], v223 offset:12288
  v_cvt_pk_bf16_f32 v99, v102, v103
  v_mfma_f32_16x16x32_bf16 a[80:83], a[168:171], v[0:3], a[80:83]
  s_waitcnt vmcnt(11)
  v_exp_f32 v108, v108
  v_mfma_f32_16x16x32_bf16 a[80:83], a[172:175], v[32:35], a[80:83]
  v_mfma_f32_16x16x32_bf16 a[84:87], a[172:175], v[40:43], a[84:87]
  s_barrier
  v_exp_f32 v109, v109
  v_mfma_f32_16x16x32_bf16 a[84:87], a[168:171], v[8:11], a[84:87]
  ds_read_b128 a[128:131], v212 offset:32768
  v_cvt_pk_bf16_f32 v106, v108, v109
  v_mfma_f32_16x16x32_bf16 a[88:91], a[168:171], v[16:19], a[88:91]
  v_exp_f32 v110, v110
  v_mfma_f32_16x16x32_bf16 a[88:91], a[172:175], v[48:51], a[88:91]
  ds_read_b128 a[132:135], v213 offset:32768
  v_mfma_f32_16x16x32_bf16 a[92:95], a[172:175], v[56:59], a[92:95]
  s_waitcnt lgkmcnt(6)
  v_exp_f32 v111, v111
  v_mfma_f32_16x16x32_bf16 a[92:95], a[168:171], v[24:27], a[92:95]
  ds_read_b128 a[136:139], v214 offset:32768
  v_cvt_pk_bf16_f32 v107, v110, v111
  v_mfma_f32_16x16x32_bf16 a[96:99], a[176:179], v[0:3], a[96:99]
  v_exp_f32 v116, v116
  v_mfma_f32_16x16x32_bf16 a[96:99], a[180:183], v[32:35], a[96:99]
  ds_read_b128 a[140:143], v215 offset:32768
  buffer_load_dwordx4 a[228:231], v243, s[24:27], s38 offen sc1
  s_add_u32 s38, s38, 4096
  v_mfma_f32_16x16x32_bf16 a[100:103], a[180:183], v[40:43], a[100:103]
  v_exp_f32 v117, v117
  v_mfma_f32_16x16x32_bf16 a[100:103], a[176:179], v[8:11], a[100:103]
  v_cvt_pk_bf16_f32 v114, v116, v117
  v_mfma_f32_16x16x32_bf16 a[104:107], a[176:179], v[16:19], a[104:107]
  v_exp_f32 v118, v118
  v_mfma_f32_16x16x32_bf16 a[104:107], a[180:183], v[48:51], a[104:107]
  v_mfma_f32_16x16x32_bf16 a[108:111], a[180:183], v[56:59], a[108:111]
  s_waitcnt lgkmcnt(4)
  v_exp_f32 v119, v119
  v_mfma_f32_16x16x32_bf16 a[108:111], a[176:179], v[24:27], a[108:111]
  v_cvt_pk_bf16_f32 v115, v118, v119
  v_mfma_f32_16x16x32_bf16 a[112:115], a[184:187], v[0:3], a[112:115]
  v_exp_f32 v124, v124
  v_mfma_f32_16x16x32_bf16 a[112:115], a[188:191], v[32:35], a[112:115]
  v_mfma_f32_16x16x32_bf16 a[116:119], a[188:191], v[40:43], a[116:119]
  v_exp_f32 v125, v125
  v_mfma_f32_16x16x32_bf16 a[116:119], a[184:187], v[8:11], a[116:119]
  v_cvt_pk_bf16_f32 v122, v124, v125
  v_mfma_f32_16x16x32_bf16 a[120:123], a[184:187], v[16:19], a[120:123]
  v_exp_f32 v126, v126
  v_mfma_f32_16x16x32_bf16 a[120:123], a[188:191], v[48:51], a[120:123]
  v_mfma_f32_16x16x32_bf16 a[124:127], a[188:191], v[56:59], a[124:127]
  s_waitcnt lgkmcnt(0)
  v_exp_f32 v127, v127
  v_mfma_f32_16x16x32_bf16 a[124:127], a[184:187], v[24:27], a[124:127]
  v_cvt_pk_bf16_f32 v123, v126, v127
  v_mfma_f32_16x16x32_bf16 v[0:3], a[128:131], v[128:131], v[192:195]
  s_add_u32 m0, s28, 114688
  s_mov_b32 s20, s88
  s_mov_b32 s21, s89
  v_mfma_f32_16x16x32_bf16 v[0:3], a[132:135], v[132:135], v[0:3]
  ds_read_b128 a[144:147], v212 offset:36864
  s_mov_b32 s22, 5242880
  s_mov_b32 s23, 0x20000
  v_lshrrev_b32 v208, 4, v242
  v_mfma_f32_16x16x32_bf16 v[0:3], a[136:139], v[136:139], v[0:3]
  buffer_load_dwordx4 v236, s[16:19], s29 offen offset:0 lds
  v_mfma_f32_16x16x32_bf16 v[0:3], a[140:143], v[140:143], v[0:3]
  ds_read_b128 a[148:151], v213 offset:36864
  v_and_b32 v209, 1, v208
  v_mfma_f32_16x16x32_bf16 v[8:11], a[140:143], v[156:159], v[196:199]
  v_lshrrev_b32 v208, 1, v208
  v_mul_u32_u24 v208, 0x500, v208
  v_mfma_f32_16x16x32_bf16 v[8:11], a[136:139], v[152:155], v[8:11]
  ds_read_b128 a[152:155], v214 offset:36864
  v_lshl_add_u32 v208, v209, 4, v208
  v_mfma_f32_16x16x32_bf16 v[8:11], a[132:135], v[148:151], v[8:11]
  buffer_load_dwordx4 v237, s[16:19], s29 offen offset:1024 lds
  v_mfma_f32_16x16x32_bf16 v[8:11], a[128:131], v[144:147], v[8:11]
  ds_read_b128 a[156:159], v215 offset:36864
  v_lshrrev_b32 v209, 4, v242
  v_mfma_f32_16x16x32_bf16 v[16:19], a[128:131], v[160:163], v[200:203]
  v_exp_f32 v0, v0
  v_mfma_f32_16x16x32_bf16 v[16:19], a[132:135], v[164:167], v[16:19]
  v_lshrrev_b32 v210, 5, v209
  v_lshlrev_b32 v210, 30, v210
  v_mfma_f32_16x16x32_bf16 v[16:19], a[136:139], v[168:171], v[16:19]
  v_exp_f32 v1, v1
  v_mfma_f32_16x16x32_bf16 v[16:19], a[140:143], v[172:175], v[16:19]
  v_cvt_pk_bf16_f32 v0, v0, v1
  v_or_b32 v210, v210, v208
  v_mfma_f32_16x16x32_bf16 v[24:27], a[140:143], v[188:191], v[204:207]
  v_exp_f32 v2, v2
  v_mfma_f32_16x16x32_bf16 v[24:27], a[136:139], v[184:187], v[24:27]
  buffer_load_dwordx4 v236, s[16:19], s29 offen offset:2048 lds
  v_mfma_f32_16x16x32_bf16 v[24:27], a[132:135], v[180:183], v[24:27]
  s_waitcnt lgkmcnt(0)
  v_exp_f32 v3, v3
  v_mfma_f32_16x16x32_bf16 v[24:27], a[128:131], v[176:179], v[24:27]
  v_cvt_pk_bf16_f32 v1, v2, v3
  v_bfe_u32 v211, v209, 2, 4
  v_mfma_f32_16x16x32_bf16 v[4:7], a[144:147], v[128:131], v[192:195]
  v_exp_f32 v8, v8
  v_mfma_f32_16x16x32_bf16 v[4:7], a[148:151], v[132:135], v[4:7]
  ds_read_b128 a[128:131], v212 offset:40960
  v_and_b32 v209, 3, v209
  v_mfma_f32_16x16x32_bf16 v[4:7], a[152:155], v[136:139], v[4:7]
  v_exp_f32 v9, v9
  v_mfma_f32_16x16x32_bf16 v[4:7], a[156:159], v[140:143], v[4:7]
  ds_read_b128 a[132:135], v213 offset:40960
  v_cvt_pk_bf16_f32 v8, v8, v9
  v_mfma_f32_16x16x32_bf16 v[12:15], a[156:159], v[156:159], v[196:199]
  v_exp_f32 v10, v10
  v_mfma_f32_16x16x32_bf16 v[12:15], a[152:155], v[152:155], v[12:15]
  ds_read_b128 a[136:139], v214 offset:40960
  v_lshlrev_b32 v209, 3, v209
  v_mfma_f32_16x16x32_bf16 v[12:15], a[148:151], v[148:151], v[12:15]
  v_exp_f32 v11, v11
  v_mfma_f32_16x16x32_bf16 v[12:15], a[144:147], v[144:147], v[12:15]
  ds_read_b128 a[140:143], v215 offset:40960
  v_cvt_pk_bf16_f32 v9, v10, v11
  v_mfma_f32_16x16x32_bf16 v[20:23], a[144:147], v[160:163], v[200:203]
  v_exp_f32 v16, v16
  v_mfma_f32_16x16x32_bf16 v[20:23], a[148:151], v[164:167], v[20:23]
  buffer_load_dwordx4 v237, s[16:19], s29 offen offset:3072 lds
  v_mfma_f32_16x16x32_bf16 v[20:23], a[152:155], v[168:171], v[20:23]
  s_add_u32 s29, s29, 16384
  v_exp_f32 v17, v17
  v_mfma_f32_16x16x32_bf16 v[20:23], a[156:159], v[172:175], v[20:23]
  v_cvt_pk_bf16_f32 v16, v16, v17
  v_lshl_add_u32 v209, v211, 5, v209
  v_mfma_f32_16x16x32_bf16 v[28:31], a[156:159], v[188:191], v[204:207]
  s_add_u32 m0, s28, 0
  v_exp_f32 v18, v18
  v_mfma_f32_16x16x32_bf16 v[28:31], a[152:155], v[184:187], v[28:31]
  buffer_load_dwordx4 v232, s[12:15], s29 offen offset:0 lds
  v_mfma_f32_16x16x32_bf16 v[28:31], a[148:151], v[180:183], v[28:31]
  s_waitcnt lgkmcnt(0)
  v_exp_f32 v19, v19
  v_mfma_f32_16x16x32_bf16 v[28:31], a[144:147], v[176:179], v[28:31]
  v_cvt_pk_bf16_f32 v17, v18, v19
  v_add_u32 v209, s50, v209
  v_mfma_f32_16x16x32_bf16 v[32:35], a[128:131], v[128:131], v[192:195]
  s_and_b32 s39, s2, 1
  s_lshl_b32 s39, s39, 2
  s_add_u32 s39, s39, s3
  v_exp_f32 v24, v24
  v_mfma_f32_16x16x32_bf16 v[32:35], a[132:135], v[132:135], v[32:35]
  ds_read_b128 a[144:147], v212 offset:45056
  s_lshr_b32 s31, s2, 1
  s_mul_i32 s30, s31, 40960
  s_mul_i32 s48, s39, 160
  v_mfma_f32_16x16x32_bf16 v[32:35], a[136:139], v[136:139], v[32:35]
  s_add_u32 s30, s30, s48
  s_mul_i32 s31, s31, 5120
  s_mul_i32 s39, s39, 655360
  v_exp_f32 v25, v25
  v_mfma_f32_16x16x32_bf16 v[32:35], a[140:143], v[140:143], v[32:35]
  ds_read_b128 a[148:151], v213 offset:45056
  s_add_u32 s31, s31, s39
  s_add_u32 s31, s31, 3145728
  s_lshr_b32 s39, s2, 3
  v_cvt_pk_bf16_f32 v24, v24, v25
  v_mfma_f32_16x16x32_bf16 v[40:43], a[140:143], v[156:159], v[196:199]
  s_min_u32 s39, s39, 29
  s_and_b32 s48, s2, 7
  s_mul_i32 s48, s48, 30
  v_exp_f32 v26, v26
  v_mfma_f32_16x16x32_bf16 v[40:43], a[136:139], v[152:155], v[40:43]
  ds_read_b128 a[152:155], v214 offset:45056
  s_add_u32 s39, s39, s48
  s_mul_i32 s98, s39, 1639
  s_lshr_b32 s98, s98, 16
  v_mfma_f32_16x16x32_bf16 v[40:43], a[132:135], v[148:151], v[40:43]
  s_mul_i32 s99, s98, 40
  s_sub_u32 s99, s39, s99
  s_min_u32 s39, s3, 2
  v_exp_f32 v27, v27
  v_mfma_f32_16x16x32_bf16 v[40:43], a[128:131], v[144:147], v[40:43]
  ds_read_b128 a[156:159], v215 offset:45056
  s_mul_i32 s48, s98, 3
  s_add_u32 s48, s48, s39
  s_mul_i32 s100, s48, 122880
  v_cvt_pk_bf16_f32 v25, v26, v27
  v_mfma_f32_16x16x32_bf16 v[48:51], a[128:131], v[160:163], v[200:203]
  s_lshl_b32 s39, s99, 5
  s_add_u32 s100, s100, s39
  s_mul_i32 s101, s48, 192
  v_exp_f32 v4, v4
  v_mfma_f32_16x16x32_bf16 v[48:51], a[132:135], v[164:167], v[48:51]
  buffer_load_dwordx4 v233, s[12:15], s29 offen offset:1024 lds
  s_add_u32 s101, s101, 2633728
  s_mov_b32 s51, s50
  v_mfma_f32_16x16x32_bf16 v[48:51], a[136:139], v[168:171], v[48:51]
  v_exp_f32 v5, v5
  v_mfma_f32_16x16x32_bf16 v[48:51], a[140:143], v[172:175], v[48:51]
  v_cvt_pk_bf16_f32 v2, v4, v5
  v_mov_b32 v211, v242
  v_mfma_f32_16x16x32_bf16 v[56:59], a[140:143], v[188:191], v[204:207]
  s_mov_b32 s4, s94
  s_mov_b32 s5, s95
  s_mov_b32 s6, 2211840
  v_exp_f32 v6, v6
  v_mfma_f32_16x16x32_bf16 v[56:59], a[136:139], v[184:187], v[56:59]
  buffer_load_dwordx4 v234, s[12:15], s29 offen offset:2048 lds
  s_mov_b32 s7, 0x20000
  s_getpc_b64 s[8:9]
attn_late_pc:
  s_add_u32 s8, s8, attn_h_ready-attn_late_pc
  s_addc_u32 s9, s9, 0
  v_mfma_f32_16x16x32_bf16 v[56:59], a[132:135], v[180:183], v[56:59]
  s_waitcnt lgkmcnt(0)
  s_lshr_b32 s39, s2, 3
  v_exp_f32 v7, v7
  v_mfma_f32_16x16x32_bf16 v[56:59], a[128:131], v[176:179], v[56:59]
  v_cvt_pk_bf16_f32 v3, v6, v7
  v_lshrrev_b32 v252, 4, v242
  v_mfma_f32_16x16x32_bf16 v[36:39], a[144:147], v[128:131], v[192:195]
  v_exp_f32 v12, v12
  v_mfma_f32_16x16x32_bf16 v[36:39], a[148:151], v[132:135], v[36:39]
  ds_read_b64_tr_b16 a[160:161], v216 offset:16384
  v_min_u32 v252, 11, v252
  v_mfma_f32_16x16x32_bf16 v[36:39], a[152:155], v[136:139], v[36:39]
  v_exp_f32 v13, v13
  v_mfma_f32_16x16x32_bf16 v[36:39], a[156:159], v[140:143], v[36:39]
  ds_read_b64_tr_b16 a[162:163], v216 offset:20480
  v_cvt_pk_bf16_f32 v10, v12, v13
  v_mfma_f32_16x16x32_bf16 v[44:47], a[156:159], v[156:159], v[196:199]
  v_exp_f32 v14, v14
  v_mfma_f32_16x16x32_bf16 v[44:47], a[152:155], v[152:155], v[44:47]
  ds_read_b64_tr_b16 a[164:165], v216 offset:24576
  buffer_load_dwordx4 v235, s[12:15], s29 offen offset:3072 lds
  v_mfma_f32_16x16x32_bf16 v[44:47], a[148:151], v[148:151], v[44:47]
  v_exp_f32 v15, v15
  v_mfma_f32_16x16x32_bf16 v[44:47], a[144:147], v[144:147], v[44:47]
  ds_read_b64_tr_b16 a[166:167], v216 offset:28672
  v_cvt_pk_bf16_f32 v11, v14, v15
  v_mfma_f32_16x16x32_bf16 v[52:55], a[144:147], v[160:163], v[200:203]
  v_exp_f32 v20, v20
  v_mfma_f32_16x16x32_bf16 v[52:55], a[148:151], v[164:167], v[52:55]
  ds_read_b64_tr_b16 a[168:169], v217 offset:16384
  v_lshlrev_b32 v252, 5, v252
  v_mfma_f32_16x16x32_bf16 v[52:55], a[152:155], v[168:171], v[52:55]
  v_exp_f32 v21, v21
  v_mfma_f32_16x16x32_bf16 v[52:55], a[156:159], v[172:175], v[52:55]
  ds_read_b64_tr_b16 a[170:171], v217 offset:20480
  v_cvt_pk_bf16_f32 v18, v20, v21
  v_mfma_f32_16x16x32_bf16 v[60:63], a[156:159], v[188:191], v[204:207]
  v_exp_f32 v22, v22
  v_mfma_f32_16x16x32_bf16 v[60:63], a[152:155], v[184:187], v[60:63]
  ds_read_b64_tr_b16 a[172:173], v217 offset:24576
  v_add_u32 v252, s39, v252
  v_mfma_f32_16x16x32_bf16 v[60:63], a[148:151], v[180:183], v[60:63]
  v_exp_f32 v23, v23
  v_mfma_f32_16x16x32_bf16 v[60:63], a[144:147], v[176:179], v[60:63]
  ds_read_b64_tr_b16 a[174:175], v217 offset:28672
  v_cvt_pk_bf16_f32 v19, v22, v23
  v_mfma_f32_16x16x32_bf16 a[192:195], a[208:211], v[64:67], a[192:195]
  v_exp_f32 v28, v28
  v_mfma_f32_16x16x32_bf16 a[192:195], a[208:211], v[96:99], a[192:195]
  ds_read_b64_tr_b16 a[176:177], v218 offset:16384
  v_lshlrev_b32 v252, 7, v252
  v_mfma_f32_16x16x32_bf16 a[196:199], a[208:211], v[72:75], a[196:199]
  v_exp_f32 v29, v29
  v_mfma_f32_16x16x32_bf16 a[196:199], a[208:211], v[104:107], a[196:199]
  ds_read_b64_tr_b16 a[178:179], v218 offset:20480
  v_cvt_pk_bf16_f32 v26, v28, v29
  v_mfma_f32_16x16x32_bf16 a[200:203], a[208:211], v[80:83], a[200:203]
  v_exp_f32 v30, v30
  v_mfma_f32_16x16x32_bf16 a[200:203], a[208:211], v[112:115], a[200:203]
  ds_read_b64_tr_b16 a[180:181], v218 offset:24576
  v_min_u32 v252, attn_end-attn_h_ready-4, v252
  v_mfma_f32_16x16x32_bf16 a[204:207], a[208:211], v[88:91], a[204:207]
  s_waitcnt lgkmcnt(7)
  v_exp_f32 v31, v31
  v_mfma_f32_16x16x32_bf16 a[204:207], a[208:211], v[120:123], a[204:207]
  ds_read_b64_tr_b16 a[182:183], v218 offset:28672
  v_cvt_pk_bf16_f32 v27, v30, v31
  v_mfma_f32_16x16x32_bf16 a[0:3], a[160:163], v[64:67], a[0:3]
  v_exp_f32 v32, v32
  v_mfma_f32_16x16x32_bf16 a[0:3], a[164:167], v[96:99], a[0:3]
  ds_read_b64_tr_b16 a[184:185], v219 offset:16384
  v_mfma_f32_16x16x32_bf16 a[4:7], a[164:167], v[104:107], a[4:7]
  v_exp_f32 v33, v33
  v_mfma_f32_16x16x32_bf16 a[4:7], a[160:163], v[72:75], a[4:7]
  ds_read_b64_tr_b16 a[186:187], v219 offset:20480
  v_cvt_pk_bf16_f32 v32, v32, v33
  v_mfma_f32_16x16x32_bf16 a[8:11], a[160:163], v[80:83], a[8:11]
  v_exp_f32 v34, v34
  v_mfma_f32_16x16x32_bf16 a[8:11], a[164:167], v[112:115], a[8:11]
  ds_read_b64_tr_b16 a[188:189], v219 offset:24576
  v_mfma_f32_16x16x32_bf16 a[12:15], a[164:167], v[120:123], a[12:15]
  s_waitcnt lgkmcnt(7)
  v_exp_f32 v35, v35
  v_mfma_f32_16x16x32_bf16 a[12:15], a[160:163], v[88:91], a[12:15]
  ds_read_b64_tr_b16 a[190:191], v219 offset:28672
  v_cvt_pk_bf16_f32 v33, v34, v35
  v_mfma_f32_16x16x32_bf16 a[16:19], a[168:171], v[64:67], a[16:19]
  v_exp_f32 v40, v40
  v_mfma_f32_16x16x32_bf16 a[16:19], a[172:175], v[96:99], a[16:19]
  ds_read_b64_tr_b16 a[160:161], v220 offset:16384
  v_mfma_f32_16x16x32_bf16 a[20:23], a[172:175], v[104:107], a[20:23]
  v_exp_f32 v41, v41
  v_mfma_f32_16x16x32_bf16 a[20:23], a[168:171], v[72:75], a[20:23]
  ds_read_b64_tr_b16 a[162:163], v220 offset:20480
  v_cvt_pk_bf16_f32 v40, v40, v41
  v_mfma_f32_16x16x32_bf16 a[24:27], a[168:171], v[80:83], a[24:27]
  v_exp_f32 v42, v42
  v_mfma_f32_16x16x32_bf16 a[24:27], a[172:175], v[112:115], a[24:27]
  ds_read_b64_tr_b16 a[164:165], v220 offset:24576
  v_mfma_f32_16x16x32_bf16 a[28:31], a[172:175], v[120:123], a[28:31]
  s_waitcnt lgkmcnt(7)
  v_exp_f32 v43, v43
  v_mfma_f32_16x16x32_bf16 a[28:31], a[168:171], v[88:91], a[28:31]
  ds_read_b64_tr_b16 a[166:167], v220 offset:28672
  v_cvt_pk_bf16_f32 v41, v42, v43
  v_mfma_f32_16x16x32_bf16 a[32:35], a[176:179], v[64:67], a[32:35]
  v_exp_f32 v48, v48
  v_mfma_f32_16x16x32_bf16 a[32:35], a[180:183], v[96:99], a[32:35]
  ds_read_b64_tr_b16 a[168:169], v221 offset:16384
  v_mfma_f32_16x16x32_bf16 a[36:39], a[180:183], v[104:107], a[36:39]
  v_exp_f32 v49, v49
  v_mfma_f32_16x16x32_bf16 a[36:39], a[176:179], v[72:75], a[36:39]
  ds_read_b64_tr_b16 a[170:171], v221 offset:20480
  v_cvt_pk_bf16_f32 v48, v48, v49
  v_mfma_f32_16x16x32_bf16 a[40:43], a[176:179], v[80:83], a[40:43]
  v_exp_f32 v50, v50
  v_mfma_f32_16x16x32_bf16 a[40:43], a[180:183], v[112:115], a[40:43]
  ds_read_b64_tr_b16 a[172:173], v221 offset:24576
  v_mfma_f32_16x16x32_bf16 a[44:47], a[180:183], v[120:123], a[44:47]
  s_waitcnt lgkmcnt(7)
  v_exp_f32 v51, v51
  v_mfma_f32_16x16x32_bf16 a[44:47], a[176:179], v[88:91], a[44:47]
  ds_read_b64_tr_b16 a[174:175], v221 offset:28672
  v_cvt_pk_bf16_f32 v49, v50, v51
  v_mfma_f32_16x16x32_bf16 a[48:51], a[184:187], v[64:67], a[48:51]
  v_exp_f32 v56, v56
  v_mfma_f32_16x16x32_bf16 a[48:51], a[188:191], v[96:99], a[48:51]
  ds_read_b64_tr_b16 a[176:177], v222 offset:16384
  v_mfma_f32_16x16x32_bf16 a[52:55], a[188:191], v[104:107], a[52:55]
  v_exp_f32 v57, v57
  v_mfma_f32_16x16x32_bf16 a[52:55], a[184:187], v[72:75], a[52:55]
  ds_read_b64_tr_b16 a[178:179], v222 offset:20480
  v_cvt_pk_bf16_f32 v56, v56, v57
  v_mfma_f32_16x16x32_bf16 a[56:59], a[184:187], v[80:83], a[56:59]
  v_exp_f32 v58, v58
  v_mfma_f32_16x16x32_bf16 a[56:59], a[188:191], v[112:115], a[56:59]
  ds_read_b64_tr_b16 a[180:181], v222 offset:24576
  v_mfma_f32_16x16x32_bf16 a[60:63], a[188:191], v[120:123], a[60:63]
  s_waitcnt lgkmcnt(7)
  v_exp_f32 v59, v59
  v_mfma_f32_16x16x32_bf16 a[60:63], a[184:187], v[88:91], a[60:63]
  ds_read_b64_tr_b16 a[182:183], v222 offset:28672
  v_cvt_pk_bf16_f32 v57, v58, v59
  v_mfma_f32_16x16x32_bf16 a[64:67], a[160:163], v[64:67], a[64:67]
  v_exp_f32 v36, v36
  v_mfma_f32_16x16x32_bf16 a[64:67], a[164:167], v[96:99], a[64:67]
  ds_read_b64_tr_b16 a[184:185], v223 offset:16384
  v_mfma_f32_16x16x32_bf16 a[68:71], a[164:167], v[104:107], a[68:71]
  v_exp_f32 v37, v37
  v_mfma_f32_16x16x32_bf16 a[68:71], a[160:163], v[72:75], a[68:71]
  ds_read_b64_tr_b16 a[186:187], v223 offset:20480
  v_cvt_pk_bf16_f32 v34, v36, v37
  v_mfma_f32_16x16x32_bf16 a[72:75], a[160:163], v[80:83], a[72:75]
  v_exp_f32 v38, v38
  v_mfma_f32_16x16x32_bf16 a[72:75], a[164:167], v[112:115], a[72:75]
  ds_read_b64_tr_b16 a[188:189], v223 offset:24576
  v_mfma_f32_16x16x32_bf16 a[76:79], a[164:167], v[120:123], a[76:79]
  s_waitcnt lgkmcnt(7)
  v_exp_f32 v39, v39
  v_mfma_f32_16x16x32_bf16 a[76:79], a[160:163], v[88:91], a[76:79]
  ds_read_b64_tr_b16 a[190:191], v223 offset:28672
  v_cvt_pk_bf16_f32 v35, v38, v39
  v_mfma_f32_16x16x32_bf16 a[80:83], a[168:171], v[64:67], a[80:83]
  s_waitcnt vmcnt(10)
  v_exp_f32 v44, v44
  v_mfma_f32_16x16x32_bf16 a[80:83], a[172:175], v[96:99], a[80:83]
  v_mfma_f32_16x16x32_bf16 a[84:87], a[172:175], v[104:107], a[84:87]
  s_barrier
  v_exp_f32 v45, v45
  v_mfma_f32_16x16x32_bf16 a[84:87], a[168:171], v[72:75], a[84:87]
  ds_read_b128 a[128:131], v212 offset:49152
  v_cvt_pk_bf16_f32 v42, v44, v45
  v_mfma_f32_16x16x32_bf16 a[88:91], a[168:171], v[80:83], a[88:91]
  v_exp_f32 v46, v46
  v_mfma_f32_16x16x32_bf16 a[88:91], a[172:175], v[112:115], a[88:91]
  ds_read_b128 a[132:135], v213 offset:49152
  v_mfma_f32_16x16x32_bf16 a[92:95], a[172:175], v[120:123], a[92:95]
  s_waitcnt lgkmcnt(6)
  v_exp_f32 v47, v47
  v_mfma_f32_16x16x32_bf16 a[92:95], a[168:171], v[88:91], a[92:95]
  ds_read_b128 a[136:139], v214 offset:49152
  v_cvt_pk_bf16_f32 v43, v46, v47
  v_mfma_f32_16x16x32_bf16 a[96:99], a[176:179], v[64:67], a[96:99]
  v_exp_f32 v52, v52
  v_mfma_f32_16x16x32_bf16 a[96:99], a[180:183], v[96:99], a[96:99]
  ds_read_b128 a[140:143], v215 offset:49152
  v_mfma_f32_16x16x32_bf16 a[100:103], a[180:183], v[104:107], a[100:103]
  v_exp_f32 v53, v53
  v_mfma_f32_16x16x32_bf16 a[100:103], a[176:179], v[72:75], a[100:103]
  v_cvt_pk_bf16_f32 v50, v52, v53
  v_mfma_f32_16x16x32_bf16 a[104:107], a[176:179], v[80:83], a[104:107]
  v_exp_f32 v54, v54
  v_mfma_f32_16x16x32_bf16 a[104:107], a[180:183], v[112:115], a[104:107]
  v_mfma_f32_16x16x32_bf16 a[108:111], a[180:183], v[120:123], a[108:111]
  s_waitcnt lgkmcnt(4)
  v_exp_f32 v55, v55
  v_mfma_f32_16x16x32_bf16 a[108:111], a[176:179], v[88:91], a[108:111]
  v_cvt_pk_bf16_f32 v51, v54, v55
  v_mfma_f32_16x16x32_bf16 a[112:115], a[184:187], v[64:67], a[112:115]
  v_exp_f32 v60, v60
  v_mfma_f32_16x16x32_bf16 a[112:115], a[188:191], v[96:99], a[112:115]
  v_mfma_f32_16x16x32_bf16 a[116:119], a[188:191], v[104:107], a[116:119]
  v_exp_f32 v61, v61
  v_mfma_f32_16x16x32_bf16 a[116:119], a[184:187], v[72:75], a[116:119]
  v_cvt_pk_bf16_f32 v58, v60, v61
  v_mfma_f32_16x16x32_bf16 a[120:123], a[184:187], v[80:83], a[120:123]
  v_exp_f32 v62, v62
  v_mfma_f32_16x16x32_bf16 a[120:123], a[188:191], v[112:115], a[120:123]
  v_mfma_f32_16x16x32_bf16 a[124:127], a[188:191], v[120:123], a[124:127]
  s_waitcnt lgkmcnt(0)
  v_exp_f32 v63, v63
  v_mfma_f32_16x16x32_bf16 a[124:127], a[184:187], v[88:91], a[124:127]
  v_cvt_pk_bf16_f32 v59, v62, v63
  v_mfma_f32_16x16x32_bf16 v[64:67], a[128:131], v[128:131], v[192:195]
  s_add_u32 m0, s28, 65536
  v_lshrrev_b32 v224, 4, v242
  v_lshrrev_b32 v225, 4, v224
  v_mfma_f32_16x16x32_bf16 v[64:67], a[132:135], v[132:135], v[64:67]
  ds_read_b128 a[144:147], v212 offset:53248
  v_bfe_u32 v226, v224, 2, 2
  v_mfma_f32_16x16x32_bf16 v[64:67], a[136:139], v[136:139], v[64:67]
  buffer_load_dwordx4 v236, s[16:19], s29 offen offset:0 lds
  v_mfma_f32_16x16x32_bf16 v[64:67], a[140:143], v[140:143], v[64:67]
  ds_read_b128 a[148:151], v213 offset:53248
  v_lshl_add_u32 v225, v225, 3, v226
  v_mfma_f32_16x16x32_bf16 v[72:75], a[140:143], v[156:159], v[196:199]
  v_lshlrev_b32 v225, 4, v225
  v_bfe_u32 v226, v224, 1, 1
  v_mfma_f32_16x16x32_bf16 v[72:75], a[136:139], v[152:155], v[72:75]
  ds_read_b128 a[152:155], v214 offset:53248
  v_mul_u32_u24 v226, 0xc00, v226
  v_mfma_f32_16x16x32_bf16 v[72:75], a[132:135], v[148:151], v[72:75]
  buffer_load_dwordx4 v237, s[16:19], s29 offen offset:1024 lds
  v_mfma_f32_16x16x32_bf16 v[72:75], a[128:131], v[144:147], v[72:75]
  ds_read_b128 a[156:159], v215 offset:53248
  v_add3_u32 v225, v225, v226, s50
  v_mfma_f32_16x16x32_bf16 v[80:83], a[128:131], v[160:163], v[200:203]
  v_exp_f32 v64, v64
  v_mfma_f32_16x16x32_bf16 v[80:83], a[132:135], v[164:167], v[80:83]
  v_and_b32 v226, 1, v224
  v_lshl_add_u32 v225, v226, 3, v225
  v_mfma_f32_16x16x32_bf16 v[80:83], a[136:139], v[168:171], v[80:83]
  s_waitcnt vmcnt(10)
  v_exp_f32 v65, v65
  v_mfma_f32_16x16x32_bf16 v[80:83], a[140:143], v[172:175], v[80:83]
  ds_read_b64_tr_b16 a[232:233], v225 offset:0
  v_cvt_pk_bf16_f32 v64, v64, v65
  v_mfma_f32_16x16x32_bf16 v[88:91], a[140:143], v[188:191], v[204:207]
  v_exp_f32 v66, v66
  v_mfma_f32_16x16x32_bf16 v[88:91], a[136:139], v[184:187], v[88:91]
  buffer_load_dwordx4 v236, s[16:19], s29 offen offset:2048 lds
  v_mfma_f32_16x16x32_bf16 v[88:91], a[132:135], v[180:183], v[88:91]
  s_waitcnt lgkmcnt(1)
  v_exp_f32 v67, v67
  v_mfma_f32_16x16x32_bf16 v[88:91], a[128:131], v[176:179], v[88:91]
  ds_read_b64_tr_b16 a[234:235], v225 offset:64
  v_cvt_pk_bf16_f32 v65, v66, v67
  v_mfma_f32_16x16x32_bf16 v[68:71], a[144:147], v[128:131], v[192:195]
  v_exp_f32 v72, v72
  v_mfma_f32_16x16x32_bf16 v[68:71], a[148:151], v[132:135], v[68:71]
  ds_read_b128 a[128:131], v212 offset:57344
  ds_read_b64_tr_b16 a[236:237], v225 offset:512
  v_mfma_f32_16x16x32_bf16 v[68:71], a[152:155], v[136:139], v[68:71]
  v_exp_f32 v73, v73
  v_mfma_f32_16x16x32_bf16 v[68:71], a[156:159], v[140:143], v[68:71]
  ds_read_b128 a[132:135], v213 offset:57344
  v_cvt_pk_bf16_f32 v72, v72, v73
  v_mfma_f32_16x16x32_bf16 v[76:79], a[156:159], v[156:159], v[196:199]
  v_exp_f32 v74, v74
  v_mfma_f32_16x16x32_bf16 v[76:79], a[152:155], v[152:155], v[76:79]
  ds_read_b128 a[136:139], v214 offset:57344
  ds_read_b64_tr_b16 a[238:239], v225 offset:576
  v_mfma_f32_16x16x32_bf16 v[76:79], a[148:151], v[148:151], v[76:79]
  v_exp_f32 v75, v75
  v_mfma_f32_16x16x32_bf16 v[76:79], a[144:147], v[144:147], v[76:79]
  ds_read_b128 a[140:143], v215 offset:57344
  v_cvt_pk_bf16_f32 v73, v74, v75
  v_mfma_f32_16x16x32_bf16 v[84:87], a[144:147], v[160:163], v[200:203]
  v_exp_f32 v80, v80
  v_mfma_f32_16x16x32_bf16 v[84:87], a[148:151], v[164:167], v[84:87]
  buffer_load_dwordx4 v237, s[16:19], s29 offen offset:3072 lds
  v_mfma_f32_16x16x32_bf16 v[84:87], a[152:155], v[168:171], v[84:87]
  s_add_u32 s29, s29, 16384
  v_exp_f32 v81, v81
  v_mfma_f32_16x16x32_bf16 v[84:87], a[156:159], v[172:175], v[84:87]
  ds_read_b64_tr_b16 a[240:241], v225 offset:1024
  v_cvt_pk_bf16_f32 v80, v80, v81
  v_mfma_f32_16x16x32_bf16 v[92:95], a[156:159], v[188:191], v[204:207]
  s_add_u32 m0, s28, 16384
  v_exp_f32 v82, v82
  v_mfma_f32_16x16x32_bf16 v[92:95], a[152:155], v[184:187], v[92:95]
  buffer_load_dwordx4 v232, s[12:15], s29 offen offset:0 lds
  v_mfma_f32_16x16x32_bf16 v[92:95], a[148:151], v[180:183], v[92:95]
  s_waitcnt lgkmcnt(1)
  v_exp_f32 v83, v83
  v_mfma_f32_16x16x32_bf16 v[92:95], a[144:147], v[176:179], v[92:95]
  ds_read_b64_tr_b16 a[242:243], v225 offset:1088
  v_cvt_pk_bf16_f32 v81, v82, v83
  v_mfma_f32_16x16x32_bf16 v[96:99], a[128:131], v[128:131], v[192:195]
  v_exp_f32 v88, v88
  v_mfma_f32_16x16x32_bf16 v[96:99], a[132:135], v[132:135], v[96:99]
  ds_read_b128 a[144:147], v212 offset:61440
  ds_read_b64_tr_b16 a[244:245], v225 offset:1536
  v_mfma_f32_16x16x32_bf16 v[96:99], a[136:139], v[136:139], v[96:99]
  v_exp_f32 v89, v89
  v_mfma_f32_16x16x32_bf16 v[96:99], a[140:143], v[140:143], v[96:99]
  ds_read_b128 a[148:151], v213 offset:61440
  v_cvt_pk_bf16_f32 v88, v88, v89
  v_mfma_f32_16x16x32_bf16 v[104:107], a[140:143], v[156:159], v[196:199]
  v_exp_f32 v90, v90
  v_mfma_f32_16x16x32_bf16 v[104:107], a[136:139], v[152:155], v[104:107]
  ds_read_b128 a[152:155], v214 offset:61440
  ds_read_b64_tr_b16 a[246:247], v225 offset:1600
  v_mfma_f32_16x16x32_bf16 v[104:107], a[132:135], v[148:151], v[104:107]
  v_exp_f32 v91, v91
  v_mfma_f32_16x16x32_bf16 v[104:107], a[128:131], v[144:147], v[104:107]
  ds_read_b128 a[156:159], v215 offset:61440
  v_cvt_pk_bf16_f32 v89, v90, v91
  v_mfma_f32_16x16x32_bf16 v[112:115], a[128:131], v[160:163], v[200:203]
  v_exp_f32 v68, v68
  v_mfma_f32_16x16x32_bf16 v[112:115], a[132:135], v[164:167], v[112:115]
  buffer_load_dwordx4 v233, s[12:15], s29 offen offset:1024 lds
  v_mfma_f32_16x16x32_bf16 v[112:115], a[136:139], v[168:171], v[112:115]
  v_exp_f32 v69, v69
  v_mfma_f32_16x16x32_bf16 v[112:115], a[140:143], v[172:175], v[112:115]
  ds_read_b64_tr_b16 a[248:249], v225 offset:2048
  v_cvt_pk_bf16_f32 v66, v68, v69
  v_mfma_f32_16x16x32_bf16 v[120:123], a[140:143], v[188:191], v[204:207]
  v_exp_f32 v70, v70
  v_mfma_f32_16x16x32_bf16 v[120:123], a[136:139], v[184:187], v[120:123]
  buffer_load_dwordx4 v234, s[12:15], s29 offen offset:2048 lds
  v_mfma_f32_16x16x32_bf16 v[120:123], a[132:135], v[180:183], v[120:123]
  s_waitcnt lgkmcnt(1)
  v_exp_f32 v71, v71
  v_mfma_f32_16x16x32_bf16 v[120:123], a[128:131], v[176:179], v[120:123]
  ds_read_b64_tr_b16 a[250:251], v225 offset:2112
  v_cvt_pk_bf16_f32 v67, v70, v71
  v_mfma_f32_16x16x32_bf16 v[100:103], a[144:147], v[128:131], v[192:195]
  v_exp_f32 v76, v76
  v_mfma_f32_16x16x32_bf16 v[100:103], a[148:151], v[132:135], v[100:103]
  ds_read_b64_tr_b16 a[160:161], v216 offset:32768
  v_mfma_f32_16x16x32_bf16 v[100:103], a[152:155], v[136:139], v[100:103]
  v_exp_f32 v77, v77
  v_mfma_f32_16x16x32_bf16 v[100:103], a[156:159], v[140:143], v[100:103]
  ds_read_b64_tr_b16 a[162:163], v216 offset:36864
  v_cvt_pk_bf16_f32 v74, v76, v77
  v_mfma_f32_16x16x32_bf16 v[108:111], a[156:159], v[156:159], v[196:199]
  v_exp_f32 v78, v78
  v_mfma_f32_16x16x32_bf16 v[108:111], a[152:155], v[152:155], v[108:111]
  ds_read_b64_tr_b16 a[164:165], v216 offset:40960
  buffer_load_dwordx4 v235, s[12:15], s29 offen offset:3072 lds
  v_mfma_f32_16x16x32_bf16 v[108:111], a[148:151], v[148:151], v[108:111]
  v_exp_f32 v79, v79
  v_mfma_f32_16x16x32_bf16 v[108:111], a[144:147], v[144:147], v[108:111]
  ds_read_b64_tr_b16 a[166:167], v216 offset:45056
  s_waitcnt lgkmcnt(4)
  v_cvt_pk_bf16_f32 v75, v78, v79
  v_mfma_f32_16x16x32_bf16 v[116:119], a[144:147], v[160:163], v[200:203]
  v_exp_f32 v84, v84
  v_mfma_f32_16x16x32_bf16 v[116:119], a[148:151], v[164:167], v[116:119]
  ds_read_b64_tr_b16 a[168:169], v217 offset:32768
  v_mfma_f32_16x16x32_bf16 v[228:231], a[232:235], a[212:215], 0
  v_mfma_f32_16x16x32_bf16 v[228:231], a[236:239], a[216:219], v[228:231]
  v_mfma_f32_16x16x32_bf16 v[228:231], a[240:243], a[220:223], v[228:231]
  v_mfma_f32_16x16x32_bf16 v[228:231], a[244:247], a[224:227], v[228:231]
  v_mfma_f32_16x16x32_bf16 v[228:231], a[248:251], a[228:231], v[228:231]
  v_mfma_f32_16x16x32_bf16 v[116:119], a[152:155], v[168:171], v[116:119]
  s_lshl_b32 s35, s3, 10
  s_add_u32 s35, s35, 159744
  v_exp_f32 v85, v85
  v_mfma_f32_16x16x32_bf16 v[116:119], a[156:159], v[172:175], v[116:119]
  ds_read_b64_tr_b16 a[170:171], v217 offset:36864
  v_cvt_pk_bf16_f32 v82, v84, v85
  v_mfma_f32_16x16x32_bf16 v[124:127], a[156:159], v[188:191], v[204:207]
  v_exp_f32 v86, v86
  v_mfma_f32_16x16x32_bf16 v[124:127], a[152:155], v[184:187], v[124:127]
  ds_read_b64_tr_b16 a[172:173], v217 offset:40960
  v_add_u32 v224, s35, v242
  v_mfma_f32_16x16x32_bf16 v[124:127], a[148:151], v[180:183], v[124:127]
  v_exp_f32 v87, v87
  v_mfma_f32_16x16x32_bf16 v[124:127], a[144:147], v[176:179], v[124:127]
  ds_read_b64_tr_b16 a[174:175], v217 offset:45056
  v_cvt_pk_bf16_f32 v83, v86, v87
  v_mfma_f32_16x16x32_bf16 a[192:195], a[208:211], v[0:3], a[192:195]
  v_exp_f32 v92, v92
  v_mfma_f32_16x16x32_bf16 a[192:195], a[208:211], v[32:35], a[192:195]
  ds_read_b64_tr_b16 a[176:177], v218 offset:32768
  ds_write_b128 v224, v[228:231]
  v_mfma_f32_16x16x32_bf16 a[196:199], a[208:211], v[8:11], a[196:199]
  v_exp_f32 v93, v93
  v_mfma_f32_16x16x32_bf16 a[196:199], a[208:211], v[40:43], a[196:199]
  ds_read_b64_tr_b16 a[178:179], v218 offset:36864
  v_cvt_pk_bf16_f32 v90, v92, v93
  v_mfma_f32_16x16x32_bf16 a[200:203], a[208:211], v[16:19], a[200:203]
  v_exp_f32 v94, v94
  v_mfma_f32_16x16x32_bf16 a[200:203], a[208:211], v[48:51], a[200:203]
  ds_read_b64_tr_b16 a[180:181], v218 offset:40960
  v_mfma_f32_16x16x32_bf16 a[204:207], a[208:211], v[24:27], a[204:207]
  s_waitcnt lgkmcnt(8)
  v_exp_f32 v95, v95
  v_mfma_f32_16x16x32_bf16 a[204:207], a[208:211], v[56:59], a[204:207]
  ds_read_b64_tr_b16 a[182:183], v218 offset:45056
  v_cvt_pk_bf16_f32 v91, v94, v95
  v_mfma_f32_16x16x32_bf16 a[0:3], a[160:163], v[0:3], a[0:3]
  v_exp_f32 v96, v96
  v_mfma_f32_16x16x32_bf16 a[0:3], a[164:167], v[32:35], a[0:3]
  ds_read_b64_tr_b16 a[184:185], v219 offset:32768
  s_waitcnt lgkmcnt(4)
  s_mov_b32 m0, s51
  v_mfma_f32_16x16x32_bf16 a[4:7], a[164:167], v[40:43], a[4:7]
  v_exp_f32 v97, v97
  v_mfma_f32_16x16x32_bf16 a[4:7], a[160:163], v[8:11], a[4:7]
  ds_read_b64_tr_b16 a[186:187], v219 offset:36864
  v_cvt_pk_bf16_f32 v96, v96, v97
  v_mfma_f32_16x16x32_bf16 a[8:11], a[160:163], v[16:19], a[8:11]
  v_exp_f32 v98, v98
  v_mfma_f32_16x16x32_bf16 a[8:11], a[164:167], v[48:51], a[8:11]
  ds_read_b64_tr_b16 a[188:189], v219 offset:40960
  buffer_load_dwordx4 v210, s[4:7], s100 offen lds
  s_add_u32 s100, s100, 20480
  s_add_u32 s51, s51, 512
  v_mfma_f32_16x16x32_bf16 a[12:15], a[164:167], v[56:59], a[12:15]
  v_exp_f32 v99, v99
  v_mfma_f32_16x16x32_bf16 a[12:15], a[160:163], v[24:27], a[12:15]
  ds_read_b64_tr_b16 a[190:191], v219 offset:45056
  v_cvt_pk_bf16_f32 v97, v98, v99
  v_mfma_f32_16x16x32_bf16 a[16:19], a[168:171], v[0:3], a[16:19]
  v_exp_f32 v104, v104
  v_mfma_f32_16x16x32_bf16 a[16:19], a[172:175], v[32:35], a[16:19]
  ds_read_b64_tr_b16 a[160:161], v220 offset:32768
  v_lshrrev_b32 v224, 4, v242
  v_mfma_f32_16x16x32_bf16 a[20:23], a[172:175], v[40:43], a[20:23]
  v_exp_f32 v105, v105
  v_mfma_f32_16x16x32_bf16 a[20:23], a[168:171], v[8:11], a[20:23]
  ds_read_b64_tr_b16 a[162:163], v220 offset:36864
  v_cvt_pk_bf16_f32 v104, v104, v105
  v_mfma_f32_16x16x32_bf16 a[24:27], a[168:171], v[16:19], a[24:27]
  v_exp_f32 v106, v106
  v_mfma_f32_16x16x32_bf16 a[24:27], a[172:175], v[48:51], a[24:27]
  ds_read_b64_tr_b16 a[164:165], v220 offset:40960
  v_bfe_u32 v225, v224, 2, 1
  v_mfma_f32_16x16x32_bf16 a[28:31], a[172:175], v[56:59], a[28:31]
  s_waitcnt lgkmcnt(7)
  v_exp_f32 v107, v107
  v_mfma_f32_16x16x32_bf16 a[28:31], a[168:171], v[24:27], a[28:31]
  ds_read_b64_tr_b16 a[166:167], v220 offset:45056
  v_cvt_pk_bf16_f32 v105, v106, v107
  v_mfma_f32_16x16x32_bf16 a[32:35], a[176:179], v[0:3], a[32:35]
  v_exp_f32 v112, v112
  v_mfma_f32_16x16x32_bf16 a[32:35], a[180:183], v[32:35], a[32:35]
  ds_read_b64_tr_b16 a[168:169], v221 offset:32768
  v_lshlrev_b32 v225, 8, v225
  v_mfma_f32_16x16x32_bf16 a[36:39], a[180:183], v[40:43], a[36:39]
  v_exp_f32 v113, v113
  v_mfma_f32_16x16x32_bf16 a[36:39], a[176:179], v[8:11], a[36:39]
  ds_read_b64_tr_b16 a[170:171], v221 offset:36864
  v_cvt_pk_bf16_f32 v112, v112, v113
  v_mfma_f32_16x16x32_bf16 a[40:43], a[176:179], v[16:19], a[40:43]
  v_exp_f32 v114, v114
  v_mfma_f32_16x16x32_bf16 a[40:43], a[180:183], v[48:51], a[40:43]
  ds_read_b64_tr_b16 a[172:173], v221 offset:40960
  v_lshrrev_b32 v226, 3, v224
  v_mfma_f32_16x16x32_bf16 a[44:47], a[180:183], v[56:59], a[44:47]
  s_waitcnt lgkmcnt(7)
  v_exp_f32 v115, v115
  v_mfma_f32_16x16x32_bf16 a[44:47], a[176:179], v[24:27], a[44:47]
  ds_read_b64_tr_b16 a[174:175], v221 offset:45056
  v_cvt_pk_bf16_f32 v113, v114, v115
  v_mfma_f32_16x16x32_bf16 a[48:51], a[184:187], v[0:3], a[48:51]
  v_exp_f32 v120, v120
  v_mfma_f32_16x16x32_bf16 a[48:51], a[188:191], v[32:35], a[48:51]
  ds_read_b64_tr_b16 a[176:177], v222 offset:32768
  v_lshl_add_u32 v225, v226, 4, v225
  v_mfma_f32_16x16x32_bf16 a[52:55], a[188:191], v[40:43], a[52:55]
  v_exp_f32 v121, v121
  v_mfma_f32_16x16x32_bf16 a[52:55], a[184:187], v[8:11], a[52:55]
  ds_read_b64_tr_b16 a[178:179], v222 offset:36864
  v_cvt_pk_bf16_f32 v120, v120, v121
  v_mfma_f32_16x16x32_bf16 a[56:59], a[184:187], v[16:19], a[56:59]
  v_exp_f32 v122, v122
  v_mfma_f32_16x16x32_bf16 a[56:59], a[188:191], v[48:51], a[56:59]
  ds_read_b64_tr_b16 a[180:181], v222 offset:40960
  v_and_b32 v227, 3, v224
  v_mfma_f32_16x16x32_bf16 a[60:63], a[188:191], v[56:59], a[60:63]
  s_waitcnt lgkmcnt(7)
  v_exp_f32 v123, v123
  v_mfma_f32_16x16x32_bf16 a[60:63], a[184:187], v[24:27], a[60:63]
  ds_read_b64_tr_b16 a[182:183], v222 offset:45056
  v_cvt_pk_bf16_f32 v121, v122, v123
  v_mfma_f32_16x16x32_bf16 a[64:67], a[160:163], v[0:3], a[64:67]
  v_exp_f32 v100, v100
  v_mfma_f32_16x16x32_bf16 a[64:67], a[164:167], v[32:35], a[64:67]
  ds_read_b64_tr_b16 a[184:185], v223 offset:32768
  v_lshl_add_u32 v225, v227, 2, v225
  v_mfma_f32_16x16x32_bf16 a[68:71], a[164:167], v[40:43], a[68:71]
  v_exp_f32 v101, v101
  v_mfma_f32_16x16x32_bf16 a[68:71], a[160:163], v[8:11], a[68:71]
  ds_read_b64_tr_b16 a[186:187], v223 offset:36864
  v_cvt_pk_bf16_f32 v98, v100, v101
  v_mfma_f32_16x16x32_bf16 a[72:75], a[160:163], v[16:19], a[72:75]
  v_exp_f32 v102, v102
  v_mfma_f32_16x16x32_bf16 a[72:75], a[164:167], v[48:51], a[72:75]
  ds_read_b64_tr_b16 a[188:189], v223 offset:40960
  v_add_u32 v225, 159744, v225
  v_mfma_f32_16x16x32_bf16 a[76:79], a[164:167], v[56:59], a[76:79]
  s_waitcnt lgkmcnt(7)
  v_exp_f32 v103, v103
  v_mfma_f32_16x16x32_bf16 a[76:79], a[160:163], v[24:27], a[76:79]
  ds_read_b64_tr_b16 a[190:191], v223 offset:45056
  v_cvt_pk_bf16_f32 v99, v102, v103
  v_mfma_f32_16x16x32_bf16 a[80:83], a[168:171], v[0:3], a[80:83]
  s_waitcnt vmcnt(9)
  v_exp_f32 v108, v108
  v_mfma_f32_16x16x32_bf16 a[80:83], a[172:175], v[32:35], a[80:83]
  v_mfma_f32_16x16x32_bf16 a[84:87], a[172:175], v[40:43], a[84:87]
  s_barrier
  v_exp_f32 v109, v109
  v_mfma_f32_16x16x32_bf16 a[84:87], a[168:171], v[8:11], a[84:87]
  ds_read_b128 a[128:131], v212 offset:0
  v_cvt_pk_bf16_f32 v106, v108, v109
  v_mfma_f32_16x16x32_bf16 a[88:91], a[168:171], v[16:19], a[88:91]
  v_exp_f32 v110, v110
  v_mfma_f32_16x16x32_bf16 a[88:91], a[172:175], v[48:51], a[88:91]
  ds_read_b128 a[132:135], v213 offset:0
  ds_read_b32 v228, v225 offset:0
  v_mfma_f32_16x16x32_bf16 a[92:95], a[172:175], v[56:59], a[92:95]
  s_waitcnt lgkmcnt(7)
  v_exp_f32 v111, v111
  v_mfma_f32_16x16x32_bf16 a[92:95], a[168:171], v[24:27], a[92:95]
  ds_read_b128 a[136:139], v214 offset:0
  v_cvt_pk_bf16_f32 v107, v110, v111
  v_mfma_f32_16x16x32_bf16 a[96:99], a[176:179], v[0:3], a[96:99]
  v_exp_f32 v116, v116
  v_mfma_f32_16x16x32_bf16 a[96:99], a[180:183], v[32:35], a[96:99]
  ds_read_b128 a[140:143], v215 offset:0
  ds_read_b32 v229, v225 offset:1024
  v_mfma_f32_16x16x32_bf16 a[100:103], a[180:183], v[40:43], a[100:103]
  v_exp_f32 v117, v117
  v_mfma_f32_16x16x32_bf16 a[100:103], a[176:179], v[8:11], a[100:103]
  ds_read_b32 v230, v225 offset:2048
  v_cvt_pk_bf16_f32 v114, v116, v117
  v_mfma_f32_16x16x32_bf16 a[104:107], a[176:179], v[16:19], a[104:107]
  v_exp_f32 v118, v118
  v_mfma_f32_16x16x32_bf16 a[104:107], a[180:183], v[48:51], a[104:107]
  ds_read_b32 v231, v225 offset:3072
  ds_read_b32 v238, v225 offset:512
  v_mfma_f32_16x16x32_bf16 a[108:111], a[180:183], v[56:59], a[108:111]
  s_waitcnt lgkmcnt(9)
  v_exp_f32 v119, v119
  v_mfma_f32_16x16x32_bf16 a[108:111], a[176:179], v[24:27], a[108:111]
  ds_read_b32 v239, v225 offset:1536
  v_cvt_pk_bf16_f32 v115, v118, v119
  v_mfma_f32_16x16x32_bf16 a[112:115], a[184:187], v[0:3], a[112:115]
  v_exp_f32 v124, v124
  v_mfma_f32_16x16x32_bf16 a[112:115], a[188:191], v[32:35], a[112:115]
  ds_read_b32 v240, v225 offset:2560
  ds_read_b32 v241, v225 offset:3584
  s_cmp_eq_u32 s3, 0
  s_cselect_b32 s35, 0, 1073741824
  v_mfma_f32_16x16x32_bf16 a[116:119], a[188:191], v[40:43], a[116:119]
  v_exp_f32 v125, v125
  v_mfma_f32_16x16x32_bf16 a[116:119], a[184:187], v[8:11], a[116:119]
  v_cvt_pk_bf16_f32 v122, v124, v125
  v_mul_u32_u24 v226, 0xd80, v226
  v_mfma_f32_16x16x32_bf16 a[120:123], a[184:187], v[16:19], a[120:123]
  v_exp_f32 v126, v126
  v_mfma_f32_16x16x32_bf16 a[120:123], a[188:191], v[48:51], a[120:123]
  v_and_b32 v227, 7, v224
  v_lshl_add_u32 v226, v227, 1, v226
  v_mfma_f32_16x16x32_bf16 a[124:127], a[188:191], v[56:59], a[124:127]
  s_waitcnt lgkmcnt(7)
  v_exp_f32 v127, v127
  v_mfma_f32_16x16x32_bf16 a[124:127], a[184:187], v[24:27], a[124:127]
  v_cvt_pk_bf16_f32 v123, v126, v127
  v_and_b32 v227, 1, v224
  v_lshl_add_u32 v226, v227, 30, v226
  v_or_b32 v226, s35, v226
  v_min_u32 v249, 1, v224
  v_lshlrev_b32 v249, 30, v249
  v_or_b32 v249, s35, v249
  v_mov_b32 v251, v249
  v_mov_b32 v250, 1
  s_mov_b32 s47, 2818048
  s_lshl_b32 s35, s33, 4
  s_add_u32 s35, s35, 2633728
  s_waitcnt lgkmcnt(0)
  v_add_f32 v228, v228, v229
  v_add_f32 v238, v238, v239
  v_add_f32 v230, v230, v231
  v_add_f32 v240, v240, v241
  v_add_f32 v228, v228, v230
  v_add_f32 v238, v238, v240
  v_cvt_pk_bf16_f32 v228, v228, v228
  v_cvt_pk_bf16_f32 v238, v238, v238
  v_lshlrev_b32 v228, 16, v228
  v_lshlrev_b32 v238, 16, v238
  v_mul_f32 v229, 0xbfb8aa3b, v228
  v_exp_f32 v229, v229
  s_nop 0
  v_add_f32 v229, 1.0, v229
  v_rcp_f32 v229, v229
  s_nop 0
  v_mul_f32 v228, v228, v229
  v_cvt_pk_bf16_f32 v228, v228, v228
  v_lshlrev_b32 v228, 16, v228
  v_mul_f32 v228, v228, v238
  s_nop 1
  v_mov_b32_dpp v229, v228 quad_perm:[1,0,3,2] row_mask:0xf bank_mask:0xf
  v_cvt_pk_bf16_f32 v228, v228, v229
  buffer_store_dword v228, v226, s[24:27], s35 offen sc1
  s_mov_b32 s32, 5
attn_loop:
  v_mfma_f32_16x16x32_bf16 v[0:3], a[128:131], v[128:131], v[192:195]
  s_add_u32 m0, s28, 81920
  v_mfma_f32_16x16x32_bf16 v[0:3], a[132:135], v[132:135], v[0:3]
  ds_read_b128 a[144:147], v212 offset:4096
  v_mfma_f32_16x16x32_bf16 v[0:3], a[136:139], v[136:139], v[0:3]
  buffer_load_dwordx4 v236, s[16:19], s29 offen offset:0 lds
  v_mfma_f32_16x16x32_bf16 v[0:3], a[140:143], v[140:143], v[0:3]
  ds_read_b128 a[148:151], v213 offset:4096
  v_mfma_f32_16x16x32_bf16 v[8:11], a[140:143], v[156:159], v[196:199]
  v_mfma_f32_16x16x32_bf16 v[8:11], a[136:139], v[152:155], v[8:11]
  ds_read_b128 a[152:155], v214 offset:4096
  v_mfma_f32_16x16x32_bf16 v[8:11], a[132:135], v[148:151], v[8:11]
  buffer_load_dwordx4 v237, s[16:19], s29 offen offset:1024 lds
  v_mfma_f32_16x16x32_bf16 v[8:11], a[128:131], v[144:147], v[8:11]
  ds_read_b128 a[156:159], v215 offset:4096
  v_mfma_f32_16x16x32_bf16 v[16:19], a[128:131], v[160:163], v[200:203]
  v_exp_f32 v0, v0
  v_mfma_f32_16x16x32_bf16 v[16:19], a[132:135], v[164:167], v[16:19]
  v_mfma_f32_16x16x32_bf16 v[16:19], a[136:139], v[168:171], v[16:19]
  v_exp_f32 v1, v1
  v_mfma_f32_16x16x32_bf16 v[16:19], a[140:143], v[172:175], v[16:19]
  v_cvt_pk_bf16_f32 v0, v0, v1
  v_mfma_f32_16x16x32_bf16 v[24:27], a[140:143], v[188:191], v[204:207]
  v_exp_f32 v2, v2
  v_mfma_f32_16x16x32_bf16 v[24:27], a[136:139], v[184:187], v[24:27]
  buffer_load_dwordx4 v236, s[16:19], s29 offen offset:2048 lds
  v_mfma_f32_16x16x32_bf16 v[24:27], a[132:135], v[180:183], v[24:27]
  s_waitcnt lgkmcnt(0)
  v_exp_f32 v3, v3
  v_mfma_f32_16x16x32_bf16 v[24:27], a[128:131], v[176:179], v[24:27]
  v_cvt_pk_bf16_f32 v1, v2, v3
  v_mfma_f32_16x16x32_bf16 v[4:7], a[144:147], v[128:131], v[192:195]
  v_exp_f32 v8, v8
  v_mfma_f32_16x16x32_bf16 v[4:7], a[148:151], v[132:135], v[4:7]
  ds_read_b128 a[128:131], v212 offset:8192
  v_mfma_f32_16x16x32_bf16 v[4:7], a[152:155], v[136:139], v[4:7]
  v_exp_f32 v9, v9
  v_mfma_f32_16x16x32_bf16 v[4:7], a[156:159], v[140:143], v[4:7]
  ds_read_b128 a[132:135], v213 offset:8192
  v_cvt_pk_bf16_f32 v8, v8, v9
  v_mfma_f32_16x16x32_bf16 v[12:15], a[156:159], v[156:159], v[196:199]
  v_exp_f32 v10, v10
  v_mfma_f32_16x16x32_bf16 v[12:15], a[152:155], v[152:155], v[12:15]
  ds_read_b128 a[136:139], v214 offset:8192
  v_mfma_f32_16x16x32_bf16 v[12:15], a[148:151], v[148:151], v[12:15]
  v_exp_f32 v11, v11
  v_mfma_f32_16x16x32_bf16 v[12:15], a[144:147], v[144:147], v[12:15]
  ds_read_b128 a[140:143], v215 offset:8192
  v_cvt_pk_bf16_f32 v9, v10, v11
  v_mfma_f32_16x16x32_bf16 v[20:23], a[144:147], v[160:163], v[200:203]
  v_exp_f32 v16, v16
  v_mfma_f32_16x16x32_bf16 v[20:23], a[148:151], v[164:167], v[20:23]
  buffer_load_dwordx4 v237, s[16:19], s29 offen offset:3072 lds
  v_mfma_f32_16x16x32_bf16 v[20:23], a[152:155], v[168:171], v[20:23]
  s_add_u32 s29, s29, 16384
  v_exp_f32 v17, v17
  v_mfma_f32_16x16x32_bf16 v[20:23], a[156:159], v[172:175], v[20:23]
  v_cvt_pk_bf16_f32 v16, v16, v17
  v_mfma_f32_16x16x32_bf16 v[28:31], a[156:159], v[188:191], v[204:207]
  s_add_u32 m0, s28, 32768
  v_exp_f32 v18, v18
  v_mfma_f32_16x16x32_bf16 v[28:31], a[152:155], v[184:187], v[28:31]
  buffer_load_dwordx4 v232, s[12:15], s29 offen offset:0 lds
  v_mfma_f32_16x16x32_bf16 v[28:31], a[148:151], v[180:183], v[28:31]
  s_waitcnt lgkmcnt(0)
  v_exp_f32 v19, v19
  v_mfma_f32_16x16x32_bf16 v[28:31], a[144:147], v[176:179], v[28:31]
  v_cvt_pk_bf16_f32 v17, v18, v19
  v_mfma_f32_16x16x32_bf16 v[32:35], a[128:131], v[128:131], v[192:195]
  v_exp_f32 v24, v24
  v_mfma_f32_16x16x32_bf16 v[32:35], a[132:135], v[132:135], v[32:35]
  ds_read_b128 a[144:147], v212 offset:12288
  v_mfma_f32_16x16x32_bf16 v[32:35], a[136:139], v[136:139], v[32:35]
  v_exp_f32 v25, v25
  v_mfma_f32_16x16x32_bf16 v[32:35], a[140:143], v[140:143], v[32:35]
  ds_read_b128 a[148:151], v213 offset:12288
  v_cvt_pk_bf16_f32 v24, v24, v25
  v_mfma_f32_16x16x32_bf16 v[40:43], a[140:143], v[156:159], v[196:199]
  v_exp_f32 v26, v26
  v_mfma_f32_16x16x32_bf16 v[40:43], a[136:139], v[152:155], v[40:43]
  ds_read_b128 a[152:155], v214 offset:12288
  v_mfma_f32_16x16x32_bf16 v[40:43], a[132:135], v[148:151], v[40:43]
  v_exp_f32 v27, v27
  v_mfma_f32_16x16x32_bf16 v[40:43], a[128:131], v[144:147], v[40:43]
  ds_read_b128 a[156:159], v215 offset:12288
  v_cvt_pk_bf16_f32 v25, v26, v27
  v_mfma_f32_16x16x32_bf16 v[48:51], a[128:131], v[160:163], v[200:203]
  v_exp_f32 v4, v4
  v_mfma_f32_16x16x32_bf16 v[48:51], a[132:135], v[164:167], v[48:51]
  buffer_load_dwordx4 v233, s[12:15], s29 offen offset:1024 lds
  v_mfma_f32_16x16x32_bf16 v[48:51], a[136:139], v[168:171], v[48:51]
  v_exp_f32 v5, v5
  v_mfma_f32_16x16x32_bf16 v[48:51], a[140:143], v[172:175], v[48:51]
  v_cvt_pk_bf16_f32 v2, v4, v5
  v_mfma_f32_16x16x32_bf16 v[56:59], a[140:143], v[188:191], v[204:207]
  v_exp_f32 v6, v6
  v_mfma_f32_16x16x32_bf16 v[56:59], a[136:139], v[184:187], v[56:59]
  buffer_load_dwordx4 v234, s[12:15], s29 offen offset:2048 lds
  v_mfma_f32_16x16x32_bf16 v[56:59], a[132:135], v[180:183], v[56:59]
  s_waitcnt lgkmcnt(0)
  v_exp_f32 v7, v7
  v_mfma_f32_16x16x32_bf16 v[56:59], a[128:131], v[176:179], v[56:59]
  v_cvt_pk_bf16_f32 v3, v6, v7
  v_mfma_f32_16x16x32_bf16 v[36:39], a[144:147], v[128:131], v[192:195]
  v_exp_f32 v12, v12
  v_mfma_f32_16x16x32_bf16 v[36:39], a[148:151], v[132:135], v[36:39]
  ds_read_b64_tr_b16 a[160:161], v216 offset:49152
  v_mfma_f32_16x16x32_bf16 v[36:39], a[152:155], v[136:139], v[36:39]
  v_exp_f32 v13, v13
  v_mfma_f32_16x16x32_bf16 v[36:39], a[156:159], v[140:143], v[36:39]
  ds_read_b64_tr_b16 a[162:163], v216 offset:53248
  v_cvt_pk_bf16_f32 v10, v12, v13
  v_mfma_f32_16x16x32_bf16 v[44:47], a[156:159], v[156:159], v[196:199]
  v_exp_f32 v14, v14
  v_mfma_f32_16x16x32_bf16 v[44:47], a[152:155], v[152:155], v[44:47]
  ds_read_b64_tr_b16 a[164:165], v216 offset:57344
  buffer_load_dwordx4 v235, s[12:15], s29 offen offset:3072 lds
  v_mfma_f32_16x16x32_bf16 v[44:47], a[148:151], v[148:151], v[44:47]
  v_exp_f32 v15, v15
  v_mfma_f32_16x16x32_bf16 v[44:47], a[144:147], v[144:147], v[44:47]
  ds_read_b64_tr_b16 a[166:167], v216 offset:61440
  v_cvt_pk_bf16_f32 v11, v14, v15
  v_mfma_f32_16x16x32_bf16 v[52:55], a[144:147], v[160:163], v[200:203]
  s_add_u32 m0, s50, 4096
  v_exp_f32 v20, v20
  v_mfma_f32_16x16x32_bf16 v[52:55], a[148:151], v[164:167], v[52:55]
  ds_read_b64_tr_b16 a[168:169], v217 offset:49152
  buffer_load_dwordx4 v208, s[20:23], s30 offen lds
  s_add_u32 s30, s30, 32
  v_mfma_f32_16x16x32_bf16 v[52:55], a[152:155], v[168:171], v[52:55]
  v_exp_f32 v21, v21
  v_mfma_f32_16x16x32_bf16 v[52:55], a[156:159], v[172:175], v[52:55]
  ds_read_b64_tr_b16 a[170:171], v217 offset:53248
  v_cvt_pk_bf16_f32 v18, v20, v21
  v_mfma_f32_16x16x32_bf16 v[60:63], a[156:159], v[188:191], v[204:207]
  v_exp_f32 v22, v22
  v_mfma_f32_16x16x32_bf16 v[60:63], a[152:155], v[184:187], v[60:63]
  ds_read_b64_tr_b16 a[172:173], v217 offset:57344
  v_mfma_f32_16x16x32_bf16 v[60:63], a[148:151], v[180:183], v[60:63]
  v_exp_f32 v23, v23
  v_mfma_f32_16x16x32_bf16 v[60:63], a[144:147], v[176:179], v[60:63]
  ds_read_b64_tr_b16 a[174:175], v217 offset:61440
  v_cvt_pk_bf16_f32 v19, v22, v23
  v_mfma_f32_16x16x32_bf16 a[192:195], a[208:211], v[64:67], a[192:195]
  v_exp_f32 v28, v28
  v_mfma_f32_16x16x32_bf16 a[192:195], a[208:211], v[96:99], a[192:195]
  ds_read_b64_tr_b16 a[176:177], v218 offset:49152
  v_mfma_f32_16x16x32_bf16 a[196:199], a[208:211], v[72:75], a[196:199]
  v_exp_f32 v29, v29
  v_mfma_f32_16x16x32_bf16 a[196:199], a[208:211], v[104:107], a[196:199]
  ds_read_b64_tr_b16 a[178:179], v218 offset:53248
  v_cvt_pk_bf16_f32 v26, v28, v29
  v_mfma_f32_16x16x32_bf16 a[200:203], a[208:211], v[80:83], a[200:203]
  v_exp_f32 v30, v30
  v_mfma_f32_16x16x32_bf16 a[200:203], a[208:211], v[112:115], a[200:203]
  ds_read_b64_tr_b16 a[180:181], v218 offset:57344
  v_mfma_f32_16x16x32_bf16 a[204:207], a[208:211], v[88:91], a[204:207]
  s_waitcnt lgkmcnt(7)
  v_exp_f32 v31, v31
  v_mfma_f32_16x16x32_bf16 a[204:207], a[208:211], v[120:123], a[204:207]
  ds_read_b64_tr_b16 a[182:183], v218 offset:61440
  v_cvt_pk_bf16_f32 v27, v30, v31
  v_mfma_f32_16x16x32_bf16 a[0:3], a[160:163], v[64:67], a[0:3]
  v_exp_f32 v32, v32
  v_mfma_f32_16x16x32_bf16 a[0:3], a[164:167], v[96:99], a[0:3]
  ds_read_b64_tr_b16 a[184:185], v219 offset:49152
  v_mfma_f32_16x16x32_bf16 a[4:7], a[164:167], v[104:107], a[4:7]
  v_exp_f32 v33, v33
  v_mfma_f32_16x16x32_bf16 a[4:7], a[160:163], v[72:75], a[4:7]
  ds_read_b64_tr_b16 a[186:187], v219 offset:53248
  v_cvt_pk_bf16_f32 v32, v32, v33
  v_mfma_f32_16x16x32_bf16 a[8:11], a[160:163], v[80:83], a[8:11]
  v_exp_f32 v34, v34
  v_mfma_f32_16x16x32_bf16 a[8:11], a[164:167], v[112:115], a[8:11]
  ds_read_b64_tr_b16 a[188:189], v219 offset:57344
  v_mfma_f32_16x16x32_bf16 a[12:15], a[164:167], v[120:123], a[12:15]
  s_waitcnt lgkmcnt(7)
  v_exp_f32 v35, v35
  v_mfma_f32_16x16x32_bf16 a[12:15], a[160:163], v[88:91], a[12:15]
  ds_read_b64_tr_b16 a[190:191], v219 offset:61440
  v_cvt_pk_bf16_f32 v33, v34, v35
  v_mfma_f32_16x16x32_bf16 a[16:19], a[168:171], v[64:67], a[16:19]
  v_exp_f32 v40, v40
  v_mfma_f32_16x16x32_bf16 a[16:19], a[172:175], v[96:99], a[16:19]
  ds_read_b64_tr_b16 a[160:161], v220 offset:49152
  v_mfma_f32_16x16x32_bf16 a[20:23], a[172:175], v[104:107], a[20:23]
  v_exp_f32 v41, v41
  v_mfma_f32_16x16x32_bf16 a[20:23], a[168:171], v[72:75], a[20:23]
  ds_read_b64_tr_b16 a[162:163], v220 offset:53248
  v_cvt_pk_bf16_f32 v40, v40, v41
  v_mfma_f32_16x16x32_bf16 a[24:27], a[168:171], v[80:83], a[24:27]
  v_exp_f32 v42, v42
  v_mfma_f32_16x16x32_bf16 a[24:27], a[172:175], v[112:115], a[24:27]
  ds_read_b64_tr_b16 a[164:165], v220 offset:57344
  v_mfma_f32_16x16x32_bf16 a[28:31], a[172:175], v[120:123], a[28:31]
  s_waitcnt lgkmcnt(7)
  v_exp_f32 v43, v43
  v_mfma_f32_16x16x32_bf16 a[28:31], a[168:171], v[88:91], a[28:31]
  ds_read_b64_tr_b16 a[166:167], v220 offset:61440
  v_cvt_pk_bf16_f32 v41, v42, v43
  v_mfma_f32_16x16x32_bf16 a[32:35], a[176:179], v[64:67], a[32:35]
  v_exp_f32 v48, v48
  v_mfma_f32_16x16x32_bf16 a[32:35], a[180:183], v[96:99], a[32:35]
  ds_read_b64_tr_b16 a[168:169], v221 offset:49152
  v_mfma_f32_16x16x32_bf16 a[36:39], a[180:183], v[104:107], a[36:39]
  v_exp_f32 v49, v49
  v_mfma_f32_16x16x32_bf16 a[36:39], a[176:179], v[72:75], a[36:39]
  ds_read_b64_tr_b16 a[170:171], v221 offset:53248
  v_cvt_pk_bf16_f32 v48, v48, v49
  v_mfma_f32_16x16x32_bf16 a[40:43], a[176:179], v[80:83], a[40:43]
  v_exp_f32 v50, v50
  v_mfma_f32_16x16x32_bf16 a[40:43], a[180:183], v[112:115], a[40:43]
  ds_read_b64_tr_b16 a[172:173], v221 offset:57344
  v_mfma_f32_16x16x32_bf16 a[44:47], a[180:183], v[120:123], a[44:47]
  s_waitcnt lgkmcnt(7)
  v_exp_f32 v51, v51
  v_mfma_f32_16x16x32_bf16 a[44:47], a[176:179], v[88:91], a[44:47]
  ds_read_b64_tr_b16 a[174:175], v221 offset:61440
  v_cvt_pk_bf16_f32 v49, v50, v51
  v_mfma_f32_16x16x32_bf16 a[48:51], a[184:187], v[64:67], a[48:51]
  v_exp_f32 v56, v56
  v_mfma_f32_16x16x32_bf16 a[48:51], a[188:191], v[96:99], a[48:51]
  ds_read_b64_tr_b16 a[176:177], v222 offset:49152
  v_mfma_f32_16x16x32_bf16 a[52:55], a[188:191], v[104:107], a[52:55]
  v_exp_f32 v57, v57
  v_mfma_f32_16x16x32_bf16 a[52:55], a[184:187], v[72:75], a[52:55]
  ds_read_b64_tr_b16 a[178:179], v222 offset:53248
  v_cvt_pk_bf16_f32 v56, v56, v57
  v_mfma_f32_16x16x32_bf16 a[56:59], a[184:187], v[80:83], a[56:59]
  v_exp_f32 v58, v58
  v_mfma_f32_16x16x32_bf16 a[56:59], a[188:191], v[112:115], a[56:59]
  ds_read_b64_tr_b16 a[180:181], v222 offset:57344
  global_load_dword v255, v252, s[8:9]
  v_mfma_f32_16x16x32_bf16 a[60:63], a[188:191], v[120:123], a[60:63]
  s_waitcnt lgkmcnt(7)
  v_exp_f32 v59, v59
  v_mfma_f32_16x16x32_bf16 a[60:63], a[184:187], v[88:91], a[60:63]
  ds_read_b64_tr_b16 a[182:183], v222 offset:61440
  v_cvt_pk_bf16_f32 v57, v58, v59
  v_mfma_f32_16x16x32_bf16 a[64:67], a[160:163], v[64:67], a[64:67]
  v_exp_f32 v36, v36
  v_mfma_f32_16x16x32_bf16 a[64:67], a[164:167], v[96:99], a[64:67]
  ds_read_b64_tr_b16 a[184:185], v223 offset:49152
  v_mfma_f32_16x16x32_bf16 a[68:71], a[164:167], v[104:107], a[68:71]
  v_exp_f32 v37, v37
  v_mfma_f32_16x16x32_bf16 a[68:71], a[160:163], v[72:75], a[68:71]
  ds_read_b64_tr_b16 a[186:187], v223 offset:53248
  v_cvt_pk_bf16_f32 v34, v36, v37
  v_mfma_f32_16x16x32_bf16 a[72:75], a[160:163], v[80:83], a[72:75]
  v_exp_f32 v38, v38
  v_mfma_f32_16x16x32_bf16 a[72:75], a[164:167], v[112:115], a[72:75]
  ds_read_b64_tr_b16 a[188:189], v223 offset:57344
  v_mfma_f32_16x16x32_bf16 a[76:79], a[164:167], v[120:123], a[76:79]
  s_waitcnt lgkmcnt(7)
  v_exp_f32 v39, v39
  v_mfma_f32_16x16x32_bf16 a[76:79], a[160:163], v[88:91], a[76:79]
  ds_read_b64_tr_b16 a[190:191], v223 offset:61440
  v_cvt_pk_bf16_f32 v35, v38, v39
  v_mfma_f32_16x16x32_bf16 a[80:83], a[168:171], v[64:67], a[80:83]
  s_waitcnt vmcnt(12)
  v_exp_f32 v44, v44
  v_mfma_f32_16x16x32_bf16 a[80:83], a[172:175], v[96:99], a[80:83]
  v_mfma_f32_16x16x32_bf16 a[84:87], a[172:175], v[104:107], a[84:87]
  s_barrier
  v_exp_f32 v45, v45
  v_mfma_f32_16x16x32_bf16 a[84:87], a[168:171], v[72:75], a[84:87]
  ds_read_b128 a[128:131], v212 offset:16384
  v_cvt_pk_bf16_f32 v42, v44, v45
  v_mfma_f32_16x16x32_bf16 a[88:91], a[168:171], v[80:83], a[88:91]
  v_exp_f32 v46, v46
  v_mfma_f32_16x16x32_bf16 a[88:91], a[172:175], v[112:115], a[88:91]
  ds_read_b128 a[132:135], v213 offset:16384
  v_mfma_f32_16x16x32_bf16 a[92:95], a[172:175], v[120:123], a[92:95]
  s_waitcnt lgkmcnt(6)
  v_exp_f32 v47, v47
  v_mfma_f32_16x16x32_bf16 a[92:95], a[168:171], v[88:91], a[92:95]
  ds_read_b128 a[136:139], v214 offset:16384
  v_cvt_pk_bf16_f32 v43, v46, v47
  v_mfma_f32_16x16x32_bf16 a[96:99], a[176:179], v[64:67], a[96:99]
  v_exp_f32 v52, v52
  v_mfma_f32_16x16x32_bf16 a[96:99], a[180:183], v[96:99], a[96:99]
  ds_read_b128 a[140:143], v215 offset:16384
  v_mfma_f32_16x16x32_bf16 a[100:103], a[180:183], v[104:107], a[100:103]
  v_exp_f32 v53, v53
  v_mfma_f32_16x16x32_bf16 a[100:103], a[176:179], v[72:75], a[100:103]
  v_cvt_pk_bf16_f32 v50, v52, v53
  v_mfma_f32_16x16x32_bf16 a[104:107], a[176:179], v[80:83], a[104:107]
  v_exp_f32 v54, v54
  v_mfma_f32_16x16x32_bf16 a[104:107], a[180:183], v[112:115], a[104:107]
  v_mfma_f32_16x16x32_bf16 a[108:111], a[180:183], v[120:123], a[108:111]
  s_waitcnt lgkmcnt(4)
  v_exp_f32 v55, v55
  v_mfma_f32_16x16x32_bf16 a[108:111], a[176:179], v[88:91], a[108:111]
  v_cvt_pk_bf16_f32 v51, v54, v55
  v_mfma_f32_16x16x32_bf16 a[112:115], a[184:187], v[64:67], a[112:115]
  v_exp_f32 v60, v60
  v_mfma_f32_16x16x32_bf16 a[112:115], a[188:191], v[96:99], a[112:115]
  v_mfma_f32_16x16x32_bf16 a[116:119], a[188:191], v[104:107], a[116:119]
  v_exp_f32 v61, v61
  v_mfma_f32_16x16x32_bf16 a[116:119], a[184:187], v[72:75], a[116:119]
  v_cvt_pk_bf16_f32 v58, v60, v61
  v_mfma_f32_16x16x32_bf16 a[120:123], a[184:187], v[80:83], a[120:123]
  v_exp_f32 v62, v62
  v_mfma_f32_16x16x32_bf16 a[120:123], a[188:191], v[112:115], a[120:123]
  v_mfma_f32_16x16x32_bf16 a[124:127], a[188:191], v[120:123], a[124:127]
  s_waitcnt lgkmcnt(0)
  v_exp_f32 v63, v63
  v_mfma_f32_16x16x32_bf16 a[124:127], a[184:187], v[88:91], a[124:127]
  v_cvt_pk_bf16_f32 v59, v62, v63
  v_mfma_f32_16x16x32_bf16 v[64:67], a[128:131], v[128:131], v[192:195]
  s_add_u32 m0, s28, 98304
  v_mfma_f32_16x16x32_bf16 v[64:67], a[132:135], v[132:135], v[64:67]
  ds_read_b128 a[144:147], v212 offset:20480
  v_mfma_f32_16x16x32_bf16 v[64:67], a[136:139], v[136:139], v[64:67]
  buffer_load_dwordx4 v236, s[16:19], s29 offen offset:0 lds
  v_mfma_f32_16x16x32_bf16 v[64:67], a[140:143], v[140:143], v[64:67]
  ds_read_b128 a[148:151], v213 offset:20480
  v_mfma_f32_16x16x32_bf16 v[72:75], a[140:143], v[156:159], v[196:199]
  v_mfma_f32_16x16x32_bf16 v[72:75], a[136:139], v[152:155], v[72:75]
  ds_read_b128 a[152:155], v214 offset:20480
  v_mfma_f32_16x16x32_bf16 v[72:75], a[132:135], v[148:151], v[72:75]
  buffer_load_dwordx4 v237, s[16:19], s29 offen offset:1024 lds
  v_mfma_f32_16x16x32_bf16 v[72:75], a[128:131], v[144:147], v[72:75]
  ds_read_b128 a[156:159], v215 offset:20480
  v_mfma_f32_16x16x32_bf16 v[80:83], a[128:131], v[160:163], v[200:203]
  v_exp_f32 v64, v64
  v_mfma_f32_16x16x32_bf16 v[80:83], a[132:135], v[164:167], v[80:83]
  v_mfma_f32_16x16x32_bf16 v[80:83], a[136:139], v[168:171], v[80:83]
  v_exp_f32 v65, v65
  v_mfma_f32_16x16x32_bf16 v[80:83], a[140:143], v[172:175], v[80:83]
  v_cvt_pk_bf16_f32 v64, v64, v65
  v_mfma_f32_16x16x32_bf16 v[88:91], a[140:143], v[188:191], v[204:207]
  v_exp_f32 v66, v66
  v_mfma_f32_16x16x32_bf16 v[88:91], a[136:139], v[184:187], v[88:91]
  buffer_load_dwordx4 v236, s[16:19], s29 offen offset:2048 lds
  v_mfma_f32_16x16x32_bf16 v[88:91], a[132:135], v[180:183], v[88:91]
  s_waitcnt lgkmcnt(0)
  v_exp_f32 v67, v67
  v_mfma_f32_16x16x32_bf16 v[88:91], a[128:131], v[176:179], v[88:91]
  v_cvt_pk_bf16_f32 v65, v66, v67
  v_mfma_f32_16x16x32_bf16 v[68:71], a[144:147], v[128:131], v[192:195]
  v_exp_f32 v72, v72
  v_mfma_f32_16x16x32_bf16 v[68:71], a[148:151], v[132:135], v[68:71]
  ds_read_b128 a[128:131], v212 offset:24576
  v_mfma_f32_16x16x32_bf16 v[68:71], a[152:155], v[136:139], v[68:71]
  v_exp_f32 v73, v73
  v_mfma_f32_16x16x32_bf16 v[68:71], a[156:159], v[140:143], v[68:71]
  ds_read_b128 a[132:135], v213 offset:24576
  v_cvt_pk_bf16_f32 v72, v72, v73
  v_mfma_f32_16x16x32_bf16 v[76:79], a[156:159], v[156:159], v[196:199]
  v_exp_f32 v74, v74
  v_mfma_f32_16x16x32_bf16 v[76:79], a[152:155], v[152:155], v[76:79]
  ds_read_b128 a[136:139], v214 offset:24576
  v_mfma_f32_16x16x32_bf16 v[76:79], a[148:151], v[148:151], v[76:79]
  v_exp_f32 v75, v75
  v_mfma_f32_16x16x32_bf16 v[76:79], a[144:147], v[144:147], v[76:79]
  ds_read_b128 a[140:143], v215 offset:24576
  v_cvt_pk_bf16_f32 v73, v74, v75
  v_mfma_f32_16x16x32_bf16 v[84:87], a[144:147], v[160:163], v[200:203]
  v_exp_f32 v80, v80
  v_mfma_f32_16x16x32_bf16 v[84:87], a[148:151], v[164:167], v[84:87]
  buffer_load_dwordx4 v237, s[16:19], s29 offen offset:3072 lds
  v_mfma_f32_16x16x32_bf16 v[84:87], a[152:155], v[168:171], v[84:87]
  s_add_u32 s29, s29, 16384
  v_exp_f32 v81, v81
  v_mfma_f32_16x16x32_bf16 v[84:87], a[156:159], v[172:175], v[84:87]
  v_cvt_pk_bf16_f32 v80, v80, v81
  v_mfma_f32_16x16x32_bf16 v[92:95], a[156:159], v[188:191], v[204:207]
  s_add_u32 m0, s28, 49152
  v_exp_f32 v82, v82
  v_mfma_f32_16x16x32_bf16 v[92:95], a[152:155], v[184:187], v[92:95]
  buffer_load_dwordx4 v232, s[12:15], s29 offen offset:0 lds
  v_mfma_f32_16x16x32_bf16 v[92:95], a[148:151], v[180:183], v[92:95]
  s_waitcnt lgkmcnt(0)
  v_exp_f32 v83, v83
  v_mfma_f32_16x16x32_bf16 v[92:95], a[144:147], v[176:179], v[92:95]
  v_cvt_pk_bf16_f32 v81, v82, v83
  v_mfma_f32_16x16x32_bf16 v[96:99], a[128:131], v[128:131], v[192:195]
  v_exp_f32 v88, v88
  v_mfma_f32_16x16x32_bf16 v[96:99], a[132:135], v[132:135], v[96:99]
  ds_read_b128 a[144:147], v212 offset:28672
  v_mfma_f32_16x16x32_bf16 v[96:99], a[136:139], v[136:139], v[96:99]
  v_exp_f32 v89, v89
  v_mfma_f32_16x16x32_bf16 v[96:99], a[140:143], v[140:143], v[96:99]
  ds_read_b128 a[148:151], v213 offset:28672
  v_cvt_pk_bf16_f32 v88, v88, v89
  v_mfma_f32_16x16x32_bf16 v[104:107], a[140:143], v[156:159], v[196:199]
  v_exp_f32 v90, v90
  v_mfma_f32_16x16x32_bf16 v[104:107], a[136:139], v[152:155], v[104:107]
  ds_read_b128 a[152:155], v214 offset:28672
  v_mfma_f32_16x16x32_bf16 v[104:107], a[132:135], v[148:151], v[104:107]
  v_exp_f32 v91, v91
  v_mfma_f32_16x16x32_bf16 v[104:107], a[128:131], v[144:147], v[104:107]
  ds_read_b128 a[156:159], v215 offset:28672
  v_cvt_pk_bf16_f32 v89, v90, v91
  v_mfma_f32_16x16x32_bf16 v[112:115], a[128:131], v[160:163], v[200:203]
  v_exp_f32 v68, v68
  v_mfma_f32_16x16x32_bf16 v[112:115], a[132:135], v[164:167], v[112:115]
  buffer_load_dwordx4 v233, s[12:15], s29 offen offset:1024 lds
  v_mfma_f32_16x16x32_bf16 v[112:115], a[136:139], v[168:171], v[112:115]
  v_exp_f32 v69, v69
  v_mfma_f32_16x16x32_bf16 v[112:115], a[140:143], v[172:175], v[112:115]
  v_cvt_pk_bf16_f32 v66, v68, v69
  v_mfma_f32_16x16x32_bf16 v[120:123], a[140:143], v[188:191], v[204:207]
  v_exp_f32 v70, v70
  v_mfma_f32_16x16x32_bf16 v[120:123], a[136:139], v[184:187], v[120:123]
  buffer_load_dwordx4 v234, s[12:15], s29 offen offset:2048 lds
  v_mfma_f32_16x16x32_bf16 v[120:123], a[132:135], v[180:183], v[120:123]
  s_waitcnt lgkmcnt(0)
  v_exp_f32 v71, v71
  v_mfma_f32_16x16x32_bf16 v[120:123], a[128:131], v[176:179], v[120:123]
  v_cvt_pk_bf16_f32 v67, v70, v71
  v_mfma_f32_16x16x32_bf16 v[100:103], a[144:147], v[128:131], v[192:195]
  v_exp_f32 v76, v76
  v_mfma_f32_16x16x32_bf16 v[100:103], a[148:151], v[132:135], v[100:103]
  ds_read_b64_tr_b16 a[160:161], v216 offset:0
  v_mfma_f32_16x16x32_bf16 v[100:103], a[152:155], v[136:139], v[100:103]
  v_exp_f32 v77, v77
  v_mfma_f32_16x16x32_bf16 v[100:103], a[156:159], v[140:143], v[100:103]
  ds_read_b64_tr_b16 a[162:163], v216 offset:4096
  v_cvt_pk_bf16_f32 v74, v76, v77
  v_mfma_f32_16x16x32_bf16 v[108:111], a[156:159], v[156:159], v[196:199]
  v_exp_f32 v78, v78
  v_mfma_f32_16x16x32_bf16 v[108:111], a[152:155], v[152:155], v[108:111]
  ds_read_b64_tr_b16 a[164:165], v216 offset:8192
  buffer_load_dwordx4 v235, s[12:15], s29 offen offset:3072 lds
  v_mfma_f32_16x16x32_bf16 v[108:111], a[148:151], v[148:151], v[108:111]
  v_exp_f32 v79, v79
  v_mfma_f32_16x16x32_bf16 v[108:111], a[144:147], v[144:147], v[108:111]
  ds_read_b64_tr_b16 a[166:167], v216 offset:12288
  v_cvt_pk_bf16_f32 v75, v78, v79
  v_mfma_f32_16x16x32_bf16 v[116:119], a[144:147], v[160:163], v[200:203]
  s_add_u32 m0, s50, 5120
  v_exp_f32 v84, v84
  v_mfma_f32_16x16x32_bf16 v[116:119], a[148:151], v[164:167], v[116:119]
  ds_read_b64_tr_b16 a[168:169], v217 offset:0
  buffer_load_dwordx4 v208, s[20:23], s30 offen lds
  s_add_u32 s30, s30, 32
  v_mfma_f32_16x16x32_bf16 v[116:119], a[152:155], v[168:171], v[116:119]
  v_exp_f32 v85, v85
  v_mfma_f32_16x16x32_bf16 v[116:119], a[156:159], v[172:175], v[116:119]
  ds_read_b64_tr_b16 a[170:171], v217 offset:4096
  v_cvt_pk_bf16_f32 v82, v84, v85
  v_mfma_f32_16x16x32_bf16 v[124:127], a[156:159], v[188:191], v[204:207]
  v_exp_f32 v86, v86
  v_mfma_f32_16x16x32_bf16 v[124:127], a[152:155], v[184:187], v[124:127]
  ds_read_b64_tr_b16 a[172:173], v217 offset:8192
  v_mfma_f32_16x16x32_bf16 v[124:127], a[148:151], v[180:183], v[124:127]
  v_exp_f32 v87, v87
  v_mfma_f32_16x16x32_bf16 v[124:127], a[144:147], v[176:179], v[124:127]
  ds_read_b64_tr_b16 a[174:175], v217 offset:12288
  v_cvt_pk_bf16_f32 v83, v86, v87
  v_mfma_f32_16x16x32_bf16 a[192:195], a[208:211], v[0:3], a[192:195]
  v_exp_f32 v92, v92
  v_mfma_f32_16x16x32_bf16 a[192:195], a[208:211], v[32:35], a[192:195]
  ds_read_b64_tr_b16 a[176:177], v218 offset:0
  v_mfma_f32_16x16x32_bf16 a[196:199], a[208:211], v[8:11], a[196:199]
  v_exp_f32 v93, v93
  v_mfma_f32_16x16x32_bf16 a[196:199], a[208:211], v[40:43], a[196:199]
  ds_read_b64_tr_b16 a[178:179], v218 offset:4096
  v_cvt_pk_bf16_f32 v90, v92, v93
  v_mfma_f32_16x16x32_bf16 a[200:203], a[208:211], v[16:19], a[200:203]
  v_exp_f32 v94, v94
  v_mfma_f32_16x16x32_bf16 a[200:203], a[208:211], v[48:51], a[200:203]
  ds_read_b64_tr_b16 a[180:181], v218 offset:8192
  v_mfma_f32_16x16x32_bf16 a[204:207], a[208:211], v[24:27], a[204:207]
  s_waitcnt lgkmcnt(7)
  v_exp_f32 v95, v95
  v_mfma_f32_16x16x32_bf16 a[204:207], a[208:211], v[56:59], a[204:207]
  ds_read_b64_tr_b16 a[182:183], v218 offset:12288
  v_cvt_pk_bf16_f32 v91, v94, v95
  v_mfma_f32_16x16x32_bf16 a[0:3], a[160:163], v[0:3], a[0:3]
  v_exp_f32 v96, v96
  v_mfma_f32_16x16x32_bf16 a[0:3], a[164:167], v[32:35], a[0:3]
  ds_read_b64_tr_b16 a[184:185], v219 offset:0
  v_mfma_f32_16x16x32_bf16 a[4:7], a[164:167], v[40:43], a[4:7]
  v_exp_f32 v97, v97
  v_mfma_f32_16x16x32_bf16 a[4:7], a[160:163], v[8:11], a[4:7]
  ds_read_b64_tr_b16 a[186:187], v219 offset:4096
  v_cvt_pk_bf16_f32 v96, v96, v97
  v_mfma_f32_16x16x32_bf16 a[8:11], a[160:163], v[16:19], a[8:11]
  v_exp_f32 v98, v98
  v_mfma_f32_16x16x32_bf16 a[8:11], a[164:167], v[48:51], a[8:11]
  ds_read_b64_tr_b16 a[188:189], v219 offset:8192
  v_mfma_f32_16x16x32_bf16 a[12:15], a[164:167], v[56:59], a[12:15]
  s_waitcnt lgkmcnt(7)
  v_exp_f32 v99, v99
  v_mfma_f32_16x16x32_bf16 a[12:15], a[160:163], v[24:27], a[12:15]
  ds_read_b64_tr_b16 a[190:191], v219 offset:12288
  v_cvt_pk_bf16_f32 v97, v98, v99
  v_mfma_f32_16x16x32_bf16 a[16:19], a[168:171], v[0:3], a[16:19]
  v_exp_f32 v104, v104
  v_mfma_f32_16x16x32_bf16 a[16:19], a[172:175], v[32:35], a[16:19]
  ds_read_b64_tr_b16 a[160:161], v220 offset:0
  v_mfma_f32_16x16x32_bf16 a[20:23], a[172:175], v[40:43], a[20:23]
  v_exp_f32 v105, v105
  v_mfma_f32_16x16x32_bf16 a[20:23], a[168:171], v[8:11], a[20:23]
  ds_read_b64_tr_b16 a[162:163], v220 offset:4096
  v_cvt_pk_bf16_f32 v104, v104, v105
  v_mfma_f32_16x16x32_bf16 a[24:27], a[168:171], v[16:19], a[24:27]
  v_exp_f32 v106, v106
  v_mfma_f32_16x16x32_bf16 a[24:27], a[172:175], v[48:51], a[24:27]
  ds_read_b64_tr_b16 a[164:165], v220 offset:8192
  v_mfma_f32_16x16x32_bf16 a[28:31], a[172:175], v[56:59], a[28:31]
  s_waitcnt lgkmcnt(7)
  v_exp_f32 v107, v107
  v_mfma_f32_16x16x32_bf16 a[28:31], a[168:171], v[24:27], a[28:31]
  ds_read_b64_tr_b16 a[166:167], v220 offset:12288
  v_cvt_pk_bf16_f32 v105, v106, v107
  v_mfma_f32_16x16x32_bf16 a[32:35], a[176:179], v[0:3], a[32:35]
  v_exp_f32 v112, v112
  v_mfma_f32_16x16x32_bf16 a[32:35], a[180:183], v[32:35], a[32:35]
  ds_read_b64_tr_b16 a[168:169], v221 offset:0
  v_mfma_f32_16x16x32_bf16 a[36:39], a[180:183], v[40:43], a[36:39]
  v_exp_f32 v113, v113
  v_mfma_f32_16x16x32_bf16 a[36:39], a[176:179], v[8:11], a[36:39]
  ds_read_b64_tr_b16 a[170:171], v221 offset:4096
  v_cvt_pk_bf16_f32 v112, v112, v113
  v_mfma_f32_16x16x32_bf16 a[40:43], a[176:179], v[16:19], a[40:43]
  v_exp_f32 v114, v114
  v_mfma_f32_16x16x32_bf16 a[40:43], a[180:183], v[48:51], a[40:43]
  ds_read_b64_tr_b16 a[172:173], v221 offset:8192
  v_mfma_f32_16x16x32_bf16 a[44:47], a[180:183], v[56:59], a[44:47]
  s_waitcnt lgkmcnt(7)
  v_exp_f32 v115, v115
  v_mfma_f32_16x16x32_bf16 a[44:47], a[176:179], v[24:27], a[44:47]
  ds_read_b64_tr_b16 a[174:175], v221 offset:12288
  v_cvt_pk_bf16_f32 v113, v114, v115
  v_mfma_f32_16x16x32_bf16 a[48:51], a[184:187], v[0:3], a[48:51]
  v_exp_f32 v120, v120
  v_mfma_f32_16x16x32_bf16 a[48:51], a[188:191], v[32:35], a[48:51]
  ds_read_b64_tr_b16 a[176:177], v222 offset:0
  v_mfma_f32_16x16x32_bf16 a[52:55], a[188:191], v[40:43], a[52:55]
  v_exp_f32 v121, v121
  v_mfma_f32_16x16x32_bf16 a[52:55], a[184:187], v[8:11], a[52:55]
  ds_read_b64_tr_b16 a[178:179], v222 offset:4096
  v_cvt_pk_bf16_f32 v120, v120, v121
  v_mfma_f32_16x16x32_bf16 a[56:59], a[184:187], v[16:19], a[56:59]
  v_exp_f32 v122, v122
  v_mfma_f32_16x16x32_bf16 a[56:59], a[188:191], v[48:51], a[56:59]
  ds_read_b64_tr_b16 a[180:181], v222 offset:8192
  v_mfma_f32_16x16x32_bf16 a[60:63], a[188:191], v[56:59], a[60:63]
  s_waitcnt lgkmcnt(7)
  v_exp_f32 v123, v123
  v_mfma_f32_16x16x32_bf16 a[60:63], a[184:187], v[24:27], a[60:63]
  ds_read_b64_tr_b16 a[182:183], v222 offset:12288
  v_cvt_pk_bf16_f32 v121, v122, v123
  v_mfma_f32_16x16x32_bf16 a[64:67], a[160:163], v[0:3], a[64:67]
  v_exp_f32 v100, v100
  v_mfma_f32_16x16x32_bf16 a[64:67], a[164:167], v[32:35], a[64:67]
  ds_read_b64_tr_b16 a[184:185], v223 offset:0
  v_mfma_f32_16x16x32_bf16 a[68:71], a[164:167], v[40:43], a[68:71]
  v_exp_f32 v101, v101
  v_mfma_f32_16x16x32_bf16 a[68:71], a[160:163], v[8:11], a[68:71]
  ds_read_b64_tr_b16 a[186:187], v223 offset:4096
  v_cvt_pk_bf16_f32 v98, v100, v101
  v_mfma_f32_16x16x32_bf16 a[72:75], a[160:163], v[16:19], a[72:75]
  v_exp_f32 v102, v102
  v_mfma_f32_16x16x32_bf16 a[72:75], a[164:167], v[48:51], a[72:75]
  ds_read_b64_tr_b16 a[188:189], v223 offset:8192
  v_mfma_f32_16x16x32_bf16 a[76:79], a[164:167], v[56:59], a[76:79]
  s_waitcnt lgkmcnt(7)
  v_exp_f32 v103, v103
  v_mfma_f32_16x16x32_bf16 a[76:79], a[160:163], v[24:27], a[76:79]
  ds_read_b64_tr_b16 a[190:191], v223 offset:12288
  v_cvt_pk_bf16_f32 v99, v102, v103
  v_mfma_f32_16x16x32_bf16 a[80:83], a[168:171], v[0:3], a[80:83]
  s_waitcnt vmcnt(11)
  v_exp_f32 v108, v108
  v_mfma_f32_16x16x32_bf16 a[80:83], a[172:175], v[32:35], a[80:83]
  v_mfma_f32_16x16x32_bf16 a[84:87], a[172:175], v[40:43], a[84:87]
  s_barrier
  v_exp_f32 v109, v109
  v_mfma_f32_16x16x32_bf16 a[84:87], a[168:171], v[8:11], a[84:87]
  ds_read_b128 a[128:131], v212 offset:32768
  v_cvt_pk_bf16_f32 v106, v108, v109
  v_mfma_f32_16x16x32_bf16 a[88:91], a[168:171], v[16:19], a[88:91]
  v_exp_f32 v110, v110
  v_mfma_f32_16x16x32_bf16 a[88:91], a[172:175], v[48:51], a[88:91]
  ds_read_b128 a[132:135], v213 offset:32768
  buffer_atomic_add v250, v249, s[24:27], s47 offen
  s_cmp_eq_u32 s32, 3
  s_cselect_b32 s39, 0, 1073741824
  v_mfma_f32_16x16x32_bf16 a[92:95], a[172:175], v[56:59], a[92:95]
  s_waitcnt lgkmcnt(6)
  v_exp_f32 v111, v111
  v_mfma_f32_16x16x32_bf16 a[92:95], a[168:171], v[24:27], a[92:95]
  ds_read_b128 a[136:139], v214 offset:32768
  v_cvt_pk_bf16_f32 v107, v110, v111
  v_mfma_f32_16x16x32_bf16 a[96:99], a[176:179], v[0:3], a[96:99]
  v_exp_f32 v116, v116
  v_mfma_f32_16x16x32_bf16 a[96:99], a[180:183], v[32:35], a[96:99]
  ds_read_b128 a[140:143], v215 offset:32768
  v_or_b32 v249, s39, v251
  v_mfma_f32_16x16x32_bf16 a[100:103], a[180:183], v[40:43], a[100:103]
  v_exp_f32 v117, v117
  v_mfma_f32_16x16x32_bf16 a[100:103], a[176:179], v[8:11], a[100:103]
  v_cvt_pk_bf16_f32 v114, v116, v117
  v_mfma_f32_16x16x32_bf16 a[104:107], a[176:179], v[16:19], a[104:107]
  v_exp_f32 v118, v118
  v_mfma_f32_16x16x32_bf16 a[104:107], a[180:183], v[48:51], a[104:107]
  v_mfma_f32_16x16x32_bf16 a[108:111], a[180:183], v[56:59], a[108:111]
  s_waitcnt lgkmcnt(4)
  v_exp_f32 v119, v119
  v_mfma_f32_16x16x32_bf16 a[108:111], a[176:179], v[24:27], a[108:111]
  v_cvt_pk_bf16_f32 v115, v118, v119
  v_mfma_f32_16x16x32_bf16 a[112:115], a[184:187], v[0:3], a[112:115]
  v_exp_f32 v124, v124
  v_mfma_f32_16x16x32_bf16 a[112:115], a[188:191], v[32:35], a[112:115]
  v_mfma_f32_16x16x32_bf16 a[116:119], a[188:191], v[40:43], a[116:119]
  v_exp_f32 v125, v125
  v_mfma_f32_16x16x32_bf16 a[116:119], a[184:187], v[8:11], a[116:119]
  v_cvt_pk_bf16_f32 v122, v124, v125
  v_mfma_f32_16x16x32_bf16 a[120:123], a[184:187], v[16:19], a[120:123]
  v_exp_f32 v126, v126
  v_mfma_f32_16x16x32_bf16 a[120:123], a[188:191], v[48:51], a[120:123]
  v_mfma_f32_16x16x32_bf16 a[124:127], a[188:191], v[56:59], a[124:127]
  s_waitcnt lgkmcnt(0)
  v_exp_f32 v127, v127
  v_mfma_f32_16x16x32_bf16 a[124:127], a[184:187], v[24:27], a[124:127]
  v_cvt_pk_bf16_f32 v123, v126, v127
  v_mfma_f32_16x16x32_bf16 v[0:3], a[128:131], v[128:131], v[192:195]
  s_add_u32 m0, s28, 114688
  v_mfma_f32_16x16x32_bf16 v[0:3], a[132:135], v[132:135], v[0:3]
  ds_read_b128 a[144:147], v212 offset:36864
  v_mfma_f32_16x16x32_bf16 v[0:3], a[136:139], v[136:139], v[0:3]
  buffer_load_dwordx4 v236, s[16:19], s29 offen offset:0 lds
  v_mfma_f32_16x16x32_bf16 v[0:3], a[140:143], v[140:143], v[0:3]
  ds_read_b128 a[148:151], v213 offset:36864
  v_mfma_f32_16x16x32_bf16 v[8:11], a[140:143], v[156:159], v[196:199]
  v_mfma_f32_16x16x32_bf16 v[8:11], a[136:139], v[152:155], v[8:11]
  ds_read_b128 a[152:155], v214 offset:36864
  v_mfma_f32_16x16x32_bf16 v[8:11], a[132:135], v[148:151], v[8:11]
  buffer_load_dwordx4 v237, s[16:19], s29 offen offset:1024 lds
  v_mfma_f32_16x16x32_bf16 v[8:11], a[128:131], v[144:147], v[8:11]
  ds_read_b128 a[156:159], v215 offset:36864
  v_mfma_f32_16x16x32_bf16 v[16:19], a[128:131], v[160:163], v[200:203]
  v_exp_f32 v0, v0
  v_mfma_f32_16x16x32_bf16 v[16:19], a[132:135], v[164:167], v[16:19]
  v_mfma_f32_16x16x32_bf16 v[16:19], a[136:139], v[168:171], v[16:19]
  v_exp_f32 v1, v1
  v_mfma_f32_16x16x32_bf16 v[16:19], a[140:143], v[172:175], v[16:19]
  v_cvt_pk_bf16_f32 v0, v0, v1
  v_mfma_f32_16x16x32_bf16 v[24:27], a[140:143], v[188:191], v[204:207]
  v_exp_f32 v2, v2
  v_mfma_f32_16x16x32_bf16 v[24:27], a[136:139], v[184:187], v[24:27]
  buffer_load_dwordx4 v236, s[16:19], s29 offen offset:2048 lds
  v_mfma_f32_16x16x32_bf16 v[24:27], a[132:135], v[180:183], v[24:27]
  s_waitcnt lgkmcnt(0)
  v_exp_f32 v3, v3
  v_mfma_f32_16x16x32_bf16 v[24:27], a[128:131], v[176:179], v[24:27]
  v_cvt_pk_bf16_f32 v1, v2, v3
  v_mfma_f32_16x16x32_bf16 v[4:7], a[144:147], v[128:131], v[192:195]
  v_exp_f32 v8, v8
  v_mfma_f32_16x16x32_bf16 v[4:7], a[148:151], v[132:135], v[4:7]
  ds_read_b128 a[128:131], v212 offset:40960
  v_mfma_f32_16x16x32_bf16 v[4:7], a[152:155], v[136:139], v[4:7]
  v_exp_f32 v9, v9
  v_mfma_f32_16x16x32_bf16 v[4:7], a[156:159], v[140:143], v[4:7]
  ds_read_b128 a[132:135], v213 offset:40960
  v_cvt_pk_bf16_f32 v8, v8, v9
  v_mfma_f32_16x16x32_bf16 v[12:15], a[156:159], v[156:159], v[196:199]
  v_exp_f32 v10, v10
  v_mfma_f32_16x16x32_bf16 v[12:15], a[152:155], v[152:155], v[12:15]
  ds_read_b128 a[136:139], v214 offset:40960
  v_mfma_f32_16x16x32_bf16 v[12:15], a[148:151], v[148:151], v[12:15]
  v_exp_f32 v11, v11
  v_mfma_f32_16x16x32_bf16 v[12:15], a[144:147], v[144:147], v[12:15]
  ds_read_b128 a[140:143], v215 offset:40960
  v_cvt_pk_bf16_f32 v9, v10, v11
  v_mfma_f32_16x16x32_bf16 v[20:23], a[144:147], v[160:163], v[200:203]
  v_exp_f32 v16, v16
  v_mfma_f32_16x16x32_bf16 v[20:23], a[148:151], v[164:167], v[20:23]
  buffer_load_dwordx4 v237, s[16:19], s29 offen offset:3072 lds
  v_mfma_f32_16x16x32_bf16 v[20:23], a[152:155], v[168:171], v[20:23]
  s_add_u32 s29, s29, 16384
  v_exp_f32 v17, v17
  v_mfma_f32_16x16x32_bf16 v[20:23], a[156:159], v[172:175], v[20:23]
  v_cvt_pk_bf16_f32 v16, v16, v17
  v_mfma_f32_16x16x32_bf16 v[28:31], a[156:159], v[188:191], v[204:207]
  s_add_u32 m0, s28, 0
  v_exp_f32 v18, v18
  v_mfma_f32_16x16x32_bf16 v[28:31], a[152:155], v[184:187], v[28:31]
  buffer_load_dwordx4 v232, s[12:15], s29 offen offset:0 lds
  v_mfma_f32_16x16x32_bf16 v[28:31], a[148:151], v[180:183], v[28:31]
  s_waitcnt lgkmcnt(0)
  v_exp_f32 v19, v19
  v_mfma_f32_16x16x32_bf16 v[28:31], a[144:147], v[176:179], v[28:31]
  v_cvt_pk_bf16_f32 v17, v18, v19
  v_mfma_f32_16x16x32_bf16 v[32:35], a[128:131], v[128:131], v[192:195]
  v_exp_f32 v24, v24
  v_mfma_f32_16x16x32_bf16 v[32:35], a[132:135], v[132:135], v[32:35]
  ds_read_b128 a[144:147], v212 offset:45056
  v_mfma_f32_16x16x32_bf16 v[32:35], a[136:139], v[136:139], v[32:35]
  v_exp_f32 v25, v25
  v_mfma_f32_16x16x32_bf16 v[32:35], a[140:143], v[140:143], v[32:35]
  ds_read_b128 a[148:151], v213 offset:45056
  v_cvt_pk_bf16_f32 v24, v24, v25
  v_mfma_f32_16x16x32_bf16 v[40:43], a[140:143], v[156:159], v[196:199]
  v_exp_f32 v26, v26
  v_mfma_f32_16x16x32_bf16 v[40:43], a[136:139], v[152:155], v[40:43]
  ds_read_b128 a[152:155], v214 offset:45056
  v_mfma_f32_16x16x32_bf16 v[40:43], a[132:135], v[148:151], v[40:43]
  v_exp_f32 v27, v27
  v_mfma_f32_16x16x32_bf16 v[40:43], a[128:131], v[144:147], v[40:43]
  ds_read_b128 a[156:159], v215 offset:45056
  v_cvt_pk_bf16_f32 v25, v26, v27
  v_mfma_f32_16x16x32_bf16 v[48:51], a[128:131], v[160:163], v[200:203]
  v_exp_f32 v4, v4
  v_mfma_f32_16x16x32_bf16 v[48:51], a[132:135], v[164:167], v[48:51]
  buffer_load_dwordx4 v233, s[12:15], s29 offen offset:1024 lds
  v_mfma_f32_16x16x32_bf16 v[48:51], a[136:139], v[168:171], v[48:51]
  v_exp_f32 v5, v5
  v_mfma_f32_16x16x32_bf16 v[48:51], a[140:143], v[172:175], v[48:51]
  v_cvt_pk_bf16_f32 v2, v4, v5
  v_mfma_f32_16x16x32_bf16 v[56:59], a[140:143], v[188:191], v[204:207]
  v_exp_f32 v6, v6
  v_mfma_f32_16x16x32_bf16 v[56:59], a[136:139], v[184:187], v[56:59]
  buffer_load_dwordx4 v234, s[12:15], s29 offen offset:2048 lds
  v_mfma_f32_16x16x32_bf16 v[56:59], a[132:135], v[180:183], v[56:59]
  s_waitcnt lgkmcnt(0)
  v_exp_f32 v7, v7
  v_mfma_f32_16x16x32_bf16 v[56:59], a[128:131], v[176:179], v[56:59]
  v_cvt_pk_bf16_f32 v3, v6, v7
  v_mfma_f32_16x16x32_bf16 v[36:39], a[144:147], v[128:131], v[192:195]
  v_exp_f32 v12, v12
  v_mfma_f32_16x16x32_bf16 v[36:39], a[148:151], v[132:135], v[36:39]
  ds_read_b64_tr_b16 a[160:161], v216 offset:16384
  v_mfma_f32_16x16x32_bf16 v[36:39], a[152:155], v[136:139], v[36:39]
  v_exp_f32 v13, v13
  v_mfma_f32_16x16x32_bf16 v[36:39], a[156:159], v[140:143], v[36:39]
  ds_read_b64_tr_b16 a[162:163], v216 offset:20480
  v_cvt_pk_bf16_f32 v10, v12, v13
  v_mfma_f32_16x16x32_bf16 v[44:47], a[156:159], v[156:159], v[196:199]
  v_exp_f32 v14, v14
  v_mfma_f32_16x16x32_bf16 v[44:47], a[152:155], v[152:155], v[44:47]
  ds_read_b64_tr_b16 a[164:165], v216 offset:24576
  buffer_load_dwordx4 v235, s[12:15], s29 offen offset:3072 lds
  v_mfma_f32_16x16x32_bf16 v[44:47], a[148:151], v[148:151], v[44:47]
  v_exp_f32 v15, v15
  v_mfma_f32_16x16x32_bf16 v[44:47], a[144:147], v[144:147], v[44:47]
  ds_read_b64_tr_b16 a[166:167], v216 offset:28672
  v_cvt_pk_bf16_f32 v11, v14, v15
  v_mfma_f32_16x16x32_bf16 v[52:55], a[144:147], v[160:163], v[200:203]
  s_mov_b32 m0, s51
  v_exp_f32 v20, v20
  v_mfma_f32_16x16x32_bf16 v[52:55], a[148:151], v[164:167], v[52:55]
  ds_read_b64_tr_b16 a[168:169], v217 offset:16384
  buffer_load_dwordx4 v210, s[4:7], s100 offen lds
  s_add_u32 s100, s100, 20480
  s_add_u32 s51, s51, 512
  v_mfma_f32_16x16x32_bf16 v[52:55], a[152:155], v[168:171], v[52:55]
  v_exp_f32 v21, v21
  v_mfma_f32_16x16x32_bf16 v[52:55], a[156:159], v[172:175], v[52:55]
  ds_read_b64_tr_b16 a[170:171], v217 offset:20480
  v_cvt_pk_bf16_f32 v18, v20, v21
  v_mfma_f32_16x16x32_bf16 v[60:63], a[156:159], v[188:191], v[204:207]
  s_waitcnt vmcnt(20)
  v_exp_f32 v22, v22
  v_mfma_f32_16x16x32_bf16 v[60:63], a[152:155], v[184:187], v[60:63]
  ds_read_b64_tr_b16 a[172:173], v217 offset:24576
  ds_read_b64_tr_b16 a[232:233], v209 offset:4096
  v_mfma_f32_16x16x32_bf16 v[60:63], a[148:151], v[180:183], v[60:63]
  v_exp_f32 v23, v23
  v_mfma_f32_16x16x32_bf16 v[60:63], a[144:147], v[176:179], v[60:63]
  ds_read_b64_tr_b16 a[174:175], v217 offset:28672
  v_cvt_pk_bf16_f32 v19, v22, v23
  v_mfma_f32_16x16x32_bf16 a[192:195], a[208:211], v[64:67], a[192:195]
  v_exp_f32 v28, v28
  v_mfma_f32_16x16x32_bf16 a[192:195], a[208:211], v[96:99], a[192:195]
  ds_read_b64_tr_b16 a[176:177], v218 offset:16384
  ds_read_b64_tr_b16 a[234:235], v209 offset:4608
  v_mfma_f32_16x16x32_bf16 a[196:199], a[208:211], v[72:75], a[196:199]
  v_exp_f32 v29, v29
  v_mfma_f32_16x16x32_bf16 a[196:199], a[208:211], v[104:107], a[196:199]
  ds_read_b64_tr_b16 a[178:179], v218 offset:20480
  v_cvt_pk_bf16_f32 v26, v28, v29
  v_mfma_f32_16x16x32_bf16 a[200:203], a[208:211], v[80:83], a[200:203]
  v_exp_f32 v30, v30
  v_mfma_f32_16x16x32_bf16 a[200:203], a[208:211], v[112:115], a[200:203]
  ds_read_b64_tr_b16 a[180:181], v218 offset:24576
  v_mfma_f32_16x16x32_bf16 a[204:207], a[208:211], v[88:91], a[204:207]
  s_waitcnt lgkmcnt(9)
  v_exp_f32 v31, v31
  v_mfma_f32_16x16x32_bf16 a[204:207], a[208:211], v[120:123], a[204:207]
  ds_read_b64_tr_b16 a[182:183], v218 offset:28672
  v_cvt_pk_bf16_f32 v27, v30, v31
  v_mfma_f32_16x16x32_bf16 a[0:3], a[160:163], v[64:67], a[0:3]
  v_exp_f32 v32, v32
  v_mfma_f32_16x16x32_bf16 a[0:3], a[164:167], v[96:99], a[0:3]
  ds_read_b64_tr_b16 a[184:185], v219 offset:16384
  s_waitcnt lgkmcnt(4)
  buffer_store_dwordx4 a[232:235], v211, s[24:27], s31 offen sc1
  s_add_u32 s31, s31, 1024
  s_cmp_gt_u32 s32, 3
  v_mfma_f32_16x16x32_bf16 a[4:7], a[164:167], v[104:107], a[4:7]
  s_cselect_b32 s39, 0, 1073741824
  v_exp_f32 v33, v33
  v_mfma_f32_16x16x32_bf16 a[4:7], a[160:163], v[72:75], a[4:7]
  ds_read_b64_tr_b16 a[186:187], v219 offset:20480
  v_cvt_pk_bf16_f32 v32, v32, v33
  v_mfma_f32_16x16x32_bf16 a[8:11], a[160:163], v[80:83], a[8:11]
  v_exp_f32 v34, v34
  v_mfma_f32_16x16x32_bf16 a[8:11], a[164:167], v[112:115], a[8:11]
  ds_read_b64_tr_b16 a[188:189], v219 offset:24576
  v_or_b32 v211, s39, v211
  v_mfma_f32_16x16x32_bf16 a[12:15], a[164:167], v[120:123], a[12:15]
  v_exp_f32 v35, v35
  v_mfma_f32_16x16x32_bf16 a[12:15], a[160:163], v[88:91], a[12:15]
  ds_read_b64_tr_b16 a[190:191], v219 offset:28672
  v_cvt_pk_bf16_f32 v33, v34, v35
  v_mfma_f32_16x16x32_bf16 a[16:19], a[168:171], v[64:67], a[16:19]
  v_exp_f32 v40, v40
  v_mfma_f32_16x16x32_bf16 a[16:19], a[172:175], v[96:99], a[16:19]
  ds_read_b64_tr_b16 a[160:161], v220 offset:16384
  v_or_b32 v208, s39, v208
  v_mfma_f32_16x16x32_bf16 a[20:23], a[172:175], v[104:107], a[20:23]
  v_exp_f32 v41, v41
  v_mfma_f32_16x16x32_bf16 a[20:23], a[168:171], v[72:75], a[20:23]
  ds_read_b64_tr_b16 a[162:163], v220 offset:20480
  v_cvt_pk_bf16_f32 v40, v40, v41
  v_mfma_f32_16x16x32_bf16 a[24:27], a[168:171], v[80:83], a[24:27]
  v_exp_f32 v42, v42
  v_mfma_f32_16x16x32_bf16 a[24:27], a[172:175], v[112:115], a[24:27]
  ds_read_b64_tr_b16 a[164:165], v220 offset:24576
  v_mfma_f32_16x16x32_bf16 a[28:31], a[172:175], v[120:123], a[28:31]
  s_waitcnt lgkmcnt(7)
  v_exp_f32 v43, v43
  v_mfma_f32_16x16x32_bf16 a[28:31], a[168:171], v[88:91], a[28:31]
  ds_read_b64_tr_b16 a[166:167], v220 offset:28672
  v_cvt_pk_bf16_f32 v41, v42, v43
  v_mfma_f32_16x16x32_bf16 a[32:35], a[176:179], v[64:67], a[32:35]
  v_exp_f32 v48, v48
  v_mfma_f32_16x16x32_bf16 a[32:35], a[180:183], v[96:99], a[32:35]
  ds_read_b64_tr_b16 a[168:169], v221 offset:16384
  v_mfma_f32_16x16x32_bf16 a[36:39], a[180:183], v[104:107], a[36:39]
  v_exp_f32 v49, v49
  v_mfma_f32_16x16x32_bf16 a[36:39], a[176:179], v[72:75], a[36:39]
  ds_read_b64_tr_b16 a[170:171], v221 offset:20480
  v_cvt_pk_bf16_f32 v48, v48, v49
  v_mfma_f32_16x16x32_bf16 a[40:43], a[176:179], v[80:83], a[40:43]
  v_exp_f32 v50, v50
  v_mfma_f32_16x16x32_bf16 a[40:43], a[180:183], v[112:115], a[40:43]
  ds_read_b64_tr_b16 a[172:173], v221 offset:24576
  v_mfma_f32_16x16x32_bf16 a[44:47], a[180:183], v[120:123], a[44:47]
  s_waitcnt lgkmcnt(7)
  v_exp_f32 v51, v51
  v_mfma_f32_16x16x32_bf16 a[44:47], a[176:179], v[88:91], a[44:47]
  ds_read_b64_tr_b16 a[174:175], v221 offset:28672
  v_cvt_pk_bf16_f32 v49, v50, v51
  v_mfma_f32_16x16x32_bf16 a[48:51], a[184:187], v[64:67], a[48:51]
  v_exp_f32 v56, v56
  v_mfma_f32_16x16x32_bf16 a[48:51], a[188:191], v[96:99], a[48:51]
  ds_read_b64_tr_b16 a[176:177], v222 offset:16384
  v_mfma_f32_16x16x32_bf16 a[52:55], a[188:191], v[104:107], a[52:55]
  v_exp_f32 v57, v57
  v_mfma_f32_16x16x32_bf16 a[52:55], a[184:187], v[72:75], a[52:55]
  ds_read_b64_tr_b16 a[178:179], v222 offset:20480
  v_cvt_pk_bf16_f32 v56, v56, v57
  v_mfma_f32_16x16x32_bf16 a[56:59], a[184:187], v[80:83], a[56:59]
  v_exp_f32 v58, v58
  v_mfma_f32_16x16x32_bf16 a[56:59], a[188:191], v[112:115], a[56:59]
  ds_read_b64_tr_b16 a[180:181], v222 offset:24576
  v_mfma_f32_16x16x32_bf16 a[60:63], a[188:191], v[120:123], a[60:63]
  s_waitcnt lgkmcnt(7)
  v_exp_f32 v59, v59
  v_mfma_f32_16x16x32_bf16 a[60:63], a[184:187], v[88:91], a[60:63]
  ds_read_b64_tr_b16 a[182:183], v222 offset:28672
  v_cvt_pk_bf16_f32 v57, v58, v59
  v_mfma_f32_16x16x32_bf16 a[64:67], a[160:163], v[64:67], a[64:67]
  v_exp_f32 v36, v36
  v_mfma_f32_16x16x32_bf16 a[64:67], a[164:167], v[96:99], a[64:67]
  ds_read_b64_tr_b16 a[184:185], v223 offset:16384
  v_mfma_f32_16x16x32_bf16 a[68:71], a[164:167], v[104:107], a[68:71]
  v_exp_f32 v37, v37
  v_mfma_f32_16x16x32_bf16 a[68:71], a[160:163], v[72:75], a[68:71]
  ds_read_b64_tr_b16 a[186:187], v223 offset:20480
  v_cvt_pk_bf16_f32 v34, v36, v37
  v_mfma_f32_16x16x32_bf16 a[72:75], a[160:163], v[80:83], a[72:75]
  v_exp_f32 v38, v38
  v_mfma_f32_16x16x32_bf16 a[72:75], a[164:167], v[112:115], a[72:75]
  ds_read_b64_tr_b16 a[188:189], v223 offset:24576
  v_mfma_f32_16x16x32_bf16 a[76:79], a[164:167], v[120:123], a[76:79]
  s_waitcnt lgkmcnt(7)
  v_exp_f32 v39, v39
  v_mfma_f32_16x16x32_bf16 a[76:79], a[160:163], v[88:91], a[76:79]
  ds_read_b64_tr_b16 a[190:191], v223 offset:28672
  v_cvt_pk_bf16_f32 v35, v38, v39
  v_mfma_f32_16x16x32_bf16 a[80:83], a[168:171], v[64:67], a[80:83]
  s_waitcnt vmcnt(12)
  v_exp_f32 v44, v44
  v_mfma_f32_16x16x32_bf16 a[80:83], a[172:175], v[96:99], a[80:83]
  v_mfma_f32_16x16x32_bf16 a[84:87], a[172:175], v[104:107], a[84:87]
  s_barrier
  v_exp_f32 v45, v45
  v_mfma_f32_16x16x32_bf16 a[84:87], a[168:171], v[72:75], a[84:87]
  ds_read_b128 a[128:131], v212 offset:49152
  v_cvt_pk_bf16_f32 v42, v44, v45
  v_mfma_f32_16x16x32_bf16 a[88:91], a[168:171], v[80:83], a[88:91]
  v_exp_f32 v46, v46
  v_mfma_f32_16x16x32_bf16 a[88:91], a[172:175], v[112:115], a[88:91]
  ds_read_b128 a[132:135], v213 offset:49152
  v_mfma_f32_16x16x32_bf16 a[92:95], a[172:175], v[120:123], a[92:95]
  s_waitcnt lgkmcnt(6)
  v_exp_f32 v47, v47
  v_mfma_f32_16x16x32_bf16 a[92:95], a[168:171], v[88:91], a[92:95]
  ds_read_b128 a[136:139], v214 offset:49152
  v_cvt_pk_bf16_f32 v43, v46, v47
  v_mfma_f32_16x16x32_bf16 a[96:99], a[176:179], v[64:67], a[96:99]
  v_exp_f32 v52, v52
  v_mfma_f32_16x16x32_bf16 a[96:99], a[180:183], v[96:99], a[96:99]
  ds_read_b128 a[140:143], v215 offset:49152
  v_mfma_f32_16x16x32_bf16 a[100:103], a[180:183], v[104:107], a[100:103]
  v_exp_f32 v53, v53
  v_mfma_f32_16x16x32_bf16 a[100:103], a[176:179], v[72:75], a[100:103]
  v_cvt_pk_bf16_f32 v50, v52, v53
  v_mfma_f32_16x16x32_bf16 a[104:107], a[176:179], v[80:83], a[104:107]
  v_exp_f32 v54, v54
  v_mfma_f32_16x16x32_bf16 a[104:107], a[180:183], v[112:115], a[104:107]
  v_mfma_f32_16x16x32_bf16 a[108:111], a[180:183], v[120:123], a[108:111]
  s_waitcnt lgkmcnt(4)
  v_exp_f32 v55, v55
  v_mfma_f32_16x16x32_bf16 a[108:111], a[176:179], v[88:91], a[108:111]
  v_cvt_pk_bf16_f32 v51, v54, v55
  v_mfma_f32_16x16x32_bf16 a[112:115], a[184:187], v[64:67], a[112:115]
  v_exp_f32 v60, v60
  v_mfma_f32_16x16x32_bf16 a[112:115], a[188:191], v[96:99], a[112:115]
  v_mfma_f32_16x16x32_bf16 a[116:119], a[188:191], v[104:107], a[116:119]
  v_exp_f32 v61, v61
  v_mfma_f32_16x16x32_bf16 a[116:119], a[184:187], v[72:75], a[116:119]
  v_cvt_pk_bf16_f32 v58, v60, v61
  v_mfma_f32_16x16x32_bf16 a[120:123], a[184:187], v[80:83], a[120:123]
  v_exp_f32 v62, v62
  v_mfma_f32_16x16x32_bf16 a[120:123], a[188:191], v[112:115], a[120:123]
  v_mfma_f32_16x16x32_bf16 a[124:127], a[188:191], v[120:123], a[124:127]
  s_waitcnt lgkmcnt(0)
  v_exp_f32 v63, v63
  v_mfma_f32_16x16x32_bf16 a[124:127], a[184:187], v[88:91], a[124:127]
  v_cvt_pk_bf16_f32 v59, v62, v63
  v_mfma_f32_16x16x32_bf16 v[64:67], a[128:131], v[128:131], v[192:195]
  s_add_u32 m0, s28, 65536
  v_mfma_f32_16x16x32_bf16 v[64:67], a[132:135], v[132:135], v[64:67]
  ds_read_b128 a[144:147], v212 offset:53248
  v_mfma_f32_16x16x32_bf16 v[64:67], a[136:139], v[136:139], v[64:67]
  buffer_load_dwordx4 v236, s[16:19], s29 offen offset:0 lds
  v_mfma_f32_16x16x32_bf16 v[64:67], a[140:143], v[140:143], v[64:67]
  ds_read_b128 a[148:151], v213 offset:53248
  v_mfma_f32_16x16x32_bf16 v[72:75], a[140:143], v[156:159], v[196:199]
  v_mfma_f32_16x16x32_bf16 v[72:75], a[136:139], v[152:155], v[72:75]
  ds_read_b128 a[152:155], v214 offset:53248
  v_mfma_f32_16x16x32_bf16 v[72:75], a[132:135], v[148:151], v[72:75]
  buffer_load_dwordx4 v237, s[16:19], s29 offen offset:1024 lds
  v_mfma_f32_16x16x32_bf16 v[72:75], a[128:131], v[144:147], v[72:75]
  ds_read_b128 a[156:159], v215 offset:53248
  v_mfma_f32_16x16x32_bf16 v[80:83], a[128:131], v[160:163], v[200:203]
  v_exp_f32 v64, v64
  v_mfma_f32_16x16x32_bf16 v[80:83], a[132:135], v[164:167], v[80:83]
  v_mfma_f32_16x16x32_bf16 v[80:83], a[136:139], v[168:171], v[80:83]
  v_exp_f32 v65, v65
  v_mfma_f32_16x16x32_bf16 v[80:83], a[140:143], v[172:175], v[80:83]
  v_cvt_pk_bf16_f32 v64, v64, v65
  v_mfma_f32_16x16x32_bf16 v[88:91], a[140:143], v[188:191], v[204:207]
  v_exp_f32 v66, v66
  v_mfma_f32_16x16x32_bf16 v[88:91], a[136:139], v[184:187], v[88:91]
  buffer_load_dwordx4 v236, s[16:19], s29 offen offset:2048 lds
  v_mfma_f32_16x16x32_bf16 v[88:91], a[132:135], v[180:183], v[88:91]
  s_waitcnt lgkmcnt(0)
  v_exp_f32 v67, v67
  v_mfma_f32_16x16x32_bf16 v[88:91], a[128:131], v[176:179], v[88:91]
  v_cvt_pk_bf16_f32 v65, v66, v67
  v_mfma_f32_16x16x32_bf16 v[68:71], a[144:147], v[128:131], v[192:195]
  v_exp_f32 v72, v72
  v_mfma_f32_16x16x32_bf16 v[68:71], a[148:151], v[132:135], v[68:71]
  ds_read_b128 a[128:131], v212 offset:57344
  v_mfma_f32_16x16x32_bf16 v[68:71], a[152:155], v[136:139], v[68:71]
  v_exp_f32 v73, v73
  v_mfma_f32_16x16x32_bf16 v[68:71], a[156:159], v[140:143], v[68:71]
  ds_read_b128 a[132:135], v213 offset:57344
  v_cvt_pk_bf16_f32 v72, v72, v73
  v_mfma_f32_16x16x32_bf16 v[76:79], a[156:159], v[156:159], v[196:199]
  v_exp_f32 v74, v74
  v_mfma_f32_16x16x32_bf16 v[76:79], a[152:155], v[152:155], v[76:79]
  ds_read_b128 a[136:139], v214 offset:57344
  v_mfma_f32_16x16x32_bf16 v[76:79], a[148:151], v[148:151], v[76:79]
  v_exp_f32 v75, v75
  v_mfma_f32_16x16x32_bf16 v[76:79], a[144:147], v[144:147], v[76:79]
  ds_read_b128 a[140:143], v215 offset:57344
  v_cvt_pk_bf16_f32 v73, v74, v75
  v_mfma_f32_16x16x32_bf16 v[84:87], a[144:147], v[160:163], v[200:203]
  v_exp_f32 v80, v80
  v_mfma_f32_16x16x32_bf16 v[84:87], a[148:151], v[164:167], v[84:87]
  buffer_load_dwordx4 v237, s[16:19], s29 offen offset:3072 lds
  v_mfma_f32_16x16x32_bf16 v[84:87], a[152:155], v[168:171], v[84:87]
  s_add_u32 s29, s29, 16384
  v_exp_f32 v81, v81
  v_mfma_f32_16x16x32_bf16 v[84:87], a[156:159], v[172:175], v[84:87]
  v_cvt_pk_bf16_f32 v80, v80, v81
  v_mfma_f32_16x16x32_bf16 v[92:95], a[156:159], v[188:191], v[204:207]
  s_add_u32 m0, s28, 16384
  v_exp_f32 v82, v82
  v_mfma_f32_16x16x32_bf16 v[92:95], a[152:155], v[184:187], v[92:95]
  buffer_load_dwordx4 v232, s[12:15], s29 offen offset:0 lds
  v_mfma_f32_16x16x32_bf16 v[92:95], a[148:151], v[180:183], v[92:95]
  s_waitcnt lgkmcnt(0)
  v_exp_f32 v83, v83
  v_mfma_f32_16x16x32_bf16 v[92:95], a[144:147], v[176:179], v[92:95]
  v_cvt_pk_bf16_f32 v81, v82, v83
  v_mfma_f32_16x16x32_bf16 v[96:99], a[128:131], v[128:131], v[192:195]
  v_exp_f32 v88, v88
  v_mfma_f32_16x16x32_bf16 v[96:99], a[132:135], v[132:135], v[96:99]
  ds_read_b128 a[144:147], v212 offset:61440
  v_mfma_f32_16x16x32_bf16 v[96:99], a[136:139], v[136:139], v[96:99]
  v_exp_f32 v89, v89
  v_mfma_f32_16x16x32_bf16 v[96:99], a[140:143], v[140:143], v[96:99]
  ds_read_b128 a[148:151], v213 offset:61440
  v_cvt_pk_bf16_f32 v88, v88, v89
  v_mfma_f32_16x16x32_bf16 v[104:107], a[140:143], v[156:159], v[196:199]
  v_exp_f32 v90, v90
  v_mfma_f32_16x16x32_bf16 v[104:107], a[136:139], v[152:155], v[104:107]
  ds_read_b128 a[152:155], v214 offset:61440
  v_mfma_f32_16x16x32_bf16 v[104:107], a[132:135], v[148:151], v[104:107]
  v_exp_f32 v91, v91
  v_mfma_f32_16x16x32_bf16 v[104:107], a[128:131], v[144:147], v[104:107]
  ds_read_b128 a[156:159], v215 offset:61440
  v_cvt_pk_bf16_f32 v89, v90, v91
  v_mfma_f32_16x16x32_bf16 v[112:115], a[128:131], v[160:163], v[200:203]
  v_exp_f32 v68, v68
  v_mfma_f32_16x16x32_bf16 v[112:115], a[132:135], v[164:167], v[112:115]
  buffer_load_dwordx4 v233, s[12:15], s29 offen offset:1024 lds
  v_mfma_f32_16x16x32_bf16 v[112:115], a[136:139], v[168:171], v[112:115]
  v_exp_f32 v69, v69
  v_mfma_f32_16x16x32_bf16 v[112:115], a[140:143], v[172:175], v[112:115]
  v_cvt_pk_bf16_f32 v66, v68, v69
  v_mfma_f32_16x16x32_bf16 v[120:123], a[140:143], v[188:191], v[204:207]
  v_exp_f32 v70, v70
  v_mfma_f32_16x16x32_bf16 v[120:123], a[136:139], v[184:187], v[120:123]
  buffer_load_dwordx4 v234, s[12:15], s29 offen offset:2048 lds
  v_mfma_f32_16x16x32_bf16 v[120:123], a[132:135], v[180:183], v[120:123]
  s_waitcnt lgkmcnt(0)
  v_exp_f32 v71, v71
  v_mfma_f32_16x16x32_bf16 v[120:123], a[128:131], v[176:179], v[120:123]
  v_cvt_pk_bf16_f32 v67, v70, v71
  v_mfma_f32_16x16x32_bf16 v[100:103], a[144:147], v[128:131], v[192:195]
  v_exp_f32 v76, v76
  v_mfma_f32_16x16x32_bf16 v[100:103], a[148:151], v[132:135], v[100:103]
  ds_read_b64_tr_b16 a[160:161], v216 offset:32768
  v_mfma_f32_16x16x32_bf16 v[100:103], a[152:155], v[136:139], v[100:103]
  v_exp_f32 v77, v77
  v_mfma_f32_16x16x32_bf16 v[100:103], a[156:159], v[140:143], v[100:103]
  ds_read_b64_tr_b16 a[162:163], v216 offset:36864
  v_cvt_pk_bf16_f32 v74, v76, v77
  v_mfma_f32_16x16x32_bf16 v[108:111], a[156:159], v[156:159], v[196:199]
  v_exp_f32 v78, v78
  v_mfma_f32_16x16x32_bf16 v[108:111], a[152:155], v[152:155], v[108:111]
  ds_read_b64_tr_b16 a[164:165], v216 offset:40960
  buffer_load_dwordx4 v235, s[12:15], s29 offen offset:3072 lds
  v_mfma_f32_16x16x32_bf16 v[108:111], a[148:151], v[148:151], v[108:111]
  v_exp_f32 v79, v79
  v_mfma_f32_16x16x32_bf16 v[108:111], a[144:147], v[144:147], v[108:111]
  ds_read_b64_tr_b16 a[166:167], v216 offset:45056
  v_cvt_pk_bf16_f32 v75, v78, v79
  v_mfma_f32_16x16x32_bf16 v[116:119], a[144:147], v[160:163], v[200:203]
  v_exp_f32 v84, v84
  v_mfma_f32_16x16x32_bf16 v[116:119], a[148:151], v[164:167], v[116:119]
  ds_read_b64_tr_b16 a[168:169], v217 offset:32768
  buffer_load_dword v254, off, s[24:27], s47 sc1
  v_mfma_f32_16x16x32_bf16 v[116:119], a[152:155], v[168:171], v[116:119]
  v_exp_f32 v85, v85
  v_mfma_f32_16x16x32_bf16 v[116:119], a[156:159], v[172:175], v[116:119]
  ds_read_b64_tr_b16 a[170:171], v217 offset:36864
  v_cvt_pk_bf16_f32 v82, v84, v85
  v_mfma_f32_16x16x32_bf16 v[124:127], a[156:159], v[188:191], v[204:207]
  s_waitcnt vmcnt(20)
  v_exp_f32 v86, v86
  v_mfma_f32_16x16x32_bf16 v[124:127], a[152:155], v[184:187], v[124:127]
  ds_read_b64_tr_b16 a[172:173], v217 offset:40960
  ds_read_b64_tr_b16 a[232:233], v209 offset:5120
  v_mfma_f32_16x16x32_bf16 v[124:127], a[148:151], v[180:183], v[124:127]
  v_exp_f32 v87, v87
  v_mfma_f32_16x16x32_bf16 v[124:127], a[144:147], v[176:179], v[124:127]
  ds_read_b64_tr_b16 a[174:175], v217 offset:45056
  v_cvt_pk_bf16_f32 v83, v86, v87
  v_mfma_f32_16x16x32_bf16 a[192:195], a[208:211], v[0:3], a[192:195]
  v_exp_f32 v92, v92
  v_mfma_f32_16x16x32_bf16 a[192:195], a[208:211], v[32:35], a[192:195]
  ds_read_b64_tr_b16 a[176:177], v218 offset:32768
  ds_read_b64_tr_b16 a[234:235], v209 offset:5632
  v_mfma_f32_16x16x32_bf16 a[196:199], a[208:211], v[8:11], a[196:199]
  v_exp_f32 v93, v93
  v_mfma_f32_16x16x32_bf16 a[196:199], a[208:211], v[40:43], a[196:199]
  ds_read_b64_tr_b16 a[178:179], v218 offset:36864
  v_cvt_pk_bf16_f32 v90, v92, v93
  v_mfma_f32_16x16x32_bf16 a[200:203], a[208:211], v[16:19], a[200:203]
  v_exp_f32 v94, v94
  v_mfma_f32_16x16x32_bf16 a[200:203], a[208:211], v[48:51], a[200:203]
  ds_read_b64_tr_b16 a[180:181], v218 offset:40960
  v_mfma_f32_16x16x32_bf16 a[204:207], a[208:211], v[24:27], a[204:207]
  s_waitcnt lgkmcnt(9)
  v_exp_f32 v95, v95
  v_mfma_f32_16x16x32_bf16 a[204:207], a[208:211], v[56:59], a[204:207]
  ds_read_b64_tr_b16 a[182:183], v218 offset:45056
  v_cvt_pk_bf16_f32 v91, v94, v95
  v_mfma_f32_16x16x32_bf16 a[0:3], a[160:163], v[0:3], a[0:3]
  v_exp_f32 v96, v96
  v_mfma_f32_16x16x32_bf16 a[0:3], a[164:167], v[32:35], a[0:3]
  ds_read_b64_tr_b16 a[184:185], v219 offset:32768
  s_waitcnt lgkmcnt(4)
  buffer_store_dwordx4 a[232:235], v211, s[24:27], s31 offen sc1
  s_add_u32 s31, s31, 1024
  v_mfma_f32_16x16x32_bf16 a[4:7], a[164:167], v[40:43], a[4:7]
  v_exp_f32 v97, v97
  v_mfma_f32_16x16x32_bf16 a[4:7], a[160:163], v[8:11], a[4:7]
  ds_read_b64_tr_b16 a[186:187], v219 offset:36864
  v_cvt_pk_bf16_f32 v96, v96, v97
  v_mfma_f32_16x16x32_bf16 a[8:11], a[160:163], v[16:19], a[8:11]
  v_exp_f32 v98, v98
  v_mfma_f32_16x16x32_bf16 a[8:11], a[164:167], v[48:51], a[8:11]
  ds_read_b64_tr_b16 a[188:189], v219 offset:40960
  v_mfma_f32_16x16x32_bf16 a[12:15], a[164:167], v[56:59], a[12:15]
  v_exp_f32 v99, v99
  v_mfma_f32_16x16x32_bf16 a[12:15], a[160:163], v[24:27], a[12:15]
  ds_read_b64_tr_b16 a[190:191], v219 offset:45056
  v_cvt_pk_bf16_f32 v97, v98, v99
  v_mfma_f32_16x16x32_bf16 a[16:19], a[168:171], v[0:3], a[16:19]
  v_exp_f32 v104, v104
  v_mfma_f32_16x16x32_bf16 a[16:19], a[172:175], v[32:35], a[16:19]
  ds_read_b64_tr_b16 a[160:161], v220 offset:32768
  v_mfma_f32_16x16x32_bf16 a[20:23], a[172:175], v[40:43], a[20:23]
  v_exp_f32 v105, v105
  v_mfma_f32_16x16x32_bf16 a[20:23], a[168:171], v[8:11], a[20:23]
  ds_read_b64_tr_b16 a[162:163], v220 offset:36864
  v_cvt_pk_bf16_f32 v104, v104, v105
  v_mfma_f32_16x16x32_bf16 a[24:27], a[168:171], v[16:19], a[24:27]
  v_exp_f32 v106, v106
  v_mfma_f32_16x16x32_bf16 a[24:27], a[172:175], v[48:51], a[24:27]
  ds_read_b64_tr_b16 a[164:165], v220 offset:40960
  v_mfma_f32_16x16x32_bf16 a[28:31], a[172:175], v[56:59], a[28:31]
  s_waitcnt lgkmcnt(7)
  v_exp_f32 v107, v107
  v_mfma_f32_16x16x32_bf16 a[28:31], a[168:171], v[24:27], a[28:31]
  ds_read_b64_tr_b16 a[166:167], v220 offset:45056
  v_cvt_pk_bf16_f32 v105, v106, v107
  v_mfma_f32_16x16x32_bf16 a[32:35], a[176:179], v[0:3], a[32:35]
  v_exp_f32 v112, v112
  v_mfma_f32_16x16x32_bf16 a[32:35], a[180:183], v[32:35], a[32:35]
  ds_read_b64_tr_b16 a[168:169], v221 offset:32768
  v_mfma_f32_16x16x32_bf16 a[36:39], a[180:183], v[40:43], a[36:39]
  v_exp_f32 v113, v113
  v_mfma_f32_16x16x32_bf16 a[36:39], a[176:179], v[8:11], a[36:39]
  ds_read_b64_tr_b16 a[170:171], v221 offset:36864
  v_cvt_pk_bf16_f32 v112, v112, v113
  v_mfma_f32_16x16x32_bf16 a[40:43], a[176:179], v[16:19], a[40:43]
  v_exp_f32 v114, v114
  v_mfma_f32_16x16x32_bf16 a[40:43], a[180:183], v[48:51], a[40:43]
  ds_read_b64_tr_b16 a[172:173], v221 offset:40960
  v_mfma_f32_16x16x32_bf16 a[44:47], a[180:183], v[56:59], a[44:47]
  s_waitcnt lgkmcnt(7)
  v_exp_f32 v115, v115
  v_mfma_f32_16x16x32_bf16 a[44:47], a[176:179], v[24:27], a[44:47]
  ds_read_b64_tr_b16 a[174:175], v221 offset:45056
  v_cvt_pk_bf16_f32 v113, v114, v115
  v_mfma_f32_16x16x32_bf16 a[48:51], a[184:187], v[0:3], a[48:51]
  v_exp_f32 v120, v120
  v_mfma_f32_16x16x32_bf16 a[48:51], a[188:191], v[32:35], a[48:51]
  ds_read_b64_tr_b16 a[176:177], v222 offset:32768
  v_mfma_f32_16x16x32_bf16 a[52:55], a[188:191], v[40:43], a[52:55]
  v_exp_f32 v121, v121
  v_mfma_f32_16x16x32_bf16 a[52:55], a[184:187], v[8:11], a[52:55]
  ds_read_b64_tr_b16 a[178:179], v222 offset:36864
  v_cvt_pk_bf16_f32 v120, v120, v121
  v_mfma_f32_16x16x32_bf16 a[56:59], a[184:187], v[16:19], a[56:59]
  v_exp_f32 v122, v122
  v_mfma_f32_16x16x32_bf16 a[56:59], a[188:191], v[48:51], a[56:59]
  ds_read_b64_tr_b16 a[180:181], v222 offset:40960
  v_mfma_f32_16x16x32_bf16 a[60:63], a[188:191], v[56:59], a[60:63]
  s_waitcnt lgkmcnt(7)
  v_exp_f32 v123, v123
  v_mfma_f32_16x16x32_bf16 a[60:63], a[184:187], v[24:27], a[60:63]
  ds_read_b64_tr_b16 a[182:183], v222 offset:45056
  v_cvt_pk_bf16_f32 v121, v122, v123
  v_mfma_f32_16x16x32_bf16 a[64:67], a[160:163], v[0:3], a[64:67]
  v_exp_f32 v100, v100
  v_mfma_f32_16x16x32_bf16 a[64:67], a[164:167], v[32:35], a[64:67]
  ds_read_b64_tr_b16 a[184:185], v223 offset:32768
  v_mfma_f32_16x16x32_bf16 a[68:71], a[164:167], v[40:43], a[68:71]
  v_exp_f32 v101, v101
  v_mfma_f32_16x16x32_bf16 a[68:71], a[160:163], v[8:11], a[68:71]
  ds_read_b64_tr_b16 a[186:187], v223 offset:36864
  v_cvt_pk_bf16_f32 v98, v100, v101
  v_mfma_f32_16x16x32_bf16 a[72:75], a[160:163], v[16:19], a[72:75]
  v_exp_f32 v102, v102
  v_mfma_f32_16x16x32_bf16 a[72:75], a[164:167], v[48:51], a[72:75]
  ds_read_b64_tr_b16 a[188:189], v223 offset:40960
  v_mfma_f32_16x16x32_bf16 a[76:79], a[164:167], v[56:59], a[76:79]
  s_waitcnt lgkmcnt(7)
  v_exp_f32 v103, v103
  v_mfma_f32_16x16x32_bf16 a[76:79], a[160:163], v[24:27], a[76:79]
  ds_read_b64_tr_b16 a[190:191], v223 offset:45056
  v_cvt_pk_bf16_f32 v99, v102, v103
  v_mfma_f32_16x16x32_bf16 a[80:83], a[168:171], v[0:3], a[80:83]
  s_waitcnt vmcnt(12)
  v_exp_f32 v108, v108
  v_mfma_f32_16x16x32_bf16 a[80:83], a[172:175], v[32:35], a[80:83]
  v_mfma_f32_16x16x32_bf16 a[84:87], a[172:175], v[40:43], a[84:87]
  s_barrier
  v_exp_f32 v109, v109
  v_mfma_f32_16x16x32_bf16 a[84:87], a[168:171], v[8:11], a[84:87]
  ds_read_b128 a[128:131], v212 offset:0
  v_cvt_pk_bf16_f32 v106, v108, v109
  v_mfma_f32_16x16x32_bf16 a[88:91], a[168:171], v[16:19], a[88:91]
  v_exp_f32 v110, v110
  v_mfma_f32_16x16x32_bf16 a[88:91], a[172:175], v[48:51], a[88:91]
  ds_read_b128 a[132:135], v213 offset:0
  v_mfma_f32_16x16x32_bf16 a[92:95], a[172:175], v[56:59], a[92:95]
  s_waitcnt lgkmcnt(6)
  v_exp_f32 v111, v111
  v_mfma_f32_16x16x32_bf16 a[92:95], a[168:171], v[24:27], a[92:95]
  ds_read_b128 a[136:139], v214 offset:0
  v_cvt_pk_bf16_f32 v107, v110, v111
  v_mfma_f32_16x16x32_bf16 a[96:99], a[176:179], v[0:3], a[96:99]
  v_exp_f32 v116, v116
  v_mfma_f32_16x16x32_bf16 a[96:99], a[180:183], v[32:35], a[96:99]
  ds_read_b128 a[140:143], v215 offset:0
  v_mfma_f32_16x16x32_bf16 a[100:103], a[180:183], v[40:43], a[100:103]
  v_exp_f32 v117, v117
  v_mfma_f32_16x16x32_bf16 a[100:103], a[176:179], v[8:11], a[100:103]
  v_cvt_pk_bf16_f32 v114, v116, v117
  v_mfma_f32_16x16x32_bf16 a[104:107], a[176:179], v[16:19], a[104:107]
  v_exp_f32 v118, v118
  v_mfma_f32_16x16x32_bf16 a[104:107], a[180:183], v[48:51], a[104:107]
  v_mfma_f32_16x16x32_bf16 a[108:111], a[180:183], v[56:59], a[108:111]
  s_waitcnt lgkmcnt(4)
  v_exp_f32 v119, v119
  v_mfma_f32_16x16x32_bf16 a[108:111], a[176:179], v[24:27], a[108:111]
  v_cvt_pk_bf16_f32 v115, v118, v119
  v_mfma_f32_16x16x32_bf16 a[112:115], a[184:187], v[0:3], a[112:115]
  v_exp_f32 v124, v124
  v_mfma_f32_16x16x32_bf16 a[112:115], a[188:191], v[32:35], a[112:115]
  v_mfma_f32_16x16x32_bf16 a[116:119], a[188:191], v[40:43], a[116:119]
  s_sub_u32 s32, s32, 1
  v_exp_f32 v125, v125
  v_mfma_f32_16x16x32_bf16 a[116:119], a[184:187], v[8:11], a[116:119]
  v_cvt_pk_bf16_f32 v122, v124, v125
  v_mfma_f32_16x16x32_bf16 a[120:123], a[184:187], v[16:19], a[120:123]
  s_cmp_lg_u32 s32, 0
  v_exp_f32 v126, v126
  v_mfma_f32_16x16x32_bf16 a[120:123], a[188:191], v[48:51], a[120:123]
  v_mfma_f32_16x16x32_bf16 a[124:127], a[188:191], v[56:59], a[124:127]
  s_waitcnt lgkmcnt(0)
  v_exp_f32 v127, v127
  v_mfma_f32_16x16x32_bf16 a[124:127], a[184:187], v[24:27], a[124:127]
  v_cvt_pk_bf16_f32 v123, v126, v127
  s_cbranch_scc1 attn_loop
  s_waitcnt vmcnt(1)
  v_readfirstlane_b32 s38, v254
  s_nop 0
  s_cmp_ge_u32 s38, 512
  s_cbranch_scc1 attn_h_ready
  s_mov_b32 s39, 32768
attn_spin:
  s_sleep 4
  buffer_load_dword v254, off, s[24:27], s47 sc1
  s_waitcnt vmcnt(0)
  v_readfirstlane_b32 s38, v254
  s_nop 0
  s_cmp_ge_u32 s38, 512
  s_cbranch_scc1 attn_h_ready
  s_sub_u32 s39, s39, 1
  s_cmp_lg_u32 s39, 0
  s_cbranch_scc1 attn_spin
attn_h_ready:
  v_mfma_f32_16x16x32_bf16 v[0:3], a[128:131], v[128:131], v[192:195]
  s_add_u32 m0, s28, 81920
  s_and_b32 s38, s2, 1
  s_lshl_b32 s38, s38, 2
  v_lshrrev_b32 v224, 4, v242
  v_and_b32 v225, 7, v224
  v_mfma_f32_16x16x32_bf16 v[0:3], a[132:135], v[132:135], v[0:3]
  ds_read_b128 a[144:147], v212 offset:4096
  s_add_u32 s38, s38, s3
  s_mul_i32 s38, s38, 81920
  s_lshr_b32 s39, s2, 5
  v_mul_u32_u24 v225, 0xd80, v225
  v_mfma_f32_16x16x32_bf16 v[0:3], a[136:139], v[136:139], v[0:3]
  buffer_load_dwordx4 v236, s[16:19], s29 offen offset:0 lds
  s_mul_i32 s39, s39, 655360
  s_add_u32 s38, s38, s39
  s_add_u32 s4, s38, 3145728
  v_mfma_f32_16x16x32_bf16 v[0:3], a[140:143], v[140:143], v[0:3]
  ds_read_b128 a[148:151], v213 offset:4096
  s_add_u32 s5, s4, 12288
  s_add_u32 s6, s4, 24576
  s_add_u32 s7, s4, 36864
  v_lshrrev_b32 v224, 4, v224
  v_mfma_f32_16x16x32_bf16 v[8:11], a[140:143], v[156:159], v[196:199]
  s_add_u32 s8, s4, 49152
  s_add_u32 s9, s4, 61440
  s_add_u32 s10, s4, 73728
  v_lshl_add_u32 v225, v224, 4, v225
  v_add_u32 v252, 4096, v242
  v_mfma_f32_16x16x32_bf16 v[8:11], a[136:139], v[152:155], v[8:11]
  ds_read_b128 a[152:155], v214 offset:4096
  buffer_load_dwordx4 a[212:215], v225, s[24:27], s101 offen offset:0 sc1
  v_mfma_f32_16x16x32_bf16 v[8:11], a[132:135], v[148:151], v[8:11]
  buffer_load_dwordx4 v237, s[16:19], s29 offen offset:1024 lds
  v_mfma_f32_16x16x32_bf16 v[8:11], a[128:131], v[144:147], v[8:11]
  ds_read_b128 a[156:159], v215 offset:4096
  buffer_load_dwordx4 a[216:219], v225, s[24:27], s101 offen offset:64 sc1
  v_mfma_f32_16x16x32_bf16 v[16:19], a[128:131], v[160:163], v[200:203]
  v_exp_f32 v0, v0
  v_mfma_f32_16x16x32_bf16 v[16:19], a[132:135], v[164:167], v[16:19]
  buffer_load_dwordx4 a[220:223], v225, s[24:27], s101 offen offset:128 sc1
  v_mfma_f32_16x16x32_bf16 v[16:19], a[136:139], v[168:171], v[16:19]
  v_exp_f32 v1, v1
  v_mfma_f32_16x16x32_bf16 v[16:19], a[140:143], v[172:175], v[16:19]
  v_cvt_pk_bf16_f32 v0, v0, v1
  v_add_u32 v253, 8192, v242
  v_mfma_f32_16x16x32_bf16 v[24:27], a[140:143], v[188:191], v[204:207]
  v_exp_f32 v2, v2
  v_mfma_f32_16x16x32_bf16 v[24:27], a[136:139], v[184:187], v[24:27]
  buffer_load_dwordx4 v236, s[16:19], s29 offen offset:2048 lds
  v_mfma_f32_16x16x32_bf16 v[24:27], a[132:135], v[180:183], v[24:27]
  s_waitcnt lgkmcnt(0)
  v_exp_f32 v3, v3
  v_mfma_f32_16x16x32_bf16 v[24:27], a[128:131], v[176:179], v[24:27]
  v_cvt_pk_bf16_f32 v1, v2, v3
  v_mfma_f32_16x16x32_bf16 v[4:7], a[144:147], v[128:131], v[192:195]
  v_exp_f32 v8, v8
  v_mfma_f32_16x16x32_bf16 v[4:7], a[148:151], v[132:135], v[4:7]
  ds_read_b128 a[128:131], v212 offset:8192
  v_mfma_f32_16x16x32_bf16 v[4:7], a[152:155], v[136:139], v[4:7]
  v_exp_f32 v9, v9
  v_mfma_f32_16x16x32_bf16 v[4:7], a[156:159], v[140:143], v[4:7]
  ds_read_b128 a[132:135], v213 offset:8192
  v_cvt_pk_bf16_f32 v8, v8, v9
  v_mfma_f32_16x16x32_bf16 v[12:15], a[156:159], v[156:159], v[196:199]
  v_exp_f32 v10, v10
  v_mfma_f32_16x16x32_bf16 v[12:15], a[152:155], v[152:155], v[12:15]
  ds_read_b128 a[136:139], v214 offset:8192
  v_mfma_f32_16x16x32_bf16 v[12:15], a[148:151], v[148:151], v[12:15]
  v_exp_f32 v11, v11
  v_mfma_f32_16x16x32_bf16 v[12:15], a[144:147], v[144:147], v[12:15]
  ds_read_b128 a[140:143], v215 offset:8192
  v_cvt_pk_bf16_f32 v9, v10, v11
  v_mfma_f32_16x16x32_bf16 v[20:23], a[144:147], v[160:163], v[200:203]
  v_exp_f32 v16, v16
  v_mfma_f32_16x16x32_bf16 v[20:23], a[148:151], v[164:167], v[20:23]
  buffer_load_dwordx4 v237, s[16:19], s29 offen offset:3072 lds
  v_mfma_f32_16x16x32_bf16 v[20:23], a[152:155], v[168:171], v[20:23]
  s_add_u32 s29, s29, 16384
  v_exp_f32 v17, v17
  v_mfma_f32_16x16x32_bf16 v[20:23], a[156:159], v[172:175], v[20:23]
  v_cvt_pk_bf16_f32 v16, v16, v17
  v_mfma_f32_16x16x32_bf16 v[28:31], a[156:159], v[188:191], v[204:207]
  s_add_u32 m0, s28, 32768
  v_exp_f32 v18, v18
  v_mfma_f32_16x16x32_bf16 v[28:31], a[152:155], v[184:187], v[28:31]
  buffer_load_dwordx4 v232, s[12:15], s29 offen offset:0 lds
  v_mfma_f32_16x16x32_bf16 v[28:31], a[148:151], v[180:183], v[28:31]
  s_waitcnt lgkmcnt(0)
  v_exp_f32 v19, v19
  v_mfma_f32_16x16x32_bf16 v[28:31], a[144:147], v[176:179], v[28:31]
  v_cvt_pk_bf16_f32 v17, v18, v19
  v_mfma_f32_16x16x32_bf16 v[32:35], a[128:131], v[128:131], v[192:195]
  v_exp_f32 v24, v24
  v_mfma_f32_16x16x32_bf16 v[32:35], a[132:135], v[132:135], v[32:35]
  ds_read_b128 a[144:147], v212 offset:12288
  v_mfma_f32_16x16x32_bf16 v[32:35], a[136:139], v[136:139], v[32:35]
  v_exp_f32 v25, v25
  v_mfma_f32_16x16x32_bf16 v[32:35], a[140:143], v[140:143], v[32:35]
  ds_read_b128 a[148:151], v213 offset:12288
  v_cvt_pk_bf16_f32 v24, v24, v25
  v_mfma_f32_16x16x32_bf16 v[40:43], a[140:143], v[156:159], v[196:199]
  v_exp_f32 v26, v26
  v_mfma_f32_16x16x32_bf16 v[40:43], a[136:139], v[152:155], v[40:43]
  ds_read_b128 a[152:155], v214 offset:12288
  v_mfma_f32_16x16x32_bf16 v[40:43], a[132:135], v[148:151], v[40:43]
  v_exp_f32 v27, v27
  v_mfma_f32_16x16x32_bf16 v[40:43], a[128:131], v[144:147], v[40:43]
  ds_read_b128 a[156:159], v215 offset:12288
  v_cvt_pk_bf16_f32 v25, v26, v27
  v_mfma_f32_16x16x32_bf16 v[48:51], a[128:131], v[160:163], v[200:203]
  v_exp_f32 v4, v4
  v_mfma_f32_16x16x32_bf16 v[48:51], a[132:135], v[164:167], v[48:51]
  buffer_load_dwordx4 v233, s[12:15], s29 offen offset:1024 lds
  v_mfma_f32_16x16x32_bf16 v[48:51], a[136:139], v[168:171], v[48:51]
  v_exp_f32 v5, v5
  v_mfma_f32_16x16x32_bf16 v[48:51], a[140:143], v[172:175], v[48:51]
  v_cvt_pk_bf16_f32 v2, v4, v5
  v_mfma_f32_16x16x32_bf16 v[56:59], a[140:143], v[188:191], v[204:207]
  v_exp_f32 v6, v6
  v_mfma_f32_16x16x32_bf16 v[56:59], a[136:139], v[184:187], v[56:59]
  buffer_load_dwordx4 v234, s[12:15], s29 offen offset:2048 lds
  v_mfma_f32_16x16x32_bf16 v[56:59], a[132:135], v[180:183], v[56:59]
  s_waitcnt lgkmcnt(0)
  v_exp_f32 v7, v7
  v_mfma_f32_16x16x32_bf16 v[56:59], a[128:131], v[176:179], v[56:59]
  v_cvt_pk_bf16_f32 v3, v6, v7
  v_mfma_f32_16x16x32_bf16 v[36:39], a[144:147], v[128:131], v[192:195]
  v_exp_f32 v12, v12
  v_mfma_f32_16x16x32_bf16 v[36:39], a[148:151], v[132:135], v[36:39]
  ds_read_b64_tr_b16 a[160:161], v216 offset:49152
  v_mfma_f32_16x16x32_bf16 v[36:39], a[152:155], v[136:139], v[36:39]
  v_exp_f32 v13, v13
  v_mfma_f32_16x16x32_bf16 v[36:39], a[156:159], v[140:143], v[36:39]
  ds_read_b64_tr_b16 a[162:163], v216 offset:53248
  v_cvt_pk_bf16_f32 v10, v12, v13
  v_mfma_f32_16x16x32_bf16 v[44:47], a[156:159], v[156:159], v[196:199]
  v_exp_f32 v14, v14
  v_mfma_f32_16x16x32_bf16 v[44:47], a[152:155], v[152:155], v[44:47]
  ds_read_b64_tr_b16 a[164:165], v216 offset:57344
  buffer_load_dwordx4 v235, s[12:15], s29 offen offset:3072 lds
  v_mfma_f32_16x16x32_bf16 v[44:47], a[148:151], v[148:151], v[44:47]
  v_exp_f32 v15, v15
  v_mfma_f32_16x16x32_bf16 v[44:47], a[144:147], v[144:147], v[44:47]
  ds_read_b64_tr_b16 a[166:167], v216 offset:61440
  v_cvt_pk_bf16_f32 v11, v14, v15
  v_mfma_f32_16x16x32_bf16 v[52:55], a[144:147], v[160:163], v[200:203]
  v_exp_f32 v20, v20
  v_mfma_f32_16x16x32_bf16 v[52:55], a[148:151], v[164:167], v[52:55]
  ds_read_b64_tr_b16 a[168:169], v217 offset:49152
  v_mfma_f32_16x16x32_bf16 v[52:55], a[152:155], v[168:171], v[52:55]
  v_exp_f32 v21, v21
  v_mfma_f32_16x16x32_bf16 v[52:55], a[156:159], v[172:175], v[52:55]
  ds_read_b64_tr_b16 a[170:171], v217 offset:53248
  v_cvt_pk_bf16_f32 v18, v20, v21
  v_mfma_f32_16x16x32_bf16 v[60:63], a[156:159], v[188:191], v[204:207]
  v_exp_f32 v22, v22
  v_mfma_f32_16x16x32_bf16 v[60:63], a[152:155], v[184:187], v[60:63]
  ds_read_b64_tr_b16 a[172:173], v217 offset:57344
  v_mfma_f32_16x16x32_bf16 v[60:63], a[148:151], v[180:183], v[60:63]
  v_exp_f32 v23, v23
  v_mfma_f32_16x16x32_bf16 v[60:63], a[144:147], v[176:179], v[60:63]
  ds_read_b64_tr_b16 a[174:175], v217 offset:61440
  v_cvt_pk_bf16_f32 v19, v22, v23
  v_mfma_f32_16x16x32_bf16 a[192:195], a[208:211], v[64:67], a[192:195]
  v_exp_f32 v28, v28
  v_mfma_f32_16x16x32_bf16 a[192:195], a[208:211], v[96:99], a[192:195]
  ds_read_b64_tr_b16 a[176:177], v218 offset:49152
  v_mfma_f32_16x16x32_bf16 a[196:199], a[208:211], v[72:75], a[196:199]
  v_exp_f32 v29, v29
  v_mfma_f32_16x16x32_bf16 a[196:199], a[208:211], v[104:107], a[196:199]
  ds_read_b64_tr_b16 a[178:179], v218 offset:53248
  v_cvt_pk_bf16_f32 v26, v28, v29
  v_mfma_f32_16x16x32_bf16 a[200:203], a[208:211], v[80:83], a[200:203]
  v_exp_f32 v30, v30
  v_mfma_f32_16x16x32_bf16 a[200:203], a[208:211], v[112:115], a[200:203]
  ds_read_b64_tr_b16 a[180:181], v218 offset:57344
  v_mfma_f32_16x16x32_bf16 a[204:207], a[208:211], v[88:91], a[204:207]
  s_waitcnt lgkmcnt(7)
  v_exp_f32 v31, v31
  v_mfma_f32_16x16x32_bf16 a[204:207], a[208:211], v[120:123], a[204:207]
  ds_read_b64_tr_b16 a[182:183], v218 offset:61440
  v_cvt_pk_bf16_f32 v27, v30, v31
  v_mfma_f32_16x16x32_bf16 a[0:3], a[160:163], v[64:67], a[0:3]
  v_exp_f32 v32, v32
  v_mfma_f32_16x16x32_bf16 a[0:3], a[164:167], v[96:99], a[0:3]
  ds_read_b64_tr_b16 a[184:185], v219 offset:49152
  v_mfma_f32_16x16x32_bf16 a[4:7], a[164:167], v[104:107], a[4:7]
  v_exp_f32 v33, v33
  v_mfma_f32_16x16x32_bf16 a[4:7], a[160:163], v[72:75], a[4:7]
  ds_read_b64_tr_b16 a[186:187], v219 offset:53248
  v_cvt_pk_bf16_f32 v32, v32, v33
  v_mfma_f32_16x16x32_bf16 a[8:11], a[160:163], v[80:83], a[8:11]
  v_exp_f32 v34, v34
  v_mfma_f32_16x16x32_bf16 a[8:11], a[164:167], v[112:115], a[8:11]
  ds_read_b64_tr_b16 a[188:189], v219 offset:57344
  v_mfma_f32_16x16x32_bf16 a[12:15], a[164:167], v[120:123], a[12:15]
  s_waitcnt lgkmcnt(7)
  v_exp_f32 v35, v35
  v_mfma_f32_16x16x32_bf16 a[12:15], a[160:163], v[88:91], a[12:15]
  ds_read_b64_tr_b16 a[190:191], v219 offset:61440
  v_cvt_pk_bf16_f32 v33, v34, v35
  v_mfma_f32_16x16x32_bf16 a[16:19], a[168:171], v[64:67], a[16:19]
  v_exp_f32 v40, v40
  v_mfma_f32_16x16x32_bf16 a[16:19], a[172:175], v[96:99], a[16:19]
  ds_read_b64_tr_b16 a[160:161], v220 offset:49152
  v_mfma_f32_16x16x32_bf16 a[20:23], a[172:175], v[104:107], a[20:23]
  v_exp_f32 v41, v41
  v_mfma_f32_16x16x32_bf16 a[20:23], a[168:171], v[72:75], a[20:23]
  ds_read_b64_tr_b16 a[162:163], v220 offset:53248
  v_cvt_pk_bf16_f32 v40, v40, v41
  v_mfma_f32_16x16x32_bf16 a[24:27], a[168:171], v[80:83], a[24:27]
  v_exp_f32 v42, v42
  v_mfma_f32_16x16x32_bf16 a[24:27], a[172:175], v[112:115], a[24:27]
  ds_read_b64_tr_b16 a[164:165], v220 offset:57344
  v_mfma_f32_16x16x32_bf16 a[28:31], a[172:175], v[120:123], a[28:31]
  s_waitcnt lgkmcnt(7)
  v_exp_f32 v43, v43
  v_mfma_f32_16x16x32_bf16 a[28:31], a[168:171], v[88:91], a[28:31]
  ds_read_b64_tr_b16 a[166:167], v220 offset:61440
  v_cvt_pk_bf16_f32 v41, v42, v43
  v_mfma_f32_16x16x32_bf16 a[32:35], a[176:179], v[64:67], a[32:35]
  v_exp_f32 v48, v48
  v_mfma_f32_16x16x32_bf16 a[32:35], a[180:183], v[96:99], a[32:35]
  ds_read_b64_tr_b16 a[168:169], v221 offset:49152
  v_mfma_f32_16x16x32_bf16 a[36:39], a[180:183], v[104:107], a[36:39]
  v_exp_f32 v49, v49
  v_mfma_f32_16x16x32_bf16 a[36:39], a[176:179], v[72:75], a[36:39]
  ds_read_b64_tr_b16 a[170:171], v221 offset:53248
  v_cvt_pk_bf16_f32 v48, v48, v49
  v_mfma_f32_16x16x32_bf16 a[40:43], a[176:179], v[80:83], a[40:43]
  v_exp_f32 v50, v50
  v_mfma_f32_16x16x32_bf16 a[40:43], a[180:183], v[112:115], a[40:43]
  ds_read_b64_tr_b16 a[172:173], v221 offset:57344
  v_mfma_f32_16x16x32_bf16 a[44:47], a[180:183], v[120:123], a[44:47]
  s_waitcnt lgkmcnt(7)
  v_exp_f32 v51, v51
  v_mfma_f32_16x16x32_bf16 a[44:47], a[176:179], v[88:91], a[44:47]
  ds_read_b64_tr_b16 a[174:175], v221 offset:61440
  v_cvt_pk_bf16_f32 v49, v50, v51
  v_mfma_f32_16x16x32_bf16 a[48:51], a[184:187], v[64:67], a[48:51]
  v_exp_f32 v56, v56
  v_mfma_f32_16x16x32_bf16 a[48:51], a[188:191], v[96:99], a[48:51]
  ds_read_b64_tr_b16 a[176:177], v222 offset:49152
  v_mfma_f32_16x16x32_bf16 a[52:55], a[188:191], v[104:107], a[52:55]
  v_exp_f32 v57, v57
  v_mfma_f32_16x16x32_bf16 a[52:55], a[184:187], v[72:75], a[52:55]
  ds_read_b64_tr_b16 a[178:179], v222 offset:53248
  v_cvt_pk_bf16_f32 v56, v56, v57
  v_mfma_f32_16x16x32_bf16 a[56:59], a[184:187], v[80:83], a[56:59]
  v_exp_f32 v58, v58
  v_mfma_f32_16x16x32_bf16 a[56:59], a[188:191], v[112:115], a[56:59]
  ds_read_b64_tr_b16 a[180:181], v222 offset:57344
  v_mfma_f32_16x16x32_bf16 a[60:63], a[188:191], v[120:123], a[60:63]
  s_waitcnt lgkmcnt(7)
  v_exp_f32 v59, v59
  v_mfma_f32_16x16x32_bf16 a[60:63], a[184:187], v[88:91], a[60:63]
  ds_read_b64_tr_b16 a[182:183], v222 offset:61440
  v_cvt_pk_bf16_f32 v57, v58, v59
  v_mfma_f32_16x16x32_bf16 a[64:67], a[160:163], v[64:67], a[64:67]
  v_exp_f32 v36, v36
  v_mfma_f32_16x16x32_bf16 a[64:67], a[164:167], v[96:99], a[64:67]
  ds_read_b64_tr_b16 a[184:185], v223 offset:49152
  v_mfma_f32_16x16x32_bf16 a[68:71], a[164:167], v[104:107], a[68:71]
  v_exp_f32 v37, v37
  v_mfma_f32_16x16x32_bf16 a[68:71], a[160:163], v[72:75], a[68:71]
  ds_read_b64_tr_b16 a[186:187], v223 offset:53248
  v_cvt_pk_bf16_f32 v34, v36, v37
  v_mfma_f32_16x16x32_bf16 a[72:75], a[160:163], v[80:83], a[72:75]
  v_exp_f32 v38, v38
  v_mfma_f32_16x16x32_bf16 a[72:75], a[164:167], v[112:115], a[72:75]
  ds_read_b64_tr_b16 a[188:189], v223 offset:57344
  v_mfma_f32_16x16x32_bf16 a[76:79], a[164:167], v[120:123], a[76:79]
  s_waitcnt lgkmcnt(7)
  v_exp_f32 v39, v39
  v_mfma_f32_16x16x32_bf16 a[76:79], a[160:163], v[88:91], a[76:79]
  ds_read_b64_tr_b16 a[190:191], v223 offset:61440
  v_cvt_pk_bf16_f32 v35, v38, v39
  v_mfma_f32_16x16x32_bf16 a[80:83], a[168:171], v[64:67], a[80:83]
  v_exp_f32 v44, v44
  v_mfma_f32_16x16x32_bf16 a[80:83], a[172:175], v[96:99], a[80:83]
  v_mfma_f32_16x16x32_bf16 a[84:87], a[172:175], v[104:107], a[84:87]
  s_barrier
  v_exp_f32 v45, v45
  v_mfma_f32_16x16x32_bf16 a[84:87], a[168:171], v[72:75], a[84:87]
  ds_read_b128 a[128:131], v212 offset:16384
  v_cvt_pk_bf16_f32 v42, v44, v45
  v_mfma_f32_16x16x32_bf16 a[88:91], a[168:171], v[80:83], a[88:91]
  v_exp_f32 v46, v46
  v_mfma_f32_16x16x32_bf16 a[88:91], a[172:175], v[112:115], a[88:91]
  ds_read_b128 a[132:135], v213 offset:16384
  v_mfma_f32_16x16x32_bf16 a[92:95], a[172:175], v[120:123], a[92:95]
  s_waitcnt lgkmcnt(6)
  v_exp_f32 v47, v47
  v_mfma_f32_16x16x32_bf16 a[92:95], a[168:171], v[88:91], a[92:95]
  ds_read_b128 a[136:139], v214 offset:16384
  v_cvt_pk_bf16_f32 v43, v46, v47
  v_mfma_f32_16x16x32_bf16 a[96:99], a[176:179], v[64:67], a[96:99]
  v_exp_f32 v52, v52
  v_mfma_f32_16x16x32_bf16 a[96:99], a[180:183], v[96:99], a[96:99]
  ds_read_b128 a[140:143], v215 offset:16384
  v_mfma_f32_16x16x32_bf16 a[100:103], a[180:183], v[104:107], a[100:103]
  v_exp_f32 v53, v53
  v_mfma_f32_16x16x32_bf16 a[100:103], a[176:179], v[72:75], a[100:103]
  v_cvt_pk_bf16_f32 v50, v52, v53
  v_mfma_f32_16x16x32_bf16 a[104:107], a[176:179], v[80:83], a[104:107]
  v_exp_f32 v54, v54
  v_mfma_f32_16x16x32_bf16 a[104:107], a[180:183], v[112:115], a[104:107]
  v_mfma_f32_16x16x32_bf16 a[108:111], a[180:183], v[120:123], a[108:111]
  s_waitcnt lgkmcnt(4)
  v_exp_f32 v55, v55
  v_mfma_f32_16x16x32_bf16 a[108:111], a[176:179], v[88:91], a[108:111]
  v_cvt_pk_bf16_f32 v51, v54, v55
  v_mfma_f32_16x16x32_bf16 a[112:115], a[184:187], v[64:67], a[112:115]
  v_exp_f32 v60, v60
  v_mfma_f32_16x16x32_bf16 a[112:115], a[188:191], v[96:99], a[112:115]
  v_mfma_f32_16x16x32_bf16 a[116:119], a[188:191], v[104:107], a[116:119]
  v_exp_f32 v61, v61
  v_mfma_f32_16x16x32_bf16 a[116:119], a[184:187], v[72:75], a[116:119]
  v_cvt_pk_bf16_f32 v58, v60, v61
  v_mfma_f32_16x16x32_bf16 a[120:123], a[184:187], v[80:83], a[120:123]
  v_exp_f32 v62, v62
  v_mfma_f32_16x16x32_bf16 a[120:123], a[188:191], v[112:115], a[120:123]
  v_mfma_f32_16x16x32_bf16 a[124:127], a[188:191], v[120:123], a[124:127]
  s_waitcnt lgkmcnt(0)
  v_exp_f32 v63, v63
  v_mfma_f32_16x16x32_bf16 a[124:127], a[184:187], v[88:91], a[124:127]
  v_cvt_pk_bf16_f32 v59, v62, v63
  v_mfma_f32_16x16x32_bf16 v[64:67], a[128:131], v[128:131], v[192:195]
  s_add_u32 m0, s28, 98304
  v_mfma_f32_16x16x32_bf16 v[64:67], a[132:135], v[132:135], v[64:67]
  ds_read_b128 a[144:147], v212 offset:20480
  v_mfma_f32_16x16x32_bf16 v[64:67], a[136:139], v[136:139], v[64:67]
  buffer_load_dwordx4 v236, s[16:19], s29 offen offset:0 lds
  v_mfma_f32_16x16x32_bf16 v[64:67], a[140:143], v[140:143], v[64:67]
  ds_read_b128 a[148:151], v213 offset:20480
  v_mfma_f32_16x16x32_bf16 v[72:75], a[140:143], v[156:159], v[196:199]
  v_mfma_f32_16x16x32_bf16 v[72:75], a[136:139], v[152:155], v[72:75]
  ds_read_b128 a[152:155], v214 offset:20480
  v_mfma_f32_16x16x32_bf16 v[72:75], a[132:135], v[148:151], v[72:75]
  buffer_load_dwordx4 v237, s[16:19], s29 offen offset:1024 lds
  v_mfma_f32_16x16x32_bf16 v[72:75], a[128:131], v[144:147], v[72:75]
  ds_read_b128 a[156:159], v215 offset:20480
  v_mfma_f32_16x16x32_bf16 v[80:83], a[128:131], v[160:163], v[200:203]
  v_exp_f32 v64, v64
  v_mfma_f32_16x16x32_bf16 v[80:83], a[132:135], v[164:167], v[80:83]
  v_mfma_f32_16x16x32_bf16 v[80:83], a[136:139], v[168:171], v[80:83]
  v_exp_f32 v65, v65
  v_mfma_f32_16x16x32_bf16 v[80:83], a[140:143], v[172:175], v[80:83]
  v_cvt_pk_bf16_f32 v64, v64, v65
  v_mfma_f32_16x16x32_bf16 v[88:91], a[140:143], v[188:191], v[204:207]
  v_exp_f32 v66, v66
  v_mfma_f32_16x16x32_bf16 v[88:91], a[136:139], v[184:187], v[88:91]
  buffer_load_dwordx4 v236, s[16:19], s29 offen offset:2048 lds
  v_mfma_f32_16x16x32_bf16 v[88:91], a[132:135], v[180:183], v[88:91]
  s_waitcnt lgkmcnt(0)
  v_exp_f32 v67, v67
  v_mfma_f32_16x16x32_bf16 v[88:91], a[128:131], v[176:179], v[88:91]
  v_cvt_pk_bf16_f32 v65, v66, v67
  v_mfma_f32_16x16x32_bf16 v[68:71], a[144:147], v[128:131], v[192:195]
  v_exp_f32 v72, v72
  v_mfma_f32_16x16x32_bf16 v[68:71], a[148:151], v[132:135], v[68:71]
  ds_read_b128 a[128:131], v212 offset:24576
  v_mfma_f32_16x16x32_bf16 v[68:71], a[152:155], v[136:139], v[68:71]
  v_exp_f32 v73, v73
  v_mfma_f32_16x16x32_bf16 v[68:71], a[156:159], v[140:143], v[68:71]
  ds_read_b128 a[132:135], v213 offset:24576
  v_cvt_pk_bf16_f32 v72, v72, v73
  v_mfma_f32_16x16x32_bf16 v[76:79], a[156:159], v[156:159], v[196:199]
  v_exp_f32 v74, v74
  v_mfma_f32_16x16x32_bf16 v[76:79], a[152:155], v[152:155], v[76:79]
  ds_read_b128 a[136:139], v214 offset:24576
  v_lshrrev_b32 v224, 4, v242
  v_mfma_f32_16x16x32_bf16 v[76:79], a[148:151], v[148:151], v[76:79]
  v_exp_f32 v75, v75
  v_mfma_f32_16x16x32_bf16 v[76:79], a[144:147], v[144:147], v[76:79]
  ds_read_b128 a[140:143], v215 offset:24576
  v_cvt_pk_bf16_f32 v73, v74, v75
  v_mfma_f32_16x16x32_bf16 v[84:87], a[144:147], v[160:163], v[200:203]
  v_exp_f32 v80, v80
  v_mfma_f32_16x16x32_bf16 v[84:87], a[148:151], v[164:167], v[84:87]
  buffer_load_dwordx4 v237, s[16:19], s29 offen offset:3072 lds
  v_mfma_f32_16x16x32_bf16 v[84:87], a[152:155], v[168:171], v[84:87]
  s_add_u32 s29, s29, 16384
  v_exp_f32 v81, v81
  v_mfma_f32_16x16x32_bf16 v[84:87], a[156:159], v[172:175], v[84:87]
  v_cvt_pk_bf16_f32 v80, v80, v81
  v_lshrrev_b32 v225, 4, v224
  v_mfma_f32_16x16x32_bf16 v[92:95], a[156:159], v[188:191], v[204:207]
  s_add_u32 m0, s28, 49152
  v_exp_f32 v82, v82
  v_mfma_f32_16x16x32_bf16 v[92:95], a[152:155], v[184:187], v[92:95]
  buffer_load_dwordx4 v232, s[12:15], s29 offen offset:0 lds
  v_mfma_f32_16x16x32_bf16 v[92:95], a[148:151], v[180:183], v[92:95]
  s_waitcnt lgkmcnt(0)
  v_exp_f32 v83, v83
  v_mfma_f32_16x16x32_bf16 v[92:95], a[144:147], v[176:179], v[92:95]
  v_cvt_pk_bf16_f32 v81, v82, v83
  v_bfe_u32 v226, v224, 2, 2
  v_mfma_f32_16x16x32_bf16 v[96:99], a[128:131], v[128:131], v[192:195]
  v_exp_f32 v88, v88
  v_mfma_f32_16x16x32_bf16 v[96:99], a[132:135], v[132:135], v[96:99]
  ds_read_b128 a[144:147], v212 offset:28672
  v_lshl_add_u32 v225, v225, 3, v226
  v_mfma_f32_16x16x32_bf16 v[96:99], a[136:139], v[136:139], v[96:99]
  v_exp_f32 v89, v89
  v_mfma_f32_16x16x32_bf16 v[96:99], a[140:143], v[140:143], v[96:99]
  ds_read_b128 a[148:151], v213 offset:28672
  v_cvt_pk_bf16_f32 v88, v88, v89
  v_mfma_f32_16x16x32_bf16 v[104:107], a[140:143], v[156:159], v[196:199]
  v_exp_f32 v90, v90
  v_mfma_f32_16x16x32_bf16 v[104:107], a[136:139], v[152:155], v[104:107]
  ds_read_b128 a[152:155], v214 offset:28672
  v_lshlrev_b32 v225, 5, v225
  v_mfma_f32_16x16x32_bf16 v[104:107], a[132:135], v[148:151], v[104:107]
  v_exp_f32 v91, v91
  v_mfma_f32_16x16x32_bf16 v[104:107], a[128:131], v[144:147], v[104:107]
  ds_read_b128 a[156:159], v215 offset:28672
  v_cvt_pk_bf16_f32 v89, v90, v91
  v_mfma_f32_16x16x32_bf16 v[112:115], a[128:131], v[160:163], v[200:203]
  v_exp_f32 v68, v68
  v_mfma_f32_16x16x32_bf16 v[112:115], a[132:135], v[164:167], v[112:115]
  buffer_load_dwordx4 v233, s[12:15], s29 offen offset:1024 lds
  v_mfma_f32_16x16x32_bf16 v[112:115], a[136:139], v[168:171], v[112:115]
  v_exp_f32 v69, v69
  v_mfma_f32_16x16x32_bf16 v[112:115], a[140:143], v[172:175], v[112:115]
  v_cvt_pk_bf16_f32 v66, v68, v69
  v_and_b32 v226, 3, v224
  v_mfma_f32_16x16x32_bf16 v[120:123], a[140:143], v[188:191], v[204:207]
  v_exp_f32 v70, v70
  v_mfma_f32_16x16x32_bf16 v[120:123], a[136:139], v[184:187], v[120:123]
  buffer_load_dwordx4 v234, s[12:15], s29 offen offset:2048 lds
  v_mfma_f32_16x16x32_bf16 v[120:123], a[132:135], v[180:183], v[120:123]
  s_waitcnt lgkmcnt(0)
  v_exp_f32 v71, v71
  v_mfma_f32_16x16x32_bf16 v[120:123], a[128:131], v[176:179], v[120:123]
  v_cvt_pk_bf16_f32 v67, v70, v71
  v_lshl_add_u32 v225, v226, 3, v225
  v_mfma_f32_16x16x32_bf16 v[100:103], a[144:147], v[128:131], v[192:195]
  v_exp_f32 v76, v76
  v_mfma_f32_16x16x32_bf16 v[100:103], a[148:151], v[132:135], v[100:103]
  ds_read_b64_tr_b16 a[160:161], v216 offset:0
  v_add_u32 v225, s50, v225
  v_mfma_f32_16x16x32_bf16 v[100:103], a[152:155], v[136:139], v[100:103]
  s_waitcnt vmcnt(13)
  v_exp_f32 v77, v77
  v_mfma_f32_16x16x32_bf16 v[100:103], a[156:159], v[140:143], v[100:103]
  ds_read_b64_tr_b16 a[162:163], v216 offset:4096
  v_cvt_pk_bf16_f32 v74, v76, v77
  v_mfma_f32_16x16x32_bf16 v[108:111], a[156:159], v[156:159], v[196:199]
  v_exp_f32 v78, v78
  v_mfma_f32_16x16x32_bf16 v[108:111], a[152:155], v[152:155], v[108:111]
  ds_read_b64_tr_b16 a[164:165], v216 offset:8192
  buffer_load_dwordx4 v235, s[12:15], s29 offen offset:3072 lds
  v_mfma_f32_16x16x32_bf16 v[108:111], a[148:151], v[148:151], v[108:111]
  v_exp_f32 v79, v79
  v_mfma_f32_16x16x32_bf16 v[108:111], a[144:147], v[144:147], v[108:111]
  ds_read_b64_tr_b16 a[166:167], v216 offset:12288
  v_cvt_pk_bf16_f32 v75, v78, v79
  v_mfma_f32_16x16x32_bf16 v[116:119], a[144:147], v[160:163], v[200:203]
  v_exp_f32 v84, v84
  v_mfma_f32_16x16x32_bf16 v[116:119], a[148:151], v[164:167], v[116:119]
  ds_read_b64_tr_b16 a[168:169], v217 offset:0
  ds_read_b64_tr_b16 a[232:233], v225 offset:0
  s_add_u32 m0, s28, 0
  v_mfma_f32_16x16x32_bf16 v[116:119], a[152:155], v[168:171], v[116:119]
  v_exp_f32 v85, v85
  v_mfma_f32_16x16x32_bf16 v[116:119], a[156:159], v[172:175], v[116:119]
  ds_read_b64_tr_b16 a[170:171], v217 offset:4096
  v_cvt_pk_bf16_f32 v82, v84, v85
  v_mfma_f32_16x16x32_bf16 v[124:127], a[156:159], v[188:191], v[204:207]
  v_exp_f32 v86, v86
  v_mfma_f32_16x16x32_bf16 v[124:127], a[152:155], v[184:187], v[124:127]
  ds_read_b64_tr_b16 a[172:173], v217 offset:8192
  ds_read_b64_tr_b16 a[234:235], v225 offset:128
  v_mfma_f32_16x16x32_bf16 v[124:127], a[148:151], v[180:183], v[124:127]
  v_exp_f32 v87, v87
  v_mfma_f32_16x16x32_bf16 v[124:127], a[144:147], v[176:179], v[124:127]
  ds_read_b64_tr_b16 a[174:175], v217 offset:12288
  v_cvt_pk_bf16_f32 v83, v86, v87
  v_mfma_f32_16x16x32_bf16 a[192:195], a[208:211], v[0:3], a[192:195]
  v_exp_f32 v92, v92
  v_mfma_f32_16x16x32_bf16 a[192:195], a[208:211], v[32:35], a[192:195]
  ds_read_b64_tr_b16 a[176:177], v218 offset:0
  ds_read_b64_tr_b16 a[236:237], v225 offset:1024
  v_mfma_f32_16x16x32_bf16 a[196:199], a[208:211], v[8:11], a[196:199]
  v_exp_f32 v93, v93
  v_mfma_f32_16x16x32_bf16 a[196:199], a[208:211], v[40:43], a[196:199]
  ds_read_b64_tr_b16 a[178:179], v218 offset:4096
  v_cvt_pk_bf16_f32 v90, v92, v93
  v_mfma_f32_16x16x32_bf16 a[200:203], a[208:211], v[16:19], a[200:203]
  v_exp_f32 v94, v94
  v_mfma_f32_16x16x32_bf16 a[200:203], a[208:211], v[48:51], a[200:203]
  ds_read_b64_tr_b16 a[180:181], v218 offset:8192
  ds_read_b64_tr_b16 a[238:239], v225 offset:1152
  v_mfma_f32_16x16x32_bf16 a[204:207], a[208:211], v[24:27], a[204:207]
  s_waitcnt lgkmcnt(11)
  v_exp_f32 v95, v95
  v_mfma_f32_16x16x32_bf16 a[204:207], a[208:211], v[56:59], a[204:207]
  ds_read_b64_tr_b16 a[182:183], v218 offset:12288
  v_cvt_pk_bf16_f32 v91, v94, v95
  v_mfma_f32_16x16x32_bf16 a[0:3], a[160:163], v[0:3], a[0:3]
  v_exp_f32 v96, v96
  v_mfma_f32_16x16x32_bf16 a[0:3], a[164:167], v[32:35], a[0:3]
  ds_read_b64_tr_b16 a[184:185], v219 offset:0
  ds_read_b64_tr_b16 a[240:241], v225 offset:2048
  v_mfma_f32_16x16x32_bf16 a[4:7], a[164:167], v[40:43], a[4:7]
  v_exp_f32 v97, v97
  v_mfma_f32_16x16x32_bf16 a[4:7], a[160:163], v[8:11], a[4:7]
  ds_read_b64_tr_b16 a[186:187], v219 offset:4096
  v_cvt_pk_bf16_f32 v96, v96, v97
  v_mfma_f32_16x16x32_bf16 a[8:11], a[160:163], v[16:19], a[8:11]
  v_exp_f32 v98, v98
  v_mfma_f32_16x16x32_bf16 a[8:11], a[164:167], v[48:51], a[8:11]
  ds_read_b64_tr_b16 a[188:189], v219 offset:8192
  ds_read_b64_tr_b16 a[242:243], v225 offset:2176
  v_mfma_f32_16x16x32_bf16 a[12:15], a[164:167], v[56:59], a[12:15]
  s_waitcnt lgkmcnt(11)
  v_exp_f32 v99, v99
  v_mfma_f32_16x16x32_bf16 a[12:15], a[160:163], v[24:27], a[12:15]
  ds_read_b64_tr_b16 a[190:191], v219 offset:12288
  v_cvt_pk_bf16_f32 v97, v98, v99
  v_mfma_f32_16x16x32_bf16 a[16:19], a[168:171], v[0:3], a[16:19]
  v_exp_f32 v104, v104
  v_mfma_f32_16x16x32_bf16 a[16:19], a[172:175], v[32:35], a[16:19]
  ds_read_b64_tr_b16 a[160:161], v220 offset:0
  buffer_load_dwordx4 v253, s[24:27], s8 offen offset:0 sc1 lds
  v_mfma_f32_16x16x32_bf16 a[20:23], a[172:175], v[40:43], a[20:23]
  v_exp_f32 v105, v105
  v_mfma_f32_16x16x32_bf16 a[20:23], a[168:171], v[8:11], a[20:23]
  ds_read_b64_tr_b16 a[162:163], v220 offset:4096
  v_cvt_pk_bf16_f32 v104, v104, v105
  v_mfma_f32_16x16x32_bf16 a[24:27], a[168:171], v[16:19], a[24:27]
  v_exp_f32 v106, v106
  v_mfma_f32_16x16x32_bf16 a[24:27], a[172:175], v[48:51], a[24:27]
  ds_read_b64_tr_b16 a[164:165], v220 offset:8192
  s_waitcnt lgkmcnt(4)
  buffer_load_dwordx4 v253, s[24:27], s8 offen offset:1024 sc1 lds
  v_mfma_f32_16x16x32_bf16 v[228:231], a[232:235], a[212:215], 0
  v_mfma_f32_16x16x32_bf16 v[228:231], a[236:239], a[216:219], v[228:231]
  v_mfma_f32_16x16x32_bf16 v[228:231], a[240:243], a[220:223], v[228:231]
  v_mfma_f32_16x16x32_bf16 a[28:31], a[172:175], v[56:59], a[28:31]
  s_lshl_b32 s35, s3, 10
  s_add_u32 s35, s35, 159744
  v_exp_f32 v107, v107
  v_mfma_f32_16x16x32_bf16 a[28:31], a[168:171], v[24:27], a[28:31]
  ds_read_b64_tr_b16 a[166:167], v220 offset:12288
  v_cvt_pk_bf16_f32 v105, v106, v107
  v_mfma_f32_16x16x32_bf16 a[32:35], a[176:179], v[0:3], a[32:35]
  v_exp_f32 v112, v112
  v_mfma_f32_16x16x32_bf16 a[32:35], a[180:183], v[32:35], a[32:35]
  ds_read_b64_tr_b16 a[168:169], v221 offset:0
  buffer_load_dwordx4 v253, s[24:27], s8 offen offset:2048 sc1 lds
  v_mfma_f32_16x16x32_bf16 a[36:39], a[180:183], v[40:43], a[36:39]
  v_exp_f32 v113, v113
  v_mfma_f32_16x16x32_bf16 a[36:39], a[176:179], v[8:11], a[36:39]
  ds_read_b64_tr_b16 a[170:171], v221 offset:4096
  v_cvt_pk_bf16_f32 v112, v112, v113
  v_mfma_f32_16x16x32_bf16 a[40:43], a[176:179], v[16:19], a[40:43]
  v_exp_f32 v114, v114
  v_mfma_f32_16x16x32_bf16 a[40:43], a[180:183], v[48:51], a[40:43]
  ds_read_b64_tr_b16 a[172:173], v221 offset:8192
  buffer_load_dwordx4 v253, s[24:27], s8 offen offset:3072 sc1 lds
  v_mfma_f32_16x16x32_bf16 a[44:47], a[180:183], v[56:59], a[44:47]
  s_waitcnt lgkmcnt(7)
  v_exp_f32 v115, v115
  v_mfma_f32_16x16x32_bf16 a[44:47], a[176:179], v[24:27], a[44:47]
  ds_read_b64_tr_b16 a[174:175], v221 offset:12288
  v_cvt_pk_bf16_f32 v113, v114, v115
  v_mfma_f32_16x16x32_bf16 a[48:51], a[184:187], v[0:3], a[48:51]
  v_exp_f32 v120, v120
  v_mfma_f32_16x16x32_bf16 a[48:51], a[188:191], v[32:35], a[48:51]
  ds_read_b64_tr_b16 a[176:177], v222 offset:0
  v_add_u32 v224, s35, v242
  v_mfma_f32_16x16x32_bf16 a[52:55], a[188:191], v[40:43], a[52:55]
  v_exp_f32 v121, v121
  v_mfma_f32_16x16x32_bf16 a[52:55], a[184:187], v[8:11], a[52:55]
  ds_read_b64_tr_b16 a[178:179], v222 offset:4096
  v_cvt_pk_bf16_f32 v120, v120, v121
  v_mfma_f32_16x16x32_bf16 a[56:59], a[184:187], v[16:19], a[56:59]
  v_exp_f32 v122, v122
  v_mfma_f32_16x16x32_bf16 a[56:59], a[188:191], v[48:51], a[56:59]
  ds_read_b64_tr_b16 a[180:181], v222 offset:8192
  ds_write_b128 v224, v[228:231]
  v_mfma_f32_16x16x32_bf16 a[60:63], a[188:191], v[56:59], a[60:63]
  s_waitcnt lgkmcnt(8)
  v_exp_f32 v123, v123
  v_mfma_f32_16x16x32_bf16 a[60:63], a[184:187], v[24:27], a[60:63]
  ds_read_b64_tr_b16 a[182:183], v222 offset:12288
  v_cvt_pk_bf16_f32 v121, v122, v123
  v_mfma_f32_16x16x32_bf16 a[64:67], a[160:163], v[0:3], a[64:67]
  v_exp_f32 v100, v100
  v_mfma_f32_16x16x32_bf16 a[64:67], a[164:167], v[32:35], a[64:67]
  ds_read_b64_tr_b16 a[184:185], v223 offset:0
  v_mfma_f32_16x16x32_bf16 a[68:71], a[164:167], v[40:43], a[68:71]
  v_exp_f32 v101, v101
  v_mfma_f32_16x16x32_bf16 a[68:71], a[160:163], v[8:11], a[68:71]
  ds_read_b64_tr_b16 a[186:187], v223 offset:4096
  v_cvt_pk_bf16_f32 v98, v100, v101
  v_mfma_f32_16x16x32_bf16 a[72:75], a[160:163], v[16:19], a[72:75]
  v_exp_f32 v102, v102
  v_mfma_f32_16x16x32_bf16 a[72:75], a[164:167], v[48:51], a[72:75]
  ds_read_b64_tr_b16 a[188:189], v223 offset:8192
  s_waitcnt lgkmcnt(4)
  v_mfma_f32_16x16x32_bf16 a[76:79], a[164:167], v[56:59], a[76:79]
  v_exp_f32 v103, v103
  v_mfma_f32_16x16x32_bf16 a[76:79], a[160:163], v[24:27], a[76:79]
  ds_read_b64_tr_b16 a[190:191], v223 offset:12288
  v_cvt_pk_bf16_f32 v99, v102, v103
  v_mfma_f32_16x16x32_bf16 a[80:83], a[168:171], v[0:3], a[80:83]
  s_waitcnt vmcnt(12)
  v_exp_f32 v108, v108
  v_mfma_f32_16x16x32_bf16 a[80:83], a[172:175], v[32:35], a[80:83]
  v_mfma_f32_16x16x32_bf16 a[84:87], a[172:175], v[40:43], a[84:87]
  s_barrier
  v_exp_f32 v109, v109
  v_mfma_f32_16x16x32_bf16 a[84:87], a[168:171], v[8:11], a[84:87]
  ds_read_b128 a[128:131], v212 offset:32768
  v_cvt_pk_bf16_f32 v106, v108, v109
  v_mfma_f32_16x16x32_bf16 a[88:91], a[168:171], v[16:19], a[88:91]
  v_exp_f32 v110, v110
  v_mfma_f32_16x16x32_bf16 a[88:91], a[172:175], v[48:51], a[88:91]
  ds_read_b128 a[132:135], v213 offset:32768
  v_mfma_f32_16x16x32_bf16 a[92:95], a[172:175], v[56:59], a[92:95]
  s_waitcnt lgkmcnt(6)
  v_exp_f32 v111, v111
  v_mfma_f32_16x16x32_bf16 a[92:95], a[168:171], v[24:27], a[92:95]
  ds_read_b128 a[136:139], v214 offset:32768
  v_cvt_pk_bf16_f32 v107, v110, v111
  v_mfma_f32_16x16x32_bf16 a[96:99], a[176:179], v[0:3], a[96:99]
  v_exp_f32 v116, v116
  v_mfma_f32_16x16x32_bf16 a[96:99], a[180:183], v[32:35], a[96:99]
  ds_read_b128 a[140:143], v215 offset:32768
  v_mfma_f32_16x16x32_bf16 a[100:103], a[180:183], v[40:43], a[100:103]
  v_exp_f32 v117, v117
  v_mfma_f32_16x16x32_bf16 a[100:103], a[176:179], v[8:11], a[100:103]
  v_cvt_pk_bf16_f32 v114, v116, v117
  v_mfma_f32_16x16x32_bf16 a[104:107], a[176:179], v[16:19], a[104:107]
  v_exp_f32 v118, v118
  v_mfma_f32_16x16x32_bf16 a[104:107], a[180:183], v[48:51], a[104:107]
  v_mfma_f32_16x16x32_bf16 a[108:111], a[180:183], v[56:59], a[108:111]
  s_waitcnt lgkmcnt(4)
  v_exp_f32 v119, v119
  v_mfma_f32_16x16x32_bf16 a[108:111], a[176:179], v[24:27], a[108:111]
  v_cvt_pk_bf16_f32 v115, v118, v119
  v_mfma_f32_16x16x32_bf16 a[112:115], a[184:187], v[0:3], a[112:115]
  v_exp_f32 v124, v124
  v_mfma_f32_16x16x32_bf16 a[112:115], a[188:191], v[32:35], a[112:115]
  v_mfma_f32_16x16x32_bf16 a[116:119], a[188:191], v[40:43], a[116:119]
  v_exp_f32 v125, v125
  v_mfma_f32_16x16x32_bf16 a[116:119], a[184:187], v[8:11], a[116:119]
  v_cvt_pk_bf16_f32 v122, v124, v125
  v_mfma_f32_16x16x32_bf16 a[120:123], a[184:187], v[16:19], a[120:123]
  v_exp_f32 v126, v126
  v_mfma_f32_16x16x32_bf16 a[120:123], a[188:191], v[48:51], a[120:123]
  v_mfma_f32_16x16x32_bf16 a[124:127], a[188:191], v[56:59], a[124:127]
  s_waitcnt lgkmcnt(0)
  v_exp_f32 v127, v127
  v_mfma_f32_16x16x32_bf16 a[124:127], a[184:187], v[24:27], a[124:127]
  v_cvt_pk_bf16_f32 v123, v126, v127
  v_mfma_f32_16x16x32_bf16 v[0:3], a[128:131], v[128:131], v[192:195]
  s_add_u32 m0, s28, 114688
  v_add_u32 v224, 159744, v242
  v_mfma_f32_16x16x32_bf16 v[0:3], a[132:135], v[132:135], v[0:3]
  ds_read_b128 a[144:147], v212 offset:36864
  ds_read_b128 v[228:231], v224 offset:0
  v_mfma_f32_16x16x32_bf16 v[0:3], a[136:139], v[136:139], v[0:3]
  buffer_load_dwordx4 v236, s[16:19], s29 offen offset:0 lds
  v_mfma_f32_16x16x32_bf16 v[0:3], a[140:143], v[140:143], v[0:3]
  ds_read_b128 a[148:151], v213 offset:36864
  ds_read_b128 v[238:241], v224 offset:1024
  v_mfma_f32_16x16x32_bf16 v[8:11], a[140:143], v[156:159], v[196:199]
  ds_read_b128 v[208:211], v224 offset:2048
  v_lshrrev_b32 v224, 4, v242
  v_mfma_f32_16x16x32_bf16 v[8:11], a[136:139], v[152:155], v[8:11]
  ds_read_b128 a[152:155], v214 offset:36864
  s_min_u32 s35, s3, 1
  s_lshl_b32 s35, s35, 30
  v_and_b32 v225, 7, v224
  v_mfma_f32_16x16x32_bf16 v[8:11], a[132:135], v[148:151], v[8:11]
  buffer_load_dwordx4 v237, s[16:19], s29 offen offset:1024 lds
  v_mfma_f32_16x16x32_bf16 v[8:11], a[128:131], v[144:147], v[8:11]
  ds_read_b128 a[156:159], v215 offset:36864
  v_mul_u32_u24 v225, 0xa00, v225
  v_mfma_f32_16x16x32_bf16 v[16:19], a[128:131], v[160:163], v[200:203]
  v_exp_f32 v0, v0
  v_mfma_f32_16x16x32_bf16 v[16:19], a[132:135], v[164:167], v[16:19]
  v_lshrrev_b32 v226, 4, v224
  v_lshl_add_u32 v225, v226, 4, v225
  v_mfma_f32_16x16x32_bf16 v[16:19], a[136:139], v[168:171], v[16:19]
  v_exp_f32 v1, v1
  v_mfma_f32_16x16x32_bf16 v[16:19], a[140:143], v[172:175], v[16:19]
  v_cvt_pk_bf16_f32 v0, v0, v1
  v_bfe_u32 v226, v224, 3, 1
  v_mfma_f32_16x16x32_bf16 v[24:27], a[140:143], v[188:191], v[204:207]
  v_exp_f32 v2, v2
  v_mfma_f32_16x16x32_bf16 v[24:27], a[136:139], v[184:187], v[24:27]
  buffer_load_dwordx4 v236, s[16:19], s29 offen offset:2048 lds
  v_mfma_f32_16x16x32_bf16 v[24:27], a[132:135], v[180:183], v[24:27]
  s_waitcnt lgkmcnt(0)
  v_exp_f32 v3, v3
  v_mfma_f32_16x16x32_bf16 v[24:27], a[128:131], v[176:179], v[24:27]
  v_cvt_pk_bf16_f32 v1, v2, v3
  v_lshl_add_u32 v225, v226, 30, v225
  v_mfma_f32_16x16x32_bf16 v[4:7], a[144:147], v[128:131], v[192:195]
  v_exp_f32 v8, v8
  v_mfma_f32_16x16x32_bf16 v[4:7], a[148:151], v[132:135], v[4:7]
  ds_read_b128 a[128:131], v212 offset:40960
  v_or_b32 v225, s35, v225
  v_mfma_f32_16x16x32_bf16 v[4:7], a[152:155], v[136:139], v[4:7]
  s_mul_i32 s35, s98, 20480
  s_lshl_b32 s38, s99, 6
  s_add_u32 s35, s35, s38
  v_exp_f32 v9, v9
  v_mfma_f32_16x16x32_bf16 v[4:7], a[156:159], v[140:143], v[4:7]
  ds_read_b128 a[132:135], v213 offset:40960
  s_add_u32 s35, s35, 2686976
  v_cvt_pk_bf16_f32 v8, v8, v9
  v_mfma_f32_16x16x32_bf16 v[12:15], a[156:159], v[156:159], v[196:199]
  v_exp_f32 v10, v10
  v_mfma_f32_16x16x32_bf16 v[12:15], a[152:155], v[152:155], v[12:15]
  ds_read_b128 a[136:139], v214 offset:40960
  v_add_f32 v228, v228, v238
  v_mfma_f32_16x16x32_bf16 v[12:15], a[148:151], v[148:151], v[12:15]
  v_exp_f32 v11, v11
  v_mfma_f32_16x16x32_bf16 v[12:15], a[144:147], v[144:147], v[12:15]
  ds_read_b128 a[140:143], v215 offset:40960
  v_cvt_pk_bf16_f32 v9, v10, v11
  v_mfma_f32_16x16x32_bf16 v[20:23], a[144:147], v[160:163], v[200:203]
  v_exp_f32 v16, v16
  v_mfma_f32_16x16x32_bf16 v[20:23], a[148:151], v[164:167], v[20:23]
  buffer_load_dwordx4 v237, s[16:19], s29 offen offset:3072 lds
  v_mfma_f32_16x16x32_bf16 v[20:23], a[152:155], v[168:171], v[20:23]
  s_add_u32 s29, s29, 16384
  v_exp_f32 v17, v17
  v_mfma_f32_16x16x32_bf16 v[20:23], a[156:159], v[172:175], v[20:23]
  v_cvt_pk_bf16_f32 v16, v16, v17
  v_add_f32 v229, v229, v239
  v_mfma_f32_16x16x32_bf16 v[28:31], a[156:159], v[188:191], v[204:207]
  s_add_u32 m0, s28, 16384
  v_exp_f32 v18, v18
  v_mfma_f32_16x16x32_bf16 v[28:31], a[152:155], v[184:187], v[28:31]
  buffer_load_dwordx4 v242, s[24:27], s9 offen offset:0 sc1 lds
  v_mfma_f32_16x16x32_bf16 v[28:31], a[148:151], v[180:183], v[28:31]
  s_waitcnt lgkmcnt(0)
  v_exp_f32 v19, v19
  v_mfma_f32_16x16x32_bf16 v[28:31], a[144:147], v[176:179], v[28:31]
  v_cvt_pk_bf16_f32 v17, v18, v19
  v_add_f32 v230, v230, v240
  v_mfma_f32_16x16x32_bf16 v[32:35], a[128:131], v[128:131], v[192:195]
  v_exp_f32 v24, v24
  v_mfma_f32_16x16x32_bf16 v[32:35], a[132:135], v[132:135], v[32:35]
  ds_read_b128 a[144:147], v212 offset:45056
  v_add_f32 v231, v231, v241
  v_mfma_f32_16x16x32_bf16 v[32:35], a[136:139], v[136:139], v[32:35]
  v_exp_f32 v25, v25
  v_mfma_f32_16x16x32_bf16 v[32:35], a[140:143], v[140:143], v[32:35]
  ds_read_b128 a[148:151], v213 offset:45056
  v_cvt_pk_bf16_f32 v24, v24, v25
  v_mfma_f32_16x16x32_bf16 v[40:43], a[140:143], v[156:159], v[196:199]
  v_exp_f32 v26, v26
  v_mfma_f32_16x16x32_bf16 v[40:43], a[136:139], v[152:155], v[40:43]
  ds_read_b128 a[152:155], v214 offset:45056
  v_add_f32 v228, v228, v208
  v_mfma_f32_16x16x32_bf16 v[40:43], a[132:135], v[148:151], v[40:43]
  v_exp_f32 v27, v27
  v_mfma_f32_16x16x32_bf16 v[40:43], a[128:131], v[144:147], v[40:43]
  ds_read_b128 a[156:159], v215 offset:45056
  v_cvt_pk_bf16_f32 v25, v26, v27
  v_mfma_f32_16x16x32_bf16 v[48:51], a[128:131], v[160:163], v[200:203]
  v_exp_f32 v4, v4
  v_mfma_f32_16x16x32_bf16 v[48:51], a[132:135], v[164:167], v[48:51]
  buffer_load_dwordx4 v242, s[24:27], s9 offen offset:1024 sc1 lds
  v_mfma_f32_16x16x32_bf16 v[48:51], a[136:139], v[168:171], v[48:51]
  v_exp_f32 v5, v5
  v_mfma_f32_16x16x32_bf16 v[48:51], a[140:143], v[172:175], v[48:51]
  v_cvt_pk_bf16_f32 v2, v4, v5
  v_add_f32 v229, v229, v209
  v_mfma_f32_16x16x32_bf16 v[56:59], a[140:143], v[188:191], v[204:207]
  v_exp_f32 v6, v6
  v_mfma_f32_16x16x32_bf16 v[56:59], a[136:139], v[184:187], v[56:59]
  buffer_load_dwordx4 v242, s[24:27], s9 offen offset:2048 sc1 lds
  v_mfma_f32_16x16x32_bf16 v[56:59], a[132:135], v[180:183], v[56:59]
  s_waitcnt lgkmcnt(0)
  v_exp_f32 v7, v7
  v_mfma_f32_16x16x32_bf16 v[56:59], a[128:131], v[176:179], v[56:59]
  v_cvt_pk_bf16_f32 v3, v6, v7
  v_add_f32 v230, v230, v210
  v_mfma_f32_16x16x32_bf16 v[36:39], a[144:147], v[128:131], v[192:195]
  v_exp_f32 v12, v12
  v_mfma_f32_16x16x32_bf16 v[36:39], a[148:151], v[132:135], v[36:39]
  ds_read_b64_tr_b16 a[160:161], v216 offset:16384
  v_add_f32 v231, v231, v211
  v_mfma_f32_16x16x32_bf16 v[36:39], a[152:155], v[136:139], v[36:39]
  v_exp_f32 v13, v13
  v_mfma_f32_16x16x32_bf16 v[36:39], a[156:159], v[140:143], v[36:39]
  ds_read_b64_tr_b16 a[162:163], v216 offset:20480
  v_cvt_pk_bf16_f32 v10, v12, v13
  v_mfma_f32_16x16x32_bf16 v[44:47], a[156:159], v[156:159], v[196:199]
  v_exp_f32 v14, v14
  v_mfma_f32_16x16x32_bf16 v[44:47], a[152:155], v[152:155], v[44:47]
  ds_read_b64_tr_b16 a[164:165], v216 offset:24576
  buffer_load_dwordx4 v242, s[24:27], s9 offen offset:3072 sc1 lds
  v_mfma_f32_16x16x32_bf16 v[44:47], a[148:151], v[148:151], v[44:47]
  v_exp_f32 v15, v15
  v_mfma_f32_16x16x32_bf16 v[44:47], a[144:147], v[144:147], v[44:47]
  ds_read_b64_tr_b16 a[166:167], v216 offset:28672
  v_cvt_pk_bf16_f32 v11, v14, v15
  v_mfma_f32_16x16x32_bf16 v[52:55], a[144:147], v[160:163], v[200:203]
  v_exp_f32 v20, v20
  v_mfma_f32_16x16x32_bf16 v[52:55], a[148:151], v[164:167], v[52:55]
  ds_read_b64_tr_b16 a[168:169], v217 offset:16384
  buffer_store_dwordx4 v[228:231], v225, s[24:27], s35 offen sc1
  v_mfma_f32_16x16x32_bf16 v[52:55], a[152:155], v[168:171], v[52:55]
  v_exp_f32 v21, v21
  v_mfma_f32_16x16x32_bf16 v[52:55], a[156:159], v[172:175], v[52:55]
  ds_read_b64_tr_b16 a[170:171], v217 offset:20480
  v_cvt_pk_bf16_f32 v18, v20, v21
  v_mfma_f32_16x16x32_bf16 v[60:63], a[156:159], v[188:191], v[204:207]
  v_exp_f32 v22, v22
  v_mfma_f32_16x16x32_bf16 v[60:63], a[152:155], v[184:187], v[60:63]
  ds_read_b64_tr_b16 a[172:173], v217 offset:24576
  buffer_load_dwordx4 a[212:215], v242, s[24:27], s4 offen offset:0 sc1
  v_mfma_f32_16x16x32_bf16 v[60:63], a[148:151], v[180:183], v[60:63]
  v_exp_f32 v23, v23
  v_mfma_f32_16x16x32_bf16 v[60:63], a[144:147], v[176:179], v[60:63]
  ds_read_b64_tr_b16 a[174:175], v217 offset:28672
  v_cvt_pk_bf16_f32 v19, v22, v23
  v_mfma_f32_16x16x32_bf16 a[192:195], a[208:211], v[64:67], a[192:195]
  v_exp_f32 v28, v28
  v_mfma_f32_16x16x32_bf16 a[192:195], a[208:211], v[96:99], a[192:195]
  ds_read_b64_tr_b16 a[176:177], v218 offset:16384
  buffer_load_dwordx4 a[216:219], v242, s[24:27], s4 offen offset:1024 sc1
  v_mfma_f32_16x16x32_bf16 a[196:199], a[208:211], v[72:75], a[196:199]
  v_exp_f32 v29, v29
  v_mfma_f32_16x16x32_bf16 a[196:199], a[208:211], v[104:107], a[196:199]
  ds_read_b64_tr_b16 a[178:179], v218 offset:20480
  v_cvt_pk_bf16_f32 v26, v28, v29
  v_mfma_f32_16x16x32_bf16 a[200:203], a[208:211], v[80:83], a[200:203]
  v_exp_f32 v30, v30
  v_mfma_f32_16x16x32_bf16 a[200:203], a[208:211], v[112:115], a[200:203]
  ds_read_b64_tr_b16 a[180:181], v218 offset:24576
  v_mfma_f32_16x16x32_bf16 a[204:207], a[208:211], v[88:91], a[204:207]
  s_waitcnt lgkmcnt(7)
  v_exp_f32 v31, v31
  v_mfma_f32_16x16x32_bf16 a[204:207], a[208:211], v[120:123], a[204:207]
  ds_read_b64_tr_b16 a[182:183], v218 offset:28672
  v_cvt_pk_bf16_f32 v27, v30, v31
  v_mfma_f32_16x16x32_bf16 a[0:3], a[160:163], v[64:67], a[0:3]
  v_exp_f32 v32, v32
  v_mfma_f32_16x16x32_bf16 a[0:3], a[164:167], v[96:99], a[0:3]
  ds_read_b64_tr_b16 a[184:185], v219 offset:16384
  buffer_load_dwordx4 a[220:223], v242, s[24:27], s4 offen offset:2048 sc1
  v_mfma_f32_16x16x32_bf16 a[4:7], a[164:167], v[104:107], a[4:7]
  v_exp_f32 v33, v33
  v_mfma_f32_16x16x32_bf16 a[4:7], a[160:163], v[72:75], a[4:7]
  ds_read_b64_tr_b16 a[186:187], v219 offset:20480
  v_cvt_pk_bf16_f32 v32, v32, v33
  v_mfma_f32_16x16x32_bf16 a[8:11], a[160:163], v[80:83], a[8:11]
  v_exp_f32 v34, v34
  v_mfma_f32_16x16x32_bf16 a[8:11], a[164:167], v[112:115], a[8:11]
  ds_read_b64_tr_b16 a[188:189], v219 offset:24576
  v_mfma_f32_16x16x32_bf16 a[12:15], a[164:167], v[120:123], a[12:15]
  s_waitcnt lgkmcnt(7)
  v_exp_f32 v35, v35
  v_mfma_f32_16x16x32_bf16 a[12:15], a[160:163], v[88:91], a[12:15]
  ds_read_b64_tr_b16 a[190:191], v219 offset:28672
  v_cvt_pk_bf16_f32 v33, v34, v35
  v_mfma_f32_16x16x32_bf16 a[16:19], a[168:171], v[64:67], a[16:19]
  v_exp_f32 v40, v40
  v_mfma_f32_16x16x32_bf16 a[16:19], a[172:175], v[96:99], a[16:19]
  ds_read_b64_tr_b16 a[160:161], v220 offset:16384
  buffer_load_dwordx4 a[224:227], v242, s[24:27], s4 offen offset:3072 sc1
  v_mfma_f32_16x16x32_bf16 a[20:23], a[172:175], v[104:107], a[20:23]
  v_exp_f32 v41, v41
  v_mfma_f32_16x16x32_bf16 a[20:23], a[168:171], v[72:75], a[20:23]
  ds_read_b64_tr_b16 a[162:163], v220 offset:20480
  v_cvt_pk_bf16_f32 v40, v40, v41
  v_mfma_f32_16x16x32_bf16 a[24:27], a[168:171], v[80:83], a[24:27]
  v_exp_f32 v42, v42
  v_mfma_f32_16x16x32_bf16 a[24:27], a[172:175], v[112:115], a[24:27]
  ds_read_b64_tr_b16 a[164:165], v220 offset:24576
  v_mfma_f32_16x16x32_bf16 a[28:31], a[172:175], v[120:123], a[28:31]
  s_waitcnt lgkmcnt(7)
  v_exp_f32 v43, v43
  v_mfma_f32_16x16x32_bf16 a[28:31], a[168:171], v[88:91], a[28:31]
  ds_read_b64_tr_b16 a[166:167], v220 offset:28672
  v_cvt_pk_bf16_f32 v41, v42, v43
  v_mfma_f32_16x16x32_bf16 a[32:35], a[176:179], v[64:67], a[32:35]
  v_exp_f32 v48, v48
  v_mfma_f32_16x16x32_bf16 a[32:35], a[180:183], v[96:99], a[32:35]
  ds_read_b64_tr_b16 a[168:169], v221 offset:16384
  buffer_load_dwordx4 a[228:231], v252, s[24:27], s4 offen offset:0 sc1
  v_mfma_f32_16x16x32_bf16 a[36:39], a[180:183], v[104:107], a[36:39]
  v_exp_f32 v49, v49
  v_mfma_f32_16x16x32_bf16 a[36:39], a[176:179], v[72:75], a[36:39]
  ds_read_b64_tr_b16 a[170:171], v221 offset:20480
  v_cvt_pk_bf16_f32 v48, v48, v49
  v_mfma_f32_16x16x32_bf16 a[40:43], a[176:179], v[80:83], a[40:43]
  v_exp_f32 v50, v50
  v_mfma_f32_16x16x32_bf16 a[40:43], a[180:183], v[112:115], a[40:43]
  ds_read_b64_tr_b16 a[172:173], v221 offset:24576
  v_mfma_f32_16x16x32_bf16 a[44:47], a[180:183], v[120:123], a[44:47]
  s_waitcnt lgkmcnt(7)
  v_exp_f32 v51, v51
  v_mfma_f32_16x16x32_bf16 a[44:47], a[176:179], v[88:91], a[44:47]
  ds_read_b64_tr_b16 a[174:175], v221 offset:28672
  v_cvt_pk_bf16_f32 v49, v50, v51
  v_mfma_f32_16x16x32_bf16 a[48:51], a[184:187], v[64:67], a[48:51]
  v_exp_f32 v56, v56
  v_mfma_f32_16x16x32_bf16 a[48:51], a[188:191], v[96:99], a[48:51]
  ds_read_b64_tr_b16 a[176:177], v222 offset:16384
  buffer_load_dwordx4 a[232:235], v252, s[24:27], s4 offen offset:1024 sc1
  v_mfma_f32_16x16x32_bf16 a[52:55], a[188:191], v[104:107], a[52:55]
  v_exp_f32 v57, v57
  v_mfma_f32_16x16x32_bf16 a[52:55], a[184:187], v[72:75], a[52:55]
  ds_read_b64_tr_b16 a[178:179], v222 offset:20480
  v_cvt_pk_bf16_f32 v56, v56, v57
  v_mfma_f32_16x16x32_bf16 a[56:59], a[184:187], v[80:83], a[56:59]
  v_exp_f32 v58, v58
  v_mfma_f32_16x16x32_bf16 a[56:59], a[188:191], v[112:115], a[56:59]
  ds_read_b64_tr_b16 a[180:181], v222 offset:24576
  v_mfma_f32_16x16x32_bf16 a[60:63], a[188:191], v[120:123], a[60:63]
  s_waitcnt lgkmcnt(7)
  v_exp_f32 v59, v59
  v_mfma_f32_16x16x32_bf16 a[60:63], a[184:187], v[88:91], a[60:63]
  ds_read_b64_tr_b16 a[182:183], v222 offset:28672
  v_cvt_pk_bf16_f32 v57, v58, v59
  v_mfma_f32_16x16x32_bf16 a[64:67], a[160:163], v[64:67], a[64:67]
  v_exp_f32 v36, v36
  v_mfma_f32_16x16x32_bf16 a[64:67], a[164:167], v[96:99], a[64:67]
  ds_read_b64_tr_b16 a[184:185], v223 offset:16384
  v_mfma_f32_16x16x32_bf16 a[68:71], a[164:167], v[104:107], a[68:71]
  v_exp_f32 v37, v37
  v_mfma_f32_16x16x32_bf16 a[68:71], a[160:163], v[72:75], a[68:71]
  ds_read_b64_tr_b16 a[186:187], v223 offset:20480
  v_cvt_pk_bf16_f32 v34, v36, v37
  v_mfma_f32_16x16x32_bf16 a[72:75], a[160:163], v[80:83], a[72:75]
  v_exp_f32 v38, v38
  v_mfma_f32_16x16x32_bf16 a[72:75], a[164:167], v[112:115], a[72:75]
  ds_read_b64_tr_b16 a[188:189], v223 offset:24576
  v_mfma_f32_16x16x32_bf16 a[76:79], a[164:167], v[120:123], a[76:79]
  s_waitcnt lgkmcnt(7)
  v_exp_f32 v39, v39
  v_mfma_f32_16x16x32_bf16 a[76:79], a[160:163], v[88:91], a[76:79]
  ds_read_b64_tr_b16 a[190:191], v223 offset:28672
  v_cvt_pk_bf16_f32 v35, v38, v39
  v_mfma_f32_16x16x32_bf16 a[80:83], a[168:171], v[64:67], a[80:83]
  s_waitcnt vmcnt(19)
  v_exp_f32 v44, v44
  v_mfma_f32_16x16x32_bf16 a[80:83], a[172:175], v[96:99], a[80:83]
  v_mfma_f32_16x16x32_bf16 a[84:87], a[172:175], v[104:107], a[84:87]
  s_barrier
  v_exp_f32 v45, v45
  v_mfma_f32_16x16x32_bf16 a[84:87], a[168:171], v[72:75], a[84:87]
  ds_read_b128 a[128:131], v212 offset:49152
  v_cvt_pk_bf16_f32 v42, v44, v45
  v_mfma_f32_16x16x32_bf16 a[88:91], a[168:171], v[80:83], a[88:91]
  v_exp_f32 v46, v46
  v_mfma_f32_16x16x32_bf16 a[88:91], a[172:175], v[112:115], a[88:91]
  ds_read_b128 a[132:135], v213 offset:49152
  v_mfma_f32_16x16x32_bf16 a[92:95], a[172:175], v[120:123], a[92:95]
  s_waitcnt lgkmcnt(6)
  v_exp_f32 v47, v47
  v_mfma_f32_16x16x32_bf16 a[92:95], a[168:171], v[88:91], a[92:95]
  ds_read_b128 a[136:139], v214 offset:49152
  v_cvt_pk_bf16_f32 v43, v46, v47
  v_mfma_f32_16x16x32_bf16 a[96:99], a[176:179], v[64:67], a[96:99]
  v_exp_f32 v52, v52
  v_mfma_f32_16x16x32_bf16 a[96:99], a[180:183], v[96:99], a[96:99]
  ds_read_b128 a[140:143], v215 offset:49152
  v_mfma_f32_16x16x32_bf16 a[100:103], a[180:183], v[104:107], a[100:103]
  v_exp_f32 v53, v53
  v_mfma_f32_16x16x32_bf16 a[100:103], a[176:179], v[72:75], a[100:103]
  v_cvt_pk_bf16_f32 v50, v52, v53
  v_mfma_f32_16x16x32_bf16 a[104:107], a[176:179], v[80:83], a[104:107]
  v_exp_f32 v54, v54
  v_mfma_f32_16x16x32_bf16 a[104:107], a[180:183], v[112:115], a[104:107]
  v_mfma_f32_16x16x32_bf16 a[108:111], a[180:183], v[120:123], a[108:111]
  s_waitcnt lgkmcnt(4)
  v_exp_f32 v55, v55
  v_mfma_f32_16x16x32_bf16 a[108:111], a[176:179], v[88:91], a[108:111]
  v_cvt_pk_bf16_f32 v51, v54, v55
  v_mfma_f32_16x16x32_bf16 a[112:115], a[184:187], v[64:67], a[112:115]
  v_exp_f32 v60, v60
  v_mfma_f32_16x16x32_bf16 a[112:115], a[188:191], v[96:99], a[112:115]
  v_mfma_f32_16x16x32_bf16 a[116:119], a[188:191], v[104:107], a[116:119]
  v_exp_f32 v61, v61
  v_mfma_f32_16x16x32_bf16 a[116:119], a[184:187], v[72:75], a[116:119]
  v_cvt_pk_bf16_f32 v58, v60, v61
  v_mfma_f32_16x16x32_bf16 a[120:123], a[184:187], v[80:83], a[120:123]
  v_exp_f32 v62, v62
  v_mfma_f32_16x16x32_bf16 a[120:123], a[188:191], v[112:115], a[120:123]
  v_mfma_f32_16x16x32_bf16 a[124:127], a[188:191], v[120:123], a[124:127]
  s_waitcnt lgkmcnt(0)
  v_exp_f32 v63, v63
  v_mfma_f32_16x16x32_bf16 a[124:127], a[184:187], v[88:91], a[124:127]
  v_cvt_pk_bf16_f32 v59, v62, v63
  v_mfma_f32_16x16x32_bf16 v[64:67], a[128:131], v[128:131], v[192:195]
  s_add_u32 m0, s28, 65536
  v_mfma_f32_16x16x32_bf16 v[64:67], a[132:135], v[132:135], v[64:67]
  ds_read_b128 a[144:147], v212 offset:53248
  v_mfma_f32_16x16x32_bf16 v[64:67], a[136:139], v[136:139], v[64:67]
  buffer_load_dwordx4 v253, s[24:27], s9 offen offset:0 sc1 lds
  v_mfma_f32_16x16x32_bf16 v[64:67], a[140:143], v[140:143], v[64:67]
  ds_read_b128 a[148:151], v213 offset:53248
  v_mfma_f32_16x16x32_bf16 v[72:75], a[140:143], v[156:159], v[196:199]
  v_mfma_f32_16x16x32_bf16 v[72:75], a[136:139], v[152:155], v[72:75]
  ds_read_b128 a[152:155], v214 offset:53248
  v_mfma_f32_16x16x32_bf16 v[72:75], a[132:135], v[148:151], v[72:75]
  buffer_load_dwordx4 v253, s[24:27], s9 offen offset:1024 sc1 lds
  v_mfma_f32_16x16x32_bf16 v[72:75], a[128:131], v[144:147], v[72:75]
  ds_read_b128 a[156:159], v215 offset:53248
  v_mfma_f32_16x16x32_bf16 v[80:83], a[128:131], v[160:163], v[200:203]
  v_exp_f32 v64, v64
  v_mfma_f32_16x16x32_bf16 v[80:83], a[132:135], v[164:167], v[80:83]
  v_mfma_f32_16x16x32_bf16 v[80:83], a[136:139], v[168:171], v[80:83]
  v_exp_f32 v65, v65
  v_mfma_f32_16x16x32_bf16 v[80:83], a[140:143], v[172:175], v[80:83]
  v_cvt_pk_bf16_f32 v64, v64, v65
  v_mfma_f32_16x16x32_bf16 v[88:91], a[140:143], v[188:191], v[204:207]
  v_exp_f32 v66, v66
  v_mfma_f32_16x16x32_bf16 v[88:91], a[136:139], v[184:187], v[88:91]
  buffer_load_dwordx4 v253, s[24:27], s9 offen offset:2048 sc1 lds
  v_mfma_f32_16x16x32_bf16 v[88:91], a[132:135], v[180:183], v[88:91]
  s_waitcnt lgkmcnt(0)
  v_exp_f32 v67, v67
  v_mfma_f32_16x16x32_bf16 v[88:91], a[128:131], v[176:179], v[88:91]
  v_cvt_pk_bf16_f32 v65, v66, v67
  v_mfma_f32_16x16x32_bf16 v[68:71], a[144:147], v[128:131], v[192:195]
  v_exp_f32 v72, v72
  v_mfma_f32_16x16x32_bf16 v[68:71], a[148:151], v[132:135], v[68:71]
  ds_read_b128 a[128:131], v212 offset:57344
  v_mfma_f32_16x16x32_bf16 v[68:71], a[152:155], v[136:139], v[68:71]
  v_exp_f32 v73, v73
  v_mfma_f32_16x16x32_bf16 v[68:71], a[156:159], v[140:143], v[68:71]
  ds_read_b128 a[132:135], v213 offset:57344
  v_cvt_pk_bf16_f32 v72, v72, v73
  v_mfma_f32_16x16x32_bf16 v[76:79], a[156:159], v[156:159], v[196:199]
  v_exp_f32 v74, v74
  v_mfma_f32_16x16x32_bf16 v[76:79], a[152:155], v[152:155], v[76:79]
  ds_read_b128 a[136:139], v214 offset:57344
  v_mfma_f32_16x16x32_bf16 v[76:79], a[148:151], v[148:151], v[76:79]
  v_exp_f32 v75, v75
  v_mfma_f32_16x16x32_bf16 v[76:79], a[144:147], v[144:147], v[76:79]
  ds_read_b128 a[140:143], v215 offset:57344
  v_cvt_pk_bf16_f32 v73, v74, v75
  v_mfma_f32_16x16x32_bf16 v[84:87], a[144:147], v[160:163], v[200:203]
  v_exp_f32 v80, v80
  v_mfma_f32_16x16x32_bf16 v[84:87], a[148:151], v[164:167], v[84:87]
  buffer_load_dwordx4 v253, s[24:27], s9 offen offset:3072 sc1 lds
  v_mfma_f32_16x16x32_bf16 v[84:87], a[152:155], v[168:171], v[84:87]
  s_add_u32 s29, s29, 16384
  v_exp_f32 v81, v81
  v_mfma_f32_16x16x32_bf16 v[84:87], a[156:159], v[172:175], v[84:87]
  v_cvt_pk_bf16_f32 v80, v80, v81
  v_mfma_f32_16x16x32_bf16 v[92:95], a[156:159], v[188:191], v[204:207]
  s_add_u32 m0, s28, 32768
  v_exp_f32 v82, v82
  v_mfma_f32_16x16x32_bf16 v[92:95], a[152:155], v[184:187], v[92:95]
  buffer_load_dwordx4 v252, s[24:27], s9 offen offset:0 sc1 lds
  v_mfma_f32_16x16x32_bf16 v[92:95], a[148:151], v[180:183], v[92:95]
  s_waitcnt lgkmcnt(0)
  v_exp_f32 v83, v83
  v_mfma_f32_16x16x32_bf16 v[92:95], a[144:147], v[176:179], v[92:95]
  v_cvt_pk_bf16_f32 v81, v82, v83
  v_mfma_f32_16x16x32_bf16 v[96:99], a[128:131], v[128:131], v[192:195]
  v_exp_f32 v88, v88
  v_mfma_f32_16x16x32_bf16 v[96:99], a[132:135], v[132:135], v[96:99]
  ds_read_b128 a[144:147], v212 offset:61440
  v_mfma_f32_16x16x32_bf16 v[96:99], a[136:139], v[136:139], v[96:99]
  v_exp_f32 v89, v89
  v_mfma_f32_16x16x32_bf16 v[96:99], a[140:143], v[140:143], v[96:99]
  ds_read_b128 a[148:151], v213 offset:61440
  v_cvt_pk_bf16_f32 v88, v88, v89
  v_mfma_f32_16x16x32_bf16 v[104:107], a[140:143], v[156:159], v[196:199]
  v_exp_f32 v90, v90
  v_mfma_f32_16x16x32_bf16 v[104:107], a[136:139], v[152:155], v[104:107]
  ds_read_b128 a[152:155], v214 offset:61440
  v_mfma_f32_16x16x32_bf16 v[104:107], a[132:135], v[148:151], v[104:107]
  v_exp_f32 v91, v91
  v_mfma_f32_16x16x32_bf16 v[104:107], a[128:131], v[144:147], v[104:107]
  ds_read_b128 a[156:159], v215 offset:61440
  v_cvt_pk_bf16_f32 v89, v90, v91
  v_mfma_f32_16x16x32_bf16 v[112:115], a[128:131], v[160:163], v[200:203]
  v_exp_f32 v68, v68
  v_mfma_f32_16x16x32_bf16 v[112:115], a[132:135], v[164:167], v[112:115]
  buffer_load_dwordx4 v252, s[24:27], s9 offen offset:1024 sc1 lds
  v_mfma_f32_16x16x32_bf16 v[112:115], a[136:139], v[168:171], v[112:115]
  v_exp_f32 v69, v69
  v_mfma_f32_16x16x32_bf16 v[112:115], a[140:143], v[172:175], v[112:115]
  v_cvt_pk_bf16_f32 v66, v68, v69
  v_mfma_f32_16x16x32_bf16 v[120:123], a[140:143], v[188:191], v[204:207]
  v_exp_f32 v70, v70
  v_mfma_f32_16x16x32_bf16 v[120:123], a[136:139], v[184:187], v[120:123]
  buffer_load_dwordx4 v252, s[24:27], s9 offen offset:2048 sc1 lds
  v_mfma_f32_16x16x32_bf16 v[120:123], a[132:135], v[180:183], v[120:123]
  s_waitcnt lgkmcnt(0)
  v_exp_f32 v71, v71
  v_mfma_f32_16x16x32_bf16 v[120:123], a[128:131], v[176:179], v[120:123]
  v_cvt_pk_bf16_f32 v67, v70, v71
  v_mfma_f32_16x16x32_bf16 v[100:103], a[144:147], v[128:131], v[192:195]
  v_exp_f32 v76, v76
  v_mfma_f32_16x16x32_bf16 v[100:103], a[148:151], v[132:135], v[100:103]
  ds_read_b64_tr_b16 a[160:161], v216 offset:32768
  v_mfma_f32_16x16x32_bf16 v[100:103], a[152:155], v[136:139], v[100:103]
  v_exp_f32 v77, v77
  v_mfma_f32_16x16x32_bf16 v[100:103], a[156:159], v[140:143], v[100:103]
  ds_read_b64_tr_b16 a[162:163], v216 offset:36864
  v_cvt_pk_bf16_f32 v74, v76, v77
  v_mfma_f32_16x16x32_bf16 v[108:111], a[156:159], v[156:159], v[196:199]
  v_exp_f32 v78, v78
  v_mfma_f32_16x16x32_bf16 v[108:111], a[152:155], v[152:155], v[108:111]
  ds_read_b64_tr_b16 a[164:165], v216 offset:40960
  buffer_load_dwordx4 v252, s[24:27], s9 offen offset:3072 sc1 lds
  v_mfma_f32_16x16x32_bf16 v[108:111], a[148:151], v[148:151], v[108:111]
  v_exp_f32 v79, v79
  v_mfma_f32_16x16x32_bf16 v[108:111], a[144:147], v[144:147], v[108:111]
  ds_read_b64_tr_b16 a[166:167], v216 offset:45056
  v_cvt_pk_bf16_f32 v75, v78, v79
  v_mfma_f32_16x16x32_bf16 v[116:119], a[144:147], v[160:163], v[200:203]
  v_exp_f32 v84, v84
  v_mfma_f32_16x16x32_bf16 v[116:119], a[148:151], v[164:167], v[116:119]
  ds_read_b64_tr_b16 a[168:169], v217 offset:32768
  buffer_load_dwordx4 a[236:239], v252, s[24:27], s4 offen offset:2048 sc1
  v_mfma_f32_16x16x32_bf16 v[116:119], a[152:155], v[168:171], v[116:119]
  v_exp_f32 v85, v85
  v_mfma_f32_16x16x32_bf16 v[116:119], a[156:159], v[172:175], v[116:119]
  ds_read_b64_tr_b16 a[170:171], v217 offset:36864
  v_cvt_pk_bf16_f32 v82, v84, v85
  v_mfma_f32_16x16x32_bf16 v[124:127], a[156:159], v[188:191], v[204:207]
  v_exp_f32 v86, v86
  v_mfma_f32_16x16x32_bf16 v[124:127], a[152:155], v[184:187], v[124:127]
  ds_read_b64_tr_b16 a[172:173], v217 offset:40960
  buffer_load_dwordx4 a[240:243], v252, s[24:27], s4 offen offset:3072 sc1
  v_mfma_f32_16x16x32_bf16 v[124:127], a[148:151], v[180:183], v[124:127]
  v_exp_f32 v87, v87
  v_mfma_f32_16x16x32_bf16 v[124:127], a[144:147], v[176:179], v[124:127]
  ds_read_b64_tr_b16 a[174:175], v217 offset:45056
  v_cvt_pk_bf16_f32 v83, v86, v87
  v_mfma_f32_16x16x32_bf16 a[192:195], a[208:211], v[0:3], a[192:195]
  v_exp_f32 v92, v92
  v_mfma_f32_16x16x32_bf16 a[192:195], a[208:211], v[32:35], a[192:195]
  ds_read_b64_tr_b16 a[176:177], v218 offset:32768
  buffer_load_dwordx4 a[244:247], v253, s[24:27], s4 offen offset:0 sc1
  v_mfma_f32_16x16x32_bf16 a[196:199], a[208:211], v[8:11], a[196:199]
  v_exp_f32 v93, v93
  v_mfma_f32_16x16x32_bf16 a[196:199], a[208:211], v[40:43], a[196:199]
  ds_read_b64_tr_b16 a[178:179], v218 offset:36864
  v_cvt_pk_bf16_f32 v90, v92, v93
  v_mfma_f32_16x16x32_bf16 a[200:203], a[208:211], v[16:19], a[200:203]
  v_exp_f32 v94, v94
  v_mfma_f32_16x16x32_bf16 a[200:203], a[208:211], v[48:51], a[200:203]
  ds_read_b64_tr_b16 a[180:181], v218 offset:40960
  buffer_load_dwordx4 a[248:251], v253, s[24:27], s4 offen offset:1024 sc1
  v_mfma_f32_16x16x32_bf16 a[204:207], a[208:211], v[24:27], a[204:207]
  s_waitcnt lgkmcnt(7)
  v_exp_f32 v95, v95
  v_mfma_f32_16x16x32_bf16 a[204:207], a[208:211], v[56:59], a[204:207]
  ds_read_b64_tr_b16 a[182:183], v218 offset:45056
  v_cvt_pk_bf16_f32 v91, v94, v95
  v_mfma_f32_16x16x32_bf16 a[0:3], a[160:163], v[0:3], a[0:3]
  v_exp_f32 v96, v96
  v_mfma_f32_16x16x32_bf16 a[0:3], a[164:167], v[32:35], a[0:3]
  ds_read_b64_tr_b16 a[184:185], v219 offset:32768
  buffer_load_dwordx4 a[252:255], v253, s[24:27], s4 offen offset:2048 sc1
  v_mfma_f32_16x16x32_bf16 a[4:7], a[164:167], v[40:43], a[4:7]
  v_exp_f32 v97, v97
  v_mfma_f32_16x16x32_bf16 a[4:7], a[160:163], v[8:11], a[4:7]
  ds_read_b64_tr_b16 a[186:187], v219 offset:36864
  v_cvt_pk_bf16_f32 v96, v96, v97
  v_mfma_f32_16x16x32_bf16 a[8:11], a[160:163], v[16:19], a[8:11]
  v_exp_f32 v98, v98
  v_mfma_f32_16x16x32_bf16 a[8:11], a[164:167], v[48:51], a[8:11]
  ds_read_b64_tr_b16 a[188:189], v219 offset:40960
  buffer_load_dwordx4 a[128:131], v253, s[24:27], s4 offen offset:3072 sc1
  v_mfma_f32_16x16x32_bf16 a[12:15], a[164:167], v[56:59], a[12:15]
  s_waitcnt lgkmcnt(7)
  v_exp_f32 v99, v99
  v_mfma_f32_16x16x32_bf16 a[12:15], a[160:163], v[24:27], a[12:15]
  ds_read_b64_tr_b16 a[190:191], v219 offset:45056
  v_cvt_pk_bf16_f32 v97, v98, v99
  v_mfma_f32_16x16x32_bf16 a[16:19], a[168:171], v[0:3], a[16:19]
  v_exp_f32 v104, v104
  v_mfma_f32_16x16x32_bf16 a[16:19], a[172:175], v[32:35], a[16:19]
  ds_read_b64_tr_b16 a[160:161], v220 offset:32768
  buffer_load_dwordx4 a[132:135], v242, s[24:27], s5 offen offset:0 sc1
  v_mfma_f32_16x16x32_bf16 a[20:23], a[172:175], v[40:43], a[20:23]
  v_exp_f32 v105, v105
  v_mfma_f32_16x16x32_bf16 a[20:23], a[168:171], v[8:11], a[20:23]
  ds_read_b64_tr_b16 a[162:163], v220 offset:36864
  v_cvt_pk_bf16_f32 v104, v104, v105
  v_mfma_f32_16x16x32_bf16 a[24:27], a[168:171], v[16:19], a[24:27]
  v_exp_f32 v106, v106
  v_mfma_f32_16x16x32_bf16 a[24:27], a[172:175], v[48:51], a[24:27]
  ds_read_b64_tr_b16 a[164:165], v220 offset:40960
  buffer_load_dwordx4 a[136:139], v242, s[24:27], s5 offen offset:1024 sc1
  v_mfma_f32_16x16x32_bf16 a[28:31], a[172:175], v[56:59], a[28:31]
  s_waitcnt lgkmcnt(7)
  v_exp_f32 v107, v107
  v_mfma_f32_16x16x32_bf16 a[28:31], a[168:171], v[24:27], a[28:31]
  ds_read_b64_tr_b16 a[166:167], v220 offset:45056
  v_cvt_pk_bf16_f32 v105, v106, v107
  v_mfma_f32_16x16x32_bf16 a[32:35], a[176:179], v[0:3], a[32:35]
  v_exp_f32 v112, v112
  v_mfma_f32_16x16x32_bf16 a[32:35], a[180:183], v[32:35], a[32:35]
  ds_read_b64_tr_b16 a[168:169], v221 offset:32768
  buffer_load_dwordx4 a[140:143], v242, s[24:27], s5 offen offset:2048 sc1
  v_mfma_f32_16x16x32_bf16 a[36:39], a[180:183], v[40:43], a[36:39]
  v_exp_f32 v113, v113
  v_mfma_f32_16x16x32_bf16 a[36:39], a[176:179], v[8:11], a[36:39]
  ds_read_b64_tr_b16 a[170:171], v221 offset:36864
  v_cvt_pk_bf16_f32 v112, v112, v113
  v_mfma_f32_16x16x32_bf16 a[40:43], a[176:179], v[16:19], a[40:43]
  v_exp_f32 v114, v114
  v_mfma_f32_16x16x32_bf16 a[40:43], a[180:183], v[48:51], a[40:43]
  ds_read_b64_tr_b16 a[172:173], v221 offset:40960
  buffer_load_dwordx4 a[144:147], v242, s[24:27], s5 offen offset:3072 sc1
  v_mfma_f32_16x16x32_bf16 a[44:47], a[180:183], v[56:59], a[44:47]
  s_waitcnt lgkmcnt(7)
  v_exp_f32 v115, v115
  v_mfma_f32_16x16x32_bf16 a[44:47], a[176:179], v[24:27], a[44:47]
  ds_read_b64_tr_b16 a[174:175], v221 offset:45056
  v_cvt_pk_bf16_f32 v113, v114, v115
  v_mfma_f32_16x16x32_bf16 a[48:51], a[184:187], v[0:3], a[48:51]
  v_exp_f32 v120, v120
  v_mfma_f32_16x16x32_bf16 a[48:51], a[188:191], v[32:35], a[48:51]
  ds_read_b64_tr_b16 a[176:177], v222 offset:32768
  buffer_load_dwordx4 a[148:151], v252, s[24:27], s5 offen offset:0 sc1
  v_mfma_f32_16x16x32_bf16 a[52:55], a[188:191], v[40:43], a[52:55]
  v_exp_f32 v121, v121
  v_mfma_f32_16x16x32_bf16 a[52:55], a[184:187], v[8:11], a[52:55]
  ds_read_b64_tr_b16 a[178:179], v222 offset:36864
  v_cvt_pk_bf16_f32 v120, v120, v121
  v_mfma_f32_16x16x32_bf16 a[56:59], a[184:187], v[16:19], a[56:59]
  v_exp_f32 v122, v122
  v_mfma_f32_16x16x32_bf16 a[56:59], a[188:191], v[48:51], a[56:59]
  ds_read_b64_tr_b16 a[180:181], v222 offset:40960
  v_mfma_f32_16x16x32_bf16 a[60:63], a[188:191], v[56:59], a[60:63]
  s_waitcnt lgkmcnt(7)
  v_exp_f32 v123, v123
  v_mfma_f32_16x16x32_bf16 a[60:63], a[184:187], v[24:27], a[60:63]
  ds_read_b64_tr_b16 a[182:183], v222 offset:45056
  v_cvt_pk_bf16_f32 v121, v122, v123
  v_mfma_f32_16x16x32_bf16 a[64:67], a[160:163], v[0:3], a[64:67]
  v_exp_f32 v100, v100
  v_mfma_f32_16x16x32_bf16 a[64:67], a[164:167], v[32:35], a[64:67]
  ds_read_b64_tr_b16 a[184:185], v223 offset:32768
  buffer_load_dwordx4 a[152:155], v252, s[24:27], s5 offen offset:1024 sc1
  v_mfma_f32_16x16x32_bf16 a[68:71], a[164:167], v[40:43], a[68:71]
  v_exp_f32 v101, v101
  v_mfma_f32_16x16x32_bf16 a[68:71], a[160:163], v[8:11], a[68:71]
  ds_read_b64_tr_b16 a[186:187], v223 offset:36864
  v_cvt_pk_bf16_f32 v98, v100, v101
  v_mfma_f32_16x16x32_bf16 a[72:75], a[160:163], v[16:19], a[72:75]
  v_exp_f32 v102, v102
  v_mfma_f32_16x16x32_bf16 a[72:75], a[164:167], v[48:51], a[72:75]
  ds_read_b64_tr_b16 a[188:189], v223 offset:40960
  buffer_load_dwordx4 a[156:159], v252, s[24:27], s5 offen offset:2048 sc1
  v_mfma_f32_16x16x32_bf16 a[76:79], a[164:167], v[56:59], a[76:79]
  s_waitcnt lgkmcnt(7)
  v_exp_f32 v103, v103
  v_mfma_f32_16x16x32_bf16 a[76:79], a[160:163], v[24:27], a[76:79]
  ds_read_b64_tr_b16 a[190:191], v223 offset:45056
  v_cvt_pk_bf16_f32 v99, v102, v103
  v_mfma_f32_16x16x32_bf16 a[80:83], a[168:171], v[0:3], a[80:83]
  s_waitcnt vmcnt(27)
  v_exp_f32 v108, v108
  v_mfma_f32_16x16x32_bf16 a[80:83], a[172:175], v[32:35], a[80:83]
  v_mfma_f32_16x16x32_bf16 a[84:87], a[172:175], v[40:43], a[84:87]
  s_barrier
  v_exp_f32 v109, v109
  v_mfma_f32_16x16x32_bf16 a[84:87], a[168:171], v[8:11], a[84:87]
  s_mul_i32 s39, s99, 13108
  s_lshr_b32 s39, s39, 16
  s_lshl_b32 s39, s39, 8
  v_cvt_pk_bf16_f32 v106, v108, v109
  v_mfma_f32_16x16x32_bf16 a[88:91], a[168:171], v[16:19], a[88:91]
  s_add_u32 s39, s39, 2818304
  s_cmp_lt_u32 s2, 240
  s_cselect_b32 s48, 0, 1073741824
  v_exp_f32 v110, v110
  v_mfma_f32_16x16x32_bf16 a[88:91], a[172:175], v[48:51], a[88:91]
  v_or_b32 v249, s48, v251
  v_mfma_f32_16x16x32_bf16 a[92:95], a[172:175], v[56:59], a[92:95]
  s_waitcnt lgkmcnt(4)
  v_exp_f32 v111, v111
  v_mfma_f32_16x16x32_bf16 a[92:95], a[168:171], v[24:27], a[92:95]
  buffer_atomic_add v250, v249, s[24:27], s39 offen
  v_cvt_pk_bf16_f32 v107, v110, v111
  v_mfma_f32_16x16x32_bf16 a[96:99], a[176:179], v[0:3], a[96:99]
  v_exp_f32 v116, v116
  v_mfma_f32_16x16x32_bf16 a[96:99], a[180:183], v[32:35], a[96:99]
  v_mfma_f32_16x16x32_bf16 a[100:103], a[180:183], v[40:43], a[100:103]
  v_exp_f32 v117, v117
  v_mfma_f32_16x16x32_bf16 a[100:103], a[176:179], v[8:11], a[100:103]
  v_cvt_pk_bf16_f32 v114, v116, v117
  v_mfma_f32_16x16x32_bf16 a[104:107], a[176:179], v[16:19], a[104:107]
  v_exp_f32 v118, v118
  v_mfma_f32_16x16x32_bf16 a[104:107], a[180:183], v[48:51], a[104:107]
  v_mfma_f32_16x16x32_bf16 a[108:111], a[180:183], v[56:59], a[108:111]
  s_waitcnt lgkmcnt(0)
  v_exp_f32 v119, v119
  v_mfma_f32_16x16x32_bf16 a[108:111], a[176:179], v[24:27], a[108:111]
  v_cvt_pk_bf16_f32 v115, v118, v119
  v_mfma_f32_16x16x32_bf16 a[112:115], a[184:187], v[0:3], a[112:115]
  v_exp_f32 v124, v124
  v_mfma_f32_16x16x32_bf16 a[112:115], a[188:191], v[32:35], a[112:115]
  v_mfma_f32_16x16x32_bf16 a[116:119], a[188:191], v[40:43], a[116:119]
  v_exp_f32 v125, v125
  v_mfma_f32_16x16x32_bf16 a[116:119], a[184:187], v[8:11], a[116:119]
  v_cvt_pk_bf16_f32 v122, v124, v125
  v_mfma_f32_16x16x32_bf16 a[120:123], a[184:187], v[16:19], a[120:123]
  v_exp_f32 v126, v126
  v_mfma_f32_16x16x32_bf16 a[120:123], a[188:191], v[48:51], a[120:123]
  v_mfma_f32_16x16x32_bf16 a[124:127], a[188:191], v[56:59], a[124:127]
  s_waitcnt vmcnt(5)
  v_exp_f32 v127, v127
  v_mfma_f32_16x16x32_bf16 a[124:127], a[184:187], v[24:27], a[124:127]
  v_cvt_pk_bf16_f32 v123, v126, v127
  ds_read_b64_tr_b16 a[160:161], v216 offset:49152
  ds_read_b64_tr_b16 a[162:163], v216 offset:53248
  ds_read_b64_tr_b16 a[164:165], v216 offset:57344
  ds_read_b64_tr_b16 a[166:167], v216 offset:61440
  ds_read_b64_tr_b16 a[168:169], v217 offset:49152
  ds_read_b64_tr_b16 a[170:171], v217 offset:53248
  ds_read_b64_tr_b16 a[172:173], v217 offset:57344
  ds_read_b64_tr_b16 a[174:175], v217 offset:61440
  s_mov_b32 s48, 0x53800000
  s_lshl_b32 s39, s3, 8
  v_mfma_f32_16x16x32_bf16 a[192:195], a[208:211], v[64:67], a[192:195]
  s_add_u32 m0, s28, 81920
  v_mfma_f32_16x16x32_bf16 a[192:195], a[208:211], v[96:99], a[192:195]
  v_mfma_f32_16x16x32_bf16 a[196:199], a[208:211], v[72:75], a[196:199]
  buffer_load_dwordx4 v242, s[24:27], s10 offen offset:0 sc1 lds
  v_mfma_f32_16x16x32_bf16 a[196:199], a[208:211], v[104:107], a[196:199]
  v_mfma_f32_16x16x32_bf16 a[200:203], a[208:211], v[80:83], a[200:203]
  buffer_load_dwordx4 v242, s[24:27], s10 offen offset:1024 sc1 lds
  v_mfma_f32_16x16x32_bf16 a[200:203], a[208:211], v[112:115], a[200:203]
  v_mfma_f32_16x16x32_bf16 a[204:207], a[208:211], v[88:91], a[204:207]
  buffer_load_dwordx4 v242, s[24:27], s10 offen offset:2048 sc1 lds
  v_mfma_f32_16x16x32_bf16 a[204:207], a[208:211], v[120:123], a[204:207]
  s_waitcnt lgkmcnt(4)
  v_mfma_f32_16x16x32_bf16 a[0:3], a[160:163], v[64:67], a[0:3]
  buffer_load_dwordx4 v242, s[24:27], s10 offen offset:3072 sc1 lds
  v_mfma_f32_16x16x32_bf16 a[0:3], a[164:167], v[96:99], a[0:3]
  ds_read_b64_tr_b16 a[176:177], v218 offset:49152
  v_mfma_f32_16x16x32_bf16 a[4:7], a[164:167], v[104:107], a[4:7]
  v_mfma_f32_16x16x32_bf16 a[4:7], a[160:163], v[72:75], a[4:7]
  ds_read_b64_tr_b16 a[178:179], v218 offset:53248
  v_accvgpr_read_b32 v208, a192
  v_mfma_f32_16x16x32_bf16 a[8:11], a[160:163], v[80:83], a[8:11]
  v_accvgpr_read_b32 v209, a196
  v_accvgpr_read_b32 v210, a200
  v_mfma_f32_16x16x32_bf16 a[8:11], a[164:167], v[112:115], a[8:11]
  ds_read_b64_tr_b16 a[180:181], v218 offset:57344
  v_accvgpr_read_b32 v211, a204
  v_mfma_f32_16x16x32_bf16 a[12:15], a[164:167], v[120:123], a[12:15]
  v_mov_b32 v245, v208
  v_mov_b32 v246, v209
  v_mfma_f32_16x16x32_bf16 a[12:15], a[160:163], v[88:91], a[12:15]
  ds_read_b64_tr_b16 a[182:183], v218 offset:61440
  s_waitcnt lgkmcnt(4)
  v_mov_b32 v247, v210
  v_mfma_f32_16x16x32_bf16 a[16:19], a[168:171], v[64:67], a[16:19]
  v_mov_b32 v248, v211
  v_permlane16_swap_b32 v208, v245
  v_mfma_f32_16x16x32_bf16 a[16:19], a[172:175], v[96:99], a[16:19]
  ds_read_b64_tr_b16 a[184:185], v219 offset:49152
  v_permlane16_swap_b32 v209, v246
  v_mfma_f32_16x16x32_bf16 a[20:23], a[172:175], v[104:107], a[20:23]
  v_permlane16_swap_b32 v210, v247
  v_permlane16_swap_b32 v211, v248
  v_mfma_f32_16x16x32_bf16 a[20:23], a[168:171], v[72:75], a[20:23]
  ds_read_b64_tr_b16 a[186:187], v219 offset:53248
  v_add_f32 v208, v208, v245
  v_mfma_f32_16x16x32_bf16 a[24:27], a[168:171], v[80:83], a[24:27]
  v_add_f32 v209, v209, v246
  v_add_f32 v210, v210, v247
  v_mfma_f32_16x16x32_bf16 a[24:27], a[172:175], v[112:115], a[24:27]
  ds_read_b64_tr_b16 a[188:189], v219 offset:57344
  v_add_f32 v211, v211, v248
  v_mfma_f32_16x16x32_bf16 a[28:31], a[172:175], v[120:123], a[28:31]
  v_mov_b32 v245, v208
  v_mov_b32 v246, v209
  v_mfma_f32_16x16x32_bf16 a[28:31], a[168:171], v[88:91], a[28:31]
  ds_read_b64_tr_b16 a[190:191], v219 offset:61440
  s_waitcnt lgkmcnt(4)
  v_mov_b32 v247, v210
  v_mfma_f32_16x16x32_bf16 a[32:35], a[176:179], v[64:67], a[32:35]
  v_mov_b32 v248, v211
  v_permlane32_swap_b32 v208, v245
  v_mfma_f32_16x16x32_bf16 a[32:35], a[180:183], v[96:99], a[32:35]
  ds_read_b64_tr_b16 a[160:161], v220 offset:49152
  v_permlane32_swap_b32 v209, v246
  v_mfma_f32_16x16x32_bf16 a[36:39], a[180:183], v[104:107], a[36:39]
  v_permlane32_swap_b32 v210, v247
  v_permlane32_swap_b32 v211, v248
  v_mfma_f32_16x16x32_bf16 a[36:39], a[176:179], v[72:75], a[36:39]
  ds_read_b64_tr_b16 a[162:163], v220 offset:53248
  v_add_f32 v208, v208, v245
  v_mfma_f32_16x16x32_bf16 a[40:43], a[176:179], v[80:83], a[40:43]
  v_add_f32 v209, v209, v246
  v_add_f32 v210, v210, v247
  v_mfma_f32_16x16x32_bf16 a[40:43], a[180:183], v[112:115], a[40:43]
  ds_read_b64_tr_b16 a[164:165], v220 offset:57344
  v_add_f32 v211, v211, v248
  v_mfma_f32_16x16x32_bf16 a[44:47], a[180:183], v[120:123], a[44:47]
  v_rcp_f32 v192, v208
  v_mfma_f32_16x16x32_bf16 a[44:47], a[176:179], v[88:91], a[44:47]
  ds_read_b64_tr_b16 a[166:167], v220 offset:61440
  s_waitcnt lgkmcnt(4)
  v_mfma_f32_16x16x32_bf16 a[48:51], a[184:187], v[64:67], a[48:51]
  v_rcp_f32 v196, v209
  v_mfma_f32_16x16x32_bf16 a[48:51], a[188:191], v[96:99], a[48:51]
  ds_read_b64_tr_b16 a[168:169], v221 offset:49152
  v_mfma_f32_16x16x32_bf16 a[52:55], a[188:191], v[104:107], a[52:55]
  v_rcp_f32 v200, v210
  v_mfma_f32_16x16x32_bf16 a[52:55], a[184:187], v[72:75], a[52:55]
  ds_read_b64_tr_b16 a[170:171], v221 offset:53248
  v_mfma_f32_16x16x32_bf16 a[56:59], a[184:187], v[80:83], a[56:59]
  v_rcp_f32 v204, v211
  v_mfma_f32_16x16x32_bf16 a[56:59], a[188:191], v[112:115], a[56:59]
  ds_read_b64_tr_b16 a[172:173], v221 offset:57344
  v_add_f32 v246, v208, v209
  v_mfma_f32_16x16x32_bf16 a[60:63], a[188:191], v[120:123], a[60:63]
  v_add_f32 v247, v210, v211
  v_add_f32 v246, v246, v247
  v_mfma_f32_16x16x32_bf16 a[60:63], a[184:187], v[88:91], a[60:63]
  ds_read_b64_tr_b16 a[174:175], v221 offset:61440
  s_waitcnt lgkmcnt(4)
  v_lshrrev_b32 v247, 2, v242
  v_mfma_f32_16x16x32_bf16 a[64:67], a[160:163], v[64:67], a[64:67]
  v_cmp_nlt_f32 vcc, v246, s48
  v_add_u32 v247, s39, v247
  v_mfma_f32_16x16x32_bf16 a[64:67], a[164:167], v[96:99], a[64:67]
  ds_read_b64_tr_b16 a[176:177], v222 offset:49152
  v_add_u32 v247, 157696, v247
  v_mfma_f32_16x16x32_bf16 a[68:71], a[164:167], v[104:107], a[68:71]
  v_cndmask_b32_e64 v245, 0, 1, vcc
  v_accvgpr_read_b32 v0, a0
  v_mfma_f32_16x16x32_bf16 a[68:71], a[160:163], v[72:75], a[68:71]
  ds_read_b64_tr_b16 a[178:179], v222 offset:53248
  v_accvgpr_read_b32 v1, a1
  v_mfma_f32_16x16x32_bf16 a[72:75], a[160:163], v[80:83], a[72:75]
  v_accvgpr_read_b32 v2, a2
  v_accvgpr_read_b32 v3, a3
  v_mfma_f32_16x16x32_bf16 a[72:75], a[164:167], v[112:115], a[72:75]
  ds_read_b64_tr_b16 a[180:181], v222 offset:57344
  v_accvgpr_read_b32 v4, a16
  v_mfma_f32_16x16x32_bf16 a[76:79], a[164:167], v[120:123], a[76:79]
  v_accvgpr_read_b32 v5, a17
  v_accvgpr_read_b32 v6, a18
  v_mfma_f32_16x16x32_bf16 a[76:79], a[160:163], v[88:91], a[76:79]
  ds_read_b64_tr_b16 a[182:183], v222 offset:61440
  s_waitcnt lgkmcnt(4)
  v_accvgpr_read_b32 v7, a19
  v_mfma_f32_16x16x32_bf16 a[80:83], a[168:171], v[64:67], a[80:83]
  v_mul_f32 v0, v0, v192
  v_mul_f32 v1, v1, v192
  v_mfma_f32_16x16x32_bf16 a[80:83], a[172:175], v[96:99], a[80:83]
  ds_read_b64_tr_b16 a[184:185], v223 offset:49152
  v_mul_f32 v2, v2, v192
  v_mfma_f32_16x16x32_bf16 a[84:87], a[172:175], v[104:107], a[84:87]
  v_mul_f32 v3, v3, v192
  v_mul_f32 v4, v4, v192
  v_mfma_f32_16x16x32_bf16 a[84:87], a[168:171], v[72:75], a[84:87]
  ds_read_b64_tr_b16 a[186:187], v223 offset:53248
  v_mul_f32 v5, v5, v192
  v_mfma_f32_16x16x32_bf16 a[88:91], a[168:171], v[80:83], a[88:91]
  v_mul_f32 v6, v6, v192
  v_mul_f32 v7, v7, v192
  v_mfma_f32_16x16x32_bf16 a[88:91], a[172:175], v[112:115], a[88:91]
  ds_read_b64_tr_b16 a[188:189], v223 offset:57344
  v_cvt_pk_bf16_f32 v0, v0, v1
  v_mfma_f32_16x16x32_bf16 a[92:95], a[172:175], v[120:123], a[92:95]
  v_cvt_pk_bf16_f32 v1, v2, v3
  v_cvt_pk_bf16_f32 v2, v4, v5
  v_mfma_f32_16x16x32_bf16 a[92:95], a[168:171], v[88:91], a[92:95]
  ds_read_b64_tr_b16 a[190:191], v223 offset:61440
  s_waitcnt lgkmcnt(4)
  v_cvt_pk_bf16_f32 v3, v6, v7
  v_mfma_f32_16x16x32_bf16 a[96:99], a[176:179], v[64:67], a[96:99]
  buffer_store_dwordx4 v[0:3], v244, s[24:27], s40 offen offset:0 sc1
  v_mfma_f32_16x16x32_bf16 a[96:99], a[180:183], v[96:99], a[96:99]
  v_accvgpr_read_b32 v8, a4
  v_accvgpr_read_b32 v9, a5
  v_mfma_f32_16x16x32_bf16 a[100:103], a[180:183], v[104:107], a[100:103]
  v_accvgpr_read_b32 v10, a6
  v_accvgpr_read_b32 v11, a7
  v_mfma_f32_16x16x32_bf16 a[100:103], a[176:179], v[72:75], a[100:103]
  v_accvgpr_read_b32 v12, a20
  v_accvgpr_read_b32 v13, a21
  v_mfma_f32_16x16x32_bf16 a[104:107], a[176:179], v[80:83], a[104:107]
  v_accvgpr_read_b32 v14, a22
  v_accvgpr_read_b32 v15, a23
  v_mfma_f32_16x16x32_bf16 a[104:107], a[180:183], v[112:115], a[104:107]
  v_mul_f32 v8, v8, v196
  v_mul_f32 v9, v9, v196
  v_mfma_f32_16x16x32_bf16 a[108:111], a[180:183], v[120:123], a[108:111]
  v_mul_f32 v10, v10, v196
  v_mul_f32 v11, v11, v196
  v_mfma_f32_16x16x32_bf16 a[108:111], a[176:179], v[88:91], a[108:111]
  s_waitcnt lgkmcnt(0)
  v_mul_f32 v12, v12, v196
  v_mul_f32 v13, v13, v196
  v_mfma_f32_16x16x32_bf16 a[112:115], a[184:187], v[64:67], a[112:115]
  v_mul_f32 v14, v14, v196
  v_mul_f32 v15, v15, v196
  v_mfma_f32_16x16x32_bf16 a[112:115], a[188:191], v[96:99], a[112:115]
  v_cvt_pk_bf16_f32 v8, v8, v9
  v_cvt_pk_bf16_f32 v9, v10, v11
  v_mfma_f32_16x16x32_bf16 a[116:119], a[188:191], v[104:107], a[116:119]
  v_cvt_pk_bf16_f32 v10, v12, v13
  v_cvt_pk_bf16_f32 v11, v14, v15
  v_mfma_f32_16x16x32_bf16 a[116:119], a[184:187], v[72:75], a[116:119]
  buffer_store_dwordx4 v[8:11], v244, s[24:27], s40 offen offset:2048 sc1
  v_mfma_f32_16x16x32_bf16 a[120:123], a[184:187], v[80:83], a[120:123]
  v_accvgpr_read_b32 v16, a8
  v_accvgpr_read_b32 v17, a9
  v_mfma_f32_16x16x32_bf16 a[120:123], a[188:191], v[112:115], a[120:123]
  v_accvgpr_read_b32 v18, a10
  v_accvgpr_read_b32 v19, a11
  v_mfma_f32_16x16x32_bf16 a[124:127], a[188:191], v[120:123], a[124:127]
  v_accvgpr_read_b32 v20, a24
  v_accvgpr_read_b32 v21, a25
  v_mfma_f32_16x16x32_bf16 a[124:127], a[184:187], v[88:91], a[124:127]
  v_accvgpr_read_b32 v22, a26
  v_accvgpr_read_b32 v23, a27
  v_pk_mul_f32 v[16:17], v[16:17], v[200:201] op_sel_hi:[1,0]
  v_pk_mul_f32 v[18:19], v[18:19], v[200:201] op_sel_hi:[1,0]
  v_pk_mul_f32 v[20:21], v[20:21], v[200:201] op_sel_hi:[1,0]
  v_pk_mul_f32 v[22:23], v[22:23], v[200:201] op_sel_hi:[1,0]
  v_cvt_pk_bf16_f32 v16, v16, v17
  v_cvt_pk_bf16_f32 v17, v18, v19
  v_cvt_pk_bf16_f32 v18, v20, v21
  v_cvt_pk_bf16_f32 v19, v22, v23
  buffer_store_dwordx4 v[16:19], v244, s[24:27], s41 offen offset:0 sc1
  v_accvgpr_read_b32 v24, a12
  v_accvgpr_read_b32 v25, a13
  v_accvgpr_read_b32 v26, a14
  v_accvgpr_read_b32 v27, a15
  v_accvgpr_read_b32 v28, a28
  v_accvgpr_read_b32 v29, a29
  v_accvgpr_read_b32 v30, a30
  v_accvgpr_read_b32 v31, a31
  v_pk_mul_f32 v[24:25], v[24:25], v[204:205] op_sel_hi:[1,0]
  v_pk_mul_f32 v[26:27], v[26:27], v[204:205] op_sel_hi:[1,0]
  v_pk_mul_f32 v[28:29], v[28:29], v[204:205] op_sel_hi:[1,0]
  v_pk_mul_f32 v[30:31], v[30:31], v[204:205] op_sel_hi:[1,0]
  v_cvt_pk_bf16_f32 v24, v24, v25
  v_cvt_pk_bf16_f32 v25, v26, v27
  v_cvt_pk_bf16_f32 v26, v28, v29
  v_cvt_pk_bf16_f32 v27, v30, v31
  buffer_store_dwordx4 v[24:27], v244, s[24:27], s41 offen offset:2048 sc1
  v_accvgpr_read_b32 v32, a32
  v_accvgpr_read_b32 v33, a33
  v_accvgpr_read_b32 v34, a34
  v_accvgpr_read_b32 v35, a35
  v_accvgpr_read_b32 v36, a48
  v_accvgpr_read_b32 v37, a49
  v_accvgpr_read_b32 v38, a50
  v_accvgpr_read_b32 v39, a51
  v_pk_mul_f32 v[32:33], v[32:33], v[192:193] op_sel_hi:[1,0]
  v_pk_mul_f32 v[34:35], v[34:35], v[192:193] op_sel_hi:[1,0]
  v_pk_mul_f32 v[36:37], v[36:37], v[192:193] op_sel_hi:[1,0]
  v_pk_mul_f32 v[38:39], v[38:39], v[192:193] op_sel_hi:[1,0]
  v_cvt_pk_bf16_f32 v32, v32, v33
  v_cvt_pk_bf16_f32 v33, v34, v35
  v_cvt_pk_bf16_f32 v34, v36, v37
  v_cvt_pk_bf16_f32 v35, v38, v39
  buffer_store_dwordx4 v[32:35], v244, s[24:27], s40 offen offset:1024 sc1
  v_accvgpr_read_b32 v40, a36
  v_accvgpr_read_b32 v41, a37
  v_accvgpr_read_b32 v42, a38
  v_accvgpr_read_b32 v43, a39
  v_accvgpr_read_b32 v44, a52
  v_accvgpr_read_b32 v45, a53
  v_accvgpr_read_b32 v46, a54
  v_accvgpr_read_b32 v47, a55
  v_pk_mul_f32 v[40:41], v[40:41], v[196:197] op_sel_hi:[1,0]
  v_pk_mul_f32 v[42:43], v[42:43], v[196:197] op_sel_hi:[1,0]
  v_pk_mul_f32 v[44:45], v[44:45], v[196:197] op_sel_hi:[1,0]
  v_pk_mul_f32 v[46:47], v[46:47], v[196:197] op_sel_hi:[1,0]
  v_cvt_pk_bf16_f32 v40, v40, v41
  v_cvt_pk_bf16_f32 v41, v42, v43
  v_cvt_pk_bf16_f32 v42, v44, v45
  v_cvt_pk_bf16_f32 v43, v46, v47
  buffer_store_dwordx4 v[40:43], v244, s[24:27], s40 offen offset:3072 sc1
  v_accvgpr_read_b32 v48, a40
  v_accvgpr_read_b32 v49, a41
  v_accvgpr_read_b32 v50, a42
  v_accvgpr_read_b32 v51, a43
  v_accvgpr_read_b32 v52, a56
  v_accvgpr_read_b32 v53, a57
  v_accvgpr_read_b32 v54, a58
  v_accvgpr_read_b32 v55, a59
  v_pk_mul_f32 v[48:49], v[48:49], v[200:201] op_sel_hi:[1,0]
  v_pk_mul_f32 v[50:51], v[50:51], v[200:201] op_sel_hi:[1,0]
  v_pk_mul_f32 v[52:53], v[52:53], v[200:201] op_sel_hi:[1,0]
  v_pk_mul_f32 v[54:55], v[54:55], v[200:201] op_sel_hi:[1,0]
  v_cvt_pk_bf16_f32 v48, v48, v49
  v_cvt_pk_bf16_f32 v49, v50, v51
  v_cvt_pk_bf16_f32 v50, v52, v53
  v_cvt_pk_bf16_f32 v51, v54, v55
  buffer_store_dwordx4 v[48:51], v244, s[24:27], s41 offen offset:1024 sc1
  v_accvgpr_read_b32 v56, a44
  v_accvgpr_read_b32 v57, a45
  v_accvgpr_read_b32 v58, a46
  v_accvgpr_read_b32 v59, a47
  v_accvgpr_read_b32 v60, a60
  v_accvgpr_read_b32 v61, a61
  v_accvgpr_read_b32 v62, a62
  v_accvgpr_read_b32 v63, a63
  v_pk_mul_f32 v[56:57], v[56:57], v[204:205] op_sel_hi:[1,0]
  v_pk_mul_f32 v[58:59], v[58:59], v[204:205] op_sel_hi:[1,0]
  v_pk_mul_f32 v[60:61], v[60:61], v[204:205] op_sel_hi:[1,0]
  v_pk_mul_f32 v[62:63], v[62:63], v[204:205] op_sel_hi:[1,0]
  v_cvt_pk_bf16_f32 v56, v56, v57
  v_cvt_pk_bf16_f32 v57, v58, v59
  v_cvt_pk_bf16_f32 v58, v60, v61
  v_cvt_pk_bf16_f32 v59, v62, v63
  buffer_store_dwordx4 v[56:59], v244, s[24:27], s41 offen offset:3072 sc1
  v_accvgpr_read_b32 v0, a64
  v_accvgpr_read_b32 v1, a65
  v_accvgpr_read_b32 v2, a66
  v_accvgpr_read_b32 v3, a67
  v_accvgpr_read_b32 v4, a80
  v_accvgpr_read_b32 v5, a81
  v_accvgpr_read_b32 v6, a82
  v_accvgpr_read_b32 v7, a83
  v_pk_mul_f32 v[0:1], v[0:1], v[192:193] op_sel_hi:[1,0]
  v_pk_mul_f32 v[2:3], v[2:3], v[192:193] op_sel_hi:[1,0]
  v_pk_mul_f32 v[4:5], v[4:5], v[192:193] op_sel_hi:[1,0]
  v_pk_mul_f32 v[6:7], v[6:7], v[192:193] op_sel_hi:[1,0]
  v_cvt_pk_bf16_f32 v0, v0, v1
  v_cvt_pk_bf16_f32 v1, v2, v3
  v_cvt_pk_bf16_f32 v2, v4, v5
  v_cvt_pk_bf16_f32 v3, v6, v7
  buffer_store_dwordx4 v[0:3], v244, s[24:27], s42 offen offset:0 sc1
  v_accvgpr_read_b32 v8, a68
  v_accvgpr_read_b32 v9, a69
  v_accvgpr_read_b32 v10, a70
  v_accvgpr_read_b32 v11, a71
  v_accvgpr_read_b32 v12, a84
  v_accvgpr_read_b32 v13, a85
  v_accvgpr_read_b32 v14, a86
  v_accvgpr_read_b32 v15, a87
  v_pk_mul_f32 v[8:9], v[8:9], v[196:197] op_sel_hi:[1,0]
  v_pk_mul_f32 v[10:11], v[10:11], v[196:197] op_sel_hi:[1,0]
  v_pk_mul_f32 v[12:13], v[12:13], v[196:197] op_sel_hi:[1,0]
  v_pk_mul_f32 v[14:15], v[14:15], v[196:197] op_sel_hi:[1,0]
  v_cvt_pk_bf16_f32 v8, v8, v9
  v_cvt_pk_bf16_f32 v9, v10, v11
  v_cvt_pk_bf16_f32 v10, v12, v13
  v_cvt_pk_bf16_f32 v11, v14, v15
  buffer_store_dwordx4 v[8:11], v244, s[24:27], s42 offen offset:2048 sc1
  v_accvgpr_read_b32 v16, a72
  v_accvgpr_read_b32 v17, a73
  v_accvgpr_read_b32 v18, a74
  v_accvgpr_read_b32 v19, a75
  v_accvgpr_read_b32 v20, a88
  v_accvgpr_read_b32 v21, a89
  v_accvgpr_read_b32 v22, a90
  v_accvgpr_read_b32 v23, a91
  v_pk_mul_f32 v[16:17], v[16:17], v[200:201] op_sel_hi:[1,0]
  v_pk_mul_f32 v[18:19], v[18:19], v[200:201] op_sel_hi:[1,0]
  v_pk_mul_f32 v[20:21], v[20:21], v[200:201] op_sel_hi:[1,0]
  v_pk_mul_f32 v[22:23], v[22:23], v[200:201] op_sel_hi:[1,0]
  v_cvt_pk_bf16_f32 v16, v16, v17
  v_cvt_pk_bf16_f32 v17, v18, v19
  v_cvt_pk_bf16_f32 v18, v20, v21
  v_cvt_pk_bf16_f32 v19, v22, v23
  buffer_store_dwordx4 v[16:19], v244, s[24:27], s43 offen offset:0 sc1
  v_accvgpr_read_b32 v24, a76
  v_accvgpr_read_b32 v25, a77
  v_accvgpr_read_b32 v26, a78
  v_accvgpr_read_b32 v27, a79
  v_accvgpr_read_b32 v28, a92
  v_accvgpr_read_b32 v29, a93
  v_accvgpr_read_b32 v30, a94
  v_accvgpr_read_b32 v31, a95
  v_pk_mul_f32 v[24:25], v[24:25], v[204:205] op_sel_hi:[1,0]
  v_pk_mul_f32 v[26:27], v[26:27], v[204:205] op_sel_hi:[1,0]
  v_pk_mul_f32 v[28:29], v[28:29], v[204:205] op_sel_hi:[1,0]
  v_pk_mul_f32 v[30:31], v[30:31], v[204:205] op_sel_hi:[1,0]
  v_cvt_pk_bf16_f32 v24, v24, v25
  v_cvt_pk_bf16_f32 v25, v26, v27
  v_cvt_pk_bf16_f32 v26, v28, v29
  v_cvt_pk_bf16_f32 v27, v30, v31
  buffer_store_dwordx4 v[24:27], v244, s[24:27], s43 offen offset:2048 sc1
  v_accvgpr_read_b32 v32, a96
  v_accvgpr_read_b32 v33, a97
  v_accvgpr_read_b32 v34, a98
  v_accvgpr_read_b32 v35, a99
  v_accvgpr_read_b32 v36, a112
  v_accvgpr_read_b32 v37, a113
  v_accvgpr_read_b32 v38, a114
  v_accvgpr_read_b32 v39, a115
  v_pk_mul_f32 v[32:33], v[32:33], v[192:193] op_sel_hi:[1,0]
  v_pk_mul_f32 v[34:35], v[34:35], v[192:193] op_sel_hi:[1,0]
  v_pk_mul_f32 v[36:37], v[36:37], v[192:193] op_sel_hi:[1,0]
  v_pk_mul_f32 v[38:39], v[38:39], v[192:193] op_sel_hi:[1,0]
  v_cvt_pk_bf16_f32 v32, v32, v33
  v_cvt_pk_bf16_f32 v33, v34, v35
  v_cvt_pk_bf16_f32 v34, v36, v37
  v_cvt_pk_bf16_f32 v35, v38, v39
  buffer_store_dwordx4 v[32:35], v244, s[24:27], s42 offen offset:1024 sc1
  v_accvgpr_read_b32 v40, a100
  v_accvgpr_read_b32 v41, a101
  v_accvgpr_read_b32 v42, a102
  v_accvgpr_read_b32 v43, a103
  v_accvgpr_read_b32 v44, a116
  v_accvgpr_read_b32 v45, a117
  v_accvgpr_read_b32 v46, a118
  v_accvgpr_read_b32 v47, a119
  v_pk_mul_f32 v[40:41], v[40:41], v[196:197] op_sel_hi:[1,0]
  v_pk_mul_f32 v[42:43], v[42:43], v[196:197] op_sel_hi:[1,0]
  v_pk_mul_f32 v[44:45], v[44:45], v[196:197] op_sel_hi:[1,0]
  v_pk_mul_f32 v[46:47], v[46:47], v[196:197] op_sel_hi:[1,0]
  v_cvt_pk_bf16_f32 v40, v40, v41
  v_cvt_pk_bf16_f32 v41, v42, v43
  v_cvt_pk_bf16_f32 v42, v44, v45
  v_cvt_pk_bf16_f32 v43, v46, v47
  buffer_store_dwordx4 v[40:43], v244, s[24:27], s42 offen offset:3072 sc1
  v_accvgpr_read_b32 v48, a104
  v_accvgpr_read_b32 v49, a105
  v_accvgpr_read_b32 v50, a106
  v_accvgpr_read_b32 v51, a107
  v_accvgpr_read_b32 v52, a120
  v_accvgpr_read_b32 v53, a121
  v_accvgpr_read_b32 v54, a122
  v_accvgpr_read_b32 v55, a123
  v_pk_mul_f32 v[48:49], v[48:49], v[200:201] op_sel_hi:[1,0]
  v_pk_mul_f32 v[50:51], v[50:51], v[200:201] op_sel_hi:[1,0]
  v_pk_mul_f32 v[52:53], v[52:53], v[200:201] op_sel_hi:[1,0]
  v_pk_mul_f32 v[54:55], v[54:55], v[200:201] op_sel_hi:[1,0]
  v_cvt_pk_bf16_f32 v48, v48, v49
  v_cvt_pk_bf16_f32 v49, v50, v51
  v_cvt_pk_bf16_f32 v50, v52, v53
  v_cvt_pk_bf16_f32 v51, v54, v55
  buffer_store_dwordx4 v[48:51], v244, s[24:27], s43 offen offset:1024 sc1
  v_accvgpr_read_b32 v56, a108
  v_accvgpr_read_b32 v57, a109
  v_accvgpr_read_b32 v58, a110
  v_accvgpr_read_b32 v59, a111
  v_accvgpr_read_b32 v60, a124
  v_accvgpr_read_b32 v61, a125
  v_accvgpr_read_b32 v62, a126
  v_accvgpr_read_b32 v63, a127
  v_pk_mul_f32 v[56:57], v[56:57], v[204:205] op_sel_hi:[1,0]
  v_pk_mul_f32 v[58:59], v[58:59], v[204:205] op_sel_hi:[1,0]
  v_pk_mul_f32 v[60:61], v[60:61], v[204:205] op_sel_hi:[1,0]
  v_pk_mul_f32 v[62:63], v[62:63], v[204:205] op_sel_hi:[1,0]
  v_cvt_pk_bf16_f32 v56, v56, v57
  v_cvt_pk_bf16_f32 v57, v58, v59
  v_cvt_pk_bf16_f32 v58, v60, v61
  v_cvt_pk_bf16_f32 v59, v62, v63
  buffer_store_dwordx4 v[56:59], v244, s[24:27], s43 offen offset:3072 sc1
  ds_write_b32 v247, v245
  buffer_load_dwordx4 a[0:3], v252, s[24:27], s5 offen offset:3072 sc1
  buffer_load_dwordx4 a[4:7], v253, s[24:27], s5 offen offset:0 sc1
  buffer_load_dwordx4 a[8:11], v253, s[24:27], s5 offen offset:1024 sc1
  buffer_load_dwordx4 a[12:15], v253, s[24:27], s5 offen offset:2048 sc1
  buffer_load_dwordx4 a[16:19], v253, s[24:27], s5 offen offset:3072 sc1
  buffer_load_dwordx4 a[20:23], v242, s[24:27], s6 offen offset:0 sc1
  buffer_load_dwordx4 a[24:27], v242, s[24:27], s6 offen offset:1024 sc1
  buffer_load_dwordx4 a[28:31], v242, s[24:27], s6 offen offset:2048 sc1
  buffer_load_dwordx4 a[32:35], v242, s[24:27], s6 offen offset:3072 sc1
  buffer_load_dwordx4 a[36:39], v252, s[24:27], s6 offen offset:0 sc1
  s_lshr_b32 s39, s37, 2
  s_lshl_b32 s39, s39, 3
  s_lshr_b32 s38, s36, 2
  s_add_u32 s39, s39, s38
  s_lshl_b32 s39, s39, 7
  s_add_u32 s39, s39, 2867200
  s_lshl_b32 s38, s3, 26
  v_lshlrev_b32 v64, 22, v242
  v_or_b32 v64, s38, v64
  v_mov_b32 v65, 1
  v_add_u32 v246, 157696, v242
  s_waitcnt vmcnt(10) lgkmcnt(0)
  s_barrier
  ds_read_b128 v[68:71], v246
  s_waitcnt lgkmcnt(0)
  v_or3_b32 v68, v68, v69, v70
  v_or_b32 v68, v68, v71
  v_cmp_ne_u32 vcc, 0, v68
  s_nop 0
  s_cbranch_vccnz attn_redo
tail_go:
  buffer_atomic_add v65, v64, s[24:27], s39 offen
  s_and_b32 s36, s2, 1
  s_bfe_u32 s31, s2, 0x20001
  s_lshl_b32 s31, s31, 2
  s_bfe_u32 s38, s2, 0x20003
  s_add_u32 s31, s31, s38
  s_lshr_b32 s29, s2, 5
  v_mov_b32 v114, v242
  v_add_u32 v115, 0x1000, v114
  v_add_u32 v116, 0x2000, v114
  s_lshl_b32 s38, s36, 2
  s_add_u32 s38, s38, s3
  s_lshl_b32 s30, s38, 16
  buffer_load_dwordx4 a[40:43], v115, s[24:27], s6 offen offset:1024 sc1
  buffer_load_dwordx4 a[44:47], v115, s[24:27], s6 offen offset:2048 sc1
  buffer_load_dwordx4 a[48:51], v115, s[24:27], s6 offen offset:3072 sc1
  buffer_load_dwordx4 a[52:55], v116, s[24:27], s6 offen offset:0 sc1
  v_lshrrev_b32 v125, 4, v114
  v_and_b32 v126, 15, v125
  v_lshrrev_b32 v127, 4, v125
  s_add_u32 s38, s3, 0
  s_and_b32 s38, s38, 3
  s_lshl_b32 s38, s38, 11
  v_add_u32 v110, s38, v114
  s_sub_u32 s38, s3, 0
  s_and_b32 s38, s38, 3
  s_mul_i32 s38, s38, 15360
  s_add_u32 s38, s38, 98304
  v_add_u32 v118, s38, v114
  s_add_u32 s38, s3, 1
  s_and_b32 s38, s38, 3
  s_lshl_b32 s38, s38, 11
  v_add_u32 v111, s38, v114
  s_sub_u32 s38, s3, 1
  s_and_b32 s38, s38, 3
  s_mul_i32 s38, s38, 15360
  s_add_u32 s38, s38, 98304
  v_add_u32 v119, s38, v114
  s_add_u32 s38, s3, 2
  s_and_b32 s38, s38, 3
  s_lshl_b32 s38, s38, 11
  v_add_u32 v112, s38, v114
  s_sub_u32 s38, s3, 2
  s_and_b32 s38, s38, 3
  s_mul_i32 s38, s38, 15360
  s_add_u32 s38, s38, 98304
  v_add_u32 v120, s38, v114
  s_add_u32 s38, s3, 3
  s_and_b32 s38, s38, 3
  s_lshl_b32 s38, s38, 11
  v_add_u32 v113, s38, v114
  s_sub_u32 s38, s3, 3
  s_and_b32 s38, s38, 3
  s_mul_i32 s38, s38, 15360
  s_add_u32 s38, s38, 98304
  v_add_u32 v121, s38, v114
  v_add_u32 v122, s28, v114
  v_add_u32 v135, 0x10000, v122
  s_and_b32 s38, s31, 14
  s_add_u32 s38, s38, s36
  s_lshl_b32 s38, s38, 2
  s_add_u32 s38, s38, s3
  s_lshl_b32 s38, s38, 7
  s_add_u32 s38, s38, 2867200
  s_lshl_b32 s39, s29, 8
  s_add_u32 s39, s39, 2818304
  v_mov_b32 v133, s38
  v_writelane_b32 v133, s39, 1
  v_mov_b32 v134, 4
  v_writelane_b32 v134, 30, 1
  s_lshl_b32 s31, s31, 1
  s_add_u32 s31, s31, s36
  s_add_u32 s30, s30, 8388608
  s_lshl_b32 s38, s31, 19
  s_add_u32 s37, s30, s38
  s_xor_b32 s38, s38, 0x80000
  s_add_u32 s30, s30, s38
  s_lshl_b32 s40, s29, 5
  s_add_u32 s40, s40, s31
  s_lshl_b32 s38, s31, 6
  s_lshl_b32 s39, s3, 4
  s_add_u32 s38, s38, s39
  v_add_u32 v128, s38, v126
  v_mul_u32_u24 v117, 0x500, v128
  v_lshl_add_u32 v117, v127, 3, v117
  s_mul_i32 s38, s29, 160
  v_add_u32 v117, s38, v117
  s_mov_b32 s12, s60
  s_mov_b32 s13, s61
  s_mov_b32 s14, 2621440
  s_mov_b32 s15, 0x20000
  s_mov_b32 s16, s62
  s_mov_b32 s17, s63
  s_mov_b32 s18, 2621440
  s_mov_b32 s19, 0x20000
  s_mul_i32 s38, s31, 81920
  s_lshl_b32 s39, s3, 10
  s_add_u32 s38, s38, s39
  s_mul_i32 s39, s29, 10
  v_lshrrev_b32 v129, 1, v127
  v_add_u32 v129, s39, v129
  v_and_b32 v130, 1, v127
  v_lshlrev_b32 v130, 3, v130
  v_lshl_add_u32 v130, v126, 4, v130
  v_lshrrev_b32 v131, 2, v129
  v_lshl_add_u32 v131, v131, 12, v130
  v_and_b32 v132, 3, v129
  v_lshl_add_u32 v131, v132, 8, v131
  buffer_load_dwordx2 v[156:157], v131, s[24:27], s38 offen sc1
  v_add_u32 v129, 2, v129
  buffer_load_dwordx2 v[80:81], v117, s[12:15], 0 offen offset:0
  v_lshrrev_b32 v131, 2, v129
  v_lshl_add_u32 v131, v131, 12, v130
  v_and_b32 v132, 3, v129
  v_lshl_add_u32 v131, v132, 8, v131
  buffer_load_dwordx2 v[158:159], v131, s[24:27], s38 offen sc1
  v_add_u32 v129, 2, v129
  buffer_load_dwordx2 v[82:83], v117, s[12:15], 0 offen offset:32
  v_lshrrev_b32 v131, 2, v129
  v_lshl_add_u32 v131, v131, 12, v130
  v_and_b32 v132, 3, v129
  v_lshl_add_u32 v131, v132, 8, v131
  buffer_load_dwordx2 v[160:161], v131, s[24:27], s38 offen sc1
  v_add_u32 v129, 2, v129
  buffer_load_dwordx2 v[84:85], v117, s[12:15], 0 offen offset:64
  v_lshrrev_b32 v131, 2, v129
  v_lshl_add_u32 v131, v131, 12, v130
  v_and_b32 v132, 3, v129
  v_lshl_add_u32 v131, v132, 8, v131
  buffer_load_dwordx2 v[162:163], v131, s[24:27], s38 offen sc1
  v_add_u32 v129, 2, v129
  buffer_load_dwordx2 v[86:87], v117, s[12:15], 0 offen offset:96
  v_lshrrev_b32 v131, 2, v129
  v_lshl_add_u32 v131, v131, 12, v130
  v_and_b32 v132, 3, v129
  v_lshl_add_u32 v131, v132, 8, v131
  buffer_load_dwordx2 v[164:165], v131, s[24:27], s38 offen sc1
  v_add_u32 v129, 2, v129
  buffer_load_dwordx2 v[88:89], v117, s[12:15], 0 offen offset:128
  v_mov_b32 v123, 1073741824
  v_bfrev_b32 v124, 1
  v_sub_u32 v128, 0xffff, v128
  s_mov_b32 s34, 0xffff0000
  s_and_b32 s38, s52, 0xffff
  v_cmp_eq_u32 vcc, s38, v128
  v_mov_b32 v129, s52
  v_mov_b32 v130, 0
  v_cndmask_b32 v124, v124, v129, vcc
  v_cndmask_b32 v123, v123, v130, vcc
  s_and_b32 s38, s53, 0xffff
  v_cmp_eq_u32 vcc, s38, v128
  v_mov_b32 v129, s53
  v_mov_b32 v130, 2560
  v_cndmask_b32 v124, v124, v129, vcc
  v_cndmask_b32 v123, v123, v130, vcc
  s_and_b32 s38, s54, 0xffff
  v_cmp_eq_u32 vcc, s38, v128
  v_mov_b32 v129, s54
  v_mov_b32 v130, 5120
  v_cndmask_b32 v124, v124, v129, vcc
  v_cndmask_b32 v123, v123, v130, vcc
  s_and_b32 s38, s55, 0xffff
  v_cmp_eq_u32 vcc, s38, v128
  v_mov_b32 v129, s55
  v_mov_b32 v130, 7680
  v_cndmask_b32 v124, v124, v129, vcc
  v_cndmask_b32 v123, v123, v130, vcc
  s_and_b32 s38, s56, 0xffff
  v_cmp_eq_u32 vcc, s38, v128
  v_mov_b32 v129, s56
  v_mov_b32 v130, 10240
  v_cndmask_b32 v124, v124, v129, vcc
  v_cndmask_b32 v123, v123, v130, vcc
  s_and_b32 s38, s57, 0xffff
  v_cmp_eq_u32 vcc, s38, v128
  v_mov_b32 v129, s57
  v_mov_b32 v130, 12800
  v_cndmask_b32 v124, v124, v129, vcc
  v_cndmask_b32 v123, v123, v130, vcc
  s_and_b32 s38, s58, 0xffff
  v_cmp_eq_u32 vcc, s38, v128
  v_mov_b32 v129, s58
  v_mov_b32 v130, 15360
  v_cndmask_b32 v124, v124, v129, vcc
  v_cndmask_b32 v123, v123, v130, vcc
  s_and_b32 s38, s59, 0xffff
  v_cmp_eq_u32 vcc, s38, v128
  v_mov_b32 v129, s59
  v_mov_b32 v130, 17920
  v_cndmask_b32 v124, v124, v129, vcc
  v_cndmask_b32 v123, v123, v130, vcc
  v_lshl_add_u32 v123, v127, 4, v123
  s_mul_i32 s32, s29, 320
  s_add_u32 s32, s32, 2686976
  v_ashrrev_i32 v129, 31, v124
  v_not_b32 v129, v129
  v_or_b32 v129, 0x80000000, v129
  v_xor_b32 v124, v124, v129
  v_and_b32 v124, s34, v124
  v_mul_f32 v124, 0xbfb8aa3b, v124
  v_exp_f32 v124, v124
  s_nop 0
  v_add_f32 v124, 1.0, v124
  v_rcp_f32 v124, v124
  s_nop 0
  v_cvt_pk_bf16_f32 v124, v124, v124
  v_lshlrev_b32 v124, 16, v124
  buffer_load_dword v128, v133, s[24:27], 0 offen sc1
  buffer_load_dwordx4 a[56:59], v116, s[24:27], s6 offen offset:1024 sc1
  buffer_load_dwordx4 a[60:63], v116, s[24:27], s6 offen offset:2048 sc1
  buffer_load_dwordx4 a[64:67], v116, s[24:27], s6 offen offset:3072 sc1
  buffer_load_dwordx4 a[68:71], v114, s[24:27], s7 offen offset:0 sc1
  buffer_load_dwordx4 a[72:75], v114, s[24:27], s7 offen offset:1024 sc1
  buffer_load_dwordx4 a[76:79], v114, s[24:27], s7 offen offset:2048 sc1
  buffer_load_dwordx4 a[80:83], v114, s[24:27], s7 offen offset:3072 sc1
  buffer_load_dwordx4 a[84:87], v115, s[24:27], s7 offen offset:0 sc1
  buffer_load_dwordx4 a[88:91], v115, s[24:27], s7 offen offset:1024 sc1
  buffer_load_dwordx4 a[92:95], v115, s[24:27], s7 offen offset:2048 sc1
  s_waitcnt vmcnt(20)
  v_lshlrev_b32 v90, 16, v156
  v_and_b32 v91, s34, v156
  v_lshlrev_b32 v92, 16, v157
  v_and_b32 v93, s34, v157
  s_waitcnt vmcnt(18)
  v_lshlrev_b32 v94, 16, v158
  v_and_b32 v95, s34, v158
  v_lshlrev_b32 v96, 16, v159
  v_and_b32 v97, s34, v159
  s_waitcnt vmcnt(16)
  v_lshlrev_b32 v98, 16, v160
  v_and_b32 v99, s34, v160
  v_lshlrev_b32 v100, 16, v161
  v_and_b32 v101, s34, v161
  s_waitcnt vmcnt(14)
  v_lshlrev_b32 v102, 16, v162
  v_and_b32 v103, s34, v162
  v_lshlrev_b32 v104, 16, v163
  v_and_b32 v105, s34, v163
  s_waitcnt vmcnt(12)
  v_lshlrev_b32 v106, 16, v164
  v_and_b32 v107, s34, v164
  v_lshlrev_b32 v108, 16, v165
  v_and_b32 v109, s34, v165
  v_mov_b32 v156, 0
  v_mov_b32 v157, 0
  v_mov_b32 v158, 0
  v_mov_b32 v159, 0
  v_mov_b32 v160, 0
  v_mov_b32 v161, 0
  v_mov_b32 v162, 0
  v_mov_b32 v163, 0
  v_mov_b32 v164, 0
  v_mov_b32 v165, 0
  v_mov_b32 v166, 0
  v_mov_b32 v167, 0
  v_mov_b32 v168, 0
  v_mov_b32 v169, 0
  v_mov_b32 v170, 0
  v_mov_b32 v171, 0
  v_mov_b32 v172, 0
  v_mov_b32 v173, 0
  v_mov_b32 v174, 0
  v_mov_b32 v175, 0
  s_waitcnt vmcnt(10)
  v_cmp_lt_u32 vcc, v128, v134
  s_nop 0
  s_cbranch_vccz tail_ready
  s_waitcnt vmcnt(0)
  s_mov_b32 s35, 32768
  buffer_load_dword v128, v133, s[24:27], 0 offen sc1
  s_sleep 3
  buffer_load_dword v129, v133, s[24:27], 0 offen sc1
  s_sleep 3
tail_spin:
  buffer_load_dword v130, v133, s[24:27], 0 offen sc1
  s_waitcnt vmcnt(2)
  v_cmp_lt_u32 vcc, v128, v134
  s_nop 0
  s_cbranch_vccz tail_ready
  s_sleep 3
  buffer_load_dword v128, v133, s[24:27], 0 offen sc1
  s_waitcnt vmcnt(2)
  v_cmp_lt_u32 vcc, v129, v134
  s_nop 0
  s_cbranch_vccz tail_ready
  s_sleep 3
  buffer_load_dword v129, v133, s[24:27], 0 offen sc1
  s_waitcnt vmcnt(2)
  v_cmp_lt_u32 vcc, v130, v134
  s_nop 0
  s_cbranch_vccz tail_ready
  s_sleep 3
  s_sub_u32 s35, s35, 1
  s_cmp_lg_u32 s35, 0
  s_cbranch_scc1 tail_spin
tail_ready:
  buffer_load_dwordx4 a[180:183], v110, s[24:27], s30 offen offset:0 sc1
  buffer_load_dwordx4 a[184:187], v110, s[24:27], s30 offen offset:1024 sc1
  buffer_load_dwordx4 a[188:191], v111, s[24:27], s30 offen offset:0 sc1
  buffer_load_dwordx4 a[192:195], v111, s[24:27], s30 offen offset:1024 sc1
  buffer_load_dwordx4 a[196:199], v112, s[24:27], s30 offen offset:0 sc1
  buffer_load_dwordx4 a[200:203], v112, s[24:27], s30 offen offset:1024 sc1
  buffer_load_dwordx4 a[204:207], v113, s[24:27], s30 offen offset:0 sc1
  buffer_load_dwordx4 a[208:211], v113, s[24:27], s30 offen offset:1024 sc1
  v_cmp_gt_u32 vcc, 1073741824, v123
  s_nop 0
  s_and_saveexec_b64 s[42:43], vcc
  s_cbranch_execz tail_plain
  s_waitcnt vmcnt(30)
  buffer_load_dwordx4 v[156:159], v123, s[24:27], s32 offen offset:0 sc1
  buffer_load_dwordx4 v[160:163], v123, s[24:27], s32 offen offset:64 sc1
  buffer_load_dwordx4 v[164:167], v123, s[24:27], s32 offen offset:128 sc1
  buffer_load_dwordx4 v[168:171], v123, s[24:27], s32 offen offset:192 sc1
  buffer_load_dwordx4 v[172:175], v123, s[24:27], s32 offen offset:256 sc1
  s_add_u32 s32, s32, 20480
  buffer_load_dwordx4 v[136:139], v123, s[24:27], s32 offen offset:0 sc1
  buffer_load_dwordx4 v[140:143], v123, s[24:27], s32 offen offset:64 sc1
  buffer_load_dwordx4 v[144:147], v123, s[24:27], s32 offen offset:128 sc1
  buffer_load_dwordx4 v[148:151], v123, s[24:27], s32 offen offset:192 sc1
  buffer_load_dwordx4 v[152:155], v123, s[24:27], s32 offen offset:256 sc1
  s_add_u32 s32, s32, 20480
  buffer_load_dwordx4 v[0:3], v123, s[24:27], s32 offen offset:0 sc1
  buffer_load_dwordx4 v[4:7], v123, s[24:27], s32 offen offset:64 sc1
  buffer_load_dwordx4 v[8:11], v123, s[24:27], s32 offen offset:128 sc1
  buffer_load_dwordx4 v[12:15], v123, s[24:27], s32 offen offset:192 sc1
  buffer_load_dwordx4 v[16:19], v123, s[24:27], s32 offen offset:256 sc1
  s_add_u32 s32, s32, 20480
  buffer_load_dwordx4 v[20:23], v123, s[24:27], s32 offen offset:0 sc1
  buffer_load_dwordx4 v[24:27], v123, s[24:27], s32 offen offset:64 sc1
  buffer_load_dwordx4 v[28:31], v123, s[24:27], s32 offen offset:128 sc1
  buffer_load_dwordx4 v[32:35], v123, s[24:27], s32 offen offset:192 sc1
  buffer_load_dwordx4 v[36:39], v123, s[24:27], s32 offen offset:256 sc1
  s_add_u32 s32, s32, 20480
  buffer_load_dwordx4 v[40:43], v123, s[24:27], s32 offen offset:0 sc1
  buffer_load_dwordx4 v[44:47], v123, s[24:27], s32 offen offset:64 sc1
  buffer_load_dwordx4 v[48:51], v123, s[24:27], s32 offen offset:128 sc1
  buffer_load_dwordx4 v[52:55], v123, s[24:27], s32 offen offset:192 sc1
  buffer_load_dwordx4 v[56:59], v123, s[24:27], s32 offen offset:256 sc1
  s_add_u32 s32, s32, 20480
  buffer_load_dwordx4 v[60:63], v123, s[24:27], s32 offen offset:0 sc1
  buffer_load_dwordx4 v[64:67], v123, s[24:27], s32 offen offset:64 sc1
  buffer_load_dwordx4 v[68:71], v123, s[24:27], s32 offen offset:128 sc1
  buffer_load_dwordx4 v[72:75], v123, s[24:27], s32 offen offset:192 sc1
  buffer_load_dwordx4 v[76:79], v123, s[24:27], s32 offen offset:256 sc1
  s_add_u32 s32, s32, 20480
  s_waitcnt vmcnt(0)
  v_add_f32 v156, v156, v136
  v_add_f32 v157, v157, v137
  v_add_f32 v158, v158, v138
  v_add_f32 v159, v159, v139
  v_add_f32 v160, v160, v140
  v_add_f32 v161, v161, v141
  v_add_f32 v162, v162, v142
  v_add_f32 v163, v163, v143
  v_add_f32 v164, v164, v144
  v_add_f32 v165, v165, v145
  v_add_f32 v166, v166, v146
  v_add_f32 v167, v167, v147
  v_add_f32 v168, v168, v148
  v_add_f32 v169, v169, v149
  v_add_f32 v170, v170, v150
  v_add_f32 v171, v171, v151
  v_add_f32 v172, v172, v152
  v_add_f32 v173, v173, v153
  v_add_f32 v174, v174, v154
  v_add_f32 v175, v175, v155
  v_add_f32 v156, v156, v0
  v_add_f32 v157, v157, v1
  v_add_f32 v158, v158, v2
  v_add_f32 v159, v159, v3
  v_add_f32 v160, v160, v4
  v_add_f32 v161, v161, v5
  v_add_f32 v162, v162, v6
  v_add_f32 v163, v163, v7
  v_add_f32 v164, v164, v8
  v_add_f32 v165, v165, v9
  v_add_f32 v166, v166, v10
  v_add_f32 v167, v167, v11
  v_add_f32 v168, v168, v12
  v_add_f32 v169, v169, v13
  v_add_f32 v170, v170, v14
  v_add_f32 v171, v171, v15
  v_add_f32 v172, v172, v16
  v_add_f32 v173, v173, v17
  v_add_f32 v174, v174, v18
  v_add_f32 v175, v175, v19
  v_add_f32 v156, v156, v20
  v_add_f32 v157, v157, v21
  v_add_f32 v158, v158, v22
  v_add_f32 v159, v159, v23
  v_add_f32 v160, v160, v24
  v_add_f32 v161, v161, v25
  v_add_f32 v162, v162, v26
  v_add_f32 v163, v163, v27
  v_add_f32 v164, v164, v28
  v_add_f32 v165, v165, v29
  v_add_f32 v166, v166, v30
  v_add_f32 v167, v167, v31
  v_add_f32 v168, v168, v32
  v_add_f32 v169, v169, v33
  v_add_f32 v170, v170, v34
  v_add_f32 v171, v171, v35
  v_add_f32 v172, v172, v36
  v_add_f32 v173, v173, v37
  v_add_f32 v174, v174, v38
  v_add_f32 v175, v175, v39
  v_add_f32 v156, v156, v40
  v_add_f32 v157, v157, v41
  v_add_f32 v158, v158, v42
  v_add_f32 v159, v159, v43
  v_add_f32 v160, v160, v44
  v_add_f32 v161, v161, v45
  v_add_f32 v162, v162, v46
  v_add_f32 v163, v163, v47
  v_add_f32 v164, v164, v48
  v_add_f32 v165, v165, v49
  v_add_f32 v166, v166, v50
  v_add_f32 v167, v167, v51
  v_add_f32 v168, v168, v52
  v_add_f32 v169, v169, v53
  v_add_f32 v170, v170, v54
  v_add_f32 v171, v171, v55
  v_add_f32 v172, v172, v56
  v_add_f32 v173, v173, v57
  v_add_f32 v174, v174, v58
  v_add_f32 v175, v175, v59
  v_add_f32 v156, v156, v60
  v_add_f32 v157, v157, v61
  v_add_f32 v158, v158, v62
  v_add_f32 v159, v159, v63
  v_add_f32 v160, v160, v64
  v_add_f32 v161, v161, v65
  v_add_f32 v162, v162, v66
  v_add_f32 v163, v163, v67
  v_add_f32 v164, v164, v68
  v_add_f32 v165, v165, v69
  v_add_f32 v166, v166, v70
  v_add_f32 v167, v167, v71
  v_add_f32 v168, v168, v72
  v_add_f32 v169, v169, v73
  v_add_f32 v170, v170, v74
  v_add_f32 v171, v171, v75
  v_add_f32 v172, v172, v76
  v_add_f32 v173, v173, v77
  v_add_f32 v174, v174, v78
  v_add_f32 v175, v175, v79
tail_plain:
  s_mov_b64 exec, s[42:43]
  s_waitcnt vmcnt(0)
  v_mfma_f32_16x16x32_bf16 v[0:3], a[212:215], a[180:183], 0
  s_add_u32 s30, s30, 8192
  buffer_load_dwordx4 v[176:179], v110, s[24:27], s30 offen offset:0 sc1
  v_mfma_f32_16x16x32_bf16 v[0:3], a[232:235], a[184:187], v[0:3]
  v_cvt_pk_bf16_f32 v156, v156, v156
  v_cvt_pk_bf16_f32 v157, v157, v157
  v_mfma_f32_16x16x32_bf16 v[4:7], a[232:235], a[192:195], 0
  buffer_load_dwordx4 a[96:99], v115, s[24:27], s7 offen offset:3072 sc1
  v_mfma_f32_16x16x32_bf16 v[4:7], a[212:215], a[188:191], v[4:7]
  v_cvt_pk_bf16_f32 v158, v158, v158
  v_cvt_pk_bf16_f32 v159, v159, v159
  v_mfma_f32_16x16x32_bf16 v[8:11], a[212:215], a[196:199], 0
  buffer_load_dwordx4 v[180:183], v110, s[24:27], s30 offen offset:1024 sc1
  v_mfma_f32_16x16x32_bf16 v[8:11], a[232:235], a[200:203], v[8:11]
  v_lshlrev_b32 v156, 16, v156
  v_lshlrev_b32 v157, 16, v157
  v_mfma_f32_16x16x32_bf16 v[12:15], a[232:235], a[208:211], 0
  v_lshlrev_b32 v158, 16, v158
  v_lshlrev_b32 v159, 16, v159
  v_mfma_f32_16x16x32_bf16 v[12:15], a[212:215], a[204:207], v[12:15]
  v_mul_f32 v156, v156, v124
  v_mul_f32 v157, v157, v124
  v_mfma_f32_16x16x32_bf16 v[16:19], a[216:219], a[180:183], 0
  buffer_load_dwordx4 v[184:187], v111, s[24:27], s30 offen offset:0 sc1
  v_mfma_f32_16x16x32_bf16 v[16:19], a[236:239], a[184:187], v[16:19]
  v_mul_f32 v158, v158, v124
  v_mul_f32 v159, v159, v124
  v_mfma_f32_16x16x32_bf16 v[20:23], a[236:239], a[192:195], 0
  buffer_load_dwordx4 a[100:103], v116, s[24:27], s7 offen offset:0 sc1
  v_mfma_f32_16x16x32_bf16 v[20:23], a[216:219], a[188:191], v[20:23]
  v_cvt_pk_bf16_f32 v156, v156, v156
  v_cvt_pk_bf16_f32 v157, v157, v157
  v_mfma_f32_16x16x32_bf16 v[24:27], a[216:219], a[196:199], 0
  buffer_load_dwordx4 v[188:191], v111, s[24:27], s30 offen offset:1024 sc1
  v_mfma_f32_16x16x32_bf16 v[24:27], a[236:239], a[200:203], v[24:27]
  v_cvt_pk_bf16_f32 v158, v158, v158
  v_cvt_pk_bf16_f32 v159, v159, v159
  v_mfma_f32_16x16x32_bf16 v[28:31], a[236:239], a[208:211], 0
  v_lshlrev_b32 v156, 16, v156
  v_lshlrev_b32 v157, 16, v157
  v_mfma_f32_16x16x32_bf16 v[28:31], a[216:219], a[204:207], v[28:31]
  v_lshlrev_b32 v158, 16, v158
  v_lshlrev_b32 v159, 16, v159
  v_mfma_f32_16x16x32_bf16 v[32:35], a[220:223], a[180:183], 0
  buffer_load_dwordx4 v[192:195], v112, s[24:27], s30 offen offset:0 sc1
  v_mfma_f32_16x16x32_bf16 v[32:35], a[240:243], a[184:187], v[32:35]
  v_add_f32 v90, v90, v156
  v_add_f32 v91, v91, v157
  v_mfma_f32_16x16x32_bf16 v[36:39], a[240:243], a[192:195], 0
  buffer_load_dwordx4 a[104:107], v116, s[24:27], s7 offen offset:1024 sc1
  v_mfma_f32_16x16x32_bf16 v[36:39], a[220:223], a[188:191], v[36:39]
  v_add_f32 v92, v92, v158
  v_add_f32 v93, v93, v159
  v_mfma_f32_16x16x32_bf16 v[40:43], a[220:223], a[196:199], 0
  buffer_load_dwordx4 v[196:199], v112, s[24:27], s30 offen offset:1024 sc1
  v_mfma_f32_16x16x32_bf16 v[40:43], a[240:243], a[200:203], v[40:43]
  v_cvt_pk_bf16_f32 v90, v90, v90
  v_cvt_pk_bf16_f32 v91, v91, v91
  v_mfma_f32_16x16x32_bf16 v[44:47], a[240:243], a[208:211], 0
  v_cvt_pk_bf16_f32 v92, v92, v92
  v_cvt_pk_bf16_f32 v93, v93, v93
  v_mfma_f32_16x16x32_bf16 v[44:47], a[220:223], a[204:207], v[44:47]
  v_lshlrev_b32 v90, 16, v90
  v_lshlrev_b32 v91, 16, v91
  v_mfma_f32_16x16x32_bf16 v[48:51], a[224:227], a[180:183], 0
  buffer_load_dwordx4 v[200:203], v113, s[24:27], s30 offen offset:0 sc1
  v_mfma_f32_16x16x32_bf16 v[48:51], a[244:247], a[184:187], v[48:51]
  v_lshlrev_b32 v92, 16, v92
  v_lshlrev_b32 v93, 16, v93
  v_mfma_f32_16x16x32_bf16 v[52:55], a[244:247], a[192:195], 0
  buffer_load_dwordx4 a[108:111], v116, s[24:27], s7 offen offset:2048 sc1
  v_mfma_f32_16x16x32_bf16 v[52:55], a[224:227], a[188:191], v[52:55]
  v_mul_f32 v129, 0xbfb8aa3b, v90
  v_mul_f32 v130, 0xbfb8aa3b, v91
  v_mfma_f32_16x16x32_bf16 v[56:59], a[224:227], a[196:199], 0
  buffer_load_dwordx4 v[204:207], v113, s[24:27], s30 offen offset:1024 sc1
  v_mfma_f32_16x16x32_bf16 v[56:59], a[244:247], a[200:203], v[56:59]
  v_mul_f32 v131, 0xbfb8aa3b, v92
  v_mul_f32 v132, 0xbfb8aa3b, v93
  v_mfma_f32_16x16x32_bf16 v[60:63], a[244:247], a[208:211], 0
  v_exp_f32 v129, v129
  v_mfma_f32_16x16x32_bf16 v[60:63], a[224:227], a[204:207], v[60:63]
  v_exp_f32 v130, v130
  v_mfma_f32_16x16x32_bf16 v[64:67], a[228:231], a[180:183], 0
  s_add_u32 s30, s30, 8192
  buffer_load_dwordx4 v[208:211], v110, s[24:27], s30 offen offset:0 sc1
  v_mfma_f32_16x16x32_bf16 v[64:67], a[248:251], a[184:187], v[64:67]
  v_exp_f32 v131, v131
  v_mfma_f32_16x16x32_bf16 v[68:71], a[248:251], a[192:195], 0
  buffer_load_dwordx4 a[112:115], v116, s[24:27], s7 offen offset:3072 sc1
  v_mfma_f32_16x16x32_bf16 v[68:71], a[228:231], a[188:191], v[68:71]
  v_exp_f32 v132, v132
  v_mfma_f32_16x16x32_bf16 v[72:75], a[228:231], a[196:199], 0
  buffer_load_dwordx4 v[212:215], v110, s[24:27], s30 offen offset:1024 sc1
  v_mfma_f32_16x16x32_bf16 v[72:75], a[248:251], a[200:203], v[72:75]
  v_add_f32 v129, 1.0, v129
  v_add_f32 v130, 1.0, v130
  v_mfma_f32_16x16x32_bf16 v[76:79], a[248:251], a[208:211], 0
  v_add_f32 v131, 1.0, v131
  v_add_f32 v132, 1.0, v132
  v_mfma_f32_16x16x32_bf16 v[76:79], a[228:231], a[204:207], v[76:79]
  v_rcp_f32 v129, v129
  s_waitcnt vmcnt(3)
  v_mfma_f32_16x16x32_bf16 v[0:3], a[252:255], v[176:179], v[0:3]
  buffer_load_dwordx4 v[216:219], v111, s[24:27], s30 offen offset:0 sc1
  v_mfma_f32_16x16x32_bf16 v[0:3], a[144:147], v[180:183], v[0:3]
  v_rcp_f32 v130, v130
  v_mfma_f32_16x16x32_bf16 v[4:7], a[144:147], v[188:191], v[4:7]
  buffer_load_dwordx4 a[116:119], v114, s[24:27], s8 offen offset:0 sc1
  v_mfma_f32_16x16x32_bf16 v[4:7], a[252:255], v[184:187], v[4:7]
  v_rcp_f32 v131, v131
  v_mfma_f32_16x16x32_bf16 v[8:11], a[252:255], v[192:195], v[8:11]
  buffer_load_dwordx4 v[220:223], v111, s[24:27], s30 offen offset:1024 sc1
  v_mfma_f32_16x16x32_bf16 v[8:11], a[144:147], v[196:199], v[8:11]
  v_rcp_f32 v132, v132
  v_mfma_f32_16x16x32_bf16 v[12:15], a[144:147], v[204:207], v[12:15]
  v_mul_f32 v90, v90, v129
  v_mul_f32 v91, v91, v130
  v_mfma_f32_16x16x32_bf16 v[12:15], a[252:255], v[200:203], v[12:15]
  v_mul_f32 v92, v92, v131
  v_mul_f32 v93, v93, v132
  v_mfma_f32_16x16x32_bf16 v[16:19], a[128:131], v[176:179], v[16:19]
  buffer_load_dwordx4 v[224:227], v112, s[24:27], s30 offen offset:0 sc1
  v_mfma_f32_16x16x32_bf16 v[16:19], a[148:151], v[180:183], v[16:19]
  v_cvt_pk_bf16_f32 v90, v90, v90
  v_cvt_pk_bf16_f32 v91, v91, v91
  v_mfma_f32_16x16x32_bf16 v[20:23], a[148:151], v[188:191], v[20:23]
  buffer_load_dwordx4 a[120:123], v114, s[24:27], s8 offen offset:1024 sc1
  v_mfma_f32_16x16x32_bf16 v[20:23], a[128:131], v[184:187], v[20:23]
  v_cvt_pk_bf16_f32 v92, v92, v92
  v_cvt_pk_bf16_f32 v93, v93, v93
  v_mfma_f32_16x16x32_bf16 v[24:27], a[128:131], v[192:195], v[24:27]
  buffer_load_dwordx4 v[228:231], v112, s[24:27], s30 offen offset:1024 sc1
  v_mfma_f32_16x16x32_bf16 v[24:27], a[148:151], v[196:199], v[24:27]
  v_lshlrev_b32 v90, 16, v90
  v_lshlrev_b32 v91, 16, v91
  v_mfma_f32_16x16x32_bf16 v[28:31], a[148:151], v[204:207], v[28:31]
  v_lshlrev_b32 v92, 16, v92
  v_lshlrev_b32 v93, 16, v93
  v_mfma_f32_16x16x32_bf16 v[28:31], a[128:131], v[200:203], v[28:31]
  v_cvt_pk_bf16_f32 v160, v160, v160
  v_cvt_pk_bf16_f32 v161, v161, v161
  v_mfma_f32_16x16x32_bf16 v[32:35], a[132:135], v[176:179], v[32:35]
  buffer_load_dwordx4 v[232:235], v113, s[24:27], s30 offen offset:0 sc1
  v_mfma_f32_16x16x32_bf16 v[32:35], a[152:155], v[180:183], v[32:35]
  v_cvt_pk_bf16_f32 v162, v162, v162
  v_cvt_pk_bf16_f32 v163, v163, v163
  v_mfma_f32_16x16x32_bf16 v[36:39], a[152:155], v[188:191], v[36:39]
  buffer_load_dwordx4 a[124:127], v114, s[24:27], s8 offen offset:2048 sc1
  v_mfma_f32_16x16x32_bf16 v[36:39], a[132:135], v[184:187], v[36:39]
  v_lshlrev_b32 v160, 16, v160
  v_lshlrev_b32 v161, 16, v161
  v_mfma_f32_16x16x32_bf16 v[40:43], a[132:135], v[192:195], v[40:43]
  buffer_load_dwordx4 v[236:239], v113, s[24:27], s30 offen offset:1024 sc1
  v_mfma_f32_16x16x32_bf16 v[40:43], a[152:155], v[196:199], v[40:43]
  v_lshlrev_b32 v162, 16, v162
  v_lshlrev_b32 v163, 16, v163
  v_mfma_f32_16x16x32_bf16 v[44:47], a[152:155], v[204:207], v[44:47]
  v_mul_f32 v160, v160, v124
  v_mul_f32 v161, v161, v124
  v_mfma_f32_16x16x32_bf16 v[44:47], a[132:135], v[200:203], v[44:47]
  v_mul_f32 v162, v162, v124
  v_mul_f32 v163, v163, v124
  v_mfma_f32_16x16x32_bf16 v[48:51], a[136:139], v[176:179], v[48:51]
  s_add_u32 s30, s30, 8192
  buffer_load_dwordx4 v[240:243], v110, s[24:27], s30 offen offset:0 sc1
  v_mfma_f32_16x16x32_bf16 v[48:51], a[156:159], v[180:183], v[48:51]
  v_cvt_pk_bf16_f32 v160, v160, v160
  v_cvt_pk_bf16_f32 v161, v161, v161
  v_mfma_f32_16x16x32_bf16 v[52:55], a[156:159], v[188:191], v[52:55]
  buffer_load_dwordx4 a[160:163], v114, s[24:27], s8 offen offset:3072 sc1
  v_mfma_f32_16x16x32_bf16 v[52:55], a[136:139], v[184:187], v[52:55]
  v_cvt_pk_bf16_f32 v162, v162, v162
  v_cvt_pk_bf16_f32 v163, v163, v163
  v_mfma_f32_16x16x32_bf16 v[56:59], a[136:139], v[192:195], v[56:59]
  buffer_load_dwordx4 v[244:247], v110, s[24:27], s30 offen offset:1024 sc1
  v_mfma_f32_16x16x32_bf16 v[56:59], a[156:159], v[196:199], v[56:59]
  v_lshlrev_b32 v160, 16, v160
  v_lshlrev_b32 v161, 16, v161
  v_mfma_f32_16x16x32_bf16 v[60:63], a[156:159], v[204:207], v[60:63]
  v_lshlrev_b32 v162, 16, v162
  v_lshlrev_b32 v163, 16, v163
  v_mfma_f32_16x16x32_bf16 v[60:63], a[136:139], v[200:203], v[60:63]
  v_add_f32 v94, v94, v160
  v_add_f32 v95, v95, v161
  v_mfma_f32_16x16x32_bf16 v[64:67], a[140:143], v[176:179], v[64:67]
  buffer_load_dwordx4 v[248:251], v111, s[24:27], s30 offen offset:0 sc1
  v_mfma_f32_16x16x32_bf16 v[64:67], a[0:3], v[180:183], v[64:67]
  v_add_f32 v96, v96, v162
  v_add_f32 v97, v97, v163
  v_mfma_f32_16x16x32_bf16 v[68:71], a[0:3], v[188:191], v[68:71]
  buffer_load_dwordx4 a[164:167], v115, s[24:27], s8 offen offset:0 sc1
  v_mfma_f32_16x16x32_bf16 v[68:71], a[140:143], v[184:187], v[68:71]
  v_cvt_pk_bf16_f32 v94, v94, v94
  v_cvt_pk_bf16_f32 v95, v95, v95
  v_mfma_f32_16x16x32_bf16 v[72:75], a[140:143], v[192:195], v[72:75]
  buffer_load_dwordx4 v[252:255], v111, s[24:27], s30 offen offset:1024 sc1
  v_mfma_f32_16x16x32_bf16 v[72:75], a[0:3], v[196:199], v[72:75]
  v_cvt_pk_bf16_f32 v96, v96, v96
  v_cvt_pk_bf16_f32 v97, v97, v97
  v_mfma_f32_16x16x32_bf16 v[76:79], a[0:3], v[204:207], v[76:79]
  v_lshlrev_b32 v94, 16, v94
  v_lshlrev_b32 v95, 16, v95
  v_mfma_f32_16x16x32_bf16 v[76:79], a[140:143], v[200:203], v[76:79]
  v_lshlrev_b32 v96, 16, v96
  v_lshlrev_b32 v97, 16, v97
  s_waitcnt vmcnt(6)
  v_mfma_f32_16x16x32_bf16 v[0:3], a[4:7], v[208:211], v[0:3]
  buffer_load_dwordx4 v[136:139], v112, s[24:27], s30 offen offset:0 sc1
  v_mfma_f32_16x16x32_bf16 v[0:3], a[24:27], v[212:215], v[0:3]
  v_mul_f32 v129, 0xbfb8aa3b, v94
  v_mul_f32 v130, 0xbfb8aa3b, v95
  v_mfma_f32_16x16x32_bf16 v[4:7], a[24:27], v[220:223], v[4:7]
  buffer_load_dwordx4 a[168:171], v115, s[24:27], s8 offen offset:1024 sc1
  v_mfma_f32_16x16x32_bf16 v[4:7], a[4:7], v[216:219], v[4:7]
  v_mul_f32 v131, 0xbfb8aa3b, v96
  v_mul_f32 v132, 0xbfb8aa3b, v97
  v_mfma_f32_16x16x32_bf16 v[8:11], a[4:7], v[224:227], v[8:11]
  buffer_load_dwordx4 v[140:143], v112, s[24:27], s30 offen offset:1024 sc1
  v_mfma_f32_16x16x32_bf16 v[8:11], a[24:27], v[228:231], v[8:11]
  v_exp_f32 v129, v129
  v_mfma_f32_16x16x32_bf16 v[12:15], a[24:27], v[236:239], v[12:15]
  v_exp_f32 v130, v130
  v_mfma_f32_16x16x32_bf16 v[12:15], a[4:7], v[232:235], v[12:15]
  v_exp_f32 v131, v131
  v_mfma_f32_16x16x32_bf16 v[16:19], a[8:11], v[208:211], v[16:19]
  buffer_load_dwordx4 v[144:147], v113, s[24:27], s30 offen offset:0 sc1
  v_mfma_f32_16x16x32_bf16 v[16:19], a[28:31], v[212:215], v[16:19]
  v_exp_f32 v132, v132
  v_mfma_f32_16x16x32_bf16 v[20:23], a[28:31], v[220:223], v[20:23]
  buffer_load_dwordx4 a[172:175], v115, s[24:27], s8 offen offset:2048 sc1
  v_mfma_f32_16x16x32_bf16 v[20:23], a[8:11], v[216:219], v[20:23]
  v_add_f32 v129, 1.0, v129
  v_add_f32 v130, 1.0, v130
  v_mfma_f32_16x16x32_bf16 v[24:27], a[8:11], v[224:227], v[24:27]
  buffer_load_dwordx4 v[148:151], v113, s[24:27], s30 offen offset:1024 sc1
  v_mfma_f32_16x16x32_bf16 v[24:27], a[28:31], v[228:231], v[24:27]
  v_add_f32 v131, 1.0, v131
  v_add_f32 v132, 1.0, v132
  v_mfma_f32_16x16x32_bf16 v[28:31], a[28:31], v[236:239], v[28:31]
  v_rcp_f32 v129, v129
  v_mfma_f32_16x16x32_bf16 v[28:31], a[8:11], v[232:235], v[28:31]
  v_rcp_f32 v130, v130
  v_mfma_f32_16x16x32_bf16 v[32:35], a[12:15], v[208:211], v[32:35]
  s_add_u32 s30, s30, 8192
  buffer_load_dwordx4 v[152:155], v110, s[24:27], s30 offen offset:0 sc1
  v_mfma_f32_16x16x32_bf16 v[32:35], a[32:35], v[212:215], v[32:35]
  v_rcp_f32 v131, v131
  v_mfma_f32_16x16x32_bf16 v[36:39], a[32:35], v[220:223], v[36:39]
  buffer_load_dwordx4 a[176:179], v115, s[24:27], s8 offen offset:3072 sc1
  v_mfma_f32_16x16x32_bf16 v[36:39], a[12:15], v[216:219], v[36:39]
  v_rcp_f32 v132, v132
  v_mfma_f32_16x16x32_bf16 v[40:43], a[12:15], v[224:227], v[40:43]
  buffer_load_dwordx4 a[180:183], v110, s[24:27], s30 offen offset:1024 sc1
  v_mfma_f32_16x16x32_bf16 v[40:43], a[32:35], v[228:231], v[40:43]
  v_mul_f32 v94, v94, v129
  v_mul_f32 v95, v95, v130
  v_mfma_f32_16x16x32_bf16 v[44:47], a[32:35], v[236:239], v[44:47]
  v_mul_f32 v96, v96, v131
  v_mul_f32 v97, v97, v132
  v_mfma_f32_16x16x32_bf16 v[44:47], a[12:15], v[232:235], v[44:47]
  v_cvt_pk_bf16_f32 v94, v94, v94
  v_cvt_pk_bf16_f32 v95, v95, v95
  v_mfma_f32_16x16x32_bf16 v[48:51], a[16:19], v[208:211], v[48:51]
  buffer_load_dwordx4 a[184:187], v111, s[24:27], s30 offen offset:0 sc1
  v_mfma_f32_16x16x32_bf16 v[48:51], a[36:39], v[212:215], v[48:51]
  v_cvt_pk_bf16_f32 v96, v96, v96
  v_cvt_pk_bf16_f32 v97, v97, v97
  v_mfma_f32_16x16x32_bf16 v[52:55], a[36:39], v[220:223], v[52:55]
  s_add_u32 m0, s28, 49152
  s_nop 0
  buffer_load_dwordx4 v115, s[24:27], s10 offen offset:0 sc1 lds
  v_mfma_f32_16x16x32_bf16 v[52:55], a[16:19], v[216:219], v[52:55]
  buffer_load_dwordx4 v115, s[24:27], s10 offen offset:1024 sc1 lds
  v_mfma_f32_16x16x32_bf16 v[56:59], a[16:19], v[224:227], v[56:59]
  buffer_load_dwordx4 v115, s[24:27], s10 offen offset:2048 sc1 lds
  v_mfma_f32_16x16x32_bf16 v[56:59], a[36:39], v[228:231], v[56:59]
  buffer_load_dwordx4 v115, s[24:27], s10 offen offset:3072 sc1 lds
  v_mfma_f32_16x16x32_bf16 v[60:63], a[36:39], v[236:239], v[60:63]
  buffer_load_dwordx4 a[188:191], v111, s[24:27], s30 offen offset:1024 sc1
  v_mfma_f32_16x16x32_bf16 v[60:63], a[16:19], v[232:235], v[60:63]
  v_lshlrev_b32 v94, 16, v94
  v_lshlrev_b32 v95, 16, v95
  v_mfma_f32_16x16x32_bf16 v[64:67], a[20:23], v[208:211], v[64:67]
  buffer_load_dwordx4 a[192:195], v112, s[24:27], s30 offen offset:0 sc1
  v_mfma_f32_16x16x32_bf16 v[64:67], a[40:43], v[212:215], v[64:67]
  v_lshlrev_b32 v96, 16, v96
  v_lshlrev_b32 v97, 16, v97
  v_mfma_f32_16x16x32_bf16 v[68:71], a[40:43], v[220:223], v[68:71]
  v_cvt_pk_bf16_f32 v164, v164, v164
  v_cvt_pk_bf16_f32 v165, v165, v165
  v_mfma_f32_16x16x32_bf16 v[68:71], a[20:23], v[216:219], v[68:71]
  v_cvt_pk_bf16_f32 v166, v166, v166
  v_cvt_pk_bf16_f32 v167, v167, v167
  v_mfma_f32_16x16x32_bf16 v[72:75], a[20:23], v[224:227], v[72:75]
  buffer_load_dwordx4 a[196:199], v112, s[24:27], s30 offen offset:1024 sc1
  v_mfma_f32_16x16x32_bf16 v[72:75], a[40:43], v[228:231], v[72:75]
  v_lshlrev_b32 v164, 16, v164
  v_lshlrev_b32 v165, 16, v165
  v_mfma_f32_16x16x32_bf16 v[76:79], a[40:43], v[236:239], v[76:79]
  v_lshlrev_b32 v166, 16, v166
  v_lshlrev_b32 v167, 16, v167
  v_mfma_f32_16x16x32_bf16 v[76:79], a[20:23], v[232:235], v[76:79]
  v_mul_f32 v164, v164, v124
  v_mul_f32 v165, v165, v124
  s_waitcnt vmcnt(11)
  v_mfma_f32_16x16x32_bf16 v[0:3], a[44:47], v[240:243], v[0:3]
  buffer_load_dwordx4 a[200:203], v113, s[24:27], s30 offen offset:0 sc1
  v_mfma_f32_16x16x32_bf16 v[0:3], a[64:67], v[244:247], v[0:3]
  v_mul_f32 v166, v166, v124
  v_mul_f32 v167, v167, v124
  v_mfma_f32_16x16x32_bf16 v[4:7], a[64:67], v[252:255], v[4:7]
  v_cvt_pk_bf16_f32 v164, v164, v164
  v_cvt_pk_bf16_f32 v165, v165, v165
  v_mfma_f32_16x16x32_bf16 v[4:7], a[44:47], v[248:251], v[4:7]
  v_cvt_pk_bf16_f32 v166, v166, v166
  v_cvt_pk_bf16_f32 v167, v167, v167
  v_mfma_f32_16x16x32_bf16 v[8:11], a[44:47], v[136:139], v[8:11]
  buffer_load_dwordx4 a[204:207], v113, s[24:27], s30 offen offset:1024 sc1
  v_mfma_f32_16x16x32_bf16 v[8:11], a[64:67], v[140:143], v[8:11]
  v_lshlrev_b32 v164, 16, v164
  v_lshlrev_b32 v165, 16, v165
  v_mfma_f32_16x16x32_bf16 v[12:15], a[64:67], v[148:151], v[12:15]
  v_lshlrev_b32 v166, 16, v166
  v_lshlrev_b32 v167, 16, v167
  v_mfma_f32_16x16x32_bf16 v[12:15], a[44:47], v[144:147], v[12:15]
  v_add_f32 v98, v98, v164
  v_add_f32 v99, v99, v165
  v_mfma_f32_16x16x32_bf16 v[16:19], a[48:51], v[240:243], v[16:19]
  s_add_u32 s30, s30, 8192
  buffer_load_dwordx4 a[208:211], v110, s[24:27], s30 offen offset:0 sc1
  v_mfma_f32_16x16x32_bf16 v[16:19], a[68:71], v[244:247], v[16:19]
  v_add_f32 v100, v100, v166
  v_add_f32 v101, v101, v167
  v_mfma_f32_16x16x32_bf16 v[20:23], a[68:71], v[252:255], v[20:23]
  v_cvt_pk_bf16_f32 v98, v98, v98
  v_cvt_pk_bf16_f32 v99, v99, v99
  v_mfma_f32_16x16x32_bf16 v[20:23], a[48:51], v[248:251], v[20:23]
  v_cvt_pk_bf16_f32 v100, v100, v100
  v_cvt_pk_bf16_f32 v101, v101, v101
  v_mfma_f32_16x16x32_bf16 v[24:27], a[48:51], v[136:139], v[24:27]
  buffer_load_dwordx4 v[176:179], v110, s[24:27], s30 offen offset:1024 sc1
  v_mfma_f32_16x16x32_bf16 v[24:27], a[68:71], v[140:143], v[24:27]
  v_lshlrev_b32 v98, 16, v98
  v_lshlrev_b32 v99, 16, v99
  v_mfma_f32_16x16x32_bf16 v[28:31], a[68:71], v[148:151], v[28:31]
  v_lshlrev_b32 v100, 16, v100
  v_lshlrev_b32 v101, 16, v101
  v_mfma_f32_16x16x32_bf16 v[28:31], a[48:51], v[144:147], v[28:31]
  v_mul_f32 v129, 0xbfb8aa3b, v98
  v_mul_f32 v130, 0xbfb8aa3b, v99
  v_mfma_f32_16x16x32_bf16 v[32:35], a[52:55], v[240:243], v[32:35]
  buffer_load_dwordx4 v[180:183], v111, s[24:27], s30 offen offset:0 sc1
  v_mfma_f32_16x16x32_bf16 v[32:35], a[72:75], v[244:247], v[32:35]
  v_mul_f32 v131, 0xbfb8aa3b, v100
  v_mul_f32 v132, 0xbfb8aa3b, v101
  v_mfma_f32_16x16x32_bf16 v[36:39], a[72:75], v[252:255], v[36:39]
  v_exp_f32 v129, v129
  v_mfma_f32_16x16x32_bf16 v[36:39], a[52:55], v[248:251], v[36:39]
  v_exp_f32 v130, v130
  v_mfma_f32_16x16x32_bf16 v[40:43], a[52:55], v[136:139], v[40:43]
  buffer_load_dwordx4 v[184:187], v111, s[24:27], s30 offen offset:1024 sc1
  v_mfma_f32_16x16x32_bf16 v[40:43], a[72:75], v[140:143], v[40:43]
  v_exp_f32 v131, v131
  v_mfma_f32_16x16x32_bf16 v[44:47], a[72:75], v[148:151], v[44:47]
  v_exp_f32 v132, v132
  v_mfma_f32_16x16x32_bf16 v[44:47], a[52:55], v[144:147], v[44:47]
  v_add_f32 v129, 1.0, v129
  v_add_f32 v130, 1.0, v130
  v_mfma_f32_16x16x32_bf16 v[48:51], a[56:59], v[240:243], v[48:51]
  buffer_load_dwordx4 v[188:191], v112, s[24:27], s30 offen offset:0 sc1
  v_mfma_f32_16x16x32_bf16 v[48:51], a[76:79], v[244:247], v[48:51]
  v_add_f32 v131, 1.0, v131
  v_add_f32 v132, 1.0, v132
  v_mfma_f32_16x16x32_bf16 v[52:55], a[76:79], v[252:255], v[52:55]
  v_rcp_f32 v129, v129
  v_mfma_f32_16x16x32_bf16 v[52:55], a[56:59], v[248:251], v[52:55]
  v_rcp_f32 v130, v130
  v_mfma_f32_16x16x32_bf16 v[56:59], a[56:59], v[136:139], v[56:59]
  buffer_load_dwordx4 v[192:195], v112, s[24:27], s30 offen offset:1024 sc1
  v_mfma_f32_16x16x32_bf16 v[56:59], a[76:79], v[140:143], v[56:59]
  v_rcp_f32 v131, v131
  v_mfma_f32_16x16x32_bf16 v[60:63], a[76:79], v[148:151], v[60:63]
  v_rcp_f32 v132, v132
  v_mfma_f32_16x16x32_bf16 v[60:63], a[56:59], v[144:147], v[60:63]
  v_mul_f32 v98, v98, v129
  v_mul_f32 v99, v99, v130
  v_mfma_f32_16x16x32_bf16 v[64:67], a[60:63], v[240:243], v[64:67]
  buffer_load_dwordx4 v[196:199], v113, s[24:27], s30 offen offset:0 sc1
  v_mfma_f32_16x16x32_bf16 v[64:67], a[80:83], v[244:247], v[64:67]
  v_mul_f32 v100, v100, v131
  v_mul_f32 v101, v101, v132
  v_mfma_f32_16x16x32_bf16 v[68:71], a[80:83], v[252:255], v[68:71]
  v_cvt_pk_bf16_f32 v98, v98, v98
  v_cvt_pk_bf16_f32 v99, v99, v99
  v_mfma_f32_16x16x32_bf16 v[68:71], a[60:63], v[248:251], v[68:71]
  v_cvt_pk_bf16_f32 v100, v100, v100
  v_cvt_pk_bf16_f32 v101, v101, v101
  v_mfma_f32_16x16x32_bf16 v[72:75], a[60:63], v[136:139], v[72:75]
  buffer_load_dwordx4 v[200:203], v113, s[24:27], s30 offen offset:1024 sc1
  v_mfma_f32_16x16x32_bf16 v[72:75], a[80:83], v[140:143], v[72:75]
  v_lshlrev_b32 v98, 16, v98
  v_lshlrev_b32 v99, 16, v99
  v_mfma_f32_16x16x32_bf16 v[76:79], a[80:83], v[148:151], v[76:79]
  v_lshlrev_b32 v100, 16, v100
  v_lshlrev_b32 v101, 16, v101
  v_mfma_f32_16x16x32_bf16 v[76:79], a[60:63], v[144:147], v[76:79]
  v_cvt_pk_bf16_f32 v168, v168, v168
  v_cvt_pk_bf16_f32 v169, v169, v169
  s_waitcnt vmcnt(8)
  v_mfma_f32_16x16x32_bf16 v[0:3], a[84:87], v[152:155], v[0:3]
  s_add_u32 s30, s30, 8192
  buffer_load_dwordx4 v[204:207], v110, s[24:27], s30 offen offset:0 sc1
  v_mfma_f32_16x16x32_bf16 v[0:3], a[104:107], a[180:183], v[0:3]
  v_cvt_pk_bf16_f32 v170, v170, v170
  v_cvt_pk_bf16_f32 v171, v171, v171
  v_mfma_f32_16x16x32_bf16 v[4:7], a[104:107], a[188:191], v[4:7]
  v_lshlrev_b32 v168, 16, v168
  v_lshlrev_b32 v169, 16, v169
  v_mfma_f32_16x16x32_bf16 v[4:7], a[84:87], a[184:187], v[4:7]
  v_lshlrev_b32 v170, 16, v170
  v_lshlrev_b32 v171, 16, v171
  v_mfma_f32_16x16x32_bf16 v[8:11], a[84:87], a[192:195], v[8:11]
  buffer_load_dwordx4 v[208:211], v110, s[24:27], s30 offen offset:1024 sc1
  v_mfma_f32_16x16x32_bf16 v[8:11], a[104:107], a[196:199], v[8:11]
  v_mul_f32 v168, v168, v124
  v_mul_f32 v169, v169, v124
  v_mfma_f32_16x16x32_bf16 v[12:15], a[104:107], a[204:207], v[12:15]
  v_mul_f32 v170, v170, v124
  v_mul_f32 v171, v171, v124
  v_mfma_f32_16x16x32_bf16 v[12:15], a[84:87], a[200:203], v[12:15]
  v_cvt_pk_bf16_f32 v168, v168, v168
  v_cvt_pk_bf16_f32 v169, v169, v169
  v_mfma_f32_16x16x32_bf16 v[16:19], a[88:91], v[152:155], v[16:19]
  buffer_load_dwordx4 v[212:215], v111, s[24:27], s30 offen offset:0 sc1
  v_mfma_f32_16x16x32_bf16 v[16:19], a[108:111], a[180:183], v[16:19]
  v_cvt_pk_bf16_f32 v170, v170, v170
  v_cvt_pk_bf16_f32 v171, v171, v171
  v_mfma_f32_16x16x32_bf16 v[20:23], a[108:111], a[188:191], v[20:23]
  v_lshlrev_b32 v168, 16, v168
  v_lshlrev_b32 v169, 16, v169
  v_mfma_f32_16x16x32_bf16 v[20:23], a[88:91], a[184:187], v[20:23]
  v_lshlrev_b32 v170, 16, v170
  v_lshlrev_b32 v171, 16, v171
  v_mfma_f32_16x16x32_bf16 v[24:27], a[88:91], a[192:195], v[24:27]
  buffer_load_dwordx4 v[216:219], v111, s[24:27], s30 offen offset:1024 sc1
  v_mfma_f32_16x16x32_bf16 v[24:27], a[108:111], a[196:199], v[24:27]
  v_add_f32 v102, v102, v168
  v_add_f32 v103, v103, v169
  v_mfma_f32_16x16x32_bf16 v[28:31], a[108:111], a[204:207], v[28:31]
  v_add_f32 v104, v104, v170
  v_add_f32 v105, v105, v171
  v_mfma_f32_16x16x32_bf16 v[28:31], a[88:91], a[200:203], v[28:31]
  v_cvt_pk_bf16_f32 v102, v102, v102
  v_cvt_pk_bf16_f32 v103, v103, v103
  v_mfma_f32_16x16x32_bf16 v[32:35], a[92:95], v[152:155], v[32:35]
  buffer_load_dwordx4 v[220:223], v112, s[24:27], s30 offen offset:0 sc1
  v_mfma_f32_16x16x32_bf16 v[32:35], a[112:115], a[180:183], v[32:35]
  v_cvt_pk_bf16_f32 v104, v104, v104
  v_cvt_pk_bf16_f32 v105, v105, v105
  v_mfma_f32_16x16x32_bf16 v[36:39], a[112:115], a[188:191], v[36:39]
  v_lshlrev_b32 v102, 16, v102
  v_lshlrev_b32 v103, 16, v103
  v_mfma_f32_16x16x32_bf16 v[36:39], a[92:95], a[184:187], v[36:39]
  v_lshlrev_b32 v104, 16, v104
  v_lshlrev_b32 v105, 16, v105
  v_mfma_f32_16x16x32_bf16 v[40:43], a[92:95], a[192:195], v[40:43]
  buffer_load_dwordx4 v[224:227], v112, s[24:27], s30 offen offset:1024 sc1
  v_mfma_f32_16x16x32_bf16 v[40:43], a[112:115], a[196:199], v[40:43]
  v_mul_f32 v129, 0xbfb8aa3b, v102
  v_mul_f32 v130, 0xbfb8aa3b, v103
  v_mfma_f32_16x16x32_bf16 v[44:47], a[112:115], a[204:207], v[44:47]
  v_mul_f32 v131, 0xbfb8aa3b, v104
  v_mul_f32 v132, 0xbfb8aa3b, v105
  v_mfma_f32_16x16x32_bf16 v[44:47], a[92:95], a[200:203], v[44:47]
  v_exp_f32 v129, v129
  v_mfma_f32_16x16x32_bf16 v[48:51], a[96:99], v[152:155], v[48:51]
  buffer_load_dwordx4 v[228:231], v113, s[24:27], s30 offen offset:0 sc1
  v_mfma_f32_16x16x32_bf16 v[48:51], a[116:119], a[180:183], v[48:51]
  v_exp_f32 v130, v130
  v_mfma_f32_16x16x32_bf16 v[52:55], a[116:119], a[188:191], v[52:55]
  v_exp_f32 v131, v131
  v_mfma_f32_16x16x32_bf16 v[52:55], a[96:99], a[184:187], v[52:55]
  v_exp_f32 v132, v132
  v_mfma_f32_16x16x32_bf16 v[56:59], a[96:99], a[192:195], v[56:59]
  buffer_load_dwordx4 v[232:235], v113, s[24:27], s30 offen offset:1024 sc1
  v_mfma_f32_16x16x32_bf16 v[56:59], a[116:119], a[196:199], v[56:59]
  v_add_f32 v129, 1.0, v129
  v_add_f32 v130, 1.0, v130
  v_mfma_f32_16x16x32_bf16 v[60:63], a[116:119], a[204:207], v[60:63]
  v_add_f32 v131, 1.0, v131
  v_add_f32 v132, 1.0, v132
  v_mfma_f32_16x16x32_bf16 v[60:63], a[96:99], a[200:203], v[60:63]
  v_rcp_f32 v129, v129
  v_mfma_f32_16x16x32_bf16 v[64:67], a[100:103], v[152:155], v[64:67]
  ds_read_b128 v[236:239], v122 offset:0
  s_add_u32 s30, s30, 8192
  v_rcp_f32 v130, v130
  v_mfma_f32_16x16x32_bf16 v[64:67], a[120:123], a[180:183], v[64:67]
  buffer_load_dwordx4 v[240:243], v110, s[24:27], s30 offen offset:0 sc1
  v_mfma_f32_16x16x32_bf16 v[68:71], a[120:123], a[188:191], v[68:71]
  v_rcp_f32 v131, v131
  v_mfma_f32_16x16x32_bf16 v[68:71], a[100:103], a[184:187], v[68:71]
  v_rcp_f32 v132, v132
  v_mfma_f32_16x16x32_bf16 v[72:75], a[100:103], a[192:195], v[72:75]
  buffer_load_dwordx4 v[244:247], v110, s[24:27], s30 offen offset:1024 sc1
  v_mfma_f32_16x16x32_bf16 v[72:75], a[120:123], a[196:199], v[72:75]
  v_mul_f32 v102, v102, v129
  v_mul_f32 v103, v103, v130
  v_mfma_f32_16x16x32_bf16 v[76:79], a[120:123], a[204:207], v[76:79]
  v_mul_f32 v104, v104, v131
  v_mul_f32 v105, v105, v132
  v_mfma_f32_16x16x32_bf16 v[76:79], a[100:103], a[200:203], v[76:79]
  v_cvt_pk_bf16_f32 v102, v102, v102
  v_cvt_pk_bf16_f32 v103, v103, v103
  s_waitcnt vmcnt(10)
  v_mfma_f32_16x16x32_bf16 v[0:3], a[124:127], a[208:211], v[0:3]
  ds_read_b128 v[248:251], v122 offset:1024
  v_cvt_pk_bf16_f32 v104, v104, v104
  v_mfma_f32_16x16x32_bf16 v[0:3], a[176:179], v[176:179], v[0:3]
  buffer_load_dwordx4 v[252:255], v111, s[24:27], s30 offen offset:0 sc1
  v_mfma_f32_16x16x32_bf16 v[4:7], a[176:179], v[184:187], v[4:7]
  v_cvt_pk_bf16_f32 v105, v105, v105
  v_lshlrev_b32 v102, 16, v102
  v_mfma_f32_16x16x32_bf16 v[4:7], a[124:127], v[180:183], v[4:7]
  v_lshlrev_b32 v103, 16, v103
  v_lshlrev_b32 v104, 16, v104
  v_mfma_f32_16x16x32_bf16 v[8:11], a[124:127], v[188:191], v[8:11]
  buffer_load_dwordx4 v[136:139], v111, s[24:27], s30 offen offset:1024 sc1
  v_mfma_f32_16x16x32_bf16 v[8:11], a[176:179], v[192:195], v[8:11]
  v_lshlrev_b32 v105, 16, v105
  v_cvt_pk_bf16_f32 v172, v172, v172
  v_mfma_f32_16x16x32_bf16 v[12:15], a[176:179], v[200:203], v[12:15]
  v_cvt_pk_bf16_f32 v173, v173, v173
  v_cvt_pk_bf16_f32 v174, v174, v174
  v_mfma_f32_16x16x32_bf16 v[12:15], a[124:127], v[196:199], v[12:15]
  v_cvt_pk_bf16_f32 v175, v175, v175
  v_lshlrev_b32 v172, 16, v172
  s_waitcnt lgkmcnt(1)
  v_mfma_f32_16x16x32_bf16 v[16:19], a[160:163], a[208:211], v[16:19]
  ds_read_b128 v[140:143], v122 offset:2048
  v_lshlrev_b32 v173, 16, v173
  v_mfma_f32_16x16x32_bf16 v[16:19], v[236:239], v[176:179], v[16:19]
  buffer_load_dwordx4 v[144:147], v112, s[24:27], s30 offen offset:0 sc1
  v_mfma_f32_16x16x32_bf16 v[20:23], v[236:239], v[184:187], v[20:23]
  v_lshlrev_b32 v174, 16, v174
  v_lshlrev_b32 v175, 16, v175
  v_mfma_f32_16x16x32_bf16 v[20:23], a[160:163], v[180:183], v[20:23]
  v_mul_f32 v172, v172, v124
  v_mul_f32 v173, v173, v124
  v_mfma_f32_16x16x32_bf16 v[24:27], a[160:163], v[188:191], v[24:27]
  buffer_load_dwordx4 v[148:151], v112, s[24:27], s30 offen offset:1024 sc1
  v_mfma_f32_16x16x32_bf16 v[24:27], v[236:239], v[192:195], v[24:27]
  v_mul_f32 v174, v174, v124
  v_mul_f32 v175, v175, v124
  v_mfma_f32_16x16x32_bf16 v[28:31], v[236:239], v[200:203], v[28:31]
  v_cvt_pk_bf16_f32 v172, v172, v172
  v_cvt_pk_bf16_f32 v173, v173, v173
  v_mfma_f32_16x16x32_bf16 v[28:31], a[160:163], v[196:199], v[28:31]
  v_cvt_pk_bf16_f32 v174, v174, v174
  v_cvt_pk_bf16_f32 v175, v175, v175
  s_waitcnt lgkmcnt(1)
  v_mfma_f32_16x16x32_bf16 v[32:35], a[164:167], a[208:211], v[32:35]
  ds_read_b128 v[152:155], v122 offset:3072
  v_lshlrev_b32 v172, 16, v172
  v_mfma_f32_16x16x32_bf16 v[32:35], v[248:251], v[176:179], v[32:35]
  buffer_load_dwordx4 a[180:183], v113, s[24:27], s30 offen offset:0 sc1
  v_mfma_f32_16x16x32_bf16 v[36:39], v[248:251], v[184:187], v[36:39]
  v_lshlrev_b32 v173, 16, v173
  v_lshlrev_b32 v174, 16, v174
  v_mfma_f32_16x16x32_bf16 v[36:39], a[164:167], v[180:183], v[36:39]
  v_lshlrev_b32 v175, 16, v175
  v_add_f32 v106, v106, v172
  v_mfma_f32_16x16x32_bf16 v[40:43], a[164:167], v[188:191], v[40:43]
  buffer_load_dwordx4 a[184:187], v113, s[24:27], s30 offen offset:1024 sc1
  v_mfma_f32_16x16x32_bf16 v[40:43], v[248:251], v[192:195], v[40:43]
  v_add_f32 v107, v107, v173
  v_add_f32 v108, v108, v174
  v_mfma_f32_16x16x32_bf16 v[44:47], v[248:251], v[200:203], v[44:47]
  v_add_f32 v109, v109, v175
  v_cvt_pk_bf16_f32 v106, v106, v106
  v_mfma_f32_16x16x32_bf16 v[44:47], a[164:167], v[196:199], v[44:47]
  v_cvt_pk_bf16_f32 v107, v107, v107
  v_cvt_pk_bf16_f32 v108, v108, v108
  s_waitcnt lgkmcnt(1)
  v_mfma_f32_16x16x32_bf16 v[48:51], a[168:171], a[208:211], v[48:51]
  ds_read_b128 a[188:191], v122 offset:16384
  ds_read_b128 a[192:195], v122 offset:33792
  s_mov_b32 s30, s37
  v_mfma_f32_16x16x32_bf16 v[48:51], v[140:143], v[176:179], v[48:51]
  buffer_load_dwordx4 a[196:199], v110, s[24:27], s30 offen offset:0 sc1
  v_mfma_f32_16x16x32_bf16 v[52:55], v[140:143], v[184:187], v[52:55]
  v_cvt_pk_bf16_f32 v109, v109, v109
  v_lshlrev_b32 v106, 16, v106
  v_mfma_f32_16x16x32_bf16 v[52:55], a[168:171], v[180:183], v[52:55]
  v_lshlrev_b32 v107, 16, v107
  v_lshlrev_b32 v108, 16, v108
  v_mfma_f32_16x16x32_bf16 v[56:59], a[168:171], v[188:191], v[56:59]
  buffer_load_dwordx4 a[200:203], v110, s[24:27], s30 offen offset:1024 sc1
  v_mfma_f32_16x16x32_bf16 v[56:59], v[140:143], v[192:195], v[56:59]
  v_lshlrev_b32 v109, 16, v109
  v_mul_f32 v129, 0xbfb8aa3b, v106
  v_mfma_f32_16x16x32_bf16 v[60:63], v[140:143], v[200:203], v[60:63]
  v_mul_f32 v130, 0xbfb8aa3b, v107
  v_mul_f32 v131, 0xbfb8aa3b, v108
  v_mfma_f32_16x16x32_bf16 v[60:63], a[168:171], v[196:199], v[60:63]
  v_mul_f32 v132, 0xbfb8aa3b, v109
  v_exp_f32 v129, v129
  s_waitcnt lgkmcnt(2)
  v_mfma_f32_16x16x32_bf16 v[64:67], a[172:175], a[208:211], v[64:67]
  ds_read_b128 a[204:207], v122 offset:17408
  ds_read_b128 v[236:239], v122 offset:34816
  v_mfma_f32_16x16x32_bf16 v[64:67], v[152:155], v[176:179], v[64:67]
  v_exp_f32 v130, v130
  v_mfma_f32_16x16x32_bf16 v[68:71], v[152:155], v[184:187], v[68:71]
  v_exp_f32 v131, v131
  v_mfma_f32_16x16x32_bf16 v[68:71], a[172:175], v[180:183], v[68:71]
  v_exp_f32 v132, v132
  v_mfma_f32_16x16x32_bf16 v[72:75], a[172:175], v[188:191], v[72:75]
  v_add_f32 v129, 1.0, v129
  v_add_f32 v130, 1.0, v130
  v_mfma_f32_16x16x32_bf16 v[72:75], v[152:155], v[192:195], v[72:75]
  v_add_f32 v131, 1.0, v131
  v_add_f32 v132, 1.0, v132
  v_mfma_f32_16x16x32_bf16 v[76:79], v[152:155], v[200:203], v[76:79]
  v_rcp_f32 v129, v129
  v_mfma_f32_16x16x32_bf16 v[76:79], a[172:175], v[196:199], v[76:79]
  v_rcp_f32 v130, v130
  s_waitcnt vmcnt(10) lgkmcnt(2)
  v_mfma_f32_16x16x32_bf16 v[0:3], a[188:191], v[204:207], v[0:3]
  ds_read_b128 v[248:251], v122 offset:18432
  ds_read_b128 v[140:143], v122 offset:35840
  v_mfma_f32_16x16x32_bf16 v[0:3], a[192:195], v[208:211], v[0:3]
  buffer_load_dwordx4 v[152:155], v111, s[24:27], s30 offen offset:0 sc1
  v_mfma_f32_16x16x32_bf16 v[4:7], a[192:195], v[216:219], v[4:7]
  v_rcp_f32 v131, v131
  v_mfma_f32_16x16x32_bf16 v[4:7], a[188:191], v[212:215], v[4:7]
  v_rcp_f32 v132, v132
  v_mfma_f32_16x16x32_bf16 v[8:11], a[188:191], v[220:223], v[8:11]
  buffer_load_dwordx4 a[208:211], v111, s[24:27], s30 offen offset:1024 sc1
  v_mfma_f32_16x16x32_bf16 v[8:11], a[192:195], v[224:227], v[8:11]
  v_mul_f32 v106, v106, v129
  v_mul_f32 v107, v107, v130
  v_mfma_f32_16x16x32_bf16 v[12:15], a[192:195], v[232:235], v[12:15]
  v_mul_f32 v108, v108, v131
  v_mul_f32 v109, v109, v132
  v_mfma_f32_16x16x32_bf16 v[12:15], a[188:191], v[228:231], v[12:15]
  v_cvt_pk_bf16_f32 v106, v106, v106
  v_cvt_pk_bf16_f32 v107, v107, v107
  s_waitcnt lgkmcnt(2)
  v_mfma_f32_16x16x32_bf16 v[16:19], a[204:207], v[204:207], v[16:19]
  ds_read_b128 v[176:179], v122 offset:19456
  ds_read_b128 v[180:183], v135 offset:0
  v_mfma_f32_16x16x32_bf16 v[16:19], v[236:239], v[208:211], v[16:19]
  buffer_load_dwordx4 v[184:187], v112, s[24:27], s30 offen offset:0 sc1
  v_mfma_f32_16x16x32_bf16 v[20:23], v[236:239], v[216:219], v[20:23]
  v_cvt_pk_bf16_f32 v108, v108, v108
  v_cvt_pk_bf16_f32 v109, v109, v109
  v_mfma_f32_16x16x32_bf16 v[20:23], a[204:207], v[212:215], v[20:23]
  v_lshlrev_b32 v106, 16, v106
  v_lshlrev_b32 v107, 16, v107
  v_mfma_f32_16x16x32_bf16 v[24:27], a[204:207], v[220:223], v[24:27]
  buffer_load_dwordx4 v[188:191], v112, s[24:27], s30 offen offset:1024 sc1
  v_mfma_f32_16x16x32_bf16 v[24:27], v[236:239], v[224:227], v[24:27]
  v_lshlrev_b32 v108, 16, v108
  v_lshlrev_b32 v109, 16, v109
  v_mfma_f32_16x16x32_bf16 v[28:31], v[236:239], v[232:235], v[28:31]
  v_lshlrev_b32 v156, 16, v80
  v_and_b32 v157, s34, v80
  v_mfma_f32_16x16x32_bf16 v[28:31], a[204:207], v[228:231], v[28:31]
  v_lshlrev_b32 v158, 16, v81
  v_and_b32 v159, s34, v81
  s_waitcnt lgkmcnt(2)
  v_mfma_f32_16x16x32_bf16 v[32:35], v[248:251], v[204:207], v[32:35]
  ds_read_b128 v[192:195], v122 offset:32768
  ds_read_b128 v[196:199], v135 offset:1024
  v_mfma_f32_16x16x32_bf16 v[32:35], v[140:143], v[208:211], v[32:35]
  buffer_load_dwordx4 v[200:203], v113, s[24:27], s30 offen offset:0 sc1
  v_mfma_f32_16x16x32_bf16 v[36:39], v[140:143], v[216:219], v[36:39]
  v_lshlrev_b32 v160, 16, v82
  v_and_b32 v161, s34, v82
  v_mfma_f32_16x16x32_bf16 v[36:39], v[248:251], v[212:215], v[36:39]
  v_lshlrev_b32 v162, 16, v83
  v_and_b32 v163, s34, v83
  v_mfma_f32_16x16x32_bf16 v[40:43], v[248:251], v[220:223], v[40:43]
  buffer_load_dwordx4 a[188:191], v113, s[24:27], s30 offen offset:1024 sc1
  v_mfma_f32_16x16x32_bf16 v[40:43], v[140:143], v[224:227], v[40:43]
  v_lshlrev_b32 v164, 16, v84
  v_and_b32 v165, s34, v84
  v_mfma_f32_16x16x32_bf16 v[44:47], v[140:143], v[232:235], v[44:47]
  v_lshlrev_b32 v166, 16, v85
  v_and_b32 v167, s34, v85
  v_mfma_f32_16x16x32_bf16 v[44:47], v[248:251], v[228:231], v[44:47]
  v_lshlrev_b32 v168, 16, v86
  v_and_b32 v169, s34, v86
  s_waitcnt lgkmcnt(2)
  v_mfma_f32_16x16x32_bf16 v[48:51], v[176:179], v[204:207], v[48:51]
  ds_read_b128 a[192:195], v135 offset:2048
  ds_read_b128 a[204:207], v135 offset:19456
  s_add_u32 s30, s30, 8192
  v_mfma_f32_16x16x32_bf16 v[48:51], v[180:183], v[208:211], v[48:51]
  buffer_load_dwordx4 v[236:239], v110, s[24:27], s30 offen offset:0 sc1
  v_mfma_f32_16x16x32_bf16 v[52:55], v[180:183], v[216:219], v[52:55]
  v_lshlrev_b32 v170, 16, v87
  v_and_b32 v171, s34, v87
  v_mfma_f32_16x16x32_bf16 v[52:55], v[176:179], v[212:215], v[52:55]
  v_lshlrev_b32 v172, 16, v88
  v_and_b32 v173, s34, v88
  v_mfma_f32_16x16x32_bf16 v[56:59], v[176:179], v[220:223], v[56:59]
  v_lshlrev_b32 v174, 16, v89
  v_and_b32 v175, s34, v89
  v_mfma_f32_16x16x32_bf16 v[56:59], v[180:183], v[224:227], v[56:59]
  s_sub_u32 s41, s3, 1
  s_and_b32 s41, s41, 3
  s_lshl_b32 s41, s41, 12
  v_add_u32 v80, s41, v114
  v_mfma_f32_16x16x32_bf16 v[60:63], v[180:183], v[232:235], v[60:63]
  s_sub_u32 s41, s3, 2
  s_and_b32 s41, s41, 3
  s_lshl_b32 s41, s41, 12
  v_add_u32 v81, s41, v114
  v_mfma_f32_16x16x32_bf16 v[60:63], v[176:179], v[228:231], v[60:63]
  s_sub_u32 s41, s3, 3
  s_and_b32 s41, s41, 3
  s_lshl_b32 s41, s41, 12
  v_add_u32 v82, s41, v114
  v_bfe_u32 v129, v114, 8, 1
  s_waitcnt lgkmcnt(2)
  v_mfma_f32_16x16x32_bf16 v[64:67], v[192:195], v[204:207], v[64:67]
  ds_read_b128 v[248:251], v135 offset:3072
  ds_read_b128 v[140:143], v122 offset:49152
  v_mfma_f32_16x16x32_bf16 v[64:67], v[196:199], v[208:211], v[64:67]
  v_mul_u32_u24 v129, 24, v129
  v_add_u32 v83, v117, v129
  v_mfma_f32_16x16x32_bf16 v[68:71], v[196:199], v[216:219], v[68:71]
  v_mfma_f32_16x16x32_bf16 v[68:71], v[192:195], v[212:215], v[68:71]
  v_mfma_f32_16x16x32_bf16 v[72:75], v[192:195], v[220:223], v[72:75]
  v_mfma_f32_16x16x32_bf16 v[72:75], v[196:199], v[224:227], v[72:75]
  v_mfma_f32_16x16x32_bf16 v[76:79], v[196:199], v[232:235], v[76:79]
  v_mfma_f32_16x16x32_bf16 v[76:79], v[192:195], v[228:231], v[76:79]
  s_waitcnt vmcnt(9) lgkmcnt(2)
  v_mfma_f32_16x16x32_bf16 v[0:3], a[192:195], v[240:243], v[0:3]
  ds_read_b128 v[176:179], v135 offset:16384
  ds_read_b128 v[180:183], v122 offset:50176
  s_xor_b32 s38, s40, 1
  v_mfma_f32_16x16x32_bf16 v[0:3], a[204:207], v[244:247], v[0:3]
  buffer_load_dwordx4 v[192:195], v110, s[24:27], s30 offen offset:1024 sc1
  s_lshl_b32 s38, s38, 2
  s_add_u32 s38, s38, s3
  s_lshl_b32 s38, s38, 12
  v_mfma_f32_16x16x32_bf16 v[4:7], a[204:207], v[136:139], v[4:7]
  s_add_u32 s38, s38, 25165824
  v_lshrrev_b32 v125, 1, v114
  v_mfma_f32_16x16x32_bf16 v[4:7], a[192:195], v[252:255], v[4:7]
  v_mfma_f32_16x16x32_bf16 v[8:11], a[192:195], v[144:147], v[8:11]
  buffer_load_dwordx4 v[196:199], v111, s[24:27], s30 offen offset:0 sc1
  v_mfma_f32_16x16x32_bf16 v[8:11], a[204:207], v[148:151], v[8:11]
  v_mfma_f32_16x16x32_bf16 v[12:15], a[204:207], a[184:187], v[12:15]
  v_mfma_f32_16x16x32_bf16 v[12:15], a[192:195], a[180:183], v[12:15]
  s_waitcnt lgkmcnt(2)
  v_mfma_f32_16x16x32_bf16 v[16:19], v[248:251], v[240:243], v[16:19]
  ds_read_b128 v[204:207], v135 offset:17408
  ds_read_b128 v[208:211], v122 offset:51200
  v_mfma_f32_16x16x32_bf16 v[16:19], v[140:143], v[244:247], v[16:19]
  buffer_load_dwordx4 v[212:215], v111, s[24:27], s30 offen offset:1024 sc1
  v_mfma_f32_16x16x32_bf16 v[20:23], v[140:143], v[136:139], v[20:23]
  ds_write_b128 v118, v[4:7] offset:0
  ds_write_b128 v118, v[8:11] offset:5120
  v_mfma_f32_16x16x32_bf16 v[20:23], v[248:251], v[252:255], v[20:23]
  ds_write_b128 v118, v[12:15] offset:10240
  v_mfma_f32_16x16x32_bf16 v[24:27], v[248:251], v[144:147], v[24:27]
  buffer_load_dwordx4 v[216:219], v112, s[24:27], s30 offen offset:0 sc1
  v_mfma_f32_16x16x32_bf16 v[24:27], v[140:143], v[148:151], v[24:27]
  v_mfma_f32_16x16x32_bf16 v[28:31], v[140:143], a[184:187], v[28:31]
  v_mfma_f32_16x16x32_bf16 v[28:31], v[248:251], a[180:183], v[28:31]
  s_waitcnt lgkmcnt(5)
  v_mfma_f32_16x16x32_bf16 v[32:35], v[176:179], v[240:243], v[32:35]
  ds_read_b128 v[220:223], v135 offset:18432
  ds_read_b128 v[224:227], v122 offset:52224
  v_mfma_f32_16x16x32_bf16 v[32:35], v[180:183], v[244:247], v[32:35]
  buffer_load_dwordx4 v[228:231], v112, s[24:27], s30 offen offset:1024 sc1
  v_mfma_f32_16x16x32_bf16 v[36:39], v[180:183], v[136:139], v[36:39]
  ds_write_b128 v118, v[20:23] offset:1024
  ds_write_b128 v118, v[24:27] offset:6144
  v_mfma_f32_16x16x32_bf16 v[36:39], v[176:179], v[252:255], v[36:39]
  ds_write_b128 v118, v[28:31] offset:11264
  v_mfma_f32_16x16x32_bf16 v[40:43], v[176:179], v[144:147], v[40:43]
  buffer_load_dwordx4 v[232:235], v113, s[24:27], s30 offen offset:0 sc1
  v_mfma_f32_16x16x32_bf16 v[40:43], v[180:183], v[148:151], v[40:43]
  v_mfma_f32_16x16x32_bf16 v[44:47], v[180:183], a[184:187], v[44:47]
  v_mfma_f32_16x16x32_bf16 v[44:47], v[176:179], a[180:183], v[44:47]
  s_waitcnt lgkmcnt(8)
  v_mfma_f32_16x16x32_bf16 v[48:51], v[204:207], v[240:243], v[48:51]
  buffer_load_dwordx4 a[192:195], v113, s[24:27], s30 offen offset:1024 sc1
  v_mfma_f32_16x16x32_bf16 v[48:51], v[208:211], v[244:247], v[48:51]
  ds_write_b128 v118, v[36:39] offset:2048
  v_mfma_f32_16x16x32_bf16 v[52:55], v[208:211], v[136:139], v[52:55]
  ds_write_b128 v118, v[40:43] offset:7168
  v_mfma_f32_16x16x32_bf16 v[52:55], v[204:207], v[252:255], v[52:55]
  ds_write_b128 v118, v[44:47] offset:12288
  v_mfma_f32_16x16x32_bf16 v[56:59], v[204:207], v[144:147], v[56:59]
  s_add_u32 s30, s30, 8192
  buffer_load_dwordx4 a[204:207], v110, s[24:27], s30 offen offset:0 sc1
  v_mfma_f32_16x16x32_bf16 v[56:59], v[208:211], v[148:151], v[56:59]
  v_mfma_f32_16x16x32_bf16 v[60:63], v[208:211], a[184:187], v[60:63]
  v_mfma_f32_16x16x32_bf16 v[60:63], v[204:207], a[180:183], v[60:63]
  s_waitcnt lgkmcnt(6)
  v_mfma_f32_16x16x32_bf16 v[64:67], v[220:223], v[240:243], v[64:67]
  buffer_load_dwordx4 v[248:251], v110, s[24:27], s30 offen offset:1024 sc1
  v_mfma_f32_16x16x32_bf16 v[64:67], v[224:227], v[244:247], v[64:67]
  ds_write_b128 v118, v[52:55] offset:3072
  v_mfma_f32_16x16x32_bf16 v[68:71], v[224:227], v[136:139], v[68:71]
  ds_write_b128 v118, v[56:59] offset:8192
  v_mfma_f32_16x16x32_bf16 v[68:71], v[220:223], v[252:255], v[68:71]
  ds_write_b128 v118, v[60:63] offset:13312
  v_mfma_f32_16x16x32_bf16 v[72:75], v[220:223], v[144:147], v[72:75]
  buffer_load_dwordx4 v[140:143], v111, s[24:27], s30 offen offset:0 sc1
  v_mfma_f32_16x16x32_bf16 v[72:75], v[224:227], v[148:151], v[72:75]
  v_mfma_f32_16x16x32_bf16 v[76:79], v[224:227], a[184:187], v[76:79]
  v_mfma_f32_16x16x32_bf16 v[76:79], v[220:223], a[180:183], v[76:79]
  s_nop 1
  ds_write_b128 v118, v[68:71] offset:4096
  s_nop 2
  ds_write_b128 v118, v[72:75] offset:9216
  s_nop 0
  ds_write_b128 v118, v[76:79] offset:14336
  buffer_load_dwordx4 v[176:179], v111, s[24:27], s30 offen offset:1024 sc1
  buffer_load_dwordx4 v[180:183], v112, s[24:27], s30 offen offset:0 sc1
  buffer_load_dwordx4 v[204:207], v112, s[24:27], s30 offen offset:1024 sc1
  buffer_load_dwordx4 v[208:211], v113, s[24:27], s30 offen offset:0 sc1
  buffer_load_dwordx4 v[220:223], v113, s[24:27], s30 offen offset:1024 sc1
  s_add_u32 s30, s30, 8192
  buffer_load_dwordx4 v[224:227], v110, s[24:27], s30 offen offset:0 sc1
  buffer_load_dwordx4 v[240:243], v110, s[24:27], s30 offen offset:1024 sc1
  buffer_load_dwordx4 v[244:247], v111, s[24:27], s30 offen offset:0 sc1
  buffer_load_dwordx4 v[252:255], v111, s[24:27], s30 offen offset:1024 sc1
  buffer_load_dwordx4 v[136:139], v112, s[24:27], s30 offen offset:0 sc1
  buffer_load_dwordx4 v[144:147], v112, s[24:27], s30 offen offset:1024 sc1
  buffer_load_dwordx4 v[148:151], v113, s[24:27], s30 offen offset:0 sc1
  buffer_load_dwordx4 a[180:183], v113, s[24:27], s30 offen offset:1024 sc1
  s_add_u32 s30, s30, 8192
  buffer_load_dwordx4 a[184:187], v110, s[24:27], s30 offen offset:0 sc1
  s_waitcnt lgkmcnt(0)
  s_barrier
  ds_read_b128 v[4:7], v119 offset:0
  ds_read_b128 v[8:11], v120 offset:5120
  ds_read_b128 v[12:15], v121 offset:10240
  ds_read_b128 v[20:23], v119 offset:1024
  ds_read_b128 v[24:27], v120 offset:6144
  ds_read_b128 v[28:31], v121 offset:11264
  ds_read_b128 v[36:39], v119 offset:2048
  ds_read_b128 v[40:43], v120 offset:7168
  ds_read_b128 v[44:47], v121 offset:12288
  ds_read_b128 v[52:55], v119 offset:3072
  ds_read_b128 v[56:59], v120 offset:8192
  ds_read_b128 v[60:63], v121 offset:13312
  ds_read_b128 v[68:71], v119 offset:4096
  ds_read_b128 v[72:75], v120 offset:9216
  ds_read_b128 v[76:79], v121 offset:14336
  s_waitcnt lgkmcnt(12)
  v_add_f32 v4, v4, v8
  v_add_f32 v5, v5, v9
  v_add_f32 v6, v6, v10
  v_add_f32 v7, v7, v11
  v_add_f32 v0, v0, v12
  v_add_f32 v1, v1, v13
  v_add_f32 v2, v2, v14
  v_add_f32 v3, v3, v15
  v_add_f32 v0, v0, v4
  v_add_f32 v1, v1, v5
  v_add_f32 v2, v2, v6
  v_add_f32 v3, v3, v7
  v_cvt_pk_bf16_f32 v4, v0, v1
  v_cvt_pk_bf16_f32 v5, v2, v3
  buffer_store_dwordx2 v[4:5], v125, s[24:27], s38 offen offset:0 sc1
  s_waitcnt vmcnt(26)
  v_mfma_f32_16x16x32_bf16 v[0:3], a[212:215], a[196:199], 0
  s_waitcnt lgkmcnt(9)
  v_add_f32 v20, v20, v24
  v_add_f32 v21, v21, v25
  v_mfma_f32_16x16x32_bf16 v[0:3], a[232:235], a[200:203], v[0:3]
  v_add_f32 v22, v22, v26
  v_add_f32 v23, v23, v27
  v_mfma_f32_16x16x32_bf16 v[4:7], a[232:235], a[208:211], 0
  v_add_f32 v16, v16, v28
  v_add_f32 v17, v17, v29
  v_mfma_f32_16x16x32_bf16 v[4:7], a[212:215], v[152:155], v[4:7]
  v_add_f32 v18, v18, v30
  v_add_f32 v19, v19, v31
  v_mfma_f32_16x16x32_bf16 v[8:11], a[212:215], v[184:187], 0
  v_add_f32 v16, v16, v20
  v_add_f32 v17, v17, v21
  v_mfma_f32_16x16x32_bf16 v[8:11], a[232:235], v[188:191], v[8:11]
  v_add_f32 v18, v18, v22
  v_add_f32 v19, v19, v23
  v_mfma_f32_16x16x32_bf16 v[12:15], a[232:235], a[188:191], 0
  v_cvt_pk_bf16_f32 v20, v16, v17
  v_cvt_pk_bf16_f32 v21, v18, v19
  v_mfma_f32_16x16x32_bf16 v[12:15], a[212:215], v[200:203], v[12:15]
  buffer_store_dwordx2 v[20:21], v125, s[24:27], s38 offen offset:512 sc1
  s_waitcnt lgkmcnt(6)
  v_mfma_f32_16x16x32_bf16 v[16:19], a[216:219], a[196:199], 0
  buffer_load_dwordx4 a[212:215], v110, s[24:27], s30 offen offset:1024 sc1
  v_mfma_f32_16x16x32_bf16 v[16:19], a[236:239], a[200:203], v[16:19]
  v_add_f32 v36, v36, v40
  v_add_f32 v37, v37, v41
  v_mfma_f32_16x16x32_bf16 v[20:23], a[236:239], a[208:211], 0
  v_add_f32 v38, v38, v42
  v_add_f32 v39, v39, v43
  v_mfma_f32_16x16x32_bf16 v[20:23], a[216:219], v[152:155], v[20:23]
  v_add_f32 v32, v32, v44
  v_add_f32 v33, v33, v45
  v_mfma_f32_16x16x32_bf16 v[24:27], a[216:219], v[184:187], 0
  buffer_load_dwordx4 a[232:235], v111, s[24:27], s30 offen offset:0 sc1
  v_mfma_f32_16x16x32_bf16 v[24:27], a[236:239], v[188:191], v[24:27]
  v_add_f32 v34, v34, v46
  v_add_f32 v35, v35, v47
  v_mfma_f32_16x16x32_bf16 v[28:31], a[236:239], a[188:191], 0
  v_add_f32 v32, v32, v36
  v_add_f32 v33, v33, v37
  v_mfma_f32_16x16x32_bf16 v[28:31], a[216:219], v[200:203], v[28:31]
  v_add_f32 v34, v34, v38
  v_add_f32 v35, v35, v39
  v_cvt_pk_bf16_f32 v36, v32, v33
  v_cvt_pk_bf16_f32 v37, v34, v35
  buffer_store_dwordx2 v[36:37], v125, s[24:27], s38 offen offset:1024 sc1
  v_mfma_f32_16x16x32_bf16 v[32:35], a[220:223], a[196:199], 0
  buffer_load_dwordx4 a[216:219], v111, s[24:27], s30 offen offset:1024 sc1
  s_waitcnt lgkmcnt(3)
  v_mfma_f32_16x16x32_bf16 v[32:35], a[240:243], a[200:203], v[32:35]
  v_add_f32 v52, v52, v56
  v_add_f32 v53, v53, v57
  v_mfma_f32_16x16x32_bf16 v[36:39], a[240:243], a[208:211], 0
  v_add_f32 v54, v54, v58
  v_add_f32 v55, v55, v59
  v_mfma_f32_16x16x32_bf16 v[36:39], a[220:223], v[152:155], v[36:39]
  v_add_f32 v48, v48, v60
  v_add_f32 v49, v49, v61
  v_mfma_f32_16x16x32_bf16 v[40:43], a[220:223], v[184:187], 0
  buffer_load_dwordx4 a[236:239], v112, s[24:27], s30 offen offset:0 sc1
  v_mfma_f32_16x16x32_bf16 v[40:43], a[240:243], v[188:191], v[40:43]
  v_add_f32 v50, v50, v62
  v_add_f32 v51, v51, v63
  v_mfma_f32_16x16x32_bf16 v[44:47], a[240:243], a[188:191], 0
  v_add_f32 v48, v48, v52
  v_add_f32 v49, v49, v53
  v_mfma_f32_16x16x32_bf16 v[44:47], a[220:223], v[200:203], v[44:47]
  v_add_f32 v50, v50, v54
  v_add_f32 v51, v51, v55
  v_cvt_pk_bf16_f32 v52, v48, v49
  v_cvt_pk_bf16_f32 v53, v50, v51
  buffer_store_dwordx2 v[52:53], v125, s[24:27], s38 offen offset:1536 sc1
  v_mfma_f32_16x16x32_bf16 v[48:51], a[224:227], a[196:199], 0
  buffer_load_dwordx4 a[220:223], v112, s[24:27], s30 offen offset:1024 sc1
  s_waitcnt lgkmcnt(0)
  v_mfma_f32_16x16x32_bf16 v[48:51], a[244:247], a[200:203], v[48:51]
  v_add_f32 v68, v68, v72
  v_add_f32 v69, v69, v73
  v_mfma_f32_16x16x32_bf16 v[52:55], a[244:247], a[208:211], 0
  v_add_f32 v70, v70, v74
  v_add_f32 v71, v71, v75
  v_mfma_f32_16x16x32_bf16 v[52:55], a[224:227], v[152:155], v[52:55]
  v_add_f32 v64, v64, v76
  v_add_f32 v65, v65, v77
  v_mfma_f32_16x16x32_bf16 v[56:59], a[224:227], v[184:187], 0
  buffer_load_dwordx4 a[240:243], v113, s[24:27], s30 offen offset:0 sc1
  v_mfma_f32_16x16x32_bf16 v[56:59], a[244:247], v[188:191], v[56:59]
  v_add_f32 v66, v66, v78
  v_add_f32 v67, v67, v79
  v_mfma_f32_16x16x32_bf16 v[60:63], a[244:247], a[188:191], 0
  v_add_f32 v64, v64, v68
  v_add_f32 v65, v65, v69
  v_mfma_f32_16x16x32_bf16 v[60:63], a[224:227], v[200:203], v[60:63]
  v_add_f32 v66, v66, v70
  v_add_f32 v67, v67, v71
  v_cvt_pk_bf16_f32 v68, v64, v65
  v_cvt_pk_bf16_f32 v69, v66, v67
  buffer_store_dwordx2 v[68:69], v125, s[24:27], s38 offen offset:2048 sc1
  v_mfma_f32_16x16x32_bf16 v[64:67], a[228:231], a[196:199], 0
  buffer_load_dwordx4 a[224:227], v113, s[24:27], s30 offen offset:1024 sc1
  s_xor_b32 s38, s40, 1
  s_lshl_b32 s38, s38, 7
  s_add_u32 s38, s38, 2834432
  v_mfma_f32_16x16x32_bf16 v[64:67], a[248:251], a[200:203], v[64:67]
  v_mov_b32 v126, 1073741824
  v_writelane_b32 v126, s38, 0
  v_mfma_f32_16x16x32_bf16 v[68:71], a[248:251], a[208:211], 0
  v_mov_b32 v127, 1
  v_mfma_f32_16x16x32_bf16 v[68:71], a[228:231], v[152:155], v[68:71]
  s_xor_b32 s38, s38, 128
  v_mov_b32 v133, s38
  v_mov_b32 v134, 4
  v_mfma_f32_16x16x32_bf16 v[72:75], a[228:231], v[184:187], 0
  s_add_u32 s30, s30, 8192
  buffer_load_dwordx4 a[244:247], v110, s[24:27], s30 offen offset:0 sc1
  v_mfma_f32_16x16x32_bf16 v[72:75], a[248:251], v[188:191], v[72:75]
  v_mfma_f32_16x16x32_bf16 v[76:79], a[248:251], a[188:191], 0
  v_mfma_f32_16x16x32_bf16 v[76:79], a[228:231], v[200:203], v[76:79]
  s_waitcnt vmcnt(30)
  v_mfma_f32_16x16x32_bf16 v[0:3], a[252:255], v[236:239], v[0:3]
  buffer_load_dwordx4 a[228:231], v110, s[24:27], s30 offen offset:1024 sc1
  v_mfma_f32_16x16x32_bf16 v[0:3], a[144:147], v[192:195], v[0:3]
  v_mfma_f32_16x16x32_bf16 v[4:7], a[144:147], v[212:215], v[4:7]
  v_mfma_f32_16x16x32_bf16 v[4:7], a[252:255], v[196:199], v[4:7]
  v_mfma_f32_16x16x32_bf16 v[8:11], a[252:255], v[216:219], v[8:11]
  buffer_load_dwordx4 a[248:251], v111, s[24:27], s30 offen offset:0 sc1
  v_mfma_f32_16x16x32_bf16 v[8:11], a[144:147], v[228:231], v[8:11]
  v_mfma_f32_16x16x32_bf16 v[12:15], a[144:147], a[192:195], v[12:15]
  v_mfma_f32_16x16x32_bf16 v[12:15], a[252:255], v[232:235], v[12:15]
  v_mfma_f32_16x16x32_bf16 v[16:19], a[128:131], v[236:239], v[16:19]
  buffer_load_dwordx4 a[196:199], v111, s[24:27], s30 offen offset:1024 sc1
  v_mfma_f32_16x16x32_bf16 v[16:19], a[148:151], v[192:195], v[16:19]
  v_mfma_f32_16x16x32_bf16 v[20:23], a[148:151], v[212:215], v[20:23]
  v_mfma_f32_16x16x32_bf16 v[20:23], a[128:131], v[196:199], v[20:23]
  v_mfma_f32_16x16x32_bf16 v[24:27], a[128:131], v[216:219], v[24:27]
  buffer_load_dwordx4 a[200:203], v112, s[24:27], s30 offen offset:0 sc1
  v_mfma_f32_16x16x32_bf16 v[24:27], a[148:151], v[228:231], v[24:27]
  v_mfma_f32_16x16x32_bf16 v[28:31], a[148:151], a[192:195], v[28:31]
  v_mfma_f32_16x16x32_bf16 v[28:31], a[128:131], v[232:235], v[28:31]
  v_mfma_f32_16x16x32_bf16 v[32:35], a[132:135], v[236:239], v[32:35]
  buffer_load_dwordx4 a[208:211], v112, s[24:27], s30 offen offset:1024 sc1
  v_mfma_f32_16x16x32_bf16 v[32:35], a[152:155], v[192:195], v[32:35]
  v_mfma_f32_16x16x32_bf16 v[36:39], a[152:155], v[212:215], v[36:39]
  v_mfma_f32_16x16x32_bf16 v[36:39], a[132:135], v[196:199], v[36:39]
  v_mfma_f32_16x16x32_bf16 v[40:43], a[132:135], v[216:219], v[40:43]
  buffer_load_dwordx4 v[184:187], v113, s[24:27], s30 offen offset:0 sc1
  v_mfma_f32_16x16x32_bf16 v[40:43], a[152:155], v[228:231], v[40:43]
  v_mfma_f32_16x16x32_bf16 v[44:47], a[152:155], a[192:195], v[44:47]
  v_mfma_f32_16x16x32_bf16 v[44:47], a[132:135], v[232:235], v[44:47]
  v_mfma_f32_16x16x32_bf16 v[48:51], a[136:139], v[236:239], v[48:51]
  buffer_load_dwordx4 v[188:191], v113, s[24:27], s30 offen offset:1024 sc1
  v_mfma_f32_16x16x32_bf16 v[48:51], a[156:159], v[192:195], v[48:51]
  v_mfma_f32_16x16x32_bf16 v[52:55], a[156:159], v[212:215], v[52:55]
  v_mfma_f32_16x16x32_bf16 v[52:55], a[136:139], v[196:199], v[52:55]
  v_mfma_f32_16x16x32_bf16 v[56:59], a[136:139], v[216:219], v[56:59]
  s_add_u32 s30, s30, 8192
  buffer_load_dwordx4 v[200:203], v110, s[24:27], s30 offen offset:0 sc1
  v_mfma_f32_16x16x32_bf16 v[56:59], a[156:159], v[228:231], v[56:59]
  v_mfma_f32_16x16x32_bf16 v[60:63], a[156:159], a[192:195], v[60:63]
  v_mfma_f32_16x16x32_bf16 v[60:63], a[136:139], v[232:235], v[60:63]
  v_mfma_f32_16x16x32_bf16 v[64:67], a[140:143], v[236:239], v[64:67]
  buffer_load_dwordx4 a[188:191], v110, s[24:27], s30 offen offset:1024 sc1
  v_mfma_f32_16x16x32_bf16 v[64:67], a[0:3], v[192:195], v[64:67]
  v_mfma_f32_16x16x32_bf16 v[68:71], a[0:3], v[212:215], v[68:71]
  v_mfma_f32_16x16x32_bf16 v[68:71], a[140:143], v[196:199], v[68:71]
  v_mfma_f32_16x16x32_bf16 v[72:75], a[140:143], v[216:219], v[72:75]
  buffer_load_dwordx4 a[252:255], v111, s[24:27], s30 offen offset:0 sc1
  v_mfma_f32_16x16x32_bf16 v[72:75], a[0:3], v[228:231], v[72:75]
  v_mfma_f32_16x16x32_bf16 v[76:79], a[0:3], a[192:195], v[76:79]
  v_mfma_f32_16x16x32_bf16 v[76:79], a[140:143], v[232:235], v[76:79]
  s_waitcnt vmcnt(32)
  v_mfma_f32_16x16x32_bf16 v[0:3], a[4:7], a[204:207], v[0:3]
  buffer_load_dwordx4 a[144:147], v111, s[24:27], s30 offen offset:1024 sc1
  v_mfma_f32_16x16x32_bf16 v[0:3], a[24:27], v[248:251], v[0:3]
  v_mfma_f32_16x16x32_bf16 v[4:7], a[24:27], v[176:179], v[4:7]
  v_mfma_f32_16x16x32_bf16 v[4:7], a[4:7], v[140:143], v[4:7]
  v_mfma_f32_16x16x32_bf16 v[8:11], a[4:7], v[180:183], v[8:11]
  buffer_load_dwordx4 a[128:131], v112, s[24:27], s30 offen offset:0 sc1
  v_mfma_f32_16x16x32_bf16 v[8:11], a[24:27], v[204:207], v[8:11]
  v_mfma_f32_16x16x32_bf16 v[12:15], a[24:27], v[220:223], v[12:15]
  v_mfma_f32_16x16x32_bf16 v[12:15], a[4:7], v[208:211], v[12:15]
  v_mfma_f32_16x16x32_bf16 v[16:19], a[8:11], a[204:207], v[16:19]
  buffer_load_dwordx4 a[148:151], v112, s[24:27], s30 offen offset:1024 sc1
  v_mfma_f32_16x16x32_bf16 v[16:19], a[28:31], v[248:251], v[16:19]
  v_mfma_f32_16x16x32_bf16 v[20:23], a[28:31], v[176:179], v[20:23]
  v_mfma_f32_16x16x32_bf16 v[20:23], a[8:11], v[140:143], v[20:23]
  v_mfma_f32_16x16x32_bf16 v[24:27], a[8:11], v[180:183], v[24:27]
  buffer_load_dwordx4 a[132:135], v113, s[24:27], s30 offen offset:0 sc1
  v_mfma_f32_16x16x32_bf16 v[24:27], a[28:31], v[204:207], v[24:27]
  v_mfma_f32_16x16x32_bf16 v[28:31], a[28:31], v[220:223], v[28:31]
  v_mfma_f32_16x16x32_bf16 v[28:31], a[8:11], v[208:211], v[28:31]
  v_mfma_f32_16x16x32_bf16 v[32:35], a[12:15], a[204:207], v[32:35]
  buffer_load_dwordx4 a[152:155], v113, s[24:27], s30 offen offset:1024 sc1
  v_mfma_f32_16x16x32_bf16 v[32:35], a[32:35], v[248:251], v[32:35]
  v_mfma_f32_16x16x32_bf16 v[36:39], a[32:35], v[176:179], v[36:39]
  v_mfma_f32_16x16x32_bf16 v[36:39], a[12:15], v[140:143], v[36:39]
  v_mfma_f32_16x16x32_bf16 v[40:43], a[12:15], v[180:183], v[40:43]
  s_add_u32 s30, s30, 8192
  buffer_load_dwordx4 a[136:139], v110, s[24:27], s30 offen offset:0 sc1
  v_mfma_f32_16x16x32_bf16 v[40:43], a[32:35], v[204:207], v[40:43]
  v_mfma_f32_16x16x32_bf16 v[44:47], a[32:35], v[220:223], v[44:47]
  v_mfma_f32_16x16x32_bf16 v[44:47], a[12:15], v[208:211], v[44:47]
  v_mfma_f32_16x16x32_bf16 v[48:51], a[16:19], a[204:207], v[48:51]
  buffer_load_dwordx4 a[156:159], v110, s[24:27], s30 offen offset:1024 sc1
  v_mfma_f32_16x16x32_bf16 v[48:51], a[36:39], v[248:251], v[48:51]
  v_mfma_f32_16x16x32_bf16 v[52:55], a[36:39], v[176:179], v[52:55]
  v_mfma_f32_16x16x32_bf16 v[52:55], a[16:19], v[140:143], v[52:55]
  v_mfma_f32_16x16x32_bf16 v[56:59], a[16:19], v[180:183], v[56:59]
  buffer_load_dwordx4 a[140:143], v111, s[24:27], s30 offen offset:0 sc1
  v_mfma_f32_16x16x32_bf16 v[56:59], a[36:39], v[204:207], v[56:59]
  v_mfma_f32_16x16x32_bf16 v[60:63], a[36:39], v[220:223], v[60:63]
  v_mfma_f32_16x16x32_bf16 v[60:63], a[16:19], v[208:211], v[60:63]
  v_mfma_f32_16x16x32_bf16 v[64:67], a[20:23], a[204:207], v[64:67]
  buffer_load_dwordx4 a[0:3], v111, s[24:27], s30 offen offset:1024 sc1
  v_mfma_f32_16x16x32_bf16 v[64:67], a[40:43], v[248:251], v[64:67]
  v_mfma_f32_16x16x32_bf16 v[68:71], a[40:43], v[176:179], v[68:71]
  v_mfma_f32_16x16x32_bf16 v[68:71], a[20:23], v[140:143], v[68:71]
  v_mfma_f32_16x16x32_bf16 v[72:75], a[20:23], v[180:183], v[72:75]
  buffer_load_dwordx4 v[236:239], v112, s[24:27], s30 offen offset:0 sc1
  v_mfma_f32_16x16x32_bf16 v[72:75], a[40:43], v[204:207], v[72:75]
  v_mfma_f32_16x16x32_bf16 v[76:79], a[40:43], v[220:223], v[76:79]
  v_mfma_f32_16x16x32_bf16 v[76:79], a[20:23], v[208:211], v[76:79]
  s_waitcnt vmcnt(34)
  v_mfma_f32_16x16x32_bf16 v[0:3], a[44:47], v[224:227], v[0:3]
  buffer_load_dwordx4 v[192:195], v112, s[24:27], s30 offen offset:1024 sc1
  s_waitcnt vmcnt(23)
  v_mfma_f32_16x16x32_bf16 v[0:3], a[64:67], v[240:243], v[0:3]
  buffer_atomic_add v127, v126, s[24:27], 0 offen
  v_mfma_f32_16x16x32_bf16 v[4:7], a[64:67], v[252:255], v[4:7]
  v_mfma_f32_16x16x32_bf16 v[4:7], a[44:47], v[244:247], v[4:7]
  v_mfma_f32_16x16x32_bf16 v[8:11], a[44:47], v[136:139], v[8:11]
  buffer_load_dwordx4 v[196:199], v113, s[24:27], s30 offen offset:0 sc1
  v_mfma_f32_16x16x32_bf16 v[8:11], a[64:67], v[144:147], v[8:11]
  v_mfma_f32_16x16x32_bf16 v[12:15], a[64:67], a[180:183], v[12:15]
  v_mfma_f32_16x16x32_bf16 v[12:15], a[44:47], v[148:151], v[12:15]
  v_mfma_f32_16x16x32_bf16 v[16:19], a[48:51], v[224:227], v[16:19]
  buffer_load_dwordx4 v[212:215], v113, s[24:27], s30 offen offset:1024 sc1
  v_mfma_f32_16x16x32_bf16 v[16:19], a[68:71], v[240:243], v[16:19]
  v_mfma_f32_16x16x32_bf16 v[20:23], a[68:71], v[252:255], v[20:23]
  v_mfma_f32_16x16x32_bf16 v[20:23], a[48:51], v[244:247], v[20:23]
  v_mfma_f32_16x16x32_bf16 v[24:27], a[48:51], v[136:139], v[24:27]
  s_add_u32 s30, s30, 8192
  v_mfma_f32_16x16x32_bf16 v[24:27], a[68:71], v[144:147], v[24:27]
  v_mfma_f32_16x16x32_bf16 v[28:31], a[68:71], a[180:183], v[28:31]
  v_mfma_f32_16x16x32_bf16 v[28:31], a[48:51], v[148:151], v[28:31]
  v_mfma_f32_16x16x32_bf16 v[32:35], a[52:55], v[224:227], v[32:35]
  v_mfma_f32_16x16x32_bf16 v[32:35], a[72:75], v[240:243], v[32:35]
  v_mfma_f32_16x16x32_bf16 v[36:39], a[72:75], v[252:255], v[36:39]
  v_mfma_f32_16x16x32_bf16 v[36:39], a[52:55], v[244:247], v[36:39]
  v_mfma_f32_16x16x32_bf16 v[40:43], a[52:55], v[136:139], v[40:43]
  v_mfma_f32_16x16x32_bf16 v[40:43], a[72:75], v[144:147], v[40:43]
  v_mfma_f32_16x16x32_bf16 v[44:47], a[72:75], a[180:183], v[44:47]
  v_mfma_f32_16x16x32_bf16 v[44:47], a[52:55], v[148:151], v[44:47]
  v_mfma_f32_16x16x32_bf16 v[48:51], a[56:59], v[224:227], v[48:51]
  v_mfma_f32_16x16x32_bf16 v[48:51], a[76:79], v[240:243], v[48:51]
  v_mfma_f32_16x16x32_bf16 v[52:55], a[76:79], v[252:255], v[52:55]
  v_mfma_f32_16x16x32_bf16 v[52:55], a[56:59], v[244:247], v[52:55]
  v_mfma_f32_16x16x32_bf16 v[56:59], a[56:59], v[136:139], v[56:59]
  v_mfma_f32_16x16x32_bf16 v[56:59], a[76:79], v[144:147], v[56:59]
  v_mfma_f32_16x16x32_bf16 v[60:63], a[76:79], a[180:183], v[60:63]
  v_mfma_f32_16x16x32_bf16 v[60:63], a[56:59], v[148:151], v[60:63]
  v_mfma_f32_16x16x32_bf16 v[64:67], a[60:63], v[224:227], v[64:67]
  v_mfma_f32_16x16x32_bf16 v[64:67], a[80:83], v[240:243], v[64:67]
  v_mfma_f32_16x16x32_bf16 v[68:71], a[80:83], v[252:255], v[68:71]
  v_mfma_f32_16x16x32_bf16 v[68:71], a[60:63], v[244:247], v[68:71]
  v_mfma_f32_16x16x32_bf16 v[72:75], a[60:63], v[136:139], v[72:75]
  v_mfma_f32_16x16x32_bf16 v[72:75], a[80:83], v[144:147], v[72:75]
  v_mfma_f32_16x16x32_bf16 v[76:79], a[80:83], a[180:183], v[76:79]
  v_mfma_f32_16x16x32_bf16 v[76:79], a[60:63], v[148:151], v[76:79]
  s_waitcnt vmcnt(25)
  v_mfma_f32_16x16x32_bf16 v[0:3], a[84:87], a[184:187], v[0:3]
  v_mfma_f32_16x16x32_bf16 v[0:3], a[104:107], a[212:215], v[0:3]
  v_mfma_f32_16x16x32_bf16 v[4:7], a[104:107], a[216:219], v[4:7]
  v_mfma_f32_16x16x32_bf16 v[4:7], a[84:87], a[232:235], v[4:7]
  v_mfma_f32_16x16x32_bf16 v[8:11], a[84:87], a[236:239], v[8:11]
  v_mfma_f32_16x16x32_bf16 v[8:11], a[104:107], a[220:223], v[8:11]
  v_mfma_f32_16x16x32_bf16 v[12:15], a[104:107], a[224:227], v[12:15]
  v_mfma_f32_16x16x32_bf16 v[12:15], a[84:87], a[240:243], v[12:15]
  v_mfma_f32_16x16x32_bf16 v[16:19], a[88:91], a[184:187], v[16:19]
  v_mfma_f32_16x16x32_bf16 v[16:19], a[108:111], a[212:215], v[16:19]
  v_mfma_f32_16x16x32_bf16 v[20:23], a[108:111], a[216:219], v[20:23]
  v_mfma_f32_16x16x32_bf16 v[20:23], a[88:91], a[232:235], v[20:23]
  v_mfma_f32_16x16x32_bf16 v[24:27], a[88:91], a[236:239], v[24:27]
  v_mfma_f32_16x16x32_bf16 v[24:27], a[108:111], a[220:223], v[24:27]
  v_mfma_f32_16x16x32_bf16 v[28:31], a[108:111], a[224:227], v[28:31]
  v_mfma_f32_16x16x32_bf16 v[28:31], a[88:91], a[240:243], v[28:31]
  v_mfma_f32_16x16x32_bf16 v[32:35], a[92:95], a[184:187], v[32:35]
  v_mfma_f32_16x16x32_bf16 v[32:35], a[112:115], a[212:215], v[32:35]
  v_mfma_f32_16x16x32_bf16 v[36:39], a[112:115], a[216:219], v[36:39]
  v_mfma_f32_16x16x32_bf16 v[36:39], a[92:95], a[232:235], v[36:39]
  v_mfma_f32_16x16x32_bf16 v[40:43], a[92:95], a[236:239], v[40:43]
  v_mfma_f32_16x16x32_bf16 v[40:43], a[112:115], a[220:223], v[40:43]
  v_mfma_f32_16x16x32_bf16 v[44:47], a[112:115], a[224:227], v[44:47]
  v_mfma_f32_16x16x32_bf16 v[44:47], a[92:95], a[240:243], v[44:47]
  v_mfma_f32_16x16x32_bf16 v[48:51], a[96:99], a[184:187], v[48:51]
  v_mfma_f32_16x16x32_bf16 v[48:51], a[116:119], a[212:215], v[48:51]
  v_mfma_f32_16x16x32_bf16 v[52:55], a[116:119], a[216:219], v[52:55]
  v_mfma_f32_16x16x32_bf16 v[52:55], a[96:99], a[232:235], v[52:55]
  v_mfma_f32_16x16x32_bf16 v[56:59], a[96:99], a[236:239], v[56:59]
  v_mfma_f32_16x16x32_bf16 v[56:59], a[116:119], a[220:223], v[56:59]
  v_mfma_f32_16x16x32_bf16 v[60:63], a[116:119], a[224:227], v[60:63]
  v_mfma_f32_16x16x32_bf16 v[60:63], a[96:99], a[240:243], v[60:63]
  v_mfma_f32_16x16x32_bf16 v[64:67], a[100:103], a[184:187], v[64:67]
  ds_read_b128 v[216:219], v122 offset:0
  v_mfma_f32_16x16x32_bf16 v[64:67], a[120:123], a[212:215], v[64:67]
  v_mfma_f32_16x16x32_bf16 v[68:71], a[120:123], a[216:219], v[68:71]
  v_mfma_f32_16x16x32_bf16 v[68:71], a[100:103], a[232:235], v[68:71]
  v_mfma_f32_16x16x32_bf16 v[72:75], a[100:103], a[236:239], v[72:75]
  v_mfma_f32_16x16x32_bf16 v[72:75], a[120:123], a[220:223], v[72:75]
  v_mfma_f32_16x16x32_bf16 v[76:79], a[120:123], a[224:227], v[76:79]
  v_mfma_f32_16x16x32_bf16 v[76:79], a[100:103], a[240:243], v[76:79]
  s_waitcnt vmcnt(17)
  v_mfma_f32_16x16x32_bf16 v[0:3], a[124:127], a[244:247], v[0:3]
  ds_read_b128 v[228:231], v122 offset:1024
  buffer_load_dword v128, v133, s[24:27], 0 offen sc1
  s_xor_b32 s38, s40, 0
  s_lshl_b32 s38, s38, 2
  s_add_u32 s38, s38, s3
  v_mfma_f32_16x16x32_bf16 v[0:3], a[176:179], a[228:231], v[0:3]
  s_lshl_b32 s38, s38, 12
  s_add_u32 s38, s38, 25165824
  v_mfma_f32_16x16x32_bf16 v[4:7], a[176:179], a[196:199], v[4:7]
  v_mfma_f32_16x16x32_bf16 v[4:7], a[124:127], a[248:251], v[4:7]
  v_mfma_f32_16x16x32_bf16 v[8:11], a[124:127], a[200:203], v[8:11]
  v_mfma_f32_16x16x32_bf16 v[8:11], a[176:179], a[208:211], v[8:11]
  v_mfma_f32_16x16x32_bf16 v[12:15], a[176:179], v[188:191], v[12:15]
  v_mfma_f32_16x16x32_bf16 v[12:15], a[124:127], v[184:187], v[12:15]
  s_waitcnt lgkmcnt(1)
  v_mfma_f32_16x16x32_bf16 v[16:19], a[160:163], a[244:247], v[16:19]
  ds_read_b128 v[232:235], v122 offset:2048
  v_mfma_f32_16x16x32_bf16 v[16:19], v[216:219], a[228:231], v[16:19]
  v_mfma_f32_16x16x32_bf16 v[20:23], v[216:219], a[196:199], v[20:23]
  v_mfma_f32_16x16x32_bf16 v[20:23], a[160:163], a[248:251], v[20:23]
  v_mfma_f32_16x16x32_bf16 v[24:27], a[160:163], a[200:203], v[24:27]
  v_mfma_f32_16x16x32_bf16 v[24:27], v[216:219], a[208:211], v[24:27]
  v_mfma_f32_16x16x32_bf16 v[28:31], v[216:219], v[188:191], v[28:31]
  v_mfma_f32_16x16x32_bf16 v[28:31], a[160:163], v[184:187], v[28:31]
  s_waitcnt lgkmcnt(1)
  v_mfma_f32_16x16x32_bf16 v[32:35], a[164:167], a[244:247], v[32:35]
  ds_read_b128 a[192:195], v122 offset:3072
  v_mfma_f32_16x16x32_bf16 v[32:35], v[228:231], a[228:231], v[32:35]
  v_mfma_f32_16x16x32_bf16 v[36:39], v[228:231], a[196:199], v[36:39]
  v_mfma_f32_16x16x32_bf16 v[36:39], a[164:167], a[248:251], v[36:39]
  v_mfma_f32_16x16x32_bf16 v[40:43], a[164:167], a[200:203], v[40:43]
  v_mfma_f32_16x16x32_bf16 v[40:43], v[228:231], a[208:211], v[40:43]
  v_mfma_f32_16x16x32_bf16 v[44:47], v[228:231], v[188:191], v[44:47]
  v_mfma_f32_16x16x32_bf16 v[44:47], a[164:167], v[184:187], v[44:47]
  s_waitcnt lgkmcnt(1)
  v_mfma_f32_16x16x32_bf16 v[48:51], a[168:171], a[244:247], v[48:51]
  ds_read_b128 a[4:7], v122 offset:16384
  ds_read_b128 a[24:27], v122 offset:33792
  v_mfma_f32_16x16x32_bf16 v[48:51], v[232:235], a[228:231], v[48:51]
  v_mfma_f32_16x16x32_bf16 v[52:55], v[232:235], a[196:199], v[52:55]
  v_mfma_f32_16x16x32_bf16 v[52:55], a[168:171], a[248:251], v[52:55]
  v_mfma_f32_16x16x32_bf16 v[56:59], a[168:171], a[200:203], v[56:59]
  v_mfma_f32_16x16x32_bf16 v[56:59], v[232:235], a[208:211], v[56:59]
  v_mfma_f32_16x16x32_bf16 v[60:63], v[232:235], v[188:191], v[60:63]
  v_mfma_f32_16x16x32_bf16 v[60:63], a[168:171], v[184:187], v[60:63]
  s_waitcnt lgkmcnt(2)
  v_mfma_f32_16x16x32_bf16 v[64:67], a[172:175], a[244:247], v[64:67]
  ds_read_b128 a[8:11], v122 offset:17408
  ds_read_b128 a[28:31], v122 offset:34816
  v_mfma_f32_16x16x32_bf16 v[64:67], a[192:195], a[228:231], v[64:67]
  v_mfma_f32_16x16x32_bf16 v[68:71], a[192:195], a[196:199], v[68:71]
  v_mfma_f32_16x16x32_bf16 v[68:71], a[172:175], a[248:251], v[68:71]
  v_mfma_f32_16x16x32_bf16 v[72:75], a[172:175], a[200:203], v[72:75]
  v_mfma_f32_16x16x32_bf16 v[72:75], a[192:195], a[208:211], v[72:75]
  v_mfma_f32_16x16x32_bf16 v[76:79], a[192:195], v[188:191], v[76:79]
  v_mfma_f32_16x16x32_bf16 v[76:79], a[172:175], v[184:187], v[76:79]
  s_waitcnt vmcnt(10) lgkmcnt(2)
  v_mfma_f32_16x16x32_bf16 v[0:3], a[4:7], v[200:203], v[0:3]
  ds_read_b128 a[12:15], v122 offset:18432
  ds_read_b128 a[32:35], v122 offset:35840
  v_mfma_f32_16x16x32_bf16 v[0:3], a[24:27], a[188:191], v[0:3]
  v_mfma_f32_16x16x32_bf16 v[4:7], a[24:27], a[144:147], v[4:7]
  v_mfma_f32_16x16x32_bf16 v[4:7], a[4:7], a[252:255], v[4:7]
  v_mfma_f32_16x16x32_bf16 v[8:11], a[4:7], a[128:131], v[8:11]
  v_mfma_f32_16x16x32_bf16 v[8:11], a[24:27], a[148:151], v[8:11]
  v_mfma_f32_16x16x32_bf16 v[12:15], a[24:27], a[152:155], v[12:15]
  v_mfma_f32_16x16x32_bf16 v[12:15], a[4:7], a[132:135], v[12:15]
  s_waitcnt lgkmcnt(2)
  v_mfma_f32_16x16x32_bf16 v[16:19], a[8:11], v[200:203], v[16:19]
  ds_read_b128 a[16:19], v122 offset:19456
  ds_read_b128 a[36:39], v135 offset:0
  v_mfma_f32_16x16x32_bf16 v[16:19], a[28:31], a[188:191], v[16:19]
  v_mfma_f32_16x16x32_bf16 v[20:23], a[28:31], a[144:147], v[20:23]
  v_mfma_f32_16x16x32_bf16 v[20:23], a[8:11], a[252:255], v[20:23]
  v_mfma_f32_16x16x32_bf16 v[24:27], a[8:11], a[128:131], v[24:27]
  v_mfma_f32_16x16x32_bf16 v[24:27], a[28:31], a[148:151], v[24:27]
  v_mfma_f32_16x16x32_bf16 v[28:31], a[28:31], a[152:155], v[28:31]
  v_mfma_f32_16x16x32_bf16 v[28:31], a[8:11], a[132:135], v[28:31]
  s_waitcnt lgkmcnt(2)
  v_mfma_f32_16x16x32_bf16 v[32:35], a[12:15], v[200:203], v[32:35]
  ds_read_b128 a[20:23], v122 offset:32768
  ds_read_b128 a[40:43], v135 offset:1024
  v_mfma_f32_16x16x32_bf16 v[32:35], a[32:35], a[188:191], v[32:35]
  v_mfma_f32_16x16x32_bf16 v[36:39], a[32:35], a[144:147], v[36:39]
  v_mfma_f32_16x16x32_bf16 v[36:39], a[12:15], a[252:255], v[36:39]
  v_mfma_f32_16x16x32_bf16 v[40:43], a[12:15], a[128:131], v[40:43]
  v_mfma_f32_16x16x32_bf16 v[40:43], a[32:35], a[148:151], v[40:43]
  v_mfma_f32_16x16x32_bf16 v[44:47], a[32:35], a[152:155], v[44:47]
  v_mfma_f32_16x16x32_bf16 v[44:47], a[12:15], a[132:135], v[44:47]
  s_waitcnt lgkmcnt(2)
  v_mfma_f32_16x16x32_bf16 v[48:51], a[16:19], v[200:203], v[48:51]
  ds_read_b128 a[204:207], v135 offset:2048
  ds_read_b128 v[248:251], v135 offset:19456
  v_mfma_f32_16x16x32_bf16 v[48:51], a[36:39], a[188:191], v[48:51]
  v_mfma_f32_16x16x32_bf16 v[52:55], a[36:39], a[144:147], v[52:55]
  v_mfma_f32_16x16x32_bf16 v[52:55], a[16:19], a[252:255], v[52:55]
  v_mfma_f32_16x16x32_bf16 v[56:59], a[16:19], a[128:131], v[56:59]
  v_mfma_f32_16x16x32_bf16 v[56:59], a[36:39], a[148:151], v[56:59]
  v_mfma_f32_16x16x32_bf16 v[60:63], a[36:39], a[152:155], v[60:63]
  v_mfma_f32_16x16x32_bf16 v[60:63], a[16:19], a[132:135], v[60:63]
  s_waitcnt lgkmcnt(2)
  v_mfma_f32_16x16x32_bf16 v[64:67], a[20:23], v[200:203], v[64:67]
  ds_read_b128 v[176:179], v135 offset:3072
  ds_read_b128 v[180:183], v122 offset:49152
  v_mfma_f32_16x16x32_bf16 v[64:67], a[40:43], a[188:191], v[64:67]
  v_mfma_f32_16x16x32_bf16 v[68:71], a[40:43], a[144:147], v[68:71]
  v_mfma_f32_16x16x32_bf16 v[68:71], a[20:23], a[252:255], v[68:71]
  v_mfma_f32_16x16x32_bf16 v[72:75], a[20:23], a[128:131], v[72:75]
  v_mfma_f32_16x16x32_bf16 v[72:75], a[40:43], a[148:151], v[72:75]
  v_mfma_f32_16x16x32_bf16 v[76:79], a[40:43], a[152:155], v[76:79]
  v_mfma_f32_16x16x32_bf16 v[76:79], a[20:23], a[132:135], v[76:79]
  s_waitcnt vmcnt(0)
  v_cmp_lt_u32 vcc, v128, v134
  s_nop 0
  s_cbranch_vccz tail_partner
  s_mov_b32 s35, 32768
tail_spin2:
  s_sleep 2
  buffer_load_dword v128, v133, s[24:27], 0 offen sc1
  s_waitcnt vmcnt(0)
  v_cmp_lt_u32 vcc, v128, v134
  s_nop 0
  s_cbranch_vccz tail_partner
  s_sub_u32 s35, s35, 1
  s_cmp_lg_u32 s35, 0
  s_cbranch_scc1 tail_spin2
tail_partner:
  s_waitcnt lgkmcnt(2)
  v_mfma_f32_16x16x32_bf16 v[0:3], a[204:207], a[136:139], v[0:3]
  ds_read_b128 v[204:207], v135 offset:16384
  ds_read_b128 v[208:211], v122 offset:50176
  v_mfma_f32_16x16x32_bf16 v[0:3], v[248:251], a[156:159], v[0:3]
  buffer_load_dwordx2 v[138:139], v125, s[24:27], s38 offen offset:0 sc1
  v_mfma_f32_16x16x32_bf16 v[4:7], v[248:251], a[0:3], v[4:7]
  buffer_load_dwordx2 v[142:143], v125, s[24:27], s38 offen offset:512 sc1
  v_mfma_f32_16x16x32_bf16 v[4:7], a[204:207], a[140:143], v[4:7]
  buffer_load_dwordx2 v[146:147], v125, s[24:27], s38 offen offset:1024 sc1
  v_mfma_f32_16x16x32_bf16 v[8:11], a[204:207], v[236:239], v[8:11]
  buffer_load_dwordx2 v[150:151], v125, s[24:27], s38 offen offset:1536 sc1
  v_mfma_f32_16x16x32_bf16 v[8:11], v[248:251], v[192:195], v[8:11]
  buffer_load_dwordx2 v[154:155], v125, s[24:27], s38 offen offset:2048 sc1
  v_mfma_f32_16x16x32_bf16 v[12:15], v[248:251], v[212:215], v[12:15]
  v_mfma_f32_16x16x32_bf16 v[12:15], a[204:207], v[196:199], v[12:15]
  s_waitcnt lgkmcnt(2)
  v_mfma_f32_16x16x32_bf16 v[16:19], v[176:179], a[136:139], v[16:19]
  ds_read_b128 v[220:223], v135 offset:17408
  ds_read_b128 a[44:47], v122 offset:51200
  v_mfma_f32_16x16x32_bf16 v[16:19], v[180:183], a[156:159], v[16:19]
  ds_write_b128 v122, v[4:7] offset:0
  ds_write_b128 v122, v[8:11] offset:17408
  v_mfma_f32_16x16x32_bf16 v[20:23], v[180:183], a[0:3], v[20:23]
  ds_write_b128 v122, v[12:15] offset:34816
  v_mfma_f32_16x16x32_bf16 v[20:23], v[176:179], a[140:143], v[20:23]
  v_mfma_f32_16x16x32_bf16 v[24:27], v[176:179], v[236:239], v[24:27]
  v_mfma_f32_16x16x32_bf16 v[24:27], v[180:183], v[192:195], v[24:27]
  v_mfma_f32_16x16x32_bf16 v[28:31], v[180:183], v[212:215], v[28:31]
  v_mfma_f32_16x16x32_bf16 v[28:31], v[176:179], v[196:199], v[28:31]
  s_waitcnt lgkmcnt(5)
  v_mfma_f32_16x16x32_bf16 v[32:35], v[204:207], a[136:139], v[32:35]
  ds_read_b128 a[64:67], v135 offset:18432
  ds_read_b128 a[48:51], v122 offset:52224
  v_mfma_f32_16x16x32_bf16 v[32:35], v[208:211], a[156:159], v[32:35]
  ds_write_b128 v122, v[20:23] offset:1024
  ds_write_b128 v122, v[24:27] offset:18432
  v_mfma_f32_16x16x32_bf16 v[36:39], v[208:211], a[0:3], v[36:39]
  ds_write_b128 v122, v[28:31] offset:35840
  v_mfma_f32_16x16x32_bf16 v[36:39], v[204:207], a[140:143], v[36:39]
  v_mfma_f32_16x16x32_bf16 v[40:43], v[204:207], v[236:239], v[40:43]
  v_mfma_f32_16x16x32_bf16 v[40:43], v[208:211], v[192:195], v[40:43]
  v_mfma_f32_16x16x32_bf16 v[44:47], v[208:211], v[212:215], v[44:47]
  v_mfma_f32_16x16x32_bf16 v[44:47], v[204:207], v[196:199], v[44:47]
  s_waitcnt lgkmcnt(8)
  v_mfma_f32_16x16x32_bf16 v[48:51], v[220:223], a[136:139], v[48:51]
  v_mfma_f32_16x16x32_bf16 v[48:51], a[44:47], a[156:159], v[48:51]
  v_mfma_f32_16x16x32_bf16 v[52:55], a[44:47], a[0:3], v[52:55]
  ds_write_b128 v122, v[36:39] offset:2048
  v_mfma_f32_16x16x32_bf16 v[52:55], v[220:223], a[140:143], v[52:55]
  ds_write_b128 v122, v[40:43] offset:19456
  v_mfma_f32_16x16x32_bf16 v[56:59], v[220:223], v[236:239], v[56:59]
  ds_write_b128 v122, v[44:47] offset:49152
  v_mfma_f32_16x16x32_bf16 v[56:59], a[44:47], v[192:195], v[56:59]
  v_mfma_f32_16x16x32_bf16 v[60:63], a[44:47], v[212:215], v[60:63]
  v_mfma_f32_16x16x32_bf16 v[60:63], v[220:223], v[196:199], v[60:63]
  s_waitcnt lgkmcnt(6)
  v_mfma_f32_16x16x32_bf16 v[64:67], a[64:67], a[136:139], v[64:67]
  ds_write_b128 v122, v[52:55] offset:3072
  v_mfma_f32_16x16x32_bf16 v[64:67], a[48:51], a[156:159], v[64:67]
  v_mfma_f32_16x16x32_bf16 v[68:71], a[48:51], a[0:3], v[68:71]
  v_mfma_f32_16x16x32_bf16 v[68:71], a[64:67], a[140:143], v[68:71]
  ds_write_b128 v122, v[56:59] offset:32768
  v_mfma_f32_16x16x32_bf16 v[72:75], a[64:67], v[236:239], v[72:75]
  ds_write_b128 v122, v[60:63] offset:50176
  v_mfma_f32_16x16x32_bf16 v[72:75], a[48:51], v[192:195], v[72:75]
  v_mfma_f32_16x16x32_bf16 v[76:79], a[48:51], v[212:215], v[76:79]
  v_mfma_f32_16x16x32_bf16 v[76:79], a[64:67], v[196:199], v[76:79]
  s_nop 1
  ds_write_b128 v122, v[68:71] offset:16384
  s_nop 2
  ds_write_b128 v122, v[72:75] offset:33792
  s_nop 0
  ds_write_b128 v122, v[76:79] offset:51200
  s_waitcnt vmcnt(4)
  v_lshlrev_b32 v136, 16, v138
  v_and_b32 v137, s34, v138
  v_lshlrev_b32 v138, 16, v139
  v_and_b32 v139, s34, v139
  v_pk_add_f32 v[0:1], v[0:1], v[136:137]
  v_pk_add_f32 v[2:3], v[2:3], v[138:139]
  s_waitcnt vmcnt(3)
  v_lshlrev_b32 v140, 16, v142
  v_and_b32 v141, s34, v142
  v_lshlrev_b32 v142, 16, v143
  v_and_b32 v143, s34, v143
  v_pk_add_f32 v[16:17], v[16:17], v[140:141]
  v_pk_add_f32 v[18:19], v[18:19], v[142:143]
  s_waitcnt vmcnt(2)
  v_lshlrev_b32 v144, 16, v146
  v_and_b32 v145, s34, v146
  v_lshlrev_b32 v146, 16, v147
  v_and_b32 v147, s34, v147
  v_pk_add_f32 v[32:33], v[32:33], v[144:145]
  v_pk_add_f32 v[34:35], v[34:35], v[146:147]
  s_waitcnt vmcnt(1)
  v_lshlrev_b32 v148, 16, v150
  v_and_b32 v149, s34, v150
  v_lshlrev_b32 v150, 16, v151
  v_and_b32 v151, s34, v151
  v_pk_add_f32 v[48:49], v[48:49], v[148:149]
  v_pk_add_f32 v[50:51], v[50:51], v[150:151]
  s_waitcnt vmcnt(0)
  v_lshlrev_b32 v152, 16, v154
  v_and_b32 v153, s34, v154
  v_lshlrev_b32 v154, 16, v155
  v_and_b32 v155, s34, v155
  v_pk_add_f32 v[64:65], v[64:65], v[152:153]
  v_pk_add_f32 v[66:67], v[66:67], v[154:155]
  s_waitcnt lgkmcnt(0)
  s_barrier
  ds_read_b128 v[4:7], v80 offset:0
  ds_read_b128 v[8:11], v81 offset:17408
  ds_read_b128 v[12:15], v82 offset:34816
  ds_read_b128 v[20:23], v80 offset:1024
  ds_read_b128 v[24:27], v81 offset:18432
  ds_read_b128 v[28:31], v82 offset:35840
  ds_read_b128 v[36:39], v80 offset:2048
  ds_read_b128 v[40:43], v81 offset:19456
  ds_read_b128 v[44:47], v82 offset:49152
  ds_read_b128 v[52:55], v80 offset:3072
  ds_read_b128 v[56:59], v81 offset:32768
  ds_read_b128 v[60:63], v82 offset:50176
  ds_read_b128 v[68:71], v80 offset:16384
  ds_read_b128 v[72:75], v81 offset:33792
  ds_read_b128 v[76:79], v82 offset:51200
  s_waitcnt lgkmcnt(13)
  v_pk_add_f32 v[4:5], v[4:5], v[8:9]
  v_pk_add_f32 v[6:7], v[6:7], v[10:11]
  s_waitcnt lgkmcnt(12)
  v_pk_add_f32 v[0:1], v[0:1], v[12:13]
  v_pk_add_f32 v[2:3], v[2:3], v[14:15]
  v_pk_add_f32 v[0:1], v[0:1], v[4:5]
  v_pk_add_f32 v[2:3], v[2:3], v[6:7]
  v_cvt_pk_bf16_f32 v4, v0, v1
  v_cvt_pk_bf16_f32 v5, v2, v3
  v_lshlrev_b32 v0, 16, v4
  v_and_b32 v1, s34, v4
  v_lshlrev_b32 v2, 16, v5
  v_and_b32 v3, s34, v5
  v_pk_mul_f32 v[0:1], v[0:1], v[90:91]
  v_pk_mul_f32 v[2:3], v[2:3], v[92:93]
  v_cvt_pk_bf16_f32 v4, v0, v1
  v_cvt_pk_bf16_f32 v5, v2, v3
  v_lshlrev_b32 v0, 16, v4
  v_and_b32 v1, s34, v4
  v_lshlrev_b32 v2, 16, v5
  v_and_b32 v3, s34, v5
  v_pk_add_f32 v[0:1], v[0:1], v[156:157]
  v_pk_add_f32 v[2:3], v[2:3], v[158:159]
  v_cvt_pk_bf16_f32 v4, v0, v1
  v_cvt_pk_bf16_f32 v5, v2, v3
  s_waitcnt lgkmcnt(10)
  v_pk_add_f32 v[20:21], v[20:21], v[24:25]
  v_pk_add_f32 v[22:23], v[22:23], v[26:27]
  s_waitcnt lgkmcnt(9)
  v_pk_add_f32 v[16:17], v[16:17], v[28:29]
  v_pk_add_f32 v[18:19], v[18:19], v[30:31]
  v_pk_add_f32 v[16:17], v[16:17], v[20:21]
  v_pk_add_f32 v[18:19], v[18:19], v[22:23]
  v_cvt_pk_bf16_f32 v20, v16, v17
  v_cvt_pk_bf16_f32 v21, v18, v19
  v_lshlrev_b32 v16, 16, v20
  v_and_b32 v17, s34, v20
  v_lshlrev_b32 v18, 16, v21
  v_and_b32 v19, s34, v21
  v_pk_mul_f32 v[16:17], v[16:17], v[94:95]
  v_pk_mul_f32 v[18:19], v[18:19], v[96:97]
  v_cvt_pk_bf16_f32 v20, v16, v17
  v_cvt_pk_bf16_f32 v21, v18, v19
  v_lshlrev_b32 v16, 16, v20
  v_and_b32 v17, s34, v20
  v_lshlrev_b32 v18, 16, v21
  v_and_b32 v19, s34, v21
  v_pk_add_f32 v[16:17], v[16:17], v[160:161]
  v_pk_add_f32 v[18:19], v[18:19], v[162:163]
  v_cvt_pk_bf16_f32 v6, v16, v17
  v_cvt_pk_bf16_f32 v7, v18, v19
  s_nop 0
  v_permlane16_swap_b32 v4, v6
  v_permlane16_swap_b32 v5, v7
  buffer_store_dwordx4 v[4:7], v83, s[16:19], 0 offen offset:0
  s_waitcnt lgkmcnt(7)
  v_pk_add_f32 v[36:37], v[36:37], v[40:41]
  v_pk_add_f32 v[38:39], v[38:39], v[42:43]
  s_waitcnt lgkmcnt(6)
  v_pk_add_f32 v[32:33], v[32:33], v[44:45]
  v_pk_add_f32 v[34:35], v[34:35], v[46:47]
  v_pk_add_f32 v[32:33], v[32:33], v[36:37]
  v_pk_add_f32 v[34:35], v[34:35], v[38:39]
  v_cvt_pk_bf16_f32 v36, v32, v33
  v_cvt_pk_bf16_f32 v37, v34, v35
  v_lshlrev_b32 v32, 16, v36
  v_and_b32 v33, s34, v36
  v_lshlrev_b32 v34, 16, v37
  v_and_b32 v35, s34, v37
  v_pk_mul_f32 v[32:33], v[32:33], v[98:99]
  v_pk_mul_f32 v[34:35], v[34:35], v[100:101]
  v_cvt_pk_bf16_f32 v36, v32, v33
  v_cvt_pk_bf16_f32 v37, v34, v35
  v_lshlrev_b32 v32, 16, v36
  v_and_b32 v33, s34, v36
  v_lshlrev_b32 v34, 16, v37
  v_and_b32 v35, s34, v37
  v_pk_add_f32 v[32:33], v[32:33], v[164:165]
  v_pk_add_f32 v[34:35], v[34:35], v[166:167]
  v_cvt_pk_bf16_f32 v36, v32, v33
  v_cvt_pk_bf16_f32 v37, v34, v35
  s_waitcnt lgkmcnt(4)
  v_pk_add_f32 v[52:53], v[52:53], v[56:57]
  v_pk_add_f32 v[54:55], v[54:55], v[58:59]
  s_waitcnt lgkmcnt(3)
  v_pk_add_f32 v[48:49], v[48:49], v[60:61]
  v_pk_add_f32 v[50:51], v[50:51], v[62:63]
  v_pk_add_f32 v[48:49], v[48:49], v[52:53]
  v_pk_add_f32 v[50:51], v[50:51], v[54:55]
  v_cvt_pk_bf16_f32 v52, v48, v49
  v_cvt_pk_bf16_f32 v53, v50, v51
  v_lshlrev_b32 v48, 16, v52
  v_and_b32 v49, s34, v52
  v_lshlrev_b32 v50, 16, v53
  v_and_b32 v51, s34, v53
  v_pk_mul_f32 v[48:49], v[48:49], v[102:103]
  v_pk_mul_f32 v[50:51], v[50:51], v[104:105]
  v_cvt_pk_bf16_f32 v52, v48, v49
  v_cvt_pk_bf16_f32 v53, v50, v51
  v_lshlrev_b32 v48, 16, v52
  v_and_b32 v49, s34, v52
  v_lshlrev_b32 v50, 16, v53
  v_and_b32 v51, s34, v53
  v_pk_add_f32 v[48:49], v[48:49], v[168:169]
  v_pk_add_f32 v[50:51], v[50:51], v[170:171]
  v_cvt_pk_bf16_f32 v38, v48, v49
  v_cvt_pk_bf16_f32 v39, v50, v51
  s_nop 0
  v_permlane16_swap_b32 v36, v38
  v_permlane16_swap_b32 v37, v39
  buffer_store_dwordx4 v[36:39], v83, s[16:19], 0 offen offset:64
  s_waitcnt lgkmcnt(1)
  v_pk_add_f32 v[68:69], v[68:69], v[72:73]
  v_pk_add_f32 v[70:71], v[70:71], v[74:75]
  s_waitcnt lgkmcnt(0)
  v_pk_add_f32 v[64:65], v[64:65], v[76:77]
  v_pk_add_f32 v[66:67], v[66:67], v[78:79]
  v_pk_add_f32 v[64:65], v[64:65], v[68:69]
  v_pk_add_f32 v[66:67], v[66:67], v[70:71]
  v_cvt_pk_bf16_f32 v68, v64, v65
  v_cvt_pk_bf16_f32 v69, v66, v67
  v_lshlrev_b32 v64, 16, v68
  v_and_b32 v65, s34, v68
  v_lshlrev_b32 v66, 16, v69
  v_and_b32 v67, s34, v69
  v_pk_mul_f32 v[64:65], v[64:65], v[106:107]
  v_pk_mul_f32 v[66:67], v[66:67], v[108:109]
  v_cvt_pk_bf16_f32 v68, v64, v65
  v_cvt_pk_bf16_f32 v69, v66, v67
  v_lshlrev_b32 v64, 16, v68
  v_and_b32 v65, s34, v68
  v_lshlrev_b32 v66, 16, v69
  v_and_b32 v67, s34, v69
  v_pk_add_f32 v[64:65], v[64:65], v[172:173]
  v_pk_add_f32 v[66:67], v[66:67], v[174:175]
  v_cvt_pk_bf16_f32 v68, v64, v65
  v_cvt_pk_bf16_f32 v69, v66, v67
  buffer_store_dwordx2 v[68:69], v117, s[16:19], 0 offen offset:128
attn_end:
  s_endpgm
attn_redo:
  s_waitcnt vmcnt(0)
  v_accvgpr_write_b32 a0, 0
  v_accvgpr_write_b32 a1, 0
  v_accvgpr_write_b32 a2, 0
  v_accvgpr_write_b32 a3, 0
  v_accvgpr_write_b32 a4, 0
  v_accvgpr_write_b32 a5, 0
  v_accvgpr_write_b32 a6, 0
  v_accvgpr_write_b32 a7, 0
  v_accvgpr_write_b32 a8, 0
  v_accvgpr_write_b32 a9, 0
  v_accvgpr_write_b32 a10, 0
  v_accvgpr_write_b32 a11, 0
  v_accvgpr_write_b32 a12, 0
  v_accvgpr_write_b32 a13, 0
  v_accvgpr_write_b32 a14, 0
  v_accvgpr_write_b32 a15, 0
  v_accvgpr_write_b32 a16, 0
  v_accvgpr_write_b32 a17, 0
  v_accvgpr_write_b32 a18, 0
  v_accvgpr_write_b32 a19, 0
  v_accvgpr_write_b32 a20, 0
  v_accvgpr_write_b32 a21, 0
  v_accvgpr_write_b32 a22, 0
  v_accvgpr_write_b32 a23, 0
  v_accvgpr_write_b32 a24, 0
  v_accvgpr_write_b32 a25, 0
  v_accvgpr_write_b32 a26, 0
  v_accvgpr_write_b32 a27, 0
  v_accvgpr_write_b32 a28, 0
  v_accvgpr_write_b32 a29, 0
  v_accvgpr_write_b32 a30, 0
  v_accvgpr_write_b32 a31, 0
  v_accvgpr_write_b32 a32, 0
  v_accvgpr_write_b32 a33, 0
  v_accvgpr_write_b32 a34, 0
  v_accvgpr_write_b32 a35, 0
  v_accvgpr_write_b32 a36, 0
  v_accvgpr_write_b32 a37, 0
  v_accvgpr_write_b32 a38, 0
  v_accvgpr_write_b32 a39, 0
  v_accvgpr_write_b32 a40, 0
  v_accvgpr_write_b32 a41, 0
  v_accvgpr_write_b32 a42, 0
  v_accvgpr_write_b32 a43, 0
  v_accvgpr_write_b32 a44, 0
  v_accvgpr_write_b32 a45, 0
  v_accvgpr_write_b32 a46, 0
  v_accvgpr_write_b32 a47, 0
  v_accvgpr_write_b32 a48, 0
  v_accvgpr_write_b32 a49, 0
  v_accvgpr_write_b32 a50, 0
  v_accvgpr_write_b32 a51, 0
  v_accvgpr_write_b32 a52, 0
  v_accvgpr_write_b32 a53, 0
  v_accvgpr_write_b32 a54, 0
  v_accvgpr_write_b32 a55, 0
  v_accvgpr_write_b32 a56, 0
  v_accvgpr_write_b32 a57, 0
  v_accvgpr_write_b32 a58, 0
  v_accvgpr_write_b32 a59, 0
  v_accvgpr_write_b32 a60, 0
  v_accvgpr_write_b32 a61, 0
  v_accvgpr_write_b32 a62, 0
  v_accvgpr_write_b32 a63, 0
  v_accvgpr_write_b32 a64, 0
  v_accvgpr_write_b32 a65, 0
  v_accvgpr_write_b32 a66, 0
  v_accvgpr_write_b32 a67, 0
  v_accvgpr_write_b32 a68, 0
  v_accvgpr_write_b32 a69, 0
  v_accvgpr_write_b32 a70, 0
  v_accvgpr_write_b32 a71, 0
  v_accvgpr_write_b32 a72, 0
  v_accvgpr_write_b32 a73, 0
  v_accvgpr_write_b32 a74, 0
  v_accvgpr_write_b32 a75, 0
  v_accvgpr_write_b32 a76, 0
  v_accvgpr_write_b32 a77, 0
  v_accvgpr_write_b32 a78, 0
  v_accvgpr_write_b32 a79, 0
  v_accvgpr_write_b32 a80, 0
  v_accvgpr_write_b32 a81, 0
  v_accvgpr_write_b32 a82, 0
  v_accvgpr_write_b32 a83, 0
  v_accvgpr_write_b32 a84, 0
  v_accvgpr_write_b32 a85, 0
  v_accvgpr_write_b32 a86, 0
  v_accvgpr_write_b32 a87, 0
  v_accvgpr_write_b32 a88, 0
  v_accvgpr_write_b32 a89, 0
  v_accvgpr_write_b32 a90, 0
  v_accvgpr_write_b32 a91, 0
  v_accvgpr_write_b32 a92, 0
  v_accvgpr_write_b32 a93, 0
  v_accvgpr_write_b32 a94, 0
  v_accvgpr_write_b32 a95, 0
  v_accvgpr_write_b32 a96, 0
  v_accvgpr_write_b32 a97, 0
  v_accvgpr_write_b32 a98, 0
  v_accvgpr_write_b32 a99, 0
  v_accvgpr_write_b32 a100, 0
  v_accvgpr_write_b32 a101, 0
  v_accvgpr_write_b32 a102, 0
  v_accvgpr_write_b32 a103, 0
  v_accvgpr_write_b32 a104, 0
  v_accvgpr_write_b32 a105, 0
  v_accvgpr_write_b32 a106, 0
  v_accvgpr_write_b32 a107, 0
  v_accvgpr_write_b32 a108, 0
  v_accvgpr_write_b32 a109, 0
  v_accvgpr_write_b32 a110, 0
  v_accvgpr_write_b32 a111, 0
  v_accvgpr_write_b32 a112, 0
  v_accvgpr_write_b32 a113, 0
  v_accvgpr_write_b32 a114, 0
  v_accvgpr_write_b32 a115, 0
  v_accvgpr_write_b32 a116, 0
  v_accvgpr_write_b32 a117, 0
  v_accvgpr_write_b32 a118, 0
  v_accvgpr_write_b32 a119, 0
  v_accvgpr_write_b32 a120, 0
  v_accvgpr_write_b32 a121, 0
  v_accvgpr_write_b32 a122, 0
  v_accvgpr_write_b32 a123, 0
  v_accvgpr_write_b32 a124, 0
  v_accvgpr_write_b32 a125, 0
  v_accvgpr_write_b32 a126, 0
  v_accvgpr_write_b32 a127, 0
  v_mov_b32 v208, 0
  v_mov_b32 v249, 0xff800000
  v_mov_b32 v209, 0
  v_mov_b32 v250, 0xff800000
  v_mov_b32 v210, 0
  v_mov_b32 v251, 0xff800000
  v_mov_b32 v211, 0
  v_mov_b32 v252, 0xff800000
  s_mov_b32 s29, 0
attn_slow:
  s_barrier
  s_add_u32 m0, s28, 49152
  s_nop 0
  buffer_load_dwordx4 v232, s[12:15], s29 offen offset:0 lds
  buffer_load_dwordx4 v233, s[12:15], s29 offen offset:1024 lds
  buffer_load_dwordx4 v234, s[12:15], s29 offen offset:2048 lds
  buffer_load_dwordx4 v235, s[12:15], s29 offen offset:3072 lds
  s_add_u32 m0, s28, 114688
  s_nop 0
  buffer_load_dwordx4 v236, s[16:19], s29 offen offset:0 lds
  buffer_load_dwordx4 v237, s[16:19], s29 offen offset:1024 lds
  buffer_load_dwordx4 v236, s[16:19], s29 offen offset:2048 lds
  buffer_load_dwordx4 v237, s[16:19], s29 offen offset:3072 lds
  s_waitcnt vmcnt(0)
  s_barrier
  ds_read_b128 a[128:131], v212 offset:49152
  ds_read_b128 a[132:135], v213 offset:49152
  ds_read_b128 a[136:139], v214 offset:49152
  ds_read_b128 a[140:143], v215 offset:49152
  s_waitcnt lgkmcnt(3)
  v_mfma_f32_16x16x32_bf16 v[0:3], a[128:131], v[128:131], 0
  s_waitcnt lgkmcnt(2)
  v_mfma_f32_16x16x32_bf16 v[0:3], a[132:135], v[132:135], v[0:3]
  s_waitcnt lgkmcnt(1)
  v_mfma_f32_16x16x32_bf16 v[0:3], a[136:139], v[136:139], v[0:3]
  s_waitcnt lgkmcnt(0)
  v_mfma_f32_16x16x32_bf16 v[0:3], a[140:143], v[140:143], v[0:3]
  v_mfma_f32_16x16x32_bf16 v[8:11], a[140:143], v[156:159], 0
  v_mfma_f32_16x16x32_bf16 v[8:11], a[136:139], v[152:155], v[8:11]
  v_mfma_f32_16x16x32_bf16 v[8:11], a[132:135], v[148:151], v[8:11]
  v_mfma_f32_16x16x32_bf16 v[8:11], a[128:131], v[144:147], v[8:11]
  v_mfma_f32_16x16x32_bf16 v[16:19], a[128:131], v[160:163], 0
  v_mfma_f32_16x16x32_bf16 v[16:19], a[132:135], v[164:167], v[16:19]
  v_mfma_f32_16x16x32_bf16 v[16:19], a[136:139], v[168:171], v[16:19]
  v_mfma_f32_16x16x32_bf16 v[16:19], a[140:143], v[172:175], v[16:19]
  v_mfma_f32_16x16x32_bf16 v[24:27], a[140:143], v[188:191], 0
  v_mfma_f32_16x16x32_bf16 v[24:27], a[136:139], v[184:187], v[24:27]
  v_mfma_f32_16x16x32_bf16 v[24:27], a[132:135], v[180:183], v[24:27]
  v_mfma_f32_16x16x32_bf16 v[24:27], a[128:131], v[176:179], v[24:27]
  ds_read_b128 a[144:147], v212 offset:53248
  ds_read_b128 a[148:151], v213 offset:53248
  ds_read_b128 a[152:155], v214 offset:53248
  ds_read_b128 a[156:159], v215 offset:53248
  s_waitcnt lgkmcnt(3)
  v_mfma_f32_16x16x32_bf16 v[4:7], a[144:147], v[128:131], 0
  s_waitcnt lgkmcnt(2)
  v_mfma_f32_16x16x32_bf16 v[4:7], a[148:151], v[132:135], v[4:7]
  s_waitcnt lgkmcnt(1)
  v_mfma_f32_16x16x32_bf16 v[4:7], a[152:155], v[136:139], v[4:7]
  s_waitcnt lgkmcnt(0)
  v_mfma_f32_16x16x32_bf16 v[4:7], a[156:159], v[140:143], v[4:7]
  v_mfma_f32_16x16x32_bf16 v[12:15], a[156:159], v[156:159], 0
  v_mfma_f32_16x16x32_bf16 v[12:15], a[152:155], v[152:155], v[12:15]
  v_mfma_f32_16x16x32_bf16 v[12:15], a[148:151], v[148:151], v[12:15]
  v_mfma_f32_16x16x32_bf16 v[12:15], a[144:147], v[144:147], v[12:15]
  v_mfma_f32_16x16x32_bf16 v[20:23], a[144:147], v[160:163], 0
  v_mfma_f32_16x16x32_bf16 v[20:23], a[148:151], v[164:167], v[20:23]
  v_mfma_f32_16x16x32_bf16 v[20:23], a[152:155], v[168:171], v[20:23]
  v_mfma_f32_16x16x32_bf16 v[20:23], a[156:159], v[172:175], v[20:23]
  v_mfma_f32_16x16x32_bf16 v[28:31], a[156:159], v[188:191], 0
  v_mfma_f32_16x16x32_bf16 v[28:31], a[152:155], v[184:187], v[28:31]
  v_mfma_f32_16x16x32_bf16 v[28:31], a[148:151], v[180:183], v[28:31]
  v_mfma_f32_16x16x32_bf16 v[28:31], a[144:147], v[176:179], v[28:31]
  ds_read_b128 a[128:131], v212 offset:57344
  ds_read_b128 a[132:135], v213 offset:57344
  ds_read_b128 a[136:139], v214 offset:57344
  ds_read_b128 a[140:143], v215 offset:57344
  s_waitcnt lgkmcnt(3)
  v_mfma_f32_16x16x32_bf16 v[32:35], a[128:131], v[128:131], 0
  s_waitcnt lgkmcnt(2)
  v_mfma_f32_16x16x32_bf16 v[32:35], a[132:135], v[132:135], v[32:35]
  s_waitcnt lgkmcnt(1)
  v_mfma_f32_16x16x32_bf16 v[32:35], a[136:139], v[136:139], v[32:35]
  s_waitcnt lgkmcnt(0)
  v_mfma_f32_16x16x32_bf16 v[32:35], a[140:143], v[140:143], v[32:35]
  v_mfma_f32_16x16x32_bf16 v[40:43], a[140:143], v[156:159], 0
  v_mfma_f32_16x16x32_bf16 v[40:43], a[136:139], v[152:155], v[40:43]
  v_mfma_f32_16x16x32_bf16 v[40:43], a[132:135], v[148:151], v[40:43]
  v_mfma_f32_16x16x32_bf16 v[40:43], a[128:131], v[144:147], v[40:43]
  v_mfma_f32_16x16x32_bf16 v[48:51], a[128:131], v[160:163], 0
  v_mfma_f32_16x16x32_bf16 v[48:51], a[132:135], v[164:167], v[48:51]
  v_mfma_f32_16x16x32_bf16 v[48:51], a[136:139], v[168:171], v[48:51]
  v_mfma_f32_16x16x32_bf16 v[48:51], a[140:143], v[172:175], v[48:51]
  v_mfma_f32_16x16x32_bf16 v[56:59], a[140:143], v[188:191], 0
  v_mfma_f32_16x16x32_bf16 v[56:59], a[136:139], v[184:187], v[56:59]
  v_mfma_f32_16x16x32_bf16 v[56:59], a[132:135], v[180:183], v[56:59]
  v_mfma_f32_16x16x32_bf16 v[56:59], a[128:131], v[176:179], v[56:59]
  ds_read_b128 a[144:147], v212 offset:61440
  ds_read_b128 a[148:151], v213 offset:61440
  ds_read_b128 a[152:155], v214 offset:61440
  ds_read_b128 a[156:159], v215 offset:61440
  s_waitcnt lgkmcnt(3)
  v_mfma_f32_16x16x32_bf16 v[36:39], a[144:147], v[128:131], 0
  s_waitcnt lgkmcnt(2)
  v_mfma_f32_16x16x32_bf16 v[36:39], a[148:151], v[132:135], v[36:39]
  s_waitcnt lgkmcnt(1)
  v_mfma_f32_16x16x32_bf16 v[36:39], a[152:155], v[136:139], v[36:39]
  s_waitcnt lgkmcnt(0)
  v_mfma_f32_16x16x32_bf16 v[36:39], a[156:159], v[140:143], v[36:39]
  v_mfma_f32_16x16x32_bf16 v[44:47], a[156:159], v[156:159], 0
  v_mfma_f32_16x16x32_bf16 v[44:47], a[152:155], v[152:155], v[44:47]
  v_mfma_f32_16x16x32_bf16 v[44:47], a[148:151], v[148:151], v[44:47]
  v_mfma_f32_16x16x32_bf16 v[44:47], a[144:147], v[144:147], v[44:47]
  v_mfma_f32_16x16x32_bf16 v[52:55], a[144:147], v[160:163], 0
  v_mfma_f32_16x16x32_bf16 v[52:55], a[148:151], v[164:167], v[52:55]
  v_mfma_f32_16x16x32_bf16 v[52:55], a[152:155], v[168:171], v[52:55]
  v_mfma_f32_16x16x32_bf16 v[52:55], a[156:159], v[172:175], v[52:55]
  v_mfma_f32_16x16x32_bf16 v[60:63], a[156:159], v[188:191], 0
  v_mfma_f32_16x16x32_bf16 v[60:63], a[152:155], v[184:187], v[60:63]
  v_mfma_f32_16x16x32_bf16 v[60:63], a[148:151], v[180:183], v[60:63]
  v_mfma_f32_16x16x32_bf16 v[60:63], a[144:147], v[176:179], v[60:63]
  v_mov_b32 v192, v249
  v_max3_f32 v192, v192, v0, v1
  v_max3_f32 v192, v192, v2, v3
  v_max3_f32 v192, v192, v4, v5
  v_max3_f32 v192, v192, v6, v7
  v_max3_f32 v192, v192, v32, v33
  v_max3_f32 v192, v192, v34, v35
  v_max3_f32 v192, v192, v36, v37
  v_max3_f32 v192, v192, v38, v39
  v_mov_b32 v245, v192
  s_nop 1
  v_permlane16_swap_b32 v192, v245
  v_max_f32 v192, v192, v245
  v_mov_b32 v245, v192
  s_nop 1
  v_permlane32_swap_b32 v192, v245
  v_max_f32 v192, v192, v245
  v_sub_f32 v193, v249, v192
  v_exp_f32 v193, v193
  v_mov_b32 v249, v192
  v_mul_f32 v208, v208, v193
  v_sub_f32 v0, v0, v192
  v_sub_f32 v1, v1, v192
  v_sub_f32 v2, v2, v192
  v_sub_f32 v3, v3, v192
  v_sub_f32 v4, v4, v192
  v_sub_f32 v5, v5, v192
  v_sub_f32 v6, v6, v192
  v_sub_f32 v7, v7, v192
  v_sub_f32 v32, v32, v192
  v_sub_f32 v33, v33, v192
  v_sub_f32 v34, v34, v192
  v_sub_f32 v35, v35, v192
  v_sub_f32 v36, v36, v192
  v_sub_f32 v37, v37, v192
  v_sub_f32 v38, v38, v192
  v_sub_f32 v39, v39, v192
  v_exp_f32 v0, v0
  v_exp_f32 v1, v1
  v_add_f32 v208, v208, v0
  v_exp_f32 v2, v2
  v_add_f32 v208, v208, v1
  v_cvt_pk_bf16_f32 v0, v0, v1
  v_exp_f32 v3, v3
  v_add_f32 v208, v208, v2
  v_add_f32 v208, v208, v3
  v_cvt_pk_bf16_f32 v1, v2, v3
  v_exp_f32 v4, v4
  v_exp_f32 v5, v5
  v_add_f32 v208, v208, v4
  v_exp_f32 v6, v6
  v_add_f32 v208, v208, v5
  v_cvt_pk_bf16_f32 v2, v4, v5
  v_exp_f32 v7, v7
  v_add_f32 v208, v208, v6
  v_add_f32 v208, v208, v7
  v_cvt_pk_bf16_f32 v3, v6, v7
  v_exp_f32 v32, v32
  v_exp_f32 v33, v33
  v_add_f32 v208, v208, v32
  v_exp_f32 v34, v34
  v_add_f32 v208, v208, v33
  v_cvt_pk_bf16_f32 v32, v32, v33
  v_exp_f32 v35, v35
  v_add_f32 v208, v208, v34
  v_add_f32 v208, v208, v35
  v_cvt_pk_bf16_f32 v33, v34, v35
  v_exp_f32 v36, v36
  v_exp_f32 v37, v37
  v_add_f32 v208, v208, v36
  v_exp_f32 v38, v38
  v_add_f32 v208, v208, v37
  v_cvt_pk_bf16_f32 v34, v36, v37
  v_exp_f32 v39, v39
  v_add_f32 v208, v208, v38
  v_add_f32 v208, v208, v39
  v_cvt_pk_bf16_f32 v35, v38, v39
  v_accvgpr_read_b32 v64, a0
  v_accvgpr_read_b32 v65, a1
  v_accvgpr_read_b32 v66, a2
  v_accvgpr_read_b32 v67, a3
  v_mul_f32 v64, v64, v193
  v_mul_f32 v65, v65, v193
  v_mul_f32 v66, v66, v193
  v_mul_f32 v67, v67, v193
  v_accvgpr_write_b32 a0, v64
  v_accvgpr_write_b32 a1, v65
  v_accvgpr_write_b32 a2, v66
  v_accvgpr_write_b32 a3, v67
  v_accvgpr_read_b32 v64, a16
  v_accvgpr_read_b32 v65, a17
  v_accvgpr_read_b32 v66, a18
  v_accvgpr_read_b32 v67, a19
  v_mul_f32 v64, v64, v193
  v_mul_f32 v65, v65, v193
  v_mul_f32 v66, v66, v193
  v_mul_f32 v67, v67, v193
  v_accvgpr_write_b32 a16, v64
  v_accvgpr_write_b32 a17, v65
  v_accvgpr_write_b32 a18, v66
  v_accvgpr_write_b32 a19, v67
  v_accvgpr_read_b32 v64, a32
  v_accvgpr_read_b32 v65, a33
  v_accvgpr_read_b32 v66, a34
  v_accvgpr_read_b32 v67, a35
  v_mul_f32 v64, v64, v193
  v_mul_f32 v65, v65, v193
  v_mul_f32 v66, v66, v193
  v_mul_f32 v67, v67, v193
  v_accvgpr_write_b32 a32, v64
  v_accvgpr_write_b32 a33, v65
  v_accvgpr_write_b32 a34, v66
  v_accvgpr_write_b32 a35, v67
  v_accvgpr_read_b32 v64, a48
  v_accvgpr_read_b32 v65, a49
  v_accvgpr_read_b32 v66, a50
  v_accvgpr_read_b32 v67, a51
  v_mul_f32 v64, v64, v193
  v_mul_f32 v65, v65, v193
  v_mul_f32 v66, v66, v193
  v_mul_f32 v67, v67, v193
  v_accvgpr_write_b32 a48, v64
  v_accvgpr_write_b32 a49, v65
  v_accvgpr_write_b32 a50, v66
  v_accvgpr_write_b32 a51, v67
  v_accvgpr_read_b32 v64, a64
  v_accvgpr_read_b32 v65, a65
  v_accvgpr_read_b32 v66, a66
  v_accvgpr_read_b32 v67, a67
  v_mul_f32 v64, v64, v193
  v_mul_f32 v65, v65, v193
  v_mul_f32 v66, v66, v193
  v_mul_f32 v67, v67, v193
  v_accvgpr_write_b32 a64, v64
  v_accvgpr_write_b32 a65, v65
  v_accvgpr_write_b32 a66, v66
  v_accvgpr_write_b32 a67, v67
  v_accvgpr_read_b32 v64, a80
  v_accvgpr_read_b32 v65, a81
  v_accvgpr_read_b32 v66, a82
  v_accvgpr_read_b32 v67, a83
  v_mul_f32 v64, v64, v193
  v_mul_f32 v65, v65, v193
  v_mul_f32 v66, v66, v193
  v_mul_f32 v67, v67, v193
  v_accvgpr_write_b32 a80, v64
  v_accvgpr_write_b32 a81, v65
  v_accvgpr_write_b32 a82, v66
  v_accvgpr_write_b32 a83, v67
  v_accvgpr_read_b32 v64, a96
  v_accvgpr_read_b32 v65, a97
  v_accvgpr_read_b32 v66, a98
  v_accvgpr_read_b32 v67, a99
  v_mul_f32 v64, v64, v193
  v_mul_f32 v65, v65, v193
  v_mul_f32 v66, v66, v193
  v_mul_f32 v67, v67, v193
  v_accvgpr_write_b32 a96, v64
  v_accvgpr_write_b32 a97, v65
  v_accvgpr_write_b32 a98, v66
  v_accvgpr_write_b32 a99, v67
  v_accvgpr_read_b32 v64, a112
  v_accvgpr_read_b32 v65, a113
  v_accvgpr_read_b32 v66, a114
  v_accvgpr_read_b32 v67, a115
  v_mul_f32 v64, v64, v193
  v_mul_f32 v65, v65, v193
  v_mul_f32 v66, v66, v193
  v_mul_f32 v67, v67, v193
  v_accvgpr_write_b32 a112, v64
  v_accvgpr_write_b32 a113, v65
  v_accvgpr_write_b32 a114, v66
  v_accvgpr_write_b32 a115, v67
  v_mov_b32 v196, v250
  v_max3_f32 v196, v196, v8, v9
  v_max3_f32 v196, v196, v10, v11
  v_max3_f32 v196, v196, v12, v13
  v_max3_f32 v196, v196, v14, v15
  v_max3_f32 v196, v196, v40, v41
  v_max3_f32 v196, v196, v42, v43
  v_max3_f32 v196, v196, v44, v45
  v_max3_f32 v196, v196, v46, v47
  v_mov_b32 v245, v196
  s_nop 1
  v_permlane16_swap_b32 v196, v245
  v_max_f32 v196, v196, v245
  v_mov_b32 v245, v196
  s_nop 1
  v_permlane32_swap_b32 v196, v245
  v_max_f32 v196, v196, v245
  v_sub_f32 v197, v250, v196
  v_exp_f32 v197, v197
  v_mov_b32 v250, v196
  v_mul_f32 v209, v209, v197
  v_sub_f32 v8, v8, v196
  v_sub_f32 v9, v9, v196
  v_sub_f32 v10, v10, v196
  v_sub_f32 v11, v11, v196
  v_sub_f32 v12, v12, v196
  v_sub_f32 v13, v13, v196
  v_sub_f32 v14, v14, v196
  v_sub_f32 v15, v15, v196
  v_sub_f32 v40, v40, v196
  v_sub_f32 v41, v41, v196
  v_sub_f32 v42, v42, v196
  v_sub_f32 v43, v43, v196
  v_sub_f32 v44, v44, v196
  v_sub_f32 v45, v45, v196
  v_sub_f32 v46, v46, v196
  v_sub_f32 v47, v47, v196
  v_exp_f32 v8, v8
  v_exp_f32 v9, v9
  v_add_f32 v209, v209, v8
  v_exp_f32 v10, v10
  v_add_f32 v209, v209, v9
  v_cvt_pk_bf16_f32 v8, v8, v9
  v_exp_f32 v11, v11
  v_add_f32 v209, v209, v10
  v_add_f32 v209, v209, v11
  v_cvt_pk_bf16_f32 v9, v10, v11
  v_exp_f32 v12, v12
  v_exp_f32 v13, v13
  v_add_f32 v209, v209, v12
  v_exp_f32 v14, v14
  v_add_f32 v209, v209, v13
  v_cvt_pk_bf16_f32 v10, v12, v13
  v_exp_f32 v15, v15
  v_add_f32 v209, v209, v14
  v_add_f32 v209, v209, v15
  v_cvt_pk_bf16_f32 v11, v14, v15
  v_exp_f32 v40, v40
  v_exp_f32 v41, v41
  v_add_f32 v209, v209, v40
  v_exp_f32 v42, v42
  v_add_f32 v209, v209, v41
  v_cvt_pk_bf16_f32 v40, v40, v41
  v_exp_f32 v43, v43
  v_add_f32 v209, v209, v42
  v_add_f32 v209, v209, v43
  v_cvt_pk_bf16_f32 v41, v42, v43
  v_exp_f32 v44, v44
  v_exp_f32 v45, v45
  v_add_f32 v209, v209, v44
  v_exp_f32 v46, v46
  v_add_f32 v209, v209, v45
  v_cvt_pk_bf16_f32 v42, v44, v45
  v_exp_f32 v47, v47
  v_add_f32 v209, v209, v46
  v_add_f32 v209, v209, v47
  v_cvt_pk_bf16_f32 v43, v46, v47
  v_accvgpr_read_b32 v64, a4
  v_accvgpr_read_b32 v65, a5
  v_accvgpr_read_b32 v66, a6
  v_accvgpr_read_b32 v67, a7
  v_mul_f32 v64, v64, v197
  v_mul_f32 v65, v65, v197
  v_mul_f32 v66, v66, v197
  v_mul_f32 v67, v67, v197
  v_accvgpr_write_b32 a4, v64
  v_accvgpr_write_b32 a5, v65
  v_accvgpr_write_b32 a6, v66
  v_accvgpr_write_b32 a7, v67
  v_accvgpr_read_b32 v64, a20
  v_accvgpr_read_b32 v65, a21
  v_accvgpr_read_b32 v66, a22
  v_accvgpr_read_b32 v67, a23
  v_mul_f32 v64, v64, v197
  v_mul_f32 v65, v65, v197
  v_mul_f32 v66, v66, v197
  v_mul_f32 v67, v67, v197
  v_accvgpr_write_b32 a20, v64
  v_accvgpr_write_b32 a21, v65
  v_accvgpr_write_b32 a22, v66
  v_accvgpr_write_b32 a23, v67
  v_accvgpr_read_b32 v64, a36
  v_accvgpr_read_b32 v65, a37
  v_accvgpr_read_b32 v66, a38
  v_accvgpr_read_b32 v67, a39
  v_mul_f32 v64, v64, v197
  v_mul_f32 v65, v65, v197
  v_mul_f32 v66, v66, v197
  v_mul_f32 v67, v67, v197
  v_accvgpr_write_b32 a36, v64
  v_accvgpr_write_b32 a37, v65
  v_accvgpr_write_b32 a38, v66
  v_accvgpr_write_b32 a39, v67
  v_accvgpr_read_b32 v64, a52
  v_accvgpr_read_b32 v65, a53
  v_accvgpr_read_b32 v66, a54
  v_accvgpr_read_b32 v67, a55
  v_mul_f32 v64, v64, v197
  v_mul_f32 v65, v65, v197
  v_mul_f32 v66, v66, v197
  v_mul_f32 v67, v67, v197
  v_accvgpr_write_b32 a52, v64
  v_accvgpr_write_b32 a53, v65
  v_accvgpr_write_b32 a54, v66
  v_accvgpr_write_b32 a55, v67
  v_accvgpr_read_b32 v64, a68
  v_accvgpr_read_b32 v65, a69
  v_accvgpr_read_b32 v66, a70
  v_accvgpr_read_b32 v67, a71
  v_mul_f32 v64, v64, v197
  v_mul_f32 v65, v65, v197
  v_mul_f32 v66, v66, v197
  v_mul_f32 v67, v67, v197
  v_accvgpr_write_b32 a68, v64
  v_accvgpr_write_b32 a69, v65
  v_accvgpr_write_b32 a70, v66
  v_accvgpr_write_b32 a71, v67
  v_accvgpr_read_b32 v64, a84
  v_accvgpr_read_b32 v65, a85
  v_accvgpr_read_b32 v66, a86
  v_accvgpr_read_b32 v67, a87
  v_mul_f32 v64, v64, v197
  v_mul_f32 v65, v65, v197
  v_mul_f32 v66, v66, v197
  v_mul_f32 v67, v67, v197
  v_accvgpr_write_b32 a84, v64
  v_accvgpr_write_b32 a85, v65
  v_accvgpr_write_b32 a86, v66
  v_accvgpr_write_b32 a87, v67
  v_accvgpr_read_b32 v64, a100
  v_accvgpr_read_b32 v65, a101
  v_accvgpr_read_b32 v66, a102
  v_accvgpr_read_b32 v67, a103
  v_mul_f32 v64, v64, v197
  v_mul_f32 v65, v65, v197
  v_mul_f32 v66, v66, v197
  v_mul_f32 v67, v67, v197
  v_accvgpr_write_b32 a100, v64
  v_accvgpr_write_b32 a101, v65
  v_accvgpr_write_b32 a102, v66
  v_accvgpr_write_b32 a103, v67
  v_accvgpr_read_b32 v64, a116
  v_accvgpr_read_b32 v65, a117
  v_accvgpr_read_b32 v66, a118
  v_accvgpr_read_b32 v67, a119
  v_mul_f32 v64, v64, v197
  v_mul_f32 v65, v65, v197
  v_mul_f32 v66, v66, v197
  v_mul_f32 v67, v67, v197
  v_accvgpr_write_b32 a116, v64
  v_accvgpr_write_b32 a117, v65
  v_accvgpr_write_b32 a118, v66
  v_accvgpr_write_b32 a119, v67
  v_mov_b32 v200, v251
  v_max3_f32 v200, v200, v16, v17
  v_max3_f32 v200, v200, v18, v19
  v_max3_f32 v200, v200, v20, v21
  v_max3_f32 v200, v200, v22, v23
  v_max3_f32 v200, v200, v48, v49
  v_max3_f32 v200, v200, v50, v51
  v_max3_f32 v200, v200, v52, v53
  v_max3_f32 v200, v200, v54, v55
  v_mov_b32 v245, v200
  s_nop 1
  v_permlane16_swap_b32 v200, v245
  v_max_f32 v200, v200, v245
  v_mov_b32 v245, v200
  s_nop 1
  v_permlane32_swap_b32 v200, v245
  v_max_f32 v200, v200, v245
  v_sub_f32 v201, v251, v200
  v_exp_f32 v201, v201
  v_mov_b32 v251, v200
  v_mul_f32 v210, v210, v201
  v_sub_f32 v16, v16, v200
  v_sub_f32 v17, v17, v200
  v_sub_f32 v18, v18, v200
  v_sub_f32 v19, v19, v200
  v_sub_f32 v20, v20, v200
  v_sub_f32 v21, v21, v200
  v_sub_f32 v22, v22, v200
  v_sub_f32 v23, v23, v200
  v_sub_f32 v48, v48, v200
  v_sub_f32 v49, v49, v200
  v_sub_f32 v50, v50, v200
  v_sub_f32 v51, v51, v200
  v_sub_f32 v52, v52, v200
  v_sub_f32 v53, v53, v200
  v_sub_f32 v54, v54, v200
  v_sub_f32 v55, v55, v200
  v_exp_f32 v16, v16
  v_exp_f32 v17, v17
  v_add_f32 v210, v210, v16
  v_exp_f32 v18, v18
  v_add_f32 v210, v210, v17
  v_cvt_pk_bf16_f32 v16, v16, v17
  v_exp_f32 v19, v19
  v_add_f32 v210, v210, v18
  v_add_f32 v210, v210, v19
  v_cvt_pk_bf16_f32 v17, v18, v19
  v_exp_f32 v20, v20
  v_exp_f32 v21, v21
  v_add_f32 v210, v210, v20
  v_exp_f32 v22, v22
  v_add_f32 v210, v210, v21
  v_cvt_pk_bf16_f32 v18, v20, v21
  v_exp_f32 v23, v23
  v_add_f32 v210, v210, v22
  v_add_f32 v210, v210, v23
  v_cvt_pk_bf16_f32 v19, v22, v23
  v_exp_f32 v48, v48
  v_exp_f32 v49, v49
  v_add_f32 v210, v210, v48
  v_exp_f32 v50, v50
  v_add_f32 v210, v210, v49
  v_cvt_pk_bf16_f32 v48, v48, v49
  v_exp_f32 v51, v51
  v_add_f32 v210, v210, v50
  v_add_f32 v210, v210, v51
  v_cvt_pk_bf16_f32 v49, v50, v51
  v_exp_f32 v52, v52
  v_exp_f32 v53, v53
  v_add_f32 v210, v210, v52
  v_exp_f32 v54, v54
  v_add_f32 v210, v210, v53
  v_cvt_pk_bf16_f32 v50, v52, v53
  v_exp_f32 v55, v55
  v_add_f32 v210, v210, v54
  v_add_f32 v210, v210, v55
  v_cvt_pk_bf16_f32 v51, v54, v55
  v_accvgpr_read_b32 v64, a8
  v_accvgpr_read_b32 v65, a9
  v_accvgpr_read_b32 v66, a10
  v_accvgpr_read_b32 v67, a11
  v_mul_f32 v64, v64, v201
  v_mul_f32 v65, v65, v201
  v_mul_f32 v66, v66, v201
  v_mul_f32 v67, v67, v201
  v_accvgpr_write_b32 a8, v64
  v_accvgpr_write_b32 a9, v65
  v_accvgpr_write_b32 a10, v66
  v_accvgpr_write_b32 a11, v67
  v_accvgpr_read_b32 v64, a24
  v_accvgpr_read_b32 v65, a25
  v_accvgpr_read_b32 v66, a26
  v_accvgpr_read_b32 v67, a27
  v_mul_f32 v64, v64, v201
  v_mul_f32 v65, v65, v201
  v_mul_f32 v66, v66, v201
  v_mul_f32 v67, v67, v201
  v_accvgpr_write_b32 a24, v64
  v_accvgpr_write_b32 a25, v65
  v_accvgpr_write_b32 a26, v66
  v_accvgpr_write_b32 a27, v67
  v_accvgpr_read_b32 v64, a40
  v_accvgpr_read_b32 v65, a41
  v_accvgpr_read_b32 v66, a42
  v_accvgpr_read_b32 v67, a43
  v_mul_f32 v64, v64, v201
  v_mul_f32 v65, v65, v201
  v_mul_f32 v66, v66, v201
  v_mul_f32 v67, v67, v201
  v_accvgpr_write_b32 a40, v64
  v_accvgpr_write_b32 a41, v65
  v_accvgpr_write_b32 a42, v66
  v_accvgpr_write_b32 a43, v67
  v_accvgpr_read_b32 v64, a56
  v_accvgpr_read_b32 v65, a57
  v_accvgpr_read_b32 v66, a58
  v_accvgpr_read_b32 v67, a59
  v_mul_f32 v64, v64, v201
  v_mul_f32 v65, v65, v201
  v_mul_f32 v66, v66, v201
  v_mul_f32 v67, v67, v201
  v_accvgpr_write_b32 a56, v64
  v_accvgpr_write_b32 a57, v65
  v_accvgpr_write_b32 a58, v66
  v_accvgpr_write_b32 a59, v67
  v_accvgpr_read_b32 v64, a72
  v_accvgpr_read_b32 v65, a73
  v_accvgpr_read_b32 v66, a74
  v_accvgpr_read_b32 v67, a75
  v_mul_f32 v64, v64, v201
  v_mul_f32 v65, v65, v201
  v_mul_f32 v66, v66, v201
  v_mul_f32 v67, v67, v201
  v_accvgpr_write_b32 a72, v64
  v_accvgpr_write_b32 a73, v65
  v_accvgpr_write_b32 a74, v66
  v_accvgpr_write_b32 a75, v67
  v_accvgpr_read_b32 v64, a88
  v_accvgpr_read_b32 v65, a89
  v_accvgpr_read_b32 v66, a90
  v_accvgpr_read_b32 v67, a91
  v_mul_f32 v64, v64, v201
  v_mul_f32 v65, v65, v201
  v_mul_f32 v66, v66, v201
  v_mul_f32 v67, v67, v201
  v_accvgpr_write_b32 a88, v64
  v_accvgpr_write_b32 a89, v65
  v_accvgpr_write_b32 a90, v66
  v_accvgpr_write_b32 a91, v67
  v_accvgpr_read_b32 v64, a104
  v_accvgpr_read_b32 v65, a105
  v_accvgpr_read_b32 v66, a106
  v_accvgpr_read_b32 v67, a107
  v_mul_f32 v64, v64, v201
  v_mul_f32 v65, v65, v201
  v_mul_f32 v66, v66, v201
  v_mul_f32 v67, v67, v201
  v_accvgpr_write_b32 a104, v64
  v_accvgpr_write_b32 a105, v65
  v_accvgpr_write_b32 a106, v66
  v_accvgpr_write_b32 a107, v67
  v_accvgpr_read_b32 v64, a120
  v_accvgpr_read_b32 v65, a121
  v_accvgpr_read_b32 v66, a122
  v_accvgpr_read_b32 v67, a123
  v_mul_f32 v64, v64, v201
  v_mul_f32 v65, v65, v201
  v_mul_f32 v66, v66, v201
  v_mul_f32 v67, v67, v201
  v_accvgpr_write_b32 a120, v64
  v_accvgpr_write_b32 a121, v65
  v_accvgpr_write_b32 a122, v66
  v_accvgpr_write_b32 a123, v67
  v_mov_b32 v204, v252
  v_max3_f32 v204, v204, v24, v25
  v_max3_f32 v204, v204, v26, v27
  v_max3_f32 v204, v204, v28, v29
  v_max3_f32 v204, v204, v30, v31
  v_max3_f32 v204, v204, v56, v57
  v_max3_f32 v204, v204, v58, v59
  v_max3_f32 v204, v204, v60, v61
  v_max3_f32 v204, v204, v62, v63
  v_mov_b32 v245, v204
  s_nop 1
  v_permlane16_swap_b32 v204, v245
  v_max_f32 v204, v204, v245
  v_mov_b32 v245, v204
  s_nop 1
  v_permlane32_swap_b32 v204, v245
  v_max_f32 v204, v204, v245
  v_sub_f32 v205, v252, v204
  v_exp_f32 v205, v205
  v_mov_b32 v252, v204
  v_mul_f32 v211, v211, v205
  v_sub_f32 v24, v24, v204
  v_sub_f32 v25, v25, v204
  v_sub_f32 v26, v26, v204
  v_sub_f32 v27, v27, v204
  v_sub_f32 v28, v28, v204
  v_sub_f32 v29, v29, v204
  v_sub_f32 v30, v30, v204
  v_sub_f32 v31, v31, v204
  v_sub_f32 v56, v56, v204
  v_sub_f32 v57, v57, v204
  v_sub_f32 v58, v58, v204
  v_sub_f32 v59, v59, v204
  v_sub_f32 v60, v60, v204
  v_sub_f32 v61, v61, v204
  v_sub_f32 v62, v62, v204
  v_sub_f32 v63, v63, v204
  v_exp_f32 v24, v24
  v_exp_f32 v25, v25
  v_add_f32 v211, v211, v24
  v_exp_f32 v26, v26
  v_add_f32 v211, v211, v25
  v_cvt_pk_bf16_f32 v24, v24, v25
  v_exp_f32 v27, v27
  v_add_f32 v211, v211, v26
  v_add_f32 v211, v211, v27
  v_cvt_pk_bf16_f32 v25, v26, v27
  v_exp_f32 v28, v28
  v_exp_f32 v29, v29
  v_add_f32 v211, v211, v28
  v_exp_f32 v30, v30
  v_add_f32 v211, v211, v29
  v_cvt_pk_bf16_f32 v26, v28, v29
  v_exp_f32 v31, v31
  v_add_f32 v211, v211, v30
  v_add_f32 v211, v211, v31
  v_cvt_pk_bf16_f32 v27, v30, v31
  v_exp_f32 v56, v56
  v_exp_f32 v57, v57
  v_add_f32 v211, v211, v56
  v_exp_f32 v58, v58
  v_add_f32 v211, v211, v57
  v_cvt_pk_bf16_f32 v56, v56, v57
  v_exp_f32 v59, v59
  v_add_f32 v211, v211, v58
  v_add_f32 v211, v211, v59
  v_cvt_pk_bf16_f32 v57, v58, v59
  v_exp_f32 v60, v60
  v_exp_f32 v61, v61
  v_add_f32 v211, v211, v60
  v_exp_f32 v62, v62
  v_add_f32 v211, v211, v61
  v_cvt_pk_bf16_f32 v58, v60, v61
  v_exp_f32 v63, v63
  v_add_f32 v211, v211, v62
  v_add_f32 v211, v211, v63
  v_cvt_pk_bf16_f32 v59, v62, v63
  v_accvgpr_read_b32 v64, a12
  v_accvgpr_read_b32 v65, a13
  v_accvgpr_read_b32 v66, a14
  v_accvgpr_read_b32 v67, a15
  v_mul_f32 v64, v64, v205
  v_mul_f32 v65, v65, v205
  v_mul_f32 v66, v66, v205
  v_mul_f32 v67, v67, v205
  v_accvgpr_write_b32 a12, v64
  v_accvgpr_write_b32 a13, v65
  v_accvgpr_write_b32 a14, v66
  v_accvgpr_write_b32 a15, v67
  v_accvgpr_read_b32 v64, a28
  v_accvgpr_read_b32 v65, a29
  v_accvgpr_read_b32 v66, a30
  v_accvgpr_read_b32 v67, a31
  v_mul_f32 v64, v64, v205
  v_mul_f32 v65, v65, v205
  v_mul_f32 v66, v66, v205
  v_mul_f32 v67, v67, v205
  v_accvgpr_write_b32 a28, v64
  v_accvgpr_write_b32 a29, v65
  v_accvgpr_write_b32 a30, v66
  v_accvgpr_write_b32 a31, v67
  v_accvgpr_read_b32 v64, a44
  v_accvgpr_read_b32 v65, a45
  v_accvgpr_read_b32 v66, a46
  v_accvgpr_read_b32 v67, a47
  v_mul_f32 v64, v64, v205
  v_mul_f32 v65, v65, v205
  v_mul_f32 v66, v66, v205
  v_mul_f32 v67, v67, v205
  v_accvgpr_write_b32 a44, v64
  v_accvgpr_write_b32 a45, v65
  v_accvgpr_write_b32 a46, v66
  v_accvgpr_write_b32 a47, v67
  v_accvgpr_read_b32 v64, a60
  v_accvgpr_read_b32 v65, a61
  v_accvgpr_read_b32 v66, a62
  v_accvgpr_read_b32 v67, a63
  v_mul_f32 v64, v64, v205
  v_mul_f32 v65, v65, v205
  v_mul_f32 v66, v66, v205
  v_mul_f32 v67, v67, v205
  v_accvgpr_write_b32 a60, v64
  v_accvgpr_write_b32 a61, v65
  v_accvgpr_write_b32 a62, v66
  v_accvgpr_write_b32 a63, v67
  v_accvgpr_read_b32 v64, a76
  v_accvgpr_read_b32 v65, a77
  v_accvgpr_read_b32 v66, a78
  v_accvgpr_read_b32 v67, a79
  v_mul_f32 v64, v64, v205
  v_mul_f32 v65, v65, v205
  v_mul_f32 v66, v66, v205
  v_mul_f32 v67, v67, v205
  v_accvgpr_write_b32 a76, v64
  v_accvgpr_write_b32 a77, v65
  v_accvgpr_write_b32 a78, v66
  v_accvgpr_write_b32 a79, v67
  v_accvgpr_read_b32 v64, a92
  v_accvgpr_read_b32 v65, a93
  v_accvgpr_read_b32 v66, a94
  v_accvgpr_read_b32 v67, a95
  v_mul_f32 v64, v64, v205
  v_mul_f32 v65, v65, v205
  v_mul_f32 v66, v66, v205
  v_mul_f32 v67, v67, v205
  v_accvgpr_write_b32 a92, v64
  v_accvgpr_write_b32 a93, v65
  v_accvgpr_write_b32 a94, v66
  v_accvgpr_write_b32 a95, v67
  v_accvgpr_read_b32 v64, a108
  v_accvgpr_read_b32 v65, a109
  v_accvgpr_read_b32 v66, a110
  v_accvgpr_read_b32 v67, a111
  v_mul_f32 v64, v64, v205
  v_mul_f32 v65, v65, v205
  v_mul_f32 v66, v66, v205
  v_mul_f32 v67, v67, v205
  v_accvgpr_write_b32 a108, v64
  v_accvgpr_write_b32 a109, v65
  v_accvgpr_write_b32 a110, v66
  v_accvgpr_write_b32 a111, v67
  v_accvgpr_read_b32 v64, a124
  v_accvgpr_read_b32 v65, a125
  v_accvgpr_read_b32 v66, a126
  v_accvgpr_read_b32 v67, a127
  v_mul_f32 v64, v64, v205
  v_mul_f32 v65, v65, v205
  v_mul_f32 v66, v66, v205
  v_mul_f32 v67, v67, v205
  v_accvgpr_write_b32 a124, v64
  v_accvgpr_write_b32 a125, v65
  v_accvgpr_write_b32 a126, v66
  v_accvgpr_write_b32 a127, v67
  ds_read_b64_tr_b16 a[160:161], v216 offset:49152
  ds_read_b64_tr_b16 a[162:163], v216 offset:53248
  ds_read_b64_tr_b16 a[164:165], v216 offset:57344
  ds_read_b64_tr_b16 a[166:167], v216 offset:61440
  s_waitcnt lgkmcnt(2)
  v_mfma_f32_16x16x32_bf16 a[0:3], a[160:163], v[0:3], a[0:3]
  s_waitcnt lgkmcnt(0)
  v_mfma_f32_16x16x32_bf16 a[0:3], a[164:167], v[32:35], a[0:3]
  v_mfma_f32_16x16x32_bf16 a[4:7], a[164:167], v[40:43], a[4:7]
  v_mfma_f32_16x16x32_bf16 a[4:7], a[160:163], v[8:11], a[4:7]
  v_mfma_f32_16x16x32_bf16 a[8:11], a[160:163], v[16:19], a[8:11]
  v_mfma_f32_16x16x32_bf16 a[8:11], a[164:167], v[48:51], a[8:11]
  v_mfma_f32_16x16x32_bf16 a[12:15], a[164:167], v[56:59], a[12:15]
  v_mfma_f32_16x16x32_bf16 a[12:15], a[160:163], v[24:27], a[12:15]
  ds_read_b64_tr_b16 a[168:169], v217 offset:49152
  ds_read_b64_tr_b16 a[170:171], v217 offset:53248
  ds_read_b64_tr_b16 a[172:173], v217 offset:57344
  ds_read_b64_tr_b16 a[174:175], v217 offset:61440
  s_waitcnt lgkmcnt(2)
  v_mfma_f32_16x16x32_bf16 a[16:19], a[168:171], v[0:3], a[16:19]
  s_waitcnt lgkmcnt(0)
  v_mfma_f32_16x16x32_bf16 a[16:19], a[172:175], v[32:35], a[16:19]
  v_mfma_f32_16x16x32_bf16 a[20:23], a[172:175], v[40:43], a[20:23]
  v_mfma_f32_16x16x32_bf16 a[20:23], a[168:171], v[8:11], a[20:23]
  v_mfma_f32_16x16x32_bf16 a[24:27], a[168:171], v[16:19], a[24:27]
  v_mfma_f32_16x16x32_bf16 a[24:27], a[172:175], v[48:51], a[24:27]
  v_mfma_f32_16x16x32_bf16 a[28:31], a[172:175], v[56:59], a[28:31]
  v_mfma_f32_16x16x32_bf16 a[28:31], a[168:171], v[24:27], a[28:31]
  ds_read_b64_tr_b16 a[176:177], v218 offset:49152
  ds_read_b64_tr_b16 a[178:179], v218 offset:53248
  ds_read_b64_tr_b16 a[180:181], v218 offset:57344
  ds_read_b64_tr_b16 a[182:183], v218 offset:61440
  s_waitcnt lgkmcnt(2)
  v_mfma_f32_16x16x32_bf16 a[32:35], a[176:179], v[0:3], a[32:35]
  s_waitcnt lgkmcnt(0)
  v_mfma_f32_16x16x32_bf16 a[32:35], a[180:183], v[32:35], a[32:35]
  v_mfma_f32_16x16x32_bf16 a[36:39], a[180:183], v[40:43], a[36:39]
  v_mfma_f32_16x16x32_bf16 a[36:39], a[176:179], v[8:11], a[36:39]
  v_mfma_f32_16x16x32_bf16 a[40:43], a[176:179], v[16:19], a[40:43]
  v_mfma_f32_16x16x32_bf16 a[40:43], a[180:183], v[48:51], a[40:43]
  v_mfma_f32_16x16x32_bf16 a[44:47], a[180:183], v[56:59], a[44:47]
  v_mfma_f32_16x16x32_bf16 a[44:47], a[176:179], v[24:27], a[44:47]
  ds_read_b64_tr_b16 a[184:185], v219 offset:49152
  ds_read_b64_tr_b16 a[186:187], v219 offset:53248
  ds_read_b64_tr_b16 a[188:189], v219 offset:57344
  ds_read_b64_tr_b16 a[190:191], v219 offset:61440
  s_waitcnt lgkmcnt(2)
  v_mfma_f32_16x16x32_bf16 a[48:51], a[184:187], v[0:3], a[48:51]
  s_waitcnt lgkmcnt(0)
  v_mfma_f32_16x16x32_bf16 a[48:51], a[188:191], v[32:35], a[48:51]
  v_mfma_f32_16x16x32_bf16 a[52:55], a[188:191], v[40:43], a[52:55]
  v_mfma_f32_16x16x32_bf16 a[52:55], a[184:187], v[8:11], a[52:55]
  v_mfma_f32_16x16x32_bf16 a[56:59], a[184:187], v[16:19], a[56:59]
  v_mfma_f32_16x16x32_bf16 a[56:59], a[188:191], v[48:51], a[56:59]
  v_mfma_f32_16x16x32_bf16 a[60:63], a[188:191], v[56:59], a[60:63]
  v_mfma_f32_16x16x32_bf16 a[60:63], a[184:187], v[24:27], a[60:63]
  ds_read_b64_tr_b16 a[160:161], v220 offset:49152
  ds_read_b64_tr_b16 a[162:163], v220 offset:53248
  ds_read_b64_tr_b16 a[164:165], v220 offset:57344
  ds_read_b64_tr_b16 a[166:167], v220 offset:61440
  s_waitcnt lgkmcnt(2)
  v_mfma_f32_16x16x32_bf16 a[64:67], a[160:163], v[0:3], a[64:67]
  s_waitcnt lgkmcnt(0)
  v_mfma_f32_16x16x32_bf16 a[64:67], a[164:167], v[32:35], a[64:67]
  v_mfma_f32_16x16x32_bf16 a[68:71], a[164:167], v[40:43], a[68:71]
  v_mfma_f32_16x16x32_bf16 a[68:71], a[160:163], v[8:11], a[68:71]
  v_mfma_f32_16x16x32_bf16 a[72:75], a[160:163], v[16:19], a[72:75]
  v_mfma_f32_16x16x32_bf16 a[72:75], a[164:167], v[48:51], a[72:75]
  v_mfma_f32_16x16x32_bf16 a[76:79], a[164:167], v[56:59], a[76:79]
  v_mfma_f32_16x16x32_bf16 a[76:79], a[160:163], v[24:27], a[76:79]
  ds_read_b64_tr_b16 a[168:169], v221 offset:49152
  ds_read_b64_tr_b16 a[170:171], v221 offset:53248
  ds_read_b64_tr_b16 a[172:173], v221 offset:57344
  ds_read_b64_tr_b16 a[174:175], v221 offset:61440
  s_waitcnt lgkmcnt(2)
  v_mfma_f32_16x16x32_bf16 a[80:83], a[168:171], v[0:3], a[80:83]
  s_waitcnt lgkmcnt(0)
  v_mfma_f32_16x16x32_bf16 a[80:83], a[172:175], v[32:35], a[80:83]
  v_mfma_f32_16x16x32_bf16 a[84:87], a[172:175], v[40:43], a[84:87]
  v_mfma_f32_16x16x32_bf16 a[84:87], a[168:171], v[8:11], a[84:87]
  v_mfma_f32_16x16x32_bf16 a[88:91], a[168:171], v[16:19], a[88:91]
  v_mfma_f32_16x16x32_bf16 a[88:91], a[172:175], v[48:51], a[88:91]
  v_mfma_f32_16x16x32_bf16 a[92:95], a[172:175], v[56:59], a[92:95]
  v_mfma_f32_16x16x32_bf16 a[92:95], a[168:171], v[24:27], a[92:95]
  ds_read_b64_tr_b16 a[176:177], v222 offset:49152
  ds_read_b64_tr_b16 a[178:179], v222 offset:53248
  ds_read_b64_tr_b16 a[180:181], v222 offset:57344
  ds_read_b64_tr_b16 a[182:183], v222 offset:61440
  s_waitcnt lgkmcnt(2)
  v_mfma_f32_16x16x32_bf16 a[96:99], a[176:179], v[0:3], a[96:99]
  s_waitcnt lgkmcnt(0)
  v_mfma_f32_16x16x32_bf16 a[96:99], a[180:183], v[32:35], a[96:99]
  v_mfma_f32_16x16x32_bf16 a[100:103], a[180:183], v[40:43], a[100:103]
  v_mfma_f32_16x16x32_bf16 a[100:103], a[176:179], v[8:11], a[100:103]
  v_mfma_f32_16x16x32_bf16 a[104:107], a[176:179], v[16:19], a[104:107]
  v_mfma_f32_16x16x32_bf16 a[104:107], a[180:183], v[48:51], a[104:107]
  v_mfma_f32_16x16x32_bf16 a[108:111], a[180:183], v[56:59], a[108:111]
  v_mfma_f32_16x16x32_bf16 a[108:111], a[176:179], v[24:27], a[108:111]
  ds_read_b64_tr_b16 a[184:185], v223 offset:49152
  ds_read_b64_tr_b16 a[186:187], v223 offset:53248
  ds_read_b64_tr_b16 a[188:189], v223 offset:57344
  ds_read_b64_tr_b16 a[190:191], v223 offset:61440
  s_waitcnt lgkmcnt(2)
  v_mfma_f32_16x16x32_bf16 a[112:115], a[184:187], v[0:3], a[112:115]
  s_waitcnt lgkmcnt(0)
  v_mfma_f32_16x16x32_bf16 a[112:115], a[188:191], v[32:35], a[112:115]
  v_mfma_f32_16x16x32_bf16 a[116:119], a[188:191], v[40:43], a[116:119]
  v_mfma_f32_16x16x32_bf16 a[116:119], a[184:187], v[8:11], a[116:119]
  v_mfma_f32_16x16x32_bf16 a[120:123], a[184:187], v[16:19], a[120:123]
  v_mfma_f32_16x16x32_bf16 a[120:123], a[188:191], v[48:51], a[120:123]
  v_mfma_f32_16x16x32_bf16 a[124:127], a[188:191], v[56:59], a[124:127]
  v_mfma_f32_16x16x32_bf16 a[124:127], a[184:187], v[24:27], a[124:127]
  s_add_u32 s29, s29, 16384
  s_cmp_lt_u32 s29, 524288
  s_cbranch_scc1 attn_slow
  v_mov_b32 v245, v208
  v_mov_b32 v246, v209
  v_mov_b32 v247, v210
  v_mov_b32 v248, v211
  v_permlane16_swap_b32 v208, v245
  v_permlane16_swap_b32 v209, v246
  v_permlane16_swap_b32 v210, v247
  v_permlane16_swap_b32 v211, v248
  v_add_f32 v208, v208, v245
  v_add_f32 v209, v209, v246
  v_add_f32 v210, v210, v247
  v_add_f32 v211, v211, v248
  v_mov_b32 v245, v208
  v_mov_b32 v246, v209
  v_mov_b32 v247, v210
  v_mov_b32 v248, v211
  v_permlane32_swap_b32 v208, v245
  v_permlane32_swap_b32 v209, v246
  v_permlane32_swap_b32 v210, v247
  v_permlane32_swap_b32 v211, v248
  v_add_f32 v208, v208, v245
  v_add_f32 v209, v209, v246
  v_add_f32 v210, v210, v247
  v_add_f32 v211, v211, v248
  v_rcp_f32 v192, v208
  v_rcp_f32 v196, v209
  v_rcp_f32 v200, v210
  v_rcp_f32 v204, v211
  v_accvgpr_read_b32 v0, a0
  v_accvgpr_read_b32 v1, a1
  v_accvgpr_read_b32 v2, a2
  v_accvgpr_read_b32 v3, a3
  v_accvgpr_read_b32 v4, a16
  v_accvgpr_read_b32 v5, a17
  v_accvgpr_read_b32 v6, a18
  v_accvgpr_read_b32 v7, a19
  v_mul_f32 v0, v0, v192
  v_mul_f32 v1, v1, v192
  v_mul_f32 v2, v2, v192
  v_mul_f32 v3, v3, v192
  v_mul_f32 v4, v4, v192
  v_mul_f32 v5, v5, v192
  v_mul_f32 v6, v6, v192
  v_mul_f32 v7, v7, v192
  v_cvt_pk_bf16_f32 v0, v0, v1
  v_cvt_pk_bf16_f32 v1, v2, v3
  v_cvt_pk_bf16_f32 v2, v4, v5
  v_cvt_pk_bf16_f32 v3, v6, v7
  buffer_store_dwordx4 v[0:3], v244, s[24:27], s40 offen offset:0 sc1
  v_accvgpr_read_b32 v8, a4
  v_accvgpr_read_b32 v9, a5
  v_accvgpr_read_b32 v10, a6
  v_accvgpr_read_b32 v11, a7
  v_accvgpr_read_b32 v12, a20
  v_accvgpr_read_b32 v13, a21
  v_accvgpr_read_b32 v14, a22
  v_accvgpr_read_b32 v15, a23
  v_mul_f32 v8, v8, v196
  v_mul_f32 v9, v9, v196
  v_mul_f32 v10, v10, v196
  v_mul_f32 v11, v11, v196
  v_mul_f32 v12, v12, v196
  v_mul_f32 v13, v13, v196
  v_mul_f32 v14, v14, v196
  v_mul_f32 v15, v15, v196
  v_cvt_pk_bf16_f32 v8, v8, v9
  v_cvt_pk_bf16_f32 v9, v10, v11
  v_cvt_pk_bf16_f32 v10, v12, v13
  v_cvt_pk_bf16_f32 v11, v14, v15
  buffer_store_dwordx4 v[8:11], v244, s[24:27], s40 offen offset:2048 sc1
  v_accvgpr_read_b32 v16, a8
  v_accvgpr_read_b32 v17, a9
  v_accvgpr_read_b32 v18, a10
  v_accvgpr_read_b32 v19, a11
  v_accvgpr_read_b32 v20, a24
  v_accvgpr_read_b32 v21, a25
  v_accvgpr_read_b32 v22, a26
  v_accvgpr_read_b32 v23, a27
  v_mul_f32 v16, v16, v200
  v_mul_f32 v17, v17, v200
  v_mul_f32 v18, v18, v200
  v_mul_f32 v19, v19, v200
  v_mul_f32 v20, v20, v200
  v_mul_f32 v21, v21, v200
  v_mul_f32 v22, v22, v200
  v_mul_f32 v23, v23, v200
  v_cvt_pk_bf16_f32 v16, v16, v17
  v_cvt_pk_bf16_f32 v17, v18, v19
  v_cvt_pk_bf16_f32 v18, v20, v21
  v_cvt_pk_bf16_f32 v19, v22, v23
  buffer_store_dwordx4 v[16:19], v244, s[24:27], s41 offen offset:0 sc1
  v_accvgpr_read_b32 v24, a12
  v_accvgpr_read_b32 v25, a13
  v_accvgpr_read_b32 v26, a14
  v_accvgpr_read_b32 v27, a15
  v_accvgpr_read_b32 v28, a28
  v_accvgpr_read_b32 v29, a29
  v_accvgpr_read_b32 v30, a30
  v_accvgpr_read_b32 v31, a31
  v_mul_f32 v24, v24, v204
  v_mul_f32 v25, v25, v204
  v_mul_f32 v26, v26, v204
  v_mul_f32 v27, v27, v204
  v_mul_f32 v28, v28, v204
  v_mul_f32 v29, v29, v204
  v_mul_f32 v30, v30, v204
  v_mul_f32 v31, v31, v204
  v_cvt_pk_bf16_f32 v24, v24, v25
  v_cvt_pk_bf16_f32 v25, v26, v27
  v_cvt_pk_bf16_f32 v26, v28, v29
  v_cvt_pk_bf16_f32 v27, v30, v31
  buffer_store_dwordx4 v[24:27], v244, s[24:27], s41 offen offset:2048 sc1
  v_accvgpr_read_b32 v32, a32
  v_accvgpr_read_b32 v33, a33
  v_accvgpr_read_b32 v34, a34
  v_accvgpr_read_b32 v35, a35
  v_accvgpr_read_b32 v36, a48
  v_accvgpr_read_b32 v37, a49
  v_accvgpr_read_b32 v38, a50
  v_accvgpr_read_b32 v39, a51
  v_mul_f32 v32, v32, v192
  v_mul_f32 v33, v33, v192
  v_mul_f32 v34, v34, v192
  v_mul_f32 v35, v35, v192
  v_mul_f32 v36, v36, v192
  v_mul_f32 v37, v37, v192
  v_mul_f32 v38, v38, v192
  v_mul_f32 v39, v39, v192
  v_cvt_pk_bf16_f32 v32, v32, v33
  v_cvt_pk_bf16_f32 v33, v34, v35
  v_cvt_pk_bf16_f32 v34, v36, v37
  v_cvt_pk_bf16_f32 v35, v38, v39
  buffer_store_dwordx4 v[32:35], v244, s[24:27], s40 offen offset:1024 sc1
  v_accvgpr_read_b32 v40, a36
  v_accvgpr_read_b32 v41, a37
  v_accvgpr_read_b32 v42, a38
  v_accvgpr_read_b32 v43, a39
  v_accvgpr_read_b32 v44, a52
  v_accvgpr_read_b32 v45, a53
  v_accvgpr_read_b32 v46, a54
  v_accvgpr_read_b32 v47, a55
  v_mul_f32 v40, v40, v196
  v_mul_f32 v41, v41, v196
  v_mul_f32 v42, v42, v196
  v_mul_f32 v43, v43, v196
  v_mul_f32 v44, v44, v196
  v_mul_f32 v45, v45, v196
  v_mul_f32 v46, v46, v196
  v_mul_f32 v47, v47, v196
  v_cvt_pk_bf16_f32 v40, v40, v41
  v_cvt_pk_bf16_f32 v41, v42, v43
  v_cvt_pk_bf16_f32 v42, v44, v45
  v_cvt_pk_bf16_f32 v43, v46, v47
  buffer_store_dwordx4 v[40:43], v244, s[24:27], s40 offen offset:3072 sc1
  v_accvgpr_read_b32 v48, a40
  v_accvgpr_read_b32 v49, a41
  v_accvgpr_read_b32 v50, a42
  v_accvgpr_read_b32 v51, a43
  v_accvgpr_read_b32 v52, a56
  v_accvgpr_read_b32 v53, a57
  v_accvgpr_read_b32 v54, a58
  v_accvgpr_read_b32 v55, a59
  v_mul_f32 v48, v48, v200
  v_mul_f32 v49, v49, v200
  v_mul_f32 v50, v50, v200
  v_mul_f32 v51, v51, v200
  v_mul_f32 v52, v52, v200
  v_mul_f32 v53, v53, v200
  v_mul_f32 v54, v54, v200
  v_mul_f32 v55, v55, v200
  v_cvt_pk_bf16_f32 v48, v48, v49
  v_cvt_pk_bf16_f32 v49, v50, v51
  v_cvt_pk_bf16_f32 v50, v52, v53
  v_cvt_pk_bf16_f32 v51, v54, v55
  buffer_store_dwordx4 v[48:51], v244, s[24:27], s41 offen offset:1024 sc1
  v_accvgpr_read_b32 v56, a44
  v_accvgpr_read_b32 v57, a45
  v_accvgpr_read_b32 v58, a46
  v_accvgpr_read_b32 v59, a47
  v_accvgpr_read_b32 v60, a60
  v_accvgpr_read_b32 v61, a61
  v_accvgpr_read_b32 v62, a62
  v_accvgpr_read_b32 v63, a63
  v_mul_f32 v56, v56, v204
  v_mul_f32 v57, v57, v204
  v_mul_f32 v58, v58, v204
  v_mul_f32 v59, v59, v204
  v_mul_f32 v60, v60, v204
  v_mul_f32 v61, v61, v204
  v_mul_f32 v62, v62, v204
  v_mul_f32 v63, v63, v204
  v_cvt_pk_bf16_f32 v56, v56, v57
  v_cvt_pk_bf16_f32 v57, v58, v59
  v_cvt_pk_bf16_f32 v58, v60, v61
  v_cvt_pk_bf16_f32 v59, v62, v63
  buffer_store_dwordx4 v[56:59], v244, s[24:27], s41 offen offset:3072 sc1
  v_accvgpr_read_b32 v0, a64
  v_accvgpr_read_b32 v1, a65
  v_accvgpr_read_b32 v2, a66
  v_accvgpr_read_b32 v3, a67
  v_accvgpr_read_b32 v4, a80
  v_accvgpr_read_b32 v5, a81
  v_accvgpr_read_b32 v6, a82
  v_accvgpr_read_b32 v7, a83
  v_mul_f32 v0, v0, v192
  v_mul_f32 v1, v1, v192
  v_mul_f32 v2, v2, v192
  v_mul_f32 v3, v3, v192
  v_mul_f32 v4, v4, v192
  v_mul_f32 v5, v5, v192
  v_mul_f32 v6, v6, v192
  v_mul_f32 v7, v7, v192
  v_cvt_pk_bf16_f32 v0, v0, v1
  v_cvt_pk_bf16_f32 v1, v2, v3
  v_cvt_pk_bf16_f32 v2, v4, v5
  v_cvt_pk_bf16_f32 v3, v6, v7
  buffer_store_dwordx4 v[0:3], v244, s[24:27], s42 offen offset:0 sc1
  v_accvgpr_read_b32 v8, a68
  v_accvgpr_read_b32 v9, a69
  v_accvgpr_read_b32 v10, a70
  v_accvgpr_read_b32 v11, a71
  v_accvgpr_read_b32 v12, a84
  v_accvgpr_read_b32 v13, a85
  v_accvgpr_read_b32 v14, a86
  v_accvgpr_read_b32 v15, a87
  v_mul_f32 v8, v8, v196
  v_mul_f32 v9, v9, v196
  v_mul_f32 v10, v10, v196
  v_mul_f32 v11, v11, v196
  v_mul_f32 v12, v12, v196
  v_mul_f32 v13, v13, v196
  v_mul_f32 v14, v14, v196
  v_mul_f32 v15, v15, v196
  v_cvt_pk_bf16_f32 v8, v8, v9
  v_cvt_pk_bf16_f32 v9, v10, v11
  v_cvt_pk_bf16_f32 v10, v12, v13
  v_cvt_pk_bf16_f32 v11, v14, v15
  buffer_store_dwordx4 v[8:11], v244, s[24:27], s42 offen offset:2048 sc1
  v_accvgpr_read_b32 v16, a72
  v_accvgpr_read_b32 v17, a73
  v_accvgpr_read_b32 v18, a74
  v_accvgpr_read_b32 v19, a75
  v_accvgpr_read_b32 v20, a88
  v_accvgpr_read_b32 v21, a89
  v_accvgpr_read_b32 v22, a90
  v_accvgpr_read_b32 v23, a91
  v_mul_f32 v16, v16, v200
  v_mul_f32 v17, v17, v200
  v_mul_f32 v18, v18, v200
  v_mul_f32 v19, v19, v200
  v_mul_f32 v20, v20, v200
  v_mul_f32 v21, v21, v200
  v_mul_f32 v22, v22, v200
  v_mul_f32 v23, v23, v200
  v_cvt_pk_bf16_f32 v16, v16, v17
  v_cvt_pk_bf16_f32 v17, v18, v19
  v_cvt_pk_bf16_f32 v18, v20, v21
  v_cvt_pk_bf16_f32 v19, v22, v23
  buffer_store_dwordx4 v[16:19], v244, s[24:27], s43 offen offset:0 sc1
  v_accvgpr_read_b32 v24, a76
  v_accvgpr_read_b32 v25, a77
  v_accvgpr_read_b32 v26, a78
  v_accvgpr_read_b32 v27, a79
  v_accvgpr_read_b32 v28, a92
  v_accvgpr_read_b32 v29, a93
  v_accvgpr_read_b32 v30, a94
  v_accvgpr_read_b32 v31, a95
  v_mul_f32 v24, v24, v204
  v_mul_f32 v25, v25, v204
  v_mul_f32 v26, v26, v204
  v_mul_f32 v27, v27, v204
  v_mul_f32 v28, v28, v204
  v_mul_f32 v29, v29, v204
  v_mul_f32 v30, v30, v204
  v_mul_f32 v31, v31, v204
  v_cvt_pk_bf16_f32 v24, v24, v25
  v_cvt_pk_bf16_f32 v25, v26, v27
  v_cvt_pk_bf16_f32 v26, v28, v29
  v_cvt_pk_bf16_f32 v27, v30, v31
  buffer_store_dwordx4 v[24:27], v244, s[24:27], s43 offen offset:2048 sc1
  v_accvgpr_read_b32 v32, a96
  v_accvgpr_read_b32 v33, a97
  v_accvgpr_read_b32 v34, a98
  v_accvgpr_read_b32 v35, a99
  v_accvgpr_read_b32 v36, a112
  v_accvgpr_read_b32 v37, a113
  v_accvgpr_read_b32 v38, a114
  v_accvgpr_read_b32 v39, a115
  v_mul_f32 v32, v32, v192
  v_mul_f32 v33, v33, v192
  v_mul_f32 v34, v34, v192
  v_mul_f32 v35, v35, v192
  v_mul_f32 v36, v36, v192
  v_mul_f32 v37, v37, v192
  v_mul_f32 v38, v38, v192
  v_mul_f32 v39, v39, v192
  v_cvt_pk_bf16_f32 v32, v32, v33
  v_cvt_pk_bf16_f32 v33, v34, v35
  v_cvt_pk_bf16_f32 v34, v36, v37
  v_cvt_pk_bf16_f32 v35, v38, v39
  buffer_store_dwordx4 v[32:35], v244, s[24:27], s42 offen offset:1024 sc1
  v_accvgpr_read_b32 v40, a100
  v_accvgpr_read_b32 v41, a101
  v_accvgpr_read_b32 v42, a102
  v_accvgpr_read_b32 v43, a103
  v_accvgpr_read_b32 v44, a116
  v_accvgpr_read_b32 v45, a117
  v_accvgpr_read_b32 v46, a118
  v_accvgpr_read_b32 v47, a119
  v_mul_f32 v40, v40, v196
  v_mul_f32 v41, v41, v196
  v_mul_f32 v42, v42, v196
  v_mul_f32 v43, v43, v196
  v_mul_f32 v44, v44, v196
  v_mul_f32 v45, v45, v196
  v_mul_f32 v46, v46, v196
  v_mul_f32 v47, v47, v196
  v_cvt_pk_bf16_f32 v40, v40, v41
  v_cvt_pk_bf16_f32 v41, v42, v43
  v_cvt_pk_bf16_f32 v42, v44, v45
  v_cvt_pk_bf16_f32 v43, v46, v47
  buffer_store_dwordx4 v[40:43], v244, s[24:27], s42 offen offset:3072 sc1
  v_accvgpr_read_b32 v48, a104
  v_accvgpr_read_b32 v49, a105
  v_accvgpr_read_b32 v50, a106
  v_accvgpr_read_b32 v51, a107
  v_accvgpr_read_b32 v52, a120
  v_accvgpr_read_b32 v53, a121
  v_accvgpr_read_b32 v54, a122
  v_accvgpr_read_b32 v55, a123
  v_mul_f32 v48, v48, v200
  v_mul_f32 v49, v49, v200
  v_mul_f32 v50, v50, v200
  v_mul_f32 v51, v51, v200
  v_mul_f32 v52, v52, v200
  v_mul_f32 v53, v53, v200
  v_mul_f32 v54, v54, v200
  v_mul_f32 v55, v55, v200
  v_cvt_pk_bf16_f32 v48, v48, v49
  v_cvt_pk_bf16_f32 v49, v50, v51
  v_cvt_pk_bf16_f32 v50, v52, v53
  v_cvt_pk_bf16_f32 v51, v54, v55
  buffer_store_dwordx4 v[48:51], v244, s[24:27], s43 offen offset:1024 sc1
  v_accvgpr_read_b32 v56, a108
  v_accvgpr_read_b32 v57, a109
  v_accvgpr_read_b32 v58, a110
  v_accvgpr_read_b32 v59, a111
  v_accvgpr_read_b32 v60, a124
  v_accvgpr_read_b32 v61, a125
  v_accvgpr_read_b32 v62, a126
  v_accvgpr_read_b32 v63, a127
  v_mul_f32 v56, v56, v204
  v_mul_f32 v57, v57, v204
  v_mul_f32 v58, v58, v204
  v_mul_f32 v59, v59, v204
  v_mul_f32 v60, v60, v204
  v_mul_f32 v61, v61, v204
  v_mul_f32 v62, v62, v204
  v_mul_f32 v63, v63, v204
  v_cvt_pk_bf16_f32 v56, v56, v57
  v_cvt_pk_bf16_f32 v57, v58, v59
  v_cvt_pk_bf16_f32 v58, v60, v61
  v_cvt_pk_bf16_f32 v59, v62, v63
  buffer_store_dwordx4 v[56:59], v244, s[24:27], s43 offen offset:3072 sc1
  v_add_u32 v252, 4096, v242
  v_add_u32 v253, 8192, v242
  buffer_load_dwordx4 a[128:131], v253, s[24:27], s4 offen offset:3072 sc1
  buffer_load_dwordx4 a[132:135], v242, s[24:27], s5 offen offset:0 sc1
  buffer_load_dwordx4 a[136:139], v242, s[24:27], s5 offen offset:1024 sc1
  buffer_load_dwordx4 a[140:143], v242, s[24:27], s5 offen offset:2048 sc1
  buffer_load_dwordx4 a[144:147], v242, s[24:27], s5 offen offset:3072 sc1
  buffer_load_dwordx4 a[148:151], v252, s[24:27], s5 offen offset:0 sc1
  buffer_load_dwordx4 a[152:155], v252, s[24:27], s5 offen offset:1024 sc1
  buffer_load_dwordx4 a[156:159], v252, s[24:27], s5 offen offset:2048 sc1
  buffer_load_dwordx4 a[0:3], v252, s[24:27], s5 offen offset:3072 sc1
  buffer_load_dwordx4 a[4:7], v253, s[24:27], s5 offen offset:0 sc1
  buffer_load_dwordx4 a[8:11], v253, s[24:27], s5 offen offset:1024 sc1
  buffer_load_dwordx4 a[12:15], v253, s[24:27], s5 offen offset:2048 sc1
  buffer_load_dwordx4 a[16:19], v253, s[24:27], s5 offen offset:3072 sc1
  buffer_load_dwordx4 a[20:23], v242, s[24:27], s6 offen offset:0 sc1
  buffer_load_dwordx4 a[24:27], v242, s[24:27], s6 offen offset:1024 sc1
  buffer_load_dwordx4 a[28:31], v242, s[24:27], s6 offen offset:2048 sc1
  buffer_load_dwordx4 a[32:35], v242, s[24:27], s6 offen offset:3072 sc1
  buffer_load_dwordx4 a[36:39], v252, s[24:27], s6 offen offset:0 sc1
  s_lshr_b32 s39, s37, 2
  s_lshl_b32 s39, s39, 3
  s_lshr_b32 s38, s36, 2
  s_add_u32 s39, s39, s38
  s_lshl_b32 s39, s39, 7
  s_add_u32 s39, s39, 2867200
  s_lshl_b32 s38, s3, 26
  v_lshlrev_b32 v64, 22, v242
  v_or_b32 v64, s38, v64
  v_mov_b32 v65, 1
  s_waitcnt vmcnt(0)
  s_barrier
  s_branch tail_go
.section .rodata,"a"
.p2align 6
.amdhsa_kernel recurrent_scan__mha_block_cached__moe_arch_mod__prompt_kernel
  .amdhsa_next_free_vgpr 512
  .amdhsa_next_free_sgpr 102
  .amdhsa_accum_offset 256
  .amdhsa_group_segment_fixed_size 0
  .amdhsa_kernarg_size 104
  .amdhsa_user_sgpr_count 2
  .amdhsa_user_sgpr_kernarg_segment_ptr 1
  .amdhsa_system_sgpr_workgroup_id_x 1
.end_amdhsa_kernel
```

```asm
; @launch grid=(256,1,1) block=(256,1,1) lds=163840
.amdgcn_target "amdgcn-amd-amdhsa--gfx950"
.text
.globl recurrent_scan__mha_block_cached__moe_arch_mod__prompt_kernel
.p2align 8
.type recurrent_scan__mha_block_cached__moe_arch_mod__prompt_kernel,@function
recurrent_scan__mha_block_cached__moe_arch_mod__prompt_kernel:
  s_cmp_ge_u32 s2, 256
  s_cbranch_scc1 attn_end
  s_load_dwordx2 s[60:61], s[0:1], 0
  s_load_dwordx2 s[48:49], s[0:1], 48
  s_load_dwordx4 s[4:7], s[0:1], 8
  s_load_dwordx2 s[8:9], s[0:1], 24
  s_load_dwordx2 s[10:11], s[0:1], 96
  s_load_dwordx2 s[88:89], s[0:1], 32
  s_load_dwordx2 s[90:91], s[0:1], 56
  s_load_dwordx4 s[92:95], s[0:1], 64
  s_load_dwordx2 s[62:63], s[0:1], 80
  v_lshrrev_b32 v249, 6, v0
  v_and_b32 v0, 63, v0
  v_mov_b32 v245, v0
  v_readfirstlane_b32 s3, v249
  s_and_b32 s36, s2, 7
  s_lshl_b32 s36, s36, 2
  s_lshr_b32 s37, s2, 6
  s_add_u32 s36, s36, s37
  s_bfe_u32 s37, s2, 196611
  s_lshl_b32 s37, s37, 2
  s_add_u32 s37, s37, s3
  s_lshl_b32 s28, s3, 12
  v_lshrrev_b32 v248, 4, v245
  v_and_b32 v247, 15, v245
  s_lshl_b32 s38, s3, 17
  v_lshlrev_b32 v249, 13, v248
  v_add_u32 v249, s38, v249
  v_or_b32 v250, 0, v248
  v_lshlrev_b32 v250, 1, v250
  v_xor_b32 v250, v250, v247
  v_lshl_add_u32 v238, v250, 4, v249
  v_or_b32 v250, 0, v248
  v_lshlrev_b32 v250, 1, v250
  v_xor_b32 v250, v250, v247
  v_lshl_add_u32 v239, v250, 4, v249
  v_add_u32 v239, 31744, v239
  v_or_b32 v250, 4, v248
  v_lshlrev_b32 v250, 1, v250
  v_xor_b32 v250, v250, v247
  v_lshl_add_u32 v240, v250, 4, v249
  v_add_u32 v240, 63488, v240
  v_or_b32 v250, 4, v248
  v_lshlrev_b32 v250, 1, v250
  v_xor_b32 v250, v250, v247
  v_lshl_add_u32 v241, v250, 4, v249
  v_add_u32 v241, 95232, v241
  s_waitcnt lgkmcnt(0)
  s_add_u32 s58, s10, 2830336
  s_addc_u32 s59, s11, 0
  s_load_dword s59, s[58:59], 0
  s_mov_b32 s24, s10
  s_mov_b32 s25, s11
  s_mov_b32 s26, 29360128
  s_mov_b32 s27, 0x20000
  s_lshl_b32 s38, s36, 8
  s_add_u32 s20, s8, s38
  s_addc_u32 s21, s9, 0
  s_mov_b32 s22, 5242880
  s_mov_b32 s23, 0x20000
  s_sub_u32 s22, s22, s38
  s_cmp_ge_u32 s3, 2
  s_cbranch_scc1 front_fetch
  s_mov_b32 s12, s60
  s_mov_b32 s13, s61
  s_mov_b32 s14, 2621440
  s_mov_b32 s15, 0x20000
  s_mov_b32 s16, s48
  s_mov_b32 s17, s49
  s_mov_b32 s18, 1280
  s_mov_b32 s19, 0x20000
  s_lshr_b32 s52, s37, 2
  s_lshl_b32 s52, s52, 5
  s_add_u32 s52, s52, s36
  s_lshl_b32 s52, s52, 1
  s_add_u32 s52, s52, s3
  s_lshl_b32 s52, s52, 2
  s_mul_i32 s53, s52, 1280
  v_lshrrev_b32 v1, 4, v0
  v_and_b32 v2, 15, v0
  v_lshlrev_b32 v3, 4, v2
  v_mul_u32_u24 v4, 0x500, v1
  v_add_u32 v4, v4, v3
  buffer_load_dwordx4 v[8:11], v4, s[12:15], s53 offen offset:0
  buffer_load_dwordx4 v[12:15], v4, s[12:15], s53 offen offset:256
  buffer_load_dwordx4 v[16:19], v4, s[12:15], s53 offen offset:512
  buffer_load_dwordx4 v[20:23], v4, s[12:15], s53 offen offset:768
  buffer_load_dwordx4 v[24:27], v4, s[12:15], s53 offen offset:1024
  buffer_load_dwordx4 v[28:31], v3, s[16:19], 0 offen offset:0
  buffer_load_dwordx4 v[32:35], v3, s[16:19], 0 offen offset:256
  buffer_load_dwordx4 v[36:39], v3, s[16:19], 0 offen offset:512
  buffer_load_dwordx4 v[40:43], v3, s[16:19], 0 offen offset:768
  buffer_load_dwordx4 v[44:47], v3, s[16:19], 0 offen offset:1024
  v_mov_b32 v7, 0
  v_lshlrev_b32 v6, 26, v0
  s_lshl_b32 s53, s2, 7
  s_add_u32 s53, s53, 2834432
  buffer_store_dword v7, v6, s[24:27], s53 offen sc1
  v_lshlrev_b32 v6, 8, v0
  v_lshrrev_b32 v5, 5, v0
  v_lshl_add_u32 v6, v5, 26, v6
  s_cmp_eq_u32 s2, 0
  s_cselect_b32 s53, 0, 1073741824
  v_or_b32 v6, s53, v6
  s_mov_b32 s53, 2818048
  buffer_store_dword v7, v6, s[24:27], s53 offen sc1
  v_lshlrev_b32 v6, 7, v0
  s_cmp_eq_u32 s2, 1
  s_cselect_b32 s53, 0, 1073741824
  v_or_b32 v6, s53, v6
  s_mov_b32 s53, 2867200
  buffer_store_dword v7, v6, s[24:27], s53 offen sc1
  s_lshr_b32 s53, s52, 6
  s_mul_i32 s53, s53, 81920
  s_bfe_u32 s54, s52, 0x20004
  s_lshl_b32 s54, s54, 10
  s_add_u32 s53, s53, s54
  s_and_b32 s54, s52, 15
  s_lshl_b32 s54, s54, 4
  s_add_u32 s53, s53, s54
  v_lshrrev_b32 v5, 2, v2
  v_lshlrev_b32 v5, 12, v5
  v_and_b32 v6, 3, v2
  v_lshl_add_u32 v5, v6, 8, v5
  v_lshl_add_u32 v5, v1, 4, v5
  s_mov_b32 s56, 0xffff0000
  s_waitcnt vmcnt(12)
  v_lshlrev_b32 v48, 16, v8
  v_and_b32 v49, s56, v8
  v_lshlrev_b32 v50, 16, v9
  v_and_b32 v51, s56, v9
  v_lshlrev_b32 v52, 16, v10
  v_and_b32 v53, s56, v10
  v_lshlrev_b32 v54, 16, v11
  v_and_b32 v55, s56, v11
  s_waitcnt vmcnt(11)
  v_lshlrev_b32 v56, 16, v12
  v_and_b32 v57, s56, v12
  v_lshlrev_b32 v58, 16, v13
  v_and_b32 v59, s56, v13
  v_lshlrev_b32 v60, 16, v14
  v_and_b32 v61, s56, v14
  v_lshlrev_b32 v62, 16, v15
  v_and_b32 v63, s56, v15
  s_waitcnt vmcnt(10)
  v_lshlrev_b32 v64, 16, v16
  v_and_b32 v65, s56, v16
  v_lshlrev_b32 v66, 16, v17
  v_and_b32 v67, s56, v17
  v_lshlrev_b32 v68, 16, v18
  v_and_b32 v69, s56, v18
  v_lshlrev_b32 v70, 16, v19
  v_and_b32 v71, s56, v19
  s_waitcnt vmcnt(9)
  v_lshlrev_b32 v72, 16, v20
  v_and_b32 v73, s56, v20
  v_lshlrev_b32 v74, 16, v21
  v_and_b32 v75, s56, v21
  v_lshlrev_b32 v76, 16, v22
  v_and_b32 v77, s56, v22
  v_lshlrev_b32 v78, 16, v23
  v_and_b32 v79, s56, v23
  s_waitcnt vmcnt(8)
  v_lshlrev_b32 v80, 16, v24
  v_and_b32 v81, s56, v24
  v_lshlrev_b32 v82, 16, v25
  v_and_b32 v83, s56, v25
  v_lshlrev_b32 v84, 16, v26
  v_and_b32 v85, s56, v26
  v_lshlrev_b32 v86, 16, v27
  v_and_b32 v87, s56, v27
  v_pk_add_f32 v[88:89], v[48:49], v[50:51]
  v_pk_add_f32 v[90:91], v[52:53], v[54:55]
  v_pk_add_f32 v[88:89], v[88:89], v[56:57]
  v_pk_add_f32 v[90:91], v[90:91], v[58:59]
  v_pk_add_f32 v[88:89], v[88:89], v[60:61]
  v_pk_add_f32 v[90:91], v[90:91], v[62:63]
  v_pk_add_f32 v[88:89], v[88:89], v[64:65]
  v_pk_add_f32 v[90:91], v[90:91], v[66:67]
  v_pk_add_f32 v[88:89], v[88:89], v[68:69]
  v_pk_add_f32 v[90:91], v[90:91], v[70:71]
  v_pk_add_f32 v[88:89], v[88:89], v[72:73]
  v_pk_add_f32 v[90:91], v[90:91], v[74:75]
  v_pk_add_f32 v[88:89], v[88:89], v[76:77]
  v_pk_add_f32 v[90:91], v[90:91], v[78:79]
  v_pk_add_f32 v[88:89], v[88:89], v[80:81]
  v_pk_add_f32 v[90:91], v[90:91], v[82:83]
  v_pk_add_f32 v[88:89], v[88:89], v[84:85]
  v_pk_add_f32 v[90:91], v[90:91], v[86:87]
  v_pk_add_f32 v[88:89], v[88:89], v[90:91]
  v_add_f32 v92, v88, v89
  s_nop 1
  v_add_f32_dpp v92, v92, v92 row_ror:8 row_mask:0xf bank_mask:0xf
  s_nop 1
  v_add_f32_dpp v92, v92, v92 row_ror:4 row_mask:0xf bank_mask:0xf
  s_nop 1
  v_add_f32_dpp v92, v92, v92 row_ror:2 row_mask:0xf bank_mask:0xf
  s_nop 1
  v_add_f32_dpp v92, v92, v92 row_ror:1 row_mask:0xf bank_mask:0xf
  v_mul_f32 v92, 0x3acccccd, v92
  v_pk_add_f32 v[94:95], v[48:49], v[92:93] op_sel_hi:[1,0] neg_lo:[0,1] neg_hi:[0,1]
  v_pk_mul_f32 v[88:89], v[94:95], v[94:95]
  v_pk_add_f32 v[96:97], v[50:51], v[92:93] op_sel_hi:[1,0] neg_lo:[0,1] neg_hi:[0,1]
  v_pk_mul_f32 v[90:91], v[96:97], v[96:97]
  v_pk_add_f32 v[94:95], v[52:53], v[92:93] op_sel_hi:[1,0] neg_lo:[0,1] neg_hi:[0,1]
  v_pk_fma_f32 v[88:89], v[94:95], v[94:95], v[88:89]
  v_pk_add_f32 v[96:97], v[54:55], v[92:93] op_sel_hi:[1,0] neg_lo:[0,1] neg_hi:[0,1]
  v_pk_fma_f32 v[90:91], v[96:97], v[96:97], v[90:91]
  v_pk_add_f32 v[94:95], v[56:57], v[92:93] op_sel_hi:[1,0] neg_lo:[0,1] neg_hi:[0,1]
  v_pk_fma_f32 v[88:89], v[94:95], v[94:95], v[88:89]
  v_pk_add_f32 v[96:97], v[58:59], v[92:93] op_sel_hi:[1,0] neg_lo:[0,1] neg_hi:[0,1]
  v_pk_fma_f32 v[90:91], v[96:97], v[96:97], v[90:91]
  v_pk_add_f32 v[94:95], v[60:61], v[92:93] op_sel_hi:[1,0] neg_lo:[0,1] neg_hi:[0,1]
  v_pk_fma_f32 v[88:89], v[94:95], v[94:95], v[88:89]
  v_pk_add_f32 v[96:97], v[62:63], v[92:93] op_sel_hi:[1,0] neg_lo:[0,1] neg_hi:[0,1]
  v_pk_fma_f32 v[90:91], v[96:97], v[96:97], v[90:91]
  v_pk_add_f32 v[94:95], v[64:65], v[92:93] op_sel_hi:[1,0] neg_lo:[0,1] neg_hi:[0,1]
  v_pk_fma_f32 v[88:89], v[94:95], v[94:95], v[88:89]
  v_pk_add_f32 v[96:97], v[66:67], v[92:93] op_sel_hi:[1,0] neg_lo:[0,1] neg_hi:[0,1]
  v_pk_fma_f32 v[90:91], v[96:97], v[96:97], v[90:91]
  v_pk_add_f32 v[94:95], v[68:69], v[92:93] op_sel_hi:[1,0] neg_lo:[0,1] neg_hi:[0,1]
  v_pk_fma_f32 v[88:89], v[94:95], v[94:95], v[88:89]
  v_pk_add_f32 v[96:97], v[70:71], v[92:93] op_sel_hi:[1,0] neg_lo:[0,1] neg_hi:[0,1]
  v_pk_fma_f32 v[90:91], v[96:97], v[96:97], v[90:91]
  v_pk_add_f32 v[94:95], v[72:73], v[92:93] op_sel_hi:[1,0] neg_lo:[0,1] neg_hi:[0,1]
  v_pk_fma_f32 v[88:89], v[94:95], v[94:95], v[88:89]
  v_pk_add_f32 v[96:97], v[74:75], v[92:93] op_sel_hi:[1,0] neg_lo:[0,1] neg_hi:[0,1]
  v_pk_fma_f32 v[90:91], v[96:97], v[96:97], v[90:91]
  v_pk_add_f32 v[94:95], v[76:77], v[92:93] op_sel_hi:[1,0] neg_lo:[0,1] neg_hi:[0,1]
  v_pk_fma_f32 v[88:89], v[94:95], v[94:95], v[88:89]
  v_pk_add_f32 v[96:97], v[78:79], v[92:93] op_sel_hi:[1,0] neg_lo:[0,1] neg_hi:[0,1]
  v_pk_fma_f32 v[90:91], v[96:97], v[96:97], v[90:91]
  v_pk_add_f32 v[94:95], v[80:81], v[92:93] op_sel_hi:[1,0] neg_lo:[0,1] neg_hi:[0,1]
  v_pk_fma_f32 v[88:89], v[94:95], v[94:95], v[88:89]
  v_pk_add_f32 v[96:97], v[82:83], v[92:93] op_sel_hi:[1,0] neg_lo:[0,1] neg_hi:[0,1]
  v_pk_fma_f32 v[90:91], v[96:97], v[96:97], v[90:91]
  v_pk_add_f32 v[94:95], v[84:85], v[92:93] op_sel_hi:[1,0] neg_lo:[0,1] neg_hi:[0,1]
  v_pk_fma_f32 v[88:89], v[94:95], v[94:95], v[88:89]
  v_pk_add_f32 v[96:97], v[86:87], v[92:93] op_sel_hi:[1,0] neg_lo:[0,1] neg_hi:[0,1]
  v_pk_fma_f32 v[90:91], v[96:97], v[96:97], v[90:91]
  v_pk_add_f32 v[88:89], v[88:89], v[90:91]
  v_add_f32 v98, v88, v89
  s_nop 1
  v_add_f32_dpp v98, v98, v98 row_ror:8 row_mask:0xf bank_mask:0xf
  v_cvt_pk_bf16_f32 v92, v92, v92
  s_nop 0
  v_add_f32_dpp v98, v98, v98 row_ror:4 row_mask:0xf bank_mask:0xf
  v_lshlrev_b32 v92, 16, v92
  s_nop 0
  v_add_f32_dpp v98, v98, v98 row_ror:2 row_mask:0xf bank_mask:0xf
  s_nop 1
  v_add_f32_dpp v98, v98, v98 row_ror:1 row_mask:0xf bank_mask:0xf
  v_mul_f32 v98, 0x3acccccd, v98
  v_cvt_pk_bf16_f32 v98, v98, v98
  v_pk_add_f32 v[48:49], v[48:49], v[92:93] op_sel_hi:[1,0] neg_lo:[0,1] neg_hi:[0,1]
  v_lshlrev_b32 v98, 16, v98
  v_pk_add_f32 v[50:51], v[50:51], v[92:93] op_sel_hi:[1,0] neg_lo:[0,1] neg_hi:[0,1]
  v_add_f32 v98, 0x3727c5ac, v98
  v_pk_add_f32 v[52:53], v[52:53], v[92:93] op_sel_hi:[1,0] neg_lo:[0,1] neg_hi:[0,1]
  v_cvt_pk_bf16_f32 v98, v98, v98
  v_pk_add_f32 v[54:55], v[54:55], v[92:93] op_sel_hi:[1,0] neg_lo:[0,1] neg_hi:[0,1]
  v_lshlrev_b32 v98, 16, v98
  v_pk_add_f32 v[56:57], v[56:57], v[92:93] op_sel_hi:[1,0] neg_lo:[0,1] neg_hi:[0,1]
  v_sqrt_f32 v98, v98
  v_pk_add_f32 v[58:59], v[58:59], v[92:93] op_sel_hi:[1,0] neg_lo:[0,1] neg_hi:[0,1]
  v_cvt_pk_bf16_f32 v98, v98, v98
  v_pk_add_f32 v[60:61], v[60:61], v[92:93] op_sel_hi:[1,0] neg_lo:[0,1] neg_hi:[0,1]
  v_lshlrev_b32 v98, 16, v98
  v_pk_add_f32 v[62:63], v[62:63], v[92:93] op_sel_hi:[1,0] neg_lo:[0,1] neg_hi:[0,1]
  v_rcp_f32 v100, v98
  v_pk_add_f32 v[64:65], v[64:65], v[92:93] op_sel_hi:[1,0] neg_lo:[0,1] neg_hi:[0,1]
  v_pk_add_f32 v[66:67], v[66:67], v[92:93] op_sel_hi:[1,0] neg_lo:[0,1] neg_hi:[0,1]
  v_pk_add_f32 v[68:69], v[68:69], v[92:93] op_sel_hi:[1,0] neg_lo:[0,1] neg_hi:[0,1]
  v_pk_add_f32 v[70:71], v[70:71], v[92:93] op_sel_hi:[1,0] neg_lo:[0,1] neg_hi:[0,1]
  v_pk_add_f32 v[72:73], v[72:73], v[92:93] op_sel_hi:[1,0] neg_lo:[0,1] neg_hi:[0,1]
  v_pk_add_f32 v[74:75], v[74:75], v[92:93] op_sel_hi:[1,0] neg_lo:[0,1] neg_hi:[0,1]
  v_pk_add_f32 v[76:77], v[76:77], v[92:93] op_sel_hi:[1,0] neg_lo:[0,1] neg_hi:[0,1]
  v_pk_add_f32 v[78:79], v[78:79], v[92:93] op_sel_hi:[1,0] neg_lo:[0,1] neg_hi:[0,1]
  v_pk_add_f32 v[80:81], v[80:81], v[92:93] op_sel_hi:[1,0] neg_lo:[0,1] neg_hi:[0,1]
  v_pk_add_f32 v[82:83], v[82:83], v[92:93] op_sel_hi:[1,0] neg_lo:[0,1] neg_hi:[0,1]
  v_pk_add_f32 v[84:85], v[84:85], v[92:93] op_sel_hi:[1,0] neg_lo:[0,1] neg_hi:[0,1]
  v_pk_add_f32 v[86:87], v[86:87], v[92:93] op_sel_hi:[1,0] neg_lo:[0,1] neg_hi:[0,1]
  v_mov_b32 v104, 0
  v_mov_b32 v105, 0
  v_cvt_pk_bf16_f32 v8, v48, v49
  v_cvt_pk_bf16_f32 v9, v50, v51
  v_cvt_pk_bf16_f32 v10, v52, v53
  v_cvt_pk_bf16_f32 v11, v54, v55
  v_cvt_pk_bf16_f32 v12, v56, v57
  v_cvt_pk_bf16_f32 v13, v58, v59
  v_cvt_pk_bf16_f32 v14, v60, v61
  v_cvt_pk_bf16_f32 v15, v62, v63
  v_cvt_pk_bf16_f32 v16, v64, v65
  v_cvt_pk_bf16_f32 v17, v66, v67
  v_cvt_pk_bf16_f32 v18, v68, v69
  v_cvt_pk_bf16_f32 v19, v70, v71
  v_cvt_pk_bf16_f32 v20, v72, v73
  v_cvt_pk_bf16_f32 v21, v74, v75
  v_cvt_pk_bf16_f32 v22, v76, v77
  v_cvt_pk_bf16_f32 v23, v78, v79
  v_cvt_pk_bf16_f32 v24, v80, v81
  v_cvt_pk_bf16_f32 v25, v82, v83
  v_cvt_pk_bf16_f32 v26, v84, v85
  v_cvt_pk_bf16_f32 v27, v86, v87
  v_lshlrev_b32 v48, 16, v8
  v_and_b32 v49, s56, v8
  v_lshlrev_b32 v50, 16, v9
  v_and_b32 v51, s56, v9
  v_lshlrev_b32 v52, 16, v10
  v_and_b32 v53, s56, v10
  v_lshlrev_b32 v54, 16, v11
  v_and_b32 v55, s56, v11
  v_lshlrev_b32 v56, 16, v12
  v_and_b32 v57, s56, v12
  v_lshlrev_b32 v58, 16, v13
  v_and_b32 v59, s56, v13
  v_lshlrev_b32 v60, 16, v14
  v_and_b32 v61, s56, v14
  v_lshlrev_b32 v62, 16, v15
  v_and_b32 v63, s56, v15
  v_lshlrev_b32 v64, 16, v16
  v_and_b32 v65, s56, v16
  v_lshlrev_b32 v66, 16, v17
  v_and_b32 v67, s56, v17
  v_lshlrev_b32 v68, 16, v18
  v_and_b32 v69, s56, v18
  v_lshlrev_b32 v70, 16, v19
  v_and_b32 v71, s56, v19
  v_lshlrev_b32 v72, 16, v20
  v_and_b32 v73, s56, v20
  v_lshlrev_b32 v74, 16, v21
  v_and_b32 v75, s56, v21
  v_lshlrev_b32 v76, 16, v22
  v_and_b32 v77, s56, v22
  v_lshlrev_b32 v78, 16, v23
  v_and_b32 v79, s56, v23
  v_lshlrev_b32 v80, 16, v24
  v_and_b32 v81, s56, v24
  v_lshlrev_b32 v82, 16, v25
  v_and_b32 v83, s56, v25
  v_lshlrev_b32 v84, 16, v26
  v_and_b32 v85, s56, v26
  v_lshlrev_b32 v86, 16, v27
  v_and_b32 v87, s56, v27
  v_pk_mul_f32 v[48:49], v[48:49], v[100:101] op_sel_hi:[1,0]
  v_pk_mul_f32 v[50:51], v[50:51], v[100:101] op_sel_hi:[1,0]
  v_pk_mul_f32 v[52:53], v[52:53], v[100:101] op_sel_hi:[1,0]
  v_pk_mul_f32 v[54:55], v[54:55], v[100:101] op_sel_hi:[1,0]
  v_cvt_pk_bf16_f32 v8, v48, v49
  v_cvt_pk_bf16_f32 v9, v50, v51
  v_cvt_pk_bf16_f32 v10, v52, v53
  v_cvt_pk_bf16_f32 v11, v54, v55
  buffer_store_dwordx4 v[8:11], v5, s[24:27], s53 offen sc1
  s_add_u32 s53, s53, 16384
  v_pk_mul_f32 v[56:57], v[56:57], v[100:101] op_sel_hi:[1,0]
  v_pk_mul_f32 v[58:59], v[58:59], v[100:101] op_sel_hi:[1,0]
  v_pk_mul_f32 v[60:61], v[60:61], v[100:101] op_sel_hi:[1,0]
  v_pk_mul_f32 v[62:63], v[62:63], v[100:101] op_sel_hi:[1,0]
  v_cvt_pk_bf16_f32 v12, v56, v57
  v_cvt_pk_bf16_f32 v13, v58, v59
  v_cvt_pk_bf16_f32 v14, v60, v61
  v_cvt_pk_bf16_f32 v15, v62, v63
  buffer_store_dwordx4 v[12:15], v5, s[24:27], s53 offen sc1
  s_add_u32 s53, s53, 16384
  v_pk_mul_f32 v[64:65], v[64:65], v[100:101] op_sel_hi:[1,0]
  v_pk_mul_f32 v[66:67], v[66:67], v[100:101] op_sel_hi:[1,0]
  v_pk_mul_f32 v[68:69], v[68:69], v[100:101] op_sel_hi:[1,0]
  v_pk_mul_f32 v[70:71], v[70:71], v[100:101] op_sel_hi:[1,0]
  v_cvt_pk_bf16_f32 v16, v64, v65
  v_cvt_pk_bf16_f32 v17, v66, v67
  v_cvt_pk_bf16_f32 v18, v68, v69
  v_cvt_pk_bf16_f32 v19, v70, v71
  buffer_store_dwordx4 v[16:19], v5, s[24:27], s53 offen sc1
  s_add_u32 s53, s53, 16384
  v_pk_mul_f32 v[72:73], v[72:73], v[100:101] op_sel_hi:[1,0]
  v_pk_mul_f32 v[74:75], v[74:75], v[100:101] op_sel_hi:[1,0]
  v_pk_mul_f32 v[76:77], v[76:77], v[100:101] op_sel_hi:[1,0]
  v_pk_mul_f32 v[78:79], v[78:79], v[100:101] op_sel_hi:[1,0]
  v_cvt_pk_bf16_f32 v20, v72, v73
  v_cvt_pk_bf16_f32 v21, v74, v75
  v_cvt_pk_bf16_f32 v22, v76, v77
  v_cvt_pk_bf16_f32 v23, v78, v79
  buffer_store_dwordx4 v[20:23], v5, s[24:27], s53 offen sc1
  s_add_u32 s53, s53, 16384
  v_pk_mul_f32 v[80:81], v[80:81], v[100:101] op_sel_hi:[1,0]
  v_pk_mul_f32 v[82:83], v[82:83], v[100:101] op_sel_hi:[1,0]
  v_pk_mul_f32 v[84:85], v[84:85], v[100:101] op_sel_hi:[1,0]
  v_pk_mul_f32 v[86:87], v[86:87], v[100:101] op_sel_hi:[1,0]
  v_cvt_pk_bf16_f32 v24, v80, v81
  v_cvt_pk_bf16_f32 v25, v82, v83
  v_cvt_pk_bf16_f32 v26, v84, v85
  v_cvt_pk_bf16_f32 v27, v86, v87
  buffer_store_dwordx4 v[24:27], v5, s[24:27], s53 offen sc1
  s_add_u32 s53, s53, 16384
  s_waitcnt vmcnt(12)
  v_dot2_f32_bf16 v104, v8, v28, v104
  v_dot2_f32_bf16 v105, v9, v29, v105
  v_dot2_f32_bf16 v104, v10, v30, v104
  v_dot2_f32_bf16 v105, v11, v31, v105
  s_waitcnt vmcnt(11)
  v_dot2_f32_bf16 v104, v12, v32, v104
  v_dot2_f32_bf16 v105, v13, v33, v105
  v_dot2_f32_bf16 v104, v14, v34, v104
  v_dot2_f32_bf16 v105, v15, v35, v105
  s_waitcnt vmcnt(10)
  v_dot2_f32_bf16 v104, v16, v36, v104
  v_dot2_f32_bf16 v105, v17, v37, v105
  v_dot2_f32_bf16 v104, v18, v38, v104
  v_dot2_f32_bf16 v105, v19, v39, v105
  s_waitcnt vmcnt(9)
  v_dot2_f32_bf16 v104, v20, v40, v104
  v_dot2_f32_bf16 v105, v21, v41, v105
  v_dot2_f32_bf16 v104, v22, v42, v104
  v_dot2_f32_bf16 v105, v23, v43, v105
  s_waitcnt vmcnt(8)
  v_dot2_f32_bf16 v104, v24, v44, v104
  v_dot2_f32_bf16 v105, v25, v45, v105
  v_dot2_f32_bf16 v104, v26, v46, v104
  v_dot2_f32_bf16 v105, v27, v47, v105
  s_nop 2
  v_add_f32 v104, v104, v105
  s_nop 1
  v_add_f32_dpp v104, v104, v104 row_ror:8 row_mask:0xf bank_mask:0xf
  s_nop 1
  v_add_f32_dpp v104, v104, v104 row_ror:4 row_mask:0xf bank_mask:0xf
  s_nop 1
  v_add_f32_dpp v104, v104, v104 row_ror:2 row_mask:0xf bank_mask:0xf
  s_nop 1
  v_add_f32_dpp v104, v104, v104 row_ror:1 row_mask:0xf bank_mask:0xf
  v_cvt_pk_bf16_f32 v104, v104, v104
  v_lshlrev_b32 v104, 16, v104
  v_ashrrev_i32 v105, 31, v104
  v_or_b32 v105, 0x80000000, v105
  v_xor_b32 v104, v104, v105
  v_and_b32 v104, s56, v104
  v_add_u32 v6, s52, v1
  v_sub_u32 v7, 0xffff, v6
  v_or_b32 v104, v104, v7
  v_lshlrev_b32 v6, 2, v6
  v_lshl_add_u32 v6, v2, 26, v6
  s_mov_b32 s53, 2621440
  buffer_store_dword v104, v6, s[24:27], s53 offen sc1
  s_waitcnt vmcnt(0)
  s_branch front_join
front_fetch:
  s_getpc_b64 s[98:99]
attn_hot_pc:
  s_add_u32 s98, s98, attn_hot-attn_hot_pc
  s_addc_u32 s99, s99, 0
  s_lshr_b32 s100, s2, 3
  v_min_u32 v249, 17, v0
  v_lshlrev_b32 v249, 5, v249
  v_add_u32 v249, s100, v249
  v_lshlrev_b32 v249, 7, v249
  v_min_u32 v249, attn_end-attn_hot-4, v249
  global_load_dword v255, v249, s[98:99]
attn_hot:
  v_subrev_u32 v16, 0x40000, v238
  v_subrev_u32 v17, 0x40000, v239
  v_subrev_u32 v18, 0x40000, v240
  v_subrev_u32 v19, 0x40000, v241
  s_mov_b32 s31, 0
  s_add_u32 m0, s28, 90112
  s_nop 0
  buffer_load_dwordx4 v16, s[20:23], s31 offen offset:0 lds
  buffer_load_dwordx4 v17, s[20:23], s31 offen offset:1024 lds
  buffer_load_dwordx4 v18, s[20:23], s31 offen offset:2048 lds
  buffer_load_dwordx4 v19, s[20:23], s31 offen offset:3072 lds
  s_add_u32 m0, s28, 98304
  s_nop 0
  buffer_load_dwordx4 v238, s[20:23], s31 offen offset:0 lds
  buffer_load_dwordx4 v239, s[20:23], s31 offen offset:1024 lds
  buffer_load_dwordx4 v240, s[20:23], s31 offen offset:2048 lds
  buffer_load_dwordx4 v241, s[20:23], s31 offen offset:3072 lds
front_join:
  s_waitcnt lgkmcnt(0)
  s_barrier
  s_mul_i32 s55, s59, 0x9e3779b1
  s_add_u32 s55, s55, 0x7f4a7c15
  s_lshr_b32 s58, s37, 2
  s_lshl_b32 s58, s58, 8
  s_add_u32 s58, s58, 2826240
  s_lshl_b32 s53, s36, 2
  s_lshl_b32 s54, s3, 26
  s_add_u32 s53, s53, s54
  v_min_u32 v1, 1, v0
  v_lshlrev_b32 v1, 28, v1
  v_add_u32 v1, s53, v1
  v_mov_b32 v2, s55
  buffer_store_dword v2, v1, s[24:27], s58 offen sc1
  s_cmp_lt_u32 s3, 2
  s_cbranch_scc1 front_addr
  s_mov_b32 s31, 524288
  s_add_u32 m0, s28, 106496
  s_nop 0
  buffer_load_dwordx4 v16, s[20:23], s31 offen offset:0 lds
  buffer_load_dwordx4 v17, s[20:23], s31 offen offset:1024 lds
  buffer_load_dwordx4 v18, s[20:23], s31 offen offset:2048 lds
  buffer_load_dwordx4 v19, s[20:23], s31 offen offset:3072 lds
  s_add_u32 m0, s28, 114688
  s_nop 0
  buffer_load_dwordx4 v238, s[20:23], s31 offen offset:0 lds
  buffer_load_dwordx4 v239, s[20:23], s31 offen offset:1024 lds
  buffer_load_dwordx4 v240, s[20:23], s31 offen offset:2048 lds
  buffer_load_dwordx4 v241, s[20:23], s31 offen offset:3072 lds
  s_mov_b32 s31, 1048576
  s_add_u32 m0, s28, 24576
  s_nop 0
  buffer_load_dwordx4 v16, s[20:23], s31 offen offset:0 lds
  buffer_load_dwordx4 v17, s[20:23], s31 offen offset:1024 lds
  buffer_load_dwordx4 v18, s[20:23], s31 offen offset:2048 lds
  buffer_load_dwordx4 v19, s[20:23], s31 offen offset:3072 lds
  s_add_u32 m0, s28, 32768
  s_nop 0
  buffer_load_dwordx4 v238, s[20:23], s31 offen offset:0 lds
  buffer_load_dwordx4 v239, s[20:23], s31 offen offset:1024 lds
  buffer_load_dwordx4 v240, s[20:23], s31 offen offset:2048 lds
  buffer_load_dwordx4 v241, s[20:23], s31 offen offset:3072 lds
  s_mov_b32 s31, 1572864
  s_add_u32 m0, s28, 40960
  s_nop 0
  buffer_load_dwordx4 v16, s[20:23], s31 offen offset:0 lds
  buffer_load_dwordx4 v17, s[20:23], s31 offen offset:1024 lds
  buffer_load_dwordx4 v18, s[20:23], s31 offen offset:2048 lds
  buffer_load_dwordx4 v19, s[20:23], s31 offen offset:3072 lds
  s_add_u32 m0, s28, 49152
  s_nop 0
  buffer_load_dwordx4 v238, s[20:23], s31 offen offset:0 lds
  buffer_load_dwordx4 v239, s[20:23], s31 offen offset:1024 lds
  buffer_load_dwordx4 v240, s[20:23], s31 offen offset:2048 lds
  buffer_load_dwordx4 v241, s[20:23], s31 offen offset:3072 lds
front_addr:
  s_mov_b32 s31, 2097152
  v_lshlrev_b32 v242, 4, v245
  v_add_u32 v243, 0x1000, v242
  s_mul_i32 s30, s37, 81920
  s_lshl_b32 s38, s36, 19
  s_add_u32 s12, s4, s38
  s_addc_u32 s13, s5, 0
  s_mov_b32 s14, 524288
  s_mov_b32 s15, 0x20000
  s_add_u32 s16, s6, s38
  s_addc_u32 s17, s7, 0
  s_mov_b32 s18, 524288
  s_mov_b32 s19, 0x20000
  v_lshlrev_b32 v249, 8, v248
  v_add_u32 v249, s28, v249
  v_add_u32 v250, 0, v248
  v_xor_b32 v250, v250, v247
  v_lshl_add_u32 v232, v250, 4, v249
  v_add_u32 v250, 4, v248
  v_xor_b32 v250, v250, v247
  v_lshl_add_u32 v233, v250, 4, v249
  v_add_u32 v250, 8, v248
  v_xor_b32 v250, v250, v247
  v_lshl_add_u32 v234, v250, 4, v249
  v_add_u32 v250, 12, v248
  v_xor_b32 v250, v250, v247
  v_lshl_add_u32 v235, v250, 4, v249
  v_add_u32 v250, 0, v248
  v_lshlrev_b32 v250, 1, v250
  v_xor_b32 v250, v250, v247
  v_lshl_add_u32 v236, v250, 4, v249
  v_add_u32 v250, 4, v248
  v_lshlrev_b32 v250, 1, v250
  v_xor_b32 v250, v250, v247
  v_lshl_add_u32 v237, v250, 4, v249
  v_lshrrev_b32 v249, 1, v248
  v_and_b32 v250, 1, v248
  v_lshl_or_b32 v249, v250, 1, v249
  v_xor_b32 v249, v249, v247
  v_lshlrev_b32 v249, 4, v249
  v_lshl_add_u32 v212, v247, 8, v249
  v_xor_b32 v213, 64, v212
  v_xor_b32 v214, 128, v212
  v_xor_b32 v215, 192, v212
  v_bfe_u32 v246, v245, 2, 2
  v_and_b32 v247, 3, v245
  v_lshlrev_b32 v247, 3, v247
  v_add_u32 v247, 65536, v247
  v_lshl_add_u32 v249, v248, 3, v246
  v_and_b32 v250, 1, v248
  v_lshl_add_u32 v250, v250, 2, v246
  v_lshl_add_u32 v250, v250, 5, v247
  v_lshl_add_u32 v224, v249, 8, v250
  v_xor_b32 v225, 32, v224
  v_xor_b32 v226, 64, v224
  v_xor_b32 v227, 96, v224
  v_xor_b32 v228, 128, v224
  v_xor_b32 v229, 160, v224
  v_xor_b32 v230, 192, v224
  v_xor_b32 v231, 224, v224
  v_lshl_add_u32 v249, v248, 2, v246
  v_and_b32 v250, 7, v249
  v_lshl_add_u32 v250, v250, 5, v247
  v_lshl_add_u32 v216, v249, 8, v250
  v_xor_b32 v217, 32, v216
  v_xor_b32 v218, 64, v216
  v_xor_b32 v219, 96, v216
  v_xor_b32 v220, 128, v216
  v_xor_b32 v221, 160, v216
  v_xor_b32 v222, 192, v216
  v_xor_b32 v223, 224, v216
  v_subrev_u32 v148, 65536, v224
  v_subrev_u32 v149, 65536, v225
  v_subrev_u32 v150, 65536, v226
  v_subrev_u32 v151, 65536, v227
  v_subrev_u32 v152, 65536, v228
  v_subrev_u32 v153, 65536, v229
  v_subrev_u32 v154, 65536, v230
  v_subrev_u32 v155, 65536, v231
  s_lshr_b32 s38, s2, 3
  s_min_u32 s38, s38, 26
  s_and_b32 s39, s2, 7
  s_mul_i32 s39, s39, 27
  s_add_u32 s33, s38, s39
  s_mul_i32 s50, s3, 6144
  s_add_u32 s50, s50, 133120
  v_mov_b32 v244, v242
  s_lshl_b32 s40, s37, 19
  s_lshl_b32 s38, s36, 14
  s_add_u32 s40, s40, s38
  s_add_u32 s40, s40, 8388608
  s_add_u32 s41, s40, 4096
  s_add_u32 s42, s40, 8192
  s_add_u32 s43, s40, 12288
  s_mov_b32 s34, 0x3e0293ee
  s_mov_b32 s29, 0
  v_and_b32 v249, 15, v245
  v_cmp_eq_u32 vcc, 0, v249
  v_mov_b32 v249, 0x3f803f80
  s_nop 0
  v_cndmask_b32 v249, 0, v249, vcc
  v_accvgpr_write_b32 a208, v249
  v_accvgpr_write_b32 a209, v249
  v_accvgpr_write_b32 a210, v249
  v_accvgpr_write_b32 a211, v249
  v_and_b32 v2, 7, v0
  v_lshlrev_b32 v2, 2, v2
  s_lshl_b32 s54, s3, 5
  v_add_u32 v2, s54, v2
  s_mov_b32 s54, 32768
  buffer_load_dword v3, v2, s[24:27], s58 offen sc1
  s_sleep 2
  buffer_load_dword v4, v2, s[24:27], s58 offen sc1
  s_sleep 2
  buffer_load_dword v5, v2, s[24:27], s58 offen sc1
  s_sleep 2
front_poll:
  buffer_load_dword v6, v2, s[24:27], s58 offen sc1
  s_waitcnt vmcnt(3)
  v_cmp_ne_u32 vcc, s55, v3
  s_nop 0
  s_cbranch_vccz front_go
  s_sleep 2
  buffer_load_dword v3, v2, s[24:27], s58 offen sc1
  s_waitcnt vmcnt(3)
  v_cmp_ne_u32 vcc, s55, v4
  s_nop 0
  s_cbranch_vccz front_go
  s_sleep 2
  buffer_load_dword v4, v2, s[24:27], s58 offen sc1
  s_waitcnt vmcnt(3)
  v_cmp_ne_u32 vcc, s55, v5
  s_nop 0
  s_cbranch_vccz front_go
  s_sleep 2
  buffer_load_dword v5, v2, s[24:27], s58 offen sc1
  s_waitcnt vmcnt(3)
  v_cmp_ne_u32 vcc, s55, v6
  s_nop 0
  s_cbranch_vccz front_go
  s_sleep 2
  s_sub_u32 s54, s54, 1
  s_cmp_lg_u32 s54, 0
  s_cbranch_scc1 front_poll
front_go:
  buffer_load_dwordx4 a[0:3], v242, s[24:27], s30 offen offset:0 sc1
  buffer_load_dwordx4 a[4:7], v242, s[24:27], s30 offen offset:1024 sc1
  buffer_load_dwordx4 a[8:11], v242, s[24:27], s30 offen offset:2048 sc1
  buffer_load_dwordx4 a[12:15], v242, s[24:27], s30 offen offset:3072 sc1
  buffer_load_dwordx4 a[16:19], v243, s[24:27], s30 offen offset:0 sc1
  buffer_load_dwordx4 a[20:23], v243, s[24:27], s30 offen offset:1024 sc1
  buffer_load_dwordx4 a[24:27], v243, s[24:27], s30 offen offset:2048 sc1
  buffer_load_dwordx4 a[28:31], v243, s[24:27], s30 offen offset:3072 sc1
  s_add_u32 s30, s30, 8192
  buffer_load_dwordx4 a[32:35], v242, s[24:27], s30 offen offset:0 sc1
  buffer_load_dwordx4 a[36:39], v242, s[24:27], s30 offen offset:1024 sc1
  buffer_load_dwordx4 a[40:43], v242, s[24:27], s30 offen offset:2048 sc1
  buffer_load_dwordx4 a[44:47], v242, s[24:27], s30 offen offset:3072 sc1
  buffer_load_dwordx4 a[48:51], v243, s[24:27], s30 offen offset:0 sc1
  buffer_load_dwordx4 a[52:55], v243, s[24:27], s30 offen offset:1024 sc1
  buffer_load_dwordx4 a[56:59], v243, s[24:27], s30 offen offset:2048 sc1
  buffer_load_dwordx4 a[60:63], v243, s[24:27], s30 offen offset:3072 sc1
  s_add_u32 s30, s30, 8192
  v_lshrrev_b32 v140, 7, v242
  v_lshlrev_b32 v140, 8, v140
  v_and_b32 v136, 0x70, v242
  v_add_u32 v140, v140, v136
  s_mov_b32 s58, 2826240
  buffer_load_dwordx4 v[136:139], v140, s[24:27], s58 offen sc1
  s_barrier
  ds_read_b64_tr_b16 a[160:161], v224 offset:32768
  ds_read_b64_tr_b16 a[162:163], v224 offset:33792
  ds_read_b64_tr_b16 a[164:165], v224 offset:40960
  ds_read_b64_tr_b16 a[166:167], v224 offset:41984
  ds_read_b64_tr_b16 a[168:169], v225 offset:32768
  ds_read_b64_tr_b16 a[170:171], v225 offset:33792
  ds_read_b64_tr_b16 a[172:173], v225 offset:40960
  ds_read_b64_tr_b16 a[174:175], v225 offset:41984
  s_waitcnt vmcnt(9) lgkmcnt(4)
  v_mfma_f32_16x16x32_bf16 v[0:3], a[160:163], a[0:3], 0
  ds_read_b64_tr_b16 a[176:177], v226 offset:32768
  v_mfma_f32_16x16x32_bf16 v[0:3], a[164:167], a[16:19], v[0:3]
  buffer_load_dwordx4 a[64:67], v242, s[24:27], s30 offen offset:0 sc1
  v_mfma_f32_16x16x32_bf16 v[4:7], a[164:167], a[20:23], 0
  ds_read_b64_tr_b16 a[178:179], v226 offset:33792
  v_mfma_f32_16x16x32_bf16 v[4:7], a[160:163], a[4:7], v[4:7]
  buffer_load_dwordx4 a[68:71], v242, s[24:27], s30 offen offset:1024 sc1
  v_mfma_f32_16x16x32_bf16 v[8:11], a[160:163], a[8:11], 0
  ds_read_b64_tr_b16 a[180:181], v226 offset:40960
  v_mfma_f32_16x16x32_bf16 v[8:11], a[164:167], a[24:27], v[8:11]
  v_mfma_f32_16x16x32_bf16 v[12:15], a[164:167], a[28:31], 0
  ds_read_b64_tr_b16 a[182:183], v226 offset:41984
  v_mfma_f32_16x16x32_bf16 v[12:15], a[160:163], a[12:15], v[12:15]
  s_waitcnt lgkmcnt(4)
  buffer_load_dwordx4 a[72:75], v242, s[24:27], s30 offen offset:2048 sc1
  v_mfma_f32_16x16x32_bf16 v[16:19], a[168:171], a[0:3], 0
  ds_read_b64_tr_b16 a[184:185], v227 offset:32768
  v_mfma_f32_16x16x32_bf16 v[16:19], a[172:175], a[16:19], v[16:19]
  v_mfma_f32_16x16x32_bf16 v[20:23], a[172:175], a[20:23], 0
  ds_read_b64_tr_b16 a[186:187], v227 offset:33792
  v_mfma_f32_16x16x32_bf16 v[20:23], a[168:171], a[4:7], v[20:23]
  buffer_load_dwordx4 a[76:79], v242, s[24:27], s30 offen offset:3072 sc1
  v_mfma_f32_16x16x32_bf16 v[24:27], a[168:171], a[8:11], 0
  ds_read_b64_tr_b16 a[188:189], v227 offset:40960
  v_mfma_f32_16x16x32_bf16 v[24:27], a[172:175], a[24:27], v[24:27]
  buffer_load_dwordx4 a[80:83], v243, s[24:27], s30 offen offset:0 sc1
  v_mfma_f32_16x16x32_bf16 v[28:31], a[172:175], a[28:31], 0
  ds_read_b64_tr_b16 a[190:191], v227 offset:41984
  v_mfma_f32_16x16x32_bf16 v[28:31], a[168:171], a[12:15], v[28:31]
  s_waitcnt lgkmcnt(4)
  v_mfma_f32_16x16x32_bf16 v[32:35], a[176:179], a[0:3], 0
  ds_read_b64_tr_b16 a[160:161], v228 offset:32768
  v_mfma_f32_16x16x32_bf16 v[32:35], a[180:183], a[16:19], v[32:35]
  buffer_load_dwordx4 a[84:87], v243, s[24:27], s30 offen offset:1024 sc1
  v_mfma_f32_16x16x32_bf16 v[36:39], a[180:183], a[20:23], 0
  ds_read_b64_tr_b16 a[162:163], v228 offset:33792
  v_mfma_f32_16x16x32_bf16 v[36:39], a[176:179], a[4:7], v[36:39]
  v_mfma_f32_16x16x32_bf16 v[40:43], a[176:179], a[8:11], 0
  ds_read_b64_tr_b16 a[164:165], v228 offset:40960
  v_mfma_f32_16x16x32_bf16 v[40:43], a[180:183], a[24:27], v[40:43]
  buffer_load_dwordx4 a[88:91], v243, s[24:27], s30 offen offset:2048 sc1
  v_mfma_f32_16x16x32_bf16 v[44:47], a[180:183], a[28:31], 0
  ds_read_b64_tr_b16 a[166:167], v228 offset:41984
  v_mfma_f32_16x16x32_bf16 v[44:47], a[176:179], a[12:15], v[44:47]
  s_waitcnt lgkmcnt(4)
  buffer_load_dwordx4 a[92:95], v243, s[24:27], s30 offen offset:3072 sc1
  v_mfma_f32_16x16x32_bf16 v[48:51], a[184:187], a[0:3], 0
  ds_read_b64_tr_b16 a[168:169], v229 offset:32768
  v_mfma_f32_16x16x32_bf16 v[48:51], a[188:191], a[16:19], v[48:51]
  v_mfma_f32_16x16x32_bf16 v[52:55], a[188:191], a[20:23], 0
  ds_read_b64_tr_b16 a[170:171], v229 offset:33792
  v_mfma_f32_16x16x32_bf16 v[52:55], a[184:187], a[4:7], v[52:55]
  s_add_u32 s30, s30, 8192
  v_mfma_f32_16x16x32_bf16 v[56:59], a[184:187], a[8:11], 0
  ds_read_b64_tr_b16 a[172:173], v229 offset:40960
  v_mfma_f32_16x16x32_bf16 v[56:59], a[188:191], a[24:27], v[56:59]
  v_mfma_f32_16x16x32_bf16 v[60:63], a[188:191], a[28:31], 0
  ds_read_b64_tr_b16 a[174:175], v229 offset:41984
  v_mfma_f32_16x16x32_bf16 v[60:63], a[184:187], a[12:15], v[60:63]
  s_waitcnt lgkmcnt(4)
  buffer_load_dwordx4 a[96:99], v242, s[24:27], s30 offen offset:0 sc1
  v_mfma_f32_16x16x32_bf16 v[64:67], a[160:163], a[0:3], 0
  ds_read_b64_tr_b16 a[176:177], v230 offset:32768
  v_mfma_f32_16x16x32_bf16 v[64:67], a[164:167], a[16:19], v[64:67]
  buffer_load_dwordx4 a[100:103], v242, s[24:27], s30 offen offset:1024 sc1
  v_mfma_f32_16x16x32_bf16 v[68:71], a[164:167], a[20:23], 0
  ds_read_b64_tr_b16 a[178:179], v230 offset:33792
  v_mfma_f32_16x16x32_bf16 v[68:71], a[160:163], a[4:7], v[68:71]
  v_mfma_f32_16x16x32_bf16 v[72:75], a[160:163], a[8:11], 0
  ds_read_b64_tr_b16 a[180:181], v230 offset:40960
  v_mfma_f32_16x16x32_bf16 v[72:75], a[164:167], a[24:27], v[72:75]
  buffer_load_dwordx4 a[104:107], v242, s[24:27], s30 offen offset:2048 sc1
  v_mfma_f32_16x16x32_bf16 v[76:79], a[164:167], a[28:31], 0
  ds_read_b64_tr_b16 a[182:183], v230 offset:41984
  v_mfma_f32_16x16x32_bf16 v[76:79], a[160:163], a[12:15], v[76:79]
  s_waitcnt lgkmcnt(4)
  v_mfma_f32_16x16x32_bf16 v[80:83], a[168:171], a[0:3], 0
  ds_read_b64_tr_b16 a[184:185], v231 offset:32768
  v_mfma_f32_16x16x32_bf16 v[80:83], a[172:175], a[16:19], v[80:83]
  buffer_load_dwordx4 a[108:111], v242, s[24:27], s30 offen offset:3072 sc1
  v_mfma_f32_16x16x32_bf16 v[84:87], a[172:175], a[20:23], 0
  ds_read_b64_tr_b16 a[186:187], v231 offset:33792
  v_mfma_f32_16x16x32_bf16 v[84:87], a[168:171], a[4:7], v[84:87]
  buffer_load_dwordx4 a[112:115], v243, s[24:27], s30 offen offset:0 sc1
  v_mfma_f32_16x16x32_bf16 v[88:91], a[168:171], a[8:11], 0
  ds_read_b64_tr_b16 a[188:189], v231 offset:40960
  v_mfma_f32_16x16x32_bf16 v[88:91], a[172:175], a[24:27], v[88:91]
  s_barrier
  v_mfma_f32_16x16x32_bf16 v[92:95], a[172:175], a[28:31], 0
  ds_read_b64_tr_b16 a[190:191], v231 offset:41984
  v_mfma_f32_16x16x32_bf16 v[92:95], a[168:171], a[12:15], v[92:95]
  s_waitcnt lgkmcnt(4)
  buffer_load_dwordx4 a[116:119], v243, s[24:27], s30 offen offset:1024 sc1
  v_mfma_f32_16x16x32_bf16 v[96:99], a[176:179], a[0:3], 0
  ds_read_b64_tr_b16 a[160:161], v224 offset:49152
  v_mfma_f32_16x16x32_bf16 v[96:99], a[180:183], a[16:19], v[96:99]
  v_mfma_f32_16x16x32_bf16 v[100:103], a[180:183], a[20:23], 0
  ds_read_b64_tr_b16 a[162:163], v224 offset:50176
  v_mfma_f32_16x16x32_bf16 v[100:103], a[176:179], a[4:7], v[100:103]
  buffer_load_dwordx4 a[120:123], v243, s[24:27], s30 offen offset:2048 sc1
  v_mfma_f32_16x16x32_bf16 v[104:107], a[176:179], a[8:11], 0
  ds_read_b64_tr_b16 a[164:165], v224 offset:57344
  v_mfma_f32_16x16x32_bf16 v[104:107], a[180:183], a[24:27], v[104:107]
  buffer_load_dwordx4 a[124:127], v243, s[24:27], s30 offen offset:3072 sc1
  v_mfma_f32_16x16x32_bf16 v[108:111], a[180:183], a[28:31], 0
  ds_read_b64_tr_b16 a[166:167], v224 offset:58368
  v_mfma_f32_16x16x32_bf16 v[108:111], a[176:179], a[12:15], v[108:111]
  s_waitcnt lgkmcnt(4)
  v_mfma_f32_16x16x32_bf16 v[112:115], a[184:187], a[0:3], 0
  ds_read_b64_tr_b16 a[168:169], v225 offset:49152
  v_mfma_f32_16x16x32_bf16 v[112:115], a[188:191], a[16:19], v[112:115]
  s_add_u32 s30, s30, 8192
  v_mfma_f32_16x16x32_bf16 v[116:119], a[188:191], a[20:23], 0
  ds_read_b64_tr_b16 a[170:171], v225 offset:50176
  v_mfma_f32_16x16x32_bf16 v[116:119], a[184:187], a[4:7], v[116:119]
  v_mfma_f32_16x16x32_bf16 v[120:123], a[184:187], a[8:11], 0
  ds_read_b64_tr_b16 a[172:173], v225 offset:57344
  v_mfma_f32_16x16x32_bf16 v[120:123], a[188:191], a[24:27], v[120:123]
  v_mfma_f32_16x16x32_bf16 v[124:127], a[188:191], a[28:31], 0
  ds_read_b64_tr_b16 a[174:175], v225 offset:58368
  v_mfma_f32_16x16x32_bf16 v[124:127], a[184:187], a[12:15], v[124:127]
  s_waitcnt vmcnt(17) lgkmcnt(4)
  v_mfma_f32_16x16x32_bf16 v[0:3], a[160:163], a[32:35], v[0:3]
  ds_read_b64_tr_b16 a[176:177], v226 offset:49152
  v_mfma_f32_16x16x32_bf16 v[0:3], a[164:167], a[48:51], v[0:3]
  buffer_load_dwordx4 a[0:3], v242, s[24:27], s30 offen offset:0 sc1
  v_mfma_f32_16x16x32_bf16 v[4:7], a[164:167], a[52:55], v[4:7]
  ds_read_b64_tr_b16 a[178:179], v226 offset:50176
  v_mfma_f32_16x16x32_bf16 v[4:7], a[160:163], a[36:39], v[4:7]
  v_mfma_f32_16x16x32_bf16 v[8:11], a[160:163], a[40:43], v[8:11]
  ds_read_b64_tr_b16 a[180:181], v226 offset:57344
  s_add_u32 m0, s28, 16384
  v_mfma_f32_16x16x32_bf16 v[8:11], a[164:167], a[56:59], v[8:11]
  buffer_load_dwordx4 v238, s[20:23], s31 offen offset:0 lds
  v_mfma_f32_16x16x32_bf16 v[12:15], a[164:167], a[60:63], v[12:15]
  ds_read_b64_tr_b16 a[182:183], v226 offset:58368
  v_mfma_f32_16x16x32_bf16 v[12:15], a[160:163], a[44:47], v[12:15]
  s_waitcnt lgkmcnt(4)
  v_mfma_f32_16x16x32_bf16 v[16:19], a[168:171], a[32:35], v[16:19]
  ds_read_b64_tr_b16 a[184:185], v227 offset:49152
  v_mfma_f32_16x16x32_bf16 v[16:19], a[172:175], a[48:51], v[16:19]
  buffer_load_dwordx4 a[4:7], v242, s[24:27], s30 offen offset:1024 sc1
  v_mfma_f32_16x16x32_bf16 v[20:23], a[172:175], a[52:55], v[20:23]
  ds_read_b64_tr_b16 a[186:187], v227 offset:50176
  v_mfma_f32_16x16x32_bf16 v[20:23], a[168:171], a[36:39], v[20:23]
  v_mfma_f32_16x16x32_bf16 v[24:27], a[168:171], a[40:43], v[24:27]
  ds_read_b64_tr_b16 a[188:189], v227 offset:57344
  v_mfma_f32_16x16x32_bf16 v[24:27], a[172:175], a[56:59], v[24:27]
  v_mfma_f32_16x16x32_bf16 v[28:31], a[172:175], a[60:63], v[28:31]
  ds_read_b64_tr_b16 a[190:191], v227 offset:58368
  v_mfma_f32_16x16x32_bf16 v[28:31], a[168:171], a[44:47], v[28:31]
  s_waitcnt lgkmcnt(4)
  v_mfma_f32_16x16x32_bf16 v[32:35], a[176:179], a[32:35], v[32:35]
  ds_read_b64_tr_b16 a[160:161], v228 offset:49152
  v_mfma_f32_16x16x32_bf16 v[32:35], a[180:183], a[48:51], v[32:35]
  buffer_load_dwordx4 a[8:11], v242, s[24:27], s30 offen offset:2048 sc1
  v_mfma_f32_16x16x32_bf16 v[36:39], a[180:183], a[52:55], v[36:39]
  ds_read_b64_tr_b16 a[162:163], v228 offset:50176
  v_mfma_f32_16x16x32_bf16 v[36:39], a[176:179], a[36:39], v[36:39]
  v_mfma_f32_16x16x32_bf16 v[40:43], a[176:179], a[40:43], v[40:43]
  ds_read_b64_tr_b16 a[164:165], v228 offset:57344
  v_mfma_f32_16x16x32_bf16 v[40:43], a[180:183], a[56:59], v[40:43]
  buffer_load_dwordx4 v239, s[20:23], s31 offen offset:1024 lds
  v_mfma_f32_16x16x32_bf16 v[44:47], a[180:183], a[60:63], v[44:47]
  ds_read_b64_tr_b16 a[166:167], v228 offset:58368
  v_mfma_f32_16x16x32_bf16 v[44:47], a[176:179], a[44:47], v[44:47]
  s_waitcnt lgkmcnt(4)
  v_mfma_f32_16x16x32_bf16 v[48:51], a[184:187], a[32:35], v[48:51]
  ds_read_b64_tr_b16 a[168:169], v229 offset:49152
  v_mfma_f32_16x16x32_bf16 v[48:51], a[188:191], a[48:51], v[48:51]
  buffer_load_dwordx4 a[12:15], v242, s[24:27], s30 offen offset:3072 sc1
  v_mfma_f32_16x16x32_bf16 v[52:55], a[188:191], a[52:55], v[52:55]
  ds_read_b64_tr_b16 a[170:171], v229 offset:50176
  v_mfma_f32_16x16x32_bf16 v[52:55], a[184:187], a[36:39], v[52:55]
  v_mfma_f32_16x16x32_bf16 v[56:59], a[184:187], a[40:43], v[56:59]
  ds_read_b64_tr_b16 a[172:173], v229 offset:57344
  v_mfma_f32_16x16x32_bf16 v[56:59], a[188:191], a[56:59], v[56:59]
  v_mfma_f32_16x16x32_bf16 v[60:63], a[188:191], a[60:63], v[60:63]
  ds_read_b64_tr_b16 a[174:175], v229 offset:58368
  v_mfma_f32_16x16x32_bf16 v[60:63], a[184:187], a[44:47], v[60:63]
  s_waitcnt lgkmcnt(4)
  v_mfma_f32_16x16x32_bf16 v[64:67], a[160:163], a[32:35], v[64:67]
  ds_read_b64_tr_b16 a[176:177], v230 offset:49152
  v_mfma_f32_16x16x32_bf16 v[64:67], a[164:167], a[48:51], v[64:67]
  buffer_load_dwordx4 a[16:19], v243, s[24:27], s30 offen offset:0 sc1
  v_mfma_f32_16x16x32_bf16 v[68:71], a[164:167], a[52:55], v[68:71]
  ds_read_b64_tr_b16 a[178:179], v230 offset:50176
  v_mfma_f32_16x16x32_bf16 v[68:71], a[160:163], a[36:39], v[68:71]
  v_mfma_f32_16x16x32_bf16 v[72:75], a[160:163], a[40:43], v[72:75]
  ds_read_b64_tr_b16 a[180:181], v230 offset:57344
  v_mfma_f32_16x16x32_bf16 v[72:75], a[164:167], a[56:59], v[72:75]
  buffer_load_dwordx4 v240, s[20:23], s31 offen offset:2048 lds
  v_mfma_f32_16x16x32_bf16 v[76:79], a[164:167], a[60:63], v[76:79]
  ds_read_b64_tr_b16 a[182:183], v230 offset:58368
  v_mfma_f32_16x16x32_bf16 v[76:79], a[160:163], a[44:47], v[76:79]
  s_waitcnt lgkmcnt(4)
  v_mfma_f32_16x16x32_bf16 v[80:83], a[168:171], a[32:35], v[80:83]
  ds_read_b64_tr_b16 a[184:185], v231 offset:49152
  v_mfma_f32_16x16x32_bf16 v[80:83], a[172:175], a[48:51], v[80:83]
  buffer_load_dwordx4 a[20:23], v243, s[24:27], s30 offen offset:1024 sc1
  v_mfma_f32_16x16x32_bf16 v[84:87], a[172:175], a[52:55], v[84:87]
  ds_read_b64_tr_b16 a[186:187], v231 offset:50176
  v_mfma_f32_16x16x32_bf16 v[84:87], a[168:171], a[36:39], v[84:87]
  v_mfma_f32_16x16x32_bf16 v[88:91], a[168:171], a[40:43], v[88:91]
  ds_read_b64_tr_b16 a[188:189], v231 offset:57344
  v_mfma_f32_16x16x32_bf16 v[88:91], a[172:175], a[56:59], v[88:91]
  s_barrier
  v_mfma_f32_16x16x32_bf16 v[92:95], a[172:175], a[60:63], v[92:95]
  ds_read_b64_tr_b16 a[190:191], v231 offset:58368
  v_mfma_f32_16x16x32_bf16 v[92:95], a[168:171], a[44:47], v[92:95]
  s_waitcnt lgkmcnt(4)
  v_mfma_f32_16x16x32_bf16 v[96:99], a[176:179], a[32:35], v[96:99]
  ds_read_b64_tr_b16 a[160:161], v148 offset:32768
  v_mfma_f32_16x16x32_bf16 v[96:99], a[180:183], a[48:51], v[96:99]
  buffer_load_dwordx4 a[24:27], v243, s[24:27], s30 offen offset:2048 sc1
  v_mfma_f32_16x16x32_bf16 v[100:103], a[180:183], a[52:55], v[100:103]
  ds_read_b64_tr_b16 a[162:163], v148 offset:33792
  v_mfma_f32_16x16x32_bf16 v[100:103], a[176:179], a[36:39], v[100:103]
  v_mfma_f32_16x16x32_bf16 v[104:107], a[176:179], a[40:43], v[104:107]
  ds_read_b64_tr_b16 a[164:165], v148 offset:40960
  v_mfma_f32_16x16x32_bf16 v[104:107], a[180:183], a[56:59], v[104:107]
  buffer_load_dwordx4 v241, s[20:23], s31 offen offset:3072 lds
  s_add_u32 s31, s31, 0x80000
  v_mfma_f32_16x16x32_bf16 v[108:111], a[180:183], a[60:63], v[108:111]
  ds_read_b64_tr_b16 a[166:167], v148 offset:41984
  v_mfma_f32_16x16x32_bf16 v[108:111], a[176:179], a[44:47], v[108:111]
  s_waitcnt lgkmcnt(4)
  v_mfma_f32_16x16x32_bf16 v[112:115], a[184:187], a[32:35], v[112:115]
  ds_read_b64_tr_b16 a[168:169], v149 offset:32768
  v_mfma_f32_16x16x32_bf16 v[112:115], a[188:191], a[48:51], v[112:115]
  buffer_load_dwordx4 a[28:31], v243, s[24:27], s30 offen offset:3072 sc1
  s_add_u32 s30, s30, 8192
  v_mfma_f32_16x16x32_bf16 v[116:119], a[188:191], a[52:55], v[116:119]
  ds_read_b64_tr_b16 a[170:171], v149 offset:33792
  v_mfma_f32_16x16x32_bf16 v[116:119], a[184:187], a[36:39], v[116:119]
  v_mfma_f32_16x16x32_bf16 v[120:123], a[184:187], a[40:43], v[120:123]
  ds_read_b64_tr_b16 a[172:173], v149 offset:40960
  v_mfma_f32_16x16x32_bf16 v[120:123], a[188:191], a[56:59], v[120:123]
  v_mfma_f32_16x16x32_bf16 v[124:127], a[188:191], a[60:63], v[124:127]
  ds_read_b64_tr_b16 a[174:175], v149 offset:41984
  v_mfma_f32_16x16x32_bf16 v[124:127], a[184:187], a[44:47], v[124:127]
  s_waitcnt vmcnt(20) lgkmcnt(4)
  v_xor_b32 v136, s55, v136
  v_xor_b32 v137, s55, v137
  v_xor_b32 v138, s55, v138
  v_xor_b32 v139, s55, v139
  v_or3_b32 v136, v136, v137, v138
  v_or_b32 v136, v136, v139
  v_cmp_ne_u32 vcc, 0, v136
  s_nop 0
  s_cbranch_vccz front_keys
  s_mov_b32 s54, 32768
front_all:
  s_sleep 2
  buffer_load_dwordx4 v[136:139], v140, s[24:27], s58 offen sc1
  s_waitcnt vmcnt(0)
  v_xor_b32 v136, s55, v136
  v_xor_b32 v137, s55, v137
  v_xor_b32 v138, s55, v138
  v_xor_b32 v139, s55, v139
  v_or3_b32 v136, v136, v137, v138
  v_or_b32 v136, v136, v139
  v_cmp_ne_u32 vcc, 0, v136
  s_nop 0
  s_cbranch_vccz front_keys
  s_sub_u32 s54, s54, 1
  s_cmp_lg_u32 s54, 0
  s_cbranch_scc1 front_all
front_keys:
  s_lshl_b32 s35, s3, 11
  s_add_u32 s35, s35, 2621440
  buffer_load_dwordx4 v[128:131], v242, s[24:27], s35 offen sc1
  buffer_load_dwordx4 v[132:135], v242, s[24:27], s35 offen offset:1024 sc1
  v_mfma_f32_16x16x32_bf16 v[0:3], a[160:163], a[64:67], v[0:3]
  ds_read_b64_tr_b16 a[176:177], v150 offset:32768
  s_add_u32 s59, s59, 1
  s_or_b32 s54, s2, s3
  s_min_u32 s54, s54, 1
  v_mfma_f32_16x16x32_bf16 v[0:3], a[164:167], a[80:83], v[0:3]
  buffer_load_dwordx4 a[32:35], v242, s[24:27], s30 offen offset:0 sc1
  s_lshl_b32 s54, s54, 28
  v_mfma_f32_16x16x32_bf16 v[4:7], a[164:167], a[84:87], v[4:7]
  ds_read_b64_tr_b16 a[178:179], v150 offset:33792
  v_lshlrev_b32 v137, 22, v242
  v_mfma_f32_16x16x32_bf16 v[4:7], a[160:163], a[68:71], v[4:7]
  v_or_b32 v137, s54, v137
  v_mov_b32 v136, s59
  v_mfma_f32_16x16x32_bf16 v[8:11], a[160:163], a[72:75], v[8:11]
  ds_read_b64_tr_b16 a[180:181], v150 offset:40960
  s_add_u32 m0, s28, 0
  s_mov_b32 s58, 2830336
  buffer_store_dword v136, v137, s[24:27], s58 offen sc1
  v_mfma_f32_16x16x32_bf16 v[8:11], a[164:167], a[88:91], v[8:11]
  buffer_load_dwordx4 v238, s[20:23], s31 offen offset:0 lds
  v_mfma_f32_16x16x32_bf16 v[12:15], a[164:167], a[92:95], v[12:15]
  ds_read_b64_tr_b16 a[182:183], v150 offset:41984
  v_mfma_f32_16x16x32_bf16 v[12:15], a[160:163], a[76:79], v[12:15]
  s_waitcnt lgkmcnt(4)
  v_mfma_f32_16x16x32_bf16 v[16:19], a[168:171], a[64:67], v[16:19]
  ds_read_b64_tr_b16 a[184:185], v151 offset:32768
  v_mfma_f32_16x16x32_bf16 v[16:19], a[172:175], a[80:83], v[16:19]
  buffer_load_dwordx4 a[36:39], v242, s[24:27], s30 offen offset:1024 sc1
  v_mfma_f32_16x16x32_bf16 v[20:23], a[172:175], a[84:87], v[20:23]
  ds_read_b64_tr_b16 a[186:187], v151 offset:33792
  v_mfma_f32_16x16x32_bf16 v[20:23], a[168:171], a[68:71], v[20:23]
  v_mfma_f32_16x16x32_bf16 v[24:27], a[168:171], a[72:75], v[24:27]
  ds_read_b64_tr_b16 a[188:189], v151 offset:40960
  v_mfma_f32_16x16x32_bf16 v[24:27], a[172:175], a[88:91], v[24:27]
  v_mfma_f32_16x16x32_bf16 v[28:31], a[172:175], a[92:95], v[28:31]
  ds_read_b64_tr_b16 a[190:191], v151 offset:41984
  v_mfma_f32_16x16x32_bf16 v[28:31], a[168:171], a[76:79], v[28:31]
  s_waitcnt lgkmcnt(4)
  v_mfma_f32_16x16x32_bf16 v[32:35], a[176:179], a[64:67], v[32:35]
  ds_read_b64_tr_b16 a[160:161], v152 offset:32768
  v_mfma_f32_16x16x32_bf16 v[32:35], a[180:183], a[80:83], v[32:35]
  buffer_load_dwordx4 a[40:43], v242, s[24:27], s30 offen offset:2048 sc1
  v_mfma_f32_16x16x32_bf16 v[36:39], a[180:183], a[84:87], v[36:39]
  ds_read_b64_tr_b16 a[162:163], v152 offset:33792
  v_mfma_f32_16x16x32_bf16 v[36:39], a[176:179], a[68:71], v[36:39]
  v_mfma_f32_16x16x32_bf16 v[40:43], a[176:179], a[72:75], v[40:43]
  ds_read_b64_tr_b16 a[164:165], v152 offset:40960
  v_mfma_f32_16x16x32_bf16 v[40:43], a[180:183], a[88:91], v[40:43]
  buffer_load_dwordx4 v239, s[20:23], s31 offen offset:1024 lds
  v_mfma_f32_16x16x32_bf16 v[44:47], a[180:183], a[92:95], v[44:47]
  ds_read_b64_tr_b16 a[166:167], v152 offset:41984
  v_mfma_f32_16x16x32_bf16 v[44:47], a[176:179], a[76:79], v[44:47]
  s_waitcnt lgkmcnt(4)
  v_mfma_f32_16x16x32_bf16 v[48:51], a[184:187], a[64:67], v[48:51]
  ds_read_b64_tr_b16 a[168:169], v153 offset:32768
  v_mfma_f32_16x16x32_bf16 v[48:51], a[188:191], a[80:83], v[48:51]
  buffer_load_dwordx4 a[44:47], v242, s[24:27], s30 offen offset:3072 sc1
  v_mfma_f32_16x16x32_bf16 v[52:55], a[188:191], a[84:87], v[52:55]
  ds_read_b64_tr_b16 a[170:171], v153 offset:33792
  v_mfma_f32_16x16x32_bf16 v[52:55], a[184:187], a[68:71], v[52:55]
  v_mfma_f32_16x16x32_bf16 v[56:59], a[184:187], a[72:75], v[56:59]
  ds_read_b64_tr_b16 a[172:173], v153 offset:40960
  v_mfma_f32_16x16x32_bf16 v[56:59], a[188:191], a[88:91], v[56:59]
  v_mfma_f32_16x16x32_bf16 v[60:63], a[188:191], a[92:95], v[60:63]
  ds_read_b64_tr_b16 a[174:175], v153 offset:41984
  v_mfma_f32_16x16x32_bf16 v[60:63], a[184:187], a[76:79], v[60:63]
  s_waitcnt lgkmcnt(4)
  v_mfma_f32_16x16x32_bf16 v[64:67], a[160:163], a[64:67], v[64:67]
  ds_read_b64_tr_b16 a[176:177], v154 offset:32768
  v_mfma_f32_16x16x32_bf16 v[64:67], a[164:167], a[80:83], v[64:67]
  buffer_load_dwordx4 a[48:51], v243, s[24:27], s30 offen offset:0 sc1
  v_mfma_f32_16x16x32_bf16 v[68:71], a[164:167], a[84:87], v[68:71]
  ds_read_b64_tr_b16 a[178:179], v154 offset:33792
  v_mfma_f32_16x16x32_bf16 v[68:71], a[160:163], a[68:71], v[68:71]
  v_mfma_f32_16x16x32_bf16 v[72:75], a[160:163], a[72:75], v[72:75]
  ds_read_b64_tr_b16 a[180:181], v154 offset:40960
  v_mfma_f32_16x16x32_bf16 v[72:75], a[164:167], a[88:91], v[72:75]
  buffer_load_dwordx4 v240, s[20:23], s31 offen offset:2048 lds
  v_mfma_f32_16x16x32_bf16 v[76:79], a[164:167], a[92:95], v[76:79]
  ds_read_b64_tr_b16 a[182:183], v154 offset:41984
  v_mfma_f32_16x16x32_bf16 v[76:79], a[160:163], a[76:79], v[76:79]
  s_waitcnt lgkmcnt(4)
  v_mfma_f32_16x16x32_bf16 v[80:83], a[168:171], a[64:67], v[80:83]
  ds_read_b64_tr_b16 a[184:185], v155 offset:32768
  v_mfma_f32_16x16x32_bf16 v[80:83], a[172:175], a[80:83], v[80:83]
  buffer_load_dwordx4 a[52:55], v243, s[24:27], s30 offen offset:1024 sc1
  v_mfma_f32_16x16x32_bf16 v[84:87], a[172:175], a[84:87], v[84:87]
  ds_read_b64_tr_b16 a[186:187], v155 offset:33792
  v_mfma_f32_16x16x32_bf16 v[84:87], a[168:171], a[68:71], v[84:87]
  v_mfma_f32_16x16x32_bf16 v[88:91], a[168:171], a[72:75], v[88:91]
  ds_read_b64_tr_b16 a[188:189], v155 offset:40960
  v_mfma_f32_16x16x32_bf16 v[88:91], a[172:175], a[88:91], v[88:91]
  s_barrier
  v_mfma_f32_16x16x32_bf16 v[92:95], a[172:175], a[92:95], v[92:95]
  ds_read_b64_tr_b16 a[190:191], v155 offset:41984
  v_mfma_f32_16x16x32_bf16 v[92:95], a[168:171], a[76:79], v[92:95]
  s_waitcnt lgkmcnt(4)
  v_mfma_f32_16x16x32_bf16 v[96:99], a[176:179], a[64:67], v[96:99]
  ds_read_b64_tr_b16 a[160:161], v148 offset:49152
  v_mfma_f32_16x16x32_bf16 v[96:99], a[180:183], a[80:83], v[96:99]
  buffer_load_dwordx4 a[56:59], v243, s[24:27], s30 offen offset:2048 sc1
  v_mfma_f32_16x16x32_bf16 v[100:103], a[180:183], a[84:87], v[100:103]
  ds_read_b64_tr_b16 a[162:163], v148 offset:50176
  v_mfma_f32_16x16x32_bf16 v[100:103], a[176:179], a[68:71], v[100:103]
  v_mfma_f32_16x16x32_bf16 v[104:107], a[176:179], a[72:75], v[104:107]
  ds_read_b64_tr_b16 a[164:165], v148 offset:57344
  v_mfma_f32_16x16x32_bf16 v[104:107], a[180:183], a[88:91], v[104:107]
  buffer_load_dwordx4 v241, s[20:23], s31 offen offset:3072 lds
  s_add_u32 s31, s31, 0x80000
  v_mfma_f32_16x16x32_bf16 v[108:111], a[180:183], a[92:95], v[108:111]
  ds_read_b64_tr_b16 a[166:167], v148 offset:58368
  v_mfma_f32_16x16x32_bf16 v[108:111], a[176:179], a[76:79], v[108:111]
  s_waitcnt lgkmcnt(4)
  v_mfma_f32_16x16x32_bf16 v[112:115], a[184:187], a[64:67], v[112:115]
  ds_read_b64_tr_b16 a[168:169], v149 offset:49152
  v_mfma_f32_16x16x32_bf16 v[112:115], a[188:191], a[80:83], v[112:115]
  buffer_load_dwordx4 a[60:63], v243, s[24:27], s30 offen offset:3072 sc1
  s_add_u32 s30, s30, 8192
  v_mfma_f32_16x16x32_bf16 v[116:119], a[188:191], a[84:87], v[116:119]
  ds_read_b64_tr_b16 a[170:171], v149 offset:50176
  v_mfma_f32_16x16x32_bf16 v[116:119], a[184:187], a[68:71], v[116:119]
  v_mfma_f32_16x16x32_bf16 v[120:123], a[184:187], a[72:75], v[120:123]
  ds_read_b64_tr_b16 a[172:173], v149 offset:57344
  v_mfma_f32_16x16x32_bf16 v[120:123], a[188:191], a[88:91], v[120:123]
  v_mfma_f32_16x16x32_bf16 v[124:127], a[188:191], a[92:95], v[124:127]
  ds_read_b64_tr_b16 a[174:175], v149 offset:58368
  v_mfma_f32_16x16x32_bf16 v[124:127], a[184:187], a[76:79], v[124:127]
  s_waitcnt vmcnt(27) lgkmcnt(4)
  v_mfma_f32_16x16x32_bf16 v[0:3], a[160:163], a[96:99], v[0:3]
  ds_read_b64_tr_b16 a[176:177], v150 offset:49152
  v_mfma_f32_16x16x32_bf16 v[0:3], a[164:167], a[112:115], v[0:3]
  buffer_load_dwordx4 a[64:67], v242, s[24:27], s30 offen offset:0 sc1
  v_mfma_f32_16x16x32_bf16 v[4:7], a[164:167], a[116:119], v[4:7]
  ds_read_b64_tr_b16 a[178:179], v150 offset:50176
  v_mfma_f32_16x16x32_bf16 v[4:7], a[160:163], a[100:103], v[4:7]
  v_mfma_f32_16x16x32_bf16 v[8:11], a[160:163], a[104:107], v[8:11]
  ds_read_b64_tr_b16 a[180:181], v150 offset:57344
  s_add_u32 m0, s28, 65536
  v_mfma_f32_16x16x32_bf16 v[8:11], a[164:167], a[120:123], v[8:11]
  buffer_load_dwordx4 v238, s[20:23], s31 offen offset:0 lds
  v_mfma_f32_16x16x32_bf16 v[12:15], a[164:167], a[124:127], v[12:15]
  ds_read_b64_tr_b16 a[182:183], v150 offset:58368
  v_mfma_f32_16x16x32_bf16 v[12:15], a[160:163], a[108:111], v[12:15]
  s_waitcnt lgkmcnt(4)
  v_mfma_f32_16x16x32_bf16 v[16:19], a[168:171], a[96:99], v[16:19]
  ds_read_b64_tr_b16 a[184:185], v151 offset:49152
  v_mfma_f32_16x16x32_bf16 v[16:19], a[172:175], a[112:115], v[16:19]
  buffer_load_dwordx4 a[68:71], v242, s[24:27], s30 offen offset:1024 sc1
  v_mfma_f32_16x16x32_bf16 v[20:23], a[172:175], a[116:119], v[20:23]
  ds_read_b64_tr_b16 a[186:187], v151 offset:50176
  v_mfma_f32_16x16x32_bf16 v[20:23], a[168:171], a[100:103], v[20:23]
  v_mfma_f32_16x16x32_bf16 v[24:27], a[168:171], a[104:107], v[24:27]
  ds_read_b64_tr_b16 a[188:189], v151 offset:57344
  v_mfma_f32_16x16x32_bf16 v[24:27], a[172:175], a[120:123], v[24:27]
  v_mfma_f32_16x16x32_bf16 v[28:31], a[172:175], a[124:127], v[28:31]
  ds_read_b64_tr_b16 a[190:191], v151 offset:58368
  v_mfma_f32_16x16x32_bf16 v[28:31], a[168:171], a[108:111], v[28:31]
  s_waitcnt lgkmcnt(4)
  v_mfma_f32_16x16x32_bf16 v[32:35], a[176:179], a[96:99], v[32:35]
  ds_read_b64_tr_b16 a[160:161], v152 offset:49152
  v_mfma_f32_16x16x32_bf16 v[32:35], a[180:183], a[112:115], v[32:35]
  buffer_load_dwordx4 a[72:75], v242, s[24:27], s30 offen offset:2048 sc1
  v_mfma_f32_16x16x32_bf16 v[36:39], a[180:183], a[116:119], v[36:39]
  ds_read_b64_tr_b16 a[162:163], v152 offset:50176
  v_mfma_f32_16x16x32_bf16 v[36:39], a[176:179], a[100:103], v[36:39]
  v_mfma_f32_16x16x32_bf16 v[40:43], a[176:179], a[104:107], v[40:43]
  ds_read_b64_tr_b16 a[164:165], v152 offset:57344
  v_mfma_f32_16x16x32_bf16 v[40:43], a[180:183], a[120:123], v[40:43]
  buffer_load_dwordx4 v239, s[20:23], s31 offen offset:1024 lds
  v_mfma_f32_16x16x32_bf16 v[44:47], a[180:183], a[124:127], v[44:47]
  ds_read_b64_tr_b16 a[166:167], v152 offset:58368
  v_mfma_f32_16x16x32_bf16 v[44:47], a[176:179], a[108:111], v[44:47]
  s_waitcnt lgkmcnt(4)
  v_mfma_f32_16x16x32_bf16 v[48:51], a[184:187], a[96:99], v[48:51]
  ds_read_b64_tr_b16 a[168:169], v153 offset:49152
  v_mfma_f32_16x16x32_bf16 v[48:51], a[188:191], a[112:115], v[48:51]
  buffer_load_dwordx4 a[76:79], v242, s[24:27], s30 offen offset:3072 sc1
  v_mfma_f32_16x16x32_bf16 v[52:55], a[188:191], a[116:119], v[52:55]
  ds_read_b64_tr_b16 a[170:171], v153 offset:50176
  v_mfma_f32_16x16x32_bf16 v[52:55], a[184:187], a[100:103], v[52:55]
  v_mfma_f32_16x16x32_bf16 v[56:59], a[184:187], a[104:107], v[56:59]
  ds_read_b64_tr_b16 a[172:173], v153 offset:57344
  v_mfma_f32_16x16x32_bf16 v[56:59], a[188:191], a[120:123], v[56:59]
  v_mfma_f32_16x16x32_bf16 v[60:63], a[188:191], a[124:127], v[60:63]
  ds_read_b64_tr_b16 a[174:175], v153 offset:58368
  v_mfma_f32_16x16x32_bf16 v[60:63], a[184:187], a[108:111], v[60:63]
  s_waitcnt lgkmcnt(4)
  v_mfma_f32_16x16x32_bf16 v[64:67], a[160:163], a[96:99], v[64:67]
  ds_read_b64_tr_b16 a[176:177], v154 offset:49152
  v_mfma_f32_16x16x32_bf16 v[64:67], a[164:167], a[112:115], v[64:67]
  buffer_load_dwordx4 a[80:83], v243, s[24:27], s30 offen offset:0 sc1
  v_mfma_f32_16x16x32_bf16 v[68:71], a[164:167], a[116:119], v[68:71]
  ds_read_b64_tr_b16 a[178:179], v154 offset:50176
  v_mfma_f32_16x16x32_bf16 v[68:71], a[160:163], a[100:103], v[68:71]
  v_mfma_f32_16x16x32_bf16 v[72:75], a[160:163], a[104:107], v[72:75]
  ds_read_b64_tr_b16 a[180:181], v154 offset:57344
  v_mfma_f32_16x16x32_bf16 v[72:75], a[164:167], a[120:123], v[72:75]
  buffer_load_dwordx4 v240, s[20:23], s31 offen offset:2048 lds
  v_mfma_f32_16x16x32_bf16 v[76:79], a[164:167], a[124:127], v[76:79]
  ds_read_b64_tr_b16 a[182:183], v154 offset:58368
  v_mfma_f32_16x16x32_bf16 v[76:79], a[160:163], a[108:111], v[76:79]
  s_waitcnt lgkmcnt(4)
  v_mfma_f32_16x16x32_bf16 v[80:83], a[168:171], a[96:99], v[80:83]
  ds_read_b64_tr_b16 a[184:185], v155 offset:49152
  v_mfma_f32_16x16x32_bf16 v[80:83], a[172:175], a[112:115], v[80:83]
  buffer_load_dwordx4 a[84:87], v243, s[24:27], s30 offen offset:1024 sc1
  v_mfma_f32_16x16x32_bf16 v[84:87], a[172:175], a[116:119], v[84:87]
  ds_read_b64_tr_b16 a[186:187], v155 offset:50176
  v_mfma_f32_16x16x32_bf16 v[84:87], a[168:171], a[100:103], v[84:87]
  s_waitcnt vmcnt(25)
  v_mfma_f32_16x16x32_bf16 v[88:91], a[168:171], a[104:107], v[88:91]
  ds_read_b64_tr_b16 a[188:189], v155 offset:57344
  v_mfma_f32_16x16x32_bf16 v[88:91], a[172:175], a[120:123], v[88:91]
  s_barrier
  v_mfma_f32_16x16x32_bf16 v[92:95], a[172:175], a[124:127], v[92:95]
  ds_read_b64_tr_b16 a[190:191], v155 offset:58368
  v_mfma_f32_16x16x32_bf16 v[92:95], a[168:171], a[108:111], v[92:95]
  s_waitcnt lgkmcnt(4)
  v_mfma_f32_16x16x32_bf16 v[96:99], a[176:179], a[96:99], v[96:99]
  ds_read_b64_tr_b16 a[160:161], v148 offset:16384
  v_mfma_f32_16x16x32_bf16 v[96:99], a[180:183], a[112:115], v[96:99]
  buffer_load_dwordx4 a[88:91], v243, s[24:27], s30 offen offset:2048 sc1
  v_mfma_f32_16x16x32_bf16 v[100:103], a[180:183], a[116:119], v[100:103]
  ds_read_b64_tr_b16 a[162:163], v148 offset:17408
  v_mfma_f32_16x16x32_bf16 v[100:103], a[176:179], a[100:103], v[100:103]
  v_mfma_f32_16x16x32_bf16 v[104:107], a[176:179], a[104:107], v[104:107]
  ds_read_b64_tr_b16 a[164:165], v148 offset:24576
  v_mfma_f32_16x16x32_bf16 v[104:107], a[180:183], a[120:123], v[104:107]
  buffer_load_dwordx4 v241, s[20:23], s31 offen offset:3072 lds
  s_add_u32 s31, s31, 0x80000
  v_mfma_f32_16x16x32_bf16 v[108:111], a[180:183], a[124:127], v[108:111]
  ds_read_b64_tr_b16 a[166:167], v148 offset:25600
  v_mfma_f32_16x16x32_bf16 v[108:111], a[176:179], a[108:111], v[108:111]
  s_waitcnt lgkmcnt(4)
  v_mfma_f32_16x16x32_bf16 v[112:115], a[184:187], a[96:99], v[112:115]
  ds_read_b64_tr_b16 a[168:169], v149 offset:16384
  v_mfma_f32_16x16x32_bf16 v[112:115], a[188:191], a[112:115], v[112:115]
  buffer_load_dwordx4 a[92:95], v243, s[24:27], s30 offen offset:3072 sc1
  s_add_u32 s30, s30, 8192
  v_mfma_f32_16x16x32_bf16 v[116:119], a[188:191], a[116:119], v[116:119]
  ds_read_b64_tr_b16 a[170:171], v149 offset:17408
  v_mfma_f32_16x16x32_bf16 v[116:119], a[184:187], a[100:103], v[116:119]
  v_mfma_f32_16x16x32_bf16 v[120:123], a[184:187], a[104:107], v[120:123]
  ds_read_b64_tr_b16 a[172:173], v149 offset:24576
  v_mfma_f32_16x16x32_bf16 v[120:123], a[188:191], a[120:123], v[120:123]
  v_mfma_f32_16x16x32_bf16 v[124:127], a[188:191], a[124:127], v[124:127]
  ds_read_b64_tr_b16 a[174:175], v149 offset:25600
  v_mfma_f32_16x16x32_bf16 v[124:127], a[184:187], a[108:111], v[124:127]
  s_waitcnt vmcnt(27) lgkmcnt(4)
  v_mfma_f32_16x16x32_bf16 v[0:3], a[160:163], a[0:3], v[0:3]
  ds_read_b64_tr_b16 a[176:177], v150 offset:16384
  s_waitcnt vmcnt(25)
  v_mov_b32 v136, -1
  v_mfma_f32_16x16x32_bf16 v[0:3], a[164:167], a[16:19], v[0:3]
  buffer_load_dwordx4 a[96:99], v242, s[24:27], s30 offen offset:0 sc1
  v_mfma_f32_16x16x32_bf16 v[4:7], a[164:167], a[20:23], v[4:7]
  ds_read_b64_tr_b16 a[178:179], v150 offset:17408
  v_sub_u32 v139, v136, v128
  v_mfma_f32_16x16x32_bf16 v[4:7], a[160:163], a[4:7], v[4:7]
  v_sub_u32 v140, v136, v129
  v_min_u32 v138, v139, v140
  v_mfma_f32_16x16x32_bf16 v[8:11], a[160:163], a[8:11], v[8:11]
  ds_read_b64_tr_b16 a[180:181], v150 offset:24576
  s_add_u32 m0, s28, 81920
  v_sub_u32 v141, v136, v130
  v_mfma_f32_16x16x32_bf16 v[8:11], a[164:167], a[24:27], v[8:11]
  buffer_load_dwordx4 v238, s[20:23], s31 offen offset:0 lds
  v_mfma_f32_16x16x32_bf16 v[12:15], a[164:167], a[28:31], v[12:15]
  ds_read_b64_tr_b16 a[182:183], v150 offset:25600
  v_sub_u32 v142, v136, v131
  v_mfma_f32_16x16x32_bf16 v[12:15], a[160:163], a[12:15], v[12:15]
  s_waitcnt lgkmcnt(4)
  v_min3_u32 v138, v138, v141, v142
  v_sub_u32 v139, v136, v132
  v_mfma_f32_16x16x32_bf16 v[16:19], a[168:171], a[0:3], v[16:19]
  ds_read_b64_tr_b16 a[184:185], v151 offset:16384
  v_sub_u32 v140, v136, v133
  v_mfma_f32_16x16x32_bf16 v[16:19], a[172:175], a[16:19], v[16:19]
  buffer_load_dwordx4 a[100:103], v242, s[24:27], s30 offen offset:1024 sc1
  v_mfma_f32_16x16x32_bf16 v[20:23], a[172:175], a[20:23], v[20:23]
  ds_read_b64_tr_b16 a[186:187], v151 offset:17408
  v_min3_u32 v138, v138, v139, v140
  v_mfma_f32_16x16x32_bf16 v[20:23], a[168:171], a[4:7], v[20:23]
  v_sub_u32 v141, v136, v134
  v_sub_u32 v142, v136, v135
  v_mfma_f32_16x16x32_bf16 v[24:27], a[168:171], a[8:11], v[24:27]
  ds_read_b64_tr_b16 a[188:189], v151 offset:24576
  v_min3_u32 v138, v138, v141, v142
  v_mfma_f32_16x16x32_bf16 v[24:27], a[172:175], a[24:27], v[24:27]
  v_mfma_f32_16x16x32_bf16 v[28:31], a[172:175], a[28:31], v[28:31]
  ds_read_b64_tr_b16 a[190:191], v151 offset:25600
  v_min_u32_dpp v138, v138, v138 row_ror:8 row_mask:0xf bank_mask:0xf
  v_mfma_f32_16x16x32_bf16 v[28:31], a[168:171], a[12:15], v[28:31]
  s_waitcnt lgkmcnt(4)
  v_min_u32_dpp v138, v138, v138 row_ror:4 row_mask:0xf bank_mask:0xf
  v_mfma_f32_16x16x32_bf16 v[32:35], a[176:179], a[0:3], v[32:35]
  ds_read_b64_tr_b16 a[160:161], v152 offset:16384
  v_min_u32_dpp v138, v138, v138 row_ror:2 row_mask:0xf bank_mask:0xf
  v_mfma_f32_16x16x32_bf16 v[32:35], a[180:183], a[16:19], v[32:35]
  buffer_load_dwordx4 a[104:107], v242, s[24:27], s30 offen offset:2048 sc1
  v_mfma_f32_16x16x32_bf16 v[36:39], a[180:183], a[20:23], v[36:39]
  ds_read_b64_tr_b16 a[162:163], v152 offset:17408
  v_min_u32_dpp v138, v138, v138 row_ror:1 row_mask:0xf bank_mask:0xf
  v_mfma_f32_16x16x32_bf16 v[36:39], a[176:179], a[4:7], v[36:39]
  v_sub_u32 v137, v136, v138
  v_add_u32 v136, -1, v137
  v_mfma_f32_16x16x32_bf16 v[40:43], a[176:179], a[8:11], v[40:43]
  ds_read_b64_tr_b16 a[164:165], v152 offset:24576
  v_sub_u32 v139, v136, v128
  v_mfma_f32_16x16x32_bf16 v[40:43], a[180:183], a[24:27], v[40:43]
  buffer_load_dwordx4 v239, s[20:23], s31 offen offset:1024 lds
  v_mfma_f32_16x16x32_bf16 v[44:47], a[180:183], a[28:31], v[44:47]
  ds_read_b64_tr_b16 a[166:167], v152 offset:25600
  v_mov_b32_dpp v144, v137 quad_perm:[0,1,2,3] row_mask:0xf bank_mask:0x1
  v_mfma_f32_16x16x32_bf16 v[44:47], a[176:179], a[12:15], v[44:47]
  s_waitcnt lgkmcnt(4)
  v_sub_u32 v140, v136, v129
  v_min_u32 v138, v139, v140
  v_mfma_f32_16x16x32_bf16 v[48:51], a[184:187], a[0:3], v[48:51]
  ds_read_b64_tr_b16 a[168:169], v153 offset:16384
  v_sub_u32 v141, v136, v130
  v_mfma_f32_16x16x32_bf16 v[48:51], a[188:191], a[16:19], v[48:51]
  buffer_load_dwordx4 a[108:111], v242, s[24:27], s30 offen offset:3072 sc1
  v_mfma_f32_16x16x32_bf16 v[52:55], a[188:191], a[20:23], v[52:55]
  ds_read_b64_tr_b16 a[170:171], v153 offset:17408
  v_sub_u32 v142, v136, v131
  v_mfma_f32_16x16x32_bf16 v[52:55], a[184:187], a[4:7], v[52:55]
  v_min3_u32 v138, v138, v141, v142
  v_sub_u32 v139, v136, v132
  v_mfma_f32_16x16x32_bf16 v[56:59], a[184:187], a[8:11], v[56:59]
  ds_read_b64_tr_b16 a[172:173], v153 offset:24576
  v_sub_u32 v140, v136, v133
  v_mfma_f32_16x16x32_bf16 v[56:59], a[188:191], a[24:27], v[56:59]
  v_min3_u32 v138, v138, v139, v140
  v_sub_u32 v141, v136, v134
  v_mfma_f32_16x16x32_bf16 v[60:63], a[188:191], a[28:31], v[60:63]
  ds_read_b64_tr_b16 a[174:175], v153 offset:25600
  v_sub_u32 v142, v136, v135
  v_mfma_f32_16x16x32_bf16 v[60:63], a[184:187], a[12:15], v[60:63]
  s_waitcnt lgkmcnt(4)
  v_min3_u32 v138, v138, v141, v142
  v_mfma_f32_16x16x32_bf16 v[64:67], a[160:163], a[0:3], v[64:67]
  ds_read_b64_tr_b16 a[176:177], v154 offset:16384
  v_min_u32_dpp v138, v138, v138 row_ror:8 row_mask:0xf bank_mask:0xf
  v_mfma_f32_16x16x32_bf16 v[64:67], a[164:167], a[16:19], v[64:67]
  buffer_load_dwordx4 a[112:115], v243, s[24:27], s30 offen offset:0 sc1
  v_mfma_f32_16x16x32_bf16 v[68:71], a[164:167], a[20:23], v[68:71]
  ds_read_b64_tr_b16 a[178:179], v154 offset:17408
  v_min_u32_dpp v138, v138, v138 row_ror:4 row_mask:0xf bank_mask:0xf
  v_mfma_f32_16x16x32_bf16 v[68:71], a[160:163], a[4:7], v[68:71]
  v_mfma_f32_16x16x32_bf16 v[72:75], a[160:163], a[8:11], v[72:75]
  ds_read_b64_tr_b16 a[180:181], v154 offset:24576
  v_min_u32_dpp v138, v138, v138 row_ror:2 row_mask:0xf bank_mask:0xf
  v_mfma_f32_16x16x32_bf16 v[72:75], a[164:167], a[24:27], v[72:75]
  buffer_load_dwordx4 v240, s[20:23], s31 offen offset:2048 lds
  v_mfma_f32_16x16x32_bf16 v[76:79], a[164:167], a[28:31], v[76:79]
  ds_read_b64_tr_b16 a[182:183], v154 offset:25600
  v_min_u32_dpp v138, v138, v138 row_ror:1 row_mask:0xf bank_mask:0xf
  v_mfma_f32_16x16x32_bf16 v[76:79], a[160:163], a[12:15], v[76:79]
  s_waitcnt lgkmcnt(4)
  v_sub_u32 v137, v136, v138
  v_add_u32 v136, -1, v137
  v_mfma_f32_16x16x32_bf16 v[80:83], a[168:171], a[0:3], v[80:83]
  ds_read_b64_tr_b16 a[184:185], v155 offset:16384
  v_sub_u32 v139, v136, v128
  v_mfma_f32_16x16x32_bf16 v[80:83], a[172:175], a[16:19], v[80:83]
  buffer_load_dwordx4 a[116:119], v243, s[24:27], s30 offen offset:1024 sc1
  v_mfma_f32_16x16x32_bf16 v[84:87], a[172:175], a[20:23], v[84:87]
  ds_read_b64_tr_b16 a[186:187], v155 offset:17408
  v_mov_b32_dpp v144, v137 quad_perm:[0,1,2,3] row_mask:0xf bank_mask:0x2
  v_mfma_f32_16x16x32_bf16 v[84:87], a[168:171], a[4:7], v[84:87]
  s_waitcnt vmcnt(22)
  v_sub_u32 v140, v136, v129
  v_min_u32 v138, v139, v140
  v_mfma_f32_16x16x32_bf16 v[88:91], a[168:171], a[8:11], v[88:91]
  ds_read_b64_tr_b16 a[188:189], v155 offset:24576
  v_sub_u32 v141, v136, v130
  v_mfma_f32_16x16x32_bf16 v[88:91], a[172:175], a[24:27], v[88:91]
  s_barrier
  v_sub_u32 v142, v136, v131
  v_min3_u32 v138, v138, v141, v142
  v_mfma_f32_16x16x32_bf16 v[92:95], a[172:175], a[28:31], v[92:95]
  ds_read_b64_tr_b16 a[190:191], v155 offset:25600
  v_sub_u32 v139, v136, v132
  v_mfma_f32_16x16x32_bf16 v[92:95], a[168:171], a[12:15], v[92:95]
  s_waitcnt lgkmcnt(4)
  v_sub_u32 v140, v136, v133
  v_min3_u32 v138, v138, v139, v140
  v_mfma_f32_16x16x32_bf16 v[96:99], a[176:179], a[0:3], v[96:99]
  ds_read_b64_tr_b16 a[160:161], v148 offset:0
  v_sub_u32 v141, v136, v134
  v_mfma_f32_16x16x32_bf16 v[96:99], a[180:183], a[16:19], v[96:99]
  buffer_load_dwordx4 a[120:123], v243, s[24:27], s30 offen offset:2048 sc1
  v_mfma_f32_16x16x32_bf16 v[100:103], a[180:183], a[20:23], v[100:103]
  ds_read_b64_tr_b16 a[162:163], v148 offset:1024
  v_sub_u32 v142, v136, v135
  v_mfma_f32_16x16x32_bf16 v[100:103], a[176:179], a[4:7], v[100:103]
  v_min3_u32 v138, v138, v141, v142
  v_mfma_f32_16x16x32_bf16 v[104:107], a[176:179], a[8:11], v[104:107]
  ds_read_b64_tr_b16 a[164:165], v148 offset:8192
  v_min_u32_dpp v138, v138, v138 row_ror:8 row_mask:0xf bank_mask:0xf
  v_mfma_f32_16x16x32_bf16 v[104:107], a[180:183], a[24:27], v[104:107]
  buffer_load_dwordx4 v241, s[20:23], s31 offen offset:3072 lds
  s_add_u32 s31, s31, 0x80000
  v_mfma_f32_16x16x32_bf16 v[108:111], a[180:183], a[28:31], v[108:111]
  ds_read_b64_tr_b16 a[166:167], v148 offset:9216
  v_min_u32_dpp v138, v138, v138 row_ror:4 row_mask:0xf bank_mask:0xf
  v_mfma_f32_16x16x32_bf16 v[108:111], a[176:179], a[12:15], v[108:111]
  s_waitcnt lgkmcnt(4)
  v_min_u32_dpp v138, v138, v138 row_ror:2 row_mask:0xf bank_mask:0xf
  v_mfma_f32_16x16x32_bf16 v[112:115], a[184:187], a[0:3], v[112:115]
  ds_read_b64_tr_b16 a[168:169], v149 offset:0
  v_min_u32_dpp v138, v138, v138 row_ror:1 row_mask:0xf bank_mask:0xf
  v_mfma_f32_16x16x32_bf16 v[112:115], a[188:191], a[16:19], v[112:115]
  buffer_load_dwordx4 a[124:127], v243, s[24:27], s30 offen offset:3072 sc1
  s_add_u32 s30, s30, 8192
  v_mfma_f32_16x16x32_bf16 v[116:119], a[188:191], a[20:23], v[116:119]
  ds_read_b64_tr_b16 a[170:171], v149 offset:1024
  v_sub_u32 v137, v136, v138
  v_mfma_f32_16x16x32_bf16 v[116:119], a[184:187], a[4:7], v[116:119]
  v_add_u32 v136, -1, v137
  v_sub_u32 v139, v136, v128
  v_mfma_f32_16x16x32_bf16 v[120:123], a[184:187], a[8:11], v[120:123]
  ds_read_b64_tr_b16 a[172:173], v149 offset:8192
  v_mov_b32_dpp v144, v137 quad_perm:[0,1,2,3] row_mask:0xf bank_mask:0x4
  v_mfma_f32_16x16x32_bf16 v[120:123], a[188:191], a[24:27], v[120:123]
  v_sub_u32 v140, v136, v129
  v_min_u32 v138, v139, v140
  v_mfma_f32_16x16x32_bf16 v[124:127], a[188:191], a[28:31], v[124:127]
  ds_read_b64_tr_b16 a[174:175], v149 offset:9216
  v_sub_u32 v141, v136, v130
  v_mfma_f32_16x16x32_bf16 v[124:127], a[184:187], a[12:15], v[124:127]
  s_waitcnt vmcnt(24) lgkmcnt(4)
  v_sub_u32 v142, v136, v131
  v_min3_u32 v138, v138, v141, v142
  v_mfma_f32_16x16x32_bf16 v[0:3], a[160:163], a[32:35], v[0:3]
  ds_read_b64_tr_b16 a[176:177], v150 offset:0
  v_sub_u32 v139, v136, v132
  v_mfma_f32_16x16x32_bf16 v[0:3], a[164:167], a[48:51], v[0:3]
  buffer_load_dwordx4 a[0:3], v242, s[24:27], s30 offen offset:0 sc1
  v_mfma_f32_16x16x32_bf16 v[4:7], a[164:167], a[52:55], v[4:7]
  ds_read_b64_tr_b16 a[178:179], v150 offset:1024
  v_sub_u32 v140, v136, v133
  v_mfma_f32_16x16x32_bf16 v[4:7], a[160:163], a[36:39], v[4:7]
  v_min3_u32 v138, v138, v139, v140
  v_sub_u32 v141, v136, v134
  v_mfma_f32_16x16x32_bf16 v[8:11], a[160:163], a[40:43], v[8:11]
  ds_read_b64_tr_b16 a[180:181], v150 offset:8192
  s_add_u32 m0, s28, 98304
  v_sub_u32 v142, v136, v135
  v_mfma_f32_16x16x32_bf16 v[8:11], a[164:167], a[56:59], v[8:11]
  buffer_load_dwordx4 v238, s[20:23], s31 offen offset:0 lds
  v_mfma_f32_16x16x32_bf16 v[12:15], a[164:167], a[60:63], v[12:15]
  ds_read_b64_tr_b16 a[182:183], v150 offset:9216
  v_min3_u32 v138, v138, v141, v142
  v_mfma_f32_16x16x32_bf16 v[12:15], a[160:163], a[44:47], v[12:15]
  s_waitcnt lgkmcnt(4)
  v_min_u32_dpp v138, v138, v138 row_ror:8 row_mask:0xf bank_mask:0xf
  v_mfma_f32_16x16x32_bf16 v[16:19], a[168:171], a[32:35], v[16:19]
  ds_read_b64_tr_b16 a[184:185], v151 offset:0
  v_min_u32_dpp v138, v138, v138 row_ror:4 row_mask:0xf bank_mask:0xf
  v_mfma_f32_16x16x32_bf16 v[16:19], a[172:175], a[48:51], v[16:19]
  buffer_load_dwordx4 a[4:7], v242, s[24:27], s30 offen offset:1024 sc1
  v_mfma_f32_16x16x32_bf16 v[20:23], a[172:175], a[52:55], v[20:23]
  ds_read_b64_tr_b16 a[186:187], v151 offset:1024
  v_min_u32_dpp v138, v138, v138 row_ror:2 row_mask:0xf bank_mask:0xf
  v_mfma_f32_16x16x32_bf16 v[20:23], a[168:171], a[36:39], v[20:23]
  v_mfma_f32_16x16x32_bf16 v[24:27], a[168:171], a[40:43], v[24:27]
  ds_read_b64_tr_b16 a[188:189], v151 offset:8192
  v_min_u32_dpp v138, v138, v138 row_ror:1 row_mask:0xf bank_mask:0xf
  v_mfma_f32_16x16x32_bf16 v[24:27], a[172:175], a[56:59], v[24:27]
  v_sub_u32 v137, v136, v138
  v_add_u32 v136, -1, v137
  v_mfma_f32_16x16x32_bf16 v[28:31], a[172:175], a[60:63], v[28:31]
  ds_read_b64_tr_b16 a[190:191], v151 offset:9216
  v_sub_u32 v139, v136, v128
  v_mfma_f32_16x16x32_bf16 v[28:31], a[168:171], a[44:47], v[28:31]
  s_waitcnt lgkmcnt(4)
  v_mov_b32_dpp v144, v137 quad_perm:[0,1,2,3] row_mask:0xf bank_mask:0x8
  v_sub_u32 v140, v136, v129
  v_mfma_f32_16x16x32_bf16 v[32:35], a[176:179], a[32:35], v[32:35]
  ds_read_b64_tr_b16 a[160:161], v152 offset:0
  v_min_u32 v138, v139, v140
  v_mfma_f32_16x16x32_bf16 v[32:35], a[180:183], a[48:51], v[32:35]
  buffer_load_dwordx4 a[8:11], v242, s[24:27], s30 offen offset:2048 sc1
  v_mfma_f32_16x16x32_bf16 v[36:39], a[180:183], a[52:55], v[36:39]
  ds_read_b64_tr_b16 a[162:163], v152 offset:1024
  v_sub_u32 v141, v136, v130
  v_mfma_f32_16x16x32_bf16 v[36:39], a[176:179], a[36:39], v[36:39]
  v_sub_u32 v142, v136, v131
  v_min3_u32 v138, v138, v141, v142
  v_mfma_f32_16x16x32_bf16 v[40:43], a[176:179], a[40:43], v[40:43]
  ds_read_b64_tr_b16 a[164:165], v152 offset:8192
  v_sub_u32 v139, v136, v132
  v_mfma_f32_16x16x32_bf16 v[40:43], a[180:183], a[56:59], v[40:43]
  buffer_load_dwordx4 v239, s[20:23], s31 offen offset:1024 lds
  v_mfma_f32_16x16x32_bf16 v[44:47], a[180:183], a[60:63], v[44:47]
  ds_read_b64_tr_b16 a[166:167], v152 offset:9216
  v_sub_u32 v140, v136, v133
  v_mfma_f32_16x16x32_bf16 v[44:47], a[176:179], a[44:47], v[44:47]
  s_waitcnt lgkmcnt(4)
  v_min3_u32 v138, v138, v139, v140
  v_sub_u32 v141, v136, v134
  v_mfma_f32_16x16x32_bf16 v[48:51], a[184:187], a[32:35], v[48:51]
  ds_read_b64_tr_b16 a[168:169], v153 offset:0
  v_sub_u32 v142, v136, v135
  v_mfma_f32_16x16x32_bf16 v[48:51], a[188:191], a[48:51], v[48:51]
  buffer_load_dwordx4 a[12:15], v242, s[24:27], s30 offen offset:3072 sc1
  v_mfma_f32_16x16x32_bf16 v[52:55], a[188:191], a[52:55], v[52:55]
  ds_read_b64_tr_b16 a[170:171], v153 offset:1024
  v_min3_u32 v138, v138, v141, v142
  v_mfma_f32_16x16x32_bf16 v[52:55], a[184:187], a[36:39], v[52:55]
  v_mfma_f32_16x16x32_bf16 v[56:59], a[184:187], a[40:43], v[56:59]
  ds_read_b64_tr_b16 a[172:173], v153 offset:8192
  v_min_u32_dpp v138, v138, v138 row_ror:8 row_mask:0xf bank_mask:0xf
  v_mfma_f32_16x16x32_bf16 v[56:59], a[188:191], a[56:59], v[56:59]
  v_mfma_f32_16x16x32_bf16 v[60:63], a[188:191], a[60:63], v[60:63]
  ds_read_b64_tr_b16 a[174:175], v153 offset:9216
  v_min_u32_dpp v138, v138, v138 row_ror:4 row_mask:0xf bank_mask:0xf
  v_mfma_f32_16x16x32_bf16 v[60:63], a[184:187], a[44:47], v[60:63]
  s_waitcnt lgkmcnt(4)
  v_min_u32_dpp v138, v138, v138 row_ror:2 row_mask:0xf bank_mask:0xf
  v_mfma_f32_16x16x32_bf16 v[64:67], a[160:163], a[32:35], v[64:67]
  ds_read_b64_tr_b16 a[176:177], v154 offset:0
  v_min_u32_dpp v138, v138, v138 row_ror:1 row_mask:0xf bank_mask:0xf
  v_mfma_f32_16x16x32_bf16 v[64:67], a[164:167], a[48:51], v[64:67]
  buffer_load_dwordx4 a[16:19], v243, s[24:27], s30 offen offset:0 sc1
  v_mfma_f32_16x16x32_bf16 v[68:71], a[164:167], a[52:55], v[68:71]
  ds_read_b64_tr_b16 a[178:179], v154 offset:1024
  v_sub_u32 v137, v136, v138
  v_mfma_f32_16x16x32_bf16 v[68:71], a[160:163], a[36:39], v[68:71]
  v_add_u32 v136, -1, v137
  v_sub_u32 v139, v136, v128
  v_mfma_f32_16x16x32_bf16 v[72:75], a[160:163], a[40:43], v[72:75]
  ds_read_b64_tr_b16 a[180:181], v154 offset:8192
  v_mov_b32_dpp v145, v137 quad_perm:[0,1,2,3] row_mask:0xf bank_mask:0x1
  v_mfma_f32_16x16x32_bf16 v[72:75], a[164:167], a[56:59], v[72:75]
  buffer_load_dwordx4 v240, s[20:23], s31 offen offset:2048 lds
  v_mfma_f32_16x16x32_bf16 v[76:79], a[164:167], a[60:63], v[76:79]
  ds_read_b64_tr_b16 a[182:183], v154 offset:9216
  v_sub_u32 v140, v136, v129
  v_mfma_f32_16x16x32_bf16 v[76:79], a[160:163], a[44:47], v[76:79]
  s_waitcnt lgkmcnt(4)
  v_min_u32 v138, v139, v140
  v_sub_u32 v141, v136, v130
  v_mfma_f32_16x16x32_bf16 v[80:83], a[168:171], a[32:35], v[80:83]
  ds_read_b64_tr_b16 a[184:185], v155 offset:0
  v_sub_u32 v142, v136, v131
  v_mfma_f32_16x16x32_bf16 v[80:83], a[172:175], a[48:51], v[80:83]
  buffer_load_dwordx4 a[20:23], v243, s[24:27], s30 offen offset:1024 sc1
  v_mfma_f32_16x16x32_bf16 v[84:87], a[172:175], a[52:55], v[84:87]
  ds_read_b64_tr_b16 a[186:187], v155 offset:1024
  v_min3_u32 v138, v138, v141, v142
  v_mfma_f32_16x16x32_bf16 v[84:87], a[168:171], a[36:39], v[84:87]
  s_waitcnt vmcnt(22)
  v_sub_u32 v139, v136, v132
  v_sub_u32 v140, v136, v133
  v_mfma_f32_16x16x32_bf16 v[88:91], a[168:171], a[40:43], v[88:91]
  ds_read_b64_tr_b16 a[188:189], v155 offset:8192
  v_min3_u32 v138, v138, v139, v140
  v_mfma_f32_16x16x32_bf16 v[88:91], a[172:175], a[56:59], v[88:91]
  s_barrier
  v_sub_u32 v141, v136, v134
  v_sub_u32 v142, v136, v135
  v_mfma_f32_16x16x32_bf16 v[92:95], a[172:175], a[60:63], v[92:95]
  ds_read_b64_tr_b16 a[190:191], v155 offset:9216
  v_min3_u32 v138, v138, v141, v142
  v_mfma_f32_16x16x32_bf16 v[92:95], a[168:171], a[44:47], v[92:95]
  s_waitcnt lgkmcnt(4)
  v_min_u32_dpp v138, v138, v138 row_ror:8 row_mask:0xf bank_mask:0xf
  v_mfma_f32_16x16x32_bf16 v[96:99], a[176:179], a[32:35], v[96:99]
  ds_read_b64_tr_b16 a[160:161], v224 offset:0
  v_min_u32_dpp v138, v138, v138 row_ror:4 row_mask:0xf bank_mask:0xf
  v_mfma_f32_16x16x32_bf16 v[96:99], a[180:183], a[48:51], v[96:99]
  buffer_load_dwordx4 a[24:27], v243, s[24:27], s30 offen offset:2048 sc1
  v_mfma_f32_16x16x32_bf16 v[100:103], a[180:183], a[52:55], v[100:103]
  ds_read_b64_tr_b16 a[162:163], v224 offset:1024
  v_min_u32_dpp v138, v138, v138 row_ror:2 row_mask:0xf bank_mask:0xf
  v_mfma_f32_16x16x32_bf16 v[100:103], a[176:179], a[36:39], v[100:103]
  v_mfma_f32_16x16x32_bf16 v[104:107], a[176:179], a[40:43], v[104:107]
  ds_read_b64_tr_b16 a[164:165], v224 offset:8192
  v_min_u32_dpp v138, v138, v138 row_ror:1 row_mask:0xf bank_mask:0xf
  v_mfma_f32_16x16x32_bf16 v[104:107], a[180:183], a[56:59], v[104:107]
  buffer_load_dwordx4 v241, s[20:23], s31 offen offset:3072 lds
  s_add_u32 s31, s31, 0x80000
  v_mfma_f32_16x16x32_bf16 v[108:111], a[180:183], a[60:63], v[108:111]
  ds_read_b64_tr_b16 a[166:167], v224 offset:9216
  v_sub_u32 v137, v136, v138
  v_mfma_f32_16x16x32_bf16 v[108:111], a[176:179], a[44:47], v[108:111]
  s_waitcnt lgkmcnt(4)
  v_add_u32 v136, -1, v137
  v_sub_u32 v139, v136, v128
  v_mfma_f32_16x16x32_bf16 v[112:115], a[184:187], a[32:35], v[112:115]
  ds_read_b64_tr_b16 a[168:169], v225 offset:0
  v_mov_b32_dpp v145, v137 quad_perm:[0,1,2,3] row_mask:0xf bank_mask:0x2
  v_mfma_f32_16x16x32_bf16 v[112:115], a[188:191], a[48:51], v[112:115]
  buffer_load_dwordx4 a[28:31], v243, s[24:27], s30 offen offset:3072 sc1
  s_add_u32 s30, s30, 8192
  v_mfma_f32_16x16x32_bf16 v[116:119], a[188:191], a[52:55], v[116:119]
  ds_read_b64_tr_b16 a[170:171], v225 offset:1024
  v_sub_u32 v140, v136, v129
  v_mfma_f32_16x16x32_bf16 v[116:119], a[184:187], a[36:39], v[116:119]
  v_min_u32 v138, v139, v140
  v_sub_u32 v141, v136, v130
  v_mfma_f32_16x16x32_bf16 v[120:123], a[184:187], a[40:43], v[120:123]
  ds_read_b64_tr_b16 a[172:173], v225 offset:8192
  v_sub_u32 v142, v136, v131
  v_mfma_f32_16x16x32_bf16 v[120:123], a[188:191], a[56:59], v[120:123]
  v_min3_u32 v138, v138, v141, v142
  v_sub_u32 v139, v136, v132
  v_mfma_f32_16x16x32_bf16 v[124:127], a[188:191], a[60:63], v[124:127]
  ds_read_b64_tr_b16 a[174:175], v225 offset:9216
  v_sub_u32 v140, v136, v133
  v_mfma_f32_16x16x32_bf16 v[124:127], a[184:187], a[44:47], v[124:127]
  s_waitcnt vmcnt(24) lgkmcnt(4)
  v_min3_u32 v138, v138, v139, v140
  v_sub_u32 v141, v136, v134
  v_mfma_f32_16x16x32_bf16 v[0:3], a[160:163], a[64:67], v[0:3]
  ds_read_b64_tr_b16 a[176:177], v226 offset:0
  v_sub_u32 v142, v136, v135
  v_mfma_f32_16x16x32_bf16 v[0:3], a[164:167], a[80:83], v[0:3]
  buffer_load_dwordx4 a[32:35], v242, s[24:27], s30 offen offset:0 sc1
  v_mfma_f32_16x16x32_bf16 v[4:7], a[164:167], a[84:87], v[4:7]
  ds_read_b64_tr_b16 a[178:179], v226 offset:1024
  v_min3_u32 v138, v138, v141, v142
  v_mfma_f32_16x16x32_bf16 v[4:7], a[160:163], a[68:71], v[4:7]
  v_mfma_f32_16x16x32_bf16 v[8:11], a[160:163], a[72:75], v[8:11]
  ds_read_b64_tr_b16 a[180:181], v226 offset:8192
  s_add_u32 m0, s28, 114688
  v_min_u32_dpp v138, v138, v138 row_ror:8 row_mask:0xf bank_mask:0xf
  v_mfma_f32_16x16x32_bf16 v[8:11], a[164:167], a[88:91], v[8:11]
  buffer_load_dwordx4 v238, s[20:23], s31 offen offset:0 lds
  v_mfma_f32_16x16x32_bf16 v[12:15], a[164:167], a[92:95], v[12:15]
  ds_read_b64_tr_b16 a[182:183], v226 offset:9216
  v_min_u32_dpp v138, v138, v138 row_ror:4 row_mask:0xf bank_mask:0xf
  v_mfma_f32_16x16x32_bf16 v[12:15], a[160:163], a[76:79], v[12:15]
  s_waitcnt lgkmcnt(4)
  v_min_u32_dpp v138, v138, v138 row_ror:2 row_mask:0xf bank_mask:0xf
  v_mfma_f32_16x16x32_bf16 v[16:19], a[168:171], a[64:67], v[16:19]
  ds_read_b64_tr_b16 a[184:185], v227 offset:0
  v_min_u32_dpp v138, v138, v138 row_ror:1 row_mask:0xf bank_mask:0xf
  v_mfma_f32_16x16x32_bf16 v[16:19], a[172:175], a[80:83], v[16:19]
  buffer_load_dwordx4 a[36:39], v242, s[24:27], s30 offen offset:1024 sc1
  v_mfma_f32_16x16x32_bf16 v[20:23], a[172:175], a[84:87], v[20:23]
  ds_read_b64_tr_b16 a[186:187], v227 offset:1024
  v_sub_u32 v137, v136, v138
  v_mfma_f32_16x16x32_bf16 v[20:23], a[168:171], a[68:71], v[20:23]
  v_add_u32 v136, -1, v137
  v_sub_u32 v139, v136, v128
  v_mfma_f32_16x16x32_bf16 v[24:27], a[168:171], a[72:75], v[24:27]
  ds_read_b64_tr_b16 a[188:189], v227 offset:8192
  v_mov_b32_dpp v145, v137 quad_perm:[0,1,2,3] row_mask:0xf bank_mask:0x4
  v_mfma_f32_16x16x32_bf16 v[24:27], a[172:175], a[88:91], v[24:27]
  v_sub_u32 v140, v136, v129
  v_min_u32 v138, v139, v140
  v_mfma_f32_16x16x32_bf16 v[28:31], a[172:175], a[92:95], v[28:31]
  ds_read_b64_tr_b16 a[190:191], v227 offset:9216
  v_sub_u32 v141, v136, v130
  v_mfma_f32_16x16x32_bf16 v[28:31], a[168:171], a[76:79], v[28:31]
  s_waitcnt lgkmcnt(4)
  v_sub_u32 v142, v136, v131
  v_min3_u32 v138, v138, v141, v142
  v_mfma_f32_16x16x32_bf16 v[32:35], a[176:179], a[64:67], v[32:35]
  ds_read_b64_tr_b16 a[160:161], v228 offset:0
  v_sub_u32 v139, v136, v132
  v_mfma_f32_16x16x32_bf16 v[32:35], a[180:183], a[80:83], v[32:35]
  buffer_load_dwordx4 a[40:43], v242, s[24:27], s30 offen offset:2048 sc1
  v_mfma_f32_16x16x32_bf16 v[36:39], a[180:183], a[84:87], v[36:39]
  ds_read_b64_tr_b16 a[162:163], v228 offset:1024
  v_sub_u32 v140, v136, v133
  v_mfma_f32_16x16x32_bf16 v[36:39], a[176:179], a[68:71], v[36:39]
  v_min3_u32 v138, v138, v139, v140
  v_sub_u32 v141, v136, v134
  v_mfma_f32_16x16x32_bf16 v[40:43], a[176:179], a[72:75], v[40:43]
  ds_read_b64_tr_b16 a[164:165], v228 offset:8192
  v_sub_u32 v142, v136, v135
  v_mfma_f32_16x16x32_bf16 v[40:43], a[180:183], a[88:91], v[40:43]
  buffer_load_dwordx4 v239, s[20:23], s31 offen offset:1024 lds
  v_mfma_f32_16x16x32_bf16 v[44:47], a[180:183], a[92:95], v[44:47]
  ds_read_b64_tr_b16 a[166:167], v228 offset:9216
  v_min3_u32 v138, v138, v141, v142
  v_mfma_f32_16x16x32_bf16 v[44:47], a[176:179], a[76:79], v[44:47]
  s_waitcnt lgkmcnt(4)
  v_min_u32_dpp v138, v138, v138 row_ror:8 row_mask:0xf bank_mask:0xf
  v_mfma_f32_16x16x32_bf16 v[48:51], a[184:187], a[64:67], v[48:51]
  ds_read_b64_tr_b16 a[168:169], v229 offset:0
  v_min_u32_dpp v138, v138, v138 row_ror:4 row_mask:0xf bank_mask:0xf
  v_mfma_f32_16x16x32_bf16 v[48:51], a[188:191], a[80:83], v[48:51]
  buffer_load_dwordx4 a[44:47], v242, s[24:27], s30 offen offset:3072 sc1
  v_mfma_f32_16x16x32_bf16 v[52:55], a[188:191], a[84:87], v[52:55]
  ds_read_b64_tr_b16 a[170:171], v229 offset:1024
  v_min_u32_dpp v138, v138, v138 row_ror:2 row_mask:0xf bank_mask:0xf
  v_mfma_f32_16x16x32_bf16 v[52:55], a[184:187], a[68:71], v[52:55]
  v_mfma_f32_16x16x32_bf16 v[56:59], a[184:187], a[72:75], v[56:59]
  ds_read_b64_tr_b16 a[172:173], v229 offset:8192
  v_min_u32_dpp v138, v138, v138 row_ror:1 row_mask:0xf bank_mask:0xf
  v_mfma_f32_16x16x32_bf16 v[56:59], a[188:191], a[88:91], v[56:59]
  v_sub_u32 v137, v136, v138
  v_add_u32 v136, -1, v137
  v_mfma_f32_16x16x32_bf16 v[60:63], a[188:191], a[92:95], v[60:63]
  ds_read_b64_tr_b16 a[174:175], v229 offset:9216
  v_mov_b32_dpp v145, v137 quad_perm:[0,1,2,3] row_mask:0xf bank_mask:0x8
  v_mfma_f32_16x16x32_bf16 v[60:63], a[184:187], a[76:79], v[60:63]
  s_waitcnt lgkmcnt(4)
  s_lshl_b32 s35, s3, 9
  s_add_u32 s35, s35, 157696
  v_lshrrev_b32 v136, 1, v242
  v_add_u32 v136, s35, v136
  v_mfma_f32_16x16x32_bf16 v[64:67], a[160:163], a[64:67], v[64:67]
  ds_read_b64_tr_b16 a[176:177], v230 offset:0
  ds_write_b64 v136, v[144:145]
  v_mfma_f32_16x16x32_bf16 v[64:67], a[164:167], a[80:83], v[64:67]
  buffer_load_dwordx4 a[48:51], v243, s[24:27], s30 offen offset:0 sc1
  v_mfma_f32_16x16x32_bf16 v[68:71], a[164:167], a[84:87], v[68:71]
  ds_read_b64_tr_b16 a[178:179], v230 offset:1024
  v_mfma_f32_16x16x32_bf16 v[68:71], a[160:163], a[68:71], v[68:71]
  v_mfma_f32_16x16x32_bf16 v[72:75], a[160:163], a[72:75], v[72:75]
  ds_read_b64_tr_b16 a[180:181], v230 offset:8192
  v_mfma_f32_16x16x32_bf16 v[72:75], a[164:167], a[88:91], v[72:75]
  buffer_load_dwordx4 v240, s[20:23], s31 offen offset:2048 lds
  v_mfma_f32_16x16x32_bf16 v[76:79], a[164:167], a[92:95], v[76:79]
  ds_read_b64_tr_b16 a[182:183], v230 offset:9216
  v_mfma_f32_16x16x32_bf16 v[76:79], a[160:163], a[76:79], v[76:79]
  s_waitcnt lgkmcnt(5)
  v_mfma_f32_16x16x32_bf16 v[80:83], a[168:171], a[64:67], v[80:83]
  ds_read_b64_tr_b16 a[184:185], v231 offset:0
  s_waitcnt lgkmcnt(4)
  v_mfma_f32_16x16x32_bf16 v[80:83], a[172:175], a[80:83], v[80:83]
  buffer_load_dwordx4 a[52:55], v243, s[24:27], s30 offen offset:1024 sc1
  v_mfma_f32_16x16x32_bf16 v[84:87], a[172:175], a[84:87], v[84:87]
  ds_read_b64_tr_b16 a[186:187], v231 offset:1024
  v_mfma_f32_16x16x32_bf16 v[84:87], a[168:171], a[68:71], v[84:87]
  s_waitcnt vmcnt(22)
  v_mfma_f32_16x16x32_bf16 v[88:91], a[168:171], a[72:75], v[88:91]
  ds_read_b64_tr_b16 a[188:189], v231 offset:8192
  v_mfma_f32_16x16x32_bf16 v[88:91], a[172:175], a[88:91], v[88:91]
  s_barrier
  v_mfma_f32_16x16x32_bf16 v[92:95], a[172:175], a[92:95], v[92:95]
  ds_read_b64_tr_b16 a[190:191], v231 offset:9216
  v_lshlrev_b32 v137, 1, v242
  v_mfma_f32_16x16x32_bf16 v[92:95], a[168:171], a[76:79], v[92:95]
  s_waitcnt lgkmcnt(4)
  v_add_u32 v137, 157696, v137
  v_mfma_f32_16x16x32_bf16 v[96:99], a[176:179], a[64:67], v[96:99]
  ds_read_b64_tr_b16 a[160:161], v224 offset:16384
  ds_read_b64 v[128:129], v137
  v_mfma_f32_16x16x32_bf16 v[96:99], a[180:183], a[80:83], v[96:99]
  buffer_load_dwordx4 a[56:59], v243, s[24:27], s30 offen offset:2048 sc1
  v_mfma_f32_16x16x32_bf16 v[100:103], a[180:183], a[84:87], v[100:103]
  ds_read_b64_tr_b16 a[162:163], v224 offset:17408
  v_mfma_f32_16x16x32_bf16 v[100:103], a[176:179], a[68:71], v[100:103]
  v_mfma_f32_16x16x32_bf16 v[104:107], a[176:179], a[72:75], v[104:107]
  ds_read_b64_tr_b16 a[164:165], v224 offset:24576
  v_mfma_f32_16x16x32_bf16 v[104:107], a[180:183], a[88:91], v[104:107]
  buffer_load_dwordx4 v241, s[20:23], s31 offen offset:3072 lds
  s_add_u32 s31, s31, 0x80000
  v_mfma_f32_16x16x32_bf16 v[108:111], a[180:183], a[92:95], v[108:111]
  ds_read_b64_tr_b16 a[166:167], v224 offset:25600
  v_mfma_f32_16x16x32_bf16 v[108:111], a[176:179], a[76:79], v[108:111]
  s_waitcnt lgkmcnt(5)
  v_mfma_f32_16x16x32_bf16 v[112:115], a[184:187], a[64:67], v[112:115]
  ds_read_b64_tr_b16 a[168:169], v225 offset:16384
  s_waitcnt lgkmcnt(4)
  v_mov_b32 v137, -1
  v_mfma_f32_16x16x32_bf16 v[112:115], a[188:191], a[80:83], v[112:115]
  buffer_load_dwordx4 a[60:63], v243, s[24:27], s30 offen offset:3072 sc1
  s_add_u32 s30, s30, 8192
  v_mfma_f32_16x16x32_bf16 v[116:119], a[188:191], a[84:87], v[116:119]
  ds_read_b64_tr_b16 a[170:171], v225 offset:17408
  v_sub_u32 v140, v137, v128
  v_mfma_f32_16x16x32_bf16 v[116:119], a[184:187], a[68:71], v[116:119]
  v_sub_u32 v141, v137, v129
  v_min_u32 v139, v140, v141
  v_mfma_f32_16x16x32_bf16 v[120:123], a[184:187], a[72:75], v[120:123]
  ds_read_b64_tr_b16 a[172:173], v225 offset:24576
  v_min_u32_dpp v139, v139, v139 row_ror:8 row_mask:0xf bank_mask:0xf
  v_mfma_f32_16x16x32_bf16 v[120:123], a[188:191], a[88:91], v[120:123]
  v_mfma_f32_16x16x32_bf16 v[124:127], a[188:191], a[92:95], v[124:127]
  ds_read_b64_tr_b16 a[174:175], v225 offset:25600
  v_min_u32_dpp v139, v139, v139 row_ror:4 row_mask:0xf bank_mask:0xf
  v_mfma_f32_16x16x32_bf16 v[124:127], a[184:187], a[76:79], v[124:127]
  s_waitcnt vmcnt(24) lgkmcnt(4)
  v_min_u32_dpp v139, v139, v139 row_ror:2 row_mask:0xf bank_mask:0xf
  v_mfma_f32_16x16x32_bf16 v[0:3], a[160:163], a[96:99], v[0:3]
  ds_read_b64_tr_b16 a[176:177], v226 offset:16384
  v_min_u32_dpp v139, v139, v139 row_ror:1 row_mask:0xf bank_mask:0xf
  v_mfma_f32_16x16x32_bf16 v[0:3], a[164:167], a[112:115], v[0:3]
  v_mov_b32 v140, v139
  v_mfma_f32_16x16x32_bf16 v[4:7], a[164:167], a[116:119], v[4:7]
  ds_read_b64_tr_b16 a[178:179], v226 offset:17408
  v_permlane16_swap_b32 v139, v140
  v_mfma_f32_16x16x32_bf16 v[4:7], a[160:163], a[100:103], v[4:7]
  v_min_u32 v139, v139, v140
  v_mov_b32 v140, v139
  v_mfma_f32_16x16x32_bf16 v[8:11], a[160:163], a[104:107], v[8:11]
  ds_read_b64_tr_b16 a[180:181], v226 offset:24576
  s_add_u32 m0, s28, 0
  v_permlane32_swap_b32 v139, v140
  v_mfma_f32_16x16x32_bf16 v[8:11], a[164:167], a[120:123], v[8:11]
  buffer_load_dwordx4 v232, s[12:15], s29 offen offset:0 lds
  v_mfma_f32_16x16x32_bf16 v[12:15], a[164:167], a[124:127], v[12:15]
  ds_read_b64_tr_b16 a[182:183], v226 offset:25600
  v_min_u32 v139, v139, v140
  v_mfma_f32_16x16x32_bf16 v[12:15], a[160:163], a[108:111], v[12:15]
  s_waitcnt lgkmcnt(4)
  v_sub_u32 v138, v137, v139
  v_add_u32 v137, -1, v138
  v_mfma_f32_16x16x32_bf16 v[16:19], a[168:171], a[96:99], v[16:19]
  ds_read_b64_tr_b16 a[184:185], v227 offset:16384
  v_sub_u32 v140, v137, v128
  v_mfma_f32_16x16x32_bf16 v[16:19], a[172:175], a[112:115], v[16:19]
  v_readfirstlane_b32 s52, v138
  v_sub_u32 v141, v137, v129
  v_mfma_f32_16x16x32_bf16 v[20:23], a[172:175], a[116:119], v[20:23]
  ds_read_b64_tr_b16 a[186:187], v227 offset:17408
  v_min_u32 v139, v140, v141
  v_mfma_f32_16x16x32_bf16 v[20:23], a[168:171], a[100:103], v[20:23]
  v_mfma_f32_16x16x32_bf16 v[24:27], a[168:171], a[104:107], v[24:27]
  ds_read_b64_tr_b16 a[188:189], v227 offset:24576
  v_min_u32_dpp v139, v139, v139 row_ror:8 row_mask:0xf bank_mask:0xf
  v_mfma_f32_16x16x32_bf16 v[24:27], a[172:175], a[120:123], v[24:27]
  v_mfma_f32_16x16x32_bf16 v[28:31], a[172:175], a[124:127], v[28:31]
  ds_read_b64_tr_b16 a[190:191], v227 offset:25600
  v_min_u32_dpp v139, v139, v139 row_ror:4 row_mask:0xf bank_mask:0xf
  v_mfma_f32_16x16x32_bf16 v[28:31], a[168:171], a[108:111], v[28:31]
  s_waitcnt lgkmcnt(4)
  v_min_u32_dpp v139, v139, v139 row_ror:2 row_mask:0xf bank_mask:0xf
  v_mfma_f32_16x16x32_bf16 v[32:35], a[176:179], a[96:99], v[32:35]
  ds_read_b64_tr_b16 a[160:161], v228 offset:16384
  v_min_u32_dpp v139, v139, v139 row_ror:1 row_mask:0xf bank_mask:0xf
  v_mfma_f32_16x16x32_bf16 v[32:35], a[180:183], a[112:115], v[32:35]
  v_mov_b32 v140, v139
  v_mfma_f32_16x16x32_bf16 v[36:39], a[180:183], a[116:119], v[36:39]
  ds_read_b64_tr_b16 a[162:163], v228 offset:17408
  v_permlane16_swap_b32 v139, v140
  v_mfma_f32_16x16x32_bf16 v[36:39], a[176:179], a[100:103], v[36:39]
  v_min_u32 v139, v139, v140
  v_mov_b32 v140, v139
  v_mfma_f32_16x16x32_bf16 v[40:43], a[176:179], a[104:107], v[40:43]
  ds_read_b64_tr_b16 a[164:165], v228 offset:24576
  v_permlane32_swap_b32 v139, v140
  v_mfma_f32_16x16x32_bf16 v[40:43], a[180:183], a[120:123], v[40:43]
  buffer_load_dwordx4 v233, s[12:15], s29 offen offset:1024 lds
  v_mfma_f32_16x16x32_bf16 v[44:47], a[180:183], a[124:127], v[44:47]
  ds_read_b64_tr_b16 a[166:167], v228 offset:25600
  v_min_u32 v139, v139, v140
  v_mfma_f32_16x16x32_bf16 v[44:47], a[176:179], a[108:111], v[44:47]
  s_waitcnt lgkmcnt(4)
  v_sub_u32 v138, v137, v139
  v_add_u32 v137, -1, v138
  v_mfma_f32_16x16x32_bf16 v[48:51], a[184:187], a[96:99], v[48:51]
  ds_read_b64_tr_b16 a[168:169], v229 offset:16384
  v_sub_u32 v140, v137, v128
  v_mfma_f32_16x16x32_bf16 v[48:51], a[188:191], a[112:115], v[48:51]
  v_readfirstlane_b32 s53, v138
  v_sub_u32 v141, v137, v129
  v_mfma_f32_16x16x32_bf16 v[52:55], a[188:191], a[116:119], v[52:55]
  ds_read_b64_tr_b16 a[170:171], v229 offset:17408
  v_min_u32 v139, v140, v141
  v_mfma_f32_16x16x32_bf16 v[52:55], a[184:187], a[100:103], v[52:55]
  v_mfma_f32_16x16x32_bf16 v[56:59], a[184:187], a[104:107], v[56:59]
  ds_read_b64_tr_b16 a[172:173], v229 offset:24576
  v_min_u32_dpp v139, v139, v139 row_ror:8 row_mask:0xf bank_mask:0xf
  v_mfma_f32_16x16x32_bf16 v[56:59], a[188:191], a[120:123], v[56:59]
  v_mfma_f32_16x16x32_bf16 v[60:63], a[188:191], a[124:127], v[60:63]
  ds_read_b64_tr_b16 a[174:175], v229 offset:25600
  v_min_u32_dpp v139, v139, v139 row_ror:4 row_mask:0xf bank_mask:0xf
  v_mfma_f32_16x16x32_bf16 v[60:63], a[184:187], a[108:111], v[60:63]
  s_waitcnt lgkmcnt(4)
  v_min_u32_dpp v139, v139, v139 row_ror:2 row_mask:0xf bank_mask:0xf
  v_mfma_f32_16x16x32_bf16 v[64:67], a[160:163], a[96:99], v[64:67]
  ds_read_b64_tr_b16 a[176:177], v230 offset:16384
  v_min_u32_dpp v139, v139, v139 row_ror:1 row_mask:0xf bank_mask:0xf
  v_mfma_f32_16x16x32_bf16 v[64:67], a[164:167], a[112:115], v[64:67]
  v_mov_b32 v140, v139
  v_mfma_f32_16x16x32_bf16 v[68:71], a[164:167], a[116:119], v[68:71]
  ds_read_b64_tr_b16 a[178:179], v230 offset:17408
  v_permlane16_swap_b32 v139, v140
  v_mfma_f32_16x16x32_bf16 v[68:71], a[160:163], a[100:103], v[68:71]
  v_min_u32 v139, v139, v140
  v_mov_b32 v140, v139
  v_mfma_f32_16x16x32_bf16 v[72:75], a[160:163], a[104:107], v[72:75]
  ds_read_b64_tr_b16 a[180:181], v230 offset:24576
  v_permlane32_swap_b32 v139, v140
  v_mfma_f32_16x16x32_bf16 v[72:75], a[164:167], a[120:123], v[72:75]
  buffer_load_dwordx4 v234, s[12:15], s29 offen offset:2048 lds
  v_mfma_f32_16x16x32_bf16 v[76:79], a[164:167], a[124:127], v[76:79]
  ds_read_b64_tr_b16 a[182:183], v230 offset:25600
  v_min_u32 v139, v139, v140
  v_mfma_f32_16x16x32_bf16 v[76:79], a[160:163], a[108:111], v[76:79]
  s_waitcnt lgkmcnt(4)
  v_sub_u32 v138, v137, v139
  v_add_u32 v137, -1, v138
  v_mfma_f32_16x16x32_bf16 v[80:83], a[168:171], a[96:99], v[80:83]
  ds_read_b64_tr_b16 a[184:185], v231 offset:16384
  v_sub_u32 v140, v137, v128
  v_mfma_f32_16x16x32_bf16 v[80:83], a[172:175], a[112:115], v[80:83]
  v_readfirstlane_b32 s54, v138
  v_sub_u32 v141, v137, v129
  v_mfma_f32_16x16x32_bf16 v[84:87], a[172:175], a[116:119], v[84:87]
  ds_read_b64_tr_b16 a[186:187], v231 offset:17408
  v_min_u32 v139, v140, v141
  v_mfma_f32_16x16x32_bf16 v[84:87], a[168:171], a[100:103], v[84:87]
  s_waitcnt vmcnt(16)
  v_min_u32_dpp v139, v139, v139 row_ror:8 row_mask:0xf bank_mask:0xf
  v_mfma_f32_16x16x32_bf16 v[88:91], a[168:171], a[104:107], v[88:91]
  ds_read_b64_tr_b16 a[188:189], v231 offset:24576
  v_min_u32_dpp v139, v139, v139 row_ror:4 row_mask:0xf bank_mask:0xf
  v_mfma_f32_16x16x32_bf16 v[88:91], a[172:175], a[120:123], v[88:91]
  s_barrier
  v_min_u32_dpp v139, v139, v139 row_ror:2 row_mask:0xf bank_mask:0xf
  v_mfma_f32_16x16x32_bf16 v[92:95], a[172:175], a[124:127], v[92:95]
  ds_read_b64_tr_b16 a[190:191], v231 offset:25600
  v_min_u32_dpp v139, v139, v139 row_ror:1 row_mask:0xf bank_mask:0xf
  v_mfma_f32_16x16x32_bf16 v[92:95], a[168:171], a[108:111], v[92:95]
  s_waitcnt lgkmcnt(4)
  v_mov_b32 v140, v139
  v_mfma_f32_16x16x32_bf16 v[96:99], a[176:179], a[96:99], v[96:99]
  ds_read_b64_tr_b16 a[160:161], v224 offset:32768
  v_permlane16_swap_b32 v139, v140
  v_mfma_f32_16x16x32_bf16 v[96:99], a[180:183], a[112:115], v[96:99]
  v_min_u32 v139, v139, v140
  v_mov_b32 v140, v139
  v_mfma_f32_16x16x32_bf16 v[100:103], a[180:183], a[116:119], v[100:103]
  ds_read_b64_tr_b16 a[162:163], v224 offset:33792
  v_permlane32_swap_b32 v139, v140
  v_mfma_f32_16x16x32_bf16 v[100:103], a[176:179], a[100:103], v[100:103]
  v_min_u32 v139, v139, v140
  v_sub_u32 v138, v137, v139
  v_mfma_f32_16x16x32_bf16 v[104:107], a[176:179], a[104:107], v[104:107]
  ds_read_b64_tr_b16 a[164:165], v224 offset:40960
  v_add_u32 v137, -1, v138
  v_mfma_f32_16x16x32_bf16 v[104:107], a[180:183], a[120:123], v[104:107]
  buffer_load_dwordx4 v235, s[12:15], s29 offen offset:3072 lds
  v_mfma_f32_16x16x32_bf16 v[108:111], a[180:183], a[124:127], v[108:111]
  ds_read_b64_tr_b16 a[166:167], v224 offset:41984
  v_sub_u32 v140, v137, v128
  v_mfma_f32_16x16x32_bf16 v[108:111], a[176:179], a[108:111], v[108:111]
  s_waitcnt lgkmcnt(4)
  v_readfirstlane_b32 s55, v138
  v_sub_u32 v141, v137, v129
  v_mfma_f32_16x16x32_bf16 v[112:115], a[184:187], a[96:99], v[112:115]
  ds_read_b64_tr_b16 a[168:169], v225 offset:32768
  v_min_u32 v139, v140, v141
  v_mfma_f32_16x16x32_bf16 v[112:115], a[188:191], a[112:115], v[112:115]
  v_mfma_f32_16x16x32_bf16 v[116:119], a[188:191], a[116:119], v[116:119]
  ds_read_b64_tr_b16 a[170:171], v225 offset:33792
  v_min_u32_dpp v139, v139, v139 row_ror:8 row_mask:0xf bank_mask:0xf
  v_mfma_f32_16x16x32_bf16 v[116:119], a[184:187], a[100:103], v[116:119]
  v_mfma_f32_16x16x32_bf16 v[120:123], a[184:187], a[104:107], v[120:123]
  ds_read_b64_tr_b16 a[172:173], v225 offset:40960
  v_min_u32_dpp v139, v139, v139 row_ror:4 row_mask:0xf bank_mask:0xf
  v_mfma_f32_16x16x32_bf16 v[120:123], a[188:191], a[120:123], v[120:123]
  v_mfma_f32_16x16x32_bf16 v[124:127], a[188:191], a[124:127], v[124:127]
  ds_read_b64_tr_b16 a[174:175], v225 offset:41984
  v_min_u32_dpp v139, v139, v139 row_ror:2 row_mask:0xf bank_mask:0xf
  v_mfma_f32_16x16x32_bf16 v[124:127], a[184:187], a[108:111], v[124:127]
  s_waitcnt vmcnt(16) lgkmcnt(4)
  v_min_u32_dpp v139, v139, v139 row_ror:1 row_mask:0xf bank_mask:0xf
  v_mov_b32 v140, v139
  v_mfma_f32_16x16x32_bf16 v[0:3], a[160:163], a[0:3], v[0:3]
  ds_read_b64_tr_b16 a[176:177], v226 offset:32768
  v_permlane16_swap_b32 v139, v140
  v_mfma_f32_16x16x32_bf16 v[0:3], a[164:167], a[16:19], v[0:3]
  v_min_u32 v139, v139, v140
  v_mov_b32 v140, v139
  v_mfma_f32_16x16x32_bf16 v[4:7], a[164:167], a[20:23], v[4:7]
  ds_read_b64_tr_b16 a[178:179], v226 offset:33792
  v_permlane32_swap_b32 v139, v140
  v_mfma_f32_16x16x32_bf16 v[4:7], a[160:163], a[4:7], v[4:7]
  v_min_u32 v139, v139, v140
  v_sub_u32 v138, v137, v139
  v_mfma_f32_16x16x32_bf16 v[8:11], a[160:163], a[8:11], v[8:11]
  ds_read_b64_tr_b16 a[180:181], v226 offset:40960
  s_add_u32 m0, s28, 65536
  v_add_u32 v137, -1, v138
  v_mfma_f32_16x16x32_bf16 v[8:11], a[164:167], a[24:27], v[8:11]
  buffer_load_dwordx4 v236, s[16:19], s29 offen offset:0 lds
  v_mfma_f32_16x16x32_bf16 v[12:15], a[164:167], a[28:31], v[12:15]
  ds_read_b64_tr_b16 a[182:183], v226 offset:41984
  v_sub_u32 v140, v137, v128
  v_mfma_f32_16x16x32_bf16 v[12:15], a[160:163], a[12:15], v[12:15]
  s_waitcnt lgkmcnt(4)
  v_readfirstlane_b32 s56, v138
  v_sub_u32 v141, v137, v129
  v_mfma_f32_16x16x32_bf16 v[16:19], a[168:171], a[0:3], v[16:19]
  ds_read_b64_tr_b16 a[184:185], v227 offset:32768
  v_min_u32 v139, v140, v141
  v_mfma_f32_16x16x32_bf16 v[16:19], a[172:175], a[16:19], v[16:19]
  v_mfma_f32_16x16x32_bf16 v[20:23], a[172:175], a[20:23], v[20:23]
  ds_read_b64_tr_b16 a[186:187], v227 offset:33792
  v_min_u32_dpp v139, v139, v139 row_ror:8 row_mask:0xf bank_mask:0xf
  v_mfma_f32_16x16x32_bf16 v[20:23], a[168:171], a[4:7], v[20:23]
  v_mfma_f32_16x16x32_bf16 v[24:27], a[168:171], a[8:11], v[24:27]
  ds_read_b64_tr_b16 a[188:189], v227 offset:40960
  v_min_u32_dpp v139, v139, v139 row_ror:4 row_mask:0xf bank_mask:0xf
  v_mfma_f32_16x16x32_bf16 v[24:27], a[172:175], a[24:27], v[24:27]
  v_mfma_f32_16x16x32_bf16 v[28:31], a[172:175], a[28:31], v[28:31]
  ds_read_b64_tr_b16 a[190:191], v227 offset:41984
  v_min_u32_dpp v139, v139, v139 row_ror:2 row_mask:0xf bank_mask:0xf
  v_mfma_f32_16x16x32_bf16 v[28:31], a[168:171], a[12:15], v[28:31]
  s_waitcnt lgkmcnt(4)
  v_min_u32_dpp v139, v139, v139 row_ror:1 row_mask:0xf bank_mask:0xf
  v_mov_b32 v140, v139
  v_mfma_f32_16x16x32_bf16 v[32:35], a[176:179], a[0:3], v[32:35]
  ds_read_b64_tr_b16 a[160:161], v228 offset:32768
  v_permlane16_swap_b32 v139, v140
  v_mfma_f32_16x16x32_bf16 v[32:35], a[180:183], a[16:19], v[32:35]
  v_min_u32 v139, v139, v140
  v_mov_b32 v140, v139
  v_mfma_f32_16x16x32_bf16 v[36:39], a[180:183], a[20:23], v[36:39]
  ds_read_b64_tr_b16 a[162:163], v228 offset:33792
  v_permlane32_swap_b32 v139, v140
  v_mfma_f32_16x16x32_bf16 v[36:39], a[176:179], a[4:7], v[36:39]
  v_min_u32 v139, v139, v140
  v_sub_u32 v138, v137, v139
  v_mfma_f32_16x16x32_bf16 v[40:43], a[176:179], a[8:11], v[40:43]
  ds_read_b64_tr_b16 a[164:165], v228 offset:40960
  v_add_u32 v137, -1, v138
  v_mfma_f32_16x16x32_bf16 v[40:43], a[180:183], a[24:27], v[40:43]
  buffer_load_dwordx4 v237, s[16:19], s29 offen offset:1024 lds
  v_mfma_f32_16x16x32_bf16 v[44:47], a[180:183], a[28:31], v[44:47]
  ds_read_b64_tr_b16 a[166:167], v228 offset:41984
  v_sub_u32 v140, v137, v128
  v_mfma_f32_16x16x32_bf16 v[44:47], a[176:179], a[12:15], v[44:47]
  s_waitcnt lgkmcnt(4)
  v_readfirstlane_b32 s57, v138
  v_sub_u32 v141, v137, v129
  v_mfma_f32_16x16x32_bf16 v[48:51], a[184:187], a[0:3], v[48:51]
  ds_read_b64_tr_b16 a[168:169], v229 offset:32768
  v_min_u32 v139, v140, v141
  v_mfma_f32_16x16x32_bf16 v[48:51], a[188:191], a[16:19], v[48:51]
  v_mfma_f32_16x16x32_bf16 v[52:55], a[188:191], a[20:23], v[52:55]
  ds_read_b64_tr_b16 a[170:171], v229 offset:33792
  v_min_u32_dpp v139, v139, v139 row_ror:8 row_mask:0xf bank_mask:0xf
  v_mfma_f32_16x16x32_bf16 v[52:55], a[184:187], a[4:7], v[52:55]
  v_mfma_f32_16x16x32_bf16 v[56:59], a[184:187], a[8:11], v[56:59]
  ds_read_b64_tr_b16 a[172:173], v229 offset:40960
  v_min_u32_dpp v139, v139, v139 row_ror:4 row_mask:0xf bank_mask:0xf
  v_mfma_f32_16x16x32_bf16 v[56:59], a[188:191], a[24:27], v[56:59]
  v_mfma_f32_16x16x32_bf16 v[60:63], a[188:191], a[28:31], v[60:63]
  ds_read_b64_tr_b16 a[174:175], v229 offset:41984
  v_min_u32_dpp v139, v139, v139 row_ror:2 row_mask:0xf bank_mask:0xf
  v_mfma_f32_16x16x32_bf16 v[60:63], a[184:187], a[12:15], v[60:63]
  s_waitcnt lgkmcnt(4)
  v_min_u32_dpp v139, v139, v139 row_ror:1 row_mask:0xf bank_mask:0xf
  v_mov_b32 v140, v139
  v_mfma_f32_16x16x32_bf16 v[64:67], a[160:163], a[0:3], v[64:67]
  ds_read_b64_tr_b16 a[176:177], v230 offset:32768
  v_permlane16_swap_b32 v139, v140
  v_mfma_f32_16x16x32_bf16 v[64:67], a[164:167], a[16:19], v[64:67]
  v_min_u32 v139, v139, v140
  v_mov_b32 v140, v139
  v_mfma_f32_16x16x32_bf16 v[68:71], a[164:167], a[20:23], v[68:71]
  ds_read_b64_tr_b16 a[178:179], v230 offset:33792
  v_permlane32_swap_b32 v139, v140
  v_mfma_f32_16x16x32_bf16 v[68:71], a[160:163], a[4:7], v[68:71]
  v_min_u32 v139, v139, v140
  v_sub_u32 v138, v137, v139
  v_mfma_f32_16x16x32_bf16 v[72:75], a[160:163], a[8:11], v[72:75]
  ds_read_b64_tr_b16 a[180:181], v230 offset:40960
  v_add_u32 v137, -1, v138
  v_mfma_f32_16x16x32_bf16 v[72:75], a[164:167], a[24:27], v[72:75]
  buffer_load_dwordx4 v236, s[16:19], s29 offen offset:2048 lds
  v_mfma_f32_16x16x32_bf16 v[76:79], a[164:167], a[28:31], v[76:79]
  ds_read_b64_tr_b16 a[182:183], v230 offset:41984
  v_sub_u32 v140, v137, v128
  v_mfma_f32_16x16x32_bf16 v[76:79], a[160:163], a[12:15], v[76:79]
  s_waitcnt lgkmcnt(4)
  v_readfirstlane_b32 s58, v138
  v_sub_u32 v141, v137, v129
  v_mfma_f32_16x16x32_bf16 v[80:83], a[168:171], a[0:3], v[80:83]
  ds_read_b64_tr_b16 a[184:185], v231 offset:32768
  v_min_u32 v139, v140, v141
  v_mfma_f32_16x16x32_bf16 v[80:83], a[172:175], a[16:19], v[80:83]
  v_mfma_f32_16x16x32_bf16 v[84:87], a[172:175], a[20:23], v[84:87]
  ds_read_b64_tr_b16 a[186:187], v231 offset:33792
  v_min_u32_dpp v139, v139, v139 row_ror:8 row_mask:0xf bank_mask:0xf
  v_mfma_f32_16x16x32_bf16 v[84:87], a[168:171], a[4:7], v[84:87]
  s_waitcnt vmcnt(8)
  v_min_u32_dpp v139, v139, v139 row_ror:4 row_mask:0xf bank_mask:0xf
  v_mfma_f32_16x16x32_bf16 v[88:91], a[168:171], a[8:11], v[88:91]
  ds_read_b64_tr_b16 a[188:189], v231 offset:40960
  v_min_u32_dpp v139, v139, v139 row_ror:2 row_mask:0xf bank_mask:0xf
  v_mfma_f32_16x16x32_bf16 v[88:91], a[172:175], a[24:27], v[88:91]
  s_barrier
  v_min_u32_dpp v139, v139, v139 row_ror:1 row_mask:0xf bank_mask:0xf
  v_mov_b32 v140, v139
  v_mfma_f32_16x16x32_bf16 v[92:95], a[172:175], a[28:31], v[92:95]
  ds_read_b64_tr_b16 a[190:191], v231 offset:41984
  v_permlane16_swap_b32 v139, v140
  v_mfma_f32_16x16x32_bf16 v[92:95], a[168:171], a[12:15], v[92:95]
  s_waitcnt lgkmcnt(4)
  v_min_u32 v139, v139, v140
  v_mov_b32 v140, v139
  v_mfma_f32_16x16x32_bf16 v[96:99], a[176:179], a[0:3], v[96:99]
  ds_read_b64_tr_b16 a[160:161], v224 offset:49152
  v_permlane32_swap_b32 v139, v140
  v_mfma_f32_16x16x32_bf16 v[96:99], a[180:183], a[16:19], v[96:99]
  v_min_u32 v139, v139, v140
  v_sub_u32 v138, v137, v139
  v_mfma_f32_16x16x32_bf16 v[100:103], a[180:183], a[20:23], v[100:103]
  ds_read_b64_tr_b16 a[162:163], v224 offset:50176
  v_add_u32 v137, -1, v138
  v_mfma_f32_16x16x32_bf16 v[100:103], a[176:179], a[4:7], v[100:103]
  v_readfirstlane_b32 s59, v138
  v_lshrrev_b32 v136, 4, v242
  v_mfma_f32_16x16x32_bf16 v[104:107], a[176:179], a[8:11], v[104:107]
  ds_read_b64_tr_b16 a[164:165], v224 offset:57344
  v_mov_b32 v128, 0
  v_mfma_f32_16x16x32_bf16 v[104:107], a[180:183], a[24:27], v[104:107]
  buffer_load_dwordx4 v237, s[16:19], s29 offen offset:3072 lds
  s_add_u32 s29, s29, 16384
  v_mfma_f32_16x16x32_bf16 v[108:111], a[180:183], a[28:31], v[108:111]
  ds_read_b64_tr_b16 a[166:167], v224 offset:58368
  v_writelane_b32 v128, s52, 0
  v_mfma_f32_16x16x32_bf16 v[108:111], a[176:179], a[12:15], v[108:111]
  s_waitcnt lgkmcnt(4)
  v_writelane_b32 v128, s53, 1
  v_writelane_b32 v128, s54, 2
  v_mfma_f32_16x16x32_bf16 v[112:115], a[184:187], a[0:3], v[112:115]
  ds_read_b64_tr_b16 a[168:169], v225 offset:49152
  v_writelane_b32 v128, s55, 3
  v_mfma_f32_16x16x32_bf16 v[112:115], a[188:191], a[16:19], v[112:115]
  v_writelane_b32 v128, s56, 4
  v_writelane_b32 v128, s57, 5
  v_mfma_f32_16x16x32_bf16 v[116:119], a[188:191], a[20:23], v[116:119]
  ds_read_b64_tr_b16 a[170:171], v225 offset:50176
  v_writelane_b32 v128, s58, 6
  v_mfma_f32_16x16x32_bf16 v[116:119], a[184:187], a[4:7], v[116:119]
  v_writelane_b32 v128, s59, 7
  v_and_b32 v129, 0xffff, v128
  v_mfma_f32_16x16x32_bf16 v[120:123], a[184:187], a[8:11], v[120:123]
  ds_read_b64_tr_b16 a[172:173], v225 offset:57344
  v_sub_u32 v129, 0xffff, v129
  v_mfma_f32_16x16x32_bf16 v[120:123], a[188:191], a[24:27], v[120:123]
  v_and_b32 v129, 0x7ff, v129
  v_mov_b32 v130, v129
  v_mfma_f32_16x16x32_bf16 v[124:127], a[188:191], a[28:31], v[124:127]
  ds_read_b64_tr_b16 a[174:175], v225 offset:58368
  v_permlane16_swap_b32 v129, v130
  v_mfma_f32_16x16x32_bf16 v[124:127], a[184:187], a[12:15], v[124:127]
  s_waitcnt vmcnt(8) lgkmcnt(4)
  v_mov_b32 v130, v129
  v_mfma_f32_16x16x32_bf16 v[0:3], a[160:163], a[32:35], v[0:3]
  ds_read_b64_tr_b16 a[176:177], v226 offset:49152
  s_add_u32 m0, s28, 16384
  v_permlane32_swap_b32 v129, v130
  v_mfma_f32_16x16x32_bf16 v[0:3], a[164:167], a[48:51], v[0:3]
  buffer_load_dwordx4 v232, s[12:15], s29 offen offset:0 lds
  v_mfma_f32_16x16x32_bf16 v[4:7], a[164:167], a[52:55], v[4:7]
  ds_read_b64_tr_b16 a[178:179], v226 offset:50176
  v_lshrrev_b32 v130, 6, v129
  v_mfma_f32_16x16x32_bf16 v[4:7], a[160:163], a[36:39], v[4:7]
  v_mul_u32_u24 v130, 0x14000, v130
  v_bfe_u32 v131, v129, 4, 2
  v_mfma_f32_16x16x32_bf16 v[8:11], a[160:163], a[40:43], v[8:11]
  ds_read_b64_tr_b16 a[180:181], v226 offset:57344
  v_lshl_add_u32 v130, v131, 10, v130
  v_mfma_f32_16x16x32_bf16 v[8:11], a[164:167], a[56:59], v[8:11]
  buffer_load_dwordx4 v233, s[12:15], s29 offen offset:1024 lds
  v_mfma_f32_16x16x32_bf16 v[12:15], a[164:167], a[60:63], v[12:15]
  ds_read_b64_tr_b16 a[182:183], v226 offset:58368
  v_and_b32 v131, 15, v129
  v_mfma_f32_16x16x32_bf16 v[12:15], a[160:163], a[44:47], v[12:15]
  s_waitcnt lgkmcnt(4)
  v_lshl_add_u32 v130, v131, 4, v130
  v_lshrrev_b32 v131, 4, v136
  v_mfma_f32_16x16x32_bf16 v[16:19], a[168:171], a[32:35], v[16:19]
  ds_read_b64_tr_b16 a[184:185], v227 offset:49152
  v_lshl_add_u32 v243, v131, 8, v130
  v_mfma_f32_16x16x32_bf16 v[16:19], a[172:175], a[48:51], v[16:19]
  buffer_load_dwordx4 v234, s[12:15], s29 offen offset:2048 lds
  v_mfma_f32_16x16x32_bf16 v[20:23], a[172:175], a[52:55], v[20:23]
  ds_read_b64_tr_b16 a[186:187], v227 offset:50176
  v_mfma_f32_16x16x32_bf16 v[20:23], a[168:171], a[36:39], v[20:23]
  buffer_load_dwordx4 v235, s[12:15], s29 offen offset:3072 lds
  v_mfma_f32_16x16x32_bf16 v[24:27], a[168:171], a[40:43], v[24:27]
  ds_read_b64_tr_b16 a[188:189], v227 offset:57344
  v_mfma_f32_16x16x32_bf16 v[24:27], a[172:175], a[56:59], v[24:27]
  v_mul_f32 v0, s34, v0
  v_mul_f32 v1, s34, v1
  v_mfma_f32_16x16x32_bf16 v[28:31], a[172:175], a[60:63], v[28:31]
  ds_read_b64_tr_b16 a[190:191], v227 offset:58368
  v_mul_f32 v2, s34, v2
  v_mfma_f32_16x16x32_bf16 v[28:31], a[168:171], a[44:47], v[28:31]
  s_waitcnt lgkmcnt(4)
  v_mul_f32 v3, s34, v3
  v_mul_f32 v16, s34, v16
  v_mfma_f32_16x16x32_bf16 v[32:35], a[176:179], a[32:35], v[32:35]
  ds_read_b64_tr_b16 a[160:161], v228 offset:49152
  v_mul_f32 v17, s34, v17
  v_mfma_f32_16x16x32_bf16 v[32:35], a[180:183], a[48:51], v[32:35]
  v_mul_f32 v18, s34, v18
  v_mul_f32 v19, s34, v19
  v_mfma_f32_16x16x32_bf16 v[36:39], a[180:183], a[52:55], v[36:39]
  ds_read_b64_tr_b16 a[162:163], v228 offset:50176
  v_cvt_pk_bf16_f32 v128, v0, v1
  v_mfma_f32_16x16x32_bf16 v[36:39], a[176:179], a[36:39], v[36:39]
  v_cvt_pk_bf16_f32 v129, v2, v3
  v_cvt_pk_bf16_f32 v130, v16, v17
  v_mfma_f32_16x16x32_bf16 v[40:43], a[176:179], a[40:43], v[40:43]
  ds_read_b64_tr_b16 a[164:165], v228 offset:57344
  v_cvt_pk_bf16_f32 v131, v18, v19
  v_mfma_f32_16x16x32_bf16 v[40:43], a[180:183], a[56:59], v[40:43]
  v_mul_f32 v4, s34, v4
  v_mul_f32 v5, s34, v5
  v_mfma_f32_16x16x32_bf16 v[44:47], a[180:183], a[60:63], v[44:47]
  ds_read_b64_tr_b16 a[166:167], v228 offset:58368
  v_mul_f32 v6, s34, v6
  v_mfma_f32_16x16x32_bf16 v[44:47], a[176:179], a[44:47], v[44:47]
  s_waitcnt lgkmcnt(4)
  v_mul_f32 v7, s34, v7
  v_mul_f32 v20, s34, v20
  v_mfma_f32_16x16x32_bf16 v[48:51], a[184:187], a[32:35], v[48:51]
  ds_read_b64_tr_b16 a[168:169], v229 offset:49152
  v_mul_f32 v21, s34, v21
  v_mfma_f32_16x16x32_bf16 v[48:51], a[188:191], a[48:51], v[48:51]
  v_mul_f32 v22, s34, v22
  v_mul_f32 v23, s34, v23
  v_mfma_f32_16x16x32_bf16 v[52:55], a[188:191], a[52:55], v[52:55]
  ds_read_b64_tr_b16 a[170:171], v229 offset:50176
  v_cvt_pk_bf16_f32 v144, v4, v5
  v_mfma_f32_16x16x32_bf16 v[52:55], a[184:187], a[36:39], v[52:55]
  v_cvt_pk_bf16_f32 v145, v6, v7
  v_cvt_pk_bf16_f32 v146, v20, v21
  v_mfma_f32_16x16x32_bf16 v[56:59], a[184:187], a[40:43], v[56:59]
  ds_read_b64_tr_b16 a[172:173], v229 offset:57344
  v_cvt_pk_bf16_f32 v147, v22, v23
  v_mfma_f32_16x16x32_bf16 v[56:59], a[188:191], a[56:59], v[56:59]
  v_permlane16_swap_b32 v128, v130
  v_permlane16_swap_b32 v129, v131
  v_mfma_f32_16x16x32_bf16 v[60:63], a[188:191], a[60:63], v[60:63]
  ds_read_b64_tr_b16 a[174:175], v229 offset:58368
  v_mul_f32 v8, s34, v8
  v_mfma_f32_16x16x32_bf16 v[60:63], a[184:187], a[44:47], v[60:63]
  s_waitcnt lgkmcnt(4)
  v_mul_f32 v9, s34, v9
  v_mul_f32 v10, s34, v10
  v_mfma_f32_16x16x32_bf16 v[64:67], a[160:163], a[32:35], v[64:67]
  ds_read_b64_tr_b16 a[176:177], v230 offset:49152
  v_mul_f32 v11, s34, v11
  v_mfma_f32_16x16x32_bf16 v[64:67], a[164:167], a[48:51], v[64:67]
  v_mul_f32 v24, s34, v24
  v_mul_f32 v25, s34, v25
  v_mfma_f32_16x16x32_bf16 v[68:71], a[164:167], a[52:55], v[68:71]
  ds_read_b64_tr_b16 a[178:179], v230 offset:50176
  v_mul_f32 v26, s34, v26
  v_mfma_f32_16x16x32_bf16 v[68:71], a[160:163], a[36:39], v[68:71]
  v_mul_f32 v27, s34, v27
  v_cvt_pk_bf16_f32 v160, v8, v9
  v_mfma_f32_16x16x32_bf16 v[72:75], a[160:163], a[40:43], v[72:75]
  ds_read_b64_tr_b16 a[180:181], v230 offset:57344
  v_cvt_pk_bf16_f32 v161, v10, v11
  v_mfma_f32_16x16x32_bf16 v[72:75], a[164:167], a[56:59], v[72:75]
  v_cvt_pk_bf16_f32 v162, v24, v25
  v_cvt_pk_bf16_f32 v163, v26, v27
  v_mfma_f32_16x16x32_bf16 v[76:79], a[164:167], a[60:63], v[76:79]
  ds_read_b64_tr_b16 a[182:183], v230 offset:58368
  v_permlane16_swap_b32 v144, v146
  v_mfma_f32_16x16x32_bf16 v[76:79], a[160:163], a[44:47], v[76:79]
  s_waitcnt lgkmcnt(4)
  v_permlane16_swap_b32 v145, v147
  v_mul_f32 v12, s34, v12
  v_mfma_f32_16x16x32_bf16 v[80:83], a[168:171], a[32:35], v[80:83]
  ds_read_b64_tr_b16 a[184:185], v231 offset:49152
  v_mul_f32 v13, s34, v13
  v_mfma_f32_16x16x32_bf16 v[80:83], a[172:175], a[48:51], v[80:83]
  v_mul_f32 v14, s34, v14
  v_mul_f32 v15, s34, v15
  v_mfma_f32_16x16x32_bf16 v[84:87], a[172:175], a[52:55], v[84:87]
  ds_read_b64_tr_b16 a[186:187], v231 offset:50176
  v_mul_f32 v28, s34, v28
  v_mfma_f32_16x16x32_bf16 v[84:87], a[168:171], a[36:39], v[84:87]
  s_waitcnt vmcnt(8)
  v_mul_f32 v29, s34, v29
  v_mul_f32 v30, s34, v30
  v_mfma_f32_16x16x32_bf16 v[88:91], a[168:171], a[40:43], v[88:91]
  ds_read_b64_tr_b16 a[188:189], v231 offset:57344
  v_mul_f32 v31, s34, v31
  v_mfma_f32_16x16x32_bf16 v[88:91], a[172:175], a[56:59], v[88:91]
  s_barrier
  v_cvt_pk_bf16_f32 v176, v12, v13
  v_cvt_pk_bf16_f32 v177, v14, v15
  v_mfma_f32_16x16x32_bf16 v[92:95], a[172:175], a[60:63], v[92:95]
  ds_read_b64_tr_b16 a[190:191], v231 offset:58368
  v_cvt_pk_bf16_f32 v178, v28, v29
  v_mfma_f32_16x16x32_bf16 v[92:95], a[168:171], a[44:47], v[92:95]
  s_waitcnt lgkmcnt(4)
  v_cvt_pk_bf16_f32 v179, v30, v31
  v_permlane16_swap_b32 v160, v162
  v_mfma_f32_16x16x32_bf16 v[96:99], a[176:179], a[32:35], v[96:99]
  ds_read_b128 a[128:131], v212 offset:0
  v_permlane16_swap_b32 v161, v163
  v_mfma_f32_16x16x32_bf16 v[96:99], a[180:183], a[48:51], v[96:99]
  v_mul_f32 v32, s34, v32
  v_mul_f32 v33, s34, v33
  v_mfma_f32_16x16x32_bf16 v[100:103], a[180:183], a[52:55], v[100:103]
  ds_read_b128 a[132:135], v213 offset:0
  v_mul_f32 v34, s34, v34
  v_mfma_f32_16x16x32_bf16 v[100:103], a[176:179], a[36:39], v[100:103]
  v_mul_f32 v35, s34, v35
  v_mul_f32 v48, s34, v48
  v_mfma_f32_16x16x32_bf16 v[104:107], a[176:179], a[40:43], v[104:107]
  ds_read_b128 a[136:139], v214 offset:0
  v_mul_f32 v49, s34, v49
  v_mfma_f32_16x16x32_bf16 v[104:107], a[180:183], a[56:59], v[104:107]
  v_mul_f32 v50, s34, v50
  v_mul_f32 v51, s34, v51
  v_mfma_f32_16x16x32_bf16 v[108:111], a[180:183], a[60:63], v[108:111]
  ds_read_b128 a[140:143], v215 offset:0
  v_cvt_pk_bf16_f32 v132, v32, v33
  v_mfma_f32_16x16x32_bf16 v[108:111], a[176:179], a[44:47], v[108:111]
  s_waitcnt lgkmcnt(4)
  v_cvt_pk_bf16_f32 v133, v34, v35
  v_cvt_pk_bf16_f32 v134, v48, v49
  v_mfma_f32_16x16x32_bf16 v[112:115], a[184:187], a[32:35], v[112:115]
  v_cvt_pk_bf16_f32 v135, v50, v51
  v_permlane16_swap_b32 v176, v178
  v_mfma_f32_16x16x32_bf16 v[112:115], a[188:191], a[48:51], v[112:115]
  v_permlane16_swap_b32 v177, v179
  v_mul_f32 v36, s34, v36
  v_mfma_f32_16x16x32_bf16 v[116:119], a[188:191], a[52:55], v[116:119]
  v_mul_f32 v37, s34, v37
  v_mul_f32 v38, s34, v38
  v_mfma_f32_16x16x32_bf16 v[116:119], a[184:187], a[36:39], v[116:119]
  v_mul_f32 v39, s34, v39
  v_mul_f32 v52, s34, v52
  v_mfma_f32_16x16x32_bf16 v[120:123], a[184:187], a[40:43], v[120:123]
  v_mul_f32 v53, s34, v53
  v_mul_f32 v54, s34, v54
  v_mfma_f32_16x16x32_bf16 v[120:123], a[188:191], a[56:59], v[120:123]
  v_mul_f32 v55, s34, v55
  v_cvt_pk_bf16_f32 v148, v36, v37
  v_mfma_f32_16x16x32_bf16 v[124:127], a[188:191], a[60:63], v[124:127]
  v_cvt_pk_bf16_f32 v149, v38, v39
  v_cvt_pk_bf16_f32 v150, v52, v53
  v_mfma_f32_16x16x32_bf16 v[124:127], a[184:187], a[44:47], v[124:127]
  s_waitcnt lgkmcnt(0)
  v_cvt_pk_bf16_f32 v151, v54, v55
  v_permlane16_swap_b32 v132, v134
  v_permlane16_swap_b32 v133, v135
  v_pk_mul_f32 v[40:41], v[40:41], s[34:35] op_sel_hi:[1,0]
  v_pk_mul_f32 v[42:43], v[42:43], s[34:35] op_sel_hi:[1,0]
  v_pk_mul_f32 v[56:57], v[56:57], s[34:35] op_sel_hi:[1,0]
  v_pk_mul_f32 v[58:59], v[58:59], s[34:35] op_sel_hi:[1,0]
  v_cvt_pk_bf16_f32 v164, v40, v41
  v_cvt_pk_bf16_f32 v165, v42, v43
  v_cvt_pk_bf16_f32 v166, v56, v57
  v_cvt_pk_bf16_f32 v167, v58, v59
  v_permlane16_swap_b32 v148, v150
  v_permlane16_swap_b32 v149, v151
  v_pk_mul_f32 v[44:45], v[44:45], s[34:35] op_sel_hi:[1,0]
  v_pk_mul_f32 v[46:47], v[46:47], s[34:35] op_sel_hi:[1,0]
  v_pk_mul_f32 v[60:61], v[60:61], s[34:35] op_sel_hi:[1,0]
  v_pk_mul_f32 v[62:63], v[62:63], s[34:35] op_sel_hi:[1,0]
  v_cvt_pk_bf16_f32 v180, v44, v45
  v_cvt_pk_bf16_f32 v181, v46, v47
  v_cvt_pk_bf16_f32 v182, v60, v61
  v_cvt_pk_bf16_f32 v183, v62, v63
  v_permlane16_swap_b32 v164, v166
  v_permlane16_swap_b32 v165, v167
  v_pk_mul_f32 v[64:65], v[64:65], s[34:35] op_sel_hi:[1,0]
  v_pk_mul_f32 v[66:67], v[66:67], s[34:35] op_sel_hi:[1,0]
  v_pk_mul_f32 v[80:81], v[80:81], s[34:35] op_sel_hi:[1,0]
  v_pk_mul_f32 v[82:83], v[82:83], s[34:35] op_sel_hi:[1,0]
  v_cvt_pk_bf16_f32 v136, v64, v65
  v_cvt_pk_bf16_f32 v137, v66, v67
  v_cvt_pk_bf16_f32 v138, v80, v81
  v_cvt_pk_bf16_f32 v139, v82, v83
  v_permlane16_swap_b32 v180, v182
  v_permlane16_swap_b32 v181, v183
  v_pk_mul_f32 v[68:69], v[68:69], s[34:35] op_sel_hi:[1,0]
  v_pk_mul_f32 v[70:71], v[70:71], s[34:35] op_sel_hi:[1,0]
  v_pk_mul_f32 v[84:85], v[84:85], s[34:35] op_sel_hi:[1,0]
  v_pk_mul_f32 v[86:87], v[86:87], s[34:35] op_sel_hi:[1,0]
  v_cvt_pk_bf16_f32 v152, v68, v69
  v_cvt_pk_bf16_f32 v153, v70, v71
  v_cvt_pk_bf16_f32 v154, v84, v85
  v_cvt_pk_bf16_f32 v155, v86, v87
  v_permlane16_swap_b32 v136, v138
  v_permlane16_swap_b32 v137, v139
  v_pk_mul_f32 v[72:73], v[72:73], s[34:35] op_sel_hi:[1,0]
  v_pk_mul_f32 v[74:75], v[74:75], s[34:35] op_sel_hi:[1,0]
  v_pk_mul_f32 v[88:89], v[88:89], s[34:35] op_sel_hi:[1,0]
  v_pk_mul_f32 v[90:91], v[90:91], s[34:35] op_sel_hi:[1,0]
  v_cvt_pk_bf16_f32 v168, v72, v73
  v_cvt_pk_bf16_f32 v169, v74, v75
  v_cvt_pk_bf16_f32 v170, v88, v89
  v_cvt_pk_bf16_f32 v171, v90, v91
  v_permlane16_swap_b32 v152, v154
  v_permlane16_swap_b32 v153, v155
  v_pk_mul_f32 v[76:77], v[76:77], s[34:35] op_sel_hi:[1,0]
  v_pk_mul_f32 v[78:79], v[78:79], s[34:35] op_sel_hi:[1,0]
  v_pk_mul_f32 v[92:93], v[92:93], s[34:35] op_sel_hi:[1,0]
  v_pk_mul_f32 v[94:95], v[94:95], s[34:35] op_sel_hi:[1,0]
  v_cvt_pk_bf16_f32 v184, v76, v77
  v_cvt_pk_bf16_f32 v185, v78, v79
  v_cvt_pk_bf16_f32 v186, v92, v93
  v_cvt_pk_bf16_f32 v187, v94, v95
  v_permlane16_swap_b32 v168, v170
  v_permlane16_swap_b32 v169, v171
  v_pk_mul_f32 v[96:97], v[96:97], s[34:35] op_sel_hi:[1,0]
  v_pk_mul_f32 v[98:99], v[98:99], s[34:35] op_sel_hi:[1,0]
  v_pk_mul_f32 v[112:113], v[112:113], s[34:35] op_sel_hi:[1,0]
  v_pk_mul_f32 v[114:115], v[114:115], s[34:35] op_sel_hi:[1,0]
  v_cvt_pk_bf16_f32 v140, v96, v97
  v_cvt_pk_bf16_f32 v141, v98, v99
  v_cvt_pk_bf16_f32 v142, v112, v113
  v_cvt_pk_bf16_f32 v143, v114, v115
  v_permlane16_swap_b32 v184, v186
  v_permlane16_swap_b32 v185, v187
  v_pk_mul_f32 v[100:101], v[100:101], s[34:35] op_sel_hi:[1,0]
  v_pk_mul_f32 v[102:103], v[102:103], s[34:35] op_sel_hi:[1,0]
  v_pk_mul_f32 v[116:117], v[116:117], s[34:35] op_sel_hi:[1,0]
  v_pk_mul_f32 v[118:119], v[118:119], s[34:35] op_sel_hi:[1,0]
  v_cvt_pk_bf16_f32 v156, v100, v101
  v_cvt_pk_bf16_f32 v157, v102, v103
  v_cvt_pk_bf16_f32 v158, v116, v117
  v_cvt_pk_bf16_f32 v159, v118, v119
  v_permlane16_swap_b32 v140, v142
  v_permlane16_swap_b32 v141, v143
  v_pk_mul_f32 v[104:105], v[104:105], s[34:35] op_sel_hi:[1,0]
  v_pk_mul_f32 v[106:107], v[106:107], s[34:35] op_sel_hi:[1,0]
  v_pk_mul_f32 v[120:121], v[120:121], s[34:35] op_sel_hi:[1,0]
  v_pk_mul_f32 v[122:123], v[122:123], s[34:35] op_sel_hi:[1,0]
  v_cvt_pk_bf16_f32 v172, v104, v105
  v_cvt_pk_bf16_f32 v173, v106, v107
  v_cvt_pk_bf16_f32 v174, v120, v121
  v_cvt_pk_bf16_f32 v175, v122, v123
  v_permlane16_swap_b32 v156, v158
  v_permlane16_swap_b32 v157, v159
  v_pk_mul_f32 v[108:109], v[108:109], s[34:35] op_sel_hi:[1,0]
  v_pk_mul_f32 v[110:111], v[110:111], s[34:35] op_sel_hi:[1,0]
  v_pk_mul_f32 v[124:125], v[124:125], s[34:35] op_sel_hi:[1,0]
  v_pk_mul_f32 v[126:127], v[126:127], s[34:35] op_sel_hi:[1,0]
  v_cvt_pk_bf16_f32 v188, v108, v109
  v_cvt_pk_bf16_f32 v189, v110, v111
  v_cvt_pk_bf16_f32 v190, v124, v125
  v_cvt_pk_bf16_f32 v191, v126, v127
  v_permlane16_swap_b32 v172, v174
  v_permlane16_swap_b32 v173, v175
  v_permlane16_swap_b32 v188, v190
  v_permlane16_swap_b32 v189, v191
  v_mfma_f32_16x16x32_bf16 v[0:3], a[128:131], v[128:131], 0
  s_add_u32 m0, s28, 81920
  ds_read_b128 a[144:147], v212 offset:4096
  s_mov_b32 s20, s90
  s_mov_b32 s21, s91
  v_mfma_f32_16x16x32_bf16 v[0:3], a[132:135], v[132:135], v[0:3]
  buffer_load_dwordx4 v236, s[16:19], s29 offen offset:0 lds
  s_mov_b32 s22, 2211840
  s_mov_b32 s23, 0x20000
  s_mov_b32 s44, s92
  v_mfma_f32_16x16x32_bf16 v[0:3], a[136:139], v[136:139], v[0:3]
  ds_read_b128 a[148:151], v213 offset:4096
  s_mov_b32 s45, s93
  s_mov_b32 s46, 2211840
  s_mov_b32 s47, 0x20000
  v_lshrrev_b32 v253, 4, v242
  v_mfma_f32_16x16x32_bf16 v[0:3], a[140:143], v[140:143], v[0:3]
  buffer_load_dwordx4 v237, s[16:19], s29 offen offset:1024 lds
  v_mfma_f32_16x16x32_bf16 v[8:11], a[140:143], v[156:159], 0
  ds_read_b128 a[152:155], v214 offset:4096
  v_mul_u32_u24 v253, 0xd80, v253
  v_mfma_f32_16x16x32_bf16 v[8:11], a[136:139], v[152:155], v[8:11]
  buffer_load_dwordx4 v236, s[16:19], s29 offen offset:2048 lds
  s_mul_i32 s35, s3, 552960
  s_lshl_b32 s38, s33, 4
  s_add_u32 s35, s35, s38
  v_mfma_f32_16x16x32_bf16 v[8:11], a[132:135], v[148:151], v[8:11]
  ds_read_b128 a[156:159], v215 offset:4096
  v_mfma_f32_16x16x32_bf16 v[8:11], a[128:131], v[144:147], v[8:11]
  buffer_load_dwordx4 v237, s[16:19], s29 offen offset:3072 lds
  v_mfma_f32_16x16x32_bf16 v[16:19], a[128:131], v[160:163], 0
  s_add_u32 s29, s29, 16384
  s_add_u32 m0, s28, 32768
  v_mfma_f32_16x16x32_bf16 v[16:19], a[132:135], v[164:167], v[16:19]
  buffer_load_dwordx4 v232, s[12:15], s29 offen offset:0 lds
  v_mfma_f32_16x16x32_bf16 v[16:19], a[136:139], v[168:171], v[16:19]
  buffer_load_dwordx4 v233, s[12:15], s29 offen offset:1024 lds
  v_mfma_f32_16x16x32_bf16 v[16:19], a[140:143], v[172:175], v[16:19]
  v_max3_f32 v192, v0, v1, v2
  v_max3_f32 v196, v8, v9, v10
  v_mfma_f32_16x16x32_bf16 v[24:27], a[140:143], v[188:191], 0
  v_max_f32 v192, v192, v3
  v_max_f32 v196, v196, v11
  v_mfma_f32_16x16x32_bf16 v[24:27], a[136:139], v[184:187], v[24:27]
  v_mov_b32 v245, v192
  v_mov_b32 v246, v196
  v_mfma_f32_16x16x32_bf16 v[24:27], a[132:135], v[180:183], v[24:27]
  v_permlane16_swap_b32 v192, v245
  v_permlane16_swap_b32 v196, v246
  v_mfma_f32_16x16x32_bf16 v[24:27], a[128:131], v[176:179], v[24:27]
  s_waitcnt lgkmcnt(0)
  v_max_f32 v192, v192, v245
  v_max_f32 v196, v196, v246
  v_mfma_f32_16x16x32_bf16 v[4:7], a[144:147], v[128:131], 0
  ds_read_b128 a[128:131], v212 offset:8192
  v_mov_b32 v245, v192
  v_mfma_f32_16x16x32_bf16 v[4:7], a[148:151], v[132:135], v[4:7]
  v_mov_b32 v246, v196
  v_permlane32_swap_b32 v192, v245
  v_mfma_f32_16x16x32_bf16 v[4:7], a[152:155], v[136:139], v[4:7]
  ds_read_b128 a[132:135], v213 offset:8192
  v_permlane32_swap_b32 v196, v246
  v_mfma_f32_16x16x32_bf16 v[4:7], a[156:159], v[140:143], v[4:7]
  v_max_f32 v192, v192, v245
  v_max_f32 v196, v196, v246
  v_mfma_f32_16x16x32_bf16 v[12:15], a[156:159], v[156:159], 0
  ds_read_b128 a[136:139], v214 offset:8192
  v_sub_f32 v193, 0, v192
  v_mfma_f32_16x16x32_bf16 v[12:15], a[152:155], v[152:155], v[12:15]
  v_sub_f32 v197, 0, v196
  v_sub_f32 v194, 0, v192
  v_mfma_f32_16x16x32_bf16 v[12:15], a[148:151], v[148:151], v[12:15]
  ds_read_b128 a[140:143], v215 offset:8192
  v_sub_f32 v198, 0, v196
  v_mfma_f32_16x16x32_bf16 v[12:15], a[144:147], v[144:147], v[12:15]
  v_sub_f32 v195, 0, v192
  v_sub_f32 v199, 0, v196
  v_mfma_f32_16x16x32_bf16 v[20:23], a[144:147], v[160:163], 0
  buffer_load_dwordx4 v234, s[12:15], s29 offen offset:2048 lds
  v_mfma_f32_16x16x32_bf16 v[20:23], a[148:151], v[164:167], v[20:23]
  v_sub_f32 v192, 0, v192
  v_sub_f32 v196, 0, v196
  v_mfma_f32_16x16x32_bf16 v[20:23], a[152:155], v[168:171], v[20:23]
  buffer_load_dwordx4 v235, s[12:15], s29 offen offset:3072 lds
  v_mfma_f32_16x16x32_bf16 v[20:23], a[156:159], v[172:175], v[20:23]
  v_max3_f32 v200, v16, v17, v18
  v_max3_f32 v204, v24, v25, v26
  v_mfma_f32_16x16x32_bf16 v[28:31], a[156:159], v[188:191], 0
  v_max_f32 v200, v200, v19
  v_max_f32 v204, v204, v27
  v_mfma_f32_16x16x32_bf16 v[28:31], a[152:155], v[184:187], v[28:31]
  v_mov_b32 v247, v200
  v_mov_b32 v248, v204
  v_mfma_f32_16x16x32_bf16 v[28:31], a[148:151], v[180:183], v[28:31]
  v_permlane16_swap_b32 v200, v247
  v_permlane16_swap_b32 v204, v248
  v_max_f32 v200, v200, v247
  v_max_f32 v204, v204, v248
  v_mov_b32 v247, v200
  v_mov_b32 v248, v204
  s_nop 0
  v_permlane32_swap_b32 v200, v247
  v_permlane32_swap_b32 v204, v248
  v_max_f32 v200, v200, v247
  v_max_f32 v204, v204, v248
  v_sub_f32 v201, 0, v200
  v_sub_f32 v205, 0, v204
  v_sub_f32 v202, 0, v200
  v_sub_f32 v206, 0, v204
  v_sub_f32 v203, 0, v200
  v_sub_f32 v207, 0, v204
  v_sub_f32 v200, 0, v200
  v_sub_f32 v204, 0, v204
  v_mfma_f32_16x16x32_bf16 v[28:31], a[144:147], v[176:179], v[28:31]
  s_waitcnt lgkmcnt(0)
  v_add_f32 v0, v192, v0
  v_add_f32 v1, v192, v1
  v_mfma_f32_16x16x32_bf16 v[32:35], a[128:131], v[128:131], v[192:195]
  ds_read_b128 a[144:147], v212 offset:12288
  v_add_f32 v2, v192, v2
  v_mfma_f32_16x16x32_bf16 v[32:35], a[132:135], v[132:135], v[32:35]
  v_add_f32 v3, v192, v3
  v_mfma_f32_16x16x32_bf16 v[32:35], a[136:139], v[136:139], v[32:35]
  ds_read_b128 a[148:151], v213 offset:12288
  v_mfma_f32_16x16x32_bf16 v[32:35], a[140:143], v[140:143], v[32:35]
  v_exp_f32 v0, v0
  v_mfma_f32_16x16x32_bf16 v[40:43], a[140:143], v[156:159], v[196:199]
  ds_read_b128 a[152:155], v214 offset:12288
  v_mfma_f32_16x16x32_bf16 v[40:43], a[136:139], v[152:155], v[40:43]
  v_exp_f32 v1, v1
  v_mfma_f32_16x16x32_bf16 v[40:43], a[132:135], v[148:151], v[40:43]
  ds_read_b128 a[156:159], v215 offset:12288
  v_mfma_f32_16x16x32_bf16 v[40:43], a[128:131], v[144:147], v[40:43]
  v_exp_f32 v2, v2
  v_mfma_f32_16x16x32_bf16 v[48:51], a[128:131], v[160:163], v[200:203]
  s_add_u32 m0, s50, 0
  v_cvt_pk_bf16_f32 v0, v0, v1
  v_mfma_f32_16x16x32_bf16 v[48:51], a[132:135], v[164:167], v[48:51]
  v_exp_f32 v3, v3
  v_mfma_f32_16x16x32_bf16 v[48:51], a[136:139], v[168:171], v[48:51]
  v_add_f32 v8, v196, v8
  v_add_f32 v9, v196, v9
  v_mfma_f32_16x16x32_bf16 v[48:51], a[140:143], v[172:175], v[48:51]
  v_add_f32 v10, v196, v10
  v_add_f32 v11, v196, v11
  v_mfma_f32_16x16x32_bf16 v[56:59], a[140:143], v[188:191], v[204:207]
  v_exp_f32 v8, v8
  v_mfma_f32_16x16x32_bf16 v[56:59], a[136:139], v[184:187], v[56:59]
  v_exp_f32 v9, v9
  buffer_load_dwordx4 v253, s[20:23], s35 offen lds
  v_mfma_f32_16x16x32_bf16 v[56:59], a[132:135], v[180:183], v[56:59]
  v_exp_f32 v10, v10
  v_mfma_f32_16x16x32_bf16 v[56:59], a[128:131], v[176:179], v[56:59]
  s_waitcnt lgkmcnt(0)
  v_cvt_pk_bf16_f32 v8, v8, v9
  v_mfma_f32_16x16x32_bf16 v[36:39], a[144:147], v[128:131], v[192:195]
  s_waitcnt vmcnt(9)
  v_exp_f32 v11, v11
  v_mfma_f32_16x16x32_bf16 v[36:39], a[148:151], v[132:135], v[36:39]
  s_barrier
  v_cvt_pk_bf16_f32 v1, v2, v3
  v_add_f32 v16, v200, v16
  v_mfma_f32_16x16x32_bf16 v[36:39], a[152:155], v[136:139], v[36:39]
  ds_read_b128 a[128:131], v212 offset:16384
  v_add_f32 v17, v200, v17
  v_mfma_f32_16x16x32_bf16 v[36:39], a[156:159], v[140:143], v[36:39]
  v_add_f32 v18, v200, v18
  v_add_f32 v19, v200, v19
  v_mfma_f32_16x16x32_bf16 v[44:47], a[156:159], v[156:159], v[196:199]
  ds_read_b128 a[132:135], v213 offset:16384
  v_mfma_f32_16x16x32_bf16 v[44:47], a[152:155], v[152:155], v[44:47]
  v_exp_f32 v16, v16
  v_mfma_f32_16x16x32_bf16 v[44:47], a[148:151], v[148:151], v[44:47]
  ds_read_b128 a[136:139], v214 offset:16384
  v_mfma_f32_16x16x32_bf16 v[44:47], a[144:147], v[144:147], v[44:47]
  v_exp_f32 v17, v17
  v_mfma_f32_16x16x32_bf16 v[52:55], a[144:147], v[160:163], v[200:203]
  ds_read_b128 a[140:143], v215 offset:16384
  v_mfma_f32_16x16x32_bf16 v[52:55], a[148:151], v[164:167], v[52:55]
  v_exp_f32 v18, v18
  v_mfma_f32_16x16x32_bf16 v[52:55], a[152:155], v[168:171], v[52:55]
  v_cvt_pk_bf16_f32 v16, v16, v17
  v_mfma_f32_16x16x32_bf16 v[52:55], a[156:159], v[172:175], v[52:55]
  v_exp_f32 v19, v19
  v_mfma_f32_16x16x32_bf16 v[60:63], a[156:159], v[188:191], v[204:207]
  v_cvt_pk_bf16_f32 v9, v10, v11
  v_add_f32 v24, v204, v24
  v_mfma_f32_16x16x32_bf16 v[60:63], a[152:155], v[184:187], v[60:63]
  v_add_f32 v25, v204, v25
  v_add_f32 v26, v204, v26
  v_mfma_f32_16x16x32_bf16 v[60:63], a[148:151], v[180:183], v[60:63]
  v_add_f32 v27, v204, v27
  v_mfma_f32_16x16x32_bf16 v[60:63], a[144:147], v[176:179], v[60:63]
  s_waitcnt lgkmcnt(0)
  v_exp_f32 v24, v24
  v_exp_f32 v25, v25
  v_exp_f32 v26, v26
  v_cvt_pk_bf16_f32 v24, v24, v25
  v_exp_f32 v27, v27
  v_cvt_pk_bf16_f32 v17, v18, v19
  v_add_f32 v4, v192, v4
  v_add_f32 v5, v192, v5
  v_add_f32 v6, v192, v6
  v_add_f32 v7, v192, v7
  v_exp_f32 v4, v4
  v_exp_f32 v5, v5
  v_exp_f32 v6, v6
  v_cvt_pk_bf16_f32 v2, v4, v5
  v_exp_f32 v7, v7
  v_cvt_pk_bf16_f32 v25, v26, v27
  v_add_f32 v12, v196, v12
  v_add_f32 v13, v196, v13
  v_add_f32 v14, v196, v14
  v_add_f32 v15, v196, v15
  v_exp_f32 v12, v12
  v_exp_f32 v13, v13
  v_exp_f32 v14, v14
  v_cvt_pk_bf16_f32 v10, v12, v13
  v_exp_f32 v15, v15
  v_cvt_pk_bf16_f32 v3, v6, v7
  v_add_f32 v20, v200, v20
  v_add_f32 v21, v200, v21
  v_add_f32 v22, v200, v22
  v_add_f32 v23, v200, v23
  v_exp_f32 v20, v20
  v_exp_f32 v21, v21
  v_exp_f32 v22, v22
  v_cvt_pk_bf16_f32 v18, v20, v21
  v_exp_f32 v23, v23
  v_cvt_pk_bf16_f32 v11, v14, v15
  v_add_f32 v28, v204, v28
  v_add_f32 v29, v204, v29
  v_add_f32 v30, v204, v30
  v_add_f32 v31, v204, v31
  v_exp_f32 v28, v28
  v_exp_f32 v29, v29
  v_exp_f32 v30, v30
  v_cvt_pk_bf16_f32 v26, v28, v29
  v_exp_f32 v31, v31
  v_cvt_pk_bf16_f32 v19, v22, v23
  v_exp_f32 v32, v32
  v_exp_f32 v33, v33
  v_exp_f32 v34, v34
  v_cvt_pk_bf16_f32 v32, v32, v33
  v_exp_f32 v35, v35
  v_cvt_pk_bf16_f32 v27, v30, v31
  v_exp_f32 v40, v40
  v_exp_f32 v41, v41
  v_exp_f32 v42, v42
  v_cvt_pk_bf16_f32 v40, v40, v41
  v_exp_f32 v43, v43
  v_cvt_pk_bf16_f32 v33, v34, v35
  v_exp_f32 v48, v48
  v_exp_f32 v49, v49
  v_exp_f32 v50, v50
  v_cvt_pk_bf16_f32 v48, v48, v49
  v_exp_f32 v51, v51
  v_cvt_pk_bf16_f32 v41, v42, v43
  v_exp_f32 v56, v56
  v_exp_f32 v57, v57
  v_exp_f32 v58, v58
  v_cvt_pk_bf16_f32 v56, v56, v57
  v_exp_f32 v59, v59
  v_cvt_pk_bf16_f32 v49, v50, v51
  v_exp_f32 v36, v36
  v_exp_f32 v37, v37
  v_exp_f32 v38, v38
  v_cvt_pk_bf16_f32 v34, v36, v37
  v_exp_f32 v39, v39
  v_cvt_pk_bf16_f32 v57, v58, v59
  v_exp_f32 v44, v44
  v_exp_f32 v45, v45
  v_exp_f32 v46, v46
  v_cvt_pk_bf16_f32 v42, v44, v45
  v_exp_f32 v47, v47
  v_cvt_pk_bf16_f32 v35, v38, v39
  v_exp_f32 v52, v52
  v_exp_f32 v53, v53
  v_exp_f32 v54, v54
  v_cvt_pk_bf16_f32 v50, v52, v53
  v_exp_f32 v55, v55
  v_cvt_pk_bf16_f32 v43, v46, v47
  v_exp_f32 v60, v60
  v_exp_f32 v61, v61
  v_exp_f32 v62, v62
  v_cvt_pk_bf16_f32 v58, v60, v61
  v_exp_f32 v63, v63
  v_cvt_pk_bf16_f32 v51, v54, v55
  v_cvt_pk_bf16_f32 v59, v62, v63
  v_mfma_f32_16x16x32_bf16 v[64:67], a[128:131], v[128:131], v[192:195]
  s_add_u32 m0, s28, 98304
  v_mfma_f32_16x16x32_bf16 v[64:67], a[132:135], v[132:135], v[64:67]
  ds_read_b128 a[144:147], v212 offset:20480
  v_mfma_f32_16x16x32_bf16 v[64:67], a[136:139], v[136:139], v[64:67]
  buffer_load_dwordx4 v236, s[16:19], s29 offen offset:0 lds
  v_mfma_f32_16x16x32_bf16 v[64:67], a[140:143], v[140:143], v[64:67]
  ds_read_b128 a[148:151], v213 offset:20480
  v_mfma_f32_16x16x32_bf16 v[72:75], a[140:143], v[156:159], v[196:199]
  v_mfma_f32_16x16x32_bf16 v[72:75], a[136:139], v[152:155], v[72:75]
  ds_read_b128 a[152:155], v214 offset:20480
  v_mfma_f32_16x16x32_bf16 v[72:75], a[132:135], v[148:151], v[72:75]
  buffer_load_dwordx4 v237, s[16:19], s29 offen offset:1024 lds
  v_mfma_f32_16x16x32_bf16 v[72:75], a[128:131], v[144:147], v[72:75]
  ds_read_b128 a[156:159], v215 offset:20480
  v_mfma_f32_16x16x32_bf16 v[80:83], a[128:131], v[160:163], v[200:203]
  v_exp_f32 v64, v64
  v_mfma_f32_16x16x32_bf16 v[80:83], a[132:135], v[164:167], v[80:83]
  v_mfma_f32_16x16x32_bf16 v[80:83], a[136:139], v[168:171], v[80:83]
  v_exp_f32 v65, v65
  v_mfma_f32_16x16x32_bf16 v[80:83], a[140:143], v[172:175], v[80:83]
  v_cvt_pk_bf16_f32 v64, v64, v65
  v_mfma_f32_16x16x32_bf16 v[88:91], a[140:143], v[188:191], v[204:207]
  v_exp_f32 v66, v66
  v_mfma_f32_16x16x32_bf16 v[88:91], a[136:139], v[184:187], v[88:91]
  buffer_load_dwordx4 v236, s[16:19], s29 offen offset:2048 lds
  v_mfma_f32_16x16x32_bf16 v[88:91], a[132:135], v[180:183], v[88:91]
  s_waitcnt lgkmcnt(0)
  v_exp_f32 v67, v67
  v_mfma_f32_16x16x32_bf16 v[88:91], a[128:131], v[176:179], v[88:91]
  v_cvt_pk_bf16_f32 v65, v66, v67
  v_mfma_f32_16x16x32_bf16 v[68:71], a[144:147], v[128:131], v[192:195]
  v_exp_f32 v72, v72
  v_mfma_f32_16x16x32_bf16 v[68:71], a[148:151], v[132:135], v[68:71]
  ds_read_b128 a[128:131], v212 offset:24576
  v_mfma_f32_16x16x32_bf16 v[68:71], a[152:155], v[136:139], v[68:71]
  v_exp_f32 v73, v73
  v_mfma_f32_16x16x32_bf16 v[68:71], a[156:159], v[140:143], v[68:71]
  ds_read_b128 a[132:135], v213 offset:24576
  v_cvt_pk_bf16_f32 v72, v72, v73
  v_mfma_f32_16x16x32_bf16 v[76:79], a[156:159], v[156:159], v[196:199]
  v_exp_f32 v74, v74
  v_mfma_f32_16x16x32_bf16 v[76:79], a[152:155], v[152:155], v[76:79]
  ds_read_b128 a[136:139], v214 offset:24576
  v_mfma_f32_16x16x32_bf16 v[76:79], a[148:151], v[148:151], v[76:79]
  v_exp_f32 v75, v75
  v_mfma_f32_16x16x32_bf16 v[76:79], a[144:147], v[144:147], v[76:79]
  ds_read_b128 a[140:143], v215 offset:24576
  v_cvt_pk_bf16_f32 v73, v74, v75
  v_mfma_f32_16x16x32_bf16 v[84:87], a[144:147], v[160:163], v[200:203]
  v_exp_f32 v80, v80
  v_mfma_f32_16x16x32_bf16 v[84:87], a[148:151], v[164:167], v[84:87]
  buffer_load_dwordx4 v237, s[16:19], s29 offen offset:3072 lds
  v_mfma_f32_16x16x32_bf16 v[84:87], a[152:155], v[168:171], v[84:87]
  s_add_u32 s29, s29, 16384
  v_exp_f32 v81, v81
  v_mfma_f32_16x16x32_bf16 v[84:87], a[156:159], v[172:175], v[84:87]
  v_cvt_pk_bf16_f32 v80, v80, v81
  v_mfma_f32_16x16x32_bf16 v[92:95], a[156:159], v[188:191], v[204:207]
  s_add_u32 m0, s28, 49152
  v_exp_f32 v82, v82
  v_mfma_f32_16x16x32_bf16 v[92:95], a[152:155], v[184:187], v[92:95]
  buffer_load_dwordx4 v232, s[12:15], s29 offen offset:0 lds
  v_mfma_f32_16x16x32_bf16 v[92:95], a[148:151], v[180:183], v[92:95]
  s_waitcnt lgkmcnt(0)
  v_exp_f32 v83, v83
  v_mfma_f32_16x16x32_bf16 v[92:95], a[144:147], v[176:179], v[92:95]
  v_cvt_pk_bf16_f32 v81, v82, v83
  v_mfma_f32_16x16x32_bf16 v[96:99], a[128:131], v[128:131], v[192:195]
  v_exp_f32 v88, v88
  v_mfma_f32_16x16x32_bf16 v[96:99], a[132:135], v[132:135], v[96:99]
  ds_read_b128 a[144:147], v212 offset:28672
  v_mfma_f32_16x16x32_bf16 v[96:99], a[136:139], v[136:139], v[96:99]
  v_exp_f32 v89, v89
  v_mfma_f32_16x16x32_bf16 v[96:99], a[140:143], v[140:143], v[96:99]
  ds_read_b128 a[148:151], v213 offset:28672
  v_cvt_pk_bf16_f32 v88, v88, v89
  v_mfma_f32_16x16x32_bf16 v[104:107], a[140:143], v[156:159], v[196:199]
  v_exp_f32 v90, v90
  v_mfma_f32_16x16x32_bf16 v[104:107], a[136:139], v[152:155], v[104:107]
  ds_read_b128 a[152:155], v214 offset:28672
  v_mfma_f32_16x16x32_bf16 v[104:107], a[132:135], v[148:151], v[104:107]
  v_exp_f32 v91, v91
  v_mfma_f32_16x16x32_bf16 v[104:107], a[128:131], v[144:147], v[104:107]
  ds_read_b128 a[156:159], v215 offset:28672
  v_cvt_pk_bf16_f32 v89, v90, v91
  v_mfma_f32_16x16x32_bf16 v[112:115], a[128:131], v[160:163], v[200:203]
  v_exp_f32 v68, v68
  v_mfma_f32_16x16x32_bf16 v[112:115], a[132:135], v[164:167], v[112:115]
  buffer_load_dwordx4 v233, s[12:15], s29 offen offset:1024 lds
  v_mfma_f32_16x16x32_bf16 v[112:115], a[136:139], v[168:171], v[112:115]
  v_exp_f32 v69, v69
  v_mfma_f32_16x16x32_bf16 v[112:115], a[140:143], v[172:175], v[112:115]
  v_cvt_pk_bf16_f32 v66, v68, v69
  v_mfma_f32_16x16x32_bf16 v[120:123], a[140:143], v[188:191], v[204:207]
  v_exp_f32 v70, v70
  v_mfma_f32_16x16x32_bf16 v[120:123], a[136:139], v[184:187], v[120:123]
  buffer_load_dwordx4 v234, s[12:15], s29 offen offset:2048 lds
  v_mfma_f32_16x16x32_bf16 v[120:123], a[132:135], v[180:183], v[120:123]
  s_waitcnt lgkmcnt(0)
  v_exp_f32 v71, v71
  v_mfma_f32_16x16x32_bf16 v[120:123], a[128:131], v[176:179], v[120:123]
  v_cvt_pk_bf16_f32 v67, v70, v71
  v_mfma_f32_16x16x32_bf16 v[100:103], a[144:147], v[128:131], v[192:195]
  v_exp_f32 v76, v76
  v_mfma_f32_16x16x32_bf16 v[100:103], a[148:151], v[132:135], v[100:103]
  ds_read_b64_tr_b16 a[160:161], v216 offset:0
  v_mfma_f32_16x16x32_bf16 v[100:103], a[152:155], v[136:139], v[100:103]
  v_exp_f32 v77, v77
  v_mfma_f32_16x16x32_bf16 v[100:103], a[156:159], v[140:143], v[100:103]
  ds_read_b64_tr_b16 a[162:163], v216 offset:4096
  v_cvt_pk_bf16_f32 v74, v76, v77
  v_mfma_f32_16x16x32_bf16 v[108:111], a[156:159], v[156:159], v[196:199]
  v_exp_f32 v78, v78
  v_mfma_f32_16x16x32_bf16 v[108:111], a[152:155], v[152:155], v[108:111]
  ds_read_b64_tr_b16 a[164:165], v216 offset:8192
  buffer_load_dwordx4 v235, s[12:15], s29 offen offset:3072 lds
  v_mfma_f32_16x16x32_bf16 v[108:111], a[148:151], v[148:151], v[108:111]
  v_exp_f32 v79, v79
  v_mfma_f32_16x16x32_bf16 v[108:111], a[144:147], v[144:147], v[108:111]
  ds_read_b64_tr_b16 a[166:167], v216 offset:12288
  v_cvt_pk_bf16_f32 v75, v78, v79
  v_mfma_f32_16x16x32_bf16 v[116:119], a[144:147], v[160:163], v[200:203]
  v_exp_f32 v84, v84
  v_mfma_f32_16x16x32_bf16 v[116:119], a[148:151], v[164:167], v[116:119]
  ds_read_b64_tr_b16 a[168:169], v217 offset:0
  s_add_u32 m0, s50, 3072
  v_mfma_f32_16x16x32_bf16 v[116:119], a[152:155], v[168:171], v[116:119]
  v_exp_f32 v85, v85
  v_mfma_f32_16x16x32_bf16 v[116:119], a[156:159], v[172:175], v[116:119]
  ds_read_b64_tr_b16 a[170:171], v217 offset:4096
  v_cvt_pk_bf16_f32 v82, v84, v85
  v_mfma_f32_16x16x32_bf16 v[124:127], a[156:159], v[188:191], v[204:207]
  v_exp_f32 v86, v86
  v_mfma_f32_16x16x32_bf16 v[124:127], a[152:155], v[184:187], v[124:127]
  ds_read_b64_tr_b16 a[172:173], v217 offset:8192
  buffer_load_dwordx4 v253, s[44:47], s35 offen lds
  s_add_u32 s35, s35, 221184
  v_mfma_f32_16x16x32_bf16 v[124:127], a[148:151], v[180:183], v[124:127]
  v_exp_f32 v87, v87
  v_mfma_f32_16x16x32_bf16 v[124:127], a[144:147], v[176:179], v[124:127]
  ds_read_b64_tr_b16 a[174:175], v217 offset:12288
  v_cvt_pk_bf16_f32 v83, v86, v87
  v_mfma_f32_16x16x32_bf16 a[192:195], a[208:211], v[0:3], 0
  v_exp_f32 v92, v92
  v_mfma_f32_16x16x32_bf16 a[192:195], a[208:211], v[32:35], a[192:195]
  ds_read_b64_tr_b16 a[176:177], v218 offset:0
  v_mfma_f32_16x16x32_bf16 a[196:199], a[208:211], v[8:11], 0
  v_exp_f32 v93, v93
  v_mfma_f32_16x16x32_bf16 a[196:199], a[208:211], v[40:43], a[196:199]
  ds_read_b64_tr_b16 a[178:179], v218 offset:4096
  v_cvt_pk_bf16_f32 v90, v92, v93
  v_mfma_f32_16x16x32_bf16 a[200:203], a[208:211], v[16:19], 0
  v_exp_f32 v94, v94
  v_mfma_f32_16x16x32_bf16 a[200:203], a[208:211], v[48:51], a[200:203]
  ds_read_b64_tr_b16 a[180:181], v218 offset:8192
  v_mfma_f32_16x16x32_bf16 a[204:207], a[208:211], v[24:27], 0
  s_waitcnt lgkmcnt(7)
  v_exp_f32 v95, v95
  v_mfma_f32_16x16x32_bf16 a[204:207], a[208:211], v[56:59], a[204:207]
  ds_read_b64_tr_b16 a[182:183], v218 offset:12288
  v_cvt_pk_bf16_f32 v91, v94, v95
  v_mfma_f32_16x16x32_bf16 a[0:3], a[160:163], v[0:3], 0
  v_exp_f32 v96, v96
  v_mfma_f32_16x16x32_bf16 a[0:3], a[164:167], v[32:35], a[0:3]
  ds_read_b64_tr_b16 a[184:185], v219 offset:0
  v_mfma_f32_16x16x32_bf16 a[4:7], a[164:167], v[40:43], 0
  v_exp_f32 v97, v97
  v_mfma_f32_16x16x32_bf16 a[4:7], a[160:163], v[8:11], a[4:7]
  ds_read_b64_tr_b16 a[186:187], v219 offset:4096
  v_cvt_pk_bf16_f32 v96, v96, v97
  v_mfma_f32_16x16x32_bf16 a[8:11], a[160:163], v[16:19], 0
  v_exp_f32 v98, v98
  v_mfma_f32_16x16x32_bf16 a[8:11], a[164:167], v[48:51], a[8:11]
  ds_read_b64_tr_b16 a[188:189], v219 offset:8192
  v_mfma_f32_16x16x32_bf16 a[12:15], a[164:167], v[56:59], 0
  s_waitcnt lgkmcnt(7)
  v_exp_f32 v99, v99
  v_mfma_f32_16x16x32_bf16 a[12:15], a[160:163], v[24:27], a[12:15]
  ds_read_b64_tr_b16 a[190:191], v219 offset:12288
  v_cvt_pk_bf16_f32 v97, v98, v99
  v_mfma_f32_16x16x32_bf16 a[16:19], a[168:171], v[0:3], 0
  v_exp_f32 v104, v104
  v_mfma_f32_16x16x32_bf16 a[16:19], a[172:175], v[32:35], a[16:19]
  ds_read_b64_tr_b16 a[160:161], v220 offset:0
  v_mfma_f32_16x16x32_bf16 a[20:23], a[172:175], v[40:43], 0
  v_exp_f32 v105, v105
  v_mfma_f32_16x16x32_bf16 a[20:23], a[168:171], v[8:11], a[20:23]
  ds_read_b64_tr_b16 a[162:163], v220 offset:4096
  v_cvt_pk_bf16_f32 v104, v104, v105
  v_mfma_f32_16x16x32_bf16 a[24:27], a[168:171], v[16:19], 0
  v_exp_f32 v106, v106
  v_mfma_f32_16x16x32_bf16 a[24:27], a[172:175], v[48:51], a[24:27]
  ds_read_b64_tr_b16 a[164:165], v220 offset:8192
  v_mfma_f32_16x16x32_bf16 a[28:31], a[172:175], v[56:59], 0
  s_waitcnt lgkmcnt(7)
  v_exp_f32 v107, v107
  v_mfma_f32_16x16x32_bf16 a[28:31], a[168:171], v[24:27], a[28:31]
  ds_read_b64_tr_b16 a[166:167], v220 offset:12288
  v_cvt_pk_bf16_f32 v105, v106, v107
  v_mfma_f32_16x16x32_bf16 a[32:35], a[176:179], v[0:3], 0
  v_exp_f32 v112, v112
  v_mfma_f32_16x16x32_bf16 a[32:35], a[180:183], v[32:35], a[32:35]
  ds_read_b64_tr_b16 a[168:169], v221 offset:0
  v_mfma_f32_16x16x32_bf16 a[36:39], a[180:183], v[40:43], 0
  v_exp_f32 v113, v113
  v_mfma_f32_16x16x32_bf16 a[36:39], a[176:179], v[8:11], a[36:39]
  ds_read_b64_tr_b16 a[170:171], v221 offset:4096
  v_cvt_pk_bf16_f32 v112, v112, v113
  v_mfma_f32_16x16x32_bf16 a[40:43], a[176:179], v[16:19], 0
  v_exp_f32 v114, v114
  v_mfma_f32_16x16x32_bf16 a[40:43], a[180:183], v[48:51], a[40:43]
  ds_read_b64_tr_b16 a[172:173], v221 offset:8192
  v_mfma_f32_16x16x32_bf16 a[44:47], a[180:183], v[56:59], 0
  s_waitcnt lgkmcnt(7)
  v_exp_f32 v115, v115
  v_mfma_f32_16x16x32_bf16 a[44:47], a[176:179], v[24:27], a[44:47]
  ds_read_b64_tr_b16 a[174:175], v221 offset:12288
  v_cvt_pk_bf16_f32 v113, v114, v115
  v_mfma_f32_16x16x32_bf16 a[48:51], a[184:187], v[0:3], 0
  v_exp_f32 v120, v120
  v_mfma_f32_16x16x32_bf16 a[48:51], a[188:191], v[32:35], a[48:51]
  ds_read_b64_tr_b16 a[176:177], v222 offset:0
  v_mfma_f32_16x16x32_bf16 a[52:55], a[188:191], v[40:43], 0
  v_exp_f32 v121, v121
  v_mfma_f32_16x16x32_bf16 a[52:55], a[184:187], v[8:11], a[52:55]
  ds_read_b64_tr_b16 a[178:179], v222 offset:4096
  v_cvt_pk_bf16_f32 v120, v120, v121
  v_mfma_f32_16x16x32_bf16 a[56:59], a[184:187], v[16:19], 0
  v_exp_f32 v122, v122
  v_mfma_f32_16x16x32_bf16 a[56:59], a[188:191], v[48:51], a[56:59]
  ds_read_b64_tr_b16 a[180:181], v222 offset:8192
  v_mfma_f32_16x16x32_bf16 a[60:63], a[188:191], v[56:59], 0
  s_waitcnt lgkmcnt(7)
  v_exp_f32 v123, v123
  v_mfma_f32_16x16x32_bf16 a[60:63], a[184:187], v[24:27], a[60:63]
  ds_read_b64_tr_b16 a[182:183], v222 offset:12288
  v_cvt_pk_bf16_f32 v121, v122, v123
  v_mfma_f32_16x16x32_bf16 a[64:67], a[160:163], v[0:3], 0
  v_exp_f32 v100, v100
  v_mfma_f32_16x16x32_bf16 a[64:67], a[164:167], v[32:35], a[64:67]
  ds_read_b64_tr_b16 a[184:185], v223 offset:0
  v_mfma_f32_16x16x32_bf16 a[68:71], a[164:167], v[40:43], 0
  v_exp_f32 v101, v101
  v_mfma_f32_16x16x32_bf16 a[68:71], a[160:163], v[8:11], a[68:71]
  ds_read_b64_tr_b16 a[186:187], v223 offset:4096
  v_cvt_pk_bf16_f32 v98, v100, v101
  v_mfma_f32_16x16x32_bf16 a[72:75], a[160:163], v[16:19], 0
  v_exp_f32 v102, v102
  v_mfma_f32_16x16x32_bf16 a[72:75], a[164:167], v[48:51], a[72:75]
  ds_read_b64_tr_b16 a[188:189], v223 offset:8192
  v_mfma_f32_16x16x32_bf16 a[76:79], a[164:167], v[56:59], 0
  s_waitcnt lgkmcnt(7)
  v_exp_f32 v103, v103
  v_mfma_f32_16x16x32_bf16 a[76:79], a[160:163], v[24:27], a[76:79]
  ds_read_b64_tr_b16 a[190:191], v223 offset:12288
  v_cvt_pk_bf16_f32 v99, v102, v103
  v_mfma_f32_16x16x32_bf16 a[80:83], a[168:171], v[0:3], 0
  s_waitcnt vmcnt(10)
  v_exp_f32 v108, v108
  v_mfma_f32_16x16x32_bf16 a[80:83], a[172:175], v[32:35], a[80:83]
  v_mfma_f32_16x16x32_bf16 a[84:87], a[172:175], v[40:43], 0
  s_barrier
  v_exp_f32 v109, v109
  v_mfma_f32_16x16x32_bf16 a[84:87], a[168:171], v[8:11], a[84:87]
  ds_read_b128 a[128:131], v212 offset:32768
  v_cvt_pk_bf16_f32 v106, v108, v109
  v_mfma_f32_16x16x32_bf16 a[88:91], a[168:171], v[16:19], 0
  v_exp_f32 v110, v110
  v_mfma_f32_16x16x32_bf16 a[88:91], a[172:175], v[48:51], a[88:91]
  ds_read_b128 a[132:135], v213 offset:32768
  v_mfma_f32_16x16x32_bf16 a[92:95], a[172:175], v[56:59], 0
  s_waitcnt lgkmcnt(6)
  v_exp_f32 v111, v111
  v_mfma_f32_16x16x32_bf16 a[92:95], a[168:171], v[24:27], a[92:95]
  ds_read_b128 a[136:139], v214 offset:32768
  v_cvt_pk_bf16_f32 v107, v110, v111
  v_mfma_f32_16x16x32_bf16 a[96:99], a[176:179], v[0:3], 0
  s_mul_i32 s38, s3, 20480
  v_exp_f32 v116, v116
  v_mfma_f32_16x16x32_bf16 a[96:99], a[180:183], v[32:35], a[96:99]
  ds_read_b128 a[140:143], v215 offset:32768
  buffer_load_dwordx4 a[212:215], v243, s[24:27], s38 offen sc1
  s_add_u32 s38, s38, 4096
  v_mfma_f32_16x16x32_bf16 a[100:103], a[180:183], v[40:43], 0
  v_exp_f32 v117, v117
  v_mfma_f32_16x16x32_bf16 a[100:103], a[176:179], v[8:11], a[100:103]
  v_cvt_pk_bf16_f32 v114, v116, v117
  v_mfma_f32_16x16x32_bf16 a[104:107], a[176:179], v[16:19], 0
  v_exp_f32 v118, v118
  v_mfma_f32_16x16x32_bf16 a[104:107], a[180:183], v[48:51], a[104:107]
  v_mfma_f32_16x16x32_bf16 a[108:111], a[180:183], v[56:59], 0
  s_waitcnt lgkmcnt(4)
  v_exp_f32 v119, v119
  v_mfma_f32_16x16x32_bf16 a[108:111], a[176:179], v[24:27], a[108:111]
  v_cvt_pk_bf16_f32 v115, v118, v119
  v_mfma_f32_16x16x32_bf16 a[112:115], a[184:187], v[0:3], 0
  v_exp_f32 v124, v124
  v_mfma_f32_16x16x32_bf16 a[112:115], a[188:191], v[32:35], a[112:115]
  v_mfma_f32_16x16x32_bf16 a[116:119], a[188:191], v[40:43], 0
  v_exp_f32 v125, v125
  v_mfma_f32_16x16x32_bf16 a[116:119], a[184:187], v[8:11], a[116:119]
  v_cvt_pk_bf16_f32 v122, v124, v125
  v_mfma_f32_16x16x32_bf16 a[120:123], a[184:187], v[16:19], 0
  v_exp_f32 v126, v126
  v_mfma_f32_16x16x32_bf16 a[120:123], a[188:191], v[48:51], a[120:123]
  v_mfma_f32_16x16x32_bf16 a[124:127], a[188:191], v[56:59], 0
  s_waitcnt lgkmcnt(0)
  v_exp_f32 v127, v127
  v_mfma_f32_16x16x32_bf16 a[124:127], a[184:187], v[24:27], a[124:127]
  v_cvt_pk_bf16_f32 v123, v126, v127
  v_mfma_f32_16x16x32_bf16 v[0:3], a[128:131], v[128:131], v[192:195]
  s_add_u32 m0, s28, 114688
  v_mfma_f32_16x16x32_bf16 v[0:3], a[132:135], v[132:135], v[0:3]
  ds_read_b128 a[144:147], v212 offset:36864
  v_mfma_f32_16x16x32_bf16 v[0:3], a[136:139], v[136:139], v[0:3]
  buffer_load_dwordx4 v236, s[16:19], s29 offen offset:0 lds
  v_mfma_f32_16x16x32_bf16 v[0:3], a[140:143], v[140:143], v[0:3]
  ds_read_b128 a[148:151], v213 offset:36864
  v_mfma_f32_16x16x32_bf16 v[8:11], a[140:143], v[156:159], v[196:199]
  v_mfma_f32_16x16x32_bf16 v[8:11], a[136:139], v[152:155], v[8:11]
  ds_read_b128 a[152:155], v214 offset:36864
  v_mfma_f32_16x16x32_bf16 v[8:11], a[132:135], v[148:151], v[8:11]
  buffer_load_dwordx4 v237, s[16:19], s29 offen offset:1024 lds
  v_mfma_f32_16x16x32_bf16 v[8:11], a[128:131], v[144:147], v[8:11]
  ds_read_b128 a[156:159], v215 offset:36864
  v_mfma_f32_16x16x32_bf16 v[16:19], a[128:131], v[160:163], v[200:203]
  v_exp_f32 v0, v0
  v_mfma_f32_16x16x32_bf16 v[16:19], a[132:135], v[164:167], v[16:19]
  v_mfma_f32_16x16x32_bf16 v[16:19], a[136:139], v[168:171], v[16:19]
  v_exp_f32 v1, v1
  v_mfma_f32_16x16x32_bf16 v[16:19], a[140:143], v[172:175], v[16:19]
  v_cvt_pk_bf16_f32 v0, v0, v1
  v_mfma_f32_16x16x32_bf16 v[24:27], a[140:143], v[188:191], v[204:207]
  v_exp_f32 v2, v2
  v_mfma_f32_16x16x32_bf16 v[24:27], a[136:139], v[184:187], v[24:27]
  buffer_load_dwordx4 v236, s[16:19], s29 offen offset:2048 lds
  v_mfma_f32_16x16x32_bf16 v[24:27], a[132:135], v[180:183], v[24:27]
  s_waitcnt lgkmcnt(0)
  v_exp_f32 v3, v3
  v_mfma_f32_16x16x32_bf16 v[24:27], a[128:131], v[176:179], v[24:27]
  v_cvt_pk_bf16_f32 v1, v2, v3
  v_mfma_f32_16x16x32_bf16 v[4:7], a[144:147], v[128:131], v[192:195]
  v_exp_f32 v8, v8
  v_mfma_f32_16x16x32_bf16 v[4:7], a[148:151], v[132:135], v[4:7]
  ds_read_b128 a[128:131], v212 offset:40960
  v_mfma_f32_16x16x32_bf16 v[4:7], a[152:155], v[136:139], v[4:7]
  v_exp_f32 v9, v9
  v_mfma_f32_16x16x32_bf16 v[4:7], a[156:159], v[140:143], v[4:7]
  ds_read_b128 a[132:135], v213 offset:40960
  v_cvt_pk_bf16_f32 v8, v8, v9
  v_mfma_f32_16x16x32_bf16 v[12:15], a[156:159], v[156:159], v[196:199]
  v_exp_f32 v10, v10
  v_mfma_f32_16x16x32_bf16 v[12:15], a[152:155], v[152:155], v[12:15]
  ds_read_b128 a[136:139], v214 offset:40960
  v_mfma_f32_16x16x32_bf16 v[12:15], a[148:151], v[148:151], v[12:15]
  v_exp_f32 v11, v11
  v_mfma_f32_16x16x32_bf16 v[12:15], a[144:147], v[144:147], v[12:15]
  ds_read_b128 a[140:143], v215 offset:40960
  v_cvt_pk_bf16_f32 v9, v10, v11
  v_mfma_f32_16x16x32_bf16 v[20:23], a[144:147], v[160:163], v[200:203]
  v_exp_f32 v16, v16
  v_mfma_f32_16x16x32_bf16 v[20:23], a[148:151], v[164:167], v[20:23]
  buffer_load_dwordx4 v237, s[16:19], s29 offen offset:3072 lds
  v_mfma_f32_16x16x32_bf16 v[20:23], a[152:155], v[168:171], v[20:23]
  s_add_u32 s29, s29, 16384
  v_exp_f32 v17, v17
  v_mfma_f32_16x16x32_bf16 v[20:23], a[156:159], v[172:175], v[20:23]
  v_cvt_pk_bf16_f32 v16, v16, v17
  v_mfma_f32_16x16x32_bf16 v[28:31], a[156:159], v[188:191], v[204:207]
  s_add_u32 m0, s28, 0
  v_exp_f32 v18, v18
  v_mfma_f32_16x16x32_bf16 v[28:31], a[152:155], v[184:187], v[28:31]
  buffer_load_dwordx4 v232, s[12:15], s29 offen offset:0 lds
  v_mfma_f32_16x16x32_bf16 v[28:31], a[148:151], v[180:183], v[28:31]
  s_waitcnt lgkmcnt(0)
  v_exp_f32 v19, v19
  v_mfma_f32_16x16x32_bf16 v[28:31], a[144:147], v[176:179], v[28:31]
  v_cvt_pk_bf16_f32 v17, v18, v19
  v_mfma_f32_16x16x32_bf16 v[32:35], a[128:131], v[128:131], v[192:195]
  v_exp_f32 v24, v24
  v_mfma_f32_16x16x32_bf16 v[32:35], a[132:135], v[132:135], v[32:35]
  ds_read_b128 a[144:147], v212 offset:45056
  v_mfma_f32_16x16x32_bf16 v[32:35], a[136:139], v[136:139], v[32:35]
  v_exp_f32 v25, v25
  v_mfma_f32_16x16x32_bf16 v[32:35], a[140:143], v[140:143], v[32:35]
  ds_read_b128 a[148:151], v213 offset:45056
  v_cvt_pk_bf16_f32 v24, v24, v25
  v_mfma_f32_16x16x32_bf16 v[40:43], a[140:143], v[156:159], v[196:199]
  v_exp_f32 v26, v26
  v_mfma_f32_16x16x32_bf16 v[40:43], a[136:139], v[152:155], v[40:43]
  ds_read_b128 a[152:155], v214 offset:45056
  v_mfma_f32_16x16x32_bf16 v[40:43], a[132:135], v[148:151], v[40:43]
  v_exp_f32 v27, v27
  v_mfma_f32_16x16x32_bf16 v[40:43], a[128:131], v[144:147], v[40:43]
  ds_read_b128 a[156:159], v215 offset:45056
  v_cvt_pk_bf16_f32 v25, v26, v27
  v_mfma_f32_16x16x32_bf16 v[48:51], a[128:131], v[160:163], v[200:203]
  v_exp_f32 v4, v4
  v_mfma_f32_16x16x32_bf16 v[48:51], a[132:135], v[164:167], v[48:51]
  buffer_load_dwordx4 v233, s[12:15], s29 offen offset:1024 lds
  v_mfma_f32_16x16x32_bf16 v[48:51], a[136:139], v[168:171], v[48:51]
  v_exp_f32 v5, v5
  v_mfma_f32_16x16x32_bf16 v[48:51], a[140:143], v[172:175], v[48:51]
  v_cvt_pk_bf16_f32 v2, v4, v5
  v_mfma_f32_16x16x32_bf16 v[56:59], a[140:143], v[188:191], v[204:207]
  v_exp_f32 v6, v6
  v_mfma_f32_16x16x32_bf16 v[56:59], a[136:139], v[184:187], v[56:59]
  buffer_load_dwordx4 v234, s[12:15], s29 offen offset:2048 lds
  v_mfma_f32_16x16x32_bf16 v[56:59], a[132:135], v[180:183], v[56:59]
  s_waitcnt lgkmcnt(0)
  v_exp_f32 v7, v7
  v_mfma_f32_16x16x32_bf16 v[56:59], a[128:131], v[176:179], v[56:59]
  v_cvt_pk_bf16_f32 v3, v6, v7
  v_mfma_f32_16x16x32_bf16 v[36:39], a[144:147], v[128:131], v[192:195]
  v_exp_f32 v12, v12
  v_mfma_f32_16x16x32_bf16 v[36:39], a[148:151], v[132:135], v[36:39]
  ds_read_b64_tr_b16 a[160:161], v216 offset:16384
  v_mfma_f32_16x16x32_bf16 v[36:39], a[152:155], v[136:139], v[36:39]
  v_exp_f32 v13, v13
  v_mfma_f32_16x16x32_bf16 v[36:39], a[156:159], v[140:143], v[36:39]
  ds_read_b64_tr_b16 a[162:163], v216 offset:20480
  v_cvt_pk_bf16_f32 v10, v12, v13
  v_mfma_f32_16x16x32_bf16 v[44:47], a[156:159], v[156:159], v[196:199]
  v_exp_f32 v14, v14
  v_mfma_f32_16x16x32_bf16 v[44:47], a[152:155], v[152:155], v[44:47]
  ds_read_b64_tr_b16 a[164:165], v216 offset:24576
  buffer_load_dwordx4 v235, s[12:15], s29 offen offset:3072 lds
  v_mfma_f32_16x16x32_bf16 v[44:47], a[148:151], v[148:151], v[44:47]
  v_exp_f32 v15, v15
  v_mfma_f32_16x16x32_bf16 v[44:47], a[144:147], v[144:147], v[44:47]
  ds_read_b64_tr_b16 a[166:167], v216 offset:28672
  v_cvt_pk_bf16_f32 v11, v14, v15
  v_mfma_f32_16x16x32_bf16 v[52:55], a[144:147], v[160:163], v[200:203]
  v_exp_f32 v20, v20
  v_mfma_f32_16x16x32_bf16 v[52:55], a[148:151], v[164:167], v[52:55]
  ds_read_b64_tr_b16 a[168:169], v217 offset:16384
  s_add_u32 m0, s50, 1024
  v_mfma_f32_16x16x32_bf16 v[52:55], a[152:155], v[168:171], v[52:55]
  v_exp_f32 v21, v21
  v_mfma_f32_16x16x32_bf16 v[52:55], a[156:159], v[172:175], v[52:55]
  ds_read_b64_tr_b16 a[170:171], v217 offset:20480
  v_cvt_pk_bf16_f32 v18, v20, v21
  v_mfma_f32_16x16x32_bf16 v[60:63], a[156:159], v[188:191], v[204:207]
  v_exp_f32 v22, v22
  v_mfma_f32_16x16x32_bf16 v[60:63], a[152:155], v[184:187], v[60:63]
  ds_read_b64_tr_b16 a[172:173], v217 offset:24576
  buffer_load_dwordx4 v253, s[20:23], s35 offen lds
  v_mfma_f32_16x16x32_bf16 v[60:63], a[148:151], v[180:183], v[60:63]
  v_exp_f32 v23, v23
  v_mfma_f32_16x16x32_bf16 v[60:63], a[144:147], v[176:179], v[60:63]
  ds_read_b64_tr_b16 a[174:175], v217 offset:28672
  v_cvt_pk_bf16_f32 v19, v22, v23
  v_mfma_f32_16x16x32_bf16 a[192:195], a[208:211], v[64:67], a[192:195]
  v_exp_f32 v28, v28
  v_mfma_f32_16x16x32_bf16 a[192:195], a[208:211], v[96:99], a[192:195]
  ds_read_b64_tr_b16 a[176:177], v218 offset:16384
  v_mfma_f32_16x16x32_bf16 a[196:199], a[208:211], v[72:75], a[196:199]
  v_exp_f32 v29, v29
  v_mfma_f32_16x16x32_bf16 a[196:199], a[208:211], v[104:107], a[196:199]
  ds_read_b64_tr_b16 a[178:179], v218 offset:20480
  v_cvt_pk_bf16_f32 v26, v28, v29
  v_mfma_f32_16x16x32_bf16 a[200:203], a[208:211], v[80:83], a[200:203]
  v_exp_f32 v30, v30
  v_mfma_f32_16x16x32_bf16 a[200:203], a[208:211], v[112:115], a[200:203]
  ds_read_b64_tr_b16 a[180:181], v218 offset:24576
  v_mfma_f32_16x16x32_bf16 a[204:207], a[208:211], v[88:91], a[204:207]
  s_waitcnt lgkmcnt(7)
  v_exp_f32 v31, v31
  v_mfma_f32_16x16x32_bf16 a[204:207], a[208:211], v[120:123], a[204:207]
  ds_read_b64_tr_b16 a[182:183], v218 offset:28672
  v_cvt_pk_bf16_f32 v27, v30, v31
  v_mfma_f32_16x16x32_bf16 a[0:3], a[160:163], v[64:67], a[0:3]
  v_exp_f32 v32, v32
  v_mfma_f32_16x16x32_bf16 a[0:3], a[164:167], v[96:99], a[0:3]
  ds_read_b64_tr_b16 a[184:185], v219 offset:16384
  v_mfma_f32_16x16x32_bf16 a[4:7], a[164:167], v[104:107], a[4:7]
  v_exp_f32 v33, v33
  v_mfma_f32_16x16x32_bf16 a[4:7], a[160:163], v[72:75], a[4:7]
  ds_read_b64_tr_b16 a[186:187], v219 offset:20480
  v_cvt_pk_bf16_f32 v32, v32, v33
  v_mfma_f32_16x16x32_bf16 a[8:11], a[160:163], v[80:83], a[8:11]
  v_exp_f32 v34, v34
  v_mfma_f32_16x16x32_bf16 a[8:11], a[164:167], v[112:115], a[8:11]
  ds_read_b64_tr_b16 a[188:189], v219 offset:24576
  v_mfma_f32_16x16x32_bf16 a[12:15], a[164:167], v[120:123], a[12:15]
  s_waitcnt lgkmcnt(7)
  v_exp_f32 v35, v35
  v_mfma_f32_16x16x32_bf16 a[12:15], a[160:163], v[88:91], a[12:15]
  ds_read_b64_tr_b16 a[190:191], v219 offset:28672
  v_cvt_pk_bf16_f32 v33, v34, v35
  v_mfma_f32_16x16x32_bf16 a[16:19], a[168:171], v[64:67], a[16:19]
  v_exp_f32 v40, v40
  v_mfma_f32_16x16x32_bf16 a[16:19], a[172:175], v[96:99], a[16:19]
  ds_read_b64_tr_b16 a[160:161], v220 offset:16384
  v_mfma_f32_16x16x32_bf16 a[20:23], a[172:175], v[104:107], a[20:23]
  v_exp_f32 v41, v41
  v_mfma_f32_16x16x32_bf16 a[20:23], a[168:171], v[72:75], a[20:23]
  ds_read_b64_tr_b16 a[162:163], v220 offset:20480
  v_cvt_pk_bf16_f32 v40, v40, v41
  v_mfma_f32_16x16x32_bf16 a[24:27], a[168:171], v[80:83], a[24:27]
  v_exp_f32 v42, v42
  v_mfma_f32_16x16x32_bf16 a[24:27], a[172:175], v[112:115], a[24:27]
  ds_read_b64_tr_b16 a[164:165], v220 offset:24576
  v_mfma_f32_16x16x32_bf16 a[28:31], a[172:175], v[120:123], a[28:31]
  s_waitcnt lgkmcnt(7)
  v_exp_f32 v43, v43
  v_mfma_f32_16x16x32_bf16 a[28:31], a[168:171], v[88:91], a[28:31]
  ds_read_b64_tr_b16 a[166:167], v220 offset:28672
  v_cvt_pk_bf16_f32 v41, v42, v43
  v_mfma_f32_16x16x32_bf16 a[32:35], a[176:179], v[64:67], a[32:35]
  v_exp_f32 v48, v48
  v_mfma_f32_16x16x32_bf16 a[32:35], a[180:183], v[96:99], a[32:35]
  ds_read_b64_tr_b16 a[168:169], v221 offset:16384
  v_mfma_f32_16x16x32_bf16 a[36:39], a[180:183], v[104:107], a[36:39]
  v_exp_f32 v49, v49
  v_mfma_f32_16x16x32_bf16 a[36:39], a[176:179], v[72:75], a[36:39]
  ds_read_b64_tr_b16 a[170:171], v221 offset:20480
  v_cvt_pk_bf16_f32 v48, v48, v49
  v_mfma_f32_16x16x32_bf16 a[40:43], a[176:179], v[80:83], a[40:43]
  v_exp_f32 v50, v50
  v_mfma_f32_16x16x32_bf16 a[40:43], a[180:183], v[112:115], a[40:43]
  ds_read_b64_tr_b16 a[172:173], v221 offset:24576
  v_mfma_f32_16x16x32_bf16 a[44:47], a[180:183], v[120:123], a[44:47]
  s_waitcnt lgkmcnt(7)
  v_exp_f32 v51, v51
  v_mfma_f32_16x16x32_bf16 a[44:47], a[176:179], v[88:91], a[44:47]
  ds_read_b64_tr_b16 a[174:175], v221 offset:28672
  v_cvt_pk_bf16_f32 v49, v50, v51
  v_mfma_f32_16x16x32_bf16 a[48:51], a[184:187], v[64:67], a[48:51]
  v_exp_f32 v56, v56
  v_mfma_f32_16x16x32_bf16 a[48:51], a[188:191], v[96:99], a[48:51]
  ds_read_b64_tr_b16 a[176:177], v222 offset:16384
  v_mfma_f32_16x16x32_bf16 a[52:55], a[188:191], v[104:107], a[52:55]
  v_exp_f32 v57, v57
  v_mfma_f32_16x16x32_bf16 a[52:55], a[184:187], v[72:75], a[52:55]
  ds_read_b64_tr_b16 a[178:179], v222 offset:20480
  v_cvt_pk_bf16_f32 v56, v56, v57
  v_mfma_f32_16x16x32_bf16 a[56:59], a[184:187], v[80:83], a[56:59]
  v_exp_f32 v58, v58
  v_mfma_f32_16x16x32_bf16 a[56:59], a[188:191], v[112:115], a[56:59]
  ds_read_b64_tr_b16 a[180:181], v222 offset:24576
  v_mfma_f32_16x16x32_bf16 a[60:63], a[188:191], v[120:123], a[60:63]
  s_waitcnt lgkmcnt(7)
  v_exp_f32 v59, v59
  v_mfma_f32_16x16x32_bf16 a[60:63], a[184:187], v[88:91], a[60:63]
  ds_read_b64_tr_b16 a[182:183], v222 offset:28672
  v_cvt_pk_bf16_f32 v57, v58, v59
  v_mfma_f32_16x16x32_bf16 a[64:67], a[160:163], v[64:67], a[64:67]
  v_exp_f32 v36, v36
  v_mfma_f32_16x16x32_bf16 a[64:67], a[164:167], v[96:99], a[64:67]
  ds_read_b64_tr_b16 a[184:185], v223 offset:16384
  v_mfma_f32_16x16x32_bf16 a[68:71], a[164:167], v[104:107], a[68:71]
  v_exp_f32 v37, v37
  v_mfma_f32_16x16x32_bf16 a[68:71], a[160:163], v[72:75], a[68:71]
  ds_read_b64_tr_b16 a[186:187], v223 offset:20480
  v_cvt_pk_bf16_f32 v34, v36, v37
  v_mfma_f32_16x16x32_bf16 a[72:75], a[160:163], v[80:83], a[72:75]
  v_exp_f32 v38, v38
  v_mfma_f32_16x16x32_bf16 a[72:75], a[164:167], v[112:115], a[72:75]
  ds_read_b64_tr_b16 a[188:189], v223 offset:24576
  v_mfma_f32_16x16x32_bf16 a[76:79], a[164:167], v[120:123], a[76:79]
  s_waitcnt lgkmcnt(7)
  v_exp_f32 v39, v39
  v_mfma_f32_16x16x32_bf16 a[76:79], a[160:163], v[88:91], a[76:79]
  ds_read_b64_tr_b16 a[190:191], v223 offset:28672
  v_cvt_pk_bf16_f32 v35, v38, v39
  v_mfma_f32_16x16x32_bf16 a[80:83], a[168:171], v[64:67], a[80:83]
  s_waitcnt vmcnt(11)
  v_exp_f32 v44, v44
  v_mfma_f32_16x16x32_bf16 a[80:83], a[172:175], v[96:99], a[80:83]
  v_mfma_f32_16x16x32_bf16 a[84:87], a[172:175], v[104:107], a[84:87]
  s_barrier
  v_exp_f32 v45, v45
  v_mfma_f32_16x16x32_bf16 a[84:87], a[168:171], v[72:75], a[84:87]
  ds_read_b128 a[128:131], v212 offset:49152
  v_cvt_pk_bf16_f32 v42, v44, v45
  v_mfma_f32_16x16x32_bf16 a[88:91], a[168:171], v[80:83], a[88:91]
  v_exp_f32 v46, v46
  v_mfma_f32_16x16x32_bf16 a[88:91], a[172:175], v[112:115], a[88:91]
  ds_read_b128 a[132:135], v213 offset:49152
  v_mfma_f32_16x16x32_bf16 a[92:95], a[172:175], v[120:123], a[92:95]
  s_waitcnt lgkmcnt(6)
  v_exp_f32 v47, v47
  v_mfma_f32_16x16x32_bf16 a[92:95], a[168:171], v[88:91], a[92:95]
  ds_read_b128 a[136:139], v214 offset:49152
  v_cvt_pk_bf16_f32 v43, v46, v47
  v_mfma_f32_16x16x32_bf16 a[96:99], a[176:179], v[64:67], a[96:99]
  v_exp_f32 v52, v52
  v_mfma_f32_16x16x32_bf16 a[96:99], a[180:183], v[96:99], a[96:99]
  ds_read_b128 a[140:143], v215 offset:49152
  buffer_load_dwordx4 a[216:219], v243, s[24:27], s38 offen sc1
  s_add_u32 s38, s38, 4096
  v_mfma_f32_16x16x32_bf16 a[100:103], a[180:183], v[104:107], a[100:103]
  v_exp_f32 v53, v53
  v_mfma_f32_16x16x32_bf16 a[100:103], a[176:179], v[72:75], a[100:103]
  v_cvt_pk_bf16_f32 v50, v52, v53
  v_mfma_f32_16x16x32_bf16 a[104:107], a[176:179], v[80:83], a[104:107]
  v_exp_f32 v54, v54
  v_mfma_f32_16x16x32_bf16 a[104:107], a[180:183], v[112:115], a[104:107]
  v_mfma_f32_16x16x32_bf16 a[108:111], a[180:183], v[120:123], a[108:111]
  s_waitcnt lgkmcnt(4)
  v_exp_f32 v55, v55
  v_mfma_f32_16x16x32_bf16 a[108:111], a[176:179], v[88:91], a[108:111]
  v_cvt_pk_bf16_f32 v51, v54, v55
  v_mfma_f32_16x16x32_bf16 a[112:115], a[184:187], v[64:67], a[112:115]
  v_exp_f32 v60, v60
  v_mfma_f32_16x16x32_bf16 a[112:115], a[188:191], v[96:99], a[112:115]
  v_mfma_f32_16x16x32_bf16 a[116:119], a[188:191], v[104:107], a[116:119]
  v_exp_f32 v61, v61
  v_mfma_f32_16x16x32_bf16 a[116:119], a[184:187], v[72:75], a[116:119]
  v_cvt_pk_bf16_f32 v58, v60, v61
  v_mfma_f32_16x16x32_bf16 a[120:123], a[184:187], v[80:83], a[120:123]
  v_exp_f32 v62, v62
  v_mfma_f32_16x16x32_bf16 a[120:123], a[188:191], v[112:115], a[120:123]
  v_mfma_f32_16x16x32_bf16 a[124:127], a[188:191], v[120:123], a[124:127]
  s_waitcnt lgkmcnt(0)
  v_exp_f32 v63, v63
  v_mfma_f32_16x16x32_bf16 a[124:127], a[184:187], v[88:91], a[124:127]
  v_cvt_pk_bf16_f32 v59, v62, v63
  v_mfma_f32_16x16x32_bf16 v[64:67], a[128:131], v[128:131], v[192:195]
  s_add_u32 m0, s28, 65536
  v_mfma_f32_16x16x32_bf16 v[64:67], a[132:135], v[132:135], v[64:67]
  ds_read_b128 a[144:147], v212 offset:53248
  v_mfma_f32_16x16x32_bf16 v[64:67], a[136:139], v[136:139], v[64:67]
  buffer_load_dwordx4 v236, s[16:19], s29 offen offset:0 lds
  v_mfma_f32_16x16x32_bf16 v[64:67], a[140:143], v[140:143], v[64:67]
  ds_read_b128 a[148:151], v213 offset:53248
  v_mfma_f32_16x16x32_bf16 v[72:75], a[140:143], v[156:159], v[196:199]
  v_mfma_f32_16x16x32_bf16 v[72:75], a[136:139], v[152:155], v[72:75]
  ds_read_b128 a[152:155], v214 offset:53248
  v_mfma_f32_16x16x32_bf16 v[72:75], a[132:135], v[148:151], v[72:75]
  buffer_load_dwordx4 v237, s[16:19], s29 offen offset:1024 lds
  v_mfma_f32_16x16x32_bf16 v[72:75], a[128:131], v[144:147], v[72:75]
  ds_read_b128 a[156:159], v215 offset:53248
  v_mfma_f32_16x16x32_bf16 v[80:83], a[128:131], v[160:163], v[200:203]
  v_exp_f32 v64, v64
  v_mfma_f32_16x16x32_bf16 v[80:83], a[132:135], v[164:167], v[80:83]
  v_mfma_f32_16x16x32_bf16 v[80:83], a[136:139], v[168:171], v[80:83]
  v_exp_f32 v65, v65
  v_mfma_f32_16x16x32_bf16 v[80:83], a[140:143], v[172:175], v[80:83]
  v_cvt_pk_bf16_f32 v64, v64, v65
  v_mfma_f32_16x16x32_bf16 v[88:91], a[140:143], v[188:191], v[204:207]
  v_exp_f32 v66, v66
  v_mfma_f32_16x16x32_bf16 v[88:91], a[136:139], v[184:187], v[88:91]
  buffer_load_dwordx4 v236, s[16:19], s29 offen offset:2048 lds
  v_mfma_f32_16x16x32_bf16 v[88:91], a[132:135], v[180:183], v[88:91]
  s_waitcnt lgkmcnt(0)
  v_exp_f32 v67, v67
  v_mfma_f32_16x16x32_bf16 v[88:91], a[128:131], v[176:179], v[88:91]
  v_cvt_pk_bf16_f32 v65, v66, v67
  v_mfma_f32_16x16x32_bf16 v[68:71], a[144:147], v[128:131], v[192:195]
  v_exp_f32 v72, v72
  v_mfma_f32_16x16x32_bf16 v[68:71], a[148:151], v[132:135], v[68:71]
  ds_read_b128 a[128:131], v212 offset:57344
  v_mfma_f32_16x16x32_bf16 v[68:71], a[152:155], v[136:139], v[68:71]
  v_exp_f32 v73, v73
  v_mfma_f32_16x16x32_bf16 v[68:71], a[156:159], v[140:143], v[68:71]
  ds_read_b128 a[132:135], v213 offset:57344
  v_cvt_pk_bf16_f32 v72, v72, v73
  v_mfma_f32_16x16x32_bf16 v[76:79], a[156:159], v[156:159], v[196:199]
  v_exp_f32 v74, v74
  v_mfma_f32_16x16x32_bf16 v[76:79], a[152:155], v[152:155], v[76:79]
  ds_read_b128 a[136:139], v214 offset:57344
  v_mfma_f32_16x16x32_bf16 v[76:79], a[148:151], v[148:151], v[76:79]
  v_exp_f32 v75, v75
  v_mfma_f32_16x16x32_bf16 v[76:79], a[144:147], v[144:147], v[76:79]
  ds_read_b128 a[140:143], v215 offset:57344
  v_cvt_pk_bf16_f32 v73, v74, v75
  v_mfma_f32_16x16x32_bf16 v[84:87], a[144:147], v[160:163], v[200:203]
  v_exp_f32 v80, v80
  v_mfma_f32_16x16x32_bf16 v[84:87], a[148:151], v[164:167], v[84:87]
  buffer_load_dwordx4 v237, s[16:19], s29 offen offset:3072 lds
  v_mfma_f32_16x16x32_bf16 v[84:87], a[152:155], v[168:171], v[84:87]
  s_add_u32 s29, s29, 16384
  v_exp_f32 v81, v81
  v_mfma_f32_16x16x32_bf16 v[84:87], a[156:159], v[172:175], v[84:87]
  v_cvt_pk_bf16_f32 v80, v80, v81
  v_mfma_f32_16x16x32_bf16 v[92:95], a[156:159], v[188:191], v[204:207]
  s_add_u32 m0, s28, 16384
  v_exp_f32 v82, v82
  v_mfma_f32_16x16x32_bf16 v[92:95], a[152:155], v[184:187], v[92:95]
  buffer_load_dwordx4 v232, s[12:15], s29 offen offset:0 lds
  v_mfma_f32_16x16x32_bf16 v[92:95], a[148:151], v[180:183], v[92:95]
  s_waitcnt lgkmcnt(0)
  v_exp_f32 v83, v83
  v_mfma_f32_16x16x32_bf16 v[92:95], a[144:147], v[176:179], v[92:95]
  v_cvt_pk_bf16_f32 v81, v82, v83
  v_mfma_f32_16x16x32_bf16 v[96:99], a[128:131], v[128:131], v[192:195]
  v_exp_f32 v88, v88
  v_mfma_f32_16x16x32_bf16 v[96:99], a[132:135], v[132:135], v[96:99]
  ds_read_b128 a[144:147], v212 offset:61440
  v_mfma_f32_16x16x32_bf16 v[96:99], a[136:139], v[136:139], v[96:99]
  v_exp_f32 v89, v89
  v_mfma_f32_16x16x32_bf16 v[96:99], a[140:143], v[140:143], v[96:99]
  ds_read_b128 a[148:151], v213 offset:61440
  v_cvt_pk_bf16_f32 v88, v88, v89
  v_mfma_f32_16x16x32_bf16 v[104:107], a[140:143], v[156:159], v[196:199]
  v_exp_f32 v90, v90
  v_mfma_f32_16x16x32_bf16 v[104:107], a[136:139], v[152:155], v[104:107]
  ds_read_b128 a[152:155], v214 offset:61440
  v_mfma_f32_16x16x32_bf16 v[104:107], a[132:135], v[148:151], v[104:107]
  v_exp_f32 v91, v91
  v_mfma_f32_16x16x32_bf16 v[104:107], a[128:131], v[144:147], v[104:107]
  ds_read_b128 a[156:159], v215 offset:61440
  v_cvt_pk_bf16_f32 v89, v90, v91
  v_mfma_f32_16x16x32_bf16 v[112:115], a[128:131], v[160:163], v[200:203]
  v_exp_f32 v68, v68
  v_mfma_f32_16x16x32_bf16 v[112:115], a[132:135], v[164:167], v[112:115]
  buffer_load_dwordx4 v233, s[12:15], s29 offen offset:1024 lds
  v_mfma_f32_16x16x32_bf16 v[112:115], a[136:139], v[168:171], v[112:115]
  v_exp_f32 v69, v69
  v_mfma_f32_16x16x32_bf16 v[112:115], a[140:143], v[172:175], v[112:115]
  v_cvt_pk_bf16_f32 v66, v68, v69
  v_mfma_f32_16x16x32_bf16 v[120:123], a[140:143], v[188:191], v[204:207]
  v_exp_f32 v70, v70
  v_mfma_f32_16x16x32_bf16 v[120:123], a[136:139], v[184:187], v[120:123]
  buffer_load_dwordx4 v234, s[12:15], s29 offen offset:2048 lds
  v_mfma_f32_16x16x32_bf16 v[120:123], a[132:135], v[180:183], v[120:123]
  s_waitcnt lgkmcnt(0)
  v_exp_f32 v71, v71
  v_mfma_f32_16x16x32_bf16 v[120:123], a[128:131], v[176:179], v[120:123]
  v_cvt_pk_bf16_f32 v67, v70, v71
  v_mfma_f32_16x16x32_bf16 v[100:103], a[144:147], v[128:131], v[192:195]
  v_exp_f32 v76, v76
  v_mfma_f32_16x16x32_bf16 v[100:103], a[148:151], v[132:135], v[100:103]
  ds_read_b64_tr_b16 a[160:161], v216 offset:32768
  v_mfma_f32_16x16x32_bf16 v[100:103], a[152:155], v[136:139], v[100:103]
  v_exp_f32 v77, v77
  v_mfma_f32_16x16x32_bf16 v[100:103], a[156:159], v[140:143], v[100:103]
  ds_read_b64_tr_b16 a[162:163], v216 offset:36864
  v_cvt_pk_bf16_f32 v74, v76, v77
  v_mfma_f32_16x16x32_bf16 v[108:111], a[156:159], v[156:159], v[196:199]
  v_exp_f32 v78, v78
  v_mfma_f32_16x16x32_bf16 v[108:111], a[152:155], v[152:155], v[108:111]
  ds_read_b64_tr_b16 a[164:165], v216 offset:40960
  buffer_load_dwordx4 v235, s[12:15], s29 offen offset:3072 lds
  v_mfma_f32_16x16x32_bf16 v[108:111], a[148:151], v[148:151], v[108:111]
  v_exp_f32 v79, v79
  v_mfma_f32_16x16x32_bf16 v[108:111], a[144:147], v[144:147], v[108:111]
  ds_read_b64_tr_b16 a[166:167], v216 offset:45056
  v_cvt_pk_bf16_f32 v75, v78, v79
  v_mfma_f32_16x16x32_bf16 v[116:119], a[144:147], v[160:163], v[200:203]
  v_exp_f32 v84, v84
  v_mfma_f32_16x16x32_bf16 v[116:119], a[148:151], v[164:167], v[116:119]
  ds_read_b64_tr_b16 a[168:169], v217 offset:32768
  s_add_u32 m0, s50, 4096
  v_mfma_f32_16x16x32_bf16 v[116:119], a[152:155], v[168:171], v[116:119]
  v_exp_f32 v85, v85
  v_mfma_f32_16x16x32_bf16 v[116:119], a[156:159], v[172:175], v[116:119]
  ds_read_b64_tr_b16 a[170:171], v217 offset:36864
  v_cvt_pk_bf16_f32 v82, v84, v85
  v_mfma_f32_16x16x32_bf16 v[124:127], a[156:159], v[188:191], v[204:207]
  v_exp_f32 v86, v86
  v_mfma_f32_16x16x32_bf16 v[124:127], a[152:155], v[184:187], v[124:127]
  ds_read_b64_tr_b16 a[172:173], v217 offset:40960
  buffer_load_dwordx4 v253, s[44:47], s35 offen lds
  s_add_u32 s35, s35, 221184
  v_mfma_f32_16x16x32_bf16 v[124:127], a[148:151], v[180:183], v[124:127]
  v_exp_f32 v87, v87
  v_mfma_f32_16x16x32_bf16 v[124:127], a[144:147], v[176:179], v[124:127]
  ds_read_b64_tr_b16 a[174:175], v217 offset:45056
  v_cvt_pk_bf16_f32 v83, v86, v87
  v_mfma_f32_16x16x32_bf16 a[192:195], a[208:211], v[0:3], a[192:195]
  v_exp_f32 v92, v92
  v_mfma_f32_16x16x32_bf16 a[192:195], a[208:211], v[32:35], a[192:195]
  ds_read_b64_tr_b16 a[176:177], v218 offset:32768
  v_lshrrev_b32 v254, 4, v242
  v_mfma_f32_16x16x32_bf16 a[196:199], a[208:211], v[8:11], a[196:199]
  v_exp_f32 v93, v93
  v_mfma_f32_16x16x32_bf16 a[196:199], a[208:211], v[40:43], a[196:199]
  ds_read_b64_tr_b16 a[178:179], v218 offset:36864
  v_cvt_pk_bf16_f32 v90, v92, v93
  v_mfma_f32_16x16x32_bf16 a[200:203], a[208:211], v[16:19], a[200:203]
  v_exp_f32 v94, v94
  v_mfma_f32_16x16x32_bf16 a[200:203], a[208:211], v[48:51], a[200:203]
  ds_read_b64_tr_b16 a[180:181], v218 offset:40960
  v_lshrrev_b32 v254, 5, v254
  v_mfma_f32_16x16x32_bf16 a[204:207], a[208:211], v[24:27], a[204:207]
  s_waitcnt lgkmcnt(7)
  v_exp_f32 v95, v95
  v_mfma_f32_16x16x32_bf16 a[204:207], a[208:211], v[56:59], a[204:207]
  ds_read_b64_tr_b16 a[182:183], v218 offset:45056
  v_cvt_pk_bf16_f32 v91, v94, v95
  v_mfma_f32_16x16x32_bf16 a[0:3], a[160:163], v[0:3], a[0:3]
  v_exp_f32 v96, v96
  v_mfma_f32_16x16x32_bf16 a[0:3], a[164:167], v[32:35], a[0:3]
  ds_read_b64_tr_b16 a[184:185], v219 offset:32768
  v_lshl_add_u32 v253, v254, 30, v253
  v_mfma_f32_16x16x32_bf16 a[4:7], a[164:167], v[40:43], a[4:7]
  v_exp_f32 v97, v97
  v_mfma_f32_16x16x32_bf16 a[4:7], a[160:163], v[8:11], a[4:7]
  ds_read_b64_tr_b16 a[186:187], v219 offset:36864
  v_cvt_pk_bf16_f32 v96, v96, v97
  v_mfma_f32_16x16x32_bf16 a[8:11], a[160:163], v[16:19], a[8:11]
  v_exp_f32 v98, v98
  v_mfma_f32_16x16x32_bf16 a[8:11], a[164:167], v[48:51], a[8:11]
  ds_read_b64_tr_b16 a[188:189], v219 offset:40960
  v_mfma_f32_16x16x32_bf16 a[12:15], a[164:167], v[56:59], a[12:15]
  s_waitcnt lgkmcnt(7)
  v_exp_f32 v99, v99
  v_mfma_f32_16x16x32_bf16 a[12:15], a[160:163], v[24:27], a[12:15]
  ds_read_b64_tr_b16 a[190:191], v219 offset:45056
  v_cvt_pk_bf16_f32 v97, v98, v99
  v_mfma_f32_16x16x32_bf16 a[16:19], a[168:171], v[0:3], a[16:19]
  v_exp_f32 v104, v104
  v_mfma_f32_16x16x32_bf16 a[16:19], a[172:175], v[32:35], a[16:19]
  ds_read_b64_tr_b16 a[160:161], v220 offset:32768
  v_mfma_f32_16x16x32_bf16 a[20:23], a[172:175], v[40:43], a[20:23]
  v_exp_f32 v105, v105
  v_mfma_f32_16x16x32_bf16 a[20:23], a[168:171], v[8:11], a[20:23]
  ds_read_b64_tr_b16 a[162:163], v220 offset:36864
  v_cvt_pk_bf16_f32 v104, v104, v105
  v_mfma_f32_16x16x32_bf16 a[24:27], a[168:171], v[16:19], a[24:27]
  v_exp_f32 v106, v106
  v_mfma_f32_16x16x32_bf16 a[24:27], a[172:175], v[48:51], a[24:27]
  ds_read_b64_tr_b16 a[164:165], v220 offset:40960
  v_mfma_f32_16x16x32_bf16 a[28:31], a[172:175], v[56:59], a[28:31]
  s_waitcnt lgkmcnt(7)
  v_exp_f32 v107, v107
  v_mfma_f32_16x16x32_bf16 a[28:31], a[168:171], v[24:27], a[28:31]
  ds_read_b64_tr_b16 a[166:167], v220 offset:45056
  v_cvt_pk_bf16_f32 v105, v106, v107
  v_mfma_f32_16x16x32_bf16 a[32:35], a[176:179], v[0:3], a[32:35]
  v_exp_f32 v112, v112
  v_mfma_f32_16x16x32_bf16 a[32:35], a[180:183], v[32:35], a[32:35]
  ds_read_b64_tr_b16 a[168:169], v221 offset:32768
  v_mfma_f32_16x16x32_bf16 a[36:39], a[180:183], v[40:43], a[36:39]
  v_exp_f32 v113, v113
  v_mfma_f32_16x16x32_bf16 a[36:39], a[176:179], v[8:11], a[36:39]
  ds_read_b64_tr_b16 a[170:171], v221 offset:36864
  v_cvt_pk_bf16_f32 v112, v112, v113
  v_mfma_f32_16x16x32_bf16 a[40:43], a[176:179], v[16:19], a[40:43]
  v_exp_f32 v114, v114
  v_mfma_f32_16x16x32_bf16 a[40:43], a[180:183], v[48:51], a[40:43]
  ds_read_b64_tr_b16 a[172:173], v221 offset:40960
  v_mfma_f32_16x16x32_bf16 a[44:47], a[180:183], v[56:59], a[44:47]
  s_waitcnt lgkmcnt(7)
  v_exp_f32 v115, v115
  v_mfma_f32_16x16x32_bf16 a[44:47], a[176:179], v[24:27], a[44:47]
  ds_read_b64_tr_b16 a[174:175], v221 offset:45056
  v_cvt_pk_bf16_f32 v113, v114, v115
  v_mfma_f32_16x16x32_bf16 a[48:51], a[184:187], v[0:3], a[48:51]
  v_exp_f32 v120, v120
  v_mfma_f32_16x16x32_bf16 a[48:51], a[188:191], v[32:35], a[48:51]
  ds_read_b64_tr_b16 a[176:177], v222 offset:32768
  v_mfma_f32_16x16x32_bf16 a[52:55], a[188:191], v[40:43], a[52:55]
  v_exp_f32 v121, v121
  v_mfma_f32_16x16x32_bf16 a[52:55], a[184:187], v[8:11], a[52:55]
  ds_read_b64_tr_b16 a[178:179], v222 offset:36864
  v_cvt_pk_bf16_f32 v120, v120, v121
  v_mfma_f32_16x16x32_bf16 a[56:59], a[184:187], v[16:19], a[56:59]
  v_exp_f32 v122, v122
  v_mfma_f32_16x16x32_bf16 a[56:59], a[188:191], v[48:51], a[56:59]
  ds_read_b64_tr_b16 a[180:181], v222 offset:40960
  v_mfma_f32_16x16x32_bf16 a[60:63], a[188:191], v[56:59], a[60:63]
  s_waitcnt lgkmcnt(7)
  v_exp_f32 v123, v123
  v_mfma_f32_16x16x32_bf16 a[60:63], a[184:187], v[24:27], a[60:63]
  ds_read_b64_tr_b16 a[182:183], v222 offset:45056
  v_cvt_pk_bf16_f32 v121, v122, v123
  v_mfma_f32_16x16x32_bf16 a[64:67], a[160:163], v[0:3], a[64:67]
  v_exp_f32 v100, v100
  v_mfma_f32_16x16x32_bf16 a[64:67], a[164:167], v[32:35], a[64:67]
  ds_read_b64_tr_b16 a[184:185], v223 offset:32768
  v_mfma_f32_16x16x32_bf16 a[68:71], a[164:167], v[40:43], a[68:71]
  v_exp_f32 v101, v101
  v_mfma_f32_16x16x32_bf16 a[68:71], a[160:163], v[8:11], a[68:71]
  ds_read_b64_tr_b16 a[186:187], v223 offset:36864
  v_cvt_pk_bf16_f32 v98, v100, v101
  v_mfma_f32_16x16x32_bf16 a[72:75], a[160:163], v[16:19], a[72:75]
  v_exp_f32 v102, v102
  v_mfma_f32_16x16x32_bf16 a[72:75], a[164:167], v[48:51], a[72:75]
  ds_read_b64_tr_b16 a[188:189], v223 offset:40960
  v_mfma_f32_16x16x32_bf16 a[76:79], a[164:167], v[56:59], a[76:79]
  s_waitcnt lgkmcnt(7)
  v_exp_f32 v103, v103
  v_mfma_f32_16x16x32_bf16 a[76:79], a[160:163], v[24:27], a[76:79]
  ds_read_b64_tr_b16 a[190:191], v223 offset:45056
  v_cvt_pk_bf16_f32 v99, v102, v103
  v_mfma_f32_16x16x32_bf16 a[80:83], a[168:171], v[0:3], a[80:83]
  s_waitcnt vmcnt(11)
  v_exp_f32 v108, v108
  v_mfma_f32_16x16x32_bf16 a[80:83], a[172:175], v[32:35], a[80:83]
  v_mfma_f32_16x16x32_bf16 a[84:87], a[172:175], v[40:43], a[84:87]
  s_barrier
  v_exp_f32 v109, v109
  v_mfma_f32_16x16x32_bf16 a[84:87], a[168:171], v[8:11], a[84:87]
  ds_read_b128 a[128:131], v212 offset:0
  v_cvt_pk_bf16_f32 v106, v108, v109
  v_mfma_f32_16x16x32_bf16 a[88:91], a[168:171], v[16:19], a[88:91]
  v_exp_f32 v110, v110
  v_mfma_f32_16x16x32_bf16 a[88:91], a[172:175], v[48:51], a[88:91]
  ds_read_b128 a[132:135], v213 offset:0
  v_mfma_f32_16x16x32_bf16 a[92:95], a[172:175], v[56:59], a[92:95]
  s_waitcnt lgkmcnt(6)
  v_exp_f32 v111, v111
  v_mfma_f32_16x16x32_bf16 a[92:95], a[168:171], v[24:27], a[92:95]
  ds_read_b128 a[136:139], v214 offset:0
  v_cvt_pk_bf16_f32 v107, v110, v111
  v_mfma_f32_16x16x32_bf16 a[96:99], a[176:179], v[0:3], a[96:99]
  v_exp_f32 v116, v116
  v_mfma_f32_16x16x32_bf16 a[96:99], a[180:183], v[32:35], a[96:99]
  ds_read_b128 a[140:143], v215 offset:0
  buffer_load_dwordx4 a[220:223], v243, s[24:27], s38 offen sc1
  s_add_u32 s38, s38, 4096
  v_mfma_f32_16x16x32_bf16 a[100:103], a[180:183], v[40:43], a[100:103]
  v_exp_f32 v117, v117
  v_mfma_f32_16x16x32_bf16 a[100:103], a[176:179], v[8:11], a[100:103]
  v_cvt_pk_bf16_f32 v114, v116, v117
  v_mfma_f32_16x16x32_bf16 a[104:107], a[176:179], v[16:19], a[104:107]
  v_exp_f32 v118, v118
  v_mfma_f32_16x16x32_bf16 a[104:107], a[180:183], v[48:51], a[104:107]
  v_mfma_f32_16x16x32_bf16 a[108:111], a[180:183], v[56:59], a[108:111]
  s_waitcnt lgkmcnt(4)
  v_exp_f32 v119, v119
  v_mfma_f32_16x16x32_bf16 a[108:111], a[176:179], v[24:27], a[108:111]
  v_cvt_pk_bf16_f32 v115, v118, v119
  v_mfma_f32_16x16x32_bf16 a[112:115], a[184:187], v[0:3], a[112:115]
  v_exp_f32 v124, v124
  v_mfma_f32_16x16x32_bf16 a[112:115], a[188:191], v[32:35], a[112:115]
  v_mfma_f32_16x16x32_bf16 a[116:119], a[188:191], v[40:43], a[116:119]
  v_exp_f32 v125, v125
  v_mfma_f32_16x16x32_bf16 a[116:119], a[184:187], v[8:11], a[116:119]
  v_cvt_pk_bf16_f32 v122, v124, v125
  v_mfma_f32_16x16x32_bf16 a[120:123], a[184:187], v[16:19], a[120:123]
  v_exp_f32 v126, v126
  v_mfma_f32_16x16x32_bf16 a[120:123], a[188:191], v[48:51], a[120:123]
  v_mfma_f32_16x16x32_bf16 a[124:127], a[188:191], v[56:59], a[124:127]
  s_waitcnt lgkmcnt(0)
  v_exp_f32 v127, v127
  v_mfma_f32_16x16x32_bf16 a[124:127], a[184:187], v[24:27], a[124:127]
  v_cvt_pk_bf16_f32 v123, v126, v127
  v_mfma_f32_16x16x32_bf16 v[0:3], a[128:131], v[128:131], v[192:195]
  s_add_u32 m0, s28, 81920
  v_mfma_f32_16x16x32_bf16 v[0:3], a[132:135], v[132:135], v[0:3]
  ds_read_b128 a[144:147], v212 offset:4096
  v_mfma_f32_16x16x32_bf16 v[0:3], a[136:139], v[136:139], v[0:3]
  buffer_load_dwordx4 v236, s[16:19], s29 offen offset:0 lds
  v_mfma_f32_16x16x32_bf16 v[0:3], a[140:143], v[140:143], v[0:3]
  ds_read_b128 a[148:151], v213 offset:4096
  v_mfma_f32_16x16x32_bf16 v[8:11], a[140:143], v[156:159], v[196:199]
  v_mfma_f32_16x16x32_bf16 v[8:11], a[136:139], v[152:155], v[8:11]
  ds_read_b128 a[152:155], v214 offset:4096
  v_mfma_f32_16x16x32_bf16 v[8:11], a[132:135], v[148:151], v[8:11]
  buffer_load_dwordx4 v237, s[16:19], s29 offen offset:1024 lds
  v_mfma_f32_16x16x32_bf16 v[8:11], a[128:131], v[144:147], v[8:11]
  ds_read_b128 a[156:159], v215 offset:4096
  v_mfma_f32_16x16x32_bf16 v[16:19], a[128:131], v[160:163], v[200:203]
  v_exp_f32 v0, v0
  v_mfma_f32_16x16x32_bf16 v[16:19], a[132:135], v[164:167], v[16:19]
  v_mfma_f32_16x16x32_bf16 v[16:19], a[136:139], v[168:171], v[16:19]
  v_exp_f32 v1, v1
  v_mfma_f32_16x16x32_bf16 v[16:19], a[140:143], v[172:175], v[16:19]
  v_cvt_pk_bf16_f32 v0, v0, v1
  v_mfma_f32_16x16x32_bf16 v[24:27], a[140:143], v[188:191], v[204:207]
  v_exp_f32 v2, v2
  v_mfma_f32_16x16x32_bf16 v[24:27], a[136:139], v[184:187], v[24:27]
  buffer_load_dwordx4 v236, s[16:19], s29 offen offset:2048 lds
  v_mfma_f32_16x16x32_bf16 v[24:27], a[132:135], v[180:183], v[24:27]
  s_waitcnt lgkmcnt(0)
  v_exp_f32 v3, v3
  v_mfma_f32_16x16x32_bf16 v[24:27], a[128:131], v[176:179], v[24:27]
  v_cvt_pk_bf16_f32 v1, v2, v3
  v_mfma_f32_16x16x32_bf16 v[4:7], a[144:147], v[128:131], v[192:195]
  v_exp_f32 v8, v8
  v_mfma_f32_16x16x32_bf16 v[4:7], a[148:151], v[132:135], v[4:7]
  ds_read_b128 a[128:131], v212 offset:8192
  v_mfma_f32_16x16x32_bf16 v[4:7], a[152:155], v[136:139], v[4:7]
  v_exp_f32 v9, v9
  v_mfma_f32_16x16x32_bf16 v[4:7], a[156:159], v[140:143], v[4:7]
  ds_read_b128 a[132:135], v213 offset:8192
  v_cvt_pk_bf16_f32 v8, v8, v9
  v_mfma_f32_16x16x32_bf16 v[12:15], a[156:159], v[156:159], v[196:199]
  v_exp_f32 v10, v10
  v_mfma_f32_16x16x32_bf16 v[12:15], a[152:155], v[152:155], v[12:15]
  ds_read_b128 a[136:139], v214 offset:8192
  v_mfma_f32_16x16x32_bf16 v[12:15], a[148:151], v[148:151], v[12:15]
  v_exp_f32 v11, v11
  v_mfma_f32_16x16x32_bf16 v[12:15], a[144:147], v[144:147], v[12:15]
  ds_read_b128 a[140:143], v215 offset:8192
  v_cvt_pk_bf16_f32 v9, v10, v11
  v_mfma_f32_16x16x32_bf16 v[20:23], a[144:147], v[160:163], v[200:203]
  v_exp_f32 v16, v16
  v_mfma_f32_16x16x32_bf16 v[20:23], a[148:151], v[164:167], v[20:23]
  buffer_load_dwordx4 v237, s[16:19], s29 offen offset:3072 lds
  v_mfma_f32_16x16x32_bf16 v[20:23], a[152:155], v[168:171], v[20:23]
  s_add_u32 s29, s29, 16384
  v_exp_f32 v17, v17
  v_mfma_f32_16x16x32_bf16 v[20:23], a[156:159], v[172:175], v[20:23]
  v_cvt_pk_bf16_f32 v16, v16, v17
  v_mfma_f32_16x16x32_bf16 v[28:31], a[156:159], v[188:191], v[204:207]
  s_add_u32 m0, s28, 32768
  v_exp_f32 v18, v18
  v_mfma_f32_16x16x32_bf16 v[28:31], a[152:155], v[184:187], v[28:31]
  buffer_load_dwordx4 v232, s[12:15], s29 offen offset:0 lds
  v_mfma_f32_16x16x32_bf16 v[28:31], a[148:151], v[180:183], v[28:31]
  s_waitcnt lgkmcnt(0)
  v_exp_f32 v19, v19
  v_mfma_f32_16x16x32_bf16 v[28:31], a[144:147], v[176:179], v[28:31]
  v_cvt_pk_bf16_f32 v17, v18, v19
  v_mfma_f32_16x16x32_bf16 v[32:35], a[128:131], v[128:131], v[192:195]
  v_exp_f32 v24, v24
  v_mfma_f32_16x16x32_bf16 v[32:35], a[132:135], v[132:135], v[32:35]
  ds_read_b128 a[144:147], v212 offset:12288
  v_mfma_f32_16x16x32_bf16 v[32:35], a[136:139], v[136:139], v[32:35]
  v_exp_f32 v25, v25
  v_mfma_f32_16x16x32_bf16 v[32:35], a[140:143], v[140:143], v[32:35]
  ds_read_b128 a[148:151], v213 offset:12288
  v_cvt_pk_bf16_f32 v24, v24, v25
  v_mfma_f32_16x16x32_bf16 v[40:43], a[140:143], v[156:159], v[196:199]
  v_exp_f32 v26, v26
  v_mfma_f32_16x16x32_bf16 v[40:43], a[136:139], v[152:155], v[40:43]
  ds_read_b128 a[152:155], v214 offset:12288
  v_mfma_f32_16x16x32_bf16 v[40:43], a[132:135], v[148:151], v[40:43]
  v_exp_f32 v27, v27
  v_mfma_f32_16x16x32_bf16 v[40:43], a[128:131], v[144:147], v[40:43]
  ds_read_b128 a[156:159], v215 offset:12288
  v_cvt_pk_bf16_f32 v25, v26, v27
  v_mfma_f32_16x16x32_bf16 v[48:51], a[128:131], v[160:163], v[200:203]
  v_exp_f32 v4, v4
  v_mfma_f32_16x16x32_bf16 v[48:51], a[132:135], v[164:167], v[48:51]
  buffer_load_dwordx4 v233, s[12:15], s29 offen offset:1024 lds
  v_mfma_f32_16x16x32_bf16 v[48:51], a[136:139], v[168:171], v[48:51]
  v_exp_f32 v5, v5
  v_mfma_f32_16x16x32_bf16 v[48:51], a[140:143], v[172:175], v[48:51]
  v_cvt_pk_bf16_f32 v2, v4, v5
  v_mfma_f32_16x16x32_bf16 v[56:59], a[140:143], v[188:191], v[204:207]
  v_exp_f32 v6, v6
  v_mfma_f32_16x16x32_bf16 v[56:59], a[136:139], v[184:187], v[56:59]
  buffer_load_dwordx4 v234, s[12:15], s29 offen offset:2048 lds
  v_mfma_f32_16x16x32_bf16 v[56:59], a[132:135], v[180:183], v[56:59]
  s_waitcnt lgkmcnt(0)
  v_exp_f32 v7, v7
  v_mfma_f32_16x16x32_bf16 v[56:59], a[128:131], v[176:179], v[56:59]
  v_cvt_pk_bf16_f32 v3, v6, v7
  v_mfma_f32_16x16x32_bf16 v[36:39], a[144:147], v[128:131], v[192:195]
  v_exp_f32 v12, v12
  v_mfma_f32_16x16x32_bf16 v[36:39], a[148:151], v[132:135], v[36:39]
  ds_read_b64_tr_b16 a[160:161], v216 offset:49152
  v_mfma_f32_16x16x32_bf16 v[36:39], a[152:155], v[136:139], v[36:39]
  v_exp_f32 v13, v13
  v_mfma_f32_16x16x32_bf16 v[36:39], a[156:159], v[140:143], v[36:39]
  ds_read_b64_tr_b16 a[162:163], v216 offset:53248
  v_cvt_pk_bf16_f32 v10, v12, v13
  v_mfma_f32_16x16x32_bf16 v[44:47], a[156:159], v[156:159], v[196:199]
  v_exp_f32 v14, v14
  v_mfma_f32_16x16x32_bf16 v[44:47], a[152:155], v[152:155], v[44:47]
  ds_read_b64_tr_b16 a[164:165], v216 offset:57344
  buffer_load_dwordx4 v235, s[12:15], s29 offen offset:3072 lds
  v_mfma_f32_16x16x32_bf16 v[44:47], a[148:151], v[148:151], v[44:47]
  v_exp_f32 v15, v15
  v_mfma_f32_16x16x32_bf16 v[44:47], a[144:147], v[144:147], v[44:47]
  ds_read_b64_tr_b16 a[166:167], v216 offset:61440
  v_cvt_pk_bf16_f32 v11, v14, v15
  v_mfma_f32_16x16x32_bf16 v[52:55], a[144:147], v[160:163], v[200:203]
  v_exp_f32 v20, v20
  v_mfma_f32_16x16x32_bf16 v[52:55], a[148:151], v[164:167], v[52:55]
  ds_read_b64_tr_b16 a[168:169], v217 offset:49152
  s_add_u32 m0, s50, 2048
  v_mfma_f32_16x16x32_bf16 v[52:55], a[152:155], v[168:171], v[52:55]
  v_exp_f32 v21, v21
  v_mfma_f32_16x16x32_bf16 v[52:55], a[156:159], v[172:175], v[52:55]
  ds_read_b64_tr_b16 a[170:171], v217 offset:53248
  v_cvt_pk_bf16_f32 v18, v20, v21
  v_mfma_f32_16x16x32_bf16 v[60:63], a[156:159], v[188:191], v[204:207]
  v_exp_f32 v22, v22
  v_mfma_f32_16x16x32_bf16 v[60:63], a[152:155], v[184:187], v[60:63]
  ds_read_b64_tr_b16 a[172:173], v217 offset:57344
  buffer_load_dwordx4 v253, s[20:23], s35 offen lds
  v_mfma_f32_16x16x32_bf16 v[60:63], a[148:151], v[180:183], v[60:63]
  v_exp_f32 v23, v23
  v_mfma_f32_16x16x32_bf16 v[60:63], a[144:147], v[176:179], v[60:63]
  ds_read_b64_tr_b16 a[174:175], v217 offset:61440
  v_cvt_pk_bf16_f32 v19, v22, v23
  v_mfma_f32_16x16x32_bf16 a[192:195], a[208:211], v[64:67], a[192:195]
  v_exp_f32 v28, v28
  v_mfma_f32_16x16x32_bf16 a[192:195], a[208:211], v[96:99], a[192:195]
  ds_read_b64_tr_b16 a[176:177], v218 offset:49152
  v_mfma_f32_16x16x32_bf16 a[196:199], a[208:211], v[72:75], a[196:199]
  v_exp_f32 v29, v29
  v_mfma_f32_16x16x32_bf16 a[196:199], a[208:211], v[104:107], a[196:199]
  ds_read_b64_tr_b16 a[178:179], v218 offset:53248
  v_cvt_pk_bf16_f32 v26, v28, v29
  v_mfma_f32_16x16x32_bf16 a[200:203], a[208:211], v[80:83], a[200:203]
  v_exp_f32 v30, v30
  v_mfma_f32_16x16x32_bf16 a[200:203], a[208:211], v[112:115], a[200:203]
  ds_read_b64_tr_b16 a[180:181], v218 offset:57344
  v_mfma_f32_16x16x32_bf16 a[204:207], a[208:211], v[88:91], a[204:207]
  s_waitcnt lgkmcnt(7)
  v_exp_f32 v31, v31
  v_mfma_f32_16x16x32_bf16 a[204:207], a[208:211], v[120:123], a[204:207]
  ds_read_b64_tr_b16 a[182:183], v218 offset:61440
  v_cvt_pk_bf16_f32 v27, v30, v31
  v_mfma_f32_16x16x32_bf16 a[0:3], a[160:163], v[64:67], a[0:3]
  v_exp_f32 v32, v32
  v_mfma_f32_16x16x32_bf16 a[0:3], a[164:167], v[96:99], a[0:3]
  ds_read_b64_tr_b16 a[184:185], v219 offset:49152
  v_mfma_f32_16x16x32_bf16 a[4:7], a[164:167], v[104:107], a[4:7]
  v_exp_f32 v33, v33
  v_mfma_f32_16x16x32_bf16 a[4:7], a[160:163], v[72:75], a[4:7]
  ds_read_b64_tr_b16 a[186:187], v219 offset:53248
  v_cvt_pk_bf16_f32 v32, v32, v33
  v_mfma_f32_16x16x32_bf16 a[8:11], a[160:163], v[80:83], a[8:11]
  v_exp_f32 v34, v34
  v_mfma_f32_16x16x32_bf16 a[8:11], a[164:167], v[112:115], a[8:11]
  ds_read_b64_tr_b16 a[188:189], v219 offset:57344
  v_mfma_f32_16x16x32_bf16 a[12:15], a[164:167], v[120:123], a[12:15]
  s_waitcnt lgkmcnt(7)
  v_exp_f32 v35, v35
  v_mfma_f32_16x16x32_bf16 a[12:15], a[160:163], v[88:91], a[12:15]
  ds_read_b64_tr_b16 a[190:191], v219 offset:61440
  v_cvt_pk_bf16_f32 v33, v34, v35
  v_mfma_f32_16x16x32_bf16 a[16:19], a[168:171], v[64:67], a[16:19]
  v_exp_f32 v40, v40
  v_mfma_f32_16x16x32_bf16 a[16:19], a[172:175], v[96:99], a[16:19]
  ds_read_b64_tr_b16 a[160:161], v220 offset:49152
  v_mfma_f32_16x16x32_bf16 a[20:23], a[172:175], v[104:107], a[20:23]
  v_exp_f32 v41, v41
  v_mfma_f32_16x16x32_bf16 a[20:23], a[168:171], v[72:75], a[20:23]
  ds_read_b64_tr_b16 a[162:163], v220 offset:53248
  v_cvt_pk_bf16_f32 v40, v40, v41
  v_mfma_f32_16x16x32_bf16 a[24:27], a[168:171], v[80:83], a[24:27]
  v_exp_f32 v42, v42
  v_mfma_f32_16x16x32_bf16 a[24:27], a[172:175], v[112:115], a[24:27]
  ds_read_b64_tr_b16 a[164:165], v220 offset:57344
  v_mfma_f32_16x16x32_bf16 a[28:31], a[172:175], v[120:123], a[28:31]
  s_waitcnt lgkmcnt(7)
  v_exp_f32 v43, v43
  v_mfma_f32_16x16x32_bf16 a[28:31], a[168:171], v[88:91], a[28:31]
  ds_read_b64_tr_b16 a[166:167], v220 offset:61440
  v_cvt_pk_bf16_f32 v41, v42, v43
  v_mfma_f32_16x16x32_bf16 a[32:35], a[176:179], v[64:67], a[32:35]
  v_exp_f32 v48, v48
  v_mfma_f32_16x16x32_bf16 a[32:35], a[180:183], v[96:99], a[32:35]
  ds_read_b64_tr_b16 a[168:169], v221 offset:49152
  v_mfma_f32_16x16x32_bf16 a[36:39], a[180:183], v[104:107], a[36:39]
  v_exp_f32 v49, v49
  v_mfma_f32_16x16x32_bf16 a[36:39], a[176:179], v[72:75], a[36:39]
  ds_read_b64_tr_b16 a[170:171], v221 offset:53248
  v_cvt_pk_bf16_f32 v48, v48, v49
  v_mfma_f32_16x16x32_bf16 a[40:43], a[176:179], v[80:83], a[40:43]
  v_exp_f32 v50, v50
  v_mfma_f32_16x16x32_bf16 a[40:43], a[180:183], v[112:115], a[40:43]
  ds_read_b64_tr_b16 a[172:173], v221 offset:57344
  v_mfma_f32_16x16x32_bf16 a[44:47], a[180:183], v[120:123], a[44:47]
  s_waitcnt lgkmcnt(7)
  v_exp_f32 v51, v51
  v_mfma_f32_16x16x32_bf16 a[44:47], a[176:179], v[88:91], a[44:47]
  ds_read_b64_tr_b16 a[174:175], v221 offset:61440
  v_cvt_pk_bf16_f32 v49, v50, v51
  v_mfma_f32_16x16x32_bf16 a[48:51], a[184:187], v[64:67], a[48:51]
  v_exp_f32 v56, v56
  v_mfma_f32_16x16x32_bf16 a[48:51], a[188:191], v[96:99], a[48:51]
  ds_read_b64_tr_b16 a[176:177], v222 offset:49152
  v_mfma_f32_16x16x32_bf16 a[52:55], a[188:191], v[104:107], a[52:55]
  v_exp_f32 v57, v57
  v_mfma_f32_16x16x32_bf16 a[52:55], a[184:187], v[72:75], a[52:55]
  ds_read_b64_tr_b16 a[178:179], v222 offset:53248
  v_cvt_pk_bf16_f32 v56, v56, v57
  v_mfma_f32_16x16x32_bf16 a[56:59], a[184:187], v[80:83], a[56:59]
  v_exp_f32 v58, v58
  v_mfma_f32_16x16x32_bf16 a[56:59], a[188:191], v[112:115], a[56:59]
  ds_read_b64_tr_b16 a[180:181], v222 offset:57344
  v_mfma_f32_16x16x32_bf16 a[60:63], a[188:191], v[120:123], a[60:63]
  s_waitcnt lgkmcnt(7)
  v_exp_f32 v59, v59
  v_mfma_f32_16x16x32_bf16 a[60:63], a[184:187], v[88:91], a[60:63]
  ds_read_b64_tr_b16 a[182:183], v222 offset:61440
  v_cvt_pk_bf16_f32 v57, v58, v59
  v_mfma_f32_16x16x32_bf16 a[64:67], a[160:163], v[64:67], a[64:67]
  v_exp_f32 v36, v36
  v_mfma_f32_16x16x32_bf16 a[64:67], a[164:167], v[96:99], a[64:67]
  ds_read_b64_tr_b16 a[184:185], v223 offset:49152
  v_mfma_f32_16x16x32_bf16 a[68:71], a[164:167], v[104:107], a[68:71]
  v_exp_f32 v37, v37
  v_mfma_f32_16x16x32_bf16 a[68:71], a[160:163], v[72:75], a[68:71]
  ds_read_b64_tr_b16 a[186:187], v223 offset:53248
  v_cvt_pk_bf16_f32 v34, v36, v37
  v_mfma_f32_16x16x32_bf16 a[72:75], a[160:163], v[80:83], a[72:75]
  v_exp_f32 v38, v38
  v_mfma_f32_16x16x32_bf16 a[72:75], a[164:167], v[112:115], a[72:75]
  ds_read_b64_tr_b16 a[188:189], v223 offset:57344
  v_mfma_f32_16x16x32_bf16 a[76:79], a[164:167], v[120:123], a[76:79]
  s_waitcnt lgkmcnt(7)
  v_exp_f32 v39, v39
  v_mfma_f32_16x16x32_bf16 a[76:79], a[160:163], v[88:91], a[76:79]
  ds_read_b64_tr_b16 a[190:191], v223 offset:61440
  v_cvt_pk_bf16_f32 v35, v38, v39
  v_mfma_f32_16x16x32_bf16 a[80:83], a[168:171], v[64:67], a[80:83]
  s_waitcnt vmcnt(11)
  v_exp_f32 v44, v44
  v_mfma_f32_16x16x32_bf16 a[80:83], a[172:175], v[96:99], a[80:83]
  v_mfma_f32_16x16x32_bf16 a[84:87], a[172:175], v[104:107], a[84:87]
  s_barrier
  v_exp_f32 v45, v45
  v_mfma_f32_16x16x32_bf16 a[84:87], a[168:171], v[72:75], a[84:87]
  ds_read_b128 a[128:131], v212 offset:16384
  v_cvt_pk_bf16_f32 v42, v44, v45
  v_mfma_f32_16x16x32_bf16 a[88:91], a[168:171], v[80:83], a[88:91]
  v_exp_f32 v46, v46
  v_mfma_f32_16x16x32_bf16 a[88:91], a[172:175], v[112:115], a[88:91]
  ds_read_b128 a[132:135], v213 offset:16384
  v_mfma_f32_16x16x32_bf16 a[92:95], a[172:175], v[120:123], a[92:95]
  s_waitcnt lgkmcnt(6)
  v_exp_f32 v47, v47
  v_mfma_f32_16x16x32_bf16 a[92:95], a[168:171], v[88:91], a[92:95]
  ds_read_b128 a[136:139], v214 offset:16384
  v_cvt_pk_bf16_f32 v43, v46, v47
  v_mfma_f32_16x16x32_bf16 a[96:99], a[176:179], v[64:67], a[96:99]
  v_exp_f32 v52, v52
  v_mfma_f32_16x16x32_bf16 a[96:99], a[180:183], v[96:99], a[96:99]
  ds_read_b128 a[140:143], v215 offset:16384
  buffer_load_dwordx4 a[224:227], v243, s[24:27], s38 offen sc1
  s_add_u32 s38, s38, 4096
  v_mfma_f32_16x16x32_bf16 a[100:103], a[180:183], v[104:107], a[100:103]
  v_exp_f32 v53, v53
  v_mfma_f32_16x16x32_bf16 a[100:103], a[176:179], v[72:75], a[100:103]
  v_cvt_pk_bf16_f32 v50, v52, v53
  v_mfma_f32_16x16x32_bf16 a[104:107], a[176:179], v[80:83], a[104:107]
  v_exp_f32 v54, v54
  v_mfma_f32_16x16x32_bf16 a[104:107], a[180:183], v[112:115], a[104:107]
  v_mfma_f32_16x16x32_bf16 a[108:111], a[180:183], v[120:123], a[108:111]
  s_waitcnt lgkmcnt(4)
  v_exp_f32 v55, v55
  v_mfma_f32_16x16x32_bf16 a[108:111], a[176:179], v[88:91], a[108:111]
  v_cvt_pk_bf16_f32 v51, v54, v55
  v_mfma_f32_16x16x32_bf16 a[112:115], a[184:187], v[64:67], a[112:115]
  v_exp_f32 v60, v60
  v_mfma_f32_16x16x32_bf16 a[112:115], a[188:191], v[96:99], a[112:115]
  v_mfma_f32_16x16x32_bf16 a[116:119], a[188:191], v[104:107], a[116:119]
  v_exp_f32 v61, v61
  v_mfma_f32_16x16x32_bf16 a[116:119], a[184:187], v[72:75], a[116:119]
  v_cvt_pk_bf16_f32 v58, v60, v61
  v_mfma_f32_16x16x32_bf16 a[120:123], a[184:187], v[80:83], a[120:123]
  v_exp_f32 v62, v62
  v_mfma_f32_16x16x32_bf16 a[120:123], a[188:191], v[112:115], a[120:123]
  v_mfma_f32_16x16x32_bf16 a[124:127], a[188:191], v[120:123], a[124:127]
  s_waitcnt lgkmcnt(0)
  v_exp_f32 v63, v63
  v_mfma_f32_16x16x32_bf16 a[124:127], a[184:187], v[88:91], a[124:127]
  v_cvt_pk_bf16_f32 v59, v62, v63
  v_mfma_f32_16x16x32_bf16 v[64:67], a[128:131], v[128:131], v[192:195]
  s_add_u32 m0, s28, 98304
  v_mfma_f32_16x16x32_bf16 v[64:67], a[132:135], v[132:135], v[64:67]
  ds_read_b128 a[144:147], v212 offset:20480
  v_mfma_f32_16x16x32_bf16 v[64:67], a[136:139], v[136:139], v[64:67]
  buffer_load_dwordx4 v236, s[16:19], s29 offen offset:0 lds
  v_mfma_f32_16x16x32_bf16 v[64:67], a[140:143], v[140:143], v[64:67]
  ds_read_b128 a[148:151], v213 offset:20480
  v_mfma_f32_16x16x32_bf16 v[72:75], a[140:143], v[156:159], v[196:199]
  v_mfma_f32_16x16x32_bf16 v[72:75], a[136:139], v[152:155], v[72:75]
  ds_read_b128 a[152:155], v214 offset:20480
  v_mfma_f32_16x16x32_bf16 v[72:75], a[132:135], v[148:151], v[72:75]
  buffer_load_dwordx4 v237, s[16:19], s29 offen offset:1024 lds
  v_mfma_f32_16x16x32_bf16 v[72:75], a[128:131], v[144:147], v[72:75]
  ds_read_b128 a[156:159], v215 offset:20480
  v_mfma_f32_16x16x32_bf16 v[80:83], a[128:131], v[160:163], v[200:203]
  v_exp_f32 v64, v64
  v_mfma_f32_16x16x32_bf16 v[80:83], a[132:135], v[164:167], v[80:83]
  v_mfma_f32_16x16x32_bf16 v[80:83], a[136:139], v[168:171], v[80:83]
  v_exp_f32 v65, v65
  v_mfma_f32_16x16x32_bf16 v[80:83], a[140:143], v[172:175], v[80:83]
  v_cvt_pk_bf16_f32 v64, v64, v65
  v_mfma_f32_16x16x32_bf16 v[88:91], a[140:143], v[188:191], v[204:207]
  v_exp_f32 v66, v66
  v_mfma_f32_16x16x32_bf16 v[88:91], a[136:139], v[184:187], v[88:91]
  buffer_load_dwordx4 v236, s[16:19], s29 offen offset:2048 lds
  v_mfma_f32_16x16x32_bf16 v[88:91], a[132:135], v[180:183], v[88:91]
  s_waitcnt lgkmcnt(0)
  v_exp_f32 v67, v67
  v_mfma_f32_16x16x32_bf16 v[88:91], a[128:131], v[176:179], v[88:91]
  v_cvt_pk_bf16_f32 v65, v66, v67
  v_mfma_f32_16x16x32_bf16 v[68:71], a[144:147], v[128:131], v[192:195]
  v_exp_f32 v72, v72
  v_mfma_f32_16x16x32_bf16 v[68:71], a[148:151], v[132:135], v[68:71]
  ds_read_b128 a[128:131], v212 offset:24576
  v_mfma_f32_16x16x32_bf16 v[68:71], a[152:155], v[136:139], v[68:71]
  v_exp_f32 v73, v73
  v_mfma_f32_16x16x32_bf16 v[68:71], a[156:159], v[140:143], v[68:71]
  ds_read_b128 a[132:135], v213 offset:24576
  v_cvt_pk_bf16_f32 v72, v72, v73
  v_mfma_f32_16x16x32_bf16 v[76:79], a[156:159], v[156:159], v[196:199]
  v_exp_f32 v74, v74
  v_mfma_f32_16x16x32_bf16 v[76:79], a[152:155], v[152:155], v[76:79]
  ds_read_b128 a[136:139], v214 offset:24576
  v_mfma_f32_16x16x32_bf16 v[76:79], a[148:151], v[148:151], v[76:79]
  v_exp_f32 v75, v75
  v_mfma_f32_16x16x32_bf16 v[76:79], a[144:147], v[144:147], v[76:79]
  ds_read_b128 a[140:143], v215 offset:24576
  v_cvt_pk_bf16_f32 v73, v74, v75
  v_mfma_f32_16x16x32_bf16 v[84:87], a[144:147], v[160:163], v[200:203]
  v_exp_f32 v80, v80
  v_mfma_f32_16x16x32_bf16 v[84:87], a[148:151], v[164:167], v[84:87]
  buffer_load_dwordx4 v237, s[16:19], s29 offen offset:3072 lds
  v_mfma_f32_16x16x32_bf16 v[84:87], a[152:155], v[168:171], v[84:87]
  s_add_u32 s29, s29, 16384
  v_exp_f32 v81, v81
  v_mfma_f32_16x16x32_bf16 v[84:87], a[156:159], v[172:175], v[84:87]
  v_cvt_pk_bf16_f32 v80, v80, v81
  v_mfma_f32_16x16x32_bf16 v[92:95], a[156:159], v[188:191], v[204:207]
  s_add_u32 m0, s28, 49152
  v_exp_f32 v82, v82
  v_mfma_f32_16x16x32_bf16 v[92:95], a[152:155], v[184:187], v[92:95]
  buffer_load_dwordx4 v232, s[12:15], s29 offen offset:0 lds
  v_mfma_f32_16x16x32_bf16 v[92:95], a[148:151], v[180:183], v[92:95]
  s_waitcnt lgkmcnt(0)
  v_exp_f32 v83, v83
  v_mfma_f32_16x16x32_bf16 v[92:95], a[144:147], v[176:179], v[92:95]
  v_cvt_pk_bf16_f32 v81, v82, v83
  v_mfma_f32_16x16x32_bf16 v[96:99], a[128:131], v[128:131], v[192:195]
  v_exp_f32 v88, v88
  v_mfma_f32_16x16x32_bf16 v[96:99], a[132:135], v[132:135], v[96:99]
  ds_read_b128 a[144:147], v212 offset:28672
  v_mfma_f32_16x16x32_bf16 v[96:99], a[136:139], v[136:139], v[96:99]
  v_exp_f32 v89, v89
  v_mfma_f32_16x16x32_bf16 v[96:99], a[140:143], v[140:143], v[96:99]
  ds_read_b128 a[148:151], v213 offset:28672
  v_cvt_pk_bf16_f32 v88, v88, v89
  v_mfma_f32_16x16x32_bf16 v[104:107], a[140:143], v[156:159], v[196:199]
  v_exp_f32 v90, v90
  v_mfma_f32_16x16x32_bf16 v[104:107], a[136:139], v[152:155], v[104:107]
  ds_read_b128 a[152:155], v214 offset:28672
  v_mfma_f32_16x16x32_bf16 v[104:107], a[132:135], v[148:151], v[104:107]
  v_exp_f32 v91, v91
  v_mfma_f32_16x16x32_bf16 v[104:107], a[128:131], v[144:147], v[104:107]
  ds_read_b128 a[156:159], v215 offset:28672
  v_cvt_pk_bf16_f32 v89, v90, v91
  v_mfma_f32_16x16x32_bf16 v[112:115], a[128:131], v[160:163], v[200:203]
  v_exp_f32 v68, v68
  v_mfma_f32_16x16x32_bf16 v[112:115], a[132:135], v[164:167], v[112:115]
  buffer_load_dwordx4 v233, s[12:15], s29 offen offset:1024 lds
  v_mfma_f32_16x16x32_bf16 v[112:115], a[136:139], v[168:171], v[112:115]
  v_exp_f32 v69, v69
  v_mfma_f32_16x16x32_bf16 v[112:115], a[140:143], v[172:175], v[112:115]
  v_cvt_pk_bf16_f32 v66, v68, v69
  v_mfma_f32_16x16x32_bf16 v[120:123], a[140:143], v[188:191], v[204:207]
  v_exp_f32 v70, v70
  v_mfma_f32_16x16x32_bf16 v[120:123], a[136:139], v[184:187], v[120:123]
  buffer_load_dwordx4 v234, s[12:15], s29 offen offset:2048 lds
  v_mfma_f32_16x16x32_bf16 v[120:123], a[132:135], v[180:183], v[120:123]
  s_waitcnt lgkmcnt(0)
  v_exp_f32 v71, v71
  v_mfma_f32_16x16x32_bf16 v[120:123], a[128:131], v[176:179], v[120:123]
  v_cvt_pk_bf16_f32 v67, v70, v71
  v_mfma_f32_16x16x32_bf16 v[100:103], a[144:147], v[128:131], v[192:195]
  v_exp_f32 v76, v76
  v_mfma_f32_16x16x32_bf16 v[100:103], a[148:151], v[132:135], v[100:103]
  ds_read_b64_tr_b16 a[160:161], v216 offset:0
  v_mfma_f32_16x16x32_bf16 v[100:103], a[152:155], v[136:139], v[100:103]
  v_exp_f32 v77, v77
  v_mfma_f32_16x16x32_bf16 v[100:103], a[156:159], v[140:143], v[100:103]
  ds_read_b64_tr_b16 a[162:163], v216 offset:4096
  v_cvt_pk_bf16_f32 v74, v76, v77
  v_mfma_f32_16x16x32_bf16 v[108:111], a[156:159], v[156:159], v[196:199]
  v_exp_f32 v78, v78
  v_mfma_f32_16x16x32_bf16 v[108:111], a[152:155], v[152:155], v[108:111]
  ds_read_b64_tr_b16 a[164:165], v216 offset:8192
  buffer_load_dwordx4 v235, s[12:15], s29 offen offset:3072 lds
  v_mfma_f32_16x16x32_bf16 v[108:111], a[148:151], v[148:151], v[108:111]
  v_exp_f32 v79, v79
  v_mfma_f32_16x16x32_bf16 v[108:111], a[144:147], v[144:147], v[108:111]
  ds_read_b64_tr_b16 a[166:167], v216 offset:12288
  v_cvt_pk_bf16_f32 v75, v78, v79
  v_mfma_f32_16x16x32_bf16 v[116:119], a[144:147], v[160:163], v[200:203]
  v_exp_f32 v84, v84
  v_mfma_f32_16x16x32_bf16 v[116:119], a[148:151], v[164:167], v[116:119]
  ds_read_b64_tr_b16 a[168:169], v217 offset:0
  s_add_u32 m0, s50, 5120
  v_mfma_f32_16x16x32_bf16 v[116:119], a[152:155], v[168:171], v[116:119]
  v_exp_f32 v85, v85
  v_mfma_f32_16x16x32_bf16 v[116:119], a[156:159], v[172:175], v[116:119]
  ds_read_b64_tr_b16 a[170:171], v217 offset:4096
  v_cvt_pk_bf16_f32 v82, v84, v85
  v_mfma_f32_16x16x32_bf16 v[124:127], a[156:159], v[188:191], v[204:207]
  v_exp_f32 v86, v86
  v_mfma_f32_16x16x32_bf16 v[124:127], a[152:155], v[184:187], v[124:127]
  ds_read_b64_tr_b16 a[172:173], v217 offset:8192
  buffer_load_dwordx4 v253, s[44:47], s35 offen lds
  s_add_u32 s35, s35, 221184
  v_mfma_f32_16x16x32_bf16 v[124:127], a[148:151], v[180:183], v[124:127]
  v_exp_f32 v87, v87
  v_mfma_f32_16x16x32_bf16 v[124:127], a[144:147], v[176:179], v[124:127]
  ds_read_b64_tr_b16 a[174:175], v217 offset:12288
  v_cvt_pk_bf16_f32 v83, v86, v87
  v_mfma_f32_16x16x32_bf16 a[192:195], a[208:211], v[0:3], a[192:195]
  v_exp_f32 v92, v92
  v_mfma_f32_16x16x32_bf16 a[192:195], a[208:211], v[32:35], a[192:195]
  ds_read_b64_tr_b16 a[176:177], v218 offset:0
  v_mfma_f32_16x16x32_bf16 a[196:199], a[208:211], v[8:11], a[196:199]
  v_exp_f32 v93, v93
  v_mfma_f32_16x16x32_bf16 a[196:199], a[208:211], v[40:43], a[196:199]
  ds_read_b64_tr_b16 a[178:179], v218 offset:4096
  v_cvt_pk_bf16_f32 v90, v92, v93
  v_mfma_f32_16x16x32_bf16 a[200:203], a[208:211], v[16:19], a[200:203]
  v_exp_f32 v94, v94
  v_mfma_f32_16x16x32_bf16 a[200:203], a[208:211], v[48:51], a[200:203]
  ds_read_b64_tr_b16 a[180:181], v218 offset:8192
  v_mfma_f32_16x16x32_bf16 a[204:207], a[208:211], v[24:27], a[204:207]
  s_waitcnt lgkmcnt(7)
  v_exp_f32 v95, v95
  v_mfma_f32_16x16x32_bf16 a[204:207], a[208:211], v[56:59], a[204:207]
  ds_read_b64_tr_b16 a[182:183], v218 offset:12288
  v_cvt_pk_bf16_f32 v91, v94, v95
  v_mfma_f32_16x16x32_bf16 a[0:3], a[160:163], v[0:3], a[0:3]
  v_exp_f32 v96, v96
  v_mfma_f32_16x16x32_bf16 a[0:3], a[164:167], v[32:35], a[0:3]
  ds_read_b64_tr_b16 a[184:185], v219 offset:0
  v_mfma_f32_16x16x32_bf16 a[4:7], a[164:167], v[40:43], a[4:7]
  v_exp_f32 v97, v97
  v_mfma_f32_16x16x32_bf16 a[4:7], a[160:163], v[8:11], a[4:7]
  ds_read_b64_tr_b16 a[186:187], v219 offset:4096
  v_cvt_pk_bf16_f32 v96, v96, v97
  v_mfma_f32_16x16x32_bf16 a[8:11], a[160:163], v[16:19], a[8:11]
  v_exp_f32 v98, v98
  v_mfma_f32_16x16x32_bf16 a[8:11], a[164:167], v[48:51], a[8:11]
  ds_read_b64_tr_b16 a[188:189], v219 offset:8192
  v_mfma_f32_16x16x32_bf16 a[12:15], a[164:167], v[56:59], a[12:15]
  s_waitcnt lgkmcnt(7)
  v_exp_f32 v99, v99
  v_mfma_f32_16x16x32_bf16 a[12:15], a[160:163], v[24:27], a[12:15]
  ds_read_b64_tr_b16 a[190:191], v219 offset:12288
  v_cvt_pk_bf16_f32 v97, v98, v99
  v_mfma_f32_16x16x32_bf16 a[16:19], a[168:171], v[0:3], a[16:19]
  v_exp_f32 v104, v104
  v_mfma_f32_16x16x32_bf16 a[16:19], a[172:175], v[32:35], a[16:19]
  ds_read_b64_tr_b16 a[160:161], v220 offset:0
  v_mfma_f32_16x16x32_bf16 a[20:23], a[172:175], v[40:43], a[20:23]
  v_exp_f32 v105, v105
  v_mfma_f32_16x16x32_bf16 a[20:23], a[168:171], v[8:11], a[20:23]
  ds_read_b64_tr_b16 a[162:163], v220 offset:4096
  v_cvt_pk_bf16_f32 v104, v104, v105
  v_mfma_f32_16x16x32_bf16 a[24:27], a[168:171], v[16:19], a[24:27]
  v_exp_f32 v106, v106
  v_mfma_f32_16x16x32_bf16 a[24:27], a[172:175], v[48:51], a[24:27]
  ds_read_b64_tr_b16 a[164:165], v220 offset:8192
  v_mfma_f32_16x16x32_bf16 a[28:31], a[172:175], v[56:59], a[28:31]
  s_waitcnt lgkmcnt(7)
  v_exp_f32 v107, v107
  v_mfma_f32_16x16x32_bf16 a[28:31], a[168:171], v[24:27], a[28:31]
  ds_read_b64_tr_b16 a[166:167], v220 offset:12288
  v_cvt_pk_bf16_f32 v105, v106, v107
  v_mfma_f32_16x16x32_bf16 a[32:35], a[176:179], v[0:3], a[32:35]
  v_exp_f32 v112, v112
  v_mfma_f32_16x16x32_bf16 a[32:35], a[180:183], v[32:35], a[32:35]
  ds_read_b64_tr_b16 a[168:169], v221 offset:0
  v_mfma_f32_16x16x32_bf16 a[36:39], a[180:183], v[40:43], a[36:39]
  v_exp_f32 v113, v113
  v_mfma_f32_16x16x32_bf16 a[36:39], a[176:179], v[8:11], a[36:39]
  ds_read_b64_tr_b16 a[170:171], v221 offset:4096
  v_cvt_pk_bf16_f32 v112, v112, v113
  v_mfma_f32_16x16x32_bf16 a[40:43], a[176:179], v[16:19], a[40:43]
  v_exp_f32 v114, v114
  v_mfma_f32_16x16x32_bf16 a[40:43], a[180:183], v[48:51], a[40:43]
  ds_read_b64_tr_b16 a[172:173], v221 offset:8192
  v_mfma_f32_16x16x32_bf16 a[44:47], a[180:183], v[56:59], a[44:47]
  s_waitcnt lgkmcnt(7)
  v_exp_f32 v115, v115
  v_mfma_f32_16x16x32_bf16 a[44:47], a[176:179], v[24:27], a[44:47]
  ds_read_b64_tr_b16 a[174:175], v221 offset:12288
  v_cvt_pk_bf16_f32 v113, v114, v115
  v_mfma_f32_16x16x32_bf16 a[48:51], a[184:187], v[0:3], a[48:51]
  v_exp_f32 v120, v120
  v_mfma_f32_16x16x32_bf16 a[48:51], a[188:191], v[32:35], a[48:51]
  ds_read_b64_tr_b16 a[176:177], v222 offset:0
  v_mfma_f32_16x16x32_bf16 a[52:55], a[188:191], v[40:43], a[52:55]
  v_exp_f32 v121, v121
  v_mfma_f32_16x16x32_bf16 a[52:55], a[184:187], v[8:11], a[52:55]
  ds_read_b64_tr_b16 a[178:179], v222 offset:4096
  v_cvt_pk_bf16_f32 v120, v120, v121
  v_mfma_f32_16x16x32_bf16 a[56:59], a[184:187], v[16:19], a[56:59]
  v_exp_f32 v122, v122
  v_mfma_f32_16x16x32_bf16 a[56:59], a[188:191], v[48:51], a[56:59]
  ds_read_b64_tr_b16 a[180:181], v222 offset:8192
  v_mfma_f32_16x16x32_bf16 a[60:63], a[188:191], v[56:59], a[60:63]
  s_waitcnt lgkmcnt(7)
  v_exp_f32 v123, v123
  v_mfma_f32_16x16x32_bf16 a[60:63], a[184:187], v[24:27], a[60:63]
  ds_read_b64_tr_b16 a[182:183], v222 offset:12288
  v_cvt_pk_bf16_f32 v121, v122, v123
  v_mfma_f32_16x16x32_bf16 a[64:67], a[160:163], v[0:3], a[64:67]
  v_exp_f32 v100, v100
  v_mfma_f32_16x16x32_bf16 a[64:67], a[164:167], v[32:35], a[64:67]
  ds_read_b64_tr_b16 a[184:185], v223 offset:0
  v_mfma_f32_16x16x32_bf16 a[68:71], a[164:167], v[40:43], a[68:71]
  v_exp_f32 v101, v101
  v_mfma_f32_16x16x32_bf16 a[68:71], a[160:163], v[8:11], a[68:71]
  ds_read_b64_tr_b16 a[186:187], v223 offset:4096
  v_cvt_pk_bf16_f32 v98, v100, v101
  v_mfma_f32_16x16x32_bf16 a[72:75], a[160:163], v[16:19], a[72:75]
  v_exp_f32 v102, v102
  v_mfma_f32_16x16x32_bf16 a[72:75], a[164:167], v[48:51], a[72:75]
  ds_read_b64_tr_b16 a[188:189], v223 offset:8192
  v_mfma_f32_16x16x32_bf16 a[76:79], a[164:167], v[56:59], a[76:79]
  s_waitcnt lgkmcnt(7)
  v_exp_f32 v103, v103
  v_mfma_f32_16x16x32_bf16 a[76:79], a[160:163], v[24:27], a[76:79]
  ds_read_b64_tr_b16 a[190:191], v223 offset:12288
  v_cvt_pk_bf16_f32 v99, v102, v103
  v_mfma_f32_16x16x32_bf16 a[80:83], a[168:171], v[0:3], a[80:83]
  s_waitcnt vmcnt(11)
  v_exp_f32 v108, v108
  v_mfma_f32_16x16x32_bf16 a[80:83], a[172:175], v[32:35], a[80:83]
  v_mfma_f32_16x16x32_bf16 a[84:87], a[172:175], v[40:43], a[84:87]
  s_barrier
  v_exp_f32 v109, v109
  v_mfma_f32_16x16x32_bf16 a[84:87], a[168:171], v[8:11], a[84:87]
  ds_read_b128 a[128:131], v212 offset:32768
  v_cvt_pk_bf16_f32 v106, v108, v109
  v_mfma_f32_16x16x32_bf16 a[88:91], a[168:171], v[16:19], a[88:91]
  v_exp_f32 v110, v110
  v_mfma_f32_16x16x32_bf16 a[88:91], a[172:175], v[48:51], a[88:91]
  ds_read_b128 a[132:135], v213 offset:32768
  v_mfma_f32_16x16x32_bf16 a[92:95], a[172:175], v[56:59], a[92:95]
  s_waitcnt lgkmcnt(6)
  v_exp_f32 v111, v111
  v_mfma_f32_16x16x32_bf16 a[92:95], a[168:171], v[24:27], a[92:95]
  ds_read_b128 a[136:139], v214 offset:32768
  v_cvt_pk_bf16_f32 v107, v110, v111
  v_mfma_f32_16x16x32_bf16 a[96:99], a[176:179], v[0:3], a[96:99]
  v_exp_f32 v116, v116
  v_mfma_f32_16x16x32_bf16 a[96:99], a[180:183], v[32:35], a[96:99]
  ds_read_b128 a[140:143], v215 offset:32768
  buffer_load_dwordx4 a[228:231], v243, s[24:27], s38 offen sc1
  s_add_u32 s38, s38, 4096
  v_mfma_f32_16x16x32_bf16 a[100:103], a[180:183], v[40:43], a[100:103]
  v_exp_f32 v117, v117
  v_mfma_f32_16x16x32_bf16 a[100:103], a[176:179], v[8:11], a[100:103]
  v_cvt_pk_bf16_f32 v114, v116, v117
  v_mfma_f32_16x16x32_bf16 a[104:107], a[176:179], v[16:19], a[104:107]
  v_exp_f32 v118, v118
  v_mfma_f32_16x16x32_bf16 a[104:107], a[180:183], v[48:51], a[104:107]
  v_mfma_f32_16x16x32_bf16 a[108:111], a[180:183], v[56:59], a[108:111]
  s_waitcnt lgkmcnt(4)
  v_exp_f32 v119, v119
  v_mfma_f32_16x16x32_bf16 a[108:111], a[176:179], v[24:27], a[108:111]
  v_cvt_pk_bf16_f32 v115, v118, v119
  v_mfma_f32_16x16x32_bf16 a[112:115], a[184:187], v[0:3], a[112:115]
  v_exp_f32 v124, v124
  v_mfma_f32_16x16x32_bf16 a[112:115], a[188:191], v[32:35], a[112:115]
  v_mfma_f32_16x16x32_bf16 a[116:119], a[188:191], v[40:43], a[116:119]
  v_exp_f32 v125, v125
  v_mfma_f32_16x16x32_bf16 a[116:119], a[184:187], v[8:11], a[116:119]
  v_cvt_pk_bf16_f32 v122, v124, v125
  v_mfma_f32_16x16x32_bf16 a[120:123], a[184:187], v[16:19], a[120:123]
  v_exp_f32 v126, v126
  v_mfma_f32_16x16x32_bf16 a[120:123], a[188:191], v[48:51], a[120:123]
  v_mfma_f32_16x16x32_bf16 a[124:127], a[188:191], v[56:59], a[124:127]
  s_waitcnt lgkmcnt(0)
  v_exp_f32 v127, v127
  v_mfma_f32_16x16x32_bf16 a[124:127], a[184:187], v[24:27], a[124:127]
  v_cvt_pk_bf16_f32 v123, v126, v127
  v_mfma_f32_16x16x32_bf16 v[0:3], a[128:131], v[128:131], v[192:195]
  s_add_u32 m0, s28, 114688
  s_mov_b32 s20, s88
  s_mov_b32 s21, s89
  v_mfma_f32_16x16x32_bf16 v[0:3], a[132:135], v[132:135], v[0:3]
  ds_read_b128 a[144:147], v212 offset:36864
  s_mov_b32 s22, 5242880
  s_mov_b32 s23, 0x20000
  v_lshrrev_b32 v208, 4, v242
  v_mfma_f32_16x16x32_bf16 v[0:3], a[136:139], v[136:139], v[0:3]
  buffer_load_dwordx4 v236, s[16:19], s29 offen offset:0 lds
  v_mfma_f32_16x16x32_bf16 v[0:3], a[140:143], v[140:143], v[0:3]
  ds_read_b128 a[148:151], v213 offset:36864
  v_and_b32 v209, 1, v208
  v_mfma_f32_16x16x32_bf16 v[8:11], a[140:143], v[156:159], v[196:199]
  v_lshrrev_b32 v208, 1, v208
  v_mul_u32_u24 v208, 0x500, v208
  v_mfma_f32_16x16x32_bf16 v[8:11], a[136:139], v[152:155], v[8:11]
  ds_read_b128 a[152:155], v214 offset:36864
  v_lshl_add_u32 v208, v209, 4, v208
  v_mfma_f32_16x16x32_bf16 v[8:11], a[132:135], v[148:151], v[8:11]
  buffer_load_dwordx4 v237, s[16:19], s29 offen offset:1024 lds
  v_mfma_f32_16x16x32_bf16 v[8:11], a[128:131], v[144:147], v[8:11]
  ds_read_b128 a[156:159], v215 offset:36864
  v_lshrrev_b32 v209, 4, v242
  v_mfma_f32_16x16x32_bf16 v[16:19], a[128:131], v[160:163], v[200:203]
  v_exp_f32 v0, v0
  v_mfma_f32_16x16x32_bf16 v[16:19], a[132:135], v[164:167], v[16:19]
  v_lshrrev_b32 v210, 5, v209
  v_lshlrev_b32 v210, 30, v210
  v_mfma_f32_16x16x32_bf16 v[16:19], a[136:139], v[168:171], v[16:19]
  v_exp_f32 v1, v1
  v_mfma_f32_16x16x32_bf16 v[16:19], a[140:143], v[172:175], v[16:19]
  v_cvt_pk_bf16_f32 v0, v0, v1
  v_or_b32 v210, v210, v208
  v_mfma_f32_16x16x32_bf16 v[24:27], a[140:143], v[188:191], v[204:207]
  v_exp_f32 v2, v2
  v_mfma_f32_16x16x32_bf16 v[24:27], a[136:139], v[184:187], v[24:27]
  buffer_load_dwordx4 v236, s[16:19], s29 offen offset:2048 lds
  v_mfma_f32_16x16x32_bf16 v[24:27], a[132:135], v[180:183], v[24:27]
  s_waitcnt lgkmcnt(0)
  v_exp_f32 v3, v3
  v_mfma_f32_16x16x32_bf16 v[24:27], a[128:131], v[176:179], v[24:27]
  v_cvt_pk_bf16_f32 v1, v2, v3
  v_bfe_u32 v211, v209, 2, 4
  v_mfma_f32_16x16x32_bf16 v[4:7], a[144:147], v[128:131], v[192:195]
  v_exp_f32 v8, v8
  v_mfma_f32_16x16x32_bf16 v[4:7], a[148:151], v[132:135], v[4:7]
  ds_read_b128 a[128:131], v212 offset:40960
  v_and_b32 v209, 3, v209
  v_mfma_f32_16x16x32_bf16 v[4:7], a[152:155], v[136:139], v[4:7]
  v_exp_f32 v9, v9
  v_mfma_f32_16x16x32_bf16 v[4:7], a[156:159], v[140:143], v[4:7]
  ds_read_b128 a[132:135], v213 offset:40960
  v_cvt_pk_bf16_f32 v8, v8, v9
  v_mfma_f32_16x16x32_bf16 v[12:15], a[156:159], v[156:159], v[196:199]
  v_exp_f32 v10, v10
  v_mfma_f32_16x16x32_bf16 v[12:15], a[152:155], v[152:155], v[12:15]
  ds_read_b128 a[136:139], v214 offset:40960
  v_lshlrev_b32 v209, 3, v209
  v_mfma_f32_16x16x32_bf16 v[12:15], a[148:151], v[148:151], v[12:15]
  v_exp_f32 v11, v11
  v_mfma_f32_16x16x32_bf16 v[12:15], a[144:147], v[144:147], v[12:15]
  ds_read_b128 a[140:143], v215 offset:40960
  v_cvt_pk_bf16_f32 v9, v10, v11
  v_mfma_f32_16x16x32_bf16 v[20:23], a[144:147], v[160:163], v[200:203]
  v_exp_f32 v16, v16
  v_mfma_f32_16x16x32_bf16 v[20:23], a[148:151], v[164:167], v[20:23]
  buffer_load_dwordx4 v237, s[16:19], s29 offen offset:3072 lds
  v_mfma_f32_16x16x32_bf16 v[20:23], a[152:155], v[168:171], v[20:23]
  s_add_u32 s29, s29, 16384
  v_exp_f32 v17, v17
  v_mfma_f32_16x16x32_bf16 v[20:23], a[156:159], v[172:175], v[20:23]
  v_cvt_pk_bf16_f32 v16, v16, v17
  v_lshl_add_u32 v209, v211, 5, v209
  v_mfma_f32_16x16x32_bf16 v[28:31], a[156:159], v[188:191], v[204:207]
  s_add_u32 m0, s28, 0
  v_exp_f32 v18, v18
  v_mfma_f32_16x16x32_bf16 v[28:31], a[152:155], v[184:187], v[28:31]
  buffer_load_dwordx4 v232, s[12:15], s29 offen offset:0 lds
  v_mfma_f32_16x16x32_bf16 v[28:31], a[148:151], v[180:183], v[28:31]
  s_waitcnt lgkmcnt(0)
  v_exp_f32 v19, v19
  v_mfma_f32_16x16x32_bf16 v[28:31], a[144:147], v[176:179], v[28:31]
  v_cvt_pk_bf16_f32 v17, v18, v19
  v_add_u32 v209, s50, v209
  v_mfma_f32_16x16x32_bf16 v[32:35], a[128:131], v[128:131], v[192:195]
  s_and_b32 s39, s2, 1
  s_lshl_b32 s39, s39, 2
  s_add_u32 s39, s39, s3
  v_exp_f32 v24, v24
  v_mfma_f32_16x16x32_bf16 v[32:35], a[132:135], v[132:135], v[32:35]
  ds_read_b128 a[144:147], v212 offset:45056
  s_lshr_b32 s31, s2, 1
  s_mul_i32 s30, s31, 40960
  s_mul_i32 s48, s39, 160
  v_mfma_f32_16x16x32_bf16 v[32:35], a[136:139], v[136:139], v[32:35]
  s_add_u32 s30, s30, s48
  s_mul_i32 s31, s31, 5120
  s_mul_i32 s39, s39, 655360
  v_exp_f32 v25, v25
  v_mfma_f32_16x16x32_bf16 v[32:35], a[140:143], v[140:143], v[32:35]
  ds_read_b128 a[148:151], v213 offset:45056
  s_add_u32 s31, s31, s39
  s_add_u32 s31, s31, 3145728
  s_lshr_b32 s39, s2, 3
  v_cvt_pk_bf16_f32 v24, v24, v25
  v_mfma_f32_16x16x32_bf16 v[40:43], a[140:143], v[156:159], v[196:199]
  s_min_u32 s39, s39, 29
  s_and_b32 s48, s2, 7
  s_mul_i32 s48, s48, 30
  v_exp_f32 v26, v26
  v_mfma_f32_16x16x32_bf16 v[40:43], a[136:139], v[152:155], v[40:43]
  ds_read_b128 a[152:155], v214 offset:45056
  s_add_u32 s39, s39, s48
  s_mul_i32 s98, s39, 1639
  s_lshr_b32 s98, s98, 16
  v_mfma_f32_16x16x32_bf16 v[40:43], a[132:135], v[148:151], v[40:43]
  s_mul_i32 s99, s98, 40
  s_sub_u32 s99, s39, s99
  s_min_u32 s39, s3, 2
  v_exp_f32 v27, v27
  v_mfma_f32_16x16x32_bf16 v[40:43], a[128:131], v[144:147], v[40:43]
  ds_read_b128 a[156:159], v215 offset:45056
  s_mul_i32 s48, s98, 3
  s_add_u32 s48, s48, s39
  s_mul_i32 s100, s48, 122880
  v_cvt_pk_bf16_f32 v25, v26, v27
  v_mfma_f32_16x16x32_bf16 v[48:51], a[128:131], v[160:163], v[200:203]
  s_lshl_b32 s39, s99, 5
  s_add_u32 s100, s100, s39
  s_mul_i32 s101, s48, 192
  v_exp_f32 v4, v4
  v_mfma_f32_16x16x32_bf16 v[48:51], a[132:135], v[164:167], v[48:51]
  buffer_load_dwordx4 v233, s[12:15], s29 offen offset:1024 lds
  s_add_u32 s101, s101, 2633728
  s_mov_b32 s51, s50
  v_mfma_f32_16x16x32_bf16 v[48:51], a[136:139], v[168:171], v[48:51]
  v_exp_f32 v5, v5
  v_mfma_f32_16x16x32_bf16 v[48:51], a[140:143], v[172:175], v[48:51]
  v_cvt_pk_bf16_f32 v2, v4, v5
  v_mov_b32 v211, v242
  v_mfma_f32_16x16x32_bf16 v[56:59], a[140:143], v[188:191], v[204:207]
  s_mov_b32 s4, s94
  s_mov_b32 s5, s95
  s_mov_b32 s6, 2211840
  v_exp_f32 v6, v6
  v_mfma_f32_16x16x32_bf16 v[56:59], a[136:139], v[184:187], v[56:59]
  buffer_load_dwordx4 v234, s[12:15], s29 offen offset:2048 lds
  s_mov_b32 s7, 0x20000
  s_getpc_b64 s[8:9]
attn_late_pc:
  s_add_u32 s8, s8, attn_h_ready-attn_late_pc
  s_addc_u32 s9, s9, 0
  v_mfma_f32_16x16x32_bf16 v[56:59], a[132:135], v[180:183], v[56:59]
  s_waitcnt lgkmcnt(0)
  s_lshr_b32 s39, s2, 3
  v_exp_f32 v7, v7
  v_mfma_f32_16x16x32_bf16 v[56:59], a[128:131], v[176:179], v[56:59]
  v_cvt_pk_bf16_f32 v3, v6, v7
  v_lshrrev_b32 v252, 4, v242
  v_mfma_f32_16x16x32_bf16 v[36:39], a[144:147], v[128:131], v[192:195]
  v_exp_f32 v12, v12
  v_mfma_f32_16x16x32_bf16 v[36:39], a[148:151], v[132:135], v[36:39]
  ds_read_b64_tr_b16 a[160:161], v216 offset:16384
  v_min_u32 v252, 11, v252
  v_mfma_f32_16x16x32_bf16 v[36:39], a[152:155], v[136:139], v[36:39]
  v_exp_f32 v13, v13
  v_mfma_f32_16x16x32_bf16 v[36:39], a[156:159], v[140:143], v[36:39]
  ds_read_b64_tr_b16 a[162:163], v216 offset:20480
  v_cvt_pk_bf16_f32 v10, v12, v13
  v_mfma_f32_16x16x32_bf16 v[44:47], a[156:159], v[156:159], v[196:199]
  v_exp_f32 v14, v14
  v_mfma_f32_16x16x32_bf16 v[44:47], a[152:155], v[152:155], v[44:47]
  ds_read_b64_tr_b16 a[164:165], v216 offset:24576
  buffer_load_dwordx4 v235, s[12:15], s29 offen offset:3072 lds
  v_mfma_f32_16x16x32_bf16 v[44:47], a[148:151], v[148:151], v[44:47]
  v_exp_f32 v15, v15
  v_mfma_f32_16x16x32_bf16 v[44:47], a[144:147], v[144:147], v[44:47]
  ds_read_b64_tr_b16 a[166:167], v216 offset:28672
  v_cvt_pk_bf16_f32 v11, v14, v15
  v_mfma_f32_16x16x32_bf16 v[52:55], a[144:147], v[160:163], v[200:203]
  v_exp_f32 v20, v20
  v_mfma_f32_16x16x32_bf16 v[52:55], a[148:151], v[164:167], v[52:55]
  ds_read_b64_tr_b16 a[168:169], v217 offset:16384
  v_lshlrev_b32 v252, 5, v252
  v_mfma_f32_16x16x32_bf16 v[52:55], a[152:155], v[168:171], v[52:55]
  v_exp_f32 v21, v21
  v_mfma_f32_16x16x32_bf16 v[52:55], a[156:159], v[172:175], v[52:55]
  ds_read_b64_tr_b16 a[170:171], v217 offset:20480
  v_cvt_pk_bf16_f32 v18, v20, v21
  v_mfma_f32_16x16x32_bf16 v[60:63], a[156:159], v[188:191], v[204:207]
  v_exp_f32 v22, v22
  v_mfma_f32_16x16x32_bf16 v[60:63], a[152:155], v[184:187], v[60:63]
  ds_read_b64_tr_b16 a[172:173], v217 offset:24576
  v_add_u32 v252, s39, v252
  v_mfma_f32_16x16x32_bf16 v[60:63], a[148:151], v[180:183], v[60:63]
  v_exp_f32 v23, v23
  v_mfma_f32_16x16x32_bf16 v[60:63], a[144:147], v[176:179], v[60:63]
  ds_read_b64_tr_b16 a[174:175], v217 offset:28672
  v_cvt_pk_bf16_f32 v19, v22, v23
  v_mfma_f32_16x16x32_bf16 a[192:195], a[208:211], v[64:67], a[192:195]
  v_exp_f32 v28, v28
  v_mfma_f32_16x16x32_bf16 a[192:195], a[208:211], v[96:99], a[192:195]
  ds_read_b64_tr_b16 a[176:177], v218 offset:16384
  v_lshlrev_b32 v252, 7, v252
  v_mfma_f32_16x16x32_bf16 a[196:199], a[208:211], v[72:75], a[196:199]
  v_exp_f32 v29, v29
  v_mfma_f32_16x16x32_bf16 a[196:199], a[208:211], v[104:107], a[196:199]
  ds_read_b64_tr_b16 a[178:179], v218 offset:20480
  v_cvt_pk_bf16_f32 v26, v28, v29
  v_mfma_f32_16x16x32_bf16 a[200:203], a[208:211], v[80:83], a[200:203]
  v_exp_f32 v30, v30
  v_mfma_f32_16x16x32_bf16 a[200:203], a[208:211], v[112:115], a[200:203]
  ds_read_b64_tr_b16 a[180:181], v218 offset:24576
  v_min_u32 v252, attn_end-attn_h_ready-4, v252
  v_mfma_f32_16x16x32_bf16 a[204:207], a[208:211], v[88:91], a[204:207]
  s_waitcnt lgkmcnt(7)
  v_exp_f32 v31, v31
  v_mfma_f32_16x16x32_bf16 a[204:207], a[208:211], v[120:123], a[204:207]
  ds_read_b64_tr_b16 a[182:183], v218 offset:28672
  v_cvt_pk_bf16_f32 v27, v30, v31
  v_mfma_f32_16x16x32_bf16 a[0:3], a[160:163], v[64:67], a[0:3]
  v_exp_f32 v32, v32
  v_mfma_f32_16x16x32_bf16 a[0:3], a[164:167], v[96:99], a[0:3]
  ds_read_b64_tr_b16 a[184:185], v219 offset:16384
  v_mfma_f32_16x16x32_bf16 a[4:7], a[164:167], v[104:107], a[4:7]
  v_exp_f32 v33, v33
  v_mfma_f32_16x16x32_bf16 a[4:7], a[160:163], v[72:75], a[4:7]
  ds_read_b64_tr_b16 a[186:187], v219 offset:20480
  v_cvt_pk_bf16_f32 v32, v32, v33
  v_mfma_f32_16x16x32_bf16 a[8:11], a[160:163], v[80:83], a[8:11]
  v_exp_f32 v34, v34
  v_mfma_f32_16x16x32_bf16 a[8:11], a[164:167], v[112:115], a[8:11]
  ds_read_b64_tr_b16 a[188:189], v219 offset:24576
  v_mfma_f32_16x16x32_bf16 a[12:15], a[164:167], v[120:123], a[12:15]
  s_waitcnt lgkmcnt(7)
  v_exp_f32 v35, v35
  v_mfma_f32_16x16x32_bf16 a[12:15], a[160:163], v[88:91], a[12:15]
  ds_read_b64_tr_b16 a[190:191], v219 offset:28672
  v_cvt_pk_bf16_f32 v33, v34, v35
  v_mfma_f32_16x16x32_bf16 a[16:19], a[168:171], v[64:67], a[16:19]
  v_exp_f32 v40, v40
  v_mfma_f32_16x16x32_bf16 a[16:19], a[172:175], v[96:99], a[16:19]
  ds_read_b64_tr_b16 a[160:161], v220 offset:16384
  v_mfma_f32_16x16x32_bf16 a[20:23], a[172:175], v[104:107], a[20:23]
  v_exp_f32 v41, v41
  v_mfma_f32_16x16x32_bf16 a[20:23], a[168:171], v[72:75], a[20:23]
  ds_read_b64_tr_b16 a[162:163], v220 offset:20480
  v_cvt_pk_bf16_f32 v40, v40, v41
  v_mfma_f32_16x16x32_bf16 a[24:27], a[168:171], v[80:83], a[24:27]
  v_exp_f32 v42, v42
  v_mfma_f32_16x16x32_bf16 a[24:27], a[172:175], v[112:115], a[24:27]
  ds_read_b64_tr_b16 a[164:165], v220 offset:24576
  v_mfma_f32_16x16x32_bf16 a[28:31], a[172:175], v[120:123], a[28:31]
  s_waitcnt lgkmcnt(7)
  v_exp_f32 v43, v43
  v_mfma_f32_16x16x32_bf16 a[28:31], a[168:171], v[88:91], a[28:31]
  ds_read_b64_tr_b16 a[166:167], v220 offset:28672
  v_cvt_pk_bf16_f32 v41, v42, v43
  v_mfma_f32_16x16x32_bf16 a[32:35], a[176:179], v[64:67], a[32:35]
  v_exp_f32 v48, v48
  v_mfma_f32_16x16x32_bf16 a[32:35], a[180:183], v[96:99], a[32:35]
  ds_read_b64_tr_b16 a[168:169], v221 offset:16384
  v_mfma_f32_16x16x32_bf16 a[36:39], a[180:183], v[104:107], a[36:39]
  v_exp_f32 v49, v49
  v_mfma_f32_16x16x32_bf16 a[36:39], a[176:179], v[72:75], a[36:39]
  ds_read_b64_tr_b16 a[170:171], v221 offset:20480
  v_cvt_pk_bf16_f32 v48, v48, v49
  v_mfma_f32_16x16x32_bf16 a[40:43], a[176:179], v[80:83], a[40:43]
  v_exp_f32 v50, v50
  v_mfma_f32_16x16x32_bf16 a[40:43], a[180:183], v[112:115], a[40:43]
  ds_read_b64_tr_b16 a[172:173], v221 offset:24576
  v_mfma_f32_16x16x32_bf16 a[44:47], a[180:183], v[120:123], a[44:47]
  s_waitcnt lgkmcnt(7)
  v_exp_f32 v51, v51
  v_mfma_f32_16x16x32_bf16 a[44:47], a[176:179], v[88:91], a[44:47]
  ds_read_b64_tr_b16 a[174:175], v221 offset:28672
  v_cvt_pk_bf16_f32 v49, v50, v51
  v_mfma_f32_16x16x32_bf16 a[48:51], a[184:187], v[64:67], a[48:51]
  v_exp_f32 v56, v56
  v_mfma_f32_16x16x32_bf16 a[48:51], a[188:191], v[96:99], a[48:51]
  ds_read_b64_tr_b16 a[176:177], v222 offset:16384
  v_mfma_f32_16x16x32_bf16 a[52:55], a[188:191], v[104:107], a[52:55]
  v_exp_f32 v57, v57
  v_mfma_f32_16x16x32_bf16 a[52:55], a[184:187], v[72:75], a[52:55]
  ds_read_b64_tr_b16 a[178:179], v222 offset:20480
  v_cvt_pk_bf16_f32 v56, v56, v57
  v_mfma_f32_16x16x32_bf16 a[56:59], a[184:187], v[80:83], a[56:59]
  v_exp_f32 v58, v58
  v_mfma_f32_16x16x32_bf16 a[56:59], a[188:191], v[112:115], a[56:59]
  ds_read_b64_tr_b16 a[180:181], v222 offset:24576
  v_mfma_f32_16x16x32_bf16 a[60:63], a[188:191], v[120:123], a[60:63]
  s_waitcnt lgkmcnt(7)
  v_exp_f32 v59, v59
  v_mfma_f32_16x16x32_bf16 a[60:63], a[184:187], v[88:91], a[60:63]
  ds_read_b64_tr_b16 a[182:183], v222 offset:28672
  v_cvt_pk_bf16_f32 v57, v58, v59
  v_mfma_f32_16x16x32_bf16 a[64:67], a[160:163], v[64:67], a[64:67]
  v_exp_f32 v36, v36
  v_mfma_f32_16x16x32_bf16 a[64:67], a[164:167], v[96:99], a[64:67]
  ds_read_b64_tr_b16 a[184:185], v223 offset:16384
  v_mfma_f32_16x16x32_bf16 a[68:71], a[164:167], v[104:107], a[68:71]
  v_exp_f32 v37, v37
  v_mfma_f32_16x16x32_bf16 a[68:71], a[160:163], v[72:75], a[68:71]
  ds_read_b64_tr_b16 a[186:187], v223 offset:20480
  v_cvt_pk_bf16_f32 v34, v36, v37
  v_mfma_f32_16x16x32_bf16 a[72:75], a[160:163], v[80:83], a[72:75]
  v_exp_f32 v38, v38
  v_mfma_f32_16x16x32_bf16 a[72:75], a[164:167], v[112:115], a[72:75]
  ds_read_b64_tr_b16 a[188:189], v223 offset:24576
  v_mfma_f32_16x16x32_bf16 a[76:79], a[164:167], v[120:123], a[76:79]
  s_waitcnt lgkmcnt(7)
  v_exp_f32 v39, v39
  v_mfma_f32_16x16x32_bf16 a[76:79], a[160:163], v[88:91], a[76:79]
  ds_read_b64_tr_b16 a[190:191], v223 offset:28672
  v_cvt_pk_bf16_f32 v35, v38, v39
  v_mfma_f32_16x16x32_bf16 a[80:83], a[168:171], v[64:67], a[80:83]
  s_waitcnt vmcnt(10)
  v_exp_f32 v44, v44
  v_mfma_f32_16x16x32_bf16 a[80:83], a[172:175], v[96:99], a[80:83]
  v_mfma_f32_16x16x32_bf16 a[84:87], a[172:175], v[104:107], a[84:87]
  s_barrier
  v_exp_f32 v45, v45
  v_mfma_f32_16x16x32_bf16 a[84:87], a[168:171], v[72:75], a[84:87]
  ds_read_b128 a[128:131], v212 offset:49152
  v_cvt_pk_bf16_f32 v42, v44, v45
  v_mfma_f32_16x16x32_bf16 a[88:91], a[168:171], v[80:83], a[88:91]
  v_exp_f32 v46, v46
  v_mfma_f32_16x16x32_bf16 a[88:91], a[172:175], v[112:115], a[88:91]
  ds_read_b128 a[132:135], v213 offset:49152
  v_mfma_f32_16x16x32_bf16 a[92:95], a[172:175], v[120:123], a[92:95]
  s_waitcnt lgkmcnt(6)
  v_exp_f32 v47, v47
  v_mfma_f32_16x16x32_bf16 a[92:95], a[168:171], v[88:91], a[92:95]
  ds_read_b128 a[136:139], v214 offset:49152
  v_cvt_pk_bf16_f32 v43, v46, v47
  v_mfma_f32_16x16x32_bf16 a[96:99], a[176:179], v[64:67], a[96:99]
  v_exp_f32 v52, v52
  v_mfma_f32_16x16x32_bf16 a[96:99], a[180:183], v[96:99], a[96:99]
  ds_read_b128 a[140:143], v215 offset:49152
  v_mfma_f32_16x16x32_bf16 a[100:103], a[180:183], v[104:107], a[100:103]
  v_exp_f32 v53, v53
  v_mfma_f32_16x16x32_bf16 a[100:103], a[176:179], v[72:75], a[100:103]
  v_cvt_pk_bf16_f32 v50, v52, v53
  v_mfma_f32_16x16x32_bf16 a[104:107], a[176:179], v[80:83], a[104:107]
  v_exp_f32 v54, v54
  v_mfma_f32_16x16x32_bf16 a[104:107], a[180:183], v[112:115], a[104:107]
  v_mfma_f32_16x16x32_bf16 a[108:111], a[180:183], v[120:123], a[108:111]
  s_waitcnt lgkmcnt(4)
  v_exp_f32 v55, v55
  v_mfma_f32_16x16x32_bf16 a[108:111], a[176:179], v[88:91], a[108:111]
  v_cvt_pk_bf16_f32 v51, v54, v55
  v_mfma_f32_16x16x32_bf16 a[112:115], a[184:187], v[64:67], a[112:115]
  v_exp_f32 v60, v60
  v_mfma_f32_16x16x32_bf16 a[112:115], a[188:191], v[96:99], a[112:115]
  v_mfma_f32_16x16x32_bf16 a[116:119], a[188:191], v[104:107], a[116:119]
  v_exp_f32 v61, v61
  v_mfma_f32_16x16x32_bf16 a[116:119], a[184:187], v[72:75], a[116:119]
  v_cvt_pk_bf16_f32 v58, v60, v61
  v_mfma_f32_16x16x32_bf16 a[120:123], a[184:187], v[80:83], a[120:123]
  v_exp_f32 v62, v62
  v_mfma_f32_16x16x32_bf16 a[120:123], a[188:191], v[112:115], a[120:123]
  v_mfma_f32_16x16x32_bf16 a[124:127], a[188:191], v[120:123], a[124:127]
  s_waitcnt lgkmcnt(0)
  v_exp_f32 v63, v63
  v_mfma_f32_16x16x32_bf16 a[124:127], a[184:187], v[88:91], a[124:127]
  v_cvt_pk_bf16_f32 v59, v62, v63
  v_mfma_f32_16x16x32_bf16 v[64:67], a[128:131], v[128:131], v[192:195]
  s_add_u32 m0, s28, 65536
  v_lshrrev_b32 v224, 4, v242
  v_lshrrev_b32 v225, 4, v224
  v_mfma_f32_16x16x32_bf16 v[64:67], a[132:135], v[132:135], v[64:67]
  ds_read_b128 a[144:147], v212 offset:53248
  v_bfe_u32 v226, v224, 2, 2
  v_mfma_f32_16x16x32_bf16 v[64:67], a[136:139], v[136:139], v[64:67]
  buffer_load_dwordx4 v236, s[16:19], s29 offen offset:0 lds
  v_mfma_f32_16x16x32_bf16 v[64:67], a[140:143], v[140:143], v[64:67]
  ds_read_b128 a[148:151], v213 offset:53248
  v_lshl_add_u32 v225, v225, 3, v226
  v_mfma_f32_16x16x32_bf16 v[72:75], a[140:143], v[156:159], v[196:199]
  v_lshlrev_b32 v225, 4, v225
  v_bfe_u32 v226, v224, 1, 1
  v_mfma_f32_16x16x32_bf16 v[72:75], a[136:139], v[152:155], v[72:75]
  ds_read_b128 a[152:155], v214 offset:53248
  v_mul_u32_u24 v226, 0xc00, v226
  v_mfma_f32_16x16x32_bf16 v[72:75], a[132:135], v[148:151], v[72:75]
  buffer_load_dwordx4 v237, s[16:19], s29 offen offset:1024 lds
  v_mfma_f32_16x16x32_bf16 v[72:75], a[128:131], v[144:147], v[72:75]
  ds_read_b128 a[156:159], v215 offset:53248
  v_add3_u32 v225, v225, v226, s50
  v_mfma_f32_16x16x32_bf16 v[80:83], a[128:131], v[160:163], v[200:203]
  v_exp_f32 v64, v64
  v_mfma_f32_16x16x32_bf16 v[80:83], a[132:135], v[164:167], v[80:83]
  v_and_b32 v226, 1, v224
  v_lshl_add_u32 v225, v226, 3, v225
  v_mfma_f32_16x16x32_bf16 v[80:83], a[136:139], v[168:171], v[80:83]
  s_waitcnt vmcnt(10)
  v_exp_f32 v65, v65
  v_mfma_f32_16x16x32_bf16 v[80:83], a[140:143], v[172:175], v[80:83]
  ds_read_b64_tr_b16 a[232:233], v225 offset:0
  v_cvt_pk_bf16_f32 v64, v64, v65
  v_mfma_f32_16x16x32_bf16 v[88:91], a[140:143], v[188:191], v[204:207]
  v_exp_f32 v66, v66
  v_mfma_f32_16x16x32_bf16 v[88:91], a[136:139], v[184:187], v[88:91]
  buffer_load_dwordx4 v236, s[16:19], s29 offen offset:2048 lds
  v_mfma_f32_16x16x32_bf16 v[88:91], a[132:135], v[180:183], v[88:91]
  s_waitcnt lgkmcnt(1)
  v_exp_f32 v67, v67
  v_mfma_f32_16x16x32_bf16 v[88:91], a[128:131], v[176:179], v[88:91]
  ds_read_b64_tr_b16 a[234:235], v225 offset:64
  v_cvt_pk_bf16_f32 v65, v66, v67
  v_mfma_f32_16x16x32_bf16 v[68:71], a[144:147], v[128:131], v[192:195]
  v_exp_f32 v72, v72
  v_mfma_f32_16x16x32_bf16 v[68:71], a[148:151], v[132:135], v[68:71]
  ds_read_b128 a[128:131], v212 offset:57344
  ds_read_b64_tr_b16 a[236:237], v225 offset:512
  v_mfma_f32_16x16x32_bf16 v[68:71], a[152:155], v[136:139], v[68:71]
  v_exp_f32 v73, v73
  v_mfma_f32_16x16x32_bf16 v[68:71], a[156:159], v[140:143], v[68:71]
  ds_read_b128 a[132:135], v213 offset:57344
  v_cvt_pk_bf16_f32 v72, v72, v73
  v_mfma_f32_16x16x32_bf16 v[76:79], a[156:159], v[156:159], v[196:199]
  v_exp_f32 v74, v74
  v_mfma_f32_16x16x32_bf16 v[76:79], a[152:155], v[152:155], v[76:79]
  ds_read_b128 a[136:139], v214 offset:57344
  ds_read_b64_tr_b16 a[238:239], v225 offset:576
  v_mfma_f32_16x16x32_bf16 v[76:79], a[148:151], v[148:151], v[76:79]
  v_exp_f32 v75, v75
  v_mfma_f32_16x16x32_bf16 v[76:79], a[144:147], v[144:147], v[76:79]
  ds_read_b128 a[140:143], v215 offset:57344
  v_cvt_pk_bf16_f32 v73, v74, v75
  v_mfma_f32_16x16x32_bf16 v[84:87], a[144:147], v[160:163], v[200:203]
  v_exp_f32 v80, v80
  v_mfma_f32_16x16x32_bf16 v[84:87], a[148:151], v[164:167], v[84:87]
  buffer_load_dwordx4 v237, s[16:19], s29 offen offset:3072 lds
  v_mfma_f32_16x16x32_bf16 v[84:87], a[152:155], v[168:171], v[84:87]
  s_add_u32 s29, s29, 16384
  v_exp_f32 v81, v81
  v_mfma_f32_16x16x32_bf16 v[84:87], a[156:159], v[172:175], v[84:87]
  ds_read_b64_tr_b16 a[240:241], v225 offset:1024
  v_cvt_pk_bf16_f32 v80, v80, v81
  v_mfma_f32_16x16x32_bf16 v[92:95], a[156:159], v[188:191], v[204:207]
  s_add_u32 m0, s28, 16384
  v_exp_f32 v82, v82
  v_mfma_f32_16x16x32_bf16 v[92:95], a[152:155], v[184:187], v[92:95]
  buffer_load_dwordx4 v232, s[12:15], s29 offen offset:0 lds
  v_mfma_f32_16x16x32_bf16 v[92:95], a[148:151], v[180:183], v[92:95]
  s_waitcnt lgkmcnt(1)
  v_exp_f32 v83, v83
  v_mfma_f32_16x16x32_bf16 v[92:95], a[144:147], v[176:179], v[92:95]
  ds_read_b64_tr_b16 a[242:243], v225 offset:1088
  v_cvt_pk_bf16_f32 v81, v82, v83
  v_mfma_f32_16x16x32_bf16 v[96:99], a[128:131], v[128:131], v[192:195]
  v_exp_f32 v88, v88
  v_mfma_f32_16x16x32_bf16 v[96:99], a[132:135], v[132:135], v[96:99]
  ds_read_b128 a[144:147], v212 offset:61440
  ds_read_b64_tr_b16 a[244:245], v225 offset:1536
  v_mfma_f32_16x16x32_bf16 v[96:99], a[136:139], v[136:139], v[96:99]
  v_exp_f32 v89, v89
  v_mfma_f32_16x16x32_bf16 v[96:99], a[140:143], v[140:143], v[96:99]
  ds_read_b128 a[148:151], v213 offset:61440
  v_cvt_pk_bf16_f32 v88, v88, v89
  v_mfma_f32_16x16x32_bf16 v[104:107], a[140:143], v[156:159], v[196:199]
  v_exp_f32 v90, v90
  v_mfma_f32_16x16x32_bf16 v[104:107], a[136:139], v[152:155], v[104:107]
  ds_read_b128 a[152:155], v214 offset:61440
  ds_read_b64_tr_b16 a[246:247], v225 offset:1600
  v_mfma_f32_16x16x32_bf16 v[104:107], a[132:135], v[148:151], v[104:107]
  v_exp_f32 v91, v91
  v_mfma_f32_16x16x32_bf16 v[104:107], a[128:131], v[144:147], v[104:107]
  ds_read_b128 a[156:159], v215 offset:61440
  v_cvt_pk_bf16_f32 v89, v90, v91
  v_mfma_f32_16x16x32_bf16 v[112:115], a[128:131], v[160:163], v[200:203]
  v_exp_f32 v68, v68
  v_mfma_f32_16x16x32_bf16 v[112:115], a[132:135], v[164:167], v[112:115]
  buffer_load_dwordx4 v233, s[12:15], s29 offen offset:1024 lds
  v_mfma_f32_16x16x32_bf16 v[112:115], a[136:139], v[168:171], v[112:115]
  v_exp_f32 v69, v69
  v_mfma_f32_16x16x32_bf16 v[112:115], a[140:143], v[172:175], v[112:115]
  ds_read_b64_tr_b16 a[248:249], v225 offset:2048
  v_cvt_pk_bf16_f32 v66, v68, v69
  v_mfma_f32_16x16x32_bf16 v[120:123], a[140:143], v[188:191], v[204:207]
  v_exp_f32 v70, v70
  v_mfma_f32_16x16x32_bf16 v[120:123], a[136:139], v[184:187], v[120:123]
  buffer_load_dwordx4 v234, s[12:15], s29 offen offset:2048 lds
  v_mfma_f32_16x16x32_bf16 v[120:123], a[132:135], v[180:183], v[120:123]
  s_waitcnt lgkmcnt(1)
  v_exp_f32 v71, v71
  v_mfma_f32_16x16x32_bf16 v[120:123], a[128:131], v[176:179], v[120:123]
  ds_read_b64_tr_b16 a[250:251], v225 offset:2112
  v_cvt_pk_bf16_f32 v67, v70, v71
  v_mfma_f32_16x16x32_bf16 v[100:103], a[144:147], v[128:131], v[192:195]
  v_exp_f32 v76, v76
  v_mfma_f32_16x16x32_bf16 v[100:103], a[148:151], v[132:135], v[100:103]
  ds_read_b64_tr_b16 a[160:161], v216 offset:32768
  v_mfma_f32_16x16x32_bf16 v[100:103], a[152:155], v[136:139], v[100:103]
  v_exp_f32 v77, v77
  v_mfma_f32_16x16x32_bf16 v[100:103], a[156:159], v[140:143], v[100:103]
  ds_read_b64_tr_b16 a[162:163], v216 offset:36864
  v_cvt_pk_bf16_f32 v74, v76, v77
  v_mfma_f32_16x16x32_bf16 v[108:111], a[156:159], v[156:159], v[196:199]
  v_exp_f32 v78, v78
  v_mfma_f32_16x16x32_bf16 v[108:111], a[152:155], v[152:155], v[108:111]
  ds_read_b64_tr_b16 a[164:165], v216 offset:40960
  buffer_load_dwordx4 v235, s[12:15], s29 offen offset:3072 lds
  v_mfma_f32_16x16x32_bf16 v[108:111], a[148:151], v[148:151], v[108:111]
  v_exp_f32 v79, v79
  v_mfma_f32_16x16x32_bf16 v[108:111], a[144:147], v[144:147], v[108:111]
  ds_read_b64_tr_b16 a[166:167], v216 offset:45056
  s_waitcnt lgkmcnt(4)
  v_cvt_pk_bf16_f32 v75, v78, v79
  v_mfma_f32_16x16x32_bf16 v[116:119], a[144:147], v[160:163], v[200:203]
  v_exp_f32 v84, v84
  v_mfma_f32_16x16x32_bf16 v[116:119], a[148:151], v[164:167], v[116:119]
  ds_read_b64_tr_b16 a[168:169], v217 offset:32768
  v_mfma_f32_16x16x32_bf16 v[228:231], a[232:235], a[212:215], 0
  v_mfma_f32_16x16x32_bf16 v[228:231], a[236:239], a[216:219], v[228:231]
  v_mfma_f32_16x16x32_bf16 v[228:231], a[240:243], a[220:223], v[228:231]
  v_mfma_f32_16x16x32_bf16 v[228:231], a[244:247], a[224:227], v[228:231]
  v_mfma_f32_16x16x32_bf16 v[228:231], a[248:251], a[228:231], v[228:231]
  v_mfma_f32_16x16x32_bf16 v[116:119], a[152:155], v[168:171], v[116:119]
  s_lshl_b32 s35, s3, 10
  s_add_u32 s35, s35, 159744
  v_exp_f32 v85, v85
  v_mfma_f32_16x16x32_bf16 v[116:119], a[156:159], v[172:175], v[116:119]
  ds_read_b64_tr_b16 a[170:171], v217 offset:36864
  v_cvt_pk_bf16_f32 v82, v84, v85
  v_mfma_f32_16x16x32_bf16 v[124:127], a[156:159], v[188:191], v[204:207]
  v_exp_f32 v86, v86
  v_mfma_f32_16x16x32_bf16 v[124:127], a[152:155], v[184:187], v[124:127]
  ds_read_b64_tr_b16 a[172:173], v217 offset:40960
  v_add_u32 v224, s35, v242
  v_mfma_f32_16x16x32_bf16 v[124:127], a[148:151], v[180:183], v[124:127]
  v_exp_f32 v87, v87
  v_mfma_f32_16x16x32_bf16 v[124:127], a[144:147], v[176:179], v[124:127]
  ds_read_b64_tr_b16 a[174:175], v217 offset:45056
  v_cvt_pk_bf16_f32 v83, v86, v87
  v_mfma_f32_16x16x32_bf16 a[192:195], a[208:211], v[0:3], a[192:195]
  v_exp_f32 v92, v92
  v_mfma_f32_16x16x32_bf16 a[192:195], a[208:211], v[32:35], a[192:195]
  ds_read_b64_tr_b16 a[176:177], v218 offset:32768
  ds_write_b128 v224, v[228:231]
  v_mfma_f32_16x16x32_bf16 a[196:199], a[208:211], v[8:11], a[196:199]
  v_exp_f32 v93, v93
  v_mfma_f32_16x16x32_bf16 a[196:199], a[208:211], v[40:43], a[196:199]
  ds_read_b64_tr_b16 a[178:179], v218 offset:36864
  v_cvt_pk_bf16_f32 v90, v92, v93
  v_mfma_f32_16x16x32_bf16 a[200:203], a[208:211], v[16:19], a[200:203]
  v_exp_f32 v94, v94
  v_mfma_f32_16x16x32_bf16 a[200:203], a[208:211], v[48:51], a[200:203]
  ds_read_b64_tr_b16 a[180:181], v218 offset:40960
  v_mfma_f32_16x16x32_bf16 a[204:207], a[208:211], v[24:27], a[204:207]
  s_waitcnt lgkmcnt(8)
  v_exp_f32 v95, v95
  v_mfma_f32_16x16x32_bf16 a[204:207], a[208:211], v[56:59], a[204:207]
  ds_read_b64_tr_b16 a[182:183], v218 offset:45056
  v_cvt_pk_bf16_f32 v91, v94, v95
  v_mfma_f32_16x16x32_bf16 a[0:3], a[160:163], v[0:3], a[0:3]
  v_exp_f32 v96, v96
  v_mfma_f32_16x16x32_bf16 a[0:3], a[164:167], v[32:35], a[0:3]
  ds_read_b64_tr_b16 a[184:185], v219 offset:32768
  s_waitcnt lgkmcnt(4)
  s_mov_b32 m0, s51
  v_mfma_f32_16x16x32_bf16 a[4:7], a[164:167], v[40:43], a[4:7]
  v_exp_f32 v97, v97
  v_mfma_f32_16x16x32_bf16 a[4:7], a[160:163], v[8:11], a[4:7]
  ds_read_b64_tr_b16 a[186:187], v219 offset:36864
  v_cvt_pk_bf16_f32 v96, v96, v97
  v_mfma_f32_16x16x32_bf16 a[8:11], a[160:163], v[16:19], a[8:11]
  v_exp_f32 v98, v98
  v_mfma_f32_16x16x32_bf16 a[8:11], a[164:167], v[48:51], a[8:11]
  ds_read_b64_tr_b16 a[188:189], v219 offset:40960
  buffer_load_dwordx4 v210, s[4:7], s100 offen lds
  s_add_u32 s100, s100, 20480
  s_add_u32 s51, s51, 512
  v_mfma_f32_16x16x32_bf16 a[12:15], a[164:167], v[56:59], a[12:15]
  v_exp_f32 v99, v99
  v_mfma_f32_16x16x32_bf16 a[12:15], a[160:163], v[24:27], a[12:15]
  ds_read_b64_tr_b16 a[190:191], v219 offset:45056
  v_cvt_pk_bf16_f32 v97, v98, v99
  v_mfma_f32_16x16x32_bf16 a[16:19], a[168:171], v[0:3], a[16:19]
  v_exp_f32 v104, v104
  v_mfma_f32_16x16x32_bf16 a[16:19], a[172:175], v[32:35], a[16:19]
  ds_read_b64_tr_b16 a[160:161], v220 offset:32768
  v_lshrrev_b32 v224, 4, v242
  v_mfma_f32_16x16x32_bf16 a[20:23], a[172:175], v[40:43], a[20:23]
  v_exp_f32 v105, v105
  v_mfma_f32_16x16x32_bf16 a[20:23], a[168:171], v[8:11], a[20:23]
  ds_read_b64_tr_b16 a[162:163], v220 offset:36864
  v_cvt_pk_bf16_f32 v104, v104, v105
  v_mfma_f32_16x16x32_bf16 a[24:27], a[168:171], v[16:19], a[24:27]
  v_exp_f32 v106, v106
  v_mfma_f32_16x16x32_bf16 a[24:27], a[172:175], v[48:51], a[24:27]
  ds_read_b64_tr_b16 a[164:165], v220 offset:40960
  v_bfe_u32 v225, v224, 2, 1
  v_mfma_f32_16x16x32_bf16 a[28:31], a[172:175], v[56:59], a[28:31]
  s_waitcnt lgkmcnt(7)
  v_exp_f32 v107, v107
  v_mfma_f32_16x16x32_bf16 a[28:31], a[168:171], v[24:27], a[28:31]
  ds_read_b64_tr_b16 a[166:167], v220 offset:45056
  v_cvt_pk_bf16_f32 v105, v106, v107
  v_mfma_f32_16x16x32_bf16 a[32:35], a[176:179], v[0:3], a[32:35]
  v_exp_f32 v112, v112
  v_mfma_f32_16x16x32_bf16 a[32:35], a[180:183], v[32:35], a[32:35]
  ds_read_b64_tr_b16 a[168:169], v221 offset:32768
  v_lshlrev_b32 v225, 8, v225
  v_mfma_f32_16x16x32_bf16 a[36:39], a[180:183], v[40:43], a[36:39]
  v_exp_f32 v113, v113
  v_mfma_f32_16x16x32_bf16 a[36:39], a[176:179], v[8:11], a[36:39]
  ds_read_b64_tr_b16 a[170:171], v221 offset:36864
  v_cvt_pk_bf16_f32 v112, v112, v113
  v_mfma_f32_16x16x32_bf16 a[40:43], a[176:179], v[16:19], a[40:43]
  v_exp_f32 v114, v114
  v_mfma_f32_16x16x32_bf16 a[40:43], a[180:183], v[48:51], a[40:43]
  ds_read_b64_tr_b16 a[172:173], v221 offset:40960
  v_lshrrev_b32 v226, 3, v224
  v_mfma_f32_16x16x32_bf16 a[44:47], a[180:183], v[56:59], a[44:47]
  s_waitcnt lgkmcnt(7)
  v_exp_f32 v115, v115
  v_mfma_f32_16x16x32_bf16 a[44:47], a[176:179], v[24:27], a[44:47]
  ds_read_b64_tr_b16 a[174:175], v221 offset:45056
  v_cvt_pk_bf16_f32 v113, v114, v115
  v_mfma_f32_16x16x32_bf16 a[48:51], a[184:187], v[0:3], a[48:51]
  v_exp_f32 v120, v120
  v_mfma_f32_16x16x32_bf16 a[48:51], a[188:191], v[32:35], a[48:51]
  ds_read_b64_tr_b16 a[176:177], v222 offset:32768
  v_lshl_add_u32 v225, v226, 4, v225
  v_mfma_f32_16x16x32_bf16 a[52:55], a[188:191], v[40:43], a[52:55]
  v_exp_f32 v121, v121
  v_mfma_f32_16x16x32_bf16 a[52:55], a[184:187], v[8:11], a[52:55]
  ds_read_b64_tr_b16 a[178:179], v222 offset:36864
  v_cvt_pk_bf16_f32 v120, v120, v121
  v_mfma_f32_16x16x32_bf16 a[56:59], a[184:187], v[16:19], a[56:59]
  v_exp_f32 v122, v122
  v_mfma_f32_16x16x32_bf16 a[56:59], a[188:191], v[48:51], a[56:59]
  ds_read_b64_tr_b16 a[180:181], v222 offset:40960
  v_and_b32 v227, 3, v224
  v_mfma_f32_16x16x32_bf16 a[60:63], a[188:191], v[56:59], a[60:63]
  s_waitcnt lgkmcnt(7)
  v_exp_f32 v123, v123
  v_mfma_f32_16x16x32_bf16 a[60:63], a[184:187], v[24:27], a[60:63]
  ds_read_b64_tr_b16 a[182:183], v222 offset:45056
  v_cvt_pk_bf16_f32 v121, v122, v123
  v_mfma_f32_16x16x32_bf16 a[64:67], a[160:163], v[0:3], a[64:67]
  v_exp_f32 v100, v100
  v_mfma_f32_16x16x32_bf16 a[64:67], a[164:167], v[32:35], a[64:67]
  ds_read_b64_tr_b16 a[184:185], v223 offset:32768
  v_lshl_add_u32 v225, v227, 2, v225
  v_mfma_f32_16x16x32_bf16 a[68:71], a[164:167], v[40:43], a[68:71]
  v_exp_f32 v101, v101
  v_mfma_f32_16x16x32_bf16 a[68:71], a[160:163], v[8:11], a[68:71]
  ds_read_b64_tr_b16 a[186:187], v223 offset:36864
  v_cvt_pk_bf16_f32 v98, v100, v101
  v_mfma_f32_16x16x32_bf16 a[72:75], a[160:163], v[16:19], a[72:75]
  v_exp_f32 v102, v102
  v_mfma_f32_16x16x32_bf16 a[72:75], a[164:167], v[48:51], a[72:75]
  ds_read_b64_tr_b16 a[188:189], v223 offset:40960
  v_add_u32 v225, 159744, v225
  v_mfma_f32_16x16x32_bf16 a[76:79], a[164:167], v[56:59], a[76:79]
  s_waitcnt lgkmcnt(7)
  v_exp_f32 v103, v103
  v_mfma_f32_16x16x32_bf16 a[76:79], a[160:163], v[24:27], a[76:79]
  ds_read_b64_tr_b16 a[190:191], v223 offset:45056
  v_cvt_pk_bf16_f32 v99, v102, v103
  v_mfma_f32_16x16x32_bf16 a[80:83], a[168:171], v[0:3], a[80:83]
  s_waitcnt vmcnt(9)
  v_exp_f32 v108, v108
  v_mfma_f32_16x16x32_bf16 a[80:83], a[172:175], v[32:35], a[80:83]
  v_mfma_f32_16x16x32_bf16 a[84:87], a[172:175], v[40:43], a[84:87]
  s_barrier
  v_exp_f32 v109, v109
  v_mfma_f32_16x16x32_bf16 a[84:87], a[168:171], v[8:11], a[84:87]
  ds_read_b128 a[128:131], v212 offset:0
  v_cvt_pk_bf16_f32 v106, v108, v109
  v_mfma_f32_16x16x32_bf16 a[88:91], a[168:171], v[16:19], a[88:91]
  v_exp_f32 v110, v110
  v_mfma_f32_16x16x32_bf16 a[88:91], a[172:175], v[48:51], a[88:91]
  ds_read_b128 a[132:135], v213 offset:0
  ds_read_b32 v228, v225 offset:0
  v_mfma_f32_16x16x32_bf16 a[92:95], a[172:175], v[56:59], a[92:95]
  s_waitcnt lgkmcnt(7)
  v_exp_f32 v111, v111
  v_mfma_f32_16x16x32_bf16 a[92:95], a[168:171], v[24:27], a[92:95]
  ds_read_b128 a[136:139], v214 offset:0
  v_cvt_pk_bf16_f32 v107, v110, v111
  v_mfma_f32_16x16x32_bf16 a[96:99], a[176:179], v[0:3], a[96:99]
  v_exp_f32 v116, v116
  v_mfma_f32_16x16x32_bf16 a[96:99], a[180:183], v[32:35], a[96:99]
  ds_read_b128 a[140:143], v215 offset:0
  ds_read_b32 v229, v225 offset:1024
  v_mfma_f32_16x16x32_bf16 a[100:103], a[180:183], v[40:43], a[100:103]
  v_exp_f32 v117, v117
  v_mfma_f32_16x16x32_bf16 a[100:103], a[176:179], v[8:11], a[100:103]
  ds_read_b32 v230, v225 offset:2048
  v_cvt_pk_bf16_f32 v114, v116, v117
  v_mfma_f32_16x16x32_bf16 a[104:107], a[176:179], v[16:19], a[104:107]
  v_exp_f32 v118, v118
  v_mfma_f32_16x16x32_bf16 a[104:107], a[180:183], v[48:51], a[104:107]
  ds_read_b32 v231, v225 offset:3072
  ds_read_b32 v238, v225 offset:512
  v_mfma_f32_16x16x32_bf16 a[108:111], a[180:183], v[56:59], a[108:111]
  s_waitcnt lgkmcnt(9)
  v_exp_f32 v119, v119
  v_mfma_f32_16x16x32_bf16 a[108:111], a[176:179], v[24:27], a[108:111]
  ds_read_b32 v239, v225 offset:1536
  v_cvt_pk_bf16_f32 v115, v118, v119
  v_mfma_f32_16x16x32_bf16 a[112:115], a[184:187], v[0:3], a[112:115]
  v_exp_f32 v124, v124
  v_mfma_f32_16x16x32_bf16 a[112:115], a[188:191], v[32:35], a[112:115]
  ds_read_b32 v240, v225 offset:2560
  ds_read_b32 v241, v225 offset:3584
  s_cmp_eq_u32 s3, 0
  s_cselect_b32 s35, 0, 1073741824
  v_mfma_f32_16x16x32_bf16 a[116:119], a[188:191], v[40:43], a[116:119]
  v_exp_f32 v125, v125
  v_mfma_f32_16x16x32_bf16 a[116:119], a[184:187], v[8:11], a[116:119]
  v_cvt_pk_bf16_f32 v122, v124, v125
  v_mul_u32_u24 v226, 0xd80, v226
  v_mfma_f32_16x16x32_bf16 a[120:123], a[184:187], v[16:19], a[120:123]
  v_exp_f32 v126, v126
  v_mfma_f32_16x16x32_bf16 a[120:123], a[188:191], v[48:51], a[120:123]
  v_and_b32 v227, 7, v224
  v_lshl_add_u32 v226, v227, 1, v226
  v_mfma_f32_16x16x32_bf16 a[124:127], a[188:191], v[56:59], a[124:127]
  s_waitcnt lgkmcnt(7)
  v_exp_f32 v127, v127
  v_mfma_f32_16x16x32_bf16 a[124:127], a[184:187], v[24:27], a[124:127]
  v_cvt_pk_bf16_f32 v123, v126, v127
  v_and_b32 v227, 1, v224
  v_lshl_add_u32 v226, v227, 30, v226
  v_or_b32 v226, s35, v226
  v_min_u32 v249, 1, v224
  v_lshlrev_b32 v249, 30, v249
  v_or_b32 v249, s35, v249
  v_mov_b32 v251, v249
  v_mov_b32 v250, 1
  s_mov_b32 s47, 2818048
  s_lshl_b32 s35, s33, 4
  s_add_u32 s35, s35, 2633728
  s_waitcnt lgkmcnt(0)
  v_add_f32 v228, v228, v229
  v_add_f32 v238, v238, v239
  v_add_f32 v230, v230, v231
  v_add_f32 v240, v240, v241
  v_add_f32 v228, v228, v230
  v_add_f32 v238, v238, v240
  v_cvt_pk_bf16_f32 v228, v228, v228
  v_cvt_pk_bf16_f32 v238, v238, v238
  v_lshlrev_b32 v228, 16, v228
  v_lshlrev_b32 v238, 16, v238
  v_mul_f32 v229, 0xbfb8aa3b, v228
  v_exp_f32 v229, v229
  s_nop 0
  v_add_f32 v229, 1.0, v229
  v_rcp_f32 v229, v229
  s_nop 0
  v_mul_f32 v228, v228, v229
  v_cvt_pk_bf16_f32 v228, v228, v228
  v_lshlrev_b32 v228, 16, v228
  v_mul_f32 v228, v228, v238
  s_nop 1
  v_mov_b32_dpp v229, v228 quad_perm:[1,0,3,2] row_mask:0xf bank_mask:0xf
  v_cvt_pk_bf16_f32 v228, v228, v229
  buffer_store_dword v228, v226, s[24:27], s35 offen sc1
  s_mov_b32 s32, 5
attn_loop:
  v_mfma_f32_16x16x32_bf16 v[0:3], a[128:131], v[128:131], v[192:195]
  s_add_u32 m0, s28, 81920
  v_mfma_f32_16x16x32_bf16 v[0:3], a[132:135], v[132:135], v[0:3]
  ds_read_b128 a[144:147], v212 offset:4096
  v_mfma_f32_16x16x32_bf16 v[0:3], a[136:139], v[136:139], v[0:3]
  buffer_load_dwordx4 v236, s[16:19], s29 offen offset:0 lds
  v_mfma_f32_16x16x32_bf16 v[0:3], a[140:143], v[140:143], v[0:3]
  ds_read_b128 a[148:151], v213 offset:4096
  v_mfma_f32_16x16x32_bf16 v[8:11], a[140:143], v[156:159], v[196:199]
  v_mfma_f32_16x16x32_bf16 v[8:11], a[136:139], v[152:155], v[8:11]
  ds_read_b128 a[152:155], v214 offset:4096
  v_mfma_f32_16x16x32_bf16 v[8:11], a[132:135], v[148:151], v[8:11]
  buffer_load_dwordx4 v237, s[16:19], s29 offen offset:1024 lds
  v_mfma_f32_16x16x32_bf16 v[8:11], a[128:131], v[144:147], v[8:11]
  ds_read_b128 a[156:159], v215 offset:4096
  v_mfma_f32_16x16x32_bf16 v[16:19], a[128:131], v[160:163], v[200:203]
  v_exp_f32 v0, v0
  v_mfma_f32_16x16x32_bf16 v[16:19], a[132:135], v[164:167], v[16:19]
  v_mfma_f32_16x16x32_bf16 v[16:19], a[136:139], v[168:171], v[16:19]
  v_exp_f32 v1, v1
  v_mfma_f32_16x16x32_bf16 v[16:19], a[140:143], v[172:175], v[16:19]
  v_cvt_pk_bf16_f32 v0, v0, v1
  v_mfma_f32_16x16x32_bf16 v[24:27], a[140:143], v[188:191], v[204:207]
  v_exp_f32 v2, v2
  v_mfma_f32_16x16x32_bf16 v[24:27], a[136:139], v[184:187], v[24:27]
  buffer_load_dwordx4 v236, s[16:19], s29 offen offset:2048 lds
  v_mfma_f32_16x16x32_bf16 v[24:27], a[132:135], v[180:183], v[24:27]
  s_waitcnt lgkmcnt(0)
  v_exp_f32 v3, v3
  v_mfma_f32_16x16x32_bf16 v[24:27], a[128:131], v[176:179], v[24:27]
  v_cvt_pk_bf16_f32 v1, v2, v3
  v_mfma_f32_16x16x32_bf16 v[4:7], a[144:147], v[128:131], v[192:195]
  v_exp_f32 v8, v8
  v_mfma_f32_16x16x32_bf16 v[4:7], a[148:151], v[132:135], v[4:7]
  ds_read_b128 a[128:131], v212 offset:8192
  v_mfma_f32_16x16x32_bf16 v[4:7], a[152:155], v[136:139], v[4:7]
  v_exp_f32 v9, v9
  v_mfma_f32_16x16x32_bf16 v[4:7], a[156:159], v[140:143], v[4:7]
  ds_read_b128 a[132:135], v213 offset:8192
  v_cvt_pk_bf16_f32 v8, v8, v9
  v_mfma_f32_16x16x32_bf16 v[12:15], a[156:159], v[156:159], v[196:199]
  v_exp_f32 v10, v10
  v_mfma_f32_16x16x32_bf16 v[12:15], a[152:155], v[152:155], v[12:15]
  ds_read_b128 a[136:139], v214 offset:8192
  v_mfma_f32_16x16x32_bf16 v[12:15], a[148:151], v[148:151], v[12:15]
  v_exp_f32 v11, v11
  v_mfma_f32_16x16x32_bf16 v[12:15], a[144:147], v[144:147], v[12:15]
  ds_read_b128 a[140:143], v215 offset:8192
  v_cvt_pk_bf16_f32 v9, v10, v11
  v_mfma_f32_16x16x32_bf16 v[20:23], a[144:147], v[160:163], v[200:203]
  v_exp_f32 v16, v16
  v_mfma_f32_16x16x32_bf16 v[20:23], a[148:151], v[164:167], v[20:23]
  buffer_load_dwordx4 v237, s[16:19], s29 offen offset:3072 lds
  v_mfma_f32_16x16x32_bf16 v[20:23], a[152:155], v[168:171], v[20:23]
  s_add_u32 s29, s29, 16384
  v_exp_f32 v17, v17
  v_mfma_f32_16x16x32_bf16 v[20:23], a[156:159], v[172:175], v[20:23]
  v_cvt_pk_bf16_f32 v16, v16, v17
  v_mfma_f32_16x16x32_bf16 v[28:31], a[156:159], v[188:191], v[204:207]
  s_add_u32 m0, s28, 32768
  v_exp_f32 v18, v18
  v_mfma_f32_16x16x32_bf16 v[28:31], a[152:155], v[184:187], v[28:31]
  buffer_load_dwordx4 v232, s[12:15], s29 offen offset:0 lds
  v_mfma_f32_16x16x32_bf16 v[28:31], a[148:151], v[180:183], v[28:31]
  s_waitcnt lgkmcnt(0)
  v_exp_f32 v19, v19
  v_mfma_f32_16x16x32_bf16 v[28:31], a[144:147], v[176:179], v[28:31]
  v_cvt_pk_bf16_f32 v17, v18, v19
  v_mfma_f32_16x16x32_bf16 v[32:35], a[128:131], v[128:131], v[192:195]
  v_exp_f32 v24, v24
  v_mfma_f32_16x16x32_bf16 v[32:35], a[132:135], v[132:135], v[32:35]
  ds_read_b128 a[144:147], v212 offset:12288
  v_mfma_f32_16x16x32_bf16 v[32:35], a[136:139], v[136:139], v[32:35]
  v_exp_f32 v25, v25
  v_mfma_f32_16x16x32_bf16 v[32:35], a[140:143], v[140:143], v[32:35]
  ds_read_b128 a[148:151], v213 offset:12288
  v_cvt_pk_bf16_f32 v24, v24, v25
  v_mfma_f32_16x16x32_bf16 v[40:43], a[140:143], v[156:159], v[196:199]
  v_exp_f32 v26, v26
  v_mfma_f32_16x16x32_bf16 v[40:43], a[136:139], v[152:155], v[40:43]
  ds_read_b128 a[152:155], v214 offset:12288
  v_mfma_f32_16x16x32_bf16 v[40:43], a[132:135], v[148:151], v[40:43]
  v_exp_f32 v27, v27
  v_mfma_f32_16x16x32_bf16 v[40:43], a[128:131], v[144:147], v[40:43]
  ds_read_b128 a[156:159], v215 offset:12288
  v_cvt_pk_bf16_f32 v25, v26, v27
  v_mfma_f32_16x16x32_bf16 v[48:51], a[128:131], v[160:163], v[200:203]
  v_exp_f32 v4, v4
  v_mfma_f32_16x16x32_bf16 v[48:51], a[132:135], v[164:167], v[48:51]
  buffer_load_dwordx4 v233, s[12:15], s29 offen offset:1024 lds
  v_mfma_f32_16x16x32_bf16 v[48:51], a[136:139], v[168:171], v[48:51]
  v_exp_f32 v5, v5
  v_mfma_f32_16x16x32_bf16 v[48:51], a[140:143], v[172:175], v[48:51]
  v_cvt_pk_bf16_f32 v2, v4, v5
  v_mfma_f32_16x16x32_bf16 v[56:59], a[140:143], v[188:191], v[204:207]
  v_exp_f32 v6, v6
  v_mfma_f32_16x16x32_bf16 v[56:59], a[136:139], v[184:187], v[56:59]
  buffer_load_dwordx4 v234, s[12:15], s29 offen offset:2048 lds
  v_mfma_f32_16x16x32_bf16 v[56:59], a[132:135], v[180:183], v[56:59]
  s_waitcnt lgkmcnt(0)
  v_exp_f32 v7, v7
  v_mfma_f32_16x16x32_bf16 v[56:59], a[128:131], v[176:179], v[56:59]
  v_cvt_pk_bf16_f32 v3, v6, v7
  v_mfma_f32_16x16x32_bf16 v[36:39], a[144:147], v[128:131], v[192:195]
  v_exp_f32 v12, v12
  v_mfma_f32_16x16x32_bf16 v[36:39], a[148:151], v[132:135], v[36:39]
  ds_read_b64_tr_b16 a[160:161], v216 offset:49152
  v_mfma_f32_16x16x32_bf16 v[36:39], a[152:155], v[136:139], v[36:39]
  v_exp_f32 v13, v13
  v_mfma_f32_16x16x32_bf16 v[36:39], a[156:159], v[140:143], v[36:39]
  ds_read_b64_tr_b16 a[162:163], v216 offset:53248
  v_cvt_pk_bf16_f32 v10, v12, v13
  v_mfma_f32_16x16x32_bf16 v[44:47], a[156:159], v[156:159], v[196:199]
  v_exp_f32 v14, v14
  v_mfma_f32_16x16x32_bf16 v[44:47], a[152:155], v[152:155], v[44:47]
  ds_read_b64_tr_b16 a[164:165], v216 offset:57344
  buffer_load_dwordx4 v235, s[12:15], s29 offen offset:3072 lds
  v_mfma_f32_16x16x32_bf16 v[44:47], a[148:151], v[148:151], v[44:47]
  v_exp_f32 v15, v15
  v_mfma_f32_16x16x32_bf16 v[44:47], a[144:147], v[144:147], v[44:47]
  ds_read_b64_tr_b16 a[166:167], v216 offset:61440
  v_cvt_pk_bf16_f32 v11, v14, v15
  v_mfma_f32_16x16x32_bf16 v[52:55], a[144:147], v[160:163], v[200:203]
  s_add_u32 m0, s50, 4096
  v_exp_f32 v20, v20
  v_mfma_f32_16x16x32_bf16 v[52:55], a[148:151], v[164:167], v[52:55]
  ds_read_b64_tr_b16 a[168:169], v217 offset:49152
  buffer_load_dwordx4 v208, s[20:23], s30 offen lds
  s_add_u32 s30, s30, 32
  v_mfma_f32_16x16x32_bf16 v[52:55], a[152:155], v[168:171], v[52:55]
  v_exp_f32 v21, v21
  v_mfma_f32_16x16x32_bf16 v[52:55], a[156:159], v[172:175], v[52:55]
  ds_read_b64_tr_b16 a[170:171], v217 offset:53248
  v_cvt_pk_bf16_f32 v18, v20, v21
  v_mfma_f32_16x16x32_bf16 v[60:63], a[156:159], v[188:191], v[204:207]
  v_exp_f32 v22, v22
  v_mfma_f32_16x16x32_bf16 v[60:63], a[152:155], v[184:187], v[60:63]
  ds_read_b64_tr_b16 a[172:173], v217 offset:57344
  v_mfma_f32_16x16x32_bf16 v[60:63], a[148:151], v[180:183], v[60:63]
  v_exp_f32 v23, v23
  v_mfma_f32_16x16x32_bf16 v[60:63], a[144:147], v[176:179], v[60:63]
  ds_read_b64_tr_b16 a[174:175], v217 offset:61440
  v_cvt_pk_bf16_f32 v19, v22, v23
  v_mfma_f32_16x16x32_bf16 a[192:195], a[208:211], v[64:67], a[192:195]
  v_exp_f32 v28, v28
  v_mfma_f32_16x16x32_bf16 a[192:195], a[208:211], v[96:99], a[192:195]
  ds_read_b64_tr_b16 a[176:177], v218 offset:49152
  v_mfma_f32_16x16x32_bf16 a[196:199], a[208:211], v[72:75], a[196:199]
  v_exp_f32 v29, v29
  v_mfma_f32_16x16x32_bf16 a[196:199], a[208:211], v[104:107], a[196:199]
  ds_read_b64_tr_b16 a[178:179], v218 offset:53248
  v_cvt_pk_bf16_f32 v26, v28, v29
  v_mfma_f32_16x16x32_bf16 a[200:203], a[208:211], v[80:83], a[200:203]
  v_exp_f32 v30, v30
  v_mfma_f32_16x16x32_bf16 a[200:203], a[208:211], v[112:115], a[200:203]
  ds_read_b64_tr_b16 a[180:181], v218 offset:57344
  v_mfma_f32_16x16x32_bf16 a[204:207], a[208:211], v[88:91], a[204:207]
  s_waitcnt lgkmcnt(7)
  v_exp_f32 v31, v31
  v_mfma_f32_16x16x32_bf16 a[204:207], a[208:211], v[120:123], a[204:207]
  ds_read_b64_tr_b16 a[182:183], v218 offset:61440
  v_cvt_pk_bf16_f32 v27, v30, v31
  v_mfma_f32_16x16x32_bf16 a[0:3], a[160:163], v[64:67], a[0:3]
  v_exp_f32 v32, v32
  v_mfma_f32_16x16x32_bf16 a[0:3], a[164:167], v[96:99], a[0:3]
  ds_read_b64_tr_b16 a[184:185], v219 offset:49152
  v_mfma_f32_16x16x32_bf16 a[4:7], a[164:167], v[104:107], a[4:7]
  v_exp_f32 v33, v33
  v_mfma_f32_16x16x32_bf16 a[4:7], a[160:163], v[72:75], a[4:7]
  ds_read_b64_tr_b16 a[186:187], v219 offset:53248
  v_cvt_pk_bf16_f32 v32, v32, v33
  v_mfma_f32_16x16x32_bf16 a[8:11], a[160:163], v[80:83], a[8:11]
  v_exp_f32 v34, v34
  v_mfma_f32_16x16x32_bf16 a[8:11], a[164:167], v[112:115], a[8:11]
  ds_read_b64_tr_b16 a[188:189], v219 offset:57344
  v_mfma_f32_16x16x32_bf16 a[12:15], a[164:167], v[120:123], a[12:15]
  s_waitcnt lgkmcnt(7)
  v_exp_f32 v35, v35
  v_mfma_f32_16x16x32_bf16 a[12:15], a[160:163], v[88:91], a[12:15]
  ds_read_b64_tr_b16 a[190:191], v219 offset:61440
  v_cvt_pk_bf16_f32 v33, v34, v35
  v_mfma_f32_16x16x32_bf16 a[16:19], a[168:171], v[64:67], a[16:19]
  v_exp_f32 v40, v40
  v_mfma_f32_16x16x32_bf16 a[16:19], a[172:175], v[96:99], a[16:19]
  ds_read_b64_tr_b16 a[160:161], v220 offset:49152
  v_mfma_f32_16x16x32_bf16 a[20:23], a[172:175], v[104:107], a[20:23]
  v_exp_f32 v41, v41
  v_mfma_f32_16x16x32_bf16 a[20:23], a[168:171], v[72:75], a[20:23]
  ds_read_b64_tr_b16 a[162:163], v220 offset:53248
  v_cvt_pk_bf16_f32 v40, v40, v41
  v_mfma_f32_16x16x32_bf16 a[24:27], a[168:171], v[80:83], a[24:27]
  v_exp_f32 v42, v42
  v_mfma_f32_16x16x32_bf16 a[24:27], a[172:175], v[112:115], a[24:27]
  ds_read_b64_tr_b16 a[164:165], v220 offset:57344
  v_mfma_f32_16x16x32_bf16 a[28:31], a[172:175], v[120:123], a[28:31]
  s_waitcnt lgkmcnt(7)
  v_exp_f32 v43, v43
  v_mfma_f32_16x16x32_bf16 a[28:31], a[168:171], v[88:91], a[28:31]
  ds_read_b64_tr_b16 a[166:167], v220 offset:61440
  v_cvt_pk_bf16_f32 v41, v42, v43
  v_mfma_f32_16x16x32_bf16 a[32:35], a[176:179], v[64:67], a[32:35]
  v_exp_f32 v48, v48
  v_mfma_f32_16x16x32_bf16 a[32:35], a[180:183], v[96:99], a[32:35]
  ds_read_b64_tr_b16 a[168:169], v221 offset:49152
  v_mfma_f32_16x16x32_bf16 a[36:39], a[180:183], v[104:107], a[36:39]
  v_exp_f32 v49, v49
  v_mfma_f32_16x16x32_bf16 a[36:39], a[176:179], v[72:75], a[36:39]
  ds_read_b64_tr_b16 a[170:171], v221 offset:53248
  v_cvt_pk_bf16_f32 v48, v48, v49
  v_mfma_f32_16x16x32_bf16 a[40:43], a[176:179], v[80:83], a[40:43]
  v_exp_f32 v50, v50
  v_mfma_f32_16x16x32_bf16 a[40:43], a[180:183], v[112:115], a[40:43]
  ds_read_b64_tr_b16 a[172:173], v221 offset:57344
  v_mfma_f32_16x16x32_bf16 a[44:47], a[180:183], v[120:123], a[44:47]
  s_waitcnt lgkmcnt(7)
  v_exp_f32 v51, v51
  v_mfma_f32_16x16x32_bf16 a[44:47], a[176:179], v[88:91], a[44:47]
  ds_read_b64_tr_b16 a[174:175], v221 offset:61440
  v_cvt_pk_bf16_f32 v49, v50, v51
  v_mfma_f32_16x16x32_bf16 a[48:51], a[184:187], v[64:67], a[48:51]
  v_exp_f32 v56, v56
  v_mfma_f32_16x16x32_bf16 a[48:51], a[188:191], v[96:99], a[48:51]
  ds_read_b64_tr_b16 a[176:177], v222 offset:49152
  v_mfma_f32_16x16x32_bf16 a[52:55], a[188:191], v[104:107], a[52:55]
  v_exp_f32 v57, v57
  v_mfma_f32_16x16x32_bf16 a[52:55], a[184:187], v[72:75], a[52:55]
  ds_read_b64_tr_b16 a[178:179], v222 offset:53248
  v_cvt_pk_bf16_f32 v56, v56, v57
  v_mfma_f32_16x16x32_bf16 a[56:59], a[184:187], v[80:83], a[56:59]
  v_exp_f32 v58, v58
  v_mfma_f32_16x16x32_bf16 a[56:59], a[188:191], v[112:115], a[56:59]
  ds_read_b64_tr_b16 a[180:181], v222 offset:57344
  global_load_dword v255, v252, s[8:9]
  v_mfma_f32_16x16x32_bf16 a[60:63], a[188:191], v[120:123], a[60:63]
  s_waitcnt lgkmcnt(7)
  v_exp_f32 v59, v59
  v_mfma_f32_16x16x32_bf16 a[60:63], a[184:187], v[88:91], a[60:63]
  ds_read_b64_tr_b16 a[182:183], v222 offset:61440
  v_cvt_pk_bf16_f32 v57, v58, v59
  v_mfma_f32_16x16x32_bf16 a[64:67], a[160:163], v[64:67], a[64:67]
  v_exp_f32 v36, v36
  v_mfma_f32_16x16x32_bf16 a[64:67], a[164:167], v[96:99], a[64:67]
  ds_read_b64_tr_b16 a[184:185], v223 offset:49152
  v_mfma_f32_16x16x32_bf16 a[68:71], a[164:167], v[104:107], a[68:71]
  v_exp_f32 v37, v37
  v_mfma_f32_16x16x32_bf16 a[68:71], a[160:163], v[72:75], a[68:71]
  ds_read_b64_tr_b16 a[186:187], v223 offset:53248
  v_cvt_pk_bf16_f32 v34, v36, v37
  v_mfma_f32_16x16x32_bf16 a[72:75], a[160:163], v[80:83], a[72:75]
  v_exp_f32 v38, v38
  v_mfma_f32_16x16x32_bf16 a[72:75], a[164:167], v[112:115], a[72:75]
  ds_read_b64_tr_b16 a[188:189], v223 offset:57344
  v_mfma_f32_16x16x32_bf16 a[76:79], a[164:167], v[120:123], a[76:79]
  s_waitcnt lgkmcnt(7)
  v_exp_f32 v39, v39
  v_mfma_f32_16x16x32_bf16 a[76:79], a[160:163], v[88:91], a[76:79]
  ds_read_b64_tr_b16 a[190:191], v223 offset:61440
  v_cvt_pk_bf16_f32 v35, v38, v39
  v_mfma_f32_16x16x32_bf16 a[80:83], a[168:171], v[64:67], a[80:83]
  s_waitcnt vmcnt(12)
  v_exp_f32 v44, v44
  v_mfma_f32_16x16x32_bf16 a[80:83], a[172:175], v[96:99], a[80:83]
  v_mfma_f32_16x16x32_bf16 a[84:87], a[172:175], v[104:107], a[84:87]
  s_barrier
  v_exp_f32 v45, v45
  v_mfma_f32_16x16x32_bf16 a[84:87], a[168:171], v[72:75], a[84:87]
  ds_read_b128 a[128:131], v212 offset:16384
  v_cvt_pk_bf16_f32 v42, v44, v45
  v_mfma_f32_16x16x32_bf16 a[88:91], a[168:171], v[80:83], a[88:91]
  v_exp_f32 v46, v46
  v_mfma_f32_16x16x32_bf16 a[88:91], a[172:175], v[112:115], a[88:91]
  ds_read_b128 a[132:135], v213 offset:16384
  v_mfma_f32_16x16x32_bf16 a[92:95], a[172:175], v[120:123], a[92:95]
  s_waitcnt lgkmcnt(6)
  v_exp_f32 v47, v47
  v_mfma_f32_16x16x32_bf16 a[92:95], a[168:171], v[88:91], a[92:95]
  ds_read_b128 a[136:139], v214 offset:16384
  v_cvt_pk_bf16_f32 v43, v46, v47
  v_mfma_f32_16x16x32_bf16 a[96:99], a[176:179], v[64:67], a[96:99]
  v_exp_f32 v52, v52
  v_mfma_f32_16x16x32_bf16 a[96:99], a[180:183], v[96:99], a[96:99]
  ds_read_b128 a[140:143], v215 offset:16384
  v_mfma_f32_16x16x32_bf16 a[100:103], a[180:183], v[104:107], a[100:103]
  v_exp_f32 v53, v53
  v_mfma_f32_16x16x32_bf16 a[100:103], a[176:179], v[72:75], a[100:103]
  v_cvt_pk_bf16_f32 v50, v52, v53
  v_mfma_f32_16x16x32_bf16 a[104:107], a[176:179], v[80:83], a[104:107]
  v_exp_f32 v54, v54
  v_mfma_f32_16x16x32_bf16 a[104:107], a[180:183], v[112:115], a[104:107]
  v_mfma_f32_16x16x32_bf16 a[108:111], a[180:183], v[120:123], a[108:111]
  s_waitcnt lgkmcnt(4)
  v_exp_f32 v55, v55
  v_mfma_f32_16x16x32_bf16 a[108:111], a[176:179], v[88:91], a[108:111]
  v_cvt_pk_bf16_f32 v51, v54, v55
  v_mfma_f32_16x16x32_bf16 a[112:115], a[184:187], v[64:67], a[112:115]
  v_exp_f32 v60, v60
  v_mfma_f32_16x16x32_bf16 a[112:115], a[188:191], v[96:99], a[112:115]
  v_mfma_f32_16x16x32_bf16 a[116:119], a[188:191], v[104:107], a[116:119]
  v_exp_f32 v61, v61
  v_mfma_f32_16x16x32_bf16 a[116:119], a[184:187], v[72:75], a[116:119]
  v_cvt_pk_bf16_f32 v58, v60, v61
  v_mfma_f32_16x16x32_bf16 a[120:123], a[184:187], v[80:83], a[120:123]
  v_exp_f32 v62, v62
  v_mfma_f32_16x16x32_bf16 a[120:123], a[188:191], v[112:115], a[120:123]
  v_mfma_f32_16x16x32_bf16 a[124:127], a[188:191], v[120:123], a[124:127]
  s_waitcnt lgkmcnt(0)
  v_exp_f32 v63, v63
  v_mfma_f32_16x16x32_bf16 a[124:127], a[184:187], v[88:91], a[124:127]
  v_cvt_pk_bf16_f32 v59, v62, v63
  v_mfma_f32_16x16x32_bf16 v[64:67], a[128:131], v[128:131], v[192:195]
  s_add_u32 m0, s28, 98304
  v_mfma_f32_16x16x32_bf16 v[64:67], a[132:135], v[132:135], v[64:67]
  ds_read_b128 a[144:147], v212 offset:20480
  v_mfma_f32_16x16x32_bf16 v[64:67], a[136:139], v[136:139], v[64:67]
  buffer_load_dwordx4 v236, s[16:19], s29 offen offset:0 lds
  v_mfma_f32_16x16x32_bf16 v[64:67], a[140:143], v[140:143], v[64:67]
  ds_read_b128 a[148:151], v213 offset:20480
  v_mfma_f32_16x16x32_bf16 v[72:75], a[140:143], v[156:159], v[196:199]
  v_mfma_f32_16x16x32_bf16 v[72:75], a[136:139], v[152:155], v[72:75]
  ds_read_b128 a[152:155], v214 offset:20480
  v_mfma_f32_16x16x32_bf16 v[72:75], a[132:135], v[148:151], v[72:75]
  buffer_load_dwordx4 v237, s[16:19], s29 offen offset:1024 lds
  v_mfma_f32_16x16x32_bf16 v[72:75], a[128:131], v[144:147], v[72:75]
  ds_read_b128 a[156:159], v215 offset:20480
  v_mfma_f32_16x16x32_bf16 v[80:83], a[128:131], v[160:163], v[200:203]
  v_exp_f32 v64, v64
  v_mfma_f32_16x16x32_bf16 v[80:83], a[132:135], v[164:167], v[80:83]
  v_mfma_f32_16x16x32_bf16 v[80:83], a[136:139], v[168:171], v[80:83]
  v_exp_f32 v65, v65
  v_mfma_f32_16x16x32_bf16 v[80:83], a[140:143], v[172:175], v[80:83]
  v_cvt_pk_bf16_f32 v64, v64, v65
  v_mfma_f32_16x16x32_bf16 v[88:91], a[140:143], v[188:191], v[204:207]
  v_exp_f32 v66, v66
  v_mfma_f32_16x16x32_bf16 v[88:91], a[136:139], v[184:187], v[88:91]
  buffer_load_dwordx4 v236, s[16:19], s29 offen offset:2048 lds
  v_mfma_f32_16x16x32_bf16 v[88:91], a[132:135], v[180:183], v[88:91]
  s_waitcnt lgkmcnt(0)
  v_exp_f32 v67, v67
  v_mfma_f32_16x16x32_bf16 v[88:91], a[128:131], v[176:179], v[88:91]
  v_cvt_pk_bf16_f32 v65, v66, v67
  v_mfma_f32_16x16x32_bf16 v[68:71], a[144:147], v[128:131], v[192:195]
  v_exp_f32 v72, v72
  v_mfma_f32_16x16x32_bf16 v[68:71], a[148:151], v[132:135], v[68:71]
  ds_read_b128 a[128:131], v212 offset:24576
  v_mfma_f32_16x16x32_bf16 v[68:71], a[152:155], v[136:139], v[68:71]
  v_exp_f32 v73, v73
  v_mfma_f32_16x16x32_bf16 v[68:71], a[156:159], v[140:143], v[68:71]
  ds_read_b128 a[132:135], v213 offset:24576
  v_cvt_pk_bf16_f32 v72, v72, v73
  v_mfma_f32_16x16x32_bf16 v[76:79], a[156:159], v[156:159], v[196:199]
  v_exp_f32 v74, v74
  v_mfma_f32_16x16x32_bf16 v[76:79], a[152:155], v[152:155], v[76:79]
  ds_read_b128 a[136:139], v214 offset:24576
  v_mfma_f32_16x16x32_bf16 v[76:79], a[148:151], v[148:151], v[76:79]
  v_exp_f32 v75, v75
  v_mfma_f32_16x16x32_bf16 v[76:79], a[144:147], v[144:147], v[76:79]
  ds_read_b128 a[140:143], v215 offset:24576
  v_cvt_pk_bf16_f32 v73, v74, v75
  v_mfma_f32_16x16x32_bf16 v[84:87], a[144:147], v[160:163], v[200:203]
  v_exp_f32 v80, v80
  v_mfma_f32_16x16x32_bf16 v[84:87], a[148:151], v[164:167], v[84:87]
  buffer_load_dwordx4 v237, s[16:19], s29 offen offset:3072 lds
  v_mfma_f32_16x16x32_bf16 v[84:87], a[152:155], v[168:171], v[84:87]
  s_add_u32 s29, s29, 16384
  v_exp_f32 v81, v81
  v_mfma_f32_16x16x32_bf16 v[84:87], a[156:159], v[172:175], v[84:87]
  v_cvt_pk_bf16_f32 v80, v80, v81
  v_mfma_f32_16x16x32_bf16 v[92:95], a[156:159], v[188:191], v[204:207]
  s_add_u32 m0, s28, 49152
  v_exp_f32 v82, v82
  v_mfma_f32_16x16x32_bf16 v[92:95], a[152:155], v[184:187], v[92:95]
  buffer_load_dwordx4 v232, s[12:15], s29 offen offset:0 lds
  v_mfma_f32_16x16x32_bf16 v[92:95], a[148:151], v[180:183], v[92:95]
  s_waitcnt lgkmcnt(0)
  v_exp_f32 v83, v83
  v_mfma_f32_16x16x32_bf16 v[92:95], a[144:147], v[176:179], v[92:95]
  v_cvt_pk_bf16_f32 v81, v82, v83
  v_mfma_f32_16x16x32_bf16 v[96:99], a[128:131], v[128:131], v[192:195]
  v_exp_f32 v88, v88
  v_mfma_f32_16x16x32_bf16 v[96:99], a[132:135], v[132:135], v[96:99]
  ds_read_b128 a[144:147], v212 offset:28672
  v_mfma_f32_16x16x32_bf16 v[96:99], a[136:139], v[136:139], v[96:99]
  v_exp_f32 v89, v89
  v_mfma_f32_16x16x32_bf16 v[96:99], a[140:143], v[140:143], v[96:99]
  ds_read_b128 a[148:151], v213 offset:28672
  v_cvt_pk_bf16_f32 v88, v88, v89
  v_mfma_f32_16x16x32_bf16 v[104:107], a[140:143], v[156:159], v[196:199]
  v_exp_f32 v90, v90
  v_mfma_f32_16x16x32_bf16 v[104:107], a[136:139], v[152:155], v[104:107]
  ds_read_b128 a[152:155], v214 offset:28672
  v_mfma_f32_16x16x32_bf16 v[104:107], a[132:135], v[148:151], v[104:107]
  v_exp_f32 v91, v91
  v_mfma_f32_16x16x32_bf16 v[104:107], a[128:131], v[144:147], v[104:107]
  ds_read_b128 a[156:159], v215 offset:28672
  v_cvt_pk_bf16_f32 v89, v90, v91
  v_mfma_f32_16x16x32_bf16 v[112:115], a[128:131], v[160:163], v[200:203]
  v_exp_f32 v68, v68
  v_mfma_f32_16x16x32_bf16 v[112:115], a[132:135], v[164:167], v[112:115]
  buffer_load_dwordx4 v233, s[12:15], s29 offen offset:1024 lds
  v_mfma_f32_16x16x32_bf16 v[112:115], a[136:139], v[168:171], v[112:115]
  v_exp_f32 v69, v69
  v_mfma_f32_16x16x32_bf16 v[112:115], a[140:143], v[172:175], v[112:115]
  v_cvt_pk_bf16_f32 v66, v68, v69
  v_mfma_f32_16x16x32_bf16 v[120:123], a[140:143], v[188:191], v[204:207]
  v_exp_f32 v70, v70
  v_mfma_f32_16x16x32_bf16 v[120:123], a[136:139], v[184:187], v[120:123]
  buffer_load_dwordx4 v234, s[12:15], s29 offen offset:2048 lds
  v_mfma_f32_16x16x32_bf16 v[120:123], a[132:135], v[180:183], v[120:123]
  s_waitcnt lgkmcnt(0)
  v_exp_f32 v71, v71
  v_mfma_f32_16x16x32_bf16 v[120:123], a[128:131], v[176:179], v[120:123]
  v_cvt_pk_bf16_f32 v67, v70, v71
  v_mfma_f32_16x16x32_bf16 v[100:103], a[144:147], v[128:131], v[192:195]
  v_exp_f32 v76, v76
  v_mfma_f32_16x16x32_bf16 v[100:103], a[148:151], v[132:135], v[100:103]
  ds_read_b64_tr_b16 a[160:161], v216 offset:0
  v_mfma_f32_16x16x32_bf16 v[100:103], a[152:155], v[136:139], v[100:103]
  v_exp_f32 v77, v77
  v_mfma_f32_16x16x32_bf16 v[100:103], a[156:159], v[140:143], v[100:103]
  ds_read_b64_tr_b16 a[162:163], v216 offset:4096
  v_cvt_pk_bf16_f32 v74, v76, v77
  v_mfma_f32_16x16x32_bf16 v[108:111], a[156:159], v[156:159], v[196:199]
  v_exp_f32 v78, v78
  v_mfma_f32_16x16x32_bf16 v[108:111], a[152:155], v[152:155], v[108:111]
  ds_read_b64_tr_b16 a[164:165], v216 offset:8192
  buffer_load_dwordx4 v235, s[12:15], s29 offen offset:3072 lds
  v_mfma_f32_16x16x32_bf16 v[108:111], a[148:151], v[148:151], v[108:111]
  v_exp_f32 v79, v79
  v_mfma_f32_16x16x32_bf16 v[108:111], a[144:147], v[144:147], v[108:111]
  ds_read_b64_tr_b16 a[166:167], v216 offset:12288
  v_cvt_pk_bf16_f32 v75, v78, v79
  v_mfma_f32_16x16x32_bf16 v[116:119], a[144:147], v[160:163], v[200:203]
  s_add_u32 m0, s50, 5120
  v_exp_f32 v84, v84
  v_mfma_f32_16x16x32_bf16 v[116:119], a[148:151], v[164:167], v[116:119]
  ds_read_b64_tr_b16 a[168:169], v217 offset:0
  buffer_load_dwordx4 v208, s[20:23], s30 offen lds
  s_add_u32 s30, s30, 32
  v_mfma_f32_16x16x32_bf16 v[116:119], a[152:155], v[168:171], v[116:119]
  v_exp_f32 v85, v85
  v_mfma_f32_16x16x32_bf16 v[116:119], a[156:159], v[172:175], v[116:119]
  ds_read_b64_tr_b16 a[170:171], v217 offset:4096
  v_cvt_pk_bf16_f32 v82, v84, v85
  v_mfma_f32_16x16x32_bf16 v[124:127], a[156:159], v[188:191], v[204:207]
  v_exp_f32 v86, v86
  v_mfma_f32_16x16x32_bf16 v[124:127], a[152:155], v[184:187], v[124:127]
  ds_read_b64_tr_b16 a[172:173], v217 offset:8192
  v_mfma_f32_16x16x32_bf16 v[124:127], a[148:151], v[180:183], v[124:127]
  v_exp_f32 v87, v87
  v_mfma_f32_16x16x32_bf16 v[124:127], a[144:147], v[176:179], v[124:127]
  ds_read_b64_tr_b16 a[174:175], v217 offset:12288
  v_cvt_pk_bf16_f32 v83, v86, v87
  v_mfma_f32_16x16x32_bf16 a[192:195], a[208:211], v[0:3], a[192:195]
  v_exp_f32 v92, v92
  v_mfma_f32_16x16x32_bf16 a[192:195], a[208:211], v[32:35], a[192:195]
  ds_read_b64_tr_b16 a[176:177], v218 offset:0
  v_mfma_f32_16x16x32_bf16 a[196:199], a[208:211], v[8:11], a[196:199]
  v_exp_f32 v93, v93
  v_mfma_f32_16x16x32_bf16 a[196:199], a[208:211], v[40:43], a[196:199]
  ds_read_b64_tr_b16 a[178:179], v218 offset:4096
  v_cvt_pk_bf16_f32 v90, v92, v93
  v_mfma_f32_16x16x32_bf16 a[200:203], a[208:211], v[16:19], a[200:203]
  v_exp_f32 v94, v94
  v_mfma_f32_16x16x32_bf16 a[200:203], a[208:211], v[48:51], a[200:203]
  ds_read_b64_tr_b16 a[180:181], v218 offset:8192
  v_mfma_f32_16x16x32_bf16 a[204:207], a[208:211], v[24:27], a[204:207]
  s_waitcnt lgkmcnt(7)
  v_exp_f32 v95, v95
  v_mfma_f32_16x16x32_bf16 a[204:207], a[208:211], v[56:59], a[204:207]
  ds_read_b64_tr_b16 a[182:183], v218 offset:12288
  v_cvt_pk_bf16_f32 v91, v94, v95
  v_mfma_f32_16x16x32_bf16 a[0:3], a[160:163], v[0:3], a[0:3]
  v_exp_f32 v96, v96
  v_mfma_f32_16x16x32_bf16 a[0:3], a[164:167], v[32:35], a[0:3]
  ds_read_b64_tr_b16 a[184:185], v219 offset:0
  v_mfma_f32_16x16x32_bf16 a[4:7], a[164:167], v[40:43], a[4:7]
  v_exp_f32 v97, v97
  v_mfma_f32_16x16x32_bf16 a[4:7], a[160:163], v[8:11], a[4:7]
  ds_read_b64_tr_b16 a[186:187], v219 offset:4096
  v_cvt_pk_bf16_f32 v96, v96, v97
  v_mfma_f32_16x16x32_bf16 a[8:11], a[160:163], v[16:19], a[8:11]
  v_exp_f32 v98, v98
  v_mfma_f32_16x16x32_bf16 a[8:11], a[164:167], v[48:51], a[8:11]
  ds_read_b64_tr_b16 a[188:189], v219 offset:8192
  v_mfma_f32_16x16x32_bf16 a[12:15], a[164:167], v[56:59], a[12:15]
  s_waitcnt lgkmcnt(7)
  v_exp_f32 v99, v99
  v_mfma_f32_16x16x32_bf16 a[12:15], a[160:163], v[24:27], a[12:15]
  ds_read_b64_tr_b16 a[190:191], v219 offset:12288
  v_cvt_pk_bf16_f32 v97, v98, v99
  v_mfma_f32_16x16x32_bf16 a[16:19], a[168:171], v[0:3], a[16:19]
  v_exp_f32 v104, v104
  v_mfma_f32_16x16x32_bf16 a[16:19], a[172:175], v[32:35], a[16:19]
  ds_read_b64_tr_b16 a[160:161], v220 offset:0
  v_mfma_f32_16x16x32_bf16 a[20:23], a[172:175], v[40:43], a[20:23]
  v_exp_f32 v105, v105
  v_mfma_f32_16x16x32_bf16 a[20:23], a[168:171], v[8:11], a[20:23]
  ds_read_b64_tr_b16 a[162:163], v220 offset:4096
  v_cvt_pk_bf16_f32 v104, v104, v105
  v_mfma_f32_16x16x32_bf16 a[24:27], a[168:171], v[16:19], a[24:27]
  v_exp_f32 v106, v106
  v_mfma_f32_16x16x32_bf16 a[24:27], a[172:175], v[48:51], a[24:27]
  ds_read_b64_tr_b16 a[164:165], v220 offset:8192
  v_mfma_f32_16x16x32_bf16 a[28:31], a[172:175], v[56:59], a[28:31]
  s_waitcnt lgkmcnt(7)
  v_exp_f32 v107, v107
  v_mfma_f32_16x16x32_bf16 a[28:31], a[168:171], v[24:27], a[28:31]
  ds_read_b64_tr_b16 a[166:167], v220 offset:12288
  v_cvt_pk_bf16_f32 v105, v106, v107
  v_mfma_f32_16x16x32_bf16 a[32:35], a[176:179], v[0:3], a[32:35]
  v_exp_f32 v112, v112
  v_mfma_f32_16x16x32_bf16 a[32:35], a[180:183], v[32:35], a[32:35]
  ds_read_b64_tr_b16 a[168:169], v221 offset:0
  v_mfma_f32_16x16x32_bf16 a[36:39], a[180:183], v[40:43], a[36:39]
  v_exp_f32 v113, v113
  v_mfma_f32_16x16x32_bf16 a[36:39], a[176:179], v[8:11], a[36:39]
  ds_read_b64_tr_b16 a[170:171], v221 offset:4096
  v_cvt_pk_bf16_f32 v112, v112, v113
  v_mfma_f32_16x16x32_bf16 a[40:43], a[176:179], v[16:19], a[40:43]
  v_exp_f32 v114, v114
  v_mfma_f32_16x16x32_bf16 a[40:43], a[180:183], v[48:51], a[40:43]
  ds_read_b64_tr_b16 a[172:173], v221 offset:8192
  v_mfma_f32_16x16x32_bf16 a[44:47], a[180:183], v[56:59], a[44:47]
  s_waitcnt lgkmcnt(7)
  v_exp_f32 v115, v115
  v_mfma_f32_16x16x32_bf16 a[44:47], a[176:179], v[24:27], a[44:47]
  ds_read_b64_tr_b16 a[174:175], v221 offset:12288
  v_cvt_pk_bf16_f32 v113, v114, v115
  v_mfma_f32_16x16x32_bf16 a[48:51], a[184:187], v[0:3], a[48:51]
  v_exp_f32 v120, v120
  v_mfma_f32_16x16x32_bf16 a[48:51], a[188:191], v[32:35], a[48:51]
  ds_read_b64_tr_b16 a[176:177], v222 offset:0
  v_mfma_f32_16x16x32_bf16 a[52:55], a[188:191], v[40:43], a[52:55]
  v_exp_f32 v121, v121
  v_mfma_f32_16x16x32_bf16 a[52:55], a[184:187], v[8:11], a[52:55]
  ds_read_b64_tr_b16 a[178:179], v222 offset:4096
  v_cvt_pk_bf16_f32 v120, v120, v121
  v_mfma_f32_16x16x32_bf16 a[56:59], a[184:187], v[16:19], a[56:59]
  v_exp_f32 v122, v122
  v_mfma_f32_16x16x32_bf16 a[56:59], a[188:191], v[48:51], a[56:59]
  ds_read_b64_tr_b16 a[180:181], v222 offset:8192
  v_mfma_f32_16x16x32_bf16 a[60:63], a[188:191], v[56:59], a[60:63]
  s_waitcnt lgkmcnt(7)
  v_exp_f32 v123, v123
  v_mfma_f32_16x16x32_bf16 a[60:63], a[184:187], v[24:27], a[60:63]
  ds_read_b64_tr_b16 a[182:183], v222 offset:12288
  v_cvt_pk_bf16_f32 v121, v122, v123
  v_mfma_f32_16x16x32_bf16 a[64:67], a[160:163], v[0:3], a[64:67]
  v_exp_f32 v100, v100
  v_mfma_f32_16x16x32_bf16 a[64:67], a[164:167], v[32:35], a[64:67]
  ds_read_b64_tr_b16 a[184:185], v223 offset:0
  v_mfma_f32_16x16x32_bf16 a[68:71], a[164:167], v[40:43], a[68:71]
  v_exp_f32 v101, v101
  v_mfma_f32_16x16x32_bf16 a[68:71], a[160:163], v[8:11], a[68:71]
  ds_read_b64_tr_b16 a[186:187], v223 offset:4096
  v_cvt_pk_bf16_f32 v98, v100, v101
  v_mfma_f32_16x16x32_bf16 a[72:75], a[160:163], v[16:19], a[72:75]
  v_exp_f32 v102, v102
  v_mfma_f32_16x16x32_bf16 a[72:75], a[164:167], v[48:51], a[72:75]
  ds_read_b64_tr_b16 a[188:189], v223 offset:8192
  v_mfma_f32_16x16x32_bf16 a[76:79], a[164:167], v[56:59], a[76:79]
  s_waitcnt lgkmcnt(7)
  v_exp_f32 v103, v103
  v_mfma_f32_16x16x32_bf16 a[76:79], a[160:163], v[24:27], a[76:79]
  ds_read_b64_tr_b16 a[190:191], v223 offset:12288
  v_cvt_pk_bf16_f32 v99, v102, v103
  v_mfma_f32_16x16x32_bf16 a[80:83], a[168:171], v[0:3], a[80:83]
  s_waitcnt vmcnt(11)
  v_exp_f32 v108, v108
  v_mfma_f32_16x16x32_bf16 a[80:83], a[172:175], v[32:35], a[80:83]
  v_mfma_f32_16x16x32_bf16 a[84:87], a[172:175], v[40:43], a[84:87]
  s_barrier
  v_exp_f32 v109, v109
  v_mfma_f32_16x16x32_bf16 a[84:87], a[168:171], v[8:11], a[84:87]
  ds_read_b128 a[128:131], v212 offset:32768
  v_cvt_pk_bf16_f32 v106, v108, v109
  v_mfma_f32_16x16x32_bf16 a[88:91], a[168:171], v[16:19], a[88:91]
  v_exp_f32 v110, v110
  v_mfma_f32_16x16x32_bf16 a[88:91], a[172:175], v[48:51], a[88:91]
  ds_read_b128 a[132:135], v213 offset:32768
  buffer_atomic_add v250, v249, s[24:27], s47 offen
  s_cmp_eq_u32 s32, 3
  s_cselect_b32 s39, 0, 1073741824
  v_mfma_f32_16x16x32_bf16 a[92:95], a[172:175], v[56:59], a[92:95]
  s_waitcnt lgkmcnt(6)
  v_exp_f32 v111, v111
  v_mfma_f32_16x16x32_bf16 a[92:95], a[168:171], v[24:27], a[92:95]
  ds_read_b128 a[136:139], v214 offset:32768
  v_cvt_pk_bf16_f32 v107, v110, v111
  v_mfma_f32_16x16x32_bf16 a[96:99], a[176:179], v[0:3], a[96:99]
  v_exp_f32 v116, v116
  v_mfma_f32_16x16x32_bf16 a[96:99], a[180:183], v[32:35], a[96:99]
  ds_read_b128 a[140:143], v215 offset:32768
  v_or_b32 v249, s39, v251
  v_mfma_f32_16x16x32_bf16 a[100:103], a[180:183], v[40:43], a[100:103]
  v_exp_f32 v117, v117
  v_mfma_f32_16x16x32_bf16 a[100:103], a[176:179], v[8:11], a[100:103]
  v_cvt_pk_bf16_f32 v114, v116, v117
  v_mfma_f32_16x16x32_bf16 a[104:107], a[176:179], v[16:19], a[104:107]
  v_exp_f32 v118, v118
  v_mfma_f32_16x16x32_bf16 a[104:107], a[180:183], v[48:51], a[104:107]
  v_mfma_f32_16x16x32_bf16 a[108:111], a[180:183], v[56:59], a[108:111]
  s_waitcnt lgkmcnt(4)
  v_exp_f32 v119, v119
  v_mfma_f32_16x16x32_bf16 a[108:111], a[176:179], v[24:27], a[108:111]
  v_cvt_pk_bf16_f32 v115, v118, v119
  v_mfma_f32_16x16x32_bf16 a[112:115], a[184:187], v[0:3], a[112:115]
  v_exp_f32 v124, v124
  v_mfma_f32_16x16x32_bf16 a[112:115], a[188:191], v[32:35], a[112:115]
  v_mfma_f32_16x16x32_bf16 a[116:119], a[188:191], v[40:43], a[116:119]
  v_exp_f32 v125, v125
  v_mfma_f32_16x16x32_bf16 a[116:119], a[184:187], v[8:11], a[116:119]
  v_cvt_pk_bf16_f32 v122, v124, v125
  v_mfma_f32_16x16x32_bf16 a[120:123], a[184:187], v[16:19], a[120:123]
  v_exp_f32 v126, v126
  v_mfma_f32_16x16x32_bf16 a[120:123], a[188:191], v[48:51], a[120:123]
  v_mfma_f32_16x16x32_bf16 a[124:127], a[188:191], v[56:59], a[124:127]
  s_waitcnt lgkmcnt(0)
  v_exp_f32 v127, v127
  v_mfma_f32_16x16x32_bf16 a[124:127], a[184:187], v[24:27], a[124:127]
  v_cvt_pk_bf16_f32 v123, v126, v127
  v_mfma_f32_16x16x32_bf16 v[0:3], a[128:131], v[128:131], v[192:195]
  s_add_u32 m0, s28, 114688
  v_mfma_f32_16x16x32_bf16 v[0:3], a[132:135], v[132:135], v[0:3]
  ds_read_b128 a[144:147], v212 offset:36864
  v_mfma_f32_16x16x32_bf16 v[0:3], a[136:139], v[136:139], v[0:3]
  buffer_load_dwordx4 v236, s[16:19], s29 offen offset:0 lds
  v_mfma_f32_16x16x32_bf16 v[0:3], a[140:143], v[140:143], v[0:3]
  ds_read_b128 a[148:151], v213 offset:36864
  v_mfma_f32_16x16x32_bf16 v[8:11], a[140:143], v[156:159], v[196:199]
  v_mfma_f32_16x16x32_bf16 v[8:11], a[136:139], v[152:155], v[8:11]
  ds_read_b128 a[152:155], v214 offset:36864
  v_mfma_f32_16x16x32_bf16 v[8:11], a[132:135], v[148:151], v[8:11]
  buffer_load_dwordx4 v237, s[16:19], s29 offen offset:1024 lds
  v_mfma_f32_16x16x32_bf16 v[8:11], a[128:131], v[144:147], v[8:11]
  ds_read_b128 a[156:159], v215 offset:36864
  v_mfma_f32_16x16x32_bf16 v[16:19], a[128:131], v[160:163], v[200:203]
  v_exp_f32 v0, v0
  v_mfma_f32_16x16x32_bf16 v[16:19], a[132:135], v[164:167], v[16:19]
  v_mfma_f32_16x16x32_bf16 v[16:19], a[136:139], v[168:171], v[16:19]
  v_exp_f32 v1, v1
  v_mfma_f32_16x16x32_bf16 v[16:19], a[140:143], v[172:175], v[16:19]
  v_cvt_pk_bf16_f32 v0, v0, v1
  v_mfma_f32_16x16x32_bf16 v[24:27], a[140:143], v[188:191], v[204:207]
  v_exp_f32 v2, v2
  v_mfma_f32_16x16x32_bf16 v[24:27], a[136:139], v[184:187], v[24:27]
  buffer_load_dwordx4 v236, s[16:19], s29 offen offset:2048 lds
  v_mfma_f32_16x16x32_bf16 v[24:27], a[132:135], v[180:183], v[24:27]
  s_waitcnt lgkmcnt(0)
  v_exp_f32 v3, v3
  v_mfma_f32_16x16x32_bf16 v[24:27], a[128:131], v[176:179], v[24:27]
  v_cvt_pk_bf16_f32 v1, v2, v3
  v_mfma_f32_16x16x32_bf16 v[4:7], a[144:147], v[128:131], v[192:195]
  v_exp_f32 v8, v8
  v_mfma_f32_16x16x32_bf16 v[4:7], a[148:151], v[132:135], v[4:7]
  ds_read_b128 a[128:131], v212 offset:40960
  v_mfma_f32_16x16x32_bf16 v[4:7], a[152:155], v[136:139], v[4:7]
  v_exp_f32 v9, v9
  v_mfma_f32_16x16x32_bf16 v[4:7], a[156:159], v[140:143], v[4:7]
  ds_read_b128 a[132:135], v213 offset:40960
  v_cvt_pk_bf16_f32 v8, v8, v9
  v_mfma_f32_16x16x32_bf16 v[12:15], a[156:159], v[156:159], v[196:199]
  v_exp_f32 v10, v10
  v_mfma_f32_16x16x32_bf16 v[12:15], a[152:155], v[152:155], v[12:15]
  ds_read_b128 a[136:139], v214 offset:40960
  v_mfma_f32_16x16x32_bf16 v[12:15], a[148:151], v[148:151], v[12:15]
  v_exp_f32 v11, v11
  v_mfma_f32_16x16x32_bf16 v[12:15], a[144:147], v[144:147], v[12:15]
  ds_read_b128 a[140:143], v215 offset:40960
  v_cvt_pk_bf16_f32 v9, v10, v11
  v_mfma_f32_16x16x32_bf16 v[20:23], a[144:147], v[160:163], v[200:203]
  v_exp_f32 v16, v16
  v_mfma_f32_16x16x32_bf16 v[20:23], a[148:151], v[164:167], v[20:23]
  buffer_load_dwordx4 v237, s[16:19], s29 offen offset:3072 lds
  v_mfma_f32_16x16x32_bf16 v[20:23], a[152:155], v[168:171], v[20:23]
  s_add_u32 s29, s29, 16384
  v_exp_f32 v17, v17
  v_mfma_f32_16x16x32_bf16 v[20:23], a[156:159], v[172:175], v[20:23]
  v_cvt_pk_bf16_f32 v16, v16, v17
  v_mfma_f32_16x16x32_bf16 v[28:31], a[156:159], v[188:191], v[204:207]
  s_add_u32 m0, s28, 0
  v_exp_f32 v18, v18
  v_mfma_f32_16x16x32_bf16 v[28:31], a[152:155], v[184:187], v[28:31]
  buffer_load_dwordx4 v232, s[12:15], s29 offen offset:0 lds
  v_mfma_f32_16x16x32_bf16 v[28:31], a[148:151], v[180:183], v[28:31]
  s_waitcnt lgkmcnt(0)
  v_exp_f32 v19, v19
  v_mfma_f32_16x16x32_bf16 v[28:31], a[144:147], v[176:179], v[28:31]
  v_cvt_pk_bf16_f32 v17, v18, v19
  v_mfma_f32_16x16x32_bf16 v[32:35], a[128:131], v[128:131], v[192:195]
  v_exp_f32 v24, v24
  v_mfma_f32_16x16x32_bf16 v[32:35], a[132:135], v[132:135], v[32:35]
  ds_read_b128 a[144:147], v212 offset:45056
  v_mfma_f32_16x16x32_bf16 v[32:35], a[136:139], v[136:139], v[32:35]
  v_exp_f32 v25, v25
  v_mfma_f32_16x16x32_bf16 v[32:35], a[140:143], v[140:143], v[32:35]
  ds_read_b128 a[148:151], v213 offset:45056
  v_cvt_pk_bf16_f32 v24, v24, v25
  v_mfma_f32_16x16x32_bf16 v[40:43], a[140:143], v[156:159], v[196:199]
  v_exp_f32 v26, v26
  v_mfma_f32_16x16x32_bf16 v[40:43], a[136:139], v[152:155], v[40:43]
  ds_read_b128 a[152:155], v214 offset:45056
  v_mfma_f32_16x16x32_bf16 v[40:43], a[132:135], v[148:151], v[40:43]
  v_exp_f32 v27, v27
  v_mfma_f32_16x16x32_bf16 v[40:43], a[128:131], v[144:147], v[40:43]
  ds_read_b128 a[156:159], v215 offset:45056
  v_cvt_pk_bf16_f32 v25, v26, v27
  v_mfma_f32_16x16x32_bf16 v[48:51], a[128:131], v[160:163], v[200:203]
  v_exp_f32 v4, v4
  v_mfma_f32_16x16x32_bf16 v[48:51], a[132:135], v[164:167], v[48:51]
  buffer_load_dwordx4 v233, s[12:15], s29 offen offset:1024 lds
  v_mfma_f32_16x16x32_bf16 v[48:51], a[136:139], v[168:171], v[48:51]
  v_exp_f32 v5, v5
  v_mfma_f32_16x16x32_bf16 v[48:51], a[140:143], v[172:175], v[48:51]
  v_cvt_pk_bf16_f32 v2, v4, v5
  v_mfma_f32_16x16x32_bf16 v[56:59], a[140:143], v[188:191], v[204:207]
  v_exp_f32 v6, v6
  v_mfma_f32_16x16x32_bf16 v[56:59], a[136:139], v[184:187], v[56:59]
  buffer_load_dwordx4 v234, s[12:15], s29 offen offset:2048 lds
  v_mfma_f32_16x16x32_bf16 v[56:59], a[132:135], v[180:183], v[56:59]
  s_waitcnt lgkmcnt(0)
  v_exp_f32 v7, v7
  v_mfma_f32_16x16x32_bf16 v[56:59], a[128:131], v[176:179], v[56:59]
  v_cvt_pk_bf16_f32 v3, v6, v7
  v_mfma_f32_16x16x32_bf16 v[36:39], a[144:147], v[128:131], v[192:195]
  v_exp_f32 v12, v12
  v_mfma_f32_16x16x32_bf16 v[36:39], a[148:151], v[132:135], v[36:39]
  ds_read_b64_tr_b16 a[160:161], v216 offset:16384
  v_mfma_f32_16x16x32_bf16 v[36:39], a[152:155], v[136:139], v[36:39]
  v_exp_f32 v13, v13
  v_mfma_f32_16x16x32_bf16 v[36:39], a[156:159], v[140:143], v[36:39]
  ds_read_b64_tr_b16 a[162:163], v216 offset:20480
  v_cvt_pk_bf16_f32 v10, v12, v13
  v_mfma_f32_16x16x32_bf16 v[44:47], a[156:159], v[156:159], v[196:199]
  v_exp_f32 v14, v14
  v_mfma_f32_16x16x32_bf16 v[44:47], a[152:155], v[152:155], v[44:47]
  ds_read_b64_tr_b16 a[164:165], v216 offset:24576
  buffer_load_dwordx4 v235, s[12:15], s29 offen offset:3072 lds
  v_mfma_f32_16x16x32_bf16 v[44:47], a[148:151], v[148:151], v[44:47]
  v_exp_f32 v15, v15
  v_mfma_f32_16x16x32_bf16 v[44:47], a[144:147], v[144:147], v[44:47]
  ds_read_b64_tr_b16 a[166:167], v216 offset:28672
  v_cvt_pk_bf16_f32 v11, v14, v15
  v_mfma_f32_16x16x32_bf16 v[52:55], a[144:147], v[160:163], v[200:203]
  s_mov_b32 m0, s51
  v_exp_f32 v20, v20
  v_mfma_f32_16x16x32_bf16 v[52:55], a[148:151], v[164:167], v[52:55]
  ds_read_b64_tr_b16 a[168:169], v217 offset:16384
  buffer_load_dwordx4 v210, s[4:7], s100 offen lds
  s_add_u32 s100, s100, 20480
  s_add_u32 s51, s51, 512
  v_mfma_f32_16x16x32_bf16 v[52:55], a[152:155], v[168:171], v[52:55]
  v_exp_f32 v21, v21
  v_mfma_f32_16x16x32_bf16 v[52:55], a[156:159], v[172:175], v[52:55]
  ds_read_b64_tr_b16 a[170:171], v217 offset:20480
  v_cvt_pk_bf16_f32 v18, v20, v21
  v_mfma_f32_16x16x32_bf16 v[60:63], a[156:159], v[188:191], v[204:207]
  s_waitcnt vmcnt(20)
  v_exp_f32 v22, v22
  v_mfma_f32_16x16x32_bf16 v[60:63], a[152:155], v[184:187], v[60:63]
  ds_read_b64_tr_b16 a[172:173], v217 offset:24576
  ds_read_b64_tr_b16 a[232:233], v209 offset:4096
  v_mfma_f32_16x16x32_bf16 v[60:63], a[148:151], v[180:183], v[60:63]
  v_exp_f32 v23, v23
  v_mfma_f32_16x16x32_bf16 v[60:63], a[144:147], v[176:179], v[60:63]
  ds_read_b64_tr_b16 a[174:175], v217 offset:28672
  v_cvt_pk_bf16_f32 v19, v22, v23
  v_mfma_f32_16x16x32_bf16 a[192:195], a[208:211], v[64:67], a[192:195]
  v_exp_f32 v28, v28
  v_mfma_f32_16x16x32_bf16 a[192:195], a[208:211], v[96:99], a[192:195]
  ds_read_b64_tr_b16 a[176:177], v218 offset:16384
  ds_read_b64_tr_b16 a[234:235], v209 offset:4608
  v_mfma_f32_16x16x32_bf16 a[196:199], a[208:211], v[72:75], a[196:199]
  v_exp_f32 v29, v29
  v_mfma_f32_16x16x32_bf16 a[196:199], a[208:211], v[104:107], a[196:199]
  ds_read_b64_tr_b16 a[178:179], v218 offset:20480
  v_cvt_pk_bf16_f32 v26, v28, v29
  v_mfma_f32_16x16x32_bf16 a[200:203], a[208:211], v[80:83], a[200:203]
  v_exp_f32 v30, v30
  v_mfma_f32_16x16x32_bf16 a[200:203], a[208:211], v[112:115], a[200:203]
  ds_read_b64_tr_b16 a[180:181], v218 offset:24576
  v_mfma_f32_16x16x32_bf16 a[204:207], a[208:211], v[88:91], a[204:207]
  s_waitcnt lgkmcnt(9)
  v_exp_f32 v31, v31
  v_mfma_f32_16x16x32_bf16 a[204:207], a[208:211], v[120:123], a[204:207]
  ds_read_b64_tr_b16 a[182:183], v218 offset:28672
  v_cvt_pk_bf16_f32 v27, v30, v31
  v_mfma_f32_16x16x32_bf16 a[0:3], a[160:163], v[64:67], a[0:3]
  v_exp_f32 v32, v32
  v_mfma_f32_16x16x32_bf16 a[0:3], a[164:167], v[96:99], a[0:3]
  ds_read_b64_tr_b16 a[184:185], v219 offset:16384
  s_waitcnt lgkmcnt(4)
  buffer_store_dwordx4 a[232:235], v211, s[24:27], s31 offen sc1
  s_add_u32 s31, s31, 1024
  s_cmp_gt_u32 s32, 3
  v_mfma_f32_16x16x32_bf16 a[4:7], a[164:167], v[104:107], a[4:7]
  s_cselect_b32 s39, 0, 1073741824
  v_exp_f32 v33, v33
  v_mfma_f32_16x16x32_bf16 a[4:7], a[160:163], v[72:75], a[4:7]
  ds_read_b64_tr_b16 a[186:187], v219 offset:20480
  v_cvt_pk_bf16_f32 v32, v32, v33
  v_mfma_f32_16x16x32_bf16 a[8:11], a[160:163], v[80:83], a[8:11]
  v_exp_f32 v34, v34
  v_mfma_f32_16x16x32_bf16 a[8:11], a[164:167], v[112:115], a[8:11]
  ds_read_b64_tr_b16 a[188:189], v219 offset:24576
  v_or_b32 v211, s39, v211
  v_mfma_f32_16x16x32_bf16 a[12:15], a[164:167], v[120:123], a[12:15]
  v_exp_f32 v35, v35
  v_mfma_f32_16x16x32_bf16 a[12:15], a[160:163], v[88:91], a[12:15]
  ds_read_b64_tr_b16 a[190:191], v219 offset:28672
  v_cvt_pk_bf16_f32 v33, v34, v35
  v_mfma_f32_16x16x32_bf16 a[16:19], a[168:171], v[64:67], a[16:19]
  v_exp_f32 v40, v40
  v_mfma_f32_16x16x32_bf16 a[16:19], a[172:175], v[96:99], a[16:19]
  ds_read_b64_tr_b16 a[160:161], v220 offset:16384
  v_or_b32 v208, s39, v208
  v_mfma_f32_16x16x32_bf16 a[20:23], a[172:175], v[104:107], a[20:23]
  v_exp_f32 v41, v41
  v_mfma_f32_16x16x32_bf16 a[20:23], a[168:171], v[72:75], a[20:23]
  ds_read_b64_tr_b16 a[162:163], v220 offset:20480
  v_cvt_pk_bf16_f32 v40, v40, v41
  v_mfma_f32_16x16x32_bf16 a[24:27], a[168:171], v[80:83], a[24:27]
  v_exp_f32 v42, v42
  v_mfma_f32_16x16x32_bf16 a[24:27], a[172:175], v[112:115], a[24:27]
  ds_read_b64_tr_b16 a[164:165], v220 offset:24576
  v_mfma_f32_16x16x32_bf16 a[28:31], a[172:175], v[120:123], a[28:31]
  s_waitcnt lgkmcnt(7)
  v_exp_f32 v43, v43
  v_mfma_f32_16x16x32_bf16 a[28:31], a[168:171], v[88:91], a[28:31]
  ds_read_b64_tr_b16 a[166:167], v220 offset:28672
  v_cvt_pk_bf16_f32 v41, v42, v43
  v_mfma_f32_16x16x32_bf16 a[32:35], a[176:179], v[64:67], a[32:35]
  v_exp_f32 v48, v48
  v_mfma_f32_16x16x32_bf16 a[32:35], a[180:183], v[96:99], a[32:35]
  ds_read_b64_tr_b16 a[168:169], v221 offset:16384
  v_mfma_f32_16x16x32_bf16 a[36:39], a[180:183], v[104:107], a[36:39]
  v_exp_f32 v49, v49
  v_mfma_f32_16x16x32_bf16 a[36:39], a[176:179], v[72:75], a[36:39]
  ds_read_b64_tr_b16 a[170:171], v221 offset:20480
  v_cvt_pk_bf16_f32 v48, v48, v49
  v_mfma_f32_16x16x32_bf16 a[40:43], a[176:179], v[80:83], a[40:43]
  v_exp_f32 v50, v50
  v_mfma_f32_16x16x32_bf16 a[40:43], a[180:183], v[112:115], a[40:43]
  ds_read_b64_tr_b16 a[172:173], v221 offset:24576
  v_mfma_f32_16x16x32_bf16 a[44:47], a[180:183], v[120:123], a[44:47]
  s_waitcnt lgkmcnt(7)
  v_exp_f32 v51, v51
  v_mfma_f32_16x16x32_bf16 a[44:47], a[176:179], v[88:91], a[44:47]
  ds_read_b64_tr_b16 a[174:175], v221 offset:28672
  v_cvt_pk_bf16_f32 v49, v50, v51
  v_mfma_f32_16x16x32_bf16 a[48:51], a[184:187], v[64:67], a[48:51]
  v_exp_f32 v56, v56
  v_mfma_f32_16x16x32_bf16 a[48:51], a[188:191], v[96:99], a[48:51]
  ds_read_b64_tr_b16 a[176:177], v222 offset:16384
  v_mfma_f32_16x16x32_bf16 a[52:55], a[188:191], v[104:107], a[52:55]
  v_exp_f32 v57, v57
  v_mfma_f32_16x16x32_bf16 a[52:55], a[184:187], v[72:75], a[52:55]
  ds_read_b64_tr_b16 a[178:179], v222 offset:20480
  v_cvt_pk_bf16_f32 v56, v56, v57
  v_mfma_f32_16x16x32_bf16 a[56:59], a[184:187], v[80:83], a[56:59]
  v_exp_f32 v58, v58
  v_mfma_f32_16x16x32_bf16 a[56:59], a[188:191], v[112:115], a[56:59]
  ds_read_b64_tr_b16 a[180:181], v222 offset:24576
  v_mfma_f32_16x16x32_bf16 a[60:63], a[188:191], v[120:123], a[60:63]
  s_waitcnt lgkmcnt(7)
  v_exp_f32 v59, v59
  v_mfma_f32_16x16x32_bf16 a[60:63], a[184:187], v[88:91], a[60:63]
  ds_read_b64_tr_b16 a[182:183], v222 offset:28672
  v_cvt_pk_bf16_f32 v57, v58, v59
  v_mfma_f32_16x16x32_bf16 a[64:67], a[160:163], v[64:67], a[64:67]
  v_exp_f32 v36, v36
  v_mfma_f32_16x16x32_bf16 a[64:67], a[164:167], v[96:99], a[64:67]
  ds_read_b64_tr_b16 a[184:185], v223 offset:16384
  v_mfma_f32_16x16x32_bf16 a[68:71], a[164:167], v[104:107], a[68:71]
  v_exp_f32 v37, v37
  v_mfma_f32_16x16x32_bf16 a[68:71], a[160:163], v[72:75], a[68:71]
  ds_read_b64_tr_b16 a[186:187], v223 offset:20480
  v_cvt_pk_bf16_f32 v34, v36, v37
  v_mfma_f32_16x16x32_bf16 a[72:75], a[160:163], v[80:83], a[72:75]
  v_exp_f32 v38, v38
  v_mfma_f32_16x16x32_bf16 a[72:75], a[164:167], v[112:115], a[72:75]
  ds_read_b64_tr_b16 a[188:189], v223 offset:24576
  v_mfma_f32_16x16x32_bf16 a[76:79], a[164:167], v[120:123], a[76:79]
  s_waitcnt lgkmcnt(7)
  v_exp_f32 v39, v39
  v_mfma_f32_16x16x32_bf16 a[76:79], a[160:163], v[88:91], a[76:79]
  ds_read_b64_tr_b16 a[190:191], v223 offset:28672
  v_cvt_pk_bf16_f32 v35, v38, v39
  v_mfma_f32_16x16x32_bf16 a[80:83], a[168:171], v[64:67], a[80:83]
  s_waitcnt vmcnt(12)
  v_exp_f32 v44, v44
  v_mfma_f32_16x16x32_bf16 a[80:83], a[172:175], v[96:99], a[80:83]
  v_mfma_f32_16x16x32_bf16 a[84:87], a[172:175], v[104:107], a[84:87]
  s_barrier
  v_exp_f32 v45, v45
  v_mfma_f32_16x16x32_bf16 a[84:87], a[168:171], v[72:75], a[84:87]
  ds_read_b128 a[128:131], v212 offset:49152
  v_cvt_pk_bf16_f32 v42, v44, v45
  v_mfma_f32_16x16x32_bf16 a[88:91], a[168:171], v[80:83], a[88:91]
  v_exp_f32 v46, v46
  v_mfma_f32_16x16x32_bf16 a[88:91], a[172:175], v[112:115], a[88:91]
  ds_read_b128 a[132:135], v213 offset:49152
  v_mfma_f32_16x16x32_bf16 a[92:95], a[172:175], v[120:123], a[92:95]
  s_waitcnt lgkmcnt(6)
  v_exp_f32 v47, v47
  v_mfma_f32_16x16x32_bf16 a[92:95], a[168:171], v[88:91], a[92:95]
  ds_read_b128 a[136:139], v214 offset:49152
  v_cvt_pk_bf16_f32 v43, v46, v47
  v_mfma_f32_16x16x32_bf16 a[96:99], a[176:179], v[64:67], a[96:99]
  v_exp_f32 v52, v52
  v_mfma_f32_16x16x32_bf16 a[96:99], a[180:183], v[96:99], a[96:99]
  ds_read_b128 a[140:143], v215 offset:49152
  v_mfma_f32_16x16x32_bf16 a[100:103], a[180:183], v[104:107], a[100:103]
  v_exp_f32 v53, v53
  v_mfma_f32_16x16x32_bf16 a[100:103], a[176:179], v[72:75], a[100:103]
  v_cvt_pk_bf16_f32 v50, v52, v53
  v_mfma_f32_16x16x32_bf16 a[104:107], a[176:179], v[80:83], a[104:107]
  v_exp_f32 v54, v54
  v_mfma_f32_16x16x32_bf16 a[104:107], a[180:183], v[112:115], a[104:107]
  v_mfma_f32_16x16x32_bf16 a[108:111], a[180:183], v[120:123], a[108:111]
  s_waitcnt lgkmcnt(4)
  v_exp_f32 v55, v55
  v_mfma_f32_16x16x32_bf16 a[108:111], a[176:179], v[88:91], a[108:111]
  v_cvt_pk_bf16_f32 v51, v54, v55
  v_mfma_f32_16x16x32_bf16 a[112:115], a[184:187], v[64:67], a[112:115]
  v_exp_f32 v60, v60
  v_mfma_f32_16x16x32_bf16 a[112:115], a[188:191], v[96:99], a[112:115]
  v_mfma_f32_16x16x32_bf16 a[116:119], a[188:191], v[104:107], a[116:119]
  v_exp_f32 v61, v61
  v_mfma_f32_16x16x32_bf16 a[116:119], a[184:187], v[72:75], a[116:119]
  v_cvt_pk_bf16_f32 v58, v60, v61
  v_mfma_f32_16x16x32_bf16 a[120:123], a[184:187], v[80:83], a[120:123]
  v_exp_f32 v62, v62
  v_mfma_f32_16x16x32_bf16 a[120:123], a[188:191], v[112:115], a[120:123]
  v_mfma_f32_16x16x32_bf16 a[124:127], a[188:191], v[120:123], a[124:127]
  s_waitcnt lgkmcnt(0)
  v_exp_f32 v63, v63
  v_mfma_f32_16x16x32_bf16 a[124:127], a[184:187], v[88:91], a[124:127]
  v_cvt_pk_bf16_f32 v59, v62, v63
  v_mfma_f32_16x16x32_bf16 v[64:67], a[128:131], v[128:131], v[192:195]
  s_add_u32 m0, s28, 65536
  v_mfma_f32_16x16x32_bf16 v[64:67], a[132:135], v[132:135], v[64:67]
  ds_read_b128 a[144:147], v212 offset:53248
  v_mfma_f32_16x16x32_bf16 v[64:67], a[136:139], v[136:139], v[64:67]
  buffer_load_dwordx4 v236, s[16:19], s29 offen offset:0 lds
  v_mfma_f32_16x16x32_bf16 v[64:67], a[140:143], v[140:143], v[64:67]
  ds_read_b128 a[148:151], v213 offset:53248
  v_mfma_f32_16x16x32_bf16 v[72:75], a[140:143], v[156:159], v[196:199]
  v_mfma_f32_16x16x32_bf16 v[72:75], a[136:139], v[152:155], v[72:75]
  ds_read_b128 a[152:155], v214 offset:53248
  v_mfma_f32_16x16x32_bf16 v[72:75], a[132:135], v[148:151], v[72:75]
  buffer_load_dwordx4 v237, s[16:19], s29 offen offset:1024 lds
  v_mfma_f32_16x16x32_bf16 v[72:75], a[128:131], v[144:147], v[72:75]
  ds_read_b128 a[156:159], v215 offset:53248
  v_mfma_f32_16x16x32_bf16 v[80:83], a[128:131], v[160:163], v[200:203]
  v_exp_f32 v64, v64
  v_mfma_f32_16x16x32_bf16 v[80:83], a[132:135], v[164:167], v[80:83]
  v_mfma_f32_16x16x32_bf16 v[80:83], a[136:139], v[168:171], v[80:83]
  v_exp_f32 v65, v65
  v_mfma_f32_16x16x32_bf16 v[80:83], a[140:143], v[172:175], v[80:83]
  v_cvt_pk_bf16_f32 v64, v64, v65
  v_mfma_f32_16x16x32_bf16 v[88:91], a[140:143], v[188:191], v[204:207]
  v_exp_f32 v66, v66
  v_mfma_f32_16x16x32_bf16 v[88:91], a[136:139], v[184:187], v[88:91]
  buffer_load_dwordx4 v236, s[16:19], s29 offen offset:2048 lds
  v_mfma_f32_16x16x32_bf16 v[88:91], a[132:135], v[180:183], v[88:91]
  s_waitcnt lgkmcnt(0)
  v_exp_f32 v67, v67
  v_mfma_f32_16x16x32_bf16 v[88:91], a[128:131], v[176:179], v[88:91]
  v_cvt_pk_bf16_f32 v65, v66, v67
  v_mfma_f32_16x16x32_bf16 v[68:71], a[144:147], v[128:131], v[192:195]
  v_exp_f32 v72, v72
  v_mfma_f32_16x16x32_bf16 v[68:71], a[148:151], v[132:135], v[68:71]
  ds_read_b128 a[128:131], v212 offset:57344
  v_mfma_f32_16x16x32_bf16 v[68:71], a[152:155], v[136:139], v[68:71]
  v_exp_f32 v73, v73
  v_mfma_f32_16x16x32_bf16 v[68:71], a[156:159], v[140:143], v[68:71]
  ds_read_b128 a[132:135], v213 offset:57344
  v_cvt_pk_bf16_f32 v72, v72, v73
  v_mfma_f32_16x16x32_bf16 v[76:79], a[156:159], v[156:159], v[196:199]
  v_exp_f32 v74, v74
  v_mfma_f32_16x16x32_bf16 v[76:79], a[152:155], v[152:155], v[76:79]
  ds_read_b128 a[136:139], v214 offset:57344
  v_mfma_f32_16x16x32_bf16 v[76:79], a[148:151], v[148:151], v[76:79]
  v_exp_f32 v75, v75
  v_mfma_f32_16x16x32_bf16 v[76:79], a[144:147], v[144:147], v[76:79]
  ds_read_b128 a[140:143], v215 offset:57344
  v_cvt_pk_bf16_f32 v73, v74, v75
  v_mfma_f32_16x16x32_bf16 v[84:87], a[144:147], v[160:163], v[200:203]
  v_exp_f32 v80, v80
  v_mfma_f32_16x16x32_bf16 v[84:87], a[148:151], v[164:167], v[84:87]
  buffer_load_dwordx4 v237, s[16:19], s29 offen offset:3072 lds
  v_mfma_f32_16x16x32_bf16 v[84:87], a[152:155], v[168:171], v[84:87]
  s_add_u32 s29, s29, 16384
  v_exp_f32 v81, v81
  v_mfma_f32_16x16x32_bf16 v[84:87], a[156:159], v[172:175], v[84:87]
  v_cvt_pk_bf16_f32 v80, v80, v81
  v_mfma_f32_16x16x32_bf16 v[92:95], a[156:159], v[188:191], v[204:207]
  s_add_u32 m0, s28, 16384
  v_exp_f32 v82, v82
  v_mfma_f32_16x16x32_bf16 v[92:95], a[152:155], v[184:187], v[92:95]
  buffer_load_dwordx4 v232, s[12:15], s29 offen offset:0 lds
  v_mfma_f32_16x16x32_bf16 v[92:95], a[148:151], v[180:183], v[92:95]
  s_waitcnt lgkmcnt(0)
  v_exp_f32 v83, v83
  v_mfma_f32_16x16x32_bf16 v[92:95], a[144:147], v[176:179], v[92:95]
  v_cvt_pk_bf16_f32 v81, v82, v83
  v_mfma_f32_16x16x32_bf16 v[96:99], a[128:131], v[128:131], v[192:195]
  v_exp_f32 v88, v88
  v_mfma_f32_16x16x32_bf16 v[96:99], a[132:135], v[132:135], v[96:99]
  ds_read_b128 a[144:147], v212 offset:61440
  v_mfma_f32_16x16x32_bf16 v[96:99], a[136:139], v[136:139], v[96:99]
  v_exp_f32 v89, v89
  v_mfma_f32_16x16x32_bf16 v[96:99], a[140:143], v[140:143], v[96:99]
  ds_read_b128 a[148:151], v213 offset:61440
  v_cvt_pk_bf16_f32 v88, v88, v89
  v_mfma_f32_16x16x32_bf16 v[104:107], a[140:143], v[156:159], v[196:199]
  v_exp_f32 v90, v90
  v_mfma_f32_16x16x32_bf16 v[104:107], a[136:139], v[152:155], v[104:107]
  ds_read_b128 a[152:155], v214 offset:61440
  v_mfma_f32_16x16x32_bf16 v[104:107], a[132:135], v[148:151], v[104:107]
  v_exp_f32 v91, v91
  v_mfma_f32_16x16x32_bf16 v[104:107], a[128:131], v[144:147], v[104:107]
  ds_read_b128 a[156:159], v215 offset:61440
  v_cvt_pk_bf16_f32 v89, v90, v91
  v_mfma_f32_16x16x32_bf16 v[112:115], a[128:131], v[160:163], v[200:203]
  v_exp_f32 v68, v68
  v_mfma_f32_16x16x32_bf16 v[112:115], a[132:135], v[164:167], v[112:115]
  buffer_load_dwordx4 v233, s[12:15], s29 offen offset:1024 lds
  v_mfma_f32_16x16x32_bf16 v[112:115], a[136:139], v[168:171], v[112:115]
  v_exp_f32 v69, v69
  v_mfma_f32_16x16x32_bf16 v[112:115], a[140:143], v[172:175], v[112:115]
  v_cvt_pk_bf16_f32 v66, v68, v69
  v_mfma_f32_16x16x32_bf16 v[120:123], a[140:143], v[188:191], v[204:207]
  v_exp_f32 v70, v70
  v_mfma_f32_16x16x32_bf16 v[120:123], a[136:139], v[184:187], v[120:123]
  buffer_load_dwordx4 v234, s[12:15], s29 offen offset:2048 lds
  v_mfma_f32_16x16x32_bf16 v[120:123], a[132:135], v[180:183], v[120:123]
  s_waitcnt lgkmcnt(0)
  v_exp_f32 v71, v71
  v_mfma_f32_16x16x32_bf16 v[120:123], a[128:131], v[176:179], v[120:123]
  v_cvt_pk_bf16_f32 v67, v70, v71
  v_mfma_f32_16x16x32_bf16 v[100:103], a[144:147], v[128:131], v[192:195]
  v_exp_f32 v76, v76
  v_mfma_f32_16x16x32_bf16 v[100:103], a[148:151], v[132:135], v[100:103]
  ds_read_b64_tr_b16 a[160:161], v216 offset:32768
  v_mfma_f32_16x16x32_bf16 v[100:103], a[152:155], v[136:139], v[100:103]
  v_exp_f32 v77, v77
  v_mfma_f32_16x16x32_bf16 v[100:103], a[156:159], v[140:143], v[100:103]
  ds_read_b64_tr_b16 a[162:163], v216 offset:36864
  v_cvt_pk_bf16_f32 v74, v76, v77
  v_mfma_f32_16x16x32_bf16 v[108:111], a[156:159], v[156:159], v[196:199]
  v_exp_f32 v78, v78
  v_mfma_f32_16x16x32_bf16 v[108:111], a[152:155], v[152:155], v[108:111]
  ds_read_b64_tr_b16 a[164:165], v216 offset:40960
  buffer_load_dwordx4 v235, s[12:15], s29 offen offset:3072 lds
  v_mfma_f32_16x16x32_bf16 v[108:111], a[148:151], v[148:151], v[108:111]
  v_exp_f32 v79, v79
  v_mfma_f32_16x16x32_bf16 v[108:111], a[144:147], v[144:147], v[108:111]
  ds_read_b64_tr_b16 a[166:167], v216 offset:45056
  v_cvt_pk_bf16_f32 v75, v78, v79
  v_mfma_f32_16x16x32_bf16 v[116:119], a[144:147], v[160:163], v[200:203]
  v_exp_f32 v84, v84
  v_mfma_f32_16x16x32_bf16 v[116:119], a[148:151], v[164:167], v[116:119]
  ds_read_b64_tr_b16 a[168:169], v217 offset:32768
  buffer_load_dword v254, off, s[24:27], s47 sc1
  v_mfma_f32_16x16x32_bf16 v[116:119], a[152:155], v[168:171], v[116:119]
  v_exp_f32 v85, v85
  v_mfma_f32_16x16x32_bf16 v[116:119], a[156:159], v[172:175], v[116:119]
  ds_read_b64_tr_b16 a[170:171], v217 offset:36864
  v_cvt_pk_bf16_f32 v82, v84, v85
  v_mfma_f32_16x16x32_bf16 v[124:127], a[156:159], v[188:191], v[204:207]
  s_waitcnt vmcnt(20)
  v_exp_f32 v86, v86
  v_mfma_f32_16x16x32_bf16 v[124:127], a[152:155], v[184:187], v[124:127]
  ds_read_b64_tr_b16 a[172:173], v217 offset:40960
  ds_read_b64_tr_b16 a[232:233], v209 offset:5120
  v_mfma_f32_16x16x32_bf16 v[124:127], a[148:151], v[180:183], v[124:127]
  v_exp_f32 v87, v87
  v_mfma_f32_16x16x32_bf16 v[124:127], a[144:147], v[176:179], v[124:127]
  ds_read_b64_tr_b16 a[174:175], v217 offset:45056
  v_cvt_pk_bf16_f32 v83, v86, v87
  v_mfma_f32_16x16x32_bf16 a[192:195], a[208:211], v[0:3], a[192:195]
  v_exp_f32 v92, v92
  v_mfma_f32_16x16x32_bf16 a[192:195], a[208:211], v[32:35], a[192:195]
  ds_read_b64_tr_b16 a[176:177], v218 offset:32768
  ds_read_b64_tr_b16 a[234:235], v209 offset:5632
  v_mfma_f32_16x16x32_bf16 a[196:199], a[208:211], v[8:11], a[196:199]
  v_exp_f32 v93, v93
  v_mfma_f32_16x16x32_bf16 a[196:199], a[208:211], v[40:43], a[196:199]
  ds_read_b64_tr_b16 a[178:179], v218 offset:36864
  v_cvt_pk_bf16_f32 v90, v92, v93
  v_mfma_f32_16x16x32_bf16 a[200:203], a[208:211], v[16:19], a[200:203]
  v_exp_f32 v94, v94
  v_mfma_f32_16x16x32_bf16 a[200:203], a[208:211], v[48:51], a[200:203]
  ds_read_b64_tr_b16 a[180:181], v218 offset:40960
  v_mfma_f32_16x16x32_bf16 a[204:207], a[208:211], v[24:27], a[204:207]
  s_waitcnt lgkmcnt(9)
  v_exp_f32 v95, v95
  v_mfma_f32_16x16x32_bf16 a[204:207], a[208:211], v[56:59], a[204:207]
  ds_read_b64_tr_b16 a[182:183], v218 offset:45056
  v_cvt_pk_bf16_f32 v91, v94, v95
  v_mfma_f32_16x16x32_bf16 a[0:3], a[160:163], v[0:3], a[0:3]
  v_exp_f32 v96, v96
  v_mfma_f32_16x16x32_bf16 a[0:3], a[164:167], v[32:35], a[0:3]
  ds_read_b64_tr_b16 a[184:185], v219 offset:32768
  s_waitcnt lgkmcnt(4)
  buffer_store_dwordx4 a[232:235], v211, s[24:27], s31 offen sc1
  s_add_u32 s31, s31, 1024
  v_mfma_f32_16x16x32_bf16 a[4:7], a[164:167], v[40:43], a[4:7]
  v_exp_f32 v97, v97
  v_mfma_f32_16x16x32_bf16 a[4:7], a[160:163], v[8:11], a[4:7]
  ds_read_b64_tr_b16 a[186:187], v219 offset:36864
  v_cvt_pk_bf16_f32 v96, v96, v97
  v_mfma_f32_16x16x32_bf16 a[8:11], a[160:163], v[16:19], a[8:11]
  v_exp_f32 v98, v98
  v_mfma_f32_16x16x32_bf16 a[8:11], a[164:167], v[48:51], a[8:11]
  ds_read_b64_tr_b16 a[188:189], v219 offset:40960
  v_mfma_f32_16x16x32_bf16 a[12:15], a[164:167], v[56:59], a[12:15]
  v_exp_f32 v99, v99
  v_mfma_f32_16x16x32_bf16 a[12:15], a[160:163], v[24:27], a[12:15]
  ds_read_b64_tr_b16 a[190:191], v219 offset:45056
  v_cvt_pk_bf16_f32 v97, v98, v99
  v_mfma_f32_16x16x32_bf16 a[16:19], a[168:171], v[0:3], a[16:19]
  v_exp_f32 v104, v104
  v_mfma_f32_16x16x32_bf16 a[16:19], a[172:175], v[32:35], a[16:19]
  ds_read_b64_tr_b16 a[160:161], v220 offset:32768
  v_mfma_f32_16x16x32_bf16 a[20:23], a[172:175], v[40:43], a[20:23]
  v_exp_f32 v105, v105
  v_mfma_f32_16x16x32_bf16 a[20:23], a[168:171], v[8:11], a[20:23]
  ds_read_b64_tr_b16 a[162:163], v220 offset:36864
  v_cvt_pk_bf16_f32 v104, v104, v105
  v_mfma_f32_16x16x32_bf16 a[24:27], a[168:171], v[16:19], a[24:27]
  v_exp_f32 v106, v106
  v_mfma_f32_16x16x32_bf16 a[24:27], a[172:175], v[48:51], a[24:27]
  ds_read_b64_tr_b16 a[164:165], v220 offset:40960
  v_mfma_f32_16x16x32_bf16 a[28:31], a[172:175], v[56:59], a[28:31]
  s_waitcnt lgkmcnt(7)
  v_exp_f32 v107, v107
  v_mfma_f32_16x16x32_bf16 a[28:31], a[168:171], v[24:27], a[28:31]
  ds_read_b64_tr_b16 a[166:167], v220 offset:45056
  v_cvt_pk_bf16_f32 v105, v106, v107
  v_mfma_f32_16x16x32_bf16 a[32:35], a[176:179], v[0:3], a[32:35]
  v_exp_f32 v112, v112
  v_mfma_f32_16x16x32_bf16 a[32:35], a[180:183], v[32:35], a[32:35]
  ds_read_b64_tr_b16 a[168:169], v221 offset:32768
  v_mfma_f32_16x16x32_bf16 a[36:39], a[180:183], v[40:43], a[36:39]
  v_exp_f32 v113, v113
  v_mfma_f32_16x16x32_bf16 a[36:39], a[176:179], v[8:11], a[36:39]
  ds_read_b64_tr_b16 a[170:171], v221 offset:36864
  v_cvt_pk_bf16_f32 v112, v112, v113
  v_mfma_f32_16x16x32_bf16 a[40:43], a[176:179], v[16:19], a[40:43]
  v_exp_f32 v114, v114
  v_mfma_f32_16x16x32_bf16 a[40:43], a[180:183], v[48:51], a[40:43]
  ds_read_b64_tr_b16 a[172:173], v221 offset:40960
  v_mfma_f32_16x16x32_bf16 a[44:47], a[180:183], v[56:59], a[44:47]
  s_waitcnt lgkmcnt(7)
  v_exp_f32 v115, v115
  v_mfma_f32_16x16x32_bf16 a[44:47], a[176:179], v[24:27], a[44:47]
  ds_read_b64_tr_b16 a[174:175], v221 offset:45056
  v_cvt_pk_bf16_f32 v113, v114, v115
  v_mfma_f32_16x16x32_bf16 a[48:51], a[184:187], v[0:3], a[48:51]
  v_exp_f32 v120, v120
  v_mfma_f32_16x16x32_bf16 a[48:51], a[188:191], v[32:35], a[48:51]
  ds_read_b64_tr_b16 a[176:177], v222 offset:32768
  v_mfma_f32_16x16x32_bf16 a[52:55], a[188:191], v[40:43], a[52:55]
  v_exp_f32 v121, v121
  v_mfma_f32_16x16x32_bf16 a[52:55], a[184:187], v[8:11], a[52:55]
  ds_read_b64_tr_b16 a[178:179], v222 offset:36864
  v_cvt_pk_bf16_f32 v120, v120, v121
  v_mfma_f32_16x16x32_bf16 a[56:59], a[184:187], v[16:19], a[56:59]
  v_exp_f32 v122, v122
  v_mfma_f32_16x16x32_bf16 a[56:59], a[188:191], v[48:51], a[56:59]
  ds_read_b64_tr_b16 a[180:181], v222 offset:40960
  v_mfma_f32_16x16x32_bf16 a[60:63], a[188:191], v[56:59], a[60:63]
  s_waitcnt lgkmcnt(7)
  v_exp_f32 v123, v123
  v_mfma_f32_16x16x32_bf16 a[60:63], a[184:187], v[24:27], a[60:63]
  ds_read_b64_tr_b16 a[182:183], v222 offset:45056
  v_cvt_pk_bf16_f32 v121, v122, v123
  v_mfma_f32_16x16x32_bf16 a[64:67], a[160:163], v[0:3], a[64:67]
  v_exp_f32 v100, v100
  v_mfma_f32_16x16x32_bf16 a[64:67], a[164:167], v[32:35], a[64:67]
  ds_read_b64_tr_b16 a[184:185], v223 offset:32768
  v_mfma_f32_16x16x32_bf16 a[68:71], a[164:167], v[40:43], a[68:71]
  v_exp_f32 v101, v101
  v_mfma_f32_16x16x32_bf16 a[68:71], a[160:163], v[8:11], a[68:71]
  ds_read_b64_tr_b16 a[186:187], v223 offset:36864
  v_cvt_pk_bf16_f32 v98, v100, v101
  v_mfma_f32_16x16x32_bf16 a[72:75], a[160:163], v[16:19], a[72:75]
  v_exp_f32 v102, v102
  v_mfma_f32_16x16x32_bf16 a[72:75], a[164:167], v[48:51], a[72:75]
  ds_read_b64_tr_b16 a[188:189], v223 offset:40960
  v_mfma_f32_16x16x32_bf16 a[76:79], a[164:167], v[56:59], a[76:79]
  s_waitcnt lgkmcnt(7)
  v_exp_f32 v103, v103
  v_mfma_f32_16x16x32_bf16 a[76:79], a[160:163], v[24:27], a[76:79]
  ds_read_b64_tr_b16 a[190:191], v223 offset:45056
  v_cvt_pk_bf16_f32 v99, v102, v103
  v_mfma_f32_16x16x32_bf16 a[80:83], a[168:171], v[0:3], a[80:83]
  s_waitcnt vmcnt(12)
  v_exp_f32 v108, v108
  v_mfma_f32_16x16x32_bf16 a[80:83], a[172:175], v[32:35], a[80:83]
  v_mfma_f32_16x16x32_bf16 a[84:87], a[172:175], v[40:43], a[84:87]
  s_barrier
  v_exp_f32 v109, v109
  v_mfma_f32_16x16x32_bf16 a[84:87], a[168:171], v[8:11], a[84:87]
  ds_read_b128 a[128:131], v212 offset:0
  v_cvt_pk_bf16_f32 v106, v108, v109
  v_mfma_f32_16x16x32_bf16 a[88:91], a[168:171], v[16:19], a[88:91]
  v_exp_f32 v110, v110
  v_mfma_f32_16x16x32_bf16 a[88:91], a[172:175], v[48:51], a[88:91]
  ds_read_b128 a[132:135], v213 offset:0
  v_mfma_f32_16x16x32_bf16 a[92:95], a[172:175], v[56:59], a[92:95]
  s_waitcnt lgkmcnt(6)
  v_exp_f32 v111, v111
  v_mfma_f32_16x16x32_bf16 a[92:95], a[168:171], v[24:27], a[92:95]
  ds_read_b128 a[136:139], v214 offset:0
  v_cvt_pk_bf16_f32 v107, v110, v111
  v_mfma_f32_16x16x32_bf16 a[96:99], a[176:179], v[0:3], a[96:99]
  v_exp_f32 v116, v116
  v_mfma_f32_16x16x32_bf16 a[96:99], a[180:183], v[32:35], a[96:99]
  ds_read_b128 a[140:143], v215 offset:0
  v_mfma_f32_16x16x32_bf16 a[100:103], a[180:183], v[40:43], a[100:103]
  v_exp_f32 v117, v117
  v_mfma_f32_16x16x32_bf16 a[100:103], a[176:179], v[8:11], a[100:103]
  v_cvt_pk_bf16_f32 v114, v116, v117
  v_mfma_f32_16x16x32_bf16 a[104:107], a[176:179], v[16:19], a[104:107]
  v_exp_f32 v118, v118
  v_mfma_f32_16x16x32_bf16 a[104:107], a[180:183], v[48:51], a[104:107]
  v_mfma_f32_16x16x32_bf16 a[108:111], a[180:183], v[56:59], a[108:111]
  s_waitcnt lgkmcnt(4)
  v_exp_f32 v119, v119
  v_mfma_f32_16x16x32_bf16 a[108:111], a[176:179], v[24:27], a[108:111]
  v_cvt_pk_bf16_f32 v115, v118, v119
  v_mfma_f32_16x16x32_bf16 a[112:115], a[184:187], v[0:3], a[112:115]
  v_exp_f32 v124, v124
  v_mfma_f32_16x16x32_bf16 a[112:115], a[188:191], v[32:35], a[112:115]
  v_mfma_f32_16x16x32_bf16 a[116:119], a[188:191], v[40:43], a[116:119]
  s_sub_u32 s32, s32, 1
  v_exp_f32 v125, v125
  v_mfma_f32_16x16x32_bf16 a[116:119], a[184:187], v[8:11], a[116:119]
  v_cvt_pk_bf16_f32 v122, v124, v125
  v_mfma_f32_16x16x32_bf16 a[120:123], a[184:187], v[16:19], a[120:123]
  s_cmp_lg_u32 s32, 0
  v_exp_f32 v126, v126
  v_mfma_f32_16x16x32_bf16 a[120:123], a[188:191], v[48:51], a[120:123]
  v_mfma_f32_16x16x32_bf16 a[124:127], a[188:191], v[56:59], a[124:127]
  s_waitcnt lgkmcnt(0)
  v_exp_f32 v127, v127
  v_mfma_f32_16x16x32_bf16 a[124:127], a[184:187], v[24:27], a[124:127]
  v_cvt_pk_bf16_f32 v123, v126, v127
  s_cbranch_scc1 attn_loop
  s_waitcnt vmcnt(1)
  v_readfirstlane_b32 s38, v254
  s_nop 0
  s_cmp_ge_u32 s38, 512
  s_cbranch_scc1 attn_h_ready
  s_mov_b32 s39, 32768
attn_spin:
  s_sleep 4
  buffer_load_dword v254, off, s[24:27], s47 sc1
  s_waitcnt vmcnt(0)
  v_readfirstlane_b32 s38, v254
  s_nop 0
  s_cmp_ge_u32 s38, 512
  s_cbranch_scc1 attn_h_ready
  s_sub_u32 s39, s39, 1
  s_cmp_lg_u32 s39, 0
  s_cbranch_scc1 attn_spin
attn_h_ready:
  v_mfma_f32_16x16x32_bf16 v[0:3], a[128:131], v[128:131], v[192:195]
  s_add_u32 m0, s28, 81920
  s_and_b32 s38, s2, 1
  s_lshl_b32 s38, s38, 2
  v_lshrrev_b32 v224, 4, v242
  v_and_b32 v225, 7, v224
  v_mfma_f32_16x16x32_bf16 v[0:3], a[132:135], v[132:135], v[0:3]
  ds_read_b128 a[144:147], v212 offset:4096
  s_add_u32 s38, s38, s3
  s_mul_i32 s38, s38, 81920
  s_lshr_b32 s39, s2, 5
  v_mul_u32_u24 v225, 0xd80, v225
  v_mfma_f32_16x16x32_bf16 v[0:3], a[136:139], v[136:139], v[0:3]
  buffer_load_dwordx4 v236, s[16:19], s29 offen offset:0 lds
  s_mul_i32 s39, s39, 655360
  s_add_u32 s38, s38, s39
  s_add_u32 s4, s38, 3145728
  v_mfma_f32_16x16x32_bf16 v[0:3], a[140:143], v[140:143], v[0:3]
  ds_read_b128 a[148:151], v213 offset:4096
  s_add_u32 s5, s4, 12288
  s_add_u32 s6, s4, 24576
  s_add_u32 s7, s4, 36864
  v_lshrrev_b32 v224, 4, v224
  v_mfma_f32_16x16x32_bf16 v[8:11], a[140:143], v[156:159], v[196:199]
  s_add_u32 s8, s4, 49152
  s_add_u32 s9, s4, 61440
  s_add_u32 s10, s4, 73728
  v_lshl_add_u32 v225, v224, 4, v225
  v_add_u32 v252, 4096, v242
  v_mfma_f32_16x16x32_bf16 v[8:11], a[136:139], v[152:155], v[8:11]
  ds_read_b128 a[152:155], v214 offset:4096
  buffer_load_dwordx4 a[212:215], v225, s[24:27], s101 offen offset:0 sc1
  v_mfma_f32_16x16x32_bf16 v[8:11], a[132:135], v[148:151], v[8:11]
  buffer_load_dwordx4 v237, s[16:19], s29 offen offset:1024 lds
  v_mfma_f32_16x16x32_bf16 v[8:11], a[128:131], v[144:147], v[8:11]
  ds_read_b128 a[156:159], v215 offset:4096
  buffer_load_dwordx4 a[216:219], v225, s[24:27], s101 offen offset:64 sc1
  v_mfma_f32_16x16x32_bf16 v[16:19], a[128:131], v[160:163], v[200:203]
  v_exp_f32 v0, v0
  v_mfma_f32_16x16x32_bf16 v[16:19], a[132:135], v[164:167], v[16:19]
  buffer_load_dwordx4 a[220:223], v225, s[24:27], s101 offen offset:128 sc1
  v_mfma_f32_16x16x32_bf16 v[16:19], a[136:139], v[168:171], v[16:19]
  v_exp_f32 v1, v1
  v_mfma_f32_16x16x32_bf16 v[16:19], a[140:143], v[172:175], v[16:19]
  v_cvt_pk_bf16_f32 v0, v0, v1
  v_add_u32 v253, 8192, v242
  v_mfma_f32_16x16x32_bf16 v[24:27], a[140:143], v[188:191], v[204:207]
  v_exp_f32 v2, v2
  v_mfma_f32_16x16x32_bf16 v[24:27], a[136:139], v[184:187], v[24:27]
  buffer_load_dwordx4 v236, s[16:19], s29 offen offset:2048 lds
  v_mfma_f32_16x16x32_bf16 v[24:27], a[132:135], v[180:183], v[24:27]
  s_waitcnt lgkmcnt(0)
  v_exp_f32 v3, v3
  v_mfma_f32_16x16x32_bf16 v[24:27], a[128:131], v[176:179], v[24:27]
  v_cvt_pk_bf16_f32 v1, v2, v3
  v_mfma_f32_16x16x32_bf16 v[4:7], a[144:147], v[128:131], v[192:195]
  v_exp_f32 v8, v8
  v_mfma_f32_16x16x32_bf16 v[4:7], a[148:151], v[132:135], v[4:7]
  ds_read_b128 a[128:131], v212 offset:8192
  v_mfma_f32_16x16x32_bf16 v[4:7], a[152:155], v[136:139], v[4:7]
  v_exp_f32 v9, v9
  v_mfma_f32_16x16x32_bf16 v[4:7], a[156:159], v[140:143], v[4:7]
  ds_read_b128 a[132:135], v213 offset:8192
  v_cvt_pk_bf16_f32 v8, v8, v9
  v_mfma_f32_16x16x32_bf16 v[12:15], a[156:159], v[156:159], v[196:199]
  v_exp_f32 v10, v10
  v_mfma_f32_16x16x32_bf16 v[12:15], a[152:155], v[152:155], v[12:15]
  ds_read_b128 a[136:139], v214 offset:8192
  v_mfma_f32_16x16x32_bf16 v[12:15], a[148:151], v[148:151], v[12:15]
  v_exp_f32 v11, v11
  v_mfma_f32_16x16x32_bf16 v[12:15], a[144:147], v[144:147], v[12:15]
  ds_read_b128 a[140:143], v215 offset:8192
  v_cvt_pk_bf16_f32 v9, v10, v11
  v_mfma_f32_16x16x32_bf16 v[20:23], a[144:147], v[160:163], v[200:203]
  v_exp_f32 v16, v16
  v_mfma_f32_16x16x32_bf16 v[20:23], a[148:151], v[164:167], v[20:23]
  buffer_load_dwordx4 v237, s[16:19], s29 offen offset:3072 lds
  v_mfma_f32_16x16x32_bf16 v[20:23], a[152:155], v[168:171], v[20:23]
  s_add_u32 s29, s29, 16384
  v_exp_f32 v17, v17
  v_mfma_f32_16x16x32_bf16 v[20:23], a[156:159], v[172:175], v[20:23]
  v_cvt_pk_bf16_f32 v16, v16, v17
  v_mfma_f32_16x16x32_bf16 v[28:31], a[156:159], v[188:191], v[204:207]
  s_add_u32 m0, s28, 32768
  v_exp_f32 v18, v18
  v_mfma_f32_16x16x32_bf16 v[28:31], a[152:155], v[184:187], v[28:31]
  buffer_load_dwordx4 v232, s[12:15], s29 offen offset:0 lds
  v_mfma_f32_16x16x32_bf16 v[28:31], a[148:151], v[180:183], v[28:31]
  s_waitcnt lgkmcnt(0)
  v_exp_f32 v19, v19
  v_mfma_f32_16x16x32_bf16 v[28:31], a[144:147], v[176:179], v[28:31]
  v_cvt_pk_bf16_f32 v17, v18, v19
  v_mfma_f32_16x16x32_bf16 v[32:35], a[128:131], v[128:131], v[192:195]
  v_exp_f32 v24, v24
  v_mfma_f32_16x16x32_bf16 v[32:35], a[132:135], v[132:135], v[32:35]
  ds_read_b128 a[144:147], v212 offset:12288
  v_mfma_f32_16x16x32_bf16 v[32:35], a[136:139], v[136:139], v[32:35]
  v_exp_f32 v25, v25
  v_mfma_f32_16x16x32_bf16 v[32:35], a[140:143], v[140:143], v[32:35]
  ds_read_b128 a[148:151], v213 offset:12288
  v_cvt_pk_bf16_f32 v24, v24, v25
  v_mfma_f32_16x16x32_bf16 v[40:43], a[140:143], v[156:159], v[196:199]
  v_exp_f32 v26, v26
  v_mfma_f32_16x16x32_bf16 v[40:43], a[136:139], v[152:155], v[40:43]
  ds_read_b128 a[152:155], v214 offset:12288
  v_mfma_f32_16x16x32_bf16 v[40:43], a[132:135], v[148:151], v[40:43]
  v_exp_f32 v27, v27
  v_mfma_f32_16x16x32_bf16 v[40:43], a[128:131], v[144:147], v[40:43]
  ds_read_b128 a[156:159], v215 offset:12288
  v_cvt_pk_bf16_f32 v25, v26, v27
  v_mfma_f32_16x16x32_bf16 v[48:51], a[128:131], v[160:163], v[200:203]
  v_exp_f32 v4, v4
  v_mfma_f32_16x16x32_bf16 v[48:51], a[132:135], v[164:167], v[48:51]
  buffer_load_dwordx4 v233, s[12:15], s29 offen offset:1024 lds
  v_mfma_f32_16x16x32_bf16 v[48:51], a[136:139], v[168:171], v[48:51]
  v_exp_f32 v5, v5
  v_mfma_f32_16x16x32_bf16 v[48:51], a[140:143], v[172:175], v[48:51]
  v_cvt_pk_bf16_f32 v2, v4, v5
  v_mfma_f32_16x16x32_bf16 v[56:59], a[140:143], v[188:191], v[204:207]
  v_exp_f32 v6, v6
  v_mfma_f32_16x16x32_bf16 v[56:59], a[136:139], v[184:187], v[56:59]
  buffer_load_dwordx4 v234, s[12:15], s29 offen offset:2048 lds
  v_mfma_f32_16x16x32_bf16 v[56:59], a[132:135], v[180:183], v[56:59]
  s_waitcnt lgkmcnt(0)
  v_exp_f32 v7, v7
  v_mfma_f32_16x16x32_bf16 v[56:59], a[128:131], v[176:179], v[56:59]
  v_cvt_pk_bf16_f32 v3, v6, v7
  v_mfma_f32_16x16x32_bf16 v[36:39], a[144:147], v[128:131], v[192:195]
  v_exp_f32 v12, v12
  v_mfma_f32_16x16x32_bf16 v[36:39], a[148:151], v[132:135], v[36:39]
  ds_read_b64_tr_b16 a[160:161], v216 offset:49152
  v_mfma_f32_16x16x32_bf16 v[36:39], a[152:155], v[136:139], v[36:39]
  v_exp_f32 v13, v13
  v_mfma_f32_16x16x32_bf16 v[36:39], a[156:159], v[140:143], v[36:39]
  ds_read_b64_tr_b16 a[162:163], v216 offset:53248
  v_cvt_pk_bf16_f32 v10, v12, v13
  v_mfma_f32_16x16x32_bf16 v[44:47], a[156:159], v[156:159], v[196:199]
  v_exp_f32 v14, v14
  v_mfma_f32_16x16x32_bf16 v[44:47], a[152:155], v[152:155], v[44:47]
  ds_read_b64_tr_b16 a[164:165], v216 offset:57344
  buffer_load_dwordx4 v235, s[12:15], s29 offen offset:3072 lds
  v_mfma_f32_16x16x32_bf16 v[44:47], a[148:151], v[148:151], v[44:47]
  v_exp_f32 v15, v15
  v_mfma_f32_16x16x32_bf16 v[44:47], a[144:147], v[144:147], v[44:47]
  ds_read_b64_tr_b16 a[166:167], v216 offset:61440
  v_cvt_pk_bf16_f32 v11, v14, v15
  v_mfma_f32_16x16x32_bf16 v[52:55], a[144:147], v[160:163], v[200:203]
  v_exp_f32 v20, v20
  v_mfma_f32_16x16x32_bf16 v[52:55], a[148:151], v[164:167], v[52:55]
  ds_read_b64_tr_b16 a[168:169], v217 offset:49152
  v_mfma_f32_16x16x32_bf16 v[52:55], a[152:155], v[168:171], v[52:55]
  v_exp_f32 v21, v21
  v_mfma_f32_16x16x32_bf16 v[52:55], a[156:159], v[172:175], v[52:55]
  ds_read_b64_tr_b16 a[170:171], v217 offset:53248
  v_cvt_pk_bf16_f32 v18, v20, v21
  v_mfma_f32_16x16x32_bf16 v[60:63], a[156:159], v[188:191], v[204:207]
  v_exp_f32 v22, v22
  v_mfma_f32_16x16x32_bf16 v[60:63], a[152:155], v[184:187], v[60:63]
  ds_read_b64_tr_b16 a[172:173], v217 offset:57344
  v_mfma_f32_16x16x32_bf16 v[60:63], a[148:151], v[180:183], v[60:63]
  v_exp_f32 v23, v23
  v_mfma_f32_16x16x32_bf16 v[60:63], a[144:147], v[176:179], v[60:63]
  ds_read_b64_tr_b16 a[174:175], v217 offset:61440
  v_cvt_pk_bf16_f32 v19, v22, v23
  v_mfma_f32_16x16x32_bf16 a[192:195], a[208:211], v[64:67], a[192:195]
  v_exp_f32 v28, v28
  v_mfma_f32_16x16x32_bf16 a[192:195], a[208:211], v[96:99], a[192:195]
  ds_read_b64_tr_b16 a[176:177], v218 offset:49152
  v_mfma_f32_16x16x32_bf16 a[196:199], a[208:211], v[72:75], a[196:199]
  v_exp_f32 v29, v29
  v_mfma_f32_16x16x32_bf16 a[196:199], a[208:211], v[104:107], a[196:199]
  ds_read_b64_tr_b16 a[178:179], v218 offset:53248
  v_cvt_pk_bf16_f32 v26, v28, v29
  v_mfma_f32_16x16x32_bf16 a[200:203], a[208:211], v[80:83], a[200:203]
  v_exp_f32 v30, v30
  v_mfma_f32_16x16x32_bf16 a[200:203], a[208:211], v[112:115], a[200:203]
  ds_read_b64_tr_b16 a[180:181], v218 offset:57344
  v_mfma_f32_16x16x32_bf16 a[204:207], a[208:211], v[88:91], a[204:207]
  s_waitcnt lgkmcnt(7)
  v_exp_f32 v31, v31
  v_mfma_f32_16x16x32_bf16 a[204:207], a[208:211], v[120:123], a[204:207]
  ds_read_b64_tr_b16 a[182:183], v218 offset:61440
  v_cvt_pk_bf16_f32 v27, v30, v31
  v_mfma_f32_16x16x32_bf16 a[0:3], a[160:163], v[64:67], a[0:3]
  v_exp_f32 v32, v32
  v_mfma_f32_16x16x32_bf16 a[0:3], a[164:167], v[96:99], a[0:3]
  ds_read_b64_tr_b16 a[184:185], v219 offset:49152
  v_mfma_f32_16x16x32_bf16 a[4:7], a[164:167], v[104:107], a[4:7]
  v_exp_f32 v33, v33
  v_mfma_f32_16x16x32_bf16 a[4:7], a[160:163], v[72:75], a[4:7]
  ds_read_b64_tr_b16 a[186:187], v219 offset:53248
  v_cvt_pk_bf16_f32 v32, v32, v33
  v_mfma_f32_16x16x32_bf16 a[8:11], a[160:163], v[80:83], a[8:11]
  v_exp_f32 v34, v34
  v_mfma_f32_16x16x32_bf16 a[8:11], a[164:167], v[112:115], a[8:11]
  ds_read_b64_tr_b16 a[188:189], v219 offset:57344
  v_mfma_f32_16x16x32_bf16 a[12:15], a[164:167], v[120:123], a[12:15]
  s_waitcnt lgkmcnt(7)
  v_exp_f32 v35, v35
  v_mfma_f32_16x16x32_bf16 a[12:15], a[160:163], v[88:91], a[12:15]
  ds_read_b64_tr_b16 a[190:191], v219 offset:61440
  v_cvt_pk_bf16_f32 v33, v34, v35
  v_mfma_f32_16x16x32_bf16 a[16:19], a[168:171], v[64:67], a[16:19]
  v_exp_f32 v40, v40
  v_mfma_f32_16x16x32_bf16 a[16:19], a[172:175], v[96:99], a[16:19]
  ds_read_b64_tr_b16 a[160:161], v220 offset:49152
  v_mfma_f32_16x16x32_bf16 a[20:23], a[172:175], v[104:107], a[20:23]
  v_exp_f32 v41, v41
  v_mfma_f32_16x16x32_bf16 a[20:23], a[168:171], v[72:75], a[20:23]
  ds_read_b64_tr_b16 a[162:163], v220 offset:53248
  v_cvt_pk_bf16_f32 v40, v40, v41
  v_mfma_f32_16x16x32_bf16 a[24:27], a[168:171], v[80:83], a[24:27]
  v_exp_f32 v42, v42
  v_mfma_f32_16x16x32_bf16 a[24:27], a[172:175], v[112:115], a[24:27]
  ds_read_b64_tr_b16 a[164:165], v220 offset:57344
  v_mfma_f32_16x16x32_bf16 a[28:31], a[172:175], v[120:123], a[28:31]
  s_waitcnt lgkmcnt(7)
  v_exp_f32 v43, v43
  v_mfma_f32_16x16x32_bf16 a[28:31], a[168:171], v[88:91], a[28:31]
  ds_read_b64_tr_b16 a[166:167], v220 offset:61440
  v_cvt_pk_bf16_f32 v41, v42, v43
  v_mfma_f32_16x16x32_bf16 a[32:35], a[176:179], v[64:67], a[32:35]
  v_exp_f32 v48, v48
  v_mfma_f32_16x16x32_bf16 a[32:35], a[180:183], v[96:99], a[32:35]
  ds_read_b64_tr_b16 a[168:169], v221 offset:49152
  v_mfma_f32_16x16x32_bf16 a[36:39], a[180:183], v[104:107], a[36:39]
  v_exp_f32 v49, v49
  v_mfma_f32_16x16x32_bf16 a[36:39], a[176:179], v[72:75], a[36:39]
  ds_read_b64_tr_b16 a[170:171], v221 offset:53248
  v_cvt_pk_bf16_f32 v48, v48, v49
  v_mfma_f32_16x16x32_bf16 a[40:43], a[176:179], v[80:83], a[40:43]
  v_exp_f32 v50, v50
  v_mfma_f32_16x16x32_bf16 a[40:43], a[180:183], v[112:115], a[40:43]
  ds_read_b64_tr_b16 a[172:173], v221 offset:57344
  v_mfma_f32_16x16x32_bf16 a[44:47], a[180:183], v[120:123], a[44:47]
  s_waitcnt lgkmcnt(7)
  v_exp_f32 v51, v51
  v_mfma_f32_16x16x32_bf16 a[44:47], a[176:179], v[88:91], a[44:47]
  ds_read_b64_tr_b16 a[174:175], v221 offset:61440
  v_cvt_pk_bf16_f32 v49, v50, v51
  v_mfma_f32_16x16x32_bf16 a[48:51], a[184:187], v[64:67], a[48:51]
  v_exp_f32 v56, v56
  v_mfma_f32_16x16x32_bf16 a[48:51], a[188:191], v[96:99], a[48:51]
  ds_read_b64_tr_b16 a[176:177], v222 offset:49152
  v_mfma_f32_16x16x32_bf16 a[52:55], a[188:191], v[104:107], a[52:55]
  v_exp_f32 v57, v57
  v_mfma_f32_16x16x32_bf16 a[52:55], a[184:187], v[72:75], a[52:55]
  ds_read_b64_tr_b16 a[178:179], v222 offset:53248
  v_cvt_pk_bf16_f32 v56, v56, v57
  v_mfma_f32_16x16x32_bf16 a[56:59], a[184:187], v[80:83], a[56:59]
  v_exp_f32 v58, v58
  v_mfma_f32_16x16x32_bf16 a[56:59], a[188:191], v[112:115], a[56:59]
  ds_read_b64_tr_b16 a[180:181], v222 offset:57344
  v_mfma_f32_16x16x32_bf16 a[60:63], a[188:191], v[120:123], a[60:63]
  s_waitcnt lgkmcnt(7)
  v_exp_f32 v59, v59
  v_mfma_f32_16x16x32_bf16 a[60:63], a[184:187], v[88:91], a[60:63]
  ds_read_b64_tr_b16 a[182:183], v222 offset:61440
  v_cvt_pk_bf16_f32 v57, v58, v59
  v_mfma_f32_16x16x32_bf16 a[64:67], a[160:163], v[64:67], a[64:67]
  v_exp_f32 v36, v36
  v_mfma_f32_16x16x32_bf16 a[64:67], a[164:167], v[96:99], a[64:67]
  ds_read_b64_tr_b16 a[184:185], v223 offset:49152
  v_mfma_f32_16x16x32_bf16 a[68:71], a[164:167], v[104:107], a[68:71]
  v_exp_f32 v37, v37
  v_mfma_f32_16x16x32_bf16 a[68:71], a[160:163], v[72:75], a[68:71]
  ds_read_b64_tr_b16 a[186:187], v223 offset:53248
  v_cvt_pk_bf16_f32 v34, v36, v37
  v_mfma_f32_16x16x32_bf16 a[72:75], a[160:163], v[80:83], a[72:75]
  v_exp_f32 v38, v38
  v_mfma_f32_16x16x32_bf16 a[72:75], a[164:167], v[112:115], a[72:75]
  ds_read_b64_tr_b16 a[188:189], v223 offset:57344
  v_mfma_f32_16x16x32_bf16 a[76:79], a[164:167], v[120:123], a[76:79]
  s_waitcnt lgkmcnt(7)
  v_exp_f32 v39, v39
  v_mfma_f32_16x16x32_bf16 a[76:79], a[160:163], v[88:91], a[76:79]
  ds_read_b64_tr_b16 a[190:191], v223 offset:61440
  v_cvt_pk_bf16_f32 v35, v38, v39
  v_mfma_f32_16x16x32_bf16 a[80:83], a[168:171], v[64:67], a[80:83]
  v_exp_f32 v44, v44
  v_mfma_f32_16x16x32_bf16 a[80:83], a[172:175], v[96:99], a[80:83]
  v_mfma_f32_16x16x32_bf16 a[84:87], a[172:175], v[104:107], a[84:87]
  s_barrier
  v_exp_f32 v45, v45
  v_mfma_f32_16x16x32_bf16 a[84:87], a[168:171], v[72:75], a[84:87]
  ds_read_b128 a[128:131], v212 offset:16384
  v_cvt_pk_bf16_f32 v42, v44, v45
  v_mfma_f32_16x16x32_bf16 a[88:91], a[168:171], v[80:83], a[88:91]
  v_exp_f32 v46, v46
  v_mfma_f32_16x16x32_bf16 a[88:91], a[172:175], v[112:115], a[88:91]
  ds_read_b128 a[132:135], v213 offset:16384
  v_mfma_f32_16x16x32_bf16 a[92:95], a[172:175], v[120:123], a[92:95]
  s_waitcnt lgkmcnt(6)
  v_exp_f32 v47, v47
  v_mfma_f32_16x16x32_bf16 a[92:95], a[168:171], v[88:91], a[92:95]
  ds_read_b128 a[136:139], v214 offset:16384
  v_cvt_pk_bf16_f32 v43, v46, v47
  v_mfma_f32_16x16x32_bf16 a[96:99], a[176:179], v[64:67], a[96:99]
  v_exp_f32 v52, v52
  v_mfma_f32_16x16x32_bf16 a[96:99], a[180:183], v[96:99], a[96:99]
  ds_read_b128 a[140:143], v215 offset:16384
  v_mfma_f32_16x16x32_bf16 a[100:103], a[180:183], v[104:107], a[100:103]
  v_exp_f32 v53, v53
  v_mfma_f32_16x16x32_bf16 a[100:103], a[176:179], v[72:75], a[100:103]
  v_cvt_pk_bf16_f32 v50, v52, v53
  v_mfma_f32_16x16x32_bf16 a[104:107], a[176:179], v[80:83], a[104:107]
  v_exp_f32 v54, v54
  v_mfma_f32_16x16x32_bf16 a[104:107], a[180:183], v[112:115], a[104:107]
  v_mfma_f32_16x16x32_bf16 a[108:111], a[180:183], v[120:123], a[108:111]
  s_waitcnt lgkmcnt(4)
  v_exp_f32 v55, v55
  v_mfma_f32_16x16x32_bf16 a[108:111], a[176:179], v[88:91], a[108:111]
  v_cvt_pk_bf16_f32 v51, v54, v55
  v_mfma_f32_16x16x32_bf16 a[112:115], a[184:187], v[64:67], a[112:115]
  v_exp_f32 v60, v60
  v_mfma_f32_16x16x32_bf16 a[112:115], a[188:191], v[96:99], a[112:115]
  v_mfma_f32_16x16x32_bf16 a[116:119], a[188:191], v[104:107], a[116:119]
  v_exp_f32 v61, v61
  v_mfma_f32_16x16x32_bf16 a[116:119], a[184:187], v[72:75], a[116:119]
  v_cvt_pk_bf16_f32 v58, v60, v61
  v_mfma_f32_16x16x32_bf16 a[120:123], a[184:187], v[80:83], a[120:123]
  v_exp_f32 v62, v62
  v_mfma_f32_16x16x32_bf16 a[120:123], a[188:191], v[112:115], a[120:123]
  v_mfma_f32_16x16x32_bf16 a[124:127], a[188:191], v[120:123], a[124:127]
  s_waitcnt lgkmcnt(0)
  v_exp_f32 v63, v63
  v_mfma_f32_16x16x32_bf16 a[124:127], a[184:187], v[88:91], a[124:127]
  v_cvt_pk_bf16_f32 v59, v62, v63
  v_mfma_f32_16x16x32_bf16 v[64:67], a[128:131], v[128:131], v[192:195]
  s_add_u32 m0, s28, 98304
  v_mfma_f32_16x16x32_bf16 v[64:67], a[132:135], v[132:135], v[64:67]
  ds_read_b128 a[144:147], v212 offset:20480
  v_mfma_f32_16x16x32_bf16 v[64:67], a[136:139], v[136:139], v[64:67]
  buffer_load_dwordx4 v236, s[16:19], s29 offen offset:0 lds
  v_mfma_f32_16x16x32_bf16 v[64:67], a[140:143], v[140:143], v[64:67]
  ds_read_b128 a[148:151], v213 offset:20480
  v_mfma_f32_16x16x32_bf16 v[72:75], a[140:143], v[156:159], v[196:199]
  v_mfma_f32_16x16x32_bf16 v[72:75], a[136:139], v[152:155], v[72:75]
  ds_read_b128 a[152:155], v214 offset:20480
  v_mfma_f32_16x16x32_bf16 v[72:75], a[132:135], v[148:151], v[72:75]
  buffer_load_dwordx4 v237, s[16:19], s29 offen offset:1024 lds
  v_mfma_f32_16x16x32_bf16 v[72:75], a[128:131], v[144:147], v[72:75]
  ds_read_b128 a[156:159], v215 offset:20480
  v_mfma_f32_16x16x32_bf16 v[80:83], a[128:131], v[160:163], v[200:203]
  v_exp_f32 v64, v64
  v_mfma_f32_16x16x32_bf16 v[80:83], a[132:135], v[164:167], v[80:83]
  v_mfma_f32_16x16x32_bf16 v[80:83], a[136:139], v[168:171], v[80:83]
  v_exp_f32 v65, v65
  v_mfma_f32_16x16x32_bf16 v[80:83], a[140:143], v[172:175], v[80:83]
  v_cvt_pk_bf16_f32 v64, v64, v65
  v_mfma_f32_16x16x32_bf16 v[88:91], a[140:143], v[188:191], v[204:207]
  v_exp_f32 v66, v66
  v_mfma_f32_16x16x32_bf16 v[88:91], a[136:139], v[184:187], v[88:91]
  buffer_load_dwordx4 v236, s[16:19], s29 offen offset:2048 lds
  v_mfma_f32_16x16x32_bf16 v[88:91], a[132:135], v[180:183], v[88:91]
  s_waitcnt lgkmcnt(0)
  v_exp_f32 v67, v67
  v_mfma_f32_16x16x32_bf16 v[88:91], a[128:131], v[176:179], v[88:91]
  v_cvt_pk_bf16_f32 v65, v66, v67
  v_mfma_f32_16x16x32_bf16 v[68:71], a[144:147], v[128:131], v[192:195]
  v_exp_f32 v72, v72
  v_mfma_f32_16x16x32_bf16 v[68:71], a[148:151], v[132:135], v[68:71]
  ds_read_b128 a[128:131], v212 offset:24576
  v_mfma_f32_16x16x32_bf16 v[68:71], a[152:155], v[136:139], v[68:71]
  v_exp_f32 v73, v73
  v_mfma_f32_16x16x32_bf16 v[68:71], a[156:159], v[140:143], v[68:71]
  ds_read_b128 a[132:135], v213 offset:24576
  v_cvt_pk_bf16_f32 v72, v72, v73
  v_mfma_f32_16x16x32_bf16 v[76:79], a[156:159], v[156:159], v[196:199]
  v_exp_f32 v74, v74
  v_mfma_f32_16x16x32_bf16 v[76:79], a[152:155], v[152:155], v[76:79]
  ds_read_b128 a[136:139], v214 offset:24576
  v_lshrrev_b32 v224, 4, v242
  v_mfma_f32_16x16x32_bf16 v[76:79], a[148:151], v[148:151], v[76:79]
  v_exp_f32 v75, v75
  v_mfma_f32_16x16x32_bf16 v[76:79], a[144:147], v[144:147], v[76:79]
  ds_read_b128 a[140:143], v215 offset:24576
  v_cvt_pk_bf16_f32 v73, v74, v75
  v_mfma_f32_16x16x32_bf16 v[84:87], a[144:147], v[160:163], v[200:203]
  v_exp_f32 v80, v80
  v_mfma_f32_16x16x32_bf16 v[84:87], a[148:151], v[164:167], v[84:87]
  buffer_load_dwordx4 v237, s[16:19], s29 offen offset:3072 lds
  v_mfma_f32_16x16x32_bf16 v[84:87], a[152:155], v[168:171], v[84:87]
  s_add_u32 s29, s29, 16384
  v_exp_f32 v81, v81
  v_mfma_f32_16x16x32_bf16 v[84:87], a[156:159], v[172:175], v[84:87]
  v_cvt_pk_bf16_f32 v80, v80, v81
  v_lshrrev_b32 v225, 4, v224
  v_mfma_f32_16x16x32_bf16 v[92:95], a[156:159], v[188:191], v[204:207]
  s_add_u32 m0, s28, 49152
  v_exp_f32 v82, v82
  v_mfma_f32_16x16x32_bf16 v[92:95], a[152:155], v[184:187], v[92:95]
  buffer_load_dwordx4 v232, s[12:15], s29 offen offset:0 lds
  v_mfma_f32_16x16x32_bf16 v[92:95], a[148:151], v[180:183], v[92:95]
  s_waitcnt lgkmcnt(0)
  v_exp_f32 v83, v83
  v_mfma_f32_16x16x32_bf16 v[92:95], a[144:147], v[176:179], v[92:95]
  v_cvt_pk_bf16_f32 v81, v82, v83
  v_bfe_u32 v226, v224, 2, 2
  v_mfma_f32_16x16x32_bf16 v[96:99], a[128:131], v[128:131], v[192:195]
  v_exp_f32 v88, v88
  v_mfma_f32_16x16x32_bf16 v[96:99], a[132:135], v[132:135], v[96:99]
  ds_read_b128 a[144:147], v212 offset:28672
  v_lshl_add_u32 v225, v225, 3, v226
  v_mfma_f32_16x16x32_bf16 v[96:99], a[136:139], v[136:139], v[96:99]
  v_exp_f32 v89, v89
  v_mfma_f32_16x16x32_bf16 v[96:99], a[140:143], v[140:143], v[96:99]
  ds_read_b128 a[148:151], v213 offset:28672
  v_cvt_pk_bf16_f32 v88, v88, v89
  v_mfma_f32_16x16x32_bf16 v[104:107], a[140:143], v[156:159], v[196:199]
  v_exp_f32 v90, v90
  v_mfma_f32_16x16x32_bf16 v[104:107], a[136:139], v[152:155], v[104:107]
  ds_read_b128 a[152:155], v214 offset:28672
  v_lshlrev_b32 v225, 5, v225
  v_mfma_f32_16x16x32_bf16 v[104:107], a[132:135], v[148:151], v[104:107]
  v_exp_f32 v91, v91
  v_mfma_f32_16x16x32_bf16 v[104:107], a[128:131], v[144:147], v[104:107]
  ds_read_b128 a[156:159], v215 offset:28672
  v_cvt_pk_bf16_f32 v89, v90, v91
  v_mfma_f32_16x16x32_bf16 v[112:115], a[128:131], v[160:163], v[200:203]
  v_exp_f32 v68, v68
  v_mfma_f32_16x16x32_bf16 v[112:115], a[132:135], v[164:167], v[112:115]
  buffer_load_dwordx4 v233, s[12:15], s29 offen offset:1024 lds
  v_mfma_f32_16x16x32_bf16 v[112:115], a[136:139], v[168:171], v[112:115]
  v_exp_f32 v69, v69
  v_mfma_f32_16x16x32_bf16 v[112:115], a[140:143], v[172:175], v[112:115]
  v_cvt_pk_bf16_f32 v66, v68, v69
  v_and_b32 v226, 3, v224
  v_mfma_f32_16x16x32_bf16 v[120:123], a[140:143], v[188:191], v[204:207]
  v_exp_f32 v70, v70
  v_mfma_f32_16x16x32_bf16 v[120:123], a[136:139], v[184:187], v[120:123]
  buffer_load_dwordx4 v234, s[12:15], s29 offen offset:2048 lds
  v_mfma_f32_16x16x32_bf16 v[120:123], a[132:135], v[180:183], v[120:123]
  s_waitcnt lgkmcnt(0)
  v_exp_f32 v71, v71
  v_mfma_f32_16x16x32_bf16 v[120:123], a[128:131], v[176:179], v[120:123]
  v_cvt_pk_bf16_f32 v67, v70, v71
  v_lshl_add_u32 v225, v226, 3, v225
  v_mfma_f32_16x16x32_bf16 v[100:103], a[144:147], v[128:131], v[192:195]
  v_exp_f32 v76, v76
  v_mfma_f32_16x16x32_bf16 v[100:103], a[148:151], v[132:135], v[100:103]
  ds_read_b64_tr_b16 a[160:161], v216 offset:0
  v_add_u32 v225, s50, v225
  v_mfma_f32_16x16x32_bf16 v[100:103], a[152:155], v[136:139], v[100:103]
  s_waitcnt vmcnt(13)
  v_exp_f32 v77, v77
  v_mfma_f32_16x16x32_bf16 v[100:103], a[156:159], v[140:143], v[100:103]
  ds_read_b64_tr_b16 a[162:163], v216 offset:4096
  v_cvt_pk_bf16_f32 v74, v76, v77
  v_mfma_f32_16x16x32_bf16 v[108:111], a[156:159], v[156:159], v[196:199]
  v_exp_f32 v78, v78
  v_mfma_f32_16x16x32_bf16 v[108:111], a[152:155], v[152:155], v[108:111]
  ds_read_b64_tr_b16 a[164:165], v216 offset:8192
  buffer_load_dwordx4 v235, s[12:15], s29 offen offset:3072 lds
  v_mfma_f32_16x16x32_bf16 v[108:111], a[148:151], v[148:151], v[108:111]
  v_exp_f32 v79, v79
  v_mfma_f32_16x16x32_bf16 v[108:111], a[144:147], v[144:147], v[108:111]
  ds_read_b64_tr_b16 a[166:167], v216 offset:12288
  v_cvt_pk_bf16_f32 v75, v78, v79
  v_mfma_f32_16x16x32_bf16 v[116:119], a[144:147], v[160:163], v[200:203]
  v_exp_f32 v84, v84
  v_mfma_f32_16x16x32_bf16 v[116:119], a[148:151], v[164:167], v[116:119]
  ds_read_b64_tr_b16 a[168:169], v217 offset:0
  ds_read_b64_tr_b16 a[232:233], v225 offset:0
  s_add_u32 m0, s28, 0
  v_mfma_f32_16x16x32_bf16 v[116:119], a[152:155], v[168:171], v[116:119]
  v_exp_f32 v85, v85
  v_mfma_f32_16x16x32_bf16 v[116:119], a[156:159], v[172:175], v[116:119]
  ds_read_b64_tr_b16 a[170:171], v217 offset:4096
  v_cvt_pk_bf16_f32 v82, v84, v85
  v_mfma_f32_16x16x32_bf16 v[124:127], a[156:159], v[188:191], v[204:207]
  v_exp_f32 v86, v86
  v_mfma_f32_16x16x32_bf16 v[124:127], a[152:155], v[184:187], v[124:127]
  ds_read_b64_tr_b16 a[172:173], v217 offset:8192
  ds_read_b64_tr_b16 a[234:235], v225 offset:128
  v_mfma_f32_16x16x32_bf16 v[124:127], a[148:151], v[180:183], v[124:127]
  v_exp_f32 v87, v87
  v_mfma_f32_16x16x32_bf16 v[124:127], a[144:147], v[176:179], v[124:127]
  ds_read_b64_tr_b16 a[174:175], v217 offset:12288
  v_cvt_pk_bf16_f32 v83, v86, v87
  v_mfma_f32_16x16x32_bf16 a[192:195], a[208:211], v[0:3], a[192:195]
  v_exp_f32 v92, v92
  v_mfma_f32_16x16x32_bf16 a[192:195], a[208:211], v[32:35], a[192:195]
  ds_read_b64_tr_b16 a[176:177], v218 offset:0
  ds_read_b64_tr_b16 a[236:237], v225 offset:1024
  v_mfma_f32_16x16x32_bf16 a[196:199], a[208:211], v[8:11], a[196:199]
  v_exp_f32 v93, v93
  v_mfma_f32_16x16x32_bf16 a[196:199], a[208:211], v[40:43], a[196:199]
  ds_read_b64_tr_b16 a[178:179], v218 offset:4096
  v_cvt_pk_bf16_f32 v90, v92, v93
  v_mfma_f32_16x16x32_bf16 a[200:203], a[208:211], v[16:19], a[200:203]
  v_exp_f32 v94, v94
  v_mfma_f32_16x16x32_bf16 a[200:203], a[208:211], v[48:51], a[200:203]
  ds_read_b64_tr_b16 a[180:181], v218 offset:8192
  ds_read_b64_tr_b16 a[238:239], v225 offset:1152
  v_mfma_f32_16x16x32_bf16 a[204:207], a[208:211], v[24:27], a[204:207]
  s_waitcnt lgkmcnt(11)
  v_exp_f32 v95, v95
  v_mfma_f32_16x16x32_bf16 a[204:207], a[208:211], v[56:59], a[204:207]
  ds_read_b64_tr_b16 a[182:183], v218 offset:12288
  v_cvt_pk_bf16_f32 v91, v94, v95
  v_mfma_f32_16x16x32_bf16 a[0:3], a[160:163], v[0:3], a[0:3]
  v_exp_f32 v96, v96
  v_mfma_f32_16x16x32_bf16 a[0:3], a[164:167], v[32:35], a[0:3]
  ds_read_b64_tr_b16 a[184:185], v219 offset:0
  ds_read_b64_tr_b16 a[240:241], v225 offset:2048
  v_mfma_f32_16x16x32_bf16 a[4:7], a[164:167], v[40:43], a[4:7]
  v_exp_f32 v97, v97
  v_mfma_f32_16x16x32_bf16 a[4:7], a[160:163], v[8:11], a[4:7]
  ds_read_b64_tr_b16 a[186:187], v219 offset:4096
  v_cvt_pk_bf16_f32 v96, v96, v97
  v_mfma_f32_16x16x32_bf16 a[8:11], a[160:163], v[16:19], a[8:11]
  v_exp_f32 v98, v98
  v_mfma_f32_16x16x32_bf16 a[8:11], a[164:167], v[48:51], a[8:11]
  ds_read_b64_tr_b16 a[188:189], v219 offset:8192
  ds_read_b64_tr_b16 a[242:243], v225 offset:2176
  v_mfma_f32_16x16x32_bf16 a[12:15], a[164:167], v[56:59], a[12:15]
  s_waitcnt lgkmcnt(11)
  v_exp_f32 v99, v99
  v_mfma_f32_16x16x32_bf16 a[12:15], a[160:163], v[24:27], a[12:15]
  ds_read_b64_tr_b16 a[190:191], v219 offset:12288
  v_cvt_pk_bf16_f32 v97, v98, v99
  v_mfma_f32_16x16x32_bf16 a[16:19], a[168:171], v[0:3], a[16:19]
  v_exp_f32 v104, v104
  v_mfma_f32_16x16x32_bf16 a[16:19], a[172:175], v[32:35], a[16:19]
  ds_read_b64_tr_b16 a[160:161], v220 offset:0
  buffer_load_dwordx4 v253, s[24:27], s8 offen offset:0 sc1 lds
  v_mfma_f32_16x16x32_bf16 a[20:23], a[172:175], v[40:43], a[20:23]
  v_exp_f32 v105, v105
  v_mfma_f32_16x16x32_bf16 a[20:23], a[168:171], v[8:11], a[20:23]
  ds_read_b64_tr_b16 a[162:163], v220 offset:4096
  v_cvt_pk_bf16_f32 v104, v104, v105
  v_mfma_f32_16x16x32_bf16 a[24:27], a[168:171], v[16:19], a[24:27]
  v_exp_f32 v106, v106
  v_mfma_f32_16x16x32_bf16 a[24:27], a[172:175], v[48:51], a[24:27]
  ds_read_b64_tr_b16 a[164:165], v220 offset:8192
  s_waitcnt lgkmcnt(4)
  buffer_load_dwordx4 v253, s[24:27], s8 offen offset:1024 sc1 lds
  v_mfma_f32_16x16x32_bf16 v[228:231], a[232:235], a[212:215], 0
  v_mfma_f32_16x16x32_bf16 v[228:231], a[236:239], a[216:219], v[228:231]
  v_mfma_f32_16x16x32_bf16 v[228:231], a[240:243], a[220:223], v[228:231]
  v_mfma_f32_16x16x32_bf16 a[28:31], a[172:175], v[56:59], a[28:31]
  s_lshl_b32 s35, s3, 10
  s_add_u32 s35, s35, 159744
  v_exp_f32 v107, v107
  v_mfma_f32_16x16x32_bf16 a[28:31], a[168:171], v[24:27], a[28:31]
  ds_read_b64_tr_b16 a[166:167], v220 offset:12288
  v_cvt_pk_bf16_f32 v105, v106, v107
  v_mfma_f32_16x16x32_bf16 a[32:35], a[176:179], v[0:3], a[32:35]
  v_exp_f32 v112, v112
  v_mfma_f32_16x16x32_bf16 a[32:35], a[180:183], v[32:35], a[32:35]
  ds_read_b64_tr_b16 a[168:169], v221 offset:0
  buffer_load_dwordx4 v253, s[24:27], s8 offen offset:2048 sc1 lds
  v_mfma_f32_16x16x32_bf16 a[36:39], a[180:183], v[40:43], a[36:39]
  v_exp_f32 v113, v113
  v_mfma_f32_16x16x32_bf16 a[36:39], a[176:179], v[8:11], a[36:39]
  ds_read_b64_tr_b16 a[170:171], v221 offset:4096
  v_cvt_pk_bf16_f32 v112, v112, v113
  v_mfma_f32_16x16x32_bf16 a[40:43], a[176:179], v[16:19], a[40:43]
  v_exp_f32 v114, v114
  v_mfma_f32_16x16x32_bf16 a[40:43], a[180:183], v[48:51], a[40:43]
  ds_read_b64_tr_b16 a[172:173], v221 offset:8192
  buffer_load_dwordx4 v253, s[24:27], s8 offen offset:3072 sc1 lds
  v_mfma_f32_16x16x32_bf16 a[44:47], a[180:183], v[56:59], a[44:47]
  s_waitcnt lgkmcnt(7)
  v_exp_f32 v115, v115
  v_mfma_f32_16x16x32_bf16 a[44:47], a[176:179], v[24:27], a[44:47]
  ds_read_b64_tr_b16 a[174:175], v221 offset:12288
  v_cvt_pk_bf16_f32 v113, v114, v115
  v_mfma_f32_16x16x32_bf16 a[48:51], a[184:187], v[0:3], a[48:51]
  v_exp_f32 v120, v120
  v_mfma_f32_16x16x32_bf16 a[48:51], a[188:191], v[32:35], a[48:51]
  ds_read_b64_tr_b16 a[176:177], v222 offset:0
  v_add_u32 v224, s35, v242
  v_mfma_f32_16x16x32_bf16 a[52:55], a[188:191], v[40:43], a[52:55]
  v_exp_f32 v121, v121
  v_mfma_f32_16x16x32_bf16 a[52:55], a[184:187], v[8:11], a[52:55]
  ds_read_b64_tr_b16 a[178:179], v222 offset:4096
  v_cvt_pk_bf16_f32 v120, v120, v121
  v_mfma_f32_16x16x32_bf16 a[56:59], a[184:187], v[16:19], a[56:59]
  v_exp_f32 v122, v122
  v_mfma_f32_16x16x32_bf16 a[56:59], a[188:191], v[48:51], a[56:59]
  ds_read_b64_tr_b16 a[180:181], v222 offset:8192
  ds_write_b128 v224, v[228:231]
  v_mfma_f32_16x16x32_bf16 a[60:63], a[188:191], v[56:59], a[60:63]
  s_waitcnt lgkmcnt(8)
  v_exp_f32 v123, v123
  v_mfma_f32_16x16x32_bf16 a[60:63], a[184:187], v[24:27], a[60:63]
  ds_read_b64_tr_b16 a[182:183], v222 offset:12288
  v_cvt_pk_bf16_f32 v121, v122, v123
  v_mfma_f32_16x16x32_bf16 a[64:67], a[160:163], v[0:3], a[64:67]
  v_exp_f32 v100, v100
  v_mfma_f32_16x16x32_bf16 a[64:67], a[164:167], v[32:35], a[64:67]
  ds_read_b64_tr_b16 a[184:185], v223 offset:0
  v_mfma_f32_16x16x32_bf16 a[68:71], a[164:167], v[40:43], a[68:71]
  v_exp_f32 v101, v101
  v_mfma_f32_16x16x32_bf16 a[68:71], a[160:163], v[8:11], a[68:71]
  ds_read_b64_tr_b16 a[186:187], v223 offset:4096
  v_cvt_pk_bf16_f32 v98, v100, v101
  v_mfma_f32_16x16x32_bf16 a[72:75], a[160:163], v[16:19], a[72:75]
  v_exp_f32 v102, v102
  v_mfma_f32_16x16x32_bf16 a[72:75], a[164:167], v[48:51], a[72:75]
  ds_read_b64_tr_b16 a[188:189], v223 offset:8192
  s_waitcnt lgkmcnt(4)
  v_mfma_f32_16x16x32_bf16 a[76:79], a[164:167], v[56:59], a[76:79]
  v_exp_f32 v103, v103
  v_mfma_f32_16x16x32_bf16 a[76:79], a[160:163], v[24:27], a[76:79]
  ds_read_b64_tr_b16 a[190:191], v223 offset:12288
  v_cvt_pk_bf16_f32 v99, v102, v103
  v_mfma_f32_16x16x32_bf16 a[80:83], a[168:171], v[0:3], a[80:83]
  s_waitcnt vmcnt(12)
  v_exp_f32 v108, v108
  v_mfma_f32_16x16x32_bf16 a[80:83], a[172:175], v[32:35], a[80:83]
  v_mfma_f32_16x16x32_bf16 a[84:87], a[172:175], v[40:43], a[84:87]
  s_barrier
  v_exp_f32 v109, v109
  v_mfma_f32_16x16x32_bf16 a[84:87], a[168:171], v[8:11], a[84:87]
  ds_read_b128 a[128:131], v212 offset:32768
  v_cvt_pk_bf16_f32 v106, v108, v109
  v_mfma_f32_16x16x32_bf16 a[88:91], a[168:171], v[16:19], a[88:91]
  v_exp_f32 v110, v110
  v_mfma_f32_16x16x32_bf16 a[88:91], a[172:175], v[48:51], a[88:91]
  ds_read_b128 a[132:135], v213 offset:32768
  v_mfma_f32_16x16x32_bf16 a[92:95], a[172:175], v[56:59], a[92:95]
  s_waitcnt lgkmcnt(6)
  v_exp_f32 v111, v111
  v_mfma_f32_16x16x32_bf16 a[92:95], a[168:171], v[24:27], a[92:95]
  ds_read_b128 a[136:139], v214 offset:32768
  v_cvt_pk_bf16_f32 v107, v110, v111
  v_mfma_f32_16x16x32_bf16 a[96:99], a[176:179], v[0:3], a[96:99]
  v_exp_f32 v116, v116
  v_mfma_f32_16x16x32_bf16 a[96:99], a[180:183], v[32:35], a[96:99]
  ds_read_b128 a[140:143], v215 offset:32768
  v_mfma_f32_16x16x32_bf16 a[100:103], a[180:183], v[40:43], a[100:103]
  v_exp_f32 v117, v117
  v_mfma_f32_16x16x32_bf16 a[100:103], a[176:179], v[8:11], a[100:103]
  v_cvt_pk_bf16_f32 v114, v116, v117
  v_mfma_f32_16x16x32_bf16 a[104:107], a[176:179], v[16:19], a[104:107]
  v_exp_f32 v118, v118
  v_mfma_f32_16x16x32_bf16 a[104:107], a[180:183], v[48:51], a[104:107]
  v_mfma_f32_16x16x32_bf16 a[108:111], a[180:183], v[56:59], a[108:111]
  s_waitcnt lgkmcnt(4)
  v_exp_f32 v119, v119
  v_mfma_f32_16x16x32_bf16 a[108:111], a[176:179], v[24:27], a[108:111]
  v_cvt_pk_bf16_f32 v115, v118, v119
  v_mfma_f32_16x16x32_bf16 a[112:115], a[184:187], v[0:3], a[112:115]
  v_exp_f32 v124, v124
  v_mfma_f32_16x16x32_bf16 a[112:115], a[188:191], v[32:35], a[112:115]
  v_mfma_f32_16x16x32_bf16 a[116:119], a[188:191], v[40:43], a[116:119]
  v_exp_f32 v125, v125
  v_mfma_f32_16x16x32_bf16 a[116:119], a[184:187], v[8:11], a[116:119]
  v_cvt_pk_bf16_f32 v122, v124, v125
  v_mfma_f32_16x16x32_bf16 a[120:123], a[184:187], v[16:19], a[120:123]
  v_exp_f32 v126, v126
  v_mfma_f32_16x16x32_bf16 a[120:123], a[188:191], v[48:51], a[120:123]
  v_mfma_f32_16x16x32_bf16 a[124:127], a[188:191], v[56:59], a[124:127]
  s_waitcnt lgkmcnt(0)
  v_exp_f32 v127, v127
  v_mfma_f32_16x16x32_bf16 a[124:127], a[184:187], v[24:27], a[124:127]
  v_cvt_pk_bf16_f32 v123, v126, v127
  v_mfma_f32_16x16x32_bf16 v[0:3], a[128:131], v[128:131], v[192:195]
  s_add_u32 m0, s28, 114688
  v_add_u32 v224, 159744, v242
  v_mfma_f32_16x16x32_bf16 v[0:3], a[132:135], v[132:135], v[0:3]
  ds_read_b128 a[144:147], v212 offset:36864
  ds_read_b128 v[228:231], v224 offset:0
  v_mfma_f32_16x16x32_bf16 v[0:3], a[136:139], v[136:139], v[0:3]
  buffer_load_dwordx4 v236, s[16:19], s29 offen offset:0 lds
  v_mfma_f32_16x16x32_bf16 v[0:3], a[140:143], v[140:143], v[0:3]
  ds_read_b128 a[148:151], v213 offset:36864
  ds_read_b128 v[238:241], v224 offset:1024
  v_mfma_f32_16x16x32_bf16 v[8:11], a[140:143], v[156:159], v[196:199]
  ds_read_b128 v[208:211], v224 offset:2048
  v_lshrrev_b32 v224, 4, v242
  v_mfma_f32_16x16x32_bf16 v[8:11], a[136:139], v[152:155], v[8:11]
  ds_read_b128 a[152:155], v214 offset:36864
  s_min_u32 s35, s3, 1
  s_lshl_b32 s35, s35, 30
  v_and_b32 v225, 7, v224
  v_mfma_f32_16x16x32_bf16 v[8:11], a[132:135], v[148:151], v[8:11]
  buffer_load_dwordx4 v237, s[16:19], s29 offen offset:1024 lds
  v_mfma_f32_16x16x32_bf16 v[8:11], a[128:131], v[144:147], v[8:11]
  ds_read_b128 a[156:159], v215 offset:36864
  v_mul_u32_u24 v225, 0xa00, v225
  v_mfma_f32_16x16x32_bf16 v[16:19], a[128:131], v[160:163], v[200:203]
  v_exp_f32 v0, v0
  v_mfma_f32_16x16x32_bf16 v[16:19], a[132:135], v[164:167], v[16:19]
  v_lshrrev_b32 v226, 4, v224
  v_lshl_add_u32 v225, v226, 4, v225
  v_mfma_f32_16x16x32_bf16 v[16:19], a[136:139], v[168:171], v[16:19]
  v_exp_f32 v1, v1
  v_mfma_f32_16x16x32_bf16 v[16:19], a[140:143], v[172:175], v[16:19]
  v_cvt_pk_bf16_f32 v0, v0, v1
  v_bfe_u32 v226, v224, 3, 1
  v_mfma_f32_16x16x32_bf16 v[24:27], a[140:143], v[188:191], v[204:207]
  v_exp_f32 v2, v2
  v_mfma_f32_16x16x32_bf16 v[24:27], a[136:139], v[184:187], v[24:27]
  buffer_load_dwordx4 v236, s[16:19], s29 offen offset:2048 lds
  v_mfma_f32_16x16x32_bf16 v[24:27], a[132:135], v[180:183], v[24:27]
  s_waitcnt lgkmcnt(0)
  v_exp_f32 v3, v3
  v_mfma_f32_16x16x32_bf16 v[24:27], a[128:131], v[176:179], v[24:27]
  v_cvt_pk_bf16_f32 v1, v2, v3
  v_lshl_add_u32 v225, v226, 30, v225
  v_mfma_f32_16x16x32_bf16 v[4:7], a[144:147], v[128:131], v[192:195]
  v_exp_f32 v8, v8
  v_mfma_f32_16x16x32_bf16 v[4:7], a[148:151], v[132:135], v[4:7]
  ds_read_b128 a[128:131], v212 offset:40960
  v_or_b32 v225, s35, v225
  v_mfma_f32_16x16x32_bf16 v[4:7], a[152:155], v[136:139], v[4:7]
  s_mul_i32 s35, s98, 20480
  s_lshl_b32 s38, s99, 6
  s_add_u32 s35, s35, s38
  v_exp_f32 v9, v9
  v_mfma_f32_16x16x32_bf16 v[4:7], a[156:159], v[140:143], v[4:7]
  ds_read_b128 a[132:135], v213 offset:40960
  s_add_u32 s35, s35, 2686976
  v_cvt_pk_bf16_f32 v8, v8, v9
  v_mfma_f32_16x16x32_bf16 v[12:15], a[156:159], v[156:159], v[196:199]
  v_exp_f32 v10, v10
  v_mfma_f32_16x16x32_bf16 v[12:15], a[152:155], v[152:155], v[12:15]
  ds_read_b128 a[136:139], v214 offset:40960
  v_add_f32 v228, v228, v238
  v_mfma_f32_16x16x32_bf16 v[12:15], a[148:151], v[148:151], v[12:15]
  v_exp_f32 v11, v11
  v_mfma_f32_16x16x32_bf16 v[12:15], a[144:147], v[144:147], v[12:15]
  ds_read_b128 a[140:143], v215 offset:40960
  v_cvt_pk_bf16_f32 v9, v10, v11
  v_mfma_f32_16x16x32_bf16 v[20:23], a[144:147], v[160:163], v[200:203]
  v_exp_f32 v16, v16
  v_mfma_f32_16x16x32_bf16 v[20:23], a[148:151], v[164:167], v[20:23]
  buffer_load_dwordx4 v237, s[16:19], s29 offen offset:3072 lds
  v_mfma_f32_16x16x32_bf16 v[20:23], a[152:155], v[168:171], v[20:23]
  s_add_u32 s29, s29, 16384
  v_exp_f32 v17, v17
  v_mfma_f32_16x16x32_bf16 v[20:23], a[156:159], v[172:175], v[20:23]
  v_cvt_pk_bf16_f32 v16, v16, v17
  v_add_f32 v229, v229, v239
  v_mfma_f32_16x16x32_bf16 v[28:31], a[156:159], v[188:191], v[204:207]
  s_add_u32 m0, s28, 16384
  v_exp_f32 v18, v18
  v_mfma_f32_16x16x32_bf16 v[28:31], a[152:155], v[184:187], v[28:31]
  buffer_load_dwordx4 v242, s[24:27], s9 offen offset:0 sc1 lds
  v_mfma_f32_16x16x32_bf16 v[28:31], a[148:151], v[180:183], v[28:31]
  s_waitcnt lgkmcnt(0)
  v_exp_f32 v19, v19
  v_mfma_f32_16x16x32_bf16 v[28:31], a[144:147], v[176:179], v[28:31]
  v_cvt_pk_bf16_f32 v17, v18, v19
  v_add_f32 v230, v230, v240
  v_mfma_f32_16x16x32_bf16 v[32:35], a[128:131], v[128:131], v[192:195]
  v_exp_f32 v24, v24
  v_mfma_f32_16x16x32_bf16 v[32:35], a[132:135], v[132:135], v[32:35]
  ds_read_b128 a[144:147], v212 offset:45056
  v_add_f32 v231, v231, v241
  v_mfma_f32_16x16x32_bf16 v[32:35], a[136:139], v[136:139], v[32:35]
  v_exp_f32 v25, v25
  v_mfma_f32_16x16x32_bf16 v[32:35], a[140:143], v[140:143], v[32:35]
  ds_read_b128 a[148:151], v213 offset:45056
  v_cvt_pk_bf16_f32 v24, v24, v25
  v_mfma_f32_16x16x32_bf16 v[40:43], a[140:143], v[156:159], v[196:199]
  v_exp_f32 v26, v26
  v_mfma_f32_16x16x32_bf16 v[40:43], a[136:139], v[152:155], v[40:43]
  ds_read_b128 a[152:155], v214 offset:45056
  v_add_f32 v228, v228, v208
  v_mfma_f32_16x16x32_bf16 v[40:43], a[132:135], v[148:151], v[40:43]
  v_exp_f32 v27, v27
  v_mfma_f32_16x16x32_bf16 v[40:43], a[128:131], v[144:147], v[40:43]
  ds_read_b128 a[156:159], v215 offset:45056
  v_cvt_pk_bf16_f32 v25, v26, v27
  v_mfma_f32_16x16x32_bf16 v[48:51], a[128:131], v[160:163], v[200:203]
  v_exp_f32 v4, v4
  v_mfma_f32_16x16x32_bf16 v[48:51], a[132:135], v[164:167], v[48:51]
  buffer_load_dwordx4 v242, s[24:27], s9 offen offset:1024 sc1 lds
  v_mfma_f32_16x16x32_bf16 v[48:51], a[136:139], v[168:171], v[48:51]
  v_exp_f32 v5, v5
  v_mfma_f32_16x16x32_bf16 v[48:51], a[140:143], v[172:175], v[48:51]
  v_cvt_pk_bf16_f32 v2, v4, v5
  v_add_f32 v229, v229, v209
  v_mfma_f32_16x16x32_bf16 v[56:59], a[140:143], v[188:191], v[204:207]
  v_exp_f32 v6, v6
  v_mfma_f32_16x16x32_bf16 v[56:59], a[136:139], v[184:187], v[56:59]
  buffer_load_dwordx4 v242, s[24:27], s9 offen offset:2048 sc1 lds
  v_mfma_f32_16x16x32_bf16 v[56:59], a[132:135], v[180:183], v[56:59]
  s_waitcnt lgkmcnt(0)
  v_exp_f32 v7, v7
  v_mfma_f32_16x16x32_bf16 v[56:59], a[128:131], v[176:179], v[56:59]
  v_cvt_pk_bf16_f32 v3, v6, v7
  v_add_f32 v230, v230, v210
  v_mfma_f32_16x16x32_bf16 v[36:39], a[144:147], v[128:131], v[192:195]
  v_exp_f32 v12, v12
  v_mfma_f32_16x16x32_bf16 v[36:39], a[148:151], v[132:135], v[36:39]
  ds_read_b64_tr_b16 a[160:161], v216 offset:16384
  v_add_f32 v231, v231, v211
  v_mfma_f32_16x16x32_bf16 v[36:39], a[152:155], v[136:139], v[36:39]
  v_exp_f32 v13, v13
  v_mfma_f32_16x16x32_bf16 v[36:39], a[156:159], v[140:143], v[36:39]
  ds_read_b64_tr_b16 a[162:163], v216 offset:20480
  v_cvt_pk_bf16_f32 v10, v12, v13
  v_mfma_f32_16x16x32_bf16 v[44:47], a[156:159], v[156:159], v[196:199]
  v_exp_f32 v14, v14
  v_mfma_f32_16x16x32_bf16 v[44:47], a[152:155], v[152:155], v[44:47]
  ds_read_b64_tr_b16 a[164:165], v216 offset:24576
  buffer_load_dwordx4 v242, s[24:27], s9 offen offset:3072 sc1 lds
  v_mfma_f32_16x16x32_bf16 v[44:47], a[148:151], v[148:151], v[44:47]
  v_exp_f32 v15, v15
  v_mfma_f32_16x16x32_bf16 v[44:47], a[144:147], v[144:147], v[44:47]
  ds_read_b64_tr_b16 a[166:167], v216 offset:28672
  v_cvt_pk_bf16_f32 v11, v14, v15
  v_mfma_f32_16x16x32_bf16 v[52:55], a[144:147], v[160:163], v[200:203]
  v_exp_f32 v20, v20
  v_mfma_f32_16x16x32_bf16 v[52:55], a[148:151], v[164:167], v[52:55]
  ds_read_b64_tr_b16 a[168:169], v217 offset:16384
  buffer_store_dwordx4 v[228:231], v225, s[24:27], s35 offen sc1
  v_mfma_f32_16x16x32_bf16 v[52:55], a[152:155], v[168:171], v[52:55]
  v_exp_f32 v21, v21
  v_mfma_f32_16x16x32_bf16 v[52:55], a[156:159], v[172:175], v[52:55]
  ds_read_b64_tr_b16 a[170:171], v217 offset:20480
  v_cvt_pk_bf16_f32 v18, v20, v21
  v_mfma_f32_16x16x32_bf16 v[60:63], a[156:159], v[188:191], v[204:207]
  v_exp_f32 v22, v22
  v_mfma_f32_16x16x32_bf16 v[60:63], a[152:155], v[184:187], v[60:63]
  ds_read_b64_tr_b16 a[172:173], v217 offset:24576
  buffer_load_dwordx4 a[212:215], v242, s[24:27], s4 offen offset:0 sc1
  v_mfma_f32_16x16x32_bf16 v[60:63], a[148:151], v[180:183], v[60:63]
  v_exp_f32 v23, v23
  v_mfma_f32_16x16x32_bf16 v[60:63], a[144:147], v[176:179], v[60:63]
  ds_read_b64_tr_b16 a[174:175], v217 offset:28672
  v_cvt_pk_bf16_f32 v19, v22, v23
  v_mfma_f32_16x16x32_bf16 a[192:195], a[208:211], v[64:67], a[192:195]
  v_exp_f32 v28, v28
  v_mfma_f32_16x16x32_bf16 a[192:195], a[208:211], v[96:99], a[192:195]
  ds_read_b64_tr_b16 a[176:177], v218 offset:16384
  buffer_load_dwordx4 a[216:219], v242, s[24:27], s4 offen offset:1024 sc1
  v_mfma_f32_16x16x32_bf16 a[196:199], a[208:211], v[72:75], a[196:199]
  v_exp_f32 v29, v29
  v_mfma_f32_16x16x32_bf16 a[196:199], a[208:211], v[104:107], a[196:199]
  ds_read_b64_tr_b16 a[178:179], v218 offset:20480
  v_cvt_pk_bf16_f32 v26, v28, v29
  v_mfma_f32_16x16x32_bf16 a[200:203], a[208:211], v[80:83], a[200:203]
  v_exp_f32 v30, v30
  v_mfma_f32_16x16x32_bf16 a[200:203], a[208:211], v[112:115], a[200:203]
  ds_read_b64_tr_b16 a[180:181], v218 offset:24576
  v_mfma_f32_16x16x32_bf16 a[204:207], a[208:211], v[88:91], a[204:207]
  s_waitcnt lgkmcnt(7)
  v_exp_f32 v31, v31
  v_mfma_f32_16x16x32_bf16 a[204:207], a[208:211], v[120:123], a[204:207]
  ds_read_b64_tr_b16 a[182:183], v218 offset:28672
  v_cvt_pk_bf16_f32 v27, v30, v31
  v_mfma_f32_16x16x32_bf16 a[0:3], a[160:163], v[64:67], a[0:3]
  v_exp_f32 v32, v32
  v_mfma_f32_16x16x32_bf16 a[0:3], a[164:167], v[96:99], a[0:3]
  ds_read_b64_tr_b16 a[184:185], v219 offset:16384
  buffer_load_dwordx4 a[220:223], v242, s[24:27], s4 offen offset:2048 sc1
  v_mfma_f32_16x16x32_bf16 a[4:7], a[164:167], v[104:107], a[4:7]
  v_exp_f32 v33, v33
  v_mfma_f32_16x16x32_bf16 a[4:7], a[160:163], v[72:75], a[4:7]
  ds_read_b64_tr_b16 a[186:187], v219 offset:20480
  v_cvt_pk_bf16_f32 v32, v32, v33
  v_mfma_f32_16x16x32_bf16 a[8:11], a[160:163], v[80:83], a[8:11]
  v_exp_f32 v34, v34
  v_mfma_f32_16x16x32_bf16 a[8:11], a[164:167], v[112:115], a[8:11]
  ds_read_b64_tr_b16 a[188:189], v219 offset:24576
  v_mfma_f32_16x16x32_bf16 a[12:15], a[164:167], v[120:123], a[12:15]
  s_waitcnt lgkmcnt(7)
  v_exp_f32 v35, v35
  v_mfma_f32_16x16x32_bf16 a[12:15], a[160:163], v[88:91], a[12:15]
  ds_read_b64_tr_b16 a[190:191], v219 offset:28672
  v_cvt_pk_bf16_f32 v33, v34, v35
  v_mfma_f32_16x16x32_bf16 a[16:19], a[168:171], v[64:67], a[16:19]
  v_exp_f32 v40, v40
  v_mfma_f32_16x16x32_bf16 a[16:19], a[172:175], v[96:99], a[16:19]
  ds_read_b64_tr_b16 a[160:161], v220 offset:16384
  buffer_load_dwordx4 a[224:227], v242, s[24:27], s4 offen offset:3072 sc1
  v_mfma_f32_16x16x32_bf16 a[20:23], a[172:175], v[104:107], a[20:23]
  v_exp_f32 v41, v41
  v_mfma_f32_16x16x32_bf16 a[20:23], a[168:171], v[72:75], a[20:23]
  ds_read_b64_tr_b16 a[162:163], v220 offset:20480
  v_cvt_pk_bf16_f32 v40, v40, v41
  v_mfma_f32_16x16x32_bf16 a[24:27], a[168:171], v[80:83], a[24:27]
  v_exp_f32 v42, v42
  v_mfma_f32_16x16x32_bf16 a[24:27], a[172:175], v[112:115], a[24:27]
  ds_read_b64_tr_b16 a[164:165], v220 offset:24576
  v_mfma_f32_16x16x32_bf16 a[28:31], a[172:175], v[120:123], a[28:31]
  s_waitcnt lgkmcnt(7)
  v_exp_f32 v43, v43
  v_mfma_f32_16x16x32_bf16 a[28:31], a[168:171], v[88:91], a[28:31]
  ds_read_b64_tr_b16 a[166:167], v220 offset:28672
  v_cvt_pk_bf16_f32 v41, v42, v43
  v_mfma_f32_16x16x32_bf16 a[32:35], a[176:179], v[64:67], a[32:35]
  v_exp_f32 v48, v48
  v_mfma_f32_16x16x32_bf16 a[32:35], a[180:183], v[96:99], a[32:35]
  ds_read_b64_tr_b16 a[168:169], v221 offset:16384
  buffer_load_dwordx4 a[228:231], v252, s[24:27], s4 offen offset:0 sc1
  v_mfma_f32_16x16x32_bf16 a[36:39], a[180:183], v[104:107], a[36:39]
  v_exp_f32 v49, v49
  v_mfma_f32_16x16x32_bf16 a[36:39], a[176:179], v[72:75], a[36:39]
  ds_read_b64_tr_b16 a[170:171], v221 offset:20480
  v_cvt_pk_bf16_f32 v48, v48, v49
  v_mfma_f32_16x16x32_bf16 a[40:43], a[176:179], v[80:83], a[40:43]
  v_exp_f32 v50, v50
  v_mfma_f32_16x16x32_bf16 a[40:43], a[180:183], v[112:115], a[40:43]
  ds_read_b64_tr_b16 a[172:173], v221 offset:24576
  v_mfma_f32_16x16x32_bf16 a[44:47], a[180:183], v[120:123], a[44:47]
  s_waitcnt lgkmcnt(7)
  v_exp_f32 v51, v51
  v_mfma_f32_16x16x32_bf16 a[44:47], a[176:179], v[88:91], a[44:47]
  ds_read_b64_tr_b16 a[174:175], v221 offset:28672
  v_cvt_pk_bf16_f32 v49, v50, v51
  v_mfma_f32_16x16x32_bf16 a[48:51], a[184:187], v[64:67], a[48:51]
  v_exp_f32 v56, v56
  v_mfma_f32_16x16x32_bf16 a[48:51], a[188:191], v[96:99], a[48:51]
  ds_read_b64_tr_b16 a[176:177], v222 offset:16384
  buffer_load_dwordx4 a[232:235], v252, s[24:27], s4 offen offset:1024 sc1
  v_mfma_f32_16x16x32_bf16 a[52:55], a[188:191], v[104:107], a[52:55]
  v_exp_f32 v57, v57
  v_mfma_f32_16x16x32_bf16 a[52:55], a[184:187], v[72:75], a[52:55]
  ds_read_b64_tr_b16 a[178:179], v222 offset:20480
  v_cvt_pk_bf16_f32 v56, v56, v57
  v_mfma_f32_16x16x32_bf16 a[56:59], a[184:187], v[80:83], a[56:59]
  v_exp_f32 v58, v58
  v_mfma_f32_16x16x32_bf16 a[56:59], a[188:191], v[112:115], a[56:59]
  ds_read_b64_tr_b16 a[180:181], v222 offset:24576
  v_mfma_f32_16x16x32_bf16 a[60:63], a[188:191], v[120:123], a[60:63]
  s_waitcnt lgkmcnt(7)
  v_exp_f32 v59, v59
  v_mfma_f32_16x16x32_bf16 a[60:63], a[184:187], v[88:91], a[60:63]
  ds_read_b64_tr_b16 a[182:183], v222 offset:28672
  v_cvt_pk_bf16_f32 v57, v58, v59
  v_mfma_f32_16x16x32_bf16 a[64:67], a[160:163], v[64:67], a[64:67]
  v_exp_f32 v36, v36
  v_mfma_f32_16x16x32_bf16 a[64:67], a[164:167], v[96:99], a[64:67]
  ds_read_b64_tr_b16 a[184:185], v223 offset:16384
  v_mfma_f32_16x16x32_bf16 a[68:71], a[164:167], v[104:107], a[68:71]
  v_exp_f32 v37, v37
  v_mfma_f32_16x16x32_bf16 a[68:71], a[160:163], v[72:75], a[68:71]
  ds_read_b64_tr_b16 a[186:187], v223 offset:20480
  v_cvt_pk_bf16_f32 v34, v36, v37
  v_mfma_f32_16x16x32_bf16 a[72:75], a[160:163], v[80:83], a[72:75]
  v_exp_f32 v38, v38
  v_mfma_f32_16x16x32_bf16 a[72:75], a[164:167], v[112:115], a[72:75]
  ds_read_b64_tr_b16 a[188:189], v223 offset:24576
  v_mfma_f32_16x16x32_bf16 a[76:79], a[164:167], v[120:123], a[76:79]
  s_waitcnt lgkmcnt(7)
  v_exp_f32 v39, v39
  v_mfma_f32_16x16x32_bf16 a[76:79], a[160:163], v[88:91], a[76:79]
  ds_read_b64_tr_b16 a[190:191], v223 offset:28672
  v_cvt_pk_bf16_f32 v35, v38, v39
  v_mfma_f32_16x16x32_bf16 a[80:83], a[168:171], v[64:67], a[80:83]
  s_waitcnt vmcnt(19)
  v_exp_f32 v44, v44
  v_mfma_f32_16x16x32_bf16 a[80:83], a[172:175], v[96:99], a[80:83]
  v_mfma_f32_16x16x32_bf16 a[84:87], a[172:175], v[104:107], a[84:87]
  s_barrier
  v_exp_f32 v45, v45
  v_mfma_f32_16x16x32_bf16 a[84:87], a[168:171], v[72:75], a[84:87]
  ds_read_b128 a[128:131], v212 offset:49152
  v_cvt_pk_bf16_f32 v42, v44, v45
  v_mfma_f32_16x16x32_bf16 a[88:91], a[168:171], v[80:83], a[88:91]
  v_exp_f32 v46, v46
  v_mfma_f32_16x16x32_bf16 a[88:91], a[172:175], v[112:115], a[88:91]
  ds_read_b128 a[132:135], v213 offset:49152
  v_mfma_f32_16x16x32_bf16 a[92:95], a[172:175], v[120:123], a[92:95]
  s_waitcnt lgkmcnt(6)
  v_exp_f32 v47, v47
  v_mfma_f32_16x16x32_bf16 a[92:95], a[168:171], v[88:91], a[92:95]
  ds_read_b128 a[136:139], v214 offset:49152
  v_cvt_pk_bf16_f32 v43, v46, v47
  v_mfma_f32_16x16x32_bf16 a[96:99], a[176:179], v[64:67], a[96:99]
  v_exp_f32 v52, v52
  v_mfma_f32_16x16x32_bf16 a[96:99], a[180:183], v[96:99], a[96:99]
  ds_read_b128 a[140:143], v215 offset:49152
  v_mfma_f32_16x16x32_bf16 a[100:103], a[180:183], v[104:107], a[100:103]
  v_exp_f32 v53, v53
  v_mfma_f32_16x16x32_bf16 a[100:103], a[176:179], v[72:75], a[100:103]
  v_cvt_pk_bf16_f32 v50, v52, v53
  v_mfma_f32_16x16x32_bf16 a[104:107], a[176:179], v[80:83], a[104:107]
  v_exp_f32 v54, v54
  v_mfma_f32_16x16x32_bf16 a[104:107], a[180:183], v[112:115], a[104:107]
  v_mfma_f32_16x16x32_bf16 a[108:111], a[180:183], v[120:123], a[108:111]
  s_waitcnt lgkmcnt(4)
  v_exp_f32 v55, v55
  v_mfma_f32_16x16x32_bf16 a[108:111], a[176:179], v[88:91], a[108:111]
  v_cvt_pk_bf16_f32 v51, v54, v55
  v_mfma_f32_16x16x32_bf16 a[112:115], a[184:187], v[64:67], a[112:115]
  v_exp_f32 v60, v60
  v_mfma_f32_16x16x32_bf16 a[112:115], a[188:191], v[96:99], a[112:115]
  v_mfma_f32_16x16x32_bf16 a[116:119], a[188:191], v[104:107], a[116:119]
  v_exp_f32 v61, v61
  v_mfma_f32_16x16x32_bf16 a[116:119], a[184:187], v[72:75], a[116:119]
  v_cvt_pk_bf16_f32 v58, v60, v61
  v_mfma_f32_16x16x32_bf16 a[120:123], a[184:187], v[80:83], a[120:123]
  v_exp_f32 v62, v62
  v_mfma_f32_16x16x32_bf16 a[120:123], a[188:191], v[112:115], a[120:123]
  v_mfma_f32_16x16x32_bf16 a[124:127], a[188:191], v[120:123], a[124:127]
  s_waitcnt lgkmcnt(0)
  v_exp_f32 v63, v63
  v_mfma_f32_16x16x32_bf16 a[124:127], a[184:187], v[88:91], a[124:127]
  v_cvt_pk_bf16_f32 v59, v62, v63
  v_mfma_f32_16x16x32_bf16 v[64:67], a[128:131], v[128:131], v[192:195]
  s_add_u32 m0, s28, 65536
  v_mfma_f32_16x16x32_bf16 v[64:67], a[132:135], v[132:135], v[64:67]
  ds_read_b128 a[144:147], v212 offset:53248
  v_mfma_f32_16x16x32_bf16 v[64:67], a[136:139], v[136:139], v[64:67]
  buffer_load_dwordx4 v253, s[24:27], s9 offen offset:0 sc1 lds
  v_mfma_f32_16x16x32_bf16 v[64:67], a[140:143], v[140:143], v[64:67]
  ds_read_b128 a[148:151], v213 offset:53248
  v_mfma_f32_16x16x32_bf16 v[72:75], a[140:143], v[156:159], v[196:199]
  v_mfma_f32_16x16x32_bf16 v[72:75], a[136:139], v[152:155], v[72:75]
  ds_read_b128 a[152:155], v214 offset:53248
  v_mfma_f32_16x16x32_bf16 v[72:75], a[132:135], v[148:151], v[72:75]
  buffer_load_dwordx4 v253, s[24:27], s9 offen offset:1024 sc1 lds
  v_mfma_f32_16x16x32_bf16 v[72:75], a[128:131], v[144:147], v[72:75]
  ds_read_b128 a[156:159], v215 offset:53248
  v_mfma_f32_16x16x32_bf16 v[80:83], a[128:131], v[160:163], v[200:203]
  v_exp_f32 v64, v64
  v_mfma_f32_16x16x32_bf16 v[80:83], a[132:135], v[164:167], v[80:83]
  v_mfma_f32_16x16x32_bf16 v[80:83], a[136:139], v[168:171], v[80:83]
  v_exp_f32 v65, v65
  v_mfma_f32_16x16x32_bf16 v[80:83], a[140:143], v[172:175], v[80:83]
  v_cvt_pk_bf16_f32 v64, v64, v65
  v_mfma_f32_16x16x32_bf16 v[88:91], a[140:143], v[188:191], v[204:207]
  v_exp_f32 v66, v66
  v_mfma_f32_16x16x32_bf16 v[88:91], a[136:139], v[184:187], v[88:91]
  buffer_load_dwordx4 v253, s[24:27], s9 offen offset:2048 sc1 lds
  v_mfma_f32_16x16x32_bf16 v[88:91], a[132:135], v[180:183], v[88:91]
  s_waitcnt lgkmcnt(0)
  v_exp_f32 v67, v67
  v_mfma_f32_16x16x32_bf16 v[88:91], a[128:131], v[176:179], v[88:91]
  v_cvt_pk_bf16_f32 v65, v66, v67
  v_mfma_f32_16x16x32_bf16 v[68:71], a[144:147], v[128:131], v[192:195]
  v_exp_f32 v72, v72
  v_mfma_f32_16x16x32_bf16 v[68:71], a[148:151], v[132:135], v[68:71]
  ds_read_b128 a[128:131], v212 offset:57344
  v_mfma_f32_16x16x32_bf16 v[68:71], a[152:155], v[136:139], v[68:71]
  v_exp_f32 v73, v73
  v_mfma_f32_16x16x32_bf16 v[68:71], a[156:159], v[140:143], v[68:71]
  ds_read_b128 a[132:135], v213 offset:57344
  v_cvt_pk_bf16_f32 v72, v72, v73
  v_mfma_f32_16x16x32_bf16 v[76:79], a[156:159], v[156:159], v[196:199]
  v_exp_f32 v74, v74
  v_mfma_f32_16x16x32_bf16 v[76:79], a[152:155], v[152:155], v[76:79]
  ds_read_b128 a[136:139], v214 offset:57344
  v_mfma_f32_16x16x32_bf16 v[76:79], a[148:151], v[148:151], v[76:79]
  v_exp_f32 v75, v75
  v_mfma_f32_16x16x32_bf16 v[76:79], a[144:147], v[144:147], v[76:79]
  ds_read_b128 a[140:143], v215 offset:57344
  v_cvt_pk_bf16_f32 v73, v74, v75
  v_mfma_f32_16x16x32_bf16 v[84:87], a[144:147], v[160:163], v[200:203]
  v_exp_f32 v80, v80
  v_mfma_f32_16x16x32_bf16 v[84:87], a[148:151], v[164:167], v[84:87]
  buffer_load_dwordx4 v253, s[24:27], s9 offen offset:3072 sc1 lds
  v_mfma_f32_16x16x32_bf16 v[84:87], a[152:155], v[168:171], v[84:87]
  s_add_u32 s29, s29, 16384
  v_exp_f32 v81, v81
  v_mfma_f32_16x16x32_bf16 v[84:87], a[156:159], v[172:175], v[84:87]
  v_cvt_pk_bf16_f32 v80, v80, v81
  v_mfma_f32_16x16x32_bf16 v[92:95], a[156:159], v[188:191], v[204:207]
  s_add_u32 m0, s28, 32768
  v_exp_f32 v82, v82
  v_mfma_f32_16x16x32_bf16 v[92:95], a[152:155], v[184:187], v[92:95]
  buffer_load_dwordx4 v252, s[24:27], s9 offen offset:0 sc1 lds
  v_mfma_f32_16x16x32_bf16 v[92:95], a[148:151], v[180:183], v[92:95]
  s_waitcnt lgkmcnt(0)
  v_exp_f32 v83, v83
  v_mfma_f32_16x16x32_bf16 v[92:95], a[144:147], v[176:179], v[92:95]
  v_cvt_pk_bf16_f32 v81, v82, v83
  v_mfma_f32_16x16x32_bf16 v[96:99], a[128:131], v[128:131], v[192:195]
  v_exp_f32 v88, v88
  v_mfma_f32_16x16x32_bf16 v[96:99], a[132:135], v[132:135], v[96:99]
  ds_read_b128 a[144:147], v212 offset:61440
  v_mfma_f32_16x16x32_bf16 v[96:99], a[136:139], v[136:139], v[96:99]
  v_exp_f32 v89, v89
  v_mfma_f32_16x16x32_bf16 v[96:99], a[140:143], v[140:143], v[96:99]
  ds_read_b128 a[148:151], v213 offset:61440
  v_cvt_pk_bf16_f32 v88, v88, v89
  v_mfma_f32_16x16x32_bf16 v[104:107], a[140:143], v[156:159], v[196:199]
  v_exp_f32 v90, v90
  v_mfma_f32_16x16x32_bf16 v[104:107], a[136:139], v[152:155], v[104:107]
  ds_read_b128 a[152:155], v214 offset:61440
  v_mfma_f32_16x16x32_bf16 v[104:107], a[132:135], v[148:151], v[104:107]
  v_exp_f32 v91, v91
  v_mfma_f32_16x16x32_bf16 v[104:107], a[128:131], v[144:147], v[104:107]
  ds_read_b128 a[156:159], v215 offset:61440
  v_cvt_pk_bf16_f32 v89, v90, v91
  v_mfma_f32_16x16x32_bf16 v[112:115], a[128:131], v[160:163], v[200:203]
  v_exp_f32 v68, v68
  v_mfma_f32_16x16x32_bf16 v[112:115], a[132:135], v[164:167], v[112:115]
  buffer_load_dwordx4 v252, s[24:27], s9 offen offset:1024 sc1 lds
  v_mfma_f32_16x16x32_bf16 v[112:115], a[136:139], v[168:171], v[112:115]
  v_exp_f32 v69, v69
  v_mfma_f32_16x16x32_bf16 v[112:115], a[140:143], v[172:175], v[112:115]
  v_cvt_pk_bf16_f32 v66, v68, v69
  v_mfma_f32_16x16x32_bf16 v[120:123], a[140:143], v[188:191], v[204:207]
  v_exp_f32 v70, v70
  v_mfma_f32_16x16x32_bf16 v[120:123], a[136:139], v[184:187], v[120:123]
  buffer_load_dwordx4 v252, s[24:27], s9 offen offset:2048 sc1 lds
  v_mfma_f32_16x16x32_bf16 v[120:123], a[132:135], v[180:183], v[120:123]
  s_waitcnt lgkmcnt(0)
  v_exp_f32 v71, v71
  v_mfma_f32_16x16x32_bf16 v[120:123], a[128:131], v[176:179], v[120:123]
  v_cvt_pk_bf16_f32 v67, v70, v71
  v_mfma_f32_16x16x32_bf16 v[100:103], a[144:147], v[128:131], v[192:195]
  v_exp_f32 v76, v76
  v_mfma_f32_16x16x32_bf16 v[100:103], a[148:151], v[132:135], v[100:103]
  ds_read_b64_tr_b16 a[160:161], v216 offset:32768
  v_mfma_f32_16x16x32_bf16 v[100:103], a[152:155], v[136:139], v[100:103]
  v_exp_f32 v77, v77
  v_mfma_f32_16x16x32_bf16 v[100:103], a[156:159], v[140:143], v[100:103]
  ds_read_b64_tr_b16 a[162:163], v216 offset:36864
  v_cvt_pk_bf16_f32 v74, v76, v77
  v_mfma_f32_16x16x32_bf16 v[108:111], a[156:159], v[156:159], v[196:199]
  v_exp_f32 v78, v78
  v_mfma_f32_16x16x32_bf16 v[108:111], a[152:155], v[152:155], v[108:111]
  ds_read_b64_tr_b16 a[164:165], v216 offset:40960
  buffer_load_dwordx4 v252, s[24:27], s9 offen offset:3072 sc1 lds
  v_mfma_f32_16x16x32_bf16 v[108:111], a[148:151], v[148:151], v[108:111]
  v_exp_f32 v79, v79
  v_mfma_f32_16x16x32_bf16 v[108:111], a[144:147], v[144:147], v[108:111]
  ds_read_b64_tr_b16 a[166:167], v216 offset:45056
  v_cvt_pk_bf16_f32 v75, v78, v79
  v_mfma_f32_16x16x32_bf16 v[116:119], a[144:147], v[160:163], v[200:203]
  v_exp_f32 v84, v84
  v_mfma_f32_16x16x32_bf16 v[116:119], a[148:151], v[164:167], v[116:119]
  ds_read_b64_tr_b16 a[168:169], v217 offset:32768
  buffer_load_dwordx4 a[236:239], v252, s[24:27], s4 offen offset:2048 sc1
  v_mfma_f32_16x16x32_bf16 v[116:119], a[152:155], v[168:171], v[116:119]
  v_exp_f32 v85, v85
  v_mfma_f32_16x16x32_bf16 v[116:119], a[156:159], v[172:175], v[116:119]
  ds_read_b64_tr_b16 a[170:171], v217 offset:36864
  v_cvt_pk_bf16_f32 v82, v84, v85
  v_mfma_f32_16x16x32_bf16 v[124:127], a[156:159], v[188:191], v[204:207]
  v_exp_f32 v86, v86
  v_mfma_f32_16x16x32_bf16 v[124:127], a[152:155], v[184:187], v[124:127]
  ds_read_b64_tr_b16 a[172:173], v217 offset:40960
  buffer_load_dwordx4 a[240:243], v252, s[24:27], s4 offen offset:3072 sc1
  v_mfma_f32_16x16x32_bf16 v[124:127], a[148:151], v[180:183], v[124:127]
  v_exp_f32 v87, v87
  v_mfma_f32_16x16x32_bf16 v[124:127], a[144:147], v[176:179], v[124:127]
  ds_read_b64_tr_b16 a[174:175], v217 offset:45056
  v_cvt_pk_bf16_f32 v83, v86, v87
  v_mfma_f32_16x16x32_bf16 a[192:195], a[208:211], v[0:3], a[192:195]
  v_exp_f32 v92, v92
  v_mfma_f32_16x16x32_bf16 a[192:195], a[208:211], v[32:35], a[192:195]
  ds_read_b64_tr_b16 a[176:177], v218 offset:32768
  buffer_load_dwordx4 a[244:247], v253, s[24:27], s4 offen offset:0 sc1
  v_mfma_f32_16x16x32_bf16 a[196:199], a[208:211], v[8:11], a[196:199]
  v_exp_f32 v93, v93
  v_mfma_f32_16x16x32_bf16 a[196:199], a[208:211], v[40:43], a[196:199]
  ds_read_b64_tr_b16 a[178:179], v218 offset:36864
  v_cvt_pk_bf16_f32 v90, v92, v93
  v_mfma_f32_16x16x32_bf16 a[200:203], a[208:211], v[16:19], a[200:203]
  v_exp_f32 v94, v94
  v_mfma_f32_16x16x32_bf16 a[200:203], a[208:211], v[48:51], a[200:203]
  ds_read_b64_tr_b16 a[180:181], v218 offset:40960
  buffer_load_dwordx4 a[248:251], v253, s[24:27], s4 offen offset:1024 sc1
  v_mfma_f32_16x16x32_bf16 a[204:207], a[208:211], v[24:27], a[204:207]
  s_waitcnt lgkmcnt(7)
  v_exp_f32 v95, v95
  v_mfma_f32_16x16x32_bf16 a[204:207], a[208:211], v[56:59], a[204:207]
  ds_read_b64_tr_b16 a[182:183], v218 offset:45056
  v_cvt_pk_bf16_f32 v91, v94, v95
  v_mfma_f32_16x16x32_bf16 a[0:3], a[160:163], v[0:3], a[0:3]
  v_exp_f32 v96, v96
  v_mfma_f32_16x16x32_bf16 a[0:3], a[164:167], v[32:35], a[0:3]
  ds_read_b64_tr_b16 a[184:185], v219 offset:32768
  buffer_load_dwordx4 a[252:255], v253, s[24:27], s4 offen offset:2048 sc1
  v_mfma_f32_16x16x32_bf16 a[4:7], a[164:167], v[40:43], a[4:7]
  v_exp_f32 v97, v97
  v_mfma_f32_16x16x32_bf16 a[4:7], a[160:163], v[8:11], a[4:7]
  ds_read_b64_tr_b16 a[186:187], v219 offset:36864
  v_cvt_pk_bf16_f32 v96, v96, v97
  v_mfma_f32_16x16x32_bf16 a[8:11], a[160:163], v[16:19], a[8:11]
  v_exp_f32 v98, v98
  v_mfma_f32_16x16x32_bf16 a[8:11], a[164:167], v[48:51], a[8:11]
  ds_read_b64_tr_b16 a[188:189], v219 offset:40960
  buffer_load_dwordx4 a[128:131], v253, s[24:27], s4 offen offset:3072 sc1
  v_mfma_f32_16x16x32_bf16 a[12:15], a[164:167], v[56:59], a[12:15]
  s_waitcnt lgkmcnt(7)
  v_exp_f32 v99, v99
  v_mfma_f32_16x16x32_bf16 a[12:15], a[160:163], v[24:27], a[12:15]
  ds_read_b64_tr_b16 a[190:191], v219 offset:45056
  v_cvt_pk_bf16_f32 v97, v98, v99
  v_mfma_f32_16x16x32_bf16 a[16:19], a[168:171], v[0:3], a[16:19]
  v_exp_f32 v104, v104
  v_mfma_f32_16x16x32_bf16 a[16:19], a[172:175], v[32:35], a[16:19]
  ds_read_b64_tr_b16 a[160:161], v220 offset:32768
  buffer_load_dwordx4 a[132:135], v242, s[24:27], s5 offen offset:0 sc1
  v_mfma_f32_16x16x32_bf16 a[20:23], a[172:175], v[40:43], a[20:23]
  v_exp_f32 v105, v105
  v_mfma_f32_16x16x32_bf16 a[20:23], a[168:171], v[8:11], a[20:23]
  ds_read_b64_tr_b16 a[162:163], v220 offset:36864
  v_cvt_pk_bf16_f32 v104, v104, v105
  v_mfma_f32_16x16x32_bf16 a[24:27], a[168:171], v[16:19], a[24:27]
  v_exp_f32 v106, v106
  v_mfma_f32_16x16x32_bf16 a[24:27], a[172:175], v[48:51], a[24:27]
  ds_read_b64_tr_b16 a[164:165], v220 offset:40960
  buffer_load_dwordx4 a[136:139], v242, s[24:27], s5 offen offset:1024 sc1
  v_mfma_f32_16x16x32_bf16 a[28:31], a[172:175], v[56:59], a[28:31]
  s_waitcnt lgkmcnt(7)
  v_exp_f32 v107, v107
  v_mfma_f32_16x16x32_bf16 a[28:31], a[168:171], v[24:27], a[28:31]
  ds_read_b64_tr_b16 a[166:167], v220 offset:45056
  v_cvt_pk_bf16_f32 v105, v106, v107
  v_mfma_f32_16x16x32_bf16 a[32:35], a[176:179], v[0:3], a[32:35]
  v_exp_f32 v112, v112
  v_mfma_f32_16x16x32_bf16 a[32:35], a[180:183], v[32:35], a[32:35]
  ds_read_b64_tr_b16 a[168:169], v221 offset:32768
  buffer_load_dwordx4 a[140:143], v242, s[24:27], s5 offen offset:2048 sc1
  v_mfma_f32_16x16x32_bf16 a[36:39], a[180:183], v[40:43], a[36:39]
  v_exp_f32 v113, v113
  v_mfma_f32_16x16x32_bf16 a[36:39], a[176:179], v[8:11], a[36:39]
  ds_read_b64_tr_b16 a[170:171], v221 offset:36864
  v_cvt_pk_bf16_f32 v112, v112, v113
  v_mfma_f32_16x16x32_bf16 a[40:43], a[176:179], v[16:19], a[40:43]
  v_exp_f32 v114, v114
  v_mfma_f32_16x16x32_bf16 a[40:43], a[180:183], v[48:51], a[40:43]
  ds_read_b64_tr_b16 a[172:173], v221 offset:40960
  buffer_load_dwordx4 a[144:147], v242, s[24:27], s5 offen offset:3072 sc1
  v_mfma_f32_16x16x32_bf16 a[44:47], a[180:183], v[56:59], a[44:47]
  s_waitcnt lgkmcnt(7)
  v_exp_f32 v115, v115
  v_mfma_f32_16x16x32_bf16 a[44:47], a[176:179], v[24:27], a[44:47]
  ds_read_b64_tr_b16 a[174:175], v221 offset:45056
  v_cvt_pk_bf16_f32 v113, v114, v115
  v_mfma_f32_16x16x32_bf16 a[48:51], a[184:187], v[0:3], a[48:51]
  v_exp_f32 v120, v120
  v_mfma_f32_16x16x32_bf16 a[48:51], a[188:191], v[32:35], a[48:51]
  ds_read_b64_tr_b16 a[176:177], v222 offset:32768
  buffer_load_dwordx4 a[148:151], v252, s[24:27], s5 offen offset:0 sc1
  v_mfma_f32_16x16x32_bf16 a[52:55], a[188:191], v[40:43], a[52:55]
  v_exp_f32 v121, v121
  v_mfma_f32_16x16x32_bf16 a[52:55], a[184:187], v[8:11], a[52:55]
  ds_read_b64_tr_b16 a[178:179], v222 offset:36864
  v_cvt_pk_bf16_f32 v120, v120, v121
  v_mfma_f32_16x16x32_bf16 a[56:59], a[184:187], v[16:19], a[56:59]
  v_exp_f32 v122, v122
  v_mfma_f32_16x16x32_bf16 a[56:59], a[188:191], v[48:51], a[56:59]
  ds_read_b64_tr_b16 a[180:181], v222 offset:40960
  v_mfma_f32_16x16x32_bf16 a[60:63], a[188:191], v[56:59], a[60:63]
  s_waitcnt lgkmcnt(7)
  v_exp_f32 v123, v123
  v_mfma_f32_16x16x32_bf16 a[60:63], a[184:187], v[24:27], a[60:63]
  ds_read_b64_tr_b16 a[182:183], v222 offset:45056
  v_cvt_pk_bf16_f32 v121, v122, v123
  v_mfma_f32_16x16x32_bf16 a[64:67], a[160:163], v[0:3], a[64:67]
  v_exp_f32 v100, v100
  v_mfma_f32_16x16x32_bf16 a[64:67], a[164:167], v[32:35], a[64:67]
  ds_read_b64_tr_b16 a[184:185], v223 offset:32768
  buffer_load_dwordx4 a[152:155], v252, s[24:27], s5 offen offset:1024 sc1
  v_mfma_f32_16x16x32_bf16 a[68:71], a[164:167], v[40:43], a[68:71]
  v_exp_f32 v101, v101
  v_mfma_f32_16x16x32_bf16 a[68:71], a[160:163], v[8:11], a[68:71]
  ds_read_b64_tr_b16 a[186:187], v223 offset:36864
  v_cvt_pk_bf16_f32 v98, v100, v101
  v_mfma_f32_16x16x32_bf16 a[72:75], a[160:163], v[16:19], a[72:75]
  v_exp_f32 v102, v102
  v_mfma_f32_16x16x32_bf16 a[72:75], a[164:167], v[48:51], a[72:75]
  ds_read_b64_tr_b16 a[188:189], v223 offset:40960
  buffer_load_dwordx4 a[156:159], v252, s[24:27], s5 offen offset:2048 sc1
  v_mfma_f32_16x16x32_bf16 a[76:79], a[164:167], v[56:59], a[76:79]
  s_waitcnt lgkmcnt(7)
  v_exp_f32 v103, v103
  v_mfma_f32_16x16x32_bf16 a[76:79], a[160:163], v[24:27], a[76:79]
  ds_read_b64_tr_b16 a[190:191], v223 offset:45056
  v_cvt_pk_bf16_f32 v99, v102, v103
  v_mfma_f32_16x16x32_bf16 a[80:83], a[168:171], v[0:3], a[80:83]
  s_waitcnt vmcnt(27)
  v_exp_f32 v108, v108
  v_mfma_f32_16x16x32_bf16 a[80:83], a[172:175], v[32:35], a[80:83]
  buffer_load_dwordx4 v[128:131], v252, s[24:27], s5 offen offset:3072 sc1
  v_mfma_f32_16x16x32_bf16 a[84:87], a[172:175], v[40:43], a[84:87]
  s_barrier
  v_exp_f32 v109, v109
  v_mfma_f32_16x16x32_bf16 a[84:87], a[168:171], v[8:11], a[84:87]
  s_mul_i32 s39, s99, 13108
  s_lshr_b32 s39, s39, 16
  s_lshl_b32 s39, s39, 8
  v_cvt_pk_bf16_f32 v106, v108, v109
  v_mfma_f32_16x16x32_bf16 a[88:91], a[168:171], v[16:19], a[88:91]
  s_add_u32 s39, s39, 2818304
  s_cmp_lt_u32 s2, 240
  s_cselect_b32 s48, 0, 1073741824
  v_exp_f32 v110, v110
  v_mfma_f32_16x16x32_bf16 a[88:91], a[172:175], v[48:51], a[88:91]
  buffer_load_dwordx4 v[132:135], v253, s[24:27], s5 offen offset:0 sc1
  v_mfma_f32_16x16x32_bf16 a[92:95], a[172:175], v[56:59], a[92:95]
  s_waitcnt lgkmcnt(4)
  v_exp_f32 v111, v111
  v_mfma_f32_16x16x32_bf16 a[92:95], a[168:171], v[24:27], a[92:95]
  v_cvt_pk_bf16_f32 v107, v110, v111
  v_or_b32 v249, s48, v251
  v_mfma_f32_16x16x32_bf16 a[96:99], a[176:179], v[0:3], a[96:99]
  v_exp_f32 v116, v116
  v_mfma_f32_16x16x32_bf16 a[96:99], a[180:183], v[32:35], a[96:99]
  buffer_atomic_add v250, v249, s[24:27], s39 offen
  v_mfma_f32_16x16x32_bf16 a[100:103], a[180:183], v[40:43], a[100:103]
  v_exp_f32 v117, v117
  v_mfma_f32_16x16x32_bf16 a[100:103], a[176:179], v[8:11], a[100:103]
  buffer_load_dwordx4 v[136:139], v253, s[24:27], s5 offen offset:1024 sc1
  v_cvt_pk_bf16_f32 v114, v116, v117
  v_mfma_f32_16x16x32_bf16 a[104:107], a[176:179], v[16:19], a[104:107]
  v_exp_f32 v118, v118
  v_mfma_f32_16x16x32_bf16 a[104:107], a[180:183], v[48:51], a[104:107]
  v_mfma_f32_16x16x32_bf16 a[108:111], a[180:183], v[56:59], a[108:111]
  s_waitcnt lgkmcnt(0)
  v_exp_f32 v119, v119
  v_mfma_f32_16x16x32_bf16 a[108:111], a[176:179], v[24:27], a[108:111]
  buffer_load_dwordx4 v[140:143], v253, s[24:27], s5 offen offset:2048 sc1
  v_cvt_pk_bf16_f32 v115, v118, v119
  v_mfma_f32_16x16x32_bf16 a[112:115], a[184:187], v[0:3], a[112:115]
  v_exp_f32 v124, v124
  v_mfma_f32_16x16x32_bf16 a[112:115], a[188:191], v[32:35], a[112:115]
  v_mfma_f32_16x16x32_bf16 a[116:119], a[188:191], v[40:43], a[116:119]
  v_exp_f32 v125, v125
  v_mfma_f32_16x16x32_bf16 a[116:119], a[184:187], v[8:11], a[116:119]
  v_cvt_pk_bf16_f32 v122, v124, v125
  v_mfma_f32_16x16x32_bf16 a[120:123], a[184:187], v[16:19], a[120:123]
  v_exp_f32 v126, v126
  v_mfma_f32_16x16x32_bf16 a[120:123], a[188:191], v[48:51], a[120:123]
  v_mfma_f32_16x16x32_bf16 a[124:127], a[188:191], v[56:59], a[124:127]
  s_waitcnt vmcnt(9)
  v_exp_f32 v127, v127
  v_mfma_f32_16x16x32_bf16 a[124:127], a[184:187], v[24:27], a[124:127]
  v_cvt_pk_bf16_f32 v123, v126, v127
  ds_read_b64_tr_b16 a[160:161], v216 offset:49152
  ds_read_b64_tr_b16 a[162:163], v216 offset:53248
  ds_read_b64_tr_b16 a[164:165], v216 offset:57344
  ds_read_b64_tr_b16 a[166:167], v216 offset:61440
  ds_read_b64_tr_b16 a[168:169], v217 offset:49152
  ds_read_b64_tr_b16 a[170:171], v217 offset:53248
  ds_read_b64_tr_b16 a[172:173], v217 offset:57344
  ds_read_b64_tr_b16 a[174:175], v217 offset:61440
  s_mov_b32 s48, 0x53800000
  s_lshl_b32 s39, s3, 8
  v_mfma_f32_16x16x32_bf16 a[192:195], a[208:211], v[64:67], a[192:195]
  s_add_u32 m0, s28, 81920
  v_mfma_f32_16x16x32_bf16 a[192:195], a[208:211], v[96:99], a[192:195]
  v_mfma_f32_16x16x32_bf16 a[196:199], a[208:211], v[72:75], a[196:199]
  buffer_load_dwordx4 v242, s[24:27], s10 offen offset:0 sc1 lds
  v_mfma_f32_16x16x32_bf16 a[196:199], a[208:211], v[104:107], a[196:199]
  v_mfma_f32_16x16x32_bf16 a[200:203], a[208:211], v[80:83], a[200:203]
  buffer_load_dwordx4 v242, s[24:27], s10 offen offset:1024 sc1 lds
  v_mfma_f32_16x16x32_bf16 a[200:203], a[208:211], v[112:115], a[200:203]
  v_mfma_f32_16x16x32_bf16 a[204:207], a[208:211], v[88:91], a[204:207]
  buffer_load_dwordx4 v242, s[24:27], s10 offen offset:2048 sc1 lds
  v_mfma_f32_16x16x32_bf16 a[204:207], a[208:211], v[120:123], a[204:207]
  s_waitcnt lgkmcnt(4)
  v_mfma_f32_16x16x32_bf16 a[0:3], a[160:163], v[64:67], a[0:3]
  buffer_load_dwordx4 v242, s[24:27], s10 offen offset:3072 sc1 lds
  v_mfma_f32_16x16x32_bf16 a[0:3], a[164:167], v[96:99], a[0:3]
  ds_read_b64_tr_b16 a[176:177], v218 offset:49152
  v_mfma_f32_16x16x32_bf16 a[4:7], a[164:167], v[104:107], a[4:7]
  buffer_load_dwordx4 v[144:147], v253, s[24:27], s5 offen offset:3072 sc1
  v_mfma_f32_16x16x32_bf16 a[4:7], a[160:163], v[72:75], a[4:7]
  ds_read_b64_tr_b16 a[178:179], v218 offset:53248
  v_accvgpr_read_b32 v208, a192
  v_mfma_f32_16x16x32_bf16 a[8:11], a[160:163], v[80:83], a[8:11]
  v_accvgpr_read_b32 v209, a196
  v_accvgpr_read_b32 v210, a200
  v_mfma_f32_16x16x32_bf16 a[8:11], a[164:167], v[112:115], a[8:11]
  ds_read_b64_tr_b16 a[180:181], v218 offset:57344
  v_accvgpr_read_b32 v211, a204
  v_mfma_f32_16x16x32_bf16 a[12:15], a[164:167], v[120:123], a[12:15]
  v_mov_b32 v245, v208
  v_mov_b32 v246, v209
  v_mfma_f32_16x16x32_bf16 a[12:15], a[160:163], v[88:91], a[12:15]
  ds_read_b64_tr_b16 a[182:183], v218 offset:61440
  s_waitcnt lgkmcnt(4)
  v_mov_b32 v247, v210
  v_mfma_f32_16x16x32_bf16 a[16:19], a[168:171], v[64:67], a[16:19]
  v_mov_b32 v248, v211
  v_permlane16_swap_b32 v208, v245
  v_mfma_f32_16x16x32_bf16 a[16:19], a[172:175], v[96:99], a[16:19]
  ds_read_b64_tr_b16 a[184:185], v219 offset:49152
  v_permlane16_swap_b32 v209, v246
  v_mfma_f32_16x16x32_bf16 a[20:23], a[172:175], v[104:107], a[20:23]
  v_permlane16_swap_b32 v210, v247
  v_permlane16_swap_b32 v211, v248
  v_mfma_f32_16x16x32_bf16 a[20:23], a[168:171], v[72:75], a[20:23]
  ds_read_b64_tr_b16 a[186:187], v219 offset:53248
  v_add_f32 v208, v208, v245
  v_mfma_f32_16x16x32_bf16 a[24:27], a[168:171], v[80:83], a[24:27]
  v_add_f32 v209, v209, v246
  v_add_f32 v210, v210, v247
  v_mfma_f32_16x16x32_bf16 a[24:27], a[172:175], v[112:115], a[24:27]
  ds_read_b64_tr_b16 a[188:189], v219 offset:57344
  v_add_f32 v211, v211, v248
  v_mfma_f32_16x16x32_bf16 a[28:31], a[172:175], v[120:123], a[28:31]
  v_mov_b32 v245, v208
  v_mov_b32 v246, v209
  v_mfma_f32_16x16x32_bf16 a[28:31], a[168:171], v[88:91], a[28:31]
  ds_read_b64_tr_b16 a[190:191], v219 offset:61440
  s_waitcnt lgkmcnt(4)
  v_mov_b32 v247, v210
  v_mfma_f32_16x16x32_bf16 a[32:35], a[176:179], v[64:67], a[32:35]
  v_mov_b32 v248, v211
  v_permlane32_swap_b32 v208, v245
  v_mfma_f32_16x16x32_bf16 a[32:35], a[180:183], v[96:99], a[32:35]
  ds_read_b64_tr_b16 a[160:161], v220 offset:49152
  v_permlane32_swap_b32 v209, v246
  v_mfma_f32_16x16x32_bf16 a[36:39], a[180:183], v[104:107], a[36:39]
  v_permlane32_swap_b32 v210, v247
  v_permlane32_swap_b32 v211, v248
  v_mfma_f32_16x16x32_bf16 a[36:39], a[176:179], v[72:75], a[36:39]
  ds_read_b64_tr_b16 a[162:163], v220 offset:53248
  v_add_f32 v208, v208, v245
  v_mfma_f32_16x16x32_bf16 a[40:43], a[176:179], v[80:83], a[40:43]
  v_add_f32 v209, v209, v246
  v_add_f32 v210, v210, v247
  v_mfma_f32_16x16x32_bf16 a[40:43], a[180:183], v[112:115], a[40:43]
  ds_read_b64_tr_b16 a[164:165], v220 offset:57344
  v_add_f32 v211, v211, v248
  buffer_load_dwordx4 v[148:151], v242, s[24:27], s6 offen offset:0 sc1
  buffer_load_dwordx4 v[152:155], v242, s[24:27], s6 offen offset:1024 sc1
  buffer_load_dwordx4 v[156:159], v242, s[24:27], s6 offen offset:2048 sc1
  buffer_load_dwordx4 v[160:163], v242, s[24:27], s6 offen offset:3072 sc1
  buffer_load_dwordx4 v[164:167], v252, s[24:27], s6 offen offset:0 sc1
  buffer_load_dwordx4 v[168:171], v252, s[24:27], s6 offen offset:1024 sc1
  buffer_load_dwordx4 v[172:175], v252, s[24:27], s6 offen offset:2048 sc1
  v_mfma_f32_16x16x32_bf16 a[44:47], a[180:183], v[120:123], a[44:47]
  v_rcp_f32 v192, v208
  v_mfma_f32_16x16x32_bf16 a[44:47], a[176:179], v[88:91], a[44:47]
  ds_read_b64_tr_b16 a[166:167], v220 offset:61440
  s_waitcnt lgkmcnt(4)
  v_mfma_f32_16x16x32_bf16 a[48:51], a[184:187], v[64:67], a[48:51]
  v_rcp_f32 v196, v209
  v_mfma_f32_16x16x32_bf16 a[48:51], a[188:191], v[96:99], a[48:51]
  ds_read_b64_tr_b16 a[168:169], v221 offset:49152
  v_mfma_f32_16x16x32_bf16 a[52:55], a[188:191], v[104:107], a[52:55]
  v_rcp_f32 v200, v210
  v_mfma_f32_16x16x32_bf16 a[52:55], a[184:187], v[72:75], a[52:55]
  ds_read_b64_tr_b16 a[170:171], v221 offset:53248
  v_mfma_f32_16x16x32_bf16 a[56:59], a[184:187], v[80:83], a[56:59]
  v_rcp_f32 v204, v211
  v_mfma_f32_16x16x32_bf16 a[56:59], a[188:191], v[112:115], a[56:59]
  ds_read_b64_tr_b16 a[172:173], v221 offset:57344
  v_add_f32 v246, v208, v209
  v_mfma_f32_16x16x32_bf16 a[60:63], a[188:191], v[120:123], a[60:63]
  v_add_f32 v247, v210, v211
  v_add_f32 v246, v246, v247
  v_mfma_f32_16x16x32_bf16 a[60:63], a[184:187], v[88:91], a[60:63]
  ds_read_b64_tr_b16 a[174:175], v221 offset:61440
  s_waitcnt lgkmcnt(4)
  v_lshrrev_b32 v247, 2, v242
  v_mfma_f32_16x16x32_bf16 a[64:67], a[160:163], v[64:67], a[64:67]
  v_cmp_nlt_f32 vcc, v246, s48
  v_add_u32 v247, s39, v247
  v_mfma_f32_16x16x32_bf16 a[64:67], a[164:167], v[96:99], a[64:67]
  ds_read_b64_tr_b16 a[176:177], v222 offset:49152
  v_add_u32 v247, 157696, v247
  v_mfma_f32_16x16x32_bf16 a[68:71], a[164:167], v[104:107], a[68:71]
  v_cndmask_b32_e64 v245, 0, 1, vcc
  v_accvgpr_read_b32 v0, a0
  v_mfma_f32_16x16x32_bf16 a[68:71], a[160:163], v[72:75], a[68:71]
  ds_read_b64_tr_b16 a[178:179], v222 offset:53248
  v_accvgpr_read_b32 v1, a1
  v_mfma_f32_16x16x32_bf16 a[72:75], a[160:163], v[80:83], a[72:75]
  v_accvgpr_read_b32 v2, a2
  v_accvgpr_read_b32 v3, a3
  v_mfma_f32_16x16x32_bf16 a[72:75], a[164:167], v[112:115], a[72:75]
  ds_read_b64_tr_b16 a[180:181], v222 offset:57344
  v_accvgpr_read_b32 v4, a16
  v_mfma_f32_16x16x32_bf16 a[76:79], a[164:167], v[120:123], a[76:79]
  v_accvgpr_read_b32 v5, a17
  v_accvgpr_read_b32 v6, a18
  v_mfma_f32_16x16x32_bf16 a[76:79], a[160:163], v[88:91], a[76:79]
  ds_read_b64_tr_b16 a[182:183], v222 offset:61440
  s_waitcnt lgkmcnt(4)
  v_accvgpr_read_b32 v7, a19
  v_mfma_f32_16x16x32_bf16 a[80:83], a[168:171], v[64:67], a[80:83]
  v_mul_f32 v0, v0, v192
  v_mul_f32 v1, v1, v192
  v_mfma_f32_16x16x32_bf16 a[80:83], a[172:175], v[96:99], a[80:83]
  ds_read_b64_tr_b16 a[184:185], v223 offset:49152
  v_mul_f32 v2, v2, v192
  v_mfma_f32_16x16x32_bf16 a[84:87], a[172:175], v[104:107], a[84:87]
  v_mul_f32 v3, v3, v192
  v_mul_f32 v4, v4, v192
  v_mfma_f32_16x16x32_bf16 a[84:87], a[168:171], v[72:75], a[84:87]
  ds_read_b64_tr_b16 a[186:187], v223 offset:53248
  v_mul_f32 v5, v5, v192
  v_mfma_f32_16x16x32_bf16 a[88:91], a[168:171], v[80:83], a[88:91]
  v_mul_f32 v6, v6, v192
  v_mul_f32 v7, v7, v192
  v_mfma_f32_16x16x32_bf16 a[88:91], a[172:175], v[112:115], a[88:91]
  ds_read_b64_tr_b16 a[188:189], v223 offset:57344
  v_cvt_pk_bf16_f32 v0, v0, v1
  v_mfma_f32_16x16x32_bf16 a[92:95], a[172:175], v[120:123], a[92:95]
  v_cvt_pk_bf16_f32 v1, v2, v3
  v_cvt_pk_bf16_f32 v2, v4, v5
  v_mfma_f32_16x16x32_bf16 a[92:95], a[168:171], v[88:91], a[92:95]
  ds_read_b64_tr_b16 a[190:191], v223 offset:61440
  s_waitcnt lgkmcnt(4)
  v_cvt_pk_bf16_f32 v3, v6, v7
  v_mfma_f32_16x16x32_bf16 a[96:99], a[176:179], v[64:67], a[96:99]
  buffer_store_dwordx4 v[0:3], v244, s[24:27], s40 offen offset:0 sc1
  v_mfma_f32_16x16x32_bf16 a[96:99], a[180:183], v[96:99], a[96:99]
  v_accvgpr_read_b32 v8, a4
  v_accvgpr_read_b32 v9, a5
  v_mfma_f32_16x16x32_bf16 a[100:103], a[180:183], v[104:107], a[100:103]
  v_accvgpr_read_b32 v10, a6
  v_accvgpr_read_b32 v11, a7
  v_mfma_f32_16x16x32_bf16 a[100:103], a[176:179], v[72:75], a[100:103]
  v_accvgpr_read_b32 v12, a20
  v_accvgpr_read_b32 v13, a21
  v_mfma_f32_16x16x32_bf16 a[104:107], a[176:179], v[80:83], a[104:107]
  v_accvgpr_read_b32 v14, a22
  v_accvgpr_read_b32 v15, a23
  v_mfma_f32_16x16x32_bf16 a[104:107], a[180:183], v[112:115], a[104:107]
  v_mul_f32 v8, v8, v196
  v_mul_f32 v9, v9, v196
  v_mfma_f32_16x16x32_bf16 a[108:111], a[180:183], v[120:123], a[108:111]
  v_mul_f32 v10, v10, v196
  v_mul_f32 v11, v11, v196
  v_mfma_f32_16x16x32_bf16 a[108:111], a[176:179], v[88:91], a[108:111]
  s_waitcnt lgkmcnt(0)
  v_mul_f32 v12, v12, v196
  v_mul_f32 v13, v13, v196
  v_mfma_f32_16x16x32_bf16 a[112:115], a[184:187], v[64:67], a[112:115]
  v_mul_f32 v14, v14, v196
  v_mul_f32 v15, v15, v196
  v_mfma_f32_16x16x32_bf16 a[112:115], a[188:191], v[96:99], a[112:115]
  v_cvt_pk_bf16_f32 v8, v8, v9
  v_cvt_pk_bf16_f32 v9, v10, v11
  v_mfma_f32_16x16x32_bf16 a[116:119], a[188:191], v[104:107], a[116:119]
  v_cvt_pk_bf16_f32 v10, v12, v13
  v_cvt_pk_bf16_f32 v11, v14, v15
  v_mfma_f32_16x16x32_bf16 a[116:119], a[184:187], v[72:75], a[116:119]
  buffer_store_dwordx4 v[8:11], v244, s[24:27], s40 offen offset:2048 sc1
  v_mfma_f32_16x16x32_bf16 a[120:123], a[184:187], v[80:83], a[120:123]
  v_accvgpr_read_b32 v16, a8
  v_accvgpr_read_b32 v17, a9
  v_mfma_f32_16x16x32_bf16 a[120:123], a[188:191], v[112:115], a[120:123]
  v_accvgpr_read_b32 v18, a10
  v_accvgpr_read_b32 v19, a11
  v_mfma_f32_16x16x32_bf16 a[124:127], a[188:191], v[120:123], a[124:127]
  v_accvgpr_read_b32 v20, a24
  v_accvgpr_read_b32 v21, a25
  v_mfma_f32_16x16x32_bf16 a[124:127], a[184:187], v[88:91], a[124:127]
  v_accvgpr_read_b32 v22, a26
  v_accvgpr_read_b32 v23, a27
  v_pk_mul_f32 v[16:17], v[16:17], v[200:201] op_sel_hi:[1,0]
  v_pk_mul_f32 v[18:19], v[18:19], v[200:201] op_sel_hi:[1,0]
  v_pk_mul_f32 v[20:21], v[20:21], v[200:201] op_sel_hi:[1,0]
  v_pk_mul_f32 v[22:23], v[22:23], v[200:201] op_sel_hi:[1,0]
  v_cvt_pk_bf16_f32 v16, v16, v17
  v_cvt_pk_bf16_f32 v17, v18, v19
  v_cvt_pk_bf16_f32 v18, v20, v21
  v_cvt_pk_bf16_f32 v19, v22, v23
  buffer_store_dwordx4 v[16:19], v244, s[24:27], s41 offen offset:0 sc1
  v_accvgpr_read_b32 v24, a12
  v_accvgpr_read_b32 v25, a13
  v_accvgpr_read_b32 v26, a14
  v_accvgpr_read_b32 v27, a15
  v_accvgpr_read_b32 v28, a28
  v_accvgpr_read_b32 v29, a29
  v_accvgpr_read_b32 v30, a30
  v_accvgpr_read_b32 v31, a31
  v_pk_mul_f32 v[24:25], v[24:25], v[204:205] op_sel_hi:[1,0]
  v_pk_mul_f32 v[26:27], v[26:27], v[204:205] op_sel_hi:[1,0]
  v_pk_mul_f32 v[28:29], v[28:29], v[204:205] op_sel_hi:[1,0]
  v_pk_mul_f32 v[30:31], v[30:31], v[204:205] op_sel_hi:[1,0]
  v_cvt_pk_bf16_f32 v24, v24, v25
  v_cvt_pk_bf16_f32 v25, v26, v27
  v_cvt_pk_bf16_f32 v26, v28, v29
  v_cvt_pk_bf16_f32 v27, v30, v31
  buffer_store_dwordx4 v[24:27], v244, s[24:27], s41 offen offset:2048 sc1
  v_accvgpr_read_b32 v32, a32
  v_accvgpr_read_b32 v33, a33
  v_accvgpr_read_b32 v34, a34
  v_accvgpr_read_b32 v35, a35
  v_accvgpr_read_b32 v36, a48
  v_accvgpr_read_b32 v37, a49
  v_accvgpr_read_b32 v38, a50
  v_accvgpr_read_b32 v39, a51
  v_pk_mul_f32 v[32:33], v[32:33], v[192:193] op_sel_hi:[1,0]
  v_pk_mul_f32 v[34:35], v[34:35], v[192:193] op_sel_hi:[1,0]
  v_pk_mul_f32 v[36:37], v[36:37], v[192:193] op_sel_hi:[1,0]
  v_pk_mul_f32 v[38:39], v[38:39], v[192:193] op_sel_hi:[1,0]
  v_cvt_pk_bf16_f32 v32, v32, v33
  v_cvt_pk_bf16_f32 v33, v34, v35
  v_cvt_pk_bf16_f32 v34, v36, v37
  v_cvt_pk_bf16_f32 v35, v38, v39
  buffer_store_dwordx4 v[32:35], v244, s[24:27], s40 offen offset:1024 sc1
  v_accvgpr_read_b32 v40, a36
  v_accvgpr_read_b32 v41, a37
  v_accvgpr_read_b32 v42, a38
  v_accvgpr_read_b32 v43, a39
  v_accvgpr_read_b32 v44, a52
  v_accvgpr_read_b32 v45, a53
  v_accvgpr_read_b32 v46, a54
  v_accvgpr_read_b32 v47, a55
  v_pk_mul_f32 v[40:41], v[40:41], v[196:197] op_sel_hi:[1,0]
  v_pk_mul_f32 v[42:43], v[42:43], v[196:197] op_sel_hi:[1,0]
  v_pk_mul_f32 v[44:45], v[44:45], v[196:197] op_sel_hi:[1,0]
  v_pk_mul_f32 v[46:47], v[46:47], v[196:197] op_sel_hi:[1,0]
  v_cvt_pk_bf16_f32 v40, v40, v41
  v_cvt_pk_bf16_f32 v41, v42, v43
  v_cvt_pk_bf16_f32 v42, v44, v45
  v_cvt_pk_bf16_f32 v43, v46, v47
  buffer_store_dwordx4 v[40:43], v244, s[24:27], s40 offen offset:3072 sc1
  v_accvgpr_read_b32 v48, a40
  v_accvgpr_read_b32 v49, a41
  v_accvgpr_read_b32 v50, a42
  v_accvgpr_read_b32 v51, a43
  v_accvgpr_read_b32 v52, a56
  v_accvgpr_read_b32 v53, a57
  v_accvgpr_read_b32 v54, a58
  v_accvgpr_read_b32 v55, a59
  v_pk_mul_f32 v[48:49], v[48:49], v[200:201] op_sel_hi:[1,0]
  v_pk_mul_f32 v[50:51], v[50:51], v[200:201] op_sel_hi:[1,0]
  v_pk_mul_f32 v[52:53], v[52:53], v[200:201] op_sel_hi:[1,0]
  v_pk_mul_f32 v[54:55], v[54:55], v[200:201] op_sel_hi:[1,0]
  v_cvt_pk_bf16_f32 v48, v48, v49
  v_cvt_pk_bf16_f32 v49, v50, v51
  v_cvt_pk_bf16_f32 v50, v52, v53
  v_cvt_pk_bf16_f32 v51, v54, v55
  buffer_store_dwordx4 v[48:51], v244, s[24:27], s41 offen offset:1024 sc1
  v_accvgpr_read_b32 v56, a44
  v_accvgpr_read_b32 v57, a45
  v_accvgpr_read_b32 v58, a46
  v_accvgpr_read_b32 v59, a47
  v_accvgpr_read_b32 v60, a60
  v_accvgpr_read_b32 v61, a61
  v_accvgpr_read_b32 v62, a62
  v_accvgpr_read_b32 v63, a63
  v_pk_mul_f32 v[56:57], v[56:57], v[204:205] op_sel_hi:[1,0]
  v_pk_mul_f32 v[58:59], v[58:59], v[204:205] op_sel_hi:[1,0]
  v_pk_mul_f32 v[60:61], v[60:61], v[204:205] op_sel_hi:[1,0]
  v_pk_mul_f32 v[62:63], v[62:63], v[204:205] op_sel_hi:[1,0]
  v_cvt_pk_bf16_f32 v56, v56, v57
  v_cvt_pk_bf16_f32 v57, v58, v59
  v_cvt_pk_bf16_f32 v58, v60, v61
  v_cvt_pk_bf16_f32 v59, v62, v63
  buffer_store_dwordx4 v[56:59], v244, s[24:27], s41 offen offset:3072 sc1
  v_accvgpr_read_b32 v0, a64
  v_accvgpr_read_b32 v1, a65
  v_accvgpr_read_b32 v2, a66
  v_accvgpr_read_b32 v3, a67
  v_accvgpr_read_b32 v4, a80
  v_accvgpr_read_b32 v5, a81
  v_accvgpr_read_b32 v6, a82
  v_accvgpr_read_b32 v7, a83
  v_pk_mul_f32 v[0:1], v[0:1], v[192:193] op_sel_hi:[1,0]
  v_pk_mul_f32 v[2:3], v[2:3], v[192:193] op_sel_hi:[1,0]
  v_pk_mul_f32 v[4:5], v[4:5], v[192:193] op_sel_hi:[1,0]
  v_pk_mul_f32 v[6:7], v[6:7], v[192:193] op_sel_hi:[1,0]
  v_cvt_pk_bf16_f32 v0, v0, v1
  v_cvt_pk_bf16_f32 v1, v2, v3
  v_cvt_pk_bf16_f32 v2, v4, v5
  v_cvt_pk_bf16_f32 v3, v6, v7
  buffer_store_dwordx4 v[0:3], v244, s[24:27], s42 offen offset:0 sc1
  v_accvgpr_read_b32 v8, a68
  v_accvgpr_read_b32 v9, a69
  v_accvgpr_read_b32 v10, a70
  v_accvgpr_read_b32 v11, a71
  v_accvgpr_read_b32 v12, a84
  v_accvgpr_read_b32 v13, a85
  v_accvgpr_read_b32 v14, a86
  v_accvgpr_read_b32 v15, a87
  v_pk_mul_f32 v[8:9], v[8:9], v[196:197] op_sel_hi:[1,0]
  v_pk_mul_f32 v[10:11], v[10:11], v[196:197] op_sel_hi:[1,0]
  v_pk_mul_f32 v[12:13], v[12:13], v[196:197] op_sel_hi:[1,0]
  v_pk_mul_f32 v[14:15], v[14:15], v[196:197] op_sel_hi:[1,0]
  v_cvt_pk_bf16_f32 v8, v8, v9
  v_cvt_pk_bf16_f32 v9, v10, v11
  v_cvt_pk_bf16_f32 v10, v12, v13
  v_cvt_pk_bf16_f32 v11, v14, v15
  buffer_store_dwordx4 v[8:11], v244, s[24:27], s42 offen offset:2048 sc1
  v_accvgpr_read_b32 v16, a72
  v_accvgpr_read_b32 v17, a73
  v_accvgpr_read_b32 v18, a74
  v_accvgpr_read_b32 v19, a75
  v_accvgpr_read_b32 v20, a88
  v_accvgpr_read_b32 v21, a89
  v_accvgpr_read_b32 v22, a90
  v_accvgpr_read_b32 v23, a91
  v_pk_mul_f32 v[16:17], v[16:17], v[200:201] op_sel_hi:[1,0]
  v_pk_mul_f32 v[18:19], v[18:19], v[200:201] op_sel_hi:[1,0]
  v_pk_mul_f32 v[20:21], v[20:21], v[200:201] op_sel_hi:[1,0]
  v_pk_mul_f32 v[22:23], v[22:23], v[200:201] op_sel_hi:[1,0]
  v_cvt_pk_bf16_f32 v16, v16, v17
  v_cvt_pk_bf16_f32 v17, v18, v19
  v_cvt_pk_bf16_f32 v18, v20, v21
  v_cvt_pk_bf16_f32 v19, v22, v23
  buffer_store_dwordx4 v[16:19], v244, s[24:27], s43 offen offset:0 sc1
  v_accvgpr_read_b32 v24, a76
  v_accvgpr_read_b32 v25, a77
  v_accvgpr_read_b32 v26, a78
  v_accvgpr_read_b32 v27, a79
  v_accvgpr_read_b32 v28, a92
  v_accvgpr_read_b32 v29, a93
  v_accvgpr_read_b32 v30, a94
  v_accvgpr_read_b32 v31, a95
  v_pk_mul_f32 v[24:25], v[24:25], v[204:205] op_sel_hi:[1,0]
  v_pk_mul_f32 v[26:27], v[26:27], v[204:205] op_sel_hi:[1,0]
  v_pk_mul_f32 v[28:29], v[28:29], v[204:205] op_sel_hi:[1,0]
  v_pk_mul_f32 v[30:31], v[30:31], v[204:205] op_sel_hi:[1,0]
  v_cvt_pk_bf16_f32 v24, v24, v25
  v_cvt_pk_bf16_f32 v25, v26, v27
  v_cvt_pk_bf16_f32 v26, v28, v29
  v_cvt_pk_bf16_f32 v27, v30, v31
  buffer_store_dwordx4 v[24:27], v244, s[24:27], s43 offen offset:2048 sc1
  v_accvgpr_read_b32 v32, a96
  v_accvgpr_read_b32 v33, a97
  v_accvgpr_read_b32 v34, a98
  v_accvgpr_read_b32 v35, a99
  v_accvgpr_read_b32 v36, a112
  v_accvgpr_read_b32 v37, a113
  v_accvgpr_read_b32 v38, a114
  v_accvgpr_read_b32 v39, a115
  v_pk_mul_f32 v[32:33], v[32:33], v[192:193] op_sel_hi:[1,0]
  v_pk_mul_f32 v[34:35], v[34:35], v[192:193] op_sel_hi:[1,0]
  v_pk_mul_f32 v[36:37], v[36:37], v[192:193] op_sel_hi:[1,0]
  v_pk_mul_f32 v[38:39], v[38:39], v[192:193] op_sel_hi:[1,0]
  v_cvt_pk_bf16_f32 v32, v32, v33
  v_cvt_pk_bf16_f32 v33, v34, v35
  v_cvt_pk_bf16_f32 v34, v36, v37
  v_cvt_pk_bf16_f32 v35, v38, v39
  buffer_store_dwordx4 v[32:35], v244, s[24:27], s42 offen offset:1024 sc1
  v_accvgpr_read_b32 v40, a100
  v_accvgpr_read_b32 v41, a101
  v_accvgpr_read_b32 v42, a102
  v_accvgpr_read_b32 v43, a103
  v_accvgpr_read_b32 v44, a116
  v_accvgpr_read_b32 v45, a117
  v_accvgpr_read_b32 v46, a118
  v_accvgpr_read_b32 v47, a119
  v_pk_mul_f32 v[40:41], v[40:41], v[196:197] op_sel_hi:[1,0]
  v_pk_mul_f32 v[42:43], v[42:43], v[196:197] op_sel_hi:[1,0]
  v_pk_mul_f32 v[44:45], v[44:45], v[196:197] op_sel_hi:[1,0]
  v_pk_mul_f32 v[46:47], v[46:47], v[196:197] op_sel_hi:[1,0]
  v_cvt_pk_bf16_f32 v40, v40, v41
  v_cvt_pk_bf16_f32 v41, v42, v43
  v_cvt_pk_bf16_f32 v42, v44, v45
  v_cvt_pk_bf16_f32 v43, v46, v47
  buffer_store_dwordx4 v[40:43], v244, s[24:27], s42 offen offset:3072 sc1
  v_accvgpr_read_b32 v48, a104
  v_accvgpr_read_b32 v49, a105
  v_accvgpr_read_b32 v50, a106
  v_accvgpr_read_b32 v51, a107
  v_accvgpr_read_b32 v52, a120
  v_accvgpr_read_b32 v53, a121
  v_accvgpr_read_b32 v54, a122
  v_accvgpr_read_b32 v55, a123
  v_pk_mul_f32 v[48:49], v[48:49], v[200:201] op_sel_hi:[1,0]
  v_pk_mul_f32 v[50:51], v[50:51], v[200:201] op_sel_hi:[1,0]
  v_pk_mul_f32 v[52:53], v[52:53], v[200:201] op_sel_hi:[1,0]
  v_pk_mul_f32 v[54:55], v[54:55], v[200:201] op_sel_hi:[1,0]
  v_cvt_pk_bf16_f32 v48, v48, v49
  v_cvt_pk_bf16_f32 v49, v50, v51
  v_cvt_pk_bf16_f32 v50, v52, v53
  v_cvt_pk_bf16_f32 v51, v54, v55
  buffer_store_dwordx4 v[48:51], v244, s[24:27], s43 offen offset:1024 sc1
  v_accvgpr_read_b32 v56, a108
  v_accvgpr_read_b32 v57, a109
  v_accvgpr_read_b32 v58, a110
  v_accvgpr_read_b32 v59, a111
  v_accvgpr_read_b32 v60, a124
  v_accvgpr_read_b32 v61, a125
  v_accvgpr_read_b32 v62, a126
  v_accvgpr_read_b32 v63, a127
  v_pk_mul_f32 v[56:57], v[56:57], v[204:205] op_sel_hi:[1,0]
  v_pk_mul_f32 v[58:59], v[58:59], v[204:205] op_sel_hi:[1,0]
  v_pk_mul_f32 v[60:61], v[60:61], v[204:205] op_sel_hi:[1,0]
  v_pk_mul_f32 v[62:63], v[62:63], v[204:205] op_sel_hi:[1,0]
  v_cvt_pk_bf16_f32 v56, v56, v57
  v_cvt_pk_bf16_f32 v57, v58, v59
  v_cvt_pk_bf16_f32 v58, v60, v61
  v_cvt_pk_bf16_f32 v59, v62, v63
  buffer_store_dwordx4 v[56:59], v244, s[24:27], s43 offen offset:3072 sc1
  ds_write_b32 v247, v245
  buffer_load_dwordx4 v[176:179], v252, s[24:27], s6 offen offset:3072 sc1
  buffer_load_dwordx4 v[180:183], v253, s[24:27], s6 offen offset:0 sc1
  buffer_load_dwordx4 v[184:187], v253, s[24:27], s6 offen offset:1024 sc1
  buffer_load_dwordx4 v[188:191], v253, s[24:27], s6 offen offset:2048 sc1
  buffer_load_dwordx4 a[0:3], v253, s[24:27], s6 offen offset:3072 sc1
  buffer_load_dwordx4 a[4:7], v242, s[24:27], s7 offen offset:0 sc1
  buffer_load_dwordx4 a[8:11], v242, s[24:27], s7 offen offset:1024 sc1
  buffer_load_dwordx4 a[12:15], v242, s[24:27], s7 offen offset:2048 sc1
  s_lshr_b32 s39, s37, 2
  s_lshl_b32 s39, s39, 3
  s_lshr_b32 s38, s36, 2
  s_add_u32 s39, s39, s38
  s_lshl_b32 s39, s39, 7
  s_add_u32 s39, s39, 2867200
  s_lshl_b32 s38, s3, 26
  v_lshlrev_b32 v64, 22, v242
  v_or_b32 v64, s38, v64
  v_mov_b32 v65, 1
  v_add_u32 v246, 157696, v242
  s_waitcnt vmcnt(8) lgkmcnt(0)
  s_barrier
  ds_read_b128 v[68:71], v246
  s_waitcnt lgkmcnt(0)
  v_or3_b32 v68, v68, v69, v70
  v_or_b32 v68, v68, v71
  v_cmp_ne_u32 vcc, 0, v68
  s_nop 0
  s_cbranch_vccnz attn_redo
tail_go:
  buffer_atomic_add v65, v64, s[24:27], s39 offen
  s_and_b32 s36, s2, 1
  s_bfe_u32 s31, s2, 0x20001
  s_lshl_b32 s31, s31, 2
  s_bfe_u32 s38, s2, 0x20003
  s_add_u32 s31, s31, s38
  s_lshr_b32 s29, s2, 5
  v_mov_b32 v114, v242
  v_add_u32 v115, 0x1000, v114
  v_add_u32 v116, 0x2000, v114
  s_lshl_b32 s38, s36, 2
  s_add_u32 s38, s38, s3
  s_lshl_b32 s30, s38, 16
  buffer_load_dwordx4 a[16:19], v114, s[24:27], s7 offen offset:3072 sc1
  buffer_load_dwordx4 a[20:23], v115, s[24:27], s7 offen offset:0 sc1
  buffer_load_dwordx4 a[24:27], v115, s[24:27], s7 offen offset:1024 sc1
  buffer_load_dwordx4 a[28:31], v115, s[24:27], s7 offen offset:2048 sc1
  v_lshrrev_b32 v192, 4, v114
  v_and_b32 v193, 15, v192
  v_lshrrev_b32 v194, 4, v192
  s_add_u32 s38, s3, 0
  s_and_b32 s38, s38, 3
  s_lshl_b32 s38, s38, 11
  v_add_u32 v110, s38, v114
  s_sub_u32 s38, s3, 0
  s_and_b32 s38, s38, 3
  s_mul_i32 s38, s38, 15360
  s_add_u32 s38, s38, 98304
  v_add_u32 v118, s38, v114
  s_add_u32 s38, s3, 1
  s_and_b32 s38, s38, 3
  s_lshl_b32 s38, s38, 11
  v_add_u32 v111, s38, v114
  s_sub_u32 s38, s3, 1
  s_and_b32 s38, s38, 3
  s_mul_i32 s38, s38, 15360
  s_add_u32 s38, s38, 98304
  v_add_u32 v119, s38, v114
  s_add_u32 s38, s3, 2
  s_and_b32 s38, s38, 3
  s_lshl_b32 s38, s38, 11
  v_add_u32 v112, s38, v114
  s_sub_u32 s38, s3, 2
  s_and_b32 s38, s38, 3
  s_mul_i32 s38, s38, 15360
  s_add_u32 s38, s38, 98304
  v_add_u32 v120, s38, v114
  s_add_u32 s38, s3, 3
  s_and_b32 s38, s38, 3
  s_lshl_b32 s38, s38, 11
  v_add_u32 v113, s38, v114
  s_sub_u32 s38, s3, 3
  s_and_b32 s38, s38, 3
  s_mul_i32 s38, s38, 15360
  s_add_u32 s38, s38, 98304
  v_add_u32 v121, s38, v114
  v_add_u32 v122, s28, v114
  v_add_u32 v202, 0x10000, v122
  s_and_b32 s38, s31, 14
  s_add_u32 s38, s38, s36
  s_lshl_b32 s38, s38, 2
  s_add_u32 s38, s38, s3
  s_lshl_b32 s38, s38, 7
  s_add_u32 s38, s38, 2867200
  s_lshl_b32 s39, s29, 8
  s_add_u32 s39, s39, 2818304
  v_mov_b32 v200, s38
  v_writelane_b32 v200, s39, 1
  v_mov_b32 v201, 4
  v_writelane_b32 v201, 30, 1
  s_lshl_b32 s31, s31, 1
  s_add_u32 s31, s31, s36
  s_add_u32 s30, s30, 8388608
  s_lshl_b32 s38, s31, 19
  s_add_u32 s37, s30, s38
  s_xor_b32 s38, s38, 0x80000
  s_add_u32 s30, s30, s38
  s_lshl_b32 s40, s29, 5
  s_add_u32 s40, s40, s31
  s_lshl_b32 s38, s31, 6
  s_lshl_b32 s39, s3, 4
  s_add_u32 s38, s38, s39
  v_add_u32 v195, s38, v193
  v_mul_u32_u24 v117, 0x500, v195
  v_lshl_add_u32 v117, v194, 3, v117
  s_mul_i32 s38, s29, 160
  v_add_u32 v117, s38, v117
  s_mov_b32 s12, s60
  s_mov_b32 s13, s61
  s_mov_b32 s14, 2621440
  s_mov_b32 s15, 0x20000
  s_mov_b32 s16, s62
  s_mov_b32 s17, s63
  s_mov_b32 s18, 2621440
  s_mov_b32 s19, 0x20000
  s_mul_i32 s38, s31, 81920
  s_lshl_b32 s39, s3, 10
  s_add_u32 s38, s38, s39
  s_mul_i32 s39, s29, 10
  v_lshrrev_b32 v196, 1, v194
  v_add_u32 v196, s39, v196
  v_and_b32 v197, 1, v194
  v_lshlrev_b32 v197, 3, v197
  v_lshl_add_u32 v197, v193, 4, v197
  v_lshrrev_b32 v198, 2, v196
  v_lshl_add_u32 v198, v198, 12, v197
  v_and_b32 v199, 3, v196
  v_lshl_add_u32 v198, v199, 8, v198
  buffer_load_dwordx2 v[224:225], v198, s[24:27], s38 offen sc1
  v_add_u32 v196, 2, v196
  buffer_load_dwordx2 v[80:81], v117, s[12:15], 0 offen offset:0
  v_lshrrev_b32 v198, 2, v196
  v_lshl_add_u32 v198, v198, 12, v197
  v_and_b32 v199, 3, v196
  v_lshl_add_u32 v198, v199, 8, v198
  buffer_load_dwordx2 v[226:227], v198, s[24:27], s38 offen sc1
  v_add_u32 v196, 2, v196
  buffer_load_dwordx2 v[82:83], v117, s[12:15], 0 offen offset:32
  v_lshrrev_b32 v198, 2, v196
  v_lshl_add_u32 v198, v198, 12, v197
  v_and_b32 v199, 3, v196
  v_lshl_add_u32 v198, v199, 8, v198
  buffer_load_dwordx2 v[228:229], v198, s[24:27], s38 offen sc1
  v_add_u32 v196, 2, v196
  buffer_load_dwordx2 v[84:85], v117, s[12:15], 0 offen offset:64
  v_lshrrev_b32 v198, 2, v196
  v_lshl_add_u32 v198, v198, 12, v197
  v_and_b32 v199, 3, v196
  v_lshl_add_u32 v198, v199, 8, v198
  buffer_load_dwordx2 v[230:231], v198, s[24:27], s38 offen sc1
  v_add_u32 v196, 2, v196
  buffer_load_dwordx2 v[86:87], v117, s[12:15], 0 offen offset:96
  v_lshrrev_b32 v198, 2, v196
  v_lshl_add_u32 v198, v198, 12, v197
  v_and_b32 v199, 3, v196
  v_lshl_add_u32 v198, v199, 8, v198
  buffer_load_dwordx2 v[232:233], v198, s[24:27], s38 offen sc1
  v_add_u32 v196, 2, v196
  buffer_load_dwordx2 v[88:89], v117, s[12:15], 0 offen offset:128
  v_mov_b32 v123, 1073741824
  v_bfrev_b32 v124, 1
  v_sub_u32 v195, 0xffff, v195
  s_mov_b32 s34, 0xffff0000
  s_and_b32 s38, s52, 0xffff
  v_cmp_eq_u32 vcc, s38, v195
  v_mov_b32 v196, s52
  v_mov_b32 v197, 0
  v_cndmask_b32 v124, v124, v196, vcc
  v_cndmask_b32 v123, v123, v197, vcc
  s_and_b32 s38, s53, 0xffff
  v_cmp_eq_u32 vcc, s38, v195
  v_mov_b32 v196, s53
  v_mov_b32 v197, 2560
  v_cndmask_b32 v124, v124, v196, vcc
  v_cndmask_b32 v123, v123, v197, vcc
  s_and_b32 s38, s54, 0xffff
  v_cmp_eq_u32 vcc, s38, v195
  v_mov_b32 v196, s54
  v_mov_b32 v197, 5120
  v_cndmask_b32 v124, v124, v196, vcc
  v_cndmask_b32 v123, v123, v197, vcc
  s_and_b32 s38, s55, 0xffff
  v_cmp_eq_u32 vcc, s38, v195
  v_mov_b32 v196, s55
  v_mov_b32 v197, 7680
  v_cndmask_b32 v124, v124, v196, vcc
  v_cndmask_b32 v123, v123, v197, vcc
  s_and_b32 s38, s56, 0xffff
  v_cmp_eq_u32 vcc, s38, v195
  v_mov_b32 v196, s56
  v_mov_b32 v197, 10240
  v_cndmask_b32 v124, v124, v196, vcc
  v_cndmask_b32 v123, v123, v197, vcc
  s_and_b32 s38, s57, 0xffff
  v_cmp_eq_u32 vcc, s38, v195
  v_mov_b32 v196, s57
  v_mov_b32 v197, 12800
  v_cndmask_b32 v124, v124, v196, vcc
  v_cndmask_b32 v123, v123, v197, vcc
  s_and_b32 s38, s58, 0xffff
  v_cmp_eq_u32 vcc, s38, v195
  v_mov_b32 v196, s58
  v_mov_b32 v197, 15360
  v_cndmask_b32 v124, v124, v196, vcc
  v_cndmask_b32 v123, v123, v197, vcc
  s_and_b32 s38, s59, 0xffff
  v_cmp_eq_u32 vcc, s38, v195
  v_mov_b32 v196, s59
  v_mov_b32 v197, 17920
  v_cndmask_b32 v124, v124, v196, vcc
  v_cndmask_b32 v123, v123, v197, vcc
  v_lshl_add_u32 v123, v194, 4, v123
  s_mul_i32 s32, s29, 320
  s_add_u32 s32, s32, 2686976
  v_ashrrev_i32 v196, 31, v124
  v_not_b32 v196, v196
  v_or_b32 v196, 0x80000000, v196
  v_xor_b32 v124, v124, v196
  v_and_b32 v124, s34, v124
  v_mul_f32 v124, 0xbfb8aa3b, v124
  v_exp_f32 v124, v124
  s_nop 0
  v_add_f32 v124, 1.0, v124
  v_rcp_f32 v124, v124
  s_nop 0
  v_cvt_pk_bf16_f32 v124, v124, v124
  v_lshlrev_b32 v124, 16, v124
  buffer_load_dword v195, v200, s[24:27], 0 offen sc1
  buffer_load_dwordx4 a[32:35], v115, s[24:27], s7 offen offset:3072 sc1
  buffer_load_dwordx4 a[36:39], v116, s[24:27], s7 offen offset:0 sc1
  buffer_load_dwordx4 a[40:43], v116, s[24:27], s7 offen offset:1024 sc1
  buffer_load_dwordx4 a[44:47], v116, s[24:27], s7 offen offset:2048 sc1
  buffer_load_dwordx4 a[48:51], v116, s[24:27], s7 offen offset:3072 sc1
  buffer_load_dwordx4 a[52:55], v114, s[24:27], s8 offen offset:0 sc1
  s_waitcnt vmcnt(16)
  v_lshlrev_b32 v90, 16, v224
  v_and_b32 v91, s34, v224
  v_lshlrev_b32 v92, 16, v225
  v_and_b32 v93, s34, v225
  s_waitcnt vmcnt(14)
  v_lshlrev_b32 v94, 16, v226
  v_and_b32 v95, s34, v226
  v_lshlrev_b32 v96, 16, v227
  v_and_b32 v97, s34, v227
  s_waitcnt vmcnt(12)
  v_lshlrev_b32 v98, 16, v228
  v_and_b32 v99, s34, v228
  v_lshlrev_b32 v100, 16, v229
  v_and_b32 v101, s34, v229
  s_waitcnt vmcnt(10)
  v_lshlrev_b32 v102, 16, v230
  v_and_b32 v103, s34, v230
  v_lshlrev_b32 v104, 16, v231
  v_and_b32 v105, s34, v231
  s_waitcnt vmcnt(8)
  v_lshlrev_b32 v106, 16, v232
  v_and_b32 v107, s34, v232
  v_lshlrev_b32 v108, 16, v233
  v_and_b32 v109, s34, v233
  v_mov_b32 v224, 0
  v_mov_b32 v225, 0
  v_mov_b32 v226, 0
  v_mov_b32 v227, 0
  v_mov_b32 v228, 0
  v_mov_b32 v229, 0
  v_mov_b32 v230, 0
  v_mov_b32 v231, 0
  v_mov_b32 v232, 0
  v_mov_b32 v233, 0
  v_mov_b32 v234, 0
  v_mov_b32 v235, 0
  v_mov_b32 v236, 0
  v_mov_b32 v237, 0
  v_mov_b32 v238, 0
  v_mov_b32 v239, 0
  v_mov_b32 v240, 0
  v_mov_b32 v241, 0
  v_mov_b32 v242, 0
  v_mov_b32 v243, 0
  s_waitcnt vmcnt(6)
  v_cmp_lt_u32 vcc, v195, v201
  s_nop 0
  s_cbranch_vccz tail_ready
  s_waitcnt vmcnt(0)
  s_mov_b32 s35, 32768
  buffer_load_dword v195, v200, s[24:27], 0 offen sc1
  s_sleep 3
  buffer_load_dword v196, v200, s[24:27], 0 offen sc1
  s_sleep 3
tail_spin:
  buffer_load_dword v197, v200, s[24:27], 0 offen sc1
  s_waitcnt vmcnt(2)
  v_cmp_lt_u32 vcc, v195, v201
  s_nop 0
  s_cbranch_vccz tail_ready
  s_sleep 3
  buffer_load_dword v195, v200, s[24:27], 0 offen sc1
  s_waitcnt vmcnt(2)
  v_cmp_lt_u32 vcc, v196, v201
  s_nop 0
  s_cbranch_vccz tail_ready
  s_sleep 3
  buffer_load_dword v196, v200, s[24:27], 0 offen sc1
  s_waitcnt vmcnt(2)
  v_cmp_lt_u32 vcc, v197, v201
  s_nop 0
  s_cbranch_vccz tail_ready
  s_sleep 3
  s_sub_u32 s35, s35, 1
  s_cmp_lg_u32 s35, 0
  s_cbranch_scc1 tail_spin
tail_ready:
  buffer_load_dwordx4 a[84:87], v110, s[24:27], s30 offen offset:0 sc1
  buffer_load_dwordx4 a[88:91], v110, s[24:27], s30 offen offset:1024 sc1
  buffer_load_dwordx4 a[92:95], v111, s[24:27], s30 offen offset:0 sc1
  buffer_load_dwordx4 a[96:99], v111, s[24:27], s30 offen offset:1024 sc1
  buffer_load_dwordx4 a[100:103], v112, s[24:27], s30 offen offset:0 sc1
  buffer_load_dwordx4 a[104:107], v112, s[24:27], s30 offen offset:1024 sc1
  buffer_load_dwordx4 a[108:111], v113, s[24:27], s30 offen offset:0 sc1
  buffer_load_dwordx4 a[112:115], v113, s[24:27], s30 offen offset:1024 sc1
  v_cmp_gt_u32 vcc, 1073741824, v123
  s_nop 0
  s_and_saveexec_b64 s[42:43], vcc
  s_cbranch_execz tail_plain
  s_waitcnt vmcnt(30)
  buffer_load_dwordx4 v[224:227], v123, s[24:27], s32 offen offset:0 sc1
  buffer_load_dwordx4 v[228:231], v123, s[24:27], s32 offen offset:64 sc1
  buffer_load_dwordx4 v[232:235], v123, s[24:27], s32 offen offset:128 sc1
  buffer_load_dwordx4 v[236:239], v123, s[24:27], s32 offen offset:192 sc1
  buffer_load_dwordx4 v[240:243], v123, s[24:27], s32 offen offset:256 sc1
  s_add_u32 s32, s32, 20480
  buffer_load_dwordx4 v[204:207], v123, s[24:27], s32 offen offset:0 sc1
  buffer_load_dwordx4 v[208:211], v123, s[24:27], s32 offen offset:64 sc1
  buffer_load_dwordx4 v[212:215], v123, s[24:27], s32 offen offset:128 sc1
  buffer_load_dwordx4 v[216:219], v123, s[24:27], s32 offen offset:192 sc1
  buffer_load_dwordx4 v[220:223], v123, s[24:27], s32 offen offset:256 sc1
  s_add_u32 s32, s32, 20480
  buffer_load_dwordx4 v[0:3], v123, s[24:27], s32 offen offset:0 sc1
  buffer_load_dwordx4 v[4:7], v123, s[24:27], s32 offen offset:64 sc1
  buffer_load_dwordx4 v[8:11], v123, s[24:27], s32 offen offset:128 sc1
  buffer_load_dwordx4 v[12:15], v123, s[24:27], s32 offen offset:192 sc1
  buffer_load_dwordx4 v[16:19], v123, s[24:27], s32 offen offset:256 sc1
  s_add_u32 s32, s32, 20480
  buffer_load_dwordx4 v[20:23], v123, s[24:27], s32 offen offset:0 sc1
  buffer_load_dwordx4 v[24:27], v123, s[24:27], s32 offen offset:64 sc1
  buffer_load_dwordx4 v[28:31], v123, s[24:27], s32 offen offset:128 sc1
  buffer_load_dwordx4 v[32:35], v123, s[24:27], s32 offen offset:192 sc1
  buffer_load_dwordx4 v[36:39], v123, s[24:27], s32 offen offset:256 sc1
  s_add_u32 s32, s32, 20480
  buffer_load_dwordx4 v[40:43], v123, s[24:27], s32 offen offset:0 sc1
  buffer_load_dwordx4 v[44:47], v123, s[24:27], s32 offen offset:64 sc1
  buffer_load_dwordx4 v[48:51], v123, s[24:27], s32 offen offset:128 sc1
  buffer_load_dwordx4 v[52:55], v123, s[24:27], s32 offen offset:192 sc1
  buffer_load_dwordx4 v[56:59], v123, s[24:27], s32 offen offset:256 sc1
  s_add_u32 s32, s32, 20480
  buffer_load_dwordx4 v[60:63], v123, s[24:27], s32 offen offset:0 sc1
  buffer_load_dwordx4 v[64:67], v123, s[24:27], s32 offen offset:64 sc1
  buffer_load_dwordx4 v[68:71], v123, s[24:27], s32 offen offset:128 sc1
  buffer_load_dwordx4 v[72:75], v123, s[24:27], s32 offen offset:192 sc1
  buffer_load_dwordx4 v[76:79], v123, s[24:27], s32 offen offset:256 sc1
  s_add_u32 s32, s32, 20480
  s_waitcnt vmcnt(0)
  v_add_f32 v224, v224, v204
  v_add_f32 v225, v225, v205
  v_add_f32 v226, v226, v206
  v_add_f32 v227, v227, v207
  v_add_f32 v228, v228, v208
  v_add_f32 v229, v229, v209
  v_add_f32 v230, v230, v210
  v_add_f32 v231, v231, v211
  v_add_f32 v232, v232, v212
  v_add_f32 v233, v233, v213
  v_add_f32 v234, v234, v214
  v_add_f32 v235, v235, v215
  v_add_f32 v236, v236, v216
  v_add_f32 v237, v237, v217
  v_add_f32 v238, v238, v218
  v_add_f32 v239, v239, v219
  v_add_f32 v240, v240, v220
  v_add_f32 v241, v241, v221
  v_add_f32 v242, v242, v222
  v_add_f32 v243, v243, v223
  v_add_f32 v224, v224, v0
  v_add_f32 v225, v225, v1
  v_add_f32 v226, v226, v2
  v_add_f32 v227, v227, v3
  v_add_f32 v228, v228, v4
  v_add_f32 v229, v229, v5
  v_add_f32 v230, v230, v6
  v_add_f32 v231, v231, v7
  v_add_f32 v232, v232, v8
  v_add_f32 v233, v233, v9
  v_add_f32 v234, v234, v10
  v_add_f32 v235, v235, v11
  v_add_f32 v236, v236, v12
  v_add_f32 v237, v237, v13
  v_add_f32 v238, v238, v14
  v_add_f32 v239, v239, v15
  v_add_f32 v240, v240, v16
  v_add_f32 v241, v241, v17
  v_add_f32 v242, v242, v18
  v_add_f32 v243, v243, v19
  v_add_f32 v224, v224, v20
  v_add_f32 v225, v225, v21
  v_add_f32 v226, v226, v22
  v_add_f32 v227, v227, v23
  v_add_f32 v228, v228, v24
  v_add_f32 v229, v229, v25
  v_add_f32 v230, v230, v26
  v_add_f32 v231, v231, v27
  v_add_f32 v232, v232, v28
  v_add_f32 v233, v233, v29
  v_add_f32 v234, v234, v30
  v_add_f32 v235, v235, v31
  v_add_f32 v236, v236, v32
  v_add_f32 v237, v237, v33
  v_add_f32 v238, v238, v34
  v_add_f32 v239, v239, v35
  v_add_f32 v240, v240, v36
  v_add_f32 v241, v241, v37
  v_add_f32 v242, v242, v38
  v_add_f32 v243, v243, v39
  v_add_f32 v224, v224, v40
  v_add_f32 v225, v225, v41
  v_add_f32 v226, v226, v42
  v_add_f32 v227, v227, v43
  v_add_f32 v228, v228, v44
  v_add_f32 v229, v229, v45
  v_add_f32 v230, v230, v46
  v_add_f32 v231, v231, v47
  v_add_f32 v232, v232, v48
  v_add_f32 v233, v233, v49
  v_add_f32 v234, v234, v50
  v_add_f32 v235, v235, v51
  v_add_f32 v236, v236, v52
  v_add_f32 v237, v237, v53
  v_add_f32 v238, v238, v54
  v_add_f32 v239, v239, v55
  v_add_f32 v240, v240, v56
  v_add_f32 v241, v241, v57
  v_add_f32 v242, v242, v58
  v_add_f32 v243, v243, v59
  v_add_f32 v224, v224, v60
  v_add_f32 v225, v225, v61
  v_add_f32 v226, v226, v62
  v_add_f32 v227, v227, v63
  v_add_f32 v228, v228, v64
  v_add_f32 v229, v229, v65
  v_add_f32 v230, v230, v66
  v_add_f32 v231, v231, v67
  v_add_f32 v232, v232, v68
  v_add_f32 v233, v233, v69
  v_add_f32 v234, v234, v70
  v_add_f32 v235, v235, v71
  v_add_f32 v236, v236, v72
  v_add_f32 v237, v237, v73
  v_add_f32 v238, v238, v74
  v_add_f32 v239, v239, v75
  v_add_f32 v240, v240, v76
  v_add_f32 v241, v241, v77
  v_add_f32 v242, v242, v78
  v_add_f32 v243, v243, v79
tail_plain:
  s_mov_b64 exec, s[42:43]
  s_waitcnt vmcnt(0)
  v_mfma_f32_16x16x32_bf16 v[0:3], a[212:215], a[84:87], 0
  s_add_u32 s30, s30, 8192
  buffer_load_dwordx4 a[116:119], v110, s[24:27], s30 offen offset:0 sc1
  v_mfma_f32_16x16x32_bf16 v[0:3], a[232:235], a[88:91], v[0:3]
  v_cvt_pk_bf16_f32 v224, v224, v224
  v_cvt_pk_bf16_f32 v225, v225, v225
  v_mfma_f32_16x16x32_bf16 v[4:7], a[232:235], a[96:99], 0
  buffer_load_dwordx4 a[56:59], v114, s[24:27], s8 offen offset:1024 sc1
  v_mfma_f32_16x16x32_bf16 v[4:7], a[212:215], a[92:95], v[4:7]
  v_cvt_pk_bf16_f32 v226, v226, v226
  v_cvt_pk_bf16_f32 v227, v227, v227
  v_mfma_f32_16x16x32_bf16 v[8:11], a[212:215], a[100:103], 0
  buffer_load_dwordx4 a[120:123], v110, s[24:27], s30 offen offset:1024 sc1
  v_mfma_f32_16x16x32_bf16 v[8:11], a[232:235], a[104:107], v[8:11]
  v_lshlrev_b32 v224, 16, v224
  v_lshlrev_b32 v225, 16, v225
  v_mfma_f32_16x16x32_bf16 v[12:15], a[232:235], a[112:115], 0
  v_lshlrev_b32 v226, 16, v226
  v_lshlrev_b32 v227, 16, v227
  v_mfma_f32_16x16x32_bf16 v[12:15], a[212:215], a[108:111], v[12:15]
  v_mul_f32 v224, v224, v124
  v_mul_f32 v225, v225, v124
  v_mfma_f32_16x16x32_bf16 v[16:19], a[216:219], a[84:87], 0
  buffer_load_dwordx4 a[124:127], v111, s[24:27], s30 offen offset:0 sc1
  v_mfma_f32_16x16x32_bf16 v[16:19], a[236:239], a[88:91], v[16:19]
  v_mul_f32 v226, v226, v124
  v_mul_f32 v227, v227, v124
  v_mfma_f32_16x16x32_bf16 v[20:23], a[236:239], a[96:99], 0
  buffer_load_dwordx4 a[60:63], v114, s[24:27], s8 offen offset:2048 sc1
  v_mfma_f32_16x16x32_bf16 v[20:23], a[216:219], a[92:95], v[20:23]
  v_cvt_pk_bf16_f32 v224, v224, v224
  v_cvt_pk_bf16_f32 v225, v225, v225
  v_mfma_f32_16x16x32_bf16 v[24:27], a[216:219], a[100:103], 0
  buffer_load_dwordx4 a[160:163], v111, s[24:27], s30 offen offset:1024 sc1
  v_mfma_f32_16x16x32_bf16 v[24:27], a[236:239], a[104:107], v[24:27]
  v_cvt_pk_bf16_f32 v226, v226, v226
  v_cvt_pk_bf16_f32 v227, v227, v227
  v_mfma_f32_16x16x32_bf16 v[28:31], a[236:239], a[112:115], 0
  v_lshlrev_b32 v224, 16, v224
  v_lshlrev_b32 v225, 16, v225
  v_mfma_f32_16x16x32_bf16 v[28:31], a[216:219], a[108:111], v[28:31]
  v_lshlrev_b32 v226, 16, v226
  v_lshlrev_b32 v227, 16, v227
  v_mfma_f32_16x16x32_bf16 v[32:35], a[220:223], a[84:87], 0
  buffer_load_dwordx4 a[164:167], v112, s[24:27], s30 offen offset:0 sc1
  v_mfma_f32_16x16x32_bf16 v[32:35], a[240:243], a[88:91], v[32:35]
  v_add_f32 v90, v90, v224
  v_add_f32 v91, v91, v225
  v_mfma_f32_16x16x32_bf16 v[36:39], a[240:243], a[96:99], 0
  buffer_load_dwordx4 a[64:67], v114, s[24:27], s8 offen offset:3072 sc1
  v_mfma_f32_16x16x32_bf16 v[36:39], a[220:223], a[92:95], v[36:39]
  v_add_f32 v92, v92, v226
  v_add_f32 v93, v93, v227
  v_mfma_f32_16x16x32_bf16 v[40:43], a[220:223], a[100:103], 0
  buffer_load_dwordx4 a[168:171], v112, s[24:27], s30 offen offset:1024 sc1
  v_mfma_f32_16x16x32_bf16 v[40:43], a[240:243], a[104:107], v[40:43]
  v_cvt_pk_bf16_f32 v90, v90, v90
  v_cvt_pk_bf16_f32 v91, v91, v91
  v_mfma_f32_16x16x32_bf16 v[44:47], a[240:243], a[112:115], 0
  v_cvt_pk_bf16_f32 v92, v92, v92
  v_cvt_pk_bf16_f32 v93, v93, v93
  v_mfma_f32_16x16x32_bf16 v[44:47], a[220:223], a[108:111], v[44:47]
  v_lshlrev_b32 v90, 16, v90
  v_lshlrev_b32 v91, 16, v91
  v_mfma_f32_16x16x32_bf16 v[48:51], a[224:227], a[84:87], 0
  buffer_load_dwordx4 a[172:175], v113, s[24:27], s30 offen offset:0 sc1
  v_mfma_f32_16x16x32_bf16 v[48:51], a[244:247], a[88:91], v[48:51]
  v_lshlrev_b32 v92, 16, v92
  v_lshlrev_b32 v93, 16, v93
  v_mfma_f32_16x16x32_bf16 v[52:55], a[244:247], a[96:99], 0
  buffer_load_dwordx4 a[68:71], v115, s[24:27], s8 offen offset:0 sc1
  v_mfma_f32_16x16x32_bf16 v[52:55], a[224:227], a[92:95], v[52:55]
  v_mul_f32 v196, 0xbfb8aa3b, v90
  v_mul_f32 v197, 0xbfb8aa3b, v91
  v_mfma_f32_16x16x32_bf16 v[56:59], a[224:227], a[100:103], 0
  buffer_load_dwordx4 a[176:179], v113, s[24:27], s30 offen offset:1024 sc1
  v_mfma_f32_16x16x32_bf16 v[56:59], a[244:247], a[104:107], v[56:59]
  v_mul_f32 v198, 0xbfb8aa3b, v92
  v_mul_f32 v199, 0xbfb8aa3b, v93
  v_mfma_f32_16x16x32_bf16 v[60:63], a[244:247], a[112:115], 0
  v_exp_f32 v196, v196
  v_mfma_f32_16x16x32_bf16 v[60:63], a[224:227], a[108:111], v[60:63]
  v_exp_f32 v197, v197
  v_mfma_f32_16x16x32_bf16 v[64:67], a[228:231], a[84:87], 0
  s_add_u32 s30, s30, 8192
  buffer_load_dwordx4 a[180:183], v110, s[24:27], s30 offen offset:0 sc1
  v_mfma_f32_16x16x32_bf16 v[64:67], a[248:251], a[88:91], v[64:67]
  v_exp_f32 v198, v198
  v_mfma_f32_16x16x32_bf16 v[68:71], a[248:251], a[96:99], 0
  buffer_load_dwordx4 a[72:75], v115, s[24:27], s8 offen offset:1024 sc1
  v_mfma_f32_16x16x32_bf16 v[68:71], a[228:231], a[92:95], v[68:71]
  v_exp_f32 v199, v199
  v_mfma_f32_16x16x32_bf16 v[72:75], a[228:231], a[100:103], 0
  buffer_load_dwordx4 a[184:187], v110, s[24:27], s30 offen offset:1024 sc1
  v_mfma_f32_16x16x32_bf16 v[72:75], a[248:251], a[104:107], v[72:75]
  v_add_f32 v196, 1.0, v196
  v_add_f32 v197, 1.0, v197
  v_mfma_f32_16x16x32_bf16 v[76:79], a[248:251], a[112:115], 0
  v_add_f32 v198, 1.0, v198
  v_add_f32 v199, 1.0, v199
  v_mfma_f32_16x16x32_bf16 v[76:79], a[228:231], a[108:111], v[76:79]
  v_rcp_f32 v196, v196
  s_waitcnt vmcnt(3)
  v_mfma_f32_16x16x32_bf16 v[0:3], a[252:255], a[116:119], v[0:3]
  buffer_load_dwordx4 a[188:191], v111, s[24:27], s30 offen offset:0 sc1
  v_mfma_f32_16x16x32_bf16 v[0:3], a[144:147], a[120:123], v[0:3]
  v_rcp_f32 v197, v197
  v_mfma_f32_16x16x32_bf16 v[4:7], a[144:147], a[160:163], v[4:7]
  buffer_load_dwordx4 a[76:79], v115, s[24:27], s8 offen offset:2048 sc1
  v_mfma_f32_16x16x32_bf16 v[4:7], a[252:255], a[124:127], v[4:7]
  v_rcp_f32 v198, v198
  v_mfma_f32_16x16x32_bf16 v[8:11], a[252:255], a[164:167], v[8:11]
  buffer_load_dwordx4 a[192:195], v111, s[24:27], s30 offen offset:1024 sc1
  v_mfma_f32_16x16x32_bf16 v[8:11], a[144:147], a[168:171], v[8:11]
  v_rcp_f32 v199, v199
  v_mfma_f32_16x16x32_bf16 v[12:15], a[144:147], a[176:179], v[12:15]
  v_mul_f32 v90, v90, v196
  v_mul_f32 v91, v91, v197
  v_mfma_f32_16x16x32_bf16 v[12:15], a[252:255], a[172:175], v[12:15]
  v_mul_f32 v92, v92, v198
  v_mul_f32 v93, v93, v199
  v_mfma_f32_16x16x32_bf16 v[16:19], a[128:131], a[116:119], v[16:19]
  buffer_load_dwordx4 a[196:199], v112, s[24:27], s30 offen offset:0 sc1
  v_mfma_f32_16x16x32_bf16 v[16:19], a[148:151], a[120:123], v[16:19]
  v_cvt_pk_bf16_f32 v90, v90, v90
  v_cvt_pk_bf16_f32 v91, v91, v91
  v_mfma_f32_16x16x32_bf16 v[20:23], a[148:151], a[160:163], v[20:23]
  buffer_load_dwordx4 a[80:83], v115, s[24:27], s8 offen offset:3072 sc1
  v_mfma_f32_16x16x32_bf16 v[20:23], a[128:131], a[124:127], v[20:23]
  v_cvt_pk_bf16_f32 v92, v92, v92
  v_cvt_pk_bf16_f32 v93, v93, v93
  v_mfma_f32_16x16x32_bf16 v[24:27], a[128:131], a[164:167], v[24:27]
  buffer_load_dwordx4 a[200:203], v112, s[24:27], s30 offen offset:1024 sc1
  v_mfma_f32_16x16x32_bf16 v[24:27], a[148:151], a[168:171], v[24:27]
  v_lshlrev_b32 v90, 16, v90
  v_lshlrev_b32 v91, 16, v91
  v_mfma_f32_16x16x32_bf16 v[28:31], a[148:151], a[176:179], v[28:31]
  v_lshlrev_b32 v92, 16, v92
  v_lshlrev_b32 v93, 16, v93
  v_mfma_f32_16x16x32_bf16 v[28:31], a[128:131], a[172:175], v[28:31]
  v_cvt_pk_bf16_f32 v228, v228, v228
  v_cvt_pk_bf16_f32 v229, v229, v229
  v_mfma_f32_16x16x32_bf16 v[32:35], a[132:135], a[116:119], v[32:35]
  buffer_load_dwordx4 a[204:207], v113, s[24:27], s30 offen offset:0 sc1
  v_mfma_f32_16x16x32_bf16 v[32:35], a[152:155], a[120:123], v[32:35]
  v_cvt_pk_bf16_f32 v230, v230, v230
  v_cvt_pk_bf16_f32 v231, v231, v231
  v_mfma_f32_16x16x32_bf16 v[36:39], a[152:155], a[160:163], v[36:39]
  s_add_u32 m0, s28, 49152
  s_nop 0
  buffer_load_dwordx4 v115, s[24:27], s10 offen offset:0 sc1 lds
  v_mfma_f32_16x16x32_bf16 v[36:39], a[132:135], a[124:127], v[36:39]
  buffer_load_dwordx4 v115, s[24:27], s10 offen offset:1024 sc1 lds
  v_mfma_f32_16x16x32_bf16 v[40:43], a[132:135], a[164:167], v[40:43]
  buffer_load_dwordx4 v115, s[24:27], s10 offen offset:2048 sc1 lds
  v_mfma_f32_16x16x32_bf16 v[40:43], a[152:155], a[168:171], v[40:43]
  buffer_load_dwordx4 v115, s[24:27], s10 offen offset:3072 sc1 lds
  v_mfma_f32_16x16x32_bf16 v[44:47], a[152:155], a[176:179], v[44:47]
  buffer_load_dwordx4 a[208:211], v113, s[24:27], s30 offen offset:1024 sc1
  v_mfma_f32_16x16x32_bf16 v[44:47], a[132:135], a[172:175], v[44:47]
  v_lshlrev_b32 v228, 16, v228
  v_lshlrev_b32 v229, 16, v229
  v_mfma_f32_16x16x32_bf16 v[48:51], a[136:139], a[116:119], v[48:51]
  s_add_u32 s30, s30, 8192
  buffer_load_dwordx4 v[244:247], v110, s[24:27], s30 offen offset:0 sc1
  v_mfma_f32_16x16x32_bf16 v[48:51], a[156:159], a[120:123], v[48:51]
  v_lshlrev_b32 v230, 16, v230
  v_lshlrev_b32 v231, 16, v231
  v_mfma_f32_16x16x32_bf16 v[52:55], a[156:159], a[160:163], v[52:55]
  v_mul_f32 v228, v228, v124
  v_mul_f32 v229, v229, v124
  v_mfma_f32_16x16x32_bf16 v[52:55], a[136:139], a[124:127], v[52:55]
  v_mul_f32 v230, v230, v124
  v_mul_f32 v231, v231, v124
  v_mfma_f32_16x16x32_bf16 v[56:59], a[136:139], a[164:167], v[56:59]
  buffer_load_dwordx4 v[248:251], v110, s[24:27], s30 offen offset:1024 sc1
  v_mfma_f32_16x16x32_bf16 v[56:59], a[156:159], a[168:171], v[56:59]
  v_cvt_pk_bf16_f32 v228, v228, v228
  v_cvt_pk_bf16_f32 v229, v229, v229
  v_mfma_f32_16x16x32_bf16 v[60:63], a[156:159], a[176:179], v[60:63]
  v_cvt_pk_bf16_f32 v230, v230, v230
  v_cvt_pk_bf16_f32 v231, v231, v231
  v_mfma_f32_16x16x32_bf16 v[60:63], a[136:139], a[172:175], v[60:63]
  v_lshlrev_b32 v228, 16, v228
  v_lshlrev_b32 v229, 16, v229
  v_mfma_f32_16x16x32_bf16 v[64:67], a[140:143], a[116:119], v[64:67]
  buffer_load_dwordx4 v[252:255], v111, s[24:27], s30 offen offset:0 sc1
  v_mfma_f32_16x16x32_bf16 v[64:67], v[128:131], a[120:123], v[64:67]
  v_lshlrev_b32 v230, 16, v230
  v_lshlrev_b32 v231, 16, v231
  v_mfma_f32_16x16x32_bf16 v[68:71], v[128:131], a[160:163], v[68:71]
  v_add_f32 v94, v94, v228
  v_add_f32 v95, v95, v229
  v_mfma_f32_16x16x32_bf16 v[68:71], a[140:143], a[124:127], v[68:71]
  v_add_f32 v96, v96, v230
  v_add_f32 v97, v97, v231
  v_mfma_f32_16x16x32_bf16 v[72:75], a[140:143], a[164:167], v[72:75]
  buffer_load_dwordx4 v[204:207], v111, s[24:27], s30 offen offset:1024 sc1
  v_mfma_f32_16x16x32_bf16 v[72:75], v[128:131], a[168:171], v[72:75]
  v_cvt_pk_bf16_f32 v94, v94, v94
  v_cvt_pk_bf16_f32 v95, v95, v95
  v_mfma_f32_16x16x32_bf16 v[76:79], v[128:131], a[176:179], v[76:79]
  v_cvt_pk_bf16_f32 v96, v96, v96
  v_cvt_pk_bf16_f32 v97, v97, v97
  v_mfma_f32_16x16x32_bf16 v[76:79], a[140:143], a[172:175], v[76:79]
  v_lshlrev_b32 v94, 16, v94
  v_lshlrev_b32 v95, 16, v95
  s_waitcnt vmcnt(4)
  v_mfma_f32_16x16x32_bf16 v[0:3], v[132:135], a[180:183], v[0:3]
  buffer_load_dwordx4 v[208:211], v112, s[24:27], s30 offen offset:0 sc1
  v_mfma_f32_16x16x32_bf16 v[0:3], v[152:155], a[184:187], v[0:3]
  v_lshlrev_b32 v96, 16, v96
  v_lshlrev_b32 v97, 16, v97
  v_mfma_f32_16x16x32_bf16 v[4:7], v[152:155], a[192:195], v[4:7]
  v_mul_f32 v196, 0xbfb8aa3b, v94
  v_mul_f32 v197, 0xbfb8aa3b, v95
  v_mfma_f32_16x16x32_bf16 v[4:7], v[132:135], a[188:191], v[4:7]
  v_mul_f32 v198, 0xbfb8aa3b, v96
  v_mul_f32 v199, 0xbfb8aa3b, v97
  v_mfma_f32_16x16x32_bf16 v[8:11], v[132:135], a[196:199], v[8:11]
  buffer_load_dwordx4 v[212:215], v112, s[24:27], s30 offen offset:1024 sc1
  v_mfma_f32_16x16x32_bf16 v[8:11], v[152:155], a[200:203], v[8:11]
  v_exp_f32 v196, v196
  v_mfma_f32_16x16x32_bf16 v[12:15], v[152:155], a[208:211], v[12:15]
  v_exp_f32 v197, v197
  v_mfma_f32_16x16x32_bf16 v[12:15], v[132:135], a[204:207], v[12:15]
  v_exp_f32 v198, v198
  v_mfma_f32_16x16x32_bf16 v[16:19], v[136:139], a[180:183], v[16:19]
  buffer_load_dwordx4 v[216:219], v113, s[24:27], s30 offen offset:0 sc1
  v_mfma_f32_16x16x32_bf16 v[16:19], v[156:159], a[184:187], v[16:19]
  v_exp_f32 v199, v199
  v_mfma_f32_16x16x32_bf16 v[20:23], v[156:159], a[192:195], v[20:23]
  v_add_f32 v196, 1.0, v196
  v_add_f32 v197, 1.0, v197
  v_mfma_f32_16x16x32_bf16 v[20:23], v[136:139], a[188:191], v[20:23]
  v_add_f32 v198, 1.0, v198
  v_add_f32 v199, 1.0, v199
  v_mfma_f32_16x16x32_bf16 v[24:27], v[136:139], a[196:199], v[24:27]
  buffer_load_dwordx4 v[220:223], v113, s[24:27], s30 offen offset:1024 sc1
  v_mfma_f32_16x16x32_bf16 v[24:27], v[156:159], a[200:203], v[24:27]
  v_rcp_f32 v196, v196
  v_mfma_f32_16x16x32_bf16 v[28:31], v[156:159], a[208:211], v[28:31]
  v_rcp_f32 v197, v197
  v_mfma_f32_16x16x32_bf16 v[28:31], v[136:139], a[204:207], v[28:31]
  v_rcp_f32 v198, v198
  v_mfma_f32_16x16x32_bf16 v[32:35], v[140:143], a[180:183], v[32:35]
  s_add_u32 s30, s30, 8192
  buffer_load_dwordx4 a[84:87], v110, s[24:27], s30 offen offset:0 sc1
  v_mfma_f32_16x16x32_bf16 v[32:35], v[160:163], a[184:187], v[32:35]
  v_rcp_f32 v199, v199
  v_mfma_f32_16x16x32_bf16 v[36:39], v[160:163], a[192:195], v[36:39]
  v_mul_f32 v94, v94, v196
  v_mul_f32 v95, v95, v197
  v_mfma_f32_16x16x32_bf16 v[36:39], v[140:143], a[188:191], v[36:39]
  v_mul_f32 v96, v96, v198
  v_mul_f32 v97, v97, v199
  v_mfma_f32_16x16x32_bf16 v[40:43], v[140:143], a[196:199], v[40:43]
  buffer_load_dwordx4 a[88:91], v110, s[24:27], s30 offen offset:1024 sc1
  v_mfma_f32_16x16x32_bf16 v[40:43], v[160:163], a[200:203], v[40:43]
  v_cvt_pk_bf16_f32 v94, v94, v94
  v_cvt_pk_bf16_f32 v95, v95, v95
  v_mfma_f32_16x16x32_bf16 v[44:47], v[160:163], a[208:211], v[44:47]
  v_cvt_pk_bf16_f32 v96, v96, v96
  v_cvt_pk_bf16_f32 v97, v97, v97
  v_mfma_f32_16x16x32_bf16 v[44:47], v[140:143], a[204:207], v[44:47]
  v_lshlrev_b32 v94, 16, v94
  v_lshlrev_b32 v95, 16, v95
  v_mfma_f32_16x16x32_bf16 v[48:51], v[144:147], a[180:183], v[48:51]
  buffer_load_dwordx4 a[92:95], v111, s[24:27], s30 offen offset:0 sc1
  v_mfma_f32_16x16x32_bf16 v[48:51], v[164:167], a[184:187], v[48:51]
  v_lshlrev_b32 v96, 16, v96
  v_lshlrev_b32 v97, 16, v97
  v_mfma_f32_16x16x32_bf16 v[52:55], v[164:167], a[192:195], v[52:55]
  v_cvt_pk_bf16_f32 v232, v232, v232
  v_cvt_pk_bf16_f32 v233, v233, v233
  v_mfma_f32_16x16x32_bf16 v[52:55], v[144:147], a[188:191], v[52:55]
  v_cvt_pk_bf16_f32 v234, v234, v234
  v_cvt_pk_bf16_f32 v235, v235, v235
  v_mfma_f32_16x16x32_bf16 v[56:59], v[144:147], a[196:199], v[56:59]
  buffer_load_dwordx4 a[96:99], v111, s[24:27], s30 offen offset:1024 sc1
  v_mfma_f32_16x16x32_bf16 v[56:59], v[164:167], a[200:203], v[56:59]
  v_lshlrev_b32 v232, 16, v232
  v_lshlrev_b32 v233, 16, v233
  v_mfma_f32_16x16x32_bf16 v[60:63], v[164:167], a[208:211], v[60:63]
  v_lshlrev_b32 v234, 16, v234
  v_lshlrev_b32 v235, 16, v235
  v_mfma_f32_16x16x32_bf16 v[60:63], v[144:147], a[204:207], v[60:63]
  v_mul_f32 v232, v232, v124
  v_mul_f32 v233, v233, v124
  v_mfma_f32_16x16x32_bf16 v[64:67], v[148:151], a[180:183], v[64:67]
  buffer_load_dwordx4 a[100:103], v112, s[24:27], s30 offen offset:0 sc1
  v_mfma_f32_16x16x32_bf16 v[64:67], v[168:171], a[184:187], v[64:67]
  v_mul_f32 v234, v234, v124
  v_mul_f32 v235, v235, v124
  v_mfma_f32_16x16x32_bf16 v[68:71], v[168:171], a[192:195], v[68:71]
  v_cvt_pk_bf16_f32 v232, v232, v232
  v_cvt_pk_bf16_f32 v233, v233, v233
  v_mfma_f32_16x16x32_bf16 v[68:71], v[148:151], a[188:191], v[68:71]
  v_cvt_pk_bf16_f32 v234, v234, v234
  v_cvt_pk_bf16_f32 v235, v235, v235
  v_mfma_f32_16x16x32_bf16 v[72:75], v[148:151], a[196:199], v[72:75]
  buffer_load_dwordx4 a[104:107], v112, s[24:27], s30 offen offset:1024 sc1
  v_mfma_f32_16x16x32_bf16 v[72:75], v[168:171], a[200:203], v[72:75]
  v_lshlrev_b32 v232, 16, v232
  v_lshlrev_b32 v233, 16, v233
  v_mfma_f32_16x16x32_bf16 v[76:79], v[168:171], a[208:211], v[76:79]
  v_lshlrev_b32 v234, 16, v234
  v_lshlrev_b32 v235, 16, v235
  v_mfma_f32_16x16x32_bf16 v[76:79], v[148:151], a[204:207], v[76:79]
  v_add_f32 v98, v98, v232
  v_add_f32 v99, v99, v233
  s_waitcnt vmcnt(6)
  v_mfma_f32_16x16x32_bf16 v[0:3], v[172:175], v[244:247], v[0:3]
  buffer_load_dwordx4 a[108:111], v113, s[24:27], s30 offen offset:0 sc1
  v_mfma_f32_16x16x32_bf16 v[0:3], a[0:3], v[248:251], v[0:3]
  v_add_f32 v100, v100, v234
  v_add_f32 v101, v101, v235
  v_mfma_f32_16x16x32_bf16 v[4:7], a[0:3], v[204:207], v[4:7]
  v_cvt_pk_bf16_f32 v98, v98, v98
  v_cvt_pk_bf16_f32 v99, v99, v99
  v_mfma_f32_16x16x32_bf16 v[4:7], v[172:175], v[252:255], v[4:7]
  v_cvt_pk_bf16_f32 v100, v100, v100
  v_cvt_pk_bf16_f32 v101, v101, v101
  v_mfma_f32_16x16x32_bf16 v[8:11], v[172:175], v[208:211], v[8:11]
  buffer_load_dwordx4 a[112:115], v113, s[24:27], s30 offen offset:1024 sc1
  v_mfma_f32_16x16x32_bf16 v[8:11], a[0:3], v[212:215], v[8:11]
  v_lshlrev_b32 v98, 16, v98
  v_lshlrev_b32 v99, 16, v99
  v_mfma_f32_16x16x32_bf16 v[12:15], a[0:3], v[220:223], v[12:15]
  v_lshlrev_b32 v100, 16, v100
  v_lshlrev_b32 v101, 16, v101
  v_mfma_f32_16x16x32_bf16 v[12:15], v[172:175], v[216:219], v[12:15]
  v_mul_f32 v196, 0xbfb8aa3b, v98
  v_mul_f32 v197, 0xbfb8aa3b, v99
  v_mfma_f32_16x16x32_bf16 v[16:19], v[176:179], v[244:247], v[16:19]
  s_add_u32 s30, s30, 8192
  buffer_load_dwordx4 a[116:119], v110, s[24:27], s30 offen offset:0 sc1
  v_mfma_f32_16x16x32_bf16 v[16:19], a[4:7], v[248:251], v[16:19]
  v_mul_f32 v198, 0xbfb8aa3b, v100
  v_mul_f32 v199, 0xbfb8aa3b, v101
  v_mfma_f32_16x16x32_bf16 v[20:23], a[4:7], v[204:207], v[20:23]
  v_exp_f32 v196, v196
  v_mfma_f32_16x16x32_bf16 v[20:23], v[176:179], v[252:255], v[20:23]
  v_exp_f32 v197, v197
  v_mfma_f32_16x16x32_bf16 v[24:27], v[176:179], v[208:211], v[24:27]
  buffer_load_dwordx4 a[120:123], v110, s[24:27], s30 offen offset:1024 sc1
  v_mfma_f32_16x16x32_bf16 v[24:27], a[4:7], v[212:215], v[24:27]
  v_exp_f32 v198, v198
  v_mfma_f32_16x16x32_bf16 v[28:31], a[4:7], v[220:223], v[28:31]
  v_exp_f32 v199, v199
  v_mfma_f32_16x16x32_bf16 v[28:31], v[176:179], v[216:219], v[28:31]
  v_add_f32 v196, 1.0, v196
  v_add_f32 v197, 1.0, v197
  v_mfma_f32_16x16x32_bf16 v[32:35], v[180:183], v[244:247], v[32:35]
  buffer_load_dwordx4 a[124:127], v111, s[24:27], s30 offen offset:0 sc1
  v_mfma_f32_16x16x32_bf16 v[32:35], a[8:11], v[248:251], v[32:35]
  v_add_f32 v198, 1.0, v198
  v_add_f32 v199, 1.0, v199
  v_mfma_f32_16x16x32_bf16 v[36:39], a[8:11], v[204:207], v[36:39]
  v_rcp_f32 v196, v196
  v_mfma_f32_16x16x32_bf16 v[36:39], v[180:183], v[252:255], v[36:39]
  v_rcp_f32 v197, v197
  v_mfma_f32_16x16x32_bf16 v[40:43], v[180:183], v[208:211], v[40:43]
  buffer_load_dwordx4 a[160:163], v111, s[24:27], s30 offen offset:1024 sc1
  v_mfma_f32_16x16x32_bf16 v[40:43], a[8:11], v[212:215], v[40:43]
  v_rcp_f32 v198, v198
  v_mfma_f32_16x16x32_bf16 v[44:47], a[8:11], v[220:223], v[44:47]
  v_rcp_f32 v199, v199
  v_mfma_f32_16x16x32_bf16 v[44:47], v[180:183], v[216:219], v[44:47]
  v_mul_f32 v98, v98, v196
  v_mul_f32 v99, v99, v197
  v_mfma_f32_16x16x32_bf16 v[48:51], v[184:187], v[244:247], v[48:51]
  buffer_load_dwordx4 a[164:167], v112, s[24:27], s30 offen offset:0 sc1
  v_mfma_f32_16x16x32_bf16 v[48:51], a[12:15], v[248:251], v[48:51]
  v_mul_f32 v100, v100, v198
  v_mul_f32 v101, v101, v199
  v_mfma_f32_16x16x32_bf16 v[52:55], a[12:15], v[204:207], v[52:55]
  v_cvt_pk_bf16_f32 v98, v98, v98
  v_cvt_pk_bf16_f32 v99, v99, v99
  v_mfma_f32_16x16x32_bf16 v[52:55], v[184:187], v[252:255], v[52:55]
  v_cvt_pk_bf16_f32 v100, v100, v100
  v_cvt_pk_bf16_f32 v101, v101, v101
  v_mfma_f32_16x16x32_bf16 v[56:59], v[184:187], v[208:211], v[56:59]
  buffer_load_dwordx4 a[168:171], v112, s[24:27], s30 offen offset:1024 sc1
  v_mfma_f32_16x16x32_bf16 v[56:59], a[12:15], v[212:215], v[56:59]
  v_lshlrev_b32 v98, 16, v98
  v_lshlrev_b32 v99, 16, v99
  v_mfma_f32_16x16x32_bf16 v[60:63], a[12:15], v[220:223], v[60:63]
  v_lshlrev_b32 v100, 16, v100
  v_lshlrev_b32 v101, 16, v101
  v_mfma_f32_16x16x32_bf16 v[60:63], v[184:187], v[216:219], v[60:63]
  v_cvt_pk_bf16_f32 v236, v236, v236
  v_cvt_pk_bf16_f32 v237, v237, v237
  v_mfma_f32_16x16x32_bf16 v[64:67], v[188:191], v[244:247], v[64:67]
  buffer_load_dwordx4 a[172:175], v113, s[24:27], s30 offen offset:0 sc1
  v_mfma_f32_16x16x32_bf16 v[64:67], a[16:19], v[248:251], v[64:67]
  v_cvt_pk_bf16_f32 v238, v238, v238
  v_cvt_pk_bf16_f32 v239, v239, v239
  v_mfma_f32_16x16x32_bf16 v[68:71], a[16:19], v[204:207], v[68:71]
  v_lshlrev_b32 v236, 16, v236
  v_lshlrev_b32 v237, 16, v237
  v_mfma_f32_16x16x32_bf16 v[68:71], v[188:191], v[252:255], v[68:71]
  v_lshlrev_b32 v238, 16, v238
  v_lshlrev_b32 v239, 16, v239
  v_mfma_f32_16x16x32_bf16 v[72:75], v[188:191], v[208:211], v[72:75]
  buffer_load_dwordx4 a[176:179], v113, s[24:27], s30 offen offset:1024 sc1
  v_mfma_f32_16x16x32_bf16 v[72:75], a[16:19], v[212:215], v[72:75]
  v_mul_f32 v236, v236, v124
  v_mul_f32 v237, v237, v124
  v_mfma_f32_16x16x32_bf16 v[76:79], a[16:19], v[220:223], v[76:79]
  v_mul_f32 v238, v238, v124
  v_mul_f32 v239, v239, v124
  v_mfma_f32_16x16x32_bf16 v[76:79], v[188:191], v[216:219], v[76:79]
  v_cvt_pk_bf16_f32 v236, v236, v236
  v_cvt_pk_bf16_f32 v237, v237, v237
  s_waitcnt vmcnt(8)
  v_mfma_f32_16x16x32_bf16 v[0:3], a[20:23], a[84:87], v[0:3]
  s_add_u32 s30, s30, 8192
  buffer_load_dwordx4 a[180:183], v110, s[24:27], s30 offen offset:0 sc1
  v_mfma_f32_16x16x32_bf16 v[0:3], a[40:43], a[88:91], v[0:3]
  v_cvt_pk_bf16_f32 v238, v238, v238
  v_cvt_pk_bf16_f32 v239, v239, v239
  v_mfma_f32_16x16x32_bf16 v[4:7], a[40:43], a[96:99], v[4:7]
  v_lshlrev_b32 v236, 16, v236
  v_lshlrev_b32 v237, 16, v237
  v_mfma_f32_16x16x32_bf16 v[4:7], a[20:23], a[92:95], v[4:7]
  v_lshlrev_b32 v238, 16, v238
  v_lshlrev_b32 v239, 16, v239
  v_mfma_f32_16x16x32_bf16 v[8:11], a[20:23], a[100:103], v[8:11]
  buffer_load_dwordx4 a[184:187], v110, s[24:27], s30 offen offset:1024 sc1
  v_mfma_f32_16x16x32_bf16 v[8:11], a[40:43], a[104:107], v[8:11]
  v_add_f32 v102, v102, v236
  v_add_f32 v103, v103, v237
  v_mfma_f32_16x16x32_bf16 v[12:15], a[40:43], a[112:115], v[12:15]
  v_add_f32 v104, v104, v238
  v_add_f32 v105, v105, v239
  v_mfma_f32_16x16x32_bf16 v[12:15], a[20:23], a[108:111], v[12:15]
  v_cvt_pk_bf16_f32 v102, v102, v102
  v_cvt_pk_bf16_f32 v103, v103, v103
  v_mfma_f32_16x16x32_bf16 v[16:19], a[24:27], a[84:87], v[16:19]
  buffer_load_dwordx4 a[188:191], v111, s[24:27], s30 offen offset:0 sc1
  v_mfma_f32_16x16x32_bf16 v[16:19], a[44:47], a[88:91], v[16:19]
  v_cvt_pk_bf16_f32 v104, v104, v104
  v_cvt_pk_bf16_f32 v105, v105, v105
  v_mfma_f32_16x16x32_bf16 v[20:23], a[44:47], a[96:99], v[20:23]
  v_lshlrev_b32 v102, 16, v102
  v_lshlrev_b32 v103, 16, v103
  v_mfma_f32_16x16x32_bf16 v[20:23], a[24:27], a[92:95], v[20:23]
  v_lshlrev_b32 v104, 16, v104
  v_lshlrev_b32 v105, 16, v105
  v_mfma_f32_16x16x32_bf16 v[24:27], a[24:27], a[100:103], v[24:27]
  buffer_load_dwordx4 a[192:195], v111, s[24:27], s30 offen offset:1024 sc1
  v_mfma_f32_16x16x32_bf16 v[24:27], a[44:47], a[104:107], v[24:27]
  v_mul_f32 v196, 0xbfb8aa3b, v102
  v_mul_f32 v197, 0xbfb8aa3b, v103
  v_mfma_f32_16x16x32_bf16 v[28:31], a[44:47], a[112:115], v[28:31]
  v_mul_f32 v198, 0xbfb8aa3b, v104
  v_mul_f32 v199, 0xbfb8aa3b, v105
  v_mfma_f32_16x16x32_bf16 v[28:31], a[24:27], a[108:111], v[28:31]
  v_exp_f32 v196, v196
  v_mfma_f32_16x16x32_bf16 v[32:35], a[28:31], a[84:87], v[32:35]
  buffer_load_dwordx4 a[196:199], v112, s[24:27], s30 offen offset:0 sc1
  v_mfma_f32_16x16x32_bf16 v[32:35], a[48:51], a[88:91], v[32:35]
  v_exp_f32 v197, v197
  v_mfma_f32_16x16x32_bf16 v[36:39], a[48:51], a[96:99], v[36:39]
  v_exp_f32 v198, v198
  v_mfma_f32_16x16x32_bf16 v[36:39], a[28:31], a[92:95], v[36:39]
  v_exp_f32 v199, v199
  v_mfma_f32_16x16x32_bf16 v[40:43], a[28:31], a[100:103], v[40:43]
  buffer_load_dwordx4 a[200:203], v112, s[24:27], s30 offen offset:1024 sc1
  v_mfma_f32_16x16x32_bf16 v[40:43], a[48:51], a[104:107], v[40:43]
  v_add_f32 v196, 1.0, v196
  v_add_f32 v197, 1.0, v197
  v_mfma_f32_16x16x32_bf16 v[44:47], a[48:51], a[112:115], v[44:47]
  v_add_f32 v198, 1.0, v198
  v_add_f32 v199, 1.0, v199
  v_mfma_f32_16x16x32_bf16 v[44:47], a[28:31], a[108:111], v[44:47]
  v_rcp_f32 v196, v196
  v_mfma_f32_16x16x32_bf16 v[48:51], a[32:35], a[84:87], v[48:51]
  buffer_load_dwordx4 a[204:207], v113, s[24:27], s30 offen offset:0 sc1
  v_mfma_f32_16x16x32_bf16 v[48:51], a[52:55], a[88:91], v[48:51]
  v_rcp_f32 v197, v197
  v_mfma_f32_16x16x32_bf16 v[52:55], a[52:55], a[96:99], v[52:55]
  v_rcp_f32 v198, v198
  v_mfma_f32_16x16x32_bf16 v[52:55], a[32:35], a[92:95], v[52:55]
  v_rcp_f32 v199, v199
  v_mfma_f32_16x16x32_bf16 v[56:59], a[32:35], a[100:103], v[56:59]
  buffer_load_dwordx4 a[208:211], v113, s[24:27], s30 offen offset:1024 sc1
  v_mfma_f32_16x16x32_bf16 v[56:59], a[52:55], a[104:107], v[56:59]
  v_mul_f32 v102, v102, v196
  v_mul_f32 v103, v103, v197
  v_mfma_f32_16x16x32_bf16 v[60:63], a[52:55], a[112:115], v[60:63]
  v_mul_f32 v104, v104, v198
  v_mul_f32 v105, v105, v199
  v_mfma_f32_16x16x32_bf16 v[60:63], a[32:35], a[108:111], v[60:63]
  v_cvt_pk_bf16_f32 v102, v102, v102
  v_cvt_pk_bf16_f32 v103, v103, v103
  v_mfma_f32_16x16x32_bf16 v[64:67], a[36:39], a[84:87], v[64:67]
  ds_read_b128 v[244:247], v122 offset:0
  s_add_u32 s30, s30, 8192
  v_cvt_pk_bf16_f32 v104, v104, v104
  v_mfma_f32_16x16x32_bf16 v[64:67], a[56:59], a[88:91], v[64:67]
  buffer_load_dwordx4 v[248:251], v110, s[24:27], s30 offen offset:0 sc1
  v_mfma_f32_16x16x32_bf16 v[68:71], a[56:59], a[96:99], v[68:71]
  v_cvt_pk_bf16_f32 v105, v105, v105
  v_lshlrev_b32 v102, 16, v102
  v_mfma_f32_16x16x32_bf16 v[68:71], a[36:39], a[92:95], v[68:71]
  v_lshlrev_b32 v103, 16, v103
  v_lshlrev_b32 v104, 16, v104
  v_mfma_f32_16x16x32_bf16 v[72:75], a[36:39], a[100:103], v[72:75]
  buffer_load_dwordx4 v[252:255], v110, s[24:27], s30 offen offset:1024 sc1
  v_mfma_f32_16x16x32_bf16 v[72:75], a[56:59], a[104:107], v[72:75]
  v_lshlrev_b32 v105, 16, v105
  v_cvt_pk_bf16_f32 v240, v240, v240
  v_mfma_f32_16x16x32_bf16 v[76:79], a[56:59], a[112:115], v[76:79]
  v_cvt_pk_bf16_f32 v241, v241, v241
  v_cvt_pk_bf16_f32 v242, v242, v242
  v_mfma_f32_16x16x32_bf16 v[76:79], a[36:39], a[108:111], v[76:79]
  v_cvt_pk_bf16_f32 v243, v243, v243
  v_lshlrev_b32 v240, 16, v240
  s_waitcnt vmcnt(10)
  v_mfma_f32_16x16x32_bf16 v[0:3], a[60:63], a[116:119], v[0:3]
  ds_read_b128 v[204:207], v122 offset:1024
  v_lshlrev_b32 v241, 16, v241
  v_mfma_f32_16x16x32_bf16 v[0:3], a[80:83], a[120:123], v[0:3]
  buffer_load_dwordx4 v[208:211], v111, s[24:27], s30 offen offset:0 sc1
  v_mfma_f32_16x16x32_bf16 v[4:7], a[80:83], a[160:163], v[4:7]
  v_lshlrev_b32 v242, 16, v242
  v_lshlrev_b32 v243, 16, v243
  v_mfma_f32_16x16x32_bf16 v[4:7], a[60:63], a[124:127], v[4:7]
  v_mul_f32 v240, v240, v124
  v_mul_f32 v241, v241, v124
  v_mfma_f32_16x16x32_bf16 v[8:11], a[60:63], a[164:167], v[8:11]
  buffer_load_dwordx4 v[212:215], v111, s[24:27], s30 offen offset:1024 sc1
  v_mfma_f32_16x16x32_bf16 v[8:11], a[80:83], a[168:171], v[8:11]
  v_mul_f32 v242, v242, v124
  v_mul_f32 v243, v243, v124
  v_mfma_f32_16x16x32_bf16 v[12:15], a[80:83], a[176:179], v[12:15]
  v_cvt_pk_bf16_f32 v240, v240, v240
  v_cvt_pk_bf16_f32 v241, v241, v241
  v_mfma_f32_16x16x32_bf16 v[12:15], a[60:63], a[172:175], v[12:15]
  v_cvt_pk_bf16_f32 v242, v242, v242
  v_cvt_pk_bf16_f32 v243, v243, v243
  s_waitcnt lgkmcnt(1)
  v_mfma_f32_16x16x32_bf16 v[16:19], a[64:67], a[116:119], v[16:19]
  ds_read_b128 v[216:219], v122 offset:2048
  v_lshlrev_b32 v240, 16, v240
  v_mfma_f32_16x16x32_bf16 v[16:19], v[244:247], a[120:123], v[16:19]
  buffer_load_dwordx4 v[220:223], v112, s[24:27], s30 offen offset:0 sc1
  v_mfma_f32_16x16x32_bf16 v[20:23], v[244:247], a[160:163], v[20:23]
  v_lshlrev_b32 v241, 16, v241
  v_lshlrev_b32 v242, 16, v242
  v_mfma_f32_16x16x32_bf16 v[20:23], a[64:67], a[124:127], v[20:23]
  v_lshlrev_b32 v243, 16, v243
  v_add_f32 v106, v106, v240
  v_mfma_f32_16x16x32_bf16 v[24:27], a[64:67], a[164:167], v[24:27]
  buffer_load_dwordx4 a[84:87], v112, s[24:27], s30 offen offset:1024 sc1
  v_mfma_f32_16x16x32_bf16 v[24:27], v[244:247], a[168:171], v[24:27]
  v_add_f32 v107, v107, v241
  v_add_f32 v108, v108, v242
  v_mfma_f32_16x16x32_bf16 v[28:31], v[244:247], a[176:179], v[28:31]
  v_add_f32 v109, v109, v243
  v_cvt_pk_bf16_f32 v106, v106, v106
  v_mfma_f32_16x16x32_bf16 v[28:31], a[64:67], a[172:175], v[28:31]
  v_cvt_pk_bf16_f32 v107, v107, v107
  v_cvt_pk_bf16_f32 v108, v108, v108
  s_waitcnt lgkmcnt(1)
  v_mfma_f32_16x16x32_bf16 v[32:35], a[68:71], a[116:119], v[32:35]
  ds_read_b128 a[88:91], v122 offset:3072
  v_cvt_pk_bf16_f32 v109, v109, v109
  v_mfma_f32_16x16x32_bf16 v[32:35], v[204:207], a[120:123], v[32:35]
  buffer_load_dwordx4 a[92:95], v113, s[24:27], s30 offen offset:0 sc1
  v_mfma_f32_16x16x32_bf16 v[36:39], v[204:207], a[160:163], v[36:39]
  v_lshlrev_b32 v106, 16, v106
  v_lshlrev_b32 v107, 16, v107
  v_mfma_f32_16x16x32_bf16 v[36:39], a[68:71], a[124:127], v[36:39]
  v_lshlrev_b32 v108, 16, v108
  v_lshlrev_b32 v109, 16, v109
  v_mfma_f32_16x16x32_bf16 v[40:43], a[68:71], a[164:167], v[40:43]
  buffer_load_dwordx4 a[96:99], v113, s[24:27], s30 offen offset:1024 sc1
  v_mfma_f32_16x16x32_bf16 v[40:43], v[204:207], a[168:171], v[40:43]
  v_mul_f32 v196, 0xbfb8aa3b, v106
  v_mul_f32 v197, 0xbfb8aa3b, v107
  v_mfma_f32_16x16x32_bf16 v[44:47], v[204:207], a[176:179], v[44:47]
  v_mul_f32 v198, 0xbfb8aa3b, v108
  v_mul_f32 v199, 0xbfb8aa3b, v109
  v_mfma_f32_16x16x32_bf16 v[44:47], a[68:71], a[172:175], v[44:47]
  v_exp_f32 v196, v196
  s_waitcnt lgkmcnt(1)
  v_mfma_f32_16x16x32_bf16 v[48:51], a[72:75], a[116:119], v[48:51]
  ds_read_b128 a[100:103], v122 offset:16384
  ds_read_b128 a[104:107], v122 offset:33792
  s_mov_b32 s30, s37
  v_mfma_f32_16x16x32_bf16 v[48:51], v[216:219], a[120:123], v[48:51]
  buffer_load_dwordx4 a[108:111], v110, s[24:27], s30 offen offset:0 sc1
  v_mfma_f32_16x16x32_bf16 v[52:55], v[216:219], a[160:163], v[52:55]
  v_exp_f32 v197, v197
  v_mfma_f32_16x16x32_bf16 v[52:55], a[72:75], a[124:127], v[52:55]
  v_exp_f32 v198, v198
  v_mfma_f32_16x16x32_bf16 v[56:59], a[72:75], a[164:167], v[56:59]
  buffer_load_dwordx4 a[112:115], v110, s[24:27], s30 offen offset:1024 sc1
  v_mfma_f32_16x16x32_bf16 v[56:59], v[216:219], a[168:171], v[56:59]
  v_exp_f32 v199, v199
  v_mfma_f32_16x16x32_bf16 v[60:63], v[216:219], a[176:179], v[60:63]
  v_add_f32 v196, 1.0, v196
  v_add_f32 v197, 1.0, v197
  v_mfma_f32_16x16x32_bf16 v[60:63], a[72:75], a[172:175], v[60:63]
  v_add_f32 v198, 1.0, v198
  v_add_f32 v199, 1.0, v199
  s_waitcnt lgkmcnt(2)
  v_mfma_f32_16x16x32_bf16 v[64:67], a[76:79], a[116:119], v[64:67]
  ds_read_b128 v[244:247], v122 offset:17408
  ds_read_b128 v[204:207], v122 offset:34816
  v_mfma_f32_16x16x32_bf16 v[64:67], a[88:91], a[120:123], v[64:67]
  v_rcp_f32 v196, v196
  v_mfma_f32_16x16x32_bf16 v[68:71], a[88:91], a[160:163], v[68:71]
  v_rcp_f32 v197, v197
  v_mfma_f32_16x16x32_bf16 v[68:71], a[76:79], a[124:127], v[68:71]
  v_rcp_f32 v198, v198
  v_mfma_f32_16x16x32_bf16 v[72:75], a[76:79], a[164:167], v[72:75]
  v_rcp_f32 v199, v199
  v_mfma_f32_16x16x32_bf16 v[72:75], a[88:91], a[168:171], v[72:75]
  v_mul_f32 v106, v106, v196
  v_mul_f32 v107, v107, v197
  v_mfma_f32_16x16x32_bf16 v[76:79], a[88:91], a[176:179], v[76:79]
  v_mul_f32 v108, v108, v198
  v_mul_f32 v109, v109, v199
  v_mfma_f32_16x16x32_bf16 v[76:79], a[76:79], a[172:175], v[76:79]
  v_cvt_pk_bf16_f32 v106, v106, v106
  v_cvt_pk_bf16_f32 v107, v107, v107
  s_waitcnt vmcnt(10) lgkmcnt(2)
  v_mfma_f32_16x16x32_bf16 v[0:3], a[100:103], a[180:183], v[0:3]
  ds_read_b128 v[216:219], v122 offset:18432
  ds_read_b128 a[88:91], v122 offset:35840
  v_mfma_f32_16x16x32_bf16 v[0:3], a[104:107], a[184:187], v[0:3]
  buffer_load_dwordx4 a[116:119], v111, s[24:27], s30 offen offset:0 sc1
  v_mfma_f32_16x16x32_bf16 v[4:7], a[104:107], a[192:195], v[4:7]
  v_cvt_pk_bf16_f32 v108, v108, v108
  v_cvt_pk_bf16_f32 v109, v109, v109
  v_mfma_f32_16x16x32_bf16 v[4:7], a[100:103], a[188:191], v[4:7]
  v_lshlrev_b32 v106, 16, v106
  v_lshlrev_b32 v107, 16, v107
  v_mfma_f32_16x16x32_bf16 v[8:11], a[100:103], a[196:199], v[8:11]
  buffer_load_dwordx4 a[120:123], v111, s[24:27], s30 offen offset:1024 sc1
  v_mfma_f32_16x16x32_bf16 v[8:11], a[104:107], a[200:203], v[8:11]
  v_lshlrev_b32 v108, 16, v108
  v_lshlrev_b32 v109, 16, v109
  v_mfma_f32_16x16x32_bf16 v[12:15], a[104:107], a[208:211], v[12:15]
  v_lshlrev_b32 v224, 16, v80
  v_and_b32 v225, s34, v80
  v_mfma_f32_16x16x32_bf16 v[12:15], a[100:103], a[204:207], v[12:15]
  v_lshlrev_b32 v226, 16, v81
  v_and_b32 v227, s34, v81
  s_waitcnt lgkmcnt(2)
  v_mfma_f32_16x16x32_bf16 v[16:19], v[244:247], a[180:183], v[16:19]
  ds_read_b128 a[124:127], v122 offset:19456
  ds_read_b128 a[160:163], v202 offset:0
  v_mfma_f32_16x16x32_bf16 v[16:19], v[204:207], a[184:187], v[16:19]
  buffer_load_dwordx4 a[164:167], v112, s[24:27], s30 offen offset:0 sc1
  v_mfma_f32_16x16x32_bf16 v[20:23], v[204:207], a[192:195], v[20:23]
  v_lshlrev_b32 v228, 16, v82
  v_and_b32 v229, s34, v82
  v_mfma_f32_16x16x32_bf16 v[20:23], v[244:247], a[188:191], v[20:23]
  v_lshlrev_b32 v230, 16, v83
  v_and_b32 v231, s34, v83
  v_mfma_f32_16x16x32_bf16 v[24:27], v[244:247], a[196:199], v[24:27]
  buffer_load_dwordx4 a[168:171], v112, s[24:27], s30 offen offset:1024 sc1
  v_mfma_f32_16x16x32_bf16 v[24:27], v[204:207], a[200:203], v[24:27]
  v_lshlrev_b32 v232, 16, v84
  v_and_b32 v233, s34, v84
  v_mfma_f32_16x16x32_bf16 v[28:31], v[204:207], a[208:211], v[28:31]
  v_lshlrev_b32 v234, 16, v85
  v_and_b32 v235, s34, v85
  v_mfma_f32_16x16x32_bf16 v[28:31], v[244:247], a[204:207], v[28:31]
  v_lshlrev_b32 v236, 16, v86
  v_and_b32 v237, s34, v86
  s_waitcnt lgkmcnt(2)
  v_mfma_f32_16x16x32_bf16 v[32:35], v[216:219], a[180:183], v[32:35]
  ds_read_b128 a[172:175], v122 offset:32768
  ds_read_b128 a[176:179], v202 offset:1024
  v_mfma_f32_16x16x32_bf16 v[32:35], a[88:91], a[184:187], v[32:35]
  buffer_load_dwordx4 a[100:103], v113, s[24:27], s30 offen offset:0 sc1
  v_mfma_f32_16x16x32_bf16 v[36:39], a[88:91], a[192:195], v[36:39]
  v_lshlrev_b32 v238, 16, v87
  v_and_b32 v239, s34, v87
  v_mfma_f32_16x16x32_bf16 v[36:39], v[216:219], a[188:191], v[36:39]
  v_lshlrev_b32 v240, 16, v88
  v_and_b32 v241, s34, v88
  v_mfma_f32_16x16x32_bf16 v[40:43], v[216:219], a[196:199], v[40:43]
  buffer_load_dwordx4 a[104:107], v113, s[24:27], s30 offen offset:1024 sc1
  v_mfma_f32_16x16x32_bf16 v[40:43], a[88:91], a[200:203], v[40:43]
  v_lshlrev_b32 v242, 16, v89
  v_and_b32 v243, s34, v89
  v_mfma_f32_16x16x32_bf16 v[44:47], a[88:91], a[208:211], v[44:47]
  s_sub_u32 s41, s3, 1
  s_and_b32 s41, s41, 3
  s_lshl_b32 s41, s41, 12
  v_add_u32 v80, s41, v114
  v_mfma_f32_16x16x32_bf16 v[44:47], v[216:219], a[204:207], v[44:47]
  s_sub_u32 s41, s3, 2
  s_and_b32 s41, s41, 3
  s_lshl_b32 s41, s41, 12
  v_add_u32 v81, s41, v114
  s_waitcnt lgkmcnt(2)
  v_mfma_f32_16x16x32_bf16 v[48:51], a[124:127], a[180:183], v[48:51]
  ds_read_b128 v[244:247], v202 offset:2048
  ds_read_b128 v[204:207], v202 offset:19456
  s_add_u32 s30, s30, 8192
  v_mfma_f32_16x16x32_bf16 v[48:51], a[160:163], a[184:187], v[48:51]
  s_sub_u32 s41, s3, 3
  s_and_b32 s41, s41, 3
  s_lshl_b32 s41, s41, 12
  v_add_u32 v82, s41, v114
  v_bfe_u32 v196, v114, 8, 1
  v_mfma_f32_16x16x32_bf16 v[52:55], a[160:163], a[192:195], v[52:55]
  v_mul_u32_u24 v196, 24, v196
  v_add_u32 v83, v117, v196
  v_mfma_f32_16x16x32_bf16 v[52:55], a[124:127], a[188:191], v[52:55]
  v_mfma_f32_16x16x32_bf16 v[56:59], a[124:127], a[196:199], v[56:59]
  v_mfma_f32_16x16x32_bf16 v[56:59], a[160:163], a[200:203], v[56:59]
  v_mfma_f32_16x16x32_bf16 v[60:63], a[160:163], a[208:211], v[60:63]
  v_mfma_f32_16x16x32_bf16 v[60:63], a[124:127], a[204:207], v[60:63]
  s_waitcnt lgkmcnt(2)
  v_mfma_f32_16x16x32_bf16 v[64:67], a[172:175], a[180:183], v[64:67]
  ds_read_b128 v[216:219], v202 offset:3072
  ds_read_b128 a[88:91], v122 offset:49152
  v_mfma_f32_16x16x32_bf16 v[64:67], a[176:179], a[184:187], v[64:67]
  v_mfma_f32_16x16x32_bf16 v[68:71], a[176:179], a[192:195], v[68:71]
  v_mfma_f32_16x16x32_bf16 v[68:71], a[172:175], a[188:191], v[68:71]
  v_mfma_f32_16x16x32_bf16 v[72:75], a[172:175], a[196:199], v[72:75]
  v_mfma_f32_16x16x32_bf16 v[72:75], a[176:179], a[200:203], v[72:75]
  v_mfma_f32_16x16x32_bf16 v[76:79], a[176:179], a[208:211], v[76:79]
  v_mfma_f32_16x16x32_bf16 v[76:79], a[172:175], a[204:207], v[76:79]
  s_waitcnt vmcnt(8) lgkmcnt(2)
  v_mfma_f32_16x16x32_bf16 v[0:3], v[244:247], v[248:251], v[0:3]
  ds_read_b128 a[124:127], v202 offset:16384
  ds_read_b128 a[160:163], v122 offset:50176
  s_xor_b32 s38, s40, 1
  v_mfma_f32_16x16x32_bf16 v[0:3], v[204:207], v[252:255], v[0:3]
  buffer_load_dwordx4 a[172:175], v110, s[24:27], s30 offen offset:0 sc1
  s_lshl_b32 s38, s38, 2
  s_add_u32 s38, s38, s3
  s_lshl_b32 s38, s38, 12
  v_mfma_f32_16x16x32_bf16 v[4:7], v[204:207], v[212:215], v[4:7]
  s_add_u32 s38, s38, 25165824
  v_lshrrev_b32 v192, 1, v114
  v_mfma_f32_16x16x32_bf16 v[4:7], v[244:247], v[208:211], v[4:7]
  v_mfma_f32_16x16x32_bf16 v[8:11], v[244:247], v[220:223], v[8:11]
  buffer_load_dwordx4 a[176:179], v110, s[24:27], s30 offen offset:1024 sc1
  v_mfma_f32_16x16x32_bf16 v[8:11], v[204:207], a[84:87], v[8:11]
  v_mfma_f32_16x16x32_bf16 v[12:15], v[204:207], a[96:99], v[12:15]
  v_mfma_f32_16x16x32_bf16 v[12:15], v[244:247], a[92:95], v[12:15]
  s_waitcnt lgkmcnt(2)
  v_mfma_f32_16x16x32_bf16 v[16:19], v[216:219], v[248:251], v[16:19]
  ds_read_b128 a[180:183], v202 offset:17408
  ds_read_b128 a[184:187], v122 offset:51200
  v_mfma_f32_16x16x32_bf16 v[16:19], a[88:91], v[252:255], v[16:19]
  buffer_load_dwordx4 a[188:191], v111, s[24:27], s30 offen offset:0 sc1
  v_mfma_f32_16x16x32_bf16 v[20:23], a[88:91], v[212:215], v[20:23]
  ds_write_b128 v118, v[4:7] offset:0
  ds_write_b128 v118, v[8:11] offset:5120
  v_mfma_f32_16x16x32_bf16 v[20:23], v[216:219], v[208:211], v[20:23]
  ds_write_b128 v118, v[12:15] offset:10240
  v_mfma_f32_16x16x32_bf16 v[24:27], v[216:219], v[220:223], v[24:27]
  buffer_load_dwordx4 a[192:195], v111, s[24:27], s30 offen offset:1024 sc1
  v_mfma_f32_16x16x32_bf16 v[24:27], a[88:91], a[84:87], v[24:27]
  v_mfma_f32_16x16x32_bf16 v[28:31], a[88:91], a[96:99], v[28:31]
  v_mfma_f32_16x16x32_bf16 v[28:31], v[216:219], a[92:95], v[28:31]
  s_waitcnt lgkmcnt(5)
  v_mfma_f32_16x16x32_bf16 v[32:35], a[124:127], v[248:251], v[32:35]
  ds_read_b128 a[196:199], v202 offset:18432
  ds_read_b128 a[200:203], v122 offset:52224
  v_mfma_f32_16x16x32_bf16 v[32:35], a[160:163], v[252:255], v[32:35]
  buffer_load_dwordx4 a[204:207], v112, s[24:27], s30 offen offset:0 sc1
  v_mfma_f32_16x16x32_bf16 v[36:39], a[160:163], v[212:215], v[36:39]
  ds_write_b128 v118, v[20:23] offset:1024
  ds_write_b128 v118, v[24:27] offset:6144
  v_mfma_f32_16x16x32_bf16 v[36:39], a[124:127], v[208:211], v[36:39]
  ds_write_b128 v118, v[28:31] offset:11264
  v_mfma_f32_16x16x32_bf16 v[40:43], a[124:127], v[220:223], v[40:43]
  buffer_load_dwordx4 a[208:211], v112, s[24:27], s30 offen offset:1024 sc1
  v_mfma_f32_16x16x32_bf16 v[40:43], a[160:163], a[84:87], v[40:43]
  v_mfma_f32_16x16x32_bf16 v[44:47], a[160:163], a[96:99], v[44:47]
  v_mfma_f32_16x16x32_bf16 v[44:47], a[124:127], a[92:95], v[44:47]
  s_waitcnt lgkmcnt(8)
  v_mfma_f32_16x16x32_bf16 v[48:51], a[180:183], v[248:251], v[48:51]
  buffer_load_dwordx4 v[244:247], v113, s[24:27], s30 offen offset:0 sc1
  v_mfma_f32_16x16x32_bf16 v[48:51], a[184:187], v[252:255], v[48:51]
  ds_write_b128 v118, v[36:39] offset:2048
  v_mfma_f32_16x16x32_bf16 v[52:55], a[184:187], v[212:215], v[52:55]
  ds_write_b128 v118, v[40:43] offset:7168
  v_mfma_f32_16x16x32_bf16 v[52:55], a[180:183], v[208:211], v[52:55]
  ds_write_b128 v118, v[44:47] offset:12288
  v_mfma_f32_16x16x32_bf16 v[56:59], a[180:183], v[220:223], v[56:59]
  buffer_load_dwordx4 v[204:207], v113, s[24:27], s30 offen offset:1024 sc1
  v_mfma_f32_16x16x32_bf16 v[56:59], a[184:187], a[84:87], v[56:59]
  v_mfma_f32_16x16x32_bf16 v[60:63], a[184:187], a[96:99], v[60:63]
  v_mfma_f32_16x16x32_bf16 v[60:63], a[180:183], a[92:95], v[60:63]
  s_waitcnt lgkmcnt(6)
  v_mfma_f32_16x16x32_bf16 v[64:67], a[196:199], v[248:251], v[64:67]
  s_add_u32 s30, s30, 8192
  buffer_load_dwordx4 v[216:219], v110, s[24:27], s30 offen offset:0 sc1
  v_mfma_f32_16x16x32_bf16 v[64:67], a[200:203], v[252:255], v[64:67]
  ds_write_b128 v118, v[52:55] offset:3072
  ds_write_b128 v118, v[56:59] offset:8192
  v_mfma_f32_16x16x32_bf16 v[68:71], a[200:203], v[212:215], v[68:71]
  ds_write_b128 v118, v[60:63] offset:13312
  v_mfma_f32_16x16x32_bf16 v[68:71], a[196:199], v[208:211], v[68:71]
  v_mfma_f32_16x16x32_bf16 v[72:75], a[196:199], v[220:223], v[72:75]
  buffer_load_dwordx4 a[88:91], v110, s[24:27], s30 offen offset:1024 sc1
  v_mfma_f32_16x16x32_bf16 v[72:75], a[200:203], a[84:87], v[72:75]
  v_mfma_f32_16x16x32_bf16 v[76:79], a[200:203], a[96:99], v[76:79]
  v_mfma_f32_16x16x32_bf16 v[76:79], a[196:199], a[92:95], v[76:79]
  s_nop 2
  ds_write_b128 v118, v[68:71] offset:4096
  s_nop 1
  ds_write_b128 v118, v[72:75] offset:9216
  s_nop 0
  ds_write_b128 v118, v[76:79] offset:14336
  buffer_load_dwordx4 a[124:127], v111, s[24:27], s30 offen offset:0 sc1
  buffer_load_dwordx4 a[160:163], v111, s[24:27], s30 offen offset:1024 sc1
  buffer_load_dwordx4 a[180:183], v112, s[24:27], s30 offen offset:0 sc1
  buffer_load_dwordx4 a[184:187], v112, s[24:27], s30 offen offset:1024 sc1
  buffer_load_dwordx4 a[196:199], v113, s[24:27], s30 offen offset:0 sc1
  buffer_load_dwordx4 a[200:203], v113, s[24:27], s30 offen offset:1024 sc1
  s_add_u32 s30, s30, 8192
  buffer_load_dwordx4 v[248:251], v110, s[24:27], s30 offen offset:0 sc1
  buffer_load_dwordx4 v[252:255], v110, s[24:27], s30 offen offset:1024 sc1
  buffer_load_dwordx4 v[208:211], v111, s[24:27], s30 offen offset:0 sc1
  buffer_load_dwordx4 v[212:215], v111, s[24:27], s30 offen offset:1024 sc1
  buffer_load_dwordx4 v[220:223], v112, s[24:27], s30 offen offset:0 sc1
  buffer_load_dwordx4 a[84:87], v112, s[24:27], s30 offen offset:1024 sc1
  buffer_load_dwordx4 a[92:95], v113, s[24:27], s30 offen offset:0 sc1
  buffer_load_dwordx4 a[96:99], v113, s[24:27], s30 offen offset:1024 sc1
  s_waitcnt lgkmcnt(0)
  s_barrier
  ds_read_b128 v[4:7], v119 offset:0
  ds_read_b128 v[8:11], v120 offset:5120
  ds_read_b128 v[12:15], v121 offset:10240
  ds_read_b128 v[20:23], v119 offset:1024
  ds_read_b128 v[24:27], v120 offset:6144
  ds_read_b128 v[28:31], v121 offset:11264
  ds_read_b128 v[36:39], v119 offset:2048
  ds_read_b128 v[40:43], v120 offset:7168
  ds_read_b128 v[44:47], v121 offset:12288
  ds_read_b128 v[52:55], v119 offset:3072
  ds_read_b128 v[56:59], v120 offset:8192
  ds_read_b128 v[60:63], v121 offset:13312
  ds_read_b128 v[68:71], v119 offset:4096
  ds_read_b128 v[72:75], v120 offset:9216
  ds_read_b128 v[76:79], v121 offset:14336
  s_waitcnt lgkmcnt(12)
  v_add_f32 v4, v4, v8
  v_add_f32 v5, v5, v9
  v_add_f32 v6, v6, v10
  v_add_f32 v7, v7, v11
  v_add_f32 v0, v0, v12
  v_add_f32 v1, v1, v13
  v_add_f32 v2, v2, v14
  v_add_f32 v3, v3, v15
  v_add_f32 v0, v0, v4
  v_add_f32 v1, v1, v5
  v_add_f32 v2, v2, v6
  v_add_f32 v3, v3, v7
  v_cvt_pk_bf16_f32 v4, v0, v1
  v_cvt_pk_bf16_f32 v5, v2, v3
  buffer_store_dwordx2 v[4:5], v192, s[24:27], s38 offen offset:0 sc1
  s_waitcnt vmcnt(25)
  v_mfma_f32_16x16x32_bf16 v[0:3], a[212:215], a[108:111], 0
  s_add_u32 s30, s30, 8192
  s_waitcnt lgkmcnt(9)
  v_add_f32 v20, v20, v24
  v_add_f32 v21, v21, v25
  v_mfma_f32_16x16x32_bf16 v[0:3], a[232:235], a[112:115], v[0:3]
  v_add_f32 v22, v22, v26
  v_add_f32 v23, v23, v27
  v_mfma_f32_16x16x32_bf16 v[4:7], a[232:235], a[120:123], 0
  v_add_f32 v16, v16, v28
  v_add_f32 v17, v17, v29
  v_mfma_f32_16x16x32_bf16 v[4:7], a[212:215], a[116:119], v[4:7]
  v_add_f32 v18, v18, v30
  v_add_f32 v19, v19, v31
  v_mfma_f32_16x16x32_bf16 v[8:11], a[212:215], a[164:167], 0
  v_add_f32 v16, v16, v20
  v_add_f32 v17, v17, v21
  v_mfma_f32_16x16x32_bf16 v[8:11], a[232:235], a[168:171], v[8:11]
  v_add_f32 v18, v18, v22
  v_add_f32 v19, v19, v23
  v_mfma_f32_16x16x32_bf16 v[12:15], a[232:235], a[104:107], 0
  v_cvt_pk_bf16_f32 v20, v16, v17
  v_cvt_pk_bf16_f32 v21, v18, v19
  v_mfma_f32_16x16x32_bf16 v[12:15], a[212:215], a[100:103], v[12:15]
  buffer_store_dwordx2 v[20:21], v192, s[24:27], s38 offen offset:512 sc1
  s_waitcnt lgkmcnt(6)
  v_mfma_f32_16x16x32_bf16 v[16:19], a[216:219], a[108:111], 0
  buffer_load_dwordx4 a[212:215], v110, s[24:27], s30 offen offset:0 sc1
  v_mfma_f32_16x16x32_bf16 v[16:19], a[236:239], a[112:115], v[16:19]
  v_add_f32 v36, v36, v40
  v_add_f32 v37, v37, v41
  v_mfma_f32_16x16x32_bf16 v[20:23], a[236:239], a[120:123], 0
  v_add_f32 v38, v38, v42
  v_add_f32 v39, v39, v43
  v_mfma_f32_16x16x32_bf16 v[20:23], a[216:219], a[116:119], v[20:23]
  v_add_f32 v32, v32, v44
  v_add_f32 v33, v33, v45
  v_mfma_f32_16x16x32_bf16 v[24:27], a[216:219], a[164:167], 0
  buffer_load_dwordx4 a[232:235], v110, s[24:27], s30 offen offset:1024 sc1
  v_mfma_f32_16x16x32_bf16 v[24:27], a[236:239], a[168:171], v[24:27]
  v_add_f32 v34, v34, v46
  v_add_f32 v35, v35, v47
  v_mfma_f32_16x16x32_bf16 v[28:31], a[236:239], a[104:107], 0
  v_add_f32 v32, v32, v36
  v_add_f32 v33, v33, v37
  v_mfma_f32_16x16x32_bf16 v[28:31], a[216:219], a[100:103], v[28:31]
  v_add_f32 v34, v34, v38
  v_add_f32 v35, v35, v39
  v_cvt_pk_bf16_f32 v36, v32, v33
  v_cvt_pk_bf16_f32 v37, v34, v35
  buffer_store_dwordx2 v[36:37], v192, s[24:27], s38 offen offset:1024 sc1
  v_mfma_f32_16x16x32_bf16 v[32:35], a[220:223], a[108:111], 0
  buffer_load_dwordx4 a[216:219], v111, s[24:27], s30 offen offset:0 sc1
  s_waitcnt lgkmcnt(3)
  v_mfma_f32_16x16x32_bf16 v[32:35], a[240:243], a[112:115], v[32:35]
  v_add_f32 v52, v52, v56
  v_add_f32 v53, v53, v57
  v_mfma_f32_16x16x32_bf16 v[36:39], a[240:243], a[120:123], 0
  v_add_f32 v54, v54, v58
  v_add_f32 v55, v55, v59
  v_mfma_f32_16x16x32_bf16 v[36:39], a[220:223], a[116:119], v[36:39]
  v_add_f32 v48, v48, v60
  v_add_f32 v49, v49, v61
  v_mfma_f32_16x16x32_bf16 v[40:43], a[220:223], a[164:167], 0
  buffer_load_dwordx4 a[236:239], v111, s[24:27], s30 offen offset:1024 sc1
  v_mfma_f32_16x16x32_bf16 v[40:43], a[240:243], a[168:171], v[40:43]
  v_add_f32 v50, v50, v62
  v_add_f32 v51, v51, v63
  v_mfma_f32_16x16x32_bf16 v[44:47], a[240:243], a[104:107], 0
  v_add_f32 v48, v48, v52
  v_add_f32 v49, v49, v53
  v_mfma_f32_16x16x32_bf16 v[44:47], a[220:223], a[100:103], v[44:47]
  v_add_f32 v50, v50, v54
  v_add_f32 v51, v51, v55
  v_cvt_pk_bf16_f32 v52, v48, v49
  v_cvt_pk_bf16_f32 v53, v50, v51
  buffer_store_dwordx2 v[52:53], v192, s[24:27], s38 offen offset:1536 sc1
  v_mfma_f32_16x16x32_bf16 v[48:51], a[224:227], a[108:111], 0
  buffer_load_dwordx4 a[220:223], v112, s[24:27], s30 offen offset:0 sc1
  s_waitcnt lgkmcnt(0)
  v_mfma_f32_16x16x32_bf16 v[48:51], a[244:247], a[112:115], v[48:51]
  v_add_f32 v68, v68, v72
  v_add_f32 v69, v69, v73
  v_mfma_f32_16x16x32_bf16 v[52:55], a[244:247], a[120:123], 0
  v_add_f32 v70, v70, v74
  v_add_f32 v71, v71, v75
  v_mfma_f32_16x16x32_bf16 v[52:55], a[224:227], a[116:119], v[52:55]
  v_add_f32 v64, v64, v76
  v_add_f32 v65, v65, v77
  v_mfma_f32_16x16x32_bf16 v[56:59], a[224:227], a[164:167], 0
  buffer_load_dwordx4 a[240:243], v112, s[24:27], s30 offen offset:1024 sc1
  v_mfma_f32_16x16x32_bf16 v[56:59], a[244:247], a[168:171], v[56:59]
  v_add_f32 v66, v66, v78
  v_add_f32 v67, v67, v79
  v_mfma_f32_16x16x32_bf16 v[60:63], a[244:247], a[104:107], 0
  v_add_f32 v64, v64, v68
  v_add_f32 v65, v65, v69
  v_mfma_f32_16x16x32_bf16 v[60:63], a[224:227], a[100:103], v[60:63]
  v_add_f32 v66, v66, v70
  v_add_f32 v67, v67, v71
  v_cvt_pk_bf16_f32 v68, v64, v65
  v_cvt_pk_bf16_f32 v69, v66, v67
  buffer_store_dwordx2 v[68:69], v192, s[24:27], s38 offen offset:2048 sc1
  v_mfma_f32_16x16x32_bf16 v[64:67], a[228:231], a[108:111], 0
  buffer_load_dwordx4 a[224:227], v113, s[24:27], s30 offen offset:0 sc1
  s_xor_b32 s38, s40, 1
  s_lshl_b32 s38, s38, 7
  s_add_u32 s38, s38, 2834432
  v_mfma_f32_16x16x32_bf16 v[64:67], a[248:251], a[112:115], v[64:67]
  v_mov_b32 v193, 1073741824
  v_writelane_b32 v193, s38, 0
  v_mfma_f32_16x16x32_bf16 v[68:71], a[248:251], a[120:123], 0
  v_mov_b32 v194, 1
  v_mfma_f32_16x16x32_bf16 v[68:71], a[228:231], a[116:119], v[68:71]
  s_xor_b32 s38, s38, 128
  v_mov_b32 v200, s38
  v_mov_b32 v201, 4
  v_mfma_f32_16x16x32_bf16 v[72:75], a[228:231], a[164:167], 0
  buffer_load_dwordx4 a[244:247], v113, s[24:27], s30 offen offset:1024 sc1
  v_mfma_f32_16x16x32_bf16 v[72:75], a[248:251], a[168:171], v[72:75]
  v_mfma_f32_16x16x32_bf16 v[76:79], a[248:251], a[104:107], 0
  v_mfma_f32_16x16x32_bf16 v[76:79], a[228:231], a[100:103], v[76:79]
  s_waitcnt vmcnt(29)
  v_mfma_f32_16x16x32_bf16 v[0:3], a[252:255], a[172:175], v[0:3]
  s_add_u32 s30, s30, 8192
  buffer_load_dwordx4 a[228:231], v110, s[24:27], s30 offen offset:0 sc1
  v_mfma_f32_16x16x32_bf16 v[0:3], a[144:147], a[176:179], v[0:3]
  v_mfma_f32_16x16x32_bf16 v[4:7], a[144:147], a[192:195], v[4:7]
  v_mfma_f32_16x16x32_bf16 v[4:7], a[252:255], a[188:191], v[4:7]
  v_mfma_f32_16x16x32_bf16 v[8:11], a[252:255], a[204:207], v[8:11]
  buffer_load_dwordx4 a[248:251], v110, s[24:27], s30 offen offset:1024 sc1
  v_mfma_f32_16x16x32_bf16 v[8:11], a[144:147], a[208:211], v[8:11]
  v_mfma_f32_16x16x32_bf16 v[12:15], a[144:147], v[204:207], v[12:15]
  v_mfma_f32_16x16x32_bf16 v[12:15], a[252:255], v[244:247], v[12:15]
  v_mfma_f32_16x16x32_bf16 v[16:19], a[128:131], a[172:175], v[16:19]
  buffer_load_dwordx4 a[108:111], v111, s[24:27], s30 offen offset:0 sc1
  v_mfma_f32_16x16x32_bf16 v[16:19], a[148:151], a[176:179], v[16:19]
  v_mfma_f32_16x16x32_bf16 v[20:23], a[148:151], a[192:195], v[20:23]
  v_mfma_f32_16x16x32_bf16 v[20:23], a[128:131], a[188:191], v[20:23]
  v_mfma_f32_16x16x32_bf16 v[24:27], a[128:131], a[204:207], v[24:27]
  buffer_load_dwordx4 a[112:115], v111, s[24:27], s30 offen offset:1024 sc1
  v_mfma_f32_16x16x32_bf16 v[24:27], a[148:151], a[208:211], v[24:27]
  v_mfma_f32_16x16x32_bf16 v[28:31], a[148:151], v[204:207], v[28:31]
  v_mfma_f32_16x16x32_bf16 v[28:31], a[128:131], v[244:247], v[28:31]
  v_mfma_f32_16x16x32_bf16 v[32:35], a[132:135], a[172:175], v[32:35]
  buffer_load_dwordx4 a[116:119], v112, s[24:27], s30 offen offset:0 sc1
  v_mfma_f32_16x16x32_bf16 v[32:35], a[152:155], a[176:179], v[32:35]
  v_mfma_f32_16x16x32_bf16 v[36:39], a[152:155], a[192:195], v[36:39]
  v_mfma_f32_16x16x32_bf16 v[36:39], a[132:135], a[188:191], v[36:39]
  v_mfma_f32_16x16x32_bf16 v[40:43], a[132:135], a[204:207], v[40:43]
  buffer_load_dwordx4 a[120:123], v112, s[24:27], s30 offen offset:1024 sc1
  v_mfma_f32_16x16x32_bf16 v[40:43], a[152:155], a[208:211], v[40:43]
  v_mfma_f32_16x16x32_bf16 v[44:47], a[152:155], v[204:207], v[44:47]
  v_mfma_f32_16x16x32_bf16 v[44:47], a[132:135], v[244:247], v[44:47]
  v_mfma_f32_16x16x32_bf16 v[48:51], a[136:139], a[172:175], v[48:51]
  buffer_load_dwordx4 a[164:167], v113, s[24:27], s30 offen offset:0 sc1
  v_mfma_f32_16x16x32_bf16 v[48:51], a[156:159], a[176:179], v[48:51]
  v_mfma_f32_16x16x32_bf16 v[52:55], a[156:159], a[192:195], v[52:55]
  v_mfma_f32_16x16x32_bf16 v[52:55], a[136:139], a[188:191], v[52:55]
  v_mfma_f32_16x16x32_bf16 v[56:59], a[136:139], a[204:207], v[56:59]
  buffer_load_dwordx4 a[168:171], v113, s[24:27], s30 offen offset:1024 sc1
  v_mfma_f32_16x16x32_bf16 v[56:59], a[156:159], a[208:211], v[56:59]
  v_mfma_f32_16x16x32_bf16 v[60:63], a[156:159], v[204:207], v[60:63]
  v_mfma_f32_16x16x32_bf16 v[60:63], a[136:139], v[244:247], v[60:63]
  v_mfma_f32_16x16x32_bf16 v[64:67], a[140:143], a[172:175], v[64:67]
  s_add_u32 s30, s30, 8192
  buffer_load_dwordx4 a[100:103], v110, s[24:27], s30 offen offset:0 sc1
  v_mfma_f32_16x16x32_bf16 v[64:67], v[128:131], a[176:179], v[64:67]
  v_mfma_f32_16x16x32_bf16 v[68:71], v[128:131], a[192:195], v[68:71]
  v_mfma_f32_16x16x32_bf16 v[68:71], a[140:143], a[188:191], v[68:71]
  v_mfma_f32_16x16x32_bf16 v[72:75], a[140:143], a[204:207], v[72:75]
  buffer_load_dwordx4 a[104:107], v110, s[24:27], s30 offen offset:1024 sc1
  v_mfma_f32_16x16x32_bf16 v[72:75], v[128:131], a[208:211], v[72:75]
  v_mfma_f32_16x16x32_bf16 v[76:79], v[128:131], v[204:207], v[76:79]
  v_mfma_f32_16x16x32_bf16 v[76:79], a[140:143], v[244:247], v[76:79]
  s_waitcnt vmcnt(31)
  v_mfma_f32_16x16x32_bf16 v[0:3], v[132:135], v[216:219], v[0:3]
  buffer_load_dwordx4 a[252:255], v111, s[24:27], s30 offen offset:0 sc1
  v_mfma_f32_16x16x32_bf16 v[0:3], v[152:155], a[88:91], v[0:3]
  v_mfma_f32_16x16x32_bf16 v[4:7], v[152:155], a[160:163], v[4:7]
  v_mfma_f32_16x16x32_bf16 v[4:7], v[132:135], a[124:127], v[4:7]
  v_mfma_f32_16x16x32_bf16 v[8:11], v[132:135], a[180:183], v[8:11]
  buffer_load_dwordx4 a[144:147], v111, s[24:27], s30 offen offset:1024 sc1
  v_mfma_f32_16x16x32_bf16 v[8:11], v[152:155], a[184:187], v[8:11]
  v_mfma_f32_16x16x32_bf16 v[12:15], v[152:155], a[200:203], v[12:15]
  v_mfma_f32_16x16x32_bf16 v[12:15], v[132:135], a[196:199], v[12:15]
  v_mfma_f32_16x16x32_bf16 v[16:19], v[136:139], v[216:219], v[16:19]
  buffer_load_dwordx4 a[128:131], v112, s[24:27], s30 offen offset:0 sc1
  v_mfma_f32_16x16x32_bf16 v[16:19], v[156:159], a[88:91], v[16:19]
  v_mfma_f32_16x16x32_bf16 v[20:23], v[156:159], a[160:163], v[20:23]
  v_mfma_f32_16x16x32_bf16 v[20:23], v[136:139], a[124:127], v[20:23]
  v_mfma_f32_16x16x32_bf16 v[24:27], v[136:139], a[180:183], v[24:27]
  buffer_load_dwordx4 a[148:151], v112, s[24:27], s30 offen offset:1024 sc1
  v_mfma_f32_16x16x32_bf16 v[24:27], v[156:159], a[184:187], v[24:27]
  v_mfma_f32_16x16x32_bf16 v[28:31], v[156:159], a[200:203], v[28:31]
  v_mfma_f32_16x16x32_bf16 v[28:31], v[136:139], a[196:199], v[28:31]
  v_mfma_f32_16x16x32_bf16 v[32:35], v[140:143], v[216:219], v[32:35]
  buffer_load_dwordx4 a[132:135], v113, s[24:27], s30 offen offset:0 sc1
  v_mfma_f32_16x16x32_bf16 v[32:35], v[160:163], a[88:91], v[32:35]
  v_mfma_f32_16x16x32_bf16 v[36:39], v[160:163], a[160:163], v[36:39]
  v_mfma_f32_16x16x32_bf16 v[36:39], v[140:143], a[124:127], v[36:39]
  v_mfma_f32_16x16x32_bf16 v[40:43], v[140:143], a[180:183], v[40:43]
  buffer_load_dwordx4 a[152:155], v113, s[24:27], s30 offen offset:1024 sc1
  v_mfma_f32_16x16x32_bf16 v[40:43], v[160:163], a[184:187], v[40:43]
  v_mfma_f32_16x16x32_bf16 v[44:47], v[160:163], a[200:203], v[44:47]
  v_mfma_f32_16x16x32_bf16 v[44:47], v[140:143], a[196:199], v[44:47]
  v_mfma_f32_16x16x32_bf16 v[48:51], v[144:147], v[216:219], v[48:51]
  s_add_u32 s30, s30, 8192
  buffer_load_dwordx4 a[136:139], v110, s[24:27], s30 offen offset:0 sc1
  v_mfma_f32_16x16x32_bf16 v[48:51], v[164:167], a[88:91], v[48:51]
  v_mfma_f32_16x16x32_bf16 v[52:55], v[164:167], a[160:163], v[52:55]
  v_mfma_f32_16x16x32_bf16 v[52:55], v[144:147], a[124:127], v[52:55]
  v_mfma_f32_16x16x32_bf16 v[56:59], v[144:147], a[180:183], v[56:59]
  buffer_load_dwordx4 a[156:159], v110, s[24:27], s30 offen offset:1024 sc1
  v_mfma_f32_16x16x32_bf16 v[56:59], v[164:167], a[184:187], v[56:59]
  v_mfma_f32_16x16x32_bf16 v[60:63], v[164:167], a[200:203], v[60:63]
  v_mfma_f32_16x16x32_bf16 v[60:63], v[144:147], a[196:199], v[60:63]
  v_mfma_f32_16x16x32_bf16 v[64:67], v[148:151], v[216:219], v[64:67]
  buffer_load_dwordx4 a[140:143], v111, s[24:27], s30 offen offset:0 sc1
  v_mfma_f32_16x16x32_bf16 v[64:67], v[168:171], a[88:91], v[64:67]
  v_mfma_f32_16x16x32_bf16 v[68:71], v[168:171], a[160:163], v[68:71]
  v_mfma_f32_16x16x32_bf16 v[68:71], v[148:151], a[124:127], v[68:71]
  v_mfma_f32_16x16x32_bf16 v[72:75], v[148:151], a[180:183], v[72:75]
  buffer_load_dwordx4 v[128:131], v111, s[24:27], s30 offen offset:1024 sc1
  v_mfma_f32_16x16x32_bf16 v[72:75], v[168:171], a[184:187], v[72:75]
  v_mfma_f32_16x16x32_bf16 v[76:79], v[168:171], a[200:203], v[76:79]
  v_mfma_f32_16x16x32_bf16 v[76:79], v[148:151], a[196:199], v[76:79]
  s_waitcnt vmcnt(33)
  v_mfma_f32_16x16x32_bf16 v[0:3], v[172:175], v[248:251], v[0:3]
  buffer_load_dwordx4 a[172:175], v112, s[24:27], s30 offen offset:0 sc1
  s_waitcnt vmcnt(23)
  v_mfma_f32_16x16x32_bf16 v[0:3], a[0:3], v[252:255], v[0:3]
  buffer_atomic_add v194, v193, s[24:27], 0 offen
  v_mfma_f32_16x16x32_bf16 v[4:7], a[0:3], v[212:215], v[4:7]
  v_mfma_f32_16x16x32_bf16 v[4:7], v[172:175], v[208:211], v[4:7]
  v_mfma_f32_16x16x32_bf16 v[8:11], v[172:175], v[220:223], v[8:11]
  buffer_load_dwordx4 a[176:179], v112, s[24:27], s30 offen offset:1024 sc1
  v_mfma_f32_16x16x32_bf16 v[8:11], a[0:3], a[84:87], v[8:11]
  v_mfma_f32_16x16x32_bf16 v[12:15], a[0:3], a[96:99], v[12:15]
  v_mfma_f32_16x16x32_bf16 v[12:15], v[172:175], a[92:95], v[12:15]
  v_mfma_f32_16x16x32_bf16 v[16:19], v[176:179], v[248:251], v[16:19]
  buffer_load_dwordx4 a[188:191], v113, s[24:27], s30 offen offset:0 sc1
  v_mfma_f32_16x16x32_bf16 v[16:19], a[4:7], v[252:255], v[16:19]
  v_mfma_f32_16x16x32_bf16 v[20:23], a[4:7], v[212:215], v[20:23]
  v_mfma_f32_16x16x32_bf16 v[20:23], v[176:179], v[208:211], v[20:23]
  v_mfma_f32_16x16x32_bf16 v[24:27], v[176:179], v[220:223], v[24:27]
  buffer_load_dwordx4 a[192:195], v113, s[24:27], s30 offen offset:1024 sc1
  v_mfma_f32_16x16x32_bf16 v[24:27], a[4:7], a[84:87], v[24:27]
  v_mfma_f32_16x16x32_bf16 v[28:31], a[4:7], a[96:99], v[28:31]
  v_mfma_f32_16x16x32_bf16 v[28:31], v[176:179], a[92:95], v[28:31]
  v_mfma_f32_16x16x32_bf16 v[32:35], v[180:183], v[248:251], v[32:35]
  s_add_u32 s30, s30, 8192
  v_mfma_f32_16x16x32_bf16 v[32:35], a[8:11], v[252:255], v[32:35]
  v_mfma_f32_16x16x32_bf16 v[36:39], a[8:11], v[212:215], v[36:39]
  v_mfma_f32_16x16x32_bf16 v[36:39], v[180:183], v[208:211], v[36:39]
  v_mfma_f32_16x16x32_bf16 v[40:43], v[180:183], v[220:223], v[40:43]
  v_mfma_f32_16x16x32_bf16 v[40:43], a[8:11], a[84:87], v[40:43]
  v_mfma_f32_16x16x32_bf16 v[44:47], a[8:11], a[96:99], v[44:47]
  v_mfma_f32_16x16x32_bf16 v[44:47], v[180:183], a[92:95], v[44:47]
  v_mfma_f32_16x16x32_bf16 v[48:51], v[184:187], v[248:251], v[48:51]
  v_mfma_f32_16x16x32_bf16 v[48:51], a[12:15], v[252:255], v[48:51]
  v_mfma_f32_16x16x32_bf16 v[52:55], a[12:15], v[212:215], v[52:55]
  v_mfma_f32_16x16x32_bf16 v[52:55], v[184:187], v[208:211], v[52:55]
  v_mfma_f32_16x16x32_bf16 v[56:59], v[184:187], v[220:223], v[56:59]
  v_mfma_f32_16x16x32_bf16 v[56:59], a[12:15], a[84:87], v[56:59]
  v_mfma_f32_16x16x32_bf16 v[60:63], a[12:15], a[96:99], v[60:63]
  v_mfma_f32_16x16x32_bf16 v[60:63], v[184:187], a[92:95], v[60:63]
  v_mfma_f32_16x16x32_bf16 v[64:67], v[188:191], v[248:251], v[64:67]
  v_mfma_f32_16x16x32_bf16 v[64:67], a[16:19], v[252:255], v[64:67]
  v_mfma_f32_16x16x32_bf16 v[68:71], a[16:19], v[212:215], v[68:71]
  v_mfma_f32_16x16x32_bf16 v[68:71], v[188:191], v[208:211], v[68:71]
  v_mfma_f32_16x16x32_bf16 v[72:75], v[188:191], v[220:223], v[72:75]
  v_mfma_f32_16x16x32_bf16 v[72:75], a[16:19], a[84:87], v[72:75]
  v_mfma_f32_16x16x32_bf16 v[76:79], a[16:19], a[96:99], v[76:79]
  v_mfma_f32_16x16x32_bf16 v[76:79], v[188:191], a[92:95], v[76:79]
  s_waitcnt vmcnt(25)
  v_mfma_f32_16x16x32_bf16 v[0:3], a[20:23], a[212:215], v[0:3]
  v_mfma_f32_16x16x32_bf16 v[0:3], a[40:43], a[232:235], v[0:3]
  v_mfma_f32_16x16x32_bf16 v[4:7], a[40:43], a[236:239], v[4:7]
  v_mfma_f32_16x16x32_bf16 v[4:7], a[20:23], a[216:219], v[4:7]
  v_mfma_f32_16x16x32_bf16 v[8:11], a[20:23], a[220:223], v[8:11]
  v_mfma_f32_16x16x32_bf16 v[8:11], a[40:43], a[240:243], v[8:11]
  v_mfma_f32_16x16x32_bf16 v[12:15], a[40:43], a[244:247], v[12:15]
  v_mfma_f32_16x16x32_bf16 v[12:15], a[20:23], a[224:227], v[12:15]
  v_mfma_f32_16x16x32_bf16 v[16:19], a[24:27], a[212:215], v[16:19]
  v_mfma_f32_16x16x32_bf16 v[16:19], a[44:47], a[232:235], v[16:19]
  v_mfma_f32_16x16x32_bf16 v[20:23], a[44:47], a[236:239], v[20:23]
  v_mfma_f32_16x16x32_bf16 v[20:23], a[24:27], a[216:219], v[20:23]
  v_mfma_f32_16x16x32_bf16 v[24:27], a[24:27], a[220:223], v[24:27]
  v_mfma_f32_16x16x32_bf16 v[24:27], a[44:47], a[240:243], v[24:27]
  v_mfma_f32_16x16x32_bf16 v[28:31], a[44:47], a[244:247], v[28:31]
  v_mfma_f32_16x16x32_bf16 v[28:31], a[24:27], a[224:227], v[28:31]
  v_mfma_f32_16x16x32_bf16 v[32:35], a[28:31], a[212:215], v[32:35]
  v_mfma_f32_16x16x32_bf16 v[32:35], a[48:51], a[232:235], v[32:35]
  v_mfma_f32_16x16x32_bf16 v[36:39], a[48:51], a[236:239], v[36:39]
  v_mfma_f32_16x16x32_bf16 v[36:39], a[28:31], a[216:219], v[36:39]
  v_mfma_f32_16x16x32_bf16 v[40:43], a[28:31], a[220:223], v[40:43]
  v_mfma_f32_16x16x32_bf16 v[40:43], a[48:51], a[240:243], v[40:43]
  v_mfma_f32_16x16x32_bf16 v[44:47], a[48:51], a[244:247], v[44:47]
  v_mfma_f32_16x16x32_bf16 v[44:47], a[28:31], a[224:227], v[44:47]
  v_mfma_f32_16x16x32_bf16 v[48:51], a[32:35], a[212:215], v[48:51]
  v_mfma_f32_16x16x32_bf16 v[48:51], a[52:55], a[232:235], v[48:51]
  v_mfma_f32_16x16x32_bf16 v[52:55], a[52:55], a[236:239], v[52:55]
  v_mfma_f32_16x16x32_bf16 v[52:55], a[32:35], a[216:219], v[52:55]
  v_mfma_f32_16x16x32_bf16 v[56:59], a[32:35], a[220:223], v[56:59]
  v_mfma_f32_16x16x32_bf16 v[56:59], a[52:55], a[240:243], v[56:59]
  v_mfma_f32_16x16x32_bf16 v[60:63], a[52:55], a[244:247], v[60:63]
  v_mfma_f32_16x16x32_bf16 v[60:63], a[32:35], a[224:227], v[60:63]
  v_mfma_f32_16x16x32_bf16 v[64:67], a[36:39], a[212:215], v[64:67]
  ds_read_b128 a[204:207], v122 offset:0
  v_mfma_f32_16x16x32_bf16 v[64:67], a[56:59], a[232:235], v[64:67]
  v_mfma_f32_16x16x32_bf16 v[68:71], a[56:59], a[236:239], v[68:71]
  v_mfma_f32_16x16x32_bf16 v[68:71], a[36:39], a[216:219], v[68:71]
  v_mfma_f32_16x16x32_bf16 v[72:75], a[36:39], a[220:223], v[72:75]
  v_mfma_f32_16x16x32_bf16 v[72:75], a[56:59], a[240:243], v[72:75]
  v_mfma_f32_16x16x32_bf16 v[76:79], a[56:59], a[244:247], v[76:79]
  v_mfma_f32_16x16x32_bf16 v[76:79], a[36:39], a[224:227], v[76:79]
  s_waitcnt vmcnt(17)
  v_mfma_f32_16x16x32_bf16 v[0:3], a[60:63], a[228:231], v[0:3]
  ds_read_b128 a[208:211], v122 offset:1024
  buffer_load_dword v195, v200, s[24:27], 0 offen sc1
  s_xor_b32 s38, s40, 0
  s_lshl_b32 s38, s38, 2
  s_add_u32 s38, s38, s3
  v_mfma_f32_16x16x32_bf16 v[0:3], a[80:83], a[248:251], v[0:3]
  s_lshl_b32 s38, s38, 12
  s_add_u32 s38, s38, 25165824
  v_mfma_f32_16x16x32_bf16 v[4:7], a[80:83], a[112:115], v[4:7]
  v_mfma_f32_16x16x32_bf16 v[4:7], a[60:63], a[108:111], v[4:7]
  v_mfma_f32_16x16x32_bf16 v[8:11], a[60:63], a[116:119], v[8:11]
  v_mfma_f32_16x16x32_bf16 v[8:11], a[80:83], a[120:123], v[8:11]
  v_mfma_f32_16x16x32_bf16 v[12:15], a[80:83], a[168:171], v[12:15]
  v_mfma_f32_16x16x32_bf16 v[12:15], a[60:63], a[164:167], v[12:15]
  s_waitcnt lgkmcnt(1)
  v_mfma_f32_16x16x32_bf16 v[16:19], a[64:67], a[228:231], v[16:19]
  ds_read_b128 v[244:247], v122 offset:2048
  v_mfma_f32_16x16x32_bf16 v[16:19], a[204:207], a[248:251], v[16:19]
  v_mfma_f32_16x16x32_bf16 v[20:23], a[204:207], a[112:115], v[20:23]
  v_mfma_f32_16x16x32_bf16 v[20:23], a[64:67], a[108:111], v[20:23]
  v_mfma_f32_16x16x32_bf16 v[24:27], a[64:67], a[116:119], v[24:27]
  v_mfma_f32_16x16x32_bf16 v[24:27], a[204:207], a[120:123], v[24:27]
  v_mfma_f32_16x16x32_bf16 v[28:31], a[204:207], a[168:171], v[28:31]
  v_mfma_f32_16x16x32_bf16 v[28:31], a[64:67], a[164:167], v[28:31]
  s_waitcnt lgkmcnt(1)
  v_mfma_f32_16x16x32_bf16 v[32:35], a[68:71], a[228:231], v[32:35]
  ds_read_b128 v[132:135], v122 offset:3072
  v_mfma_f32_16x16x32_bf16 v[32:35], a[208:211], a[248:251], v[32:35]
  v_mfma_f32_16x16x32_bf16 v[36:39], a[208:211], a[112:115], v[36:39]
  v_mfma_f32_16x16x32_bf16 v[36:39], a[68:71], a[108:111], v[36:39]
  v_mfma_f32_16x16x32_bf16 v[40:43], a[68:71], a[116:119], v[40:43]
  v_mfma_f32_16x16x32_bf16 v[40:43], a[208:211], a[120:123], v[40:43]
  v_mfma_f32_16x16x32_bf16 v[44:47], a[208:211], a[168:171], v[44:47]
  v_mfma_f32_16x16x32_bf16 v[44:47], a[68:71], a[164:167], v[44:47]
  s_waitcnt lgkmcnt(1)
  v_mfma_f32_16x16x32_bf16 v[48:51], a[72:75], a[228:231], v[48:51]
  ds_read_b128 v[152:155], v122 offset:16384
  ds_read_b128 v[136:139], v122 offset:33792
  v_mfma_f32_16x16x32_bf16 v[48:51], v[244:247], a[248:251], v[48:51]
  v_mfma_f32_16x16x32_bf16 v[52:55], v[244:247], a[112:115], v[52:55]
  v_mfma_f32_16x16x32_bf16 v[52:55], a[72:75], a[108:111], v[52:55]
  v_mfma_f32_16x16x32_bf16 v[56:59], a[72:75], a[116:119], v[56:59]
  v_mfma_f32_16x16x32_bf16 v[56:59], v[244:247], a[120:123], v[56:59]
  v_mfma_f32_16x16x32_bf16 v[60:63], v[244:247], a[168:171], v[60:63]
  v_mfma_f32_16x16x32_bf16 v[60:63], a[72:75], a[164:167], v[60:63]
  s_waitcnt lgkmcnt(2)
  v_mfma_f32_16x16x32_bf16 v[64:67], a[76:79], a[228:231], v[64:67]
  ds_read_b128 v[156:159], v122 offset:17408
  ds_read_b128 v[140:143], v122 offset:34816
  v_mfma_f32_16x16x32_bf16 v[64:67], v[132:135], a[248:251], v[64:67]
  v_mfma_f32_16x16x32_bf16 v[68:71], v[132:135], a[112:115], v[68:71]
  v_mfma_f32_16x16x32_bf16 v[68:71], a[76:79], a[108:111], v[68:71]
  v_mfma_f32_16x16x32_bf16 v[72:75], a[76:79], a[116:119], v[72:75]
  v_mfma_f32_16x16x32_bf16 v[72:75], v[132:135], a[120:123], v[72:75]
  v_mfma_f32_16x16x32_bf16 v[76:79], v[132:135], a[168:171], v[76:79]
  v_mfma_f32_16x16x32_bf16 v[76:79], a[76:79], a[164:167], v[76:79]
  s_waitcnt vmcnt(10) lgkmcnt(2)
  v_mfma_f32_16x16x32_bf16 v[0:3], v[152:155], a[100:103], v[0:3]
  ds_read_b128 v[160:163], v122 offset:18432
  ds_read_b128 v[144:147], v122 offset:35840
  v_mfma_f32_16x16x32_bf16 v[0:3], v[136:139], a[104:107], v[0:3]
  v_mfma_f32_16x16x32_bf16 v[4:7], v[136:139], a[144:147], v[4:7]
  v_mfma_f32_16x16x32_bf16 v[4:7], v[152:155], a[252:255], v[4:7]
  v_mfma_f32_16x16x32_bf16 v[8:11], v[152:155], a[128:131], v[8:11]
  v_mfma_f32_16x16x32_bf16 v[8:11], v[136:139], a[148:151], v[8:11]
  v_mfma_f32_16x16x32_bf16 v[12:15], v[136:139], a[152:155], v[12:15]
  v_mfma_f32_16x16x32_bf16 v[12:15], v[152:155], a[132:135], v[12:15]
  s_waitcnt lgkmcnt(2)
  v_mfma_f32_16x16x32_bf16 v[16:19], v[156:159], a[100:103], v[16:19]
  ds_read_b128 v[164:167], v122 offset:19456
  ds_read_b128 v[148:151], v202 offset:0
  v_mfma_f32_16x16x32_bf16 v[16:19], v[140:143], a[104:107], v[16:19]
  v_mfma_f32_16x16x32_bf16 v[20:23], v[140:143], a[144:147], v[20:23]
  v_mfma_f32_16x16x32_bf16 v[20:23], v[156:159], a[252:255], v[20:23]
  v_mfma_f32_16x16x32_bf16 v[24:27], v[156:159], a[128:131], v[24:27]
  v_mfma_f32_16x16x32_bf16 v[24:27], v[140:143], a[148:151], v[24:27]
  v_mfma_f32_16x16x32_bf16 v[28:31], v[140:143], a[152:155], v[28:31]
  v_mfma_f32_16x16x32_bf16 v[28:31], v[156:159], a[132:135], v[28:31]
  s_waitcnt lgkmcnt(2)
  v_mfma_f32_16x16x32_bf16 v[32:35], v[160:163], a[100:103], v[32:35]
  ds_read_b128 v[168:171], v122 offset:32768
  ds_read_b128 a[88:91], v202 offset:1024
  v_mfma_f32_16x16x32_bf16 v[32:35], v[144:147], a[104:107], v[32:35]
  v_mfma_f32_16x16x32_bf16 v[36:39], v[144:147], a[144:147], v[36:39]
  v_mfma_f32_16x16x32_bf16 v[36:39], v[160:163], a[252:255], v[36:39]
  v_mfma_f32_16x16x32_bf16 v[40:43], v[160:163], a[128:131], v[40:43]
  v_mfma_f32_16x16x32_bf16 v[40:43], v[144:147], a[148:151], v[40:43]
  v_mfma_f32_16x16x32_bf16 v[44:47], v[144:147], a[152:155], v[44:47]
  v_mfma_f32_16x16x32_bf16 v[44:47], v[160:163], a[132:135], v[44:47]
  s_waitcnt lgkmcnt(2)
  v_mfma_f32_16x16x32_bf16 v[48:51], v[164:167], a[100:103], v[48:51]
  ds_read_b128 a[124:127], v202 offset:2048
  ds_read_b128 a[160:163], v202 offset:19456
  v_mfma_f32_16x16x32_bf16 v[48:51], v[148:151], a[104:107], v[48:51]
  v_mfma_f32_16x16x32_bf16 v[52:55], v[148:151], a[144:147], v[52:55]
  v_mfma_f32_16x16x32_bf16 v[52:55], v[164:167], a[252:255], v[52:55]
  v_mfma_f32_16x16x32_bf16 v[56:59], v[164:167], a[128:131], v[56:59]
  v_mfma_f32_16x16x32_bf16 v[56:59], v[148:151], a[148:151], v[56:59]
  v_mfma_f32_16x16x32_bf16 v[60:63], v[148:151], a[152:155], v[60:63]
  v_mfma_f32_16x16x32_bf16 v[60:63], v[164:167], a[132:135], v[60:63]
  s_waitcnt lgkmcnt(2)
  v_mfma_f32_16x16x32_bf16 v[64:67], v[168:171], a[100:103], v[64:67]
  ds_read_b128 a[180:183], v202 offset:3072
  ds_read_b128 a[184:187], v122 offset:49152
  v_mfma_f32_16x16x32_bf16 v[64:67], a[88:91], a[104:107], v[64:67]
  v_mfma_f32_16x16x32_bf16 v[68:71], a[88:91], a[144:147], v[68:71]
  v_mfma_f32_16x16x32_bf16 v[68:71], v[168:171], a[252:255], v[68:71]
  v_mfma_f32_16x16x32_bf16 v[72:75], v[168:171], a[128:131], v[72:75]
  v_mfma_f32_16x16x32_bf16 v[72:75], a[88:91], a[148:151], v[72:75]
  v_mfma_f32_16x16x32_bf16 v[76:79], a[88:91], a[152:155], v[76:79]
  v_mfma_f32_16x16x32_bf16 v[76:79], v[168:171], a[132:135], v[76:79]
  s_waitcnt vmcnt(0)
  v_cmp_lt_u32 vcc, v195, v201
  s_nop 0
  s_cbranch_vccz tail_partner
  s_mov_b32 s35, 32768
tail_spin2:
  s_sleep 2
  buffer_load_dword v195, v200, s[24:27], 0 offen sc1
  s_waitcnt vmcnt(0)
  v_cmp_lt_u32 vcc, v195, v201
  s_nop 0
  s_cbranch_vccz tail_partner
  s_sub_u32 s35, s35, 1
  s_cmp_lg_u32 s35, 0
  s_cbranch_scc1 tail_spin2
tail_partner:
  s_waitcnt lgkmcnt(2)
  v_mfma_f32_16x16x32_bf16 v[0:3], a[124:127], a[136:139], v[0:3]
  ds_read_b128 a[196:199], v202 offset:16384
  ds_read_b128 a[200:203], v122 offset:50176
  v_mfma_f32_16x16x32_bf16 v[0:3], a[160:163], a[156:159], v[0:3]
  buffer_load_dwordx2 v[206:207], v192, s[24:27], s38 offen offset:0 sc1
  v_mfma_f32_16x16x32_bf16 v[4:7], a[160:163], v[128:131], v[4:7]
  buffer_load_dwordx2 v[210:211], v192, s[24:27], s38 offen offset:512 sc1
  v_mfma_f32_16x16x32_bf16 v[4:7], a[124:127], a[140:143], v[4:7]
  buffer_load_dwordx2 v[214:215], v192, s[24:27], s38 offen offset:1024 sc1
  v_mfma_f32_16x16x32_bf16 v[8:11], a[124:127], a[172:175], v[8:11]
  buffer_load_dwordx2 v[218:219], v192, s[24:27], s38 offen offset:1536 sc1
  v_mfma_f32_16x16x32_bf16 v[8:11], a[160:163], a[176:179], v[8:11]
  buffer_load_dwordx2 v[222:223], v192, s[24:27], s38 offen offset:2048 sc1
  v_mfma_f32_16x16x32_bf16 v[12:15], a[160:163], a[192:195], v[12:15]
  v_mfma_f32_16x16x32_bf16 v[12:15], a[124:127], a[188:191], v[12:15]
  s_waitcnt lgkmcnt(2)
  v_mfma_f32_16x16x32_bf16 v[16:19], a[180:183], a[136:139], v[16:19]
  ds_read_b128 v[172:175], v202 offset:17408
  ds_read_b128 a[0:3], v122 offset:51200
  v_mfma_f32_16x16x32_bf16 v[16:19], a[184:187], a[156:159], v[16:19]
  ds_write_b128 v122, v[4:7] offset:0
  ds_write_b128 v122, v[8:11] offset:17408
  v_mfma_f32_16x16x32_bf16 v[20:23], a[184:187], v[128:131], v[20:23]
  ds_write_b128 v122, v[12:15] offset:34816
  v_mfma_f32_16x16x32_bf16 v[20:23], a[180:183], a[140:143], v[20:23]
  v_mfma_f32_16x16x32_bf16 v[24:27], a[180:183], a[172:175], v[24:27]
  v_mfma_f32_16x16x32_bf16 v[24:27], a[184:187], a[176:179], v[24:27]
  v_mfma_f32_16x16x32_bf16 v[28:31], a[184:187], a[192:195], v[28:31]
  v_mfma_f32_16x16x32_bf16 v[28:31], a[180:183], a[188:191], v[28:31]
  s_waitcnt lgkmcnt(5)
  v_mfma_f32_16x16x32_bf16 v[32:35], a[196:199], a[136:139], v[32:35]
  ds_read_b128 v[176:179], v202 offset:18432
  ds_read_b128 a[4:7], v122 offset:52224
  v_mfma_f32_16x16x32_bf16 v[32:35], a[200:203], a[156:159], v[32:35]
  ds_write_b128 v122, v[20:23] offset:1024
  ds_write_b128 v122, v[24:27] offset:18432
  v_mfma_f32_16x16x32_bf16 v[36:39], a[200:203], v[128:131], v[36:39]
  ds_write_b128 v122, v[28:31] offset:35840
  v_mfma_f32_16x16x32_bf16 v[36:39], a[196:199], a[140:143], v[36:39]
  v_mfma_f32_16x16x32_bf16 v[40:43], a[196:199], a[172:175], v[40:43]
  v_mfma_f32_16x16x32_bf16 v[40:43], a[200:203], a[176:179], v[40:43]
  v_mfma_f32_16x16x32_bf16 v[44:47], a[200:203], a[192:195], v[44:47]
  v_mfma_f32_16x16x32_bf16 v[44:47], a[196:199], a[188:191], v[44:47]
  s_waitcnt lgkmcnt(8)
  v_mfma_f32_16x16x32_bf16 v[48:51], v[172:175], a[136:139], v[48:51]
  v_mfma_f32_16x16x32_bf16 v[48:51], a[0:3], a[156:159], v[48:51]
  v_mfma_f32_16x16x32_bf16 v[52:55], a[0:3], v[128:131], v[52:55]
  ds_write_b128 v122, v[36:39] offset:2048
  v_mfma_f32_16x16x32_bf16 v[52:55], v[172:175], a[140:143], v[52:55]
  ds_write_b128 v122, v[40:43] offset:19456
  v_mfma_f32_16x16x32_bf16 v[56:59], v[172:175], a[172:175], v[56:59]
  ds_write_b128 v122, v[44:47] offset:49152
  v_mfma_f32_16x16x32_bf16 v[56:59], a[0:3], a[176:179], v[56:59]
  v_mfma_f32_16x16x32_bf16 v[60:63], a[0:3], a[192:195], v[60:63]
  v_mfma_f32_16x16x32_bf16 v[60:63], v[172:175], a[188:191], v[60:63]
  s_waitcnt lgkmcnt(6)
  v_mfma_f32_16x16x32_bf16 v[64:67], v[176:179], a[136:139], v[64:67]
  ds_write_b128 v122, v[52:55] offset:3072
  v_mfma_f32_16x16x32_bf16 v[64:67], a[4:7], a[156:159], v[64:67]
  v_mfma_f32_16x16x32_bf16 v[68:71], a[4:7], v[128:131], v[68:71]
  v_mfma_f32_16x16x32_bf16 v[68:71], v[176:179], a[140:143], v[68:71]
  ds_write_b128 v122, v[56:59] offset:32768
  v_mfma_f32_16x16x32_bf16 v[72:75], v[176:179], a[172:175], v[72:75]
  ds_write_b128 v122, v[60:63] offset:50176
  v_mfma_f32_16x16x32_bf16 v[72:75], a[4:7], a[176:179], v[72:75]
  v_mfma_f32_16x16x32_bf16 v[76:79], a[4:7], a[192:195], v[76:79]
  v_mfma_f32_16x16x32_bf16 v[76:79], v[176:179], a[188:191], v[76:79]
  s_nop 1
  ds_write_b128 v122, v[68:71] offset:16384
  s_nop 2
  ds_write_b128 v122, v[72:75] offset:33792
  s_nop 0
  ds_write_b128 v122, v[76:79] offset:51200
  s_waitcnt vmcnt(4)
  v_lshlrev_b32 v204, 16, v206
  v_and_b32 v205, s34, v206
  v_lshlrev_b32 v206, 16, v207
  v_and_b32 v207, s34, v207
  v_pk_add_f32 v[0:1], v[0:1], v[204:205]
  v_pk_add_f32 v[2:3], v[2:3], v[206:207]
  s_waitcnt vmcnt(3)
  v_lshlrev_b32 v208, 16, v210
  v_and_b32 v209, s34, v210
  v_lshlrev_b32 v210, 16, v211
  v_and_b32 v211, s34, v211
  v_pk_add_f32 v[16:17], v[16:17], v[208:209]
  v_pk_add_f32 v[18:19], v[18:19], v[210:211]
  s_waitcnt vmcnt(2)
  v_lshlrev_b32 v212, 16, v214
  v_and_b32 v213, s34, v214
  v_lshlrev_b32 v214, 16, v215
  v_and_b32 v215, s34, v215
  v_pk_add_f32 v[32:33], v[32:33], v[212:213]
  v_pk_add_f32 v[34:35], v[34:35], v[214:215]
  s_waitcnt vmcnt(1)
  v_lshlrev_b32 v216, 16, v218
  v_and_b32 v217, s34, v218
  v_lshlrev_b32 v218, 16, v219
  v_and_b32 v219, s34, v219
  v_pk_add_f32 v[48:49], v[48:49], v[216:217]
  v_pk_add_f32 v[50:51], v[50:51], v[218:219]
  s_waitcnt vmcnt(0)
  v_lshlrev_b32 v220, 16, v222
  v_and_b32 v221, s34, v222
  v_lshlrev_b32 v222, 16, v223
  v_and_b32 v223, s34, v223
  v_pk_add_f32 v[64:65], v[64:65], v[220:221]
  v_pk_add_f32 v[66:67], v[66:67], v[222:223]
  s_waitcnt lgkmcnt(0)
  s_barrier
  ds_read_b128 v[4:7], v80 offset:0
  ds_read_b128 v[8:11], v81 offset:17408
  ds_read_b128 v[12:15], v82 offset:34816
  ds_read_b128 v[20:23], v80 offset:1024
  ds_read_b128 v[24:27], v81 offset:18432
  ds_read_b128 v[28:31], v82 offset:35840
  ds_read_b128 v[36:39], v80 offset:2048
  ds_read_b128 v[40:43], v81 offset:19456
  ds_read_b128 v[44:47], v82 offset:49152
  ds_read_b128 v[52:55], v80 offset:3072
  ds_read_b128 v[56:59], v81 offset:32768
  ds_read_b128 v[60:63], v82 offset:50176
  ds_read_b128 v[68:71], v80 offset:16384
  ds_read_b128 v[72:75], v81 offset:33792
  ds_read_b128 v[76:79], v82 offset:51200
  s_waitcnt lgkmcnt(13)
  v_pk_add_f32 v[4:5], v[4:5], v[8:9]
  v_pk_add_f32 v[6:7], v[6:7], v[10:11]
  s_waitcnt lgkmcnt(12)
  v_pk_add_f32 v[0:1], v[0:1], v[12:13]
  v_pk_add_f32 v[2:3], v[2:3], v[14:15]
  v_pk_add_f32 v[0:1], v[0:1], v[4:5]
  v_pk_add_f32 v[2:3], v[2:3], v[6:7]
  v_cvt_pk_bf16_f32 v4, v0, v1
  v_cvt_pk_bf16_f32 v5, v2, v3
  v_lshlrev_b32 v0, 16, v4
  v_and_b32 v1, s34, v4
  v_lshlrev_b32 v2, 16, v5
  v_and_b32 v3, s34, v5
  v_pk_mul_f32 v[0:1], v[0:1], v[90:91]
  v_pk_mul_f32 v[2:3], v[2:3], v[92:93]
  v_cvt_pk_bf16_f32 v4, v0, v1
  v_cvt_pk_bf16_f32 v5, v2, v3
  v_lshlrev_b32 v0, 16, v4
  v_and_b32 v1, s34, v4
  v_lshlrev_b32 v2, 16, v5
  v_and_b32 v3, s34, v5
  v_pk_add_f32 v[0:1], v[0:1], v[224:225]
  v_pk_add_f32 v[2:3], v[2:3], v[226:227]
  v_cvt_pk_bf16_f32 v4, v0, v1
  v_cvt_pk_bf16_f32 v5, v2, v3
  s_waitcnt lgkmcnt(10)
  v_pk_add_f32 v[20:21], v[20:21], v[24:25]
  v_pk_add_f32 v[22:23], v[22:23], v[26:27]
  s_waitcnt lgkmcnt(9)
  v_pk_add_f32 v[16:17], v[16:17], v[28:29]
  v_pk_add_f32 v[18:19], v[18:19], v[30:31]
  v_pk_add_f32 v[16:17], v[16:17], v[20:21]
  v_pk_add_f32 v[18:19], v[18:19], v[22:23]
  v_cvt_pk_bf16_f32 v20, v16, v17
  v_cvt_pk_bf16_f32 v21, v18, v19
  v_lshlrev_b32 v16, 16, v20
  v_and_b32 v17, s34, v20
  v_lshlrev_b32 v18, 16, v21
  v_and_b32 v19, s34, v21
  v_pk_mul_f32 v[16:17], v[16:17], v[94:95]
  v_pk_mul_f32 v[18:19], v[18:19], v[96:97]
  v_cvt_pk_bf16_f32 v20, v16, v17
  v_cvt_pk_bf16_f32 v21, v18, v19
  v_lshlrev_b32 v16, 16, v20
  v_and_b32 v17, s34, v20
  v_lshlrev_b32 v18, 16, v21
  v_and_b32 v19, s34, v21
  v_pk_add_f32 v[16:17], v[16:17], v[228:229]
  v_pk_add_f32 v[18:19], v[18:19], v[230:231]
  v_cvt_pk_bf16_f32 v6, v16, v17
  v_cvt_pk_bf16_f32 v7, v18, v19
  s_nop 0
  v_permlane16_swap_b32 v4, v6
  v_permlane16_swap_b32 v5, v7
  buffer_store_dwordx4 v[4:7], v83, s[16:19], 0 offen offset:0
  s_waitcnt lgkmcnt(7)
  v_pk_add_f32 v[36:37], v[36:37], v[40:41]
  v_pk_add_f32 v[38:39], v[38:39], v[42:43]
  s_waitcnt lgkmcnt(6)
  v_pk_add_f32 v[32:33], v[32:33], v[44:45]
  v_pk_add_f32 v[34:35], v[34:35], v[46:47]
  v_pk_add_f32 v[32:33], v[32:33], v[36:37]
  v_pk_add_f32 v[34:35], v[34:35], v[38:39]
  v_cvt_pk_bf16_f32 v36, v32, v33
  v_cvt_pk_bf16_f32 v37, v34, v35
  v_lshlrev_b32 v32, 16, v36
  v_and_b32 v33, s34, v36
  v_lshlrev_b32 v34, 16, v37
  v_and_b32 v35, s34, v37
  v_pk_mul_f32 v[32:33], v[32:33], v[98:99]
  v_pk_mul_f32 v[34:35], v[34:35], v[100:101]
  v_cvt_pk_bf16_f32 v36, v32, v33
  v_cvt_pk_bf16_f32 v37, v34, v35
  v_lshlrev_b32 v32, 16, v36
  v_and_b32 v33, s34, v36
  v_lshlrev_b32 v34, 16, v37
  v_and_b32 v35, s34, v37
  v_pk_add_f32 v[32:33], v[32:33], v[232:233]
  v_pk_add_f32 v[34:35], v[34:35], v[234:235]
  v_cvt_pk_bf16_f32 v36, v32, v33
  v_cvt_pk_bf16_f32 v37, v34, v35
  s_waitcnt lgkmcnt(4)
  v_pk_add_f32 v[52:53], v[52:53], v[56:57]
  v_pk_add_f32 v[54:55], v[54:55], v[58:59]
  s_waitcnt lgkmcnt(3)
  v_pk_add_f32 v[48:49], v[48:49], v[60:61]
  v_pk_add_f32 v[50:51], v[50:51], v[62:63]
  v_pk_add_f32 v[48:49], v[48:49], v[52:53]
  v_pk_add_f32 v[50:51], v[50:51], v[54:55]
  v_cvt_pk_bf16_f32 v52, v48, v49
  v_cvt_pk_bf16_f32 v53, v50, v51
  v_lshlrev_b32 v48, 16, v52
  v_and_b32 v49, s34, v52
  v_lshlrev_b32 v50, 16, v53
  v_and_b32 v51, s34, v53
  v_pk_mul_f32 v[48:49], v[48:49], v[102:103]
  v_pk_mul_f32 v[50:51], v[50:51], v[104:105]
  v_cvt_pk_bf16_f32 v52, v48, v49
  v_cvt_pk_bf16_f32 v53, v50, v51
  v_lshlrev_b32 v48, 16, v52
  v_and_b32 v49, s34, v52
  v_lshlrev_b32 v50, 16, v53
  v_and_b32 v51, s34, v53
  v_pk_add_f32 v[48:49], v[48:49], v[236:237]
  v_pk_add_f32 v[50:51], v[50:51], v[238:239]
  v_cvt_pk_bf16_f32 v38, v48, v49
  v_cvt_pk_bf16_f32 v39, v50, v51
  s_nop 0
  v_permlane16_swap_b32 v36, v38
  v_permlane16_swap_b32 v37, v39
  buffer_store_dwordx4 v[36:39], v83, s[16:19], 0 offen offset:64
  s_waitcnt lgkmcnt(1)
  v_pk_add_f32 v[68:69], v[68:69], v[72:73]
  v_pk_add_f32 v[70:71], v[70:71], v[74:75]
  s_waitcnt lgkmcnt(0)
  v_pk_add_f32 v[64:65], v[64:65], v[76:77]
  v_pk_add_f32 v[66:67], v[66:67], v[78:79]
  v_pk_add_f32 v[64:65], v[64:65], v[68:69]
  v_pk_add_f32 v[66:67], v[66:67], v[70:71]
  v_cvt_pk_bf16_f32 v68, v64, v65
  v_cvt_pk_bf16_f32 v69, v66, v67
  v_lshlrev_b32 v64, 16, v68
  v_and_b32 v65, s34, v68
  v_lshlrev_b32 v66, 16, v69
  v_and_b32 v67, s34, v69
  v_pk_mul_f32 v[64:65], v[64:65], v[106:107]
  v_pk_mul_f32 v[66:67], v[66:67], v[108:109]
  v_cvt_pk_bf16_f32 v68, v64, v65
  v_cvt_pk_bf16_f32 v69, v66, v67
  v_lshlrev_b32 v64, 16, v68
  v_and_b32 v65, s34, v68
  v_lshlrev_b32 v66, 16, v69
  v_and_b32 v67, s34, v69
  v_pk_add_f32 v[64:65], v[64:65], v[240:241]
  v_pk_add_f32 v[66:67], v[66:67], v[242:243]
  v_cvt_pk_bf16_f32 v68, v64, v65
  v_cvt_pk_bf16_f32 v69, v66, v67
  buffer_store_dwordx2 v[68:69], v117, s[16:19], 0 offen offset:128
attn_end:
  s_endpgm
attn_redo:
  s_load_dwordx2 s[48:49], s[0:1], 24
  s_waitcnt vmcnt(0) lgkmcnt(0)
  s_lshl_b32 s38, s36, 8
  s_add_u32 s20, s48, s38
  s_addc_u32 s21, s49, 0
  s_mov_b32 s22, 5242880
  s_mov_b32 s23, 0x20000
  s_sub_u32 s22, s22, s38
  v_lshrrev_b32 v245, 4, v242
  v_add_u32 v243, 0x1000, v242
  s_mul_i32 s30, s37, 81920
  s_mov_b32 s31, 0
  v_lshrrev_b32 v248, 4, v245
  v_and_b32 v247, 15, v245
  s_lshl_b32 s38, s3, 17
  v_lshlrev_b32 v249, 13, v248
  v_add_u32 v249, s38, v249
  v_or_b32 v250, 0, v248
  v_lshlrev_b32 v250, 1, v250
  v_xor_b32 v250, v250, v247
  v_lshl_add_u32 v238, v250, 4, v249
  v_or_b32 v250, 0, v248
  v_lshlrev_b32 v250, 1, v250
  v_xor_b32 v250, v250, v247
  v_lshl_add_u32 v239, v250, 4, v249
  v_add_u32 v239, 31744, v239
  v_or_b32 v250, 4, v248
  v_lshlrev_b32 v250, 1, v250
  v_xor_b32 v250, v250, v247
  v_lshl_add_u32 v240, v250, 4, v249
  v_add_u32 v240, 63488, v240
  v_or_b32 v250, 4, v248
  v_lshlrev_b32 v250, 1, v250
  v_xor_b32 v250, v250, v247
  v_lshl_add_u32 v241, v250, 4, v249
  v_add_u32 v241, 95232, v241
  v_bfe_u32 v246, v245, 2, 2
  v_and_b32 v247, 3, v245
  v_lshlrev_b32 v247, 3, v247
  v_add_u32 v247, 65536, v247
  v_lshl_add_u32 v249, v248, 3, v246
  v_and_b32 v250, 1, v248
  v_lshl_add_u32 v250, v250, 2, v246
  v_lshl_add_u32 v250, v250, 5, v247
  v_lshl_add_u32 v224, v249, 8, v250
  v_xor_b32 v225, 32, v224
  v_xor_b32 v226, 64, v224
  v_xor_b32 v227, 96, v224
  v_xor_b32 v228, 128, v224
  v_xor_b32 v229, 160, v224
  v_xor_b32 v230, 192, v224
  v_xor_b32 v231, 224, v224
  v_mov_b32 v0, 0
  v_mov_b32 v1, 0
  v_mov_b32 v2, 0
  v_mov_b32 v3, 0
  v_mov_b32 v4, 0
  v_mov_b32 v5, 0
  v_mov_b32 v6, 0
  v_mov_b32 v7, 0
  v_mov_b32 v8, 0
  v_mov_b32 v9, 0
  v_mov_b32 v10, 0
  v_mov_b32 v11, 0
  v_mov_b32 v12, 0
  v_mov_b32 v13, 0
  v_mov_b32 v14, 0
  v_mov_b32 v15, 0
  v_mov_b32 v16, 0
  v_mov_b32 v17, 0
  v_mov_b32 v18, 0
  v_mov_b32 v19, 0
  v_mov_b32 v20, 0
  v_mov_b32 v21, 0
  v_mov_b32 v22, 0
  v_mov_b32 v23, 0
  v_mov_b32 v24, 0
  v_mov_b32 v25, 0
  v_mov_b32 v26, 0
  v_mov_b32 v27, 0
  v_mov_b32 v28, 0
  v_mov_b32 v29, 0
  v_mov_b32 v30, 0
  v_mov_b32 v31, 0
  v_mov_b32 v32, 0
  v_mov_b32 v33, 0
  v_mov_b32 v34, 0
  v_mov_b32 v35, 0
  v_mov_b32 v36, 0
  v_mov_b32 v37, 0
  v_mov_b32 v38, 0
  v_mov_b32 v39, 0
  v_mov_b32 v40, 0
  v_mov_b32 v41, 0
  v_mov_b32 v42, 0
  v_mov_b32 v43, 0
  v_mov_b32 v44, 0
  v_mov_b32 v45, 0
  v_mov_b32 v46, 0
  v_mov_b32 v47, 0
  v_mov_b32 v48, 0
  v_mov_b32 v49, 0
  v_mov_b32 v50, 0
  v_mov_b32 v51, 0
  v_mov_b32 v52, 0
  v_mov_b32 v53, 0
  v_mov_b32 v54, 0
  v_mov_b32 v55, 0
  v_mov_b32 v56, 0
  v_mov_b32 v57, 0
  v_mov_b32 v58, 0
  v_mov_b32 v59, 0
  v_mov_b32 v60, 0
  v_mov_b32 v61, 0
  v_mov_b32 v62, 0
  v_mov_b32 v63, 0
  v_mov_b32 v64, 0
  v_mov_b32 v65, 0
  v_mov_b32 v66, 0
  v_mov_b32 v67, 0
  v_mov_b32 v68, 0
  v_mov_b32 v69, 0
  v_mov_b32 v70, 0
  v_mov_b32 v71, 0
  v_mov_b32 v72, 0
  v_mov_b32 v73, 0
  v_mov_b32 v74, 0
  v_mov_b32 v75, 0
  v_mov_b32 v76, 0
  v_mov_b32 v77, 0
  v_mov_b32 v78, 0
  v_mov_b32 v79, 0
  v_mov_b32 v80, 0
  v_mov_b32 v81, 0
  v_mov_b32 v82, 0
  v_mov_b32 v83, 0
  v_mov_b32 v84, 0
  v_mov_b32 v85, 0
  v_mov_b32 v86, 0
  v_mov_b32 v87, 0
  v_mov_b32 v88, 0
  v_mov_b32 v89, 0
  v_mov_b32 v90, 0
  v_mov_b32 v91, 0
  v_mov_b32 v92, 0
  v_mov_b32 v93, 0
  v_mov_b32 v94, 0
  v_mov_b32 v95, 0
  v_mov_b32 v96, 0
  v_mov_b32 v97, 0
  v_mov_b32 v98, 0
  v_mov_b32 v99, 0
  v_mov_b32 v100, 0
  v_mov_b32 v101, 0
  v_mov_b32 v102, 0
  v_mov_b32 v103, 0
  v_mov_b32 v104, 0
  v_mov_b32 v105, 0
  v_mov_b32 v106, 0
  v_mov_b32 v107, 0
  v_mov_b32 v108, 0
  v_mov_b32 v109, 0
  v_mov_b32 v110, 0
  v_mov_b32 v111, 0
  v_mov_b32 v112, 0
  v_mov_b32 v113, 0
  v_mov_b32 v114, 0
  v_mov_b32 v115, 0
  v_mov_b32 v116, 0
  v_mov_b32 v117, 0
  v_mov_b32 v118, 0
  v_mov_b32 v119, 0
  v_mov_b32 v120, 0
  v_mov_b32 v121, 0
  v_mov_b32 v122, 0
  v_mov_b32 v123, 0
  v_mov_b32 v124, 0
  v_mov_b32 v125, 0
  v_mov_b32 v126, 0
  v_mov_b32 v127, 0
attn_requery:
  s_barrier
  s_add_u32 m0, s28, 114688
  s_nop 0
  buffer_load_dwordx4 v238, s[20:23], s31 offen offset:0 lds
  buffer_load_dwordx4 v239, s[20:23], s31 offen offset:1024 lds
  buffer_load_dwordx4 v240, s[20:23], s31 offen offset:2048 lds
  buffer_load_dwordx4 v241, s[20:23], s31 offen offset:3072 lds
  buffer_load_dwordx4 a[0:3], v242, s[24:27], s30 offen offset:0 sc1
  buffer_load_dwordx4 a[4:7], v242, s[24:27], s30 offen offset:1024 sc1
  buffer_load_dwordx4 a[8:11], v242, s[24:27], s30 offen offset:2048 sc1
  buffer_load_dwordx4 a[12:15], v242, s[24:27], s30 offen offset:3072 sc1
  buffer_load_dwordx4 a[16:19], v243, s[24:27], s30 offen offset:0 sc1
  buffer_load_dwordx4 a[20:23], v243, s[24:27], s30 offen offset:1024 sc1
  buffer_load_dwordx4 a[24:27], v243, s[24:27], s30 offen offset:2048 sc1
  buffer_load_dwordx4 a[28:31], v243, s[24:27], s30 offen offset:3072 sc1
  s_add_u32 s30, s30, 8192
  s_waitcnt vmcnt(0)
  s_barrier
  ds_read_b64_tr_b16 a[160:161], v224 offset:49152
  ds_read_b64_tr_b16 a[162:163], v224 offset:50176
  ds_read_b64_tr_b16 a[164:165], v224 offset:57344
  ds_read_b64_tr_b16 a[166:167], v224 offset:58368
  s_waitcnt lgkmcnt(2)
  v_mfma_f32_16x16x32_bf16 v[0:3], a[160:163], a[0:3], v[0:3]
  s_waitcnt lgkmcnt(0)
  v_mfma_f32_16x16x32_bf16 v[0:3], a[164:167], a[16:19], v[0:3]
  v_mfma_f32_16x16x32_bf16 v[4:7], a[164:167], a[20:23], v[4:7]
  v_mfma_f32_16x16x32_bf16 v[4:7], a[160:163], a[4:7], v[4:7]
  v_mfma_f32_16x16x32_bf16 v[8:11], a[160:163], a[8:11], v[8:11]
  v_mfma_f32_16x16x32_bf16 v[8:11], a[164:167], a[24:27], v[8:11]
  v_mfma_f32_16x16x32_bf16 v[12:15], a[164:167], a[28:31], v[12:15]
  v_mfma_f32_16x16x32_bf16 v[12:15], a[160:163], a[12:15], v[12:15]
  ds_read_b64_tr_b16 a[168:169], v225 offset:49152
  ds_read_b64_tr_b16 a[170:171], v225 offset:50176
  ds_read_b64_tr_b16 a[172:173], v225 offset:57344
  ds_read_b64_tr_b16 a[174:175], v225 offset:58368
  s_waitcnt lgkmcnt(2)
  v_mfma_f32_16x16x32_bf16 v[16:19], a[168:171], a[0:3], v[16:19]
  s_waitcnt lgkmcnt(0)
  v_mfma_f32_16x16x32_bf16 v[16:19], a[172:175], a[16:19], v[16:19]
  v_mfma_f32_16x16x32_bf16 v[20:23], a[172:175], a[20:23], v[20:23]
  v_mfma_f32_16x16x32_bf16 v[20:23], a[168:171], a[4:7], v[20:23]
  v_mfma_f32_16x16x32_bf16 v[24:27], a[168:171], a[8:11], v[24:27]
  v_mfma_f32_16x16x32_bf16 v[24:27], a[172:175], a[24:27], v[24:27]
  v_mfma_f32_16x16x32_bf16 v[28:31], a[172:175], a[28:31], v[28:31]
  v_mfma_f32_16x16x32_bf16 v[28:31], a[168:171], a[12:15], v[28:31]
  ds_read_b64_tr_b16 a[176:177], v226 offset:49152
  ds_read_b64_tr_b16 a[178:179], v226 offset:50176
  ds_read_b64_tr_b16 a[180:181], v226 offset:57344
  ds_read_b64_tr_b16 a[182:183], v226 offset:58368
  s_waitcnt lgkmcnt(2)
  v_mfma_f32_16x16x32_bf16 v[32:35], a[176:179], a[0:3], v[32:35]
  s_waitcnt lgkmcnt(0)
  v_mfma_f32_16x16x32_bf16 v[32:35], a[180:183], a[16:19], v[32:35]
  v_mfma_f32_16x16x32_bf16 v[36:39], a[180:183], a[20:23], v[36:39]
  v_mfma_f32_16x16x32_bf16 v[36:39], a[176:179], a[4:7], v[36:39]
  v_mfma_f32_16x16x32_bf16 v[40:43], a[176:179], a[8:11], v[40:43]
  v_mfma_f32_16x16x32_bf16 v[40:43], a[180:183], a[24:27], v[40:43]
  v_mfma_f32_16x16x32_bf16 v[44:47], a[180:183], a[28:31], v[44:47]
  v_mfma_f32_16x16x32_bf16 v[44:47], a[176:179], a[12:15], v[44:47]
  ds_read_b64_tr_b16 a[184:185], v227 offset:49152
  ds_read_b64_tr_b16 a[186:187], v227 offset:50176
  ds_read_b64_tr_b16 a[188:189], v227 offset:57344
  ds_read_b64_tr_b16 a[190:191], v227 offset:58368
  s_waitcnt lgkmcnt(2)
  v_mfma_f32_16x16x32_bf16 v[48:51], a[184:187], a[0:3], v[48:51]
  s_waitcnt lgkmcnt(0)
  v_mfma_f32_16x16x32_bf16 v[48:51], a[188:191], a[16:19], v[48:51]
  v_mfma_f32_16x16x32_bf16 v[52:55], a[188:191], a[20:23], v[52:55]
  v_mfma_f32_16x16x32_bf16 v[52:55], a[184:187], a[4:7], v[52:55]
  v_mfma_f32_16x16x32_bf16 v[56:59], a[184:187], a[8:11], v[56:59]
  v_mfma_f32_16x16x32_bf16 v[56:59], a[188:191], a[24:27], v[56:59]
  v_mfma_f32_16x16x32_bf16 v[60:63], a[188:191], a[28:31], v[60:63]
  v_mfma_f32_16x16x32_bf16 v[60:63], a[184:187], a[12:15], v[60:63]
  ds_read_b64_tr_b16 a[160:161], v228 offset:49152
  ds_read_b64_tr_b16 a[162:163], v228 offset:50176
  ds_read_b64_tr_b16 a[164:165], v228 offset:57344
  ds_read_b64_tr_b16 a[166:167], v228 offset:58368
  s_waitcnt lgkmcnt(2)
  v_mfma_f32_16x16x32_bf16 v[64:67], a[160:163], a[0:3], v[64:67]
  s_waitcnt lgkmcnt(0)
  v_mfma_f32_16x16x32_bf16 v[64:67], a[164:167], a[16:19], v[64:67]
  v_mfma_f32_16x16x32_bf16 v[68:71], a[164:167], a[20:23], v[68:71]
  v_mfma_f32_16x16x32_bf16 v[68:71], a[160:163], a[4:7], v[68:71]
  v_mfma_f32_16x16x32_bf16 v[72:75], a[160:163], a[8:11], v[72:75]
  v_mfma_f32_16x16x32_bf16 v[72:75], a[164:167], a[24:27], v[72:75]
  v_mfma_f32_16x16x32_bf16 v[76:79], a[164:167], a[28:31], v[76:79]
  v_mfma_f32_16x16x32_bf16 v[76:79], a[160:163], a[12:15], v[76:79]
  ds_read_b64_tr_b16 a[168:169], v229 offset:49152
  ds_read_b64_tr_b16 a[170:171], v229 offset:50176
  ds_read_b64_tr_b16 a[172:173], v229 offset:57344
  ds_read_b64_tr_b16 a[174:175], v229 offset:58368
  s_waitcnt lgkmcnt(2)
  v_mfma_f32_16x16x32_bf16 v[80:83], a[168:171], a[0:3], v[80:83]
  s_waitcnt lgkmcnt(0)
  v_mfma_f32_16x16x32_bf16 v[80:83], a[172:175], a[16:19], v[80:83]
  v_mfma_f32_16x16x32_bf16 v[84:87], a[172:175], a[20:23], v[84:87]
  v_mfma_f32_16x16x32_bf16 v[84:87], a[168:171], a[4:7], v[84:87]
  v_mfma_f32_16x16x32_bf16 v[88:91], a[168:171], a[8:11], v[88:91]
  v_mfma_f32_16x16x32_bf16 v[88:91], a[172:175], a[24:27], v[88:91]
  v_mfma_f32_16x16x32_bf16 v[92:95], a[172:175], a[28:31], v[92:95]
  v_mfma_f32_16x16x32_bf16 v[92:95], a[168:171], a[12:15], v[92:95]
  ds_read_b64_tr_b16 a[176:177], v230 offset:49152
  ds_read_b64_tr_b16 a[178:179], v230 offset:50176
  ds_read_b64_tr_b16 a[180:181], v230 offset:57344
  ds_read_b64_tr_b16 a[182:183], v230 offset:58368
  s_waitcnt lgkmcnt(2)
  v_mfma_f32_16x16x32_bf16 v[96:99], a[176:179], a[0:3], v[96:99]
  s_waitcnt lgkmcnt(0)
  v_mfma_f32_16x16x32_bf16 v[96:99], a[180:183], a[16:19], v[96:99]
  v_mfma_f32_16x16x32_bf16 v[100:103], a[180:183], a[20:23], v[100:103]
  v_mfma_f32_16x16x32_bf16 v[100:103], a[176:179], a[4:7], v[100:103]
  v_mfma_f32_16x16x32_bf16 v[104:107], a[176:179], a[8:11], v[104:107]
  v_mfma_f32_16x16x32_bf16 v[104:107], a[180:183], a[24:27], v[104:107]
  v_mfma_f32_16x16x32_bf16 v[108:111], a[180:183], a[28:31], v[108:111]
  v_mfma_f32_16x16x32_bf16 v[108:111], a[176:179], a[12:15], v[108:111]
  ds_read_b64_tr_b16 a[184:185], v231 offset:49152
  ds_read_b64_tr_b16 a[186:187], v231 offset:50176
  ds_read_b64_tr_b16 a[188:189], v231 offset:57344
  ds_read_b64_tr_b16 a[190:191], v231 offset:58368
  s_waitcnt lgkmcnt(2)
  v_mfma_f32_16x16x32_bf16 v[112:115], a[184:187], a[0:3], v[112:115]
  s_waitcnt lgkmcnt(0)
  v_mfma_f32_16x16x32_bf16 v[112:115], a[188:191], a[16:19], v[112:115]
  v_mfma_f32_16x16x32_bf16 v[116:119], a[188:191], a[20:23], v[116:119]
  v_mfma_f32_16x16x32_bf16 v[116:119], a[184:187], a[4:7], v[116:119]
  v_mfma_f32_16x16x32_bf16 v[120:123], a[184:187], a[8:11], v[120:123]
  v_mfma_f32_16x16x32_bf16 v[120:123], a[188:191], a[24:27], v[120:123]
  v_mfma_f32_16x16x32_bf16 v[124:127], a[188:191], a[28:31], v[124:127]
  v_mfma_f32_16x16x32_bf16 v[124:127], a[184:187], a[12:15], v[124:127]
  s_add_u32 s31, s31, 0x80000
  s_cmp_lt_u32 s31, 5242880
  s_cbranch_scc1 attn_requery
  v_mul_f32 v0, s34, v0
  v_mul_f32 v1, s34, v1
  v_mul_f32 v2, s34, v2
  v_mul_f32 v3, s34, v3
  v_mul_f32 v16, s34, v16
  v_mul_f32 v17, s34, v17
  v_mul_f32 v18, s34, v18
  v_mul_f32 v19, s34, v19
  v_cvt_pk_bf16_f32 v128, v0, v1
  v_cvt_pk_bf16_f32 v129, v2, v3
  v_cvt_pk_bf16_f32 v130, v16, v17
  v_cvt_pk_bf16_f32 v131, v18, v19
  s_nop 0
  v_permlane16_swap_b32 v128, v130
  v_permlane16_swap_b32 v129, v131
  v_mul_f32 v4, s34, v4
  v_mul_f32 v5, s34, v5
  v_mul_f32 v6, s34, v6
  v_mul_f32 v7, s34, v7
  v_mul_f32 v20, s34, v20
  v_mul_f32 v21, s34, v21
  v_mul_f32 v22, s34, v22
  v_mul_f32 v23, s34, v23
  v_cvt_pk_bf16_f32 v144, v4, v5
  v_cvt_pk_bf16_f32 v145, v6, v7
  v_cvt_pk_bf16_f32 v146, v20, v21
  v_cvt_pk_bf16_f32 v147, v22, v23
  s_nop 0
  v_permlane16_swap_b32 v144, v146
  v_permlane16_swap_b32 v145, v147
  v_mul_f32 v8, s34, v8
  v_mul_f32 v9, s34, v9
  v_mul_f32 v10, s34, v10
  v_mul_f32 v11, s34, v11
  v_mul_f32 v24, s34, v24
  v_mul_f32 v25, s34, v25
  v_mul_f32 v26, s34, v26
  v_mul_f32 v27, s34, v27
  v_cvt_pk_bf16_f32 v160, v8, v9
  v_cvt_pk_bf16_f32 v161, v10, v11
  v_cvt_pk_bf16_f32 v162, v24, v25
  v_cvt_pk_bf16_f32 v163, v26, v27
  s_nop 0
  v_permlane16_swap_b32 v160, v162
  v_permlane16_swap_b32 v161, v163
  v_mul_f32 v12, s34, v12
  v_mul_f32 v13, s34, v13
  v_mul_f32 v14, s34, v14
  v_mul_f32 v15, s34, v15
  v_mul_f32 v28, s34, v28
  v_mul_f32 v29, s34, v29
  v_mul_f32 v30, s34, v30
  v_mul_f32 v31, s34, v31
  v_cvt_pk_bf16_f32 v176, v12, v13
  v_cvt_pk_bf16_f32 v177, v14, v15
  v_cvt_pk_bf16_f32 v178, v28, v29
  v_cvt_pk_bf16_f32 v179, v30, v31
  s_nop 0
  v_permlane16_swap_b32 v176, v178
  v_permlane16_swap_b32 v177, v179
  v_mul_f32 v32, s34, v32
  v_mul_f32 v33, s34, v33
  v_mul_f32 v34, s34, v34
  v_mul_f32 v35, s34, v35
  v_mul_f32 v48, s34, v48
  v_mul_f32 v49, s34, v49
  v_mul_f32 v50, s34, v50
  v_mul_f32 v51, s34, v51
  v_cvt_pk_bf16_f32 v132, v32, v33
  v_cvt_pk_bf16_f32 v133, v34, v35
  v_cvt_pk_bf16_f32 v134, v48, v49
  v_cvt_pk_bf16_f32 v135, v50, v51
  s_nop 0
  v_permlane16_swap_b32 v132, v134
  v_permlane16_swap_b32 v133, v135
  v_mul_f32 v36, s34, v36
  v_mul_f32 v37, s34, v37
  v_mul_f32 v38, s34, v38
  v_mul_f32 v39, s34, v39
  v_mul_f32 v52, s34, v52
  v_mul_f32 v53, s34, v53
  v_mul_f32 v54, s34, v54
  v_mul_f32 v55, s34, v55
  v_cvt_pk_bf16_f32 v148, v36, v37
  v_cvt_pk_bf16_f32 v149, v38, v39
  v_cvt_pk_bf16_f32 v150, v52, v53
  v_cvt_pk_bf16_f32 v151, v54, v55
  s_nop 0
  v_permlane16_swap_b32 v148, v150
  v_permlane16_swap_b32 v149, v151
  v_mul_f32 v40, s34, v40
  v_mul_f32 v41, s34, v41
  v_mul_f32 v42, s34, v42
  v_mul_f32 v43, s34, v43
  v_mul_f32 v56, s34, v56
  v_mul_f32 v57, s34, v57
  v_mul_f32 v58, s34, v58
  v_mul_f32 v59, s34, v59
  v_cvt_pk_bf16_f32 v164, v40, v41
  v_cvt_pk_bf16_f32 v165, v42, v43
  v_cvt_pk_bf16_f32 v166, v56, v57
  v_cvt_pk_bf16_f32 v167, v58, v59
  s_nop 0
  v_permlane16_swap_b32 v164, v166
  v_permlane16_swap_b32 v165, v167
  v_mul_f32 v44, s34, v44
  v_mul_f32 v45, s34, v45
  v_mul_f32 v46, s34, v46
  v_mul_f32 v47, s34, v47
  v_mul_f32 v60, s34, v60
  v_mul_f32 v61, s34, v61
  v_mul_f32 v62, s34, v62
  v_mul_f32 v63, s34, v63
  v_cvt_pk_bf16_f32 v180, v44, v45
  v_cvt_pk_bf16_f32 v181, v46, v47
  v_cvt_pk_bf16_f32 v182, v60, v61
  v_cvt_pk_bf16_f32 v183, v62, v63
  s_nop 0
  v_permlane16_swap_b32 v180, v182
  v_permlane16_swap_b32 v181, v183
  v_mul_f32 v64, s34, v64
  v_mul_f32 v65, s34, v65
  v_mul_f32 v66, s34, v66
  v_mul_f32 v67, s34, v67
  v_mul_f32 v80, s34, v80
  v_mul_f32 v81, s34, v81
  v_mul_f32 v82, s34, v82
  v_mul_f32 v83, s34, v83
  v_cvt_pk_bf16_f32 v136, v64, v65
  v_cvt_pk_bf16_f32 v137, v66, v67
  v_cvt_pk_bf16_f32 v138, v80, v81
  v_cvt_pk_bf16_f32 v139, v82, v83
  s_nop 0
  v_permlane16_swap_b32 v136, v138
  v_permlane16_swap_b32 v137, v139
  v_mul_f32 v68, s34, v68
  v_mul_f32 v69, s34, v69
  v_mul_f32 v70, s34, v70
  v_mul_f32 v71, s34, v71
  v_mul_f32 v84, s34, v84
  v_mul_f32 v85, s34, v85
  v_mul_f32 v86, s34, v86
  v_mul_f32 v87, s34, v87
  v_cvt_pk_bf16_f32 v152, v68, v69
  v_cvt_pk_bf16_f32 v153, v70, v71
  v_cvt_pk_bf16_f32 v154, v84, v85
  v_cvt_pk_bf16_f32 v155, v86, v87
  s_nop 0
  v_permlane16_swap_b32 v152, v154
  v_permlane16_swap_b32 v153, v155
  v_mul_f32 v72, s34, v72
  v_mul_f32 v73, s34, v73
  v_mul_f32 v74, s34, v74
  v_mul_f32 v75, s34, v75
  v_mul_f32 v88, s34, v88
  v_mul_f32 v89, s34, v89
  v_mul_f32 v90, s34, v90
  v_mul_f32 v91, s34, v91
  v_cvt_pk_bf16_f32 v168, v72, v73
  v_cvt_pk_bf16_f32 v169, v74, v75
  v_cvt_pk_bf16_f32 v170, v88, v89
  v_cvt_pk_bf16_f32 v171, v90, v91
  s_nop 0
  v_permlane16_swap_b32 v168, v170
  v_permlane16_swap_b32 v169, v171
  v_mul_f32 v76, s34, v76
  v_mul_f32 v77, s34, v77
  v_mul_f32 v78, s34, v78
  v_mul_f32 v79, s34, v79
  v_mul_f32 v92, s34, v92
  v_mul_f32 v93, s34, v93
  v_mul_f32 v94, s34, v94
  v_mul_f32 v95, s34, v95
  v_cvt_pk_bf16_f32 v184, v76, v77
  v_cvt_pk_bf16_f32 v185, v78, v79
  v_cvt_pk_bf16_f32 v186, v92, v93
  v_cvt_pk_bf16_f32 v187, v94, v95
  s_nop 0
  v_permlane16_swap_b32 v184, v186
  v_permlane16_swap_b32 v185, v187
  v_mul_f32 v96, s34, v96
  v_mul_f32 v97, s34, v97
  v_mul_f32 v98, s34, v98
  v_mul_f32 v99, s34, v99
  v_mul_f32 v112, s34, v112
  v_mul_f32 v113, s34, v113
  v_mul_f32 v114, s34, v114
  v_mul_f32 v115, s34, v115
  v_cvt_pk_bf16_f32 v140, v96, v97
  v_cvt_pk_bf16_f32 v141, v98, v99
  v_cvt_pk_bf16_f32 v142, v112, v113
  v_cvt_pk_bf16_f32 v143, v114, v115
  s_nop 0
  v_permlane16_swap_b32 v140, v142
  v_permlane16_swap_b32 v141, v143
  v_mul_f32 v100, s34, v100
  v_mul_f32 v101, s34, v101
  v_mul_f32 v102, s34, v102
  v_mul_f32 v103, s34, v103
  v_mul_f32 v116, s34, v116
  v_mul_f32 v117, s34, v117
  v_mul_f32 v118, s34, v118
  v_mul_f32 v119, s34, v119
  v_cvt_pk_bf16_f32 v156, v100, v101
  v_cvt_pk_bf16_f32 v157, v102, v103
  v_cvt_pk_bf16_f32 v158, v116, v117
  v_cvt_pk_bf16_f32 v159, v118, v119
  s_nop 0
  v_permlane16_swap_b32 v156, v158
  v_permlane16_swap_b32 v157, v159
  v_mul_f32 v104, s34, v104
  v_mul_f32 v105, s34, v105
  v_mul_f32 v106, s34, v106
  v_mul_f32 v107, s34, v107
  v_mul_f32 v120, s34, v120
  v_mul_f32 v121, s34, v121
  v_mul_f32 v122, s34, v122
  v_mul_f32 v123, s34, v123
  v_cvt_pk_bf16_f32 v172, v104, v105
  v_cvt_pk_bf16_f32 v173, v106, v107
  v_cvt_pk_bf16_f32 v174, v120, v121
  v_cvt_pk_bf16_f32 v175, v122, v123
  s_nop 0
  v_permlane16_swap_b32 v172, v174
  v_permlane16_swap_b32 v173, v175
  v_mul_f32 v108, s34, v108
  v_mul_f32 v109, s34, v109
  v_mul_f32 v110, s34, v110
  v_mul_f32 v111, s34, v111
  v_mul_f32 v124, s34, v124
  v_mul_f32 v125, s34, v125
  v_mul_f32 v126, s34, v126
  v_mul_f32 v127, s34, v127
  v_cvt_pk_bf16_f32 v188, v108, v109
  v_cvt_pk_bf16_f32 v189, v110, v111
  v_cvt_pk_bf16_f32 v190, v124, v125
  v_cvt_pk_bf16_f32 v191, v126, v127
  s_nop 0
  v_permlane16_swap_b32 v188, v190
  v_permlane16_swap_b32 v189, v191
  v_accvgpr_write_b32 a0, 0
  v_accvgpr_write_b32 a1, 0
  v_accvgpr_write_b32 a2, 0
  v_accvgpr_write_b32 a3, 0
  v_accvgpr_write_b32 a4, 0
  v_accvgpr_write_b32 a5, 0
  v_accvgpr_write_b32 a6, 0
  v_accvgpr_write_b32 a7, 0
  v_accvgpr_write_b32 a8, 0
  v_accvgpr_write_b32 a9, 0
  v_accvgpr_write_b32 a10, 0
  v_accvgpr_write_b32 a11, 0
  v_accvgpr_write_b32 a12, 0
  v_accvgpr_write_b32 a13, 0
  v_accvgpr_write_b32 a14, 0
  v_accvgpr_write_b32 a15, 0
  v_accvgpr_write_b32 a16, 0
  v_accvgpr_write_b32 a17, 0
  v_accvgpr_write_b32 a18, 0
  v_accvgpr_write_b32 a19, 0
  v_accvgpr_write_b32 a20, 0
  v_accvgpr_write_b32 a21, 0
  v_accvgpr_write_b32 a22, 0
  v_accvgpr_write_b32 a23, 0
  v_accvgpr_write_b32 a24, 0
  v_accvgpr_write_b32 a25, 0
  v_accvgpr_write_b32 a26, 0
  v_accvgpr_write_b32 a27, 0
  v_accvgpr_write_b32 a28, 0
  v_accvgpr_write_b32 a29, 0
  v_accvgpr_write_b32 a30, 0
  v_accvgpr_write_b32 a31, 0
  v_accvgpr_write_b32 a32, 0
  v_accvgpr_write_b32 a33, 0
  v_accvgpr_write_b32 a34, 0
  v_accvgpr_write_b32 a35, 0
  v_accvgpr_write_b32 a36, 0
  v_accvgpr_write_b32 a37, 0
  v_accvgpr_write_b32 a38, 0
  v_accvgpr_write_b32 a39, 0
  v_accvgpr_write_b32 a40, 0
  v_accvgpr_write_b32 a41, 0
  v_accvgpr_write_b32 a42, 0
  v_accvgpr_write_b32 a43, 0
  v_accvgpr_write_b32 a44, 0
  v_accvgpr_write_b32 a45, 0
  v_accvgpr_write_b32 a46, 0
  v_accvgpr_write_b32 a47, 0
  v_accvgpr_write_b32 a48, 0
  v_accvgpr_write_b32 a49, 0
  v_accvgpr_write_b32 a50, 0
  v_accvgpr_write_b32 a51, 0
  v_accvgpr_write_b32 a52, 0
  v_accvgpr_write_b32 a53, 0
  v_accvgpr_write_b32 a54, 0
  v_accvgpr_write_b32 a55, 0
  v_accvgpr_write_b32 a56, 0
  v_accvgpr_write_b32 a57, 0
  v_accvgpr_write_b32 a58, 0
  v_accvgpr_write_b32 a59, 0
  v_accvgpr_write_b32 a60, 0
  v_accvgpr_write_b32 a61, 0
  v_accvgpr_write_b32 a62, 0
  v_accvgpr_write_b32 a63, 0
  v_accvgpr_write_b32 a64, 0
  v_accvgpr_write_b32 a65, 0
  v_accvgpr_write_b32 a66, 0
  v_accvgpr_write_b32 a67, 0
  v_accvgpr_write_b32 a68, 0
  v_accvgpr_write_b32 a69, 0
  v_accvgpr_write_b32 a70, 0
  v_accvgpr_write_b32 a71, 0
  v_accvgpr_write_b32 a72, 0
  v_accvgpr_write_b32 a73, 0
  v_accvgpr_write_b32 a74, 0
  v_accvgpr_write_b32 a75, 0
  v_accvgpr_write_b32 a76, 0
  v_accvgpr_write_b32 a77, 0
  v_accvgpr_write_b32 a78, 0
  v_accvgpr_write_b32 a79, 0
  v_accvgpr_write_b32 a80, 0
  v_accvgpr_write_b32 a81, 0
  v_accvgpr_write_b32 a82, 0
  v_accvgpr_write_b32 a83, 0
  v_accvgpr_write_b32 a84, 0
  v_accvgpr_write_b32 a85, 0
  v_accvgpr_write_b32 a86, 0
  v_accvgpr_write_b32 a87, 0
  v_accvgpr_write_b32 a88, 0
  v_accvgpr_write_b32 a89, 0
  v_accvgpr_write_b32 a90, 0
  v_accvgpr_write_b32 a91, 0
  v_accvgpr_write_b32 a92, 0
  v_accvgpr_write_b32 a93, 0
  v_accvgpr_write_b32 a94, 0
  v_accvgpr_write_b32 a95, 0
  v_accvgpr_write_b32 a96, 0
  v_accvgpr_write_b32 a97, 0
  v_accvgpr_write_b32 a98, 0
  v_accvgpr_write_b32 a99, 0
  v_accvgpr_write_b32 a100, 0
  v_accvgpr_write_b32 a101, 0
  v_accvgpr_write_b32 a102, 0
  v_accvgpr_write_b32 a103, 0
  v_accvgpr_write_b32 a104, 0
  v_accvgpr_write_b32 a105, 0
  v_accvgpr_write_b32 a106, 0
  v_accvgpr_write_b32 a107, 0
  v_accvgpr_write_b32 a108, 0
  v_accvgpr_write_b32 a109, 0
  v_accvgpr_write_b32 a110, 0
  v_accvgpr_write_b32 a111, 0
  v_accvgpr_write_b32 a112, 0
  v_accvgpr_write_b32 a113, 0
  v_accvgpr_write_b32 a114, 0
  v_accvgpr_write_b32 a115, 0
  v_accvgpr_write_b32 a116, 0
  v_accvgpr_write_b32 a117, 0
  v_accvgpr_write_b32 a118, 0
  v_accvgpr_write_b32 a119, 0
  v_accvgpr_write_b32 a120, 0
  v_accvgpr_write_b32 a121, 0
  v_accvgpr_write_b32 a122, 0
  v_accvgpr_write_b32 a123, 0
  v_accvgpr_write_b32 a124, 0
  v_accvgpr_write_b32 a125, 0
  v_accvgpr_write_b32 a126, 0
  v_accvgpr_write_b32 a127, 0
  v_mov_b32 v208, 0
  v_mov_b32 v249, 0xff800000
  v_mov_b32 v209, 0
  v_mov_b32 v250, 0xff800000
  v_mov_b32 v210, 0
  v_mov_b32 v251, 0xff800000
  v_mov_b32 v211, 0
  v_mov_b32 v252, 0xff800000
  s_mov_b32 s29, 0
attn_slow:
  s_barrier
  s_add_u32 m0, s28, 49152
  s_nop 0
  buffer_load_dwordx4 v232, s[12:15], s29 offen offset:0 lds
  buffer_load_dwordx4 v233, s[12:15], s29 offen offset:1024 lds
  buffer_load_dwordx4 v234, s[12:15], s29 offen offset:2048 lds
  buffer_load_dwordx4 v235, s[12:15], s29 offen offset:3072 lds
  s_add_u32 m0, s28, 114688
  s_nop 0
  buffer_load_dwordx4 v236, s[16:19], s29 offen offset:0 lds
  buffer_load_dwordx4 v237, s[16:19], s29 offen offset:1024 lds
  buffer_load_dwordx4 v236, s[16:19], s29 offen offset:2048 lds
  buffer_load_dwordx4 v237, s[16:19], s29 offen offset:3072 lds
  s_waitcnt vmcnt(0)
  s_barrier
  ds_read_b128 a[128:131], v212 offset:49152
  ds_read_b128 a[132:135], v213 offset:49152
  ds_read_b128 a[136:139], v214 offset:49152
  ds_read_b128 a[140:143], v215 offset:49152
  s_waitcnt lgkmcnt(3)
  v_mfma_f32_16x16x32_bf16 v[0:3], a[128:131], v[128:131], 0
  s_waitcnt lgkmcnt(2)
  v_mfma_f32_16x16x32_bf16 v[0:3], a[132:135], v[132:135], v[0:3]
  s_waitcnt lgkmcnt(1)
  v_mfma_f32_16x16x32_bf16 v[0:3], a[136:139], v[136:139], v[0:3]
  s_waitcnt lgkmcnt(0)
  v_mfma_f32_16x16x32_bf16 v[0:3], a[140:143], v[140:143], v[0:3]
  v_mfma_f32_16x16x32_bf16 v[8:11], a[140:143], v[156:159], 0
  v_mfma_f32_16x16x32_bf16 v[8:11], a[136:139], v[152:155], v[8:11]
  v_mfma_f32_16x16x32_bf16 v[8:11], a[132:135], v[148:151], v[8:11]
  v_mfma_f32_16x16x32_bf16 v[8:11], a[128:131], v[144:147], v[8:11]
  v_mfma_f32_16x16x32_bf16 v[16:19], a[128:131], v[160:163], 0
  v_mfma_f32_16x16x32_bf16 v[16:19], a[132:135], v[164:167], v[16:19]
  v_mfma_f32_16x16x32_bf16 v[16:19], a[136:139], v[168:171], v[16:19]
  v_mfma_f32_16x16x32_bf16 v[16:19], a[140:143], v[172:175], v[16:19]
  v_mfma_f32_16x16x32_bf16 v[24:27], a[140:143], v[188:191], 0
  v_mfma_f32_16x16x32_bf16 v[24:27], a[136:139], v[184:187], v[24:27]
  v_mfma_f32_16x16x32_bf16 v[24:27], a[132:135], v[180:183], v[24:27]
  v_mfma_f32_16x16x32_bf16 v[24:27], a[128:131], v[176:179], v[24:27]
  ds_read_b128 a[144:147], v212 offset:53248
  ds_read_b128 a[148:151], v213 offset:53248
  ds_read_b128 a[152:155], v214 offset:53248
  ds_read_b128 a[156:159], v215 offset:53248
  s_waitcnt lgkmcnt(3)
  v_mfma_f32_16x16x32_bf16 v[4:7], a[144:147], v[128:131], 0
  s_waitcnt lgkmcnt(2)
  v_mfma_f32_16x16x32_bf16 v[4:7], a[148:151], v[132:135], v[4:7]
  s_waitcnt lgkmcnt(1)
  v_mfma_f32_16x16x32_bf16 v[4:7], a[152:155], v[136:139], v[4:7]
  s_waitcnt lgkmcnt(0)
  v_mfma_f32_16x16x32_bf16 v[4:7], a[156:159], v[140:143], v[4:7]
  v_mfma_f32_16x16x32_bf16 v[12:15], a[156:159], v[156:159], 0
  v_mfma_f32_16x16x32_bf16 v[12:15], a[152:155], v[152:155], v[12:15]
  v_mfma_f32_16x16x32_bf16 v[12:15], a[148:151], v[148:151], v[12:15]
  v_mfma_f32_16x16x32_bf16 v[12:15], a[144:147], v[144:147], v[12:15]
  v_mfma_f32_16x16x32_bf16 v[20:23], a[144:147], v[160:163], 0
  v_mfma_f32_16x16x32_bf16 v[20:23], a[148:151], v[164:167], v[20:23]
  v_mfma_f32_16x16x32_bf16 v[20:23], a[152:155], v[168:171], v[20:23]
  v_mfma_f32_16x16x32_bf16 v[20:23], a[156:159], v[172:175], v[20:23]
  v_mfma_f32_16x16x32_bf16 v[28:31], a[156:159], v[188:191], 0
  v_mfma_f32_16x16x32_bf16 v[28:31], a[152:155], v[184:187], v[28:31]
  v_mfma_f32_16x16x32_bf16 v[28:31], a[148:151], v[180:183], v[28:31]
  v_mfma_f32_16x16x32_bf16 v[28:31], a[144:147], v[176:179], v[28:31]
  ds_read_b128 a[128:131], v212 offset:57344
  ds_read_b128 a[132:135], v213 offset:57344
  ds_read_b128 a[136:139], v214 offset:57344
  ds_read_b128 a[140:143], v215 offset:57344
  s_waitcnt lgkmcnt(3)
  v_mfma_f32_16x16x32_bf16 v[32:35], a[128:131], v[128:131], 0
  s_waitcnt lgkmcnt(2)
  v_mfma_f32_16x16x32_bf16 v[32:35], a[132:135], v[132:135], v[32:35]
  s_waitcnt lgkmcnt(1)
  v_mfma_f32_16x16x32_bf16 v[32:35], a[136:139], v[136:139], v[32:35]
  s_waitcnt lgkmcnt(0)
  v_mfma_f32_16x16x32_bf16 v[32:35], a[140:143], v[140:143], v[32:35]
  v_mfma_f32_16x16x32_bf16 v[40:43], a[140:143], v[156:159], 0
  v_mfma_f32_16x16x32_bf16 v[40:43], a[136:139], v[152:155], v[40:43]
  v_mfma_f32_16x16x32_bf16 v[40:43], a[132:135], v[148:151], v[40:43]
  v_mfma_f32_16x16x32_bf16 v[40:43], a[128:131], v[144:147], v[40:43]
  v_mfma_f32_16x16x32_bf16 v[48:51], a[128:131], v[160:163], 0
  v_mfma_f32_16x16x32_bf16 v[48:51], a[132:135], v[164:167], v[48:51]
  v_mfma_f32_16x16x32_bf16 v[48:51], a[136:139], v[168:171], v[48:51]
  v_mfma_f32_16x16x32_bf16 v[48:51], a[140:143], v[172:175], v[48:51]
  v_mfma_f32_16x16x32_bf16 v[56:59], a[140:143], v[188:191], 0
  v_mfma_f32_16x16x32_bf16 v[56:59], a[136:139], v[184:187], v[56:59]
  v_mfma_f32_16x16x32_bf16 v[56:59], a[132:135], v[180:183], v[56:59]
  v_mfma_f32_16x16x32_bf16 v[56:59], a[128:131], v[176:179], v[56:59]
  ds_read_b128 a[144:147], v212 offset:61440
  ds_read_b128 a[148:151], v213 offset:61440
  ds_read_b128 a[152:155], v214 offset:61440
  ds_read_b128 a[156:159], v215 offset:61440
  s_waitcnt lgkmcnt(3)
  v_mfma_f32_16x16x32_bf16 v[36:39], a[144:147], v[128:131], 0
  s_waitcnt lgkmcnt(2)
  v_mfma_f32_16x16x32_bf16 v[36:39], a[148:151], v[132:135], v[36:39]
  s_waitcnt lgkmcnt(1)
  v_mfma_f32_16x16x32_bf16 v[36:39], a[152:155], v[136:139], v[36:39]
  s_waitcnt lgkmcnt(0)
  v_mfma_f32_16x16x32_bf16 v[36:39], a[156:159], v[140:143], v[36:39]
  v_mfma_f32_16x16x32_bf16 v[44:47], a[156:159], v[156:159], 0
  v_mfma_f32_16x16x32_bf16 v[44:47], a[152:155], v[152:155], v[44:47]
  v_mfma_f32_16x16x32_bf16 v[44:47], a[148:151], v[148:151], v[44:47]
  v_mfma_f32_16x16x32_bf16 v[44:47], a[144:147], v[144:147], v[44:47]
  v_mfma_f32_16x16x32_bf16 v[52:55], a[144:147], v[160:163], 0
  v_mfma_f32_16x16x32_bf16 v[52:55], a[148:151], v[164:167], v[52:55]
  v_mfma_f32_16x16x32_bf16 v[52:55], a[152:155], v[168:171], v[52:55]
  v_mfma_f32_16x16x32_bf16 v[52:55], a[156:159], v[172:175], v[52:55]
  v_mfma_f32_16x16x32_bf16 v[60:63], a[156:159], v[188:191], 0
  v_mfma_f32_16x16x32_bf16 v[60:63], a[152:155], v[184:187], v[60:63]
  v_mfma_f32_16x16x32_bf16 v[60:63], a[148:151], v[180:183], v[60:63]
  v_mfma_f32_16x16x32_bf16 v[60:63], a[144:147], v[176:179], v[60:63]
  v_mov_b32 v192, v249
  v_max3_f32 v192, v192, v0, v1
  v_max3_f32 v192, v192, v2, v3
  v_max3_f32 v192, v192, v4, v5
  v_max3_f32 v192, v192, v6, v7
  v_max3_f32 v192, v192, v32, v33
  v_max3_f32 v192, v192, v34, v35
  v_max3_f32 v192, v192, v36, v37
  v_max3_f32 v192, v192, v38, v39
  v_mov_b32 v245, v192
  s_nop 1
  v_permlane16_swap_b32 v192, v245
  v_max_f32 v192, v192, v245
  v_mov_b32 v245, v192
  s_nop 1
  v_permlane32_swap_b32 v192, v245
  v_max_f32 v192, v192, v245
  v_sub_f32 v193, v249, v192
  v_exp_f32 v193, v193
  v_mov_b32 v249, v192
  v_mul_f32 v208, v208, v193
  v_sub_f32 v0, v0, v192
  v_sub_f32 v1, v1, v192
  v_sub_f32 v2, v2, v192
  v_sub_f32 v3, v3, v192
  v_sub_f32 v4, v4, v192
  v_sub_f32 v5, v5, v192
  v_sub_f32 v6, v6, v192
  v_sub_f32 v7, v7, v192
  v_sub_f32 v32, v32, v192
  v_sub_f32 v33, v33, v192
  v_sub_f32 v34, v34, v192
  v_sub_f32 v35, v35, v192
  v_sub_f32 v36, v36, v192
  v_sub_f32 v37, v37, v192
  v_sub_f32 v38, v38, v192
  v_sub_f32 v39, v39, v192
  v_exp_f32 v0, v0
  v_exp_f32 v1, v1
  v_add_f32 v208, v208, v0
  v_exp_f32 v2, v2
  v_add_f32 v208, v208, v1
  v_cvt_pk_bf16_f32 v0, v0, v1
  v_exp_f32 v3, v3
  v_add_f32 v208, v208, v2
  v_add_f32 v208, v208, v3
  v_cvt_pk_bf16_f32 v1, v2, v3
  v_exp_f32 v4, v4
  v_exp_f32 v5, v5
  v_add_f32 v208, v208, v4
  v_exp_f32 v6, v6
  v_add_f32 v208, v208, v5
  v_cvt_pk_bf16_f32 v2, v4, v5
  v_exp_f32 v7, v7
  v_add_f32 v208, v208, v6
  v_add_f32 v208, v208, v7
  v_cvt_pk_bf16_f32 v3, v6, v7
  v_exp_f32 v32, v32
  v_exp_f32 v33, v33
  v_add_f32 v208, v208, v32
  v_exp_f32 v34, v34
  v_add_f32 v208, v208, v33
  v_cvt_pk_bf16_f32 v32, v32, v33
  v_exp_f32 v35, v35
  v_add_f32 v208, v208, v34
  v_add_f32 v208, v208, v35
  v_cvt_pk_bf16_f32 v33, v34, v35
  v_exp_f32 v36, v36
  v_exp_f32 v37, v37
  v_add_f32 v208, v208, v36
  v_exp_f32 v38, v38
  v_add_f32 v208, v208, v37
  v_cvt_pk_bf16_f32 v34, v36, v37
  v_exp_f32 v39, v39
  v_add_f32 v208, v208, v38
  v_add_f32 v208, v208, v39
  v_cvt_pk_bf16_f32 v35, v38, v39
  v_accvgpr_read_b32 v64, a0
  v_accvgpr_read_b32 v65, a1
  v_accvgpr_read_b32 v66, a2
  v_accvgpr_read_b32 v67, a3
  v_mul_f32 v64, v64, v193
  v_mul_f32 v65, v65, v193
  v_mul_f32 v66, v66, v193
  v_mul_f32 v67, v67, v193
  v_accvgpr_write_b32 a0, v64
  v_accvgpr_write_b32 a1, v65
  v_accvgpr_write_b32 a2, v66
  v_accvgpr_write_b32 a3, v67
  v_accvgpr_read_b32 v64, a16
  v_accvgpr_read_b32 v65, a17
  v_accvgpr_read_b32 v66, a18
  v_accvgpr_read_b32 v67, a19
  v_mul_f32 v64, v64, v193
  v_mul_f32 v65, v65, v193
  v_mul_f32 v66, v66, v193
  v_mul_f32 v67, v67, v193
  v_accvgpr_write_b32 a16, v64
  v_accvgpr_write_b32 a17, v65
  v_accvgpr_write_b32 a18, v66
  v_accvgpr_write_b32 a19, v67
  v_accvgpr_read_b32 v64, a32
  v_accvgpr_read_b32 v65, a33
  v_accvgpr_read_b32 v66, a34
  v_accvgpr_read_b32 v67, a35
  v_mul_f32 v64, v64, v193
  v_mul_f32 v65, v65, v193
  v_mul_f32 v66, v66, v193
  v_mul_f32 v67, v67, v193
  v_accvgpr_write_b32 a32, v64
  v_accvgpr_write_b32 a33, v65
  v_accvgpr_write_b32 a34, v66
  v_accvgpr_write_b32 a35, v67
  v_accvgpr_read_b32 v64, a48
  v_accvgpr_read_b32 v65, a49
  v_accvgpr_read_b32 v66, a50
  v_accvgpr_read_b32 v67, a51
  v_mul_f32 v64, v64, v193
  v_mul_f32 v65, v65, v193
  v_mul_f32 v66, v66, v193
  v_mul_f32 v67, v67, v193
  v_accvgpr_write_b32 a48, v64
  v_accvgpr_write_b32 a49, v65
  v_accvgpr_write_b32 a50, v66
  v_accvgpr_write_b32 a51, v67
  v_accvgpr_read_b32 v64, a64
  v_accvgpr_read_b32 v65, a65
  v_accvgpr_read_b32 v66, a66
  v_accvgpr_read_b32 v67, a67
  v_mul_f32 v64, v64, v193
  v_mul_f32 v65, v65, v193
  v_mul_f32 v66, v66, v193
  v_mul_f32 v67, v67, v193
  v_accvgpr_write_b32 a64, v64
  v_accvgpr_write_b32 a65, v65
  v_accvgpr_write_b32 a66, v66
  v_accvgpr_write_b32 a67, v67
  v_accvgpr_read_b32 v64, a80
  v_accvgpr_read_b32 v65, a81
  v_accvgpr_read_b32 v66, a82
  v_accvgpr_read_b32 v67, a83
  v_mul_f32 v64, v64, v193
  v_mul_f32 v65, v65, v193
  v_mul_f32 v66, v66, v193
  v_mul_f32 v67, v67, v193
  v_accvgpr_write_b32 a80, v64
  v_accvgpr_write_b32 a81, v65
  v_accvgpr_write_b32 a82, v66
  v_accvgpr_write_b32 a83, v67
  v_accvgpr_read_b32 v64, a96
  v_accvgpr_read_b32 v65, a97
  v_accvgpr_read_b32 v66, a98
  v_accvgpr_read_b32 v67, a99
  v_mul_f32 v64, v64, v193
  v_mul_f32 v65, v65, v193
  v_mul_f32 v66, v66, v193
  v_mul_f32 v67, v67, v193
  v_accvgpr_write_b32 a96, v64
  v_accvgpr_write_b32 a97, v65
  v_accvgpr_write_b32 a98, v66
  v_accvgpr_write_b32 a99, v67
  v_accvgpr_read_b32 v64, a112
  v_accvgpr_read_b32 v65, a113
  v_accvgpr_read_b32 v66, a114
  v_accvgpr_read_b32 v67, a115
  v_mul_f32 v64, v64, v193
  v_mul_f32 v65, v65, v193
  v_mul_f32 v66, v66, v193
  v_mul_f32 v67, v67, v193
  v_accvgpr_write_b32 a112, v64
  v_accvgpr_write_b32 a113, v65
  v_accvgpr_write_b32 a114, v66
  v_accvgpr_write_b32 a115, v67
  v_mov_b32 v196, v250
  v_max3_f32 v196, v196, v8, v9
  v_max3_f32 v196, v196, v10, v11
  v_max3_f32 v196, v196, v12, v13
  v_max3_f32 v196, v196, v14, v15
  v_max3_f32 v196, v196, v40, v41
  v_max3_f32 v196, v196, v42, v43
  v_max3_f32 v196, v196, v44, v45
  v_max3_f32 v196, v196, v46, v47
  v_mov_b32 v245, v196
  s_nop 1
  v_permlane16_swap_b32 v196, v245
  v_max_f32 v196, v196, v245
  v_mov_b32 v245, v196
  s_nop 1
  v_permlane32_swap_b32 v196, v245
  v_max_f32 v196, v196, v245
  v_sub_f32 v197, v250, v196
  v_exp_f32 v197, v197
  v_mov_b32 v250, v196
  v_mul_f32 v209, v209, v197
  v_sub_f32 v8, v8, v196
  v_sub_f32 v9, v9, v196
  v_sub_f32 v10, v10, v196
  v_sub_f32 v11, v11, v196
  v_sub_f32 v12, v12, v196
  v_sub_f32 v13, v13, v196
  v_sub_f32 v14, v14, v196
  v_sub_f32 v15, v15, v196
  v_sub_f32 v40, v40, v196
  v_sub_f32 v41, v41, v196
  v_sub_f32 v42, v42, v196
  v_sub_f32 v43, v43, v196
  v_sub_f32 v44, v44, v196
  v_sub_f32 v45, v45, v196
  v_sub_f32 v46, v46, v196
  v_sub_f32 v47, v47, v196
  v_exp_f32 v8, v8
  v_exp_f32 v9, v9
  v_add_f32 v209, v209, v8
  v_exp_f32 v10, v10
  v_add_f32 v209, v209, v9
  v_cvt_pk_bf16_f32 v8, v8, v9
  v_exp_f32 v11, v11
  v_add_f32 v209, v209, v10
  v_add_f32 v209, v209, v11
  v_cvt_pk_bf16_f32 v9, v10, v11
  v_exp_f32 v12, v12
  v_exp_f32 v13, v13
  v_add_f32 v209, v209, v12
  v_exp_f32 v14, v14
  v_add_f32 v209, v209, v13
  v_cvt_pk_bf16_f32 v10, v12, v13
  v_exp_f32 v15, v15
  v_add_f32 v209, v209, v14
  v_add_f32 v209, v209, v15
  v_cvt_pk_bf16_f32 v11, v14, v15
  v_exp_f32 v40, v40
  v_exp_f32 v41, v41
  v_add_f32 v209, v209, v40
  v_exp_f32 v42, v42
  v_add_f32 v209, v209, v41
  v_cvt_pk_bf16_f32 v40, v40, v41
  v_exp_f32 v43, v43
  v_add_f32 v209, v209, v42
  v_add_f32 v209, v209, v43
  v_cvt_pk_bf16_f32 v41, v42, v43
  v_exp_f32 v44, v44
  v_exp_f32 v45, v45
  v_add_f32 v209, v209, v44
  v_exp_f32 v46, v46
  v_add_f32 v209, v209, v45
  v_cvt_pk_bf16_f32 v42, v44, v45
  v_exp_f32 v47, v47
  v_add_f32 v209, v209, v46
  v_add_f32 v209, v209, v47
  v_cvt_pk_bf16_f32 v43, v46, v47
  v_accvgpr_read_b32 v64, a4
  v_accvgpr_read_b32 v65, a5
  v_accvgpr_read_b32 v66, a6
  v_accvgpr_read_b32 v67, a7
  v_mul_f32 v64, v64, v197
  v_mul_f32 v65, v65, v197
  v_mul_f32 v66, v66, v197
  v_mul_f32 v67, v67, v197
  v_accvgpr_write_b32 a4, v64
  v_accvgpr_write_b32 a5, v65
  v_accvgpr_write_b32 a6, v66
  v_accvgpr_write_b32 a7, v67
  v_accvgpr_read_b32 v64, a20
  v_accvgpr_read_b32 v65, a21
  v_accvgpr_read_b32 v66, a22
  v_accvgpr_read_b32 v67, a23
  v_mul_f32 v64, v64, v197
  v_mul_f32 v65, v65, v197
  v_mul_f32 v66, v66, v197
  v_mul_f32 v67, v67, v197
  v_accvgpr_write_b32 a20, v64
  v_accvgpr_write_b32 a21, v65
  v_accvgpr_write_b32 a22, v66
  v_accvgpr_write_b32 a23, v67
  v_accvgpr_read_b32 v64, a36
  v_accvgpr_read_b32 v65, a37
  v_accvgpr_read_b32 v66, a38
  v_accvgpr_read_b32 v67, a39
  v_mul_f32 v64, v64, v197
  v_mul_f32 v65, v65, v197
  v_mul_f32 v66, v66, v197
  v_mul_f32 v67, v67, v197
  v_accvgpr_write_b32 a36, v64
  v_accvgpr_write_b32 a37, v65
  v_accvgpr_write_b32 a38, v66
  v_accvgpr_write_b32 a39, v67
  v_accvgpr_read_b32 v64, a52
  v_accvgpr_read_b32 v65, a53
  v_accvgpr_read_b32 v66, a54
  v_accvgpr_read_b32 v67, a55
  v_mul_f32 v64, v64, v197
  v_mul_f32 v65, v65, v197
  v_mul_f32 v66, v66, v197
  v_mul_f32 v67, v67, v197
  v_accvgpr_write_b32 a52, v64
  v_accvgpr_write_b32 a53, v65
  v_accvgpr_write_b32 a54, v66
  v_accvgpr_write_b32 a55, v67
  v_accvgpr_read_b32 v64, a68
  v_accvgpr_read_b32 v65, a69
  v_accvgpr_read_b32 v66, a70
  v_accvgpr_read_b32 v67, a71
  v_mul_f32 v64, v64, v197
  v_mul_f32 v65, v65, v197
  v_mul_f32 v66, v66, v197
  v_mul_f32 v67, v67, v197
  v_accvgpr_write_b32 a68, v64
  v_accvgpr_write_b32 a69, v65
  v_accvgpr_write_b32 a70, v66
  v_accvgpr_write_b32 a71, v67
  v_accvgpr_read_b32 v64, a84
  v_accvgpr_read_b32 v65, a85
  v_accvgpr_read_b32 v66, a86
  v_accvgpr_read_b32 v67, a87
  v_mul_f32 v64, v64, v197
  v_mul_f32 v65, v65, v197
  v_mul_f32 v66, v66, v197
  v_mul_f32 v67, v67, v197
  v_accvgpr_write_b32 a84, v64
  v_accvgpr_write_b32 a85, v65
  v_accvgpr_write_b32 a86, v66
  v_accvgpr_write_b32 a87, v67
  v_accvgpr_read_b32 v64, a100
  v_accvgpr_read_b32 v65, a101
  v_accvgpr_read_b32 v66, a102
  v_accvgpr_read_b32 v67, a103
  v_mul_f32 v64, v64, v197
  v_mul_f32 v65, v65, v197
  v_mul_f32 v66, v66, v197
  v_mul_f32 v67, v67, v197
  v_accvgpr_write_b32 a100, v64
  v_accvgpr_write_b32 a101, v65
  v_accvgpr_write_b32 a102, v66
  v_accvgpr_write_b32 a103, v67
  v_accvgpr_read_b32 v64, a116
  v_accvgpr_read_b32 v65, a117
  v_accvgpr_read_b32 v66, a118
  v_accvgpr_read_b32 v67, a119
  v_mul_f32 v64, v64, v197
  v_mul_f32 v65, v65, v197
  v_mul_f32 v66, v66, v197
  v_mul_f32 v67, v67, v197
  v_accvgpr_write_b32 a116, v64
  v_accvgpr_write_b32 a117, v65
  v_accvgpr_write_b32 a118, v66
  v_accvgpr_write_b32 a119, v67
  v_mov_b32 v200, v251
  v_max3_f32 v200, v200, v16, v17
  v_max3_f32 v200, v200, v18, v19
  v_max3_f32 v200, v200, v20, v21
  v_max3_f32 v200, v200, v22, v23
  v_max3_f32 v200, v200, v48, v49
  v_max3_f32 v200, v200, v50, v51
  v_max3_f32 v200, v200, v52, v53
  v_max3_f32 v200, v200, v54, v55
  v_mov_b32 v245, v200
  s_nop 1
  v_permlane16_swap_b32 v200, v245
  v_max_f32 v200, v200, v245
  v_mov_b32 v245, v200
  s_nop 1
  v_permlane32_swap_b32 v200, v245
  v_max_f32 v200, v200, v245
  v_sub_f32 v201, v251, v200
  v_exp_f32 v201, v201
  v_mov_b32 v251, v200
  v_mul_f32 v210, v210, v201
  v_sub_f32 v16, v16, v200
  v_sub_f32 v17, v17, v200
  v_sub_f32 v18, v18, v200
  v_sub_f32 v19, v19, v200
  v_sub_f32 v20, v20, v200
  v_sub_f32 v21, v21, v200
  v_sub_f32 v22, v22, v200
  v_sub_f32 v23, v23, v200
  v_sub_f32 v48, v48, v200
  v_sub_f32 v49, v49, v200
  v_sub_f32 v50, v50, v200
  v_sub_f32 v51, v51, v200
  v_sub_f32 v52, v52, v200
  v_sub_f32 v53, v53, v200
  v_sub_f32 v54, v54, v200
  v_sub_f32 v55, v55, v200
  v_exp_f32 v16, v16
  v_exp_f32 v17, v17
  v_add_f32 v210, v210, v16
  v_exp_f32 v18, v18
  v_add_f32 v210, v210, v17
  v_cvt_pk_bf16_f32 v16, v16, v17
  v_exp_f32 v19, v19
  v_add_f32 v210, v210, v18
  v_add_f32 v210, v210, v19
  v_cvt_pk_bf16_f32 v17, v18, v19
  v_exp_f32 v20, v20
  v_exp_f32 v21, v21
  v_add_f32 v210, v210, v20
  v_exp_f32 v22, v22
  v_add_f32 v210, v210, v21
  v_cvt_pk_bf16_f32 v18, v20, v21
  v_exp_f32 v23, v23
  v_add_f32 v210, v210, v22
  v_add_f32 v210, v210, v23
  v_cvt_pk_bf16_f32 v19, v22, v23
  v_exp_f32 v48, v48
  v_exp_f32 v49, v49
  v_add_f32 v210, v210, v48
  v_exp_f32 v50, v50
  v_add_f32 v210, v210, v49
  v_cvt_pk_bf16_f32 v48, v48, v49
  v_exp_f32 v51, v51
  v_add_f32 v210, v210, v50
  v_add_f32 v210, v210, v51
  v_cvt_pk_bf16_f32 v49, v50, v51
  v_exp_f32 v52, v52
  v_exp_f32 v53, v53
  v_add_f32 v210, v210, v52
  v_exp_f32 v54, v54
  v_add_f32 v210, v210, v53
  v_cvt_pk_bf16_f32 v50, v52, v53
  v_exp_f32 v55, v55
  v_add_f32 v210, v210, v54
  v_add_f32 v210, v210, v55
  v_cvt_pk_bf16_f32 v51, v54, v55
  v_accvgpr_read_b32 v64, a8
  v_accvgpr_read_b32 v65, a9
  v_accvgpr_read_b32 v66, a10
  v_accvgpr_read_b32 v67, a11
  v_mul_f32 v64, v64, v201
  v_mul_f32 v65, v65, v201
  v_mul_f32 v66, v66, v201
  v_mul_f32 v67, v67, v201
  v_accvgpr_write_b32 a8, v64
  v_accvgpr_write_b32 a9, v65
  v_accvgpr_write_b32 a10, v66
  v_accvgpr_write_b32 a11, v67
  v_accvgpr_read_b32 v64, a24
  v_accvgpr_read_b32 v65, a25
  v_accvgpr_read_b32 v66, a26
  v_accvgpr_read_b32 v67, a27
  v_mul_f32 v64, v64, v201
  v_mul_f32 v65, v65, v201
  v_mul_f32 v66, v66, v201
  v_mul_f32 v67, v67, v201
  v_accvgpr_write_b32 a24, v64
  v_accvgpr_write_b32 a25, v65
  v_accvgpr_write_b32 a26, v66
  v_accvgpr_write_b32 a27, v67
  v_accvgpr_read_b32 v64, a40
  v_accvgpr_read_b32 v65, a41
  v_accvgpr_read_b32 v66, a42
  v_accvgpr_read_b32 v67, a43
  v_mul_f32 v64, v64, v201
  v_mul_f32 v65, v65, v201
  v_mul_f32 v66, v66, v201
  v_mul_f32 v67, v67, v201
  v_accvgpr_write_b32 a40, v64
  v_accvgpr_write_b32 a41, v65
  v_accvgpr_write_b32 a42, v66
  v_accvgpr_write_b32 a43, v67
  v_accvgpr_read_b32 v64, a56
  v_accvgpr_read_b32 v65, a57
  v_accvgpr_read_b32 v66, a58
  v_accvgpr_read_b32 v67, a59
  v_mul_f32 v64, v64, v201
  v_mul_f32 v65, v65, v201
  v_mul_f32 v66, v66, v201
  v_mul_f32 v67, v67, v201
  v_accvgpr_write_b32 a56, v64
  v_accvgpr_write_b32 a57, v65
  v_accvgpr_write_b32 a58, v66
  v_accvgpr_write_b32 a59, v67
  v_accvgpr_read_b32 v64, a72
  v_accvgpr_read_b32 v65, a73
  v_accvgpr_read_b32 v66, a74
  v_accvgpr_read_b32 v67, a75
  v_mul_f32 v64, v64, v201
  v_mul_f32 v65, v65, v201
  v_mul_f32 v66, v66, v201
  v_mul_f32 v67, v67, v201
  v_accvgpr_write_b32 a72, v64
  v_accvgpr_write_b32 a73, v65
  v_accvgpr_write_b32 a74, v66
  v_accvgpr_write_b32 a75, v67
  v_accvgpr_read_b32 v64, a88
  v_accvgpr_read_b32 v65, a89
  v_accvgpr_read_b32 v66, a90
  v_accvgpr_read_b32 v67, a91
  v_mul_f32 v64, v64, v201
  v_mul_f32 v65, v65, v201
  v_mul_f32 v66, v66, v201
  v_mul_f32 v67, v67, v201
  v_accvgpr_write_b32 a88, v64
  v_accvgpr_write_b32 a89, v65
  v_accvgpr_write_b32 a90, v66
  v_accvgpr_write_b32 a91, v67
  v_accvgpr_read_b32 v64, a104
  v_accvgpr_read_b32 v65, a105
  v_accvgpr_read_b32 v66, a106
  v_accvgpr_read_b32 v67, a107
  v_mul_f32 v64, v64, v201
  v_mul_f32 v65, v65, v201
  v_mul_f32 v66, v66, v201
  v_mul_f32 v67, v67, v201
  v_accvgpr_write_b32 a104, v64
  v_accvgpr_write_b32 a105, v65
  v_accvgpr_write_b32 a106, v66
  v_accvgpr_write_b32 a107, v67
  v_accvgpr_read_b32 v64, a120
  v_accvgpr_read_b32 v65, a121
  v_accvgpr_read_b32 v66, a122
  v_accvgpr_read_b32 v67, a123
  v_mul_f32 v64, v64, v201
  v_mul_f32 v65, v65, v201
  v_mul_f32 v66, v66, v201
  v_mul_f32 v67, v67, v201
  v_accvgpr_write_b32 a120, v64
  v_accvgpr_write_b32 a121, v65
  v_accvgpr_write_b32 a122, v66
  v_accvgpr_write_b32 a123, v67
  v_mov_b32 v204, v252
  v_max3_f32 v204, v204, v24, v25
  v_max3_f32 v204, v204, v26, v27
  v_max3_f32 v204, v204, v28, v29
  v_max3_f32 v204, v204, v30, v31
  v_max3_f32 v204, v204, v56, v57
  v_max3_f32 v204, v204, v58, v59
  v_max3_f32 v204, v204, v60, v61
  v_max3_f32 v204, v204, v62, v63
  v_mov_b32 v245, v204
  s_nop 1
  v_permlane16_swap_b32 v204, v245
  v_max_f32 v204, v204, v245
  v_mov_b32 v245, v204
  s_nop 1
  v_permlane32_swap_b32 v204, v245
  v_max_f32 v204, v204, v245
  v_sub_f32 v205, v252, v204
  v_exp_f32 v205, v205
  v_mov_b32 v252, v204
  v_mul_f32 v211, v211, v205
  v_sub_f32 v24, v24, v204
  v_sub_f32 v25, v25, v204
  v_sub_f32 v26, v26, v204
  v_sub_f32 v27, v27, v204
  v_sub_f32 v28, v28, v204
  v_sub_f32 v29, v29, v204
  v_sub_f32 v30, v30, v204
  v_sub_f32 v31, v31, v204
  v_sub_f32 v56, v56, v204
  v_sub_f32 v57, v57, v204
  v_sub_f32 v58, v58, v204
  v_sub_f32 v59, v59, v204
  v_sub_f32 v60, v60, v204
  v_sub_f32 v61, v61, v204
  v_sub_f32 v62, v62, v204
  v_sub_f32 v63, v63, v204
  v_exp_f32 v24, v24
  v_exp_f32 v25, v25
  v_add_f32 v211, v211, v24
  v_exp_f32 v26, v26
  v_add_f32 v211, v211, v25
  v_cvt_pk_bf16_f32 v24, v24, v25
  v_exp_f32 v27, v27
  v_add_f32 v211, v211, v26
  v_add_f32 v211, v211, v27
  v_cvt_pk_bf16_f32 v25, v26, v27
  v_exp_f32 v28, v28
  v_exp_f32 v29, v29
  v_add_f32 v211, v211, v28
  v_exp_f32 v30, v30
  v_add_f32 v211, v211, v29
  v_cvt_pk_bf16_f32 v26, v28, v29
  v_exp_f32 v31, v31
  v_add_f32 v211, v211, v30
  v_add_f32 v211, v211, v31
  v_cvt_pk_bf16_f32 v27, v30, v31
  v_exp_f32 v56, v56
  v_exp_f32 v57, v57
  v_add_f32 v211, v211, v56
  v_exp_f32 v58, v58
  v_add_f32 v211, v211, v57
  v_cvt_pk_bf16_f32 v56, v56, v57
  v_exp_f32 v59, v59
  v_add_f32 v211, v211, v58
  v_add_f32 v211, v211, v59
  v_cvt_pk_bf16_f32 v57, v58, v59
  v_exp_f32 v60, v60
  v_exp_f32 v61, v61
  v_add_f32 v211, v211, v60
  v_exp_f32 v62, v62
  v_add_f32 v211, v211, v61
  v_cvt_pk_bf16_f32 v58, v60, v61
  v_exp_f32 v63, v63
  v_add_f32 v211, v211, v62
  v_add_f32 v211, v211, v63
  v_cvt_pk_bf16_f32 v59, v62, v63
  v_accvgpr_read_b32 v64, a12
  v_accvgpr_read_b32 v65, a13
  v_accvgpr_read_b32 v66, a14
  v_accvgpr_read_b32 v67, a15
  v_mul_f32 v64, v64, v205
  v_mul_f32 v65, v65, v205
  v_mul_f32 v66, v66, v205
  v_mul_f32 v67, v67, v205
  v_accvgpr_write_b32 a12, v64
  v_accvgpr_write_b32 a13, v65
  v_accvgpr_write_b32 a14, v66
  v_accvgpr_write_b32 a15, v67
  v_accvgpr_read_b32 v64, a28
  v_accvgpr_read_b32 v65, a29
  v_accvgpr_read_b32 v66, a30
  v_accvgpr_read_b32 v67, a31
  v_mul_f32 v64, v64, v205
  v_mul_f32 v65, v65, v205
  v_mul_f32 v66, v66, v205
  v_mul_f32 v67, v67, v205
  v_accvgpr_write_b32 a28, v64
  v_accvgpr_write_b32 a29, v65
  v_accvgpr_write_b32 a30, v66
  v_accvgpr_write_b32 a31, v67
  v_accvgpr_read_b32 v64, a44
  v_accvgpr_read_b32 v65, a45
  v_accvgpr_read_b32 v66, a46
  v_accvgpr_read_b32 v67, a47
  v_mul_f32 v64, v64, v205
  v_mul_f32 v65, v65, v205
  v_mul_f32 v66, v66, v205
  v_mul_f32 v67, v67, v205
  v_accvgpr_write_b32 a44, v64
  v_accvgpr_write_b32 a45, v65
  v_accvgpr_write_b32 a46, v66
  v_accvgpr_write_b32 a47, v67
  v_accvgpr_read_b32 v64, a60
  v_accvgpr_read_b32 v65, a61
  v_accvgpr_read_b32 v66, a62
  v_accvgpr_read_b32 v67, a63
  v_mul_f32 v64, v64, v205
  v_mul_f32 v65, v65, v205
  v_mul_f32 v66, v66, v205
  v_mul_f32 v67, v67, v205
  v_accvgpr_write_b32 a60, v64
  v_accvgpr_write_b32 a61, v65
  v_accvgpr_write_b32 a62, v66
  v_accvgpr_write_b32 a63, v67
  v_accvgpr_read_b32 v64, a76
  v_accvgpr_read_b32 v65, a77
  v_accvgpr_read_b32 v66, a78
  v_accvgpr_read_b32 v67, a79
  v_mul_f32 v64, v64, v205
  v_mul_f32 v65, v65, v205
  v_mul_f32 v66, v66, v205
  v_mul_f32 v67, v67, v205
  v_accvgpr_write_b32 a76, v64
  v_accvgpr_write_b32 a77, v65
  v_accvgpr_write_b32 a78, v66
  v_accvgpr_write_b32 a79, v67
  v_accvgpr_read_b32 v64, a92
  v_accvgpr_read_b32 v65, a93
  v_accvgpr_read_b32 v66, a94
  v_accvgpr_read_b32 v67, a95
  v_mul_f32 v64, v64, v205
  v_mul_f32 v65, v65, v205
  v_mul_f32 v66, v66, v205
  v_mul_f32 v67, v67, v205
  v_accvgpr_write_b32 a92, v64
  v_accvgpr_write_b32 a93, v65
  v_accvgpr_write_b32 a94, v66
  v_accvgpr_write_b32 a95, v67
  v_accvgpr_read_b32 v64, a108
  v_accvgpr_read_b32 v65, a109
  v_accvgpr_read_b32 v66, a110
  v_accvgpr_read_b32 v67, a111
  v_mul_f32 v64, v64, v205
  v_mul_f32 v65, v65, v205
  v_mul_f32 v66, v66, v205
  v_mul_f32 v67, v67, v205
  v_accvgpr_write_b32 a108, v64
  v_accvgpr_write_b32 a109, v65
  v_accvgpr_write_b32 a110, v66
  v_accvgpr_write_b32 a111, v67
  v_accvgpr_read_b32 v64, a124
  v_accvgpr_read_b32 v65, a125
  v_accvgpr_read_b32 v66, a126
  v_accvgpr_read_b32 v67, a127
  v_mul_f32 v64, v64, v205
  v_mul_f32 v65, v65, v205
  v_mul_f32 v66, v66, v205
  v_mul_f32 v67, v67, v205
  v_accvgpr_write_b32 a124, v64
  v_accvgpr_write_b32 a125, v65
  v_accvgpr_write_b32 a126, v66
  v_accvgpr_write_b32 a127, v67
  ds_read_b64_tr_b16 a[160:161], v216 offset:49152
  ds_read_b64_tr_b16 a[162:163], v216 offset:53248
  ds_read_b64_tr_b16 a[164:165], v216 offset:57344
  ds_read_b64_tr_b16 a[166:167], v216 offset:61440
  s_waitcnt lgkmcnt(2)
  v_mfma_f32_16x16x32_bf16 a[0:3], a[160:163], v[0:3], a[0:3]
  s_waitcnt lgkmcnt(0)
  v_mfma_f32_16x16x32_bf16 a[0:3], a[164:167], v[32:35], a[0:3]
  v_mfma_f32_16x16x32_bf16 a[4:7], a[164:167], v[40:43], a[4:7]
  v_mfma_f32_16x16x32_bf16 a[4:7], a[160:163], v[8:11], a[4:7]
  v_mfma_f32_16x16x32_bf16 a[8:11], a[160:163], v[16:19], a[8:11]
  v_mfma_f32_16x16x32_bf16 a[8:11], a[164:167], v[48:51], a[8:11]
  v_mfma_f32_16x16x32_bf16 a[12:15], a[164:167], v[56:59], a[12:15]
  v_mfma_f32_16x16x32_bf16 a[12:15], a[160:163], v[24:27], a[12:15]
  ds_read_b64_tr_b16 a[168:169], v217 offset:49152
  ds_read_b64_tr_b16 a[170:171], v217 offset:53248
  ds_read_b64_tr_b16 a[172:173], v217 offset:57344
  ds_read_b64_tr_b16 a[174:175], v217 offset:61440
  s_waitcnt lgkmcnt(2)
  v_mfma_f32_16x16x32_bf16 a[16:19], a[168:171], v[0:3], a[16:19]
  s_waitcnt lgkmcnt(0)
  v_mfma_f32_16x16x32_bf16 a[16:19], a[172:175], v[32:35], a[16:19]
  v_mfma_f32_16x16x32_bf16 a[20:23], a[172:175], v[40:43], a[20:23]
  v_mfma_f32_16x16x32_bf16 a[20:23], a[168:171], v[8:11], a[20:23]
  v_mfma_f32_16x16x32_bf16 a[24:27], a[168:171], v[16:19], a[24:27]
  v_mfma_f32_16x16x32_bf16 a[24:27], a[172:175], v[48:51], a[24:27]
  v_mfma_f32_16x16x32_bf16 a[28:31], a[172:175], v[56:59], a[28:31]
  v_mfma_f32_16x16x32_bf16 a[28:31], a[168:171], v[24:27], a[28:31]
  ds_read_b64_tr_b16 a[176:177], v218 offset:49152
  ds_read_b64_tr_b16 a[178:179], v218 offset:53248
  ds_read_b64_tr_b16 a[180:181], v218 offset:57344
  ds_read_b64_tr_b16 a[182:183], v218 offset:61440
  s_waitcnt lgkmcnt(2)
  v_mfma_f32_16x16x32_bf16 a[32:35], a[176:179], v[0:3], a[32:35]
  s_waitcnt lgkmcnt(0)
  v_mfma_f32_16x16x32_bf16 a[32:35], a[180:183], v[32:35], a[32:35]
  v_mfma_f32_16x16x32_bf16 a[36:39], a[180:183], v[40:43], a[36:39]
  v_mfma_f32_16x16x32_bf16 a[36:39], a[176:179], v[8:11], a[36:39]
  v_mfma_f32_16x16x32_bf16 a[40:43], a[176:179], v[16:19], a[40:43]
  v_mfma_f32_16x16x32_bf16 a[40:43], a[180:183], v[48:51], a[40:43]
  v_mfma_f32_16x16x32_bf16 a[44:47], a[180:183], v[56:59], a[44:47]
  v_mfma_f32_16x16x32_bf16 a[44:47], a[176:179], v[24:27], a[44:47]
  ds_read_b64_tr_b16 a[184:185], v219 offset:49152
  ds_read_b64_tr_b16 a[186:187], v219 offset:53248
  ds_read_b64_tr_b16 a[188:189], v219 offset:57344
  ds_read_b64_tr_b16 a[190:191], v219 offset:61440
  s_waitcnt lgkmcnt(2)
  v_mfma_f32_16x16x32_bf16 a[48:51], a[184:187], v[0:3], a[48:51]
  s_waitcnt lgkmcnt(0)
  v_mfma_f32_16x16x32_bf16 a[48:51], a[188:191], v[32:35], a[48:51]
  v_mfma_f32_16x16x32_bf16 a[52:55], a[188:191], v[40:43], a[52:55]
  v_mfma_f32_16x16x32_bf16 a[52:55], a[184:187], v[8:11], a[52:55]
  v_mfma_f32_16x16x32_bf16 a[56:59], a[184:187], v[16:19], a[56:59]
  v_mfma_f32_16x16x32_bf16 a[56:59], a[188:191], v[48:51], a[56:59]
  v_mfma_f32_16x16x32_bf16 a[60:63], a[188:191], v[56:59], a[60:63]
  v_mfma_f32_16x16x32_bf16 a[60:63], a[184:187], v[24:27], a[60:63]
  ds_read_b64_tr_b16 a[160:161], v220 offset:49152
  ds_read_b64_tr_b16 a[162:163], v220 offset:53248
  ds_read_b64_tr_b16 a[164:165], v220 offset:57344
  ds_read_b64_tr_b16 a[166:167], v220 offset:61440
  s_waitcnt lgkmcnt(2)
  v_mfma_f32_16x16x32_bf16 a[64:67], a[160:163], v[0:3], a[64:67]
  s_waitcnt lgkmcnt(0)
  v_mfma_f32_16x16x32_bf16 a[64:67], a[164:167], v[32:35], a[64:67]
  v_mfma_f32_16x16x32_bf16 a[68:71], a[164:167], v[40:43], a[68:71]
  v_mfma_f32_16x16x32_bf16 a[68:71], a[160:163], v[8:11], a[68:71]
  v_mfma_f32_16x16x32_bf16 a[72:75], a[160:163], v[16:19], a[72:75]
  v_mfma_f32_16x16x32_bf16 a[72:75], a[164:167], v[48:51], a[72:75]
  v_mfma_f32_16x16x32_bf16 a[76:79], a[164:167], v[56:59], a[76:79]
  v_mfma_f32_16x16x32_bf16 a[76:79], a[160:163], v[24:27], a[76:79]
  ds_read_b64_tr_b16 a[168:169], v221 offset:49152
  ds_read_b64_tr_b16 a[170:171], v221 offset:53248
  ds_read_b64_tr_b16 a[172:173], v221 offset:57344
  ds_read_b64_tr_b16 a[174:175], v221 offset:61440
  s_waitcnt lgkmcnt(2)
  v_mfma_f32_16x16x32_bf16 a[80:83], a[168:171], v[0:3], a[80:83]
  s_waitcnt lgkmcnt(0)
  v_mfma_f32_16x16x32_bf16 a[80:83], a[172:175], v[32:35], a[80:83]
  v_mfma_f32_16x16x32_bf16 a[84:87], a[172:175], v[40:43], a[84:87]
  v_mfma_f32_16x16x32_bf16 a[84:87], a[168:171], v[8:11], a[84:87]
  v_mfma_f32_16x16x32_bf16 a[88:91], a[168:171], v[16:19], a[88:91]
  v_mfma_f32_16x16x32_bf16 a[88:91], a[172:175], v[48:51], a[88:91]
  v_mfma_f32_16x16x32_bf16 a[92:95], a[172:175], v[56:59], a[92:95]
  v_mfma_f32_16x16x32_bf16 a[92:95], a[168:171], v[24:27], a[92:95]
  ds_read_b64_tr_b16 a[176:177], v222 offset:49152
  ds_read_b64_tr_b16 a[178:179], v222 offset:53248
  ds_read_b64_tr_b16 a[180:181], v222 offset:57344
  ds_read_b64_tr_b16 a[182:183], v222 offset:61440
  s_waitcnt lgkmcnt(2)
  v_mfma_f32_16x16x32_bf16 a[96:99], a[176:179], v[0:3], a[96:99]
  s_waitcnt lgkmcnt(0)
  v_mfma_f32_16x16x32_bf16 a[96:99], a[180:183], v[32:35], a[96:99]
  v_mfma_f32_16x16x32_bf16 a[100:103], a[180:183], v[40:43], a[100:103]
  v_mfma_f32_16x16x32_bf16 a[100:103], a[176:179], v[8:11], a[100:103]
  v_mfma_f32_16x16x32_bf16 a[104:107], a[176:179], v[16:19], a[104:107]
  v_mfma_f32_16x16x32_bf16 a[104:107], a[180:183], v[48:51], a[104:107]
  v_mfma_f32_16x16x32_bf16 a[108:111], a[180:183], v[56:59], a[108:111]
  v_mfma_f32_16x16x32_bf16 a[108:111], a[176:179], v[24:27], a[108:111]
  ds_read_b64_tr_b16 a[184:185], v223 offset:49152
  ds_read_b64_tr_b16 a[186:187], v223 offset:53248
  ds_read_b64_tr_b16 a[188:189], v223 offset:57344
  ds_read_b64_tr_b16 a[190:191], v223 offset:61440
  s_waitcnt lgkmcnt(2)
  v_mfma_f32_16x16x32_bf16 a[112:115], a[184:187], v[0:3], a[112:115]
  s_waitcnt lgkmcnt(0)
  v_mfma_f32_16x16x32_bf16 a[112:115], a[188:191], v[32:35], a[112:115]
  v_mfma_f32_16x16x32_bf16 a[116:119], a[188:191], v[40:43], a[116:119]
  v_mfma_f32_16x16x32_bf16 a[116:119], a[184:187], v[8:11], a[116:119]
  v_mfma_f32_16x16x32_bf16 a[120:123], a[184:187], v[16:19], a[120:123]
  v_mfma_f32_16x16x32_bf16 a[120:123], a[188:191], v[48:51], a[120:123]
  v_mfma_f32_16x16x32_bf16 a[124:127], a[188:191], v[56:59], a[124:127]
  v_mfma_f32_16x16x32_bf16 a[124:127], a[184:187], v[24:27], a[124:127]
  s_add_u32 s29, s29, 16384
  s_cmp_lt_u32 s29, 524288
  s_cbranch_scc1 attn_slow
  v_mov_b32 v245, v208
  v_mov_b32 v246, v209
  v_mov_b32 v247, v210
  v_mov_b32 v248, v211
  v_permlane16_swap_b32 v208, v245
  v_permlane16_swap_b32 v209, v246
  v_permlane16_swap_b32 v210, v247
  v_permlane16_swap_b32 v211, v248
  v_add_f32 v208, v208, v245
  v_add_f32 v209, v209, v246
  v_add_f32 v210, v210, v247
  v_add_f32 v211, v211, v248
  v_mov_b32 v245, v208
  v_mov_b32 v246, v209
  v_mov_b32 v247, v210
  v_mov_b32 v248, v211
  v_permlane32_swap_b32 v208, v245
  v_permlane32_swap_b32 v209, v246
  v_permlane32_swap_b32 v210, v247
  v_permlane32_swap_b32 v211, v248
  v_add_f32 v208, v208, v245
  v_add_f32 v209, v209, v246
  v_add_f32 v210, v210, v247
  v_add_f32 v211, v211, v248
  v_rcp_f32 v192, v208
  v_rcp_f32 v196, v209
  v_rcp_f32 v200, v210
  v_rcp_f32 v204, v211
  v_accvgpr_read_b32 v0, a0
  v_accvgpr_read_b32 v1, a1
  v_accvgpr_read_b32 v2, a2
  v_accvgpr_read_b32 v3, a3
  v_accvgpr_read_b32 v4, a16
  v_accvgpr_read_b32 v5, a17
  v_accvgpr_read_b32 v6, a18
  v_accvgpr_read_b32 v7, a19
  v_mul_f32 v0, v0, v192
  v_mul_f32 v1, v1, v192
  v_mul_f32 v2, v2, v192
  v_mul_f32 v3, v3, v192
  v_mul_f32 v4, v4, v192
  v_mul_f32 v5, v5, v192
  v_mul_f32 v6, v6, v192
  v_mul_f32 v7, v7, v192
  v_cvt_pk_bf16_f32 v0, v0, v1
  v_cvt_pk_bf16_f32 v1, v2, v3
  v_cvt_pk_bf16_f32 v2, v4, v5
  v_cvt_pk_bf16_f32 v3, v6, v7
  buffer_store_dwordx4 v[0:3], v244, s[24:27], s40 offen offset:0 sc1
  v_accvgpr_read_b32 v8, a4
  v_accvgpr_read_b32 v9, a5
  v_accvgpr_read_b32 v10, a6
  v_accvgpr_read_b32 v11, a7
  v_accvgpr_read_b32 v12, a20
  v_accvgpr_read_b32 v13, a21
  v_accvgpr_read_b32 v14, a22
  v_accvgpr_read_b32 v15, a23
  v_mul_f32 v8, v8, v196
  v_mul_f32 v9, v9, v196
  v_mul_f32 v10, v10, v196
  v_mul_f32 v11, v11, v196
  v_mul_f32 v12, v12, v196
  v_mul_f32 v13, v13, v196
  v_mul_f32 v14, v14, v196
  v_mul_f32 v15, v15, v196
  v_cvt_pk_bf16_f32 v8, v8, v9
  v_cvt_pk_bf16_f32 v9, v10, v11
  v_cvt_pk_bf16_f32 v10, v12, v13
  v_cvt_pk_bf16_f32 v11, v14, v15
  buffer_store_dwordx4 v[8:11], v244, s[24:27], s40 offen offset:2048 sc1
  v_accvgpr_read_b32 v16, a8
  v_accvgpr_read_b32 v17, a9
  v_accvgpr_read_b32 v18, a10
  v_accvgpr_read_b32 v19, a11
  v_accvgpr_read_b32 v20, a24
  v_accvgpr_read_b32 v21, a25
  v_accvgpr_read_b32 v22, a26
  v_accvgpr_read_b32 v23, a27
  v_mul_f32 v16, v16, v200
  v_mul_f32 v17, v17, v200
  v_mul_f32 v18, v18, v200
  v_mul_f32 v19, v19, v200
  v_mul_f32 v20, v20, v200
  v_mul_f32 v21, v21, v200
  v_mul_f32 v22, v22, v200
  v_mul_f32 v23, v23, v200
  v_cvt_pk_bf16_f32 v16, v16, v17
  v_cvt_pk_bf16_f32 v17, v18, v19
  v_cvt_pk_bf16_f32 v18, v20, v21
  v_cvt_pk_bf16_f32 v19, v22, v23
  buffer_store_dwordx4 v[16:19], v244, s[24:27], s41 offen offset:0 sc1
  v_accvgpr_read_b32 v24, a12
  v_accvgpr_read_b32 v25, a13
  v_accvgpr_read_b32 v26, a14
  v_accvgpr_read_b32 v27, a15
  v_accvgpr_read_b32 v28, a28
  v_accvgpr_read_b32 v29, a29
  v_accvgpr_read_b32 v30, a30
  v_accvgpr_read_b32 v31, a31
  v_mul_f32 v24, v24, v204
  v_mul_f32 v25, v25, v204
  v_mul_f32 v26, v26, v204
  v_mul_f32 v27, v27, v204
  v_mul_f32 v28, v28, v204
  v_mul_f32 v29, v29, v204
  v_mul_f32 v30, v30, v204
  v_mul_f32 v31, v31, v204
  v_cvt_pk_bf16_f32 v24, v24, v25
  v_cvt_pk_bf16_f32 v25, v26, v27
  v_cvt_pk_bf16_f32 v26, v28, v29
  v_cvt_pk_bf16_f32 v27, v30, v31
  buffer_store_dwordx4 v[24:27], v244, s[24:27], s41 offen offset:2048 sc1
  v_accvgpr_read_b32 v32, a32
  v_accvgpr_read_b32 v33, a33
  v_accvgpr_read_b32 v34, a34
  v_accvgpr_read_b32 v35, a35
  v_accvgpr_read_b32 v36, a48
  v_accvgpr_read_b32 v37, a49
  v_accvgpr_read_b32 v38, a50
  v_accvgpr_read_b32 v39, a51
  v_mul_f32 v32, v32, v192
  v_mul_f32 v33, v33, v192
  v_mul_f32 v34, v34, v192
  v_mul_f32 v35, v35, v192
  v_mul_f32 v36, v36, v192
  v_mul_f32 v37, v37, v192
  v_mul_f32 v38, v38, v192
  v_mul_f32 v39, v39, v192
  v_cvt_pk_bf16_f32 v32, v32, v33
  v_cvt_pk_bf16_f32 v33, v34, v35
  v_cvt_pk_bf16_f32 v34, v36, v37
  v_cvt_pk_bf16_f32 v35, v38, v39
  buffer_store_dwordx4 v[32:35], v244, s[24:27], s40 offen offset:1024 sc1
  v_accvgpr_read_b32 v40, a36
  v_accvgpr_read_b32 v41, a37
  v_accvgpr_read_b32 v42, a38
  v_accvgpr_read_b32 v43, a39
  v_accvgpr_read_b32 v44, a52
  v_accvgpr_read_b32 v45, a53
  v_accvgpr_read_b32 v46, a54
  v_accvgpr_read_b32 v47, a55
  v_mul_f32 v40, v40, v196
  v_mul_f32 v41, v41, v196
  v_mul_f32 v42, v42, v196
  v_mul_f32 v43, v43, v196
  v_mul_f32 v44, v44, v196
  v_mul_f32 v45, v45, v196
  v_mul_f32 v46, v46, v196
  v_mul_f32 v47, v47, v196
  v_cvt_pk_bf16_f32 v40, v40, v41
  v_cvt_pk_bf16_f32 v41, v42, v43
  v_cvt_pk_bf16_f32 v42, v44, v45
  v_cvt_pk_bf16_f32 v43, v46, v47
  buffer_store_dwordx4 v[40:43], v244, s[24:27], s40 offen offset:3072 sc1
  v_accvgpr_read_b32 v48, a40
  v_accvgpr_read_b32 v49, a41
  v_accvgpr_read_b32 v50, a42
  v_accvgpr_read_b32 v51, a43
  v_accvgpr_read_b32 v52, a56
  v_accvgpr_read_b32 v53, a57
  v_accvgpr_read_b32 v54, a58
  v_accvgpr_read_b32 v55, a59
  v_mul_f32 v48, v48, v200
  v_mul_f32 v49, v49, v200
  v_mul_f32 v50, v50, v200
  v_mul_f32 v51, v51, v200
  v_mul_f32 v52, v52, v200
  v_mul_f32 v53, v53, v200
  v_mul_f32 v54, v54, v200
  v_mul_f32 v55, v55, v200
  v_cvt_pk_bf16_f32 v48, v48, v49
  v_cvt_pk_bf16_f32 v49, v50, v51
  v_cvt_pk_bf16_f32 v50, v52, v53
  v_cvt_pk_bf16_f32 v51, v54, v55
  buffer_store_dwordx4 v[48:51], v244, s[24:27], s41 offen offset:1024 sc1
  v_accvgpr_read_b32 v56, a44
  v_accvgpr_read_b32 v57, a45
  v_accvgpr_read_b32 v58, a46
  v_accvgpr_read_b32 v59, a47
  v_accvgpr_read_b32 v60, a60
  v_accvgpr_read_b32 v61, a61
  v_accvgpr_read_b32 v62, a62
  v_accvgpr_read_b32 v63, a63
  v_mul_f32 v56, v56, v204
  v_mul_f32 v57, v57, v204
  v_mul_f32 v58, v58, v204
  v_mul_f32 v59, v59, v204
  v_mul_f32 v60, v60, v204
  v_mul_f32 v61, v61, v204
  v_mul_f32 v62, v62, v204
  v_mul_f32 v63, v63, v204
  v_cvt_pk_bf16_f32 v56, v56, v57
  v_cvt_pk_bf16_f32 v57, v58, v59
  v_cvt_pk_bf16_f32 v58, v60, v61
  v_cvt_pk_bf16_f32 v59, v62, v63
  buffer_store_dwordx4 v[56:59], v244, s[24:27], s41 offen offset:3072 sc1
  v_accvgpr_read_b32 v0, a64
  v_accvgpr_read_b32 v1, a65
  v_accvgpr_read_b32 v2, a66
  v_accvgpr_read_b32 v3, a67
  v_accvgpr_read_b32 v4, a80
  v_accvgpr_read_b32 v5, a81
  v_accvgpr_read_b32 v6, a82
  v_accvgpr_read_b32 v7, a83
  v_mul_f32 v0, v0, v192
  v_mul_f32 v1, v1, v192
  v_mul_f32 v2, v2, v192
  v_mul_f32 v3, v3, v192
  v_mul_f32 v4, v4, v192
  v_mul_f32 v5, v5, v192
  v_mul_f32 v6, v6, v192
  v_mul_f32 v7, v7, v192
  v_cvt_pk_bf16_f32 v0, v0, v1
  v_cvt_pk_bf16_f32 v1, v2, v3
  v_cvt_pk_bf16_f32 v2, v4, v5
  v_cvt_pk_bf16_f32 v3, v6, v7
  buffer_store_dwordx4 v[0:3], v244, s[24:27], s42 offen offset:0 sc1
  v_accvgpr_read_b32 v8, a68
  v_accvgpr_read_b32 v9, a69
  v_accvgpr_read_b32 v10, a70
  v_accvgpr_read_b32 v11, a71
  v_accvgpr_read_b32 v12, a84
  v_accvgpr_read_b32 v13, a85
  v_accvgpr_read_b32 v14, a86
  v_accvgpr_read_b32 v15, a87
  v_mul_f32 v8, v8, v196
  v_mul_f32 v9, v9, v196
  v_mul_f32 v10, v10, v196
  v_mul_f32 v11, v11, v196
  v_mul_f32 v12, v12, v196
  v_mul_f32 v13, v13, v196
  v_mul_f32 v14, v14, v196
  v_mul_f32 v15, v15, v196
  v_cvt_pk_bf16_f32 v8, v8, v9
  v_cvt_pk_bf16_f32 v9, v10, v11
  v_cvt_pk_bf16_f32 v10, v12, v13
  v_cvt_pk_bf16_f32 v11, v14, v15
  buffer_store_dwordx4 v[8:11], v244, s[24:27], s42 offen offset:2048 sc1
  v_accvgpr_read_b32 v16, a72
  v_accvgpr_read_b32 v17, a73
  v_accvgpr_read_b32 v18, a74
  v_accvgpr_read_b32 v19, a75
  v_accvgpr_read_b32 v20, a88
  v_accvgpr_read_b32 v21, a89
  v_accvgpr_read_b32 v22, a90
  v_accvgpr_read_b32 v23, a91
  v_mul_f32 v16, v16, v200
  v_mul_f32 v17, v17, v200
  v_mul_f32 v18, v18, v200
  v_mul_f32 v19, v19, v200
  v_mul_f32 v20, v20, v200
  v_mul_f32 v21, v21, v200
  v_mul_f32 v22, v22, v200
  v_mul_f32 v23, v23, v200
  v_cvt_pk_bf16_f32 v16, v16, v17
  v_cvt_pk_bf16_f32 v17, v18, v19
  v_cvt_pk_bf16_f32 v18, v20, v21
  v_cvt_pk_bf16_f32 v19, v22, v23
  buffer_store_dwordx4 v[16:19], v244, s[24:27], s43 offen offset:0 sc1
  v_accvgpr_read_b32 v24, a76
  v_accvgpr_read_b32 v25, a77
  v_accvgpr_read_b32 v26, a78
  v_accvgpr_read_b32 v27, a79
  v_accvgpr_read_b32 v28, a92
  v_accvgpr_read_b32 v29, a93
  v_accvgpr_read_b32 v30, a94
  v_accvgpr_read_b32 v31, a95
  v_mul_f32 v24, v24, v204
  v_mul_f32 v25, v25, v204
  v_mul_f32 v26, v26, v204
  v_mul_f32 v27, v27, v204
  v_mul_f32 v28, v28, v204
  v_mul_f32 v29, v29, v204
  v_mul_f32 v30, v30, v204
  v_mul_f32 v31, v31, v204
  v_cvt_pk_bf16_f32 v24, v24, v25
  v_cvt_pk_bf16_f32 v25, v26, v27
  v_cvt_pk_bf16_f32 v26, v28, v29
  v_cvt_pk_bf16_f32 v27, v30, v31
  buffer_store_dwordx4 v[24:27], v244, s[24:27], s43 offen offset:2048 sc1
  v_accvgpr_read_b32 v32, a96
  v_accvgpr_read_b32 v33, a97
  v_accvgpr_read_b32 v34, a98
  v_accvgpr_read_b32 v35, a99
  v_accvgpr_read_b32 v36, a112
  v_accvgpr_read_b32 v37, a113
  v_accvgpr_read_b32 v38, a114
  v_accvgpr_read_b32 v39, a115
  v_mul_f32 v32, v32, v192
  v_mul_f32 v33, v33, v192
  v_mul_f32 v34, v34, v192
  v_mul_f32 v35, v35, v192
  v_mul_f32 v36, v36, v192
  v_mul_f32 v37, v37, v192
  v_mul_f32 v38, v38, v192
  v_mul_f32 v39, v39, v192
  v_cvt_pk_bf16_f32 v32, v32, v33
  v_cvt_pk_bf16_f32 v33, v34, v35
  v_cvt_pk_bf16_f32 v34, v36, v37
  v_cvt_pk_bf16_f32 v35, v38, v39
  buffer_store_dwordx4 v[32:35], v244, s[24:27], s42 offen offset:1024 sc1
  v_accvgpr_read_b32 v40, a100
  v_accvgpr_read_b32 v41, a101
  v_accvgpr_read_b32 v42, a102
  v_accvgpr_read_b32 v43, a103
  v_accvgpr_read_b32 v44, a116
  v_accvgpr_read_b32 v45, a117
  v_accvgpr_read_b32 v46, a118
  v_accvgpr_read_b32 v47, a119
  v_mul_f32 v40, v40, v196
  v_mul_f32 v41, v41, v196
  v_mul_f32 v42, v42, v196
  v_mul_f32 v43, v43, v196
  v_mul_f32 v44, v44, v196
  v_mul_f32 v45, v45, v196
  v_mul_f32 v46, v46, v196
  v_mul_f32 v47, v47, v196
  v_cvt_pk_bf16_f32 v40, v40, v41
  v_cvt_pk_bf16_f32 v41, v42, v43
  v_cvt_pk_bf16_f32 v42, v44, v45
  v_cvt_pk_bf16_f32 v43, v46, v47
  buffer_store_dwordx4 v[40:43], v244, s[24:27], s42 offen offset:3072 sc1
  v_accvgpr_read_b32 v48, a104
  v_accvgpr_read_b32 v49, a105
  v_accvgpr_read_b32 v50, a106
  v_accvgpr_read_b32 v51, a107
  v_accvgpr_read_b32 v52, a120
  v_accvgpr_read_b32 v53, a121
  v_accvgpr_read_b32 v54, a122
  v_accvgpr_read_b32 v55, a123
  v_mul_f32 v48, v48, v200
  v_mul_f32 v49, v49, v200
  v_mul_f32 v50, v50, v200
  v_mul_f32 v51, v51, v200
  v_mul_f32 v52, v52, v200
  v_mul_f32 v53, v53, v200
  v_mul_f32 v54, v54, v200
  v_mul_f32 v55, v55, v200
  v_cvt_pk_bf16_f32 v48, v48, v49
  v_cvt_pk_bf16_f32 v49, v50, v51
  v_cvt_pk_bf16_f32 v50, v52, v53
  v_cvt_pk_bf16_f32 v51, v54, v55
  buffer_store_dwordx4 v[48:51], v244, s[24:27], s43 offen offset:1024 sc1
  v_accvgpr_read_b32 v56, a108
  v_accvgpr_read_b32 v57, a109
  v_accvgpr_read_b32 v58, a110
  v_accvgpr_read_b32 v59, a111
  v_accvgpr_read_b32 v60, a124
  v_accvgpr_read_b32 v61, a125
  v_accvgpr_read_b32 v62, a126
  v_accvgpr_read_b32 v63, a127
  v_mul_f32 v56, v56, v204
  v_mul_f32 v57, v57, v204
  v_mul_f32 v58, v58, v204
  v_mul_f32 v59, v59, v204
  v_mul_f32 v60, v60, v204
  v_mul_f32 v61, v61, v204
  v_mul_f32 v62, v62, v204
  v_mul_f32 v63, v63, v204
  v_cvt_pk_bf16_f32 v56, v56, v57
  v_cvt_pk_bf16_f32 v57, v58, v59
  v_cvt_pk_bf16_f32 v58, v60, v61
  v_cvt_pk_bf16_f32 v59, v62, v63
  buffer_store_dwordx4 v[56:59], v244, s[24:27], s43 offen offset:3072 sc1
  v_add_u32 v252, 4096, v242
  v_add_u32 v253, 8192, v242
  buffer_load_dwordx4 a[128:131], v253, s[24:27], s4 offen offset:3072 sc1
  buffer_load_dwordx4 a[132:135], v242, s[24:27], s5 offen offset:0 sc1
  buffer_load_dwordx4 a[136:139], v242, s[24:27], s5 offen offset:1024 sc1
  buffer_load_dwordx4 a[140:143], v242, s[24:27], s5 offen offset:2048 sc1
  buffer_load_dwordx4 a[144:147], v242, s[24:27], s5 offen offset:3072 sc1
  buffer_load_dwordx4 a[148:151], v252, s[24:27], s5 offen offset:0 sc1
  buffer_load_dwordx4 a[152:155], v252, s[24:27], s5 offen offset:1024 sc1
  buffer_load_dwordx4 a[156:159], v252, s[24:27], s5 offen offset:2048 sc1
  buffer_load_dwordx4 v[128:131], v252, s[24:27], s5 offen offset:3072 sc1
  buffer_load_dwordx4 v[132:135], v253, s[24:27], s5 offen offset:0 sc1
  buffer_load_dwordx4 v[136:139], v253, s[24:27], s5 offen offset:1024 sc1
  buffer_load_dwordx4 v[140:143], v253, s[24:27], s5 offen offset:2048 sc1
  buffer_load_dwordx4 v[144:147], v253, s[24:27], s5 offen offset:3072 sc1
  buffer_load_dwordx4 v[148:151], v242, s[24:27], s6 offen offset:0 sc1
  buffer_load_dwordx4 v[152:155], v242, s[24:27], s6 offen offset:1024 sc1
  buffer_load_dwordx4 v[156:159], v242, s[24:27], s6 offen offset:2048 sc1
  buffer_load_dwordx4 v[160:163], v242, s[24:27], s6 offen offset:3072 sc1
  buffer_load_dwordx4 v[164:167], v252, s[24:27], s6 offen offset:0 sc1
  buffer_load_dwordx4 v[168:171], v252, s[24:27], s6 offen offset:1024 sc1
  buffer_load_dwordx4 v[172:175], v252, s[24:27], s6 offen offset:2048 sc1
  buffer_load_dwordx4 v[176:179], v252, s[24:27], s6 offen offset:3072 sc1
  buffer_load_dwordx4 v[180:183], v253, s[24:27], s6 offen offset:0 sc1
  buffer_load_dwordx4 v[184:187], v253, s[24:27], s6 offen offset:1024 sc1
  buffer_load_dwordx4 v[188:191], v253, s[24:27], s6 offen offset:2048 sc1
  buffer_load_dwordx4 a[0:3], v253, s[24:27], s6 offen offset:3072 sc1
  buffer_load_dwordx4 a[4:7], v242, s[24:27], s7 offen offset:0 sc1
  buffer_load_dwordx4 a[8:11], v242, s[24:27], s7 offen offset:1024 sc1
  buffer_load_dwordx4 a[12:15], v242, s[24:27], s7 offen offset:2048 sc1
  s_lshr_b32 s39, s37, 2
  s_lshl_b32 s39, s39, 3
  s_lshr_b32 s38, s36, 2
  s_add_u32 s39, s39, s38
  s_lshl_b32 s39, s39, 7
  s_add_u32 s39, s39, 2867200
  s_lshl_b32 s38, s3, 26
  v_lshlrev_b32 v64, 22, v242
  v_or_b32 v64, s38, v64
  v_mov_b32 v65, 1
  s_waitcnt vmcnt(0)
  s_barrier
  s_branch tail_go
.section .rodata,"a"
.p2align 6
.amdhsa_kernel recurrent_scan__mha_block_cached__moe_arch_mod__prompt_kernel
  .amdhsa_next_free_vgpr 512
  .amdhsa_next_free_sgpr 102
  .amdhsa_accum_offset 256
  .amdhsa_group_segment_fixed_size 0
  .amdhsa_kernarg_size 104
  .amdhsa_user_sgpr_count 2
  .amdhsa_user_sgpr_kernarg_segment_ptr 1
  .amdhsa_system_sgpr_workgroup_id_x 1
.end_amdhsa_kernel
```

```asm
; @launch grid=(256,1,1) block=(256,1,1) lds=163840
.amdgcn_target "amdgcn-amd-amdhsa--gfx950"
.text
.globl recurrent_scan__mha_block_cached__moe_arch_mod__prompt_kernel
.p2align 8
.type recurrent_scan__mha_block_cached__moe_arch_mod__prompt_kernel,@function
recurrent_scan__mha_block_cached__moe_arch_mod__prompt_kernel:
  s_cmp_ge_u32 s2, 256
  s_cbranch_scc1 attn_end
  s_load_dwordx2 s[60:61], s[0:1], 0
  s_load_dwordx2 s[48:49], s[0:1], 48
  s_load_dwordx4 s[4:7], s[0:1], 8
  s_load_dwordx2 s[8:9], s[0:1], 24
  s_load_dwordx2 s[10:11], s[0:1], 96
  s_load_dwordx2 s[88:89], s[0:1], 32
  s_load_dwordx2 s[90:91], s[0:1], 56
  s_load_dwordx4 s[92:95], s[0:1], 64
  s_load_dwordx2 s[62:63], s[0:1], 80
  v_lshrrev_b32 v249, 6, v0
  v_and_b32 v0, 63, v0
  v_mov_b32 v245, v0
  v_readfirstlane_b32 s3, v249
  s_and_b32 s36, s2, 7
  s_lshl_b32 s36, s36, 2
  s_lshr_b32 s37, s2, 6
  s_add_u32 s36, s36, s37
  s_bfe_u32 s37, s2, 196611
  s_lshl_b32 s37, s37, 2
  s_add_u32 s37, s37, s3
  s_lshl_b32 s28, s3, 12
  v_lshrrev_b32 v248, 4, v245
  v_and_b32 v247, 15, v245
  s_lshl_b32 s38, s3, 17
  v_lshlrev_b32 v249, 13, v248
  v_add_u32 v249, s38, v249
  v_or_b32 v250, 0, v248
  v_lshlrev_b32 v250, 1, v250
  v_xor_b32 v250, v250, v247
  v_lshl_add_u32 v238, v250, 4, v249
  v_or_b32 v250, 0, v248
  v_lshlrev_b32 v250, 1, v250
  v_xor_b32 v250, v250, v247
  v_lshl_add_u32 v239, v250, 4, v249
  v_add_u32 v239, 31744, v239
  v_or_b32 v250, 4, v248
  v_lshlrev_b32 v250, 1, v250
  v_xor_b32 v250, v250, v247
  v_lshl_add_u32 v240, v250, 4, v249
  v_add_u32 v240, 63488, v240
  v_or_b32 v250, 4, v248
  v_lshlrev_b32 v250, 1, v250
  v_xor_b32 v250, v250, v247
  v_lshl_add_u32 v241, v250, 4, v249
  v_add_u32 v241, 95232, v241
  s_waitcnt lgkmcnt(0)
  s_add_u32 s58, s10, 2830336
  s_addc_u32 s59, s11, 0
  s_load_dword s59, s[58:59], 0
  s_mov_b32 s24, s10
  s_mov_b32 s25, s11
  s_mov_b32 s26, 29360128
  s_mov_b32 s27, 0x20000
  s_lshl_b32 s38, s36, 8
  s_add_u32 s20, s8, s38
  s_addc_u32 s21, s9, 0
  s_mov_b32 s22, 5242880
  s_mov_b32 s23, 0x20000
  s_sub_u32 s22, s22, s38
  s_cmp_ge_u32 s3, 2
  s_cbranch_scc1 front_fetch
  s_mov_b32 s12, s60
  s_mov_b32 s13, s61
  s_mov_b32 s14, 2621440
  s_mov_b32 s15, 0x20000
  s_mov_b32 s16, s48
  s_mov_b32 s17, s49
  s_mov_b32 s18, 1280
  s_mov_b32 s19, 0x20000
  s_lshr_b32 s52, s37, 2
  s_lshl_b32 s52, s52, 5
  s_add_u32 s52, s52, s36
  s_lshl_b32 s52, s52, 1
  s_add_u32 s52, s52, s3
  s_lshl_b32 s52, s52, 2
  s_mul_i32 s53, s52, 1280
  v_lshrrev_b32 v1, 4, v0
  v_and_b32 v2, 15, v0
  v_lshlrev_b32 v3, 4, v2
  v_mul_u32_u24 v4, 0x500, v1
  v_add_u32 v4, v4, v3
  buffer_load_dwordx4 v[8:11], v4, s[12:15], s53 offen offset:0
  buffer_load_dwordx4 v[12:15], v4, s[12:15], s53 offen offset:256
  buffer_load_dwordx4 v[16:19], v4, s[12:15], s53 offen offset:512
  buffer_load_dwordx4 v[20:23], v4, s[12:15], s53 offen offset:768
  buffer_load_dwordx4 v[24:27], v4, s[12:15], s53 offen offset:1024
  buffer_load_dwordx4 v[28:31], v3, s[16:19], 0 offen offset:0
  buffer_load_dwordx4 v[32:35], v3, s[16:19], 0 offen offset:256
  buffer_load_dwordx4 v[36:39], v3, s[16:19], 0 offen offset:512
  buffer_load_dwordx4 v[40:43], v3, s[16:19], 0 offen offset:768
  buffer_load_dwordx4 v[44:47], v3, s[16:19], 0 offen offset:1024
  v_mov_b32 v7, 0
  v_lshlrev_b32 v6, 26, v0
  s_lshl_b32 s53, s2, 7
  s_add_u32 s53, s53, 2834432
  buffer_store_dword v7, v6, s[24:27], s53 offen sc1
  v_lshlrev_b32 v6, 8, v0
  v_lshrrev_b32 v5, 5, v0
  v_lshl_add_u32 v6, v5, 26, v6
  s_cmp_eq_u32 s2, 0
  s_cselect_b32 s53, 0, 1073741824
  v_or_b32 v6, s53, v6
  s_mov_b32 s53, 2818048
  buffer_store_dword v7, v6, s[24:27], s53 offen sc1
  v_lshlrev_b32 v6, 7, v0
  s_cmp_eq_u32 s2, 1
  s_cselect_b32 s53, 0, 1073741824
  v_or_b32 v6, s53, v6
  s_mov_b32 s53, 2867200
  buffer_store_dword v7, v6, s[24:27], s53 offen sc1
  s_lshr_b32 s53, s52, 6
  s_mul_i32 s53, s53, 81920
  s_bfe_u32 s54, s52, 0x20004
  s_lshl_b32 s54, s54, 10
  s_add_u32 s53, s53, s54
  s_and_b32 s54, s52, 15
  s_lshl_b32 s54, s54, 4
  s_add_u32 s53, s53, s54
  v_lshrrev_b32 v5, 2, v2
  v_lshlrev_b32 v5, 12, v5
  v_and_b32 v6, 3, v2
  v_lshl_add_u32 v5, v6, 8, v5
  v_lshl_add_u32 v5, v1, 4, v5
  s_mov_b32 s56, 0xffff0000
  s_waitcnt vmcnt(12)
  v_lshlrev_b32 v48, 16, v8
  v_and_b32 v49, s56, v8
  v_lshlrev_b32 v50, 16, v9
  v_and_b32 v51, s56, v9
  v_lshlrev_b32 v52, 16, v10
  v_and_b32 v53, s56, v10
  v_lshlrev_b32 v54, 16, v11
  v_and_b32 v55, s56, v11
  s_waitcnt vmcnt(11)
  v_lshlrev_b32 v56, 16, v12
  v_and_b32 v57, s56, v12
  v_lshlrev_b32 v58, 16, v13
  v_and_b32 v59, s56, v13
  v_lshlrev_b32 v60, 16, v14
  v_and_b32 v61, s56, v14
  v_lshlrev_b32 v62, 16, v15
  v_and_b32 v63, s56, v15
  s_waitcnt vmcnt(10)
  v_lshlrev_b32 v64, 16, v16
  v_and_b32 v65, s56, v16
  v_lshlrev_b32 v66, 16, v17
  v_and_b32 v67, s56, v17
  v_lshlrev_b32 v68, 16, v18
  v_and_b32 v69, s56, v18
  v_lshlrev_b32 v70, 16, v19
  v_and_b32 v71, s56, v19
  s_waitcnt vmcnt(9)
  v_lshlrev_b32 v72, 16, v20
  v_and_b32 v73, s56, v20
  v_lshlrev_b32 v74, 16, v21
  v_and_b32 v75, s56, v21
  v_lshlrev_b32 v76, 16, v22
  v_and_b32 v77, s56, v22
  v_lshlrev_b32 v78, 16, v23
  v_and_b32 v79, s56, v23
  s_waitcnt vmcnt(8)
  v_lshlrev_b32 v80, 16, v24
  v_and_b32 v81, s56, v24
  v_lshlrev_b32 v82, 16, v25
  v_and_b32 v83, s56, v25
  v_lshlrev_b32 v84, 16, v26
  v_and_b32 v85, s56, v26
  v_lshlrev_b32 v86, 16, v27
  v_and_b32 v87, s56, v27
  v_pk_add_f32 v[88:89], v[48:49], v[50:51]
  v_pk_add_f32 v[90:91], v[52:53], v[54:55]
  v_pk_add_f32 v[88:89], v[88:89], v[56:57]
  v_pk_add_f32 v[90:91], v[90:91], v[58:59]
  v_pk_add_f32 v[88:89], v[88:89], v[60:61]
  v_pk_add_f32 v[90:91], v[90:91], v[62:63]
  v_pk_add_f32 v[88:89], v[88:89], v[64:65]
  v_pk_add_f32 v[90:91], v[90:91], v[66:67]
  v_pk_add_f32 v[88:89], v[88:89], v[68:69]
  v_pk_add_f32 v[90:91], v[90:91], v[70:71]
  v_pk_add_f32 v[88:89], v[88:89], v[72:73]
  v_pk_add_f32 v[90:91], v[90:91], v[74:75]
  v_pk_add_f32 v[88:89], v[88:89], v[76:77]
  v_pk_add_f32 v[90:91], v[90:91], v[78:79]
  v_pk_add_f32 v[88:89], v[88:89], v[80:81]
  v_pk_add_f32 v[90:91], v[90:91], v[82:83]
  v_pk_add_f32 v[88:89], v[88:89], v[84:85]
  v_pk_add_f32 v[90:91], v[90:91], v[86:87]
  v_pk_add_f32 v[88:89], v[88:89], v[90:91]
  v_add_f32 v92, v88, v89
  s_nop 1
  v_add_f32_dpp v92, v92, v92 row_ror:8 row_mask:0xf bank_mask:0xf
  s_nop 1
  v_add_f32_dpp v92, v92, v92 row_ror:4 row_mask:0xf bank_mask:0xf
  s_nop 1
  v_add_f32_dpp v92, v92, v92 row_ror:2 row_mask:0xf bank_mask:0xf
  s_nop 1
  v_add_f32_dpp v92, v92, v92 row_ror:1 row_mask:0xf bank_mask:0xf
  v_mul_f32 v92, 0x3acccccd, v92
  v_pk_add_f32 v[94:95], v[48:49], v[92:93] op_sel_hi:[1,0] neg_lo:[0,1] neg_hi:[0,1]
  v_pk_mul_f32 v[88:89], v[94:95], v[94:95]
  v_pk_add_f32 v[96:97], v[50:51], v[92:93] op_sel_hi:[1,0] neg_lo:[0,1] neg_hi:[0,1]
  v_pk_mul_f32 v[90:91], v[96:97], v[96:97]
  v_pk_add_f32 v[94:95], v[52:53], v[92:93] op_sel_hi:[1,0] neg_lo:[0,1] neg_hi:[0,1]
  v_pk_fma_f32 v[88:89], v[94:95], v[94:95], v[88:89]
  v_pk_add_f32 v[96:97], v[54:55], v[92:93] op_sel_hi:[1,0] neg_lo:[0,1] neg_hi:[0,1]
  v_pk_fma_f32 v[90:91], v[96:97], v[96:97], v[90:91]
  v_pk_add_f32 v[94:95], v[56:57], v[92:93] op_sel_hi:[1,0] neg_lo:[0,1] neg_hi:[0,1]
  v_pk_fma_f32 v[88:89], v[94:95], v[94:95], v[88:89]
  v_pk_add_f32 v[96:97], v[58:59], v[92:93] op_sel_hi:[1,0] neg_lo:[0,1] neg_hi:[0,1]
  v_pk_fma_f32 v[90:91], v[96:97], v[96:97], v[90:91]
  v_pk_add_f32 v[94:95], v[60:61], v[92:93] op_sel_hi:[1,0] neg_lo:[0,1] neg_hi:[0,1]
  v_pk_fma_f32 v[88:89], v[94:95], v[94:95], v[88:89]
  v_pk_add_f32 v[96:97], v[62:63], v[92:93] op_sel_hi:[1,0] neg_lo:[0,1] neg_hi:[0,1]
  v_pk_fma_f32 v[90:91], v[96:97], v[96:97], v[90:91]
  v_pk_add_f32 v[94:95], v[64:65], v[92:93] op_sel_hi:[1,0] neg_lo:[0,1] neg_hi:[0,1]
  v_pk_fma_f32 v[88:89], v[94:95], v[94:95], v[88:89]
  v_pk_add_f32 v[96:97], v[66:67], v[92:93] op_sel_hi:[1,0] neg_lo:[0,1] neg_hi:[0,1]
  v_pk_fma_f32 v[90:91], v[96:97], v[96:97], v[90:91]
  v_pk_add_f32 v[94:95], v[68:69], v[92:93] op_sel_hi:[1,0] neg_lo:[0,1] neg_hi:[0,1]
  v_pk_fma_f32 v[88:89], v[94:95], v[94:95], v[88:89]
  v_pk_add_f32 v[96:97], v[70:71], v[92:93] op_sel_hi:[1,0] neg_lo:[0,1] neg_hi:[0,1]
  v_pk_fma_f32 v[90:91], v[96:97], v[96:97], v[90:91]
  v_pk_add_f32 v[94:95], v[72:73], v[92:93] op_sel_hi:[1,0] neg_lo:[0,1] neg_hi:[0,1]
  v_pk_fma_f32 v[88:89], v[94:95], v[94:95], v[88:89]
  v_pk_add_f32 v[96:97], v[74:75], v[92:93] op_sel_hi:[1,0] neg_lo:[0,1] neg_hi:[0,1]
  v_pk_fma_f32 v[90:91], v[96:97], v[96:97], v[90:91]
  v_pk_add_f32 v[94:95], v[76:77], v[92:93] op_sel_hi:[1,0] neg_lo:[0,1] neg_hi:[0,1]
  v_pk_fma_f32 v[88:89], v[94:95], v[94:95], v[88:89]
  v_pk_add_f32 v[96:97], v[78:79], v[92:93] op_sel_hi:[1,0] neg_lo:[0,1] neg_hi:[0,1]
  v_pk_fma_f32 v[90:91], v[96:97], v[96:97], v[90:91]
  v_pk_add_f32 v[94:95], v[80:81], v[92:93] op_sel_hi:[1,0] neg_lo:[0,1] neg_hi:[0,1]
  v_pk_fma_f32 v[88:89], v[94:95], v[94:95], v[88:89]
  v_pk_add_f32 v[96:97], v[82:83], v[92:93] op_sel_hi:[1,0] neg_lo:[0,1] neg_hi:[0,1]
  v_pk_fma_f32 v[90:91], v[96:97], v[96:97], v[90:91]
  v_pk_add_f32 v[94:95], v[84:85], v[92:93] op_sel_hi:[1,0] neg_lo:[0,1] neg_hi:[0,1]
  v_pk_fma_f32 v[88:89], v[94:95], v[94:95], v[88:89]
  v_pk_add_f32 v[96:97], v[86:87], v[92:93] op_sel_hi:[1,0] neg_lo:[0,1] neg_hi:[0,1]
  v_pk_fma_f32 v[90:91], v[96:97], v[96:97], v[90:91]
  v_pk_add_f32 v[88:89], v[88:89], v[90:91]
  v_add_f32 v98, v88, v89
  s_nop 1
  v_add_f32_dpp v98, v98, v98 row_ror:8 row_mask:0xf bank_mask:0xf
  v_cvt_pk_bf16_f32 v92, v92, v92
  s_nop 0
  v_add_f32_dpp v98, v98, v98 row_ror:4 row_mask:0xf bank_mask:0xf
  v_lshlrev_b32 v92, 16, v92
  s_nop 0
  v_add_f32_dpp v98, v98, v98 row_ror:2 row_mask:0xf bank_mask:0xf
  s_nop 1
  v_add_f32_dpp v98, v98, v98 row_ror:1 row_mask:0xf bank_mask:0xf
  v_mul_f32 v98, 0x3acccccd, v98
  v_cvt_pk_bf16_f32 v98, v98, v98
  v_pk_add_f32 v[48:49], v[48:49], v[92:93] op_sel_hi:[1,0] neg_lo:[0,1] neg_hi:[0,1]
  v_lshlrev_b32 v98, 16, v98
  v_pk_add_f32 v[50:51], v[50:51], v[92:93] op_sel_hi:[1,0] neg_lo:[0,1] neg_hi:[0,1]
  v_add_f32 v98, 0x3727c5ac, v98
  v_pk_add_f32 v[52:53], v[52:53], v[92:93] op_sel_hi:[1,0] neg_lo:[0,1] neg_hi:[0,1]
  v_cvt_pk_bf16_f32 v98, v98, v98
  v_pk_add_f32 v[54:55], v[54:55], v[92:93] op_sel_hi:[1,0] neg_lo:[0,1] neg_hi:[0,1]
  v_lshlrev_b32 v98, 16, v98
  v_pk_add_f32 v[56:57], v[56:57], v[92:93] op_sel_hi:[1,0] neg_lo:[0,1] neg_hi:[0,1]
  v_sqrt_f32 v98, v98
  v_pk_add_f32 v[58:59], v[58:59], v[92:93] op_sel_hi:[1,0] neg_lo:[0,1] neg_hi:[0,1]
  v_cvt_pk_bf16_f32 v98, v98, v98
  v_pk_add_f32 v[60:61], v[60:61], v[92:93] op_sel_hi:[1,0] neg_lo:[0,1] neg_hi:[0,1]
  v_lshlrev_b32 v98, 16, v98
  v_pk_add_f32 v[62:63], v[62:63], v[92:93] op_sel_hi:[1,0] neg_lo:[0,1] neg_hi:[0,1]
  v_rcp_f32 v100, v98
  v_pk_add_f32 v[64:65], v[64:65], v[92:93] op_sel_hi:[1,0] neg_lo:[0,1] neg_hi:[0,1]
  v_pk_add_f32 v[66:67], v[66:67], v[92:93] op_sel_hi:[1,0] neg_lo:[0,1] neg_hi:[0,1]
  v_pk_add_f32 v[68:69], v[68:69], v[92:93] op_sel_hi:[1,0] neg_lo:[0,1] neg_hi:[0,1]
  v_pk_add_f32 v[70:71], v[70:71], v[92:93] op_sel_hi:[1,0] neg_lo:[0,1] neg_hi:[0,1]
  v_pk_add_f32 v[72:73], v[72:73], v[92:93] op_sel_hi:[1,0] neg_lo:[0,1] neg_hi:[0,1]
  v_pk_add_f32 v[74:75], v[74:75], v[92:93] op_sel_hi:[1,0] neg_lo:[0,1] neg_hi:[0,1]
  v_pk_add_f32 v[76:77], v[76:77], v[92:93] op_sel_hi:[1,0] neg_lo:[0,1] neg_hi:[0,1]
  v_pk_add_f32 v[78:79], v[78:79], v[92:93] op_sel_hi:[1,0] neg_lo:[0,1] neg_hi:[0,1]
  v_pk_add_f32 v[80:81], v[80:81], v[92:93] op_sel_hi:[1,0] neg_lo:[0,1] neg_hi:[0,1]
  v_pk_add_f32 v[82:83], v[82:83], v[92:93] op_sel_hi:[1,0] neg_lo:[0,1] neg_hi:[0,1]
  v_pk_add_f32 v[84:85], v[84:85], v[92:93] op_sel_hi:[1,0] neg_lo:[0,1] neg_hi:[0,1]
  v_pk_add_f32 v[86:87], v[86:87], v[92:93] op_sel_hi:[1,0] neg_lo:[0,1] neg_hi:[0,1]
  v_mov_b32 v104, 0
  v_mov_b32 v105, 0
  v_cvt_pk_bf16_f32 v8, v48, v49
  v_cvt_pk_bf16_f32 v9, v50, v51
  v_cvt_pk_bf16_f32 v10, v52, v53
  v_cvt_pk_bf16_f32 v11, v54, v55
  v_cvt_pk_bf16_f32 v12, v56, v57
  v_cvt_pk_bf16_f32 v13, v58, v59
  v_cvt_pk_bf16_f32 v14, v60, v61
  v_cvt_pk_bf16_f32 v15, v62, v63
  v_cvt_pk_bf16_f32 v16, v64, v65
  v_cvt_pk_bf16_f32 v17, v66, v67
  v_cvt_pk_bf16_f32 v18, v68, v69
  v_cvt_pk_bf16_f32 v19, v70, v71
  v_cvt_pk_bf16_f32 v20, v72, v73
  v_cvt_pk_bf16_f32 v21, v74, v75
  v_cvt_pk_bf16_f32 v22, v76, v77
  v_cvt_pk_bf16_f32 v23, v78, v79
  v_cvt_pk_bf16_f32 v24, v80, v81
  v_cvt_pk_bf16_f32 v25, v82, v83
  v_cvt_pk_bf16_f32 v26, v84, v85
  v_cvt_pk_bf16_f32 v27, v86, v87
  v_lshlrev_b32 v48, 16, v8
  v_and_b32 v49, s56, v8
  v_lshlrev_b32 v50, 16, v9
  v_and_b32 v51, s56, v9
  v_lshlrev_b32 v52, 16, v10
  v_and_b32 v53, s56, v10
  v_lshlrev_b32 v54, 16, v11
  v_and_b32 v55, s56, v11
  v_lshlrev_b32 v56, 16, v12
  v_and_b32 v57, s56, v12
  v_lshlrev_b32 v58, 16, v13
  v_and_b32 v59, s56, v13
  v_lshlrev_b32 v60, 16, v14
  v_and_b32 v61, s56, v14
  v_lshlrev_b32 v62, 16, v15
  v_and_b32 v63, s56, v15
  v_lshlrev_b32 v64, 16, v16
  v_and_b32 v65, s56, v16
  v_lshlrev_b32 v66, 16, v17
  v_and_b32 v67, s56, v17
  v_lshlrev_b32 v68, 16, v18
  v_and_b32 v69, s56, v18
  v_lshlrev_b32 v70, 16, v19
  v_and_b32 v71, s56, v19
  v_lshlrev_b32 v72, 16, v20
  v_and_b32 v73, s56, v20
  v_lshlrev_b32 v74, 16, v21
  v_and_b32 v75, s56, v21
  v_lshlrev_b32 v76, 16, v22
  v_and_b32 v77, s56, v22
  v_lshlrev_b32 v78, 16, v23
  v_and_b32 v79, s56, v23
  v_lshlrev_b32 v80, 16, v24
  v_and_b32 v81, s56, v24
  v_lshlrev_b32 v82, 16, v25
  v_and_b32 v83, s56, v25
  v_lshlrev_b32 v84, 16, v26
  v_and_b32 v85, s56, v26
  v_lshlrev_b32 v86, 16, v27
  v_and_b32 v87, s56, v27
  v_pk_mul_f32 v[48:49], v[48:49], v[100:101] op_sel_hi:[1,0]
  v_pk_mul_f32 v[50:51], v[50:51], v[100:101] op_sel_hi:[1,0]
  v_pk_mul_f32 v[52:53], v[52:53], v[100:101] op_sel_hi:[1,0]
  v_pk_mul_f32 v[54:55], v[54:55], v[100:101] op_sel_hi:[1,0]
  v_cvt_pk_bf16_f32 v8, v48, v49
  v_cvt_pk_bf16_f32 v9, v50, v51
  v_cvt_pk_bf16_f32 v10, v52, v53
  v_cvt_pk_bf16_f32 v11, v54, v55
  buffer_store_dwordx4 v[8:11], v5, s[24:27], s53 offen sc1
  s_add_u32 s53, s53, 16384
  v_pk_mul_f32 v[56:57], v[56:57], v[100:101] op_sel_hi:[1,0]
  v_pk_mul_f32 v[58:59], v[58:59], v[100:101] op_sel_hi:[1,0]
  v_pk_mul_f32 v[60:61], v[60:61], v[100:101] op_sel_hi:[1,0]
  v_pk_mul_f32 v[62:63], v[62:63], v[100:101] op_sel_hi:[1,0]
  v_cvt_pk_bf16_f32 v12, v56, v57
  v_cvt_pk_bf16_f32 v13, v58, v59
  v_cvt_pk_bf16_f32 v14, v60, v61
  v_cvt_pk_bf16_f32 v15, v62, v63
  buffer_store_dwordx4 v[12:15], v5, s[24:27], s53 offen sc1
  s_add_u32 s53, s53, 16384
  v_pk_mul_f32 v[64:65], v[64:65], v[100:101] op_sel_hi:[1,0]
  v_pk_mul_f32 v[66:67], v[66:67], v[100:101] op_sel_hi:[1,0]
  v_pk_mul_f32 v[68:69], v[68:69], v[100:101] op_sel_hi:[1,0]
  v_pk_mul_f32 v[70:71], v[70:71], v[100:101] op_sel_hi:[1,0]
  v_cvt_pk_bf16_f32 v16, v64, v65
  v_cvt_pk_bf16_f32 v17, v66, v67
  v_cvt_pk_bf16_f32 v18, v68, v69
  v_cvt_pk_bf16_f32 v19, v70, v71
  buffer_store_dwordx4 v[16:19], v5, s[24:27], s53 offen sc1
  s_add_u32 s53, s53, 16384
  v_pk_mul_f32 v[72:73], v[72:73], v[100:101] op_sel_hi:[1,0]
  v_pk_mul_f32 v[74:75], v[74:75], v[100:101] op_sel_hi:[1,0]
  v_pk_mul_f32 v[76:77], v[76:77], v[100:101] op_sel_hi:[1,0]
  v_pk_mul_f32 v[78:79], v[78:79], v[100:101] op_sel_hi:[1,0]
  v_cvt_pk_bf16_f32 v20, v72, v73
  v_cvt_pk_bf16_f32 v21, v74, v75
  v_cvt_pk_bf16_f32 v22, v76, v77
  v_cvt_pk_bf16_f32 v23, v78, v79
  buffer_store_dwordx4 v[20:23], v5, s[24:27], s53 offen sc1
  s_add_u32 s53, s53, 16384
  v_pk_mul_f32 v[80:81], v[80:81], v[100:101] op_sel_hi:[1,0]
  v_pk_mul_f32 v[82:83], v[82:83], v[100:101] op_sel_hi:[1,0]
  v_pk_mul_f32 v[84:85], v[84:85], v[100:101] op_sel_hi:[1,0]
  v_pk_mul_f32 v[86:87], v[86:87], v[100:101] op_sel_hi:[1,0]
  v_cvt_pk_bf16_f32 v24, v80, v81
  v_cvt_pk_bf16_f32 v25, v82, v83
  v_cvt_pk_bf16_f32 v26, v84, v85
  v_cvt_pk_bf16_f32 v27, v86, v87
  buffer_store_dwordx4 v[24:27], v5, s[24:27], s53 offen sc1
  s_add_u32 s53, s53, 16384
  s_waitcnt vmcnt(12)
  v_dot2_f32_bf16 v104, v8, v28, v104
  v_dot2_f32_bf16 v105, v9, v29, v105
  v_dot2_f32_bf16 v104, v10, v30, v104
  v_dot2_f32_bf16 v105, v11, v31, v105
  s_waitcnt vmcnt(11)
  v_dot2_f32_bf16 v104, v12, v32, v104
  v_dot2_f32_bf16 v105, v13, v33, v105
  v_dot2_f32_bf16 v104, v14, v34, v104
  v_dot2_f32_bf16 v105, v15, v35, v105
  s_waitcnt vmcnt(10)
  v_dot2_f32_bf16 v104, v16, v36, v104
  v_dot2_f32_bf16 v105, v17, v37, v105
  v_dot2_f32_bf16 v104, v18, v38, v104
  v_dot2_f32_bf16 v105, v19, v39, v105
  s_waitcnt vmcnt(9)
  v_dot2_f32_bf16 v104, v20, v40, v104
  v_dot2_f32_bf16 v105, v21, v41, v105
  v_dot2_f32_bf16 v104, v22, v42, v104
  v_dot2_f32_bf16 v105, v23, v43, v105
  s_waitcnt vmcnt(8)
  v_dot2_f32_bf16 v104, v24, v44, v104
  v_dot2_f32_bf16 v105, v25, v45, v105
  v_dot2_f32_bf16 v104, v26, v46, v104
  v_dot2_f32_bf16 v105, v27, v47, v105
  s_nop 2
  v_add_f32 v104, v104, v105
  s_nop 1
  v_add_f32_dpp v104, v104, v104 row_ror:8 row_mask:0xf bank_mask:0xf
  s_nop 1
  v_add_f32_dpp v104, v104, v104 row_ror:4 row_mask:0xf bank_mask:0xf
  s_nop 1
  v_add_f32_dpp v104, v104, v104 row_ror:2 row_mask:0xf bank_mask:0xf
  s_nop 1
  v_add_f32_dpp v104, v104, v104 row_ror:1 row_mask:0xf bank_mask:0xf
  v_cvt_pk_bf16_f32 v104, v104, v104
  v_lshlrev_b32 v104, 16, v104
  v_ashrrev_i32 v105, 31, v104
  v_or_b32 v105, 0x80000000, v105
  v_xor_b32 v104, v104, v105
  v_and_b32 v104, s56, v104
  v_add_u32 v6, s52, v1
  v_sub_u32 v7, 0xffff, v6
  v_or_b32 v104, v104, v7
  v_lshlrev_b32 v6, 2, v6
  v_lshl_add_u32 v6, v2, 26, v6
  s_mov_b32 s53, 2621440
  buffer_store_dword v104, v6, s[24:27], s53 offen sc1
  s_waitcnt vmcnt(0)
  s_branch front_join
front_fetch:
  s_getpc_b64 s[98:99]
attn_hot_pc:
  s_add_u32 s98, s98, attn_hot-attn_hot_pc
  s_addc_u32 s99, s99, 0
  s_lshr_b32 s100, s2, 3
  v_min_u32 v249, 17, v0
  v_lshlrev_b32 v249, 5, v249
  v_add_u32 v249, s100, v249
  v_lshlrev_b32 v249, 7, v249
  v_min_u32 v249, attn_end-attn_hot-4, v249
  global_load_dword v255, v249, s[98:99]
attn_hot:
  v_subrev_u32 v16, 0x40000, v238
  v_subrev_u32 v17, 0x40000, v239
  v_subrev_u32 v18, 0x40000, v240
  v_subrev_u32 v19, 0x40000, v241
  s_mov_b32 s31, 0
  s_add_u32 m0, s28, 90112
  s_nop 0
  buffer_load_dwordx4 v16, s[20:23], s31 offen offset:0 lds
  buffer_load_dwordx4 v17, s[20:23], s31 offen offset:1024 lds
  buffer_load_dwordx4 v18, s[20:23], s31 offen offset:2048 lds
  buffer_load_dwordx4 v19, s[20:23], s31 offen offset:3072 lds
  s_add_u32 m0, s28, 98304
  s_nop 0
  buffer_load_dwordx4 v238, s[20:23], s31 offen offset:0 lds
  buffer_load_dwordx4 v239, s[20:23], s31 offen offset:1024 lds
  buffer_load_dwordx4 v240, s[20:23], s31 offen offset:2048 lds
  buffer_load_dwordx4 v241, s[20:23], s31 offen offset:3072 lds
front_join:
  s_waitcnt lgkmcnt(0)
  s_barrier
  s_mul_i32 s55, s59, 0x9e3779b1
  s_add_u32 s55, s55, 0x7f4a7c15
  s_lshr_b32 s58, s37, 2
  s_lshl_b32 s58, s58, 8
  s_add_u32 s58, s58, 2826240
  s_lshl_b32 s53, s36, 2
  s_lshl_b32 s54, s3, 26
  s_add_u32 s53, s53, s54
  v_min_u32 v1, 1, v0
  v_lshlrev_b32 v1, 28, v1
  v_add_u32 v1, s53, v1
  v_mov_b32 v2, s55
  buffer_store_dword v2, v1, s[24:27], s58 offen sc1
  s_cmp_lt_u32 s3, 2
  s_cbranch_scc1 front_addr
  s_mov_b32 s31, 524288
  s_add_u32 m0, s28, 106496
  s_nop 0
  buffer_load_dwordx4 v16, s[20:23], s31 offen offset:0 lds
  buffer_load_dwordx4 v17, s[20:23], s31 offen offset:1024 lds
  buffer_load_dwordx4 v18, s[20:23], s31 offen offset:2048 lds
  buffer_load_dwordx4 v19, s[20:23], s31 offen offset:3072 lds
  s_add_u32 m0, s28, 114688
  s_nop 0
  buffer_load_dwordx4 v238, s[20:23], s31 offen offset:0 lds
  buffer_load_dwordx4 v239, s[20:23], s31 offen offset:1024 lds
  buffer_load_dwordx4 v240, s[20:23], s31 offen offset:2048 lds
  buffer_load_dwordx4 v241, s[20:23], s31 offen offset:3072 lds
  s_mov_b32 s31, 1048576
  s_add_u32 m0, s28, 24576
  s_nop 0
  buffer_load_dwordx4 v16, s[20:23], s31 offen offset:0 lds
  buffer_load_dwordx4 v17, s[20:23], s31 offen offset:1024 lds
  buffer_load_dwordx4 v18, s[20:23], s31 offen offset:2048 lds
  buffer_load_dwordx4 v19, s[20:23], s31 offen offset:3072 lds
  s_add_u32 m0, s28, 32768
  s_nop 0
  buffer_load_dwordx4 v238, s[20:23], s31 offen offset:0 lds
  buffer_load_dwordx4 v239, s[20:23], s31 offen offset:1024 lds
  buffer_load_dwordx4 v240, s[20:23], s31 offen offset:2048 lds
  buffer_load_dwordx4 v241, s[20:23], s31 offen offset:3072 lds
  s_mov_b32 s31, 1572864
  s_add_u32 m0, s28, 40960
  s_nop 0
  buffer_load_dwordx4 v16, s[20:23], s31 offen offset:0 lds
  buffer_load_dwordx4 v17, s[20:23], s31 offen offset:1024 lds
  buffer_load_dwordx4 v18, s[20:23], s31 offen offset:2048 lds
  buffer_load_dwordx4 v19, s[20:23], s31 offen offset:3072 lds
  s_add_u32 m0, s28, 49152
  s_nop 0
  buffer_load_dwordx4 v238, s[20:23], s31 offen offset:0 lds
  buffer_load_dwordx4 v239, s[20:23], s31 offen offset:1024 lds
  buffer_load_dwordx4 v240, s[20:23], s31 offen offset:2048 lds
  buffer_load_dwordx4 v241, s[20:23], s31 offen offset:3072 lds
front_addr:
  s_mov_b32 s31, 2097152
  v_lshlrev_b32 v242, 4, v245
  v_add_u32 v243, 0x1000, v242
  s_mul_i32 s30, s37, 81920
  s_lshl_b32 s38, s36, 19
  s_add_u32 s12, s4, s38
  s_addc_u32 s13, s5, 0
  s_mov_b32 s14, 524288
  s_mov_b32 s15, 0x20000
  s_add_u32 s16, s6, s38
  s_addc_u32 s17, s7, 0
  s_mov_b32 s18, 524288
  s_mov_b32 s19, 0x20000
  v_lshlrev_b32 v249, 8, v248
  v_add_u32 v249, s28, v249
  v_add_u32 v250, 0, v248
  v_xor_b32 v250, v250, v247
  v_lshl_add_u32 v232, v250, 4, v249
  v_add_u32 v250, 4, v248
  v_xor_b32 v250, v250, v247
  v_lshl_add_u32 v233, v250, 4, v249
  v_add_u32 v250, 8, v248
  v_xor_b32 v250, v250, v247
  v_lshl_add_u32 v234, v250, 4, v249
  v_add_u32 v250, 12, v248
  v_xor_b32 v250, v250, v247
  v_lshl_add_u32 v235, v250, 4, v249
  v_add_u32 v250, 0, v248
  v_lshlrev_b32 v250, 1, v250
  v_xor_b32 v250, v250, v247
  v_lshl_add_u32 v236, v250, 4, v249
  v_add_u32 v250, 4, v248
  v_lshlrev_b32 v250, 1, v250
  v_xor_b32 v250, v250, v247
  v_lshl_add_u32 v237, v250, 4, v249
  v_lshrrev_b32 v249, 1, v248
  v_and_b32 v250, 1, v248
  v_lshl_or_b32 v249, v250, 1, v249
  v_xor_b32 v249, v249, v247
  v_lshlrev_b32 v249, 4, v249
  v_lshl_add_u32 v212, v247, 8, v249
  v_xor_b32 v213, 64, v212
  v_xor_b32 v214, 128, v212
  v_xor_b32 v215, 192, v212
  v_bfe_u32 v246, v245, 2, 2
  v_and_b32 v247, 3, v245
  v_lshlrev_b32 v247, 3, v247
  v_add_u32 v247, 65536, v247
  v_lshl_add_u32 v249, v248, 3, v246
  v_and_b32 v250, 1, v248
  v_lshl_add_u32 v250, v250, 2, v246
  v_lshl_add_u32 v250, v250, 5, v247
  v_lshl_add_u32 v224, v249, 8, v250
  v_xor_b32 v225, 32, v224
  v_xor_b32 v226, 64, v224
  v_xor_b32 v227, 96, v224
  v_xor_b32 v228, 128, v224
  v_xor_b32 v229, 160, v224
  v_xor_b32 v230, 192, v224
  v_xor_b32 v231, 224, v224
  v_lshl_add_u32 v249, v248, 2, v246
  v_and_b32 v250, 7, v249
  v_lshl_add_u32 v250, v250, 5, v247
  v_lshl_add_u32 v216, v249, 8, v250
  v_xor_b32 v217, 32, v216
  v_xor_b32 v218, 64, v216
  v_xor_b32 v219, 96, v216
  v_xor_b32 v220, 128, v216
  v_xor_b32 v221, 160, v216
  v_xor_b32 v222, 192, v216
  v_xor_b32 v223, 224, v216
  v_subrev_u32 v148, 65536, v224
  v_subrev_u32 v149, 65536, v225
  v_subrev_u32 v150, 65536, v226
  v_subrev_u32 v151, 65536, v227
  v_subrev_u32 v152, 65536, v228
  v_subrev_u32 v153, 65536, v229
  v_subrev_u32 v154, 65536, v230
  v_subrev_u32 v155, 65536, v231
  s_lshr_b32 s38, s2, 3
  s_min_u32 s38, s38, 26
  s_and_b32 s39, s2, 7
  s_mul_i32 s39, s39, 27
  s_add_u32 s33, s38, s39
  s_mul_i32 s50, s3, 6144
  s_add_u32 s50, s50, 133120
  v_mov_b32 v244, v242
  s_lshl_b32 s40, s37, 19
  s_lshl_b32 s38, s36, 14
  s_add_u32 s40, s40, s38
  s_add_u32 s40, s40, 8388608
  s_add_u32 s41, s40, 4096
  s_add_u32 s42, s40, 8192
  s_add_u32 s43, s40, 12288
  s_mov_b32 s34, 0x3e0293ee
  s_mov_b32 s29, 0
  v_and_b32 v249, 3, v245
  v_cmp_eq_u32 vcc, 0, v249
  v_mov_b32 v249, 0x3f803f80
  s_nop 0
  v_cndmask_b32 v249, 0, v249, vcc
  v_accvgpr_write_b32 a208, v249
  v_accvgpr_write_b32 a209, v249
  v_accvgpr_write_b32 a210, v249
  v_accvgpr_write_b32 a211, v249
  v_and_b32 v2, 7, v0
  v_lshlrev_b32 v2, 2, v2
  s_lshl_b32 s54, s3, 5
  v_add_u32 v2, s54, v2
  s_mov_b32 s54, 32768
  buffer_load_dword v3, v2, s[24:27], s58 offen sc1
  s_sleep 2
  buffer_load_dword v4, v2, s[24:27], s58 offen sc1
  s_sleep 2
  buffer_load_dword v5, v2, s[24:27], s58 offen sc1
  s_sleep 2
front_poll:
  buffer_load_dword v6, v2, s[24:27], s58 offen sc1
  s_waitcnt vmcnt(3)
  v_cmp_ne_u32 vcc, s55, v3
  s_nop 0
  s_cbranch_vccz front_go
  s_sleep 2
  buffer_load_dword v3, v2, s[24:27], s58 offen sc1
  s_waitcnt vmcnt(3)
  v_cmp_ne_u32 vcc, s55, v4
  s_nop 0
  s_cbranch_vccz front_go
  s_sleep 2
  buffer_load_dword v4, v2, s[24:27], s58 offen sc1
  s_waitcnt vmcnt(3)
  v_cmp_ne_u32 vcc, s55, v5
  s_nop 0
  s_cbranch_vccz front_go
  s_sleep 2
  buffer_load_dword v5, v2, s[24:27], s58 offen sc1
  s_waitcnt vmcnt(3)
  v_cmp_ne_u32 vcc, s55, v6
  s_nop 0
  s_cbranch_vccz front_go
  s_sleep 2
  s_sub_u32 s54, s54, 1
  s_cmp_lg_u32 s54, 0
  s_cbranch_scc1 front_poll
front_go:
  buffer_load_dwordx4 a[0:3], v242, s[24:27], s30 offen offset:0 sc1
  buffer_load_dwordx4 a[4:7], v242, s[24:27], s30 offen offset:1024 sc1
  buffer_load_dwordx4 a[8:11], v242, s[24:27], s30 offen offset:2048 sc1
  buffer_load_dwordx4 a[12:15], v242, s[24:27], s30 offen offset:3072 sc1
  buffer_load_dwordx4 a[16:19], v243, s[24:27], s30 offen offset:0 sc1
  buffer_load_dwordx4 a[20:23], v243, s[24:27], s30 offen offset:1024 sc1
  buffer_load_dwordx4 a[24:27], v243, s[24:27], s30 offen offset:2048 sc1
  buffer_load_dwordx4 a[28:31], v243, s[24:27], s30 offen offset:3072 sc1
  s_add_u32 s30, s30, 8192
  buffer_load_dwordx4 a[32:35], v242, s[24:27], s30 offen offset:0 sc1
  buffer_load_dwordx4 a[36:39], v242, s[24:27], s30 offen offset:1024 sc1
  buffer_load_dwordx4 a[40:43], v242, s[24:27], s30 offen offset:2048 sc1
  buffer_load_dwordx4 a[44:47], v242, s[24:27], s30 offen offset:3072 sc1
  buffer_load_dwordx4 a[48:51], v243, s[24:27], s30 offen offset:0 sc1
  buffer_load_dwordx4 a[52:55], v243, s[24:27], s30 offen offset:1024 sc1
  buffer_load_dwordx4 a[56:59], v243, s[24:27], s30 offen offset:2048 sc1
  buffer_load_dwordx4 a[60:63], v243, s[24:27], s30 offen offset:3072 sc1
  s_add_u32 s30, s30, 8192
  v_lshrrev_b32 v140, 7, v242
  v_lshlrev_b32 v140, 8, v140
  v_and_b32 v136, 0x70, v242
  v_add_u32 v140, v140, v136
  s_mov_b32 s58, 2826240
  buffer_load_dwordx4 v[136:139], v140, s[24:27], s58 offen sc1
  s_barrier
  ds_read_b64_tr_b16 a[160:161], v224 offset:32768
  ds_read_b64_tr_b16 a[162:163], v224 offset:33792
  ds_read_b64_tr_b16 a[164:165], v224 offset:40960
  ds_read_b64_tr_b16 a[166:167], v224 offset:41984
  ds_read_b64_tr_b16 a[168:169], v225 offset:32768
  ds_read_b64_tr_b16 a[170:171], v225 offset:33792
  ds_read_b64_tr_b16 a[172:173], v225 offset:40960
  ds_read_b64_tr_b16 a[174:175], v225 offset:41984
  s_waitcnt vmcnt(9) lgkmcnt(4)
  v_mfma_f32_16x16x32_bf16 v[0:3], a[160:163], a[0:3], 0
  ds_read_b64_tr_b16 a[176:177], v226 offset:32768
  v_mfma_f32_16x16x32_bf16 v[0:3], a[164:167], a[16:19], v[0:3]
  buffer_load_dwordx4 a[64:67], v242, s[24:27], s30 offen offset:0 sc1
  v_mfma_f32_16x16x32_bf16 v[4:7], a[164:167], a[20:23], 0
  ds_read_b64_tr_b16 a[178:179], v226 offset:33792
  v_mfma_f32_16x16x32_bf16 v[4:7], a[160:163], a[4:7], v[4:7]
  buffer_load_dwordx4 a[68:71], v242, s[24:27], s30 offen offset:1024 sc1
  v_mfma_f32_16x16x32_bf16 v[8:11], a[160:163], a[8:11], 0
  ds_read_b64_tr_b16 a[180:181], v226 offset:40960
  v_mfma_f32_16x16x32_bf16 v[8:11], a[164:167], a[24:27], v[8:11]
  v_mfma_f32_16x16x32_bf16 v[12:15], a[164:167], a[28:31], 0
  ds_read_b64_tr_b16 a[182:183], v226 offset:41984
  v_mfma_f32_16x16x32_bf16 v[12:15], a[160:163], a[12:15], v[12:15]
  s_waitcnt lgkmcnt(4)
  buffer_load_dwordx4 a[72:75], v242, s[24:27], s30 offen offset:2048 sc1
  v_mfma_f32_16x16x32_bf16 v[16:19], a[168:171], a[0:3], 0
  ds_read_b64_tr_b16 a[184:185], v227 offset:32768
  v_mfma_f32_16x16x32_bf16 v[16:19], a[172:175], a[16:19], v[16:19]
  v_mfma_f32_16x16x32_bf16 v[20:23], a[172:175], a[20:23], 0
  ds_read_b64_tr_b16 a[186:187], v227 offset:33792
  v_mfma_f32_16x16x32_bf16 v[20:23], a[168:171], a[4:7], v[20:23]
  buffer_load_dwordx4 a[76:79], v242, s[24:27], s30 offen offset:3072 sc1
  v_mfma_f32_16x16x32_bf16 v[24:27], a[168:171], a[8:11], 0
  ds_read_b64_tr_b16 a[188:189], v227 offset:40960
  v_mfma_f32_16x16x32_bf16 v[24:27], a[172:175], a[24:27], v[24:27]
  buffer_load_dwordx4 a[80:83], v243, s[24:27], s30 offen offset:0 sc1
  v_mfma_f32_16x16x32_bf16 v[28:31], a[172:175], a[28:31], 0
  ds_read_b64_tr_b16 a[190:191], v227 offset:41984
  v_mfma_f32_16x16x32_bf16 v[28:31], a[168:171], a[12:15], v[28:31]
  s_waitcnt lgkmcnt(4)
  v_mfma_f32_16x16x32_bf16 v[32:35], a[176:179], a[0:3], 0
  ds_read_b64_tr_b16 a[160:161], v228 offset:32768
  v_mfma_f32_16x16x32_bf16 v[32:35], a[180:183], a[16:19], v[32:35]
  buffer_load_dwordx4 a[84:87], v243, s[24:27], s30 offen offset:1024 sc1
  v_mfma_f32_16x16x32_bf16 v[36:39], a[180:183], a[20:23], 0
  ds_read_b64_tr_b16 a[162:163], v228 offset:33792
  v_mfma_f32_16x16x32_bf16 v[36:39], a[176:179], a[4:7], v[36:39]
  v_mfma_f32_16x16x32_bf16 v[40:43], a[176:179], a[8:11], 0
  ds_read_b64_tr_b16 a[164:165], v228 offset:40960
  v_mfma_f32_16x16x32_bf16 v[40:43], a[180:183], a[24:27], v[40:43]
  buffer_load_dwordx4 a[88:91], v243, s[24:27], s30 offen offset:2048 sc1
  v_mfma_f32_16x16x32_bf16 v[44:47], a[180:183], a[28:31], 0
  ds_read_b64_tr_b16 a[166:167], v228 offset:41984
  v_mfma_f32_16x16x32_bf16 v[44:47], a[176:179], a[12:15], v[44:47]
  s_waitcnt lgkmcnt(4)
  buffer_load_dwordx4 a[92:95], v243, s[24:27], s30 offen offset:3072 sc1
  v_mfma_f32_16x16x32_bf16 v[48:51], a[184:187], a[0:3], 0
  ds_read_b64_tr_b16 a[168:169], v229 offset:32768
  v_mfma_f32_16x16x32_bf16 v[48:51], a[188:191], a[16:19], v[48:51]
  v_mfma_f32_16x16x32_bf16 v[52:55], a[188:191], a[20:23], 0
  ds_read_b64_tr_b16 a[170:171], v229 offset:33792
  v_mfma_f32_16x16x32_bf16 v[52:55], a[184:187], a[4:7], v[52:55]
  s_add_u32 s30, s30, 8192
  v_mfma_f32_16x16x32_bf16 v[56:59], a[184:187], a[8:11], 0
  ds_read_b64_tr_b16 a[172:173], v229 offset:40960
  v_mfma_f32_16x16x32_bf16 v[56:59], a[188:191], a[24:27], v[56:59]
  v_mfma_f32_16x16x32_bf16 v[60:63], a[188:191], a[28:31], 0
  ds_read_b64_tr_b16 a[174:175], v229 offset:41984
  v_mfma_f32_16x16x32_bf16 v[60:63], a[184:187], a[12:15], v[60:63]
  s_waitcnt lgkmcnt(4)
  buffer_load_dwordx4 a[96:99], v242, s[24:27], s30 offen offset:0 sc1
  v_mfma_f32_16x16x32_bf16 v[64:67], a[160:163], a[0:3], 0
  ds_read_b64_tr_b16 a[176:177], v230 offset:32768
  v_mfma_f32_16x16x32_bf16 v[64:67], a[164:167], a[16:19], v[64:67]
  buffer_load_dwordx4 a[100:103], v242, s[24:27], s30 offen offset:1024 sc1
  v_mfma_f32_16x16x32_bf16 v[68:71], a[164:167], a[20:23], 0
  ds_read_b64_tr_b16 a[178:179], v230 offset:33792
  v_mfma_f32_16x16x32_bf16 v[68:71], a[160:163], a[4:7], v[68:71]
  v_mfma_f32_16x16x32_bf16 v[72:75], a[160:163], a[8:11], 0
  ds_read_b64_tr_b16 a[180:181], v230 offset:40960
  v_mfma_f32_16x16x32_bf16 v[72:75], a[164:167], a[24:27], v[72:75]
  buffer_load_dwordx4 a[104:107], v242, s[24:27], s30 offen offset:2048 sc1
  v_mfma_f32_16x16x32_bf16 v[76:79], a[164:167], a[28:31], 0
  ds_read_b64_tr_b16 a[182:183], v230 offset:41984
  v_mfma_f32_16x16x32_bf16 v[76:79], a[160:163], a[12:15], v[76:79]
  s_waitcnt lgkmcnt(4)
  v_mfma_f32_16x16x32_bf16 v[80:83], a[168:171], a[0:3], 0
  ds_read_b64_tr_b16 a[184:185], v231 offset:32768
  v_mfma_f32_16x16x32_bf16 v[80:83], a[172:175], a[16:19], v[80:83]
  buffer_load_dwordx4 a[108:111], v242, s[24:27], s30 offen offset:3072 sc1
  v_mfma_f32_16x16x32_bf16 v[84:87], a[172:175], a[20:23], 0
  ds_read_b64_tr_b16 a[186:187], v231 offset:33792
  v_mfma_f32_16x16x32_bf16 v[84:87], a[168:171], a[4:7], v[84:87]
  buffer_load_dwordx4 a[112:115], v243, s[24:27], s30 offen offset:0 sc1
  v_mfma_f32_16x16x32_bf16 v[88:91], a[168:171], a[8:11], 0
  ds_read_b64_tr_b16 a[188:189], v231 offset:40960
  v_mfma_f32_16x16x32_bf16 v[88:91], a[172:175], a[24:27], v[88:91]
  s_barrier
  v_mfma_f32_16x16x32_bf16 v[92:95], a[172:175], a[28:31], 0
  ds_read_b64_tr_b16 a[190:191], v231 offset:41984
  v_mfma_f32_16x16x32_bf16 v[92:95], a[168:171], a[12:15], v[92:95]
  s_waitcnt lgkmcnt(4)
  buffer_load_dwordx4 a[116:119], v243, s[24:27], s30 offen offset:1024 sc1
  v_mfma_f32_16x16x32_bf16 v[96:99], a[176:179], a[0:3], 0
  ds_read_b64_tr_b16 a[160:161], v224 offset:49152
  v_mfma_f32_16x16x32_bf16 v[96:99], a[180:183], a[16:19], v[96:99]
  v_mfma_f32_16x16x32_bf16 v[100:103], a[180:183], a[20:23], 0
  ds_read_b64_tr_b16 a[162:163], v224 offset:50176
  v_mfma_f32_16x16x32_bf16 v[100:103], a[176:179], a[4:7], v[100:103]
  buffer_load_dwordx4 a[120:123], v243, s[24:27], s30 offen offset:2048 sc1
  v_mfma_f32_16x16x32_bf16 v[104:107], a[176:179], a[8:11], 0
  ds_read_b64_tr_b16 a[164:165], v224 offset:57344
  v_mfma_f32_16x16x32_bf16 v[104:107], a[180:183], a[24:27], v[104:107]
  buffer_load_dwordx4 a[124:127], v243, s[24:27], s30 offen offset:3072 sc1
  v_mfma_f32_16x16x32_bf16 v[108:111], a[180:183], a[28:31], 0
  ds_read_b64_tr_b16 a[166:167], v224 offset:58368
  v_mfma_f32_16x16x32_bf16 v[108:111], a[176:179], a[12:15], v[108:111]
  s_waitcnt lgkmcnt(4)
  v_mfma_f32_16x16x32_bf16 v[112:115], a[184:187], a[0:3], 0
  ds_read_b64_tr_b16 a[168:169], v225 offset:49152
  v_mfma_f32_16x16x32_bf16 v[112:115], a[188:191], a[16:19], v[112:115]
  s_add_u32 s30, s30, 8192
  v_mfma_f32_16x16x32_bf16 v[116:119], a[188:191], a[20:23], 0
  ds_read_b64_tr_b16 a[170:171], v225 offset:50176
  v_mfma_f32_16x16x32_bf16 v[116:119], a[184:187], a[4:7], v[116:119]
  v_mfma_f32_16x16x32_bf16 v[120:123], a[184:187], a[8:11], 0
  ds_read_b64_tr_b16 a[172:173], v225 offset:57344
  v_mfma_f32_16x16x32_bf16 v[120:123], a[188:191], a[24:27], v[120:123]
  v_mfma_f32_16x16x32_bf16 v[124:127], a[188:191], a[28:31], 0
  ds_read_b64_tr_b16 a[174:175], v225 offset:58368
  v_mfma_f32_16x16x32_bf16 v[124:127], a[184:187], a[12:15], v[124:127]
  s_waitcnt vmcnt(17) lgkmcnt(4)
  v_mfma_f32_16x16x32_bf16 v[0:3], a[160:163], a[32:35], v[0:3]
  ds_read_b64_tr_b16 a[176:177], v226 offset:49152
  v_mfma_f32_16x16x32_bf16 v[0:3], a[164:167], a[48:51], v[0:3]
  buffer_load_dwordx4 a[0:3], v242, s[24:27], s30 offen offset:0 sc1
  v_mfma_f32_16x16x32_bf16 v[4:7], a[164:167], a[52:55], v[4:7]
  ds_read_b64_tr_b16 a[178:179], v226 offset:50176
  v_mfma_f32_16x16x32_bf16 v[4:7], a[160:163], a[36:39], v[4:7]
  v_mfma_f32_16x16x32_bf16 v[8:11], a[160:163], a[40:43], v[8:11]
  ds_read_b64_tr_b16 a[180:181], v226 offset:57344
  s_add_u32 m0, s28, 16384
  v_mfma_f32_16x16x32_bf16 v[8:11], a[164:167], a[56:59], v[8:11]
  buffer_load_dwordx4 v238, s[20:23], s31 offen offset:0 lds
  v_mfma_f32_16x16x32_bf16 v[12:15], a[164:167], a[60:63], v[12:15]
  ds_read_b64_tr_b16 a[182:183], v226 offset:58368
  v_mfma_f32_16x16x32_bf16 v[12:15], a[160:163], a[44:47], v[12:15]
  s_waitcnt lgkmcnt(4)
  v_mfma_f32_16x16x32_bf16 v[16:19], a[168:171], a[32:35], v[16:19]
  ds_read_b64_tr_b16 a[184:185], v227 offset:49152
  v_mfma_f32_16x16x32_bf16 v[16:19], a[172:175], a[48:51], v[16:19]
  buffer_load_dwordx4 a[4:7], v242, s[24:27], s30 offen offset:1024 sc1
  v_mfma_f32_16x16x32_bf16 v[20:23], a[172:175], a[52:55], v[20:23]
  ds_read_b64_tr_b16 a[186:187], v227 offset:50176
  v_mfma_f32_16x16x32_bf16 v[20:23], a[168:171], a[36:39], v[20:23]
  v_mfma_f32_16x16x32_bf16 v[24:27], a[168:171], a[40:43], v[24:27]
  ds_read_b64_tr_b16 a[188:189], v227 offset:57344
  v_mfma_f32_16x16x32_bf16 v[24:27], a[172:175], a[56:59], v[24:27]
  v_mfma_f32_16x16x32_bf16 v[28:31], a[172:175], a[60:63], v[28:31]
  ds_read_b64_tr_b16 a[190:191], v227 offset:58368
  v_mfma_f32_16x16x32_bf16 v[28:31], a[168:171], a[44:47], v[28:31]
  s_waitcnt lgkmcnt(4)
  v_mfma_f32_16x16x32_bf16 v[32:35], a[176:179], a[32:35], v[32:35]
  ds_read_b64_tr_b16 a[160:161], v228 offset:49152
  v_mfma_f32_16x16x32_bf16 v[32:35], a[180:183], a[48:51], v[32:35]
  buffer_load_dwordx4 a[8:11], v242, s[24:27], s30 offen offset:2048 sc1
  v_mfma_f32_16x16x32_bf16 v[36:39], a[180:183], a[52:55], v[36:39]
  ds_read_b64_tr_b16 a[162:163], v228 offset:50176
  v_mfma_f32_16x16x32_bf16 v[36:39], a[176:179], a[36:39], v[36:39]
  v_mfma_f32_16x16x32_bf16 v[40:43], a[176:179], a[40:43], v[40:43]
  ds_read_b64_tr_b16 a[164:165], v228 offset:57344
  v_mfma_f32_16x16x32_bf16 v[40:43], a[180:183], a[56:59], v[40:43]
  buffer_load_dwordx4 v239, s[20:23], s31 offen offset:1024 lds
  v_mfma_f32_16x16x32_bf16 v[44:47], a[180:183], a[60:63], v[44:47]
  ds_read_b64_tr_b16 a[166:167], v228 offset:58368
  v_mfma_f32_16x16x32_bf16 v[44:47], a[176:179], a[44:47], v[44:47]
  s_waitcnt lgkmcnt(4)
  v_mfma_f32_16x16x32_bf16 v[48:51], a[184:187], a[32:35], v[48:51]
  ds_read_b64_tr_b16 a[168:169], v229 offset:49152
  v_mfma_f32_16x16x32_bf16 v[48:51], a[188:191], a[48:51], v[48:51]
  buffer_load_dwordx4 a[12:15], v242, s[24:27], s30 offen offset:3072 sc1
  v_mfma_f32_16x16x32_bf16 v[52:55], a[188:191], a[52:55], v[52:55]
  ds_read_b64_tr_b16 a[170:171], v229 offset:50176
  v_mfma_f32_16x16x32_bf16 v[52:55], a[184:187], a[36:39], v[52:55]
  v_mfma_f32_16x16x32_bf16 v[56:59], a[184:187], a[40:43], v[56:59]
  ds_read_b64_tr_b16 a[172:173], v229 offset:57344
  v_mfma_f32_16x16x32_bf16 v[56:59], a[188:191], a[56:59], v[56:59]
  v_mfma_f32_16x16x32_bf16 v[60:63], a[188:191], a[60:63], v[60:63]
  ds_read_b64_tr_b16 a[174:175], v229 offset:58368
  v_mfma_f32_16x16x32_bf16 v[60:63], a[184:187], a[44:47], v[60:63]
  s_waitcnt lgkmcnt(4)
  v_mfma_f32_16x16x32_bf16 v[64:67], a[160:163], a[32:35], v[64:67]
  ds_read_b64_tr_b16 a[176:177], v230 offset:49152
  v_mfma_f32_16x16x32_bf16 v[64:67], a[164:167], a[48:51], v[64:67]
  buffer_load_dwordx4 a[16:19], v243, s[24:27], s30 offen offset:0 sc1
  v_mfma_f32_16x16x32_bf16 v[68:71], a[164:167], a[52:55], v[68:71]
  ds_read_b64_tr_b16 a[178:179], v230 offset:50176
  v_mfma_f32_16x16x32_bf16 v[68:71], a[160:163], a[36:39], v[68:71]
  v_mfma_f32_16x16x32_bf16 v[72:75], a[160:163], a[40:43], v[72:75]
  ds_read_b64_tr_b16 a[180:181], v230 offset:57344
  v_mfma_f32_16x16x32_bf16 v[72:75], a[164:167], a[56:59], v[72:75]
  buffer_load_dwordx4 v240, s[20:23], s31 offen offset:2048 lds
  v_mfma_f32_16x16x32_bf16 v[76:79], a[164:167], a[60:63], v[76:79]
  ds_read_b64_tr_b16 a[182:183], v230 offset:58368
  v_mfma_f32_16x16x32_bf16 v[76:79], a[160:163], a[44:47], v[76:79]
  s_waitcnt lgkmcnt(4)
  v_mfma_f32_16x16x32_bf16 v[80:83], a[168:171], a[32:35], v[80:83]
  ds_read_b64_tr_b16 a[184:185], v231 offset:49152
  v_mfma_f32_16x16x32_bf16 v[80:83], a[172:175], a[48:51], v[80:83]
  buffer_load_dwordx4 a[20:23], v243, s[24:27], s30 offen offset:1024 sc1
  v_mfma_f32_16x16x32_bf16 v[84:87], a[172:175], a[52:55], v[84:87]
  ds_read_b64_tr_b16 a[186:187], v231 offset:50176
  v_mfma_f32_16x16x32_bf16 v[84:87], a[168:171], a[36:39], v[84:87]
  v_mfma_f32_16x16x32_bf16 v[88:91], a[168:171], a[40:43], v[88:91]
  ds_read_b64_tr_b16 a[188:189], v231 offset:57344
  v_mfma_f32_16x16x32_bf16 v[88:91], a[172:175], a[56:59], v[88:91]
  s_barrier
  v_mfma_f32_16x16x32_bf16 v[92:95], a[172:175], a[60:63], v[92:95]
  ds_read_b64_tr_b16 a[190:191], v231 offset:58368
  v_mfma_f32_16x16x32_bf16 v[92:95], a[168:171], a[44:47], v[92:95]
  s_waitcnt lgkmcnt(4)
  v_mfma_f32_16x16x32_bf16 v[96:99], a[176:179], a[32:35], v[96:99]
  ds_read_b64_tr_b16 a[160:161], v148 offset:32768
  v_mfma_f32_16x16x32_bf16 v[96:99], a[180:183], a[48:51], v[96:99]
  buffer_load_dwordx4 a[24:27], v243, s[24:27], s30 offen offset:2048 sc1
  v_mfma_f32_16x16x32_bf16 v[100:103], a[180:183], a[52:55], v[100:103]
  ds_read_b64_tr_b16 a[162:163], v148 offset:33792
  v_mfma_f32_16x16x32_bf16 v[100:103], a[176:179], a[36:39], v[100:103]
  v_mfma_f32_16x16x32_bf16 v[104:107], a[176:179], a[40:43], v[104:107]
  ds_read_b64_tr_b16 a[164:165], v148 offset:40960
  v_mfma_f32_16x16x32_bf16 v[104:107], a[180:183], a[56:59], v[104:107]
  buffer_load_dwordx4 v241, s[20:23], s31 offen offset:3072 lds
  s_add_u32 s31, s31, 0x80000
  v_mfma_f32_16x16x32_bf16 v[108:111], a[180:183], a[60:63], v[108:111]
  ds_read_b64_tr_b16 a[166:167], v148 offset:41984
  v_mfma_f32_16x16x32_bf16 v[108:111], a[176:179], a[44:47], v[108:111]
  s_waitcnt lgkmcnt(4)
  v_mfma_f32_16x16x32_bf16 v[112:115], a[184:187], a[32:35], v[112:115]
  ds_read_b64_tr_b16 a[168:169], v149 offset:32768
  v_mfma_f32_16x16x32_bf16 v[112:115], a[188:191], a[48:51], v[112:115]
  buffer_load_dwordx4 a[28:31], v243, s[24:27], s30 offen offset:3072 sc1
  s_add_u32 s30, s30, 8192
  v_mfma_f32_16x16x32_bf16 v[116:119], a[188:191], a[52:55], v[116:119]
  ds_read_b64_tr_b16 a[170:171], v149 offset:33792
  v_mfma_f32_16x16x32_bf16 v[116:119], a[184:187], a[36:39], v[116:119]
  v_mfma_f32_16x16x32_bf16 v[120:123], a[184:187], a[40:43], v[120:123]
  ds_read_b64_tr_b16 a[172:173], v149 offset:40960
  v_mfma_f32_16x16x32_bf16 v[120:123], a[188:191], a[56:59], v[120:123]
  v_mfma_f32_16x16x32_bf16 v[124:127], a[188:191], a[60:63], v[124:127]
  ds_read_b64_tr_b16 a[174:175], v149 offset:41984
  v_mfma_f32_16x16x32_bf16 v[124:127], a[184:187], a[44:47], v[124:127]
  s_waitcnt vmcnt(20) lgkmcnt(4)
  v_xor_b32 v136, s55, v136
  v_xor_b32 v137, s55, v137
  v_xor_b32 v138, s55, v138
  v_xor_b32 v139, s55, v139
  v_or3_b32 v136, v136, v137, v138
  v_or_b32 v136, v136, v139
  v_cmp_ne_u32 vcc, 0, v136
  s_nop 0
  s_cbranch_vccz front_keys
  s_mov_b32 s54, 32768
front_all:
  s_sleep 2
  buffer_load_dwordx4 v[136:139], v140, s[24:27], s58 offen sc1
  s_waitcnt vmcnt(0)
  v_xor_b32 v136, s55, v136
  v_xor_b32 v137, s55, v137
  v_xor_b32 v138, s55, v138
  v_xor_b32 v139, s55, v139
  v_or3_b32 v136, v136, v137, v138
  v_or_b32 v136, v136, v139
  v_cmp_ne_u32 vcc, 0, v136
  s_nop 0
  s_cbranch_vccz front_keys
  s_sub_u32 s54, s54, 1
  s_cmp_lg_u32 s54, 0
  s_cbranch_scc1 front_all
front_keys:
  s_lshl_b32 s35, s3, 11
  s_add_u32 s35, s35, 2621440
  buffer_load_dwordx4 v[128:131], v242, s[24:27], s35 offen sc1
  buffer_load_dwordx4 v[132:135], v242, s[24:27], s35 offen offset:1024 sc1
  v_mfma_f32_16x16x32_bf16 v[0:3], a[160:163], a[64:67], v[0:3]
  ds_read_b64_tr_b16 a[176:177], v150 offset:32768
  s_add_u32 s59, s59, 1
  s_or_b32 s54, s2, s3
  s_min_u32 s54, s54, 1
  v_mfma_f32_16x16x32_bf16 v[0:3], a[164:167], a[80:83], v[0:3]
  buffer_load_dwordx4 a[32:35], v242, s[24:27], s30 offen offset:0 sc1
  s_lshl_b32 s54, s54, 28
  v_mfma_f32_16x16x32_bf16 v[4:7], a[164:167], a[84:87], v[4:7]
  ds_read_b64_tr_b16 a[178:179], v150 offset:33792
  v_lshlrev_b32 v137, 22, v242
  v_mfma_f32_16x16x32_bf16 v[4:7], a[160:163], a[68:71], v[4:7]
  v_or_b32 v137, s54, v137
  v_mov_b32 v136, s59
  v_mfma_f32_16x16x32_bf16 v[8:11], a[160:163], a[72:75], v[8:11]
  ds_read_b64_tr_b16 a[180:181], v150 offset:40960
  s_add_u32 m0, s28, 0
  s_mov_b32 s58, 2830336
  buffer_store_dword v136, v137, s[24:27], s58 offen sc1
  v_mfma_f32_16x16x32_bf16 v[8:11], a[164:167], a[88:91], v[8:11]
  buffer_load_dwordx4 v238, s[20:23], s31 offen offset:0 lds
  v_mfma_f32_16x16x32_bf16 v[12:15], a[164:167], a[92:95], v[12:15]
  ds_read_b64_tr_b16 a[182:183], v150 offset:41984
  v_mfma_f32_16x16x32_bf16 v[12:15], a[160:163], a[76:79], v[12:15]
  s_waitcnt lgkmcnt(4)
  v_mfma_f32_16x16x32_bf16 v[16:19], a[168:171], a[64:67], v[16:19]
  ds_read_b64_tr_b16 a[184:185], v151 offset:32768
  v_mfma_f32_16x16x32_bf16 v[16:19], a[172:175], a[80:83], v[16:19]
  buffer_load_dwordx4 a[36:39], v242, s[24:27], s30 offen offset:1024 sc1
  v_mfma_f32_16x16x32_bf16 v[20:23], a[172:175], a[84:87], v[20:23]
  ds_read_b64_tr_b16 a[186:187], v151 offset:33792
  v_mfma_f32_16x16x32_bf16 v[20:23], a[168:171], a[68:71], v[20:23]
  v_mfma_f32_16x16x32_bf16 v[24:27], a[168:171], a[72:75], v[24:27]
  ds_read_b64_tr_b16 a[188:189], v151 offset:40960
  v_mfma_f32_16x16x32_bf16 v[24:27], a[172:175], a[88:91], v[24:27]
  v_mfma_f32_16x16x32_bf16 v[28:31], a[172:175], a[92:95], v[28:31]
  ds_read_b64_tr_b16 a[190:191], v151 offset:41984
  v_mfma_f32_16x16x32_bf16 v[28:31], a[168:171], a[76:79], v[28:31]
  s_waitcnt lgkmcnt(4)
  v_mfma_f32_16x16x32_bf16 v[32:35], a[176:179], a[64:67], v[32:35]
  ds_read_b64_tr_b16 a[160:161], v152 offset:32768
  v_mfma_f32_16x16x32_bf16 v[32:35], a[180:183], a[80:83], v[32:35]
  buffer_load_dwordx4 a[40:43], v242, s[24:27], s30 offen offset:2048 sc1
  v_mfma_f32_16x16x32_bf16 v[36:39], a[180:183], a[84:87], v[36:39]
  ds_read_b64_tr_b16 a[162:163], v152 offset:33792
  v_mfma_f32_16x16x32_bf16 v[36:39], a[176:179], a[68:71], v[36:39]
  v_mfma_f32_16x16x32_bf16 v[40:43], a[176:179], a[72:75], v[40:43]
  ds_read_b64_tr_b16 a[164:165], v152 offset:40960
  v_mfma_f32_16x16x32_bf16 v[40:43], a[180:183], a[88:91], v[40:43]
  buffer_load_dwordx4 v239, s[20:23], s31 offen offset:1024 lds
  v_mfma_f32_16x16x32_bf16 v[44:47], a[180:183], a[92:95], v[44:47]
  ds_read_b64_tr_b16 a[166:167], v152 offset:41984
  v_mfma_f32_16x16x32_bf16 v[44:47], a[176:179], a[76:79], v[44:47]
  s_waitcnt lgkmcnt(4)
  v_mfma_f32_16x16x32_bf16 v[48:51], a[184:187], a[64:67], v[48:51]
  ds_read_b64_tr_b16 a[168:169], v153 offset:32768
  v_mfma_f32_16x16x32_bf16 v[48:51], a[188:191], a[80:83], v[48:51]
  buffer_load_dwordx4 a[44:47], v242, s[24:27], s30 offen offset:3072 sc1
  v_mfma_f32_16x16x32_bf16 v[52:55], a[188:191], a[84:87], v[52:55]
  ds_read_b64_tr_b16 a[170:171], v153 offset:33792
  v_mfma_f32_16x16x32_bf16 v[52:55], a[184:187], a[68:71], v[52:55]
  v_mfma_f32_16x16x32_bf16 v[56:59], a[184:187], a[72:75], v[56:59]
  ds_read_b64_tr_b16 a[172:173], v153 offset:40960
  v_mfma_f32_16x16x32_bf16 v[56:59], a[188:191], a[88:91], v[56:59]
  v_mfma_f32_16x16x32_bf16 v[60:63], a[188:191], a[92:95], v[60:63]
  ds_read_b64_tr_b16 a[174:175], v153 offset:41984
  v_mfma_f32_16x16x32_bf16 v[60:63], a[184:187], a[76:79], v[60:63]
  s_waitcnt lgkmcnt(4)
  v_mfma_f32_16x16x32_bf16 v[64:67], a[160:163], a[64:67], v[64:67]
  ds_read_b64_tr_b16 a[176:177], v154 offset:32768
  v_mfma_f32_16x16x32_bf16 v[64:67], a[164:167], a[80:83], v[64:67]
  buffer_load_dwordx4 a[48:51], v243, s[24:27], s30 offen offset:0 sc1
  v_mfma_f32_16x16x32_bf16 v[68:71], a[164:167], a[84:87], v[68:71]
  ds_read_b64_tr_b16 a[178:179], v154 offset:33792
  v_mfma_f32_16x16x32_bf16 v[68:71], a[160:163], a[68:71], v[68:71]
  v_mfma_f32_16x16x32_bf16 v[72:75], a[160:163], a[72:75], v[72:75]
  ds_read_b64_tr_b16 a[180:181], v154 offset:40960
  v_mfma_f32_16x16x32_bf16 v[72:75], a[164:167], a[88:91], v[72:75]
  buffer_load_dwordx4 v240, s[20:23], s31 offen offset:2048 lds
  v_mfma_f32_16x16x32_bf16 v[76:79], a[164:167], a[92:95], v[76:79]
  ds_read_b64_tr_b16 a[182:183], v154 offset:41984
  v_mfma_f32_16x16x32_bf16 v[76:79], a[160:163], a[76:79], v[76:79]
  s_waitcnt lgkmcnt(4)
  v_mfma_f32_16x16x32_bf16 v[80:83], a[168:171], a[64:67], v[80:83]
  ds_read_b64_tr_b16 a[184:185], v155 offset:32768
  v_mfma_f32_16x16x32_bf16 v[80:83], a[172:175], a[80:83], v[80:83]
  buffer_load_dwordx4 a[52:55], v243, s[24:27], s30 offen offset:1024 sc1
  v_mfma_f32_16x16x32_bf16 v[84:87], a[172:175], a[84:87], v[84:87]
  ds_read_b64_tr_b16 a[186:187], v155 offset:33792
  v_mfma_f32_16x16x32_bf16 v[84:87], a[168:171], a[68:71], v[84:87]
  v_mfma_f32_16x16x32_bf16 v[88:91], a[168:171], a[72:75], v[88:91]
  ds_read_b64_tr_b16 a[188:189], v155 offset:40960
  v_mfma_f32_16x16x32_bf16 v[88:91], a[172:175], a[88:91], v[88:91]
  s_barrier
  v_mfma_f32_16x16x32_bf16 v[92:95], a[172:175], a[92:95], v[92:95]
  ds_read_b64_tr_b16 a[190:191], v155 offset:41984
  v_mfma_f32_16x16x32_bf16 v[92:95], a[168:171], a[76:79], v[92:95]
  s_waitcnt lgkmcnt(4)
  v_mfma_f32_16x16x32_bf16 v[96:99], a[176:179], a[64:67], v[96:99]
  ds_read_b64_tr_b16 a[160:161], v148 offset:49152
  v_mfma_f32_16x16x32_bf16 v[96:99], a[180:183], a[80:83], v[96:99]
  buffer_load_dwordx4 a[56:59], v243, s[24:27], s30 offen offset:2048 sc1
  v_mfma_f32_16x16x32_bf16 v[100:103], a[180:183], a[84:87], v[100:103]
  ds_read_b64_tr_b16 a[162:163], v148 offset:50176
  v_mfma_f32_16x16x32_bf16 v[100:103], a[176:179], a[68:71], v[100:103]
  v_mfma_f32_16x16x32_bf16 v[104:107], a[176:179], a[72:75], v[104:107]
  ds_read_b64_tr_b16 a[164:165], v148 offset:57344
  v_mfma_f32_16x16x32_bf16 v[104:107], a[180:183], a[88:91], v[104:107]
  buffer_load_dwordx4 v241, s[20:23], s31 offen offset:3072 lds
  s_add_u32 s31, s31, 0x80000
  v_mfma_f32_16x16x32_bf16 v[108:111], a[180:183], a[92:95], v[108:111]
  ds_read_b64_tr_b16 a[166:167], v148 offset:58368
  v_mfma_f32_16x16x32_bf16 v[108:111], a[176:179], a[76:79], v[108:111]
  s_waitcnt lgkmcnt(4)
  v_mfma_f32_16x16x32_bf16 v[112:115], a[184:187], a[64:67], v[112:115]
  ds_read_b64_tr_b16 a[168:169], v149 offset:49152
  v_mfma_f32_16x16x32_bf16 v[112:115], a[188:191], a[80:83], v[112:115]
  buffer_load_dwordx4 a[60:63], v243, s[24:27], s30 offen offset:3072 sc1
  s_add_u32 s30, s30, 8192
  v_mfma_f32_16x16x32_bf16 v[116:119], a[188:191], a[84:87], v[116:119]
  ds_read_b64_tr_b16 a[170:171], v149 offset:50176
  v_mfma_f32_16x16x32_bf16 v[116:119], a[184:187], a[68:71], v[116:119]
  v_mfma_f32_16x16x32_bf16 v[120:123], a[184:187], a[72:75], v[120:123]
  ds_read_b64_tr_b16 a[172:173], v149 offset:57344
  v_mfma_f32_16x16x32_bf16 v[120:123], a[188:191], a[88:91], v[120:123]
  v_mfma_f32_16x16x32_bf16 v[124:127], a[188:191], a[92:95], v[124:127]
  ds_read_b64_tr_b16 a[174:175], v149 offset:58368
  v_mfma_f32_16x16x32_bf16 v[124:127], a[184:187], a[76:79], v[124:127]
  s_waitcnt vmcnt(27) lgkmcnt(4)
  v_mfma_f32_16x16x32_bf16 v[0:3], a[160:163], a[96:99], v[0:3]
  ds_read_b64_tr_b16 a[176:177], v150 offset:49152
  v_mfma_f32_16x16x32_bf16 v[0:3], a[164:167], a[112:115], v[0:3]
  buffer_load_dwordx4 a[64:67], v242, s[24:27], s30 offen offset:0 sc1
  v_mfma_f32_16x16x32_bf16 v[4:7], a[164:167], a[116:119], v[4:7]
  ds_read_b64_tr_b16 a[178:179], v150 offset:50176
  v_mfma_f32_16x16x32_bf16 v[4:7], a[160:163], a[100:103], v[4:7]
  v_mfma_f32_16x16x32_bf16 v[8:11], a[160:163], a[104:107], v[8:11]
  ds_read_b64_tr_b16 a[180:181], v150 offset:57344
  s_add_u32 m0, s28, 65536
  v_mfma_f32_16x16x32_bf16 v[8:11], a[164:167], a[120:123], v[8:11]
  buffer_load_dwordx4 v238, s[20:23], s31 offen offset:0 lds
  v_mfma_f32_16x16x32_bf16 v[12:15], a[164:167], a[124:127], v[12:15]
  ds_read_b64_tr_b16 a[182:183], v150 offset:58368
  v_mfma_f32_16x16x32_bf16 v[12:15], a[160:163], a[108:111], v[12:15]
  s_waitcnt lgkmcnt(4)
  v_mfma_f32_16x16x32_bf16 v[16:19], a[168:171], a[96:99], v[16:19]
  ds_read_b64_tr_b16 a[184:185], v151 offset:49152
  v_mfma_f32_16x16x32_bf16 v[16:19], a[172:175], a[112:115], v[16:19]
  buffer_load_dwordx4 a[68:71], v242, s[24:27], s30 offen offset:1024 sc1
  v_mfma_f32_16x16x32_bf16 v[20:23], a[172:175], a[116:119], v[20:23]
  ds_read_b64_tr_b16 a[186:187], v151 offset:50176
  v_mfma_f32_16x16x32_bf16 v[20:23], a[168:171], a[100:103], v[20:23]
  v_mfma_f32_16x16x32_bf16 v[24:27], a[168:171], a[104:107], v[24:27]
  ds_read_b64_tr_b16 a[188:189], v151 offset:57344
  v_mfma_f32_16x16x32_bf16 v[24:27], a[172:175], a[120:123], v[24:27]
  v_mfma_f32_16x16x32_bf16 v[28:31], a[172:175], a[124:127], v[28:31]
  ds_read_b64_tr_b16 a[190:191], v151 offset:58368
  v_mfma_f32_16x16x32_bf16 v[28:31], a[168:171], a[108:111], v[28:31]
  s_waitcnt lgkmcnt(4)
  v_mfma_f32_16x16x32_bf16 v[32:35], a[176:179], a[96:99], v[32:35]
  ds_read_b64_tr_b16 a[160:161], v152 offset:49152
  v_mfma_f32_16x16x32_bf16 v[32:35], a[180:183], a[112:115], v[32:35]
  buffer_load_dwordx4 a[72:75], v242, s[24:27], s30 offen offset:2048 sc1
  v_mfma_f32_16x16x32_bf16 v[36:39], a[180:183], a[116:119], v[36:39]
  ds_read_b64_tr_b16 a[162:163], v152 offset:50176
  v_mfma_f32_16x16x32_bf16 v[36:39], a[176:179], a[100:103], v[36:39]
  v_mfma_f32_16x16x32_bf16 v[40:43], a[176:179], a[104:107], v[40:43]
  ds_read_b64_tr_b16 a[164:165], v152 offset:57344
  v_mfma_f32_16x16x32_bf16 v[40:43], a[180:183], a[120:123], v[40:43]
  buffer_load_dwordx4 v239, s[20:23], s31 offen offset:1024 lds
  v_mfma_f32_16x16x32_bf16 v[44:47], a[180:183], a[124:127], v[44:47]
  ds_read_b64_tr_b16 a[166:167], v152 offset:58368
  v_mfma_f32_16x16x32_bf16 v[44:47], a[176:179], a[108:111], v[44:47]
  s_waitcnt lgkmcnt(4)
  v_mfma_f32_16x16x32_bf16 v[48:51], a[184:187], a[96:99], v[48:51]
  ds_read_b64_tr_b16 a[168:169], v153 offset:49152
  v_mfma_f32_16x16x32_bf16 v[48:51], a[188:191], a[112:115], v[48:51]
  buffer_load_dwordx4 a[76:79], v242, s[24:27], s30 offen offset:3072 sc1
  v_mfma_f32_16x16x32_bf16 v[52:55], a[188:191], a[116:119], v[52:55]
  ds_read_b64_tr_b16 a[170:171], v153 offset:50176
  v_mfma_f32_16x16x32_bf16 v[52:55], a[184:187], a[100:103], v[52:55]
  v_mfma_f32_16x16x32_bf16 v[56:59], a[184:187], a[104:107], v[56:59]
  ds_read_b64_tr_b16 a[172:173], v153 offset:57344
  v_mfma_f32_16x16x32_bf16 v[56:59], a[188:191], a[120:123], v[56:59]
  v_mfma_f32_16x16x32_bf16 v[60:63], a[188:191], a[124:127], v[60:63]
  ds_read_b64_tr_b16 a[174:175], v153 offset:58368
  v_mfma_f32_16x16x32_bf16 v[60:63], a[184:187], a[108:111], v[60:63]
  s_waitcnt lgkmcnt(4)
  v_mfma_f32_16x16x32_bf16 v[64:67], a[160:163], a[96:99], v[64:67]
  ds_read_b64_tr_b16 a[176:177], v154 offset:49152
  v_mfma_f32_16x16x32_bf16 v[64:67], a[164:167], a[112:115], v[64:67]
  buffer_load_dwordx4 a[80:83], v243, s[24:27], s30 offen offset:0 sc1
  v_mfma_f32_16x16x32_bf16 v[68:71], a[164:167], a[116:119], v[68:71]
  ds_read_b64_tr_b16 a[178:179], v154 offset:50176
  v_mfma_f32_16x16x32_bf16 v[68:71], a[160:163], a[100:103], v[68:71]
  v_mfma_f32_16x16x32_bf16 v[72:75], a[160:163], a[104:107], v[72:75]
  ds_read_b64_tr_b16 a[180:181], v154 offset:57344
  v_mfma_f32_16x16x32_bf16 v[72:75], a[164:167], a[120:123], v[72:75]
  buffer_load_dwordx4 v240, s[20:23], s31 offen offset:2048 lds
  v_mfma_f32_16x16x32_bf16 v[76:79], a[164:167], a[124:127], v[76:79]
  ds_read_b64_tr_b16 a[182:183], v154 offset:58368
  v_mfma_f32_16x16x32_bf16 v[76:79], a[160:163], a[108:111], v[76:79]
  s_waitcnt lgkmcnt(4)
  v_mfma_f32_16x16x32_bf16 v[80:83], a[168:171], a[96:99], v[80:83]
  ds_read_b64_tr_b16 a[184:185], v155 offset:49152
  v_mfma_f32_16x16x32_bf16 v[80:83], a[172:175], a[112:115], v[80:83]
  buffer_load_dwordx4 a[84:87], v243, s[24:27], s30 offen offset:1024 sc1
  v_mfma_f32_16x16x32_bf16 v[84:87], a[172:175], a[116:119], v[84:87]
  ds_read_b64_tr_b16 a[186:187], v155 offset:50176
  v_mfma_f32_16x16x32_bf16 v[84:87], a[168:171], a[100:103], v[84:87]
  s_waitcnt vmcnt(25)
  v_mfma_f32_16x16x32_bf16 v[88:91], a[168:171], a[104:107], v[88:91]
  ds_read_b64_tr_b16 a[188:189], v155 offset:57344
  v_mfma_f32_16x16x32_bf16 v[88:91], a[172:175], a[120:123], v[88:91]
  s_barrier
  v_mfma_f32_16x16x32_bf16 v[92:95], a[172:175], a[124:127], v[92:95]
  ds_read_b64_tr_b16 a[190:191], v155 offset:58368
  v_mfma_f32_16x16x32_bf16 v[92:95], a[168:171], a[108:111], v[92:95]
  s_waitcnt lgkmcnt(4)
  v_mfma_f32_16x16x32_bf16 v[96:99], a[176:179], a[96:99], v[96:99]
  ds_read_b64_tr_b16 a[160:161], v148 offset:16384
  v_mfma_f32_16x16x32_bf16 v[96:99], a[180:183], a[112:115], v[96:99]
  buffer_load_dwordx4 a[88:91], v243, s[24:27], s30 offen offset:2048 sc1
  v_mfma_f32_16x16x32_bf16 v[100:103], a[180:183], a[116:119], v[100:103]
  ds_read_b64_tr_b16 a[162:163], v148 offset:17408
  v_mfma_f32_16x16x32_bf16 v[100:103], a[176:179], a[100:103], v[100:103]
  v_mfma_f32_16x16x32_bf16 v[104:107], a[176:179], a[104:107], v[104:107]
  ds_read_b64_tr_b16 a[164:165], v148 offset:24576
  v_mfma_f32_16x16x32_bf16 v[104:107], a[180:183], a[120:123], v[104:107]
  buffer_load_dwordx4 v241, s[20:23], s31 offen offset:3072 lds
  s_add_u32 s31, s31, 0x80000
  v_mfma_f32_16x16x32_bf16 v[108:111], a[180:183], a[124:127], v[108:111]
  ds_read_b64_tr_b16 a[166:167], v148 offset:25600
  v_mfma_f32_16x16x32_bf16 v[108:111], a[176:179], a[108:111], v[108:111]
  s_waitcnt lgkmcnt(4)
  v_mfma_f32_16x16x32_bf16 v[112:115], a[184:187], a[96:99], v[112:115]
  ds_read_b64_tr_b16 a[168:169], v149 offset:16384
  v_mfma_f32_16x16x32_bf16 v[112:115], a[188:191], a[112:115], v[112:115]
  buffer_load_dwordx4 a[92:95], v243, s[24:27], s30 offen offset:3072 sc1
  s_add_u32 s30, s30, 8192
  v_mfma_f32_16x16x32_bf16 v[116:119], a[188:191], a[116:119], v[116:119]
  ds_read_b64_tr_b16 a[170:171], v149 offset:17408
  v_mfma_f32_16x16x32_bf16 v[116:119], a[184:187], a[100:103], v[116:119]
  v_mfma_f32_16x16x32_bf16 v[120:123], a[184:187], a[104:107], v[120:123]
  ds_read_b64_tr_b16 a[172:173], v149 offset:24576
  v_mfma_f32_16x16x32_bf16 v[120:123], a[188:191], a[120:123], v[120:123]
  v_mfma_f32_16x16x32_bf16 v[124:127], a[188:191], a[124:127], v[124:127]
  ds_read_b64_tr_b16 a[174:175], v149 offset:25600
  v_mfma_f32_16x16x32_bf16 v[124:127], a[184:187], a[108:111], v[124:127]
  s_waitcnt vmcnt(27) lgkmcnt(4)
  v_mfma_f32_16x16x32_bf16 v[0:3], a[160:163], a[0:3], v[0:3]
  ds_read_b64_tr_b16 a[176:177], v150 offset:16384
  s_waitcnt vmcnt(25)
  v_mov_b32 v136, -1
  v_mfma_f32_16x16x32_bf16 v[0:3], a[164:167], a[16:19], v[0:3]
  buffer_load_dwordx4 a[96:99], v242, s[24:27], s30 offen offset:0 sc1
  v_mfma_f32_16x16x32_bf16 v[4:7], a[164:167], a[20:23], v[4:7]
  ds_read_b64_tr_b16 a[178:179], v150 offset:17408
  v_sub_u32 v139, v136, v128
  v_mfma_f32_16x16x32_bf16 v[4:7], a[160:163], a[4:7], v[4:7]
  v_sub_u32 v140, v136, v129
  v_min_u32 v138, v139, v140
  v_mfma_f32_16x16x32_bf16 v[8:11], a[160:163], a[8:11], v[8:11]
  ds_read_b64_tr_b16 a[180:181], v150 offset:24576
  s_add_u32 m0, s28, 81920
  v_sub_u32 v141, v136, v130
  v_mfma_f32_16x16x32_bf16 v[8:11], a[164:167], a[24:27], v[8:11]
  buffer_load_dwordx4 v238, s[20:23], s31 offen offset:0 lds
  v_mfma_f32_16x16x32_bf16 v[12:15], a[164:167], a[28:31], v[12:15]
  ds_read_b64_tr_b16 a[182:183], v150 offset:25600
  v_sub_u32 v142, v136, v131
  v_mfma_f32_16x16x32_bf16 v[12:15], a[160:163], a[12:15], v[12:15]
  s_waitcnt lgkmcnt(4)
  v_min3_u32 v138, v138, v141, v142
  v_sub_u32 v139, v136, v132
  v_mfma_f32_16x16x32_bf16 v[16:19], a[168:171], a[0:3], v[16:19]
  ds_read_b64_tr_b16 a[184:185], v151 offset:16384
  v_sub_u32 v140, v136, v133
  v_mfma_f32_16x16x32_bf16 v[16:19], a[172:175], a[16:19], v[16:19]
  buffer_load_dwordx4 a[100:103], v242, s[24:27], s30 offen offset:1024 sc1
  v_mfma_f32_16x16x32_bf16 v[20:23], a[172:175], a[20:23], v[20:23]
  ds_read_b64_tr_b16 a[186:187], v151 offset:17408
  v_min3_u32 v138, v138, v139, v140
  v_mfma_f32_16x16x32_bf16 v[20:23], a[168:171], a[4:7], v[20:23]
  v_sub_u32 v141, v136, v134
  v_sub_u32 v142, v136, v135
  v_mfma_f32_16x16x32_bf16 v[24:27], a[168:171], a[8:11], v[24:27]
  ds_read_b64_tr_b16 a[188:189], v151 offset:24576
  v_min3_u32 v138, v138, v141, v142
  v_mfma_f32_16x16x32_bf16 v[24:27], a[172:175], a[24:27], v[24:27]
  v_mfma_f32_16x16x32_bf16 v[28:31], a[172:175], a[28:31], v[28:31]
  ds_read_b64_tr_b16 a[190:191], v151 offset:25600
  v_min_u32_dpp v138, v138, v138 row_ror:8 row_mask:0xf bank_mask:0xf
  v_mfma_f32_16x16x32_bf16 v[28:31], a[168:171], a[12:15], v[28:31]
  s_waitcnt lgkmcnt(4)
  v_min_u32_dpp v138, v138, v138 row_ror:4 row_mask:0xf bank_mask:0xf
  v_mfma_f32_16x16x32_bf16 v[32:35], a[176:179], a[0:3], v[32:35]
  ds_read_b64_tr_b16 a[160:161], v152 offset:16384
  v_min_u32_dpp v138, v138, v138 row_ror:2 row_mask:0xf bank_mask:0xf
  v_mfma_f32_16x16x32_bf16 v[32:35], a[180:183], a[16:19], v[32:35]
  buffer_load_dwordx4 a[104:107], v242, s[24:27], s30 offen offset:2048 sc1
  v_mfma_f32_16x16x32_bf16 v[36:39], a[180:183], a[20:23], v[36:39]
  ds_read_b64_tr_b16 a[162:163], v152 offset:17408
  v_min_u32_dpp v138, v138, v138 row_ror:1 row_mask:0xf bank_mask:0xf
  v_mfma_f32_16x16x32_bf16 v[36:39], a[176:179], a[4:7], v[36:39]
  v_sub_u32 v137, v136, v138
  v_add_u32 v136, -1, v137
  v_mfma_f32_16x16x32_bf16 v[40:43], a[176:179], a[8:11], v[40:43]
  ds_read_b64_tr_b16 a[164:165], v152 offset:24576
  v_sub_u32 v139, v136, v128
  v_mfma_f32_16x16x32_bf16 v[40:43], a[180:183], a[24:27], v[40:43]
  buffer_load_dwordx4 v239, s[20:23], s31 offen offset:1024 lds
  v_mfma_f32_16x16x32_bf16 v[44:47], a[180:183], a[28:31], v[44:47]
  ds_read_b64_tr_b16 a[166:167], v152 offset:25600
  v_mov_b32_dpp v144, v137 quad_perm:[0,1,2,3] row_mask:0xf bank_mask:0x1
  v_mfma_f32_16x16x32_bf16 v[44:47], a[176:179], a[12:15], v[44:47]
  s_waitcnt lgkmcnt(4)
  v_sub_u32 v140, v136, v129
  v_min_u32 v138, v139, v140
  v_mfma_f32_16x16x32_bf16 v[48:51], a[184:187], a[0:3], v[48:51]
  ds_read_b64_tr_b16 a[168:169], v153 offset:16384
  v_sub_u32 v141, v136, v130
  v_mfma_f32_16x16x32_bf16 v[48:51], a[188:191], a[16:19], v[48:51]
  buffer_load_dwordx4 a[108:111], v242, s[24:27], s30 offen offset:3072 sc1
  v_mfma_f32_16x16x32_bf16 v[52:55], a[188:191], a[20:23], v[52:55]
  ds_read_b64_tr_b16 a[170:171], v153 offset:17408
  v_sub_u32 v142, v136, v131
  v_mfma_f32_16x16x32_bf16 v[52:55], a[184:187], a[4:7], v[52:55]
  v_min3_u32 v138, v138, v141, v142
  v_sub_u32 v139, v136, v132
  v_mfma_f32_16x16x32_bf16 v[56:59], a[184:187], a[8:11], v[56:59]
  ds_read_b64_tr_b16 a[172:173], v153 offset:24576
  v_sub_u32 v140, v136, v133
  v_mfma_f32_16x16x32_bf16 v[56:59], a[188:191], a[24:27], v[56:59]
  v_min3_u32 v138, v138, v139, v140
  v_sub_u32 v141, v136, v134
  v_mfma_f32_16x16x32_bf16 v[60:63], a[188:191], a[28:31], v[60:63]
  ds_read_b64_tr_b16 a[174:175], v153 offset:25600
  v_sub_u32 v142, v136, v135
  v_mfma_f32_16x16x32_bf16 v[60:63], a[184:187], a[12:15], v[60:63]
  s_waitcnt lgkmcnt(4)
  v_min3_u32 v138, v138, v141, v142
  v_mfma_f32_16x16x32_bf16 v[64:67], a[160:163], a[0:3], v[64:67]
  ds_read_b64_tr_b16 a[176:177], v154 offset:16384
  v_min_u32_dpp v138, v138, v138 row_ror:8 row_mask:0xf bank_mask:0xf
  v_mfma_f32_16x16x32_bf16 v[64:67], a[164:167], a[16:19], v[64:67]
  buffer_load_dwordx4 a[112:115], v243, s[24:27], s30 offen offset:0 sc1
  v_mfma_f32_16x16x32_bf16 v[68:71], a[164:167], a[20:23], v[68:71]
  ds_read_b64_tr_b16 a[178:179], v154 offset:17408
  v_min_u32_dpp v138, v138, v138 row_ror:4 row_mask:0xf bank_mask:0xf
  v_mfma_f32_16x16x32_bf16 v[68:71], a[160:163], a[4:7], v[68:71]
  v_mfma_f32_16x16x32_bf16 v[72:75], a[160:163], a[8:11], v[72:75]
  ds_read_b64_tr_b16 a[180:181], v154 offset:24576
  v_min_u32_dpp v138, v138, v138 row_ror:2 row_mask:0xf bank_mask:0xf
  v_mfma_f32_16x16x32_bf16 v[72:75], a[164:167], a[24:27], v[72:75]
  buffer_load_dwordx4 v240, s[20:23], s31 offen offset:2048 lds
  v_mfma_f32_16x16x32_bf16 v[76:79], a[164:167], a[28:31], v[76:79]
  ds_read_b64_tr_b16 a[182:183], v154 offset:25600
  v_min_u32_dpp v138, v138, v138 row_ror:1 row_mask:0xf bank_mask:0xf
  v_mfma_f32_16x16x32_bf16 v[76:79], a[160:163], a[12:15], v[76:79]
  s_waitcnt lgkmcnt(4)
  v_sub_u32 v137, v136, v138
  v_add_u32 v136, -1, v137
  v_mfma_f32_16x16x32_bf16 v[80:83], a[168:171], a[0:3], v[80:83]
  ds_read_b64_tr_b16 a[184:185], v155 offset:16384
  v_sub_u32 v139, v136, v128
  v_mfma_f32_16x16x32_bf16 v[80:83], a[172:175], a[16:19], v[80:83]
  buffer_load_dwordx4 a[116:119], v243, s[24:27], s30 offen offset:1024 sc1
  v_mfma_f32_16x16x32_bf16 v[84:87], a[172:175], a[20:23], v[84:87]
  ds_read_b64_tr_b16 a[186:187], v155 offset:17408
  v_mov_b32_dpp v144, v137 quad_perm:[0,1,2,3] row_mask:0xf bank_mask:0x2
  v_mfma_f32_16x16x32_bf16 v[84:87], a[168:171], a[4:7], v[84:87]
  s_waitcnt vmcnt(22)
  v_sub_u32 v140, v136, v129
  v_min_u32 v138, v139, v140
  v_mfma_f32_16x16x32_bf16 v[88:91], a[168:171], a[8:11], v[88:91]
  ds_read_b64_tr_b16 a[188:189], v155 offset:24576
  v_sub_u32 v141, v136, v130
  v_mfma_f32_16x16x32_bf16 v[88:91], a[172:175], a[24:27], v[88:91]
  s_barrier
  v_sub_u32 v142, v136, v131
  v_min3_u32 v138, v138, v141, v142
  v_mfma_f32_16x16x32_bf16 v[92:95], a[172:175], a[28:31], v[92:95]
  ds_read_b64_tr_b16 a[190:191], v155 offset:25600
  v_sub_u32 v139, v136, v132
  v_mfma_f32_16x16x32_bf16 v[92:95], a[168:171], a[12:15], v[92:95]
  s_waitcnt lgkmcnt(4)
  v_sub_u32 v140, v136, v133
  v_min3_u32 v138, v138, v139, v140
  v_mfma_f32_16x16x32_bf16 v[96:99], a[176:179], a[0:3], v[96:99]
  ds_read_b64_tr_b16 a[160:161], v148 offset:0
  v_sub_u32 v141, v136, v134
  v_mfma_f32_16x16x32_bf16 v[96:99], a[180:183], a[16:19], v[96:99]
  buffer_load_dwordx4 a[120:123], v243, s[24:27], s30 offen offset:2048 sc1
  v_mfma_f32_16x16x32_bf16 v[100:103], a[180:183], a[20:23], v[100:103]
  ds_read_b64_tr_b16 a[162:163], v148 offset:1024
  v_sub_u32 v142, v136, v135
  v_mfma_f32_16x16x32_bf16 v[100:103], a[176:179], a[4:7], v[100:103]
  v_min3_u32 v138, v138, v141, v142
  v_mfma_f32_16x16x32_bf16 v[104:107], a[176:179], a[8:11], v[104:107]
  ds_read_b64_tr_b16 a[164:165], v148 offset:8192
  v_min_u32_dpp v138, v138, v138 row_ror:8 row_mask:0xf bank_mask:0xf
  v_mfma_f32_16x16x32_bf16 v[104:107], a[180:183], a[24:27], v[104:107]
  buffer_load_dwordx4 v241, s[20:23], s31 offen offset:3072 lds
  s_add_u32 s31, s31, 0x80000
  v_mfma_f32_16x16x32_bf16 v[108:111], a[180:183], a[28:31], v[108:111]
  ds_read_b64_tr_b16 a[166:167], v148 offset:9216
  v_min_u32_dpp v138, v138, v138 row_ror:4 row_mask:0xf bank_mask:0xf
  v_mfma_f32_16x16x32_bf16 v[108:111], a[176:179], a[12:15], v[108:111]
  s_waitcnt lgkmcnt(4)
  v_min_u32_dpp v138, v138, v138 row_ror:2 row_mask:0xf bank_mask:0xf
  v_mfma_f32_16x16x32_bf16 v[112:115], a[184:187], a[0:3], v[112:115]
  ds_read_b64_tr_b16 a[168:169], v149 offset:0
  v_min_u32_dpp v138, v138, v138 row_ror:1 row_mask:0xf bank_mask:0xf
  v_mfma_f32_16x16x32_bf16 v[112:115], a[188:191], a[16:19], v[112:115]
  buffer_load_dwordx4 a[124:127], v243, s[24:27], s30 offen offset:3072 sc1
  s_add_u32 s30, s30, 8192
  v_mfma_f32_16x16x32_bf16 v[116:119], a[188:191], a[20:23], v[116:119]
  ds_read_b64_tr_b16 a[170:171], v149 offset:1024
  v_sub_u32 v137, v136, v138
  v_mfma_f32_16x16x32_bf16 v[116:119], a[184:187], a[4:7], v[116:119]
  v_add_u32 v136, -1, v137
  v_sub_u32 v139, v136, v128
  v_mfma_f32_16x16x32_bf16 v[120:123], a[184:187], a[8:11], v[120:123]
  ds_read_b64_tr_b16 a[172:173], v149 offset:8192
  v_mov_b32_dpp v144, v137 quad_perm:[0,1,2,3] row_mask:0xf bank_mask:0x4
  v_mfma_f32_16x16x32_bf16 v[120:123], a[188:191], a[24:27], v[120:123]
  v_sub_u32 v140, v136, v129
  v_min_u32 v138, v139, v140
  v_mfma_f32_16x16x32_bf16 v[124:127], a[188:191], a[28:31], v[124:127]
  ds_read_b64_tr_b16 a[174:175], v149 offset:9216
  v_sub_u32 v141, v136, v130
  v_mfma_f32_16x16x32_bf16 v[124:127], a[184:187], a[12:15], v[124:127]
  s_waitcnt vmcnt(24) lgkmcnt(4)
  v_sub_u32 v142, v136, v131
  v_min3_u32 v138, v138, v141, v142
  v_mfma_f32_16x16x32_bf16 v[0:3], a[160:163], a[32:35], v[0:3]
  ds_read_b64_tr_b16 a[176:177], v150 offset:0
  v_sub_u32 v139, v136, v132
  v_mfma_f32_16x16x32_bf16 v[0:3], a[164:167], a[48:51], v[0:3]
  buffer_load_dwordx4 a[0:3], v242, s[24:27], s30 offen offset:0 sc1
  v_mfma_f32_16x16x32_bf16 v[4:7], a[164:167], a[52:55], v[4:7]
  ds_read_b64_tr_b16 a[178:179], v150 offset:1024
  v_sub_u32 v140, v136, v133
  v_mfma_f32_16x16x32_bf16 v[4:7], a[160:163], a[36:39], v[4:7]
  v_min3_u32 v138, v138, v139, v140
  v_sub_u32 v141, v136, v134
  v_mfma_f32_16x16x32_bf16 v[8:11], a[160:163], a[40:43], v[8:11]
  ds_read_b64_tr_b16 a[180:181], v150 offset:8192
  s_add_u32 m0, s28, 98304
  v_sub_u32 v142, v136, v135
  v_mfma_f32_16x16x32_bf16 v[8:11], a[164:167], a[56:59], v[8:11]
  buffer_load_dwordx4 v238, s[20:23], s31 offen offset:0 lds
  v_mfma_f32_16x16x32_bf16 v[12:15], a[164:167], a[60:63], v[12:15]
  ds_read_b64_tr_b16 a[182:183], v150 offset:9216
  v_min3_u32 v138, v138, v141, v142
  v_mfma_f32_16x16x32_bf16 v[12:15], a[160:163], a[44:47], v[12:15]
  s_waitcnt lgkmcnt(4)
  v_min_u32_dpp v138, v138, v138 row_ror:8 row_mask:0xf bank_mask:0xf
  v_mfma_f32_16x16x32_bf16 v[16:19], a[168:171], a[32:35], v[16:19]
  ds_read_b64_tr_b16 a[184:185], v151 offset:0
  v_min_u32_dpp v138, v138, v138 row_ror:4 row_mask:0xf bank_mask:0xf
  v_mfma_f32_16x16x32_bf16 v[16:19], a[172:175], a[48:51], v[16:19]
  buffer_load_dwordx4 a[4:7], v242, s[24:27], s30 offen offset:1024 sc1
  v_mfma_f32_16x16x32_bf16 v[20:23], a[172:175], a[52:55], v[20:23]
  ds_read_b64_tr_b16 a[186:187], v151 offset:1024
  v_min_u32_dpp v138, v138, v138 row_ror:2 row_mask:0xf bank_mask:0xf
  v_mfma_f32_16x16x32_bf16 v[20:23], a[168:171], a[36:39], v[20:23]
  v_mfma_f32_16x16x32_bf16 v[24:27], a[168:171], a[40:43], v[24:27]
  ds_read_b64_tr_b16 a[188:189], v151 offset:8192
  v_min_u32_dpp v138, v138, v138 row_ror:1 row_mask:0xf bank_mask:0xf
  v_mfma_f32_16x16x32_bf16 v[24:27], a[172:175], a[56:59], v[24:27]
  v_sub_u32 v137, v136, v138
  v_add_u32 v136, -1, v137
  v_mfma_f32_16x16x32_bf16 v[28:31], a[172:175], a[60:63], v[28:31]
  ds_read_b64_tr_b16 a[190:191], v151 offset:9216
  v_sub_u32 v139, v136, v128
  v_mfma_f32_16x16x32_bf16 v[28:31], a[168:171], a[44:47], v[28:31]
  s_waitcnt lgkmcnt(4)
  v_mov_b32_dpp v144, v137 quad_perm:[0,1,2,3] row_mask:0xf bank_mask:0x8
  v_sub_u32 v140, v136, v129
  v_mfma_f32_16x16x32_bf16 v[32:35], a[176:179], a[32:35], v[32:35]
  ds_read_b64_tr_b16 a[160:161], v152 offset:0
  v_min_u32 v138, v139, v140
  v_mfma_f32_16x16x32_bf16 v[32:35], a[180:183], a[48:51], v[32:35]
  buffer_load_dwordx4 a[8:11], v242, s[24:27], s30 offen offset:2048 sc1
  v_mfma_f32_16x16x32_bf16 v[36:39], a[180:183], a[52:55], v[36:39]
  ds_read_b64_tr_b16 a[162:163], v152 offset:1024
  v_sub_u32 v141, v136, v130
  v_mfma_f32_16x16x32_bf16 v[36:39], a[176:179], a[36:39], v[36:39]
  v_sub_u32 v142, v136, v131
  v_min3_u32 v138, v138, v141, v142
  v_mfma_f32_16x16x32_bf16 v[40:43], a[176:179], a[40:43], v[40:43]
  ds_read_b64_tr_b16 a[164:165], v152 offset:8192
  v_sub_u32 v139, v136, v132
  v_mfma_f32_16x16x32_bf16 v[40:43], a[180:183], a[56:59], v[40:43]
  buffer_load_dwordx4 v239, s[20:23], s31 offen offset:1024 lds
  v_mfma_f32_16x16x32_bf16 v[44:47], a[180:183], a[60:63], v[44:47]
  ds_read_b64_tr_b16 a[166:167], v152 offset:9216
  v_sub_u32 v140, v136, v133
  v_mfma_f32_16x16x32_bf16 v[44:47], a[176:179], a[44:47], v[44:47]
  s_waitcnt lgkmcnt(4)
  v_min3_u32 v138, v138, v139, v140
  v_sub_u32 v141, v136, v134
  v_mfma_f32_16x16x32_bf16 v[48:51], a[184:187], a[32:35], v[48:51]
  ds_read_b64_tr_b16 a[168:169], v153 offset:0
  v_sub_u32 v142, v136, v135
  v_mfma_f32_16x16x32_bf16 v[48:51], a[188:191], a[48:51], v[48:51]
  buffer_load_dwordx4 a[12:15], v242, s[24:27], s30 offen offset:3072 sc1
  v_mfma_f32_16x16x32_bf16 v[52:55], a[188:191], a[52:55], v[52:55]
  ds_read_b64_tr_b16 a[170:171], v153 offset:1024
  v_min3_u32 v138, v138, v141, v142
  v_mfma_f32_16x16x32_bf16 v[52:55], a[184:187], a[36:39], v[52:55]
  v_mfma_f32_16x16x32_bf16 v[56:59], a[184:187], a[40:43], v[56:59]
  ds_read_b64_tr_b16 a[172:173], v153 offset:8192
  v_min_u32_dpp v138, v138, v138 row_ror:8 row_mask:0xf bank_mask:0xf
  v_mfma_f32_16x16x32_bf16 v[56:59], a[188:191], a[56:59], v[56:59]
  v_mfma_f32_16x16x32_bf16 v[60:63], a[188:191], a[60:63], v[60:63]
  ds_read_b64_tr_b16 a[174:175], v153 offset:9216
  v_min_u32_dpp v138, v138, v138 row_ror:4 row_mask:0xf bank_mask:0xf
  v_mfma_f32_16x16x32_bf16 v[60:63], a[184:187], a[44:47], v[60:63]
  s_waitcnt lgkmcnt(4)
  v_min_u32_dpp v138, v138, v138 row_ror:2 row_mask:0xf bank_mask:0xf
  v_mfma_f32_16x16x32_bf16 v[64:67], a[160:163], a[32:35], v[64:67]
  ds_read_b64_tr_b16 a[176:177], v154 offset:0
  v_min_u32_dpp v138, v138, v138 row_ror:1 row_mask:0xf bank_mask:0xf
  v_mfma_f32_16x16x32_bf16 v[64:67], a[164:167], a[48:51], v[64:67]
  buffer_load_dwordx4 a[16:19], v243, s[24:27], s30 offen offset:0 sc1
  v_mfma_f32_16x16x32_bf16 v[68:71], a[164:167], a[52:55], v[68:71]
  ds_read_b64_tr_b16 a[178:179], v154 offset:1024
  v_sub_u32 v137, v136, v138
  v_mfma_f32_16x16x32_bf16 v[68:71], a[160:163], a[36:39], v[68:71]
  v_add_u32 v136, -1, v137
  v_sub_u32 v139, v136, v128
  v_mfma_f32_16x16x32_bf16 v[72:75], a[160:163], a[40:43], v[72:75]
  ds_read_b64_tr_b16 a[180:181], v154 offset:8192
  v_mov_b32_dpp v145, v137 quad_perm:[0,1,2,3] row_mask:0xf bank_mask:0x1
  v_mfma_f32_16x16x32_bf16 v[72:75], a[164:167], a[56:59], v[72:75]
  buffer_load_dwordx4 v240, s[20:23], s31 offen offset:2048 lds
  v_mfma_f32_16x16x32_bf16 v[76:79], a[164:167], a[60:63], v[76:79]
  ds_read_b64_tr_b16 a[182:183], v154 offset:9216
  v_sub_u32 v140, v136, v129
  v_mfma_f32_16x16x32_bf16 v[76:79], a[160:163], a[44:47], v[76:79]
  s_waitcnt lgkmcnt(4)
  v_min_u32 v138, v139, v140
  v_sub_u32 v141, v136, v130
  v_mfma_f32_16x16x32_bf16 v[80:83], a[168:171], a[32:35], v[80:83]
  ds_read_b64_tr_b16 a[184:185], v155 offset:0
  v_sub_u32 v142, v136, v131
  v_mfma_f32_16x16x32_bf16 v[80:83], a[172:175], a[48:51], v[80:83]
  buffer_load_dwordx4 a[20:23], v243, s[24:27], s30 offen offset:1024 sc1
  v_mfma_f32_16x16x32_bf16 v[84:87], a[172:175], a[52:55], v[84:87]
  ds_read_b64_tr_b16 a[186:187], v155 offset:1024
  v_min3_u32 v138, v138, v141, v142
  v_mfma_f32_16x16x32_bf16 v[84:87], a[168:171], a[36:39], v[84:87]
  s_waitcnt vmcnt(22)
  v_sub_u32 v139, v136, v132
  v_sub_u32 v140, v136, v133
  v_mfma_f32_16x16x32_bf16 v[88:91], a[168:171], a[40:43], v[88:91]
  ds_read_b64_tr_b16 a[188:189], v155 offset:8192
  v_min3_u32 v138, v138, v139, v140
  v_mfma_f32_16x16x32_bf16 v[88:91], a[172:175], a[56:59], v[88:91]
  s_barrier
  v_sub_u32 v141, v136, v134
  v_sub_u32 v142, v136, v135
  v_mfma_f32_16x16x32_bf16 v[92:95], a[172:175], a[60:63], v[92:95]
  ds_read_b64_tr_b16 a[190:191], v155 offset:9216
  v_min3_u32 v138, v138, v141, v142
  v_mfma_f32_16x16x32_bf16 v[92:95], a[168:171], a[44:47], v[92:95]
  s_waitcnt lgkmcnt(4)
  v_min_u32_dpp v138, v138, v138 row_ror:8 row_mask:0xf bank_mask:0xf
  v_mfma_f32_16x16x32_bf16 v[96:99], a[176:179], a[32:35], v[96:99]
  ds_read_b64_tr_b16 a[160:161], v224 offset:0
  v_min_u32_dpp v138, v138, v138 row_ror:4 row_mask:0xf bank_mask:0xf
  v_mfma_f32_16x16x32_bf16 v[96:99], a[180:183], a[48:51], v[96:99]
  buffer_load_dwordx4 a[24:27], v243, s[24:27], s30 offen offset:2048 sc1
  v_mfma_f32_16x16x32_bf16 v[100:103], a[180:183], a[52:55], v[100:103]
  ds_read_b64_tr_b16 a[162:163], v224 offset:1024
  v_min_u32_dpp v138, v138, v138 row_ror:2 row_mask:0xf bank_mask:0xf
  v_mfma_f32_16x16x32_bf16 v[100:103], a[176:179], a[36:39], v[100:103]
  v_mfma_f32_16x16x32_bf16 v[104:107], a[176:179], a[40:43], v[104:107]
  ds_read_b64_tr_b16 a[164:165], v224 offset:8192
  v_min_u32_dpp v138, v138, v138 row_ror:1 row_mask:0xf bank_mask:0xf
  v_mfma_f32_16x16x32_bf16 v[104:107], a[180:183], a[56:59], v[104:107]
  buffer_load_dwordx4 v241, s[20:23], s31 offen offset:3072 lds
  s_add_u32 s31, s31, 0x80000
  v_mfma_f32_16x16x32_bf16 v[108:111], a[180:183], a[60:63], v[108:111]
  ds_read_b64_tr_b16 a[166:167], v224 offset:9216
  v_sub_u32 v137, v136, v138
  v_mfma_f32_16x16x32_bf16 v[108:111], a[176:179], a[44:47], v[108:111]
  s_waitcnt lgkmcnt(4)
  v_add_u32 v136, -1, v137
  v_sub_u32 v139, v136, v128
  v_mfma_f32_16x16x32_bf16 v[112:115], a[184:187], a[32:35], v[112:115]
  ds_read_b64_tr_b16 a[168:169], v225 offset:0
  v_mov_b32_dpp v145, v137 quad_perm:[0,1,2,3] row_mask:0xf bank_mask:0x2
  v_mfma_f32_16x16x32_bf16 v[112:115], a[188:191], a[48:51], v[112:115]
  buffer_load_dwordx4 a[28:31], v243, s[24:27], s30 offen offset:3072 sc1
  s_add_u32 s30, s30, 8192
  v_mfma_f32_16x16x32_bf16 v[116:119], a[188:191], a[52:55], v[116:119]
  ds_read_b64_tr_b16 a[170:171], v225 offset:1024
  v_sub_u32 v140, v136, v129
  v_mfma_f32_16x16x32_bf16 v[116:119], a[184:187], a[36:39], v[116:119]
  v_min_u32 v138, v139, v140
  v_sub_u32 v141, v136, v130
  v_mfma_f32_16x16x32_bf16 v[120:123], a[184:187], a[40:43], v[120:123]
  ds_read_b64_tr_b16 a[172:173], v225 offset:8192
  v_sub_u32 v142, v136, v131
  v_mfma_f32_16x16x32_bf16 v[120:123], a[188:191], a[56:59], v[120:123]
  v_min3_u32 v138, v138, v141, v142
  v_sub_u32 v139, v136, v132
  v_mfma_f32_16x16x32_bf16 v[124:127], a[188:191], a[60:63], v[124:127]
  ds_read_b64_tr_b16 a[174:175], v225 offset:9216
  v_sub_u32 v140, v136, v133
  v_mfma_f32_16x16x32_bf16 v[124:127], a[184:187], a[44:47], v[124:127]
  s_waitcnt vmcnt(24) lgkmcnt(4)
  v_min3_u32 v138, v138, v139, v140
  v_sub_u32 v141, v136, v134
  v_mfma_f32_16x16x32_bf16 v[0:3], a[160:163], a[64:67], v[0:3]
  ds_read_b64_tr_b16 a[176:177], v226 offset:0
  v_sub_u32 v142, v136, v135
  v_mfma_f32_16x16x32_bf16 v[0:3], a[164:167], a[80:83], v[0:3]
  buffer_load_dwordx4 a[32:35], v242, s[24:27], s30 offen offset:0 sc1
  v_mfma_f32_16x16x32_bf16 v[4:7], a[164:167], a[84:87], v[4:7]
  ds_read_b64_tr_b16 a[178:179], v226 offset:1024
  v_min3_u32 v138, v138, v141, v142
  v_mfma_f32_16x16x32_bf16 v[4:7], a[160:163], a[68:71], v[4:7]
  v_mfma_f32_16x16x32_bf16 v[8:11], a[160:163], a[72:75], v[8:11]
  ds_read_b64_tr_b16 a[180:181], v226 offset:8192
  s_add_u32 m0, s28, 114688
  v_min_u32_dpp v138, v138, v138 row_ror:8 row_mask:0xf bank_mask:0xf
  v_mfma_f32_16x16x32_bf16 v[8:11], a[164:167], a[88:91], v[8:11]
  buffer_load_dwordx4 v238, s[20:23], s31 offen offset:0 lds
  v_mfma_f32_16x16x32_bf16 v[12:15], a[164:167], a[92:95], v[12:15]
  ds_read_b64_tr_b16 a[182:183], v226 offset:9216
  v_min_u32_dpp v138, v138, v138 row_ror:4 row_mask:0xf bank_mask:0xf
  v_mfma_f32_16x16x32_bf16 v[12:15], a[160:163], a[76:79], v[12:15]
  s_waitcnt lgkmcnt(4)
  v_min_u32_dpp v138, v138, v138 row_ror:2 row_mask:0xf bank_mask:0xf
  v_mfma_f32_16x16x32_bf16 v[16:19], a[168:171], a[64:67], v[16:19]
  ds_read_b64_tr_b16 a[184:185], v227 offset:0
  v_min_u32_dpp v138, v138, v138 row_ror:1 row_mask:0xf bank_mask:0xf
  v_mfma_f32_16x16x32_bf16 v[16:19], a[172:175], a[80:83], v[16:19]
  buffer_load_dwordx4 a[36:39], v242, s[24:27], s30 offen offset:1024 sc1
  v_mfma_f32_16x16x32_bf16 v[20:23], a[172:175], a[84:87], v[20:23]
  ds_read_b64_tr_b16 a[186:187], v227 offset:1024
  v_sub_u32 v137, v136, v138
  v_mfma_f32_16x16x32_bf16 v[20:23], a[168:171], a[68:71], v[20:23]
  v_add_u32 v136, -1, v137
  v_sub_u32 v139, v136, v128
  v_mfma_f32_16x16x32_bf16 v[24:27], a[168:171], a[72:75], v[24:27]
  ds_read_b64_tr_b16 a[188:189], v227 offset:8192
  v_mov_b32_dpp v145, v137 quad_perm:[0,1,2,3] row_mask:0xf bank_mask:0x4
  v_mfma_f32_16x16x32_bf16 v[24:27], a[172:175], a[88:91], v[24:27]
  v_sub_u32 v140, v136, v129
  v_min_u32 v138, v139, v140
  v_mfma_f32_16x16x32_bf16 v[28:31], a[172:175], a[92:95], v[28:31]
  ds_read_b64_tr_b16 a[190:191], v227 offset:9216
  v_sub_u32 v141, v136, v130
  v_mfma_f32_16x16x32_bf16 v[28:31], a[168:171], a[76:79], v[28:31]
  s_waitcnt lgkmcnt(4)
  v_sub_u32 v142, v136, v131
  v_min3_u32 v138, v138, v141, v142
  v_mfma_f32_16x16x32_bf16 v[32:35], a[176:179], a[64:67], v[32:35]
  ds_read_b64_tr_b16 a[160:161], v228 offset:0
  v_sub_u32 v139, v136, v132
  v_mfma_f32_16x16x32_bf16 v[32:35], a[180:183], a[80:83], v[32:35]
  buffer_load_dwordx4 a[40:43], v242, s[24:27], s30 offen offset:2048 sc1
  v_mfma_f32_16x16x32_bf16 v[36:39], a[180:183], a[84:87], v[36:39]
  ds_read_b64_tr_b16 a[162:163], v228 offset:1024
  v_sub_u32 v140, v136, v133
  v_mfma_f32_16x16x32_bf16 v[36:39], a[176:179], a[68:71], v[36:39]
  v_min3_u32 v138, v138, v139, v140
  v_sub_u32 v141, v136, v134
  v_mfma_f32_16x16x32_bf16 v[40:43], a[176:179], a[72:75], v[40:43]
  ds_read_b64_tr_b16 a[164:165], v228 offset:8192
  v_sub_u32 v142, v136, v135
  v_mfma_f32_16x16x32_bf16 v[40:43], a[180:183], a[88:91], v[40:43]
  buffer_load_dwordx4 v239, s[20:23], s31 offen offset:1024 lds
  v_mfma_f32_16x16x32_bf16 v[44:47], a[180:183], a[92:95], v[44:47]
  ds_read_b64_tr_b16 a[166:167], v228 offset:9216
  v_min3_u32 v138, v138, v141, v142
  v_mfma_f32_16x16x32_bf16 v[44:47], a[176:179], a[76:79], v[44:47]
  s_waitcnt lgkmcnt(4)
  v_min_u32_dpp v138, v138, v138 row_ror:8 row_mask:0xf bank_mask:0xf
  v_mfma_f32_16x16x32_bf16 v[48:51], a[184:187], a[64:67], v[48:51]
  ds_read_b64_tr_b16 a[168:169], v229 offset:0
  v_min_u32_dpp v138, v138, v138 row_ror:4 row_mask:0xf bank_mask:0xf
  v_mfma_f32_16x16x32_bf16 v[48:51], a[188:191], a[80:83], v[48:51]
  buffer_load_dwordx4 a[44:47], v242, s[24:27], s30 offen offset:3072 sc1
  v_mfma_f32_16x16x32_bf16 v[52:55], a[188:191], a[84:87], v[52:55]
  ds_read_b64_tr_b16 a[170:171], v229 offset:1024
  v_min_u32_dpp v138, v138, v138 row_ror:2 row_mask:0xf bank_mask:0xf
  v_mfma_f32_16x16x32_bf16 v[52:55], a[184:187], a[68:71], v[52:55]
  v_mfma_f32_16x16x32_bf16 v[56:59], a[184:187], a[72:75], v[56:59]
  ds_read_b64_tr_b16 a[172:173], v229 offset:8192
  v_min_u32_dpp v138, v138, v138 row_ror:1 row_mask:0xf bank_mask:0xf
  v_mfma_f32_16x16x32_bf16 v[56:59], a[188:191], a[88:91], v[56:59]
  v_sub_u32 v137, v136, v138
  v_add_u32 v136, -1, v137
  v_mfma_f32_16x16x32_bf16 v[60:63], a[188:191], a[92:95], v[60:63]
  ds_read_b64_tr_b16 a[174:175], v229 offset:9216
  v_mov_b32_dpp v145, v137 quad_perm:[0,1,2,3] row_mask:0xf bank_mask:0x8
  v_mfma_f32_16x16x32_bf16 v[60:63], a[184:187], a[76:79], v[60:63]
  s_waitcnt lgkmcnt(4)
  s_lshl_b32 s35, s3, 9
  s_add_u32 s35, s35, 157696
  v_lshrrev_b32 v136, 1, v242
  v_add_u32 v136, s35, v136
  v_mfma_f32_16x16x32_bf16 v[64:67], a[160:163], a[64:67], v[64:67]
  ds_read_b64_tr_b16 a[176:177], v230 offset:0
  ds_write_b64 v136, v[144:145]
  v_mfma_f32_16x16x32_bf16 v[64:67], a[164:167], a[80:83], v[64:67]
  buffer_load_dwordx4 a[48:51], v243, s[24:27], s30 offen offset:0 sc1
  v_mfma_f32_16x16x32_bf16 v[68:71], a[164:167], a[84:87], v[68:71]
  ds_read_b64_tr_b16 a[178:179], v230 offset:1024
  v_mfma_f32_16x16x32_bf16 v[68:71], a[160:163], a[68:71], v[68:71]
  v_mfma_f32_16x16x32_bf16 v[72:75], a[160:163], a[72:75], v[72:75]
  ds_read_b64_tr_b16 a[180:181], v230 offset:8192
  v_mfma_f32_16x16x32_bf16 v[72:75], a[164:167], a[88:91], v[72:75]
  buffer_load_dwordx4 v240, s[20:23], s31 offen offset:2048 lds
  v_mfma_f32_16x16x32_bf16 v[76:79], a[164:167], a[92:95], v[76:79]
  ds_read_b64_tr_b16 a[182:183], v230 offset:9216
  v_mfma_f32_16x16x32_bf16 v[76:79], a[160:163], a[76:79], v[76:79]
  s_waitcnt lgkmcnt(5)
  v_mfma_f32_16x16x32_bf16 v[80:83], a[168:171], a[64:67], v[80:83]
  ds_read_b64_tr_b16 a[184:185], v231 offset:0
  s_waitcnt lgkmcnt(4)
  v_mfma_f32_16x16x32_bf16 v[80:83], a[172:175], a[80:83], v[80:83]
  buffer_load_dwordx4 a[52:55], v243, s[24:27], s30 offen offset:1024 sc1
  v_mfma_f32_16x16x32_bf16 v[84:87], a[172:175], a[84:87], v[84:87]
  ds_read_b64_tr_b16 a[186:187], v231 offset:1024
  v_mfma_f32_16x16x32_bf16 v[84:87], a[168:171], a[68:71], v[84:87]
  s_waitcnt vmcnt(22)
  v_mfma_f32_16x16x32_bf16 v[88:91], a[168:171], a[72:75], v[88:91]
  ds_read_b64_tr_b16 a[188:189], v231 offset:8192
  v_mfma_f32_16x16x32_bf16 v[88:91], a[172:175], a[88:91], v[88:91]
  s_barrier
  v_mfma_f32_16x16x32_bf16 v[92:95], a[172:175], a[92:95], v[92:95]
  ds_read_b64_tr_b16 a[190:191], v231 offset:9216
  v_lshlrev_b32 v137, 1, v242
  v_mfma_f32_16x16x32_bf16 v[92:95], a[168:171], a[76:79], v[92:95]
  s_waitcnt lgkmcnt(4)
  v_add_u32 v137, 157696, v137
  v_mfma_f32_16x16x32_bf16 v[96:99], a[176:179], a[64:67], v[96:99]
  ds_read_b64_tr_b16 a[160:161], v224 offset:16384
  ds_read_b64 v[128:129], v137
  v_mfma_f32_16x16x32_bf16 v[96:99], a[180:183], a[80:83], v[96:99]
  buffer_load_dwordx4 a[56:59], v243, s[24:27], s30 offen offset:2048 sc1
  v_mfma_f32_16x16x32_bf16 v[100:103], a[180:183], a[84:87], v[100:103]
  ds_read_b64_tr_b16 a[162:163], v224 offset:17408
  v_mfma_f32_16x16x32_bf16 v[100:103], a[176:179], a[68:71], v[100:103]
  v_mfma_f32_16x16x32_bf16 v[104:107], a[176:179], a[72:75], v[104:107]
  ds_read_b64_tr_b16 a[164:165], v224 offset:24576
  v_mfma_f32_16x16x32_bf16 v[104:107], a[180:183], a[88:91], v[104:107]
  buffer_load_dwordx4 v241, s[20:23], s31 offen offset:3072 lds
  s_add_u32 s31, s31, 0x80000
  v_mfma_f32_16x16x32_bf16 v[108:111], a[180:183], a[92:95], v[108:111]
  ds_read_b64_tr_b16 a[166:167], v224 offset:25600
  v_mfma_f32_16x16x32_bf16 v[108:111], a[176:179], a[76:79], v[108:111]
  s_waitcnt lgkmcnt(5)
  v_mfma_f32_16x16x32_bf16 v[112:115], a[184:187], a[64:67], v[112:115]
  ds_read_b64_tr_b16 a[168:169], v225 offset:16384
  s_waitcnt lgkmcnt(4)
  v_mov_b32 v137, -1
  v_mfma_f32_16x16x32_bf16 v[112:115], a[188:191], a[80:83], v[112:115]
  buffer_load_dwordx4 a[60:63], v243, s[24:27], s30 offen offset:3072 sc1
  s_add_u32 s30, s30, 8192
  v_mfma_f32_16x16x32_bf16 v[116:119], a[188:191], a[84:87], v[116:119]
  ds_read_b64_tr_b16 a[170:171], v225 offset:17408
  v_sub_u32 v140, v137, v128
  v_mfma_f32_16x16x32_bf16 v[116:119], a[184:187], a[68:71], v[116:119]
  v_sub_u32 v141, v137, v129
  v_min_u32 v139, v140, v141
  v_mfma_f32_16x16x32_bf16 v[120:123], a[184:187], a[72:75], v[120:123]
  ds_read_b64_tr_b16 a[172:173], v225 offset:24576
  v_min_u32_dpp v139, v139, v139 row_ror:8 row_mask:0xf bank_mask:0xf
  v_mfma_f32_16x16x32_bf16 v[120:123], a[188:191], a[88:91], v[120:123]
  v_mfma_f32_16x16x32_bf16 v[124:127], a[188:191], a[92:95], v[124:127]
  ds_read_b64_tr_b16 a[174:175], v225 offset:25600
  v_min_u32_dpp v139, v139, v139 row_ror:4 row_mask:0xf bank_mask:0xf
  v_mfma_f32_16x16x32_bf16 v[124:127], a[184:187], a[76:79], v[124:127]
  s_waitcnt vmcnt(24) lgkmcnt(4)
  v_min_u32_dpp v139, v139, v139 row_ror:2 row_mask:0xf bank_mask:0xf
  v_mfma_f32_16x16x32_bf16 v[0:3], a[160:163], a[96:99], v[0:3]
  ds_read_b64_tr_b16 a[176:177], v226 offset:16384
  v_min_u32_dpp v139, v139, v139 row_ror:1 row_mask:0xf bank_mask:0xf
  v_mfma_f32_16x16x32_bf16 v[0:3], a[164:167], a[112:115], v[0:3]
  v_mov_b32 v140, v139
  v_mfma_f32_16x16x32_bf16 v[4:7], a[164:167], a[116:119], v[4:7]
  ds_read_b64_tr_b16 a[178:179], v226 offset:17408
  v_permlane16_swap_b32 v139, v140
  v_mfma_f32_16x16x32_bf16 v[4:7], a[160:163], a[100:103], v[4:7]
  v_min_u32 v139, v139, v140
  v_mov_b32 v140, v139
  v_mfma_f32_16x16x32_bf16 v[8:11], a[160:163], a[104:107], v[8:11]
  ds_read_b64_tr_b16 a[180:181], v226 offset:24576
  s_add_u32 m0, s28, 0
  v_permlane32_swap_b32 v139, v140
  v_mfma_f32_16x16x32_bf16 v[8:11], a[164:167], a[120:123], v[8:11]
  buffer_load_dwordx4 v232, s[12:15], s29 offen offset:0 lds
  v_mfma_f32_16x16x32_bf16 v[12:15], a[164:167], a[124:127], v[12:15]
  ds_read_b64_tr_b16 a[182:183], v226 offset:25600
  v_min_u32 v139, v139, v140
  v_mfma_f32_16x16x32_bf16 v[12:15], a[160:163], a[108:111], v[12:15]
  s_waitcnt lgkmcnt(4)
  v_sub_u32 v138, v137, v139
  v_add_u32 v137, -1, v138
  v_mfma_f32_16x16x32_bf16 v[16:19], a[168:171], a[96:99], v[16:19]
  ds_read_b64_tr_b16 a[184:185], v227 offset:16384
  v_sub_u32 v140, v137, v128
  v_mfma_f32_16x16x32_bf16 v[16:19], a[172:175], a[112:115], v[16:19]
  v_readfirstlane_b32 s52, v138
  v_sub_u32 v141, v137, v129
  v_mfma_f32_16x16x32_bf16 v[20:23], a[172:175], a[116:119], v[20:23]
  ds_read_b64_tr_b16 a[186:187], v227 offset:17408
  v_min_u32 v139, v140, v141
  v_mfma_f32_16x16x32_bf16 v[20:23], a[168:171], a[100:103], v[20:23]
  v_mfma_f32_16x16x32_bf16 v[24:27], a[168:171], a[104:107], v[24:27]
  ds_read_b64_tr_b16 a[188:189], v227 offset:24576
  v_min_u32_dpp v139, v139, v139 row_ror:8 row_mask:0xf bank_mask:0xf
  v_mfma_f32_16x16x32_bf16 v[24:27], a[172:175], a[120:123], v[24:27]
  v_mfma_f32_16x16x32_bf16 v[28:31], a[172:175], a[124:127], v[28:31]
  ds_read_b64_tr_b16 a[190:191], v227 offset:25600
  v_min_u32_dpp v139, v139, v139 row_ror:4 row_mask:0xf bank_mask:0xf
  v_mfma_f32_16x16x32_bf16 v[28:31], a[168:171], a[108:111], v[28:31]
  s_waitcnt lgkmcnt(4)
  v_min_u32_dpp v139, v139, v139 row_ror:2 row_mask:0xf bank_mask:0xf
  v_mfma_f32_16x16x32_bf16 v[32:35], a[176:179], a[96:99], v[32:35]
  ds_read_b64_tr_b16 a[160:161], v228 offset:16384
  v_min_u32_dpp v139, v139, v139 row_ror:1 row_mask:0xf bank_mask:0xf
  v_mfma_f32_16x16x32_bf16 v[32:35], a[180:183], a[112:115], v[32:35]
  v_mov_b32 v140, v139
  v_mfma_f32_16x16x32_bf16 v[36:39], a[180:183], a[116:119], v[36:39]
  ds_read_b64_tr_b16 a[162:163], v228 offset:17408
  v_permlane16_swap_b32 v139, v140
  v_mfma_f32_16x16x32_bf16 v[36:39], a[176:179], a[100:103], v[36:39]
  v_min_u32 v139, v139, v140
  v_mov_b32 v140, v139
  v_mfma_f32_16x16x32_bf16 v[40:43], a[176:179], a[104:107], v[40:43]
  ds_read_b64_tr_b16 a[164:165], v228 offset:24576
  v_permlane32_swap_b32 v139, v140
  v_mfma_f32_16x16x32_bf16 v[40:43], a[180:183], a[120:123], v[40:43]
  buffer_load_dwordx4 v233, s[12:15], s29 offen offset:1024 lds
  v_mfma_f32_16x16x32_bf16 v[44:47], a[180:183], a[124:127], v[44:47]
  ds_read_b64_tr_b16 a[166:167], v228 offset:25600
  v_min_u32 v139, v139, v140
  v_mfma_f32_16x16x32_bf16 v[44:47], a[176:179], a[108:111], v[44:47]
  s_waitcnt lgkmcnt(4)
  v_sub_u32 v138, v137, v139
  v_add_u32 v137, -1, v138
  v_mfma_f32_16x16x32_bf16 v[48:51], a[184:187], a[96:99], v[48:51]
  ds_read_b64_tr_b16 a[168:169], v229 offset:16384
  v_sub_u32 v140, v137, v128
  v_mfma_f32_16x16x32_bf16 v[48:51], a[188:191], a[112:115], v[48:51]
  v_readfirstlane_b32 s53, v138
  v_sub_u32 v141, v137, v129
  v_mfma_f32_16x16x32_bf16 v[52:55], a[188:191], a[116:119], v[52:55]
  ds_read_b64_tr_b16 a[170:171], v229 offset:17408
  v_min_u32 v139, v140, v141
  v_mfma_f32_16x16x32_bf16 v[52:55], a[184:187], a[100:103], v[52:55]
  v_mfma_f32_16x16x32_bf16 v[56:59], a[184:187], a[104:107], v[56:59]
  ds_read_b64_tr_b16 a[172:173], v229 offset:24576
  v_min_u32_dpp v139, v139, v139 row_ror:8 row_mask:0xf bank_mask:0xf
  v_mfma_f32_16x16x32_bf16 v[56:59], a[188:191], a[120:123], v[56:59]
  v_mfma_f32_16x16x32_bf16 v[60:63], a[188:191], a[124:127], v[60:63]
  ds_read_b64_tr_b16 a[174:175], v229 offset:25600
  v_min_u32_dpp v139, v139, v139 row_ror:4 row_mask:0xf bank_mask:0xf
  v_mfma_f32_16x16x32_bf16 v[60:63], a[184:187], a[108:111], v[60:63]
  s_waitcnt lgkmcnt(4)
  v_min_u32_dpp v139, v139, v139 row_ror:2 row_mask:0xf bank_mask:0xf
  v_mfma_f32_16x16x32_bf16 v[64:67], a[160:163], a[96:99], v[64:67]
  ds_read_b64_tr_b16 a[176:177], v230 offset:16384
  v_min_u32_dpp v139, v139, v139 row_ror:1 row_mask:0xf bank_mask:0xf
  v_mfma_f32_16x16x32_bf16 v[64:67], a[164:167], a[112:115], v[64:67]
  v_mov_b32 v140, v139
  v_mfma_f32_16x16x32_bf16 v[68:71], a[164:167], a[116:119], v[68:71]
  ds_read_b64_tr_b16 a[178:179], v230 offset:17408
  v_permlane16_swap_b32 v139, v140
  v_mfma_f32_16x16x32_bf16 v[68:71], a[160:163], a[100:103], v[68:71]
  v_min_u32 v139, v139, v140
  v_mov_b32 v140, v139
  v_mfma_f32_16x16x32_bf16 v[72:75], a[160:163], a[104:107], v[72:75]
  ds_read_b64_tr_b16 a[180:181], v230 offset:24576
  v_permlane32_swap_b32 v139, v140
  v_mfma_f32_16x16x32_bf16 v[72:75], a[164:167], a[120:123], v[72:75]
  buffer_load_dwordx4 v234, s[12:15], s29 offen offset:2048 lds
  v_mfma_f32_16x16x32_bf16 v[76:79], a[164:167], a[124:127], v[76:79]
  ds_read_b64_tr_b16 a[182:183], v230 offset:25600
  v_min_u32 v139, v139, v140
  v_mfma_f32_16x16x32_bf16 v[76:79], a[160:163], a[108:111], v[76:79]
  s_waitcnt lgkmcnt(4)
  v_sub_u32 v138, v137, v139
  v_add_u32 v137, -1, v138
  v_mfma_f32_16x16x32_bf16 v[80:83], a[168:171], a[96:99], v[80:83]
  ds_read_b64_tr_b16 a[184:185], v231 offset:16384
  v_sub_u32 v140, v137, v128
  v_mfma_f32_16x16x32_bf16 v[80:83], a[172:175], a[112:115], v[80:83]
  v_readfirstlane_b32 s54, v138
  v_sub_u32 v141, v137, v129
  v_mfma_f32_16x16x32_bf16 v[84:87], a[172:175], a[116:119], v[84:87]
  ds_read_b64_tr_b16 a[186:187], v231 offset:17408
  v_min_u32 v139, v140, v141
  v_mfma_f32_16x16x32_bf16 v[84:87], a[168:171], a[100:103], v[84:87]
  s_waitcnt vmcnt(16)
  v_min_u32_dpp v139, v139, v139 row_ror:8 row_mask:0xf bank_mask:0xf
  v_mfma_f32_16x16x32_bf16 v[88:91], a[168:171], a[104:107], v[88:91]
  ds_read_b64_tr_b16 a[188:189], v231 offset:24576
  v_min_u32_dpp v139, v139, v139 row_ror:4 row_mask:0xf bank_mask:0xf
  v_mfma_f32_16x16x32_bf16 v[88:91], a[172:175], a[120:123], v[88:91]
  s_barrier
  v_min_u32_dpp v139, v139, v139 row_ror:2 row_mask:0xf bank_mask:0xf
  v_mfma_f32_16x16x32_bf16 v[92:95], a[172:175], a[124:127], v[92:95]
  ds_read_b64_tr_b16 a[190:191], v231 offset:25600
  v_min_u32_dpp v139, v139, v139 row_ror:1 row_mask:0xf bank_mask:0xf
  v_mfma_f32_16x16x32_bf16 v[92:95], a[168:171], a[108:111], v[92:95]
  s_waitcnt lgkmcnt(4)
  v_mov_b32 v140, v139
  v_mfma_f32_16x16x32_bf16 v[96:99], a[176:179], a[96:99], v[96:99]
  ds_read_b64_tr_b16 a[160:161], v224 offset:32768
  v_permlane16_swap_b32 v139, v140
  v_mfma_f32_16x16x32_bf16 v[96:99], a[180:183], a[112:115], v[96:99]
  v_min_u32 v139, v139, v140
  v_mov_b32 v140, v139
  v_mfma_f32_16x16x32_bf16 v[100:103], a[180:183], a[116:119], v[100:103]
  ds_read_b64_tr_b16 a[162:163], v224 offset:33792
  v_permlane32_swap_b32 v139, v140
  v_mfma_f32_16x16x32_bf16 v[100:103], a[176:179], a[100:103], v[100:103]
  v_min_u32 v139, v139, v140
  v_sub_u32 v138, v137, v139
  v_mfma_f32_16x16x32_bf16 v[104:107], a[176:179], a[104:107], v[104:107]
  ds_read_b64_tr_b16 a[164:165], v224 offset:40960
  v_add_u32 v137, -1, v138
  v_mfma_f32_16x16x32_bf16 v[104:107], a[180:183], a[120:123], v[104:107]
  buffer_load_dwordx4 v235, s[12:15], s29 offen offset:3072 lds
  v_mfma_f32_16x16x32_bf16 v[108:111], a[180:183], a[124:127], v[108:111]
  ds_read_b64_tr_b16 a[166:167], v224 offset:41984
  v_sub_u32 v140, v137, v128
  v_mfma_f32_16x16x32_bf16 v[108:111], a[176:179], a[108:111], v[108:111]
  s_waitcnt lgkmcnt(4)
  v_readfirstlane_b32 s55, v138
  v_sub_u32 v141, v137, v129
  v_mfma_f32_16x16x32_bf16 v[112:115], a[184:187], a[96:99], v[112:115]
  ds_read_b64_tr_b16 a[168:169], v225 offset:32768
  v_min_u32 v139, v140, v141
  v_mfma_f32_16x16x32_bf16 v[112:115], a[188:191], a[112:115], v[112:115]
  v_mfma_f32_16x16x32_bf16 v[116:119], a[188:191], a[116:119], v[116:119]
  ds_read_b64_tr_b16 a[170:171], v225 offset:33792
  v_min_u32_dpp v139, v139, v139 row_ror:8 row_mask:0xf bank_mask:0xf
  v_mfma_f32_16x16x32_bf16 v[116:119], a[184:187], a[100:103], v[116:119]
  v_mfma_f32_16x16x32_bf16 v[120:123], a[184:187], a[104:107], v[120:123]
  ds_read_b64_tr_b16 a[172:173], v225 offset:40960
  v_min_u32_dpp v139, v139, v139 row_ror:4 row_mask:0xf bank_mask:0xf
  v_mfma_f32_16x16x32_bf16 v[120:123], a[188:191], a[120:123], v[120:123]
  v_mfma_f32_16x16x32_bf16 v[124:127], a[188:191], a[124:127], v[124:127]
  ds_read_b64_tr_b16 a[174:175], v225 offset:41984
  v_min_u32_dpp v139, v139, v139 row_ror:2 row_mask:0xf bank_mask:0xf
  v_mfma_f32_16x16x32_bf16 v[124:127], a[184:187], a[108:111], v[124:127]
  s_waitcnt vmcnt(16) lgkmcnt(4)
  v_min_u32_dpp v139, v139, v139 row_ror:1 row_mask:0xf bank_mask:0xf
  v_mov_b32 v140, v139
  v_mfma_f32_16x16x32_bf16 v[0:3], a[160:163], a[0:3], v[0:3]
  ds_read_b64_tr_b16 a[176:177], v226 offset:32768
  v_permlane16_swap_b32 v139, v140
  v_mfma_f32_16x16x32_bf16 v[0:3], a[164:167], a[16:19], v[0:3]
  v_min_u32 v139, v139, v140
  v_mov_b32 v140, v139
  v_mfma_f32_16x16x32_bf16 v[4:7], a[164:167], a[20:23], v[4:7]
  ds_read_b64_tr_b16 a[178:179], v226 offset:33792
  v_permlane32_swap_b32 v139, v140
  v_mfma_f32_16x16x32_bf16 v[4:7], a[160:163], a[4:7], v[4:7]
  v_min_u32 v139, v139, v140
  v_sub_u32 v138, v137, v139
  v_mfma_f32_16x16x32_bf16 v[8:11], a[160:163], a[8:11], v[8:11]
  ds_read_b64_tr_b16 a[180:181], v226 offset:40960
  s_add_u32 m0, s28, 65536
  v_add_u32 v137, -1, v138
  v_mfma_f32_16x16x32_bf16 v[8:11], a[164:167], a[24:27], v[8:11]
  buffer_load_dwordx4 v236, s[16:19], s29 offen offset:0 lds
  v_mfma_f32_16x16x32_bf16 v[12:15], a[164:167], a[28:31], v[12:15]
  ds_read_b64_tr_b16 a[182:183], v226 offset:41984
  v_sub_u32 v140, v137, v128
  v_mfma_f32_16x16x32_bf16 v[12:15], a[160:163], a[12:15], v[12:15]
  s_waitcnt lgkmcnt(4)
  v_readfirstlane_b32 s56, v138
  v_sub_u32 v141, v137, v129
  v_mfma_f32_16x16x32_bf16 v[16:19], a[168:171], a[0:3], v[16:19]
  ds_read_b64_tr_b16 a[184:185], v227 offset:32768
  v_min_u32 v139, v140, v141
  v_mfma_f32_16x16x32_bf16 v[16:19], a[172:175], a[16:19], v[16:19]
  v_mfma_f32_16x16x32_bf16 v[20:23], a[172:175], a[20:23], v[20:23]
  ds_read_b64_tr_b16 a[186:187], v227 offset:33792
  v_min_u32_dpp v139, v139, v139 row_ror:8 row_mask:0xf bank_mask:0xf
  v_mfma_f32_16x16x32_bf16 v[20:23], a[168:171], a[4:7], v[20:23]
  v_mfma_f32_16x16x32_bf16 v[24:27], a[168:171], a[8:11], v[24:27]
  ds_read_b64_tr_b16 a[188:189], v227 offset:40960
  v_min_u32_dpp v139, v139, v139 row_ror:4 row_mask:0xf bank_mask:0xf
  v_mfma_f32_16x16x32_bf16 v[24:27], a[172:175], a[24:27], v[24:27]
  v_mfma_f32_16x16x32_bf16 v[28:31], a[172:175], a[28:31], v[28:31]
  ds_read_b64_tr_b16 a[190:191], v227 offset:41984
  v_min_u32_dpp v139, v139, v139 row_ror:2 row_mask:0xf bank_mask:0xf
  v_mfma_f32_16x16x32_bf16 v[28:31], a[168:171], a[12:15], v[28:31]
  s_waitcnt lgkmcnt(4)
  v_min_u32_dpp v139, v139, v139 row_ror:1 row_mask:0xf bank_mask:0xf
  v_mov_b32 v140, v139
  v_mfma_f32_16x16x32_bf16 v[32:35], a[176:179], a[0:3], v[32:35]
  ds_read_b64_tr_b16 a[160:161], v228 offset:32768
  v_permlane16_swap_b32 v139, v140
  v_mfma_f32_16x16x32_bf16 v[32:35], a[180:183], a[16:19], v[32:35]
  v_min_u32 v139, v139, v140
  v_mov_b32 v140, v139
  v_mfma_f32_16x16x32_bf16 v[36:39], a[180:183], a[20:23], v[36:39]
  ds_read_b64_tr_b16 a[162:163], v228 offset:33792
  v_permlane32_swap_b32 v139, v140
  v_mfma_f32_16x16x32_bf16 v[36:39], a[176:179], a[4:7], v[36:39]
  v_min_u32 v139, v139, v140
  v_sub_u32 v138, v137, v139
  v_mfma_f32_16x16x32_bf16 v[40:43], a[176:179], a[8:11], v[40:43]
  ds_read_b64_tr_b16 a[164:165], v228 offset:40960
  v_add_u32 v137, -1, v138
  v_mfma_f32_16x16x32_bf16 v[40:43], a[180:183], a[24:27], v[40:43]
  buffer_load_dwordx4 v237, s[16:19], s29 offen offset:1024 lds
  v_mfma_f32_16x16x32_bf16 v[44:47], a[180:183], a[28:31], v[44:47]
  ds_read_b64_tr_b16 a[166:167], v228 offset:41984
  v_sub_u32 v140, v137, v128
  v_mfma_f32_16x16x32_bf16 v[44:47], a[176:179], a[12:15], v[44:47]
  s_waitcnt lgkmcnt(4)
  v_readfirstlane_b32 s57, v138
  v_sub_u32 v141, v137, v129
  v_mfma_f32_16x16x32_bf16 v[48:51], a[184:187], a[0:3], v[48:51]
  ds_read_b64_tr_b16 a[168:169], v229 offset:32768
  v_min_u32 v139, v140, v141
  v_mfma_f32_16x16x32_bf16 v[48:51], a[188:191], a[16:19], v[48:51]
  v_mfma_f32_16x16x32_bf16 v[52:55], a[188:191], a[20:23], v[52:55]
  ds_read_b64_tr_b16 a[170:171], v229 offset:33792
  v_min_u32_dpp v139, v139, v139 row_ror:8 row_mask:0xf bank_mask:0xf
  v_mfma_f32_16x16x32_bf16 v[52:55], a[184:187], a[4:7], v[52:55]
  v_mfma_f32_16x16x32_bf16 v[56:59], a[184:187], a[8:11], v[56:59]
  ds_read_b64_tr_b16 a[172:173], v229 offset:40960
  v_min_u32_dpp v139, v139, v139 row_ror:4 row_mask:0xf bank_mask:0xf
  v_mfma_f32_16x16x32_bf16 v[56:59], a[188:191], a[24:27], v[56:59]
  v_mfma_f32_16x16x32_bf16 v[60:63], a[188:191], a[28:31], v[60:63]
  ds_read_b64_tr_b16 a[174:175], v229 offset:41984
  v_min_u32_dpp v139, v139, v139 row_ror:2 row_mask:0xf bank_mask:0xf
  v_mfma_f32_16x16x32_bf16 v[60:63], a[184:187], a[12:15], v[60:63]
  s_waitcnt lgkmcnt(4)
  v_min_u32_dpp v139, v139, v139 row_ror:1 row_mask:0xf bank_mask:0xf
  v_mov_b32 v140, v139
  v_mfma_f32_16x16x32_bf16 v[64:67], a[160:163], a[0:3], v[64:67]
  ds_read_b64_tr_b16 a[176:177], v230 offset:32768
  v_permlane16_swap_b32 v139, v140
  v_mfma_f32_16x16x32_bf16 v[64:67], a[164:167], a[16:19], v[64:67]
  v_min_u32 v139, v139, v140
  v_mov_b32 v140, v139
  v_mfma_f32_16x16x32_bf16 v[68:71], a[164:167], a[20:23], v[68:71]
  ds_read_b64_tr_b16 a[178:179], v230 offset:33792
  v_permlane32_swap_b32 v139, v140
  v_mfma_f32_16x16x32_bf16 v[68:71], a[160:163], a[4:7], v[68:71]
  v_min_u32 v139, v139, v140
  v_sub_u32 v138, v137, v139
  v_mfma_f32_16x16x32_bf16 v[72:75], a[160:163], a[8:11], v[72:75]
  ds_read_b64_tr_b16 a[180:181], v230 offset:40960
  v_add_u32 v137, -1, v138
  v_mfma_f32_16x16x32_bf16 v[72:75], a[164:167], a[24:27], v[72:75]
  buffer_load_dwordx4 v236, s[16:19], s29 offen offset:2048 lds
  v_mfma_f32_16x16x32_bf16 v[76:79], a[164:167], a[28:31], v[76:79]
  ds_read_b64_tr_b16 a[182:183], v230 offset:41984
  v_sub_u32 v140, v137, v128
  v_mfma_f32_16x16x32_bf16 v[76:79], a[160:163], a[12:15], v[76:79]
  s_waitcnt lgkmcnt(4)
  v_readfirstlane_b32 s58, v138
  v_sub_u32 v141, v137, v129
  v_mfma_f32_16x16x32_bf16 v[80:83], a[168:171], a[0:3], v[80:83]
  ds_read_b64_tr_b16 a[184:185], v231 offset:32768
  v_min_u32 v139, v140, v141
  v_mfma_f32_16x16x32_bf16 v[80:83], a[172:175], a[16:19], v[80:83]
  v_mfma_f32_16x16x32_bf16 v[84:87], a[172:175], a[20:23], v[84:87]
  ds_read_b64_tr_b16 a[186:187], v231 offset:33792
  v_min_u32_dpp v139, v139, v139 row_ror:8 row_mask:0xf bank_mask:0xf
  v_mfma_f32_16x16x32_bf16 v[84:87], a[168:171], a[4:7], v[84:87]
  s_waitcnt vmcnt(8)
  v_min_u32_dpp v139, v139, v139 row_ror:4 row_mask:0xf bank_mask:0xf
  v_mfma_f32_16x16x32_bf16 v[88:91], a[168:171], a[8:11], v[88:91]
  ds_read_b64_tr_b16 a[188:189], v231 offset:40960
  v_min_u32_dpp v139, v139, v139 row_ror:2 row_mask:0xf bank_mask:0xf
  v_mfma_f32_16x16x32_bf16 v[88:91], a[172:175], a[24:27], v[88:91]
  s_barrier
  v_min_u32_dpp v139, v139, v139 row_ror:1 row_mask:0xf bank_mask:0xf
  v_mov_b32 v140, v139
  v_mfma_f32_16x16x32_bf16 v[92:95], a[172:175], a[28:31], v[92:95]
  ds_read_b64_tr_b16 a[190:191], v231 offset:41984
  v_permlane16_swap_b32 v139, v140
  v_mfma_f32_16x16x32_bf16 v[92:95], a[168:171], a[12:15], v[92:95]
  s_waitcnt lgkmcnt(4)
  v_min_u32 v139, v139, v140
  v_mov_b32 v140, v139
  v_mfma_f32_16x16x32_bf16 v[96:99], a[176:179], a[0:3], v[96:99]
  ds_read_b64_tr_b16 a[160:161], v224 offset:49152
  v_permlane32_swap_b32 v139, v140
  v_mfma_f32_16x16x32_bf16 v[96:99], a[180:183], a[16:19], v[96:99]
  v_min_u32 v139, v139, v140
  v_sub_u32 v138, v137, v139
  v_mfma_f32_16x16x32_bf16 v[100:103], a[180:183], a[20:23], v[100:103]
  ds_read_b64_tr_b16 a[162:163], v224 offset:50176
  v_add_u32 v137, -1, v138
  v_mfma_f32_16x16x32_bf16 v[100:103], a[176:179], a[4:7], v[100:103]
  v_readfirstlane_b32 s59, v138
  v_lshrrev_b32 v136, 4, v242
  v_mfma_f32_16x16x32_bf16 v[104:107], a[176:179], a[8:11], v[104:107]
  ds_read_b64_tr_b16 a[164:165], v224 offset:57344
  v_mov_b32 v128, 0
  v_mfma_f32_16x16x32_bf16 v[104:107], a[180:183], a[24:27], v[104:107]
  buffer_load_dwordx4 v237, s[16:19], s29 offen offset:3072 lds
  s_add_u32 s29, s29, 16384
  v_mfma_f32_16x16x32_bf16 v[108:111], a[180:183], a[28:31], v[108:111]
  ds_read_b64_tr_b16 a[166:167], v224 offset:58368
  v_writelane_b32 v128, s52, 0
  v_mfma_f32_16x16x32_bf16 v[108:111], a[176:179], a[12:15], v[108:111]
  s_waitcnt lgkmcnt(4)
  v_writelane_b32 v128, s53, 1
  v_writelane_b32 v128, s54, 2
  v_mfma_f32_16x16x32_bf16 v[112:115], a[184:187], a[0:3], v[112:115]
  ds_read_b64_tr_b16 a[168:169], v225 offset:49152
  v_writelane_b32 v128, s55, 3
  v_mfma_f32_16x16x32_bf16 v[112:115], a[188:191], a[16:19], v[112:115]
  v_writelane_b32 v128, s56, 4
  v_writelane_b32 v128, s57, 5
  v_mfma_f32_16x16x32_bf16 v[116:119], a[188:191], a[20:23], v[116:119]
  ds_read_b64_tr_b16 a[170:171], v225 offset:50176
  v_writelane_b32 v128, s58, 6
  v_mfma_f32_16x16x32_bf16 v[116:119], a[184:187], a[4:7], v[116:119]
  v_writelane_b32 v128, s59, 7
  v_and_b32 v129, 0xffff, v128
  v_mfma_f32_16x16x32_bf16 v[120:123], a[184:187], a[8:11], v[120:123]
  ds_read_b64_tr_b16 a[172:173], v225 offset:57344
  v_sub_u32 v129, 0xffff, v129
  v_mfma_f32_16x16x32_bf16 v[120:123], a[188:191], a[24:27], v[120:123]
  v_and_b32 v129, 0x7ff, v129
  v_mov_b32 v130, v129
  v_mfma_f32_16x16x32_bf16 v[124:127], a[188:191], a[28:31], v[124:127]
  ds_read_b64_tr_b16 a[174:175], v225 offset:58368
  v_permlane16_swap_b32 v129, v130
  v_mfma_f32_16x16x32_bf16 v[124:127], a[184:187], a[12:15], v[124:127]
  s_waitcnt vmcnt(8) lgkmcnt(4)
  v_mov_b32 v130, v129
  v_mfma_f32_16x16x32_bf16 v[0:3], a[160:163], a[32:35], v[0:3]
  ds_read_b64_tr_b16 a[176:177], v226 offset:49152
  s_add_u32 m0, s28, 16384
  v_permlane32_swap_b32 v129, v130
  v_mfma_f32_16x16x32_bf16 v[0:3], a[164:167], a[48:51], v[0:3]
  buffer_load_dwordx4 v232, s[12:15], s29 offen offset:0 lds
  v_mfma_f32_16x16x32_bf16 v[4:7], a[164:167], a[52:55], v[4:7]
  ds_read_b64_tr_b16 a[178:179], v226 offset:50176
  v_lshrrev_b32 v130, 6, v129
  v_mfma_f32_16x16x32_bf16 v[4:7], a[160:163], a[36:39], v[4:7]
  v_mul_u32_u24 v130, 0x14000, v130
  v_bfe_u32 v131, v129, 4, 2
  v_mfma_f32_16x16x32_bf16 v[8:11], a[160:163], a[40:43], v[8:11]
  ds_read_b64_tr_b16 a[180:181], v226 offset:57344
  v_lshl_add_u32 v130, v131, 10, v130
  v_mfma_f32_16x16x32_bf16 v[8:11], a[164:167], a[56:59], v[8:11]
  buffer_load_dwordx4 v233, s[12:15], s29 offen offset:1024 lds
  v_mfma_f32_16x16x32_bf16 v[12:15], a[164:167], a[60:63], v[12:15]
  ds_read_b64_tr_b16 a[182:183], v226 offset:58368
  v_and_b32 v131, 15, v129
  v_mfma_f32_16x16x32_bf16 v[12:15], a[160:163], a[44:47], v[12:15]
  s_waitcnt lgkmcnt(4)
  v_lshl_add_u32 v130, v131, 4, v130
  v_lshrrev_b32 v131, 4, v136
  v_mfma_f32_16x16x32_bf16 v[16:19], a[168:171], a[32:35], v[16:19]
  ds_read_b64_tr_b16 a[184:185], v227 offset:49152
  v_lshl_add_u32 v243, v131, 8, v130
  v_mfma_f32_16x16x32_bf16 v[16:19], a[172:175], a[48:51], v[16:19]
  buffer_load_dwordx4 v234, s[12:15], s29 offen offset:2048 lds
  v_mfma_f32_16x16x32_bf16 v[20:23], a[172:175], a[52:55], v[20:23]
  ds_read_b64_tr_b16 a[186:187], v227 offset:50176
  v_mfma_f32_16x16x32_bf16 v[20:23], a[168:171], a[36:39], v[20:23]
  buffer_load_dwordx4 v235, s[12:15], s29 offen offset:3072 lds
  v_mfma_f32_16x16x32_bf16 v[24:27], a[168:171], a[40:43], v[24:27]
  ds_read_b64_tr_b16 a[188:189], v227 offset:57344
  v_mfma_f32_16x16x32_bf16 v[24:27], a[172:175], a[56:59], v[24:27]
  v_mul_f32 v0, s34, v0
  v_mul_f32 v1, s34, v1
  v_mfma_f32_16x16x32_bf16 v[28:31], a[172:175], a[60:63], v[28:31]
  ds_read_b64_tr_b16 a[190:191], v227 offset:58368
  v_mul_f32 v2, s34, v2
  v_mfma_f32_16x16x32_bf16 v[28:31], a[168:171], a[44:47], v[28:31]
  s_waitcnt lgkmcnt(4)
  v_mul_f32 v3, s34, v3
  v_mul_f32 v16, s34, v16
  v_mfma_f32_16x16x32_bf16 v[32:35], a[176:179], a[32:35], v[32:35]
  ds_read_b64_tr_b16 a[160:161], v228 offset:49152
  v_mul_f32 v17, s34, v17
  v_mfma_f32_16x16x32_bf16 v[32:35], a[180:183], a[48:51], v[32:35]
  v_mul_f32 v18, s34, v18
  v_mul_f32 v19, s34, v19
  v_mfma_f32_16x16x32_bf16 v[36:39], a[180:183], a[52:55], v[36:39]
  ds_read_b64_tr_b16 a[162:163], v228 offset:50176
  v_cvt_pk_bf16_f32 v128, v0, v1
  v_mfma_f32_16x16x32_bf16 v[36:39], a[176:179], a[36:39], v[36:39]
  v_cvt_pk_bf16_f32 v129, v2, v3
  v_cvt_pk_bf16_f32 v130, v16, v17
  v_mfma_f32_16x16x32_bf16 v[40:43], a[176:179], a[40:43], v[40:43]
  ds_read_b64_tr_b16 a[164:165], v228 offset:57344
  v_cvt_pk_bf16_f32 v131, v18, v19
  v_mfma_f32_16x16x32_bf16 v[40:43], a[180:183], a[56:59], v[40:43]
  v_mul_f32 v4, s34, v4
  v_mul_f32 v5, s34, v5
  v_mfma_f32_16x16x32_bf16 v[44:47], a[180:183], a[60:63], v[44:47]
  ds_read_b64_tr_b16 a[166:167], v228 offset:58368
  v_mul_f32 v6, s34, v6
  v_mfma_f32_16x16x32_bf16 v[44:47], a[176:179], a[44:47], v[44:47]
  s_waitcnt lgkmcnt(4)
  v_mul_f32 v7, s34, v7
  v_mul_f32 v20, s34, v20
  v_mfma_f32_16x16x32_bf16 v[48:51], a[184:187], a[32:35], v[48:51]
  ds_read_b64_tr_b16 a[168:169], v229 offset:49152
  v_mul_f32 v21, s34, v21
  v_mfma_f32_16x16x32_bf16 v[48:51], a[188:191], a[48:51], v[48:51]
  v_mul_f32 v22, s34, v22
  v_mul_f32 v23, s34, v23
  v_mfma_f32_16x16x32_bf16 v[52:55], a[188:191], a[52:55], v[52:55]
  ds_read_b64_tr_b16 a[170:171], v229 offset:50176
  v_cvt_pk_bf16_f32 v144, v4, v5
  v_mfma_f32_16x16x32_bf16 v[52:55], a[184:187], a[36:39], v[52:55]
  v_cvt_pk_bf16_f32 v145, v6, v7
  v_cvt_pk_bf16_f32 v146, v20, v21
  v_mfma_f32_16x16x32_bf16 v[56:59], a[184:187], a[40:43], v[56:59]
  ds_read_b64_tr_b16 a[172:173], v229 offset:57344
  v_cvt_pk_bf16_f32 v147, v22, v23
  v_mfma_f32_16x16x32_bf16 v[56:59], a[188:191], a[56:59], v[56:59]
  v_permlane16_swap_b32 v128, v130
  v_permlane16_swap_b32 v129, v131
  v_mfma_f32_16x16x32_bf16 v[60:63], a[188:191], a[60:63], v[60:63]
  ds_read_b64_tr_b16 a[174:175], v229 offset:58368
  v_mul_f32 v8, s34, v8
  v_mfma_f32_16x16x32_bf16 v[60:63], a[184:187], a[44:47], v[60:63]
  s_waitcnt lgkmcnt(4)
  v_mul_f32 v9, s34, v9
  v_mul_f32 v10, s34, v10
  v_mfma_f32_16x16x32_bf16 v[64:67], a[160:163], a[32:35], v[64:67]
  ds_read_b64_tr_b16 a[176:177], v230 offset:49152
  v_mul_f32 v11, s34, v11
  v_mfma_f32_16x16x32_bf16 v[64:67], a[164:167], a[48:51], v[64:67]
  v_mul_f32 v24, s34, v24
  v_mul_f32 v25, s34, v25
  v_mfma_f32_16x16x32_bf16 v[68:71], a[164:167], a[52:55], v[68:71]
  ds_read_b64_tr_b16 a[178:179], v230 offset:50176
  v_mul_f32 v26, s34, v26
  v_mfma_f32_16x16x32_bf16 v[68:71], a[160:163], a[36:39], v[68:71]
  v_mul_f32 v27, s34, v27
  v_cvt_pk_bf16_f32 v160, v8, v9
  v_mfma_f32_16x16x32_bf16 v[72:75], a[160:163], a[40:43], v[72:75]
  ds_read_b64_tr_b16 a[180:181], v230 offset:57344
  v_cvt_pk_bf16_f32 v161, v10, v11
  v_mfma_f32_16x16x32_bf16 v[72:75], a[164:167], a[56:59], v[72:75]
  v_cvt_pk_bf16_f32 v162, v24, v25
  v_cvt_pk_bf16_f32 v163, v26, v27
  v_mfma_f32_16x16x32_bf16 v[76:79], a[164:167], a[60:63], v[76:79]
  ds_read_b64_tr_b16 a[182:183], v230 offset:58368
  v_permlane16_swap_b32 v144, v146
  v_mfma_f32_16x16x32_bf16 v[76:79], a[160:163], a[44:47], v[76:79]
  s_waitcnt lgkmcnt(4)
  v_permlane16_swap_b32 v145, v147
  v_mul_f32 v12, s34, v12
  v_mfma_f32_16x16x32_bf16 v[80:83], a[168:171], a[32:35], v[80:83]
  ds_read_b64_tr_b16 a[184:185], v231 offset:49152
  v_mul_f32 v13, s34, v13
  v_mfma_f32_16x16x32_bf16 v[80:83], a[172:175], a[48:51], v[80:83]
  v_mul_f32 v14, s34, v14
  v_mul_f32 v15, s34, v15
  v_mfma_f32_16x16x32_bf16 v[84:87], a[172:175], a[52:55], v[84:87]
  ds_read_b64_tr_b16 a[186:187], v231 offset:50176
  v_mul_f32 v28, s34, v28
  v_mfma_f32_16x16x32_bf16 v[84:87], a[168:171], a[36:39], v[84:87]
  s_waitcnt vmcnt(8)
  v_mul_f32 v29, s34, v29
  v_mul_f32 v30, s34, v30
  v_mfma_f32_16x16x32_bf16 v[88:91], a[168:171], a[40:43], v[88:91]
  ds_read_b64_tr_b16 a[188:189], v231 offset:57344
  v_mul_f32 v31, s34, v31
  v_mfma_f32_16x16x32_bf16 v[88:91], a[172:175], a[56:59], v[88:91]
  s_barrier
  v_cvt_pk_bf16_f32 v176, v12, v13
  v_cvt_pk_bf16_f32 v177, v14, v15
  v_mfma_f32_16x16x32_bf16 v[92:95], a[172:175], a[60:63], v[92:95]
  ds_read_b64_tr_b16 a[190:191], v231 offset:58368
  v_cvt_pk_bf16_f32 v178, v28, v29
  v_mfma_f32_16x16x32_bf16 v[92:95], a[168:171], a[44:47], v[92:95]
  s_waitcnt lgkmcnt(4)
  v_cvt_pk_bf16_f32 v179, v30, v31
  v_permlane16_swap_b32 v160, v162
  v_mfma_f32_16x16x32_bf16 v[96:99], a[176:179], a[32:35], v[96:99]
  ds_read_b128 a[128:131], v212 offset:0
  v_permlane16_swap_b32 v161, v163
  v_mfma_f32_16x16x32_bf16 v[96:99], a[180:183], a[48:51], v[96:99]
  v_mul_f32 v32, s34, v32
  v_mul_f32 v33, s34, v33
  v_mfma_f32_16x16x32_bf16 v[100:103], a[180:183], a[52:55], v[100:103]
  ds_read_b128 a[132:135], v213 offset:0
  v_mul_f32 v34, s34, v34
  v_mfma_f32_16x16x32_bf16 v[100:103], a[176:179], a[36:39], v[100:103]
  v_mul_f32 v35, s34, v35
  v_mul_f32 v48, s34, v48
  v_mfma_f32_16x16x32_bf16 v[104:107], a[176:179], a[40:43], v[104:107]
  ds_read_b128 a[136:139], v214 offset:0
  v_mul_f32 v49, s34, v49
  v_mfma_f32_16x16x32_bf16 v[104:107], a[180:183], a[56:59], v[104:107]
  v_mul_f32 v50, s34, v50
  v_mul_f32 v51, s34, v51
  v_mfma_f32_16x16x32_bf16 v[108:111], a[180:183], a[60:63], v[108:111]
  ds_read_b128 a[140:143], v215 offset:0
  v_cvt_pk_bf16_f32 v132, v32, v33
  v_mfma_f32_16x16x32_bf16 v[108:111], a[176:179], a[44:47], v[108:111]
  s_waitcnt lgkmcnt(4)
  v_cvt_pk_bf16_f32 v133, v34, v35
  v_cvt_pk_bf16_f32 v134, v48, v49
  v_mfma_f32_16x16x32_bf16 v[112:115], a[184:187], a[32:35], v[112:115]
  v_cvt_pk_bf16_f32 v135, v50, v51
  v_permlane16_swap_b32 v176, v178
  v_mfma_f32_16x16x32_bf16 v[112:115], a[188:191], a[48:51], v[112:115]
  v_permlane16_swap_b32 v177, v179
  v_mul_f32 v36, s34, v36
  v_mfma_f32_16x16x32_bf16 v[116:119], a[188:191], a[52:55], v[116:119]
  v_mul_f32 v37, s34, v37
  v_mul_f32 v38, s34, v38
  v_mfma_f32_16x16x32_bf16 v[116:119], a[184:187], a[36:39], v[116:119]
  v_mul_f32 v39, s34, v39
  v_mul_f32 v52, s34, v52
  v_mfma_f32_16x16x32_bf16 v[120:123], a[184:187], a[40:43], v[120:123]
  v_mul_f32 v53, s34, v53
  v_mul_f32 v54, s34, v54
  v_mfma_f32_16x16x32_bf16 v[120:123], a[188:191], a[56:59], v[120:123]
  v_mul_f32 v55, s34, v55
  v_cvt_pk_bf16_f32 v148, v36, v37
  v_mfma_f32_16x16x32_bf16 v[124:127], a[188:191], a[60:63], v[124:127]
  v_cvt_pk_bf16_f32 v149, v38, v39
  v_cvt_pk_bf16_f32 v150, v52, v53
  v_mfma_f32_16x16x32_bf16 v[124:127], a[184:187], a[44:47], v[124:127]
  s_waitcnt lgkmcnt(0)
  v_cvt_pk_bf16_f32 v151, v54, v55
  v_permlane16_swap_b32 v132, v134
  v_permlane16_swap_b32 v133, v135
  v_pk_mul_f32 v[40:41], v[40:41], s[34:35] op_sel_hi:[1,0]
  v_pk_mul_f32 v[42:43], v[42:43], s[34:35] op_sel_hi:[1,0]
  v_pk_mul_f32 v[56:57], v[56:57], s[34:35] op_sel_hi:[1,0]
  v_pk_mul_f32 v[58:59], v[58:59], s[34:35] op_sel_hi:[1,0]
  v_cvt_pk_bf16_f32 v164, v40, v41
  v_cvt_pk_bf16_f32 v165, v42, v43
  v_cvt_pk_bf16_f32 v166, v56, v57
  v_cvt_pk_bf16_f32 v167, v58, v59
  v_permlane16_swap_b32 v148, v150
  v_permlane16_swap_b32 v149, v151
  v_pk_mul_f32 v[44:45], v[44:45], s[34:35] op_sel_hi:[1,0]
  v_pk_mul_f32 v[46:47], v[46:47], s[34:35] op_sel_hi:[1,0]
  v_pk_mul_f32 v[60:61], v[60:61], s[34:35] op_sel_hi:[1,0]
  v_pk_mul_f32 v[62:63], v[62:63], s[34:35] op_sel_hi:[1,0]
  v_cvt_pk_bf16_f32 v180, v44, v45
  v_cvt_pk_bf16_f32 v181, v46, v47
  v_cvt_pk_bf16_f32 v182, v60, v61
  v_cvt_pk_bf16_f32 v183, v62, v63
  v_permlane16_swap_b32 v164, v166
  v_permlane16_swap_b32 v165, v167
  v_pk_mul_f32 v[64:65], v[64:65], s[34:35] op_sel_hi:[1,0]
  v_pk_mul_f32 v[66:67], v[66:67], s[34:35] op_sel_hi:[1,0]
  v_pk_mul_f32 v[80:81], v[80:81], s[34:35] op_sel_hi:[1,0]
  v_pk_mul_f32 v[82:83], v[82:83], s[34:35] op_sel_hi:[1,0]
  v_cvt_pk_bf16_f32 v136, v64, v65
  v_cvt_pk_bf16_f32 v137, v66, v67
  v_cvt_pk_bf16_f32 v138, v80, v81
  v_cvt_pk_bf16_f32 v139, v82, v83
  v_permlane16_swap_b32 v180, v182
  v_permlane16_swap_b32 v181, v183
  v_pk_mul_f32 v[68:69], v[68:69], s[34:35] op_sel_hi:[1,0]
  v_pk_mul_f32 v[70:71], v[70:71], s[34:35] op_sel_hi:[1,0]
  v_pk_mul_f32 v[84:85], v[84:85], s[34:35] op_sel_hi:[1,0]
  v_pk_mul_f32 v[86:87], v[86:87], s[34:35] op_sel_hi:[1,0]
  v_cvt_pk_bf16_f32 v152, v68, v69
  v_cvt_pk_bf16_f32 v153, v70, v71
  v_cvt_pk_bf16_f32 v154, v84, v85
  v_cvt_pk_bf16_f32 v155, v86, v87
  v_permlane16_swap_b32 v136, v138
  v_permlane16_swap_b32 v137, v139
  v_pk_mul_f32 v[72:73], v[72:73], s[34:35] op_sel_hi:[1,0]
  v_pk_mul_f32 v[74:75], v[74:75], s[34:35] op_sel_hi:[1,0]
  v_pk_mul_f32 v[88:89], v[88:89], s[34:35] op_sel_hi:[1,0]
  v_pk_mul_f32 v[90:91], v[90:91], s[34:35] op_sel_hi:[1,0]
  v_cvt_pk_bf16_f32 v168, v72, v73
  v_cvt_pk_bf16_f32 v169, v74, v75
  v_cvt_pk_bf16_f32 v170, v88, v89
  v_cvt_pk_bf16_f32 v171, v90, v91
  v_permlane16_swap_b32 v152, v154
  v_permlane16_swap_b32 v153, v155
  v_pk_mul_f32 v[76:77], v[76:77], s[34:35] op_sel_hi:[1,0]
  v_pk_mul_f32 v[78:79], v[78:79], s[34:35] op_sel_hi:[1,0]
  v_pk_mul_f32 v[92:93], v[92:93], s[34:35] op_sel_hi:[1,0]
  v_pk_mul_f32 v[94:95], v[94:95], s[34:35] op_sel_hi:[1,0]
  v_cvt_pk_bf16_f32 v184, v76, v77
  v_cvt_pk_bf16_f32 v185, v78, v79
  v_cvt_pk_bf16_f32 v186, v92, v93
  v_cvt_pk_bf16_f32 v187, v94, v95
  v_permlane16_swap_b32 v168, v170
  v_permlane16_swap_b32 v169, v171
  v_pk_mul_f32 v[96:97], v[96:97], s[34:35] op_sel_hi:[1,0]
  v_pk_mul_f32 v[98:99], v[98:99], s[34:35] op_sel_hi:[1,0]
  v_pk_mul_f32 v[112:113], v[112:113], s[34:35] op_sel_hi:[1,0]
  v_pk_mul_f32 v[114:115], v[114:115], s[34:35] op_sel_hi:[1,0]
  v_cvt_pk_bf16_f32 v140, v96, v97
  v_cvt_pk_bf16_f32 v141, v98, v99
  v_cvt_pk_bf16_f32 v142, v112, v113
  v_cvt_pk_bf16_f32 v143, v114, v115
  v_permlane16_swap_b32 v184, v186
  v_permlane16_swap_b32 v185, v187
  v_pk_mul_f32 v[100:101], v[100:101], s[34:35] op_sel_hi:[1,0]
  v_pk_mul_f32 v[102:103], v[102:103], s[34:35] op_sel_hi:[1,0]
  v_pk_mul_f32 v[116:117], v[116:117], s[34:35] op_sel_hi:[1,0]
  v_pk_mul_f32 v[118:119], v[118:119], s[34:35] op_sel_hi:[1,0]
  v_cvt_pk_bf16_f32 v156, v100, v101
  v_cvt_pk_bf16_f32 v157, v102, v103
  v_cvt_pk_bf16_f32 v158, v116, v117
  v_cvt_pk_bf16_f32 v159, v118, v119
  v_permlane16_swap_b32 v140, v142
  v_permlane16_swap_b32 v141, v143
  v_pk_mul_f32 v[104:105], v[104:105], s[34:35] op_sel_hi:[1,0]
  v_pk_mul_f32 v[106:107], v[106:107], s[34:35] op_sel_hi:[1,0]
  v_pk_mul_f32 v[120:121], v[120:121], s[34:35] op_sel_hi:[1,0]
  v_pk_mul_f32 v[122:123], v[122:123], s[34:35] op_sel_hi:[1,0]
  v_cvt_pk_bf16_f32 v172, v104, v105
  v_cvt_pk_bf16_f32 v173, v106, v107
  v_cvt_pk_bf16_f32 v174, v120, v121
  v_cvt_pk_bf16_f32 v175, v122, v123
  v_permlane16_swap_b32 v156, v158
  v_permlane16_swap_b32 v157, v159
  v_pk_mul_f32 v[108:109], v[108:109], s[34:35] op_sel_hi:[1,0]
  v_pk_mul_f32 v[110:111], v[110:111], s[34:35] op_sel_hi:[1,0]
  v_pk_mul_f32 v[124:125], v[124:125], s[34:35] op_sel_hi:[1,0]
  v_pk_mul_f32 v[126:127], v[126:127], s[34:35] op_sel_hi:[1,0]
  v_cvt_pk_bf16_f32 v188, v108, v109
  v_cvt_pk_bf16_f32 v189, v110, v111
  v_cvt_pk_bf16_f32 v190, v124, v125
  v_cvt_pk_bf16_f32 v191, v126, v127
  v_permlane16_swap_b32 v172, v174
  v_permlane16_swap_b32 v173, v175
  v_permlane16_swap_b32 v188, v190
  v_permlane16_swap_b32 v189, v191
  v_mfma_f32_16x16x32_bf16 v[0:3], a[128:131], v[128:131], 0
  s_add_u32 m0, s28, 81920
  ds_read_b128 a[144:147], v212 offset:4096
  s_mov_b32 s20, s90
  s_mov_b32 s21, s91
  v_mfma_f32_16x16x32_bf16 v[0:3], a[132:135], v[132:135], v[0:3]
  buffer_load_dwordx4 v236, s[16:19], s29 offen offset:0 lds
  s_mov_b32 s22, 2211840
  s_mov_b32 s23, 0x20000
  s_mov_b32 s44, s92
  v_mfma_f32_16x16x32_bf16 v[0:3], a[136:139], v[136:139], v[0:3]
  ds_read_b128 a[148:151], v213 offset:4096
  s_mov_b32 s45, s93
  s_mov_b32 s46, 2211840
  s_mov_b32 s47, 0x20000
  v_lshrrev_b32 v253, 4, v242
  v_mfma_f32_16x16x32_bf16 v[0:3], a[140:143], v[140:143], v[0:3]
  buffer_load_dwordx4 v237, s[16:19], s29 offen offset:1024 lds
  v_mfma_f32_16x16x32_bf16 v[8:11], a[140:143], v[156:159], 0
  ds_read_b128 a[152:155], v214 offset:4096
  v_mul_u32_u24 v253, 0xd80, v253
  v_mfma_f32_16x16x32_bf16 v[8:11], a[136:139], v[152:155], v[8:11]
  buffer_load_dwordx4 v236, s[16:19], s29 offen offset:2048 lds
  s_mul_i32 s35, s3, 552960
  s_lshl_b32 s38, s33, 4
  s_add_u32 s35, s35, s38
  v_mfma_f32_16x16x32_bf16 v[8:11], a[132:135], v[148:151], v[8:11]
  ds_read_b128 a[156:159], v215 offset:4096
  v_mfma_f32_16x16x32_bf16 v[8:11], a[128:131], v[144:147], v[8:11]
  buffer_load_dwordx4 v237, s[16:19], s29 offen offset:3072 lds
  v_mfma_f32_16x16x32_bf16 v[16:19], a[128:131], v[160:163], 0
  s_add_u32 s29, s29, 16384
  s_add_u32 m0, s28, 32768
  v_mfma_f32_16x16x32_bf16 v[16:19], a[132:135], v[164:167], v[16:19]
  buffer_load_dwordx4 v232, s[12:15], s29 offen offset:0 lds
  v_mfma_f32_16x16x32_bf16 v[16:19], a[136:139], v[168:171], v[16:19]
  buffer_load_dwordx4 v233, s[12:15], s29 offen offset:1024 lds
  v_mfma_f32_16x16x32_bf16 v[16:19], a[140:143], v[172:175], v[16:19]
  v_max3_f32 v192, v0, v1, v2
  v_max3_f32 v196, v8, v9, v10
  v_mfma_f32_16x16x32_bf16 v[24:27], a[140:143], v[188:191], 0
  v_max_f32 v192, v192, v3
  v_max_f32 v196, v196, v11
  v_mfma_f32_16x16x32_bf16 v[24:27], a[136:139], v[184:187], v[24:27]
  v_mov_b32 v245, v192
  v_mov_b32 v246, v196
  v_mfma_f32_16x16x32_bf16 v[24:27], a[132:135], v[180:183], v[24:27]
  v_permlane16_swap_b32 v192, v245
  v_permlane16_swap_b32 v196, v246
  v_mfma_f32_16x16x32_bf16 v[24:27], a[128:131], v[176:179], v[24:27]
  s_waitcnt lgkmcnt(0)
  v_max_f32 v192, v192, v245
  v_max_f32 v196, v196, v246
  v_mfma_f32_16x16x32_bf16 v[4:7], a[144:147], v[128:131], 0
  ds_read_b128 a[128:131], v212 offset:8192
  v_mov_b32 v245, v192
  v_mfma_f32_16x16x32_bf16 v[4:7], a[148:151], v[132:135], v[4:7]
  v_mov_b32 v246, v196
  v_permlane32_swap_b32 v192, v245
  v_mfma_f32_16x16x32_bf16 v[4:7], a[152:155], v[136:139], v[4:7]
  ds_read_b128 a[132:135], v213 offset:8192
  v_permlane32_swap_b32 v196, v246
  v_mfma_f32_16x16x32_bf16 v[4:7], a[156:159], v[140:143], v[4:7]
  v_max_f32 v192, v192, v245
  v_max_f32 v196, v196, v246
  v_mfma_f32_16x16x32_bf16 v[12:15], a[156:159], v[156:159], 0
  ds_read_b128 a[136:139], v214 offset:8192
  v_sub_f32 v193, 0, v192
  v_mfma_f32_16x16x32_bf16 v[12:15], a[152:155], v[152:155], v[12:15]
  v_sub_f32 v197, 0, v196
  v_sub_f32 v194, 0, v192
  v_mfma_f32_16x16x32_bf16 v[12:15], a[148:151], v[148:151], v[12:15]
  ds_read_b128 a[140:143], v215 offset:8192
  v_sub_f32 v198, 0, v196
  v_mfma_f32_16x16x32_bf16 v[12:15], a[144:147], v[144:147], v[12:15]
  v_sub_f32 v195, 0, v192
  v_sub_f32 v199, 0, v196
  v_mfma_f32_16x16x32_bf16 v[20:23], a[144:147], v[160:163], 0
  buffer_load_dwordx4 v234, s[12:15], s29 offen offset:2048 lds
  v_mfma_f32_16x16x32_bf16 v[20:23], a[148:151], v[164:167], v[20:23]
  v_sub_f32 v192, 0, v192
  v_sub_f32 v196, 0, v196
  v_mfma_f32_16x16x32_bf16 v[20:23], a[152:155], v[168:171], v[20:23]
  buffer_load_dwordx4 v235, s[12:15], s29 offen offset:3072 lds
  v_mfma_f32_16x16x32_bf16 v[20:23], a[156:159], v[172:175], v[20:23]
  v_max3_f32 v200, v16, v17, v18
  v_max3_f32 v204, v24, v25, v26
  v_mfma_f32_16x16x32_bf16 v[28:31], a[156:159], v[188:191], 0
  v_max_f32 v200, v200, v19
  v_max_f32 v204, v204, v27
  v_mfma_f32_16x16x32_bf16 v[28:31], a[152:155], v[184:187], v[28:31]
  v_mov_b32 v247, v200
  v_mov_b32 v248, v204
  v_mfma_f32_16x16x32_bf16 v[28:31], a[148:151], v[180:183], v[28:31]
  v_permlane16_swap_b32 v200, v247
  v_permlane16_swap_b32 v204, v248
  v_max_f32 v200, v200, v247
  v_max_f32 v204, v204, v248
  v_mov_b32 v247, v200
  v_mov_b32 v248, v204
  s_nop 0
  v_permlane32_swap_b32 v200, v247
  v_permlane32_swap_b32 v204, v248
  v_max_f32 v200, v200, v247
  v_max_f32 v204, v204, v248
  v_sub_f32 v201, 0, v200
  v_sub_f32 v205, 0, v204
  v_sub_f32 v202, 0, v200
  v_sub_f32 v206, 0, v204
  v_sub_f32 v203, 0, v200
  v_sub_f32 v207, 0, v204
  v_sub_f32 v200, 0, v200
  v_sub_f32 v204, 0, v204
  v_mfma_f32_16x16x32_bf16 v[28:31], a[144:147], v[176:179], v[28:31]
  s_waitcnt lgkmcnt(0)
  v_add_f32 v0, v192, v0
  v_add_f32 v1, v192, v1
  v_mfma_f32_16x16x32_bf16 v[32:35], a[128:131], v[128:131], v[192:195]
  ds_read_b128 a[144:147], v212 offset:12288
  v_add_f32 v2, v192, v2
  v_mfma_f32_16x16x32_bf16 v[32:35], a[132:135], v[132:135], v[32:35]
  v_add_f32 v3, v192, v3
  v_mfma_f32_16x16x32_bf16 v[32:35], a[136:139], v[136:139], v[32:35]
  ds_read_b128 a[148:151], v213 offset:12288
  v_mfma_f32_16x16x32_bf16 v[32:35], a[140:143], v[140:143], v[32:35]
  v_exp_f32 v0, v0
  v_mfma_f32_16x16x32_bf16 v[40:43], a[140:143], v[156:159], v[196:199]
  ds_read_b128 a[152:155], v214 offset:12288
  v_mfma_f32_16x16x32_bf16 v[40:43], a[136:139], v[152:155], v[40:43]
  v_exp_f32 v1, v1
  v_mfma_f32_16x16x32_bf16 v[40:43], a[132:135], v[148:151], v[40:43]
  ds_read_b128 a[156:159], v215 offset:12288
  v_mfma_f32_16x16x32_bf16 v[40:43], a[128:131], v[144:147], v[40:43]
  v_exp_f32 v2, v2
  v_mfma_f32_16x16x32_bf16 v[48:51], a[128:131], v[160:163], v[200:203]
  s_add_u32 m0, s50, 0
  v_cvt_pk_bf16_f32 v0, v0, v1
  v_mfma_f32_16x16x32_bf16 v[48:51], a[132:135], v[164:167], v[48:51]
  v_exp_f32 v3, v3
  v_mfma_f32_16x16x32_bf16 v[48:51], a[136:139], v[168:171], v[48:51]
  v_add_f32 v8, v196, v8
  v_add_f32 v9, v196, v9
  v_mfma_f32_16x16x32_bf16 v[48:51], a[140:143], v[172:175], v[48:51]
  v_add_f32 v10, v196, v10
  v_add_f32 v11, v196, v11
  v_mfma_f32_16x16x32_bf16 v[56:59], a[140:143], v[188:191], v[204:207]
  v_exp_f32 v8, v8
  v_mfma_f32_16x16x32_bf16 v[56:59], a[136:139], v[184:187], v[56:59]
  v_exp_f32 v9, v9
  buffer_load_dwordx4 v253, s[20:23], s35 offen lds
  v_mfma_f32_16x16x32_bf16 v[56:59], a[132:135], v[180:183], v[56:59]
  v_exp_f32 v10, v10
  v_mfma_f32_16x16x32_bf16 v[56:59], a[128:131], v[176:179], v[56:59]
  s_waitcnt lgkmcnt(0)
  v_cvt_pk_bf16_f32 v8, v8, v9
  v_mfma_f32_16x16x32_bf16 v[36:39], a[144:147], v[128:131], v[192:195]
  s_waitcnt vmcnt(9)
  v_exp_f32 v11, v11
  v_mfma_f32_16x16x32_bf16 v[36:39], a[148:151], v[132:135], v[36:39]
  s_barrier
  v_cvt_pk_bf16_f32 v1, v2, v3
  v_add_f32 v16, v200, v16
  v_mfma_f32_16x16x32_bf16 v[36:39], a[152:155], v[136:139], v[36:39]
  ds_read_b128 a[128:131], v212 offset:16384
  v_add_f32 v17, v200, v17
  v_mfma_f32_16x16x32_bf16 v[36:39], a[156:159], v[140:143], v[36:39]
  v_add_f32 v18, v200, v18
  v_add_f32 v19, v200, v19
  v_mfma_f32_16x16x32_bf16 v[44:47], a[156:159], v[156:159], v[196:199]
  ds_read_b128 a[132:135], v213 offset:16384
  v_mfma_f32_16x16x32_bf16 v[44:47], a[152:155], v[152:155], v[44:47]
  v_exp_f32 v16, v16
  v_mfma_f32_16x16x32_bf16 v[44:47], a[148:151], v[148:151], v[44:47]
  ds_read_b128 a[136:139], v214 offset:16384
  v_mfma_f32_16x16x32_bf16 v[44:47], a[144:147], v[144:147], v[44:47]
  v_exp_f32 v17, v17
  v_mfma_f32_16x16x32_bf16 v[52:55], a[144:147], v[160:163], v[200:203]
  ds_read_b128 a[140:143], v215 offset:16384
  v_mfma_f32_16x16x32_bf16 v[52:55], a[148:151], v[164:167], v[52:55]
  v_exp_f32 v18, v18
  v_mfma_f32_16x16x32_bf16 v[52:55], a[152:155], v[168:171], v[52:55]
  v_cvt_pk_bf16_f32 v16, v16, v17
  v_mfma_f32_16x16x32_bf16 v[52:55], a[156:159], v[172:175], v[52:55]
  v_exp_f32 v19, v19
  v_mfma_f32_16x16x32_bf16 v[60:63], a[156:159], v[188:191], v[204:207]
  v_cvt_pk_bf16_f32 v9, v10, v11
  v_add_f32 v24, v204, v24
  v_mfma_f32_16x16x32_bf16 v[60:63], a[152:155], v[184:187], v[60:63]
  v_add_f32 v25, v204, v25
  v_add_f32 v26, v204, v26
  v_mfma_f32_16x16x32_bf16 v[60:63], a[148:151], v[180:183], v[60:63]
  v_add_f32 v27, v204, v27
  v_mfma_f32_16x16x32_bf16 v[60:63], a[144:147], v[176:179], v[60:63]
  s_waitcnt lgkmcnt(0)
  v_exp_f32 v24, v24
  v_exp_f32 v25, v25
  v_exp_f32 v26, v26
  v_cvt_pk_bf16_f32 v24, v24, v25
  v_exp_f32 v27, v27
  v_cvt_pk_bf16_f32 v17, v18, v19
  v_add_f32 v4, v192, v4
  v_add_f32 v5, v192, v5
  v_add_f32 v6, v192, v6
  v_add_f32 v7, v192, v7
  v_exp_f32 v4, v4
  v_exp_f32 v5, v5
  v_exp_f32 v6, v6
  v_cvt_pk_bf16_f32 v2, v4, v5
  v_exp_f32 v7, v7
  v_cvt_pk_bf16_f32 v25, v26, v27
  v_add_f32 v12, v196, v12
  v_add_f32 v13, v196, v13
  v_add_f32 v14, v196, v14
  v_add_f32 v15, v196, v15
  v_exp_f32 v12, v12
  v_exp_f32 v13, v13
  v_exp_f32 v14, v14
  v_cvt_pk_bf16_f32 v10, v12, v13
  v_exp_f32 v15, v15
  v_cvt_pk_bf16_f32 v3, v6, v7
  v_add_f32 v20, v200, v20
  v_add_f32 v21, v200, v21
  v_add_f32 v22, v200, v22
  v_add_f32 v23, v200, v23
  v_exp_f32 v20, v20
  v_exp_f32 v21, v21
  v_exp_f32 v22, v22
  v_cvt_pk_bf16_f32 v18, v20, v21
  v_exp_f32 v23, v23
  v_cvt_pk_bf16_f32 v11, v14, v15
  v_add_f32 v28, v204, v28
  v_add_f32 v29, v204, v29
  v_add_f32 v30, v204, v30
  v_add_f32 v31, v204, v31
  v_exp_f32 v28, v28
  v_exp_f32 v29, v29
  v_exp_f32 v30, v30
  v_cvt_pk_bf16_f32 v26, v28, v29
  v_exp_f32 v31, v31
  v_cvt_pk_bf16_f32 v19, v22, v23
  v_exp_f32 v32, v32
  v_exp_f32 v33, v33
  v_exp_f32 v34, v34
  v_cvt_pk_bf16_f32 v32, v32, v33
  v_exp_f32 v35, v35
  v_cvt_pk_bf16_f32 v27, v30, v31
  v_exp_f32 v40, v40
  v_exp_f32 v41, v41
  v_exp_f32 v42, v42
  v_cvt_pk_bf16_f32 v40, v40, v41
  v_exp_f32 v43, v43
  v_cvt_pk_bf16_f32 v33, v34, v35
  v_exp_f32 v48, v48
  v_exp_f32 v49, v49
  v_exp_f32 v50, v50
  v_cvt_pk_bf16_f32 v48, v48, v49
  v_exp_f32 v51, v51
  v_cvt_pk_bf16_f32 v41, v42, v43
  v_exp_f32 v56, v56
  v_exp_f32 v57, v57
  v_exp_f32 v58, v58
  v_cvt_pk_bf16_f32 v56, v56, v57
  v_exp_f32 v59, v59
  v_cvt_pk_bf16_f32 v49, v50, v51
  v_exp_f32 v36, v36
  v_exp_f32 v37, v37
  v_exp_f32 v38, v38
  v_cvt_pk_bf16_f32 v34, v36, v37
  v_exp_f32 v39, v39
  v_cvt_pk_bf16_f32 v57, v58, v59
  v_exp_f32 v44, v44
  v_exp_f32 v45, v45
  v_exp_f32 v46, v46
  v_cvt_pk_bf16_f32 v42, v44, v45
  v_exp_f32 v47, v47
  v_cvt_pk_bf16_f32 v35, v38, v39
  v_exp_f32 v52, v52
  v_exp_f32 v53, v53
  v_exp_f32 v54, v54
  v_cvt_pk_bf16_f32 v50, v52, v53
  v_exp_f32 v55, v55
  v_cvt_pk_bf16_f32 v43, v46, v47
  v_exp_f32 v60, v60
  v_exp_f32 v61, v61
  v_exp_f32 v62, v62
  v_cvt_pk_bf16_f32 v58, v60, v61
  v_exp_f32 v63, v63
  v_cvt_pk_bf16_f32 v51, v54, v55
  v_cvt_pk_bf16_f32 v59, v62, v63
  v_mfma_f32_16x16x32_bf16 v[64:67], a[128:131], v[128:131], v[192:195]
  s_add_u32 m0, s28, 98304
  v_mfma_f32_16x16x32_bf16 v[64:67], a[132:135], v[132:135], v[64:67]
  ds_read_b128 a[144:147], v212 offset:20480
  v_mfma_f32_16x16x32_bf16 v[64:67], a[136:139], v[136:139], v[64:67]
  buffer_load_dwordx4 v236, s[16:19], s29 offen offset:0 lds
  v_mfma_f32_16x16x32_bf16 v[64:67], a[140:143], v[140:143], v[64:67]
  ds_read_b128 a[148:151], v213 offset:20480
  v_mfma_f32_16x16x32_bf16 v[72:75], a[140:143], v[156:159], v[196:199]
  v_mfma_f32_16x16x32_bf16 v[72:75], a[136:139], v[152:155], v[72:75]
  ds_read_b128 a[152:155], v214 offset:20480
  v_mfma_f32_16x16x32_bf16 v[72:75], a[132:135], v[148:151], v[72:75]
  buffer_load_dwordx4 v237, s[16:19], s29 offen offset:1024 lds
  v_mfma_f32_16x16x32_bf16 v[72:75], a[128:131], v[144:147], v[72:75]
  ds_read_b128 a[156:159], v215 offset:20480
  v_mfma_f32_16x16x32_bf16 v[80:83], a[128:131], v[160:163], v[200:203]
  v_exp_f32 v64, v64
  v_mfma_f32_16x16x32_bf16 v[80:83], a[132:135], v[164:167], v[80:83]
  v_mfma_f32_16x16x32_bf16 v[80:83], a[136:139], v[168:171], v[80:83]
  v_exp_f32 v65, v65
  v_mfma_f32_16x16x32_bf16 v[80:83], a[140:143], v[172:175], v[80:83]
  v_cvt_pk_bf16_f32 v64, v64, v65
  v_mfma_f32_16x16x32_bf16 v[88:91], a[140:143], v[188:191], v[204:207]
  v_exp_f32 v66, v66
  v_mfma_f32_16x16x32_bf16 v[88:91], a[136:139], v[184:187], v[88:91]
  buffer_load_dwordx4 v236, s[16:19], s29 offen offset:2048 lds
  v_mfma_f32_16x16x32_bf16 v[88:91], a[132:135], v[180:183], v[88:91]
  s_waitcnt lgkmcnt(0)
  v_exp_f32 v67, v67
  v_mfma_f32_16x16x32_bf16 v[88:91], a[128:131], v[176:179], v[88:91]
  v_cvt_pk_bf16_f32 v65, v66, v67
  v_mfma_f32_16x16x32_bf16 v[68:71], a[144:147], v[128:131], v[192:195]
  v_exp_f32 v72, v72
  v_mfma_f32_16x16x32_bf16 v[68:71], a[148:151], v[132:135], v[68:71]
  ds_read_b128 a[128:131], v212 offset:24576
  v_mfma_f32_16x16x32_bf16 v[68:71], a[152:155], v[136:139], v[68:71]
  v_exp_f32 v73, v73
  v_mfma_f32_16x16x32_bf16 v[68:71], a[156:159], v[140:143], v[68:71]
  ds_read_b128 a[132:135], v213 offset:24576
  v_cvt_pk_bf16_f32 v72, v72, v73
  v_mfma_f32_16x16x32_bf16 v[76:79], a[156:159], v[156:159], v[196:199]
  v_exp_f32 v74, v74
  v_mfma_f32_16x16x32_bf16 v[76:79], a[152:155], v[152:155], v[76:79]
  ds_read_b128 a[136:139], v214 offset:24576
  v_mfma_f32_16x16x32_bf16 v[76:79], a[148:151], v[148:151], v[76:79]
  v_exp_f32 v75, v75
  v_mfma_f32_16x16x32_bf16 v[76:79], a[144:147], v[144:147], v[76:79]
  ds_read_b128 a[140:143], v215 offset:24576
  v_cvt_pk_bf16_f32 v73, v74, v75
  v_mfma_f32_16x16x32_bf16 v[84:87], a[144:147], v[160:163], v[200:203]
  v_exp_f32 v80, v80
  v_mfma_f32_16x16x32_bf16 v[84:87], a[148:151], v[164:167], v[84:87]
  buffer_load_dwordx4 v237, s[16:19], s29 offen offset:3072 lds
  v_mfma_f32_16x16x32_bf16 v[84:87], a[152:155], v[168:171], v[84:87]
  s_add_u32 s29, s29, 16384
  v_exp_f32 v81, v81
  v_mfma_f32_16x16x32_bf16 v[84:87], a[156:159], v[172:175], v[84:87]
  v_cvt_pk_bf16_f32 v80, v80, v81
  v_mfma_f32_16x16x32_bf16 v[92:95], a[156:159], v[188:191], v[204:207]
  s_add_u32 m0, s28, 49152
  v_exp_f32 v82, v82
  v_mfma_f32_16x16x32_bf16 v[92:95], a[152:155], v[184:187], v[92:95]
  buffer_load_dwordx4 v232, s[12:15], s29 offen offset:0 lds
  v_mfma_f32_16x16x32_bf16 v[92:95], a[148:151], v[180:183], v[92:95]
  s_waitcnt lgkmcnt(0)
  v_exp_f32 v83, v83
  v_mfma_f32_16x16x32_bf16 v[92:95], a[144:147], v[176:179], v[92:95]
  v_cvt_pk_bf16_f32 v81, v82, v83
  v_mfma_f32_16x16x32_bf16 v[96:99], a[128:131], v[128:131], v[192:195]
  v_exp_f32 v88, v88
  v_mfma_f32_16x16x32_bf16 v[96:99], a[132:135], v[132:135], v[96:99]
  ds_read_b128 a[144:147], v212 offset:28672
  v_mfma_f32_16x16x32_bf16 v[96:99], a[136:139], v[136:139], v[96:99]
  v_exp_f32 v89, v89
  v_mfma_f32_16x16x32_bf16 v[96:99], a[140:143], v[140:143], v[96:99]
  ds_read_b128 a[148:151], v213 offset:28672
  v_cvt_pk_bf16_f32 v88, v88, v89
  v_mfma_f32_16x16x32_bf16 v[104:107], a[140:143], v[156:159], v[196:199]
  v_exp_f32 v90, v90
  v_mfma_f32_16x16x32_bf16 v[104:107], a[136:139], v[152:155], v[104:107]
  ds_read_b128 a[152:155], v214 offset:28672
  v_mfma_f32_16x16x32_bf16 v[104:107], a[132:135], v[148:151], v[104:107]
  v_exp_f32 v91, v91
  v_mfma_f32_16x16x32_bf16 v[104:107], a[128:131], v[144:147], v[104:107]
  ds_read_b128 a[156:159], v215 offset:28672
  v_cvt_pk_bf16_f32 v89, v90, v91
  v_mfma_f32_16x16x32_bf16 v[112:115], a[128:131], v[160:163], v[200:203]
  v_exp_f32 v68, v68
  v_mfma_f32_16x16x32_bf16 v[112:115], a[132:135], v[164:167], v[112:115]
  buffer_load_dwordx4 v233, s[12:15], s29 offen offset:1024 lds
  v_mfma_f32_16x16x32_bf16 v[112:115], a[136:139], v[168:171], v[112:115]
  v_exp_f32 v69, v69
  v_mfma_f32_16x16x32_bf16 v[112:115], a[140:143], v[172:175], v[112:115]
  v_cvt_pk_bf16_f32 v66, v68, v69
  v_mfma_f32_16x16x32_bf16 v[120:123], a[140:143], v[188:191], v[204:207]
  v_exp_f32 v70, v70
  v_mfma_f32_16x16x32_bf16 v[120:123], a[136:139], v[184:187], v[120:123]
  buffer_load_dwordx4 v234, s[12:15], s29 offen offset:2048 lds
  v_mfma_f32_16x16x32_bf16 v[120:123], a[132:135], v[180:183], v[120:123]
  s_waitcnt lgkmcnt(0)
  v_exp_f32 v71, v71
  v_mfma_f32_16x16x32_bf16 v[120:123], a[128:131], v[176:179], v[120:123]
  v_cvt_pk_bf16_f32 v67, v70, v71
  v_mfma_f32_16x16x32_bf16 v[100:103], a[144:147], v[128:131], v[192:195]
  v_exp_f32 v76, v76
  v_mfma_f32_16x16x32_bf16 v[100:103], a[148:151], v[132:135], v[100:103]
  ds_read_b64_tr_b16 a[160:161], v216 offset:0
  v_mfma_f32_16x16x32_bf16 v[100:103], a[152:155], v[136:139], v[100:103]
  v_exp_f32 v77, v77
  v_mfma_f32_16x16x32_bf16 v[100:103], a[156:159], v[140:143], v[100:103]
  ds_read_b64_tr_b16 a[162:163], v216 offset:4096
  v_cvt_pk_bf16_f32 v74, v76, v77
  v_mfma_f32_16x16x32_bf16 v[108:111], a[156:159], v[156:159], v[196:199]
  v_exp_f32 v78, v78
  v_mfma_f32_16x16x32_bf16 v[108:111], a[152:155], v[152:155], v[108:111]
  ds_read_b64_tr_b16 a[164:165], v216 offset:8192
  buffer_load_dwordx4 v235, s[12:15], s29 offen offset:3072 lds
  v_mfma_f32_16x16x32_bf16 v[108:111], a[148:151], v[148:151], v[108:111]
  v_exp_f32 v79, v79
  v_mfma_f32_16x16x32_bf16 v[108:111], a[144:147], v[144:147], v[108:111]
  ds_read_b64_tr_b16 a[166:167], v216 offset:12288
  v_cvt_pk_bf16_f32 v75, v78, v79
  v_mfma_f32_16x16x32_bf16 v[116:119], a[144:147], v[160:163], v[200:203]
  v_exp_f32 v84, v84
  v_mfma_f32_16x16x32_bf16 v[116:119], a[148:151], v[164:167], v[116:119]
  ds_read_b64_tr_b16 a[168:169], v217 offset:0
  s_add_u32 m0, s50, 3072
  v_mfma_f32_16x16x32_bf16 v[116:119], a[152:155], v[168:171], v[116:119]
  v_exp_f32 v85, v85
  v_mfma_f32_16x16x32_bf16 v[116:119], a[156:159], v[172:175], v[116:119]
  ds_read_b64_tr_b16 a[170:171], v217 offset:4096
  v_cvt_pk_bf16_f32 v82, v84, v85
  v_mfma_f32_16x16x32_bf16 v[124:127], a[156:159], v[188:191], v[204:207]
  v_exp_f32 v86, v86
  v_mfma_f32_16x16x32_bf16 v[124:127], a[152:155], v[184:187], v[124:127]
  ds_read_b64_tr_b16 a[172:173], v217 offset:8192
  buffer_load_dwordx4 v253, s[44:47], s35 offen lds
  s_add_u32 s35, s35, 221184
  v_mfma_f32_16x16x32_bf16 v[124:127], a[148:151], v[180:183], v[124:127]
  v_exp_f32 v87, v87
  v_mfma_f32_16x16x32_bf16 v[124:127], a[144:147], v[176:179], v[124:127]
  ds_read_b64_tr_b16 a[174:175], v217 offset:12288
  v_cvt_pk_bf16_f32 v83, v86, v87
  v_mfma_f32_16x16x32_bf16 a[192:195], a[208:211], v[0:3], 0
  v_exp_f32 v92, v92
  v_mfma_f32_16x16x32_bf16 a[192:195], a[208:211], v[32:35], a[192:195]
  ds_read_b64_tr_b16 a[176:177], v218 offset:0
  v_mfma_f32_16x16x32_bf16 a[196:199], a[208:211], v[8:11], 0
  v_exp_f32 v93, v93
  v_mfma_f32_16x16x32_bf16 a[196:199], a[208:211], v[40:43], a[196:199]
  ds_read_b64_tr_b16 a[178:179], v218 offset:4096
  v_cvt_pk_bf16_f32 v90, v92, v93
  v_mfma_f32_16x16x32_bf16 a[200:203], a[208:211], v[16:19], 0
  v_exp_f32 v94, v94
  v_mfma_f32_16x16x32_bf16 a[200:203], a[208:211], v[48:51], a[200:203]
  ds_read_b64_tr_b16 a[180:181], v218 offset:8192
  v_mfma_f32_16x16x32_bf16 a[204:207], a[208:211], v[24:27], 0
  s_waitcnt lgkmcnt(7)
  v_exp_f32 v95, v95
  v_mfma_f32_16x16x32_bf16 a[204:207], a[208:211], v[56:59], a[204:207]
  ds_read_b64_tr_b16 a[182:183], v218 offset:12288
  v_cvt_pk_bf16_f32 v91, v94, v95
  v_mfma_f32_16x16x32_bf16 a[0:3], a[160:163], v[0:3], 0
  v_exp_f32 v96, v96
  v_mfma_f32_16x16x32_bf16 a[0:3], a[164:167], v[32:35], a[0:3]
  ds_read_b64_tr_b16 a[184:185], v219 offset:0
  v_mfma_f32_16x16x32_bf16 a[4:7], a[164:167], v[40:43], 0
  v_exp_f32 v97, v97
  v_mfma_f32_16x16x32_bf16 a[4:7], a[160:163], v[8:11], a[4:7]
  ds_read_b64_tr_b16 a[186:187], v219 offset:4096
  v_cvt_pk_bf16_f32 v96, v96, v97
  v_mfma_f32_16x16x32_bf16 a[8:11], a[160:163], v[16:19], 0
  v_exp_f32 v98, v98
  v_mfma_f32_16x16x32_bf16 a[8:11], a[164:167], v[48:51], a[8:11]
  ds_read_b64_tr_b16 a[188:189], v219 offset:8192
  v_mfma_f32_16x16x32_bf16 a[12:15], a[164:167], v[56:59], 0
  s_waitcnt lgkmcnt(7)
  v_exp_f32 v99, v99
  v_mfma_f32_16x16x32_bf16 a[12:15], a[160:163], v[24:27], a[12:15]
  ds_read_b64_tr_b16 a[190:191], v219 offset:12288
  v_cvt_pk_bf16_f32 v97, v98, v99
  v_mfma_f32_16x16x32_bf16 a[16:19], a[168:171], v[0:3], 0
  v_exp_f32 v104, v104
  v_mfma_f32_16x16x32_bf16 a[16:19], a[172:175], v[32:35], a[16:19]
  ds_read_b64_tr_b16 a[160:161], v220 offset:0
  v_mfma_f32_16x16x32_bf16 a[20:23], a[172:175], v[40:43], 0
  v_exp_f32 v105, v105
  v_mfma_f32_16x16x32_bf16 a[20:23], a[168:171], v[8:11], a[20:23]
  ds_read_b64_tr_b16 a[162:163], v220 offset:4096
  v_cvt_pk_bf16_f32 v104, v104, v105
  v_mfma_f32_16x16x32_bf16 a[24:27], a[168:171], v[16:19], 0
  v_exp_f32 v106, v106
  v_mfma_f32_16x16x32_bf16 a[24:27], a[172:175], v[48:51], a[24:27]
  ds_read_b64_tr_b16 a[164:165], v220 offset:8192
  v_mfma_f32_16x16x32_bf16 a[28:31], a[172:175], v[56:59], 0
  s_waitcnt lgkmcnt(7)
  v_exp_f32 v107, v107
  v_mfma_f32_16x16x32_bf16 a[28:31], a[168:171], v[24:27], a[28:31]
  ds_read_b64_tr_b16 a[166:167], v220 offset:12288
  v_cvt_pk_bf16_f32 v105, v106, v107
  v_mfma_f32_16x16x32_bf16 a[32:35], a[176:179], v[0:3], 0
  v_exp_f32 v112, v112
  v_mfma_f32_16x16x32_bf16 a[32:35], a[180:183], v[32:35], a[32:35]
  ds_read_b64_tr_b16 a[168:169], v221 offset:0
  v_mfma_f32_16x16x32_bf16 a[36:39], a[180:183], v[40:43], 0
  v_exp_f32 v113, v113
  v_mfma_f32_16x16x32_bf16 a[36:39], a[176:179], v[8:11], a[36:39]
  ds_read_b64_tr_b16 a[170:171], v221 offset:4096
  v_cvt_pk_bf16_f32 v112, v112, v113
  v_mfma_f32_16x16x32_bf16 a[40:43], a[176:179], v[16:19], 0
  v_exp_f32 v114, v114
  v_mfma_f32_16x16x32_bf16 a[40:43], a[180:183], v[48:51], a[40:43]
  ds_read_b64_tr_b16 a[172:173], v221 offset:8192
  v_mfma_f32_16x16x32_bf16 a[44:47], a[180:183], v[56:59], 0
  s_waitcnt lgkmcnt(7)
  v_exp_f32 v115, v115
  v_mfma_f32_16x16x32_bf16 a[44:47], a[176:179], v[24:27], a[44:47]
  ds_read_b64_tr_b16 a[174:175], v221 offset:12288
  v_cvt_pk_bf16_f32 v113, v114, v115
  v_mfma_f32_16x16x32_bf16 a[48:51], a[184:187], v[0:3], 0
  v_exp_f32 v120, v120
  v_mfma_f32_16x16x32_bf16 a[48:51], a[188:191], v[32:35], a[48:51]
  ds_read_b64_tr_b16 a[176:177], v222 offset:0
  v_mfma_f32_16x16x32_bf16 a[52:55], a[188:191], v[40:43], 0
  v_exp_f32 v121, v121
  v_mfma_f32_16x16x32_bf16 a[52:55], a[184:187], v[8:11], a[52:55]
  ds_read_b64_tr_b16 a[178:179], v222 offset:4096
  v_cvt_pk_bf16_f32 v120, v120, v121
  v_mfma_f32_16x16x32_bf16 a[56:59], a[184:187], v[16:19], 0
  v_exp_f32 v122, v122
  v_mfma_f32_16x16x32_bf16 a[56:59], a[188:191], v[48:51], a[56:59]
  ds_read_b64_tr_b16 a[180:181], v222 offset:8192
  v_mfma_f32_16x16x32_bf16 a[60:63], a[188:191], v[56:59], 0
  s_waitcnt lgkmcnt(7)
  v_exp_f32 v123, v123
  v_mfma_f32_16x16x32_bf16 a[60:63], a[184:187], v[24:27], a[60:63]
  ds_read_b64_tr_b16 a[182:183], v222 offset:12288
  v_cvt_pk_bf16_f32 v121, v122, v123
  v_mfma_f32_16x16x32_bf16 a[64:67], a[160:163], v[0:3], 0
  v_exp_f32 v100, v100
  v_mfma_f32_16x16x32_bf16 a[64:67], a[164:167], v[32:35], a[64:67]
  ds_read_b64_tr_b16 a[184:185], v223 offset:0
  v_mfma_f32_16x16x32_bf16 a[68:71], a[164:167], v[40:43], 0
  v_exp_f32 v101, v101
  v_mfma_f32_16x16x32_bf16 a[68:71], a[160:163], v[8:11], a[68:71]
  ds_read_b64_tr_b16 a[186:187], v223 offset:4096
  v_cvt_pk_bf16_f32 v98, v100, v101
  v_mfma_f32_16x16x32_bf16 a[72:75], a[160:163], v[16:19], 0
  v_exp_f32 v102, v102
  v_mfma_f32_16x16x32_bf16 a[72:75], a[164:167], v[48:51], a[72:75]
  ds_read_b64_tr_b16 a[188:189], v223 offset:8192
  v_mfma_f32_16x16x32_bf16 a[76:79], a[164:167], v[56:59], 0
  s_waitcnt lgkmcnt(7)
  v_exp_f32 v103, v103
  v_mfma_f32_16x16x32_bf16 a[76:79], a[160:163], v[24:27], a[76:79]
  ds_read_b64_tr_b16 a[190:191], v223 offset:12288
  v_cvt_pk_bf16_f32 v99, v102, v103
  v_mfma_f32_16x16x32_bf16 a[80:83], a[168:171], v[0:3], 0
  s_waitcnt vmcnt(10)
  v_exp_f32 v108, v108
  v_mfma_f32_16x16x32_bf16 a[80:83], a[172:175], v[32:35], a[80:83]
  v_mfma_f32_16x16x32_bf16 a[84:87], a[172:175], v[40:43], 0
  s_barrier
  v_exp_f32 v109, v109
  v_mfma_f32_16x16x32_bf16 a[84:87], a[168:171], v[8:11], a[84:87]
  ds_read_b128 a[128:131], v212 offset:32768
  v_cvt_pk_bf16_f32 v106, v108, v109
  v_mfma_f32_16x16x32_bf16 a[88:91], a[168:171], v[16:19], 0
  v_exp_f32 v110, v110
  v_mfma_f32_16x16x32_bf16 a[88:91], a[172:175], v[48:51], a[88:91]
  ds_read_b128 a[132:135], v213 offset:32768
  v_mfma_f32_16x16x32_bf16 a[92:95], a[172:175], v[56:59], 0
  s_waitcnt lgkmcnt(6)
  v_exp_f32 v111, v111
  v_mfma_f32_16x16x32_bf16 a[92:95], a[168:171], v[24:27], a[92:95]
  ds_read_b128 a[136:139], v214 offset:32768
  v_cvt_pk_bf16_f32 v107, v110, v111
  v_mfma_f32_16x16x32_bf16 a[96:99], a[176:179], v[0:3], 0
  s_mul_i32 s38, s3, 20480
  v_exp_f32 v116, v116
  v_mfma_f32_16x16x32_bf16 a[96:99], a[180:183], v[32:35], a[96:99]
  ds_read_b128 a[140:143], v215 offset:32768
  buffer_load_dwordx4 a[212:215], v243, s[24:27], s38 offen sc1
  s_add_u32 s38, s38, 4096
  v_mfma_f32_16x16x32_bf16 a[100:103], a[180:183], v[40:43], 0
  v_exp_f32 v117, v117
  v_mfma_f32_16x16x32_bf16 a[100:103], a[176:179], v[8:11], a[100:103]
  v_cvt_pk_bf16_f32 v114, v116, v117
  v_mfma_f32_16x16x32_bf16 a[104:107], a[176:179], v[16:19], 0
  v_exp_f32 v118, v118
  v_mfma_f32_16x16x32_bf16 a[104:107], a[180:183], v[48:51], a[104:107]
  v_mfma_f32_16x16x32_bf16 a[108:111], a[180:183], v[56:59], 0
  s_waitcnt lgkmcnt(4)
  v_exp_f32 v119, v119
  v_mfma_f32_16x16x32_bf16 a[108:111], a[176:179], v[24:27], a[108:111]
  v_cvt_pk_bf16_f32 v115, v118, v119
  v_mfma_f32_16x16x32_bf16 a[112:115], a[184:187], v[0:3], 0
  v_exp_f32 v124, v124
  v_mfma_f32_16x16x32_bf16 a[112:115], a[188:191], v[32:35], a[112:115]
  v_mfma_f32_16x16x32_bf16 a[116:119], a[188:191], v[40:43], 0
  v_exp_f32 v125, v125
  v_mfma_f32_16x16x32_bf16 a[116:119], a[184:187], v[8:11], a[116:119]
  v_cvt_pk_bf16_f32 v122, v124, v125
  v_mfma_f32_16x16x32_bf16 a[120:123], a[184:187], v[16:19], 0
  v_exp_f32 v126, v126
  v_mfma_f32_16x16x32_bf16 a[120:123], a[188:191], v[48:51], a[120:123]
  v_mfma_f32_16x16x32_bf16 a[124:127], a[188:191], v[56:59], 0
  s_waitcnt lgkmcnt(0)
  v_exp_f32 v127, v127
  v_mfma_f32_16x16x32_bf16 a[124:127], a[184:187], v[24:27], a[124:127]
  v_cvt_pk_bf16_f32 v123, v126, v127
  v_mfma_f32_16x16x32_bf16 v[0:3], a[128:131], v[128:131], v[192:195]
  s_add_u32 m0, s28, 114688
  v_mfma_f32_16x16x32_bf16 v[0:3], a[132:135], v[132:135], v[0:3]
  ds_read_b128 a[144:147], v212 offset:36864
  v_mfma_f32_16x16x32_bf16 v[0:3], a[136:139], v[136:139], v[0:3]
  buffer_load_dwordx4 v236, s[16:19], s29 offen offset:0 lds
  v_mfma_f32_16x16x32_bf16 v[0:3], a[140:143], v[140:143], v[0:3]
  ds_read_b128 a[148:151], v213 offset:36864
  v_mfma_f32_16x16x32_bf16 v[8:11], a[140:143], v[156:159], v[196:199]
  v_mfma_f32_16x16x32_bf16 v[8:11], a[136:139], v[152:155], v[8:11]
  ds_read_b128 a[152:155], v214 offset:36864
  v_mfma_f32_16x16x32_bf16 v[8:11], a[132:135], v[148:151], v[8:11]
  buffer_load_dwordx4 v237, s[16:19], s29 offen offset:1024 lds
  v_mfma_f32_16x16x32_bf16 v[8:11], a[128:131], v[144:147], v[8:11]
  ds_read_b128 a[156:159], v215 offset:36864
  v_mfma_f32_16x16x32_bf16 v[16:19], a[128:131], v[160:163], v[200:203]
  v_exp_f32 v0, v0
  v_mfma_f32_16x16x32_bf16 v[16:19], a[132:135], v[164:167], v[16:19]
  v_mfma_f32_16x16x32_bf16 v[16:19], a[136:139], v[168:171], v[16:19]
  v_exp_f32 v1, v1
  v_mfma_f32_16x16x32_bf16 v[16:19], a[140:143], v[172:175], v[16:19]
  v_cvt_pk_bf16_f32 v0, v0, v1
  v_mfma_f32_16x16x32_bf16 v[24:27], a[140:143], v[188:191], v[204:207]
  v_exp_f32 v2, v2
  v_mfma_f32_16x16x32_bf16 v[24:27], a[136:139], v[184:187], v[24:27]
  buffer_load_dwordx4 v236, s[16:19], s29 offen offset:2048 lds
  v_mfma_f32_16x16x32_bf16 v[24:27], a[132:135], v[180:183], v[24:27]
  s_waitcnt lgkmcnt(0)
  v_exp_f32 v3, v3
  v_mfma_f32_16x16x32_bf16 v[24:27], a[128:131], v[176:179], v[24:27]
  v_cvt_pk_bf16_f32 v1, v2, v3
  v_mfma_f32_16x16x32_bf16 v[4:7], a[144:147], v[128:131], v[192:195]
  v_exp_f32 v8, v8
  v_mfma_f32_16x16x32_bf16 v[4:7], a[148:151], v[132:135], v[4:7]
  ds_read_b128 a[128:131], v212 offset:40960
  v_mfma_f32_16x16x32_bf16 v[4:7], a[152:155], v[136:139], v[4:7]
  v_exp_f32 v9, v9
  v_mfma_f32_16x16x32_bf16 v[4:7], a[156:159], v[140:143], v[4:7]
  ds_read_b128 a[132:135], v213 offset:40960
  v_cvt_pk_bf16_f32 v8, v8, v9
  v_mfma_f32_16x16x32_bf16 v[12:15], a[156:159], v[156:159], v[196:199]
  v_exp_f32 v10, v10
  v_mfma_f32_16x16x32_bf16 v[12:15], a[152:155], v[152:155], v[12:15]
  ds_read_b128 a[136:139], v214 offset:40960
  v_mfma_f32_16x16x32_bf16 v[12:15], a[148:151], v[148:151], v[12:15]
  v_exp_f32 v11, v11
  v_mfma_f32_16x16x32_bf16 v[12:15], a[144:147], v[144:147], v[12:15]
  ds_read_b128 a[140:143], v215 offset:40960
  v_cvt_pk_bf16_f32 v9, v10, v11
  v_mfma_f32_16x16x32_bf16 v[20:23], a[144:147], v[160:163], v[200:203]
  v_exp_f32 v16, v16
  v_mfma_f32_16x16x32_bf16 v[20:23], a[148:151], v[164:167], v[20:23]
  buffer_load_dwordx4 v237, s[16:19], s29 offen offset:3072 lds
  v_mfma_f32_16x16x32_bf16 v[20:23], a[152:155], v[168:171], v[20:23]
  s_add_u32 s29, s29, 16384
  v_exp_f32 v17, v17
  v_mfma_f32_16x16x32_bf16 v[20:23], a[156:159], v[172:175], v[20:23]
  v_cvt_pk_bf16_f32 v16, v16, v17
  v_mfma_f32_16x16x32_bf16 v[28:31], a[156:159], v[188:191], v[204:207]
  s_add_u32 m0, s28, 0
  v_exp_f32 v18, v18
  v_mfma_f32_16x16x32_bf16 v[28:31], a[152:155], v[184:187], v[28:31]
  buffer_load_dwordx4 v232, s[12:15], s29 offen offset:0 lds
  v_mfma_f32_16x16x32_bf16 v[28:31], a[148:151], v[180:183], v[28:31]
  s_waitcnt lgkmcnt(0)
  v_exp_f32 v19, v19
  v_mfma_f32_16x16x32_bf16 v[28:31], a[144:147], v[176:179], v[28:31]
  v_cvt_pk_bf16_f32 v17, v18, v19
  v_mfma_f32_16x16x32_bf16 v[32:35], a[128:131], v[128:131], v[192:195]
  v_exp_f32 v24, v24
  v_mfma_f32_16x16x32_bf16 v[32:35], a[132:135], v[132:135], v[32:35]
  ds_read_b128 a[144:147], v212 offset:45056
  v_mfma_f32_16x16x32_bf16 v[32:35], a[136:139], v[136:139], v[32:35]
  v_exp_f32 v25, v25
  v_mfma_f32_16x16x32_bf16 v[32:35], a[140:143], v[140:143], v[32:35]
  ds_read_b128 a[148:151], v213 offset:45056
  v_cvt_pk_bf16_f32 v24, v24, v25
  v_mfma_f32_16x16x32_bf16 v[40:43], a[140:143], v[156:159], v[196:199]
  v_exp_f32 v26, v26
  v_mfma_f32_16x16x32_bf16 v[40:43], a[136:139], v[152:155], v[40:43]
  ds_read_b128 a[152:155], v214 offset:45056
  v_mfma_f32_16x16x32_bf16 v[40:43], a[132:135], v[148:151], v[40:43]
  v_exp_f32 v27, v27
  v_mfma_f32_16x16x32_bf16 v[40:43], a[128:131], v[144:147], v[40:43]
  ds_read_b128 a[156:159], v215 offset:45056
  v_cvt_pk_bf16_f32 v25, v26, v27
  v_mfma_f32_16x16x32_bf16 v[48:51], a[128:131], v[160:163], v[200:203]
  v_exp_f32 v4, v4
  v_mfma_f32_16x16x32_bf16 v[48:51], a[132:135], v[164:167], v[48:51]
  buffer_load_dwordx4 v233, s[12:15], s29 offen offset:1024 lds
  v_mfma_f32_16x16x32_bf16 v[48:51], a[136:139], v[168:171], v[48:51]
  v_exp_f32 v5, v5
  v_mfma_f32_16x16x32_bf16 v[48:51], a[140:143], v[172:175], v[48:51]
  v_cvt_pk_bf16_f32 v2, v4, v5
  v_mfma_f32_16x16x32_bf16 v[56:59], a[140:143], v[188:191], v[204:207]
  v_exp_f32 v6, v6
  v_mfma_f32_16x16x32_bf16 v[56:59], a[136:139], v[184:187], v[56:59]
  buffer_load_dwordx4 v234, s[12:15], s29 offen offset:2048 lds
  v_mfma_f32_16x16x32_bf16 v[56:59], a[132:135], v[180:183], v[56:59]
  s_waitcnt lgkmcnt(0)
  v_exp_f32 v7, v7
  v_mfma_f32_16x16x32_bf16 v[56:59], a[128:131], v[176:179], v[56:59]
  v_cvt_pk_bf16_f32 v3, v6, v7
  v_mfma_f32_16x16x32_bf16 v[36:39], a[144:147], v[128:131], v[192:195]
  v_exp_f32 v12, v12
  v_mfma_f32_16x16x32_bf16 v[36:39], a[148:151], v[132:135], v[36:39]
  ds_read_b64_tr_b16 a[160:161], v216 offset:16384
  v_mfma_f32_16x16x32_bf16 v[36:39], a[152:155], v[136:139], v[36:39]
  v_exp_f32 v13, v13
  v_mfma_f32_16x16x32_bf16 v[36:39], a[156:159], v[140:143], v[36:39]
  ds_read_b64_tr_b16 a[162:163], v216 offset:20480
  v_cvt_pk_bf16_f32 v10, v12, v13
  v_mfma_f32_16x16x32_bf16 v[44:47], a[156:159], v[156:159], v[196:199]
  v_exp_f32 v14, v14
  v_mfma_f32_16x16x32_bf16 v[44:47], a[152:155], v[152:155], v[44:47]
  ds_read_b64_tr_b16 a[164:165], v216 offset:24576
  buffer_load_dwordx4 v235, s[12:15], s29 offen offset:3072 lds
  v_mfma_f32_16x16x32_bf16 v[44:47], a[148:151], v[148:151], v[44:47]
  v_exp_f32 v15, v15
  v_mfma_f32_16x16x32_bf16 v[44:47], a[144:147], v[144:147], v[44:47]
  ds_read_b64_tr_b16 a[166:167], v216 offset:28672
  v_cvt_pk_bf16_f32 v11, v14, v15
  v_mfma_f32_16x16x32_bf16 v[52:55], a[144:147], v[160:163], v[200:203]
  v_exp_f32 v20, v20
  v_mfma_f32_16x16x32_bf16 v[52:55], a[148:151], v[164:167], v[52:55]
  ds_read_b64_tr_b16 a[168:169], v217 offset:16384
  s_add_u32 m0, s50, 1024
  v_mfma_f32_16x16x32_bf16 v[52:55], a[152:155], v[168:171], v[52:55]
  v_exp_f32 v21, v21
  v_mfma_f32_16x16x32_bf16 v[52:55], a[156:159], v[172:175], v[52:55]
  ds_read_b64_tr_b16 a[170:171], v217 offset:20480
  v_cvt_pk_bf16_f32 v18, v20, v21
  v_mfma_f32_16x16x32_bf16 v[60:63], a[156:159], v[188:191], v[204:207]
  v_exp_f32 v22, v22
  v_mfma_f32_16x16x32_bf16 v[60:63], a[152:155], v[184:187], v[60:63]
  ds_read_b64_tr_b16 a[172:173], v217 offset:24576
  buffer_load_dwordx4 v253, s[20:23], s35 offen lds
  v_mfma_f32_16x16x32_bf16 v[60:63], a[148:151], v[180:183], v[60:63]
  v_exp_f32 v23, v23
  v_mfma_f32_16x16x32_bf16 v[60:63], a[144:147], v[176:179], v[60:63]
  ds_read_b64_tr_b16 a[174:175], v217 offset:28672
  v_cvt_pk_bf16_f32 v19, v22, v23
  v_mfma_f32_16x16x32_bf16 a[192:195], a[208:211], v[64:67], a[192:195]
  v_exp_f32 v28, v28
  v_mfma_f32_16x16x32_bf16 a[192:195], a[208:211], v[96:99], a[192:195]
  ds_read_b64_tr_b16 a[176:177], v218 offset:16384
  v_mfma_f32_16x16x32_bf16 a[196:199], a[208:211], v[72:75], a[196:199]
  v_exp_f32 v29, v29
  v_mfma_f32_16x16x32_bf16 a[196:199], a[208:211], v[104:107], a[196:199]
  ds_read_b64_tr_b16 a[178:179], v218 offset:20480
  v_cvt_pk_bf16_f32 v26, v28, v29
  v_mfma_f32_16x16x32_bf16 a[200:203], a[208:211], v[80:83], a[200:203]
  v_exp_f32 v30, v30
  v_mfma_f32_16x16x32_bf16 a[200:203], a[208:211], v[112:115], a[200:203]
  ds_read_b64_tr_b16 a[180:181], v218 offset:24576
  v_mfma_f32_16x16x32_bf16 a[204:207], a[208:211], v[88:91], a[204:207]
  s_waitcnt lgkmcnt(7)
  v_exp_f32 v31, v31
  v_mfma_f32_16x16x32_bf16 a[204:207], a[208:211], v[120:123], a[204:207]
  ds_read_b64_tr_b16 a[182:183], v218 offset:28672
  v_cvt_pk_bf16_f32 v27, v30, v31
  v_mfma_f32_16x16x32_bf16 a[0:3], a[160:163], v[64:67], a[0:3]
  v_exp_f32 v32, v32
  v_mfma_f32_16x16x32_bf16 a[0:3], a[164:167], v[96:99], a[0:3]
  ds_read_b64_tr_b16 a[184:185], v219 offset:16384
  v_mfma_f32_16x16x32_bf16 a[4:7], a[164:167], v[104:107], a[4:7]
  v_exp_f32 v33, v33
  v_mfma_f32_16x16x32_bf16 a[4:7], a[160:163], v[72:75], a[4:7]
  ds_read_b64_tr_b16 a[186:187], v219 offset:20480
  v_cvt_pk_bf16_f32 v32, v32, v33
  v_mfma_f32_16x16x32_bf16 a[8:11], a[160:163], v[80:83], a[8:11]
  v_exp_f32 v34, v34
  v_mfma_f32_16x16x32_bf16 a[8:11], a[164:167], v[112:115], a[8:11]
  ds_read_b64_tr_b16 a[188:189], v219 offset:24576
  v_mfma_f32_16x16x32_bf16 a[12:15], a[164:167], v[120:123], a[12:15]
  s_waitcnt lgkmcnt(7)
  v_exp_f32 v35, v35
  v_mfma_f32_16x16x32_bf16 a[12:15], a[160:163], v[88:91], a[12:15]
  ds_read_b64_tr_b16 a[190:191], v219 offset:28672
  v_cvt_pk_bf16_f32 v33, v34, v35
  v_mfma_f32_16x16x32_bf16 a[16:19], a[168:171], v[64:67], a[16:19]
  v_exp_f32 v40, v40
  v_mfma_f32_16x16x32_bf16 a[16:19], a[172:175], v[96:99], a[16:19]
  ds_read_b64_tr_b16 a[160:161], v220 offset:16384
  v_mfma_f32_16x16x32_bf16 a[20:23], a[172:175], v[104:107], a[20:23]
  v_exp_f32 v41, v41
  v_mfma_f32_16x16x32_bf16 a[20:23], a[168:171], v[72:75], a[20:23]
  ds_read_b64_tr_b16 a[162:163], v220 offset:20480
  v_cvt_pk_bf16_f32 v40, v40, v41
  v_mfma_f32_16x16x32_bf16 a[24:27], a[168:171], v[80:83], a[24:27]
  v_exp_f32 v42, v42
  v_mfma_f32_16x16x32_bf16 a[24:27], a[172:175], v[112:115], a[24:27]
  ds_read_b64_tr_b16 a[164:165], v220 offset:24576
  v_mfma_f32_16x16x32_bf16 a[28:31], a[172:175], v[120:123], a[28:31]
  s_waitcnt lgkmcnt(7)
  v_exp_f32 v43, v43
  v_mfma_f32_16x16x32_bf16 a[28:31], a[168:171], v[88:91], a[28:31]
  ds_read_b64_tr_b16 a[166:167], v220 offset:28672
  v_cvt_pk_bf16_f32 v41, v42, v43
  v_mfma_f32_16x16x32_bf16 a[32:35], a[176:179], v[64:67], a[32:35]
  v_exp_f32 v48, v48
  v_mfma_f32_16x16x32_bf16 a[32:35], a[180:183], v[96:99], a[32:35]
  ds_read_b64_tr_b16 a[168:169], v221 offset:16384
  v_mfma_f32_16x16x32_bf16 a[36:39], a[180:183], v[104:107], a[36:39]
  v_exp_f32 v49, v49
  v_mfma_f32_16x16x32_bf16 a[36:39], a[176:179], v[72:75], a[36:39]
  ds_read_b64_tr_b16 a[170:171], v221 offset:20480
  v_cvt_pk_bf16_f32 v48, v48, v49
  v_mfma_f32_16x16x32_bf16 a[40:43], a[176:179], v[80:83], a[40:43]
  v_exp_f32 v50, v50
  v_mfma_f32_16x16x32_bf16 a[40:43], a[180:183], v[112:115], a[40:43]
  ds_read_b64_tr_b16 a[172:173], v221 offset:24576
  v_mfma_f32_16x16x32_bf16 a[44:47], a[180:183], v[120:123], a[44:47]
  s_waitcnt lgkmcnt(7)
  v_exp_f32 v51, v51
  v_mfma_f32_16x16x32_bf16 a[44:47], a[176:179], v[88:91], a[44:47]
  ds_read_b64_tr_b16 a[174:175], v221 offset:28672
  v_cvt_pk_bf16_f32 v49, v50, v51
  v_mfma_f32_16x16x32_bf16 a[48:51], a[184:187], v[64:67], a[48:51]
  v_exp_f32 v56, v56
  v_mfma_f32_16x16x32_bf16 a[48:51], a[188:191], v[96:99], a[48:51]
  ds_read_b64_tr_b16 a[176:177], v222 offset:16384
  v_mfma_f32_16x16x32_bf16 a[52:55], a[188:191], v[104:107], a[52:55]
  v_exp_f32 v57, v57
  v_mfma_f32_16x16x32_bf16 a[52:55], a[184:187], v[72:75], a[52:55]
  ds_read_b64_tr_b16 a[178:179], v222 offset:20480
  v_cvt_pk_bf16_f32 v56, v56, v57
  v_mfma_f32_16x16x32_bf16 a[56:59], a[184:187], v[80:83], a[56:59]
  v_exp_f32 v58, v58
  v_mfma_f32_16x16x32_bf16 a[56:59], a[188:191], v[112:115], a[56:59]
  ds_read_b64_tr_b16 a[180:181], v222 offset:24576
  v_mfma_f32_16x16x32_bf16 a[60:63], a[188:191], v[120:123], a[60:63]
  s_waitcnt lgkmcnt(7)
  v_exp_f32 v59, v59
  v_mfma_f32_16x16x32_bf16 a[60:63], a[184:187], v[88:91], a[60:63]
  ds_read_b64_tr_b16 a[182:183], v222 offset:28672
  v_cvt_pk_bf16_f32 v57, v58, v59
  v_mfma_f32_16x16x32_bf16 a[64:67], a[160:163], v[64:67], a[64:67]
  v_exp_f32 v36, v36
  v_mfma_f32_16x16x32_bf16 a[64:67], a[164:167], v[96:99], a[64:67]
  ds_read_b64_tr_b16 a[184:185], v223 offset:16384
  v_mfma_f32_16x16x32_bf16 a[68:71], a[164:167], v[104:107], a[68:71]
  v_exp_f32 v37, v37
  v_mfma_f32_16x16x32_bf16 a[68:71], a[160:163], v[72:75], a[68:71]
  ds_read_b64_tr_b16 a[186:187], v223 offset:20480
  v_cvt_pk_bf16_f32 v34, v36, v37
  v_mfma_f32_16x16x32_bf16 a[72:75], a[160:163], v[80:83], a[72:75]
  v_exp_f32 v38, v38
  v_mfma_f32_16x16x32_bf16 a[72:75], a[164:167], v[112:115], a[72:75]
  ds_read_b64_tr_b16 a[188:189], v223 offset:24576
  v_mfma_f32_16x16x32_bf16 a[76:79], a[164:167], v[120:123], a[76:79]
  s_waitcnt lgkmcnt(7)
  v_exp_f32 v39, v39
  v_mfma_f32_16x16x32_bf16 a[76:79], a[160:163], v[88:91], a[76:79]
  ds_read_b64_tr_b16 a[190:191], v223 offset:28672
  v_cvt_pk_bf16_f32 v35, v38, v39
  v_mfma_f32_16x16x32_bf16 a[80:83], a[168:171], v[64:67], a[80:83]
  s_waitcnt vmcnt(11)
  v_exp_f32 v44, v44
  v_mfma_f32_16x16x32_bf16 a[80:83], a[172:175], v[96:99], a[80:83]
  v_mfma_f32_16x16x32_bf16 a[84:87], a[172:175], v[104:107], a[84:87]
  s_barrier
  v_exp_f32 v45, v45
  v_mfma_f32_16x16x32_bf16 a[84:87], a[168:171], v[72:75], a[84:87]
  ds_read_b128 a[128:131], v212 offset:49152
  v_cvt_pk_bf16_f32 v42, v44, v45
  v_mfma_f32_16x16x32_bf16 a[88:91], a[168:171], v[80:83], a[88:91]
  v_exp_f32 v46, v46
  v_mfma_f32_16x16x32_bf16 a[88:91], a[172:175], v[112:115], a[88:91]
  ds_read_b128 a[132:135], v213 offset:49152
  v_mfma_f32_16x16x32_bf16 a[92:95], a[172:175], v[120:123], a[92:95]
  s_waitcnt lgkmcnt(6)
  v_exp_f32 v47, v47
  v_mfma_f32_16x16x32_bf16 a[92:95], a[168:171], v[88:91], a[92:95]
  ds_read_b128 a[136:139], v214 offset:49152
  v_cvt_pk_bf16_f32 v43, v46, v47
  v_mfma_f32_16x16x32_bf16 a[96:99], a[176:179], v[64:67], a[96:99]
  v_exp_f32 v52, v52
  v_mfma_f32_16x16x32_bf16 a[96:99], a[180:183], v[96:99], a[96:99]
  ds_read_b128 a[140:143], v215 offset:49152
  buffer_load_dwordx4 a[216:219], v243, s[24:27], s38 offen sc1
  s_add_u32 s38, s38, 4096
  v_mfma_f32_16x16x32_bf16 a[100:103], a[180:183], v[104:107], a[100:103]
  v_exp_f32 v53, v53
  v_mfma_f32_16x16x32_bf16 a[100:103], a[176:179], v[72:75], a[100:103]
  v_cvt_pk_bf16_f32 v50, v52, v53
  v_mfma_f32_16x16x32_bf16 a[104:107], a[176:179], v[80:83], a[104:107]
  v_exp_f32 v54, v54
  v_mfma_f32_16x16x32_bf16 a[104:107], a[180:183], v[112:115], a[104:107]
  v_mfma_f32_16x16x32_bf16 a[108:111], a[180:183], v[120:123], a[108:111]
  s_waitcnt lgkmcnt(4)
  v_exp_f32 v55, v55
  v_mfma_f32_16x16x32_bf16 a[108:111], a[176:179], v[88:91], a[108:111]
  v_cvt_pk_bf16_f32 v51, v54, v55
  v_mfma_f32_16x16x32_bf16 a[112:115], a[184:187], v[64:67], a[112:115]
  v_exp_f32 v60, v60
  v_mfma_f32_16x16x32_bf16 a[112:115], a[188:191], v[96:99], a[112:115]
  v_mfma_f32_16x16x32_bf16 a[116:119], a[188:191], v[104:107], a[116:119]
  v_exp_f32 v61, v61
  v_mfma_f32_16x16x32_bf16 a[116:119], a[184:187], v[72:75], a[116:119]
  v_cvt_pk_bf16_f32 v58, v60, v61
  v_mfma_f32_16x16x32_bf16 a[120:123], a[184:187], v[80:83], a[120:123]
  v_exp_f32 v62, v62
  v_mfma_f32_16x16x32_bf16 a[120:123], a[188:191], v[112:115], a[120:123]
  v_mfma_f32_16x16x32_bf16 a[124:127], a[188:191], v[120:123], a[124:127]
  s_waitcnt lgkmcnt(0)
  v_exp_f32 v63, v63
  v_mfma_f32_16x16x32_bf16 a[124:127], a[184:187], v[88:91], a[124:127]
  v_cvt_pk_bf16_f32 v59, v62, v63
  v_mfma_f32_16x16x32_bf16 v[64:67], a[128:131], v[128:131], v[192:195]
  s_add_u32 m0, s28, 65536
  v_mfma_f32_16x16x32_bf16 v[64:67], a[132:135], v[132:135], v[64:67]
  ds_read_b128 a[144:147], v212 offset:53248
  v_mfma_f32_16x16x32_bf16 v[64:67], a[136:139], v[136:139], v[64:67]
  buffer_load_dwordx4 v236, s[16:19], s29 offen offset:0 lds
  v_mfma_f32_16x16x32_bf16 v[64:67], a[140:143], v[140:143], v[64:67]
  ds_read_b128 a[148:151], v213 offset:53248
  v_mfma_f32_16x16x32_bf16 v[72:75], a[140:143], v[156:159], v[196:199]
  v_mfma_f32_16x16x32_bf16 v[72:75], a[136:139], v[152:155], v[72:75]
  ds_read_b128 a[152:155], v214 offset:53248
  v_mfma_f32_16x16x32_bf16 v[72:75], a[132:135], v[148:151], v[72:75]
  buffer_load_dwordx4 v237, s[16:19], s29 offen offset:1024 lds
  v_mfma_f32_16x16x32_bf16 v[72:75], a[128:131], v[144:147], v[72:75]
  ds_read_b128 a[156:159], v215 offset:53248
  v_mfma_f32_16x16x32_bf16 v[80:83], a[128:131], v[160:163], v[200:203]
  v_exp_f32 v64, v64
  v_mfma_f32_16x16x32_bf16 v[80:83], a[132:135], v[164:167], v[80:83]
  v_mfma_f32_16x16x32_bf16 v[80:83], a[136:139], v[168:171], v[80:83]
  v_exp_f32 v65, v65
  v_mfma_f32_16x16x32_bf16 v[80:83], a[140:143], v[172:175], v[80:83]
  v_cvt_pk_bf16_f32 v64, v64, v65
  v_mfma_f32_16x16x32_bf16 v[88:91], a[140:143], v[188:191], v[204:207]
  v_exp_f32 v66, v66
  v_mfma_f32_16x16x32_bf16 v[88:91], a[136:139], v[184:187], v[88:91]
  buffer_load_dwordx4 v236, s[16:19], s29 offen offset:2048 lds
  v_mfma_f32_16x16x32_bf16 v[88:91], a[132:135], v[180:183], v[88:91]
  s_waitcnt lgkmcnt(0)
  v_exp_f32 v67, v67
  v_mfma_f32_16x16x32_bf16 v[88:91], a[128:131], v[176:179], v[88:91]
  v_cvt_pk_bf16_f32 v65, v66, v67
  v_mfma_f32_16x16x32_bf16 v[68:71], a[144:147], v[128:131], v[192:195]
  v_exp_f32 v72, v72
  v_mfma_f32_16x16x32_bf16 v[68:71], a[148:151], v[132:135], v[68:71]
  ds_read_b128 a[128:131], v212 offset:57344
  v_mfma_f32_16x16x32_bf16 v[68:71], a[152:155], v[136:139], v[68:71]
  v_exp_f32 v73, v73
  v_mfma_f32_16x16x32_bf16 v[68:71], a[156:159], v[140:143], v[68:71]
  ds_read_b128 a[132:135], v213 offset:57344
  v_cvt_pk_bf16_f32 v72, v72, v73
  v_mfma_f32_16x16x32_bf16 v[76:79], a[156:159], v[156:159], v[196:199]
  v_exp_f32 v74, v74
  v_mfma_f32_16x16x32_bf16 v[76:79], a[152:155], v[152:155], v[76:79]
  ds_read_b128 a[136:139], v214 offset:57344
  v_mfma_f32_16x16x32_bf16 v[76:79], a[148:151], v[148:151], v[76:79]
  v_exp_f32 v75, v75
  v_mfma_f32_16x16x32_bf16 v[76:79], a[144:147], v[144:147], v[76:79]
  ds_read_b128 a[140:143], v215 offset:57344
  v_cvt_pk_bf16_f32 v73, v74, v75
  v_mfma_f32_16x16x32_bf16 v[84:87], a[144:147], v[160:163], v[200:203]
  v_exp_f32 v80, v80
  v_mfma_f32_16x16x32_bf16 v[84:87], a[148:151], v[164:167], v[84:87]
  buffer_load_dwordx4 v237, s[16:19], s29 offen offset:3072 lds
  v_mfma_f32_16x16x32_bf16 v[84:87], a[152:155], v[168:171], v[84:87]
  s_add_u32 s29, s29, 16384
  v_exp_f32 v81, v81
  v_mfma_f32_16x16x32_bf16 v[84:87], a[156:159], v[172:175], v[84:87]
  v_cvt_pk_bf16_f32 v80, v80, v81
  v_mfma_f32_16x16x32_bf16 v[92:95], a[156:159], v[188:191], v[204:207]
  s_add_u32 m0, s28, 16384
  v_exp_f32 v82, v82
  v_mfma_f32_16x16x32_bf16 v[92:95], a[152:155], v[184:187], v[92:95]
  buffer_load_dwordx4 v232, s[12:15], s29 offen offset:0 lds
  v_mfma_f32_16x16x32_bf16 v[92:95], a[148:151], v[180:183], v[92:95]
  s_waitcnt lgkmcnt(0)
  v_exp_f32 v83, v83
  v_mfma_f32_16x16x32_bf16 v[92:95], a[144:147], v[176:179], v[92:95]
  v_cvt_pk_bf16_f32 v81, v82, v83
  v_mfma_f32_16x16x32_bf16 v[96:99], a[128:131], v[128:131], v[192:195]
  v_exp_f32 v88, v88
  v_mfma_f32_16x16x32_bf16 v[96:99], a[132:135], v[132:135], v[96:99]
  ds_read_b128 a[144:147], v212 offset:61440
  v_mfma_f32_16x16x32_bf16 v[96:99], a[136:139], v[136:139], v[96:99]
  v_exp_f32 v89, v89
  v_mfma_f32_16x16x32_bf16 v[96:99], a[140:143], v[140:143], v[96:99]
  ds_read_b128 a[148:151], v213 offset:61440
  v_cvt_pk_bf16_f32 v88, v88, v89
  v_mfma_f32_16x16x32_bf16 v[104:107], a[140:143], v[156:159], v[196:199]
  v_exp_f32 v90, v90
  v_mfma_f32_16x16x32_bf16 v[104:107], a[136:139], v[152:155], v[104:107]
  ds_read_b128 a[152:155], v214 offset:61440
  v_mfma_f32_16x16x32_bf16 v[104:107], a[132:135], v[148:151], v[104:107]
  v_exp_f32 v91, v91
  v_mfma_f32_16x16x32_bf16 v[104:107], a[128:131], v[144:147], v[104:107]
  ds_read_b128 a[156:159], v215 offset:61440
  v_cvt_pk_bf16_f32 v89, v90, v91
  v_mfma_f32_16x16x32_bf16 v[112:115], a[128:131], v[160:163], v[200:203]
  v_exp_f32 v68, v68
  v_mfma_f32_16x16x32_bf16 v[112:115], a[132:135], v[164:167], v[112:115]
  buffer_load_dwordx4 v233, s[12:15], s29 offen offset:1024 lds
  v_mfma_f32_16x16x32_bf16 v[112:115], a[136:139], v[168:171], v[112:115]
  v_exp_f32 v69, v69
  v_mfma_f32_16x16x32_bf16 v[112:115], a[140:143], v[172:175], v[112:115]
  v_cvt_pk_bf16_f32 v66, v68, v69
  v_mfma_f32_16x16x32_bf16 v[120:123], a[140:143], v[188:191], v[204:207]
  v_exp_f32 v70, v70
  v_mfma_f32_16x16x32_bf16 v[120:123], a[136:139], v[184:187], v[120:123]
  buffer_load_dwordx4 v234, s[12:15], s29 offen offset:2048 lds
  v_mfma_f32_16x16x32_bf16 v[120:123], a[132:135], v[180:183], v[120:123]
  s_waitcnt lgkmcnt(0)
  v_exp_f32 v71, v71
  v_mfma_f32_16x16x32_bf16 v[120:123], a[128:131], v[176:179], v[120:123]
  v_cvt_pk_bf16_f32 v67, v70, v71
  v_mfma_f32_16x16x32_bf16 v[100:103], a[144:147], v[128:131], v[192:195]
  v_exp_f32 v76, v76
  v_mfma_f32_16x16x32_bf16 v[100:103], a[148:151], v[132:135], v[100:103]
  ds_read_b64_tr_b16 a[160:161], v216 offset:32768
  v_mfma_f32_16x16x32_bf16 v[100:103], a[152:155], v[136:139], v[100:103]
  v_exp_f32 v77, v77
  v_mfma_f32_16x16x32_bf16 v[100:103], a[156:159], v[140:143], v[100:103]
  ds_read_b64_tr_b16 a[162:163], v216 offset:36864
  v_cvt_pk_bf16_f32 v74, v76, v77
  v_mfma_f32_16x16x32_bf16 v[108:111], a[156:159], v[156:159], v[196:199]
  v_exp_f32 v78, v78
  v_mfma_f32_16x16x32_bf16 v[108:111], a[152:155], v[152:155], v[108:111]
  ds_read_b64_tr_b16 a[164:165], v216 offset:40960
  buffer_load_dwordx4 v235, s[12:15], s29 offen offset:3072 lds
  v_mfma_f32_16x16x32_bf16 v[108:111], a[148:151], v[148:151], v[108:111]
  v_exp_f32 v79, v79
  v_mfma_f32_16x16x32_bf16 v[108:111], a[144:147], v[144:147], v[108:111]
  ds_read_b64_tr_b16 a[166:167], v216 offset:45056
  v_cvt_pk_bf16_f32 v75, v78, v79
  v_mfma_f32_16x16x32_bf16 v[116:119], a[144:147], v[160:163], v[200:203]
  v_exp_f32 v84, v84
  v_mfma_f32_16x16x32_bf16 v[116:119], a[148:151], v[164:167], v[116:119]
  ds_read_b64_tr_b16 a[168:169], v217 offset:32768
  s_add_u32 m0, s50, 4096
  v_mfma_f32_16x16x32_bf16 v[116:119], a[152:155], v[168:171], v[116:119]
  v_exp_f32 v85, v85
  v_mfma_f32_16x16x32_bf16 v[116:119], a[156:159], v[172:175], v[116:119]
  ds_read_b64_tr_b16 a[170:171], v217 offset:36864
  v_cvt_pk_bf16_f32 v82, v84, v85
  v_mfma_f32_16x16x32_bf16 v[124:127], a[156:159], v[188:191], v[204:207]
  v_exp_f32 v86, v86
  v_mfma_f32_16x16x32_bf16 v[124:127], a[152:155], v[184:187], v[124:127]
  ds_read_b64_tr_b16 a[172:173], v217 offset:40960
  buffer_load_dwordx4 v253, s[44:47], s35 offen lds
  s_add_u32 s35, s35, 221184
  v_mfma_f32_16x16x32_bf16 v[124:127], a[148:151], v[180:183], v[124:127]
  v_exp_f32 v87, v87
  v_mfma_f32_16x16x32_bf16 v[124:127], a[144:147], v[176:179], v[124:127]
  ds_read_b64_tr_b16 a[174:175], v217 offset:45056
  v_cvt_pk_bf16_f32 v83, v86, v87
  v_mfma_f32_16x16x32_bf16 a[192:195], a[208:211], v[0:3], a[192:195]
  v_exp_f32 v92, v92
  v_mfma_f32_16x16x32_bf16 a[192:195], a[208:211], v[32:35], a[192:195]
  ds_read_b64_tr_b16 a[176:177], v218 offset:32768
  v_lshrrev_b32 v254, 4, v242
  v_mfma_f32_16x16x32_bf16 a[196:199], a[208:211], v[8:11], a[196:199]
  v_exp_f32 v93, v93
  v_mfma_f32_16x16x32_bf16 a[196:199], a[208:211], v[40:43], a[196:199]
  ds_read_b64_tr_b16 a[178:179], v218 offset:36864
  v_cvt_pk_bf16_f32 v90, v92, v93
  v_mfma_f32_16x16x32_bf16 a[200:203], a[208:211], v[16:19], a[200:203]
  v_exp_f32 v94, v94
  v_mfma_f32_16x16x32_bf16 a[200:203], a[208:211], v[48:51], a[200:203]
  ds_read_b64_tr_b16 a[180:181], v218 offset:40960
  v_lshrrev_b32 v254, 5, v254
  v_mfma_f32_16x16x32_bf16 a[204:207], a[208:211], v[24:27], a[204:207]
  s_waitcnt lgkmcnt(7)
  v_exp_f32 v95, v95
  v_mfma_f32_16x16x32_bf16 a[204:207], a[208:211], v[56:59], a[204:207]
  ds_read_b64_tr_b16 a[182:183], v218 offset:45056
  v_cvt_pk_bf16_f32 v91, v94, v95
  v_mfma_f32_16x16x32_bf16 a[0:3], a[160:163], v[0:3], a[0:3]
  v_exp_f32 v96, v96
  v_mfma_f32_16x16x32_bf16 a[0:3], a[164:167], v[32:35], a[0:3]
  ds_read_b64_tr_b16 a[184:185], v219 offset:32768
  v_lshl_add_u32 v253, v254, 30, v253
  v_mfma_f32_16x16x32_bf16 a[4:7], a[164:167], v[40:43], a[4:7]
  v_exp_f32 v97, v97
  v_mfma_f32_16x16x32_bf16 a[4:7], a[160:163], v[8:11], a[4:7]
  ds_read_b64_tr_b16 a[186:187], v219 offset:36864
  v_cvt_pk_bf16_f32 v96, v96, v97
  v_mfma_f32_16x16x32_bf16 a[8:11], a[160:163], v[16:19], a[8:11]
  v_exp_f32 v98, v98
  v_mfma_f32_16x16x32_bf16 a[8:11], a[164:167], v[48:51], a[8:11]
  ds_read_b64_tr_b16 a[188:189], v219 offset:40960
  v_mfma_f32_16x16x32_bf16 a[12:15], a[164:167], v[56:59], a[12:15]
  s_waitcnt lgkmcnt(7)
  v_exp_f32 v99, v99
  v_mfma_f32_16x16x32_bf16 a[12:15], a[160:163], v[24:27], a[12:15]
  ds_read_b64_tr_b16 a[190:191], v219 offset:45056
  v_cvt_pk_bf16_f32 v97, v98, v99
  v_mfma_f32_16x16x32_bf16 a[16:19], a[168:171], v[0:3], a[16:19]
  v_exp_f32 v104, v104
  v_mfma_f32_16x16x32_bf16 a[16:19], a[172:175], v[32:35], a[16:19]
  ds_read_b64_tr_b16 a[160:161], v220 offset:32768
  v_mfma_f32_16x16x32_bf16 a[20:23], a[172:175], v[40:43], a[20:23]
  v_exp_f32 v105, v105
  v_mfma_f32_16x16x32_bf16 a[20:23], a[168:171], v[8:11], a[20:23]
  ds_read_b64_tr_b16 a[162:163], v220 offset:36864
  v_cvt_pk_bf16_f32 v104, v104, v105
  v_mfma_f32_16x16x32_bf16 a[24:27], a[168:171], v[16:19], a[24:27]
  v_exp_f32 v106, v106
  v_mfma_f32_16x16x32_bf16 a[24:27], a[172:175], v[48:51], a[24:27]
  ds_read_b64_tr_b16 a[164:165], v220 offset:40960
  v_mfma_f32_16x16x32_bf16 a[28:31], a[172:175], v[56:59], a[28:31]
  s_waitcnt lgkmcnt(7)
  v_exp_f32 v107, v107
  v_mfma_f32_16x16x32_bf16 a[28:31], a[168:171], v[24:27], a[28:31]
  ds_read_b64_tr_b16 a[166:167], v220 offset:45056
  v_cvt_pk_bf16_f32 v105, v106, v107
  v_mfma_f32_16x16x32_bf16 a[32:35], a[176:179], v[0:3], a[32:35]
  v_exp_f32 v112, v112
  v_mfma_f32_16x16x32_bf16 a[32:35], a[180:183], v[32:35], a[32:35]
  ds_read_b64_tr_b16 a[168:169], v221 offset:32768
  v_mfma_f32_16x16x32_bf16 a[36:39], a[180:183], v[40:43], a[36:39]
  v_exp_f32 v113, v113
  v_mfma_f32_16x16x32_bf16 a[36:39], a[176:179], v[8:11], a[36:39]
  ds_read_b64_tr_b16 a[170:171], v221 offset:36864
  v_cvt_pk_bf16_f32 v112, v112, v113
  v_mfma_f32_16x16x32_bf16 a[40:43], a[176:179], v[16:19], a[40:43]
  v_exp_f32 v114, v114
  v_mfma_f32_16x16x32_bf16 a[40:43], a[180:183], v[48:51], a[40:43]
  ds_read_b64_tr_b16 a[172:173], v221 offset:40960
  v_mfma_f32_16x16x32_bf16 a[44:47], a[180:183], v[56:59], a[44:47]
  s_waitcnt lgkmcnt(7)
  v_exp_f32 v115, v115
  v_mfma_f32_16x16x32_bf16 a[44:47], a[176:179], v[24:27], a[44:47]
  ds_read_b64_tr_b16 a[174:175], v221 offset:45056
  v_cvt_pk_bf16_f32 v113, v114, v115
  v_mfma_f32_16x16x32_bf16 a[48:51], a[184:187], v[0:3], a[48:51]
  v_exp_f32 v120, v120
  v_mfma_f32_16x16x32_bf16 a[48:51], a[188:191], v[32:35], a[48:51]
  ds_read_b64_tr_b16 a[176:177], v222 offset:32768
  v_mfma_f32_16x16x32_bf16 a[52:55], a[188:191], v[40:43], a[52:55]
  v_exp_f32 v121, v121
  v_mfma_f32_16x16x32_bf16 a[52:55], a[184:187], v[8:11], a[52:55]
  ds_read_b64_tr_b16 a[178:179], v222 offset:36864
  v_cvt_pk_bf16_f32 v120, v120, v121
  v_mfma_f32_16x16x32_bf16 a[56:59], a[184:187], v[16:19], a[56:59]
  v_exp_f32 v122, v122
  v_mfma_f32_16x16x32_bf16 a[56:59], a[188:191], v[48:51], a[56:59]
  ds_read_b64_tr_b16 a[180:181], v222 offset:40960
  v_mfma_f32_16x16x32_bf16 a[60:63], a[188:191], v[56:59], a[60:63]
  s_waitcnt lgkmcnt(7)
  v_exp_f32 v123, v123
  v_mfma_f32_16x16x32_bf16 a[60:63], a[184:187], v[24:27], a[60:63]
  ds_read_b64_tr_b16 a[182:183], v222 offset:45056
  v_cvt_pk_bf16_f32 v121, v122, v123
  v_mfma_f32_16x16x32_bf16 a[64:67], a[160:163], v[0:3], a[64:67]
  v_exp_f32 v100, v100
  v_mfma_f32_16x16x32_bf16 a[64:67], a[164:167], v[32:35], a[64:67]
  ds_read_b64_tr_b16 a[184:185], v223 offset:32768
  v_mfma_f32_16x16x32_bf16 a[68:71], a[164:167], v[40:43], a[68:71]
  v_exp_f32 v101, v101
  v_mfma_f32_16x16x32_bf16 a[68:71], a[160:163], v[8:11], a[68:71]
  ds_read_b64_tr_b16 a[186:187], v223 offset:36864
  v_cvt_pk_bf16_f32 v98, v100, v101
  v_mfma_f32_16x16x32_bf16 a[72:75], a[160:163], v[16:19], a[72:75]
  v_exp_f32 v102, v102
  v_mfma_f32_16x16x32_bf16 a[72:75], a[164:167], v[48:51], a[72:75]
  ds_read_b64_tr_b16 a[188:189], v223 offset:40960
  v_mfma_f32_16x16x32_bf16 a[76:79], a[164:167], v[56:59], a[76:79]
  s_waitcnt lgkmcnt(7)
  v_exp_f32 v103, v103
  v_mfma_f32_16x16x32_bf16 a[76:79], a[160:163], v[24:27], a[76:79]
  ds_read_b64_tr_b16 a[190:191], v223 offset:45056
  v_cvt_pk_bf16_f32 v99, v102, v103
  v_mfma_f32_16x16x32_bf16 a[80:83], a[168:171], v[0:3], a[80:83]
  s_waitcnt vmcnt(11)
  v_exp_f32 v108, v108
  v_mfma_f32_16x16x32_bf16 a[80:83], a[172:175], v[32:35], a[80:83]
  v_mfma_f32_16x16x32_bf16 a[84:87], a[172:175], v[40:43], a[84:87]
  s_barrier
  v_exp_f32 v109, v109
  v_mfma_f32_16x16x32_bf16 a[84:87], a[168:171], v[8:11], a[84:87]
  ds_read_b128 a[128:131], v212 offset:0
  v_cvt_pk_bf16_f32 v106, v108, v109
  v_mfma_f32_16x16x32_bf16 a[88:91], a[168:171], v[16:19], a[88:91]
  v_exp_f32 v110, v110
  v_mfma_f32_16x16x32_bf16 a[88:91], a[172:175], v[48:51], a[88:91]
  ds_read_b128 a[132:135], v213 offset:0
  v_mfma_f32_16x16x32_bf16 a[92:95], a[172:175], v[56:59], a[92:95]
  s_waitcnt lgkmcnt(6)
  v_exp_f32 v111, v111
  v_mfma_f32_16x16x32_bf16 a[92:95], a[168:171], v[24:27], a[92:95]
  ds_read_b128 a[136:139], v214 offset:0
  v_cvt_pk_bf16_f32 v107, v110, v111
  v_mfma_f32_16x16x32_bf16 a[96:99], a[176:179], v[0:3], a[96:99]
  v_exp_f32 v116, v116
  v_mfma_f32_16x16x32_bf16 a[96:99], a[180:183], v[32:35], a[96:99]
  ds_read_b128 a[140:143], v215 offset:0
  buffer_load_dwordx4 a[220:223], v243, s[24:27], s38 offen sc1
  s_add_u32 s38, s38, 4096
  v_mfma_f32_16x16x32_bf16 a[100:103], a[180:183], v[40:43], a[100:103]
  v_exp_f32 v117, v117
  v_mfma_f32_16x16x32_bf16 a[100:103], a[176:179], v[8:11], a[100:103]
  v_cvt_pk_bf16_f32 v114, v116, v117
  v_mfma_f32_16x16x32_bf16 a[104:107], a[176:179], v[16:19], a[104:107]
  v_exp_f32 v118, v118
  v_mfma_f32_16x16x32_bf16 a[104:107], a[180:183], v[48:51], a[104:107]
  v_mfma_f32_16x16x32_bf16 a[108:111], a[180:183], v[56:59], a[108:111]
  s_waitcnt lgkmcnt(4)
  v_exp_f32 v119, v119
  v_mfma_f32_16x16x32_bf16 a[108:111], a[176:179], v[24:27], a[108:111]
  v_cvt_pk_bf16_f32 v115, v118, v119
  v_mfma_f32_16x16x32_bf16 a[112:115], a[184:187], v[0:3], a[112:115]
  v_exp_f32 v124, v124
  v_mfma_f32_16x16x32_bf16 a[112:115], a[188:191], v[32:35], a[112:115]
  v_mfma_f32_16x16x32_bf16 a[116:119], a[188:191], v[40:43], a[116:119]
  v_exp_f32 v125, v125
  v_mfma_f32_16x16x32_bf16 a[116:119], a[184:187], v[8:11], a[116:119]
  v_cvt_pk_bf16_f32 v122, v124, v125
  v_mfma_f32_16x16x32_bf16 a[120:123], a[184:187], v[16:19], a[120:123]
  v_exp_f32 v126, v126
  v_mfma_f32_16x16x32_bf16 a[120:123], a[188:191], v[48:51], a[120:123]
  v_mfma_f32_16x16x32_bf16 a[124:127], a[188:191], v[56:59], a[124:127]
  s_waitcnt lgkmcnt(0)
  v_exp_f32 v127, v127
  v_mfma_f32_16x16x32_bf16 a[124:127], a[184:187], v[24:27], a[124:127]
  v_cvt_pk_bf16_f32 v123, v126, v127
  v_mfma_f32_16x16x32_bf16 v[0:3], a[128:131], v[128:131], v[192:195]
  s_add_u32 m0, s28, 81920
  v_mfma_f32_16x16x32_bf16 v[0:3], a[132:135], v[132:135], v[0:3]
  ds_read_b128 a[144:147], v212 offset:4096
  v_mfma_f32_16x16x32_bf16 v[0:3], a[136:139], v[136:139], v[0:3]
  buffer_load_dwordx4 v236, s[16:19], s29 offen offset:0 lds
  v_mfma_f32_16x16x32_bf16 v[0:3], a[140:143], v[140:143], v[0:3]
  ds_read_b128 a[148:151], v213 offset:4096
  v_mfma_f32_16x16x32_bf16 v[8:11], a[140:143], v[156:159], v[196:199]
  v_mfma_f32_16x16x32_bf16 v[8:11], a[136:139], v[152:155], v[8:11]
  ds_read_b128 a[152:155], v214 offset:4096
  v_mfma_f32_16x16x32_bf16 v[8:11], a[132:135], v[148:151], v[8:11]
  buffer_load_dwordx4 v237, s[16:19], s29 offen offset:1024 lds
  v_mfma_f32_16x16x32_bf16 v[8:11], a[128:131], v[144:147], v[8:11]
  ds_read_b128 a[156:159], v215 offset:4096
  v_mfma_f32_16x16x32_bf16 v[16:19], a[128:131], v[160:163], v[200:203]
  v_exp_f32 v0, v0
  v_mfma_f32_16x16x32_bf16 v[16:19], a[132:135], v[164:167], v[16:19]
  v_mfma_f32_16x16x32_bf16 v[16:19], a[136:139], v[168:171], v[16:19]
  v_exp_f32 v1, v1
  v_mfma_f32_16x16x32_bf16 v[16:19], a[140:143], v[172:175], v[16:19]
  v_cvt_pk_bf16_f32 v0, v0, v1
  v_mfma_f32_16x16x32_bf16 v[24:27], a[140:143], v[188:191], v[204:207]
  v_exp_f32 v2, v2
  v_mfma_f32_16x16x32_bf16 v[24:27], a[136:139], v[184:187], v[24:27]
  buffer_load_dwordx4 v236, s[16:19], s29 offen offset:2048 lds
  v_mfma_f32_16x16x32_bf16 v[24:27], a[132:135], v[180:183], v[24:27]
  s_waitcnt lgkmcnt(0)
  v_exp_f32 v3, v3
  v_mfma_f32_16x16x32_bf16 v[24:27], a[128:131], v[176:179], v[24:27]
  v_cvt_pk_bf16_f32 v1, v2, v3
  v_mfma_f32_16x16x32_bf16 v[4:7], a[144:147], v[128:131], v[192:195]
  v_exp_f32 v8, v8
  v_mfma_f32_16x16x32_bf16 v[4:7], a[148:151], v[132:135], v[4:7]
  ds_read_b128 a[128:131], v212 offset:8192
  v_mfma_f32_16x16x32_bf16 v[4:7], a[152:155], v[136:139], v[4:7]
  v_exp_f32 v9, v9
  v_mfma_f32_16x16x32_bf16 v[4:7], a[156:159], v[140:143], v[4:7]
  ds_read_b128 a[132:135], v213 offset:8192
  v_cvt_pk_bf16_f32 v8, v8, v9
  v_mfma_f32_16x16x32_bf16 v[12:15], a[156:159], v[156:159], v[196:199]
  v_exp_f32 v10, v10
  v_mfma_f32_16x16x32_bf16 v[12:15], a[152:155], v[152:155], v[12:15]
  ds_read_b128 a[136:139], v214 offset:8192
  v_mfma_f32_16x16x32_bf16 v[12:15], a[148:151], v[148:151], v[12:15]
  v_exp_f32 v11, v11
  v_mfma_f32_16x16x32_bf16 v[12:15], a[144:147], v[144:147], v[12:15]
  ds_read_b128 a[140:143], v215 offset:8192
  v_cvt_pk_bf16_f32 v9, v10, v11
  v_mfma_f32_16x16x32_bf16 v[20:23], a[144:147], v[160:163], v[200:203]
  v_exp_f32 v16, v16
  v_mfma_f32_16x16x32_bf16 v[20:23], a[148:151], v[164:167], v[20:23]
  buffer_load_dwordx4 v237, s[16:19], s29 offen offset:3072 lds
  v_mfma_f32_16x16x32_bf16 v[20:23], a[152:155], v[168:171], v[20:23]
  s_add_u32 s29, s29, 16384
  v_exp_f32 v17, v17
  v_mfma_f32_16x16x32_bf16 v[20:23], a[156:159], v[172:175], v[20:23]
  v_cvt_pk_bf16_f32 v16, v16, v17
  v_mfma_f32_16x16x32_bf16 v[28:31], a[156:159], v[188:191], v[204:207]
  s_add_u32 m0, s28, 32768
  v_exp_f32 v18, v18
  v_mfma_f32_16x16x32_bf16 v[28:31], a[152:155], v[184:187], v[28:31]
  buffer_load_dwordx4 v232, s[12:15], s29 offen offset:0 lds
  v_mfma_f32_16x16x32_bf16 v[28:31], a[148:151], v[180:183], v[28:31]
  s_waitcnt lgkmcnt(0)
  v_exp_f32 v19, v19
  v_mfma_f32_16x16x32_bf16 v[28:31], a[144:147], v[176:179], v[28:31]
  v_cvt_pk_bf16_f32 v17, v18, v19
  v_mfma_f32_16x16x32_bf16 v[32:35], a[128:131], v[128:131], v[192:195]
  v_exp_f32 v24, v24
  v_mfma_f32_16x16x32_bf16 v[32:35], a[132:135], v[132:135], v[32:35]
  ds_read_b128 a[144:147], v212 offset:12288
  v_mfma_f32_16x16x32_bf16 v[32:35], a[136:139], v[136:139], v[32:35]
  v_exp_f32 v25, v25
  v_mfma_f32_16x16x32_bf16 v[32:35], a[140:143], v[140:143], v[32:35]
  ds_read_b128 a[148:151], v213 offset:12288
  v_cvt_pk_bf16_f32 v24, v24, v25
  v_mfma_f32_16x16x32_bf16 v[40:43], a[140:143], v[156:159], v[196:199]
  v_exp_f32 v26, v26
  v_mfma_f32_16x16x32_bf16 v[40:43], a[136:139], v[152:155], v[40:43]
  ds_read_b128 a[152:155], v214 offset:12288
  v_mfma_f32_16x16x32_bf16 v[40:43], a[132:135], v[148:151], v[40:43]
  v_exp_f32 v27, v27
  v_mfma_f32_16x16x32_bf16 v[40:43], a[128:131], v[144:147], v[40:43]
  ds_read_b128 a[156:159], v215 offset:12288
  v_cvt_pk_bf16_f32 v25, v26, v27
  v_mfma_f32_16x16x32_bf16 v[48:51], a[128:131], v[160:163], v[200:203]
  v_exp_f32 v4, v4
  v_mfma_f32_16x16x32_bf16 v[48:51], a[132:135], v[164:167], v[48:51]
  buffer_load_dwordx4 v233, s[12:15], s29 offen offset:1024 lds
  v_mfma_f32_16x16x32_bf16 v[48:51], a[136:139], v[168:171], v[48:51]
  v_exp_f32 v5, v5
  v_mfma_f32_16x16x32_bf16 v[48:51], a[140:143], v[172:175], v[48:51]
  v_cvt_pk_bf16_f32 v2, v4, v5
  v_mfma_f32_16x16x32_bf16 v[56:59], a[140:143], v[188:191], v[204:207]
  v_exp_f32 v6, v6
  v_mfma_f32_16x16x32_bf16 v[56:59], a[136:139], v[184:187], v[56:59]
  buffer_load_dwordx4 v234, s[12:15], s29 offen offset:2048 lds
  v_mfma_f32_16x16x32_bf16 v[56:59], a[132:135], v[180:183], v[56:59]
  s_waitcnt lgkmcnt(0)
  v_exp_f32 v7, v7
  v_mfma_f32_16x16x32_bf16 v[56:59], a[128:131], v[176:179], v[56:59]
  v_cvt_pk_bf16_f32 v3, v6, v7
  v_mfma_f32_16x16x32_bf16 v[36:39], a[144:147], v[128:131], v[192:195]
  v_exp_f32 v12, v12
  v_mfma_f32_16x16x32_bf16 v[36:39], a[148:151], v[132:135], v[36:39]
  ds_read_b64_tr_b16 a[160:161], v216 offset:49152
  v_mfma_f32_16x16x32_bf16 v[36:39], a[152:155], v[136:139], v[36:39]
  v_exp_f32 v13, v13
  v_mfma_f32_16x16x32_bf16 v[36:39], a[156:159], v[140:143], v[36:39]
  ds_read_b64_tr_b16 a[162:163], v216 offset:53248
  v_cvt_pk_bf16_f32 v10, v12, v13
  v_mfma_f32_16x16x32_bf16 v[44:47], a[156:159], v[156:159], v[196:199]
  v_exp_f32 v14, v14
  v_mfma_f32_16x16x32_bf16 v[44:47], a[152:155], v[152:155], v[44:47]
  ds_read_b64_tr_b16 a[164:165], v216 offset:57344
  buffer_load_dwordx4 v235, s[12:15], s29 offen offset:3072 lds
  v_mfma_f32_16x16x32_bf16 v[44:47], a[148:151], v[148:151], v[44:47]
  v_exp_f32 v15, v15
  v_mfma_f32_16x16x32_bf16 v[44:47], a[144:147], v[144:147], v[44:47]
  ds_read_b64_tr_b16 a[166:167], v216 offset:61440
  v_cvt_pk_bf16_f32 v11, v14, v15
  v_mfma_f32_16x16x32_bf16 v[52:55], a[144:147], v[160:163], v[200:203]
  v_exp_f32 v20, v20
  v_mfma_f32_16x16x32_bf16 v[52:55], a[148:151], v[164:167], v[52:55]
  ds_read_b64_tr_b16 a[168:169], v217 offset:49152
  s_add_u32 m0, s50, 2048
  v_mfma_f32_16x16x32_bf16 v[52:55], a[152:155], v[168:171], v[52:55]
  v_exp_f32 v21, v21
  v_mfma_f32_16x16x32_bf16 v[52:55], a[156:159], v[172:175], v[52:55]
  ds_read_b64_tr_b16 a[170:171], v217 offset:53248
  v_cvt_pk_bf16_f32 v18, v20, v21
  v_mfma_f32_16x16x32_bf16 v[60:63], a[156:159], v[188:191], v[204:207]
  v_exp_f32 v22, v22
  v_mfma_f32_16x16x32_bf16 v[60:63], a[152:155], v[184:187], v[60:63]
  ds_read_b64_tr_b16 a[172:173], v217 offset:57344
  buffer_load_dwordx4 v253, s[20:23], s35 offen lds
  v_mfma_f32_16x16x32_bf16 v[60:63], a[148:151], v[180:183], v[60:63]
  v_exp_f32 v23, v23
  v_mfma_f32_16x16x32_bf16 v[60:63], a[144:147], v[176:179], v[60:63]
  ds_read_b64_tr_b16 a[174:175], v217 offset:61440
  v_cvt_pk_bf16_f32 v19, v22, v23
  v_mfma_f32_16x16x32_bf16 a[192:195], a[208:211], v[64:67], a[192:195]
  v_exp_f32 v28, v28
  v_mfma_f32_16x16x32_bf16 a[192:195], a[208:211], v[96:99], a[192:195]
  ds_read_b64_tr_b16 a[176:177], v218 offset:49152
  v_mfma_f32_16x16x32_bf16 a[196:199], a[208:211], v[72:75], a[196:199]
  v_exp_f32 v29, v29
  v_mfma_f32_16x16x32_bf16 a[196:199], a[208:211], v[104:107], a[196:199]
  ds_read_b64_tr_b16 a[178:179], v218 offset:53248
  v_cvt_pk_bf16_f32 v26, v28, v29
  v_mfma_f32_16x16x32_bf16 a[200:203], a[208:211], v[80:83], a[200:203]
  v_exp_f32 v30, v30
  v_mfma_f32_16x16x32_bf16 a[200:203], a[208:211], v[112:115], a[200:203]
  ds_read_b64_tr_b16 a[180:181], v218 offset:57344
  v_mfma_f32_16x16x32_bf16 a[204:207], a[208:211], v[88:91], a[204:207]
  s_waitcnt lgkmcnt(7)
  v_exp_f32 v31, v31
  v_mfma_f32_16x16x32_bf16 a[204:207], a[208:211], v[120:123], a[204:207]
  ds_read_b64_tr_b16 a[182:183], v218 offset:61440
  v_cvt_pk_bf16_f32 v27, v30, v31
  v_mfma_f32_16x16x32_bf16 a[0:3], a[160:163], v[64:67], a[0:3]
  v_exp_f32 v32, v32
  v_mfma_f32_16x16x32_bf16 a[0:3], a[164:167], v[96:99], a[0:3]
  ds_read_b64_tr_b16 a[184:185], v219 offset:49152
  v_mfma_f32_16x16x32_bf16 a[4:7], a[164:167], v[104:107], a[4:7]
  v_exp_f32 v33, v33
  v_mfma_f32_16x16x32_bf16 a[4:7], a[160:163], v[72:75], a[4:7]
  ds_read_b64_tr_b16 a[186:187], v219 offset:53248
  v_cvt_pk_bf16_f32 v32, v32, v33
  v_mfma_f32_16x16x32_bf16 a[8:11], a[160:163], v[80:83], a[8:11]
  v_exp_f32 v34, v34
  v_mfma_f32_16x16x32_bf16 a[8:11], a[164:167], v[112:115], a[8:11]
  ds_read_b64_tr_b16 a[188:189], v219 offset:57344
  v_mfma_f32_16x16x32_bf16 a[12:15], a[164:167], v[120:123], a[12:15]
  s_waitcnt lgkmcnt(7)
  v_exp_f32 v35, v35
  v_mfma_f32_16x16x32_bf16 a[12:15], a[160:163], v[88:91], a[12:15]
  ds_read_b64_tr_b16 a[190:191], v219 offset:61440
  v_cvt_pk_bf16_f32 v33, v34, v35
  v_mfma_f32_16x16x32_bf16 a[16:19], a[168:171], v[64:67], a[16:19]
  v_exp_f32 v40, v40
  v_mfma_f32_16x16x32_bf16 a[16:19], a[172:175], v[96:99], a[16:19]
  ds_read_b64_tr_b16 a[160:161], v220 offset:49152
  v_mfma_f32_16x16x32_bf16 a[20:23], a[172:175], v[104:107], a[20:23]
  v_exp_f32 v41, v41
  v_mfma_f32_16x16x32_bf16 a[20:23], a[168:171], v[72:75], a[20:23]
  ds_read_b64_tr_b16 a[162:163], v220 offset:53248
  v_cvt_pk_bf16_f32 v40, v40, v41
  v_mfma_f32_16x16x32_bf16 a[24:27], a[168:171], v[80:83], a[24:27]
  v_exp_f32 v42, v42
  v_mfma_f32_16x16x32_bf16 a[24:27], a[172:175], v[112:115], a[24:27]
  ds_read_b64_tr_b16 a[164:165], v220 offset:57344
  v_mfma_f32_16x16x32_bf16 a[28:31], a[172:175], v[120:123], a[28:31]
  s_waitcnt lgkmcnt(7)
  v_exp_f32 v43, v43
  v_mfma_f32_16x16x32_bf16 a[28:31], a[168:171], v[88:91], a[28:31]
  ds_read_b64_tr_b16 a[166:167], v220 offset:61440
  v_cvt_pk_bf16_f32 v41, v42, v43
  v_mfma_f32_16x16x32_bf16 a[32:35], a[176:179], v[64:67], a[32:35]
  v_exp_f32 v48, v48
  v_mfma_f32_16x16x32_bf16 a[32:35], a[180:183], v[96:99], a[32:35]
  ds_read_b64_tr_b16 a[168:169], v221 offset:49152
  v_mfma_f32_16x16x32_bf16 a[36:39], a[180:183], v[104:107], a[36:39]
  v_exp_f32 v49, v49
  v_mfma_f32_16x16x32_bf16 a[36:39], a[176:179], v[72:75], a[36:39]
  ds_read_b64_tr_b16 a[170:171], v221 offset:53248
  v_cvt_pk_bf16_f32 v48, v48, v49
  v_mfma_f32_16x16x32_bf16 a[40:43], a[176:179], v[80:83], a[40:43]
  v_exp_f32 v50, v50
  v_mfma_f32_16x16x32_bf16 a[40:43], a[180:183], v[112:115], a[40:43]
  ds_read_b64_tr_b16 a[172:173], v221 offset:57344
  v_mfma_f32_16x16x32_bf16 a[44:47], a[180:183], v[120:123], a[44:47]
  s_waitcnt lgkmcnt(7)
  v_exp_f32 v51, v51
  v_mfma_f32_16x16x32_bf16 a[44:47], a[176:179], v[88:91], a[44:47]
  ds_read_b64_tr_b16 a[174:175], v221 offset:61440
  v_cvt_pk_bf16_f32 v49, v50, v51
  v_mfma_f32_16x16x32_bf16 a[48:51], a[184:187], v[64:67], a[48:51]
  v_exp_f32 v56, v56
  v_mfma_f32_16x16x32_bf16 a[48:51], a[188:191], v[96:99], a[48:51]
  ds_read_b64_tr_b16 a[176:177], v222 offset:49152
  v_mfma_f32_16x16x32_bf16 a[52:55], a[188:191], v[104:107], a[52:55]
  v_exp_f32 v57, v57
  v_mfma_f32_16x16x32_bf16 a[52:55], a[184:187], v[72:75], a[52:55]
  ds_read_b64_tr_b16 a[178:179], v222 offset:53248
  v_cvt_pk_bf16_f32 v56, v56, v57
  v_mfma_f32_16x16x32_bf16 a[56:59], a[184:187], v[80:83], a[56:59]
  v_exp_f32 v58, v58
  v_mfma_f32_16x16x32_bf16 a[56:59], a[188:191], v[112:115], a[56:59]
  ds_read_b64_tr_b16 a[180:181], v222 offset:57344
  v_mfma_f32_16x16x32_bf16 a[60:63], a[188:191], v[120:123], a[60:63]
  s_waitcnt lgkmcnt(7)
  v_exp_f32 v59, v59
  v_mfma_f32_16x16x32_bf16 a[60:63], a[184:187], v[88:91], a[60:63]
  ds_read_b64_tr_b16 a[182:183], v222 offset:61440
  v_cvt_pk_bf16_f32 v57, v58, v59
  v_mfma_f32_16x16x32_bf16 a[64:67], a[160:163], v[64:67], a[64:67]
  v_exp_f32 v36, v36
  v_mfma_f32_16x16x32_bf16 a[64:67], a[164:167], v[96:99], a[64:67]
  ds_read_b64_tr_b16 a[184:185], v223 offset:49152
  v_mfma_f32_16x16x32_bf16 a[68:71], a[164:167], v[104:107], a[68:71]
  v_exp_f32 v37, v37
  v_mfma_f32_16x16x32_bf16 a[68:71], a[160:163], v[72:75], a[68:71]
  ds_read_b64_tr_b16 a[186:187], v223 offset:53248
  v_cvt_pk_bf16_f32 v34, v36, v37
  v_mfma_f32_16x16x32_bf16 a[72:75], a[160:163], v[80:83], a[72:75]
  v_exp_f32 v38, v38
  v_mfma_f32_16x16x32_bf16 a[72:75], a[164:167], v[112:115], a[72:75]
  ds_read_b64_tr_b16 a[188:189], v223 offset:57344
  v_mfma_f32_16x16x32_bf16 a[76:79], a[164:167], v[120:123], a[76:79]
  s_waitcnt lgkmcnt(7)
  v_exp_f32 v39, v39
  v_mfma_f32_16x16x32_bf16 a[76:79], a[160:163], v[88:91], a[76:79]
  ds_read_b64_tr_b16 a[190:191], v223 offset:61440
  v_cvt_pk_bf16_f32 v35, v38, v39
  v_mfma_f32_16x16x32_bf16 a[80:83], a[168:171], v[64:67], a[80:83]
  s_waitcnt vmcnt(11)
  v_exp_f32 v44, v44
  v_mfma_f32_16x16x32_bf16 a[80:83], a[172:175], v[96:99], a[80:83]
  v_mfma_f32_16x16x32_bf16 a[84:87], a[172:175], v[104:107], a[84:87]
  s_barrier
  v_exp_f32 v45, v45
  v_mfma_f32_16x16x32_bf16 a[84:87], a[168:171], v[72:75], a[84:87]
  ds_read_b128 a[128:131], v212 offset:16384
  v_cvt_pk_bf16_f32 v42, v44, v45
  v_mfma_f32_16x16x32_bf16 a[88:91], a[168:171], v[80:83], a[88:91]
  v_exp_f32 v46, v46
  v_mfma_f32_16x16x32_bf16 a[88:91], a[172:175], v[112:115], a[88:91]
  ds_read_b128 a[132:135], v213 offset:16384
  v_mfma_f32_16x16x32_bf16 a[92:95], a[172:175], v[120:123], a[92:95]
  s_waitcnt lgkmcnt(6)
  v_exp_f32 v47, v47
  v_mfma_f32_16x16x32_bf16 a[92:95], a[168:171], v[88:91], a[92:95]
  ds_read_b128 a[136:139], v214 offset:16384
  v_cvt_pk_bf16_f32 v43, v46, v47
  v_mfma_f32_16x16x32_bf16 a[96:99], a[176:179], v[64:67], a[96:99]
  v_exp_f32 v52, v52
  v_mfma_f32_16x16x32_bf16 a[96:99], a[180:183], v[96:99], a[96:99]
  ds_read_b128 a[140:143], v215 offset:16384
  buffer_load_dwordx4 a[224:227], v243, s[24:27], s38 offen sc1
  s_add_u32 s38, s38, 4096
  v_mfma_f32_16x16x32_bf16 a[100:103], a[180:183], v[104:107], a[100:103]
  v_exp_f32 v53, v53
  v_mfma_f32_16x16x32_bf16 a[100:103], a[176:179], v[72:75], a[100:103]
  v_cvt_pk_bf16_f32 v50, v52, v53
  v_mfma_f32_16x16x32_bf16 a[104:107], a[176:179], v[80:83], a[104:107]
  v_exp_f32 v54, v54
  v_mfma_f32_16x16x32_bf16 a[104:107], a[180:183], v[112:115], a[104:107]
  v_mfma_f32_16x16x32_bf16 a[108:111], a[180:183], v[120:123], a[108:111]
  s_waitcnt lgkmcnt(4)
  v_exp_f32 v55, v55
  v_mfma_f32_16x16x32_bf16 a[108:111], a[176:179], v[88:91], a[108:111]
  v_cvt_pk_bf16_f32 v51, v54, v55
  v_mfma_f32_16x16x32_bf16 a[112:115], a[184:187], v[64:67], a[112:115]
  v_exp_f32 v60, v60
  v_mfma_f32_16x16x32_bf16 a[112:115], a[188:191], v[96:99], a[112:115]
  v_mfma_f32_16x16x32_bf16 a[116:119], a[188:191], v[104:107], a[116:119]
  v_exp_f32 v61, v61
  v_mfma_f32_16x16x32_bf16 a[116:119], a[184:187], v[72:75], a[116:119]
  v_cvt_pk_bf16_f32 v58, v60, v61
  v_mfma_f32_16x16x32_bf16 a[120:123], a[184:187], v[80:83], a[120:123]
  v_exp_f32 v62, v62
  v_mfma_f32_16x16x32_bf16 a[120:123], a[188:191], v[112:115], a[120:123]
  v_mfma_f32_16x16x32_bf16 a[124:127], a[188:191], v[120:123], a[124:127]
  s_waitcnt lgkmcnt(0)
  v_exp_f32 v63, v63
  v_mfma_f32_16x16x32_bf16 a[124:127], a[184:187], v[88:91], a[124:127]
  v_cvt_pk_bf16_f32 v59, v62, v63
  v_mfma_f32_16x16x32_bf16 v[64:67], a[128:131], v[128:131], v[192:195]
  s_add_u32 m0, s28, 98304
  v_mfma_f32_16x16x32_bf16 v[64:67], a[132:135], v[132:135], v[64:67]
  ds_read_b128 a[144:147], v212 offset:20480
  v_mfma_f32_16x16x32_bf16 v[64:67], a[136:139], v[136:139], v[64:67]
  buffer_load_dwordx4 v236, s[16:19], s29 offen offset:0 lds
  v_mfma_f32_16x16x32_bf16 v[64:67], a[140:143], v[140:143], v[64:67]
  ds_read_b128 a[148:151], v213 offset:20480
  v_mfma_f32_16x16x32_bf16 v[72:75], a[140:143], v[156:159], v[196:199]
  v_mfma_f32_16x16x32_bf16 v[72:75], a[136:139], v[152:155], v[72:75]
  ds_read_b128 a[152:155], v214 offset:20480
  v_mfma_f32_16x16x32_bf16 v[72:75], a[132:135], v[148:151], v[72:75]
  buffer_load_dwordx4 v237, s[16:19], s29 offen offset:1024 lds
  v_mfma_f32_16x16x32_bf16 v[72:75], a[128:131], v[144:147], v[72:75]
  ds_read_b128 a[156:159], v215 offset:20480
  v_mfma_f32_16x16x32_bf16 v[80:83], a[128:131], v[160:163], v[200:203]
  v_exp_f32 v64, v64
  v_mfma_f32_16x16x32_bf16 v[80:83], a[132:135], v[164:167], v[80:83]
  v_mfma_f32_16x16x32_bf16 v[80:83], a[136:139], v[168:171], v[80:83]
  v_exp_f32 v65, v65
  v_mfma_f32_16x16x32_bf16 v[80:83], a[140:143], v[172:175], v[80:83]
  v_cvt_pk_bf16_f32 v64, v64, v65
  v_mfma_f32_16x16x32_bf16 v[88:91], a[140:143], v[188:191], v[204:207]
  v_exp_f32 v66, v66
  v_mfma_f32_16x16x32_bf16 v[88:91], a[136:139], v[184:187], v[88:91]
  buffer_load_dwordx4 v236, s[16:19], s29 offen offset:2048 lds
  v_mfma_f32_16x16x32_bf16 v[88:91], a[132:135], v[180:183], v[88:91]
  s_waitcnt lgkmcnt(0)
  v_exp_f32 v67, v67
  v_mfma_f32_16x16x32_bf16 v[88:91], a[128:131], v[176:179], v[88:91]
  v_cvt_pk_bf16_f32 v65, v66, v67
  v_mfma_f32_16x16x32_bf16 v[68:71], a[144:147], v[128:131], v[192:195]
  v_exp_f32 v72, v72
  v_mfma_f32_16x16x32_bf16 v[68:71], a[148:151], v[132:135], v[68:71]
  ds_read_b128 a[128:131], v212 offset:24576
  v_mfma_f32_16x16x32_bf16 v[68:71], a[152:155], v[136:139], v[68:71]
  v_exp_f32 v73, v73
  v_mfma_f32_16x16x32_bf16 v[68:71], a[156:159], v[140:143], v[68:71]
  ds_read_b128 a[132:135], v213 offset:24576
  v_cvt_pk_bf16_f32 v72, v72, v73
  v_mfma_f32_16x16x32_bf16 v[76:79], a[156:159], v[156:159], v[196:199]
  v_exp_f32 v74, v74
  v_mfma_f32_16x16x32_bf16 v[76:79], a[152:155], v[152:155], v[76:79]
  ds_read_b128 a[136:139], v214 offset:24576
  v_mfma_f32_16x16x32_bf16 v[76:79], a[148:151], v[148:151], v[76:79]
  v_exp_f32 v75, v75
  v_mfma_f32_16x16x32_bf16 v[76:79], a[144:147], v[144:147], v[76:79]
  ds_read_b128 a[140:143], v215 offset:24576
  v_cvt_pk_bf16_f32 v73, v74, v75
  v_mfma_f32_16x16x32_bf16 v[84:87], a[144:147], v[160:163], v[200:203]
  v_exp_f32 v80, v80
  v_mfma_f32_16x16x32_bf16 v[84:87], a[148:151], v[164:167], v[84:87]
  buffer_load_dwordx4 v237, s[16:19], s29 offen offset:3072 lds
  v_mfma_f32_16x16x32_bf16 v[84:87], a[152:155], v[168:171], v[84:87]
  s_add_u32 s29, s29, 16384
  v_exp_f32 v81, v81
  v_mfma_f32_16x16x32_bf16 v[84:87], a[156:159], v[172:175], v[84:87]
  v_cvt_pk_bf16_f32 v80, v80, v81
  v_mfma_f32_16x16x32_bf16 v[92:95], a[156:159], v[188:191], v[204:207]
  s_add_u32 m0, s28, 49152
  v_exp_f32 v82, v82
  v_mfma_f32_16x16x32_bf16 v[92:95], a[152:155], v[184:187], v[92:95]
  buffer_load_dwordx4 v232, s[12:15], s29 offen offset:0 lds
  v_mfma_f32_16x16x32_bf16 v[92:95], a[148:151], v[180:183], v[92:95]
  s_waitcnt lgkmcnt(0)
  v_exp_f32 v83, v83
  v_mfma_f32_16x16x32_bf16 v[92:95], a[144:147], v[176:179], v[92:95]
  v_cvt_pk_bf16_f32 v81, v82, v83
  v_mfma_f32_16x16x32_bf16 v[96:99], a[128:131], v[128:131], v[192:195]
  v_exp_f32 v88, v88
  v_mfma_f32_16x16x32_bf16 v[96:99], a[132:135], v[132:135], v[96:99]
  ds_read_b128 a[144:147], v212 offset:28672
  v_mfma_f32_16x16x32_bf16 v[96:99], a[136:139], v[136:139], v[96:99]
  v_exp_f32 v89, v89
  v_mfma_f32_16x16x32_bf16 v[96:99], a[140:143], v[140:143], v[96:99]
  ds_read_b128 a[148:151], v213 offset:28672
  v_cvt_pk_bf16_f32 v88, v88, v89
  v_mfma_f32_16x16x32_bf16 v[104:107], a[140:143], v[156:159], v[196:199]
  v_exp_f32 v90, v90
  v_mfma_f32_16x16x32_bf16 v[104:107], a[136:139], v[152:155], v[104:107]
  ds_read_b128 a[152:155], v214 offset:28672
  v_mfma_f32_16x16x32_bf16 v[104:107], a[132:135], v[148:151], v[104:107]
  v_exp_f32 v91, v91
  v_mfma_f32_16x16x32_bf16 v[104:107], a[128:131], v[144:147], v[104:107]
  ds_read_b128 a[156:159], v215 offset:28672
  v_cvt_pk_bf16_f32 v89, v90, v91
  v_mfma_f32_16x16x32_bf16 v[112:115], a[128:131], v[160:163], v[200:203]
  v_exp_f32 v68, v68
  v_mfma_f32_16x16x32_bf16 v[112:115], a[132:135], v[164:167], v[112:115]
  buffer_load_dwordx4 v233, s[12:15], s29 offen offset:1024 lds
  v_mfma_f32_16x16x32_bf16 v[112:115], a[136:139], v[168:171], v[112:115]
  v_exp_f32 v69, v69
  v_mfma_f32_16x16x32_bf16 v[112:115], a[140:143], v[172:175], v[112:115]
  v_cvt_pk_bf16_f32 v66, v68, v69
  v_mfma_f32_16x16x32_bf16 v[120:123], a[140:143], v[188:191], v[204:207]
  v_exp_f32 v70, v70
  v_mfma_f32_16x16x32_bf16 v[120:123], a[136:139], v[184:187], v[120:123]
  buffer_load_dwordx4 v234, s[12:15], s29 offen offset:2048 lds
  v_mfma_f32_16x16x32_bf16 v[120:123], a[132:135], v[180:183], v[120:123]
  s_waitcnt lgkmcnt(0)
  v_exp_f32 v71, v71
  v_mfma_f32_16x16x32_bf16 v[120:123], a[128:131], v[176:179], v[120:123]
  v_cvt_pk_bf16_f32 v67, v70, v71
  v_mfma_f32_16x16x32_bf16 v[100:103], a[144:147], v[128:131], v[192:195]
  v_exp_f32 v76, v76
  v_mfma_f32_16x16x32_bf16 v[100:103], a[148:151], v[132:135], v[100:103]
  ds_read_b64_tr_b16 a[160:161], v216 offset:0
  v_mfma_f32_16x16x32_bf16 v[100:103], a[152:155], v[136:139], v[100:103]
  v_exp_f32 v77, v77
  v_mfma_f32_16x16x32_bf16 v[100:103], a[156:159], v[140:143], v[100:103]
  ds_read_b64_tr_b16 a[162:163], v216 offset:4096
  v_cvt_pk_bf16_f32 v74, v76, v77
  v_mfma_f32_16x16x32_bf16 v[108:111], a[156:159], v[156:159], v[196:199]
  v_exp_f32 v78, v78
  v_mfma_f32_16x16x32_bf16 v[108:111], a[152:155], v[152:155], v[108:111]
  ds_read_b64_tr_b16 a[164:165], v216 offset:8192
  buffer_load_dwordx4 v235, s[12:15], s29 offen offset:3072 lds
  v_mfma_f32_16x16x32_bf16 v[108:111], a[148:151], v[148:151], v[108:111]
  v_exp_f32 v79, v79
  v_mfma_f32_16x16x32_bf16 v[108:111], a[144:147], v[144:147], v[108:111]
  ds_read_b64_tr_b16 a[166:167], v216 offset:12288
  v_cvt_pk_bf16_f32 v75, v78, v79
  v_mfma_f32_16x16x32_bf16 v[116:119], a[144:147], v[160:163], v[200:203]
  v_exp_f32 v84, v84
  v_mfma_f32_16x16x32_bf16 v[116:119], a[148:151], v[164:167], v[116:119]
  ds_read_b64_tr_b16 a[168:169], v217 offset:0
  s_add_u32 m0, s50, 5120
  v_mfma_f32_16x16x32_bf16 v[116:119], a[152:155], v[168:171], v[116:119]
  v_exp_f32 v85, v85
  v_mfma_f32_16x16x32_bf16 v[116:119], a[156:159], v[172:175], v[116:119]
  ds_read_b64_tr_b16 a[170:171], v217 offset:4096
  v_cvt_pk_bf16_f32 v82, v84, v85
  v_mfma_f32_16x16x32_bf16 v[124:127], a[156:159], v[188:191], v[204:207]
  v_exp_f32 v86, v86
  v_mfma_f32_16x16x32_bf16 v[124:127], a[152:155], v[184:187], v[124:127]
  ds_read_b64_tr_b16 a[172:173], v217 offset:8192
  buffer_load_dwordx4 v253, s[44:47], s35 offen lds
  s_add_u32 s35, s35, 221184
  v_mfma_f32_16x16x32_bf16 v[124:127], a[148:151], v[180:183], v[124:127]
  v_exp_f32 v87, v87
  v_mfma_f32_16x16x32_bf16 v[124:127], a[144:147], v[176:179], v[124:127]
  ds_read_b64_tr_b16 a[174:175], v217 offset:12288
  v_cvt_pk_bf16_f32 v83, v86, v87
  v_mfma_f32_16x16x32_bf16 a[192:195], a[208:211], v[0:3], a[192:195]
  v_exp_f32 v92, v92
  v_mfma_f32_16x16x32_bf16 a[192:195], a[208:211], v[32:35], a[192:195]
  ds_read_b64_tr_b16 a[176:177], v218 offset:0
  v_mfma_f32_16x16x32_bf16 a[196:199], a[208:211], v[8:11], a[196:199]
  v_exp_f32 v93, v93
  v_mfma_f32_16x16x32_bf16 a[196:199], a[208:211], v[40:43], a[196:199]
  ds_read_b64_tr_b16 a[178:179], v218 offset:4096
  v_cvt_pk_bf16_f32 v90, v92, v93
  v_mfma_f32_16x16x32_bf16 a[200:203], a[208:211], v[16:19], a[200:203]
  v_exp_f32 v94, v94
  v_mfma_f32_16x16x32_bf16 a[200:203], a[208:211], v[48:51], a[200:203]
  ds_read_b64_tr_b16 a[180:181], v218 offset:8192
  v_mfma_f32_16x16x32_bf16 a[204:207], a[208:211], v[24:27], a[204:207]
  s_waitcnt lgkmcnt(7)
  v_exp_f32 v95, v95
  v_mfma_f32_16x16x32_bf16 a[204:207], a[208:211], v[56:59], a[204:207]
  ds_read_b64_tr_b16 a[182:183], v218 offset:12288
  v_cvt_pk_bf16_f32 v91, v94, v95
  v_mfma_f32_16x16x32_bf16 a[0:3], a[160:163], v[0:3], a[0:3]
  v_exp_f32 v96, v96
  v_mfma_f32_16x16x32_bf16 a[0:3], a[164:167], v[32:35], a[0:3]
  ds_read_b64_tr_b16 a[184:185], v219 offset:0
  v_mfma_f32_16x16x32_bf16 a[4:7], a[164:167], v[40:43], a[4:7]
  v_exp_f32 v97, v97
  v_mfma_f32_16x16x32_bf16 a[4:7], a[160:163], v[8:11], a[4:7]
  ds_read_b64_tr_b16 a[186:187], v219 offset:4096
  v_cvt_pk_bf16_f32 v96, v96, v97
  v_mfma_f32_16x16x32_bf16 a[8:11], a[160:163], v[16:19], a[8:11]
  v_exp_f32 v98, v98
  v_mfma_f32_16x16x32_bf16 a[8:11], a[164:167], v[48:51], a[8:11]
  ds_read_b64_tr_b16 a[188:189], v219 offset:8192
  v_mfma_f32_16x16x32_bf16 a[12:15], a[164:167], v[56:59], a[12:15]
  s_waitcnt lgkmcnt(7)
  v_exp_f32 v99, v99
  v_mfma_f32_16x16x32_bf16 a[12:15], a[160:163], v[24:27], a[12:15]
  ds_read_b64_tr_b16 a[190:191], v219 offset:12288
  v_cvt_pk_bf16_f32 v97, v98, v99
  v_mfma_f32_16x16x32_bf16 a[16:19], a[168:171], v[0:3], a[16:19]
  v_exp_f32 v104, v104
  v_mfma_f32_16x16x32_bf16 a[16:19], a[172:175], v[32:35], a[16:19]
  ds_read_b64_tr_b16 a[160:161], v220 offset:0
  v_mfma_f32_16x16x32_bf16 a[20:23], a[172:175], v[40:43], a[20:23]
  v_exp_f32 v105, v105
  v_mfma_f32_16x16x32_bf16 a[20:23], a[168:171], v[8:11], a[20:23]
  ds_read_b64_tr_b16 a[162:163], v220 offset:4096
  v_cvt_pk_bf16_f32 v104, v104, v105
  v_mfma_f32_16x16x32_bf16 a[24:27], a[168:171], v[16:19], a[24:27]
  v_exp_f32 v106, v106
  v_mfma_f32_16x16x32_bf16 a[24:27], a[172:175], v[48:51], a[24:27]
  ds_read_b64_tr_b16 a[164:165], v220 offset:8192
  v_mfma_f32_16x16x32_bf16 a[28:31], a[172:175], v[56:59], a[28:31]
  s_waitcnt lgkmcnt(7)
  v_exp_f32 v107, v107
  v_mfma_f32_16x16x32_bf16 a[28:31], a[168:171], v[24:27], a[28:31]
  ds_read_b64_tr_b16 a[166:167], v220 offset:12288
  v_cvt_pk_bf16_f32 v105, v106, v107
  v_mfma_f32_16x16x32_bf16 a[32:35], a[176:179], v[0:3], a[32:35]
  v_exp_f32 v112, v112
  v_mfma_f32_16x16x32_bf16 a[32:35], a[180:183], v[32:35], a[32:35]
  ds_read_b64_tr_b16 a[168:169], v221 offset:0
  v_mfma_f32_16x16x32_bf16 a[36:39], a[180:183], v[40:43], a[36:39]
  v_exp_f32 v113, v113
  v_mfma_f32_16x16x32_bf16 a[36:39], a[176:179], v[8:11], a[36:39]
  ds_read_b64_tr_b16 a[170:171], v221 offset:4096
  v_cvt_pk_bf16_f32 v112, v112, v113
  v_mfma_f32_16x16x32_bf16 a[40:43], a[176:179], v[16:19], a[40:43]
  v_exp_f32 v114, v114
  v_mfma_f32_16x16x32_bf16 a[40:43], a[180:183], v[48:51], a[40:43]
  ds_read_b64_tr_b16 a[172:173], v221 offset:8192
  v_mfma_f32_16x16x32_bf16 a[44:47], a[180:183], v[56:59], a[44:47]
  s_waitcnt lgkmcnt(7)
  v_exp_f32 v115, v115
  v_mfma_f32_16x16x32_bf16 a[44:47], a[176:179], v[24:27], a[44:47]
  ds_read_b64_tr_b16 a[174:175], v221 offset:12288
  v_cvt_pk_bf16_f32 v113, v114, v115
  v_mfma_f32_16x16x32_bf16 a[48:51], a[184:187], v[0:3], a[48:51]
  v_exp_f32 v120, v120
  v_mfma_f32_16x16x32_bf16 a[48:51], a[188:191], v[32:35], a[48:51]
  ds_read_b64_tr_b16 a[176:177], v222 offset:0
  v_mfma_f32_16x16x32_bf16 a[52:55], a[188:191], v[40:43], a[52:55]
  v_exp_f32 v121, v121
  v_mfma_f32_16x16x32_bf16 a[52:55], a[184:187], v[8:11], a[52:55]
  ds_read_b64_tr_b16 a[178:179], v222 offset:4096
  v_cvt_pk_bf16_f32 v120, v120, v121
  v_mfma_f32_16x16x32_bf16 a[56:59], a[184:187], v[16:19], a[56:59]
  v_exp_f32 v122, v122
  v_mfma_f32_16x16x32_bf16 a[56:59], a[188:191], v[48:51], a[56:59]
  ds_read_b64_tr_b16 a[180:181], v222 offset:8192
  v_mfma_f32_16x16x32_bf16 a[60:63], a[188:191], v[56:59], a[60:63]
  s_waitcnt lgkmcnt(7)
  v_exp_f32 v123, v123
  v_mfma_f32_16x16x32_bf16 a[60:63], a[184:187], v[24:27], a[60:63]
  ds_read_b64_tr_b16 a[182:183], v222 offset:12288
  v_cvt_pk_bf16_f32 v121, v122, v123
  v_mfma_f32_16x16x32_bf16 a[64:67], a[160:163], v[0:3], a[64:67]
  v_exp_f32 v100, v100
  v_mfma_f32_16x16x32_bf16 a[64:67], a[164:167], v[32:35], a[64:67]
  ds_read_b64_tr_b16 a[184:185], v223 offset:0
  v_mfma_f32_16x16x32_bf16 a[68:71], a[164:167], v[40:43], a[68:71]
  v_exp_f32 v101, v101
  v_mfma_f32_16x16x32_bf16 a[68:71], a[160:163], v[8:11], a[68:71]
  ds_read_b64_tr_b16 a[186:187], v223 offset:4096
  v_cvt_pk_bf16_f32 v98, v100, v101
  v_mfma_f32_16x16x32_bf16 a[72:75], a[160:163], v[16:19], a[72:75]
  v_exp_f32 v102, v102
  v_mfma_f32_16x16x32_bf16 a[72:75], a[164:167], v[48:51], a[72:75]
  ds_read_b64_tr_b16 a[188:189], v223 offset:8192
  v_mfma_f32_16x16x32_bf16 a[76:79], a[164:167], v[56:59], a[76:79]
  s_waitcnt lgkmcnt(7)
  v_exp_f32 v103, v103
  v_mfma_f32_16x16x32_bf16 a[76:79], a[160:163], v[24:27], a[76:79]
  ds_read_b64_tr_b16 a[190:191], v223 offset:12288
  v_cvt_pk_bf16_f32 v99, v102, v103
  v_mfma_f32_16x16x32_bf16 a[80:83], a[168:171], v[0:3], a[80:83]
  s_waitcnt vmcnt(11)
  v_exp_f32 v108, v108
  v_mfma_f32_16x16x32_bf16 a[80:83], a[172:175], v[32:35], a[80:83]
  v_mfma_f32_16x16x32_bf16 a[84:87], a[172:175], v[40:43], a[84:87]
  s_barrier
  v_exp_f32 v109, v109
  v_mfma_f32_16x16x32_bf16 a[84:87], a[168:171], v[8:11], a[84:87]
  ds_read_b128 a[128:131], v212 offset:32768
  v_cvt_pk_bf16_f32 v106, v108, v109
  v_mfma_f32_16x16x32_bf16 a[88:91], a[168:171], v[16:19], a[88:91]
  v_exp_f32 v110, v110
  v_mfma_f32_16x16x32_bf16 a[88:91], a[172:175], v[48:51], a[88:91]
  ds_read_b128 a[132:135], v213 offset:32768
  v_mfma_f32_16x16x32_bf16 a[92:95], a[172:175], v[56:59], a[92:95]
  s_waitcnt lgkmcnt(6)
  v_exp_f32 v111, v111
  v_mfma_f32_16x16x32_bf16 a[92:95], a[168:171], v[24:27], a[92:95]
  ds_read_b128 a[136:139], v214 offset:32768
  v_cvt_pk_bf16_f32 v107, v110, v111
  v_mfma_f32_16x16x32_bf16 a[96:99], a[176:179], v[0:3], a[96:99]
  v_exp_f32 v116, v116
  v_mfma_f32_16x16x32_bf16 a[96:99], a[180:183], v[32:35], a[96:99]
  ds_read_b128 a[140:143], v215 offset:32768
  buffer_load_dwordx4 a[228:231], v243, s[24:27], s38 offen sc1
  s_add_u32 s38, s38, 4096
  v_mfma_f32_16x16x32_bf16 a[100:103], a[180:183], v[40:43], a[100:103]
  v_exp_f32 v117, v117
  v_mfma_f32_16x16x32_bf16 a[100:103], a[176:179], v[8:11], a[100:103]
  v_cvt_pk_bf16_f32 v114, v116, v117
  v_mfma_f32_16x16x32_bf16 a[104:107], a[176:179], v[16:19], a[104:107]
  v_exp_f32 v118, v118
  v_mfma_f32_16x16x32_bf16 a[104:107], a[180:183], v[48:51], a[104:107]
  v_mfma_f32_16x16x32_bf16 a[108:111], a[180:183], v[56:59], a[108:111]
  s_waitcnt lgkmcnt(4)
  v_exp_f32 v119, v119
  v_mfma_f32_16x16x32_bf16 a[108:111], a[176:179], v[24:27], a[108:111]
  v_cvt_pk_bf16_f32 v115, v118, v119
  v_mfma_f32_16x16x32_bf16 a[112:115], a[184:187], v[0:3], a[112:115]
  v_exp_f32 v124, v124
  v_mfma_f32_16x16x32_bf16 a[112:115], a[188:191], v[32:35], a[112:115]
  v_mfma_f32_16x16x32_bf16 a[116:119], a[188:191], v[40:43], a[116:119]
  v_exp_f32 v125, v125
  v_mfma_f32_16x16x32_bf16 a[116:119], a[184:187], v[8:11], a[116:119]
  v_cvt_pk_bf16_f32 v122, v124, v125
  v_mfma_f32_16x16x32_bf16 a[120:123], a[184:187], v[16:19], a[120:123]
  v_exp_f32 v126, v126
  v_mfma_f32_16x16x32_bf16 a[120:123], a[188:191], v[48:51], a[120:123]
  v_mfma_f32_16x16x32_bf16 a[124:127], a[188:191], v[56:59], a[124:127]
  s_waitcnt lgkmcnt(0)
  v_exp_f32 v127, v127
  v_mfma_f32_16x16x32_bf16 a[124:127], a[184:187], v[24:27], a[124:127]
  v_cvt_pk_bf16_f32 v123, v126, v127
  v_mfma_f32_16x16x32_bf16 v[0:3], a[128:131], v[128:131], v[192:195]
  s_add_u32 m0, s28, 114688
  s_mov_b32 s20, s88
  s_mov_b32 s21, s89
  v_mfma_f32_16x16x32_bf16 v[0:3], a[132:135], v[132:135], v[0:3]
  ds_read_b128 a[144:147], v212 offset:36864
  s_mov_b32 s22, 5242880
  s_mov_b32 s23, 0x20000
  v_lshrrev_b32 v208, 4, v242
  v_mfma_f32_16x16x32_bf16 v[0:3], a[136:139], v[136:139], v[0:3]
  buffer_load_dwordx4 v236, s[16:19], s29 offen offset:0 lds
  v_mfma_f32_16x16x32_bf16 v[0:3], a[140:143], v[140:143], v[0:3]
  ds_read_b128 a[148:151], v213 offset:36864
  v_and_b32 v209, 1, v208
  v_mfma_f32_16x16x32_bf16 v[8:11], a[140:143], v[156:159], v[196:199]
  v_lshrrev_b32 v208, 1, v208
  v_mul_u32_u24 v208, 0x500, v208
  v_mfma_f32_16x16x32_bf16 v[8:11], a[136:139], v[152:155], v[8:11]
  ds_read_b128 a[152:155], v214 offset:36864
  v_lshl_add_u32 v208, v209, 4, v208
  v_mfma_f32_16x16x32_bf16 v[8:11], a[132:135], v[148:151], v[8:11]
  buffer_load_dwordx4 v237, s[16:19], s29 offen offset:1024 lds
  v_mfma_f32_16x16x32_bf16 v[8:11], a[128:131], v[144:147], v[8:11]
  ds_read_b128 a[156:159], v215 offset:36864
  v_lshrrev_b32 v209, 4, v242
  v_mfma_f32_16x16x32_bf16 v[16:19], a[128:131], v[160:163], v[200:203]
  v_exp_f32 v0, v0
  v_mfma_f32_16x16x32_bf16 v[16:19], a[132:135], v[164:167], v[16:19]
  v_lshrrev_b32 v210, 5, v209
  v_lshlrev_b32 v210, 30, v210
  v_mfma_f32_16x16x32_bf16 v[16:19], a[136:139], v[168:171], v[16:19]
  v_exp_f32 v1, v1
  v_mfma_f32_16x16x32_bf16 v[16:19], a[140:143], v[172:175], v[16:19]
  v_cvt_pk_bf16_f32 v0, v0, v1
  v_or_b32 v210, v210, v208
  v_mfma_f32_16x16x32_bf16 v[24:27], a[140:143], v[188:191], v[204:207]
  v_exp_f32 v2, v2
  v_mfma_f32_16x16x32_bf16 v[24:27], a[136:139], v[184:187], v[24:27]
  buffer_load_dwordx4 v236, s[16:19], s29 offen offset:2048 lds
  v_mfma_f32_16x16x32_bf16 v[24:27], a[132:135], v[180:183], v[24:27]
  s_waitcnt lgkmcnt(0)
  v_exp_f32 v3, v3
  v_mfma_f32_16x16x32_bf16 v[24:27], a[128:131], v[176:179], v[24:27]
  v_cvt_pk_bf16_f32 v1, v2, v3
  v_bfe_u32 v211, v209, 2, 4
  v_mfma_f32_16x16x32_bf16 v[4:7], a[144:147], v[128:131], v[192:195]
  v_exp_f32 v8, v8
  v_mfma_f32_16x16x32_bf16 v[4:7], a[148:151], v[132:135], v[4:7]
  ds_read_b128 a[128:131], v212 offset:40960
  v_and_b32 v209, 3, v209
  v_mfma_f32_16x16x32_bf16 v[4:7], a[152:155], v[136:139], v[4:7]
  v_exp_f32 v9, v9
  v_mfma_f32_16x16x32_bf16 v[4:7], a[156:159], v[140:143], v[4:7]
  ds_read_b128 a[132:135], v213 offset:40960
  v_cvt_pk_bf16_f32 v8, v8, v9
  v_mfma_f32_16x16x32_bf16 v[12:15], a[156:159], v[156:159], v[196:199]
  v_exp_f32 v10, v10
  v_mfma_f32_16x16x32_bf16 v[12:15], a[152:155], v[152:155], v[12:15]
  ds_read_b128 a[136:139], v214 offset:40960
  v_lshlrev_b32 v209, 3, v209
  v_mfma_f32_16x16x32_bf16 v[12:15], a[148:151], v[148:151], v[12:15]
  v_exp_f32 v11, v11
  v_mfma_f32_16x16x32_bf16 v[12:15], a[144:147], v[144:147], v[12:15]
  ds_read_b128 a[140:143], v215 offset:40960
  v_cvt_pk_bf16_f32 v9, v10, v11
  v_mfma_f32_16x16x32_bf16 v[20:23], a[144:147], v[160:163], v[200:203]
  v_exp_f32 v16, v16
  v_mfma_f32_16x16x32_bf16 v[20:23], a[148:151], v[164:167], v[20:23]
  buffer_load_dwordx4 v237, s[16:19], s29 offen offset:3072 lds
  v_mfma_f32_16x16x32_bf16 v[20:23], a[152:155], v[168:171], v[20:23]
  s_add_u32 s29, s29, 16384
  v_exp_f32 v17, v17
  v_mfma_f32_16x16x32_bf16 v[20:23], a[156:159], v[172:175], v[20:23]
  v_cvt_pk_bf16_f32 v16, v16, v17
  v_lshl_add_u32 v209, v211, 5, v209
  v_mfma_f32_16x16x32_bf16 v[28:31], a[156:159], v[188:191], v[204:207]
  s_add_u32 m0, s28, 0
  v_exp_f32 v18, v18
  v_mfma_f32_16x16x32_bf16 v[28:31], a[152:155], v[184:187], v[28:31]
  buffer_load_dwordx4 v232, s[12:15], s29 offen offset:0 lds
  v_mfma_f32_16x16x32_bf16 v[28:31], a[148:151], v[180:183], v[28:31]
  s_waitcnt lgkmcnt(0)
  v_exp_f32 v19, v19
  v_mfma_f32_16x16x32_bf16 v[28:31], a[144:147], v[176:179], v[28:31]
  v_cvt_pk_bf16_f32 v17, v18, v19
  v_add_u32 v209, s50, v209
  v_mfma_f32_16x16x32_bf16 v[32:35], a[128:131], v[128:131], v[192:195]
  s_and_b32 s39, s2, 1
  s_lshl_b32 s39, s39, 2
  s_add_u32 s39, s39, s3
  v_exp_f32 v24, v24
  v_mfma_f32_16x16x32_bf16 v[32:35], a[132:135], v[132:135], v[32:35]
  ds_read_b128 a[144:147], v212 offset:45056
  s_lshr_b32 s31, s2, 1
  s_mul_i32 s30, s31, 40960
  s_mul_i32 s48, s39, 160
  v_mfma_f32_16x16x32_bf16 v[32:35], a[136:139], v[136:139], v[32:35]
  s_add_u32 s30, s30, s48
  s_mul_i32 s31, s31, 5120
  s_mul_i32 s39, s39, 655360
  v_exp_f32 v25, v25
  v_mfma_f32_16x16x32_bf16 v[32:35], a[140:143], v[140:143], v[32:35]
  ds_read_b128 a[148:151], v213 offset:45056
  s_add_u32 s31, s31, s39
  s_add_u32 s31, s31, 3145728
  s_lshr_b32 s39, s2, 3
  v_cvt_pk_bf16_f32 v24, v24, v25
  v_mfma_f32_16x16x32_bf16 v[40:43], a[140:143], v[156:159], v[196:199]
  s_min_u32 s39, s39, 29
  s_and_b32 s48, s2, 7
  s_mul_i32 s48, s48, 30
  v_exp_f32 v26, v26
  v_mfma_f32_16x16x32_bf16 v[40:43], a[136:139], v[152:155], v[40:43]
  ds_read_b128 a[152:155], v214 offset:45056
  s_add_u32 s39, s39, s48
  s_mul_i32 s98, s39, 1639
  s_lshr_b32 s98, s98, 16
  v_mfma_f32_16x16x32_bf16 v[40:43], a[132:135], v[148:151], v[40:43]
  s_mul_i32 s99, s98, 40
  s_sub_u32 s99, s39, s99
  s_min_u32 s39, s3, 2
  v_exp_f32 v27, v27
  v_mfma_f32_16x16x32_bf16 v[40:43], a[128:131], v[144:147], v[40:43]
  ds_read_b128 a[156:159], v215 offset:45056
  s_mul_i32 s48, s98, 3
  s_add_u32 s48, s48, s39
  s_mul_i32 s100, s48, 122880
  v_cvt_pk_bf16_f32 v25, v26, v27
  v_mfma_f32_16x16x32_bf16 v[48:51], a[128:131], v[160:163], v[200:203]
  s_lshl_b32 s39, s99, 5
  s_add_u32 s100, s100, s39
  s_mul_i32 s101, s48, 192
  v_exp_f32 v4, v4
  v_mfma_f32_16x16x32_bf16 v[48:51], a[132:135], v[164:167], v[48:51]
  buffer_load_dwordx4 v233, s[12:15], s29 offen offset:1024 lds
  s_add_u32 s101, s101, 2633728
  s_mov_b32 s51, s50
  v_mfma_f32_16x16x32_bf16 v[48:51], a[136:139], v[168:171], v[48:51]
  v_exp_f32 v5, v5
  v_mfma_f32_16x16x32_bf16 v[48:51], a[140:143], v[172:175], v[48:51]
  v_cvt_pk_bf16_f32 v2, v4, v5
  v_mov_b32 v211, v242
  v_mfma_f32_16x16x32_bf16 v[56:59], a[140:143], v[188:191], v[204:207]
  s_mov_b32 s4, s94
  s_mov_b32 s5, s95
  s_mov_b32 s6, 2211840
  v_exp_f32 v6, v6
  v_mfma_f32_16x16x32_bf16 v[56:59], a[136:139], v[184:187], v[56:59]
  buffer_load_dwordx4 v234, s[12:15], s29 offen offset:2048 lds
  s_mov_b32 s7, 0x20000
  s_getpc_b64 s[8:9]
attn_late_pc:
  s_add_u32 s8, s8, attn_h_ready-attn_late_pc
  s_addc_u32 s9, s9, 0
  v_mfma_f32_16x16x32_bf16 v[56:59], a[132:135], v[180:183], v[56:59]
  s_waitcnt lgkmcnt(0)
  s_lshr_b32 s39, s2, 3
  v_exp_f32 v7, v7
  v_mfma_f32_16x16x32_bf16 v[56:59], a[128:131], v[176:179], v[56:59]
  v_cvt_pk_bf16_f32 v3, v6, v7
  v_lshrrev_b32 v252, 4, v242
  v_mfma_f32_16x16x32_bf16 v[36:39], a[144:147], v[128:131], v[192:195]
  v_exp_f32 v12, v12
  v_mfma_f32_16x16x32_bf16 v[36:39], a[148:151], v[132:135], v[36:39]
  ds_read_b64_tr_b16 a[160:161], v216 offset:16384
  v_min_u32 v252, 11, v252
  v_mfma_f32_16x16x32_bf16 v[36:39], a[152:155], v[136:139], v[36:39]
  v_exp_f32 v13, v13
  v_mfma_f32_16x16x32_bf16 v[36:39], a[156:159], v[140:143], v[36:39]
  ds_read_b64_tr_b16 a[162:163], v216 offset:20480
  v_cvt_pk_bf16_f32 v10, v12, v13
  v_mfma_f32_16x16x32_bf16 v[44:47], a[156:159], v[156:159], v[196:199]
  v_exp_f32 v14, v14
  v_mfma_f32_16x16x32_bf16 v[44:47], a[152:155], v[152:155], v[44:47]
  ds_read_b64_tr_b16 a[164:165], v216 offset:24576
  buffer_load_dwordx4 v235, s[12:15], s29 offen offset:3072 lds
  v_mfma_f32_16x16x32_bf16 v[44:47], a[148:151], v[148:151], v[44:47]
  v_exp_f32 v15, v15
  v_mfma_f32_16x16x32_bf16 v[44:47], a[144:147], v[144:147], v[44:47]
  ds_read_b64_tr_b16 a[166:167], v216 offset:28672
  v_cvt_pk_bf16_f32 v11, v14, v15
  v_mfma_f32_16x16x32_bf16 v[52:55], a[144:147], v[160:163], v[200:203]
  v_exp_f32 v20, v20
  v_mfma_f32_16x16x32_bf16 v[52:55], a[148:151], v[164:167], v[52:55]
  ds_read_b64_tr_b16 a[168:169], v217 offset:16384
  v_lshlrev_b32 v252, 5, v252
  v_mfma_f32_16x16x32_bf16 v[52:55], a[152:155], v[168:171], v[52:55]
  v_exp_f32 v21, v21
  v_mfma_f32_16x16x32_bf16 v[52:55], a[156:159], v[172:175], v[52:55]
  ds_read_b64_tr_b16 a[170:171], v217 offset:20480
  v_cvt_pk_bf16_f32 v18, v20, v21
  v_mfma_f32_16x16x32_bf16 v[60:63], a[156:159], v[188:191], v[204:207]
  v_exp_f32 v22, v22
  v_mfma_f32_16x16x32_bf16 v[60:63], a[152:155], v[184:187], v[60:63]
  ds_read_b64_tr_b16 a[172:173], v217 offset:24576
  v_add_u32 v252, s39, v252
  v_mfma_f32_16x16x32_bf16 v[60:63], a[148:151], v[180:183], v[60:63]
  v_exp_f32 v23, v23
  v_mfma_f32_16x16x32_bf16 v[60:63], a[144:147], v[176:179], v[60:63]
  ds_read_b64_tr_b16 a[174:175], v217 offset:28672
  v_cvt_pk_bf16_f32 v19, v22, v23
  v_mfma_f32_16x16x32_bf16 a[192:195], a[208:211], v[64:67], a[192:195]
  v_exp_f32 v28, v28
  v_mfma_f32_16x16x32_bf16 a[192:195], a[208:211], v[96:99], a[192:195]
  ds_read_b64_tr_b16 a[176:177], v218 offset:16384
  v_lshlrev_b32 v252, 7, v252
  v_mfma_f32_16x16x32_bf16 a[196:199], a[208:211], v[72:75], a[196:199]
  v_exp_f32 v29, v29
  v_mfma_f32_16x16x32_bf16 a[196:199], a[208:211], v[104:107], a[196:199]
  ds_read_b64_tr_b16 a[178:179], v218 offset:20480
  v_cvt_pk_bf16_f32 v26, v28, v29
  v_mfma_f32_16x16x32_bf16 a[200:203], a[208:211], v[80:83], a[200:203]
  v_exp_f32 v30, v30
  v_mfma_f32_16x16x32_bf16 a[200:203], a[208:211], v[112:115], a[200:203]
  ds_read_b64_tr_b16 a[180:181], v218 offset:24576
  v_min_u32 v252, attn_end-attn_h_ready-4, v252
  v_mfma_f32_16x16x32_bf16 a[204:207], a[208:211], v[88:91], a[204:207]
  s_waitcnt lgkmcnt(7)
  v_exp_f32 v31, v31
  v_mfma_f32_16x16x32_bf16 a[204:207], a[208:211], v[120:123], a[204:207]
  ds_read_b64_tr_b16 a[182:183], v218 offset:28672
  v_cvt_pk_bf16_f32 v27, v30, v31
  v_mfma_f32_16x16x32_bf16 a[0:3], a[160:163], v[64:67], a[0:3]
  v_exp_f32 v32, v32
  v_mfma_f32_16x16x32_bf16 a[0:3], a[164:167], v[96:99], a[0:3]
  ds_read_b64_tr_b16 a[184:185], v219 offset:16384
  v_mfma_f32_16x16x32_bf16 a[4:7], a[164:167], v[104:107], a[4:7]
  v_exp_f32 v33, v33
  v_mfma_f32_16x16x32_bf16 a[4:7], a[160:163], v[72:75], a[4:7]
  ds_read_b64_tr_b16 a[186:187], v219 offset:20480
  v_cvt_pk_bf16_f32 v32, v32, v33
  v_mfma_f32_16x16x32_bf16 a[8:11], a[160:163], v[80:83], a[8:11]
  v_exp_f32 v34, v34
  v_mfma_f32_16x16x32_bf16 a[8:11], a[164:167], v[112:115], a[8:11]
  ds_read_b64_tr_b16 a[188:189], v219 offset:24576
  v_mfma_f32_16x16x32_bf16 a[12:15], a[164:167], v[120:123], a[12:15]
  s_waitcnt lgkmcnt(7)
  v_exp_f32 v35, v35
  v_mfma_f32_16x16x32_bf16 a[12:15], a[160:163], v[88:91], a[12:15]
  ds_read_b64_tr_b16 a[190:191], v219 offset:28672
  v_cvt_pk_bf16_f32 v33, v34, v35
  v_mfma_f32_16x16x32_bf16 a[16:19], a[168:171], v[64:67], a[16:19]
  v_exp_f32 v40, v40
  v_mfma_f32_16x16x32_bf16 a[16:19], a[172:175], v[96:99], a[16:19]
  ds_read_b64_tr_b16 a[160:161], v220 offset:16384
  v_mfma_f32_16x16x32_bf16 a[20:23], a[172:175], v[104:107], a[20:23]
  v_exp_f32 v41, v41
  v_mfma_f32_16x16x32_bf16 a[20:23], a[168:171], v[72:75], a[20:23]
  ds_read_b64_tr_b16 a[162:163], v220 offset:20480
  v_cvt_pk_bf16_f32 v40, v40, v41
  v_mfma_f32_16x16x32_bf16 a[24:27], a[168:171], v[80:83], a[24:27]
  v_exp_f32 v42, v42
  v_mfma_f32_16x16x32_bf16 a[24:27], a[172:175], v[112:115], a[24:27]
  ds_read_b64_tr_b16 a[164:165], v220 offset:24576
  v_mfma_f32_16x16x32_bf16 a[28:31], a[172:175], v[120:123], a[28:31]
  s_waitcnt lgkmcnt(7)
  v_exp_f32 v43, v43
  v_mfma_f32_16x16x32_bf16 a[28:31], a[168:171], v[88:91], a[28:31]
  ds_read_b64_tr_b16 a[166:167], v220 offset:28672
  v_cvt_pk_bf16_f32 v41, v42, v43
  v_mfma_f32_16x16x32_bf16 a[32:35], a[176:179], v[64:67], a[32:35]
  v_exp_f32 v48, v48
  v_mfma_f32_16x16x32_bf16 a[32:35], a[180:183], v[96:99], a[32:35]
  ds_read_b64_tr_b16 a[168:169], v221 offset:16384
  v_mfma_f32_16x16x32_bf16 a[36:39], a[180:183], v[104:107], a[36:39]
  v_exp_f32 v49, v49
  v_mfma_f32_16x16x32_bf16 a[36:39], a[176:179], v[72:75], a[36:39]
  ds_read_b64_tr_b16 a[170:171], v221 offset:20480
  v_cvt_pk_bf16_f32 v48, v48, v49
  v_mfma_f32_16x16x32_bf16 a[40:43], a[176:179], v[80:83], a[40:43]
  v_exp_f32 v50, v50
  v_mfma_f32_16x16x32_bf16 a[40:43], a[180:183], v[112:115], a[40:43]
  ds_read_b64_tr_b16 a[172:173], v221 offset:24576
  v_mfma_f32_16x16x32_bf16 a[44:47], a[180:183], v[120:123], a[44:47]
  s_waitcnt lgkmcnt(7)
  v_exp_f32 v51, v51
  v_mfma_f32_16x16x32_bf16 a[44:47], a[176:179], v[88:91], a[44:47]
  ds_read_b64_tr_b16 a[174:175], v221 offset:28672
  v_cvt_pk_bf16_f32 v49, v50, v51
  v_mfma_f32_16x16x32_bf16 a[48:51], a[184:187], v[64:67], a[48:51]
  v_exp_f32 v56, v56
  v_mfma_f32_16x16x32_bf16 a[48:51], a[188:191], v[96:99], a[48:51]
  ds_read_b64_tr_b16 a[176:177], v222 offset:16384
  v_mfma_f32_16x16x32_bf16 a[52:55], a[188:191], v[104:107], a[52:55]
  v_exp_f32 v57, v57
  v_mfma_f32_16x16x32_bf16 a[52:55], a[184:187], v[72:75], a[52:55]
  ds_read_b64_tr_b16 a[178:179], v222 offset:20480
  v_cvt_pk_bf16_f32 v56, v56, v57
  v_mfma_f32_16x16x32_bf16 a[56:59], a[184:187], v[80:83], a[56:59]
  v_exp_f32 v58, v58
  v_mfma_f32_16x16x32_bf16 a[56:59], a[188:191], v[112:115], a[56:59]
  ds_read_b64_tr_b16 a[180:181], v222 offset:24576
  v_mfma_f32_16x16x32_bf16 a[60:63], a[188:191], v[120:123], a[60:63]
  s_waitcnt lgkmcnt(7)
  v_exp_f32 v59, v59
  v_mfma_f32_16x16x32_bf16 a[60:63], a[184:187], v[88:91], a[60:63]
  ds_read_b64_tr_b16 a[182:183], v222 offset:28672
  v_cvt_pk_bf16_f32 v57, v58, v59
  v_mfma_f32_16x16x32_bf16 a[64:67], a[160:163], v[64:67], a[64:67]
  v_exp_f32 v36, v36
  v_mfma_f32_16x16x32_bf16 a[64:67], a[164:167], v[96:99], a[64:67]
  ds_read_b64_tr_b16 a[184:185], v223 offset:16384
  v_mfma_f32_16x16x32_bf16 a[68:71], a[164:167], v[104:107], a[68:71]
  v_exp_f32 v37, v37
  v_mfma_f32_16x16x32_bf16 a[68:71], a[160:163], v[72:75], a[68:71]
  ds_read_b64_tr_b16 a[186:187], v223 offset:20480
  v_cvt_pk_bf16_f32 v34, v36, v37
  v_mfma_f32_16x16x32_bf16 a[72:75], a[160:163], v[80:83], a[72:75]
  v_exp_f32 v38, v38
  v_mfma_f32_16x16x32_bf16 a[72:75], a[164:167], v[112:115], a[72:75]
  ds_read_b64_tr_b16 a[188:189], v223 offset:24576
  v_mfma_f32_16x16x32_bf16 a[76:79], a[164:167], v[120:123], a[76:79]
  s_waitcnt lgkmcnt(7)
  v_exp_f32 v39, v39
  v_mfma_f32_16x16x32_bf16 a[76:79], a[160:163], v[88:91], a[76:79]
  ds_read_b64_tr_b16 a[190:191], v223 offset:28672
  v_cvt_pk_bf16_f32 v35, v38, v39
  v_mfma_f32_16x16x32_bf16 a[80:83], a[168:171], v[64:67], a[80:83]
  s_waitcnt vmcnt(10)
  v_exp_f32 v44, v44
  v_mfma_f32_16x16x32_bf16 a[80:83], a[172:175], v[96:99], a[80:83]
  v_mfma_f32_16x16x32_bf16 a[84:87], a[172:175], v[104:107], a[84:87]
  s_barrier
  v_exp_f32 v45, v45
  v_mfma_f32_16x16x32_bf16 a[84:87], a[168:171], v[72:75], a[84:87]
  ds_read_b128 a[128:131], v212 offset:49152
  v_cvt_pk_bf16_f32 v42, v44, v45
  v_mfma_f32_16x16x32_bf16 a[88:91], a[168:171], v[80:83], a[88:91]
  v_exp_f32 v46, v46
  v_mfma_f32_16x16x32_bf16 a[88:91], a[172:175], v[112:115], a[88:91]
  ds_read_b128 a[132:135], v213 offset:49152
  v_mfma_f32_16x16x32_bf16 a[92:95], a[172:175], v[120:123], a[92:95]
  s_waitcnt lgkmcnt(6)
  v_exp_f32 v47, v47
  v_mfma_f32_16x16x32_bf16 a[92:95], a[168:171], v[88:91], a[92:95]
  ds_read_b128 a[136:139], v214 offset:49152
  v_cvt_pk_bf16_f32 v43, v46, v47
  v_mfma_f32_16x16x32_bf16 a[96:99], a[176:179], v[64:67], a[96:99]
  v_exp_f32 v52, v52
  v_mfma_f32_16x16x32_bf16 a[96:99], a[180:183], v[96:99], a[96:99]
  ds_read_b128 a[140:143], v215 offset:49152
  v_mfma_f32_16x16x32_bf16 a[100:103], a[180:183], v[104:107], a[100:103]
  v_exp_f32 v53, v53
  v_mfma_f32_16x16x32_bf16 a[100:103], a[176:179], v[72:75], a[100:103]
  v_cvt_pk_bf16_f32 v50, v52, v53
  v_mfma_f32_16x16x32_bf16 a[104:107], a[176:179], v[80:83], a[104:107]
  v_exp_f32 v54, v54
  v_mfma_f32_16x16x32_bf16 a[104:107], a[180:183], v[112:115], a[104:107]
  v_mfma_f32_16x16x32_bf16 a[108:111], a[180:183], v[120:123], a[108:111]
  s_waitcnt lgkmcnt(4)
  v_exp_f32 v55, v55
  v_mfma_f32_16x16x32_bf16 a[108:111], a[176:179], v[88:91], a[108:111]
  v_cvt_pk_bf16_f32 v51, v54, v55
  v_mfma_f32_16x16x32_bf16 a[112:115], a[184:187], v[64:67], a[112:115]
  v_exp_f32 v60, v60
  v_mfma_f32_16x16x32_bf16 a[112:115], a[188:191], v[96:99], a[112:115]
  v_mfma_f32_16x16x32_bf16 a[116:119], a[188:191], v[104:107], a[116:119]
  v_exp_f32 v61, v61
  v_mfma_f32_16x16x32_bf16 a[116:119], a[184:187], v[72:75], a[116:119]
  v_cvt_pk_bf16_f32 v58, v60, v61
  v_mfma_f32_16x16x32_bf16 a[120:123], a[184:187], v[80:83], a[120:123]
  v_exp_f32 v62, v62
  v_mfma_f32_16x16x32_bf16 a[120:123], a[188:191], v[112:115], a[120:123]
  v_mfma_f32_16x16x32_bf16 a[124:127], a[188:191], v[120:123], a[124:127]
  s_waitcnt lgkmcnt(0)
  v_exp_f32 v63, v63
  v_mfma_f32_16x16x32_bf16 a[124:127], a[184:187], v[88:91], a[124:127]
  v_cvt_pk_bf16_f32 v59, v62, v63
  v_mfma_f32_16x16x32_bf16 v[64:67], a[128:131], v[128:131], v[192:195]
  s_add_u32 m0, s28, 65536
  v_lshrrev_b32 v224, 4, v242
  v_lshrrev_b32 v225, 4, v224
  v_mfma_f32_16x16x32_bf16 v[64:67], a[132:135], v[132:135], v[64:67]
  ds_read_b128 a[144:147], v212 offset:53248
  v_bfe_u32 v226, v224, 2, 2
  v_mfma_f32_16x16x32_bf16 v[64:67], a[136:139], v[136:139], v[64:67]
  buffer_load_dwordx4 v236, s[16:19], s29 offen offset:0 lds
  v_mfma_f32_16x16x32_bf16 v[64:67], a[140:143], v[140:143], v[64:67]
  ds_read_b128 a[148:151], v213 offset:53248
  v_lshl_add_u32 v225, v225, 3, v226
  v_mfma_f32_16x16x32_bf16 v[72:75], a[140:143], v[156:159], v[196:199]
  v_lshlrev_b32 v225, 4, v225
  v_bfe_u32 v226, v224, 1, 1
  v_mfma_f32_16x16x32_bf16 v[72:75], a[136:139], v[152:155], v[72:75]
  ds_read_b128 a[152:155], v214 offset:53248
  v_mul_u32_u24 v226, 0xc00, v226
  v_mfma_f32_16x16x32_bf16 v[72:75], a[132:135], v[148:151], v[72:75]
  buffer_load_dwordx4 v237, s[16:19], s29 offen offset:1024 lds
  v_mfma_f32_16x16x32_bf16 v[72:75], a[128:131], v[144:147], v[72:75]
  ds_read_b128 a[156:159], v215 offset:53248
  v_add3_u32 v225, v225, v226, s50
  v_mfma_f32_16x16x32_bf16 v[80:83], a[128:131], v[160:163], v[200:203]
  v_exp_f32 v64, v64
  v_mfma_f32_16x16x32_bf16 v[80:83], a[132:135], v[164:167], v[80:83]
  v_and_b32 v226, 1, v224
  v_lshl_add_u32 v225, v226, 3, v225
  v_mfma_f32_16x16x32_bf16 v[80:83], a[136:139], v[168:171], v[80:83]
  s_waitcnt vmcnt(10)
  v_exp_f32 v65, v65
  v_mfma_f32_16x16x32_bf16 v[80:83], a[140:143], v[172:175], v[80:83]
  ds_read_b64_tr_b16 a[232:233], v225 offset:0
  v_cvt_pk_bf16_f32 v64, v64, v65
  v_mfma_f32_16x16x32_bf16 v[88:91], a[140:143], v[188:191], v[204:207]
  v_exp_f32 v66, v66
  v_mfma_f32_16x16x32_bf16 v[88:91], a[136:139], v[184:187], v[88:91]
  buffer_load_dwordx4 v236, s[16:19], s29 offen offset:2048 lds
  v_mfma_f32_16x16x32_bf16 v[88:91], a[132:135], v[180:183], v[88:91]
  s_waitcnt lgkmcnt(1)
  v_exp_f32 v67, v67
  v_mfma_f32_16x16x32_bf16 v[88:91], a[128:131], v[176:179], v[88:91]
  ds_read_b64_tr_b16 a[234:235], v225 offset:64
  v_cvt_pk_bf16_f32 v65, v66, v67
  v_mfma_f32_16x16x32_bf16 v[68:71], a[144:147], v[128:131], v[192:195]
  v_exp_f32 v72, v72
  v_mfma_f32_16x16x32_bf16 v[68:71], a[148:151], v[132:135], v[68:71]
  ds_read_b128 a[128:131], v212 offset:57344
  ds_read_b64_tr_b16 a[236:237], v225 offset:512
  v_mfma_f32_16x16x32_bf16 v[68:71], a[152:155], v[136:139], v[68:71]
  v_exp_f32 v73, v73
  v_mfma_f32_16x16x32_bf16 v[68:71], a[156:159], v[140:143], v[68:71]
  ds_read_b128 a[132:135], v213 offset:57344
  v_cvt_pk_bf16_f32 v72, v72, v73
  v_mfma_f32_16x16x32_bf16 v[76:79], a[156:159], v[156:159], v[196:199]
  v_exp_f32 v74, v74
  v_mfma_f32_16x16x32_bf16 v[76:79], a[152:155], v[152:155], v[76:79]
  ds_read_b128 a[136:139], v214 offset:57344
  ds_read_b64_tr_b16 a[238:239], v225 offset:576
  v_mfma_f32_16x16x32_bf16 v[76:79], a[148:151], v[148:151], v[76:79]
  v_exp_f32 v75, v75
  v_mfma_f32_16x16x32_bf16 v[76:79], a[144:147], v[144:147], v[76:79]
  ds_read_b128 a[140:143], v215 offset:57344
  v_cvt_pk_bf16_f32 v73, v74, v75
  v_mfma_f32_16x16x32_bf16 v[84:87], a[144:147], v[160:163], v[200:203]
  v_exp_f32 v80, v80
  v_mfma_f32_16x16x32_bf16 v[84:87], a[148:151], v[164:167], v[84:87]
  buffer_load_dwordx4 v237, s[16:19], s29 offen offset:3072 lds
  v_mfma_f32_16x16x32_bf16 v[84:87], a[152:155], v[168:171], v[84:87]
  s_add_u32 s29, s29, 16384
  v_exp_f32 v81, v81
  v_mfma_f32_16x16x32_bf16 v[84:87], a[156:159], v[172:175], v[84:87]
  ds_read_b64_tr_b16 a[240:241], v225 offset:1024
  v_cvt_pk_bf16_f32 v80, v80, v81
  v_mfma_f32_16x16x32_bf16 v[92:95], a[156:159], v[188:191], v[204:207]
  s_add_u32 m0, s28, 16384
  v_exp_f32 v82, v82
  v_mfma_f32_16x16x32_bf16 v[92:95], a[152:155], v[184:187], v[92:95]
  buffer_load_dwordx4 v232, s[12:15], s29 offen offset:0 lds
  v_mfma_f32_16x16x32_bf16 v[92:95], a[148:151], v[180:183], v[92:95]
  s_waitcnt lgkmcnt(1)
  v_exp_f32 v83, v83
  v_mfma_f32_16x16x32_bf16 v[92:95], a[144:147], v[176:179], v[92:95]
  ds_read_b64_tr_b16 a[242:243], v225 offset:1088
  v_cvt_pk_bf16_f32 v81, v82, v83
  v_mfma_f32_16x16x32_bf16 v[96:99], a[128:131], v[128:131], v[192:195]
  v_exp_f32 v88, v88
  v_mfma_f32_16x16x32_bf16 v[96:99], a[132:135], v[132:135], v[96:99]
  ds_read_b128 a[144:147], v212 offset:61440
  ds_read_b64_tr_b16 a[244:245], v225 offset:1536
  v_mfma_f32_16x16x32_bf16 v[96:99], a[136:139], v[136:139], v[96:99]
  v_exp_f32 v89, v89
  v_mfma_f32_16x16x32_bf16 v[96:99], a[140:143], v[140:143], v[96:99]
  ds_read_b128 a[148:151], v213 offset:61440
  v_cvt_pk_bf16_f32 v88, v88, v89
  v_mfma_f32_16x16x32_bf16 v[104:107], a[140:143], v[156:159], v[196:199]
  v_exp_f32 v90, v90
  v_mfma_f32_16x16x32_bf16 v[104:107], a[136:139], v[152:155], v[104:107]
  ds_read_b128 a[152:155], v214 offset:61440
  ds_read_b64_tr_b16 a[246:247], v225 offset:1600
  v_mfma_f32_16x16x32_bf16 v[104:107], a[132:135], v[148:151], v[104:107]
  v_exp_f32 v91, v91
  v_mfma_f32_16x16x32_bf16 v[104:107], a[128:131], v[144:147], v[104:107]
  ds_read_b128 a[156:159], v215 offset:61440
  v_cvt_pk_bf16_f32 v89, v90, v91
  v_mfma_f32_16x16x32_bf16 v[112:115], a[128:131], v[160:163], v[200:203]
  v_exp_f32 v68, v68
  v_mfma_f32_16x16x32_bf16 v[112:115], a[132:135], v[164:167], v[112:115]
  buffer_load_dwordx4 v233, s[12:15], s29 offen offset:1024 lds
  v_mfma_f32_16x16x32_bf16 v[112:115], a[136:139], v[168:171], v[112:115]
  v_exp_f32 v69, v69
  v_mfma_f32_16x16x32_bf16 v[112:115], a[140:143], v[172:175], v[112:115]
  ds_read_b64_tr_b16 a[248:249], v225 offset:2048
  v_cvt_pk_bf16_f32 v66, v68, v69
  v_mfma_f32_16x16x32_bf16 v[120:123], a[140:143], v[188:191], v[204:207]
  v_exp_f32 v70, v70
  v_mfma_f32_16x16x32_bf16 v[120:123], a[136:139], v[184:187], v[120:123]
  buffer_load_dwordx4 v234, s[12:15], s29 offen offset:2048 lds
  v_mfma_f32_16x16x32_bf16 v[120:123], a[132:135], v[180:183], v[120:123]
  s_waitcnt lgkmcnt(1)
  v_exp_f32 v71, v71
  v_mfma_f32_16x16x32_bf16 v[120:123], a[128:131], v[176:179], v[120:123]
  ds_read_b64_tr_b16 a[250:251], v225 offset:2112
  v_cvt_pk_bf16_f32 v67, v70, v71
  v_mfma_f32_16x16x32_bf16 v[100:103], a[144:147], v[128:131], v[192:195]
  v_exp_f32 v76, v76
  v_mfma_f32_16x16x32_bf16 v[100:103], a[148:151], v[132:135], v[100:103]
  ds_read_b64_tr_b16 a[160:161], v216 offset:32768
  v_mfma_f32_16x16x32_bf16 v[100:103], a[152:155], v[136:139], v[100:103]
  v_exp_f32 v77, v77
  v_mfma_f32_16x16x32_bf16 v[100:103], a[156:159], v[140:143], v[100:103]
  ds_read_b64_tr_b16 a[162:163], v216 offset:36864
  v_cvt_pk_bf16_f32 v74, v76, v77
  v_mfma_f32_16x16x32_bf16 v[108:111], a[156:159], v[156:159], v[196:199]
  v_exp_f32 v78, v78
  v_mfma_f32_16x16x32_bf16 v[108:111], a[152:155], v[152:155], v[108:111]
  ds_read_b64_tr_b16 a[164:165], v216 offset:40960
  buffer_load_dwordx4 v235, s[12:15], s29 offen offset:3072 lds
  v_mfma_f32_16x16x32_bf16 v[108:111], a[148:151], v[148:151], v[108:111]
  v_exp_f32 v79, v79
  v_mfma_f32_16x16x32_bf16 v[108:111], a[144:147], v[144:147], v[108:111]
  ds_read_b64_tr_b16 a[166:167], v216 offset:45056
  s_waitcnt lgkmcnt(4)
  v_cvt_pk_bf16_f32 v75, v78, v79
  v_mfma_f32_16x16x32_bf16 v[116:119], a[144:147], v[160:163], v[200:203]
  v_exp_f32 v84, v84
  v_mfma_f32_16x16x32_bf16 v[116:119], a[148:151], v[164:167], v[116:119]
  ds_read_b64_tr_b16 a[168:169], v217 offset:32768
  v_mfma_f32_16x16x32_bf16 v[228:231], a[232:235], a[212:215], 0
  v_mfma_f32_16x16x32_bf16 v[228:231], a[236:239], a[216:219], v[228:231]
  v_mfma_f32_16x16x32_bf16 v[228:231], a[240:243], a[220:223], v[228:231]
  v_mfma_f32_16x16x32_bf16 v[228:231], a[244:247], a[224:227], v[228:231]
  v_mfma_f32_16x16x32_bf16 v[228:231], a[248:251], a[228:231], v[228:231]
  v_mfma_f32_16x16x32_bf16 v[116:119], a[152:155], v[168:171], v[116:119]
  s_lshl_b32 s35, s3, 10
  s_add_u32 s35, s35, 159744
  v_exp_f32 v85, v85
  v_mfma_f32_16x16x32_bf16 v[116:119], a[156:159], v[172:175], v[116:119]
  ds_read_b64_tr_b16 a[170:171], v217 offset:36864
  v_cvt_pk_bf16_f32 v82, v84, v85
  v_mfma_f32_16x16x32_bf16 v[124:127], a[156:159], v[188:191], v[204:207]
  v_exp_f32 v86, v86
  v_mfma_f32_16x16x32_bf16 v[124:127], a[152:155], v[184:187], v[124:127]
  ds_read_b64_tr_b16 a[172:173], v217 offset:40960
  v_add_u32 v224, s35, v242
  v_mfma_f32_16x16x32_bf16 v[124:127], a[148:151], v[180:183], v[124:127]
  v_exp_f32 v87, v87
  v_mfma_f32_16x16x32_bf16 v[124:127], a[144:147], v[176:179], v[124:127]
  ds_read_b64_tr_b16 a[174:175], v217 offset:45056
  v_cvt_pk_bf16_f32 v83, v86, v87
  v_mfma_f32_16x16x32_bf16 a[192:195], a[208:211], v[0:3], a[192:195]
  v_exp_f32 v92, v92
  v_mfma_f32_16x16x32_bf16 a[192:195], a[208:211], v[32:35], a[192:195]
  ds_read_b64_tr_b16 a[176:177], v218 offset:32768
  ds_write_b128 v224, v[228:231]
  v_mfma_f32_16x16x32_bf16 a[196:199], a[208:211], v[8:11], a[196:199]
  v_exp_f32 v93, v93
  v_mfma_f32_16x16x32_bf16 a[196:199], a[208:211], v[40:43], a[196:199]
  ds_read_b64_tr_b16 a[178:179], v218 offset:36864
  v_cvt_pk_bf16_f32 v90, v92, v93
  v_mfma_f32_16x16x32_bf16 a[200:203], a[208:211], v[16:19], a[200:203]
  v_exp_f32 v94, v94
  v_mfma_f32_16x16x32_bf16 a[200:203], a[208:211], v[48:51], a[200:203]
  ds_read_b64_tr_b16 a[180:181], v218 offset:40960
  v_mfma_f32_16x16x32_bf16 a[204:207], a[208:211], v[24:27], a[204:207]
  s_waitcnt lgkmcnt(8)
  v_exp_f32 v95, v95
  v_mfma_f32_16x16x32_bf16 a[204:207], a[208:211], v[56:59], a[204:207]
  ds_read_b64_tr_b16 a[182:183], v218 offset:45056
  v_cvt_pk_bf16_f32 v91, v94, v95
  v_mfma_f32_16x16x32_bf16 a[0:3], a[160:163], v[0:3], a[0:3]
  v_exp_f32 v96, v96
  v_mfma_f32_16x16x32_bf16 a[0:3], a[164:167], v[32:35], a[0:3]
  ds_read_b64_tr_b16 a[184:185], v219 offset:32768
  s_waitcnt lgkmcnt(4)
  s_mov_b32 m0, s51
  v_mfma_f32_16x16x32_bf16 a[4:7], a[164:167], v[40:43], a[4:7]
  v_exp_f32 v97, v97
  v_mfma_f32_16x16x32_bf16 a[4:7], a[160:163], v[8:11], a[4:7]
  ds_read_b64_tr_b16 a[186:187], v219 offset:36864
  v_cvt_pk_bf16_f32 v96, v96, v97
  v_mfma_f32_16x16x32_bf16 a[8:11], a[160:163], v[16:19], a[8:11]
  v_exp_f32 v98, v98
  v_mfma_f32_16x16x32_bf16 a[8:11], a[164:167], v[48:51], a[8:11]
  ds_read_b64_tr_b16 a[188:189], v219 offset:40960
  buffer_load_dwordx4 v210, s[4:7], s100 offen lds
  s_add_u32 s100, s100, 20480
  s_add_u32 s51, s51, 512
  v_mfma_f32_16x16x32_bf16 a[12:15], a[164:167], v[56:59], a[12:15]
  v_exp_f32 v99, v99
  v_mfma_f32_16x16x32_bf16 a[12:15], a[160:163], v[24:27], a[12:15]
  ds_read_b64_tr_b16 a[190:191], v219 offset:45056
  v_cvt_pk_bf16_f32 v97, v98, v99
  v_mfma_f32_16x16x32_bf16 a[16:19], a[168:171], v[0:3], a[16:19]
  v_exp_f32 v104, v104
  v_mfma_f32_16x16x32_bf16 a[16:19], a[172:175], v[32:35], a[16:19]
  ds_read_b64_tr_b16 a[160:161], v220 offset:32768
  v_lshrrev_b32 v224, 4, v242
  v_mfma_f32_16x16x32_bf16 a[20:23], a[172:175], v[40:43], a[20:23]
  v_exp_f32 v105, v105
  v_mfma_f32_16x16x32_bf16 a[20:23], a[168:171], v[8:11], a[20:23]
  ds_read_b64_tr_b16 a[162:163], v220 offset:36864
  v_cvt_pk_bf16_f32 v104, v104, v105
  v_mfma_f32_16x16x32_bf16 a[24:27], a[168:171], v[16:19], a[24:27]
  v_exp_f32 v106, v106
  v_mfma_f32_16x16x32_bf16 a[24:27], a[172:175], v[48:51], a[24:27]
  ds_read_b64_tr_b16 a[164:165], v220 offset:40960
  v_bfe_u32 v225, v224, 2, 1
  v_mfma_f32_16x16x32_bf16 a[28:31], a[172:175], v[56:59], a[28:31]
  s_waitcnt lgkmcnt(7)
  v_exp_f32 v107, v107
  v_mfma_f32_16x16x32_bf16 a[28:31], a[168:171], v[24:27], a[28:31]
  ds_read_b64_tr_b16 a[166:167], v220 offset:45056
  v_cvt_pk_bf16_f32 v105, v106, v107
  v_mfma_f32_16x16x32_bf16 a[32:35], a[176:179], v[0:3], a[32:35]
  v_exp_f32 v112, v112
  v_mfma_f32_16x16x32_bf16 a[32:35], a[180:183], v[32:35], a[32:35]
  ds_read_b64_tr_b16 a[168:169], v221 offset:32768
  v_lshlrev_b32 v225, 8, v225
  v_mfma_f32_16x16x32_bf16 a[36:39], a[180:183], v[40:43], a[36:39]
  v_exp_f32 v113, v113
  v_mfma_f32_16x16x32_bf16 a[36:39], a[176:179], v[8:11], a[36:39]
  ds_read_b64_tr_b16 a[170:171], v221 offset:36864
  v_cvt_pk_bf16_f32 v112, v112, v113
  v_mfma_f32_16x16x32_bf16 a[40:43], a[176:179], v[16:19], a[40:43]
  v_exp_f32 v114, v114
  v_mfma_f32_16x16x32_bf16 a[40:43], a[180:183], v[48:51], a[40:43]
  ds_read_b64_tr_b16 a[172:173], v221 offset:40960
  v_lshrrev_b32 v226, 3, v224
  v_mfma_f32_16x16x32_bf16 a[44:47], a[180:183], v[56:59], a[44:47]
  s_waitcnt lgkmcnt(7)
  v_exp_f32 v115, v115
  v_mfma_f32_16x16x32_bf16 a[44:47], a[176:179], v[24:27], a[44:47]
  ds_read_b64_tr_b16 a[174:175], v221 offset:45056
  v_cvt_pk_bf16_f32 v113, v114, v115
  v_mfma_f32_16x16x32_bf16 a[48:51], a[184:187], v[0:3], a[48:51]
  v_exp_f32 v120, v120
  v_mfma_f32_16x16x32_bf16 a[48:51], a[188:191], v[32:35], a[48:51]
  ds_read_b64_tr_b16 a[176:177], v222 offset:32768
  v_lshl_add_u32 v225, v226, 4, v225
  v_mfma_f32_16x16x32_bf16 a[52:55], a[188:191], v[40:43], a[52:55]
  v_exp_f32 v121, v121
  v_mfma_f32_16x16x32_bf16 a[52:55], a[184:187], v[8:11], a[52:55]
  ds_read_b64_tr_b16 a[178:179], v222 offset:36864
  v_cvt_pk_bf16_f32 v120, v120, v121
  v_mfma_f32_16x16x32_bf16 a[56:59], a[184:187], v[16:19], a[56:59]
  v_exp_f32 v122, v122
  v_mfma_f32_16x16x32_bf16 a[56:59], a[188:191], v[48:51], a[56:59]
  ds_read_b64_tr_b16 a[180:181], v222 offset:40960
  v_and_b32 v227, 3, v224
  v_mfma_f32_16x16x32_bf16 a[60:63], a[188:191], v[56:59], a[60:63]
  s_waitcnt lgkmcnt(7)
  v_exp_f32 v123, v123
  v_mfma_f32_16x16x32_bf16 a[60:63], a[184:187], v[24:27], a[60:63]
  ds_read_b64_tr_b16 a[182:183], v222 offset:45056
  v_cvt_pk_bf16_f32 v121, v122, v123
  v_mfma_f32_16x16x32_bf16 a[64:67], a[160:163], v[0:3], a[64:67]
  v_exp_f32 v100, v100
  v_mfma_f32_16x16x32_bf16 a[64:67], a[164:167], v[32:35], a[64:67]
  ds_read_b64_tr_b16 a[184:185], v223 offset:32768
  v_lshl_add_u32 v225, v227, 2, v225
  v_mfma_f32_16x16x32_bf16 a[68:71], a[164:167], v[40:43], a[68:71]
  v_exp_f32 v101, v101
  v_mfma_f32_16x16x32_bf16 a[68:71], a[160:163], v[8:11], a[68:71]
  ds_read_b64_tr_b16 a[186:187], v223 offset:36864
  v_cvt_pk_bf16_f32 v98, v100, v101
  v_mfma_f32_16x16x32_bf16 a[72:75], a[160:163], v[16:19], a[72:75]
  v_exp_f32 v102, v102
  v_mfma_f32_16x16x32_bf16 a[72:75], a[164:167], v[48:51], a[72:75]
  ds_read_b64_tr_b16 a[188:189], v223 offset:40960
  v_add_u32 v225, 159744, v225
  v_mfma_f32_16x16x32_bf16 a[76:79], a[164:167], v[56:59], a[76:79]
  s_waitcnt lgkmcnt(7)
  v_exp_f32 v103, v103
  v_mfma_f32_16x16x32_bf16 a[76:79], a[160:163], v[24:27], a[76:79]
  ds_read_b64_tr_b16 a[190:191], v223 offset:45056
  v_cvt_pk_bf16_f32 v99, v102, v103
  v_mfma_f32_16x16x32_bf16 a[80:83], a[168:171], v[0:3], a[80:83]
  s_waitcnt vmcnt(9)
  v_exp_f32 v108, v108
  v_mfma_f32_16x16x32_bf16 a[80:83], a[172:175], v[32:35], a[80:83]
  v_mfma_f32_16x16x32_bf16 a[84:87], a[172:175], v[40:43], a[84:87]
  s_barrier
  v_exp_f32 v109, v109
  v_mfma_f32_16x16x32_bf16 a[84:87], a[168:171], v[8:11], a[84:87]
  ds_read_b128 a[128:131], v212 offset:0
  v_cvt_pk_bf16_f32 v106, v108, v109
  v_mfma_f32_16x16x32_bf16 a[88:91], a[168:171], v[16:19], a[88:91]
  v_exp_f32 v110, v110
  v_mfma_f32_16x16x32_bf16 a[88:91], a[172:175], v[48:51], a[88:91]
  ds_read_b128 a[132:135], v213 offset:0
  ds_read_b32 v228, v225 offset:0
  v_mfma_f32_16x16x32_bf16 a[92:95], a[172:175], v[56:59], a[92:95]
  s_waitcnt lgkmcnt(7)
  v_exp_f32 v111, v111
  v_mfma_f32_16x16x32_bf16 a[92:95], a[168:171], v[24:27], a[92:95]
  ds_read_b128 a[136:139], v214 offset:0
  v_cvt_pk_bf16_f32 v107, v110, v111
  v_mfma_f32_16x16x32_bf16 a[96:99], a[176:179], v[0:3], a[96:99]
  v_exp_f32 v116, v116
  v_mfma_f32_16x16x32_bf16 a[96:99], a[180:183], v[32:35], a[96:99]
  ds_read_b128 a[140:143], v215 offset:0
  ds_read_b32 v229, v225 offset:1024
  v_mfma_f32_16x16x32_bf16 a[100:103], a[180:183], v[40:43], a[100:103]
  v_exp_f32 v117, v117
  v_mfma_f32_16x16x32_bf16 a[100:103], a[176:179], v[8:11], a[100:103]
  ds_read_b32 v230, v225 offset:2048
  v_cvt_pk_bf16_f32 v114, v116, v117
  v_mfma_f32_16x16x32_bf16 a[104:107], a[176:179], v[16:19], a[104:107]
  v_exp_f32 v118, v118
  v_mfma_f32_16x16x32_bf16 a[104:107], a[180:183], v[48:51], a[104:107]
  ds_read_b32 v231, v225 offset:3072
  ds_read_b32 v238, v225 offset:512
  v_mfma_f32_16x16x32_bf16 a[108:111], a[180:183], v[56:59], a[108:111]
  s_waitcnt lgkmcnt(9)
  v_exp_f32 v119, v119
  v_mfma_f32_16x16x32_bf16 a[108:111], a[176:179], v[24:27], a[108:111]
  ds_read_b32 v239, v225 offset:1536
  v_cvt_pk_bf16_f32 v115, v118, v119
  v_mfma_f32_16x16x32_bf16 a[112:115], a[184:187], v[0:3], a[112:115]
  v_exp_f32 v124, v124
  v_mfma_f32_16x16x32_bf16 a[112:115], a[188:191], v[32:35], a[112:115]
  ds_read_b32 v240, v225 offset:2560
  ds_read_b32 v241, v225 offset:3584
  s_cmp_eq_u32 s3, 0
  s_cselect_b32 s35, 0, 1073741824
  v_mfma_f32_16x16x32_bf16 a[116:119], a[188:191], v[40:43], a[116:119]
  v_exp_f32 v125, v125
  v_mfma_f32_16x16x32_bf16 a[116:119], a[184:187], v[8:11], a[116:119]
  v_cvt_pk_bf16_f32 v122, v124, v125
  v_mul_u32_u24 v226, 0xd80, v226
  v_mfma_f32_16x16x32_bf16 a[120:123], a[184:187], v[16:19], a[120:123]
  v_exp_f32 v126, v126
  v_mfma_f32_16x16x32_bf16 a[120:123], a[188:191], v[48:51], a[120:123]
  v_and_b32 v227, 7, v224
  v_lshl_add_u32 v226, v227, 1, v226
  v_mfma_f32_16x16x32_bf16 a[124:127], a[188:191], v[56:59], a[124:127]
  s_waitcnt lgkmcnt(7)
  v_exp_f32 v127, v127
  v_mfma_f32_16x16x32_bf16 a[124:127], a[184:187], v[24:27], a[124:127]
  v_cvt_pk_bf16_f32 v123, v126, v127
  v_and_b32 v227, 1, v224
  v_lshl_add_u32 v226, v227, 30, v226
  v_or_b32 v226, s35, v226
  v_min_u32 v249, 1, v224
  v_lshlrev_b32 v249, 30, v249
  v_or_b32 v249, s35, v249
  v_mov_b32 v251, v249
  v_mov_b32 v250, 1
  s_mov_b32 s47, 2818048
  s_lshl_b32 s35, s33, 4
  s_add_u32 s35, s35, 2633728
  s_waitcnt lgkmcnt(0)
  v_add_f32 v228, v228, v229
  v_add_f32 v238, v238, v239
  v_add_f32 v230, v230, v231
  v_add_f32 v240, v240, v241
  v_add_f32 v228, v228, v230
  v_add_f32 v238, v238, v240
  v_cvt_pk_bf16_f32 v228, v228, v228
  v_cvt_pk_bf16_f32 v238, v238, v238
  v_lshlrev_b32 v228, 16, v228
  v_lshlrev_b32 v238, 16, v238
  v_mul_f32 v229, 0xbfb8aa3b, v228
  v_exp_f32 v229, v229
  s_nop 0
  v_add_f32 v229, 1.0, v229
  v_rcp_f32 v229, v229
  s_nop 0
  v_mul_f32 v228, v228, v229
  v_cvt_pk_bf16_f32 v228, v228, v228
  v_lshlrev_b32 v228, 16, v228
  v_mul_f32 v228, v228, v238
  s_nop 1
  v_mov_b32_dpp v229, v228 quad_perm:[1,0,3,2] row_mask:0xf bank_mask:0xf
  v_cvt_pk_bf16_f32 v228, v228, v229
  buffer_store_dword v228, v226, s[24:27], s35 offen sc1
  s_mov_b32 s32, 5
attn_loop:
  v_mfma_f32_16x16x32_bf16 v[0:3], a[128:131], v[128:131], v[192:195]
  s_add_u32 m0, s28, 81920
  v_mfma_f32_16x16x32_bf16 v[0:3], a[132:135], v[132:135], v[0:3]
  ds_read_b128 a[144:147], v212 offset:4096
  v_mfma_f32_16x16x32_bf16 v[0:3], a[136:139], v[136:139], v[0:3]
  buffer_load_dwordx4 v236, s[16:19], s29 offen offset:0 lds
  v_mfma_f32_16x16x32_bf16 v[0:3], a[140:143], v[140:143], v[0:3]
  ds_read_b128 a[148:151], v213 offset:4096
  v_mfma_f32_16x16x32_bf16 v[8:11], a[140:143], v[156:159], v[196:199]
  v_mfma_f32_16x16x32_bf16 v[8:11], a[136:139], v[152:155], v[8:11]
  ds_read_b128 a[152:155], v214 offset:4096
  v_mfma_f32_16x16x32_bf16 v[8:11], a[132:135], v[148:151], v[8:11]
  buffer_load_dwordx4 v237, s[16:19], s29 offen offset:1024 lds
  v_mfma_f32_16x16x32_bf16 v[8:11], a[128:131], v[144:147], v[8:11]
  ds_read_b128 a[156:159], v215 offset:4096
  v_mfma_f32_16x16x32_bf16 v[16:19], a[128:131], v[160:163], v[200:203]
  v_exp_f32 v0, v0
  v_mfma_f32_16x16x32_bf16 v[16:19], a[132:135], v[164:167], v[16:19]
  v_mfma_f32_16x16x32_bf16 v[16:19], a[136:139], v[168:171], v[16:19]
  v_exp_f32 v1, v1
  v_mfma_f32_16x16x32_bf16 v[16:19], a[140:143], v[172:175], v[16:19]
  v_cvt_pk_bf16_f32 v0, v0, v1
  v_mfma_f32_16x16x32_bf16 v[24:27], a[140:143], v[188:191], v[204:207]
  v_exp_f32 v2, v2
  v_mfma_f32_16x16x32_bf16 v[24:27], a[136:139], v[184:187], v[24:27]
  buffer_load_dwordx4 v236, s[16:19], s29 offen offset:2048 lds
  v_mfma_f32_16x16x32_bf16 v[24:27], a[132:135], v[180:183], v[24:27]
  s_waitcnt lgkmcnt(0)
  v_exp_f32 v3, v3
  v_mfma_f32_16x16x32_bf16 v[24:27], a[128:131], v[176:179], v[24:27]
  v_cvt_pk_bf16_f32 v1, v2, v3
  v_mfma_f32_16x16x32_bf16 v[4:7], a[144:147], v[128:131], v[192:195]
  v_exp_f32 v8, v8
  v_mfma_f32_16x16x32_bf16 v[4:7], a[148:151], v[132:135], v[4:7]
  ds_read_b128 a[128:131], v212 offset:8192
  v_mfma_f32_16x16x32_bf16 v[4:7], a[152:155], v[136:139], v[4:7]
  v_exp_f32 v9, v9
  v_mfma_f32_16x16x32_bf16 v[4:7], a[156:159], v[140:143], v[4:7]
  ds_read_b128 a[132:135], v213 offset:8192
  v_cvt_pk_bf16_f32 v8, v8, v9
  v_mfma_f32_16x16x32_bf16 v[12:15], a[156:159], v[156:159], v[196:199]
  v_exp_f32 v10, v10
  v_mfma_f32_16x16x32_bf16 v[12:15], a[152:155], v[152:155], v[12:15]
  ds_read_b128 a[136:139], v214 offset:8192
  v_mfma_f32_16x16x32_bf16 v[12:15], a[148:151], v[148:151], v[12:15]
  v_exp_f32 v11, v11
  v_mfma_f32_16x16x32_bf16 v[12:15], a[144:147], v[144:147], v[12:15]
  ds_read_b128 a[140:143], v215 offset:8192
  v_cvt_pk_bf16_f32 v9, v10, v11
  v_mfma_f32_16x16x32_bf16 v[20:23], a[144:147], v[160:163], v[200:203]
  v_exp_f32 v16, v16
  v_mfma_f32_16x16x32_bf16 v[20:23], a[148:151], v[164:167], v[20:23]
  buffer_load_dwordx4 v237, s[16:19], s29 offen offset:3072 lds
  v_mfma_f32_16x16x32_bf16 v[20:23], a[152:155], v[168:171], v[20:23]
  s_add_u32 s29, s29, 16384
  v_exp_f32 v17, v17
  v_mfma_f32_16x16x32_bf16 v[20:23], a[156:159], v[172:175], v[20:23]
  v_cvt_pk_bf16_f32 v16, v16, v17
  v_mfma_f32_16x16x32_bf16 v[28:31], a[156:159], v[188:191], v[204:207]
  s_add_u32 m0, s28, 32768
  v_exp_f32 v18, v18
  v_mfma_f32_16x16x32_bf16 v[28:31], a[152:155], v[184:187], v[28:31]
  buffer_load_dwordx4 v232, s[12:15], s29 offen offset:0 lds
  v_mfma_f32_16x16x32_bf16 v[28:31], a[148:151], v[180:183], v[28:31]
  s_waitcnt lgkmcnt(0)
  v_exp_f32 v19, v19
  v_mfma_f32_16x16x32_bf16 v[28:31], a[144:147], v[176:179], v[28:31]
  v_cvt_pk_bf16_f32 v17, v18, v19
  v_mfma_f32_16x16x32_bf16 v[32:35], a[128:131], v[128:131], v[192:195]
  v_exp_f32 v24, v24
  v_mfma_f32_16x16x32_bf16 v[32:35], a[132:135], v[132:135], v[32:35]
  ds_read_b128 a[144:147], v212 offset:12288
  v_mfma_f32_16x16x32_bf16 v[32:35], a[136:139], v[136:139], v[32:35]
  v_exp_f32 v25, v25
  v_mfma_f32_16x16x32_bf16 v[32:35], a[140:143], v[140:143], v[32:35]
  ds_read_b128 a[148:151], v213 offset:12288
  v_cvt_pk_bf16_f32 v24, v24, v25
  v_mfma_f32_16x16x32_bf16 v[40:43], a[140:143], v[156:159], v[196:199]
  v_exp_f32 v26, v26
  v_mfma_f32_16x16x32_bf16 v[40:43], a[136:139], v[152:155], v[40:43]
  ds_read_b128 a[152:155], v214 offset:12288
  v_mfma_f32_16x16x32_bf16 v[40:43], a[132:135], v[148:151], v[40:43]
  v_exp_f32 v27, v27
  v_mfma_f32_16x16x32_bf16 v[40:43], a[128:131], v[144:147], v[40:43]
  ds_read_b128 a[156:159], v215 offset:12288
  v_cvt_pk_bf16_f32 v25, v26, v27
  v_mfma_f32_16x16x32_bf16 v[48:51], a[128:131], v[160:163], v[200:203]
  v_exp_f32 v4, v4
  v_mfma_f32_16x16x32_bf16 v[48:51], a[132:135], v[164:167], v[48:51]
  buffer_load_dwordx4 v233, s[12:15], s29 offen offset:1024 lds
  v_mfma_f32_16x16x32_bf16 v[48:51], a[136:139], v[168:171], v[48:51]
  v_exp_f32 v5, v5
  v_mfma_f32_16x16x32_bf16 v[48:51], a[140:143], v[172:175], v[48:51]
  v_cvt_pk_bf16_f32 v2, v4, v5
  v_mfma_f32_16x16x32_bf16 v[56:59], a[140:143], v[188:191], v[204:207]
  v_exp_f32 v6, v6
  v_mfma_f32_16x16x32_bf16 v[56:59], a[136:139], v[184:187], v[56:59]
  buffer_load_dwordx4 v234, s[12:15], s29 offen offset:2048 lds
  v_mfma_f32_16x16x32_bf16 v[56:59], a[132:135], v[180:183], v[56:59]
  s_waitcnt lgkmcnt(0)
  v_exp_f32 v7, v7
  v_mfma_f32_16x16x32_bf16 v[56:59], a[128:131], v[176:179], v[56:59]
  v_cvt_pk_bf16_f32 v3, v6, v7
  v_mfma_f32_16x16x32_bf16 v[36:39], a[144:147], v[128:131], v[192:195]
  v_exp_f32 v12, v12
  v_mfma_f32_16x16x32_bf16 v[36:39], a[148:151], v[132:135], v[36:39]
  ds_read_b64_tr_b16 a[160:161], v216 offset:49152
  v_mfma_f32_16x16x32_bf16 v[36:39], a[152:155], v[136:139], v[36:39]
  v_exp_f32 v13, v13
  v_mfma_f32_16x16x32_bf16 v[36:39], a[156:159], v[140:143], v[36:39]
  ds_read_b64_tr_b16 a[162:163], v216 offset:53248
  v_cvt_pk_bf16_f32 v10, v12, v13
  v_mfma_f32_16x16x32_bf16 v[44:47], a[156:159], v[156:159], v[196:199]
  v_exp_f32 v14, v14
  v_mfma_f32_16x16x32_bf16 v[44:47], a[152:155], v[152:155], v[44:47]
  ds_read_b64_tr_b16 a[164:165], v216 offset:57344
  buffer_load_dwordx4 v235, s[12:15], s29 offen offset:3072 lds
  v_mfma_f32_16x16x32_bf16 v[44:47], a[148:151], v[148:151], v[44:47]
  v_exp_f32 v15, v15
  v_mfma_f32_16x16x32_bf16 v[44:47], a[144:147], v[144:147], v[44:47]
  ds_read_b64_tr_b16 a[166:167], v216 offset:61440
  v_cvt_pk_bf16_f32 v11, v14, v15
  v_mfma_f32_16x16x32_bf16 v[52:55], a[144:147], v[160:163], v[200:203]
  s_add_u32 m0, s50, 4096
  v_exp_f32 v20, v20
  v_mfma_f32_16x16x32_bf16 v[52:55], a[148:151], v[164:167], v[52:55]
  ds_read_b64_tr_b16 a[168:169], v217 offset:49152
  buffer_load_dwordx4 v208, s[20:23], s30 offen lds
  s_add_u32 s30, s30, 32
  v_mfma_f32_16x16x32_bf16 v[52:55], a[152:155], v[168:171], v[52:55]
  v_exp_f32 v21, v21
  v_mfma_f32_16x16x32_bf16 v[52:55], a[156:159], v[172:175], v[52:55]
  ds_read_b64_tr_b16 a[170:171], v217 offset:53248
  v_cvt_pk_bf16_f32 v18, v20, v21
  v_mfma_f32_16x16x32_bf16 v[60:63], a[156:159], v[188:191], v[204:207]
  v_exp_f32 v22, v22
  v_mfma_f32_16x16x32_bf16 v[60:63], a[152:155], v[184:187], v[60:63]
  ds_read_b64_tr_b16 a[172:173], v217 offset:57344
  v_mfma_f32_16x16x32_bf16 v[60:63], a[148:151], v[180:183], v[60:63]
  v_exp_f32 v23, v23
  v_mfma_f32_16x16x32_bf16 v[60:63], a[144:147], v[176:179], v[60:63]
  ds_read_b64_tr_b16 a[174:175], v217 offset:61440
  v_cvt_pk_bf16_f32 v19, v22, v23
  v_mfma_f32_16x16x32_bf16 a[192:195], a[208:211], v[64:67], a[192:195]
  v_exp_f32 v28, v28
  v_mfma_f32_16x16x32_bf16 a[192:195], a[208:211], v[96:99], a[192:195]
  ds_read_b64_tr_b16 a[176:177], v218 offset:49152
  v_mfma_f32_16x16x32_bf16 a[196:199], a[208:211], v[72:75], a[196:199]
  v_exp_f32 v29, v29
  v_mfma_f32_16x16x32_bf16 a[196:199], a[208:211], v[104:107], a[196:199]
  ds_read_b64_tr_b16 a[178:179], v218 offset:53248
  v_cvt_pk_bf16_f32 v26, v28, v29
  v_mfma_f32_16x16x32_bf16 a[200:203], a[208:211], v[80:83], a[200:203]
  v_exp_f32 v30, v30
  v_mfma_f32_16x16x32_bf16 a[200:203], a[208:211], v[112:115], a[200:203]
  ds_read_b64_tr_b16 a[180:181], v218 offset:57344
  v_mfma_f32_16x16x32_bf16 a[204:207], a[208:211], v[88:91], a[204:207]
  s_waitcnt lgkmcnt(7)
  v_exp_f32 v31, v31
  v_mfma_f32_16x16x32_bf16 a[204:207], a[208:211], v[120:123], a[204:207]
  ds_read_b64_tr_b16 a[182:183], v218 offset:61440
  v_cvt_pk_bf16_f32 v27, v30, v31
  v_mfma_f32_16x16x32_bf16 a[0:3], a[160:163], v[64:67], a[0:3]
  v_exp_f32 v32, v32
  v_mfma_f32_16x16x32_bf16 a[0:3], a[164:167], v[96:99], a[0:3]
  ds_read_b64_tr_b16 a[184:185], v219 offset:49152
  v_mfma_f32_16x16x32_bf16 a[4:7], a[164:167], v[104:107], a[4:7]
  v_exp_f32 v33, v33
  v_mfma_f32_16x16x32_bf16 a[4:7], a[160:163], v[72:75], a[4:7]
  ds_read_b64_tr_b16 a[186:187], v219 offset:53248
  v_cvt_pk_bf16_f32 v32, v32, v33
  v_mfma_f32_16x16x32_bf16 a[8:11], a[160:163], v[80:83], a[8:11]
  v_exp_f32 v34, v34
  v_mfma_f32_16x16x32_bf16 a[8:11], a[164:167], v[112:115], a[8:11]
  ds_read_b64_tr_b16 a[188:189], v219 offset:57344
  v_mfma_f32_16x16x32_bf16 a[12:15], a[164:167], v[120:123], a[12:15]
  s_waitcnt lgkmcnt(7)
  v_exp_f32 v35, v35
  v_mfma_f32_16x16x32_bf16 a[12:15], a[160:163], v[88:91], a[12:15]
  ds_read_b64_tr_b16 a[190:191], v219 offset:61440
  v_cvt_pk_bf16_f32 v33, v34, v35
  v_mfma_f32_16x16x32_bf16 a[16:19], a[168:171], v[64:67], a[16:19]
  v_exp_f32 v40, v40
  v_mfma_f32_16x16x32_bf16 a[16:19], a[172:175], v[96:99], a[16:19]
  ds_read_b64_tr_b16 a[160:161], v220 offset:49152
  v_mfma_f32_16x16x32_bf16 a[20:23], a[172:175], v[104:107], a[20:23]
  v_exp_f32 v41, v41
  v_mfma_f32_16x16x32_bf16 a[20:23], a[168:171], v[72:75], a[20:23]
  ds_read_b64_tr_b16 a[162:163], v220 offset:53248
  v_cvt_pk_bf16_f32 v40, v40, v41
  v_mfma_f32_16x16x32_bf16 a[24:27], a[168:171], v[80:83], a[24:27]
  v_exp_f32 v42, v42
  v_mfma_f32_16x16x32_bf16 a[24:27], a[172:175], v[112:115], a[24:27]
  ds_read_b64_tr_b16 a[164:165], v220 offset:57344
  v_mfma_f32_16x16x32_bf16 a[28:31], a[172:175], v[120:123], a[28:31]
  s_waitcnt lgkmcnt(7)
  v_exp_f32 v43, v43
  v_mfma_f32_16x16x32_bf16 a[28:31], a[168:171], v[88:91], a[28:31]
  ds_read_b64_tr_b16 a[166:167], v220 offset:61440
  v_cvt_pk_bf16_f32 v41, v42, v43
  v_mfma_f32_16x16x32_bf16 a[32:35], a[176:179], v[64:67], a[32:35]
  v_exp_f32 v48, v48
  v_mfma_f32_16x16x32_bf16 a[32:35], a[180:183], v[96:99], a[32:35]
  ds_read_b64_tr_b16 a[168:169], v221 offset:49152
  v_mfma_f32_16x16x32_bf16 a[36:39], a[180:183], v[104:107], a[36:39]
  v_exp_f32 v49, v49
  v_mfma_f32_16x16x32_bf16 a[36:39], a[176:179], v[72:75], a[36:39]
  ds_read_b64_tr_b16 a[170:171], v221 offset:53248
  v_cvt_pk_bf16_f32 v48, v48, v49
  v_mfma_f32_16x16x32_bf16 a[40:43], a[176:179], v[80:83], a[40:43]
  v_exp_f32 v50, v50
  v_mfma_f32_16x16x32_bf16 a[40:43], a[180:183], v[112:115], a[40:43]
  ds_read_b64_tr_b16 a[172:173], v221 offset:57344
  v_mfma_f32_16x16x32_bf16 a[44:47], a[180:183], v[120:123], a[44:47]
  s_waitcnt lgkmcnt(7)
  v_exp_f32 v51, v51
  v_mfma_f32_16x16x32_bf16 a[44:47], a[176:179], v[88:91], a[44:47]
  ds_read_b64_tr_b16 a[174:175], v221 offset:61440
  v_cvt_pk_bf16_f32 v49, v50, v51
  v_mfma_f32_16x16x32_bf16 a[48:51], a[184:187], v[64:67], a[48:51]
  v_exp_f32 v56, v56
  v_mfma_f32_16x16x32_bf16 a[48:51], a[188:191], v[96:99], a[48:51]
  ds_read_b64_tr_b16 a[176:177], v222 offset:49152
  v_mfma_f32_16x16x32_bf16 a[52:55], a[188:191], v[104:107], a[52:55]
  v_exp_f32 v57, v57
  v_mfma_f32_16x16x32_bf16 a[52:55], a[184:187], v[72:75], a[52:55]
  ds_read_b64_tr_b16 a[178:179], v222 offset:53248
  v_cvt_pk_bf16_f32 v56, v56, v57
  v_mfma_f32_16x16x32_bf16 a[56:59], a[184:187], v[80:83], a[56:59]
  v_exp_f32 v58, v58
  v_mfma_f32_16x16x32_bf16 a[56:59], a[188:191], v[112:115], a[56:59]
  ds_read_b64_tr_b16 a[180:181], v222 offset:57344
  global_load_dword v255, v252, s[8:9]
  v_mfma_f32_16x16x32_bf16 a[60:63], a[188:191], v[120:123], a[60:63]
  s_waitcnt lgkmcnt(7)
  v_exp_f32 v59, v59
  v_mfma_f32_16x16x32_bf16 a[60:63], a[184:187], v[88:91], a[60:63]
  ds_read_b64_tr_b16 a[182:183], v222 offset:61440
  v_cvt_pk_bf16_f32 v57, v58, v59
  v_mfma_f32_16x16x32_bf16 a[64:67], a[160:163], v[64:67], a[64:67]
  v_exp_f32 v36, v36
  v_mfma_f32_16x16x32_bf16 a[64:67], a[164:167], v[96:99], a[64:67]
  ds_read_b64_tr_b16 a[184:185], v223 offset:49152
  v_mfma_f32_16x16x32_bf16 a[68:71], a[164:167], v[104:107], a[68:71]
  v_exp_f32 v37, v37
  v_mfma_f32_16x16x32_bf16 a[68:71], a[160:163], v[72:75], a[68:71]
  ds_read_b64_tr_b16 a[186:187], v223 offset:53248
  v_cvt_pk_bf16_f32 v34, v36, v37
  v_mfma_f32_16x16x32_bf16 a[72:75], a[160:163], v[80:83], a[72:75]
  v_exp_f32 v38, v38
  v_mfma_f32_16x16x32_bf16 a[72:75], a[164:167], v[112:115], a[72:75]
  ds_read_b64_tr_b16 a[188:189], v223 offset:57344
  v_mfma_f32_16x16x32_bf16 a[76:79], a[164:167], v[120:123], a[76:79]
  s_waitcnt lgkmcnt(7)
  v_exp_f32 v39, v39
  v_mfma_f32_16x16x32_bf16 a[76:79], a[160:163], v[88:91], a[76:79]
  ds_read_b64_tr_b16 a[190:191], v223 offset:61440
  v_cvt_pk_bf16_f32 v35, v38, v39
  v_mfma_f32_16x16x32_bf16 a[80:83], a[168:171], v[64:67], a[80:83]
  s_waitcnt vmcnt(12)
  v_exp_f32 v44, v44
  v_mfma_f32_16x16x32_bf16 a[80:83], a[172:175], v[96:99], a[80:83]
  v_mfma_f32_16x16x32_bf16 a[84:87], a[172:175], v[104:107], a[84:87]
  s_barrier
  v_exp_f32 v45, v45
  v_mfma_f32_16x16x32_bf16 a[84:87], a[168:171], v[72:75], a[84:87]
  ds_read_b128 a[128:131], v212 offset:16384
  v_cvt_pk_bf16_f32 v42, v44, v45
  v_mfma_f32_16x16x32_bf16 a[88:91], a[168:171], v[80:83], a[88:91]
  v_exp_f32 v46, v46
  v_mfma_f32_16x16x32_bf16 a[88:91], a[172:175], v[112:115], a[88:91]
  ds_read_b128 a[132:135], v213 offset:16384
  v_mfma_f32_16x16x32_bf16 a[92:95], a[172:175], v[120:123], a[92:95]
  s_waitcnt lgkmcnt(6)
  v_exp_f32 v47, v47
  v_mfma_f32_16x16x32_bf16 a[92:95], a[168:171], v[88:91], a[92:95]
  ds_read_b128 a[136:139], v214 offset:16384
  v_cvt_pk_bf16_f32 v43, v46, v47
  v_mfma_f32_16x16x32_bf16 a[96:99], a[176:179], v[64:67], a[96:99]
  v_exp_f32 v52, v52
  v_mfma_f32_16x16x32_bf16 a[96:99], a[180:183], v[96:99], a[96:99]
  ds_read_b128 a[140:143], v215 offset:16384
  v_mfma_f32_16x16x32_bf16 a[100:103], a[180:183], v[104:107], a[100:103]
  v_exp_f32 v53, v53
  v_mfma_f32_16x16x32_bf16 a[100:103], a[176:179], v[72:75], a[100:103]
  v_cvt_pk_bf16_f32 v50, v52, v53
  v_mfma_f32_16x16x32_bf16 a[104:107], a[176:179], v[80:83], a[104:107]
  v_exp_f32 v54, v54
  v_mfma_f32_16x16x32_bf16 a[104:107], a[180:183], v[112:115], a[104:107]
  v_mfma_f32_16x16x32_bf16 a[108:111], a[180:183], v[120:123], a[108:111]
  s_waitcnt lgkmcnt(4)
  v_exp_f32 v55, v55
  v_mfma_f32_16x16x32_bf16 a[108:111], a[176:179], v[88:91], a[108:111]
  v_cvt_pk_bf16_f32 v51, v54, v55
  v_mfma_f32_16x16x32_bf16 a[112:115], a[184:187], v[64:67], a[112:115]
  v_exp_f32 v60, v60
  v_mfma_f32_16x16x32_bf16 a[112:115], a[188:191], v[96:99], a[112:115]
  v_mfma_f32_16x16x32_bf16 a[116:119], a[188:191], v[104:107], a[116:119]
  v_exp_f32 v61, v61
  v_mfma_f32_16x16x32_bf16 a[116:119], a[184:187], v[72:75], a[116:119]
  v_cvt_pk_bf16_f32 v58, v60, v61
  v_mfma_f32_16x16x32_bf16 a[120:123], a[184:187], v[80:83], a[120:123]
  v_exp_f32 v62, v62
  v_mfma_f32_16x16x32_bf16 a[120:123], a[188:191], v[112:115], a[120:123]
  v_mfma_f32_16x16x32_bf16 a[124:127], a[188:191], v[120:123], a[124:127]
  s_waitcnt lgkmcnt(0)
  v_exp_f32 v63, v63
  v_mfma_f32_16x16x32_bf16 a[124:127], a[184:187], v[88:91], a[124:127]
  v_cvt_pk_bf16_f32 v59, v62, v63
  v_mfma_f32_16x16x32_bf16 v[64:67], a[128:131], v[128:131], v[192:195]
  s_add_u32 m0, s28, 98304
  v_mfma_f32_16x16x32_bf16 v[64:67], a[132:135], v[132:135], v[64:67]
  ds_read_b128 a[144:147], v212 offset:20480
  v_mfma_f32_16x16x32_bf16 v[64:67], a[136:139], v[136:139], v[64:67]
  buffer_load_dwordx4 v236, s[16:19], s29 offen offset:0 lds
  v_mfma_f32_16x16x32_bf16 v[64:67], a[140:143], v[140:143], v[64:67]
  ds_read_b128 a[148:151], v213 offset:20480
  v_mfma_f32_16x16x32_bf16 v[72:75], a[140:143], v[156:159], v[196:199]
  v_mfma_f32_16x16x32_bf16 v[72:75], a[136:139], v[152:155], v[72:75]
  ds_read_b128 a[152:155], v214 offset:20480
  v_mfma_f32_16x16x32_bf16 v[72:75], a[132:135], v[148:151], v[72:75]
  buffer_load_dwordx4 v237, s[16:19], s29 offen offset:1024 lds
  v_mfma_f32_16x16x32_bf16 v[72:75], a[128:131], v[144:147], v[72:75]
  ds_read_b128 a[156:159], v215 offset:20480
  v_mfma_f32_16x16x32_bf16 v[80:83], a[128:131], v[160:163], v[200:203]
  v_exp_f32 v64, v64
  v_mfma_f32_16x16x32_bf16 v[80:83], a[132:135], v[164:167], v[80:83]
  v_mfma_f32_16x16x32_bf16 v[80:83], a[136:139], v[168:171], v[80:83]
  v_exp_f32 v65, v65
  v_mfma_f32_16x16x32_bf16 v[80:83], a[140:143], v[172:175], v[80:83]
  v_cvt_pk_bf16_f32 v64, v64, v65
  v_mfma_f32_16x16x32_bf16 v[88:91], a[140:143], v[188:191], v[204:207]
  v_exp_f32 v66, v66
  v_mfma_f32_16x16x32_bf16 v[88:91], a[136:139], v[184:187], v[88:91]
  buffer_load_dwordx4 v236, s[16:19], s29 offen offset:2048 lds
  v_mfma_f32_16x16x32_bf16 v[88:91], a[132:135], v[180:183], v[88:91]
  s_waitcnt lgkmcnt(0)
  v_exp_f32 v67, v67
  v_mfma_f32_16x16x32_bf16 v[88:91], a[128:131], v[176:179], v[88:91]
  v_cvt_pk_bf16_f32 v65, v66, v67
  v_mfma_f32_16x16x32_bf16 v[68:71], a[144:147], v[128:131], v[192:195]
  v_exp_f32 v72, v72
  v_mfma_f32_16x16x32_bf16 v[68:71], a[148:151], v[132:135], v[68:71]
  ds_read_b128 a[128:131], v212 offset:24576
  v_mfma_f32_16x16x32_bf16 v[68:71], a[152:155], v[136:139], v[68:71]
  v_exp_f32 v73, v73
  v_mfma_f32_16x16x32_bf16 v[68:71], a[156:159], v[140:143], v[68:71]
  ds_read_b128 a[132:135], v213 offset:24576
  v_cvt_pk_bf16_f32 v72, v72, v73
  v_mfma_f32_16x16x32_bf16 v[76:79], a[156:159], v[156:159], v[196:199]
  v_exp_f32 v74, v74
  v_mfma_f32_16x16x32_bf16 v[76:79], a[152:155], v[152:155], v[76:79]
  ds_read_b128 a[136:139], v214 offset:24576
  v_mfma_f32_16x16x32_bf16 v[76:79], a[148:151], v[148:151], v[76:79]
  v_exp_f32 v75, v75
  v_mfma_f32_16x16x32_bf16 v[76:79], a[144:147], v[144:147], v[76:79]
  ds_read_b128 a[140:143], v215 offset:24576
  v_cvt_pk_bf16_f32 v73, v74, v75
  v_mfma_f32_16x16x32_bf16 v[84:87], a[144:147], v[160:163], v[200:203]
  v_exp_f32 v80, v80
  v_mfma_f32_16x16x32_bf16 v[84:87], a[148:151], v[164:167], v[84:87]
  buffer_load_dwordx4 v237, s[16:19], s29 offen offset:3072 lds
  v_mfma_f32_16x16x32_bf16 v[84:87], a[152:155], v[168:171], v[84:87]
  s_add_u32 s29, s29, 16384
  v_exp_f32 v81, v81
  v_mfma_f32_16x16x32_bf16 v[84:87], a[156:159], v[172:175], v[84:87]
  v_cvt_pk_bf16_f32 v80, v80, v81
  v_mfma_f32_16x16x32_bf16 v[92:95], a[156:159], v[188:191], v[204:207]
  s_add_u32 m0, s28, 49152
  v_exp_f32 v82, v82
  v_mfma_f32_16x16x32_bf16 v[92:95], a[152:155], v[184:187], v[92:95]
  buffer_load_dwordx4 v232, s[12:15], s29 offen offset:0 lds
  v_mfma_f32_16x16x32_bf16 v[92:95], a[148:151], v[180:183], v[92:95]
  s_waitcnt lgkmcnt(0)
  v_exp_f32 v83, v83
  v_mfma_f32_16x16x32_bf16 v[92:95], a[144:147], v[176:179], v[92:95]
  v_cvt_pk_bf16_f32 v81, v82, v83
  v_mfma_f32_16x16x32_bf16 v[96:99], a[128:131], v[128:131], v[192:195]
  v_exp_f32 v88, v88
  v_mfma_f32_16x16x32_bf16 v[96:99], a[132:135], v[132:135], v[96:99]
  ds_read_b128 a[144:147], v212 offset:28672
  v_mfma_f32_16x16x32_bf16 v[96:99], a[136:139], v[136:139], v[96:99]
  v_exp_f32 v89, v89
  v_mfma_f32_16x16x32_bf16 v[96:99], a[140:143], v[140:143], v[96:99]
  ds_read_b128 a[148:151], v213 offset:28672
  v_cvt_pk_bf16_f32 v88, v88, v89
  v_mfma_f32_16x16x32_bf16 v[104:107], a[140:143], v[156:159], v[196:199]
  v_exp_f32 v90, v90
  v_mfma_f32_16x16x32_bf16 v[104:107], a[136:139], v[152:155], v[104:107]
  ds_read_b128 a[152:155], v214 offset:28672
  v_mfma_f32_16x16x32_bf16 v[104:107], a[132:135], v[148:151], v[104:107]
  v_exp_f32 v91, v91
  v_mfma_f32_16x16x32_bf16 v[104:107], a[128:131], v[144:147], v[104:107]
  ds_read_b128 a[156:159], v215 offset:28672
  v_cvt_pk_bf16_f32 v89, v90, v91
  v_mfma_f32_16x16x32_bf16 v[112:115], a[128:131], v[160:163], v[200:203]
  v_exp_f32 v68, v68
  v_mfma_f32_16x16x32_bf16 v[112:115], a[132:135], v[164:167], v[112:115]
  buffer_load_dwordx4 v233, s[12:15], s29 offen offset:1024 lds
  v_mfma_f32_16x16x32_bf16 v[112:115], a[136:139], v[168:171], v[112:115]
  v_exp_f32 v69, v69
  v_mfma_f32_16x16x32_bf16 v[112:115], a[140:143], v[172:175], v[112:115]
  v_cvt_pk_bf16_f32 v66, v68, v69
  v_mfma_f32_16x16x32_bf16 v[120:123], a[140:143], v[188:191], v[204:207]
  v_exp_f32 v70, v70
  v_mfma_f32_16x16x32_bf16 v[120:123], a[136:139], v[184:187], v[120:123]
  buffer_load_dwordx4 v234, s[12:15], s29 offen offset:2048 lds
  v_mfma_f32_16x16x32_bf16 v[120:123], a[132:135], v[180:183], v[120:123]
  s_waitcnt lgkmcnt(0)
  v_exp_f32 v71, v71
  v_mfma_f32_16x16x32_bf16 v[120:123], a[128:131], v[176:179], v[120:123]
  v_cvt_pk_bf16_f32 v67, v70, v71
  v_mfma_f32_16x16x32_bf16 v[100:103], a[144:147], v[128:131], v[192:195]
  v_exp_f32 v76, v76
  v_mfma_f32_16x16x32_bf16 v[100:103], a[148:151], v[132:135], v[100:103]
  ds_read_b64_tr_b16 a[160:161], v216 offset:0
  v_mfma_f32_16x16x32_bf16 v[100:103], a[152:155], v[136:139], v[100:103]
  v_exp_f32 v77, v77
  v_mfma_f32_16x16x32_bf16 v[100:103], a[156:159], v[140:143], v[100:103]
  ds_read_b64_tr_b16 a[162:163], v216 offset:4096
  v_cvt_pk_bf16_f32 v74, v76, v77
  v_mfma_f32_16x16x32_bf16 v[108:111], a[156:159], v[156:159], v[196:199]
  v_exp_f32 v78, v78
  v_mfma_f32_16x16x32_bf16 v[108:111], a[152:155], v[152:155], v[108:111]
  ds_read_b64_tr_b16 a[164:165], v216 offset:8192
  buffer_load_dwordx4 v235, s[12:15], s29 offen offset:3072 lds
  v_mfma_f32_16x16x32_bf16 v[108:111], a[148:151], v[148:151], v[108:111]
  v_exp_f32 v79, v79
  v_mfma_f32_16x16x32_bf16 v[108:111], a[144:147], v[144:147], v[108:111]
  ds_read_b64_tr_b16 a[166:167], v216 offset:12288
  v_cvt_pk_bf16_f32 v75, v78, v79
  v_mfma_f32_16x16x32_bf16 v[116:119], a[144:147], v[160:163], v[200:203]
  s_add_u32 m0, s50, 5120
  v_exp_f32 v84, v84
  v_mfma_f32_16x16x32_bf16 v[116:119], a[148:151], v[164:167], v[116:119]
  ds_read_b64_tr_b16 a[168:169], v217 offset:0
  buffer_load_dwordx4 v208, s[20:23], s30 offen lds
  s_add_u32 s30, s30, 32
  v_mfma_f32_16x16x32_bf16 v[116:119], a[152:155], v[168:171], v[116:119]
  v_exp_f32 v85, v85
  v_mfma_f32_16x16x32_bf16 v[116:119], a[156:159], v[172:175], v[116:119]
  ds_read_b64_tr_b16 a[170:171], v217 offset:4096
  v_cvt_pk_bf16_f32 v82, v84, v85
  v_mfma_f32_16x16x32_bf16 v[124:127], a[156:159], v[188:191], v[204:207]
  v_exp_f32 v86, v86
  v_mfma_f32_16x16x32_bf16 v[124:127], a[152:155], v[184:187], v[124:127]
  ds_read_b64_tr_b16 a[172:173], v217 offset:8192
  v_mfma_f32_16x16x32_bf16 v[124:127], a[148:151], v[180:183], v[124:127]
  v_exp_f32 v87, v87
  v_mfma_f32_16x16x32_bf16 v[124:127], a[144:147], v[176:179], v[124:127]
  ds_read_b64_tr_b16 a[174:175], v217 offset:12288
  v_cvt_pk_bf16_f32 v83, v86, v87
  v_mfma_f32_16x16x32_bf16 a[192:195], a[208:211], v[0:3], a[192:195]
  v_exp_f32 v92, v92
  v_mfma_f32_16x16x32_bf16 a[192:195], a[208:211], v[32:35], a[192:195]
  ds_read_b64_tr_b16 a[176:177], v218 offset:0
  v_mfma_f32_16x16x32_bf16 a[196:199], a[208:211], v[8:11], a[196:199]
  v_exp_f32 v93, v93
  v_mfma_f32_16x16x32_bf16 a[196:199], a[208:211], v[40:43], a[196:199]
  ds_read_b64_tr_b16 a[178:179], v218 offset:4096
  v_cvt_pk_bf16_f32 v90, v92, v93
  v_mfma_f32_16x16x32_bf16 a[200:203], a[208:211], v[16:19], a[200:203]
  v_exp_f32 v94, v94
  v_mfma_f32_16x16x32_bf16 a[200:203], a[208:211], v[48:51], a[200:203]
  ds_read_b64_tr_b16 a[180:181], v218 offset:8192
  v_mfma_f32_16x16x32_bf16 a[204:207], a[208:211], v[24:27], a[204:207]
  s_waitcnt lgkmcnt(7)
  v_exp_f32 v95, v95
  v_mfma_f32_16x16x32_bf16 a[204:207], a[208:211], v[56:59], a[204:207]
  ds_read_b64_tr_b16 a[182:183], v218 offset:12288
  v_cvt_pk_bf16_f32 v91, v94, v95
  v_mfma_f32_16x16x32_bf16 a[0:3], a[160:163], v[0:3], a[0:3]
  v_exp_f32 v96, v96
  v_mfma_f32_16x16x32_bf16 a[0:3], a[164:167], v[32:35], a[0:3]
  ds_read_b64_tr_b16 a[184:185], v219 offset:0
  v_mfma_f32_16x16x32_bf16 a[4:7], a[164:167], v[40:43], a[4:7]
  v_exp_f32 v97, v97
  v_mfma_f32_16x16x32_bf16 a[4:7], a[160:163], v[8:11], a[4:7]
  ds_read_b64_tr_b16 a[186:187], v219 offset:4096
  v_cvt_pk_bf16_f32 v96, v96, v97
  v_mfma_f32_16x16x32_bf16 a[8:11], a[160:163], v[16:19], a[8:11]
  v_exp_f32 v98, v98
  v_mfma_f32_16x16x32_bf16 a[8:11], a[164:167], v[48:51], a[8:11]
  ds_read_b64_tr_b16 a[188:189], v219 offset:8192
  v_mfma_f32_16x16x32_bf16 a[12:15], a[164:167], v[56:59], a[12:15]
  s_waitcnt lgkmcnt(7)
  v_exp_f32 v99, v99
  v_mfma_f32_16x16x32_bf16 a[12:15], a[160:163], v[24:27], a[12:15]
  ds_read_b64_tr_b16 a[190:191], v219 offset:12288
  v_cvt_pk_bf16_f32 v97, v98, v99
  v_mfma_f32_16x16x32_bf16 a[16:19], a[168:171], v[0:3], a[16:19]
  v_exp_f32 v104, v104
  v_mfma_f32_16x16x32_bf16 a[16:19], a[172:175], v[32:35], a[16:19]
  ds_read_b64_tr_b16 a[160:161], v220 offset:0
  v_mfma_f32_16x16x32_bf16 a[20:23], a[172:175], v[40:43], a[20:23]
  v_exp_f32 v105, v105
  v_mfma_f32_16x16x32_bf16 a[20:23], a[168:171], v[8:11], a[20:23]
  ds_read_b64_tr_b16 a[162:163], v220 offset:4096
  v_cvt_pk_bf16_f32 v104, v104, v105
  v_mfma_f32_16x16x32_bf16 a[24:27], a[168:171], v[16:19], a[24:27]
  v_exp_f32 v106, v106
  v_mfma_f32_16x16x32_bf16 a[24:27], a[172:175], v[48:51], a[24:27]
  ds_read_b64_tr_b16 a[164:165], v220 offset:8192
  v_mfma_f32_16x16x32_bf16 a[28:31], a[172:175], v[56:59], a[28:31]
  s_waitcnt lgkmcnt(7)
  v_exp_f32 v107, v107
  v_mfma_f32_16x16x32_bf16 a[28:31], a[168:171], v[24:27], a[28:31]
  ds_read_b64_tr_b16 a[166:167], v220 offset:12288
  v_cvt_pk_bf16_f32 v105, v106, v107
  v_mfma_f32_16x16x32_bf16 a[32:35], a[176:179], v[0:3], a[32:35]
  v_exp_f32 v112, v112
  v_mfma_f32_16x16x32_bf16 a[32:35], a[180:183], v[32:35], a[32:35]
  ds_read_b64_tr_b16 a[168:169], v221 offset:0
  v_mfma_f32_16x16x32_bf16 a[36:39], a[180:183], v[40:43], a[36:39]
  v_exp_f32 v113, v113
  v_mfma_f32_16x16x32_bf16 a[36:39], a[176:179], v[8:11], a[36:39]
  ds_read_b64_tr_b16 a[170:171], v221 offset:4096
  v_cvt_pk_bf16_f32 v112, v112, v113
  v_mfma_f32_16x16x32_bf16 a[40:43], a[176:179], v[16:19], a[40:43]
  v_exp_f32 v114, v114
  v_mfma_f32_16x16x32_bf16 a[40:43], a[180:183], v[48:51], a[40:43]
  ds_read_b64_tr_b16 a[172:173], v221 offset:8192
  v_mfma_f32_16x16x32_bf16 a[44:47], a[180:183], v[56:59], a[44:47]
  s_waitcnt lgkmcnt(7)
  v_exp_f32 v115, v115
  v_mfma_f32_16x16x32_bf16 a[44:47], a[176:179], v[24:27], a[44:47]
  ds_read_b64_tr_b16 a[174:175], v221 offset:12288
  v_cvt_pk_bf16_f32 v113, v114, v115
  v_mfma_f32_16x16x32_bf16 a[48:51], a[184:187], v[0:3], a[48:51]
  v_exp_f32 v120, v120
  v_mfma_f32_16x16x32_bf16 a[48:51], a[188:191], v[32:35], a[48:51]
  ds_read_b64_tr_b16 a[176:177], v222 offset:0
  v_mfma_f32_16x16x32_bf16 a[52:55], a[188:191], v[40:43], a[52:55]
  v_exp_f32 v121, v121
  v_mfma_f32_16x16x32_bf16 a[52:55], a[184:187], v[8:11], a[52:55]
  ds_read_b64_tr_b16 a[178:179], v222 offset:4096
  v_cvt_pk_bf16_f32 v120, v120, v121
  v_mfma_f32_16x16x32_bf16 a[56:59], a[184:187], v[16:19], a[56:59]
  v_exp_f32 v122, v122
  v_mfma_f32_16x16x32_bf16 a[56:59], a[188:191], v[48:51], a[56:59]
  ds_read_b64_tr_b16 a[180:181], v222 offset:8192
  v_mfma_f32_16x16x32_bf16 a[60:63], a[188:191], v[56:59], a[60:63]
  s_waitcnt lgkmcnt(7)
  v_exp_f32 v123, v123
  v_mfma_f32_16x16x32_bf16 a[60:63], a[184:187], v[24:27], a[60:63]
  ds_read_b64_tr_b16 a[182:183], v222 offset:12288
  v_cvt_pk_bf16_f32 v121, v122, v123
  v_mfma_f32_16x16x32_bf16 a[64:67], a[160:163], v[0:3], a[64:67]
  v_exp_f32 v100, v100
  v_mfma_f32_16x16x32_bf16 a[64:67], a[164:167], v[32:35], a[64:67]
  ds_read_b64_tr_b16 a[184:185], v223 offset:0
  v_mfma_f32_16x16x32_bf16 a[68:71], a[164:167], v[40:43], a[68:71]
  v_exp_f32 v101, v101
  v_mfma_f32_16x16x32_bf16 a[68:71], a[160:163], v[8:11], a[68:71]
  ds_read_b64_tr_b16 a[186:187], v223 offset:4096
  v_cvt_pk_bf16_f32 v98, v100, v101
  v_mfma_f32_16x16x32_bf16 a[72:75], a[160:163], v[16:19], a[72:75]
  v_exp_f32 v102, v102
  v_mfma_f32_16x16x32_bf16 a[72:75], a[164:167], v[48:51], a[72:75]
  ds_read_b64_tr_b16 a[188:189], v223 offset:8192
  v_mfma_f32_16x16x32_bf16 a[76:79], a[164:167], v[56:59], a[76:79]
  s_waitcnt lgkmcnt(7)
  v_exp_f32 v103, v103
  v_mfma_f32_16x16x32_bf16 a[76:79], a[160:163], v[24:27], a[76:79]
  ds_read_b64_tr_b16 a[190:191], v223 offset:12288
  v_cvt_pk_bf16_f32 v99, v102, v103
  v_mfma_f32_16x16x32_bf16 a[80:83], a[168:171], v[0:3], a[80:83]
  s_waitcnt vmcnt(11)
  v_exp_f32 v108, v108
  v_mfma_f32_16x16x32_bf16 a[80:83], a[172:175], v[32:35], a[80:83]
  v_mfma_f32_16x16x32_bf16 a[84:87], a[172:175], v[40:43], a[84:87]
  s_barrier
  v_exp_f32 v109, v109
  v_mfma_f32_16x16x32_bf16 a[84:87], a[168:171], v[8:11], a[84:87]
  ds_read_b128 a[128:131], v212 offset:32768
  v_cvt_pk_bf16_f32 v106, v108, v109
  v_mfma_f32_16x16x32_bf16 a[88:91], a[168:171], v[16:19], a[88:91]
  v_exp_f32 v110, v110
  v_mfma_f32_16x16x32_bf16 a[88:91], a[172:175], v[48:51], a[88:91]
  ds_read_b128 a[132:135], v213 offset:32768
  buffer_atomic_add v250, v249, s[24:27], s47 offen
  s_cmp_eq_u32 s32, 3
  s_cselect_b32 s39, 0, 1073741824
  v_mfma_f32_16x16x32_bf16 a[92:95], a[172:175], v[56:59], a[92:95]
  s_waitcnt lgkmcnt(6)
  v_exp_f32 v111, v111
  v_mfma_f32_16x16x32_bf16 a[92:95], a[168:171], v[24:27], a[92:95]
  ds_read_b128 a[136:139], v214 offset:32768
  v_cvt_pk_bf16_f32 v107, v110, v111
  v_mfma_f32_16x16x32_bf16 a[96:99], a[176:179], v[0:3], a[96:99]
  v_exp_f32 v116, v116
  v_mfma_f32_16x16x32_bf16 a[96:99], a[180:183], v[32:35], a[96:99]
  ds_read_b128 a[140:143], v215 offset:32768
  v_or_b32 v249, s39, v251
  v_mfma_f32_16x16x32_bf16 a[100:103], a[180:183], v[40:43], a[100:103]
  v_exp_f32 v117, v117
  v_mfma_f32_16x16x32_bf16 a[100:103], a[176:179], v[8:11], a[100:103]
  v_cvt_pk_bf16_f32 v114, v116, v117
  v_mfma_f32_16x16x32_bf16 a[104:107], a[176:179], v[16:19], a[104:107]
  v_exp_f32 v118, v118
  v_mfma_f32_16x16x32_bf16 a[104:107], a[180:183], v[48:51], a[104:107]
  v_mfma_f32_16x16x32_bf16 a[108:111], a[180:183], v[56:59], a[108:111]
  s_waitcnt lgkmcnt(4)
  v_exp_f32 v119, v119
  v_mfma_f32_16x16x32_bf16 a[108:111], a[176:179], v[24:27], a[108:111]
  v_cvt_pk_bf16_f32 v115, v118, v119
  v_mfma_f32_16x16x32_bf16 a[112:115], a[184:187], v[0:3], a[112:115]
  v_exp_f32 v124, v124
  v_mfma_f32_16x16x32_bf16 a[112:115], a[188:191], v[32:35], a[112:115]
  v_mfma_f32_16x16x32_bf16 a[116:119], a[188:191], v[40:43], a[116:119]
  v_exp_f32 v125, v125
  v_mfma_f32_16x16x32_bf16 a[116:119], a[184:187], v[8:11], a[116:119]
  v_cvt_pk_bf16_f32 v122, v124, v125
  v_mfma_f32_16x16x32_bf16 a[120:123], a[184:187], v[16:19], a[120:123]
  v_exp_f32 v126, v126
  v_mfma_f32_16x16x32_bf16 a[120:123], a[188:191], v[48:51], a[120:123]
  v_mfma_f32_16x16x32_bf16 a[124:127], a[188:191], v[56:59], a[124:127]
  s_waitcnt lgkmcnt(0)
  v_exp_f32 v127, v127
  v_mfma_f32_16x16x32_bf16 a[124:127], a[184:187], v[24:27], a[124:127]
  v_cvt_pk_bf16_f32 v123, v126, v127
  v_mfma_f32_16x16x32_bf16 v[0:3], a[128:131], v[128:131], v[192:195]
  s_add_u32 m0, s28, 114688
  v_mfma_f32_16x16x32_bf16 v[0:3], a[132:135], v[132:135], v[0:3]
  ds_read_b128 a[144:147], v212 offset:36864
  v_mfma_f32_16x16x32_bf16 v[0:3], a[136:139], v[136:139], v[0:3]
  buffer_load_dwordx4 v236, s[16:19], s29 offen offset:0 lds
  v_mfma_f32_16x16x32_bf16 v[0:3], a[140:143], v[140:143], v[0:3]
  ds_read_b128 a[148:151], v213 offset:36864
  v_mfma_f32_16x16x32_bf16 v[8:11], a[140:143], v[156:159], v[196:199]
  v_mfma_f32_16x16x32_bf16 v[8:11], a[136:139], v[152:155], v[8:11]
  ds_read_b128 a[152:155], v214 offset:36864
  v_mfma_f32_16x16x32_bf16 v[8:11], a[132:135], v[148:151], v[8:11]
  buffer_load_dwordx4 v237, s[16:19], s29 offen offset:1024 lds
  v_mfma_f32_16x16x32_bf16 v[8:11], a[128:131], v[144:147], v[8:11]
  ds_read_b128 a[156:159], v215 offset:36864
  v_mfma_f32_16x16x32_bf16 v[16:19], a[128:131], v[160:163], v[200:203]
  v_exp_f32 v0, v0
  v_mfma_f32_16x16x32_bf16 v[16:19], a[132:135], v[164:167], v[16:19]
  v_mfma_f32_16x16x32_bf16 v[16:19], a[136:139], v[168:171], v[16:19]
  v_exp_f32 v1, v1
  v_mfma_f32_16x16x32_bf16 v[16:19], a[140:143], v[172:175], v[16:19]
  v_cvt_pk_bf16_f32 v0, v0, v1
  v_mfma_f32_16x16x32_bf16 v[24:27], a[140:143], v[188:191], v[204:207]
  v_exp_f32 v2, v2
  v_mfma_f32_16x16x32_bf16 v[24:27], a[136:139], v[184:187], v[24:27]
  buffer_load_dwordx4 v236, s[16:19], s29 offen offset:2048 lds
  v_mfma_f32_16x16x32_bf16 v[24:27], a[132:135], v[180:183], v[24:27]
  s_waitcnt lgkmcnt(0)
  v_exp_f32 v3, v3
  v_mfma_f32_16x16x32_bf16 v[24:27], a[128:131], v[176:179], v[24:27]
  v_cvt_pk_bf16_f32 v1, v2, v3
  v_mfma_f32_16x16x32_bf16 v[4:7], a[144:147], v[128:131], v[192:195]
  v_exp_f32 v8, v8
  v_mfma_f32_16x16x32_bf16 v[4:7], a[148:151], v[132:135], v[4:7]
  ds_read_b128 a[128:131], v212 offset:40960
  v_mfma_f32_16x16x32_bf16 v[4:7], a[152:155], v[136:139], v[4:7]
  v_exp_f32 v9, v9
  v_mfma_f32_16x16x32_bf16 v[4:7], a[156:159], v[140:143], v[4:7]
  ds_read_b128 a[132:135], v213 offset:40960
  v_cvt_pk_bf16_f32 v8, v8, v9
  v_mfma_f32_16x16x32_bf16 v[12:15], a[156:159], v[156:159], v[196:199]
  v_exp_f32 v10, v10
  v_mfma_f32_16x16x32_bf16 v[12:15], a[152:155], v[152:155], v[12:15]
  ds_read_b128 a[136:139], v214 offset:40960
  v_mfma_f32_16x16x32_bf16 v[12:15], a[148:151], v[148:151], v[12:15]
  v_exp_f32 v11, v11
  v_mfma_f32_16x16x32_bf16 v[12:15], a[144:147], v[144:147], v[12:15]
  ds_read_b128 a[140:143], v215 offset:40960
  v_cvt_pk_bf16_f32 v9, v10, v11
  v_mfma_f32_16x16x32_bf16 v[20:23], a[144:147], v[160:163], v[200:203]
  v_exp_f32 v16, v16
  v_mfma_f32_16x16x32_bf16 v[20:23], a[148:151], v[164:167], v[20:23]
  buffer_load_dwordx4 v237, s[16:19], s29 offen offset:3072 lds
  v_mfma_f32_16x16x32_bf16 v[20:23], a[152:155], v[168:171], v[20:23]
  s_add_u32 s29, s29, 16384
  v_exp_f32 v17, v17
  v_mfma_f32_16x16x32_bf16 v[20:23], a[156:159], v[172:175], v[20:23]
  v_cvt_pk_bf16_f32 v16, v16, v17
  v_mfma_f32_16x16x32_bf16 v[28:31], a[156:159], v[188:191], v[204:207]
  s_add_u32 m0, s28, 0
  v_exp_f32 v18, v18
  v_mfma_f32_16x16x32_bf16 v[28:31], a[152:155], v[184:187], v[28:31]
  buffer_load_dwordx4 v232, s[12:15], s29 offen offset:0 lds
  v_mfma_f32_16x16x32_bf16 v[28:31], a[148:151], v[180:183], v[28:31]
  s_waitcnt lgkmcnt(0)
  v_exp_f32 v19, v19
  v_mfma_f32_16x16x32_bf16 v[28:31], a[144:147], v[176:179], v[28:31]
  v_cvt_pk_bf16_f32 v17, v18, v19
  v_mfma_f32_16x16x32_bf16 v[32:35], a[128:131], v[128:131], v[192:195]
  v_exp_f32 v24, v24
  v_mfma_f32_16x16x32_bf16 v[32:35], a[132:135], v[132:135], v[32:35]
  ds_read_b128 a[144:147], v212 offset:45056
  v_mfma_f32_16x16x32_bf16 v[32:35], a[136:139], v[136:139], v[32:35]
  v_exp_f32 v25, v25
  v_mfma_f32_16x16x32_bf16 v[32:35], a[140:143], v[140:143], v[32:35]
  ds_read_b128 a[148:151], v213 offset:45056
  v_cvt_pk_bf16_f32 v24, v24, v25
  v_mfma_f32_16x16x32_bf16 v[40:43], a[140:143], v[156:159], v[196:199]
  v_exp_f32 v26, v26
  v_mfma_f32_16x16x32_bf16 v[40:43], a[136:139], v[152:155], v[40:43]
  ds_read_b128 a[152:155], v214 offset:45056
  v_mfma_f32_16x16x32_bf16 v[40:43], a[132:135], v[148:151], v[40:43]
  v_exp_f32 v27, v27
  v_mfma_f32_16x16x32_bf16 v[40:43], a[128:131], v[144:147], v[40:43]
  ds_read_b128 a[156:159], v215 offset:45056
  v_cvt_pk_bf16_f32 v25, v26, v27
  v_mfma_f32_16x16x32_bf16 v[48:51], a[128:131], v[160:163], v[200:203]
  v_exp_f32 v4, v4
  v_mfma_f32_16x16x32_bf16 v[48:51], a[132:135], v[164:167], v[48:51]
  buffer_load_dwordx4 v233, s[12:15], s29 offen offset:1024 lds
  v_mfma_f32_16x16x32_bf16 v[48:51], a[136:139], v[168:171], v[48:51]
  v_exp_f32 v5, v5
  v_mfma_f32_16x16x32_bf16 v[48:51], a[140:143], v[172:175], v[48:51]
  v_cvt_pk_bf16_f32 v2, v4, v5
  v_mfma_f32_16x16x32_bf16 v[56:59], a[140:143], v[188:191], v[204:207]
  v_exp_f32 v6, v6
  v_mfma_f32_16x16x32_bf16 v[56:59], a[136:139], v[184:187], v[56:59]
  buffer_load_dwordx4 v234, s[12:15], s29 offen offset:2048 lds
  v_mfma_f32_16x16x32_bf16 v[56:59], a[132:135], v[180:183], v[56:59]
  s_waitcnt lgkmcnt(0)
  v_exp_f32 v7, v7
  v_mfma_f32_16x16x32_bf16 v[56:59], a[128:131], v[176:179], v[56:59]
  v_cvt_pk_bf16_f32 v3, v6, v7
  v_mfma_f32_16x16x32_bf16 v[36:39], a[144:147], v[128:131], v[192:195]
  v_exp_f32 v12, v12
  v_mfma_f32_16x16x32_bf16 v[36:39], a[148:151], v[132:135], v[36:39]
  ds_read_b64_tr_b16 a[160:161], v216 offset:16384
  v_mfma_f32_16x16x32_bf16 v[36:39], a[152:155], v[136:139], v[36:39]
  v_exp_f32 v13, v13
  v_mfma_f32_16x16x32_bf16 v[36:39], a[156:159], v[140:143], v[36:39]
  ds_read_b64_tr_b16 a[162:163], v216 offset:20480
  v_cvt_pk_bf16_f32 v10, v12, v13
  v_mfma_f32_16x16x32_bf16 v[44:47], a[156:159], v[156:159], v[196:199]
  v_exp_f32 v14, v14
  v_mfma_f32_16x16x32_bf16 v[44:47], a[152:155], v[152:155], v[44:47]
  ds_read_b64_tr_b16 a[164:165], v216 offset:24576
  buffer_load_dwordx4 v235, s[12:15], s29 offen offset:3072 lds
  v_mfma_f32_16x16x32_bf16 v[44:47], a[148:151], v[148:151], v[44:47]
  v_exp_f32 v15, v15
  v_mfma_f32_16x16x32_bf16 v[44:47], a[144:147], v[144:147], v[44:47]
  ds_read_b64_tr_b16 a[166:167], v216 offset:28672
  v_cvt_pk_bf16_f32 v11, v14, v15
  v_mfma_f32_16x16x32_bf16 v[52:55], a[144:147], v[160:163], v[200:203]
  s_mov_b32 m0, s51
  v_exp_f32 v20, v20
  v_mfma_f32_16x16x32_bf16 v[52:55], a[148:151], v[164:167], v[52:55]
  ds_read_b64_tr_b16 a[168:169], v217 offset:16384
  buffer_load_dwordx4 v210, s[4:7], s100 offen lds
  s_add_u32 s100, s100, 20480
  s_add_u32 s51, s51, 512
  v_mfma_f32_16x16x32_bf16 v[52:55], a[152:155], v[168:171], v[52:55]
  v_exp_f32 v21, v21
  v_mfma_f32_16x16x32_bf16 v[52:55], a[156:159], v[172:175], v[52:55]
  ds_read_b64_tr_b16 a[170:171], v217 offset:20480
  v_cvt_pk_bf16_f32 v18, v20, v21
  v_mfma_f32_16x16x32_bf16 v[60:63], a[156:159], v[188:191], v[204:207]
  s_waitcnt vmcnt(20)
  v_exp_f32 v22, v22
  v_mfma_f32_16x16x32_bf16 v[60:63], a[152:155], v[184:187], v[60:63]
  ds_read_b64_tr_b16 a[172:173], v217 offset:24576
  ds_read_b64_tr_b16 a[232:233], v209 offset:4096
  v_mfma_f32_16x16x32_bf16 v[60:63], a[148:151], v[180:183], v[60:63]
  v_exp_f32 v23, v23
  v_mfma_f32_16x16x32_bf16 v[60:63], a[144:147], v[176:179], v[60:63]
  ds_read_b64_tr_b16 a[174:175], v217 offset:28672
  v_cvt_pk_bf16_f32 v19, v22, v23
  v_mfma_f32_16x16x32_bf16 a[192:195], a[208:211], v[64:67], a[192:195]
  v_exp_f32 v28, v28
  v_mfma_f32_16x16x32_bf16 a[192:195], a[208:211], v[96:99], a[192:195]
  ds_read_b64_tr_b16 a[176:177], v218 offset:16384
  ds_read_b64_tr_b16 a[234:235], v209 offset:4608
  v_mfma_f32_16x16x32_bf16 a[196:199], a[208:211], v[72:75], a[196:199]
  v_exp_f32 v29, v29
  v_mfma_f32_16x16x32_bf16 a[196:199], a[208:211], v[104:107], a[196:199]
  ds_read_b64_tr_b16 a[178:179], v218 offset:20480
  v_cvt_pk_bf16_f32 v26, v28, v29
  v_mfma_f32_16x16x32_bf16 a[200:203], a[208:211], v[80:83], a[200:203]
  v_exp_f32 v30, v30
  v_mfma_f32_16x16x32_bf16 a[200:203], a[208:211], v[112:115], a[200:203]
  ds_read_b64_tr_b16 a[180:181], v218 offset:24576
  v_mfma_f32_16x16x32_bf16 a[204:207], a[208:211], v[88:91], a[204:207]
  s_waitcnt lgkmcnt(9)
  v_exp_f32 v31, v31
  v_mfma_f32_16x16x32_bf16 a[204:207], a[208:211], v[120:123], a[204:207]
  ds_read_b64_tr_b16 a[182:183], v218 offset:28672
  v_cvt_pk_bf16_f32 v27, v30, v31
  v_mfma_f32_16x16x32_bf16 a[0:3], a[160:163], v[64:67], a[0:3]
  v_exp_f32 v32, v32
  v_mfma_f32_16x16x32_bf16 a[0:3], a[164:167], v[96:99], a[0:3]
  ds_read_b64_tr_b16 a[184:185], v219 offset:16384
  s_waitcnt lgkmcnt(4)
  buffer_store_dwordx4 a[232:235], v211, s[24:27], s31 offen sc1
  s_add_u32 s31, s31, 1024
  s_cmp_gt_u32 s32, 3
  v_mfma_f32_16x16x32_bf16 a[4:7], a[164:167], v[104:107], a[4:7]
  s_cselect_b32 s39, 0, 1073741824
  v_exp_f32 v33, v33
  v_mfma_f32_16x16x32_bf16 a[4:7], a[160:163], v[72:75], a[4:7]
  ds_read_b64_tr_b16 a[186:187], v219 offset:20480
  v_cvt_pk_bf16_f32 v32, v32, v33
  v_mfma_f32_16x16x32_bf16 a[8:11], a[160:163], v[80:83], a[8:11]
  v_exp_f32 v34, v34
  v_mfma_f32_16x16x32_bf16 a[8:11], a[164:167], v[112:115], a[8:11]
  ds_read_b64_tr_b16 a[188:189], v219 offset:24576
  v_or_b32 v211, s39, v211
  v_mfma_f32_16x16x32_bf16 a[12:15], a[164:167], v[120:123], a[12:15]
  v_exp_f32 v35, v35
  v_mfma_f32_16x16x32_bf16 a[12:15], a[160:163], v[88:91], a[12:15]
  ds_read_b64_tr_b16 a[190:191], v219 offset:28672
  v_cvt_pk_bf16_f32 v33, v34, v35
  v_mfma_f32_16x16x32_bf16 a[16:19], a[168:171], v[64:67], a[16:19]
  v_exp_f32 v40, v40
  v_mfma_f32_16x16x32_bf16 a[16:19], a[172:175], v[96:99], a[16:19]
  ds_read_b64_tr_b16 a[160:161], v220 offset:16384
  v_or_b32 v208, s39, v208
  v_mfma_f32_16x16x32_bf16 a[20:23], a[172:175], v[104:107], a[20:23]
  v_exp_f32 v41, v41
  v_mfma_f32_16x16x32_bf16 a[20:23], a[168:171], v[72:75], a[20:23]
  ds_read_b64_tr_b16 a[162:163], v220 offset:20480
  v_cvt_pk_bf16_f32 v40, v40, v41
  v_mfma_f32_16x16x32_bf16 a[24:27], a[168:171], v[80:83], a[24:27]
  v_exp_f32 v42, v42
  v_mfma_f32_16x16x32_bf16 a[24:27], a[172:175], v[112:115], a[24:27]
  ds_read_b64_tr_b16 a[164:165], v220 offset:24576
  v_mfma_f32_16x16x32_bf16 a[28:31], a[172:175], v[120:123], a[28:31]
  s_waitcnt lgkmcnt(7)
  v_exp_f32 v43, v43
  v_mfma_f32_16x16x32_bf16 a[28:31], a[168:171], v[88:91], a[28:31]
  ds_read_b64_tr_b16 a[166:167], v220 offset:28672
  v_cvt_pk_bf16_f32 v41, v42, v43
  v_mfma_f32_16x16x32_bf16 a[32:35], a[176:179], v[64:67], a[32:35]
  v_exp_f32 v48, v48
  v_mfma_f32_16x16x32_bf16 a[32:35], a[180:183], v[96:99], a[32:35]
  ds_read_b64_tr_b16 a[168:169], v221 offset:16384
  v_mfma_f32_16x16x32_bf16 a[36:39], a[180:183], v[104:107], a[36:39]
  v_exp_f32 v49, v49
  v_mfma_f32_16x16x32_bf16 a[36:39], a[176:179], v[72:75], a[36:39]
  ds_read_b64_tr_b16 a[170:171], v221 offset:20480
  v_cvt_pk_bf16_f32 v48, v48, v49
  v_mfma_f32_16x16x32_bf16 a[40:43], a[176:179], v[80:83], a[40:43]
  v_exp_f32 v50, v50
  v_mfma_f32_16x16x32_bf16 a[40:43], a[180:183], v[112:115], a[40:43]
  ds_read_b64_tr_b16 a[172:173], v221 offset:24576
  v_mfma_f32_16x16x32_bf16 a[44:47], a[180:183], v[120:123], a[44:47]
  s_waitcnt lgkmcnt(7)
  v_exp_f32 v51, v51
  v_mfma_f32_16x16x32_bf16 a[44:47], a[176:179], v[88:91], a[44:47]
  ds_read_b64_tr_b16 a[174:175], v221 offset:28672
  v_cvt_pk_bf16_f32 v49, v50, v51
  v_mfma_f32_16x16x32_bf16 a[48:51], a[184:187], v[64:67], a[48:51]
  v_exp_f32 v56, v56
  v_mfma_f32_16x16x32_bf16 a[48:51], a[188:191], v[96:99], a[48:51]
  ds_read_b64_tr_b16 a[176:177], v222 offset:16384
  v_mfma_f32_16x16x32_bf16 a[52:55], a[188:191], v[104:107], a[52:55]
  v_exp_f32 v57, v57
  v_mfma_f32_16x16x32_bf16 a[52:55], a[184:187], v[72:75], a[52:55]
  ds_read_b64_tr_b16 a[178:179], v222 offset:20480
  v_cvt_pk_bf16_f32 v56, v56, v57
  v_mfma_f32_16x16x32_bf16 a[56:59], a[184:187], v[80:83], a[56:59]
  v_exp_f32 v58, v58
  v_mfma_f32_16x16x32_bf16 a[56:59], a[188:191], v[112:115], a[56:59]
  ds_read_b64_tr_b16 a[180:181], v222 offset:24576
  v_mfma_f32_16x16x32_bf16 a[60:63], a[188:191], v[120:123], a[60:63]
  s_waitcnt lgkmcnt(7)
  v_exp_f32 v59, v59
  v_mfma_f32_16x16x32_bf16 a[60:63], a[184:187], v[88:91], a[60:63]
  ds_read_b64_tr_b16 a[182:183], v222 offset:28672
  v_cvt_pk_bf16_f32 v57, v58, v59
  v_mfma_f32_16x16x32_bf16 a[64:67], a[160:163], v[64:67], a[64:67]
  v_exp_f32 v36, v36
  v_mfma_f32_16x16x32_bf16 a[64:67], a[164:167], v[96:99], a[64:67]
  ds_read_b64_tr_b16 a[184:185], v223 offset:16384
  v_mfma_f32_16x16x32_bf16 a[68:71], a[164:167], v[104:107], a[68:71]
  v_exp_f32 v37, v37
  v_mfma_f32_16x16x32_bf16 a[68:71], a[160:163], v[72:75], a[68:71]
  ds_read_b64_tr_b16 a[186:187], v223 offset:20480
  v_cvt_pk_bf16_f32 v34, v36, v37
  v_mfma_f32_16x16x32_bf16 a[72:75], a[160:163], v[80:83], a[72:75]
  v_exp_f32 v38, v38
  v_mfma_f32_16x16x32_bf16 a[72:75], a[164:167], v[112:115], a[72:75]
  ds_read_b64_tr_b16 a[188:189], v223 offset:24576
  v_mfma_f32_16x16x32_bf16 a[76:79], a[164:167], v[120:123], a[76:79]
  s_waitcnt lgkmcnt(7)
  v_exp_f32 v39, v39
  v_mfma_f32_16x16x32_bf16 a[76:79], a[160:163], v[88:91], a[76:79]
  ds_read_b64_tr_b16 a[190:191], v223 offset:28672
  v_cvt_pk_bf16_f32 v35, v38, v39
  v_mfma_f32_16x16x32_bf16 a[80:83], a[168:171], v[64:67], a[80:83]
  s_waitcnt vmcnt(12)
  v_exp_f32 v44, v44
  v_mfma_f32_16x16x32_bf16 a[80:83], a[172:175], v[96:99], a[80:83]
  v_mfma_f32_16x16x32_bf16 a[84:87], a[172:175], v[104:107], a[84:87]
  s_barrier
  v_exp_f32 v45, v45
  v_mfma_f32_16x16x32_bf16 a[84:87], a[168:171], v[72:75], a[84:87]
  ds_read_b128 a[128:131], v212 offset:49152
  v_cvt_pk_bf16_f32 v42, v44, v45
  v_mfma_f32_16x16x32_bf16 a[88:91], a[168:171], v[80:83], a[88:91]
  v_exp_f32 v46, v46
  v_mfma_f32_16x16x32_bf16 a[88:91], a[172:175], v[112:115], a[88:91]
  ds_read_b128 a[132:135], v213 offset:49152
  v_mfma_f32_16x16x32_bf16 a[92:95], a[172:175], v[120:123], a[92:95]
  s_waitcnt lgkmcnt(6)
  v_exp_f32 v47, v47
  v_mfma_f32_16x16x32_bf16 a[92:95], a[168:171], v[88:91], a[92:95]
  ds_read_b128 a[136:139], v214 offset:49152
  v_cvt_pk_bf16_f32 v43, v46, v47
  v_mfma_f32_16x16x32_bf16 a[96:99], a[176:179], v[64:67], a[96:99]
  v_exp_f32 v52, v52
  v_mfma_f32_16x16x32_bf16 a[96:99], a[180:183], v[96:99], a[96:99]
  ds_read_b128 a[140:143], v215 offset:49152
  v_mfma_f32_16x16x32_bf16 a[100:103], a[180:183], v[104:107], a[100:103]
  v_exp_f32 v53, v53
  v_mfma_f32_16x16x32_bf16 a[100:103], a[176:179], v[72:75], a[100:103]
  v_cvt_pk_bf16_f32 v50, v52, v53
  v_mfma_f32_16x16x32_bf16 a[104:107], a[176:179], v[80:83], a[104:107]
  v_exp_f32 v54, v54
  v_mfma_f32_16x16x32_bf16 a[104:107], a[180:183], v[112:115], a[104:107]
  v_mfma_f32_16x16x32_bf16 a[108:111], a[180:183], v[120:123], a[108:111]
  s_waitcnt lgkmcnt(4)
  v_exp_f32 v55, v55
  v_mfma_f32_16x16x32_bf16 a[108:111], a[176:179], v[88:91], a[108:111]
  v_cvt_pk_bf16_f32 v51, v54, v55
  v_mfma_f32_16x16x32_bf16 a[112:115], a[184:187], v[64:67], a[112:115]
  v_exp_f32 v60, v60
  v_mfma_f32_16x16x32_bf16 a[112:115], a[188:191], v[96:99], a[112:115]
  v_mfma_f32_16x16x32_bf16 a[116:119], a[188:191], v[104:107], a[116:119]
  v_exp_f32 v61, v61
  v_mfma_f32_16x16x32_bf16 a[116:119], a[184:187], v[72:75], a[116:119]
  v_cvt_pk_bf16_f32 v58, v60, v61
  v_mfma_f32_16x16x32_bf16 a[120:123], a[184:187], v[80:83], a[120:123]
  v_exp_f32 v62, v62
  v_mfma_f32_16x16x32_bf16 a[120:123], a[188:191], v[112:115], a[120:123]
  v_mfma_f32_16x16x32_bf16 a[124:127], a[188:191], v[120:123], a[124:127]
  s_waitcnt lgkmcnt(0)
  v_exp_f32 v63, v63
  v_mfma_f32_16x16x32_bf16 a[124:127], a[184:187], v[88:91], a[124:127]
  v_cvt_pk_bf16_f32 v59, v62, v63
  v_mfma_f32_16x16x32_bf16 v[64:67], a[128:131], v[128:131], v[192:195]
  s_add_u32 m0, s28, 65536
  v_mfma_f32_16x16x32_bf16 v[64:67], a[132:135], v[132:135], v[64:67]
  ds_read_b128 a[144:147], v212 offset:53248
  v_mfma_f32_16x16x32_bf16 v[64:67], a[136:139], v[136:139], v[64:67]
  buffer_load_dwordx4 v236, s[16:19], s29 offen offset:0 lds
  v_mfma_f32_16x16x32_bf16 v[64:67], a[140:143], v[140:143], v[64:67]
  ds_read_b128 a[148:151], v213 offset:53248
  v_mfma_f32_16x16x32_bf16 v[72:75], a[140:143], v[156:159], v[196:199]
  v_mfma_f32_16x16x32_bf16 v[72:75], a[136:139], v[152:155], v[72:75]
  ds_read_b128 a[152:155], v214 offset:53248
  v_mfma_f32_16x16x32_bf16 v[72:75], a[132:135], v[148:151], v[72:75]
  buffer_load_dwordx4 v237, s[16:19], s29 offen offset:1024 lds
  v_mfma_f32_16x16x32_bf16 v[72:75], a[128:131], v[144:147], v[72:75]
  ds_read_b128 a[156:159], v215 offset:53248
  v_mfma_f32_16x16x32_bf16 v[80:83], a[128:131], v[160:163], v[200:203]
  v_exp_f32 v64, v64
  v_mfma_f32_16x16x32_bf16 v[80:83], a[132:135], v[164:167], v[80:83]
  v_mfma_f32_16x16x32_bf16 v[80:83], a[136:139], v[168:171], v[80:83]
  v_exp_f32 v65, v65
  v_mfma_f32_16x16x32_bf16 v[80:83], a[140:143], v[172:175], v[80:83]
  v_cvt_pk_bf16_f32 v64, v64, v65
  v_mfma_f32_16x16x32_bf16 v[88:91], a[140:143], v[188:191], v[204:207]
  v_exp_f32 v66, v66
  v_mfma_f32_16x16x32_bf16 v[88:91], a[136:139], v[184:187], v[88:91]
  buffer_load_dwordx4 v236, s[16:19], s29 offen offset:2048 lds
  v_mfma_f32_16x16x32_bf16 v[88:91], a[132:135], v[180:183], v[88:91]
  s_waitcnt lgkmcnt(0)
  v_exp_f32 v67, v67
  v_mfma_f32_16x16x32_bf16 v[88:91], a[128:131], v[176:179], v[88:91]
  v_cvt_pk_bf16_f32 v65, v66, v67
  v_mfma_f32_16x16x32_bf16 v[68:71], a[144:147], v[128:131], v[192:195]
  v_exp_f32 v72, v72
  v_mfma_f32_16x16x32_bf16 v[68:71], a[148:151], v[132:135], v[68:71]
  ds_read_b128 a[128:131], v212 offset:57344
  v_mfma_f32_16x16x32_bf16 v[68:71], a[152:155], v[136:139], v[68:71]
  v_exp_f32 v73, v73
  v_mfma_f32_16x16x32_bf16 v[68:71], a[156:159], v[140:143], v[68:71]
  ds_read_b128 a[132:135], v213 offset:57344
  v_cvt_pk_bf16_f32 v72, v72, v73
  v_mfma_f32_16x16x32_bf16 v[76:79], a[156:159], v[156:159], v[196:199]
  v_exp_f32 v74, v74
  v_mfma_f32_16x16x32_bf16 v[76:79], a[152:155], v[152:155], v[76:79]
  ds_read_b128 a[136:139], v214 offset:57344
  v_mfma_f32_16x16x32_bf16 v[76:79], a[148:151], v[148:151], v[76:79]
  v_exp_f32 v75, v75
  v_mfma_f32_16x16x32_bf16 v[76:79], a[144:147], v[144:147], v[76:79]
  ds_read_b128 a[140:143], v215 offset:57344
  v_cvt_pk_bf16_f32 v73, v74, v75
  v_mfma_f32_16x16x32_bf16 v[84:87], a[144:147], v[160:163], v[200:203]
  v_exp_f32 v80, v80
  v_mfma_f32_16x16x32_bf16 v[84:87], a[148:151], v[164:167], v[84:87]
  buffer_load_dwordx4 v237, s[16:19], s29 offen offset:3072 lds
  v_mfma_f32_16x16x32_bf16 v[84:87], a[152:155], v[168:171], v[84:87]
  s_add_u32 s29, s29, 16384
  v_exp_f32 v81, v81
  v_mfma_f32_16x16x32_bf16 v[84:87], a[156:159], v[172:175], v[84:87]
  v_cvt_pk_bf16_f32 v80, v80, v81
  v_mfma_f32_16x16x32_bf16 v[92:95], a[156:159], v[188:191], v[204:207]
  s_add_u32 m0, s28, 16384
  v_exp_f32 v82, v82
  v_mfma_f32_16x16x32_bf16 v[92:95], a[152:155], v[184:187], v[92:95]
  buffer_load_dwordx4 v232, s[12:15], s29 offen offset:0 lds
  v_mfma_f32_16x16x32_bf16 v[92:95], a[148:151], v[180:183], v[92:95]
  s_waitcnt lgkmcnt(0)
  v_exp_f32 v83, v83
  v_mfma_f32_16x16x32_bf16 v[92:95], a[144:147], v[176:179], v[92:95]
  v_cvt_pk_bf16_f32 v81, v82, v83
  v_mfma_f32_16x16x32_bf16 v[96:99], a[128:131], v[128:131], v[192:195]
  v_exp_f32 v88, v88
  v_mfma_f32_16x16x32_bf16 v[96:99], a[132:135], v[132:135], v[96:99]
  ds_read_b128 a[144:147], v212 offset:61440
  v_mfma_f32_16x16x32_bf16 v[96:99], a[136:139], v[136:139], v[96:99]
  v_exp_f32 v89, v89
  v_mfma_f32_16x16x32_bf16 v[96:99], a[140:143], v[140:143], v[96:99]
  ds_read_b128 a[148:151], v213 offset:61440
  v_cvt_pk_bf16_f32 v88, v88, v89
  v_mfma_f32_16x16x32_bf16 v[104:107], a[140:143], v[156:159], v[196:199]
  v_exp_f32 v90, v90
  v_mfma_f32_16x16x32_bf16 v[104:107], a[136:139], v[152:155], v[104:107]
  ds_read_b128 a[152:155], v214 offset:61440
  v_mfma_f32_16x16x32_bf16 v[104:107], a[132:135], v[148:151], v[104:107]
  v_exp_f32 v91, v91
  v_mfma_f32_16x16x32_bf16 v[104:107], a[128:131], v[144:147], v[104:107]
  ds_read_b128 a[156:159], v215 offset:61440
  v_cvt_pk_bf16_f32 v89, v90, v91
  v_mfma_f32_16x16x32_bf16 v[112:115], a[128:131], v[160:163], v[200:203]
  v_exp_f32 v68, v68
  v_mfma_f32_16x16x32_bf16 v[112:115], a[132:135], v[164:167], v[112:115]
  buffer_load_dwordx4 v233, s[12:15], s29 offen offset:1024 lds
  v_mfma_f32_16x16x32_bf16 v[112:115], a[136:139], v[168:171], v[112:115]
  v_exp_f32 v69, v69
  v_mfma_f32_16x16x32_bf16 v[112:115], a[140:143], v[172:175], v[112:115]
  v_cvt_pk_bf16_f32 v66, v68, v69
  v_mfma_f32_16x16x32_bf16 v[120:123], a[140:143], v[188:191], v[204:207]
  v_exp_f32 v70, v70
  v_mfma_f32_16x16x32_bf16 v[120:123], a[136:139], v[184:187], v[120:123]
  buffer_load_dwordx4 v234, s[12:15], s29 offen offset:2048 lds
  v_mfma_f32_16x16x32_bf16 v[120:123], a[132:135], v[180:183], v[120:123]
  s_waitcnt lgkmcnt(0)
  v_exp_f32 v71, v71
  v_mfma_f32_16x16x32_bf16 v[120:123], a[128:131], v[176:179], v[120:123]
  v_cvt_pk_bf16_f32 v67, v70, v71
  v_mfma_f32_16x16x32_bf16 v[100:103], a[144:147], v[128:131], v[192:195]
  v_exp_f32 v76, v76
  v_mfma_f32_16x16x32_bf16 v[100:103], a[148:151], v[132:135], v[100:103]
  ds_read_b64_tr_b16 a[160:161], v216 offset:32768
  v_mfma_f32_16x16x32_bf16 v[100:103], a[152:155], v[136:139], v[100:103]
  v_exp_f32 v77, v77
  v_mfma_f32_16x16x32_bf16 v[100:103], a[156:159], v[140:143], v[100:103]
  ds_read_b64_tr_b16 a[162:163], v216 offset:36864
  v_cvt_pk_bf16_f32 v74, v76, v77
  v_mfma_f32_16x16x32_bf16 v[108:111], a[156:159], v[156:159], v[196:199]
  v_exp_f32 v78, v78
  v_mfma_f32_16x16x32_bf16 v[108:111], a[152:155], v[152:155], v[108:111]
  ds_read_b64_tr_b16 a[164:165], v216 offset:40960
  buffer_load_dwordx4 v235, s[12:15], s29 offen offset:3072 lds
  v_mfma_f32_16x16x32_bf16 v[108:111], a[148:151], v[148:151], v[108:111]
  v_exp_f32 v79, v79
  v_mfma_f32_16x16x32_bf16 v[108:111], a[144:147], v[144:147], v[108:111]
  ds_read_b64_tr_b16 a[166:167], v216 offset:45056
  v_cvt_pk_bf16_f32 v75, v78, v79
  v_mfma_f32_16x16x32_bf16 v[116:119], a[144:147], v[160:163], v[200:203]
  v_exp_f32 v84, v84
  v_mfma_f32_16x16x32_bf16 v[116:119], a[148:151], v[164:167], v[116:119]
  ds_read_b64_tr_b16 a[168:169], v217 offset:32768
  buffer_load_dword v254, off, s[24:27], s47 sc1
  v_mfma_f32_16x16x32_bf16 v[116:119], a[152:155], v[168:171], v[116:119]
  v_exp_f32 v85, v85
  v_mfma_f32_16x16x32_bf16 v[116:119], a[156:159], v[172:175], v[116:119]
  ds_read_b64_tr_b16 a[170:171], v217 offset:36864
  v_cvt_pk_bf16_f32 v82, v84, v85
  v_mfma_f32_16x16x32_bf16 v[124:127], a[156:159], v[188:191], v[204:207]
  s_waitcnt vmcnt(20)
  v_exp_f32 v86, v86
  v_mfma_f32_16x16x32_bf16 v[124:127], a[152:155], v[184:187], v[124:127]
  ds_read_b64_tr_b16 a[172:173], v217 offset:40960
  ds_read_b64_tr_b16 a[232:233], v209 offset:5120
  v_mfma_f32_16x16x32_bf16 v[124:127], a[148:151], v[180:183], v[124:127]
  v_exp_f32 v87, v87
  v_mfma_f32_16x16x32_bf16 v[124:127], a[144:147], v[176:179], v[124:127]
  ds_read_b64_tr_b16 a[174:175], v217 offset:45056
  v_cvt_pk_bf16_f32 v83, v86, v87
  v_mfma_f32_16x16x32_bf16 a[192:195], a[208:211], v[0:3], a[192:195]
  v_exp_f32 v92, v92
  v_mfma_f32_16x16x32_bf16 a[192:195], a[208:211], v[32:35], a[192:195]
  ds_read_b64_tr_b16 a[176:177], v218 offset:32768
  ds_read_b64_tr_b16 a[234:235], v209 offset:5632
  v_mfma_f32_16x16x32_bf16 a[196:199], a[208:211], v[8:11], a[196:199]
  v_exp_f32 v93, v93
  v_mfma_f32_16x16x32_bf16 a[196:199], a[208:211], v[40:43], a[196:199]
  ds_read_b64_tr_b16 a[178:179], v218 offset:36864
  v_cvt_pk_bf16_f32 v90, v92, v93
  v_mfma_f32_16x16x32_bf16 a[200:203], a[208:211], v[16:19], a[200:203]
  v_exp_f32 v94, v94
  v_mfma_f32_16x16x32_bf16 a[200:203], a[208:211], v[48:51], a[200:203]
  ds_read_b64_tr_b16 a[180:181], v218 offset:40960
  v_mfma_f32_16x16x32_bf16 a[204:207], a[208:211], v[24:27], a[204:207]
  s_waitcnt lgkmcnt(9)
  v_exp_f32 v95, v95
  v_mfma_f32_16x16x32_bf16 a[204:207], a[208:211], v[56:59], a[204:207]
  ds_read_b64_tr_b16 a[182:183], v218 offset:45056
  v_cvt_pk_bf16_f32 v91, v94, v95
  v_mfma_f32_16x16x32_bf16 a[0:3], a[160:163], v[0:3], a[0:3]
  v_exp_f32 v96, v96
  v_mfma_f32_16x16x32_bf16 a[0:3], a[164:167], v[32:35], a[0:3]
  ds_read_b64_tr_b16 a[184:185], v219 offset:32768
  s_waitcnt lgkmcnt(4)
  buffer_store_dwordx4 a[232:235], v211, s[24:27], s31 offen sc1
  s_add_u32 s31, s31, 1024
  v_mfma_f32_16x16x32_bf16 a[4:7], a[164:167], v[40:43], a[4:7]
  v_exp_f32 v97, v97
  v_mfma_f32_16x16x32_bf16 a[4:7], a[160:163], v[8:11], a[4:7]
  ds_read_b64_tr_b16 a[186:187], v219 offset:36864
  v_cvt_pk_bf16_f32 v96, v96, v97
  v_mfma_f32_16x16x32_bf16 a[8:11], a[160:163], v[16:19], a[8:11]
  v_exp_f32 v98, v98
  v_mfma_f32_16x16x32_bf16 a[8:11], a[164:167], v[48:51], a[8:11]
  ds_read_b64_tr_b16 a[188:189], v219 offset:40960
  v_mfma_f32_16x16x32_bf16 a[12:15], a[164:167], v[56:59], a[12:15]
  v_exp_f32 v99, v99
  v_mfma_f32_16x16x32_bf16 a[12:15], a[160:163], v[24:27], a[12:15]
  ds_read_b64_tr_b16 a[190:191], v219 offset:45056
  v_cvt_pk_bf16_f32 v97, v98, v99
  v_mfma_f32_16x16x32_bf16 a[16:19], a[168:171], v[0:3], a[16:19]
  v_exp_f32 v104, v104
  v_mfma_f32_16x16x32_bf16 a[16:19], a[172:175], v[32:35], a[16:19]
  ds_read_b64_tr_b16 a[160:161], v220 offset:32768
  v_mfma_f32_16x16x32_bf16 a[20:23], a[172:175], v[40:43], a[20:23]
  v_exp_f32 v105, v105
  v_mfma_f32_16x16x32_bf16 a[20:23], a[168:171], v[8:11], a[20:23]
  ds_read_b64_tr_b16 a[162:163], v220 offset:36864
  v_cvt_pk_bf16_f32 v104, v104, v105
  v_mfma_f32_16x16x32_bf16 a[24:27], a[168:171], v[16:19], a[24:27]
  v_exp_f32 v106, v106
  v_mfma_f32_16x16x32_bf16 a[24:27], a[172:175], v[48:51], a[24:27]
  ds_read_b64_tr_b16 a[164:165], v220 offset:40960
  v_mfma_f32_16x16x32_bf16 a[28:31], a[172:175], v[56:59], a[28:31]
  s_waitcnt lgkmcnt(7)
  v_exp_f32 v107, v107
  v_mfma_f32_16x16x32_bf16 a[28:31], a[168:171], v[24:27], a[28:31]
  ds_read_b64_tr_b16 a[166:167], v220 offset:45056
  v_cvt_pk_bf16_f32 v105, v106, v107
  v_mfma_f32_16x16x32_bf16 a[32:35], a[176:179], v[0:3], a[32:35]
  v_exp_f32 v112, v112
  v_mfma_f32_16x16x32_bf16 a[32:35], a[180:183], v[32:35], a[32:35]
  ds_read_b64_tr_b16 a[168:169], v221 offset:32768
  v_mfma_f32_16x16x32_bf16 a[36:39], a[180:183], v[40:43], a[36:39]
  v_exp_f32 v113, v113
  v_mfma_f32_16x16x32_bf16 a[36:39], a[176:179], v[8:11], a[36:39]
  ds_read_b64_tr_b16 a[170:171], v221 offset:36864
  v_cvt_pk_bf16_f32 v112, v112, v113
  v_mfma_f32_16x16x32_bf16 a[40:43], a[176:179], v[16:19], a[40:43]
  v_exp_f32 v114, v114
  v_mfma_f32_16x16x32_bf16 a[40:43], a[180:183], v[48:51], a[40:43]
  ds_read_b64_tr_b16 a[172:173], v221 offset:40960
  v_mfma_f32_16x16x32_bf16 a[44:47], a[180:183], v[56:59], a[44:47]
  s_waitcnt lgkmcnt(7)
  v_exp_f32 v115, v115
  v_mfma_f32_16x16x32_bf16 a[44:47], a[176:179], v[24:27], a[44:47]
  ds_read_b64_tr_b16 a[174:175], v221 offset:45056
  v_cvt_pk_bf16_f32 v113, v114, v115
  v_mfma_f32_16x16x32_bf16 a[48:51], a[184:187], v[0:3], a[48:51]
  v_exp_f32 v120, v120
  v_mfma_f32_16x16x32_bf16 a[48:51], a[188:191], v[32:35], a[48:51]
  ds_read_b64_tr_b16 a[176:177], v222 offset:32768
  v_mfma_f32_16x16x32_bf16 a[52:55], a[188:191], v[40:43], a[52:55]
  v_exp_f32 v121, v121
  v_mfma_f32_16x16x32_bf16 a[52:55], a[184:187], v[8:11], a[52:55]
  ds_read_b64_tr_b16 a[178:179], v222 offset:36864
  v_cvt_pk_bf16_f32 v120, v120, v121
  v_mfma_f32_16x16x32_bf16 a[56:59], a[184:187], v[16:19], a[56:59]
  v_exp_f32 v122, v122
  v_mfma_f32_16x16x32_bf16 a[56:59], a[188:191], v[48:51], a[56:59]
  ds_read_b64_tr_b16 a[180:181], v222 offset:40960
  v_mfma_f32_16x16x32_bf16 a[60:63], a[188:191], v[56:59], a[60:63]
  s_waitcnt lgkmcnt(7)
  v_exp_f32 v123, v123
  v_mfma_f32_16x16x32_bf16 a[60:63], a[184:187], v[24:27], a[60:63]
  ds_read_b64_tr_b16 a[182:183], v222 offset:45056
  v_cvt_pk_bf16_f32 v121, v122, v123
  v_mfma_f32_16x16x32_bf16 a[64:67], a[160:163], v[0:3], a[64:67]
  v_exp_f32 v100, v100
  v_mfma_f32_16x16x32_bf16 a[64:67], a[164:167], v[32:35], a[64:67]
  ds_read_b64_tr_b16 a[184:185], v223 offset:32768
  v_mfma_f32_16x16x32_bf16 a[68:71], a[164:167], v[40:43], a[68:71]
  v_exp_f32 v101, v101
  v_mfma_f32_16x16x32_bf16 a[68:71], a[160:163], v[8:11], a[68:71]
  ds_read_b64_tr_b16 a[186:187], v223 offset:36864
  v_cvt_pk_bf16_f32 v98, v100, v101
  v_mfma_f32_16x16x32_bf16 a[72:75], a[160:163], v[16:19], a[72:75]
  v_exp_f32 v102, v102
  v_mfma_f32_16x16x32_bf16 a[72:75], a[164:167], v[48:51], a[72:75]
  ds_read_b64_tr_b16 a[188:189], v223 offset:40960
  v_mfma_f32_16x16x32_bf16 a[76:79], a[164:167], v[56:59], a[76:79]
  s_waitcnt lgkmcnt(7)
  v_exp_f32 v103, v103
  v_mfma_f32_16x16x32_bf16 a[76:79], a[160:163], v[24:27], a[76:79]
  ds_read_b64_tr_b16 a[190:191], v223 offset:45056
  v_cvt_pk_bf16_f32 v99, v102, v103
  v_mfma_f32_16x16x32_bf16 a[80:83], a[168:171], v[0:3], a[80:83]
  s_waitcnt vmcnt(12)
  v_exp_f32 v108, v108
  v_mfma_f32_16x16x32_bf16 a[80:83], a[172:175], v[32:35], a[80:83]
  v_mfma_f32_16x16x32_bf16 a[84:87], a[172:175], v[40:43], a[84:87]
  s_barrier
  v_exp_f32 v109, v109
  v_mfma_f32_16x16x32_bf16 a[84:87], a[168:171], v[8:11], a[84:87]
  ds_read_b128 a[128:131], v212 offset:0
  v_cvt_pk_bf16_f32 v106, v108, v109
  v_mfma_f32_16x16x32_bf16 a[88:91], a[168:171], v[16:19], a[88:91]
  v_exp_f32 v110, v110
  v_mfma_f32_16x16x32_bf16 a[88:91], a[172:175], v[48:51], a[88:91]
  ds_read_b128 a[132:135], v213 offset:0
  v_mfma_f32_16x16x32_bf16 a[92:95], a[172:175], v[56:59], a[92:95]
  s_waitcnt lgkmcnt(6)
  v_exp_f32 v111, v111
  v_mfma_f32_16x16x32_bf16 a[92:95], a[168:171], v[24:27], a[92:95]
  ds_read_b128 a[136:139], v214 offset:0
  v_cvt_pk_bf16_f32 v107, v110, v111
  v_mfma_f32_16x16x32_bf16 a[96:99], a[176:179], v[0:3], a[96:99]
  v_exp_f32 v116, v116
  v_mfma_f32_16x16x32_bf16 a[96:99], a[180:183], v[32:35], a[96:99]
  ds_read_b128 a[140:143], v215 offset:0
  v_mfma_f32_16x16x32_bf16 a[100:103], a[180:183], v[40:43], a[100:103]
  v_exp_f32 v117, v117
  v_mfma_f32_16x16x32_bf16 a[100:103], a[176:179], v[8:11], a[100:103]
  v_cvt_pk_bf16_f32 v114, v116, v117
  v_mfma_f32_16x16x32_bf16 a[104:107], a[176:179], v[16:19], a[104:107]
  v_exp_f32 v118, v118
  v_mfma_f32_16x16x32_bf16 a[104:107], a[180:183], v[48:51], a[104:107]
  v_mfma_f32_16x16x32_bf16 a[108:111], a[180:183], v[56:59], a[108:111]
  s_waitcnt lgkmcnt(4)
  v_exp_f32 v119, v119
  v_mfma_f32_16x16x32_bf16 a[108:111], a[176:179], v[24:27], a[108:111]
  v_cvt_pk_bf16_f32 v115, v118, v119
  v_mfma_f32_16x16x32_bf16 a[112:115], a[184:187], v[0:3], a[112:115]
  v_exp_f32 v124, v124
  v_mfma_f32_16x16x32_bf16 a[112:115], a[188:191], v[32:35], a[112:115]
  v_mfma_f32_16x16x32_bf16 a[116:119], a[188:191], v[40:43], a[116:119]
  s_sub_u32 s32, s32, 1
  v_exp_f32 v125, v125
  v_mfma_f32_16x16x32_bf16 a[116:119], a[184:187], v[8:11], a[116:119]
  v_cvt_pk_bf16_f32 v122, v124, v125
  v_mfma_f32_16x16x32_bf16 a[120:123], a[184:187], v[16:19], a[120:123]
  s_cmp_lg_u32 s32, 0
  v_exp_f32 v126, v126
  v_mfma_f32_16x16x32_bf16 a[120:123], a[188:191], v[48:51], a[120:123]
  v_mfma_f32_16x16x32_bf16 a[124:127], a[188:191], v[56:59], a[124:127]
  s_waitcnt lgkmcnt(0)
  v_exp_f32 v127, v127
  v_mfma_f32_16x16x32_bf16 a[124:127], a[184:187], v[24:27], a[124:127]
  v_cvt_pk_bf16_f32 v123, v126, v127
  s_cbranch_scc1 attn_loop
  s_waitcnt vmcnt(1)
  v_readfirstlane_b32 s38, v254
  s_nop 0
  s_cmp_ge_u32 s38, 512
  s_cbranch_scc1 attn_h_ready
  s_mov_b32 s39, 32768
attn_spin:
  s_sleep 4
  buffer_load_dword v254, off, s[24:27], s47 sc1
  s_waitcnt vmcnt(0)
  v_readfirstlane_b32 s38, v254
  s_nop 0
  s_cmp_ge_u32 s38, 512
  s_cbranch_scc1 attn_h_ready
  s_sub_u32 s39, s39, 1
  s_cmp_lg_u32 s39, 0
  s_cbranch_scc1 attn_spin
attn_h_ready:
  v_mfma_f32_16x16x32_bf16 v[0:3], a[128:131], v[128:131], v[192:195]
  s_add_u32 m0, s28, 81920
  s_and_b32 s38, s2, 1
  s_lshl_b32 s38, s38, 2
  v_lshrrev_b32 v224, 4, v242
  v_and_b32 v225, 7, v224
  v_mfma_f32_16x16x32_bf16 v[0:3], a[132:135], v[132:135], v[0:3]
  ds_read_b128 a[144:147], v212 offset:4096
  s_add_u32 s38, s38, s3
  s_mul_i32 s38, s38, 81920
  s_lshr_b32 s39, s2, 5
  v_mul_u32_u24 v225, 0xd80, v225
  v_mfma_f32_16x16x32_bf16 v[0:3], a[136:139], v[136:139], v[0:3]
  buffer_load_dwordx4 v236, s[16:19], s29 offen offset:0 lds
  s_mul_i32 s39, s39, 655360
  s_add_u32 s38, s38, s39
  s_add_u32 s4, s38, 3145728
  v_mfma_f32_16x16x32_bf16 v[0:3], a[140:143], v[140:143], v[0:3]
  ds_read_b128 a[148:151], v213 offset:4096
  s_add_u32 s5, s4, 12288
  s_add_u32 s6, s4, 24576
  s_add_u32 s7, s4, 36864
  v_lshrrev_b32 v224, 4, v224
  v_mfma_f32_16x16x32_bf16 v[8:11], a[140:143], v[156:159], v[196:199]
  s_add_u32 s8, s4, 49152
  s_add_u32 s9, s4, 61440
  s_add_u32 s10, s4, 73728
  v_lshl_add_u32 v225, v224, 4, v225
  v_add_u32 v252, 4096, v242
  v_mfma_f32_16x16x32_bf16 v[8:11], a[136:139], v[152:155], v[8:11]
  ds_read_b128 a[152:155], v214 offset:4096
  buffer_load_dwordx4 a[212:215], v225, s[24:27], s101 offen offset:0 sc1
  v_mfma_f32_16x16x32_bf16 v[8:11], a[132:135], v[148:151], v[8:11]
  buffer_load_dwordx4 v237, s[16:19], s29 offen offset:1024 lds
  v_mfma_f32_16x16x32_bf16 v[8:11], a[128:131], v[144:147], v[8:11]
  ds_read_b128 a[156:159], v215 offset:4096
  buffer_load_dwordx4 a[216:219], v225, s[24:27], s101 offen offset:64 sc1
  v_mfma_f32_16x16x32_bf16 v[16:19], a[128:131], v[160:163], v[200:203]
  v_exp_f32 v0, v0
  v_mfma_f32_16x16x32_bf16 v[16:19], a[132:135], v[164:167], v[16:19]
  buffer_load_dwordx4 a[220:223], v225, s[24:27], s101 offen offset:128 sc1
  v_mfma_f32_16x16x32_bf16 v[16:19], a[136:139], v[168:171], v[16:19]
  v_exp_f32 v1, v1
  v_mfma_f32_16x16x32_bf16 v[16:19], a[140:143], v[172:175], v[16:19]
  v_cvt_pk_bf16_f32 v0, v0, v1
  v_add_u32 v253, 8192, v242
  v_mfma_f32_16x16x32_bf16 v[24:27], a[140:143], v[188:191], v[204:207]
  v_exp_f32 v2, v2
  v_mfma_f32_16x16x32_bf16 v[24:27], a[136:139], v[184:187], v[24:27]
  buffer_load_dwordx4 v236, s[16:19], s29 offen offset:2048 lds
  v_mfma_f32_16x16x32_bf16 v[24:27], a[132:135], v[180:183], v[24:27]
  s_waitcnt lgkmcnt(0)
  v_exp_f32 v3, v3
  v_mfma_f32_16x16x32_bf16 v[24:27], a[128:131], v[176:179], v[24:27]
  v_cvt_pk_bf16_f32 v1, v2, v3
  v_mfma_f32_16x16x32_bf16 v[4:7], a[144:147], v[128:131], v[192:195]
  v_exp_f32 v8, v8
  v_mfma_f32_16x16x32_bf16 v[4:7], a[148:151], v[132:135], v[4:7]
  ds_read_b128 a[128:131], v212 offset:8192
  v_mfma_f32_16x16x32_bf16 v[4:7], a[152:155], v[136:139], v[4:7]
  v_exp_f32 v9, v9
  v_mfma_f32_16x16x32_bf16 v[4:7], a[156:159], v[140:143], v[4:7]
  ds_read_b128 a[132:135], v213 offset:8192
  v_cvt_pk_bf16_f32 v8, v8, v9
  v_mfma_f32_16x16x32_bf16 v[12:15], a[156:159], v[156:159], v[196:199]
  v_exp_f32 v10, v10
  v_mfma_f32_16x16x32_bf16 v[12:15], a[152:155], v[152:155], v[12:15]
  ds_read_b128 a[136:139], v214 offset:8192
  v_mfma_f32_16x16x32_bf16 v[12:15], a[148:151], v[148:151], v[12:15]
  v_exp_f32 v11, v11
  v_mfma_f32_16x16x32_bf16 v[12:15], a[144:147], v[144:147], v[12:15]
  ds_read_b128 a[140:143], v215 offset:8192
  v_cvt_pk_bf16_f32 v9, v10, v11
  v_mfma_f32_16x16x32_bf16 v[20:23], a[144:147], v[160:163], v[200:203]
  v_exp_f32 v16, v16
  v_mfma_f32_16x16x32_bf16 v[20:23], a[148:151], v[164:167], v[20:23]
  buffer_load_dwordx4 v237, s[16:19], s29 offen offset:3072 lds
  v_mfma_f32_16x16x32_bf16 v[20:23], a[152:155], v[168:171], v[20:23]
  s_add_u32 s29, s29, 16384
  v_exp_f32 v17, v17
  v_mfma_f32_16x16x32_bf16 v[20:23], a[156:159], v[172:175], v[20:23]
  v_cvt_pk_bf16_f32 v16, v16, v17
  v_mfma_f32_16x16x32_bf16 v[28:31], a[156:159], v[188:191], v[204:207]
  s_add_u32 m0, s28, 32768
  v_exp_f32 v18, v18
  v_mfma_f32_16x16x32_bf16 v[28:31], a[152:155], v[184:187], v[28:31]
  buffer_load_dwordx4 v232, s[12:15], s29 offen offset:0 lds
  v_mfma_f32_16x16x32_bf16 v[28:31], a[148:151], v[180:183], v[28:31]
  s_waitcnt lgkmcnt(0)
  v_exp_f32 v19, v19
  v_mfma_f32_16x16x32_bf16 v[28:31], a[144:147], v[176:179], v[28:31]
  v_cvt_pk_bf16_f32 v17, v18, v19
  v_mfma_f32_16x16x32_bf16 v[32:35], a[128:131], v[128:131], v[192:195]
  v_exp_f32 v24, v24
  v_mfma_f32_16x16x32_bf16 v[32:35], a[132:135], v[132:135], v[32:35]
  ds_read_b128 a[144:147], v212 offset:12288
  v_mfma_f32_16x16x32_bf16 v[32:35], a[136:139], v[136:139], v[32:35]
  v_exp_f32 v25, v25
  v_mfma_f32_16x16x32_bf16 v[32:35], a[140:143], v[140:143], v[32:35]
  ds_read_b128 a[148:151], v213 offset:12288
  v_cvt_pk_bf16_f32 v24, v24, v25
  v_mfma_f32_16x16x32_bf16 v[40:43], a[140:143], v[156:159], v[196:199]
  v_exp_f32 v26, v26
  v_mfma_f32_16x16x32_bf16 v[40:43], a[136:139], v[152:155], v[40:43]
  ds_read_b128 a[152:155], v214 offset:12288
  v_mfma_f32_16x16x32_bf16 v[40:43], a[132:135], v[148:151], v[40:43]
  v_exp_f32 v27, v27
  v_mfma_f32_16x16x32_bf16 v[40:43], a[128:131], v[144:147], v[40:43]
  ds_read_b128 a[156:159], v215 offset:12288
  v_cvt_pk_bf16_f32 v25, v26, v27
  v_mfma_f32_16x16x32_bf16 v[48:51], a[128:131], v[160:163], v[200:203]
  v_exp_f32 v4, v4
  v_mfma_f32_16x16x32_bf16 v[48:51], a[132:135], v[164:167], v[48:51]
  buffer_load_dwordx4 v233, s[12:15], s29 offen offset:1024 lds
  v_mfma_f32_16x16x32_bf16 v[48:51], a[136:139], v[168:171], v[48:51]
  v_exp_f32 v5, v5
  v_mfma_f32_16x16x32_bf16 v[48:51], a[140:143], v[172:175], v[48:51]
  v_cvt_pk_bf16_f32 v2, v4, v5
  v_mfma_f32_16x16x32_bf16 v[56:59], a[140:143], v[188:191], v[204:207]
  v_exp_f32 v6, v6
  v_mfma_f32_16x16x32_bf16 v[56:59], a[136:139], v[184:187], v[56:59]
  buffer_load_dwordx4 v234, s[12:15], s29 offen offset:2048 lds
  v_mfma_f32_16x16x32_bf16 v[56:59], a[132:135], v[180:183], v[56:59]
  s_waitcnt lgkmcnt(0)
  v_exp_f32 v7, v7
  v_mfma_f32_16x16x32_bf16 v[56:59], a[128:131], v[176:179], v[56:59]
  v_cvt_pk_bf16_f32 v3, v6, v7
  v_mfma_f32_16x16x32_bf16 v[36:39], a[144:147], v[128:131], v[192:195]
  v_exp_f32 v12, v12
  v_mfma_f32_16x16x32_bf16 v[36:39], a[148:151], v[132:135], v[36:39]
  ds_read_b64_tr_b16 a[160:161], v216 offset:49152
  v_mfma_f32_16x16x32_bf16 v[36:39], a[152:155], v[136:139], v[36:39]
  v_exp_f32 v13, v13
  v_mfma_f32_16x16x32_bf16 v[36:39], a[156:159], v[140:143], v[36:39]
  ds_read_b64_tr_b16 a[162:163], v216 offset:53248
  v_cvt_pk_bf16_f32 v10, v12, v13
  v_mfma_f32_16x16x32_bf16 v[44:47], a[156:159], v[156:159], v[196:199]
  v_exp_f32 v14, v14
  v_mfma_f32_16x16x32_bf16 v[44:47], a[152:155], v[152:155], v[44:47]
  ds_read_b64_tr_b16 a[164:165], v216 offset:57344
  buffer_load_dwordx4 v235, s[12:15], s29 offen offset:3072 lds
  v_mfma_f32_16x16x32_bf16 v[44:47], a[148:151], v[148:151], v[44:47]
  v_exp_f32 v15, v15
  v_mfma_f32_16x16x32_bf16 v[44:47], a[144:147], v[144:147], v[44:47]
  ds_read_b64_tr_b16 a[166:167], v216 offset:61440
  v_cvt_pk_bf16_f32 v11, v14, v15
  v_mfma_f32_16x16x32_bf16 v[52:55], a[144:147], v[160:163], v[200:203]
  v_exp_f32 v20, v20
  v_mfma_f32_16x16x32_bf16 v[52:55], a[148:151], v[164:167], v[52:55]
  ds_read_b64_tr_b16 a[168:169], v217 offset:49152
  v_mfma_f32_16x16x32_bf16 v[52:55], a[152:155], v[168:171], v[52:55]
  v_exp_f32 v21, v21
  v_mfma_f32_16x16x32_bf16 v[52:55], a[156:159], v[172:175], v[52:55]
  ds_read_b64_tr_b16 a[170:171], v217 offset:53248
  v_cvt_pk_bf16_f32 v18, v20, v21
  v_mfma_f32_16x16x32_bf16 v[60:63], a[156:159], v[188:191], v[204:207]
  v_exp_f32 v22, v22
  v_mfma_f32_16x16x32_bf16 v[60:63], a[152:155], v[184:187], v[60:63]
  ds_read_b64_tr_b16 a[172:173], v217 offset:57344
  v_mfma_f32_16x16x32_bf16 v[60:63], a[148:151], v[180:183], v[60:63]
  v_exp_f32 v23, v23
  v_mfma_f32_16x16x32_bf16 v[60:63], a[144:147], v[176:179], v[60:63]
  ds_read_b64_tr_b16 a[174:175], v217 offset:61440
  v_cvt_pk_bf16_f32 v19, v22, v23
  v_mfma_f32_16x16x32_bf16 a[192:195], a[208:211], v[64:67], a[192:195]
  v_exp_f32 v28, v28
  v_mfma_f32_16x16x32_bf16 a[192:195], a[208:211], v[96:99], a[192:195]
  ds_read_b64_tr_b16 a[176:177], v218 offset:49152
  v_mfma_f32_16x16x32_bf16 a[196:199], a[208:211], v[72:75], a[196:199]
  v_exp_f32 v29, v29
  v_mfma_f32_16x16x32_bf16 a[196:199], a[208:211], v[104:107], a[196:199]
  ds_read_b64_tr_b16 a[178:179], v218 offset:53248
  v_cvt_pk_bf16_f32 v26, v28, v29
  v_mfma_f32_16x16x32_bf16 a[200:203], a[208:211], v[80:83], a[200:203]
  v_exp_f32 v30, v30
  v_mfma_f32_16x16x32_bf16 a[200:203], a[208:211], v[112:115], a[200:203]
  ds_read_b64_tr_b16 a[180:181], v218 offset:57344
  v_mfma_f32_16x16x32_bf16 a[204:207], a[208:211], v[88:91], a[204:207]
  s_waitcnt lgkmcnt(7)
  v_exp_f32 v31, v31
  v_mfma_f32_16x16x32_bf16 a[204:207], a[208:211], v[120:123], a[204:207]
  ds_read_b64_tr_b16 a[182:183], v218 offset:61440
  v_cvt_pk_bf16_f32 v27, v30, v31
  v_mfma_f32_16x16x32_bf16 a[0:3], a[160:163], v[64:67], a[0:3]
  v_exp_f32 v32, v32
  v_mfma_f32_16x16x32_bf16 a[0:3], a[164:167], v[96:99], a[0:3]
  ds_read_b64_tr_b16 a[184:185], v219 offset:49152
  v_mfma_f32_16x16x32_bf16 a[4:7], a[164:167], v[104:107], a[4:7]
  v_exp_f32 v33, v33
  v_mfma_f32_16x16x32_bf16 a[4:7], a[160:163], v[72:75], a[4:7]
  ds_read_b64_tr_b16 a[186:187], v219 offset:53248
  v_cvt_pk_bf16_f32 v32, v32, v33
  v_mfma_f32_16x16x32_bf16 a[8:11], a[160:163], v[80:83], a[8:11]
  v_exp_f32 v34, v34
  v_mfma_f32_16x16x32_bf16 a[8:11], a[164:167], v[112:115], a[8:11]
  ds_read_b64_tr_b16 a[188:189], v219 offset:57344
  v_mfma_f32_16x16x32_bf16 a[12:15], a[164:167], v[120:123], a[12:15]
  s_waitcnt lgkmcnt(7)
  v_exp_f32 v35, v35
  v_mfma_f32_16x16x32_bf16 a[12:15], a[160:163], v[88:91], a[12:15]
  ds_read_b64_tr_b16 a[190:191], v219 offset:61440
  v_cvt_pk_bf16_f32 v33, v34, v35
  v_mfma_f32_16x16x32_bf16 a[16:19], a[168:171], v[64:67], a[16:19]
  v_exp_f32 v40, v40
  v_mfma_f32_16x16x32_bf16 a[16:19], a[172:175], v[96:99], a[16:19]
  ds_read_b64_tr_b16 a[160:161], v220 offset:49152
  v_mfma_f32_16x16x32_bf16 a[20:23], a[172:175], v[104:107], a[20:23]
  v_exp_f32 v41, v41
  v_mfma_f32_16x16x32_bf16 a[20:23], a[168:171], v[72:75], a[20:23]
  ds_read_b64_tr_b16 a[162:163], v220 offset:53248
  v_cvt_pk_bf16_f32 v40, v40, v41
  v_mfma_f32_16x16x32_bf16 a[24:27], a[168:171], v[80:83], a[24:27]
  v_exp_f32 v42, v42
  v_mfma_f32_16x16x32_bf16 a[24:27], a[172:175], v[112:115], a[24:27]
  ds_read_b64_tr_b16 a[164:165], v220 offset:57344
  v_mfma_f32_16x16x32_bf16 a[28:31], a[172:175], v[120:123], a[28:31]
  s_waitcnt lgkmcnt(7)
  v_exp_f32 v43, v43
  v_mfma_f32_16x16x32_bf16 a[28:31], a[168:171], v[88:91], a[28:31]
  ds_read_b64_tr_b16 a[166:167], v220 offset:61440
  v_cvt_pk_bf16_f32 v41, v42, v43
  v_mfma_f32_16x16x32_bf16 a[32:35], a[176:179], v[64:67], a[32:35]
  v_exp_f32 v48, v48
  v_mfma_f32_16x16x32_bf16 a[32:35], a[180:183], v[96:99], a[32:35]
  ds_read_b64_tr_b16 a[168:169], v221 offset:49152
  v_mfma_f32_16x16x32_bf16 a[36:39], a[180:183], v[104:107], a[36:39]
  v_exp_f32 v49, v49
  v_mfma_f32_16x16x32_bf16 a[36:39], a[176:179], v[72:75], a[36:39]
  ds_read_b64_tr_b16 a[170:171], v221 offset:53248
  v_cvt_pk_bf16_f32 v48, v48, v49
  v_mfma_f32_16x16x32_bf16 a[40:43], a[176:179], v[80:83], a[40:43]
  v_exp_f32 v50, v50
  v_mfma_f32_16x16x32_bf16 a[40:43], a[180:183], v[112:115], a[40:43]
  ds_read_b64_tr_b16 a[172:173], v221 offset:57344
  v_mfma_f32_16x16x32_bf16 a[44:47], a[180:183], v[120:123], a[44:47]
  s_waitcnt lgkmcnt(7)
  v_exp_f32 v51, v51
  v_mfma_f32_16x16x32_bf16 a[44:47], a[176:179], v[88:91], a[44:47]
  ds_read_b64_tr_b16 a[174:175], v221 offset:61440
  v_cvt_pk_bf16_f32 v49, v50, v51
  v_mfma_f32_16x16x32_bf16 a[48:51], a[184:187], v[64:67], a[48:51]
  v_exp_f32 v56, v56
  v_mfma_f32_16x16x32_bf16 a[48:51], a[188:191], v[96:99], a[48:51]
  ds_read_b64_tr_b16 a[176:177], v222 offset:49152
  v_mfma_f32_16x16x32_bf16 a[52:55], a[188:191], v[104:107], a[52:55]
  v_exp_f32 v57, v57
  v_mfma_f32_16x16x32_bf16 a[52:55], a[184:187], v[72:75], a[52:55]
  ds_read_b64_tr_b16 a[178:179], v222 offset:53248
  v_cvt_pk_bf16_f32 v56, v56, v57
  v_mfma_f32_16x16x32_bf16 a[56:59], a[184:187], v[80:83], a[56:59]
  v_exp_f32 v58, v58
  v_mfma_f32_16x16x32_bf16 a[56:59], a[188:191], v[112:115], a[56:59]
  ds_read_b64_tr_b16 a[180:181], v222 offset:57344
  v_mfma_f32_16x16x32_bf16 a[60:63], a[188:191], v[120:123], a[60:63]
  s_waitcnt lgkmcnt(7)
  v_exp_f32 v59, v59
  v_mfma_f32_16x16x32_bf16 a[60:63], a[184:187], v[88:91], a[60:63]
  ds_read_b64_tr_b16 a[182:183], v222 offset:61440
  v_cvt_pk_bf16_f32 v57, v58, v59
  v_mfma_f32_16x16x32_bf16 a[64:67], a[160:163], v[64:67], a[64:67]
  v_exp_f32 v36, v36
  v_mfma_f32_16x16x32_bf16 a[64:67], a[164:167], v[96:99], a[64:67]
  ds_read_b64_tr_b16 a[184:185], v223 offset:49152
  v_mfma_f32_16x16x32_bf16 a[68:71], a[164:167], v[104:107], a[68:71]
  v_exp_f32 v37, v37
  v_mfma_f32_16x16x32_bf16 a[68:71], a[160:163], v[72:75], a[68:71]
  ds_read_b64_tr_b16 a[186:187], v223 offset:53248
  v_cvt_pk_bf16_f32 v34, v36, v37
  v_mfma_f32_16x16x32_bf16 a[72:75], a[160:163], v[80:83], a[72:75]
  v_exp_f32 v38, v38
  v_mfma_f32_16x16x32_bf16 a[72:75], a[164:167], v[112:115], a[72:75]
  ds_read_b64_tr_b16 a[188:189], v223 offset:57344
  v_mfma_f32_16x16x32_bf16 a[76:79], a[164:167], v[120:123], a[76:79]
  s_waitcnt lgkmcnt(7)
  v_exp_f32 v39, v39
  v_mfma_f32_16x16x32_bf16 a[76:79], a[160:163], v[88:91], a[76:79]
  ds_read_b64_tr_b16 a[190:191], v223 offset:61440
  v_cvt_pk_bf16_f32 v35, v38, v39
  v_mfma_f32_16x16x32_bf16 a[80:83], a[168:171], v[64:67], a[80:83]
  v_exp_f32 v44, v44
  v_mfma_f32_16x16x32_bf16 a[80:83], a[172:175], v[96:99], a[80:83]
  v_mfma_f32_16x16x32_bf16 a[84:87], a[172:175], v[104:107], a[84:87]
  s_barrier
  v_exp_f32 v45, v45
  v_mfma_f32_16x16x32_bf16 a[84:87], a[168:171], v[72:75], a[84:87]
  ds_read_b128 a[128:131], v212 offset:16384
  v_cvt_pk_bf16_f32 v42, v44, v45
  v_mfma_f32_16x16x32_bf16 a[88:91], a[168:171], v[80:83], a[88:91]
  v_exp_f32 v46, v46
  v_mfma_f32_16x16x32_bf16 a[88:91], a[172:175], v[112:115], a[88:91]
  ds_read_b128 a[132:135], v213 offset:16384
  v_mfma_f32_16x16x32_bf16 a[92:95], a[172:175], v[120:123], a[92:95]
  s_waitcnt lgkmcnt(6)
  v_exp_f32 v47, v47
  v_mfma_f32_16x16x32_bf16 a[92:95], a[168:171], v[88:91], a[92:95]
  ds_read_b128 a[136:139], v214 offset:16384
  v_cvt_pk_bf16_f32 v43, v46, v47
  v_mfma_f32_16x16x32_bf16 a[96:99], a[176:179], v[64:67], a[96:99]
  v_exp_f32 v52, v52
  v_mfma_f32_16x16x32_bf16 a[96:99], a[180:183], v[96:99], a[96:99]
  ds_read_b128 a[140:143], v215 offset:16384
  v_mfma_f32_16x16x32_bf16 a[100:103], a[180:183], v[104:107], a[100:103]
  v_exp_f32 v53, v53
  v_mfma_f32_16x16x32_bf16 a[100:103], a[176:179], v[72:75], a[100:103]
  v_cvt_pk_bf16_f32 v50, v52, v53
  v_mfma_f32_16x16x32_bf16 a[104:107], a[176:179], v[80:83], a[104:107]
  v_exp_f32 v54, v54
  v_mfma_f32_16x16x32_bf16 a[104:107], a[180:183], v[112:115], a[104:107]
  v_mfma_f32_16x16x32_bf16 a[108:111], a[180:183], v[120:123], a[108:111]
  s_waitcnt lgkmcnt(4)
  v_exp_f32 v55, v55
  v_mfma_f32_16x16x32_bf16 a[108:111], a[176:179], v[88:91], a[108:111]
  v_cvt_pk_bf16_f32 v51, v54, v55
  v_mfma_f32_16x16x32_bf16 a[112:115], a[184:187], v[64:67], a[112:115]
  v_exp_f32 v60, v60
  v_mfma_f32_16x16x32_bf16 a[112:115], a[188:191], v[96:99], a[112:115]
  v_mfma_f32_16x16x32_bf16 a[116:119], a[188:191], v[104:107], a[116:119]
  v_exp_f32 v61, v61
  v_mfma_f32_16x16x32_bf16 a[116:119], a[184:187], v[72:75], a[116:119]
  v_cvt_pk_bf16_f32 v58, v60, v61
  v_mfma_f32_16x16x32_bf16 a[120:123], a[184:187], v[80:83], a[120:123]
  v_exp_f32 v62, v62
  v_mfma_f32_16x16x32_bf16 a[120:123], a[188:191], v[112:115], a[120:123]
  v_mfma_f32_16x16x32_bf16 a[124:127], a[188:191], v[120:123], a[124:127]
  s_waitcnt lgkmcnt(0)
  v_exp_f32 v63, v63
  v_mfma_f32_16x16x32_bf16 a[124:127], a[184:187], v[88:91], a[124:127]
  v_cvt_pk_bf16_f32 v59, v62, v63
  v_mfma_f32_16x16x32_bf16 v[64:67], a[128:131], v[128:131], v[192:195]
  s_add_u32 m0, s28, 98304
  v_mfma_f32_16x16x32_bf16 v[64:67], a[132:135], v[132:135], v[64:67]
  ds_read_b128 a[144:147], v212 offset:20480
  v_mfma_f32_16x16x32_bf16 v[64:67], a[136:139], v[136:139], v[64:67]
  buffer_load_dwordx4 v236, s[16:19], s29 offen offset:0 lds
  v_mfma_f32_16x16x32_bf16 v[64:67], a[140:143], v[140:143], v[64:67]
  ds_read_b128 a[148:151], v213 offset:20480
  v_mfma_f32_16x16x32_bf16 v[72:75], a[140:143], v[156:159], v[196:199]
  v_mfma_f32_16x16x32_bf16 v[72:75], a[136:139], v[152:155], v[72:75]
  ds_read_b128 a[152:155], v214 offset:20480
  v_mfma_f32_16x16x32_bf16 v[72:75], a[132:135], v[148:151], v[72:75]
  buffer_load_dwordx4 v237, s[16:19], s29 offen offset:1024 lds
  v_mfma_f32_16x16x32_bf16 v[72:75], a[128:131], v[144:147], v[72:75]
  ds_read_b128 a[156:159], v215 offset:20480
  v_mfma_f32_16x16x32_bf16 v[80:83], a[128:131], v[160:163], v[200:203]
  v_exp_f32 v64, v64
  v_mfma_f32_16x16x32_bf16 v[80:83], a[132:135], v[164:167], v[80:83]
  v_mfma_f32_16x16x32_bf16 v[80:83], a[136:139], v[168:171], v[80:83]
  v_exp_f32 v65, v65
  v_mfma_f32_16x16x32_bf16 v[80:83], a[140:143], v[172:175], v[80:83]
  v_cvt_pk_bf16_f32 v64, v64, v65
  v_mfma_f32_16x16x32_bf16 v[88:91], a[140:143], v[188:191], v[204:207]
  v_exp_f32 v66, v66
  v_mfma_f32_16x16x32_bf16 v[88:91], a[136:139], v[184:187], v[88:91]
  buffer_load_dwordx4 v236, s[16:19], s29 offen offset:2048 lds
  v_mfma_f32_16x16x32_bf16 v[88:91], a[132:135], v[180:183], v[88:91]
  s_waitcnt lgkmcnt(0)
  v_exp_f32 v67, v67
  v_mfma_f32_16x16x32_bf16 v[88:91], a[128:131], v[176:179], v[88:91]
  v_cvt_pk_bf16_f32 v65, v66, v67
  v_mfma_f32_16x16x32_bf16 v[68:71], a[144:147], v[128:131], v[192:195]
  v_exp_f32 v72, v72
  v_mfma_f32_16x16x32_bf16 v[68:71], a[148:151], v[132:135], v[68:71]
  ds_read_b128 a[128:131], v212 offset:24576
  v_mfma_f32_16x16x32_bf16 v[68:71], a[152:155], v[136:139], v[68:71]
  v_exp_f32 v73, v73
  v_mfma_f32_16x16x32_bf16 v[68:71], a[156:159], v[140:143], v[68:71]
  ds_read_b128 a[132:135], v213 offset:24576
  v_cvt_pk_bf16_f32 v72, v72, v73
  v_mfma_f32_16x16x32_bf16 v[76:79], a[156:159], v[156:159], v[196:199]
  v_exp_f32 v74, v74
  v_mfma_f32_16x16x32_bf16 v[76:79], a[152:155], v[152:155], v[76:79]
  ds_read_b128 a[136:139], v214 offset:24576
  v_lshrrev_b32 v224, 4, v242
  v_mfma_f32_16x16x32_bf16 v[76:79], a[148:151], v[148:151], v[76:79]
  v_exp_f32 v75, v75
  v_mfma_f32_16x16x32_bf16 v[76:79], a[144:147], v[144:147], v[76:79]
  ds_read_b128 a[140:143], v215 offset:24576
  v_cvt_pk_bf16_f32 v73, v74, v75
  v_mfma_f32_16x16x32_bf16 v[84:87], a[144:147], v[160:163], v[200:203]
  v_exp_f32 v80, v80
  v_mfma_f32_16x16x32_bf16 v[84:87], a[148:151], v[164:167], v[84:87]
  buffer_load_dwordx4 v237, s[16:19], s29 offen offset:3072 lds
  v_mfma_f32_16x16x32_bf16 v[84:87], a[152:155], v[168:171], v[84:87]
  s_add_u32 s29, s29, 16384
  v_exp_f32 v81, v81
  v_mfma_f32_16x16x32_bf16 v[84:87], a[156:159], v[172:175], v[84:87]
  v_cvt_pk_bf16_f32 v80, v80, v81
  v_lshrrev_b32 v225, 4, v224
  v_mfma_f32_16x16x32_bf16 v[92:95], a[156:159], v[188:191], v[204:207]
  s_add_u32 m0, s28, 49152
  v_exp_f32 v82, v82
  v_mfma_f32_16x16x32_bf16 v[92:95], a[152:155], v[184:187], v[92:95]
  buffer_load_dwordx4 v232, s[12:15], s29 offen offset:0 lds
  v_mfma_f32_16x16x32_bf16 v[92:95], a[148:151], v[180:183], v[92:95]
  s_waitcnt lgkmcnt(0)
  v_exp_f32 v83, v83
  v_mfma_f32_16x16x32_bf16 v[92:95], a[144:147], v[176:179], v[92:95]
  v_cvt_pk_bf16_f32 v81, v82, v83
  v_bfe_u32 v226, v224, 2, 2
  v_mfma_f32_16x16x32_bf16 v[96:99], a[128:131], v[128:131], v[192:195]
  v_exp_f32 v88, v88
  v_mfma_f32_16x16x32_bf16 v[96:99], a[132:135], v[132:135], v[96:99]
  ds_read_b128 a[144:147], v212 offset:28672
  v_lshl_add_u32 v225, v225, 3, v226
  v_mfma_f32_16x16x32_bf16 v[96:99], a[136:139], v[136:139], v[96:99]
  v_exp_f32 v89, v89
  v_mfma_f32_16x16x32_bf16 v[96:99], a[140:143], v[140:143], v[96:99]
  ds_read_b128 a[148:151], v213 offset:28672
  v_cvt_pk_bf16_f32 v88, v88, v89
  v_mfma_f32_16x16x32_bf16 v[104:107], a[140:143], v[156:159], v[196:199]
  v_exp_f32 v90, v90
  v_mfma_f32_16x16x32_bf16 v[104:107], a[136:139], v[152:155], v[104:107]
  ds_read_b128 a[152:155], v214 offset:28672
  v_lshlrev_b32 v225, 5, v225
  v_mfma_f32_16x16x32_bf16 v[104:107], a[132:135], v[148:151], v[104:107]
  v_exp_f32 v91, v91
  v_mfma_f32_16x16x32_bf16 v[104:107], a[128:131], v[144:147], v[104:107]
  ds_read_b128 a[156:159], v215 offset:28672
  v_cvt_pk_bf16_f32 v89, v90, v91
  v_mfma_f32_16x16x32_bf16 v[112:115], a[128:131], v[160:163], v[200:203]
  v_exp_f32 v68, v68
  v_mfma_f32_16x16x32_bf16 v[112:115], a[132:135], v[164:167], v[112:115]
  buffer_load_dwordx4 v233, s[12:15], s29 offen offset:1024 lds
  v_mfma_f32_16x16x32_bf16 v[112:115], a[136:139], v[168:171], v[112:115]
  v_exp_f32 v69, v69
  v_mfma_f32_16x16x32_bf16 v[112:115], a[140:143], v[172:175], v[112:115]
  v_cvt_pk_bf16_f32 v66, v68, v69
  v_and_b32 v226, 3, v224
  v_mfma_f32_16x16x32_bf16 v[120:123], a[140:143], v[188:191], v[204:207]
  v_exp_f32 v70, v70
  v_mfma_f32_16x16x32_bf16 v[120:123], a[136:139], v[184:187], v[120:123]
  buffer_load_dwordx4 v234, s[12:15], s29 offen offset:2048 lds
  v_mfma_f32_16x16x32_bf16 v[120:123], a[132:135], v[180:183], v[120:123]
  s_waitcnt lgkmcnt(0)
  v_exp_f32 v71, v71
  v_mfma_f32_16x16x32_bf16 v[120:123], a[128:131], v[176:179], v[120:123]
  v_cvt_pk_bf16_f32 v67, v70, v71
  v_lshl_add_u32 v225, v226, 3, v225
  v_mfma_f32_16x16x32_bf16 v[100:103], a[144:147], v[128:131], v[192:195]
  v_exp_f32 v76, v76
  v_mfma_f32_16x16x32_bf16 v[100:103], a[148:151], v[132:135], v[100:103]
  ds_read_b64_tr_b16 a[160:161], v216 offset:0
  v_add_u32 v225, s50, v225
  v_mfma_f32_16x16x32_bf16 v[100:103], a[152:155], v[136:139], v[100:103]
  s_waitcnt vmcnt(13)
  v_exp_f32 v77, v77
  v_mfma_f32_16x16x32_bf16 v[100:103], a[156:159], v[140:143], v[100:103]
  ds_read_b64_tr_b16 a[162:163], v216 offset:4096
  v_cvt_pk_bf16_f32 v74, v76, v77
  v_mfma_f32_16x16x32_bf16 v[108:111], a[156:159], v[156:159], v[196:199]
  v_exp_f32 v78, v78
  v_mfma_f32_16x16x32_bf16 v[108:111], a[152:155], v[152:155], v[108:111]
  ds_read_b64_tr_b16 a[164:165], v216 offset:8192
  buffer_load_dwordx4 v235, s[12:15], s29 offen offset:3072 lds
  v_mfma_f32_16x16x32_bf16 v[108:111], a[148:151], v[148:151], v[108:111]
  v_exp_f32 v79, v79
  v_mfma_f32_16x16x32_bf16 v[108:111], a[144:147], v[144:147], v[108:111]
  ds_read_b64_tr_b16 a[166:167], v216 offset:12288
  v_cvt_pk_bf16_f32 v75, v78, v79
  v_mfma_f32_16x16x32_bf16 v[116:119], a[144:147], v[160:163], v[200:203]
  v_exp_f32 v84, v84
  v_mfma_f32_16x16x32_bf16 v[116:119], a[148:151], v[164:167], v[116:119]
  ds_read_b64_tr_b16 a[168:169], v217 offset:0
  ds_read_b64_tr_b16 a[232:233], v225 offset:0
  s_add_u32 m0, s28, 0
  v_mfma_f32_16x16x32_bf16 v[116:119], a[152:155], v[168:171], v[116:119]
  v_exp_f32 v85, v85
  v_mfma_f32_16x16x32_bf16 v[116:119], a[156:159], v[172:175], v[116:119]
  ds_read_b64_tr_b16 a[170:171], v217 offset:4096
  v_cvt_pk_bf16_f32 v82, v84, v85
  v_mfma_f32_16x16x32_bf16 v[124:127], a[156:159], v[188:191], v[204:207]
  v_exp_f32 v86, v86
  v_mfma_f32_16x16x32_bf16 v[124:127], a[152:155], v[184:187], v[124:127]
  ds_read_b64_tr_b16 a[172:173], v217 offset:8192
  ds_read_b64_tr_b16 a[234:235], v225 offset:128
  v_mfma_f32_16x16x32_bf16 v[124:127], a[148:151], v[180:183], v[124:127]
  v_exp_f32 v87, v87
  v_mfma_f32_16x16x32_bf16 v[124:127], a[144:147], v[176:179], v[124:127]
  ds_read_b64_tr_b16 a[174:175], v217 offset:12288
  v_cvt_pk_bf16_f32 v83, v86, v87
  v_mfma_f32_16x16x32_bf16 a[192:195], a[208:211], v[0:3], a[192:195]
  v_exp_f32 v92, v92
  v_mfma_f32_16x16x32_bf16 a[192:195], a[208:211], v[32:35], a[192:195]
  ds_read_b64_tr_b16 a[176:177], v218 offset:0
  ds_read_b64_tr_b16 a[236:237], v225 offset:1024
  v_mfma_f32_16x16x32_bf16 a[196:199], a[208:211], v[8:11], a[196:199]
  v_exp_f32 v93, v93
  v_mfma_f32_16x16x32_bf16 a[196:199], a[208:211], v[40:43], a[196:199]
  ds_read_b64_tr_b16 a[178:179], v218 offset:4096
  v_cvt_pk_bf16_f32 v90, v92, v93
  v_mfma_f32_16x16x32_bf16 a[200:203], a[208:211], v[16:19], a[200:203]
  v_exp_f32 v94, v94
  v_mfma_f32_16x16x32_bf16 a[200:203], a[208:211], v[48:51], a[200:203]
  ds_read_b64_tr_b16 a[180:181], v218 offset:8192
  ds_read_b64_tr_b16 a[238:239], v225 offset:1152
  v_mfma_f32_16x16x32_bf16 a[204:207], a[208:211], v[24:27], a[204:207]
  s_waitcnt lgkmcnt(11)
  v_exp_f32 v95, v95
  v_mfma_f32_16x16x32_bf16 a[204:207], a[208:211], v[56:59], a[204:207]
  ds_read_b64_tr_b16 a[182:183], v218 offset:12288
  v_cvt_pk_bf16_f32 v91, v94, v95
  v_mfma_f32_16x16x32_bf16 a[0:3], a[160:163], v[0:3], a[0:3]
  v_exp_f32 v96, v96
  v_mfma_f32_16x16x32_bf16 a[0:3], a[164:167], v[32:35], a[0:3]
  ds_read_b64_tr_b16 a[184:185], v219 offset:0
  ds_read_b64_tr_b16 a[240:241], v225 offset:2048
  v_mfma_f32_16x16x32_bf16 a[4:7], a[164:167], v[40:43], a[4:7]
  v_exp_f32 v97, v97
  v_mfma_f32_16x16x32_bf16 a[4:7], a[160:163], v[8:11], a[4:7]
  ds_read_b64_tr_b16 a[186:187], v219 offset:4096
  v_cvt_pk_bf16_f32 v96, v96, v97
  v_mfma_f32_16x16x32_bf16 a[8:11], a[160:163], v[16:19], a[8:11]
  v_exp_f32 v98, v98
  v_mfma_f32_16x16x32_bf16 a[8:11], a[164:167], v[48:51], a[8:11]
  ds_read_b64_tr_b16 a[188:189], v219 offset:8192
  ds_read_b64_tr_b16 a[242:243], v225 offset:2176
  v_mfma_f32_16x16x32_bf16 a[12:15], a[164:167], v[56:59], a[12:15]
  s_waitcnt lgkmcnt(11)
  v_exp_f32 v99, v99
  v_mfma_f32_16x16x32_bf16 a[12:15], a[160:163], v[24:27], a[12:15]
  ds_read_b64_tr_b16 a[190:191], v219 offset:12288
  v_cvt_pk_bf16_f32 v97, v98, v99
  v_mfma_f32_16x16x32_bf16 a[16:19], a[168:171], v[0:3], a[16:19]
  v_exp_f32 v104, v104
  v_mfma_f32_16x16x32_bf16 a[16:19], a[172:175], v[32:35], a[16:19]
  ds_read_b64_tr_b16 a[160:161], v220 offset:0
  buffer_load_dwordx4 v253, s[24:27], s8 offen offset:0 sc1 lds
  v_mfma_f32_16x16x32_bf16 a[20:23], a[172:175], v[40:43], a[20:23]
  v_exp_f32 v105, v105
  v_mfma_f32_16x16x32_bf16 a[20:23], a[168:171], v[8:11], a[20:23]
  ds_read_b64_tr_b16 a[162:163], v220 offset:4096
  v_cvt_pk_bf16_f32 v104, v104, v105
  v_mfma_f32_16x16x32_bf16 a[24:27], a[168:171], v[16:19], a[24:27]
  v_exp_f32 v106, v106
  v_mfma_f32_16x16x32_bf16 a[24:27], a[172:175], v[48:51], a[24:27]
  ds_read_b64_tr_b16 a[164:165], v220 offset:8192
  s_waitcnt lgkmcnt(4)
  buffer_load_dwordx4 v253, s[24:27], s8 offen offset:1024 sc1 lds
  v_mfma_f32_16x16x32_bf16 v[228:231], a[232:235], a[212:215], 0
  v_mfma_f32_16x16x32_bf16 v[228:231], a[236:239], a[216:219], v[228:231]
  v_mfma_f32_16x16x32_bf16 v[228:231], a[240:243], a[220:223], v[228:231]
  v_mfma_f32_16x16x32_bf16 a[28:31], a[172:175], v[56:59], a[28:31]
  s_lshl_b32 s35, s3, 10
  s_add_u32 s35, s35, 159744
  v_exp_f32 v107, v107
  v_mfma_f32_16x16x32_bf16 a[28:31], a[168:171], v[24:27], a[28:31]
  ds_read_b64_tr_b16 a[166:167], v220 offset:12288
  v_cvt_pk_bf16_f32 v105, v106, v107
  v_mfma_f32_16x16x32_bf16 a[32:35], a[176:179], v[0:3], a[32:35]
  v_exp_f32 v112, v112
  v_mfma_f32_16x16x32_bf16 a[32:35], a[180:183], v[32:35], a[32:35]
  ds_read_b64_tr_b16 a[168:169], v221 offset:0
  buffer_load_dwordx4 v253, s[24:27], s8 offen offset:2048 sc1 lds
  v_mfma_f32_16x16x32_bf16 a[36:39], a[180:183], v[40:43], a[36:39]
  v_exp_f32 v113, v113
  v_mfma_f32_16x16x32_bf16 a[36:39], a[176:179], v[8:11], a[36:39]
  ds_read_b64_tr_b16 a[170:171], v221 offset:4096
  v_cvt_pk_bf16_f32 v112, v112, v113
  v_mfma_f32_16x16x32_bf16 a[40:43], a[176:179], v[16:19], a[40:43]
  v_exp_f32 v114, v114
  v_mfma_f32_16x16x32_bf16 a[40:43], a[180:183], v[48:51], a[40:43]
  ds_read_b64_tr_b16 a[172:173], v221 offset:8192
  buffer_load_dwordx4 v253, s[24:27], s8 offen offset:3072 sc1 lds
  v_mfma_f32_16x16x32_bf16 a[44:47], a[180:183], v[56:59], a[44:47]
  s_waitcnt lgkmcnt(7)
  v_exp_f32 v115, v115
  v_mfma_f32_16x16x32_bf16 a[44:47], a[176:179], v[24:27], a[44:47]
  ds_read_b64_tr_b16 a[174:175], v221 offset:12288
  v_cvt_pk_bf16_f32 v113, v114, v115
  v_mfma_f32_16x16x32_bf16 a[48:51], a[184:187], v[0:3], a[48:51]
  v_exp_f32 v120, v120
  v_mfma_f32_16x16x32_bf16 a[48:51], a[188:191], v[32:35], a[48:51]
  ds_read_b64_tr_b16 a[176:177], v222 offset:0
  v_add_u32 v224, s35, v242
  v_mfma_f32_16x16x32_bf16 a[52:55], a[188:191], v[40:43], a[52:55]
  v_exp_f32 v121, v121
  v_mfma_f32_16x16x32_bf16 a[52:55], a[184:187], v[8:11], a[52:55]
  ds_read_b64_tr_b16 a[178:179], v222 offset:4096
  v_cvt_pk_bf16_f32 v120, v120, v121
  v_mfma_f32_16x16x32_bf16 a[56:59], a[184:187], v[16:19], a[56:59]
  v_exp_f32 v122, v122
  v_mfma_f32_16x16x32_bf16 a[56:59], a[188:191], v[48:51], a[56:59]
  ds_read_b64_tr_b16 a[180:181], v222 offset:8192
  ds_write_b128 v224, v[228:231]
  v_mfma_f32_16x16x32_bf16 a[60:63], a[188:191], v[56:59], a[60:63]
  s_waitcnt lgkmcnt(8)
  v_exp_f32 v123, v123
  v_mfma_f32_16x16x32_bf16 a[60:63], a[184:187], v[24:27], a[60:63]
  ds_read_b64_tr_b16 a[182:183], v222 offset:12288
  v_cvt_pk_bf16_f32 v121, v122, v123
  v_mfma_f32_16x16x32_bf16 a[64:67], a[160:163], v[0:3], a[64:67]
  v_exp_f32 v100, v100
  v_mfma_f32_16x16x32_bf16 a[64:67], a[164:167], v[32:35], a[64:67]
  ds_read_b64_tr_b16 a[184:185], v223 offset:0
  v_mfma_f32_16x16x32_bf16 a[68:71], a[164:167], v[40:43], a[68:71]
  v_exp_f32 v101, v101
  v_mfma_f32_16x16x32_bf16 a[68:71], a[160:163], v[8:11], a[68:71]
  ds_read_b64_tr_b16 a[186:187], v223 offset:4096
  v_cvt_pk_bf16_f32 v98, v100, v101
  v_mfma_f32_16x16x32_bf16 a[72:75], a[160:163], v[16:19], a[72:75]
  v_exp_f32 v102, v102
  v_mfma_f32_16x16x32_bf16 a[72:75], a[164:167], v[48:51], a[72:75]
  ds_read_b64_tr_b16 a[188:189], v223 offset:8192
  s_waitcnt lgkmcnt(4)
  v_mfma_f32_16x16x32_bf16 a[76:79], a[164:167], v[56:59], a[76:79]
  v_exp_f32 v103, v103
  v_mfma_f32_16x16x32_bf16 a[76:79], a[160:163], v[24:27], a[76:79]
  ds_read_b64_tr_b16 a[190:191], v223 offset:12288
  v_cvt_pk_bf16_f32 v99, v102, v103
  v_mfma_f32_16x16x32_bf16 a[80:83], a[168:171], v[0:3], a[80:83]
  s_waitcnt vmcnt(12)
  v_exp_f32 v108, v108
  v_mfma_f32_16x16x32_bf16 a[80:83], a[172:175], v[32:35], a[80:83]
  v_mfma_f32_16x16x32_bf16 a[84:87], a[172:175], v[40:43], a[84:87]
  s_barrier
  v_exp_f32 v109, v109
  v_mfma_f32_16x16x32_bf16 a[84:87], a[168:171], v[8:11], a[84:87]
  ds_read_b128 a[128:131], v212 offset:32768
  v_cvt_pk_bf16_f32 v106, v108, v109
  v_mfma_f32_16x16x32_bf16 a[88:91], a[168:171], v[16:19], a[88:91]
  v_exp_f32 v110, v110
  v_mfma_f32_16x16x32_bf16 a[88:91], a[172:175], v[48:51], a[88:91]
  ds_read_b128 a[132:135], v213 offset:32768
  v_mfma_f32_16x16x32_bf16 a[92:95], a[172:175], v[56:59], a[92:95]
  s_waitcnt lgkmcnt(6)
  v_exp_f32 v111, v111
  v_mfma_f32_16x16x32_bf16 a[92:95], a[168:171], v[24:27], a[92:95]
  ds_read_b128 a[136:139], v214 offset:32768
  v_cvt_pk_bf16_f32 v107, v110, v111
  v_mfma_f32_16x16x32_bf16 a[96:99], a[176:179], v[0:3], a[96:99]
  v_exp_f32 v116, v116
  v_mfma_f32_16x16x32_bf16 a[96:99], a[180:183], v[32:35], a[96:99]
  ds_read_b128 a[140:143], v215 offset:32768
  v_mfma_f32_16x16x32_bf16 a[100:103], a[180:183], v[40:43], a[100:103]
  v_exp_f32 v117, v117
  v_mfma_f32_16x16x32_bf16 a[100:103], a[176:179], v[8:11], a[100:103]
  v_cvt_pk_bf16_f32 v114, v116, v117
  v_mfma_f32_16x16x32_bf16 a[104:107], a[176:179], v[16:19], a[104:107]
  v_exp_f32 v118, v118
  v_mfma_f32_16x16x32_bf16 a[104:107], a[180:183], v[48:51], a[104:107]
  v_mfma_f32_16x16x32_bf16 a[108:111], a[180:183], v[56:59], a[108:111]
  s_waitcnt lgkmcnt(4)
  v_exp_f32 v119, v119
  v_mfma_f32_16x16x32_bf16 a[108:111], a[176:179], v[24:27], a[108:111]
  v_cvt_pk_bf16_f32 v115, v118, v119
  v_mfma_f32_16x16x32_bf16 a[112:115], a[184:187], v[0:3], a[112:115]
  v_exp_f32 v124, v124
  v_mfma_f32_16x16x32_bf16 a[112:115], a[188:191], v[32:35], a[112:115]
  v_mfma_f32_16x16x32_bf16 a[116:119], a[188:191], v[40:43], a[116:119]
  v_exp_f32 v125, v125
  v_mfma_f32_16x16x32_bf16 a[116:119], a[184:187], v[8:11], a[116:119]
  v_cvt_pk_bf16_f32 v122, v124, v125
  v_mfma_f32_16x16x32_bf16 a[120:123], a[184:187], v[16:19], a[120:123]
  v_exp_f32 v126, v126
  v_mfma_f32_16x16x32_bf16 a[120:123], a[188:191], v[48:51], a[120:123]
  v_mfma_f32_16x16x32_bf16 a[124:127], a[188:191], v[56:59], a[124:127]
  s_waitcnt lgkmcnt(0)
  v_exp_f32 v127, v127
  v_mfma_f32_16x16x32_bf16 a[124:127], a[184:187], v[24:27], a[124:127]
  v_cvt_pk_bf16_f32 v123, v126, v127
  v_mfma_f32_16x16x32_bf16 v[0:3], a[128:131], v[128:131], v[192:195]
  s_add_u32 m0, s28, 114688
  v_add_u32 v224, 159744, v242
  v_mfma_f32_16x16x32_bf16 v[0:3], a[132:135], v[132:135], v[0:3]
  ds_read_b128 a[144:147], v212 offset:36864
  ds_read_b128 v[228:231], v224 offset:0
  v_mfma_f32_16x16x32_bf16 v[0:3], a[136:139], v[136:139], v[0:3]
  buffer_load_dwordx4 v236, s[16:19], s29 offen offset:0 lds
  v_mfma_f32_16x16x32_bf16 v[0:3], a[140:143], v[140:143], v[0:3]
  ds_read_b128 a[148:151], v213 offset:36864
  ds_read_b128 v[238:241], v224 offset:1024
  v_mfma_f32_16x16x32_bf16 v[8:11], a[140:143], v[156:159], v[196:199]
  ds_read_b128 v[208:211], v224 offset:2048
  v_lshrrev_b32 v224, 4, v242
  v_mfma_f32_16x16x32_bf16 v[8:11], a[136:139], v[152:155], v[8:11]
  ds_read_b128 a[152:155], v214 offset:36864
  s_min_u32 s35, s3, 1
  s_lshl_b32 s35, s35, 30
  v_and_b32 v225, 7, v224
  v_mfma_f32_16x16x32_bf16 v[8:11], a[132:135], v[148:151], v[8:11]
  buffer_load_dwordx4 v237, s[16:19], s29 offen offset:1024 lds
  v_mfma_f32_16x16x32_bf16 v[8:11], a[128:131], v[144:147], v[8:11]
  ds_read_b128 a[156:159], v215 offset:36864
  v_mul_u32_u24 v225, 0xa00, v225
  v_mfma_f32_16x16x32_bf16 v[16:19], a[128:131], v[160:163], v[200:203]
  v_exp_f32 v0, v0
  v_mfma_f32_16x16x32_bf16 v[16:19], a[132:135], v[164:167], v[16:19]
  v_lshrrev_b32 v226, 4, v224
  v_lshl_add_u32 v225, v226, 4, v225
  v_mfma_f32_16x16x32_bf16 v[16:19], a[136:139], v[168:171], v[16:19]
  v_exp_f32 v1, v1
  v_mfma_f32_16x16x32_bf16 v[16:19], a[140:143], v[172:175], v[16:19]
  v_cvt_pk_bf16_f32 v0, v0, v1
  v_bfe_u32 v226, v224, 3, 1
  v_mfma_f32_16x16x32_bf16 v[24:27], a[140:143], v[188:191], v[204:207]
  v_exp_f32 v2, v2
  v_mfma_f32_16x16x32_bf16 v[24:27], a[136:139], v[184:187], v[24:27]
  buffer_load_dwordx4 v236, s[16:19], s29 offen offset:2048 lds
  v_mfma_f32_16x16x32_bf16 v[24:27], a[132:135], v[180:183], v[24:27]
  s_waitcnt lgkmcnt(0)
  v_exp_f32 v3, v3
  v_mfma_f32_16x16x32_bf16 v[24:27], a[128:131], v[176:179], v[24:27]
  v_cvt_pk_bf16_f32 v1, v2, v3
  v_lshl_add_u32 v225, v226, 30, v225
  v_mfma_f32_16x16x32_bf16 v[4:7], a[144:147], v[128:131], v[192:195]
  v_exp_f32 v8, v8
  v_mfma_f32_16x16x32_bf16 v[4:7], a[148:151], v[132:135], v[4:7]
  ds_read_b128 a[128:131], v212 offset:40960
  v_or_b32 v225, s35, v225
  v_mfma_f32_16x16x32_bf16 v[4:7], a[152:155], v[136:139], v[4:7]
  s_mul_i32 s35, s98, 20480
  s_lshl_b32 s38, s99, 6
  s_add_u32 s35, s35, s38
  v_exp_f32 v9, v9
  v_mfma_f32_16x16x32_bf16 v[4:7], a[156:159], v[140:143], v[4:7]
  ds_read_b128 a[132:135], v213 offset:40960
  s_add_u32 s35, s35, 2686976
  v_cvt_pk_bf16_f32 v8, v8, v9
  v_mfma_f32_16x16x32_bf16 v[12:15], a[156:159], v[156:159], v[196:199]
  v_exp_f32 v10, v10
  v_mfma_f32_16x16x32_bf16 v[12:15], a[152:155], v[152:155], v[12:15]
  ds_read_b128 a[136:139], v214 offset:40960
  v_add_f32 v228, v228, v238
  v_mfma_f32_16x16x32_bf16 v[12:15], a[148:151], v[148:151], v[12:15]
  v_exp_f32 v11, v11
  v_mfma_f32_16x16x32_bf16 v[12:15], a[144:147], v[144:147], v[12:15]
  ds_read_b128 a[140:143], v215 offset:40960
  v_cvt_pk_bf16_f32 v9, v10, v11
  v_mfma_f32_16x16x32_bf16 v[20:23], a[144:147], v[160:163], v[200:203]
  v_exp_f32 v16, v16
  v_mfma_f32_16x16x32_bf16 v[20:23], a[148:151], v[164:167], v[20:23]
  buffer_load_dwordx4 v237, s[16:19], s29 offen offset:3072 lds
  v_mfma_f32_16x16x32_bf16 v[20:23], a[152:155], v[168:171], v[20:23]
  s_add_u32 s29, s29, 16384
  v_exp_f32 v17, v17
  v_mfma_f32_16x16x32_bf16 v[20:23], a[156:159], v[172:175], v[20:23]
  v_cvt_pk_bf16_f32 v16, v16, v17
  v_add_f32 v229, v229, v239
  v_mfma_f32_16x16x32_bf16 v[28:31], a[156:159], v[188:191], v[204:207]
  s_add_u32 m0, s28, 16384
  v_exp_f32 v18, v18
  v_mfma_f32_16x16x32_bf16 v[28:31], a[152:155], v[184:187], v[28:31]
  buffer_load_dwordx4 v242, s[24:27], s9 offen offset:0 sc1 lds
  v_mfma_f32_16x16x32_bf16 v[28:31], a[148:151], v[180:183], v[28:31]
  s_waitcnt lgkmcnt(0)
  v_exp_f32 v19, v19
  v_mfma_f32_16x16x32_bf16 v[28:31], a[144:147], v[176:179], v[28:31]
  v_cvt_pk_bf16_f32 v17, v18, v19
  v_add_f32 v230, v230, v240
  v_mfma_f32_16x16x32_bf16 v[32:35], a[128:131], v[128:131], v[192:195]
  v_exp_f32 v24, v24
  v_mfma_f32_16x16x32_bf16 v[32:35], a[132:135], v[132:135], v[32:35]
  ds_read_b128 a[144:147], v212 offset:45056
  v_add_f32 v231, v231, v241
  v_mfma_f32_16x16x32_bf16 v[32:35], a[136:139], v[136:139], v[32:35]
  v_exp_f32 v25, v25
  v_mfma_f32_16x16x32_bf16 v[32:35], a[140:143], v[140:143], v[32:35]
  ds_read_b128 a[148:151], v213 offset:45056
  v_cvt_pk_bf16_f32 v24, v24, v25
  v_mfma_f32_16x16x32_bf16 v[40:43], a[140:143], v[156:159], v[196:199]
  v_exp_f32 v26, v26
  v_mfma_f32_16x16x32_bf16 v[40:43], a[136:139], v[152:155], v[40:43]
  ds_read_b128 a[152:155], v214 offset:45056
  v_add_f32 v228, v228, v208
  v_mfma_f32_16x16x32_bf16 v[40:43], a[132:135], v[148:151], v[40:43]
  v_exp_f32 v27, v27
  v_mfma_f32_16x16x32_bf16 v[40:43], a[128:131], v[144:147], v[40:43]
  ds_read_b128 a[156:159], v215 offset:45056
  v_cvt_pk_bf16_f32 v25, v26, v27
  v_mfma_f32_16x16x32_bf16 v[48:51], a[128:131], v[160:163], v[200:203]
  v_exp_f32 v4, v4
  v_mfma_f32_16x16x32_bf16 v[48:51], a[132:135], v[164:167], v[48:51]
  buffer_load_dwordx4 v242, s[24:27], s9 offen offset:1024 sc1 lds
  v_mfma_f32_16x16x32_bf16 v[48:51], a[136:139], v[168:171], v[48:51]
  v_exp_f32 v5, v5
  v_mfma_f32_16x16x32_bf16 v[48:51], a[140:143], v[172:175], v[48:51]
  v_cvt_pk_bf16_f32 v2, v4, v5
  v_add_f32 v229, v229, v209
  v_mfma_f32_16x16x32_bf16 v[56:59], a[140:143], v[188:191], v[204:207]
  v_exp_f32 v6, v6
  v_mfma_f32_16x16x32_bf16 v[56:59], a[136:139], v[184:187], v[56:59]
  buffer_load_dwordx4 v242, s[24:27], s9 offen offset:2048 sc1 lds
  v_mfma_f32_16x16x32_bf16 v[56:59], a[132:135], v[180:183], v[56:59]
  s_waitcnt lgkmcnt(0)
  v_exp_f32 v7, v7
  v_mfma_f32_16x16x32_bf16 v[56:59], a[128:131], v[176:179], v[56:59]
  v_cvt_pk_bf16_f32 v3, v6, v7
  v_add_f32 v230, v230, v210
  v_mfma_f32_16x16x32_bf16 v[36:39], a[144:147], v[128:131], v[192:195]
  v_exp_f32 v12, v12
  v_mfma_f32_16x16x32_bf16 v[36:39], a[148:151], v[132:135], v[36:39]
  ds_read_b64_tr_b16 a[160:161], v216 offset:16384
  v_add_f32 v231, v231, v211
  v_mfma_f32_16x16x32_bf16 v[36:39], a[152:155], v[136:139], v[36:39]
  v_exp_f32 v13, v13
  v_mfma_f32_16x16x32_bf16 v[36:39], a[156:159], v[140:143], v[36:39]
  ds_read_b64_tr_b16 a[162:163], v216 offset:20480
  v_cvt_pk_bf16_f32 v10, v12, v13
  v_mfma_f32_16x16x32_bf16 v[44:47], a[156:159], v[156:159], v[196:199]
  v_exp_f32 v14, v14
  v_mfma_f32_16x16x32_bf16 v[44:47], a[152:155], v[152:155], v[44:47]
  ds_read_b64_tr_b16 a[164:165], v216 offset:24576
  buffer_load_dwordx4 v242, s[24:27], s9 offen offset:3072 sc1 lds
  v_mfma_f32_16x16x32_bf16 v[44:47], a[148:151], v[148:151], v[44:47]
  v_exp_f32 v15, v15
  v_mfma_f32_16x16x32_bf16 v[44:47], a[144:147], v[144:147], v[44:47]
  ds_read_b64_tr_b16 a[166:167], v216 offset:28672
  v_cvt_pk_bf16_f32 v11, v14, v15
  v_mfma_f32_16x16x32_bf16 v[52:55], a[144:147], v[160:163], v[200:203]
  v_exp_f32 v20, v20
  v_mfma_f32_16x16x32_bf16 v[52:55], a[148:151], v[164:167], v[52:55]
  ds_read_b64_tr_b16 a[168:169], v217 offset:16384
  buffer_store_dwordx4 v[228:231], v225, s[24:27], s35 offen sc1
  v_mfma_f32_16x16x32_bf16 v[52:55], a[152:155], v[168:171], v[52:55]
  v_exp_f32 v21, v21
  v_mfma_f32_16x16x32_bf16 v[52:55], a[156:159], v[172:175], v[52:55]
  ds_read_b64_tr_b16 a[170:171], v217 offset:20480
  v_cvt_pk_bf16_f32 v18, v20, v21
  v_mfma_f32_16x16x32_bf16 v[60:63], a[156:159], v[188:191], v[204:207]
  v_exp_f32 v22, v22
  v_mfma_f32_16x16x32_bf16 v[60:63], a[152:155], v[184:187], v[60:63]
  ds_read_b64_tr_b16 a[172:173], v217 offset:24576
  buffer_load_dwordx4 a[212:215], v242, s[24:27], s4 offen offset:0 sc1
  v_mfma_f32_16x16x32_bf16 v[60:63], a[148:151], v[180:183], v[60:63]
  v_exp_f32 v23, v23
  v_mfma_f32_16x16x32_bf16 v[60:63], a[144:147], v[176:179], v[60:63]
  ds_read_b64_tr_b16 a[174:175], v217 offset:28672
  v_cvt_pk_bf16_f32 v19, v22, v23
  v_mfma_f32_16x16x32_bf16 a[192:195], a[208:211], v[64:67], a[192:195]
  v_exp_f32 v28, v28
  v_mfma_f32_16x16x32_bf16 a[192:195], a[208:211], v[96:99], a[192:195]
  ds_read_b64_tr_b16 a[176:177], v218 offset:16384
  buffer_load_dwordx4 a[216:219], v242, s[24:27], s4 offen offset:1024 sc1
  v_mfma_f32_16x16x32_bf16 a[196:199], a[208:211], v[72:75], a[196:199]
  v_exp_f32 v29, v29
  v_mfma_f32_16x16x32_bf16 a[196:199], a[208:211], v[104:107], a[196:199]
  ds_read_b64_tr_b16 a[178:179], v218 offset:20480
  v_cvt_pk_bf16_f32 v26, v28, v29
  v_mfma_f32_16x16x32_bf16 a[200:203], a[208:211], v[80:83], a[200:203]
  v_exp_f32 v30, v30
  v_mfma_f32_16x16x32_bf16 a[200:203], a[208:211], v[112:115], a[200:203]
  ds_read_b64_tr_b16 a[180:181], v218 offset:24576
  v_mfma_f32_16x16x32_bf16 a[204:207], a[208:211], v[88:91], a[204:207]
  s_waitcnt lgkmcnt(7)
  v_exp_f32 v31, v31
  v_mfma_f32_16x16x32_bf16 a[204:207], a[208:211], v[120:123], a[204:207]
  ds_read_b64_tr_b16 a[182:183], v218 offset:28672
  v_cvt_pk_bf16_f32 v27, v30, v31
  v_mfma_f32_16x16x32_bf16 a[0:3], a[160:163], v[64:67], a[0:3]
  v_exp_f32 v32, v32
  v_mfma_f32_16x16x32_bf16 a[0:3], a[164:167], v[96:99], a[0:3]
  ds_read_b64_tr_b16 a[184:185], v219 offset:16384
  buffer_load_dwordx4 a[220:223], v242, s[24:27], s4 offen offset:2048 sc1
  v_mfma_f32_16x16x32_bf16 a[4:7], a[164:167], v[104:107], a[4:7]
  v_exp_f32 v33, v33
  v_mfma_f32_16x16x32_bf16 a[4:7], a[160:163], v[72:75], a[4:7]
  ds_read_b64_tr_b16 a[186:187], v219 offset:20480
  v_cvt_pk_bf16_f32 v32, v32, v33
  v_mfma_f32_16x16x32_bf16 a[8:11], a[160:163], v[80:83], a[8:11]
  v_exp_f32 v34, v34
  v_mfma_f32_16x16x32_bf16 a[8:11], a[164:167], v[112:115], a[8:11]
  ds_read_b64_tr_b16 a[188:189], v219 offset:24576
  v_mfma_f32_16x16x32_bf16 a[12:15], a[164:167], v[120:123], a[12:15]
  s_waitcnt lgkmcnt(7)
  v_exp_f32 v35, v35
  v_mfma_f32_16x16x32_bf16 a[12:15], a[160:163], v[88:91], a[12:15]
  ds_read_b64_tr_b16 a[190:191], v219 offset:28672
  v_cvt_pk_bf16_f32 v33, v34, v35
  v_mfma_f32_16x16x32_bf16 a[16:19], a[168:171], v[64:67], a[16:19]
  v_exp_f32 v40, v40
  v_mfma_f32_16x16x32_bf16 a[16:19], a[172:175], v[96:99], a[16:19]
  ds_read_b64_tr_b16 a[160:161], v220 offset:16384
  buffer_load_dwordx4 a[224:227], v242, s[24:27], s4 offen offset:3072 sc1
  v_mfma_f32_16x16x32_bf16 a[20:23], a[172:175], v[104:107], a[20:23]
  v_exp_f32 v41, v41
  v_mfma_f32_16x16x32_bf16 a[20:23], a[168:171], v[72:75], a[20:23]
  ds_read_b64_tr_b16 a[162:163], v220 offset:20480
  v_cvt_pk_bf16_f32 v40, v40, v41
  v_mfma_f32_16x16x32_bf16 a[24:27], a[168:171], v[80:83], a[24:27]
  v_exp_f32 v42, v42
  v_mfma_f32_16x16x32_bf16 a[24:27], a[172:175], v[112:115], a[24:27]
  ds_read_b64_tr_b16 a[164:165], v220 offset:24576
  v_mfma_f32_16x16x32_bf16 a[28:31], a[172:175], v[120:123], a[28:31]
  s_waitcnt lgkmcnt(7)
  v_exp_f32 v43, v43
  v_mfma_f32_16x16x32_bf16 a[28:31], a[168:171], v[88:91], a[28:31]
  ds_read_b64_tr_b16 a[166:167], v220 offset:28672
  v_cvt_pk_bf16_f32 v41, v42, v43
  v_mfma_f32_16x16x32_bf16 a[32:35], a[176:179], v[64:67], a[32:35]
  v_exp_f32 v48, v48
  v_mfma_f32_16x16x32_bf16 a[32:35], a[180:183], v[96:99], a[32:35]
  ds_read_b64_tr_b16 a[168:169], v221 offset:16384
  buffer_load_dwordx4 a[228:231], v252, s[24:27], s4 offen offset:0 sc1
  v_mfma_f32_16x16x32_bf16 a[36:39], a[180:183], v[104:107], a[36:39]
  v_exp_f32 v49, v49
  v_mfma_f32_16x16x32_bf16 a[36:39], a[176:179], v[72:75], a[36:39]
  ds_read_b64_tr_b16 a[170:171], v221 offset:20480
  v_cvt_pk_bf16_f32 v48, v48, v49
  v_mfma_f32_16x16x32_bf16 a[40:43], a[176:179], v[80:83], a[40:43]
  v_exp_f32 v50, v50
  v_mfma_f32_16x16x32_bf16 a[40:43], a[180:183], v[112:115], a[40:43]
  ds_read_b64_tr_b16 a[172:173], v221 offset:24576
  v_mfma_f32_16x16x32_bf16 a[44:47], a[180:183], v[120:123], a[44:47]
  s_waitcnt lgkmcnt(7)
  v_exp_f32 v51, v51
  v_mfma_f32_16x16x32_bf16 a[44:47], a[176:179], v[88:91], a[44:47]
  ds_read_b64_tr_b16 a[174:175], v221 offset:28672
  v_cvt_pk_bf16_f32 v49, v50, v51
  v_mfma_f32_16x16x32_bf16 a[48:51], a[184:187], v[64:67], a[48:51]
  v_exp_f32 v56, v56
  v_mfma_f32_16x16x32_bf16 a[48:51], a[188:191], v[96:99], a[48:51]
  ds_read_b64_tr_b16 a[176:177], v222 offset:16384
  buffer_load_dwordx4 a[232:235], v252, s[24:27], s4 offen offset:1024 sc1
  v_mfma_f32_16x16x32_bf16 a[52:55], a[188:191], v[104:107], a[52:55]
  v_exp_f32 v57, v57
  v_mfma_f32_16x16x32_bf16 a[52:55], a[184:187], v[72:75], a[52:55]
  ds_read_b64_tr_b16 a[178:179], v222 offset:20480
  v_cvt_pk_bf16_f32 v56, v56, v57
  v_mfma_f32_16x16x32_bf16 a[56:59], a[184:187], v[80:83], a[56:59]
  v_exp_f32 v58, v58
  v_mfma_f32_16x16x32_bf16 a[56:59], a[188:191], v[112:115], a[56:59]
  ds_read_b64_tr_b16 a[180:181], v222 offset:24576
  v_mfma_f32_16x16x32_bf16 a[60:63], a[188:191], v[120:123], a[60:63]
  s_waitcnt lgkmcnt(7)
  v_exp_f32 v59, v59
  v_mfma_f32_16x16x32_bf16 a[60:63], a[184:187], v[88:91], a[60:63]
  ds_read_b64_tr_b16 a[182:183], v222 offset:28672
  v_cvt_pk_bf16_f32 v57, v58, v59
  v_mfma_f32_16x16x32_bf16 a[64:67], a[160:163], v[64:67], a[64:67]
  v_exp_f32 v36, v36
  v_mfma_f32_16x16x32_bf16 a[64:67], a[164:167], v[96:99], a[64:67]
  ds_read_b64_tr_b16 a[184:185], v223 offset:16384
  v_mfma_f32_16x16x32_bf16 a[68:71], a[164:167], v[104:107], a[68:71]
  v_exp_f32 v37, v37
  v_mfma_f32_16x16x32_bf16 a[68:71], a[160:163], v[72:75], a[68:71]
  ds_read_b64_tr_b16 a[186:187], v223 offset:20480
  v_cvt_pk_bf16_f32 v34, v36, v37
  v_mfma_f32_16x16x32_bf16 a[72:75], a[160:163], v[80:83], a[72:75]
  v_exp_f32 v38, v38
  v_mfma_f32_16x16x32_bf16 a[72:75], a[164:167], v[112:115], a[72:75]
  ds_read_b64_tr_b16 a[188:189], v223 offset:24576
  v_mfma_f32_16x16x32_bf16 a[76:79], a[164:167], v[120:123], a[76:79]
  s_waitcnt lgkmcnt(7)
  v_exp_f32 v39, v39
  v_mfma_f32_16x16x32_bf16 a[76:79], a[160:163], v[88:91], a[76:79]
  ds_read_b64_tr_b16 a[190:191], v223 offset:28672
  v_cvt_pk_bf16_f32 v35, v38, v39
  v_mfma_f32_16x16x32_bf16 a[80:83], a[168:171], v[64:67], a[80:83]
  s_waitcnt vmcnt(19)
  v_exp_f32 v44, v44
  v_mfma_f32_16x16x32_bf16 a[80:83], a[172:175], v[96:99], a[80:83]
  v_mfma_f32_16x16x32_bf16 a[84:87], a[172:175], v[104:107], a[84:87]
  s_barrier
  v_exp_f32 v45, v45
  v_mfma_f32_16x16x32_bf16 a[84:87], a[168:171], v[72:75], a[84:87]
  ds_read_b128 a[128:131], v212 offset:49152
  v_cvt_pk_bf16_f32 v42, v44, v45
  v_mfma_f32_16x16x32_bf16 a[88:91], a[168:171], v[80:83], a[88:91]
  v_exp_f32 v46, v46
  v_mfma_f32_16x16x32_bf16 a[88:91], a[172:175], v[112:115], a[88:91]
  ds_read_b128 a[132:135], v213 offset:49152
  v_mfma_f32_16x16x32_bf16 a[92:95], a[172:175], v[120:123], a[92:95]
  s_waitcnt lgkmcnt(6)
  v_exp_f32 v47, v47
  v_mfma_f32_16x16x32_bf16 a[92:95], a[168:171], v[88:91], a[92:95]
  ds_read_b128 a[136:139], v214 offset:49152
  v_cvt_pk_bf16_f32 v43, v46, v47
  v_mfma_f32_16x16x32_bf16 a[96:99], a[176:179], v[64:67], a[96:99]
  v_exp_f32 v52, v52
  v_mfma_f32_16x16x32_bf16 a[96:99], a[180:183], v[96:99], a[96:99]
  ds_read_b128 a[140:143], v215 offset:49152
  v_mfma_f32_16x16x32_bf16 a[100:103], a[180:183], v[104:107], a[100:103]
  v_exp_f32 v53, v53
  v_mfma_f32_16x16x32_bf16 a[100:103], a[176:179], v[72:75], a[100:103]
  v_cvt_pk_bf16_f32 v50, v52, v53
  v_mfma_f32_16x16x32_bf16 a[104:107], a[176:179], v[80:83], a[104:107]
  v_exp_f32 v54, v54
  v_mfma_f32_16x16x32_bf16 a[104:107], a[180:183], v[112:115], a[104:107]
  v_mfma_f32_16x16x32_bf16 a[108:111], a[180:183], v[120:123], a[108:111]
  s_waitcnt lgkmcnt(4)
  v_exp_f32 v55, v55
  v_mfma_f32_16x16x32_bf16 a[108:111], a[176:179], v[88:91], a[108:111]
  v_cvt_pk_bf16_f32 v51, v54, v55
  v_mfma_f32_16x16x32_bf16 a[112:115], a[184:187], v[64:67], a[112:115]
  v_exp_f32 v60, v60
  v_mfma_f32_16x16x32_bf16 a[112:115], a[188:191], v[96:99], a[112:115]
  v_mfma_f32_16x16x32_bf16 a[116:119], a[188:191], v[104:107], a[116:119]
  v_exp_f32 v61, v61
  v_mfma_f32_16x16x32_bf16 a[116:119], a[184:187], v[72:75], a[116:119]
  v_cvt_pk_bf16_f32 v58, v60, v61
  v_mfma_f32_16x16x32_bf16 a[120:123], a[184:187], v[80:83], a[120:123]
  v_exp_f32 v62, v62
  v_mfma_f32_16x16x32_bf16 a[120:123], a[188:191], v[112:115], a[120:123]
  v_mfma_f32_16x16x32_bf16 a[124:127], a[188:191], v[120:123], a[124:127]
  s_waitcnt lgkmcnt(0)
  v_exp_f32 v63, v63
  v_mfma_f32_16x16x32_bf16 a[124:127], a[184:187], v[88:91], a[124:127]
  v_cvt_pk_bf16_f32 v59, v62, v63
  v_mfma_f32_16x16x32_bf16 v[64:67], a[128:131], v[128:131], v[192:195]
  s_add_u32 m0, s28, 65536
  v_mfma_f32_16x16x32_bf16 v[64:67], a[132:135], v[132:135], v[64:67]
  ds_read_b128 a[144:147], v212 offset:53248
  v_mfma_f32_16x16x32_bf16 v[64:67], a[136:139], v[136:139], v[64:67]
  buffer_load_dwordx4 v253, s[24:27], s9 offen offset:0 sc1 lds
  v_mfma_f32_16x16x32_bf16 v[64:67], a[140:143], v[140:143], v[64:67]
  ds_read_b128 a[148:151], v213 offset:53248
  v_mfma_f32_16x16x32_bf16 v[72:75], a[140:143], v[156:159], v[196:199]
  v_mfma_f32_16x16x32_bf16 v[72:75], a[136:139], v[152:155], v[72:75]
  ds_read_b128 a[152:155], v214 offset:53248
  v_mfma_f32_16x16x32_bf16 v[72:75], a[132:135], v[148:151], v[72:75]
  buffer_load_dwordx4 v253, s[24:27], s9 offen offset:1024 sc1 lds
  v_mfma_f32_16x16x32_bf16 v[72:75], a[128:131], v[144:147], v[72:75]
  ds_read_b128 a[156:159], v215 offset:53248
  v_mfma_f32_16x16x32_bf16 v[80:83], a[128:131], v[160:163], v[200:203]
  v_exp_f32 v64, v64
  v_mfma_f32_16x16x32_bf16 v[80:83], a[132:135], v[164:167], v[80:83]
  v_mfma_f32_16x16x32_bf16 v[80:83], a[136:139], v[168:171], v[80:83]
  v_exp_f32 v65, v65
  v_mfma_f32_16x16x32_bf16 v[80:83], a[140:143], v[172:175], v[80:83]
  v_cvt_pk_bf16_f32 v64, v64, v65
  v_mfma_f32_16x16x32_bf16 v[88:91], a[140:143], v[188:191], v[204:207]
  v_exp_f32 v66, v66
  v_mfma_f32_16x16x32_bf16 v[88:91], a[136:139], v[184:187], v[88:91]
  buffer_load_dwordx4 v253, s[24:27], s9 offen offset:2048 sc1 lds
  v_mfma_f32_16x16x32_bf16 v[88:91], a[132:135], v[180:183], v[88:91]
  s_waitcnt lgkmcnt(0)
  v_exp_f32 v67, v67
  v_mfma_f32_16x16x32_bf16 v[88:91], a[128:131], v[176:179], v[88:91]
  v_cvt_pk_bf16_f32 v65, v66, v67
  v_mfma_f32_16x16x32_bf16 v[68:71], a[144:147], v[128:131], v[192:195]
  v_exp_f32 v72, v72
  v_mfma_f32_16x16x32_bf16 v[68:71], a[148:151], v[132:135], v[68:71]
  ds_read_b128 a[128:131], v212 offset:57344
  v_mfma_f32_16x16x32_bf16 v[68:71], a[152:155], v[136:139], v[68:71]
  v_exp_f32 v73, v73
  v_mfma_f32_16x16x32_bf16 v[68:71], a[156:159], v[140:143], v[68:71]
  ds_read_b128 a[132:135], v213 offset:57344
  v_cvt_pk_bf16_f32 v72, v72, v73
  v_mfma_f32_16x16x32_bf16 v[76:79], a[156:159], v[156:159], v[196:199]
  v_exp_f32 v74, v74
  v_mfma_f32_16x16x32_bf16 v[76:79], a[152:155], v[152:155], v[76:79]
  ds_read_b128 a[136:139], v214 offset:57344
  v_mfma_f32_16x16x32_bf16 v[76:79], a[148:151], v[148:151], v[76:79]
  v_exp_f32 v75, v75
  v_mfma_f32_16x16x32_bf16 v[76:79], a[144:147], v[144:147], v[76:79]
  ds_read_b128 a[140:143], v215 offset:57344
  v_cvt_pk_bf16_f32 v73, v74, v75
  v_mfma_f32_16x16x32_bf16 v[84:87], a[144:147], v[160:163], v[200:203]
  v_exp_f32 v80, v80
  v_mfma_f32_16x16x32_bf16 v[84:87], a[148:151], v[164:167], v[84:87]
  buffer_load_dwordx4 v253, s[24:27], s9 offen offset:3072 sc1 lds
  v_mfma_f32_16x16x32_bf16 v[84:87], a[152:155], v[168:171], v[84:87]
  s_add_u32 s29, s29, 16384
  v_exp_f32 v81, v81
  v_mfma_f32_16x16x32_bf16 v[84:87], a[156:159], v[172:175], v[84:87]
  v_cvt_pk_bf16_f32 v80, v80, v81
  v_mfma_f32_16x16x32_bf16 v[92:95], a[156:159], v[188:191], v[204:207]
  s_add_u32 m0, s28, 32768
  v_exp_f32 v82, v82
  v_mfma_f32_16x16x32_bf16 v[92:95], a[152:155], v[184:187], v[92:95]
  buffer_load_dwordx4 v252, s[24:27], s9 offen offset:0 sc1 lds
  v_mfma_f32_16x16x32_bf16 v[92:95], a[148:151], v[180:183], v[92:95]
  s_waitcnt lgkmcnt(0)
  v_exp_f32 v83, v83
  v_mfma_f32_16x16x32_bf16 v[92:95], a[144:147], v[176:179], v[92:95]
  v_cvt_pk_bf16_f32 v81, v82, v83
  v_mfma_f32_16x16x32_bf16 v[96:99], a[128:131], v[128:131], v[192:195]
  v_exp_f32 v88, v88
  v_mfma_f32_16x16x32_bf16 v[96:99], a[132:135], v[132:135], v[96:99]
  ds_read_b128 a[144:147], v212 offset:61440
  v_mfma_f32_16x16x32_bf16 v[96:99], a[136:139], v[136:139], v[96:99]
  v_exp_f32 v89, v89
  v_mfma_f32_16x16x32_bf16 v[96:99], a[140:143], v[140:143], v[96:99]
  ds_read_b128 a[148:151], v213 offset:61440
  v_cvt_pk_bf16_f32 v88, v88, v89
  v_mfma_f32_16x16x32_bf16 v[104:107], a[140:143], v[156:159], v[196:199]
  v_exp_f32 v90, v90
  v_mfma_f32_16x16x32_bf16 v[104:107], a[136:139], v[152:155], v[104:107]
  ds_read_b128 a[152:155], v214 offset:61440
  v_mfma_f32_16x16x32_bf16 v[104:107], a[132:135], v[148:151], v[104:107]
  v_exp_f32 v91, v91
  v_mfma_f32_16x16x32_bf16 v[104:107], a[128:131], v[144:147], v[104:107]
  ds_read_b128 a[156:159], v215 offset:61440
  v_cvt_pk_bf16_f32 v89, v90, v91
  v_mfma_f32_16x16x32_bf16 v[112:115], a[128:131], v[160:163], v[200:203]
  v_exp_f32 v68, v68
  v_mfma_f32_16x16x32_bf16 v[112:115], a[132:135], v[164:167], v[112:115]
  buffer_load_dwordx4 v252, s[24:27], s9 offen offset:1024 sc1 lds
  v_mfma_f32_16x16x32_bf16 v[112:115], a[136:139], v[168:171], v[112:115]
  v_exp_f32 v69, v69
  v_mfma_f32_16x16x32_bf16 v[112:115], a[140:143], v[172:175], v[112:115]
  v_cvt_pk_bf16_f32 v66, v68, v69
  v_mfma_f32_16x16x32_bf16 v[120:123], a[140:143], v[188:191], v[204:207]
  v_exp_f32 v70, v70
  v_mfma_f32_16x16x32_bf16 v[120:123], a[136:139], v[184:187], v[120:123]
  buffer_load_dwordx4 v252, s[24:27], s9 offen offset:2048 sc1 lds
  v_mfma_f32_16x16x32_bf16 v[120:123], a[132:135], v[180:183], v[120:123]
  s_waitcnt lgkmcnt(0)
  v_exp_f32 v71, v71
  v_mfma_f32_16x16x32_bf16 v[120:123], a[128:131], v[176:179], v[120:123]
  v_cvt_pk_bf16_f32 v67, v70, v71
  v_mfma_f32_16x16x32_bf16 v[100:103], a[144:147], v[128:131], v[192:195]
  v_exp_f32 v76, v76
  v_mfma_f32_16x16x32_bf16 v[100:103], a[148:151], v[132:135], v[100:103]
  ds_read_b64_tr_b16 a[160:161], v216 offset:32768
  v_mfma_f32_16x16x32_bf16 v[100:103], a[152:155], v[136:139], v[100:103]
  v_exp_f32 v77, v77
  v_mfma_f32_16x16x32_bf16 v[100:103], a[156:159], v[140:143], v[100:103]
  ds_read_b64_tr_b16 a[162:163], v216 offset:36864
  v_cvt_pk_bf16_f32 v74, v76, v77
  v_mfma_f32_16x16x32_bf16 v[108:111], a[156:159], v[156:159], v[196:199]
  v_exp_f32 v78, v78
  v_mfma_f32_16x16x32_bf16 v[108:111], a[152:155], v[152:155], v[108:111]
  ds_read_b64_tr_b16 a[164:165], v216 offset:40960
  buffer_load_dwordx4 v252, s[24:27], s9 offen offset:3072 sc1 lds
  v_mfma_f32_16x16x32_bf16 v[108:111], a[148:151], v[148:151], v[108:111]
  v_exp_f32 v79, v79
  v_mfma_f32_16x16x32_bf16 v[108:111], a[144:147], v[144:147], v[108:111]
  ds_read_b64_tr_b16 a[166:167], v216 offset:45056
  v_cvt_pk_bf16_f32 v75, v78, v79
  v_mfma_f32_16x16x32_bf16 v[116:119], a[144:147], v[160:163], v[200:203]
  v_exp_f32 v84, v84
  v_mfma_f32_16x16x32_bf16 v[116:119], a[148:151], v[164:167], v[116:119]
  ds_read_b64_tr_b16 a[168:169], v217 offset:32768
  buffer_load_dwordx4 a[236:239], v252, s[24:27], s4 offen offset:2048 sc1
  v_mfma_f32_16x16x32_bf16 v[116:119], a[152:155], v[168:171], v[116:119]
  v_exp_f32 v85, v85
  v_mfma_f32_16x16x32_bf16 v[116:119], a[156:159], v[172:175], v[116:119]
  ds_read_b64_tr_b16 a[170:171], v217 offset:36864
  v_cvt_pk_bf16_f32 v82, v84, v85
  v_mfma_f32_16x16x32_bf16 v[124:127], a[156:159], v[188:191], v[204:207]
  v_exp_f32 v86, v86
  v_mfma_f32_16x16x32_bf16 v[124:127], a[152:155], v[184:187], v[124:127]
  ds_read_b64_tr_b16 a[172:173], v217 offset:40960
  buffer_load_dwordx4 a[240:243], v252, s[24:27], s4 offen offset:3072 sc1
  v_mfma_f32_16x16x32_bf16 v[124:127], a[148:151], v[180:183], v[124:127]
  v_exp_f32 v87, v87
  v_mfma_f32_16x16x32_bf16 v[124:127], a[144:147], v[176:179], v[124:127]
  ds_read_b64_tr_b16 a[174:175], v217 offset:45056
  v_cvt_pk_bf16_f32 v83, v86, v87
  v_mfma_f32_16x16x32_bf16 a[192:195], a[208:211], v[0:3], a[192:195]
  v_exp_f32 v92, v92
  v_mfma_f32_16x16x32_bf16 a[192:195], a[208:211], v[32:35], a[192:195]
  ds_read_b64_tr_b16 a[176:177], v218 offset:32768
  buffer_load_dwordx4 a[244:247], v253, s[24:27], s4 offen offset:0 sc1
  v_mfma_f32_16x16x32_bf16 a[196:199], a[208:211], v[8:11], a[196:199]
  v_exp_f32 v93, v93
  v_mfma_f32_16x16x32_bf16 a[196:199], a[208:211], v[40:43], a[196:199]
  ds_read_b64_tr_b16 a[178:179], v218 offset:36864
  v_cvt_pk_bf16_f32 v90, v92, v93
  v_mfma_f32_16x16x32_bf16 a[200:203], a[208:211], v[16:19], a[200:203]
  v_exp_f32 v94, v94
  v_mfma_f32_16x16x32_bf16 a[200:203], a[208:211], v[48:51], a[200:203]
  ds_read_b64_tr_b16 a[180:181], v218 offset:40960
  buffer_load_dwordx4 a[248:251], v253, s[24:27], s4 offen offset:1024 sc1
  v_mfma_f32_16x16x32_bf16 a[204:207], a[208:211], v[24:27], a[204:207]
  s_waitcnt lgkmcnt(7)
  v_exp_f32 v95, v95
  v_mfma_f32_16x16x32_bf16 a[204:207], a[208:211], v[56:59], a[204:207]
  ds_read_b64_tr_b16 a[182:183], v218 offset:45056
  v_cvt_pk_bf16_f32 v91, v94, v95
  v_mfma_f32_16x16x32_bf16 a[0:3], a[160:163], v[0:3], a[0:3]
  v_exp_f32 v96, v96
  v_mfma_f32_16x16x32_bf16 a[0:3], a[164:167], v[32:35], a[0:3]
  ds_read_b64_tr_b16 a[184:185], v219 offset:32768
  buffer_load_dwordx4 a[252:255], v253, s[24:27], s4 offen offset:2048 sc1
  v_mfma_f32_16x16x32_bf16 a[4:7], a[164:167], v[40:43], a[4:7]
  v_exp_f32 v97, v97
  v_mfma_f32_16x16x32_bf16 a[4:7], a[160:163], v[8:11], a[4:7]
  ds_read_b64_tr_b16 a[186:187], v219 offset:36864
  v_cvt_pk_bf16_f32 v96, v96, v97
  v_mfma_f32_16x16x32_bf16 a[8:11], a[160:163], v[16:19], a[8:11]
  v_exp_f32 v98, v98
  v_mfma_f32_16x16x32_bf16 a[8:11], a[164:167], v[48:51], a[8:11]
  ds_read_b64_tr_b16 a[188:189], v219 offset:40960
  buffer_load_dwordx4 a[128:131], v253, s[24:27], s4 offen offset:3072 sc1
  v_mfma_f32_16x16x32_bf16 a[12:15], a[164:167], v[56:59], a[12:15]
  s_waitcnt lgkmcnt(7)
  v_exp_f32 v99, v99
  v_mfma_f32_16x16x32_bf16 a[12:15], a[160:163], v[24:27], a[12:15]
  ds_read_b64_tr_b16 a[190:191], v219 offset:45056
  v_cvt_pk_bf16_f32 v97, v98, v99
  v_mfma_f32_16x16x32_bf16 a[16:19], a[168:171], v[0:3], a[16:19]
  v_exp_f32 v104, v104
  v_mfma_f32_16x16x32_bf16 a[16:19], a[172:175], v[32:35], a[16:19]
  ds_read_b64_tr_b16 a[160:161], v220 offset:32768
  buffer_load_dwordx4 a[132:135], v242, s[24:27], s5 offen offset:0 sc1
  v_mfma_f32_16x16x32_bf16 a[20:23], a[172:175], v[40:43], a[20:23]
  v_exp_f32 v105, v105
  v_mfma_f32_16x16x32_bf16 a[20:23], a[168:171], v[8:11], a[20:23]
  ds_read_b64_tr_b16 a[162:163], v220 offset:36864
  v_cvt_pk_bf16_f32 v104, v104, v105
  v_mfma_f32_16x16x32_bf16 a[24:27], a[168:171], v[16:19], a[24:27]
  v_exp_f32 v106, v106
  v_mfma_f32_16x16x32_bf16 a[24:27], a[172:175], v[48:51], a[24:27]
  ds_read_b64_tr_b16 a[164:165], v220 offset:40960
  buffer_load_dwordx4 a[136:139], v242, s[24:27], s5 offen offset:1024 sc1
  v_mfma_f32_16x16x32_bf16 a[28:31], a[172:175], v[56:59], a[28:31]
  s_waitcnt lgkmcnt(7)
  v_exp_f32 v107, v107
  v_mfma_f32_16x16x32_bf16 a[28:31], a[168:171], v[24:27], a[28:31]
  ds_read_b64_tr_b16 a[166:167], v220 offset:45056
  v_cvt_pk_bf16_f32 v105, v106, v107
  v_mfma_f32_16x16x32_bf16 a[32:35], a[176:179], v[0:3], a[32:35]
  v_exp_f32 v112, v112
  v_mfma_f32_16x16x32_bf16 a[32:35], a[180:183], v[32:35], a[32:35]
  ds_read_b64_tr_b16 a[168:169], v221 offset:32768
  buffer_load_dwordx4 a[140:143], v242, s[24:27], s5 offen offset:2048 sc1
  v_mfma_f32_16x16x32_bf16 a[36:39], a[180:183], v[40:43], a[36:39]
  v_exp_f32 v113, v113
  v_mfma_f32_16x16x32_bf16 a[36:39], a[176:179], v[8:11], a[36:39]
  ds_read_b64_tr_b16 a[170:171], v221 offset:36864
  v_cvt_pk_bf16_f32 v112, v112, v113
  v_mfma_f32_16x16x32_bf16 a[40:43], a[176:179], v[16:19], a[40:43]
  v_exp_f32 v114, v114
  v_mfma_f32_16x16x32_bf16 a[40:43], a[180:183], v[48:51], a[40:43]
  ds_read_b64_tr_b16 a[172:173], v221 offset:40960
  buffer_load_dwordx4 a[144:147], v242, s[24:27], s5 offen offset:3072 sc1
  v_mfma_f32_16x16x32_bf16 a[44:47], a[180:183], v[56:59], a[44:47]
  s_waitcnt lgkmcnt(7)
  v_exp_f32 v115, v115
  v_mfma_f32_16x16x32_bf16 a[44:47], a[176:179], v[24:27], a[44:47]
  ds_read_b64_tr_b16 a[174:175], v221 offset:45056
  v_cvt_pk_bf16_f32 v113, v114, v115
  v_mfma_f32_16x16x32_bf16 a[48:51], a[184:187], v[0:3], a[48:51]
  v_exp_f32 v120, v120
  v_mfma_f32_16x16x32_bf16 a[48:51], a[188:191], v[32:35], a[48:51]
  ds_read_b64_tr_b16 a[176:177], v222 offset:32768
  buffer_load_dwordx4 a[148:151], v252, s[24:27], s5 offen offset:0 sc1
  v_mfma_f32_16x16x32_bf16 a[52:55], a[188:191], v[40:43], a[52:55]
  v_exp_f32 v121, v121
  v_mfma_f32_16x16x32_bf16 a[52:55], a[184:187], v[8:11], a[52:55]
  ds_read_b64_tr_b16 a[178:179], v222 offset:36864
  v_cvt_pk_bf16_f32 v120, v120, v121
  v_mfma_f32_16x16x32_bf16 a[56:59], a[184:187], v[16:19], a[56:59]
  v_exp_f32 v122, v122
  v_mfma_f32_16x16x32_bf16 a[56:59], a[188:191], v[48:51], a[56:59]
  ds_read_b64_tr_b16 a[180:181], v222 offset:40960
  v_mfma_f32_16x16x32_bf16 a[60:63], a[188:191], v[56:59], a[60:63]
  s_waitcnt lgkmcnt(7)
  v_exp_f32 v123, v123
  v_mfma_f32_16x16x32_bf16 a[60:63], a[184:187], v[24:27], a[60:63]
  ds_read_b64_tr_b16 a[182:183], v222 offset:45056
  v_cvt_pk_bf16_f32 v121, v122, v123
  v_mfma_f32_16x16x32_bf16 a[64:67], a[160:163], v[0:3], a[64:67]
  v_exp_f32 v100, v100
  v_mfma_f32_16x16x32_bf16 a[64:67], a[164:167], v[32:35], a[64:67]
  ds_read_b64_tr_b16 a[184:185], v223 offset:32768
  buffer_load_dwordx4 a[152:155], v252, s[24:27], s5 offen offset:1024 sc1
  v_mfma_f32_16x16x32_bf16 a[68:71], a[164:167], v[40:43], a[68:71]
  v_exp_f32 v101, v101
  v_mfma_f32_16x16x32_bf16 a[68:71], a[160:163], v[8:11], a[68:71]
  ds_read_b64_tr_b16 a[186:187], v223 offset:36864
  v_cvt_pk_bf16_f32 v98, v100, v101
  v_mfma_f32_16x16x32_bf16 a[72:75], a[160:163], v[16:19], a[72:75]
  v_exp_f32 v102, v102
  v_mfma_f32_16x16x32_bf16 a[72:75], a[164:167], v[48:51], a[72:75]
  ds_read_b64_tr_b16 a[188:189], v223 offset:40960
  buffer_load_dwordx4 a[156:159], v252, s[24:27], s5 offen offset:2048 sc1
  v_mfma_f32_16x16x32_bf16 a[76:79], a[164:167], v[56:59], a[76:79]
  s_waitcnt lgkmcnt(7)
  v_exp_f32 v103, v103
  v_mfma_f32_16x16x32_bf16 a[76:79], a[160:163], v[24:27], a[76:79]
  ds_read_b64_tr_b16 a[190:191], v223 offset:45056
  v_cvt_pk_bf16_f32 v99, v102, v103
  v_mfma_f32_16x16x32_bf16 a[80:83], a[168:171], v[0:3], a[80:83]
  s_waitcnt vmcnt(27)
  v_exp_f32 v108, v108
  v_mfma_f32_16x16x32_bf16 a[80:83], a[172:175], v[32:35], a[80:83]
  buffer_load_dwordx4 v[128:131], v252, s[24:27], s5 offen offset:3072 sc1
  v_mfma_f32_16x16x32_bf16 a[84:87], a[172:175], v[40:43], a[84:87]
  s_barrier
  v_exp_f32 v109, v109
  v_mfma_f32_16x16x32_bf16 a[84:87], a[168:171], v[8:11], a[84:87]
  s_mul_i32 s39, s99, 13108
  s_lshr_b32 s39, s39, 16
  s_lshl_b32 s39, s39, 8
  v_cvt_pk_bf16_f32 v106, v108, v109
  v_mfma_f32_16x16x32_bf16 a[88:91], a[168:171], v[16:19], a[88:91]
  s_add_u32 s39, s39, 2818304
  s_cmp_lt_u32 s2, 240
  s_cselect_b32 s48, 0, 1073741824
  v_exp_f32 v110, v110
  v_mfma_f32_16x16x32_bf16 a[88:91], a[172:175], v[48:51], a[88:91]
  buffer_load_dwordx4 v[132:135], v253, s[24:27], s5 offen offset:0 sc1
  v_mfma_f32_16x16x32_bf16 a[92:95], a[172:175], v[56:59], a[92:95]
  s_waitcnt lgkmcnt(4)
  v_exp_f32 v111, v111
  v_mfma_f32_16x16x32_bf16 a[92:95], a[168:171], v[24:27], a[92:95]
  v_cvt_pk_bf16_f32 v107, v110, v111
  v_or_b32 v249, s48, v251
  v_mfma_f32_16x16x32_bf16 a[96:99], a[176:179], v[0:3], a[96:99]
  v_exp_f32 v116, v116
  v_mfma_f32_16x16x32_bf16 a[96:99], a[180:183], v[32:35], a[96:99]
  buffer_atomic_add v250, v249, s[24:27], s39 offen
  v_mfma_f32_16x16x32_bf16 a[100:103], a[180:183], v[40:43], a[100:103]
  v_exp_f32 v117, v117
  v_mfma_f32_16x16x32_bf16 a[100:103], a[176:179], v[8:11], a[100:103]
  buffer_load_dwordx4 v[136:139], v253, s[24:27], s5 offen offset:1024 sc1
  v_cvt_pk_bf16_f32 v114, v116, v117
  v_mfma_f32_16x16x32_bf16 a[104:107], a[176:179], v[16:19], a[104:107]
  v_exp_f32 v118, v118
  v_mfma_f32_16x16x32_bf16 a[104:107], a[180:183], v[48:51], a[104:107]
  v_mfma_f32_16x16x32_bf16 a[108:111], a[180:183], v[56:59], a[108:111]
  s_waitcnt lgkmcnt(0)
  v_exp_f32 v119, v119
  v_mfma_f32_16x16x32_bf16 a[108:111], a[176:179], v[24:27], a[108:111]
  buffer_load_dwordx4 v[140:143], v253, s[24:27], s5 offen offset:2048 sc1
  v_cvt_pk_bf16_f32 v115, v118, v119
  v_mfma_f32_16x16x32_bf16 a[112:115], a[184:187], v[0:3], a[112:115]
  v_exp_f32 v124, v124
  v_mfma_f32_16x16x32_bf16 a[112:115], a[188:191], v[32:35], a[112:115]
  v_mfma_f32_16x16x32_bf16 a[116:119], a[188:191], v[40:43], a[116:119]
  v_exp_f32 v125, v125
  v_mfma_f32_16x16x32_bf16 a[116:119], a[184:187], v[8:11], a[116:119]
  v_cvt_pk_bf16_f32 v122, v124, v125
  v_mfma_f32_16x16x32_bf16 a[120:123], a[184:187], v[16:19], a[120:123]
  v_exp_f32 v126, v126
  v_mfma_f32_16x16x32_bf16 a[120:123], a[188:191], v[48:51], a[120:123]
  v_mfma_f32_16x16x32_bf16 a[124:127], a[188:191], v[56:59], a[124:127]
  s_waitcnt vmcnt(9)
  v_exp_f32 v127, v127
  v_mfma_f32_16x16x32_bf16 a[124:127], a[184:187], v[24:27], a[124:127]
  v_cvt_pk_bf16_f32 v123, v126, v127
  ds_read_b64_tr_b16 a[160:161], v216 offset:49152
  ds_read_b64_tr_b16 a[162:163], v216 offset:53248
  ds_read_b64_tr_b16 a[164:165], v216 offset:57344
  ds_read_b64_tr_b16 a[166:167], v216 offset:61440
  ds_read_b64_tr_b16 a[168:169], v217 offset:49152
  ds_read_b64_tr_b16 a[170:171], v217 offset:53248
  ds_read_b64_tr_b16 a[172:173], v217 offset:57344
  ds_read_b64_tr_b16 a[174:175], v217 offset:61440
  s_mov_b32 s48, 0x53800000
  s_lshl_b32 s39, s3, 8
  v_mfma_f32_16x16x32_bf16 a[192:195], a[208:211], v[64:67], a[192:195]
  s_add_u32 m0, s28, 81920
  v_mfma_f32_16x16x32_bf16 a[192:195], a[208:211], v[96:99], a[192:195]
  v_mfma_f32_16x16x32_bf16 a[196:199], a[208:211], v[72:75], a[196:199]
  buffer_load_dwordx4 v242, s[24:27], s10 offen offset:0 sc1 lds
  v_mfma_f32_16x16x32_bf16 a[196:199], a[208:211], v[104:107], a[196:199]
  v_mfma_f32_16x16x32_bf16 a[200:203], a[208:211], v[80:83], a[200:203]
  buffer_load_dwordx4 v242, s[24:27], s10 offen offset:1024 sc1 lds
  v_mfma_f32_16x16x32_bf16 a[200:203], a[208:211], v[112:115], a[200:203]
  v_mfma_f32_16x16x32_bf16 a[204:207], a[208:211], v[88:91], a[204:207]
  buffer_load_dwordx4 v242, s[24:27], s10 offen offset:2048 sc1 lds
  v_mfma_f32_16x16x32_bf16 a[204:207], a[208:211], v[120:123], a[204:207]
  s_waitcnt lgkmcnt(4)
  v_mfma_f32_16x16x32_bf16 a[0:3], a[160:163], v[64:67], a[0:3]
  buffer_load_dwordx4 v242, s[24:27], s10 offen offset:3072 sc1 lds
  v_mfma_f32_16x16x32_bf16 a[0:3], a[164:167], v[96:99], a[0:3]
  ds_read_b64_tr_b16 a[176:177], v218 offset:49152
  v_mfma_f32_16x16x32_bf16 a[4:7], a[164:167], v[104:107], a[4:7]
  buffer_load_dwordx4 v[144:147], v253, s[24:27], s5 offen offset:3072 sc1
  v_mfma_f32_16x16x32_bf16 a[4:7], a[160:163], v[72:75], a[4:7]
  ds_read_b64_tr_b16 a[178:179], v218 offset:53248
  v_accvgpr_read_b32 v208, a192
  v_mfma_f32_16x16x32_bf16 a[8:11], a[160:163], v[80:83], a[8:11]
  v_accvgpr_read_b32 v209, a196
  v_accvgpr_read_b32 v210, a200
  v_mfma_f32_16x16x32_bf16 a[8:11], a[164:167], v[112:115], a[8:11]
  ds_read_b64_tr_b16 a[180:181], v218 offset:57344
  v_accvgpr_read_b32 v211, a204
  v_mfma_f32_16x16x32_bf16 a[12:15], a[164:167], v[120:123], a[12:15]
  v_rcp_f32 v192, v208
  v_mfma_f32_16x16x32_bf16 a[12:15], a[160:163], v[88:91], a[12:15]
  ds_read_b64_tr_b16 a[182:183], v218 offset:61440
  s_waitcnt lgkmcnt(4)
  buffer_load_dwordx4 v[148:151], v242, s[24:27], s6 offen offset:0 sc1
  v_mfma_f32_16x16x32_bf16 a[16:19], a[168:171], v[64:67], a[16:19]
  v_rcp_f32 v196, v209
  v_mfma_f32_16x16x32_bf16 a[16:19], a[172:175], v[96:99], a[16:19]
  ds_read_b64_tr_b16 a[184:185], v219 offset:49152
  buffer_load_dwordx4 v[152:155], v242, s[24:27], s6 offen offset:1024 sc1
  v_mfma_f32_16x16x32_bf16 a[20:23], a[172:175], v[104:107], a[20:23]
  v_rcp_f32 v200, v210
  v_mfma_f32_16x16x32_bf16 a[20:23], a[168:171], v[72:75], a[20:23]
  ds_read_b64_tr_b16 a[186:187], v219 offset:53248
  buffer_load_dwordx4 v[156:159], v242, s[24:27], s6 offen offset:2048 sc1
  v_mfma_f32_16x16x32_bf16 a[24:27], a[168:171], v[80:83], a[24:27]
  v_rcp_f32 v204, v211
  v_mfma_f32_16x16x32_bf16 a[24:27], a[172:175], v[112:115], a[24:27]
  ds_read_b64_tr_b16 a[188:189], v219 offset:57344
  v_add_f32 v246, v208, v209
  v_mfma_f32_16x16x32_bf16 a[28:31], a[172:175], v[120:123], a[28:31]
  v_add_f32 v247, v210, v211
  v_add_f32 v246, v246, v247
  v_mfma_f32_16x16x32_bf16 a[28:31], a[168:171], v[88:91], a[28:31]
  ds_read_b64_tr_b16 a[190:191], v219 offset:61440
  s_waitcnt lgkmcnt(4)
  v_lshrrev_b32 v247, 2, v242
  v_mfma_f32_16x16x32_bf16 a[32:35], a[176:179], v[64:67], a[32:35]
  v_cmp_nlt_f32 vcc, v246, s48
  v_add_u32 v247, s39, v247
  v_mfma_f32_16x16x32_bf16 a[32:35], a[180:183], v[96:99], a[32:35]
  ds_read_b64_tr_b16 a[160:161], v220 offset:49152
  v_add_u32 v247, 157696, v247
  v_mfma_f32_16x16x32_bf16 a[36:39], a[180:183], v[104:107], a[36:39]
  v_cndmask_b32_e64 v245, 0, 1, vcc
  v_accvgpr_read_b32 v0, a0
  v_mfma_f32_16x16x32_bf16 a[36:39], a[176:179], v[72:75], a[36:39]
  ds_read_b64_tr_b16 a[162:163], v220 offset:53248
  v_accvgpr_read_b32 v1, a1
  v_mfma_f32_16x16x32_bf16 a[40:43], a[176:179], v[80:83], a[40:43]
  v_accvgpr_read_b32 v2, a2
  v_accvgpr_read_b32 v3, a3
  v_mfma_f32_16x16x32_bf16 a[40:43], a[180:183], v[112:115], a[40:43]
  ds_read_b64_tr_b16 a[164:165], v220 offset:57344
  v_accvgpr_read_b32 v4, a16
  buffer_load_dwordx4 v[160:163], v242, s[24:27], s6 offen offset:3072 sc1
  buffer_load_dwordx4 v[164:167], v252, s[24:27], s6 offen offset:0 sc1
  buffer_load_dwordx4 v[168:171], v252, s[24:27], s6 offen offset:1024 sc1
  buffer_load_dwordx4 v[172:175], v252, s[24:27], s6 offen offset:2048 sc1
  v_mfma_f32_16x16x32_bf16 a[44:47], a[180:183], v[120:123], a[44:47]
  v_accvgpr_read_b32 v5, a17
  v_accvgpr_read_b32 v6, a18
  v_mfma_f32_16x16x32_bf16 a[44:47], a[176:179], v[88:91], a[44:47]
  ds_read_b64_tr_b16 a[166:167], v220 offset:61440
  s_waitcnt lgkmcnt(4)
  v_accvgpr_read_b32 v7, a19
  v_mfma_f32_16x16x32_bf16 a[48:51], a[184:187], v[64:67], a[48:51]
  v_mul_f32 v0, v0, v192
  v_mul_f32 v1, v1, v192
  v_mfma_f32_16x16x32_bf16 a[48:51], a[188:191], v[96:99], a[48:51]
  ds_read_b64_tr_b16 a[168:169], v221 offset:49152
  v_mul_f32 v2, v2, v192
  v_mfma_f32_16x16x32_bf16 a[52:55], a[188:191], v[104:107], a[52:55]
  v_mul_f32 v3, v3, v192
  v_mul_f32 v4, v4, v192
  v_mfma_f32_16x16x32_bf16 a[52:55], a[184:187], v[72:75], a[52:55]
  ds_read_b64_tr_b16 a[170:171], v221 offset:53248
  v_mul_f32 v5, v5, v192
  v_mfma_f32_16x16x32_bf16 a[56:59], a[184:187], v[80:83], a[56:59]
  v_mul_f32 v6, v6, v192
  v_mul_f32 v7, v7, v192
  v_mfma_f32_16x16x32_bf16 a[56:59], a[188:191], v[112:115], a[56:59]
  ds_read_b64_tr_b16 a[172:173], v221 offset:57344
  v_cvt_pk_bf16_f32 v0, v0, v1
  v_mfma_f32_16x16x32_bf16 a[60:63], a[188:191], v[120:123], a[60:63]
  v_cvt_pk_bf16_f32 v1, v2, v3
  v_cvt_pk_bf16_f32 v2, v4, v5
  v_mfma_f32_16x16x32_bf16 a[60:63], a[184:187], v[88:91], a[60:63]
  ds_read_b64_tr_b16 a[174:175], v221 offset:61440
  s_waitcnt lgkmcnt(4)
  v_cvt_pk_bf16_f32 v3, v6, v7
  v_mfma_f32_16x16x32_bf16 a[64:67], a[160:163], v[64:67], a[64:67]
  buffer_store_dwordx4 v[0:3], v244, s[24:27], s40 offen offset:0 sc1
  v_mfma_f32_16x16x32_bf16 a[64:67], a[164:167], v[96:99], a[64:67]
  ds_read_b64_tr_b16 a[176:177], v222 offset:49152
  v_accvgpr_read_b32 v8, a4
  v_mfma_f32_16x16x32_bf16 a[68:71], a[164:167], v[104:107], a[68:71]
  v_accvgpr_read_b32 v9, a5
  v_accvgpr_read_b32 v10, a6
  v_mfma_f32_16x16x32_bf16 a[68:71], a[160:163], v[72:75], a[68:71]
  ds_read_b64_tr_b16 a[178:179], v222 offset:53248
  v_accvgpr_read_b32 v11, a7
  v_mfma_f32_16x16x32_bf16 a[72:75], a[160:163], v[80:83], a[72:75]
  v_accvgpr_read_b32 v12, a20
  v_accvgpr_read_b32 v13, a21
  v_mfma_f32_16x16x32_bf16 a[72:75], a[164:167], v[112:115], a[72:75]
  ds_read_b64_tr_b16 a[180:181], v222 offset:57344
  v_accvgpr_read_b32 v14, a22
  v_mfma_f32_16x16x32_bf16 a[76:79], a[164:167], v[120:123], a[76:79]
  v_accvgpr_read_b32 v15, a23
  v_mul_f32 v8, v8, v196
  v_mfma_f32_16x16x32_bf16 a[76:79], a[160:163], v[88:91], a[76:79]
  ds_read_b64_tr_b16 a[182:183], v222 offset:61440
  s_waitcnt lgkmcnt(4)
  v_mul_f32 v9, v9, v196
  v_mfma_f32_16x16x32_bf16 a[80:83], a[168:171], v[64:67], a[80:83]
  v_mul_f32 v10, v10, v196
  v_mul_f32 v11, v11, v196
  v_mfma_f32_16x16x32_bf16 a[80:83], a[172:175], v[96:99], a[80:83]
  ds_read_b64_tr_b16 a[184:185], v223 offset:49152
  v_mul_f32 v12, v12, v196
  v_mfma_f32_16x16x32_bf16 a[84:87], a[172:175], v[104:107], a[84:87]
  v_mul_f32 v13, v13, v196
  v_mul_f32 v14, v14, v196
  v_mfma_f32_16x16x32_bf16 a[84:87], a[168:171], v[72:75], a[84:87]
  ds_read_b64_tr_b16 a[186:187], v223 offset:53248
  v_mul_f32 v15, v15, v196
  v_mfma_f32_16x16x32_bf16 a[88:91], a[168:171], v[80:83], a[88:91]
  v_cvt_pk_bf16_f32 v8, v8, v9
  v_cvt_pk_bf16_f32 v9, v10, v11
  v_mfma_f32_16x16x32_bf16 a[88:91], a[172:175], v[112:115], a[88:91]
  ds_read_b64_tr_b16 a[188:189], v223 offset:57344
  v_cvt_pk_bf16_f32 v10, v12, v13
  v_mfma_f32_16x16x32_bf16 a[92:95], a[172:175], v[120:123], a[92:95]
  v_cvt_pk_bf16_f32 v11, v14, v15
  v_mfma_f32_16x16x32_bf16 a[92:95], a[168:171], v[88:91], a[92:95]
  ds_read_b64_tr_b16 a[190:191], v223 offset:61440
  s_waitcnt lgkmcnt(4)
  v_mfma_f32_16x16x32_bf16 a[96:99], a[176:179], v[64:67], a[96:99]
  buffer_store_dwordx4 v[8:11], v244, s[24:27], s40 offen offset:2048 sc1
  v_mfma_f32_16x16x32_bf16 a[96:99], a[180:183], v[96:99], a[96:99]
  v_accvgpr_read_b32 v16, a8
  v_accvgpr_read_b32 v17, a9
  v_mfma_f32_16x16x32_bf16 a[100:103], a[180:183], v[104:107], a[100:103]
  v_accvgpr_read_b32 v18, a10
  v_accvgpr_read_b32 v19, a11
  v_mfma_f32_16x16x32_bf16 a[100:103], a[176:179], v[72:75], a[100:103]
  v_accvgpr_read_b32 v20, a24
  v_accvgpr_read_b32 v21, a25
  v_mfma_f32_16x16x32_bf16 a[104:107], a[176:179], v[80:83], a[104:107]
  v_accvgpr_read_b32 v22, a26
  v_accvgpr_read_b32 v23, a27
  v_mfma_f32_16x16x32_bf16 a[104:107], a[180:183], v[112:115], a[104:107]
  v_mul_f32 v16, v16, v200
  v_mul_f32 v17, v17, v200
  v_mfma_f32_16x16x32_bf16 a[108:111], a[180:183], v[120:123], a[108:111]
  v_mul_f32 v18, v18, v200
  v_mul_f32 v19, v19, v200
  v_mfma_f32_16x16x32_bf16 a[108:111], a[176:179], v[88:91], a[108:111]
  s_waitcnt lgkmcnt(0)
  v_mul_f32 v20, v20, v200
  v_mul_f32 v21, v21, v200
  v_mfma_f32_16x16x32_bf16 a[112:115], a[184:187], v[64:67], a[112:115]
  v_mul_f32 v22, v22, v200
  v_mul_f32 v23, v23, v200
  v_mfma_f32_16x16x32_bf16 a[112:115], a[188:191], v[96:99], a[112:115]
  v_cvt_pk_bf16_f32 v16, v16, v17
  v_cvt_pk_bf16_f32 v17, v18, v19
  v_mfma_f32_16x16x32_bf16 a[116:119], a[188:191], v[104:107], a[116:119]
  v_cvt_pk_bf16_f32 v18, v20, v21
  v_cvt_pk_bf16_f32 v19, v22, v23
  v_mfma_f32_16x16x32_bf16 a[116:119], a[184:187], v[72:75], a[116:119]
  buffer_store_dwordx4 v[16:19], v244, s[24:27], s41 offen offset:0 sc1
  v_mfma_f32_16x16x32_bf16 a[120:123], a[184:187], v[80:83], a[120:123]
  v_accvgpr_read_b32 v24, a12
  v_accvgpr_read_b32 v25, a13
  v_mfma_f32_16x16x32_bf16 a[120:123], a[188:191], v[112:115], a[120:123]
  v_accvgpr_read_b32 v26, a14
  v_accvgpr_read_b32 v27, a15
  v_mfma_f32_16x16x32_bf16 a[124:127], a[188:191], v[120:123], a[124:127]
  v_accvgpr_read_b32 v28, a28
  v_accvgpr_read_b32 v29, a29
  v_mfma_f32_16x16x32_bf16 a[124:127], a[184:187], v[88:91], a[124:127]
  v_accvgpr_read_b32 v30, a30
  v_accvgpr_read_b32 v31, a31
  v_pk_mul_f32 v[24:25], v[24:25], v[204:205] op_sel_hi:[1,0]
  v_pk_mul_f32 v[26:27], v[26:27], v[204:205] op_sel_hi:[1,0]
  v_pk_mul_f32 v[28:29], v[28:29], v[204:205] op_sel_hi:[1,0]
  v_pk_mul_f32 v[30:31], v[30:31], v[204:205] op_sel_hi:[1,0]
  v_cvt_pk_bf16_f32 v24, v24, v25
  v_cvt_pk_bf16_f32 v25, v26, v27
  v_cvt_pk_bf16_f32 v26, v28, v29
  v_cvt_pk_bf16_f32 v27, v30, v31
  buffer_store_dwordx4 v[24:27], v244, s[24:27], s41 offen offset:2048 sc1
  v_accvgpr_read_b32 v32, a32
  v_accvgpr_read_b32 v33, a33
  v_accvgpr_read_b32 v34, a34
  v_accvgpr_read_b32 v35, a35
  v_accvgpr_read_b32 v36, a48
  v_accvgpr_read_b32 v37, a49
  v_accvgpr_read_b32 v38, a50
  v_accvgpr_read_b32 v39, a51
  v_pk_mul_f32 v[32:33], v[32:33], v[192:193] op_sel_hi:[1,0]
  v_pk_mul_f32 v[34:35], v[34:35], v[192:193] op_sel_hi:[1,0]
  v_pk_mul_f32 v[36:37], v[36:37], v[192:193] op_sel_hi:[1,0]
  v_pk_mul_f32 v[38:39], v[38:39], v[192:193] op_sel_hi:[1,0]
  v_cvt_pk_bf16_f32 v32, v32, v33
  v_cvt_pk_bf16_f32 v33, v34, v35
  v_cvt_pk_bf16_f32 v34, v36, v37
  v_cvt_pk_bf16_f32 v35, v38, v39
  buffer_store_dwordx4 v[32:35], v244, s[24:27], s40 offen offset:1024 sc1
  v_accvgpr_read_b32 v40, a36
  v_accvgpr_read_b32 v41, a37
  v_accvgpr_read_b32 v42, a38
  v_accvgpr_read_b32 v43, a39
  v_accvgpr_read_b32 v44, a52
  v_accvgpr_read_b32 v45, a53
  v_accvgpr_read_b32 v46, a54
  v_accvgpr_read_b32 v47, a55
  v_pk_mul_f32 v[40:41], v[40:41], v[196:197] op_sel_hi:[1,0]
  v_pk_mul_f32 v[42:43], v[42:43], v[196:197] op_sel_hi:[1,0]
  v_pk_mul_f32 v[44:45], v[44:45], v[196:197] op_sel_hi:[1,0]
  v_pk_mul_f32 v[46:47], v[46:47], v[196:197] op_sel_hi:[1,0]
  v_cvt_pk_bf16_f32 v40, v40, v41
  v_cvt_pk_bf16_f32 v41, v42, v43
  v_cvt_pk_bf16_f32 v42, v44, v45
  v_cvt_pk_bf16_f32 v43, v46, v47
  buffer_store_dwordx4 v[40:43], v244, s[24:27], s40 offen offset:3072 sc1
  v_accvgpr_read_b32 v48, a40
  v_accvgpr_read_b32 v49, a41
  v_accvgpr_read_b32 v50, a42
  v_accvgpr_read_b32 v51, a43
  v_accvgpr_read_b32 v52, a56
  v_accvgpr_read_b32 v53, a57
  v_accvgpr_read_b32 v54, a58
  v_accvgpr_read_b32 v55, a59
  v_pk_mul_f32 v[48:49], v[48:49], v[200:201] op_sel_hi:[1,0]
  v_pk_mul_f32 v[50:51], v[50:51], v[200:201] op_sel_hi:[1,0]
  v_pk_mul_f32 v[52:53], v[52:53], v[200:201] op_sel_hi:[1,0]
  v_pk_mul_f32 v[54:55], v[54:55], v[200:201] op_sel_hi:[1,0]
  v_cvt_pk_bf16_f32 v48, v48, v49
  v_cvt_pk_bf16_f32 v49, v50, v51
  v_cvt_pk_bf16_f32 v50, v52, v53
  v_cvt_pk_bf16_f32 v51, v54, v55
  buffer_store_dwordx4 v[48:51], v244, s[24:27], s41 offen offset:1024 sc1
  v_accvgpr_read_b32 v56, a44
  v_accvgpr_read_b32 v57, a45
  v_accvgpr_read_b32 v58, a46
  v_accvgpr_read_b32 v59, a47
  v_accvgpr_read_b32 v60, a60
  v_accvgpr_read_b32 v61, a61
  v_accvgpr_read_b32 v62, a62
  v_accvgpr_read_b32 v63, a63
  v_pk_mul_f32 v[56:57], v[56:57], v[204:205] op_sel_hi:[1,0]
  v_pk_mul_f32 v[58:59], v[58:59], v[204:205] op_sel_hi:[1,0]
  v_pk_mul_f32 v[60:61], v[60:61], v[204:205] op_sel_hi:[1,0]
  v_pk_mul_f32 v[62:63], v[62:63], v[204:205] op_sel_hi:[1,0]
  v_cvt_pk_bf16_f32 v56, v56, v57
  v_cvt_pk_bf16_f32 v57, v58, v59
  v_cvt_pk_bf16_f32 v58, v60, v61
  v_cvt_pk_bf16_f32 v59, v62, v63
  buffer_store_dwordx4 v[56:59], v244, s[24:27], s41 offen offset:3072 sc1
  v_accvgpr_read_b32 v0, a64
  v_accvgpr_read_b32 v1, a65
  v_accvgpr_read_b32 v2, a66
  v_accvgpr_read_b32 v3, a67
  v_accvgpr_read_b32 v4, a80
  v_accvgpr_read_b32 v5, a81
  v_accvgpr_read_b32 v6, a82
  v_accvgpr_read_b32 v7, a83
  v_pk_mul_f32 v[0:1], v[0:1], v[192:193] op_sel_hi:[1,0]
  v_pk_mul_f32 v[2:3], v[2:3], v[192:193] op_sel_hi:[1,0]
  v_pk_mul_f32 v[4:5], v[4:5], v[192:193] op_sel_hi:[1,0]
  v_pk_mul_f32 v[6:7], v[6:7], v[192:193] op_sel_hi:[1,0]
  v_cvt_pk_bf16_f32 v0, v0, v1
  v_cvt_pk_bf16_f32 v1, v2, v3
  v_cvt_pk_bf16_f32 v2, v4, v5
  v_cvt_pk_bf16_f32 v3, v6, v7
  buffer_store_dwordx4 v[0:3], v244, s[24:27], s42 offen offset:0 sc1
  v_accvgpr_read_b32 v8, a68
  v_accvgpr_read_b32 v9, a69
  v_accvgpr_read_b32 v10, a70
  v_accvgpr_read_b32 v11, a71
  v_accvgpr_read_b32 v12, a84
  v_accvgpr_read_b32 v13, a85
  v_accvgpr_read_b32 v14, a86
  v_accvgpr_read_b32 v15, a87
  v_pk_mul_f32 v[8:9], v[8:9], v[196:197] op_sel_hi:[1,0]
  v_pk_mul_f32 v[10:11], v[10:11], v[196:197] op_sel_hi:[1,0]
  v_pk_mul_f32 v[12:13], v[12:13], v[196:197] op_sel_hi:[1,0]
  v_pk_mul_f32 v[14:15], v[14:15], v[196:197] op_sel_hi:[1,0]
  v_cvt_pk_bf16_f32 v8, v8, v9
  v_cvt_pk_bf16_f32 v9, v10, v11
  v_cvt_pk_bf16_f32 v10, v12, v13
  v_cvt_pk_bf16_f32 v11, v14, v15
  buffer_store_dwordx4 v[8:11], v244, s[24:27], s42 offen offset:2048 sc1
  v_accvgpr_read_b32 v16, a72
  v_accvgpr_read_b32 v17, a73
  v_accvgpr_read_b32 v18, a74
  v_accvgpr_read_b32 v19, a75
  v_accvgpr_read_b32 v20, a88
  v_accvgpr_read_b32 v21, a89
  v_accvgpr_read_b32 v22, a90
  v_accvgpr_read_b32 v23, a91
  v_pk_mul_f32 v[16:17], v[16:17], v[200:201] op_sel_hi:[1,0]
  v_pk_mul_f32 v[18:19], v[18:19], v[200:201] op_sel_hi:[1,0]
  v_pk_mul_f32 v[20:21], v[20:21], v[200:201] op_sel_hi:[1,0]
  v_pk_mul_f32 v[22:23], v[22:23], v[200:201] op_sel_hi:[1,0]
  v_cvt_pk_bf16_f32 v16, v16, v17
  v_cvt_pk_bf16_f32 v17, v18, v19
  v_cvt_pk_bf16_f32 v18, v20, v21
  v_cvt_pk_bf16_f32 v19, v22, v23
  buffer_store_dwordx4 v[16:19], v244, s[24:27], s43 offen offset:0 sc1
  v_accvgpr_read_b32 v24, a76
  v_accvgpr_read_b32 v25, a77
  v_accvgpr_read_b32 v26, a78
  v_accvgpr_read_b32 v27, a79
  v_accvgpr_read_b32 v28, a92
  v_accvgpr_read_b32 v29, a93
  v_accvgpr_read_b32 v30, a94
  v_accvgpr_read_b32 v31, a95
  v_pk_mul_f32 v[24:25], v[24:25], v[204:205] op_sel_hi:[1,0]
  v_pk_mul_f32 v[26:27], v[26:27], v[204:205] op_sel_hi:[1,0]
  v_pk_mul_f32 v[28:29], v[28:29], v[204:205] op_sel_hi:[1,0]
  v_pk_mul_f32 v[30:31], v[30:31], v[204:205] op_sel_hi:[1,0]
  v_cvt_pk_bf16_f32 v24, v24, v25
  v_cvt_pk_bf16_f32 v25, v26, v27
  v_cvt_pk_bf16_f32 v26, v28, v29
  v_cvt_pk_bf16_f32 v27, v30, v31
  buffer_store_dwordx4 v[24:27], v244, s[24:27], s43 offen offset:2048 sc1
  v_accvgpr_read_b32 v32, a96
  v_accvgpr_read_b32 v33, a97
  v_accvgpr_read_b32 v34, a98
  v_accvgpr_read_b32 v35, a99
  v_accvgpr_read_b32 v36, a112
  v_accvgpr_read_b32 v37, a113
  v_accvgpr_read_b32 v38, a114
  v_accvgpr_read_b32 v39, a115
  v_pk_mul_f32 v[32:33], v[32:33], v[192:193] op_sel_hi:[1,0]
  v_pk_mul_f32 v[34:35], v[34:35], v[192:193] op_sel_hi:[1,0]
  v_pk_mul_f32 v[36:37], v[36:37], v[192:193] op_sel_hi:[1,0]
  v_pk_mul_f32 v[38:39], v[38:39], v[192:193] op_sel_hi:[1,0]
  v_cvt_pk_bf16_f32 v32, v32, v33
  v_cvt_pk_bf16_f32 v33, v34, v35
  v_cvt_pk_bf16_f32 v34, v36, v37
  v_cvt_pk_bf16_f32 v35, v38, v39
  buffer_store_dwordx4 v[32:35], v244, s[24:27], s42 offen offset:1024 sc1
  v_accvgpr_read_b32 v40, a100
  v_accvgpr_read_b32 v41, a101
  v_accvgpr_read_b32 v42, a102
  v_accvgpr_read_b32 v43, a103
  v_accvgpr_read_b32 v44, a116
  v_accvgpr_read_b32 v45, a117
  v_accvgpr_read_b32 v46, a118
  v_accvgpr_read_b32 v47, a119
  v_pk_mul_f32 v[40:41], v[40:41], v[196:197] op_sel_hi:[1,0]
  v_pk_mul_f32 v[42:43], v[42:43], v[196:197] op_sel_hi:[1,0]
  v_pk_mul_f32 v[44:45], v[44:45], v[196:197] op_sel_hi:[1,0]
  v_pk_mul_f32 v[46:47], v[46:47], v[196:197] op_sel_hi:[1,0]
  v_cvt_pk_bf16_f32 v40, v40, v41
  v_cvt_pk_bf16_f32 v41, v42, v43
  v_cvt_pk_bf16_f32 v42, v44, v45
  v_cvt_pk_bf16_f32 v43, v46, v47
  buffer_store_dwordx4 v[40:43], v244, s[24:27], s42 offen offset:3072 sc1
  v_accvgpr_read_b32 v48, a104
  v_accvgpr_read_b32 v49, a105
  v_accvgpr_read_b32 v50, a106
  v_accvgpr_read_b32 v51, a107
  v_accvgpr_read_b32 v52, a120
  v_accvgpr_read_b32 v53, a121
  v_accvgpr_read_b32 v54, a122
  v_accvgpr_read_b32 v55, a123
  v_pk_mul_f32 v[48:49], v[48:49], v[200:201] op_sel_hi:[1,0]
  v_pk_mul_f32 v[50:51], v[50:51], v[200:201] op_sel_hi:[1,0]
  v_pk_mul_f32 v[52:53], v[52:53], v[200:201] op_sel_hi:[1,0]
  v_pk_mul_f32 v[54:55], v[54:55], v[200:201] op_sel_hi:[1,0]
  v_cvt_pk_bf16_f32 v48, v48, v49
  v_cvt_pk_bf16_f32 v49, v50, v51
  v_cvt_pk_bf16_f32 v50, v52, v53
  v_cvt_pk_bf16_f32 v51, v54, v55
  buffer_store_dwordx4 v[48:51], v244, s[24:27], s43 offen offset:1024 sc1
  v_accvgpr_read_b32 v56, a108
  v_accvgpr_read_b32 v57, a109
  v_accvgpr_read_b32 v58, a110
  v_accvgpr_read_b32 v59, a111
  v_accvgpr_read_b32 v60, a124
  v_accvgpr_read_b32 v61, a125
  v_accvgpr_read_b32 v62, a126
  v_accvgpr_read_b32 v63, a127
  v_pk_mul_f32 v[56:57], v[56:57], v[204:205] op_sel_hi:[1,0]
  v_pk_mul_f32 v[58:59], v[58:59], v[204:205] op_sel_hi:[1,0]
  v_pk_mul_f32 v[60:61], v[60:61], v[204:205] op_sel_hi:[1,0]
  v_pk_mul_f32 v[62:63], v[62:63], v[204:205] op_sel_hi:[1,0]
  v_cvt_pk_bf16_f32 v56, v56, v57
  v_cvt_pk_bf16_f32 v57, v58, v59
  v_cvt_pk_bf16_f32 v58, v60, v61
  v_cvt_pk_bf16_f32 v59, v62, v63
  buffer_store_dwordx4 v[56:59], v244, s[24:27], s43 offen offset:3072 sc1
  ds_write_b32 v247, v245
  buffer_load_dwordx4 v[176:179], v252, s[24:27], s6 offen offset:3072 sc1
  buffer_load_dwordx4 v[180:183], v253, s[24:27], s6 offen offset:0 sc1
  buffer_load_dwordx4 v[184:187], v253, s[24:27], s6 offen offset:1024 sc1
  buffer_load_dwordx4 v[188:191], v253, s[24:27], s6 offen offset:2048 sc1
  buffer_load_dwordx4 a[0:3], v253, s[24:27], s6 offen offset:3072 sc1
  buffer_load_dwordx4 a[4:7], v242, s[24:27], s7 offen offset:0 sc1
  buffer_load_dwordx4 a[8:11], v242, s[24:27], s7 offen offset:1024 sc1
  buffer_load_dwordx4 a[12:15], v242, s[24:27], s7 offen offset:2048 sc1
  s_lshr_b32 s39, s37, 2
  s_lshl_b32 s39, s39, 3
  s_lshr_b32 s38, s36, 2
  s_add_u32 s39, s39, s38
  s_lshl_b32 s39, s39, 7
  s_add_u32 s39, s39, 2867200
  s_lshl_b32 s38, s3, 26
  v_lshlrev_b32 v64, 22, v242
  v_or_b32 v64, s38, v64
  v_mov_b32 v65, 1
  v_add_u32 v246, 157696, v242
  s_waitcnt vmcnt(8) lgkmcnt(0)
  s_barrier
  ds_read_b128 v[68:71], v246
  s_waitcnt lgkmcnt(0)
  v_or3_b32 v68, v68, v69, v70
  v_or_b32 v68, v68, v71
  v_cmp_ne_u32 vcc, 0, v68
  s_nop 0
  s_cbranch_vccnz attn_redo
tail_go:
  buffer_atomic_add v65, v64, s[24:27], s39 offen
  s_and_b32 s36, s2, 1
  s_bfe_u32 s31, s2, 0x20001
  s_lshl_b32 s31, s31, 2
  s_bfe_u32 s38, s2, 0x20003
  s_add_u32 s31, s31, s38
  s_lshr_b32 s29, s2, 5
  v_mov_b32 v114, v242
  v_add_u32 v115, 0x1000, v114
  v_add_u32 v116, 0x2000, v114
  s_lshl_b32 s38, s36, 2
  s_add_u32 s38, s38, s3
  s_lshl_b32 s30, s38, 16
  buffer_load_dwordx4 a[16:19], v114, s[24:27], s7 offen offset:3072 sc1
  buffer_load_dwordx4 a[20:23], v115, s[24:27], s7 offen offset:0 sc1
  buffer_load_dwordx4 a[24:27], v115, s[24:27], s7 offen offset:1024 sc1
  buffer_load_dwordx4 a[28:31], v115, s[24:27], s7 offen offset:2048 sc1
  v_lshrrev_b32 v192, 4, v114
  v_and_b32 v193, 15, v192
  v_lshrrev_b32 v194, 4, v192
  s_add_u32 s38, s3, 0
  s_and_b32 s38, s38, 3
  s_lshl_b32 s38, s38, 11
  v_add_u32 v110, s38, v114
  s_sub_u32 s38, s3, 0
  s_and_b32 s38, s38, 3
  s_mul_i32 s38, s38, 15360
  s_add_u32 s38, s38, 98304
  v_add_u32 v118, s38, v114
  s_add_u32 s38, s3, 1
  s_and_b32 s38, s38, 3
  s_lshl_b32 s38, s38, 11
  v_add_u32 v111, s38, v114
  s_sub_u32 s38, s3, 1
  s_and_b32 s38, s38, 3
  s_mul_i32 s38, s38, 15360
  s_add_u32 s38, s38, 98304
  v_add_u32 v119, s38, v114
  s_add_u32 s38, s3, 2
  s_and_b32 s38, s38, 3
  s_lshl_b32 s38, s38, 11
  v_add_u32 v112, s38, v114
  s_sub_u32 s38, s3, 2
  s_and_b32 s38, s38, 3
  s_mul_i32 s38, s38, 15360
  s_add_u32 s38, s38, 98304
  v_add_u32 v120, s38, v114
  s_add_u32 s38, s3, 3
  s_and_b32 s38, s38, 3
  s_lshl_b32 s38, s38, 11
  v_add_u32 v113, s38, v114
  s_sub_u32 s38, s3, 3
  s_and_b32 s38, s38, 3
  s_mul_i32 s38, s38, 15360
  s_add_u32 s38, s38, 98304
  v_add_u32 v121, s38, v114
  v_add_u32 v122, s28, v114
  v_add_u32 v202, 0x10000, v122
  s_and_b32 s38, s31, 14
  s_add_u32 s38, s38, s36
  s_lshl_b32 s38, s38, 2
  s_add_u32 s38, s38, s3
  s_lshl_b32 s38, s38, 7
  s_add_u32 s38, s38, 2867200
  s_lshl_b32 s39, s29, 8
  s_add_u32 s39, s39, 2818304
  v_mov_b32 v200, s38
  v_writelane_b32 v200, s39, 1
  v_mov_b32 v201, 4
  v_writelane_b32 v201, 30, 1
  s_lshl_b32 s31, s31, 1
  s_add_u32 s31, s31, s36
  s_add_u32 s30, s30, 8388608
  s_lshl_b32 s38, s31, 19
  s_add_u32 s37, s30, s38
  s_xor_b32 s38, s38, 0x80000
  s_add_u32 s30, s30, s38
  s_lshl_b32 s40, s29, 5
  s_add_u32 s40, s40, s31
  s_lshl_b32 s38, s31, 6
  s_lshl_b32 s39, s3, 4
  s_add_u32 s38, s38, s39
  v_add_u32 v195, s38, v193
  v_mul_u32_u24 v117, 0x500, v195
  v_lshl_add_u32 v117, v194, 3, v117
  s_mul_i32 s38, s29, 160
  v_add_u32 v117, s38, v117
  s_mov_b32 s12, s60
  s_mov_b32 s13, s61
  s_mov_b32 s14, 2621440
  s_mov_b32 s15, 0x20000
  s_mov_b32 s16, s62
  s_mov_b32 s17, s63
  s_mov_b32 s18, 2621440
  s_mov_b32 s19, 0x20000
  s_mul_i32 s38, s31, 81920
  s_lshl_b32 s39, s3, 10
  s_add_u32 s38, s38, s39
  s_mul_i32 s39, s29, 10
  v_lshrrev_b32 v196, 1, v194
  v_add_u32 v196, s39, v196
  v_and_b32 v197, 1, v194
  v_lshlrev_b32 v197, 3, v197
  v_lshl_add_u32 v197, v193, 4, v197
  v_lshrrev_b32 v198, 2, v196
  v_lshl_add_u32 v198, v198, 12, v197
  v_and_b32 v199, 3, v196
  v_lshl_add_u32 v198, v199, 8, v198
  buffer_load_dwordx2 v[224:225], v198, s[24:27], s38 offen sc1
  v_add_u32 v196, 2, v196
  buffer_load_dwordx2 v[80:81], v117, s[12:15], 0 offen offset:0
  v_lshrrev_b32 v198, 2, v196
  v_lshl_add_u32 v198, v198, 12, v197
  v_and_b32 v199, 3, v196
  v_lshl_add_u32 v198, v199, 8, v198
  buffer_load_dwordx2 v[226:227], v198, s[24:27], s38 offen sc1
  v_add_u32 v196, 2, v196
  buffer_load_dwordx2 v[82:83], v117, s[12:15], 0 offen offset:32
  v_lshrrev_b32 v198, 2, v196
  v_lshl_add_u32 v198, v198, 12, v197
  v_and_b32 v199, 3, v196
  v_lshl_add_u32 v198, v199, 8, v198
  buffer_load_dwordx2 v[228:229], v198, s[24:27], s38 offen sc1
  v_add_u32 v196, 2, v196
  buffer_load_dwordx2 v[84:85], v117, s[12:15], 0 offen offset:64
  v_lshrrev_b32 v198, 2, v196
  v_lshl_add_u32 v198, v198, 12, v197
  v_and_b32 v199, 3, v196
  v_lshl_add_u32 v198, v199, 8, v198
  buffer_load_dwordx2 v[230:231], v198, s[24:27], s38 offen sc1
  v_add_u32 v196, 2, v196
  buffer_load_dwordx2 v[86:87], v117, s[12:15], 0 offen offset:96
  v_lshrrev_b32 v198, 2, v196
  v_lshl_add_u32 v198, v198, 12, v197
  v_and_b32 v199, 3, v196
  v_lshl_add_u32 v198, v199, 8, v198
  buffer_load_dwordx2 v[232:233], v198, s[24:27], s38 offen sc1
  v_add_u32 v196, 2, v196
  buffer_load_dwordx2 v[88:89], v117, s[12:15], 0 offen offset:128
  v_mov_b32 v123, 1073741824
  v_bfrev_b32 v124, 1
  v_sub_u32 v195, 0xffff, v195
  s_mov_b32 s34, 0xffff0000
  s_and_b32 s38, s52, 0xffff
  v_cmp_eq_u32 vcc, s38, v195
  v_mov_b32 v196, s52
  v_mov_b32 v197, 0
  v_cndmask_b32 v124, v124, v196, vcc
  v_cndmask_b32 v123, v123, v197, vcc
  s_and_b32 s38, s53, 0xffff
  v_cmp_eq_u32 vcc, s38, v195
  v_mov_b32 v196, s53
  v_mov_b32 v197, 2560
  v_cndmask_b32 v124, v124, v196, vcc
  v_cndmask_b32 v123, v123, v197, vcc
  s_and_b32 s38, s54, 0xffff
  v_cmp_eq_u32 vcc, s38, v195
  v_mov_b32 v196, s54
  v_mov_b32 v197, 5120
  v_cndmask_b32 v124, v124, v196, vcc
  v_cndmask_b32 v123, v123, v197, vcc
  s_and_b32 s38, s55, 0xffff
  v_cmp_eq_u32 vcc, s38, v195
  v_mov_b32 v196, s55
  v_mov_b32 v197, 7680
  v_cndmask_b32 v124, v124, v196, vcc
  v_cndmask_b32 v123, v123, v197, vcc
  s_and_b32 s38, s56, 0xffff
  v_cmp_eq_u32 vcc, s38, v195
  v_mov_b32 v196, s56
  v_mov_b32 v197, 10240
  v_cndmask_b32 v124, v124, v196, vcc
  v_cndmask_b32 v123, v123, v197, vcc
  s_and_b32 s38, s57, 0xffff
  v_cmp_eq_u32 vcc, s38, v195
  v_mov_b32 v196, s57
  v_mov_b32 v197, 12800
  v_cndmask_b32 v124, v124, v196, vcc
  v_cndmask_b32 v123, v123, v197, vcc
  s_and_b32 s38, s58, 0xffff
  v_cmp_eq_u32 vcc, s38, v195
  v_mov_b32 v196, s58
  v_mov_b32 v197, 15360
  v_cndmask_b32 v124, v124, v196, vcc
  v_cndmask_b32 v123, v123, v197, vcc
  s_and_b32 s38, s59, 0xffff
  v_cmp_eq_u32 vcc, s38, v195
  v_mov_b32 v196, s59
  v_mov_b32 v197, 17920
  v_cndmask_b32 v124, v124, v196, vcc
  v_cndmask_b32 v123, v123, v197, vcc
  v_lshl_add_u32 v123, v194, 4, v123
  s_mul_i32 s32, s29, 320
  s_add_u32 s32, s32, 2686976
  v_ashrrev_i32 v196, 31, v124
  v_not_b32 v196, v196
  v_or_b32 v196, 0x80000000, v196
  v_xor_b32 v124, v124, v196
  v_and_b32 v124, s34, v124
  v_mul_f32 v124, 0xbfb8aa3b, v124
  v_exp_f32 v124, v124
  s_nop 0
  v_add_f32 v124, 1.0, v124
  v_rcp_f32 v124, v124
  s_nop 0
  v_cvt_pk_bf16_f32 v124, v124, v124
  v_lshlrev_b32 v124, 16, v124
  buffer_load_dword v195, v200, s[24:27], 0 offen sc1
  buffer_load_dwordx4 a[32:35], v115, s[24:27], s7 offen offset:3072 sc1
  buffer_load_dwordx4 a[36:39], v116, s[24:27], s7 offen offset:0 sc1
  buffer_load_dwordx4 a[40:43], v116, s[24:27], s7 offen offset:1024 sc1
  buffer_load_dwordx4 a[44:47], v116, s[24:27], s7 offen offset:2048 sc1
  buffer_load_dwordx4 a[48:51], v116, s[24:27], s7 offen offset:3072 sc1
  buffer_load_dwordx4 a[52:55], v114, s[24:27], s8 offen offset:0 sc1
  s_waitcnt vmcnt(16)
  v_lshlrev_b32 v90, 16, v224
  v_and_b32 v91, s34, v224
  v_lshlrev_b32 v92, 16, v225
  v_and_b32 v93, s34, v225
  s_waitcnt vmcnt(14)
  v_lshlrev_b32 v94, 16, v226
  v_and_b32 v95, s34, v226
  v_lshlrev_b32 v96, 16, v227
  v_and_b32 v97, s34, v227
  s_waitcnt vmcnt(12)
  v_lshlrev_b32 v98, 16, v228
  v_and_b32 v99, s34, v228
  v_lshlrev_b32 v100, 16, v229
  v_and_b32 v101, s34, v229
  s_waitcnt vmcnt(10)
  v_lshlrev_b32 v102, 16, v230
  v_and_b32 v103, s34, v230
  v_lshlrev_b32 v104, 16, v231
  v_and_b32 v105, s34, v231
  s_waitcnt vmcnt(8)
  v_lshlrev_b32 v106, 16, v232
  v_and_b32 v107, s34, v232
  v_lshlrev_b32 v108, 16, v233
  v_and_b32 v109, s34, v233
  v_mov_b32 v224, 0
  v_mov_b32 v225, 0
  v_mov_b32 v226, 0
  v_mov_b32 v227, 0
  v_mov_b32 v228, 0
  v_mov_b32 v229, 0
  v_mov_b32 v230, 0
  v_mov_b32 v231, 0
  v_mov_b32 v232, 0
  v_mov_b32 v233, 0
  v_mov_b32 v234, 0
  v_mov_b32 v235, 0
  v_mov_b32 v236, 0
  v_mov_b32 v237, 0
  v_mov_b32 v238, 0
  v_mov_b32 v239, 0
  v_mov_b32 v240, 0
  v_mov_b32 v241, 0
  v_mov_b32 v242, 0
  v_mov_b32 v243, 0
  s_waitcnt vmcnt(6)
  v_cmp_lt_u32 vcc, v195, v201
  s_nop 0
  s_cbranch_vccz tail_ready
  s_waitcnt vmcnt(0)
  s_mov_b32 s35, 32768
  buffer_load_dword v195, v200, s[24:27], 0 offen sc1
  s_sleep 3
  buffer_load_dword v196, v200, s[24:27], 0 offen sc1
  s_sleep 3
tail_spin:
  buffer_load_dword v197, v200, s[24:27], 0 offen sc1
  s_waitcnt vmcnt(2)
  v_cmp_lt_u32 vcc, v195, v201
  s_nop 0
  s_cbranch_vccz tail_ready
  s_sleep 3
  buffer_load_dword v195, v200, s[24:27], 0 offen sc1
  s_waitcnt vmcnt(2)
  v_cmp_lt_u32 vcc, v196, v201
  s_nop 0
  s_cbranch_vccz tail_ready
  s_sleep 3
  buffer_load_dword v196, v200, s[24:27], 0 offen sc1
  s_waitcnt vmcnt(2)
  v_cmp_lt_u32 vcc, v197, v201
  s_nop 0
  s_cbranch_vccz tail_ready
  s_sleep 3
  s_sub_u32 s35, s35, 1
  s_cmp_lg_u32 s35, 0
  s_cbranch_scc1 tail_spin
tail_ready:
  buffer_load_dwordx4 a[84:87], v110, s[24:27], s30 offen offset:0 sc1
  buffer_load_dwordx4 a[88:91], v110, s[24:27], s30 offen offset:1024 sc1
  buffer_load_dwordx4 a[92:95], v111, s[24:27], s30 offen offset:0 sc1
  buffer_load_dwordx4 a[96:99], v111, s[24:27], s30 offen offset:1024 sc1
  buffer_load_dwordx4 a[100:103], v112, s[24:27], s30 offen offset:0 sc1
  buffer_load_dwordx4 a[104:107], v112, s[24:27], s30 offen offset:1024 sc1
  buffer_load_dwordx4 a[108:111], v113, s[24:27], s30 offen offset:0 sc1
  buffer_load_dwordx4 a[112:115], v113, s[24:27], s30 offen offset:1024 sc1
  v_cmp_gt_u32 vcc, 1073741824, v123
  s_nop 0
  s_and_saveexec_b64 s[42:43], vcc
  s_cbranch_execz tail_plain
  s_waitcnt vmcnt(30)
  buffer_load_dwordx4 v[224:227], v123, s[24:27], s32 offen offset:0 sc1
  buffer_load_dwordx4 v[228:231], v123, s[24:27], s32 offen offset:64 sc1
  buffer_load_dwordx4 v[232:235], v123, s[24:27], s32 offen offset:128 sc1
  buffer_load_dwordx4 v[236:239], v123, s[24:27], s32 offen offset:192 sc1
  buffer_load_dwordx4 v[240:243], v123, s[24:27], s32 offen offset:256 sc1
  s_add_u32 s32, s32, 20480
  buffer_load_dwordx4 v[204:207], v123, s[24:27], s32 offen offset:0 sc1
  buffer_load_dwordx4 v[208:211], v123, s[24:27], s32 offen offset:64 sc1
  buffer_load_dwordx4 v[212:215], v123, s[24:27], s32 offen offset:128 sc1
  buffer_load_dwordx4 v[216:219], v123, s[24:27], s32 offen offset:192 sc1
  buffer_load_dwordx4 v[220:223], v123, s[24:27], s32 offen offset:256 sc1
  s_add_u32 s32, s32, 20480
  buffer_load_dwordx4 v[0:3], v123, s[24:27], s32 offen offset:0 sc1
  buffer_load_dwordx4 v[4:7], v123, s[24:27], s32 offen offset:64 sc1
  buffer_load_dwordx4 v[8:11], v123, s[24:27], s32 offen offset:128 sc1
  buffer_load_dwordx4 v[12:15], v123, s[24:27], s32 offen offset:192 sc1
  buffer_load_dwordx4 v[16:19], v123, s[24:27], s32 offen offset:256 sc1
  s_add_u32 s32, s32, 20480
  buffer_load_dwordx4 v[20:23], v123, s[24:27], s32 offen offset:0 sc1
  buffer_load_dwordx4 v[24:27], v123, s[24:27], s32 offen offset:64 sc1
  buffer_load_dwordx4 v[28:31], v123, s[24:27], s32 offen offset:128 sc1
  buffer_load_dwordx4 v[32:35], v123, s[24:27], s32 offen offset:192 sc1
  buffer_load_dwordx4 v[36:39], v123, s[24:27], s32 offen offset:256 sc1
  s_add_u32 s32, s32, 20480
  buffer_load_dwordx4 v[40:43], v123, s[24:27], s32 offen offset:0 sc1
  buffer_load_dwordx4 v[44:47], v123, s[24:27], s32 offen offset:64 sc1
  buffer_load_dwordx4 v[48:51], v123, s[24:27], s32 offen offset:128 sc1
  buffer_load_dwordx4 v[52:55], v123, s[24:27], s32 offen offset:192 sc1
  buffer_load_dwordx4 v[56:59], v123, s[24:27], s32 offen offset:256 sc1
  s_add_u32 s32, s32, 20480
  buffer_load_dwordx4 v[60:63], v123, s[24:27], s32 offen offset:0 sc1
  buffer_load_dwordx4 v[64:67], v123, s[24:27], s32 offen offset:64 sc1
  buffer_load_dwordx4 v[68:71], v123, s[24:27], s32 offen offset:128 sc1
  buffer_load_dwordx4 v[72:75], v123, s[24:27], s32 offen offset:192 sc1
  buffer_load_dwordx4 v[76:79], v123, s[24:27], s32 offen offset:256 sc1
  s_add_u32 s32, s32, 20480
  s_waitcnt vmcnt(0)
  v_add_f32 v224, v224, v204
  v_add_f32 v225, v225, v205
  v_add_f32 v226, v226, v206
  v_add_f32 v227, v227, v207
  v_add_f32 v228, v228, v208
  v_add_f32 v229, v229, v209
  v_add_f32 v230, v230, v210
  v_add_f32 v231, v231, v211
  v_add_f32 v232, v232, v212
  v_add_f32 v233, v233, v213
  v_add_f32 v234, v234, v214
  v_add_f32 v235, v235, v215
  v_add_f32 v236, v236, v216
  v_add_f32 v237, v237, v217
  v_add_f32 v238, v238, v218
  v_add_f32 v239, v239, v219
  v_add_f32 v240, v240, v220
  v_add_f32 v241, v241, v221
  v_add_f32 v242, v242, v222
  v_add_f32 v243, v243, v223
  v_add_f32 v224, v224, v0
  v_add_f32 v225, v225, v1
  v_add_f32 v226, v226, v2
  v_add_f32 v227, v227, v3
  v_add_f32 v228, v228, v4
  v_add_f32 v229, v229, v5
  v_add_f32 v230, v230, v6
  v_add_f32 v231, v231, v7
  v_add_f32 v232, v232, v8
  v_add_f32 v233, v233, v9
  v_add_f32 v234, v234, v10
  v_add_f32 v235, v235, v11
  v_add_f32 v236, v236, v12
  v_add_f32 v237, v237, v13
  v_add_f32 v238, v238, v14
  v_add_f32 v239, v239, v15
  v_add_f32 v240, v240, v16
  v_add_f32 v241, v241, v17
  v_add_f32 v242, v242, v18
  v_add_f32 v243, v243, v19
  v_add_f32 v224, v224, v20
  v_add_f32 v225, v225, v21
  v_add_f32 v226, v226, v22
  v_add_f32 v227, v227, v23
  v_add_f32 v228, v228, v24
  v_add_f32 v229, v229, v25
  v_add_f32 v230, v230, v26
  v_add_f32 v231, v231, v27
  v_add_f32 v232, v232, v28
  v_add_f32 v233, v233, v29
  v_add_f32 v234, v234, v30
  v_add_f32 v235, v235, v31
  v_add_f32 v236, v236, v32
  v_add_f32 v237, v237, v33
  v_add_f32 v238, v238, v34
  v_add_f32 v239, v239, v35
  v_add_f32 v240, v240, v36
  v_add_f32 v241, v241, v37
  v_add_f32 v242, v242, v38
  v_add_f32 v243, v243, v39
  v_add_f32 v224, v224, v40
  v_add_f32 v225, v225, v41
  v_add_f32 v226, v226, v42
  v_add_f32 v227, v227, v43
  v_add_f32 v228, v228, v44
  v_add_f32 v229, v229, v45
  v_add_f32 v230, v230, v46
  v_add_f32 v231, v231, v47
  v_add_f32 v232, v232, v48
  v_add_f32 v233, v233, v49
  v_add_f32 v234, v234, v50
  v_add_f32 v235, v235, v51
  v_add_f32 v236, v236, v52
  v_add_f32 v237, v237, v53
  v_add_f32 v238, v238, v54
  v_add_f32 v239, v239, v55
  v_add_f32 v240, v240, v56
  v_add_f32 v241, v241, v57
  v_add_f32 v242, v242, v58
  v_add_f32 v243, v243, v59
  v_add_f32 v224, v224, v60
  v_add_f32 v225, v225, v61
  v_add_f32 v226, v226, v62
  v_add_f32 v227, v227, v63
  v_add_f32 v228, v228, v64
  v_add_f32 v229, v229, v65
  v_add_f32 v230, v230, v66
  v_add_f32 v231, v231, v67
  v_add_f32 v232, v232, v68
  v_add_f32 v233, v233, v69
  v_add_f32 v234, v234, v70
  v_add_f32 v235, v235, v71
  v_add_f32 v236, v236, v72
  v_add_f32 v237, v237, v73
  v_add_f32 v238, v238, v74
  v_add_f32 v239, v239, v75
  v_add_f32 v240, v240, v76
  v_add_f32 v241, v241, v77
  v_add_f32 v242, v242, v78
  v_add_f32 v243, v243, v79
tail_plain:
  s_mov_b64 exec, s[42:43]
  s_waitcnt vmcnt(0)
  v_mfma_f32_16x16x32_bf16 v[0:3], a[212:215], a[84:87], 0
  s_add_u32 s30, s30, 8192
  buffer_load_dwordx4 a[116:119], v110, s[24:27], s30 offen offset:0 sc1
  v_mfma_f32_16x16x32_bf16 v[0:3], a[232:235], a[88:91], v[0:3]
  v_cvt_pk_bf16_f32 v224, v224, v224
  v_cvt_pk_bf16_f32 v225, v225, v225
  v_mfma_f32_16x16x32_bf16 v[4:7], a[232:235], a[96:99], 0
  buffer_load_dwordx4 a[56:59], v114, s[24:27], s8 offen offset:1024 sc1
  v_mfma_f32_16x16x32_bf16 v[4:7], a[212:215], a[92:95], v[4:7]
  v_cvt_pk_bf16_f32 v226, v226, v226
  v_cvt_pk_bf16_f32 v227, v227, v227
  v_mfma_f32_16x16x32_bf16 v[8:11], a[212:215], a[100:103], 0
  buffer_load_dwordx4 a[120:123], v110, s[24:27], s30 offen offset:1024 sc1
  v_mfma_f32_16x16x32_bf16 v[8:11], a[232:235], a[104:107], v[8:11]
  v_lshlrev_b32 v224, 16, v224
  v_lshlrev_b32 v225, 16, v225
  v_mfma_f32_16x16x32_bf16 v[12:15], a[232:235], a[112:115], 0
  v_lshlrev_b32 v226, 16, v226
  v_lshlrev_b32 v227, 16, v227
  v_mfma_f32_16x16x32_bf16 v[12:15], a[212:215], a[108:111], v[12:15]
  v_mul_f32 v224, v224, v124
  v_mul_f32 v225, v225, v124
  v_mfma_f32_16x16x32_bf16 v[16:19], a[216:219], a[84:87], 0
  buffer_load_dwordx4 a[124:127], v111, s[24:27], s30 offen offset:0 sc1
  v_mfma_f32_16x16x32_bf16 v[16:19], a[236:239], a[88:91], v[16:19]
  v_mul_f32 v226, v226, v124
  v_mul_f32 v227, v227, v124
  v_mfma_f32_16x16x32_bf16 v[20:23], a[236:239], a[96:99], 0
  buffer_load_dwordx4 a[60:63], v114, s[24:27], s8 offen offset:2048 sc1
  v_mfma_f32_16x16x32_bf16 v[20:23], a[216:219], a[92:95], v[20:23]
  v_cvt_pk_bf16_f32 v224, v224, v224
  v_cvt_pk_bf16_f32 v225, v225, v225
  v_mfma_f32_16x16x32_bf16 v[24:27], a[216:219], a[100:103], 0
  buffer_load_dwordx4 a[160:163], v111, s[24:27], s30 offen offset:1024 sc1
  v_mfma_f32_16x16x32_bf16 v[24:27], a[236:239], a[104:107], v[24:27]
  v_cvt_pk_bf16_f32 v226, v226, v226
  v_cvt_pk_bf16_f32 v227, v227, v227
  v_mfma_f32_16x16x32_bf16 v[28:31], a[236:239], a[112:115], 0
  v_lshlrev_b32 v224, 16, v224
  v_lshlrev_b32 v225, 16, v225
  v_mfma_f32_16x16x32_bf16 v[28:31], a[216:219], a[108:111], v[28:31]
  v_lshlrev_b32 v226, 16, v226
  v_lshlrev_b32 v227, 16, v227
  v_mfma_f32_16x16x32_bf16 v[32:35], a[220:223], a[84:87], 0
  buffer_load_dwordx4 a[164:167], v112, s[24:27], s30 offen offset:0 sc1
  v_mfma_f32_16x16x32_bf16 v[32:35], a[240:243], a[88:91], v[32:35]
  v_add_f32 v90, v90, v224
  v_add_f32 v91, v91, v225
  v_mfma_f32_16x16x32_bf16 v[36:39], a[240:243], a[96:99], 0
  buffer_load_dwordx4 a[64:67], v114, s[24:27], s8 offen offset:3072 sc1
  v_mfma_f32_16x16x32_bf16 v[36:39], a[220:223], a[92:95], v[36:39]
  v_add_f32 v92, v92, v226
  v_add_f32 v93, v93, v227
  v_mfma_f32_16x16x32_bf16 v[40:43], a[220:223], a[100:103], 0
  buffer_load_dwordx4 a[168:171], v112, s[24:27], s30 offen offset:1024 sc1
  v_mfma_f32_16x16x32_bf16 v[40:43], a[240:243], a[104:107], v[40:43]
  v_cvt_pk_bf16_f32 v90, v90, v90
  v_cvt_pk_bf16_f32 v91, v91, v91
  v_mfma_f32_16x16x32_bf16 v[44:47], a[240:243], a[112:115], 0
  v_cvt_pk_bf16_f32 v92, v92, v92
  v_cvt_pk_bf16_f32 v93, v93, v93
  v_mfma_f32_16x16x32_bf16 v[44:47], a[220:223], a[108:111], v[44:47]
  v_lshlrev_b32 v90, 16, v90
  v_lshlrev_b32 v91, 16, v91
  v_mfma_f32_16x16x32_bf16 v[48:51], a[224:227], a[84:87], 0
  buffer_load_dwordx4 a[172:175], v113, s[24:27], s30 offen offset:0 sc1
  v_mfma_f32_16x16x32_bf16 v[48:51], a[244:247], a[88:91], v[48:51]
  v_lshlrev_b32 v92, 16, v92
  v_lshlrev_b32 v93, 16, v93
  v_mfma_f32_16x16x32_bf16 v[52:55], a[244:247], a[96:99], 0
  buffer_load_dwordx4 a[68:71], v115, s[24:27], s8 offen offset:0 sc1
  v_mfma_f32_16x16x32_bf16 v[52:55], a[224:227], a[92:95], v[52:55]
  v_mul_f32 v196, 0xbfb8aa3b, v90
  v_mul_f32 v197, 0xbfb8aa3b, v91
  v_mfma_f32_16x16x32_bf16 v[56:59], a[224:227], a[100:103], 0
  buffer_load_dwordx4 a[176:179], v113, s[24:27], s30 offen offset:1024 sc1
  v_mfma_f32_16x16x32_bf16 v[56:59], a[244:247], a[104:107], v[56:59]
  v_mul_f32 v198, 0xbfb8aa3b, v92
  v_mul_f32 v199, 0xbfb8aa3b, v93
  v_mfma_f32_16x16x32_bf16 v[60:63], a[244:247], a[112:115], 0
  v_exp_f32 v196, v196
  v_mfma_f32_16x16x32_bf16 v[60:63], a[224:227], a[108:111], v[60:63]
  v_exp_f32 v197, v197
  v_mfma_f32_16x16x32_bf16 v[64:67], a[228:231], a[84:87], 0
  s_add_u32 s30, s30, 8192
  buffer_load_dwordx4 a[180:183], v110, s[24:27], s30 offen offset:0 sc1
  v_mfma_f32_16x16x32_bf16 v[64:67], a[248:251], a[88:91], v[64:67]
  v_exp_f32 v198, v198
  v_mfma_f32_16x16x32_bf16 v[68:71], a[248:251], a[96:99], 0
  buffer_load_dwordx4 a[72:75], v115, s[24:27], s8 offen offset:1024 sc1
  v_mfma_f32_16x16x32_bf16 v[68:71], a[228:231], a[92:95], v[68:71]
  v_exp_f32 v199, v199
  v_mfma_f32_16x16x32_bf16 v[72:75], a[228:231], a[100:103], 0
  buffer_load_dwordx4 a[184:187], v110, s[24:27], s30 offen offset:1024 sc1
  v_mfma_f32_16x16x32_bf16 v[72:75], a[248:251], a[104:107], v[72:75]
  v_add_f32 v196, 1.0, v196
  v_add_f32 v197, 1.0, v197
  v_mfma_f32_16x16x32_bf16 v[76:79], a[248:251], a[112:115], 0
  v_add_f32 v198, 1.0, v198
  v_add_f32 v199, 1.0, v199
  v_mfma_f32_16x16x32_bf16 v[76:79], a[228:231], a[108:111], v[76:79]
  v_rcp_f32 v196, v196
  s_waitcnt vmcnt(3)
  v_mfma_f32_16x16x32_bf16 v[0:3], a[252:255], a[116:119], v[0:3]
  buffer_load_dwordx4 a[188:191], v111, s[24:27], s30 offen offset:0 sc1
  v_mfma_f32_16x16x32_bf16 v[0:3], a[144:147], a[120:123], v[0:3]
  v_rcp_f32 v197, v197
  v_mfma_f32_16x16x32_bf16 v[4:7], a[144:147], a[160:163], v[4:7]
  buffer_load_dwordx4 a[76:79], v115, s[24:27], s8 offen offset:2048 sc1
  v_mfma_f32_16x16x32_bf16 v[4:7], a[252:255], a[124:127], v[4:7]
  v_rcp_f32 v198, v198
  v_mfma_f32_16x16x32_bf16 v[8:11], a[252:255], a[164:167], v[8:11]
  buffer_load_dwordx4 a[192:195], v111, s[24:27], s30 offen offset:1024 sc1
  v_mfma_f32_16x16x32_bf16 v[8:11], a[144:147], a[168:171], v[8:11]
  v_rcp_f32 v199, v199
  v_mfma_f32_16x16x32_bf16 v[12:15], a[144:147], a[176:179], v[12:15]
  v_mul_f32 v90, v90, v196
  v_mul_f32 v91, v91, v197
  v_mfma_f32_16x16x32_bf16 v[12:15], a[252:255], a[172:175], v[12:15]
  v_mul_f32 v92, v92, v198
  v_mul_f32 v93, v93, v199
  v_mfma_f32_16x16x32_bf16 v[16:19], a[128:131], a[116:119], v[16:19]
  buffer_load_dwordx4 a[196:199], v112, s[24:27], s30 offen offset:0 sc1
  v_mfma_f32_16x16x32_bf16 v[16:19], a[148:151], a[120:123], v[16:19]
  v_cvt_pk_bf16_f32 v90, v90, v90
  v_cvt_pk_bf16_f32 v91, v91, v91
  v_mfma_f32_16x16x32_bf16 v[20:23], a[148:151], a[160:163], v[20:23]
  buffer_load_dwordx4 a[80:83], v115, s[24:27], s8 offen offset:3072 sc1
  v_mfma_f32_16x16x32_bf16 v[20:23], a[128:131], a[124:127], v[20:23]
  v_cvt_pk_bf16_f32 v92, v92, v92
  v_cvt_pk_bf16_f32 v93, v93, v93
  v_mfma_f32_16x16x32_bf16 v[24:27], a[128:131], a[164:167], v[24:27]
  buffer_load_dwordx4 a[200:203], v112, s[24:27], s30 offen offset:1024 sc1
  v_mfma_f32_16x16x32_bf16 v[24:27], a[148:151], a[168:171], v[24:27]
  v_lshlrev_b32 v90, 16, v90
  v_lshlrev_b32 v91, 16, v91
  v_mfma_f32_16x16x32_bf16 v[28:31], a[148:151], a[176:179], v[28:31]
  v_lshlrev_b32 v92, 16, v92
  v_lshlrev_b32 v93, 16, v93
  v_mfma_f32_16x16x32_bf16 v[28:31], a[128:131], a[172:175], v[28:31]
  v_cvt_pk_bf16_f32 v228, v228, v228
  v_cvt_pk_bf16_f32 v229, v229, v229
  v_mfma_f32_16x16x32_bf16 v[32:35], a[132:135], a[116:119], v[32:35]
  buffer_load_dwordx4 a[204:207], v113, s[24:27], s30 offen offset:0 sc1
  v_mfma_f32_16x16x32_bf16 v[32:35], a[152:155], a[120:123], v[32:35]
  v_cvt_pk_bf16_f32 v230, v230, v230
  v_cvt_pk_bf16_f32 v231, v231, v231
  v_mfma_f32_16x16x32_bf16 v[36:39], a[152:155], a[160:163], v[36:39]
  s_add_u32 m0, s28, 49152
  s_nop 0
  buffer_load_dwordx4 v115, s[24:27], s10 offen offset:0 sc1 lds
  v_mfma_f32_16x16x32_bf16 v[36:39], a[132:135], a[124:127], v[36:39]
  buffer_load_dwordx4 v115, s[24:27], s10 offen offset:1024 sc1 lds
  v_mfma_f32_16x16x32_bf16 v[40:43], a[132:135], a[164:167], v[40:43]
  buffer_load_dwordx4 v115, s[24:27], s10 offen offset:2048 sc1 lds
  v_mfma_f32_16x16x32_bf16 v[40:43], a[152:155], a[168:171], v[40:43]
  buffer_load_dwordx4 v115, s[24:27], s10 offen offset:3072 sc1 lds
  v_mfma_f32_16x16x32_bf16 v[44:47], a[152:155], a[176:179], v[44:47]
  buffer_load_dwordx4 a[208:211], v113, s[24:27], s30 offen offset:1024 sc1
  v_mfma_f32_16x16x32_bf16 v[44:47], a[132:135], a[172:175], v[44:47]
  v_lshlrev_b32 v228, 16, v228
  v_lshlrev_b32 v229, 16, v229
  v_mfma_f32_16x16x32_bf16 v[48:51], a[136:139], a[116:119], v[48:51]
  s_add_u32 s30, s30, 8192
  buffer_load_dwordx4 v[244:247], v110, s[24:27], s30 offen offset:0 sc1
  v_mfma_f32_16x16x32_bf16 v[48:51], a[156:159], a[120:123], v[48:51]
  v_lshlrev_b32 v230, 16, v230
  v_lshlrev_b32 v231, 16, v231
  v_mfma_f32_16x16x32_bf16 v[52:55], a[156:159], a[160:163], v[52:55]
  v_mul_f32 v228, v228, v124
  v_mul_f32 v229, v229, v124
  v_mfma_f32_16x16x32_bf16 v[52:55], a[136:139], a[124:127], v[52:55]
  v_mul_f32 v230, v230, v124
  v_mul_f32 v231, v231, v124
  v_mfma_f32_16x16x32_bf16 v[56:59], a[136:139], a[164:167], v[56:59]
  buffer_load_dwordx4 v[248:251], v110, s[24:27], s30 offen offset:1024 sc1
  v_mfma_f32_16x16x32_bf16 v[56:59], a[156:159], a[168:171], v[56:59]
  v_cvt_pk_bf16_f32 v228, v228, v228
  v_cvt_pk_bf16_f32 v229, v229, v229
  v_mfma_f32_16x16x32_bf16 v[60:63], a[156:159], a[176:179], v[60:63]
  v_cvt_pk_bf16_f32 v230, v230, v230
  v_cvt_pk_bf16_f32 v231, v231, v231
  v_mfma_f32_16x16x32_bf16 v[60:63], a[136:139], a[172:175], v[60:63]
  v_lshlrev_b32 v228, 16, v228
  v_lshlrev_b32 v229, 16, v229
  v_mfma_f32_16x16x32_bf16 v[64:67], a[140:143], a[116:119], v[64:67]
  buffer_load_dwordx4 v[252:255], v111, s[24:27], s30 offen offset:0 sc1
  v_mfma_f32_16x16x32_bf16 v[64:67], v[128:131], a[120:123], v[64:67]
  v_lshlrev_b32 v230, 16, v230
  v_lshlrev_b32 v231, 16, v231
  v_mfma_f32_16x16x32_bf16 v[68:71], v[128:131], a[160:163], v[68:71]
  v_add_f32 v94, v94, v228
  v_add_f32 v95, v95, v229
  v_mfma_f32_16x16x32_bf16 v[68:71], a[140:143], a[124:127], v[68:71]
  v_add_f32 v96, v96, v230
  v_add_f32 v97, v97, v231
  v_mfma_f32_16x16x32_bf16 v[72:75], a[140:143], a[164:167], v[72:75]
  buffer_load_dwordx4 v[204:207], v111, s[24:27], s30 offen offset:1024 sc1
  v_mfma_f32_16x16x32_bf16 v[72:75], v[128:131], a[168:171], v[72:75]
  v_cvt_pk_bf16_f32 v94, v94, v94
  v_cvt_pk_bf16_f32 v95, v95, v95
  v_mfma_f32_16x16x32_bf16 v[76:79], v[128:131], a[176:179], v[76:79]
  v_cvt_pk_bf16_f32 v96, v96, v96
  v_cvt_pk_bf16_f32 v97, v97, v97
  v_mfma_f32_16x16x32_bf16 v[76:79], a[140:143], a[172:175], v[76:79]
  v_lshlrev_b32 v94, 16, v94
  v_lshlrev_b32 v95, 16, v95
  s_waitcnt vmcnt(4)
  v_mfma_f32_16x16x32_bf16 v[0:3], v[132:135], a[180:183], v[0:3]
  buffer_load_dwordx4 v[208:211], v112, s[24:27], s30 offen offset:0 sc1
  v_mfma_f32_16x16x32_bf16 v[0:3], v[152:155], a[184:187], v[0:3]
  v_lshlrev_b32 v96, 16, v96
  v_lshlrev_b32 v97, 16, v97
  v_mfma_f32_16x16x32_bf16 v[4:7], v[152:155], a[192:195], v[4:7]
  v_mul_f32 v196, 0xbfb8aa3b, v94
  v_mul_f32 v197, 0xbfb8aa3b, v95
  v_mfma_f32_16x16x32_bf16 v[4:7], v[132:135], a[188:191], v[4:7]
  v_mul_f32 v198, 0xbfb8aa3b, v96
  v_mul_f32 v199, 0xbfb8aa3b, v97
  v_mfma_f32_16x16x32_bf16 v[8:11], v[132:135], a[196:199], v[8:11]
  buffer_load_dwordx4 v[212:215], v112, s[24:27], s30 offen offset:1024 sc1
  v_mfma_f32_16x16x32_bf16 v[8:11], v[152:155], a[200:203], v[8:11]
  v_exp_f32 v196, v196
  v_mfma_f32_16x16x32_bf16 v[12:15], v[152:155], a[208:211], v[12:15]
  v_exp_f32 v197, v197
  v_mfma_f32_16x16x32_bf16 v[12:15], v[132:135], a[204:207], v[12:15]
  v_exp_f32 v198, v198
  v_mfma_f32_16x16x32_bf16 v[16:19], v[136:139], a[180:183], v[16:19]
  buffer_load_dwordx4 v[216:219], v113, s[24:27], s30 offen offset:0 sc1
  v_mfma_f32_16x16x32_bf16 v[16:19], v[156:159], a[184:187], v[16:19]
  v_exp_f32 v199, v199
  v_mfma_f32_16x16x32_bf16 v[20:23], v[156:159], a[192:195], v[20:23]
  v_add_f32 v196, 1.0, v196
  v_add_f32 v197, 1.0, v197
  v_mfma_f32_16x16x32_bf16 v[20:23], v[136:139], a[188:191], v[20:23]
  v_add_f32 v198, 1.0, v198
  v_add_f32 v199, 1.0, v199
  v_mfma_f32_16x16x32_bf16 v[24:27], v[136:139], a[196:199], v[24:27]
  buffer_load_dwordx4 v[220:223], v113, s[24:27], s30 offen offset:1024 sc1
  v_mfma_f32_16x16x32_bf16 v[24:27], v[156:159], a[200:203], v[24:27]
  v_rcp_f32 v196, v196
  v_mfma_f32_16x16x32_bf16 v[28:31], v[156:159], a[208:211], v[28:31]
  v_rcp_f32 v197, v197
  v_mfma_f32_16x16x32_bf16 v[28:31], v[136:139], a[204:207], v[28:31]
  v_rcp_f32 v198, v198
  v_mfma_f32_16x16x32_bf16 v[32:35], v[140:143], a[180:183], v[32:35]
  s_add_u32 s30, s30, 8192
  buffer_load_dwordx4 a[84:87], v110, s[24:27], s30 offen offset:0 sc1
  v_mfma_f32_16x16x32_bf16 v[32:35], v[160:163], a[184:187], v[32:35]
  v_rcp_f32 v199, v199
  v_mfma_f32_16x16x32_bf16 v[36:39], v[160:163], a[192:195], v[36:39]
  v_mul_f32 v94, v94, v196
  v_mul_f32 v95, v95, v197
  v_mfma_f32_16x16x32_bf16 v[36:39], v[140:143], a[188:191], v[36:39]
  v_mul_f32 v96, v96, v198
  v_mul_f32 v97, v97, v199
  v_mfma_f32_16x16x32_bf16 v[40:43], v[140:143], a[196:199], v[40:43]
  buffer_load_dwordx4 a[88:91], v110, s[24:27], s30 offen offset:1024 sc1
  v_mfma_f32_16x16x32_bf16 v[40:43], v[160:163], a[200:203], v[40:43]
  v_cvt_pk_bf16_f32 v94, v94, v94
  v_cvt_pk_bf16_f32 v95, v95, v95
  v_mfma_f32_16x16x32_bf16 v[44:47], v[160:163], a[208:211], v[44:47]
  v_cvt_pk_bf16_f32 v96, v96, v96
  v_cvt_pk_bf16_f32 v97, v97, v97
  v_mfma_f32_16x16x32_bf16 v[44:47], v[140:143], a[204:207], v[44:47]
  v_lshlrev_b32 v94, 16, v94
  v_lshlrev_b32 v95, 16, v95
  v_mfma_f32_16x16x32_bf16 v[48:51], v[144:147], a[180:183], v[48:51]
  buffer_load_dwordx4 a[92:95], v111, s[24:27], s30 offen offset:0 sc1
  v_mfma_f32_16x16x32_bf16 v[48:51], v[164:167], a[184:187], v[48:51]
  v_lshlrev_b32 v96, 16, v96
  v_lshlrev_b32 v97, 16, v97
  v_mfma_f32_16x16x32_bf16 v[52:55], v[164:167], a[192:195], v[52:55]
  v_cvt_pk_bf16_f32 v232, v232, v232
  v_cvt_pk_bf16_f32 v233, v233, v233
  v_mfma_f32_16x16x32_bf16 v[52:55], v[144:147], a[188:191], v[52:55]
  v_cvt_pk_bf16_f32 v234, v234, v234
  v_cvt_pk_bf16_f32 v235, v235, v235
  v_mfma_f32_16x16x32_bf16 v[56:59], v[144:147], a[196:199], v[56:59]
  buffer_load_dwordx4 a[96:99], v111, s[24:27], s30 offen offset:1024 sc1
  v_mfma_f32_16x16x32_bf16 v[56:59], v[164:167], a[200:203], v[56:59]
  v_lshlrev_b32 v232, 16, v232
  v_lshlrev_b32 v233, 16, v233
  v_mfma_f32_16x16x32_bf16 v[60:63], v[164:167], a[208:211], v[60:63]
  v_lshlrev_b32 v234, 16, v234
  v_lshlrev_b32 v235, 16, v235
  v_mfma_f32_16x16x32_bf16 v[60:63], v[144:147], a[204:207], v[60:63]
  v_mul_f32 v232, v232, v124
  v_mul_f32 v233, v233, v124
  v_mfma_f32_16x16x32_bf16 v[64:67], v[148:151], a[180:183], v[64:67]
  buffer_load_dwordx4 a[100:103], v112, s[24:27], s30 offen offset:0 sc1
  v_mfma_f32_16x16x32_bf16 v[64:67], v[168:171], a[184:187], v[64:67]
  v_mul_f32 v234, v234, v124
  v_mul_f32 v235, v235, v124
  v_mfma_f32_16x16x32_bf16 v[68:71], v[168:171], a[192:195], v[68:71]
  v_cvt_pk_bf16_f32 v232, v232, v232
  v_cvt_pk_bf16_f32 v233, v233, v233
  v_mfma_f32_16x16x32_bf16 v[68:71], v[148:151], a[188:191], v[68:71]
  v_cvt_pk_bf16_f32 v234, v234, v234
  v_cvt_pk_bf16_f32 v235, v235, v235
  v_mfma_f32_16x16x32_bf16 v[72:75], v[148:151], a[196:199], v[72:75]
  buffer_load_dwordx4 a[104:107], v112, s[24:27], s30 offen offset:1024 sc1
  v_mfma_f32_16x16x32_bf16 v[72:75], v[168:171], a[200:203], v[72:75]
  v_lshlrev_b32 v232, 16, v232
  v_lshlrev_b32 v233, 16, v233
  v_mfma_f32_16x16x32_bf16 v[76:79], v[168:171], a[208:211], v[76:79]
  v_lshlrev_b32 v234, 16, v234
  v_lshlrev_b32 v235, 16, v235
  v_mfma_f32_16x16x32_bf16 v[76:79], v[148:151], a[204:207], v[76:79]
  v_add_f32 v98, v98, v232
  v_add_f32 v99, v99, v233
  s_waitcnt vmcnt(6)
  v_mfma_f32_16x16x32_bf16 v[0:3], v[172:175], v[244:247], v[0:3]
  buffer_load_dwordx4 a[108:111], v113, s[24:27], s30 offen offset:0 sc1
  v_mfma_f32_16x16x32_bf16 v[0:3], a[0:3], v[248:251], v[0:3]
  v_add_f32 v100, v100, v234
  v_add_f32 v101, v101, v235
  v_mfma_f32_16x16x32_bf16 v[4:7], a[0:3], v[204:207], v[4:7]
  v_cvt_pk_bf16_f32 v98, v98, v98
  v_cvt_pk_bf16_f32 v99, v99, v99
  v_mfma_f32_16x16x32_bf16 v[4:7], v[172:175], v[252:255], v[4:7]
  v_cvt_pk_bf16_f32 v100, v100, v100
  v_cvt_pk_bf16_f32 v101, v101, v101
  v_mfma_f32_16x16x32_bf16 v[8:11], v[172:175], v[208:211], v[8:11]
  buffer_load_dwordx4 a[112:115], v113, s[24:27], s30 offen offset:1024 sc1
  v_mfma_f32_16x16x32_bf16 v[8:11], a[0:3], v[212:215], v[8:11]
  v_lshlrev_b32 v98, 16, v98
  v_lshlrev_b32 v99, 16, v99
  v_mfma_f32_16x16x32_bf16 v[12:15], a[0:3], v[220:223], v[12:15]
  v_lshlrev_b32 v100, 16, v100
  v_lshlrev_b32 v101, 16, v101
  v_mfma_f32_16x16x32_bf16 v[12:15], v[172:175], v[216:219], v[12:15]
  v_mul_f32 v196, 0xbfb8aa3b, v98
  v_mul_f32 v197, 0xbfb8aa3b, v99
  v_mfma_f32_16x16x32_bf16 v[16:19], v[176:179], v[244:247], v[16:19]
  s_add_u32 s30, s30, 8192
  buffer_load_dwordx4 a[116:119], v110, s[24:27], s30 offen offset:0 sc1
  v_mfma_f32_16x16x32_bf16 v[16:19], a[4:7], v[248:251], v[16:19]
  v_mul_f32 v198, 0xbfb8aa3b, v100
  v_mul_f32 v199, 0xbfb8aa3b, v101
  v_mfma_f32_16x16x32_bf16 v[20:23], a[4:7], v[204:207], v[20:23]
  v_exp_f32 v196, v196
  v_mfma_f32_16x16x32_bf16 v[20:23], v[176:179], v[252:255], v[20:23]
  v_exp_f32 v197, v197
  v_mfma_f32_16x16x32_bf16 v[24:27], v[176:179], v[208:211], v[24:27]
  buffer_load_dwordx4 a[120:123], v110, s[24:27], s30 offen offset:1024 sc1
  v_mfma_f32_16x16x32_bf16 v[24:27], a[4:7], v[212:215], v[24:27]
  v_exp_f32 v198, v198
  v_mfma_f32_16x16x32_bf16 v[28:31], a[4:7], v[220:223], v[28:31]
  v_exp_f32 v199, v199
  v_mfma_f32_16x16x32_bf16 v[28:31], v[176:179], v[216:219], v[28:31]
  v_add_f32 v196, 1.0, v196
  v_add_f32 v197, 1.0, v197
  v_mfma_f32_16x16x32_bf16 v[32:35], v[180:183], v[244:247], v[32:35]
  buffer_load_dwordx4 a[124:127], v111, s[24:27], s30 offen offset:0 sc1
  v_mfma_f32_16x16x32_bf16 v[32:35], a[8:11], v[248:251], v[32:35]
  v_add_f32 v198, 1.0, v198
  v_add_f32 v199, 1.0, v199
  v_mfma_f32_16x16x32_bf16 v[36:39], a[8:11], v[204:207], v[36:39]
  v_rcp_f32 v196, v196
  v_mfma_f32_16x16x32_bf16 v[36:39], v[180:183], v[252:255], v[36:39]
  v_rcp_f32 v197, v197
  v_mfma_f32_16x16x32_bf16 v[40:43], v[180:183], v[208:211], v[40:43]
  buffer_load_dwordx4 a[160:163], v111, s[24:27], s30 offen offset:1024 sc1
  v_mfma_f32_16x16x32_bf16 v[40:43], a[8:11], v[212:215], v[40:43]
  v_rcp_f32 v198, v198
  v_mfma_f32_16x16x32_bf16 v[44:47], a[8:11], v[220:223], v[44:47]
  v_rcp_f32 v199, v199
  v_mfma_f32_16x16x32_bf16 v[44:47], v[180:183], v[216:219], v[44:47]
  v_mul_f32 v98, v98, v196
  v_mul_f32 v99, v99, v197
  v_mfma_f32_16x16x32_bf16 v[48:51], v[184:187], v[244:247], v[48:51]
  buffer_load_dwordx4 a[164:167], v112, s[24:27], s30 offen offset:0 sc1
  v_mfma_f32_16x16x32_bf16 v[48:51], a[12:15], v[248:251], v[48:51]
  v_mul_f32 v100, v100, v198
  v_mul_f32 v101, v101, v199
  v_mfma_f32_16x16x32_bf16 v[52:55], a[12:15], v[204:207], v[52:55]
  v_cvt_pk_bf16_f32 v98, v98, v98
  v_cvt_pk_bf16_f32 v99, v99, v99
  v_mfma_f32_16x16x32_bf16 v[52:55], v[184:187], v[252:255], v[52:55]
  v_cvt_pk_bf16_f32 v100, v100, v100
  v_cvt_pk_bf16_f32 v101, v101, v101
  v_mfma_f32_16x16x32_bf16 v[56:59], v[184:187], v[208:211], v[56:59]
  buffer_load_dwordx4 a[168:171], v112, s[24:27], s30 offen offset:1024 sc1
  v_mfma_f32_16x16x32_bf16 v[56:59], a[12:15], v[212:215], v[56:59]
  v_lshlrev_b32 v98, 16, v98
  v_lshlrev_b32 v99, 16, v99
  v_mfma_f32_16x16x32_bf16 v[60:63], a[12:15], v[220:223], v[60:63]
  v_lshlrev_b32 v100, 16, v100
  v_lshlrev_b32 v101, 16, v101
  v_mfma_f32_16x16x32_bf16 v[60:63], v[184:187], v[216:219], v[60:63]
  v_cvt_pk_bf16_f32 v236, v236, v236
  v_cvt_pk_bf16_f32 v237, v237, v237
  v_mfma_f32_16x16x32_bf16 v[64:67], v[188:191], v[244:247], v[64:67]
  buffer_load_dwordx4 a[172:175], v113, s[24:27], s30 offen offset:0 sc1
  v_mfma_f32_16x16x32_bf16 v[64:67], a[16:19], v[248:251], v[64:67]
  v_cvt_pk_bf16_f32 v238, v238, v238
  v_cvt_pk_bf16_f32 v239, v239, v239
  v_mfma_f32_16x16x32_bf16 v[68:71], a[16:19], v[204:207], v[68:71]
  v_lshlrev_b32 v236, 16, v236
  v_lshlrev_b32 v237, 16, v237
  v_mfma_f32_16x16x32_bf16 v[68:71], v[188:191], v[252:255], v[68:71]
  v_lshlrev_b32 v238, 16, v238
  v_lshlrev_b32 v239, 16, v239
  v_mfma_f32_16x16x32_bf16 v[72:75], v[188:191], v[208:211], v[72:75]
  buffer_load_dwordx4 a[176:179], v113, s[24:27], s30 offen offset:1024 sc1
  v_mfma_f32_16x16x32_bf16 v[72:75], a[16:19], v[212:215], v[72:75]
  v_mul_f32 v236, v236, v124
  v_mul_f32 v237, v237, v124
  v_mfma_f32_16x16x32_bf16 v[76:79], a[16:19], v[220:223], v[76:79]
  v_mul_f32 v238, v238, v124
  v_mul_f32 v239, v239, v124
  v_mfma_f32_16x16x32_bf16 v[76:79], v[188:191], v[216:219], v[76:79]
  v_cvt_pk_bf16_f32 v236, v236, v236
  v_cvt_pk_bf16_f32 v237, v237, v237
  s_waitcnt vmcnt(8)
  v_mfma_f32_16x16x32_bf16 v[0:3], a[20:23], a[84:87], v[0:3]
  s_add_u32 s30, s30, 8192
  buffer_load_dwordx4 a[180:183], v110, s[24:27], s30 offen offset:0 sc1
  v_mfma_f32_16x16x32_bf16 v[0:3], a[40:43], a[88:91], v[0:3]
  v_cvt_pk_bf16_f32 v238, v238, v238
  v_cvt_pk_bf16_f32 v239, v239, v239
  v_mfma_f32_16x16x32_bf16 v[4:7], a[40:43], a[96:99], v[4:7]
  v_lshlrev_b32 v236, 16, v236
  v_lshlrev_b32 v237, 16, v237
  v_mfma_f32_16x16x32_bf16 v[4:7], a[20:23], a[92:95], v[4:7]
  v_lshlrev_b32 v238, 16, v238
  v_lshlrev_b32 v239, 16, v239
  v_mfma_f32_16x16x32_bf16 v[8:11], a[20:23], a[100:103], v[8:11]
  buffer_load_dwordx4 a[184:187], v110, s[24:27], s30 offen offset:1024 sc1
  v_mfma_f32_16x16x32_bf16 v[8:11], a[40:43], a[104:107], v[8:11]
  v_add_f32 v102, v102, v236
  v_add_f32 v103, v103, v237
  v_mfma_f32_16x16x32_bf16 v[12:15], a[40:43], a[112:115], v[12:15]
  v_add_f32 v104, v104, v238
  v_add_f32 v105, v105, v239
  v_mfma_f32_16x16x32_bf16 v[12:15], a[20:23], a[108:111], v[12:15]
  v_cvt_pk_bf16_f32 v102, v102, v102
  v_cvt_pk_bf16_f32 v103, v103, v103
  v_mfma_f32_16x16x32_bf16 v[16:19], a[24:27], a[84:87], v[16:19]
  buffer_load_dwordx4 a[188:191], v111, s[24:27], s30 offen offset:0 sc1
  v_mfma_f32_16x16x32_bf16 v[16:19], a[44:47], a[88:91], v[16:19]
  v_cvt_pk_bf16_f32 v104, v104, v104
  v_cvt_pk_bf16_f32 v105, v105, v105
  v_mfma_f32_16x16x32_bf16 v[20:23], a[44:47], a[96:99], v[20:23]
  v_lshlrev_b32 v102, 16, v102
  v_lshlrev_b32 v103, 16, v103
  v_mfma_f32_16x16x32_bf16 v[20:23], a[24:27], a[92:95], v[20:23]
  v_lshlrev_b32 v104, 16, v104
  v_lshlrev_b32 v105, 16, v105
  v_mfma_f32_16x16x32_bf16 v[24:27], a[24:27], a[100:103], v[24:27]
  buffer_load_dwordx4 a[192:195], v111, s[24:27], s30 offen offset:1024 sc1
  v_mfma_f32_16x16x32_bf16 v[24:27], a[44:47], a[104:107], v[24:27]
  v_mul_f32 v196, 0xbfb8aa3b, v102
  v_mul_f32 v197, 0xbfb8aa3b, v103
  v_mfma_f32_16x16x32_bf16 v[28:31], a[44:47], a[112:115], v[28:31]
  v_mul_f32 v198, 0xbfb8aa3b, v104
  v_mul_f32 v199, 0xbfb8aa3b, v105
  v_mfma_f32_16x16x32_bf16 v[28:31], a[24:27], a[108:111], v[28:31]
  v_exp_f32 v196, v196
  v_mfma_f32_16x16x32_bf16 v[32:35], a[28:31], a[84:87], v[32:35]
  buffer_load_dwordx4 a[196:199], v112, s[24:27], s30 offen offset:0 sc1
  v_mfma_f32_16x16x32_bf16 v[32:35], a[48:51], a[88:91], v[32:35]
  v_exp_f32 v197, v197
  v_mfma_f32_16x16x32_bf16 v[36:39], a[48:51], a[96:99], v[36:39]
  v_exp_f32 v198, v198
  v_mfma_f32_16x16x32_bf16 v[36:39], a[28:31], a[92:95], v[36:39]
  v_exp_f32 v199, v199
  v_mfma_f32_16x16x32_bf16 v[40:43], a[28:31], a[100:103], v[40:43]
  buffer_load_dwordx4 a[200:203], v112, s[24:27], s30 offen offset:1024 sc1
  v_mfma_f32_16x16x32_bf16 v[40:43], a[48:51], a[104:107], v[40:43]
  v_add_f32 v196, 1.0, v196
  v_add_f32 v197, 1.0, v197
  v_mfma_f32_16x16x32_bf16 v[44:47], a[48:51], a[112:115], v[44:47]
  v_add_f32 v198, 1.0, v198
  v_add_f32 v199, 1.0, v199
  v_mfma_f32_16x16x32_bf16 v[44:47], a[28:31], a[108:111], v[44:47]
  v_rcp_f32 v196, v196
  v_mfma_f32_16x16x32_bf16 v[48:51], a[32:35], a[84:87], v[48:51]
  buffer_load_dwordx4 a[204:207], v113, s[24:27], s30 offen offset:0 sc1
  v_mfma_f32_16x16x32_bf16 v[48:51], a[52:55], a[88:91], v[48:51]
  v_rcp_f32 v197, v197
  v_mfma_f32_16x16x32_bf16 v[52:55], a[52:55], a[96:99], v[52:55]
  v_rcp_f32 v198, v198
  v_mfma_f32_16x16x32_bf16 v[52:55], a[32:35], a[92:95], v[52:55]
  v_rcp_f32 v199, v199
  v_mfma_f32_16x16x32_bf16 v[56:59], a[32:35], a[100:103], v[56:59]
  buffer_load_dwordx4 a[208:211], v113, s[24:27], s30 offen offset:1024 sc1
  v_mfma_f32_16x16x32_bf16 v[56:59], a[52:55], a[104:107], v[56:59]
  v_mul_f32 v102, v102, v196
  v_mul_f32 v103, v103, v197
  v_mfma_f32_16x16x32_bf16 v[60:63], a[52:55], a[112:115], v[60:63]
  v_mul_f32 v104, v104, v198
  v_mul_f32 v105, v105, v199
  v_mfma_f32_16x16x32_bf16 v[60:63], a[32:35], a[108:111], v[60:63]
  v_cvt_pk_bf16_f32 v102, v102, v102
  v_cvt_pk_bf16_f32 v103, v103, v103
  v_mfma_f32_16x16x32_bf16 v[64:67], a[36:39], a[84:87], v[64:67]
  ds_read_b128 v[244:247], v122 offset:0
  s_add_u32 s30, s30, 8192
  v_cvt_pk_bf16_f32 v104, v104, v104
  v_mfma_f32_16x16x32_bf16 v[64:67], a[56:59], a[88:91], v[64:67]
  buffer_load_dwordx4 v[248:251], v110, s[24:27], s30 offen offset:0 sc1
  v_mfma_f32_16x16x32_bf16 v[68:71], a[56:59], a[96:99], v[68:71]
  v_cvt_pk_bf16_f32 v105, v105, v105
  v_lshlrev_b32 v102, 16, v102
  v_mfma_f32_16x16x32_bf16 v[68:71], a[36:39], a[92:95], v[68:71]
  v_lshlrev_b32 v103, 16, v103
  v_lshlrev_b32 v104, 16, v104
  v_mfma_f32_16x16x32_bf16 v[72:75], a[36:39], a[100:103], v[72:75]
  buffer_load_dwordx4 v[252:255], v110, s[24:27], s30 offen offset:1024 sc1
  v_mfma_f32_16x16x32_bf16 v[72:75], a[56:59], a[104:107], v[72:75]
  v_lshlrev_b32 v105, 16, v105
  v_cvt_pk_bf16_f32 v240, v240, v240
  v_mfma_f32_16x16x32_bf16 v[76:79], a[56:59], a[112:115], v[76:79]
  v_cvt_pk_bf16_f32 v241, v241, v241
  v_cvt_pk_bf16_f32 v242, v242, v242
  v_mfma_f32_16x16x32_bf16 v[76:79], a[36:39], a[108:111], v[76:79]
  v_cvt_pk_bf16_f32 v243, v243, v243
  v_lshlrev_b32 v240, 16, v240
  s_waitcnt vmcnt(10)
  v_mfma_f32_16x16x32_bf16 v[0:3], a[60:63], a[116:119], v[0:3]
  ds_read_b128 v[204:207], v122 offset:1024
  v_lshlrev_b32 v241, 16, v241
  v_mfma_f32_16x16x32_bf16 v[0:3], a[80:83], a[120:123], v[0:3]
  buffer_load_dwordx4 v[208:211], v111, s[24:27], s30 offen offset:0 sc1
  v_mfma_f32_16x16x32_bf16 v[4:7], a[80:83], a[160:163], v[4:7]
  v_lshlrev_b32 v242, 16, v242
  v_lshlrev_b32 v243, 16, v243
  v_mfma_f32_16x16x32_bf16 v[4:7], a[60:63], a[124:127], v[4:7]
  v_mul_f32 v240, v240, v124
  v_mul_f32 v241, v241, v124
  v_mfma_f32_16x16x32_bf16 v[8:11], a[60:63], a[164:167], v[8:11]
  buffer_load_dwordx4 v[212:215], v111, s[24:27], s30 offen offset:1024 sc1
  v_mfma_f32_16x16x32_bf16 v[8:11], a[80:83], a[168:171], v[8:11]
  v_mul_f32 v242, v242, v124
  v_mul_f32 v243, v243, v124
  v_mfma_f32_16x16x32_bf16 v[12:15], a[80:83], a[176:179], v[12:15]
  v_cvt_pk_bf16_f32 v240, v240, v240
  v_cvt_pk_bf16_f32 v241, v241, v241
  v_mfma_f32_16x16x32_bf16 v[12:15], a[60:63], a[172:175], v[12:15]
  v_cvt_pk_bf16_f32 v242, v242, v242
  v_cvt_pk_bf16_f32 v243, v243, v243
  s_waitcnt lgkmcnt(1)
  v_mfma_f32_16x16x32_bf16 v[16:19], a[64:67], a[116:119], v[16:19]
  ds_read_b128 v[216:219], v122 offset:2048
  v_lshlrev_b32 v240, 16, v240
  v_mfma_f32_16x16x32_bf16 v[16:19], v[244:247], a[120:123], v[16:19]
  buffer_load_dwordx4 v[220:223], v112, s[24:27], s30 offen offset:0 sc1
  v_mfma_f32_16x16x32_bf16 v[20:23], v[244:247], a[160:163], v[20:23]
  v_lshlrev_b32 v241, 16, v241
  v_lshlrev_b32 v242, 16, v242
  v_mfma_f32_16x16x32_bf16 v[20:23], a[64:67], a[124:127], v[20:23]
  v_lshlrev_b32 v243, 16, v243
  v_add_f32 v106, v106, v240
  v_mfma_f32_16x16x32_bf16 v[24:27], a[64:67], a[164:167], v[24:27]
  buffer_load_dwordx4 a[84:87], v112, s[24:27], s30 offen offset:1024 sc1
  v_mfma_f32_16x16x32_bf16 v[24:27], v[244:247], a[168:171], v[24:27]
  v_add_f32 v107, v107, v241
  v_add_f32 v108, v108, v242
  v_mfma_f32_16x16x32_bf16 v[28:31], v[244:247], a[176:179], v[28:31]
  v_add_f32 v109, v109, v243
  v_cvt_pk_bf16_f32 v106, v106, v106
  v_mfma_f32_16x16x32_bf16 v[28:31], a[64:67], a[172:175], v[28:31]
  v_cvt_pk_bf16_f32 v107, v107, v107
  v_cvt_pk_bf16_f32 v108, v108, v108
  s_waitcnt lgkmcnt(1)
  v_mfma_f32_16x16x32_bf16 v[32:35], a[68:71], a[116:119], v[32:35]
  ds_read_b128 a[88:91], v122 offset:3072
  v_cvt_pk_bf16_f32 v109, v109, v109
  v_mfma_f32_16x16x32_bf16 v[32:35], v[204:207], a[120:123], v[32:35]
  buffer_load_dwordx4 a[92:95], v113, s[24:27], s30 offen offset:0 sc1
  v_mfma_f32_16x16x32_bf16 v[36:39], v[204:207], a[160:163], v[36:39]
  v_lshlrev_b32 v106, 16, v106
  v_lshlrev_b32 v107, 16, v107
  v_mfma_f32_16x16x32_bf16 v[36:39], a[68:71], a[124:127], v[36:39]
  v_lshlrev_b32 v108, 16, v108
  v_lshlrev_b32 v109, 16, v109
  v_mfma_f32_16x16x32_bf16 v[40:43], a[68:71], a[164:167], v[40:43]
  buffer_load_dwordx4 a[96:99], v113, s[24:27], s30 offen offset:1024 sc1
  v_mfma_f32_16x16x32_bf16 v[40:43], v[204:207], a[168:171], v[40:43]
  v_mul_f32 v196, 0xbfb8aa3b, v106
  v_mul_f32 v197, 0xbfb8aa3b, v107
  v_mfma_f32_16x16x32_bf16 v[44:47], v[204:207], a[176:179], v[44:47]
  v_mul_f32 v198, 0xbfb8aa3b, v108
  v_mul_f32 v199, 0xbfb8aa3b, v109
  v_mfma_f32_16x16x32_bf16 v[44:47], a[68:71], a[172:175], v[44:47]
  v_exp_f32 v196, v196
  s_waitcnt lgkmcnt(1)
  v_mfma_f32_16x16x32_bf16 v[48:51], a[72:75], a[116:119], v[48:51]
  ds_read_b128 a[100:103], v122 offset:16384
  ds_read_b128 a[104:107], v122 offset:33792
  s_mov_b32 s30, s37
  v_mfma_f32_16x16x32_bf16 v[48:51], v[216:219], a[120:123], v[48:51]
  buffer_load_dwordx4 a[108:111], v110, s[24:27], s30 offen offset:0 sc1
  v_mfma_f32_16x16x32_bf16 v[52:55], v[216:219], a[160:163], v[52:55]
  v_exp_f32 v197, v197
  v_mfma_f32_16x16x32_bf16 v[52:55], a[72:75], a[124:127], v[52:55]
  v_exp_f32 v198, v198
  v_mfma_f32_16x16x32_bf16 v[56:59], a[72:75], a[164:167], v[56:59]
  buffer_load_dwordx4 a[112:115], v110, s[24:27], s30 offen offset:1024 sc1
  v_mfma_f32_16x16x32_bf16 v[56:59], v[216:219], a[168:171], v[56:59]
  v_exp_f32 v199, v199
  v_mfma_f32_16x16x32_bf16 v[60:63], v[216:219], a[176:179], v[60:63]
  v_add_f32 v196, 1.0, v196
  v_add_f32 v197, 1.0, v197
  v_mfma_f32_16x16x32_bf16 v[60:63], a[72:75], a[172:175], v[60:63]
  v_add_f32 v198, 1.0, v198
  v_add_f32 v199, 1.0, v199
  s_waitcnt lgkmcnt(2)
  v_mfma_f32_16x16x32_bf16 v[64:67], a[76:79], a[116:119], v[64:67]
  ds_read_b128 v[244:247], v122 offset:17408
  ds_read_b128 v[204:207], v122 offset:34816
  v_mfma_f32_16x16x32_bf16 v[64:67], a[88:91], a[120:123], v[64:67]
  v_rcp_f32 v196, v196
  v_mfma_f32_16x16x32_bf16 v[68:71], a[88:91], a[160:163], v[68:71]
  v_rcp_f32 v197, v197
  v_mfma_f32_16x16x32_bf16 v[68:71], a[76:79], a[124:127], v[68:71]
  v_rcp_f32 v198, v198
  v_mfma_f32_16x16x32_bf16 v[72:75], a[76:79], a[164:167], v[72:75]
  v_rcp_f32 v199, v199
  v_mfma_f32_16x16x32_bf16 v[72:75], a[88:91], a[168:171], v[72:75]
  v_mul_f32 v106, v106, v196
  v_mul_f32 v107, v107, v197
  v_mfma_f32_16x16x32_bf16 v[76:79], a[88:91], a[176:179], v[76:79]
  v_mul_f32 v108, v108, v198
  v_mul_f32 v109, v109, v199
  v_mfma_f32_16x16x32_bf16 v[76:79], a[76:79], a[172:175], v[76:79]
  v_cvt_pk_bf16_f32 v106, v106, v106
  v_cvt_pk_bf16_f32 v107, v107, v107
  s_waitcnt vmcnt(10) lgkmcnt(2)
  v_mfma_f32_16x16x32_bf16 v[0:3], a[100:103], a[180:183], v[0:3]
  ds_read_b128 v[216:219], v122 offset:18432
  ds_read_b128 a[88:91], v122 offset:35840
  v_mfma_f32_16x16x32_bf16 v[0:3], a[104:107], a[184:187], v[0:3]
  buffer_load_dwordx4 a[116:119], v111, s[24:27], s30 offen offset:0 sc1
  v_mfma_f32_16x16x32_bf16 v[4:7], a[104:107], a[192:195], v[4:7]
  v_cvt_pk_bf16_f32 v108, v108, v108
  v_cvt_pk_bf16_f32 v109, v109, v109
  v_mfma_f32_16x16x32_bf16 v[4:7], a[100:103], a[188:191], v[4:7]
  v_lshlrev_b32 v106, 16, v106
  v_lshlrev_b32 v107, 16, v107
  v_mfma_f32_16x16x32_bf16 v[8:11], a[100:103], a[196:199], v[8:11]
  buffer_load_dwordx4 a[120:123], v111, s[24:27], s30 offen offset:1024 sc1
  v_mfma_f32_16x16x32_bf16 v[8:11], a[104:107], a[200:203], v[8:11]
  v_lshlrev_b32 v108, 16, v108
  v_lshlrev_b32 v109, 16, v109
  v_mfma_f32_16x16x32_bf16 v[12:15], a[104:107], a[208:211], v[12:15]
  v_lshlrev_b32 v224, 16, v80
  v_and_b32 v225, s34, v80
  v_mfma_f32_16x16x32_bf16 v[12:15], a[100:103], a[204:207], v[12:15]
  v_lshlrev_b32 v226, 16, v81
  v_and_b32 v227, s34, v81
  s_waitcnt lgkmcnt(2)
  v_mfma_f32_16x16x32_bf16 v[16:19], v[244:247], a[180:183], v[16:19]
  ds_read_b128 a[124:127], v122 offset:19456
  ds_read_b128 a[160:163], v202 offset:0
  v_mfma_f32_16x16x32_bf16 v[16:19], v[204:207], a[184:187], v[16:19]
  buffer_load_dwordx4 a[164:167], v112, s[24:27], s30 offen offset:0 sc1
  v_mfma_f32_16x16x32_bf16 v[20:23], v[204:207], a[192:195], v[20:23]
  v_lshlrev_b32 v228, 16, v82
  v_and_b32 v229, s34, v82
  v_mfma_f32_16x16x32_bf16 v[20:23], v[244:247], a[188:191], v[20:23]
  v_lshlrev_b32 v230, 16, v83
  v_and_b32 v231, s34, v83
  v_mfma_f32_16x16x32_bf16 v[24:27], v[244:247], a[196:199], v[24:27]
  buffer_load_dwordx4 a[168:171], v112, s[24:27], s30 offen offset:1024 sc1
  v_mfma_f32_16x16x32_bf16 v[24:27], v[204:207], a[200:203], v[24:27]
  v_lshlrev_b32 v232, 16, v84
  v_and_b32 v233, s34, v84
  v_mfma_f32_16x16x32_bf16 v[28:31], v[204:207], a[208:211], v[28:31]
  v_lshlrev_b32 v234, 16, v85
  v_and_b32 v235, s34, v85
  v_mfma_f32_16x16x32_bf16 v[28:31], v[244:247], a[204:207], v[28:31]
  v_lshlrev_b32 v236, 16, v86
  v_and_b32 v237, s34, v86
  s_waitcnt lgkmcnt(2)
  v_mfma_f32_16x16x32_bf16 v[32:35], v[216:219], a[180:183], v[32:35]
  ds_read_b128 a[172:175], v122 offset:32768
  ds_read_b128 a[176:179], v202 offset:1024
  v_mfma_f32_16x16x32_bf16 v[32:35], a[88:91], a[184:187], v[32:35]
  buffer_load_dwordx4 a[100:103], v113, s[24:27], s30 offen offset:0 sc1
  v_mfma_f32_16x16x32_bf16 v[36:39], a[88:91], a[192:195], v[36:39]
  v_lshlrev_b32 v238, 16, v87
  v_and_b32 v239, s34, v87
  v_mfma_f32_16x16x32_bf16 v[36:39], v[216:219], a[188:191], v[36:39]
  v_lshlrev_b32 v240, 16, v88
  v_and_b32 v241, s34, v88
  v_mfma_f32_16x16x32_bf16 v[40:43], v[216:219], a[196:199], v[40:43]
  buffer_load_dwordx4 a[104:107], v113, s[24:27], s30 offen offset:1024 sc1
  v_mfma_f32_16x16x32_bf16 v[40:43], a[88:91], a[200:203], v[40:43]
  v_lshlrev_b32 v242, 16, v89
  v_and_b32 v243, s34, v89
  v_mfma_f32_16x16x32_bf16 v[44:47], a[88:91], a[208:211], v[44:47]
  s_sub_u32 s41, s3, 1
  s_and_b32 s41, s41, 3
  s_lshl_b32 s41, s41, 12
  v_add_u32 v80, s41, v114
  v_mfma_f32_16x16x32_bf16 v[44:47], v[216:219], a[204:207], v[44:47]
  s_sub_u32 s41, s3, 2
  s_and_b32 s41, s41, 3
  s_lshl_b32 s41, s41, 12
  v_add_u32 v81, s41, v114
  s_waitcnt lgkmcnt(2)
  v_mfma_f32_16x16x32_bf16 v[48:51], a[124:127], a[180:183], v[48:51]
  ds_read_b128 v[244:247], v202 offset:2048
  ds_read_b128 v[204:207], v202 offset:19456
  s_add_u32 s30, s30, 8192
  v_mfma_f32_16x16x32_bf16 v[48:51], a[160:163], a[184:187], v[48:51]
  s_sub_u32 s41, s3, 3
  s_and_b32 s41, s41, 3
  s_lshl_b32 s41, s41, 12
  v_add_u32 v82, s41, v114
  v_bfe_u32 v196, v114, 8, 1
  v_mfma_f32_16x16x32_bf16 v[52:55], a[160:163], a[192:195], v[52:55]
  v_mul_u32_u24 v196, 24, v196
  v_add_u32 v83, v117, v196
  v_mfma_f32_16x16x32_bf16 v[52:55], a[124:127], a[188:191], v[52:55]
  v_mfma_f32_16x16x32_bf16 v[56:59], a[124:127], a[196:199], v[56:59]
  v_mfma_f32_16x16x32_bf16 v[56:59], a[160:163], a[200:203], v[56:59]
  v_mfma_f32_16x16x32_bf16 v[60:63], a[160:163], a[208:211], v[60:63]
  v_mfma_f32_16x16x32_bf16 v[60:63], a[124:127], a[204:207], v[60:63]
  s_waitcnt lgkmcnt(2)
  v_mfma_f32_16x16x32_bf16 v[64:67], a[172:175], a[180:183], v[64:67]
  ds_read_b128 v[216:219], v202 offset:3072
  ds_read_b128 a[88:91], v122 offset:49152
  v_mfma_f32_16x16x32_bf16 v[64:67], a[176:179], a[184:187], v[64:67]
  v_mfma_f32_16x16x32_bf16 v[68:71], a[176:179], a[192:195], v[68:71]
  v_mfma_f32_16x16x32_bf16 v[68:71], a[172:175], a[188:191], v[68:71]
  v_mfma_f32_16x16x32_bf16 v[72:75], a[172:175], a[196:199], v[72:75]
  v_mfma_f32_16x16x32_bf16 v[72:75], a[176:179], a[200:203], v[72:75]
  v_mfma_f32_16x16x32_bf16 v[76:79], a[176:179], a[208:211], v[76:79]
  v_mfma_f32_16x16x32_bf16 v[76:79], a[172:175], a[204:207], v[76:79]
  s_waitcnt vmcnt(8) lgkmcnt(2)
  v_mfma_f32_16x16x32_bf16 v[0:3], v[244:247], v[248:251], v[0:3]
  ds_read_b128 a[124:127], v202 offset:16384
  ds_read_b128 a[160:163], v122 offset:50176
  s_xor_b32 s38, s40, 1
  v_mfma_f32_16x16x32_bf16 v[0:3], v[204:207], v[252:255], v[0:3]
  buffer_load_dwordx4 a[172:175], v110, s[24:27], s30 offen offset:0 sc1
  s_lshl_b32 s38, s38, 2
  s_add_u32 s38, s38, s3
  s_lshl_b32 s38, s38, 12
  v_mfma_f32_16x16x32_bf16 v[4:7], v[204:207], v[212:215], v[4:7]
  s_add_u32 s38, s38, 25165824
  v_lshrrev_b32 v192, 1, v114
  v_mfma_f32_16x16x32_bf16 v[4:7], v[244:247], v[208:211], v[4:7]
  v_mfma_f32_16x16x32_bf16 v[8:11], v[244:247], v[220:223], v[8:11]
  buffer_load_dwordx4 a[176:179], v110, s[24:27], s30 offen offset:1024 sc1
  v_mfma_f32_16x16x32_bf16 v[8:11], v[204:207], a[84:87], v[8:11]
  v_mfma_f32_16x16x32_bf16 v[12:15], v[204:207], a[96:99], v[12:15]
  v_mfma_f32_16x16x32_bf16 v[12:15], v[244:247], a[92:95], v[12:15]
  s_waitcnt lgkmcnt(2)
  v_mfma_f32_16x16x32_bf16 v[16:19], v[216:219], v[248:251], v[16:19]
  ds_read_b128 a[180:183], v202 offset:17408
  ds_read_b128 a[184:187], v122 offset:51200
  v_mfma_f32_16x16x32_bf16 v[16:19], a[88:91], v[252:255], v[16:19]
  buffer_load_dwordx4 a[188:191], v111, s[24:27], s30 offen offset:0 sc1
  v_mfma_f32_16x16x32_bf16 v[20:23], a[88:91], v[212:215], v[20:23]
  ds_write_b128 v118, v[4:7] offset:0
  ds_write_b128 v118, v[8:11] offset:5120
  v_mfma_f32_16x16x32_bf16 v[20:23], v[216:219], v[208:211], v[20:23]
  ds_write_b128 v118, v[12:15] offset:10240
  v_mfma_f32_16x16x32_bf16 v[24:27], v[216:219], v[220:223], v[24:27]
  buffer_load_dwordx4 a[192:195], v111, s[24:27], s30 offen offset:1024 sc1
  v_mfma_f32_16x16x32_bf16 v[24:27], a[88:91], a[84:87], v[24:27]
  v_mfma_f32_16x16x32_bf16 v[28:31], a[88:91], a[96:99], v[28:31]
  v_mfma_f32_16x16x32_bf16 v[28:31], v[216:219], a[92:95], v[28:31]
  s_waitcnt lgkmcnt(5)
  v_mfma_f32_16x16x32_bf16 v[32:35], a[124:127], v[248:251], v[32:35]
  ds_read_b128 a[196:199], v202 offset:18432
  ds_read_b128 a[200:203], v122 offset:52224
  v_mfma_f32_16x16x32_bf16 v[32:35], a[160:163], v[252:255], v[32:35]
  buffer_load_dwordx4 a[204:207], v112, s[24:27], s30 offen offset:0 sc1
  v_mfma_f32_16x16x32_bf16 v[36:39], a[160:163], v[212:215], v[36:39]
  ds_write_b128 v118, v[20:23] offset:1024
  ds_write_b128 v118, v[24:27] offset:6144
  v_mfma_f32_16x16x32_bf16 v[36:39], a[124:127], v[208:211], v[36:39]
  ds_write_b128 v118, v[28:31] offset:11264
  v_mfma_f32_16x16x32_bf16 v[40:43], a[124:127], v[220:223], v[40:43]
  buffer_load_dwordx4 a[208:211], v112, s[24:27], s30 offen offset:1024 sc1
  v_mfma_f32_16x16x32_bf16 v[40:43], a[160:163], a[84:87], v[40:43]
  v_mfma_f32_16x16x32_bf16 v[44:47], a[160:163], a[96:99], v[44:47]
  v_mfma_f32_16x16x32_bf16 v[44:47], a[124:127], a[92:95], v[44:47]
  s_waitcnt lgkmcnt(8)
  v_mfma_f32_16x16x32_bf16 v[48:51], a[180:183], v[248:251], v[48:51]
  buffer_load_dwordx4 v[244:247], v113, s[24:27], s30 offen offset:0 sc1
  v_mfma_f32_16x16x32_bf16 v[48:51], a[184:187], v[252:255], v[48:51]
  ds_write_b128 v118, v[36:39] offset:2048
  v_mfma_f32_16x16x32_bf16 v[52:55], a[184:187], v[212:215], v[52:55]
  ds_write_b128 v118, v[40:43] offset:7168
  v_mfma_f32_16x16x32_bf16 v[52:55], a[180:183], v[208:211], v[52:55]
  ds_write_b128 v118, v[44:47] offset:12288
  v_mfma_f32_16x16x32_bf16 v[56:59], a[180:183], v[220:223], v[56:59]
  buffer_load_dwordx4 v[204:207], v113, s[24:27], s30 offen offset:1024 sc1
  v_mfma_f32_16x16x32_bf16 v[56:59], a[184:187], a[84:87], v[56:59]
  v_mfma_f32_16x16x32_bf16 v[60:63], a[184:187], a[96:99], v[60:63]
  v_mfma_f32_16x16x32_bf16 v[60:63], a[180:183], a[92:95], v[60:63]
  s_waitcnt lgkmcnt(6)
  v_mfma_f32_16x16x32_bf16 v[64:67], a[196:199], v[248:251], v[64:67]
  s_add_u32 s30, s30, 8192
  buffer_load_dwordx4 v[216:219], v110, s[24:27], s30 offen offset:0 sc1
  v_mfma_f32_16x16x32_bf16 v[64:67], a[200:203], v[252:255], v[64:67]
  ds_write_b128 v118, v[52:55] offset:3072
  ds_write_b128 v118, v[56:59] offset:8192
  v_mfma_f32_16x16x32_bf16 v[68:71], a[200:203], v[212:215], v[68:71]
  ds_write_b128 v118, v[60:63] offset:13312
  v_mfma_f32_16x16x32_bf16 v[68:71], a[196:199], v[208:211], v[68:71]
  v_mfma_f32_16x16x32_bf16 v[72:75], a[196:199], v[220:223], v[72:75]
  buffer_load_dwordx4 a[88:91], v110, s[24:27], s30 offen offset:1024 sc1
  v_mfma_f32_16x16x32_bf16 v[72:75], a[200:203], a[84:87], v[72:75]
  v_mfma_f32_16x16x32_bf16 v[76:79], a[200:203], a[96:99], v[76:79]
  v_mfma_f32_16x16x32_bf16 v[76:79], a[196:199], a[92:95], v[76:79]
  s_nop 2
  ds_write_b128 v118, v[68:71] offset:4096
  s_nop 1
  ds_write_b128 v118, v[72:75] offset:9216
  s_nop 0
  ds_write_b128 v118, v[76:79] offset:14336
  buffer_load_dwordx4 a[124:127], v111, s[24:27], s30 offen offset:0 sc1
  buffer_load_dwordx4 a[160:163], v111, s[24:27], s30 offen offset:1024 sc1
  buffer_load_dwordx4 a[180:183], v112, s[24:27], s30 offen offset:0 sc1
  buffer_load_dwordx4 a[184:187], v112, s[24:27], s30 offen offset:1024 sc1
  buffer_load_dwordx4 a[196:199], v113, s[24:27], s30 offen offset:0 sc1
  buffer_load_dwordx4 a[200:203], v113, s[24:27], s30 offen offset:1024 sc1
  s_add_u32 s30, s30, 8192
  buffer_load_dwordx4 v[248:251], v110, s[24:27], s30 offen offset:0 sc1
  buffer_load_dwordx4 v[252:255], v110, s[24:27], s30 offen offset:1024 sc1
  buffer_load_dwordx4 v[208:211], v111, s[24:27], s30 offen offset:0 sc1
  buffer_load_dwordx4 v[212:215], v111, s[24:27], s30 offen offset:1024 sc1
  buffer_load_dwordx4 v[220:223], v112, s[24:27], s30 offen offset:0 sc1
  buffer_load_dwordx4 a[84:87], v112, s[24:27], s30 offen offset:1024 sc1
  buffer_load_dwordx4 a[92:95], v113, s[24:27], s30 offen offset:0 sc1
  buffer_load_dwordx4 a[96:99], v113, s[24:27], s30 offen offset:1024 sc1
  s_waitcnt lgkmcnt(0)
  s_barrier
  ds_read_b128 v[4:7], v119 offset:0
  ds_read_b128 v[8:11], v120 offset:5120
  ds_read_b128 v[12:15], v121 offset:10240
  ds_read_b128 v[20:23], v119 offset:1024
  ds_read_b128 v[24:27], v120 offset:6144
  ds_read_b128 v[28:31], v121 offset:11264
  ds_read_b128 v[36:39], v119 offset:2048
  ds_read_b128 v[40:43], v120 offset:7168
  ds_read_b128 v[44:47], v121 offset:12288
  ds_read_b128 v[52:55], v119 offset:3072
  ds_read_b128 v[56:59], v120 offset:8192
  ds_read_b128 v[60:63], v121 offset:13312
  ds_read_b128 v[68:71], v119 offset:4096
  ds_read_b128 v[72:75], v120 offset:9216
  ds_read_b128 v[76:79], v121 offset:14336
  s_waitcnt lgkmcnt(12)
  v_add_f32 v4, v4, v8
  v_add_f32 v5, v5, v9
  v_add_f32 v6, v6, v10
  v_add_f32 v7, v7, v11
  v_add_f32 v0, v0, v12
  v_add_f32 v1, v1, v13
  v_add_f32 v2, v2, v14
  v_add_f32 v3, v3, v15
  v_add_f32 v0, v0, v4
  v_add_f32 v1, v1, v5
  v_add_f32 v2, v2, v6
  v_add_f32 v3, v3, v7
  v_cvt_pk_bf16_f32 v4, v0, v1
  v_cvt_pk_bf16_f32 v5, v2, v3
  buffer_store_dwordx2 v[4:5], v192, s[24:27], s38 offen offset:0 sc1
  s_waitcnt vmcnt(25)
  v_mfma_f32_16x16x32_bf16 v[0:3], a[212:215], a[108:111], 0
  s_add_u32 s30, s30, 8192
  s_waitcnt lgkmcnt(9)
  v_add_f32 v20, v20, v24
  v_add_f32 v21, v21, v25
  v_mfma_f32_16x16x32_bf16 v[0:3], a[232:235], a[112:115], v[0:3]
  v_add_f32 v22, v22, v26
  v_add_f32 v23, v23, v27
  v_mfma_f32_16x16x32_bf16 v[4:7], a[232:235], a[120:123], 0
  v_add_f32 v16, v16, v28
  v_add_f32 v17, v17, v29
  v_mfma_f32_16x16x32_bf16 v[4:7], a[212:215], a[116:119], v[4:7]
  v_add_f32 v18, v18, v30
  v_add_f32 v19, v19, v31
  v_mfma_f32_16x16x32_bf16 v[8:11], a[212:215], a[164:167], 0
  v_add_f32 v16, v16, v20
  v_add_f32 v17, v17, v21
  v_mfma_f32_16x16x32_bf16 v[8:11], a[232:235], a[168:171], v[8:11]
  v_add_f32 v18, v18, v22
  v_add_f32 v19, v19, v23
  v_mfma_f32_16x16x32_bf16 v[12:15], a[232:235], a[104:107], 0
  v_cvt_pk_bf16_f32 v20, v16, v17
  v_cvt_pk_bf16_f32 v21, v18, v19
  v_mfma_f32_16x16x32_bf16 v[12:15], a[212:215], a[100:103], v[12:15]
  buffer_store_dwordx2 v[20:21], v192, s[24:27], s38 offen offset:512 sc1
  s_waitcnt lgkmcnt(6)
  v_mfma_f32_16x16x32_bf16 v[16:19], a[216:219], a[108:111], 0
  buffer_load_dwordx4 a[212:215], v110, s[24:27], s30 offen offset:0 sc1
  v_mfma_f32_16x16x32_bf16 v[16:19], a[236:239], a[112:115], v[16:19]
  v_add_f32 v36, v36, v40
  v_add_f32 v37, v37, v41
  v_mfma_f32_16x16x32_bf16 v[20:23], a[236:239], a[120:123], 0
  v_add_f32 v38, v38, v42
  v_add_f32 v39, v39, v43
  v_mfma_f32_16x16x32_bf16 v[20:23], a[216:219], a[116:119], v[20:23]
  v_add_f32 v32, v32, v44
  v_add_f32 v33, v33, v45
  v_mfma_f32_16x16x32_bf16 v[24:27], a[216:219], a[164:167], 0
  buffer_load_dwordx4 a[232:235], v110, s[24:27], s30 offen offset:1024 sc1
  v_mfma_f32_16x16x32_bf16 v[24:27], a[236:239], a[168:171], v[24:27]
  v_add_f32 v34, v34, v46
  v_add_f32 v35, v35, v47
  v_mfma_f32_16x16x32_bf16 v[28:31], a[236:239], a[104:107], 0
  v_add_f32 v32, v32, v36
  v_add_f32 v33, v33, v37
  v_mfma_f32_16x16x32_bf16 v[28:31], a[216:219], a[100:103], v[28:31]
  v_add_f32 v34, v34, v38
  v_add_f32 v35, v35, v39
  v_cvt_pk_bf16_f32 v36, v32, v33
  v_cvt_pk_bf16_f32 v37, v34, v35
  buffer_store_dwordx2 v[36:37], v192, s[24:27], s38 offen offset:1024 sc1
  v_mfma_f32_16x16x32_bf16 v[32:35], a[220:223], a[108:111], 0
  buffer_load_dwordx4 a[216:219], v111, s[24:27], s30 offen offset:0 sc1
  s_waitcnt lgkmcnt(3)
  v_mfma_f32_16x16x32_bf16 v[32:35], a[240:243], a[112:115], v[32:35]
  v_add_f32 v52, v52, v56
  v_add_f32 v53, v53, v57
  v_mfma_f32_16x16x32_bf16 v[36:39], a[240:243], a[120:123], 0
  v_add_f32 v54, v54, v58
  v_add_f32 v55, v55, v59
  v_mfma_f32_16x16x32_bf16 v[36:39], a[220:223], a[116:119], v[36:39]
  v_add_f32 v48, v48, v60
  v_add_f32 v49, v49, v61
  v_mfma_f32_16x16x32_bf16 v[40:43], a[220:223], a[164:167], 0
  buffer_load_dwordx4 a[236:239], v111, s[24:27], s30 offen offset:1024 sc1
  v_mfma_f32_16x16x32_bf16 v[40:43], a[240:243], a[168:171], v[40:43]
  v_add_f32 v50, v50, v62
  v_add_f32 v51, v51, v63
  v_mfma_f32_16x16x32_bf16 v[44:47], a[240:243], a[104:107], 0
  v_add_f32 v48, v48, v52
  v_add_f32 v49, v49, v53
  v_mfma_f32_16x16x32_bf16 v[44:47], a[220:223], a[100:103], v[44:47]
  v_add_f32 v50, v50, v54
  v_add_f32 v51, v51, v55
  v_cvt_pk_bf16_f32 v52, v48, v49
  v_cvt_pk_bf16_f32 v53, v50, v51
  buffer_store_dwordx2 v[52:53], v192, s[24:27], s38 offen offset:1536 sc1
  v_mfma_f32_16x16x32_bf16 v[48:51], a[224:227], a[108:111], 0
  buffer_load_dwordx4 a[220:223], v112, s[24:27], s30 offen offset:0 sc1
  s_waitcnt lgkmcnt(0)
  v_mfma_f32_16x16x32_bf16 v[48:51], a[244:247], a[112:115], v[48:51]
  v_add_f32 v68, v68, v72
  v_add_f32 v69, v69, v73
  v_mfma_f32_16x16x32_bf16 v[52:55], a[244:247], a[120:123], 0
  v_add_f32 v70, v70, v74
  v_add_f32 v71, v71, v75
  v_mfma_f32_16x16x32_bf16 v[52:55], a[224:227], a[116:119], v[52:55]
  v_add_f32 v64, v64, v76
  v_add_f32 v65, v65, v77
  v_mfma_f32_16x16x32_bf16 v[56:59], a[224:227], a[164:167], 0
  buffer_load_dwordx4 a[240:243], v112, s[24:27], s30 offen offset:1024 sc1
  v_mfma_f32_16x16x32_bf16 v[56:59], a[244:247], a[168:171], v[56:59]
  v_add_f32 v66, v66, v78
  v_add_f32 v67, v67, v79
  v_mfma_f32_16x16x32_bf16 v[60:63], a[244:247], a[104:107], 0
  v_add_f32 v64, v64, v68
  v_add_f32 v65, v65, v69
  v_mfma_f32_16x16x32_bf16 v[60:63], a[224:227], a[100:103], v[60:63]
  v_add_f32 v66, v66, v70
  v_add_f32 v67, v67, v71
  v_cvt_pk_bf16_f32 v68, v64, v65
  v_cvt_pk_bf16_f32 v69, v66, v67
  buffer_store_dwordx2 v[68:69], v192, s[24:27], s38 offen offset:2048 sc1
  v_mfma_f32_16x16x32_bf16 v[64:67], a[228:231], a[108:111], 0
  buffer_load_dwordx4 a[224:227], v113, s[24:27], s30 offen offset:0 sc1
  s_xor_b32 s38, s40, 1
  s_lshl_b32 s38, s38, 7
  s_add_u32 s38, s38, 2834432
  v_mfma_f32_16x16x32_bf16 v[64:67], a[248:251], a[112:115], v[64:67]
  v_mov_b32 v193, 1073741824
  v_writelane_b32 v193, s38, 0
  v_mfma_f32_16x16x32_bf16 v[68:71], a[248:251], a[120:123], 0
  v_mov_b32 v194, 1
  v_mfma_f32_16x16x32_bf16 v[68:71], a[228:231], a[116:119], v[68:71]
  s_xor_b32 s38, s38, 128
  v_mov_b32 v200, s38
  v_mov_b32 v201, 4
  v_mfma_f32_16x16x32_bf16 v[72:75], a[228:231], a[164:167], 0
  buffer_load_dwordx4 a[244:247], v113, s[24:27], s30 offen offset:1024 sc1
  v_mfma_f32_16x16x32_bf16 v[72:75], a[248:251], a[168:171], v[72:75]
  v_mfma_f32_16x16x32_bf16 v[76:79], a[248:251], a[104:107], 0
  v_mfma_f32_16x16x32_bf16 v[76:79], a[228:231], a[100:103], v[76:79]
  s_waitcnt vmcnt(29)
  v_mfma_f32_16x16x32_bf16 v[0:3], a[252:255], a[172:175], v[0:3]
  s_add_u32 s30, s30, 8192
  buffer_load_dwordx4 a[228:231], v110, s[24:27], s30 offen offset:0 sc1
  v_mfma_f32_16x16x32_bf16 v[0:3], a[144:147], a[176:179], v[0:3]
  v_mfma_f32_16x16x32_bf16 v[4:7], a[144:147], a[192:195], v[4:7]
  v_mfma_f32_16x16x32_bf16 v[4:7], a[252:255], a[188:191], v[4:7]
  v_mfma_f32_16x16x32_bf16 v[8:11], a[252:255], a[204:207], v[8:11]
  buffer_load_dwordx4 a[248:251], v110, s[24:27], s30 offen offset:1024 sc1
  v_mfma_f32_16x16x32_bf16 v[8:11], a[144:147], a[208:211], v[8:11]
  v_mfma_f32_16x16x32_bf16 v[12:15], a[144:147], v[204:207], v[12:15]
  v_mfma_f32_16x16x32_bf16 v[12:15], a[252:255], v[244:247], v[12:15]
  v_mfma_f32_16x16x32_bf16 v[16:19], a[128:131], a[172:175], v[16:19]
  buffer_load_dwordx4 a[108:111], v111, s[24:27], s30 offen offset:0 sc1
  v_mfma_f32_16x16x32_bf16 v[16:19], a[148:151], a[176:179], v[16:19]
  v_mfma_f32_16x16x32_bf16 v[20:23], a[148:151], a[192:195], v[20:23]
  v_mfma_f32_16x16x32_bf16 v[20:23], a[128:131], a[188:191], v[20:23]
  v_mfma_f32_16x16x32_bf16 v[24:27], a[128:131], a[204:207], v[24:27]
  buffer_load_dwordx4 a[112:115], v111, s[24:27], s30 offen offset:1024 sc1
  v_mfma_f32_16x16x32_bf16 v[24:27], a[148:151], a[208:211], v[24:27]
  v_mfma_f32_16x16x32_bf16 v[28:31], a[148:151], v[204:207], v[28:31]
  v_mfma_f32_16x16x32_bf16 v[28:31], a[128:131], v[244:247], v[28:31]
  v_mfma_f32_16x16x32_bf16 v[32:35], a[132:135], a[172:175], v[32:35]
  buffer_load_dwordx4 a[116:119], v112, s[24:27], s30 offen offset:0 sc1
  v_mfma_f32_16x16x32_bf16 v[32:35], a[152:155], a[176:179], v[32:35]
  v_mfma_f32_16x16x32_bf16 v[36:39], a[152:155], a[192:195], v[36:39]
  v_mfma_f32_16x16x32_bf16 v[36:39], a[132:135], a[188:191], v[36:39]
  v_mfma_f32_16x16x32_bf16 v[40:43], a[132:135], a[204:207], v[40:43]
  buffer_load_dwordx4 a[120:123], v112, s[24:27], s30 offen offset:1024 sc1
  v_mfma_f32_16x16x32_bf16 v[40:43], a[152:155], a[208:211], v[40:43]
  v_mfma_f32_16x16x32_bf16 v[44:47], a[152:155], v[204:207], v[44:47]
  v_mfma_f32_16x16x32_bf16 v[44:47], a[132:135], v[244:247], v[44:47]
  v_mfma_f32_16x16x32_bf16 v[48:51], a[136:139], a[172:175], v[48:51]
  buffer_load_dwordx4 a[164:167], v113, s[24:27], s30 offen offset:0 sc1
  v_mfma_f32_16x16x32_bf16 v[48:51], a[156:159], a[176:179], v[48:51]
  v_mfma_f32_16x16x32_bf16 v[52:55], a[156:159], a[192:195], v[52:55]
  v_mfma_f32_16x16x32_bf16 v[52:55], a[136:139], a[188:191], v[52:55]
  v_mfma_f32_16x16x32_bf16 v[56:59], a[136:139], a[204:207], v[56:59]
  buffer_load_dwordx4 a[168:171], v113, s[24:27], s30 offen offset:1024 sc1
  v_mfma_f32_16x16x32_bf16 v[56:59], a[156:159], a[208:211], v[56:59]
  v_mfma_f32_16x16x32_bf16 v[60:63], a[156:159], v[204:207], v[60:63]
  v_mfma_f32_16x16x32_bf16 v[60:63], a[136:139], v[244:247], v[60:63]
  v_mfma_f32_16x16x32_bf16 v[64:67], a[140:143], a[172:175], v[64:67]
  s_add_u32 s30, s30, 8192
  buffer_load_dwordx4 a[100:103], v110, s[24:27], s30 offen offset:0 sc1
  v_mfma_f32_16x16x32_bf16 v[64:67], v[128:131], a[176:179], v[64:67]
  v_mfma_f32_16x16x32_bf16 v[68:71], v[128:131], a[192:195], v[68:71]
  v_mfma_f32_16x16x32_bf16 v[68:71], a[140:143], a[188:191], v[68:71]
  v_mfma_f32_16x16x32_bf16 v[72:75], a[140:143], a[204:207], v[72:75]
  buffer_load_dwordx4 a[104:107], v110, s[24:27], s30 offen offset:1024 sc1
  v_mfma_f32_16x16x32_bf16 v[72:75], v[128:131], a[208:211], v[72:75]
  v_mfma_f32_16x16x32_bf16 v[76:79], v[128:131], v[204:207], v[76:79]
  v_mfma_f32_16x16x32_bf16 v[76:79], a[140:143], v[244:247], v[76:79]
  s_waitcnt vmcnt(31)
  v_mfma_f32_16x16x32_bf16 v[0:3], v[132:135], v[216:219], v[0:3]
  buffer_load_dwordx4 a[252:255], v111, s[24:27], s30 offen offset:0 sc1
  v_mfma_f32_16x16x32_bf16 v[0:3], v[152:155], a[88:91], v[0:3]
  v_mfma_f32_16x16x32_bf16 v[4:7], v[152:155], a[160:163], v[4:7]
  v_mfma_f32_16x16x32_bf16 v[4:7], v[132:135], a[124:127], v[4:7]
  v_mfma_f32_16x16x32_bf16 v[8:11], v[132:135], a[180:183], v[8:11]
  buffer_load_dwordx4 a[144:147], v111, s[24:27], s30 offen offset:1024 sc1
  v_mfma_f32_16x16x32_bf16 v[8:11], v[152:155], a[184:187], v[8:11]
  v_mfma_f32_16x16x32_bf16 v[12:15], v[152:155], a[200:203], v[12:15]
  v_mfma_f32_16x16x32_bf16 v[12:15], v[132:135], a[196:199], v[12:15]
  v_mfma_f32_16x16x32_bf16 v[16:19], v[136:139], v[216:219], v[16:19]
  buffer_load_dwordx4 a[128:131], v112, s[24:27], s30 offen offset:0 sc1
  v_mfma_f32_16x16x32_bf16 v[16:19], v[156:159], a[88:91], v[16:19]
  v_mfma_f32_16x16x32_bf16 v[20:23], v[156:159], a[160:163], v[20:23]
  v_mfma_f32_16x16x32_bf16 v[20:23], v[136:139], a[124:127], v[20:23]
  v_mfma_f32_16x16x32_bf16 v[24:27], v[136:139], a[180:183], v[24:27]
  buffer_load_dwordx4 a[148:151], v112, s[24:27], s30 offen offset:1024 sc1
  v_mfma_f32_16x16x32_bf16 v[24:27], v[156:159], a[184:187], v[24:27]
  v_mfma_f32_16x16x32_bf16 v[28:31], v[156:159], a[200:203], v[28:31]
  v_mfma_f32_16x16x32_bf16 v[28:31], v[136:139], a[196:199], v[28:31]
  v_mfma_f32_16x16x32_bf16 v[32:35], v[140:143], v[216:219], v[32:35]
  buffer_load_dwordx4 a[132:135], v113, s[24:27], s30 offen offset:0 sc1
  v_mfma_f32_16x16x32_bf16 v[32:35], v[160:163], a[88:91], v[32:35]
  v_mfma_f32_16x16x32_bf16 v[36:39], v[160:163], a[160:163], v[36:39]
  v_mfma_f32_16x16x32_bf16 v[36:39], v[140:143], a[124:127], v[36:39]
  v_mfma_f32_16x16x32_bf16 v[40:43], v[140:143], a[180:183], v[40:43]
  buffer_load_dwordx4 a[152:155], v113, s[24:27], s30 offen offset:1024 sc1
  v_mfma_f32_16x16x32_bf16 v[40:43], v[160:163], a[184:187], v[40:43]
  v_mfma_f32_16x16x32_bf16 v[44:47], v[160:163], a[200:203], v[44:47]
  v_mfma_f32_16x16x32_bf16 v[44:47], v[140:143], a[196:199], v[44:47]
  v_mfma_f32_16x16x32_bf16 v[48:51], v[144:147], v[216:219], v[48:51]
  s_add_u32 s30, s30, 8192
  buffer_load_dwordx4 a[136:139], v110, s[24:27], s30 offen offset:0 sc1
  v_mfma_f32_16x16x32_bf16 v[48:51], v[164:167], a[88:91], v[48:51]
  v_mfma_f32_16x16x32_bf16 v[52:55], v[164:167], a[160:163], v[52:55]
  v_mfma_f32_16x16x32_bf16 v[52:55], v[144:147], a[124:127], v[52:55]
  v_mfma_f32_16x16x32_bf16 v[56:59], v[144:147], a[180:183], v[56:59]
  buffer_load_dwordx4 a[156:159], v110, s[24:27], s30 offen offset:1024 sc1
  v_mfma_f32_16x16x32_bf16 v[56:59], v[164:167], a[184:187], v[56:59]
  v_mfma_f32_16x16x32_bf16 v[60:63], v[164:167], a[200:203], v[60:63]
  v_mfma_f32_16x16x32_bf16 v[60:63], v[144:147], a[196:199], v[60:63]
  v_mfma_f32_16x16x32_bf16 v[64:67], v[148:151], v[216:219], v[64:67]
  buffer_load_dwordx4 a[140:143], v111, s[24:27], s30 offen offset:0 sc1
  v_mfma_f32_16x16x32_bf16 v[64:67], v[168:171], a[88:91], v[64:67]
  v_mfma_f32_16x16x32_bf16 v[68:71], v[168:171], a[160:163], v[68:71]
  v_mfma_f32_16x16x32_bf16 v[68:71], v[148:151], a[124:127], v[68:71]
  v_mfma_f32_16x16x32_bf16 v[72:75], v[148:151], a[180:183], v[72:75]
  buffer_load_dwordx4 v[128:131], v111, s[24:27], s30 offen offset:1024 sc1
  v_mfma_f32_16x16x32_bf16 v[72:75], v[168:171], a[184:187], v[72:75]
  v_mfma_f32_16x16x32_bf16 v[76:79], v[168:171], a[200:203], v[76:79]
  v_mfma_f32_16x16x32_bf16 v[76:79], v[148:151], a[196:199], v[76:79]
  s_waitcnt vmcnt(33)
  v_mfma_f32_16x16x32_bf16 v[0:3], v[172:175], v[248:251], v[0:3]
  buffer_load_dwordx4 a[172:175], v112, s[24:27], s30 offen offset:0 sc1
  s_waitcnt vmcnt(23)
  v_mfma_f32_16x16x32_bf16 v[0:3], a[0:3], v[252:255], v[0:3]
  buffer_atomic_add v194, v193, s[24:27], 0 offen
  v_mfma_f32_16x16x32_bf16 v[4:7], a[0:3], v[212:215], v[4:7]
  v_mfma_f32_16x16x32_bf16 v[4:7], v[172:175], v[208:211], v[4:7]
  v_mfma_f32_16x16x32_bf16 v[8:11], v[172:175], v[220:223], v[8:11]
  buffer_load_dwordx4 a[176:179], v112, s[24:27], s30 offen offset:1024 sc1
  v_mfma_f32_16x16x32_bf16 v[8:11], a[0:3], a[84:87], v[8:11]
  v_mfma_f32_16x16x32_bf16 v[12:15], a[0:3], a[96:99], v[12:15]
  v_mfma_f32_16x16x32_bf16 v[12:15], v[172:175], a[92:95], v[12:15]
  v_mfma_f32_16x16x32_bf16 v[16:19], v[176:179], v[248:251], v[16:19]
  buffer_load_dwordx4 a[188:191], v113, s[24:27], s30 offen offset:0 sc1
  v_mfma_f32_16x16x32_bf16 v[16:19], a[4:7], v[252:255], v[16:19]
  v_mfma_f32_16x16x32_bf16 v[20:23], a[4:7], v[212:215], v[20:23]
  v_mfma_f32_16x16x32_bf16 v[20:23], v[176:179], v[208:211], v[20:23]
  v_mfma_f32_16x16x32_bf16 v[24:27], v[176:179], v[220:223], v[24:27]
  buffer_load_dwordx4 a[192:195], v113, s[24:27], s30 offen offset:1024 sc1
  v_mfma_f32_16x16x32_bf16 v[24:27], a[4:7], a[84:87], v[24:27]
  v_mfma_f32_16x16x32_bf16 v[28:31], a[4:7], a[96:99], v[28:31]
  v_mfma_f32_16x16x32_bf16 v[28:31], v[176:179], a[92:95], v[28:31]
  v_mfma_f32_16x16x32_bf16 v[32:35], v[180:183], v[248:251], v[32:35]
  s_add_u32 s30, s30, 8192
  v_mfma_f32_16x16x32_bf16 v[32:35], a[8:11], v[252:255], v[32:35]
  v_mfma_f32_16x16x32_bf16 v[36:39], a[8:11], v[212:215], v[36:39]
  v_mfma_f32_16x16x32_bf16 v[36:39], v[180:183], v[208:211], v[36:39]
  v_mfma_f32_16x16x32_bf16 v[40:43], v[180:183], v[220:223], v[40:43]
  v_mfma_f32_16x16x32_bf16 v[40:43], a[8:11], a[84:87], v[40:43]
  v_mfma_f32_16x16x32_bf16 v[44:47], a[8:11], a[96:99], v[44:47]
  v_mfma_f32_16x16x32_bf16 v[44:47], v[180:183], a[92:95], v[44:47]
  v_mfma_f32_16x16x32_bf16 v[48:51], v[184:187], v[248:251], v[48:51]
  v_mfma_f32_16x16x32_bf16 v[48:51], a[12:15], v[252:255], v[48:51]
  v_mfma_f32_16x16x32_bf16 v[52:55], a[12:15], v[212:215], v[52:55]
  v_mfma_f32_16x16x32_bf16 v[52:55], v[184:187], v[208:211], v[52:55]
  v_mfma_f32_16x16x32_bf16 v[56:59], v[184:187], v[220:223], v[56:59]
  v_mfma_f32_16x16x32_bf16 v[56:59], a[12:15], a[84:87], v[56:59]
  v_mfma_f32_16x16x32_bf16 v[60:63], a[12:15], a[96:99], v[60:63]
  v_mfma_f32_16x16x32_bf16 v[60:63], v[184:187], a[92:95], v[60:63]
  v_mfma_f32_16x16x32_bf16 v[64:67], v[188:191], v[248:251], v[64:67]
  v_mfma_f32_16x16x32_bf16 v[64:67], a[16:19], v[252:255], v[64:67]
  v_mfma_f32_16x16x32_bf16 v[68:71], a[16:19], v[212:215], v[68:71]
  v_mfma_f32_16x16x32_bf16 v[68:71], v[188:191], v[208:211], v[68:71]
  v_mfma_f32_16x16x32_bf16 v[72:75], v[188:191], v[220:223], v[72:75]
  v_mfma_f32_16x16x32_bf16 v[72:75], a[16:19], a[84:87], v[72:75]
  v_mfma_f32_16x16x32_bf16 v[76:79], a[16:19], a[96:99], v[76:79]
  v_mfma_f32_16x16x32_bf16 v[76:79], v[188:191], a[92:95], v[76:79]
  s_waitcnt vmcnt(25)
  v_mfma_f32_16x16x32_bf16 v[0:3], a[20:23], a[212:215], v[0:3]
  v_mfma_f32_16x16x32_bf16 v[0:3], a[40:43], a[232:235], v[0:3]
  v_mfma_f32_16x16x32_bf16 v[4:7], a[40:43], a[236:239], v[4:7]
  v_mfma_f32_16x16x32_bf16 v[4:7], a[20:23], a[216:219], v[4:7]
  v_mfma_f32_16x16x32_bf16 v[8:11], a[20:23], a[220:223], v[8:11]
  v_mfma_f32_16x16x32_bf16 v[8:11], a[40:43], a[240:243], v[8:11]
  v_mfma_f32_16x16x32_bf16 v[12:15], a[40:43], a[244:247], v[12:15]
  v_mfma_f32_16x16x32_bf16 v[12:15], a[20:23], a[224:227], v[12:15]
  v_mfma_f32_16x16x32_bf16 v[16:19], a[24:27], a[212:215], v[16:19]
  v_mfma_f32_16x16x32_bf16 v[16:19], a[44:47], a[232:235], v[16:19]
  v_mfma_f32_16x16x32_bf16 v[20:23], a[44:47], a[236:239], v[20:23]
  v_mfma_f32_16x16x32_bf16 v[20:23], a[24:27], a[216:219], v[20:23]
  v_mfma_f32_16x16x32_bf16 v[24:27], a[24:27], a[220:223], v[24:27]
  v_mfma_f32_16x16x32_bf16 v[24:27], a[44:47], a[240:243], v[24:27]
  v_mfma_f32_16x16x32_bf16 v[28:31], a[44:47], a[244:247], v[28:31]
  v_mfma_f32_16x16x32_bf16 v[28:31], a[24:27], a[224:227], v[28:31]
  v_mfma_f32_16x16x32_bf16 v[32:35], a[28:31], a[212:215], v[32:35]
  v_mfma_f32_16x16x32_bf16 v[32:35], a[48:51], a[232:235], v[32:35]
  v_mfma_f32_16x16x32_bf16 v[36:39], a[48:51], a[236:239], v[36:39]
  v_mfma_f32_16x16x32_bf16 v[36:39], a[28:31], a[216:219], v[36:39]
  v_mfma_f32_16x16x32_bf16 v[40:43], a[28:31], a[220:223], v[40:43]
  v_mfma_f32_16x16x32_bf16 v[40:43], a[48:51], a[240:243], v[40:43]
  v_mfma_f32_16x16x32_bf16 v[44:47], a[48:51], a[244:247], v[44:47]
  v_mfma_f32_16x16x32_bf16 v[44:47], a[28:31], a[224:227], v[44:47]
  v_mfma_f32_16x16x32_bf16 v[48:51], a[32:35], a[212:215], v[48:51]
  v_mfma_f32_16x16x32_bf16 v[48:51], a[52:55], a[232:235], v[48:51]
  v_mfma_f32_16x16x32_bf16 v[52:55], a[52:55], a[236:239], v[52:55]
  v_mfma_f32_16x16x32_bf16 v[52:55], a[32:35], a[216:219], v[52:55]
  v_mfma_f32_16x16x32_bf16 v[56:59], a[32:35], a[220:223], v[56:59]
  v_mfma_f32_16x16x32_bf16 v[56:59], a[52:55], a[240:243], v[56:59]
  v_mfma_f32_16x16x32_bf16 v[60:63], a[52:55], a[244:247], v[60:63]
  v_mfma_f32_16x16x32_bf16 v[60:63], a[32:35], a[224:227], v[60:63]
  v_mfma_f32_16x16x32_bf16 v[64:67], a[36:39], a[212:215], v[64:67]
  ds_read_b128 a[204:207], v122 offset:0
  v_mfma_f32_16x16x32_bf16 v[64:67], a[56:59], a[232:235], v[64:67]
  v_mfma_f32_16x16x32_bf16 v[68:71], a[56:59], a[236:239], v[68:71]
  v_mfma_f32_16x16x32_bf16 v[68:71], a[36:39], a[216:219], v[68:71]
  v_mfma_f32_16x16x32_bf16 v[72:75], a[36:39], a[220:223], v[72:75]
  v_mfma_f32_16x16x32_bf16 v[72:75], a[56:59], a[240:243], v[72:75]
  v_mfma_f32_16x16x32_bf16 v[76:79], a[56:59], a[244:247], v[76:79]
  v_mfma_f32_16x16x32_bf16 v[76:79], a[36:39], a[224:227], v[76:79]
  s_waitcnt vmcnt(17)
  v_mfma_f32_16x16x32_bf16 v[0:3], a[60:63], a[228:231], v[0:3]
  ds_read_b128 a[208:211], v122 offset:1024
  buffer_load_dword v195, v200, s[24:27], 0 offen sc1
  s_xor_b32 s38, s40, 0
  s_lshl_b32 s38, s38, 2
  s_add_u32 s38, s38, s3
  v_mfma_f32_16x16x32_bf16 v[0:3], a[80:83], a[248:251], v[0:3]
  s_lshl_b32 s38, s38, 12
  s_add_u32 s38, s38, 25165824
  v_mfma_f32_16x16x32_bf16 v[4:7], a[80:83], a[112:115], v[4:7]
  v_mfma_f32_16x16x32_bf16 v[4:7], a[60:63], a[108:111], v[4:7]
  v_mfma_f32_16x16x32_bf16 v[8:11], a[60:63], a[116:119], v[8:11]
  v_mfma_f32_16x16x32_bf16 v[8:11], a[80:83], a[120:123], v[8:11]
  v_mfma_f32_16x16x32_bf16 v[12:15], a[80:83], a[168:171], v[12:15]
  v_mfma_f32_16x16x32_bf16 v[12:15], a[60:63], a[164:167], v[12:15]
  s_waitcnt lgkmcnt(1)
  v_mfma_f32_16x16x32_bf16 v[16:19], a[64:67], a[228:231], v[16:19]
  ds_read_b128 v[244:247], v122 offset:2048
  v_mfma_f32_16x16x32_bf16 v[16:19], a[204:207], a[248:251], v[16:19]
  v_mfma_f32_16x16x32_bf16 v[20:23], a[204:207], a[112:115], v[20:23]
  v_mfma_f32_16x16x32_bf16 v[20:23], a[64:67], a[108:111], v[20:23]
  v_mfma_f32_16x16x32_bf16 v[24:27], a[64:67], a[116:119], v[24:27]
  v_mfma_f32_16x16x32_bf16 v[24:27], a[204:207], a[120:123], v[24:27]
  v_mfma_f32_16x16x32_bf16 v[28:31], a[204:207], a[168:171], v[28:31]
  v_mfma_f32_16x16x32_bf16 v[28:31], a[64:67], a[164:167], v[28:31]
  s_waitcnt lgkmcnt(1)
  v_mfma_f32_16x16x32_bf16 v[32:35], a[68:71], a[228:231], v[32:35]
  ds_read_b128 v[132:135], v122 offset:3072
  v_mfma_f32_16x16x32_bf16 v[32:35], a[208:211], a[248:251], v[32:35]
  v_mfma_f32_16x16x32_bf16 v[36:39], a[208:211], a[112:115], v[36:39]
  v_mfma_f32_16x16x32_bf16 v[36:39], a[68:71], a[108:111], v[36:39]
  v_mfma_f32_16x16x32_bf16 v[40:43], a[68:71], a[116:119], v[40:43]
  v_mfma_f32_16x16x32_bf16 v[40:43], a[208:211], a[120:123], v[40:43]
  v_mfma_f32_16x16x32_bf16 v[44:47], a[208:211], a[168:171], v[44:47]
  v_mfma_f32_16x16x32_bf16 v[44:47], a[68:71], a[164:167], v[44:47]
  s_waitcnt lgkmcnt(1)
  v_mfma_f32_16x16x32_bf16 v[48:51], a[72:75], a[228:231], v[48:51]
  ds_read_b128 v[152:155], v122 offset:16384
  ds_read_b128 v[136:139], v122 offset:33792
  v_mfma_f32_16x16x32_bf16 v[48:51], v[244:247], a[248:251], v[48:51]
  v_mfma_f32_16x16x32_bf16 v[52:55], v[244:247], a[112:115], v[52:55]
  v_mfma_f32_16x16x32_bf16 v[52:55], a[72:75], a[108:111], v[52:55]
  v_mfma_f32_16x16x32_bf16 v[56:59], a[72:75], a[116:119], v[56:59]
  v_mfma_f32_16x16x32_bf16 v[56:59], v[244:247], a[120:123], v[56:59]
  v_mfma_f32_16x16x32_bf16 v[60:63], v[244:247], a[168:171], v[60:63]
  v_mfma_f32_16x16x32_bf16 v[60:63], a[72:75], a[164:167], v[60:63]
  s_waitcnt lgkmcnt(2)
  v_mfma_f32_16x16x32_bf16 v[64:67], a[76:79], a[228:231], v[64:67]
  ds_read_b128 v[156:159], v122 offset:17408
  ds_read_b128 v[140:143], v122 offset:34816
  v_mfma_f32_16x16x32_bf16 v[64:67], v[132:135], a[248:251], v[64:67]
  v_mfma_f32_16x16x32_bf16 v[68:71], v[132:135], a[112:115], v[68:71]
  v_mfma_f32_16x16x32_bf16 v[68:71], a[76:79], a[108:111], v[68:71]
  v_mfma_f32_16x16x32_bf16 v[72:75], a[76:79], a[116:119], v[72:75]
  v_mfma_f32_16x16x32_bf16 v[72:75], v[132:135], a[120:123], v[72:75]
  v_mfma_f32_16x16x32_bf16 v[76:79], v[132:135], a[168:171], v[76:79]
  v_mfma_f32_16x16x32_bf16 v[76:79], a[76:79], a[164:167], v[76:79]
  s_waitcnt vmcnt(10) lgkmcnt(2)
  v_mfma_f32_16x16x32_bf16 v[0:3], v[152:155], a[100:103], v[0:3]
  ds_read_b128 v[160:163], v122 offset:18432
  ds_read_b128 v[144:147], v122 offset:35840
  v_mfma_f32_16x16x32_bf16 v[0:3], v[136:139], a[104:107], v[0:3]
  v_mfma_f32_16x16x32_bf16 v[4:7], v[136:139], a[144:147], v[4:7]
  v_mfma_f32_16x16x32_bf16 v[4:7], v[152:155], a[252:255], v[4:7]
  v_mfma_f32_16x16x32_bf16 v[8:11], v[152:155], a[128:131], v[8:11]
  v_mfma_f32_16x16x32_bf16 v[8:11], v[136:139], a[148:151], v[8:11]
  v_mfma_f32_16x16x32_bf16 v[12:15], v[136:139], a[152:155], v[12:15]
  v_mfma_f32_16x16x32_bf16 v[12:15], v[152:155], a[132:135], v[12:15]
  s_waitcnt lgkmcnt(2)
  v_mfma_f32_16x16x32_bf16 v[16:19], v[156:159], a[100:103], v[16:19]
  ds_read_b128 v[164:167], v122 offset:19456
  ds_read_b128 v[148:151], v202 offset:0
  v_mfma_f32_16x16x32_bf16 v[16:19], v[140:143], a[104:107], v[16:19]
  v_mfma_f32_16x16x32_bf16 v[20:23], v[140:143], a[144:147], v[20:23]
  v_mfma_f32_16x16x32_bf16 v[20:23], v[156:159], a[252:255], v[20:23]
  v_mfma_f32_16x16x32_bf16 v[24:27], v[156:159], a[128:131], v[24:27]
  v_mfma_f32_16x16x32_bf16 v[24:27], v[140:143], a[148:151], v[24:27]
  v_mfma_f32_16x16x32_bf16 v[28:31], v[140:143], a[152:155], v[28:31]
  v_mfma_f32_16x16x32_bf16 v[28:31], v[156:159], a[132:135], v[28:31]
  s_waitcnt lgkmcnt(2)
  v_mfma_f32_16x16x32_bf16 v[32:35], v[160:163], a[100:103], v[32:35]
  ds_read_b128 v[168:171], v122 offset:32768
  ds_read_b128 a[88:91], v202 offset:1024
  v_mfma_f32_16x16x32_bf16 v[32:35], v[144:147], a[104:107], v[32:35]
  v_mfma_f32_16x16x32_bf16 v[36:39], v[144:147], a[144:147], v[36:39]
  v_mfma_f32_16x16x32_bf16 v[36:39], v[160:163], a[252:255], v[36:39]
  v_mfma_f32_16x16x32_bf16 v[40:43], v[160:163], a[128:131], v[40:43]
  v_mfma_f32_16x16x32_bf16 v[40:43], v[144:147], a[148:151], v[40:43]
  v_mfma_f32_16x16x32_bf16 v[44:47], v[144:147], a[152:155], v[44:47]
  v_mfma_f32_16x16x32_bf16 v[44:47], v[160:163], a[132:135], v[44:47]
  s_waitcnt lgkmcnt(2)
  v_mfma_f32_16x16x32_bf16 v[48:51], v[164:167], a[100:103], v[48:51]
  ds_read_b128 a[124:127], v202 offset:2048
  ds_read_b128 a[160:163], v202 offset:19456
  v_mfma_f32_16x16x32_bf16 v[48:51], v[148:151], a[104:107], v[48:51]
  v_mfma_f32_16x16x32_bf16 v[52:55], v[148:151], a[144:147], v[52:55]
  v_mfma_f32_16x16x32_bf16 v[52:55], v[164:167], a[252:255], v[52:55]
  v_mfma_f32_16x16x32_bf16 v[56:59], v[164:167], a[128:131], v[56:59]
  v_mfma_f32_16x16x32_bf16 v[56:59], v[148:151], a[148:151], v[56:59]
  v_mfma_f32_16x16x32_bf16 v[60:63], v[148:151], a[152:155], v[60:63]
  v_mfma_f32_16x16x32_bf16 v[60:63], v[164:167], a[132:135], v[60:63]
  s_waitcnt lgkmcnt(2)
  v_mfma_f32_16x16x32_bf16 v[64:67], v[168:171], a[100:103], v[64:67]
  ds_read_b128 a[180:183], v202 offset:3072
  ds_read_b128 a[184:187], v122 offset:49152
  v_mfma_f32_16x16x32_bf16 v[64:67], a[88:91], a[104:107], v[64:67]
  v_mfma_f32_16x16x32_bf16 v[68:71], a[88:91], a[144:147], v[68:71]
  v_mfma_f32_16x16x32_bf16 v[68:71], v[168:171], a[252:255], v[68:71]
  v_mfma_f32_16x16x32_bf16 v[72:75], v[168:171], a[128:131], v[72:75]
  v_mfma_f32_16x16x32_bf16 v[72:75], a[88:91], a[148:151], v[72:75]
  v_mfma_f32_16x16x32_bf16 v[76:79], a[88:91], a[152:155], v[76:79]
  v_mfma_f32_16x16x32_bf16 v[76:79], v[168:171], a[132:135], v[76:79]
  s_waitcnt vmcnt(0)
  v_cmp_lt_u32 vcc, v195, v201
  s_nop 0
  s_cbranch_vccz tail_partner
  s_mov_b32 s35, 32768
tail_spin2:
  s_sleep 2
  buffer_load_dword v195, v200, s[24:27], 0 offen sc1
  s_waitcnt vmcnt(0)
  v_cmp_lt_u32 vcc, v195, v201
  s_nop 0
  s_cbranch_vccz tail_partner
  s_sub_u32 s35, s35, 1
  s_cmp_lg_u32 s35, 0
  s_cbranch_scc1 tail_spin2
tail_partner:
  s_waitcnt lgkmcnt(2)
  v_mfma_f32_16x16x32_bf16 v[0:3], a[124:127], a[136:139], v[0:3]
  ds_read_b128 a[196:199], v202 offset:16384
  ds_read_b128 a[200:203], v122 offset:50176
  v_mfma_f32_16x16x32_bf16 v[0:3], a[160:163], a[156:159], v[0:3]
  buffer_load_dwordx2 v[206:207], v192, s[24:27], s38 offen offset:0 sc1
  v_mfma_f32_16x16x32_bf16 v[4:7], a[160:163], v[128:131], v[4:7]
  buffer_load_dwordx2 v[210:211], v192, s[24:27], s38 offen offset:512 sc1
  v_mfma_f32_16x16x32_bf16 v[4:7], a[124:127], a[140:143], v[4:7]
  buffer_load_dwordx2 v[214:215], v192, s[24:27], s38 offen offset:1024 sc1
  v_mfma_f32_16x16x32_bf16 v[8:11], a[124:127], a[172:175], v[8:11]
  buffer_load_dwordx2 v[218:219], v192, s[24:27], s38 offen offset:1536 sc1
  v_mfma_f32_16x16x32_bf16 v[8:11], a[160:163], a[176:179], v[8:11]
  buffer_load_dwordx2 v[222:223], v192, s[24:27], s38 offen offset:2048 sc1
  v_mfma_f32_16x16x32_bf16 v[12:15], a[160:163], a[192:195], v[12:15]
  v_mfma_f32_16x16x32_bf16 v[12:15], a[124:127], a[188:191], v[12:15]
  s_waitcnt lgkmcnt(2)
  v_mfma_f32_16x16x32_bf16 v[16:19], a[180:183], a[136:139], v[16:19]
  ds_read_b128 v[172:175], v202 offset:17408
  ds_read_b128 a[0:3], v122 offset:51200
  v_mfma_f32_16x16x32_bf16 v[16:19], a[184:187], a[156:159], v[16:19]
  ds_write_b128 v122, v[4:7] offset:0
  ds_write_b128 v122, v[8:11] offset:17408
  v_mfma_f32_16x16x32_bf16 v[20:23], a[184:187], v[128:131], v[20:23]
  ds_write_b128 v122, v[12:15] offset:34816
  v_mfma_f32_16x16x32_bf16 v[20:23], a[180:183], a[140:143], v[20:23]
  v_mfma_f32_16x16x32_bf16 v[24:27], a[180:183], a[172:175], v[24:27]
  v_mfma_f32_16x16x32_bf16 v[24:27], a[184:187], a[176:179], v[24:27]
  v_mfma_f32_16x16x32_bf16 v[28:31], a[184:187], a[192:195], v[28:31]
  v_mfma_f32_16x16x32_bf16 v[28:31], a[180:183], a[188:191], v[28:31]
  s_waitcnt lgkmcnt(5)
  v_mfma_f32_16x16x32_bf16 v[32:35], a[196:199], a[136:139], v[32:35]
  ds_read_b128 v[176:179], v202 offset:18432
  ds_read_b128 a[4:7], v122 offset:52224
  v_mfma_f32_16x16x32_bf16 v[32:35], a[200:203], a[156:159], v[32:35]
  ds_write_b128 v122, v[20:23] offset:1024
  ds_write_b128 v122, v[24:27] offset:18432
  v_mfma_f32_16x16x32_bf16 v[36:39], a[200:203], v[128:131], v[36:39]
  ds_write_b128 v122, v[28:31] offset:35840
  v_mfma_f32_16x16x32_bf16 v[36:39], a[196:199], a[140:143], v[36:39]
  v_mfma_f32_16x16x32_bf16 v[40:43], a[196:199], a[172:175], v[40:43]
  v_mfma_f32_16x16x32_bf16 v[40:43], a[200:203], a[176:179], v[40:43]
  v_mfma_f32_16x16x32_bf16 v[44:47], a[200:203], a[192:195], v[44:47]
  v_mfma_f32_16x16x32_bf16 v[44:47], a[196:199], a[188:191], v[44:47]
  s_waitcnt lgkmcnt(8)
  v_mfma_f32_16x16x32_bf16 v[48:51], v[172:175], a[136:139], v[48:51]
  v_mfma_f32_16x16x32_bf16 v[48:51], a[0:3], a[156:159], v[48:51]
  v_mfma_f32_16x16x32_bf16 v[52:55], a[0:3], v[128:131], v[52:55]
  ds_write_b128 v122, v[36:39] offset:2048
  v_mfma_f32_16x16x32_bf16 v[52:55], v[172:175], a[140:143], v[52:55]
  ds_write_b128 v122, v[40:43] offset:19456
  v_mfma_f32_16x16x32_bf16 v[56:59], v[172:175], a[172:175], v[56:59]
  ds_write_b128 v122, v[44:47] offset:49152
  v_mfma_f32_16x16x32_bf16 v[56:59], a[0:3], a[176:179], v[56:59]
  v_mfma_f32_16x16x32_bf16 v[60:63], a[0:3], a[192:195], v[60:63]
  v_mfma_f32_16x16x32_bf16 v[60:63], v[172:175], a[188:191], v[60:63]
  s_waitcnt lgkmcnt(6)
  v_mfma_f32_16x16x32_bf16 v[64:67], v[176:179], a[136:139], v[64:67]
  ds_write_b128 v122, v[52:55] offset:3072
  v_mfma_f32_16x16x32_bf16 v[64:67], a[4:7], a[156:159], v[64:67]
  v_mfma_f32_16x16x32_bf16 v[68:71], a[4:7], v[128:131], v[68:71]
  v_mfma_f32_16x16x32_bf16 v[68:71], v[176:179], a[140:143], v[68:71]
  ds_write_b128 v122, v[56:59] offset:32768
  v_mfma_f32_16x16x32_bf16 v[72:75], v[176:179], a[172:175], v[72:75]
  ds_write_b128 v122, v[60:63] offset:50176
  v_mfma_f32_16x16x32_bf16 v[72:75], a[4:7], a[176:179], v[72:75]
  v_mfma_f32_16x16x32_bf16 v[76:79], a[4:7], a[192:195], v[76:79]
  v_mfma_f32_16x16x32_bf16 v[76:79], v[176:179], a[188:191], v[76:79]
  s_nop 1
  ds_write_b128 v122, v[68:71] offset:16384
  s_nop 2
  ds_write_b128 v122, v[72:75] offset:33792
  s_nop 0
  ds_write_b128 v122, v[76:79] offset:51200
  s_waitcnt vmcnt(4)
  v_lshlrev_b32 v204, 16, v206
  v_and_b32 v205, s34, v206
  v_lshlrev_b32 v206, 16, v207
  v_and_b32 v207, s34, v207
  v_pk_add_f32 v[0:1], v[0:1], v[204:205]
  v_pk_add_f32 v[2:3], v[2:3], v[206:207]
  s_waitcnt vmcnt(3)
  v_lshlrev_b32 v208, 16, v210
  v_and_b32 v209, s34, v210
  v_lshlrev_b32 v210, 16, v211
  v_and_b32 v211, s34, v211
  v_pk_add_f32 v[16:17], v[16:17], v[208:209]
  v_pk_add_f32 v[18:19], v[18:19], v[210:211]
  s_waitcnt vmcnt(2)
  v_lshlrev_b32 v212, 16, v214
  v_and_b32 v213, s34, v214
  v_lshlrev_b32 v214, 16, v215
  v_and_b32 v215, s34, v215
  v_pk_add_f32 v[32:33], v[32:33], v[212:213]
  v_pk_add_f32 v[34:35], v[34:35], v[214:215]
  s_waitcnt vmcnt(1)
  v_lshlrev_b32 v216, 16, v218
  v_and_b32 v217, s34, v218
  v_lshlrev_b32 v218, 16, v219
  v_and_b32 v219, s34, v219
  v_pk_add_f32 v[48:49], v[48:49], v[216:217]
  v_pk_add_f32 v[50:51], v[50:51], v[218:219]
  s_waitcnt vmcnt(0)
  v_lshlrev_b32 v220, 16, v222
  v_and_b32 v221, s34, v222
  v_lshlrev_b32 v222, 16, v223
  v_and_b32 v223, s34, v223
  v_pk_add_f32 v[64:65], v[64:65], v[220:221]
  v_pk_add_f32 v[66:67], v[66:67], v[222:223]
  s_waitcnt lgkmcnt(0)
  s_barrier
  ds_read_b128 v[4:7], v80 offset:0
  ds_read_b128 v[8:11], v81 offset:17408
  ds_read_b128 v[12:15], v82 offset:34816
  ds_read_b128 v[20:23], v80 offset:1024
  ds_read_b128 v[24:27], v81 offset:18432
  ds_read_b128 v[28:31], v82 offset:35840
  ds_read_b128 v[36:39], v80 offset:2048
  ds_read_b128 v[40:43], v81 offset:19456
  ds_read_b128 v[44:47], v82 offset:49152
  ds_read_b128 v[52:55], v80 offset:3072
  ds_read_b128 v[56:59], v81 offset:32768
  ds_read_b128 v[60:63], v82 offset:50176
  ds_read_b128 v[68:71], v80 offset:16384
  ds_read_b128 v[72:75], v81 offset:33792
  ds_read_b128 v[76:79], v82 offset:51200
  s_waitcnt lgkmcnt(13)
  v_pk_add_f32 v[4:5], v[4:5], v[8:9]
  v_pk_add_f32 v[6:7], v[6:7], v[10:11]
  s_waitcnt lgkmcnt(12)
  v_pk_add_f32 v[0:1], v[0:1], v[12:13]
  v_pk_add_f32 v[2:3], v[2:3], v[14:15]
  v_pk_add_f32 v[0:1], v[0:1], v[4:5]
  v_pk_add_f32 v[2:3], v[2:3], v[6:7]
  v_cvt_pk_bf16_f32 v4, v0, v1
  v_cvt_pk_bf16_f32 v5, v2, v3
  v_lshlrev_b32 v0, 16, v4
  v_and_b32 v1, s34, v4
  v_lshlrev_b32 v2, 16, v5
  v_and_b32 v3, s34, v5
  v_pk_mul_f32 v[0:1], v[0:1], v[90:91]
  v_pk_mul_f32 v[2:3], v[2:3], v[92:93]
  v_cvt_pk_bf16_f32 v4, v0, v1
  v_cvt_pk_bf16_f32 v5, v2, v3
  v_lshlrev_b32 v0, 16, v4
  v_and_b32 v1, s34, v4
  v_lshlrev_b32 v2, 16, v5
  v_and_b32 v3, s34, v5
  v_pk_add_f32 v[0:1], v[0:1], v[224:225]
  v_pk_add_f32 v[2:3], v[2:3], v[226:227]
  v_cvt_pk_bf16_f32 v4, v0, v1
  v_cvt_pk_bf16_f32 v5, v2, v3
  s_waitcnt lgkmcnt(10)
  v_pk_add_f32 v[20:21], v[20:21], v[24:25]
  v_pk_add_f32 v[22:23], v[22:23], v[26:27]
  s_waitcnt lgkmcnt(9)
  v_pk_add_f32 v[16:17], v[16:17], v[28:29]
  v_pk_add_f32 v[18:19], v[18:19], v[30:31]
  v_pk_add_f32 v[16:17], v[16:17], v[20:21]
  v_pk_add_f32 v[18:19], v[18:19], v[22:23]
  v_cvt_pk_bf16_f32 v20, v16, v17
  v_cvt_pk_bf16_f32 v21, v18, v19
  v_lshlrev_b32 v16, 16, v20
  v_and_b32 v17, s34, v20
  v_lshlrev_b32 v18, 16, v21
  v_and_b32 v19, s34, v21
  v_pk_mul_f32 v[16:17], v[16:17], v[94:95]
  v_pk_mul_f32 v[18:19], v[18:19], v[96:97]
  v_cvt_pk_bf16_f32 v20, v16, v17
  v_cvt_pk_bf16_f32 v21, v18, v19
  v_lshlrev_b32 v16, 16, v20
  v_and_b32 v17, s34, v20
  v_lshlrev_b32 v18, 16, v21
  v_and_b32 v19, s34, v21
  v_pk_add_f32 v[16:17], v[16:17], v[228:229]
  v_pk_add_f32 v[18:19], v[18:19], v[230:231]
  v_cvt_pk_bf16_f32 v6, v16, v17
  v_cvt_pk_bf16_f32 v7, v18, v19
  s_nop 0
  v_permlane16_swap_b32 v4, v6
  v_permlane16_swap_b32 v5, v7
  buffer_store_dwordx4 v[4:7], v83, s[16:19], 0 offen offset:0
  s_waitcnt lgkmcnt(7)
  v_pk_add_f32 v[36:37], v[36:37], v[40:41]
  v_pk_add_f32 v[38:39], v[38:39], v[42:43]
  s_waitcnt lgkmcnt(6)
  v_pk_add_f32 v[32:33], v[32:33], v[44:45]
  v_pk_add_f32 v[34:35], v[34:35], v[46:47]
  v_pk_add_f32 v[32:33], v[32:33], v[36:37]
  v_pk_add_f32 v[34:35], v[34:35], v[38:39]
  v_cvt_pk_bf16_f32 v36, v32, v33
  v_cvt_pk_bf16_f32 v37, v34, v35
  v_lshlrev_b32 v32, 16, v36
  v_and_b32 v33, s34, v36
  v_lshlrev_b32 v34, 16, v37
  v_and_b32 v35, s34, v37
  v_pk_mul_f32 v[32:33], v[32:33], v[98:99]
  v_pk_mul_f32 v[34:35], v[34:35], v[100:101]
  v_cvt_pk_bf16_f32 v36, v32, v33
  v_cvt_pk_bf16_f32 v37, v34, v35
  v_lshlrev_b32 v32, 16, v36
  v_and_b32 v33, s34, v36
  v_lshlrev_b32 v34, 16, v37
  v_and_b32 v35, s34, v37
  v_pk_add_f32 v[32:33], v[32:33], v[232:233]
  v_pk_add_f32 v[34:35], v[34:35], v[234:235]
  v_cvt_pk_bf16_f32 v36, v32, v33
  v_cvt_pk_bf16_f32 v37, v34, v35
  s_waitcnt lgkmcnt(4)
  v_pk_add_f32 v[52:53], v[52:53], v[56:57]
  v_pk_add_f32 v[54:55], v[54:55], v[58:59]
  s_waitcnt lgkmcnt(3)
  v_pk_add_f32 v[48:49], v[48:49], v[60:61]
  v_pk_add_f32 v[50:51], v[50:51], v[62:63]
  v_pk_add_f32 v[48:49], v[48:49], v[52:53]
  v_pk_add_f32 v[50:51], v[50:51], v[54:55]
  v_cvt_pk_bf16_f32 v52, v48, v49
  v_cvt_pk_bf16_f32 v53, v50, v51
  v_lshlrev_b32 v48, 16, v52
  v_and_b32 v49, s34, v52
  v_lshlrev_b32 v50, 16, v53
  v_and_b32 v51, s34, v53
  v_pk_mul_f32 v[48:49], v[48:49], v[102:103]
  v_pk_mul_f32 v[50:51], v[50:51], v[104:105]
  v_cvt_pk_bf16_f32 v52, v48, v49
  v_cvt_pk_bf16_f32 v53, v50, v51
  v_lshlrev_b32 v48, 16, v52
  v_and_b32 v49, s34, v52
  v_lshlrev_b32 v50, 16, v53
  v_and_b32 v51, s34, v53
  v_pk_add_f32 v[48:49], v[48:49], v[236:237]
  v_pk_add_f32 v[50:51], v[50:51], v[238:239]
  v_cvt_pk_bf16_f32 v38, v48, v49
  v_cvt_pk_bf16_f32 v39, v50, v51
  s_nop 0
  v_permlane16_swap_b32 v36, v38
  v_permlane16_swap_b32 v37, v39
  buffer_store_dwordx4 v[36:39], v83, s[16:19], 0 offen offset:64
  s_waitcnt lgkmcnt(1)
  v_pk_add_f32 v[68:69], v[68:69], v[72:73]
  v_pk_add_f32 v[70:71], v[70:71], v[74:75]
  s_waitcnt lgkmcnt(0)
  v_pk_add_f32 v[64:65], v[64:65], v[76:77]
  v_pk_add_f32 v[66:67], v[66:67], v[78:79]
  v_pk_add_f32 v[64:65], v[64:65], v[68:69]
  v_pk_add_f32 v[66:67], v[66:67], v[70:71]
  v_cvt_pk_bf16_f32 v68, v64, v65
  v_cvt_pk_bf16_f32 v69, v66, v67
  v_lshlrev_b32 v64, 16, v68
  v_and_b32 v65, s34, v68
  v_lshlrev_b32 v66, 16, v69
  v_and_b32 v67, s34, v69
  v_pk_mul_f32 v[64:65], v[64:65], v[106:107]
  v_pk_mul_f32 v[66:67], v[66:67], v[108:109]
  v_cvt_pk_bf16_f32 v68, v64, v65
  v_cvt_pk_bf16_f32 v69, v66, v67
  v_lshlrev_b32 v64, 16, v68
  v_and_b32 v65, s34, v68
  v_lshlrev_b32 v66, 16, v69
  v_and_b32 v67, s34, v69
  v_pk_add_f32 v[64:65], v[64:65], v[240:241]
  v_pk_add_f32 v[66:67], v[66:67], v[242:243]
  v_cvt_pk_bf16_f32 v68, v64, v65
  v_cvt_pk_bf16_f32 v69, v66, v67
  buffer_store_dwordx2 v[68:69], v117, s[16:19], 0 offen offset:128
attn_end:
  s_endpgm
attn_redo:
  s_load_dwordx2 s[48:49], s[0:1], 24
  s_waitcnt vmcnt(0) lgkmcnt(0)
  s_lshl_b32 s38, s36, 8
  s_add_u32 s20, s48, s38
  s_addc_u32 s21, s49, 0
  s_mov_b32 s22, 5242880
  s_mov_b32 s23, 0x20000
  s_sub_u32 s22, s22, s38
  v_lshrrev_b32 v245, 4, v242
  v_add_u32 v243, 0x1000, v242
  s_mul_i32 s30, s37, 81920
  s_mov_b32 s31, 0
  v_lshrrev_b32 v248, 4, v245
  v_and_b32 v247, 15, v245
  s_lshl_b32 s38, s3, 17
  v_lshlrev_b32 v249, 13, v248
  v_add_u32 v249, s38, v249
  v_or_b32 v250, 0, v248
  v_lshlrev_b32 v250, 1, v250
  v_xor_b32 v250, v250, v247
  v_lshl_add_u32 v238, v250, 4, v249
  v_or_b32 v250, 0, v248
  v_lshlrev_b32 v250, 1, v250
  v_xor_b32 v250, v250, v247
  v_lshl_add_u32 v239, v250, 4, v249
  v_add_u32 v239, 31744, v239
  v_or_b32 v250, 4, v248
  v_lshlrev_b32 v250, 1, v250
  v_xor_b32 v250, v250, v247
  v_lshl_add_u32 v240, v250, 4, v249
  v_add_u32 v240, 63488, v240
  v_or_b32 v250, 4, v248
  v_lshlrev_b32 v250, 1, v250
  v_xor_b32 v250, v250, v247
  v_lshl_add_u32 v241, v250, 4, v249
  v_add_u32 v241, 95232, v241
  v_bfe_u32 v246, v245, 2, 2
  v_and_b32 v247, 3, v245
  v_lshlrev_b32 v247, 3, v247
  v_add_u32 v247, 65536, v247
  v_lshl_add_u32 v249, v248, 3, v246
  v_and_b32 v250, 1, v248
  v_lshl_add_u32 v250, v250, 2, v246
  v_lshl_add_u32 v250, v250, 5, v247
  v_lshl_add_u32 v224, v249, 8, v250
  v_xor_b32 v225, 32, v224
  v_xor_b32 v226, 64, v224
  v_xor_b32 v227, 96, v224
  v_xor_b32 v228, 128, v224
  v_xor_b32 v229, 160, v224
  v_xor_b32 v230, 192, v224
  v_xor_b32 v231, 224, v224
  v_mov_b32 v0, 0
  v_mov_b32 v1, 0
  v_mov_b32 v2, 0
  v_mov_b32 v3, 0
  v_mov_b32 v4, 0
  v_mov_b32 v5, 0
  v_mov_b32 v6, 0
  v_mov_b32 v7, 0
  v_mov_b32 v8, 0
  v_mov_b32 v9, 0
  v_mov_b32 v10, 0
  v_mov_b32 v11, 0
  v_mov_b32 v12, 0
  v_mov_b32 v13, 0
  v_mov_b32 v14, 0
  v_mov_b32 v15, 0
  v_mov_b32 v16, 0
  v_mov_b32 v17, 0
  v_mov_b32 v18, 0
  v_mov_b32 v19, 0
  v_mov_b32 v20, 0
  v_mov_b32 v21, 0
  v_mov_b32 v22, 0
  v_mov_b32 v23, 0
  v_mov_b32 v24, 0
  v_mov_b32 v25, 0
  v_mov_b32 v26, 0
  v_mov_b32 v27, 0
  v_mov_b32 v28, 0
  v_mov_b32 v29, 0
  v_mov_b32 v30, 0
  v_mov_b32 v31, 0
  v_mov_b32 v32, 0
  v_mov_b32 v33, 0
  v_mov_b32 v34, 0
  v_mov_b32 v35, 0
  v_mov_b32 v36, 0
  v_mov_b32 v37, 0
  v_mov_b32 v38, 0
  v_mov_b32 v39, 0
  v_mov_b32 v40, 0
  v_mov_b32 v41, 0
  v_mov_b32 v42, 0
  v_mov_b32 v43, 0
  v_mov_b32 v44, 0
  v_mov_b32 v45, 0
  v_mov_b32 v46, 0
  v_mov_b32 v47, 0
  v_mov_b32 v48, 0
  v_mov_b32 v49, 0
  v_mov_b32 v50, 0
  v_mov_b32 v51, 0
  v_mov_b32 v52, 0
  v_mov_b32 v53, 0
  v_mov_b32 v54, 0
  v_mov_b32 v55, 0
  v_mov_b32 v56, 0
  v_mov_b32 v57, 0
  v_mov_b32 v58, 0
  v_mov_b32 v59, 0
  v_mov_b32 v60, 0
  v_mov_b32 v61, 0
  v_mov_b32 v62, 0
  v_mov_b32 v63, 0
  v_mov_b32 v64, 0
  v_mov_b32 v65, 0
  v_mov_b32 v66, 0
  v_mov_b32 v67, 0
  v_mov_b32 v68, 0
  v_mov_b32 v69, 0
  v_mov_b32 v70, 0
  v_mov_b32 v71, 0
  v_mov_b32 v72, 0
  v_mov_b32 v73, 0
  v_mov_b32 v74, 0
  v_mov_b32 v75, 0
  v_mov_b32 v76, 0
  v_mov_b32 v77, 0
  v_mov_b32 v78, 0
  v_mov_b32 v79, 0
  v_mov_b32 v80, 0
  v_mov_b32 v81, 0
  v_mov_b32 v82, 0
  v_mov_b32 v83, 0
  v_mov_b32 v84, 0
  v_mov_b32 v85, 0
  v_mov_b32 v86, 0
  v_mov_b32 v87, 0
  v_mov_b32 v88, 0
  v_mov_b32 v89, 0
  v_mov_b32 v90, 0
  v_mov_b32 v91, 0
  v_mov_b32 v92, 0
  v_mov_b32 v93, 0
  v_mov_b32 v94, 0
  v_mov_b32 v95, 0
  v_mov_b32 v96, 0
  v_mov_b32 v97, 0
  v_mov_b32 v98, 0
  v_mov_b32 v99, 0
  v_mov_b32 v100, 0
  v_mov_b32 v101, 0
  v_mov_b32 v102, 0
  v_mov_b32 v103, 0
  v_mov_b32 v104, 0
  v_mov_b32 v105, 0
  v_mov_b32 v106, 0
  v_mov_b32 v107, 0
  v_mov_b32 v108, 0
  v_mov_b32 v109, 0
  v_mov_b32 v110, 0
  v_mov_b32 v111, 0
  v_mov_b32 v112, 0
  v_mov_b32 v113, 0
  v_mov_b32 v114, 0
  v_mov_b32 v115, 0
  v_mov_b32 v116, 0
  v_mov_b32 v117, 0
  v_mov_b32 v118, 0
  v_mov_b32 v119, 0
  v_mov_b32 v120, 0
  v_mov_b32 v121, 0
  v_mov_b32 v122, 0
  v_mov_b32 v123, 0
  v_mov_b32 v124, 0
  v_mov_b32 v125, 0
  v_mov_b32 v126, 0
  v_mov_b32 v127, 0
attn_requery:
  s_barrier
  s_add_u32 m0, s28, 114688
  s_nop 0
  buffer_load_dwordx4 v238, s[20:23], s31 offen offset:0 lds
  buffer_load_dwordx4 v239, s[20:23], s31 offen offset:1024 lds
  buffer_load_dwordx4 v240, s[20:23], s31 offen offset:2048 lds
  buffer_load_dwordx4 v241, s[20:23], s31 offen offset:3072 lds
  buffer_load_dwordx4 a[0:3], v242, s[24:27], s30 offen offset:0 sc1
  buffer_load_dwordx4 a[4:7], v242, s[24:27], s30 offen offset:1024 sc1
  buffer_load_dwordx4 a[8:11], v242, s[24:27], s30 offen offset:2048 sc1
  buffer_load_dwordx4 a[12:15], v242, s[24:27], s30 offen offset:3072 sc1
  buffer_load_dwordx4 a[16:19], v243, s[24:27], s30 offen offset:0 sc1
  buffer_load_dwordx4 a[20:23], v243, s[24:27], s30 offen offset:1024 sc1
  buffer_load_dwordx4 a[24:27], v243, s[24:27], s30 offen offset:2048 sc1
  buffer_load_dwordx4 a[28:31], v243, s[24:27], s30 offen offset:3072 sc1
  s_add_u32 s30, s30, 8192
  s_waitcnt vmcnt(0)
  s_barrier
  ds_read_b64_tr_b16 a[160:161], v224 offset:49152
  ds_read_b64_tr_b16 a[162:163], v224 offset:50176
  ds_read_b64_tr_b16 a[164:165], v224 offset:57344
  ds_read_b64_tr_b16 a[166:167], v224 offset:58368
  s_waitcnt lgkmcnt(2)
  v_mfma_f32_16x16x32_bf16 v[0:3], a[160:163], a[0:3], v[0:3]
  s_waitcnt lgkmcnt(0)
  v_mfma_f32_16x16x32_bf16 v[0:3], a[164:167], a[16:19], v[0:3]
  v_mfma_f32_16x16x32_bf16 v[4:7], a[164:167], a[20:23], v[4:7]
  v_mfma_f32_16x16x32_bf16 v[4:7], a[160:163], a[4:7], v[4:7]
  v_mfma_f32_16x16x32_bf16 v[8:11], a[160:163], a[8:11], v[8:11]
  v_mfma_f32_16x16x32_bf16 v[8:11], a[164:167], a[24:27], v[8:11]
  v_mfma_f32_16x16x32_bf16 v[12:15], a[164:167], a[28:31], v[12:15]
  v_mfma_f32_16x16x32_bf16 v[12:15], a[160:163], a[12:15], v[12:15]
  ds_read_b64_tr_b16 a[168:169], v225 offset:49152
  ds_read_b64_tr_b16 a[170:171], v225 offset:50176
  ds_read_b64_tr_b16 a[172:173], v225 offset:57344
  ds_read_b64_tr_b16 a[174:175], v225 offset:58368
  s_waitcnt lgkmcnt(2)
  v_mfma_f32_16x16x32_bf16 v[16:19], a[168:171], a[0:3], v[16:19]
  s_waitcnt lgkmcnt(0)
  v_mfma_f32_16x16x32_bf16 v[16:19], a[172:175], a[16:19], v[16:19]
  v_mfma_f32_16x16x32_bf16 v[20:23], a[172:175], a[20:23], v[20:23]
  v_mfma_f32_16x16x32_bf16 v[20:23], a[168:171], a[4:7], v[20:23]
  v_mfma_f32_16x16x32_bf16 v[24:27], a[168:171], a[8:11], v[24:27]
  v_mfma_f32_16x16x32_bf16 v[24:27], a[172:175], a[24:27], v[24:27]
  v_mfma_f32_16x16x32_bf16 v[28:31], a[172:175], a[28:31], v[28:31]
  v_mfma_f32_16x16x32_bf16 v[28:31], a[168:171], a[12:15], v[28:31]
  ds_read_b64_tr_b16 a[176:177], v226 offset:49152
  ds_read_b64_tr_b16 a[178:179], v226 offset:50176
  ds_read_b64_tr_b16 a[180:181], v226 offset:57344
  ds_read_b64_tr_b16 a[182:183], v226 offset:58368
  s_waitcnt lgkmcnt(2)
  v_mfma_f32_16x16x32_bf16 v[32:35], a[176:179], a[0:3], v[32:35]
  s_waitcnt lgkmcnt(0)
  v_mfma_f32_16x16x32_bf16 v[32:35], a[180:183], a[16:19], v[32:35]
  v_mfma_f32_16x16x32_bf16 v[36:39], a[180:183], a[20:23], v[36:39]
  v_mfma_f32_16x16x32_bf16 v[36:39], a[176:179], a[4:7], v[36:39]
  v_mfma_f32_16x16x32_bf16 v[40:43], a[176:179], a[8:11], v[40:43]
  v_mfma_f32_16x16x32_bf16 v[40:43], a[180:183], a[24:27], v[40:43]
  v_mfma_f32_16x16x32_bf16 v[44:47], a[180:183], a[28:31], v[44:47]
  v_mfma_f32_16x16x32_bf16 v[44:47], a[176:179], a[12:15], v[44:47]
  ds_read_b64_tr_b16 a[184:185], v227 offset:49152
  ds_read_b64_tr_b16 a[186:187], v227 offset:50176
  ds_read_b64_tr_b16 a[188:189], v227 offset:57344
  ds_read_b64_tr_b16 a[190:191], v227 offset:58368
  s_waitcnt lgkmcnt(2)
  v_mfma_f32_16x16x32_bf16 v[48:51], a[184:187], a[0:3], v[48:51]
  s_waitcnt lgkmcnt(0)
  v_mfma_f32_16x16x32_bf16 v[48:51], a[188:191], a[16:19], v[48:51]
  v_mfma_f32_16x16x32_bf16 v[52:55], a[188:191], a[20:23], v[52:55]
  v_mfma_f32_16x16x32_bf16 v[52:55], a[184:187], a[4:7], v[52:55]
  v_mfma_f32_16x16x32_bf16 v[56:59], a[184:187], a[8:11], v[56:59]
  v_mfma_f32_16x16x32_bf16 v[56:59], a[188:191], a[24:27], v[56:59]
  v_mfma_f32_16x16x32_bf16 v[60:63], a[188:191], a[28:31], v[60:63]
  v_mfma_f32_16x16x32_bf16 v[60:63], a[184:187], a[12:15], v[60:63]
  ds_read_b64_tr_b16 a[160:161], v228 offset:49152
  ds_read_b64_tr_b16 a[162:163], v228 offset:50176
  ds_read_b64_tr_b16 a[164:165], v228 offset:57344
  ds_read_b64_tr_b16 a[166:167], v228 offset:58368
  s_waitcnt lgkmcnt(2)
  v_mfma_f32_16x16x32_bf16 v[64:67], a[160:163], a[0:3], v[64:67]
  s_waitcnt lgkmcnt(0)
  v_mfma_f32_16x16x32_bf16 v[64:67], a[164:167], a[16:19], v[64:67]
  v_mfma_f32_16x16x32_bf16 v[68:71], a[164:167], a[20:23], v[68:71]
  v_mfma_f32_16x16x32_bf16 v[68:71], a[160:163], a[4:7], v[68:71]
  v_mfma_f32_16x16x32_bf16 v[72:75], a[160:163], a[8:11], v[72:75]
  v_mfma_f32_16x16x32_bf16 v[72:75], a[164:167], a[24:27], v[72:75]
  v_mfma_f32_16x16x32_bf16 v[76:79], a[164:167], a[28:31], v[76:79]
  v_mfma_f32_16x16x32_bf16 v[76:79], a[160:163], a[12:15], v[76:79]
  ds_read_b64_tr_b16 a[168:169], v229 offset:49152
  ds_read_b64_tr_b16 a[170:171], v229 offset:50176
  ds_read_b64_tr_b16 a[172:173], v229 offset:57344
  ds_read_b64_tr_b16 a[174:175], v229 offset:58368
  s_waitcnt lgkmcnt(2)
  v_mfma_f32_16x16x32_bf16 v[80:83], a[168:171], a[0:3], v[80:83]
  s_waitcnt lgkmcnt(0)
  v_mfma_f32_16x16x32_bf16 v[80:83], a[172:175], a[16:19], v[80:83]
  v_mfma_f32_16x16x32_bf16 v[84:87], a[172:175], a[20:23], v[84:87]
  v_mfma_f32_16x16x32_bf16 v[84:87], a[168:171], a[4:7], v[84:87]
  v_mfma_f32_16x16x32_bf16 v[88:91], a[168:171], a[8:11], v[88:91]
  v_mfma_f32_16x16x32_bf16 v[88:91], a[172:175], a[24:27], v[88:91]
  v_mfma_f32_16x16x32_bf16 v[92:95], a[172:175], a[28:31], v[92:95]
  v_mfma_f32_16x16x32_bf16 v[92:95], a[168:171], a[12:15], v[92:95]
  ds_read_b64_tr_b16 a[176:177], v230 offset:49152
  ds_read_b64_tr_b16 a[178:179], v230 offset:50176
  ds_read_b64_tr_b16 a[180:181], v230 offset:57344
  ds_read_b64_tr_b16 a[182:183], v230 offset:58368
  s_waitcnt lgkmcnt(2)
  v_mfma_f32_16x16x32_bf16 v[96:99], a[176:179], a[0:3], v[96:99]
  s_waitcnt lgkmcnt(0)
  v_mfma_f32_16x16x32_bf16 v[96:99], a[180:183], a[16:19], v[96:99]
  v_mfma_f32_16x16x32_bf16 v[100:103], a[180:183], a[20:23], v[100:103]
  v_mfma_f32_16x16x32_bf16 v[100:103], a[176:179], a[4:7], v[100:103]
  v_mfma_f32_16x16x32_bf16 v[104:107], a[176:179], a[8:11], v[104:107]
  v_mfma_f32_16x16x32_bf16 v[104:107], a[180:183], a[24:27], v[104:107]
  v_mfma_f32_16x16x32_bf16 v[108:111], a[180:183], a[28:31], v[108:111]
  v_mfma_f32_16x16x32_bf16 v[108:111], a[176:179], a[12:15], v[108:111]
  ds_read_b64_tr_b16 a[184:185], v231 offset:49152
  ds_read_b64_tr_b16 a[186:187], v231 offset:50176
  ds_read_b64_tr_b16 a[188:189], v231 offset:57344
  ds_read_b64_tr_b16 a[190:191], v231 offset:58368
  s_waitcnt lgkmcnt(2)
  v_mfma_f32_16x16x32_bf16 v[112:115], a[184:187], a[0:3], v[112:115]
  s_waitcnt lgkmcnt(0)
  v_mfma_f32_16x16x32_bf16 v[112:115], a[188:191], a[16:19], v[112:115]
  v_mfma_f32_16x16x32_bf16 v[116:119], a[188:191], a[20:23], v[116:119]
  v_mfma_f32_16x16x32_bf16 v[116:119], a[184:187], a[4:7], v[116:119]
  v_mfma_f32_16x16x32_bf16 v[120:123], a[184:187], a[8:11], v[120:123]
  v_mfma_f32_16x16x32_bf16 v[120:123], a[188:191], a[24:27], v[120:123]
  v_mfma_f32_16x16x32_bf16 v[124:127], a[188:191], a[28:31], v[124:127]
  v_mfma_f32_16x16x32_bf16 v[124:127], a[184:187], a[12:15], v[124:127]
  s_add_u32 s31, s31, 0x80000
  s_cmp_lt_u32 s31, 5242880
  s_cbranch_scc1 attn_requery
  v_mul_f32 v0, s34, v0
  v_mul_f32 v1, s34, v1
  v_mul_f32 v2, s34, v2
  v_mul_f32 v3, s34, v3
  v_mul_f32 v16, s34, v16
  v_mul_f32 v17, s34, v17
  v_mul_f32 v18, s34, v18
  v_mul_f32 v19, s34, v19
  v_cvt_pk_bf16_f32 v128, v0, v1
  v_cvt_pk_bf16_f32 v129, v2, v3
  v_cvt_pk_bf16_f32 v130, v16, v17
  v_cvt_pk_bf16_f32 v131, v18, v19
  s_nop 0
  v_permlane16_swap_b32 v128, v130
  v_permlane16_swap_b32 v129, v131
  v_mul_f32 v4, s34, v4
  v_mul_f32 v5, s34, v5
  v_mul_f32 v6, s34, v6
  v_mul_f32 v7, s34, v7
  v_mul_f32 v20, s34, v20
  v_mul_f32 v21, s34, v21
  v_mul_f32 v22, s34, v22
  v_mul_f32 v23, s34, v23
  v_cvt_pk_bf16_f32 v144, v4, v5
  v_cvt_pk_bf16_f32 v145, v6, v7
  v_cvt_pk_bf16_f32 v146, v20, v21
  v_cvt_pk_bf16_f32 v147, v22, v23
  s_nop 0
  v_permlane16_swap_b32 v144, v146
  v_permlane16_swap_b32 v145, v147
  v_mul_f32 v8, s34, v8
  v_mul_f32 v9, s34, v9
  v_mul_f32 v10, s34, v10
  v_mul_f32 v11, s34, v11
  v_mul_f32 v24, s34, v24
  v_mul_f32 v25, s34, v25
  v_mul_f32 v26, s34, v26
  v_mul_f32 v27, s34, v27
  v_cvt_pk_bf16_f32 v160, v8, v9
  v_cvt_pk_bf16_f32 v161, v10, v11
  v_cvt_pk_bf16_f32 v162, v24, v25
  v_cvt_pk_bf16_f32 v163, v26, v27
  s_nop 0
  v_permlane16_swap_b32 v160, v162
  v_permlane16_swap_b32 v161, v163
  v_mul_f32 v12, s34, v12
  v_mul_f32 v13, s34, v13
  v_mul_f32 v14, s34, v14
  v_mul_f32 v15, s34, v15
  v_mul_f32 v28, s34, v28
  v_mul_f32 v29, s34, v29
  v_mul_f32 v30, s34, v30
  v_mul_f32 v31, s34, v31
  v_cvt_pk_bf16_f32 v176, v12, v13
  v_cvt_pk_bf16_f32 v177, v14, v15
  v_cvt_pk_bf16_f32 v178, v28, v29
  v_cvt_pk_bf16_f32 v179, v30, v31
  s_nop 0
  v_permlane16_swap_b32 v176, v178
  v_permlane16_swap_b32 v177, v179
  v_mul_f32 v32, s34, v32
  v_mul_f32 v33, s34, v33
  v_mul_f32 v34, s34, v34
  v_mul_f32 v35, s34, v35
  v_mul_f32 v48, s34, v48
  v_mul_f32 v49, s34, v49
  v_mul_f32 v50, s34, v50
  v_mul_f32 v51, s34, v51
  v_cvt_pk_bf16_f32 v132, v32, v33
  v_cvt_pk_bf16_f32 v133, v34, v35
  v_cvt_pk_bf16_f32 v134, v48, v49
  v_cvt_pk_bf16_f32 v135, v50, v51
  s_nop 0
  v_permlane16_swap_b32 v132, v134
  v_permlane16_swap_b32 v133, v135
  v_mul_f32 v36, s34, v36
  v_mul_f32 v37, s34, v37
  v_mul_f32 v38, s34, v38
  v_mul_f32 v39, s34, v39
  v_mul_f32 v52, s34, v52
  v_mul_f32 v53, s34, v53
  v_mul_f32 v54, s34, v54
  v_mul_f32 v55, s34, v55
  v_cvt_pk_bf16_f32 v148, v36, v37
  v_cvt_pk_bf16_f32 v149, v38, v39
  v_cvt_pk_bf16_f32 v150, v52, v53
  v_cvt_pk_bf16_f32 v151, v54, v55
  s_nop 0
  v_permlane16_swap_b32 v148, v150
  v_permlane16_swap_b32 v149, v151
  v_mul_f32 v40, s34, v40
  v_mul_f32 v41, s34, v41
  v_mul_f32 v42, s34, v42
  v_mul_f32 v43, s34, v43
  v_mul_f32 v56, s34, v56
  v_mul_f32 v57, s34, v57
  v_mul_f32 v58, s34, v58
  v_mul_f32 v59, s34, v59
  v_cvt_pk_bf16_f32 v164, v40, v41
  v_cvt_pk_bf16_f32 v165, v42, v43
  v_cvt_pk_bf16_f32 v166, v56, v57
  v_cvt_pk_bf16_f32 v167, v58, v59
  s_nop 0
  v_permlane16_swap_b32 v164, v166
  v_permlane16_swap_b32 v165, v167
  v_mul_f32 v44, s34, v44
  v_mul_f32 v45, s34, v45
  v_mul_f32 v46, s34, v46
  v_mul_f32 v47, s34, v47
  v_mul_f32 v60, s34, v60
  v_mul_f32 v61, s34, v61
  v_mul_f32 v62, s34, v62
  v_mul_f32 v63, s34, v63
  v_cvt_pk_bf16_f32 v180, v44, v45
  v_cvt_pk_bf16_f32 v181, v46, v47
  v_cvt_pk_bf16_f32 v182, v60, v61
  v_cvt_pk_bf16_f32 v183, v62, v63
  s_nop 0
  v_permlane16_swap_b32 v180, v182
  v_permlane16_swap_b32 v181, v183
  v_mul_f32 v64, s34, v64
  v_mul_f32 v65, s34, v65
  v_mul_f32 v66, s34, v66
  v_mul_f32 v67, s34, v67
  v_mul_f32 v80, s34, v80
  v_mul_f32 v81, s34, v81
  v_mul_f32 v82, s34, v82
  v_mul_f32 v83, s34, v83
  v_cvt_pk_bf16_f32 v136, v64, v65
  v_cvt_pk_bf16_f32 v137, v66, v67
  v_cvt_pk_bf16_f32 v138, v80, v81
  v_cvt_pk_bf16_f32 v139, v82, v83
  s_nop 0
  v_permlane16_swap_b32 v136, v138
  v_permlane16_swap_b32 v137, v139
  v_mul_f32 v68, s34, v68
  v_mul_f32 v69, s34, v69
  v_mul_f32 v70, s34, v70
  v_mul_f32 v71, s34, v71
  v_mul_f32 v84, s34, v84
  v_mul_f32 v85, s34, v85
  v_mul_f32 v86, s34, v86
  v_mul_f32 v87, s34, v87
  v_cvt_pk_bf16_f32 v152, v68, v69
  v_cvt_pk_bf16_f32 v153, v70, v71
  v_cvt_pk_bf16_f32 v154, v84, v85
  v_cvt_pk_bf16_f32 v155, v86, v87
  s_nop 0
  v_permlane16_swap_b32 v152, v154
  v_permlane16_swap_b32 v153, v155
  v_mul_f32 v72, s34, v72
  v_mul_f32 v73, s34, v73
  v_mul_f32 v74, s34, v74
  v_mul_f32 v75, s34, v75
  v_mul_f32 v88, s34, v88
  v_mul_f32 v89, s34, v89
  v_mul_f32 v90, s34, v90
  v_mul_f32 v91, s34, v91
  v_cvt_pk_bf16_f32 v168, v72, v73
  v_cvt_pk_bf16_f32 v169, v74, v75
  v_cvt_pk_bf16_f32 v170, v88, v89
  v_cvt_pk_bf16_f32 v171, v90, v91
  s_nop 0
  v_permlane16_swap_b32 v168, v170
  v_permlane16_swap_b32 v169, v171
  v_mul_f32 v76, s34, v76
  v_mul_f32 v77, s34, v77
  v_mul_f32 v78, s34, v78
  v_mul_f32 v79, s34, v79
  v_mul_f32 v92, s34, v92
  v_mul_f32 v93, s34, v93
  v_mul_f32 v94, s34, v94
  v_mul_f32 v95, s34, v95
  v_cvt_pk_bf16_f32 v184, v76, v77
  v_cvt_pk_bf16_f32 v185, v78, v79
  v_cvt_pk_bf16_f32 v186, v92, v93
  v_cvt_pk_bf16_f32 v187, v94, v95
  s_nop 0
  v_permlane16_swap_b32 v184, v186
  v_permlane16_swap_b32 v185, v187
  v_mul_f32 v96, s34, v96
  v_mul_f32 v97, s34, v97
  v_mul_f32 v98, s34, v98
  v_mul_f32 v99, s34, v99
  v_mul_f32 v112, s34, v112
  v_mul_f32 v113, s34, v113
  v_mul_f32 v114, s34, v114
  v_mul_f32 v115, s34, v115
  v_cvt_pk_bf16_f32 v140, v96, v97
  v_cvt_pk_bf16_f32 v141, v98, v99
  v_cvt_pk_bf16_f32 v142, v112, v113
  v_cvt_pk_bf16_f32 v143, v114, v115
  s_nop 0
  v_permlane16_swap_b32 v140, v142
  v_permlane16_swap_b32 v141, v143
  v_mul_f32 v100, s34, v100
  v_mul_f32 v101, s34, v101
  v_mul_f32 v102, s34, v102
  v_mul_f32 v103, s34, v103
  v_mul_f32 v116, s34, v116
  v_mul_f32 v117, s34, v117
  v_mul_f32 v118, s34, v118
  v_mul_f32 v119, s34, v119
  v_cvt_pk_bf16_f32 v156, v100, v101
  v_cvt_pk_bf16_f32 v157, v102, v103
  v_cvt_pk_bf16_f32 v158, v116, v117
  v_cvt_pk_bf16_f32 v159, v118, v119
  s_nop 0
  v_permlane16_swap_b32 v156, v158
  v_permlane16_swap_b32 v157, v159
  v_mul_f32 v104, s34, v104
  v_mul_f32 v105, s34, v105
  v_mul_f32 v106, s34, v106
  v_mul_f32 v107, s34, v107
  v_mul_f32 v120, s34, v120
  v_mul_f32 v121, s34, v121
  v_mul_f32 v122, s34, v122
  v_mul_f32 v123, s34, v123
  v_cvt_pk_bf16_f32 v172, v104, v105
  v_cvt_pk_bf16_f32 v173, v106, v107
  v_cvt_pk_bf16_f32 v174, v120, v121
  v_cvt_pk_bf16_f32 v175, v122, v123
  s_nop 0
  v_permlane16_swap_b32 v172, v174
  v_permlane16_swap_b32 v173, v175
  v_mul_f32 v108, s34, v108
  v_mul_f32 v109, s34, v109
  v_mul_f32 v110, s34, v110
  v_mul_f32 v111, s34, v111
  v_mul_f32 v124, s34, v124
  v_mul_f32 v125, s34, v125
  v_mul_f32 v126, s34, v126
  v_mul_f32 v127, s34, v127
  v_cvt_pk_bf16_f32 v188, v108, v109
  v_cvt_pk_bf16_f32 v189, v110, v111
  v_cvt_pk_bf16_f32 v190, v124, v125
  v_cvt_pk_bf16_f32 v191, v126, v127
  s_nop 0
  v_permlane16_swap_b32 v188, v190
  v_permlane16_swap_b32 v189, v191
  v_accvgpr_write_b32 a0, 0
  v_accvgpr_write_b32 a1, 0
  v_accvgpr_write_b32 a2, 0
  v_accvgpr_write_b32 a3, 0
  v_accvgpr_write_b32 a4, 0
  v_accvgpr_write_b32 a5, 0
  v_accvgpr_write_b32 a6, 0
  v_accvgpr_write_b32 a7, 0
  v_accvgpr_write_b32 a8, 0
  v_accvgpr_write_b32 a9, 0
  v_accvgpr_write_b32 a10, 0
  v_accvgpr_write_b32 a11, 0
  v_accvgpr_write_b32 a12, 0
  v_accvgpr_write_b32 a13, 0
  v_accvgpr_write_b32 a14, 0
  v_accvgpr_write_b32 a15, 0
  v_accvgpr_write_b32 a16, 0
  v_accvgpr_write_b32 a17, 0
  v_accvgpr_write_b32 a18, 0
  v_accvgpr_write_b32 a19, 0
  v_accvgpr_write_b32 a20, 0
  v_accvgpr_write_b32 a21, 0
  v_accvgpr_write_b32 a22, 0
  v_accvgpr_write_b32 a23, 0
  v_accvgpr_write_b32 a24, 0
  v_accvgpr_write_b32 a25, 0
  v_accvgpr_write_b32 a26, 0
  v_accvgpr_write_b32 a27, 0
  v_accvgpr_write_b32 a28, 0
  v_accvgpr_write_b32 a29, 0
  v_accvgpr_write_b32 a30, 0
  v_accvgpr_write_b32 a31, 0
  v_accvgpr_write_b32 a32, 0
  v_accvgpr_write_b32 a33, 0
  v_accvgpr_write_b32 a34, 0
  v_accvgpr_write_b32 a35, 0
  v_accvgpr_write_b32 a36, 0
  v_accvgpr_write_b32 a37, 0
  v_accvgpr_write_b32 a38, 0
  v_accvgpr_write_b32 a39, 0
  v_accvgpr_write_b32 a40, 0
  v_accvgpr_write_b32 a41, 0
  v_accvgpr_write_b32 a42, 0
  v_accvgpr_write_b32 a43, 0
  v_accvgpr_write_b32 a44, 0
  v_accvgpr_write_b32 a45, 0
  v_accvgpr_write_b32 a46, 0
  v_accvgpr_write_b32 a47, 0
  v_accvgpr_write_b32 a48, 0
  v_accvgpr_write_b32 a49, 0
  v_accvgpr_write_b32 a50, 0
  v_accvgpr_write_b32 a51, 0
  v_accvgpr_write_b32 a52, 0
  v_accvgpr_write_b32 a53, 0
  v_accvgpr_write_b32 a54, 0
  v_accvgpr_write_b32 a55, 0
  v_accvgpr_write_b32 a56, 0
  v_accvgpr_write_b32 a57, 0
  v_accvgpr_write_b32 a58, 0
  v_accvgpr_write_b32 a59, 0
  v_accvgpr_write_b32 a60, 0
  v_accvgpr_write_b32 a61, 0
  v_accvgpr_write_b32 a62, 0
  v_accvgpr_write_b32 a63, 0
  v_accvgpr_write_b32 a64, 0
  v_accvgpr_write_b32 a65, 0
  v_accvgpr_write_b32 a66, 0
  v_accvgpr_write_b32 a67, 0
  v_accvgpr_write_b32 a68, 0
  v_accvgpr_write_b32 a69, 0
  v_accvgpr_write_b32 a70, 0
  v_accvgpr_write_b32 a71, 0
  v_accvgpr_write_b32 a72, 0
  v_accvgpr_write_b32 a73, 0
  v_accvgpr_write_b32 a74, 0
  v_accvgpr_write_b32 a75, 0
  v_accvgpr_write_b32 a76, 0
  v_accvgpr_write_b32 a77, 0
  v_accvgpr_write_b32 a78, 0
  v_accvgpr_write_b32 a79, 0
  v_accvgpr_write_b32 a80, 0
  v_accvgpr_write_b32 a81, 0
  v_accvgpr_write_b32 a82, 0
  v_accvgpr_write_b32 a83, 0
  v_accvgpr_write_b32 a84, 0
  v_accvgpr_write_b32 a85, 0
  v_accvgpr_write_b32 a86, 0
  v_accvgpr_write_b32 a87, 0
  v_accvgpr_write_b32 a88, 0
  v_accvgpr_write_b32 a89, 0
  v_accvgpr_write_b32 a90, 0
  v_accvgpr_write_b32 a91, 0
  v_accvgpr_write_b32 a92, 0
  v_accvgpr_write_b32 a93, 0
  v_accvgpr_write_b32 a94, 0
  v_accvgpr_write_b32 a95, 0
  v_accvgpr_write_b32 a96, 0
  v_accvgpr_write_b32 a97, 0
  v_accvgpr_write_b32 a98, 0
  v_accvgpr_write_b32 a99, 0
  v_accvgpr_write_b32 a100, 0
  v_accvgpr_write_b32 a101, 0
  v_accvgpr_write_b32 a102, 0
  v_accvgpr_write_b32 a103, 0
  v_accvgpr_write_b32 a104, 0
  v_accvgpr_write_b32 a105, 0
  v_accvgpr_write_b32 a106, 0
  v_accvgpr_write_b32 a107, 0
  v_accvgpr_write_b32 a108, 0
  v_accvgpr_write_b32 a109, 0
  v_accvgpr_write_b32 a110, 0
  v_accvgpr_write_b32 a111, 0
  v_accvgpr_write_b32 a112, 0
  v_accvgpr_write_b32 a113, 0
  v_accvgpr_write_b32 a114, 0
  v_accvgpr_write_b32 a115, 0
  v_accvgpr_write_b32 a116, 0
  v_accvgpr_write_b32 a117, 0
  v_accvgpr_write_b32 a118, 0
  v_accvgpr_write_b32 a119, 0
  v_accvgpr_write_b32 a120, 0
  v_accvgpr_write_b32 a121, 0
  v_accvgpr_write_b32 a122, 0
  v_accvgpr_write_b32 a123, 0
  v_accvgpr_write_b32 a124, 0
  v_accvgpr_write_b32 a125, 0
  v_accvgpr_write_b32 a126, 0
  v_accvgpr_write_b32 a127, 0
  v_mov_b32 v208, 0
  v_mov_b32 v249, 0xff800000
  v_mov_b32 v209, 0
  v_mov_b32 v250, 0xff800000
  v_mov_b32 v210, 0
  v_mov_b32 v251, 0xff800000
  v_mov_b32 v211, 0
  v_mov_b32 v252, 0xff800000
  s_mov_b32 s29, 0
attn_slow:
  s_barrier
  s_add_u32 m0, s28, 49152
  s_nop 0
  buffer_load_dwordx4 v232, s[12:15], s29 offen offset:0 lds
  buffer_load_dwordx4 v233, s[12:15], s29 offen offset:1024 lds
  buffer_load_dwordx4 v234, s[12:15], s29 offen offset:2048 lds
  buffer_load_dwordx4 v235, s[12:15], s29 offen offset:3072 lds
  s_add_u32 m0, s28, 114688
  s_nop 0
  buffer_load_dwordx4 v236, s[16:19], s29 offen offset:0 lds
  buffer_load_dwordx4 v237, s[16:19], s29 offen offset:1024 lds
  buffer_load_dwordx4 v236, s[16:19], s29 offen offset:2048 lds
  buffer_load_dwordx4 v237, s[16:19], s29 offen offset:3072 lds
  s_waitcnt vmcnt(0)
  s_barrier
  ds_read_b128 a[128:131], v212 offset:49152
  ds_read_b128 a[132:135], v213 offset:49152
  ds_read_b128 a[136:139], v214 offset:49152
  ds_read_b128 a[140:143], v215 offset:49152
  s_waitcnt lgkmcnt(3)
  v_mfma_f32_16x16x32_bf16 v[0:3], a[128:131], v[128:131], 0
  s_waitcnt lgkmcnt(2)
  v_mfma_f32_16x16x32_bf16 v[0:3], a[132:135], v[132:135], v[0:3]
  s_waitcnt lgkmcnt(1)
  v_mfma_f32_16x16x32_bf16 v[0:3], a[136:139], v[136:139], v[0:3]
  s_waitcnt lgkmcnt(0)
  v_mfma_f32_16x16x32_bf16 v[0:3], a[140:143], v[140:143], v[0:3]
  v_mfma_f32_16x16x32_bf16 v[8:11], a[140:143], v[156:159], 0
  v_mfma_f32_16x16x32_bf16 v[8:11], a[136:139], v[152:155], v[8:11]
  v_mfma_f32_16x16x32_bf16 v[8:11], a[132:135], v[148:151], v[8:11]
  v_mfma_f32_16x16x32_bf16 v[8:11], a[128:131], v[144:147], v[8:11]
  v_mfma_f32_16x16x32_bf16 v[16:19], a[128:131], v[160:163], 0
  v_mfma_f32_16x16x32_bf16 v[16:19], a[132:135], v[164:167], v[16:19]
  v_mfma_f32_16x16x32_bf16 v[16:19], a[136:139], v[168:171], v[16:19]
  v_mfma_f32_16x16x32_bf16 v[16:19], a[140:143], v[172:175], v[16:19]
  v_mfma_f32_16x16x32_bf16 v[24:27], a[140:143], v[188:191], 0
  v_mfma_f32_16x16x32_bf16 v[24:27], a[136:139], v[184:187], v[24:27]
  v_mfma_f32_16x16x32_bf16 v[24:27], a[132:135], v[180:183], v[24:27]
  v_mfma_f32_16x16x32_bf16 v[24:27], a[128:131], v[176:179], v[24:27]
  ds_read_b128 a[144:147], v212 offset:53248
  ds_read_b128 a[148:151], v213 offset:53248
  ds_read_b128 a[152:155], v214 offset:53248
  ds_read_b128 a[156:159], v215 offset:53248
  s_waitcnt lgkmcnt(3)
  v_mfma_f32_16x16x32_bf16 v[4:7], a[144:147], v[128:131], 0
  s_waitcnt lgkmcnt(2)
  v_mfma_f32_16x16x32_bf16 v[4:7], a[148:151], v[132:135], v[4:7]
  s_waitcnt lgkmcnt(1)
  v_mfma_f32_16x16x32_bf16 v[4:7], a[152:155], v[136:139], v[4:7]
  s_waitcnt lgkmcnt(0)
  v_mfma_f32_16x16x32_bf16 v[4:7], a[156:159], v[140:143], v[4:7]
  v_mfma_f32_16x16x32_bf16 v[12:15], a[156:159], v[156:159], 0
  v_mfma_f32_16x16x32_bf16 v[12:15], a[152:155], v[152:155], v[12:15]
  v_mfma_f32_16x16x32_bf16 v[12:15], a[148:151], v[148:151], v[12:15]
  v_mfma_f32_16x16x32_bf16 v[12:15], a[144:147], v[144:147], v[12:15]
  v_mfma_f32_16x16x32_bf16 v[20:23], a[144:147], v[160:163], 0
  v_mfma_f32_16x16x32_bf16 v[20:23], a[148:151], v[164:167], v[20:23]
  v_mfma_f32_16x16x32_bf16 v[20:23], a[152:155], v[168:171], v[20:23]
  v_mfma_f32_16x16x32_bf16 v[20:23], a[156:159], v[172:175], v[20:23]
  v_mfma_f32_16x16x32_bf16 v[28:31], a[156:159], v[188:191], 0
  v_mfma_f32_16x16x32_bf16 v[28:31], a[152:155], v[184:187], v[28:31]
  v_mfma_f32_16x16x32_bf16 v[28:31], a[148:151], v[180:183], v[28:31]
  v_mfma_f32_16x16x32_bf16 v[28:31], a[144:147], v[176:179], v[28:31]
  ds_read_b128 a[128:131], v212 offset:57344
  ds_read_b128 a[132:135], v213 offset:57344
  ds_read_b128 a[136:139], v214 offset:57344
  ds_read_b128 a[140:143], v215 offset:57344
  s_waitcnt lgkmcnt(3)
  v_mfma_f32_16x16x32_bf16 v[32:35], a[128:131], v[128:131], 0
  s_waitcnt lgkmcnt(2)
  v_mfma_f32_16x16x32_bf16 v[32:35], a[132:135], v[132:135], v[32:35]
  s_waitcnt lgkmcnt(1)
  v_mfma_f32_16x16x32_bf16 v[32:35], a[136:139], v[136:139], v[32:35]
  s_waitcnt lgkmcnt(0)
  v_mfma_f32_16x16x32_bf16 v[32:35], a[140:143], v[140:143], v[32:35]
  v_mfma_f32_16x16x32_bf16 v[40:43], a[140:143], v[156:159], 0
  v_mfma_f32_16x16x32_bf16 v[40:43], a[136:139], v[152:155], v[40:43]
  v_mfma_f32_16x16x32_bf16 v[40:43], a[132:135], v[148:151], v[40:43]
  v_mfma_f32_16x16x32_bf16 v[40:43], a[128:131], v[144:147], v[40:43]
  v_mfma_f32_16x16x32_bf16 v[48:51], a[128:131], v[160:163], 0
  v_mfma_f32_16x16x32_bf16 v[48:51], a[132:135], v[164:167], v[48:51]
  v_mfma_f32_16x16x32_bf16 v[48:51], a[136:139], v[168:171], v[48:51]
  v_mfma_f32_16x16x32_bf16 v[48:51], a[140:143], v[172:175], v[48:51]
  v_mfma_f32_16x16x32_bf16 v[56:59], a[140:143], v[188:191], 0
  v_mfma_f32_16x16x32_bf16 v[56:59], a[136:139], v[184:187], v[56:59]
  v_mfma_f32_16x16x32_bf16 v[56:59], a[132:135], v[180:183], v[56:59]
  v_mfma_f32_16x16x32_bf16 v[56:59], a[128:131], v[176:179], v[56:59]
  ds_read_b128 a[144:147], v212 offset:61440
  ds_read_b128 a[148:151], v213 offset:61440
  ds_read_b128 a[152:155], v214 offset:61440
  ds_read_b128 a[156:159], v215 offset:61440
  s_waitcnt lgkmcnt(3)
  v_mfma_f32_16x16x32_bf16 v[36:39], a[144:147], v[128:131], 0
  s_waitcnt lgkmcnt(2)
  v_mfma_f32_16x16x32_bf16 v[36:39], a[148:151], v[132:135], v[36:39]
  s_waitcnt lgkmcnt(1)
  v_mfma_f32_16x16x32_bf16 v[36:39], a[152:155], v[136:139], v[36:39]
  s_waitcnt lgkmcnt(0)
  v_mfma_f32_16x16x32_bf16 v[36:39], a[156:159], v[140:143], v[36:39]
  v_mfma_f32_16x16x32_bf16 v[44:47], a[156:159], v[156:159], 0
  v_mfma_f32_16x16x32_bf16 v[44:47], a[152:155], v[152:155], v[44:47]
  v_mfma_f32_16x16x32_bf16 v[44:47], a[148:151], v[148:151], v[44:47]
  v_mfma_f32_16x16x32_bf16 v[44:47], a[144:147], v[144:147], v[44:47]
  v_mfma_f32_16x16x32_bf16 v[52:55], a[144:147], v[160:163], 0
  v_mfma_f32_16x16x32_bf16 v[52:55], a[148:151], v[164:167], v[52:55]
  v_mfma_f32_16x16x32_bf16 v[52:55], a[152:155], v[168:171], v[52:55]
  v_mfma_f32_16x16x32_bf16 v[52:55], a[156:159], v[172:175], v[52:55]
  v_mfma_f32_16x16x32_bf16 v[60:63], a[156:159], v[188:191], 0
  v_mfma_f32_16x16x32_bf16 v[60:63], a[152:155], v[184:187], v[60:63]
  v_mfma_f32_16x16x32_bf16 v[60:63], a[148:151], v[180:183], v[60:63]
  v_mfma_f32_16x16x32_bf16 v[60:63], a[144:147], v[176:179], v[60:63]
  v_mov_b32 v192, v249
  v_max3_f32 v192, v192, v0, v1
  v_max3_f32 v192, v192, v2, v3
  v_max3_f32 v192, v192, v4, v5
  v_max3_f32 v192, v192, v6, v7
  v_max3_f32 v192, v192, v32, v33
  v_max3_f32 v192, v192, v34, v35
  v_max3_f32 v192, v192, v36, v37
  v_max3_f32 v192, v192, v38, v39
  v_mov_b32 v245, v192
  s_nop 1
  v_permlane16_swap_b32 v192, v245
  v_max_f32 v192, v192, v245
  v_mov_b32 v245, v192
  s_nop 1
  v_permlane32_swap_b32 v192, v245
  v_max_f32 v192, v192, v245
  v_sub_f32 v193, v249, v192
  v_exp_f32 v193, v193
  v_mov_b32 v249, v192
  v_mul_f32 v208, v208, v193
  v_sub_f32 v0, v0, v192
  v_sub_f32 v1, v1, v192
  v_sub_f32 v2, v2, v192
  v_sub_f32 v3, v3, v192
  v_sub_f32 v4, v4, v192
  v_sub_f32 v5, v5, v192
  v_sub_f32 v6, v6, v192
  v_sub_f32 v7, v7, v192
  v_sub_f32 v32, v32, v192
  v_sub_f32 v33, v33, v192
  v_sub_f32 v34, v34, v192
  v_sub_f32 v35, v35, v192
  v_sub_f32 v36, v36, v192
  v_sub_f32 v37, v37, v192
  v_sub_f32 v38, v38, v192
  v_sub_f32 v39, v39, v192
  v_exp_f32 v0, v0
  v_exp_f32 v1, v1
  v_add_f32 v208, v208, v0
  v_exp_f32 v2, v2
  v_add_f32 v208, v208, v1
  v_cvt_pk_bf16_f32 v0, v0, v1
  v_exp_f32 v3, v3
  v_add_f32 v208, v208, v2
  v_add_f32 v208, v208, v3
  v_cvt_pk_bf16_f32 v1, v2, v3
  v_exp_f32 v4, v4
  v_exp_f32 v5, v5
  v_add_f32 v208, v208, v4
  v_exp_f32 v6, v6
  v_add_f32 v208, v208, v5
  v_cvt_pk_bf16_f32 v2, v4, v5
  v_exp_f32 v7, v7
  v_add_f32 v208, v208, v6
  v_add_f32 v208, v208, v7
  v_cvt_pk_bf16_f32 v3, v6, v7
  v_exp_f32 v32, v32
  v_exp_f32 v33, v33
  v_add_f32 v208, v208, v32
  v_exp_f32 v34, v34
  v_add_f32 v208, v208, v33
  v_cvt_pk_bf16_f32 v32, v32, v33
  v_exp_f32 v35, v35
  v_add_f32 v208, v208, v34
  v_add_f32 v208, v208, v35
  v_cvt_pk_bf16_f32 v33, v34, v35
  v_exp_f32 v36, v36
  v_exp_f32 v37, v37
  v_add_f32 v208, v208, v36
  v_exp_f32 v38, v38
  v_add_f32 v208, v208, v37
  v_cvt_pk_bf16_f32 v34, v36, v37
  v_exp_f32 v39, v39
  v_add_f32 v208, v208, v38
  v_add_f32 v208, v208, v39
  v_cvt_pk_bf16_f32 v35, v38, v39
  v_accvgpr_read_b32 v64, a0
  v_accvgpr_read_b32 v65, a1
  v_accvgpr_read_b32 v66, a2
  v_accvgpr_read_b32 v67, a3
  v_mul_f32 v64, v64, v193
  v_mul_f32 v65, v65, v193
  v_mul_f32 v66, v66, v193
  v_mul_f32 v67, v67, v193
  v_accvgpr_write_b32 a0, v64
  v_accvgpr_write_b32 a1, v65
  v_accvgpr_write_b32 a2, v66
  v_accvgpr_write_b32 a3, v67
  v_accvgpr_read_b32 v64, a16
  v_accvgpr_read_b32 v65, a17
  v_accvgpr_read_b32 v66, a18
  v_accvgpr_read_b32 v67, a19
  v_mul_f32 v64, v64, v193
  v_mul_f32 v65, v65, v193
  v_mul_f32 v66, v66, v193
  v_mul_f32 v67, v67, v193
  v_accvgpr_write_b32 a16, v64
  v_accvgpr_write_b32 a17, v65
  v_accvgpr_write_b32 a18, v66
  v_accvgpr_write_b32 a19, v67
  v_accvgpr_read_b32 v64, a32
  v_accvgpr_read_b32 v65, a33
  v_accvgpr_read_b32 v66, a34
  v_accvgpr_read_b32 v67, a35
  v_mul_f32 v64, v64, v193
  v_mul_f32 v65, v65, v193
  v_mul_f32 v66, v66, v193
  v_mul_f32 v67, v67, v193
  v_accvgpr_write_b32 a32, v64
  v_accvgpr_write_b32 a33, v65
  v_accvgpr_write_b32 a34, v66
  v_accvgpr_write_b32 a35, v67
  v_accvgpr_read_b32 v64, a48
  v_accvgpr_read_b32 v65, a49
  v_accvgpr_read_b32 v66, a50
  v_accvgpr_read_b32 v67, a51
  v_mul_f32 v64, v64, v193
  v_mul_f32 v65, v65, v193
  v_mul_f32 v66, v66, v193
  v_mul_f32 v67, v67, v193
  v_accvgpr_write_b32 a48, v64
  v_accvgpr_write_b32 a49, v65
  v_accvgpr_write_b32 a50, v66
  v_accvgpr_write_b32 a51, v67
  v_accvgpr_read_b32 v64, a64
  v_accvgpr_read_b32 v65, a65
  v_accvgpr_read_b32 v66, a66
  v_accvgpr_read_b32 v67, a67
  v_mul_f32 v64, v64, v193
  v_mul_f32 v65, v65, v193
  v_mul_f32 v66, v66, v193
  v_mul_f32 v67, v67, v193
  v_accvgpr_write_b32 a64, v64
  v_accvgpr_write_b32 a65, v65
  v_accvgpr_write_b32 a66, v66
  v_accvgpr_write_b32 a67, v67
  v_accvgpr_read_b32 v64, a80
  v_accvgpr_read_b32 v65, a81
  v_accvgpr_read_b32 v66, a82
  v_accvgpr_read_b32 v67, a83
  v_mul_f32 v64, v64, v193
  v_mul_f32 v65, v65, v193
  v_mul_f32 v66, v66, v193
  v_mul_f32 v67, v67, v193
  v_accvgpr_write_b32 a80, v64
  v_accvgpr_write_b32 a81, v65
  v_accvgpr_write_b32 a82, v66
  v_accvgpr_write_b32 a83, v67
  v_accvgpr_read_b32 v64, a96
  v_accvgpr_read_b32 v65, a97
  v_accvgpr_read_b32 v66, a98
  v_accvgpr_read_b32 v67, a99
  v_mul_f32 v64, v64, v193
  v_mul_f32 v65, v65, v193
  v_mul_f32 v66, v66, v193
  v_mul_f32 v67, v67, v193
  v_accvgpr_write_b32 a96, v64
  v_accvgpr_write_b32 a97, v65
  v_accvgpr_write_b32 a98, v66
  v_accvgpr_write_b32 a99, v67
  v_accvgpr_read_b32 v64, a112
  v_accvgpr_read_b32 v65, a113
  v_accvgpr_read_b32 v66, a114
  v_accvgpr_read_b32 v67, a115
  v_mul_f32 v64, v64, v193
  v_mul_f32 v65, v65, v193
  v_mul_f32 v66, v66, v193
  v_mul_f32 v67, v67, v193
  v_accvgpr_write_b32 a112, v64
  v_accvgpr_write_b32 a113, v65
  v_accvgpr_write_b32 a114, v66
  v_accvgpr_write_b32 a115, v67
  v_mov_b32 v196, v250
  v_max3_f32 v196, v196, v8, v9
  v_max3_f32 v196, v196, v10, v11
  v_max3_f32 v196, v196, v12, v13
  v_max3_f32 v196, v196, v14, v15
  v_max3_f32 v196, v196, v40, v41
  v_max3_f32 v196, v196, v42, v43
  v_max3_f32 v196, v196, v44, v45
  v_max3_f32 v196, v196, v46, v47
  v_mov_b32 v245, v196
  s_nop 1
  v_permlane16_swap_b32 v196, v245
  v_max_f32 v196, v196, v245
  v_mov_b32 v245, v196
  s_nop 1
  v_permlane32_swap_b32 v196, v245
  v_max_f32 v196, v196, v245
  v_sub_f32 v197, v250, v196
  v_exp_f32 v197, v197
  v_mov_b32 v250, v196
  v_mul_f32 v209, v209, v197
  v_sub_f32 v8, v8, v196
  v_sub_f32 v9, v9, v196
  v_sub_f32 v10, v10, v196
  v_sub_f32 v11, v11, v196
  v_sub_f32 v12, v12, v196
  v_sub_f32 v13, v13, v196
  v_sub_f32 v14, v14, v196
  v_sub_f32 v15, v15, v196
  v_sub_f32 v40, v40, v196
  v_sub_f32 v41, v41, v196
  v_sub_f32 v42, v42, v196
  v_sub_f32 v43, v43, v196
  v_sub_f32 v44, v44, v196
  v_sub_f32 v45, v45, v196
  v_sub_f32 v46, v46, v196
  v_sub_f32 v47, v47, v196
  v_exp_f32 v8, v8
  v_exp_f32 v9, v9
  v_add_f32 v209, v209, v8
  v_exp_f32 v10, v10
  v_add_f32 v209, v209, v9
  v_cvt_pk_bf16_f32 v8, v8, v9
  v_exp_f32 v11, v11
  v_add_f32 v209, v209, v10
  v_add_f32 v209, v209, v11
  v_cvt_pk_bf16_f32 v9, v10, v11
  v_exp_f32 v12, v12
  v_exp_f32 v13, v13
  v_add_f32 v209, v209, v12
  v_exp_f32 v14, v14
  v_add_f32 v209, v209, v13
  v_cvt_pk_bf16_f32 v10, v12, v13
  v_exp_f32 v15, v15
  v_add_f32 v209, v209, v14
  v_add_f32 v209, v209, v15
  v_cvt_pk_bf16_f32 v11, v14, v15
  v_exp_f32 v40, v40
  v_exp_f32 v41, v41
  v_add_f32 v209, v209, v40
  v_exp_f32 v42, v42
  v_add_f32 v209, v209, v41
  v_cvt_pk_bf16_f32 v40, v40, v41
  v_exp_f32 v43, v43
  v_add_f32 v209, v209, v42
  v_add_f32 v209, v209, v43
  v_cvt_pk_bf16_f32 v41, v42, v43
  v_exp_f32 v44, v44
  v_exp_f32 v45, v45
  v_add_f32 v209, v209, v44
  v_exp_f32 v46, v46
  v_add_f32 v209, v209, v45
  v_cvt_pk_bf16_f32 v42, v44, v45
  v_exp_f32 v47, v47
  v_add_f32 v209, v209, v46
  v_add_f32 v209, v209, v47
  v_cvt_pk_bf16_f32 v43, v46, v47
  v_accvgpr_read_b32 v64, a4
  v_accvgpr_read_b32 v65, a5
  v_accvgpr_read_b32 v66, a6
  v_accvgpr_read_b32 v67, a7
  v_mul_f32 v64, v64, v197
  v_mul_f32 v65, v65, v197
  v_mul_f32 v66, v66, v197
  v_mul_f32 v67, v67, v197
  v_accvgpr_write_b32 a4, v64
  v_accvgpr_write_b32 a5, v65
  v_accvgpr_write_b32 a6, v66
  v_accvgpr_write_b32 a7, v67
  v_accvgpr_read_b32 v64, a20
  v_accvgpr_read_b32 v65, a21
  v_accvgpr_read_b32 v66, a22
  v_accvgpr_read_b32 v67, a23
  v_mul_f32 v64, v64, v197
  v_mul_f32 v65, v65, v197
  v_mul_f32 v66, v66, v197
  v_mul_f32 v67, v67, v197
  v_accvgpr_write_b32 a20, v64
  v_accvgpr_write_b32 a21, v65
  v_accvgpr_write_b32 a22, v66
  v_accvgpr_write_b32 a23, v67
  v_accvgpr_read_b32 v64, a36
  v_accvgpr_read_b32 v65, a37
  v_accvgpr_read_b32 v66, a38
  v_accvgpr_read_b32 v67, a39
  v_mul_f32 v64, v64, v197
  v_mul_f32 v65, v65, v197
  v_mul_f32 v66, v66, v197
  v_mul_f32 v67, v67, v197
  v_accvgpr_write_b32 a36, v64
  v_accvgpr_write_b32 a37, v65
  v_accvgpr_write_b32 a38, v66
  v_accvgpr_write_b32 a39, v67
  v_accvgpr_read_b32 v64, a52
  v_accvgpr_read_b32 v65, a53
  v_accvgpr_read_b32 v66, a54
  v_accvgpr_read_b32 v67, a55
  v_mul_f32 v64, v64, v197
  v_mul_f32 v65, v65, v197
  v_mul_f32 v66, v66, v197
  v_mul_f32 v67, v67, v197
  v_accvgpr_write_b32 a52, v64
  v_accvgpr_write_b32 a53, v65
  v_accvgpr_write_b32 a54, v66
  v_accvgpr_write_b32 a55, v67
  v_accvgpr_read_b32 v64, a68
  v_accvgpr_read_b32 v65, a69
  v_accvgpr_read_b32 v66, a70
  v_accvgpr_read_b32 v67, a71
  v_mul_f32 v64, v64, v197
  v_mul_f32 v65, v65, v197
  v_mul_f32 v66, v66, v197
  v_mul_f32 v67, v67, v197
  v_accvgpr_write_b32 a68, v64
  v_accvgpr_write_b32 a69, v65
  v_accvgpr_write_b32 a70, v66
  v_accvgpr_write_b32 a71, v67
  v_accvgpr_read_b32 v64, a84
  v_accvgpr_read_b32 v65, a85
  v_accvgpr_read_b32 v66, a86
  v_accvgpr_read_b32 v67, a87
  v_mul_f32 v64, v64, v197
  v_mul_f32 v65, v65, v197
  v_mul_f32 v66, v66, v197
  v_mul_f32 v67, v67, v197
  v_accvgpr_write_b32 a84, v64
  v_accvgpr_write_b32 a85, v65
  v_accvgpr_write_b32 a86, v66
  v_accvgpr_write_b32 a87, v67
  v_accvgpr_read_b32 v64, a100
  v_accvgpr_read_b32 v65, a101
  v_accvgpr_read_b32 v66, a102
  v_accvgpr_read_b32 v67, a103
  v_mul_f32 v64, v64, v197
  v_mul_f32 v65, v65, v197
  v_mul_f32 v66, v66, v197
  v_mul_f32 v67, v67, v197
  v_accvgpr_write_b32 a100, v64
  v_accvgpr_write_b32 a101, v65
  v_accvgpr_write_b32 a102, v66
  v_accvgpr_write_b32 a103, v67
  v_accvgpr_read_b32 v64, a116
  v_accvgpr_read_b32 v65, a117
  v_accvgpr_read_b32 v66, a118
  v_accvgpr_read_b32 v67, a119
  v_mul_f32 v64, v64, v197
  v_mul_f32 v65, v65, v197
  v_mul_f32 v66, v66, v197
  v_mul_f32 v67, v67, v197
  v_accvgpr_write_b32 a116, v64
  v_accvgpr_write_b32 a117, v65
  v_accvgpr_write_b32 a118, v66
  v_accvgpr_write_b32 a119, v67
  v_mov_b32 v200, v251
  v_max3_f32 v200, v200, v16, v17
  v_max3_f32 v200, v200, v18, v19
  v_max3_f32 v200, v200, v20, v21
  v_max3_f32 v200, v200, v22, v23
  v_max3_f32 v200, v200, v48, v49
  v_max3_f32 v200, v200, v50, v51
  v_max3_f32 v200, v200, v52, v53
  v_max3_f32 v200, v200, v54, v55
  v_mov_b32 v245, v200
  s_nop 1
  v_permlane16_swap_b32 v200, v245
  v_max_f32 v200, v200, v245
  v_mov_b32 v245, v200
  s_nop 1
  v_permlane32_swap_b32 v200, v245
  v_max_f32 v200, v200, v245
  v_sub_f32 v201, v251, v200
  v_exp_f32 v201, v201
  v_mov_b32 v251, v200
  v_mul_f32 v210, v210, v201
  v_sub_f32 v16, v16, v200
  v_sub_f32 v17, v17, v200
  v_sub_f32 v18, v18, v200
  v_sub_f32 v19, v19, v200
  v_sub_f32 v20, v20, v200
  v_sub_f32 v21, v21, v200
  v_sub_f32 v22, v22, v200
  v_sub_f32 v23, v23, v200
  v_sub_f32 v48, v48, v200
  v_sub_f32 v49, v49, v200
  v_sub_f32 v50, v50, v200
  v_sub_f32 v51, v51, v200
  v_sub_f32 v52, v52, v200
  v_sub_f32 v53, v53, v200
  v_sub_f32 v54, v54, v200
  v_sub_f32 v55, v55, v200
  v_exp_f32 v16, v16
  v_exp_f32 v17, v17
  v_add_f32 v210, v210, v16
  v_exp_f32 v18, v18
  v_add_f32 v210, v210, v17
  v_cvt_pk_bf16_f32 v16, v16, v17
  v_exp_f32 v19, v19
  v_add_f32 v210, v210, v18
  v_add_f32 v210, v210, v19
  v_cvt_pk_bf16_f32 v17, v18, v19
  v_exp_f32 v20, v20
  v_exp_f32 v21, v21
  v_add_f32 v210, v210, v20
  v_exp_f32 v22, v22
  v_add_f32 v210, v210, v21
  v_cvt_pk_bf16_f32 v18, v20, v21
  v_exp_f32 v23, v23
  v_add_f32 v210, v210, v22
  v_add_f32 v210, v210, v23
  v_cvt_pk_bf16_f32 v19, v22, v23
  v_exp_f32 v48, v48
  v_exp_f32 v49, v49
  v_add_f32 v210, v210, v48
  v_exp_f32 v50, v50
  v_add_f32 v210, v210, v49
  v_cvt_pk_bf16_f32 v48, v48, v49
  v_exp_f32 v51, v51
  v_add_f32 v210, v210, v50
  v_add_f32 v210, v210, v51
  v_cvt_pk_bf16_f32 v49, v50, v51
  v_exp_f32 v52, v52
  v_exp_f32 v53, v53
  v_add_f32 v210, v210, v52
  v_exp_f32 v54, v54
  v_add_f32 v210, v210, v53
  v_cvt_pk_bf16_f32 v50, v52, v53
  v_exp_f32 v55, v55
  v_add_f32 v210, v210, v54
  v_add_f32 v210, v210, v55
  v_cvt_pk_bf16_f32 v51, v54, v55
  v_accvgpr_read_b32 v64, a8
  v_accvgpr_read_b32 v65, a9
  v_accvgpr_read_b32 v66, a10
  v_accvgpr_read_b32 v67, a11
  v_mul_f32 v64, v64, v201
  v_mul_f32 v65, v65, v201
  v_mul_f32 v66, v66, v201
  v_mul_f32 v67, v67, v201
  v_accvgpr_write_b32 a8, v64
  v_accvgpr_write_b32 a9, v65
  v_accvgpr_write_b32 a10, v66
  v_accvgpr_write_b32 a11, v67
  v_accvgpr_read_b32 v64, a24
  v_accvgpr_read_b32 v65, a25
  v_accvgpr_read_b32 v66, a26
  v_accvgpr_read_b32 v67, a27
  v_mul_f32 v64, v64, v201
  v_mul_f32 v65, v65, v201
  v_mul_f32 v66, v66, v201
  v_mul_f32 v67, v67, v201
  v_accvgpr_write_b32 a24, v64
  v_accvgpr_write_b32 a25, v65
  v_accvgpr_write_b32 a26, v66
  v_accvgpr_write_b32 a27, v67
  v_accvgpr_read_b32 v64, a40
  v_accvgpr_read_b32 v65, a41
  v_accvgpr_read_b32 v66, a42
  v_accvgpr_read_b32 v67, a43
  v_mul_f32 v64, v64, v201
  v_mul_f32 v65, v65, v201
  v_mul_f32 v66, v66, v201
  v_mul_f32 v67, v67, v201
  v_accvgpr_write_b32 a40, v64
  v_accvgpr_write_b32 a41, v65
  v_accvgpr_write_b32 a42, v66
  v_accvgpr_write_b32 a43, v67
  v_accvgpr_read_b32 v64, a56
  v_accvgpr_read_b32 v65, a57
  v_accvgpr_read_b32 v66, a58
  v_accvgpr_read_b32 v67, a59
  v_mul_f32 v64, v64, v201
  v_mul_f32 v65, v65, v201
  v_mul_f32 v66, v66, v201
  v_mul_f32 v67, v67, v201
  v_accvgpr_write_b32 a56, v64
  v_accvgpr_write_b32 a57, v65
  v_accvgpr_write_b32 a58, v66
  v_accvgpr_write_b32 a59, v67
  v_accvgpr_read_b32 v64, a72
  v_accvgpr_read_b32 v65, a73
  v_accvgpr_read_b32 v66, a74
  v_accvgpr_read_b32 v67, a75
  v_mul_f32 v64, v64, v201
  v_mul_f32 v65, v65, v201
  v_mul_f32 v66, v66, v201
  v_mul_f32 v67, v67, v201
  v_accvgpr_write_b32 a72, v64
  v_accvgpr_write_b32 a73, v65
  v_accvgpr_write_b32 a74, v66
  v_accvgpr_write_b32 a75, v67
  v_accvgpr_read_b32 v64, a88
  v_accvgpr_read_b32 v65, a89
  v_accvgpr_read_b32 v66, a90
  v_accvgpr_read_b32 v67, a91
  v_mul_f32 v64, v64, v201
  v_mul_f32 v65, v65, v201
  v_mul_f32 v66, v66, v201
  v_mul_f32 v67, v67, v201
  v_accvgpr_write_b32 a88, v64
  v_accvgpr_write_b32 a89, v65
  v_accvgpr_write_b32 a90, v66
  v_accvgpr_write_b32 a91, v67
  v_accvgpr_read_b32 v64, a104
  v_accvgpr_read_b32 v65, a105
  v_accvgpr_read_b32 v66, a106
  v_accvgpr_read_b32 v67, a107
  v_mul_f32 v64, v64, v201
  v_mul_f32 v65, v65, v201
  v_mul_f32 v66, v66, v201
  v_mul_f32 v67, v67, v201
  v_accvgpr_write_b32 a104, v64
  v_accvgpr_write_b32 a105, v65
  v_accvgpr_write_b32 a106, v66
  v_accvgpr_write_b32 a107, v67
  v_accvgpr_read_b32 v64, a120
  v_accvgpr_read_b32 v65, a121
  v_accvgpr_read_b32 v66, a122
  v_accvgpr_read_b32 v67, a123
  v_mul_f32 v64, v64, v201
  v_mul_f32 v65, v65, v201
  v_mul_f32 v66, v66, v201
  v_mul_f32 v67, v67, v201
  v_accvgpr_write_b32 a120, v64
  v_accvgpr_write_b32 a121, v65
  v_accvgpr_write_b32 a122, v66
  v_accvgpr_write_b32 a123, v67
  v_mov_b32 v204, v252
  v_max3_f32 v204, v204, v24, v25
  v_max3_f32 v204, v204, v26, v27
  v_max3_f32 v204, v204, v28, v29
  v_max3_f32 v204, v204, v30, v31
  v_max3_f32 v204, v204, v56, v57
  v_max3_f32 v204, v204, v58, v59
  v_max3_f32 v204, v204, v60, v61
  v_max3_f32 v204, v204, v62, v63
  v_mov_b32 v245, v204
  s_nop 1
  v_permlane16_swap_b32 v204, v245
  v_max_f32 v204, v204, v245
  v_mov_b32 v245, v204
  s_nop 1
  v_permlane32_swap_b32 v204, v245
  v_max_f32 v204, v204, v245
  v_sub_f32 v205, v252, v204
  v_exp_f32 v205, v205
  v_mov_b32 v252, v204
  v_mul_f32 v211, v211, v205
  v_sub_f32 v24, v24, v204
  v_sub_f32 v25, v25, v204
  v_sub_f32 v26, v26, v204
  v_sub_f32 v27, v27, v204
  v_sub_f32 v28, v28, v204
  v_sub_f32 v29, v29, v204
  v_sub_f32 v30, v30, v204
  v_sub_f32 v31, v31, v204
  v_sub_f32 v56, v56, v204
  v_sub_f32 v57, v57, v204
  v_sub_f32 v58, v58, v204
  v_sub_f32 v59, v59, v204
  v_sub_f32 v60, v60, v204
  v_sub_f32 v61, v61, v204
  v_sub_f32 v62, v62, v204
  v_sub_f32 v63, v63, v204
  v_exp_f32 v24, v24
  v_exp_f32 v25, v25
  v_add_f32 v211, v211, v24
  v_exp_f32 v26, v26
  v_add_f32 v211, v211, v25
  v_cvt_pk_bf16_f32 v24, v24, v25
  v_exp_f32 v27, v27
  v_add_f32 v211, v211, v26
  v_add_f32 v211, v211, v27
  v_cvt_pk_bf16_f32 v25, v26, v27
  v_exp_f32 v28, v28
  v_exp_f32 v29, v29
  v_add_f32 v211, v211, v28
  v_exp_f32 v30, v30
  v_add_f32 v211, v211, v29
  v_cvt_pk_bf16_f32 v26, v28, v29
  v_exp_f32 v31, v31
  v_add_f32 v211, v211, v30
  v_add_f32 v211, v211, v31
  v_cvt_pk_bf16_f32 v27, v30, v31
  v_exp_f32 v56, v56
  v_exp_f32 v57, v57
  v_add_f32 v211, v211, v56
  v_exp_f32 v58, v58
  v_add_f32 v211, v211, v57
  v_cvt_pk_bf16_f32 v56, v56, v57
  v_exp_f32 v59, v59
  v_add_f32 v211, v211, v58
  v_add_f32 v211, v211, v59
  v_cvt_pk_bf16_f32 v57, v58, v59
  v_exp_f32 v60, v60
  v_exp_f32 v61, v61
  v_add_f32 v211, v211, v60
  v_exp_f32 v62, v62
  v_add_f32 v211, v211, v61
  v_cvt_pk_bf16_f32 v58, v60, v61
  v_exp_f32 v63, v63
  v_add_f32 v211, v211, v62
  v_add_f32 v211, v211, v63
  v_cvt_pk_bf16_f32 v59, v62, v63
  v_accvgpr_read_b32 v64, a12
  v_accvgpr_read_b32 v65, a13
  v_accvgpr_read_b32 v66, a14
  v_accvgpr_read_b32 v67, a15
  v_mul_f32 v64, v64, v205
  v_mul_f32 v65, v65, v205
  v_mul_f32 v66, v66, v205
  v_mul_f32 v67, v67, v205
  v_accvgpr_write_b32 a12, v64
  v_accvgpr_write_b32 a13, v65
  v_accvgpr_write_b32 a14, v66
  v_accvgpr_write_b32 a15, v67
  v_accvgpr_read_b32 v64, a28
  v_accvgpr_read_b32 v65, a29
  v_accvgpr_read_b32 v66, a30
  v_accvgpr_read_b32 v67, a31
  v_mul_f32 v64, v64, v205
  v_mul_f32 v65, v65, v205
  v_mul_f32 v66, v66, v205
  v_mul_f32 v67, v67, v205
  v_accvgpr_write_b32 a28, v64
  v_accvgpr_write_b32 a29, v65
  v_accvgpr_write_b32 a30, v66
  v_accvgpr_write_b32 a31, v67
  v_accvgpr_read_b32 v64, a44
  v_accvgpr_read_b32 v65, a45
  v_accvgpr_read_b32 v66, a46
  v_accvgpr_read_b32 v67, a47
  v_mul_f32 v64, v64, v205
  v_mul_f32 v65, v65, v205
  v_mul_f32 v66, v66, v205
  v_mul_f32 v67, v67, v205
  v_accvgpr_write_b32 a44, v64
  v_accvgpr_write_b32 a45, v65
  v_accvgpr_write_b32 a46, v66
  v_accvgpr_write_b32 a47, v67
  v_accvgpr_read_b32 v64, a60
  v_accvgpr_read_b32 v65, a61
  v_accvgpr_read_b32 v66, a62
  v_accvgpr_read_b32 v67, a63
  v_mul_f32 v64, v64, v205
  v_mul_f32 v65, v65, v205
  v_mul_f32 v66, v66, v205
  v_mul_f32 v67, v67, v205
  v_accvgpr_write_b32 a60, v64
  v_accvgpr_write_b32 a61, v65
  v_accvgpr_write_b32 a62, v66
  v_accvgpr_write_b32 a63, v67
  v_accvgpr_read_b32 v64, a76
  v_accvgpr_read_b32 v65, a77
  v_accvgpr_read_b32 v66, a78
  v_accvgpr_read_b32 v67, a79
  v_mul_f32 v64, v64, v205
  v_mul_f32 v65, v65, v205
  v_mul_f32 v66, v66, v205
  v_mul_f32 v67, v67, v205
  v_accvgpr_write_b32 a76, v64
  v_accvgpr_write_b32 a77, v65
  v_accvgpr_write_b32 a78, v66
  v_accvgpr_write_b32 a79, v67
  v_accvgpr_read_b32 v64, a92
  v_accvgpr_read_b32 v65, a93
  v_accvgpr_read_b32 v66, a94
  v_accvgpr_read_b32 v67, a95
  v_mul_f32 v64, v64, v205
  v_mul_f32 v65, v65, v205
  v_mul_f32 v66, v66, v205
  v_mul_f32 v67, v67, v205
  v_accvgpr_write_b32 a92, v64
  v_accvgpr_write_b32 a93, v65
  v_accvgpr_write_b32 a94, v66
  v_accvgpr_write_b32 a95, v67
  v_accvgpr_read_b32 v64, a108
  v_accvgpr_read_b32 v65, a109
  v_accvgpr_read_b32 v66, a110
  v_accvgpr_read_b32 v67, a111
  v_mul_f32 v64, v64, v205
  v_mul_f32 v65, v65, v205
  v_mul_f32 v66, v66, v205
  v_mul_f32 v67, v67, v205
  v_accvgpr_write_b32 a108, v64
  v_accvgpr_write_b32 a109, v65
  v_accvgpr_write_b32 a110, v66
  v_accvgpr_write_b32 a111, v67
  v_accvgpr_read_b32 v64, a124
  v_accvgpr_read_b32 v65, a125
  v_accvgpr_read_b32 v66, a126
  v_accvgpr_read_b32 v67, a127
  v_mul_f32 v64, v64, v205
  v_mul_f32 v65, v65, v205
  v_mul_f32 v66, v66, v205
  v_mul_f32 v67, v67, v205
  v_accvgpr_write_b32 a124, v64
  v_accvgpr_write_b32 a125, v65
  v_accvgpr_write_b32 a126, v66
  v_accvgpr_write_b32 a127, v67
  ds_read_b64_tr_b16 a[160:161], v216 offset:49152
  ds_read_b64_tr_b16 a[162:163], v216 offset:53248
  ds_read_b64_tr_b16 a[164:165], v216 offset:57344
  ds_read_b64_tr_b16 a[166:167], v216 offset:61440
  s_waitcnt lgkmcnt(2)
  v_mfma_f32_16x16x32_bf16 a[0:3], a[160:163], v[0:3], a[0:3]
  s_waitcnt lgkmcnt(0)
  v_mfma_f32_16x16x32_bf16 a[0:3], a[164:167], v[32:35], a[0:3]
  v_mfma_f32_16x16x32_bf16 a[4:7], a[164:167], v[40:43], a[4:7]
  v_mfma_f32_16x16x32_bf16 a[4:7], a[160:163], v[8:11], a[4:7]
  v_mfma_f32_16x16x32_bf16 a[8:11], a[160:163], v[16:19], a[8:11]
  v_mfma_f32_16x16x32_bf16 a[8:11], a[164:167], v[48:51], a[8:11]
  v_mfma_f32_16x16x32_bf16 a[12:15], a[164:167], v[56:59], a[12:15]
  v_mfma_f32_16x16x32_bf16 a[12:15], a[160:163], v[24:27], a[12:15]
  ds_read_b64_tr_b16 a[168:169], v217 offset:49152
  ds_read_b64_tr_b16 a[170:171], v217 offset:53248
  ds_read_b64_tr_b16 a[172:173], v217 offset:57344
  ds_read_b64_tr_b16 a[174:175], v217 offset:61440
  s_waitcnt lgkmcnt(2)
  v_mfma_f32_16x16x32_bf16 a[16:19], a[168:171], v[0:3], a[16:19]
  s_waitcnt lgkmcnt(0)
  v_mfma_f32_16x16x32_bf16 a[16:19], a[172:175], v[32:35], a[16:19]
  v_mfma_f32_16x16x32_bf16 a[20:23], a[172:175], v[40:43], a[20:23]
  v_mfma_f32_16x16x32_bf16 a[20:23], a[168:171], v[8:11], a[20:23]
  v_mfma_f32_16x16x32_bf16 a[24:27], a[168:171], v[16:19], a[24:27]
  v_mfma_f32_16x16x32_bf16 a[24:27], a[172:175], v[48:51], a[24:27]
  v_mfma_f32_16x16x32_bf16 a[28:31], a[172:175], v[56:59], a[28:31]
  v_mfma_f32_16x16x32_bf16 a[28:31], a[168:171], v[24:27], a[28:31]
  ds_read_b64_tr_b16 a[176:177], v218 offset:49152
  ds_read_b64_tr_b16 a[178:179], v218 offset:53248
  ds_read_b64_tr_b16 a[180:181], v218 offset:57344
  ds_read_b64_tr_b16 a[182:183], v218 offset:61440
  s_waitcnt lgkmcnt(2)
  v_mfma_f32_16x16x32_bf16 a[32:35], a[176:179], v[0:3], a[32:35]
  s_waitcnt lgkmcnt(0)
  v_mfma_f32_16x16x32_bf16 a[32:35], a[180:183], v[32:35], a[32:35]
  v_mfma_f32_16x16x32_bf16 a[36:39], a[180:183], v[40:43], a[36:39]
  v_mfma_f32_16x16x32_bf16 a[36:39], a[176:179], v[8:11], a[36:39]
  v_mfma_f32_16x16x32_bf16 a[40:43], a[176:179], v[16:19], a[40:43]
  v_mfma_f32_16x16x32_bf16 a[40:43], a[180:183], v[48:51], a[40:43]
  v_mfma_f32_16x16x32_bf16 a[44:47], a[180:183], v[56:59], a[44:47]
  v_mfma_f32_16x16x32_bf16 a[44:47], a[176:179], v[24:27], a[44:47]
  ds_read_b64_tr_b16 a[184:185], v219 offset:49152
  ds_read_b64_tr_b16 a[186:187], v219 offset:53248
  ds_read_b64_tr_b16 a[188:189], v219 offset:57344
  ds_read_b64_tr_b16 a[190:191], v219 offset:61440
  s_waitcnt lgkmcnt(2)
  v_mfma_f32_16x16x32_bf16 a[48:51], a[184:187], v[0:3], a[48:51]
  s_waitcnt lgkmcnt(0)
  v_mfma_f32_16x16x32_bf16 a[48:51], a[188:191], v[32:35], a[48:51]
  v_mfma_f32_16x16x32_bf16 a[52:55], a[188:191], v[40:43], a[52:55]
  v_mfma_f32_16x16x32_bf16 a[52:55], a[184:187], v[8:11], a[52:55]
  v_mfma_f32_16x16x32_bf16 a[56:59], a[184:187], v[16:19], a[56:59]
  v_mfma_f32_16x16x32_bf16 a[56:59], a[188:191], v[48:51], a[56:59]
  v_mfma_f32_16x16x32_bf16 a[60:63], a[188:191], v[56:59], a[60:63]
  v_mfma_f32_16x16x32_bf16 a[60:63], a[184:187], v[24:27], a[60:63]
  ds_read_b64_tr_b16 a[160:161], v220 offset:49152
  ds_read_b64_tr_b16 a[162:163], v220 offset:53248
  ds_read_b64_tr_b16 a[164:165], v220 offset:57344
  ds_read_b64_tr_b16 a[166:167], v220 offset:61440
  s_waitcnt lgkmcnt(2)
  v_mfma_f32_16x16x32_bf16 a[64:67], a[160:163], v[0:3], a[64:67]
  s_waitcnt lgkmcnt(0)
  v_mfma_f32_16x16x32_bf16 a[64:67], a[164:167], v[32:35], a[64:67]
  v_mfma_f32_16x16x32_bf16 a[68:71], a[164:167], v[40:43], a[68:71]
  v_mfma_f32_16x16x32_bf16 a[68:71], a[160:163], v[8:11], a[68:71]
  v_mfma_f32_16x16x32_bf16 a[72:75], a[160:163], v[16:19], a[72:75]
  v_mfma_f32_16x16x32_bf16 a[72:75], a[164:167], v[48:51], a[72:75]
  v_mfma_f32_16x16x32_bf16 a[76:79], a[164:167], v[56:59], a[76:79]
  v_mfma_f32_16x16x32_bf16 a[76:79], a[160:163], v[24:27], a[76:79]
  ds_read_b64_tr_b16 a[168:169], v221 offset:49152
  ds_read_b64_tr_b16 a[170:171], v221 offset:53248
  ds_read_b64_tr_b16 a[172:173], v221 offset:57344
  ds_read_b64_tr_b16 a[174:175], v221 offset:61440
  s_waitcnt lgkmcnt(2)
  v_mfma_f32_16x16x32_bf16 a[80:83], a[168:171], v[0:3], a[80:83]
  s_waitcnt lgkmcnt(0)
  v_mfma_f32_16x16x32_bf16 a[80:83], a[172:175], v[32:35], a[80:83]
  v_mfma_f32_16x16x32_bf16 a[84:87], a[172:175], v[40:43], a[84:87]
  v_mfma_f32_16x16x32_bf16 a[84:87], a[168:171], v[8:11], a[84:87]
  v_mfma_f32_16x16x32_bf16 a[88:91], a[168:171], v[16:19], a[88:91]
  v_mfma_f32_16x16x32_bf16 a[88:91], a[172:175], v[48:51], a[88:91]
  v_mfma_f32_16x16x32_bf16 a[92:95], a[172:175], v[56:59], a[92:95]
  v_mfma_f32_16x16x32_bf16 a[92:95], a[168:171], v[24:27], a[92:95]
  ds_read_b64_tr_b16 a[176:177], v222 offset:49152
  ds_read_b64_tr_b16 a[178:179], v222 offset:53248
  ds_read_b64_tr_b16 a[180:181], v222 offset:57344
  ds_read_b64_tr_b16 a[182:183], v222 offset:61440
  s_waitcnt lgkmcnt(2)
  v_mfma_f32_16x16x32_bf16 a[96:99], a[176:179], v[0:3], a[96:99]
  s_waitcnt lgkmcnt(0)
  v_mfma_f32_16x16x32_bf16 a[96:99], a[180:183], v[32:35], a[96:99]
  v_mfma_f32_16x16x32_bf16 a[100:103], a[180:183], v[40:43], a[100:103]
  v_mfma_f32_16x16x32_bf16 a[100:103], a[176:179], v[8:11], a[100:103]
  v_mfma_f32_16x16x32_bf16 a[104:107], a[176:179], v[16:19], a[104:107]
  v_mfma_f32_16x16x32_bf16 a[104:107], a[180:183], v[48:51], a[104:107]
  v_mfma_f32_16x16x32_bf16 a[108:111], a[180:183], v[56:59], a[108:111]
  v_mfma_f32_16x16x32_bf16 a[108:111], a[176:179], v[24:27], a[108:111]
  ds_read_b64_tr_b16 a[184:185], v223 offset:49152
  ds_read_b64_tr_b16 a[186:187], v223 offset:53248
  ds_read_b64_tr_b16 a[188:189], v223 offset:57344
  ds_read_b64_tr_b16 a[190:191], v223 offset:61440
  s_waitcnt lgkmcnt(2)
  v_mfma_f32_16x16x32_bf16 a[112:115], a[184:187], v[0:3], a[112:115]
  s_waitcnt lgkmcnt(0)
  v_mfma_f32_16x16x32_bf16 a[112:115], a[188:191], v[32:35], a[112:115]
  v_mfma_f32_16x16x32_bf16 a[116:119], a[188:191], v[40:43], a[116:119]
  v_mfma_f32_16x16x32_bf16 a[116:119], a[184:187], v[8:11], a[116:119]
  v_mfma_f32_16x16x32_bf16 a[120:123], a[184:187], v[16:19], a[120:123]
  v_mfma_f32_16x16x32_bf16 a[120:123], a[188:191], v[48:51], a[120:123]
  v_mfma_f32_16x16x32_bf16 a[124:127], a[188:191], v[56:59], a[124:127]
  v_mfma_f32_16x16x32_bf16 a[124:127], a[184:187], v[24:27], a[124:127]
  s_add_u32 s29, s29, 16384
  s_cmp_lt_u32 s29, 524288
  s_cbranch_scc1 attn_slow
  v_mov_b32 v245, v208
  v_mov_b32 v246, v209
  v_mov_b32 v247, v210
  v_mov_b32 v248, v211
  v_permlane16_swap_b32 v208, v245
  v_permlane16_swap_b32 v209, v246
  v_permlane16_swap_b32 v210, v247
  v_permlane16_swap_b32 v211, v248
  v_add_f32 v208, v208, v245
  v_add_f32 v209, v209, v246
  v_add_f32 v210, v210, v247
  v_add_f32 v211, v211, v248
  v_mov_b32 v245, v208
  v_mov_b32 v246, v209
  v_mov_b32 v247, v210
  v_mov_b32 v248, v211
  v_permlane32_swap_b32 v208, v245
  v_permlane32_swap_b32 v209, v246
  v_permlane32_swap_b32 v210, v247
  v_permlane32_swap_b32 v211, v248
  v_add_f32 v208, v208, v245
  v_add_f32 v209, v209, v246
  v_add_f32 v210, v210, v247
  v_add_f32 v211, v211, v248
  v_rcp_f32 v192, v208
  v_rcp_f32 v196, v209
  v_rcp_f32 v200, v210
  v_rcp_f32 v204, v211
  v_accvgpr_read_b32 v0, a0
  v_accvgpr_read_b32 v1, a1
  v_accvgpr_read_b32 v2, a2
  v_accvgpr_read_b32 v3, a3
  v_accvgpr_read_b32 v4, a16
  v_accvgpr_read_b32 v5, a17
  v_accvgpr_read_b32 v6, a18
  v_accvgpr_read_b32 v7, a19
  v_mul_f32 v0, v0, v192
  v_mul_f32 v1, v1, v192
  v_mul_f32 v2, v2, v192
  v_mul_f32 v3, v3, v192
  v_mul_f32 v4, v4, v192
  v_mul_f32 v5, v5, v192
  v_mul_f32 v6, v6, v192
  v_mul_f32 v7, v7, v192
  v_cvt_pk_bf16_f32 v0, v0, v1
  v_cvt_pk_bf16_f32 v1, v2, v3
  v_cvt_pk_bf16_f32 v2, v4, v5
  v_cvt_pk_bf16_f32 v3, v6, v7
  buffer_store_dwordx4 v[0:3], v244, s[24:27], s40 offen offset:0 sc1
  v_accvgpr_read_b32 v8, a4
  v_accvgpr_read_b32 v9, a5
  v_accvgpr_read_b32 v10, a6
  v_accvgpr_read_b32 v11, a7
  v_accvgpr_read_b32 v12, a20
  v_accvgpr_read_b32 v13, a21
  v_accvgpr_read_b32 v14, a22
  v_accvgpr_read_b32 v15, a23
  v_mul_f32 v8, v8, v196
  v_mul_f32 v9, v9, v196
  v_mul_f32 v10, v10, v196
  v_mul_f32 v11, v11, v196
  v_mul_f32 v12, v12, v196
  v_mul_f32 v13, v13, v196
  v_mul_f32 v14, v14, v196
  v_mul_f32 v15, v15, v196
  v_cvt_pk_bf16_f32 v8, v8, v9
  v_cvt_pk_bf16_f32 v9, v10, v11
  v_cvt_pk_bf16_f32 v10, v12, v13
  v_cvt_pk_bf16_f32 v11, v14, v15
  buffer_store_dwordx4 v[8:11], v244, s[24:27], s40 offen offset:2048 sc1
  v_accvgpr_read_b32 v16, a8
  v_accvgpr_read_b32 v17, a9
  v_accvgpr_read_b32 v18, a10
  v_accvgpr_read_b32 v19, a11
  v_accvgpr_read_b32 v20, a24
  v_accvgpr_read_b32 v21, a25
  v_accvgpr_read_b32 v22, a26
  v_accvgpr_read_b32 v23, a27
  v_mul_f32 v16, v16, v200
  v_mul_f32 v17, v17, v200
  v_mul_f32 v18, v18, v200
  v_mul_f32 v19, v19, v200
  v_mul_f32 v20, v20, v200
  v_mul_f32 v21, v21, v200
  v_mul_f32 v22, v22, v200
  v_mul_f32 v23, v23, v200
  v_cvt_pk_bf16_f32 v16, v16, v17
  v_cvt_pk_bf16_f32 v17, v18, v19
  v_cvt_pk_bf16_f32 v18, v20, v21
  v_cvt_pk_bf16_f32 v19, v22, v23
  buffer_store_dwordx4 v[16:19], v244, s[24:27], s41 offen offset:0 sc1
  v_accvgpr_read_b32 v24, a12
  v_accvgpr_read_b32 v25, a13
  v_accvgpr_read_b32 v26, a14
  v_accvgpr_read_b32 v27, a15
  v_accvgpr_read_b32 v28, a28
  v_accvgpr_read_b32 v29, a29
  v_accvgpr_read_b32 v30, a30
  v_accvgpr_read_b32 v31, a31
  v_mul_f32 v24, v24, v204
  v_mul_f32 v25, v25, v204
  v_mul_f32 v26, v26, v204
  v_mul_f32 v27, v27, v204
  v_mul_f32 v28, v28, v204
  v_mul_f32 v29, v29, v204
  v_mul_f32 v30, v30, v204
  v_mul_f32 v31, v31, v204
  v_cvt_pk_bf16_f32 v24, v24, v25
  v_cvt_pk_bf16_f32 v25, v26, v27
  v_cvt_pk_bf16_f32 v26, v28, v29
  v_cvt_pk_bf16_f32 v27, v30, v31
  buffer_store_dwordx4 v[24:27], v244, s[24:27], s41 offen offset:2048 sc1
  v_accvgpr_read_b32 v32, a32
  v_accvgpr_read_b32 v33, a33
  v_accvgpr_read_b32 v34, a34
  v_accvgpr_read_b32 v35, a35
  v_accvgpr_read_b32 v36, a48
  v_accvgpr_read_b32 v37, a49
  v_accvgpr_read_b32 v38, a50
  v_accvgpr_read_b32 v39, a51
  v_mul_f32 v32, v32, v192
  v_mul_f32 v33, v33, v192
  v_mul_f32 v34, v34, v192
  v_mul_f32 v35, v35, v192
  v_mul_f32 v36, v36, v192
  v_mul_f32 v37, v37, v192
  v_mul_f32 v38, v38, v192
  v_mul_f32 v39, v39, v192
  v_cvt_pk_bf16_f32 v32, v32, v33
  v_cvt_pk_bf16_f32 v33, v34, v35
  v_cvt_pk_bf16_f32 v34, v36, v37
  v_cvt_pk_bf16_f32 v35, v38, v39
  buffer_store_dwordx4 v[32:35], v244, s[24:27], s40 offen offset:1024 sc1
  v_accvgpr_read_b32 v40, a36
  v_accvgpr_read_b32 v41, a37
  v_accvgpr_read_b32 v42, a38
  v_accvgpr_read_b32 v43, a39
  v_accvgpr_read_b32 v44, a52
  v_accvgpr_read_b32 v45, a53
  v_accvgpr_read_b32 v46, a54
  v_accvgpr_read_b32 v47, a55
  v_mul_f32 v40, v40, v196
  v_mul_f32 v41, v41, v196
  v_mul_f32 v42, v42, v196
  v_mul_f32 v43, v43, v196
  v_mul_f32 v44, v44, v196
  v_mul_f32 v45, v45, v196
  v_mul_f32 v46, v46, v196
  v_mul_f32 v47, v47, v196
  v_cvt_pk_bf16_f32 v40, v40, v41
  v_cvt_pk_bf16_f32 v41, v42, v43
  v_cvt_pk_bf16_f32 v42, v44, v45
  v_cvt_pk_bf16_f32 v43, v46, v47
  buffer_store_dwordx4 v[40:43], v244, s[24:27], s40 offen offset:3072 sc1
  v_accvgpr_read_b32 v48, a40
  v_accvgpr_read_b32 v49, a41
  v_accvgpr_read_b32 v50, a42
  v_accvgpr_read_b32 v51, a43
  v_accvgpr_read_b32 v52, a56
  v_accvgpr_read_b32 v53, a57
  v_accvgpr_read_b32 v54, a58
  v_accvgpr_read_b32 v55, a59
  v_mul_f32 v48, v48, v200
  v_mul_f32 v49, v49, v200
  v_mul_f32 v50, v50, v200
  v_mul_f32 v51, v51, v200
  v_mul_f32 v52, v52, v200
  v_mul_f32 v53, v53, v200
  v_mul_f32 v54, v54, v200
  v_mul_f32 v55, v55, v200
  v_cvt_pk_bf16_f32 v48, v48, v49
  v_cvt_pk_bf16_f32 v49, v50, v51
  v_cvt_pk_bf16_f32 v50, v52, v53
  v_cvt_pk_bf16_f32 v51, v54, v55
  buffer_store_dwordx4 v[48:51], v244, s[24:27], s41 offen offset:1024 sc1
  v_accvgpr_read_b32 v56, a44
  v_accvgpr_read_b32 v57, a45
  v_accvgpr_read_b32 v58, a46
  v_accvgpr_read_b32 v59, a47
  v_accvgpr_read_b32 v60, a60
  v_accvgpr_read_b32 v61, a61
  v_accvgpr_read_b32 v62, a62
  v_accvgpr_read_b32 v63, a63
  v_mul_f32 v56, v56, v204
  v_mul_f32 v57, v57, v204
  v_mul_f32 v58, v58, v204
  v_mul_f32 v59, v59, v204
  v_mul_f32 v60, v60, v204
  v_mul_f32 v61, v61, v204
  v_mul_f32 v62, v62, v204
  v_mul_f32 v63, v63, v204
  v_cvt_pk_bf16_f32 v56, v56, v57
  v_cvt_pk_bf16_f32 v57, v58, v59
  v_cvt_pk_bf16_f32 v58, v60, v61
  v_cvt_pk_bf16_f32 v59, v62, v63
  buffer_store_dwordx4 v[56:59], v244, s[24:27], s41 offen offset:3072 sc1
  v_accvgpr_read_b32 v0, a64
  v_accvgpr_read_b32 v1, a65
  v_accvgpr_read_b32 v2, a66
  v_accvgpr_read_b32 v3, a67
  v_accvgpr_read_b32 v4, a80
  v_accvgpr_read_b32 v5, a81
  v_accvgpr_read_b32 v6, a82
  v_accvgpr_read_b32 v7, a83
  v_mul_f32 v0, v0, v192
  v_mul_f32 v1, v1, v192
  v_mul_f32 v2, v2, v192
  v_mul_f32 v3, v3, v192
  v_mul_f32 v4, v4, v192
  v_mul_f32 v5, v5, v192
  v_mul_f32 v6, v6, v192
  v_mul_f32 v7, v7, v192
  v_cvt_pk_bf16_f32 v0, v0, v1
  v_cvt_pk_bf16_f32 v1, v2, v3
  v_cvt_pk_bf16_f32 v2, v4, v5
  v_cvt_pk_bf16_f32 v3, v6, v7
  buffer_store_dwordx4 v[0:3], v244, s[24:27], s42 offen offset:0 sc1
  v_accvgpr_read_b32 v8, a68
  v_accvgpr_read_b32 v9, a69
  v_accvgpr_read_b32 v10, a70
  v_accvgpr_read_b32 v11, a71
  v_accvgpr_read_b32 v12, a84
  v_accvgpr_read_b32 v13, a85
  v_accvgpr_read_b32 v14, a86
  v_accvgpr_read_b32 v15, a87
  v_mul_f32 v8, v8, v196
  v_mul_f32 v9, v9, v196
  v_mul_f32 v10, v10, v196
  v_mul_f32 v11, v11, v196
  v_mul_f32 v12, v12, v196
  v_mul_f32 v13, v13, v196
  v_mul_f32 v14, v14, v196
  v_mul_f32 v15, v15, v196
  v_cvt_pk_bf16_f32 v8, v8, v9
  v_cvt_pk_bf16_f32 v9, v10, v11
  v_cvt_pk_bf16_f32 v10, v12, v13
  v_cvt_pk_bf16_f32 v11, v14, v15
  buffer_store_dwordx4 v[8:11], v244, s[24:27], s42 offen offset:2048 sc1
  v_accvgpr_read_b32 v16, a72
  v_accvgpr_read_b32 v17, a73
  v_accvgpr_read_b32 v18, a74
  v_accvgpr_read_b32 v19, a75
  v_accvgpr_read_b32 v20, a88
  v_accvgpr_read_b32 v21, a89
  v_accvgpr_read_b32 v22, a90
  v_accvgpr_read_b32 v23, a91
  v_mul_f32 v16, v16, v200
  v_mul_f32 v17, v17, v200
  v_mul_f32 v18, v18, v200
  v_mul_f32 v19, v19, v200
  v_mul_f32 v20, v20, v200
  v_mul_f32 v21, v21, v200
  v_mul_f32 v22, v22, v200
  v_mul_f32 v23, v23, v200
  v_cvt_pk_bf16_f32 v16, v16, v17
  v_cvt_pk_bf16_f32 v17, v18, v19
  v_cvt_pk_bf16_f32 v18, v20, v21
  v_cvt_pk_bf16_f32 v19, v22, v23
  buffer_store_dwordx4 v[16:19], v244, s[24:27], s43 offen offset:0 sc1
  v_accvgpr_read_b32 v24, a76
  v_accvgpr_read_b32 v25, a77
  v_accvgpr_read_b32 v26, a78
  v_accvgpr_read_b32 v27, a79
  v_accvgpr_read_b32 v28, a92
  v_accvgpr_read_b32 v29, a93
  v_accvgpr_read_b32 v30, a94
  v_accvgpr_read_b32 v31, a95
  v_mul_f32 v24, v24, v204
  v_mul_f32 v25, v25, v204
  v_mul_f32 v26, v26, v204
  v_mul_f32 v27, v27, v204
  v_mul_f32 v28, v28, v204
  v_mul_f32 v29, v29, v204
  v_mul_f32 v30, v30, v204
  v_mul_f32 v31, v31, v204
  v_cvt_pk_bf16_f32 v24, v24, v25
  v_cvt_pk_bf16_f32 v25, v26, v27
  v_cvt_pk_bf16_f32 v26, v28, v29
  v_cvt_pk_bf16_f32 v27, v30, v31
  buffer_store_dwordx4 v[24:27], v244, s[24:27], s43 offen offset:2048 sc1
  v_accvgpr_read_b32 v32, a96
  v_accvgpr_read_b32 v33, a97
  v_accvgpr_read_b32 v34, a98
  v_accvgpr_read_b32 v35, a99
  v_accvgpr_read_b32 v36, a112
  v_accvgpr_read_b32 v37, a113
  v_accvgpr_read_b32 v38, a114
  v_accvgpr_read_b32 v39, a115
  v_mul_f32 v32, v32, v192
  v_mul_f32 v33, v33, v192
  v_mul_f32 v34, v34, v192
  v_mul_f32 v35, v35, v192
  v_mul_f32 v36, v36, v192
  v_mul_f32 v37, v37, v192
  v_mul_f32 v38, v38, v192
  v_mul_f32 v39, v39, v192
  v_cvt_pk_bf16_f32 v32, v32, v33
  v_cvt_pk_bf16_f32 v33, v34, v35
  v_cvt_pk_bf16_f32 v34, v36, v37
  v_cvt_pk_bf16_f32 v35, v38, v39
  buffer_store_dwordx4 v[32:35], v244, s[24:27], s42 offen offset:1024 sc1
  v_accvgpr_read_b32 v40, a100
  v_accvgpr_read_b32 v41, a101
  v_accvgpr_read_b32 v42, a102
  v_accvgpr_read_b32 v43, a103
  v_accvgpr_read_b32 v44, a116
  v_accvgpr_read_b32 v45, a117
  v_accvgpr_read_b32 v46, a118
  v_accvgpr_read_b32 v47, a119
  v_mul_f32 v40, v40, v196
  v_mul_f32 v41, v41, v196
  v_mul_f32 v42, v42, v196
  v_mul_f32 v43, v43, v196
  v_mul_f32 v44, v44, v196
  v_mul_f32 v45, v45, v196
  v_mul_f32 v46, v46, v196
  v_mul_f32 v47, v47, v196
  v_cvt_pk_bf16_f32 v40, v40, v41
  v_cvt_pk_bf16_f32 v41, v42, v43
  v_cvt_pk_bf16_f32 v42, v44, v45
  v_cvt_pk_bf16_f32 v43, v46, v47
  buffer_store_dwordx4 v[40:43], v244, s[24:27], s42 offen offset:3072 sc1
  v_accvgpr_read_b32 v48, a104
  v_accvgpr_read_b32 v49, a105
  v_accvgpr_read_b32 v50, a106
  v_accvgpr_read_b32 v51, a107
  v_accvgpr_read_b32 v52, a120
  v_accvgpr_read_b32 v53, a121
  v_accvgpr_read_b32 v54, a122
  v_accvgpr_read_b32 v55, a123
  v_mul_f32 v48, v48, v200
  v_mul_f32 v49, v49, v200
  v_mul_f32 v50, v50, v200
  v_mul_f32 v51, v51, v200
  v_mul_f32 v52, v52, v200
  v_mul_f32 v53, v53, v200
  v_mul_f32 v54, v54, v200
  v_mul_f32 v55, v55, v200
  v_cvt_pk_bf16_f32 v48, v48, v49
  v_cvt_pk_bf16_f32 v49, v50, v51
  v_cvt_pk_bf16_f32 v50, v52, v53
  v_cvt_pk_bf16_f32 v51, v54, v55
  buffer_store_dwordx4 v[48:51], v244, s[24:27], s43 offen offset:1024 sc1
  v_accvgpr_read_b32 v56, a108
  v_accvgpr_read_b32 v57, a109
  v_accvgpr_read_b32 v58, a110
  v_accvgpr_read_b32 v59, a111
  v_accvgpr_read_b32 v60, a124
  v_accvgpr_read_b32 v61, a125
  v_accvgpr_read_b32 v62, a126
  v_accvgpr_read_b32 v63, a127
  v_mul_f32 v56, v56, v204
  v_mul_f32 v57, v57, v204
  v_mul_f32 v58, v58, v204
  v_mul_f32 v59, v59, v204
  v_mul_f32 v60, v60, v204
  v_mul_f32 v61, v61, v204
  v_mul_f32 v62, v62, v204
  v_mul_f32 v63, v63, v204
  v_cvt_pk_bf16_f32 v56, v56, v57
  v_cvt_pk_bf16_f32 v57, v58, v59
  v_cvt_pk_bf16_f32 v58, v60, v61
  v_cvt_pk_bf16_f32 v59, v62, v63
  buffer_store_dwordx4 v[56:59], v244, s[24:27], s43 offen offset:3072 sc1
  v_add_u32 v252, 4096, v242
  v_add_u32 v253, 8192, v242
  buffer_load_dwordx4 a[128:131], v253, s[24:27], s4 offen offset:3072 sc1
  buffer_load_dwordx4 a[132:135], v242, s[24:27], s5 offen offset:0 sc1
  buffer_load_dwordx4 a[136:139], v242, s[24:27], s5 offen offset:1024 sc1
  buffer_load_dwordx4 a[140:143], v242, s[24:27], s5 offen offset:2048 sc1
  buffer_load_dwordx4 a[144:147], v242, s[24:27], s5 offen offset:3072 sc1
  buffer_load_dwordx4 a[148:151], v252, s[24:27], s5 offen offset:0 sc1
  buffer_load_dwordx4 a[152:155], v252, s[24:27], s5 offen offset:1024 sc1
  buffer_load_dwordx4 a[156:159], v252, s[24:27], s5 offen offset:2048 sc1
  buffer_load_dwordx4 v[128:131], v252, s[24:27], s5 offen offset:3072 sc1
  buffer_load_dwordx4 v[132:135], v253, s[24:27], s5 offen offset:0 sc1
  buffer_load_dwordx4 v[136:139], v253, s[24:27], s5 offen offset:1024 sc1
  buffer_load_dwordx4 v[140:143], v253, s[24:27], s5 offen offset:2048 sc1
  buffer_load_dwordx4 v[144:147], v253, s[24:27], s5 offen offset:3072 sc1
  buffer_load_dwordx4 v[148:151], v242, s[24:27], s6 offen offset:0 sc1
  buffer_load_dwordx4 v[152:155], v242, s[24:27], s6 offen offset:1024 sc1
  buffer_load_dwordx4 v[156:159], v242, s[24:27], s6 offen offset:2048 sc1
  buffer_load_dwordx4 v[160:163], v242, s[24:27], s6 offen offset:3072 sc1
  buffer_load_dwordx4 v[164:167], v252, s[24:27], s6 offen offset:0 sc1
  buffer_load_dwordx4 v[168:171], v252, s[24:27], s6 offen offset:1024 sc1
  buffer_load_dwordx4 v[172:175], v252, s[24:27], s6 offen offset:2048 sc1
  buffer_load_dwordx4 v[176:179], v252, s[24:27], s6 offen offset:3072 sc1
  buffer_load_dwordx4 v[180:183], v253, s[24:27], s6 offen offset:0 sc1
  buffer_load_dwordx4 v[184:187], v253, s[24:27], s6 offen offset:1024 sc1
  buffer_load_dwordx4 v[188:191], v253, s[24:27], s6 offen offset:2048 sc1
  buffer_load_dwordx4 a[0:3], v253, s[24:27], s6 offen offset:3072 sc1
  buffer_load_dwordx4 a[4:7], v242, s[24:27], s7 offen offset:0 sc1
  buffer_load_dwordx4 a[8:11], v242, s[24:27], s7 offen offset:1024 sc1
  buffer_load_dwordx4 a[12:15], v242, s[24:27], s7 offen offset:2048 sc1
  s_lshr_b32 s39, s37, 2
  s_lshl_b32 s39, s39, 3
  s_lshr_b32 s38, s36, 2
  s_add_u32 s39, s39, s38
  s_lshl_b32 s39, s39, 7
  s_add_u32 s39, s39, 2867200
  s_lshl_b32 s38, s3, 26
  v_lshlrev_b32 v64, 22, v242
  v_or_b32 v64, s38, v64
  v_mov_b32 v65, 1
  s_waitcnt vmcnt(0)
  s_barrier
  s_branch tail_go
.section .rodata,"a"
.p2align 6
.amdhsa_kernel recurrent_scan__mha_block_cached__moe_arch_mod__prompt_kernel
  .amdhsa_next_free_vgpr 512
  .amdhsa_next_free_sgpr 102
  .amdhsa_accum_offset 256
  .amdhsa_group_segment_fixed_size 0
  .amdhsa_kernarg_size 104
  .amdhsa_user_sgpr_count 2
  .amdhsa_user_sgpr_kernarg_segment_ptr 1
  .amdhsa_system_sgpr_workgroup_id_x 1
.end_amdhsa_kernel
```

```asm
; @launch grid=(256,1,1) block=(256,1,1) lds=163840
.amdgcn_target "amdgcn-amd-amdhsa--gfx950"
.text
.globl recurrent_scan__mha_block_cached__moe_arch_mod__prompt_kernel
.p2align 8
.type recurrent_scan__mha_block_cached__moe_arch_mod__prompt_kernel,@function
recurrent_scan__mha_block_cached__moe_arch_mod__prompt_kernel:
  s_cmp_ge_u32 s2, 256
  s_cbranch_scc1 attn_end
  s_load_dwordx2 s[60:61], s[0:1], 0
  s_load_dwordx2 s[48:49], s[0:1], 48
  s_load_dwordx4 s[4:7], s[0:1], 8
  s_load_dwordx2 s[8:9], s[0:1], 24
  s_load_dwordx2 s[10:11], s[0:1], 96
  s_load_dwordx2 s[88:89], s[0:1], 32
  s_load_dwordx2 s[90:91], s[0:1], 56
  s_load_dwordx4 s[92:95], s[0:1], 64
  s_load_dwordx2 s[62:63], s[0:1], 80
  v_lshrrev_b32 v249, 6, v0
  v_and_b32 v0, 63, v0
  v_mov_b32 v245, v0
  v_readfirstlane_b32 s3, v249
  s_and_b32 s36, s2, 7
  s_lshl_b32 s36, s36, 2
  s_lshr_b32 s37, s2, 6
  s_add_u32 s36, s36, s37
  s_bfe_u32 s37, s2, 196611
  s_lshl_b32 s37, s37, 2
  s_add_u32 s37, s37, s3
  s_lshl_b32 s28, s3, 12
  v_lshrrev_b32 v248, 4, v245
  v_and_b32 v247, 15, v245
  s_lshl_b32 s38, s3, 17
  v_lshlrev_b32 v249, 13, v248
  v_add_u32 v249, s38, v249
  v_or_b32 v250, 0, v248
  v_lshlrev_b32 v250, 1, v250
  v_xor_b32 v250, v250, v247
  v_lshl_add_u32 v238, v250, 4, v249
  v_or_b32 v250, 0, v248
  v_lshlrev_b32 v250, 1, v250
  v_xor_b32 v250, v250, v247
  v_lshl_add_u32 v239, v250, 4, v249
  v_add_u32 v239, 31744, v239
  v_or_b32 v250, 4, v248
  v_lshlrev_b32 v250, 1, v250
  v_xor_b32 v250, v250, v247
  v_lshl_add_u32 v240, v250, 4, v249
  v_add_u32 v240, 63488, v240
  v_or_b32 v250, 4, v248
  v_lshlrev_b32 v250, 1, v250
  v_xor_b32 v250, v250, v247
  v_lshl_add_u32 v241, v250, 4, v249
  v_add_u32 v241, 95232, v241
  s_waitcnt lgkmcnt(0)
  s_add_u32 s58, s10, 2830336
  s_addc_u32 s59, s11, 0
  s_load_dword s59, s[58:59], 0
  s_mov_b32 s24, s10
  s_mov_b32 s25, s11
  s_mov_b32 s26, 29360128
  s_mov_b32 s27, 0x20000
  s_lshl_b32 s38, s36, 8
  s_add_u32 s20, s8, s38
  s_addc_u32 s21, s9, 0
  s_mov_b32 s22, 5242880
  s_mov_b32 s23, 0x20000
  s_sub_u32 s22, s22, s38
  s_cmp_ge_u32 s3, 2
  s_cbranch_scc1 front_fetch
  s_mov_b32 s12, s60
  s_mov_b32 s13, s61
  s_mov_b32 s14, 2621440
  s_mov_b32 s15, 0x20000
  s_mov_b32 s16, s48
  s_mov_b32 s17, s49
  s_mov_b32 s18, 1280
  s_mov_b32 s19, 0x20000
  s_lshr_b32 s52, s37, 2
  s_lshl_b32 s52, s52, 5
  s_add_u32 s52, s52, s36
  s_lshl_b32 s52, s52, 1
  s_add_u32 s52, s52, s3
  s_lshl_b32 s52, s52, 2
  s_mul_i32 s53, s52, 1280
  v_lshrrev_b32 v1, 4, v0
  v_and_b32 v2, 15, v0
  v_lshlrev_b32 v3, 4, v2
  v_mul_u32_u24 v4, 0x500, v1
  v_add_u32 v4, v4, v3
  buffer_load_dwordx4 v[8:11], v4, s[12:15], s53 offen offset:0
  buffer_load_dwordx4 v[12:15], v4, s[12:15], s53 offen offset:256
  buffer_load_dwordx4 v[16:19], v4, s[12:15], s53 offen offset:512
  buffer_load_dwordx4 v[20:23], v4, s[12:15], s53 offen offset:768
  buffer_load_dwordx4 v[24:27], v4, s[12:15], s53 offen offset:1024
  buffer_load_dwordx4 v[28:31], v3, s[16:19], 0 offen offset:0
  buffer_load_dwordx4 v[32:35], v3, s[16:19], 0 offen offset:256
  buffer_load_dwordx4 v[36:39], v3, s[16:19], 0 offen offset:512
  buffer_load_dwordx4 v[40:43], v3, s[16:19], 0 offen offset:768
  buffer_load_dwordx4 v[44:47], v3, s[16:19], 0 offen offset:1024
  v_mov_b32 v7, 0
  v_lshlrev_b32 v6, 26, v0
  s_lshl_b32 s53, s2, 7
  s_add_u32 s53, s53, 2834432
  buffer_store_dword v7, v6, s[24:27], s53 offen sc1
  v_lshlrev_b32 v6, 8, v0
  v_lshrrev_b32 v5, 5, v0
  v_lshl_add_u32 v6, v5, 26, v6
  s_cmp_eq_u32 s2, 0
  s_cselect_b32 s53, 0, 1073741824
  v_or_b32 v6, s53, v6
  s_mov_b32 s53, 2818048
  buffer_store_dword v7, v6, s[24:27], s53 offen sc1
  v_lshlrev_b32 v6, 7, v0
  s_cmp_eq_u32 s2, 1
  s_cselect_b32 s53, 0, 1073741824
  v_or_b32 v6, s53, v6
  s_mov_b32 s53, 2867200
  buffer_store_dword v7, v6, s[24:27], s53 offen sc1
  s_lshr_b32 s53, s52, 6
  s_mul_i32 s53, s53, 81920
  s_bfe_u32 s54, s52, 0x20004
  s_lshl_b32 s54, s54, 10
  s_add_u32 s53, s53, s54
  s_and_b32 s54, s52, 15
  s_lshl_b32 s54, s54, 4
  s_add_u32 s53, s53, s54
  v_lshrrev_b32 v5, 2, v2
  v_lshlrev_b32 v5, 12, v5
  v_and_b32 v6, 3, v2
  v_lshl_add_u32 v5, v6, 8, v5
  v_lshl_add_u32 v5, v1, 4, v5
  s_mov_b32 s56, 0xffff0000
  s_waitcnt vmcnt(12)
  v_lshlrev_b32 v48, 16, v8
  v_and_b32 v49, s56, v8
  v_lshlrev_b32 v50, 16, v9
  v_and_b32 v51, s56, v9
  v_lshlrev_b32 v52, 16, v10
  v_and_b32 v53, s56, v10
  v_lshlrev_b32 v54, 16, v11
  v_and_b32 v55, s56, v11
  s_waitcnt vmcnt(11)
  v_lshlrev_b32 v56, 16, v12
  v_and_b32 v57, s56, v12
  v_lshlrev_b32 v58, 16, v13
  v_and_b32 v59, s56, v13
  v_lshlrev_b32 v60, 16, v14
  v_and_b32 v61, s56, v14
  v_lshlrev_b32 v62, 16, v15
  v_and_b32 v63, s56, v15
  s_waitcnt vmcnt(10)
  v_lshlrev_b32 v64, 16, v16
  v_and_b32 v65, s56, v16
  v_lshlrev_b32 v66, 16, v17
  v_and_b32 v67, s56, v17
  v_lshlrev_b32 v68, 16, v18
  v_and_b32 v69, s56, v18
  v_lshlrev_b32 v70, 16, v19
  v_and_b32 v71, s56, v19
  s_waitcnt vmcnt(9)
  v_lshlrev_b32 v72, 16, v20
  v_and_b32 v73, s56, v20
  v_lshlrev_b32 v74, 16, v21
  v_and_b32 v75, s56, v21
  v_lshlrev_b32 v76, 16, v22
  v_and_b32 v77, s56, v22
  v_lshlrev_b32 v78, 16, v23
  v_and_b32 v79, s56, v23
  s_waitcnt vmcnt(8)
  v_lshlrev_b32 v80, 16, v24
  v_and_b32 v81, s56, v24
  v_lshlrev_b32 v82, 16, v25
  v_and_b32 v83, s56, v25
  v_lshlrev_b32 v84, 16, v26
  v_and_b32 v85, s56, v26
  v_lshlrev_b32 v86, 16, v27
  v_and_b32 v87, s56, v27
  v_pk_add_f32 v[88:89], v[48:49], v[50:51]
  v_pk_add_f32 v[90:91], v[52:53], v[54:55]
  v_pk_add_f32 v[88:89], v[88:89], v[56:57]
  v_pk_add_f32 v[90:91], v[90:91], v[58:59]
  v_pk_add_f32 v[88:89], v[88:89], v[60:61]
  v_pk_add_f32 v[90:91], v[90:91], v[62:63]
  v_pk_add_f32 v[88:89], v[88:89], v[64:65]
  v_pk_add_f32 v[90:91], v[90:91], v[66:67]
  v_pk_add_f32 v[88:89], v[88:89], v[68:69]
  v_pk_add_f32 v[90:91], v[90:91], v[70:71]
  v_pk_add_f32 v[88:89], v[88:89], v[72:73]
  v_pk_add_f32 v[90:91], v[90:91], v[74:75]
  v_pk_add_f32 v[88:89], v[88:89], v[76:77]
  v_pk_add_f32 v[90:91], v[90:91], v[78:79]
  v_pk_add_f32 v[88:89], v[88:89], v[80:81]
  v_pk_add_f32 v[90:91], v[90:91], v[82:83]
  v_pk_add_f32 v[88:89], v[88:89], v[84:85]
  v_pk_add_f32 v[90:91], v[90:91], v[86:87]
  v_pk_add_f32 v[88:89], v[88:89], v[90:91]
  v_add_f32 v92, v88, v89
  s_nop 1
  v_add_f32_dpp v92, v92, v92 row_ror:8 row_mask:0xf bank_mask:0xf
  s_nop 1
  v_add_f32_dpp v92, v92, v92 row_ror:4 row_mask:0xf bank_mask:0xf
  s_nop 1
  v_add_f32_dpp v92, v92, v92 row_ror:2 row_mask:0xf bank_mask:0xf
  s_nop 1
  v_add_f32_dpp v92, v92, v92 row_ror:1 row_mask:0xf bank_mask:0xf
  v_mul_f32 v92, 0x3acccccd, v92
  v_pk_add_f32 v[94:95], v[48:49], v[92:93] op_sel_hi:[1,0] neg_lo:[0,1] neg_hi:[0,1]
  v_pk_mul_f32 v[88:89], v[94:95], v[94:95]
  v_pk_add_f32 v[96:97], v[50:51], v[92:93] op_sel_hi:[1,0] neg_lo:[0,1] neg_hi:[0,1]
  v_pk_mul_f32 v[90:91], v[96:97], v[96:97]
  v_pk_add_f32 v[94:95], v[52:53], v[92:93] op_sel_hi:[1,0] neg_lo:[0,1] neg_hi:[0,1]
  v_pk_fma_f32 v[88:89], v[94:95], v[94:95], v[88:89]
  v_pk_add_f32 v[96:97], v[54:55], v[92:93] op_sel_hi:[1,0] neg_lo:[0,1] neg_hi:[0,1]
  v_pk_fma_f32 v[90:91], v[96:97], v[96:97], v[90:91]
  v_pk_add_f32 v[94:95], v[56:57], v[92:93] op_sel_hi:[1,0] neg_lo:[0,1] neg_hi:[0,1]
  v_pk_fma_f32 v[88:89], v[94:95], v[94:95], v[88:89]
  v_pk_add_f32 v[96:97], v[58:59], v[92:93] op_sel_hi:[1,0] neg_lo:[0,1] neg_hi:[0,1]
  v_pk_fma_f32 v[90:91], v[96:97], v[96:97], v[90:91]
  v_pk_add_f32 v[94:95], v[60:61], v[92:93] op_sel_hi:[1,0] neg_lo:[0,1] neg_hi:[0,1]
  v_pk_fma_f32 v[88:89], v[94:95], v[94:95], v[88:89]
  v_pk_add_f32 v[96:97], v[62:63], v[92:93] op_sel_hi:[1,0] neg_lo:[0,1] neg_hi:[0,1]
  v_pk_fma_f32 v[90:91], v[96:97], v[96:97], v[90:91]
  v_pk_add_f32 v[94:95], v[64:65], v[92:93] op_sel_hi:[1,0] neg_lo:[0,1] neg_hi:[0,1]
  v_pk_fma_f32 v[88:89], v[94:95], v[94:95], v[88:89]
  v_pk_add_f32 v[96:97], v[66:67], v[92:93] op_sel_hi:[1,0] neg_lo:[0,1] neg_hi:[0,1]
  v_pk_fma_f32 v[90:91], v[96:97], v[96:97], v[90:91]
  v_pk_add_f32 v[94:95], v[68:69], v[92:93] op_sel_hi:[1,0] neg_lo:[0,1] neg_hi:[0,1]
  v_pk_fma_f32 v[88:89], v[94:95], v[94:95], v[88:89]
  v_pk_add_f32 v[96:97], v[70:71], v[92:93] op_sel_hi:[1,0] neg_lo:[0,1] neg_hi:[0,1]
  v_pk_fma_f32 v[90:91], v[96:97], v[96:97], v[90:91]
  v_pk_add_f32 v[94:95], v[72:73], v[92:93] op_sel_hi:[1,0] neg_lo:[0,1] neg_hi:[0,1]
  v_pk_fma_f32 v[88:89], v[94:95], v[94:95], v[88:89]
  v_pk_add_f32 v[96:97], v[74:75], v[92:93] op_sel_hi:[1,0] neg_lo:[0,1] neg_hi:[0,1]
  v_pk_fma_f32 v[90:91], v[96:97], v[96:97], v[90:91]
  v_pk_add_f32 v[94:95], v[76:77], v[92:93] op_sel_hi:[1,0] neg_lo:[0,1] neg_hi:[0,1]
  v_pk_fma_f32 v[88:89], v[94:95], v[94:95], v[88:89]
  v_pk_add_f32 v[96:97], v[78:79], v[92:93] op_sel_hi:[1,0] neg_lo:[0,1] neg_hi:[0,1]
  v_pk_fma_f32 v[90:91], v[96:97], v[96:97], v[90:91]
  v_pk_add_f32 v[94:95], v[80:81], v[92:93] op_sel_hi:[1,0] neg_lo:[0,1] neg_hi:[0,1]
  v_pk_fma_f32 v[88:89], v[94:95], v[94:95], v[88:89]
  v_pk_add_f32 v[96:97], v[82:83], v[92:93] op_sel_hi:[1,0] neg_lo:[0,1] neg_hi:[0,1]
  v_pk_fma_f32 v[90:91], v[96:97], v[96:97], v[90:91]
  v_pk_add_f32 v[94:95], v[84:85], v[92:93] op_sel_hi:[1,0] neg_lo:[0,1] neg_hi:[0,1]
  v_pk_fma_f32 v[88:89], v[94:95], v[94:95], v[88:89]
  v_pk_add_f32 v[96:97], v[86:87], v[92:93] op_sel_hi:[1,0] neg_lo:[0,1] neg_hi:[0,1]
  v_pk_fma_f32 v[90:91], v[96:97], v[96:97], v[90:91]
  v_pk_add_f32 v[88:89], v[88:89], v[90:91]
  v_add_f32 v98, v88, v89
  s_nop 1
  v_add_f32_dpp v98, v98, v98 row_ror:8 row_mask:0xf bank_mask:0xf
  v_cvt_pk_bf16_f32 v92, v92, v92
  s_nop 0
  v_add_f32_dpp v98, v98, v98 row_ror:4 row_mask:0xf bank_mask:0xf
  v_lshlrev_b32 v92, 16, v92
  s_nop 0
  v_add_f32_dpp v98, v98, v98 row_ror:2 row_mask:0xf bank_mask:0xf
  s_nop 1
  v_add_f32_dpp v98, v98, v98 row_ror:1 row_mask:0xf bank_mask:0xf
  v_mul_f32 v98, 0x3acccccd, v98
  v_cvt_pk_bf16_f32 v98, v98, v98
  v_pk_add_f32 v[48:49], v[48:49], v[92:93] op_sel_hi:[1,0] neg_lo:[0,1] neg_hi:[0,1]
  v_lshlrev_b32 v98, 16, v98
  v_pk_add_f32 v[50:51], v[50:51], v[92:93] op_sel_hi:[1,0] neg_lo:[0,1] neg_hi:[0,1]
  v_add_f32 v98, 0x3727c5ac, v98
  v_pk_add_f32 v[52:53], v[52:53], v[92:93] op_sel_hi:[1,0] neg_lo:[0,1] neg_hi:[0,1]
  v_cvt_pk_bf16_f32 v98, v98, v98
  v_pk_add_f32 v[54:55], v[54:55], v[92:93] op_sel_hi:[1,0] neg_lo:[0,1] neg_hi:[0,1]
  v_lshlrev_b32 v98, 16, v98
  v_pk_add_f32 v[56:57], v[56:57], v[92:93] op_sel_hi:[1,0] neg_lo:[0,1] neg_hi:[0,1]
  v_sqrt_f32 v98, v98
  v_pk_add_f32 v[58:59], v[58:59], v[92:93] op_sel_hi:[1,0] neg_lo:[0,1] neg_hi:[0,1]
  v_cvt_pk_bf16_f32 v98, v98, v98
  v_pk_add_f32 v[60:61], v[60:61], v[92:93] op_sel_hi:[1,0] neg_lo:[0,1] neg_hi:[0,1]
  v_lshlrev_b32 v98, 16, v98
  v_pk_add_f32 v[62:63], v[62:63], v[92:93] op_sel_hi:[1,0] neg_lo:[0,1] neg_hi:[0,1]
  v_rcp_f32 v100, v98
  v_pk_add_f32 v[64:65], v[64:65], v[92:93] op_sel_hi:[1,0] neg_lo:[0,1] neg_hi:[0,1]
  v_pk_add_f32 v[66:67], v[66:67], v[92:93] op_sel_hi:[1,0] neg_lo:[0,1] neg_hi:[0,1]
  v_pk_add_f32 v[68:69], v[68:69], v[92:93] op_sel_hi:[1,0] neg_lo:[0,1] neg_hi:[0,1]
  v_pk_add_f32 v[70:71], v[70:71], v[92:93] op_sel_hi:[1,0] neg_lo:[0,1] neg_hi:[0,1]
  v_pk_add_f32 v[72:73], v[72:73], v[92:93] op_sel_hi:[1,0] neg_lo:[0,1] neg_hi:[0,1]
  v_pk_add_f32 v[74:75], v[74:75], v[92:93] op_sel_hi:[1,0] neg_lo:[0,1] neg_hi:[0,1]
  v_pk_add_f32 v[76:77], v[76:77], v[92:93] op_sel_hi:[1,0] neg_lo:[0,1] neg_hi:[0,1]
  v_pk_add_f32 v[78:79], v[78:79], v[92:93] op_sel_hi:[1,0] neg_lo:[0,1] neg_hi:[0,1]
  v_pk_add_f32 v[80:81], v[80:81], v[92:93] op_sel_hi:[1,0] neg_lo:[0,1] neg_hi:[0,1]
  v_pk_add_f32 v[82:83], v[82:83], v[92:93] op_sel_hi:[1,0] neg_lo:[0,1] neg_hi:[0,1]
  v_pk_add_f32 v[84:85], v[84:85], v[92:93] op_sel_hi:[1,0] neg_lo:[0,1] neg_hi:[0,1]
  v_pk_add_f32 v[86:87], v[86:87], v[92:93] op_sel_hi:[1,0] neg_lo:[0,1] neg_hi:[0,1]
  v_mov_b32 v104, 0
  v_mov_b32 v105, 0
  v_cvt_pk_bf16_f32 v8, v48, v49
  v_cvt_pk_bf16_f32 v9, v50, v51
  v_cvt_pk_bf16_f32 v10, v52, v53
  v_cvt_pk_bf16_f32 v11, v54, v55
  v_cvt_pk_bf16_f32 v12, v56, v57
  v_cvt_pk_bf16_f32 v13, v58, v59
  v_cvt_pk_bf16_f32 v14, v60, v61
  v_cvt_pk_bf16_f32 v15, v62, v63
  v_cvt_pk_bf16_f32 v16, v64, v65
  v_cvt_pk_bf16_f32 v17, v66, v67
  v_cvt_pk_bf16_f32 v18, v68, v69
  v_cvt_pk_bf16_f32 v19, v70, v71
  v_cvt_pk_bf16_f32 v20, v72, v73
  v_cvt_pk_bf16_f32 v21, v74, v75
  v_cvt_pk_bf16_f32 v22, v76, v77
  v_cvt_pk_bf16_f32 v23, v78, v79
  v_cvt_pk_bf16_f32 v24, v80, v81
  v_cvt_pk_bf16_f32 v25, v82, v83
  v_cvt_pk_bf16_f32 v26, v84, v85
  v_cvt_pk_bf16_f32 v27, v86, v87
  v_lshlrev_b32 v48, 16, v8
  v_and_b32 v49, s56, v8
  v_lshlrev_b32 v50, 16, v9
  v_and_b32 v51, s56, v9
  v_lshlrev_b32 v52, 16, v10
  v_and_b32 v53, s56, v10
  v_lshlrev_b32 v54, 16, v11
  v_and_b32 v55, s56, v11
  v_lshlrev_b32 v56, 16, v12
  v_and_b32 v57, s56, v12
  v_lshlrev_b32 v58, 16, v13
  v_and_b32 v59, s56, v13
  v_lshlrev_b32 v60, 16, v14
  v_and_b32 v61, s56, v14
  v_lshlrev_b32 v62, 16, v15
  v_and_b32 v63, s56, v15
  v_lshlrev_b32 v64, 16, v16
  v_and_b32 v65, s56, v16
  v_lshlrev_b32 v66, 16, v17
  v_and_b32 v67, s56, v17
  v_lshlrev_b32 v68, 16, v18
  v_and_b32 v69, s56, v18
  v_lshlrev_b32 v70, 16, v19
  v_and_b32 v71, s56, v19
  v_lshlrev_b32 v72, 16, v20
  v_and_b32 v73, s56, v20
  v_lshlrev_b32 v74, 16, v21
  v_and_b32 v75, s56, v21
  v_lshlrev_b32 v76, 16, v22
  v_and_b32 v77, s56, v22
  v_lshlrev_b32 v78, 16, v23
  v_and_b32 v79, s56, v23
  v_lshlrev_b32 v80, 16, v24
  v_and_b32 v81, s56, v24
  v_lshlrev_b32 v82, 16, v25
  v_and_b32 v83, s56, v25
  v_lshlrev_b32 v84, 16, v26
  v_and_b32 v85, s56, v26
  v_lshlrev_b32 v86, 16, v27
  v_and_b32 v87, s56, v27
  v_pk_mul_f32 v[48:49], v[48:49], v[100:101] op_sel_hi:[1,0]
  v_pk_mul_f32 v[50:51], v[50:51], v[100:101] op_sel_hi:[1,0]
  v_pk_mul_f32 v[52:53], v[52:53], v[100:101] op_sel_hi:[1,0]
  v_pk_mul_f32 v[54:55], v[54:55], v[100:101] op_sel_hi:[1,0]
  v_cvt_pk_bf16_f32 v8, v48, v49
  v_cvt_pk_bf16_f32 v9, v50, v51
  v_cvt_pk_bf16_f32 v10, v52, v53
  v_cvt_pk_bf16_f32 v11, v54, v55
  buffer_store_dwordx4 v[8:11], v5, s[24:27], s53 offen sc1
  s_add_u32 s53, s53, 16384
  v_pk_mul_f32 v[56:57], v[56:57], v[100:101] op_sel_hi:[1,0]
  v_pk_mul_f32 v[58:59], v[58:59], v[100:101] op_sel_hi:[1,0]
  v_pk_mul_f32 v[60:61], v[60:61], v[100:101] op_sel_hi:[1,0]
  v_pk_mul_f32 v[62:63], v[62:63], v[100:101] op_sel_hi:[1,0]
  v_cvt_pk_bf16_f32 v12, v56, v57
  v_cvt_pk_bf16_f32 v13, v58, v59
  v_cvt_pk_bf16_f32 v14, v60, v61
  v_cvt_pk_bf16_f32 v15, v62, v63
  buffer_store_dwordx4 v[12:15], v5, s[24:27], s53 offen sc1
  s_add_u32 s53, s53, 16384
  v_pk_mul_f32 v[64:65], v[64:65], v[100:101] op_sel_hi:[1,0]
  v_pk_mul_f32 v[66:67], v[66:67], v[100:101] op_sel_hi:[1,0]
  v_pk_mul_f32 v[68:69], v[68:69], v[100:101] op_sel_hi:[1,0]
  v_pk_mul_f32 v[70:71], v[70:71], v[100:101] op_sel_hi:[1,0]
  v_cvt_pk_bf16_f32 v16, v64, v65
  v_cvt_pk_bf16_f32 v17, v66, v67
  v_cvt_pk_bf16_f32 v18, v68, v69
  v_cvt_pk_bf16_f32 v19, v70, v71
  buffer_store_dwordx4 v[16:19], v5, s[24:27], s53 offen sc1
  s_add_u32 s53, s53, 16384
  v_pk_mul_f32 v[72:73], v[72:73], v[100:101] op_sel_hi:[1,0]
  v_pk_mul_f32 v[74:75], v[74:75], v[100:101] op_sel_hi:[1,0]
  v_pk_mul_f32 v[76:77], v[76:77], v[100:101] op_sel_hi:[1,0]
  v_pk_mul_f32 v[78:79], v[78:79], v[100:101] op_sel_hi:[1,0]
  v_cvt_pk_bf16_f32 v20, v72, v73
  v_cvt_pk_bf16_f32 v21, v74, v75
  v_cvt_pk_bf16_f32 v22, v76, v77
  v_cvt_pk_bf16_f32 v23, v78, v79
  buffer_store_dwordx4 v[20:23], v5, s[24:27], s53 offen sc1
  s_add_u32 s53, s53, 16384
  v_pk_mul_f32 v[80:81], v[80:81], v[100:101] op_sel_hi:[1,0]
  v_pk_mul_f32 v[82:83], v[82:83], v[100:101] op_sel_hi:[1,0]
  v_pk_mul_f32 v[84:85], v[84:85], v[100:101] op_sel_hi:[1,0]
  v_pk_mul_f32 v[86:87], v[86:87], v[100:101] op_sel_hi:[1,0]
  v_cvt_pk_bf16_f32 v24, v80, v81
  v_cvt_pk_bf16_f32 v25, v82, v83
  v_cvt_pk_bf16_f32 v26, v84, v85
  v_cvt_pk_bf16_f32 v27, v86, v87
  buffer_store_dwordx4 v[24:27], v5, s[24:27], s53 offen sc1
  s_add_u32 s53, s53, 16384
  s_waitcnt vmcnt(12)
  v_dot2_f32_bf16 v104, v8, v28, v104
  v_dot2_f32_bf16 v105, v9, v29, v105
  v_dot2_f32_bf16 v104, v10, v30, v104
  v_dot2_f32_bf16 v105, v11, v31, v105
  s_waitcnt vmcnt(11)
  v_dot2_f32_bf16 v104, v12, v32, v104
  v_dot2_f32_bf16 v105, v13, v33, v105
  v_dot2_f32_bf16 v104, v14, v34, v104
  v_dot2_f32_bf16 v105, v15, v35, v105
  s_waitcnt vmcnt(10)
  v_dot2_f32_bf16 v104, v16, v36, v104
  v_dot2_f32_bf16 v105, v17, v37, v105
  v_dot2_f32_bf16 v104, v18, v38, v104
  v_dot2_f32_bf16 v105, v19, v39, v105
  s_waitcnt vmcnt(9)
  v_dot2_f32_bf16 v104, v20, v40, v104
  v_dot2_f32_bf16 v105, v21, v41, v105
  v_dot2_f32_bf16 v104, v22, v42, v104
  v_dot2_f32_bf16 v105, v23, v43, v105
  s_waitcnt vmcnt(8)
  v_dot2_f32_bf16 v104, v24, v44, v104
  v_dot2_f32_bf16 v105, v25, v45, v105
  v_dot2_f32_bf16 v104, v26, v46, v104
  v_dot2_f32_bf16 v105, v27, v47, v105
  s_nop 2
  v_add_f32 v104, v104, v105
  s_nop 1
  v_add_f32_dpp v104, v104, v104 row_ror:8 row_mask:0xf bank_mask:0xf
  s_nop 1
  v_add_f32_dpp v104, v104, v104 row_ror:4 row_mask:0xf bank_mask:0xf
  s_nop 1
  v_add_f32_dpp v104, v104, v104 row_ror:2 row_mask:0xf bank_mask:0xf
  s_nop 1
  v_add_f32_dpp v104, v104, v104 row_ror:1 row_mask:0xf bank_mask:0xf
  v_cvt_pk_bf16_f32 v104, v104, v104
  v_lshlrev_b32 v104, 16, v104
  v_ashrrev_i32 v105, 31, v104
  v_or_b32 v105, 0x80000000, v105
  v_xor_b32 v104, v104, v105
  v_and_b32 v104, s56, v104
  v_add_u32 v6, s52, v1
  v_sub_u32 v7, 0xffff, v6
  v_or_b32 v104, v104, v7
  v_lshlrev_b32 v6, 2, v6
  v_lshl_add_u32 v6, v2, 26, v6
  s_mov_b32 s53, 2621440
  buffer_store_dword v104, v6, s[24:27], s53 offen sc1
  s_waitcnt vmcnt(0)
  s_branch front_join
front_fetch:
  s_getpc_b64 s[98:99]
attn_hot_pc:
  s_add_u32 s98, s98, attn_hot-attn_hot_pc
  s_addc_u32 s99, s99, 0
  s_lshr_b32 s100, s2, 3
  v_min_u32 v249, 17, v0
  v_lshlrev_b32 v249, 5, v249
  v_add_u32 v249, s100, v249
  v_lshlrev_b32 v249, 7, v249
  v_min_u32 v249, attn_end-attn_hot-4, v249
  global_load_dword v255, v249, s[98:99]
attn_hot:
  v_subrev_u32 v16, 0x40000, v238
  v_subrev_u32 v17, 0x40000, v239
  v_subrev_u32 v18, 0x40000, v240
  v_subrev_u32 v19, 0x40000, v241
  s_mov_b32 s31, 0
  s_add_u32 m0, s28, 90112
  s_nop 0
  buffer_load_dwordx4 v16, s[20:23], s31 offen offset:0 lds
  buffer_load_dwordx4 v17, s[20:23], s31 offen offset:1024 lds
  buffer_load_dwordx4 v18, s[20:23], s31 offen offset:2048 lds
  buffer_load_dwordx4 v19, s[20:23], s31 offen offset:3072 lds
  s_add_u32 m0, s28, 98304
  s_nop 0
  buffer_load_dwordx4 v238, s[20:23], s31 offen offset:0 lds
  buffer_load_dwordx4 v239, s[20:23], s31 offen offset:1024 lds
  buffer_load_dwordx4 v240, s[20:23], s31 offen offset:2048 lds
  buffer_load_dwordx4 v241, s[20:23], s31 offen offset:3072 lds
front_join:
  s_waitcnt lgkmcnt(0)
  s_barrier
  s_mul_i32 s55, s59, 0x9e3779b1
  s_add_u32 s55, s55, 0x7f4a7c15
  s_lshr_b32 s58, s37, 2
  s_lshl_b32 s58, s58, 8
  s_add_u32 s58, s58, 2826240
  s_lshl_b32 s53, s36, 2
  s_lshl_b32 s54, s3, 26
  s_add_u32 s53, s53, s54
  v_min_u32 v1, 1, v0
  v_lshlrev_b32 v1, 28, v1
  v_add_u32 v1, s53, v1
  v_mov_b32 v2, s55
  buffer_store_dword v2, v1, s[24:27], s58 offen sc1
  s_cmp_lt_u32 s3, 2
  s_cbranch_scc1 front_addr
  s_mov_b32 s31, 524288
  s_add_u32 m0, s28, 106496
  s_nop 0
  buffer_load_dwordx4 v16, s[20:23], s31 offen offset:0 lds
  buffer_load_dwordx4 v17, s[20:23], s31 offen offset:1024 lds
  buffer_load_dwordx4 v18, s[20:23], s31 offen offset:2048 lds
  buffer_load_dwordx4 v19, s[20:23], s31 offen offset:3072 lds
  s_add_u32 m0, s28, 114688
  s_nop 0
  buffer_load_dwordx4 v238, s[20:23], s31 offen offset:0 lds
  buffer_load_dwordx4 v239, s[20:23], s31 offen offset:1024 lds
  buffer_load_dwordx4 v240, s[20:23], s31 offen offset:2048 lds
  buffer_load_dwordx4 v241, s[20:23], s31 offen offset:3072 lds
  s_mov_b32 s31, 1048576
  s_add_u32 m0, s28, 24576
  s_nop 0
  buffer_load_dwordx4 v16, s[20:23], s31 offen offset:0 lds
  buffer_load_dwordx4 v17, s[20:23], s31 offen offset:1024 lds
  buffer_load_dwordx4 v18, s[20:23], s31 offen offset:2048 lds
  buffer_load_dwordx4 v19, s[20:23], s31 offen offset:3072 lds
  s_add_u32 m0, s28, 32768
  s_nop 0
  buffer_load_dwordx4 v238, s[20:23], s31 offen offset:0 lds
  buffer_load_dwordx4 v239, s[20:23], s31 offen offset:1024 lds
  buffer_load_dwordx4 v240, s[20:23], s31 offen offset:2048 lds
  buffer_load_dwordx4 v241, s[20:23], s31 offen offset:3072 lds
  s_mov_b32 s31, 1572864
  s_add_u32 m0, s28, 40960
  s_nop 0
  buffer_load_dwordx4 v16, s[20:23], s31 offen offset:0 lds
  buffer_load_dwordx4 v17, s[20:23], s31 offen offset:1024 lds
  buffer_load_dwordx4 v18, s[20:23], s31 offen offset:2048 lds
  buffer_load_dwordx4 v19, s[20:23], s31 offen offset:3072 lds
  s_add_u32 m0, s28, 49152
  s_nop 0
  buffer_load_dwordx4 v238, s[20:23], s31 offen offset:0 lds
  buffer_load_dwordx4 v239, s[20:23], s31 offen offset:1024 lds
  buffer_load_dwordx4 v240, s[20:23], s31 offen offset:2048 lds
  buffer_load_dwordx4 v241, s[20:23], s31 offen offset:3072 lds
front_addr:
  s_mov_b32 s31, 2097152
  v_lshlrev_b32 v242, 4, v245
  v_add_u32 v243, 0x1000, v242
  s_mul_i32 s30, s37, 81920
  s_lshl_b32 s38, s36, 19
  s_add_u32 s12, s4, s38
  s_addc_u32 s13, s5, 0
  s_mov_b32 s14, 524288
  s_mov_b32 s15, 0x20000
  s_add_u32 s16, s6, s38
  s_addc_u32 s17, s7, 0
  s_mov_b32 s18, 524288
  s_mov_b32 s19, 0x20000
  v_lshlrev_b32 v249, 8, v248
  v_add_u32 v249, s28, v249
  v_add_u32 v250, 0, v248
  v_xor_b32 v250, v250, v247
  v_lshl_add_u32 v232, v250, 4, v249
  v_add_u32 v250, 4, v248
  v_xor_b32 v250, v250, v247
  v_lshl_add_u32 v233, v250, 4, v249
  v_add_u32 v250, 8, v248
  v_xor_b32 v250, v250, v247
  v_lshl_add_u32 v234, v250, 4, v249
  v_add_u32 v250, 12, v248
  v_xor_b32 v250, v250, v247
  v_lshl_add_u32 v235, v250, 4, v249
  v_add_u32 v250, 0, v248
  v_lshlrev_b32 v250, 1, v250
  v_xor_b32 v250, v250, v247
  v_lshl_add_u32 v236, v250, 4, v249
  v_add_u32 v250, 4, v248
  v_lshlrev_b32 v250, 1, v250
  v_xor_b32 v250, v250, v247
  v_lshl_add_u32 v237, v250, 4, v249
  v_lshrrev_b32 v249, 1, v248
  v_and_b32 v250, 1, v248
  v_lshl_or_b32 v249, v250, 1, v249
  v_xor_b32 v249, v249, v247
  v_lshlrev_b32 v249, 4, v249
  v_lshl_add_u32 v212, v247, 8, v249
  v_xor_b32 v213, 64, v212
  v_xor_b32 v214, 128, v212
  v_xor_b32 v215, 192, v212
  v_bfe_u32 v246, v245, 2, 2
  v_and_b32 v247, 3, v245
  v_lshlrev_b32 v247, 3, v247
  v_add_u32 v247, 65536, v247
  v_lshl_add_u32 v249, v248, 3, v246
  v_and_b32 v250, 1, v248
  v_lshl_add_u32 v250, v250, 2, v246
  v_lshl_add_u32 v250, v250, 5, v247
  v_lshl_add_u32 v224, v249, 8, v250
  v_xor_b32 v225, 32, v224
  v_xor_b32 v226, 64, v224
  v_xor_b32 v227, 96, v224
  v_xor_b32 v228, 128, v224
  v_xor_b32 v229, 160, v224
  v_xor_b32 v230, 192, v224
  v_xor_b32 v231, 224, v224
  v_lshl_add_u32 v249, v248, 2, v246
  v_and_b32 v250, 7, v249
  v_lshl_add_u32 v250, v250, 5, v247
  v_lshl_add_u32 v216, v249, 8, v250
  v_xor_b32 v217, 32, v216
  v_xor_b32 v218, 64, v216
  v_xor_b32 v219, 96, v216
  v_xor_b32 v220, 128, v216
  v_xor_b32 v221, 160, v216
  v_xor_b32 v222, 192, v216
  v_xor_b32 v223, 224, v216
  v_subrev_u32 v148, 65536, v224
  v_subrev_u32 v149, 65536, v225
  v_subrev_u32 v150, 65536, v226
  v_subrev_u32 v151, 65536, v227
  v_subrev_u32 v152, 65536, v228
  v_subrev_u32 v153, 65536, v229
  v_subrev_u32 v154, 65536, v230
  v_subrev_u32 v155, 65536, v231
  s_lshr_b32 s38, s2, 3
  s_min_u32 s38, s38, 26
  s_and_b32 s39, s2, 7
  s_mul_i32 s39, s39, 27
  s_add_u32 s33, s38, s39
  s_mul_i32 s50, s3, 6144
  s_add_u32 s50, s50, 133120
  v_mov_b32 v244, v242
  s_lshl_b32 s40, s37, 19
  s_lshl_b32 s38, s36, 14
  s_add_u32 s40, s40, s38
  s_add_u32 s40, s40, 8388608
  s_add_u32 s41, s40, 4096
  s_add_u32 s42, s40, 8192
  s_add_u32 s43, s40, 12288
  s_mov_b32 s34, 0x3e0293ee
  s_mov_b32 s29, 0
  v_and_b32 v249, 3, v245
  v_cmp_eq_u32 vcc, 0, v249
  v_mov_b32 v249, 0x3f803f80
  s_nop 0
  v_cndmask_b32 v249, 0, v249, vcc
  v_accvgpr_write_b32 a208, v249
  v_accvgpr_write_b32 a209, v249
  v_accvgpr_write_b32 a210, v249
  v_accvgpr_write_b32 a211, v249
  v_lshlrev_b32 v249, 2, v245
  v_add_u32 v249, 131072, v249
  v_mov_b32 v250, 0
  ds_write_b32 v249, v250
  v_and_b32 v2, 7, v0
  v_lshlrev_b32 v2, 2, v2
  s_lshl_b32 s54, s3, 5
  v_add_u32 v2, s54, v2
  s_mov_b32 s54, 32768
  buffer_load_dword v3, v2, s[24:27], s58 offen sc1
  s_sleep 2
  buffer_load_dword v4, v2, s[24:27], s58 offen sc1
  s_sleep 2
  buffer_load_dword v5, v2, s[24:27], s58 offen sc1
  s_sleep 2
front_poll:
  buffer_load_dword v6, v2, s[24:27], s58 offen sc1
  s_waitcnt vmcnt(3)
  v_cmp_ne_u32 vcc, s55, v3
  s_nop 0
  s_cbranch_vccz front_go
  s_sleep 2
  buffer_load_dword v3, v2, s[24:27], s58 offen sc1
  s_waitcnt vmcnt(3)
  v_cmp_ne_u32 vcc, s55, v4
  s_nop 0
  s_cbranch_vccz front_go
  s_sleep 2
  buffer_load_dword v4, v2, s[24:27], s58 offen sc1
  s_waitcnt vmcnt(3)
  v_cmp_ne_u32 vcc, s55, v5
  s_nop 0
  s_cbranch_vccz front_go
  s_sleep 2
  buffer_load_dword v5, v2, s[24:27], s58 offen sc1
  s_waitcnt vmcnt(3)
  v_cmp_ne_u32 vcc, s55, v6
  s_nop 0
  s_cbranch_vccz front_go
  s_sleep 2
  s_sub_u32 s54, s54, 1
  s_cmp_lg_u32 s54, 0
  s_cbranch_scc1 front_poll
front_go:
  buffer_load_dwordx4 a[0:3], v242, s[24:27], s30 offen offset:0 sc1
  buffer_load_dwordx4 a[4:7], v242, s[24:27], s30 offen offset:1024 sc1
  buffer_load_dwordx4 a[8:11], v242, s[24:27], s30 offen offset:2048 sc1
  buffer_load_dwordx4 a[12:15], v242, s[24:27], s30 offen offset:3072 sc1
  buffer_load_dwordx4 a[16:19], v243, s[24:27], s30 offen offset:0 sc1
  buffer_load_dwordx4 a[20:23], v243, s[24:27], s30 offen offset:1024 sc1
  buffer_load_dwordx4 a[24:27], v243, s[24:27], s30 offen offset:2048 sc1
  buffer_load_dwordx4 a[28:31], v243, s[24:27], s30 offen offset:3072 sc1
  s_add_u32 s30, s30, 8192
  buffer_load_dwordx4 a[32:35], v242, s[24:27], s30 offen offset:0 sc1
  buffer_load_dwordx4 a[36:39], v242, s[24:27], s30 offen offset:1024 sc1
  buffer_load_dwordx4 a[40:43], v242, s[24:27], s30 offen offset:2048 sc1
  buffer_load_dwordx4 a[44:47], v242, s[24:27], s30 offen offset:3072 sc1
  buffer_load_dwordx4 a[48:51], v243, s[24:27], s30 offen offset:0 sc1
  buffer_load_dwordx4 a[52:55], v243, s[24:27], s30 offen offset:1024 sc1
  buffer_load_dwordx4 a[56:59], v243, s[24:27], s30 offen offset:2048 sc1
  buffer_load_dwordx4 a[60:63], v243, s[24:27], s30 offen offset:3072 sc1
  s_add_u32 s30, s30, 8192
  v_lshrrev_b32 v140, 7, v242
  v_lshlrev_b32 v140, 8, v140
  v_and_b32 v136, 0x70, v242
  v_add_u32 v140, v140, v136
  s_mov_b32 s58, 2826240
  buffer_load_dwordx4 v[136:139], v140, s[24:27], s58 offen sc1
  s_barrier
  ds_read_b64_tr_b16 a[160:161], v224 offset:32768
  ds_read_b64_tr_b16 a[162:163], v224 offset:33792
  ds_read_b64_tr_b16 a[164:165], v224 offset:40960
  ds_read_b64_tr_b16 a[166:167], v224 offset:41984
  ds_read_b64_tr_b16 a[168:169], v225 offset:32768
  ds_read_b64_tr_b16 a[170:171], v225 offset:33792
  ds_read_b64_tr_b16 a[172:173], v225 offset:40960
  ds_read_b64_tr_b16 a[174:175], v225 offset:41984
  s_waitcnt vmcnt(9) lgkmcnt(4)
  v_mfma_f32_16x16x32_bf16 v[0:3], a[160:163], a[0:3], 0
  ds_read_b64_tr_b16 a[176:177], v226 offset:32768
  v_mfma_f32_16x16x32_bf16 v[0:3], a[164:167], a[16:19], v[0:3]
  buffer_load_dwordx4 a[64:67], v242, s[24:27], s30 offen offset:0 sc1
  v_mfma_f32_16x16x32_bf16 v[4:7], a[164:167], a[20:23], 0
  ds_read_b64_tr_b16 a[178:179], v226 offset:33792
  v_mfma_f32_16x16x32_bf16 v[4:7], a[160:163], a[4:7], v[4:7]
  buffer_load_dwordx4 a[68:71], v242, s[24:27], s30 offen offset:1024 sc1
  v_mfma_f32_16x16x32_bf16 v[8:11], a[160:163], a[8:11], 0
  ds_read_b64_tr_b16 a[180:181], v226 offset:40960
  v_mfma_f32_16x16x32_bf16 v[8:11], a[164:167], a[24:27], v[8:11]
  v_mfma_f32_16x16x32_bf16 v[12:15], a[164:167], a[28:31], 0
  ds_read_b64_tr_b16 a[182:183], v226 offset:41984
  v_mfma_f32_16x16x32_bf16 v[12:15], a[160:163], a[12:15], v[12:15]
  s_waitcnt lgkmcnt(4)
  buffer_load_dwordx4 a[72:75], v242, s[24:27], s30 offen offset:2048 sc1
  v_mfma_f32_16x16x32_bf16 v[16:19], a[168:171], a[0:3], 0
  ds_read_b64_tr_b16 a[184:185], v227 offset:32768
  v_mfma_f32_16x16x32_bf16 v[16:19], a[172:175], a[16:19], v[16:19]
  v_mfma_f32_16x16x32_bf16 v[20:23], a[172:175], a[20:23], 0
  ds_read_b64_tr_b16 a[186:187], v227 offset:33792
  v_mfma_f32_16x16x32_bf16 v[20:23], a[168:171], a[4:7], v[20:23]
  buffer_load_dwordx4 a[76:79], v242, s[24:27], s30 offen offset:3072 sc1
  v_mfma_f32_16x16x32_bf16 v[24:27], a[168:171], a[8:11], 0
  ds_read_b64_tr_b16 a[188:189], v227 offset:40960
  v_mfma_f32_16x16x32_bf16 v[24:27], a[172:175], a[24:27], v[24:27]
  buffer_load_dwordx4 a[80:83], v243, s[24:27], s30 offen offset:0 sc1
  v_mfma_f32_16x16x32_bf16 v[28:31], a[172:175], a[28:31], 0
  ds_read_b64_tr_b16 a[190:191], v227 offset:41984
  v_mfma_f32_16x16x32_bf16 v[28:31], a[168:171], a[12:15], v[28:31]
  s_waitcnt lgkmcnt(4)
  v_mfma_f32_16x16x32_bf16 v[32:35], a[176:179], a[0:3], 0
  ds_read_b64_tr_b16 a[160:161], v228 offset:32768
  v_mfma_f32_16x16x32_bf16 v[32:35], a[180:183], a[16:19], v[32:35]
  buffer_load_dwordx4 a[84:87], v243, s[24:27], s30 offen offset:1024 sc1
  v_mfma_f32_16x16x32_bf16 v[36:39], a[180:183], a[20:23], 0
  ds_read_b64_tr_b16 a[162:163], v228 offset:33792
  v_mfma_f32_16x16x32_bf16 v[36:39], a[176:179], a[4:7], v[36:39]
  v_mfma_f32_16x16x32_bf16 v[40:43], a[176:179], a[8:11], 0
  ds_read_b64_tr_b16 a[164:165], v228 offset:40960
  v_mfma_f32_16x16x32_bf16 v[40:43], a[180:183], a[24:27], v[40:43]
  buffer_load_dwordx4 a[88:91], v243, s[24:27], s30 offen offset:2048 sc1
  v_mfma_f32_16x16x32_bf16 v[44:47], a[180:183], a[28:31], 0
  ds_read_b64_tr_b16 a[166:167], v228 offset:41984
  v_mfma_f32_16x16x32_bf16 v[44:47], a[176:179], a[12:15], v[44:47]
  s_waitcnt lgkmcnt(4)
  buffer_load_dwordx4 a[92:95], v243, s[24:27], s30 offen offset:3072 sc1
  v_mfma_f32_16x16x32_bf16 v[48:51], a[184:187], a[0:3], 0
  ds_read_b64_tr_b16 a[168:169], v229 offset:32768
  v_mfma_f32_16x16x32_bf16 v[48:51], a[188:191], a[16:19], v[48:51]
  v_mfma_f32_16x16x32_bf16 v[52:55], a[188:191], a[20:23], 0
  ds_read_b64_tr_b16 a[170:171], v229 offset:33792
  v_mfma_f32_16x16x32_bf16 v[52:55], a[184:187], a[4:7], v[52:55]
  s_add_u32 s30, s30, 8192
  v_mfma_f32_16x16x32_bf16 v[56:59], a[184:187], a[8:11], 0
  ds_read_b64_tr_b16 a[172:173], v229 offset:40960
  v_mfma_f32_16x16x32_bf16 v[56:59], a[188:191], a[24:27], v[56:59]
  v_mfma_f32_16x16x32_bf16 v[60:63], a[188:191], a[28:31], 0
  ds_read_b64_tr_b16 a[174:175], v229 offset:41984
  v_mfma_f32_16x16x32_bf16 v[60:63], a[184:187], a[12:15], v[60:63]
  s_waitcnt lgkmcnt(4)
  buffer_load_dwordx4 a[96:99], v242, s[24:27], s30 offen offset:0 sc1
  v_mfma_f32_16x16x32_bf16 v[64:67], a[160:163], a[0:3], 0
  ds_read_b64_tr_b16 a[176:177], v230 offset:32768
  v_mfma_f32_16x16x32_bf16 v[64:67], a[164:167], a[16:19], v[64:67]
  buffer_load_dwordx4 a[100:103], v242, s[24:27], s30 offen offset:1024 sc1
  v_mfma_f32_16x16x32_bf16 v[68:71], a[164:167], a[20:23], 0
  ds_read_b64_tr_b16 a[178:179], v230 offset:33792
  v_mfma_f32_16x16x32_bf16 v[68:71], a[160:163], a[4:7], v[68:71]
  v_mfma_f32_16x16x32_bf16 v[72:75], a[160:163], a[8:11], 0
  ds_read_b64_tr_b16 a[180:181], v230 offset:40960
  v_mfma_f32_16x16x32_bf16 v[72:75], a[164:167], a[24:27], v[72:75]
  buffer_load_dwordx4 a[104:107], v242, s[24:27], s30 offen offset:2048 sc1
  v_mfma_f32_16x16x32_bf16 v[76:79], a[164:167], a[28:31], 0
  ds_read_b64_tr_b16 a[182:183], v230 offset:41984
  v_mfma_f32_16x16x32_bf16 v[76:79], a[160:163], a[12:15], v[76:79]
  s_waitcnt lgkmcnt(4)
  v_mfma_f32_16x16x32_bf16 v[80:83], a[168:171], a[0:3], 0
  ds_read_b64_tr_b16 a[184:185], v231 offset:32768
  v_mfma_f32_16x16x32_bf16 v[80:83], a[172:175], a[16:19], v[80:83]
  buffer_load_dwordx4 a[108:111], v242, s[24:27], s30 offen offset:3072 sc1
  v_mfma_f32_16x16x32_bf16 v[84:87], a[172:175], a[20:23], 0
  ds_read_b64_tr_b16 a[186:187], v231 offset:33792
  v_mfma_f32_16x16x32_bf16 v[84:87], a[168:171], a[4:7], v[84:87]
  buffer_load_dwordx4 a[112:115], v243, s[24:27], s30 offen offset:0 sc1
  v_mfma_f32_16x16x32_bf16 v[88:91], a[168:171], a[8:11], 0
  ds_read_b64_tr_b16 a[188:189], v231 offset:40960
  v_mfma_f32_16x16x32_bf16 v[88:91], a[172:175], a[24:27], v[88:91]
  s_barrier
  v_mfma_f32_16x16x32_bf16 v[92:95], a[172:175], a[28:31], 0
  ds_read_b64_tr_b16 a[190:191], v231 offset:41984
  v_mfma_f32_16x16x32_bf16 v[92:95], a[168:171], a[12:15], v[92:95]
  s_waitcnt lgkmcnt(4)
  buffer_load_dwordx4 a[116:119], v243, s[24:27], s30 offen offset:1024 sc1
  v_mfma_f32_16x16x32_bf16 v[96:99], a[176:179], a[0:3], 0
  ds_read_b64_tr_b16 a[160:161], v224 offset:49152
  v_mfma_f32_16x16x32_bf16 v[96:99], a[180:183], a[16:19], v[96:99]
  v_mfma_f32_16x16x32_bf16 v[100:103], a[180:183], a[20:23], 0
  ds_read_b64_tr_b16 a[162:163], v224 offset:50176
  v_mfma_f32_16x16x32_bf16 v[100:103], a[176:179], a[4:7], v[100:103]
  buffer_load_dwordx4 a[120:123], v243, s[24:27], s30 offen offset:2048 sc1
  v_mfma_f32_16x16x32_bf16 v[104:107], a[176:179], a[8:11], 0
  ds_read_b64_tr_b16 a[164:165], v224 offset:57344
  v_mfma_f32_16x16x32_bf16 v[104:107], a[180:183], a[24:27], v[104:107]
  buffer_load_dwordx4 a[124:127], v243, s[24:27], s30 offen offset:3072 sc1
  v_mfma_f32_16x16x32_bf16 v[108:111], a[180:183], a[28:31], 0
  ds_read_b64_tr_b16 a[166:167], v224 offset:58368
  v_mfma_f32_16x16x32_bf16 v[108:111], a[176:179], a[12:15], v[108:111]
  s_waitcnt lgkmcnt(4)
  v_mfma_f32_16x16x32_bf16 v[112:115], a[184:187], a[0:3], 0
  ds_read_b64_tr_b16 a[168:169], v225 offset:49152
  v_mfma_f32_16x16x32_bf16 v[112:115], a[188:191], a[16:19], v[112:115]
  s_add_u32 s30, s30, 8192
  v_mfma_f32_16x16x32_bf16 v[116:119], a[188:191], a[20:23], 0
  ds_read_b64_tr_b16 a[170:171], v225 offset:50176
  v_mfma_f32_16x16x32_bf16 v[116:119], a[184:187], a[4:7], v[116:119]
  v_mfma_f32_16x16x32_bf16 v[120:123], a[184:187], a[8:11], 0
  ds_read_b64_tr_b16 a[172:173], v225 offset:57344
  v_mfma_f32_16x16x32_bf16 v[120:123], a[188:191], a[24:27], v[120:123]
  v_mfma_f32_16x16x32_bf16 v[124:127], a[188:191], a[28:31], 0
  ds_read_b64_tr_b16 a[174:175], v225 offset:58368
  v_mfma_f32_16x16x32_bf16 v[124:127], a[184:187], a[12:15], v[124:127]
  s_waitcnt vmcnt(17) lgkmcnt(4)
  v_mfma_f32_16x16x32_bf16 v[0:3], a[160:163], a[32:35], v[0:3]
  ds_read_b64_tr_b16 a[176:177], v226 offset:49152
  v_mfma_f32_16x16x32_bf16 v[0:3], a[164:167], a[48:51], v[0:3]
  buffer_load_dwordx4 a[0:3], v242, s[24:27], s30 offen offset:0 sc1
  v_mfma_f32_16x16x32_bf16 v[4:7], a[164:167], a[52:55], v[4:7]
  ds_read_b64_tr_b16 a[178:179], v226 offset:50176
  v_mfma_f32_16x16x32_bf16 v[4:7], a[160:163], a[36:39], v[4:7]
  v_mfma_f32_16x16x32_bf16 v[8:11], a[160:163], a[40:43], v[8:11]
  ds_read_b64_tr_b16 a[180:181], v226 offset:57344
  s_add_u32 m0, s28, 16384
  v_mfma_f32_16x16x32_bf16 v[8:11], a[164:167], a[56:59], v[8:11]
  buffer_load_dwordx4 v238, s[20:23], s31 offen offset:0 lds
  v_mfma_f32_16x16x32_bf16 v[12:15], a[164:167], a[60:63], v[12:15]
  ds_read_b64_tr_b16 a[182:183], v226 offset:58368
  v_mfma_f32_16x16x32_bf16 v[12:15], a[160:163], a[44:47], v[12:15]
  s_waitcnt lgkmcnt(4)
  v_mfma_f32_16x16x32_bf16 v[16:19], a[168:171], a[32:35], v[16:19]
  ds_read_b64_tr_b16 a[184:185], v227 offset:49152
  v_mfma_f32_16x16x32_bf16 v[16:19], a[172:175], a[48:51], v[16:19]
  buffer_load_dwordx4 a[4:7], v242, s[24:27], s30 offen offset:1024 sc1
  v_mfma_f32_16x16x32_bf16 v[20:23], a[172:175], a[52:55], v[20:23]
  ds_read_b64_tr_b16 a[186:187], v227 offset:50176
  v_mfma_f32_16x16x32_bf16 v[20:23], a[168:171], a[36:39], v[20:23]
  v_mfma_f32_16x16x32_bf16 v[24:27], a[168:171], a[40:43], v[24:27]
  ds_read_b64_tr_b16 a[188:189], v227 offset:57344
  v_mfma_f32_16x16x32_bf16 v[24:27], a[172:175], a[56:59], v[24:27]
  v_mfma_f32_16x16x32_bf16 v[28:31], a[172:175], a[60:63], v[28:31]
  ds_read_b64_tr_b16 a[190:191], v227 offset:58368
  v_mfma_f32_16x16x32_bf16 v[28:31], a[168:171], a[44:47], v[28:31]
  s_waitcnt lgkmcnt(4)
  v_mfma_f32_16x16x32_bf16 v[32:35], a[176:179], a[32:35], v[32:35]
  ds_read_b64_tr_b16 a[160:161], v228 offset:49152
  v_mfma_f32_16x16x32_bf16 v[32:35], a[180:183], a[48:51], v[32:35]
  buffer_load_dwordx4 a[8:11], v242, s[24:27], s30 offen offset:2048 sc1
  v_mfma_f32_16x16x32_bf16 v[36:39], a[180:183], a[52:55], v[36:39]
  ds_read_b64_tr_b16 a[162:163], v228 offset:50176
  v_mfma_f32_16x16x32_bf16 v[36:39], a[176:179], a[36:39], v[36:39]
  v_mfma_f32_16x16x32_bf16 v[40:43], a[176:179], a[40:43], v[40:43]
  ds_read_b64_tr_b16 a[164:165], v228 offset:57344
  v_mfma_f32_16x16x32_bf16 v[40:43], a[180:183], a[56:59], v[40:43]
  buffer_load_dwordx4 v239, s[20:23], s31 offen offset:1024 lds
  v_mfma_f32_16x16x32_bf16 v[44:47], a[180:183], a[60:63], v[44:47]
  ds_read_b64_tr_b16 a[166:167], v228 offset:58368
  v_mfma_f32_16x16x32_bf16 v[44:47], a[176:179], a[44:47], v[44:47]
  s_waitcnt lgkmcnt(4)
  v_mfma_f32_16x16x32_bf16 v[48:51], a[184:187], a[32:35], v[48:51]
  ds_read_b64_tr_b16 a[168:169], v229 offset:49152
  v_mfma_f32_16x16x32_bf16 v[48:51], a[188:191], a[48:51], v[48:51]
  buffer_load_dwordx4 a[12:15], v242, s[24:27], s30 offen offset:3072 sc1
  v_mfma_f32_16x16x32_bf16 v[52:55], a[188:191], a[52:55], v[52:55]
  ds_read_b64_tr_b16 a[170:171], v229 offset:50176
  v_mfma_f32_16x16x32_bf16 v[52:55], a[184:187], a[36:39], v[52:55]
  v_mfma_f32_16x16x32_bf16 v[56:59], a[184:187], a[40:43], v[56:59]
  ds_read_b64_tr_b16 a[172:173], v229 offset:57344
  v_mfma_f32_16x16x32_bf16 v[56:59], a[188:191], a[56:59], v[56:59]
  v_mfma_f32_16x16x32_bf16 v[60:63], a[188:191], a[60:63], v[60:63]
  ds_read_b64_tr_b16 a[174:175], v229 offset:58368
  v_mfma_f32_16x16x32_bf16 v[60:63], a[184:187], a[44:47], v[60:63]
  s_waitcnt lgkmcnt(4)
  v_mfma_f32_16x16x32_bf16 v[64:67], a[160:163], a[32:35], v[64:67]
  ds_read_b64_tr_b16 a[176:177], v230 offset:49152
  v_mfma_f32_16x16x32_bf16 v[64:67], a[164:167], a[48:51], v[64:67]
  buffer_load_dwordx4 a[16:19], v243, s[24:27], s30 offen offset:0 sc1
  v_mfma_f32_16x16x32_bf16 v[68:71], a[164:167], a[52:55], v[68:71]
  ds_read_b64_tr_b16 a[178:179], v230 offset:50176
  v_mfma_f32_16x16x32_bf16 v[68:71], a[160:163], a[36:39], v[68:71]
  v_mfma_f32_16x16x32_bf16 v[72:75], a[160:163], a[40:43], v[72:75]
  ds_read_b64_tr_b16 a[180:181], v230 offset:57344
  v_mfma_f32_16x16x32_bf16 v[72:75], a[164:167], a[56:59], v[72:75]
  buffer_load_dwordx4 v240, s[20:23], s31 offen offset:2048 lds
  v_mfma_f32_16x16x32_bf16 v[76:79], a[164:167], a[60:63], v[76:79]
  ds_read_b64_tr_b16 a[182:183], v230 offset:58368
  v_mfma_f32_16x16x32_bf16 v[76:79], a[160:163], a[44:47], v[76:79]
  s_waitcnt lgkmcnt(4)
  v_mfma_f32_16x16x32_bf16 v[80:83], a[168:171], a[32:35], v[80:83]
  ds_read_b64_tr_b16 a[184:185], v231 offset:49152
  v_mfma_f32_16x16x32_bf16 v[80:83], a[172:175], a[48:51], v[80:83]
  buffer_load_dwordx4 a[20:23], v243, s[24:27], s30 offen offset:1024 sc1
  v_mfma_f32_16x16x32_bf16 v[84:87], a[172:175], a[52:55], v[84:87]
  ds_read_b64_tr_b16 a[186:187], v231 offset:50176
  v_mfma_f32_16x16x32_bf16 v[84:87], a[168:171], a[36:39], v[84:87]
  v_mfma_f32_16x16x32_bf16 v[88:91], a[168:171], a[40:43], v[88:91]
  ds_read_b64_tr_b16 a[188:189], v231 offset:57344
  v_mfma_f32_16x16x32_bf16 v[88:91], a[172:175], a[56:59], v[88:91]
  s_barrier
  v_mfma_f32_16x16x32_bf16 v[92:95], a[172:175], a[60:63], v[92:95]
  ds_read_b64_tr_b16 a[190:191], v231 offset:58368
  v_mfma_f32_16x16x32_bf16 v[92:95], a[168:171], a[44:47], v[92:95]
  s_waitcnt lgkmcnt(4)
  v_mfma_f32_16x16x32_bf16 v[96:99], a[176:179], a[32:35], v[96:99]
  ds_read_b64_tr_b16 a[160:161], v148 offset:32768
  v_mfma_f32_16x16x32_bf16 v[96:99], a[180:183], a[48:51], v[96:99]
  buffer_load_dwordx4 a[24:27], v243, s[24:27], s30 offen offset:2048 sc1
  v_mfma_f32_16x16x32_bf16 v[100:103], a[180:183], a[52:55], v[100:103]
  ds_read_b64_tr_b16 a[162:163], v148 offset:33792
  v_mfma_f32_16x16x32_bf16 v[100:103], a[176:179], a[36:39], v[100:103]
  v_mfma_f32_16x16x32_bf16 v[104:107], a[176:179], a[40:43], v[104:107]
  ds_read_b64_tr_b16 a[164:165], v148 offset:40960
  v_mfma_f32_16x16x32_bf16 v[104:107], a[180:183], a[56:59], v[104:107]
  buffer_load_dwordx4 v241, s[20:23], s31 offen offset:3072 lds
  s_add_u32 s31, s31, 0x80000
  v_mfma_f32_16x16x32_bf16 v[108:111], a[180:183], a[60:63], v[108:111]
  ds_read_b64_tr_b16 a[166:167], v148 offset:41984
  v_mfma_f32_16x16x32_bf16 v[108:111], a[176:179], a[44:47], v[108:111]
  s_waitcnt lgkmcnt(4)
  v_mfma_f32_16x16x32_bf16 v[112:115], a[184:187], a[32:35], v[112:115]
  ds_read_b64_tr_b16 a[168:169], v149 offset:32768
  v_mfma_f32_16x16x32_bf16 v[112:115], a[188:191], a[48:51], v[112:115]
  buffer_load_dwordx4 a[28:31], v243, s[24:27], s30 offen offset:3072 sc1
  s_add_u32 s30, s30, 8192
  v_mfma_f32_16x16x32_bf16 v[116:119], a[188:191], a[52:55], v[116:119]
  ds_read_b64_tr_b16 a[170:171], v149 offset:33792
  v_mfma_f32_16x16x32_bf16 v[116:119], a[184:187], a[36:39], v[116:119]
  v_mfma_f32_16x16x32_bf16 v[120:123], a[184:187], a[40:43], v[120:123]
  ds_read_b64_tr_b16 a[172:173], v149 offset:40960
  v_mfma_f32_16x16x32_bf16 v[120:123], a[188:191], a[56:59], v[120:123]
  v_mfma_f32_16x16x32_bf16 v[124:127], a[188:191], a[60:63], v[124:127]
  ds_read_b64_tr_b16 a[174:175], v149 offset:41984
  v_mfma_f32_16x16x32_bf16 v[124:127], a[184:187], a[44:47], v[124:127]
  s_waitcnt vmcnt(20) lgkmcnt(4)
  v_xor_b32 v136, s55, v136
  v_xor_b32 v137, s55, v137
  v_xor_b32 v138, s55, v138
  v_xor_b32 v139, s55, v139
  v_or3_b32 v136, v136, v137, v138
  v_or_b32 v136, v136, v139
  v_cmp_ne_u32 vcc, 0, v136
  s_nop 0
  s_cbranch_vccz front_keys
  s_mov_b32 s54, 32768
front_all:
  s_sleep 2
  buffer_load_dwordx4 v[136:139], v140, s[24:27], s58 offen sc1
  s_waitcnt vmcnt(0)
  v_xor_b32 v136, s55, v136
  v_xor_b32 v137, s55, v137
  v_xor_b32 v138, s55, v138
  v_xor_b32 v139, s55, v139
  v_or3_b32 v136, v136, v137, v138
  v_or_b32 v136, v136, v139
  v_cmp_ne_u32 vcc, 0, v136
  s_nop 0
  s_cbranch_vccz front_keys
  s_sub_u32 s54, s54, 1
  s_cmp_lg_u32 s54, 0
  s_cbranch_scc1 front_all
front_keys:
  s_lshl_b32 s35, s3, 11
  s_add_u32 s35, s35, 2621440
  buffer_load_dwordx4 v[128:131], v242, s[24:27], s35 offen sc1
  buffer_load_dwordx4 v[132:135], v242, s[24:27], s35 offen offset:1024 sc1
  v_mfma_f32_16x16x32_bf16 v[0:3], a[160:163], a[64:67], v[0:3]
  ds_read_b64_tr_b16 a[176:177], v150 offset:32768
  s_add_u32 s59, s59, 1
  s_or_b32 s54, s2, s3
  s_min_u32 s54, s54, 1
  v_mfma_f32_16x16x32_bf16 v[0:3], a[164:167], a[80:83], v[0:3]
  buffer_load_dwordx4 a[32:35], v242, s[24:27], s30 offen offset:0 sc1
  s_lshl_b32 s54, s54, 28
  v_mfma_f32_16x16x32_bf16 v[4:7], a[164:167], a[84:87], v[4:7]
  ds_read_b64_tr_b16 a[178:179], v150 offset:33792
  v_lshlrev_b32 v137, 22, v242
  v_mfma_f32_16x16x32_bf16 v[4:7], a[160:163], a[68:71], v[4:7]
  v_or_b32 v137, s54, v137
  v_mov_b32 v136, s59
  v_mfma_f32_16x16x32_bf16 v[8:11], a[160:163], a[72:75], v[8:11]
  ds_read_b64_tr_b16 a[180:181], v150 offset:40960
  s_add_u32 m0, s28, 0
  s_mov_b32 s58, 2830336
  buffer_store_dword v136, v137, s[24:27], s58 offen sc1
  v_mfma_f32_16x16x32_bf16 v[8:11], a[164:167], a[88:91], v[8:11]
  buffer_load_dwordx4 v238, s[20:23], s31 offen offset:0 lds
  v_mfma_f32_16x16x32_bf16 v[12:15], a[164:167], a[92:95], v[12:15]
  ds_read_b64_tr_b16 a[182:183], v150 offset:41984
  v_mfma_f32_16x16x32_bf16 v[12:15], a[160:163], a[76:79], v[12:15]
  s_waitcnt lgkmcnt(4)
  v_mfma_f32_16x16x32_bf16 v[16:19], a[168:171], a[64:67], v[16:19]
  ds_read_b64_tr_b16 a[184:185], v151 offset:32768
  v_mfma_f32_16x16x32_bf16 v[16:19], a[172:175], a[80:83], v[16:19]
  buffer_load_dwordx4 a[36:39], v242, s[24:27], s30 offen offset:1024 sc1
  v_mfma_f32_16x16x32_bf16 v[20:23], a[172:175], a[84:87], v[20:23]
  ds_read_b64_tr_b16 a[186:187], v151 offset:33792
  v_mfma_f32_16x16x32_bf16 v[20:23], a[168:171], a[68:71], v[20:23]
  v_mfma_f32_16x16x32_bf16 v[24:27], a[168:171], a[72:75], v[24:27]
  ds_read_b64_tr_b16 a[188:189], v151 offset:40960
  v_mfma_f32_16x16x32_bf16 v[24:27], a[172:175], a[88:91], v[24:27]
  v_mfma_f32_16x16x32_bf16 v[28:31], a[172:175], a[92:95], v[28:31]
  ds_read_b64_tr_b16 a[190:191], v151 offset:41984
  v_mfma_f32_16x16x32_bf16 v[28:31], a[168:171], a[76:79], v[28:31]
  s_waitcnt lgkmcnt(4)
  v_mfma_f32_16x16x32_bf16 v[32:35], a[176:179], a[64:67], v[32:35]
  ds_read_b64_tr_b16 a[160:161], v152 offset:32768
  v_mfma_f32_16x16x32_bf16 v[32:35], a[180:183], a[80:83], v[32:35]
  buffer_load_dwordx4 a[40:43], v242, s[24:27], s30 offen offset:2048 sc1
  v_mfma_f32_16x16x32_bf16 v[36:39], a[180:183], a[84:87], v[36:39]
  ds_read_b64_tr_b16 a[162:163], v152 offset:33792
  v_mfma_f32_16x16x32_bf16 v[36:39], a[176:179], a[68:71], v[36:39]
  v_mfma_f32_16x16x32_bf16 v[40:43], a[176:179], a[72:75], v[40:43]
  ds_read_b64_tr_b16 a[164:165], v152 offset:40960
  v_mfma_f32_16x16x32_bf16 v[40:43], a[180:183], a[88:91], v[40:43]
  buffer_load_dwordx4 v239, s[20:23], s31 offen offset:1024 lds
  v_mfma_f32_16x16x32_bf16 v[44:47], a[180:183], a[92:95], v[44:47]
  ds_read_b64_tr_b16 a[166:167], v152 offset:41984
  v_mfma_f32_16x16x32_bf16 v[44:47], a[176:179], a[76:79], v[44:47]
  s_waitcnt lgkmcnt(4)
  v_mfma_f32_16x16x32_bf16 v[48:51], a[184:187], a[64:67], v[48:51]
  ds_read_b64_tr_b16 a[168:169], v153 offset:32768
  v_mfma_f32_16x16x32_bf16 v[48:51], a[188:191], a[80:83], v[48:51]
  buffer_load_dwordx4 a[44:47], v242, s[24:27], s30 offen offset:3072 sc1
  v_mfma_f32_16x16x32_bf16 v[52:55], a[188:191], a[84:87], v[52:55]
  ds_read_b64_tr_b16 a[170:171], v153 offset:33792
  v_mfma_f32_16x16x32_bf16 v[52:55], a[184:187], a[68:71], v[52:55]
  v_mfma_f32_16x16x32_bf16 v[56:59], a[184:187], a[72:75], v[56:59]
  ds_read_b64_tr_b16 a[172:173], v153 offset:40960
  v_mfma_f32_16x16x32_bf16 v[56:59], a[188:191], a[88:91], v[56:59]
  v_mfma_f32_16x16x32_bf16 v[60:63], a[188:191], a[92:95], v[60:63]
  ds_read_b64_tr_b16 a[174:175], v153 offset:41984
  v_mfma_f32_16x16x32_bf16 v[60:63], a[184:187], a[76:79], v[60:63]
  s_waitcnt lgkmcnt(4)
  v_mfma_f32_16x16x32_bf16 v[64:67], a[160:163], a[64:67], v[64:67]
  ds_read_b64_tr_b16 a[176:177], v154 offset:32768
  v_mfma_f32_16x16x32_bf16 v[64:67], a[164:167], a[80:83], v[64:67]
  buffer_load_dwordx4 a[48:51], v243, s[24:27], s30 offen offset:0 sc1
  v_mfma_f32_16x16x32_bf16 v[68:71], a[164:167], a[84:87], v[68:71]
  ds_read_b64_tr_b16 a[178:179], v154 offset:33792
  v_mfma_f32_16x16x32_bf16 v[68:71], a[160:163], a[68:71], v[68:71]
  v_mfma_f32_16x16x32_bf16 v[72:75], a[160:163], a[72:75], v[72:75]
  ds_read_b64_tr_b16 a[180:181], v154 offset:40960
  v_mfma_f32_16x16x32_bf16 v[72:75], a[164:167], a[88:91], v[72:75]
  buffer_load_dwordx4 v240, s[20:23], s31 offen offset:2048 lds
  v_mfma_f32_16x16x32_bf16 v[76:79], a[164:167], a[92:95], v[76:79]
  ds_read_b64_tr_b16 a[182:183], v154 offset:41984
  v_mfma_f32_16x16x32_bf16 v[76:79], a[160:163], a[76:79], v[76:79]
  s_waitcnt lgkmcnt(4)
  v_mfma_f32_16x16x32_bf16 v[80:83], a[168:171], a[64:67], v[80:83]
  ds_read_b64_tr_b16 a[184:185], v155 offset:32768
  v_mfma_f32_16x16x32_bf16 v[80:83], a[172:175], a[80:83], v[80:83]
  buffer_load_dwordx4 a[52:55], v243, s[24:27], s30 offen offset:1024 sc1
  v_mfma_f32_16x16x32_bf16 v[84:87], a[172:175], a[84:87], v[84:87]
  ds_read_b64_tr_b16 a[186:187], v155 offset:33792
  v_mfma_f32_16x16x32_bf16 v[84:87], a[168:171], a[68:71], v[84:87]
  v_mfma_f32_16x16x32_bf16 v[88:91], a[168:171], a[72:75], v[88:91]
  ds_read_b64_tr_b16 a[188:189], v155 offset:40960
  v_mfma_f32_16x16x32_bf16 v[88:91], a[172:175], a[88:91], v[88:91]
  s_barrier
  v_mfma_f32_16x16x32_bf16 v[92:95], a[172:175], a[92:95], v[92:95]
  ds_read_b64_tr_b16 a[190:191], v155 offset:41984
  v_mfma_f32_16x16x32_bf16 v[92:95], a[168:171], a[76:79], v[92:95]
  s_waitcnt lgkmcnt(4)
  v_mfma_f32_16x16x32_bf16 v[96:99], a[176:179], a[64:67], v[96:99]
  ds_read_b64_tr_b16 a[160:161], v148 offset:49152
  v_mfma_f32_16x16x32_bf16 v[96:99], a[180:183], a[80:83], v[96:99]
  buffer_load_dwordx4 a[56:59], v243, s[24:27], s30 offen offset:2048 sc1
  v_mfma_f32_16x16x32_bf16 v[100:103], a[180:183], a[84:87], v[100:103]
  ds_read_b64_tr_b16 a[162:163], v148 offset:50176
  v_mfma_f32_16x16x32_bf16 v[100:103], a[176:179], a[68:71], v[100:103]
  v_mfma_f32_16x16x32_bf16 v[104:107], a[176:179], a[72:75], v[104:107]
  ds_read_b64_tr_b16 a[164:165], v148 offset:57344
  v_mfma_f32_16x16x32_bf16 v[104:107], a[180:183], a[88:91], v[104:107]
  buffer_load_dwordx4 v241, s[20:23], s31 offen offset:3072 lds
  s_add_u32 s31, s31, 0x80000
  v_mfma_f32_16x16x32_bf16 v[108:111], a[180:183], a[92:95], v[108:111]
  ds_read_b64_tr_b16 a[166:167], v148 offset:58368
  v_mfma_f32_16x16x32_bf16 v[108:111], a[176:179], a[76:79], v[108:111]
  s_waitcnt lgkmcnt(4)
  v_mfma_f32_16x16x32_bf16 v[112:115], a[184:187], a[64:67], v[112:115]
  ds_read_b64_tr_b16 a[168:169], v149 offset:49152
  v_mfma_f32_16x16x32_bf16 v[112:115], a[188:191], a[80:83], v[112:115]
  buffer_load_dwordx4 a[60:63], v243, s[24:27], s30 offen offset:3072 sc1
  s_add_u32 s30, s30, 8192
  v_mfma_f32_16x16x32_bf16 v[116:119], a[188:191], a[84:87], v[116:119]
  ds_read_b64_tr_b16 a[170:171], v149 offset:50176
  v_mfma_f32_16x16x32_bf16 v[116:119], a[184:187], a[68:71], v[116:119]
  v_mfma_f32_16x16x32_bf16 v[120:123], a[184:187], a[72:75], v[120:123]
  ds_read_b64_tr_b16 a[172:173], v149 offset:57344
  v_mfma_f32_16x16x32_bf16 v[120:123], a[188:191], a[88:91], v[120:123]
  v_mfma_f32_16x16x32_bf16 v[124:127], a[188:191], a[92:95], v[124:127]
  ds_read_b64_tr_b16 a[174:175], v149 offset:58368
  v_mfma_f32_16x16x32_bf16 v[124:127], a[184:187], a[76:79], v[124:127]
  s_waitcnt vmcnt(27) lgkmcnt(4)
  v_mfma_f32_16x16x32_bf16 v[0:3], a[160:163], a[96:99], v[0:3]
  ds_read_b64_tr_b16 a[176:177], v150 offset:49152
  v_mfma_f32_16x16x32_bf16 v[0:3], a[164:167], a[112:115], v[0:3]
  buffer_load_dwordx4 a[64:67], v242, s[24:27], s30 offen offset:0 sc1
  v_mfma_f32_16x16x32_bf16 v[4:7], a[164:167], a[116:119], v[4:7]
  ds_read_b64_tr_b16 a[178:179], v150 offset:50176
  v_mfma_f32_16x16x32_bf16 v[4:7], a[160:163], a[100:103], v[4:7]
  v_mfma_f32_16x16x32_bf16 v[8:11], a[160:163], a[104:107], v[8:11]
  ds_read_b64_tr_b16 a[180:181], v150 offset:57344
  s_add_u32 m0, s28, 65536
  v_mfma_f32_16x16x32_bf16 v[8:11], a[164:167], a[120:123], v[8:11]
  buffer_load_dwordx4 v238, s[20:23], s31 offen offset:0 lds
  v_mfma_f32_16x16x32_bf16 v[12:15], a[164:167], a[124:127], v[12:15]
  ds_read_b64_tr_b16 a[182:183], v150 offset:58368
  v_mfma_f32_16x16x32_bf16 v[12:15], a[160:163], a[108:111], v[12:15]
  s_waitcnt lgkmcnt(4)
  v_mfma_f32_16x16x32_bf16 v[16:19], a[168:171], a[96:99], v[16:19]
  ds_read_b64_tr_b16 a[184:185], v151 offset:49152
  v_mfma_f32_16x16x32_bf16 v[16:19], a[172:175], a[112:115], v[16:19]
  buffer_load_dwordx4 a[68:71], v242, s[24:27], s30 offen offset:1024 sc1
  v_mfma_f32_16x16x32_bf16 v[20:23], a[172:175], a[116:119], v[20:23]
  ds_read_b64_tr_b16 a[186:187], v151 offset:50176
  v_mfma_f32_16x16x32_bf16 v[20:23], a[168:171], a[100:103], v[20:23]
  v_mfma_f32_16x16x32_bf16 v[24:27], a[168:171], a[104:107], v[24:27]
  ds_read_b64_tr_b16 a[188:189], v151 offset:57344
  v_mfma_f32_16x16x32_bf16 v[24:27], a[172:175], a[120:123], v[24:27]
  v_mfma_f32_16x16x32_bf16 v[28:31], a[172:175], a[124:127], v[28:31]
  ds_read_b64_tr_b16 a[190:191], v151 offset:58368
  v_mfma_f32_16x16x32_bf16 v[28:31], a[168:171], a[108:111], v[28:31]
  s_waitcnt lgkmcnt(4)
  v_mfma_f32_16x16x32_bf16 v[32:35], a[176:179], a[96:99], v[32:35]
  ds_read_b64_tr_b16 a[160:161], v152 offset:49152
  v_mfma_f32_16x16x32_bf16 v[32:35], a[180:183], a[112:115], v[32:35]
  buffer_load_dwordx4 a[72:75], v242, s[24:27], s30 offen offset:2048 sc1
  v_mfma_f32_16x16x32_bf16 v[36:39], a[180:183], a[116:119], v[36:39]
  ds_read_b64_tr_b16 a[162:163], v152 offset:50176
  v_mfma_f32_16x16x32_bf16 v[36:39], a[176:179], a[100:103], v[36:39]
  v_mfma_f32_16x16x32_bf16 v[40:43], a[176:179], a[104:107], v[40:43]
  ds_read_b64_tr_b16 a[164:165], v152 offset:57344
  v_mfma_f32_16x16x32_bf16 v[40:43], a[180:183], a[120:123], v[40:43]
  buffer_load_dwordx4 v239, s[20:23], s31 offen offset:1024 lds
  v_mfma_f32_16x16x32_bf16 v[44:47], a[180:183], a[124:127], v[44:47]
  ds_read_b64_tr_b16 a[166:167], v152 offset:58368
  v_mfma_f32_16x16x32_bf16 v[44:47], a[176:179], a[108:111], v[44:47]
  s_waitcnt lgkmcnt(4)
  v_mfma_f32_16x16x32_bf16 v[48:51], a[184:187], a[96:99], v[48:51]
  ds_read_b64_tr_b16 a[168:169], v153 offset:49152
  v_mfma_f32_16x16x32_bf16 v[48:51], a[188:191], a[112:115], v[48:51]
  buffer_load_dwordx4 a[76:79], v242, s[24:27], s30 offen offset:3072 sc1
  v_mfma_f32_16x16x32_bf16 v[52:55], a[188:191], a[116:119], v[52:55]
  ds_read_b64_tr_b16 a[170:171], v153 offset:50176
  v_mfma_f32_16x16x32_bf16 v[52:55], a[184:187], a[100:103], v[52:55]
  v_mfma_f32_16x16x32_bf16 v[56:59], a[184:187], a[104:107], v[56:59]
  ds_read_b64_tr_b16 a[172:173], v153 offset:57344
  v_mfma_f32_16x16x32_bf16 v[56:59], a[188:191], a[120:123], v[56:59]
  v_mfma_f32_16x16x32_bf16 v[60:63], a[188:191], a[124:127], v[60:63]
  ds_read_b64_tr_b16 a[174:175], v153 offset:58368
  v_mfma_f32_16x16x32_bf16 v[60:63], a[184:187], a[108:111], v[60:63]
  s_waitcnt lgkmcnt(4)
  v_mfma_f32_16x16x32_bf16 v[64:67], a[160:163], a[96:99], v[64:67]
  ds_read_b64_tr_b16 a[176:177], v154 offset:49152
  v_mfma_f32_16x16x32_bf16 v[64:67], a[164:167], a[112:115], v[64:67]
  buffer_load_dwordx4 a[80:83], v243, s[24:27], s30 offen offset:0 sc1
  v_mfma_f32_16x16x32_bf16 v[68:71], a[164:167], a[116:119], v[68:71]
  ds_read_b64_tr_b16 a[178:179], v154 offset:50176
  v_mfma_f32_16x16x32_bf16 v[68:71], a[160:163], a[100:103], v[68:71]
  v_mfma_f32_16x16x32_bf16 v[72:75], a[160:163], a[104:107], v[72:75]
  ds_read_b64_tr_b16 a[180:181], v154 offset:57344
  v_mfma_f32_16x16x32_bf16 v[72:75], a[164:167], a[120:123], v[72:75]
  buffer_load_dwordx4 v240, s[20:23], s31 offen offset:2048 lds
  v_mfma_f32_16x16x32_bf16 v[76:79], a[164:167], a[124:127], v[76:79]
  ds_read_b64_tr_b16 a[182:183], v154 offset:58368
  v_mfma_f32_16x16x32_bf16 v[76:79], a[160:163], a[108:111], v[76:79]
  s_waitcnt lgkmcnt(4)
  v_mfma_f32_16x16x32_bf16 v[80:83], a[168:171], a[96:99], v[80:83]
  ds_read_b64_tr_b16 a[184:185], v155 offset:49152
  v_mfma_f32_16x16x32_bf16 v[80:83], a[172:175], a[112:115], v[80:83]
  buffer_load_dwordx4 a[84:87], v243, s[24:27], s30 offen offset:1024 sc1
  v_mfma_f32_16x16x32_bf16 v[84:87], a[172:175], a[116:119], v[84:87]
  ds_read_b64_tr_b16 a[186:187], v155 offset:50176
  v_mfma_f32_16x16x32_bf16 v[84:87], a[168:171], a[100:103], v[84:87]
  s_waitcnt vmcnt(25)
  v_mfma_f32_16x16x32_bf16 v[88:91], a[168:171], a[104:107], v[88:91]
  ds_read_b64_tr_b16 a[188:189], v155 offset:57344
  v_mfma_f32_16x16x32_bf16 v[88:91], a[172:175], a[120:123], v[88:91]
  s_barrier
  v_mfma_f32_16x16x32_bf16 v[92:95], a[172:175], a[124:127], v[92:95]
  ds_read_b64_tr_b16 a[190:191], v155 offset:58368
  v_mfma_f32_16x16x32_bf16 v[92:95], a[168:171], a[108:111], v[92:95]
  s_waitcnt lgkmcnt(4)
  v_mfma_f32_16x16x32_bf16 v[96:99], a[176:179], a[96:99], v[96:99]
  ds_read_b64_tr_b16 a[160:161], v148 offset:16384
  v_mfma_f32_16x16x32_bf16 v[96:99], a[180:183], a[112:115], v[96:99]
  buffer_load_dwordx4 a[88:91], v243, s[24:27], s30 offen offset:2048 sc1
  v_mfma_f32_16x16x32_bf16 v[100:103], a[180:183], a[116:119], v[100:103]
  ds_read_b64_tr_b16 a[162:163], v148 offset:17408
  v_mfma_f32_16x16x32_bf16 v[100:103], a[176:179], a[100:103], v[100:103]
  v_mfma_f32_16x16x32_bf16 v[104:107], a[176:179], a[104:107], v[104:107]
  ds_read_b64_tr_b16 a[164:165], v148 offset:24576
  v_mfma_f32_16x16x32_bf16 v[104:107], a[180:183], a[120:123], v[104:107]
  buffer_load_dwordx4 v241, s[20:23], s31 offen offset:3072 lds
  s_add_u32 s31, s31, 0x80000
  v_mfma_f32_16x16x32_bf16 v[108:111], a[180:183], a[124:127], v[108:111]
  ds_read_b64_tr_b16 a[166:167], v148 offset:25600
  v_mfma_f32_16x16x32_bf16 v[108:111], a[176:179], a[108:111], v[108:111]
  s_waitcnt lgkmcnt(4)
  v_mfma_f32_16x16x32_bf16 v[112:115], a[184:187], a[96:99], v[112:115]
  ds_read_b64_tr_b16 a[168:169], v149 offset:16384
  v_mfma_f32_16x16x32_bf16 v[112:115], a[188:191], a[112:115], v[112:115]
  buffer_load_dwordx4 a[92:95], v243, s[24:27], s30 offen offset:3072 sc1
  s_add_u32 s30, s30, 8192
  v_mfma_f32_16x16x32_bf16 v[116:119], a[188:191], a[116:119], v[116:119]
  ds_read_b64_tr_b16 a[170:171], v149 offset:17408
  v_mfma_f32_16x16x32_bf16 v[116:119], a[184:187], a[100:103], v[116:119]
  v_mfma_f32_16x16x32_bf16 v[120:123], a[184:187], a[104:107], v[120:123]
  ds_read_b64_tr_b16 a[172:173], v149 offset:24576
  v_mfma_f32_16x16x32_bf16 v[120:123], a[188:191], a[120:123], v[120:123]
  v_mfma_f32_16x16x32_bf16 v[124:127], a[188:191], a[124:127], v[124:127]
  ds_read_b64_tr_b16 a[174:175], v149 offset:25600
  v_mfma_f32_16x16x32_bf16 v[124:127], a[184:187], a[108:111], v[124:127]
  s_waitcnt vmcnt(27) lgkmcnt(4)
  v_mfma_f32_16x16x32_bf16 v[0:3], a[160:163], a[0:3], v[0:3]
  ds_read_b64_tr_b16 a[176:177], v150 offset:16384
  s_waitcnt vmcnt(25)
  v_mov_b32 v136, -1
  v_mfma_f32_16x16x32_bf16 v[0:3], a[164:167], a[16:19], v[0:3]
  buffer_load_dwordx4 a[96:99], v242, s[24:27], s30 offen offset:0 sc1
  v_mfma_f32_16x16x32_bf16 v[4:7], a[164:167], a[20:23], v[4:7]
  ds_read_b64_tr_b16 a[178:179], v150 offset:17408
  v_sub_u32 v139, v136, v128
  v_mfma_f32_16x16x32_bf16 v[4:7], a[160:163], a[4:7], v[4:7]
  v_sub_u32 v140, v136, v129
  v_min_u32 v138, v139, v140
  v_mfma_f32_16x16x32_bf16 v[8:11], a[160:163], a[8:11], v[8:11]
  ds_read_b64_tr_b16 a[180:181], v150 offset:24576
  s_add_u32 m0, s28, 81920
  v_sub_u32 v141, v136, v130
  v_mfma_f32_16x16x32_bf16 v[8:11], a[164:167], a[24:27], v[8:11]
  buffer_load_dwordx4 v238, s[20:23], s31 offen offset:0 lds
  v_mfma_f32_16x16x32_bf16 v[12:15], a[164:167], a[28:31], v[12:15]
  ds_read_b64_tr_b16 a[182:183], v150 offset:25600
  v_sub_u32 v142, v136, v131
  v_mfma_f32_16x16x32_bf16 v[12:15], a[160:163], a[12:15], v[12:15]
  s_waitcnt lgkmcnt(4)
  v_min3_u32 v138, v138, v141, v142
  v_sub_u32 v139, v136, v132
  v_mfma_f32_16x16x32_bf16 v[16:19], a[168:171], a[0:3], v[16:19]
  ds_read_b64_tr_b16 a[184:185], v151 offset:16384
  v_sub_u32 v140, v136, v133
  v_mfma_f32_16x16x32_bf16 v[16:19], a[172:175], a[16:19], v[16:19]
  buffer_load_dwordx4 a[100:103], v242, s[24:27], s30 offen offset:1024 sc1
  v_mfma_f32_16x16x32_bf16 v[20:23], a[172:175], a[20:23], v[20:23]
  ds_read_b64_tr_b16 a[186:187], v151 offset:17408
  v_min3_u32 v138, v138, v139, v140
  v_mfma_f32_16x16x32_bf16 v[20:23], a[168:171], a[4:7], v[20:23]
  v_sub_u32 v141, v136, v134
  v_sub_u32 v142, v136, v135
  v_mfma_f32_16x16x32_bf16 v[24:27], a[168:171], a[8:11], v[24:27]
  ds_read_b64_tr_b16 a[188:189], v151 offset:24576
  v_min3_u32 v138, v138, v141, v142
  v_mfma_f32_16x16x32_bf16 v[24:27], a[172:175], a[24:27], v[24:27]
  v_mfma_f32_16x16x32_bf16 v[28:31], a[172:175], a[28:31], v[28:31]
  ds_read_b64_tr_b16 a[190:191], v151 offset:25600
  v_min_u32_dpp v138, v138, v138 row_ror:8 row_mask:0xf bank_mask:0xf
  v_mfma_f32_16x16x32_bf16 v[28:31], a[168:171], a[12:15], v[28:31]
  s_waitcnt lgkmcnt(4)
  v_min_u32_dpp v138, v138, v138 row_ror:4 row_mask:0xf bank_mask:0xf
  v_mfma_f32_16x16x32_bf16 v[32:35], a[176:179], a[0:3], v[32:35]
  ds_read_b64_tr_b16 a[160:161], v152 offset:16384
  v_min_u32_dpp v138, v138, v138 row_ror:2 row_mask:0xf bank_mask:0xf
  v_mfma_f32_16x16x32_bf16 v[32:35], a[180:183], a[16:19], v[32:35]
  buffer_load_dwordx4 a[104:107], v242, s[24:27], s30 offen offset:2048 sc1
  v_mfma_f32_16x16x32_bf16 v[36:39], a[180:183], a[20:23], v[36:39]
  ds_read_b64_tr_b16 a[162:163], v152 offset:17408
  v_min_u32_dpp v138, v138, v138 row_ror:1 row_mask:0xf bank_mask:0xf
  v_mfma_f32_16x16x32_bf16 v[36:39], a[176:179], a[4:7], v[36:39]
  v_sub_u32 v137, v136, v138
  v_add_u32 v136, -1, v137
  v_mfma_f32_16x16x32_bf16 v[40:43], a[176:179], a[8:11], v[40:43]
  ds_read_b64_tr_b16 a[164:165], v152 offset:24576
  v_sub_u32 v139, v136, v128
  v_mfma_f32_16x16x32_bf16 v[40:43], a[180:183], a[24:27], v[40:43]
  buffer_load_dwordx4 v239, s[20:23], s31 offen offset:1024 lds
  v_mfma_f32_16x16x32_bf16 v[44:47], a[180:183], a[28:31], v[44:47]
  ds_read_b64_tr_b16 a[166:167], v152 offset:25600
  v_mov_b32_dpp v144, v137 quad_perm:[0,1,2,3] row_mask:0xf bank_mask:0x1
  v_mfma_f32_16x16x32_bf16 v[44:47], a[176:179], a[12:15], v[44:47]
  s_waitcnt lgkmcnt(4)
  v_sub_u32 v140, v136, v129
  v_min_u32 v138, v139, v140
  v_mfma_f32_16x16x32_bf16 v[48:51], a[184:187], a[0:3], v[48:51]
  ds_read_b64_tr_b16 a[168:169], v153 offset:16384
  v_sub_u32 v141, v136, v130
  v_mfma_f32_16x16x32_bf16 v[48:51], a[188:191], a[16:19], v[48:51]
  buffer_load_dwordx4 a[108:111], v242, s[24:27], s30 offen offset:3072 sc1
  v_mfma_f32_16x16x32_bf16 v[52:55], a[188:191], a[20:23], v[52:55]
  ds_read_b64_tr_b16 a[170:171], v153 offset:17408
  v_sub_u32 v142, v136, v131
  v_mfma_f32_16x16x32_bf16 v[52:55], a[184:187], a[4:7], v[52:55]
  v_min3_u32 v138, v138, v141, v142
  v_sub_u32 v139, v136, v132
  v_mfma_f32_16x16x32_bf16 v[56:59], a[184:187], a[8:11], v[56:59]
  ds_read_b64_tr_b16 a[172:173], v153 offset:24576
  v_sub_u32 v140, v136, v133
  v_mfma_f32_16x16x32_bf16 v[56:59], a[188:191], a[24:27], v[56:59]
  v_min3_u32 v138, v138, v139, v140
  v_sub_u32 v141, v136, v134
  v_mfma_f32_16x16x32_bf16 v[60:63], a[188:191], a[28:31], v[60:63]
  ds_read_b64_tr_b16 a[174:175], v153 offset:25600
  v_sub_u32 v142, v136, v135
  v_mfma_f32_16x16x32_bf16 v[60:63], a[184:187], a[12:15], v[60:63]
  s_waitcnt lgkmcnt(4)
  v_min3_u32 v138, v138, v141, v142
  v_mfma_f32_16x16x32_bf16 v[64:67], a[160:163], a[0:3], v[64:67]
  ds_read_b64_tr_b16 a[176:177], v154 offset:16384
  v_min_u32_dpp v138, v138, v138 row_ror:8 row_mask:0xf bank_mask:0xf
  v_mfma_f32_16x16x32_bf16 v[64:67], a[164:167], a[16:19], v[64:67]
  buffer_load_dwordx4 a[112:115], v243, s[24:27], s30 offen offset:0 sc1
  v_mfma_f32_16x16x32_bf16 v[68:71], a[164:167], a[20:23], v[68:71]
  ds_read_b64_tr_b16 a[178:179], v154 offset:17408
  v_min_u32_dpp v138, v138, v138 row_ror:4 row_mask:0xf bank_mask:0xf
  v_mfma_f32_16x16x32_bf16 v[68:71], a[160:163], a[4:7], v[68:71]
  v_mfma_f32_16x16x32_bf16 v[72:75], a[160:163], a[8:11], v[72:75]
  ds_read_b64_tr_b16 a[180:181], v154 offset:24576
  v_min_u32_dpp v138, v138, v138 row_ror:2 row_mask:0xf bank_mask:0xf
  v_mfma_f32_16x16x32_bf16 v[72:75], a[164:167], a[24:27], v[72:75]
  buffer_load_dwordx4 v240, s[20:23], s31 offen offset:2048 lds
  v_mfma_f32_16x16x32_bf16 v[76:79], a[164:167], a[28:31], v[76:79]
  ds_read_b64_tr_b16 a[182:183], v154 offset:25600
  v_min_u32_dpp v138, v138, v138 row_ror:1 row_mask:0xf bank_mask:0xf
  v_mfma_f32_16x16x32_bf16 v[76:79], a[160:163], a[12:15], v[76:79]
  s_waitcnt lgkmcnt(4)
  v_sub_u32 v137, v136, v138
  v_add_u32 v136, -1, v137
  v_mfma_f32_16x16x32_bf16 v[80:83], a[168:171], a[0:3], v[80:83]
  ds_read_b64_tr_b16 a[184:185], v155 offset:16384
  v_sub_u32 v139, v136, v128
  v_mfma_f32_16x16x32_bf16 v[80:83], a[172:175], a[16:19], v[80:83]
  buffer_load_dwordx4 a[116:119], v243, s[24:27], s30 offen offset:1024 sc1
  v_mfma_f32_16x16x32_bf16 v[84:87], a[172:175], a[20:23], v[84:87]
  ds_read_b64_tr_b16 a[186:187], v155 offset:17408
  v_mov_b32_dpp v144, v137 quad_perm:[0,1,2,3] row_mask:0xf bank_mask:0x2
  v_mfma_f32_16x16x32_bf16 v[84:87], a[168:171], a[4:7], v[84:87]
  s_waitcnt vmcnt(22)
  v_sub_u32 v140, v136, v129
  v_min_u32 v138, v139, v140
  v_mfma_f32_16x16x32_bf16 v[88:91], a[168:171], a[8:11], v[88:91]
  ds_read_b64_tr_b16 a[188:189], v155 offset:24576
  v_sub_u32 v141, v136, v130
  v_mfma_f32_16x16x32_bf16 v[88:91], a[172:175], a[24:27], v[88:91]
  s_barrier
  v_sub_u32 v142, v136, v131
  v_min3_u32 v138, v138, v141, v142
  v_mfma_f32_16x16x32_bf16 v[92:95], a[172:175], a[28:31], v[92:95]
  ds_read_b64_tr_b16 a[190:191], v155 offset:25600
  v_sub_u32 v139, v136, v132
  v_mfma_f32_16x16x32_bf16 v[92:95], a[168:171], a[12:15], v[92:95]
  s_waitcnt lgkmcnt(4)
  v_sub_u32 v140, v136, v133
  v_min3_u32 v138, v138, v139, v140
  v_mfma_f32_16x16x32_bf16 v[96:99], a[176:179], a[0:3], v[96:99]
  ds_read_b64_tr_b16 a[160:161], v148 offset:0
  v_sub_u32 v141, v136, v134
  v_mfma_f32_16x16x32_bf16 v[96:99], a[180:183], a[16:19], v[96:99]
  buffer_load_dwordx4 a[120:123], v243, s[24:27], s30 offen offset:2048 sc1
  v_mfma_f32_16x16x32_bf16 v[100:103], a[180:183], a[20:23], v[100:103]
  ds_read_b64_tr_b16 a[162:163], v148 offset:1024
  v_sub_u32 v142, v136, v135
  v_mfma_f32_16x16x32_bf16 v[100:103], a[176:179], a[4:7], v[100:103]
  v_min3_u32 v138, v138, v141, v142
  v_mfma_f32_16x16x32_bf16 v[104:107], a[176:179], a[8:11], v[104:107]
  ds_read_b64_tr_b16 a[164:165], v148 offset:8192
  v_min_u32_dpp v138, v138, v138 row_ror:8 row_mask:0xf bank_mask:0xf
  v_mfma_f32_16x16x32_bf16 v[104:107], a[180:183], a[24:27], v[104:107]
  buffer_load_dwordx4 v241, s[20:23], s31 offen offset:3072 lds
  s_add_u32 s31, s31, 0x80000
  v_mfma_f32_16x16x32_bf16 v[108:111], a[180:183], a[28:31], v[108:111]
  ds_read_b64_tr_b16 a[166:167], v148 offset:9216
  v_min_u32_dpp v138, v138, v138 row_ror:4 row_mask:0xf bank_mask:0xf
  v_mfma_f32_16x16x32_bf16 v[108:111], a[176:179], a[12:15], v[108:111]
  s_waitcnt lgkmcnt(4)
  v_min_u32_dpp v138, v138, v138 row_ror:2 row_mask:0xf bank_mask:0xf
  v_mfma_f32_16x16x32_bf16 v[112:115], a[184:187], a[0:3], v[112:115]
  ds_read_b64_tr_b16 a[168:169], v149 offset:0
  v_min_u32_dpp v138, v138, v138 row_ror:1 row_mask:0xf bank_mask:0xf
  v_mfma_f32_16x16x32_bf16 v[112:115], a[188:191], a[16:19], v[112:115]
  buffer_load_dwordx4 a[124:127], v243, s[24:27], s30 offen offset:3072 sc1
  s_add_u32 s30, s30, 8192
  v_mfma_f32_16x16x32_bf16 v[116:119], a[188:191], a[20:23], v[116:119]
  ds_read_b64_tr_b16 a[170:171], v149 offset:1024
  v_sub_u32 v137, v136, v138
  v_mfma_f32_16x16x32_bf16 v[116:119], a[184:187], a[4:7], v[116:119]
  v_add_u32 v136, -1, v137
  v_sub_u32 v139, v136, v128
  v_mfma_f32_16x16x32_bf16 v[120:123], a[184:187], a[8:11], v[120:123]
  ds_read_b64_tr_b16 a[172:173], v149 offset:8192
  v_mov_b32_dpp v144, v137 quad_perm:[0,1,2,3] row_mask:0xf bank_mask:0x4
  v_mfma_f32_16x16x32_bf16 v[120:123], a[188:191], a[24:27], v[120:123]
  v_sub_u32 v140, v136, v129
  v_min_u32 v138, v139, v140
  v_mfma_f32_16x16x32_bf16 v[124:127], a[188:191], a[28:31], v[124:127]
  ds_read_b64_tr_b16 a[174:175], v149 offset:9216
  v_sub_u32 v141, v136, v130
  v_mfma_f32_16x16x32_bf16 v[124:127], a[184:187], a[12:15], v[124:127]
  s_waitcnt vmcnt(24) lgkmcnt(4)
  v_sub_u32 v142, v136, v131
  v_min3_u32 v138, v138, v141, v142
  v_mfma_f32_16x16x32_bf16 v[0:3], a[160:163], a[32:35], v[0:3]
  ds_read_b64_tr_b16 a[176:177], v150 offset:0
  v_sub_u32 v139, v136, v132
  v_mfma_f32_16x16x32_bf16 v[0:3], a[164:167], a[48:51], v[0:3]
  buffer_load_dwordx4 a[0:3], v242, s[24:27], s30 offen offset:0 sc1
  v_mfma_f32_16x16x32_bf16 v[4:7], a[164:167], a[52:55], v[4:7]
  ds_read_b64_tr_b16 a[178:179], v150 offset:1024
  v_sub_u32 v140, v136, v133
  v_mfma_f32_16x16x32_bf16 v[4:7], a[160:163], a[36:39], v[4:7]
  v_min3_u32 v138, v138, v139, v140
  v_sub_u32 v141, v136, v134
  v_mfma_f32_16x16x32_bf16 v[8:11], a[160:163], a[40:43], v[8:11]
  ds_read_b64_tr_b16 a[180:181], v150 offset:8192
  s_add_u32 m0, s28, 98304
  v_sub_u32 v142, v136, v135
  v_mfma_f32_16x16x32_bf16 v[8:11], a[164:167], a[56:59], v[8:11]
  buffer_load_dwordx4 v238, s[20:23], s31 offen offset:0 lds
  v_mfma_f32_16x16x32_bf16 v[12:15], a[164:167], a[60:63], v[12:15]
  ds_read_b64_tr_b16 a[182:183], v150 offset:9216
  v_min3_u32 v138, v138, v141, v142
  v_mfma_f32_16x16x32_bf16 v[12:15], a[160:163], a[44:47], v[12:15]
  s_waitcnt lgkmcnt(4)
  v_min_u32_dpp v138, v138, v138 row_ror:8 row_mask:0xf bank_mask:0xf
  v_mfma_f32_16x16x32_bf16 v[16:19], a[168:171], a[32:35], v[16:19]
  ds_read_b64_tr_b16 a[184:185], v151 offset:0
  v_min_u32_dpp v138, v138, v138 row_ror:4 row_mask:0xf bank_mask:0xf
  v_mfma_f32_16x16x32_bf16 v[16:19], a[172:175], a[48:51], v[16:19]
  buffer_load_dwordx4 a[4:7], v242, s[24:27], s30 offen offset:1024 sc1
  v_mfma_f32_16x16x32_bf16 v[20:23], a[172:175], a[52:55], v[20:23]
  ds_read_b64_tr_b16 a[186:187], v151 offset:1024
  v_min_u32_dpp v138, v138, v138 row_ror:2 row_mask:0xf bank_mask:0xf
  v_mfma_f32_16x16x32_bf16 v[20:23], a[168:171], a[36:39], v[20:23]
  v_mfma_f32_16x16x32_bf16 v[24:27], a[168:171], a[40:43], v[24:27]
  ds_read_b64_tr_b16 a[188:189], v151 offset:8192
  v_min_u32_dpp v138, v138, v138 row_ror:1 row_mask:0xf bank_mask:0xf
  v_mfma_f32_16x16x32_bf16 v[24:27], a[172:175], a[56:59], v[24:27]
  v_sub_u32 v137, v136, v138
  v_add_u32 v136, -1, v137
  v_mfma_f32_16x16x32_bf16 v[28:31], a[172:175], a[60:63], v[28:31]
  ds_read_b64_tr_b16 a[190:191], v151 offset:9216
  v_sub_u32 v139, v136, v128
  v_mfma_f32_16x16x32_bf16 v[28:31], a[168:171], a[44:47], v[28:31]
  s_waitcnt lgkmcnt(4)
  v_mov_b32_dpp v144, v137 quad_perm:[0,1,2,3] row_mask:0xf bank_mask:0x8
  v_sub_u32 v140, v136, v129
  v_mfma_f32_16x16x32_bf16 v[32:35], a[176:179], a[32:35], v[32:35]
  ds_read_b64_tr_b16 a[160:161], v152 offset:0
  v_min_u32 v138, v139, v140
  v_mfma_f32_16x16x32_bf16 v[32:35], a[180:183], a[48:51], v[32:35]
  buffer_load_dwordx4 a[8:11], v242, s[24:27], s30 offen offset:2048 sc1
  v_mfma_f32_16x16x32_bf16 v[36:39], a[180:183], a[52:55], v[36:39]
  ds_read_b64_tr_b16 a[162:163], v152 offset:1024
  v_sub_u32 v141, v136, v130
  v_mfma_f32_16x16x32_bf16 v[36:39], a[176:179], a[36:39], v[36:39]
  v_sub_u32 v142, v136, v131
  v_min3_u32 v138, v138, v141, v142
  v_mfma_f32_16x16x32_bf16 v[40:43], a[176:179], a[40:43], v[40:43]
  ds_read_b64_tr_b16 a[164:165], v152 offset:8192
  v_sub_u32 v139, v136, v132
  v_mfma_f32_16x16x32_bf16 v[40:43], a[180:183], a[56:59], v[40:43]
  buffer_load_dwordx4 v239, s[20:23], s31 offen offset:1024 lds
  v_mfma_f32_16x16x32_bf16 v[44:47], a[180:183], a[60:63], v[44:47]
  ds_read_b64_tr_b16 a[166:167], v152 offset:9216
  v_sub_u32 v140, v136, v133
  v_mfma_f32_16x16x32_bf16 v[44:47], a[176:179], a[44:47], v[44:47]
  s_waitcnt lgkmcnt(4)
  v_min3_u32 v138, v138, v139, v140
  v_sub_u32 v141, v136, v134
  v_mfma_f32_16x16x32_bf16 v[48:51], a[184:187], a[32:35], v[48:51]
  ds_read_b64_tr_b16 a[168:169], v153 offset:0
  v_sub_u32 v142, v136, v135
  v_mfma_f32_16x16x32_bf16 v[48:51], a[188:191], a[48:51], v[48:51]
  buffer_load_dwordx4 a[12:15], v242, s[24:27], s30 offen offset:3072 sc1
  v_mfma_f32_16x16x32_bf16 v[52:55], a[188:191], a[52:55], v[52:55]
  ds_read_b64_tr_b16 a[170:171], v153 offset:1024
  v_min3_u32 v138, v138, v141, v142
  v_mfma_f32_16x16x32_bf16 v[52:55], a[184:187], a[36:39], v[52:55]
  v_mfma_f32_16x16x32_bf16 v[56:59], a[184:187], a[40:43], v[56:59]
  ds_read_b64_tr_b16 a[172:173], v153 offset:8192
  v_min_u32_dpp v138, v138, v138 row_ror:8 row_mask:0xf bank_mask:0xf
  v_mfma_f32_16x16x32_bf16 v[56:59], a[188:191], a[56:59], v[56:59]
  v_mfma_f32_16x16x32_bf16 v[60:63], a[188:191], a[60:63], v[60:63]
  ds_read_b64_tr_b16 a[174:175], v153 offset:9216
  v_min_u32_dpp v138, v138, v138 row_ror:4 row_mask:0xf bank_mask:0xf
  v_mfma_f32_16x16x32_bf16 v[60:63], a[184:187], a[44:47], v[60:63]
  s_waitcnt lgkmcnt(4)
  v_min_u32_dpp v138, v138, v138 row_ror:2 row_mask:0xf bank_mask:0xf
  v_mfma_f32_16x16x32_bf16 v[64:67], a[160:163], a[32:35], v[64:67]
  ds_read_b64_tr_b16 a[176:177], v154 offset:0
  v_min_u32_dpp v138, v138, v138 row_ror:1 row_mask:0xf bank_mask:0xf
  v_mfma_f32_16x16x32_bf16 v[64:67], a[164:167], a[48:51], v[64:67]
  buffer_load_dwordx4 a[16:19], v243, s[24:27], s30 offen offset:0 sc1
  v_mfma_f32_16x16x32_bf16 v[68:71], a[164:167], a[52:55], v[68:71]
  ds_read_b64_tr_b16 a[178:179], v154 offset:1024
  v_sub_u32 v137, v136, v138
  v_mfma_f32_16x16x32_bf16 v[68:71], a[160:163], a[36:39], v[68:71]
  v_add_u32 v136, -1, v137
  v_sub_u32 v139, v136, v128
  v_mfma_f32_16x16x32_bf16 v[72:75], a[160:163], a[40:43], v[72:75]
  ds_read_b64_tr_b16 a[180:181], v154 offset:8192
  v_mov_b32_dpp v145, v137 quad_perm:[0,1,2,3] row_mask:0xf bank_mask:0x1
  v_mfma_f32_16x16x32_bf16 v[72:75], a[164:167], a[56:59], v[72:75]
  buffer_load_dwordx4 v240, s[20:23], s31 offen offset:2048 lds
  v_mfma_f32_16x16x32_bf16 v[76:79], a[164:167], a[60:63], v[76:79]
  ds_read_b64_tr_b16 a[182:183], v154 offset:9216
  v_sub_u32 v140, v136, v129
  v_mfma_f32_16x16x32_bf16 v[76:79], a[160:163], a[44:47], v[76:79]
  s_waitcnt lgkmcnt(4)
  v_min_u32 v138, v139, v140
  v_sub_u32 v141, v136, v130
  v_mfma_f32_16x16x32_bf16 v[80:83], a[168:171], a[32:35], v[80:83]
  ds_read_b64_tr_b16 a[184:185], v155 offset:0
  v_sub_u32 v142, v136, v131
  v_mfma_f32_16x16x32_bf16 v[80:83], a[172:175], a[48:51], v[80:83]
  buffer_load_dwordx4 a[20:23], v243, s[24:27], s30 offen offset:1024 sc1
  v_mfma_f32_16x16x32_bf16 v[84:87], a[172:175], a[52:55], v[84:87]
  ds_read_b64_tr_b16 a[186:187], v155 offset:1024
  v_min3_u32 v138, v138, v141, v142
  v_mfma_f32_16x16x32_bf16 v[84:87], a[168:171], a[36:39], v[84:87]
  s_waitcnt vmcnt(22)
  v_sub_u32 v139, v136, v132
  v_sub_u32 v140, v136, v133
  v_mfma_f32_16x16x32_bf16 v[88:91], a[168:171], a[40:43], v[88:91]
  ds_read_b64_tr_b16 a[188:189], v155 offset:8192
  v_min3_u32 v138, v138, v139, v140
  v_mfma_f32_16x16x32_bf16 v[88:91], a[172:175], a[56:59], v[88:91]
  s_barrier
  v_sub_u32 v141, v136, v134
  v_sub_u32 v142, v136, v135
  v_mfma_f32_16x16x32_bf16 v[92:95], a[172:175], a[60:63], v[92:95]
  ds_read_b64_tr_b16 a[190:191], v155 offset:9216
  v_min3_u32 v138, v138, v141, v142
  v_mfma_f32_16x16x32_bf16 v[92:95], a[168:171], a[44:47], v[92:95]
  s_waitcnt lgkmcnt(4)
  v_min_u32_dpp v138, v138, v138 row_ror:8 row_mask:0xf bank_mask:0xf
  v_mfma_f32_16x16x32_bf16 v[96:99], a[176:179], a[32:35], v[96:99]
  ds_read_b64_tr_b16 a[160:161], v224 offset:0
  v_min_u32_dpp v138, v138, v138 row_ror:4 row_mask:0xf bank_mask:0xf
  v_mfma_f32_16x16x32_bf16 v[96:99], a[180:183], a[48:51], v[96:99]
  buffer_load_dwordx4 a[24:27], v243, s[24:27], s30 offen offset:2048 sc1
  v_mfma_f32_16x16x32_bf16 v[100:103], a[180:183], a[52:55], v[100:103]
  ds_read_b64_tr_b16 a[162:163], v224 offset:1024
  v_min_u32_dpp v138, v138, v138 row_ror:2 row_mask:0xf bank_mask:0xf
  v_mfma_f32_16x16x32_bf16 v[100:103], a[176:179], a[36:39], v[100:103]
  v_mfma_f32_16x16x32_bf16 v[104:107], a[176:179], a[40:43], v[104:107]
  ds_read_b64_tr_b16 a[164:165], v224 offset:8192
  v_min_u32_dpp v138, v138, v138 row_ror:1 row_mask:0xf bank_mask:0xf
  v_mfma_f32_16x16x32_bf16 v[104:107], a[180:183], a[56:59], v[104:107]
  buffer_load_dwordx4 v241, s[20:23], s31 offen offset:3072 lds
  s_add_u32 s31, s31, 0x80000
  v_mfma_f32_16x16x32_bf16 v[108:111], a[180:183], a[60:63], v[108:111]
  ds_read_b64_tr_b16 a[166:167], v224 offset:9216
  v_sub_u32 v137, v136, v138
  v_mfma_f32_16x16x32_bf16 v[108:111], a[176:179], a[44:47], v[108:111]
  s_waitcnt lgkmcnt(4)
  v_add_u32 v136, -1, v137
  v_sub_u32 v139, v136, v128
  v_mfma_f32_16x16x32_bf16 v[112:115], a[184:187], a[32:35], v[112:115]
  ds_read_b64_tr_b16 a[168:169], v225 offset:0
  v_mov_b32_dpp v145, v137 quad_perm:[0,1,2,3] row_mask:0xf bank_mask:0x2
  v_mfma_f32_16x16x32_bf16 v[112:115], a[188:191], a[48:51], v[112:115]
  buffer_load_dwordx4 a[28:31], v243, s[24:27], s30 offen offset:3072 sc1
  s_add_u32 s30, s30, 8192
  v_mfma_f32_16x16x32_bf16 v[116:119], a[188:191], a[52:55], v[116:119]
  ds_read_b64_tr_b16 a[170:171], v225 offset:1024
  v_sub_u32 v140, v136, v129
  v_mfma_f32_16x16x32_bf16 v[116:119], a[184:187], a[36:39], v[116:119]
  v_min_u32 v138, v139, v140
  v_sub_u32 v141, v136, v130
  v_mfma_f32_16x16x32_bf16 v[120:123], a[184:187], a[40:43], v[120:123]
  ds_read_b64_tr_b16 a[172:173], v225 offset:8192
  v_sub_u32 v142, v136, v131
  v_mfma_f32_16x16x32_bf16 v[120:123], a[188:191], a[56:59], v[120:123]
  v_min3_u32 v138, v138, v141, v142
  v_sub_u32 v139, v136, v132
  v_mfma_f32_16x16x32_bf16 v[124:127], a[188:191], a[60:63], v[124:127]
  ds_read_b64_tr_b16 a[174:175], v225 offset:9216
  v_sub_u32 v140, v136, v133
  v_mfma_f32_16x16x32_bf16 v[124:127], a[184:187], a[44:47], v[124:127]
  s_waitcnt vmcnt(24) lgkmcnt(4)
  v_min3_u32 v138, v138, v139, v140
  v_sub_u32 v141, v136, v134
  v_mfma_f32_16x16x32_bf16 v[0:3], a[160:163], a[64:67], v[0:3]
  ds_read_b64_tr_b16 a[176:177], v226 offset:0
  v_sub_u32 v142, v136, v135
  v_mfma_f32_16x16x32_bf16 v[0:3], a[164:167], a[80:83], v[0:3]
  buffer_load_dwordx4 a[32:35], v242, s[24:27], s30 offen offset:0 sc1
  v_mfma_f32_16x16x32_bf16 v[4:7], a[164:167], a[84:87], v[4:7]
  ds_read_b64_tr_b16 a[178:179], v226 offset:1024
  v_min3_u32 v138, v138, v141, v142
  v_mfma_f32_16x16x32_bf16 v[4:7], a[160:163], a[68:71], v[4:7]
  v_mfma_f32_16x16x32_bf16 v[8:11], a[160:163], a[72:75], v[8:11]
  ds_read_b64_tr_b16 a[180:181], v226 offset:8192
  s_add_u32 m0, s28, 114688
  v_min_u32_dpp v138, v138, v138 row_ror:8 row_mask:0xf bank_mask:0xf
  v_mfma_f32_16x16x32_bf16 v[8:11], a[164:167], a[88:91], v[8:11]
  buffer_load_dwordx4 v238, s[20:23], s31 offen offset:0 lds
  v_mfma_f32_16x16x32_bf16 v[12:15], a[164:167], a[92:95], v[12:15]
  ds_read_b64_tr_b16 a[182:183], v226 offset:9216
  v_min_u32_dpp v138, v138, v138 row_ror:4 row_mask:0xf bank_mask:0xf
  v_mfma_f32_16x16x32_bf16 v[12:15], a[160:163], a[76:79], v[12:15]
  s_waitcnt lgkmcnt(4)
  v_min_u32_dpp v138, v138, v138 row_ror:2 row_mask:0xf bank_mask:0xf
  v_mfma_f32_16x16x32_bf16 v[16:19], a[168:171], a[64:67], v[16:19]
  ds_read_b64_tr_b16 a[184:185], v227 offset:0
  v_min_u32_dpp v138, v138, v138 row_ror:1 row_mask:0xf bank_mask:0xf
  v_mfma_f32_16x16x32_bf16 v[16:19], a[172:175], a[80:83], v[16:19]
  buffer_load_dwordx4 a[36:39], v242, s[24:27], s30 offen offset:1024 sc1
  v_mfma_f32_16x16x32_bf16 v[20:23], a[172:175], a[84:87], v[20:23]
  ds_read_b64_tr_b16 a[186:187], v227 offset:1024
  v_sub_u32 v137, v136, v138
  v_mfma_f32_16x16x32_bf16 v[20:23], a[168:171], a[68:71], v[20:23]
  v_add_u32 v136, -1, v137
  v_sub_u32 v139, v136, v128
  v_mfma_f32_16x16x32_bf16 v[24:27], a[168:171], a[72:75], v[24:27]
  ds_read_b64_tr_b16 a[188:189], v227 offset:8192
  v_mov_b32_dpp v145, v137 quad_perm:[0,1,2,3] row_mask:0xf bank_mask:0x4
  v_mfma_f32_16x16x32_bf16 v[24:27], a[172:175], a[88:91], v[24:27]
  v_sub_u32 v140, v136, v129
  v_min_u32 v138, v139, v140
  v_mfma_f32_16x16x32_bf16 v[28:31], a[172:175], a[92:95], v[28:31]
  ds_read_b64_tr_b16 a[190:191], v227 offset:9216
  v_sub_u32 v141, v136, v130
  v_mfma_f32_16x16x32_bf16 v[28:31], a[168:171], a[76:79], v[28:31]
  s_waitcnt lgkmcnt(4)
  v_sub_u32 v142, v136, v131
  v_min3_u32 v138, v138, v141, v142
  v_mfma_f32_16x16x32_bf16 v[32:35], a[176:179], a[64:67], v[32:35]
  ds_read_b64_tr_b16 a[160:161], v228 offset:0
  v_sub_u32 v139, v136, v132
  v_mfma_f32_16x16x32_bf16 v[32:35], a[180:183], a[80:83], v[32:35]
  buffer_load_dwordx4 a[40:43], v242, s[24:27], s30 offen offset:2048 sc1
  v_mfma_f32_16x16x32_bf16 v[36:39], a[180:183], a[84:87], v[36:39]
  ds_read_b64_tr_b16 a[162:163], v228 offset:1024
  v_sub_u32 v140, v136, v133
  v_mfma_f32_16x16x32_bf16 v[36:39], a[176:179], a[68:71], v[36:39]
  v_min3_u32 v138, v138, v139, v140
  v_sub_u32 v141, v136, v134
  v_mfma_f32_16x16x32_bf16 v[40:43], a[176:179], a[72:75], v[40:43]
  ds_read_b64_tr_b16 a[164:165], v228 offset:8192
  v_sub_u32 v142, v136, v135
  v_mfma_f32_16x16x32_bf16 v[40:43], a[180:183], a[88:91], v[40:43]
  buffer_load_dwordx4 v239, s[20:23], s31 offen offset:1024 lds
  v_mfma_f32_16x16x32_bf16 v[44:47], a[180:183], a[92:95], v[44:47]
  ds_read_b64_tr_b16 a[166:167], v228 offset:9216
  v_min3_u32 v138, v138, v141, v142
  v_mfma_f32_16x16x32_bf16 v[44:47], a[176:179], a[76:79], v[44:47]
  s_waitcnt lgkmcnt(4)
  v_min_u32_dpp v138, v138, v138 row_ror:8 row_mask:0xf bank_mask:0xf
  v_mfma_f32_16x16x32_bf16 v[48:51], a[184:187], a[64:67], v[48:51]
  ds_read_b64_tr_b16 a[168:169], v229 offset:0
  v_min_u32_dpp v138, v138, v138 row_ror:4 row_mask:0xf bank_mask:0xf
  v_mfma_f32_16x16x32_bf16 v[48:51], a[188:191], a[80:83], v[48:51]
  buffer_load_dwordx4 a[44:47], v242, s[24:27], s30 offen offset:3072 sc1
  v_mfma_f32_16x16x32_bf16 v[52:55], a[188:191], a[84:87], v[52:55]
  ds_read_b64_tr_b16 a[170:171], v229 offset:1024
  v_min_u32_dpp v138, v138, v138 row_ror:2 row_mask:0xf bank_mask:0xf
  v_mfma_f32_16x16x32_bf16 v[52:55], a[184:187], a[68:71], v[52:55]
  v_mfma_f32_16x16x32_bf16 v[56:59], a[184:187], a[72:75], v[56:59]
  ds_read_b64_tr_b16 a[172:173], v229 offset:8192
  v_min_u32_dpp v138, v138, v138 row_ror:1 row_mask:0xf bank_mask:0xf
  v_mfma_f32_16x16x32_bf16 v[56:59], a[188:191], a[88:91], v[56:59]
  v_sub_u32 v137, v136, v138
  v_add_u32 v136, -1, v137
  v_mfma_f32_16x16x32_bf16 v[60:63], a[188:191], a[92:95], v[60:63]
  ds_read_b64_tr_b16 a[174:175], v229 offset:9216
  v_mov_b32_dpp v145, v137 quad_perm:[0,1,2,3] row_mask:0xf bank_mask:0x8
  v_mfma_f32_16x16x32_bf16 v[60:63], a[184:187], a[76:79], v[60:63]
  s_waitcnt lgkmcnt(4)
  s_lshl_b32 s35, s3, 9
  s_add_u32 s35, s35, 157696
  v_lshrrev_b32 v136, 1, v242
  v_add_u32 v136, s35, v136
  v_mfma_f32_16x16x32_bf16 v[64:67], a[160:163], a[64:67], v[64:67]
  ds_read_b64_tr_b16 a[176:177], v230 offset:0
  ds_write_b64 v136, v[144:145]
  v_mfma_f32_16x16x32_bf16 v[64:67], a[164:167], a[80:83], v[64:67]
  buffer_load_dwordx4 a[48:51], v243, s[24:27], s30 offen offset:0 sc1
  v_mfma_f32_16x16x32_bf16 v[68:71], a[164:167], a[84:87], v[68:71]
  ds_read_b64_tr_b16 a[178:179], v230 offset:1024
  v_mfma_f32_16x16x32_bf16 v[68:71], a[160:163], a[68:71], v[68:71]
  v_mfma_f32_16x16x32_bf16 v[72:75], a[160:163], a[72:75], v[72:75]
  ds_read_b64_tr_b16 a[180:181], v230 offset:8192
  v_mfma_f32_16x16x32_bf16 v[72:75], a[164:167], a[88:91], v[72:75]
  buffer_load_dwordx4 v240, s[20:23], s31 offen offset:2048 lds
  v_mfma_f32_16x16x32_bf16 v[76:79], a[164:167], a[92:95], v[76:79]
  ds_read_b64_tr_b16 a[182:183], v230 offset:9216
  v_mfma_f32_16x16x32_bf16 v[76:79], a[160:163], a[76:79], v[76:79]
  s_waitcnt lgkmcnt(5)
  v_mfma_f32_16x16x32_bf16 v[80:83], a[168:171], a[64:67], v[80:83]
  ds_read_b64_tr_b16 a[184:185], v231 offset:0
  s_waitcnt lgkmcnt(4)
  v_mfma_f32_16x16x32_bf16 v[80:83], a[172:175], a[80:83], v[80:83]
  buffer_load_dwordx4 a[52:55], v243, s[24:27], s30 offen offset:1024 sc1
  v_mfma_f32_16x16x32_bf16 v[84:87], a[172:175], a[84:87], v[84:87]
  ds_read_b64_tr_b16 a[186:187], v231 offset:1024
  v_mfma_f32_16x16x32_bf16 v[84:87], a[168:171], a[68:71], v[84:87]
  s_waitcnt vmcnt(22)
  v_mfma_f32_16x16x32_bf16 v[88:91], a[168:171], a[72:75], v[88:91]
  ds_read_b64_tr_b16 a[188:189], v231 offset:8192
  v_mfma_f32_16x16x32_bf16 v[88:91], a[172:175], a[88:91], v[88:91]
  s_barrier
  v_mfma_f32_16x16x32_bf16 v[92:95], a[172:175], a[92:95], v[92:95]
  ds_read_b64_tr_b16 a[190:191], v231 offset:9216
  v_lshlrev_b32 v137, 1, v242
  v_mfma_f32_16x16x32_bf16 v[92:95], a[168:171], a[76:79], v[92:95]
  s_waitcnt lgkmcnt(4)
  v_add_u32 v137, 157696, v137
  v_mfma_f32_16x16x32_bf16 v[96:99], a[176:179], a[64:67], v[96:99]
  ds_read_b64_tr_b16 a[160:161], v224 offset:16384
  ds_read_b64 v[128:129], v137
  v_mfma_f32_16x16x32_bf16 v[96:99], a[180:183], a[80:83], v[96:99]
  buffer_load_dwordx4 a[56:59], v243, s[24:27], s30 offen offset:2048 sc1
  v_mfma_f32_16x16x32_bf16 v[100:103], a[180:183], a[84:87], v[100:103]
  ds_read_b64_tr_b16 a[162:163], v224 offset:17408
  v_mfma_f32_16x16x32_bf16 v[100:103], a[176:179], a[68:71], v[100:103]
  v_mfma_f32_16x16x32_bf16 v[104:107], a[176:179], a[72:75], v[104:107]
  ds_read_b64_tr_b16 a[164:165], v224 offset:24576
  v_mfma_f32_16x16x32_bf16 v[104:107], a[180:183], a[88:91], v[104:107]
  buffer_load_dwordx4 v241, s[20:23], s31 offen offset:3072 lds
  s_add_u32 s31, s31, 0x80000
  v_mfma_f32_16x16x32_bf16 v[108:111], a[180:183], a[92:95], v[108:111]
  ds_read_b64_tr_b16 a[166:167], v224 offset:25600
  v_mfma_f32_16x16x32_bf16 v[108:111], a[176:179], a[76:79], v[108:111]
  s_waitcnt lgkmcnt(5)
  v_mfma_f32_16x16x32_bf16 v[112:115], a[184:187], a[64:67], v[112:115]
  ds_read_b64_tr_b16 a[168:169], v225 offset:16384
  s_waitcnt lgkmcnt(4)
  v_mov_b32 v137, -1
  v_mfma_f32_16x16x32_bf16 v[112:115], a[188:191], a[80:83], v[112:115]
  buffer_load_dwordx4 a[60:63], v243, s[24:27], s30 offen offset:3072 sc1
  s_add_u32 s30, s30, 8192
  v_mfma_f32_16x16x32_bf16 v[116:119], a[188:191], a[84:87], v[116:119]
  ds_read_b64_tr_b16 a[170:171], v225 offset:17408
  v_sub_u32 v140, v137, v128
  v_mfma_f32_16x16x32_bf16 v[116:119], a[184:187], a[68:71], v[116:119]
  v_sub_u32 v141, v137, v129
  v_min_u32 v139, v140, v141
  v_mfma_f32_16x16x32_bf16 v[120:123], a[184:187], a[72:75], v[120:123]
  ds_read_b64_tr_b16 a[172:173], v225 offset:24576
  v_min_u32_dpp v139, v139, v139 row_ror:8 row_mask:0xf bank_mask:0xf
  v_mfma_f32_16x16x32_bf16 v[120:123], a[188:191], a[88:91], v[120:123]
  v_mfma_f32_16x16x32_bf16 v[124:127], a[188:191], a[92:95], v[124:127]
  ds_read_b64_tr_b16 a[174:175], v225 offset:25600
  v_min_u32_dpp v139, v139, v139 row_ror:4 row_mask:0xf bank_mask:0xf
  v_mfma_f32_16x16x32_bf16 v[124:127], a[184:187], a[76:79], v[124:127]
  s_waitcnt vmcnt(24) lgkmcnt(4)
  v_min_u32_dpp v139, v139, v139 row_ror:2 row_mask:0xf bank_mask:0xf
  v_mfma_f32_16x16x32_bf16 v[0:3], a[160:163], a[96:99], v[0:3]
  ds_read_b64_tr_b16 a[176:177], v226 offset:16384
  v_min_u32_dpp v139, v139, v139 row_ror:1 row_mask:0xf bank_mask:0xf
  v_mfma_f32_16x16x32_bf16 v[0:3], a[164:167], a[112:115], v[0:3]
  v_mov_b32 v140, v139
  v_mfma_f32_16x16x32_bf16 v[4:7], a[164:167], a[116:119], v[4:7]
  ds_read_b64_tr_b16 a[178:179], v226 offset:17408
  v_permlane16_swap_b32 v139, v140
  v_mfma_f32_16x16x32_bf16 v[4:7], a[160:163], a[100:103], v[4:7]
  v_min_u32 v139, v139, v140
  v_mov_b32 v140, v139
  v_mfma_f32_16x16x32_bf16 v[8:11], a[160:163], a[104:107], v[8:11]
  ds_read_b64_tr_b16 a[180:181], v226 offset:24576
  s_add_u32 m0, s28, 0
  v_permlane32_swap_b32 v139, v140
  v_mfma_f32_16x16x32_bf16 v[8:11], a[164:167], a[120:123], v[8:11]
  buffer_load_dwordx4 v232, s[12:15], s29 offen offset:0 lds
  v_mfma_f32_16x16x32_bf16 v[12:15], a[164:167], a[124:127], v[12:15]
  ds_read_b64_tr_b16 a[182:183], v226 offset:25600
  v_min_u32 v139, v139, v140
  v_mfma_f32_16x16x32_bf16 v[12:15], a[160:163], a[108:111], v[12:15]
  s_waitcnt lgkmcnt(4)
  v_sub_u32 v138, v137, v139
  v_add_u32 v137, -1, v138
  v_mfma_f32_16x16x32_bf16 v[16:19], a[168:171], a[96:99], v[16:19]
  ds_read_b64_tr_b16 a[184:185], v227 offset:16384
  v_sub_u32 v140, v137, v128
  v_mfma_f32_16x16x32_bf16 v[16:19], a[172:175], a[112:115], v[16:19]
  v_readfirstlane_b32 s52, v138
  v_sub_u32 v141, v137, v129
  v_mfma_f32_16x16x32_bf16 v[20:23], a[172:175], a[116:119], v[20:23]
  ds_read_b64_tr_b16 a[186:187], v227 offset:17408
  v_min_u32 v139, v140, v141
  v_mfma_f32_16x16x32_bf16 v[20:23], a[168:171], a[100:103], v[20:23]
  v_mfma_f32_16x16x32_bf16 v[24:27], a[168:171], a[104:107], v[24:27]
  ds_read_b64_tr_b16 a[188:189], v227 offset:24576
  v_min_u32_dpp v139, v139, v139 row_ror:8 row_mask:0xf bank_mask:0xf
  v_mfma_f32_16x16x32_bf16 v[24:27], a[172:175], a[120:123], v[24:27]
  v_mfma_f32_16x16x32_bf16 v[28:31], a[172:175], a[124:127], v[28:31]
  ds_read_b64_tr_b16 a[190:191], v227 offset:25600
  v_min_u32_dpp v139, v139, v139 row_ror:4 row_mask:0xf bank_mask:0xf
  v_mfma_f32_16x16x32_bf16 v[28:31], a[168:171], a[108:111], v[28:31]
  s_waitcnt lgkmcnt(4)
  v_min_u32_dpp v139, v139, v139 row_ror:2 row_mask:0xf bank_mask:0xf
  v_mfma_f32_16x16x32_bf16 v[32:35], a[176:179], a[96:99], v[32:35]
  ds_read_b64_tr_b16 a[160:161], v228 offset:16384
  v_min_u32_dpp v139, v139, v139 row_ror:1 row_mask:0xf bank_mask:0xf
  v_mfma_f32_16x16x32_bf16 v[32:35], a[180:183], a[112:115], v[32:35]
  v_mov_b32 v140, v139
  v_mfma_f32_16x16x32_bf16 v[36:39], a[180:183], a[116:119], v[36:39]
  ds_read_b64_tr_b16 a[162:163], v228 offset:17408
  v_permlane16_swap_b32 v139, v140
  v_mfma_f32_16x16x32_bf16 v[36:39], a[176:179], a[100:103], v[36:39]
  v_min_u32 v139, v139, v140
  v_mov_b32 v140, v139
  v_mfma_f32_16x16x32_bf16 v[40:43], a[176:179], a[104:107], v[40:43]
  ds_read_b64_tr_b16 a[164:165], v228 offset:24576
  v_permlane32_swap_b32 v139, v140
  v_mfma_f32_16x16x32_bf16 v[40:43], a[180:183], a[120:123], v[40:43]
  buffer_load_dwordx4 v233, s[12:15], s29 offen offset:1024 lds
  v_mfma_f32_16x16x32_bf16 v[44:47], a[180:183], a[124:127], v[44:47]
  ds_read_b64_tr_b16 a[166:167], v228 offset:25600
  v_min_u32 v139, v139, v140
  v_mfma_f32_16x16x32_bf16 v[44:47], a[176:179], a[108:111], v[44:47]
  s_waitcnt lgkmcnt(4)
  v_sub_u32 v138, v137, v139
  v_add_u32 v137, -1, v138
  v_mfma_f32_16x16x32_bf16 v[48:51], a[184:187], a[96:99], v[48:51]
  ds_read_b64_tr_b16 a[168:169], v229 offset:16384
  v_sub_u32 v140, v137, v128
  v_mfma_f32_16x16x32_bf16 v[48:51], a[188:191], a[112:115], v[48:51]
  v_readfirstlane_b32 s53, v138
  v_sub_u32 v141, v137, v129
  v_mfma_f32_16x16x32_bf16 v[52:55], a[188:191], a[116:119], v[52:55]
  ds_read_b64_tr_b16 a[170:171], v229 offset:17408
  v_min_u32 v139, v140, v141
  v_mfma_f32_16x16x32_bf16 v[52:55], a[184:187], a[100:103], v[52:55]
  v_mfma_f32_16x16x32_bf16 v[56:59], a[184:187], a[104:107], v[56:59]
  ds_read_b64_tr_b16 a[172:173], v229 offset:24576
  v_min_u32_dpp v139, v139, v139 row_ror:8 row_mask:0xf bank_mask:0xf
  v_mfma_f32_16x16x32_bf16 v[56:59], a[188:191], a[120:123], v[56:59]
  v_mfma_f32_16x16x32_bf16 v[60:63], a[188:191], a[124:127], v[60:63]
  ds_read_b64_tr_b16 a[174:175], v229 offset:25600
  v_min_u32_dpp v139, v139, v139 row_ror:4 row_mask:0xf bank_mask:0xf
  v_mfma_f32_16x16x32_bf16 v[60:63], a[184:187], a[108:111], v[60:63]
  s_waitcnt lgkmcnt(4)
  v_min_u32_dpp v139, v139, v139 row_ror:2 row_mask:0xf bank_mask:0xf
  v_mfma_f32_16x16x32_bf16 v[64:67], a[160:163], a[96:99], v[64:67]
  ds_read_b64_tr_b16 a[176:177], v230 offset:16384
  v_min_u32_dpp v139, v139, v139 row_ror:1 row_mask:0xf bank_mask:0xf
  v_mfma_f32_16x16x32_bf16 v[64:67], a[164:167], a[112:115], v[64:67]
  v_mov_b32 v140, v139
  v_mfma_f32_16x16x32_bf16 v[68:71], a[164:167], a[116:119], v[68:71]
  ds_read_b64_tr_b16 a[178:179], v230 offset:17408
  v_permlane16_swap_b32 v139, v140
  v_mfma_f32_16x16x32_bf16 v[68:71], a[160:163], a[100:103], v[68:71]
  v_min_u32 v139, v139, v140
  v_mov_b32 v140, v139
  v_mfma_f32_16x16x32_bf16 v[72:75], a[160:163], a[104:107], v[72:75]
  ds_read_b64_tr_b16 a[180:181], v230 offset:24576
  v_permlane32_swap_b32 v139, v140
  v_mfma_f32_16x16x32_bf16 v[72:75], a[164:167], a[120:123], v[72:75]
  buffer_load_dwordx4 v234, s[12:15], s29 offen offset:2048 lds
  v_mfma_f32_16x16x32_bf16 v[76:79], a[164:167], a[124:127], v[76:79]
  ds_read_b64_tr_b16 a[182:183], v230 offset:25600
  v_min_u32 v139, v139, v140
  v_mfma_f32_16x16x32_bf16 v[76:79], a[160:163], a[108:111], v[76:79]
  s_waitcnt lgkmcnt(4)
  v_sub_u32 v138, v137, v139
  v_add_u32 v137, -1, v138
  v_mfma_f32_16x16x32_bf16 v[80:83], a[168:171], a[96:99], v[80:83]
  ds_read_b64_tr_b16 a[184:185], v231 offset:16384
  v_sub_u32 v140, v137, v128
  v_mfma_f32_16x16x32_bf16 v[80:83], a[172:175], a[112:115], v[80:83]
  v_readfirstlane_b32 s54, v138
  v_sub_u32 v141, v137, v129
  v_mfma_f32_16x16x32_bf16 v[84:87], a[172:175], a[116:119], v[84:87]
  ds_read_b64_tr_b16 a[186:187], v231 offset:17408
  v_min_u32 v139, v140, v141
  v_mfma_f32_16x16x32_bf16 v[84:87], a[168:171], a[100:103], v[84:87]
  s_waitcnt vmcnt(16)
  v_min_u32_dpp v139, v139, v139 row_ror:8 row_mask:0xf bank_mask:0xf
  v_mfma_f32_16x16x32_bf16 v[88:91], a[168:171], a[104:107], v[88:91]
  ds_read_b64_tr_b16 a[188:189], v231 offset:24576
  v_min_u32_dpp v139, v139, v139 row_ror:4 row_mask:0xf bank_mask:0xf
  v_mfma_f32_16x16x32_bf16 v[88:91], a[172:175], a[120:123], v[88:91]
  s_barrier
  v_min_u32_dpp v139, v139, v139 row_ror:2 row_mask:0xf bank_mask:0xf
  v_mfma_f32_16x16x32_bf16 v[92:95], a[172:175], a[124:127], v[92:95]
  ds_read_b64_tr_b16 a[190:191], v231 offset:25600
  v_min_u32_dpp v139, v139, v139 row_ror:1 row_mask:0xf bank_mask:0xf
  v_mfma_f32_16x16x32_bf16 v[92:95], a[168:171], a[108:111], v[92:95]
  s_waitcnt lgkmcnt(4)
  v_mov_b32 v140, v139
  v_mfma_f32_16x16x32_bf16 v[96:99], a[176:179], a[96:99], v[96:99]
  ds_read_b64_tr_b16 a[160:161], v224 offset:32768
  v_permlane16_swap_b32 v139, v140
  v_mfma_f32_16x16x32_bf16 v[96:99], a[180:183], a[112:115], v[96:99]
  v_min_u32 v139, v139, v140
  v_mov_b32 v140, v139
  v_mfma_f32_16x16x32_bf16 v[100:103], a[180:183], a[116:119], v[100:103]
  ds_read_b64_tr_b16 a[162:163], v224 offset:33792
  v_permlane32_swap_b32 v139, v140
  v_mfma_f32_16x16x32_bf16 v[100:103], a[176:179], a[100:103], v[100:103]
  v_min_u32 v139, v139, v140
  v_sub_u32 v138, v137, v139
  v_mfma_f32_16x16x32_bf16 v[104:107], a[176:179], a[104:107], v[104:107]
  ds_read_b64_tr_b16 a[164:165], v224 offset:40960
  v_add_u32 v137, -1, v138
  v_mfma_f32_16x16x32_bf16 v[104:107], a[180:183], a[120:123], v[104:107]
  buffer_load_dwordx4 v235, s[12:15], s29 offen offset:3072 lds
  v_mfma_f32_16x16x32_bf16 v[108:111], a[180:183], a[124:127], v[108:111]
  ds_read_b64_tr_b16 a[166:167], v224 offset:41984
  v_sub_u32 v140, v137, v128
  v_mfma_f32_16x16x32_bf16 v[108:111], a[176:179], a[108:111], v[108:111]
  s_waitcnt lgkmcnt(4)
  v_readfirstlane_b32 s55, v138
  v_sub_u32 v141, v137, v129
  v_mfma_f32_16x16x32_bf16 v[112:115], a[184:187], a[96:99], v[112:115]
  ds_read_b64_tr_b16 a[168:169], v225 offset:32768
  v_min_u32 v139, v140, v141
  v_mfma_f32_16x16x32_bf16 v[112:115], a[188:191], a[112:115], v[112:115]
  v_mfma_f32_16x16x32_bf16 v[116:119], a[188:191], a[116:119], v[116:119]
  ds_read_b64_tr_b16 a[170:171], v225 offset:33792
  v_min_u32_dpp v139, v139, v139 row_ror:8 row_mask:0xf bank_mask:0xf
  v_mfma_f32_16x16x32_bf16 v[116:119], a[184:187], a[100:103], v[116:119]
  v_mfma_f32_16x16x32_bf16 v[120:123], a[184:187], a[104:107], v[120:123]
  ds_read_b64_tr_b16 a[172:173], v225 offset:40960
  v_min_u32_dpp v139, v139, v139 row_ror:4 row_mask:0xf bank_mask:0xf
  v_mfma_f32_16x16x32_bf16 v[120:123], a[188:191], a[120:123], v[120:123]
  v_mfma_f32_16x16x32_bf16 v[124:127], a[188:191], a[124:127], v[124:127]
  ds_read_b64_tr_b16 a[174:175], v225 offset:41984
  v_min_u32_dpp v139, v139, v139 row_ror:2 row_mask:0xf bank_mask:0xf
  v_mfma_f32_16x16x32_bf16 v[124:127], a[184:187], a[108:111], v[124:127]
  s_waitcnt vmcnt(16) lgkmcnt(4)
  v_min_u32_dpp v139, v139, v139 row_ror:1 row_mask:0xf bank_mask:0xf
  v_mov_b32 v140, v139
  v_mfma_f32_16x16x32_bf16 v[0:3], a[160:163], a[0:3], v[0:3]
  ds_read_b64_tr_b16 a[176:177], v226 offset:32768
  v_permlane16_swap_b32 v139, v140
  v_mfma_f32_16x16x32_bf16 v[0:3], a[164:167], a[16:19], v[0:3]
  v_min_u32 v139, v139, v140
  v_mov_b32 v140, v139
  v_mfma_f32_16x16x32_bf16 v[4:7], a[164:167], a[20:23], v[4:7]
  ds_read_b64_tr_b16 a[178:179], v226 offset:33792
  v_permlane32_swap_b32 v139, v140
  v_mfma_f32_16x16x32_bf16 v[4:7], a[160:163], a[4:7], v[4:7]
  v_min_u32 v139, v139, v140
  v_sub_u32 v138, v137, v139
  v_mfma_f32_16x16x32_bf16 v[8:11], a[160:163], a[8:11], v[8:11]
  ds_read_b64_tr_b16 a[180:181], v226 offset:40960
  s_add_u32 m0, s28, 65536
  v_add_u32 v137, -1, v138
  v_mfma_f32_16x16x32_bf16 v[8:11], a[164:167], a[24:27], v[8:11]
  buffer_load_dwordx4 v236, s[16:19], s29 offen offset:0 lds
  v_mfma_f32_16x16x32_bf16 v[12:15], a[164:167], a[28:31], v[12:15]
  ds_read_b64_tr_b16 a[182:183], v226 offset:41984
  v_sub_u32 v140, v137, v128
  v_mfma_f32_16x16x32_bf16 v[12:15], a[160:163], a[12:15], v[12:15]
  s_waitcnt lgkmcnt(4)
  v_readfirstlane_b32 s56, v138
  v_sub_u32 v141, v137, v129
  v_mfma_f32_16x16x32_bf16 v[16:19], a[168:171], a[0:3], v[16:19]
  ds_read_b64_tr_b16 a[184:185], v227 offset:32768
  v_min_u32 v139, v140, v141
  v_mfma_f32_16x16x32_bf16 v[16:19], a[172:175], a[16:19], v[16:19]
  v_mfma_f32_16x16x32_bf16 v[20:23], a[172:175], a[20:23], v[20:23]
  ds_read_b64_tr_b16 a[186:187], v227 offset:33792
  v_min_u32_dpp v139, v139, v139 row_ror:8 row_mask:0xf bank_mask:0xf
  v_mfma_f32_16x16x32_bf16 v[20:23], a[168:171], a[4:7], v[20:23]
  v_mfma_f32_16x16x32_bf16 v[24:27], a[168:171], a[8:11], v[24:27]
  ds_read_b64_tr_b16 a[188:189], v227 offset:40960
  v_min_u32_dpp v139, v139, v139 row_ror:4 row_mask:0xf bank_mask:0xf
  v_mfma_f32_16x16x32_bf16 v[24:27], a[172:175], a[24:27], v[24:27]
  v_mfma_f32_16x16x32_bf16 v[28:31], a[172:175], a[28:31], v[28:31]
  ds_read_b64_tr_b16 a[190:191], v227 offset:41984
  v_min_u32_dpp v139, v139, v139 row_ror:2 row_mask:0xf bank_mask:0xf
  v_mfma_f32_16x16x32_bf16 v[28:31], a[168:171], a[12:15], v[28:31]
  s_waitcnt lgkmcnt(4)
  v_min_u32_dpp v139, v139, v139 row_ror:1 row_mask:0xf bank_mask:0xf
  v_mov_b32 v140, v139
  v_mfma_f32_16x16x32_bf16 v[32:35], a[176:179], a[0:3], v[32:35]
  ds_read_b64_tr_b16 a[160:161], v228 offset:32768
  v_permlane16_swap_b32 v139, v140
  v_mfma_f32_16x16x32_bf16 v[32:35], a[180:183], a[16:19], v[32:35]
  v_min_u32 v139, v139, v140
  v_mov_b32 v140, v139
  v_mfma_f32_16x16x32_bf16 v[36:39], a[180:183], a[20:23], v[36:39]
  ds_read_b64_tr_b16 a[162:163], v228 offset:33792
  v_permlane32_swap_b32 v139, v140
  v_mfma_f32_16x16x32_bf16 v[36:39], a[176:179], a[4:7], v[36:39]
  v_min_u32 v139, v139, v140
  v_sub_u32 v138, v137, v139
  v_mfma_f32_16x16x32_bf16 v[40:43], a[176:179], a[8:11], v[40:43]
  ds_read_b64_tr_b16 a[164:165], v228 offset:40960
  v_add_u32 v137, -1, v138
  v_mfma_f32_16x16x32_bf16 v[40:43], a[180:183], a[24:27], v[40:43]
  buffer_load_dwordx4 v237, s[16:19], s29 offen offset:1024 lds
  v_mfma_f32_16x16x32_bf16 v[44:47], a[180:183], a[28:31], v[44:47]
  ds_read_b64_tr_b16 a[166:167], v228 offset:41984
  v_sub_u32 v140, v137, v128
  v_mfma_f32_16x16x32_bf16 v[44:47], a[176:179], a[12:15], v[44:47]
  s_waitcnt lgkmcnt(4)
  v_readfirstlane_b32 s57, v138
  v_sub_u32 v141, v137, v129
  v_mfma_f32_16x16x32_bf16 v[48:51], a[184:187], a[0:3], v[48:51]
  ds_read_b64_tr_b16 a[168:169], v229 offset:32768
  v_min_u32 v139, v140, v141
  v_mfma_f32_16x16x32_bf16 v[48:51], a[188:191], a[16:19], v[48:51]
  v_mfma_f32_16x16x32_bf16 v[52:55], a[188:191], a[20:23], v[52:55]
  ds_read_b64_tr_b16 a[170:171], v229 offset:33792
  v_min_u32_dpp v139, v139, v139 row_ror:8 row_mask:0xf bank_mask:0xf
  v_mfma_f32_16x16x32_bf16 v[52:55], a[184:187], a[4:7], v[52:55]
  v_mfma_f32_16x16x32_bf16 v[56:59], a[184:187], a[8:11], v[56:59]
  ds_read_b64_tr_b16 a[172:173], v229 offset:40960
  v_min_u32_dpp v139, v139, v139 row_ror:4 row_mask:0xf bank_mask:0xf
  v_mfma_f32_16x16x32_bf16 v[56:59], a[188:191], a[24:27], v[56:59]
  v_mfma_f32_16x16x32_bf16 v[60:63], a[188:191], a[28:31], v[60:63]
  ds_read_b64_tr_b16 a[174:175], v229 offset:41984
  v_min_u32_dpp v139, v139, v139 row_ror:2 row_mask:0xf bank_mask:0xf
  v_mfma_f32_16x16x32_bf16 v[60:63], a[184:187], a[12:15], v[60:63]
  s_waitcnt lgkmcnt(4)
  v_min_u32_dpp v139, v139, v139 row_ror:1 row_mask:0xf bank_mask:0xf
  v_mov_b32 v140, v139
  v_mfma_f32_16x16x32_bf16 v[64:67], a[160:163], a[0:3], v[64:67]
  ds_read_b64_tr_b16 a[176:177], v230 offset:32768
  v_permlane16_swap_b32 v139, v140
  v_mfma_f32_16x16x32_bf16 v[64:67], a[164:167], a[16:19], v[64:67]
  v_min_u32 v139, v139, v140
  v_mov_b32 v140, v139
  v_mfma_f32_16x16x32_bf16 v[68:71], a[164:167], a[20:23], v[68:71]
  ds_read_b64_tr_b16 a[178:179], v230 offset:33792
  v_permlane32_swap_b32 v139, v140
  v_mfma_f32_16x16x32_bf16 v[68:71], a[160:163], a[4:7], v[68:71]
  v_min_u32 v139, v139, v140
  v_sub_u32 v138, v137, v139
  v_mfma_f32_16x16x32_bf16 v[72:75], a[160:163], a[8:11], v[72:75]
  ds_read_b64_tr_b16 a[180:181], v230 offset:40960
  v_add_u32 v137, -1, v138
  v_mfma_f32_16x16x32_bf16 v[72:75], a[164:167], a[24:27], v[72:75]
  buffer_load_dwordx4 v236, s[16:19], s29 offen offset:2048 lds
  v_mfma_f32_16x16x32_bf16 v[76:79], a[164:167], a[28:31], v[76:79]
  ds_read_b64_tr_b16 a[182:183], v230 offset:41984
  v_sub_u32 v140, v137, v128
  v_mfma_f32_16x16x32_bf16 v[76:79], a[160:163], a[12:15], v[76:79]
  s_waitcnt lgkmcnt(4)
  v_readfirstlane_b32 s58, v138
  v_sub_u32 v141, v137, v129
  v_mfma_f32_16x16x32_bf16 v[80:83], a[168:171], a[0:3], v[80:83]
  ds_read_b64_tr_b16 a[184:185], v231 offset:32768
  v_min_u32 v139, v140, v141
  v_mfma_f32_16x16x32_bf16 v[80:83], a[172:175], a[16:19], v[80:83]
  v_mfma_f32_16x16x32_bf16 v[84:87], a[172:175], a[20:23], v[84:87]
  ds_read_b64_tr_b16 a[186:187], v231 offset:33792
  v_min_u32_dpp v139, v139, v139 row_ror:8 row_mask:0xf bank_mask:0xf
  v_mfma_f32_16x16x32_bf16 v[84:87], a[168:171], a[4:7], v[84:87]
  s_waitcnt vmcnt(8)
  v_min_u32_dpp v139, v139, v139 row_ror:4 row_mask:0xf bank_mask:0xf
  v_mfma_f32_16x16x32_bf16 v[88:91], a[168:171], a[8:11], v[88:91]
  ds_read_b64_tr_b16 a[188:189], v231 offset:40960
  v_min_u32_dpp v139, v139, v139 row_ror:2 row_mask:0xf bank_mask:0xf
  v_mfma_f32_16x16x32_bf16 v[88:91], a[172:175], a[24:27], v[88:91]
  s_barrier
  v_min_u32_dpp v139, v139, v139 row_ror:1 row_mask:0xf bank_mask:0xf
  v_mov_b32 v140, v139
  v_mfma_f32_16x16x32_bf16 v[92:95], a[172:175], a[28:31], v[92:95]
  ds_read_b64_tr_b16 a[190:191], v231 offset:41984
  v_permlane16_swap_b32 v139, v140
  v_mfma_f32_16x16x32_bf16 v[92:95], a[168:171], a[12:15], v[92:95]
  s_waitcnt lgkmcnt(4)
  v_min_u32 v139, v139, v140
  v_mov_b32 v140, v139
  v_mfma_f32_16x16x32_bf16 v[96:99], a[176:179], a[0:3], v[96:99]
  ds_read_b64_tr_b16 a[160:161], v224 offset:49152
  v_permlane32_swap_b32 v139, v140
  v_mfma_f32_16x16x32_bf16 v[96:99], a[180:183], a[16:19], v[96:99]
  v_min_u32 v139, v139, v140
  v_sub_u32 v138, v137, v139
  v_mfma_f32_16x16x32_bf16 v[100:103], a[180:183], a[20:23], v[100:103]
  ds_read_b64_tr_b16 a[162:163], v224 offset:50176
  v_add_u32 v137, -1, v138
  v_mfma_f32_16x16x32_bf16 v[100:103], a[176:179], a[4:7], v[100:103]
  v_readfirstlane_b32 s59, v138
  v_lshrrev_b32 v136, 4, v242
  v_mfma_f32_16x16x32_bf16 v[104:107], a[176:179], a[8:11], v[104:107]
  ds_read_b64_tr_b16 a[164:165], v224 offset:57344
  v_mov_b32 v128, 0
  v_mfma_f32_16x16x32_bf16 v[104:107], a[180:183], a[24:27], v[104:107]
  buffer_load_dwordx4 v237, s[16:19], s29 offen offset:3072 lds
  s_add_u32 s29, s29, 16384
  v_mfma_f32_16x16x32_bf16 v[108:111], a[180:183], a[28:31], v[108:111]
  ds_read_b64_tr_b16 a[166:167], v224 offset:58368
  v_writelane_b32 v128, s52, 0
  v_mfma_f32_16x16x32_bf16 v[108:111], a[176:179], a[12:15], v[108:111]
  s_waitcnt lgkmcnt(4)
  v_writelane_b32 v128, s53, 1
  v_writelane_b32 v128, s54, 2
  v_mfma_f32_16x16x32_bf16 v[112:115], a[184:187], a[0:3], v[112:115]
  ds_read_b64_tr_b16 a[168:169], v225 offset:49152
  v_writelane_b32 v128, s55, 3
  v_mfma_f32_16x16x32_bf16 v[112:115], a[188:191], a[16:19], v[112:115]
  v_writelane_b32 v128, s56, 4
  v_writelane_b32 v128, s57, 5
  v_mfma_f32_16x16x32_bf16 v[116:119], a[188:191], a[20:23], v[116:119]
  ds_read_b64_tr_b16 a[170:171], v225 offset:50176
  v_writelane_b32 v128, s58, 6
  v_mfma_f32_16x16x32_bf16 v[116:119], a[184:187], a[4:7], v[116:119]
  v_writelane_b32 v128, s59, 7
  v_and_b32 v129, 0xffff, v128
  v_mfma_f32_16x16x32_bf16 v[120:123], a[184:187], a[8:11], v[120:123]
  ds_read_b64_tr_b16 a[172:173], v225 offset:57344
  v_sub_u32 v129, 0xffff, v129
  v_mfma_f32_16x16x32_bf16 v[120:123], a[188:191], a[24:27], v[120:123]
  v_and_b32 v129, 0x7ff, v129
  v_mov_b32 v130, v129
  v_mfma_f32_16x16x32_bf16 v[124:127], a[188:191], a[28:31], v[124:127]
  ds_read_b64_tr_b16 a[174:175], v225 offset:58368
  v_permlane16_swap_b32 v129, v130
  v_mfma_f32_16x16x32_bf16 v[124:127], a[184:187], a[12:15], v[124:127]
  s_waitcnt vmcnt(8) lgkmcnt(4)
  v_mov_b32 v130, v129
  v_mfma_f32_16x16x32_bf16 v[0:3], a[160:163], a[32:35], v[0:3]
  ds_read_b64_tr_b16 a[176:177], v226 offset:49152
  s_add_u32 m0, s28, 16384
  v_permlane32_swap_b32 v129, v130
  v_mfma_f32_16x16x32_bf16 v[0:3], a[164:167], a[48:51], v[0:3]
  buffer_load_dwordx4 v232, s[12:15], s29 offen offset:0 lds
  v_mfma_f32_16x16x32_bf16 v[4:7], a[164:167], a[52:55], v[4:7]
  ds_read_b64_tr_b16 a[178:179], v226 offset:50176
  v_lshrrev_b32 v130, 6, v129
  v_mfma_f32_16x16x32_bf16 v[4:7], a[160:163], a[36:39], v[4:7]
  v_mul_u32_u24 v130, 0x14000, v130
  v_bfe_u32 v131, v129, 4, 2
  v_mfma_f32_16x16x32_bf16 v[8:11], a[160:163], a[40:43], v[8:11]
  ds_read_b64_tr_b16 a[180:181], v226 offset:57344
  v_lshl_add_u32 v130, v131, 10, v130
  v_mfma_f32_16x16x32_bf16 v[8:11], a[164:167], a[56:59], v[8:11]
  buffer_load_dwordx4 v233, s[12:15], s29 offen offset:1024 lds
  v_mfma_f32_16x16x32_bf16 v[12:15], a[164:167], a[60:63], v[12:15]
  ds_read_b64_tr_b16 a[182:183], v226 offset:58368
  v_and_b32 v131, 15, v129
  v_mfma_f32_16x16x32_bf16 v[12:15], a[160:163], a[44:47], v[12:15]
  s_waitcnt lgkmcnt(4)
  v_lshl_add_u32 v130, v131, 4, v130
  v_lshrrev_b32 v131, 4, v136
  v_mfma_f32_16x16x32_bf16 v[16:19], a[168:171], a[32:35], v[16:19]
  ds_read_b64_tr_b16 a[184:185], v227 offset:49152
  v_lshl_add_u32 v243, v131, 8, v130
  v_mfma_f32_16x16x32_bf16 v[16:19], a[172:175], a[48:51], v[16:19]
  buffer_load_dwordx4 v234, s[12:15], s29 offen offset:2048 lds
  v_mfma_f32_16x16x32_bf16 v[20:23], a[172:175], a[52:55], v[20:23]
  ds_read_b64_tr_b16 a[186:187], v227 offset:50176
  v_mfma_f32_16x16x32_bf16 v[20:23], a[168:171], a[36:39], v[20:23]
  buffer_load_dwordx4 v235, s[12:15], s29 offen offset:3072 lds
  v_mfma_f32_16x16x32_bf16 v[24:27], a[168:171], a[40:43], v[24:27]
  ds_read_b64_tr_b16 a[188:189], v227 offset:57344
  v_mfma_f32_16x16x32_bf16 v[24:27], a[172:175], a[56:59], v[24:27]
  v_mul_f32 v0, s34, v0
  v_mul_f32 v1, s34, v1
  v_mfma_f32_16x16x32_bf16 v[28:31], a[172:175], a[60:63], v[28:31]
  ds_read_b64_tr_b16 a[190:191], v227 offset:58368
  v_mul_f32 v2, s34, v2
  v_mfma_f32_16x16x32_bf16 v[28:31], a[168:171], a[44:47], v[28:31]
  s_waitcnt lgkmcnt(4)
  v_mul_f32 v3, s34, v3
  v_mul_f32 v16, s34, v16
  v_mfma_f32_16x16x32_bf16 v[32:35], a[176:179], a[32:35], v[32:35]
  ds_read_b64_tr_b16 a[160:161], v228 offset:49152
  v_mul_f32 v17, s34, v17
  v_mfma_f32_16x16x32_bf16 v[32:35], a[180:183], a[48:51], v[32:35]
  v_mul_f32 v18, s34, v18
  v_mul_f32 v19, s34, v19
  v_mfma_f32_16x16x32_bf16 v[36:39], a[180:183], a[52:55], v[36:39]
  ds_read_b64_tr_b16 a[162:163], v228 offset:50176
  v_cvt_pk_bf16_f32 v128, v0, v1
  v_mfma_f32_16x16x32_bf16 v[36:39], a[176:179], a[36:39], v[36:39]
  v_cvt_pk_bf16_f32 v129, v2, v3
  v_cvt_pk_bf16_f32 v130, v16, v17
  v_mfma_f32_16x16x32_bf16 v[40:43], a[176:179], a[40:43], v[40:43]
  ds_read_b64_tr_b16 a[164:165], v228 offset:57344
  v_cvt_pk_bf16_f32 v131, v18, v19
  v_mfma_f32_16x16x32_bf16 v[40:43], a[180:183], a[56:59], v[40:43]
  v_mul_f32 v4, s34, v4
  v_mul_f32 v5, s34, v5
  v_mfma_f32_16x16x32_bf16 v[44:47], a[180:183], a[60:63], v[44:47]
  ds_read_b64_tr_b16 a[166:167], v228 offset:58368
  v_mul_f32 v6, s34, v6
  v_mfma_f32_16x16x32_bf16 v[44:47], a[176:179], a[44:47], v[44:47]
  s_waitcnt lgkmcnt(4)
  v_mul_f32 v7, s34, v7
  v_mul_f32 v20, s34, v20
  v_mfma_f32_16x16x32_bf16 v[48:51], a[184:187], a[32:35], v[48:51]
  ds_read_b64_tr_b16 a[168:169], v229 offset:49152
  v_mul_f32 v21, s34, v21
  v_mfma_f32_16x16x32_bf16 v[48:51], a[188:191], a[48:51], v[48:51]
  v_mul_f32 v22, s34, v22
  v_mul_f32 v23, s34, v23
  v_mfma_f32_16x16x32_bf16 v[52:55], a[188:191], a[52:55], v[52:55]
  ds_read_b64_tr_b16 a[170:171], v229 offset:50176
  v_cvt_pk_bf16_f32 v144, v4, v5
  v_mfma_f32_16x16x32_bf16 v[52:55], a[184:187], a[36:39], v[52:55]
  v_cvt_pk_bf16_f32 v145, v6, v7
  v_cvt_pk_bf16_f32 v146, v20, v21
  v_mfma_f32_16x16x32_bf16 v[56:59], a[184:187], a[40:43], v[56:59]
  ds_read_b64_tr_b16 a[172:173], v229 offset:57344
  v_cvt_pk_bf16_f32 v147, v22, v23
  v_mfma_f32_16x16x32_bf16 v[56:59], a[188:191], a[56:59], v[56:59]
  v_permlane16_swap_b32 v128, v130
  v_permlane16_swap_b32 v129, v131
  v_mfma_f32_16x16x32_bf16 v[60:63], a[188:191], a[60:63], v[60:63]
  ds_read_b64_tr_b16 a[174:175], v229 offset:58368
  v_mul_f32 v8, s34, v8
  v_mfma_f32_16x16x32_bf16 v[60:63], a[184:187], a[44:47], v[60:63]
  s_waitcnt lgkmcnt(4)
  v_mul_f32 v9, s34, v9
  v_mul_f32 v10, s34, v10
  v_mfma_f32_16x16x32_bf16 v[64:67], a[160:163], a[32:35], v[64:67]
  ds_read_b64_tr_b16 a[176:177], v230 offset:49152
  v_mul_f32 v11, s34, v11
  v_mfma_f32_16x16x32_bf16 v[64:67], a[164:167], a[48:51], v[64:67]
  v_mul_f32 v24, s34, v24
  v_mul_f32 v25, s34, v25
  v_mfma_f32_16x16x32_bf16 v[68:71], a[164:167], a[52:55], v[68:71]
  ds_read_b64_tr_b16 a[178:179], v230 offset:50176
  v_mul_f32 v26, s34, v26
  v_mfma_f32_16x16x32_bf16 v[68:71], a[160:163], a[36:39], v[68:71]
  v_mul_f32 v27, s34, v27
  v_cvt_pk_bf16_f32 v160, v8, v9
  v_mfma_f32_16x16x32_bf16 v[72:75], a[160:163], a[40:43], v[72:75]
  ds_read_b64_tr_b16 a[180:181], v230 offset:57344
  v_cvt_pk_bf16_f32 v161, v10, v11
  v_mfma_f32_16x16x32_bf16 v[72:75], a[164:167], a[56:59], v[72:75]
  v_cvt_pk_bf16_f32 v162, v24, v25
  v_cvt_pk_bf16_f32 v163, v26, v27
  v_mfma_f32_16x16x32_bf16 v[76:79], a[164:167], a[60:63], v[76:79]
  ds_read_b64_tr_b16 a[182:183], v230 offset:58368
  v_permlane16_swap_b32 v144, v146
  v_mfma_f32_16x16x32_bf16 v[76:79], a[160:163], a[44:47], v[76:79]
  s_waitcnt lgkmcnt(4)
  v_permlane16_swap_b32 v145, v147
  v_mul_f32 v12, s34, v12
  v_mfma_f32_16x16x32_bf16 v[80:83], a[168:171], a[32:35], v[80:83]
  ds_read_b64_tr_b16 a[184:185], v231 offset:49152
  v_mul_f32 v13, s34, v13
  v_mfma_f32_16x16x32_bf16 v[80:83], a[172:175], a[48:51], v[80:83]
  v_mul_f32 v14, s34, v14
  v_mul_f32 v15, s34, v15
  v_mfma_f32_16x16x32_bf16 v[84:87], a[172:175], a[52:55], v[84:87]
  ds_read_b64_tr_b16 a[186:187], v231 offset:50176
  v_mul_f32 v28, s34, v28
  v_mfma_f32_16x16x32_bf16 v[84:87], a[168:171], a[36:39], v[84:87]
  s_waitcnt vmcnt(8)
  v_mul_f32 v29, s34, v29
  v_mul_f32 v30, s34, v30
  v_mfma_f32_16x16x32_bf16 v[88:91], a[168:171], a[40:43], v[88:91]
  ds_read_b64_tr_b16 a[188:189], v231 offset:57344
  v_mul_f32 v31, s34, v31
  v_mfma_f32_16x16x32_bf16 v[88:91], a[172:175], a[56:59], v[88:91]
  s_barrier
  v_cvt_pk_bf16_f32 v176, v12, v13
  v_cvt_pk_bf16_f32 v177, v14, v15
  v_mfma_f32_16x16x32_bf16 v[92:95], a[172:175], a[60:63], v[92:95]
  ds_read_b64_tr_b16 a[190:191], v231 offset:58368
  v_cvt_pk_bf16_f32 v178, v28, v29
  v_mfma_f32_16x16x32_bf16 v[92:95], a[168:171], a[44:47], v[92:95]
  s_waitcnt lgkmcnt(4)
  v_cvt_pk_bf16_f32 v179, v30, v31
  v_permlane16_swap_b32 v160, v162
  v_mfma_f32_16x16x32_bf16 v[96:99], a[176:179], a[32:35], v[96:99]
  ds_read_b128 a[128:131], v212 offset:0
  v_permlane16_swap_b32 v161, v163
  v_mfma_f32_16x16x32_bf16 v[96:99], a[180:183], a[48:51], v[96:99]
  v_mul_f32 v32, s34, v32
  v_mul_f32 v33, s34, v33
  v_mfma_f32_16x16x32_bf16 v[100:103], a[180:183], a[52:55], v[100:103]
  ds_read_b128 a[132:135], v213 offset:0
  v_mul_f32 v34, s34, v34
  v_mfma_f32_16x16x32_bf16 v[100:103], a[176:179], a[36:39], v[100:103]
  v_mul_f32 v35, s34, v35
  v_mul_f32 v48, s34, v48
  v_mfma_f32_16x16x32_bf16 v[104:107], a[176:179], a[40:43], v[104:107]
  ds_read_b128 a[136:139], v214 offset:0
  v_mul_f32 v49, s34, v49
  v_mfma_f32_16x16x32_bf16 v[104:107], a[180:183], a[56:59], v[104:107]
  v_mul_f32 v50, s34, v50
  v_mul_f32 v51, s34, v51
  v_mfma_f32_16x16x32_bf16 v[108:111], a[180:183], a[60:63], v[108:111]
  ds_read_b128 a[140:143], v215 offset:0
  v_cvt_pk_bf16_f32 v132, v32, v33
  v_mfma_f32_16x16x32_bf16 v[108:111], a[176:179], a[44:47], v[108:111]
  s_waitcnt lgkmcnt(4)
  v_cvt_pk_bf16_f32 v133, v34, v35
  v_cvt_pk_bf16_f32 v134, v48, v49
  v_mfma_f32_16x16x32_bf16 v[112:115], a[184:187], a[32:35], v[112:115]
  v_cvt_pk_bf16_f32 v135, v50, v51
  v_permlane16_swap_b32 v176, v178
  v_mfma_f32_16x16x32_bf16 v[112:115], a[188:191], a[48:51], v[112:115]
  v_permlane16_swap_b32 v177, v179
  v_mul_f32 v36, s34, v36
  v_mfma_f32_16x16x32_bf16 v[116:119], a[188:191], a[52:55], v[116:119]
  v_mul_f32 v37, s34, v37
  v_mul_f32 v38, s34, v38
  v_mfma_f32_16x16x32_bf16 v[116:119], a[184:187], a[36:39], v[116:119]
  v_mul_f32 v39, s34, v39
  v_mul_f32 v52, s34, v52
  v_mfma_f32_16x16x32_bf16 v[120:123], a[184:187], a[40:43], v[120:123]
  v_mul_f32 v53, s34, v53
  v_mul_f32 v54, s34, v54
  v_mfma_f32_16x16x32_bf16 v[120:123], a[188:191], a[56:59], v[120:123]
  v_mul_f32 v55, s34, v55
  v_cvt_pk_bf16_f32 v148, v36, v37
  v_mfma_f32_16x16x32_bf16 v[124:127], a[188:191], a[60:63], v[124:127]
  v_cvt_pk_bf16_f32 v149, v38, v39
  v_cvt_pk_bf16_f32 v150, v52, v53
  v_mfma_f32_16x16x32_bf16 v[124:127], a[184:187], a[44:47], v[124:127]
  s_waitcnt lgkmcnt(0)
  v_cvt_pk_bf16_f32 v151, v54, v55
  v_permlane16_swap_b32 v132, v134
  v_permlane16_swap_b32 v133, v135
  v_pk_mul_f32 v[40:41], v[40:41], s[34:35] op_sel_hi:[1,0]
  v_pk_mul_f32 v[42:43], v[42:43], s[34:35] op_sel_hi:[1,0]
  v_pk_mul_f32 v[56:57], v[56:57], s[34:35] op_sel_hi:[1,0]
  v_pk_mul_f32 v[58:59], v[58:59], s[34:35] op_sel_hi:[1,0]
  v_cvt_pk_bf16_f32 v164, v40, v41
  v_cvt_pk_bf16_f32 v165, v42, v43
  v_cvt_pk_bf16_f32 v166, v56, v57
  v_cvt_pk_bf16_f32 v167, v58, v59
  v_permlane16_swap_b32 v148, v150
  v_permlane16_swap_b32 v149, v151
  v_pk_mul_f32 v[44:45], v[44:45], s[34:35] op_sel_hi:[1,0]
  v_pk_mul_f32 v[46:47], v[46:47], s[34:35] op_sel_hi:[1,0]
  v_pk_mul_f32 v[60:61], v[60:61], s[34:35] op_sel_hi:[1,0]
  v_pk_mul_f32 v[62:63], v[62:63], s[34:35] op_sel_hi:[1,0]
  v_cvt_pk_bf16_f32 v180, v44, v45
  v_cvt_pk_bf16_f32 v181, v46, v47
  v_cvt_pk_bf16_f32 v182, v60, v61
  v_cvt_pk_bf16_f32 v183, v62, v63
  v_permlane16_swap_b32 v164, v166
  v_permlane16_swap_b32 v165, v167
  v_pk_mul_f32 v[64:65], v[64:65], s[34:35] op_sel_hi:[1,0]
  v_pk_mul_f32 v[66:67], v[66:67], s[34:35] op_sel_hi:[1,0]
  v_pk_mul_f32 v[80:81], v[80:81], s[34:35] op_sel_hi:[1,0]
  v_pk_mul_f32 v[82:83], v[82:83], s[34:35] op_sel_hi:[1,0]
  v_cvt_pk_bf16_f32 v136, v64, v65
  v_cvt_pk_bf16_f32 v137, v66, v67
  v_cvt_pk_bf16_f32 v138, v80, v81
  v_cvt_pk_bf16_f32 v139, v82, v83
  v_permlane16_swap_b32 v180, v182
  v_permlane16_swap_b32 v181, v183
  v_pk_mul_f32 v[68:69], v[68:69], s[34:35] op_sel_hi:[1,0]
  v_pk_mul_f32 v[70:71], v[70:71], s[34:35] op_sel_hi:[1,0]
  v_pk_mul_f32 v[84:85], v[84:85], s[34:35] op_sel_hi:[1,0]
  v_pk_mul_f32 v[86:87], v[86:87], s[34:35] op_sel_hi:[1,0]
  v_cvt_pk_bf16_f32 v152, v68, v69
  v_cvt_pk_bf16_f32 v153, v70, v71
  v_cvt_pk_bf16_f32 v154, v84, v85
  v_cvt_pk_bf16_f32 v155, v86, v87
  v_permlane16_swap_b32 v136, v138
  v_permlane16_swap_b32 v137, v139
  v_pk_mul_f32 v[72:73], v[72:73], s[34:35] op_sel_hi:[1,0]
  v_pk_mul_f32 v[74:75], v[74:75], s[34:35] op_sel_hi:[1,0]
  v_pk_mul_f32 v[88:89], v[88:89], s[34:35] op_sel_hi:[1,0]
  v_pk_mul_f32 v[90:91], v[90:91], s[34:35] op_sel_hi:[1,0]
  v_cvt_pk_bf16_f32 v168, v72, v73
  v_cvt_pk_bf16_f32 v169, v74, v75
  v_cvt_pk_bf16_f32 v170, v88, v89
  v_cvt_pk_bf16_f32 v171, v90, v91
  v_permlane16_swap_b32 v152, v154
  v_permlane16_swap_b32 v153, v155
  v_pk_mul_f32 v[76:77], v[76:77], s[34:35] op_sel_hi:[1,0]
  v_pk_mul_f32 v[78:79], v[78:79], s[34:35] op_sel_hi:[1,0]
  v_pk_mul_f32 v[92:93], v[92:93], s[34:35] op_sel_hi:[1,0]
  v_pk_mul_f32 v[94:95], v[94:95], s[34:35] op_sel_hi:[1,0]
  v_cvt_pk_bf16_f32 v184, v76, v77
  v_cvt_pk_bf16_f32 v185, v78, v79
  v_cvt_pk_bf16_f32 v186, v92, v93
  v_cvt_pk_bf16_f32 v187, v94, v95
  v_permlane16_swap_b32 v168, v170
  v_permlane16_swap_b32 v169, v171
  v_pk_mul_f32 v[96:97], v[96:97], s[34:35] op_sel_hi:[1,0]
  v_pk_mul_f32 v[98:99], v[98:99], s[34:35] op_sel_hi:[1,0]
  v_pk_mul_f32 v[112:113], v[112:113], s[34:35] op_sel_hi:[1,0]
  v_pk_mul_f32 v[114:115], v[114:115], s[34:35] op_sel_hi:[1,0]
  v_cvt_pk_bf16_f32 v140, v96, v97
  v_cvt_pk_bf16_f32 v141, v98, v99
  v_cvt_pk_bf16_f32 v142, v112, v113
  v_cvt_pk_bf16_f32 v143, v114, v115
  v_permlane16_swap_b32 v184, v186
  v_permlane16_swap_b32 v185, v187
  v_pk_mul_f32 v[100:101], v[100:101], s[34:35] op_sel_hi:[1,0]
  v_pk_mul_f32 v[102:103], v[102:103], s[34:35] op_sel_hi:[1,0]
  v_pk_mul_f32 v[116:117], v[116:117], s[34:35] op_sel_hi:[1,0]
  v_pk_mul_f32 v[118:119], v[118:119], s[34:35] op_sel_hi:[1,0]
  v_cvt_pk_bf16_f32 v156, v100, v101
  v_cvt_pk_bf16_f32 v157, v102, v103
  v_cvt_pk_bf16_f32 v158, v116, v117
  v_cvt_pk_bf16_f32 v159, v118, v119
  v_permlane16_swap_b32 v140, v142
  v_permlane16_swap_b32 v141, v143
  v_pk_mul_f32 v[104:105], v[104:105], s[34:35] op_sel_hi:[1,0]
  v_pk_mul_f32 v[106:107], v[106:107], s[34:35] op_sel_hi:[1,0]
  v_pk_mul_f32 v[120:121], v[120:121], s[34:35] op_sel_hi:[1,0]
  v_pk_mul_f32 v[122:123], v[122:123], s[34:35] op_sel_hi:[1,0]
  v_cvt_pk_bf16_f32 v172, v104, v105
  v_cvt_pk_bf16_f32 v173, v106, v107
  v_cvt_pk_bf16_f32 v174, v120, v121
  v_cvt_pk_bf16_f32 v175, v122, v123
  v_permlane16_swap_b32 v156, v158
  v_permlane16_swap_b32 v157, v159
  v_pk_mul_f32 v[108:109], v[108:109], s[34:35] op_sel_hi:[1,0]
  v_pk_mul_f32 v[110:111], v[110:111], s[34:35] op_sel_hi:[1,0]
  v_pk_mul_f32 v[124:125], v[124:125], s[34:35] op_sel_hi:[1,0]
  v_pk_mul_f32 v[126:127], v[126:127], s[34:35] op_sel_hi:[1,0]
  v_cvt_pk_bf16_f32 v188, v108, v109
  v_cvt_pk_bf16_f32 v189, v110, v111
  v_cvt_pk_bf16_f32 v190, v124, v125
  v_cvt_pk_bf16_f32 v191, v126, v127
  v_permlane16_swap_b32 v172, v174
  v_permlane16_swap_b32 v173, v175
  v_permlane16_swap_b32 v188, v190
  v_permlane16_swap_b32 v189, v191
  v_mfma_f32_16x16x32_bf16 v[0:3], a[128:131], v[128:131], 0
  s_add_u32 m0, s28, 81920
  ds_read_b128 a[144:147], v212 offset:4096
  s_mov_b32 s20, s90
  s_mov_b32 s21, s91
  v_mfma_f32_16x16x32_bf16 v[0:3], a[132:135], v[132:135], v[0:3]
  buffer_load_dwordx4 v236, s[16:19], s29 offen offset:0 lds
  s_mov_b32 s22, 2211840
  s_mov_b32 s23, 0x20000
  s_mov_b32 s44, s92
  v_mfma_f32_16x16x32_bf16 v[0:3], a[136:139], v[136:139], v[0:3]
  ds_read_b128 a[148:151], v213 offset:4096
  s_mov_b32 s45, s93
  s_mov_b32 s46, 2211840
  s_mov_b32 s47, 0x20000
  v_lshrrev_b32 v253, 4, v242
  v_mfma_f32_16x16x32_bf16 v[0:3], a[140:143], v[140:143], v[0:3]
  buffer_load_dwordx4 v237, s[16:19], s29 offen offset:1024 lds
  v_mfma_f32_16x16x32_bf16 v[8:11], a[140:143], v[156:159], 0
  ds_read_b128 a[152:155], v214 offset:4096
  v_mul_u32_u24 v253, 0xd80, v253
  v_mfma_f32_16x16x32_bf16 v[8:11], a[136:139], v[152:155], v[8:11]
  buffer_load_dwordx4 v236, s[16:19], s29 offen offset:2048 lds
  s_mul_i32 s35, s3, 552960
  s_lshl_b32 s38, s33, 4
  s_add_u32 s35, s35, s38
  v_mfma_f32_16x16x32_bf16 v[8:11], a[132:135], v[148:151], v[8:11]
  ds_read_b128 a[156:159], v215 offset:4096
  v_mfma_f32_16x16x32_bf16 v[8:11], a[128:131], v[144:147], v[8:11]
  buffer_load_dwordx4 v237, s[16:19], s29 offen offset:3072 lds
  v_mfma_f32_16x16x32_bf16 v[16:19], a[128:131], v[160:163], 0
  s_add_u32 s29, s29, 16384
  s_add_u32 m0, s28, 32768
  v_mfma_f32_16x16x32_bf16 v[16:19], a[132:135], v[164:167], v[16:19]
  buffer_load_dwordx4 v232, s[12:15], s29 offen offset:0 lds
  v_mfma_f32_16x16x32_bf16 v[16:19], a[136:139], v[168:171], v[16:19]
  buffer_load_dwordx4 v233, s[12:15], s29 offen offset:1024 lds
  v_mfma_f32_16x16x32_bf16 v[16:19], a[140:143], v[172:175], v[16:19]
  v_max3_f32 v192, v0, v1, v2
  v_max3_f32 v196, v8, v9, v10
  v_mfma_f32_16x16x32_bf16 v[24:27], a[140:143], v[188:191], 0
  v_max_f32 v192, v192, v3
  v_max_f32 v196, v196, v11
  v_mfma_f32_16x16x32_bf16 v[24:27], a[136:139], v[184:187], v[24:27]
  v_mov_b32 v245, v192
  v_mov_b32 v246, v196
  v_mfma_f32_16x16x32_bf16 v[24:27], a[132:135], v[180:183], v[24:27]
  v_permlane16_swap_b32 v192, v245
  v_permlane16_swap_b32 v196, v246
  v_mfma_f32_16x16x32_bf16 v[24:27], a[128:131], v[176:179], v[24:27]
  s_waitcnt lgkmcnt(0)
  v_max_f32 v192, v192, v245
  v_max_f32 v196, v196, v246
  v_mfma_f32_16x16x32_bf16 v[4:7], a[144:147], v[128:131], 0
  ds_read_b128 a[128:131], v212 offset:8192
  v_mov_b32 v245, v192
  v_mfma_f32_16x16x32_bf16 v[4:7], a[148:151], v[132:135], v[4:7]
  v_mov_b32 v246, v196
  v_permlane32_swap_b32 v192, v245
  v_mfma_f32_16x16x32_bf16 v[4:7], a[152:155], v[136:139], v[4:7]
  ds_read_b128 a[132:135], v213 offset:8192
  v_permlane32_swap_b32 v196, v246
  v_mfma_f32_16x16x32_bf16 v[4:7], a[156:159], v[140:143], v[4:7]
  v_max_f32 v192, v192, v245
  v_max_f32 v196, v196, v246
  v_mfma_f32_16x16x32_bf16 v[12:15], a[156:159], v[156:159], 0
  ds_read_b128 a[136:139], v214 offset:8192
  v_sub_f32 v193, 0, v192
  v_mfma_f32_16x16x32_bf16 v[12:15], a[152:155], v[152:155], v[12:15]
  v_sub_f32 v197, 0, v196
  v_sub_f32 v194, 0, v192
  v_mfma_f32_16x16x32_bf16 v[12:15], a[148:151], v[148:151], v[12:15]
  ds_read_b128 a[140:143], v215 offset:8192
  v_sub_f32 v198, 0, v196
  v_mfma_f32_16x16x32_bf16 v[12:15], a[144:147], v[144:147], v[12:15]
  v_sub_f32 v195, 0, v192
  v_sub_f32 v199, 0, v196
  v_mfma_f32_16x16x32_bf16 v[20:23], a[144:147], v[160:163], 0
  buffer_load_dwordx4 v234, s[12:15], s29 offen offset:2048 lds
  v_mfma_f32_16x16x32_bf16 v[20:23], a[148:151], v[164:167], v[20:23]
  v_sub_f32 v192, 0, v192
  v_sub_f32 v196, 0, v196
  v_mfma_f32_16x16x32_bf16 v[20:23], a[152:155], v[168:171], v[20:23]
  buffer_load_dwordx4 v235, s[12:15], s29 offen offset:3072 lds
  v_mfma_f32_16x16x32_bf16 v[20:23], a[156:159], v[172:175], v[20:23]
  v_max3_f32 v200, v16, v17, v18
  v_max3_f32 v204, v24, v25, v26
  v_mfma_f32_16x16x32_bf16 v[28:31], a[156:159], v[188:191], 0
  v_max_f32 v200, v200, v19
  v_max_f32 v204, v204, v27
  v_mfma_f32_16x16x32_bf16 v[28:31], a[152:155], v[184:187], v[28:31]
  v_mov_b32 v247, v200
  v_mov_b32 v248, v204
  v_mfma_f32_16x16x32_bf16 v[28:31], a[148:151], v[180:183], v[28:31]
  v_permlane16_swap_b32 v200, v247
  v_permlane16_swap_b32 v204, v248
  v_max_f32 v200, v200, v247
  v_max_f32 v204, v204, v248
  v_mov_b32 v247, v200
  v_mov_b32 v248, v204
  s_nop 0
  v_permlane32_swap_b32 v200, v247
  v_permlane32_swap_b32 v204, v248
  v_max_f32 v200, v200, v247
  v_max_f32 v204, v204, v248
  v_sub_f32 v201, 0, v200
  v_sub_f32 v205, 0, v204
  v_sub_f32 v202, 0, v200
  v_sub_f32 v206, 0, v204
  v_sub_f32 v203, 0, v200
  v_sub_f32 v207, 0, v204
  v_sub_f32 v200, 0, v200
  v_sub_f32 v204, 0, v204
  v_mfma_f32_16x16x32_bf16 v[28:31], a[144:147], v[176:179], v[28:31]
  s_waitcnt lgkmcnt(0)
  v_add_f32 v0, v192, v0
  v_add_f32 v1, v192, v1
  v_mfma_f32_16x16x32_bf16 v[32:35], a[128:131], v[128:131], v[192:195]
  ds_read_b128 a[144:147], v212 offset:12288
  v_add_f32 v2, v192, v2
  v_mfma_f32_16x16x32_bf16 v[32:35], a[132:135], v[132:135], v[32:35]
  v_add_f32 v3, v192, v3
  v_mfma_f32_16x16x32_bf16 v[32:35], a[136:139], v[136:139], v[32:35]
  ds_read_b128 a[148:151], v213 offset:12288
  v_mfma_f32_16x16x32_bf16 v[32:35], a[140:143], v[140:143], v[32:35]
  v_exp_f32 v0, v0
  v_mfma_f32_16x16x32_bf16 v[40:43], a[140:143], v[156:159], v[196:199]
  ds_read_b128 a[152:155], v214 offset:12288
  v_mfma_f32_16x16x32_bf16 v[40:43], a[136:139], v[152:155], v[40:43]
  v_exp_f32 v1, v1
  v_mfma_f32_16x16x32_bf16 v[40:43], a[132:135], v[148:151], v[40:43]
  ds_read_b128 a[156:159], v215 offset:12288
  v_mfma_f32_16x16x32_bf16 v[40:43], a[128:131], v[144:147], v[40:43]
  v_exp_f32 v2, v2
  v_mfma_f32_16x16x32_bf16 v[48:51], a[128:131], v[160:163], v[200:203]
  s_add_u32 m0, s50, 0
  v_cvt_pk_bf16_f32 v0, v0, v1
  v_mfma_f32_16x16x32_bf16 v[48:51], a[132:135], v[164:167], v[48:51]
  v_exp_f32 v3, v3
  v_mfma_f32_16x16x32_bf16 v[48:51], a[136:139], v[168:171], v[48:51]
  v_add_f32 v8, v196, v8
  v_add_f32 v9, v196, v9
  v_mfma_f32_16x16x32_bf16 v[48:51], a[140:143], v[172:175], v[48:51]
  v_add_f32 v10, v196, v10
  v_add_f32 v11, v196, v11
  v_mfma_f32_16x16x32_bf16 v[56:59], a[140:143], v[188:191], v[204:207]
  v_exp_f32 v8, v8
  v_mfma_f32_16x16x32_bf16 v[56:59], a[136:139], v[184:187], v[56:59]
  v_exp_f32 v9, v9
  buffer_load_dwordx4 v253, s[20:23], s35 offen lds
  v_mfma_f32_16x16x32_bf16 v[56:59], a[132:135], v[180:183], v[56:59]
  v_exp_f32 v10, v10
  v_mfma_f32_16x16x32_bf16 v[56:59], a[128:131], v[176:179], v[56:59]
  s_waitcnt lgkmcnt(0)
  v_cvt_pk_bf16_f32 v8, v8, v9
  v_mfma_f32_16x16x32_bf16 v[36:39], a[144:147], v[128:131], v[192:195]
  s_waitcnt vmcnt(9)
  v_exp_f32 v11, v11
  v_mfma_f32_16x16x32_bf16 v[36:39], a[148:151], v[132:135], v[36:39]
  s_barrier
  v_cvt_pk_bf16_f32 v1, v2, v3
  v_add_f32 v16, v200, v16
  v_mfma_f32_16x16x32_bf16 v[36:39], a[152:155], v[136:139], v[36:39]
  ds_read_b128 a[128:131], v212 offset:16384
  v_add_f32 v17, v200, v17
  v_mfma_f32_16x16x32_bf16 v[36:39], a[156:159], v[140:143], v[36:39]
  v_add_f32 v18, v200, v18
  v_add_f32 v19, v200, v19
  v_mfma_f32_16x16x32_bf16 v[44:47], a[156:159], v[156:159], v[196:199]
  ds_read_b128 a[132:135], v213 offset:16384
  v_mfma_f32_16x16x32_bf16 v[44:47], a[152:155], v[152:155], v[44:47]
  v_exp_f32 v16, v16
  v_mfma_f32_16x16x32_bf16 v[44:47], a[148:151], v[148:151], v[44:47]
  ds_read_b128 a[136:139], v214 offset:16384
  v_mfma_f32_16x16x32_bf16 v[44:47], a[144:147], v[144:147], v[44:47]
  v_exp_f32 v17, v17
  v_mfma_f32_16x16x32_bf16 v[52:55], a[144:147], v[160:163], v[200:203]
  ds_read_b128 a[140:143], v215 offset:16384
  v_mfma_f32_16x16x32_bf16 v[52:55], a[148:151], v[164:167], v[52:55]
  v_exp_f32 v18, v18
  v_mfma_f32_16x16x32_bf16 v[52:55], a[152:155], v[168:171], v[52:55]
  v_cvt_pk_bf16_f32 v16, v16, v17
  v_mfma_f32_16x16x32_bf16 v[52:55], a[156:159], v[172:175], v[52:55]
  v_exp_f32 v19, v19
  v_mfma_f32_16x16x32_bf16 v[60:63], a[156:159], v[188:191], v[204:207]
  v_cvt_pk_bf16_f32 v9, v10, v11
  v_add_f32 v24, v204, v24
  v_mfma_f32_16x16x32_bf16 v[60:63], a[152:155], v[184:187], v[60:63]
  v_add_f32 v25, v204, v25
  v_add_f32 v26, v204, v26
  v_mfma_f32_16x16x32_bf16 v[60:63], a[148:151], v[180:183], v[60:63]
  v_add_f32 v27, v204, v27
  v_mfma_f32_16x16x32_bf16 v[60:63], a[144:147], v[176:179], v[60:63]
  s_waitcnt lgkmcnt(0)
  v_exp_f32 v24, v24
  v_exp_f32 v25, v25
  v_exp_f32 v26, v26
  v_cvt_pk_bf16_f32 v24, v24, v25
  v_exp_f32 v27, v27
  v_cvt_pk_bf16_f32 v17, v18, v19
  v_add_f32 v4, v192, v4
  v_add_f32 v5, v192, v5
  v_add_f32 v6, v192, v6
  v_add_f32 v7, v192, v7
  v_exp_f32 v4, v4
  v_exp_f32 v5, v5
  v_exp_f32 v6, v6
  v_cvt_pk_bf16_f32 v2, v4, v5
  v_exp_f32 v7, v7
  v_cvt_pk_bf16_f32 v25, v26, v27
  v_add_f32 v12, v196, v12
  v_add_f32 v13, v196, v13
  v_add_f32 v14, v196, v14
  v_add_f32 v15, v196, v15
  v_exp_f32 v12, v12
  v_exp_f32 v13, v13
  v_exp_f32 v14, v14
  v_cvt_pk_bf16_f32 v10, v12, v13
  v_exp_f32 v15, v15
  v_cvt_pk_bf16_f32 v3, v6, v7
  v_add_f32 v20, v200, v20
  v_add_f32 v21, v200, v21
  v_add_f32 v22, v200, v22
  v_add_f32 v23, v200, v23
  v_exp_f32 v20, v20
  v_exp_f32 v21, v21
  v_exp_f32 v22, v22
  v_cvt_pk_bf16_f32 v18, v20, v21
  v_exp_f32 v23, v23
  v_cvt_pk_bf16_f32 v11, v14, v15
  v_add_f32 v28, v204, v28
  v_add_f32 v29, v204, v29
  v_add_f32 v30, v204, v30
  v_add_f32 v31, v204, v31
  v_exp_f32 v28, v28
  v_exp_f32 v29, v29
  v_exp_f32 v30, v30
  v_cvt_pk_bf16_f32 v26, v28, v29
  v_exp_f32 v31, v31
  v_cvt_pk_bf16_f32 v19, v22, v23
  v_exp_f32 v32, v32
  v_exp_f32 v33, v33
  v_exp_f32 v34, v34
  v_cvt_pk_bf16_f32 v32, v32, v33
  v_exp_f32 v35, v35
  v_cvt_pk_bf16_f32 v27, v30, v31
  v_exp_f32 v40, v40
  v_exp_f32 v41, v41
  v_exp_f32 v42, v42
  v_cvt_pk_bf16_f32 v40, v40, v41
  v_exp_f32 v43, v43
  v_cvt_pk_bf16_f32 v33, v34, v35
  v_exp_f32 v48, v48
  v_exp_f32 v49, v49
  v_exp_f32 v50, v50
  v_cvt_pk_bf16_f32 v48, v48, v49
  v_exp_f32 v51, v51
  v_cvt_pk_bf16_f32 v41, v42, v43
  v_exp_f32 v56, v56
  v_exp_f32 v57, v57
  v_exp_f32 v58, v58
  v_cvt_pk_bf16_f32 v56, v56, v57
  v_exp_f32 v59, v59
  v_cvt_pk_bf16_f32 v49, v50, v51
  v_exp_f32 v36, v36
  v_exp_f32 v37, v37
  v_exp_f32 v38, v38
  v_cvt_pk_bf16_f32 v34, v36, v37
  v_exp_f32 v39, v39
  v_cvt_pk_bf16_f32 v57, v58, v59
  v_exp_f32 v44, v44
  v_exp_f32 v45, v45
  v_exp_f32 v46, v46
  v_cvt_pk_bf16_f32 v42, v44, v45
  v_exp_f32 v47, v47
  v_cvt_pk_bf16_f32 v35, v38, v39
  v_exp_f32 v52, v52
  v_exp_f32 v53, v53
  v_exp_f32 v54, v54
  v_cvt_pk_bf16_f32 v50, v52, v53
  v_exp_f32 v55, v55
  v_cvt_pk_bf16_f32 v43, v46, v47
  v_exp_f32 v60, v60
  v_exp_f32 v61, v61
  v_exp_f32 v62, v62
  v_cvt_pk_bf16_f32 v58, v60, v61
  v_exp_f32 v63, v63
  v_cvt_pk_bf16_f32 v51, v54, v55
  v_cvt_pk_bf16_f32 v59, v62, v63
  v_lshrrev_b32 v247, 2, v242
  v_add_u32 v247, 131072, v247
  v_and_b32 v246, 0xfffffff0, v247
  v_lshl_add_u32 v246, s3, 2, v246
  v_mov_b32 v245, 0
  v_mfma_f32_16x16x32_bf16 v[64:67], a[128:131], v[128:131], v[192:195]
  s_add_u32 m0, s28, 98304
  v_mfma_f32_16x16x32_bf16 v[64:67], a[132:135], v[132:135], v[64:67]
  ds_read_b128 a[144:147], v212 offset:20480
  v_mfma_f32_16x16x32_bf16 v[64:67], a[136:139], v[136:139], v[64:67]
  buffer_load_dwordx4 v236, s[16:19], s29 offen offset:0 lds
  v_mfma_f32_16x16x32_bf16 v[64:67], a[140:143], v[140:143], v[64:67]
  ds_read_b128 a[148:151], v213 offset:20480
  v_mfma_f32_16x16x32_bf16 v[72:75], a[140:143], v[156:159], v[196:199]
  v_mfma_f32_16x16x32_bf16 v[72:75], a[136:139], v[152:155], v[72:75]
  ds_read_b128 a[152:155], v214 offset:20480
  v_mfma_f32_16x16x32_bf16 v[72:75], a[132:135], v[148:151], v[72:75]
  buffer_load_dwordx4 v237, s[16:19], s29 offen offset:1024 lds
  v_mfma_f32_16x16x32_bf16 v[72:75], a[128:131], v[144:147], v[72:75]
  ds_read_b128 a[156:159], v215 offset:20480
  v_mfma_f32_16x16x32_bf16 v[80:83], a[128:131], v[160:163], v[200:203]
  v_exp_f32 v64, v64
  v_mfma_f32_16x16x32_bf16 v[80:83], a[132:135], v[164:167], v[80:83]
  v_mfma_f32_16x16x32_bf16 v[80:83], a[136:139], v[168:171], v[80:83]
  v_exp_f32 v65, v65
  v_mfma_f32_16x16x32_bf16 v[80:83], a[140:143], v[172:175], v[80:83]
  v_cvt_pk_bf16_f32 v64, v64, v65
  v_mfma_f32_16x16x32_bf16 v[88:91], a[140:143], v[188:191], v[204:207]
  v_exp_f32 v66, v66
  v_mfma_f32_16x16x32_bf16 v[88:91], a[136:139], v[184:187], v[88:91]
  buffer_load_dwordx4 v236, s[16:19], s29 offen offset:2048 lds
  v_mfma_f32_16x16x32_bf16 v[88:91], a[132:135], v[180:183], v[88:91]
  s_waitcnt lgkmcnt(0)
  v_exp_f32 v67, v67
  v_mfma_f32_16x16x32_bf16 v[88:91], a[128:131], v[176:179], v[88:91]
  v_cvt_pk_bf16_f32 v65, v66, v67
  v_mfma_f32_16x16x32_bf16 v[68:71], a[144:147], v[128:131], v[192:195]
  v_exp_f32 v72, v72
  v_mfma_f32_16x16x32_bf16 v[68:71], a[148:151], v[132:135], v[68:71]
  ds_read_b128 a[128:131], v212 offset:24576
  v_mfma_f32_16x16x32_bf16 v[68:71], a[152:155], v[136:139], v[68:71]
  v_exp_f32 v73, v73
  v_mfma_f32_16x16x32_bf16 v[68:71], a[156:159], v[140:143], v[68:71]
  ds_read_b128 a[132:135], v213 offset:24576
  v_cvt_pk_bf16_f32 v72, v72, v73
  v_mfma_f32_16x16x32_bf16 v[76:79], a[156:159], v[156:159], v[196:199]
  v_exp_f32 v74, v74
  v_mfma_f32_16x16x32_bf16 v[76:79], a[152:155], v[152:155], v[76:79]
  ds_read_b128 a[136:139], v214 offset:24576
  v_mfma_f32_16x16x32_bf16 v[76:79], a[148:151], v[148:151], v[76:79]
  v_exp_f32 v75, v75
  v_mfma_f32_16x16x32_bf16 v[76:79], a[144:147], v[144:147], v[76:79]
  ds_read_b128 a[140:143], v215 offset:24576
  v_cvt_pk_bf16_f32 v73, v74, v75
  v_mfma_f32_16x16x32_bf16 v[84:87], a[144:147], v[160:163], v[200:203]
  v_exp_f32 v80, v80
  v_mfma_f32_16x16x32_bf16 v[84:87], a[148:151], v[164:167], v[84:87]
  buffer_load_dwordx4 v237, s[16:19], s29 offen offset:3072 lds
  v_mfma_f32_16x16x32_bf16 v[84:87], a[152:155], v[168:171], v[84:87]
  s_add_u32 s29, s29, 16384
  v_exp_f32 v81, v81
  v_mfma_f32_16x16x32_bf16 v[84:87], a[156:159], v[172:175], v[84:87]
  v_cvt_pk_bf16_f32 v80, v80, v81
  v_mfma_f32_16x16x32_bf16 v[92:95], a[156:159], v[188:191], v[204:207]
  s_add_u32 m0, s28, 49152
  v_exp_f32 v82, v82
  v_mfma_f32_16x16x32_bf16 v[92:95], a[152:155], v[184:187], v[92:95]
  buffer_load_dwordx4 v232, s[12:15], s29 offen offset:0 lds
  v_mfma_f32_16x16x32_bf16 v[92:95], a[148:151], v[180:183], v[92:95]
  s_waitcnt lgkmcnt(0)
  v_exp_f32 v83, v83
  v_mfma_f32_16x16x32_bf16 v[92:95], a[144:147], v[176:179], v[92:95]
  v_cvt_pk_bf16_f32 v81, v82, v83
  v_mfma_f32_16x16x32_bf16 v[96:99], a[128:131], v[128:131], v[192:195]
  v_exp_f32 v88, v88
  v_mfma_f32_16x16x32_bf16 v[96:99], a[132:135], v[132:135], v[96:99]
  ds_read_b128 a[144:147], v212 offset:28672
  v_mfma_f32_16x16x32_bf16 v[96:99], a[136:139], v[136:139], v[96:99]
  v_exp_f32 v89, v89
  v_mfma_f32_16x16x32_bf16 v[96:99], a[140:143], v[140:143], v[96:99]
  ds_read_b128 a[148:151], v213 offset:28672
  v_cvt_pk_bf16_f32 v88, v88, v89
  v_mfma_f32_16x16x32_bf16 v[104:107], a[140:143], v[156:159], v[196:199]
  v_exp_f32 v90, v90
  v_mfma_f32_16x16x32_bf16 v[104:107], a[136:139], v[152:155], v[104:107]
  ds_read_b128 a[152:155], v214 offset:28672
  v_mfma_f32_16x16x32_bf16 v[104:107], a[132:135], v[148:151], v[104:107]
  v_exp_f32 v91, v91
  v_mfma_f32_16x16x32_bf16 v[104:107], a[128:131], v[144:147], v[104:107]
  ds_read_b128 a[156:159], v215 offset:28672
  v_cvt_pk_bf16_f32 v89, v90, v91
  v_mfma_f32_16x16x32_bf16 v[112:115], a[128:131], v[160:163], v[200:203]
  v_exp_f32 v68, v68
  v_mfma_f32_16x16x32_bf16 v[112:115], a[132:135], v[164:167], v[112:115]
  buffer_load_dwordx4 v233, s[12:15], s29 offen offset:1024 lds
  v_mfma_f32_16x16x32_bf16 v[112:115], a[136:139], v[168:171], v[112:115]
  v_exp_f32 v69, v69
  v_mfma_f32_16x16x32_bf16 v[112:115], a[140:143], v[172:175], v[112:115]
  v_cvt_pk_bf16_f32 v66, v68, v69
  v_mfma_f32_16x16x32_bf16 v[120:123], a[140:143], v[188:191], v[204:207]
  v_exp_f32 v70, v70
  v_mfma_f32_16x16x32_bf16 v[120:123], a[136:139], v[184:187], v[120:123]
  buffer_load_dwordx4 v234, s[12:15], s29 offen offset:2048 lds
  v_mfma_f32_16x16x32_bf16 v[120:123], a[132:135], v[180:183], v[120:123]
  s_waitcnt lgkmcnt(0)
  v_exp_f32 v71, v71
  v_mfma_f32_16x16x32_bf16 v[120:123], a[128:131], v[176:179], v[120:123]
  v_cvt_pk_bf16_f32 v67, v70, v71
  v_mfma_f32_16x16x32_bf16 v[100:103], a[144:147], v[128:131], v[192:195]
  v_exp_f32 v76, v76
  v_mfma_f32_16x16x32_bf16 v[100:103], a[148:151], v[132:135], v[100:103]
  ds_read_b64_tr_b16 a[160:161], v216 offset:0
  v_mfma_f32_16x16x32_bf16 v[100:103], a[152:155], v[136:139], v[100:103]
  v_exp_f32 v77, v77
  v_mfma_f32_16x16x32_bf16 v[100:103], a[156:159], v[140:143], v[100:103]
  ds_read_b64_tr_b16 a[162:163], v216 offset:4096
  v_cvt_pk_bf16_f32 v74, v76, v77
  v_mfma_f32_16x16x32_bf16 v[108:111], a[156:159], v[156:159], v[196:199]
  v_exp_f32 v78, v78
  v_mfma_f32_16x16x32_bf16 v[108:111], a[152:155], v[152:155], v[108:111]
  ds_read_b64_tr_b16 a[164:165], v216 offset:8192
  buffer_load_dwordx4 v235, s[12:15], s29 offen offset:3072 lds
  v_mfma_f32_16x16x32_bf16 v[108:111], a[148:151], v[148:151], v[108:111]
  v_exp_f32 v79, v79
  v_mfma_f32_16x16x32_bf16 v[108:111], a[144:147], v[144:147], v[108:111]
  ds_read_b64_tr_b16 a[166:167], v216 offset:12288
  v_cvt_pk_bf16_f32 v75, v78, v79
  v_mfma_f32_16x16x32_bf16 v[116:119], a[144:147], v[160:163], v[200:203]
  v_exp_f32 v84, v84
  v_mfma_f32_16x16x32_bf16 v[116:119], a[148:151], v[164:167], v[116:119]
  ds_read_b64_tr_b16 a[168:169], v217 offset:0
  s_add_u32 m0, s50, 3072
  v_mfma_f32_16x16x32_bf16 v[116:119], a[152:155], v[168:171], v[116:119]
  v_exp_f32 v85, v85
  v_mfma_f32_16x16x32_bf16 v[116:119], a[156:159], v[172:175], v[116:119]
  ds_read_b64_tr_b16 a[170:171], v217 offset:4096
  v_cvt_pk_bf16_f32 v82, v84, v85
  v_mfma_f32_16x16x32_bf16 v[124:127], a[156:159], v[188:191], v[204:207]
  v_exp_f32 v86, v86
  v_mfma_f32_16x16x32_bf16 v[124:127], a[152:155], v[184:187], v[124:127]
  ds_read_b64_tr_b16 a[172:173], v217 offset:8192
  buffer_load_dwordx4 v253, s[44:47], s35 offen lds
  s_add_u32 s35, s35, 221184
  v_mfma_f32_16x16x32_bf16 v[124:127], a[148:151], v[180:183], v[124:127]
  v_exp_f32 v87, v87
  v_mfma_f32_16x16x32_bf16 v[124:127], a[144:147], v[176:179], v[124:127]
  ds_read_b64_tr_b16 a[174:175], v217 offset:12288
  v_cvt_pk_bf16_f32 v83, v86, v87
  v_mfma_f32_16x16x32_bf16 a[192:195], a[208:211], v[0:3], 0
  v_exp_f32 v92, v92
  v_mfma_f32_16x16x32_bf16 a[192:195], a[208:211], v[32:35], a[192:195]
  ds_read_b64_tr_b16 a[176:177], v218 offset:0
  v_add_u32 v245, 1, v245
  v_mfma_f32_16x16x32_bf16 a[196:199], a[208:211], v[8:11], 0
  v_exp_f32 v93, v93
  v_mfma_f32_16x16x32_bf16 a[196:199], a[208:211], v[40:43], a[196:199]
  ds_read_b64_tr_b16 a[178:179], v218 offset:4096
  v_cvt_pk_bf16_f32 v90, v92, v93
  v_mfma_f32_16x16x32_bf16 a[200:203], a[208:211], v[16:19], 0
  s_waitcnt vmcnt(10)
  v_exp_f32 v94, v94
  v_mfma_f32_16x16x32_bf16 a[200:203], a[208:211], v[48:51], a[200:203]
  ds_read_b64_tr_b16 a[180:181], v218 offset:8192
  ds_write_b32 v246, v245
  v_mfma_f32_16x16x32_bf16 a[204:207], a[208:211], v[24:27], 0
  s_waitcnt lgkmcnt(8)
  v_exp_f32 v95, v95
  v_mfma_f32_16x16x32_bf16 a[204:207], a[208:211], v[56:59], a[204:207]
  ds_read_b64_tr_b16 a[182:183], v218 offset:12288
  v_cvt_pk_bf16_f32 v91, v94, v95
  v_mfma_f32_16x16x32_bf16 a[0:3], a[160:163], v[0:3], 0
  v_exp_f32 v96, v96
  v_mfma_f32_16x16x32_bf16 a[0:3], a[164:167], v[32:35], a[0:3]
  ds_read_b64_tr_b16 a[184:185], v219 offset:0
  v_mfma_f32_16x16x32_bf16 a[4:7], a[164:167], v[40:43], 0
  v_exp_f32 v97, v97
  v_mfma_f32_16x16x32_bf16 a[4:7], a[160:163], v[8:11], a[4:7]
  ds_read_b64_tr_b16 a[186:187], v219 offset:4096
  v_cvt_pk_bf16_f32 v96, v96, v97
  v_mfma_f32_16x16x32_bf16 a[8:11], a[160:163], v[16:19], 0
  v_exp_f32 v98, v98
  v_mfma_f32_16x16x32_bf16 a[8:11], a[164:167], v[48:51], a[8:11]
  ds_read_b64_tr_b16 a[188:189], v219 offset:8192
  v_mfma_f32_16x16x32_bf16 a[12:15], a[164:167], v[56:59], 0
  s_waitcnt lgkmcnt(8)
  v_exp_f32 v99, v99
  v_mfma_f32_16x16x32_bf16 a[12:15], a[160:163], v[24:27], a[12:15]
  ds_read_b64_tr_b16 a[190:191], v219 offset:12288
  v_cvt_pk_bf16_f32 v97, v98, v99
  v_mfma_f32_16x16x32_bf16 a[16:19], a[168:171], v[0:3], 0
  v_exp_f32 v104, v104
  v_mfma_f32_16x16x32_bf16 a[16:19], a[172:175], v[32:35], a[16:19]
  ds_read_b64_tr_b16 a[160:161], v220 offset:0
  v_mfma_f32_16x16x32_bf16 a[20:23], a[172:175], v[40:43], 0
  v_exp_f32 v105, v105
  v_mfma_f32_16x16x32_bf16 a[20:23], a[168:171], v[8:11], a[20:23]
  ds_read_b64_tr_b16 a[162:163], v220 offset:4096
  v_cvt_pk_bf16_f32 v104, v104, v105
  v_mfma_f32_16x16x32_bf16 a[24:27], a[168:171], v[16:19], 0
  v_exp_f32 v106, v106
  v_mfma_f32_16x16x32_bf16 a[24:27], a[172:175], v[48:51], a[24:27]
  ds_read_b64_tr_b16 a[164:165], v220 offset:8192
  v_mfma_f32_16x16x32_bf16 a[28:31], a[172:175], v[56:59], 0
  s_waitcnt lgkmcnt(7)
  v_exp_f32 v107, v107
  v_mfma_f32_16x16x32_bf16 a[28:31], a[168:171], v[24:27], a[28:31]
  ds_read_b64_tr_b16 a[166:167], v220 offset:12288
  v_cvt_pk_bf16_f32 v105, v106, v107
  v_mfma_f32_16x16x32_bf16 a[32:35], a[176:179], v[0:3], 0
  v_exp_f32 v112, v112
  v_mfma_f32_16x16x32_bf16 a[32:35], a[180:183], v[32:35], a[32:35]
  ds_read_b64_tr_b16 a[168:169], v221 offset:0
  v_mfma_f32_16x16x32_bf16 a[36:39], a[180:183], v[40:43], 0
  v_exp_f32 v113, v113
  v_mfma_f32_16x16x32_bf16 a[36:39], a[176:179], v[8:11], a[36:39]
  ds_read_b64_tr_b16 a[170:171], v221 offset:4096
  v_cvt_pk_bf16_f32 v112, v112, v113
  v_mfma_f32_16x16x32_bf16 a[40:43], a[176:179], v[16:19], 0
  v_exp_f32 v114, v114
  v_mfma_f32_16x16x32_bf16 a[40:43], a[180:183], v[48:51], a[40:43]
  ds_read_b64_tr_b16 a[172:173], v221 offset:8192
  v_mfma_f32_16x16x32_bf16 a[44:47], a[180:183], v[56:59], 0
  s_waitcnt lgkmcnt(7)
  v_exp_f32 v115, v115
  v_mfma_f32_16x16x32_bf16 a[44:47], a[176:179], v[24:27], a[44:47]
  ds_read_b64_tr_b16 a[174:175], v221 offset:12288
  v_cvt_pk_bf16_f32 v113, v114, v115
  v_mfma_f32_16x16x32_bf16 a[48:51], a[184:187], v[0:3], 0
  v_exp_f32 v120, v120
  v_mfma_f32_16x16x32_bf16 a[48:51], a[188:191], v[32:35], a[48:51]
  ds_read_b64_tr_b16 a[176:177], v222 offset:0
  v_mfma_f32_16x16x32_bf16 a[52:55], a[188:191], v[40:43], 0
  v_exp_f32 v121, v121
  v_mfma_f32_16x16x32_bf16 a[52:55], a[184:187], v[8:11], a[52:55]
  ds_read_b64_tr_b16 a[178:179], v222 offset:4096
  v_cvt_pk_bf16_f32 v120, v120, v121
  v_mfma_f32_16x16x32_bf16 a[56:59], a[184:187], v[16:19], 0
  v_exp_f32 v122, v122
  v_mfma_f32_16x16x32_bf16 a[56:59], a[188:191], v[48:51], a[56:59]
  ds_read_b64_tr_b16 a[180:181], v222 offset:8192
  v_mfma_f32_16x16x32_bf16 a[60:63], a[188:191], v[56:59], 0
  s_waitcnt lgkmcnt(7)
  v_exp_f32 v123, v123
  v_mfma_f32_16x16x32_bf16 a[60:63], a[184:187], v[24:27], a[60:63]
  ds_read_b64_tr_b16 a[182:183], v222 offset:12288
  v_cvt_pk_bf16_f32 v121, v122, v123
  v_mfma_f32_16x16x32_bf16 a[64:67], a[160:163], v[0:3], 0
  v_exp_f32 v100, v100
  v_mfma_f32_16x16x32_bf16 a[64:67], a[164:167], v[32:35], a[64:67]
  ds_read_b64_tr_b16 a[184:185], v223 offset:0
  ds_read_b32 v248, v247
  v_mfma_f32_16x16x32_bf16 a[68:71], a[164:167], v[40:43], 0
  v_exp_f32 v101, v101
  v_mfma_f32_16x16x32_bf16 a[68:71], a[160:163], v[8:11], a[68:71]
  ds_read_b64_tr_b16 a[186:187], v223 offset:4096
  v_cvt_pk_bf16_f32 v98, v100, v101
  v_mfma_f32_16x16x32_bf16 a[72:75], a[160:163], v[16:19], 0
  v_exp_f32 v102, v102
  v_mfma_f32_16x16x32_bf16 a[72:75], a[164:167], v[48:51], a[72:75]
  ds_read_b64_tr_b16 a[188:189], v223 offset:8192
  v_mfma_f32_16x16x32_bf16 a[76:79], a[164:167], v[56:59], 0
  s_waitcnt lgkmcnt(8)
  v_exp_f32 v103, v103
  v_mfma_f32_16x16x32_bf16 a[76:79], a[160:163], v[24:27], a[76:79]
  ds_read_b64_tr_b16 a[190:191], v223 offset:12288
  v_cvt_pk_bf16_f32 v99, v102, v103
  v_mfma_f32_16x16x32_bf16 a[80:83], a[168:171], v[0:3], 0
  s_waitcnt lgkmcnt(3)
  v_exp_f32 v108, v108
  v_mfma_f32_16x16x32_bf16 a[80:83], a[172:175], v[32:35], a[80:83]
  v_cmp_lt_u32 vcc, v248, v245
  v_mfma_f32_16x16x32_bf16 a[84:87], a[172:175], v[40:43], 0
  s_cbranch_vccnz attn_wait0
attn_on0:
  v_exp_f32 v109, v109
  v_mfma_f32_16x16x32_bf16 a[84:87], a[168:171], v[8:11], a[84:87]
  ds_read_b128 a[128:131], v212 offset:32768
  v_cvt_pk_bf16_f32 v106, v108, v109
  v_mfma_f32_16x16x32_bf16 a[88:91], a[168:171], v[16:19], 0
  v_exp_f32 v110, v110
  v_mfma_f32_16x16x32_bf16 a[88:91], a[172:175], v[48:51], a[88:91]
  ds_read_b128 a[132:135], v213 offset:32768
  v_mfma_f32_16x16x32_bf16 a[92:95], a[172:175], v[56:59], 0
  v_exp_f32 v111, v111
  v_mfma_f32_16x16x32_bf16 a[92:95], a[168:171], v[24:27], a[92:95]
  ds_read_b128 a[136:139], v214 offset:32768
  v_cvt_pk_bf16_f32 v107, v110, v111
  v_mfma_f32_16x16x32_bf16 a[96:99], a[176:179], v[0:3], 0
  s_mul_i32 s38, s3, 20480
  v_exp_f32 v116, v116
  v_mfma_f32_16x16x32_bf16 a[96:99], a[180:183], v[32:35], a[96:99]
  ds_read_b128 a[140:143], v215 offset:32768
  buffer_load_dwordx4 a[212:215], v243, s[24:27], s38 offen sc1
  s_add_u32 s38, s38, 4096
  v_mfma_f32_16x16x32_bf16 a[100:103], a[180:183], v[40:43], 0
  v_exp_f32 v117, v117
  v_mfma_f32_16x16x32_bf16 a[100:103], a[176:179], v[8:11], a[100:103]
  v_cvt_pk_bf16_f32 v114, v116, v117
  v_mfma_f32_16x16x32_bf16 a[104:107], a[176:179], v[16:19], 0
  v_exp_f32 v118, v118
  v_mfma_f32_16x16x32_bf16 a[104:107], a[180:183], v[48:51], a[104:107]
  v_mfma_f32_16x16x32_bf16 a[108:111], a[180:183], v[56:59], 0
  s_waitcnt lgkmcnt(4)
  v_exp_f32 v119, v119
  v_mfma_f32_16x16x32_bf16 a[108:111], a[176:179], v[24:27], a[108:111]
  v_cvt_pk_bf16_f32 v115, v118, v119
  v_mfma_f32_16x16x32_bf16 a[112:115], a[184:187], v[0:3], 0
  v_exp_f32 v124, v124
  v_mfma_f32_16x16x32_bf16 a[112:115], a[188:191], v[32:35], a[112:115]
  v_mfma_f32_16x16x32_bf16 a[116:119], a[188:191], v[40:43], 0
  v_exp_f32 v125, v125
  v_mfma_f32_16x16x32_bf16 a[116:119], a[184:187], v[8:11], a[116:119]
  v_cvt_pk_bf16_f32 v122, v124, v125
  v_mfma_f32_16x16x32_bf16 a[120:123], a[184:187], v[16:19], 0
  v_exp_f32 v126, v126
  v_mfma_f32_16x16x32_bf16 a[120:123], a[188:191], v[48:51], a[120:123]
  v_mfma_f32_16x16x32_bf16 a[124:127], a[188:191], v[56:59], 0
  s_waitcnt lgkmcnt(0)
  v_exp_f32 v127, v127
  v_mfma_f32_16x16x32_bf16 a[124:127], a[184:187], v[24:27], a[124:127]
  v_cvt_pk_bf16_f32 v123, v126, v127
  v_mfma_f32_16x16x32_bf16 v[0:3], a[128:131], v[128:131], v[192:195]
  s_add_u32 m0, s28, 114688
  v_mfma_f32_16x16x32_bf16 v[0:3], a[132:135], v[132:135], v[0:3]
  ds_read_b128 a[144:147], v212 offset:36864
  v_mfma_f32_16x16x32_bf16 v[0:3], a[136:139], v[136:139], v[0:3]
  buffer_load_dwordx4 v236, s[16:19], s29 offen offset:0 lds
  v_mfma_f32_16x16x32_bf16 v[0:3], a[140:143], v[140:143], v[0:3]
  ds_read_b128 a[148:151], v213 offset:36864
  v_mfma_f32_16x16x32_bf16 v[8:11], a[140:143], v[156:159], v[196:199]
  v_mfma_f32_16x16x32_bf16 v[8:11], a[136:139], v[152:155], v[8:11]
  ds_read_b128 a[152:155], v214 offset:36864
  v_mfma_f32_16x16x32_bf16 v[8:11], a[132:135], v[148:151], v[8:11]
  buffer_load_dwordx4 v237, s[16:19], s29 offen offset:1024 lds
  v_mfma_f32_16x16x32_bf16 v[8:11], a[128:131], v[144:147], v[8:11]
  ds_read_b128 a[156:159], v215 offset:36864
  v_mfma_f32_16x16x32_bf16 v[16:19], a[128:131], v[160:163], v[200:203]
  v_exp_f32 v0, v0
  v_mfma_f32_16x16x32_bf16 v[16:19], a[132:135], v[164:167], v[16:19]
  v_mfma_f32_16x16x32_bf16 v[16:19], a[136:139], v[168:171], v[16:19]
  v_exp_f32 v1, v1
  v_mfma_f32_16x16x32_bf16 v[16:19], a[140:143], v[172:175], v[16:19]
  v_cvt_pk_bf16_f32 v0, v0, v1
  v_mfma_f32_16x16x32_bf16 v[24:27], a[140:143], v[188:191], v[204:207]
  v_exp_f32 v2, v2
  v_mfma_f32_16x16x32_bf16 v[24:27], a[136:139], v[184:187], v[24:27]
  buffer_load_dwordx4 v236, s[16:19], s29 offen offset:2048 lds
  v_mfma_f32_16x16x32_bf16 v[24:27], a[132:135], v[180:183], v[24:27]
  s_waitcnt lgkmcnt(0)
  v_exp_f32 v3, v3
  v_mfma_f32_16x16x32_bf16 v[24:27], a[128:131], v[176:179], v[24:27]
  v_cvt_pk_bf16_f32 v1, v2, v3
  v_mfma_f32_16x16x32_bf16 v[4:7], a[144:147], v[128:131], v[192:195]
  v_exp_f32 v8, v8
  v_mfma_f32_16x16x32_bf16 v[4:7], a[148:151], v[132:135], v[4:7]
  ds_read_b128 a[128:131], v212 offset:40960
  v_mfma_f32_16x16x32_bf16 v[4:7], a[152:155], v[136:139], v[4:7]
  v_exp_f32 v9, v9
  v_mfma_f32_16x16x32_bf16 v[4:7], a[156:159], v[140:143], v[4:7]
  ds_read_b128 a[132:135], v213 offset:40960
  v_cvt_pk_bf16_f32 v8, v8, v9
  v_mfma_f32_16x16x32_bf16 v[12:15], a[156:159], v[156:159], v[196:199]
  v_exp_f32 v10, v10
  v_mfma_f32_16x16x32_bf16 v[12:15], a[152:155], v[152:155], v[12:15]
  ds_read_b128 a[136:139], v214 offset:40960
  v_mfma_f32_16x16x32_bf16 v[12:15], a[148:151], v[148:151], v[12:15]
  v_exp_f32 v11, v11
  v_mfma_f32_16x16x32_bf16 v[12:15], a[144:147], v[144:147], v[12:15]
  ds_read_b128 a[140:143], v215 offset:40960
  v_cvt_pk_bf16_f32 v9, v10, v11
  v_mfma_f32_16x16x32_bf16 v[20:23], a[144:147], v[160:163], v[200:203]
  v_exp_f32 v16, v16
  v_mfma_f32_16x16x32_bf16 v[20:23], a[148:151], v[164:167], v[20:23]
  buffer_load_dwordx4 v237, s[16:19], s29 offen offset:3072 lds
  v_mfma_f32_16x16x32_bf16 v[20:23], a[152:155], v[168:171], v[20:23]
  s_add_u32 s29, s29, 16384
  v_exp_f32 v17, v17
  v_mfma_f32_16x16x32_bf16 v[20:23], a[156:159], v[172:175], v[20:23]
  v_cvt_pk_bf16_f32 v16, v16, v17
  v_mfma_f32_16x16x32_bf16 v[28:31], a[156:159], v[188:191], v[204:207]
  s_add_u32 m0, s28, 0
  v_exp_f32 v18, v18
  v_mfma_f32_16x16x32_bf16 v[28:31], a[152:155], v[184:187], v[28:31]
  buffer_load_dwordx4 v232, s[12:15], s29 offen offset:0 lds
  v_mfma_f32_16x16x32_bf16 v[28:31], a[148:151], v[180:183], v[28:31]
  s_waitcnt lgkmcnt(0)
  v_exp_f32 v19, v19
  v_mfma_f32_16x16x32_bf16 v[28:31], a[144:147], v[176:179], v[28:31]
  v_cvt_pk_bf16_f32 v17, v18, v19
  v_mfma_f32_16x16x32_bf16 v[32:35], a[128:131], v[128:131], v[192:195]
  v_exp_f32 v24, v24
  v_mfma_f32_16x16x32_bf16 v[32:35], a[132:135], v[132:135], v[32:35]
  ds_read_b128 a[144:147], v212 offset:45056
  v_mfma_f32_16x16x32_bf16 v[32:35], a[136:139], v[136:139], v[32:35]
  v_exp_f32 v25, v25
  v_mfma_f32_16x16x32_bf16 v[32:35], a[140:143], v[140:143], v[32:35]
  ds_read_b128 a[148:151], v213 offset:45056
  v_cvt_pk_bf16_f32 v24, v24, v25
  v_mfma_f32_16x16x32_bf16 v[40:43], a[140:143], v[156:159], v[196:199]
  v_exp_f32 v26, v26
  v_mfma_f32_16x16x32_bf16 v[40:43], a[136:139], v[152:155], v[40:43]
  ds_read_b128 a[152:155], v214 offset:45056
  v_mfma_f32_16x16x32_bf16 v[40:43], a[132:135], v[148:151], v[40:43]
  v_exp_f32 v27, v27
  v_mfma_f32_16x16x32_bf16 v[40:43], a[128:131], v[144:147], v[40:43]
  ds_read_b128 a[156:159], v215 offset:45056
  v_cvt_pk_bf16_f32 v25, v26, v27
  v_mfma_f32_16x16x32_bf16 v[48:51], a[128:131], v[160:163], v[200:203]
  v_exp_f32 v4, v4
  v_mfma_f32_16x16x32_bf16 v[48:51], a[132:135], v[164:167], v[48:51]
  buffer_load_dwordx4 v233, s[12:15], s29 offen offset:1024 lds
  v_mfma_f32_16x16x32_bf16 v[48:51], a[136:139], v[168:171], v[48:51]
  v_exp_f32 v5, v5
  v_mfma_f32_16x16x32_bf16 v[48:51], a[140:143], v[172:175], v[48:51]
  v_cvt_pk_bf16_f32 v2, v4, v5
  v_mfma_f32_16x16x32_bf16 v[56:59], a[140:143], v[188:191], v[204:207]
  v_exp_f32 v6, v6
  v_mfma_f32_16x16x32_bf16 v[56:59], a[136:139], v[184:187], v[56:59]
  buffer_load_dwordx4 v234, s[12:15], s29 offen offset:2048 lds
  v_mfma_f32_16x16x32_bf16 v[56:59], a[132:135], v[180:183], v[56:59]
  s_waitcnt lgkmcnt(0)
  v_exp_f32 v7, v7
  v_mfma_f32_16x16x32_bf16 v[56:59], a[128:131], v[176:179], v[56:59]
  v_cvt_pk_bf16_f32 v3, v6, v7
  v_mfma_f32_16x16x32_bf16 v[36:39], a[144:147], v[128:131], v[192:195]
  v_exp_f32 v12, v12
  v_mfma_f32_16x16x32_bf16 v[36:39], a[148:151], v[132:135], v[36:39]
  ds_read_b64_tr_b16 a[160:161], v216 offset:16384
  v_mfma_f32_16x16x32_bf16 v[36:39], a[152:155], v[136:139], v[36:39]
  v_exp_f32 v13, v13
  v_mfma_f32_16x16x32_bf16 v[36:39], a[156:159], v[140:143], v[36:39]
  ds_read_b64_tr_b16 a[162:163], v216 offset:20480
  v_cvt_pk_bf16_f32 v10, v12, v13
  v_mfma_f32_16x16x32_bf16 v[44:47], a[156:159], v[156:159], v[196:199]
  v_exp_f32 v14, v14
  v_mfma_f32_16x16x32_bf16 v[44:47], a[152:155], v[152:155], v[44:47]
  ds_read_b64_tr_b16 a[164:165], v216 offset:24576
  buffer_load_dwordx4 v235, s[12:15], s29 offen offset:3072 lds
  v_mfma_f32_16x16x32_bf16 v[44:47], a[148:151], v[148:151], v[44:47]
  v_exp_f32 v15, v15
  v_mfma_f32_16x16x32_bf16 v[44:47], a[144:147], v[144:147], v[44:47]
  ds_read_b64_tr_b16 a[166:167], v216 offset:28672
  v_cvt_pk_bf16_f32 v11, v14, v15
  v_mfma_f32_16x16x32_bf16 v[52:55], a[144:147], v[160:163], v[200:203]
  v_exp_f32 v20, v20
  v_mfma_f32_16x16x32_bf16 v[52:55], a[148:151], v[164:167], v[52:55]
  ds_read_b64_tr_b16 a[168:169], v217 offset:16384
  s_add_u32 m0, s50, 1024
  v_mfma_f32_16x16x32_bf16 v[52:55], a[152:155], v[168:171], v[52:55]
  v_exp_f32 v21, v21
  v_mfma_f32_16x16x32_bf16 v[52:55], a[156:159], v[172:175], v[52:55]
  ds_read_b64_tr_b16 a[170:171], v217 offset:20480
  v_cvt_pk_bf16_f32 v18, v20, v21
  v_mfma_f32_16x16x32_bf16 v[60:63], a[156:159], v[188:191], v[204:207]
  v_exp_f32 v22, v22
  v_mfma_f32_16x16x32_bf16 v[60:63], a[152:155], v[184:187], v[60:63]
  ds_read_b64_tr_b16 a[172:173], v217 offset:24576
  buffer_load_dwordx4 v253, s[20:23], s35 offen lds
  v_mfma_f32_16x16x32_bf16 v[60:63], a[148:151], v[180:183], v[60:63]
  v_exp_f32 v23, v23
  v_mfma_f32_16x16x32_bf16 v[60:63], a[144:147], v[176:179], v[60:63]
  ds_read_b64_tr_b16 a[174:175], v217 offset:28672
  v_cvt_pk_bf16_f32 v19, v22, v23
  v_mfma_f32_16x16x32_bf16 a[192:195], a[208:211], v[64:67], a[192:195]
  v_exp_f32 v28, v28
  v_mfma_f32_16x16x32_bf16 a[192:195], a[208:211], v[96:99], a[192:195]
  ds_read_b64_tr_b16 a[176:177], v218 offset:16384
  v_add_u32 v245, 1, v245
  v_mfma_f32_16x16x32_bf16 a[196:199], a[208:211], v[72:75], a[196:199]
  v_exp_f32 v29, v29
  v_mfma_f32_16x16x32_bf16 a[196:199], a[208:211], v[104:107], a[196:199]
  ds_read_b64_tr_b16 a[178:179], v218 offset:20480
  v_cvt_pk_bf16_f32 v26, v28, v29
  v_mfma_f32_16x16x32_bf16 a[200:203], a[208:211], v[80:83], a[200:203]
  s_waitcnt vmcnt(11)
  v_exp_f32 v30, v30
  v_mfma_f32_16x16x32_bf16 a[200:203], a[208:211], v[112:115], a[200:203]
  ds_read_b64_tr_b16 a[180:181], v218 offset:24576
  ds_write_b32 v246, v245
  v_mfma_f32_16x16x32_bf16 a[204:207], a[208:211], v[88:91], a[204:207]
  s_waitcnt lgkmcnt(8)
  v_exp_f32 v31, v31
  v_mfma_f32_16x16x32_bf16 a[204:207], a[208:211], v[120:123], a[204:207]
  ds_read_b64_tr_b16 a[182:183], v218 offset:28672
  v_cvt_pk_bf16_f32 v27, v30, v31
  v_mfma_f32_16x16x32_bf16 a[0:3], a[160:163], v[64:67], a[0:3]
  v_exp_f32 v32, v32
  v_mfma_f32_16x16x32_bf16 a[0:3], a[164:167], v[96:99], a[0:3]
  ds_read_b64_tr_b16 a[184:185], v219 offset:16384
  v_mfma_f32_16x16x32_bf16 a[4:7], a[164:167], v[104:107], a[4:7]
  v_exp_f32 v33, v33
  v_mfma_f32_16x16x32_bf16 a[4:7], a[160:163], v[72:75], a[4:7]
  ds_read_b64_tr_b16 a[186:187], v219 offset:20480
  v_cvt_pk_bf16_f32 v32, v32, v33
  v_mfma_f32_16x16x32_bf16 a[8:11], a[160:163], v[80:83], a[8:11]
  v_exp_f32 v34, v34
  v_mfma_f32_16x16x32_bf16 a[8:11], a[164:167], v[112:115], a[8:11]
  ds_read_b64_tr_b16 a[188:189], v219 offset:24576
  v_mfma_f32_16x16x32_bf16 a[12:15], a[164:167], v[120:123], a[12:15]
  s_waitcnt lgkmcnt(8)
  v_exp_f32 v35, v35
  v_mfma_f32_16x16x32_bf16 a[12:15], a[160:163], v[88:91], a[12:15]
  ds_read_b64_tr_b16 a[190:191], v219 offset:28672
  v_cvt_pk_bf16_f32 v33, v34, v35
  v_mfma_f32_16x16x32_bf16 a[16:19], a[168:171], v[64:67], a[16:19]
  v_exp_f32 v40, v40
  v_mfma_f32_16x16x32_bf16 a[16:19], a[172:175], v[96:99], a[16:19]
  ds_read_b64_tr_b16 a[160:161], v220 offset:16384
  v_mfma_f32_16x16x32_bf16 a[20:23], a[172:175], v[104:107], a[20:23]
  v_exp_f32 v41, v41
  v_mfma_f32_16x16x32_bf16 a[20:23], a[168:171], v[72:75], a[20:23]
  ds_read_b64_tr_b16 a[162:163], v220 offset:20480
  v_cvt_pk_bf16_f32 v40, v40, v41
  v_mfma_f32_16x16x32_bf16 a[24:27], a[168:171], v[80:83], a[24:27]
  v_exp_f32 v42, v42
  v_mfma_f32_16x16x32_bf16 a[24:27], a[172:175], v[112:115], a[24:27]
  ds_read_b64_tr_b16 a[164:165], v220 offset:24576
  v_mfma_f32_16x16x32_bf16 a[28:31], a[172:175], v[120:123], a[28:31]
  s_waitcnt lgkmcnt(7)
  v_exp_f32 v43, v43
  v_mfma_f32_16x16x32_bf16 a[28:31], a[168:171], v[88:91], a[28:31]
  ds_read_b64_tr_b16 a[166:167], v220 offset:28672
  v_cvt_pk_bf16_f32 v41, v42, v43
  v_mfma_f32_16x16x32_bf16 a[32:35], a[176:179], v[64:67], a[32:35]
  v_exp_f32 v48, v48
  v_mfma_f32_16x16x32_bf16 a[32:35], a[180:183], v[96:99], a[32:35]
  ds_read_b64_tr_b16 a[168:169], v221 offset:16384
  v_mfma_f32_16x16x32_bf16 a[36:39], a[180:183], v[104:107], a[36:39]
  v_exp_f32 v49, v49
  v_mfma_f32_16x16x32_bf16 a[36:39], a[176:179], v[72:75], a[36:39]
  ds_read_b64_tr_b16 a[170:171], v221 offset:20480
  v_cvt_pk_bf16_f32 v48, v48, v49
  v_mfma_f32_16x16x32_bf16 a[40:43], a[176:179], v[80:83], a[40:43]
  v_exp_f32 v50, v50
  v_mfma_f32_16x16x32_bf16 a[40:43], a[180:183], v[112:115], a[40:43]
  ds_read_b64_tr_b16 a[172:173], v221 offset:24576
  v_mfma_f32_16x16x32_bf16 a[44:47], a[180:183], v[120:123], a[44:47]
  s_waitcnt lgkmcnt(7)
  v_exp_f32 v51, v51
  v_mfma_f32_16x16x32_bf16 a[44:47], a[176:179], v[88:91], a[44:47]
  ds_read_b64_tr_b16 a[174:175], v221 offset:28672
  v_cvt_pk_bf16_f32 v49, v50, v51
  v_mfma_f32_16x16x32_bf16 a[48:51], a[184:187], v[64:67], a[48:51]
  v_exp_f32 v56, v56
  v_mfma_f32_16x16x32_bf16 a[48:51], a[188:191], v[96:99], a[48:51]
  ds_read_b64_tr_b16 a[176:177], v222 offset:16384
  v_mfma_f32_16x16x32_bf16 a[52:55], a[188:191], v[104:107], a[52:55]
  v_exp_f32 v57, v57
  v_mfma_f32_16x16x32_bf16 a[52:55], a[184:187], v[72:75], a[52:55]
  ds_read_b64_tr_b16 a[178:179], v222 offset:20480
  v_cvt_pk_bf16_f32 v56, v56, v57
  v_mfma_f32_16x16x32_bf16 a[56:59], a[184:187], v[80:83], a[56:59]
  v_exp_f32 v58, v58
  v_mfma_f32_16x16x32_bf16 a[56:59], a[188:191], v[112:115], a[56:59]
  ds_read_b64_tr_b16 a[180:181], v222 offset:24576
  v_mfma_f32_16x16x32_bf16 a[60:63], a[188:191], v[120:123], a[60:63]
  s_waitcnt lgkmcnt(7)
  v_exp_f32 v59, v59
  v_mfma_f32_16x16x32_bf16 a[60:63], a[184:187], v[88:91], a[60:63]
  ds_read_b64_tr_b16 a[182:183], v222 offset:28672
  v_cvt_pk_bf16_f32 v57, v58, v59
  v_mfma_f32_16x16x32_bf16 a[64:67], a[160:163], v[64:67], a[64:67]
  v_exp_f32 v36, v36
  v_mfma_f32_16x16x32_bf16 a[64:67], a[164:167], v[96:99], a[64:67]
  ds_read_b64_tr_b16 a[184:185], v223 offset:16384
  ds_read_b32 v248, v247
  v_mfma_f32_16x16x32_bf16 a[68:71], a[164:167], v[104:107], a[68:71]
  v_exp_f32 v37, v37
  v_mfma_f32_16x16x32_bf16 a[68:71], a[160:163], v[72:75], a[68:71]
  ds_read_b64_tr_b16 a[186:187], v223 offset:20480
  v_cvt_pk_bf16_f32 v34, v36, v37
  v_mfma_f32_16x16x32_bf16 a[72:75], a[160:163], v[80:83], a[72:75]
  v_exp_f32 v38, v38
  v_mfma_f32_16x16x32_bf16 a[72:75], a[164:167], v[112:115], a[72:75]
  ds_read_b64_tr_b16 a[188:189], v223 offset:24576
  v_mfma_f32_16x16x32_bf16 a[76:79], a[164:167], v[120:123], a[76:79]
  s_waitcnt lgkmcnt(8)
  v_exp_f32 v39, v39
  v_mfma_f32_16x16x32_bf16 a[76:79], a[160:163], v[88:91], a[76:79]
  ds_read_b64_tr_b16 a[190:191], v223 offset:28672
  v_cvt_pk_bf16_f32 v35, v38, v39
  v_mfma_f32_16x16x32_bf16 a[80:83], a[168:171], v[64:67], a[80:83]
  s_waitcnt lgkmcnt(3)
  v_exp_f32 v44, v44
  v_mfma_f32_16x16x32_bf16 a[80:83], a[172:175], v[96:99], a[80:83]
  v_cmp_lt_u32 vcc, v248, v245
  v_mfma_f32_16x16x32_bf16 a[84:87], a[172:175], v[104:107], a[84:87]
  s_cbranch_vccnz attn_wait1
attn_on1:
  v_exp_f32 v45, v45
  v_mfma_f32_16x16x32_bf16 a[84:87], a[168:171], v[72:75], a[84:87]
  ds_read_b128 a[128:131], v212 offset:49152
  v_cvt_pk_bf16_f32 v42, v44, v45
  v_mfma_f32_16x16x32_bf16 a[88:91], a[168:171], v[80:83], a[88:91]
  v_exp_f32 v46, v46
  v_mfma_f32_16x16x32_bf16 a[88:91], a[172:175], v[112:115], a[88:91]
  ds_read_b128 a[132:135], v213 offset:49152
  v_mfma_f32_16x16x32_bf16 a[92:95], a[172:175], v[120:123], a[92:95]
  v_exp_f32 v47, v47
  v_mfma_f32_16x16x32_bf16 a[92:95], a[168:171], v[88:91], a[92:95]
  ds_read_b128 a[136:139], v214 offset:49152
  v_cvt_pk_bf16_f32 v43, v46, v47
  v_mfma_f32_16x16x32_bf16 a[96:99], a[176:179], v[64:67], a[96:99]
  v_exp_f32 v52, v52
  v_mfma_f32_16x16x32_bf16 a[96:99], a[180:183], v[96:99], a[96:99]
  ds_read_b128 a[140:143], v215 offset:49152
  buffer_load_dwordx4 a[216:219], v243, s[24:27], s38 offen sc1
  s_add_u32 s38, s38, 4096
  v_mfma_f32_16x16x32_bf16 a[100:103], a[180:183], v[104:107], a[100:103]
  v_exp_f32 v53, v53
  v_mfma_f32_16x16x32_bf16 a[100:103], a[176:179], v[72:75], a[100:103]
  v_cvt_pk_bf16_f32 v50, v52, v53
  v_mfma_f32_16x16x32_bf16 a[104:107], a[176:179], v[80:83], a[104:107]
  v_exp_f32 v54, v54
  v_mfma_f32_16x16x32_bf16 a[104:107], a[180:183], v[112:115], a[104:107]
  v_mfma_f32_16x16x32_bf16 a[108:111], a[180:183], v[120:123], a[108:111]
  s_waitcnt lgkmcnt(4)
  v_exp_f32 v55, v55
  v_mfma_f32_16x16x32_bf16 a[108:111], a[176:179], v[88:91], a[108:111]
  v_cvt_pk_bf16_f32 v51, v54, v55
  v_mfma_f32_16x16x32_bf16 a[112:115], a[184:187], v[64:67], a[112:115]
  v_exp_f32 v60, v60
  v_mfma_f32_16x16x32_bf16 a[112:115], a[188:191], v[96:99], a[112:115]
  v_mfma_f32_16x16x32_bf16 a[116:119], a[188:191], v[104:107], a[116:119]
  v_exp_f32 v61, v61
  v_mfma_f32_16x16x32_bf16 a[116:119], a[184:187], v[72:75], a[116:119]
  v_cvt_pk_bf16_f32 v58, v60, v61
  v_mfma_f32_16x16x32_bf16 a[120:123], a[184:187], v[80:83], a[120:123]
  v_exp_f32 v62, v62
  v_mfma_f32_16x16x32_bf16 a[120:123], a[188:191], v[112:115], a[120:123]
  v_mfma_f32_16x16x32_bf16 a[124:127], a[188:191], v[120:123], a[124:127]
  s_waitcnt lgkmcnt(0)
  v_exp_f32 v63, v63
  v_mfma_f32_16x16x32_bf16 a[124:127], a[184:187], v[88:91], a[124:127]
  v_cvt_pk_bf16_f32 v59, v62, v63
  v_mfma_f32_16x16x32_bf16 v[64:67], a[128:131], v[128:131], v[192:195]
  s_add_u32 m0, s28, 65536
  v_mfma_f32_16x16x32_bf16 v[64:67], a[132:135], v[132:135], v[64:67]
  ds_read_b128 a[144:147], v212 offset:53248
  v_mfma_f32_16x16x32_bf16 v[64:67], a[136:139], v[136:139], v[64:67]
  buffer_load_dwordx4 v236, s[16:19], s29 offen offset:0 lds
  v_mfma_f32_16x16x32_bf16 v[64:67], a[140:143], v[140:143], v[64:67]
  ds_read_b128 a[148:151], v213 offset:53248
  v_mfma_f32_16x16x32_bf16 v[72:75], a[140:143], v[156:159], v[196:199]
  v_mfma_f32_16x16x32_bf16 v[72:75], a[136:139], v[152:155], v[72:75]
  ds_read_b128 a[152:155], v214 offset:53248
  v_mfma_f32_16x16x32_bf16 v[72:75], a[132:135], v[148:151], v[72:75]
  buffer_load_dwordx4 v237, s[16:19], s29 offen offset:1024 lds
  v_mfma_f32_16x16x32_bf16 v[72:75], a[128:131], v[144:147], v[72:75]
  ds_read_b128 a[156:159], v215 offset:53248
  v_mfma_f32_16x16x32_bf16 v[80:83], a[128:131], v[160:163], v[200:203]
  v_exp_f32 v64, v64
  v_mfma_f32_16x16x32_bf16 v[80:83], a[132:135], v[164:167], v[80:83]
  v_mfma_f32_16x16x32_bf16 v[80:83], a[136:139], v[168:171], v[80:83]
  v_exp_f32 v65, v65
  v_mfma_f32_16x16x32_bf16 v[80:83], a[140:143], v[172:175], v[80:83]
  v_cvt_pk_bf16_f32 v64, v64, v65
  v_mfma_f32_16x16x32_bf16 v[88:91], a[140:143], v[188:191], v[204:207]
  v_exp_f32 v66, v66
  v_mfma_f32_16x16x32_bf16 v[88:91], a[136:139], v[184:187], v[88:91]
  buffer_load_dwordx4 v236, s[16:19], s29 offen offset:2048 lds
  v_mfma_f32_16x16x32_bf16 v[88:91], a[132:135], v[180:183], v[88:91]
  s_waitcnt lgkmcnt(0)
  v_exp_f32 v67, v67
  v_mfma_f32_16x16x32_bf16 v[88:91], a[128:131], v[176:179], v[88:91]
  v_cvt_pk_bf16_f32 v65, v66, v67
  v_mfma_f32_16x16x32_bf16 v[68:71], a[144:147], v[128:131], v[192:195]
  v_exp_f32 v72, v72
  v_mfma_f32_16x16x32_bf16 v[68:71], a[148:151], v[132:135], v[68:71]
  ds_read_b128 a[128:131], v212 offset:57344
  v_mfma_f32_16x16x32_bf16 v[68:71], a[152:155], v[136:139], v[68:71]
  v_exp_f32 v73, v73
  v_mfma_f32_16x16x32_bf16 v[68:71], a[156:159], v[140:143], v[68:71]
  ds_read_b128 a[132:135], v213 offset:57344
  v_cvt_pk_bf16_f32 v72, v72, v73
  v_mfma_f32_16x16x32_bf16 v[76:79], a[156:159], v[156:159], v[196:199]
  v_exp_f32 v74, v74
  v_mfma_f32_16x16x32_bf16 v[76:79], a[152:155], v[152:155], v[76:79]
  ds_read_b128 a[136:139], v214 offset:57344
  v_mfma_f32_16x16x32_bf16 v[76:79], a[148:151], v[148:151], v[76:79]
  v_exp_f32 v75, v75
  v_mfma_f32_16x16x32_bf16 v[76:79], a[144:147], v[144:147], v[76:79]
  ds_read_b128 a[140:143], v215 offset:57344
  v_cvt_pk_bf16_f32 v73, v74, v75
  v_mfma_f32_16x16x32_bf16 v[84:87], a[144:147], v[160:163], v[200:203]
  v_exp_f32 v80, v80
  v_mfma_f32_16x16x32_bf16 v[84:87], a[148:151], v[164:167], v[84:87]
  buffer_load_dwordx4 v237, s[16:19], s29 offen offset:3072 lds
  v_mfma_f32_16x16x32_bf16 v[84:87], a[152:155], v[168:171], v[84:87]
  s_add_u32 s29, s29, 16384
  v_exp_f32 v81, v81
  v_mfma_f32_16x16x32_bf16 v[84:87], a[156:159], v[172:175], v[84:87]
  v_cvt_pk_bf16_f32 v80, v80, v81
  v_mfma_f32_16x16x32_bf16 v[92:95], a[156:159], v[188:191], v[204:207]
  s_add_u32 m0, s28, 16384
  v_exp_f32 v82, v82
  v_mfma_f32_16x16x32_bf16 v[92:95], a[152:155], v[184:187], v[92:95]
  buffer_load_dwordx4 v232, s[12:15], s29 offen offset:0 lds
  v_mfma_f32_16x16x32_bf16 v[92:95], a[148:151], v[180:183], v[92:95]
  s_waitcnt lgkmcnt(0)
  v_exp_f32 v83, v83
  v_mfma_f32_16x16x32_bf16 v[92:95], a[144:147], v[176:179], v[92:95]
  v_cvt_pk_bf16_f32 v81, v82, v83
  v_mfma_f32_16x16x32_bf16 v[96:99], a[128:131], v[128:131], v[192:195]
  v_exp_f32 v88, v88
  v_mfma_f32_16x16x32_bf16 v[96:99], a[132:135], v[132:135], v[96:99]
  ds_read_b128 a[144:147], v212 offset:61440
  v_mfma_f32_16x16x32_bf16 v[96:99], a[136:139], v[136:139], v[96:99]
  v_exp_f32 v89, v89
  v_mfma_f32_16x16x32_bf16 v[96:99], a[140:143], v[140:143], v[96:99]
  ds_read_b128 a[148:151], v213 offset:61440
  v_cvt_pk_bf16_f32 v88, v88, v89
  v_mfma_f32_16x16x32_bf16 v[104:107], a[140:143], v[156:159], v[196:199]
  v_exp_f32 v90, v90
  v_mfma_f32_16x16x32_bf16 v[104:107], a[136:139], v[152:155], v[104:107]
  ds_read_b128 a[152:155], v214 offset:61440
  v_mfma_f32_16x16x32_bf16 v[104:107], a[132:135], v[148:151], v[104:107]
  v_exp_f32 v91, v91
  v_mfma_f32_16x16x32_bf16 v[104:107], a[128:131], v[144:147], v[104:107]
  ds_read_b128 a[156:159], v215 offset:61440
  v_cvt_pk_bf16_f32 v89, v90, v91
  v_mfma_f32_16x16x32_bf16 v[112:115], a[128:131], v[160:163], v[200:203]
  v_exp_f32 v68, v68
  v_mfma_f32_16x16x32_bf16 v[112:115], a[132:135], v[164:167], v[112:115]
  buffer_load_dwordx4 v233, s[12:15], s29 offen offset:1024 lds
  v_mfma_f32_16x16x32_bf16 v[112:115], a[136:139], v[168:171], v[112:115]
  v_exp_f32 v69, v69
  v_mfma_f32_16x16x32_bf16 v[112:115], a[140:143], v[172:175], v[112:115]
  v_cvt_pk_bf16_f32 v66, v68, v69
  v_mfma_f32_16x16x32_bf16 v[120:123], a[140:143], v[188:191], v[204:207]
  v_exp_f32 v70, v70
  v_mfma_f32_16x16x32_bf16 v[120:123], a[136:139], v[184:187], v[120:123]
  buffer_load_dwordx4 v234, s[12:15], s29 offen offset:2048 lds
  v_mfma_f32_16x16x32_bf16 v[120:123], a[132:135], v[180:183], v[120:123]
  s_waitcnt lgkmcnt(0)
  v_exp_f32 v71, v71
  v_mfma_f32_16x16x32_bf16 v[120:123], a[128:131], v[176:179], v[120:123]
  v_cvt_pk_bf16_f32 v67, v70, v71
  v_mfma_f32_16x16x32_bf16 v[100:103], a[144:147], v[128:131], v[192:195]
  v_exp_f32 v76, v76
  v_mfma_f32_16x16x32_bf16 v[100:103], a[148:151], v[132:135], v[100:103]
  ds_read_b64_tr_b16 a[160:161], v216 offset:32768
  v_mfma_f32_16x16x32_bf16 v[100:103], a[152:155], v[136:139], v[100:103]
  v_exp_f32 v77, v77
  v_mfma_f32_16x16x32_bf16 v[100:103], a[156:159], v[140:143], v[100:103]
  ds_read_b64_tr_b16 a[162:163], v216 offset:36864
  v_cvt_pk_bf16_f32 v74, v76, v77
  v_mfma_f32_16x16x32_bf16 v[108:111], a[156:159], v[156:159], v[196:199]
  v_exp_f32 v78, v78
  v_mfma_f32_16x16x32_bf16 v[108:111], a[152:155], v[152:155], v[108:111]
  ds_read_b64_tr_b16 a[164:165], v216 offset:40960
  buffer_load_dwordx4 v235, s[12:15], s29 offen offset:3072 lds
  v_mfma_f32_16x16x32_bf16 v[108:111], a[148:151], v[148:151], v[108:111]
  v_exp_f32 v79, v79
  v_mfma_f32_16x16x32_bf16 v[108:111], a[144:147], v[144:147], v[108:111]
  ds_read_b64_tr_b16 a[166:167], v216 offset:45056
  v_cvt_pk_bf16_f32 v75, v78, v79
  v_mfma_f32_16x16x32_bf16 v[116:119], a[144:147], v[160:163], v[200:203]
  v_exp_f32 v84, v84
  v_mfma_f32_16x16x32_bf16 v[116:119], a[148:151], v[164:167], v[116:119]
  ds_read_b64_tr_b16 a[168:169], v217 offset:32768
  s_add_u32 m0, s50, 4096
  v_mfma_f32_16x16x32_bf16 v[116:119], a[152:155], v[168:171], v[116:119]
  v_exp_f32 v85, v85
  v_mfma_f32_16x16x32_bf16 v[116:119], a[156:159], v[172:175], v[116:119]
  ds_read_b64_tr_b16 a[170:171], v217 offset:36864
  v_cvt_pk_bf16_f32 v82, v84, v85
  v_mfma_f32_16x16x32_bf16 v[124:127], a[156:159], v[188:191], v[204:207]
  v_exp_f32 v86, v86
  v_mfma_f32_16x16x32_bf16 v[124:127], a[152:155], v[184:187], v[124:127]
  ds_read_b64_tr_b16 a[172:173], v217 offset:40960
  buffer_load_dwordx4 v253, s[44:47], s35 offen lds
  s_add_u32 s35, s35, 221184
  v_mfma_f32_16x16x32_bf16 v[124:127], a[148:151], v[180:183], v[124:127]
  v_exp_f32 v87, v87
  v_mfma_f32_16x16x32_bf16 v[124:127], a[144:147], v[176:179], v[124:127]
  ds_read_b64_tr_b16 a[174:175], v217 offset:45056
  v_cvt_pk_bf16_f32 v83, v86, v87
  v_mfma_f32_16x16x32_bf16 a[192:195], a[208:211], v[0:3], a[192:195]
  v_exp_f32 v92, v92
  v_mfma_f32_16x16x32_bf16 a[192:195], a[208:211], v[32:35], a[192:195]
  ds_read_b64_tr_b16 a[176:177], v218 offset:32768
  v_add_u32 v245, 1, v245
  v_mfma_f32_16x16x32_bf16 a[196:199], a[208:211], v[8:11], a[196:199]
  v_exp_f32 v93, v93
  v_mfma_f32_16x16x32_bf16 a[196:199], a[208:211], v[40:43], a[196:199]
  ds_read_b64_tr_b16 a[178:179], v218 offset:36864
  v_cvt_pk_bf16_f32 v90, v92, v93
  v_mfma_f32_16x16x32_bf16 a[200:203], a[208:211], v[16:19], a[200:203]
  s_waitcnt vmcnt(11)
  v_exp_f32 v94, v94
  v_mfma_f32_16x16x32_bf16 a[200:203], a[208:211], v[48:51], a[200:203]
  ds_read_b64_tr_b16 a[180:181], v218 offset:40960
  ds_write_b32 v246, v245
  v_mfma_f32_16x16x32_bf16 a[204:207], a[208:211], v[24:27], a[204:207]
  s_waitcnt lgkmcnt(8)
  v_exp_f32 v95, v95
  v_mfma_f32_16x16x32_bf16 a[204:207], a[208:211], v[56:59], a[204:207]
  ds_read_b64_tr_b16 a[182:183], v218 offset:45056
  v_cvt_pk_bf16_f32 v91, v94, v95
  v_mfma_f32_16x16x32_bf16 a[0:3], a[160:163], v[0:3], a[0:3]
  v_exp_f32 v96, v96
  v_mfma_f32_16x16x32_bf16 a[0:3], a[164:167], v[32:35], a[0:3]
  ds_read_b64_tr_b16 a[184:185], v219 offset:32768
  v_lshrrev_b32 v254, 4, v242
  v_mfma_f32_16x16x32_bf16 a[4:7], a[164:167], v[40:43], a[4:7]
  v_exp_f32 v97, v97
  v_mfma_f32_16x16x32_bf16 a[4:7], a[160:163], v[8:11], a[4:7]
  ds_read_b64_tr_b16 a[186:187], v219 offset:36864
  v_cvt_pk_bf16_f32 v96, v96, v97
  v_mfma_f32_16x16x32_bf16 a[8:11], a[160:163], v[16:19], a[8:11]
  v_exp_f32 v98, v98
  v_mfma_f32_16x16x32_bf16 a[8:11], a[164:167], v[48:51], a[8:11]
  ds_read_b64_tr_b16 a[188:189], v219 offset:40960
  v_lshrrev_b32 v254, 5, v254
  v_mfma_f32_16x16x32_bf16 a[12:15], a[164:167], v[56:59], a[12:15]
  s_waitcnt lgkmcnt(8)
  v_exp_f32 v99, v99
  v_mfma_f32_16x16x32_bf16 a[12:15], a[160:163], v[24:27], a[12:15]
  ds_read_b64_tr_b16 a[190:191], v219 offset:45056
  v_cvt_pk_bf16_f32 v97, v98, v99
  v_mfma_f32_16x16x32_bf16 a[16:19], a[168:171], v[0:3], a[16:19]
  v_exp_f32 v104, v104
  v_mfma_f32_16x16x32_bf16 a[16:19], a[172:175], v[32:35], a[16:19]
  ds_read_b64_tr_b16 a[160:161], v220 offset:32768
  v_lshl_add_u32 v253, v254, 30, v253
  v_mfma_f32_16x16x32_bf16 a[20:23], a[172:175], v[40:43], a[20:23]
  v_exp_f32 v105, v105
  v_mfma_f32_16x16x32_bf16 a[20:23], a[168:171], v[8:11], a[20:23]
  ds_read_b64_tr_b16 a[162:163], v220 offset:36864
  v_cvt_pk_bf16_f32 v104, v104, v105
  v_mfma_f32_16x16x32_bf16 a[24:27], a[168:171], v[16:19], a[24:27]
  v_exp_f32 v106, v106
  v_mfma_f32_16x16x32_bf16 a[24:27], a[172:175], v[48:51], a[24:27]
  ds_read_b64_tr_b16 a[164:165], v220 offset:40960
  v_mfma_f32_16x16x32_bf16 a[28:31], a[172:175], v[56:59], a[28:31]
  s_waitcnt lgkmcnt(7)
  v_exp_f32 v107, v107
  v_mfma_f32_16x16x32_bf16 a[28:31], a[168:171], v[24:27], a[28:31]
  ds_read_b64_tr_b16 a[166:167], v220 offset:45056
  v_cvt_pk_bf16_f32 v105, v106, v107
  v_mfma_f32_16x16x32_bf16 a[32:35], a[176:179], v[0:3], a[32:35]
  v_exp_f32 v112, v112
  v_mfma_f32_16x16x32_bf16 a[32:35], a[180:183], v[32:35], a[32:35]
  ds_read_b64_tr_b16 a[168:169], v221 offset:32768
  v_mfma_f32_16x16x32_bf16 a[36:39], a[180:183], v[40:43], a[36:39]
  v_exp_f32 v113, v113
  v_mfma_f32_16x16x32_bf16 a[36:39], a[176:179], v[8:11], a[36:39]
  ds_read_b64_tr_b16 a[170:171], v221 offset:36864
  v_cvt_pk_bf16_f32 v112, v112, v113
  v_mfma_f32_16x16x32_bf16 a[40:43], a[176:179], v[16:19], a[40:43]
  v_exp_f32 v114, v114
  v_mfma_f32_16x16x32_bf16 a[40:43], a[180:183], v[48:51], a[40:43]
  ds_read_b64_tr_b16 a[172:173], v221 offset:40960
  v_mfma_f32_16x16x32_bf16 a[44:47], a[180:183], v[56:59], a[44:47]
  s_waitcnt lgkmcnt(7)
  v_exp_f32 v115, v115
  v_mfma_f32_16x16x32_bf16 a[44:47], a[176:179], v[24:27], a[44:47]
  ds_read_b64_tr_b16 a[174:175], v221 offset:45056
  v_cvt_pk_bf16_f32 v113, v114, v115
  v_mfma_f32_16x16x32_bf16 a[48:51], a[184:187], v[0:3], a[48:51]
  v_exp_f32 v120, v120
  v_mfma_f32_16x16x32_bf16 a[48:51], a[188:191], v[32:35], a[48:51]
  ds_read_b64_tr_b16 a[176:177], v222 offset:32768
  v_mfma_f32_16x16x32_bf16 a[52:55], a[188:191], v[40:43], a[52:55]
  v_exp_f32 v121, v121
  v_mfma_f32_16x16x32_bf16 a[52:55], a[184:187], v[8:11], a[52:55]
  ds_read_b64_tr_b16 a[178:179], v222 offset:36864
  v_cvt_pk_bf16_f32 v120, v120, v121
  v_mfma_f32_16x16x32_bf16 a[56:59], a[184:187], v[16:19], a[56:59]
  v_exp_f32 v122, v122
  v_mfma_f32_16x16x32_bf16 a[56:59], a[188:191], v[48:51], a[56:59]
  ds_read_b64_tr_b16 a[180:181], v222 offset:40960
  v_mfma_f32_16x16x32_bf16 a[60:63], a[188:191], v[56:59], a[60:63]
  s_waitcnt lgkmcnt(7)
  v_exp_f32 v123, v123
  v_mfma_f32_16x16x32_bf16 a[60:63], a[184:187], v[24:27], a[60:63]
  ds_read_b64_tr_b16 a[182:183], v222 offset:45056
  v_cvt_pk_bf16_f32 v121, v122, v123
  v_mfma_f32_16x16x32_bf16 a[64:67], a[160:163], v[0:3], a[64:67]
  v_exp_f32 v100, v100
  v_mfma_f32_16x16x32_bf16 a[64:67], a[164:167], v[32:35], a[64:67]
  ds_read_b64_tr_b16 a[184:185], v223 offset:32768
  ds_read_b32 v248, v247
  v_mfma_f32_16x16x32_bf16 a[68:71], a[164:167], v[40:43], a[68:71]
  v_exp_f32 v101, v101
  v_mfma_f32_16x16x32_bf16 a[68:71], a[160:163], v[8:11], a[68:71]
  ds_read_b64_tr_b16 a[186:187], v223 offset:36864
  v_cvt_pk_bf16_f32 v98, v100, v101
  v_mfma_f32_16x16x32_bf16 a[72:75], a[160:163], v[16:19], a[72:75]
  v_exp_f32 v102, v102
  v_mfma_f32_16x16x32_bf16 a[72:75], a[164:167], v[48:51], a[72:75]
  ds_read_b64_tr_b16 a[188:189], v223 offset:40960
  v_mfma_f32_16x16x32_bf16 a[76:79], a[164:167], v[56:59], a[76:79]
  s_waitcnt lgkmcnt(8)
  v_exp_f32 v103, v103
  v_mfma_f32_16x16x32_bf16 a[76:79], a[160:163], v[24:27], a[76:79]
  ds_read_b64_tr_b16 a[190:191], v223 offset:45056
  v_cvt_pk_bf16_f32 v99, v102, v103
  v_mfma_f32_16x16x32_bf16 a[80:83], a[168:171], v[0:3], a[80:83]
  s_waitcnt lgkmcnt(3)
  v_exp_f32 v108, v108
  v_mfma_f32_16x16x32_bf16 a[80:83], a[172:175], v[32:35], a[80:83]
  v_cmp_lt_u32 vcc, v248, v245
  v_mfma_f32_16x16x32_bf16 a[84:87], a[172:175], v[40:43], a[84:87]
  s_cbranch_vccnz attn_wait2
attn_on2:
  v_exp_f32 v109, v109
  v_mfma_f32_16x16x32_bf16 a[84:87], a[168:171], v[8:11], a[84:87]
  ds_read_b128 a[128:131], v212 offset:0
  v_cvt_pk_bf16_f32 v106, v108, v109
  v_mfma_f32_16x16x32_bf16 a[88:91], a[168:171], v[16:19], a[88:91]
  v_exp_f32 v110, v110
  v_mfma_f32_16x16x32_bf16 a[88:91], a[172:175], v[48:51], a[88:91]
  ds_read_b128 a[132:135], v213 offset:0
  v_mfma_f32_16x16x32_bf16 a[92:95], a[172:175], v[56:59], a[92:95]
  v_exp_f32 v111, v111
  v_mfma_f32_16x16x32_bf16 a[92:95], a[168:171], v[24:27], a[92:95]
  ds_read_b128 a[136:139], v214 offset:0
  v_cvt_pk_bf16_f32 v107, v110, v111
  v_mfma_f32_16x16x32_bf16 a[96:99], a[176:179], v[0:3], a[96:99]
  v_exp_f32 v116, v116
  v_mfma_f32_16x16x32_bf16 a[96:99], a[180:183], v[32:35], a[96:99]
  ds_read_b128 a[140:143], v215 offset:0
  buffer_load_dwordx4 a[220:223], v243, s[24:27], s38 offen sc1
  s_add_u32 s38, s38, 4096
  v_mfma_f32_16x16x32_bf16 a[100:103], a[180:183], v[40:43], a[100:103]
  v_exp_f32 v117, v117
  v_mfma_f32_16x16x32_bf16 a[100:103], a[176:179], v[8:11], a[100:103]
  v_cvt_pk_bf16_f32 v114, v116, v117
  v_mfma_f32_16x16x32_bf16 a[104:107], a[176:179], v[16:19], a[104:107]
  v_exp_f32 v118, v118
  v_mfma_f32_16x16x32_bf16 a[104:107], a[180:183], v[48:51], a[104:107]
  v_mfma_f32_16x16x32_bf16 a[108:111], a[180:183], v[56:59], a[108:111]
  s_waitcnt lgkmcnt(4)
  v_exp_f32 v119, v119
  v_mfma_f32_16x16x32_bf16 a[108:111], a[176:179], v[24:27], a[108:111]
  v_cvt_pk_bf16_f32 v115, v118, v119
  v_mfma_f32_16x16x32_bf16 a[112:115], a[184:187], v[0:3], a[112:115]
  v_exp_f32 v124, v124
  v_mfma_f32_16x16x32_bf16 a[112:115], a[188:191], v[32:35], a[112:115]
  v_mfma_f32_16x16x32_bf16 a[116:119], a[188:191], v[40:43], a[116:119]
  v_exp_f32 v125, v125
  v_mfma_f32_16x16x32_bf16 a[116:119], a[184:187], v[8:11], a[116:119]
  v_cvt_pk_bf16_f32 v122, v124, v125
  v_mfma_f32_16x16x32_bf16 a[120:123], a[184:187], v[16:19], a[120:123]
  v_exp_f32 v126, v126
  v_mfma_f32_16x16x32_bf16 a[120:123], a[188:191], v[48:51], a[120:123]
  v_mfma_f32_16x16x32_bf16 a[124:127], a[188:191], v[56:59], a[124:127]
  s_waitcnt lgkmcnt(0)
  v_exp_f32 v127, v127
  v_mfma_f32_16x16x32_bf16 a[124:127], a[184:187], v[24:27], a[124:127]
  v_cvt_pk_bf16_f32 v123, v126, v127
  v_mfma_f32_16x16x32_bf16 v[0:3], a[128:131], v[128:131], v[192:195]
  s_add_u32 m0, s28, 81920
  v_mfma_f32_16x16x32_bf16 v[0:3], a[132:135], v[132:135], v[0:3]
  ds_read_b128 a[144:147], v212 offset:4096
  v_mfma_f32_16x16x32_bf16 v[0:3], a[136:139], v[136:139], v[0:3]
  buffer_load_dwordx4 v236, s[16:19], s29 offen offset:0 lds
  v_mfma_f32_16x16x32_bf16 v[0:3], a[140:143], v[140:143], v[0:3]
  ds_read_b128 a[148:151], v213 offset:4096
  v_mfma_f32_16x16x32_bf16 v[8:11], a[140:143], v[156:159], v[196:199]
  v_mfma_f32_16x16x32_bf16 v[8:11], a[136:139], v[152:155], v[8:11]
  ds_read_b128 a[152:155], v214 offset:4096
  v_mfma_f32_16x16x32_bf16 v[8:11], a[132:135], v[148:151], v[8:11]
  buffer_load_dwordx4 v237, s[16:19], s29 offen offset:1024 lds
  v_mfma_f32_16x16x32_bf16 v[8:11], a[128:131], v[144:147], v[8:11]
  ds_read_b128 a[156:159], v215 offset:4096
  v_mfma_f32_16x16x32_bf16 v[16:19], a[128:131], v[160:163], v[200:203]
  v_exp_f32 v0, v0
  v_mfma_f32_16x16x32_bf16 v[16:19], a[132:135], v[164:167], v[16:19]
  v_mfma_f32_16x16x32_bf16 v[16:19], a[136:139], v[168:171], v[16:19]
  v_exp_f32 v1, v1
  v_mfma_f32_16x16x32_bf16 v[16:19], a[140:143], v[172:175], v[16:19]
  v_cvt_pk_bf16_f32 v0, v0, v1
  v_mfma_f32_16x16x32_bf16 v[24:27], a[140:143], v[188:191], v[204:207]
  v_exp_f32 v2, v2
  v_mfma_f32_16x16x32_bf16 v[24:27], a[136:139], v[184:187], v[24:27]
  buffer_load_dwordx4 v236, s[16:19], s29 offen offset:2048 lds
  v_mfma_f32_16x16x32_bf16 v[24:27], a[132:135], v[180:183], v[24:27]
  s_waitcnt lgkmcnt(0)
  v_exp_f32 v3, v3
  v_mfma_f32_16x16x32_bf16 v[24:27], a[128:131], v[176:179], v[24:27]
  v_cvt_pk_bf16_f32 v1, v2, v3
  v_mfma_f32_16x16x32_bf16 v[4:7], a[144:147], v[128:131], v[192:195]
  v_exp_f32 v8, v8
  v_mfma_f32_16x16x32_bf16 v[4:7], a[148:151], v[132:135], v[4:7]
  ds_read_b128 a[128:131], v212 offset:8192
  v_mfma_f32_16x16x32_bf16 v[4:7], a[152:155], v[136:139], v[4:7]
  v_exp_f32 v9, v9
  v_mfma_f32_16x16x32_bf16 v[4:7], a[156:159], v[140:143], v[4:7]
  ds_read_b128 a[132:135], v213 offset:8192
  v_cvt_pk_bf16_f32 v8, v8, v9
  v_mfma_f32_16x16x32_bf16 v[12:15], a[156:159], v[156:159], v[196:199]
  v_exp_f32 v10, v10
  v_mfma_f32_16x16x32_bf16 v[12:15], a[152:155], v[152:155], v[12:15]
  ds_read_b128 a[136:139], v214 offset:8192
  v_mfma_f32_16x16x32_bf16 v[12:15], a[148:151], v[148:151], v[12:15]
  v_exp_f32 v11, v11
  v_mfma_f32_16x16x32_bf16 v[12:15], a[144:147], v[144:147], v[12:15]
  ds_read_b128 a[140:143], v215 offset:8192
  v_cvt_pk_bf16_f32 v9, v10, v11
  v_mfma_f32_16x16x32_bf16 v[20:23], a[144:147], v[160:163], v[200:203]
  v_exp_f32 v16, v16
  v_mfma_f32_16x16x32_bf16 v[20:23], a[148:151], v[164:167], v[20:23]
  buffer_load_dwordx4 v237, s[16:19], s29 offen offset:3072 lds
  v_mfma_f32_16x16x32_bf16 v[20:23], a[152:155], v[168:171], v[20:23]
  s_add_u32 s29, s29, 16384
  v_exp_f32 v17, v17
  v_mfma_f32_16x16x32_bf16 v[20:23], a[156:159], v[172:175], v[20:23]
  v_cvt_pk_bf16_f32 v16, v16, v17
  v_mfma_f32_16x16x32_bf16 v[28:31], a[156:159], v[188:191], v[204:207]
  s_add_u32 m0, s28, 32768
  v_exp_f32 v18, v18
  v_mfma_f32_16x16x32_bf16 v[28:31], a[152:155], v[184:187], v[28:31]
  buffer_load_dwordx4 v232, s[12:15], s29 offen offset:0 lds
  v_mfma_f32_16x16x32_bf16 v[28:31], a[148:151], v[180:183], v[28:31]
  s_waitcnt lgkmcnt(0)
  v_exp_f32 v19, v19
  v_mfma_f32_16x16x32_bf16 v[28:31], a[144:147], v[176:179], v[28:31]
  v_cvt_pk_bf16_f32 v17, v18, v19
  v_mfma_f32_16x16x32_bf16 v[32:35], a[128:131], v[128:131], v[192:195]
  v_exp_f32 v24, v24
  v_mfma_f32_16x16x32_bf16 v[32:35], a[132:135], v[132:135], v[32:35]
  ds_read_b128 a[144:147], v212 offset:12288
  v_mfma_f32_16x16x32_bf16 v[32:35], a[136:139], v[136:139], v[32:35]
  v_exp_f32 v25, v25
  v_mfma_f32_16x16x32_bf16 v[32:35], a[140:143], v[140:143], v[32:35]
  ds_read_b128 a[148:151], v213 offset:12288
  v_cvt_pk_bf16_f32 v24, v24, v25
  v_mfma_f32_16x16x32_bf16 v[40:43], a[140:143], v[156:159], v[196:199]
  v_exp_f32 v26, v26
  v_mfma_f32_16x16x32_bf16 v[40:43], a[136:139], v[152:155], v[40:43]
  ds_read_b128 a[152:155], v214 offset:12288
  v_mfma_f32_16x16x32_bf16 v[40:43], a[132:135], v[148:151], v[40:43]
  v_exp_f32 v27, v27
  v_mfma_f32_16x16x32_bf16 v[40:43], a[128:131], v[144:147], v[40:43]
  ds_read_b128 a[156:159], v215 offset:12288
  v_cvt_pk_bf16_f32 v25, v26, v27
  v_mfma_f32_16x16x32_bf16 v[48:51], a[128:131], v[160:163], v[200:203]
  v_exp_f32 v4, v4
  v_mfma_f32_16x16x32_bf16 v[48:51], a[132:135], v[164:167], v[48:51]
  buffer_load_dwordx4 v233, s[12:15], s29 offen offset:1024 lds
  v_mfma_f32_16x16x32_bf16 v[48:51], a[136:139], v[168:171], v[48:51]
  v_exp_f32 v5, v5
  v_mfma_f32_16x16x32_bf16 v[48:51], a[140:143], v[172:175], v[48:51]
  v_cvt_pk_bf16_f32 v2, v4, v5
  v_mfma_f32_16x16x32_bf16 v[56:59], a[140:143], v[188:191], v[204:207]
  v_exp_f32 v6, v6
  v_mfma_f32_16x16x32_bf16 v[56:59], a[136:139], v[184:187], v[56:59]
  buffer_load_dwordx4 v234, s[12:15], s29 offen offset:2048 lds
  v_mfma_f32_16x16x32_bf16 v[56:59], a[132:135], v[180:183], v[56:59]
  s_waitcnt lgkmcnt(0)
  v_exp_f32 v7, v7
  v_mfma_f32_16x16x32_bf16 v[56:59], a[128:131], v[176:179], v[56:59]
  v_cvt_pk_bf16_f32 v3, v6, v7
  v_mfma_f32_16x16x32_bf16 v[36:39], a[144:147], v[128:131], v[192:195]
  v_exp_f32 v12, v12
  v_mfma_f32_16x16x32_bf16 v[36:39], a[148:151], v[132:135], v[36:39]
  ds_read_b64_tr_b16 a[160:161], v216 offset:49152
  v_mfma_f32_16x16x32_bf16 v[36:39], a[152:155], v[136:139], v[36:39]
  v_exp_f32 v13, v13
  v_mfma_f32_16x16x32_bf16 v[36:39], a[156:159], v[140:143], v[36:39]
  ds_read_b64_tr_b16 a[162:163], v216 offset:53248
  v_cvt_pk_bf16_f32 v10, v12, v13
  v_mfma_f32_16x16x32_bf16 v[44:47], a[156:159], v[156:159], v[196:199]
  v_exp_f32 v14, v14
  v_mfma_f32_16x16x32_bf16 v[44:47], a[152:155], v[152:155], v[44:47]
  ds_read_b64_tr_b16 a[164:165], v216 offset:57344
  buffer_load_dwordx4 v235, s[12:15], s29 offen offset:3072 lds
  v_mfma_f32_16x16x32_bf16 v[44:47], a[148:151], v[148:151], v[44:47]
  v_exp_f32 v15, v15
  v_mfma_f32_16x16x32_bf16 v[44:47], a[144:147], v[144:147], v[44:47]
  ds_read_b64_tr_b16 a[166:167], v216 offset:61440
  v_cvt_pk_bf16_f32 v11, v14, v15
  v_mfma_f32_16x16x32_bf16 v[52:55], a[144:147], v[160:163], v[200:203]
  v_exp_f32 v20, v20
  v_mfma_f32_16x16x32_bf16 v[52:55], a[148:151], v[164:167], v[52:55]
  ds_read_b64_tr_b16 a[168:169], v217 offset:49152
  s_add_u32 m0, s50, 2048
  v_mfma_f32_16x16x32_bf16 v[52:55], a[152:155], v[168:171], v[52:55]
  v_exp_f32 v21, v21
  v_mfma_f32_16x16x32_bf16 v[52:55], a[156:159], v[172:175], v[52:55]
  ds_read_b64_tr_b16 a[170:171], v217 offset:53248
  v_cvt_pk_bf16_f32 v18, v20, v21
  v_mfma_f32_16x16x32_bf16 v[60:63], a[156:159], v[188:191], v[204:207]
  v_exp_f32 v22, v22
  v_mfma_f32_16x16x32_bf16 v[60:63], a[152:155], v[184:187], v[60:63]
  ds_read_b64_tr_b16 a[172:173], v217 offset:57344
  buffer_load_dwordx4 v253, s[20:23], s35 offen lds
  v_mfma_f32_16x16x32_bf16 v[60:63], a[148:151], v[180:183], v[60:63]
  v_exp_f32 v23, v23
  v_mfma_f32_16x16x32_bf16 v[60:63], a[144:147], v[176:179], v[60:63]
  ds_read_b64_tr_b16 a[174:175], v217 offset:61440
  v_cvt_pk_bf16_f32 v19, v22, v23
  v_mfma_f32_16x16x32_bf16 a[192:195], a[208:211], v[64:67], a[192:195]
  v_exp_f32 v28, v28
  v_mfma_f32_16x16x32_bf16 a[192:195], a[208:211], v[96:99], a[192:195]
  ds_read_b64_tr_b16 a[176:177], v218 offset:49152
  v_add_u32 v245, 1, v245
  v_mfma_f32_16x16x32_bf16 a[196:199], a[208:211], v[72:75], a[196:199]
  v_exp_f32 v29, v29
  v_mfma_f32_16x16x32_bf16 a[196:199], a[208:211], v[104:107], a[196:199]
  ds_read_b64_tr_b16 a[178:179], v218 offset:53248
  v_cvt_pk_bf16_f32 v26, v28, v29
  v_mfma_f32_16x16x32_bf16 a[200:203], a[208:211], v[80:83], a[200:203]
  s_waitcnt vmcnt(11)
  v_exp_f32 v30, v30
  v_mfma_f32_16x16x32_bf16 a[200:203], a[208:211], v[112:115], a[200:203]
  ds_read_b64_tr_b16 a[180:181], v218 offset:57344
  ds_write_b32 v246, v245
  v_mfma_f32_16x16x32_bf16 a[204:207], a[208:211], v[88:91], a[204:207]
  s_waitcnt lgkmcnt(8)
  v_exp_f32 v31, v31
  v_mfma_f32_16x16x32_bf16 a[204:207], a[208:211], v[120:123], a[204:207]
  ds_read_b64_tr_b16 a[182:183], v218 offset:61440
  v_cvt_pk_bf16_f32 v27, v30, v31
  v_mfma_f32_16x16x32_bf16 a[0:3], a[160:163], v[64:67], a[0:3]
  v_exp_f32 v32, v32
  v_mfma_f32_16x16x32_bf16 a[0:3], a[164:167], v[96:99], a[0:3]
  ds_read_b64_tr_b16 a[184:185], v219 offset:49152
  v_mfma_f32_16x16x32_bf16 a[4:7], a[164:167], v[104:107], a[4:7]
  v_exp_f32 v33, v33
  v_mfma_f32_16x16x32_bf16 a[4:7], a[160:163], v[72:75], a[4:7]
  ds_read_b64_tr_b16 a[186:187], v219 offset:53248
  v_cvt_pk_bf16_f32 v32, v32, v33
  v_mfma_f32_16x16x32_bf16 a[8:11], a[160:163], v[80:83], a[8:11]
  v_exp_f32 v34, v34
  v_mfma_f32_16x16x32_bf16 a[8:11], a[164:167], v[112:115], a[8:11]
  ds_read_b64_tr_b16 a[188:189], v219 offset:57344
  v_mfma_f32_16x16x32_bf16 a[12:15], a[164:167], v[120:123], a[12:15]
  s_waitcnt lgkmcnt(8)
  v_exp_f32 v35, v35
  v_mfma_f32_16x16x32_bf16 a[12:15], a[160:163], v[88:91], a[12:15]
  ds_read_b64_tr_b16 a[190:191], v219 offset:61440
  v_cvt_pk_bf16_f32 v33, v34, v35
  v_mfma_f32_16x16x32_bf16 a[16:19], a[168:171], v[64:67], a[16:19]
  v_exp_f32 v40, v40
  v_mfma_f32_16x16x32_bf16 a[16:19], a[172:175], v[96:99], a[16:19]
  ds_read_b64_tr_b16 a[160:161], v220 offset:49152
  v_mfma_f32_16x16x32_bf16 a[20:23], a[172:175], v[104:107], a[20:23]
  v_exp_f32 v41, v41
  v_mfma_f32_16x16x32_bf16 a[20:23], a[168:171], v[72:75], a[20:23]
  ds_read_b64_tr_b16 a[162:163], v220 offset:53248
  v_cvt_pk_bf16_f32 v40, v40, v41
  v_mfma_f32_16x16x32_bf16 a[24:27], a[168:171], v[80:83], a[24:27]
  v_exp_f32 v42, v42
  v_mfma_f32_16x16x32_bf16 a[24:27], a[172:175], v[112:115], a[24:27]
  ds_read_b64_tr_b16 a[164:165], v220 offset:57344
  v_mfma_f32_16x16x32_bf16 a[28:31], a[172:175], v[120:123], a[28:31]
  s_waitcnt lgkmcnt(7)
  v_exp_f32 v43, v43
  v_mfma_f32_16x16x32_bf16 a[28:31], a[168:171], v[88:91], a[28:31]
  ds_read_b64_tr_b16 a[166:167], v220 offset:61440
  v_cvt_pk_bf16_f32 v41, v42, v43
  v_mfma_f32_16x16x32_bf16 a[32:35], a[176:179], v[64:67], a[32:35]
  v_exp_f32 v48, v48
  v_mfma_f32_16x16x32_bf16 a[32:35], a[180:183], v[96:99], a[32:35]
  ds_read_b64_tr_b16 a[168:169], v221 offset:49152
  v_mfma_f32_16x16x32_bf16 a[36:39], a[180:183], v[104:107], a[36:39]
  v_exp_f32 v49, v49
  v_mfma_f32_16x16x32_bf16 a[36:39], a[176:179], v[72:75], a[36:39]
  ds_read_b64_tr_b16 a[170:171], v221 offset:53248
  v_cvt_pk_bf16_f32 v48, v48, v49
  v_mfma_f32_16x16x32_bf16 a[40:43], a[176:179], v[80:83], a[40:43]
  v_exp_f32 v50, v50
  v_mfma_f32_16x16x32_bf16 a[40:43], a[180:183], v[112:115], a[40:43]
  ds_read_b64_tr_b16 a[172:173], v221 offset:57344
  v_mfma_f32_16x16x32_bf16 a[44:47], a[180:183], v[120:123], a[44:47]
  s_waitcnt lgkmcnt(7)
  v_exp_f32 v51, v51
  v_mfma_f32_16x16x32_bf16 a[44:47], a[176:179], v[88:91], a[44:47]
  ds_read_b64_tr_b16 a[174:175], v221 offset:61440
  v_cvt_pk_bf16_f32 v49, v50, v51
  v_mfma_f32_16x16x32_bf16 a[48:51], a[184:187], v[64:67], a[48:51]
  v_exp_f32 v56, v56
  v_mfma_f32_16x16x32_bf16 a[48:51], a[188:191], v[96:99], a[48:51]
  ds_read_b64_tr_b16 a[176:177], v222 offset:49152
  v_mfma_f32_16x16x32_bf16 a[52:55], a[188:191], v[104:107], a[52:55]
  v_exp_f32 v57, v57
  v_mfma_f32_16x16x32_bf16 a[52:55], a[184:187], v[72:75], a[52:55]
  ds_read_b64_tr_b16 a[178:179], v222 offset:53248
  v_cvt_pk_bf16_f32 v56, v56, v57
  v_mfma_f32_16x16x32_bf16 a[56:59], a[184:187], v[80:83], a[56:59]
  v_exp_f32 v58, v58
  v_mfma_f32_16x16x32_bf16 a[56:59], a[188:191], v[112:115], a[56:59]
  ds_read_b64_tr_b16 a[180:181], v222 offset:57344
  v_mfma_f32_16x16x32_bf16 a[60:63], a[188:191], v[120:123], a[60:63]
  s_waitcnt lgkmcnt(7)
  v_exp_f32 v59, v59
  v_mfma_f32_16x16x32_bf16 a[60:63], a[184:187], v[88:91], a[60:63]
  ds_read_b64_tr_b16 a[182:183], v222 offset:61440
  v_cvt_pk_bf16_f32 v57, v58, v59
  v_mfma_f32_16x16x32_bf16 a[64:67], a[160:163], v[64:67], a[64:67]
  v_exp_f32 v36, v36
  v_mfma_f32_16x16x32_bf16 a[64:67], a[164:167], v[96:99], a[64:67]
  ds_read_b64_tr_b16 a[184:185], v223 offset:49152
  ds_read_b32 v248, v247
  v_mfma_f32_16x16x32_bf16 a[68:71], a[164:167], v[104:107], a[68:71]
  v_exp_f32 v37, v37
  v_mfma_f32_16x16x32_bf16 a[68:71], a[160:163], v[72:75], a[68:71]
  ds_read_b64_tr_b16 a[186:187], v223 offset:53248
  v_cvt_pk_bf16_f32 v34, v36, v37
  v_mfma_f32_16x16x32_bf16 a[72:75], a[160:163], v[80:83], a[72:75]
  v_exp_f32 v38, v38
  v_mfma_f32_16x16x32_bf16 a[72:75], a[164:167], v[112:115], a[72:75]
  ds_read_b64_tr_b16 a[188:189], v223 offset:57344
  v_mfma_f32_16x16x32_bf16 a[76:79], a[164:167], v[120:123], a[76:79]
  s_waitcnt lgkmcnt(8)
  v_exp_f32 v39, v39
  v_mfma_f32_16x16x32_bf16 a[76:79], a[160:163], v[88:91], a[76:79]
  ds_read_b64_tr_b16 a[190:191], v223 offset:61440
  v_cvt_pk_bf16_f32 v35, v38, v39
  v_mfma_f32_16x16x32_bf16 a[80:83], a[168:171], v[64:67], a[80:83]
  s_waitcnt lgkmcnt(3)
  v_exp_f32 v44, v44
  v_mfma_f32_16x16x32_bf16 a[80:83], a[172:175], v[96:99], a[80:83]
  v_cmp_lt_u32 vcc, v248, v245
  v_mfma_f32_16x16x32_bf16 a[84:87], a[172:175], v[104:107], a[84:87]
  s_cbranch_vccnz attn_wait3
attn_on3:
  v_exp_f32 v45, v45
  v_mfma_f32_16x16x32_bf16 a[84:87], a[168:171], v[72:75], a[84:87]
  ds_read_b128 a[128:131], v212 offset:16384
  v_cvt_pk_bf16_f32 v42, v44, v45
  v_mfma_f32_16x16x32_bf16 a[88:91], a[168:171], v[80:83], a[88:91]
  v_exp_f32 v46, v46
  v_mfma_f32_16x16x32_bf16 a[88:91], a[172:175], v[112:115], a[88:91]
  ds_read_b128 a[132:135], v213 offset:16384
  v_mfma_f32_16x16x32_bf16 a[92:95], a[172:175], v[120:123], a[92:95]
  v_exp_f32 v47, v47
  v_mfma_f32_16x16x32_bf16 a[92:95], a[168:171], v[88:91], a[92:95]
  ds_read_b128 a[136:139], v214 offset:16384
  v_cvt_pk_bf16_f32 v43, v46, v47
  v_mfma_f32_16x16x32_bf16 a[96:99], a[176:179], v[64:67], a[96:99]
  v_exp_f32 v52, v52
  v_mfma_f32_16x16x32_bf16 a[96:99], a[180:183], v[96:99], a[96:99]
  ds_read_b128 a[140:143], v215 offset:16384
  buffer_load_dwordx4 a[224:227], v243, s[24:27], s38 offen sc1
  s_add_u32 s38, s38, 4096
  v_mfma_f32_16x16x32_bf16 a[100:103], a[180:183], v[104:107], a[100:103]
  v_exp_f32 v53, v53
  v_mfma_f32_16x16x32_bf16 a[100:103], a[176:179], v[72:75], a[100:103]
  v_cvt_pk_bf16_f32 v50, v52, v53
  v_mfma_f32_16x16x32_bf16 a[104:107], a[176:179], v[80:83], a[104:107]
  v_exp_f32 v54, v54
  v_mfma_f32_16x16x32_bf16 a[104:107], a[180:183], v[112:115], a[104:107]
  v_mfma_f32_16x16x32_bf16 a[108:111], a[180:183], v[120:123], a[108:111]
  s_waitcnt lgkmcnt(4)
  v_exp_f32 v55, v55
  v_mfma_f32_16x16x32_bf16 a[108:111], a[176:179], v[88:91], a[108:111]
  v_cvt_pk_bf16_f32 v51, v54, v55
  v_mfma_f32_16x16x32_bf16 a[112:115], a[184:187], v[64:67], a[112:115]
  v_exp_f32 v60, v60
  v_mfma_f32_16x16x32_bf16 a[112:115], a[188:191], v[96:99], a[112:115]
  v_mfma_f32_16x16x32_bf16 a[116:119], a[188:191], v[104:107], a[116:119]
  v_exp_f32 v61, v61
  v_mfma_f32_16x16x32_bf16 a[116:119], a[184:187], v[72:75], a[116:119]
  v_cvt_pk_bf16_f32 v58, v60, v61
  v_mfma_f32_16x16x32_bf16 a[120:123], a[184:187], v[80:83], a[120:123]
  v_exp_f32 v62, v62
  v_mfma_f32_16x16x32_bf16 a[120:123], a[188:191], v[112:115], a[120:123]
  v_mfma_f32_16x16x32_bf16 a[124:127], a[188:191], v[120:123], a[124:127]
  s_waitcnt lgkmcnt(0)
  v_exp_f32 v63, v63
  v_mfma_f32_16x16x32_bf16 a[124:127], a[184:187], v[88:91], a[124:127]
  v_cvt_pk_bf16_f32 v59, v62, v63
  v_mfma_f32_16x16x32_bf16 v[64:67], a[128:131], v[128:131], v[192:195]
  s_add_u32 m0, s28, 98304
  v_mfma_f32_16x16x32_bf16 v[64:67], a[132:135], v[132:135], v[64:67]
  ds_read_b128 a[144:147], v212 offset:20480
  v_mfma_f32_16x16x32_bf16 v[64:67], a[136:139], v[136:139], v[64:67]
  buffer_load_dwordx4 v236, s[16:19], s29 offen offset:0 lds
  v_mfma_f32_16x16x32_bf16 v[64:67], a[140:143], v[140:143], v[64:67]
  ds_read_b128 a[148:151], v213 offset:20480
  v_mfma_f32_16x16x32_bf16 v[72:75], a[140:143], v[156:159], v[196:199]
  v_mfma_f32_16x16x32_bf16 v[72:75], a[136:139], v[152:155], v[72:75]
  ds_read_b128 a[152:155], v214 offset:20480
  v_mfma_f32_16x16x32_bf16 v[72:75], a[132:135], v[148:151], v[72:75]
  buffer_load_dwordx4 v237, s[16:19], s29 offen offset:1024 lds
  v_mfma_f32_16x16x32_bf16 v[72:75], a[128:131], v[144:147], v[72:75]
  ds_read_b128 a[156:159], v215 offset:20480
  v_mfma_f32_16x16x32_bf16 v[80:83], a[128:131], v[160:163], v[200:203]
  v_exp_f32 v64, v64
  v_mfma_f32_16x16x32_bf16 v[80:83], a[132:135], v[164:167], v[80:83]
  v_mfma_f32_16x16x32_bf16 v[80:83], a[136:139], v[168:171], v[80:83]
  v_exp_f32 v65, v65
  v_mfma_f32_16x16x32_bf16 v[80:83], a[140:143], v[172:175], v[80:83]
  v_cvt_pk_bf16_f32 v64, v64, v65
  v_mfma_f32_16x16x32_bf16 v[88:91], a[140:143], v[188:191], v[204:207]
  v_exp_f32 v66, v66
  v_mfma_f32_16x16x32_bf16 v[88:91], a[136:139], v[184:187], v[88:91]
  buffer_load_dwordx4 v236, s[16:19], s29 offen offset:2048 lds
  v_mfma_f32_16x16x32_bf16 v[88:91], a[132:135], v[180:183], v[88:91]
  s_waitcnt lgkmcnt(0)
  v_exp_f32 v67, v67
  v_mfma_f32_16x16x32_bf16 v[88:91], a[128:131], v[176:179], v[88:91]
  v_cvt_pk_bf16_f32 v65, v66, v67
  v_mfma_f32_16x16x32_bf16 v[68:71], a[144:147], v[128:131], v[192:195]
  v_exp_f32 v72, v72
  v_mfma_f32_16x16x32_bf16 v[68:71], a[148:151], v[132:135], v[68:71]
  ds_read_b128 a[128:131], v212 offset:24576
  v_mfma_f32_16x16x32_bf16 v[68:71], a[152:155], v[136:139], v[68:71]
  v_exp_f32 v73, v73
  v_mfma_f32_16x16x32_bf16 v[68:71], a[156:159], v[140:143], v[68:71]
  ds_read_b128 a[132:135], v213 offset:24576
  v_cvt_pk_bf16_f32 v72, v72, v73
  v_mfma_f32_16x16x32_bf16 v[76:79], a[156:159], v[156:159], v[196:199]
  v_exp_f32 v74, v74
  v_mfma_f32_16x16x32_bf16 v[76:79], a[152:155], v[152:155], v[76:79]
  ds_read_b128 a[136:139], v214 offset:24576
  v_mfma_f32_16x16x32_bf16 v[76:79], a[148:151], v[148:151], v[76:79]
  v_exp_f32 v75, v75
  v_mfma_f32_16x16x32_bf16 v[76:79], a[144:147], v[144:147], v[76:79]
  ds_read_b128 a[140:143], v215 offset:24576
  v_cvt_pk_bf16_f32 v73, v74, v75
  v_mfma_f32_16x16x32_bf16 v[84:87], a[144:147], v[160:163], v[200:203]
  v_exp_f32 v80, v80
  v_mfma_f32_16x16x32_bf16 v[84:87], a[148:151], v[164:167], v[84:87]
  buffer_load_dwordx4 v237, s[16:19], s29 offen offset:3072 lds
  v_mfma_f32_16x16x32_bf16 v[84:87], a[152:155], v[168:171], v[84:87]
  s_add_u32 s29, s29, 16384
  v_exp_f32 v81, v81
  v_mfma_f32_16x16x32_bf16 v[84:87], a[156:159], v[172:175], v[84:87]
  v_cvt_pk_bf16_f32 v80, v80, v81
  v_mfma_f32_16x16x32_bf16 v[92:95], a[156:159], v[188:191], v[204:207]
  s_add_u32 m0, s28, 49152
  v_exp_f32 v82, v82
  v_mfma_f32_16x16x32_bf16 v[92:95], a[152:155], v[184:187], v[92:95]
  buffer_load_dwordx4 v232, s[12:15], s29 offen offset:0 lds
  v_mfma_f32_16x16x32_bf16 v[92:95], a[148:151], v[180:183], v[92:95]
  s_waitcnt lgkmcnt(0)
  v_exp_f32 v83, v83
  v_mfma_f32_16x16x32_bf16 v[92:95], a[144:147], v[176:179], v[92:95]
  v_cvt_pk_bf16_f32 v81, v82, v83
  v_mfma_f32_16x16x32_bf16 v[96:99], a[128:131], v[128:131], v[192:195]
  v_exp_f32 v88, v88
  v_mfma_f32_16x16x32_bf16 v[96:99], a[132:135], v[132:135], v[96:99]
  ds_read_b128 a[144:147], v212 offset:28672
  v_mfma_f32_16x16x32_bf16 v[96:99], a[136:139], v[136:139], v[96:99]
  v_exp_f32 v89, v89
  v_mfma_f32_16x16x32_bf16 v[96:99], a[140:143], v[140:143], v[96:99]
  ds_read_b128 a[148:151], v213 offset:28672
  v_cvt_pk_bf16_f32 v88, v88, v89
  v_mfma_f32_16x16x32_bf16 v[104:107], a[140:143], v[156:159], v[196:199]
  v_exp_f32 v90, v90
  v_mfma_f32_16x16x32_bf16 v[104:107], a[136:139], v[152:155], v[104:107]
  ds_read_b128 a[152:155], v214 offset:28672
  v_mfma_f32_16x16x32_bf16 v[104:107], a[132:135], v[148:151], v[104:107]
  v_exp_f32 v91, v91
  v_mfma_f32_16x16x32_bf16 v[104:107], a[128:131], v[144:147], v[104:107]
  ds_read_b128 a[156:159], v215 offset:28672
  v_cvt_pk_bf16_f32 v89, v90, v91
  v_mfma_f32_16x16x32_bf16 v[112:115], a[128:131], v[160:163], v[200:203]
  v_exp_f32 v68, v68
  v_mfma_f32_16x16x32_bf16 v[112:115], a[132:135], v[164:167], v[112:115]
  buffer_load_dwordx4 v233, s[12:15], s29 offen offset:1024 lds
  v_mfma_f32_16x16x32_bf16 v[112:115], a[136:139], v[168:171], v[112:115]
  v_exp_f32 v69, v69
  v_mfma_f32_16x16x32_bf16 v[112:115], a[140:143], v[172:175], v[112:115]
  v_cvt_pk_bf16_f32 v66, v68, v69
  v_mfma_f32_16x16x32_bf16 v[120:123], a[140:143], v[188:191], v[204:207]
  v_exp_f32 v70, v70
  v_mfma_f32_16x16x32_bf16 v[120:123], a[136:139], v[184:187], v[120:123]
  buffer_load_dwordx4 v234, s[12:15], s29 offen offset:2048 lds
  v_mfma_f32_16x16x32_bf16 v[120:123], a[132:135], v[180:183], v[120:123]
  s_waitcnt lgkmcnt(0)
  v_exp_f32 v71, v71
  v_mfma_f32_16x16x32_bf16 v[120:123], a[128:131], v[176:179], v[120:123]
  v_cvt_pk_bf16_f32 v67, v70, v71
  v_mfma_f32_16x16x32_bf16 v[100:103], a[144:147], v[128:131], v[192:195]
  v_exp_f32 v76, v76
  v_mfma_f32_16x16x32_bf16 v[100:103], a[148:151], v[132:135], v[100:103]
  ds_read_b64_tr_b16 a[160:161], v216 offset:0
  v_mfma_f32_16x16x32_bf16 v[100:103], a[152:155], v[136:139], v[100:103]
  v_exp_f32 v77, v77
  v_mfma_f32_16x16x32_bf16 v[100:103], a[156:159], v[140:143], v[100:103]
  ds_read_b64_tr_b16 a[162:163], v216 offset:4096
  v_cvt_pk_bf16_f32 v74, v76, v77
  v_mfma_f32_16x16x32_bf16 v[108:111], a[156:159], v[156:159], v[196:199]
  v_exp_f32 v78, v78
  v_mfma_f32_16x16x32_bf16 v[108:111], a[152:155], v[152:155], v[108:111]
  ds_read_b64_tr_b16 a[164:165], v216 offset:8192
  buffer_load_dwordx4 v235, s[12:15], s29 offen offset:3072 lds
  v_mfma_f32_16x16x32_bf16 v[108:111], a[148:151], v[148:151], v[108:111]
  v_exp_f32 v79, v79
  v_mfma_f32_16x16x32_bf16 v[108:111], a[144:147], v[144:147], v[108:111]
  ds_read_b64_tr_b16 a[166:167], v216 offset:12288
  v_cvt_pk_bf16_f32 v75, v78, v79
  v_mfma_f32_16x16x32_bf16 v[116:119], a[144:147], v[160:163], v[200:203]
  v_exp_f32 v84, v84
  v_mfma_f32_16x16x32_bf16 v[116:119], a[148:151], v[164:167], v[116:119]
  ds_read_b64_tr_b16 a[168:169], v217 offset:0
  s_add_u32 m0, s50, 5120
  v_mfma_f32_16x16x32_bf16 v[116:119], a[152:155], v[168:171], v[116:119]
  v_exp_f32 v85, v85
  v_mfma_f32_16x16x32_bf16 v[116:119], a[156:159], v[172:175], v[116:119]
  ds_read_b64_tr_b16 a[170:171], v217 offset:4096
  v_cvt_pk_bf16_f32 v82, v84, v85
  v_mfma_f32_16x16x32_bf16 v[124:127], a[156:159], v[188:191], v[204:207]
  v_exp_f32 v86, v86
  v_mfma_f32_16x16x32_bf16 v[124:127], a[152:155], v[184:187], v[124:127]
  ds_read_b64_tr_b16 a[172:173], v217 offset:8192
  buffer_load_dwordx4 v253, s[44:47], s35 offen lds
  s_add_u32 s35, s35, 221184
  v_mfma_f32_16x16x32_bf16 v[124:127], a[148:151], v[180:183], v[124:127]
  v_exp_f32 v87, v87
  v_mfma_f32_16x16x32_bf16 v[124:127], a[144:147], v[176:179], v[124:127]
  ds_read_b64_tr_b16 a[174:175], v217 offset:12288
  v_cvt_pk_bf16_f32 v83, v86, v87
  v_mfma_f32_16x16x32_bf16 a[192:195], a[208:211], v[0:3], a[192:195]
  v_exp_f32 v92, v92
  v_mfma_f32_16x16x32_bf16 a[192:195], a[208:211], v[32:35], a[192:195]
  ds_read_b64_tr_b16 a[176:177], v218 offset:0
  v_add_u32 v245, 1, v245
  v_mfma_f32_16x16x32_bf16 a[196:199], a[208:211], v[8:11], a[196:199]
  v_exp_f32 v93, v93
  v_mfma_f32_16x16x32_bf16 a[196:199], a[208:211], v[40:43], a[196:199]
  ds_read_b64_tr_b16 a[178:179], v218 offset:4096
  v_cvt_pk_bf16_f32 v90, v92, v93
  v_mfma_f32_16x16x32_bf16 a[200:203], a[208:211], v[16:19], a[200:203]
  s_waitcnt vmcnt(11)
  v_exp_f32 v94, v94
  v_mfma_f32_16x16x32_bf16 a[200:203], a[208:211], v[48:51], a[200:203]
  ds_read_b64_tr_b16 a[180:181], v218 offset:8192
  ds_write_b32 v246, v245
  v_mfma_f32_16x16x32_bf16 a[204:207], a[208:211], v[24:27], a[204:207]
  s_waitcnt lgkmcnt(8)
  v_exp_f32 v95, v95
  v_mfma_f32_16x16x32_bf16 a[204:207], a[208:211], v[56:59], a[204:207]
  ds_read_b64_tr_b16 a[182:183], v218 offset:12288
  v_cvt_pk_bf16_f32 v91, v94, v95
  v_mfma_f32_16x16x32_bf16 a[0:3], a[160:163], v[0:3], a[0:3]
  v_exp_f32 v96, v96
  v_mfma_f32_16x16x32_bf16 a[0:3], a[164:167], v[32:35], a[0:3]
  ds_read_b64_tr_b16 a[184:185], v219 offset:0
  v_mfma_f32_16x16x32_bf16 a[4:7], a[164:167], v[40:43], a[4:7]
  v_exp_f32 v97, v97
  v_mfma_f32_16x16x32_bf16 a[4:7], a[160:163], v[8:11], a[4:7]
  ds_read_b64_tr_b16 a[186:187], v219 offset:4096
  v_cvt_pk_bf16_f32 v96, v96, v97
  v_mfma_f32_16x16x32_bf16 a[8:11], a[160:163], v[16:19], a[8:11]
  v_exp_f32 v98, v98
  v_mfma_f32_16x16x32_bf16 a[8:11], a[164:167], v[48:51], a[8:11]
  ds_read_b64_tr_b16 a[188:189], v219 offset:8192
  v_mfma_f32_16x16x32_bf16 a[12:15], a[164:167], v[56:59], a[12:15]
  s_waitcnt lgkmcnt(8)
  v_exp_f32 v99, v99
  v_mfma_f32_16x16x32_bf16 a[12:15], a[160:163], v[24:27], a[12:15]
  ds_read_b64_tr_b16 a[190:191], v219 offset:12288
  v_cvt_pk_bf16_f32 v97, v98, v99
  v_mfma_f32_16x16x32_bf16 a[16:19], a[168:171], v[0:3], a[16:19]
  v_exp_f32 v104, v104
  v_mfma_f32_16x16x32_bf16 a[16:19], a[172:175], v[32:35], a[16:19]
  ds_read_b64_tr_b16 a[160:161], v220 offset:0
  v_mfma_f32_16x16x32_bf16 a[20:23], a[172:175], v[40:43], a[20:23]
  v_exp_f32 v105, v105
  v_mfma_f32_16x16x32_bf16 a[20:23], a[168:171], v[8:11], a[20:23]
  ds_read_b64_tr_b16 a[162:163], v220 offset:4096
  v_cvt_pk_bf16_f32 v104, v104, v105
  v_mfma_f32_16x16x32_bf16 a[24:27], a[168:171], v[16:19], a[24:27]
  v_exp_f32 v106, v106
  v_mfma_f32_16x16x32_bf16 a[24:27], a[172:175], v[48:51], a[24:27]
  ds_read_b64_tr_b16 a[164:165], v220 offset:8192
  v_mfma_f32_16x16x32_bf16 a[28:31], a[172:175], v[56:59], a[28:31]
  s_waitcnt lgkmcnt(7)
  v_exp_f32 v107, v107
  v_mfma_f32_16x16x32_bf16 a[28:31], a[168:171], v[24:27], a[28:31]
  ds_read_b64_tr_b16 a[166:167], v220 offset:12288
  v_cvt_pk_bf16_f32 v105, v106, v107
  v_mfma_f32_16x16x32_bf16 a[32:35], a[176:179], v[0:3], a[32:35]
  v_exp_f32 v112, v112
  v_mfma_f32_16x16x32_bf16 a[32:35], a[180:183], v[32:35], a[32:35]
  ds_read_b64_tr_b16 a[168:169], v221 offset:0
  v_mfma_f32_16x16x32_bf16 a[36:39], a[180:183], v[40:43], a[36:39]
  v_exp_f32 v113, v113
  v_mfma_f32_16x16x32_bf16 a[36:39], a[176:179], v[8:11], a[36:39]
  ds_read_b64_tr_b16 a[170:171], v221 offset:4096
  v_cvt_pk_bf16_f32 v112, v112, v113
  v_mfma_f32_16x16x32_bf16 a[40:43], a[176:179], v[16:19], a[40:43]
  v_exp_f32 v114, v114
  v_mfma_f32_16x16x32_bf16 a[40:43], a[180:183], v[48:51], a[40:43]
  ds_read_b64_tr_b16 a[172:173], v221 offset:8192
  v_mfma_f32_16x16x32_bf16 a[44:47], a[180:183], v[56:59], a[44:47]
  s_waitcnt lgkmcnt(7)
  v_exp_f32 v115, v115
  v_mfma_f32_16x16x32_bf16 a[44:47], a[176:179], v[24:27], a[44:47]
  ds_read_b64_tr_b16 a[174:175], v221 offset:12288
  v_cvt_pk_bf16_f32 v113, v114, v115
  v_mfma_f32_16x16x32_bf16 a[48:51], a[184:187], v[0:3], a[48:51]
  v_exp_f32 v120, v120
  v_mfma_f32_16x16x32_bf16 a[48:51], a[188:191], v[32:35], a[48:51]
  ds_read_b64_tr_b16 a[176:177], v222 offset:0
  v_mfma_f32_16x16x32_bf16 a[52:55], a[188:191], v[40:43], a[52:55]
  v_exp_f32 v121, v121
  v_mfma_f32_16x16x32_bf16 a[52:55], a[184:187], v[8:11], a[52:55]
  ds_read_b64_tr_b16 a[178:179], v222 offset:4096
  v_cvt_pk_bf16_f32 v120, v120, v121
  v_mfma_f32_16x16x32_bf16 a[56:59], a[184:187], v[16:19], a[56:59]
  v_exp_f32 v122, v122
  v_mfma_f32_16x16x32_bf16 a[56:59], a[188:191], v[48:51], a[56:59]
  ds_read_b64_tr_b16 a[180:181], v222 offset:8192
  v_mfma_f32_16x16x32_bf16 a[60:63], a[188:191], v[56:59], a[60:63]
  s_waitcnt lgkmcnt(7)
  v_exp_f32 v123, v123
  v_mfma_f32_16x16x32_bf16 a[60:63], a[184:187], v[24:27], a[60:63]
  ds_read_b64_tr_b16 a[182:183], v222 offset:12288
  v_cvt_pk_bf16_f32 v121, v122, v123
  v_mfma_f32_16x16x32_bf16 a[64:67], a[160:163], v[0:3], a[64:67]
  v_exp_f32 v100, v100
  v_mfma_f32_16x16x32_bf16 a[64:67], a[164:167], v[32:35], a[64:67]
  ds_read_b64_tr_b16 a[184:185], v223 offset:0
  ds_read_b32 v248, v247
  v_mfma_f32_16x16x32_bf16 a[68:71], a[164:167], v[40:43], a[68:71]
  v_exp_f32 v101, v101
  v_mfma_f32_16x16x32_bf16 a[68:71], a[160:163], v[8:11], a[68:71]
  ds_read_b64_tr_b16 a[186:187], v223 offset:4096
  v_cvt_pk_bf16_f32 v98, v100, v101
  v_mfma_f32_16x16x32_bf16 a[72:75], a[160:163], v[16:19], a[72:75]
  v_exp_f32 v102, v102
  v_mfma_f32_16x16x32_bf16 a[72:75], a[164:167], v[48:51], a[72:75]
  ds_read_b64_tr_b16 a[188:189], v223 offset:8192
  v_mfma_f32_16x16x32_bf16 a[76:79], a[164:167], v[56:59], a[76:79]
  s_waitcnt lgkmcnt(8)
  v_exp_f32 v103, v103
  v_mfma_f32_16x16x32_bf16 a[76:79], a[160:163], v[24:27], a[76:79]
  ds_read_b64_tr_b16 a[190:191], v223 offset:12288
  v_cvt_pk_bf16_f32 v99, v102, v103
  v_mfma_f32_16x16x32_bf16 a[80:83], a[168:171], v[0:3], a[80:83]
  s_waitcnt lgkmcnt(3)
  v_exp_f32 v108, v108
  v_mfma_f32_16x16x32_bf16 a[80:83], a[172:175], v[32:35], a[80:83]
  v_cmp_lt_u32 vcc, v248, v245
  v_mfma_f32_16x16x32_bf16 a[84:87], a[172:175], v[40:43], a[84:87]
  s_cbranch_vccnz attn_wait4
attn_on4:
  v_exp_f32 v109, v109
  v_mfma_f32_16x16x32_bf16 a[84:87], a[168:171], v[8:11], a[84:87]
  ds_read_b128 a[128:131], v212 offset:32768
  v_cvt_pk_bf16_f32 v106, v108, v109
  v_mfma_f32_16x16x32_bf16 a[88:91], a[168:171], v[16:19], a[88:91]
  v_exp_f32 v110, v110
  v_mfma_f32_16x16x32_bf16 a[88:91], a[172:175], v[48:51], a[88:91]
  ds_read_b128 a[132:135], v213 offset:32768
  v_mfma_f32_16x16x32_bf16 a[92:95], a[172:175], v[56:59], a[92:95]
  v_exp_f32 v111, v111
  v_mfma_f32_16x16x32_bf16 a[92:95], a[168:171], v[24:27], a[92:95]
  ds_read_b128 a[136:139], v214 offset:32768
  v_cvt_pk_bf16_f32 v107, v110, v111
  v_mfma_f32_16x16x32_bf16 a[96:99], a[176:179], v[0:3], a[96:99]
  v_exp_f32 v116, v116
  v_mfma_f32_16x16x32_bf16 a[96:99], a[180:183], v[32:35], a[96:99]
  ds_read_b128 a[140:143], v215 offset:32768
  buffer_load_dwordx4 a[228:231], v243, s[24:27], s38 offen sc1
  s_add_u32 s38, s38, 4096
  v_mfma_f32_16x16x32_bf16 a[100:103], a[180:183], v[40:43], a[100:103]
  v_exp_f32 v117, v117
  v_mfma_f32_16x16x32_bf16 a[100:103], a[176:179], v[8:11], a[100:103]
  v_cvt_pk_bf16_f32 v114, v116, v117
  v_mfma_f32_16x16x32_bf16 a[104:107], a[176:179], v[16:19], a[104:107]
  v_exp_f32 v118, v118
  v_mfma_f32_16x16x32_bf16 a[104:107], a[180:183], v[48:51], a[104:107]
  v_mfma_f32_16x16x32_bf16 a[108:111], a[180:183], v[56:59], a[108:111]
  s_waitcnt lgkmcnt(4)
  v_exp_f32 v119, v119
  v_mfma_f32_16x16x32_bf16 a[108:111], a[176:179], v[24:27], a[108:111]
  v_cvt_pk_bf16_f32 v115, v118, v119
  v_mfma_f32_16x16x32_bf16 a[112:115], a[184:187], v[0:3], a[112:115]
  v_exp_f32 v124, v124
  v_mfma_f32_16x16x32_bf16 a[112:115], a[188:191], v[32:35], a[112:115]
  v_mfma_f32_16x16x32_bf16 a[116:119], a[188:191], v[40:43], a[116:119]
  v_exp_f32 v125, v125
  v_mfma_f32_16x16x32_bf16 a[116:119], a[184:187], v[8:11], a[116:119]
  v_cvt_pk_bf16_f32 v122, v124, v125
  v_mfma_f32_16x16x32_bf16 a[120:123], a[184:187], v[16:19], a[120:123]
  v_exp_f32 v126, v126
  v_mfma_f32_16x16x32_bf16 a[120:123], a[188:191], v[48:51], a[120:123]
  v_mfma_f32_16x16x32_bf16 a[124:127], a[188:191], v[56:59], a[124:127]
  s_waitcnt lgkmcnt(0)
  v_exp_f32 v127, v127
  v_mfma_f32_16x16x32_bf16 a[124:127], a[184:187], v[24:27], a[124:127]
  v_cvt_pk_bf16_f32 v123, v126, v127
  v_mfma_f32_16x16x32_bf16 v[0:3], a[128:131], v[128:131], v[192:195]
  s_add_u32 m0, s28, 114688
  s_mov_b32 s20, s88
  s_mov_b32 s21, s89
  v_mfma_f32_16x16x32_bf16 v[0:3], a[132:135], v[132:135], v[0:3]
  ds_read_b128 a[144:147], v212 offset:36864
  s_mov_b32 s22, 5242880
  s_mov_b32 s23, 0x20000
  v_lshrrev_b32 v208, 4, v242
  v_mfma_f32_16x16x32_bf16 v[0:3], a[136:139], v[136:139], v[0:3]
  buffer_load_dwordx4 v236, s[16:19], s29 offen offset:0 lds
  v_mfma_f32_16x16x32_bf16 v[0:3], a[140:143], v[140:143], v[0:3]
  ds_read_b128 a[148:151], v213 offset:36864
  v_and_b32 v209, 1, v208
  v_mfma_f32_16x16x32_bf16 v[8:11], a[140:143], v[156:159], v[196:199]
  v_lshrrev_b32 v208, 1, v208
  v_mul_u32_u24 v208, 0x500, v208
  v_mfma_f32_16x16x32_bf16 v[8:11], a[136:139], v[152:155], v[8:11]
  ds_read_b128 a[152:155], v214 offset:36864
  v_lshl_add_u32 v208, v209, 4, v208
  v_mfma_f32_16x16x32_bf16 v[8:11], a[132:135], v[148:151], v[8:11]
  buffer_load_dwordx4 v237, s[16:19], s29 offen offset:1024 lds
  v_mfma_f32_16x16x32_bf16 v[8:11], a[128:131], v[144:147], v[8:11]
  ds_read_b128 a[156:159], v215 offset:36864
  v_lshrrev_b32 v209, 4, v242
  v_mfma_f32_16x16x32_bf16 v[16:19], a[128:131], v[160:163], v[200:203]
  v_exp_f32 v0, v0
  v_mfma_f32_16x16x32_bf16 v[16:19], a[132:135], v[164:167], v[16:19]
  v_lshrrev_b32 v210, 5, v209
  v_lshlrev_b32 v210, 30, v210
  v_mfma_f32_16x16x32_bf16 v[16:19], a[136:139], v[168:171], v[16:19]
  v_exp_f32 v1, v1
  v_mfma_f32_16x16x32_bf16 v[16:19], a[140:143], v[172:175], v[16:19]
  v_cvt_pk_bf16_f32 v0, v0, v1
  v_or_b32 v210, v210, v208
  v_mfma_f32_16x16x32_bf16 v[24:27], a[140:143], v[188:191], v[204:207]
  v_exp_f32 v2, v2
  v_mfma_f32_16x16x32_bf16 v[24:27], a[136:139], v[184:187], v[24:27]
  buffer_load_dwordx4 v236, s[16:19], s29 offen offset:2048 lds
  v_mfma_f32_16x16x32_bf16 v[24:27], a[132:135], v[180:183], v[24:27]
  s_waitcnt lgkmcnt(0)
  v_exp_f32 v3, v3
  v_mfma_f32_16x16x32_bf16 v[24:27], a[128:131], v[176:179], v[24:27]
  v_cvt_pk_bf16_f32 v1, v2, v3
  v_bfe_u32 v211, v209, 2, 4
  v_mfma_f32_16x16x32_bf16 v[4:7], a[144:147], v[128:131], v[192:195]
  v_exp_f32 v8, v8
  v_mfma_f32_16x16x32_bf16 v[4:7], a[148:151], v[132:135], v[4:7]
  ds_read_b128 a[128:131], v212 offset:40960
  v_and_b32 v209, 3, v209
  v_mfma_f32_16x16x32_bf16 v[4:7], a[152:155], v[136:139], v[4:7]
  v_exp_f32 v9, v9
  v_mfma_f32_16x16x32_bf16 v[4:7], a[156:159], v[140:143], v[4:7]
  ds_read_b128 a[132:135], v213 offset:40960
  v_cvt_pk_bf16_f32 v8, v8, v9
  v_mfma_f32_16x16x32_bf16 v[12:15], a[156:159], v[156:159], v[196:199]
  v_exp_f32 v10, v10
  v_mfma_f32_16x16x32_bf16 v[12:15], a[152:155], v[152:155], v[12:15]
  ds_read_b128 a[136:139], v214 offset:40960
  v_lshlrev_b32 v209, 3, v209
  v_mfma_f32_16x16x32_bf16 v[12:15], a[148:151], v[148:151], v[12:15]
  v_exp_f32 v11, v11
  v_mfma_f32_16x16x32_bf16 v[12:15], a[144:147], v[144:147], v[12:15]
  ds_read_b128 a[140:143], v215 offset:40960
  v_cvt_pk_bf16_f32 v9, v10, v11
  v_mfma_f32_16x16x32_bf16 v[20:23], a[144:147], v[160:163], v[200:203]
  v_exp_f32 v16, v16
  v_mfma_f32_16x16x32_bf16 v[20:23], a[148:151], v[164:167], v[20:23]
  buffer_load_dwordx4 v237, s[16:19], s29 offen offset:3072 lds
  v_mfma_f32_16x16x32_bf16 v[20:23], a[152:155], v[168:171], v[20:23]
  s_add_u32 s29, s29, 16384
  v_exp_f32 v17, v17
  v_mfma_f32_16x16x32_bf16 v[20:23], a[156:159], v[172:175], v[20:23]
  v_cvt_pk_bf16_f32 v16, v16, v17
  v_lshl_add_u32 v209, v211, 5, v209
  v_mfma_f32_16x16x32_bf16 v[28:31], a[156:159], v[188:191], v[204:207]
  s_add_u32 m0, s28, 0
  v_exp_f32 v18, v18
  v_mfma_f32_16x16x32_bf16 v[28:31], a[152:155], v[184:187], v[28:31]
  buffer_load_dwordx4 v232, s[12:15], s29 offen offset:0 lds
  v_mfma_f32_16x16x32_bf16 v[28:31], a[148:151], v[180:183], v[28:31]
  s_waitcnt lgkmcnt(0)
  v_exp_f32 v19, v19
  v_mfma_f32_16x16x32_bf16 v[28:31], a[144:147], v[176:179], v[28:31]
  v_cvt_pk_bf16_f32 v17, v18, v19
  v_add_u32 v209, s50, v209
  v_mfma_f32_16x16x32_bf16 v[32:35], a[128:131], v[128:131], v[192:195]
  s_and_b32 s39, s2, 1
  s_lshl_b32 s39, s39, 2
  s_add_u32 s39, s39, s3
  v_exp_f32 v24, v24
  v_mfma_f32_16x16x32_bf16 v[32:35], a[132:135], v[132:135], v[32:35]
  ds_read_b128 a[144:147], v212 offset:45056
  s_lshr_b32 s31, s2, 1
  s_mul_i32 s30, s31, 40960
  s_mul_i32 s48, s39, 160
  v_mfma_f32_16x16x32_bf16 v[32:35], a[136:139], v[136:139], v[32:35]
  s_add_u32 s30, s30, s48
  s_mul_i32 s31, s31, 5120
  s_mul_i32 s39, s39, 655360
  v_exp_f32 v25, v25
  v_mfma_f32_16x16x32_bf16 v[32:35], a[140:143], v[140:143], v[32:35]
  ds_read_b128 a[148:151], v213 offset:45056
  s_add_u32 s31, s31, s39
  s_add_u32 s31, s31, 3145728
  s_lshr_b32 s39, s2, 3
  v_cvt_pk_bf16_f32 v24, v24, v25
  v_mfma_f32_16x16x32_bf16 v[40:43], a[140:143], v[156:159], v[196:199]
  s_min_u32 s39, s39, 29
  s_and_b32 s48, s2, 7
  s_mul_i32 s48, s48, 30
  v_exp_f32 v26, v26
  v_mfma_f32_16x16x32_bf16 v[40:43], a[136:139], v[152:155], v[40:43]
  ds_read_b128 a[152:155], v214 offset:45056
  s_add_u32 s39, s39, s48
  s_mul_i32 s98, s39, 1639
  s_lshr_b32 s98, s98, 16
  v_mfma_f32_16x16x32_bf16 v[40:43], a[132:135], v[148:151], v[40:43]
  s_mul_i32 s99, s98, 40
  s_sub_u32 s99, s39, s99
  s_min_u32 s39, s3, 2
  v_exp_f32 v27, v27
  v_mfma_f32_16x16x32_bf16 v[40:43], a[128:131], v[144:147], v[40:43]
  ds_read_b128 a[156:159], v215 offset:45056
  s_mul_i32 s48, s98, 3
  s_add_u32 s48, s48, s39
  s_mul_i32 s100, s48, 122880
  v_cvt_pk_bf16_f32 v25, v26, v27
  v_mfma_f32_16x16x32_bf16 v[48:51], a[128:131], v[160:163], v[200:203]
  s_lshl_b32 s39, s99, 5
  s_add_u32 s100, s100, s39
  s_mul_i32 s101, s48, 192
  v_exp_f32 v4, v4
  v_mfma_f32_16x16x32_bf16 v[48:51], a[132:135], v[164:167], v[48:51]
  buffer_load_dwordx4 v233, s[12:15], s29 offen offset:1024 lds
  s_add_u32 s101, s101, 2633728
  s_mov_b32 s51, s50
  v_mfma_f32_16x16x32_bf16 v[48:51], a[136:139], v[168:171], v[48:51]
  v_exp_f32 v5, v5
  v_mfma_f32_16x16x32_bf16 v[48:51], a[140:143], v[172:175], v[48:51]
  v_cvt_pk_bf16_f32 v2, v4, v5
  v_mov_b32 v211, v242
  v_mfma_f32_16x16x32_bf16 v[56:59], a[140:143], v[188:191], v[204:207]
  s_mov_b32 s4, s94
  s_mov_b32 s5, s95
  s_mov_b32 s6, 2211840
  v_exp_f32 v6, v6
  v_mfma_f32_16x16x32_bf16 v[56:59], a[136:139], v[184:187], v[56:59]
  buffer_load_dwordx4 v234, s[12:15], s29 offen offset:2048 lds
  s_mov_b32 s7, 0x20000
  s_getpc_b64 s[8:9]
attn_late_pc:
  s_add_u32 s8, s8, attn_h_ready-attn_late_pc
  s_addc_u32 s9, s9, 0
  v_mfma_f32_16x16x32_bf16 v[56:59], a[132:135], v[180:183], v[56:59]
  s_waitcnt lgkmcnt(0)
  s_lshr_b32 s39, s2, 3
  v_exp_f32 v7, v7
  v_mfma_f32_16x16x32_bf16 v[56:59], a[128:131], v[176:179], v[56:59]
  v_cvt_pk_bf16_f32 v3, v6, v7
  v_lshrrev_b32 v252, 4, v242
  v_mfma_f32_16x16x32_bf16 v[36:39], a[144:147], v[128:131], v[192:195]
  v_exp_f32 v12, v12
  v_mfma_f32_16x16x32_bf16 v[36:39], a[148:151], v[132:135], v[36:39]
  ds_read_b64_tr_b16 a[160:161], v216 offset:16384
  v_min_u32 v252, 11, v252
  v_mfma_f32_16x16x32_bf16 v[36:39], a[152:155], v[136:139], v[36:39]
  v_exp_f32 v13, v13
  v_mfma_f32_16x16x32_bf16 v[36:39], a[156:159], v[140:143], v[36:39]
  ds_read_b64_tr_b16 a[162:163], v216 offset:20480
  v_cvt_pk_bf16_f32 v10, v12, v13
  v_mfma_f32_16x16x32_bf16 v[44:47], a[156:159], v[156:159], v[196:199]
  v_exp_f32 v14, v14
  v_mfma_f32_16x16x32_bf16 v[44:47], a[152:155], v[152:155], v[44:47]
  ds_read_b64_tr_b16 a[164:165], v216 offset:24576
  buffer_load_dwordx4 v235, s[12:15], s29 offen offset:3072 lds
  v_mfma_f32_16x16x32_bf16 v[44:47], a[148:151], v[148:151], v[44:47]
  v_exp_f32 v15, v15
  v_mfma_f32_16x16x32_bf16 v[44:47], a[144:147], v[144:147], v[44:47]
  ds_read_b64_tr_b16 a[166:167], v216 offset:28672
  v_cvt_pk_bf16_f32 v11, v14, v15
  v_mfma_f32_16x16x32_bf16 v[52:55], a[144:147], v[160:163], v[200:203]
  v_exp_f32 v20, v20
  v_mfma_f32_16x16x32_bf16 v[52:55], a[148:151], v[164:167], v[52:55]
  ds_read_b64_tr_b16 a[168:169], v217 offset:16384
  v_lshlrev_b32 v252, 5, v252
  v_mfma_f32_16x16x32_bf16 v[52:55], a[152:155], v[168:171], v[52:55]
  v_exp_f32 v21, v21
  v_mfma_f32_16x16x32_bf16 v[52:55], a[156:159], v[172:175], v[52:55]
  ds_read_b64_tr_b16 a[170:171], v217 offset:20480
  v_cvt_pk_bf16_f32 v18, v20, v21
  v_mfma_f32_16x16x32_bf16 v[60:63], a[156:159], v[188:191], v[204:207]
  v_exp_f32 v22, v22
  v_mfma_f32_16x16x32_bf16 v[60:63], a[152:155], v[184:187], v[60:63]
  ds_read_b64_tr_b16 a[172:173], v217 offset:24576
  v_add_u32 v252, s39, v252
  v_mfma_f32_16x16x32_bf16 v[60:63], a[148:151], v[180:183], v[60:63]
  v_exp_f32 v23, v23
  v_mfma_f32_16x16x32_bf16 v[60:63], a[144:147], v[176:179], v[60:63]
  ds_read_b64_tr_b16 a[174:175], v217 offset:28672
  v_cvt_pk_bf16_f32 v19, v22, v23
  v_mfma_f32_16x16x32_bf16 a[192:195], a[208:211], v[64:67], a[192:195]
  v_exp_f32 v28, v28
  v_mfma_f32_16x16x32_bf16 a[192:195], a[208:211], v[96:99], a[192:195]
  ds_read_b64_tr_b16 a[176:177], v218 offset:16384
  v_add_u32 v245, 1, v245
  v_mfma_f32_16x16x32_bf16 a[196:199], a[208:211], v[72:75], a[196:199]
  v_exp_f32 v29, v29
  v_mfma_f32_16x16x32_bf16 a[196:199], a[208:211], v[104:107], a[196:199]
  ds_read_b64_tr_b16 a[178:179], v218 offset:20480
  v_cvt_pk_bf16_f32 v26, v28, v29
  v_mfma_f32_16x16x32_bf16 a[200:203], a[208:211], v[80:83], a[200:203]
  s_waitcnt vmcnt(10)
  v_exp_f32 v30, v30
  v_mfma_f32_16x16x32_bf16 a[200:203], a[208:211], v[112:115], a[200:203]
  ds_read_b64_tr_b16 a[180:181], v218 offset:24576
  ds_write_b32 v246, v245
  v_mfma_f32_16x16x32_bf16 a[204:207], a[208:211], v[88:91], a[204:207]
  s_waitcnt lgkmcnt(8)
  v_exp_f32 v31, v31
  v_mfma_f32_16x16x32_bf16 a[204:207], a[208:211], v[120:123], a[204:207]
  ds_read_b64_tr_b16 a[182:183], v218 offset:28672
  v_cvt_pk_bf16_f32 v27, v30, v31
  v_mfma_f32_16x16x32_bf16 a[0:3], a[160:163], v[64:67], a[0:3]
  v_exp_f32 v32, v32
  v_mfma_f32_16x16x32_bf16 a[0:3], a[164:167], v[96:99], a[0:3]
  ds_read_b64_tr_b16 a[184:185], v219 offset:16384
  v_lshlrev_b32 v252, 7, v252
  v_mfma_f32_16x16x32_bf16 a[4:7], a[164:167], v[104:107], a[4:7]
  v_exp_f32 v33, v33
  v_mfma_f32_16x16x32_bf16 a[4:7], a[160:163], v[72:75], a[4:7]
  ds_read_b64_tr_b16 a[186:187], v219 offset:20480
  v_cvt_pk_bf16_f32 v32, v32, v33
  v_mfma_f32_16x16x32_bf16 a[8:11], a[160:163], v[80:83], a[8:11]
  v_exp_f32 v34, v34
  v_mfma_f32_16x16x32_bf16 a[8:11], a[164:167], v[112:115], a[8:11]
  ds_read_b64_tr_b16 a[188:189], v219 offset:24576
  v_min_u32 v252, attn_end-attn_h_ready-4, v252
  v_mfma_f32_16x16x32_bf16 a[12:15], a[164:167], v[120:123], a[12:15]
  s_waitcnt lgkmcnt(8)
  v_exp_f32 v35, v35
  v_mfma_f32_16x16x32_bf16 a[12:15], a[160:163], v[88:91], a[12:15]
  ds_read_b64_tr_b16 a[190:191], v219 offset:28672
  v_cvt_pk_bf16_f32 v33, v34, v35
  v_mfma_f32_16x16x32_bf16 a[16:19], a[168:171], v[64:67], a[16:19]
  v_exp_f32 v40, v40
  v_mfma_f32_16x16x32_bf16 a[16:19], a[172:175], v[96:99], a[16:19]
  ds_read_b64_tr_b16 a[160:161], v220 offset:16384
  v_mfma_f32_16x16x32_bf16 a[20:23], a[172:175], v[104:107], a[20:23]
  v_exp_f32 v41, v41
  v_mfma_f32_16x16x32_bf16 a[20:23], a[168:171], v[72:75], a[20:23]
  ds_read_b64_tr_b16 a[162:163], v220 offset:20480
  v_cvt_pk_bf16_f32 v40, v40, v41
  v_mfma_f32_16x16x32_bf16 a[24:27], a[168:171], v[80:83], a[24:27]
  v_exp_f32 v42, v42
  v_mfma_f32_16x16x32_bf16 a[24:27], a[172:175], v[112:115], a[24:27]
  ds_read_b64_tr_b16 a[164:165], v220 offset:24576
  v_mfma_f32_16x16x32_bf16 a[28:31], a[172:175], v[120:123], a[28:31]
  s_waitcnt lgkmcnt(7)
  v_exp_f32 v43, v43
  v_mfma_f32_16x16x32_bf16 a[28:31], a[168:171], v[88:91], a[28:31]
  ds_read_b64_tr_b16 a[166:167], v220 offset:28672
  v_cvt_pk_bf16_f32 v41, v42, v43
  v_mfma_f32_16x16x32_bf16 a[32:35], a[176:179], v[64:67], a[32:35]
  v_exp_f32 v48, v48
  v_mfma_f32_16x16x32_bf16 a[32:35], a[180:183], v[96:99], a[32:35]
  ds_read_b64_tr_b16 a[168:169], v221 offset:16384
  v_mfma_f32_16x16x32_bf16 a[36:39], a[180:183], v[104:107], a[36:39]
  v_exp_f32 v49, v49
  v_mfma_f32_16x16x32_bf16 a[36:39], a[176:179], v[72:75], a[36:39]
  ds_read_b64_tr_b16 a[170:171], v221 offset:20480
  v_cvt_pk_bf16_f32 v48, v48, v49
  v_mfma_f32_16x16x32_bf16 a[40:43], a[176:179], v[80:83], a[40:43]
  v_exp_f32 v50, v50
  v_mfma_f32_16x16x32_bf16 a[40:43], a[180:183], v[112:115], a[40:43]
  ds_read_b64_tr_b16 a[172:173], v221 offset:24576
  v_mfma_f32_16x16x32_bf16 a[44:47], a[180:183], v[120:123], a[44:47]
  s_waitcnt lgkmcnt(7)
  v_exp_f32 v51, v51
  v_mfma_f32_16x16x32_bf16 a[44:47], a[176:179], v[88:91], a[44:47]
  ds_read_b64_tr_b16 a[174:175], v221 offset:28672
  v_cvt_pk_bf16_f32 v49, v50, v51
  v_mfma_f32_16x16x32_bf16 a[48:51], a[184:187], v[64:67], a[48:51]
  v_exp_f32 v56, v56
  v_mfma_f32_16x16x32_bf16 a[48:51], a[188:191], v[96:99], a[48:51]
  ds_read_b64_tr_b16 a[176:177], v222 offset:16384
  v_mfma_f32_16x16x32_bf16 a[52:55], a[188:191], v[104:107], a[52:55]
  v_exp_f32 v57, v57
  v_mfma_f32_16x16x32_bf16 a[52:55], a[184:187], v[72:75], a[52:55]
  ds_read_b64_tr_b16 a[178:179], v222 offset:20480
  v_cvt_pk_bf16_f32 v56, v56, v57
  v_mfma_f32_16x16x32_bf16 a[56:59], a[184:187], v[80:83], a[56:59]
  v_exp_f32 v58, v58
  v_mfma_f32_16x16x32_bf16 a[56:59], a[188:191], v[112:115], a[56:59]
  ds_read_b64_tr_b16 a[180:181], v222 offset:24576
  v_mfma_f32_16x16x32_bf16 a[60:63], a[188:191], v[120:123], a[60:63]
  s_waitcnt lgkmcnt(7)
  v_exp_f32 v59, v59
  v_mfma_f32_16x16x32_bf16 a[60:63], a[184:187], v[88:91], a[60:63]
  ds_read_b64_tr_b16 a[182:183], v222 offset:28672
  v_cvt_pk_bf16_f32 v57, v58, v59
  v_mfma_f32_16x16x32_bf16 a[64:67], a[160:163], v[64:67], a[64:67]
  v_exp_f32 v36, v36
  v_mfma_f32_16x16x32_bf16 a[64:67], a[164:167], v[96:99], a[64:67]
  ds_read_b64_tr_b16 a[184:185], v223 offset:16384
  ds_read_b32 v248, v247
  v_mfma_f32_16x16x32_bf16 a[68:71], a[164:167], v[104:107], a[68:71]
  v_exp_f32 v37, v37
  v_mfma_f32_16x16x32_bf16 a[68:71], a[160:163], v[72:75], a[68:71]
  ds_read_b64_tr_b16 a[186:187], v223 offset:20480
  v_cvt_pk_bf16_f32 v34, v36, v37
  v_mfma_f32_16x16x32_bf16 a[72:75], a[160:163], v[80:83], a[72:75]
  v_exp_f32 v38, v38
  v_mfma_f32_16x16x32_bf16 a[72:75], a[164:167], v[112:115], a[72:75]
  ds_read_b64_tr_b16 a[188:189], v223 offset:24576
  v_mfma_f32_16x16x32_bf16 a[76:79], a[164:167], v[120:123], a[76:79]
  s_waitcnt lgkmcnt(8)
  v_exp_f32 v39, v39
  v_mfma_f32_16x16x32_bf16 a[76:79], a[160:163], v[88:91], a[76:79]
  ds_read_b64_tr_b16 a[190:191], v223 offset:28672
  v_cvt_pk_bf16_f32 v35, v38, v39
  v_mfma_f32_16x16x32_bf16 a[80:83], a[168:171], v[64:67], a[80:83]
  s_waitcnt lgkmcnt(3)
  v_exp_f32 v44, v44
  v_mfma_f32_16x16x32_bf16 a[80:83], a[172:175], v[96:99], a[80:83]
  v_cmp_lt_u32 vcc, v248, v245
  v_mfma_f32_16x16x32_bf16 a[84:87], a[172:175], v[104:107], a[84:87]
  s_cbranch_vccnz attn_wait5
attn_on5:
  v_exp_f32 v45, v45
  v_mfma_f32_16x16x32_bf16 a[84:87], a[168:171], v[72:75], a[84:87]
  ds_read_b128 a[128:131], v212 offset:49152
  v_cvt_pk_bf16_f32 v42, v44, v45
  v_mfma_f32_16x16x32_bf16 a[88:91], a[168:171], v[80:83], a[88:91]
  v_exp_f32 v46, v46
  v_mfma_f32_16x16x32_bf16 a[88:91], a[172:175], v[112:115], a[88:91]
  ds_read_b128 a[132:135], v213 offset:49152
  v_mfma_f32_16x16x32_bf16 a[92:95], a[172:175], v[120:123], a[92:95]
  v_exp_f32 v47, v47
  v_mfma_f32_16x16x32_bf16 a[92:95], a[168:171], v[88:91], a[92:95]
  ds_read_b128 a[136:139], v214 offset:49152
  v_cvt_pk_bf16_f32 v43, v46, v47
  v_mfma_f32_16x16x32_bf16 a[96:99], a[176:179], v[64:67], a[96:99]
  v_exp_f32 v52, v52
  v_mfma_f32_16x16x32_bf16 a[96:99], a[180:183], v[96:99], a[96:99]
  ds_read_b128 a[140:143], v215 offset:49152
  v_mfma_f32_16x16x32_bf16 a[100:103], a[180:183], v[104:107], a[100:103]
  v_exp_f32 v53, v53
  v_mfma_f32_16x16x32_bf16 a[100:103], a[176:179], v[72:75], a[100:103]
  v_cvt_pk_bf16_f32 v50, v52, v53
  v_mfma_f32_16x16x32_bf16 a[104:107], a[176:179], v[80:83], a[104:107]
  v_exp_f32 v54, v54
  v_mfma_f32_16x16x32_bf16 a[104:107], a[180:183], v[112:115], a[104:107]
  v_mfma_f32_16x16x32_bf16 a[108:111], a[180:183], v[120:123], a[108:111]
  s_waitcnt lgkmcnt(4)
  v_exp_f32 v55, v55
  v_mfma_f32_16x16x32_bf16 a[108:111], a[176:179], v[88:91], a[108:111]
  v_cvt_pk_bf16_f32 v51, v54, v55
  v_mfma_f32_16x16x32_bf16 a[112:115], a[184:187], v[64:67], a[112:115]
  v_exp_f32 v60, v60
  v_mfma_f32_16x16x32_bf16 a[112:115], a[188:191], v[96:99], a[112:115]
  v_mfma_f32_16x16x32_bf16 a[116:119], a[188:191], v[104:107], a[116:119]
  v_exp_f32 v61, v61
  v_mfma_f32_16x16x32_bf16 a[116:119], a[184:187], v[72:75], a[116:119]
  v_cvt_pk_bf16_f32 v58, v60, v61
  v_mfma_f32_16x16x32_bf16 a[120:123], a[184:187], v[80:83], a[120:123]
  v_exp_f32 v62, v62
  v_mfma_f32_16x16x32_bf16 a[120:123], a[188:191], v[112:115], a[120:123]
  v_mfma_f32_16x16x32_bf16 a[124:127], a[188:191], v[120:123], a[124:127]
  s_waitcnt lgkmcnt(0)
  v_exp_f32 v63, v63
  v_mfma_f32_16x16x32_bf16 a[124:127], a[184:187], v[88:91], a[124:127]
  v_cvt_pk_bf16_f32 v59, v62, v63
  v_mfma_f32_16x16x32_bf16 v[64:67], a[128:131], v[128:131], v[192:195]
  s_add_u32 m0, s28, 65536
  v_lshrrev_b32 v224, 4, v242
  v_lshrrev_b32 v225, 4, v224
  v_mfma_f32_16x16x32_bf16 v[64:67], a[132:135], v[132:135], v[64:67]
  ds_read_b128 a[144:147], v212 offset:53248
  v_bfe_u32 v226, v224, 2, 2
  v_mfma_f32_16x16x32_bf16 v[64:67], a[136:139], v[136:139], v[64:67]
  buffer_load_dwordx4 v236, s[16:19], s29 offen offset:0 lds
  v_mfma_f32_16x16x32_bf16 v[64:67], a[140:143], v[140:143], v[64:67]
  ds_read_b128 a[148:151], v213 offset:53248
  v_lshl_add_u32 v225, v225, 3, v226
  v_mfma_f32_16x16x32_bf16 v[72:75], a[140:143], v[156:159], v[196:199]
  v_lshlrev_b32 v225, 4, v225
  v_bfe_u32 v226, v224, 1, 1
  v_mfma_f32_16x16x32_bf16 v[72:75], a[136:139], v[152:155], v[72:75]
  ds_read_b128 a[152:155], v214 offset:53248
  v_mul_u32_u24 v226, 0xc00, v226
  v_mfma_f32_16x16x32_bf16 v[72:75], a[132:135], v[148:151], v[72:75]
  buffer_load_dwordx4 v237, s[16:19], s29 offen offset:1024 lds
  v_mfma_f32_16x16x32_bf16 v[72:75], a[128:131], v[144:147], v[72:75]
  ds_read_b128 a[156:159], v215 offset:53248
  v_add3_u32 v225, v225, v226, s50
  v_mfma_f32_16x16x32_bf16 v[80:83], a[128:131], v[160:163], v[200:203]
  v_exp_f32 v64, v64
  v_mfma_f32_16x16x32_bf16 v[80:83], a[132:135], v[164:167], v[80:83]
  v_and_b32 v226, 1, v224
  v_lshl_add_u32 v225, v226, 3, v225
  v_mfma_f32_16x16x32_bf16 v[80:83], a[136:139], v[168:171], v[80:83]
  s_waitcnt vmcnt(10)
  v_exp_f32 v65, v65
  v_mfma_f32_16x16x32_bf16 v[80:83], a[140:143], v[172:175], v[80:83]
  ds_read_b64_tr_b16 a[232:233], v225 offset:0
  v_cvt_pk_bf16_f32 v64, v64, v65
  v_mfma_f32_16x16x32_bf16 v[88:91], a[140:143], v[188:191], v[204:207]
  v_exp_f32 v66, v66
  v_mfma_f32_16x16x32_bf16 v[88:91], a[136:139], v[184:187], v[88:91]
  buffer_load_dwordx4 v236, s[16:19], s29 offen offset:2048 lds
  v_mfma_f32_16x16x32_bf16 v[88:91], a[132:135], v[180:183], v[88:91]
  s_waitcnt lgkmcnt(1)
  v_exp_f32 v67, v67
  v_mfma_f32_16x16x32_bf16 v[88:91], a[128:131], v[176:179], v[88:91]
  ds_read_b64_tr_b16 a[234:235], v225 offset:64
  v_cvt_pk_bf16_f32 v65, v66, v67
  v_mfma_f32_16x16x32_bf16 v[68:71], a[144:147], v[128:131], v[192:195]
  v_exp_f32 v72, v72
  v_mfma_f32_16x16x32_bf16 v[68:71], a[148:151], v[132:135], v[68:71]
  ds_read_b128 a[128:131], v212 offset:57344
  ds_read_b64_tr_b16 a[236:237], v225 offset:512
  v_mfma_f32_16x16x32_bf16 v[68:71], a[152:155], v[136:139], v[68:71]
  v_exp_f32 v73, v73
  v_mfma_f32_16x16x32_bf16 v[68:71], a[156:159], v[140:143], v[68:71]
  ds_read_b128 a[132:135], v213 offset:57344
  v_cvt_pk_bf16_f32 v72, v72, v73
  v_mfma_f32_16x16x32_bf16 v[76:79], a[156:159], v[156:159], v[196:199]
  v_exp_f32 v74, v74
  v_mfma_f32_16x16x32_bf16 v[76:79], a[152:155], v[152:155], v[76:79]
  ds_read_b128 a[136:139], v214 offset:57344
  ds_read_b64_tr_b16 a[238:239], v225 offset:576
  v_mfma_f32_16x16x32_bf16 v[76:79], a[148:151], v[148:151], v[76:79]
  v_exp_f32 v75, v75
  v_mfma_f32_16x16x32_bf16 v[76:79], a[144:147], v[144:147], v[76:79]
  ds_read_b128 a[140:143], v215 offset:57344
  v_cvt_pk_bf16_f32 v73, v74, v75
  v_mfma_f32_16x16x32_bf16 v[84:87], a[144:147], v[160:163], v[200:203]
  v_exp_f32 v80, v80
  v_mfma_f32_16x16x32_bf16 v[84:87], a[148:151], v[164:167], v[84:87]
  buffer_load_dwordx4 v237, s[16:19], s29 offen offset:3072 lds
  v_mfma_f32_16x16x32_bf16 v[84:87], a[152:155], v[168:171], v[84:87]
  s_add_u32 s29, s29, 16384
  v_exp_f32 v81, v81
  v_mfma_f32_16x16x32_bf16 v[84:87], a[156:159], v[172:175], v[84:87]
  ds_read_b64_tr_b16 a[240:241], v225 offset:1024
  v_cvt_pk_bf16_f32 v80, v80, v81
  v_mfma_f32_16x16x32_bf16 v[92:95], a[156:159], v[188:191], v[204:207]
  s_add_u32 m0, s28, 16384
  v_exp_f32 v82, v82
  v_mfma_f32_16x16x32_bf16 v[92:95], a[152:155], v[184:187], v[92:95]
  buffer_load_dwordx4 v232, s[12:15], s29 offen offset:0 lds
  v_mfma_f32_16x16x32_bf16 v[92:95], a[148:151], v[180:183], v[92:95]
  s_waitcnt lgkmcnt(1)
  v_exp_f32 v83, v83
  v_mfma_f32_16x16x32_bf16 v[92:95], a[144:147], v[176:179], v[92:95]
  ds_read_b64_tr_b16 a[242:243], v225 offset:1088
  v_cvt_pk_bf16_f32 v81, v82, v83
  v_mfma_f32_16x16x32_bf16 v[96:99], a[128:131], v[128:131], v[192:195]
  v_exp_f32 v88, v88
  v_mfma_f32_16x16x32_bf16 v[96:99], a[132:135], v[132:135], v[96:99]
  ds_read_b128 a[144:147], v212 offset:61440
  ds_read_b64_tr_b16 a[244:245], v225 offset:1536
  v_mfma_f32_16x16x32_bf16 v[96:99], a[136:139], v[136:139], v[96:99]
  v_exp_f32 v89, v89
  v_mfma_f32_16x16x32_bf16 v[96:99], a[140:143], v[140:143], v[96:99]
  ds_read_b128 a[148:151], v213 offset:61440
  v_cvt_pk_bf16_f32 v88, v88, v89
  v_mfma_f32_16x16x32_bf16 v[104:107], a[140:143], v[156:159], v[196:199]
  v_exp_f32 v90, v90
  v_mfma_f32_16x16x32_bf16 v[104:107], a[136:139], v[152:155], v[104:107]
  ds_read_b128 a[152:155], v214 offset:61440
  ds_read_b64_tr_b16 a[246:247], v225 offset:1600
  v_mfma_f32_16x16x32_bf16 v[104:107], a[132:135], v[148:151], v[104:107]
  v_exp_f32 v91, v91
  v_mfma_f32_16x16x32_bf16 v[104:107], a[128:131], v[144:147], v[104:107]
  ds_read_b128 a[156:159], v215 offset:61440
  v_cvt_pk_bf16_f32 v89, v90, v91
  v_mfma_f32_16x16x32_bf16 v[112:115], a[128:131], v[160:163], v[200:203]
  v_exp_f32 v68, v68
  v_mfma_f32_16x16x32_bf16 v[112:115], a[132:135], v[164:167], v[112:115]
  buffer_load_dwordx4 v233, s[12:15], s29 offen offset:1024 lds
  v_mfma_f32_16x16x32_bf16 v[112:115], a[136:139], v[168:171], v[112:115]
  v_exp_f32 v69, v69
  v_mfma_f32_16x16x32_bf16 v[112:115], a[140:143], v[172:175], v[112:115]
  ds_read_b64_tr_b16 a[248:249], v225 offset:2048
  v_cvt_pk_bf16_f32 v66, v68, v69
  v_mfma_f32_16x16x32_bf16 v[120:123], a[140:143], v[188:191], v[204:207]
  v_exp_f32 v70, v70
  v_mfma_f32_16x16x32_bf16 v[120:123], a[136:139], v[184:187], v[120:123]
  buffer_load_dwordx4 v234, s[12:15], s29 offen offset:2048 lds
  v_mfma_f32_16x16x32_bf16 v[120:123], a[132:135], v[180:183], v[120:123]
  s_waitcnt lgkmcnt(1)
  v_exp_f32 v71, v71
  v_mfma_f32_16x16x32_bf16 v[120:123], a[128:131], v[176:179], v[120:123]
  ds_read_b64_tr_b16 a[250:251], v225 offset:2112
  v_cvt_pk_bf16_f32 v67, v70, v71
  v_mfma_f32_16x16x32_bf16 v[100:103], a[144:147], v[128:131], v[192:195]
  v_exp_f32 v76, v76
  v_mfma_f32_16x16x32_bf16 v[100:103], a[148:151], v[132:135], v[100:103]
  ds_read_b64_tr_b16 a[160:161], v216 offset:32768
  v_mfma_f32_16x16x32_bf16 v[100:103], a[152:155], v[136:139], v[100:103]
  v_exp_f32 v77, v77
  v_mfma_f32_16x16x32_bf16 v[100:103], a[156:159], v[140:143], v[100:103]
  ds_read_b64_tr_b16 a[162:163], v216 offset:36864
  v_cvt_pk_bf16_f32 v74, v76, v77
  v_mfma_f32_16x16x32_bf16 v[108:111], a[156:159], v[156:159], v[196:199]
  v_exp_f32 v78, v78
  v_mfma_f32_16x16x32_bf16 v[108:111], a[152:155], v[152:155], v[108:111]
  ds_read_b64_tr_b16 a[164:165], v216 offset:40960
  buffer_load_dwordx4 v235, s[12:15], s29 offen offset:3072 lds
  v_mfma_f32_16x16x32_bf16 v[108:111], a[148:151], v[148:151], v[108:111]
  v_exp_f32 v79, v79
  v_mfma_f32_16x16x32_bf16 v[108:111], a[144:147], v[144:147], v[108:111]
  ds_read_b64_tr_b16 a[166:167], v216 offset:45056
  s_waitcnt lgkmcnt(4)
  v_cvt_pk_bf16_f32 v75, v78, v79
  v_mfma_f32_16x16x32_bf16 v[228:231], a[232:235], a[212:215], 0
  v_mfma_f32_16x16x32_bf16 v[228:231], a[236:239], a[216:219], v[228:231]
  v_mfma_f32_16x16x32_bf16 v[228:231], a[240:243], a[220:223], v[228:231]
  v_mfma_f32_16x16x32_bf16 v[228:231], a[244:247], a[224:227], v[228:231]
  v_mfma_f32_16x16x32_bf16 v[228:231], a[248:251], a[228:231], v[228:231]
  v_mfma_f32_16x16x32_bf16 v[116:119], a[144:147], v[160:163], v[200:203]
  s_lshl_b32 s35, s3, 10
  s_add_u32 s35, s35, 159744
  v_exp_f32 v84, v84
  v_mfma_f32_16x16x32_bf16 v[116:119], a[148:151], v[164:167], v[116:119]
  ds_read_b64_tr_b16 a[168:169], v217 offset:32768
  v_add_u32 v224, s35, v242
  v_mfma_f32_16x16x32_bf16 v[116:119], a[152:155], v[168:171], v[116:119]
  v_exp_f32 v85, v85
  v_mfma_f32_16x16x32_bf16 v[116:119], a[156:159], v[172:175], v[116:119]
  ds_read_b64_tr_b16 a[170:171], v217 offset:36864
  v_cvt_pk_bf16_f32 v82, v84, v85
  v_mfma_f32_16x16x32_bf16 v[124:127], a[156:159], v[188:191], v[204:207]
  v_exp_f32 v86, v86
  v_mfma_f32_16x16x32_bf16 v[124:127], a[152:155], v[184:187], v[124:127]
  ds_read_b64_tr_b16 a[172:173], v217 offset:40960
  ds_write_b128 v224, v[228:231]
  v_mfma_f32_16x16x32_bf16 v[124:127], a[148:151], v[180:183], v[124:127]
  v_exp_f32 v87, v87
  v_mfma_f32_16x16x32_bf16 v[124:127], a[144:147], v[176:179], v[124:127]
  ds_read_b64_tr_b16 a[174:175], v217 offset:45056
  v_cvt_pk_bf16_f32 v83, v86, v87
  v_mfma_f32_16x16x32_bf16 a[192:195], a[208:211], v[0:3], a[192:195]
  v_exp_f32 v92, v92
  v_mfma_f32_16x16x32_bf16 a[192:195], a[208:211], v[32:35], a[192:195]
  ds_read_b64_tr_b16 a[176:177], v218 offset:32768
  v_add_u32 v245, 1, v245
  v_mfma_f32_16x16x32_bf16 a[196:199], a[208:211], v[8:11], a[196:199]
  v_exp_f32 v93, v93
  v_mfma_f32_16x16x32_bf16 a[196:199], a[208:211], v[40:43], a[196:199]
  ds_read_b64_tr_b16 a[178:179], v218 offset:36864
  v_cvt_pk_bf16_f32 v90, v92, v93
  v_mfma_f32_16x16x32_bf16 a[200:203], a[208:211], v[16:19], a[200:203]
  s_waitcnt vmcnt(8)
  v_exp_f32 v94, v94
  s_waitcnt lgkmcnt(3)
  v_mfma_f32_16x16x32_bf16 a[200:203], a[208:211], v[48:51], a[200:203]
  ds_read_b64_tr_b16 a[180:181], v218 offset:40960
  ds_write_b32 v246, v245
  s_mov_b32 m0, s51
  v_mfma_f32_16x16x32_bf16 a[204:207], a[208:211], v[24:27], a[204:207]
  v_exp_f32 v95, v95
  v_mfma_f32_16x16x32_bf16 a[204:207], a[208:211], v[56:59], a[204:207]
  ds_read_b64_tr_b16 a[182:183], v218 offset:45056
  v_cvt_pk_bf16_f32 v91, v94, v95
  v_mfma_f32_16x16x32_bf16 a[0:3], a[160:163], v[0:3], a[0:3]
  v_exp_f32 v96, v96
  v_mfma_f32_16x16x32_bf16 a[0:3], a[164:167], v[32:35], a[0:3]
  ds_read_b64_tr_b16 a[184:185], v219 offset:32768
  buffer_load_dwordx4 v210, s[4:7], s100 offen lds
  s_add_u32 s100, s100, 20480
  s_add_u32 s51, s51, 512
  v_mfma_f32_16x16x32_bf16 a[4:7], a[164:167], v[40:43], a[4:7]
  v_exp_f32 v97, v97
  v_mfma_f32_16x16x32_bf16 a[4:7], a[160:163], v[8:11], a[4:7]
  ds_read_b64_tr_b16 a[186:187], v219 offset:36864
  v_cvt_pk_bf16_f32 v96, v96, v97
  v_mfma_f32_16x16x32_bf16 a[8:11], a[160:163], v[16:19], a[8:11]
  v_exp_f32 v98, v98
  v_mfma_f32_16x16x32_bf16 a[8:11], a[164:167], v[48:51], a[8:11]
  ds_read_b64_tr_b16 a[188:189], v219 offset:40960
  v_lshrrev_b32 v224, 4, v242
  v_mfma_f32_16x16x32_bf16 a[12:15], a[164:167], v[56:59], a[12:15]
  s_waitcnt lgkmcnt(8)
  v_exp_f32 v99, v99
  v_mfma_f32_16x16x32_bf16 a[12:15], a[160:163], v[24:27], a[12:15]
  ds_read_b64_tr_b16 a[190:191], v219 offset:45056
  v_cvt_pk_bf16_f32 v97, v98, v99
  v_mfma_f32_16x16x32_bf16 a[16:19], a[168:171], v[0:3], a[16:19]
  v_exp_f32 v104, v104
  v_mfma_f32_16x16x32_bf16 a[16:19], a[172:175], v[32:35], a[16:19]
  ds_read_b64_tr_b16 a[160:161], v220 offset:32768
  v_bfe_u32 v225, v224, 2, 1
  v_mfma_f32_16x16x32_bf16 a[20:23], a[172:175], v[40:43], a[20:23]
  v_exp_f32 v105, v105
  v_mfma_f32_16x16x32_bf16 a[20:23], a[168:171], v[8:11], a[20:23]
  ds_read_b64_tr_b16 a[162:163], v220 offset:36864
  v_cvt_pk_bf16_f32 v104, v104, v105
  v_mfma_f32_16x16x32_bf16 a[24:27], a[168:171], v[16:19], a[24:27]
  v_exp_f32 v106, v106
  v_mfma_f32_16x16x32_bf16 a[24:27], a[172:175], v[48:51], a[24:27]
  ds_read_b64_tr_b16 a[164:165], v220 offset:40960
  v_lshlrev_b32 v225, 8, v225
  v_mfma_f32_16x16x32_bf16 a[28:31], a[172:175], v[56:59], a[28:31]
  s_waitcnt lgkmcnt(7)
  v_exp_f32 v107, v107
  v_mfma_f32_16x16x32_bf16 a[28:31], a[168:171], v[24:27], a[28:31]
  ds_read_b64_tr_b16 a[166:167], v220 offset:45056
  v_cvt_pk_bf16_f32 v105, v106, v107
  v_mfma_f32_16x16x32_bf16 a[32:35], a[176:179], v[0:3], a[32:35]
  v_exp_f32 v112, v112
  v_mfma_f32_16x16x32_bf16 a[32:35], a[180:183], v[32:35], a[32:35]
  ds_read_b64_tr_b16 a[168:169], v221 offset:32768
  v_lshrrev_b32 v226, 3, v224
  v_mfma_f32_16x16x32_bf16 a[36:39], a[180:183], v[40:43], a[36:39]
  v_exp_f32 v113, v113
  v_mfma_f32_16x16x32_bf16 a[36:39], a[176:179], v[8:11], a[36:39]
  ds_read_b64_tr_b16 a[170:171], v221 offset:36864
  v_cvt_pk_bf16_f32 v112, v112, v113
  v_mfma_f32_16x16x32_bf16 a[40:43], a[176:179], v[16:19], a[40:43]
  v_exp_f32 v114, v114
  v_mfma_f32_16x16x32_bf16 a[40:43], a[180:183], v[48:51], a[40:43]
  ds_read_b64_tr_b16 a[172:173], v221 offset:40960
  v_lshl_add_u32 v225, v226, 4, v225
  v_mfma_f32_16x16x32_bf16 a[44:47], a[180:183], v[56:59], a[44:47]
  s_waitcnt lgkmcnt(7)
  v_exp_f32 v115, v115
  v_mfma_f32_16x16x32_bf16 a[44:47], a[176:179], v[24:27], a[44:47]
  ds_read_b64_tr_b16 a[174:175], v221 offset:45056
  v_cvt_pk_bf16_f32 v113, v114, v115
  v_mfma_f32_16x16x32_bf16 a[48:51], a[184:187], v[0:3], a[48:51]
  v_exp_f32 v120, v120
  v_mfma_f32_16x16x32_bf16 a[48:51], a[188:191], v[32:35], a[48:51]
  ds_read_b64_tr_b16 a[176:177], v222 offset:32768
  v_and_b32 v227, 3, v224
  v_mfma_f32_16x16x32_bf16 a[52:55], a[188:191], v[40:43], a[52:55]
  v_exp_f32 v121, v121
  v_mfma_f32_16x16x32_bf16 a[52:55], a[184:187], v[8:11], a[52:55]
  ds_read_b64_tr_b16 a[178:179], v222 offset:36864
  v_cvt_pk_bf16_f32 v120, v120, v121
  v_mfma_f32_16x16x32_bf16 a[56:59], a[184:187], v[16:19], a[56:59]
  v_exp_f32 v122, v122
  v_mfma_f32_16x16x32_bf16 a[56:59], a[188:191], v[48:51], a[56:59]
  ds_read_b64_tr_b16 a[180:181], v222 offset:40960
  v_lshl_add_u32 v225, v227, 2, v225
  v_mfma_f32_16x16x32_bf16 a[60:63], a[188:191], v[56:59], a[60:63]
  s_waitcnt lgkmcnt(7)
  v_exp_f32 v123, v123
  v_mfma_f32_16x16x32_bf16 a[60:63], a[184:187], v[24:27], a[60:63]
  ds_read_b64_tr_b16 a[182:183], v222 offset:45056
  v_cvt_pk_bf16_f32 v121, v122, v123
  v_mfma_f32_16x16x32_bf16 a[64:67], a[160:163], v[0:3], a[64:67]
  v_exp_f32 v100, v100
  v_mfma_f32_16x16x32_bf16 a[64:67], a[164:167], v[32:35], a[64:67]
  ds_read_b64_tr_b16 a[184:185], v223 offset:32768
  ds_read_b32 v248, v247
  v_mfma_f32_16x16x32_bf16 a[68:71], a[164:167], v[40:43], a[68:71]
  v_exp_f32 v101, v101
  v_mfma_f32_16x16x32_bf16 a[68:71], a[160:163], v[8:11], a[68:71]
  ds_read_b64_tr_b16 a[186:187], v223 offset:36864
  v_cvt_pk_bf16_f32 v98, v100, v101
  v_mfma_f32_16x16x32_bf16 a[72:75], a[160:163], v[16:19], a[72:75]
  v_exp_f32 v102, v102
  v_mfma_f32_16x16x32_bf16 a[72:75], a[164:167], v[48:51], a[72:75]
  ds_read_b64_tr_b16 a[188:189], v223 offset:40960
  v_add_u32 v225, 159744, v225
  v_mfma_f32_16x16x32_bf16 a[76:79], a[164:167], v[56:59], a[76:79]
  s_waitcnt lgkmcnt(8)
  v_exp_f32 v103, v103
  v_mfma_f32_16x16x32_bf16 a[76:79], a[160:163], v[24:27], a[76:79]
  ds_read_b64_tr_b16 a[190:191], v223 offset:45056
  v_cvt_pk_bf16_f32 v99, v102, v103
  v_mfma_f32_16x16x32_bf16 a[80:83], a[168:171], v[0:3], a[80:83]
  s_waitcnt lgkmcnt(3)
  v_exp_f32 v108, v108
  v_mfma_f32_16x16x32_bf16 a[80:83], a[172:175], v[32:35], a[80:83]
  v_cmp_lt_u32 vcc, v248, v245
  v_mfma_f32_16x16x32_bf16 a[84:87], a[172:175], v[40:43], a[84:87]
  s_cbranch_vccnz attn_wait6
attn_on6:
  v_exp_f32 v109, v109
  v_mfma_f32_16x16x32_bf16 a[84:87], a[168:171], v[8:11], a[84:87]
  ds_read_b128 a[128:131], v212 offset:0
  v_cvt_pk_bf16_f32 v106, v108, v109
  v_mfma_f32_16x16x32_bf16 a[88:91], a[168:171], v[16:19], a[88:91]
  v_exp_f32 v110, v110
  v_mfma_f32_16x16x32_bf16 a[88:91], a[172:175], v[48:51], a[88:91]
  ds_read_b128 a[132:135], v213 offset:0
  ds_read_b32 v228, v225 offset:0
  v_mfma_f32_16x16x32_bf16 a[92:95], a[172:175], v[56:59], a[92:95]
  v_exp_f32 v111, v111
  v_mfma_f32_16x16x32_bf16 a[92:95], a[168:171], v[24:27], a[92:95]
  ds_read_b128 a[136:139], v214 offset:0
  v_cvt_pk_bf16_f32 v107, v110, v111
  v_mfma_f32_16x16x32_bf16 a[96:99], a[176:179], v[0:3], a[96:99]
  v_exp_f32 v116, v116
  v_mfma_f32_16x16x32_bf16 a[96:99], a[180:183], v[32:35], a[96:99]
  ds_read_b128 a[140:143], v215 offset:0
  ds_read_b32 v229, v225 offset:1024
  v_mfma_f32_16x16x32_bf16 a[100:103], a[180:183], v[40:43], a[100:103]
  v_exp_f32 v117, v117
  v_mfma_f32_16x16x32_bf16 a[100:103], a[176:179], v[8:11], a[100:103]
  ds_read_b32 v230, v225 offset:2048
  v_cvt_pk_bf16_f32 v114, v116, v117
  v_mfma_f32_16x16x32_bf16 a[104:107], a[176:179], v[16:19], a[104:107]
  v_exp_f32 v118, v118
  v_mfma_f32_16x16x32_bf16 a[104:107], a[180:183], v[48:51], a[104:107]
  ds_read_b32 v231, v225 offset:3072
  ds_read_b32 v238, v225 offset:512
  v_mfma_f32_16x16x32_bf16 a[108:111], a[180:183], v[56:59], a[108:111]
  s_waitcnt lgkmcnt(9)
  v_exp_f32 v119, v119
  v_mfma_f32_16x16x32_bf16 a[108:111], a[176:179], v[24:27], a[108:111]
  ds_read_b32 v239, v225 offset:1536
  v_cvt_pk_bf16_f32 v115, v118, v119
  v_mfma_f32_16x16x32_bf16 a[112:115], a[184:187], v[0:3], a[112:115]
  v_exp_f32 v124, v124
  v_mfma_f32_16x16x32_bf16 a[112:115], a[188:191], v[32:35], a[112:115]
  ds_read_b32 v240, v225 offset:2560
  ds_read_b32 v241, v225 offset:3584
  s_cmp_eq_u32 s3, 0
  s_cselect_b32 s35, 0, 1073741824
  v_mfma_f32_16x16x32_bf16 a[116:119], a[188:191], v[40:43], a[116:119]
  v_exp_f32 v125, v125
  v_mfma_f32_16x16x32_bf16 a[116:119], a[184:187], v[8:11], a[116:119]
  v_cvt_pk_bf16_f32 v122, v124, v125
  v_mul_u32_u24 v226, 0xd80, v226
  v_mfma_f32_16x16x32_bf16 a[120:123], a[184:187], v[16:19], a[120:123]
  v_exp_f32 v126, v126
  v_mfma_f32_16x16x32_bf16 a[120:123], a[188:191], v[48:51], a[120:123]
  v_and_b32 v227, 7, v224
  v_lshl_add_u32 v226, v227, 1, v226
  v_mfma_f32_16x16x32_bf16 a[124:127], a[188:191], v[56:59], a[124:127]
  s_waitcnt lgkmcnt(7)
  v_exp_f32 v127, v127
  v_mfma_f32_16x16x32_bf16 a[124:127], a[184:187], v[24:27], a[124:127]
  v_cvt_pk_bf16_f32 v123, v126, v127
  v_and_b32 v227, 1, v224
  v_lshl_add_u32 v226, v227, 30, v226
  v_or_b32 v226, s35, v226
  v_min_u32 v249, 1, v224
  v_lshlrev_b32 v249, 30, v249
  v_or_b32 v249, s35, v249
  v_mov_b32 v251, v249
  v_mov_b32 v250, 1
  s_mov_b32 s47, 2818048
  s_lshl_b32 s35, s33, 4
  s_add_u32 s35, s35, 2633728
  s_waitcnt lgkmcnt(0)
  v_add_f32 v228, v228, v229
  v_add_f32 v238, v238, v239
  v_add_f32 v230, v230, v231
  v_add_f32 v240, v240, v241
  v_add_f32 v228, v228, v230
  v_add_f32 v238, v238, v240
  v_cvt_pk_bf16_f32 v228, v228, v228
  v_cvt_pk_bf16_f32 v238, v238, v238
  v_lshlrev_b32 v228, 16, v228
  v_lshlrev_b32 v238, 16, v238
  v_mul_f32 v229, 0xbfb8aa3b, v228
  v_exp_f32 v229, v229
  s_nop 0
  v_add_f32 v229, 1.0, v229
  v_rcp_f32 v229, v229
  s_nop 0
  v_mul_f32 v228, v228, v229
  v_cvt_pk_bf16_f32 v228, v228, v228
  v_lshlrev_b32 v228, 16, v228
  v_mul_f32 v228, v228, v238
  s_nop 1
  v_mov_b32_dpp v229, v228 quad_perm:[1,0,3,2] row_mask:0xf bank_mask:0xf
  v_cvt_pk_bf16_f32 v228, v228, v229
  buffer_store_dword v228, v226, s[24:27], s35 offen sc1
  s_mov_b32 s32, 5
attn_loop:
  v_mfma_f32_16x16x32_bf16 v[0:3], a[128:131], v[128:131], v[192:195]
  s_add_u32 m0, s28, 81920
  v_mfma_f32_16x16x32_bf16 v[0:3], a[132:135], v[132:135], v[0:3]
  ds_read_b128 a[144:147], v212 offset:4096
  v_mfma_f32_16x16x32_bf16 v[0:3], a[136:139], v[136:139], v[0:3]
  buffer_load_dwordx4 v236, s[16:19], s29 offen offset:0 lds
  v_mfma_f32_16x16x32_bf16 v[0:3], a[140:143], v[140:143], v[0:3]
  ds_read_b128 a[148:151], v213 offset:4096
  v_mfma_f32_16x16x32_bf16 v[8:11], a[140:143], v[156:159], v[196:199]
  v_mfma_f32_16x16x32_bf16 v[8:11], a[136:139], v[152:155], v[8:11]
  ds_read_b128 a[152:155], v214 offset:4096
  v_mfma_f32_16x16x32_bf16 v[8:11], a[132:135], v[148:151], v[8:11]
  buffer_load_dwordx4 v237, s[16:19], s29 offen offset:1024 lds
  v_mfma_f32_16x16x32_bf16 v[8:11], a[128:131], v[144:147], v[8:11]
  ds_read_b128 a[156:159], v215 offset:4096
  v_mfma_f32_16x16x32_bf16 v[16:19], a[128:131], v[160:163], v[200:203]
  v_exp_f32 v0, v0
  v_mfma_f32_16x16x32_bf16 v[16:19], a[132:135], v[164:167], v[16:19]
  v_mfma_f32_16x16x32_bf16 v[16:19], a[136:139], v[168:171], v[16:19]
  v_exp_f32 v1, v1
  v_mfma_f32_16x16x32_bf16 v[16:19], a[140:143], v[172:175], v[16:19]
  v_cvt_pk_bf16_f32 v0, v0, v1
  v_mfma_f32_16x16x32_bf16 v[24:27], a[140:143], v[188:191], v[204:207]
  v_exp_f32 v2, v2
  v_mfma_f32_16x16x32_bf16 v[24:27], a[136:139], v[184:187], v[24:27]
  buffer_load_dwordx4 v236, s[16:19], s29 offen offset:2048 lds
  v_mfma_f32_16x16x32_bf16 v[24:27], a[132:135], v[180:183], v[24:27]
  s_waitcnt lgkmcnt(0)
  v_exp_f32 v3, v3
  v_mfma_f32_16x16x32_bf16 v[24:27], a[128:131], v[176:179], v[24:27]
  v_cvt_pk_bf16_f32 v1, v2, v3
  v_mfma_f32_16x16x32_bf16 v[4:7], a[144:147], v[128:131], v[192:195]
  v_exp_f32 v8, v8
  v_mfma_f32_16x16x32_bf16 v[4:7], a[148:151], v[132:135], v[4:7]
  ds_read_b128 a[128:131], v212 offset:8192
  v_mfma_f32_16x16x32_bf16 v[4:7], a[152:155], v[136:139], v[4:7]
  v_exp_f32 v9, v9
  v_mfma_f32_16x16x32_bf16 v[4:7], a[156:159], v[140:143], v[4:7]
  ds_read_b128 a[132:135], v213 offset:8192
  v_cvt_pk_bf16_f32 v8, v8, v9
  v_mfma_f32_16x16x32_bf16 v[12:15], a[156:159], v[156:159], v[196:199]
  v_exp_f32 v10, v10
  v_mfma_f32_16x16x32_bf16 v[12:15], a[152:155], v[152:155], v[12:15]
  ds_read_b128 a[136:139], v214 offset:8192
  v_mfma_f32_16x16x32_bf16 v[12:15], a[148:151], v[148:151], v[12:15]
  v_exp_f32 v11, v11
  v_mfma_f32_16x16x32_bf16 v[12:15], a[144:147], v[144:147], v[12:15]
  ds_read_b128 a[140:143], v215 offset:8192
  v_cvt_pk_bf16_f32 v9, v10, v11
  v_mfma_f32_16x16x32_bf16 v[20:23], a[144:147], v[160:163], v[200:203]
  v_exp_f32 v16, v16
  v_mfma_f32_16x16x32_bf16 v[20:23], a[148:151], v[164:167], v[20:23]
  buffer_load_dwordx4 v237, s[16:19], s29 offen offset:3072 lds
  v_mfma_f32_16x16x32_bf16 v[20:23], a[152:155], v[168:171], v[20:23]
  s_add_u32 s29, s29, 16384
  v_exp_f32 v17, v17
  v_mfma_f32_16x16x32_bf16 v[20:23], a[156:159], v[172:175], v[20:23]
  v_cvt_pk_bf16_f32 v16, v16, v17
  v_mfma_f32_16x16x32_bf16 v[28:31], a[156:159], v[188:191], v[204:207]
  s_add_u32 m0, s28, 32768
  v_exp_f32 v18, v18
  v_mfma_f32_16x16x32_bf16 v[28:31], a[152:155], v[184:187], v[28:31]
  buffer_load_dwordx4 v232, s[12:15], s29 offen offset:0 lds
  v_mfma_f32_16x16x32_bf16 v[28:31], a[148:151], v[180:183], v[28:31]
  s_waitcnt lgkmcnt(0)
  v_exp_f32 v19, v19
  v_mfma_f32_16x16x32_bf16 v[28:31], a[144:147], v[176:179], v[28:31]
  v_cvt_pk_bf16_f32 v17, v18, v19
  v_mfma_f32_16x16x32_bf16 v[32:35], a[128:131], v[128:131], v[192:195]
  v_exp_f32 v24, v24
  v_mfma_f32_16x16x32_bf16 v[32:35], a[132:135], v[132:135], v[32:35]
  ds_read_b128 a[144:147], v212 offset:12288
  v_mfma_f32_16x16x32_bf16 v[32:35], a[136:139], v[136:139], v[32:35]
  v_exp_f32 v25, v25
  v_mfma_f32_16x16x32_bf16 v[32:35], a[140:143], v[140:143], v[32:35]
  ds_read_b128 a[148:151], v213 offset:12288
  v_cvt_pk_bf16_f32 v24, v24, v25
  v_mfma_f32_16x16x32_bf16 v[40:43], a[140:143], v[156:159], v[196:199]
  v_exp_f32 v26, v26
  v_mfma_f32_16x16x32_bf16 v[40:43], a[136:139], v[152:155], v[40:43]
  ds_read_b128 a[152:155], v214 offset:12288
  v_mfma_f32_16x16x32_bf16 v[40:43], a[132:135], v[148:151], v[40:43]
  v_exp_f32 v27, v27
  v_mfma_f32_16x16x32_bf16 v[40:43], a[128:131], v[144:147], v[40:43]
  ds_read_b128 a[156:159], v215 offset:12288
  v_cvt_pk_bf16_f32 v25, v26, v27
  v_mfma_f32_16x16x32_bf16 v[48:51], a[128:131], v[160:163], v[200:203]
  v_exp_f32 v4, v4
  v_mfma_f32_16x16x32_bf16 v[48:51], a[132:135], v[164:167], v[48:51]
  buffer_load_dwordx4 v233, s[12:15], s29 offen offset:1024 lds
  v_mfma_f32_16x16x32_bf16 v[48:51], a[136:139], v[168:171], v[48:51]
  v_exp_f32 v5, v5
  v_mfma_f32_16x16x32_bf16 v[48:51], a[140:143], v[172:175], v[48:51]
  v_cvt_pk_bf16_f32 v2, v4, v5
  v_mfma_f32_16x16x32_bf16 v[56:59], a[140:143], v[188:191], v[204:207]
  v_exp_f32 v6, v6
  v_mfma_f32_16x16x32_bf16 v[56:59], a[136:139], v[184:187], v[56:59]
  buffer_load_dwordx4 v234, s[12:15], s29 offen offset:2048 lds
  v_mfma_f32_16x16x32_bf16 v[56:59], a[132:135], v[180:183], v[56:59]
  s_waitcnt lgkmcnt(0)
  v_exp_f32 v7, v7
  v_mfma_f32_16x16x32_bf16 v[56:59], a[128:131], v[176:179], v[56:59]
  v_cvt_pk_bf16_f32 v3, v6, v7
  v_mfma_f32_16x16x32_bf16 v[36:39], a[144:147], v[128:131], v[192:195]
  v_exp_f32 v12, v12
  v_mfma_f32_16x16x32_bf16 v[36:39], a[148:151], v[132:135], v[36:39]
  ds_read_b64_tr_b16 a[160:161], v216 offset:49152
  v_mfma_f32_16x16x32_bf16 v[36:39], a[152:155], v[136:139], v[36:39]
  v_exp_f32 v13, v13
  v_mfma_f32_16x16x32_bf16 v[36:39], a[156:159], v[140:143], v[36:39]
  ds_read_b64_tr_b16 a[162:163], v216 offset:53248
  v_cvt_pk_bf16_f32 v10, v12, v13
  v_mfma_f32_16x16x32_bf16 v[44:47], a[156:159], v[156:159], v[196:199]
  v_exp_f32 v14, v14
  v_mfma_f32_16x16x32_bf16 v[44:47], a[152:155], v[152:155], v[44:47]
  ds_read_b64_tr_b16 a[164:165], v216 offset:57344
  buffer_load_dwordx4 v235, s[12:15], s29 offen offset:3072 lds
  v_mfma_f32_16x16x32_bf16 v[44:47], a[148:151], v[148:151], v[44:47]
  v_exp_f32 v15, v15
  v_mfma_f32_16x16x32_bf16 v[44:47], a[144:147], v[144:147], v[44:47]
  ds_read_b64_tr_b16 a[166:167], v216 offset:61440
  v_cvt_pk_bf16_f32 v11, v14, v15
  v_mfma_f32_16x16x32_bf16 v[52:55], a[144:147], v[160:163], v[200:203]
  s_add_u32 m0, s50, 4096
  v_exp_f32 v20, v20
  v_mfma_f32_16x16x32_bf16 v[52:55], a[148:151], v[164:167], v[52:55]
  ds_read_b64_tr_b16 a[168:169], v217 offset:49152
  buffer_load_dwordx4 v208, s[20:23], s30 offen lds
  s_add_u32 s30, s30, 32
  v_mfma_f32_16x16x32_bf16 v[52:55], a[152:155], v[168:171], v[52:55]
  v_exp_f32 v21, v21
  v_mfma_f32_16x16x32_bf16 v[52:55], a[156:159], v[172:175], v[52:55]
  ds_read_b64_tr_b16 a[170:171], v217 offset:53248
  v_cvt_pk_bf16_f32 v18, v20, v21
  v_mfma_f32_16x16x32_bf16 v[60:63], a[156:159], v[188:191], v[204:207]
  v_exp_f32 v22, v22
  v_mfma_f32_16x16x32_bf16 v[60:63], a[152:155], v[184:187], v[60:63]
  ds_read_b64_tr_b16 a[172:173], v217 offset:57344
  v_mfma_f32_16x16x32_bf16 v[60:63], a[148:151], v[180:183], v[60:63]
  v_exp_f32 v23, v23
  v_mfma_f32_16x16x32_bf16 v[60:63], a[144:147], v[176:179], v[60:63]
  ds_read_b64_tr_b16 a[174:175], v217 offset:61440
  v_cvt_pk_bf16_f32 v19, v22, v23
  v_mfma_f32_16x16x32_bf16 a[192:195], a[208:211], v[64:67], a[192:195]
  v_exp_f32 v28, v28
  v_mfma_f32_16x16x32_bf16 a[192:195], a[208:211], v[96:99], a[192:195]
  ds_read_b64_tr_b16 a[176:177], v218 offset:49152
  v_add_u32 v245, 1, v245
  v_mfma_f32_16x16x32_bf16 a[196:199], a[208:211], v[72:75], a[196:199]
  v_exp_f32 v29, v29
  v_mfma_f32_16x16x32_bf16 a[196:199], a[208:211], v[104:107], a[196:199]
  ds_read_b64_tr_b16 a[178:179], v218 offset:53248
  v_cvt_pk_bf16_f32 v26, v28, v29
  v_mfma_f32_16x16x32_bf16 a[200:203], a[208:211], v[80:83], a[200:203]
  s_waitcnt vmcnt(11)
  v_exp_f32 v30, v30
  v_mfma_f32_16x16x32_bf16 a[200:203], a[208:211], v[112:115], a[200:203]
  ds_read_b64_tr_b16 a[180:181], v218 offset:57344
  ds_write_b32 v246, v245
  v_mfma_f32_16x16x32_bf16 a[204:207], a[208:211], v[88:91], a[204:207]
  s_waitcnt lgkmcnt(8)
  v_exp_f32 v31, v31
  v_mfma_f32_16x16x32_bf16 a[204:207], a[208:211], v[120:123], a[204:207]
  ds_read_b64_tr_b16 a[182:183], v218 offset:61440
  v_cvt_pk_bf16_f32 v27, v30, v31
  v_mfma_f32_16x16x32_bf16 a[0:3], a[160:163], v[64:67], a[0:3]
  v_exp_f32 v32, v32
  v_mfma_f32_16x16x32_bf16 a[0:3], a[164:167], v[96:99], a[0:3]
  ds_read_b64_tr_b16 a[184:185], v219 offset:49152
  v_mfma_f32_16x16x32_bf16 a[4:7], a[164:167], v[104:107], a[4:7]
  v_exp_f32 v33, v33
  v_mfma_f32_16x16x32_bf16 a[4:7], a[160:163], v[72:75], a[4:7]
  ds_read_b64_tr_b16 a[186:187], v219 offset:53248
  v_cvt_pk_bf16_f32 v32, v32, v33
  v_mfma_f32_16x16x32_bf16 a[8:11], a[160:163], v[80:83], a[8:11]
  v_exp_f32 v34, v34
  v_mfma_f32_16x16x32_bf16 a[8:11], a[164:167], v[112:115], a[8:11]
  ds_read_b64_tr_b16 a[188:189], v219 offset:57344
  v_mfma_f32_16x16x32_bf16 a[12:15], a[164:167], v[120:123], a[12:15]
  s_waitcnt lgkmcnt(8)
  v_exp_f32 v35, v35
  v_mfma_f32_16x16x32_bf16 a[12:15], a[160:163], v[88:91], a[12:15]
  ds_read_b64_tr_b16 a[190:191], v219 offset:61440
  v_cvt_pk_bf16_f32 v33, v34, v35
  v_mfma_f32_16x16x32_bf16 a[16:19], a[168:171], v[64:67], a[16:19]
  v_exp_f32 v40, v40
  v_mfma_f32_16x16x32_bf16 a[16:19], a[172:175], v[96:99], a[16:19]
  ds_read_b64_tr_b16 a[160:161], v220 offset:49152
  v_mfma_f32_16x16x32_bf16 a[20:23], a[172:175], v[104:107], a[20:23]
  v_exp_f32 v41, v41
  v_mfma_f32_16x16x32_bf16 a[20:23], a[168:171], v[72:75], a[20:23]
  ds_read_b64_tr_b16 a[162:163], v220 offset:53248
  v_cvt_pk_bf16_f32 v40, v40, v41
  v_mfma_f32_16x16x32_bf16 a[24:27], a[168:171], v[80:83], a[24:27]
  v_exp_f32 v42, v42
  v_mfma_f32_16x16x32_bf16 a[24:27], a[172:175], v[112:115], a[24:27]
  ds_read_b64_tr_b16 a[164:165], v220 offset:57344
  v_mfma_f32_16x16x32_bf16 a[28:31], a[172:175], v[120:123], a[28:31]
  s_waitcnt lgkmcnt(7)
  v_exp_f32 v43, v43
  v_mfma_f32_16x16x32_bf16 a[28:31], a[168:171], v[88:91], a[28:31]
  ds_read_b64_tr_b16 a[166:167], v220 offset:61440
  v_cvt_pk_bf16_f32 v41, v42, v43
  v_mfma_f32_16x16x32_bf16 a[32:35], a[176:179], v[64:67], a[32:35]
  v_exp_f32 v48, v48
  v_mfma_f32_16x16x32_bf16 a[32:35], a[180:183], v[96:99], a[32:35]
  ds_read_b64_tr_b16 a[168:169], v221 offset:49152
  v_mfma_f32_16x16x32_bf16 a[36:39], a[180:183], v[104:107], a[36:39]
  v_exp_f32 v49, v49
  v_mfma_f32_16x16x32_bf16 a[36:39], a[176:179], v[72:75], a[36:39]
  ds_read_b64_tr_b16 a[170:171], v221 offset:53248
  v_cvt_pk_bf16_f32 v48, v48, v49
  v_mfma_f32_16x16x32_bf16 a[40:43], a[176:179], v[80:83], a[40:43]
  v_exp_f32 v50, v50
  v_mfma_f32_16x16x32_bf16 a[40:43], a[180:183], v[112:115], a[40:43]
  ds_read_b64_tr_b16 a[172:173], v221 offset:57344
  v_mfma_f32_16x16x32_bf16 a[44:47], a[180:183], v[120:123], a[44:47]
  s_waitcnt lgkmcnt(7)
  v_exp_f32 v51, v51
  v_mfma_f32_16x16x32_bf16 a[44:47], a[176:179], v[88:91], a[44:47]
  ds_read_b64_tr_b16 a[174:175], v221 offset:61440
  v_cvt_pk_bf16_f32 v49, v50, v51
  v_mfma_f32_16x16x32_bf16 a[48:51], a[184:187], v[64:67], a[48:51]
  v_exp_f32 v56, v56
  v_mfma_f32_16x16x32_bf16 a[48:51], a[188:191], v[96:99], a[48:51]
  ds_read_b64_tr_b16 a[176:177], v222 offset:49152
  v_mfma_f32_16x16x32_bf16 a[52:55], a[188:191], v[104:107], a[52:55]
  v_exp_f32 v57, v57
  v_mfma_f32_16x16x32_bf16 a[52:55], a[184:187], v[72:75], a[52:55]
  ds_read_b64_tr_b16 a[178:179], v222 offset:53248
  v_cvt_pk_bf16_f32 v56, v56, v57
  v_mfma_f32_16x16x32_bf16 a[56:59], a[184:187], v[80:83], a[56:59]
  v_exp_f32 v58, v58
  v_mfma_f32_16x16x32_bf16 a[56:59], a[188:191], v[112:115], a[56:59]
  ds_read_b64_tr_b16 a[180:181], v222 offset:57344
  global_load_dword v255, v252, s[8:9]
  v_mfma_f32_16x16x32_bf16 a[60:63], a[188:191], v[120:123], a[60:63]
  s_waitcnt lgkmcnt(7)
  v_exp_f32 v59, v59
  v_mfma_f32_16x16x32_bf16 a[60:63], a[184:187], v[88:91], a[60:63]
  ds_read_b64_tr_b16 a[182:183], v222 offset:61440
  v_cvt_pk_bf16_f32 v57, v58, v59
  v_mfma_f32_16x16x32_bf16 a[64:67], a[160:163], v[64:67], a[64:67]
  v_exp_f32 v36, v36
  v_mfma_f32_16x16x32_bf16 a[64:67], a[164:167], v[96:99], a[64:67]
  ds_read_b64_tr_b16 a[184:185], v223 offset:49152
  ds_read_b32 v248, v247
  v_mfma_f32_16x16x32_bf16 a[68:71], a[164:167], v[104:107], a[68:71]
  v_exp_f32 v37, v37
  v_mfma_f32_16x16x32_bf16 a[68:71], a[160:163], v[72:75], a[68:71]
  ds_read_b64_tr_b16 a[186:187], v223 offset:53248
  v_cvt_pk_bf16_f32 v34, v36, v37
  v_mfma_f32_16x16x32_bf16 a[72:75], a[160:163], v[80:83], a[72:75]
  v_exp_f32 v38, v38
  v_mfma_f32_16x16x32_bf16 a[72:75], a[164:167], v[112:115], a[72:75]
  ds_read_b64_tr_b16 a[188:189], v223 offset:57344
  v_mfma_f32_16x16x32_bf16 a[76:79], a[164:167], v[120:123], a[76:79]
  s_waitcnt lgkmcnt(8)
  v_exp_f32 v39, v39
  v_mfma_f32_16x16x32_bf16 a[76:79], a[160:163], v[88:91], a[76:79]
  ds_read_b64_tr_b16 a[190:191], v223 offset:61440
  v_cvt_pk_bf16_f32 v35, v38, v39
  v_mfma_f32_16x16x32_bf16 a[80:83], a[168:171], v[64:67], a[80:83]
  s_waitcnt lgkmcnt(3)
  v_exp_f32 v44, v44
  v_mfma_f32_16x16x32_bf16 a[80:83], a[172:175], v[96:99], a[80:83]
  v_cmp_lt_u32 vcc, v248, v245
  v_mfma_f32_16x16x32_bf16 a[84:87], a[172:175], v[104:107], a[84:87]
  s_cbranch_vccnz attn_wait7
attn_on7:
  v_exp_f32 v45, v45
  v_mfma_f32_16x16x32_bf16 a[84:87], a[168:171], v[72:75], a[84:87]
  ds_read_b128 a[128:131], v212 offset:16384
  v_cvt_pk_bf16_f32 v42, v44, v45
  v_mfma_f32_16x16x32_bf16 a[88:91], a[168:171], v[80:83], a[88:91]
  v_exp_f32 v46, v46
  v_mfma_f32_16x16x32_bf16 a[88:91], a[172:175], v[112:115], a[88:91]
  ds_read_b128 a[132:135], v213 offset:16384
  v_mfma_f32_16x16x32_bf16 a[92:95], a[172:175], v[120:123], a[92:95]
  v_exp_f32 v47, v47
  v_mfma_f32_16x16x32_bf16 a[92:95], a[168:171], v[88:91], a[92:95]
  ds_read_b128 a[136:139], v214 offset:16384
  v_cvt_pk_bf16_f32 v43, v46, v47
  v_mfma_f32_16x16x32_bf16 a[96:99], a[176:179], v[64:67], a[96:99]
  v_exp_f32 v52, v52
  v_mfma_f32_16x16x32_bf16 a[96:99], a[180:183], v[96:99], a[96:99]
  ds_read_b128 a[140:143], v215 offset:16384
  v_mfma_f32_16x16x32_bf16 a[100:103], a[180:183], v[104:107], a[100:103]
  v_exp_f32 v53, v53
  v_mfma_f32_16x16x32_bf16 a[100:103], a[176:179], v[72:75], a[100:103]
  v_cvt_pk_bf16_f32 v50, v52, v53
  v_mfma_f32_16x16x32_bf16 a[104:107], a[176:179], v[80:83], a[104:107]
  v_exp_f32 v54, v54
  v_mfma_f32_16x16x32_bf16 a[104:107], a[180:183], v[112:115], a[104:107]
  v_mfma_f32_16x16x32_bf16 a[108:111], a[180:183], v[120:123], a[108:111]
  s_waitcnt lgkmcnt(4)
  v_exp_f32 v55, v55
  v_mfma_f32_16x16x32_bf16 a[108:111], a[176:179], v[88:91], a[108:111]
  v_cvt_pk_bf16_f32 v51, v54, v55
  v_mfma_f32_16x16x32_bf16 a[112:115], a[184:187], v[64:67], a[112:115]
  v_exp_f32 v60, v60
  v_mfma_f32_16x16x32_bf16 a[112:115], a[188:191], v[96:99], a[112:115]
  v_mfma_f32_16x16x32_bf16 a[116:119], a[188:191], v[104:107], a[116:119]
  v_exp_f32 v61, v61
  v_mfma_f32_16x16x32_bf16 a[116:119], a[184:187], v[72:75], a[116:119]
  v_cvt_pk_bf16_f32 v58, v60, v61
  v_mfma_f32_16x16x32_bf16 a[120:123], a[184:187], v[80:83], a[120:123]
  v_exp_f32 v62, v62
  v_mfma_f32_16x16x32_bf16 a[120:123], a[188:191], v[112:115], a[120:123]
  v_mfma_f32_16x16x32_bf16 a[124:127], a[188:191], v[120:123], a[124:127]
  s_waitcnt lgkmcnt(0)
  v_exp_f32 v63, v63
  v_mfma_f32_16x16x32_bf16 a[124:127], a[184:187], v[88:91], a[124:127]
  v_cvt_pk_bf16_f32 v59, v62, v63
  v_mfma_f32_16x16x32_bf16 v[64:67], a[128:131], v[128:131], v[192:195]
  s_add_u32 m0, s28, 98304
  v_mfma_f32_16x16x32_bf16 v[64:67], a[132:135], v[132:135], v[64:67]
  ds_read_b128 a[144:147], v212 offset:20480
  v_mfma_f32_16x16x32_bf16 v[64:67], a[136:139], v[136:139], v[64:67]
  buffer_load_dwordx4 v236, s[16:19], s29 offen offset:0 lds
  v_mfma_f32_16x16x32_bf16 v[64:67], a[140:143], v[140:143], v[64:67]
  ds_read_b128 a[148:151], v213 offset:20480
  v_mfma_f32_16x16x32_bf16 v[72:75], a[140:143], v[156:159], v[196:199]
  v_mfma_f32_16x16x32_bf16 v[72:75], a[136:139], v[152:155], v[72:75]
  ds_read_b128 a[152:155], v214 offset:20480
  v_mfma_f32_16x16x32_bf16 v[72:75], a[132:135], v[148:151], v[72:75]
  buffer_load_dwordx4 v237, s[16:19], s29 offen offset:1024 lds
  v_mfma_f32_16x16x32_bf16 v[72:75], a[128:131], v[144:147], v[72:75]
  ds_read_b128 a[156:159], v215 offset:20480
  v_mfma_f32_16x16x32_bf16 v[80:83], a[128:131], v[160:163], v[200:203]
  v_exp_f32 v64, v64
  v_mfma_f32_16x16x32_bf16 v[80:83], a[132:135], v[164:167], v[80:83]
  v_mfma_f32_16x16x32_bf16 v[80:83], a[136:139], v[168:171], v[80:83]
  v_exp_f32 v65, v65
  v_mfma_f32_16x16x32_bf16 v[80:83], a[140:143], v[172:175], v[80:83]
  v_cvt_pk_bf16_f32 v64, v64, v65
  v_mfma_f32_16x16x32_bf16 v[88:91], a[140:143], v[188:191], v[204:207]
  v_exp_f32 v66, v66
  v_mfma_f32_16x16x32_bf16 v[88:91], a[136:139], v[184:187], v[88:91]
  buffer_load_dwordx4 v236, s[16:19], s29 offen offset:2048 lds
  v_mfma_f32_16x16x32_bf16 v[88:91], a[132:135], v[180:183], v[88:91]
  s_waitcnt lgkmcnt(0)
  v_exp_f32 v67, v67
  v_mfma_f32_16x16x32_bf16 v[88:91], a[128:131], v[176:179], v[88:91]
  v_cvt_pk_bf16_f32 v65, v66, v67
  v_mfma_f32_16x16x32_bf16 v[68:71], a[144:147], v[128:131], v[192:195]
  v_exp_f32 v72, v72
  v_mfma_f32_16x16x32_bf16 v[68:71], a[148:151], v[132:135], v[68:71]
  ds_read_b128 a[128:131], v212 offset:24576
  v_mfma_f32_16x16x32_bf16 v[68:71], a[152:155], v[136:139], v[68:71]
  v_exp_f32 v73, v73
  v_mfma_f32_16x16x32_bf16 v[68:71], a[156:159], v[140:143], v[68:71]
  ds_read_b128 a[132:135], v213 offset:24576
  v_cvt_pk_bf16_f32 v72, v72, v73
  v_mfma_f32_16x16x32_bf16 v[76:79], a[156:159], v[156:159], v[196:199]
  v_exp_f32 v74, v74
  v_mfma_f32_16x16x32_bf16 v[76:79], a[152:155], v[152:155], v[76:79]
  ds_read_b128 a[136:139], v214 offset:24576
  v_mfma_f32_16x16x32_bf16 v[76:79], a[148:151], v[148:151], v[76:79]
  v_exp_f32 v75, v75
  v_mfma_f32_16x16x32_bf16 v[76:79], a[144:147], v[144:147], v[76:79]
  ds_read_b128 a[140:143], v215 offset:24576
  v_cvt_pk_bf16_f32 v73, v74, v75
  v_mfma_f32_16x16x32_bf16 v[84:87], a[144:147], v[160:163], v[200:203]
  v_exp_f32 v80, v80
  v_mfma_f32_16x16x32_bf16 v[84:87], a[148:151], v[164:167], v[84:87]
  buffer_load_dwordx4 v237, s[16:19], s29 offen offset:3072 lds
  v_mfma_f32_16x16x32_bf16 v[84:87], a[152:155], v[168:171], v[84:87]
  s_add_u32 s29, s29, 16384
  v_exp_f32 v81, v81
  v_mfma_f32_16x16x32_bf16 v[84:87], a[156:159], v[172:175], v[84:87]
  v_cvt_pk_bf16_f32 v80, v80, v81
  v_mfma_f32_16x16x32_bf16 v[92:95], a[156:159], v[188:191], v[204:207]
  s_add_u32 m0, s28, 49152
  v_exp_f32 v82, v82
  v_mfma_f32_16x16x32_bf16 v[92:95], a[152:155], v[184:187], v[92:95]
  buffer_load_dwordx4 v232, s[12:15], s29 offen offset:0 lds
  v_mfma_f32_16x16x32_bf16 v[92:95], a[148:151], v[180:183], v[92:95]
  s_waitcnt lgkmcnt(0)
  v_exp_f32 v83, v83
  v_mfma_f32_16x16x32_bf16 v[92:95], a[144:147], v[176:179], v[92:95]
  v_cvt_pk_bf16_f32 v81, v82, v83
  v_mfma_f32_16x16x32_bf16 v[96:99], a[128:131], v[128:131], v[192:195]
  v_exp_f32 v88, v88
  v_mfma_f32_16x16x32_bf16 v[96:99], a[132:135], v[132:135], v[96:99]
  ds_read_b128 a[144:147], v212 offset:28672
  v_mfma_f32_16x16x32_bf16 v[96:99], a[136:139], v[136:139], v[96:99]
  v_exp_f32 v89, v89
  v_mfma_f32_16x16x32_bf16 v[96:99], a[140:143], v[140:143], v[96:99]
  ds_read_b128 a[148:151], v213 offset:28672
  v_cvt_pk_bf16_f32 v88, v88, v89
  v_mfma_f32_16x16x32_bf16 v[104:107], a[140:143], v[156:159], v[196:199]
  v_exp_f32 v90, v90
  v_mfma_f32_16x16x32_bf16 v[104:107], a[136:139], v[152:155], v[104:107]
  ds_read_b128 a[152:155], v214 offset:28672
  v_mfma_f32_16x16x32_bf16 v[104:107], a[132:135], v[148:151], v[104:107]
  v_exp_f32 v91, v91
  v_mfma_f32_16x16x32_bf16 v[104:107], a[128:131], v[144:147], v[104:107]
  ds_read_b128 a[156:159], v215 offset:28672
  v_cvt_pk_bf16_f32 v89, v90, v91
  v_mfma_f32_16x16x32_bf16 v[112:115], a[128:131], v[160:163], v[200:203]
  v_exp_f32 v68, v68
  v_mfma_f32_16x16x32_bf16 v[112:115], a[132:135], v[164:167], v[112:115]
  buffer_load_dwordx4 v233, s[12:15], s29 offen offset:1024 lds
  v_mfma_f32_16x16x32_bf16 v[112:115], a[136:139], v[168:171], v[112:115]
  v_exp_f32 v69, v69
  v_mfma_f32_16x16x32_bf16 v[112:115], a[140:143], v[172:175], v[112:115]
  v_cvt_pk_bf16_f32 v66, v68, v69
  v_mfma_f32_16x16x32_bf16 v[120:123], a[140:143], v[188:191], v[204:207]
  v_exp_f32 v70, v70
  v_mfma_f32_16x16x32_bf16 v[120:123], a[136:139], v[184:187], v[120:123]
  buffer_load_dwordx4 v234, s[12:15], s29 offen offset:2048 lds
  v_mfma_f32_16x16x32_bf16 v[120:123], a[132:135], v[180:183], v[120:123]
  s_waitcnt lgkmcnt(0)
  v_exp_f32 v71, v71
  v_mfma_f32_16x16x32_bf16 v[120:123], a[128:131], v[176:179], v[120:123]
  v_cvt_pk_bf16_f32 v67, v70, v71
  v_mfma_f32_16x16x32_bf16 v[100:103], a[144:147], v[128:131], v[192:195]
  v_exp_f32 v76, v76
  v_mfma_f32_16x16x32_bf16 v[100:103], a[148:151], v[132:135], v[100:103]
  ds_read_b64_tr_b16 a[160:161], v216 offset:0
  v_mfma_f32_16x16x32_bf16 v[100:103], a[152:155], v[136:139], v[100:103]
  v_exp_f32 v77, v77
  v_mfma_f32_16x16x32_bf16 v[100:103], a[156:159], v[140:143], v[100:103]
  ds_read_b64_tr_b16 a[162:163], v216 offset:4096
  v_cvt_pk_bf16_f32 v74, v76, v77
  v_mfma_f32_16x16x32_bf16 v[108:111], a[156:159], v[156:159], v[196:199]
  v_exp_f32 v78, v78
  v_mfma_f32_16x16x32_bf16 v[108:111], a[152:155], v[152:155], v[108:111]
  ds_read_b64_tr_b16 a[164:165], v216 offset:8192
  buffer_load_dwordx4 v235, s[12:15], s29 offen offset:3072 lds
  v_mfma_f32_16x16x32_bf16 v[108:111], a[148:151], v[148:151], v[108:111]
  v_exp_f32 v79, v79
  v_mfma_f32_16x16x32_bf16 v[108:111], a[144:147], v[144:147], v[108:111]
  ds_read_b64_tr_b16 a[166:167], v216 offset:12288
  v_cvt_pk_bf16_f32 v75, v78, v79
  v_mfma_f32_16x16x32_bf16 v[116:119], a[144:147], v[160:163], v[200:203]
  s_add_u32 m0, s50, 5120
  v_exp_f32 v84, v84
  v_mfma_f32_16x16x32_bf16 v[116:119], a[148:151], v[164:167], v[116:119]
  ds_read_b64_tr_b16 a[168:169], v217 offset:0
  buffer_load_dwordx4 v208, s[20:23], s30 offen lds
  s_add_u32 s30, s30, 32
  v_mfma_f32_16x16x32_bf16 v[116:119], a[152:155], v[168:171], v[116:119]
  v_exp_f32 v85, v85
  v_mfma_f32_16x16x32_bf16 v[116:119], a[156:159], v[172:175], v[116:119]
  ds_read_b64_tr_b16 a[170:171], v217 offset:4096
  v_cvt_pk_bf16_f32 v82, v84, v85
  v_mfma_f32_16x16x32_bf16 v[124:127], a[156:159], v[188:191], v[204:207]
  v_exp_f32 v86, v86
  v_mfma_f32_16x16x32_bf16 v[124:127], a[152:155], v[184:187], v[124:127]
  ds_read_b64_tr_b16 a[172:173], v217 offset:8192
  v_mfma_f32_16x16x32_bf16 v[124:127], a[148:151], v[180:183], v[124:127]
  v_exp_f32 v87, v87
  v_mfma_f32_16x16x32_bf16 v[124:127], a[144:147], v[176:179], v[124:127]
  ds_read_b64_tr_b16 a[174:175], v217 offset:12288
  v_cvt_pk_bf16_f32 v83, v86, v87
  v_mfma_f32_16x16x32_bf16 a[192:195], a[208:211], v[0:3], a[192:195]
  v_exp_f32 v92, v92
  v_mfma_f32_16x16x32_bf16 a[192:195], a[208:211], v[32:35], a[192:195]
  ds_read_b64_tr_b16 a[176:177], v218 offset:0
  v_add_u32 v245, 1, v245
  v_mfma_f32_16x16x32_bf16 a[196:199], a[208:211], v[8:11], a[196:199]
  v_exp_f32 v93, v93
  v_mfma_f32_16x16x32_bf16 a[196:199], a[208:211], v[40:43], a[196:199]
  ds_read_b64_tr_b16 a[178:179], v218 offset:4096
  v_cvt_pk_bf16_f32 v90, v92, v93
  v_mfma_f32_16x16x32_bf16 a[200:203], a[208:211], v[16:19], a[200:203]
  s_waitcnt vmcnt(11)
  v_exp_f32 v94, v94
  v_mfma_f32_16x16x32_bf16 a[200:203], a[208:211], v[48:51], a[200:203]
  ds_read_b64_tr_b16 a[180:181], v218 offset:8192
  ds_write_b32 v246, v245
  v_mfma_f32_16x16x32_bf16 a[204:207], a[208:211], v[24:27], a[204:207]
  s_waitcnt lgkmcnt(8)
  v_exp_f32 v95, v95
  v_mfma_f32_16x16x32_bf16 a[204:207], a[208:211], v[56:59], a[204:207]
  ds_read_b64_tr_b16 a[182:183], v218 offset:12288
  v_cvt_pk_bf16_f32 v91, v94, v95
  v_mfma_f32_16x16x32_bf16 a[0:3], a[160:163], v[0:3], a[0:3]
  v_exp_f32 v96, v96
  v_mfma_f32_16x16x32_bf16 a[0:3], a[164:167], v[32:35], a[0:3]
  ds_read_b64_tr_b16 a[184:185], v219 offset:0
  v_mfma_f32_16x16x32_bf16 a[4:7], a[164:167], v[40:43], a[4:7]
  v_exp_f32 v97, v97
  v_mfma_f32_16x16x32_bf16 a[4:7], a[160:163], v[8:11], a[4:7]
  ds_read_b64_tr_b16 a[186:187], v219 offset:4096
  v_cvt_pk_bf16_f32 v96, v96, v97
  v_mfma_f32_16x16x32_bf16 a[8:11], a[160:163], v[16:19], a[8:11]
  v_exp_f32 v98, v98
  v_mfma_f32_16x16x32_bf16 a[8:11], a[164:167], v[48:51], a[8:11]
  ds_read_b64_tr_b16 a[188:189], v219 offset:8192
  v_mfma_f32_16x16x32_bf16 a[12:15], a[164:167], v[56:59], a[12:15]
  s_waitcnt lgkmcnt(8)
  v_exp_f32 v99, v99
  v_mfma_f32_16x16x32_bf16 a[12:15], a[160:163], v[24:27], a[12:15]
  ds_read_b64_tr_b16 a[190:191], v219 offset:12288
  v_cvt_pk_bf16_f32 v97, v98, v99
  v_mfma_f32_16x16x32_bf16 a[16:19], a[168:171], v[0:3], a[16:19]
  v_exp_f32 v104, v104
  v_mfma_f32_16x16x32_bf16 a[16:19], a[172:175], v[32:35], a[16:19]
  ds_read_b64_tr_b16 a[160:161], v220 offset:0
  v_mfma_f32_16x16x32_bf16 a[20:23], a[172:175], v[40:43], a[20:23]
  v_exp_f32 v105, v105
  v_mfma_f32_16x16x32_bf16 a[20:23], a[168:171], v[8:11], a[20:23]
  ds_read_b64_tr_b16 a[162:163], v220 offset:4096
  v_cvt_pk_bf16_f32 v104, v104, v105
  v_mfma_f32_16x16x32_bf16 a[24:27], a[168:171], v[16:19], a[24:27]
  v_exp_f32 v106, v106
  v_mfma_f32_16x16x32_bf16 a[24:27], a[172:175], v[48:51], a[24:27]
  ds_read_b64_tr_b16 a[164:165], v220 offset:8192
  v_mfma_f32_16x16x32_bf16 a[28:31], a[172:175], v[56:59], a[28:31]
  s_waitcnt lgkmcnt(7)
  v_exp_f32 v107, v107
  v_mfma_f32_16x16x32_bf16 a[28:31], a[168:171], v[24:27], a[28:31]
  ds_read_b64_tr_b16 a[166:167], v220 offset:12288
  v_cvt_pk_bf16_f32 v105, v106, v107
  v_mfma_f32_16x16x32_bf16 a[32:35], a[176:179], v[0:3], a[32:35]
  v_exp_f32 v112, v112
  v_mfma_f32_16x16x32_bf16 a[32:35], a[180:183], v[32:35], a[32:35]
  ds_read_b64_tr_b16 a[168:169], v221 offset:0
  v_mfma_f32_16x16x32_bf16 a[36:39], a[180:183], v[40:43], a[36:39]
  v_exp_f32 v113, v113
  v_mfma_f32_16x16x32_bf16 a[36:39], a[176:179], v[8:11], a[36:39]
  ds_read_b64_tr_b16 a[170:171], v221 offset:4096
  v_cvt_pk_bf16_f32 v112, v112, v113
  v_mfma_f32_16x16x32_bf16 a[40:43], a[176:179], v[16:19], a[40:43]
  v_exp_f32 v114, v114
  v_mfma_f32_16x16x32_bf16 a[40:43], a[180:183], v[48:51], a[40:43]
  ds_read_b64_tr_b16 a[172:173], v221 offset:8192
  v_mfma_f32_16x16x32_bf16 a[44:47], a[180:183], v[56:59], a[44:47]
  s_waitcnt lgkmcnt(7)
  v_exp_f32 v115, v115
  v_mfma_f32_16x16x32_bf16 a[44:47], a[176:179], v[24:27], a[44:47]
  ds_read_b64_tr_b16 a[174:175], v221 offset:12288
  v_cvt_pk_bf16_f32 v113, v114, v115
  v_mfma_f32_16x16x32_bf16 a[48:51], a[184:187], v[0:3], a[48:51]
  v_exp_f32 v120, v120
  v_mfma_f32_16x16x32_bf16 a[48:51], a[188:191], v[32:35], a[48:51]
  ds_read_b64_tr_b16 a[176:177], v222 offset:0
  v_mfma_f32_16x16x32_bf16 a[52:55], a[188:191], v[40:43], a[52:55]
  v_exp_f32 v121, v121
  v_mfma_f32_16x16x32_bf16 a[52:55], a[184:187], v[8:11], a[52:55]
  ds_read_b64_tr_b16 a[178:179], v222 offset:4096
  v_cvt_pk_bf16_f32 v120, v120, v121
  v_mfma_f32_16x16x32_bf16 a[56:59], a[184:187], v[16:19], a[56:59]
  v_exp_f32 v122, v122
  v_mfma_f32_16x16x32_bf16 a[56:59], a[188:191], v[48:51], a[56:59]
  ds_read_b64_tr_b16 a[180:181], v222 offset:8192
  v_mfma_f32_16x16x32_bf16 a[60:63], a[188:191], v[56:59], a[60:63]
  s_waitcnt lgkmcnt(7)
  v_exp_f32 v123, v123
  v_mfma_f32_16x16x32_bf16 a[60:63], a[184:187], v[24:27], a[60:63]
  ds_read_b64_tr_b16 a[182:183], v222 offset:12288
  v_cvt_pk_bf16_f32 v121, v122, v123
  v_mfma_f32_16x16x32_bf16 a[64:67], a[160:163], v[0:3], a[64:67]
  v_exp_f32 v100, v100
  v_mfma_f32_16x16x32_bf16 a[64:67], a[164:167], v[32:35], a[64:67]
  ds_read_b64_tr_b16 a[184:185], v223 offset:0
  ds_read_b32 v248, v247
  v_mfma_f32_16x16x32_bf16 a[68:71], a[164:167], v[40:43], a[68:71]
  v_exp_f32 v101, v101
  v_mfma_f32_16x16x32_bf16 a[68:71], a[160:163], v[8:11], a[68:71]
  ds_read_b64_tr_b16 a[186:187], v223 offset:4096
  v_cvt_pk_bf16_f32 v98, v100, v101
  v_mfma_f32_16x16x32_bf16 a[72:75], a[160:163], v[16:19], a[72:75]
  v_exp_f32 v102, v102
  v_mfma_f32_16x16x32_bf16 a[72:75], a[164:167], v[48:51], a[72:75]
  ds_read_b64_tr_b16 a[188:189], v223 offset:8192
  v_mfma_f32_16x16x32_bf16 a[76:79], a[164:167], v[56:59], a[76:79]
  s_waitcnt lgkmcnt(8)
  v_exp_f32 v103, v103
  v_mfma_f32_16x16x32_bf16 a[76:79], a[160:163], v[24:27], a[76:79]
  ds_read_b64_tr_b16 a[190:191], v223 offset:12288
  v_cvt_pk_bf16_f32 v99, v102, v103
  v_mfma_f32_16x16x32_bf16 a[80:83], a[168:171], v[0:3], a[80:83]
  s_waitcnt lgkmcnt(3)
  v_exp_f32 v108, v108
  v_mfma_f32_16x16x32_bf16 a[80:83], a[172:175], v[32:35], a[80:83]
  v_cmp_lt_u32 vcc, v248, v245
  v_mfma_f32_16x16x32_bf16 a[84:87], a[172:175], v[40:43], a[84:87]
  s_cbranch_vccnz attn_wait8
attn_on8:
  v_exp_f32 v109, v109
  v_mfma_f32_16x16x32_bf16 a[84:87], a[168:171], v[8:11], a[84:87]
  ds_read_b128 a[128:131], v212 offset:32768
  v_cvt_pk_bf16_f32 v106, v108, v109
  v_mfma_f32_16x16x32_bf16 a[88:91], a[168:171], v[16:19], a[88:91]
  v_exp_f32 v110, v110
  v_mfma_f32_16x16x32_bf16 a[88:91], a[172:175], v[48:51], a[88:91]
  ds_read_b128 a[132:135], v213 offset:32768
  buffer_atomic_add v250, v249, s[24:27], s47 offen
  s_cmp_eq_u32 s32, 3
  s_cselect_b32 s39, 0, 1073741824
  v_mfma_f32_16x16x32_bf16 a[92:95], a[172:175], v[56:59], a[92:95]
  v_exp_f32 v111, v111
  v_mfma_f32_16x16x32_bf16 a[92:95], a[168:171], v[24:27], a[92:95]
  ds_read_b128 a[136:139], v214 offset:32768
  v_cvt_pk_bf16_f32 v107, v110, v111
  v_mfma_f32_16x16x32_bf16 a[96:99], a[176:179], v[0:3], a[96:99]
  v_exp_f32 v116, v116
  v_mfma_f32_16x16x32_bf16 a[96:99], a[180:183], v[32:35], a[96:99]
  ds_read_b128 a[140:143], v215 offset:32768
  v_or_b32 v249, s39, v251
  v_mfma_f32_16x16x32_bf16 a[100:103], a[180:183], v[40:43], a[100:103]
  v_exp_f32 v117, v117
  v_mfma_f32_16x16x32_bf16 a[100:103], a[176:179], v[8:11], a[100:103]
  v_cvt_pk_bf16_f32 v114, v116, v117
  v_mfma_f32_16x16x32_bf16 a[104:107], a[176:179], v[16:19], a[104:107]
  v_exp_f32 v118, v118
  v_mfma_f32_16x16x32_bf16 a[104:107], a[180:183], v[48:51], a[104:107]
  v_mfma_f32_16x16x32_bf16 a[108:111], a[180:183], v[56:59], a[108:111]
  s_waitcnt lgkmcnt(4)
  v_exp_f32 v119, v119
  v_mfma_f32_16x16x32_bf16 a[108:111], a[176:179], v[24:27], a[108:111]
  v_cvt_pk_bf16_f32 v115, v118, v119
  v_mfma_f32_16x16x32_bf16 a[112:115], a[184:187], v[0:3], a[112:115]
  v_exp_f32 v124, v124
  v_mfma_f32_16x16x32_bf16 a[112:115], a[188:191], v[32:35], a[112:115]
  v_mfma_f32_16x16x32_bf16 a[116:119], a[188:191], v[40:43], a[116:119]
  v_exp_f32 v125, v125
  v_mfma_f32_16x16x32_bf16 a[116:119], a[184:187], v[8:11], a[116:119]
  v_cvt_pk_bf16_f32 v122, v124, v125
  v_mfma_f32_16x16x32_bf16 a[120:123], a[184:187], v[16:19], a[120:123]
  v_exp_f32 v126, v126
  v_mfma_f32_16x16x32_bf16 a[120:123], a[188:191], v[48:51], a[120:123]
  v_mfma_f32_16x16x32_bf16 a[124:127], a[188:191], v[56:59], a[124:127]
  s_waitcnt lgkmcnt(0)
  v_exp_f32 v127, v127
  v_mfma_f32_16x16x32_bf16 a[124:127], a[184:187], v[24:27], a[124:127]
  v_cvt_pk_bf16_f32 v123, v126, v127
  v_mfma_f32_16x16x32_bf16 v[0:3], a[128:131], v[128:131], v[192:195]
  s_add_u32 m0, s28, 114688
  v_mfma_f32_16x16x32_bf16 v[0:3], a[132:135], v[132:135], v[0:3]
  ds_read_b128 a[144:147], v212 offset:36864
  v_mfma_f32_16x16x32_bf16 v[0:3], a[136:139], v[136:139], v[0:3]
  buffer_load_dwordx4 v236, s[16:19], s29 offen offset:0 lds
  v_mfma_f32_16x16x32_bf16 v[0:3], a[140:143], v[140:143], v[0:3]
  ds_read_b128 a[148:151], v213 offset:36864
  v_mfma_f32_16x16x32_bf16 v[8:11], a[140:143], v[156:159], v[196:199]
  v_mfma_f32_16x16x32_bf16 v[8:11], a[136:139], v[152:155], v[8:11]
  ds_read_b128 a[152:155], v214 offset:36864
  v_mfma_f32_16x16x32_bf16 v[8:11], a[132:135], v[148:151], v[8:11]
  buffer_load_dwordx4 v237, s[16:19], s29 offen offset:1024 lds
  v_mfma_f32_16x16x32_bf16 v[8:11], a[128:131], v[144:147], v[8:11]
  ds_read_b128 a[156:159], v215 offset:36864
  v_mfma_f32_16x16x32_bf16 v[16:19], a[128:131], v[160:163], v[200:203]
  v_exp_f32 v0, v0
  v_mfma_f32_16x16x32_bf16 v[16:19], a[132:135], v[164:167], v[16:19]
  v_mfma_f32_16x16x32_bf16 v[16:19], a[136:139], v[168:171], v[16:19]
  v_exp_f32 v1, v1
  v_mfma_f32_16x16x32_bf16 v[16:19], a[140:143], v[172:175], v[16:19]
  v_cvt_pk_bf16_f32 v0, v0, v1
  v_mfma_f32_16x16x32_bf16 v[24:27], a[140:143], v[188:191], v[204:207]
  v_exp_f32 v2, v2
  v_mfma_f32_16x16x32_bf16 v[24:27], a[136:139], v[184:187], v[24:27]
  buffer_load_dwordx4 v236, s[16:19], s29 offen offset:2048 lds
  v_mfma_f32_16x16x32_bf16 v[24:27], a[132:135], v[180:183], v[24:27]
  s_waitcnt lgkmcnt(0)
  v_exp_f32 v3, v3
  v_mfma_f32_16x16x32_bf16 v[24:27], a[128:131], v[176:179], v[24:27]
  v_cvt_pk_bf16_f32 v1, v2, v3
  v_mfma_f32_16x16x32_bf16 v[4:7], a[144:147], v[128:131], v[192:195]
  v_exp_f32 v8, v8
  v_mfma_f32_16x16x32_bf16 v[4:7], a[148:151], v[132:135], v[4:7]
  ds_read_b128 a[128:131], v212 offset:40960
  v_mfma_f32_16x16x32_bf16 v[4:7], a[152:155], v[136:139], v[4:7]
  v_exp_f32 v9, v9
  v_mfma_f32_16x16x32_bf16 v[4:7], a[156:159], v[140:143], v[4:7]
  ds_read_b128 a[132:135], v213 offset:40960
  v_cvt_pk_bf16_f32 v8, v8, v9
  v_mfma_f32_16x16x32_bf16 v[12:15], a[156:159], v[156:159], v[196:199]
  v_exp_f32 v10, v10
  v_mfma_f32_16x16x32_bf16 v[12:15], a[152:155], v[152:155], v[12:15]
  ds_read_b128 a[136:139], v214 offset:40960
  v_mfma_f32_16x16x32_bf16 v[12:15], a[148:151], v[148:151], v[12:15]
  v_exp_f32 v11, v11
  v_mfma_f32_16x16x32_bf16 v[12:15], a[144:147], v[144:147], v[12:15]
  ds_read_b128 a[140:143], v215 offset:40960
  v_cvt_pk_bf16_f32 v9, v10, v11
  v_mfma_f32_16x16x32_bf16 v[20:23], a[144:147], v[160:163], v[200:203]
  v_exp_f32 v16, v16
  v_mfma_f32_16x16x32_bf16 v[20:23], a[148:151], v[164:167], v[20:23]
  buffer_load_dwordx4 v237, s[16:19], s29 offen offset:3072 lds
  v_mfma_f32_16x16x32_bf16 v[20:23], a[152:155], v[168:171], v[20:23]
  s_add_u32 s29, s29, 16384
  v_exp_f32 v17, v17
  v_mfma_f32_16x16x32_bf16 v[20:23], a[156:159], v[172:175], v[20:23]
  v_cvt_pk_bf16_f32 v16, v16, v17
  v_mfma_f32_16x16x32_bf16 v[28:31], a[156:159], v[188:191], v[204:207]
  s_add_u32 m0, s28, 0
  v_exp_f32 v18, v18
  v_mfma_f32_16x16x32_bf16 v[28:31], a[152:155], v[184:187], v[28:31]
  buffer_load_dwordx4 v232, s[12:15], s29 offen offset:0 lds
  v_mfma_f32_16x16x32_bf16 v[28:31], a[148:151], v[180:183], v[28:31]
  s_waitcnt lgkmcnt(0)
  v_exp_f32 v19, v19
  v_mfma_f32_16x16x32_bf16 v[28:31], a[144:147], v[176:179], v[28:31]
  v_cvt_pk_bf16_f32 v17, v18, v19
  v_mfma_f32_16x16x32_bf16 v[32:35], a[128:131], v[128:131], v[192:195]
  v_exp_f32 v24, v24
  v_mfma_f32_16x16x32_bf16 v[32:35], a[132:135], v[132:135], v[32:35]
  ds_read_b128 a[144:147], v212 offset:45056
  v_mfma_f32_16x16x32_bf16 v[32:35], a[136:139], v[136:139], v[32:35]
  v_exp_f32 v25, v25
  v_mfma_f32_16x16x32_bf16 v[32:35], a[140:143], v[140:143], v[32:35]
  ds_read_b128 a[148:151], v213 offset:45056
  v_cvt_pk_bf16_f32 v24, v24, v25
  v_mfma_f32_16x16x32_bf16 v[40:43], a[140:143], v[156:159], v[196:199]
  v_exp_f32 v26, v26
  v_mfma_f32_16x16x32_bf16 v[40:43], a[136:139], v[152:155], v[40:43]
  ds_read_b128 a[152:155], v214 offset:45056
  v_mfma_f32_16x16x32_bf16 v[40:43], a[132:135], v[148:151], v[40:43]
  v_exp_f32 v27, v27
  v_mfma_f32_16x16x32_bf16 v[40:43], a[128:131], v[144:147], v[40:43]
  ds_read_b128 a[156:159], v215 offset:45056
  v_cvt_pk_bf16_f32 v25, v26, v27
  v_mfma_f32_16x16x32_bf16 v[48:51], a[128:131], v[160:163], v[200:203]
  v_exp_f32 v4, v4
  v_mfma_f32_16x16x32_bf16 v[48:51], a[132:135], v[164:167], v[48:51]
  buffer_load_dwordx4 v233, s[12:15], s29 offen offset:1024 lds
  v_mfma_f32_16x16x32_bf16 v[48:51], a[136:139], v[168:171], v[48:51]
  v_exp_f32 v5, v5
  v_mfma_f32_16x16x32_bf16 v[48:51], a[140:143], v[172:175], v[48:51]
  v_cvt_pk_bf16_f32 v2, v4, v5
  v_mfma_f32_16x16x32_bf16 v[56:59], a[140:143], v[188:191], v[204:207]
  v_exp_f32 v6, v6
  v_mfma_f32_16x16x32_bf16 v[56:59], a[136:139], v[184:187], v[56:59]
  buffer_load_dwordx4 v234, s[12:15], s29 offen offset:2048 lds
  v_mfma_f32_16x16x32_bf16 v[56:59], a[132:135], v[180:183], v[56:59]
  s_waitcnt lgkmcnt(0)
  v_exp_f32 v7, v7
  v_mfma_f32_16x16x32_bf16 v[56:59], a[128:131], v[176:179], v[56:59]
  v_cvt_pk_bf16_f32 v3, v6, v7
  v_mfma_f32_16x16x32_bf16 v[36:39], a[144:147], v[128:131], v[192:195]
  v_exp_f32 v12, v12
  v_mfma_f32_16x16x32_bf16 v[36:39], a[148:151], v[132:135], v[36:39]
  ds_read_b64_tr_b16 a[160:161], v216 offset:16384
  v_mfma_f32_16x16x32_bf16 v[36:39], a[152:155], v[136:139], v[36:39]
  v_exp_f32 v13, v13
  v_mfma_f32_16x16x32_bf16 v[36:39], a[156:159], v[140:143], v[36:39]
  ds_read_b64_tr_b16 a[162:163], v216 offset:20480
  v_cvt_pk_bf16_f32 v10, v12, v13
  v_mfma_f32_16x16x32_bf16 v[44:47], a[156:159], v[156:159], v[196:199]
  v_exp_f32 v14, v14
  v_mfma_f32_16x16x32_bf16 v[44:47], a[152:155], v[152:155], v[44:47]
  ds_read_b64_tr_b16 a[164:165], v216 offset:24576
  buffer_load_dwordx4 v235, s[12:15], s29 offen offset:3072 lds
  v_mfma_f32_16x16x32_bf16 v[44:47], a[148:151], v[148:151], v[44:47]
  v_exp_f32 v15, v15
  v_mfma_f32_16x16x32_bf16 v[44:47], a[144:147], v[144:147], v[44:47]
  ds_read_b64_tr_b16 a[166:167], v216 offset:28672
  v_cvt_pk_bf16_f32 v11, v14, v15
  v_mfma_f32_16x16x32_bf16 v[52:55], a[144:147], v[160:163], v[200:203]
  s_mov_b32 m0, s51
  v_exp_f32 v20, v20
  v_mfma_f32_16x16x32_bf16 v[52:55], a[148:151], v[164:167], v[52:55]
  ds_read_b64_tr_b16 a[168:169], v217 offset:16384
  buffer_load_dwordx4 v210, s[4:7], s100 offen lds
  s_add_u32 s100, s100, 20480
  s_add_u32 s51, s51, 512
  v_mfma_f32_16x16x32_bf16 v[52:55], a[152:155], v[168:171], v[52:55]
  v_exp_f32 v21, v21
  v_mfma_f32_16x16x32_bf16 v[52:55], a[156:159], v[172:175], v[52:55]
  ds_read_b64_tr_b16 a[170:171], v217 offset:20480
  v_cvt_pk_bf16_f32 v18, v20, v21
  v_mfma_f32_16x16x32_bf16 v[60:63], a[156:159], v[188:191], v[204:207]
  s_waitcnt vmcnt(20)
  v_exp_f32 v22, v22
  v_mfma_f32_16x16x32_bf16 v[60:63], a[152:155], v[184:187], v[60:63]
  ds_read_b64_tr_b16 a[172:173], v217 offset:24576
  ds_read_b64_tr_b16 a[232:233], v209 offset:4096
  v_mfma_f32_16x16x32_bf16 v[60:63], a[148:151], v[180:183], v[60:63]
  v_exp_f32 v23, v23
  v_mfma_f32_16x16x32_bf16 v[60:63], a[144:147], v[176:179], v[60:63]
  ds_read_b64_tr_b16 a[174:175], v217 offset:28672
  v_cvt_pk_bf16_f32 v19, v22, v23
  v_mfma_f32_16x16x32_bf16 a[192:195], a[208:211], v[64:67], a[192:195]
  v_exp_f32 v28, v28
  v_mfma_f32_16x16x32_bf16 a[192:195], a[208:211], v[96:99], a[192:195]
  ds_read_b64_tr_b16 a[176:177], v218 offset:16384
  v_add_u32 v245, 1, v245
  v_mfma_f32_16x16x32_bf16 a[196:199], a[208:211], v[72:75], a[196:199]
  v_exp_f32 v29, v29
  v_mfma_f32_16x16x32_bf16 a[196:199], a[208:211], v[104:107], a[196:199]
  ds_read_b64_tr_b16 a[178:179], v218 offset:20480
  v_cvt_pk_bf16_f32 v26, v28, v29
  v_mfma_f32_16x16x32_bf16 a[200:203], a[208:211], v[80:83], a[200:203]
  s_waitcnt vmcnt(11)
  v_exp_f32 v30, v30
  v_mfma_f32_16x16x32_bf16 a[200:203], a[208:211], v[112:115], a[200:203]
  ds_read_b64_tr_b16 a[180:181], v218 offset:24576
  ds_write_b32 v246, v245
  v_mfma_f32_16x16x32_bf16 a[204:207], a[208:211], v[88:91], a[204:207]
  s_waitcnt lgkmcnt(9)
  v_exp_f32 v31, v31
  v_mfma_f32_16x16x32_bf16 a[204:207], a[208:211], v[120:123], a[204:207]
  ds_read_b64_tr_b16 a[182:183], v218 offset:28672
  v_cvt_pk_bf16_f32 v27, v30, v31
  v_mfma_f32_16x16x32_bf16 a[0:3], a[160:163], v[64:67], a[0:3]
  v_exp_f32 v32, v32
  v_mfma_f32_16x16x32_bf16 a[0:3], a[164:167], v[96:99], a[0:3]
  ds_read_b64_tr_b16 a[184:185], v219 offset:16384
  ds_read_b64_tr_b16 a[234:235], v209 offset:4608
  v_mfma_f32_16x16x32_bf16 a[4:7], a[164:167], v[104:107], a[4:7]
  v_exp_f32 v33, v33
  v_mfma_f32_16x16x32_bf16 a[4:7], a[160:163], v[72:75], a[4:7]
  ds_read_b64_tr_b16 a[186:187], v219 offset:20480
  v_cvt_pk_bf16_f32 v32, v32, v33
  v_mfma_f32_16x16x32_bf16 a[8:11], a[160:163], v[80:83], a[8:11]
  v_exp_f32 v34, v34
  v_mfma_f32_16x16x32_bf16 a[8:11], a[164:167], v[112:115], a[8:11]
  ds_read_b64_tr_b16 a[188:189], v219 offset:24576
  v_mfma_f32_16x16x32_bf16 a[12:15], a[164:167], v[120:123], a[12:15]
  s_waitcnt lgkmcnt(9)
  v_exp_f32 v35, v35
  v_mfma_f32_16x16x32_bf16 a[12:15], a[160:163], v[88:91], a[12:15]
  ds_read_b64_tr_b16 a[190:191], v219 offset:28672
  v_cvt_pk_bf16_f32 v33, v34, v35
  v_mfma_f32_16x16x32_bf16 a[16:19], a[168:171], v[64:67], a[16:19]
  v_exp_f32 v40, v40
  v_mfma_f32_16x16x32_bf16 a[16:19], a[172:175], v[96:99], a[16:19]
  ds_read_b64_tr_b16 a[160:161], v220 offset:16384
  s_waitcnt lgkmcnt(4)
  buffer_store_dwordx4 a[232:235], v211, s[24:27], s31 offen sc1
  s_add_u32 s31, s31, 1024
  s_cmp_gt_u32 s32, 3
  v_mfma_f32_16x16x32_bf16 a[20:23], a[172:175], v[104:107], a[20:23]
  s_cselect_b32 s39, 0, 1073741824
  v_exp_f32 v41, v41
  v_mfma_f32_16x16x32_bf16 a[20:23], a[168:171], v[72:75], a[20:23]
  ds_read_b64_tr_b16 a[162:163], v220 offset:20480
  v_cvt_pk_bf16_f32 v40, v40, v41
  v_mfma_f32_16x16x32_bf16 a[24:27], a[168:171], v[80:83], a[24:27]
  v_exp_f32 v42, v42
  v_mfma_f32_16x16x32_bf16 a[24:27], a[172:175], v[112:115], a[24:27]
  ds_read_b64_tr_b16 a[164:165], v220 offset:24576
  v_or_b32 v211, s39, v211
  v_mfma_f32_16x16x32_bf16 a[28:31], a[172:175], v[120:123], a[28:31]
  v_exp_f32 v43, v43
  v_mfma_f32_16x16x32_bf16 a[28:31], a[168:171], v[88:91], a[28:31]
  ds_read_b64_tr_b16 a[166:167], v220 offset:28672
  v_cvt_pk_bf16_f32 v41, v42, v43
  v_mfma_f32_16x16x32_bf16 a[32:35], a[176:179], v[64:67], a[32:35]
  v_exp_f32 v48, v48
  v_mfma_f32_16x16x32_bf16 a[32:35], a[180:183], v[96:99], a[32:35]
  ds_read_b64_tr_b16 a[168:169], v221 offset:16384
  v_or_b32 v208, s39, v208
  v_mfma_f32_16x16x32_bf16 a[36:39], a[180:183], v[104:107], a[36:39]
  v_exp_f32 v49, v49
  v_mfma_f32_16x16x32_bf16 a[36:39], a[176:179], v[72:75], a[36:39]
  ds_read_b64_tr_b16 a[170:171], v221 offset:20480
  v_cvt_pk_bf16_f32 v48, v48, v49
  v_mfma_f32_16x16x32_bf16 a[40:43], a[176:179], v[80:83], a[40:43]
  v_exp_f32 v50, v50
  v_mfma_f32_16x16x32_bf16 a[40:43], a[180:183], v[112:115], a[40:43]
  ds_read_b64_tr_b16 a[172:173], v221 offset:24576
  v_mfma_f32_16x16x32_bf16 a[44:47], a[180:183], v[120:123], a[44:47]
  s_waitcnt lgkmcnt(7)
  v_exp_f32 v51, v51
  v_mfma_f32_16x16x32_bf16 a[44:47], a[176:179], v[88:91], a[44:47]
  ds_read_b64_tr_b16 a[174:175], v221 offset:28672
  v_cvt_pk_bf16_f32 v49, v50, v51
  v_mfma_f32_16x16x32_bf16 a[48:51], a[184:187], v[64:67], a[48:51]
  v_exp_f32 v56, v56
  v_mfma_f32_16x16x32_bf16 a[48:51], a[188:191], v[96:99], a[48:51]
  ds_read_b64_tr_b16 a[176:177], v222 offset:16384
  v_mfma_f32_16x16x32_bf16 a[52:55], a[188:191], v[104:107], a[52:55]
  v_exp_f32 v57, v57
  v_mfma_f32_16x16x32_bf16 a[52:55], a[184:187], v[72:75], a[52:55]
  ds_read_b64_tr_b16 a[178:179], v222 offset:20480
  v_cvt_pk_bf16_f32 v56, v56, v57
  v_mfma_f32_16x16x32_bf16 a[56:59], a[184:187], v[80:83], a[56:59]
  v_exp_f32 v58, v58
  v_mfma_f32_16x16x32_bf16 a[56:59], a[188:191], v[112:115], a[56:59]
  ds_read_b64_tr_b16 a[180:181], v222 offset:24576
  v_mfma_f32_16x16x32_bf16 a[60:63], a[188:191], v[120:123], a[60:63]
  s_waitcnt lgkmcnt(7)
  v_exp_f32 v59, v59
  v_mfma_f32_16x16x32_bf16 a[60:63], a[184:187], v[88:91], a[60:63]
  ds_read_b64_tr_b16 a[182:183], v222 offset:28672
  v_cvt_pk_bf16_f32 v57, v58, v59
  v_mfma_f32_16x16x32_bf16 a[64:67], a[160:163], v[64:67], a[64:67]
  v_exp_f32 v36, v36
  v_mfma_f32_16x16x32_bf16 a[64:67], a[164:167], v[96:99], a[64:67]
  ds_read_b64_tr_b16 a[184:185], v223 offset:16384
  ds_read_b32 v248, v247
  v_mfma_f32_16x16x32_bf16 a[68:71], a[164:167], v[104:107], a[68:71]
  v_exp_f32 v37, v37
  v_mfma_f32_16x16x32_bf16 a[68:71], a[160:163], v[72:75], a[68:71]
  ds_read_b64_tr_b16 a[186:187], v223 offset:20480
  v_cvt_pk_bf16_f32 v34, v36, v37
  v_mfma_f32_16x16x32_bf16 a[72:75], a[160:163], v[80:83], a[72:75]
  v_exp_f32 v38, v38
  v_mfma_f32_16x16x32_bf16 a[72:75], a[164:167], v[112:115], a[72:75]
  ds_read_b64_tr_b16 a[188:189], v223 offset:24576
  v_mfma_f32_16x16x32_bf16 a[76:79], a[164:167], v[120:123], a[76:79]
  s_waitcnt lgkmcnt(8)
  v_exp_f32 v39, v39
  v_mfma_f32_16x16x32_bf16 a[76:79], a[160:163], v[88:91], a[76:79]
  ds_read_b64_tr_b16 a[190:191], v223 offset:28672
  v_cvt_pk_bf16_f32 v35, v38, v39
  v_mfma_f32_16x16x32_bf16 a[80:83], a[168:171], v[64:67], a[80:83]
  s_waitcnt lgkmcnt(3)
  v_exp_f32 v44, v44
  v_mfma_f32_16x16x32_bf16 a[80:83], a[172:175], v[96:99], a[80:83]
  v_cmp_lt_u32 vcc, v248, v245
  v_mfma_f32_16x16x32_bf16 a[84:87], a[172:175], v[104:107], a[84:87]
  s_cbranch_vccnz attn_wait9
attn_on9:
  v_exp_f32 v45, v45
  v_mfma_f32_16x16x32_bf16 a[84:87], a[168:171], v[72:75], a[84:87]
  ds_read_b128 a[128:131], v212 offset:49152
  v_cvt_pk_bf16_f32 v42, v44, v45
  v_mfma_f32_16x16x32_bf16 a[88:91], a[168:171], v[80:83], a[88:91]
  v_exp_f32 v46, v46
  v_mfma_f32_16x16x32_bf16 a[88:91], a[172:175], v[112:115], a[88:91]
  ds_read_b128 a[132:135], v213 offset:49152
  v_mfma_f32_16x16x32_bf16 a[92:95], a[172:175], v[120:123], a[92:95]
  v_exp_f32 v47, v47
  v_mfma_f32_16x16x32_bf16 a[92:95], a[168:171], v[88:91], a[92:95]
  ds_read_b128 a[136:139], v214 offset:49152
  v_cvt_pk_bf16_f32 v43, v46, v47
  v_mfma_f32_16x16x32_bf16 a[96:99], a[176:179], v[64:67], a[96:99]
  v_exp_f32 v52, v52
  v_mfma_f32_16x16x32_bf16 a[96:99], a[180:183], v[96:99], a[96:99]
  ds_read_b128 a[140:143], v215 offset:49152
  v_mfma_f32_16x16x32_bf16 a[100:103], a[180:183], v[104:107], a[100:103]
  v_exp_f32 v53, v53
  v_mfma_f32_16x16x32_bf16 a[100:103], a[176:179], v[72:75], a[100:103]
  v_cvt_pk_bf16_f32 v50, v52, v53
  v_mfma_f32_16x16x32_bf16 a[104:107], a[176:179], v[80:83], a[104:107]
  v_exp_f32 v54, v54
  v_mfma_f32_16x16x32_bf16 a[104:107], a[180:183], v[112:115], a[104:107]
  v_mfma_f32_16x16x32_bf16 a[108:111], a[180:183], v[120:123], a[108:111]
  s_waitcnt lgkmcnt(4)
  v_exp_f32 v55, v55
  v_mfma_f32_16x16x32_bf16 a[108:111], a[176:179], v[88:91], a[108:111]
  v_cvt_pk_bf16_f32 v51, v54, v55
  v_mfma_f32_16x16x32_bf16 a[112:115], a[184:187], v[64:67], a[112:115]
  v_exp_f32 v60, v60
  v_mfma_f32_16x16x32_bf16 a[112:115], a[188:191], v[96:99], a[112:115]
  v_mfma_f32_16x16x32_bf16 a[116:119], a[188:191], v[104:107], a[116:119]
  v_exp_f32 v61, v61
  v_mfma_f32_16x16x32_bf16 a[116:119], a[184:187], v[72:75], a[116:119]
  v_cvt_pk_bf16_f32 v58, v60, v61
  v_mfma_f32_16x16x32_bf16 a[120:123], a[184:187], v[80:83], a[120:123]
  v_exp_f32 v62, v62
  v_mfma_f32_16x16x32_bf16 a[120:123], a[188:191], v[112:115], a[120:123]
  v_mfma_f32_16x16x32_bf16 a[124:127], a[188:191], v[120:123], a[124:127]
  s_waitcnt lgkmcnt(0)
  v_exp_f32 v63, v63
  v_mfma_f32_16x16x32_bf16 a[124:127], a[184:187], v[88:91], a[124:127]
  v_cvt_pk_bf16_f32 v59, v62, v63
  v_mfma_f32_16x16x32_bf16 v[64:67], a[128:131], v[128:131], v[192:195]
  s_add_u32 m0, s28, 65536
  v_mfma_f32_16x16x32_bf16 v[64:67], a[132:135], v[132:135], v[64:67]
  ds_read_b128 a[144:147], v212 offset:53248
  v_mfma_f32_16x16x32_bf16 v[64:67], a[136:139], v[136:139], v[64:67]
  buffer_load_dwordx4 v236, s[16:19], s29 offen offset:0 lds
  v_mfma_f32_16x16x32_bf16 v[64:67], a[140:143], v[140:143], v[64:67]
  ds_read_b128 a[148:151], v213 offset:53248
  v_mfma_f32_16x16x32_bf16 v[72:75], a[140:143], v[156:159], v[196:199]
  v_mfma_f32_16x16x32_bf16 v[72:75], a[136:139], v[152:155], v[72:75]
  ds_read_b128 a[152:155], v214 offset:53248
  v_mfma_f32_16x16x32_bf16 v[72:75], a[132:135], v[148:151], v[72:75]
  buffer_load_dwordx4 v237, s[16:19], s29 offen offset:1024 lds
  v_mfma_f32_16x16x32_bf16 v[72:75], a[128:131], v[144:147], v[72:75]
  ds_read_b128 a[156:159], v215 offset:53248
  v_mfma_f32_16x16x32_bf16 v[80:83], a[128:131], v[160:163], v[200:203]
  v_exp_f32 v64, v64
  v_mfma_f32_16x16x32_bf16 v[80:83], a[132:135], v[164:167], v[80:83]
  v_mfma_f32_16x16x32_bf16 v[80:83], a[136:139], v[168:171], v[80:83]
  v_exp_f32 v65, v65
  v_mfma_f32_16x16x32_bf16 v[80:83], a[140:143], v[172:175], v[80:83]
  v_cvt_pk_bf16_f32 v64, v64, v65
  v_mfma_f32_16x16x32_bf16 v[88:91], a[140:143], v[188:191], v[204:207]
  v_exp_f32 v66, v66
  v_mfma_f32_16x16x32_bf16 v[88:91], a[136:139], v[184:187], v[88:91]
  buffer_load_dwordx4 v236, s[16:19], s29 offen offset:2048 lds
  v_mfma_f32_16x16x32_bf16 v[88:91], a[132:135], v[180:183], v[88:91]
  s_waitcnt lgkmcnt(0)
  v_exp_f32 v67, v67
  v_mfma_f32_16x16x32_bf16 v[88:91], a[128:131], v[176:179], v[88:91]
  v_cvt_pk_bf16_f32 v65, v66, v67
  v_mfma_f32_16x16x32_bf16 v[68:71], a[144:147], v[128:131], v[192:195]
  v_exp_f32 v72, v72
  v_mfma_f32_16x16x32_bf16 v[68:71], a[148:151], v[132:135], v[68:71]
  ds_read_b128 a[128:131], v212 offset:57344
  v_mfma_f32_16x16x32_bf16 v[68:71], a[152:155], v[136:139], v[68:71]
  v_exp_f32 v73, v73
  v_mfma_f32_16x16x32_bf16 v[68:71], a[156:159], v[140:143], v[68:71]
  ds_read_b128 a[132:135], v213 offset:57344
  v_cvt_pk_bf16_f32 v72, v72, v73
  v_mfma_f32_16x16x32_bf16 v[76:79], a[156:159], v[156:159], v[196:199]
  v_exp_f32 v74, v74
  v_mfma_f32_16x16x32_bf16 v[76:79], a[152:155], v[152:155], v[76:79]
  ds_read_b128 a[136:139], v214 offset:57344
  v_mfma_f32_16x16x32_bf16 v[76:79], a[148:151], v[148:151], v[76:79]
  v_exp_f32 v75, v75
  v_mfma_f32_16x16x32_bf16 v[76:79], a[144:147], v[144:147], v[76:79]
  ds_read_b128 a[140:143], v215 offset:57344
  v_cvt_pk_bf16_f32 v73, v74, v75
  v_mfma_f32_16x16x32_bf16 v[84:87], a[144:147], v[160:163], v[200:203]
  v_exp_f32 v80, v80
  v_mfma_f32_16x16x32_bf16 v[84:87], a[148:151], v[164:167], v[84:87]
  buffer_load_dwordx4 v237, s[16:19], s29 offen offset:3072 lds
  v_mfma_f32_16x16x32_bf16 v[84:87], a[152:155], v[168:171], v[84:87]
  s_add_u32 s29, s29, 16384
  v_exp_f32 v81, v81
  v_mfma_f32_16x16x32_bf16 v[84:87], a[156:159], v[172:175], v[84:87]
  v_cvt_pk_bf16_f32 v80, v80, v81
  v_mfma_f32_16x16x32_bf16 v[92:95], a[156:159], v[188:191], v[204:207]
  s_add_u32 m0, s28, 16384
  v_exp_f32 v82, v82
  v_mfma_f32_16x16x32_bf16 v[92:95], a[152:155], v[184:187], v[92:95]
  buffer_load_dwordx4 v232, s[12:15], s29 offen offset:0 lds
  v_mfma_f32_16x16x32_bf16 v[92:95], a[148:151], v[180:183], v[92:95]
  s_waitcnt lgkmcnt(0)
  v_exp_f32 v83, v83
  v_mfma_f32_16x16x32_bf16 v[92:95], a[144:147], v[176:179], v[92:95]
  v_cvt_pk_bf16_f32 v81, v82, v83
  v_mfma_f32_16x16x32_bf16 v[96:99], a[128:131], v[128:131], v[192:195]
  v_exp_f32 v88, v88
  v_mfma_f32_16x16x32_bf16 v[96:99], a[132:135], v[132:135], v[96:99]
  ds_read_b128 a[144:147], v212 offset:61440
  v_mfma_f32_16x16x32_bf16 v[96:99], a[136:139], v[136:139], v[96:99]
  v_exp_f32 v89, v89
  v_mfma_f32_16x16x32_bf16 v[96:99], a[140:143], v[140:143], v[96:99]
  ds_read_b128 a[148:151], v213 offset:61440
  v_cvt_pk_bf16_f32 v88, v88, v89
  v_mfma_f32_16x16x32_bf16 v[104:107], a[140:143], v[156:159], v[196:199]
  v_exp_f32 v90, v90
  v_mfma_f32_16x16x32_bf16 v[104:107], a[136:139], v[152:155], v[104:107]
  ds_read_b128 a[152:155], v214 offset:61440
  v_mfma_f32_16x16x32_bf16 v[104:107], a[132:135], v[148:151], v[104:107]
  v_exp_f32 v91, v91
  v_mfma_f32_16x16x32_bf16 v[104:107], a[128:131], v[144:147], v[104:107]
  ds_read_b128 a[156:159], v215 offset:61440
  v_cvt_pk_bf16_f32 v89, v90, v91
  v_mfma_f32_16x16x32_bf16 v[112:115], a[128:131], v[160:163], v[200:203]
  v_exp_f32 v68, v68
  v_mfma_f32_16x16x32_bf16 v[112:115], a[132:135], v[164:167], v[112:115]
  buffer_load_dwordx4 v233, s[12:15], s29 offen offset:1024 lds
  v_mfma_f32_16x16x32_bf16 v[112:115], a[136:139], v[168:171], v[112:115]
  v_exp_f32 v69, v69
  v_mfma_f32_16x16x32_bf16 v[112:115], a[140:143], v[172:175], v[112:115]
  v_cvt_pk_bf16_f32 v66, v68, v69
  v_mfma_f32_16x16x32_bf16 v[120:123], a[140:143], v[188:191], v[204:207]
  v_exp_f32 v70, v70
  v_mfma_f32_16x16x32_bf16 v[120:123], a[136:139], v[184:187], v[120:123]
  buffer_load_dwordx4 v234, s[12:15], s29 offen offset:2048 lds
  v_mfma_f32_16x16x32_bf16 v[120:123], a[132:135], v[180:183], v[120:123]
  s_waitcnt lgkmcnt(0)
  v_exp_f32 v71, v71
  v_mfma_f32_16x16x32_bf16 v[120:123], a[128:131], v[176:179], v[120:123]
  v_cvt_pk_bf16_f32 v67, v70, v71
  v_mfma_f32_16x16x32_bf16 v[100:103], a[144:147], v[128:131], v[192:195]
  v_exp_f32 v76, v76
  v_mfma_f32_16x16x32_bf16 v[100:103], a[148:151], v[132:135], v[100:103]
  ds_read_b64_tr_b16 a[160:161], v216 offset:32768
  v_mfma_f32_16x16x32_bf16 v[100:103], a[152:155], v[136:139], v[100:103]
  v_exp_f32 v77, v77
  v_mfma_f32_16x16x32_bf16 v[100:103], a[156:159], v[140:143], v[100:103]
  ds_read_b64_tr_b16 a[162:163], v216 offset:36864
  v_cvt_pk_bf16_f32 v74, v76, v77
  v_mfma_f32_16x16x32_bf16 v[108:111], a[156:159], v[156:159], v[196:199]
  v_exp_f32 v78, v78
  v_mfma_f32_16x16x32_bf16 v[108:111], a[152:155], v[152:155], v[108:111]
  ds_read_b64_tr_b16 a[164:165], v216 offset:40960
  buffer_load_dwordx4 v235, s[12:15], s29 offen offset:3072 lds
  v_mfma_f32_16x16x32_bf16 v[108:111], a[148:151], v[148:151], v[108:111]
  v_exp_f32 v79, v79
  v_mfma_f32_16x16x32_bf16 v[108:111], a[144:147], v[144:147], v[108:111]
  ds_read_b64_tr_b16 a[166:167], v216 offset:45056
  v_cvt_pk_bf16_f32 v75, v78, v79
  v_mfma_f32_16x16x32_bf16 v[116:119], a[144:147], v[160:163], v[200:203]
  v_exp_f32 v84, v84
  v_mfma_f32_16x16x32_bf16 v[116:119], a[148:151], v[164:167], v[116:119]
  ds_read_b64_tr_b16 a[168:169], v217 offset:32768
  buffer_load_dword v254, off, s[24:27], s47 sc1
  v_mfma_f32_16x16x32_bf16 v[116:119], a[152:155], v[168:171], v[116:119]
  v_exp_f32 v85, v85
  v_mfma_f32_16x16x32_bf16 v[116:119], a[156:159], v[172:175], v[116:119]
  ds_read_b64_tr_b16 a[170:171], v217 offset:36864
  v_cvt_pk_bf16_f32 v82, v84, v85
  v_mfma_f32_16x16x32_bf16 v[124:127], a[156:159], v[188:191], v[204:207]
  s_waitcnt vmcnt(20)
  v_exp_f32 v86, v86
  v_mfma_f32_16x16x32_bf16 v[124:127], a[152:155], v[184:187], v[124:127]
  ds_read_b64_tr_b16 a[172:173], v217 offset:40960
  ds_read_b64_tr_b16 a[232:233], v209 offset:5120
  v_mfma_f32_16x16x32_bf16 v[124:127], a[148:151], v[180:183], v[124:127]
  v_exp_f32 v87, v87
  v_mfma_f32_16x16x32_bf16 v[124:127], a[144:147], v[176:179], v[124:127]
  ds_read_b64_tr_b16 a[174:175], v217 offset:45056
  v_cvt_pk_bf16_f32 v83, v86, v87
  v_mfma_f32_16x16x32_bf16 a[192:195], a[208:211], v[0:3], a[192:195]
  v_exp_f32 v92, v92
  v_mfma_f32_16x16x32_bf16 a[192:195], a[208:211], v[32:35], a[192:195]
  ds_read_b64_tr_b16 a[176:177], v218 offset:32768
  v_add_u32 v245, 1, v245
  v_mfma_f32_16x16x32_bf16 a[196:199], a[208:211], v[8:11], a[196:199]
  v_exp_f32 v93, v93
  v_mfma_f32_16x16x32_bf16 a[196:199], a[208:211], v[40:43], a[196:199]
  ds_read_b64_tr_b16 a[178:179], v218 offset:36864
  v_cvt_pk_bf16_f32 v90, v92, v93
  v_mfma_f32_16x16x32_bf16 a[200:203], a[208:211], v[16:19], a[200:203]
  s_waitcnt vmcnt(11)
  v_exp_f32 v94, v94
  v_mfma_f32_16x16x32_bf16 a[200:203], a[208:211], v[48:51], a[200:203]
  ds_read_b64_tr_b16 a[180:181], v218 offset:40960
  ds_write_b32 v246, v245
  v_mfma_f32_16x16x32_bf16 a[204:207], a[208:211], v[24:27], a[204:207]
  s_waitcnt lgkmcnt(9)
  v_exp_f32 v95, v95
  v_mfma_f32_16x16x32_bf16 a[204:207], a[208:211], v[56:59], a[204:207]
  ds_read_b64_tr_b16 a[182:183], v218 offset:45056
  v_cvt_pk_bf16_f32 v91, v94, v95
  v_mfma_f32_16x16x32_bf16 a[0:3], a[160:163], v[0:3], a[0:3]
  v_exp_f32 v96, v96
  v_mfma_f32_16x16x32_bf16 a[0:3], a[164:167], v[32:35], a[0:3]
  ds_read_b64_tr_b16 a[184:185], v219 offset:32768
  ds_read_b64_tr_b16 a[234:235], v209 offset:5632
  v_mfma_f32_16x16x32_bf16 a[4:7], a[164:167], v[40:43], a[4:7]
  v_exp_f32 v97, v97
  v_mfma_f32_16x16x32_bf16 a[4:7], a[160:163], v[8:11], a[4:7]
  ds_read_b64_tr_b16 a[186:187], v219 offset:36864
  v_cvt_pk_bf16_f32 v96, v96, v97
  v_mfma_f32_16x16x32_bf16 a[8:11], a[160:163], v[16:19], a[8:11]
  v_exp_f32 v98, v98
  v_mfma_f32_16x16x32_bf16 a[8:11], a[164:167], v[48:51], a[8:11]
  ds_read_b64_tr_b16 a[188:189], v219 offset:40960
  v_mfma_f32_16x16x32_bf16 a[12:15], a[164:167], v[56:59], a[12:15]
  s_waitcnt lgkmcnt(9)
  v_exp_f32 v99, v99
  v_mfma_f32_16x16x32_bf16 a[12:15], a[160:163], v[24:27], a[12:15]
  ds_read_b64_tr_b16 a[190:191], v219 offset:45056
  v_cvt_pk_bf16_f32 v97, v98, v99
  v_mfma_f32_16x16x32_bf16 a[16:19], a[168:171], v[0:3], a[16:19]
  v_exp_f32 v104, v104
  v_mfma_f32_16x16x32_bf16 a[16:19], a[172:175], v[32:35], a[16:19]
  ds_read_b64_tr_b16 a[160:161], v220 offset:32768
  s_waitcnt lgkmcnt(4)
  buffer_store_dwordx4 a[232:235], v211, s[24:27], s31 offen sc1
  s_add_u32 s31, s31, 1024
  v_mfma_f32_16x16x32_bf16 a[20:23], a[172:175], v[40:43], a[20:23]
  v_exp_f32 v105, v105
  v_mfma_f32_16x16x32_bf16 a[20:23], a[168:171], v[8:11], a[20:23]
  ds_read_b64_tr_b16 a[162:163], v220 offset:36864
  v_cvt_pk_bf16_f32 v104, v104, v105
  v_mfma_f32_16x16x32_bf16 a[24:27], a[168:171], v[16:19], a[24:27]
  v_exp_f32 v106, v106
  v_mfma_f32_16x16x32_bf16 a[24:27], a[172:175], v[48:51], a[24:27]
  ds_read_b64_tr_b16 a[164:165], v220 offset:40960
  v_mfma_f32_16x16x32_bf16 a[28:31], a[172:175], v[56:59], a[28:31]
  v_exp_f32 v107, v107
  v_mfma_f32_16x16x32_bf16 a[28:31], a[168:171], v[24:27], a[28:31]
  ds_read_b64_tr_b16 a[166:167], v220 offset:45056
  v_cvt_pk_bf16_f32 v105, v106, v107
  v_mfma_f32_16x16x32_bf16 a[32:35], a[176:179], v[0:3], a[32:35]
  v_exp_f32 v112, v112
  v_mfma_f32_16x16x32_bf16 a[32:35], a[180:183], v[32:35], a[32:35]
  ds_read_b64_tr_b16 a[168:169], v221 offset:32768
  v_mfma_f32_16x16x32_bf16 a[36:39], a[180:183], v[40:43], a[36:39]
  v_exp_f32 v113, v113
  v_mfma_f32_16x16x32_bf16 a[36:39], a[176:179], v[8:11], a[36:39]
  ds_read_b64_tr_b16 a[170:171], v221 offset:36864
  v_cvt_pk_bf16_f32 v112, v112, v113
  v_mfma_f32_16x16x32_bf16 a[40:43], a[176:179], v[16:19], a[40:43]
  v_exp_f32 v114, v114
  v_mfma_f32_16x16x32_bf16 a[40:43], a[180:183], v[48:51], a[40:43]
  ds_read_b64_tr_b16 a[172:173], v221 offset:40960
  v_mfma_f32_16x16x32_bf16 a[44:47], a[180:183], v[56:59], a[44:47]
  s_waitcnt lgkmcnt(7)
  v_exp_f32 v115, v115
  v_mfma_f32_16x16x32_bf16 a[44:47], a[176:179], v[24:27], a[44:47]
  ds_read_b64_tr_b16 a[174:175], v221 offset:45056
  v_cvt_pk_bf16_f32 v113, v114, v115
  v_mfma_f32_16x16x32_bf16 a[48:51], a[184:187], v[0:3], a[48:51]
  v_exp_f32 v120, v120
  v_mfma_f32_16x16x32_bf16 a[48:51], a[188:191], v[32:35], a[48:51]
  ds_read_b64_tr_b16 a[176:177], v222 offset:32768
  v_mfma_f32_16x16x32_bf16 a[52:55], a[188:191], v[40:43], a[52:55]
  v_exp_f32 v121, v121
  v_mfma_f32_16x16x32_bf16 a[52:55], a[184:187], v[8:11], a[52:55]
  ds_read_b64_tr_b16 a[178:179], v222 offset:36864
  v_cvt_pk_bf16_f32 v120, v120, v121
  v_mfma_f32_16x16x32_bf16 a[56:59], a[184:187], v[16:19], a[56:59]
  v_exp_f32 v122, v122
  v_mfma_f32_16x16x32_bf16 a[56:59], a[188:191], v[48:51], a[56:59]
  ds_read_b64_tr_b16 a[180:181], v222 offset:40960
  v_mfma_f32_16x16x32_bf16 a[60:63], a[188:191], v[56:59], a[60:63]
  s_waitcnt lgkmcnt(7)
  v_exp_f32 v123, v123
  v_mfma_f32_16x16x32_bf16 a[60:63], a[184:187], v[24:27], a[60:63]
  ds_read_b64_tr_b16 a[182:183], v222 offset:45056
  v_cvt_pk_bf16_f32 v121, v122, v123
  v_mfma_f32_16x16x32_bf16 a[64:67], a[160:163], v[0:3], a[64:67]
  v_exp_f32 v100, v100
  v_mfma_f32_16x16x32_bf16 a[64:67], a[164:167], v[32:35], a[64:67]
  ds_read_b64_tr_b16 a[184:185], v223 offset:32768
  ds_read_b32 v248, v247
  v_mfma_f32_16x16x32_bf16 a[68:71], a[164:167], v[40:43], a[68:71]
  v_exp_f32 v101, v101
  v_mfma_f32_16x16x32_bf16 a[68:71], a[160:163], v[8:11], a[68:71]
  ds_read_b64_tr_b16 a[186:187], v223 offset:36864
  v_cvt_pk_bf16_f32 v98, v100, v101
  v_mfma_f32_16x16x32_bf16 a[72:75], a[160:163], v[16:19], a[72:75]
  v_exp_f32 v102, v102
  v_mfma_f32_16x16x32_bf16 a[72:75], a[164:167], v[48:51], a[72:75]
  ds_read_b64_tr_b16 a[188:189], v223 offset:40960
  v_mfma_f32_16x16x32_bf16 a[76:79], a[164:167], v[56:59], a[76:79]
  s_waitcnt lgkmcnt(8)
  v_exp_f32 v103, v103
  v_mfma_f32_16x16x32_bf16 a[76:79], a[160:163], v[24:27], a[76:79]
  ds_read_b64_tr_b16 a[190:191], v223 offset:45056
  v_cvt_pk_bf16_f32 v99, v102, v103
  v_mfma_f32_16x16x32_bf16 a[80:83], a[168:171], v[0:3], a[80:83]
  s_waitcnt lgkmcnt(3)
  v_exp_f32 v108, v108
  v_mfma_f32_16x16x32_bf16 a[80:83], a[172:175], v[32:35], a[80:83]
  v_cmp_lt_u32 vcc, v248, v245
  v_mfma_f32_16x16x32_bf16 a[84:87], a[172:175], v[40:43], a[84:87]
  s_cbranch_vccnz attn_wait10
attn_on10:
  v_exp_f32 v109, v109
  v_mfma_f32_16x16x32_bf16 a[84:87], a[168:171], v[8:11], a[84:87]
  ds_read_b128 a[128:131], v212 offset:0
  v_cvt_pk_bf16_f32 v106, v108, v109
  v_mfma_f32_16x16x32_bf16 a[88:91], a[168:171], v[16:19], a[88:91]
  v_exp_f32 v110, v110
  v_mfma_f32_16x16x32_bf16 a[88:91], a[172:175], v[48:51], a[88:91]
  ds_read_b128 a[132:135], v213 offset:0
  v_mfma_f32_16x16x32_bf16 a[92:95], a[172:175], v[56:59], a[92:95]
  v_exp_f32 v111, v111
  v_mfma_f32_16x16x32_bf16 a[92:95], a[168:171], v[24:27], a[92:95]
  ds_read_b128 a[136:139], v214 offset:0
  v_cvt_pk_bf16_f32 v107, v110, v111
  v_mfma_f32_16x16x32_bf16 a[96:99], a[176:179], v[0:3], a[96:99]
  v_exp_f32 v116, v116
  v_mfma_f32_16x16x32_bf16 a[96:99], a[180:183], v[32:35], a[96:99]
  ds_read_b128 a[140:143], v215 offset:0
  v_mfma_f32_16x16x32_bf16 a[100:103], a[180:183], v[40:43], a[100:103]
  v_exp_f32 v117, v117
  v_mfma_f32_16x16x32_bf16 a[100:103], a[176:179], v[8:11], a[100:103]
  v_cvt_pk_bf16_f32 v114, v116, v117
  v_mfma_f32_16x16x32_bf16 a[104:107], a[176:179], v[16:19], a[104:107]
  v_exp_f32 v118, v118
  v_mfma_f32_16x16x32_bf16 a[104:107], a[180:183], v[48:51], a[104:107]
  v_mfma_f32_16x16x32_bf16 a[108:111], a[180:183], v[56:59], a[108:111]
  s_waitcnt lgkmcnt(4)
  v_exp_f32 v119, v119
  v_mfma_f32_16x16x32_bf16 a[108:111], a[176:179], v[24:27], a[108:111]
  v_cvt_pk_bf16_f32 v115, v118, v119
  v_mfma_f32_16x16x32_bf16 a[112:115], a[184:187], v[0:3], a[112:115]
  v_exp_f32 v124, v124
  v_mfma_f32_16x16x32_bf16 a[112:115], a[188:191], v[32:35], a[112:115]
  v_mfma_f32_16x16x32_bf16 a[116:119], a[188:191], v[40:43], a[116:119]
  s_sub_u32 s32, s32, 1
  v_exp_f32 v125, v125
  v_mfma_f32_16x16x32_bf16 a[116:119], a[184:187], v[8:11], a[116:119]
  v_cvt_pk_bf16_f32 v122, v124, v125
  v_mfma_f32_16x16x32_bf16 a[120:123], a[184:187], v[16:19], a[120:123]
  s_cmp_lg_u32 s32, 0
  v_exp_f32 v126, v126
  v_mfma_f32_16x16x32_bf16 a[120:123], a[188:191], v[48:51], a[120:123]
  v_mfma_f32_16x16x32_bf16 a[124:127], a[188:191], v[56:59], a[124:127]
  s_waitcnt lgkmcnt(0)
  v_exp_f32 v127, v127
  v_mfma_f32_16x16x32_bf16 a[124:127], a[184:187], v[24:27], a[124:127]
  v_cvt_pk_bf16_f32 v123, v126, v127
  s_cbranch_scc1 attn_loop
  s_waitcnt vmcnt(1)
  v_readfirstlane_b32 s38, v254
  s_nop 0
  s_cmp_ge_u32 s38, 512
  s_cbranch_scc1 attn_h_ready
  s_mov_b32 s39, 32768
attn_spin:
  s_sleep 4
  buffer_load_dword v254, off, s[24:27], s47 sc1
  s_waitcnt vmcnt(0)
  v_readfirstlane_b32 s38, v254
  s_nop 0
  s_cmp_ge_u32 s38, 512
  s_cbranch_scc1 attn_h_ready
  s_sub_u32 s39, s39, 1
  s_cmp_lg_u32 s39, 0
  s_cbranch_scc1 attn_spin
attn_h_ready:
  v_mfma_f32_16x16x32_bf16 v[0:3], a[128:131], v[128:131], v[192:195]
  s_add_u32 m0, s28, 81920
  s_and_b32 s38, s2, 1
  s_lshl_b32 s38, s38, 2
  v_lshrrev_b32 v224, 4, v242
  v_and_b32 v225, 7, v224
  v_mfma_f32_16x16x32_bf16 v[0:3], a[132:135], v[132:135], v[0:3]
  ds_read_b128 a[144:147], v212 offset:4096
  s_add_u32 s38, s38, s3
  s_mul_i32 s38, s38, 81920
  s_lshr_b32 s39, s2, 5
  v_mul_u32_u24 v225, 0xd80, v225
  v_mfma_f32_16x16x32_bf16 v[0:3], a[136:139], v[136:139], v[0:3]
  buffer_load_dwordx4 v236, s[16:19], s29 offen offset:0 lds
  s_mul_i32 s39, s39, 655360
  s_add_u32 s38, s38, s39
  s_add_u32 s4, s38, 3145728
  v_mfma_f32_16x16x32_bf16 v[0:3], a[140:143], v[140:143], v[0:3]
  ds_read_b128 a[148:151], v213 offset:4096
  s_add_u32 s5, s4, 12288
  s_add_u32 s6, s4, 24576
  s_add_u32 s7, s4, 36864
  v_lshrrev_b32 v224, 4, v224
  v_mfma_f32_16x16x32_bf16 v[8:11], a[140:143], v[156:159], v[196:199]
  s_add_u32 s8, s4, 49152
  s_add_u32 s9, s4, 61440
  s_add_u32 s10, s4, 73728
  v_lshl_add_u32 v225, v224, 4, v225
  v_add_u32 v252, 4096, v242
  v_mfma_f32_16x16x32_bf16 v[8:11], a[136:139], v[152:155], v[8:11]
  ds_read_b128 a[152:155], v214 offset:4096
  buffer_load_dwordx4 a[212:215], v225, s[24:27], s101 offen offset:0 sc1
  v_mfma_f32_16x16x32_bf16 v[8:11], a[132:135], v[148:151], v[8:11]
  buffer_load_dwordx4 v237, s[16:19], s29 offen offset:1024 lds
  v_mfma_f32_16x16x32_bf16 v[8:11], a[128:131], v[144:147], v[8:11]
  ds_read_b128 a[156:159], v215 offset:4096
  buffer_load_dwordx4 a[216:219], v225, s[24:27], s101 offen offset:64 sc1
  v_mfma_f32_16x16x32_bf16 v[16:19], a[128:131], v[160:163], v[200:203]
  v_exp_f32 v0, v0
  v_mfma_f32_16x16x32_bf16 v[16:19], a[132:135], v[164:167], v[16:19]
  buffer_load_dwordx4 a[220:223], v225, s[24:27], s101 offen offset:128 sc1
  v_mfma_f32_16x16x32_bf16 v[16:19], a[136:139], v[168:171], v[16:19]
  v_exp_f32 v1, v1
  v_mfma_f32_16x16x32_bf16 v[16:19], a[140:143], v[172:175], v[16:19]
  v_cvt_pk_bf16_f32 v0, v0, v1
  v_add_u32 v253, 8192, v242
  v_mfma_f32_16x16x32_bf16 v[24:27], a[140:143], v[188:191], v[204:207]
  v_exp_f32 v2, v2
  v_mfma_f32_16x16x32_bf16 v[24:27], a[136:139], v[184:187], v[24:27]
  buffer_load_dwordx4 v236, s[16:19], s29 offen offset:2048 lds
  v_mfma_f32_16x16x32_bf16 v[24:27], a[132:135], v[180:183], v[24:27]
  s_waitcnt lgkmcnt(0)
  v_exp_f32 v3, v3
  v_mfma_f32_16x16x32_bf16 v[24:27], a[128:131], v[176:179], v[24:27]
  v_cvt_pk_bf16_f32 v1, v2, v3
  v_mfma_f32_16x16x32_bf16 v[4:7], a[144:147], v[128:131], v[192:195]
  v_exp_f32 v8, v8
  v_mfma_f32_16x16x32_bf16 v[4:7], a[148:151], v[132:135], v[4:7]
  ds_read_b128 a[128:131], v212 offset:8192
  v_mfma_f32_16x16x32_bf16 v[4:7], a[152:155], v[136:139], v[4:7]
  v_exp_f32 v9, v9
  v_mfma_f32_16x16x32_bf16 v[4:7], a[156:159], v[140:143], v[4:7]
  ds_read_b128 a[132:135], v213 offset:8192
  v_cvt_pk_bf16_f32 v8, v8, v9
  v_mfma_f32_16x16x32_bf16 v[12:15], a[156:159], v[156:159], v[196:199]
  v_exp_f32 v10, v10
  v_mfma_f32_16x16x32_bf16 v[12:15], a[152:155], v[152:155], v[12:15]
  ds_read_b128 a[136:139], v214 offset:8192
  v_mfma_f32_16x16x32_bf16 v[12:15], a[148:151], v[148:151], v[12:15]
  v_exp_f32 v11, v11
  v_mfma_f32_16x16x32_bf16 v[12:15], a[144:147], v[144:147], v[12:15]
  ds_read_b128 a[140:143], v215 offset:8192
  v_cvt_pk_bf16_f32 v9, v10, v11
  v_mfma_f32_16x16x32_bf16 v[20:23], a[144:147], v[160:163], v[200:203]
  v_exp_f32 v16, v16
  v_mfma_f32_16x16x32_bf16 v[20:23], a[148:151], v[164:167], v[20:23]
  buffer_load_dwordx4 v237, s[16:19], s29 offen offset:3072 lds
  v_mfma_f32_16x16x32_bf16 v[20:23], a[152:155], v[168:171], v[20:23]
  s_add_u32 s29, s29, 16384
  v_exp_f32 v17, v17
  v_mfma_f32_16x16x32_bf16 v[20:23], a[156:159], v[172:175], v[20:23]
  v_cvt_pk_bf16_f32 v16, v16, v17
  v_mfma_f32_16x16x32_bf16 v[28:31], a[156:159], v[188:191], v[204:207]
  s_add_u32 m0, s28, 32768
  v_exp_f32 v18, v18
  v_mfma_f32_16x16x32_bf16 v[28:31], a[152:155], v[184:187], v[28:31]
  buffer_load_dwordx4 v232, s[12:15], s29 offen offset:0 lds
  v_mfma_f32_16x16x32_bf16 v[28:31], a[148:151], v[180:183], v[28:31]
  s_waitcnt lgkmcnt(0)
  v_exp_f32 v19, v19
  v_mfma_f32_16x16x32_bf16 v[28:31], a[144:147], v[176:179], v[28:31]
  v_cvt_pk_bf16_f32 v17, v18, v19
  v_mfma_f32_16x16x32_bf16 v[32:35], a[128:131], v[128:131], v[192:195]
  v_exp_f32 v24, v24
  v_mfma_f32_16x16x32_bf16 v[32:35], a[132:135], v[132:135], v[32:35]
  ds_read_b128 a[144:147], v212 offset:12288
  v_mfma_f32_16x16x32_bf16 v[32:35], a[136:139], v[136:139], v[32:35]
  v_exp_f32 v25, v25
  v_mfma_f32_16x16x32_bf16 v[32:35], a[140:143], v[140:143], v[32:35]
  ds_read_b128 a[148:151], v213 offset:12288
  v_cvt_pk_bf16_f32 v24, v24, v25
  v_mfma_f32_16x16x32_bf16 v[40:43], a[140:143], v[156:159], v[196:199]
  v_exp_f32 v26, v26
  v_mfma_f32_16x16x32_bf16 v[40:43], a[136:139], v[152:155], v[40:43]
  ds_read_b128 a[152:155], v214 offset:12288
  v_mfma_f32_16x16x32_bf16 v[40:43], a[132:135], v[148:151], v[40:43]
  v_exp_f32 v27, v27
  v_mfma_f32_16x16x32_bf16 v[40:43], a[128:131], v[144:147], v[40:43]
  ds_read_b128 a[156:159], v215 offset:12288
  v_cvt_pk_bf16_f32 v25, v26, v27
  v_mfma_f32_16x16x32_bf16 v[48:51], a[128:131], v[160:163], v[200:203]
  v_exp_f32 v4, v4
  v_mfma_f32_16x16x32_bf16 v[48:51], a[132:135], v[164:167], v[48:51]
  buffer_load_dwordx4 v233, s[12:15], s29 offen offset:1024 lds
  v_mfma_f32_16x16x32_bf16 v[48:51], a[136:139], v[168:171], v[48:51]
  v_exp_f32 v5, v5
  v_mfma_f32_16x16x32_bf16 v[48:51], a[140:143], v[172:175], v[48:51]
  v_cvt_pk_bf16_f32 v2, v4, v5
  v_mfma_f32_16x16x32_bf16 v[56:59], a[140:143], v[188:191], v[204:207]
  v_exp_f32 v6, v6
  v_mfma_f32_16x16x32_bf16 v[56:59], a[136:139], v[184:187], v[56:59]
  buffer_load_dwordx4 v234, s[12:15], s29 offen offset:2048 lds
  v_mfma_f32_16x16x32_bf16 v[56:59], a[132:135], v[180:183], v[56:59]
  s_waitcnt lgkmcnt(0)
  v_exp_f32 v7, v7
  v_mfma_f32_16x16x32_bf16 v[56:59], a[128:131], v[176:179], v[56:59]
  v_cvt_pk_bf16_f32 v3, v6, v7
  v_mfma_f32_16x16x32_bf16 v[36:39], a[144:147], v[128:131], v[192:195]
  v_exp_f32 v12, v12
  v_mfma_f32_16x16x32_bf16 v[36:39], a[148:151], v[132:135], v[36:39]
  ds_read_b64_tr_b16 a[160:161], v216 offset:49152
  v_mfma_f32_16x16x32_bf16 v[36:39], a[152:155], v[136:139], v[36:39]
  v_exp_f32 v13, v13
  v_mfma_f32_16x16x32_bf16 v[36:39], a[156:159], v[140:143], v[36:39]
  ds_read_b64_tr_b16 a[162:163], v216 offset:53248
  v_cvt_pk_bf16_f32 v10, v12, v13
  v_mfma_f32_16x16x32_bf16 v[44:47], a[156:159], v[156:159], v[196:199]
  v_exp_f32 v14, v14
  v_mfma_f32_16x16x32_bf16 v[44:47], a[152:155], v[152:155], v[44:47]
  ds_read_b64_tr_b16 a[164:165], v216 offset:57344
  buffer_load_dwordx4 v235, s[12:15], s29 offen offset:3072 lds
  v_mfma_f32_16x16x32_bf16 v[44:47], a[148:151], v[148:151], v[44:47]
  v_exp_f32 v15, v15
  v_mfma_f32_16x16x32_bf16 v[44:47], a[144:147], v[144:147], v[44:47]
  ds_read_b64_tr_b16 a[166:167], v216 offset:61440
  v_cvt_pk_bf16_f32 v11, v14, v15
  v_mfma_f32_16x16x32_bf16 v[52:55], a[144:147], v[160:163], v[200:203]
  v_exp_f32 v20, v20
  v_mfma_f32_16x16x32_bf16 v[52:55], a[148:151], v[164:167], v[52:55]
  ds_read_b64_tr_b16 a[168:169], v217 offset:49152
  v_mfma_f32_16x16x32_bf16 v[52:55], a[152:155], v[168:171], v[52:55]
  v_exp_f32 v21, v21
  v_mfma_f32_16x16x32_bf16 v[52:55], a[156:159], v[172:175], v[52:55]
  ds_read_b64_tr_b16 a[170:171], v217 offset:53248
  v_cvt_pk_bf16_f32 v18, v20, v21
  v_mfma_f32_16x16x32_bf16 v[60:63], a[156:159], v[188:191], v[204:207]
  v_exp_f32 v22, v22
  v_mfma_f32_16x16x32_bf16 v[60:63], a[152:155], v[184:187], v[60:63]
  ds_read_b64_tr_b16 a[172:173], v217 offset:57344
  v_mfma_f32_16x16x32_bf16 v[60:63], a[148:151], v[180:183], v[60:63]
  v_exp_f32 v23, v23
  v_mfma_f32_16x16x32_bf16 v[60:63], a[144:147], v[176:179], v[60:63]
  ds_read_b64_tr_b16 a[174:175], v217 offset:61440
  v_cvt_pk_bf16_f32 v19, v22, v23
  v_mfma_f32_16x16x32_bf16 a[192:195], a[208:211], v[64:67], a[192:195]
  v_exp_f32 v28, v28
  v_mfma_f32_16x16x32_bf16 a[192:195], a[208:211], v[96:99], a[192:195]
  ds_read_b64_tr_b16 a[176:177], v218 offset:49152
  v_add_u32 v245, 1, v245
  v_mfma_f32_16x16x32_bf16 a[196:199], a[208:211], v[72:75], a[196:199]
  v_exp_f32 v29, v29
  v_mfma_f32_16x16x32_bf16 a[196:199], a[208:211], v[104:107], a[196:199]
  ds_read_b64_tr_b16 a[178:179], v218 offset:53248
  v_cvt_pk_bf16_f32 v26, v28, v29
  v_mfma_f32_16x16x32_bf16 a[200:203], a[208:211], v[80:83], a[200:203]
  v_exp_f32 v30, v30
  v_mfma_f32_16x16x32_bf16 a[200:203], a[208:211], v[112:115], a[200:203]
  ds_read_b64_tr_b16 a[180:181], v218 offset:57344
  ds_write_b32 v246, v245
  v_mfma_f32_16x16x32_bf16 a[204:207], a[208:211], v[88:91], a[204:207]
  s_waitcnt lgkmcnt(8)
  v_exp_f32 v31, v31
  v_mfma_f32_16x16x32_bf16 a[204:207], a[208:211], v[120:123], a[204:207]
  ds_read_b64_tr_b16 a[182:183], v218 offset:61440
  v_cvt_pk_bf16_f32 v27, v30, v31
  v_mfma_f32_16x16x32_bf16 a[0:3], a[160:163], v[64:67], a[0:3]
  v_exp_f32 v32, v32
  v_mfma_f32_16x16x32_bf16 a[0:3], a[164:167], v[96:99], a[0:3]
  ds_read_b64_tr_b16 a[184:185], v219 offset:49152
  v_mfma_f32_16x16x32_bf16 a[4:7], a[164:167], v[104:107], a[4:7]
  v_exp_f32 v33, v33
  v_mfma_f32_16x16x32_bf16 a[4:7], a[160:163], v[72:75], a[4:7]
  ds_read_b64_tr_b16 a[186:187], v219 offset:53248
  v_cvt_pk_bf16_f32 v32, v32, v33
  v_mfma_f32_16x16x32_bf16 a[8:11], a[160:163], v[80:83], a[8:11]
  v_exp_f32 v34, v34
  v_mfma_f32_16x16x32_bf16 a[8:11], a[164:167], v[112:115], a[8:11]
  ds_read_b64_tr_b16 a[188:189], v219 offset:57344
  v_mfma_f32_16x16x32_bf16 a[12:15], a[164:167], v[120:123], a[12:15]
  s_waitcnt lgkmcnt(8)
  v_exp_f32 v35, v35
  v_mfma_f32_16x16x32_bf16 a[12:15], a[160:163], v[88:91], a[12:15]
  ds_read_b64_tr_b16 a[190:191], v219 offset:61440
  v_cvt_pk_bf16_f32 v33, v34, v35
  v_mfma_f32_16x16x32_bf16 a[16:19], a[168:171], v[64:67], a[16:19]
  v_exp_f32 v40, v40
  v_mfma_f32_16x16x32_bf16 a[16:19], a[172:175], v[96:99], a[16:19]
  ds_read_b64_tr_b16 a[160:161], v220 offset:49152
  v_mfma_f32_16x16x32_bf16 a[20:23], a[172:175], v[104:107], a[20:23]
  v_exp_f32 v41, v41
  v_mfma_f32_16x16x32_bf16 a[20:23], a[168:171], v[72:75], a[20:23]
  ds_read_b64_tr_b16 a[162:163], v220 offset:53248
  v_cvt_pk_bf16_f32 v40, v40, v41
  v_mfma_f32_16x16x32_bf16 a[24:27], a[168:171], v[80:83], a[24:27]
  v_exp_f32 v42, v42
  v_mfma_f32_16x16x32_bf16 a[24:27], a[172:175], v[112:115], a[24:27]
  ds_read_b64_tr_b16 a[164:165], v220 offset:57344
  v_mfma_f32_16x16x32_bf16 a[28:31], a[172:175], v[120:123], a[28:31]
  s_waitcnt lgkmcnt(7)
  v_exp_f32 v43, v43
  v_mfma_f32_16x16x32_bf16 a[28:31], a[168:171], v[88:91], a[28:31]
  ds_read_b64_tr_b16 a[166:167], v220 offset:61440
  v_cvt_pk_bf16_f32 v41, v42, v43
  v_mfma_f32_16x16x32_bf16 a[32:35], a[176:179], v[64:67], a[32:35]
  v_exp_f32 v48, v48
  v_mfma_f32_16x16x32_bf16 a[32:35], a[180:183], v[96:99], a[32:35]
  ds_read_b64_tr_b16 a[168:169], v221 offset:49152
  v_mfma_f32_16x16x32_bf16 a[36:39], a[180:183], v[104:107], a[36:39]
  v_exp_f32 v49, v49
  v_mfma_f32_16x16x32_bf16 a[36:39], a[176:179], v[72:75], a[36:39]
  ds_read_b64_tr_b16 a[170:171], v221 offset:53248
  v_cvt_pk_bf16_f32 v48, v48, v49
  v_mfma_f32_16x16x32_bf16 a[40:43], a[176:179], v[80:83], a[40:43]
  v_exp_f32 v50, v50
  v_mfma_f32_16x16x32_bf16 a[40:43], a[180:183], v[112:115], a[40:43]
  ds_read_b64_tr_b16 a[172:173], v221 offset:57344
  v_mfma_f32_16x16x32_bf16 a[44:47], a[180:183], v[120:123], a[44:47]
  s_waitcnt lgkmcnt(7)
  v_exp_f32 v51, v51
  v_mfma_f32_16x16x32_bf16 a[44:47], a[176:179], v[88:91], a[44:47]
  ds_read_b64_tr_b16 a[174:175], v221 offset:61440
  v_cvt_pk_bf16_f32 v49, v50, v51
  v_mfma_f32_16x16x32_bf16 a[48:51], a[184:187], v[64:67], a[48:51]
  v_exp_f32 v56, v56
  v_mfma_f32_16x16x32_bf16 a[48:51], a[188:191], v[96:99], a[48:51]
  ds_read_b64_tr_b16 a[176:177], v222 offset:49152
  v_mfma_f32_16x16x32_bf16 a[52:55], a[188:191], v[104:107], a[52:55]
  v_exp_f32 v57, v57
  v_mfma_f32_16x16x32_bf16 a[52:55], a[184:187], v[72:75], a[52:55]
  ds_read_b64_tr_b16 a[178:179], v222 offset:53248
  v_cvt_pk_bf16_f32 v56, v56, v57
  v_mfma_f32_16x16x32_bf16 a[56:59], a[184:187], v[80:83], a[56:59]
  v_exp_f32 v58, v58
  v_mfma_f32_16x16x32_bf16 a[56:59], a[188:191], v[112:115], a[56:59]
  ds_read_b64_tr_b16 a[180:181], v222 offset:57344
  v_mfma_f32_16x16x32_bf16 a[60:63], a[188:191], v[120:123], a[60:63]
  s_waitcnt lgkmcnt(7)
  v_exp_f32 v59, v59
  v_mfma_f32_16x16x32_bf16 a[60:63], a[184:187], v[88:91], a[60:63]
  ds_read_b64_tr_b16 a[182:183], v222 offset:61440
  v_cvt_pk_bf16_f32 v57, v58, v59
  v_mfma_f32_16x16x32_bf16 a[64:67], a[160:163], v[64:67], a[64:67]
  v_exp_f32 v36, v36
  v_mfma_f32_16x16x32_bf16 a[64:67], a[164:167], v[96:99], a[64:67]
  ds_read_b64_tr_b16 a[184:185], v223 offset:49152
  ds_read_b32 v248, v247
  v_mfma_f32_16x16x32_bf16 a[68:71], a[164:167], v[104:107], a[68:71]
  v_exp_f32 v37, v37
  v_mfma_f32_16x16x32_bf16 a[68:71], a[160:163], v[72:75], a[68:71]
  ds_read_b64_tr_b16 a[186:187], v223 offset:53248
  v_cvt_pk_bf16_f32 v34, v36, v37
  v_mfma_f32_16x16x32_bf16 a[72:75], a[160:163], v[80:83], a[72:75]
  v_exp_f32 v38, v38
  v_mfma_f32_16x16x32_bf16 a[72:75], a[164:167], v[112:115], a[72:75]
  ds_read_b64_tr_b16 a[188:189], v223 offset:57344
  v_mfma_f32_16x16x32_bf16 a[76:79], a[164:167], v[120:123], a[76:79]
  s_waitcnt lgkmcnt(8)
  v_exp_f32 v39, v39
  v_mfma_f32_16x16x32_bf16 a[76:79], a[160:163], v[88:91], a[76:79]
  ds_read_b64_tr_b16 a[190:191], v223 offset:61440
  v_cvt_pk_bf16_f32 v35, v38, v39
  v_mfma_f32_16x16x32_bf16 a[80:83], a[168:171], v[64:67], a[80:83]
  s_waitcnt lgkmcnt(3)
  v_exp_f32 v44, v44
  v_mfma_f32_16x16x32_bf16 a[80:83], a[172:175], v[96:99], a[80:83]
  v_cmp_lt_u32 vcc, v248, v245
  v_mfma_f32_16x16x32_bf16 a[84:87], a[172:175], v[104:107], a[84:87]
  s_cbranch_vccnz attn_wait27
attn_on27:
  v_exp_f32 v45, v45
  v_mfma_f32_16x16x32_bf16 a[84:87], a[168:171], v[72:75], a[84:87]
  ds_read_b128 a[128:131], v212 offset:16384
  v_cvt_pk_bf16_f32 v42, v44, v45
  v_mfma_f32_16x16x32_bf16 a[88:91], a[168:171], v[80:83], a[88:91]
  v_exp_f32 v46, v46
  v_mfma_f32_16x16x32_bf16 a[88:91], a[172:175], v[112:115], a[88:91]
  ds_read_b128 a[132:135], v213 offset:16384
  v_mfma_f32_16x16x32_bf16 a[92:95], a[172:175], v[120:123], a[92:95]
  v_exp_f32 v47, v47
  v_mfma_f32_16x16x32_bf16 a[92:95], a[168:171], v[88:91], a[92:95]
  ds_read_b128 a[136:139], v214 offset:16384
  v_cvt_pk_bf16_f32 v43, v46, v47
  v_mfma_f32_16x16x32_bf16 a[96:99], a[176:179], v[64:67], a[96:99]
  v_exp_f32 v52, v52
  v_mfma_f32_16x16x32_bf16 a[96:99], a[180:183], v[96:99], a[96:99]
  ds_read_b128 a[140:143], v215 offset:16384
  v_mfma_f32_16x16x32_bf16 a[100:103], a[180:183], v[104:107], a[100:103]
  v_exp_f32 v53, v53
  v_mfma_f32_16x16x32_bf16 a[100:103], a[176:179], v[72:75], a[100:103]
  v_cvt_pk_bf16_f32 v50, v52, v53
  v_mfma_f32_16x16x32_bf16 a[104:107], a[176:179], v[80:83], a[104:107]
  v_exp_f32 v54, v54
  v_mfma_f32_16x16x32_bf16 a[104:107], a[180:183], v[112:115], a[104:107]
  v_mfma_f32_16x16x32_bf16 a[108:111], a[180:183], v[120:123], a[108:111]
  s_waitcnt lgkmcnt(4)
  v_exp_f32 v55, v55
  v_mfma_f32_16x16x32_bf16 a[108:111], a[176:179], v[88:91], a[108:111]
  v_cvt_pk_bf16_f32 v51, v54, v55
  v_mfma_f32_16x16x32_bf16 a[112:115], a[184:187], v[64:67], a[112:115]
  v_exp_f32 v60, v60
  v_mfma_f32_16x16x32_bf16 a[112:115], a[188:191], v[96:99], a[112:115]
  v_mfma_f32_16x16x32_bf16 a[116:119], a[188:191], v[104:107], a[116:119]
  v_exp_f32 v61, v61
  v_mfma_f32_16x16x32_bf16 a[116:119], a[184:187], v[72:75], a[116:119]
  v_cvt_pk_bf16_f32 v58, v60, v61
  v_mfma_f32_16x16x32_bf16 a[120:123], a[184:187], v[80:83], a[120:123]
  v_exp_f32 v62, v62
  v_mfma_f32_16x16x32_bf16 a[120:123], a[188:191], v[112:115], a[120:123]
  v_mfma_f32_16x16x32_bf16 a[124:127], a[188:191], v[120:123], a[124:127]
  s_waitcnt lgkmcnt(0)
  v_exp_f32 v63, v63
  v_mfma_f32_16x16x32_bf16 a[124:127], a[184:187], v[88:91], a[124:127]
  v_cvt_pk_bf16_f32 v59, v62, v63
  v_mfma_f32_16x16x32_bf16 v[64:67], a[128:131], v[128:131], v[192:195]
  s_add_u32 m0, s28, 98304
  v_mfma_f32_16x16x32_bf16 v[64:67], a[132:135], v[132:135], v[64:67]
  ds_read_b128 a[144:147], v212 offset:20480
  v_mfma_f32_16x16x32_bf16 v[64:67], a[136:139], v[136:139], v[64:67]
  buffer_load_dwordx4 v236, s[16:19], s29 offen offset:0 lds
  v_mfma_f32_16x16x32_bf16 v[64:67], a[140:143], v[140:143], v[64:67]
  ds_read_b128 a[148:151], v213 offset:20480
  v_mfma_f32_16x16x32_bf16 v[72:75], a[140:143], v[156:159], v[196:199]
  v_mfma_f32_16x16x32_bf16 v[72:75], a[136:139], v[152:155], v[72:75]
  ds_read_b128 a[152:155], v214 offset:20480
  v_mfma_f32_16x16x32_bf16 v[72:75], a[132:135], v[148:151], v[72:75]
  buffer_load_dwordx4 v237, s[16:19], s29 offen offset:1024 lds
  v_mfma_f32_16x16x32_bf16 v[72:75], a[128:131], v[144:147], v[72:75]
  ds_read_b128 a[156:159], v215 offset:20480
  v_mfma_f32_16x16x32_bf16 v[80:83], a[128:131], v[160:163], v[200:203]
  v_exp_f32 v64, v64
  v_mfma_f32_16x16x32_bf16 v[80:83], a[132:135], v[164:167], v[80:83]
  v_mfma_f32_16x16x32_bf16 v[80:83], a[136:139], v[168:171], v[80:83]
  v_exp_f32 v65, v65
  v_mfma_f32_16x16x32_bf16 v[80:83], a[140:143], v[172:175], v[80:83]
  v_cvt_pk_bf16_f32 v64, v64, v65
  v_mfma_f32_16x16x32_bf16 v[88:91], a[140:143], v[188:191], v[204:207]
  v_exp_f32 v66, v66
  v_mfma_f32_16x16x32_bf16 v[88:91], a[136:139], v[184:187], v[88:91]
  buffer_load_dwordx4 v236, s[16:19], s29 offen offset:2048 lds
  v_mfma_f32_16x16x32_bf16 v[88:91], a[132:135], v[180:183], v[88:91]
  s_waitcnt lgkmcnt(0)
  v_exp_f32 v67, v67
  v_mfma_f32_16x16x32_bf16 v[88:91], a[128:131], v[176:179], v[88:91]
  v_cvt_pk_bf16_f32 v65, v66, v67
  v_mfma_f32_16x16x32_bf16 v[68:71], a[144:147], v[128:131], v[192:195]
  v_exp_f32 v72, v72
  v_mfma_f32_16x16x32_bf16 v[68:71], a[148:151], v[132:135], v[68:71]
  ds_read_b128 a[128:131], v212 offset:24576
  v_mfma_f32_16x16x32_bf16 v[68:71], a[152:155], v[136:139], v[68:71]
  v_exp_f32 v73, v73
  v_mfma_f32_16x16x32_bf16 v[68:71], a[156:159], v[140:143], v[68:71]
  ds_read_b128 a[132:135], v213 offset:24576
  v_cvt_pk_bf16_f32 v72, v72, v73
  v_mfma_f32_16x16x32_bf16 v[76:79], a[156:159], v[156:159], v[196:199]
  v_exp_f32 v74, v74
  v_mfma_f32_16x16x32_bf16 v[76:79], a[152:155], v[152:155], v[76:79]
  ds_read_b128 a[136:139], v214 offset:24576
  v_lshrrev_b32 v224, 4, v242
  v_mfma_f32_16x16x32_bf16 v[76:79], a[148:151], v[148:151], v[76:79]
  v_exp_f32 v75, v75
  v_mfma_f32_16x16x32_bf16 v[76:79], a[144:147], v[144:147], v[76:79]
  ds_read_b128 a[140:143], v215 offset:24576
  v_cvt_pk_bf16_f32 v73, v74, v75
  v_mfma_f32_16x16x32_bf16 v[84:87], a[144:147], v[160:163], v[200:203]
  v_exp_f32 v80, v80
  v_mfma_f32_16x16x32_bf16 v[84:87], a[148:151], v[164:167], v[84:87]
  buffer_load_dwordx4 v237, s[16:19], s29 offen offset:3072 lds
  v_mfma_f32_16x16x32_bf16 v[84:87], a[152:155], v[168:171], v[84:87]
  s_add_u32 s29, s29, 16384
  v_exp_f32 v81, v81
  v_mfma_f32_16x16x32_bf16 v[84:87], a[156:159], v[172:175], v[84:87]
  v_cvt_pk_bf16_f32 v80, v80, v81
  v_lshrrev_b32 v225, 4, v224
  v_mfma_f32_16x16x32_bf16 v[92:95], a[156:159], v[188:191], v[204:207]
  s_add_u32 m0, s28, 49152
  v_exp_f32 v82, v82
  v_mfma_f32_16x16x32_bf16 v[92:95], a[152:155], v[184:187], v[92:95]
  buffer_load_dwordx4 v232, s[12:15], s29 offen offset:0 lds
  v_mfma_f32_16x16x32_bf16 v[92:95], a[148:151], v[180:183], v[92:95]
  s_waitcnt lgkmcnt(0)
  v_exp_f32 v83, v83
  v_mfma_f32_16x16x32_bf16 v[92:95], a[144:147], v[176:179], v[92:95]
  v_cvt_pk_bf16_f32 v81, v82, v83
  v_bfe_u32 v226, v224, 2, 2
  v_mfma_f32_16x16x32_bf16 v[96:99], a[128:131], v[128:131], v[192:195]
  v_exp_f32 v88, v88
  v_mfma_f32_16x16x32_bf16 v[96:99], a[132:135], v[132:135], v[96:99]
  ds_read_b128 a[144:147], v212 offset:28672
  v_lshl_add_u32 v225, v225, 3, v226
  v_mfma_f32_16x16x32_bf16 v[96:99], a[136:139], v[136:139], v[96:99]
  v_exp_f32 v89, v89
  v_mfma_f32_16x16x32_bf16 v[96:99], a[140:143], v[140:143], v[96:99]
  ds_read_b128 a[148:151], v213 offset:28672
  v_cvt_pk_bf16_f32 v88, v88, v89
  v_mfma_f32_16x16x32_bf16 v[104:107], a[140:143], v[156:159], v[196:199]
  v_exp_f32 v90, v90
  v_mfma_f32_16x16x32_bf16 v[104:107], a[136:139], v[152:155], v[104:107]
  ds_read_b128 a[152:155], v214 offset:28672
  v_lshlrev_b32 v225, 5, v225
  v_mfma_f32_16x16x32_bf16 v[104:107], a[132:135], v[148:151], v[104:107]
  v_exp_f32 v91, v91
  v_mfma_f32_16x16x32_bf16 v[104:107], a[128:131], v[144:147], v[104:107]
  ds_read_b128 a[156:159], v215 offset:28672
  v_cvt_pk_bf16_f32 v89, v90, v91
  v_mfma_f32_16x16x32_bf16 v[112:115], a[128:131], v[160:163], v[200:203]
  v_exp_f32 v68, v68
  v_mfma_f32_16x16x32_bf16 v[112:115], a[132:135], v[164:167], v[112:115]
  buffer_load_dwordx4 v233, s[12:15], s29 offen offset:1024 lds
  v_mfma_f32_16x16x32_bf16 v[112:115], a[136:139], v[168:171], v[112:115]
  v_exp_f32 v69, v69
  v_mfma_f32_16x16x32_bf16 v[112:115], a[140:143], v[172:175], v[112:115]
  v_cvt_pk_bf16_f32 v66, v68, v69
  v_and_b32 v226, 3, v224
  v_mfma_f32_16x16x32_bf16 v[120:123], a[140:143], v[188:191], v[204:207]
  v_exp_f32 v70, v70
  v_mfma_f32_16x16x32_bf16 v[120:123], a[136:139], v[184:187], v[120:123]
  buffer_load_dwordx4 v234, s[12:15], s29 offen offset:2048 lds
  v_mfma_f32_16x16x32_bf16 v[120:123], a[132:135], v[180:183], v[120:123]
  s_waitcnt lgkmcnt(0)
  v_exp_f32 v71, v71
  v_mfma_f32_16x16x32_bf16 v[120:123], a[128:131], v[176:179], v[120:123]
  v_cvt_pk_bf16_f32 v67, v70, v71
  v_lshl_add_u32 v225, v226, 3, v225
  v_mfma_f32_16x16x32_bf16 v[100:103], a[144:147], v[128:131], v[192:195]
  v_exp_f32 v76, v76
  v_mfma_f32_16x16x32_bf16 v[100:103], a[148:151], v[132:135], v[100:103]
  ds_read_b64_tr_b16 a[160:161], v216 offset:0
  v_add_u32 v225, s50, v225
  v_mfma_f32_16x16x32_bf16 v[100:103], a[152:155], v[136:139], v[100:103]
  s_waitcnt vmcnt(13)
  v_exp_f32 v77, v77
  v_mfma_f32_16x16x32_bf16 v[100:103], a[156:159], v[140:143], v[100:103]
  ds_read_b64_tr_b16 a[162:163], v216 offset:4096
  v_cvt_pk_bf16_f32 v74, v76, v77
  v_mfma_f32_16x16x32_bf16 v[108:111], a[156:159], v[156:159], v[196:199]
  v_exp_f32 v78, v78
  v_mfma_f32_16x16x32_bf16 v[108:111], a[152:155], v[152:155], v[108:111]
  ds_read_b64_tr_b16 a[164:165], v216 offset:8192
  buffer_load_dwordx4 v235, s[12:15], s29 offen offset:3072 lds
  v_mfma_f32_16x16x32_bf16 v[108:111], a[148:151], v[148:151], v[108:111]
  v_exp_f32 v79, v79
  v_mfma_f32_16x16x32_bf16 v[108:111], a[144:147], v[144:147], v[108:111]
  ds_read_b64_tr_b16 a[166:167], v216 offset:12288
  v_cvt_pk_bf16_f32 v75, v78, v79
  v_mfma_f32_16x16x32_bf16 v[116:119], a[144:147], v[160:163], v[200:203]
  v_exp_f32 v84, v84
  v_mfma_f32_16x16x32_bf16 v[116:119], a[148:151], v[164:167], v[116:119]
  ds_read_b64_tr_b16 a[168:169], v217 offset:0
  ds_read_b64_tr_b16 a[232:233], v225 offset:0
  s_add_u32 m0, s28, 0
  v_mfma_f32_16x16x32_bf16 v[116:119], a[152:155], v[168:171], v[116:119]
  v_exp_f32 v85, v85
  v_mfma_f32_16x16x32_bf16 v[116:119], a[156:159], v[172:175], v[116:119]
  ds_read_b64_tr_b16 a[170:171], v217 offset:4096
  v_cvt_pk_bf16_f32 v82, v84, v85
  v_mfma_f32_16x16x32_bf16 v[124:127], a[156:159], v[188:191], v[204:207]
  v_exp_f32 v86, v86
  v_mfma_f32_16x16x32_bf16 v[124:127], a[152:155], v[184:187], v[124:127]
  ds_read_b64_tr_b16 a[172:173], v217 offset:8192
  ds_read_b64_tr_b16 a[234:235], v225 offset:128
  v_mfma_f32_16x16x32_bf16 v[124:127], a[148:151], v[180:183], v[124:127]
  v_exp_f32 v87, v87
  v_mfma_f32_16x16x32_bf16 v[124:127], a[144:147], v[176:179], v[124:127]
  ds_read_b64_tr_b16 a[174:175], v217 offset:12288
  v_cvt_pk_bf16_f32 v83, v86, v87
  v_mfma_f32_16x16x32_bf16 a[192:195], a[208:211], v[0:3], a[192:195]
  v_exp_f32 v92, v92
  v_mfma_f32_16x16x32_bf16 a[192:195], a[208:211], v[32:35], a[192:195]
  ds_read_b64_tr_b16 a[176:177], v218 offset:0
  v_add_u32 v245, 1, v245
  v_mfma_f32_16x16x32_bf16 a[196:199], a[208:211], v[8:11], a[196:199]
  v_exp_f32 v93, v93
  v_mfma_f32_16x16x32_bf16 a[196:199], a[208:211], v[40:43], a[196:199]
  ds_read_b64_tr_b16 a[178:179], v218 offset:4096
  v_cvt_pk_bf16_f32 v90, v92, v93
  v_mfma_f32_16x16x32_bf16 a[200:203], a[208:211], v[16:19], a[200:203]
  s_waitcnt vmcnt(8)
  v_exp_f32 v94, v94
  ds_read_b64_tr_b16 a[236:237], v225 offset:1024
  ds_read_b64_tr_b16 a[238:239], v225 offset:1152
  ds_read_b64_tr_b16 a[240:241], v225 offset:2048
  ds_read_b64_tr_b16 a[242:243], v225 offset:2176
  s_waitcnt lgkmcnt(0)
  v_mfma_f32_16x16x32_bf16 v[228:231], a[232:235], a[212:215], 0
  v_mfma_f32_16x16x32_bf16 v[228:231], a[236:239], a[216:219], v[228:231]
  v_mfma_f32_16x16x32_bf16 v[228:231], a[240:243], a[220:223], v[228:231]
  s_lshl_b32 s35, s3, 10
  s_add_u32 s35, s35, 159744
  v_add_u32 v224, s35, v242
  s_nop 4
  ds_write_b128 v224, v[228:231]
  s_waitcnt lgkmcnt(0)
  v_mfma_f32_16x16x32_bf16 a[200:203], a[208:211], v[48:51], a[200:203]
  ds_read_b64_tr_b16 a[180:181], v218 offset:8192
  ds_write_b32 v246, v245
  v_mfma_f32_16x16x32_bf16 a[204:207], a[208:211], v[24:27], a[204:207]
  v_exp_f32 v95, v95
  v_mfma_f32_16x16x32_bf16 a[204:207], a[208:211], v[56:59], a[204:207]
  ds_read_b64_tr_b16 a[182:183], v218 offset:12288
  v_cvt_pk_bf16_f32 v91, v94, v95
  v_mfma_f32_16x16x32_bf16 a[0:3], a[160:163], v[0:3], a[0:3]
  v_exp_f32 v96, v96
  v_mfma_f32_16x16x32_bf16 a[0:3], a[164:167], v[32:35], a[0:3]
  ds_read_b64_tr_b16 a[184:185], v219 offset:0
  buffer_load_dwordx4 v253, s[24:27], s8 offen offset:0 sc1 lds
  v_mfma_f32_16x16x32_bf16 a[4:7], a[164:167], v[40:43], a[4:7]
  v_exp_f32 v97, v97
  v_mfma_f32_16x16x32_bf16 a[4:7], a[160:163], v[8:11], a[4:7]
  ds_read_b64_tr_b16 a[186:187], v219 offset:4096
  v_cvt_pk_bf16_f32 v96, v96, v97
  v_mfma_f32_16x16x32_bf16 a[8:11], a[160:163], v[16:19], a[8:11]
  v_exp_f32 v98, v98
  v_mfma_f32_16x16x32_bf16 a[8:11], a[164:167], v[48:51], a[8:11]
  ds_read_b64_tr_b16 a[188:189], v219 offset:8192
  buffer_load_dwordx4 v253, s[24:27], s8 offen offset:1024 sc1 lds
  v_mfma_f32_16x16x32_bf16 a[12:15], a[164:167], v[56:59], a[12:15]
  v_exp_f32 v99, v99
  v_mfma_f32_16x16x32_bf16 a[12:15], a[160:163], v[24:27], a[12:15]
  ds_read_b64_tr_b16 a[190:191], v219 offset:12288
  v_cvt_pk_bf16_f32 v97, v98, v99
  v_mfma_f32_16x16x32_bf16 a[16:19], a[168:171], v[0:3], a[16:19]
  v_exp_f32 v104, v104
  v_mfma_f32_16x16x32_bf16 a[16:19], a[172:175], v[32:35], a[16:19]
  ds_read_b64_tr_b16 a[160:161], v220 offset:0
  buffer_load_dwordx4 v253, s[24:27], s8 offen offset:2048 sc1 lds
  v_mfma_f32_16x16x32_bf16 a[20:23], a[172:175], v[40:43], a[20:23]
  v_exp_f32 v105, v105
  v_mfma_f32_16x16x32_bf16 a[20:23], a[168:171], v[8:11], a[20:23]
  ds_read_b64_tr_b16 a[162:163], v220 offset:4096
  v_cvt_pk_bf16_f32 v104, v104, v105
  v_mfma_f32_16x16x32_bf16 a[24:27], a[168:171], v[16:19], a[24:27]
  v_exp_f32 v106, v106
  v_mfma_f32_16x16x32_bf16 a[24:27], a[172:175], v[48:51], a[24:27]
  ds_read_b64_tr_b16 a[164:165], v220 offset:8192
  v_mfma_f32_16x16x32_bf16 a[28:31], a[172:175], v[56:59], a[28:31]
  s_waitcnt lgkmcnt(7)
  v_exp_f32 v107, v107
  v_mfma_f32_16x16x32_bf16 a[28:31], a[168:171], v[24:27], a[28:31]
  ds_read_b64_tr_b16 a[166:167], v220 offset:12288
  v_cvt_pk_bf16_f32 v105, v106, v107
  v_mfma_f32_16x16x32_bf16 a[32:35], a[176:179], v[0:3], a[32:35]
  v_exp_f32 v112, v112
  v_mfma_f32_16x16x32_bf16 a[32:35], a[180:183], v[32:35], a[32:35]
  ds_read_b64_tr_b16 a[168:169], v221 offset:0
  buffer_load_dwordx4 v253, s[24:27], s8 offen offset:3072 sc1 lds
  v_mfma_f32_16x16x32_bf16 a[36:39], a[180:183], v[40:43], a[36:39]
  v_exp_f32 v113, v113
  v_mfma_f32_16x16x32_bf16 a[36:39], a[176:179], v[8:11], a[36:39]
  ds_read_b64_tr_b16 a[170:171], v221 offset:4096
  v_cvt_pk_bf16_f32 v112, v112, v113
  v_mfma_f32_16x16x32_bf16 a[40:43], a[176:179], v[16:19], a[40:43]
  v_exp_f32 v114, v114
  v_mfma_f32_16x16x32_bf16 a[40:43], a[180:183], v[48:51], a[40:43]
  ds_read_b64_tr_b16 a[172:173], v221 offset:8192
  v_mfma_f32_16x16x32_bf16 a[44:47], a[180:183], v[56:59], a[44:47]
  s_waitcnt lgkmcnt(7)
  v_exp_f32 v115, v115
  v_mfma_f32_16x16x32_bf16 a[44:47], a[176:179], v[24:27], a[44:47]
  ds_read_b64_tr_b16 a[174:175], v221 offset:12288
  v_cvt_pk_bf16_f32 v113, v114, v115
  v_mfma_f32_16x16x32_bf16 a[48:51], a[184:187], v[0:3], a[48:51]
  v_exp_f32 v120, v120
  v_mfma_f32_16x16x32_bf16 a[48:51], a[188:191], v[32:35], a[48:51]
  ds_read_b64_tr_b16 a[176:177], v222 offset:0
  v_mfma_f32_16x16x32_bf16 a[52:55], a[188:191], v[40:43], a[52:55]
  v_exp_f32 v121, v121
  v_mfma_f32_16x16x32_bf16 a[52:55], a[184:187], v[8:11], a[52:55]
  ds_read_b64_tr_b16 a[178:179], v222 offset:4096
  v_cvt_pk_bf16_f32 v120, v120, v121
  v_mfma_f32_16x16x32_bf16 a[56:59], a[184:187], v[16:19], a[56:59]
  v_exp_f32 v122, v122
  v_mfma_f32_16x16x32_bf16 a[56:59], a[188:191], v[48:51], a[56:59]
  ds_read_b64_tr_b16 a[180:181], v222 offset:8192
  v_mfma_f32_16x16x32_bf16 a[60:63], a[188:191], v[56:59], a[60:63]
  s_waitcnt lgkmcnt(7)
  v_exp_f32 v123, v123
  v_mfma_f32_16x16x32_bf16 a[60:63], a[184:187], v[24:27], a[60:63]
  ds_read_b64_tr_b16 a[182:183], v222 offset:12288
  v_cvt_pk_bf16_f32 v121, v122, v123
  v_mfma_f32_16x16x32_bf16 a[64:67], a[160:163], v[0:3], a[64:67]
  v_exp_f32 v100, v100
  v_mfma_f32_16x16x32_bf16 a[64:67], a[164:167], v[32:35], a[64:67]
  ds_read_b64_tr_b16 a[184:185], v223 offset:0
  ds_read_b32 v248, v247
  v_mfma_f32_16x16x32_bf16 a[68:71], a[164:167], v[40:43], a[68:71]
  v_exp_f32 v101, v101
  v_mfma_f32_16x16x32_bf16 a[68:71], a[160:163], v[8:11], a[68:71]
  ds_read_b64_tr_b16 a[186:187], v223 offset:4096
  v_cvt_pk_bf16_f32 v98, v100, v101
  v_mfma_f32_16x16x32_bf16 a[72:75], a[160:163], v[16:19], a[72:75]
  v_exp_f32 v102, v102
  v_mfma_f32_16x16x32_bf16 a[72:75], a[164:167], v[48:51], a[72:75]
  ds_read_b64_tr_b16 a[188:189], v223 offset:8192
  v_mfma_f32_16x16x32_bf16 a[76:79], a[164:167], v[56:59], a[76:79]
  s_waitcnt lgkmcnt(8)
  v_exp_f32 v103, v103
  v_mfma_f32_16x16x32_bf16 a[76:79], a[160:163], v[24:27], a[76:79]
  ds_read_b64_tr_b16 a[190:191], v223 offset:12288
  v_cvt_pk_bf16_f32 v99, v102, v103
  v_mfma_f32_16x16x32_bf16 a[80:83], a[168:171], v[0:3], a[80:83]
  s_waitcnt lgkmcnt(3)
  v_exp_f32 v108, v108
  v_mfma_f32_16x16x32_bf16 a[80:83], a[172:175], v[32:35], a[80:83]
  v_cmp_lt_u32 vcc, v248, v245
  v_mfma_f32_16x16x32_bf16 a[84:87], a[172:175], v[40:43], a[84:87]
  s_cbranch_vccnz attn_wait28
attn_on28:
  v_exp_f32 v109, v109
  v_mfma_f32_16x16x32_bf16 a[84:87], a[168:171], v[8:11], a[84:87]
  ds_read_b128 a[128:131], v212 offset:32768
  v_cvt_pk_bf16_f32 v106, v108, v109
  v_mfma_f32_16x16x32_bf16 a[88:91], a[168:171], v[16:19], a[88:91]
  v_exp_f32 v110, v110
  v_mfma_f32_16x16x32_bf16 a[88:91], a[172:175], v[48:51], a[88:91]
  ds_read_b128 a[132:135], v213 offset:32768
  v_mfma_f32_16x16x32_bf16 a[92:95], a[172:175], v[56:59], a[92:95]
  v_exp_f32 v111, v111
  v_mfma_f32_16x16x32_bf16 a[92:95], a[168:171], v[24:27], a[92:95]
  ds_read_b128 a[136:139], v214 offset:32768
  v_cvt_pk_bf16_f32 v107, v110, v111
  v_mfma_f32_16x16x32_bf16 a[96:99], a[176:179], v[0:3], a[96:99]
  v_exp_f32 v116, v116
  v_mfma_f32_16x16x32_bf16 a[96:99], a[180:183], v[32:35], a[96:99]
  ds_read_b128 a[140:143], v215 offset:32768
  v_mfma_f32_16x16x32_bf16 a[100:103], a[180:183], v[40:43], a[100:103]
  v_exp_f32 v117, v117
  v_mfma_f32_16x16x32_bf16 a[100:103], a[176:179], v[8:11], a[100:103]
  v_cvt_pk_bf16_f32 v114, v116, v117
  v_mfma_f32_16x16x32_bf16 a[104:107], a[176:179], v[16:19], a[104:107]
  v_exp_f32 v118, v118
  v_mfma_f32_16x16x32_bf16 a[104:107], a[180:183], v[48:51], a[104:107]
  v_mfma_f32_16x16x32_bf16 a[108:111], a[180:183], v[56:59], a[108:111]
  s_waitcnt lgkmcnt(4)
  v_exp_f32 v119, v119
  v_mfma_f32_16x16x32_bf16 a[108:111], a[176:179], v[24:27], a[108:111]
  v_cvt_pk_bf16_f32 v115, v118, v119
  v_mfma_f32_16x16x32_bf16 a[112:115], a[184:187], v[0:3], a[112:115]
  v_exp_f32 v124, v124
  v_mfma_f32_16x16x32_bf16 a[112:115], a[188:191], v[32:35], a[112:115]
  v_mfma_f32_16x16x32_bf16 a[116:119], a[188:191], v[40:43], a[116:119]
  v_exp_f32 v125, v125
  v_mfma_f32_16x16x32_bf16 a[116:119], a[184:187], v[8:11], a[116:119]
  v_cvt_pk_bf16_f32 v122, v124, v125
  v_mfma_f32_16x16x32_bf16 a[120:123], a[184:187], v[16:19], a[120:123]
  v_exp_f32 v126, v126
  v_mfma_f32_16x16x32_bf16 a[120:123], a[188:191], v[48:51], a[120:123]
  v_mfma_f32_16x16x32_bf16 a[124:127], a[188:191], v[56:59], a[124:127]
  s_waitcnt lgkmcnt(0)
  v_exp_f32 v127, v127
  v_mfma_f32_16x16x32_bf16 a[124:127], a[184:187], v[24:27], a[124:127]
  v_cvt_pk_bf16_f32 v123, v126, v127
  v_mfma_f32_16x16x32_bf16 v[0:3], a[128:131], v[128:131], v[192:195]
  s_add_u32 m0, s28, 114688
  v_add_u32 v224, 159744, v242
  v_mfma_f32_16x16x32_bf16 v[0:3], a[132:135], v[132:135], v[0:3]
  ds_read_b128 a[144:147], v212 offset:36864
  ds_read_b128 v[228:231], v224 offset:0
  v_mfma_f32_16x16x32_bf16 v[0:3], a[136:139], v[136:139], v[0:3]
  buffer_load_dwordx4 v236, s[16:19], s29 offen offset:0 lds
  v_mfma_f32_16x16x32_bf16 v[0:3], a[140:143], v[140:143], v[0:3]
  ds_read_b128 a[148:151], v213 offset:36864
  ds_read_b128 v[238:241], v224 offset:1024
  v_mfma_f32_16x16x32_bf16 v[8:11], a[140:143], v[156:159], v[196:199]
  ds_read_b128 v[208:211], v224 offset:2048
  v_lshrrev_b32 v224, 4, v242
  v_mfma_f32_16x16x32_bf16 v[8:11], a[136:139], v[152:155], v[8:11]
  ds_read_b128 a[152:155], v214 offset:36864
  s_min_u32 s35, s3, 1
  s_lshl_b32 s35, s35, 30
  v_and_b32 v225, 7, v224
  v_mfma_f32_16x16x32_bf16 v[8:11], a[132:135], v[148:151], v[8:11]
  buffer_load_dwordx4 v237, s[16:19], s29 offen offset:1024 lds
  v_mfma_f32_16x16x32_bf16 v[8:11], a[128:131], v[144:147], v[8:11]
  ds_read_b128 a[156:159], v215 offset:36864
  v_mul_u32_u24 v225, 0xa00, v225
  v_mfma_f32_16x16x32_bf16 v[16:19], a[128:131], v[160:163], v[200:203]
  v_exp_f32 v0, v0
  v_mfma_f32_16x16x32_bf16 v[16:19], a[132:135], v[164:167], v[16:19]
  v_lshrrev_b32 v226, 4, v224
  v_lshl_add_u32 v225, v226, 4, v225
  v_mfma_f32_16x16x32_bf16 v[16:19], a[136:139], v[168:171], v[16:19]
  v_exp_f32 v1, v1
  v_mfma_f32_16x16x32_bf16 v[16:19], a[140:143], v[172:175], v[16:19]
  v_cvt_pk_bf16_f32 v0, v0, v1
  v_bfe_u32 v226, v224, 3, 1
  v_mfma_f32_16x16x32_bf16 v[24:27], a[140:143], v[188:191], v[204:207]
  v_exp_f32 v2, v2
  v_mfma_f32_16x16x32_bf16 v[24:27], a[136:139], v[184:187], v[24:27]
  buffer_load_dwordx4 v236, s[16:19], s29 offen offset:2048 lds
  v_mfma_f32_16x16x32_bf16 v[24:27], a[132:135], v[180:183], v[24:27]
  s_waitcnt lgkmcnt(0)
  v_exp_f32 v3, v3
  v_mfma_f32_16x16x32_bf16 v[24:27], a[128:131], v[176:179], v[24:27]
  v_cvt_pk_bf16_f32 v1, v2, v3
  v_lshl_add_u32 v225, v226, 30, v225
  v_mfma_f32_16x16x32_bf16 v[4:7], a[144:147], v[128:131], v[192:195]
  v_exp_f32 v8, v8
  v_mfma_f32_16x16x32_bf16 v[4:7], a[148:151], v[132:135], v[4:7]
  ds_read_b128 a[128:131], v212 offset:40960
  v_or_b32 v225, s35, v225
  v_mfma_f32_16x16x32_bf16 v[4:7], a[152:155], v[136:139], v[4:7]
  s_mul_i32 s35, s98, 20480
  s_lshl_b32 s38, s99, 6
  s_add_u32 s35, s35, s38
  v_exp_f32 v9, v9
  v_mfma_f32_16x16x32_bf16 v[4:7], a[156:159], v[140:143], v[4:7]
  ds_read_b128 a[132:135], v213 offset:40960
  s_add_u32 s35, s35, 2686976
  v_cvt_pk_bf16_f32 v8, v8, v9
  v_mfma_f32_16x16x32_bf16 v[12:15], a[156:159], v[156:159], v[196:199]
  v_exp_f32 v10, v10
  v_mfma_f32_16x16x32_bf16 v[12:15], a[152:155], v[152:155], v[12:15]
  ds_read_b128 a[136:139], v214 offset:40960
  v_add_f32 v228, v228, v238
  v_mfma_f32_16x16x32_bf16 v[12:15], a[148:151], v[148:151], v[12:15]
  v_exp_f32 v11, v11
  v_mfma_f32_16x16x32_bf16 v[12:15], a[144:147], v[144:147], v[12:15]
  ds_read_b128 a[140:143], v215 offset:40960
  v_cvt_pk_bf16_f32 v9, v10, v11
  v_mfma_f32_16x16x32_bf16 v[20:23], a[144:147], v[160:163], v[200:203]
  v_exp_f32 v16, v16
  v_mfma_f32_16x16x32_bf16 v[20:23], a[148:151], v[164:167], v[20:23]
  buffer_load_dwordx4 v237, s[16:19], s29 offen offset:3072 lds
  v_mfma_f32_16x16x32_bf16 v[20:23], a[152:155], v[168:171], v[20:23]
  s_add_u32 s29, s29, 16384
  v_exp_f32 v17, v17
  v_mfma_f32_16x16x32_bf16 v[20:23], a[156:159], v[172:175], v[20:23]
  v_cvt_pk_bf16_f32 v16, v16, v17
  v_add_f32 v229, v229, v239
  v_mfma_f32_16x16x32_bf16 v[28:31], a[156:159], v[188:191], v[204:207]
  s_add_u32 m0, s28, 16384
  v_exp_f32 v18, v18
  v_mfma_f32_16x16x32_bf16 v[28:31], a[152:155], v[184:187], v[28:31]
  buffer_load_dwordx4 v242, s[24:27], s9 offen offset:0 sc1 lds
  v_mfma_f32_16x16x32_bf16 v[28:31], a[148:151], v[180:183], v[28:31]
  s_waitcnt lgkmcnt(0)
  v_exp_f32 v19, v19
  v_mfma_f32_16x16x32_bf16 v[28:31], a[144:147], v[176:179], v[28:31]
  v_cvt_pk_bf16_f32 v17, v18, v19
  v_add_f32 v230, v230, v240
  v_mfma_f32_16x16x32_bf16 v[32:35], a[128:131], v[128:131], v[192:195]
  v_exp_f32 v24, v24
  v_mfma_f32_16x16x32_bf16 v[32:35], a[132:135], v[132:135], v[32:35]
  ds_read_b128 a[144:147], v212 offset:45056
  v_add_f32 v231, v231, v241
  v_mfma_f32_16x16x32_bf16 v[32:35], a[136:139], v[136:139], v[32:35]
  v_exp_f32 v25, v25
  v_mfma_f32_16x16x32_bf16 v[32:35], a[140:143], v[140:143], v[32:35]
  ds_read_b128 a[148:151], v213 offset:45056
  v_cvt_pk_bf16_f32 v24, v24, v25
  v_mfma_f32_16x16x32_bf16 v[40:43], a[140:143], v[156:159], v[196:199]
  v_exp_f32 v26, v26
  v_mfma_f32_16x16x32_bf16 v[40:43], a[136:139], v[152:155], v[40:43]
  ds_read_b128 a[152:155], v214 offset:45056
  v_add_f32 v228, v228, v208
  v_mfma_f32_16x16x32_bf16 v[40:43], a[132:135], v[148:151], v[40:43]
  v_exp_f32 v27, v27
  v_mfma_f32_16x16x32_bf16 v[40:43], a[128:131], v[144:147], v[40:43]
  ds_read_b128 a[156:159], v215 offset:45056
  v_cvt_pk_bf16_f32 v25, v26, v27
  v_mfma_f32_16x16x32_bf16 v[48:51], a[128:131], v[160:163], v[200:203]
  v_exp_f32 v4, v4
  v_mfma_f32_16x16x32_bf16 v[48:51], a[132:135], v[164:167], v[48:51]
  buffer_load_dwordx4 v242, s[24:27], s9 offen offset:1024 sc1 lds
  v_mfma_f32_16x16x32_bf16 v[48:51], a[136:139], v[168:171], v[48:51]
  v_exp_f32 v5, v5
  v_mfma_f32_16x16x32_bf16 v[48:51], a[140:143], v[172:175], v[48:51]
  v_cvt_pk_bf16_f32 v2, v4, v5
  v_add_f32 v229, v229, v209
  v_mfma_f32_16x16x32_bf16 v[56:59], a[140:143], v[188:191], v[204:207]
  v_exp_f32 v6, v6
  v_mfma_f32_16x16x32_bf16 v[56:59], a[136:139], v[184:187], v[56:59]
  buffer_load_dwordx4 v242, s[24:27], s9 offen offset:2048 sc1 lds
  v_mfma_f32_16x16x32_bf16 v[56:59], a[132:135], v[180:183], v[56:59]
  s_waitcnt lgkmcnt(0)
  v_exp_f32 v7, v7
  v_mfma_f32_16x16x32_bf16 v[56:59], a[128:131], v[176:179], v[56:59]
  v_cvt_pk_bf16_f32 v3, v6, v7
  v_add_f32 v230, v230, v210
  v_mfma_f32_16x16x32_bf16 v[36:39], a[144:147], v[128:131], v[192:195]
  v_exp_f32 v12, v12
  v_mfma_f32_16x16x32_bf16 v[36:39], a[148:151], v[132:135], v[36:39]
  ds_read_b64_tr_b16 a[160:161], v216 offset:16384
  v_add_f32 v231, v231, v211
  v_mfma_f32_16x16x32_bf16 v[36:39], a[152:155], v[136:139], v[36:39]
  v_exp_f32 v13, v13
  v_mfma_f32_16x16x32_bf16 v[36:39], a[156:159], v[140:143], v[36:39]
  ds_read_b64_tr_b16 a[162:163], v216 offset:20480
  v_cvt_pk_bf16_f32 v10, v12, v13
  v_mfma_f32_16x16x32_bf16 v[44:47], a[156:159], v[156:159], v[196:199]
  v_exp_f32 v14, v14
  v_mfma_f32_16x16x32_bf16 v[44:47], a[152:155], v[152:155], v[44:47]
  ds_read_b64_tr_b16 a[164:165], v216 offset:24576
  buffer_load_dwordx4 v242, s[24:27], s9 offen offset:3072 sc1 lds
  v_mfma_f32_16x16x32_bf16 v[44:47], a[148:151], v[148:151], v[44:47]
  v_exp_f32 v15, v15
  v_mfma_f32_16x16x32_bf16 v[44:47], a[144:147], v[144:147], v[44:47]
  ds_read_b64_tr_b16 a[166:167], v216 offset:28672
  v_cvt_pk_bf16_f32 v11, v14, v15
  v_mfma_f32_16x16x32_bf16 v[52:55], a[144:147], v[160:163], v[200:203]
  v_exp_f32 v20, v20
  v_mfma_f32_16x16x32_bf16 v[52:55], a[148:151], v[164:167], v[52:55]
  ds_read_b64_tr_b16 a[168:169], v217 offset:16384
  buffer_store_dwordx4 v[228:231], v225, s[24:27], s35 offen sc1
  v_mfma_f32_16x16x32_bf16 v[52:55], a[152:155], v[168:171], v[52:55]
  v_exp_f32 v21, v21
  v_mfma_f32_16x16x32_bf16 v[52:55], a[156:159], v[172:175], v[52:55]
  ds_read_b64_tr_b16 a[170:171], v217 offset:20480
  v_cvt_pk_bf16_f32 v18, v20, v21
  v_mfma_f32_16x16x32_bf16 v[60:63], a[156:159], v[188:191], v[204:207]
  v_exp_f32 v22, v22
  v_mfma_f32_16x16x32_bf16 v[60:63], a[152:155], v[184:187], v[60:63]
  ds_read_b64_tr_b16 a[172:173], v217 offset:24576
  buffer_load_dwordx4 a[212:215], v242, s[24:27], s4 offen offset:0 sc1
  v_mfma_f32_16x16x32_bf16 v[60:63], a[148:151], v[180:183], v[60:63]
  v_exp_f32 v23, v23
  v_mfma_f32_16x16x32_bf16 v[60:63], a[144:147], v[176:179], v[60:63]
  ds_read_b64_tr_b16 a[174:175], v217 offset:28672
  v_cvt_pk_bf16_f32 v19, v22, v23
  v_mfma_f32_16x16x32_bf16 a[192:195], a[208:211], v[64:67], a[192:195]
  v_exp_f32 v28, v28
  v_mfma_f32_16x16x32_bf16 a[192:195], a[208:211], v[96:99], a[192:195]
  ds_read_b64_tr_b16 a[176:177], v218 offset:16384
  v_add_u32 v245, 1, v245
  v_mfma_f32_16x16x32_bf16 a[196:199], a[208:211], v[72:75], a[196:199]
  v_exp_f32 v29, v29
  v_mfma_f32_16x16x32_bf16 a[196:199], a[208:211], v[104:107], a[196:199]
  ds_read_b64_tr_b16 a[178:179], v218 offset:20480
  v_cvt_pk_bf16_f32 v26, v28, v29
  v_mfma_f32_16x16x32_bf16 a[200:203], a[208:211], v[80:83], a[200:203]
  s_waitcnt vmcnt(14)
  v_exp_f32 v30, v30
  v_mfma_f32_16x16x32_bf16 a[200:203], a[208:211], v[112:115], a[200:203]
  ds_read_b64_tr_b16 a[180:181], v218 offset:24576
  ds_write_b32 v246, v245
  v_mfma_f32_16x16x32_bf16 a[204:207], a[208:211], v[88:91], a[204:207]
  s_waitcnt lgkmcnt(8)
  v_exp_f32 v31, v31
  v_mfma_f32_16x16x32_bf16 a[204:207], a[208:211], v[120:123], a[204:207]
  ds_read_b64_tr_b16 a[182:183], v218 offset:28672
  v_cvt_pk_bf16_f32 v27, v30, v31
  v_mfma_f32_16x16x32_bf16 a[0:3], a[160:163], v[64:67], a[0:3]
  v_exp_f32 v32, v32
  v_mfma_f32_16x16x32_bf16 a[0:3], a[164:167], v[96:99], a[0:3]
  ds_read_b64_tr_b16 a[184:185], v219 offset:16384
  buffer_load_dwordx4 a[216:219], v242, s[24:27], s4 offen offset:1024 sc1
  v_mfma_f32_16x16x32_bf16 a[4:7], a[164:167], v[104:107], a[4:7]
  v_exp_f32 v33, v33
  v_mfma_f32_16x16x32_bf16 a[4:7], a[160:163], v[72:75], a[4:7]
  ds_read_b64_tr_b16 a[186:187], v219 offset:20480
  v_cvt_pk_bf16_f32 v32, v32, v33
  v_mfma_f32_16x16x32_bf16 a[8:11], a[160:163], v[80:83], a[8:11]
  v_exp_f32 v34, v34
  v_mfma_f32_16x16x32_bf16 a[8:11], a[164:167], v[112:115], a[8:11]
  ds_read_b64_tr_b16 a[188:189], v219 offset:24576
  buffer_load_dwordx4 a[220:223], v242, s[24:27], s4 offen offset:2048 sc1
  v_mfma_f32_16x16x32_bf16 a[12:15], a[164:167], v[120:123], a[12:15]
  s_waitcnt lgkmcnt(8)
  v_exp_f32 v35, v35
  v_mfma_f32_16x16x32_bf16 a[12:15], a[160:163], v[88:91], a[12:15]
  ds_read_b64_tr_b16 a[190:191], v219 offset:28672
  v_cvt_pk_bf16_f32 v33, v34, v35
  v_mfma_f32_16x16x32_bf16 a[16:19], a[168:171], v[64:67], a[16:19]
  v_exp_f32 v40, v40
  v_mfma_f32_16x16x32_bf16 a[16:19], a[172:175], v[96:99], a[16:19]
  ds_read_b64_tr_b16 a[160:161], v220 offset:16384
  buffer_load_dwordx4 a[224:227], v242, s[24:27], s4 offen offset:3072 sc1
  v_mfma_f32_16x16x32_bf16 a[20:23], a[172:175], v[104:107], a[20:23]
  v_exp_f32 v41, v41
  v_mfma_f32_16x16x32_bf16 a[20:23], a[168:171], v[72:75], a[20:23]
  ds_read_b64_tr_b16 a[162:163], v220 offset:20480
  v_cvt_pk_bf16_f32 v40, v40, v41
  v_mfma_f32_16x16x32_bf16 a[24:27], a[168:171], v[80:83], a[24:27]
  v_exp_f32 v42, v42
  v_mfma_f32_16x16x32_bf16 a[24:27], a[172:175], v[112:115], a[24:27]
  ds_read_b64_tr_b16 a[164:165], v220 offset:24576
  v_mfma_f32_16x16x32_bf16 a[28:31], a[172:175], v[120:123], a[28:31]
  s_waitcnt lgkmcnt(7)
  v_exp_f32 v43, v43
  v_mfma_f32_16x16x32_bf16 a[28:31], a[168:171], v[88:91], a[28:31]
  ds_read_b64_tr_b16 a[166:167], v220 offset:28672
  v_cvt_pk_bf16_f32 v41, v42, v43
  v_mfma_f32_16x16x32_bf16 a[32:35], a[176:179], v[64:67], a[32:35]
  v_exp_f32 v48, v48
  v_mfma_f32_16x16x32_bf16 a[32:35], a[180:183], v[96:99], a[32:35]
  ds_read_b64_tr_b16 a[168:169], v221 offset:16384
  buffer_load_dwordx4 a[228:231], v252, s[24:27], s4 offen offset:0 sc1
  v_mfma_f32_16x16x32_bf16 a[36:39], a[180:183], v[104:107], a[36:39]
  v_exp_f32 v49, v49
  v_mfma_f32_16x16x32_bf16 a[36:39], a[176:179], v[72:75], a[36:39]
  ds_read_b64_tr_b16 a[170:171], v221 offset:20480
  v_cvt_pk_bf16_f32 v48, v48, v49
  v_mfma_f32_16x16x32_bf16 a[40:43], a[176:179], v[80:83], a[40:43]
  v_exp_f32 v50, v50
  v_mfma_f32_16x16x32_bf16 a[40:43], a[180:183], v[112:115], a[40:43]
  ds_read_b64_tr_b16 a[172:173], v221 offset:24576
  v_mfma_f32_16x16x32_bf16 a[44:47], a[180:183], v[120:123], a[44:47]
  s_waitcnt lgkmcnt(7)
  v_exp_f32 v51, v51
  v_mfma_f32_16x16x32_bf16 a[44:47], a[176:179], v[88:91], a[44:47]
  ds_read_b64_tr_b16 a[174:175], v221 offset:28672
  v_cvt_pk_bf16_f32 v49, v50, v51
  v_mfma_f32_16x16x32_bf16 a[48:51], a[184:187], v[64:67], a[48:51]
  v_exp_f32 v56, v56
  v_mfma_f32_16x16x32_bf16 a[48:51], a[188:191], v[96:99], a[48:51]
  ds_read_b64_tr_b16 a[176:177], v222 offset:16384
  buffer_load_dwordx4 a[232:235], v252, s[24:27], s4 offen offset:1024 sc1
  v_mfma_f32_16x16x32_bf16 a[52:55], a[188:191], v[104:107], a[52:55]
  v_exp_f32 v57, v57
  v_mfma_f32_16x16x32_bf16 a[52:55], a[184:187], v[72:75], a[52:55]
  ds_read_b64_tr_b16 a[178:179], v222 offset:20480
  v_cvt_pk_bf16_f32 v56, v56, v57
  v_mfma_f32_16x16x32_bf16 a[56:59], a[184:187], v[80:83], a[56:59]
  v_exp_f32 v58, v58
  v_mfma_f32_16x16x32_bf16 a[56:59], a[188:191], v[112:115], a[56:59]
  ds_read_b64_tr_b16 a[180:181], v222 offset:24576
  v_mfma_f32_16x16x32_bf16 a[60:63], a[188:191], v[120:123], a[60:63]
  s_waitcnt lgkmcnt(7)
  v_exp_f32 v59, v59
  v_mfma_f32_16x16x32_bf16 a[60:63], a[184:187], v[88:91], a[60:63]
  ds_read_b64_tr_b16 a[182:183], v222 offset:28672
  v_cvt_pk_bf16_f32 v57, v58, v59
  v_mfma_f32_16x16x32_bf16 a[64:67], a[160:163], v[64:67], a[64:67]
  v_exp_f32 v36, v36
  v_mfma_f32_16x16x32_bf16 a[64:67], a[164:167], v[96:99], a[64:67]
  ds_read_b64_tr_b16 a[184:185], v223 offset:16384
  ds_read_b32 v248, v247
  v_mfma_f32_16x16x32_bf16 a[68:71], a[164:167], v[104:107], a[68:71]
  v_exp_f32 v37, v37
  v_mfma_f32_16x16x32_bf16 a[68:71], a[160:163], v[72:75], a[68:71]
  ds_read_b64_tr_b16 a[186:187], v223 offset:20480
  v_cvt_pk_bf16_f32 v34, v36, v37
  v_mfma_f32_16x16x32_bf16 a[72:75], a[160:163], v[80:83], a[72:75]
  v_exp_f32 v38, v38
  v_mfma_f32_16x16x32_bf16 a[72:75], a[164:167], v[112:115], a[72:75]
  ds_read_b64_tr_b16 a[188:189], v223 offset:24576
  v_mfma_f32_16x16x32_bf16 a[76:79], a[164:167], v[120:123], a[76:79]
  s_waitcnt lgkmcnt(8)
  v_exp_f32 v39, v39
  v_mfma_f32_16x16x32_bf16 a[76:79], a[160:163], v[88:91], a[76:79]
  ds_read_b64_tr_b16 a[190:191], v223 offset:28672
  v_cvt_pk_bf16_f32 v35, v38, v39
  v_mfma_f32_16x16x32_bf16 a[80:83], a[168:171], v[64:67], a[80:83]
  s_waitcnt lgkmcnt(3)
  v_exp_f32 v44, v44
  v_mfma_f32_16x16x32_bf16 a[80:83], a[172:175], v[96:99], a[80:83]
  v_cmp_lt_u32 vcc, v248, v245
  v_mfma_f32_16x16x32_bf16 a[84:87], a[172:175], v[104:107], a[84:87]
  s_cbranch_vccnz attn_wait29
attn_on29:
  v_exp_f32 v45, v45
  v_mfma_f32_16x16x32_bf16 a[84:87], a[168:171], v[72:75], a[84:87]
  ds_read_b128 a[128:131], v212 offset:49152
  v_cvt_pk_bf16_f32 v42, v44, v45
  v_mfma_f32_16x16x32_bf16 a[88:91], a[168:171], v[80:83], a[88:91]
  v_exp_f32 v46, v46
  v_mfma_f32_16x16x32_bf16 a[88:91], a[172:175], v[112:115], a[88:91]
  ds_read_b128 a[132:135], v213 offset:49152
  v_mfma_f32_16x16x32_bf16 a[92:95], a[172:175], v[120:123], a[92:95]
  v_exp_f32 v47, v47
  v_mfma_f32_16x16x32_bf16 a[92:95], a[168:171], v[88:91], a[92:95]
  ds_read_b128 a[136:139], v214 offset:49152
  v_cvt_pk_bf16_f32 v43, v46, v47
  v_mfma_f32_16x16x32_bf16 a[96:99], a[176:179], v[64:67], a[96:99]
  v_exp_f32 v52, v52
  v_mfma_f32_16x16x32_bf16 a[96:99], a[180:183], v[96:99], a[96:99]
  ds_read_b128 a[140:143], v215 offset:49152
  v_mfma_f32_16x16x32_bf16 a[100:103], a[180:183], v[104:107], a[100:103]
  v_exp_f32 v53, v53
  v_mfma_f32_16x16x32_bf16 a[100:103], a[176:179], v[72:75], a[100:103]
  v_cvt_pk_bf16_f32 v50, v52, v53
  v_mfma_f32_16x16x32_bf16 a[104:107], a[176:179], v[80:83], a[104:107]
  v_exp_f32 v54, v54
  v_mfma_f32_16x16x32_bf16 a[104:107], a[180:183], v[112:115], a[104:107]
  v_mfma_f32_16x16x32_bf16 a[108:111], a[180:183], v[120:123], a[108:111]
  s_waitcnt lgkmcnt(4)
  v_exp_f32 v55, v55
  v_mfma_f32_16x16x32_bf16 a[108:111], a[176:179], v[88:91], a[108:111]
  v_cvt_pk_bf16_f32 v51, v54, v55
  v_mfma_f32_16x16x32_bf16 a[112:115], a[184:187], v[64:67], a[112:115]
  v_exp_f32 v60, v60
  v_mfma_f32_16x16x32_bf16 a[112:115], a[188:191], v[96:99], a[112:115]
  v_mfma_f32_16x16x32_bf16 a[116:119], a[188:191], v[104:107], a[116:119]
  v_exp_f32 v61, v61
  v_mfma_f32_16x16x32_bf16 a[116:119], a[184:187], v[72:75], a[116:119]
  v_cvt_pk_bf16_f32 v58, v60, v61
  v_mfma_f32_16x16x32_bf16 a[120:123], a[184:187], v[80:83], a[120:123]
  v_exp_f32 v62, v62
  v_mfma_f32_16x16x32_bf16 a[120:123], a[188:191], v[112:115], a[120:123]
  v_mfma_f32_16x16x32_bf16 a[124:127], a[188:191], v[120:123], a[124:127]
  s_waitcnt lgkmcnt(0)
  v_exp_f32 v63, v63
  v_mfma_f32_16x16x32_bf16 a[124:127], a[184:187], v[88:91], a[124:127]
  v_cvt_pk_bf16_f32 v59, v62, v63
  v_mfma_f32_16x16x32_bf16 v[64:67], a[128:131], v[128:131], v[192:195]
  s_add_u32 m0, s28, 65536
  v_mfma_f32_16x16x32_bf16 v[64:67], a[132:135], v[132:135], v[64:67]
  ds_read_b128 a[144:147], v212 offset:53248
  v_mfma_f32_16x16x32_bf16 v[64:67], a[136:139], v[136:139], v[64:67]
  buffer_load_dwordx4 v253, s[24:27], s9 offen offset:0 sc1 lds
  v_mfma_f32_16x16x32_bf16 v[64:67], a[140:143], v[140:143], v[64:67]
  ds_read_b128 a[148:151], v213 offset:53248
  v_mfma_f32_16x16x32_bf16 v[72:75], a[140:143], v[156:159], v[196:199]
  v_mfma_f32_16x16x32_bf16 v[72:75], a[136:139], v[152:155], v[72:75]
  ds_read_b128 a[152:155], v214 offset:53248
  v_mfma_f32_16x16x32_bf16 v[72:75], a[132:135], v[148:151], v[72:75]
  buffer_load_dwordx4 v253, s[24:27], s9 offen offset:1024 sc1 lds
  v_mfma_f32_16x16x32_bf16 v[72:75], a[128:131], v[144:147], v[72:75]
  ds_read_b128 a[156:159], v215 offset:53248
  v_mfma_f32_16x16x32_bf16 v[80:83], a[128:131], v[160:163], v[200:203]
  v_exp_f32 v64, v64
  v_mfma_f32_16x16x32_bf16 v[80:83], a[132:135], v[164:167], v[80:83]
  v_mfma_f32_16x16x32_bf16 v[80:83], a[136:139], v[168:171], v[80:83]
  v_exp_f32 v65, v65
  v_mfma_f32_16x16x32_bf16 v[80:83], a[140:143], v[172:175], v[80:83]
  v_cvt_pk_bf16_f32 v64, v64, v65
  v_mfma_f32_16x16x32_bf16 v[88:91], a[140:143], v[188:191], v[204:207]
  v_exp_f32 v66, v66
  v_mfma_f32_16x16x32_bf16 v[88:91], a[136:139], v[184:187], v[88:91]
  buffer_load_dwordx4 v253, s[24:27], s9 offen offset:2048 sc1 lds
  v_mfma_f32_16x16x32_bf16 v[88:91], a[132:135], v[180:183], v[88:91]
  s_waitcnt lgkmcnt(0)
  v_exp_f32 v67, v67
  v_mfma_f32_16x16x32_bf16 v[88:91], a[128:131], v[176:179], v[88:91]
  v_cvt_pk_bf16_f32 v65, v66, v67
  v_mfma_f32_16x16x32_bf16 v[68:71], a[144:147], v[128:131], v[192:195]
  v_exp_f32 v72, v72
  v_mfma_f32_16x16x32_bf16 v[68:71], a[148:151], v[132:135], v[68:71]
  ds_read_b128 a[128:131], v212 offset:57344
  v_mfma_f32_16x16x32_bf16 v[68:71], a[152:155], v[136:139], v[68:71]
  v_exp_f32 v73, v73
  v_mfma_f32_16x16x32_bf16 v[68:71], a[156:159], v[140:143], v[68:71]
  ds_read_b128 a[132:135], v213 offset:57344
  v_cvt_pk_bf16_f32 v72, v72, v73
  v_mfma_f32_16x16x32_bf16 v[76:79], a[156:159], v[156:159], v[196:199]
  v_exp_f32 v74, v74
  v_mfma_f32_16x16x32_bf16 v[76:79], a[152:155], v[152:155], v[76:79]
  ds_read_b128 a[136:139], v214 offset:57344
  v_mfma_f32_16x16x32_bf16 v[76:79], a[148:151], v[148:151], v[76:79]
  v_exp_f32 v75, v75
  v_mfma_f32_16x16x32_bf16 v[76:79], a[144:147], v[144:147], v[76:79]
  ds_read_b128 a[140:143], v215 offset:57344
  v_cvt_pk_bf16_f32 v73, v74, v75
  v_mfma_f32_16x16x32_bf16 v[84:87], a[144:147], v[160:163], v[200:203]
  v_exp_f32 v80, v80
  v_mfma_f32_16x16x32_bf16 v[84:87], a[148:151], v[164:167], v[84:87]
  buffer_load_dwordx4 v253, s[24:27], s9 offen offset:3072 sc1 lds
  v_mfma_f32_16x16x32_bf16 v[84:87], a[152:155], v[168:171], v[84:87]
  s_add_u32 s29, s29, 16384
  v_exp_f32 v81, v81
  v_mfma_f32_16x16x32_bf16 v[84:87], a[156:159], v[172:175], v[84:87]
  v_cvt_pk_bf16_f32 v80, v80, v81
  v_mfma_f32_16x16x32_bf16 v[92:95], a[156:159], v[188:191], v[204:207]
  s_add_u32 m0, s28, 32768
  v_exp_f32 v82, v82
  v_mfma_f32_16x16x32_bf16 v[92:95], a[152:155], v[184:187], v[92:95]
  buffer_load_dwordx4 v252, s[24:27], s9 offen offset:0 sc1 lds
  v_mfma_f32_16x16x32_bf16 v[92:95], a[148:151], v[180:183], v[92:95]
  s_waitcnt lgkmcnt(0)
  v_exp_f32 v83, v83
  v_mfma_f32_16x16x32_bf16 v[92:95], a[144:147], v[176:179], v[92:95]
  v_cvt_pk_bf16_f32 v81, v82, v83
  v_mfma_f32_16x16x32_bf16 v[96:99], a[128:131], v[128:131], v[192:195]
  v_exp_f32 v88, v88
  v_mfma_f32_16x16x32_bf16 v[96:99], a[132:135], v[132:135], v[96:99]
  ds_read_b128 a[144:147], v212 offset:61440
  v_mfma_f32_16x16x32_bf16 v[96:99], a[136:139], v[136:139], v[96:99]
  v_exp_f32 v89, v89
  v_mfma_f32_16x16x32_bf16 v[96:99], a[140:143], v[140:143], v[96:99]
  ds_read_b128 a[148:151], v213 offset:61440
  v_cvt_pk_bf16_f32 v88, v88, v89
  v_mfma_f32_16x16x32_bf16 v[104:107], a[140:143], v[156:159], v[196:199]
  v_exp_f32 v90, v90
  v_mfma_f32_16x16x32_bf16 v[104:107], a[136:139], v[152:155], v[104:107]
  ds_read_b128 a[152:155], v214 offset:61440
  v_mfma_f32_16x16x32_bf16 v[104:107], a[132:135], v[148:151], v[104:107]
  v_exp_f32 v91, v91
  v_mfma_f32_16x16x32_bf16 v[104:107], a[128:131], v[144:147], v[104:107]
  ds_read_b128 a[156:159], v215 offset:61440
  v_cvt_pk_bf16_f32 v89, v90, v91
  v_mfma_f32_16x16x32_bf16 v[112:115], a[128:131], v[160:163], v[200:203]
  v_exp_f32 v68, v68
  v_mfma_f32_16x16x32_bf16 v[112:115], a[132:135], v[164:167], v[112:115]
  buffer_load_dwordx4 v252, s[24:27], s9 offen offset:1024 sc1 lds
  v_mfma_f32_16x16x32_bf16 v[112:115], a[136:139], v[168:171], v[112:115]
  v_exp_f32 v69, v69
  v_mfma_f32_16x16x32_bf16 v[112:115], a[140:143], v[172:175], v[112:115]
  v_cvt_pk_bf16_f32 v66, v68, v69
  v_mfma_f32_16x16x32_bf16 v[120:123], a[140:143], v[188:191], v[204:207]
  v_exp_f32 v70, v70
  v_mfma_f32_16x16x32_bf16 v[120:123], a[136:139], v[184:187], v[120:123]
  buffer_load_dwordx4 v252, s[24:27], s9 offen offset:2048 sc1 lds
  v_mfma_f32_16x16x32_bf16 v[120:123], a[132:135], v[180:183], v[120:123]
  s_waitcnt lgkmcnt(0)
  v_exp_f32 v71, v71
  v_mfma_f32_16x16x32_bf16 v[120:123], a[128:131], v[176:179], v[120:123]
  v_cvt_pk_bf16_f32 v67, v70, v71
  v_mfma_f32_16x16x32_bf16 v[100:103], a[144:147], v[128:131], v[192:195]
  v_exp_f32 v76, v76
  v_mfma_f32_16x16x32_bf16 v[100:103], a[148:151], v[132:135], v[100:103]
  ds_read_b64_tr_b16 a[160:161], v216 offset:32768
  v_mfma_f32_16x16x32_bf16 v[100:103], a[152:155], v[136:139], v[100:103]
  v_exp_f32 v77, v77
  v_mfma_f32_16x16x32_bf16 v[100:103], a[156:159], v[140:143], v[100:103]
  ds_read_b64_tr_b16 a[162:163], v216 offset:36864
  v_cvt_pk_bf16_f32 v74, v76, v77
  v_mfma_f32_16x16x32_bf16 v[108:111], a[156:159], v[156:159], v[196:199]
  v_exp_f32 v78, v78
  v_mfma_f32_16x16x32_bf16 v[108:111], a[152:155], v[152:155], v[108:111]
  ds_read_b64_tr_b16 a[164:165], v216 offset:40960
  buffer_load_dwordx4 v252, s[24:27], s9 offen offset:3072 sc1 lds
  v_mfma_f32_16x16x32_bf16 v[108:111], a[148:151], v[148:151], v[108:111]
  v_exp_f32 v79, v79
  v_mfma_f32_16x16x32_bf16 v[108:111], a[144:147], v[144:147], v[108:111]
  ds_read_b64_tr_b16 a[166:167], v216 offset:45056
  v_cvt_pk_bf16_f32 v75, v78, v79
  v_mfma_f32_16x16x32_bf16 v[116:119], a[144:147], v[160:163], v[200:203]
  v_exp_f32 v84, v84
  v_mfma_f32_16x16x32_bf16 v[116:119], a[148:151], v[164:167], v[116:119]
  ds_read_b64_tr_b16 a[168:169], v217 offset:32768
  buffer_load_dwordx4 a[236:239], v252, s[24:27], s4 offen offset:2048 sc1
  v_mfma_f32_16x16x32_bf16 v[116:119], a[152:155], v[168:171], v[116:119]
  v_exp_f32 v85, v85
  v_mfma_f32_16x16x32_bf16 v[116:119], a[156:159], v[172:175], v[116:119]
  ds_read_b64_tr_b16 a[170:171], v217 offset:36864
  v_cvt_pk_bf16_f32 v82, v84, v85
  v_mfma_f32_16x16x32_bf16 v[124:127], a[156:159], v[188:191], v[204:207]
  v_exp_f32 v86, v86
  v_mfma_f32_16x16x32_bf16 v[124:127], a[152:155], v[184:187], v[124:127]
  ds_read_b64_tr_b16 a[172:173], v217 offset:40960
  buffer_load_dwordx4 a[240:243], v252, s[24:27], s4 offen offset:3072 sc1
  v_mfma_f32_16x16x32_bf16 v[124:127], a[148:151], v[180:183], v[124:127]
  v_exp_f32 v87, v87
  v_mfma_f32_16x16x32_bf16 v[124:127], a[144:147], v[176:179], v[124:127]
  ds_read_b64_tr_b16 a[174:175], v217 offset:45056
  v_cvt_pk_bf16_f32 v83, v86, v87
  v_mfma_f32_16x16x32_bf16 a[192:195], a[208:211], v[0:3], a[192:195]
  v_exp_f32 v92, v92
  v_mfma_f32_16x16x32_bf16 a[192:195], a[208:211], v[32:35], a[192:195]
  ds_read_b64_tr_b16 a[176:177], v218 offset:32768
  v_add_u32 v245, 1, v245
  v_mfma_f32_16x16x32_bf16 a[196:199], a[208:211], v[8:11], a[196:199]
  v_exp_f32 v93, v93
  v_mfma_f32_16x16x32_bf16 a[196:199], a[208:211], v[40:43], a[196:199]
  ds_read_b64_tr_b16 a[178:179], v218 offset:36864
  v_cvt_pk_bf16_f32 v90, v92, v93
  v_mfma_f32_16x16x32_bf16 a[200:203], a[208:211], v[16:19], a[200:203]
  s_waitcnt vmcnt(16)
  v_exp_f32 v94, v94
  v_mfma_f32_16x16x32_bf16 a[200:203], a[208:211], v[48:51], a[200:203]
  ds_read_b64_tr_b16 a[180:181], v218 offset:40960
  ds_write_b32 v246, v245
  v_mfma_f32_16x16x32_bf16 a[204:207], a[208:211], v[24:27], a[204:207]
  s_waitcnt lgkmcnt(8)
  v_exp_f32 v95, v95
  v_mfma_f32_16x16x32_bf16 a[204:207], a[208:211], v[56:59], a[204:207]
  ds_read_b64_tr_b16 a[182:183], v218 offset:45056
  v_cvt_pk_bf16_f32 v91, v94, v95
  v_mfma_f32_16x16x32_bf16 a[0:3], a[160:163], v[0:3], a[0:3]
  v_exp_f32 v96, v96
  v_mfma_f32_16x16x32_bf16 a[0:3], a[164:167], v[32:35], a[0:3]
  ds_read_b64_tr_b16 a[184:185], v219 offset:32768
  buffer_load_dwordx4 a[244:247], v253, s[24:27], s4 offen offset:0 sc1
  v_mfma_f32_16x16x32_bf16 a[4:7], a[164:167], v[40:43], a[4:7]
  v_exp_f32 v97, v97
  v_mfma_f32_16x16x32_bf16 a[4:7], a[160:163], v[8:11], a[4:7]
  ds_read_b64_tr_b16 a[186:187], v219 offset:36864
  v_cvt_pk_bf16_f32 v96, v96, v97
  v_mfma_f32_16x16x32_bf16 a[8:11], a[160:163], v[16:19], a[8:11]
  v_exp_f32 v98, v98
  v_mfma_f32_16x16x32_bf16 a[8:11], a[164:167], v[48:51], a[8:11]
  ds_read_b64_tr_b16 a[188:189], v219 offset:40960
  buffer_load_dwordx4 a[248:251], v253, s[24:27], s4 offen offset:1024 sc1
  v_mfma_f32_16x16x32_bf16 a[12:15], a[164:167], v[56:59], a[12:15]
  s_waitcnt lgkmcnt(8)
  v_exp_f32 v99, v99
  v_mfma_f32_16x16x32_bf16 a[12:15], a[160:163], v[24:27], a[12:15]
  ds_read_b64_tr_b16 a[190:191], v219 offset:45056
  v_cvt_pk_bf16_f32 v97, v98, v99
  v_mfma_f32_16x16x32_bf16 a[16:19], a[168:171], v[0:3], a[16:19]
  v_exp_f32 v104, v104
  v_mfma_f32_16x16x32_bf16 a[16:19], a[172:175], v[32:35], a[16:19]
  ds_read_b64_tr_b16 a[160:161], v220 offset:32768
  buffer_load_dwordx4 a[252:255], v253, s[24:27], s4 offen offset:2048 sc1
  v_mfma_f32_16x16x32_bf16 a[20:23], a[172:175], v[40:43], a[20:23]
  v_exp_f32 v105, v105
  v_mfma_f32_16x16x32_bf16 a[20:23], a[168:171], v[8:11], a[20:23]
  ds_read_b64_tr_b16 a[162:163], v220 offset:36864
  v_cvt_pk_bf16_f32 v104, v104, v105
  v_mfma_f32_16x16x32_bf16 a[24:27], a[168:171], v[16:19], a[24:27]
  v_exp_f32 v106, v106
  v_mfma_f32_16x16x32_bf16 a[24:27], a[172:175], v[48:51], a[24:27]
  ds_read_b64_tr_b16 a[164:165], v220 offset:40960
  buffer_load_dwordx4 a[128:131], v253, s[24:27], s4 offen offset:3072 sc1
  v_mfma_f32_16x16x32_bf16 a[28:31], a[172:175], v[56:59], a[28:31]
  s_waitcnt lgkmcnt(7)
  v_exp_f32 v107, v107
  v_mfma_f32_16x16x32_bf16 a[28:31], a[168:171], v[24:27], a[28:31]
  ds_read_b64_tr_b16 a[166:167], v220 offset:45056
  v_cvt_pk_bf16_f32 v105, v106, v107
  v_mfma_f32_16x16x32_bf16 a[32:35], a[176:179], v[0:3], a[32:35]
  v_exp_f32 v112, v112
  v_mfma_f32_16x16x32_bf16 a[32:35], a[180:183], v[32:35], a[32:35]
  ds_read_b64_tr_b16 a[168:169], v221 offset:32768
  buffer_load_dwordx4 a[132:135], v242, s[24:27], s5 offen offset:0 sc1
  v_mfma_f32_16x16x32_bf16 a[36:39], a[180:183], v[40:43], a[36:39]
  v_exp_f32 v113, v113
  v_mfma_f32_16x16x32_bf16 a[36:39], a[176:179], v[8:11], a[36:39]
  ds_read_b64_tr_b16 a[170:171], v221 offset:36864
  v_cvt_pk_bf16_f32 v112, v112, v113
  v_mfma_f32_16x16x32_bf16 a[40:43], a[176:179], v[16:19], a[40:43]
  v_exp_f32 v114, v114
  v_mfma_f32_16x16x32_bf16 a[40:43], a[180:183], v[48:51], a[40:43]
  ds_read_b64_tr_b16 a[172:173], v221 offset:40960
  buffer_load_dwordx4 a[136:139], v242, s[24:27], s5 offen offset:1024 sc1
  v_mfma_f32_16x16x32_bf16 a[44:47], a[180:183], v[56:59], a[44:47]
  s_waitcnt lgkmcnt(7)
  v_exp_f32 v115, v115
  v_mfma_f32_16x16x32_bf16 a[44:47], a[176:179], v[24:27], a[44:47]
  ds_read_b64_tr_b16 a[174:175], v221 offset:45056
  v_cvt_pk_bf16_f32 v113, v114, v115
  v_mfma_f32_16x16x32_bf16 a[48:51], a[184:187], v[0:3], a[48:51]
  v_exp_f32 v120, v120
  v_mfma_f32_16x16x32_bf16 a[48:51], a[188:191], v[32:35], a[48:51]
  ds_read_b64_tr_b16 a[176:177], v222 offset:32768
  buffer_load_dwordx4 a[140:143], v242, s[24:27], s5 offen offset:2048 sc1
  v_mfma_f32_16x16x32_bf16 a[52:55], a[188:191], v[40:43], a[52:55]
  v_exp_f32 v121, v121
  v_mfma_f32_16x16x32_bf16 a[52:55], a[184:187], v[8:11], a[52:55]
  ds_read_b64_tr_b16 a[178:179], v222 offset:36864
  v_cvt_pk_bf16_f32 v120, v120, v121
  v_mfma_f32_16x16x32_bf16 a[56:59], a[184:187], v[16:19], a[56:59]
  v_exp_f32 v122, v122
  v_mfma_f32_16x16x32_bf16 a[56:59], a[188:191], v[48:51], a[56:59]
  ds_read_b64_tr_b16 a[180:181], v222 offset:40960
  buffer_load_dwordx4 a[144:147], v242, s[24:27], s5 offen offset:3072 sc1
  v_mfma_f32_16x16x32_bf16 a[60:63], a[188:191], v[56:59], a[60:63]
  s_waitcnt lgkmcnt(7)
  v_exp_f32 v123, v123
  v_mfma_f32_16x16x32_bf16 a[60:63], a[184:187], v[24:27], a[60:63]
  ds_read_b64_tr_b16 a[182:183], v222 offset:45056
  v_cvt_pk_bf16_f32 v121, v122, v123
  v_mfma_f32_16x16x32_bf16 a[64:67], a[160:163], v[0:3], a[64:67]
  v_exp_f32 v100, v100
  v_mfma_f32_16x16x32_bf16 a[64:67], a[164:167], v[32:35], a[64:67]
  ds_read_b64_tr_b16 a[184:185], v223 offset:32768
  ds_read_b32 v248, v247
  v_mfma_f32_16x16x32_bf16 a[68:71], a[164:167], v[40:43], a[68:71]
  v_exp_f32 v101, v101
  v_mfma_f32_16x16x32_bf16 a[68:71], a[160:163], v[8:11], a[68:71]
  ds_read_b64_tr_b16 a[186:187], v223 offset:36864
  v_cvt_pk_bf16_f32 v98, v100, v101
  v_mfma_f32_16x16x32_bf16 a[72:75], a[160:163], v[16:19], a[72:75]
  v_exp_f32 v102, v102
  v_mfma_f32_16x16x32_bf16 a[72:75], a[164:167], v[48:51], a[72:75]
  ds_read_b64_tr_b16 a[188:189], v223 offset:40960
  buffer_load_dwordx4 a[148:151], v252, s[24:27], s5 offen offset:0 sc1
  v_mfma_f32_16x16x32_bf16 a[76:79], a[164:167], v[56:59], a[76:79]
  s_waitcnt lgkmcnt(8)
  v_exp_f32 v103, v103
  v_mfma_f32_16x16x32_bf16 a[76:79], a[160:163], v[24:27], a[76:79]
  ds_read_b64_tr_b16 a[190:191], v223 offset:45056
  v_cvt_pk_bf16_f32 v99, v102, v103
  v_mfma_f32_16x16x32_bf16 a[80:83], a[168:171], v[0:3], a[80:83]
  s_waitcnt lgkmcnt(3)
  v_exp_f32 v108, v108
  v_mfma_f32_16x16x32_bf16 a[80:83], a[172:175], v[32:35], a[80:83]
  buffer_load_dwordx4 a[152:155], v252, s[24:27], s5 offen offset:1024 sc1
  v_cmp_lt_u32 vcc, v248, v245
  v_mfma_f32_16x16x32_bf16 a[84:87], a[172:175], v[40:43], a[84:87]
  s_cbranch_vccnz attn_wait30
attn_on30:
  v_exp_f32 v109, v109
  v_mfma_f32_16x16x32_bf16 a[84:87], a[168:171], v[8:11], a[84:87]
  s_mul_i32 s39, s99, 13108
  s_lshr_b32 s39, s39, 16
  s_lshl_b32 s39, s39, 8
  buffer_load_dwordx4 a[156:159], v252, s[24:27], s5 offen offset:2048 sc1
  v_cvt_pk_bf16_f32 v106, v108, v109
  v_mfma_f32_16x16x32_bf16 a[88:91], a[168:171], v[16:19], a[88:91]
  s_add_u32 s39, s39, 2818304
  s_cmp_lt_u32 s2, 240
  s_cselect_b32 s48, 0, 1073741824
  v_exp_f32 v110, v110
  v_mfma_f32_16x16x32_bf16 a[88:91], a[172:175], v[48:51], a[88:91]
  buffer_load_dwordx4 v[128:131], v252, s[24:27], s5 offen offset:3072 sc1
  v_mfma_f32_16x16x32_bf16 a[92:95], a[172:175], v[56:59], a[92:95]
  v_exp_f32 v111, v111
  v_mfma_f32_16x16x32_bf16 a[92:95], a[168:171], v[24:27], a[92:95]
  buffer_load_dwordx4 v[132:135], v253, s[24:27], s5 offen offset:0 sc1
  v_cvt_pk_bf16_f32 v107, v110, v111
  v_mfma_f32_16x16x32_bf16 a[96:99], a[176:179], v[0:3], a[96:99]
  v_exp_f32 v116, v116
  v_mfma_f32_16x16x32_bf16 a[96:99], a[180:183], v[32:35], a[96:99]
  v_or_b32 v249, s48, v251
  v_mfma_f32_16x16x32_bf16 a[100:103], a[180:183], v[40:43], a[100:103]
  v_exp_f32 v117, v117
  v_mfma_f32_16x16x32_bf16 a[100:103], a[176:179], v[8:11], a[100:103]
  buffer_atomic_add v250, v249, s[24:27], s39 offen
  v_cvt_pk_bf16_f32 v114, v116, v117
  v_mfma_f32_16x16x32_bf16 a[104:107], a[176:179], v[16:19], a[104:107]
  v_exp_f32 v118, v118
  v_mfma_f32_16x16x32_bf16 a[104:107], a[180:183], v[48:51], a[104:107]
  buffer_load_dwordx4 v[136:139], v253, s[24:27], s5 offen offset:1024 sc1
  v_mfma_f32_16x16x32_bf16 a[108:111], a[180:183], v[56:59], a[108:111]
  s_waitcnt lgkmcnt(0)
  v_exp_f32 v119, v119
  v_mfma_f32_16x16x32_bf16 a[108:111], a[176:179], v[24:27], a[108:111]
  buffer_load_dwordx4 v[140:143], v253, s[24:27], s5 offen offset:2048 sc1
  v_cvt_pk_bf16_f32 v115, v118, v119
  v_mfma_f32_16x16x32_bf16 a[112:115], a[184:187], v[0:3], a[112:115]
  v_exp_f32 v124, v124
  v_mfma_f32_16x16x32_bf16 a[112:115], a[188:191], v[32:35], a[112:115]
  v_mfma_f32_16x16x32_bf16 a[116:119], a[188:191], v[40:43], a[116:119]
  v_exp_f32 v125, v125
  v_mfma_f32_16x16x32_bf16 a[116:119], a[184:187], v[8:11], a[116:119]
  v_cvt_pk_bf16_f32 v122, v124, v125
  v_mfma_f32_16x16x32_bf16 a[120:123], a[184:187], v[16:19], a[120:123]
  v_exp_f32 v126, v126
  v_mfma_f32_16x16x32_bf16 a[120:123], a[188:191], v[48:51], a[120:123]
  v_mfma_f32_16x16x32_bf16 a[124:127], a[188:191], v[56:59], a[124:127]
  s_waitcnt vmcnt(9)
  v_exp_f32 v127, v127
  v_mfma_f32_16x16x32_bf16 a[124:127], a[184:187], v[24:27], a[124:127]
  v_cvt_pk_bf16_f32 v123, v126, v127
  ds_read_b64_tr_b16 a[160:161], v216 offset:49152
  ds_read_b64_tr_b16 a[162:163], v216 offset:53248
  ds_read_b64_tr_b16 a[164:165], v216 offset:57344
  ds_read_b64_tr_b16 a[166:167], v216 offset:61440
  ds_read_b64_tr_b16 a[168:169], v217 offset:49152
  ds_read_b64_tr_b16 a[170:171], v217 offset:53248
  ds_read_b64_tr_b16 a[172:173], v217 offset:57344
  ds_read_b64_tr_b16 a[174:175], v217 offset:61440
  s_mov_b32 s48, 0x53800000
  s_lshl_b32 s39, s3, 8
  v_mfma_f32_16x16x32_bf16 a[192:195], a[208:211], v[64:67], a[192:195]
  s_add_u32 m0, s28, 81920
  v_mfma_f32_16x16x32_bf16 a[192:195], a[208:211], v[96:99], a[192:195]
  v_mfma_f32_16x16x32_bf16 a[196:199], a[208:211], v[72:75], a[196:199]
  buffer_load_dwordx4 v242, s[24:27], s10 offen offset:0 sc1 lds
  v_mfma_f32_16x16x32_bf16 a[196:199], a[208:211], v[104:107], a[196:199]
  v_mfma_f32_16x16x32_bf16 a[200:203], a[208:211], v[80:83], a[200:203]
  buffer_load_dwordx4 v242, s[24:27], s10 offen offset:1024 sc1 lds
  v_mfma_f32_16x16x32_bf16 a[200:203], a[208:211], v[112:115], a[200:203]
  v_mfma_f32_16x16x32_bf16 a[204:207], a[208:211], v[88:91], a[204:207]
  buffer_load_dwordx4 v242, s[24:27], s10 offen offset:2048 sc1 lds
  v_mfma_f32_16x16x32_bf16 a[204:207], a[208:211], v[120:123], a[204:207]
  s_waitcnt lgkmcnt(4)
  v_mfma_f32_16x16x32_bf16 a[0:3], a[160:163], v[64:67], a[0:3]
  buffer_load_dwordx4 v242, s[24:27], s10 offen offset:3072 sc1 lds
  v_mfma_f32_16x16x32_bf16 a[0:3], a[164:167], v[96:99], a[0:3]
  ds_read_b64_tr_b16 a[176:177], v218 offset:49152
  v_mfma_f32_16x16x32_bf16 a[4:7], a[164:167], v[104:107], a[4:7]
  buffer_load_dwordx4 v[144:147], v253, s[24:27], s5 offen offset:3072 sc1
  v_mfma_f32_16x16x32_bf16 a[4:7], a[160:163], v[72:75], a[4:7]
  ds_read_b64_tr_b16 a[178:179], v218 offset:53248
  v_accvgpr_read_b32 v208, a192
  v_mfma_f32_16x16x32_bf16 a[8:11], a[160:163], v[80:83], a[8:11]
  v_accvgpr_read_b32 v209, a196
  v_accvgpr_read_b32 v210, a200
  v_mfma_f32_16x16x32_bf16 a[8:11], a[164:167], v[112:115], a[8:11]
  ds_read_b64_tr_b16 a[180:181], v218 offset:57344
  v_accvgpr_read_b32 v211, a204
  v_mfma_f32_16x16x32_bf16 a[12:15], a[164:167], v[120:123], a[12:15]
  v_rcp_f32 v192, v208
  v_mfma_f32_16x16x32_bf16 a[12:15], a[160:163], v[88:91], a[12:15]
  ds_read_b64_tr_b16 a[182:183], v218 offset:61440
  s_waitcnt lgkmcnt(4)
  buffer_load_dwordx4 v[148:151], v242, s[24:27], s6 offen offset:0 sc1
  v_mfma_f32_16x16x32_bf16 a[16:19], a[168:171], v[64:67], a[16:19]
  v_rcp_f32 v196, v209
  v_mfma_f32_16x16x32_bf16 a[16:19], a[172:175], v[96:99], a[16:19]
  ds_read_b64_tr_b16 a[184:185], v219 offset:49152
  buffer_load_dwordx4 v[152:155], v242, s[24:27], s6 offen offset:1024 sc1
  v_mfma_f32_16x16x32_bf16 a[20:23], a[172:175], v[104:107], a[20:23]
  v_rcp_f32 v200, v210
  v_mfma_f32_16x16x32_bf16 a[20:23], a[168:171], v[72:75], a[20:23]
  ds_read_b64_tr_b16 a[186:187], v219 offset:53248
  buffer_load_dwordx4 v[156:159], v242, s[24:27], s6 offen offset:2048 sc1
  v_mfma_f32_16x16x32_bf16 a[24:27], a[168:171], v[80:83], a[24:27]
  v_rcp_f32 v204, v211
  v_mfma_f32_16x16x32_bf16 a[24:27], a[172:175], v[112:115], a[24:27]
  ds_read_b64_tr_b16 a[188:189], v219 offset:57344
  v_add_f32 v246, v208, v209
  v_mfma_f32_16x16x32_bf16 a[28:31], a[172:175], v[120:123], a[28:31]
  v_add_f32 v247, v210, v211
  v_add_f32 v246, v246, v247
  v_mfma_f32_16x16x32_bf16 a[28:31], a[168:171], v[88:91], a[28:31]
  ds_read_b64_tr_b16 a[190:191], v219 offset:61440
  s_waitcnt lgkmcnt(4)
  v_lshrrev_b32 v247, 2, v242
  v_mfma_f32_16x16x32_bf16 a[32:35], a[176:179], v[64:67], a[32:35]
  v_cmp_nlt_f32 vcc, v246, s48
  v_add_u32 v247, s39, v247
  v_mfma_f32_16x16x32_bf16 a[32:35], a[180:183], v[96:99], a[32:35]
  ds_read_b64_tr_b16 a[160:161], v220 offset:49152
  v_add_u32 v247, 157696, v247
  v_mfma_f32_16x16x32_bf16 a[36:39], a[180:183], v[104:107], a[36:39]
  v_cndmask_b32_e64 v245, 0, 1, vcc
  v_accvgpr_read_b32 v0, a0
  v_mfma_f32_16x16x32_bf16 a[36:39], a[176:179], v[72:75], a[36:39]
  ds_read_b64_tr_b16 a[162:163], v220 offset:53248
  v_accvgpr_read_b32 v1, a1
  v_mfma_f32_16x16x32_bf16 a[40:43], a[176:179], v[80:83], a[40:43]
  v_accvgpr_read_b32 v2, a2
  v_accvgpr_read_b32 v3, a3
  v_mfma_f32_16x16x32_bf16 a[40:43], a[180:183], v[112:115], a[40:43]
  ds_read_b64_tr_b16 a[164:165], v220 offset:57344
  v_accvgpr_read_b32 v4, a16
  buffer_load_dwordx4 v[160:163], v242, s[24:27], s6 offen offset:3072 sc1
  buffer_load_dwordx4 v[164:167], v252, s[24:27], s6 offen offset:0 sc1
  buffer_load_dwordx4 v[168:171], v252, s[24:27], s6 offen offset:1024 sc1
  buffer_load_dwordx4 v[172:175], v252, s[24:27], s6 offen offset:2048 sc1
  v_mfma_f32_16x16x32_bf16 a[44:47], a[180:183], v[120:123], a[44:47]
  v_accvgpr_read_b32 v5, a17
  v_accvgpr_read_b32 v6, a18
  v_mfma_f32_16x16x32_bf16 a[44:47], a[176:179], v[88:91], a[44:47]
  ds_read_b64_tr_b16 a[166:167], v220 offset:61440
  s_waitcnt lgkmcnt(4)
  v_accvgpr_read_b32 v7, a19
  v_mfma_f32_16x16x32_bf16 a[48:51], a[184:187], v[64:67], a[48:51]
  v_mul_f32 v0, v0, v192
  v_mul_f32 v1, v1, v192
  v_mfma_f32_16x16x32_bf16 a[48:51], a[188:191], v[96:99], a[48:51]
  ds_read_b64_tr_b16 a[168:169], v221 offset:49152
  v_mul_f32 v2, v2, v192
  v_mfma_f32_16x16x32_bf16 a[52:55], a[188:191], v[104:107], a[52:55]
  v_mul_f32 v3, v3, v192
  v_mul_f32 v4, v4, v192
  v_mfma_f32_16x16x32_bf16 a[52:55], a[184:187], v[72:75], a[52:55]
  ds_read_b64_tr_b16 a[170:171], v221 offset:53248
  v_mul_f32 v5, v5, v192
  v_mfma_f32_16x16x32_bf16 a[56:59], a[184:187], v[80:83], a[56:59]
  v_mul_f32 v6, v6, v192
  v_mul_f32 v7, v7, v192
  v_mfma_f32_16x16x32_bf16 a[56:59], a[188:191], v[112:115], a[56:59]
  ds_read_b64_tr_b16 a[172:173], v221 offset:57344
  v_cvt_pk_bf16_f32 v0, v0, v1
  v_mfma_f32_16x16x32_bf16 a[60:63], a[188:191], v[120:123], a[60:63]
  v_cvt_pk_bf16_f32 v1, v2, v3
  v_cvt_pk_bf16_f32 v2, v4, v5
  v_mfma_f32_16x16x32_bf16 a[60:63], a[184:187], v[88:91], a[60:63]
  ds_read_b64_tr_b16 a[174:175], v221 offset:61440
  s_waitcnt lgkmcnt(4)
  v_cvt_pk_bf16_f32 v3, v6, v7
  v_mfma_f32_16x16x32_bf16 a[64:67], a[160:163], v[64:67], a[64:67]
  buffer_store_dwordx4 v[0:3], v244, s[24:27], s40 offen offset:0 sc1
  v_mfma_f32_16x16x32_bf16 a[64:67], a[164:167], v[96:99], a[64:67]
  ds_read_b64_tr_b16 a[176:177], v222 offset:49152
  v_accvgpr_read_b32 v8, a4
  v_mfma_f32_16x16x32_bf16 a[68:71], a[164:167], v[104:107], a[68:71]
  v_accvgpr_read_b32 v9, a5
  v_accvgpr_read_b32 v10, a6
  v_mfma_f32_16x16x32_bf16 a[68:71], a[160:163], v[72:75], a[68:71]
  ds_read_b64_tr_b16 a[178:179], v222 offset:53248
  v_accvgpr_read_b32 v11, a7
  v_mfma_f32_16x16x32_bf16 a[72:75], a[160:163], v[80:83], a[72:75]
  v_accvgpr_read_b32 v12, a20
  v_accvgpr_read_b32 v13, a21
  v_mfma_f32_16x16x32_bf16 a[72:75], a[164:167], v[112:115], a[72:75]
  ds_read_b64_tr_b16 a[180:181], v222 offset:57344
  v_accvgpr_read_b32 v14, a22
  v_mfma_f32_16x16x32_bf16 a[76:79], a[164:167], v[120:123], a[76:79]
  v_accvgpr_read_b32 v15, a23
  v_mul_f32 v8, v8, v196
  v_mfma_f32_16x16x32_bf16 a[76:79], a[160:163], v[88:91], a[76:79]
  ds_read_b64_tr_b16 a[182:183], v222 offset:61440
  s_waitcnt lgkmcnt(4)
  v_mul_f32 v9, v9, v196
  v_mfma_f32_16x16x32_bf16 a[80:83], a[168:171], v[64:67], a[80:83]
  v_mul_f32 v10, v10, v196
  v_mul_f32 v11, v11, v196
  v_mfma_f32_16x16x32_bf16 a[80:83], a[172:175], v[96:99], a[80:83]
  ds_read_b64_tr_b16 a[184:185], v223 offset:49152
  v_mul_f32 v12, v12, v196
  v_mfma_f32_16x16x32_bf16 a[84:87], a[172:175], v[104:107], a[84:87]
  v_mul_f32 v13, v13, v196
  v_mul_f32 v14, v14, v196
  v_mfma_f32_16x16x32_bf16 a[84:87], a[168:171], v[72:75], a[84:87]
  ds_read_b64_tr_b16 a[186:187], v223 offset:53248
  v_mul_f32 v15, v15, v196
  v_mfma_f32_16x16x32_bf16 a[88:91], a[168:171], v[80:83], a[88:91]
  v_cvt_pk_bf16_f32 v8, v8, v9
  v_cvt_pk_bf16_f32 v9, v10, v11
  v_mfma_f32_16x16x32_bf16 a[88:91], a[172:175], v[112:115], a[88:91]
  ds_read_b64_tr_b16 a[188:189], v223 offset:57344
  v_cvt_pk_bf16_f32 v10, v12, v13
  v_mfma_f32_16x16x32_bf16 a[92:95], a[172:175], v[120:123], a[92:95]
  v_cvt_pk_bf16_f32 v11, v14, v15
  v_mfma_f32_16x16x32_bf16 a[92:95], a[168:171], v[88:91], a[92:95]
  ds_read_b64_tr_b16 a[190:191], v223 offset:61440
  s_waitcnt lgkmcnt(4)
  v_mfma_f32_16x16x32_bf16 a[96:99], a[176:179], v[64:67], a[96:99]
  buffer_store_dwordx4 v[8:11], v244, s[24:27], s40 offen offset:2048 sc1
  v_mfma_f32_16x16x32_bf16 a[96:99], a[180:183], v[96:99], a[96:99]
  v_accvgpr_read_b32 v16, a8
  v_accvgpr_read_b32 v17, a9
  v_mfma_f32_16x16x32_bf16 a[100:103], a[180:183], v[104:107], a[100:103]
  v_accvgpr_read_b32 v18, a10
  v_accvgpr_read_b32 v19, a11
  v_mfma_f32_16x16x32_bf16 a[100:103], a[176:179], v[72:75], a[100:103]
  v_accvgpr_read_b32 v20, a24
  v_accvgpr_read_b32 v21, a25
  v_mfma_f32_16x16x32_bf16 a[104:107], a[176:179], v[80:83], a[104:107]
  v_accvgpr_read_b32 v22, a26
  v_accvgpr_read_b32 v23, a27
  v_mfma_f32_16x16x32_bf16 a[104:107], a[180:183], v[112:115], a[104:107]
  v_mul_f32 v16, v16, v200
  v_mul_f32 v17, v17, v200
  v_mfma_f32_16x16x32_bf16 a[108:111], a[180:183], v[120:123], a[108:111]
  v_mul_f32 v18, v18, v200
  v_mul_f32 v19, v19, v200
  v_mfma_f32_16x16x32_bf16 a[108:111], a[176:179], v[88:91], a[108:111]
  s_waitcnt lgkmcnt(0)
  v_mul_f32 v20, v20, v200
  v_mul_f32 v21, v21, v200
  v_mfma_f32_16x16x32_bf16 a[112:115], a[184:187], v[64:67], a[112:115]
  v_mul_f32 v22, v22, v200
  v_mul_f32 v23, v23, v200
  v_mfma_f32_16x16x32_bf16 a[112:115], a[188:191], v[96:99], a[112:115]
  v_cvt_pk_bf16_f32 v16, v16, v17
  v_cvt_pk_bf16_f32 v17, v18, v19
  v_mfma_f32_16x16x32_bf16 a[116:119], a[188:191], v[104:107], a[116:119]
  v_cvt_pk_bf16_f32 v18, v20, v21
  v_cvt_pk_bf16_f32 v19, v22, v23
  v_mfma_f32_16x16x32_bf16 a[116:119], a[184:187], v[72:75], a[116:119]
  buffer_store_dwordx4 v[16:19], v244, s[24:27], s41 offen offset:0 sc1
  v_mfma_f32_16x16x32_bf16 a[120:123], a[184:187], v[80:83], a[120:123]
  v_accvgpr_read_b32 v24, a12
  v_accvgpr_read_b32 v25, a13
  v_mfma_f32_16x16x32_bf16 a[120:123], a[188:191], v[112:115], a[120:123]
  v_accvgpr_read_b32 v26, a14
  v_accvgpr_read_b32 v27, a15
  v_mfma_f32_16x16x32_bf16 a[124:127], a[188:191], v[120:123], a[124:127]
  v_accvgpr_read_b32 v28, a28
  v_accvgpr_read_b32 v29, a29
  v_mfma_f32_16x16x32_bf16 a[124:127], a[184:187], v[88:91], a[124:127]
  v_accvgpr_read_b32 v30, a30
  v_accvgpr_read_b32 v31, a31
  v_pk_mul_f32 v[24:25], v[24:25], v[204:205] op_sel_hi:[1,0]
  v_pk_mul_f32 v[26:27], v[26:27], v[204:205] op_sel_hi:[1,0]
  v_pk_mul_f32 v[28:29], v[28:29], v[204:205] op_sel_hi:[1,0]
  v_pk_mul_f32 v[30:31], v[30:31], v[204:205] op_sel_hi:[1,0]
  v_cvt_pk_bf16_f32 v24, v24, v25
  v_cvt_pk_bf16_f32 v25, v26, v27
  v_cvt_pk_bf16_f32 v26, v28, v29
  v_cvt_pk_bf16_f32 v27, v30, v31
  buffer_store_dwordx4 v[24:27], v244, s[24:27], s41 offen offset:2048 sc1
  v_accvgpr_read_b32 v32, a32
  v_accvgpr_read_b32 v33, a33
  v_accvgpr_read_b32 v34, a34
  v_accvgpr_read_b32 v35, a35
  v_accvgpr_read_b32 v36, a48
  v_accvgpr_read_b32 v37, a49
  v_accvgpr_read_b32 v38, a50
  v_accvgpr_read_b32 v39, a51
  v_pk_mul_f32 v[32:33], v[32:33], v[192:193] op_sel_hi:[1,0]
  v_pk_mul_f32 v[34:35], v[34:35], v[192:193] op_sel_hi:[1,0]
  v_pk_mul_f32 v[36:37], v[36:37], v[192:193] op_sel_hi:[1,0]
  v_pk_mul_f32 v[38:39], v[38:39], v[192:193] op_sel_hi:[1,0]
  v_cvt_pk_bf16_f32 v32, v32, v33
  v_cvt_pk_bf16_f32 v33, v34, v35
  v_cvt_pk_bf16_f32 v34, v36, v37
  v_cvt_pk_bf16_f32 v35, v38, v39
  buffer_store_dwordx4 v[32:35], v244, s[24:27], s40 offen offset:1024 sc1
  v_accvgpr_read_b32 v40, a36
  v_accvgpr_read_b32 v41, a37
  v_accvgpr_read_b32 v42, a38
  v_accvgpr_read_b32 v43, a39
  v_accvgpr_read_b32 v44, a52
  v_accvgpr_read_b32 v45, a53
  v_accvgpr_read_b32 v46, a54
  v_accvgpr_read_b32 v47, a55
  v_pk_mul_f32 v[40:41], v[40:41], v[196:197] op_sel_hi:[1,0]
  v_pk_mul_f32 v[42:43], v[42:43], v[196:197] op_sel_hi:[1,0]
  v_pk_mul_f32 v[44:45], v[44:45], v[196:197] op_sel_hi:[1,0]
  v_pk_mul_f32 v[46:47], v[46:47], v[196:197] op_sel_hi:[1,0]
  v_cvt_pk_bf16_f32 v40, v40, v41
  v_cvt_pk_bf16_f32 v41, v42, v43
  v_cvt_pk_bf16_f32 v42, v44, v45
  v_cvt_pk_bf16_f32 v43, v46, v47
  buffer_store_dwordx4 v[40:43], v244, s[24:27], s40 offen offset:3072 sc1
  v_accvgpr_read_b32 v48, a40
  v_accvgpr_read_b32 v49, a41
  v_accvgpr_read_b32 v50, a42
  v_accvgpr_read_b32 v51, a43
  v_accvgpr_read_b32 v52, a56
  v_accvgpr_read_b32 v53, a57
  v_accvgpr_read_b32 v54, a58
  v_accvgpr_read_b32 v55, a59
  v_pk_mul_f32 v[48:49], v[48:49], v[200:201] op_sel_hi:[1,0]
  v_pk_mul_f32 v[50:51], v[50:51], v[200:201] op_sel_hi:[1,0]
  v_pk_mul_f32 v[52:53], v[52:53], v[200:201] op_sel_hi:[1,0]
  v_pk_mul_f32 v[54:55], v[54:55], v[200:201] op_sel_hi:[1,0]
  v_cvt_pk_bf16_f32 v48, v48, v49
  v_cvt_pk_bf16_f32 v49, v50, v51
  v_cvt_pk_bf16_f32 v50, v52, v53
  v_cvt_pk_bf16_f32 v51, v54, v55
  buffer_store_dwordx4 v[48:51], v244, s[24:27], s41 offen offset:1024 sc1
  v_accvgpr_read_b32 v56, a44
  v_accvgpr_read_b32 v57, a45
  v_accvgpr_read_b32 v58, a46
  v_accvgpr_read_b32 v59, a47
  v_accvgpr_read_b32 v60, a60
  v_accvgpr_read_b32 v61, a61
  v_accvgpr_read_b32 v62, a62
  v_accvgpr_read_b32 v63, a63
  v_pk_mul_f32 v[56:57], v[56:57], v[204:205] op_sel_hi:[1,0]
  v_pk_mul_f32 v[58:59], v[58:59], v[204:205] op_sel_hi:[1,0]
  v_pk_mul_f32 v[60:61], v[60:61], v[204:205] op_sel_hi:[1,0]
  v_pk_mul_f32 v[62:63], v[62:63], v[204:205] op_sel_hi:[1,0]
  v_cvt_pk_bf16_f32 v56, v56, v57
  v_cvt_pk_bf16_f32 v57, v58, v59
  v_cvt_pk_bf16_f32 v58, v60, v61
  v_cvt_pk_bf16_f32 v59, v62, v63
  buffer_store_dwordx4 v[56:59], v244, s[24:27], s41 offen offset:3072 sc1
  v_accvgpr_read_b32 v0, a64
  v_accvgpr_read_b32 v1, a65
  v_accvgpr_read_b32 v2, a66
  v_accvgpr_read_b32 v3, a67
  v_accvgpr_read_b32 v4, a80
  v_accvgpr_read_b32 v5, a81
  v_accvgpr_read_b32 v6, a82
  v_accvgpr_read_b32 v7, a83
  v_pk_mul_f32 v[0:1], v[0:1], v[192:193] op_sel_hi:[1,0]
  v_pk_mul_f32 v[2:3], v[2:3], v[192:193] op_sel_hi:[1,0]
  v_pk_mul_f32 v[4:5], v[4:5], v[192:193] op_sel_hi:[1,0]
  v_pk_mul_f32 v[6:7], v[6:7], v[192:193] op_sel_hi:[1,0]
  v_cvt_pk_bf16_f32 v0, v0, v1
  v_cvt_pk_bf16_f32 v1, v2, v3
  v_cvt_pk_bf16_f32 v2, v4, v5
  v_cvt_pk_bf16_f32 v3, v6, v7
  buffer_store_dwordx4 v[0:3], v244, s[24:27], s42 offen offset:0 sc1
  v_accvgpr_read_b32 v8, a68
  v_accvgpr_read_b32 v9, a69
  v_accvgpr_read_b32 v10, a70
  v_accvgpr_read_b32 v11, a71
  v_accvgpr_read_b32 v12, a84
  v_accvgpr_read_b32 v13, a85
  v_accvgpr_read_b32 v14, a86
  v_accvgpr_read_b32 v15, a87
  v_pk_mul_f32 v[8:9], v[8:9], v[196:197] op_sel_hi:[1,0]
  v_pk_mul_f32 v[10:11], v[10:11], v[196:197] op_sel_hi:[1,0]
  v_pk_mul_f32 v[12:13], v[12:13], v[196:197] op_sel_hi:[1,0]
  v_pk_mul_f32 v[14:15], v[14:15], v[196:197] op_sel_hi:[1,0]
  v_cvt_pk_bf16_f32 v8, v8, v9
  v_cvt_pk_bf16_f32 v9, v10, v11
  v_cvt_pk_bf16_f32 v10, v12, v13
  v_cvt_pk_bf16_f32 v11, v14, v15
  buffer_store_dwordx4 v[8:11], v244, s[24:27], s42 offen offset:2048 sc1
  v_accvgpr_read_b32 v16, a72
  v_accvgpr_read_b32 v17, a73
  v_accvgpr_read_b32 v18, a74
  v_accvgpr_read_b32 v19, a75
  v_accvgpr_read_b32 v20, a88
  v_accvgpr_read_b32 v21, a89
  v_accvgpr_read_b32 v22, a90
  v_accvgpr_read_b32 v23, a91
  v_pk_mul_f32 v[16:17], v[16:17], v[200:201] op_sel_hi:[1,0]
  v_pk_mul_f32 v[18:19], v[18:19], v[200:201] op_sel_hi:[1,0]
  v_pk_mul_f32 v[20:21], v[20:21], v[200:201] op_sel_hi:[1,0]
  v_pk_mul_f32 v[22:23], v[22:23], v[200:201] op_sel_hi:[1,0]
  v_cvt_pk_bf16_f32 v16, v16, v17
  v_cvt_pk_bf16_f32 v17, v18, v19
  v_cvt_pk_bf16_f32 v18, v20, v21
  v_cvt_pk_bf16_f32 v19, v22, v23
  buffer_store_dwordx4 v[16:19], v244, s[24:27], s43 offen offset:0 sc1
  v_accvgpr_read_b32 v24, a76
  v_accvgpr_read_b32 v25, a77
  v_accvgpr_read_b32 v26, a78
  v_accvgpr_read_b32 v27, a79
  v_accvgpr_read_b32 v28, a92
  v_accvgpr_read_b32 v29, a93
  v_accvgpr_read_b32 v30, a94
  v_accvgpr_read_b32 v31, a95
  v_pk_mul_f32 v[24:25], v[24:25], v[204:205] op_sel_hi:[1,0]
  v_pk_mul_f32 v[26:27], v[26:27], v[204:205] op_sel_hi:[1,0]
  v_pk_mul_f32 v[28:29], v[28:29], v[204:205] op_sel_hi:[1,0]
  v_pk_mul_f32 v[30:31], v[30:31], v[204:205] op_sel_hi:[1,0]
  v_cvt_pk_bf16_f32 v24, v24, v25
  v_cvt_pk_bf16_f32 v25, v26, v27
  v_cvt_pk_bf16_f32 v26, v28, v29
  v_cvt_pk_bf16_f32 v27, v30, v31
  buffer_store_dwordx4 v[24:27], v244, s[24:27], s43 offen offset:2048 sc1
  v_accvgpr_read_b32 v32, a96
  v_accvgpr_read_b32 v33, a97
  v_accvgpr_read_b32 v34, a98
  v_accvgpr_read_b32 v35, a99
  v_accvgpr_read_b32 v36, a112
  v_accvgpr_read_b32 v37, a113
  v_accvgpr_read_b32 v38, a114
  v_accvgpr_read_b32 v39, a115
  v_pk_mul_f32 v[32:33], v[32:33], v[192:193] op_sel_hi:[1,0]
  v_pk_mul_f32 v[34:35], v[34:35], v[192:193] op_sel_hi:[1,0]
  v_pk_mul_f32 v[36:37], v[36:37], v[192:193] op_sel_hi:[1,0]
  v_pk_mul_f32 v[38:39], v[38:39], v[192:193] op_sel_hi:[1,0]
  v_cvt_pk_bf16_f32 v32, v32, v33
  v_cvt_pk_bf16_f32 v33, v34, v35
  v_cvt_pk_bf16_f32 v34, v36, v37
  v_cvt_pk_bf16_f32 v35, v38, v39
  buffer_store_dwordx4 v[32:35], v244, s[24:27], s42 offen offset:1024 sc1
  v_accvgpr_read_b32 v40, a100
  v_accvgpr_read_b32 v41, a101
  v_accvgpr_read_b32 v42, a102
  v_accvgpr_read_b32 v43, a103
  v_accvgpr_read_b32 v44, a116
  v_accvgpr_read_b32 v45, a117
  v_accvgpr_read_b32 v46, a118
  v_accvgpr_read_b32 v47, a119
  v_pk_mul_f32 v[40:41], v[40:41], v[196:197] op_sel_hi:[1,0]
  v_pk_mul_f32 v[42:43], v[42:43], v[196:197] op_sel_hi:[1,0]
  v_pk_mul_f32 v[44:45], v[44:45], v[196:197] op_sel_hi:[1,0]
  v_pk_mul_f32 v[46:47], v[46:47], v[196:197] op_sel_hi:[1,0]
  v_cvt_pk_bf16_f32 v40, v40, v41
  v_cvt_pk_bf16_f32 v41, v42, v43
  v_cvt_pk_bf16_f32 v42, v44, v45
  v_cvt_pk_bf16_f32 v43, v46, v47
  buffer_store_dwordx4 v[40:43], v244, s[24:27], s42 offen offset:3072 sc1
  v_accvgpr_read_b32 v48, a104
  v_accvgpr_read_b32 v49, a105
  v_accvgpr_read_b32 v50, a106
  v_accvgpr_read_b32 v51, a107
  v_accvgpr_read_b32 v52, a120
  v_accvgpr_read_b32 v53, a121
  v_accvgpr_read_b32 v54, a122
  v_accvgpr_read_b32 v55, a123
  v_pk_mul_f32 v[48:49], v[48:49], v[200:201] op_sel_hi:[1,0]
  v_pk_mul_f32 v[50:51], v[50:51], v[200:201] op_sel_hi:[1,0]
  v_pk_mul_f32 v[52:53], v[52:53], v[200:201] op_sel_hi:[1,0]
  v_pk_mul_f32 v[54:55], v[54:55], v[200:201] op_sel_hi:[1,0]
  v_cvt_pk_bf16_f32 v48, v48, v49
  v_cvt_pk_bf16_f32 v49, v50, v51
  v_cvt_pk_bf16_f32 v50, v52, v53
  v_cvt_pk_bf16_f32 v51, v54, v55
  buffer_store_dwordx4 v[48:51], v244, s[24:27], s43 offen offset:1024 sc1
  v_accvgpr_read_b32 v56, a108
  v_accvgpr_read_b32 v57, a109
  v_accvgpr_read_b32 v58, a110
  v_accvgpr_read_b32 v59, a111
  v_accvgpr_read_b32 v60, a124
  v_accvgpr_read_b32 v61, a125
  v_accvgpr_read_b32 v62, a126
  v_accvgpr_read_b32 v63, a127
  v_pk_mul_f32 v[56:57], v[56:57], v[204:205] op_sel_hi:[1,0]
  v_pk_mul_f32 v[58:59], v[58:59], v[204:205] op_sel_hi:[1,0]
  v_pk_mul_f32 v[60:61], v[60:61], v[204:205] op_sel_hi:[1,0]
  v_pk_mul_f32 v[62:63], v[62:63], v[204:205] op_sel_hi:[1,0]
  v_cvt_pk_bf16_f32 v56, v56, v57
  v_cvt_pk_bf16_f32 v57, v58, v59
  v_cvt_pk_bf16_f32 v58, v60, v61
  v_cvt_pk_bf16_f32 v59, v62, v63
  buffer_store_dwordx4 v[56:59], v244, s[24:27], s43 offen offset:3072 sc1
  ds_write_b32 v247, v245
  buffer_load_dwordx4 v[176:179], v252, s[24:27], s6 offen offset:3072 sc1
  buffer_load_dwordx4 v[180:183], v253, s[24:27], s6 offen offset:0 sc1
  buffer_load_dwordx4 v[184:187], v253, s[24:27], s6 offen offset:1024 sc1
  buffer_load_dwordx4 v[188:191], v253, s[24:27], s6 offen offset:2048 sc1
  buffer_load_dwordx4 a[0:3], v253, s[24:27], s6 offen offset:3072 sc1
  buffer_load_dwordx4 a[4:7], v242, s[24:27], s7 offen offset:0 sc1
  buffer_load_dwordx4 a[8:11], v242, s[24:27], s7 offen offset:1024 sc1
  buffer_load_dwordx4 a[12:15], v242, s[24:27], s7 offen offset:2048 sc1
  s_lshr_b32 s39, s37, 2
  s_lshl_b32 s39, s39, 3
  s_lshr_b32 s38, s36, 2
  s_add_u32 s39, s39, s38
  s_lshl_b32 s39, s39, 7
  s_add_u32 s39, s39, 2867200
  s_lshl_b32 s38, s3, 26
  v_lshlrev_b32 v64, 22, v242
  v_or_b32 v64, s38, v64
  v_mov_b32 v65, 1
  v_add_u32 v246, 157696, v242
  s_waitcnt vmcnt(8) lgkmcnt(0)
  s_barrier
  ds_read_b128 v[68:71], v246
  s_waitcnt lgkmcnt(0)
  v_or3_b32 v68, v68, v69, v70
  v_or_b32 v68, v68, v71
  v_cmp_ne_u32 vcc, 0, v68
  s_nop 0
  s_cbranch_vccnz attn_redo
tail_go:
  buffer_atomic_add v65, v64, s[24:27], s39 offen
  s_and_b32 s36, s2, 1
  s_bfe_u32 s31, s2, 0x20001
  s_lshl_b32 s31, s31, 2
  s_bfe_u32 s38, s2, 0x20003
  s_add_u32 s31, s31, s38
  s_lshr_b32 s29, s2, 5
  v_mov_b32 v114, v242
  v_add_u32 v115, 0x1000, v114
  v_add_u32 v116, 0x2000, v114
  s_lshl_b32 s38, s36, 2
  s_add_u32 s38, s38, s3
  s_lshl_b32 s30, s38, 16
  buffer_load_dwordx4 a[16:19], v114, s[24:27], s7 offen offset:3072 sc1
  buffer_load_dwordx4 a[20:23], v115, s[24:27], s7 offen offset:0 sc1
  buffer_load_dwordx4 a[24:27], v115, s[24:27], s7 offen offset:1024 sc1
  buffer_load_dwordx4 a[28:31], v115, s[24:27], s7 offen offset:2048 sc1
  v_lshrrev_b32 v192, 4, v114
  v_and_b32 v193, 15, v192
  v_lshrrev_b32 v194, 4, v192
  s_add_u32 s38, s3, 0
  s_and_b32 s38, s38, 3
  s_lshl_b32 s38, s38, 11
  v_add_u32 v110, s38, v114
  s_sub_u32 s38, s3, 0
  s_and_b32 s38, s38, 3
  s_mul_i32 s38, s38, 15360
  s_add_u32 s38, s38, 98304
  v_add_u32 v118, s38, v114
  s_add_u32 s38, s3, 1
  s_and_b32 s38, s38, 3
  s_lshl_b32 s38, s38, 11
  v_add_u32 v111, s38, v114
  s_sub_u32 s38, s3, 1
  s_and_b32 s38, s38, 3
  s_mul_i32 s38, s38, 15360
  s_add_u32 s38, s38, 98304
  v_add_u32 v119, s38, v114
  s_add_u32 s38, s3, 2
  s_and_b32 s38, s38, 3
  s_lshl_b32 s38, s38, 11
  v_add_u32 v112, s38, v114
  s_sub_u32 s38, s3, 2
  s_and_b32 s38, s38, 3
  s_mul_i32 s38, s38, 15360
  s_add_u32 s38, s38, 98304
  v_add_u32 v120, s38, v114
  s_add_u32 s38, s3, 3
  s_and_b32 s38, s38, 3
  s_lshl_b32 s38, s38, 11
  v_add_u32 v113, s38, v114
  s_sub_u32 s38, s3, 3
  s_and_b32 s38, s38, 3
  s_mul_i32 s38, s38, 15360
  s_add_u32 s38, s38, 98304
  v_add_u32 v121, s38, v114
  v_add_u32 v122, s28, v114
  v_add_u32 v202, 0x10000, v122
  s_and_b32 s38, s31, 14
  s_add_u32 s38, s38, s36
  s_lshl_b32 s38, s38, 2
  s_add_u32 s38, s38, s3
  s_lshl_b32 s38, s38, 7
  s_add_u32 s38, s38, 2867200
  s_lshl_b32 s39, s29, 8
  s_add_u32 s39, s39, 2818304
  v_mov_b32 v200, s38
  v_writelane_b32 v200, s39, 1
  v_mov_b32 v201, 4
  v_writelane_b32 v201, 30, 1
  s_lshl_b32 s31, s31, 1
  s_add_u32 s31, s31, s36
  s_add_u32 s30, s30, 8388608
  s_lshl_b32 s38, s31, 19
  s_add_u32 s37, s30, s38
  s_xor_b32 s38, s38, 0x80000
  s_add_u32 s30, s30, s38
  s_lshl_b32 s40, s29, 5
  s_add_u32 s40, s40, s31
  s_lshl_b32 s38, s31, 6
  s_lshl_b32 s39, s3, 4
  s_add_u32 s38, s38, s39
  v_add_u32 v195, s38, v193
  v_mul_u32_u24 v117, 0x500, v195
  v_lshl_add_u32 v117, v194, 3, v117
  s_mul_i32 s38, s29, 160
  v_add_u32 v117, s38, v117
  s_mov_b32 s12, s60
  s_mov_b32 s13, s61
  s_mov_b32 s14, 2621440
  s_mov_b32 s15, 0x20000
  s_mov_b32 s16, s62
  s_mov_b32 s17, s63
  s_mov_b32 s18, 2621440
  s_mov_b32 s19, 0x20000
  s_mul_i32 s38, s31, 81920
  s_lshl_b32 s39, s3, 10
  s_add_u32 s38, s38, s39
  s_mul_i32 s39, s29, 10
  v_lshrrev_b32 v196, 1, v194
  v_add_u32 v196, s39, v196
  v_and_b32 v197, 1, v194
  v_lshlrev_b32 v197, 3, v197
  v_lshl_add_u32 v197, v193, 4, v197
  v_lshrrev_b32 v198, 2, v196
  v_lshl_add_u32 v198, v198, 12, v197
  v_and_b32 v199, 3, v196
  v_lshl_add_u32 v198, v199, 8, v198
  buffer_load_dwordx2 v[224:225], v198, s[24:27], s38 offen sc1
  v_add_u32 v196, 2, v196
  buffer_load_dwordx2 v[80:81], v117, s[12:15], 0 offen offset:0
  v_lshrrev_b32 v198, 2, v196
  v_lshl_add_u32 v198, v198, 12, v197
  v_and_b32 v199, 3, v196
  v_lshl_add_u32 v198, v199, 8, v198
  buffer_load_dwordx2 v[226:227], v198, s[24:27], s38 offen sc1
  v_add_u32 v196, 2, v196
  buffer_load_dwordx2 v[82:83], v117, s[12:15], 0 offen offset:32
  v_lshrrev_b32 v198, 2, v196
  v_lshl_add_u32 v198, v198, 12, v197
  v_and_b32 v199, 3, v196
  v_lshl_add_u32 v198, v199, 8, v198
  buffer_load_dwordx2 v[228:229], v198, s[24:27], s38 offen sc1
  v_add_u32 v196, 2, v196
  buffer_load_dwordx2 v[84:85], v117, s[12:15], 0 offen offset:64
  v_lshrrev_b32 v198, 2, v196
  v_lshl_add_u32 v198, v198, 12, v197
  v_and_b32 v199, 3, v196
  v_lshl_add_u32 v198, v199, 8, v198
  buffer_load_dwordx2 v[230:231], v198, s[24:27], s38 offen sc1
  v_add_u32 v196, 2, v196
  buffer_load_dwordx2 v[86:87], v117, s[12:15], 0 offen offset:96
  v_lshrrev_b32 v198, 2, v196
  v_lshl_add_u32 v198, v198, 12, v197
  v_and_b32 v199, 3, v196
  v_lshl_add_u32 v198, v199, 8, v198
  buffer_load_dwordx2 v[232:233], v198, s[24:27], s38 offen sc1
  v_add_u32 v196, 2, v196
  buffer_load_dwordx2 v[88:89], v117, s[12:15], 0 offen offset:128
  v_mov_b32 v123, 1073741824
  v_bfrev_b32 v124, 1
  v_sub_u32 v195, 0xffff, v195
  s_mov_b32 s34, 0xffff0000
  s_and_b32 s38, s52, 0xffff
  v_cmp_eq_u32 vcc, s38, v195
  v_mov_b32 v196, s52
  v_mov_b32 v197, 0
  v_cndmask_b32 v124, v124, v196, vcc
  v_cndmask_b32 v123, v123, v197, vcc
  s_and_b32 s38, s53, 0xffff
  v_cmp_eq_u32 vcc, s38, v195
  v_mov_b32 v196, s53
  v_mov_b32 v197, 2560
  v_cndmask_b32 v124, v124, v196, vcc
  v_cndmask_b32 v123, v123, v197, vcc
  s_and_b32 s38, s54, 0xffff
  v_cmp_eq_u32 vcc, s38, v195
  v_mov_b32 v196, s54
  v_mov_b32 v197, 5120
  v_cndmask_b32 v124, v124, v196, vcc
  v_cndmask_b32 v123, v123, v197, vcc
  s_and_b32 s38, s55, 0xffff
  v_cmp_eq_u32 vcc, s38, v195
  v_mov_b32 v196, s55
  v_mov_b32 v197, 7680
  v_cndmask_b32 v124, v124, v196, vcc
  v_cndmask_b32 v123, v123, v197, vcc
  s_and_b32 s38, s56, 0xffff
  v_cmp_eq_u32 vcc, s38, v195
  v_mov_b32 v196, s56
  v_mov_b32 v197, 10240
  v_cndmask_b32 v124, v124, v196, vcc
  v_cndmask_b32 v123, v123, v197, vcc
  s_and_b32 s38, s57, 0xffff
  v_cmp_eq_u32 vcc, s38, v195
  v_mov_b32 v196, s57
  v_mov_b32 v197, 12800
  v_cndmask_b32 v124, v124, v196, vcc
  v_cndmask_b32 v123, v123, v197, vcc
  s_and_b32 s38, s58, 0xffff
  v_cmp_eq_u32 vcc, s38, v195
  v_mov_b32 v196, s58
  v_mov_b32 v197, 15360
  v_cndmask_b32 v124, v124, v196, vcc
  v_cndmask_b32 v123, v123, v197, vcc
  s_and_b32 s38, s59, 0xffff
  v_cmp_eq_u32 vcc, s38, v195
  v_mov_b32 v196, s59
  v_mov_b32 v197, 17920
  v_cndmask_b32 v124, v124, v196, vcc
  v_cndmask_b32 v123, v123, v197, vcc
  v_lshl_add_u32 v123, v194, 4, v123
  s_mul_i32 s32, s29, 320
  s_add_u32 s32, s32, 2686976
  v_ashrrev_i32 v196, 31, v124
  v_not_b32 v196, v196
  v_or_b32 v196, 0x80000000, v196
  v_xor_b32 v124, v124, v196
  v_and_b32 v124, s34, v124
  v_mul_f32 v124, 0xbfb8aa3b, v124
  v_exp_f32 v124, v124
  s_nop 0
  v_add_f32 v124, 1.0, v124
  v_rcp_f32 v124, v124
  s_nop 0
  v_cvt_pk_bf16_f32 v124, v124, v124
  v_lshlrev_b32 v124, 16, v124
  buffer_load_dword v195, v200, s[24:27], 0 offen sc1
  buffer_load_dwordx4 a[32:35], v115, s[24:27], s7 offen offset:3072 sc1
  buffer_load_dwordx4 a[36:39], v116, s[24:27], s7 offen offset:0 sc1
  buffer_load_dwordx4 a[40:43], v116, s[24:27], s7 offen offset:1024 sc1
  buffer_load_dwordx4 a[44:47], v116, s[24:27], s7 offen offset:2048 sc1
  buffer_load_dwordx4 a[48:51], v116, s[24:27], s7 offen offset:3072 sc1
  buffer_load_dwordx4 a[52:55], v114, s[24:27], s8 offen offset:0 sc1
  s_waitcnt vmcnt(16)
  v_lshlrev_b32 v90, 16, v224
  v_and_b32 v91, s34, v224
  v_lshlrev_b32 v92, 16, v225
  v_and_b32 v93, s34, v225
  s_waitcnt vmcnt(14)
  v_lshlrev_b32 v94, 16, v226
  v_and_b32 v95, s34, v226
  v_lshlrev_b32 v96, 16, v227
  v_and_b32 v97, s34, v227
  s_waitcnt vmcnt(12)
  v_lshlrev_b32 v98, 16, v228
  v_and_b32 v99, s34, v228
  v_lshlrev_b32 v100, 16, v229
  v_and_b32 v101, s34, v229
  s_waitcnt vmcnt(10)
  v_lshlrev_b32 v102, 16, v230
  v_and_b32 v103, s34, v230
  v_lshlrev_b32 v104, 16, v231
  v_and_b32 v105, s34, v231
  s_waitcnt vmcnt(8)
  v_lshlrev_b32 v106, 16, v232
  v_and_b32 v107, s34, v232
  v_lshlrev_b32 v108, 16, v233
  v_and_b32 v109, s34, v233
  v_mov_b32 v224, 0
  v_mov_b32 v225, 0
  v_mov_b32 v226, 0
  v_mov_b32 v227, 0
  v_mov_b32 v228, 0
  v_mov_b32 v229, 0
  v_mov_b32 v230, 0
  v_mov_b32 v231, 0
  v_mov_b32 v232, 0
  v_mov_b32 v233, 0
  v_mov_b32 v234, 0
  v_mov_b32 v235, 0
  v_mov_b32 v236, 0
  v_mov_b32 v237, 0
  v_mov_b32 v238, 0
  v_mov_b32 v239, 0
  v_mov_b32 v240, 0
  v_mov_b32 v241, 0
  v_mov_b32 v242, 0
  v_mov_b32 v243, 0
  s_waitcnt vmcnt(6)
  v_cmp_lt_u32 vcc, v195, v201
  s_nop 0
  s_cbranch_vccz tail_ready
  s_waitcnt vmcnt(0)
  s_mov_b32 s35, 32768
  buffer_load_dword v195, v200, s[24:27], 0 offen sc1
  s_sleep 3
  buffer_load_dword v196, v200, s[24:27], 0 offen sc1
  s_sleep 3
tail_spin:
  buffer_load_dword v197, v200, s[24:27], 0 offen sc1
  s_waitcnt vmcnt(2)
  v_cmp_lt_u32 vcc, v195, v201
  s_nop 0
  s_cbranch_vccz tail_ready
  s_sleep 3
  buffer_load_dword v195, v200, s[24:27], 0 offen sc1
  s_waitcnt vmcnt(2)
  v_cmp_lt_u32 vcc, v196, v201
  s_nop 0
  s_cbranch_vccz tail_ready
  s_sleep 3
  buffer_load_dword v196, v200, s[24:27], 0 offen sc1
  s_waitcnt vmcnt(2)
  v_cmp_lt_u32 vcc, v197, v201
  s_nop 0
  s_cbranch_vccz tail_ready
  s_sleep 3
  s_sub_u32 s35, s35, 1
  s_cmp_lg_u32 s35, 0
  s_cbranch_scc1 tail_spin
tail_ready:
  buffer_load_dwordx4 a[84:87], v110, s[24:27], s30 offen offset:0 sc1
  buffer_load_dwordx4 a[88:91], v110, s[24:27], s30 offen offset:1024 sc1
  buffer_load_dwordx4 a[92:95], v111, s[24:27], s30 offen offset:0 sc1
  buffer_load_dwordx4 a[96:99], v111, s[24:27], s30 offen offset:1024 sc1
  buffer_load_dwordx4 a[100:103], v112, s[24:27], s30 offen offset:0 sc1
  buffer_load_dwordx4 a[104:107], v112, s[24:27], s30 offen offset:1024 sc1
  buffer_load_dwordx4 a[108:111], v113, s[24:27], s30 offen offset:0 sc1
  buffer_load_dwordx4 a[112:115], v113, s[24:27], s30 offen offset:1024 sc1
  v_cmp_gt_u32 vcc, 1073741824, v123
  s_nop 0
  s_and_saveexec_b64 s[42:43], vcc
  s_cbranch_execz tail_plain
  s_waitcnt vmcnt(30)
  buffer_load_dwordx4 v[224:227], v123, s[24:27], s32 offen offset:0 sc1
  buffer_load_dwordx4 v[228:231], v123, s[24:27], s32 offen offset:64 sc1
  buffer_load_dwordx4 v[232:235], v123, s[24:27], s32 offen offset:128 sc1
  buffer_load_dwordx4 v[236:239], v123, s[24:27], s32 offen offset:192 sc1
  buffer_load_dwordx4 v[240:243], v123, s[24:27], s32 offen offset:256 sc1
  s_add_u32 s32, s32, 20480
  buffer_load_dwordx4 v[204:207], v123, s[24:27], s32 offen offset:0 sc1
  buffer_load_dwordx4 v[208:211], v123, s[24:27], s32 offen offset:64 sc1
  buffer_load_dwordx4 v[212:215], v123, s[24:27], s32 offen offset:128 sc1
  buffer_load_dwordx4 v[216:219], v123, s[24:27], s32 offen offset:192 sc1
  buffer_load_dwordx4 v[220:223], v123, s[24:27], s32 offen offset:256 sc1
  s_add_u32 s32, s32, 20480
  buffer_load_dwordx4 v[0:3], v123, s[24:27], s32 offen offset:0 sc1
  buffer_load_dwordx4 v[4:7], v123, s[24:27], s32 offen offset:64 sc1
  buffer_load_dwordx4 v[8:11], v123, s[24:27], s32 offen offset:128 sc1
  buffer_load_dwordx4 v[12:15], v123, s[24:27], s32 offen offset:192 sc1
  buffer_load_dwordx4 v[16:19], v123, s[24:27], s32 offen offset:256 sc1
  s_add_u32 s32, s32, 20480
  buffer_load_dwordx4 v[20:23], v123, s[24:27], s32 offen offset:0 sc1
  buffer_load_dwordx4 v[24:27], v123, s[24:27], s32 offen offset:64 sc1
  buffer_load_dwordx4 v[28:31], v123, s[24:27], s32 offen offset:128 sc1
  buffer_load_dwordx4 v[32:35], v123, s[24:27], s32 offen offset:192 sc1
  buffer_load_dwordx4 v[36:39], v123, s[24:27], s32 offen offset:256 sc1
  s_add_u32 s32, s32, 20480
  buffer_load_dwordx4 v[40:43], v123, s[24:27], s32 offen offset:0 sc1
  buffer_load_dwordx4 v[44:47], v123, s[24:27], s32 offen offset:64 sc1
  buffer_load_dwordx4 v[48:51], v123, s[24:27], s32 offen offset:128 sc1
  buffer_load_dwordx4 v[52:55], v123, s[24:27], s32 offen offset:192 sc1
  buffer_load_dwordx4 v[56:59], v123, s[24:27], s32 offen offset:256 sc1
  s_add_u32 s32, s32, 20480
  buffer_load_dwordx4 v[60:63], v123, s[24:27], s32 offen offset:0 sc1
  buffer_load_dwordx4 v[64:67], v123, s[24:27], s32 offen offset:64 sc1
  buffer_load_dwordx4 v[68:71], v123, s[24:27], s32 offen offset:128 sc1
  buffer_load_dwordx4 v[72:75], v123, s[24:27], s32 offen offset:192 sc1
  buffer_load_dwordx4 v[76:79], v123, s[24:27], s32 offen offset:256 sc1
  s_add_u32 s32, s32, 20480
  s_waitcnt vmcnt(0)
  v_add_f32 v224, v224, v204
  v_add_f32 v225, v225, v205
  v_add_f32 v226, v226, v206
  v_add_f32 v227, v227, v207
  v_add_f32 v228, v228, v208
  v_add_f32 v229, v229, v209
  v_add_f32 v230, v230, v210
  v_add_f32 v231, v231, v211
  v_add_f32 v232, v232, v212
  v_add_f32 v233, v233, v213
  v_add_f32 v234, v234, v214
  v_add_f32 v235, v235, v215
  v_add_f32 v236, v236, v216
  v_add_f32 v237, v237, v217
  v_add_f32 v238, v238, v218
  v_add_f32 v239, v239, v219
  v_add_f32 v240, v240, v220
  v_add_f32 v241, v241, v221
  v_add_f32 v242, v242, v222
  v_add_f32 v243, v243, v223
  v_add_f32 v224, v224, v0
  v_add_f32 v225, v225, v1
  v_add_f32 v226, v226, v2
  v_add_f32 v227, v227, v3
  v_add_f32 v228, v228, v4
  v_add_f32 v229, v229, v5
  v_add_f32 v230, v230, v6
  v_add_f32 v231, v231, v7
  v_add_f32 v232, v232, v8
  v_add_f32 v233, v233, v9
  v_add_f32 v234, v234, v10
  v_add_f32 v235, v235, v11
  v_add_f32 v236, v236, v12
  v_add_f32 v237, v237, v13
  v_add_f32 v238, v238, v14
  v_add_f32 v239, v239, v15
  v_add_f32 v240, v240, v16
  v_add_f32 v241, v241, v17
  v_add_f32 v242, v242, v18
  v_add_f32 v243, v243, v19
  v_add_f32 v224, v224, v20
  v_add_f32 v225, v225, v21
  v_add_f32 v226, v226, v22
  v_add_f32 v227, v227, v23
  v_add_f32 v228, v228, v24
  v_add_f32 v229, v229, v25
  v_add_f32 v230, v230, v26
  v_add_f32 v231, v231, v27
  v_add_f32 v232, v232, v28
  v_add_f32 v233, v233, v29
  v_add_f32 v234, v234, v30
  v_add_f32 v235, v235, v31
  v_add_f32 v236, v236, v32
  v_add_f32 v237, v237, v33
  v_add_f32 v238, v238, v34
  v_add_f32 v239, v239, v35
  v_add_f32 v240, v240, v36
  v_add_f32 v241, v241, v37
  v_add_f32 v242, v242, v38
  v_add_f32 v243, v243, v39
  v_add_f32 v224, v224, v40
  v_add_f32 v225, v225, v41
  v_add_f32 v226, v226, v42
  v_add_f32 v227, v227, v43
  v_add_f32 v228, v228, v44
  v_add_f32 v229, v229, v45
  v_add_f32 v230, v230, v46
  v_add_f32 v231, v231, v47
  v_add_f32 v232, v232, v48
  v_add_f32 v233, v233, v49
  v_add_f32 v234, v234, v50
  v_add_f32 v235, v235, v51
  v_add_f32 v236, v236, v52
  v_add_f32 v237, v237, v53
  v_add_f32 v238, v238, v54
  v_add_f32 v239, v239, v55
  v_add_f32 v240, v240, v56
  v_add_f32 v241, v241, v57
  v_add_f32 v242, v242, v58
  v_add_f32 v243, v243, v59
  v_add_f32 v224, v224, v60
  v_add_f32 v225, v225, v61
  v_add_f32 v226, v226, v62
  v_add_f32 v227, v227, v63
  v_add_f32 v228, v228, v64
  v_add_f32 v229, v229, v65
  v_add_f32 v230, v230, v66
  v_add_f32 v231, v231, v67
  v_add_f32 v232, v232, v68
  v_add_f32 v233, v233, v69
  v_add_f32 v234, v234, v70
  v_add_f32 v235, v235, v71
  v_add_f32 v236, v236, v72
  v_add_f32 v237, v237, v73
  v_add_f32 v238, v238, v74
  v_add_f32 v239, v239, v75
  v_add_f32 v240, v240, v76
  v_add_f32 v241, v241, v77
  v_add_f32 v242, v242, v78
  v_add_f32 v243, v243, v79
tail_plain:
  s_mov_b64 exec, s[42:43]
  s_waitcnt vmcnt(0)
  v_mfma_f32_16x16x32_bf16 v[0:3], a[212:215], a[84:87], 0
  s_add_u32 s30, s30, 8192
  buffer_load_dwordx4 a[116:119], v110, s[24:27], s30 offen offset:0 sc1
  v_mfma_f32_16x16x32_bf16 v[0:3], a[232:235], a[88:91], v[0:3]
  v_cvt_pk_bf16_f32 v224, v224, v224
  v_cvt_pk_bf16_f32 v225, v225, v225
  v_mfma_f32_16x16x32_bf16 v[4:7], a[232:235], a[96:99], 0
  buffer_load_dwordx4 a[56:59], v114, s[24:27], s8 offen offset:1024 sc1
  v_mfma_f32_16x16x32_bf16 v[4:7], a[212:215], a[92:95], v[4:7]
  v_cvt_pk_bf16_f32 v226, v226, v226
  v_cvt_pk_bf16_f32 v227, v227, v227
  v_mfma_f32_16x16x32_bf16 v[8:11], a[212:215], a[100:103], 0
  buffer_load_dwordx4 a[120:123], v110, s[24:27], s30 offen offset:1024 sc1
  v_mfma_f32_16x16x32_bf16 v[8:11], a[232:235], a[104:107], v[8:11]
  v_lshlrev_b32 v224, 16, v224
  v_lshlrev_b32 v225, 16, v225
  v_mfma_f32_16x16x32_bf16 v[12:15], a[232:235], a[112:115], 0
  v_lshlrev_b32 v226, 16, v226
  v_lshlrev_b32 v227, 16, v227
  v_mfma_f32_16x16x32_bf16 v[12:15], a[212:215], a[108:111], v[12:15]
  v_mul_f32 v224, v224, v124
  v_mul_f32 v225, v225, v124
  v_mfma_f32_16x16x32_bf16 v[16:19], a[216:219], a[84:87], 0
  buffer_load_dwordx4 a[124:127], v111, s[24:27], s30 offen offset:0 sc1
  v_mfma_f32_16x16x32_bf16 v[16:19], a[236:239], a[88:91], v[16:19]
  v_mul_f32 v226, v226, v124
  v_mul_f32 v227, v227, v124
  v_mfma_f32_16x16x32_bf16 v[20:23], a[236:239], a[96:99], 0
  buffer_load_dwordx4 a[60:63], v114, s[24:27], s8 offen offset:2048 sc1
  v_mfma_f32_16x16x32_bf16 v[20:23], a[216:219], a[92:95], v[20:23]
  v_cvt_pk_bf16_f32 v224, v224, v224
  v_cvt_pk_bf16_f32 v225, v225, v225
  v_mfma_f32_16x16x32_bf16 v[24:27], a[216:219], a[100:103], 0
  buffer_load_dwordx4 a[160:163], v111, s[24:27], s30 offen offset:1024 sc1
  v_mfma_f32_16x16x32_bf16 v[24:27], a[236:239], a[104:107], v[24:27]
  v_cvt_pk_bf16_f32 v226, v226, v226
  v_cvt_pk_bf16_f32 v227, v227, v227
  v_mfma_f32_16x16x32_bf16 v[28:31], a[236:239], a[112:115], 0
  v_lshlrev_b32 v224, 16, v224
  v_lshlrev_b32 v225, 16, v225
  v_mfma_f32_16x16x32_bf16 v[28:31], a[216:219], a[108:111], v[28:31]
  v_lshlrev_b32 v226, 16, v226
  v_lshlrev_b32 v227, 16, v227
  v_mfma_f32_16x16x32_bf16 v[32:35], a[220:223], a[84:87], 0
  buffer_load_dwordx4 a[164:167], v112, s[24:27], s30 offen offset:0 sc1
  v_mfma_f32_16x16x32_bf16 v[32:35], a[240:243], a[88:91], v[32:35]
  v_add_f32 v90, v90, v224
  v_add_f32 v91, v91, v225
  v_mfma_f32_16x16x32_bf16 v[36:39], a[240:243], a[96:99], 0
  buffer_load_dwordx4 a[64:67], v114, s[24:27], s8 offen offset:3072 sc1
  v_mfma_f32_16x16x32_bf16 v[36:39], a[220:223], a[92:95], v[36:39]
  v_add_f32 v92, v92, v226
  v_add_f32 v93, v93, v227
  v_mfma_f32_16x16x32_bf16 v[40:43], a[220:223], a[100:103], 0
  buffer_load_dwordx4 a[168:171], v112, s[24:27], s30 offen offset:1024 sc1
  v_mfma_f32_16x16x32_bf16 v[40:43], a[240:243], a[104:107], v[40:43]
  v_cvt_pk_bf16_f32 v90, v90, v90
  v_cvt_pk_bf16_f32 v91, v91, v91
  v_mfma_f32_16x16x32_bf16 v[44:47], a[240:243], a[112:115], 0
  v_cvt_pk_bf16_f32 v92, v92, v92
  v_cvt_pk_bf16_f32 v93, v93, v93
  v_mfma_f32_16x16x32_bf16 v[44:47], a[220:223], a[108:111], v[44:47]
  v_lshlrev_b32 v90, 16, v90
  v_lshlrev_b32 v91, 16, v91
  v_mfma_f32_16x16x32_bf16 v[48:51], a[224:227], a[84:87], 0
  buffer_load_dwordx4 a[172:175], v113, s[24:27], s30 offen offset:0 sc1
  v_mfma_f32_16x16x32_bf16 v[48:51], a[244:247], a[88:91], v[48:51]
  v_lshlrev_b32 v92, 16, v92
  v_lshlrev_b32 v93, 16, v93
  v_mfma_f32_16x16x32_bf16 v[52:55], a[244:247], a[96:99], 0
  buffer_load_dwordx4 a[68:71], v115, s[24:27], s8 offen offset:0 sc1
  v_mfma_f32_16x16x32_bf16 v[52:55], a[224:227], a[92:95], v[52:55]
  v_mul_f32 v196, 0xbfb8aa3b, v90
  v_mul_f32 v197, 0xbfb8aa3b, v91
  v_mfma_f32_16x16x32_bf16 v[56:59], a[224:227], a[100:103], 0
  buffer_load_dwordx4 a[176:179], v113, s[24:27], s30 offen offset:1024 sc1
  v_mfma_f32_16x16x32_bf16 v[56:59], a[244:247], a[104:107], v[56:59]
  v_mul_f32 v198, 0xbfb8aa3b, v92
  v_mul_f32 v199, 0xbfb8aa3b, v93
  v_mfma_f32_16x16x32_bf16 v[60:63], a[244:247], a[112:115], 0
  v_exp_f32 v196, v196
  v_mfma_f32_16x16x32_bf16 v[60:63], a[224:227], a[108:111], v[60:63]
  v_exp_f32 v197, v197
  v_mfma_f32_16x16x32_bf16 v[64:67], a[228:231], a[84:87], 0
  s_add_u32 s30, s30, 8192
  buffer_load_dwordx4 a[180:183], v110, s[24:27], s30 offen offset:0 sc1
  v_mfma_f32_16x16x32_bf16 v[64:67], a[248:251], a[88:91], v[64:67]
  v_exp_f32 v198, v198
  v_mfma_f32_16x16x32_bf16 v[68:71], a[248:251], a[96:99], 0
  buffer_load_dwordx4 a[72:75], v115, s[24:27], s8 offen offset:1024 sc1
  v_mfma_f32_16x16x32_bf16 v[68:71], a[228:231], a[92:95], v[68:71]
  v_exp_f32 v199, v199
  v_mfma_f32_16x16x32_bf16 v[72:75], a[228:231], a[100:103], 0
  buffer_load_dwordx4 a[184:187], v110, s[24:27], s30 offen offset:1024 sc1
  v_mfma_f32_16x16x32_bf16 v[72:75], a[248:251], a[104:107], v[72:75]
  v_add_f32 v196, 1.0, v196
  v_add_f32 v197, 1.0, v197
  v_mfma_f32_16x16x32_bf16 v[76:79], a[248:251], a[112:115], 0
  v_add_f32 v198, 1.0, v198
  v_add_f32 v199, 1.0, v199
  v_mfma_f32_16x16x32_bf16 v[76:79], a[228:231], a[108:111], v[76:79]
  v_rcp_f32 v196, v196
  s_waitcnt vmcnt(3)
  v_mfma_f32_16x16x32_bf16 v[0:3], a[252:255], a[116:119], v[0:3]
  buffer_load_dwordx4 a[188:191], v111, s[24:27], s30 offen offset:0 sc1
  v_mfma_f32_16x16x32_bf16 v[0:3], a[144:147], a[120:123], v[0:3]
  v_rcp_f32 v197, v197
  v_mfma_f32_16x16x32_bf16 v[4:7], a[144:147], a[160:163], v[4:7]
  buffer_load_dwordx4 a[76:79], v115, s[24:27], s8 offen offset:2048 sc1
  v_mfma_f32_16x16x32_bf16 v[4:7], a[252:255], a[124:127], v[4:7]
  v_rcp_f32 v198, v198
  v_mfma_f32_16x16x32_bf16 v[8:11], a[252:255], a[164:167], v[8:11]
  buffer_load_dwordx4 a[192:195], v111, s[24:27], s30 offen offset:1024 sc1
  v_mfma_f32_16x16x32_bf16 v[8:11], a[144:147], a[168:171], v[8:11]
  v_rcp_f32 v199, v199
  v_mfma_f32_16x16x32_bf16 v[12:15], a[144:147], a[176:179], v[12:15]
  v_mul_f32 v90, v90, v196
  v_mul_f32 v91, v91, v197
  v_mfma_f32_16x16x32_bf16 v[12:15], a[252:255], a[172:175], v[12:15]
  v_mul_f32 v92, v92, v198
  v_mul_f32 v93, v93, v199
  v_mfma_f32_16x16x32_bf16 v[16:19], a[128:131], a[116:119], v[16:19]
  buffer_load_dwordx4 a[196:199], v112, s[24:27], s30 offen offset:0 sc1
  v_mfma_f32_16x16x32_bf16 v[16:19], a[148:151], a[120:123], v[16:19]
  v_cvt_pk_bf16_f32 v90, v90, v90
  v_cvt_pk_bf16_f32 v91, v91, v91
  v_mfma_f32_16x16x32_bf16 v[20:23], a[148:151], a[160:163], v[20:23]
  buffer_load_dwordx4 a[80:83], v115, s[24:27], s8 offen offset:3072 sc1
  v_mfma_f32_16x16x32_bf16 v[20:23], a[128:131], a[124:127], v[20:23]
  v_cvt_pk_bf16_f32 v92, v92, v92
  v_cvt_pk_bf16_f32 v93, v93, v93
  v_mfma_f32_16x16x32_bf16 v[24:27], a[128:131], a[164:167], v[24:27]
  buffer_load_dwordx4 a[200:203], v112, s[24:27], s30 offen offset:1024 sc1
  v_mfma_f32_16x16x32_bf16 v[24:27], a[148:151], a[168:171], v[24:27]
  v_lshlrev_b32 v90, 16, v90
  v_lshlrev_b32 v91, 16, v91
  v_mfma_f32_16x16x32_bf16 v[28:31], a[148:151], a[176:179], v[28:31]
  v_lshlrev_b32 v92, 16, v92
  v_lshlrev_b32 v93, 16, v93
  v_mfma_f32_16x16x32_bf16 v[28:31], a[128:131], a[172:175], v[28:31]
  v_cvt_pk_bf16_f32 v228, v228, v228
  v_cvt_pk_bf16_f32 v229, v229, v229
  v_mfma_f32_16x16x32_bf16 v[32:35], a[132:135], a[116:119], v[32:35]
  buffer_load_dwordx4 a[204:207], v113, s[24:27], s30 offen offset:0 sc1
  v_mfma_f32_16x16x32_bf16 v[32:35], a[152:155], a[120:123], v[32:35]
  v_cvt_pk_bf16_f32 v230, v230, v230
  v_cvt_pk_bf16_f32 v231, v231, v231
  v_mfma_f32_16x16x32_bf16 v[36:39], a[152:155], a[160:163], v[36:39]
  s_add_u32 m0, s28, 49152
  s_nop 0
  buffer_load_dwordx4 v115, s[24:27], s10 offen offset:0 sc1 lds
  v_mfma_f32_16x16x32_bf16 v[36:39], a[132:135], a[124:127], v[36:39]
  buffer_load_dwordx4 v115, s[24:27], s10 offen offset:1024 sc1 lds
  v_mfma_f32_16x16x32_bf16 v[40:43], a[132:135], a[164:167], v[40:43]
  buffer_load_dwordx4 v115, s[24:27], s10 offen offset:2048 sc1 lds
  v_mfma_f32_16x16x32_bf16 v[40:43], a[152:155], a[168:171], v[40:43]
  buffer_load_dwordx4 v115, s[24:27], s10 offen offset:3072 sc1 lds
  v_mfma_f32_16x16x32_bf16 v[44:47], a[152:155], a[176:179], v[44:47]
  buffer_load_dwordx4 a[208:211], v113, s[24:27], s30 offen offset:1024 sc1
  v_mfma_f32_16x16x32_bf16 v[44:47], a[132:135], a[172:175], v[44:47]
  v_lshlrev_b32 v228, 16, v228
  v_lshlrev_b32 v229, 16, v229
  v_mfma_f32_16x16x32_bf16 v[48:51], a[136:139], a[116:119], v[48:51]
  s_add_u32 s30, s30, 8192
  buffer_load_dwordx4 v[244:247], v110, s[24:27], s30 offen offset:0 sc1
  v_mfma_f32_16x16x32_bf16 v[48:51], a[156:159], a[120:123], v[48:51]
  v_lshlrev_b32 v230, 16, v230
  v_lshlrev_b32 v231, 16, v231
  v_mfma_f32_16x16x32_bf16 v[52:55], a[156:159], a[160:163], v[52:55]
  v_mul_f32 v228, v228, v124
  v_mul_f32 v229, v229, v124
  v_mfma_f32_16x16x32_bf16 v[52:55], a[136:139], a[124:127], v[52:55]
  v_mul_f32 v230, v230, v124
  v_mul_f32 v231, v231, v124
  v_mfma_f32_16x16x32_bf16 v[56:59], a[136:139], a[164:167], v[56:59]
  buffer_load_dwordx4 v[248:251], v110, s[24:27], s30 offen offset:1024 sc1
  v_mfma_f32_16x16x32_bf16 v[56:59], a[156:159], a[168:171], v[56:59]
  v_cvt_pk_bf16_f32 v228, v228, v228
  v_cvt_pk_bf16_f32 v229, v229, v229
  v_mfma_f32_16x16x32_bf16 v[60:63], a[156:159], a[176:179], v[60:63]
  v_cvt_pk_bf16_f32 v230, v230, v230
  v_cvt_pk_bf16_f32 v231, v231, v231
  v_mfma_f32_16x16x32_bf16 v[60:63], a[136:139], a[172:175], v[60:63]
  v_lshlrev_b32 v228, 16, v228
  v_lshlrev_b32 v229, 16, v229
  v_mfma_f32_16x16x32_bf16 v[64:67], a[140:143], a[116:119], v[64:67]
  buffer_load_dwordx4 v[252:255], v111, s[24:27], s30 offen offset:0 sc1
  v_mfma_f32_16x16x32_bf16 v[64:67], v[128:131], a[120:123], v[64:67]
  v_lshlrev_b32 v230, 16, v230
  v_lshlrev_b32 v231, 16, v231
  v_mfma_f32_16x16x32_bf16 v[68:71], v[128:131], a[160:163], v[68:71]
  v_add_f32 v94, v94, v228
  v_add_f32 v95, v95, v229
  v_mfma_f32_16x16x32_bf16 v[68:71], a[140:143], a[124:127], v[68:71]
  v_add_f32 v96, v96, v230
  v_add_f32 v97, v97, v231
  v_mfma_f32_16x16x32_bf16 v[72:75], a[140:143], a[164:167], v[72:75]
  buffer_load_dwordx4 v[204:207], v111, s[24:27], s30 offen offset:1024 sc1
  v_mfma_f32_16x16x32_bf16 v[72:75], v[128:131], a[168:171], v[72:75]
  v_cvt_pk_bf16_f32 v94, v94, v94
  v_cvt_pk_bf16_f32 v95, v95, v95
  v_mfma_f32_16x16x32_bf16 v[76:79], v[128:131], a[176:179], v[76:79]
  v_cvt_pk_bf16_f32 v96, v96, v96
  v_cvt_pk_bf16_f32 v97, v97, v97
  v_mfma_f32_16x16x32_bf16 v[76:79], a[140:143], a[172:175], v[76:79]
  v_lshlrev_b32 v94, 16, v94
  v_lshlrev_b32 v95, 16, v95
  s_waitcnt vmcnt(4)
  v_mfma_f32_16x16x32_bf16 v[0:3], v[132:135], a[180:183], v[0:3]
  buffer_load_dwordx4 v[208:211], v112, s[24:27], s30 offen offset:0 sc1
  v_mfma_f32_16x16x32_bf16 v[0:3], v[152:155], a[184:187], v[0:3]
  v_lshlrev_b32 v96, 16, v96
  v_lshlrev_b32 v97, 16, v97
  v_mfma_f32_16x16x32_bf16 v[4:7], v[152:155], a[192:195], v[4:7]
  v_mul_f32 v196, 0xbfb8aa3b, v94
  v_mul_f32 v197, 0xbfb8aa3b, v95
  v_mfma_f32_16x16x32_bf16 v[4:7], v[132:135], a[188:191], v[4:7]
  v_mul_f32 v198, 0xbfb8aa3b, v96
  v_mul_f32 v199, 0xbfb8aa3b, v97
  v_mfma_f32_16x16x32_bf16 v[8:11], v[132:135], a[196:199], v[8:11]
  buffer_load_dwordx4 v[212:215], v112, s[24:27], s30 offen offset:1024 sc1
  v_mfma_f32_16x16x32_bf16 v[8:11], v[152:155], a[200:203], v[8:11]
  v_exp_f32 v196, v196
  v_mfma_f32_16x16x32_bf16 v[12:15], v[152:155], a[208:211], v[12:15]
  v_exp_f32 v197, v197
  v_mfma_f32_16x16x32_bf16 v[12:15], v[132:135], a[204:207], v[12:15]
  v_exp_f32 v198, v198
  v_mfma_f32_16x16x32_bf16 v[16:19], v[136:139], a[180:183], v[16:19]
  buffer_load_dwordx4 v[216:219], v113, s[24:27], s30 offen offset:0 sc1
  v_mfma_f32_16x16x32_bf16 v[16:19], v[156:159], a[184:187], v[16:19]
  v_exp_f32 v199, v199
  v_mfma_f32_16x16x32_bf16 v[20:23], v[156:159], a[192:195], v[20:23]
  v_add_f32 v196, 1.0, v196
  v_add_f32 v197, 1.0, v197
  v_mfma_f32_16x16x32_bf16 v[20:23], v[136:139], a[188:191], v[20:23]
  v_add_f32 v198, 1.0, v198
  v_add_f32 v199, 1.0, v199
  v_mfma_f32_16x16x32_bf16 v[24:27], v[136:139], a[196:199], v[24:27]
  buffer_load_dwordx4 v[220:223], v113, s[24:27], s30 offen offset:1024 sc1
  v_mfma_f32_16x16x32_bf16 v[24:27], v[156:159], a[200:203], v[24:27]
  v_rcp_f32 v196, v196
  v_mfma_f32_16x16x32_bf16 v[28:31], v[156:159], a[208:211], v[28:31]
  v_rcp_f32 v197, v197
  v_mfma_f32_16x16x32_bf16 v[28:31], v[136:139], a[204:207], v[28:31]
  v_rcp_f32 v198, v198
  v_mfma_f32_16x16x32_bf16 v[32:35], v[140:143], a[180:183], v[32:35]
  s_add_u32 s30, s30, 8192
  buffer_load_dwordx4 a[84:87], v110, s[24:27], s30 offen offset:0 sc1
  v_mfma_f32_16x16x32_bf16 v[32:35], v[160:163], a[184:187], v[32:35]
  v_rcp_f32 v199, v199
  v_mfma_f32_16x16x32_bf16 v[36:39], v[160:163], a[192:195], v[36:39]
  v_mul_f32 v94, v94, v196
  v_mul_f32 v95, v95, v197
  v_mfma_f32_16x16x32_bf16 v[36:39], v[140:143], a[188:191], v[36:39]
  v_mul_f32 v96, v96, v198
  v_mul_f32 v97, v97, v199
  v_mfma_f32_16x16x32_bf16 v[40:43], v[140:143], a[196:199], v[40:43]
  buffer_load_dwordx4 a[88:91], v110, s[24:27], s30 offen offset:1024 sc1
  v_mfma_f32_16x16x32_bf16 v[40:43], v[160:163], a[200:203], v[40:43]
  v_cvt_pk_bf16_f32 v94, v94, v94
  v_cvt_pk_bf16_f32 v95, v95, v95
  v_mfma_f32_16x16x32_bf16 v[44:47], v[160:163], a[208:211], v[44:47]
  v_cvt_pk_bf16_f32 v96, v96, v96
  v_cvt_pk_bf16_f32 v97, v97, v97
  v_mfma_f32_16x16x32_bf16 v[44:47], v[140:143], a[204:207], v[44:47]
  v_lshlrev_b32 v94, 16, v94
  v_lshlrev_b32 v95, 16, v95
  v_mfma_f32_16x16x32_bf16 v[48:51], v[144:147], a[180:183], v[48:51]
  buffer_load_dwordx4 a[92:95], v111, s[24:27], s30 offen offset:0 sc1
  v_mfma_f32_16x16x32_bf16 v[48:51], v[164:167], a[184:187], v[48:51]
  v_lshlrev_b32 v96, 16, v96
  v_lshlrev_b32 v97, 16, v97
  v_mfma_f32_16x16x32_bf16 v[52:55], v[164:167], a[192:195], v[52:55]
  v_cvt_pk_bf16_f32 v232, v232, v232
  v_cvt_pk_bf16_f32 v233, v233, v233
  v_mfma_f32_16x16x32_bf16 v[52:55], v[144:147], a[188:191], v[52:55]
  v_cvt_pk_bf16_f32 v234, v234, v234
  v_cvt_pk_bf16_f32 v235, v235, v235
  v_mfma_f32_16x16x32_bf16 v[56:59], v[144:147], a[196:199], v[56:59]
  buffer_load_dwordx4 a[96:99], v111, s[24:27], s30 offen offset:1024 sc1
  v_mfma_f32_16x16x32_bf16 v[56:59], v[164:167], a[200:203], v[56:59]
  v_lshlrev_b32 v232, 16, v232
  v_lshlrev_b32 v233, 16, v233
  v_mfma_f32_16x16x32_bf16 v[60:63], v[164:167], a[208:211], v[60:63]
  v_lshlrev_b32 v234, 16, v234
  v_lshlrev_b32 v235, 16, v235
  v_mfma_f32_16x16x32_bf16 v[60:63], v[144:147], a[204:207], v[60:63]
  v_mul_f32 v232, v232, v124
  v_mul_f32 v233, v233, v124
  v_mfma_f32_16x16x32_bf16 v[64:67], v[148:151], a[180:183], v[64:67]
  buffer_load_dwordx4 a[100:103], v112, s[24:27], s30 offen offset:0 sc1
  v_mfma_f32_16x16x32_bf16 v[64:67], v[168:171], a[184:187], v[64:67]
  v_mul_f32 v234, v234, v124
  v_mul_f32 v235, v235, v124
  v_mfma_f32_16x16x32_bf16 v[68:71], v[168:171], a[192:195], v[68:71]
  v_cvt_pk_bf16_f32 v232, v232, v232
  v_cvt_pk_bf16_f32 v233, v233, v233
  v_mfma_f32_16x16x32_bf16 v[68:71], v[148:151], a[188:191], v[68:71]
  v_cvt_pk_bf16_f32 v234, v234, v234
  v_cvt_pk_bf16_f32 v235, v235, v235
  v_mfma_f32_16x16x32_bf16 v[72:75], v[148:151], a[196:199], v[72:75]
  buffer_load_dwordx4 a[104:107], v112, s[24:27], s30 offen offset:1024 sc1
  v_mfma_f32_16x16x32_bf16 v[72:75], v[168:171], a[200:203], v[72:75]
  v_lshlrev_b32 v232, 16, v232
  v_lshlrev_b32 v233, 16, v233
  v_mfma_f32_16x16x32_bf16 v[76:79], v[168:171], a[208:211], v[76:79]
  v_lshlrev_b32 v234, 16, v234
  v_lshlrev_b32 v235, 16, v235
  v_mfma_f32_16x16x32_bf16 v[76:79], v[148:151], a[204:207], v[76:79]
  v_add_f32 v98, v98, v232
  v_add_f32 v99, v99, v233
  s_waitcnt vmcnt(6)
  v_mfma_f32_16x16x32_bf16 v[0:3], v[172:175], v[244:247], v[0:3]
  buffer_load_dwordx4 a[108:111], v113, s[24:27], s30 offen offset:0 sc1
  v_mfma_f32_16x16x32_bf16 v[0:3], a[0:3], v[248:251], v[0:3]
  v_add_f32 v100, v100, v234
  v_add_f32 v101, v101, v235
  v_mfma_f32_16x16x32_bf16 v[4:7], a[0:3], v[204:207], v[4:7]
  v_cvt_pk_bf16_f32 v98, v98, v98
  v_cvt_pk_bf16_f32 v99, v99, v99
  v_mfma_f32_16x16x32_bf16 v[4:7], v[172:175], v[252:255], v[4:7]
  v_cvt_pk_bf16_f32 v100, v100, v100
  v_cvt_pk_bf16_f32 v101, v101, v101
  v_mfma_f32_16x16x32_bf16 v[8:11], v[172:175], v[208:211], v[8:11]
  buffer_load_dwordx4 a[112:115], v113, s[24:27], s30 offen offset:1024 sc1
  v_mfma_f32_16x16x32_bf16 v[8:11], a[0:3], v[212:215], v[8:11]
  v_lshlrev_b32 v98, 16, v98
  v_lshlrev_b32 v99, 16, v99
  v_mfma_f32_16x16x32_bf16 v[12:15], a[0:3], v[220:223], v[12:15]
  v_lshlrev_b32 v100, 16, v100
  v_lshlrev_b32 v101, 16, v101
  v_mfma_f32_16x16x32_bf16 v[12:15], v[172:175], v[216:219], v[12:15]
  v_mul_f32 v196, 0xbfb8aa3b, v98
  v_mul_f32 v197, 0xbfb8aa3b, v99
  v_mfma_f32_16x16x32_bf16 v[16:19], v[176:179], v[244:247], v[16:19]
  s_add_u32 s30, s30, 8192
  buffer_load_dwordx4 a[116:119], v110, s[24:27], s30 offen offset:0 sc1
  v_mfma_f32_16x16x32_bf16 v[16:19], a[4:7], v[248:251], v[16:19]
  v_mul_f32 v198, 0xbfb8aa3b, v100
  v_mul_f32 v199, 0xbfb8aa3b, v101
  v_mfma_f32_16x16x32_bf16 v[20:23], a[4:7], v[204:207], v[20:23]
  v_exp_f32 v196, v196
  v_mfma_f32_16x16x32_bf16 v[20:23], v[176:179], v[252:255], v[20:23]
  v_exp_f32 v197, v197
  v_mfma_f32_16x16x32_bf16 v[24:27], v[176:179], v[208:211], v[24:27]
  buffer_load_dwordx4 a[120:123], v110, s[24:27], s30 offen offset:1024 sc1
  v_mfma_f32_16x16x32_bf16 v[24:27], a[4:7], v[212:215], v[24:27]
  v_exp_f32 v198, v198
  v_mfma_f32_16x16x32_bf16 v[28:31], a[4:7], v[220:223], v[28:31]
  v_exp_f32 v199, v199
  v_mfma_f32_16x16x32_bf16 v[28:31], v[176:179], v[216:219], v[28:31]
  v_add_f32 v196, 1.0, v196
  v_add_f32 v197, 1.0, v197
  v_mfma_f32_16x16x32_bf16 v[32:35], v[180:183], v[244:247], v[32:35]
  buffer_load_dwordx4 a[124:127], v111, s[24:27], s30 offen offset:0 sc1
  v_mfma_f32_16x16x32_bf16 v[32:35], a[8:11], v[248:251], v[32:35]
  v_add_f32 v198, 1.0, v198
  v_add_f32 v199, 1.0, v199
  v_mfma_f32_16x16x32_bf16 v[36:39], a[8:11], v[204:207], v[36:39]
  v_rcp_f32 v196, v196
  v_mfma_f32_16x16x32_bf16 v[36:39], v[180:183], v[252:255], v[36:39]
  v_rcp_f32 v197, v197
  v_mfma_f32_16x16x32_bf16 v[40:43], v[180:183], v[208:211], v[40:43]
  buffer_load_dwordx4 a[160:163], v111, s[24:27], s30 offen offset:1024 sc1
  v_mfma_f32_16x16x32_bf16 v[40:43], a[8:11], v[212:215], v[40:43]
  v_rcp_f32 v198, v198
  v_mfma_f32_16x16x32_bf16 v[44:47], a[8:11], v[220:223], v[44:47]
  v_rcp_f32 v199, v199
  v_mfma_f32_16x16x32_bf16 v[44:47], v[180:183], v[216:219], v[44:47]
  v_mul_f32 v98, v98, v196
  v_mul_f32 v99, v99, v197
  v_mfma_f32_16x16x32_bf16 v[48:51], v[184:187], v[244:247], v[48:51]
  buffer_load_dwordx4 a[164:167], v112, s[24:27], s30 offen offset:0 sc1
  v_mfma_f32_16x16x32_bf16 v[48:51], a[12:15], v[248:251], v[48:51]
  v_mul_f32 v100, v100, v198
  v_mul_f32 v101, v101, v199
  v_mfma_f32_16x16x32_bf16 v[52:55], a[12:15], v[204:207], v[52:55]
  v_cvt_pk_bf16_f32 v98, v98, v98
  v_cvt_pk_bf16_f32 v99, v99, v99
  v_mfma_f32_16x16x32_bf16 v[52:55], v[184:187], v[252:255], v[52:55]
  v_cvt_pk_bf16_f32 v100, v100, v100
  v_cvt_pk_bf16_f32 v101, v101, v101
  v_mfma_f32_16x16x32_bf16 v[56:59], v[184:187], v[208:211], v[56:59]
  buffer_load_dwordx4 a[168:171], v112, s[24:27], s30 offen offset:1024 sc1
  v_mfma_f32_16x16x32_bf16 v[56:59], a[12:15], v[212:215], v[56:59]
  v_lshlrev_b32 v98, 16, v98
  v_lshlrev_b32 v99, 16, v99
  v_mfma_f32_16x16x32_bf16 v[60:63], a[12:15], v[220:223], v[60:63]
  v_lshlrev_b32 v100, 16, v100
  v_lshlrev_b32 v101, 16, v101
  v_mfma_f32_16x16x32_bf16 v[60:63], v[184:187], v[216:219], v[60:63]
  v_cvt_pk_bf16_f32 v236, v236, v236
  v_cvt_pk_bf16_f32 v237, v237, v237
  v_mfma_f32_16x16x32_bf16 v[64:67], v[188:191], v[244:247], v[64:67]
  buffer_load_dwordx4 a[172:175], v113, s[24:27], s30 offen offset:0 sc1
  v_mfma_f32_16x16x32_bf16 v[64:67], a[16:19], v[248:251], v[64:67]
  v_cvt_pk_bf16_f32 v238, v238, v238
  v_cvt_pk_bf16_f32 v239, v239, v239
  v_mfma_f32_16x16x32_bf16 v[68:71], a[16:19], v[204:207], v[68:71]
  v_lshlrev_b32 v236, 16, v236
  v_lshlrev_b32 v237, 16, v237
  v_mfma_f32_16x16x32_bf16 v[68:71], v[188:191], v[252:255], v[68:71]
  v_lshlrev_b32 v238, 16, v238
  v_lshlrev_b32 v239, 16, v239
  v_mfma_f32_16x16x32_bf16 v[72:75], v[188:191], v[208:211], v[72:75]
  buffer_load_dwordx4 a[176:179], v113, s[24:27], s30 offen offset:1024 sc1
  v_mfma_f32_16x16x32_bf16 v[72:75], a[16:19], v[212:215], v[72:75]
  v_mul_f32 v236, v236, v124
  v_mul_f32 v237, v237, v124
  v_mfma_f32_16x16x32_bf16 v[76:79], a[16:19], v[220:223], v[76:79]
  v_mul_f32 v238, v238, v124
  v_mul_f32 v239, v239, v124
  v_mfma_f32_16x16x32_bf16 v[76:79], v[188:191], v[216:219], v[76:79]
  v_cvt_pk_bf16_f32 v236, v236, v236
  v_cvt_pk_bf16_f32 v237, v237, v237
  s_waitcnt vmcnt(8)
  v_mfma_f32_16x16x32_bf16 v[0:3], a[20:23], a[84:87], v[0:3]
  s_add_u32 s30, s30, 8192
  buffer_load_dwordx4 a[180:183], v110, s[24:27], s30 offen offset:0 sc1
  v_mfma_f32_16x16x32_bf16 v[0:3], a[40:43], a[88:91], v[0:3]
  v_cvt_pk_bf16_f32 v238, v238, v238
  v_cvt_pk_bf16_f32 v239, v239, v239
  v_mfma_f32_16x16x32_bf16 v[4:7], a[40:43], a[96:99], v[4:7]
  v_lshlrev_b32 v236, 16, v236
  v_lshlrev_b32 v237, 16, v237
  v_mfma_f32_16x16x32_bf16 v[4:7], a[20:23], a[92:95], v[4:7]
  v_lshlrev_b32 v238, 16, v238
  v_lshlrev_b32 v239, 16, v239
  v_mfma_f32_16x16x32_bf16 v[8:11], a[20:23], a[100:103], v[8:11]
  buffer_load_dwordx4 a[184:187], v110, s[24:27], s30 offen offset:1024 sc1
  v_mfma_f32_16x16x32_bf16 v[8:11], a[40:43], a[104:107], v[8:11]
  v_add_f32 v102, v102, v236
  v_add_f32 v103, v103, v237
  v_mfma_f32_16x16x32_bf16 v[12:15], a[40:43], a[112:115], v[12:15]
  v_add_f32 v104, v104, v238
  v_add_f32 v105, v105, v239
  v_mfma_f32_16x16x32_bf16 v[12:15], a[20:23], a[108:111], v[12:15]
  v_cvt_pk_bf16_f32 v102, v102, v102
  v_cvt_pk_bf16_f32 v103, v103, v103
  v_mfma_f32_16x16x32_bf16 v[16:19], a[24:27], a[84:87], v[16:19]
  buffer_load_dwordx4 a[188:191], v111, s[24:27], s30 offen offset:0 sc1
  v_mfma_f32_16x16x32_bf16 v[16:19], a[44:47], a[88:91], v[16:19]
  v_cvt_pk_bf16_f32 v104, v104, v104
  v_cvt_pk_bf16_f32 v105, v105, v105
  v_mfma_f32_16x16x32_bf16 v[20:23], a[44:47], a[96:99], v[20:23]
  v_lshlrev_b32 v102, 16, v102
  v_lshlrev_b32 v103, 16, v103
  v_mfma_f32_16x16x32_bf16 v[20:23], a[24:27], a[92:95], v[20:23]
  v_lshlrev_b32 v104, 16, v104
  v_lshlrev_b32 v105, 16, v105
  v_mfma_f32_16x16x32_bf16 v[24:27], a[24:27], a[100:103], v[24:27]
  buffer_load_dwordx4 a[192:195], v111, s[24:27], s30 offen offset:1024 sc1
  v_mfma_f32_16x16x32_bf16 v[24:27], a[44:47], a[104:107], v[24:27]
  v_mul_f32 v196, 0xbfb8aa3b, v102
  v_mul_f32 v197, 0xbfb8aa3b, v103
  v_mfma_f32_16x16x32_bf16 v[28:31], a[44:47], a[112:115], v[28:31]
  v_mul_f32 v198, 0xbfb8aa3b, v104
  v_mul_f32 v199, 0xbfb8aa3b, v105
  v_mfma_f32_16x16x32_bf16 v[28:31], a[24:27], a[108:111], v[28:31]
  v_exp_f32 v196, v196
  v_mfma_f32_16x16x32_bf16 v[32:35], a[28:31], a[84:87], v[32:35]
  buffer_load_dwordx4 a[196:199], v112, s[24:27], s30 offen offset:0 sc1
  v_mfma_f32_16x16x32_bf16 v[32:35], a[48:51], a[88:91], v[32:35]
  v_exp_f32 v197, v197
  v_mfma_f32_16x16x32_bf16 v[36:39], a[48:51], a[96:99], v[36:39]
  v_exp_f32 v198, v198
  v_mfma_f32_16x16x32_bf16 v[36:39], a[28:31], a[92:95], v[36:39]
  v_exp_f32 v199, v199
  v_mfma_f32_16x16x32_bf16 v[40:43], a[28:31], a[100:103], v[40:43]
  buffer_load_dwordx4 a[200:203], v112, s[24:27], s30 offen offset:1024 sc1
  v_mfma_f32_16x16x32_bf16 v[40:43], a[48:51], a[104:107], v[40:43]
  v_add_f32 v196, 1.0, v196
  v_add_f32 v197, 1.0, v197
  v_mfma_f32_16x16x32_bf16 v[44:47], a[48:51], a[112:115], v[44:47]
  v_add_f32 v198, 1.0, v198
  v_add_f32 v199, 1.0, v199
  v_mfma_f32_16x16x32_bf16 v[44:47], a[28:31], a[108:111], v[44:47]
  v_rcp_f32 v196, v196
  v_mfma_f32_16x16x32_bf16 v[48:51], a[32:35], a[84:87], v[48:51]
  buffer_load_dwordx4 a[204:207], v113, s[24:27], s30 offen offset:0 sc1
  v_mfma_f32_16x16x32_bf16 v[48:51], a[52:55], a[88:91], v[48:51]
  v_rcp_f32 v197, v197
  v_mfma_f32_16x16x32_bf16 v[52:55], a[52:55], a[96:99], v[52:55]
  v_rcp_f32 v198, v198
  v_mfma_f32_16x16x32_bf16 v[52:55], a[32:35], a[92:95], v[52:55]
  v_rcp_f32 v199, v199
  v_mfma_f32_16x16x32_bf16 v[56:59], a[32:35], a[100:103], v[56:59]
  buffer_load_dwordx4 a[208:211], v113, s[24:27], s30 offen offset:1024 sc1
  v_mfma_f32_16x16x32_bf16 v[56:59], a[52:55], a[104:107], v[56:59]
  v_mul_f32 v102, v102, v196
  v_mul_f32 v103, v103, v197
  v_mfma_f32_16x16x32_bf16 v[60:63], a[52:55], a[112:115], v[60:63]
  v_mul_f32 v104, v104, v198
  v_mul_f32 v105, v105, v199
  v_mfma_f32_16x16x32_bf16 v[60:63], a[32:35], a[108:111], v[60:63]
  v_cvt_pk_bf16_f32 v102, v102, v102
  v_cvt_pk_bf16_f32 v103, v103, v103
  v_mfma_f32_16x16x32_bf16 v[64:67], a[36:39], a[84:87], v[64:67]
  ds_read_b128 v[244:247], v122 offset:0
  s_add_u32 s30, s30, 8192
  v_cvt_pk_bf16_f32 v104, v104, v104
  v_mfma_f32_16x16x32_bf16 v[64:67], a[56:59], a[88:91], v[64:67]
  buffer_load_dwordx4 v[248:251], v110, s[24:27], s30 offen offset:0 sc1
  v_mfma_f32_16x16x32_bf16 v[68:71], a[56:59], a[96:99], v[68:71]
  v_cvt_pk_bf16_f32 v105, v105, v105
  v_lshlrev_b32 v102, 16, v102
  v_mfma_f32_16x16x32_bf16 v[68:71], a[36:39], a[92:95], v[68:71]
  v_lshlrev_b32 v103, 16, v103
  v_lshlrev_b32 v104, 16, v104
  v_mfma_f32_16x16x32_bf16 v[72:75], a[36:39], a[100:103], v[72:75]
  buffer_load_dwordx4 v[252:255], v110, s[24:27], s30 offen offset:1024 sc1
  v_mfma_f32_16x16x32_bf16 v[72:75], a[56:59], a[104:107], v[72:75]
  v_lshlrev_b32 v105, 16, v105
  v_cvt_pk_bf16_f32 v240, v240, v240
  v_mfma_f32_16x16x32_bf16 v[76:79], a[56:59], a[112:115], v[76:79]
  v_cvt_pk_bf16_f32 v241, v241, v241
  v_cvt_pk_bf16_f32 v242, v242, v242
  v_mfma_f32_16x16x32_bf16 v[76:79], a[36:39], a[108:111], v[76:79]
  v_cvt_pk_bf16_f32 v243, v243, v243
  v_lshlrev_b32 v240, 16, v240
  s_waitcnt vmcnt(10)
  v_mfma_f32_16x16x32_bf16 v[0:3], a[60:63], a[116:119], v[0:3]
  ds_read_b128 v[204:207], v122 offset:1024
  v_lshlrev_b32 v241, 16, v241
  v_mfma_f32_16x16x32_bf16 v[0:3], a[80:83], a[120:123], v[0:3]
  buffer_load_dwordx4 v[208:211], v111, s[24:27], s30 offen offset:0 sc1
  v_mfma_f32_16x16x32_bf16 v[4:7], a[80:83], a[160:163], v[4:7]
  v_lshlrev_b32 v242, 16, v242
  v_lshlrev_b32 v243, 16, v243
  v_mfma_f32_16x16x32_bf16 v[4:7], a[60:63], a[124:127], v[4:7]
  v_mul_f32 v240, v240, v124
  v_mul_f32 v241, v241, v124
  v_mfma_f32_16x16x32_bf16 v[8:11], a[60:63], a[164:167], v[8:11]
  buffer_load_dwordx4 v[212:215], v111, s[24:27], s30 offen offset:1024 sc1
  v_mfma_f32_16x16x32_bf16 v[8:11], a[80:83], a[168:171], v[8:11]
  v_mul_f32 v242, v242, v124
  v_mul_f32 v243, v243, v124
  v_mfma_f32_16x16x32_bf16 v[12:15], a[80:83], a[176:179], v[12:15]
  v_cvt_pk_bf16_f32 v240, v240, v240
  v_cvt_pk_bf16_f32 v241, v241, v241
  v_mfma_f32_16x16x32_bf16 v[12:15], a[60:63], a[172:175], v[12:15]
  v_cvt_pk_bf16_f32 v242, v242, v242
  v_cvt_pk_bf16_f32 v243, v243, v243
  s_waitcnt lgkmcnt(1)
  v_mfma_f32_16x16x32_bf16 v[16:19], a[64:67], a[116:119], v[16:19]
  ds_read_b128 v[216:219], v122 offset:2048
  v_lshlrev_b32 v240, 16, v240
  v_mfma_f32_16x16x32_bf16 v[16:19], v[244:247], a[120:123], v[16:19]
  buffer_load_dwordx4 v[220:223], v112, s[24:27], s30 offen offset:0 sc1
  v_mfma_f32_16x16x32_bf16 v[20:23], v[244:247], a[160:163], v[20:23]
  v_lshlrev_b32 v241, 16, v241
  v_lshlrev_b32 v242, 16, v242
  v_mfma_f32_16x16x32_bf16 v[20:23], a[64:67], a[124:127], v[20:23]
  v_lshlrev_b32 v243, 16, v243
  v_add_f32 v106, v106, v240
  v_mfma_f32_16x16x32_bf16 v[24:27], a[64:67], a[164:167], v[24:27]
  buffer_load_dwordx4 a[84:87], v112, s[24:27], s30 offen offset:1024 sc1
  v_mfma_f32_16x16x32_bf16 v[24:27], v[244:247], a[168:171], v[24:27]
  v_add_f32 v107, v107, v241
  v_add_f32 v108, v108, v242
  v_mfma_f32_16x16x32_bf16 v[28:31], v[244:247], a[176:179], v[28:31]
  v_add_f32 v109, v109, v243
  v_cvt_pk_bf16_f32 v106, v106, v106
  v_mfma_f32_16x16x32_bf16 v[28:31], a[64:67], a[172:175], v[28:31]
  v_cvt_pk_bf16_f32 v107, v107, v107
  v_cvt_pk_bf16_f32 v108, v108, v108
  s_waitcnt lgkmcnt(1)
  v_mfma_f32_16x16x32_bf16 v[32:35], a[68:71], a[116:119], v[32:35]
  ds_read_b128 a[88:91], v122 offset:3072
  v_cvt_pk_bf16_f32 v109, v109, v109
  v_mfma_f32_16x16x32_bf16 v[32:35], v[204:207], a[120:123], v[32:35]
  buffer_load_dwordx4 a[92:95], v113, s[24:27], s30 offen offset:0 sc1
  v_mfma_f32_16x16x32_bf16 v[36:39], v[204:207], a[160:163], v[36:39]
  v_lshlrev_b32 v106, 16, v106
  v_lshlrev_b32 v107, 16, v107
  v_mfma_f32_16x16x32_bf16 v[36:39], a[68:71], a[124:127], v[36:39]
  v_lshlrev_b32 v108, 16, v108
  v_lshlrev_b32 v109, 16, v109
  v_mfma_f32_16x16x32_bf16 v[40:43], a[68:71], a[164:167], v[40:43]
  buffer_load_dwordx4 a[96:99], v113, s[24:27], s30 offen offset:1024 sc1
  v_mfma_f32_16x16x32_bf16 v[40:43], v[204:207], a[168:171], v[40:43]
  v_mul_f32 v196, 0xbfb8aa3b, v106
  v_mul_f32 v197, 0xbfb8aa3b, v107
  v_mfma_f32_16x16x32_bf16 v[44:47], v[204:207], a[176:179], v[44:47]
  v_mul_f32 v198, 0xbfb8aa3b, v108
  v_mul_f32 v199, 0xbfb8aa3b, v109
  v_mfma_f32_16x16x32_bf16 v[44:47], a[68:71], a[172:175], v[44:47]
  v_exp_f32 v196, v196
  s_waitcnt lgkmcnt(1)
  v_mfma_f32_16x16x32_bf16 v[48:51], a[72:75], a[116:119], v[48:51]
  ds_read_b128 a[100:103], v122 offset:16384
  ds_read_b128 a[104:107], v122 offset:33792
  s_mov_b32 s30, s37
  v_mfma_f32_16x16x32_bf16 v[48:51], v[216:219], a[120:123], v[48:51]
  buffer_load_dwordx4 a[108:111], v110, s[24:27], s30 offen offset:0 sc1
  v_mfma_f32_16x16x32_bf16 v[52:55], v[216:219], a[160:163], v[52:55]
  v_exp_f32 v197, v197
  v_mfma_f32_16x16x32_bf16 v[52:55], a[72:75], a[124:127], v[52:55]
  v_exp_f32 v198, v198
  v_mfma_f32_16x16x32_bf16 v[56:59], a[72:75], a[164:167], v[56:59]
  buffer_load_dwordx4 a[112:115], v110, s[24:27], s30 offen offset:1024 sc1
  v_mfma_f32_16x16x32_bf16 v[56:59], v[216:219], a[168:171], v[56:59]
  v_exp_f32 v199, v199
  v_mfma_f32_16x16x32_bf16 v[60:63], v[216:219], a[176:179], v[60:63]
  v_add_f32 v196, 1.0, v196
  v_add_f32 v197, 1.0, v197
  v_mfma_f32_16x16x32_bf16 v[60:63], a[72:75], a[172:175], v[60:63]
  v_add_f32 v198, 1.0, v198
  v_add_f32 v199, 1.0, v199
  s_waitcnt lgkmcnt(2)
  v_mfma_f32_16x16x32_bf16 v[64:67], a[76:79], a[116:119], v[64:67]
  ds_read_b128 v[244:247], v122 offset:17408
  ds_read_b128 v[204:207], v122 offset:34816
  v_mfma_f32_16x16x32_bf16 v[64:67], a[88:91], a[120:123], v[64:67]
  v_rcp_f32 v196, v196
  v_mfma_f32_16x16x32_bf16 v[68:71], a[88:91], a[160:163], v[68:71]
  v_rcp_f32 v197, v197
  v_mfma_f32_16x16x32_bf16 v[68:71], a[76:79], a[124:127], v[68:71]
  v_rcp_f32 v198, v198
  v_mfma_f32_16x16x32_bf16 v[72:75], a[76:79], a[164:167], v[72:75]
  v_rcp_f32 v199, v199
  v_mfma_f32_16x16x32_bf16 v[72:75], a[88:91], a[168:171], v[72:75]
  v_mul_f32 v106, v106, v196
  v_mul_f32 v107, v107, v197
  v_mfma_f32_16x16x32_bf16 v[76:79], a[88:91], a[176:179], v[76:79]
  v_mul_f32 v108, v108, v198
  v_mul_f32 v109, v109, v199
  v_mfma_f32_16x16x32_bf16 v[76:79], a[76:79], a[172:175], v[76:79]
  v_cvt_pk_bf16_f32 v106, v106, v106
  v_cvt_pk_bf16_f32 v107, v107, v107
  s_waitcnt vmcnt(10) lgkmcnt(2)
  v_mfma_f32_16x16x32_bf16 v[0:3], a[100:103], a[180:183], v[0:3]
  ds_read_b128 v[216:219], v122 offset:18432
  ds_read_b128 a[88:91], v122 offset:35840
  v_mfma_f32_16x16x32_bf16 v[0:3], a[104:107], a[184:187], v[0:3]
  buffer_load_dwordx4 a[116:119], v111, s[24:27], s30 offen offset:0 sc1
  v_mfma_f32_16x16x32_bf16 v[4:7], a[104:107], a[192:195], v[4:7]
  v_cvt_pk_bf16_f32 v108, v108, v108
  v_cvt_pk_bf16_f32 v109, v109, v109
  v_mfma_f32_16x16x32_bf16 v[4:7], a[100:103], a[188:191], v[4:7]
  v_lshlrev_b32 v106, 16, v106
  v_lshlrev_b32 v107, 16, v107
  v_mfma_f32_16x16x32_bf16 v[8:11], a[100:103], a[196:199], v[8:11]
  buffer_load_dwordx4 a[120:123], v111, s[24:27], s30 offen offset:1024 sc1
  v_mfma_f32_16x16x32_bf16 v[8:11], a[104:107], a[200:203], v[8:11]
  v_lshlrev_b32 v108, 16, v108
  v_lshlrev_b32 v109, 16, v109
  v_mfma_f32_16x16x32_bf16 v[12:15], a[104:107], a[208:211], v[12:15]
  v_lshlrev_b32 v224, 16, v80
  v_and_b32 v225, s34, v80
  v_mfma_f32_16x16x32_bf16 v[12:15], a[100:103], a[204:207], v[12:15]
  v_lshlrev_b32 v226, 16, v81
  v_and_b32 v227, s34, v81
  s_waitcnt lgkmcnt(2)
  v_mfma_f32_16x16x32_bf16 v[16:19], v[244:247], a[180:183], v[16:19]
  ds_read_b128 a[124:127], v122 offset:19456
  ds_read_b128 a[160:163], v202 offset:0
  v_mfma_f32_16x16x32_bf16 v[16:19], v[204:207], a[184:187], v[16:19]
  buffer_load_dwordx4 a[164:167], v112, s[24:27], s30 offen offset:0 sc1
  v_mfma_f32_16x16x32_bf16 v[20:23], v[204:207], a[192:195], v[20:23]
  v_lshlrev_b32 v228, 16, v82
  v_and_b32 v229, s34, v82
  v_mfma_f32_16x16x32_bf16 v[20:23], v[244:247], a[188:191], v[20:23]
  v_lshlrev_b32 v230, 16, v83
  v_and_b32 v231, s34, v83
  v_mfma_f32_16x16x32_bf16 v[24:27], v[244:247], a[196:199], v[24:27]
  buffer_load_dwordx4 a[168:171], v112, s[24:27], s30 offen offset:1024 sc1
  v_mfma_f32_16x16x32_bf16 v[24:27], v[204:207], a[200:203], v[24:27]
  v_lshlrev_b32 v232, 16, v84
  v_and_b32 v233, s34, v84
  v_mfma_f32_16x16x32_bf16 v[28:31], v[204:207], a[208:211], v[28:31]
  v_lshlrev_b32 v234, 16, v85
  v_and_b32 v235, s34, v85
  v_mfma_f32_16x16x32_bf16 v[28:31], v[244:247], a[204:207], v[28:31]
  v_lshlrev_b32 v236, 16, v86
  v_and_b32 v237, s34, v86
  s_waitcnt lgkmcnt(2)
  v_mfma_f32_16x16x32_bf16 v[32:35], v[216:219], a[180:183], v[32:35]
  ds_read_b128 a[172:175], v122 offset:32768
  ds_read_b128 a[176:179], v202 offset:1024
  v_mfma_f32_16x16x32_bf16 v[32:35], a[88:91], a[184:187], v[32:35]
  buffer_load_dwordx4 a[100:103], v113, s[24:27], s30 offen offset:0 sc1
  v_mfma_f32_16x16x32_bf16 v[36:39], a[88:91], a[192:195], v[36:39]
  v_lshlrev_b32 v238, 16, v87
  v_and_b32 v239, s34, v87
  v_mfma_f32_16x16x32_bf16 v[36:39], v[216:219], a[188:191], v[36:39]
  v_lshlrev_b32 v240, 16, v88
  v_and_b32 v241, s34, v88
  v_mfma_f32_16x16x32_bf16 v[40:43], v[216:219], a[196:199], v[40:43]
  buffer_load_dwordx4 a[104:107], v113, s[24:27], s30 offen offset:1024 sc1
  v_mfma_f32_16x16x32_bf16 v[40:43], a[88:91], a[200:203], v[40:43]
  v_lshlrev_b32 v242, 16, v89
  v_and_b32 v243, s34, v89
  v_mfma_f32_16x16x32_bf16 v[44:47], a[88:91], a[208:211], v[44:47]
  s_sub_u32 s41, s3, 1
  s_and_b32 s41, s41, 3
  s_lshl_b32 s41, s41, 12
  v_add_u32 v80, s41, v114
  v_mfma_f32_16x16x32_bf16 v[44:47], v[216:219], a[204:207], v[44:47]
  s_sub_u32 s41, s3, 2
  s_and_b32 s41, s41, 3
  s_lshl_b32 s41, s41, 12
  v_add_u32 v81, s41, v114
  s_waitcnt lgkmcnt(2)
  v_mfma_f32_16x16x32_bf16 v[48:51], a[124:127], a[180:183], v[48:51]
  ds_read_b128 v[244:247], v202 offset:2048
  ds_read_b128 v[204:207], v202 offset:19456
  s_add_u32 s30, s30, 8192
  v_mfma_f32_16x16x32_bf16 v[48:51], a[160:163], a[184:187], v[48:51]
  s_sub_u32 s41, s3, 3
  s_and_b32 s41, s41, 3
  s_lshl_b32 s41, s41, 12
  v_add_u32 v82, s41, v114
  v_bfe_u32 v196, v114, 8, 1
  v_mfma_f32_16x16x32_bf16 v[52:55], a[160:163], a[192:195], v[52:55]
  v_mul_u32_u24 v196, 24, v196
  v_add_u32 v83, v117, v196
  v_mfma_f32_16x16x32_bf16 v[52:55], a[124:127], a[188:191], v[52:55]
  v_mfma_f32_16x16x32_bf16 v[56:59], a[124:127], a[196:199], v[56:59]
  v_mfma_f32_16x16x32_bf16 v[56:59], a[160:163], a[200:203], v[56:59]
  v_mfma_f32_16x16x32_bf16 v[60:63], a[160:163], a[208:211], v[60:63]
  v_mfma_f32_16x16x32_bf16 v[60:63], a[124:127], a[204:207], v[60:63]
  s_waitcnt lgkmcnt(2)
  v_mfma_f32_16x16x32_bf16 v[64:67], a[172:175], a[180:183], v[64:67]
  ds_read_b128 v[216:219], v202 offset:3072
  ds_read_b128 a[88:91], v122 offset:49152
  v_mfma_f32_16x16x32_bf16 v[64:67], a[176:179], a[184:187], v[64:67]
  v_mfma_f32_16x16x32_bf16 v[68:71], a[176:179], a[192:195], v[68:71]
  v_mfma_f32_16x16x32_bf16 v[68:71], a[172:175], a[188:191], v[68:71]
  v_mfma_f32_16x16x32_bf16 v[72:75], a[172:175], a[196:199], v[72:75]
  v_mfma_f32_16x16x32_bf16 v[72:75], a[176:179], a[200:203], v[72:75]
  v_mfma_f32_16x16x32_bf16 v[76:79], a[176:179], a[208:211], v[76:79]
  v_mfma_f32_16x16x32_bf16 v[76:79], a[172:175], a[204:207], v[76:79]
  s_waitcnt vmcnt(8) lgkmcnt(2)
  v_mfma_f32_16x16x32_bf16 v[0:3], v[244:247], v[248:251], v[0:3]
  ds_read_b128 a[124:127], v202 offset:16384
  ds_read_b128 a[160:163], v122 offset:50176
  s_xor_b32 s38, s40, 1
  v_mfma_f32_16x16x32_bf16 v[0:3], v[204:207], v[252:255], v[0:3]
  buffer_load_dwordx4 a[172:175], v110, s[24:27], s30 offen offset:0 sc1
  s_lshl_b32 s38, s38, 2
  s_add_u32 s38, s38, s3
  s_lshl_b32 s38, s38, 12
  v_mfma_f32_16x16x32_bf16 v[4:7], v[204:207], v[212:215], v[4:7]
  s_add_u32 s38, s38, 25165824
  v_lshrrev_b32 v192, 1, v114
  v_mfma_f32_16x16x32_bf16 v[4:7], v[244:247], v[208:211], v[4:7]
  v_mfma_f32_16x16x32_bf16 v[8:11], v[244:247], v[220:223], v[8:11]
  buffer_load_dwordx4 a[176:179], v110, s[24:27], s30 offen offset:1024 sc1
  v_mfma_f32_16x16x32_bf16 v[8:11], v[204:207], a[84:87], v[8:11]
  v_mfma_f32_16x16x32_bf16 v[12:15], v[204:207], a[96:99], v[12:15]
  v_mfma_f32_16x16x32_bf16 v[12:15], v[244:247], a[92:95], v[12:15]
  s_waitcnt lgkmcnt(2)
  v_mfma_f32_16x16x32_bf16 v[16:19], v[216:219], v[248:251], v[16:19]
  ds_read_b128 a[180:183], v202 offset:17408
  ds_read_b128 a[184:187], v122 offset:51200
  v_mfma_f32_16x16x32_bf16 v[16:19], a[88:91], v[252:255], v[16:19]
  buffer_load_dwordx4 a[188:191], v111, s[24:27], s30 offen offset:0 sc1
  v_mfma_f32_16x16x32_bf16 v[20:23], a[88:91], v[212:215], v[20:23]
  ds_write_b128 v118, v[4:7] offset:0
  ds_write_b128 v118, v[8:11] offset:5120
  v_mfma_f32_16x16x32_bf16 v[20:23], v[216:219], v[208:211], v[20:23]
  ds_write_b128 v118, v[12:15] offset:10240
  v_mfma_f32_16x16x32_bf16 v[24:27], v[216:219], v[220:223], v[24:27]
  buffer_load_dwordx4 a[192:195], v111, s[24:27], s30 offen offset:1024 sc1
  v_mfma_f32_16x16x32_bf16 v[24:27], a[88:91], a[84:87], v[24:27]
  v_mfma_f32_16x16x32_bf16 v[28:31], a[88:91], a[96:99], v[28:31]
  v_mfma_f32_16x16x32_bf16 v[28:31], v[216:219], a[92:95], v[28:31]
  s_waitcnt lgkmcnt(5)
  v_mfma_f32_16x16x32_bf16 v[32:35], a[124:127], v[248:251], v[32:35]
  ds_read_b128 a[196:199], v202 offset:18432
  ds_read_b128 a[200:203], v122 offset:52224
  v_mfma_f32_16x16x32_bf16 v[32:35], a[160:163], v[252:255], v[32:35]
  buffer_load_dwordx4 a[204:207], v112, s[24:27], s30 offen offset:0 sc1
  v_mfma_f32_16x16x32_bf16 v[36:39], a[160:163], v[212:215], v[36:39]
  ds_write_b128 v118, v[20:23] offset:1024
  ds_write_b128 v118, v[24:27] offset:6144
  v_mfma_f32_16x16x32_bf16 v[36:39], a[124:127], v[208:211], v[36:39]
  ds_write_b128 v118, v[28:31] offset:11264
  v_mfma_f32_16x16x32_bf16 v[40:43], a[124:127], v[220:223], v[40:43]
  buffer_load_dwordx4 a[208:211], v112, s[24:27], s30 offen offset:1024 sc1
  v_mfma_f32_16x16x32_bf16 v[40:43], a[160:163], a[84:87], v[40:43]
  v_mfma_f32_16x16x32_bf16 v[44:47], a[160:163], a[96:99], v[44:47]
  v_mfma_f32_16x16x32_bf16 v[44:47], a[124:127], a[92:95], v[44:47]
  s_waitcnt lgkmcnt(8)
  v_mfma_f32_16x16x32_bf16 v[48:51], a[180:183], v[248:251], v[48:51]
  buffer_load_dwordx4 v[244:247], v113, s[24:27], s30 offen offset:0 sc1
  v_mfma_f32_16x16x32_bf16 v[48:51], a[184:187], v[252:255], v[48:51]
  ds_write_b128 v118, v[36:39] offset:2048
  v_mfma_f32_16x16x32_bf16 v[52:55], a[184:187], v[212:215], v[52:55]
  ds_write_b128 v118, v[40:43] offset:7168
  v_mfma_f32_16x16x32_bf16 v[52:55], a[180:183], v[208:211], v[52:55]
  ds_write_b128 v118, v[44:47] offset:12288
  v_mfma_f32_16x16x32_bf16 v[56:59], a[180:183], v[220:223], v[56:59]
  buffer_load_dwordx4 v[204:207], v113, s[24:27], s30 offen offset:1024 sc1
  v_mfma_f32_16x16x32_bf16 v[56:59], a[184:187], a[84:87], v[56:59]
  v_mfma_f32_16x16x32_bf16 v[60:63], a[184:187], a[96:99], v[60:63]
  v_mfma_f32_16x16x32_bf16 v[60:63], a[180:183], a[92:95], v[60:63]
  s_waitcnt lgkmcnt(6)
  v_mfma_f32_16x16x32_bf16 v[64:67], a[196:199], v[248:251], v[64:67]
  s_add_u32 s30, s30, 8192
  buffer_load_dwordx4 v[216:219], v110, s[24:27], s30 offen offset:0 sc1
  v_mfma_f32_16x16x32_bf16 v[64:67], a[200:203], v[252:255], v[64:67]
  ds_write_b128 v118, v[52:55] offset:3072
  ds_write_b128 v118, v[56:59] offset:8192
  v_mfma_f32_16x16x32_bf16 v[68:71], a[200:203], v[212:215], v[68:71]
  ds_write_b128 v118, v[60:63] offset:13312
  v_mfma_f32_16x16x32_bf16 v[68:71], a[196:199], v[208:211], v[68:71]
  v_mfma_f32_16x16x32_bf16 v[72:75], a[196:199], v[220:223], v[72:75]
  buffer_load_dwordx4 a[88:91], v110, s[24:27], s30 offen offset:1024 sc1
  v_mfma_f32_16x16x32_bf16 v[72:75], a[200:203], a[84:87], v[72:75]
  v_mfma_f32_16x16x32_bf16 v[76:79], a[200:203], a[96:99], v[76:79]
  v_mfma_f32_16x16x32_bf16 v[76:79], a[196:199], a[92:95], v[76:79]
  s_nop 2
  ds_write_b128 v118, v[68:71] offset:4096
  s_nop 1
  ds_write_b128 v118, v[72:75] offset:9216
  s_nop 0
  ds_write_b128 v118, v[76:79] offset:14336
  buffer_load_dwordx4 a[124:127], v111, s[24:27], s30 offen offset:0 sc1
  buffer_load_dwordx4 a[160:163], v111, s[24:27], s30 offen offset:1024 sc1
  buffer_load_dwordx4 a[180:183], v112, s[24:27], s30 offen offset:0 sc1
  buffer_load_dwordx4 a[184:187], v112, s[24:27], s30 offen offset:1024 sc1
  buffer_load_dwordx4 a[196:199], v113, s[24:27], s30 offen offset:0 sc1
  buffer_load_dwordx4 a[200:203], v113, s[24:27], s30 offen offset:1024 sc1
  s_add_u32 s30, s30, 8192
  buffer_load_dwordx4 v[248:251], v110, s[24:27], s30 offen offset:0 sc1
  buffer_load_dwordx4 v[252:255], v110, s[24:27], s30 offen offset:1024 sc1
  buffer_load_dwordx4 v[208:211], v111, s[24:27], s30 offen offset:0 sc1
  buffer_load_dwordx4 v[212:215], v111, s[24:27], s30 offen offset:1024 sc1
  buffer_load_dwordx4 v[220:223], v112, s[24:27], s30 offen offset:0 sc1
  buffer_load_dwordx4 a[84:87], v112, s[24:27], s30 offen offset:1024 sc1
  buffer_load_dwordx4 a[92:95], v113, s[24:27], s30 offen offset:0 sc1
  buffer_load_dwordx4 a[96:99], v113, s[24:27], s30 offen offset:1024 sc1
  s_waitcnt lgkmcnt(0)
  s_barrier
  ds_read_b128 v[4:7], v119 offset:0
  ds_read_b128 v[8:11], v120 offset:5120
  ds_read_b128 v[12:15], v121 offset:10240
  ds_read_b128 v[20:23], v119 offset:1024
  ds_read_b128 v[24:27], v120 offset:6144
  ds_read_b128 v[28:31], v121 offset:11264
  ds_read_b128 v[36:39], v119 offset:2048
  ds_read_b128 v[40:43], v120 offset:7168
  ds_read_b128 v[44:47], v121 offset:12288
  ds_read_b128 v[52:55], v119 offset:3072
  ds_read_b128 v[56:59], v120 offset:8192
  ds_read_b128 v[60:63], v121 offset:13312
  ds_read_b128 v[68:71], v119 offset:4096
  ds_read_b128 v[72:75], v120 offset:9216
  ds_read_b128 v[76:79], v121 offset:14336
  s_waitcnt lgkmcnt(12)
  v_add_f32 v4, v4, v8
  v_add_f32 v5, v5, v9
  v_add_f32 v6, v6, v10
  v_add_f32 v7, v7, v11
  v_add_f32 v0, v0, v12
  v_add_f32 v1, v1, v13
  v_add_f32 v2, v2, v14
  v_add_f32 v3, v3, v15
  v_add_f32 v0, v0, v4
  v_add_f32 v1, v1, v5
  v_add_f32 v2, v2, v6
  v_add_f32 v3, v3, v7
  v_cvt_pk_bf16_f32 v4, v0, v1
  v_cvt_pk_bf16_f32 v5, v2, v3
  buffer_store_dwordx2 v[4:5], v192, s[24:27], s38 offen offset:0 sc1
  s_waitcnt vmcnt(25)
  v_mfma_f32_16x16x32_bf16 v[0:3], a[212:215], a[108:111], 0
  s_add_u32 s30, s30, 8192
  s_waitcnt lgkmcnt(9)
  v_add_f32 v20, v20, v24
  v_add_f32 v21, v21, v25
  v_mfma_f32_16x16x32_bf16 v[0:3], a[232:235], a[112:115], v[0:3]
  v_add_f32 v22, v22, v26
  v_add_f32 v23, v23, v27
  v_mfma_f32_16x16x32_bf16 v[4:7], a[232:235], a[120:123], 0
  v_add_f32 v16, v16, v28
  v_add_f32 v17, v17, v29
  v_mfma_f32_16x16x32_bf16 v[4:7], a[212:215], a[116:119], v[4:7]
  v_add_f32 v18, v18, v30
  v_add_f32 v19, v19, v31
  v_mfma_f32_16x16x32_bf16 v[8:11], a[212:215], a[164:167], 0
  v_add_f32 v16, v16, v20
  v_add_f32 v17, v17, v21
  v_mfma_f32_16x16x32_bf16 v[8:11], a[232:235], a[168:171], v[8:11]
  v_add_f32 v18, v18, v22
  v_add_f32 v19, v19, v23
  v_mfma_f32_16x16x32_bf16 v[12:15], a[232:235], a[104:107], 0
  v_cvt_pk_bf16_f32 v20, v16, v17
  v_cvt_pk_bf16_f32 v21, v18, v19
  v_mfma_f32_16x16x32_bf16 v[12:15], a[212:215], a[100:103], v[12:15]
  buffer_store_dwordx2 v[20:21], v192, s[24:27], s38 offen offset:512 sc1
  s_waitcnt lgkmcnt(6)
  v_mfma_f32_16x16x32_bf16 v[16:19], a[216:219], a[108:111], 0
  buffer_load_dwordx4 a[212:215], v110, s[24:27], s30 offen offset:0 sc1
  v_mfma_f32_16x16x32_bf16 v[16:19], a[236:239], a[112:115], v[16:19]
  v_add_f32 v36, v36, v40
  v_add_f32 v37, v37, v41
  v_mfma_f32_16x16x32_bf16 v[20:23], a[236:239], a[120:123], 0
  v_add_f32 v38, v38, v42
  v_add_f32 v39, v39, v43
  v_mfma_f32_16x16x32_bf16 v[20:23], a[216:219], a[116:119], v[20:23]
  v_add_f32 v32, v32, v44
  v_add_f32 v33, v33, v45
  v_mfma_f32_16x16x32_bf16 v[24:27], a[216:219], a[164:167], 0
  buffer_load_dwordx4 a[232:235], v110, s[24:27], s30 offen offset:1024 sc1
  v_mfma_f32_16x16x32_bf16 v[24:27], a[236:239], a[168:171], v[24:27]
  v_add_f32 v34, v34, v46
  v_add_f32 v35, v35, v47
  v_mfma_f32_16x16x32_bf16 v[28:31], a[236:239], a[104:107], 0
  v_add_f32 v32, v32, v36
  v_add_f32 v33, v33, v37
  v_mfma_f32_16x16x32_bf16 v[28:31], a[216:219], a[100:103], v[28:31]
  v_add_f32 v34, v34, v38
  v_add_f32 v35, v35, v39
  v_cvt_pk_bf16_f32 v36, v32, v33
  v_cvt_pk_bf16_f32 v37, v34, v35
  buffer_store_dwordx2 v[36:37], v192, s[24:27], s38 offen offset:1024 sc1
  v_mfma_f32_16x16x32_bf16 v[32:35], a[220:223], a[108:111], 0
  buffer_load_dwordx4 a[216:219], v111, s[24:27], s30 offen offset:0 sc1
  s_waitcnt lgkmcnt(3)
  v_mfma_f32_16x16x32_bf16 v[32:35], a[240:243], a[112:115], v[32:35]
  v_add_f32 v52, v52, v56
  v_add_f32 v53, v53, v57
  v_mfma_f32_16x16x32_bf16 v[36:39], a[240:243], a[120:123], 0
  v_add_f32 v54, v54, v58
  v_add_f32 v55, v55, v59
  v_mfma_f32_16x16x32_bf16 v[36:39], a[220:223], a[116:119], v[36:39]
  v_add_f32 v48, v48, v60
  v_add_f32 v49, v49, v61
  v_mfma_f32_16x16x32_bf16 v[40:43], a[220:223], a[164:167], 0
  buffer_load_dwordx4 a[236:239], v111, s[24:27], s30 offen offset:1024 sc1
  v_mfma_f32_16x16x32_bf16 v[40:43], a[240:243], a[168:171], v[40:43]
  v_add_f32 v50, v50, v62
  v_add_f32 v51, v51, v63
  v_mfma_f32_16x16x32_bf16 v[44:47], a[240:243], a[104:107], 0
  v_add_f32 v48, v48, v52
  v_add_f32 v49, v49, v53
  v_mfma_f32_16x16x32_bf16 v[44:47], a[220:223], a[100:103], v[44:47]
  v_add_f32 v50, v50, v54
  v_add_f32 v51, v51, v55
  v_cvt_pk_bf16_f32 v52, v48, v49
  v_cvt_pk_bf16_f32 v53, v50, v51
  buffer_store_dwordx2 v[52:53], v192, s[24:27], s38 offen offset:1536 sc1
  v_mfma_f32_16x16x32_bf16 v[48:51], a[224:227], a[108:111], 0
  buffer_load_dwordx4 a[220:223], v112, s[24:27], s30 offen offset:0 sc1
  s_waitcnt lgkmcnt(0)
  v_mfma_f32_16x16x32_bf16 v[48:51], a[244:247], a[112:115], v[48:51]
  v_add_f32 v68, v68, v72
  v_add_f32 v69, v69, v73
  v_mfma_f32_16x16x32_bf16 v[52:55], a[244:247], a[120:123], 0
  v_add_f32 v70, v70, v74
  v_add_f32 v71, v71, v75
  v_mfma_f32_16x16x32_bf16 v[52:55], a[224:227], a[116:119], v[52:55]
  v_add_f32 v64, v64, v76
  v_add_f32 v65, v65, v77
  v_mfma_f32_16x16x32_bf16 v[56:59], a[224:227], a[164:167], 0
  buffer_load_dwordx4 a[240:243], v112, s[24:27], s30 offen offset:1024 sc1
  v_mfma_f32_16x16x32_bf16 v[56:59], a[244:247], a[168:171], v[56:59]
  v_add_f32 v66, v66, v78
  v_add_f32 v67, v67, v79
  v_mfma_f32_16x16x32_bf16 v[60:63], a[244:247], a[104:107], 0
  v_add_f32 v64, v64, v68
  v_add_f32 v65, v65, v69
  v_mfma_f32_16x16x32_bf16 v[60:63], a[224:227], a[100:103], v[60:63]
  v_add_f32 v66, v66, v70
  v_add_f32 v67, v67, v71
  v_cvt_pk_bf16_f32 v68, v64, v65
  v_cvt_pk_bf16_f32 v69, v66, v67
  buffer_store_dwordx2 v[68:69], v192, s[24:27], s38 offen offset:2048 sc1
  v_mfma_f32_16x16x32_bf16 v[64:67], a[228:231], a[108:111], 0
  buffer_load_dwordx4 a[224:227], v113, s[24:27], s30 offen offset:0 sc1
  s_xor_b32 s38, s40, 1
  s_lshl_b32 s38, s38, 7
  s_add_u32 s38, s38, 2834432
  v_mfma_f32_16x16x32_bf16 v[64:67], a[248:251], a[112:115], v[64:67]
  v_mov_b32 v193, 1073741824
  v_writelane_b32 v193, s38, 0
  v_mfma_f32_16x16x32_bf16 v[68:71], a[248:251], a[120:123], 0
  v_mov_b32 v194, 1
  v_mfma_f32_16x16x32_bf16 v[68:71], a[228:231], a[116:119], v[68:71]
  s_xor_b32 s38, s38, 128
  v_mov_b32 v200, s38
  v_mov_b32 v201, 4
  v_mfma_f32_16x16x32_bf16 v[72:75], a[228:231], a[164:167], 0
  buffer_load_dwordx4 a[244:247], v113, s[24:27], s30 offen offset:1024 sc1
  v_mfma_f32_16x16x32_bf16 v[72:75], a[248:251], a[168:171], v[72:75]
  v_mfma_f32_16x16x32_bf16 v[76:79], a[248:251], a[104:107], 0
  v_mfma_f32_16x16x32_bf16 v[76:79], a[228:231], a[100:103], v[76:79]
  s_waitcnt vmcnt(29)
  v_mfma_f32_16x16x32_bf16 v[0:3], a[252:255], a[172:175], v[0:3]
  s_add_u32 s30, s30, 8192
  buffer_load_dwordx4 a[228:231], v110, s[24:27], s30 offen offset:0 sc1
  v_mfma_f32_16x16x32_bf16 v[0:3], a[144:147], a[176:179], v[0:3]
  v_mfma_f32_16x16x32_bf16 v[4:7], a[144:147], a[192:195], v[4:7]
  v_mfma_f32_16x16x32_bf16 v[4:7], a[252:255], a[188:191], v[4:7]
  v_mfma_f32_16x16x32_bf16 v[8:11], a[252:255], a[204:207], v[8:11]
  buffer_load_dwordx4 a[248:251], v110, s[24:27], s30 offen offset:1024 sc1
  v_mfma_f32_16x16x32_bf16 v[8:11], a[144:147], a[208:211], v[8:11]
  v_mfma_f32_16x16x32_bf16 v[12:15], a[144:147], v[204:207], v[12:15]
  v_mfma_f32_16x16x32_bf16 v[12:15], a[252:255], v[244:247], v[12:15]
  v_mfma_f32_16x16x32_bf16 v[16:19], a[128:131], a[172:175], v[16:19]
  buffer_load_dwordx4 a[108:111], v111, s[24:27], s30 offen offset:0 sc1
  v_mfma_f32_16x16x32_bf16 v[16:19], a[148:151], a[176:179], v[16:19]
  v_mfma_f32_16x16x32_bf16 v[20:23], a[148:151], a[192:195], v[20:23]
  v_mfma_f32_16x16x32_bf16 v[20:23], a[128:131], a[188:191], v[20:23]
  v_mfma_f32_16x16x32_bf16 v[24:27], a[128:131], a[204:207], v[24:27]
  buffer_load_dwordx4 a[112:115], v111, s[24:27], s30 offen offset:1024 sc1
  v_mfma_f32_16x16x32_bf16 v[24:27], a[148:151], a[208:211], v[24:27]
  v_mfma_f32_16x16x32_bf16 v[28:31], a[148:151], v[204:207], v[28:31]
  v_mfma_f32_16x16x32_bf16 v[28:31], a[128:131], v[244:247], v[28:31]
  v_mfma_f32_16x16x32_bf16 v[32:35], a[132:135], a[172:175], v[32:35]
  buffer_load_dwordx4 a[116:119], v112, s[24:27], s30 offen offset:0 sc1
  v_mfma_f32_16x16x32_bf16 v[32:35], a[152:155], a[176:179], v[32:35]
  v_mfma_f32_16x16x32_bf16 v[36:39], a[152:155], a[192:195], v[36:39]
  v_mfma_f32_16x16x32_bf16 v[36:39], a[132:135], a[188:191], v[36:39]
  v_mfma_f32_16x16x32_bf16 v[40:43], a[132:135], a[204:207], v[40:43]
  buffer_load_dwordx4 a[120:123], v112, s[24:27], s30 offen offset:1024 sc1
  v_mfma_f32_16x16x32_bf16 v[40:43], a[152:155], a[208:211], v[40:43]
  v_mfma_f32_16x16x32_bf16 v[44:47], a[152:155], v[204:207], v[44:47]
  v_mfma_f32_16x16x32_bf16 v[44:47], a[132:135], v[244:247], v[44:47]
  v_mfma_f32_16x16x32_bf16 v[48:51], a[136:139], a[172:175], v[48:51]
  buffer_load_dwordx4 a[164:167], v113, s[24:27], s30 offen offset:0 sc1
  v_mfma_f32_16x16x32_bf16 v[48:51], a[156:159], a[176:179], v[48:51]
  v_mfma_f32_16x16x32_bf16 v[52:55], a[156:159], a[192:195], v[52:55]
  v_mfma_f32_16x16x32_bf16 v[52:55], a[136:139], a[188:191], v[52:55]
  v_mfma_f32_16x16x32_bf16 v[56:59], a[136:139], a[204:207], v[56:59]
  buffer_load_dwordx4 a[168:171], v113, s[24:27], s30 offen offset:1024 sc1
  v_mfma_f32_16x16x32_bf16 v[56:59], a[156:159], a[208:211], v[56:59]
  v_mfma_f32_16x16x32_bf16 v[60:63], a[156:159], v[204:207], v[60:63]
  v_mfma_f32_16x16x32_bf16 v[60:63], a[136:139], v[244:247], v[60:63]
  v_mfma_f32_16x16x32_bf16 v[64:67], a[140:143], a[172:175], v[64:67]
  s_add_u32 s30, s30, 8192
  buffer_load_dwordx4 a[100:103], v110, s[24:27], s30 offen offset:0 sc1
  v_mfma_f32_16x16x32_bf16 v[64:67], v[128:131], a[176:179], v[64:67]
  v_mfma_f32_16x16x32_bf16 v[68:71], v[128:131], a[192:195], v[68:71]
  v_mfma_f32_16x16x32_bf16 v[68:71], a[140:143], a[188:191], v[68:71]
  v_mfma_f32_16x16x32_bf16 v[72:75], a[140:143], a[204:207], v[72:75]
  buffer_load_dwordx4 a[104:107], v110, s[24:27], s30 offen offset:1024 sc1
  v_mfma_f32_16x16x32_bf16 v[72:75], v[128:131], a[208:211], v[72:75]
  v_mfma_f32_16x16x32_bf16 v[76:79], v[128:131], v[204:207], v[76:79]
  v_mfma_f32_16x16x32_bf16 v[76:79], a[140:143], v[244:247], v[76:79]
  s_waitcnt vmcnt(31)
  v_mfma_f32_16x16x32_bf16 v[0:3], v[132:135], v[216:219], v[0:3]
  buffer_load_dwordx4 a[252:255], v111, s[24:27], s30 offen offset:0 sc1
  v_mfma_f32_16x16x32_bf16 v[0:3], v[152:155], a[88:91], v[0:3]
  v_mfma_f32_16x16x32_bf16 v[4:7], v[152:155], a[160:163], v[4:7]
  v_mfma_f32_16x16x32_bf16 v[4:7], v[132:135], a[124:127], v[4:7]
  v_mfma_f32_16x16x32_bf16 v[8:11], v[132:135], a[180:183], v[8:11]
  buffer_load_dwordx4 a[144:147], v111, s[24:27], s30 offen offset:1024 sc1
  v_mfma_f32_16x16x32_bf16 v[8:11], v[152:155], a[184:187], v[8:11]
  v_mfma_f32_16x16x32_bf16 v[12:15], v[152:155], a[200:203], v[12:15]
  v_mfma_f32_16x16x32_bf16 v[12:15], v[132:135], a[196:199], v[12:15]
  v_mfma_f32_16x16x32_bf16 v[16:19], v[136:139], v[216:219], v[16:19]
  buffer_load_dwordx4 a[128:131], v112, s[24:27], s30 offen offset:0 sc1
  v_mfma_f32_16x16x32_bf16 v[16:19], v[156:159], a[88:91], v[16:19]
  v_mfma_f32_16x16x32_bf16 v[20:23], v[156:159], a[160:163], v[20:23]
  v_mfma_f32_16x16x32_bf16 v[20:23], v[136:139], a[124:127], v[20:23]
  v_mfma_f32_16x16x32_bf16 v[24:27], v[136:139], a[180:183], v[24:27]
  buffer_load_dwordx4 a[148:151], v112, s[24:27], s30 offen offset:1024 sc1
  v_mfma_f32_16x16x32_bf16 v[24:27], v[156:159], a[184:187], v[24:27]
  v_mfma_f32_16x16x32_bf16 v[28:31], v[156:159], a[200:203], v[28:31]
  v_mfma_f32_16x16x32_bf16 v[28:31], v[136:139], a[196:199], v[28:31]
  v_mfma_f32_16x16x32_bf16 v[32:35], v[140:143], v[216:219], v[32:35]
  buffer_load_dwordx4 a[132:135], v113, s[24:27], s30 offen offset:0 sc1
  v_mfma_f32_16x16x32_bf16 v[32:35], v[160:163], a[88:91], v[32:35]
  v_mfma_f32_16x16x32_bf16 v[36:39], v[160:163], a[160:163], v[36:39]
  v_mfma_f32_16x16x32_bf16 v[36:39], v[140:143], a[124:127], v[36:39]
  v_mfma_f32_16x16x32_bf16 v[40:43], v[140:143], a[180:183], v[40:43]
  buffer_load_dwordx4 a[152:155], v113, s[24:27], s30 offen offset:1024 sc1
  v_mfma_f32_16x16x32_bf16 v[40:43], v[160:163], a[184:187], v[40:43]
  v_mfma_f32_16x16x32_bf16 v[44:47], v[160:163], a[200:203], v[44:47]
  v_mfma_f32_16x16x32_bf16 v[44:47], v[140:143], a[196:199], v[44:47]
  v_mfma_f32_16x16x32_bf16 v[48:51], v[144:147], v[216:219], v[48:51]
  s_add_u32 s30, s30, 8192
  buffer_load_dwordx4 a[136:139], v110, s[24:27], s30 offen offset:0 sc1
  v_mfma_f32_16x16x32_bf16 v[48:51], v[164:167], a[88:91], v[48:51]
  v_mfma_f32_16x16x32_bf16 v[52:55], v[164:167], a[160:163], v[52:55]
  v_mfma_f32_16x16x32_bf16 v[52:55], v[144:147], a[124:127], v[52:55]
  v_mfma_f32_16x16x32_bf16 v[56:59], v[144:147], a[180:183], v[56:59]
  buffer_load_dwordx4 a[156:159], v110, s[24:27], s30 offen offset:1024 sc1
  v_mfma_f32_16x16x32_bf16 v[56:59], v[164:167], a[184:187], v[56:59]
  v_mfma_f32_16x16x32_bf16 v[60:63], v[164:167], a[200:203], v[60:63]
  v_mfma_f32_16x16x32_bf16 v[60:63], v[144:147], a[196:199], v[60:63]
  v_mfma_f32_16x16x32_bf16 v[64:67], v[148:151], v[216:219], v[64:67]
  buffer_load_dwordx4 a[140:143], v111, s[24:27], s30 offen offset:0 sc1
  v_mfma_f32_16x16x32_bf16 v[64:67], v[168:171], a[88:91], v[64:67]
  v_mfma_f32_16x16x32_bf16 v[68:71], v[168:171], a[160:163], v[68:71]
  v_mfma_f32_16x16x32_bf16 v[68:71], v[148:151], a[124:127], v[68:71]
  v_mfma_f32_16x16x32_bf16 v[72:75], v[148:151], a[180:183], v[72:75]
  buffer_load_dwordx4 v[128:131], v111, s[24:27], s30 offen offset:1024 sc1
  v_mfma_f32_16x16x32_bf16 v[72:75], v[168:171], a[184:187], v[72:75]
  v_mfma_f32_16x16x32_bf16 v[76:79], v[168:171], a[200:203], v[76:79]
  v_mfma_f32_16x16x32_bf16 v[76:79], v[148:151], a[196:199], v[76:79]
  s_waitcnt vmcnt(33)
  v_mfma_f32_16x16x32_bf16 v[0:3], v[172:175], v[248:251], v[0:3]
  buffer_load_dwordx4 a[172:175], v112, s[24:27], s30 offen offset:0 sc1
  s_waitcnt vmcnt(23)
  v_mfma_f32_16x16x32_bf16 v[0:3], a[0:3], v[252:255], v[0:3]
  buffer_atomic_add v194, v193, s[24:27], 0 offen
  v_mfma_f32_16x16x32_bf16 v[4:7], a[0:3], v[212:215], v[4:7]
  v_mfma_f32_16x16x32_bf16 v[4:7], v[172:175], v[208:211], v[4:7]
  v_mfma_f32_16x16x32_bf16 v[8:11], v[172:175], v[220:223], v[8:11]
  buffer_load_dwordx4 a[176:179], v112, s[24:27], s30 offen offset:1024 sc1
  v_mfma_f32_16x16x32_bf16 v[8:11], a[0:3], a[84:87], v[8:11]
  v_mfma_f32_16x16x32_bf16 v[12:15], a[0:3], a[96:99], v[12:15]
  v_mfma_f32_16x16x32_bf16 v[12:15], v[172:175], a[92:95], v[12:15]
  v_mfma_f32_16x16x32_bf16 v[16:19], v[176:179], v[248:251], v[16:19]
  buffer_load_dwordx4 a[188:191], v113, s[24:27], s30 offen offset:0 sc1
  v_mfma_f32_16x16x32_bf16 v[16:19], a[4:7], v[252:255], v[16:19]
  v_mfma_f32_16x16x32_bf16 v[20:23], a[4:7], v[212:215], v[20:23]
  v_mfma_f32_16x16x32_bf16 v[20:23], v[176:179], v[208:211], v[20:23]
  v_mfma_f32_16x16x32_bf16 v[24:27], v[176:179], v[220:223], v[24:27]
  buffer_load_dwordx4 a[192:195], v113, s[24:27], s30 offen offset:1024 sc1
  v_mfma_f32_16x16x32_bf16 v[24:27], a[4:7], a[84:87], v[24:27]
  v_mfma_f32_16x16x32_bf16 v[28:31], a[4:7], a[96:99], v[28:31]
  v_mfma_f32_16x16x32_bf16 v[28:31], v[176:179], a[92:95], v[28:31]
  v_mfma_f32_16x16x32_bf16 v[32:35], v[180:183], v[248:251], v[32:35]
  s_add_u32 s30, s30, 8192
  v_mfma_f32_16x16x32_bf16 v[32:35], a[8:11], v[252:255], v[32:35]
  v_mfma_f32_16x16x32_bf16 v[36:39], a[8:11], v[212:215], v[36:39]
  v_mfma_f32_16x16x32_bf16 v[36:39], v[180:183], v[208:211], v[36:39]
  v_mfma_f32_16x16x32_bf16 v[40:43], v[180:183], v[220:223], v[40:43]
  v_mfma_f32_16x16x32_bf16 v[40:43], a[8:11], a[84:87], v[40:43]
  v_mfma_f32_16x16x32_bf16 v[44:47], a[8:11], a[96:99], v[44:47]
  v_mfma_f32_16x16x32_bf16 v[44:47], v[180:183], a[92:95], v[44:47]
  v_mfma_f32_16x16x32_bf16 v[48:51], v[184:187], v[248:251], v[48:51]
  v_mfma_f32_16x16x32_bf16 v[48:51], a[12:15], v[252:255], v[48:51]
  v_mfma_f32_16x16x32_bf16 v[52:55], a[12:15], v[212:215], v[52:55]
  v_mfma_f32_16x16x32_bf16 v[52:55], v[184:187], v[208:211], v[52:55]
  v_mfma_f32_16x16x32_bf16 v[56:59], v[184:187], v[220:223], v[56:59]
  v_mfma_f32_16x16x32_bf16 v[56:59], a[12:15], a[84:87], v[56:59]
  v_mfma_f32_16x16x32_bf16 v[60:63], a[12:15], a[96:99], v[60:63]
  v_mfma_f32_16x16x32_bf16 v[60:63], v[184:187], a[92:95], v[60:63]
  v_mfma_f32_16x16x32_bf16 v[64:67], v[188:191], v[248:251], v[64:67]
  v_mfma_f32_16x16x32_bf16 v[64:67], a[16:19], v[252:255], v[64:67]
  v_mfma_f32_16x16x32_bf16 v[68:71], a[16:19], v[212:215], v[68:71]
  v_mfma_f32_16x16x32_bf16 v[68:71], v[188:191], v[208:211], v[68:71]
  v_mfma_f32_16x16x32_bf16 v[72:75], v[188:191], v[220:223], v[72:75]
  v_mfma_f32_16x16x32_bf16 v[72:75], a[16:19], a[84:87], v[72:75]
  v_mfma_f32_16x16x32_bf16 v[76:79], a[16:19], a[96:99], v[76:79]
  v_mfma_f32_16x16x32_bf16 v[76:79], v[188:191], a[92:95], v[76:79]
  s_waitcnt vmcnt(25)
  v_mfma_f32_16x16x32_bf16 v[0:3], a[20:23], a[212:215], v[0:3]
  v_mfma_f32_16x16x32_bf16 v[0:3], a[40:43], a[232:235], v[0:3]
  v_mfma_f32_16x16x32_bf16 v[4:7], a[40:43], a[236:239], v[4:7]
  v_mfma_f32_16x16x32_bf16 v[4:7], a[20:23], a[216:219], v[4:7]
  v_mfma_f32_16x16x32_bf16 v[8:11], a[20:23], a[220:223], v[8:11]
  v_mfma_f32_16x16x32_bf16 v[8:11], a[40:43], a[240:243], v[8:11]
  v_mfma_f32_16x16x32_bf16 v[12:15], a[40:43], a[244:247], v[12:15]
  v_mfma_f32_16x16x32_bf16 v[12:15], a[20:23], a[224:227], v[12:15]
  v_mfma_f32_16x16x32_bf16 v[16:19], a[24:27], a[212:215], v[16:19]
  v_mfma_f32_16x16x32_bf16 v[16:19], a[44:47], a[232:235], v[16:19]
  v_mfma_f32_16x16x32_bf16 v[20:23], a[44:47], a[236:239], v[20:23]
  v_mfma_f32_16x16x32_bf16 v[20:23], a[24:27], a[216:219], v[20:23]
  v_mfma_f32_16x16x32_bf16 v[24:27], a[24:27], a[220:223], v[24:27]
  v_mfma_f32_16x16x32_bf16 v[24:27], a[44:47], a[240:243], v[24:27]
  v_mfma_f32_16x16x32_bf16 v[28:31], a[44:47], a[244:247], v[28:31]
  v_mfma_f32_16x16x32_bf16 v[28:31], a[24:27], a[224:227], v[28:31]
  v_mfma_f32_16x16x32_bf16 v[32:35], a[28:31], a[212:215], v[32:35]
  v_mfma_f32_16x16x32_bf16 v[32:35], a[48:51], a[232:235], v[32:35]
  v_mfma_f32_16x16x32_bf16 v[36:39], a[48:51], a[236:239], v[36:39]
  v_mfma_f32_16x16x32_bf16 v[36:39], a[28:31], a[216:219], v[36:39]
  v_mfma_f32_16x16x32_bf16 v[40:43], a[28:31], a[220:223], v[40:43]
  v_mfma_f32_16x16x32_bf16 v[40:43], a[48:51], a[240:243], v[40:43]
  v_mfma_f32_16x16x32_bf16 v[44:47], a[48:51], a[244:247], v[44:47]
  v_mfma_f32_16x16x32_bf16 v[44:47], a[28:31], a[224:227], v[44:47]
  v_mfma_f32_16x16x32_bf16 v[48:51], a[32:35], a[212:215], v[48:51]
  v_mfma_f32_16x16x32_bf16 v[48:51], a[52:55], a[232:235], v[48:51]
  v_mfma_f32_16x16x32_bf16 v[52:55], a[52:55], a[236:239], v[52:55]
  v_mfma_f32_16x16x32_bf16 v[52:55], a[32:35], a[216:219], v[52:55]
  v_mfma_f32_16x16x32_bf16 v[56:59], a[32:35], a[220:223], v[56:59]
  v_mfma_f32_16x16x32_bf16 v[56:59], a[52:55], a[240:243], v[56:59]
  v_mfma_f32_16x16x32_bf16 v[60:63], a[52:55], a[244:247], v[60:63]
  v_mfma_f32_16x16x32_bf16 v[60:63], a[32:35], a[224:227], v[60:63]
  v_mfma_f32_16x16x32_bf16 v[64:67], a[36:39], a[212:215], v[64:67]
  ds_read_b128 a[204:207], v122 offset:0
  v_mfma_f32_16x16x32_bf16 v[64:67], a[56:59], a[232:235], v[64:67]
  v_mfma_f32_16x16x32_bf16 v[68:71], a[56:59], a[236:239], v[68:71]
  v_mfma_f32_16x16x32_bf16 v[68:71], a[36:39], a[216:219], v[68:71]
  v_mfma_f32_16x16x32_bf16 v[72:75], a[36:39], a[220:223], v[72:75]
  v_mfma_f32_16x16x32_bf16 v[72:75], a[56:59], a[240:243], v[72:75]
  v_mfma_f32_16x16x32_bf16 v[76:79], a[56:59], a[244:247], v[76:79]
  v_mfma_f32_16x16x32_bf16 v[76:79], a[36:39], a[224:227], v[76:79]
  s_waitcnt vmcnt(17)
  v_mfma_f32_16x16x32_bf16 v[0:3], a[60:63], a[228:231], v[0:3]
  ds_read_b128 a[208:211], v122 offset:1024
  buffer_load_dword v195, v200, s[24:27], 0 offen sc1
  s_xor_b32 s38, s40, 0
  s_lshl_b32 s38, s38, 2
  s_add_u32 s38, s38, s3
  v_mfma_f32_16x16x32_bf16 v[0:3], a[80:83], a[248:251], v[0:3]
  s_lshl_b32 s38, s38, 12
  s_add_u32 s38, s38, 25165824
  v_mfma_f32_16x16x32_bf16 v[4:7], a[80:83], a[112:115], v[4:7]
  v_mfma_f32_16x16x32_bf16 v[4:7], a[60:63], a[108:111], v[4:7]
  v_mfma_f32_16x16x32_bf16 v[8:11], a[60:63], a[116:119], v[8:11]
  v_mfma_f32_16x16x32_bf16 v[8:11], a[80:83], a[120:123], v[8:11]
  v_mfma_f32_16x16x32_bf16 v[12:15], a[80:83], a[168:171], v[12:15]
  v_mfma_f32_16x16x32_bf16 v[12:15], a[60:63], a[164:167], v[12:15]
  s_waitcnt lgkmcnt(1)
  v_mfma_f32_16x16x32_bf16 v[16:19], a[64:67], a[228:231], v[16:19]
  ds_read_b128 v[244:247], v122 offset:2048
  v_mfma_f32_16x16x32_bf16 v[16:19], a[204:207], a[248:251], v[16:19]
  v_mfma_f32_16x16x32_bf16 v[20:23], a[204:207], a[112:115], v[20:23]
  v_mfma_f32_16x16x32_bf16 v[20:23], a[64:67], a[108:111], v[20:23]
  v_mfma_f32_16x16x32_bf16 v[24:27], a[64:67], a[116:119], v[24:27]
  v_mfma_f32_16x16x32_bf16 v[24:27], a[204:207], a[120:123], v[24:27]
  v_mfma_f32_16x16x32_bf16 v[28:31], a[204:207], a[168:171], v[28:31]
  v_mfma_f32_16x16x32_bf16 v[28:31], a[64:67], a[164:167], v[28:31]
  s_waitcnt lgkmcnt(1)
  v_mfma_f32_16x16x32_bf16 v[32:35], a[68:71], a[228:231], v[32:35]
  ds_read_b128 v[132:135], v122 offset:3072
  v_mfma_f32_16x16x32_bf16 v[32:35], a[208:211], a[248:251], v[32:35]
  v_mfma_f32_16x16x32_bf16 v[36:39], a[208:211], a[112:115], v[36:39]
  v_mfma_f32_16x16x32_bf16 v[36:39], a[68:71], a[108:111], v[36:39]
  v_mfma_f32_16x16x32_bf16 v[40:43], a[68:71], a[116:119], v[40:43]
  v_mfma_f32_16x16x32_bf16 v[40:43], a[208:211], a[120:123], v[40:43]
  v_mfma_f32_16x16x32_bf16 v[44:47], a[208:211], a[168:171], v[44:47]
  v_mfma_f32_16x16x32_bf16 v[44:47], a[68:71], a[164:167], v[44:47]
  s_waitcnt lgkmcnt(1)
  v_mfma_f32_16x16x32_bf16 v[48:51], a[72:75], a[228:231], v[48:51]
  ds_read_b128 v[152:155], v122 offset:16384
  ds_read_b128 v[136:139], v122 offset:33792
  v_mfma_f32_16x16x32_bf16 v[48:51], v[244:247], a[248:251], v[48:51]
  v_mfma_f32_16x16x32_bf16 v[52:55], v[244:247], a[112:115], v[52:55]
  v_mfma_f32_16x16x32_bf16 v[52:55], a[72:75], a[108:111], v[52:55]
  v_mfma_f32_16x16x32_bf16 v[56:59], a[72:75], a[116:119], v[56:59]
  v_mfma_f32_16x16x32_bf16 v[56:59], v[244:247], a[120:123], v[56:59]
  v_mfma_f32_16x16x32_bf16 v[60:63], v[244:247], a[168:171], v[60:63]
  v_mfma_f32_16x16x32_bf16 v[60:63], a[72:75], a[164:167], v[60:63]
  s_waitcnt lgkmcnt(2)
  v_mfma_f32_16x16x32_bf16 v[64:67], a[76:79], a[228:231], v[64:67]
  ds_read_b128 v[156:159], v122 offset:17408
  ds_read_b128 v[140:143], v122 offset:34816
  v_mfma_f32_16x16x32_bf16 v[64:67], v[132:135], a[248:251], v[64:67]
  v_mfma_f32_16x16x32_bf16 v[68:71], v[132:135], a[112:115], v[68:71]
  v_mfma_f32_16x16x32_bf16 v[68:71], a[76:79], a[108:111], v[68:71]
  v_mfma_f32_16x16x32_bf16 v[72:75], a[76:79], a[116:119], v[72:75]
  v_mfma_f32_16x16x32_bf16 v[72:75], v[132:135], a[120:123], v[72:75]
  v_mfma_f32_16x16x32_bf16 v[76:79], v[132:135], a[168:171], v[76:79]
  v_mfma_f32_16x16x32_bf16 v[76:79], a[76:79], a[164:167], v[76:79]
  s_waitcnt vmcnt(10) lgkmcnt(2)
  v_mfma_f32_16x16x32_bf16 v[0:3], v[152:155], a[100:103], v[0:3]
  ds_read_b128 v[160:163], v122 offset:18432
  ds_read_b128 v[144:147], v122 offset:35840
  v_mfma_f32_16x16x32_bf16 v[0:3], v[136:139], a[104:107], v[0:3]
  v_mfma_f32_16x16x32_bf16 v[4:7], v[136:139], a[144:147], v[4:7]
  v_mfma_f32_16x16x32_bf16 v[4:7], v[152:155], a[252:255], v[4:7]
  v_mfma_f32_16x16x32_bf16 v[8:11], v[152:155], a[128:131], v[8:11]
  v_mfma_f32_16x16x32_bf16 v[8:11], v[136:139], a[148:151], v[8:11]
  v_mfma_f32_16x16x32_bf16 v[12:15], v[136:139], a[152:155], v[12:15]
  v_mfma_f32_16x16x32_bf16 v[12:15], v[152:155], a[132:135], v[12:15]
  s_waitcnt lgkmcnt(2)
  v_mfma_f32_16x16x32_bf16 v[16:19], v[156:159], a[100:103], v[16:19]
  ds_read_b128 v[164:167], v122 offset:19456
  ds_read_b128 v[148:151], v202 offset:0
  v_mfma_f32_16x16x32_bf16 v[16:19], v[140:143], a[104:107], v[16:19]
  v_mfma_f32_16x16x32_bf16 v[20:23], v[140:143], a[144:147], v[20:23]
  v_mfma_f32_16x16x32_bf16 v[20:23], v[156:159], a[252:255], v[20:23]
  v_mfma_f32_16x16x32_bf16 v[24:27], v[156:159], a[128:131], v[24:27]
  v_mfma_f32_16x16x32_bf16 v[24:27], v[140:143], a[148:151], v[24:27]
  v_mfma_f32_16x16x32_bf16 v[28:31], v[140:143], a[152:155], v[28:31]
  v_mfma_f32_16x16x32_bf16 v[28:31], v[156:159], a[132:135], v[28:31]
  s_waitcnt lgkmcnt(2)
  v_mfma_f32_16x16x32_bf16 v[32:35], v[160:163], a[100:103], v[32:35]
  ds_read_b128 v[168:171], v122 offset:32768
  ds_read_b128 a[88:91], v202 offset:1024
  v_mfma_f32_16x16x32_bf16 v[32:35], v[144:147], a[104:107], v[32:35]
  v_mfma_f32_16x16x32_bf16 v[36:39], v[144:147], a[144:147], v[36:39]
  v_mfma_f32_16x16x32_bf16 v[36:39], v[160:163], a[252:255], v[36:39]
  v_mfma_f32_16x16x32_bf16 v[40:43], v[160:163], a[128:131], v[40:43]
  v_mfma_f32_16x16x32_bf16 v[40:43], v[144:147], a[148:151], v[40:43]
  v_mfma_f32_16x16x32_bf16 v[44:47], v[144:147], a[152:155], v[44:47]
  v_mfma_f32_16x16x32_bf16 v[44:47], v[160:163], a[132:135], v[44:47]
  s_waitcnt lgkmcnt(2)
  v_mfma_f32_16x16x32_bf16 v[48:51], v[164:167], a[100:103], v[48:51]
  ds_read_b128 a[124:127], v202 offset:2048
  ds_read_b128 a[160:163], v202 offset:19456
  v_mfma_f32_16x16x32_bf16 v[48:51], v[148:151], a[104:107], v[48:51]
  v_mfma_f32_16x16x32_bf16 v[52:55], v[148:151], a[144:147], v[52:55]
  v_mfma_f32_16x16x32_bf16 v[52:55], v[164:167], a[252:255], v[52:55]
  v_mfma_f32_16x16x32_bf16 v[56:59], v[164:167], a[128:131], v[56:59]
  v_mfma_f32_16x16x32_bf16 v[56:59], v[148:151], a[148:151], v[56:59]
  v_mfma_f32_16x16x32_bf16 v[60:63], v[148:151], a[152:155], v[60:63]
  v_mfma_f32_16x16x32_bf16 v[60:63], v[164:167], a[132:135], v[60:63]
  s_waitcnt lgkmcnt(2)
  v_mfma_f32_16x16x32_bf16 v[64:67], v[168:171], a[100:103], v[64:67]
  ds_read_b128 a[180:183], v202 offset:3072
  ds_read_b128 a[184:187], v122 offset:49152
  v_mfma_f32_16x16x32_bf16 v[64:67], a[88:91], a[104:107], v[64:67]
  v_mfma_f32_16x16x32_bf16 v[68:71], a[88:91], a[144:147], v[68:71]
  v_mfma_f32_16x16x32_bf16 v[68:71], v[168:171], a[252:255], v[68:71]
  v_mfma_f32_16x16x32_bf16 v[72:75], v[168:171], a[128:131], v[72:75]
  v_mfma_f32_16x16x32_bf16 v[72:75], a[88:91], a[148:151], v[72:75]
  v_mfma_f32_16x16x32_bf16 v[76:79], a[88:91], a[152:155], v[76:79]
  v_mfma_f32_16x16x32_bf16 v[76:79], v[168:171], a[132:135], v[76:79]
  s_waitcnt vmcnt(0)
  v_cmp_lt_u32 vcc, v195, v201
  s_nop 0
  s_cbranch_vccz tail_partner
  s_mov_b32 s35, 32768
tail_spin2:
  s_sleep 2
  buffer_load_dword v195, v200, s[24:27], 0 offen sc1
  s_waitcnt vmcnt(0)
  v_cmp_lt_u32 vcc, v195, v201
  s_nop 0
  s_cbranch_vccz tail_partner
  s_sub_u32 s35, s35, 1
  s_cmp_lg_u32 s35, 0
  s_cbranch_scc1 tail_spin2
tail_partner:
  s_waitcnt lgkmcnt(2)
  v_mfma_f32_16x16x32_bf16 v[0:3], a[124:127], a[136:139], v[0:3]
  ds_read_b128 a[196:199], v202 offset:16384
  ds_read_b128 a[200:203], v122 offset:50176
  v_mfma_f32_16x16x32_bf16 v[0:3], a[160:163], a[156:159], v[0:3]
  buffer_load_dwordx2 v[206:207], v192, s[24:27], s38 offen offset:0 sc1
  v_mfma_f32_16x16x32_bf16 v[4:7], a[160:163], v[128:131], v[4:7]
  buffer_load_dwordx2 v[210:211], v192, s[24:27], s38 offen offset:512 sc1
  v_mfma_f32_16x16x32_bf16 v[4:7], a[124:127], a[140:143], v[4:7]
  buffer_load_dwordx2 v[214:215], v192, s[24:27], s38 offen offset:1024 sc1
  v_mfma_f32_16x16x32_bf16 v[8:11], a[124:127], a[172:175], v[8:11]
  buffer_load_dwordx2 v[218:219], v192, s[24:27], s38 offen offset:1536 sc1
  v_mfma_f32_16x16x32_bf16 v[8:11], a[160:163], a[176:179], v[8:11]
  buffer_load_dwordx2 v[222:223], v192, s[24:27], s38 offen offset:2048 sc1
  v_mfma_f32_16x16x32_bf16 v[12:15], a[160:163], a[192:195], v[12:15]
  v_mfma_f32_16x16x32_bf16 v[12:15], a[124:127], a[188:191], v[12:15]
  s_waitcnt lgkmcnt(2)
  v_mfma_f32_16x16x32_bf16 v[16:19], a[180:183], a[136:139], v[16:19]
  ds_read_b128 v[172:175], v202 offset:17408
  ds_read_b128 a[0:3], v122 offset:51200
  v_mfma_f32_16x16x32_bf16 v[16:19], a[184:187], a[156:159], v[16:19]
  ds_write_b128 v122, v[4:7] offset:0
  ds_write_b128 v122, v[8:11] offset:17408
  v_mfma_f32_16x16x32_bf16 v[20:23], a[184:187], v[128:131], v[20:23]
  ds_write_b128 v122, v[12:15] offset:34816
  v_mfma_f32_16x16x32_bf16 v[20:23], a[180:183], a[140:143], v[20:23]
  v_mfma_f32_16x16x32_bf16 v[24:27], a[180:183], a[172:175], v[24:27]
  v_mfma_f32_16x16x32_bf16 v[24:27], a[184:187], a[176:179], v[24:27]
  v_mfma_f32_16x16x32_bf16 v[28:31], a[184:187], a[192:195], v[28:31]
  v_mfma_f32_16x16x32_bf16 v[28:31], a[180:183], a[188:191], v[28:31]
  s_waitcnt lgkmcnt(5)
  v_mfma_f32_16x16x32_bf16 v[32:35], a[196:199], a[136:139], v[32:35]
  ds_read_b128 v[176:179], v202 offset:18432
  ds_read_b128 a[4:7], v122 offset:52224
  v_mfma_f32_16x16x32_bf16 v[32:35], a[200:203], a[156:159], v[32:35]
  ds_write_b128 v122, v[20:23] offset:1024
  ds_write_b128 v122, v[24:27] offset:18432
  v_mfma_f32_16x16x32_bf16 v[36:39], a[200:203], v[128:131], v[36:39]
  ds_write_b128 v122, v[28:31] offset:35840
  v_mfma_f32_16x16x32_bf16 v[36:39], a[196:199], a[140:143], v[36:39]
  v_mfma_f32_16x16x32_bf16 v[40:43], a[196:199], a[172:175], v[40:43]
  v_mfma_f32_16x16x32_bf16 v[40:43], a[200:203], a[176:179], v[40:43]
  v_mfma_f32_16x16x32_bf16 v[44:47], a[200:203], a[192:195], v[44:47]
  v_mfma_f32_16x16x32_bf16 v[44:47], a[196:199], a[188:191], v[44:47]
  s_waitcnt lgkmcnt(8)
  v_mfma_f32_16x16x32_bf16 v[48:51], v[172:175], a[136:139], v[48:51]
  v_mfma_f32_16x16x32_bf16 v[48:51], a[0:3], a[156:159], v[48:51]
  v_mfma_f32_16x16x32_bf16 v[52:55], a[0:3], v[128:131], v[52:55]
  ds_write_b128 v122, v[36:39] offset:2048
  v_mfma_f32_16x16x32_bf16 v[52:55], v[172:175], a[140:143], v[52:55]
  ds_write_b128 v122, v[40:43] offset:19456
  v_mfma_f32_16x16x32_bf16 v[56:59], v[172:175], a[172:175], v[56:59]
  ds_write_b128 v122, v[44:47] offset:49152
  v_mfma_f32_16x16x32_bf16 v[56:59], a[0:3], a[176:179], v[56:59]
  v_mfma_f32_16x16x32_bf16 v[60:63], a[0:3], a[192:195], v[60:63]
  v_mfma_f32_16x16x32_bf16 v[60:63], v[172:175], a[188:191], v[60:63]
  s_waitcnt lgkmcnt(6)
  v_mfma_f32_16x16x32_bf16 v[64:67], v[176:179], a[136:139], v[64:67]
  ds_write_b128 v122, v[52:55] offset:3072
  v_mfma_f32_16x16x32_bf16 v[64:67], a[4:7], a[156:159], v[64:67]
  v_mfma_f32_16x16x32_bf16 v[68:71], a[4:7], v[128:131], v[68:71]
  v_mfma_f32_16x16x32_bf16 v[68:71], v[176:179], a[140:143], v[68:71]
  ds_write_b128 v122, v[56:59] offset:32768
  v_mfma_f32_16x16x32_bf16 v[72:75], v[176:179], a[172:175], v[72:75]
  ds_write_b128 v122, v[60:63] offset:50176
  v_mfma_f32_16x16x32_bf16 v[72:75], a[4:7], a[176:179], v[72:75]
  v_mfma_f32_16x16x32_bf16 v[76:79], a[4:7], a[192:195], v[76:79]
  v_mfma_f32_16x16x32_bf16 v[76:79], v[176:179], a[188:191], v[76:79]
  s_nop 1
  ds_write_b128 v122, v[68:71] offset:16384
  s_nop 2
  ds_write_b128 v122, v[72:75] offset:33792
  s_nop 0
  ds_write_b128 v122, v[76:79] offset:51200
  s_waitcnt vmcnt(4)
  v_lshlrev_b32 v204, 16, v206
  v_and_b32 v205, s34, v206
  v_lshlrev_b32 v206, 16, v207
  v_and_b32 v207, s34, v207
  v_pk_add_f32 v[0:1], v[0:1], v[204:205]
  v_pk_add_f32 v[2:3], v[2:3], v[206:207]
  s_waitcnt vmcnt(3)
  v_lshlrev_b32 v208, 16, v210
  v_and_b32 v209, s34, v210
  v_lshlrev_b32 v210, 16, v211
  v_and_b32 v211, s34, v211
  v_pk_add_f32 v[16:17], v[16:17], v[208:209]
  v_pk_add_f32 v[18:19], v[18:19], v[210:211]
  s_waitcnt vmcnt(2)
  v_lshlrev_b32 v212, 16, v214
  v_and_b32 v213, s34, v214
  v_lshlrev_b32 v214, 16, v215
  v_and_b32 v215, s34, v215
  v_pk_add_f32 v[32:33], v[32:33], v[212:213]
  v_pk_add_f32 v[34:35], v[34:35], v[214:215]
  s_waitcnt vmcnt(1)
  v_lshlrev_b32 v216, 16, v218
  v_and_b32 v217, s34, v218
  v_lshlrev_b32 v218, 16, v219
  v_and_b32 v219, s34, v219
  v_pk_add_f32 v[48:49], v[48:49], v[216:217]
  v_pk_add_f32 v[50:51], v[50:51], v[218:219]
  s_waitcnt vmcnt(0)
  v_lshlrev_b32 v220, 16, v222
  v_and_b32 v221, s34, v222
  v_lshlrev_b32 v222, 16, v223
  v_and_b32 v223, s34, v223
  v_pk_add_f32 v[64:65], v[64:65], v[220:221]
  v_pk_add_f32 v[66:67], v[66:67], v[222:223]
  s_waitcnt lgkmcnt(0)
  s_barrier
  ds_read_b128 v[4:7], v80 offset:0
  ds_read_b128 v[8:11], v81 offset:17408
  ds_read_b128 v[12:15], v82 offset:34816
  ds_read_b128 v[20:23], v80 offset:1024
  ds_read_b128 v[24:27], v81 offset:18432
  ds_read_b128 v[28:31], v82 offset:35840
  ds_read_b128 v[36:39], v80 offset:2048
  ds_read_b128 v[40:43], v81 offset:19456
  ds_read_b128 v[44:47], v82 offset:49152
  ds_read_b128 v[52:55], v80 offset:3072
  ds_read_b128 v[56:59], v81 offset:32768
  ds_read_b128 v[60:63], v82 offset:50176
  ds_read_b128 v[68:71], v80 offset:16384
  ds_read_b128 v[72:75], v81 offset:33792
  ds_read_b128 v[76:79], v82 offset:51200
  s_waitcnt lgkmcnt(13)
  v_pk_add_f32 v[4:5], v[4:5], v[8:9]
  v_pk_add_f32 v[6:7], v[6:7], v[10:11]
  s_waitcnt lgkmcnt(12)
  v_pk_add_f32 v[0:1], v[0:1], v[12:13]
  v_pk_add_f32 v[2:3], v[2:3], v[14:15]
  v_pk_add_f32 v[0:1], v[0:1], v[4:5]
  v_pk_add_f32 v[2:3], v[2:3], v[6:7]
  v_cvt_pk_bf16_f32 v4, v0, v1
  v_cvt_pk_bf16_f32 v5, v2, v3
  v_lshlrev_b32 v0, 16, v4
  v_and_b32 v1, s34, v4
  v_lshlrev_b32 v2, 16, v5
  v_and_b32 v3, s34, v5
  v_pk_mul_f32 v[0:1], v[0:1], v[90:91]
  v_pk_mul_f32 v[2:3], v[2:3], v[92:93]
  v_cvt_pk_bf16_f32 v4, v0, v1
  v_cvt_pk_bf16_f32 v5, v2, v3
  v_lshlrev_b32 v0, 16, v4
  v_and_b32 v1, s34, v4
  v_lshlrev_b32 v2, 16, v5
  v_and_b32 v3, s34, v5
  v_pk_add_f32 v[0:1], v[0:1], v[224:225]
  v_pk_add_f32 v[2:3], v[2:3], v[226:227]
  v_cvt_pk_bf16_f32 v4, v0, v1
  v_cvt_pk_bf16_f32 v5, v2, v3
  s_waitcnt lgkmcnt(10)
  v_pk_add_f32 v[20:21], v[20:21], v[24:25]
  v_pk_add_f32 v[22:23], v[22:23], v[26:27]
  s_waitcnt lgkmcnt(9)
  v_pk_add_f32 v[16:17], v[16:17], v[28:29]
  v_pk_add_f32 v[18:19], v[18:19], v[30:31]
  v_pk_add_f32 v[16:17], v[16:17], v[20:21]
  v_pk_add_f32 v[18:19], v[18:19], v[22:23]
  v_cvt_pk_bf16_f32 v20, v16, v17
  v_cvt_pk_bf16_f32 v21, v18, v19
  v_lshlrev_b32 v16, 16, v20
  v_and_b32 v17, s34, v20
  v_lshlrev_b32 v18, 16, v21
  v_and_b32 v19, s34, v21
  v_pk_mul_f32 v[16:17], v[16:17], v[94:95]
  v_pk_mul_f32 v[18:19], v[18:19], v[96:97]
  v_cvt_pk_bf16_f32 v20, v16, v17
  v_cvt_pk_bf16_f32 v21, v18, v19
  v_lshlrev_b32 v16, 16, v20
  v_and_b32 v17, s34, v20
  v_lshlrev_b32 v18, 16, v21
  v_and_b32 v19, s34, v21
  v_pk_add_f32 v[16:17], v[16:17], v[228:229]
  v_pk_add_f32 v[18:19], v[18:19], v[230:231]
  v_cvt_pk_bf16_f32 v6, v16, v17
  v_cvt_pk_bf16_f32 v7, v18, v19
  s_nop 0
  v_permlane16_swap_b32 v4, v6
  v_permlane16_swap_b32 v5, v7
  buffer_store_dwordx4 v[4:7], v83, s[16:19], 0 offen offset:0
  s_waitcnt lgkmcnt(7)
  v_pk_add_f32 v[36:37], v[36:37], v[40:41]
  v_pk_add_f32 v[38:39], v[38:39], v[42:43]
  s_waitcnt lgkmcnt(6)
  v_pk_add_f32 v[32:33], v[32:33], v[44:45]
  v_pk_add_f32 v[34:35], v[34:35], v[46:47]
  v_pk_add_f32 v[32:33], v[32:33], v[36:37]
  v_pk_add_f32 v[34:35], v[34:35], v[38:39]
  v_cvt_pk_bf16_f32 v36, v32, v33
  v_cvt_pk_bf16_f32 v37, v34, v35
  v_lshlrev_b32 v32, 16, v36
  v_and_b32 v33, s34, v36
  v_lshlrev_b32 v34, 16, v37
  v_and_b32 v35, s34, v37
  v_pk_mul_f32 v[32:33], v[32:33], v[98:99]
  v_pk_mul_f32 v[34:35], v[34:35], v[100:101]
  v_cvt_pk_bf16_f32 v36, v32, v33
  v_cvt_pk_bf16_f32 v37, v34, v35
  v_lshlrev_b32 v32, 16, v36
  v_and_b32 v33, s34, v36
  v_lshlrev_b32 v34, 16, v37
  v_and_b32 v35, s34, v37
  v_pk_add_f32 v[32:33], v[32:33], v[232:233]
  v_pk_add_f32 v[34:35], v[34:35], v[234:235]
  v_cvt_pk_bf16_f32 v36, v32, v33
  v_cvt_pk_bf16_f32 v37, v34, v35
  s_waitcnt lgkmcnt(4)
  v_pk_add_f32 v[52:53], v[52:53], v[56:57]
  v_pk_add_f32 v[54:55], v[54:55], v[58:59]
  s_waitcnt lgkmcnt(3)
  v_pk_add_f32 v[48:49], v[48:49], v[60:61]
  v_pk_add_f32 v[50:51], v[50:51], v[62:63]
  v_pk_add_f32 v[48:49], v[48:49], v[52:53]
  v_pk_add_f32 v[50:51], v[50:51], v[54:55]
  v_cvt_pk_bf16_f32 v52, v48, v49
  v_cvt_pk_bf16_f32 v53, v50, v51
  v_lshlrev_b32 v48, 16, v52
  v_and_b32 v49, s34, v52
  v_lshlrev_b32 v50, 16, v53
  v_and_b32 v51, s34, v53
  v_pk_mul_f32 v[48:49], v[48:49], v[102:103]
  v_pk_mul_f32 v[50:51], v[50:51], v[104:105]
  v_cvt_pk_bf16_f32 v52, v48, v49
  v_cvt_pk_bf16_f32 v53, v50, v51
  v_lshlrev_b32 v48, 16, v52
  v_and_b32 v49, s34, v52
  v_lshlrev_b32 v50, 16, v53
  v_and_b32 v51, s34, v53
  v_pk_add_f32 v[48:49], v[48:49], v[236:237]
  v_pk_add_f32 v[50:51], v[50:51], v[238:239]
  v_cvt_pk_bf16_f32 v38, v48, v49
  v_cvt_pk_bf16_f32 v39, v50, v51
  s_nop 0
  v_permlane16_swap_b32 v36, v38
  v_permlane16_swap_b32 v37, v39
  buffer_store_dwordx4 v[36:39], v83, s[16:19], 0 offen offset:64
  s_waitcnt lgkmcnt(1)
  v_pk_add_f32 v[68:69], v[68:69], v[72:73]
  v_pk_add_f32 v[70:71], v[70:71], v[74:75]
  s_waitcnt lgkmcnt(0)
  v_pk_add_f32 v[64:65], v[64:65], v[76:77]
  v_pk_add_f32 v[66:67], v[66:67], v[78:79]
  v_pk_add_f32 v[64:65], v[64:65], v[68:69]
  v_pk_add_f32 v[66:67], v[66:67], v[70:71]
  v_cvt_pk_bf16_f32 v68, v64, v65
  v_cvt_pk_bf16_f32 v69, v66, v67
  v_lshlrev_b32 v64, 16, v68
  v_and_b32 v65, s34, v68
  v_lshlrev_b32 v66, 16, v69
  v_and_b32 v67, s34, v69
  v_pk_mul_f32 v[64:65], v[64:65], v[106:107]
  v_pk_mul_f32 v[66:67], v[66:67], v[108:109]
  v_cvt_pk_bf16_f32 v68, v64, v65
  v_cvt_pk_bf16_f32 v69, v66, v67
  v_lshlrev_b32 v64, 16, v68
  v_and_b32 v65, s34, v68
  v_lshlrev_b32 v66, 16, v69
  v_and_b32 v67, s34, v69
  v_pk_add_f32 v[64:65], v[64:65], v[240:241]
  v_pk_add_f32 v[66:67], v[66:67], v[242:243]
  v_cvt_pk_bf16_f32 v68, v64, v65
  v_cvt_pk_bf16_f32 v69, v66, v67
  buffer_store_dwordx2 v[68:69], v117, s[16:19], 0 offen offset:128
attn_end:
  s_endpgm
attn_redo:
  s_load_dwordx2 s[48:49], s[0:1], 24
  s_waitcnt vmcnt(0) lgkmcnt(0)
  s_lshl_b32 s38, s36, 8
  s_add_u32 s20, s48, s38
  s_addc_u32 s21, s49, 0
  s_mov_b32 s22, 5242880
  s_mov_b32 s23, 0x20000
  s_sub_u32 s22, s22, s38
  v_lshrrev_b32 v245, 4, v242
  v_add_u32 v243, 0x1000, v242
  s_mul_i32 s30, s37, 81920
  s_mov_b32 s31, 0
  v_lshrrev_b32 v248, 4, v245
  v_and_b32 v247, 15, v245
  s_lshl_b32 s38, s3, 17
  v_lshlrev_b32 v249, 13, v248
  v_add_u32 v249, s38, v249
  v_or_b32 v250, 0, v248
  v_lshlrev_b32 v250, 1, v250
  v_xor_b32 v250, v250, v247
  v_lshl_add_u32 v238, v250, 4, v249
  v_or_b32 v250, 0, v248
  v_lshlrev_b32 v250, 1, v250
  v_xor_b32 v250, v250, v247
  v_lshl_add_u32 v239, v250, 4, v249
  v_add_u32 v239, 31744, v239
  v_or_b32 v250, 4, v248
  v_lshlrev_b32 v250, 1, v250
  v_xor_b32 v250, v250, v247
  v_lshl_add_u32 v240, v250, 4, v249
  v_add_u32 v240, 63488, v240
  v_or_b32 v250, 4, v248
  v_lshlrev_b32 v250, 1, v250
  v_xor_b32 v250, v250, v247
  v_lshl_add_u32 v241, v250, 4, v249
  v_add_u32 v241, 95232, v241
  v_bfe_u32 v246, v245, 2, 2
  v_and_b32 v247, 3, v245
  v_lshlrev_b32 v247, 3, v247
  v_add_u32 v247, 65536, v247
  v_lshl_add_u32 v249, v248, 3, v246
  v_and_b32 v250, 1, v248
  v_lshl_add_u32 v250, v250, 2, v246
  v_lshl_add_u32 v250, v250, 5, v247
  v_lshl_add_u32 v224, v249, 8, v250
  v_xor_b32 v225, 32, v224
  v_xor_b32 v226, 64, v224
  v_xor_b32 v227, 96, v224
  v_xor_b32 v228, 128, v224
  v_xor_b32 v229, 160, v224
  v_xor_b32 v230, 192, v224
  v_xor_b32 v231, 224, v224
  v_mov_b32 v0, 0
  v_mov_b32 v1, 0
  v_mov_b32 v2, 0
  v_mov_b32 v3, 0
  v_mov_b32 v4, 0
  v_mov_b32 v5, 0
  v_mov_b32 v6, 0
  v_mov_b32 v7, 0
  v_mov_b32 v8, 0
  v_mov_b32 v9, 0
  v_mov_b32 v10, 0
  v_mov_b32 v11, 0
  v_mov_b32 v12, 0
  v_mov_b32 v13, 0
  v_mov_b32 v14, 0
  v_mov_b32 v15, 0
  v_mov_b32 v16, 0
  v_mov_b32 v17, 0
  v_mov_b32 v18, 0
  v_mov_b32 v19, 0
  v_mov_b32 v20, 0
  v_mov_b32 v21, 0
  v_mov_b32 v22, 0
  v_mov_b32 v23, 0
  v_mov_b32 v24, 0
  v_mov_b32 v25, 0
  v_mov_b32 v26, 0
  v_mov_b32 v27, 0
  v_mov_b32 v28, 0
  v_mov_b32 v29, 0
  v_mov_b32 v30, 0
  v_mov_b32 v31, 0
  v_mov_b32 v32, 0
  v_mov_b32 v33, 0
  v_mov_b32 v34, 0
  v_mov_b32 v35, 0
  v_mov_b32 v36, 0
  v_mov_b32 v37, 0
  v_mov_b32 v38, 0
  v_mov_b32 v39, 0
  v_mov_b32 v40, 0
  v_mov_b32 v41, 0
  v_mov_b32 v42, 0
  v_mov_b32 v43, 0
  v_mov_b32 v44, 0
  v_mov_b32 v45, 0
  v_mov_b32 v46, 0
  v_mov_b32 v47, 0
  v_mov_b32 v48, 0
  v_mov_b32 v49, 0
  v_mov_b32 v50, 0
  v_mov_b32 v51, 0
  v_mov_b32 v52, 0
  v_mov_b32 v53, 0
  v_mov_b32 v54, 0
  v_mov_b32 v55, 0
  v_mov_b32 v56, 0
  v_mov_b32 v57, 0
  v_mov_b32 v58, 0
  v_mov_b32 v59, 0
  v_mov_b32 v60, 0
  v_mov_b32 v61, 0
  v_mov_b32 v62, 0
  v_mov_b32 v63, 0
  v_mov_b32 v64, 0
  v_mov_b32 v65, 0
  v_mov_b32 v66, 0
  v_mov_b32 v67, 0
  v_mov_b32 v68, 0
  v_mov_b32 v69, 0
  v_mov_b32 v70, 0
  v_mov_b32 v71, 0
  v_mov_b32 v72, 0
  v_mov_b32 v73, 0
  v_mov_b32 v74, 0
  v_mov_b32 v75, 0
  v_mov_b32 v76, 0
  v_mov_b32 v77, 0
  v_mov_b32 v78, 0
  v_mov_b32 v79, 0
  v_mov_b32 v80, 0
  v_mov_b32 v81, 0
  v_mov_b32 v82, 0
  v_mov_b32 v83, 0
  v_mov_b32 v84, 0
  v_mov_b32 v85, 0
  v_mov_b32 v86, 0
  v_mov_b32 v87, 0
  v_mov_b32 v88, 0
  v_mov_b32 v89, 0
  v_mov_b32 v90, 0
  v_mov_b32 v91, 0
  v_mov_b32 v92, 0
  v_mov_b32 v93, 0
  v_mov_b32 v94, 0
  v_mov_b32 v95, 0
  v_mov_b32 v96, 0
  v_mov_b32 v97, 0
  v_mov_b32 v98, 0
  v_mov_b32 v99, 0
  v_mov_b32 v100, 0
  v_mov_b32 v101, 0
  v_mov_b32 v102, 0
  v_mov_b32 v103, 0
  v_mov_b32 v104, 0
  v_mov_b32 v105, 0
  v_mov_b32 v106, 0
  v_mov_b32 v107, 0
  v_mov_b32 v108, 0
  v_mov_b32 v109, 0
  v_mov_b32 v110, 0
  v_mov_b32 v111, 0
  v_mov_b32 v112, 0
  v_mov_b32 v113, 0
  v_mov_b32 v114, 0
  v_mov_b32 v115, 0
  v_mov_b32 v116, 0
  v_mov_b32 v117, 0
  v_mov_b32 v118, 0
  v_mov_b32 v119, 0
  v_mov_b32 v120, 0
  v_mov_b32 v121, 0
  v_mov_b32 v122, 0
  v_mov_b32 v123, 0
  v_mov_b32 v124, 0
  v_mov_b32 v125, 0
  v_mov_b32 v126, 0
  v_mov_b32 v127, 0
attn_requery:
  s_barrier
  s_add_u32 m0, s28, 114688
  s_nop 0
  buffer_load_dwordx4 v238, s[20:23], s31 offen offset:0 lds
  buffer_load_dwordx4 v239, s[20:23], s31 offen offset:1024 lds
  buffer_load_dwordx4 v240, s[20:23], s31 offen offset:2048 lds
  buffer_load_dwordx4 v241, s[20:23], s31 offen offset:3072 lds
  buffer_load_dwordx4 a[0:3], v242, s[24:27], s30 offen offset:0 sc1
  buffer_load_dwordx4 a[4:7], v242, s[24:27], s30 offen offset:1024 sc1
  buffer_load_dwordx4 a[8:11], v242, s[24:27], s30 offen offset:2048 sc1
  buffer_load_dwordx4 a[12:15], v242, s[24:27], s30 offen offset:3072 sc1
  buffer_load_dwordx4 a[16:19], v243, s[24:27], s30 offen offset:0 sc1
  buffer_load_dwordx4 a[20:23], v243, s[24:27], s30 offen offset:1024 sc1
  buffer_load_dwordx4 a[24:27], v243, s[24:27], s30 offen offset:2048 sc1
  buffer_load_dwordx4 a[28:31], v243, s[24:27], s30 offen offset:3072 sc1
  s_add_u32 s30, s30, 8192
  s_waitcnt vmcnt(0)
  s_barrier
  ds_read_b64_tr_b16 a[160:161], v224 offset:49152
  ds_read_b64_tr_b16 a[162:163], v224 offset:50176
  ds_read_b64_tr_b16 a[164:165], v224 offset:57344
  ds_read_b64_tr_b16 a[166:167], v224 offset:58368
  s_waitcnt lgkmcnt(2)
  v_mfma_f32_16x16x32_bf16 v[0:3], a[160:163], a[0:3], v[0:3]
  s_waitcnt lgkmcnt(0)
  v_mfma_f32_16x16x32_bf16 v[0:3], a[164:167], a[16:19], v[0:3]
  v_mfma_f32_16x16x32_bf16 v[4:7], a[164:167], a[20:23], v[4:7]
  v_mfma_f32_16x16x32_bf16 v[4:7], a[160:163], a[4:7], v[4:7]
  v_mfma_f32_16x16x32_bf16 v[8:11], a[160:163], a[8:11], v[8:11]
  v_mfma_f32_16x16x32_bf16 v[8:11], a[164:167], a[24:27], v[8:11]
  v_mfma_f32_16x16x32_bf16 v[12:15], a[164:167], a[28:31], v[12:15]
  v_mfma_f32_16x16x32_bf16 v[12:15], a[160:163], a[12:15], v[12:15]
  ds_read_b64_tr_b16 a[168:169], v225 offset:49152
  ds_read_b64_tr_b16 a[170:171], v225 offset:50176
  ds_read_b64_tr_b16 a[172:173], v225 offset:57344
  ds_read_b64_tr_b16 a[174:175], v225 offset:58368
  s_waitcnt lgkmcnt(2)
  v_mfma_f32_16x16x32_bf16 v[16:19], a[168:171], a[0:3], v[16:19]
  s_waitcnt lgkmcnt(0)
  v_mfma_f32_16x16x32_bf16 v[16:19], a[172:175], a[16:19], v[16:19]
  v_mfma_f32_16x16x32_bf16 v[20:23], a[172:175], a[20:23], v[20:23]
  v_mfma_f32_16x16x32_bf16 v[20:23], a[168:171], a[4:7], v[20:23]
  v_mfma_f32_16x16x32_bf16 v[24:27], a[168:171], a[8:11], v[24:27]
  v_mfma_f32_16x16x32_bf16 v[24:27], a[172:175], a[24:27], v[24:27]
  v_mfma_f32_16x16x32_bf16 v[28:31], a[172:175], a[28:31], v[28:31]
  v_mfma_f32_16x16x32_bf16 v[28:31], a[168:171], a[12:15], v[28:31]
  ds_read_b64_tr_b16 a[176:177], v226 offset:49152
  ds_read_b64_tr_b16 a[178:179], v226 offset:50176
  ds_read_b64_tr_b16 a[180:181], v226 offset:57344
  ds_read_b64_tr_b16 a[182:183], v226 offset:58368
  s_waitcnt lgkmcnt(2)
  v_mfma_f32_16x16x32_bf16 v[32:35], a[176:179], a[0:3], v[32:35]
  s_waitcnt lgkmcnt(0)
  v_mfma_f32_16x16x32_bf16 v[32:35], a[180:183], a[16:19], v[32:35]
  v_mfma_f32_16x16x32_bf16 v[36:39], a[180:183], a[20:23], v[36:39]
  v_mfma_f32_16x16x32_bf16 v[36:39], a[176:179], a[4:7], v[36:39]
  v_mfma_f32_16x16x32_bf16 v[40:43], a[176:179], a[8:11], v[40:43]
  v_mfma_f32_16x16x32_bf16 v[40:43], a[180:183], a[24:27], v[40:43]
  v_mfma_f32_16x16x32_bf16 v[44:47], a[180:183], a[28:31], v[44:47]
  v_mfma_f32_16x16x32_bf16 v[44:47], a[176:179], a[12:15], v[44:47]
  ds_read_b64_tr_b16 a[184:185], v227 offset:49152
  ds_read_b64_tr_b16 a[186:187], v227 offset:50176
  ds_read_b64_tr_b16 a[188:189], v227 offset:57344
  ds_read_b64_tr_b16 a[190:191], v227 offset:58368
  s_waitcnt lgkmcnt(2)
  v_mfma_f32_16x16x32_bf16 v[48:51], a[184:187], a[0:3], v[48:51]
  s_waitcnt lgkmcnt(0)
  v_mfma_f32_16x16x32_bf16 v[48:51], a[188:191], a[16:19], v[48:51]
  v_mfma_f32_16x16x32_bf16 v[52:55], a[188:191], a[20:23], v[52:55]
  v_mfma_f32_16x16x32_bf16 v[52:55], a[184:187], a[4:7], v[52:55]
  v_mfma_f32_16x16x32_bf16 v[56:59], a[184:187], a[8:11], v[56:59]
  v_mfma_f32_16x16x32_bf16 v[56:59], a[188:191], a[24:27], v[56:59]
  v_mfma_f32_16x16x32_bf16 v[60:63], a[188:191], a[28:31], v[60:63]
  v_mfma_f32_16x16x32_bf16 v[60:63], a[184:187], a[12:15], v[60:63]
  ds_read_b64_tr_b16 a[160:161], v228 offset:49152
  ds_read_b64_tr_b16 a[162:163], v228 offset:50176
  ds_read_b64_tr_b16 a[164:165], v228 offset:57344
  ds_read_b64_tr_b16 a[166:167], v228 offset:58368
  s_waitcnt lgkmcnt(2)
  v_mfma_f32_16x16x32_bf16 v[64:67], a[160:163], a[0:3], v[64:67]
  s_waitcnt lgkmcnt(0)
  v_mfma_f32_16x16x32_bf16 v[64:67], a[164:167], a[16:19], v[64:67]
  v_mfma_f32_16x16x32_bf16 v[68:71], a[164:167], a[20:23], v[68:71]
  v_mfma_f32_16x16x32_bf16 v[68:71], a[160:163], a[4:7], v[68:71]
  v_mfma_f32_16x16x32_bf16 v[72:75], a[160:163], a[8:11], v[72:75]
  v_mfma_f32_16x16x32_bf16 v[72:75], a[164:167], a[24:27], v[72:75]
  v_mfma_f32_16x16x32_bf16 v[76:79], a[164:167], a[28:31], v[76:79]
  v_mfma_f32_16x16x32_bf16 v[76:79], a[160:163], a[12:15], v[76:79]
  ds_read_b64_tr_b16 a[168:169], v229 offset:49152
  ds_read_b64_tr_b16 a[170:171], v229 offset:50176
  ds_read_b64_tr_b16 a[172:173], v229 offset:57344
  ds_read_b64_tr_b16 a[174:175], v229 offset:58368
  s_waitcnt lgkmcnt(2)
  v_mfma_f32_16x16x32_bf16 v[80:83], a[168:171], a[0:3], v[80:83]
  s_waitcnt lgkmcnt(0)
  v_mfma_f32_16x16x32_bf16 v[80:83], a[172:175], a[16:19], v[80:83]
  v_mfma_f32_16x16x32_bf16 v[84:87], a[172:175], a[20:23], v[84:87]
  v_mfma_f32_16x16x32_bf16 v[84:87], a[168:171], a[4:7], v[84:87]
  v_mfma_f32_16x16x32_bf16 v[88:91], a[168:171], a[8:11], v[88:91]
  v_mfma_f32_16x16x32_bf16 v[88:91], a[172:175], a[24:27], v[88:91]
  v_mfma_f32_16x16x32_bf16 v[92:95], a[172:175], a[28:31], v[92:95]
  v_mfma_f32_16x16x32_bf16 v[92:95], a[168:171], a[12:15], v[92:95]
  ds_read_b64_tr_b16 a[176:177], v230 offset:49152
  ds_read_b64_tr_b16 a[178:179], v230 offset:50176
  ds_read_b64_tr_b16 a[180:181], v230 offset:57344
  ds_read_b64_tr_b16 a[182:183], v230 offset:58368
  s_waitcnt lgkmcnt(2)
  v_mfma_f32_16x16x32_bf16 v[96:99], a[176:179], a[0:3], v[96:99]
  s_waitcnt lgkmcnt(0)
  v_mfma_f32_16x16x32_bf16 v[96:99], a[180:183], a[16:19], v[96:99]
  v_mfma_f32_16x16x32_bf16 v[100:103], a[180:183], a[20:23], v[100:103]
  v_mfma_f32_16x16x32_bf16 v[100:103], a[176:179], a[4:7], v[100:103]
  v_mfma_f32_16x16x32_bf16 v[104:107], a[176:179], a[8:11], v[104:107]
  v_mfma_f32_16x16x32_bf16 v[104:107], a[180:183], a[24:27], v[104:107]
  v_mfma_f32_16x16x32_bf16 v[108:111], a[180:183], a[28:31], v[108:111]
  v_mfma_f32_16x16x32_bf16 v[108:111], a[176:179], a[12:15], v[108:111]
  ds_read_b64_tr_b16 a[184:185], v231 offset:49152
  ds_read_b64_tr_b16 a[186:187], v231 offset:50176
  ds_read_b64_tr_b16 a[188:189], v231 offset:57344
  ds_read_b64_tr_b16 a[190:191], v231 offset:58368
  s_waitcnt lgkmcnt(2)
  v_mfma_f32_16x16x32_bf16 v[112:115], a[184:187], a[0:3], v[112:115]
  s_waitcnt lgkmcnt(0)
  v_mfma_f32_16x16x32_bf16 v[112:115], a[188:191], a[16:19], v[112:115]
  v_mfma_f32_16x16x32_bf16 v[116:119], a[188:191], a[20:23], v[116:119]
  v_mfma_f32_16x16x32_bf16 v[116:119], a[184:187], a[4:7], v[116:119]
  v_mfma_f32_16x16x32_bf16 v[120:123], a[184:187], a[8:11], v[120:123]
  v_mfma_f32_16x16x32_bf16 v[120:123], a[188:191], a[24:27], v[120:123]
  v_mfma_f32_16x16x32_bf16 v[124:127], a[188:191], a[28:31], v[124:127]
  v_mfma_f32_16x16x32_bf16 v[124:127], a[184:187], a[12:15], v[124:127]
  s_add_u32 s31, s31, 0x80000
  s_cmp_lt_u32 s31, 5242880
  s_cbranch_scc1 attn_requery
  v_mul_f32 v0, s34, v0
  v_mul_f32 v1, s34, v1
  v_mul_f32 v2, s34, v2
  v_mul_f32 v3, s34, v3
  v_mul_f32 v16, s34, v16
  v_mul_f32 v17, s34, v17
  v_mul_f32 v18, s34, v18
  v_mul_f32 v19, s34, v19
  v_cvt_pk_bf16_f32 v128, v0, v1
  v_cvt_pk_bf16_f32 v129, v2, v3
  v_cvt_pk_bf16_f32 v130, v16, v17
  v_cvt_pk_bf16_f32 v131, v18, v19
  s_nop 0
  v_permlane16_swap_b32 v128, v130
  v_permlane16_swap_b32 v129, v131
  v_mul_f32 v4, s34, v4
  v_mul_f32 v5, s34, v5
  v_mul_f32 v6, s34, v6
  v_mul_f32 v7, s34, v7
  v_mul_f32 v20, s34, v20
  v_mul_f32 v21, s34, v21
  v_mul_f32 v22, s34, v22
  v_mul_f32 v23, s34, v23
  v_cvt_pk_bf16_f32 v144, v4, v5
  v_cvt_pk_bf16_f32 v145, v6, v7
  v_cvt_pk_bf16_f32 v146, v20, v21
  v_cvt_pk_bf16_f32 v147, v22, v23
  s_nop 0
  v_permlane16_swap_b32 v144, v146
  v_permlane16_swap_b32 v145, v147
  v_mul_f32 v8, s34, v8
  v_mul_f32 v9, s34, v9
  v_mul_f32 v10, s34, v10
  v_mul_f32 v11, s34, v11
  v_mul_f32 v24, s34, v24
  v_mul_f32 v25, s34, v25
  v_mul_f32 v26, s34, v26
  v_mul_f32 v27, s34, v27
  v_cvt_pk_bf16_f32 v160, v8, v9
  v_cvt_pk_bf16_f32 v161, v10, v11
  v_cvt_pk_bf16_f32 v162, v24, v25
  v_cvt_pk_bf16_f32 v163, v26, v27
  s_nop 0
  v_permlane16_swap_b32 v160, v162
  v_permlane16_swap_b32 v161, v163
  v_mul_f32 v12, s34, v12
  v_mul_f32 v13, s34, v13
  v_mul_f32 v14, s34, v14
  v_mul_f32 v15, s34, v15
  v_mul_f32 v28, s34, v28
  v_mul_f32 v29, s34, v29
  v_mul_f32 v30, s34, v30
  v_mul_f32 v31, s34, v31
  v_cvt_pk_bf16_f32 v176, v12, v13
  v_cvt_pk_bf16_f32 v177, v14, v15
  v_cvt_pk_bf16_f32 v178, v28, v29
  v_cvt_pk_bf16_f32 v179, v30, v31
  s_nop 0
  v_permlane16_swap_b32 v176, v178
  v_permlane16_swap_b32 v177, v179
  v_mul_f32 v32, s34, v32
  v_mul_f32 v33, s34, v33
  v_mul_f32 v34, s34, v34
  v_mul_f32 v35, s34, v35
  v_mul_f32 v48, s34, v48
  v_mul_f32 v49, s34, v49
  v_mul_f32 v50, s34, v50
  v_mul_f32 v51, s34, v51
  v_cvt_pk_bf16_f32 v132, v32, v33
  v_cvt_pk_bf16_f32 v133, v34, v35
  v_cvt_pk_bf16_f32 v134, v48, v49
  v_cvt_pk_bf16_f32 v135, v50, v51
  s_nop 0
  v_permlane16_swap_b32 v132, v134
  v_permlane16_swap_b32 v133, v135
  v_mul_f32 v36, s34, v36
  v_mul_f32 v37, s34, v37
  v_mul_f32 v38, s34, v38
  v_mul_f32 v39, s34, v39
  v_mul_f32 v52, s34, v52
  v_mul_f32 v53, s34, v53
  v_mul_f32 v54, s34, v54
  v_mul_f32 v55, s34, v55
  v_cvt_pk_bf16_f32 v148, v36, v37
  v_cvt_pk_bf16_f32 v149, v38, v39
  v_cvt_pk_bf16_f32 v150, v52, v53
  v_cvt_pk_bf16_f32 v151, v54, v55
  s_nop 0
  v_permlane16_swap_b32 v148, v150
  v_permlane16_swap_b32 v149, v151
  v_mul_f32 v40, s34, v40
  v_mul_f32 v41, s34, v41
  v_mul_f32 v42, s34, v42
  v_mul_f32 v43, s34, v43
  v_mul_f32 v56, s34, v56
  v_mul_f32 v57, s34, v57
  v_mul_f32 v58, s34, v58
  v_mul_f32 v59, s34, v59
  v_cvt_pk_bf16_f32 v164, v40, v41
  v_cvt_pk_bf16_f32 v165, v42, v43
  v_cvt_pk_bf16_f32 v166, v56, v57
  v_cvt_pk_bf16_f32 v167, v58, v59
  s_nop 0
  v_permlane16_swap_b32 v164, v166
  v_permlane16_swap_b32 v165, v167
  v_mul_f32 v44, s34, v44
  v_mul_f32 v45, s34, v45
  v_mul_f32 v46, s34, v46
  v_mul_f32 v47, s34, v47
  v_mul_f32 v60, s34, v60
  v_mul_f32 v61, s34, v61
  v_mul_f32 v62, s34, v62
  v_mul_f32 v63, s34, v63
  v_cvt_pk_bf16_f32 v180, v44, v45
  v_cvt_pk_bf16_f32 v181, v46, v47
  v_cvt_pk_bf16_f32 v182, v60, v61
  v_cvt_pk_bf16_f32 v183, v62, v63
  s_nop 0
  v_permlane16_swap_b32 v180, v182
  v_permlane16_swap_b32 v181, v183
  v_mul_f32 v64, s34, v64
  v_mul_f32 v65, s34, v65
  v_mul_f32 v66, s34, v66
  v_mul_f32 v67, s34, v67
  v_mul_f32 v80, s34, v80
  v_mul_f32 v81, s34, v81
  v_mul_f32 v82, s34, v82
  v_mul_f32 v83, s34, v83
  v_cvt_pk_bf16_f32 v136, v64, v65
  v_cvt_pk_bf16_f32 v137, v66, v67
  v_cvt_pk_bf16_f32 v138, v80, v81
  v_cvt_pk_bf16_f32 v139, v82, v83
  s_nop 0
  v_permlane16_swap_b32 v136, v138
  v_permlane16_swap_b32 v137, v139
  v_mul_f32 v68, s34, v68
  v_mul_f32 v69, s34, v69
  v_mul_f32 v70, s34, v70
  v_mul_f32 v71, s34, v71
  v_mul_f32 v84, s34, v84
  v_mul_f32 v85, s34, v85
  v_mul_f32 v86, s34, v86
  v_mul_f32 v87, s34, v87
  v_cvt_pk_bf16_f32 v152, v68, v69
  v_cvt_pk_bf16_f32 v153, v70, v71
  v_cvt_pk_bf16_f32 v154, v84, v85
  v_cvt_pk_bf16_f32 v155, v86, v87
  s_nop 0
  v_permlane16_swap_b32 v152, v154
  v_permlane16_swap_b32 v153, v155
  v_mul_f32 v72, s34, v72
  v_mul_f32 v73, s34, v73
  v_mul_f32 v74, s34, v74
  v_mul_f32 v75, s34, v75
  v_mul_f32 v88, s34, v88
  v_mul_f32 v89, s34, v89
  v_mul_f32 v90, s34, v90
  v_mul_f32 v91, s34, v91
  v_cvt_pk_bf16_f32 v168, v72, v73
  v_cvt_pk_bf16_f32 v169, v74, v75
  v_cvt_pk_bf16_f32 v170, v88, v89
  v_cvt_pk_bf16_f32 v171, v90, v91
  s_nop 0
  v_permlane16_swap_b32 v168, v170
  v_permlane16_swap_b32 v169, v171
  v_mul_f32 v76, s34, v76
  v_mul_f32 v77, s34, v77
  v_mul_f32 v78, s34, v78
  v_mul_f32 v79, s34, v79
  v_mul_f32 v92, s34, v92
  v_mul_f32 v93, s34, v93
  v_mul_f32 v94, s34, v94
  v_mul_f32 v95, s34, v95
  v_cvt_pk_bf16_f32 v184, v76, v77
  v_cvt_pk_bf16_f32 v185, v78, v79
  v_cvt_pk_bf16_f32 v186, v92, v93
  v_cvt_pk_bf16_f32 v187, v94, v95
  s_nop 0
  v_permlane16_swap_b32 v184, v186
  v_permlane16_swap_b32 v185, v187
  v_mul_f32 v96, s34, v96
  v_mul_f32 v97, s34, v97
  v_mul_f32 v98, s34, v98
  v_mul_f32 v99, s34, v99
  v_mul_f32 v112, s34, v112
  v_mul_f32 v113, s34, v113
  v_mul_f32 v114, s34, v114
  v_mul_f32 v115, s34, v115
  v_cvt_pk_bf16_f32 v140, v96, v97
  v_cvt_pk_bf16_f32 v141, v98, v99
  v_cvt_pk_bf16_f32 v142, v112, v113
  v_cvt_pk_bf16_f32 v143, v114, v115
  s_nop 0
  v_permlane16_swap_b32 v140, v142
  v_permlane16_swap_b32 v141, v143
  v_mul_f32 v100, s34, v100
  v_mul_f32 v101, s34, v101
  v_mul_f32 v102, s34, v102
  v_mul_f32 v103, s34, v103
  v_mul_f32 v116, s34, v116
  v_mul_f32 v117, s34, v117
  v_mul_f32 v118, s34, v118
  v_mul_f32 v119, s34, v119
  v_cvt_pk_bf16_f32 v156, v100, v101
  v_cvt_pk_bf16_f32 v157, v102, v103
  v_cvt_pk_bf16_f32 v158, v116, v117
  v_cvt_pk_bf16_f32 v159, v118, v119
  s_nop 0
  v_permlane16_swap_b32 v156, v158
  v_permlane16_swap_b32 v157, v159
  v_mul_f32 v104, s34, v104
  v_mul_f32 v105, s34, v105
  v_mul_f32 v106, s34, v106
  v_mul_f32 v107, s34, v107
  v_mul_f32 v120, s34, v120
  v_mul_f32 v121, s34, v121
  v_mul_f32 v122, s34, v122
  v_mul_f32 v123, s34, v123
  v_cvt_pk_bf16_f32 v172, v104, v105
  v_cvt_pk_bf16_f32 v173, v106, v107
  v_cvt_pk_bf16_f32 v174, v120, v121
  v_cvt_pk_bf16_f32 v175, v122, v123
  s_nop 0
  v_permlane16_swap_b32 v172, v174
  v_permlane16_swap_b32 v173, v175
  v_mul_f32 v108, s34, v108
  v_mul_f32 v109, s34, v109
  v_mul_f32 v110, s34, v110
  v_mul_f32 v111, s34, v111
  v_mul_f32 v124, s34, v124
  v_mul_f32 v125, s34, v125
  v_mul_f32 v126, s34, v126
  v_mul_f32 v127, s34, v127
  v_cvt_pk_bf16_f32 v188, v108, v109
  v_cvt_pk_bf16_f32 v189, v110, v111
  v_cvt_pk_bf16_f32 v190, v124, v125
  v_cvt_pk_bf16_f32 v191, v126, v127
  s_nop 0
  v_permlane16_swap_b32 v188, v190
  v_permlane16_swap_b32 v189, v191
  v_accvgpr_write_b32 a0, 0
  v_accvgpr_write_b32 a1, 0
  v_accvgpr_write_b32 a2, 0
  v_accvgpr_write_b32 a3, 0
  v_accvgpr_write_b32 a4, 0
  v_accvgpr_write_b32 a5, 0
  v_accvgpr_write_b32 a6, 0
  v_accvgpr_write_b32 a7, 0
  v_accvgpr_write_b32 a8, 0
  v_accvgpr_write_b32 a9, 0
  v_accvgpr_write_b32 a10, 0
  v_accvgpr_write_b32 a11, 0
  v_accvgpr_write_b32 a12, 0
  v_accvgpr_write_b32 a13, 0
  v_accvgpr_write_b32 a14, 0
  v_accvgpr_write_b32 a15, 0
  v_accvgpr_write_b32 a16, 0
  v_accvgpr_write_b32 a17, 0
  v_accvgpr_write_b32 a18, 0
  v_accvgpr_write_b32 a19, 0
  v_accvgpr_write_b32 a20, 0
  v_accvgpr_write_b32 a21, 0
  v_accvgpr_write_b32 a22, 0
  v_accvgpr_write_b32 a23, 0
  v_accvgpr_write_b32 a24, 0
  v_accvgpr_write_b32 a25, 0
  v_accvgpr_write_b32 a26, 0
  v_accvgpr_write_b32 a27, 0
  v_accvgpr_write_b32 a28, 0
  v_accvgpr_write_b32 a29, 0
  v_accvgpr_write_b32 a30, 0
  v_accvgpr_write_b32 a31, 0
  v_accvgpr_write_b32 a32, 0
  v_accvgpr_write_b32 a33, 0
  v_accvgpr_write_b32 a34, 0
  v_accvgpr_write_b32 a35, 0
  v_accvgpr_write_b32 a36, 0
  v_accvgpr_write_b32 a37, 0
  v_accvgpr_write_b32 a38, 0
  v_accvgpr_write_b32 a39, 0
  v_accvgpr_write_b32 a40, 0
  v_accvgpr_write_b32 a41, 0
  v_accvgpr_write_b32 a42, 0
  v_accvgpr_write_b32 a43, 0
  v_accvgpr_write_b32 a44, 0
  v_accvgpr_write_b32 a45, 0
  v_accvgpr_write_b32 a46, 0
  v_accvgpr_write_b32 a47, 0
  v_accvgpr_write_b32 a48, 0
  v_accvgpr_write_b32 a49, 0
  v_accvgpr_write_b32 a50, 0
  v_accvgpr_write_b32 a51, 0
  v_accvgpr_write_b32 a52, 0
  v_accvgpr_write_b32 a53, 0
  v_accvgpr_write_b32 a54, 0
  v_accvgpr_write_b32 a55, 0
  v_accvgpr_write_b32 a56, 0
  v_accvgpr_write_b32 a57, 0
  v_accvgpr_write_b32 a58, 0
  v_accvgpr_write_b32 a59, 0
  v_accvgpr_write_b32 a60, 0
  v_accvgpr_write_b32 a61, 0
  v_accvgpr_write_b32 a62, 0
  v_accvgpr_write_b32 a63, 0
  v_accvgpr_write_b32 a64, 0
  v_accvgpr_write_b32 a65, 0
  v_accvgpr_write_b32 a66, 0
  v_accvgpr_write_b32 a67, 0
  v_accvgpr_write_b32 a68, 0
  v_accvgpr_write_b32 a69, 0
  v_accvgpr_write_b32 a70, 0
  v_accvgpr_write_b32 a71, 0
  v_accvgpr_write_b32 a72, 0
  v_accvgpr_write_b32 a73, 0
  v_accvgpr_write_b32 a74, 0
  v_accvgpr_write_b32 a75, 0
  v_accvgpr_write_b32 a76, 0
  v_accvgpr_write_b32 a77, 0
  v_accvgpr_write_b32 a78, 0
  v_accvgpr_write_b32 a79, 0
  v_accvgpr_write_b32 a80, 0
  v_accvgpr_write_b32 a81, 0
  v_accvgpr_write_b32 a82, 0
  v_accvgpr_write_b32 a83, 0
  v_accvgpr_write_b32 a84, 0
  v_accvgpr_write_b32 a85, 0
  v_accvgpr_write_b32 a86, 0
  v_accvgpr_write_b32 a87, 0
  v_accvgpr_write_b32 a88, 0
  v_accvgpr_write_b32 a89, 0
  v_accvgpr_write_b32 a90, 0
  v_accvgpr_write_b32 a91, 0
  v_accvgpr_write_b32 a92, 0
  v_accvgpr_write_b32 a93, 0
  v_accvgpr_write_b32 a94, 0
  v_accvgpr_write_b32 a95, 0
  v_accvgpr_write_b32 a96, 0
  v_accvgpr_write_b32 a97, 0
  v_accvgpr_write_b32 a98, 0
  v_accvgpr_write_b32 a99, 0
  v_accvgpr_write_b32 a100, 0
  v_accvgpr_write_b32 a101, 0
  v_accvgpr_write_b32 a102, 0
  v_accvgpr_write_b32 a103, 0
  v_accvgpr_write_b32 a104, 0
  v_accvgpr_write_b32 a105, 0
  v_accvgpr_write_b32 a106, 0
  v_accvgpr_write_b32 a107, 0
  v_accvgpr_write_b32 a108, 0
  v_accvgpr_write_b32 a109, 0
  v_accvgpr_write_b32 a110, 0
  v_accvgpr_write_b32 a111, 0
  v_accvgpr_write_b32 a112, 0
  v_accvgpr_write_b32 a113, 0
  v_accvgpr_write_b32 a114, 0
  v_accvgpr_write_b32 a115, 0
  v_accvgpr_write_b32 a116, 0
  v_accvgpr_write_b32 a117, 0
  v_accvgpr_write_b32 a118, 0
  v_accvgpr_write_b32 a119, 0
  v_accvgpr_write_b32 a120, 0
  v_accvgpr_write_b32 a121, 0
  v_accvgpr_write_b32 a122, 0
  v_accvgpr_write_b32 a123, 0
  v_accvgpr_write_b32 a124, 0
  v_accvgpr_write_b32 a125, 0
  v_accvgpr_write_b32 a126, 0
  v_accvgpr_write_b32 a127, 0
  v_mov_b32 v208, 0
  v_mov_b32 v249, 0xff800000
  v_mov_b32 v209, 0
  v_mov_b32 v250, 0xff800000
  v_mov_b32 v210, 0
  v_mov_b32 v251, 0xff800000
  v_mov_b32 v211, 0
  v_mov_b32 v252, 0xff800000
  s_mov_b32 s29, 0
attn_slow:
  s_barrier
  s_add_u32 m0, s28, 49152
  s_nop 0
  buffer_load_dwordx4 v232, s[12:15], s29 offen offset:0 lds
  buffer_load_dwordx4 v233, s[12:15], s29 offen offset:1024 lds
  buffer_load_dwordx4 v234, s[12:15], s29 offen offset:2048 lds
  buffer_load_dwordx4 v235, s[12:15], s29 offen offset:3072 lds
  s_add_u32 m0, s28, 114688
  s_nop 0
  buffer_load_dwordx4 v236, s[16:19], s29 offen offset:0 lds
  buffer_load_dwordx4 v237, s[16:19], s29 offen offset:1024 lds
  buffer_load_dwordx4 v236, s[16:19], s29 offen offset:2048 lds
  buffer_load_dwordx4 v237, s[16:19], s29 offen offset:3072 lds
  s_waitcnt vmcnt(0)
  s_barrier
  ds_read_b128 a[128:131], v212 offset:49152
  ds_read_b128 a[132:135], v213 offset:49152
  ds_read_b128 a[136:139], v214 offset:49152
  ds_read_b128 a[140:143], v215 offset:49152
  s_waitcnt lgkmcnt(3)
  v_mfma_f32_16x16x32_bf16 v[0:3], a[128:131], v[128:131], 0
  s_waitcnt lgkmcnt(2)
  v_mfma_f32_16x16x32_bf16 v[0:3], a[132:135], v[132:135], v[0:3]
  s_waitcnt lgkmcnt(1)
  v_mfma_f32_16x16x32_bf16 v[0:3], a[136:139], v[136:139], v[0:3]
  s_waitcnt lgkmcnt(0)
  v_mfma_f32_16x16x32_bf16 v[0:3], a[140:143], v[140:143], v[0:3]
  v_mfma_f32_16x16x32_bf16 v[8:11], a[140:143], v[156:159], 0
  v_mfma_f32_16x16x32_bf16 v[8:11], a[136:139], v[152:155], v[8:11]
  v_mfma_f32_16x16x32_bf16 v[8:11], a[132:135], v[148:151], v[8:11]
  v_mfma_f32_16x16x32_bf16 v[8:11], a[128:131], v[144:147], v[8:11]
  v_mfma_f32_16x16x32_bf16 v[16:19], a[128:131], v[160:163], 0
  v_mfma_f32_16x16x32_bf16 v[16:19], a[132:135], v[164:167], v[16:19]
  v_mfma_f32_16x16x32_bf16 v[16:19], a[136:139], v[168:171], v[16:19]
  v_mfma_f32_16x16x32_bf16 v[16:19], a[140:143], v[172:175], v[16:19]
  v_mfma_f32_16x16x32_bf16 v[24:27], a[140:143], v[188:191], 0
  v_mfma_f32_16x16x32_bf16 v[24:27], a[136:139], v[184:187], v[24:27]
  v_mfma_f32_16x16x32_bf16 v[24:27], a[132:135], v[180:183], v[24:27]
  v_mfma_f32_16x16x32_bf16 v[24:27], a[128:131], v[176:179], v[24:27]
  ds_read_b128 a[144:147], v212 offset:53248
  ds_read_b128 a[148:151], v213 offset:53248
  ds_read_b128 a[152:155], v214 offset:53248
  ds_read_b128 a[156:159], v215 offset:53248
  s_waitcnt lgkmcnt(3)
  v_mfma_f32_16x16x32_bf16 v[4:7], a[144:147], v[128:131], 0
  s_waitcnt lgkmcnt(2)
  v_mfma_f32_16x16x32_bf16 v[4:7], a[148:151], v[132:135], v[4:7]
  s_waitcnt lgkmcnt(1)
  v_mfma_f32_16x16x32_bf16 v[4:7], a[152:155], v[136:139], v[4:7]
  s_waitcnt lgkmcnt(0)
  v_mfma_f32_16x16x32_bf16 v[4:7], a[156:159], v[140:143], v[4:7]
  v_mfma_f32_16x16x32_bf16 v[12:15], a[156:159], v[156:159], 0
  v_mfma_f32_16x16x32_bf16 v[12:15], a[152:155], v[152:155], v[12:15]
  v_mfma_f32_16x16x32_bf16 v[12:15], a[148:151], v[148:151], v[12:15]
  v_mfma_f32_16x16x32_bf16 v[12:15], a[144:147], v[144:147], v[12:15]
  v_mfma_f32_16x16x32_bf16 v[20:23], a[144:147], v[160:163], 0
  v_mfma_f32_16x16x32_bf16 v[20:23], a[148:151], v[164:167], v[20:23]
  v_mfma_f32_16x16x32_bf16 v[20:23], a[152:155], v[168:171], v[20:23]
  v_mfma_f32_16x16x32_bf16 v[20:23], a[156:159], v[172:175], v[20:23]
  v_mfma_f32_16x16x32_bf16 v[28:31], a[156:159], v[188:191], 0
  v_mfma_f32_16x16x32_bf16 v[28:31], a[152:155], v[184:187], v[28:31]
  v_mfma_f32_16x16x32_bf16 v[28:31], a[148:151], v[180:183], v[28:31]
  v_mfma_f32_16x16x32_bf16 v[28:31], a[144:147], v[176:179], v[28:31]
  ds_read_b128 a[128:131], v212 offset:57344
  ds_read_b128 a[132:135], v213 offset:57344
  ds_read_b128 a[136:139], v214 offset:57344
  ds_read_b128 a[140:143], v215 offset:57344
  s_waitcnt lgkmcnt(3)
  v_mfma_f32_16x16x32_bf16 v[32:35], a[128:131], v[128:131], 0
  s_waitcnt lgkmcnt(2)
  v_mfma_f32_16x16x32_bf16 v[32:35], a[132:135], v[132:135], v[32:35]
  s_waitcnt lgkmcnt(1)
  v_mfma_f32_16x16x32_bf16 v[32:35], a[136:139], v[136:139], v[32:35]
  s_waitcnt lgkmcnt(0)
  v_mfma_f32_16x16x32_bf16 v[32:35], a[140:143], v[140:143], v[32:35]
  v_mfma_f32_16x16x32_bf16 v[40:43], a[140:143], v[156:159], 0
  v_mfma_f32_16x16x32_bf16 v[40:43], a[136:139], v[152:155], v[40:43]
  v_mfma_f32_16x16x32_bf16 v[40:43], a[132:135], v[148:151], v[40:43]
  v_mfma_f32_16x16x32_bf16 v[40:43], a[128:131], v[144:147], v[40:43]
  v_mfma_f32_16x16x32_bf16 v[48:51], a[128:131], v[160:163], 0
  v_mfma_f32_16x16x32_bf16 v[48:51], a[132:135], v[164:167], v[48:51]
  v_mfma_f32_16x16x32_bf16 v[48:51], a[136:139], v[168:171], v[48:51]
  v_mfma_f32_16x16x32_bf16 v[48:51], a[140:143], v[172:175], v[48:51]
  v_mfma_f32_16x16x32_bf16 v[56:59], a[140:143], v[188:191], 0
  v_mfma_f32_16x16x32_bf16 v[56:59], a[136:139], v[184:187], v[56:59]
  v_mfma_f32_16x16x32_bf16 v[56:59], a[132:135], v[180:183], v[56:59]
  v_mfma_f32_16x16x32_bf16 v[56:59], a[128:131], v[176:179], v[56:59]
  ds_read_b128 a[144:147], v212 offset:61440
  ds_read_b128 a[148:151], v213 offset:61440
  ds_read_b128 a[152:155], v214 offset:61440
  ds_read_b128 a[156:159], v215 offset:61440
  s_waitcnt lgkmcnt(3)
  v_mfma_f32_16x16x32_bf16 v[36:39], a[144:147], v[128:131], 0
  s_waitcnt lgkmcnt(2)
  v_mfma_f32_16x16x32_bf16 v[36:39], a[148:151], v[132:135], v[36:39]
  s_waitcnt lgkmcnt(1)
  v_mfma_f32_16x16x32_bf16 v[36:39], a[152:155], v[136:139], v[36:39]
  s_waitcnt lgkmcnt(0)
  v_mfma_f32_16x16x32_bf16 v[36:39], a[156:159], v[140:143], v[36:39]
  v_mfma_f32_16x16x32_bf16 v[44:47], a[156:159], v[156:159], 0
  v_mfma_f32_16x16x32_bf16 v[44:47], a[152:155], v[152:155], v[44:47]
  v_mfma_f32_16x16x32_bf16 v[44:47], a[148:151], v[148:151], v[44:47]
  v_mfma_f32_16x16x32_bf16 v[44:47], a[144:147], v[144:147], v[44:47]
  v_mfma_f32_16x16x32_bf16 v[52:55], a[144:147], v[160:163], 0
  v_mfma_f32_16x16x32_bf16 v[52:55], a[148:151], v[164:167], v[52:55]
  v_mfma_f32_16x16x32_bf16 v[52:55], a[152:155], v[168:171], v[52:55]
  v_mfma_f32_16x16x32_bf16 v[52:55], a[156:159], v[172:175], v[52:55]
  v_mfma_f32_16x16x32_bf16 v[60:63], a[156:159], v[188:191], 0
  v_mfma_f32_16x16x32_bf16 v[60:63], a[152:155], v[184:187], v[60:63]
  v_mfma_f32_16x16x32_bf16 v[60:63], a[148:151], v[180:183], v[60:63]
  v_mfma_f32_16x16x32_bf16 v[60:63], a[144:147], v[176:179], v[60:63]
  v_mov_b32 v192, v249
  v_max3_f32 v192, v192, v0, v1
  v_max3_f32 v192, v192, v2, v3
  v_max3_f32 v192, v192, v4, v5
  v_max3_f32 v192, v192, v6, v7
  v_max3_f32 v192, v192, v32, v33
  v_max3_f32 v192, v192, v34, v35
  v_max3_f32 v192, v192, v36, v37
  v_max3_f32 v192, v192, v38, v39
  v_mov_b32 v245, v192
  s_nop 1
  v_permlane16_swap_b32 v192, v245
  v_max_f32 v192, v192, v245
  v_mov_b32 v245, v192
  s_nop 1
  v_permlane32_swap_b32 v192, v245
  v_max_f32 v192, v192, v245
  v_sub_f32 v193, v249, v192
  v_exp_f32 v193, v193
  v_mov_b32 v249, v192
  v_mul_f32 v208, v208, v193
  v_sub_f32 v0, v0, v192
  v_sub_f32 v1, v1, v192
  v_sub_f32 v2, v2, v192
  v_sub_f32 v3, v3, v192
  v_sub_f32 v4, v4, v192
  v_sub_f32 v5, v5, v192
  v_sub_f32 v6, v6, v192
  v_sub_f32 v7, v7, v192
  v_sub_f32 v32, v32, v192
  v_sub_f32 v33, v33, v192
  v_sub_f32 v34, v34, v192
  v_sub_f32 v35, v35, v192
  v_sub_f32 v36, v36, v192
  v_sub_f32 v37, v37, v192
  v_sub_f32 v38, v38, v192
  v_sub_f32 v39, v39, v192
  v_exp_f32 v0, v0
  v_exp_f32 v1, v1
  v_add_f32 v208, v208, v0
  v_exp_f32 v2, v2
  v_add_f32 v208, v208, v1
  v_cvt_pk_bf16_f32 v0, v0, v1
  v_exp_f32 v3, v3
  v_add_f32 v208, v208, v2
  v_add_f32 v208, v208, v3
  v_cvt_pk_bf16_f32 v1, v2, v3
  v_exp_f32 v4, v4
  v_exp_f32 v5, v5
  v_add_f32 v208, v208, v4
  v_exp_f32 v6, v6
  v_add_f32 v208, v208, v5
  v_cvt_pk_bf16_f32 v2, v4, v5
  v_exp_f32 v7, v7
  v_add_f32 v208, v208, v6
  v_add_f32 v208, v208, v7
  v_cvt_pk_bf16_f32 v3, v6, v7
  v_exp_f32 v32, v32
  v_exp_f32 v33, v33
  v_add_f32 v208, v208, v32
  v_exp_f32 v34, v34
  v_add_f32 v208, v208, v33
  v_cvt_pk_bf16_f32 v32, v32, v33
  v_exp_f32 v35, v35
  v_add_f32 v208, v208, v34
  v_add_f32 v208, v208, v35
  v_cvt_pk_bf16_f32 v33, v34, v35
  v_exp_f32 v36, v36
  v_exp_f32 v37, v37
  v_add_f32 v208, v208, v36
  v_exp_f32 v38, v38
  v_add_f32 v208, v208, v37
  v_cvt_pk_bf16_f32 v34, v36, v37
  v_exp_f32 v39, v39
  v_add_f32 v208, v208, v38
  v_add_f32 v208, v208, v39
  v_cvt_pk_bf16_f32 v35, v38, v39
  v_accvgpr_read_b32 v64, a0
  v_accvgpr_read_b32 v65, a1
  v_accvgpr_read_b32 v66, a2
  v_accvgpr_read_b32 v67, a3
  v_mul_f32 v64, v64, v193
  v_mul_f32 v65, v65, v193
  v_mul_f32 v66, v66, v193
  v_mul_f32 v67, v67, v193
  v_accvgpr_write_b32 a0, v64
  v_accvgpr_write_b32 a1, v65
  v_accvgpr_write_b32 a2, v66
  v_accvgpr_write_b32 a3, v67
  v_accvgpr_read_b32 v64, a16
  v_accvgpr_read_b32 v65, a17
  v_accvgpr_read_b32 v66, a18
  v_accvgpr_read_b32 v67, a19
  v_mul_f32 v64, v64, v193
  v_mul_f32 v65, v65, v193
  v_mul_f32 v66, v66, v193
  v_mul_f32 v67, v67, v193
  v_accvgpr_write_b32 a16, v64
  v_accvgpr_write_b32 a17, v65
  v_accvgpr_write_b32 a18, v66
  v_accvgpr_write_b32 a19, v67
  v_accvgpr_read_b32 v64, a32
  v_accvgpr_read_b32 v65, a33
  v_accvgpr_read_b32 v66, a34
  v_accvgpr_read_b32 v67, a35
  v_mul_f32 v64, v64, v193
  v_mul_f32 v65, v65, v193
  v_mul_f32 v66, v66, v193
  v_mul_f32 v67, v67, v193
  v_accvgpr_write_b32 a32, v64
  v_accvgpr_write_b32 a33, v65
  v_accvgpr_write_b32 a34, v66
  v_accvgpr_write_b32 a35, v67
  v_accvgpr_read_b32 v64, a48
  v_accvgpr_read_b32 v65, a49
  v_accvgpr_read_b32 v66, a50
  v_accvgpr_read_b32 v67, a51
  v_mul_f32 v64, v64, v193
  v_mul_f32 v65, v65, v193
  v_mul_f32 v66, v66, v193
  v_mul_f32 v67, v67, v193
  v_accvgpr_write_b32 a48, v64
  v_accvgpr_write_b32 a49, v65
  v_accvgpr_write_b32 a50, v66
  v_accvgpr_write_b32 a51, v67
  v_accvgpr_read_b32 v64, a64
  v_accvgpr_read_b32 v65, a65
  v_accvgpr_read_b32 v66, a66
  v_accvgpr_read_b32 v67, a67
  v_mul_f32 v64, v64, v193
  v_mul_f32 v65, v65, v193
  v_mul_f32 v66, v66, v193
  v_mul_f32 v67, v67, v193
  v_accvgpr_write_b32 a64, v64
  v_accvgpr_write_b32 a65, v65
  v_accvgpr_write_b32 a66, v66
  v_accvgpr_write_b32 a67, v67
  v_accvgpr_read_b32 v64, a80
  v_accvgpr_read_b32 v65, a81
  v_accvgpr_read_b32 v66, a82
  v_accvgpr_read_b32 v67, a83
  v_mul_f32 v64, v64, v193
  v_mul_f32 v65, v65, v193
  v_mul_f32 v66, v66, v193
  v_mul_f32 v67, v67, v193
  v_accvgpr_write_b32 a80, v64
  v_accvgpr_write_b32 a81, v65
  v_accvgpr_write_b32 a82, v66
  v_accvgpr_write_b32 a83, v67
  v_accvgpr_read_b32 v64, a96
  v_accvgpr_read_b32 v65, a97
  v_accvgpr_read_b32 v66, a98
  v_accvgpr_read_b32 v67, a99
  v_mul_f32 v64, v64, v193
  v_mul_f32 v65, v65, v193
  v_mul_f32 v66, v66, v193
  v_mul_f32 v67, v67, v193
  v_accvgpr_write_b32 a96, v64
  v_accvgpr_write_b32 a97, v65
  v_accvgpr_write_b32 a98, v66
  v_accvgpr_write_b32 a99, v67
  v_accvgpr_read_b32 v64, a112
  v_accvgpr_read_b32 v65, a113
  v_accvgpr_read_b32 v66, a114
  v_accvgpr_read_b32 v67, a115
  v_mul_f32 v64, v64, v193
  v_mul_f32 v65, v65, v193
  v_mul_f32 v66, v66, v193
  v_mul_f32 v67, v67, v193
  v_accvgpr_write_b32 a112, v64
  v_accvgpr_write_b32 a113, v65
  v_accvgpr_write_b32 a114, v66
  v_accvgpr_write_b32 a115, v67
  v_mov_b32 v196, v250
  v_max3_f32 v196, v196, v8, v9
  v_max3_f32 v196, v196, v10, v11
  v_max3_f32 v196, v196, v12, v13
  v_max3_f32 v196, v196, v14, v15
  v_max3_f32 v196, v196, v40, v41
  v_max3_f32 v196, v196, v42, v43
  v_max3_f32 v196, v196, v44, v45
  v_max3_f32 v196, v196, v46, v47
  v_mov_b32 v245, v196
  s_nop 1
  v_permlane16_swap_b32 v196, v245
  v_max_f32 v196, v196, v245
  v_mov_b32 v245, v196
  s_nop 1
  v_permlane32_swap_b32 v196, v245
  v_max_f32 v196, v196, v245
  v_sub_f32 v197, v250, v196
  v_exp_f32 v197, v197
  v_mov_b32 v250, v196
  v_mul_f32 v209, v209, v197
  v_sub_f32 v8, v8, v196
  v_sub_f32 v9, v9, v196
  v_sub_f32 v10, v10, v196
  v_sub_f32 v11, v11, v196
  v_sub_f32 v12, v12, v196
  v_sub_f32 v13, v13, v196
  v_sub_f32 v14, v14, v196
  v_sub_f32 v15, v15, v196
  v_sub_f32 v40, v40, v196
  v_sub_f32 v41, v41, v196
  v_sub_f32 v42, v42, v196
  v_sub_f32 v43, v43, v196
  v_sub_f32 v44, v44, v196
  v_sub_f32 v45, v45, v196
  v_sub_f32 v46, v46, v196
  v_sub_f32 v47, v47, v196
  v_exp_f32 v8, v8
  v_exp_f32 v9, v9
  v_add_f32 v209, v209, v8
  v_exp_f32 v10, v10
  v_add_f32 v209, v209, v9
  v_cvt_pk_bf16_f32 v8, v8, v9
  v_exp_f32 v11, v11
  v_add_f32 v209, v209, v10
  v_add_f32 v209, v209, v11
  v_cvt_pk_bf16_f32 v9, v10, v11
  v_exp_f32 v12, v12
  v_exp_f32 v13, v13
  v_add_f32 v209, v209, v12
  v_exp_f32 v14, v14
  v_add_f32 v209, v209, v13
  v_cvt_pk_bf16_f32 v10, v12, v13
  v_exp_f32 v15, v15
  v_add_f32 v209, v209, v14
  v_add_f32 v209, v209, v15
  v_cvt_pk_bf16_f32 v11, v14, v15
  v_exp_f32 v40, v40
  v_exp_f32 v41, v41
  v_add_f32 v209, v209, v40
  v_exp_f32 v42, v42
  v_add_f32 v209, v209, v41
  v_cvt_pk_bf16_f32 v40, v40, v41
  v_exp_f32 v43, v43
  v_add_f32 v209, v209, v42
  v_add_f32 v209, v209, v43
  v_cvt_pk_bf16_f32 v41, v42, v43
  v_exp_f32 v44, v44
  v_exp_f32 v45, v45
  v_add_f32 v209, v209, v44
  v_exp_f32 v46, v46
  v_add_f32 v209, v209, v45
  v_cvt_pk_bf16_f32 v42, v44, v45
  v_exp_f32 v47, v47
  v_add_f32 v209, v209, v46
  v_add_f32 v209, v209, v47
  v_cvt_pk_bf16_f32 v43, v46, v47
  v_accvgpr_read_b32 v64, a4
  v_accvgpr_read_b32 v65, a5
  v_accvgpr_read_b32 v66, a6
  v_accvgpr_read_b32 v67, a7
  v_mul_f32 v64, v64, v197
  v_mul_f32 v65, v65, v197
  v_mul_f32 v66, v66, v197
  v_mul_f32 v67, v67, v197
  v_accvgpr_write_b32 a4, v64
  v_accvgpr_write_b32 a5, v65
  v_accvgpr_write_b32 a6, v66
  v_accvgpr_write_b32 a7, v67
  v_accvgpr_read_b32 v64, a20
  v_accvgpr_read_b32 v65, a21
  v_accvgpr_read_b32 v66, a22
  v_accvgpr_read_b32 v67, a23
  v_mul_f32 v64, v64, v197
  v_mul_f32 v65, v65, v197
  v_mul_f32 v66, v66, v197
  v_mul_f32 v67, v67, v197
  v_accvgpr_write_b32 a20, v64
  v_accvgpr_write_b32 a21, v65
  v_accvgpr_write_b32 a22, v66
  v_accvgpr_write_b32 a23, v67
  v_accvgpr_read_b32 v64, a36
  v_accvgpr_read_b32 v65, a37
  v_accvgpr_read_b32 v66, a38
  v_accvgpr_read_b32 v67, a39
  v_mul_f32 v64, v64, v197
  v_mul_f32 v65, v65, v197
  v_mul_f32 v66, v66, v197
  v_mul_f32 v67, v67, v197
  v_accvgpr_write_b32 a36, v64
  v_accvgpr_write_b32 a37, v65
  v_accvgpr_write_b32 a38, v66
  v_accvgpr_write_b32 a39, v67
  v_accvgpr_read_b32 v64, a52
  v_accvgpr_read_b32 v65, a53
  v_accvgpr_read_b32 v66, a54
  v_accvgpr_read_b32 v67, a55
  v_mul_f32 v64, v64, v197
  v_mul_f32 v65, v65, v197
  v_mul_f32 v66, v66, v197
  v_mul_f32 v67, v67, v197
  v_accvgpr_write_b32 a52, v64
  v_accvgpr_write_b32 a53, v65
  v_accvgpr_write_b32 a54, v66
  v_accvgpr_write_b32 a55, v67
  v_accvgpr_read_b32 v64, a68
  v_accvgpr_read_b32 v65, a69
  v_accvgpr_read_b32 v66, a70
  v_accvgpr_read_b32 v67, a71
  v_mul_f32 v64, v64, v197
  v_mul_f32 v65, v65, v197
  v_mul_f32 v66, v66, v197
  v_mul_f32 v67, v67, v197
  v_accvgpr_write_b32 a68, v64
  v_accvgpr_write_b32 a69, v65
  v_accvgpr_write_b32 a70, v66
  v_accvgpr_write_b32 a71, v67
  v_accvgpr_read_b32 v64, a84
  v_accvgpr_read_b32 v65, a85
  v_accvgpr_read_b32 v66, a86
  v_accvgpr_read_b32 v67, a87
  v_mul_f32 v64, v64, v197
  v_mul_f32 v65, v65, v197
  v_mul_f32 v66, v66, v197
  v_mul_f32 v67, v67, v197
  v_accvgpr_write_b32 a84, v64
  v_accvgpr_write_b32 a85, v65
  v_accvgpr_write_b32 a86, v66
  v_accvgpr_write_b32 a87, v67
  v_accvgpr_read_b32 v64, a100
  v_accvgpr_read_b32 v65, a101
  v_accvgpr_read_b32 v66, a102
  v_accvgpr_read_b32 v67, a103
  v_mul_f32 v64, v64, v197
  v_mul_f32 v65, v65, v197
  v_mul_f32 v66, v66, v197
  v_mul_f32 v67, v67, v197
  v_accvgpr_write_b32 a100, v64
  v_accvgpr_write_b32 a101, v65
  v_accvgpr_write_b32 a102, v66
  v_accvgpr_write_b32 a103, v67
  v_accvgpr_read_b32 v64, a116
  v_accvgpr_read_b32 v65, a117
  v_accvgpr_read_b32 v66, a118
  v_accvgpr_read_b32 v67, a119
  v_mul_f32 v64, v64, v197
  v_mul_f32 v65, v65, v197
  v_mul_f32 v66, v66, v197
  v_mul_f32 v67, v67, v197
  v_accvgpr_write_b32 a116, v64
  v_accvgpr_write_b32 a117, v65
  v_accvgpr_write_b32 a118, v66
  v_accvgpr_write_b32 a119, v67
  v_mov_b32 v200, v251
  v_max3_f32 v200, v200, v16, v17
  v_max3_f32 v200, v200, v18, v19
  v_max3_f32 v200, v200, v20, v21
  v_max3_f32 v200, v200, v22, v23
  v_max3_f32 v200, v200, v48, v49
  v_max3_f32 v200, v200, v50, v51
  v_max3_f32 v200, v200, v52, v53
  v_max3_f32 v200, v200, v54, v55
  v_mov_b32 v245, v200
  s_nop 1
  v_permlane16_swap_b32 v200, v245
  v_max_f32 v200, v200, v245
  v_mov_b32 v245, v200
  s_nop 1
  v_permlane32_swap_b32 v200, v245
  v_max_f32 v200, v200, v245
  v_sub_f32 v201, v251, v200
  v_exp_f32 v201, v201
  v_mov_b32 v251, v200
  v_mul_f32 v210, v210, v201
  v_sub_f32 v16, v16, v200
  v_sub_f32 v17, v17, v200
  v_sub_f32 v18, v18, v200
  v_sub_f32 v19, v19, v200
  v_sub_f32 v20, v20, v200
  v_sub_f32 v21, v21, v200
  v_sub_f32 v22, v22, v200
  v_sub_f32 v23, v23, v200
  v_sub_f32 v48, v48, v200
  v_sub_f32 v49, v49, v200
  v_sub_f32 v50, v50, v200
  v_sub_f32 v51, v51, v200
  v_sub_f32 v52, v52, v200
  v_sub_f32 v53, v53, v200
  v_sub_f32 v54, v54, v200
  v_sub_f32 v55, v55, v200
  v_exp_f32 v16, v16
  v_exp_f32 v17, v17
  v_add_f32 v210, v210, v16
  v_exp_f32 v18, v18
  v_add_f32 v210, v210, v17
  v_cvt_pk_bf16_f32 v16, v16, v17
  v_exp_f32 v19, v19
  v_add_f32 v210, v210, v18
  v_add_f32 v210, v210, v19
  v_cvt_pk_bf16_f32 v17, v18, v19
  v_exp_f32 v20, v20
  v_exp_f32 v21, v21
  v_add_f32 v210, v210, v20
  v_exp_f32 v22, v22
  v_add_f32 v210, v210, v21
  v_cvt_pk_bf16_f32 v18, v20, v21
  v_exp_f32 v23, v23
  v_add_f32 v210, v210, v22
  v_add_f32 v210, v210, v23
  v_cvt_pk_bf16_f32 v19, v22, v23
  v_exp_f32 v48, v48
  v_exp_f32 v49, v49
  v_add_f32 v210, v210, v48
  v_exp_f32 v50, v50
  v_add_f32 v210, v210, v49
  v_cvt_pk_bf16_f32 v48, v48, v49
  v_exp_f32 v51, v51
  v_add_f32 v210, v210, v50
  v_add_f32 v210, v210, v51
  v_cvt_pk_bf16_f32 v49, v50, v51
  v_exp_f32 v52, v52
  v_exp_f32 v53, v53
  v_add_f32 v210, v210, v52
  v_exp_f32 v54, v54
  v_add_f32 v210, v210, v53
  v_cvt_pk_bf16_f32 v50, v52, v53
  v_exp_f32 v55, v55
  v_add_f32 v210, v210, v54
  v_add_f32 v210, v210, v55
  v_cvt_pk_bf16_f32 v51, v54, v55
  v_accvgpr_read_b32 v64, a8
  v_accvgpr_read_b32 v65, a9
  v_accvgpr_read_b32 v66, a10
  v_accvgpr_read_b32 v67, a11
  v_mul_f32 v64, v64, v201
  v_mul_f32 v65, v65, v201
  v_mul_f32 v66, v66, v201
  v_mul_f32 v67, v67, v201
  v_accvgpr_write_b32 a8, v64
  v_accvgpr_write_b32 a9, v65
  v_accvgpr_write_b32 a10, v66
  v_accvgpr_write_b32 a11, v67
  v_accvgpr_read_b32 v64, a24
  v_accvgpr_read_b32 v65, a25
  v_accvgpr_read_b32 v66, a26
  v_accvgpr_read_b32 v67, a27
  v_mul_f32 v64, v64, v201
  v_mul_f32 v65, v65, v201
  v_mul_f32 v66, v66, v201
  v_mul_f32 v67, v67, v201
  v_accvgpr_write_b32 a24, v64
  v_accvgpr_write_b32 a25, v65
  v_accvgpr_write_b32 a26, v66
  v_accvgpr_write_b32 a27, v67
  v_accvgpr_read_b32 v64, a40
  v_accvgpr_read_b32 v65, a41
  v_accvgpr_read_b32 v66, a42
  v_accvgpr_read_b32 v67, a43
  v_mul_f32 v64, v64, v201
  v_mul_f32 v65, v65, v201
  v_mul_f32 v66, v66, v201
  v_mul_f32 v67, v67, v201
  v_accvgpr_write_b32 a40, v64
  v_accvgpr_write_b32 a41, v65
  v_accvgpr_write_b32 a42, v66
  v_accvgpr_write_b32 a43, v67
  v_accvgpr_read_b32 v64, a56
  v_accvgpr_read_b32 v65, a57
  v_accvgpr_read_b32 v66, a58
  v_accvgpr_read_b32 v67, a59
  v_mul_f32 v64, v64, v201
  v_mul_f32 v65, v65, v201
  v_mul_f32 v66, v66, v201
  v_mul_f32 v67, v67, v201
  v_accvgpr_write_b32 a56, v64
  v_accvgpr_write_b32 a57, v65
  v_accvgpr_write_b32 a58, v66
  v_accvgpr_write_b32 a59, v67
  v_accvgpr_read_b32 v64, a72
  v_accvgpr_read_b32 v65, a73
  v_accvgpr_read_b32 v66, a74
  v_accvgpr_read_b32 v67, a75
  v_mul_f32 v64, v64, v201
  v_mul_f32 v65, v65, v201
  v_mul_f32 v66, v66, v201
  v_mul_f32 v67, v67, v201
  v_accvgpr_write_b32 a72, v64
  v_accvgpr_write_b32 a73, v65
  v_accvgpr_write_b32 a74, v66
  v_accvgpr_write_b32 a75, v67
  v_accvgpr_read_b32 v64, a88
  v_accvgpr_read_b32 v65, a89
  v_accvgpr_read_b32 v66, a90
  v_accvgpr_read_b32 v67, a91
  v_mul_f32 v64, v64, v201
  v_mul_f32 v65, v65, v201
  v_mul_f32 v66, v66, v201
  v_mul_f32 v67, v67, v201
  v_accvgpr_write_b32 a88, v64
  v_accvgpr_write_b32 a89, v65
  v_accvgpr_write_b32 a90, v66
  v_accvgpr_write_b32 a91, v67
  v_accvgpr_read_b32 v64, a104
  v_accvgpr_read_b32 v65, a105
  v_accvgpr_read_b32 v66, a106
  v_accvgpr_read_b32 v67, a107
  v_mul_f32 v64, v64, v201
  v_mul_f32 v65, v65, v201
  v_mul_f32 v66, v66, v201
  v_mul_f32 v67, v67, v201
  v_accvgpr_write_b32 a104, v64
  v_accvgpr_write_b32 a105, v65
  v_accvgpr_write_b32 a106, v66
  v_accvgpr_write_b32 a107, v67
  v_accvgpr_read_b32 v64, a120
  v_accvgpr_read_b32 v65, a121
  v_accvgpr_read_b32 v66, a122
  v_accvgpr_read_b32 v67, a123
  v_mul_f32 v64, v64, v201
  v_mul_f32 v65, v65, v201
  v_mul_f32 v66, v66, v201
  v_mul_f32 v67, v67, v201
  v_accvgpr_write_b32 a120, v64
  v_accvgpr_write_b32 a121, v65
  v_accvgpr_write_b32 a122, v66
  v_accvgpr_write_b32 a123, v67
  v_mov_b32 v204, v252
  v_max3_f32 v204, v204, v24, v25
  v_max3_f32 v204, v204, v26, v27
  v_max3_f32 v204, v204, v28, v29
  v_max3_f32 v204, v204, v30, v31
  v_max3_f32 v204, v204, v56, v57
  v_max3_f32 v204, v204, v58, v59
  v_max3_f32 v204, v204, v60, v61
  v_max3_f32 v204, v204, v62, v63
  v_mov_b32 v245, v204
  s_nop 1
  v_permlane16_swap_b32 v204, v245
  v_max_f32 v204, v204, v245
  v_mov_b32 v245, v204
  s_nop 1
  v_permlane32_swap_b32 v204, v245
  v_max_f32 v204, v204, v245
  v_sub_f32 v205, v252, v204
  v_exp_f32 v205, v205
  v_mov_b32 v252, v204
  v_mul_f32 v211, v211, v205
  v_sub_f32 v24, v24, v204
  v_sub_f32 v25, v25, v204
  v_sub_f32 v26, v26, v204
  v_sub_f32 v27, v27, v204
  v_sub_f32 v28, v28, v204
  v_sub_f32 v29, v29, v204
  v_sub_f32 v30, v30, v204
  v_sub_f32 v31, v31, v204
  v_sub_f32 v56, v56, v204
  v_sub_f32 v57, v57, v204
  v_sub_f32 v58, v58, v204
  v_sub_f32 v59, v59, v204
  v_sub_f32 v60, v60, v204
  v_sub_f32 v61, v61, v204
  v_sub_f32 v62, v62, v204
  v_sub_f32 v63, v63, v204
  v_exp_f32 v24, v24
  v_exp_f32 v25, v25
  v_add_f32 v211, v211, v24
  v_exp_f32 v26, v26
  v_add_f32 v211, v211, v25
  v_cvt_pk_bf16_f32 v24, v24, v25
  v_exp_f32 v27, v27
  v_add_f32 v211, v211, v26
  v_add_f32 v211, v211, v27
  v_cvt_pk_bf16_f32 v25, v26, v27
  v_exp_f32 v28, v28
  v_exp_f32 v29, v29
  v_add_f32 v211, v211, v28
  v_exp_f32 v30, v30
  v_add_f32 v211, v211, v29
  v_cvt_pk_bf16_f32 v26, v28, v29
  v_exp_f32 v31, v31
  v_add_f32 v211, v211, v30
  v_add_f32 v211, v211, v31
  v_cvt_pk_bf16_f32 v27, v30, v31
  v_exp_f32 v56, v56
  v_exp_f32 v57, v57
  v_add_f32 v211, v211, v56
  v_exp_f32 v58, v58
  v_add_f32 v211, v211, v57
  v_cvt_pk_bf16_f32 v56, v56, v57
  v_exp_f32 v59, v59
  v_add_f32 v211, v211, v58
  v_add_f32 v211, v211, v59
  v_cvt_pk_bf16_f32 v57, v58, v59
  v_exp_f32 v60, v60
  v_exp_f32 v61, v61
  v_add_f32 v211, v211, v60
  v_exp_f32 v62, v62
  v_add_f32 v211, v211, v61
  v_cvt_pk_bf16_f32 v58, v60, v61
  v_exp_f32 v63, v63
  v_add_f32 v211, v211, v62
  v_add_f32 v211, v211, v63
  v_cvt_pk_bf16_f32 v59, v62, v63
  v_accvgpr_read_b32 v64, a12
  v_accvgpr_read_b32 v65, a13
  v_accvgpr_read_b32 v66, a14
  v_accvgpr_read_b32 v67, a15
  v_mul_f32 v64, v64, v205
  v_mul_f32 v65, v65, v205
  v_mul_f32 v66, v66, v205
  v_mul_f32 v67, v67, v205
  v_accvgpr_write_b32 a12, v64
  v_accvgpr_write_b32 a13, v65
  v_accvgpr_write_b32 a14, v66
  v_accvgpr_write_b32 a15, v67
  v_accvgpr_read_b32 v64, a28
  v_accvgpr_read_b32 v65, a29
  v_accvgpr_read_b32 v66, a30
  v_accvgpr_read_b32 v67, a31
  v_mul_f32 v64, v64, v205
  v_mul_f32 v65, v65, v205
  v_mul_f32 v66, v66, v205
  v_mul_f32 v67, v67, v205
  v_accvgpr_write_b32 a28, v64
  v_accvgpr_write_b32 a29, v65
  v_accvgpr_write_b32 a30, v66
  v_accvgpr_write_b32 a31, v67
  v_accvgpr_read_b32 v64, a44
  v_accvgpr_read_b32 v65, a45
  v_accvgpr_read_b32 v66, a46
  v_accvgpr_read_b32 v67, a47
  v_mul_f32 v64, v64, v205
  v_mul_f32 v65, v65, v205
  v_mul_f32 v66, v66, v205
  v_mul_f32 v67, v67, v205
  v_accvgpr_write_b32 a44, v64
  v_accvgpr_write_b32 a45, v65
  v_accvgpr_write_b32 a46, v66
  v_accvgpr_write_b32 a47, v67
  v_accvgpr_read_b32 v64, a60
  v_accvgpr_read_b32 v65, a61
  v_accvgpr_read_b32 v66, a62
  v_accvgpr_read_b32 v67, a63
  v_mul_f32 v64, v64, v205
  v_mul_f32 v65, v65, v205
  v_mul_f32 v66, v66, v205
  v_mul_f32 v67, v67, v205
  v_accvgpr_write_b32 a60, v64
  v_accvgpr_write_b32 a61, v65
  v_accvgpr_write_b32 a62, v66
  v_accvgpr_write_b32 a63, v67
  v_accvgpr_read_b32 v64, a76
  v_accvgpr_read_b32 v65, a77
  v_accvgpr_read_b32 v66, a78
  v_accvgpr_read_b32 v67, a79
  v_mul_f32 v64, v64, v205
  v_mul_f32 v65, v65, v205
  v_mul_f32 v66, v66, v205
  v_mul_f32 v67, v67, v205
  v_accvgpr_write_b32 a76, v64
  v_accvgpr_write_b32 a77, v65
  v_accvgpr_write_b32 a78, v66
  v_accvgpr_write_b32 a79, v67
  v_accvgpr_read_b32 v64, a92
  v_accvgpr_read_b32 v65, a93
  v_accvgpr_read_b32 v66, a94
  v_accvgpr_read_b32 v67, a95
  v_mul_f32 v64, v64, v205
  v_mul_f32 v65, v65, v205
  v_mul_f32 v66, v66, v205
  v_mul_f32 v67, v67, v205
  v_accvgpr_write_b32 a92, v64
  v_accvgpr_write_b32 a93, v65
  v_accvgpr_write_b32 a94, v66
  v_accvgpr_write_b32 a95, v67
  v_accvgpr_read_b32 v64, a108
  v_accvgpr_read_b32 v65, a109
  v_accvgpr_read_b32 v66, a110
  v_accvgpr_read_b32 v67, a111
  v_mul_f32 v64, v64, v205
  v_mul_f32 v65, v65, v205
  v_mul_f32 v66, v66, v205
  v_mul_f32 v67, v67, v205
  v_accvgpr_write_b32 a108, v64
  v_accvgpr_write_b32 a109, v65
  v_accvgpr_write_b32 a110, v66
  v_accvgpr_write_b32 a111, v67
  v_accvgpr_read_b32 v64, a124
  v_accvgpr_read_b32 v65, a125
  v_accvgpr_read_b32 v66, a126
  v_accvgpr_read_b32 v67, a127
  v_mul_f32 v64, v64, v205
  v_mul_f32 v65, v65, v205
  v_mul_f32 v66, v66, v205
  v_mul_f32 v67, v67, v205
  v_accvgpr_write_b32 a124, v64
  v_accvgpr_write_b32 a125, v65
  v_accvgpr_write_b32 a126, v66
  v_accvgpr_write_b32 a127, v67
  ds_read_b64_tr_b16 a[160:161], v216 offset:49152
  ds_read_b64_tr_b16 a[162:163], v216 offset:53248
  ds_read_b64_tr_b16 a[164:165], v216 offset:57344
  ds_read_b64_tr_b16 a[166:167], v216 offset:61440
  s_waitcnt lgkmcnt(2)
  v_mfma_f32_16x16x32_bf16 a[0:3], a[160:163], v[0:3], a[0:3]
  s_waitcnt lgkmcnt(0)
  v_mfma_f32_16x16x32_bf16 a[0:3], a[164:167], v[32:35], a[0:3]
  v_mfma_f32_16x16x32_bf16 a[4:7], a[164:167], v[40:43], a[4:7]
  v_mfma_f32_16x16x32_bf16 a[4:7], a[160:163], v[8:11], a[4:7]
  v_mfma_f32_16x16x32_bf16 a[8:11], a[160:163], v[16:19], a[8:11]
  v_mfma_f32_16x16x32_bf16 a[8:11], a[164:167], v[48:51], a[8:11]
  v_mfma_f32_16x16x32_bf16 a[12:15], a[164:167], v[56:59], a[12:15]
  v_mfma_f32_16x16x32_bf16 a[12:15], a[160:163], v[24:27], a[12:15]
  ds_read_b64_tr_b16 a[168:169], v217 offset:49152
  ds_read_b64_tr_b16 a[170:171], v217 offset:53248
  ds_read_b64_tr_b16 a[172:173], v217 offset:57344
  ds_read_b64_tr_b16 a[174:175], v217 offset:61440
  s_waitcnt lgkmcnt(2)
  v_mfma_f32_16x16x32_bf16 a[16:19], a[168:171], v[0:3], a[16:19]
  s_waitcnt lgkmcnt(0)
  v_mfma_f32_16x16x32_bf16 a[16:19], a[172:175], v[32:35], a[16:19]
  v_mfma_f32_16x16x32_bf16 a[20:23], a[172:175], v[40:43], a[20:23]
  v_mfma_f32_16x16x32_bf16 a[20:23], a[168:171], v[8:11], a[20:23]
  v_mfma_f32_16x16x32_bf16 a[24:27], a[168:171], v[16:19], a[24:27]
  v_mfma_f32_16x16x32_bf16 a[24:27], a[172:175], v[48:51], a[24:27]
  v_mfma_f32_16x16x32_bf16 a[28:31], a[172:175], v[56:59], a[28:31]
  v_mfma_f32_16x16x32_bf16 a[28:31], a[168:171], v[24:27], a[28:31]
  ds_read_b64_tr_b16 a[176:177], v218 offset:49152
  ds_read_b64_tr_b16 a[178:179], v218 offset:53248
  ds_read_b64_tr_b16 a[180:181], v218 offset:57344
  ds_read_b64_tr_b16 a[182:183], v218 offset:61440
  s_waitcnt lgkmcnt(2)
  v_mfma_f32_16x16x32_bf16 a[32:35], a[176:179], v[0:3], a[32:35]
  s_waitcnt lgkmcnt(0)
  v_mfma_f32_16x16x32_bf16 a[32:35], a[180:183], v[32:35], a[32:35]
  v_mfma_f32_16x16x32_bf16 a[36:39], a[180:183], v[40:43], a[36:39]
  v_mfma_f32_16x16x32_bf16 a[36:39], a[176:179], v[8:11], a[36:39]
  v_mfma_f32_16x16x32_bf16 a[40:43], a[176:179], v[16:19], a[40:43]
  v_mfma_f32_16x16x32_bf16 a[40:43], a[180:183], v[48:51], a[40:43]
  v_mfma_f32_16x16x32_bf16 a[44:47], a[180:183], v[56:59], a[44:47]
  v_mfma_f32_16x16x32_bf16 a[44:47], a[176:179], v[24:27], a[44:47]
  ds_read_b64_tr_b16 a[184:185], v219 offset:49152
  ds_read_b64_tr_b16 a[186:187], v219 offset:53248
  ds_read_b64_tr_b16 a[188:189], v219 offset:57344
  ds_read_b64_tr_b16 a[190:191], v219 offset:61440
  s_waitcnt lgkmcnt(2)
  v_mfma_f32_16x16x32_bf16 a[48:51], a[184:187], v[0:3], a[48:51]
  s_waitcnt lgkmcnt(0)
  v_mfma_f32_16x16x32_bf16 a[48:51], a[188:191], v[32:35], a[48:51]
  v_mfma_f32_16x16x32_bf16 a[52:55], a[188:191], v[40:43], a[52:55]
  v_mfma_f32_16x16x32_bf16 a[52:55], a[184:187], v[8:11], a[52:55]
  v_mfma_f32_16x16x32_bf16 a[56:59], a[184:187], v[16:19], a[56:59]
  v_mfma_f32_16x16x32_bf16 a[56:59], a[188:191], v[48:51], a[56:59]
  v_mfma_f32_16x16x32_bf16 a[60:63], a[188:191], v[56:59], a[60:63]
  v_mfma_f32_16x16x32_bf16 a[60:63], a[184:187], v[24:27], a[60:63]
  ds_read_b64_tr_b16 a[160:161], v220 offset:49152
  ds_read_b64_tr_b16 a[162:163], v220 offset:53248
  ds_read_b64_tr_b16 a[164:165], v220 offset:57344
  ds_read_b64_tr_b16 a[166:167], v220 offset:61440
  s_waitcnt lgkmcnt(2)
  v_mfma_f32_16x16x32_bf16 a[64:67], a[160:163], v[0:3], a[64:67]
  s_waitcnt lgkmcnt(0)
  v_mfma_f32_16x16x32_bf16 a[64:67], a[164:167], v[32:35], a[64:67]
  v_mfma_f32_16x16x32_bf16 a[68:71], a[164:167], v[40:43], a[68:71]
  v_mfma_f32_16x16x32_bf16 a[68:71], a[160:163], v[8:11], a[68:71]
  v_mfma_f32_16x16x32_bf16 a[72:75], a[160:163], v[16:19], a[72:75]
  v_mfma_f32_16x16x32_bf16 a[72:75], a[164:167], v[48:51], a[72:75]
  v_mfma_f32_16x16x32_bf16 a[76:79], a[164:167], v[56:59], a[76:79]
  v_mfma_f32_16x16x32_bf16 a[76:79], a[160:163], v[24:27], a[76:79]
  ds_read_b64_tr_b16 a[168:169], v221 offset:49152
  ds_read_b64_tr_b16 a[170:171], v221 offset:53248
  ds_read_b64_tr_b16 a[172:173], v221 offset:57344
  ds_read_b64_tr_b16 a[174:175], v221 offset:61440
  s_waitcnt lgkmcnt(2)
  v_mfma_f32_16x16x32_bf16 a[80:83], a[168:171], v[0:3], a[80:83]
  s_waitcnt lgkmcnt(0)
  v_mfma_f32_16x16x32_bf16 a[80:83], a[172:175], v[32:35], a[80:83]
  v_mfma_f32_16x16x32_bf16 a[84:87], a[172:175], v[40:43], a[84:87]
  v_mfma_f32_16x16x32_bf16 a[84:87], a[168:171], v[8:11], a[84:87]
  v_mfma_f32_16x16x32_bf16 a[88:91], a[168:171], v[16:19], a[88:91]
  v_mfma_f32_16x16x32_bf16 a[88:91], a[172:175], v[48:51], a[88:91]
  v_mfma_f32_16x16x32_bf16 a[92:95], a[172:175], v[56:59], a[92:95]
  v_mfma_f32_16x16x32_bf16 a[92:95], a[168:171], v[24:27], a[92:95]
  ds_read_b64_tr_b16 a[176:177], v222 offset:49152
  ds_read_b64_tr_b16 a[178:179], v222 offset:53248
  ds_read_b64_tr_b16 a[180:181], v222 offset:57344
  ds_read_b64_tr_b16 a[182:183], v222 offset:61440
  s_waitcnt lgkmcnt(2)
  v_mfma_f32_16x16x32_bf16 a[96:99], a[176:179], v[0:3], a[96:99]
  s_waitcnt lgkmcnt(0)
  v_mfma_f32_16x16x32_bf16 a[96:99], a[180:183], v[32:35], a[96:99]
  v_mfma_f32_16x16x32_bf16 a[100:103], a[180:183], v[40:43], a[100:103]
  v_mfma_f32_16x16x32_bf16 a[100:103], a[176:179], v[8:11], a[100:103]
  v_mfma_f32_16x16x32_bf16 a[104:107], a[176:179], v[16:19], a[104:107]
  v_mfma_f32_16x16x32_bf16 a[104:107], a[180:183], v[48:51], a[104:107]
  v_mfma_f32_16x16x32_bf16 a[108:111], a[180:183], v[56:59], a[108:111]
  v_mfma_f32_16x16x32_bf16 a[108:111], a[176:179], v[24:27], a[108:111]
  ds_read_b64_tr_b16 a[184:185], v223 offset:49152
  ds_read_b64_tr_b16 a[186:187], v223 offset:53248
  ds_read_b64_tr_b16 a[188:189], v223 offset:57344
  ds_read_b64_tr_b16 a[190:191], v223 offset:61440
  s_waitcnt lgkmcnt(2)
  v_mfma_f32_16x16x32_bf16 a[112:115], a[184:187], v[0:3], a[112:115]
  s_waitcnt lgkmcnt(0)
  v_mfma_f32_16x16x32_bf16 a[112:115], a[188:191], v[32:35], a[112:115]
  v_mfma_f32_16x16x32_bf16 a[116:119], a[188:191], v[40:43], a[116:119]
  v_mfma_f32_16x16x32_bf16 a[116:119], a[184:187], v[8:11], a[116:119]
  v_mfma_f32_16x16x32_bf16 a[120:123], a[184:187], v[16:19], a[120:123]
  v_mfma_f32_16x16x32_bf16 a[120:123], a[188:191], v[48:51], a[120:123]
  v_mfma_f32_16x16x32_bf16 a[124:127], a[188:191], v[56:59], a[124:127]
  v_mfma_f32_16x16x32_bf16 a[124:127], a[184:187], v[24:27], a[124:127]
  s_add_u32 s29, s29, 16384
  s_cmp_lt_u32 s29, 524288
  s_cbranch_scc1 attn_slow
  v_mov_b32 v245, v208
  v_mov_b32 v246, v209
  v_mov_b32 v247, v210
  v_mov_b32 v248, v211
  v_permlane16_swap_b32 v208, v245
  v_permlane16_swap_b32 v209, v246
  v_permlane16_swap_b32 v210, v247
  v_permlane16_swap_b32 v211, v248
  v_add_f32 v208, v208, v245
  v_add_f32 v209, v209, v246
  v_add_f32 v210, v210, v247
  v_add_f32 v211, v211, v248
  v_mov_b32 v245, v208
  v_mov_b32 v246, v209
  v_mov_b32 v247, v210
  v_mov_b32 v248, v211
  v_permlane32_swap_b32 v208, v245
  v_permlane32_swap_b32 v209, v246
  v_permlane32_swap_b32 v210, v247
  v_permlane32_swap_b32 v211, v248
  v_add_f32 v208, v208, v245
  v_add_f32 v209, v209, v246
  v_add_f32 v210, v210, v247
  v_add_f32 v211, v211, v248
  v_rcp_f32 v192, v208
  v_rcp_f32 v196, v209
  v_rcp_f32 v200, v210
  v_rcp_f32 v204, v211
  v_accvgpr_read_b32 v0, a0
  v_accvgpr_read_b32 v1, a1
  v_accvgpr_read_b32 v2, a2
  v_accvgpr_read_b32 v3, a3
  v_accvgpr_read_b32 v4, a16
  v_accvgpr_read_b32 v5, a17
  v_accvgpr_read_b32 v6, a18
  v_accvgpr_read_b32 v7, a19
  v_mul_f32 v0, v0, v192
  v_mul_f32 v1, v1, v192
  v_mul_f32 v2, v2, v192
  v_mul_f32 v3, v3, v192
  v_mul_f32 v4, v4, v192
  v_mul_f32 v5, v5, v192
  v_mul_f32 v6, v6, v192
  v_mul_f32 v7, v7, v192
  v_cvt_pk_bf16_f32 v0, v0, v1
  v_cvt_pk_bf16_f32 v1, v2, v3
  v_cvt_pk_bf16_f32 v2, v4, v5
  v_cvt_pk_bf16_f32 v3, v6, v7
  buffer_store_dwordx4 v[0:3], v244, s[24:27], s40 offen offset:0 sc1
  v_accvgpr_read_b32 v8, a4
  v_accvgpr_read_b32 v9, a5
  v_accvgpr_read_b32 v10, a6
  v_accvgpr_read_b32 v11, a7
  v_accvgpr_read_b32 v12, a20
  v_accvgpr_read_b32 v13, a21
  v_accvgpr_read_b32 v14, a22
  v_accvgpr_read_b32 v15, a23
  v_mul_f32 v8, v8, v196
  v_mul_f32 v9, v9, v196
  v_mul_f32 v10, v10, v196
  v_mul_f32 v11, v11, v196
  v_mul_f32 v12, v12, v196
  v_mul_f32 v13, v13, v196
  v_mul_f32 v14, v14, v196
  v_mul_f32 v15, v15, v196
  v_cvt_pk_bf16_f32 v8, v8, v9
  v_cvt_pk_bf16_f32 v9, v10, v11
  v_cvt_pk_bf16_f32 v10, v12, v13
  v_cvt_pk_bf16_f32 v11, v14, v15
  buffer_store_dwordx4 v[8:11], v244, s[24:27], s40 offen offset:2048 sc1
  v_accvgpr_read_b32 v16, a8
  v_accvgpr_read_b32 v17, a9
  v_accvgpr_read_b32 v18, a10
  v_accvgpr_read_b32 v19, a11
  v_accvgpr_read_b32 v20, a24
  v_accvgpr_read_b32 v21, a25
  v_accvgpr_read_b32 v22, a26
  v_accvgpr_read_b32 v23, a27
  v_mul_f32 v16, v16, v200
  v_mul_f32 v17, v17, v200
  v_mul_f32 v18, v18, v200
  v_mul_f32 v19, v19, v200
  v_mul_f32 v20, v20, v200
  v_mul_f32 v21, v21, v200
  v_mul_f32 v22, v22, v200
  v_mul_f32 v23, v23, v200
  v_cvt_pk_bf16_f32 v16, v16, v17
  v_cvt_pk_bf16_f32 v17, v18, v19
  v_cvt_pk_bf16_f32 v18, v20, v21
  v_cvt_pk_bf16_f32 v19, v22, v23
  buffer_store_dwordx4 v[16:19], v244, s[24:27], s41 offen offset:0 sc1
  v_accvgpr_read_b32 v24, a12
  v_accvgpr_read_b32 v25, a13
  v_accvgpr_read_b32 v26, a14
  v_accvgpr_read_b32 v27, a15
  v_accvgpr_read_b32 v28, a28
  v_accvgpr_read_b32 v29, a29
  v_accvgpr_read_b32 v30, a30
  v_accvgpr_read_b32 v31, a31
  v_mul_f32 v24, v24, v204
  v_mul_f32 v25, v25, v204
  v_mul_f32 v26, v26, v204
  v_mul_f32 v27, v27, v204
  v_mul_f32 v28, v28, v204
  v_mul_f32 v29, v29, v204
  v_mul_f32 v30, v30, v204
  v_mul_f32 v31, v31, v204
  v_cvt_pk_bf16_f32 v24, v24, v25
  v_cvt_pk_bf16_f32 v25, v26, v27
  v_cvt_pk_bf16_f32 v26, v28, v29
  v_cvt_pk_bf16_f32 v27, v30, v31
  buffer_store_dwordx4 v[24:27], v244, s[24:27], s41 offen offset:2048 sc1
  v_accvgpr_read_b32 v32, a32
  v_accvgpr_read_b32 v33, a33
  v_accvgpr_read_b32 v34, a34
  v_accvgpr_read_b32 v35, a35
  v_accvgpr_read_b32 v36, a48
  v_accvgpr_read_b32 v37, a49
  v_accvgpr_read_b32 v38, a50
  v_accvgpr_read_b32 v39, a51
  v_mul_f32 v32, v32, v192
  v_mul_f32 v33, v33, v192
  v_mul_f32 v34, v34, v192
  v_mul_f32 v35, v35, v192
  v_mul_f32 v36, v36, v192
  v_mul_f32 v37, v37, v192
  v_mul_f32 v38, v38, v192
  v_mul_f32 v39, v39, v192
  v_cvt_pk_bf16_f32 v32, v32, v33
  v_cvt_pk_bf16_f32 v33, v34, v35
  v_cvt_pk_bf16_f32 v34, v36, v37
  v_cvt_pk_bf16_f32 v35, v38, v39
  buffer_store_dwordx4 v[32:35], v244, s[24:27], s40 offen offset:1024 sc1
  v_accvgpr_read_b32 v40, a36
  v_accvgpr_read_b32 v41, a37
  v_accvgpr_read_b32 v42, a38
  v_accvgpr_read_b32 v43, a39
  v_accvgpr_read_b32 v44, a52
  v_accvgpr_read_b32 v45, a53
  v_accvgpr_read_b32 v46, a54
  v_accvgpr_read_b32 v47, a55
  v_mul_f32 v40, v40, v196
  v_mul_f32 v41, v41, v196
  v_mul_f32 v42, v42, v196
  v_mul_f32 v43, v43, v196
  v_mul_f32 v44, v44, v196
  v_mul_f32 v45, v45, v196
  v_mul_f32 v46, v46, v196
  v_mul_f32 v47, v47, v196
  v_cvt_pk_bf16_f32 v40, v40, v41
  v_cvt_pk_bf16_f32 v41, v42, v43
  v_cvt_pk_bf16_f32 v42, v44, v45
  v_cvt_pk_bf16_f32 v43, v46, v47
  buffer_store_dwordx4 v[40:43], v244, s[24:27], s40 offen offset:3072 sc1
  v_accvgpr_read_b32 v48, a40
  v_accvgpr_read_b32 v49, a41
  v_accvgpr_read_b32 v50, a42
  v_accvgpr_read_b32 v51, a43
  v_accvgpr_read_b32 v52, a56
  v_accvgpr_read_b32 v53, a57
  v_accvgpr_read_b32 v54, a58
  v_accvgpr_read_b32 v55, a59
  v_mul_f32 v48, v48, v200
  v_mul_f32 v49, v49, v200
  v_mul_f32 v50, v50, v200
  v_mul_f32 v51, v51, v200
  v_mul_f32 v52, v52, v200
  v_mul_f32 v53, v53, v200
  v_mul_f32 v54, v54, v200
  v_mul_f32 v55, v55, v200
  v_cvt_pk_bf16_f32 v48, v48, v49
  v_cvt_pk_bf16_f32 v49, v50, v51
  v_cvt_pk_bf16_f32 v50, v52, v53
  v_cvt_pk_bf16_f32 v51, v54, v55
  buffer_store_dwordx4 v[48:51], v244, s[24:27], s41 offen offset:1024 sc1
  v_accvgpr_read_b32 v56, a44
  v_accvgpr_read_b32 v57, a45
  v_accvgpr_read_b32 v58, a46
  v_accvgpr_read_b32 v59, a47
  v_accvgpr_read_b32 v60, a60
  v_accvgpr_read_b32 v61, a61
  v_accvgpr_read_b32 v62, a62
  v_accvgpr_read_b32 v63, a63
  v_mul_f32 v56, v56, v204
  v_mul_f32 v57, v57, v204
  v_mul_f32 v58, v58, v204
  v_mul_f32 v59, v59, v204
  v_mul_f32 v60, v60, v204
  v_mul_f32 v61, v61, v204
  v_mul_f32 v62, v62, v204
  v_mul_f32 v63, v63, v204
  v_cvt_pk_bf16_f32 v56, v56, v57
  v_cvt_pk_bf16_f32 v57, v58, v59
  v_cvt_pk_bf16_f32 v58, v60, v61
  v_cvt_pk_bf16_f32 v59, v62, v63
  buffer_store_dwordx4 v[56:59], v244, s[24:27], s41 offen offset:3072 sc1
  v_accvgpr_read_b32 v0, a64
  v_accvgpr_read_b32 v1, a65
  v_accvgpr_read_b32 v2, a66
  v_accvgpr_read_b32 v3, a67
  v_accvgpr_read_b32 v4, a80
  v_accvgpr_read_b32 v5, a81
  v_accvgpr_read_b32 v6, a82
  v_accvgpr_read_b32 v7, a83
  v_mul_f32 v0, v0, v192
  v_mul_f32 v1, v1, v192
  v_mul_f32 v2, v2, v192
  v_mul_f32 v3, v3, v192
  v_mul_f32 v4, v4, v192
  v_mul_f32 v5, v5, v192
  v_mul_f32 v6, v6, v192
  v_mul_f32 v7, v7, v192
  v_cvt_pk_bf16_f32 v0, v0, v1
  v_cvt_pk_bf16_f32 v1, v2, v3
  v_cvt_pk_bf16_f32 v2, v4, v5
  v_cvt_pk_bf16_f32 v3, v6, v7
  buffer_store_dwordx4 v[0:3], v244, s[24:27], s42 offen offset:0 sc1
  v_accvgpr_read_b32 v8, a68
  v_accvgpr_read_b32 v9, a69
  v_accvgpr_read_b32 v10, a70
  v_accvgpr_read_b32 v11, a71
  v_accvgpr_read_b32 v12, a84
  v_accvgpr_read_b32 v13, a85
  v_accvgpr_read_b32 v14, a86
  v_accvgpr_read_b32 v15, a87
  v_mul_f32 v8, v8, v196
  v_mul_f32 v9, v9, v196
  v_mul_f32 v10, v10, v196
  v_mul_f32 v11, v11, v196
  v_mul_f32 v12, v12, v196
  v_mul_f32 v13, v13, v196
  v_mul_f32 v14, v14, v196
  v_mul_f32 v15, v15, v196
  v_cvt_pk_bf16_f32 v8, v8, v9
  v_cvt_pk_bf16_f32 v9, v10, v11
  v_cvt_pk_bf16_f32 v10, v12, v13
  v_cvt_pk_bf16_f32 v11, v14, v15
  buffer_store_dwordx4 v[8:11], v244, s[24:27], s42 offen offset:2048 sc1
  v_accvgpr_read_b32 v16, a72
  v_accvgpr_read_b32 v17, a73
  v_accvgpr_read_b32 v18, a74
  v_accvgpr_read_b32 v19, a75
  v_accvgpr_read_b32 v20, a88
  v_accvgpr_read_b32 v21, a89
  v_accvgpr_read_b32 v22, a90
  v_accvgpr_read_b32 v23, a91
  v_mul_f32 v16, v16, v200
  v_mul_f32 v17, v17, v200
  v_mul_f32 v18, v18, v200
  v_mul_f32 v19, v19, v200
  v_mul_f32 v20, v20, v200
  v_mul_f32 v21, v21, v200
  v_mul_f32 v22, v22, v200
  v_mul_f32 v23, v23, v200
  v_cvt_pk_bf16_f32 v16, v16, v17
  v_cvt_pk_bf16_f32 v17, v18, v19
  v_cvt_pk_bf16_f32 v18, v20, v21
  v_cvt_pk_bf16_f32 v19, v22, v23
  buffer_store_dwordx4 v[16:19], v244, s[24:27], s43 offen offset:0 sc1
  v_accvgpr_read_b32 v24, a76
  v_accvgpr_read_b32 v25, a77
  v_accvgpr_read_b32 v26, a78
  v_accvgpr_read_b32 v27, a79
  v_accvgpr_read_b32 v28, a92
  v_accvgpr_read_b32 v29, a93
  v_accvgpr_read_b32 v30, a94
  v_accvgpr_read_b32 v31, a95
  v_mul_f32 v24, v24, v204
  v_mul_f32 v25, v25, v204
  v_mul_f32 v26, v26, v204
  v_mul_f32 v27, v27, v204
  v_mul_f32 v28, v28, v204
  v_mul_f32 v29, v29, v204
  v_mul_f32 v30, v30, v204
  v_mul_f32 v31, v31, v204
  v_cvt_pk_bf16_f32 v24, v24, v25
  v_cvt_pk_bf16_f32 v25, v26, v27
  v_cvt_pk_bf16_f32 v26, v28, v29
  v_cvt_pk_bf16_f32 v27, v30, v31
  buffer_store_dwordx4 v[24:27], v244, s[24:27], s43 offen offset:2048 sc1
  v_accvgpr_read_b32 v32, a96
  v_accvgpr_read_b32 v33, a97
  v_accvgpr_read_b32 v34, a98
  v_accvgpr_read_b32 v35, a99
  v_accvgpr_read_b32 v36, a112
  v_accvgpr_read_b32 v37, a113
  v_accvgpr_read_b32 v38, a114
  v_accvgpr_read_b32 v39, a115
  v_mul_f32 v32, v32, v192
  v_mul_f32 v33, v33, v192
  v_mul_f32 v34, v34, v192
  v_mul_f32 v35, v35, v192
  v_mul_f32 v36, v36, v192
  v_mul_f32 v37, v37, v192
  v_mul_f32 v38, v38, v192
  v_mul_f32 v39, v39, v192
  v_cvt_pk_bf16_f32 v32, v32, v33
  v_cvt_pk_bf16_f32 v33, v34, v35
  v_cvt_pk_bf16_f32 v34, v36, v37
  v_cvt_pk_bf16_f32 v35, v38, v39
  buffer_store_dwordx4 v[32:35], v244, s[24:27], s42 offen offset:1024 sc1
  v_accvgpr_read_b32 v40, a100
  v_accvgpr_read_b32 v41, a101
  v_accvgpr_read_b32 v42, a102
  v_accvgpr_read_b32 v43, a103
  v_accvgpr_read_b32 v44, a116
  v_accvgpr_read_b32 v45, a117
  v_accvgpr_read_b32 v46, a118
  v_accvgpr_read_b32 v47, a119
  v_mul_f32 v40, v40, v196
  v_mul_f32 v41, v41, v196
  v_mul_f32 v42, v42, v196
  v_mul_f32 v43, v43, v196
  v_mul_f32 v44, v44, v196
  v_mul_f32 v45, v45, v196
  v_mul_f32 v46, v46, v196
  v_mul_f32 v47, v47, v196
  v_cvt_pk_bf16_f32 v40, v40, v41
  v_cvt_pk_bf16_f32 v41, v42, v43
  v_cvt_pk_bf16_f32 v42, v44, v45
  v_cvt_pk_bf16_f32 v43, v46, v47
  buffer_store_dwordx4 v[40:43], v244, s[24:27], s42 offen offset:3072 sc1
  v_accvgpr_read_b32 v48, a104
  v_accvgpr_read_b32 v49, a105
  v_accvgpr_read_b32 v50, a106
  v_accvgpr_read_b32 v51, a107
  v_accvgpr_read_b32 v52, a120
  v_accvgpr_read_b32 v53, a121
  v_accvgpr_read_b32 v54, a122
  v_accvgpr_read_b32 v55, a123
  v_mul_f32 v48, v48, v200
  v_mul_f32 v49, v49, v200
  v_mul_f32 v50, v50, v200
  v_mul_f32 v51, v51, v200
  v_mul_f32 v52, v52, v200
  v_mul_f32 v53, v53, v200
  v_mul_f32 v54, v54, v200
  v_mul_f32 v55, v55, v200
  v_cvt_pk_bf16_f32 v48, v48, v49
  v_cvt_pk_bf16_f32 v49, v50, v51
  v_cvt_pk_bf16_f32 v50, v52, v53
  v_cvt_pk_bf16_f32 v51, v54, v55
  buffer_store_dwordx4 v[48:51], v244, s[24:27], s43 offen offset:1024 sc1
  v_accvgpr_read_b32 v56, a108
  v_accvgpr_read_b32 v57, a109
  v_accvgpr_read_b32 v58, a110
  v_accvgpr_read_b32 v59, a111
  v_accvgpr_read_b32 v60, a124
  v_accvgpr_read_b32 v61, a125
  v_accvgpr_read_b32 v62, a126
  v_accvgpr_read_b32 v63, a127
  v_mul_f32 v56, v56, v204
  v_mul_f32 v57, v57, v204
  v_mul_f32 v58, v58, v204
  v_mul_f32 v59, v59, v204
  v_mul_f32 v60, v60, v204
  v_mul_f32 v61, v61, v204
  v_mul_f32 v62, v62, v204
  v_mul_f32 v63, v63, v204
  v_cvt_pk_bf16_f32 v56, v56, v57
  v_cvt_pk_bf16_f32 v57, v58, v59
  v_cvt_pk_bf16_f32 v58, v60, v61
  v_cvt_pk_bf16_f32 v59, v62, v63
  buffer_store_dwordx4 v[56:59], v244, s[24:27], s43 offen offset:3072 sc1
  v_add_u32 v252, 4096, v242
  v_add_u32 v253, 8192, v242
  buffer_load_dwordx4 a[128:131], v253, s[24:27], s4 offen offset:3072 sc1
  buffer_load_dwordx4 a[132:135], v242, s[24:27], s5 offen offset:0 sc1
  buffer_load_dwordx4 a[136:139], v242, s[24:27], s5 offen offset:1024 sc1
  buffer_load_dwordx4 a[140:143], v242, s[24:27], s5 offen offset:2048 sc1
  buffer_load_dwordx4 a[144:147], v242, s[24:27], s5 offen offset:3072 sc1
  buffer_load_dwordx4 a[148:151], v252, s[24:27], s5 offen offset:0 sc1
  buffer_load_dwordx4 a[152:155], v252, s[24:27], s5 offen offset:1024 sc1
  buffer_load_dwordx4 a[156:159], v252, s[24:27], s5 offen offset:2048 sc1
  buffer_load_dwordx4 v[128:131], v252, s[24:27], s5 offen offset:3072 sc1
  buffer_load_dwordx4 v[132:135], v253, s[24:27], s5 offen offset:0 sc1
  buffer_load_dwordx4 v[136:139], v253, s[24:27], s5 offen offset:1024 sc1
  buffer_load_dwordx4 v[140:143], v253, s[24:27], s5 offen offset:2048 sc1
  buffer_load_dwordx4 v[144:147], v253, s[24:27], s5 offen offset:3072 sc1
  buffer_load_dwordx4 v[148:151], v242, s[24:27], s6 offen offset:0 sc1
  buffer_load_dwordx4 v[152:155], v242, s[24:27], s6 offen offset:1024 sc1
  buffer_load_dwordx4 v[156:159], v242, s[24:27], s6 offen offset:2048 sc1
  buffer_load_dwordx4 v[160:163], v242, s[24:27], s6 offen offset:3072 sc1
  buffer_load_dwordx4 v[164:167], v252, s[24:27], s6 offen offset:0 sc1
  buffer_load_dwordx4 v[168:171], v252, s[24:27], s6 offen offset:1024 sc1
  buffer_load_dwordx4 v[172:175], v252, s[24:27], s6 offen offset:2048 sc1
  buffer_load_dwordx4 v[176:179], v252, s[24:27], s6 offen offset:3072 sc1
  buffer_load_dwordx4 v[180:183], v253, s[24:27], s6 offen offset:0 sc1
  buffer_load_dwordx4 v[184:187], v253, s[24:27], s6 offen offset:1024 sc1
  buffer_load_dwordx4 v[188:191], v253, s[24:27], s6 offen offset:2048 sc1
  buffer_load_dwordx4 a[0:3], v253, s[24:27], s6 offen offset:3072 sc1
  buffer_load_dwordx4 a[4:7], v242, s[24:27], s7 offen offset:0 sc1
  buffer_load_dwordx4 a[8:11], v242, s[24:27], s7 offen offset:1024 sc1
  buffer_load_dwordx4 a[12:15], v242, s[24:27], s7 offen offset:2048 sc1
  s_lshr_b32 s39, s37, 2
  s_lshl_b32 s39, s39, 3
  s_lshr_b32 s38, s36, 2
  s_add_u32 s39, s39, s38
  s_lshl_b32 s39, s39, 7
  s_add_u32 s39, s39, 2867200
  s_lshl_b32 s38, s3, 26
  v_lshlrev_b32 v64, 22, v242
  v_or_b32 v64, s38, v64
  v_mov_b32 v65, 1
  s_waitcnt vmcnt(0)
  s_barrier
  s_branch tail_go
attn_wait0:
  s_mov_b32 s96, 524288
attn_again0:
  ds_read_b32 v248, v247
  s_waitcnt lgkmcnt(0)
  v_cmp_lt_u32 vcc, v248, v245
  s_nop 1
  s_cbranch_vccz attn_on0
  s_sub_u32 s96, s96, 1
  s_cmp_lg_u32 s96, 0
  s_cbranch_scc1 attn_again0
  s_branch attn_on0
attn_wait1:
  s_mov_b32 s96, 524288
attn_again1:
  ds_read_b32 v248, v247
  s_waitcnt lgkmcnt(0)
  v_cmp_lt_u32 vcc, v248, v245
  s_nop 1
  s_cbranch_vccz attn_on1
  s_sub_u32 s96, s96, 1
  s_cmp_lg_u32 s96, 0
  s_cbranch_scc1 attn_again1
  s_branch attn_on1
attn_wait2:
  s_mov_b32 s96, 524288
attn_again2:
  ds_read_b32 v248, v247
  s_waitcnt lgkmcnt(0)
  v_cmp_lt_u32 vcc, v248, v245
  s_nop 1
  s_cbranch_vccz attn_on2
  s_sub_u32 s96, s96, 1
  s_cmp_lg_u32 s96, 0
  s_cbranch_scc1 attn_again2
  s_branch attn_on2
attn_wait3:
  s_mov_b32 s96, 524288
attn_again3:
  ds_read_b32 v248, v247
  s_waitcnt lgkmcnt(0)
  v_cmp_lt_u32 vcc, v248, v245
  s_nop 1
  s_cbranch_vccz attn_on3
  s_sub_u32 s96, s96, 1
  s_cmp_lg_u32 s96, 0
  s_cbranch_scc1 attn_again3
  s_branch attn_on3
attn_wait4:
  s_mov_b32 s96, 524288
attn_again4:
  ds_read_b32 v248, v247
  s_waitcnt lgkmcnt(0)
  v_cmp_lt_u32 vcc, v248, v245
  s_nop 1
  s_cbranch_vccz attn_on4
  s_sub_u32 s96, s96, 1
  s_cmp_lg_u32 s96, 0
  s_cbranch_scc1 attn_again4
  s_branch attn_on4
attn_wait5:
  s_mov_b32 s96, 524288
attn_again5:
  ds_read_b32 v248, v247
  s_waitcnt lgkmcnt(0)
  v_cmp_lt_u32 vcc, v248, v245
  s_nop 1
  s_cbranch_vccz attn_on5
  s_sub_u32 s96, s96, 1
  s_cmp_lg_u32 s96, 0
  s_cbranch_scc1 attn_again5
  s_branch attn_on5
attn_wait6:
  s_mov_b32 s96, 524288
attn_again6:
  ds_read_b32 v248, v247
  s_waitcnt lgkmcnt(0)
  v_cmp_lt_u32 vcc, v248, v245
  s_nop 1
  s_cbranch_vccz attn_on6
  s_sub_u32 s96, s96, 1
  s_cmp_lg_u32 s96, 0
  s_cbranch_scc1 attn_again6
  s_branch attn_on6
attn_wait7:
  s_mov_b32 s96, 524288
attn_again7:
  ds_read_b32 v248, v247
  s_waitcnt lgkmcnt(0)
  v_cmp_lt_u32 vcc, v248, v245
  s_nop 1
  s_cbranch_vccz attn_on7
  s_sub_u32 s96, s96, 1
  s_cmp_lg_u32 s96, 0
  s_cbranch_scc1 attn_again7
  s_branch attn_on7
attn_wait8:
  s_mov_b32 s96, 524288
attn_again8:
  ds_read_b32 v248, v247
  s_waitcnt lgkmcnt(0)
  v_cmp_lt_u32 vcc, v248, v245
  s_nop 1
  s_cbranch_vccz attn_on8
  s_sub_u32 s96, s96, 1
  s_cmp_lg_u32 s96, 0
  s_cbranch_scc1 attn_again8
  s_branch attn_on8
attn_wait9:
  s_mov_b32 s96, 524288
attn_again9:
  ds_read_b32 v248, v247
  s_waitcnt lgkmcnt(0)
  v_cmp_lt_u32 vcc, v248, v245
  s_nop 1
  s_cbranch_vccz attn_on9
  s_sub_u32 s96, s96, 1
  s_cmp_lg_u32 s96, 0
  s_cbranch_scc1 attn_again9
  s_branch attn_on9
attn_wait10:
  s_mov_b32 s96, 524288
attn_again10:
  ds_read_b32 v248, v247
  s_waitcnt lgkmcnt(0)
  v_cmp_lt_u32 vcc, v248, v245
  s_nop 1
  s_cbranch_vccz attn_on10
  s_sub_u32 s96, s96, 1
  s_cmp_lg_u32 s96, 0
  s_cbranch_scc1 attn_again10
  s_branch attn_on10
attn_wait27:
  s_mov_b32 s96, 524288
attn_again27:
  ds_read_b32 v248, v247
  s_waitcnt lgkmcnt(0)
  v_cmp_lt_u32 vcc, v248, v245
  s_nop 1
  s_cbranch_vccz attn_on27
  s_sub_u32 s96, s96, 1
  s_cmp_lg_u32 s96, 0
  s_cbranch_scc1 attn_again27
  s_branch attn_on27
attn_wait28:
  s_mov_b32 s96, 524288
attn_again28:
  ds_read_b32 v248, v247
  s_waitcnt lgkmcnt(0)
  v_cmp_lt_u32 vcc, v248, v245
  s_nop 1
  s_cbranch_vccz attn_on28
  s_sub_u32 s96, s96, 1
  s_cmp_lg_u32 s96, 0
  s_cbranch_scc1 attn_again28
  s_branch attn_on28
attn_wait29:
  s_mov_b32 s96, 524288
attn_again29:
  ds_read_b32 v248, v247
  s_waitcnt lgkmcnt(0)
  v_cmp_lt_u32 vcc, v248, v245
  s_nop 1
  s_cbranch_vccz attn_on29
  s_sub_u32 s96, s96, 1
  s_cmp_lg_u32 s96, 0
  s_cbranch_scc1 attn_again29
  s_branch attn_on29
attn_wait30:
  s_mov_b32 s96, 524288
attn_again30:
  ds_read_b32 v248, v247
  s_waitcnt lgkmcnt(0)
  v_cmp_lt_u32 vcc, v248, v245
  s_nop 1
  s_cbranch_vccz attn_on30
  s_sub_u32 s96, s96, 1
  s_cmp_lg_u32 s96, 0
  s_cbranch_scc1 attn_again30
  s_branch attn_on30
.section .rodata,"a"
.p2align 6
.amdhsa_kernel recurrent_scan__mha_block_cached__moe_arch_mod__prompt_kernel
  .amdhsa_next_free_vgpr 512
  .amdhsa_next_free_sgpr 102
  .amdhsa_accum_offset 256
  .amdhsa_group_segment_fixed_size 0
  .amdhsa_kernarg_size 104
  .amdhsa_user_sgpr_count 2
  .amdhsa_user_sgpr_kernarg_segment_ptr 1
  .amdhsa_system_sgpr_workgroup_id_x 1
.end_amdhsa_kernel
```
